```python
import torch

def _softmax(x, axis=-1):
    return torch.softmax(x, dim=axis)
def _gelu(x):
    return torch.nn.functional.gelu(x, approximate="tanh")
def _silu(x):
    return torch.nn.functional.silu(x)
def _sigmoid(x):
    return torch.sigmoid(x)
def _layernorm(x, axis=-1, eps=1e-5):
    m = x.mean(dim=axis, keepdim=True)
    v = x.var(dim=axis, keepdim=True, unbiased=False)
    return (x - m) / torch.sqrt(v + eps)
def _scatter_add(tgt, idx, src, axis=0):
    return tgt.clone().index_add_(axis, idx, src)
def _segment_sum(src, seg, n):
    out = torch.zeros((n,) + src.shape[1:], dtype=src.dtype)
    return out.index_add_(0, seg, src)
def _pad(x, pw):
    flat = tuple(v for pair in reversed(pw) for v in pair)
    return torch.nn.functional.pad(x, flat)

kernel_name = 'standalone__window_attn_swin_v2__vision'

def setup_inputs():

    _w = (lambda a: (lambda t: t.to(torch.bfloat16) if t.is_floating_point() else t)(torch.as_tensor(a)))
    win = 7
    H = W = (512 // win) * win
    C = 192
    nh = 4
    shift = win // 2
    coords = torch.stack(torch.meshgrid(torch.arange(win), torch.arange(win), indexing="ij"), -1).reshape(-1, 2)
    rel = coords[:, None, :] - coords[None, :, :]
    rel_idx = ((rel[..., 0] + win - 1) * (2 * win - 1) + (rel[..., 1] + win - 1)).to(torch.int64)
    tab = torch.stack(torch.meshgrid(torch.arange(1 - win, win), torch.arange(1 - win, win), indexing="ij"), -1).reshape(-1, 2).to(float)
    tab = (lambda _x: torch.sign(torch.as_tensor(_x)))(tab) * (lambda _x: torch.log1p(torch.as_tensor(_x)))(torch.abs(tab))
    img = torch.zeros((H, W), dtype=torch.int64)
    cnt = 0
    for hs in (slice(0, H - win), slice(H - win, H - shift), slice(H - shift, H)):
        for ws in (slice(0, W - win), slice(W - win, W - shift), slice(W - shift, W)):
            img[hs, ws] = cnt; cnt += 1
    mw = img.reshape(H // win, win, W // win, win).permute(0, 2, 1, 3).reshape(-1, win * win)
    mask = (mw[:, :, None] != mw[:, None, :]).to(float) * (-100.0)
    return {
        "x": _w((lambda *s: torch.randn(*s, dtype=torch.bfloat16) * 0.05)(1, H, W, C)),
        "wqkv": _w((lambda *s: torch.randn(*s, dtype=torch.bfloat16) * 1.6)(C, 3 * C)),
        "wo": _w((lambda *s: torch.randn(*s, dtype=torch.bfloat16) * 0.05)(C, C)),
        "logit_scale": _w((lambda *s: torch.randn(*s, dtype=torch.bfloat16) * 1.6)(nh)),
        "cpb_w1": _w((lambda *s: torch.randn(*s, dtype=torch.bfloat16) * 1.6)(2, 4 * nh)),
        "cpb_w2": _w((lambda *s: torch.randn(*s, dtype=torch.bfloat16) * 1.6)(4 * nh, nh)),
        "rel_coords": _w(tab),
        "rel_idx": _w(rel_idx),
        "attn_mask": _w(mask),
    }

def reference(x, wqkv, wo, logit_scale, cpb_w1, cpb_w2, rel_coords, rel_idx, attn_mask):
    B, H, W, C = x.shape
    win = 7
    nh = 4
    hd = C // nh
    shift = win // 2
    ww = win * win
    nH, nW = H // win, W // win
    xs = torch.roll(x, (-shift, -shift), (1, 2))
    xw = (lambda x, *d: x.permute(*d))(xs.reshape(B, nH, win, nW, win, C), 0, 1, 3, 2, 4, 5).reshape(B * nH * nW, ww, C)
    qkv = (lambda x, *d: x.permute(*d))((xw @ wqkv).reshape(B * nH * nW, ww, 3, nh, hd), 2, 0, 3, 1, 4)
    q, k, v = qkv[0], qkv[1], qkv[2]
    qn = q * (torch.einsum("bhqd,bhqd->bhq", q, q)[..., None] + 1e-12) ** -0.5
    kn = k * (torch.einsum("bhkd,bhkd->bhk", k, k)[..., None] + 1e-12) ** -0.5
    logits = torch.einsum("bhqd,bhkd->bhqk", qn, kn)
    tau = torch.exp(torch.clip(logit_scale, -100.0, 4.6052))
    logits = logits * tau[None, :, None, None]
    hcpb = rel_coords @ cpb_w1
    hcpb = torch.where(hcpb > 0, hcpb, hcpb * 0)
    bias_tab = 16.0 * _sigmoid(hcpb @ cpb_w2)
    bias = (lambda x, *d: x.permute(*d))(bias_tab[rel_idx], 2, 0, 1)
    logits = logits.reshape(B, nH * nW, nh, ww, ww) + bias[None, None, :, :, :] + attn_mask[None, :, None, :, :]
    p = _softmax(logits.reshape(B * nH * nW, nh, ww, ww), axis=-1)
    o = (lambda x, *d: x.permute(*d))(torch.einsum("bhqk,bhkd->bhqd", p, v), 0, 2, 1, 3).reshape(B * nH * nW, ww, C) @ wo
    o = (lambda x, *d: x.permute(*d))(o.reshape(B, nH, nW, win, win, C), 0, 1, 3, 2, 4, 5).reshape(B, H, W, C)
    o = torch.roll(o, (shift, shift), (1, 2))
    return _layernorm(o, axis=-1)
```

```asm
; @launch grid=(256,1,1) block=(256,1,1) lds=163840
.amdgcn_target "amdgcn-amd-amdhsa--gfx950"
.text
.globl standalone__window_attn_swin_v2__vision_kernel
.p2align 8
.type standalone__window_attn_swin_v2__vision_kernel,@function
standalone__window_attn_swin_v2__vision_kernel:
    s_cmp_ge_u32 s2, 256
    s_cbranch_scc1 L_done
    s_load_dwordx4 s[40:43], s[0:1], 0
    s_load_dwordx4 s[44:47], s[0:1], 16
    s_load_dwordx4 s[48:51], s[0:1], 32
    s_load_dwordx2 s[52:53], s[0:1], 48
    s_load_dwordx2 s[54:55], s[0:1], 72
    v_lshrrev_b32 v255, 6, v0
    v_and_b32 v254, 63, v0
    v_readfirstlane_b32 s16, v255
    v_lshrrev_b32 v253, 4, v254
    v_and_b32 v252, 15, v254
    s_mul_i32 s3, s2, 911
    s_lshr_b32 s3, s3, 16
    s_mul_i32 s4, s3, 72
    s_sub_u32 s38, s2, s4
    s_mul_i32 s3, s3, 1373568
    s_mul_i32 s4, s38, 2688
    s_add_u32 s3, s3, s4
    s_add_u32 s37, s3, 589824
    s_mov_b32 s20, 31
    s_mov_b32 s21, 4204032
    s_mov_b32 s22, 1180032
    s_cmp_lt_u32 s2, 244
    s_cselect_b32 s17, 21, 20
    s_mov_b32 s5, 0
    s_mov_b32 s6, 0
    s_cmp_lt_u32 s2, 247
    s_cbranch_scc1 L_mode
    s_mov_b32 s20, 0
    s_mov_b32 s38, 0
    s_mov_b32 s17, 18
    s_sub_u32 s3, s2, 247
    s_and_b32 s3, s3, 3
    s_mul_i32 s3, s3, 7
    s_add_u32 s3, s3, 3
    s_mov_b32 s4, 196224
    s_cmp_lt_u32 s2, 251
    s_cselect_b32 s4, s4, 384
    s_cselect_b32 s6, 1, 0
    s_cselect_b32 s5, 0, 1
    s_mul_i32 s37, s3, s4
    s_mul_i32 s21, s4, 28
    s_cmp_lt_u32 s2, 255
    s_cbranch_scc1 L_mode
    s_mov_b32 s17, 1
    s_mov_b32 s37, 0
    s_mov_b32 s6, 1
L_mode:
    s_waitcnt lgkmcnt(0)
    s_load_dwordx2 s[76:77], s[46:47], 0
    s_mov_b32 s36, 100270464
    s_mov_b32 s8, s40
    s_mov_b32 s9, s41
    s_mov_b32 s10, 100270464
    s_mov_b32 s11, 0x00020000
    s_mov_b32 s12, s54
    s_mov_b32 s13, s55
    s_mov_b32 s14, 0
    s_mov_b32 s15, 0x00020000
    s_mov_b32 s56, s42
    s_mov_b32 s57, s43
    s_mov_b32 s58, 221184
    s_mov_b32 s59, 0x00020000
    s_mov_b32 s60, s44
    s_mov_b32 s61, s45
    s_mov_b32 s62, 73728
    s_mov_b32 s63, 0x00020000
    s_mov_b32 s64, s52
    s_mov_b32 s65, s53
    s_mov_b32 s66, 676
    s_mov_b32 s67, 0x00020000
    s_mov_b32 s68, s48
    s_mov_b32 s69, s49
    s_mov_b32 s70, 64
    s_mov_b32 s71, 0x00020000
    s_mov_b32 s72, s50
    s_mov_b32 s73, s51
    s_mov_b32 s74, 128
    s_mov_b32 s75, 0x00020000
    s_mul_i32 s3, s16, 48
    v_add_u32 v255, s3, v252
    v_mul_u32_u24 v251, 384, v255
    v_lshl_add_u32 v251, v253, 4, v251
    v_mul_u32_u24 v250, 400, v255
    v_lshl_add_u32 v250, v253, 4, v250
    s_mov_b32 s4, 0
    buffer_load_dwordx4 v[108:111], v251, s[60:63], s4 offen offset:0
    buffer_load_dwordx4 v[112:115], v251, s[60:63], s4 offen offset:64
    buffer_load_dwordx4 v[116:119], v251, s[60:63], s4 offen offset:128
    buffer_load_dwordx4 v[120:123], v251, s[60:63], s4 offen offset:192
    buffer_load_dwordx4 v[124:127], v251, s[60:63], s4 offen offset:256
    buffer_load_dwordx4 v[128:131], v251, s[60:63], s4 offen offset:320
    s_mov_b32 s4, 6144
    buffer_load_dwordx4 v[132:135], v251, s[60:63], s4 offen offset:0
    buffer_load_dwordx4 v[136:139], v251, s[60:63], s4 offen offset:64
    buffer_load_dwordx4 v[140:143], v251, s[60:63], s4 offen offset:128
    buffer_load_dwordx4 v[144:147], v251, s[60:63], s4 offen offset:192
    buffer_load_dwordx4 v[148:151], v251, s[60:63], s4 offen offset:256
    buffer_load_dwordx4 v[152:155], v251, s[60:63], s4 offen offset:320
    s_mov_b32 s4, 12288
    buffer_load_dwordx4 v[156:159], v251, s[60:63], s4 offen offset:0
    buffer_load_dwordx4 v[160:163], v251, s[60:63], s4 offen offset:64
    buffer_load_dwordx4 v[164:167], v251, s[60:63], s4 offen offset:128
    buffer_load_dwordx4 v[168:171], v251, s[60:63], s4 offen offset:192
    buffer_load_dwordx4 v[172:175], v251, s[60:63], s4 offen offset:256
    buffer_load_dwordx4 v[176:179], v251, s[60:63], s4 offen offset:320
    v_mov_b32 v251, 0x40000000
    v_cmp_gt_u32 vcc, 16, v254
    v_lshlrev_b32 v255, 1, v252
    s_nop 0
    v_cndmask_b32 v255, v251, v255, vcc
    buffer_load_ushort v248, v255, s[68:71], 0 offen
    buffer_load_ushort v249, v255, s[68:71], 0 offen offset:32
    v_add_u32 v247, s3, v252
    v_lshlrev_b32 v247, 2, v247
    v_cndmask_b32 v247, v251, v247, vcc
    buffer_load_dword v246, v247, s[64:67], 0 offen offset:0
    buffer_load_dword v244, v247, s[64:67], 0 offen offset:64
    buffer_load_dword v242, v247, s[64:67], 0 offen offset:128
    v_lshrrev_b32 v255, 2, v252
    v_lshlrev_b32 v255, 1, v255
    v_lshl_add_u32 v255, v253, 5, v255
    buffer_load_ushort v245, v255, s[72:75], 0 offen offset:0
    buffer_load_ushort v243, v255, s[72:75], 0 offen offset:8
    buffer_load_ushort v241, v255, s[72:75], 0 offen offset:16
    buffer_load_ushort v240, v255, s[72:75], 0 offen offset:24
    v_add_u32 v255, 0, v254
    v_mul_u32_u24 v247, 171, v255
    v_lshrrev_b32 v247, 10, v247
    v_mul_u32_u24 v239, 6, v247
    v_sub_u32 v239, v255, v239
    v_and_b32 v238, 19, v247
    v_bfe_u32 v255, v247, 2, 1
    v_lshl_or_b32 v238, v255, 3, v238
    v_bfe_u32 v255, v247, 3, 1
    v_lshl_or_b32 v238, v255, 2, v238
    v_mul_u32_u24 v238, 1152, v238
    v_lshl_add_u32 v239, v239, 4, v238
    v_add_u32 v255, 64, v254
    v_mul_u32_u24 v247, 171, v255
    v_lshrrev_b32 v247, 10, v247
    v_mul_u32_u24 v238, 6, v247
    v_sub_u32 v238, v255, v238
    v_and_b32 v237, 19, v247
    v_bfe_u32 v255, v247, 2, 1
    v_lshl_or_b32 v237, v255, 3, v237
    v_bfe_u32 v255, v247, 3, 1
    v_lshl_or_b32 v237, v255, 2, v237
    v_mul_u32_u24 v237, 1152, v237
    v_lshl_add_u32 v238, v238, 4, v237
    v_subrev_u32 v238, 1024, v238
    v_add_u32 v255, 128, v254
    v_mul_u32_u24 v247, 171, v255
    v_lshrrev_b32 v247, 10, v247
    v_mul_u32_u24 v237, 6, v247
    v_sub_u32 v237, v255, v237
    v_and_b32 v236, 19, v247
    v_bfe_u32 v255, v247, 2, 1
    v_lshl_or_b32 v236, v255, 3, v236
    v_bfe_u32 v255, v247, 3, 1
    v_lshl_or_b32 v236, v255, 2, v236
    v_mul_u32_u24 v236, 1152, v236
    v_lshl_add_u32 v237, v237, 4, v236
    v_subrev_u32 v237, 2048, v237
    s_mul_i32 s78, s16, 15360
    s_add_u32 s78, s78, 76800
    s_mul_i32 s79, s16, 96
    s_add_u32 m0, s78, 0
    s_add_u32 s4, s79, 384
    buffer_load_dwordx4 v239, s[56:59], s4 offen lds
    buffer_load_dwordx4 v238, s[56:59], s4 offen offset:1024 lds
    buffer_load_dwordx4 v237, s[56:59], s4 offen offset:2048 lds
    s_add_u32 m0, s78, 3072
    s_add_u32 s4, s79, 37248
    buffer_load_dwordx4 v239, s[56:59], s4 offen lds
    buffer_load_dwordx4 v238, s[56:59], s4 offen offset:1024 lds
    buffer_load_dwordx4 v237, s[56:59], s4 offen offset:2048 lds
    s_add_u32 m0, s78, 6144
    s_add_u32 s4, s79, 74112
    buffer_load_dwordx4 v239, s[56:59], s4 offen lds
    buffer_load_dwordx4 v238, s[56:59], s4 offen offset:1024 lds
    buffer_load_dwordx4 v237, s[56:59], s4 offen offset:2048 lds
    s_add_u32 m0, s78, 9216
    s_add_u32 s4, s79, 110976
    buffer_load_dwordx4 v239, s[56:59], s4 offen lds
    buffer_load_dwordx4 v238, s[56:59], s4 offen offset:1024 lds
    buffer_load_dwordx4 v237, s[56:59], s4 offen offset:2048 lds
    s_add_u32 m0, s78, 12288
    s_add_u32 s4, s79, 147840
    buffer_load_dwordx4 v239, s[56:59], s4 offen lds
    buffer_load_dwordx4 v238, s[56:59], s4 offen offset:1024 lds
    buffer_load_dwordx4 v237, s[56:59], s4 offen offset:2048 lds
    v_lshrrev_b32 v255, 1, v253
    v_and_b32 v247, 1, v253
    v_lshlrev_b32 v255, 4, v255
    v_lshl_add_u32 v255, v247, 2, v255
    v_lshrrev_b32 v247, 2, v252
    v_add_u32 v255, v255, v247
    v_mul_u32_u24 v236, 96, v255
    v_and_b32 v247, 3, v252
    v_lshl_add_u32 v236, v247, 3, v236
    v_add_u32 v236, s78, v236
    s_mul_i32 s3, s5, 507
    s_mul_i32 s4, s5, -4
    v_mov_b32 v235, s3
    v_mov_b32 v234, s4
    s_mul_i32 s3, s6, 507
    s_mul_i32 s4, s6, -4
    v_mov_b32 v233, s3
    v_mov_b32 v232, s4
    s_mul_i32 s3, s5, -784896
    s_mul_i32 s4, s6, -1536
    s_add_u32 s3, s3, s4
    s_add_u32 s7, s3, 1179648
    s_mul_i32 s3, s16, 192
    s_mul_i32 s4, s16, 3072
    v_add_u32 v255, s3, v254
    v_mul_u32_u24 v247, 2731, v255
    v_lshrrev_b32 v247, 16, v247
    v_mul_u32_u24 v231, 24, v247
    v_sub_u32 v231, v255, v231
    v_bfe_u32 v255, v247, 1, 3
    v_xor_b32 v231, v231, v255
    v_lshlrev_b32 v255, 4, v231
    v_mul_u32_u24 v231, s20, v247
    v_add_u32 v231, s38, v231
    v_mul_u32_u24 v230, 911, v231
    v_lshrrev_b32 v230, 16, v230
    v_mul_lo_u32 v230, v230, s22
    v_mul_lo_u32 v231, v247, s21
    v_add3_u32 v230, v231, v230, s37
    v_add_u32 v230, s7, v230
    v_mov_b32 v231, 0x40000000
    v_cmp_gt_u32 vcc, s17, v247
    s_nop 0
    s_nop 0
    v_cndmask_b32 v230, v231, v230, vcc
    v_add_u32 v230, v230, v255
    s_add_u32 m0, s4, 147456
    s_nop 0
    buffer_load_dwordx4 v230, s[8:11], 0 offen nt lds
    v_add_u32 v255, s3, v254
    v_add_u32 v255, 64, v255
    v_mul_u32_u24 v247, 2731, v255
    v_lshrrev_b32 v247, 16, v247
    v_mul_u32_u24 v231, 24, v247
    v_sub_u32 v231, v255, v231
    v_bfe_u32 v255, v247, 1, 3
    v_xor_b32 v231, v231, v255
    v_lshlrev_b32 v255, 4, v231
    v_mul_u32_u24 v231, s20, v247
    v_add_u32 v231, s38, v231
    v_mul_u32_u24 v230, 911, v231
    v_lshrrev_b32 v230, 16, v230
    v_mul_lo_u32 v230, v230, s22
    v_mul_lo_u32 v231, v247, s21
    v_add3_u32 v230, v231, v230, s37
    v_add_u32 v230, s7, v230
    v_mov_b32 v231, 0x40000000
    v_cmp_gt_u32 vcc, s17, v247
    s_nop 0
    s_nop 0
    v_cndmask_b32 v230, v231, v230, vcc
    v_add_u32 v230, v230, v255
    s_add_u32 m0, s4, 148480
    s_nop 0
    buffer_load_dwordx4 v230, s[8:11], 0 offen nt lds
    v_add_u32 v255, s3, v254
    v_add_u32 v255, 128, v255
    v_mul_u32_u24 v247, 2731, v255
    v_lshrrev_b32 v247, 16, v247
    v_mul_u32_u24 v231, 24, v247
    v_sub_u32 v231, v255, v231
    v_bfe_u32 v255, v247, 1, 3
    v_xor_b32 v231, v231, v255
    v_lshlrev_b32 v255, 4, v231
    v_mul_u32_u24 v231, s20, v247
    v_add_u32 v231, s38, v231
    v_mul_u32_u24 v230, 911, v231
    v_lshrrev_b32 v230, 16, v230
    v_mul_lo_u32 v230, v230, s22
    v_mul_lo_u32 v231, v247, s21
    v_add3_u32 v230, v231, v230, s37
    v_add_u32 v230, s7, v230
    v_mov_b32 v231, 0x40000000
    v_cmp_gt_u32 vcc, s17, v247
    s_nop 0
    s_nop 0
    v_cndmask_b32 v230, v231, v230, vcc
    v_add_u32 v230, v230, v255
    s_add_u32 m0, s4, 149504
    s_nop 0
    buffer_load_dwordx4 v230, s[8:11], 0 offen nt lds
    v_mov_b32 v28, 0x3f803f80
    v_mov_b32 v29, 0x3f803f80
    v_mov_b32 v30, 0x3f803f80
    v_mov_b32 v31, 0x3f803f80
    v_and_b32 v255, 1, v252
    v_lshlrev_b32 v255, 4, v255
    v_mov_b32 v247, 0x3f80
    v_lshlrev_b32 v247, v255, v247
    v_and_b32 v255, 2, v252
    v_cmp_eq_u32 vcc, 0, v255
    s_nop 0
    s_nop 0
    v_cndmask_b32 v32, 0, v247, vcc
    v_cndmask_b32 v33, v247, 0, vcc
    v_mov_b32 v34, v32
    v_mov_b32 v35, v33
    v_mov_b32 v39, 0
    s_mov_b32 s32, 0x2a8cbccc
    s_mov_b32 s33, 0x38fba882
    s_waitcnt lgkmcnt(0)
    s_cmp_lt_u32 s16, 2
    s_cselect_b32 s3, s76, s77
    s_and_b32 s4, s16, 1
    s_lshl_b32 s4, s4, 4
    s_lshr_b32 s3, s3, s4
    s_lshl_b32 s3, s3, 16
    v_mov_b32 v255, s3
    v_max_f32 v255, 0xc2c80000, v255
    v_min_f32 v255, 0x40930000, v255
    v_mul_f32 v255, 0x3fb8aa3b, v255
    v_exp_f32 v255, v255
    s_nop 0
    v_cvt_pk_bf16_f32 v255, v255, v255
    v_and_b32 v255, 0xffff0000, v255
    s_nop 0
    v_readfirstlane_b32 s80, v255
    v_mul_f32 v255, 0x3fb8aa3b, v255
    s_nop 0
    v_readfirstlane_b32 s31, v255
    s_waitcnt vmcnt(18)
    v_lshl_or_b32 v248, v249, 16, v248
    v_mov_b32 v249, 0
    v_lshl_or_b32 v230, v243, 16, v245
    v_lshl_or_b32 v231, v240, 16, v241
    s_mul_i32 s3, s16, 192
    s_add_u32 s3, s3, 159744
    v_mul_u32_u24 v255, 768, v253
    v_lshl_add_u32 v255, v252, 2, v255
    v_add_u32 v255, s3, v255
    v_mov_b32 v247, 0
    v_mov_b32 v245, 0
    v_mov_b32 v243, 0
    v_mfma_f32_16x16x16_bf16 v[180:183], v[248:249], v[246:247], 0
    v_mfma_f32_16x16x16_bf16 v[184:187], v[248:249], v[244:245], 0
    v_mfma_f32_16x16x16_bf16 v[188:191], v[248:249], v[242:243], 0
    s_waitcnt vmcnt(15)
    ds_read_b64_tr_b16 a[72:73], v236 offset:0
    ds_read_b64_tr_b16 a[74:75], v236 offset:768
    ds_read_b64_tr_b16 a[96:97], v236 offset:32
    ds_read_b64_tr_b16 a[98:99], v236 offset:800
    ds_read_b64_tr_b16 a[120:121], v236 offset:64
    ds_read_b64_tr_b16 a[122:123], v236 offset:832
    s_waitcnt lgkmcnt(0)
    s_add_u32 m0, s78, 0
    s_add_u32 s4, s79, 184704
    buffer_load_dwordx4 v239, s[56:59], s4 offen lds
    buffer_load_dwordx4 v238, s[56:59], s4 offen offset:1024 lds
    buffer_load_dwordx4 v237, s[56:59], s4 offen offset:2048 lds
    v_max_f32 v180, 0, v180
    v_max_f32 v181, 0, v181
    v_max_f32 v182, 0, v182
    v_max_f32 v183, 0, v183
    v_cvt_pk_bf16_f32 v248, v180, v181
    v_cvt_pk_bf16_f32 v249, v182, v183
    v_max_f32 v184, 0, v184
    v_max_f32 v185, 0, v185
    v_max_f32 v186, 0, v186
    v_max_f32 v187, 0, v187
    v_cvt_pk_bf16_f32 v246, v184, v185
    v_cvt_pk_bf16_f32 v247, v186, v187
    v_max_f32 v188, 0, v188
    v_max_f32 v189, 0, v189
    v_max_f32 v190, 0, v190
    v_max_f32 v191, 0, v191
    v_cvt_pk_bf16_f32 v244, v188, v189
    v_cvt_pk_bf16_f32 v245, v190, v191
    v_mfma_f32_16x16x16_bf16 v[180:183], v[230:231], v[248:249], 0
    v_mfma_f32_16x16x16_bf16 v[184:187], v[230:231], v[246:247], 0
    v_mfma_f32_16x16x16_bf16 v[188:191], v[230:231], v[244:245], 0
    s_waitcnt vmcnt(15)
    ds_read_b64_tr_b16 a[76:77], v236 offset:3072
    ds_read_b64_tr_b16 a[78:79], v236 offset:3840
    ds_read_b64_tr_b16 a[100:101], v236 offset:3104
    ds_read_b64_tr_b16 a[102:103], v236 offset:3872
    ds_read_b64_tr_b16 a[124:125], v236 offset:3136
    ds_read_b64_tr_b16 a[126:127], v236 offset:3904
    s_waitcnt lgkmcnt(0)
    s_add_u32 m0, s78, 3072
    s_add_u32 s4, s79, 0
    buffer_load_dwordx4 v239, s[56:59], s4 offen lds
    buffer_load_dwordx4 v238, s[56:59], s4 offen offset:1024 lds
    buffer_load_dwordx4 v237, s[56:59], s4 offen offset:2048 lds
    v_cvt_pk_bf16_f32 v180, v180, v180
    v_and_b32 v180, 0xffff0000, v180
    v_mul_f32 v180, 0xbfb8aa3b, v180
    v_exp_f32 v180, v180
    s_nop 0
    v_add_f32 v180, 1.0, v180
    v_rcp_f32 v180, v180
    s_nop 0
    v_cvt_pk_bf16_f32 v180, v180, v180
    v_and_b32 v180, 0xffff0000, v180
    v_add_f32 v180, -0.5, v180
    v_mul_f32 v180, 0x41b8aa3b, v180
    ds_write_b32 v255, v180 offset:0
    v_cvt_pk_bf16_f32 v184, v184, v184
    v_and_b32 v184, 0xffff0000, v184
    v_mul_f32 v184, 0xbfb8aa3b, v184
    v_exp_f32 v184, v184
    s_nop 0
    v_add_f32 v184, 1.0, v184
    v_rcp_f32 v184, v184
    s_nop 0
    v_cvt_pk_bf16_f32 v184, v184, v184
    v_and_b32 v184, 0xffff0000, v184
    v_add_f32 v184, -0.5, v184
    v_mul_f32 v184, 0x41b8aa3b, v184
    ds_write_b32 v255, v184 offset:64
    v_cvt_pk_bf16_f32 v188, v188, v188
    v_and_b32 v188, 0xffff0000, v188
    v_mul_f32 v188, 0xbfb8aa3b, v188
    v_exp_f32 v188, v188
    s_nop 0
    v_add_f32 v188, 1.0, v188
    v_rcp_f32 v188, v188
    s_nop 0
    v_cvt_pk_bf16_f32 v188, v188, v188
    v_and_b32 v188, 0xffff0000, v188
    v_add_f32 v188, -0.5, v188
    v_mul_f32 v188, 0x41b8aa3b, v188
    ds_write_b32 v255, v188 offset:128
    s_waitcnt vmcnt(15)
    ds_read_b64_tr_b16 a[80:81], v236 offset:6144
    ds_read_b64_tr_b16 a[82:83], v236 offset:6912
    ds_read_b64_tr_b16 a[104:105], v236 offset:6176
    ds_read_b64_tr_b16 a[106:107], v236 offset:6944
    ds_read_b64_tr_b16 a[128:129], v236 offset:6208
    ds_read_b64_tr_b16 a[130:131], v236 offset:6976
    s_waitcnt lgkmcnt(0)
    s_add_u32 m0, s78, 6144
    s_add_u32 s4, s79, 36864
    buffer_load_dwordx4 v239, s[56:59], s4 offen lds
    buffer_load_dwordx4 v238, s[56:59], s4 offen offset:1024 lds
    buffer_load_dwordx4 v237, s[56:59], s4 offen offset:2048 lds
    v_mfma_f32_16x16x32_bf16 v[180:183], v[28:31], v[108:111], 0
    v_mfma_f32_16x16x32_bf16 v[180:183], v[28:31], v[112:115], v[180:183]
    v_mfma_f32_16x16x32_bf16 v[180:183], v[28:31], v[116:119], v[180:183]
    v_mfma_f32_16x16x32_bf16 v[180:183], v[28:31], v[120:123], v[180:183]
    v_mfma_f32_16x16x32_bf16 v[180:183], v[28:31], v[124:127], v[180:183]
    v_mfma_f32_16x16x32_bf16 v[180:183], v[28:31], v[128:131], v[180:183]
    v_mfma_f32_16x16x32_bf16 v[184:187], v[28:31], v[132:135], 0
    v_mfma_f32_16x16x32_bf16 v[184:187], v[28:31], v[136:139], v[184:187]
    v_mfma_f32_16x16x32_bf16 v[184:187], v[28:31], v[140:143], v[184:187]
    v_mfma_f32_16x16x32_bf16 v[184:187], v[28:31], v[144:147], v[184:187]
    v_mfma_f32_16x16x32_bf16 v[184:187], v[28:31], v[148:151], v[184:187]
    v_mfma_f32_16x16x32_bf16 v[184:187], v[28:31], v[152:155], v[184:187]
    v_mfma_f32_16x16x32_bf16 v[188:191], v[28:31], v[156:159], 0
    v_mfma_f32_16x16x32_bf16 v[188:191], v[28:31], v[160:163], v[188:191]
    v_mfma_f32_16x16x32_bf16 v[188:191], v[28:31], v[164:167], v[188:191]
    v_mfma_f32_16x16x32_bf16 v[188:191], v[28:31], v[168:171], v[188:191]
    v_mfma_f32_16x16x32_bf16 v[188:191], v[28:31], v[172:175], v[188:191]
    v_mfma_f32_16x16x32_bf16 v[188:191], v[28:31], v[176:179], v[188:191]
    s_waitcnt vmcnt(15)
    ds_read_b64_tr_b16 a[84:85], v236 offset:9216
    ds_read_b64_tr_b16 a[86:87], v236 offset:9984
    ds_read_b64_tr_b16 a[108:109], v236 offset:9248
    ds_read_b64_tr_b16 a[110:111], v236 offset:10016
    ds_read_b64_tr_b16 a[132:133], v236 offset:9280
    ds_read_b64_tr_b16 a[134:135], v236 offset:10048
    s_waitcnt lgkmcnt(0)
    s_add_u32 m0, s78, 9216
    s_add_u32 s4, s79, 73728
    buffer_load_dwordx4 v239, s[56:59], s4 offen lds
    buffer_load_dwordx4 v238, s[56:59], s4 offen offset:1024 lds
    buffer_load_dwordx4 v237, s[56:59], s4 offen offset:2048 lds
    v_mul_f32 v180, 0x3baaaaab, v180
    v_lshlrev_b32 v255, 16, v108
    v_and_b32 v247, 0xffff0000, v108
    v_sub_f32 v255, v255, v180
    v_sub_f32 v247, v247, v180
    v_cvt_pk_bf16_f32 v108, v255, v247
    v_lshlrev_b32 v255, 16, v109
    v_and_b32 v247, 0xffff0000, v109
    v_sub_f32 v255, v255, v180
    v_sub_f32 v247, v247, v180
    v_cvt_pk_bf16_f32 v109, v255, v247
    v_lshlrev_b32 v255, 16, v110
    v_and_b32 v247, 0xffff0000, v110
    v_sub_f32 v255, v255, v180
    v_sub_f32 v247, v247, v180
    v_cvt_pk_bf16_f32 v110, v255, v247
    v_lshlrev_b32 v255, 16, v111
    v_and_b32 v247, 0xffff0000, v111
    v_sub_f32 v255, v255, v180
    v_sub_f32 v247, v247, v180
    v_cvt_pk_bf16_f32 v111, v255, v247
    ds_write_b128 v250, v[108:111] offset:0
    v_lshlrev_b32 v255, 16, v112
    v_and_b32 v247, 0xffff0000, v112
    v_sub_f32 v255, v255, v180
    v_sub_f32 v247, v247, v180
    v_cvt_pk_bf16_f32 v112, v255, v247
    v_lshlrev_b32 v255, 16, v113
    v_and_b32 v247, 0xffff0000, v113
    v_sub_f32 v255, v255, v180
    v_sub_f32 v247, v247, v180
    v_cvt_pk_bf16_f32 v113, v255, v247
    v_lshlrev_b32 v255, 16, v114
    v_and_b32 v247, 0xffff0000, v114
    v_sub_f32 v255, v255, v180
    v_sub_f32 v247, v247, v180
    v_cvt_pk_bf16_f32 v114, v255, v247
    v_lshlrev_b32 v255, 16, v115
    v_and_b32 v247, 0xffff0000, v115
    v_sub_f32 v255, v255, v180
    v_sub_f32 v247, v247, v180
    v_cvt_pk_bf16_f32 v115, v255, v247
    ds_write_b128 v250, v[112:115] offset:64
    v_lshlrev_b32 v255, 16, v116
    v_and_b32 v247, 0xffff0000, v116
    v_sub_f32 v255, v255, v180
    v_sub_f32 v247, v247, v180
    v_cvt_pk_bf16_f32 v116, v255, v247
    v_lshlrev_b32 v255, 16, v117
    v_and_b32 v247, 0xffff0000, v117
    v_sub_f32 v255, v255, v180
    v_sub_f32 v247, v247, v180
    v_cvt_pk_bf16_f32 v117, v255, v247
    v_lshlrev_b32 v255, 16, v118
    v_and_b32 v247, 0xffff0000, v118
    v_sub_f32 v255, v255, v180
    v_sub_f32 v247, v247, v180
    v_cvt_pk_bf16_f32 v118, v255, v247
    v_lshlrev_b32 v255, 16, v119
    v_and_b32 v247, 0xffff0000, v119
    v_sub_f32 v255, v255, v180
    v_sub_f32 v247, v247, v180
    v_cvt_pk_bf16_f32 v119, v255, v247
    ds_write_b128 v250, v[116:119] offset:128
    s_waitcnt vmcnt(15)
    ds_read_b64_tr_b16 a[88:89], v236 offset:12288
    ds_read_b64_tr_b16 a[90:91], v236 offset:13056
    ds_read_b64_tr_b16 a[112:113], v236 offset:12320
    ds_read_b64_tr_b16 a[114:115], v236 offset:13088
    ds_read_b64_tr_b16 a[136:137], v236 offset:12352
    ds_read_b64_tr_b16 a[138:139], v236 offset:13120
    s_waitcnt lgkmcnt(0)
    s_add_u32 m0, s78, 12288
    s_add_u32 s4, s79, 110592
    buffer_load_dwordx4 v239, s[56:59], s4 offen lds
    buffer_load_dwordx4 v238, s[56:59], s4 offen offset:1024 lds
    buffer_load_dwordx4 v237, s[56:59], s4 offen offset:2048 lds
    v_lshlrev_b32 v255, 16, v120
    v_and_b32 v247, 0xffff0000, v120
    v_sub_f32 v255, v255, v180
    v_sub_f32 v247, v247, v180
    v_cvt_pk_bf16_f32 v120, v255, v247
    v_lshlrev_b32 v255, 16, v121
    v_and_b32 v247, 0xffff0000, v121
    v_sub_f32 v255, v255, v180
    v_sub_f32 v247, v247, v180
    v_cvt_pk_bf16_f32 v121, v255, v247
    v_lshlrev_b32 v255, 16, v122
    v_and_b32 v247, 0xffff0000, v122
    v_sub_f32 v255, v255, v180
    v_sub_f32 v247, v247, v180
    v_cvt_pk_bf16_f32 v122, v255, v247
    v_lshlrev_b32 v255, 16, v123
    v_and_b32 v247, 0xffff0000, v123
    v_sub_f32 v255, v255, v180
    v_sub_f32 v247, v247, v180
    v_cvt_pk_bf16_f32 v123, v255, v247
    ds_write_b128 v250, v[120:123] offset:192
    v_lshlrev_b32 v255, 16, v124
    v_and_b32 v247, 0xffff0000, v124
    v_sub_f32 v255, v255, v180
    v_sub_f32 v247, v247, v180
    v_cvt_pk_bf16_f32 v124, v255, v247
    v_lshlrev_b32 v255, 16, v125
    v_and_b32 v247, 0xffff0000, v125
    v_sub_f32 v255, v255, v180
    v_sub_f32 v247, v247, v180
    v_cvt_pk_bf16_f32 v125, v255, v247
    v_lshlrev_b32 v255, 16, v126
    v_and_b32 v247, 0xffff0000, v126
    v_sub_f32 v255, v255, v180
    v_sub_f32 v247, v247, v180
    v_cvt_pk_bf16_f32 v126, v255, v247
    v_lshlrev_b32 v255, 16, v127
    v_and_b32 v247, 0xffff0000, v127
    v_sub_f32 v255, v255, v180
    v_sub_f32 v247, v247, v180
    v_cvt_pk_bf16_f32 v127, v255, v247
    ds_write_b128 v250, v[124:127] offset:256
    v_lshlrev_b32 v255, 16, v128
    v_and_b32 v247, 0xffff0000, v128
    v_sub_f32 v255, v255, v180
    v_sub_f32 v247, v247, v180
    v_cvt_pk_bf16_f32 v128, v255, v247
    v_lshlrev_b32 v255, 16, v129
    v_and_b32 v247, 0xffff0000, v129
    v_sub_f32 v255, v255, v180
    v_sub_f32 v247, v247, v180
    v_cvt_pk_bf16_f32 v129, v255, v247
    v_lshlrev_b32 v255, 16, v130
    v_and_b32 v247, 0xffff0000, v130
    v_sub_f32 v255, v255, v180
    v_sub_f32 v247, v247, v180
    v_cvt_pk_bf16_f32 v130, v255, v247
    v_lshlrev_b32 v255, 16, v131
    v_and_b32 v247, 0xffff0000, v131
    v_sub_f32 v255, v255, v180
    v_sub_f32 v247, v247, v180
    v_cvt_pk_bf16_f32 v131, v255, v247
    ds_write_b128 v250, v[128:131] offset:320
    s_waitcnt vmcnt(12)
    ds_read_b64_tr_b16 a[92:93], v236 offset:0
    ds_read_b64_tr_b16 a[94:95], v236 offset:768
    ds_read_b64_tr_b16 a[116:117], v236 offset:32
    ds_read_b64_tr_b16 a[118:119], v236 offset:800
    ds_read_b64_tr_b16 a[140:141], v236 offset:64
    ds_read_b64_tr_b16 a[142:143], v236 offset:832
    s_waitcnt lgkmcnt(0)
    s_add_u32 m0, s78, 0
    s_add_u32 s4, s79, 147456
    buffer_load_dwordx4 v239, s[56:59], s4 offen lds
    buffer_load_dwordx4 v238, s[56:59], s4 offen offset:1024 lds
    buffer_load_dwordx4 v237, s[56:59], s4 offen offset:2048 lds
    v_mul_f32 v184, 0x3baaaaab, v184
    v_lshlrev_b32 v255, 16, v132
    v_and_b32 v247, 0xffff0000, v132
    v_sub_f32 v255, v255, v184
    v_sub_f32 v247, v247, v184
    v_cvt_pk_bf16_f32 v132, v255, v247
    v_lshlrev_b32 v255, 16, v133
    v_and_b32 v247, 0xffff0000, v133
    v_sub_f32 v255, v255, v184
    v_sub_f32 v247, v247, v184
    v_cvt_pk_bf16_f32 v133, v255, v247
    v_lshlrev_b32 v255, 16, v134
    v_and_b32 v247, 0xffff0000, v134
    v_sub_f32 v255, v255, v184
    v_sub_f32 v247, v247, v184
    v_cvt_pk_bf16_f32 v134, v255, v247
    v_lshlrev_b32 v255, 16, v135
    v_and_b32 v247, 0xffff0000, v135
    v_sub_f32 v255, v255, v184
    v_sub_f32 v247, v247, v184
    v_cvt_pk_bf16_f32 v135, v255, v247
    ds_write_b128 v250, v[132:135] offset:6400
    v_lshlrev_b32 v255, 16, v136
    v_and_b32 v247, 0xffff0000, v136
    v_sub_f32 v255, v255, v184
    v_sub_f32 v247, v247, v184
    v_cvt_pk_bf16_f32 v136, v255, v247
    v_lshlrev_b32 v255, 16, v137
    v_and_b32 v247, 0xffff0000, v137
    v_sub_f32 v255, v255, v184
    v_sub_f32 v247, v247, v184
    v_cvt_pk_bf16_f32 v137, v255, v247
    v_lshlrev_b32 v255, 16, v138
    v_and_b32 v247, 0xffff0000, v138
    v_sub_f32 v255, v255, v184
    v_sub_f32 v247, v247, v184
    v_cvt_pk_bf16_f32 v138, v255, v247
    v_lshlrev_b32 v255, 16, v139
    v_and_b32 v247, 0xffff0000, v139
    v_sub_f32 v255, v255, v184
    v_sub_f32 v247, v247, v184
    v_cvt_pk_bf16_f32 v139, v255, v247
    ds_write_b128 v250, v[136:139] offset:6464
    v_lshlrev_b32 v255, 16, v140
    v_and_b32 v247, 0xffff0000, v140
    v_sub_f32 v255, v255, v184
    v_sub_f32 v247, v247, v184
    v_cvt_pk_bf16_f32 v140, v255, v247
    v_lshlrev_b32 v255, 16, v141
    v_and_b32 v247, 0xffff0000, v141
    v_sub_f32 v255, v255, v184
    v_sub_f32 v247, v247, v184
    v_cvt_pk_bf16_f32 v141, v255, v247
    v_lshlrev_b32 v255, 16, v142
    v_and_b32 v247, 0xffff0000, v142
    v_sub_f32 v255, v255, v184
    v_sub_f32 v247, v247, v184
    v_cvt_pk_bf16_f32 v142, v255, v247
    v_lshlrev_b32 v255, 16, v143
    v_and_b32 v247, 0xffff0000, v143
    v_sub_f32 v255, v255, v184
    v_sub_f32 v247, v247, v184
    v_cvt_pk_bf16_f32 v143, v255, v247
    ds_write_b128 v250, v[140:143] offset:6528
    s_waitcnt vmcnt(12)
    ds_read_b64_tr_b16 a[0:1], v236 offset:3072
    ds_read_b64_tr_b16 a[2:3], v236 offset:3840
    ds_read_b64_tr_b16 a[24:25], v236 offset:3104
    ds_read_b64_tr_b16 a[26:27], v236 offset:3872
    ds_read_b64_tr_b16 a[48:49], v236 offset:3136
    ds_read_b64_tr_b16 a[50:51], v236 offset:3904
    s_waitcnt lgkmcnt(0)
    s_add_u32 m0, s78, 3072
    s_add_u32 s4, s79, 184320
    buffer_load_dwordx4 v239, s[56:59], s4 offen lds
    buffer_load_dwordx4 v238, s[56:59], s4 offen offset:1024 lds
    buffer_load_dwordx4 v237, s[56:59], s4 offen offset:2048 lds
    v_lshlrev_b32 v255, 16, v144
    v_and_b32 v247, 0xffff0000, v144
    v_sub_f32 v255, v255, v184
    v_sub_f32 v247, v247, v184
    v_cvt_pk_bf16_f32 v144, v255, v247
    v_lshlrev_b32 v255, 16, v145
    v_and_b32 v247, 0xffff0000, v145
    v_sub_f32 v255, v255, v184
    v_sub_f32 v247, v247, v184
    v_cvt_pk_bf16_f32 v145, v255, v247
    v_lshlrev_b32 v255, 16, v146
    v_and_b32 v247, 0xffff0000, v146
    v_sub_f32 v255, v255, v184
    v_sub_f32 v247, v247, v184
    v_cvt_pk_bf16_f32 v146, v255, v247
    v_lshlrev_b32 v255, 16, v147
    v_and_b32 v247, 0xffff0000, v147
    v_sub_f32 v255, v255, v184
    v_sub_f32 v247, v247, v184
    v_cvt_pk_bf16_f32 v147, v255, v247
    ds_write_b128 v250, v[144:147] offset:6592
    v_lshlrev_b32 v255, 16, v148
    v_and_b32 v247, 0xffff0000, v148
    v_sub_f32 v255, v255, v184
    v_sub_f32 v247, v247, v184
    v_cvt_pk_bf16_f32 v148, v255, v247
    v_lshlrev_b32 v255, 16, v149
    v_and_b32 v247, 0xffff0000, v149
    v_sub_f32 v255, v255, v184
    v_sub_f32 v247, v247, v184
    v_cvt_pk_bf16_f32 v149, v255, v247
    v_lshlrev_b32 v255, 16, v150
    v_and_b32 v247, 0xffff0000, v150
    v_sub_f32 v255, v255, v184
    v_sub_f32 v247, v247, v184
    v_cvt_pk_bf16_f32 v150, v255, v247
    v_lshlrev_b32 v255, 16, v151
    v_and_b32 v247, 0xffff0000, v151
    v_sub_f32 v255, v255, v184
    v_sub_f32 v247, v247, v184
    v_cvt_pk_bf16_f32 v151, v255, v247
    ds_write_b128 v250, v[148:151] offset:6656
    v_lshlrev_b32 v255, 16, v152
    v_and_b32 v247, 0xffff0000, v152
    v_sub_f32 v255, v255, v184
    v_sub_f32 v247, v247, v184
    v_cvt_pk_bf16_f32 v152, v255, v247
    v_lshlrev_b32 v255, 16, v153
    v_and_b32 v247, 0xffff0000, v153
    v_sub_f32 v255, v255, v184
    v_sub_f32 v247, v247, v184
    v_cvt_pk_bf16_f32 v153, v255, v247
    v_lshlrev_b32 v255, 16, v154
    v_and_b32 v247, 0xffff0000, v154
    v_sub_f32 v255, v255, v184
    v_sub_f32 v247, v247, v184
    v_cvt_pk_bf16_f32 v154, v255, v247
    v_lshlrev_b32 v255, 16, v155
    v_and_b32 v247, 0xffff0000, v155
    v_sub_f32 v255, v255, v184
    v_sub_f32 v247, v247, v184
    v_cvt_pk_bf16_f32 v155, v255, v247
    ds_write_b128 v250, v[152:155] offset:6720
    s_waitcnt vmcnt(12)
    ds_read_b64_tr_b16 a[4:5], v236 offset:6144
    ds_read_b64_tr_b16 a[6:7], v236 offset:6912
    ds_read_b64_tr_b16 a[28:29], v236 offset:6176
    ds_read_b64_tr_b16 a[30:31], v236 offset:6944
    ds_read_b64_tr_b16 a[52:53], v236 offset:6208
    ds_read_b64_tr_b16 a[54:55], v236 offset:6976
    s_waitcnt lgkmcnt(0)
    s_add_u32 m0, s78, 6144
    s_add_u32 s4, s79, 768
    buffer_load_dwordx4 v239, s[56:59], s4 offen lds
    buffer_load_dwordx4 v238, s[56:59], s4 offen offset:1024 lds
    buffer_load_dwordx4 v237, s[56:59], s4 offen offset:2048 lds
    v_mul_f32 v188, 0x3baaaaab, v188
    v_lshlrev_b32 v255, 16, v156
    v_and_b32 v247, 0xffff0000, v156
    v_sub_f32 v255, v255, v188
    v_sub_f32 v247, v247, v188
    v_cvt_pk_bf16_f32 v156, v255, v247
    v_lshlrev_b32 v255, 16, v157
    v_and_b32 v247, 0xffff0000, v157
    v_sub_f32 v255, v255, v188
    v_sub_f32 v247, v247, v188
    v_cvt_pk_bf16_f32 v157, v255, v247
    v_lshlrev_b32 v255, 16, v158
    v_and_b32 v247, 0xffff0000, v158
    v_sub_f32 v255, v255, v188
    v_sub_f32 v247, v247, v188
    v_cvt_pk_bf16_f32 v158, v255, v247
    v_lshlrev_b32 v255, 16, v159
    v_and_b32 v247, 0xffff0000, v159
    v_sub_f32 v255, v255, v188
    v_sub_f32 v247, v247, v188
    v_cvt_pk_bf16_f32 v159, v255, v247
    ds_write_b128 v250, v[156:159] offset:12800
    v_lshlrev_b32 v255, 16, v160
    v_and_b32 v247, 0xffff0000, v160
    v_sub_f32 v255, v255, v188
    v_sub_f32 v247, v247, v188
    v_cvt_pk_bf16_f32 v160, v255, v247
    v_lshlrev_b32 v255, 16, v161
    v_and_b32 v247, 0xffff0000, v161
    v_sub_f32 v255, v255, v188
    v_sub_f32 v247, v247, v188
    v_cvt_pk_bf16_f32 v161, v255, v247
    v_lshlrev_b32 v255, 16, v162
    v_and_b32 v247, 0xffff0000, v162
    v_sub_f32 v255, v255, v188
    v_sub_f32 v247, v247, v188
    v_cvt_pk_bf16_f32 v162, v255, v247
    v_lshlrev_b32 v255, 16, v163
    v_and_b32 v247, 0xffff0000, v163
    v_sub_f32 v255, v255, v188
    v_sub_f32 v247, v247, v188
    v_cvt_pk_bf16_f32 v163, v255, v247
    ds_write_b128 v250, v[160:163] offset:12864
    v_lshlrev_b32 v255, 16, v164
    v_and_b32 v247, 0xffff0000, v164
    v_sub_f32 v255, v255, v188
    v_sub_f32 v247, v247, v188
    v_cvt_pk_bf16_f32 v164, v255, v247
    v_lshlrev_b32 v255, 16, v165
    v_and_b32 v247, 0xffff0000, v165
    v_sub_f32 v255, v255, v188
    v_sub_f32 v247, v247, v188
    v_cvt_pk_bf16_f32 v165, v255, v247
    v_lshlrev_b32 v255, 16, v166
    v_and_b32 v247, 0xffff0000, v166
    v_sub_f32 v255, v255, v188
    v_sub_f32 v247, v247, v188
    v_cvt_pk_bf16_f32 v166, v255, v247
    v_lshlrev_b32 v255, 16, v167
    v_and_b32 v247, 0xffff0000, v167
    v_sub_f32 v255, v255, v188
    v_sub_f32 v247, v247, v188
    v_cvt_pk_bf16_f32 v167, v255, v247
    ds_write_b128 v250, v[164:167] offset:12928
    s_waitcnt vmcnt(12)
    ds_read_b64_tr_b16 a[8:9], v236 offset:9216
    ds_read_b64_tr_b16 a[10:11], v236 offset:9984
    ds_read_b64_tr_b16 a[32:33], v236 offset:9248
    ds_read_b64_tr_b16 a[34:35], v236 offset:10016
    ds_read_b64_tr_b16 a[56:57], v236 offset:9280
    ds_read_b64_tr_b16 a[58:59], v236 offset:10048
    s_waitcnt lgkmcnt(0)
    s_add_u32 m0, s78, 9216
    s_add_u32 s4, s79, 37632
    buffer_load_dwordx4 v239, s[56:59], s4 offen lds
    buffer_load_dwordx4 v238, s[56:59], s4 offen offset:1024 lds
    buffer_load_dwordx4 v237, s[56:59], s4 offen offset:2048 lds
    v_lshlrev_b32 v255, 16, v168
    v_and_b32 v247, 0xffff0000, v168
    v_sub_f32 v255, v255, v188
    v_sub_f32 v247, v247, v188
    v_cvt_pk_bf16_f32 v168, v255, v247
    v_lshlrev_b32 v255, 16, v169
    v_and_b32 v247, 0xffff0000, v169
    v_sub_f32 v255, v255, v188
    v_sub_f32 v247, v247, v188
    v_cvt_pk_bf16_f32 v169, v255, v247
    v_lshlrev_b32 v255, 16, v170
    v_and_b32 v247, 0xffff0000, v170
    v_sub_f32 v255, v255, v188
    v_sub_f32 v247, v247, v188
    v_cvt_pk_bf16_f32 v170, v255, v247
    v_lshlrev_b32 v255, 16, v171
    v_and_b32 v247, 0xffff0000, v171
    v_sub_f32 v255, v255, v188
    v_sub_f32 v247, v247, v188
    v_cvt_pk_bf16_f32 v171, v255, v247
    ds_write_b128 v250, v[168:171] offset:12992
    v_lshlrev_b32 v255, 16, v172
    v_and_b32 v247, 0xffff0000, v172
    v_sub_f32 v255, v255, v188
    v_sub_f32 v247, v247, v188
    v_cvt_pk_bf16_f32 v172, v255, v247
    v_lshlrev_b32 v255, 16, v173
    v_and_b32 v247, 0xffff0000, v173
    v_sub_f32 v255, v255, v188
    v_sub_f32 v247, v247, v188
    v_cvt_pk_bf16_f32 v173, v255, v247
    v_lshlrev_b32 v255, 16, v174
    v_and_b32 v247, 0xffff0000, v174
    v_sub_f32 v255, v255, v188
    v_sub_f32 v247, v247, v188
    v_cvt_pk_bf16_f32 v174, v255, v247
    v_lshlrev_b32 v255, 16, v175
    v_and_b32 v247, 0xffff0000, v175
    v_sub_f32 v255, v255, v188
    v_sub_f32 v247, v247, v188
    v_cvt_pk_bf16_f32 v175, v255, v247
    ds_write_b128 v250, v[172:175] offset:13056
    v_lshlrev_b32 v255, 16, v176
    v_and_b32 v247, 0xffff0000, v176
    v_sub_f32 v255, v255, v188
    v_sub_f32 v247, v247, v188
    v_cvt_pk_bf16_f32 v176, v255, v247
    v_lshlrev_b32 v255, 16, v177
    v_and_b32 v247, 0xffff0000, v177
    v_sub_f32 v255, v255, v188
    v_sub_f32 v247, v247, v188
    v_cvt_pk_bf16_f32 v177, v255, v247
    v_lshlrev_b32 v255, 16, v178
    v_and_b32 v247, 0xffff0000, v178
    v_sub_f32 v255, v255, v188
    v_sub_f32 v247, v247, v188
    v_cvt_pk_bf16_f32 v178, v255, v247
    v_lshlrev_b32 v255, 16, v179
    v_and_b32 v247, 0xffff0000, v179
    v_sub_f32 v255, v255, v188
    v_sub_f32 v247, v247, v188
    v_cvt_pk_bf16_f32 v179, v255, v247
    ds_write_b128 v250, v[176:179] offset:13120
    s_waitcnt vmcnt(12)
    ds_read_b64_tr_b16 a[12:13], v236 offset:12288
    ds_read_b64_tr_b16 a[14:15], v236 offset:13056
    ds_read_b64_tr_b16 a[36:37], v236 offset:12320
    ds_read_b64_tr_b16 a[38:39], v236 offset:13088
    ds_read_b64_tr_b16 a[60:61], v236 offset:12352
    ds_read_b64_tr_b16 a[62:63], v236 offset:13120
    s_waitcnt lgkmcnt(0)
    s_add_u32 m0, s78, 12288
    s_add_u32 s4, s79, 74496
    buffer_load_dwordx4 v239, s[56:59], s4 offen lds
    buffer_load_dwordx4 v238, s[56:59], s4 offen offset:1024 lds
    buffer_load_dwordx4 v237, s[56:59], s4 offen offset:2048 lds
    s_waitcnt lgkmcnt(0)
    s_barrier
    v_lshrrev_b32 v255, 2, v254
    v_mul_u32_u24 v255, 400, v255
    v_and_b32 v247, 3, v252
    s_lshl_b32 s3, s16, 6
    v_lshl_add_u32 v250, v247, 4, v255
    v_add_u32 v250, s3, v250
    s_lshl_b32 s3, s16, 5
    s_add_u32 s3, s3, 256
    v_lshl_add_u32 v255, v247, 3, v255
    v_add_u32 v255, s3, v255
    v_add_u32 v249, 38400, v250
    v_add_u32 v248, 38400, v255
    ds_read_b64_tr_b16 a[216:217], v250 offset:0
    ds_read_b64_tr_b16 a[218:219], v250 offset:6400
    ds_read_b64_tr_b16 a[220:221], v250 offset:19200
    ds_read_b64_tr_b16 a[222:223], v250 offset:25600
    ds_read_b64_tr_b16 a[224:225], v249 offset:0
    ds_read_b64_tr_b16 a[226:227], v249 offset:6400
    ds_read_b64_tr_b16 a[228:229], v249 offset:19200
    ds_read_b64_tr_b16 a[230:231], v249 offset:25600
    ds_read_b64_tr_b16 a[232:233], v250 offset:12800
    ds_read_b64_tr_b16 a[234:235], v250 offset:32000
    ds_read_b64_tr_b16 a[236:237], v249 offset:12800
    ds_read_b64_tr_b16 a[238:239], v249 offset:32000
    s_waitcnt vmcnt(12)
    ds_read_b64_tr_b16 a[16:17], v236 offset:0
    ds_read_b64_tr_b16 a[18:19], v236 offset:768
    ds_read_b64_tr_b16 a[40:41], v236 offset:32
    ds_read_b64_tr_b16 a[42:43], v236 offset:800
    ds_read_b64_tr_b16 a[64:65], v236 offset:64
    ds_read_b64_tr_b16 a[66:67], v236 offset:832
    s_waitcnt lgkmcnt(0)
    s_add_u32 m0, s78, 0
    s_add_u32 s4, s79, 111360
    buffer_load_dwordx4 v239, s[56:59], s4 offen lds
    buffer_load_dwordx4 v238, s[56:59], s4 offen offset:1024 lds
    buffer_load_dwordx4 v237, s[56:59], s4 offen offset:2048 lds
    ds_read_b64_tr_b16 a[240:241], v250 offset:8
    ds_read_b64_tr_b16 a[242:243], v250 offset:6408
    ds_read_b64_tr_b16 a[244:245], v250 offset:19208
    ds_read_b64_tr_b16 a[246:247], v250 offset:25608
    ds_read_b64_tr_b16 a[248:249], v249 offset:8
    ds_read_b64_tr_b16 a[250:251], v249 offset:6408
    ds_read_b64_tr_b16 a[252:253], v249 offset:19208
    ds_read_b64_tr_b16 a[254:255], v249 offset:25608
    ds_read_b64_tr_b16 v[76:77], v250 offset:12808
    ds_read_b64_tr_b16 v[78:79], v250 offset:32008
    ds_read_b64_tr_b16 v[80:81], v249 offset:12808
    ds_read_b64_tr_b16 v[82:83], v249 offset:32008
    s_waitcnt vmcnt(12)
    ds_read_b64_tr_b16 a[20:21], v236 offset:3072
    ds_read_b64_tr_b16 a[22:23], v236 offset:3840
    ds_read_b64_tr_b16 a[44:45], v236 offset:3104
    ds_read_b64_tr_b16 a[46:47], v236 offset:3872
    ds_read_b64_tr_b16 a[68:69], v236 offset:3136
    ds_read_b64_tr_b16 a[70:71], v236 offset:3904
    s_waitcnt lgkmcnt(0)
    s_add_u32 m0, s78, 3072
    s_add_u32 s4, s79, 148224
    buffer_load_dwordx4 v239, s[56:59], s4 offen lds
    buffer_load_dwordx4 v238, s[56:59], s4 offen offset:1024 lds
    buffer_load_dwordx4 v237, s[56:59], s4 offen offset:2048 lds
    ds_read_b64_tr_b16 v[84:85], v255 offset:0
    ds_read_b64_tr_b16 v[86:87], v255 offset:6400
    ds_read_b64_tr_b16 v[88:89], v255 offset:19200
    ds_read_b64_tr_b16 v[90:91], v255 offset:25600
    ds_read_b64_tr_b16 v[92:93], v248 offset:0
    ds_read_b64_tr_b16 v[94:95], v248 offset:6400
    ds_read_b64_tr_b16 v[96:97], v248 offset:19200
    ds_read_b64_tr_b16 v[98:99], v248 offset:25600
    ds_read_b64_tr_b16 v[100:101], v255 offset:12800
    ds_read_b64_tr_b16 v[102:103], v255 offset:32000
    ds_read_b64_tr_b16 v[104:105], v248 offset:12800
    ds_read_b64_tr_b16 v[106:107], v248 offset:32000
    s_lshl_b32 s3, s16, 8
    v_add_u32 v255, s3, v254
    v_mul_u32_u24 v250, 2731, v255
    v_lshrrev_b32 v250, 16, v250
    v_mul_u32_u24 v249, 24, v250
    v_sub_u32 v249, v255, v249
    v_bfe_u32 v255, v250, 1, 3
    v_xor_b32 v249, v249, v255
    v_lshlrev_b32 v255, 4, v249
    v_mul_u32_u24 v249, 37, v250
    v_lshrrev_b32 v249, 8, v249
    v_mul_u32_u24 v248, 7, v249
    v_sub_u32 v248, v250, v248
    v_cmp_gt_u32 vcc, 4, v249
    s_nop 0
    s_nop 0
    v_cndmask_b32 v250, v234, v235, vcc
    v_add_u32 v249, v249, v250
    v_cmp_gt_u32 vcc, 4, v248
    s_nop 0
    s_nop 0
    v_cndmask_b32 v250, v232, v233, vcc
    v_add_u32 v248, v248, v250
    v_mul_u32_u24 v249, 511, v249
    v_add_u32 v249, v249, v248
    v_mul_u32_u24 v10, 384, v249
    v_add_u32 v10, v10, v255
    v_add_u32 v255, s3, v254
    v_add_u32 v255, 64, v255
    v_mul_u32_u24 v250, 2731, v255
    v_lshrrev_b32 v250, 16, v250
    v_mul_u32_u24 v249, 24, v250
    v_sub_u32 v249, v255, v249
    v_bfe_u32 v255, v250, 1, 3
    v_xor_b32 v249, v249, v255
    v_lshlrev_b32 v255, 4, v249
    v_mul_u32_u24 v249, 37, v250
    v_lshrrev_b32 v249, 8, v249
    v_mul_u32_u24 v248, 7, v249
    v_sub_u32 v248, v250, v248
    v_cmp_gt_u32 vcc, 4, v249
    s_nop 0
    s_nop 0
    v_cndmask_b32 v250, v234, v235, vcc
    v_add_u32 v249, v249, v250
    v_cmp_gt_u32 vcc, 4, v248
    s_nop 0
    s_nop 0
    v_cndmask_b32 v250, v232, v233, vcc
    v_add_u32 v248, v248, v250
    v_mul_u32_u24 v249, 511, v249
    v_add_u32 v249, v249, v248
    v_mul_u32_u24 v11, 384, v249
    v_add_u32 v11, v11, v255
    v_add_u32 v255, s3, v254
    v_add_u32 v255, 128, v255
    v_mul_u32_u24 v250, 2731, v255
    v_lshrrev_b32 v250, 16, v250
    v_mul_u32_u24 v249, 24, v250
    v_sub_u32 v249, v255, v249
    v_bfe_u32 v255, v250, 1, 3
    v_xor_b32 v249, v249, v255
    v_lshlrev_b32 v255, 4, v249
    v_mul_u32_u24 v249, 37, v250
    v_lshrrev_b32 v249, 8, v249
    v_mul_u32_u24 v248, 7, v249
    v_sub_u32 v248, v250, v248
    v_cmp_gt_u32 vcc, 4, v249
    s_nop 0
    s_nop 0
    v_cndmask_b32 v250, v234, v235, vcc
    v_add_u32 v249, v249, v250
    v_cmp_gt_u32 vcc, 4, v248
    s_nop 0
    s_nop 0
    v_cndmask_b32 v250, v232, v233, vcc
    v_add_u32 v248, v248, v250
    v_mul_u32_u24 v249, 511, v249
    v_add_u32 v249, v249, v248
    v_mul_u32_u24 v12, 384, v249
    v_add_u32 v12, v12, v255
    v_add_u32 v255, s3, v254
    v_add_u32 v255, 192, v255
    v_mul_u32_u24 v250, 2731, v255
    v_lshrrev_b32 v250, 16, v250
    v_mul_u32_u24 v249, 24, v250
    v_sub_u32 v249, v255, v249
    v_bfe_u32 v255, v250, 1, 3
    v_xor_b32 v249, v249, v255
    v_lshlrev_b32 v255, 4, v249
    v_mul_u32_u24 v249, 37, v250
    v_lshrrev_b32 v249, 8, v249
    v_mul_u32_u24 v248, 7, v249
    v_sub_u32 v248, v250, v248
    v_cmp_gt_u32 vcc, 4, v249
    s_nop 0
    s_nop 0
    v_cndmask_b32 v250, v234, v235, vcc
    v_add_u32 v249, v249, v250
    v_cmp_gt_u32 vcc, 4, v248
    s_nop 0
    s_nop 0
    v_cndmask_b32 v250, v232, v233, vcc
    v_add_u32 v248, v248, v250
    v_mul_u32_u24 v249, 511, v249
    v_add_u32 v249, v249, v248
    v_mul_u32_u24 v13, 384, v249
    v_add_u32 v13, v13, v255
    s_lshl_b32 s3, s16, 6
    v_add_u32 v255, s3, v254
    v_add_u32 v255, 1024, v255
    v_mul_u32_u24 v250, 2731, v255
    v_lshrrev_b32 v250, 16, v250
    v_mul_u32_u24 v249, 24, v250
    v_sub_u32 v249, v255, v249
    v_bfe_u32 v255, v250, 1, 3
    v_xor_b32 v249, v249, v255
    v_lshlrev_b32 v255, 4, v249
    v_mul_u32_u24 v249, 37, v250
    v_lshrrev_b32 v249, 8, v249
    v_mul_u32_u24 v248, 7, v249
    v_sub_u32 v248, v250, v248
    v_cmp_gt_u32 vcc, 4, v249
    s_nop 0
    s_nop 0
    v_cndmask_b32 v247, v234, v235, vcc
    v_add_u32 v249, v249, v247
    v_cmp_gt_u32 vcc, 4, v248
    s_nop 0
    s_nop 0
    v_cndmask_b32 v247, v232, v233, vcc
    v_add_u32 v248, v248, v247
    v_mul_u32_u24 v249, 511, v249
    v_add_u32 v249, v249, v248
    v_mul_u32_u24 v14, 384, v249
    v_add_u32 v14, v14, v255
    v_cmp_gt_u32 vcc, 48, v250
    s_nop 0
    s_nop 0
    v_cndmask_b32 v14, v251, v14, vcc
    s_lshl_b32 s28, s16, 12
    s_add_u32 s28, s28, 20480
    s_lshl_b32 s3, s16, 10
    s_add_u32 s3, s3, 36864
    s_cmp_lt_u32 s16, 2
    s_cselect_b32 s29, s3, 64000
    s_cselect_b32 s30, 65536, 0
    s_mov_b32 s19, s38
    s_mov_b32 s23, s37
    s_mov_b32 s25, s37
    s_mov_b32 s26, 0
    s_mov_b32 s27, 0
    s_mov_b32 s18, 0
    s_waitcnt lgkmcnt(0)
    s_barrier
    s_add_u32 m0, s28, 0
    s_nop 0
    buffer_load_dwordx4 v10, s[8:11], s23 offen nt lds
    s_add_u32 m0, s28, 1024
    s_nop 0
    buffer_load_dwordx4 v11, s[8:11], s23 offen nt lds
    s_add_u32 m0, s28, 2048
    s_nop 0
    buffer_load_dwordx4 v12, s[8:11], s23 offen nt lds
    s_add_u32 m0, s28, 3072
    s_nop 0
    buffer_load_dwordx4 v13, s[8:11], s23 offen nt lds
    s_mov_b32 m0, s29
    s_nop 0
    buffer_load_dwordx4 v14, s[8:11], s23 offen nt lds
    s_add_u32 s19, s19, s20
    s_add_u32 s23, s23, s21
    s_cmp_ge_u32 s19, 72
    s_cselect_b32 s34, 72, 0
    s_cselect_b32 s35, s22, 0
    s_sub_u32 s19, s19, s34
    s_add_u32 s23, s23, s35
    s_mov_b32 s24, s23
    s_waitcnt vmcnt(17)
    ds_read_b64_tr_b16 a[144:145], v236 offset:6144
    ds_read_b64_tr_b16 a[146:147], v236 offset:6912
    ds_read_b64_tr_b16 a[168:169], v236 offset:6176
    ds_read_b64_tr_b16 a[170:171], v236 offset:6944
    ds_read_b64_tr_b16 a[192:193], v236 offset:6208
    ds_read_b64_tr_b16 a[194:195], v236 offset:6976
    s_waitcnt lgkmcnt(0)
    s_add_u32 m0, s78, 6144
    s_add_u32 s4, s79, 185088
    buffer_load_dwordx4 v239, s[56:59], s4 offen lds
    buffer_load_dwordx4 v238, s[56:59], s4 offen offset:1024 lds
    buffer_load_dwordx4 v237, s[56:59], s4 offen offset:2048 lds
    v_add_u32 v255, 0, v252
    v_mul_u32_u24 v251, 37, v255
    v_lshrrev_b32 v251, 8, v251
    v_mul_u32_u24 v250, 7, v251
    v_sub_u32 v250, v255, v250
    v_cmp_gt_u32 vcc, 4, v251
    s_nop 0
    s_nop 0
    v_cndmask_b32 v255, v234, v235, vcc
    v_add_u32 v251, v251, v255
    v_cmp_gt_u32 vcc, 4, v250
    s_nop 0
    s_nop 0
    v_cndmask_b32 v255, v232, v233, vcc
    v_add_u32 v250, v250, v255
    v_mul_u32_u24 v251, 511, v251
    v_add_u32 v251, v251, v250
    v_mul_u32_u24 v255, 384, v251
    s_lshl_b32 s3, s16, 6
    v_lshl_add_u32 v247, v253, 4, v255
    v_add_u32 v15, s3, v247
    s_lshl_b32 s3, s16, 5
    s_add_u32 s3, s3, 256
    v_lshl_add_u32 v247, v253, 3, v255
    v_add_u32 v18, s3, v247
    v_add_u32 v255, 16, v252
    v_mul_u32_u24 v251, 37, v255
    v_lshrrev_b32 v251, 8, v251
    v_mul_u32_u24 v250, 7, v251
    v_sub_u32 v250, v255, v250
    v_cmp_gt_u32 vcc, 4, v251
    s_nop 0
    s_nop 0
    v_cndmask_b32 v255, v234, v235, vcc
    v_add_u32 v251, v251, v255
    v_cmp_gt_u32 vcc, 4, v250
    s_nop 0
    s_nop 0
    v_cndmask_b32 v255, v232, v233, vcc
    v_add_u32 v250, v250, v255
    v_mul_u32_u24 v251, 511, v251
    v_add_u32 v251, v251, v250
    v_mul_u32_u24 v255, 384, v251
    s_lshl_b32 s3, s16, 6
    v_lshl_add_u32 v247, v253, 4, v255
    v_add_u32 v16, s3, v247
    s_lshl_b32 s3, s16, 5
    s_add_u32 s3, s3, 256
    v_lshl_add_u32 v247, v253, 3, v255
    v_add_u32 v19, s3, v247
    v_add_u32 v255, 32, v252
    v_mul_u32_u24 v251, 37, v255
    v_lshrrev_b32 v251, 8, v251
    v_mul_u32_u24 v250, 7, v251
    v_sub_u32 v250, v255, v250
    v_cmp_gt_u32 vcc, 4, v251
    s_nop 0
    s_nop 0
    v_cndmask_b32 v255, v234, v235, vcc
    v_add_u32 v251, v251, v255
    v_cmp_gt_u32 vcc, 4, v250
    s_nop 0
    s_nop 0
    v_cndmask_b32 v255, v232, v233, vcc
    v_add_u32 v250, v250, v255
    v_mul_u32_u24 v251, 511, v251
    v_add_u32 v251, v251, v250
    v_mul_u32_u24 v255, 384, v251
    s_lshl_b32 s3, s16, 6
    v_lshl_add_u32 v247, v253, 4, v255
    v_add_u32 v17, s3, v247
    s_lshl_b32 s3, s16, 5
    s_add_u32 s3, s3, 256
    v_lshl_add_u32 v247, v253, 3, v255
    v_add_u32 v20, s3, v247
    s_waitcnt vmcnt(17)
    ds_read_b64_tr_b16 a[148:149], v236 offset:9216
    ds_read_b64_tr_b16 a[150:151], v236 offset:9984
    ds_read_b64_tr_b16 a[172:173], v236 offset:9248
    ds_read_b64_tr_b16 a[174:175], v236 offset:10016
    ds_read_b64_tr_b16 a[196:197], v236 offset:9280
    ds_read_b64_tr_b16 a[198:199], v236 offset:10048
    s_mul_i32 s3, s16, 768
    s_add_u32 s3, s3, 159744
    v_add_u32 v255, 0, v252
    v_mul_u32_u24 v251, 37, v255
    v_lshrrev_b32 v251, 8, v251
    v_mul_u32_u24 v250, 7, v251
    v_sub_u32 v250, v255, v250
    v_mul_u32_u24 v249, 52, v251
    v_lshl_add_u32 v249, v250, 2, v249
    v_lshrrev_b32 v251, 2, v251
    v_lshrrev_b32 v250, 2, v250
    v_and_b32 v251, s5, v251
    v_and_b32 v250, s6, v250
    v_lshl_or_b32 v251, v251, 1, v250
    v_add_u32 v255, 16, v252
    v_mul_u32_u24 v250, 37, v255
    v_lshrrev_b32 v250, 8, v250
    v_mul_u32_u24 v248, 7, v250
    v_sub_u32 v248, v255, v248
    v_mul_u32_u24 v246, 52, v250
    v_lshl_add_u32 v246, v248, 2, v246
    v_lshrrev_b32 v250, 2, v250
    v_lshrrev_b32 v248, 2, v248
    v_and_b32 v250, s5, v250
    v_and_b32 v248, s6, v248
    v_lshl_or_b32 v250, v250, 1, v248
    v_add_u32 v255, 32, v252
    v_mul_u32_u24 v248, 37, v255
    v_lshrrev_b32 v248, 8, v248
    v_mul_u32_u24 v247, 7, v248
    v_sub_u32 v247, v255, v247
    v_mul_u32_u24 v245, 52, v248
    v_lshl_add_u32 v245, v247, 2, v245
    v_lshrrev_b32 v248, 2, v248
    v_lshrrev_b32 v247, 2, v247
    v_and_b32 v248, s5, v248
    v_and_b32 v247, s6, v247
    v_lshl_or_b32 v248, v248, 1, v247
    v_add_u32 v255, s3, v249
    ds_read_b32 v22, v255
    v_sub_u32 v247, s3, v249
    ds_read_b32 v23, v247 offset:672
    v_add_u32 v249, 336, v255
    v_add_u32 v255, s3, v246
    ds_read_b32 v24, v255
    v_sub_u32 v247, s3, v246
    ds_read_b32 v25, v247 offset:672
    v_add_u32 v246, 336, v255
    v_add_u32 v255, s3, v245
    ds_read_b32 v26, v255
    v_sub_u32 v247, s3, v245
    ds_read_b32 v27, v247 offset:672
    v_add_u32 v247, 336, v255
    v_mov_b32 v255, s3
    ds_read_b32 v245, v255 offset:336
    s_waitcnt vmcnt(14)
    ds_read_b64_tr_b16 a[152:153], v236 offset:12288
    ds_read_b64_tr_b16 a[154:155], v236 offset:13056
    ds_read_b64_tr_b16 a[176:177], v236 offset:12320
    ds_read_b64_tr_b16 a[178:179], v236 offset:13088
    ds_read_b64_tr_b16 a[200:201], v236 offset:12352
    ds_read_b64_tr_b16 a[202:203], v236 offset:13120
    v_lshl_add_u32 v255, v253, 2, 0
    v_mul_u32_u24 v244, 37, v255
    v_lshrrev_b32 v244, 8, v244
    v_mul_u32_u24 v243, 7, v244
    v_sub_u32 v243, v255, v243
    v_mul_u32_u24 v255, 52, v244
    v_lshl_add_u32 v255, v243, 2, v255
    v_lshrrev_b32 v244, 2, v244
    v_lshrrev_b32 v243, 2, v243
    v_and_b32 v244, s5, v244
    v_and_b32 v243, s6, v243
    v_lshl_or_b32 v244, v244, 1, v243
    v_sub_u32 v243, v249, v255
    ds_read_b32 v40, v243
    v_sub_u32 v243, v246, v255
    ds_read_b32 v52, v243
    v_sub_u32 v255, v247, v255
    ds_read_b32 v64, v255
    v_lshl_add_u32 v255, v253, 2, 1
    v_mul_u32_u24 v243, 37, v255
    v_lshrrev_b32 v243, 8, v243
    v_mul_u32_u24 v242, 7, v243
    v_sub_u32 v242, v255, v242
    v_mul_u32_u24 v255, 52, v243
    v_lshl_add_u32 v255, v242, 2, v255
    v_lshrrev_b32 v243, 2, v243
    v_lshrrev_b32 v242, 2, v242
    v_and_b32 v243, s5, v243
    v_and_b32 v242, s6, v242
    v_lshl_or_b32 v243, v243, 1, v242
    v_sub_u32 v242, v249, v255
    ds_read_b32 v41, v242
    v_sub_u32 v242, v246, v255
    ds_read_b32 v53, v242
    v_sub_u32 v255, v247, v255
    ds_read_b32 v65, v255
    v_lshl_add_u32 v255, v253, 2, 2
    v_mul_u32_u24 v242, 37, v255
    v_lshrrev_b32 v242, 8, v242
    v_mul_u32_u24 v241, 7, v242
    v_sub_u32 v241, v255, v241
    v_mul_u32_u24 v255, 52, v242
    v_lshl_add_u32 v255, v241, 2, v255
    v_lshrrev_b32 v242, 2, v242
    v_lshrrev_b32 v241, 2, v241
    v_and_b32 v242, s5, v242
    v_and_b32 v241, s6, v241
    v_lshl_or_b32 v242, v242, 1, v241
    v_sub_u32 v241, v249, v255
    ds_read_b32 v42, v241
    v_sub_u32 v241, v246, v255
    ds_read_b32 v54, v241
    v_sub_u32 v255, v247, v255
    ds_read_b32 v66, v255
    v_lshl_add_u32 v255, v253, 2, 3
    v_mul_u32_u24 v241, 37, v255
    v_lshrrev_b32 v241, 8, v241
    v_mul_u32_u24 v240, 7, v241
    v_sub_u32 v240, v255, v240
    v_mul_u32_u24 v255, 52, v241
    v_lshl_add_u32 v255, v240, 2, v255
    v_lshrrev_b32 v241, 2, v241
    v_lshrrev_b32 v240, 2, v240
    v_and_b32 v241, s5, v241
    v_and_b32 v240, s6, v240
    v_lshl_or_b32 v241, v241, 1, v240
    v_sub_u32 v240, v249, v255
    ds_read_b32 v43, v240
    v_sub_u32 v240, v246, v255
    ds_read_b32 v55, v240
    v_sub_u32 v255, v247, v255
    ds_read_b32 v67, v255
    s_waitcnt vmcnt(11)
    ds_read_b64_tr_b16 a[156:157], v236 offset:0
    ds_read_b64_tr_b16 a[158:159], v236 offset:768
    ds_read_b64_tr_b16 a[180:181], v236 offset:32
    ds_read_b64_tr_b16 a[182:183], v236 offset:800
    ds_read_b64_tr_b16 a[204:205], v236 offset:64
    ds_read_b64_tr_b16 a[206:207], v236 offset:832
    v_lshl_add_u32 v255, v253, 2, 16
    v_mul_u32_u24 v240, 37, v255
    v_lshrrev_b32 v240, 8, v240
    v_mul_u32_u24 v239, 7, v240
    v_sub_u32 v239, v255, v239
    v_mul_u32_u24 v255, 52, v240
    v_lshl_add_u32 v255, v239, 2, v255
    v_lshrrev_b32 v240, 2, v240
    v_lshrrev_b32 v239, 2, v239
    v_and_b32 v240, s5, v240
    v_and_b32 v239, s6, v239
    v_lshl_or_b32 v240, v240, 1, v239
    v_sub_u32 v239, v249, v255
    ds_read_b32 v44, v239
    v_sub_u32 v239, v246, v255
    ds_read_b32 v56, v239
    v_sub_u32 v255, v247, v255
    ds_read_b32 v68, v255
    v_lshl_add_u32 v255, v253, 2, 17
    v_mul_u32_u24 v239, 37, v255
    v_lshrrev_b32 v239, 8, v239
    v_mul_u32_u24 v238, 7, v239
    v_sub_u32 v238, v255, v238
    v_mul_u32_u24 v255, 52, v239
    v_lshl_add_u32 v255, v238, 2, v255
    v_lshrrev_b32 v239, 2, v239
    v_lshrrev_b32 v238, 2, v238
    v_and_b32 v239, s5, v239
    v_and_b32 v238, s6, v238
    v_lshl_or_b32 v239, v239, 1, v238
    v_sub_u32 v238, v249, v255
    ds_read_b32 v45, v238
    v_sub_u32 v238, v246, v255
    ds_read_b32 v57, v238
    v_sub_u32 v255, v247, v255
    ds_read_b32 v69, v255
    v_lshl_add_u32 v255, v253, 2, 18
    v_mul_u32_u24 v238, 37, v255
    v_lshrrev_b32 v238, 8, v238
    v_mul_u32_u24 v237, 7, v238
    v_sub_u32 v237, v255, v237
    v_mul_u32_u24 v255, 52, v238
    v_lshl_add_u32 v255, v237, 2, v255
    v_lshrrev_b32 v238, 2, v238
    v_lshrrev_b32 v237, 2, v237
    v_and_b32 v238, s5, v238
    v_and_b32 v237, s6, v237
    v_lshl_or_b32 v238, v238, 1, v237
    v_sub_u32 v237, v249, v255
    ds_read_b32 v46, v237
    v_sub_u32 v237, v246, v255
    ds_read_b32 v58, v237
    v_sub_u32 v255, v247, v255
    ds_read_b32 v70, v255
    v_lshl_add_u32 v255, v253, 2, 19
    v_mul_u32_u24 v237, 37, v255
    v_lshrrev_b32 v237, 8, v237
    v_mul_u32_u24 v235, 7, v237
    v_sub_u32 v235, v255, v235
    v_mul_u32_u24 v255, 52, v237
    v_lshl_add_u32 v255, v235, 2, v255
    v_lshrrev_b32 v237, 2, v237
    v_lshrrev_b32 v235, 2, v235
    v_and_b32 v237, s5, v237
    v_and_b32 v235, s6, v235
    v_lshl_or_b32 v237, v237, 1, v235
    v_sub_u32 v235, v249, v255
    ds_read_b32 v47, v235
    v_sub_u32 v235, v246, v255
    ds_read_b32 v59, v235
    v_sub_u32 v255, v247, v255
    ds_read_b32 v71, v255
    s_waitcnt vmcnt(8)
    ds_read_b64_tr_b16 a[160:161], v236 offset:3072
    ds_read_b64_tr_b16 a[162:163], v236 offset:3840
    ds_read_b64_tr_b16 a[184:185], v236 offset:3104
    ds_read_b64_tr_b16 a[186:187], v236 offset:3872
    ds_read_b64_tr_b16 a[208:209], v236 offset:3136
    ds_read_b64_tr_b16 a[210:211], v236 offset:3904
    v_lshl_add_u32 v255, v253, 2, 32
    v_mul_u32_u24 v235, 37, v255
    v_lshrrev_b32 v235, 8, v235
    v_mul_u32_u24 v234, 7, v235
    v_sub_u32 v234, v255, v234
    v_mul_u32_u24 v255, 52, v235
    v_lshl_add_u32 v255, v234, 2, v255
    v_lshrrev_b32 v235, 2, v235
    v_lshrrev_b32 v234, 2, v234
    v_and_b32 v235, s5, v235
    v_and_b32 v234, s6, v234
    v_lshl_or_b32 v235, v235, 1, v234
    v_sub_u32 v234, v249, v255
    ds_read_b32 v48, v234
    v_sub_u32 v234, v246, v255
    ds_read_b32 v60, v234
    v_sub_u32 v255, v247, v255
    ds_read_b32 v72, v255
    v_lshl_add_u32 v255, v253, 2, 33
    v_mul_u32_u24 v234, 37, v255
    v_lshrrev_b32 v234, 8, v234
    v_mul_u32_u24 v233, 7, v234
    v_sub_u32 v233, v255, v233
    v_mul_u32_u24 v255, 52, v234
    v_lshl_add_u32 v255, v233, 2, v255
    v_lshrrev_b32 v234, 2, v234
    v_lshrrev_b32 v233, 2, v233
    v_and_b32 v234, s5, v234
    v_and_b32 v233, s6, v233
    v_lshl_or_b32 v234, v234, 1, v233
    v_sub_u32 v233, v249, v255
    ds_read_b32 v49, v233
    v_sub_u32 v233, v246, v255
    ds_read_b32 v61, v233
    v_sub_u32 v255, v247, v255
    ds_read_b32 v73, v255
    v_lshl_add_u32 v255, v253, 2, 34
    v_mul_u32_u24 v233, 37, v255
    v_lshrrev_b32 v233, 8, v233
    v_mul_u32_u24 v232, 7, v233
    v_sub_u32 v232, v255, v232
    v_mul_u32_u24 v255, 52, v233
    v_lshl_add_u32 v255, v232, 2, v255
    v_lshrrev_b32 v233, 2, v233
    v_lshrrev_b32 v232, 2, v232
    v_and_b32 v233, s5, v233
    v_and_b32 v232, s6, v232
    v_lshl_or_b32 v233, v233, 1, v232
    v_sub_u32 v232, v249, v255
    ds_read_b32 v50, v232
    v_sub_u32 v232, v246, v255
    ds_read_b32 v62, v232
    v_sub_u32 v255, v247, v255
    ds_read_b32 v74, v255
    v_lshl_add_u32 v255, v253, 2, 35
    v_mul_u32_u24 v232, 37, v255
    v_lshrrev_b32 v232, 8, v232
    v_mul_u32_u24 v231, 7, v232
    v_sub_u32 v231, v255, v231
    v_mul_u32_u24 v255, 52, v232
    v_lshl_add_u32 v255, v231, 2, v255
    v_lshrrev_b32 v232, 2, v232
    v_lshrrev_b32 v231, 2, v231
    v_and_b32 v232, s5, v232
    v_and_b32 v231, s6, v231
    v_lshl_or_b32 v232, v232, 1, v231
    v_sub_u32 v249, v249, v255
    ds_read_b32 v51, v249
    v_sub_u32 v249, v246, v255
    ds_read_b32 v63, v249
    v_sub_u32 v255, v247, v255
    ds_read_b32 v75, v255
    s_waitcnt vmcnt(0)
    ds_read_b64_tr_b16 a[164:165], v236 offset:6144
    ds_read_b64_tr_b16 a[166:167], v236 offset:6912
    ds_read_b64_tr_b16 a[188:189], v236 offset:6176
    ds_read_b64_tr_b16 a[190:191], v236 offset:6944
    ds_read_b64_tr_b16 a[212:213], v236 offset:6208
    ds_read_b64_tr_b16 a[214:215], v236 offset:6976
    s_waitcnt lgkmcnt(0)
    s_waitcnt lgkmcnt(9)
    v_readfirstlane_b32 s39, v245
    s_lshl_b32 s3, s5, 1
    s_or_b32 s3, s3, s6
    s_cbranch_scc0 L_nomask
    v_mov_b32 v247, 0xc31044fe
    v_cmp_ne_u32 vcc, s3, v251
    s_nop 0
    s_nop 0
    v_cndmask_b32 v255, 0, v247, vcc
    v_add_f32 v22, v22, v255
    v_cmp_ne_u32 vcc, s3, v251
    s_nop 0
    s_nop 0
    v_cndmask_b32 v255, 0, v247, vcc
    v_add_f32 v23, v23, v255
    v_cmp_ne_u32 vcc, s3, v250
    s_nop 0
    s_nop 0
    v_cndmask_b32 v255, 0, v247, vcc
    v_add_f32 v24, v24, v255
    v_cmp_ne_u32 vcc, s3, v250
    s_nop 0
    s_nop 0
    v_cndmask_b32 v255, 0, v247, vcc
    v_add_f32 v25, v25, v255
    v_cmp_ne_u32 vcc, s3, v248
    s_nop 0
    s_nop 0
    v_cndmask_b32 v255, 0, v247, vcc
    v_add_f32 v26, v26, v255
    v_cmp_ne_u32 vcc, s3, v248
    s_nop 0
    s_nop 0
    v_cndmask_b32 v255, 0, v247, vcc
    v_add_f32 v27, v27, v255
    v_cmp_ne_u32 vcc, v244, v251
    s_nop 0
    s_nop 0
    v_cndmask_b32 v255, 0, v247, vcc
    v_add_f32 v40, v40, v255
    v_cmp_ne_u32 vcc, v244, v250
    s_nop 0
    s_nop 0
    v_cndmask_b32 v255, 0, v247, vcc
    v_add_f32 v52, v52, v255
    v_cmp_ne_u32 vcc, v244, v248
    s_nop 0
    s_nop 0
    v_cndmask_b32 v255, 0, v247, vcc
    v_add_f32 v64, v64, v255
    v_cmp_ne_u32 vcc, v243, v251
    s_nop 0
    s_nop 0
    v_cndmask_b32 v255, 0, v247, vcc
    v_add_f32 v41, v41, v255
    v_cmp_ne_u32 vcc, v243, v250
    s_nop 0
    s_nop 0
    v_cndmask_b32 v255, 0, v247, vcc
    v_add_f32 v53, v53, v255
    v_cmp_ne_u32 vcc, v243, v248
    s_nop 0
    s_nop 0
    v_cndmask_b32 v255, 0, v247, vcc
    v_add_f32 v65, v65, v255
    v_cmp_ne_u32 vcc, v242, v251
    s_nop 0
    s_nop 0
    v_cndmask_b32 v255, 0, v247, vcc
    v_add_f32 v42, v42, v255
    v_cmp_ne_u32 vcc, v242, v250
    s_nop 0
    s_nop 0
    v_cndmask_b32 v255, 0, v247, vcc
    v_add_f32 v54, v54, v255
    v_cmp_ne_u32 vcc, v242, v248
    s_nop 0
    s_nop 0
    v_cndmask_b32 v255, 0, v247, vcc
    v_add_f32 v66, v66, v255
    v_cmp_ne_u32 vcc, v241, v251
    s_nop 0
    s_nop 0
    v_cndmask_b32 v255, 0, v247, vcc
    v_add_f32 v43, v43, v255
    v_cmp_ne_u32 vcc, v241, v250
    s_nop 0
    s_nop 0
    v_cndmask_b32 v255, 0, v247, vcc
    v_add_f32 v55, v55, v255
    v_cmp_ne_u32 vcc, v241, v248
    s_nop 0
    s_nop 0
    v_cndmask_b32 v255, 0, v247, vcc
    v_add_f32 v67, v67, v255
    v_cmp_ne_u32 vcc, v240, v251
    s_nop 0
    s_nop 0
    v_cndmask_b32 v255, 0, v247, vcc
    v_add_f32 v44, v44, v255
    v_cmp_ne_u32 vcc, v240, v250
    s_nop 0
    s_nop 0
    v_cndmask_b32 v255, 0, v247, vcc
    v_add_f32 v56, v56, v255
    v_cmp_ne_u32 vcc, v240, v248
    s_nop 0
    s_nop 0
    v_cndmask_b32 v255, 0, v247, vcc
    v_add_f32 v68, v68, v255
    v_cmp_ne_u32 vcc, v239, v251
    s_nop 0
    s_nop 0
    v_cndmask_b32 v255, 0, v247, vcc
    v_add_f32 v45, v45, v255
    v_cmp_ne_u32 vcc, v239, v250
    s_nop 0
    s_nop 0
    v_cndmask_b32 v255, 0, v247, vcc
    v_add_f32 v57, v57, v255
    v_cmp_ne_u32 vcc, v239, v248
    s_nop 0
    s_nop 0
    v_cndmask_b32 v255, 0, v247, vcc
    v_add_f32 v69, v69, v255
    v_cmp_ne_u32 vcc, v238, v251
    s_nop 0
    s_nop 0
    v_cndmask_b32 v255, 0, v247, vcc
    v_add_f32 v46, v46, v255
    v_cmp_ne_u32 vcc, v238, v250
    s_nop 0
    s_nop 0
    v_cndmask_b32 v255, 0, v247, vcc
    v_add_f32 v58, v58, v255
    v_cmp_ne_u32 vcc, v238, v248
    s_nop 0
    s_nop 0
    v_cndmask_b32 v255, 0, v247, vcc
    v_add_f32 v70, v70, v255
    v_cmp_ne_u32 vcc, v237, v251
    s_nop 0
    s_nop 0
    v_cndmask_b32 v255, 0, v247, vcc
    v_add_f32 v47, v47, v255
    v_cmp_ne_u32 vcc, v237, v250
    s_nop 0
    s_nop 0
    v_cndmask_b32 v255, 0, v247, vcc
    v_add_f32 v59, v59, v255
    v_cmp_ne_u32 vcc, v237, v248
    s_nop 0
    s_nop 0
    v_cndmask_b32 v255, 0, v247, vcc
    v_add_f32 v71, v71, v255
    v_cmp_ne_u32 vcc, v235, v251
    s_nop 0
    s_nop 0
    v_cndmask_b32 v255, 0, v247, vcc
    v_add_f32 v48, v48, v255
    v_cmp_ne_u32 vcc, v235, v250
    s_nop 0
    s_nop 0
    v_cndmask_b32 v255, 0, v247, vcc
    v_add_f32 v60, v60, v255
    v_cmp_ne_u32 vcc, v235, v248
    s_nop 0
    s_nop 0
    v_cndmask_b32 v255, 0, v247, vcc
    v_add_f32 v72, v72, v255
    v_cmp_ne_u32 vcc, v234, v251
    s_nop 0
    s_nop 0
    v_cndmask_b32 v255, 0, v247, vcc
    v_add_f32 v49, v49, v255
    v_cmp_ne_u32 vcc, v234, v250
    s_nop 0
    s_nop 0
    v_cndmask_b32 v255, 0, v247, vcc
    v_add_f32 v61, v61, v255
    v_cmp_ne_u32 vcc, v234, v248
    s_nop 0
    s_nop 0
    v_cndmask_b32 v255, 0, v247, vcc
    v_add_f32 v73, v73, v255
    v_cmp_ne_u32 vcc, v233, v251
    s_nop 0
    s_nop 0
    v_cndmask_b32 v255, 0, v247, vcc
    v_add_f32 v50, v50, v255
    v_cmp_ne_u32 vcc, v233, v250
    s_nop 0
    s_nop 0
    v_cndmask_b32 v255, 0, v247, vcc
    v_add_f32 v62, v62, v255
    v_cmp_ne_u32 vcc, v233, v248
    s_nop 0
    s_nop 0
    v_cndmask_b32 v255, 0, v247, vcc
    v_add_f32 v74, v74, v255
    v_cmp_ne_u32 vcc, v232, v251
    s_nop 0
    s_nop 0
    v_cndmask_b32 v255, 0, v247, vcc
    s_waitcnt lgkmcnt(0)
    v_add_f32 v51, v51, v255
    v_cmp_ne_u32 vcc, v232, v250
    s_nop 0
    s_nop 0
    v_cndmask_b32 v255, 0, v247, vcc
    v_add_f32 v63, v63, v255
    v_cmp_ne_u32 vcc, v232, v248
    s_nop 0
    s_nop 0
    v_cndmask_b32 v255, 0, v247, vcc
    v_add_f32 v75, v75, v255
L_nomask:
    v_mov_b32 v247, 0xf149f2ca
    v_cmp_gt_u32 vcc, 16, v254
    s_nop 0
    s_nop 0
    v_cndmask_b32 v22, v247, v22, vcc
    v_cndmask_b32 v24, v247, v24, vcc
    v_cndmask_b32 v26, v247, v26, vcc
    v_lshrrev_b32 v255, 1, v252
    v_xor_b32 v255, v255, v253
    v_mul_u32_u24 v247, 384, v252
    v_lshl_add_u32 v0, v255, 4, v247
    v_xor_b32 v1, 64, v0
    v_lshlrev_b32 v255, 4, v254
    v_xor_b32 v2, 65536, v255
    s_lshl_b32 s3, s16, 10
    v_add_u32 v3, s3, v255
    s_lshr_b32 s3, s16, 1
    s_and_b32 s4, s16, 1
    s_lshl_b32 s4, s4, 3
    s_lshl_b32 s81, s3, 10
    s_add_u32 s81, s81, s4
    v_add_u32 v4, s81, v255
    s_lshl_b32 s81, s3, 11
    s_add_u32 s81, s81, s4
    s_add_u32 s81, s81, 143360
    s_lshl_b32 s3, s16, 11
    s_add_u32 s3, s3, 135168
    v_lshl_add_u32 v255, v253, 3, s3
    v_mov_b32 v247, s81
    v_cmp_gt_u32 vcc, 2, v253
    s_nop 0
    s_nop 0
    v_cndmask_b32 v255, v247, v255, vcc
    v_lshrrev_b32 v247, 2, v252
    v_lshl_add_u32 v255, v247, 9, v255
    v_and_b32 v247, 3, v252
    v_lshl_add_u32 v255, v247, 1, v255
    v_mov_b32 v247, 65024
    v_cmp_gt_u32 vcc, 3, v253
    s_nop 0
    s_nop 0
    v_cndmask_b32 v7, v247, v255, vcc
    s_mul_i32 s3, s16, 7680
    s_add_u32 s3, s3, 104448
    v_mul_u32_u24 v255, 80, v253
    v_and_b32 v247, 1, v252
    v_lshl_add_u32 v255, v247, 4, v255
    v_add_u32 v5, s3, v255
    s_mul_i32 s3, s16, 6144
    s_add_u32 s3, s3, 38912
    v_lshl_add_u32 v6, v252, 2, s3
    s_lshl_b32 s3, s16, 7
    s_add_u32 s3, s3, 63488
    v_lshl_add_u32 v9, v253, 4, s3
    v_lshrrev_b32 v255, 1, v253
    v_lshl_add_u32 v255, v255, 6, s3
    v_and_b32 v247, 1, v253
    v_lshl_add_u32 v255, v247, 3, v255
    v_lshrrev_b32 v247, 2, v252
    v_lshl_add_u32 v255, v247, 4, v255
    v_and_b32 v247, 3, v252
    v_lshl_add_u32 v8, v247, 1, v255
    s_waitcnt vmcnt(3)
    s_barrier
    s_cmp_lt_u32 1, s17
    s_cselect_b32 s10, s36, 0
    s_add_u32 m0, s28, 65536
    s_nop 0
    buffer_load_dwordx4 v10, s[8:11], s23 offen nt lds
    s_add_u32 m0, s28, 66560
    s_nop 0
    buffer_load_dwordx4 v11, s[8:11], s23 offen nt lds
    s_add_u32 m0, s28, 67584
    s_nop 0
    buffer_load_dwordx4 v12, s[8:11], s23 offen nt lds
    s_add_u32 m0, s28, 68608
    s_nop 0
    buffer_load_dwordx4 v13, s[8:11], s23 offen nt lds
    s_xor_b32 m0, s29, s30
    s_nop 0
    buffer_load_dwordx4 v14, s[8:11], s23 offen nt lds
    s_add_u32 s19, s19, s20
    s_add_u32 s23, s23, s21
    s_cmp_ge_u32 s19, 72
    s_cselect_b32 s34, 72, 0
    s_cselect_b32 s35, s22, 0
    s_sub_u32 s19, s19, s34
    s_add_u32 s23, s23, s35
    s_cmp_gt_u32 s80, 0x42000000
    s_cbranch_scc1 L_safe
    v_bfe_u32 v255, v2, 4, 6
    v_lshrrev_b32 v254, 4, v255
    v_and_b32 v253, 15, v255
    v_add_u32 v252, 147456, v0
    v_add_u32 v251, 147456, v1
    v_mov_b32 v108, 0
    v_mov_b32 v109, 0
    v_mov_b32 v110, 0
    v_mov_b32 v111, 0
    v_lshlrev_b32 v250, 4, v254
    v_add_u32 v250, 64000, v250
    v_mul_u32_u24 v249, 320, v253
    v_mul_u32_u24 v248, 80, v254
    v_lshlrev_b32 v247, 8, v253
    v_lshl_add_u32 v247, v254, 4, v247
    v_lshl_add_u32 v246, v254, 10, v6
    v_add_u32 v245, 4096, v246
    v_cmp_gt_u32 vcc, 8, v253
    v_cmp_gt_u32 s[82:83], 16, v255
    v_mov_b32 v113, 0xf149f2ca
    v_mov_b32 v114, 0xf149f2ca
    v_mov_b32 v115, 0xf149f2ca
    v_mov_b32 v149, 0xf149f2ca
    v_mov_b32 v150, 0xf149f2ca
    v_mov_b32 v151, 0xf149f2ca
    s_mul_i32 s3, s16, 7680
    s_add_u32 s3, s3, 104448
    ds_read_b128 v[116:119], v252 offset:0
    ds_read_b128 v[120:123], v251 offset:0
    ds_read_b128 v[124:127], v252 offset:128
    ds_read_b128 v[128:131], v251 offset:128
    ds_read_b128 v[132:135], v252 offset:256
    ds_read_b128 v[136:139], v251 offset:256
    v_add3_u32 v249, v249, v248, s3
    v_add_u32 v253, 5120, v249
    v_cndmask_b32 v253, v250, v253, vcc
    s_mul_i32 s4, s16, 6144
    s_add_u32 s4, s4, 38912
    ds_write_b128 v249, v[108:111] offset:16
    v_add_u32 v247, s4, v247
    v_add_u32 v248, 4096, v247
    v_cndmask_b32 v248, v250, v248, vcc
    v_cmp_gt_u32 vcc, 2, v254
    ds_write_b64 v249, v[108:109] offset:56
    ds_write_b64 v249, v[108:109] offset:64
    v_cndmask_b32 v245, v250, v245, vcc
    s_waitcnt lgkmcnt(4)
    v_mfma_f32_16x16x32_bf16 v[140:143], a[72:75], v[116:119], 0
    s_waitcnt lgkmcnt(3)
    ds_write_b128 v253, v[108:111] offset:16
    v_mfma_f32_16x16x32_bf16 v[140:143], a[76:79], v[120:123], v[140:143]
    v_mfma_f32_16x16x32_bf16 v[140:143], a[80:83], v[124:127], v[140:143]
    v_mfma_f32_16x16x32_bf16 v[140:143], a[84:87], v[128:131], v[140:143]
    ds_write_b64 v253, v[108:109] offset:56
    v_mfma_f32_16x16x32_bf16 v[140:143], a[88:91], v[132:135], v[140:143]
    v_mfma_f32_16x16x32_bf16 v[140:143], a[92:95], v[136:139], v[140:143]
    ds_write_b64 v253, v[108:109] offset:64
    v_mfma_f32_16x16x32_bf16 v[108:111], a[96:99], v[116:119], 0
    v_mfma_f32_16x16x32_bf16 v[108:111], a[100:103], v[120:123], v[108:111]
    v_mfma_f32_16x16x32_bf16 v[108:111], a[104:107], v[124:127], v[108:111]
    v_mfma_f32_16x16x32_bf16 v[108:111], a[108:111], v[128:131], v[108:111]
    v_mfma_f32_16x16x32_bf16 v[108:111], a[112:115], v[132:135], v[108:111]
    v_mfma_f32_16x16x32_bf16 v[108:111], a[116:119], v[136:139], v[108:111]
    v_mfma_f32_16x16x32_bf16 v[144:147], a[120:123], v[116:119], 0
    v_fma_f32 v255, v140, v140, s32
    v_fmac_f32 v255, v141, v141
    v_mfma_f32_16x16x32_bf16 v[144:147], a[124:127], v[120:123], v[144:147]
    v_fmac_f32 v255, v142, v142
    v_fmac_f32 v255, v143, v143
    v_mfma_f32_16x16x32_bf16 v[144:147], a[128:131], v[124:127], v[144:147]
    v_mfma_f32_16x16x32_bf16 v[144:147], a[132:135], v[128:131], v[144:147]
    v_fmac_f32 v255, v108, v108
    v_fmac_f32 v255, v109, v109
    v_mfma_f32_16x16x32_bf16 v[144:147], a[136:139], v[132:135], v[144:147]
    v_fmac_f32 v255, v110, v110
    v_fmac_f32 v255, v111, v111
    v_mfma_f32_16x16x32_bf16 v[144:147], a[140:143], v[136:139], v[144:147]
    v_mfma_f32_16x16x32_bf16 v[152:155], a[0:3], v[116:119], 0
    v_mfma_f32_16x16x32_bf16 v[152:155], a[4:7], v[120:123], v[152:155]
    v_mfma_f32_16x16x32_bf16 v[152:155], a[8:11], v[124:127], v[152:155]
    v_mfma_f32_16x16x32_bf16 v[152:155], a[12:15], v[128:131], v[152:155]
    v_mfma_f32_16x16x32_bf16 v[152:155], a[16:19], v[132:135], v[152:155]
    v_mfma_f32_16x16x32_bf16 v[152:155], a[20:23], v[136:139], v[152:155]
    v_mfma_f32_16x16x32_bf16 v[156:159], a[24:27], v[116:119], 0
    v_mfma_f32_16x16x32_bf16 v[156:159], a[28:31], v[120:123], v[156:159]
    v_fmac_f32 v255, v144, v144
    v_fmac_f32 v255, v145, v145
    v_mfma_f32_16x16x32_bf16 v[156:159], a[32:35], v[124:127], v[156:159]
    v_fmac_f32 v255, v146, v146
    v_fmac_f32 v255, v147, v147
    v_mfma_f32_16x16x32_bf16 v[156:159], a[36:39], v[128:131], v[156:159]
    v_fma_f32 v254, v152, v152, s32
    v_fmac_f32 v254, v153, v153
    v_mfma_f32_16x16x32_bf16 v[156:159], a[40:43], v[132:135], v[156:159]
    v_fmac_f32 v254, v154, v154
    v_fmac_f32 v254, v155, v155
    v_mfma_f32_16x16x32_bf16 v[156:159], a[44:47], v[136:139], v[156:159]
    v_mfma_f32_16x16x32_bf16 v[160:163], a[48:51], v[116:119], 0
    v_mfma_f32_16x16x32_bf16 v[160:163], a[52:55], v[120:123], v[160:163]
    v_mfma_f32_16x16x32_bf16 v[160:163], a[56:59], v[124:127], v[160:163]
    v_mfma_f32_16x16x32_bf16 v[160:163], a[60:63], v[128:131], v[160:163]
    v_mfma_f32_16x16x32_bf16 v[160:163], a[64:67], v[132:135], v[160:163]
    v_mfma_f32_16x16x32_bf16 v[160:163], a[68:71], v[136:139], v[160:163]
    v_mfma_f32_16x16x32_bf16 v[164:167], v[116:119], a[144:147], 0
    v_mfma_f32_16x16x32_bf16 v[164:167], v[120:123], a[148:151], v[164:167]
    v_fmac_f32 v254, v156, v156
    v_fmac_f32 v254, v157, v157
    v_mfma_f32_16x16x32_bf16 v[164:167], v[124:127], a[152:155], v[164:167]
    v_fmac_f32 v254, v158, v158
    v_fmac_f32 v254, v159, v159
    v_mfma_f32_16x16x32_bf16 v[164:167], v[128:131], a[156:159], v[164:167]
    v_fmac_f32 v254, v160, v160
    v_fmac_f32 v254, v161, v161
    v_mfma_f32_16x16x32_bf16 v[164:167], v[132:135], a[160:163], v[164:167]
    v_fmac_f32 v254, v162, v162
    v_fmac_f32 v254, v163, v163
    v_mfma_f32_16x16x32_bf16 v[164:167], v[136:139], a[164:167], v[164:167]
    v_cvt_pk_bf16_f32 v38, v254, v255
    v_mfma_f32_16x16x32_bf16 v[168:171], v[116:119], a[168:171], 0
    v_mfma_f32_16x16x32_bf16 v[168:171], v[120:123], a[172:175], v[168:171]
    v_mfma_f32_16x16x16_bf16 v[172:175], v[32:33], v[38:39], 0
    v_mfma_f32_16x16x32_bf16 v[168:171], v[124:127], a[176:179], v[168:171]
    ds_read_b128 v[176:179], v252 offset:6144
    v_mfma_f32_16x16x32_bf16 v[168:171], v[128:131], a[180:183], v[168:171]
    ds_read_b128 v[180:183], v251 offset:6144
    v_cvt_pk_bf16_f32 v164, v164, v164
    v_mfma_f32_16x16x32_bf16 v[168:171], v[132:135], a[184:187], v[168:171]
    ds_read_b128 v[184:187], v252 offset:6272
    v_cvt_pk_bf16_f32 v165, v165, v165
    v_mfma_f32_16x16x32_bf16 v[168:171], v[136:139], a[188:191], v[168:171]
    ds_read_b128 v[188:191], v251 offset:6272
    v_cvt_pk_bf16_f32 v166, v166, v166
    v_mfma_f32_16x16x32_bf16 v[192:195], v[116:119], a[192:195], 0
    ds_read_b128 v[116:119], v252 offset:6400
    v_cvt_pk_bf16_f32 v167, v167, v167
    v_mfma_f32_16x16x32_bf16 v[192:195], v[120:123], a[196:199], v[192:195]
    ds_read_b128 v[120:123], v251 offset:6400
    v_mfma_f32_16x16x32_bf16 v[192:195], v[124:127], a[200:203], v[192:195]
    ds_write_b32 v246, v164 offset:0
    v_mfma_f32_16x16x32_bf16 v[192:195], v[128:131], a[204:207], v[192:195]
    v_rsq_f32 v173, v173
    v_mfma_f32_16x16x32_bf16 v[192:195], v[132:135], a[208:211], v[192:195]
    ds_write_b32 v246, v165 offset:256
    v_mfma_f32_16x16x32_bf16 v[192:195], v[136:139], a[212:215], v[192:195]
    s_waitcnt lgkmcnt(7)
    v_rsq_f32 v172, v172
    v_mfma_f32_16x16x32_bf16 v[196:199], a[72:75], v[176:179], 0
    s_waitcnt lgkmcnt(6)
    ds_write_b32 v246, v166 offset:512
    v_mfma_f32_16x16x32_bf16 v[196:199], a[76:79], v[180:183], v[196:199]
    s_waitcnt lgkmcnt(6)
    v_mul_f32 v172, s31, v172
    v_mul_f32 v140, v173, v140
    v_mfma_f32_16x16x32_bf16 v[196:199], a[80:83], v[184:187], v[196:199]
    s_waitcnt lgkmcnt(5)
    ds_write_b32 v246, v167 offset:768
    v_mfma_f32_16x16x32_bf16 v[196:199], a[84:87], v[188:191], v[196:199]
    s_waitcnt lgkmcnt(5)
    v_mul_f32 v141, v173, v141
    v_cvt_pk_bf16_f32 v124, v140, v141
    v_mfma_f32_16x16x32_bf16 v[196:199], a[88:91], v[116:119], v[196:199]
    s_waitcnt lgkmcnt(4)
    v_mul_f32 v142, v173, v142
    v_mul_f32 v143, v173, v143
    v_mfma_f32_16x16x32_bf16 v[196:199], a[92:95], v[120:123], v[196:199]
    v_cvt_pk_bf16_f32 v125, v142, v143
    v_mul_f32 v108, v173, v108
    v_mfma_f32_16x16x32_bf16 v[164:167], a[96:99], v[176:179], 0
    v_mul_f32 v109, v173, v109
    v_cvt_pk_bf16_f32 v126, v108, v109
    v_mfma_f32_16x16x32_bf16 v[164:167], a[100:103], v[180:183], v[164:167]
    v_mul_f32 v110, v173, v110
    v_mul_f32 v111, v173, v111
    v_mfma_f32_16x16x32_bf16 v[164:167], a[104:107], v[184:187], v[164:167]
    v_cvt_pk_bf16_f32 v127, v110, v111
    v_mul_f32 v144, v173, v144
    v_mfma_f32_16x16x32_bf16 v[164:167], a[108:111], v[188:191], v[164:167]
    ds_write_b128 v249, v[124:127]
    v_mfma_f32_16x16x32_bf16 v[164:167], a[112:115], v[116:119], v[164:167]
    v_mul_f32 v145, v173, v145
    v_cvt_pk_bf16_f32 v126, v144, v145
    v_mfma_f32_16x16x32_bf16 v[164:167], a[116:119], v[120:123], v[164:167]
    v_mul_f32 v146, v173, v146
    v_mul_f32 v147, v173, v147
    v_mfma_f32_16x16x32_bf16 v[200:203], a[120:123], v[176:179], 0
    v_cvt_pk_bf16_f32 v127, v146, v147
    v_mul_f32 v152, v172, v152
    v_mfma_f32_16x16x32_bf16 v[200:203], a[124:127], v[180:183], v[200:203]
    ds_write_b64 v249, v[126:127] offset:48
    v_mfma_f32_16x16x32_bf16 v[200:203], a[128:131], v[184:187], v[200:203]
    v_mul_f32 v153, v172, v153
    v_cvt_pk_bf16_f32 v124, v152, v153
    v_mfma_f32_16x16x32_bf16 v[200:203], a[132:135], v[188:191], v[200:203]
    v_mul_f32 v154, v172, v154
    v_mul_f32 v155, v172, v155
    v_mfma_f32_16x16x32_bf16 v[200:203], a[136:139], v[116:119], v[200:203]
    v_cvt_pk_bf16_f32 v125, v154, v155
    v_mul_f32 v156, v172, v156
    v_mfma_f32_16x16x32_bf16 v[200:203], a[140:143], v[120:123], v[200:203]
    v_mul_f32 v157, v172, v157
    v_cvt_pk_bf16_f32 v126, v156, v157
    v_mfma_f32_16x16x32_bf16 v[204:207], a[0:3], v[176:179], 0
    v_mul_f32 v158, v172, v158
    v_mul_f32 v159, v172, v159
    v_mfma_f32_16x16x32_bf16 v[204:207], a[4:7], v[180:183], v[204:207]
    v_cvt_pk_bf16_f32 v127, v158, v159
    v_mul_f32 v160, v172, v160
    v_mfma_f32_16x16x32_bf16 v[204:207], a[8:11], v[184:187], v[204:207]
    ds_write_b128 v249, v[124:127] offset:32
    v_mfma_f32_16x16x32_bf16 v[204:207], a[12:15], v[188:191], v[204:207]
    v_mul_f32 v161, v172, v161
    v_cvt_pk_bf16_f32 v124, v160, v161
    v_mfma_f32_16x16x32_bf16 v[204:207], a[16:19], v[116:119], v[204:207]
    v_mul_f32 v162, v172, v162
    v_mul_f32 v163, v172, v163
    v_mfma_f32_16x16x32_bf16 v[204:207], a[20:23], v[120:123], v[204:207]
    v_cvt_pk_bf16_f32 v125, v162, v163
    v_mul_f32 v112, v152, v140
    v_mfma_f32_16x16x32_bf16 v[172:175], a[24:27], v[176:179], 0
    ds_write_b64 v249, v[124:125] offset:72
    v_mfma_f32_16x16x32_bf16 v[172:175], a[28:31], v[180:183], v[172:175]
    v_fmac_f32 v112, v153, v141
    v_fmac_f32 v112, v154, v142
    v_mfma_f32_16x16x32_bf16 v[172:175], a[32:35], v[184:187], v[172:175]
    v_fmac_f32 v112, v155, v143
    v_fmac_f32 v112, v156, v108
    v_mfma_f32_16x16x32_bf16 v[172:175], a[36:39], v[188:191], v[172:175]
    v_fmac_f32 v112, v157, v109
    v_fmac_f32 v112, v158, v110
    v_mfma_f32_16x16x32_bf16 v[172:175], a[40:43], v[116:119], v[172:175]
    v_fmac_f32 v112, v159, v111
    v_fmac_f32 v112, v160, v144
    v_mfma_f32_16x16x32_bf16 v[172:175], a[44:47], v[120:123], v[172:175]
    v_fmac_f32 v112, v161, v145
    v_fmac_f32 v112, v162, v146
    v_mfma_f32_16x16x32_bf16 v[152:155], a[48:51], v[176:179], 0
    v_fmac_f32 v112, v163, v147
    v_mov_b32 v255, v112
    v_mfma_f32_16x16x32_bf16 v[152:155], a[52:55], v[180:183], v[152:155]
    v_cvt_pk_bf16_f32 v168, v168, v168
    v_cvt_pk_bf16_f32 v169, v169, v169
    v_mfma_f32_16x16x32_bf16 v[152:155], a[56:59], v[184:187], v[152:155]
    ds_write_b32 v246, v168 offset:64
    v_mfma_f32_16x16x32_bf16 v[152:155], a[60:63], v[188:191], v[152:155]
    v_permlane32_swap_b32 v112, v255
    v_mfma_f32_16x16x32_bf16 v[152:155], a[64:67], v[116:119], v[152:155]
    ds_write_b32 v246, v169 offset:320
    v_mfma_f32_16x16x32_bf16 v[152:155], a[68:71], v[120:123], v[152:155]
    v_add_f32 v112, v112, v255
    v_mov_b32 v255, v112
    v_mfma_f32_16x16x32_bf16 v[156:159], v[176:179], a[144:147], 0
    v_cvt_pk_bf16_f32 v170, v170, v170
    v_cvt_pk_bf16_f32 v171, v171, v171
    v_mfma_f32_16x16x32_bf16 v[156:159], v[180:183], a[148:151], v[156:159]
    ds_write_b32 v246, v170 offset:576
    v_mfma_f32_16x16x32_bf16 v[156:159], v[184:187], a[152:155], v[156:159]
    v_permlane16_swap_b32 v112, v255
    v_mfma_f32_16x16x32_bf16 v[156:159], v[188:191], a[156:159], v[156:159]
    ds_write_b32 v246, v171 offset:832
    v_mfma_f32_16x16x32_bf16 v[156:159], v[116:119], a[160:163], v[156:159]
    v_add_f32 v112, v112, v255
    v_add_f32 v112, s39, v112
    v_mfma_f32_16x16x32_bf16 v[156:159], v[120:123], a[164:167], v[156:159]
    v_cndmask_b32 v112, v113, v112, s[82:83]
    v_cvt_pk_bf16_f32 v192, v192, v192
    v_mfma_f32_16x16x32_bf16 v[160:163], v[176:179], a[168:171], 0
    ds_write_b32 v246, v192 offset:128
    v_mfma_f32_16x16x32_bf16 v[160:163], v[180:183], a[172:175], v[160:163]
    v_cvt_pk_bf16_f32 v193, v193, v193
    v_cvt_pk_bf16_f32 v194, v194, v194
    v_mfma_f32_16x16x32_bf16 v[160:163], v[184:187], a[176:179], v[160:163]
    ds_read_b128 v[124:127], v0 offset:20480
    v_cvt_pk_bf16_f32 v195, v195, v195
    v_mfma_f32_16x16x32_bf16 v[160:163], v[188:191], a[180:183], v[160:163]
    ds_read_b128 v[128:131], v1 offset:20480
    v_fma_f32 v255, v196, v196, s32
    v_mfma_f32_16x16x32_bf16 v[160:163], v[116:119], a[184:187], v[160:163]
    ds_read_b128 v[132:135], v0 offset:20608
    v_fmac_f32 v255, v197, v197
    v_mfma_f32_16x16x32_bf16 v[160:163], v[120:123], a[188:191], v[160:163]
    ds_read_b128 v[136:139], v1 offset:20608
    v_fmac_f32 v255, v198, v198
    v_mfma_f32_16x16x32_bf16 v[168:171], v[176:179], a[192:195], 0
    ds_read_b128 v[140:143], v0 offset:20736
    v_fmac_f32 v255, v199, v199
    v_mfma_f32_16x16x32_bf16 v[168:171], v[180:183], a[196:199], v[168:171]
    ds_read_b128 v[144:147], v1 offset:20736
    v_fmac_f32 v255, v164, v164
    v_mfma_f32_16x16x32_bf16 v[168:171], v[184:187], a[200:203], v[168:171]
    ds_write_b32 v246, v193 offset:384
    v_mfma_f32_16x16x32_bf16 v[168:171], v[188:191], a[204:207], v[168:171]
    v_fmac_f32 v255, v165, v165
    v_fmac_f32 v255, v166, v166
    v_mfma_f32_16x16x32_bf16 v[168:171], v[116:119], a[208:211], v[168:171]
    ds_write_b32 v246, v194 offset:640
    v_mfma_f32_16x16x32_bf16 v[168:171], v[120:123], a[212:215], v[168:171]
    s_waitcnt lgkmcnt(7)
    v_fmac_f32 v255, v167, v167
    v_fmac_f32 v255, v200, v200
    v_mfma_f32_16x16x32_bf16 v[108:111], a[72:75], v[124:127], 0
    s_waitcnt lgkmcnt(6)
    ds_write_b32 v246, v195 offset:896
    v_mfma_f32_16x16x32_bf16 v[108:111], a[76:79], v[128:131], v[108:111]
    s_waitcnt lgkmcnt(6)
    v_fmac_f32 v255, v201, v201
    v_fmac_f32 v255, v202, v202
    v_mfma_f32_16x16x32_bf16 v[108:111], a[80:83], v[132:135], v[108:111]
    s_waitcnt lgkmcnt(5)
    ds_write_b128 v247, v[112:115] offset:192
    v_mfma_f32_16x16x32_bf16 v[108:111], a[84:87], v[136:139], v[108:111]
    s_waitcnt lgkmcnt(4)
    v_fmac_f32 v255, v203, v203
    v_fma_f32 v254, v204, v204, s32
    v_mfma_f32_16x16x32_bf16 v[108:111], a[88:91], v[140:143], v[108:111]
    v_fmac_f32 v254, v205, v205
    v_fmac_f32 v254, v206, v206
    v_mfma_f32_16x16x32_bf16 v[108:111], a[92:95], v[144:147], v[108:111]
    v_fmac_f32 v254, v207, v207
    v_fmac_f32 v254, v172, v172
    v_mfma_f32_16x16x32_bf16 v[112:115], a[96:99], v[124:127], 0
    v_fmac_f32 v254, v173, v173
    v_fmac_f32 v254, v174, v174
    v_mfma_f32_16x16x32_bf16 v[112:115], a[100:103], v[128:131], v[112:115]
    v_fmac_f32 v254, v175, v175
    v_fmac_f32 v254, v152, v152
    v_mfma_f32_16x16x32_bf16 v[112:115], a[104:107], v[132:135], v[112:115]
    v_fmac_f32 v254, v153, v153
    v_fmac_f32 v254, v154, v154
    v_mfma_f32_16x16x32_bf16 v[112:115], a[108:111], v[136:139], v[112:115]
    v_fmac_f32 v254, v155, v155
    v_cvt_pk_bf16_f32 v38, v254, v255
    v_mfma_f32_16x16x32_bf16 v[112:115], a[112:115], v[140:143], v[112:115]
    v_cvt_pk_bf16_f32 v156, v156, v156
    v_cvt_pk_bf16_f32 v157, v157, v157
    v_mfma_f32_16x16x16_bf16 v[176:179], v[32:33], v[38:39], 0
    ds_write_b32 v245, v156 offset:0
    v_mfma_f32_16x16x32_bf16 v[112:115], a[116:119], v[144:147], v[112:115]
    v_cvt_pk_bf16_f32 v158, v158, v158
    v_cvt_pk_bf16_f32 v159, v159, v159
    v_mfma_f32_16x16x32_bf16 v[116:119], a[120:123], v[124:127], 0
    ds_write_b32 v245, v157 offset:256
    v_mfma_f32_16x16x32_bf16 v[116:119], a[124:127], v[128:131], v[116:119]
    v_cvt_pk_bf16_f32 v160, v160, v160
    v_cvt_pk_bf16_f32 v161, v161, v161
    v_mfma_f32_16x16x32_bf16 v[116:119], a[128:131], v[132:135], v[116:119]
    ds_write_b32 v245, v158 offset:512
    v_mfma_f32_16x16x32_bf16 v[116:119], a[132:135], v[136:139], v[116:119]
    v_rsq_f32 v177, v177
    v_mfma_f32_16x16x32_bf16 v[116:119], a[136:139], v[140:143], v[116:119]
    ds_write_b32 v245, v159 offset:768
    v_mfma_f32_16x16x32_bf16 v[116:119], a[140:143], v[144:147], v[116:119]
    v_rsq_f32 v176, v176
    v_mfma_f32_16x16x32_bf16 v[120:123], a[0:3], v[124:127], 0
    ds_write_b32 v245, v160 offset:64
    v_mfma_f32_16x16x32_bf16 v[120:123], a[4:7], v[128:131], v[120:123]
    v_mul_f32 v176, s31, v176
    v_mul_f32 v196, v177, v196
    v_mfma_f32_16x16x32_bf16 v[120:123], a[8:11], v[132:135], v[120:123]
    ds_write_b32 v245, v161 offset:320
    v_mfma_f32_16x16x32_bf16 v[120:123], a[12:15], v[136:139], v[120:123]
    v_mul_f32 v197, v177, v197
    v_cvt_pk_bf16_f32 v156, v196, v197
    v_mfma_f32_16x16x32_bf16 v[120:123], a[16:19], v[140:143], v[120:123]
    v_mul_f32 v198, v177, v198
    v_mul_f32 v199, v177, v199
    v_mfma_f32_16x16x32_bf16 v[120:123], a[20:23], v[144:147], v[120:123]
    v_cvt_pk_bf16_f32 v157, v198, v199
    v_mul_f32 v164, v177, v164
    v_mul_f32 v165, v177, v165
    v_cvt_pk_bf16_f32 v158, v164, v165
    v_mul_f32 v166, v177, v166
    v_mul_f32 v167, v177, v167
    v_cvt_pk_bf16_f32 v159, v166, v167
    v_mul_f32 v200, v177, v200
    v_mul_f32 v201, v177, v201
    v_cvt_pk_bf16_f32 v182, v200, v201
    v_mul_f32 v202, v177, v202
    v_mul_f32 v203, v177, v203
    v_cvt_pk_bf16_f32 v183, v202, v203
    v_mul_f32 v204, v176, v204
    v_mul_f32 v205, v176, v205
    v_cvt_pk_bf16_f32 v184, v204, v205
    v_mul_f32 v206, v176, v206
    v_mul_f32 v207, v176, v207
    v_cvt_pk_bf16_f32 v185, v206, v207
    v_mul_f32 v172, v176, v172
    v_mul_f32 v173, v176, v173
    v_cvt_pk_bf16_f32 v186, v172, v173
    v_mul_f32 v174, v176, v174
    v_mul_f32 v175, v176, v175
    v_cvt_pk_bf16_f32 v187, v174, v175
    v_mul_f32 v152, v176, v152
    v_mul_f32 v153, v176, v153
    v_cvt_pk_bf16_f32 v180, v152, v153
    v_mul_f32 v154, v176, v154
    v_mul_f32 v155, v176, v155
    v_cvt_pk_bf16_f32 v181, v154, v155
    v_mul_f32 v148, v204, v196
    v_fmac_f32 v148, v205, v197
    v_fmac_f32 v148, v206, v198
    v_fmac_f32 v148, v207, v199
    v_fmac_f32 v148, v172, v164
    v_fmac_f32 v148, v173, v165
    v_fmac_f32 v148, v174, v166
    v_fmac_f32 v148, v175, v167
    v_fmac_f32 v148, v152, v200
    v_fmac_f32 v148, v153, v201
    v_fmac_f32 v148, v154, v202
    v_fmac_f32 v148, v155, v203
    v_mov_b32 v255, v148
    v_cvt_pk_bf16_f32 v162, v162, v162
    v_cvt_pk_bf16_f32 v163, v163, v163
    v_permlane32_swap_b32 v148, v255
    v_add_f32 v148, v148, v255
    v_mov_b32 v255, v148
    v_cvt_pk_bf16_f32 v168, v168, v168
    v_cvt_pk_bf16_f32 v169, v169, v169
    v_permlane16_swap_b32 v148, v255
    v_add_f32 v148, v148, v255
    v_add_f32 v148, s39, v148
    v_cndmask_b32 v148, v149, v148, s[82:83]
    v_cvt_pk_bf16_f32 v170, v170, v170
    v_cvt_pk_bf16_f32 v171, v171, v171
    v_fma_f32 v255, v108, v108, s32
    v_fmac_f32 v255, v109, v109
    v_fmac_f32 v255, v110, v110
    v_fmac_f32 v255, v111, v111
    v_fmac_f32 v255, v112, v112
    v_fmac_f32 v255, v113, v113
    v_fmac_f32 v255, v114, v114
    v_fmac_f32 v255, v115, v115
    v_fmac_f32 v255, v116, v116
    v_fmac_f32 v255, v117, v117
    v_fmac_f32 v255, v118, v118
    v_fmac_f32 v255, v119, v119
    ds_write_b128 v248, v[148:151] offset:192
    ds_write_b128 v253, v[156:159]
    ds_write_b128 v253, v[184:187] offset:32
    ds_write_b64 v253, v[182:183] offset:48
    ds_write_b64 v253, v[180:181] offset:72
    ds_write_b32 v245, v162 offset:576
    ds_write_b32 v245, v163 offset:832
    ds_write_b32 v245, v168 offset:128
    ds_write_b32 v245, v169 offset:384
    ds_write_b32 v245, v170 offset:640
    ds_write_b32 v245, v171 offset:896
.p2align 6
L_loop_fast:
    v_mfma_f32_16x16x32_bf16 v[184:187], a[24:27], v[124:127], 0
    s_cmp_ge_u32 s18, 2
    ds_read_b128 v[188:191], v2 offset:18432
    ds_read_b128 v[192:195], v2 offset:19456
    v_mfma_f32_16x16x32_bf16 v[184:187], a[28:31], v[128:131], v[184:187]
    s_cselect_b32 s14, s36, 0
    v_mfma_f32_16x16x32_bf16 v[184:187], a[32:35], v[132:135], v[184:187]
    v_fma_f32 v254, v120, v120, s32
    v_fmac_f32 v254, v121, v121
    v_mfma_f32_16x16x32_bf16 v[184:187], a[36:39], v[136:139], v[184:187]
    v_fmac_f32 v254, v122, v122
    v_fmac_f32 v254, v123, v123
    v_mfma_f32_16x16x32_bf16 v[184:187], a[40:43], v[140:143], v[184:187]
    v_mfma_f32_16x16x32_bf16 v[184:187], a[44:47], v[144:147], v[184:187]
    v_mfma_f32_16x16x32_bf16 v[196:199], a[48:51], v[124:127], 0
    v_mfma_f32_16x16x32_bf16 v[196:199], a[52:55], v[128:131], v[196:199]
    v_mfma_f32_16x16x32_bf16 v[196:199], a[56:59], v[132:135], v[196:199]
    v_mfma_f32_16x16x32_bf16 v[196:199], a[60:63], v[136:139], v[196:199]
    s_waitcnt lgkmcnt(0)
    v_mfma_f32_16x16x32_bf16 v[200:203], v[32:35], v[188:191], 0
    v_mfma_f32_16x16x32_bf16 v[200:203], v[32:35], v[192:195], v[200:203]
    v_mfma_f32_16x16x32_bf16 v[196:199], a[64:67], v[140:143], v[196:199]
    v_fmac_f32 v254, v184, v184
    v_fmac_f32 v254, v185, v185
    v_mfma_f32_16x16x32_bf16 v[196:199], a[68:71], v[144:147], v[196:199]
    v_fmac_f32 v254, v186, v186
    v_fmac_f32 v254, v187, v187
    v_mfma_f32_16x16x32_bf16 v[188:191], v[124:127], a[144:147], 0
    v_mfma_f32_16x16x32_bf16 v[188:191], v[128:131], a[148:151], v[188:191]
    v_mul_f32 v253, 0x3baaaaab, v200
    v_mul_f32 v252, 0x3baaaaab, v201
    v_mfma_f32_16x16x32_bf16 v[188:191], v[132:135], a[152:155], v[188:191]
    v_rsq_f32 v253, v253
    v_mfma_f32_16x16x32_bf16 v[188:191], v[136:139], a[156:159], v[188:191]
    v_fmac_f32 v254, v196, v196
    v_fmac_f32 v254, v197, v197
    v_mfma_f32_16x16x32_bf16 v[188:191], v[140:143], a[160:163], v[188:191]
    v_fmac_f32 v254, v198, v198
    v_fmac_f32 v254, v199, v199
    v_mfma_f32_16x16x32_bf16 v[188:191], v[144:147], a[164:167], v[188:191]
    v_cvt_pk_bf16_f32 v38, v254, v255
    v_mul_f32 v255, 0x3baaaaab, v202
    v_mfma_f32_16x16x32_bf16 v[192:195], v[124:127], a[168:171], 0
    v_rsq_f32 v252, v252
    v_mfma_f32_16x16x16_bf16 v[200:203], v[32:33], v[38:39], 0
    v_rsq_f32 v255, v255
    v_mfma_f32_16x16x32_bf16 v[192:195], v[128:131], a[172:175], v[192:195]
    v_mul_f32 v148, v253, v148
    v_cvt_pk_bf16_f32 v188, v188, v189
    v_mfma_f32_16x16x32_bf16 v[192:195], v[132:135], a[176:179], v[192:195]
    ds_read_b128 v[204:207], v0 offset:26624
    v_cvt_pk_bf16_f32 v189, v190, v191
    v_mfma_f32_16x16x32_bf16 v[192:195], v[136:139], a[180:183], v[192:195]
    ds_read_b128 v[208:211], v1 offset:26624
    v_mul_f32 v149, v253, v149
    v_mfma_f32_16x16x32_bf16 v[192:195], v[140:143], a[184:187], v[192:195]
    ds_read_b128 v[212:215], v0 offset:26752
    v_cvt_pk_bf16_f32 v148, v148, v149
    v_mfma_f32_16x16x32_bf16 v[192:195], v[144:147], a[188:191], v[192:195]
    ds_read_b128 v[216:219], v1 offset:26752
    v_mul_f32 v150, v253, v150
    v_mfma_f32_16x16x32_bf16 v[220:223], v[124:127], a[192:195], 0
    ds_read_b128 v[124:127], v0 offset:26880
    v_mul_f32 v151, v253, v151
    v_mfma_f32_16x16x32_bf16 v[220:223], v[128:131], a[196:199], v[220:223]
    ds_read_b128 v[128:131], v1 offset:26880
    v_cvt_pk_bf16_f32 v149, v150, v151
    v_mfma_f32_16x16x32_bf16 v[220:223], v[132:135], a[200:203], v[220:223]
    v_rsq_f32 v201, v201
    v_mfma_f32_16x16x32_bf16 v[220:223], v[136:139], a[204:207], v[220:223]
    v_rsq_f32 v200, v200
    v_mfma_f32_16x16x32_bf16 v[220:223], v[140:143], a[208:211], v[220:223]
    v_mul_f32 v200, s31, v200
    v_cvt_pk_bf16_f32 v192, v192, v193
    v_mfma_f32_16x16x32_bf16 v[220:223], v[144:147], a[212:215], v[220:223]
    s_waitcnt lgkmcnt(5)
    v_cvt_pk_bf16_f32 v193, v194, v195
    v_mul_f32 v152, v253, v152
    v_mfma_f32_16x16x32_bf16 v[132:135], a[72:75], v[204:207], 0
    s_waitcnt lgkmcnt(4)
    v_mul_f32 v153, v253, v153
    v_cvt_pk_bf16_f32 v150, v152, v153
    v_mfma_f32_16x16x32_bf16 v[132:135], a[76:79], v[208:211], v[132:135]
    s_waitcnt lgkmcnt(3)
    v_cvt_pk_bf16_f32 v220, v220, v221
    v_cvt_pk_bf16_f32 v221, v222, v223
    v_mfma_f32_16x16x32_bf16 v[132:135], a[80:83], v[212:215], v[132:135]
    s_waitcnt lgkmcnt(2)
    v_mul_f32 v154, v253, v154
    v_mul_f32 v155, v253, v155
    v_mfma_f32_16x16x32_bf16 v[132:135], a[84:87], v[216:219], v[132:135]
    s_waitcnt lgkmcnt(1)
    v_cvt_pk_bf16_f32 v151, v154, v155
    v_mul_f32 v156, v253, v156
    v_mfma_f32_16x16x32_bf16 v[132:135], a[88:91], v[124:127], v[132:135]
    s_waitcnt lgkmcnt(0)
    buffer_store_dwordx4 v[148:151], v15, s[12:15], s27 offen
    v_mul_f32 v157, v253, v157
    v_cvt_pk_bf16_f32 v250, v156, v157
    v_mul_f32 v158, v253, v158
    v_mul_f32 v159, v253, v159
    v_mfma_f32_16x16x32_bf16 v[132:135], a[92:95], v[128:131], v[132:135]
    v_cvt_pk_bf16_f32 v251, v158, v159
    v_mul_f32 v108, v201, v108
    v_mfma_f32_16x16x32_bf16 v[136:139], a[96:99], v[204:207], 0
    buffer_store_dwordx2 v[250:251], v18, s[12:15], s27 offen
    v_mul_f32 v109, v201, v109
    v_cvt_pk_bf16_f32 v108, v108, v109
    v_mfma_f32_16x16x32_bf16 v[136:139], a[100:103], v[208:211], v[136:139]
    v_mul_f32 v110, v201, v110
    v_mul_f32 v111, v201, v111
    v_mfma_f32_16x16x32_bf16 v[136:139], a[104:107], v[212:215], v[136:139]
    v_cvt_pk_bf16_f32 v109, v110, v111
    v_mul_f32 v112, v201, v112
    v_mfma_f32_16x16x32_bf16 v[136:139], a[108:111], v[216:219], v[136:139]
    v_mul_f32 v113, v201, v113
    v_cvt_pk_bf16_f32 v110, v112, v113
    v_mfma_f32_16x16x32_bf16 v[136:139], a[112:115], v[124:127], v[136:139]
    v_mul_f32 v114, v201, v114
    v_mul_f32 v115, v201, v115
    v_mfma_f32_16x16x32_bf16 v[136:139], a[116:119], v[128:131], v[136:139]
    v_cvt_pk_bf16_f32 v111, v114, v115
    v_mul_f32 v116, v201, v116
    v_mfma_f32_16x16x32_bf16 v[112:115], a[120:123], v[204:207], 0
    v_mul_f32 v117, v201, v117
    v_cvt_pk_bf16_f32 v142, v116, v117
    v_mfma_f32_16x16x32_bf16 v[112:115], a[124:127], v[208:211], v[112:115]
    v_mul_f32 v118, v201, v118
    v_mul_f32 v119, v201, v119
    v_mfma_f32_16x16x32_bf16 v[112:115], a[128:131], v[212:215], v[112:115]
    v_cvt_pk_bf16_f32 v143, v118, v119
    v_mul_f32 v120, v200, v120
    v_mfma_f32_16x16x32_bf16 v[112:115], a[132:135], v[216:219], v[112:115]
    v_mul_f32 v121, v200, v121
    v_cvt_pk_bf16_f32 v116, v120, v121
    v_mfma_f32_16x16x32_bf16 v[112:115], a[136:139], v[124:127], v[112:115]
    v_mul_f32 v122, v200, v122
    v_mul_f32 v123, v200, v123
    v_mfma_f32_16x16x32_bf16 v[112:115], a[140:143], v[128:131], v[112:115]
    v_cvt_pk_bf16_f32 v117, v122, v123
    v_mul_f32 v184, v200, v184
    v_mfma_f32_16x16x32_bf16 v[120:123], a[0:3], v[204:207], 0
    v_mul_f32 v185, v200, v185
    v_cvt_pk_bf16_f32 v118, v184, v185
    v_mfma_f32_16x16x32_bf16 v[120:123], a[4:7], v[208:211], v[120:123]
    v_mul_f32 v186, v200, v186
    v_mul_f32 v187, v200, v187
    v_mfma_f32_16x16x32_bf16 v[120:123], a[8:11], v[212:215], v[120:123]
    v_cvt_pk_bf16_f32 v119, v186, v187
    v_mul_f32 v196, v200, v196
    v_mfma_f32_16x16x32_bf16 v[120:123], a[12:15], v[216:219], v[120:123]
    v_mul_f32 v197, v200, v197
    v_cvt_pk_bf16_f32 v140, v196, v197
    v_mfma_f32_16x16x32_bf16 v[120:123], a[16:19], v[124:127], v[120:123]
    v_mul_f32 v198, v200, v198
    v_mul_f32 v199, v200, v199
    v_mfma_f32_16x16x32_bf16 v[120:123], a[20:23], v[128:131], v[120:123]
    v_cvt_pk_bf16_f32 v141, v198, v199
    v_mul_f32 v160, v252, v160
    v_mfma_f32_16x16x32_bf16 v[144:147], a[24:27], v[204:207], 0
    v_mul_f32 v161, v252, v161
    v_cvt_pk_bf16_f32 v148, v160, v161
    v_mfma_f32_16x16x32_bf16 v[144:147], a[28:31], v[208:211], v[144:147]
    v_mul_f32 v162, v252, v162
    v_mul_f32 v163, v252, v163
    v_mfma_f32_16x16x32_bf16 v[144:147], a[32:35], v[212:215], v[144:147]
    v_cvt_pk_bf16_f32 v149, v162, v163
    v_mul_f32 v164, v252, v164
    v_mfma_f32_16x16x32_bf16 v[144:147], a[36:39], v[216:219], v[144:147]
    v_mul_f32 v165, v252, v165
    v_cvt_pk_bf16_f32 v150, v164, v165
    v_mfma_f32_16x16x32_bf16 v[144:147], a[40:43], v[124:127], v[144:147]
    v_mul_f32 v166, v252, v166
    v_mul_f32 v167, v252, v167
    v_mfma_f32_16x16x32_bf16 v[144:147], a[44:47], v[128:131], v[144:147]
    v_cvt_pk_bf16_f32 v151, v166, v167
    v_mul_f32 v168, v252, v168
    v_mfma_f32_16x16x32_bf16 v[152:155], a[48:51], v[204:207], 0
    buffer_store_dwordx4 v[148:151], v16, s[12:15], s27 offen
    v_mul_f32 v169, v252, v169
    v_cvt_pk_bf16_f32 v250, v168, v169
    v_mul_f32 v170, v252, v170
    v_mul_f32 v171, v252, v171
    v_mfma_f32_16x16x32_bf16 v[152:155], a[52:55], v[208:211], v[152:155]
    v_cvt_pk_bf16_f32 v251, v170, v171
    v_fma_f32 v254, v120, v120, s32
    v_mfma_f32_16x16x32_bf16 v[152:155], a[56:59], v[212:215], v[152:155]
    buffer_store_dwordx2 v[250:251], v19, s[12:15], s27 offen
    v_fmac_f32 v254, v121, v121
    v_fmac_f32 v254, v122, v122
    v_mfma_f32_16x16x32_bf16 v[152:155], a[60:63], v[216:219], v[152:155]
    v_fmac_f32 v254, v123, v123
    v_fmac_f32 v254, v144, v144
    v_mfma_f32_16x16x32_bf16 v[152:155], a[64:67], v[124:127], v[152:155]
    v_fmac_f32 v254, v145, v145
    v_fmac_f32 v254, v146, v146
    v_mfma_f32_16x16x32_bf16 v[152:155], a[68:71], v[128:131], v[152:155]
    v_fmac_f32 v254, v147, v147
    v_fma_f32 v253, v132, v132, s32
    v_mfma_f32_16x16x32_bf16 v[148:151], v[204:207], a[144:147], 0
    v_fmac_f32 v253, v133, v133
    v_fmac_f32 v253, v134, v134
    v_mfma_f32_16x16x32_bf16 v[148:151], v[208:211], a[148:151], v[148:151]
    v_fmac_f32 v253, v135, v135
    v_fmac_f32 v253, v136, v136
    v_mfma_f32_16x16x32_bf16 v[148:151], v[212:215], a[152:155], v[148:151]
    v_fmac_f32 v254, v152, v152
    v_fmac_f32 v254, v153, v153
    v_mfma_f32_16x16x32_bf16 v[148:151], v[216:219], a[156:159], v[148:151]
    v_fmac_f32 v254, v154, v154
    v_fmac_f32 v254, v155, v155
    v_mfma_f32_16x16x32_bf16 v[148:151], v[124:127], a[160:163], v[148:151]
    v_fmac_f32 v253, v137, v137
    v_fmac_f32 v253, v138, v138
    v_mfma_f32_16x16x32_bf16 v[148:151], v[128:131], a[164:167], v[148:151]
    v_fmac_f32 v253, v139, v139
    v_fmac_f32 v253, v112, v112
    v_mfma_f32_16x16x32_bf16 v[156:159], v[204:207], a[168:171], 0
    v_fmac_f32 v253, v113, v113
    v_fmac_f32 v253, v114, v114
    v_mfma_f32_16x16x32_bf16 v[156:159], v[208:211], a[172:175], v[156:159]
    v_fmac_f32 v253, v115, v115
    v_cvt_pk_bf16_f32 v38, v254, v253
    v_mfma_f32_16x16x32_bf16 v[156:159], v[212:215], a[176:179], v[156:159]
    ds_read_b128 v[160:163], v0 offset:32768
    v_cvt_pk_bf16_f32 v190, v148, v149
    v_mfma_f32_16x16x16_bf16 v[164:167], v[32:33], v[38:39], 0
    v_cvt_pk_bf16_f32 v191, v150, v151
    v_mul_f32 v172, v255, v172
    v_mfma_f32_16x16x32_bf16 v[156:159], v[216:219], a[180:183], v[156:159]
    ds_read_b128 v[148:151], v1 offset:32768
    v_mul_f32 v173, v255, v173
    v_mfma_f32_16x16x32_bf16 v[156:159], v[124:127], a[184:187], v[156:159]
    ds_read_b128 v[168:171], v0 offset:32896
    v_cvt_pk_bf16_f32 v172, v172, v173
    v_mfma_f32_16x16x32_bf16 v[156:159], v[128:131], a[188:191], v[156:159]
    ds_read_b128 v[184:187], v1 offset:32896
    v_mul_f32 v174, v255, v174
    v_mfma_f32_16x16x32_bf16 v[196:199], v[204:207], a[192:195], 0
    ds_read_b128 v[200:203], v0 offset:33024
    v_mul_f32 v175, v255, v175
    v_mfma_f32_16x16x32_bf16 v[196:199], v[208:211], a[196:199], v[196:199]
    ds_read_b128 v[204:207], v1 offset:33024
    v_cvt_pk_bf16_f32 v173, v174, v175
    v_mfma_f32_16x16x32_bf16 v[196:199], v[212:215], a[200:203], v[196:199]
    v_rsq_f32 v165, v165
    v_mfma_f32_16x16x32_bf16 v[196:199], v[216:219], a[204:207], v[196:199]
    v_rsq_f32 v164, v164
    v_mfma_f32_16x16x32_bf16 v[196:199], v[124:127], a[208:211], v[196:199]
    s_waitcnt lgkmcnt(5)
    v_mul_f32 v164, s31, v164
    v_cvt_pk_bf16_f32 v194, v156, v157
    v_mfma_f32_16x16x32_bf16 v[196:199], v[128:131], a[212:215], v[196:199]
    v_cvt_pk_bf16_f32 v195, v158, v159
    v_mul_f32 v176, v255, v176
    v_mfma_f32_16x16x32_bf16 v[124:127], a[72:75], v[160:163], 0
    s_waitcnt lgkmcnt(4)
    v_mul_f32 v177, v255, v177
    v_cvt_pk_bf16_f32 v174, v176, v177
    v_mfma_f32_16x16x32_bf16 v[124:127], a[76:79], v[148:151], v[124:127]
    s_waitcnt lgkmcnt(3)
    v_cvt_pk_bf16_f32 v222, v196, v197
    v_cvt_pk_bf16_f32 v223, v198, v199
    v_mfma_f32_16x16x32_bf16 v[124:127], a[80:83], v[168:171], v[124:127]
    s_waitcnt lgkmcnt(2)
    v_mul_f32 v178, v255, v178
    v_mul_f32 v179, v255, v179
    v_mfma_f32_16x16x32_bf16 v[124:127], a[84:87], v[184:187], v[124:127]
    s_waitcnt lgkmcnt(1)
    v_cvt_pk_bf16_f32 v175, v178, v179
    v_mul_f32 v180, v255, v180
    v_mfma_f32_16x16x32_bf16 v[124:127], a[88:91], v[200:203], v[124:127]
    s_waitcnt lgkmcnt(0)
    buffer_store_dwordx4 v[172:175], v17, s[12:15], s27 offen
    v_mul_f32 v181, v255, v181
    v_cvt_pk_bf16_f32 v254, v180, v181
    v_mul_f32 v182, v255, v182
    v_mul_f32 v183, v255, v183
    v_mfma_f32_16x16x32_bf16 v[124:127], a[92:95], v[204:207], v[124:127]
    v_cvt_pk_bf16_f32 v255, v182, v183
    v_mul_f32 v132, v165, v132
    v_mfma_f32_16x16x32_bf16 v[128:131], a[96:99], v[160:163], 0
    buffer_store_dwordx2 v[254:255], v20, s[12:15], s27 offen
    v_mul_f32 v133, v165, v133
    v_cvt_pk_bf16_f32 v132, v132, v133
    v_mfma_f32_16x16x32_bf16 v[128:131], a[100:103], v[148:151], v[128:131]
    s_mov_b32 s27, s26
    v_mul_f32 v134, v165, v134
    v_mul_f32 v135, v165, v135
    v_mfma_f32_16x16x32_bf16 v[128:131], a[104:107], v[168:171], v[128:131]
    s_mov_b32 s26, s25
    v_cvt_pk_bf16_f32 v133, v134, v135
    v_mul_f32 v136, v165, v136
    v_mfma_f32_16x16x32_bf16 v[128:131], a[108:111], v[184:187], v[128:131]
    s_mov_b32 s25, s24
    v_mul_f32 v137, v165, v137
    v_cvt_pk_bf16_f32 v134, v136, v137
    v_mfma_f32_16x16x32_bf16 v[128:131], a[112:115], v[200:203], v[128:131]
    s_mov_b32 s24, s23
    v_mul_f32 v138, v165, v138
    v_mul_f32 v139, v165, v139
    v_mfma_f32_16x16x32_bf16 v[128:131], a[116:119], v[204:207], v[128:131]
    v_cvt_pk_bf16_f32 v135, v138, v139
    v_mul_f32 v112, v165, v112
    v_mfma_f32_16x16x32_bf16 v[136:139], a[120:123], v[160:163], 0
    v_mul_f32 v113, v165, v113
    v_cvt_pk_bf16_f32 v174, v112, v113
    v_mfma_f32_16x16x32_bf16 v[136:139], a[124:127], v[148:151], v[136:139]
    v_mul_f32 v114, v165, v114
    v_mul_f32 v115, v165, v115
    v_mfma_f32_16x16x32_bf16 v[136:139], a[128:131], v[168:171], v[136:139]
    v_cvt_pk_bf16_f32 v175, v114, v115
    v_mul_f32 v120, v164, v120
    v_mfma_f32_16x16x32_bf16 v[136:139], a[132:135], v[184:187], v[136:139]
    v_mul_f32 v121, v164, v121
    v_cvt_pk_bf16_f32 v112, v120, v121
    v_mfma_f32_16x16x32_bf16 v[136:139], a[136:139], v[200:203], v[136:139]
    v_mul_f32 v122, v164, v122
    v_mul_f32 v123, v164, v123
    v_mfma_f32_16x16x32_bf16 v[136:139], a[140:143], v[204:207], v[136:139]
    s_waitcnt vmcnt(6)
    v_cvt_pk_bf16_f32 v113, v122, v123
    v_mul_f32 v144, v164, v144
    v_mfma_f32_16x16x32_bf16 v[120:123], a[0:3], v[160:163], 0
    s_barrier
    v_mul_f32 v145, v164, v145
    v_cvt_pk_bf16_f32 v114, v144, v145
    v_mfma_f32_16x16x32_bf16 v[120:123], a[4:7], v[148:151], v[120:123]
    s_add_u32 s34, s18, 2
    v_mul_f32 v146, v164, v146
    v_mul_f32 v147, v164, v147
    v_mfma_f32_16x16x32_bf16 v[120:123], a[8:11], v[168:171], v[120:123]
    s_cmp_lt_u32 s34, s17
    v_cvt_pk_bf16_f32 v115, v146, v147
    v_mul_f32 v152, v164, v152
    v_mfma_f32_16x16x32_bf16 v[120:123], a[12:15], v[184:187], v[120:123]
    s_cselect_b32 s10, s36, 0
    v_mul_f32 v153, v164, v153
    v_cvt_pk_bf16_f32 v172, v152, v153
    v_mfma_f32_16x16x32_bf16 v[120:123], a[16:19], v[200:203], v[120:123]
    s_add_u32 m0, s28, 0
    v_mul_f32 v154, v164, v154
    v_mul_f32 v155, v164, v155
    v_mfma_f32_16x16x32_bf16 v[120:123], a[20:23], v[204:207], v[120:123]
    v_cvt_pk_bf16_f32 v173, v154, v155
    v_fma_f32 v255, v124, v124, s32
    v_mfma_f32_16x16x32_bf16 v[144:147], a[24:27], v[160:163], 0
    buffer_load_dwordx4 v10, s[8:11], s23 offen nt lds
    ds_read_b128 v[152:155], v5 offset:0
    v_mfma_f32_16x16x32_bf16 v[144:147], a[28:31], v[148:151], v[144:147]
    s_add_u32 m0, s28, 1024
    ds_read_b128 v[156:159], v5 offset:16
    ds_read_b128 v[164:167], v5 offset:48
    v_mfma_f32_16x16x32_bf16 v[144:147], a[32:35], v[168:171], v[144:147]
    ds_read_b32 v254, v6 offset:192
    v_fma_f32 v253, v120, v120, s32
    v_mfma_f32_16x16x32_bf16 v[144:147], a[36:39], v[184:187], v[144:147]
    v_fmac_f32 v253, v121, v121
    v_fmac_f32 v253, v122, v122
    v_mfma_f32_16x16x32_bf16 v[144:147], a[40:43], v[200:203], v[144:147]
    v_fmac_f32 v253, v123, v123
    v_fmac_f32 v255, v125, v125
    v_mfma_f32_16x16x32_bf16 v[144:147], a[44:47], v[204:207], v[144:147]
    v_fmac_f32 v255, v126, v126
    v_fmac_f32 v255, v127, v127
    v_mfma_f32_16x16x32_bf16 v[176:179], a[48:51], v[160:163], 0
    v_fmac_f32 v255, v128, v128
    v_fmac_f32 v255, v129, v129
    v_mfma_f32_16x16x32_bf16 v[176:179], a[52:55], v[148:151], v[176:179]
    v_fmac_f32 v255, v130, v130
    v_fmac_f32 v255, v131, v131
    v_mfma_f32_16x16x32_bf16 v[176:179], a[56:59], v[168:171], v[176:179]
    buffer_load_dwordx4 v11, s[8:11], s23 offen nt lds
    v_fmac_f32 v253, v144, v144
    v_mfma_f32_16x16x32_bf16 v[176:179], a[60:63], v[184:187], v[176:179]
    s_waitcnt lgkmcnt(3)
    v_fmac_f32 v253, v145, v145
    v_fmac_f32 v253, v146, v146
    v_mfma_f32_16x16x32_bf16 v[176:179], a[64:67], v[200:203], v[176:179]
    s_add_u32 m0, s28, 2048
    v_fmac_f32 v253, v147, v147
    v_fmac_f32 v255, v136, v136
    v_mfma_f32_16x16x32_bf16 v[176:179], a[68:71], v[204:207], v[176:179]
    s_waitcnt lgkmcnt(0)
    v_fmac_f32 v255, v137, v137
    v_fmac_f32 v255, v138, v138
    v_mfma_f32_16x16x32_bf16 v[180:183], v[160:163], a[144:147], 0
    v_fmac_f32 v255, v139, v139
    v_xor_b32 v0, 65536, v0
    v_mfma_f32_16x16x32_bf16 v[180:183], v[148:151], a[148:151], v[180:183]
    v_xor_b32 v1, 65536, v1
    v_fmac_f32 v253, v176, v176
    v_mfma_f32_16x16x32_bf16 v[180:183], v[168:171], a[152:155], v[180:183]
    v_fmac_f32 v253, v177, v177
    v_fmac_f32 v253, v178, v178
    v_mfma_f32_16x16x32_bf16 v[180:183], v[184:187], a[156:159], v[180:183]
    v_fmac_f32 v253, v179, v179
    v_cvt_pk_bf16_f32 v38, v253, v255
    v_mfma_f32_16x16x32_bf16 v[180:183], v[200:203], a[160:163], v[180:183]
    ds_read_b128 v[196:199], v2 offset:0
    buffer_load_dwordx4 v12, s[8:11], s23 offen nt lds
    v_mfma_f32_16x16x16_bf16 v[208:211], v[32:33], v[38:39], 0
    s_add_u32 m0, s28, 3072
    v_add_u32 v5, 320, v5
    s_xor_b32 s28, s28, 65536
    v_mfma_f32_16x16x32_bf16 v[180:183], v[204:207], a[164:167], v[180:183]
    ds_read_b128 v[212:215], v2 offset:1024
    v_mfma_f32_16x16x32_bf16 v[216:219], v[160:163], a[168:171], 0
    ds_read_b128 v[224:227], v2 offset:2048
    ds_read2_b32 v[230:231], v6 offset0:0 offset1:0
    v_mfma_f32_16x16x32_bf16 v[216:219], v[148:151], a[172:175], v[216:219]
    ds_read2_b32 v[234:235], v6 offset0:16 offset1:16
    ds_read2_b32 v[210:211], v6 offset0:32 offset1:32
    v_mfma_f32_16x16x32_bf16 v[216:219], v[168:171], a[176:179], v[216:219]
    v_cvt_pk_bf16_f32 v228, v180, v181
    v_cvt_pk_bf16_f32 v229, v182, v183
    v_mfma_f32_16x16x32_bf16 v[180:183], v[152:155], v[116:119], v[22:25]
    v_rsq_f32 v209, v209
    v_mfma_f32_16x16x32_bf16 v[180:183], v[156:159], v[108:111], v[180:183]
    v_rsq_f32 v208, v208
    v_mfma_f32_16x16x32_bf16 v[180:183], v[164:167], v[140:143], v[180:183]
    v_mul_f32 v208, s31, v208
    v_mul_f32 v124, v209, v124
    v_mfma_f32_16x16x32_bf16 v[236:239], v[152:155], v[112:115], v[24:27]
    s_waitcnt lgkmcnt(5)
    v_mul_f32 v125, v209, v125
    v_cvt_pk_bf16_f32 v124, v124, v125
    v_mfma_f32_16x16x32_bf16 v[236:239], v[156:159], v[132:135], v[236:239]
    v_mul_f32 v126, v209, v126
    v_mul_f32 v127, v209, v127
    v_mfma_f32_16x16x32_bf16 v[236:239], v[164:167], v[172:175], v[236:239]
    s_waitcnt lgkmcnt(4)
    v_cvt_pk_bf16_f32 v125, v126, v127
    v_mul_f32 v128, v209, v128
    v_mfma_f32_16x16x32_bf16 v[216:219], v[184:187], a[180:183], v[216:219]
    s_waitcnt lgkmcnt(2)
    v_mul_f32 v129, v209, v129
    v_cvt_pk_bf16_f32 v126, v128, v129
    v_mfma_f32_16x16x32_bf16 v[216:219], v[200:203], a[184:187], v[216:219]
    s_waitcnt lgkmcnt(0)
    v_mul_f32 v130, v209, v130
    v_mul_f32 v131, v209, v131
    v_mfma_f32_16x16x32_bf16 v[216:219], v[204:207], a[188:191], v[216:219]
    v_cvt_pk_bf16_f32 v127, v130, v131
    v_mul_f32 v136, v209, v136
    v_mfma_f32_16x16x32_bf16 v[128:131], v[160:163], a[192:195], 0
    buffer_load_dwordx4 v13, s[8:11], s23 offen nt lds
    v_mul_f32 v137, v209, v137
    v_mfma_f32_16x16x32_bf16 v[128:131], v[148:151], a[196:199], v[128:131]
    s_mov_b32 m0, s29
    v_cvt_pk_bf16_f32 v242, v136, v137
    v_cvt_pk_bf16_f32 v232, v216, v217
    v_mfma_f32_16x16x32_bf16 v[160:163], v[108:111], v[116:119], v[40:43]
    s_xor_b32 s29, s29, s30
    v_cvt_pk_bf16_f32 v233, v218, v219
    v_mul_f32 v138, v209, v138
    v_mfma_f32_16x16x32_bf16 v[216:219], v[132:135], v[116:119], v[44:47]
    s_add_u32 s19, s19, s20
    v_mul_f32 v139, v209, v139
    v_cvt_pk_bf16_f32 v243, v138, v139
    v_mfma_f32_16x16x16_bf16 v[160:163], v[142:143], v[140:141], v[160:163]
    v_mul_f32 v120, v208, v120
    v_mul_f32 v121, v208, v121
    v_mfma_f32_16x16x16_bf16 v[216:219], v[174:175], v[140:141], v[216:219]
    v_cvt_pk_bf16_f32 v120, v120, v121
    v_mul_f32 v122, v208, v122
    v_mfma_f32_16x16x32_bf16 v[136:139], v[124:127], v[116:119], v[48:51]
    v_mul_f32 v123, v208, v123
    v_cvt_pk_bf16_f32 v121, v122, v123
    v_mfma_f32_16x16x32_bf16 v[128:131], v[168:171], a[200:203], v[128:131]
    v_mul_f32 v144, v208, v144
    v_mul_f32 v145, v208, v145
    v_mfma_f32_16x16x32_bf16 v[128:131], v[184:187], a[204:207], v[128:131]
    v_cvt_pk_bf16_f32 v122, v144, v145
    v_mul_f32 v146, v208, v146
    v_mfma_f32_16x16x16_bf16 v[136:139], v[242:243], v[140:141], v[136:139]
    v_mul_f32 v147, v208, v147
    v_cvt_pk_bf16_f32 v123, v146, v147
    v_mfma_f32_16x16x32_bf16 v[128:131], v[200:203], a[208:211], v[128:131]
    v_mul_f32 v176, v208, v176
    v_mul_f32 v177, v208, v177
    v_mfma_f32_16x16x32_bf16 v[116:119], v[152:155], v[120:123], v[26:29]
    v_cvt_pk_bf16_f32 v240, v176, v177
    v_mul_f32 v178, v208, v178
    v_mfma_f32_16x16x32_bf16 v[116:119], v[156:159], v[124:127], v[116:119]
    v_mul_f32 v179, v208, v179
    v_cvt_pk_bf16_f32 v241, v178, v179
    v_mfma_f32_16x16x32_bf16 v[128:131], v[204:207], a[212:215], v[128:131]
    v_mov_b32_dpp v254, v181 quad_perm:[0,1,2,3] row_mask:0x1 bank_mask:0xf
    v_mov_b32_dpp v254, v237 quad_perm:[0,1,2,3] row_mask:0x2 bank_mask:0xf
    v_mfma_f32_16x16x32_bf16 v[116:119], v[164:167], v[240:243], v[116:119]
    v_exp_f32 v160, v160
    v_mfma_f32_16x16x32_bf16 v[148:151], a[216:219], v[196:199], 0
    ds_read_b128 v[144:147], v2 offset:3072
    v_add_u32 v6, 256, v6
    v_mfma_f32_16x16x32_bf16 v[152:155], a[240:243], v[196:199], 0
    v_cvt_pk_bf16_f32 v208, v128, v129
    v_cvt_pk_bf16_f32 v209, v130, v131
    v_mfma_f32_16x16x32_bf16 v[156:159], v[84:87], v[196:199], 0
    v_mov_b32_dpp v254, v117 quad_perm:[0,1,2,3] row_mask:0x4 bank_mask:0xf
    v_mfma_f32_16x16x32_bf16 v[148:151], a[220:223], v[212:215], v[148:151]
    ds_read_b128 v[128:131], v2 offset:4096
    v_mfma_f32_16x16x32_bf16 v[152:155], a[244:247], v[212:215], v[152:155]
    buffer_load_dwordx4 v14, s[8:11], s23 offen nt lds
    s_add_u32 s23, s23, s21
    v_mfma_f32_16x16x32_bf16 v[156:159], v[88:91], v[212:215], v[156:159]
    s_cmp_ge_u32 s19, 72
    v_exp_f32 v254, v254
    v_mfma_f32_16x16x32_bf16 v[148:151], a[224:227], v[224:227], v[148:151]
    s_cselect_b32 s34, 72, 0
    ds_read_b128 v[164:167], v2 offset:5120
    v_cvt_pk_bf16_f32 v254, v254, v254
    v_mfma_f32_16x16x32_bf16 v[152:155], a[248:251], v[224:227], v[152:155]
    s_cselect_b32 s35, s22, 0
    ds_write_b16 v8, v254
    v_mfma_f32_16x16x32_bf16 v[156:159], v[92:95], v[224:227], v[156:159]
    s_sub_u32 s19, s19, s34
    v_exp_f32 v161, v161
    v_exp_f32 v162, v162
    v_cvt_pk_bf16_f32 v160, v160, v161
    v_exp_f32 v163, v163
    v_exp_f32 v216, v216
    v_cvt_pk_bf16_f32 v161, v162, v163
    v_mfma_f32_16x16x32_bf16 v[168:171], v[108:111], v[112:115], v[52:55]
    s_waitcnt lgkmcnt(3)
    v_exp_f32 v217, v217
    v_mfma_f32_16x16x32_bf16 v[176:179], v[132:135], v[112:115], v[56:59]
    s_add_u32 s23, s23, s35
    v_cvt_pk_bf16_f32 v162, v216, v217
    s_add_u32 s18, s18, 1
    v_mfma_f32_16x16x16_bf16 v[168:171], v[142:143], v[172:173], v[168:171]
    s_cmp_lt_u32 s18, s17
    v_exp_f32 v218, v218
    v_mfma_f32_16x16x16_bf16 v[176:179], v[174:175], v[172:173], v[176:179]
    s_waitcnt lgkmcnt(2)
    v_exp_f32 v219, v219
    v_mfma_f32_16x16x32_bf16 v[148:151], a[228:231], v[144:147], v[148:151]
    s_waitcnt lgkmcnt(1)
    ds_read_b128 v[184:187], v2 offset:6144
    v_cvt_pk_bf16_f32 v163, v218, v219
    v_mfma_f32_16x16x32_bf16 v[196:199], v[124:127], v[112:115], v[60:63]
    ds_read_b128 v[112:115], v9
    ds_read_b128 v[200:203], v9 offset:64
    v_mfma_f32_16x16x32_bf16 v[152:155], a[252:255], v[144:147], v[152:155]
    v_exp_f32 v136, v136
    v_mfma_f32_16x16x32_bf16 v[156:159], v[96:99], v[144:147], v[156:159]
    v_exp_f32 v137, v137
    v_mfma_f32_16x16x16_bf16 v[196:199], v[242:243], v[172:173], v[196:199]
    v_cvt_pk_bf16_f32 v36, v136, v137
    v_mfma_f32_16x16x32_bf16 v[148:151], a[232:235], v[128:131], v[148:151]
    ds_read_b128 v[144:147], v2 offset:7168
    v_mfma_f32_16x16x32_bf16 v[152:155], v[76:79], v[128:131], v[152:155]
    v_exp_f32 v138, v138
    v_mfma_f32_16x16x32_bf16 v[156:159], v[100:103], v[128:131], v[156:159]
    v_exp_f32 v139, v139
    v_mfma_f32_16x16x32_bf16 v[148:151], a[236:239], v[164:167], v[148:151]
    ds_read_b128 v[128:131], v2 offset:8192
    v_cvt_pk_bf16_f32 v37, v138, v139
    v_mfma_f32_16x16x32_bf16 v[152:155], v[80:83], v[164:167], v[152:155]
    s_waitcnt lgkmcnt(4)
    v_exp_f32 v180, v180
    v_mfma_f32_16x16x32_bf16 v[156:159], v[104:107], v[164:167], v[156:159]
    s_waitcnt lgkmcnt(2)
    v_cvt_pk_bf16_f32 v38, v180, 0
    v_fma_f32 v255, v148, v148, s33
    v_mfma_f32_16x16x32_bf16 v[136:139], v[112:115], v[28:31], 0
    v_exp_f32 v168, v168
    v_mfma_f32_16x16x32_bf16 v[164:167], v[28:31], v[36:39], 0
    v_exp_f32 v169, v169
    v_mfma_f32_16x16x32_bf16 v[164:167], v[28:31], v[160:163], v[164:167]
    v_cvt_pk_bf16_f32 v140, v168, v169
    v_fmac_f32 v255, v149, v149
    v_mfma_f32_16x16x32_bf16 v[180:183], v[228:231], v[36:39], 0
    s_waitcnt lgkmcnt(1)
    v_exp_f32 v170, v170
    v_mfma_f32_16x16x32_bf16 v[180:183], v[188:191], v[160:163], v[180:183]
    v_exp_f32 v171, v171
    v_mfma_f32_16x16x32_bf16 v[204:207], v[232:235], v[36:39], 0
    v_rcp_f32 v164, v164
    v_mfma_f32_16x16x32_bf16 v[204:207], v[192:195], v[160:163], v[204:207]
    s_waitcnt lgkmcnt(0)
    v_cvt_pk_bf16_f32 v141, v170, v171
    v_fmac_f32 v255, v150, v150
    v_mfma_f32_16x16x32_bf16 v[168:171], v[208:211], v[36:39], 0
    v_mul_f32 v180, v164, v180
    v_mul_f32 v181, v164, v181
    v_mfma_f32_16x16x32_bf16 v[168:171], v[220:223], v[160:163], v[168:171]
    v_cvt_pk_bf16_f32 v160, v180, v181
    v_mul_f32 v182, v164, v182
    v_mfma_f32_16x16x32_bf16 v[136:139], v[200:203], v[28:31], v[136:139]
    v_mul_f32 v183, v164, v183
    v_cvt_pk_bf16_f32 v161, v182, v183
    v_mfma_f32_16x16x32_bf16 v[180:183], v[112:115], v[188:191], 0
    v_mul_f32 v204, v164, v204
    v_mul_f32 v205, v164, v205
    v_mfma_f32_16x16x32_bf16 v[180:183], v[200:203], v[228:231], v[180:183]
    v_cvt_pk_bf16_f32 v162, v204, v205
    v_mul_f32 v206, v164, v206
    v_mfma_f32_16x16x32_bf16 v[212:215], v[112:115], v[192:195], 0
    v_rcp_f32 v136, v136
    v_mfma_f32_16x16x32_bf16 v[212:215], v[200:203], v[232:235], v[212:215]
    v_mul_f32 v207, v164, v207
    v_cvt_pk_bf16_f32 v163, v206, v207
    v_mfma_f32_16x16x32_bf16 v[204:207], v[112:115], v[220:223], 0
    ds_write_b128 v3, v[160:163] offset:0
    v_mfma_f32_16x16x32_bf16 v[204:207], v[200:203], v[208:211], v[204:207]
    v_mul_f32 v180, v180, v136
    v_mul_f32 v168, v164, v168
    v_mfma_f32_16x16x32_bf16 v[112:115], v[108:111], v[120:123], v[64:67]
    v_mul_f32_dpp v180, v212, v136 quad_perm:[0,1,2,3] row_mask:0x2 bank_mask:0xf
    v_mul_f32 v169, v164, v169
    v_mfma_f32_16x16x32_bf16 v[108:111], v[132:135], v[120:123], v[68:71]
    v_cvt_pk_bf16_f32 v252, v168, v169
    v_mul_f32 v170, v164, v170
    v_mfma_f32_16x16x32_bf16 v[160:163], a[216:219], v[184:187], 0
    ds_read_b128 v[132:135], v2 offset:9216
    v_mul_f32_dpp v180, v204, v136 quad_perm:[0,1,2,3] row_mask:0x4 bank_mask:0xf
    v_mfma_f32_16x16x16_bf16 v[112:115], v[142:143], v[240:241], v[112:115]
    v_cvt_pk_bf16_f32 v180, v180, v180
    v_mul_f32 v171, v164, v171
    v_mfma_f32_16x16x16_bf16 v[108:111], v[174:175], v[240:241], v[108:111]
    ds_write_b16 v7, v180
    v_mfma_f32_16x16x32_bf16 v[164:167], a[240:243], v[184:187], 0
    v_cvt_pk_bf16_f32 v253, v170, v171
    v_fmac_f32 v255, v151, v151
    v_mfma_f32_16x16x32_bf16 v[168:171], v[84:87], v[184:187], 0
    ds_write_b64 v4, v[252:253] offset:4096
    v_mfma_f32_16x16x32_bf16 v[160:163], a[220:223], v[144:147], v[160:163]
    v_exp_f32 v176, v176
    v_mfma_f32_16x16x32_bf16 v[164:167], a[244:247], v[144:147], v[164:167]
    ds_read_b128 v[136:139], v2 offset:10240
    v_fmac_f32 v255, v152, v152
    v_mfma_f32_16x16x32_bf16 v[168:171], v[88:91], v[144:147], v[168:171]
    v_exp_f32 v177, v177
    v_mfma_f32_16x16x32_bf16 v[160:163], a[224:227], v[128:131], v[160:163]
    s_waitcnt lgkmcnt(3)
    ds_read_b128 v[144:147], v2 offset:11264
    v_cvt_pk_bf16_f32 v142, v176, v177
    v_mfma_f32_16x16x32_bf16 v[164:167], a[248:251], v[128:131], v[164:167]
    v_exp_f32 v178, v178
    v_mfma_f32_16x16x32_bf16 v[168:171], v[92:95], v[128:131], v[168:171]
    v_exp_f32 v179, v179
    v_mfma_f32_16x16x32_bf16 v[160:163], a[228:231], v[132:135], v[160:163]
    ds_read_b128 v[128:131], v2 offset:12288
    v_cvt_pk_bf16_f32 v143, v178, v179
    v_mfma_f32_16x16x32_bf16 v[184:187], v[124:127], v[120:123], v[72:75]
    v_exp_f32 v196, v196
    v_mfma_f32_16x16x32_bf16 v[164:167], a[252:255], v[132:135], v[164:167]
    v_exp_f32 v197, v197
    v_mfma_f32_16x16x32_bf16 v[168:171], v[96:99], v[132:135], v[168:171]
    v_cvt_pk_bf16_f32 v36, v196, v197
    v_exp_f32 v198, v198
    v_mfma_f32_16x16x16_bf16 v[184:187], v[242:243], v[240:241], v[184:187]
    s_waitcnt lgkmcnt(2)
    v_exp_f32 v199, v199
    v_mfma_f32_16x16x32_bf16 v[160:163], a[232:235], v[136:139], v[160:163]
    s_waitcnt lgkmcnt(1)
    ds_read_b128 v[120:123], v2 offset:13312
    v_cvt_pk_bf16_f32 v37, v198, v199
    v_mfma_f32_16x16x32_bf16 v[164:167], v[76:79], v[136:139], v[164:167]
    v_exp_f32 v236, v236
    v_mfma_f32_16x16x32_bf16 v[168:171], v[100:103], v[136:139], v[168:171]
    v_cvt_pk_bf16_f32 v38, v236, 0
    v_fmac_f32 v255, v153, v153
    v_mfma_f32_16x16x32_bf16 v[160:163], a[236:239], v[144:147], v[160:163]
    s_waitcnt lgkmcnt(1)
    ds_read_b128 v[132:135], v2 offset:14336
    v_fmac_f32 v255, v154, v154
    v_mfma_f32_16x16x32_bf16 v[124:127], v[28:31], v[36:39], 0
    v_fmac_f32 v255, v155, v155
    v_fmac_f32 v255, v156, v156
    v_mfma_f32_16x16x32_bf16 v[124:127], v[28:31], v[140:143], v[124:127]
    v_fmac_f32 v255, v157, v157
    v_fmac_f32 v255, v158, v158
    v_mfma_f32_16x16x32_bf16 v[136:139], v[228:231], v[36:39], 0
    v_fmac_f32 v255, v159, v159
    v_fma_f32 v254, v160, v160, s33
    v_mfma_f32_16x16x32_bf16 v[136:139], v[188:191], v[140:143], v[136:139]
    v_exp_f32 v112, v112
    v_mfma_f32_16x16x32_bf16 v[196:199], v[232:235], v[36:39], 0
    v_rcp_f32 v124, v124
    v_mfma_f32_16x16x32_bf16 v[196:199], v[192:195], v[140:143], v[196:199]
    s_waitcnt lgkmcnt(1)
    v_exp_f32 v113, v113
    v_mfma_f32_16x16x32_bf16 v[200:203], v[208:211], v[36:39], 0
    v_cvt_pk_bf16_f32 v112, v112, v113
    v_mul_f32 v136, v124, v136
    v_mfma_f32_16x16x32_bf16 v[200:203], v[220:223], v[140:143], v[200:203]
    v_mul_f32 v137, v124, v137
    v_cvt_pk_bf16_f32 v136, v136, v137
    v_mfma_f32_16x16x32_bf16 v[164:167], v[80:83], v[144:147], v[164:167]
    s_waitcnt lgkmcnt(0)
    v_mul_f32 v138, v124, v138
    v_mul_f32 v139, v124, v139
    v_mfma_f32_16x16x32_bf16 v[168:171], v[104:107], v[144:147], v[168:171]
    v_cvt_pk_bf16_f32 v137, v138, v139
    v_mul_f32 v196, v124, v196
    v_mfma_f32_16x16x32_bf16 v[172:175], a[216:219], v[128:131], 0
    ds_read_b128 v[144:147], v2 offset:15360
    v_mul_f32 v197, v124, v197
    v_mfma_f32_16x16x32_bf16 v[176:179], a[240:243], v[128:131], 0
    v_cvt_pk_bf16_f32 v138, v196, v197
    v_mul_f32 v198, v124, v198
    v_mfma_f32_16x16x32_bf16 v[180:183], v[84:87], v[128:131], 0
    v_mul_f32 v199, v124, v199
    v_cvt_pk_bf16_f32 v139, v198, v199
    v_mfma_f32_16x16x32_bf16 v[172:175], a[220:223], v[120:123], v[172:175]
    ds_read_b128 v[196:199], v2 offset:16384
    v_mul_f32 v200, v124, v200
    v_mfma_f32_16x16x32_bf16 v[176:179], a[244:247], v[120:123], v[176:179]
    ds_write_b128 v3, v[136:139] offset:6144
    v_mfma_f32_16x16x32_bf16 v[180:183], v[88:91], v[120:123], v[180:183]
    v_mul_f32 v201, v124, v201
    v_cvt_pk_bf16_f32 v252, v200, v201
    v_mfma_f32_16x16x32_bf16 v[172:175], a[224:227], v[132:135], v[172:175]
    v_mul_f32 v202, v124, v202
    v_mul_f32 v203, v124, v203
    v_mfma_f32_16x16x32_bf16 v[176:179], a[248:251], v[132:135], v[176:179]
    ds_read_b128 v[124:127], v0 offset:20480
    ds_read_b128 v[128:131], v1 offset:20480
    v_mfma_f32_16x16x32_bf16 v[180:183], v[92:95], v[132:135], v[180:183]
    s_waitcnt lgkmcnt(4)
    ds_read_b128 v[132:135], v0 offset:20608
    ds_read_b128 v[120:123], v2 offset:17408
    v_mfma_f32_16x16x32_bf16 v[172:175], a[228:231], v[144:147], v[172:175]
    ds_read_b128 v[136:139], v1 offset:20608
    v_cvt_pk_bf16_f32 v253, v202, v203
    v_mfma_f32_16x16x32_bf16 v[176:179], a[252:255], v[144:147], v[176:179]
    ds_read_b128 v[140:143], v0 offset:20736
    v_fmac_f32 v254, v161, v161
    v_mfma_f32_16x16x32_bf16 v[180:183], v[96:99], v[144:147], v[180:183]
    s_waitcnt lgkmcnt(7)
    ds_read_b128 v[144:147], v1 offset:20736
    v_fmac_f32 v254, v162, v162
    v_mfma_f32_16x16x32_bf16 v[172:175], a[232:235], v[196:199], v[172:175]
    ds_write_b64 v4, v[252:253] offset:10240
    v_mfma_f32_16x16x32_bf16 v[176:179], v[76:79], v[196:199], v[176:179]
    v_exp_f32 v114, v114
    v_mfma_f32_16x16x32_bf16 v[180:183], v[100:103], v[196:199], v[180:183]
    v_exp_f32 v115, v115
    v_exp_f32 v108, v108
    v_cvt_pk_bf16_f32 v113, v114, v115
    v_exp_f32 v109, v109
    v_exp_f32 v110, v110
    v_cvt_pk_bf16_f32 v114, v108, v109
    v_exp_f32 v111, v111
    v_exp_f32 v184, v184
    v_cvt_pk_bf16_f32 v115, v110, v111
    v_exp_f32 v185, v185
    v_exp_f32 v186, v186
    v_cvt_pk_bf16_f32 v36, v184, v185
    v_exp_f32 v187, v187
    v_exp_f32 v116, v116
    v_cvt_pk_bf16_f32 v37, v186, v187
    v_cvt_pk_bf16_f32 v38, v116, 0
    v_fmac_f32 v254, v163, v163
    v_fmac_f32 v254, v164, v164
    v_mfma_f32_16x16x32_bf16 v[116:119], v[28:31], v[36:39], 0
    s_waitcnt lgkmcnt(0)
    v_fmac_f32 v254, v165, v165
    v_fmac_f32 v254, v166, v166
    v_mfma_f32_16x16x32_bf16 v[116:119], v[28:31], v[112:115], v[116:119]
    v_fmac_f32 v254, v167, v167
    v_fmac_f32 v254, v168, v168
    v_mfma_f32_16x16x32_bf16 v[108:111], v[228:231], v[36:39], 0
    v_fmac_f32 v254, v169, v169
    v_fmac_f32 v254, v170, v170
    v_mfma_f32_16x16x32_bf16 v[108:111], v[188:191], v[112:115], v[108:111]
    v_fmac_f32 v254, v171, v171
    v_cvt_pk_bf16_f32 v252, v255, v254
    v_mfma_f32_16x16x32_bf16 v[184:187], v[232:235], v[36:39], 0
    v_rcp_f32 v116, v116
    v_mfma_f32_16x16x32_bf16 v[184:187], v[192:195], v[112:115], v[184:187]
    v_add_u32 v7, 16, v7
    v_xor_b32 v2, 65536, v2
    v_mfma_f32_16x16x32_bf16 v[188:191], v[208:211], v[36:39], 0
    v_mul_f32 v108, v116, v108
    v_mul_f32 v109, v116, v109
    v_mfma_f32_16x16x32_bf16 v[188:191], v[220:223], v[112:115], v[188:191]
    v_cvt_pk_bf16_f32 v112, v108, v109
    v_mul_f32 v110, v116, v110
    v_mfma_f32_16x16x32_bf16 v[172:175], a[236:239], v[120:123], v[172:175]
    v_mul_f32 v111, v116, v111
    v_cvt_pk_bf16_f32 v113, v110, v111
    v_mfma_f32_16x16x32_bf16 v[176:179], v[80:83], v[120:123], v[176:179]
    v_mul_f32 v184, v116, v184
    v_mul_f32 v185, v116, v185
    v_mfma_f32_16x16x32_bf16 v[180:183], v[104:107], v[120:123], v[180:183]
    v_cvt_pk_bf16_f32 v114, v184, v185
    v_mul_f32 v186, v116, v186
    v_mfma_f32_16x16x32_bf16 v[108:111], a[72:75], v[124:127], 0
    v_mul_f32 v187, v116, v187
    v_cvt_pk_bf16_f32 v115, v186, v187
    v_mfma_f32_16x16x32_bf16 v[108:111], a[76:79], v[128:131], v[108:111]
    ds_write_b128 v3, v[112:115] offset:12288
    v_mfma_f32_16x16x32_bf16 v[108:111], a[80:83], v[132:135], v[108:111]
    v_mul_f32 v188, v116, v188
    v_mul_f32 v189, v116, v189
    v_mfma_f32_16x16x32_bf16 v[108:111], a[84:87], v[136:139], v[108:111]
    v_cvt_pk_bf16_f32 v254, v188, v189
    v_mul_f32 v190, v116, v190
    v_mfma_f32_16x16x32_bf16 v[108:111], a[88:91], v[140:143], v[108:111]
    v_mul_f32 v191, v116, v191
    v_cvt_pk_bf16_f32 v255, v190, v191
    v_mfma_f32_16x16x32_bf16 v[108:111], a[92:95], v[144:147], v[108:111]
    ds_write_b64 v4, v[254:255] offset:16384
    v_mfma_f32_16x16x32_bf16 v[112:115], a[96:99], v[124:127], 0
    v_fma_f32 v255, v172, v172, s33
    v_fmac_f32 v255, v173, v173
    v_mfma_f32_16x16x32_bf16 v[112:115], a[100:103], v[128:131], v[112:115]
    v_fmac_f32 v255, v174, v174
    v_fmac_f32 v255, v175, v175
    v_mfma_f32_16x16x32_bf16 v[112:115], a[104:107], v[132:135], v[112:115]
    v_fmac_f32 v255, v176, v176
    v_fmac_f32 v255, v177, v177
    v_mfma_f32_16x16x32_bf16 v[112:115], a[108:111], v[136:139], v[112:115]
    v_fmac_f32 v255, v178, v178
    v_fmac_f32 v255, v179, v179
    v_mfma_f32_16x16x32_bf16 v[112:115], a[112:115], v[140:143], v[112:115]
    v_fmac_f32 v255, v180, v180
    v_fmac_f32 v255, v181, v181
    v_mfma_f32_16x16x32_bf16 v[112:115], a[116:119], v[144:147], v[112:115]
    v_fmac_f32 v255, v182, v182
    v_fmac_f32 v255, v183, v183
    v_mfma_f32_16x16x32_bf16 v[116:119], a[120:123], v[124:127], 0
    v_cvt_pk_bf16_f32 v253, v255, v255
    v_fma_f32 v255, v108, v108, s32
    v_mfma_f32_16x16x32_bf16 v[116:119], a[124:127], v[128:131], v[116:119]
    ds_write_b64 v4, v[252:253] offset:18432
    v_mfma_f32_16x16x32_bf16 v[116:119], a[128:131], v[132:135], v[116:119]
    v_fmac_f32 v255, v109, v109
    v_fmac_f32 v255, v110, v110
    v_mfma_f32_16x16x32_bf16 v[116:119], a[132:135], v[136:139], v[116:119]
    v_fmac_f32 v255, v111, v111
    v_fmac_f32 v255, v112, v112
    v_mfma_f32_16x16x32_bf16 v[116:119], a[136:139], v[140:143], v[116:119]
    v_fmac_f32 v255, v113, v113
    v_fmac_f32 v255, v114, v114
    v_mfma_f32_16x16x32_bf16 v[116:119], a[140:143], v[144:147], v[116:119]
    v_fmac_f32 v255, v115, v115
    v_xor_b32 v3, 65536, v3
    v_mfma_f32_16x16x32_bf16 v[120:123], a[0:3], v[124:127], 0
    v_xor_b32 v4, 65536, v4
    v_mfma_f32_16x16x32_bf16 v[120:123], a[4:7], v[128:131], v[120:123]
    v_mfma_f32_16x16x32_bf16 v[120:123], a[8:11], v[132:135], v[120:123]
    v_mfma_f32_16x16x32_bf16 v[120:123], a[12:15], v[136:139], v[120:123]
    v_mfma_f32_16x16x32_bf16 v[120:123], a[16:19], v[140:143], v[120:123]
    s_waitcnt lgkmcnt(0)
    v_fmac_f32 v255, v116, v116
    v_fmac_f32 v255, v117, v117
    v_fmac_f32 v255, v118, v118
    v_fmac_f32 v255, v119, v119
    s_barrier
    v_mfma_f32_16x16x32_bf16 v[120:123], a[20:23], v[144:147], v[120:123]
    s_cbranch_scc1 L_loop_fast
    ds_read_b128 v[108:111], v2 offset:18432
    ds_read_b128 v[112:115], v2 offset:19456
    ds_read_b128 v[116:119], v2 offset:0
    s_nop 3
    ds_read_b128 v[120:123], v2 offset:1024
    ds_read_b128 v[124:127], v2 offset:2048
    ds_read_b128 v[128:131], v2 offset:3072
    ds_read_b128 v[132:135], v2 offset:4096
    ds_read_b128 v[136:139], v2 offset:5120
    v_bfe_u32 v255, v2, 4, 6
    v_lshrrev_b32 v254, 4, v255
    v_and_b32 v255, 15, v255
    v_lshlrev_b32 v253, 9, v254
    v_lshl_add_u32 v253, v255, 4, v253
    v_add_u32 v253, 135168, v253
    v_mov_b32 v251, 0
    v_mov_b32 v249, 0
    v_add_u32 v252, 0, v255
    v_mul_u32_u24 v250, s20, v252
    v_add_u32 v250, s38, v250
    v_mul_u32_u24 v248, 911, v250
    v_lshrrev_b32 v248, 16, v248
    v_mul_lo_u32 v248, v248, s22
    v_mul_lo_u32 v250, v252, s21
    v_add3_u32 v248, v250, v248, s37
    v_add_u32 v248, s7, v248
    v_mov_b32 v250, 0x40000000
    v_cmp_gt_u32 vcc, s17, v252
    v_add_u32 v255, 16, v255
    v_mul_u32_u24 v252, s20, v255
    v_cndmask_b32 v248, v250, v248, vcc
    v_lshl_add_u32 v247, v254, 4, v248
    v_lshl_add_u32 v246, v254, 3, v248
    v_add_u32 v252, s38, v252
    v_mul_u32_u24 v250, 911, v252
    v_lshrrev_b32 v250, 16, v250
    v_mul_lo_u32 v250, v250, s22
    v_mul_lo_u32 v252, v255, s21
    v_add3_u32 v250, v252, v250, s37
    v_add_u32 v250, s7, v250
    v_mov_b32 v252, 0x40000000
    v_cmp_gt_u32 vcc, s17, v255
    s_cmp_ge_u32 s18, 2
    s_cselect_b32 s14, s36, 0
    v_cndmask_b32 v250, v252, v250, vcc
    v_lshl_add_u32 v255, v254, 4, v250
    v_lshl_add_u32 v254, v254, 3, v250
    s_lshl_b32 s3, s16, 6
    v_add_u32 v247, s3, v247
    s_lshl_b32 s4, s16, 5
    s_add_u32 s4, s4, 256
    v_add_u32 v246, s4, v246
    s_lshl_b32 s3, s16, 6
    v_add_u32 v255, s3, v255
    s_lshl_b32 s4, s16, 5
    s_add_u32 s4, s4, 256
    v_add_u32 v254, s4, v254
    s_waitcnt lgkmcnt(0)
    v_mfma_f32_16x16x32_bf16 v[140:143], v[32:35], v[108:111], 0
    v_mfma_f32_16x16x32_bf16 v[140:143], v[32:35], v[112:115], v[140:143]
    v_mfma_f32_16x16x32_bf16 v[108:111], a[216:219], v[116:119], 0
    v_mfma_f32_16x16x32_bf16 v[108:111], a[220:223], v[120:123], v[108:111]
    v_mfma_f32_16x16x32_bf16 v[108:111], a[224:227], v[124:127], v[108:111]
    v_mfma_f32_16x16x32_bf16 v[108:111], a[228:231], v[128:131], v[108:111]
    v_mfma_f32_16x16x32_bf16 v[108:111], a[232:235], v[132:135], v[108:111]
    v_mfma_f32_16x16x32_bf16 v[108:111], a[236:239], v[136:139], v[108:111]
    v_mfma_f32_16x16x32_bf16 v[112:115], a[240:243], v[116:119], 0
    v_mfma_f32_16x16x32_bf16 v[112:115], a[244:247], v[120:123], v[112:115]
    v_mul_f32 v252, 0x3baaaaab, v140
    v_mul_f32 v250, 0x3baaaaab, v141
    v_mfma_f32_16x16x32_bf16 v[112:115], a[248:251], v[124:127], v[112:115]
    ds_read_b128 v[144:147], v2 offset:6144
    v_mul_f32 v248, 0x3baaaaab, v142
    v_mfma_f32_16x16x32_bf16 v[112:115], a[252:255], v[128:131], v[112:115]
    ds_read_b128 v[140:143], v2 offset:7168
    v_fma_f32 v245, v108, v108, s33
    v_mfma_f32_16x16x32_bf16 v[112:115], v[76:79], v[132:135], v[112:115]
    ds_read_b128 v[184:187], v2 offset:8192
    v_fmac_f32 v245, v109, v109
    v_mfma_f32_16x16x32_bf16 v[112:115], v[80:83], v[136:139], v[112:115]
    ds_read_b128 v[188:191], v2 offset:9216
    v_fmac_f32 v245, v110, v110
    v_mfma_f32_16x16x32_bf16 v[192:195], v[84:87], v[116:119], 0
    ds_read_b128 v[116:119], v2 offset:10240
    v_fmac_f32 v245, v111, v111
    v_mfma_f32_16x16x32_bf16 v[192:195], v[88:91], v[120:123], v[192:195]
    ds_read_b128 v[120:123], v2 offset:11264
    v_mfma_f32_16x16x32_bf16 v[192:195], v[92:95], v[124:127], v[192:195]
    v_fmac_f32 v245, v112, v112
    v_fmac_f32 v245, v113, v113
    v_mfma_f32_16x16x32_bf16 v[192:195], v[96:99], v[128:131], v[192:195]
    v_fmac_f32 v245, v114, v114
    v_fmac_f32 v245, v115, v115
    v_mfma_f32_16x16x32_bf16 v[192:195], v[100:103], v[132:135], v[192:195]
    v_rsq_f32 v252, v252
    v_mfma_f32_16x16x32_bf16 v[192:195], v[104:107], v[136:139], v[192:195]
    s_waitcnt lgkmcnt(5)
    v_mul_f32 v148, v252, v148
    v_mul_f32 v149, v252, v149
    v_mfma_f32_16x16x32_bf16 v[124:127], a[216:219], v[144:147], 0
    s_waitcnt lgkmcnt(4)
    v_cvt_pk_bf16_f32 v128, v148, v149
    v_mul_f32 v150, v252, v150
    v_mfma_f32_16x16x32_bf16 v[124:127], a[220:223], v[140:143], v[124:127]
    s_waitcnt lgkmcnt(3)
    v_fmac_f32 v245, v192, v192
    v_fmac_f32 v245, v193, v193
    v_mfma_f32_16x16x32_bf16 v[124:127], a[224:227], v[184:187], v[124:127]
    s_waitcnt lgkmcnt(2)
    v_fmac_f32 v245, v194, v194
    v_fmac_f32 v245, v195, v195
    v_mfma_f32_16x16x32_bf16 v[124:127], a[228:231], v[188:191], v[124:127]
    s_waitcnt lgkmcnt(1)
    v_mul_f32 v151, v252, v151
    v_cvt_pk_bf16_f32 v129, v150, v151
    v_mfma_f32_16x16x32_bf16 v[124:127], a[232:235], v[116:119], v[124:127]
    s_waitcnt lgkmcnt(0)
    v_mul_f32 v152, v252, v152
    v_mul_f32 v153, v252, v153
    v_mfma_f32_16x16x32_bf16 v[124:127], a[236:239], v[120:123], v[124:127]
    v_cvt_pk_bf16_f32 v130, v152, v153
    v_mul_f32 v154, v252, v154
    v_mfma_f32_16x16x32_bf16 v[132:135], a[240:243], v[144:147], 0
    v_mul_f32 v155, v252, v155
    v_cvt_pk_bf16_f32 v131, v154, v155
    v_mfma_f32_16x16x32_bf16 v[132:135], a[244:247], v[140:143], v[132:135]
    buffer_store_dwordx4 v[128:131], v15, s[12:15], s27 offen
    v_mul_f32 v156, v252, v156
    v_fma_f32 v244, v124, v124, s33
    v_fmac_f32 v244, v125, v125
    v_fmac_f32 v244, v126, v126
    v_mfma_f32_16x16x32_bf16 v[132:135], a[248:251], v[184:187], v[132:135]
    ds_read_b128 v[128:131], v2 offset:12288
    v_fmac_f32 v244, v127, v127
    v_mfma_f32_16x16x32_bf16 v[132:135], a[252:255], v[188:191], v[132:135]
    ds_read_b128 v[136:139], v2 offset:13312
    v_mul_f32 v157, v252, v157
    v_mfma_f32_16x16x32_bf16 v[132:135], v[76:79], v[116:119], v[132:135]
    ds_read_b128 v[148:151], v2 offset:14336
    v_cvt_pk_bf16_f32 v242, v156, v157
    v_mfma_f32_16x16x32_bf16 v[132:135], v[80:83], v[120:123], v[132:135]
    ds_read_b128 v[152:155], v2 offset:15360
    v_mul_f32 v158, v252, v158
    v_mfma_f32_16x16x32_bf16 v[196:199], v[84:87], v[144:147], 0
    ds_read_b128 v[144:147], v2 offset:16384
    v_mul_f32 v159, v252, v159
    v_mfma_f32_16x16x32_bf16 v[196:199], v[88:91], v[140:143], v[196:199]
    ds_read_b128 v[140:143], v2 offset:17408
    v_xor_b32 v2, 65536, v2
    v_mfma_f32_16x16x32_bf16 v[196:199], v[92:95], v[184:187], v[196:199]
    v_fmac_f32 v244, v132, v132
    v_fmac_f32 v244, v133, v133
    v_mfma_f32_16x16x32_bf16 v[196:199], v[96:99], v[188:191], v[196:199]
    v_fmac_f32 v244, v134, v134
    v_fmac_f32 v244, v135, v135
    v_mfma_f32_16x16x32_bf16 v[196:199], v[100:103], v[116:119], v[196:199]
    v_cvt_pk_bf16_f32 v243, v158, v159
    v_mfma_f32_16x16x32_bf16 v[196:199], v[104:107], v[120:123], v[196:199]
    s_waitcnt lgkmcnt(5)
    buffer_store_dwordx2 v[242:243], v18, s[12:15], s27 offen
    v_rsq_f32 v250, v250
    v_mfma_f32_16x16x32_bf16 v[116:119], a[216:219], v[128:131], 0
    s_waitcnt lgkmcnt(3)
    v_mul_f32 v160, v250, v160
    v_mul_f32 v161, v250, v161
    v_mfma_f32_16x16x32_bf16 v[116:119], a[220:223], v[136:139], v[116:119]
    s_waitcnt lgkmcnt(2)
    v_fmac_f32 v244, v196, v196
    v_fmac_f32 v244, v197, v197
    v_mfma_f32_16x16x32_bf16 v[116:119], a[224:227], v[148:151], v[116:119]
    s_waitcnt lgkmcnt(1)
    v_fmac_f32 v244, v198, v198
    v_fmac_f32 v244, v199, v199
    v_mfma_f32_16x16x32_bf16 v[116:119], a[228:231], v[152:155], v[116:119]
    s_waitcnt lgkmcnt(0)
    v_cvt_pk_bf16_f32 v244, v245, v244
    v_cvt_pk_bf16_f32 v120, v160, v161
    v_mfma_f32_16x16x32_bf16 v[116:119], a[232:235], v[144:147], v[116:119]
    v_mul_f32 v162, v250, v162
    v_mul_f32 v163, v250, v163
    v_mfma_f32_16x16x32_bf16 v[116:119], a[236:239], v[140:143], v[116:119]
    v_cvt_pk_bf16_f32 v121, v162, v163
    v_mul_f32 v164, v250, v164
    v_mfma_f32_16x16x32_bf16 v[156:159], a[240:243], v[128:131], 0
    v_mul_f32 v165, v250, v165
    v_cvt_pk_bf16_f32 v122, v164, v165
    v_mfma_f32_16x16x32_bf16 v[156:159], a[244:247], v[136:139], v[156:159]
    v_mul_f32 v166, v250, v166
    v_mul_f32 v167, v250, v167
    v_mfma_f32_16x16x32_bf16 v[156:159], a[248:251], v[148:151], v[156:159]
    ds_read_b128 v[160:163], v253 offset:0
    v_fma_f32 v252, v116, v116, s33
    v_mfma_f32_16x16x32_bf16 v[156:159], a[252:255], v[152:155], v[156:159]
    ds_read_b128 v[184:187], v253 offset:2048
    v_fmac_f32 v252, v117, v117
    v_mfma_f32_16x16x32_bf16 v[156:159], v[76:79], v[144:147], v[156:159]
    ds_read_b128 v[188:191], v253 offset:4096
    v_fmac_f32 v252, v118, v118
    v_mfma_f32_16x16x32_bf16 v[156:159], v[80:83], v[140:143], v[156:159]
    ds_read_b128 v[200:203], v253 offset:6144
    v_fmac_f32 v252, v119, v119
    v_mfma_f32_16x16x32_bf16 v[204:207], v[84:87], v[128:131], 0
    ds_read_b128 v[128:131], v253 offset:8192
    v_cvt_pk_bf16_f32 v123, v166, v167
    v_mfma_f32_16x16x32_bf16 v[204:207], v[88:91], v[136:139], v[204:207]
    ds_read_b128 v[136:139], v253 offset:10240
    buffer_store_dwordx4 v[120:123], v16, s[12:15], s27 offen
    v_fmac_f32 v252, v156, v156
    v_fmac_f32 v252, v157, v157
    v_fmac_f32 v252, v158, v158
    v_fmac_f32 v252, v159, v159
    v_mfma_f32_16x16x32_bf16 v[204:207], v[92:95], v[148:151], v[204:207]
    v_mul_f32 v168, v250, v168
    v_mul_f32 v169, v250, v169
    v_mfma_f32_16x16x32_bf16 v[204:207], v[96:99], v[152:155], v[204:207]
    v_cvt_pk_bf16_f32 v242, v168, v169
    v_mul_f32 v170, v250, v170
    v_mfma_f32_16x16x32_bf16 v[204:207], v[100:103], v[144:147], v[204:207]
    s_waitcnt lgkmcnt(5)
    v_mul_f32 v171, v250, v171
    v_cvt_pk_bf16_f32 v243, v170, v171
    v_mfma_f32_16x16x32_bf16 v[204:207], v[104:107], v[140:143], v[204:207]
    s_waitcnt lgkmcnt(4)
    buffer_store_dwordx2 v[242:243], v19, s[12:15], s27 offen
    v_rsq_f32 v248, v248
    v_mfma_f32_16x16x32_bf16 v[120:123], a[216:219], v[160:163], 0
    s_waitcnt lgkmcnt(2)
    v_mul_f32 v172, v248, v172
    v_mul_f32 v173, v248, v173
    v_mfma_f32_16x16x32_bf16 v[120:123], a[220:223], v[184:187], v[120:123]
    s_waitcnt lgkmcnt(1)
    v_fmac_f32 v252, v204, v204
    v_fmac_f32 v252, v205, v205
    v_mfma_f32_16x16x32_bf16 v[120:123], a[224:227], v[188:191], v[120:123]
    s_waitcnt lgkmcnt(0)
    v_fmac_f32 v252, v206, v206
    v_fmac_f32 v252, v207, v207
    v_mfma_f32_16x16x32_bf16 v[120:123], a[228:231], v[200:203], v[120:123]
    v_cvt_pk_bf16_f32 v245, v252, v252
    v_cvt_pk_bf16_f32 v140, v172, v173
    v_mfma_f32_16x16x32_bf16 v[120:123], a[232:235], v[128:131], v[120:123]
    ds_write_b64 v4, v[244:245] offset:18432
    v_mfma_f32_16x16x32_bf16 v[120:123], a[236:239], v[136:139], v[120:123]
    v_mul_f32 v174, v248, v174
    v_mul_f32 v175, v248, v175
    v_mfma_f32_16x16x32_bf16 v[144:147], a[240:243], v[160:163], 0
    v_cvt_pk_bf16_f32 v141, v174, v175
    v_mul_f32 v176, v248, v176
    v_mfma_f32_16x16x32_bf16 v[144:147], a[244:247], v[184:187], v[144:147]
    v_mul_f32 v177, v248, v177
    v_cvt_pk_bf16_f32 v142, v176, v177
    v_mfma_f32_16x16x32_bf16 v[144:147], a[248:251], v[188:191], v[144:147]
    ds_read_b128 v[148:151], v253 offset:256
    v_fma_f32 v252, v120, v120, s33
    v_mfma_f32_16x16x32_bf16 v[144:147], a[252:255], v[200:203], v[144:147]
    ds_read_b128 v[152:155], v253 offset:2304
    v_fmac_f32 v252, v121, v121
    v_mfma_f32_16x16x32_bf16 v[144:147], v[76:79], v[128:131], v[144:147]
    ds_read_b128 v[164:167], v253 offset:4352
    v_fmac_f32 v252, v122, v122
    v_mfma_f32_16x16x32_bf16 v[144:147], v[80:83], v[136:139], v[144:147]
    ds_read_b128 v[168:171], v253 offset:6400
    v_fmac_f32 v252, v123, v123
    v_mfma_f32_16x16x32_bf16 v[172:175], v[84:87], v[160:163], 0
    ds_read_b128 v[160:163], v253 offset:8448
    v_mul_f32 v178, v248, v178
    v_mfma_f32_16x16x32_bf16 v[172:175], v[88:91], v[184:187], v[172:175]
    ds_read_b128 v[184:187], v253 offset:10496
    v_mul_f32 v179, v248, v179
    v_mfma_f32_16x16x32_bf16 v[172:175], v[92:95], v[188:191], v[172:175]
    v_fmac_f32 v252, v144, v144
    v_fmac_f32 v252, v145, v145
    v_mfma_f32_16x16x32_bf16 v[172:175], v[96:99], v[200:203], v[172:175]
    v_fmac_f32 v252, v146, v146
    v_fmac_f32 v252, v147, v147
    v_mfma_f32_16x16x32_bf16 v[172:175], v[100:103], v[128:131], v[172:175]
    v_cvt_pk_bf16_f32 v143, v178, v179
    v_mul_f32 v180, v248, v180
    v_mfma_f32_16x16x32_bf16 v[172:175], v[104:107], v[136:139], v[172:175]
    s_waitcnt lgkmcnt(5)
    buffer_store_dwordx4 v[140:143], v17, s[12:15], s27 offen
    v_mul_f32 v181, v248, v181
    v_cvt_pk_bf16_f32 v244, v180, v181
    v_mul_f32 v182, v248, v182
    v_mul_f32 v183, v248, v183
    v_mfma_f32_16x16x32_bf16 v[128:131], a[216:219], v[148:151], 0
    s_waitcnt lgkmcnt(3)
    v_fmac_f32 v252, v172, v172
    v_fmac_f32 v252, v173, v173
    v_mfma_f32_16x16x32_bf16 v[128:131], a[220:223], v[152:155], v[128:131]
    s_waitcnt lgkmcnt(2)
    v_fmac_f32 v252, v174, v174
    v_fmac_f32 v252, v175, v175
    v_mfma_f32_16x16x32_bf16 v[128:131], a[224:227], v[164:167], v[128:131]
    s_waitcnt lgkmcnt(1)
    v_cvt_pk_bf16_f32 v250, v252, v252
    v_cvt_pk_bf16_f32 v245, v182, v183
    v_mfma_f32_16x16x32_bf16 v[128:131], a[228:231], v[168:171], v[128:131]
    s_waitcnt lgkmcnt(0)
    buffer_store_dwordx2 v[244:245], v20, s[12:15], s27 offen
    ds_write_b64 v4, v[250:251] offset:0
    v_mfma_f32_16x16x32_bf16 v[128:131], a[232:235], v[160:163], v[128:131]
    s_mov_b32 s14, s36
    v_mfma_f32_16x16x32_bf16 v[128:131], a[236:239], v[184:187], v[128:131]
    v_mfma_f32_16x16x32_bf16 v[136:139], a[240:243], v[148:151], 0
    v_mfma_f32_16x16x32_bf16 v[136:139], a[244:247], v[152:155], v[136:139]
    v_mfma_f32_16x16x32_bf16 v[136:139], a[248:251], v[164:167], v[136:139]
    v_mfma_f32_16x16x32_bf16 v[136:139], a[252:255], v[168:171], v[136:139]
    v_mfma_f32_16x16x32_bf16 v[136:139], v[76:79], v[160:163], v[136:139]
    v_mfma_f32_16x16x32_bf16 v[136:139], v[80:83], v[184:187], v[136:139]
    v_mfma_f32_16x16x32_bf16 v[140:143], v[84:87], v[148:151], 0
    v_mfma_f32_16x16x32_bf16 v[140:143], v[88:91], v[152:155], v[140:143]
    v_fma_f32 v253, v128, v128, s33
    v_fmac_f32 v253, v129, v129
    v_mfma_f32_16x16x32_bf16 v[140:143], v[92:95], v[164:167], v[140:143]
    v_fmac_f32 v253, v130, v130
    v_fmac_f32 v253, v131, v131
    v_mfma_f32_16x16x32_bf16 v[140:143], v[96:99], v[168:171], v[140:143]
    v_fmac_f32 v253, v136, v136
    v_fmac_f32 v253, v137, v137
    v_mfma_f32_16x16x32_bf16 v[140:143], v[100:103], v[160:163], v[140:143]
    v_fmac_f32 v253, v138, v138
    v_fmac_f32 v253, v139, v139
    v_mfma_f32_16x16x32_bf16 v[140:143], v[104:107], v[184:187], v[140:143]
    s_nop 0
    s_nop 0
    s_nop 0
    s_nop 0
    s_nop 0
    s_nop 0
    s_nop 0
    s_nop 0
    v_fmac_f32 v253, v140, v140
    v_fmac_f32 v253, v141, v141
    v_fmac_f32 v253, v142, v142
    v_fmac_f32 v253, v143, v143
    v_cvt_pk_bf16_f32 v248, v253, v253
    ds_write_b64 v4, v[248:249] offset:2048
    s_waitcnt lgkmcnt(0)
    s_barrier
    ds_read_b128 v[148:151], v2 offset:18432
    ds_read_b128 v[152:155], v2 offset:19456
    ds_read_b128 v[160:163], v2 offset:0
    ds_read_b128 v[164:167], v2 offset:1024
    ds_read_b128 v[168:171], v2 offset:2048
    ds_read_b128 v[176:179], v2 offset:3072
    s_waitcnt lgkmcnt(5)
    v_mfma_f32_16x16x32_bf16 v[180:183], v[32:35], v[148:151], 0
    s_waitcnt lgkmcnt(4)
    v_mfma_f32_16x16x32_bf16 v[180:183], v[32:35], v[152:155], v[180:183]
    s_waitcnt lgkmcnt(0)
    v_mfma_f32_16x16x32_bf16 v[148:151], v[32:35], v[160:163], 0
    v_mfma_f32_16x16x32_bf16 v[148:151], v[32:35], v[164:167], v[148:151]
    v_mfma_f32_16x16x32_bf16 v[152:155], v[32:35], v[168:171], 0
    v_mfma_f32_16x16x32_bf16 v[152:155], v[32:35], v[176:179], v[152:155]
    s_nop 0
    s_nop 0
    s_nop 0
    v_mul_f32 v253, 0x3baaaaab, v180
    v_rsq_f32 v253, v253
    v_mul_f32 v252, 0x3baaaaab, v181
    v_mul_f32 v108, v253, v108
    v_mul_f32 v109, v253, v109
    v_cvt_pk_bf16_f32 v108, v108, v109
    v_mul_f32 v110, v253, v110
    v_mul_f32 v111, v253, v111
    v_cvt_pk_bf16_f32 v109, v110, v111
    v_mul_f32 v112, v253, v112
    v_mul_f32 v113, v253, v113
    v_cvt_pk_bf16_f32 v110, v112, v113
    v_mul_f32 v114, v253, v114
    v_mul_f32 v115, v253, v115
    v_cvt_pk_bf16_f32 v111, v114, v115
    v_mul_f32 v192, v253, v192
    v_mul_f32 v193, v253, v193
    v_cvt_pk_bf16_f32 v250, v192, v193
    v_mul_f32 v194, v253, v194
    v_mul_f32 v195, v253, v195
    v_cvt_pk_bf16_f32 v251, v194, v195
    v_rsq_f32 v252, v252
    v_mul_f32 v253, 0x3baaaaab, v182
    v_mul_f32 v124, v252, v124
    v_mul_f32 v125, v252, v125
    v_cvt_pk_bf16_f32 v112, v124, v125
    v_mul_f32 v126, v252, v126
    v_mul_f32 v127, v252, v127
    v_cvt_pk_bf16_f32 v113, v126, v127
    v_mul_f32 v132, v252, v132
    v_mul_f32 v133, v252, v133
    v_cvt_pk_bf16_f32 v114, v132, v133
    v_mul_f32 v134, v252, v134
    v_mul_f32 v135, v252, v135
    v_cvt_pk_bf16_f32 v115, v134, v135
    v_mul_f32 v196, v252, v196
    v_mul_f32 v197, v252, v197
    v_cvt_pk_bf16_f32 v248, v196, v197
    v_mul_f32 v198, v252, v198
    v_mul_f32 v199, v252, v199
    v_cvt_pk_bf16_f32 v249, v198, v199
    v_rsq_f32 v253, v253
    v_mul_f32 v252, 0x3baaaaab, v148
    v_mul_f32 v116, v253, v116
    v_mul_f32 v117, v253, v117
    v_cvt_pk_bf16_f32 v116, v116, v117
    v_mul_f32 v118, v253, v118
    v_mul_f32 v119, v253, v119
    v_cvt_pk_bf16_f32 v117, v118, v119
    v_mul_f32 v156, v253, v156
    v_mul_f32 v157, v253, v157
    v_cvt_pk_bf16_f32 v118, v156, v157
    v_mul_f32 v158, v253, v158
    v_mul_f32 v159, v253, v159
    v_cvt_pk_bf16_f32 v119, v158, v159
    v_mul_f32 v204, v253, v204
    v_mul_f32 v205, v253, v205
    v_cvt_pk_bf16_f32 v244, v204, v205
    v_mul_f32 v206, v253, v206
    v_mul_f32 v207, v253, v207
    v_cvt_pk_bf16_f32 v245, v206, v207
    v_rsq_f32 v252, v252
    v_mul_f32 v253, 0x3baaaaab, v152
    v_mul_f32 v120, v252, v120
    v_mul_f32 v121, v252, v121
    v_cvt_pk_bf16_f32 v120, v120, v121
    v_mul_f32 v122, v252, v122
    v_mul_f32 v123, v252, v123
    v_cvt_pk_bf16_f32 v121, v122, v123
    v_mul_f32 v144, v252, v144
    v_mul_f32 v145, v252, v145
    v_cvt_pk_bf16_f32 v122, v144, v145
    v_mul_f32 v146, v252, v146
    v_mul_f32 v147, v252, v147
    v_cvt_pk_bf16_f32 v123, v146, v147
    v_mul_f32 v172, v252, v172
    v_mul_f32 v173, v252, v173
    v_cvt_pk_bf16_f32 v242, v172, v173
    v_mul_f32 v174, v252, v174
    v_mul_f32 v175, v252, v175
    v_cvt_pk_bf16_f32 v243, v174, v175
    v_rsq_f32 v253, v253
    buffer_store_dwordx4 v[108:111], v15, s[12:15], s26 offen
    buffer_store_dwordx2 v[250:251], v18, s[12:15], s26 offen
    buffer_store_dwordx4 v[112:115], v16, s[12:15], s26 offen
    buffer_store_dwordx2 v[248:249], v19, s[12:15], s26 offen
    buffer_store_dwordx4 v[116:119], v17, s[12:15], s26 offen
    buffer_store_dwordx2 v[244:245], v20, s[12:15], s26 offen
    buffer_store_dwordx4 v[120:123], v247, s[12:15], 0 offen
    buffer_store_dwordx2 v[242:243], v246, s[12:15], 0 offen
    v_mul_f32 v128, v253, v128
    v_mul_f32 v129, v253, v129
    v_cvt_pk_bf16_f32 v108, v128, v129
    v_mul_f32 v130, v253, v130
    v_mul_f32 v131, v253, v131
    v_cvt_pk_bf16_f32 v109, v130, v131
    v_mul_f32 v136, v253, v136
    v_mul_f32 v137, v253, v137
    v_cvt_pk_bf16_f32 v110, v136, v137
    v_mul_f32 v138, v253, v138
    v_mul_f32 v139, v253, v139
    v_cvt_pk_bf16_f32 v111, v138, v139
    v_mul_f32 v140, v253, v140
    v_mul_f32 v141, v253, v141
    v_cvt_pk_bf16_f32 v252, v140, v141
    v_mul_f32 v142, v253, v142
    v_mul_f32 v143, v253, v143
    v_cvt_pk_bf16_f32 v253, v142, v143
    buffer_store_dwordx4 v[108:111], v255, s[12:15], 0 offen
    buffer_store_dwordx2 v[252:253], v254, s[12:15], 0 offen
    s_endpgm
L_safe:
    v_bfe_u32 v255, v2, 4, 6
    v_lshrrev_b32 v254, 4, v255
    v_and_b32 v253, 15, v255
    v_add_u32 v252, 147456, v0
    v_add_u32 v251, 147456, v1
    v_mov_b32 v108, 0
    v_mov_b32 v109, 0
    v_mov_b32 v110, 0
    v_mov_b32 v111, 0
    v_lshlrev_b32 v250, 4, v254
    v_add_u32 v250, 64000, v250
    v_mul_u32_u24 v249, 320, v253
    v_mul_u32_u24 v248, 80, v254
    v_lshlrev_b32 v247, 8, v253
    v_lshl_add_u32 v247, v254, 4, v247
    v_lshl_add_u32 v246, v254, 10, v6
    v_add_u32 v245, 4096, v246
    v_cmp_gt_u32 vcc, 8, v253
    v_cmp_gt_u32 s[82:83], 16, v255
    v_mov_b32 v113, 0xf149f2ca
    v_mov_b32 v114, 0xf149f2ca
    v_mov_b32 v115, 0xf149f2ca
    v_mov_b32 v149, 0xf149f2ca
    v_mov_b32 v150, 0xf149f2ca
    v_mov_b32 v151, 0xf149f2ca
    s_mul_i32 s3, s16, 7680
    s_add_u32 s3, s3, 104448
    ds_read_b128 v[116:119], v252 offset:0
    ds_read_b128 v[120:123], v251 offset:0
    ds_read_b128 v[124:127], v252 offset:128
    ds_read_b128 v[128:131], v251 offset:128
    ds_read_b128 v[132:135], v252 offset:256
    ds_read_b128 v[136:139], v251 offset:256
    v_add3_u32 v249, v249, v248, s3
    v_add_u32 v253, 5120, v249
    v_cndmask_b32 v253, v250, v253, vcc
    s_mul_i32 s4, s16, 6144
    s_add_u32 s4, s4, 38912
    ds_write_b128 v249, v[108:111] offset:16
    v_add_u32 v247, s4, v247
    v_add_u32 v248, 4096, v247
    v_cndmask_b32 v248, v250, v248, vcc
    v_cmp_gt_u32 vcc, 2, v254
    ds_write_b64 v249, v[108:109] offset:56
    ds_write_b64 v249, v[108:109] offset:64
    v_cndmask_b32 v245, v250, v245, vcc
    s_waitcnt lgkmcnt(4)
    v_mfma_f32_16x16x32_bf16 v[140:143], a[72:75], v[116:119], 0
    s_waitcnt lgkmcnt(3)
    ds_write_b128 v253, v[108:111] offset:16
    v_mfma_f32_16x16x32_bf16 v[140:143], a[76:79], v[120:123], v[140:143]
    v_mfma_f32_16x16x32_bf16 v[140:143], a[80:83], v[124:127], v[140:143]
    v_mfma_f32_16x16x32_bf16 v[140:143], a[84:87], v[128:131], v[140:143]
    ds_write_b64 v253, v[108:109] offset:56
    v_mfma_f32_16x16x32_bf16 v[140:143], a[88:91], v[132:135], v[140:143]
    v_mfma_f32_16x16x32_bf16 v[140:143], a[92:95], v[136:139], v[140:143]
    ds_write_b64 v253, v[108:109] offset:64
    v_mfma_f32_16x16x32_bf16 v[108:111], a[96:99], v[116:119], 0
    v_mfma_f32_16x16x32_bf16 v[108:111], a[100:103], v[120:123], v[108:111]
    v_mfma_f32_16x16x32_bf16 v[108:111], a[104:107], v[124:127], v[108:111]
    v_mfma_f32_16x16x32_bf16 v[108:111], a[108:111], v[128:131], v[108:111]
    v_mfma_f32_16x16x32_bf16 v[108:111], a[112:115], v[132:135], v[108:111]
    v_mfma_f32_16x16x32_bf16 v[108:111], a[116:119], v[136:139], v[108:111]
    v_mfma_f32_16x16x32_bf16 v[144:147], a[120:123], v[116:119], 0
    v_fma_f32 v255, v140, v140, s32
    v_fmac_f32 v255, v141, v141
    v_mfma_f32_16x16x32_bf16 v[144:147], a[124:127], v[120:123], v[144:147]
    v_fmac_f32 v255, v142, v142
    v_fmac_f32 v255, v143, v143
    v_mfma_f32_16x16x32_bf16 v[144:147], a[128:131], v[124:127], v[144:147]
    v_mfma_f32_16x16x32_bf16 v[144:147], a[132:135], v[128:131], v[144:147]
    v_fmac_f32 v255, v108, v108
    v_fmac_f32 v255, v109, v109
    v_mfma_f32_16x16x32_bf16 v[144:147], a[136:139], v[132:135], v[144:147]
    v_fmac_f32 v255, v110, v110
    v_fmac_f32 v255, v111, v111
    v_mfma_f32_16x16x32_bf16 v[144:147], a[140:143], v[136:139], v[144:147]
    v_mfma_f32_16x16x32_bf16 v[152:155], a[0:3], v[116:119], 0
    v_mfma_f32_16x16x32_bf16 v[152:155], a[4:7], v[120:123], v[152:155]
    v_mfma_f32_16x16x32_bf16 v[152:155], a[8:11], v[124:127], v[152:155]
    v_mfma_f32_16x16x32_bf16 v[152:155], a[12:15], v[128:131], v[152:155]
    v_mfma_f32_16x16x32_bf16 v[152:155], a[16:19], v[132:135], v[152:155]
    v_mfma_f32_16x16x32_bf16 v[152:155], a[20:23], v[136:139], v[152:155]
    v_mfma_f32_16x16x32_bf16 v[156:159], a[24:27], v[116:119], 0
    v_mfma_f32_16x16x32_bf16 v[156:159], a[28:31], v[120:123], v[156:159]
    v_fmac_f32 v255, v144, v144
    v_fmac_f32 v255, v145, v145
    v_mfma_f32_16x16x32_bf16 v[156:159], a[32:35], v[124:127], v[156:159]
    v_fmac_f32 v255, v146, v146
    v_fmac_f32 v255, v147, v147
    v_mfma_f32_16x16x32_bf16 v[156:159], a[36:39], v[128:131], v[156:159]
    v_fma_f32 v254, v152, v152, s32
    v_fmac_f32 v254, v153, v153
    v_mfma_f32_16x16x32_bf16 v[156:159], a[40:43], v[132:135], v[156:159]
    v_fmac_f32 v254, v154, v154
    v_fmac_f32 v254, v155, v155
    v_mfma_f32_16x16x32_bf16 v[156:159], a[44:47], v[136:139], v[156:159]
    v_mfma_f32_16x16x32_bf16 v[160:163], a[48:51], v[116:119], 0
    v_mfma_f32_16x16x32_bf16 v[160:163], a[52:55], v[120:123], v[160:163]
    v_mfma_f32_16x16x32_bf16 v[160:163], a[56:59], v[124:127], v[160:163]
    v_mfma_f32_16x16x32_bf16 v[160:163], a[60:63], v[128:131], v[160:163]
    v_mfma_f32_16x16x32_bf16 v[160:163], a[64:67], v[132:135], v[160:163]
    v_mfma_f32_16x16x32_bf16 v[160:163], a[68:71], v[136:139], v[160:163]
    v_mfma_f32_16x16x32_bf16 v[164:167], v[116:119], a[144:147], 0
    v_mfma_f32_16x16x32_bf16 v[164:167], v[120:123], a[148:151], v[164:167]
    v_fmac_f32 v254, v156, v156
    v_fmac_f32 v254, v157, v157
    v_mfma_f32_16x16x32_bf16 v[164:167], v[124:127], a[152:155], v[164:167]
    v_fmac_f32 v254, v158, v158
    v_fmac_f32 v254, v159, v159
    v_mfma_f32_16x16x32_bf16 v[164:167], v[128:131], a[156:159], v[164:167]
    v_fmac_f32 v254, v160, v160
    v_fmac_f32 v254, v161, v161
    v_mfma_f32_16x16x32_bf16 v[164:167], v[132:135], a[160:163], v[164:167]
    v_fmac_f32 v254, v162, v162
    v_fmac_f32 v254, v163, v163
    v_mfma_f32_16x16x32_bf16 v[164:167], v[136:139], a[164:167], v[164:167]
    v_cvt_pk_bf16_f32 v38, v254, v255
    v_mfma_f32_16x16x32_bf16 v[168:171], v[116:119], a[168:171], 0
    v_mfma_f32_16x16x32_bf16 v[168:171], v[120:123], a[172:175], v[168:171]
    v_mfma_f32_16x16x16_bf16 v[172:175], v[32:33], v[38:39], 0
    v_mfma_f32_16x16x32_bf16 v[168:171], v[124:127], a[176:179], v[168:171]
    ds_read_b128 v[176:179], v252 offset:6144
    v_mfma_f32_16x16x32_bf16 v[168:171], v[128:131], a[180:183], v[168:171]
    ds_read_b128 v[180:183], v251 offset:6144
    v_cvt_pk_bf16_f32 v164, v164, v164
    v_mfma_f32_16x16x32_bf16 v[168:171], v[132:135], a[184:187], v[168:171]
    ds_read_b128 v[184:187], v252 offset:6272
    v_cvt_pk_bf16_f32 v165, v165, v165
    v_mfma_f32_16x16x32_bf16 v[168:171], v[136:139], a[188:191], v[168:171]
    ds_read_b128 v[188:191], v251 offset:6272
    v_cvt_pk_bf16_f32 v166, v166, v166
    v_mfma_f32_16x16x32_bf16 v[192:195], v[116:119], a[192:195], 0
    ds_read_b128 v[116:119], v252 offset:6400
    v_cvt_pk_bf16_f32 v167, v167, v167
    v_mfma_f32_16x16x32_bf16 v[192:195], v[120:123], a[196:199], v[192:195]
    ds_read_b128 v[120:123], v251 offset:6400
    v_mfma_f32_16x16x32_bf16 v[192:195], v[124:127], a[200:203], v[192:195]
    ds_write_b32 v246, v164 offset:0
    v_mfma_f32_16x16x32_bf16 v[192:195], v[128:131], a[204:207], v[192:195]
    v_rsq_f32 v173, v173
    v_mfma_f32_16x16x32_bf16 v[192:195], v[132:135], a[208:211], v[192:195]
    ds_write_b32 v246, v165 offset:256
    v_mfma_f32_16x16x32_bf16 v[192:195], v[136:139], a[212:215], v[192:195]
    s_waitcnt lgkmcnt(7)
    v_rsq_f32 v172, v172
    v_mfma_f32_16x16x32_bf16 v[196:199], a[72:75], v[176:179], 0
    s_waitcnt lgkmcnt(6)
    ds_write_b32 v246, v166 offset:512
    v_mfma_f32_16x16x32_bf16 v[196:199], a[76:79], v[180:183], v[196:199]
    s_waitcnt lgkmcnt(6)
    v_mul_f32 v172, s31, v172
    v_mul_f32 v140, v173, v140
    v_mfma_f32_16x16x32_bf16 v[196:199], a[80:83], v[184:187], v[196:199]
    s_waitcnt lgkmcnt(5)
    ds_write_b32 v246, v167 offset:768
    v_mfma_f32_16x16x32_bf16 v[196:199], a[84:87], v[188:191], v[196:199]
    s_waitcnt lgkmcnt(5)
    v_mul_f32 v141, v173, v141
    v_cvt_pk_bf16_f32 v124, v140, v141
    v_mfma_f32_16x16x32_bf16 v[196:199], a[88:91], v[116:119], v[196:199]
    s_waitcnt lgkmcnt(4)
    v_mul_f32 v142, v173, v142
    v_mul_f32 v143, v173, v143
    v_mfma_f32_16x16x32_bf16 v[196:199], a[92:95], v[120:123], v[196:199]
    v_cvt_pk_bf16_f32 v125, v142, v143
    v_mul_f32 v108, v173, v108
    v_mfma_f32_16x16x32_bf16 v[164:167], a[96:99], v[176:179], 0
    v_mul_f32 v109, v173, v109
    v_cvt_pk_bf16_f32 v126, v108, v109
    v_mfma_f32_16x16x32_bf16 v[164:167], a[100:103], v[180:183], v[164:167]
    v_mul_f32 v110, v173, v110
    v_mul_f32 v111, v173, v111
    v_mfma_f32_16x16x32_bf16 v[164:167], a[104:107], v[184:187], v[164:167]
    v_cvt_pk_bf16_f32 v127, v110, v111
    v_mul_f32 v144, v173, v144
    v_mfma_f32_16x16x32_bf16 v[164:167], a[108:111], v[188:191], v[164:167]
    ds_write_b128 v249, v[124:127]
    v_mfma_f32_16x16x32_bf16 v[164:167], a[112:115], v[116:119], v[164:167]
    v_mul_f32 v145, v173, v145
    v_cvt_pk_bf16_f32 v126, v144, v145
    v_mfma_f32_16x16x32_bf16 v[164:167], a[116:119], v[120:123], v[164:167]
    v_mul_f32 v146, v173, v146
    v_mul_f32 v147, v173, v147
    v_mfma_f32_16x16x32_bf16 v[200:203], a[120:123], v[176:179], 0
    v_cvt_pk_bf16_f32 v127, v146, v147
    v_mul_f32 v152, v172, v152
    v_mfma_f32_16x16x32_bf16 v[200:203], a[124:127], v[180:183], v[200:203]
    ds_write_b64 v249, v[126:127] offset:48
    v_mfma_f32_16x16x32_bf16 v[200:203], a[128:131], v[184:187], v[200:203]
    v_mul_f32 v153, v172, v153
    v_cvt_pk_bf16_f32 v124, v152, v153
    v_mfma_f32_16x16x32_bf16 v[200:203], a[132:135], v[188:191], v[200:203]
    v_mul_f32 v154, v172, v154
    v_mul_f32 v155, v172, v155
    v_mfma_f32_16x16x32_bf16 v[200:203], a[136:139], v[116:119], v[200:203]
    v_cvt_pk_bf16_f32 v125, v154, v155
    v_mul_f32 v156, v172, v156
    v_mfma_f32_16x16x32_bf16 v[200:203], a[140:143], v[120:123], v[200:203]
    v_mul_f32 v157, v172, v157
    v_cvt_pk_bf16_f32 v126, v156, v157
    v_mfma_f32_16x16x32_bf16 v[204:207], a[0:3], v[176:179], 0
    v_mul_f32 v158, v172, v158
    v_mul_f32 v159, v172, v159
    v_mfma_f32_16x16x32_bf16 v[204:207], a[4:7], v[180:183], v[204:207]
    v_cvt_pk_bf16_f32 v127, v158, v159
    v_mul_f32 v160, v172, v160
    v_mfma_f32_16x16x32_bf16 v[204:207], a[8:11], v[184:187], v[204:207]
    ds_write_b128 v249, v[124:127] offset:32
    v_mfma_f32_16x16x32_bf16 v[204:207], a[12:15], v[188:191], v[204:207]
    v_mul_f32 v161, v172, v161
    v_cvt_pk_bf16_f32 v124, v160, v161
    v_mfma_f32_16x16x32_bf16 v[204:207], a[16:19], v[116:119], v[204:207]
    v_mul_f32 v162, v172, v162
    v_mul_f32 v163, v172, v163
    v_mfma_f32_16x16x32_bf16 v[204:207], a[20:23], v[120:123], v[204:207]
    v_cvt_pk_bf16_f32 v125, v162, v163
    v_mul_f32 v112, v152, v140
    v_mfma_f32_16x16x32_bf16 v[172:175], a[24:27], v[176:179], 0
    ds_write_b64 v249, v[124:125] offset:72
    v_mfma_f32_16x16x32_bf16 v[172:175], a[28:31], v[180:183], v[172:175]
    v_fmac_f32 v112, v153, v141
    v_fmac_f32 v112, v154, v142
    v_mfma_f32_16x16x32_bf16 v[172:175], a[32:35], v[184:187], v[172:175]
    v_fmac_f32 v112, v155, v143
    v_fmac_f32 v112, v156, v108
    v_mfma_f32_16x16x32_bf16 v[172:175], a[36:39], v[188:191], v[172:175]
    v_fmac_f32 v112, v157, v109
    v_fmac_f32 v112, v158, v110
    v_mfma_f32_16x16x32_bf16 v[172:175], a[40:43], v[116:119], v[172:175]
    v_fmac_f32 v112, v159, v111
    v_fmac_f32 v112, v160, v144
    v_mfma_f32_16x16x32_bf16 v[172:175], a[44:47], v[120:123], v[172:175]
    v_fmac_f32 v112, v161, v145
    v_fmac_f32 v112, v162, v146
    v_mfma_f32_16x16x32_bf16 v[152:155], a[48:51], v[176:179], 0
    v_fmac_f32 v112, v163, v147
    v_mov_b32 v255, v112
    v_mfma_f32_16x16x32_bf16 v[152:155], a[52:55], v[180:183], v[152:155]
    v_cvt_pk_bf16_f32 v168, v168, v168
    v_cvt_pk_bf16_f32 v169, v169, v169
    v_mfma_f32_16x16x32_bf16 v[152:155], a[56:59], v[184:187], v[152:155]
    ds_write_b32 v246, v168 offset:64
    v_mfma_f32_16x16x32_bf16 v[152:155], a[60:63], v[188:191], v[152:155]
    v_permlane32_swap_b32 v112, v255
    v_mfma_f32_16x16x32_bf16 v[152:155], a[64:67], v[116:119], v[152:155]
    ds_write_b32 v246, v169 offset:320
    v_mfma_f32_16x16x32_bf16 v[152:155], a[68:71], v[120:123], v[152:155]
    v_add_f32 v112, v112, v255
    v_mov_b32 v255, v112
    v_mfma_f32_16x16x32_bf16 v[156:159], v[176:179], a[144:147], 0
    v_cvt_pk_bf16_f32 v170, v170, v170
    v_cvt_pk_bf16_f32 v171, v171, v171
    v_mfma_f32_16x16x32_bf16 v[156:159], v[180:183], a[148:151], v[156:159]
    ds_write_b32 v246, v170 offset:576
    v_mfma_f32_16x16x32_bf16 v[156:159], v[184:187], a[152:155], v[156:159]
    v_permlane16_swap_b32 v112, v255
    v_mfma_f32_16x16x32_bf16 v[156:159], v[188:191], a[156:159], v[156:159]
    ds_write_b32 v246, v171 offset:832
    v_mfma_f32_16x16x32_bf16 v[156:159], v[116:119], a[160:163], v[156:159]
    v_add_f32 v112, v112, v255
    v_add_f32 v112, s39, v112
    v_mfma_f32_16x16x32_bf16 v[156:159], v[120:123], a[164:167], v[156:159]
    v_cndmask_b32 v112, v113, v112, s[82:83]
    v_cvt_pk_bf16_f32 v192, v192, v192
    v_mfma_f32_16x16x32_bf16 v[160:163], v[176:179], a[168:171], 0
    ds_write_b32 v246, v192 offset:128
    v_mfma_f32_16x16x32_bf16 v[160:163], v[180:183], a[172:175], v[160:163]
    v_cvt_pk_bf16_f32 v193, v193, v193
    v_cvt_pk_bf16_f32 v194, v194, v194
    v_mfma_f32_16x16x32_bf16 v[160:163], v[184:187], a[176:179], v[160:163]
    ds_read_b128 v[124:127], v0 offset:20480
    v_cvt_pk_bf16_f32 v195, v195, v195
    v_mfma_f32_16x16x32_bf16 v[160:163], v[188:191], a[180:183], v[160:163]
    ds_read_b128 v[128:131], v1 offset:20480
    v_fma_f32 v255, v196, v196, s32
    v_mfma_f32_16x16x32_bf16 v[160:163], v[116:119], a[184:187], v[160:163]
    ds_read_b128 v[132:135], v0 offset:20608
    v_fmac_f32 v255, v197, v197
    v_mfma_f32_16x16x32_bf16 v[160:163], v[120:123], a[188:191], v[160:163]
    ds_read_b128 v[136:139], v1 offset:20608
    v_fmac_f32 v255, v198, v198
    v_mfma_f32_16x16x32_bf16 v[168:171], v[176:179], a[192:195], 0
    ds_read_b128 v[140:143], v0 offset:20736
    v_fmac_f32 v255, v199, v199
    v_mfma_f32_16x16x32_bf16 v[168:171], v[180:183], a[196:199], v[168:171]
    ds_read_b128 v[144:147], v1 offset:20736
    v_fmac_f32 v255, v164, v164
    v_mfma_f32_16x16x32_bf16 v[168:171], v[184:187], a[200:203], v[168:171]
    ds_write_b32 v246, v193 offset:384
    v_mfma_f32_16x16x32_bf16 v[168:171], v[188:191], a[204:207], v[168:171]
    v_fmac_f32 v255, v165, v165
    v_fmac_f32 v255, v166, v166
    v_mfma_f32_16x16x32_bf16 v[168:171], v[116:119], a[208:211], v[168:171]
    ds_write_b32 v246, v194 offset:640
    v_mfma_f32_16x16x32_bf16 v[168:171], v[120:123], a[212:215], v[168:171]
    s_waitcnt lgkmcnt(7)
    v_fmac_f32 v255, v167, v167
    v_fmac_f32 v255, v200, v200
    v_mfma_f32_16x16x32_bf16 v[108:111], a[72:75], v[124:127], 0
    s_waitcnt lgkmcnt(6)
    ds_write_b32 v246, v195 offset:896
    v_mfma_f32_16x16x32_bf16 v[108:111], a[76:79], v[128:131], v[108:111]
    s_waitcnt lgkmcnt(6)
    v_fmac_f32 v255, v201, v201
    v_fmac_f32 v255, v202, v202
    v_mfma_f32_16x16x32_bf16 v[108:111], a[80:83], v[132:135], v[108:111]
    s_waitcnt lgkmcnt(5)
    ds_write_b128 v247, v[112:115] offset:192
    v_mfma_f32_16x16x32_bf16 v[108:111], a[84:87], v[136:139], v[108:111]
    s_waitcnt lgkmcnt(4)
    v_fmac_f32 v255, v203, v203
    v_fma_f32 v254, v204, v204, s32
    v_mfma_f32_16x16x32_bf16 v[108:111], a[88:91], v[140:143], v[108:111]
    v_fmac_f32 v254, v205, v205
    v_fmac_f32 v254, v206, v206
    v_mfma_f32_16x16x32_bf16 v[108:111], a[92:95], v[144:147], v[108:111]
    v_fmac_f32 v254, v207, v207
    v_fmac_f32 v254, v172, v172
    v_mfma_f32_16x16x32_bf16 v[112:115], a[96:99], v[124:127], 0
    v_fmac_f32 v254, v173, v173
    v_fmac_f32 v254, v174, v174
    v_mfma_f32_16x16x32_bf16 v[112:115], a[100:103], v[128:131], v[112:115]
    v_fmac_f32 v254, v175, v175
    v_fmac_f32 v254, v152, v152
    v_mfma_f32_16x16x32_bf16 v[112:115], a[104:107], v[132:135], v[112:115]
    v_fmac_f32 v254, v153, v153
    v_fmac_f32 v254, v154, v154
    v_mfma_f32_16x16x32_bf16 v[112:115], a[108:111], v[136:139], v[112:115]
    v_fmac_f32 v254, v155, v155
    v_cvt_pk_bf16_f32 v38, v254, v255
    v_mfma_f32_16x16x32_bf16 v[112:115], a[112:115], v[140:143], v[112:115]
    v_cvt_pk_bf16_f32 v156, v156, v156
    v_cvt_pk_bf16_f32 v157, v157, v157
    v_mfma_f32_16x16x16_bf16 v[176:179], v[32:33], v[38:39], 0
    ds_write_b32 v245, v156 offset:0
    v_mfma_f32_16x16x32_bf16 v[112:115], a[116:119], v[144:147], v[112:115]
    v_cvt_pk_bf16_f32 v158, v158, v158
    v_cvt_pk_bf16_f32 v159, v159, v159
    v_mfma_f32_16x16x32_bf16 v[116:119], a[120:123], v[124:127], 0
    ds_write_b32 v245, v157 offset:256
    v_mfma_f32_16x16x32_bf16 v[116:119], a[124:127], v[128:131], v[116:119]
    v_cvt_pk_bf16_f32 v160, v160, v160
    v_cvt_pk_bf16_f32 v161, v161, v161
    v_mfma_f32_16x16x32_bf16 v[116:119], a[128:131], v[132:135], v[116:119]
    ds_write_b32 v245, v158 offset:512
    v_mfma_f32_16x16x32_bf16 v[116:119], a[132:135], v[136:139], v[116:119]
    v_rsq_f32 v177, v177
    v_mfma_f32_16x16x32_bf16 v[116:119], a[136:139], v[140:143], v[116:119]
    ds_write_b32 v245, v159 offset:768
    v_mfma_f32_16x16x32_bf16 v[116:119], a[140:143], v[144:147], v[116:119]
    v_rsq_f32 v176, v176
    v_mfma_f32_16x16x32_bf16 v[120:123], a[0:3], v[124:127], 0
    ds_write_b32 v245, v160 offset:64
    v_mfma_f32_16x16x32_bf16 v[120:123], a[4:7], v[128:131], v[120:123]
    v_mul_f32 v176, s31, v176
    v_mul_f32 v196, v177, v196
    v_mfma_f32_16x16x32_bf16 v[120:123], a[8:11], v[132:135], v[120:123]
    ds_write_b32 v245, v161 offset:320
    v_mfma_f32_16x16x32_bf16 v[120:123], a[12:15], v[136:139], v[120:123]
    v_mul_f32 v197, v177, v197
    v_cvt_pk_bf16_f32 v156, v196, v197
    v_mfma_f32_16x16x32_bf16 v[120:123], a[16:19], v[140:143], v[120:123]
    v_mul_f32 v198, v177, v198
    v_mul_f32 v199, v177, v199
    v_mfma_f32_16x16x32_bf16 v[120:123], a[20:23], v[144:147], v[120:123]
    v_cvt_pk_bf16_f32 v157, v198, v199
    v_mul_f32 v164, v177, v164
    v_mul_f32 v165, v177, v165
    v_cvt_pk_bf16_f32 v158, v164, v165
    v_mul_f32 v166, v177, v166
    v_mul_f32 v167, v177, v167
    v_cvt_pk_bf16_f32 v159, v166, v167
    v_mul_f32 v200, v177, v200
    v_mul_f32 v201, v177, v201
    v_cvt_pk_bf16_f32 v182, v200, v201
    v_mul_f32 v202, v177, v202
    v_mul_f32 v203, v177, v203
    v_cvt_pk_bf16_f32 v183, v202, v203
    v_mul_f32 v204, v176, v204
    v_mul_f32 v205, v176, v205
    v_cvt_pk_bf16_f32 v184, v204, v205
    v_mul_f32 v206, v176, v206
    v_mul_f32 v207, v176, v207
    v_cvt_pk_bf16_f32 v185, v206, v207
    v_mul_f32 v172, v176, v172
    v_mul_f32 v173, v176, v173
    v_cvt_pk_bf16_f32 v186, v172, v173
    v_mul_f32 v174, v176, v174
    v_mul_f32 v175, v176, v175
    v_cvt_pk_bf16_f32 v187, v174, v175
    v_mul_f32 v152, v176, v152
    v_mul_f32 v153, v176, v153
    v_cvt_pk_bf16_f32 v180, v152, v153
    v_mul_f32 v154, v176, v154
    v_mul_f32 v155, v176, v155
    v_cvt_pk_bf16_f32 v181, v154, v155
    v_mul_f32 v148, v204, v196
    v_fmac_f32 v148, v205, v197
    v_fmac_f32 v148, v206, v198
    v_fmac_f32 v148, v207, v199
    v_fmac_f32 v148, v172, v164
    v_fmac_f32 v148, v173, v165
    v_fmac_f32 v148, v174, v166
    v_fmac_f32 v148, v175, v167
    v_fmac_f32 v148, v152, v200
    v_fmac_f32 v148, v153, v201
    v_fmac_f32 v148, v154, v202
    v_fmac_f32 v148, v155, v203
    v_mov_b32 v255, v148
    v_cvt_pk_bf16_f32 v162, v162, v162
    v_cvt_pk_bf16_f32 v163, v163, v163
    v_permlane32_swap_b32 v148, v255
    v_add_f32 v148, v148, v255
    v_mov_b32 v255, v148
    v_cvt_pk_bf16_f32 v168, v168, v168
    v_cvt_pk_bf16_f32 v169, v169, v169
    v_permlane16_swap_b32 v148, v255
    v_add_f32 v148, v148, v255
    v_add_f32 v148, s39, v148
    v_cndmask_b32 v148, v149, v148, s[82:83]
    v_cvt_pk_bf16_f32 v170, v170, v170
    v_cvt_pk_bf16_f32 v171, v171, v171
    v_fma_f32 v255, v108, v108, s32
    v_fmac_f32 v255, v109, v109
    v_fmac_f32 v255, v110, v110
    v_fmac_f32 v255, v111, v111
    v_fmac_f32 v255, v112, v112
    v_fmac_f32 v255, v113, v113
    v_fmac_f32 v255, v114, v114
    v_fmac_f32 v255, v115, v115
    v_fmac_f32 v255, v116, v116
    v_fmac_f32 v255, v117, v117
    v_fmac_f32 v255, v118, v118
    v_fmac_f32 v255, v119, v119
    ds_write_b128 v248, v[148:151] offset:192
    ds_write_b128 v253, v[156:159]
    ds_write_b128 v253, v[184:187] offset:32
    ds_write_b64 v253, v[182:183] offset:48
    ds_write_b64 v253, v[180:181] offset:72
    ds_write_b32 v245, v162 offset:576
    ds_write_b32 v245, v163 offset:832
    ds_write_b32 v245, v168 offset:128
    ds_write_b32 v245, v169 offset:384
    ds_write_b32 v245, v170 offset:640
    ds_write_b32 v245, v171 offset:896
.p2align 6
L_loop_safe:
    v_mfma_f32_16x16x32_bf16 v[184:187], a[24:27], v[124:127], 0
    s_cmp_ge_u32 s18, 2
    ds_read_b128 v[188:191], v2 offset:18432
    ds_read_b128 v[192:195], v2 offset:19456
    v_mfma_f32_16x16x32_bf16 v[184:187], a[28:31], v[128:131], v[184:187]
    s_cselect_b32 s14, s36, 0
    v_mfma_f32_16x16x32_bf16 v[184:187], a[32:35], v[132:135], v[184:187]
    v_fma_f32 v254, v120, v120, s32
    v_fmac_f32 v254, v121, v121
    v_mfma_f32_16x16x32_bf16 v[184:187], a[36:39], v[136:139], v[184:187]
    v_fmac_f32 v254, v122, v122
    v_fmac_f32 v254, v123, v123
    v_mfma_f32_16x16x32_bf16 v[184:187], a[40:43], v[140:143], v[184:187]
    v_mfma_f32_16x16x32_bf16 v[184:187], a[44:47], v[144:147], v[184:187]
    v_mfma_f32_16x16x32_bf16 v[196:199], a[48:51], v[124:127], 0
    v_mfma_f32_16x16x32_bf16 v[196:199], a[52:55], v[128:131], v[196:199]
    v_mfma_f32_16x16x32_bf16 v[196:199], a[56:59], v[132:135], v[196:199]
    v_mfma_f32_16x16x32_bf16 v[196:199], a[60:63], v[136:139], v[196:199]
    s_waitcnt lgkmcnt(0)
    v_mfma_f32_16x16x32_bf16 v[200:203], v[32:35], v[188:191], 0
    v_mfma_f32_16x16x32_bf16 v[200:203], v[32:35], v[192:195], v[200:203]
    v_mfma_f32_16x16x32_bf16 v[196:199], a[64:67], v[140:143], v[196:199]
    v_fmac_f32 v254, v184, v184
    v_fmac_f32 v254, v185, v185
    v_mfma_f32_16x16x32_bf16 v[196:199], a[68:71], v[144:147], v[196:199]
    v_fmac_f32 v254, v186, v186
    v_fmac_f32 v254, v187, v187
    v_mfma_f32_16x16x32_bf16 v[188:191], v[124:127], a[144:147], 0
    v_mfma_f32_16x16x32_bf16 v[188:191], v[128:131], a[148:151], v[188:191]
    v_mul_f32 v253, 0x3baaaaab, v200
    v_mul_f32 v252, 0x3baaaaab, v201
    v_mfma_f32_16x16x32_bf16 v[188:191], v[132:135], a[152:155], v[188:191]
    v_rsq_f32 v253, v253
    v_mfma_f32_16x16x32_bf16 v[188:191], v[136:139], a[156:159], v[188:191]
    v_fmac_f32 v254, v196, v196
    v_fmac_f32 v254, v197, v197
    v_mfma_f32_16x16x32_bf16 v[188:191], v[140:143], a[160:163], v[188:191]
    v_fmac_f32 v254, v198, v198
    v_fmac_f32 v254, v199, v199
    v_mfma_f32_16x16x32_bf16 v[188:191], v[144:147], a[164:167], v[188:191]
    v_cvt_pk_bf16_f32 v38, v254, v255
    v_mul_f32 v255, 0x3baaaaab, v202
    v_mfma_f32_16x16x32_bf16 v[192:195], v[124:127], a[168:171], 0
    v_rsq_f32 v252, v252
    v_mfma_f32_16x16x16_bf16 v[200:203], v[32:33], v[38:39], 0
    v_rsq_f32 v255, v255
    v_mfma_f32_16x16x32_bf16 v[192:195], v[128:131], a[172:175], v[192:195]
    v_mul_f32 v148, v253, v148
    v_cvt_pk_bf16_f32 v188, v188, v189
    v_mfma_f32_16x16x32_bf16 v[192:195], v[132:135], a[176:179], v[192:195]
    ds_read_b128 v[204:207], v0 offset:26624
    v_cvt_pk_bf16_f32 v189, v190, v191
    v_mfma_f32_16x16x32_bf16 v[192:195], v[136:139], a[180:183], v[192:195]
    ds_read_b128 v[208:211], v1 offset:26624
    v_mul_f32 v149, v253, v149
    v_mfma_f32_16x16x32_bf16 v[192:195], v[140:143], a[184:187], v[192:195]
    ds_read_b128 v[212:215], v0 offset:26752
    v_cvt_pk_bf16_f32 v148, v148, v149
    v_mfma_f32_16x16x32_bf16 v[192:195], v[144:147], a[188:191], v[192:195]
    ds_read_b128 v[216:219], v1 offset:26752
    v_mul_f32 v150, v253, v150
    v_mfma_f32_16x16x32_bf16 v[220:223], v[124:127], a[192:195], 0
    ds_read_b128 v[124:127], v0 offset:26880
    v_mul_f32 v151, v253, v151
    v_mfma_f32_16x16x32_bf16 v[220:223], v[128:131], a[196:199], v[220:223]
    ds_read_b128 v[128:131], v1 offset:26880
    v_cvt_pk_bf16_f32 v149, v150, v151
    v_mfma_f32_16x16x32_bf16 v[220:223], v[132:135], a[200:203], v[220:223]
    v_rsq_f32 v201, v201
    v_mfma_f32_16x16x32_bf16 v[220:223], v[136:139], a[204:207], v[220:223]
    v_rsq_f32 v200, v200
    v_mfma_f32_16x16x32_bf16 v[220:223], v[140:143], a[208:211], v[220:223]
    v_mul_f32 v200, s31, v200
    v_cvt_pk_bf16_f32 v192, v192, v193
    v_mfma_f32_16x16x32_bf16 v[220:223], v[144:147], a[212:215], v[220:223]
    s_waitcnt lgkmcnt(5)
    v_cvt_pk_bf16_f32 v193, v194, v195
    v_mul_f32 v152, v253, v152
    v_mfma_f32_16x16x32_bf16 v[132:135], a[72:75], v[204:207], 0
    s_waitcnt lgkmcnt(4)
    v_mul_f32 v153, v253, v153
    v_cvt_pk_bf16_f32 v150, v152, v153
    v_mfma_f32_16x16x32_bf16 v[132:135], a[76:79], v[208:211], v[132:135]
    s_waitcnt lgkmcnt(3)
    v_cvt_pk_bf16_f32 v220, v220, v221
    v_cvt_pk_bf16_f32 v221, v222, v223
    v_mfma_f32_16x16x32_bf16 v[132:135], a[80:83], v[212:215], v[132:135]
    s_waitcnt lgkmcnt(2)
    v_mul_f32 v154, v253, v154
    v_mul_f32 v155, v253, v155
    v_mfma_f32_16x16x32_bf16 v[132:135], a[84:87], v[216:219], v[132:135]
    s_waitcnt lgkmcnt(1)
    v_cvt_pk_bf16_f32 v151, v154, v155
    v_mul_f32 v156, v253, v156
    v_mfma_f32_16x16x32_bf16 v[132:135], a[88:91], v[124:127], v[132:135]
    s_waitcnt lgkmcnt(0)
    buffer_store_dwordx4 v[148:151], v15, s[12:15], s27 offen
    v_mul_f32 v157, v253, v157
    v_cvt_pk_bf16_f32 v250, v156, v157
    v_mul_f32 v158, v253, v158
    v_mul_f32 v159, v253, v159
    v_mfma_f32_16x16x32_bf16 v[132:135], a[92:95], v[128:131], v[132:135]
    v_cvt_pk_bf16_f32 v251, v158, v159
    v_mul_f32 v108, v201, v108
    v_mfma_f32_16x16x32_bf16 v[136:139], a[96:99], v[204:207], 0
    buffer_store_dwordx2 v[250:251], v18, s[12:15], s27 offen
    v_mul_f32 v109, v201, v109
    v_cvt_pk_bf16_f32 v108, v108, v109
    v_mfma_f32_16x16x32_bf16 v[136:139], a[100:103], v[208:211], v[136:139]
    v_mul_f32 v110, v201, v110
    v_mul_f32 v111, v201, v111
    v_mfma_f32_16x16x32_bf16 v[136:139], a[104:107], v[212:215], v[136:139]
    v_cvt_pk_bf16_f32 v109, v110, v111
    v_mul_f32 v112, v201, v112
    v_mfma_f32_16x16x32_bf16 v[136:139], a[108:111], v[216:219], v[136:139]
    v_mul_f32 v113, v201, v113
    v_cvt_pk_bf16_f32 v110, v112, v113
    v_mfma_f32_16x16x32_bf16 v[136:139], a[112:115], v[124:127], v[136:139]
    v_mul_f32 v114, v201, v114
    v_mul_f32 v115, v201, v115
    v_mfma_f32_16x16x32_bf16 v[136:139], a[116:119], v[128:131], v[136:139]
    v_cvt_pk_bf16_f32 v111, v114, v115
    v_mul_f32 v116, v201, v116
    v_mfma_f32_16x16x32_bf16 v[112:115], a[120:123], v[204:207], 0
    v_mul_f32 v117, v201, v117
    v_cvt_pk_bf16_f32 v142, v116, v117
    v_mfma_f32_16x16x32_bf16 v[112:115], a[124:127], v[208:211], v[112:115]
    v_mul_f32 v118, v201, v118
    v_mul_f32 v119, v201, v119
    v_mfma_f32_16x16x32_bf16 v[112:115], a[128:131], v[212:215], v[112:115]
    v_cvt_pk_bf16_f32 v143, v118, v119
    v_mul_f32 v120, v200, v120
    v_mfma_f32_16x16x32_bf16 v[112:115], a[132:135], v[216:219], v[112:115]
    v_mul_f32 v121, v200, v121
    v_cvt_pk_bf16_f32 v116, v120, v121
    v_mfma_f32_16x16x32_bf16 v[112:115], a[136:139], v[124:127], v[112:115]
    v_mul_f32 v122, v200, v122
    v_mul_f32 v123, v200, v123
    v_mfma_f32_16x16x32_bf16 v[112:115], a[140:143], v[128:131], v[112:115]
    v_cvt_pk_bf16_f32 v117, v122, v123
    v_mul_f32 v184, v200, v184
    v_mfma_f32_16x16x32_bf16 v[120:123], a[0:3], v[204:207], 0
    v_mul_f32 v185, v200, v185
    v_cvt_pk_bf16_f32 v118, v184, v185
    v_mfma_f32_16x16x32_bf16 v[120:123], a[4:7], v[208:211], v[120:123]
    v_mul_f32 v186, v200, v186
    v_mul_f32 v187, v200, v187
    v_mfma_f32_16x16x32_bf16 v[120:123], a[8:11], v[212:215], v[120:123]
    v_cvt_pk_bf16_f32 v119, v186, v187
    v_mul_f32 v196, v200, v196
    v_mfma_f32_16x16x32_bf16 v[120:123], a[12:15], v[216:219], v[120:123]
    v_mul_f32 v197, v200, v197
    v_cvt_pk_bf16_f32 v140, v196, v197
    v_mfma_f32_16x16x32_bf16 v[120:123], a[16:19], v[124:127], v[120:123]
    v_mul_f32 v198, v200, v198
    v_mul_f32 v199, v200, v199
    v_mfma_f32_16x16x32_bf16 v[120:123], a[20:23], v[128:131], v[120:123]
    v_cvt_pk_bf16_f32 v141, v198, v199
    v_mul_f32 v160, v252, v160
    v_mfma_f32_16x16x32_bf16 v[144:147], a[24:27], v[204:207], 0
    v_mul_f32 v161, v252, v161
    v_cvt_pk_bf16_f32 v148, v160, v161
    v_mfma_f32_16x16x32_bf16 v[144:147], a[28:31], v[208:211], v[144:147]
    v_mul_f32 v162, v252, v162
    v_mul_f32 v163, v252, v163
    v_mfma_f32_16x16x32_bf16 v[144:147], a[32:35], v[212:215], v[144:147]
    v_cvt_pk_bf16_f32 v149, v162, v163
    v_mul_f32 v164, v252, v164
    v_mfma_f32_16x16x32_bf16 v[144:147], a[36:39], v[216:219], v[144:147]
    v_mul_f32 v165, v252, v165
    v_cvt_pk_bf16_f32 v150, v164, v165
    v_mfma_f32_16x16x32_bf16 v[144:147], a[40:43], v[124:127], v[144:147]
    v_mul_f32 v166, v252, v166
    v_mul_f32 v167, v252, v167
    v_mfma_f32_16x16x32_bf16 v[144:147], a[44:47], v[128:131], v[144:147]
    v_cvt_pk_bf16_f32 v151, v166, v167
    v_mul_f32 v168, v252, v168
    v_mfma_f32_16x16x32_bf16 v[152:155], a[48:51], v[204:207], 0
    buffer_store_dwordx4 v[148:151], v16, s[12:15], s27 offen
    v_mul_f32 v169, v252, v169
    v_cvt_pk_bf16_f32 v250, v168, v169
    v_mul_f32 v170, v252, v170
    v_mul_f32 v171, v252, v171
    v_mfma_f32_16x16x32_bf16 v[152:155], a[52:55], v[208:211], v[152:155]
    v_cvt_pk_bf16_f32 v251, v170, v171
    v_fma_f32 v254, v120, v120, s32
    v_mfma_f32_16x16x32_bf16 v[152:155], a[56:59], v[212:215], v[152:155]
    buffer_store_dwordx2 v[250:251], v19, s[12:15], s27 offen
    v_fmac_f32 v254, v121, v121
    v_fmac_f32 v254, v122, v122
    v_mfma_f32_16x16x32_bf16 v[152:155], a[60:63], v[216:219], v[152:155]
    v_fmac_f32 v254, v123, v123
    v_fmac_f32 v254, v144, v144
    v_mfma_f32_16x16x32_bf16 v[152:155], a[64:67], v[124:127], v[152:155]
    v_fmac_f32 v254, v145, v145
    v_fmac_f32 v254, v146, v146
    v_mfma_f32_16x16x32_bf16 v[152:155], a[68:71], v[128:131], v[152:155]
    v_fmac_f32 v254, v147, v147
    v_fma_f32 v253, v132, v132, s32
    v_mfma_f32_16x16x32_bf16 v[148:151], v[204:207], a[144:147], 0
    v_fmac_f32 v253, v133, v133
    v_fmac_f32 v253, v134, v134
    v_mfma_f32_16x16x32_bf16 v[148:151], v[208:211], a[148:151], v[148:151]
    v_fmac_f32 v253, v135, v135
    v_fmac_f32 v253, v136, v136
    v_mfma_f32_16x16x32_bf16 v[148:151], v[212:215], a[152:155], v[148:151]
    v_fmac_f32 v254, v152, v152
    v_fmac_f32 v254, v153, v153
    v_mfma_f32_16x16x32_bf16 v[148:151], v[216:219], a[156:159], v[148:151]
    v_fmac_f32 v254, v154, v154
    v_fmac_f32 v254, v155, v155
    v_mfma_f32_16x16x32_bf16 v[148:151], v[124:127], a[160:163], v[148:151]
    v_fmac_f32 v253, v137, v137
    v_fmac_f32 v253, v138, v138
    v_mfma_f32_16x16x32_bf16 v[148:151], v[128:131], a[164:167], v[148:151]
    v_fmac_f32 v253, v139, v139
    v_fmac_f32 v253, v112, v112
    v_mfma_f32_16x16x32_bf16 v[156:159], v[204:207], a[168:171], 0
    v_fmac_f32 v253, v113, v113
    v_fmac_f32 v253, v114, v114
    v_mfma_f32_16x16x32_bf16 v[156:159], v[208:211], a[172:175], v[156:159]
    v_fmac_f32 v253, v115, v115
    v_cvt_pk_bf16_f32 v38, v254, v253
    v_mfma_f32_16x16x32_bf16 v[156:159], v[212:215], a[176:179], v[156:159]
    ds_read_b128 v[160:163], v0 offset:32768
    v_cvt_pk_bf16_f32 v190, v148, v149
    v_mfma_f32_16x16x16_bf16 v[164:167], v[32:33], v[38:39], 0
    v_cvt_pk_bf16_f32 v191, v150, v151
    v_mul_f32 v172, v255, v172
    v_mfma_f32_16x16x32_bf16 v[156:159], v[216:219], a[180:183], v[156:159]
    ds_read_b128 v[148:151], v1 offset:32768
    v_mul_f32 v173, v255, v173
    v_mfma_f32_16x16x32_bf16 v[156:159], v[124:127], a[184:187], v[156:159]
    ds_read_b128 v[168:171], v0 offset:32896
    v_cvt_pk_bf16_f32 v172, v172, v173
    v_mfma_f32_16x16x32_bf16 v[156:159], v[128:131], a[188:191], v[156:159]
    ds_read_b128 v[184:187], v1 offset:32896
    v_mul_f32 v174, v255, v174
    v_mfma_f32_16x16x32_bf16 v[196:199], v[204:207], a[192:195], 0
    ds_read_b128 v[200:203], v0 offset:33024
    v_mul_f32 v175, v255, v175
    v_mfma_f32_16x16x32_bf16 v[196:199], v[208:211], a[196:199], v[196:199]
    ds_read_b128 v[204:207], v1 offset:33024
    v_cvt_pk_bf16_f32 v173, v174, v175
    v_mfma_f32_16x16x32_bf16 v[196:199], v[212:215], a[200:203], v[196:199]
    v_rsq_f32 v165, v165
    v_mfma_f32_16x16x32_bf16 v[196:199], v[216:219], a[204:207], v[196:199]
    v_rsq_f32 v164, v164
    v_mfma_f32_16x16x32_bf16 v[196:199], v[124:127], a[208:211], v[196:199]
    s_waitcnt lgkmcnt(5)
    v_mul_f32 v164, s31, v164
    v_cvt_pk_bf16_f32 v194, v156, v157
    v_mfma_f32_16x16x32_bf16 v[196:199], v[128:131], a[212:215], v[196:199]
    v_cvt_pk_bf16_f32 v195, v158, v159
    v_mul_f32 v176, v255, v176
    v_mfma_f32_16x16x32_bf16 v[124:127], a[72:75], v[160:163], 0
    s_waitcnt lgkmcnt(4)
    v_mul_f32 v177, v255, v177
    v_cvt_pk_bf16_f32 v174, v176, v177
    v_mfma_f32_16x16x32_bf16 v[124:127], a[76:79], v[148:151], v[124:127]
    s_waitcnt lgkmcnt(3)
    v_cvt_pk_bf16_f32 v222, v196, v197
    v_cvt_pk_bf16_f32 v223, v198, v199
    v_mfma_f32_16x16x32_bf16 v[124:127], a[80:83], v[168:171], v[124:127]
    s_waitcnt lgkmcnt(2)
    v_mul_f32 v178, v255, v178
    v_mul_f32 v179, v255, v179
    v_mfma_f32_16x16x32_bf16 v[124:127], a[84:87], v[184:187], v[124:127]
    s_waitcnt lgkmcnt(1)
    v_cvt_pk_bf16_f32 v175, v178, v179
    v_mul_f32 v180, v255, v180
    v_mfma_f32_16x16x32_bf16 v[124:127], a[88:91], v[200:203], v[124:127]
    s_waitcnt lgkmcnt(0)
    buffer_store_dwordx4 v[172:175], v17, s[12:15], s27 offen
    v_mul_f32 v181, v255, v181
    v_cvt_pk_bf16_f32 v254, v180, v181
    v_mul_f32 v182, v255, v182
    v_mul_f32 v183, v255, v183
    v_mfma_f32_16x16x32_bf16 v[124:127], a[92:95], v[204:207], v[124:127]
    v_cvt_pk_bf16_f32 v255, v182, v183
    v_mul_f32 v132, v165, v132
    v_mfma_f32_16x16x32_bf16 v[128:131], a[96:99], v[160:163], 0
    buffer_store_dwordx2 v[254:255], v20, s[12:15], s27 offen
    v_mul_f32 v133, v165, v133
    v_cvt_pk_bf16_f32 v132, v132, v133
    v_mfma_f32_16x16x32_bf16 v[128:131], a[100:103], v[148:151], v[128:131]
    s_mov_b32 s27, s26
    v_mul_f32 v134, v165, v134
    v_mul_f32 v135, v165, v135
    v_mfma_f32_16x16x32_bf16 v[128:131], a[104:107], v[168:171], v[128:131]
    s_mov_b32 s26, s25
    v_cvt_pk_bf16_f32 v133, v134, v135
    v_mul_f32 v136, v165, v136
    v_mfma_f32_16x16x32_bf16 v[128:131], a[108:111], v[184:187], v[128:131]
    s_mov_b32 s25, s24
    v_mul_f32 v137, v165, v137
    v_cvt_pk_bf16_f32 v134, v136, v137
    v_mfma_f32_16x16x32_bf16 v[128:131], a[112:115], v[200:203], v[128:131]
    s_mov_b32 s24, s23
    v_mul_f32 v138, v165, v138
    v_mul_f32 v139, v165, v139
    v_mfma_f32_16x16x32_bf16 v[128:131], a[116:119], v[204:207], v[128:131]
    v_cvt_pk_bf16_f32 v135, v138, v139
    v_mul_f32 v112, v165, v112
    v_mfma_f32_16x16x32_bf16 v[136:139], a[120:123], v[160:163], 0
    v_mul_f32 v113, v165, v113
    v_cvt_pk_bf16_f32 v178, v112, v113
    v_mfma_f32_16x16x32_bf16 v[136:139], a[124:127], v[148:151], v[136:139]
    v_mul_f32 v114, v165, v114
    v_mul_f32 v115, v165, v115
    v_mfma_f32_16x16x32_bf16 v[136:139], a[128:131], v[168:171], v[136:139]
    v_cvt_pk_bf16_f32 v179, v114, v115
    v_mul_f32 v120, v164, v120
    v_mfma_f32_16x16x32_bf16 v[136:139], a[132:135], v[184:187], v[136:139]
    v_mul_f32 v121, v164, v121
    v_cvt_pk_bf16_f32 v112, v120, v121
    v_mfma_f32_16x16x32_bf16 v[136:139], a[136:139], v[200:203], v[136:139]
    v_mul_f32 v122, v164, v122
    v_mul_f32 v123, v164, v123
    v_mfma_f32_16x16x32_bf16 v[136:139], a[140:143], v[204:207], v[136:139]
    s_waitcnt vmcnt(6)
    v_cvt_pk_bf16_f32 v113, v122, v123
    v_mul_f32 v144, v164, v144
    v_mfma_f32_16x16x32_bf16 v[120:123], a[0:3], v[160:163], 0
    s_barrier
    v_mul_f32 v145, v164, v145
    v_cvt_pk_bf16_f32 v114, v144, v145
    v_mfma_f32_16x16x32_bf16 v[120:123], a[4:7], v[148:151], v[120:123]
    s_add_u32 s34, s18, 2
    v_mul_f32 v146, v164, v146
    v_mul_f32 v147, v164, v147
    v_mfma_f32_16x16x32_bf16 v[120:123], a[8:11], v[168:171], v[120:123]
    s_cmp_lt_u32 s34, s17
    v_cvt_pk_bf16_f32 v115, v146, v147
    v_mul_f32 v152, v164, v152
    v_mfma_f32_16x16x32_bf16 v[120:123], a[12:15], v[184:187], v[120:123]
    s_cselect_b32 s10, s36, 0
    v_mul_f32 v153, v164, v153
    v_cvt_pk_bf16_f32 v176, v152, v153
    v_mfma_f32_16x16x32_bf16 v[120:123], a[16:19], v[200:203], v[120:123]
    s_add_u32 m0, s28, 0
    v_mul_f32 v154, v164, v154
    v_mul_f32 v155, v164, v155
    v_mfma_f32_16x16x32_bf16 v[120:123], a[20:23], v[204:207], v[120:123]
    v_cvt_pk_bf16_f32 v177, v154, v155
    v_fma_f32 v255, v124, v124, s32
    v_mfma_f32_16x16x32_bf16 v[144:147], a[24:27], v[160:163], 0
    buffer_load_dwordx4 v10, s[8:11], s23 offen nt lds
    ds_read_b128 v[152:155], v5 offset:0
    v_mfma_f32_16x16x32_bf16 v[144:147], a[28:31], v[148:151], v[144:147]
    s_add_u32 m0, s28, 1024
    ds_read_b128 v[156:159], v5 offset:16
    ds_read_b128 v[164:167], v5 offset:48
    v_mfma_f32_16x16x32_bf16 v[144:147], a[32:35], v[168:171], v[144:147]
    ds_read_b32 v254, v6 offset:192
    v_fma_f32 v253, v120, v120, s32
    v_mfma_f32_16x16x32_bf16 v[144:147], a[36:39], v[184:187], v[144:147]
    v_fmac_f32 v253, v121, v121
    v_fmac_f32 v253, v122, v122
    v_mfma_f32_16x16x32_bf16 v[144:147], a[40:43], v[200:203], v[144:147]
    v_fmac_f32 v253, v123, v123
    v_fmac_f32 v255, v125, v125
    v_mfma_f32_16x16x32_bf16 v[144:147], a[44:47], v[204:207], v[144:147]
    v_fmac_f32 v255, v126, v126
    v_fmac_f32 v255, v127, v127
    v_mfma_f32_16x16x32_bf16 v[172:175], a[48:51], v[160:163], 0
    v_fmac_f32 v255, v128, v128
    v_fmac_f32 v255, v129, v129
    v_mfma_f32_16x16x32_bf16 v[172:175], a[52:55], v[148:151], v[172:175]
    v_fmac_f32 v255, v130, v130
    v_fmac_f32 v255, v131, v131
    v_mfma_f32_16x16x32_bf16 v[172:175], a[56:59], v[168:171], v[172:175]
    buffer_load_dwordx4 v11, s[8:11], s23 offen nt lds
    v_fmac_f32 v253, v144, v144
    v_mfma_f32_16x16x32_bf16 v[172:175], a[60:63], v[184:187], v[172:175]
    s_waitcnt lgkmcnt(3)
    v_fmac_f32 v253, v145, v145
    v_fmac_f32 v253, v146, v146
    v_mfma_f32_16x16x32_bf16 v[172:175], a[64:67], v[200:203], v[172:175]
    s_add_u32 m0, s28, 2048
    v_fmac_f32 v253, v147, v147
    v_fmac_f32 v255, v136, v136
    v_mfma_f32_16x16x32_bf16 v[172:175], a[68:71], v[204:207], v[172:175]
    s_waitcnt lgkmcnt(0)
    v_fmac_f32 v255, v137, v137
    v_fmac_f32 v255, v138, v138
    v_mfma_f32_16x16x32_bf16 v[180:183], v[160:163], a[144:147], 0
    v_fmac_f32 v255, v139, v139
    v_xor_b32 v0, 65536, v0
    v_mfma_f32_16x16x32_bf16 v[180:183], v[148:151], a[148:151], v[180:183]
    v_xor_b32 v1, 65536, v1
    v_fmac_f32 v253, v172, v172
    v_mfma_f32_16x16x32_bf16 v[180:183], v[168:171], a[152:155], v[180:183]
    v_fmac_f32 v253, v173, v173
    v_fmac_f32 v253, v174, v174
    v_mfma_f32_16x16x32_bf16 v[180:183], v[184:187], a[156:159], v[180:183]
    v_fmac_f32 v253, v175, v175
    v_cvt_pk_bf16_f32 v38, v253, v255
    v_mfma_f32_16x16x32_bf16 v[180:183], v[200:203], a[160:163], v[180:183]
    ds_read_b128 v[196:199], v2 offset:0
    buffer_load_dwordx4 v12, s[8:11], s23 offen nt lds
    v_mfma_f32_16x16x16_bf16 v[208:211], v[32:33], v[38:39], 0
    s_add_u32 m0, s28, 3072
    v_add_u32 v5, 320, v5
    s_xor_b32 s28, s28, 65536
    v_mfma_f32_16x16x32_bf16 v[180:183], v[204:207], a[164:167], v[180:183]
    ds_read_b128 v[212:215], v2 offset:1024
    v_mfma_f32_16x16x32_bf16 v[216:219], v[160:163], a[168:171], 0
    ds_read_b128 v[224:227], v2 offset:2048
    ds_read2_b32 v[230:231], v6 offset0:0 offset1:0
    v_mfma_f32_16x16x32_bf16 v[216:219], v[148:151], a[172:175], v[216:219]
    ds_read2_b32 v[234:235], v6 offset0:16 offset1:16
    ds_read2_b32 v[210:211], v6 offset0:32 offset1:32
    v_mfma_f32_16x16x32_bf16 v[216:219], v[168:171], a[176:179], v[216:219]
    v_cvt_pk_bf16_f32 v228, v180, v181
    v_cvt_pk_bf16_f32 v229, v182, v183
    v_mfma_f32_16x16x32_bf16 v[180:183], v[152:155], v[116:119], v[22:25]
    v_rsq_f32 v209, v209
    v_mfma_f32_16x16x32_bf16 v[180:183], v[156:159], v[108:111], v[180:183]
    v_rsq_f32 v208, v208
    v_mfma_f32_16x16x32_bf16 v[180:183], v[164:167], v[140:143], v[180:183]
    v_mul_f32 v208, s31, v208
    v_mul_f32 v124, v209, v124
    v_mfma_f32_16x16x32_bf16 v[236:239], v[152:155], v[112:115], v[24:27]
    s_waitcnt lgkmcnt(5)
    v_mul_f32 v125, v209, v125
    v_cvt_pk_bf16_f32 v124, v124, v125
    v_mfma_f32_16x16x32_bf16 v[236:239], v[156:159], v[132:135], v[236:239]
    v_mul_f32 v126, v209, v126
    v_mul_f32 v127, v209, v127
    v_mfma_f32_16x16x32_bf16 v[236:239], v[164:167], v[176:179], v[236:239]
    s_waitcnt lgkmcnt(4)
    v_cvt_pk_bf16_f32 v125, v126, v127
    v_mul_f32 v128, v209, v128
    v_mfma_f32_16x16x32_bf16 v[216:219], v[184:187], a[180:183], v[216:219]
    s_waitcnt lgkmcnt(2)
    v_mul_f32 v129, v209, v129
    v_cvt_pk_bf16_f32 v126, v128, v129
    v_mfma_f32_16x16x32_bf16 v[216:219], v[200:203], a[184:187], v[216:219]
    s_waitcnt lgkmcnt(0)
    v_mul_f32 v130, v209, v130
    v_mul_f32 v131, v209, v131
    v_mfma_f32_16x16x32_bf16 v[216:219], v[204:207], a[188:191], v[216:219]
    v_cvt_pk_bf16_f32 v127, v130, v131
    v_mul_f32 v136, v209, v136
    v_mfma_f32_16x16x32_bf16 v[128:131], v[160:163], a[192:195], 0
    buffer_load_dwordx4 v13, s[8:11], s23 offen nt lds
    v_mul_f32 v137, v209, v137
    v_mfma_f32_16x16x32_bf16 v[128:131], v[148:151], a[196:199], v[128:131]
    s_mov_b32 m0, s29
    v_cvt_pk_bf16_f32 v242, v136, v137
    v_cvt_pk_bf16_f32 v232, v216, v217
    v_mfma_f32_16x16x32_bf16 v[160:163], v[108:111], v[116:119], v[40:43]
    s_xor_b32 s29, s29, s30
    v_cvt_pk_bf16_f32 v233, v218, v219
    v_mul_f32 v138, v209, v138
    v_mfma_f32_16x16x32_bf16 v[216:219], v[132:135], v[116:119], v[44:47]
    s_add_u32 s19, s19, s20
    v_mul_f32 v139, v209, v139
    v_cvt_pk_bf16_f32 v243, v138, v139
    v_mfma_f32_16x16x16_bf16 v[160:163], v[142:143], v[140:141], v[160:163]
    v_mul_f32 v120, v208, v120
    v_mul_f32 v121, v208, v121
    v_mfma_f32_16x16x16_bf16 v[216:219], v[178:179], v[140:141], v[216:219]
    v_cvt_pk_bf16_f32 v120, v120, v121
    v_mul_f32 v122, v208, v122
    v_mfma_f32_16x16x32_bf16 v[136:139], v[124:127], v[116:119], v[48:51]
    v_mul_f32 v123, v208, v123
    v_cvt_pk_bf16_f32 v121, v122, v123
    v_mfma_f32_16x16x32_bf16 v[128:131], v[168:171], a[200:203], v[128:131]
    v_mul_f32 v144, v208, v144
    v_mul_f32 v145, v208, v145
    v_mfma_f32_16x16x32_bf16 v[128:131], v[184:187], a[204:207], v[128:131]
    v_cvt_pk_bf16_f32 v122, v144, v145
    v_mul_f32 v146, v208, v146
    v_mfma_f32_16x16x16_bf16 v[136:139], v[242:243], v[140:141], v[136:139]
    v_mul_f32 v147, v208, v147
    v_cvt_pk_bf16_f32 v123, v146, v147
    v_mfma_f32_16x16x32_bf16 v[128:131], v[200:203], a[208:211], v[128:131]
    v_mul_f32 v172, v208, v172
    v_mul_f32 v173, v208, v173
    v_mfma_f32_16x16x32_bf16 v[184:187], v[152:155], v[120:123], v[26:29]
    v_cvt_pk_bf16_f32 v240, v172, v173
    v_mul_f32 v174, v208, v174
    v_mfma_f32_16x16x32_bf16 v[184:187], v[156:159], v[124:127], v[184:187]
    v_mul_f32 v175, v208, v175
    v_cvt_pk_bf16_f32 v241, v174, v175
    v_mfma_f32_16x16x32_bf16 v[128:131], v[204:207], a[212:215], v[128:131]
    v_mov_b32_dpp v254, v181 quad_perm:[0,1,2,3] row_mask:0x1 bank_mask:0xf
    v_mov_b32_dpp v254, v237 quad_perm:[0,1,2,3] row_mask:0x2 bank_mask:0xf
    v_mfma_f32_16x16x32_bf16 v[184:187], v[164:167], v[240:243], v[184:187]
    v_max3_f32 v255, v180, v160, v161
    v_max3_f32 v255, v255, v162, v163
    v_mfma_f32_16x16x32_bf16 v[148:151], a[216:219], v[196:199], 0
    ds_read_b128 v[116:119], v2 offset:3072
    v_max3_f32 v255, v255, v216, v217
    v_mfma_f32_16x16x32_bf16 v[152:155], a[240:243], v[196:199], 0
    v_cvt_pk_bf16_f32 v208, v128, v129
    v_cvt_pk_bf16_f32 v209, v130, v131
    v_mfma_f32_16x16x32_bf16 v[156:159], v[84:87], v[196:199], 0
    v_mov_b32_dpp v254, v185 quad_perm:[0,1,2,3] row_mask:0x4 bank_mask:0xf
    v_mov_b32 v253, v254
    v_mfma_f32_16x16x32_bf16 v[148:151], a[220:223], v[212:215], v[148:151]
    ds_read_b128 v[128:131], v2 offset:4096
    v_max_f32_dpp v253, v253, v253 quad_perm:[1,0,3,2] row_mask:0xf bank_mask:0xf
    v_mfma_f32_16x16x32_bf16 v[152:155], a[244:247], v[212:215], v[152:155]
    buffer_load_dwordx4 v14, s[8:11], s23 offen nt lds
    v_max_f32_dpp v253, v253, v253 quad_perm:[2,3,0,1] row_mask:0xf bank_mask:0xf
    v_mfma_f32_16x16x32_bf16 v[156:159], v[88:91], v[212:215], v[156:159]
    s_add_u32 s23, s23, s21
    v_max_f32_dpp v253, v253, v253 row_half_mirror row_mask:0xf bank_mask:0xf
    v_max3_f32 v255, v255, v218, v219
    v_mfma_f32_16x16x32_bf16 v[148:151], a[224:227], v[224:227], v[148:151]
    s_cmp_ge_u32 s19, 72
    ds_read_b128 v[144:147], v2 offset:5120
    v_max_f32_dpp v253, v253, v253 row_mirror row_mask:0xf bank_mask:0xf
    v_mfma_f32_16x16x32_bf16 v[152:155], a[248:251], v[224:227], v[152:155]
    s_cselect_b32 s34, 72, 0
    v_mov_b32 v252, v253
    v_max3_f32 v255, v255, v136, v137
    v_mfma_f32_16x16x32_bf16 v[156:159], v[92:95], v[224:227], v[156:159]
    s_cselect_b32 s35, s22, 0
    v_permlane32_swap_b32 v253, v252
    v_max_f32 v253, v253, v252
    v_mov_b32 v252, v253
    v_max3_f32 v255, v255, v138, v139
    v_mov_b32 v251, v255
    v_permlane16_swap_b32 v253, v252
    v_max_f32 v253, v253, v252
    v_sub_f32 v254, v254, v253
    v_exp_f32 v254, v254
    v_permlane32_swap_b32 v255, v251
    v_cvt_pk_bf16_f32 v254, v254, v254
    v_max_f32 v255, v255, v251
    v_mov_b32 v251, v255
    v_add_u32 v6, 256, v6
    s_sub_u32 s19, s19, s34
    v_permlane16_swap_b32 v255, v251
    v_max_f32 v255, v255, v251
    v_sub_f32 v160, v160, v255
    v_exp_f32 v160, v160
    v_sub_f32 v161, v161, v255
    v_exp_f32 v161, v161
    v_sub_f32 v162, v162, v255
    v_cvt_pk_bf16_f32 v172, v160, v161
    v_exp_f32 v162, v162
    v_sub_f32 v163, v163, v255
    v_exp_f32 v163, v163
    v_sub_f32 v216, v216, v255
    v_cvt_pk_bf16_f32 v173, v162, v163
    v_mfma_f32_16x16x32_bf16 v[196:199], v[108:111], v[112:115], v[52:55]
    s_waitcnt lgkmcnt(0)
    ds_write_b16 v8, v254
    v_mfma_f32_16x16x32_bf16 v[200:203], v[132:135], v[112:115], v[56:59]
    s_add_u32 s23, s23, s35
    v_exp_f32 v216, v216
    v_mfma_f32_16x16x32_bf16 v[148:151], a[228:231], v[116:119], v[148:151]
    s_add_u32 s18, s18, 1
    ds_read_b128 v[204:207], v2 offset:6144
    v_sub_f32 v217, v217, v255
    v_mfma_f32_16x16x16_bf16 v[196:199], v[142:143], v[176:177], v[196:199]
    s_cmp_lt_u32 s18, s17
    v_exp_f32 v217, v217
    v_mfma_f32_16x16x16_bf16 v[200:203], v[178:179], v[176:177], v[200:203]
    v_cvt_pk_bf16_f32 v174, v216, v217
    v_sub_f32 v218, v218, v255
    v_mfma_f32_16x16x32_bf16 v[152:155], a[252:255], v[116:119], v[152:155]
    v_exp_f32 v218, v218
    v_mfma_f32_16x16x32_bf16 v[156:159], v[96:99], v[116:119], v[156:159]
    v_sub_f32 v219, v219, v255
    v_sub_f32 v136, v136, v255
    v_mfma_f32_16x16x32_bf16 v[148:151], a[232:235], v[128:131], v[148:151]
    ds_read_b128 v[116:119], v2 offset:7168
    v_sub_f32 v137, v137, v255
    v_mfma_f32_16x16x32_bf16 v[152:155], v[76:79], v[128:131], v[152:155]
    v_exp_f32 v219, v219
    v_mfma_f32_16x16x32_bf16 v[156:159], v[100:103], v[128:131], v[156:159]
    v_cvt_pk_bf16_f32 v175, v218, v219
    v_sub_f32 v138, v138, v255
    v_mfma_f32_16x16x32_bf16 v[212:215], v[124:127], v[112:115], v[60:63]
    ds_read_b128 v[112:115], v9
    ds_read_b128 v[128:131], v9 offset:64
    v_mfma_f32_16x16x32_bf16 v[148:151], a[236:239], v[144:147], v[148:151]
    s_waitcnt lgkmcnt(3)
    ds_read_b128 v[216:219], v2 offset:8192
    v_sub_f32 v139, v139, v255
    v_mfma_f32_16x16x16_bf16 v[212:215], v[242:243], v[176:177], v[212:215]
    v_exp_f32 v136, v136
    v_mfma_f32_16x16x32_bf16 v[152:155], v[80:83], v[144:147], v[152:155]
    v_exp_f32 v137, v137
    v_mfma_f32_16x16x32_bf16 v[156:159], v[104:107], v[144:147], v[156:159]
    v_cvt_pk_bf16_f32 v36, v136, v137
    v_sub_f32 v180, v180, v255
    v_mfma_f32_16x16x32_bf16 v[160:163], a[216:219], v[204:207], 0
    ds_read_b128 v[144:147], v2 offset:9216
    v_max3_f32 v255, v236, v196, v197
    v_mfma_f32_16x16x32_bf16 v[164:167], a[240:243], v[204:207], 0
    s_waitcnt lgkmcnt(4)
    v_exp_f32 v138, v138
    v_mfma_f32_16x16x32_bf16 v[168:171], v[84:87], v[204:207], 0
    v_exp_f32 v139, v139
    v_mfma_f32_16x16x32_bf16 v[160:163], a[220:223], v[116:119], v[160:163]
    ds_read_b128 v[204:207], v2 offset:10240
    v_cvt_pk_bf16_f32 v37, v138, v139
    v_mfma_f32_16x16x32_bf16 v[164:167], a[244:247], v[116:119], v[164:167]
    s_waitcnt lgkmcnt(3)
    v_exp_f32 v180, v180
    v_mfma_f32_16x16x32_bf16 v[136:139], v[112:115], v[28:31], 0
    s_waitcnt lgkmcnt(2)
    v_cvt_pk_bf16_f32 v38, v180, 0
    v_max3_f32 v255, v255, v198, v199
    v_mfma_f32_16x16x32_bf16 v[136:139], v[128:131], v[28:31], v[136:139]
    v_max3_f32 v255, v255, v200, v201
    v_max3_f32 v255, v255, v202, v203
    v_mfma_f32_16x16x32_bf16 v[180:183], v[28:31], v[36:39], 0
    v_max3_f32 v255, v255, v212, v213
    v_max3_f32 v255, v255, v214, v215
    v_mfma_f32_16x16x32_bf16 v[180:183], v[28:31], v[172:175], v[180:183]
    v_mov_b32 v254, v255
    v_fma_f32 v253, v148, v148, s33
    v_mfma_f32_16x16x32_bf16 v[224:227], v[228:231], v[36:39], 0
    s_waitcnt lgkmcnt(1)
    v_rcp_f32 v136, v136
    v_mfma_f32_16x16x32_bf16 v[224:227], v[188:191], v[172:175], v[224:227]
    v_permlane32_swap_b32 v255, v254
    v_mfma_f32_16x16x32_bf16 v[244:247], v[232:235], v[36:39], 0
    v_rcp_f32 v180, v180
    v_mfma_f32_16x16x32_bf16 v[244:247], v[192:195], v[172:175], v[244:247]
    s_waitcnt lgkmcnt(0)
    v_max_f32 v255, v255, v254
    v_mov_b32 v254, v255
    v_mfma_f32_16x16x32_bf16 v[248:251], v[208:211], v[36:39], 0
    v_mul_f32 v224, v180, v224
    v_mul_f32 v225, v180, v225
    v_mfma_f32_16x16x32_bf16 v[248:251], v[220:223], v[172:175], v[248:251]
    v_cvt_pk_bf16_f32 v172, v224, v225
    v_mul_f32 v226, v180, v226
    v_mfma_f32_16x16x32_bf16 v[138:141], v[112:115], v[188:191], 0
    v_mul_f32 v227, v180, v227
    v_cvt_pk_bf16_f32 v173, v226, v227
    v_mfma_f32_16x16x32_bf16 v[138:141], v[128:131], v[228:231], v[138:141]
    v_mul_f32 v244, v180, v244
    v_mul_f32 v245, v180, v245
    v_mfma_f32_16x16x32_bf16 v[224:227], v[112:115], v[192:195], 0
    v_cvt_pk_bf16_f32 v174, v244, v245
    v_mul_f32 v246, v180, v246
    v_mfma_f32_16x16x32_bf16 v[224:227], v[128:131], v[232:235], v[224:227]
    v_mul_f32 v247, v180, v247
    v_cvt_pk_bf16_f32 v175, v246, v247
    v_mfma_f32_16x16x32_bf16 v[244:247], v[112:115], v[220:223], 0
    ds_write_b128 v3, v[172:175] offset:0
    v_mfma_f32_16x16x32_bf16 v[244:247], v[128:131], v[208:211], v[244:247]
    v_mul_f32 v138, v138, v136
    v_mul_f32 v248, v180, v248
    v_mfma_f32_16x16x32_bf16 v[168:171], v[88:91], v[116:119], v[168:171]
    v_mul_f32_dpp v138, v224, v136 quad_perm:[0,1,2,3] row_mask:0x2 bank_mask:0xf
    v_mul_f32 v249, v180, v249
    v_mfma_f32_16x16x32_bf16 v[160:163], a[224:227], v[216:219], v[160:163]
    ds_read_b128 v[112:115], v2 offset:11264
    v_cvt_pk_bf16_f32 v248, v248, v249
    v_mfma_f32_16x16x32_bf16 v[164:167], a[248:251], v[216:219], v[164:167]
    v_mul_f32_dpp v138, v244, v136 quad_perm:[0,1,2,3] row_mask:0x4 bank_mask:0xf
    v_cvt_pk_bf16_f32 v138, v138, v138
    v_mfma_f32_16x16x32_bf16 v[168:171], v[92:95], v[216:219], v[168:171]
    ds_write_b16 v7, v138
    v_mfma_f32_16x16x32_bf16 v[160:163], a[228:231], v[144:147], v[160:163]
    v_mul_f32 v250, v180, v250
    v_mul_f32 v251, v180, v251
    v_mfma_f32_16x16x32_bf16 v[164:167], a[252:255], v[144:147], v[164:167]
    ds_read_b128 v[116:119], v2 offset:12288
    v_cvt_pk_bf16_f32 v249, v250, v251
    v_mfma_f32_16x16x32_bf16 v[168:171], v[96:99], v[144:147], v[168:171]
    ds_write_b64 v4, v[248:249] offset:4096
    v_mfma_f32_16x16x32_bf16 v[160:163], a[232:235], v[204:207], v[160:163]
    v_permlane16_swap_b32 v255, v254
    v_mfma_f32_16x16x32_bf16 v[164:167], v[76:79], v[204:207], v[164:167]
    ds_read_b128 v[128:131], v2 offset:13312
    v_max_f32 v255, v255, v254
    v_mfma_f32_16x16x32_bf16 v[168:171], v[100:103], v[204:207], v[168:171]
    s_waitcnt lgkmcnt(4)
    v_sub_f32 v196, v196, v255
    v_sub_f32 v197, v197, v255
    v_mfma_f32_16x16x32_bf16 v[160:163], a[236:239], v[112:115], v[160:163]
    ds_read_b128 v[136:139], v2 offset:14336
    v_sub_f32 v198, v198, v255
    v_mfma_f32_16x16x32_bf16 v[164:167], v[80:83], v[112:115], v[164:167]
    v_exp_f32 v196, v196
    v_mfma_f32_16x16x32_bf16 v[168:171], v[104:107], v[112:115], v[168:171]
    v_exp_f32 v197, v197
    v_exp_f32 v198, v198
    v_cvt_pk_bf16_f32 v112, v196, v197
    v_sub_f32 v199, v199, v255
    v_exp_f32 v199, v199
    v_sub_f32 v200, v200, v255
    v_cvt_pk_bf16_f32 v113, v198, v199
    v_mfma_f32_16x16x32_bf16 v[196:199], v[108:111], v[120:123], v[64:67]
    s_waitcnt lgkmcnt(2)
    v_exp_f32 v200, v200
    v_mfma_f32_16x16x32_bf16 v[204:207], v[132:135], v[120:123], v[68:71]
    v_sub_f32 v201, v201, v255
    v_sub_f32 v202, v202, v255
    v_mfma_f32_16x16x32_bf16 v[172:175], a[216:219], v[116:119], 0
    s_waitcnt lgkmcnt(1)
    ds_read_b128 v[108:111], v2 offset:15360
    v_sub_f32 v203, v203, v255
    v_mfma_f32_16x16x16_bf16 v[196:199], v[142:143], v[240:241], v[196:199]
    v_exp_f32 v201, v201
    v_mfma_f32_16x16x16_bf16 v[204:207], v[178:179], v[240:241], v[204:207]
    s_waitcnt lgkmcnt(1)
    v_cvt_pk_bf16_f32 v114, v200, v201
    v_sub_f32 v212, v212, v255
    v_mfma_f32_16x16x32_bf16 v[176:179], a[240:243], v[116:119], 0
    v_exp_f32 v202, v202
    v_mfma_f32_16x16x32_bf16 v[180:183], v[84:87], v[116:119], 0
    v_exp_f32 v203, v203
    v_mfma_f32_16x16x32_bf16 v[172:175], a[220:223], v[128:131], v[172:175]
    ds_read_b128 v[116:119], v2 offset:16384
    v_cvt_pk_bf16_f32 v115, v202, v203
    v_mfma_f32_16x16x32_bf16 v[200:203], v[124:127], v[120:123], v[72:75]
    v_exp_f32 v212, v212
    v_mfma_f32_16x16x32_bf16 v[176:179], a[244:247], v[128:131], v[176:179]
    v_sub_f32 v213, v213, v255
    v_sub_f32 v214, v214, v255
    v_mfma_f32_16x16x32_bf16 v[180:183], v[88:91], v[128:131], v[180:183]
    v_exp_f32 v213, v213
    v_mfma_f32_16x16x16_bf16 v[200:203], v[242:243], v[240:241], v[200:203]
    s_waitcnt lgkmcnt(1)
    v_cvt_pk_bf16_f32 v36, v212, v213
    v_sub_f32 v215, v215, v255
    v_mfma_f32_16x16x32_bf16 v[172:175], a[224:227], v[136:139], v[172:175]
    ds_read_b128 v[124:127], v0 offset:20480
    ds_read_b128 v[120:123], v2 offset:17408
    v_mfma_f32_16x16x32_bf16 v[176:179], a[248:251], v[136:139], v[176:179]
    ds_read_b128 v[128:131], v1 offset:20480
    v_sub_f32 v236, v236, v255
    v_mfma_f32_16x16x32_bf16 v[180:183], v[92:95], v[136:139], v[180:183]
    ds_read_b128 v[132:135], v0 offset:20608
    v_fmac_f32 v253, v149, v149
    v_mfma_f32_16x16x32_bf16 v[172:175], a[228:231], v[108:111], v[172:175]
    ds_read_b128 v[136:139], v1 offset:20608
    v_fmac_f32 v253, v150, v150
    v_mfma_f32_16x16x32_bf16 v[176:179], a[252:255], v[108:111], v[176:179]
    s_waitcnt lgkmcnt(5)
    ds_read_b128 v[140:143], v0 offset:20736
    v_fmac_f32 v253, v151, v151
    v_mfma_f32_16x16x32_bf16 v[180:183], v[96:99], v[108:111], v[180:183]
    ds_read_b128 v[144:147], v1 offset:20736
    v_fmac_f32 v253, v152, v152
    v_mfma_f32_16x16x32_bf16 v[172:175], a[232:235], v[116:119], v[172:175]
    v_exp_f32 v214, v214
    v_mfma_f32_16x16x32_bf16 v[176:179], v[76:79], v[116:119], v[176:179]
    v_exp_f32 v215, v215
    v_mfma_f32_16x16x32_bf16 v[180:183], v[100:103], v[116:119], v[180:183]
    v_cvt_pk_bf16_f32 v37, v214, v215
    v_exp_f32 v236, v236
    v_fmac_f32 v253, v153, v153
    v_cvt_pk_bf16_f32 v38, v236, 0
    v_fmac_f32 v253, v154, v154
    v_fmac_f32 v253, v155, v155
    v_mfma_f32_16x16x32_bf16 v[116:119], v[28:31], v[36:39], 0
    s_waitcnt lgkmcnt(3)
    v_fmac_f32 v253, v156, v156
    v_fmac_f32 v253, v157, v157
    v_mfma_f32_16x16x32_bf16 v[116:119], v[28:31], v[112:115], v[116:119]
    s_waitcnt lgkmcnt(2)
    v_fmac_f32 v253, v158, v158
    v_fmac_f32 v253, v159, v159
    v_mfma_f32_16x16x32_bf16 v[108:111], v[228:231], v[36:39], 0
    s_waitcnt lgkmcnt(1)
    v_max3_f32 v255, v184, v196, v197
    v_max3_f32 v255, v255, v198, v199
    v_mfma_f32_16x16x32_bf16 v[108:111], v[188:191], v[112:115], v[108:111]
    s_waitcnt lgkmcnt(0)
    v_rcp_f32 v116, v116
    v_mfma_f32_16x16x32_bf16 v[212:215], v[232:235], v[36:39], 0
    v_max3_f32 v255, v255, v204, v205
    v_max3_f32 v255, v255, v206, v207
    v_mfma_f32_16x16x32_bf16 v[212:215], v[192:195], v[112:115], v[212:215]
    v_max3_f32 v255, v255, v200, v201
    v_max3_f32 v255, v255, v202, v203
    v_mfma_f32_16x16x32_bf16 v[216:219], v[208:211], v[36:39], 0
    v_mul_f32 v108, v116, v108
    v_mul_f32 v109, v116, v109
    v_mfma_f32_16x16x32_bf16 v[216:219], v[220:223], v[112:115], v[216:219]
    v_cvt_pk_bf16_f32 v112, v108, v109
    v_mul_f32 v110, v116, v110
    v_mfma_f32_16x16x32_bf16 v[172:175], a[236:239], v[120:123], v[172:175]
    v_mul_f32 v111, v116, v111
    v_cvt_pk_bf16_f32 v113, v110, v111
    v_mfma_f32_16x16x32_bf16 v[176:179], v[80:83], v[120:123], v[176:179]
    v_mul_f32 v212, v116, v212
    v_mul_f32 v213, v116, v213
    v_mfma_f32_16x16x32_bf16 v[180:183], v[104:107], v[120:123], v[180:183]
    v_cvt_pk_bf16_f32 v114, v212, v213
    v_mul_f32 v214, v116, v214
    v_mfma_f32_16x16x32_bf16 v[108:111], a[72:75], v[124:127], 0
    v_mul_f32 v215, v116, v215
    v_cvt_pk_bf16_f32 v115, v214, v215
    v_mfma_f32_16x16x32_bf16 v[108:111], a[76:79], v[128:131], v[108:111]
    ds_write_b128 v3, v[112:115] offset:6144
    v_mfma_f32_16x16x32_bf16 v[108:111], a[80:83], v[132:135], v[108:111]
    v_mul_f32 v216, v116, v216
    v_mul_f32 v217, v116, v217
    v_mfma_f32_16x16x32_bf16 v[108:111], a[84:87], v[136:139], v[108:111]
    v_cvt_pk_bf16_f32 v250, v216, v217
    v_mul_f32 v218, v116, v218
    v_mfma_f32_16x16x32_bf16 v[108:111], a[88:91], v[140:143], v[108:111]
    v_mul_f32 v219, v116, v219
    v_cvt_pk_bf16_f32 v251, v218, v219
    v_mfma_f32_16x16x32_bf16 v[108:111], a[92:95], v[144:147], v[108:111]
    ds_write_b64 v4, v[250:251] offset:10240
    v_mfma_f32_16x16x32_bf16 v[112:115], a[96:99], v[124:127], 0
    v_mov_b32 v254, v255
    v_fma_f32 v252, v160, v160, s33
    v_mfma_f32_16x16x32_bf16 v[112:115], a[100:103], v[128:131], v[112:115]
    v_permlane32_swap_b32 v255, v254
    v_mfma_f32_16x16x32_bf16 v[112:115], a[104:107], v[132:135], v[112:115]
    v_max_f32 v255, v255, v254
    v_mov_b32 v254, v255
    v_mfma_f32_16x16x32_bf16 v[112:115], a[108:111], v[136:139], v[112:115]
    v_fmac_f32 v252, v161, v161
    v_fmac_f32 v252, v162, v162
    v_mfma_f32_16x16x32_bf16 v[112:115], a[112:115], v[140:143], v[112:115]
    v_permlane16_swap_b32 v255, v254
    v_mfma_f32_16x16x32_bf16 v[112:115], a[116:119], v[144:147], v[112:115]
    v_max_f32 v255, v255, v254
    v_sub_f32 v196, v196, v255
    v_mfma_f32_16x16x32_bf16 v[116:119], a[120:123], v[124:127], 0
    v_exp_f32 v196, v196
    v_mfma_f32_16x16x32_bf16 v[116:119], a[124:127], v[128:131], v[116:119]
    v_sub_f32 v197, v197, v255
    v_sub_f32 v198, v198, v255
    v_mfma_f32_16x16x32_bf16 v[116:119], a[128:131], v[132:135], v[116:119]
    v_exp_f32 v197, v197
    v_mfma_f32_16x16x32_bf16 v[116:119], a[132:135], v[136:139], v[116:119]
    v_cvt_pk_bf16_f32 v196, v196, v197
    v_sub_f32 v199, v199, v255
    v_mfma_f32_16x16x32_bf16 v[116:119], a[136:139], v[140:143], v[116:119]
    v_exp_f32 v198, v198
    v_mfma_f32_16x16x32_bf16 v[116:119], a[140:143], v[144:147], v[116:119]
    v_exp_f32 v199, v199
    v_mfma_f32_16x16x32_bf16 v[120:123], a[0:3], v[124:127], 0
    v_cvt_pk_bf16_f32 v197, v198, v199
    v_sub_f32 v204, v204, v255
    v_mfma_f32_16x16x32_bf16 v[120:123], a[4:7], v[128:131], v[120:123]
    v_exp_f32 v204, v204
    v_mfma_f32_16x16x32_bf16 v[120:123], a[8:11], v[132:135], v[120:123]
    v_sub_f32 v205, v205, v255
    v_sub_f32 v206, v206, v255
    v_mfma_f32_16x16x32_bf16 v[120:123], a[12:15], v[136:139], v[120:123]
    v_exp_f32 v205, v205
    v_mfma_f32_16x16x32_bf16 v[120:123], a[16:19], v[140:143], v[120:123]
    v_cvt_pk_bf16_f32 v198, v204, v205
    v_exp_f32 v206, v206
    v_sub_f32 v207, v207, v255
    v_exp_f32 v207, v207
    v_sub_f32 v200, v200, v255
    v_cvt_pk_bf16_f32 v199, v206, v207
    v_exp_f32 v200, v200
    v_sub_f32 v201, v201, v255
    v_exp_f32 v201, v201
    v_sub_f32 v202, v202, v255
    v_cvt_pk_bf16_f32 v36, v200, v201
    v_exp_f32 v202, v202
    v_sub_f32 v203, v203, v255
    v_exp_f32 v203, v203
    v_sub_f32 v184, v184, v255
    v_cvt_pk_bf16_f32 v37, v202, v203
    v_exp_f32 v184, v184
    v_fmac_f32 v252, v163, v163
    v_cvt_pk_bf16_f32 v38, v184, 0
    v_fmac_f32 v252, v164, v164
    v_fmac_f32 v252, v165, v165
    v_mfma_f32_16x16x32_bf16 v[184:187], v[28:31], v[36:39], 0
    v_fmac_f32 v252, v166, v166
    v_fmac_f32 v252, v167, v167
    v_mfma_f32_16x16x32_bf16 v[184:187], v[28:31], v[196:199], v[184:187]
    v_fmac_f32 v252, v168, v168
    v_fmac_f32 v252, v169, v169
    v_mfma_f32_16x16x32_bf16 v[200:203], v[228:231], v[36:39], 0
    v_fmac_f32 v252, v170, v170
    v_fmac_f32 v252, v171, v171
    v_mfma_f32_16x16x32_bf16 v[200:203], v[188:191], v[196:199], v[200:203]
    v_fma_f32 v255, v172, v172, s33
    v_fmac_f32 v255, v173, v173
    v_mfma_f32_16x16x32_bf16 v[188:191], v[232:235], v[36:39], 0
    v_rcp_f32 v184, v184
    v_mfma_f32_16x16x32_bf16 v[188:191], v[192:195], v[196:199], v[188:191]
    v_fmac_f32 v255, v174, v174
    v_fmac_f32 v255, v175, v175
    v_mfma_f32_16x16x32_bf16 v[192:195], v[208:211], v[36:39], 0
    v_mul_f32 v200, v184, v200
    v_mul_f32 v201, v184, v201
    v_mfma_f32_16x16x32_bf16 v[192:195], v[220:223], v[196:199], v[192:195]
    v_cvt_pk_bf16_f32 v196, v200, v201
    v_mul_f32 v202, v184, v202
    v_mul_f32 v203, v184, v203
    v_cvt_pk_bf16_f32 v197, v202, v203
    v_mul_f32 v188, v184, v188
    v_mul_f32 v189, v184, v189
    v_cvt_pk_bf16_f32 v198, v188, v189
    v_mul_f32 v190, v184, v190
    v_mul_f32 v191, v184, v191
    v_cvt_pk_bf16_f32 v199, v190, v191
    v_mul_f32 v192, v184, v192
    v_mul_f32 v193, v184, v193
    v_cvt_pk_bf16_f32 v250, v192, v193
    v_mul_f32 v194, v184, v194
    v_mul_f32 v195, v184, v195
    v_cvt_pk_bf16_f32 v251, v194, v195
    v_fmac_f32 v255, v176, v176
    v_fmac_f32 v255, v177, v177
    v_fmac_f32 v255, v178, v178
    v_fmac_f32 v255, v179, v179
    v_fmac_f32 v255, v180, v180
    v_fmac_f32 v255, v181, v181
    v_fmac_f32 v255, v182, v182
    v_fmac_f32 v255, v183, v183
    v_cvt_pk_bf16_f32 v252, v253, v252
    v_cvt_pk_bf16_f32 v253, v255, v255
    v_fma_f32 v255, v108, v108, s32
    v_fmac_f32 v255, v109, v109
    v_fmac_f32 v255, v110, v110
    v_fmac_f32 v255, v111, v111
    v_fmac_f32 v255, v112, v112
    v_fmac_f32 v255, v113, v113
    v_fmac_f32 v255, v114, v114
    v_fmac_f32 v255, v115, v115
    v_fmac_f32 v255, v116, v116
    v_fmac_f32 v255, v117, v117
    v_fmac_f32 v255, v118, v118
    v_fmac_f32 v255, v119, v119
    v_add_u32 v7, 16, v7
    v_xor_b32 v2, 65536, v2
    ds_write_b128 v3, v[196:199] offset:12288
    v_xor_b32 v3, 65536, v3
    ds_write_b64 v4, v[250:251] offset:16384
    ds_write_b64 v4, v[252:253] offset:18432
    v_xor_b32 v4, 65536, v4
    s_waitcnt lgkmcnt(0)
    s_barrier
    v_mfma_f32_16x16x32_bf16 v[120:123], a[20:23], v[144:147], v[120:123]
    s_cbranch_scc1 L_loop_safe
    ds_read_b128 v[108:111], v2 offset:18432
    ds_read_b128 v[112:115], v2 offset:19456
    ds_read_b128 v[116:119], v2 offset:0
    s_nop 3
    ds_read_b128 v[120:123], v2 offset:1024
    ds_read_b128 v[124:127], v2 offset:2048
    ds_read_b128 v[128:131], v2 offset:3072
    ds_read_b128 v[132:135], v2 offset:4096
    ds_read_b128 v[136:139], v2 offset:5120
    v_bfe_u32 v255, v2, 4, 6
    v_lshrrev_b32 v254, 4, v255
    v_and_b32 v255, 15, v255
    v_lshlrev_b32 v253, 9, v254
    v_lshl_add_u32 v253, v255, 4, v253
    v_add_u32 v253, 135168, v253
    v_mov_b32 v251, 0
    v_mov_b32 v249, 0
    v_add_u32 v252, 0, v255
    v_mul_u32_u24 v250, s20, v252
    v_add_u32 v250, s38, v250
    v_mul_u32_u24 v248, 911, v250
    v_lshrrev_b32 v248, 16, v248
    v_mul_lo_u32 v248, v248, s22
    v_mul_lo_u32 v250, v252, s21
    v_add3_u32 v248, v250, v248, s37
    v_add_u32 v248, s7, v248
    v_mov_b32 v250, 0x40000000
    v_cmp_gt_u32 vcc, s17, v252
    v_add_u32 v255, 16, v255
    v_mul_u32_u24 v252, s20, v255
    v_cndmask_b32 v248, v250, v248, vcc
    v_lshl_add_u32 v247, v254, 4, v248
    v_lshl_add_u32 v246, v254, 3, v248
    v_add_u32 v252, s38, v252
    v_mul_u32_u24 v250, 911, v252
    v_lshrrev_b32 v250, 16, v250
    v_mul_lo_u32 v250, v250, s22
    v_mul_lo_u32 v252, v255, s21
    v_add3_u32 v250, v252, v250, s37
    v_add_u32 v250, s7, v250
    v_mov_b32 v252, 0x40000000
    v_cmp_gt_u32 vcc, s17, v255
    s_cmp_ge_u32 s18, 2
    s_cselect_b32 s14, s36, 0
    v_cndmask_b32 v250, v252, v250, vcc
    v_lshl_add_u32 v255, v254, 4, v250
    v_lshl_add_u32 v254, v254, 3, v250
    s_lshl_b32 s3, s16, 6
    v_add_u32 v247, s3, v247
    s_lshl_b32 s4, s16, 5
    s_add_u32 s4, s4, 256
    v_add_u32 v246, s4, v246
    s_lshl_b32 s3, s16, 6
    v_add_u32 v255, s3, v255
    s_lshl_b32 s4, s16, 5
    s_add_u32 s4, s4, 256
    v_add_u32 v254, s4, v254
    s_waitcnt lgkmcnt(0)
    v_mfma_f32_16x16x32_bf16 v[140:143], v[32:35], v[108:111], 0
    v_mfma_f32_16x16x32_bf16 v[140:143], v[32:35], v[112:115], v[140:143]
    v_mfma_f32_16x16x32_bf16 v[108:111], a[216:219], v[116:119], 0
    v_mfma_f32_16x16x32_bf16 v[108:111], a[220:223], v[120:123], v[108:111]
    v_mfma_f32_16x16x32_bf16 v[108:111], a[224:227], v[124:127], v[108:111]
    v_mfma_f32_16x16x32_bf16 v[108:111], a[228:231], v[128:131], v[108:111]
    v_mfma_f32_16x16x32_bf16 v[108:111], a[232:235], v[132:135], v[108:111]
    v_mfma_f32_16x16x32_bf16 v[108:111], a[236:239], v[136:139], v[108:111]
    v_mfma_f32_16x16x32_bf16 v[112:115], a[240:243], v[116:119], 0
    v_mfma_f32_16x16x32_bf16 v[112:115], a[244:247], v[120:123], v[112:115]
    v_mul_f32 v252, 0x3baaaaab, v140
    v_mul_f32 v250, 0x3baaaaab, v141
    v_mfma_f32_16x16x32_bf16 v[112:115], a[248:251], v[124:127], v[112:115]
    ds_read_b128 v[144:147], v2 offset:6144
    v_mul_f32 v248, 0x3baaaaab, v142
    v_mfma_f32_16x16x32_bf16 v[112:115], a[252:255], v[128:131], v[112:115]
    ds_read_b128 v[140:143], v2 offset:7168
    v_fma_f32 v245, v108, v108, s33
    v_mfma_f32_16x16x32_bf16 v[112:115], v[76:79], v[132:135], v[112:115]
    ds_read_b128 v[184:187], v2 offset:8192
    v_fmac_f32 v245, v109, v109
    v_mfma_f32_16x16x32_bf16 v[112:115], v[80:83], v[136:139], v[112:115]
    ds_read_b128 v[188:191], v2 offset:9216
    v_fmac_f32 v245, v110, v110
    v_mfma_f32_16x16x32_bf16 v[192:195], v[84:87], v[116:119], 0
    ds_read_b128 v[116:119], v2 offset:10240
    v_fmac_f32 v245, v111, v111
    v_mfma_f32_16x16x32_bf16 v[192:195], v[88:91], v[120:123], v[192:195]
    ds_read_b128 v[120:123], v2 offset:11264
    v_mfma_f32_16x16x32_bf16 v[192:195], v[92:95], v[124:127], v[192:195]
    v_fmac_f32 v245, v112, v112
    v_fmac_f32 v245, v113, v113
    v_mfma_f32_16x16x32_bf16 v[192:195], v[96:99], v[128:131], v[192:195]
    v_fmac_f32 v245, v114, v114
    v_fmac_f32 v245, v115, v115
    v_mfma_f32_16x16x32_bf16 v[192:195], v[100:103], v[132:135], v[192:195]
    v_rsq_f32 v252, v252
    v_mfma_f32_16x16x32_bf16 v[192:195], v[104:107], v[136:139], v[192:195]
    s_waitcnt lgkmcnt(5)
    v_mul_f32 v148, v252, v148
    v_mul_f32 v149, v252, v149
    v_mfma_f32_16x16x32_bf16 v[124:127], a[216:219], v[144:147], 0
    s_waitcnt lgkmcnt(4)
    v_cvt_pk_bf16_f32 v128, v148, v149
    v_mul_f32 v150, v252, v150
    v_mfma_f32_16x16x32_bf16 v[124:127], a[220:223], v[140:143], v[124:127]
    s_waitcnt lgkmcnt(3)
    v_fmac_f32 v245, v192, v192
    v_fmac_f32 v245, v193, v193
    v_mfma_f32_16x16x32_bf16 v[124:127], a[224:227], v[184:187], v[124:127]
    s_waitcnt lgkmcnt(2)
    v_fmac_f32 v245, v194, v194
    v_fmac_f32 v245, v195, v195
    v_mfma_f32_16x16x32_bf16 v[124:127], a[228:231], v[188:191], v[124:127]
    s_waitcnt lgkmcnt(1)
    v_mul_f32 v151, v252, v151
    v_cvt_pk_bf16_f32 v129, v150, v151
    v_mfma_f32_16x16x32_bf16 v[124:127], a[232:235], v[116:119], v[124:127]
    s_waitcnt lgkmcnt(0)
    v_mul_f32 v152, v252, v152
    v_mul_f32 v153, v252, v153
    v_mfma_f32_16x16x32_bf16 v[124:127], a[236:239], v[120:123], v[124:127]
    v_cvt_pk_bf16_f32 v130, v152, v153
    v_mul_f32 v154, v252, v154
    v_mfma_f32_16x16x32_bf16 v[132:135], a[240:243], v[144:147], 0
    v_mul_f32 v155, v252, v155
    v_cvt_pk_bf16_f32 v131, v154, v155
    v_mfma_f32_16x16x32_bf16 v[132:135], a[244:247], v[140:143], v[132:135]
    buffer_store_dwordx4 v[128:131], v15, s[12:15], s27 offen
    v_mul_f32 v156, v252, v156
    v_fma_f32 v244, v124, v124, s33
    v_fmac_f32 v244, v125, v125
    v_fmac_f32 v244, v126, v126
    v_mfma_f32_16x16x32_bf16 v[132:135], a[248:251], v[184:187], v[132:135]
    ds_read_b128 v[128:131], v2 offset:12288
    v_fmac_f32 v244, v127, v127
    v_mfma_f32_16x16x32_bf16 v[132:135], a[252:255], v[188:191], v[132:135]
    ds_read_b128 v[136:139], v2 offset:13312
    v_mul_f32 v157, v252, v157
    v_mfma_f32_16x16x32_bf16 v[132:135], v[76:79], v[116:119], v[132:135]
    ds_read_b128 v[148:151], v2 offset:14336
    v_cvt_pk_bf16_f32 v242, v156, v157
    v_mfma_f32_16x16x32_bf16 v[132:135], v[80:83], v[120:123], v[132:135]
    ds_read_b128 v[152:155], v2 offset:15360
    v_mul_f32 v158, v252, v158
    v_mfma_f32_16x16x32_bf16 v[196:199], v[84:87], v[144:147], 0
    ds_read_b128 v[144:147], v2 offset:16384
    v_mul_f32 v159, v252, v159
    v_mfma_f32_16x16x32_bf16 v[196:199], v[88:91], v[140:143], v[196:199]
    ds_read_b128 v[140:143], v2 offset:17408
    v_xor_b32 v2, 65536, v2
    v_mfma_f32_16x16x32_bf16 v[196:199], v[92:95], v[184:187], v[196:199]
    v_fmac_f32 v244, v132, v132
    v_fmac_f32 v244, v133, v133
    v_mfma_f32_16x16x32_bf16 v[196:199], v[96:99], v[188:191], v[196:199]
    v_fmac_f32 v244, v134, v134
    v_fmac_f32 v244, v135, v135
    v_mfma_f32_16x16x32_bf16 v[196:199], v[100:103], v[116:119], v[196:199]
    v_cvt_pk_bf16_f32 v243, v158, v159
    v_mfma_f32_16x16x32_bf16 v[196:199], v[104:107], v[120:123], v[196:199]
    s_waitcnt lgkmcnt(5)
    buffer_store_dwordx2 v[242:243], v18, s[12:15], s27 offen
    v_rsq_f32 v250, v250
    v_mfma_f32_16x16x32_bf16 v[116:119], a[216:219], v[128:131], 0
    s_waitcnt lgkmcnt(3)
    v_mul_f32 v160, v250, v160
    v_mul_f32 v161, v250, v161
    v_mfma_f32_16x16x32_bf16 v[116:119], a[220:223], v[136:139], v[116:119]
    s_waitcnt lgkmcnt(2)
    v_fmac_f32 v244, v196, v196
    v_fmac_f32 v244, v197, v197
    v_mfma_f32_16x16x32_bf16 v[116:119], a[224:227], v[148:151], v[116:119]
    s_waitcnt lgkmcnt(1)
    v_fmac_f32 v244, v198, v198
    v_fmac_f32 v244, v199, v199
    v_mfma_f32_16x16x32_bf16 v[116:119], a[228:231], v[152:155], v[116:119]
    s_waitcnt lgkmcnt(0)
    v_cvt_pk_bf16_f32 v244, v245, v244
    v_cvt_pk_bf16_f32 v120, v160, v161
    v_mfma_f32_16x16x32_bf16 v[116:119], a[232:235], v[144:147], v[116:119]
    v_mul_f32 v162, v250, v162
    v_mul_f32 v163, v250, v163
    v_mfma_f32_16x16x32_bf16 v[116:119], a[236:239], v[140:143], v[116:119]
    v_cvt_pk_bf16_f32 v121, v162, v163
    v_mul_f32 v164, v250, v164
    v_mfma_f32_16x16x32_bf16 v[156:159], a[240:243], v[128:131], 0
    v_mul_f32 v165, v250, v165
    v_cvt_pk_bf16_f32 v122, v164, v165
    v_mfma_f32_16x16x32_bf16 v[156:159], a[244:247], v[136:139], v[156:159]
    v_mul_f32 v166, v250, v166
    v_mul_f32 v167, v250, v167
    v_mfma_f32_16x16x32_bf16 v[156:159], a[248:251], v[148:151], v[156:159]
    ds_read_b128 v[160:163], v253 offset:0
    v_fma_f32 v252, v116, v116, s33
    v_mfma_f32_16x16x32_bf16 v[156:159], a[252:255], v[152:155], v[156:159]
    ds_read_b128 v[184:187], v253 offset:2048
    v_fmac_f32 v252, v117, v117
    v_mfma_f32_16x16x32_bf16 v[156:159], v[76:79], v[144:147], v[156:159]
    ds_read_b128 v[188:191], v253 offset:4096
    v_fmac_f32 v252, v118, v118
    v_mfma_f32_16x16x32_bf16 v[156:159], v[80:83], v[140:143], v[156:159]
    ds_read_b128 v[200:203], v253 offset:6144
    v_fmac_f32 v252, v119, v119
    v_mfma_f32_16x16x32_bf16 v[204:207], v[84:87], v[128:131], 0
    ds_read_b128 v[128:131], v253 offset:8192
    v_cvt_pk_bf16_f32 v123, v166, v167
    v_mfma_f32_16x16x32_bf16 v[204:207], v[88:91], v[136:139], v[204:207]
    ds_read_b128 v[136:139], v253 offset:10240
    buffer_store_dwordx4 v[120:123], v16, s[12:15], s27 offen
    v_fmac_f32 v252, v156, v156
    v_fmac_f32 v252, v157, v157
    v_fmac_f32 v252, v158, v158
    v_fmac_f32 v252, v159, v159
    v_mfma_f32_16x16x32_bf16 v[204:207], v[92:95], v[148:151], v[204:207]
    v_mul_f32 v168, v250, v168
    v_mul_f32 v169, v250, v169
    v_mfma_f32_16x16x32_bf16 v[204:207], v[96:99], v[152:155], v[204:207]
    v_cvt_pk_bf16_f32 v242, v168, v169
    v_mul_f32 v170, v250, v170
    v_mfma_f32_16x16x32_bf16 v[204:207], v[100:103], v[144:147], v[204:207]
    s_waitcnt lgkmcnt(5)
    v_mul_f32 v171, v250, v171
    v_cvt_pk_bf16_f32 v243, v170, v171
    v_mfma_f32_16x16x32_bf16 v[204:207], v[104:107], v[140:143], v[204:207]
    s_waitcnt lgkmcnt(4)
    buffer_store_dwordx2 v[242:243], v19, s[12:15], s27 offen
    v_rsq_f32 v248, v248
    v_mfma_f32_16x16x32_bf16 v[120:123], a[216:219], v[160:163], 0
    s_waitcnt lgkmcnt(2)
    v_mul_f32 v172, v248, v172
    v_mul_f32 v173, v248, v173
    v_mfma_f32_16x16x32_bf16 v[120:123], a[220:223], v[184:187], v[120:123]
    s_waitcnt lgkmcnt(1)
    v_fmac_f32 v252, v204, v204
    v_fmac_f32 v252, v205, v205
    v_mfma_f32_16x16x32_bf16 v[120:123], a[224:227], v[188:191], v[120:123]
    s_waitcnt lgkmcnt(0)
    v_fmac_f32 v252, v206, v206
    v_fmac_f32 v252, v207, v207
    v_mfma_f32_16x16x32_bf16 v[120:123], a[228:231], v[200:203], v[120:123]
    v_cvt_pk_bf16_f32 v245, v252, v252
    v_cvt_pk_bf16_f32 v140, v172, v173
    v_mfma_f32_16x16x32_bf16 v[120:123], a[232:235], v[128:131], v[120:123]
    ds_write_b64 v4, v[244:245] offset:18432
    v_mfma_f32_16x16x32_bf16 v[120:123], a[236:239], v[136:139], v[120:123]
    v_mul_f32 v174, v248, v174
    v_mul_f32 v175, v248, v175
    v_mfma_f32_16x16x32_bf16 v[144:147], a[240:243], v[160:163], 0
    v_cvt_pk_bf16_f32 v141, v174, v175
    v_mul_f32 v176, v248, v176
    v_mfma_f32_16x16x32_bf16 v[144:147], a[244:247], v[184:187], v[144:147]
    v_mul_f32 v177, v248, v177
    v_cvt_pk_bf16_f32 v142, v176, v177
    v_mfma_f32_16x16x32_bf16 v[144:147], a[248:251], v[188:191], v[144:147]
    ds_read_b128 v[148:151], v253 offset:256
    v_fma_f32 v252, v120, v120, s33
    v_mfma_f32_16x16x32_bf16 v[144:147], a[252:255], v[200:203], v[144:147]
    ds_read_b128 v[152:155], v253 offset:2304
    v_fmac_f32 v252, v121, v121
    v_mfma_f32_16x16x32_bf16 v[144:147], v[76:79], v[128:131], v[144:147]
    ds_read_b128 v[164:167], v253 offset:4352
    v_fmac_f32 v252, v122, v122
    v_mfma_f32_16x16x32_bf16 v[144:147], v[80:83], v[136:139], v[144:147]
    ds_read_b128 v[168:171], v253 offset:6400
    v_fmac_f32 v252, v123, v123
    v_mfma_f32_16x16x32_bf16 v[172:175], v[84:87], v[160:163], 0
    ds_read_b128 v[160:163], v253 offset:8448
    v_mul_f32 v178, v248, v178
    v_mfma_f32_16x16x32_bf16 v[172:175], v[88:91], v[184:187], v[172:175]
    ds_read_b128 v[184:187], v253 offset:10496
    v_mul_f32 v179, v248, v179
    v_mfma_f32_16x16x32_bf16 v[172:175], v[92:95], v[188:191], v[172:175]
    v_fmac_f32 v252, v144, v144
    v_fmac_f32 v252, v145, v145
    v_mfma_f32_16x16x32_bf16 v[172:175], v[96:99], v[200:203], v[172:175]
    v_fmac_f32 v252, v146, v146
    v_fmac_f32 v252, v147, v147
    v_mfma_f32_16x16x32_bf16 v[172:175], v[100:103], v[128:131], v[172:175]
    v_cvt_pk_bf16_f32 v143, v178, v179
    v_mul_f32 v180, v248, v180
    v_mfma_f32_16x16x32_bf16 v[172:175], v[104:107], v[136:139], v[172:175]
    s_waitcnt lgkmcnt(5)
    buffer_store_dwordx4 v[140:143], v17, s[12:15], s27 offen
    v_mul_f32 v181, v248, v181
    v_cvt_pk_bf16_f32 v244, v180, v181
    v_mul_f32 v182, v248, v182
    v_mul_f32 v183, v248, v183
    v_mfma_f32_16x16x32_bf16 v[128:131], a[216:219], v[148:151], 0
    s_waitcnt lgkmcnt(3)
    v_fmac_f32 v252, v172, v172
    v_fmac_f32 v252, v173, v173
    v_mfma_f32_16x16x32_bf16 v[128:131], a[220:223], v[152:155], v[128:131]
    s_waitcnt lgkmcnt(2)
    v_fmac_f32 v252, v174, v174
    v_fmac_f32 v252, v175, v175
    v_mfma_f32_16x16x32_bf16 v[128:131], a[224:227], v[164:167], v[128:131]
    s_waitcnt lgkmcnt(1)
    v_cvt_pk_bf16_f32 v250, v252, v252
    v_cvt_pk_bf16_f32 v245, v182, v183
    v_mfma_f32_16x16x32_bf16 v[128:131], a[228:231], v[168:171], v[128:131]
    s_waitcnt lgkmcnt(0)
    buffer_store_dwordx2 v[244:245], v20, s[12:15], s27 offen
    ds_write_b64 v4, v[250:251] offset:0
    v_mfma_f32_16x16x32_bf16 v[128:131], a[232:235], v[160:163], v[128:131]
    s_mov_b32 s14, s36
    v_mfma_f32_16x16x32_bf16 v[128:131], a[236:239], v[184:187], v[128:131]
    v_mfma_f32_16x16x32_bf16 v[136:139], a[240:243], v[148:151], 0
    v_mfma_f32_16x16x32_bf16 v[136:139], a[244:247], v[152:155], v[136:139]
    v_mfma_f32_16x16x32_bf16 v[136:139], a[248:251], v[164:167], v[136:139]
    v_mfma_f32_16x16x32_bf16 v[136:139], a[252:255], v[168:171], v[136:139]
    v_mfma_f32_16x16x32_bf16 v[136:139], v[76:79], v[160:163], v[136:139]
    v_mfma_f32_16x16x32_bf16 v[136:139], v[80:83], v[184:187], v[136:139]
    v_mfma_f32_16x16x32_bf16 v[140:143], v[84:87], v[148:151], 0
    v_mfma_f32_16x16x32_bf16 v[140:143], v[88:91], v[152:155], v[140:143]
    v_fma_f32 v253, v128, v128, s33
    v_fmac_f32 v253, v129, v129
    v_mfma_f32_16x16x32_bf16 v[140:143], v[92:95], v[164:167], v[140:143]
    v_fmac_f32 v253, v130, v130
    v_fmac_f32 v253, v131, v131
    v_mfma_f32_16x16x32_bf16 v[140:143], v[96:99], v[168:171], v[140:143]
    v_fmac_f32 v253, v136, v136
    v_fmac_f32 v253, v137, v137
    v_mfma_f32_16x16x32_bf16 v[140:143], v[100:103], v[160:163], v[140:143]
    v_fmac_f32 v253, v138, v138
    v_fmac_f32 v253, v139, v139
    v_mfma_f32_16x16x32_bf16 v[140:143], v[104:107], v[184:187], v[140:143]
    s_nop 0
    s_nop 0
    s_nop 0
    s_nop 0
    s_nop 0
    s_nop 0
    s_nop 0
    s_nop 0
    v_fmac_f32 v253, v140, v140
    v_fmac_f32 v253, v141, v141
    v_fmac_f32 v253, v142, v142
    v_fmac_f32 v253, v143, v143
    v_cvt_pk_bf16_f32 v248, v253, v253
    ds_write_b64 v4, v[248:249] offset:2048
    s_waitcnt lgkmcnt(0)
    s_barrier
    ds_read_b128 v[148:151], v2 offset:18432
    ds_read_b128 v[152:155], v2 offset:19456
    ds_read_b128 v[160:163], v2 offset:0
    ds_read_b128 v[164:167], v2 offset:1024
    ds_read_b128 v[168:171], v2 offset:2048
    ds_read_b128 v[176:179], v2 offset:3072
    s_waitcnt lgkmcnt(5)
    v_mfma_f32_16x16x32_bf16 v[180:183], v[32:35], v[148:151], 0
    s_waitcnt lgkmcnt(4)
    v_mfma_f32_16x16x32_bf16 v[180:183], v[32:35], v[152:155], v[180:183]
    s_waitcnt lgkmcnt(0)
    v_mfma_f32_16x16x32_bf16 v[148:151], v[32:35], v[160:163], 0
    v_mfma_f32_16x16x32_bf16 v[148:151], v[32:35], v[164:167], v[148:151]
    v_mfma_f32_16x16x32_bf16 v[152:155], v[32:35], v[168:171], 0
    v_mfma_f32_16x16x32_bf16 v[152:155], v[32:35], v[176:179], v[152:155]
    s_nop 0
    s_nop 0
    s_nop 0
    v_mul_f32 v253, 0x3baaaaab, v180
    v_rsq_f32 v253, v253
    v_mul_f32 v252, 0x3baaaaab, v181
    v_mul_f32 v108, v253, v108
    v_mul_f32 v109, v253, v109
    v_cvt_pk_bf16_f32 v108, v108, v109
    v_mul_f32 v110, v253, v110
    v_mul_f32 v111, v253, v111
    v_cvt_pk_bf16_f32 v109, v110, v111
    v_mul_f32 v112, v253, v112
    v_mul_f32 v113, v253, v113
    v_cvt_pk_bf16_f32 v110, v112, v113
    v_mul_f32 v114, v253, v114
    v_mul_f32 v115, v253, v115
    v_cvt_pk_bf16_f32 v111, v114, v115
    v_mul_f32 v192, v253, v192
    v_mul_f32 v193, v253, v193
    v_cvt_pk_bf16_f32 v250, v192, v193
    v_mul_f32 v194, v253, v194
    v_mul_f32 v195, v253, v195
    v_cvt_pk_bf16_f32 v251, v194, v195
    v_rsq_f32 v252, v252
    v_mul_f32 v253, 0x3baaaaab, v182
    v_mul_f32 v124, v252, v124
    v_mul_f32 v125, v252, v125
    v_cvt_pk_bf16_f32 v112, v124, v125
    v_mul_f32 v126, v252, v126
    v_mul_f32 v127, v252, v127
    v_cvt_pk_bf16_f32 v113, v126, v127
    v_mul_f32 v132, v252, v132
    v_mul_f32 v133, v252, v133
    v_cvt_pk_bf16_f32 v114, v132, v133
    v_mul_f32 v134, v252, v134
    v_mul_f32 v135, v252, v135
    v_cvt_pk_bf16_f32 v115, v134, v135
    v_mul_f32 v196, v252, v196
    v_mul_f32 v197, v252, v197
    v_cvt_pk_bf16_f32 v248, v196, v197
    v_mul_f32 v198, v252, v198
    v_mul_f32 v199, v252, v199
    v_cvt_pk_bf16_f32 v249, v198, v199
    v_rsq_f32 v253, v253
    v_mul_f32 v252, 0x3baaaaab, v148
    v_mul_f32 v116, v253, v116
    v_mul_f32 v117, v253, v117
    v_cvt_pk_bf16_f32 v116, v116, v117
    v_mul_f32 v118, v253, v118
    v_mul_f32 v119, v253, v119
    v_cvt_pk_bf16_f32 v117, v118, v119
    v_mul_f32 v156, v253, v156
    v_mul_f32 v157, v253, v157
    v_cvt_pk_bf16_f32 v118, v156, v157
    v_mul_f32 v158, v253, v158
    v_mul_f32 v159, v253, v159
    v_cvt_pk_bf16_f32 v119, v158, v159
    v_mul_f32 v204, v253, v204
    v_mul_f32 v205, v253, v205
    v_cvt_pk_bf16_f32 v244, v204, v205
    v_mul_f32 v206, v253, v206
    v_mul_f32 v207, v253, v207
    v_cvt_pk_bf16_f32 v245, v206, v207
    v_rsq_f32 v252, v252
    v_mul_f32 v253, 0x3baaaaab, v152
    v_mul_f32 v120, v252, v120
    v_mul_f32 v121, v252, v121
    v_cvt_pk_bf16_f32 v120, v120, v121
    v_mul_f32 v122, v252, v122
    v_mul_f32 v123, v252, v123
    v_cvt_pk_bf16_f32 v121, v122, v123
    v_mul_f32 v144, v252, v144
    v_mul_f32 v145, v252, v145
    v_cvt_pk_bf16_f32 v122, v144, v145
    v_mul_f32 v146, v252, v146
    v_mul_f32 v147, v252, v147
    v_cvt_pk_bf16_f32 v123, v146, v147
    v_mul_f32 v172, v252, v172
    v_mul_f32 v173, v252, v173
    v_cvt_pk_bf16_f32 v242, v172, v173
    v_mul_f32 v174, v252, v174
    v_mul_f32 v175, v252, v175
    v_cvt_pk_bf16_f32 v243, v174, v175
    v_rsq_f32 v253, v253
    buffer_store_dwordx4 v[108:111], v15, s[12:15], s26 offen
    buffer_store_dwordx2 v[250:251], v18, s[12:15], s26 offen
    buffer_store_dwordx4 v[112:115], v16, s[12:15], s26 offen
    buffer_store_dwordx2 v[248:249], v19, s[12:15], s26 offen
    buffer_store_dwordx4 v[116:119], v17, s[12:15], s26 offen
    buffer_store_dwordx2 v[244:245], v20, s[12:15], s26 offen
    buffer_store_dwordx4 v[120:123], v247, s[12:15], 0 offen
    buffer_store_dwordx2 v[242:243], v246, s[12:15], 0 offen
    v_mul_f32 v128, v253, v128
    v_mul_f32 v129, v253, v129
    v_cvt_pk_bf16_f32 v108, v128, v129
    v_mul_f32 v130, v253, v130
    v_mul_f32 v131, v253, v131
    v_cvt_pk_bf16_f32 v109, v130, v131
    v_mul_f32 v136, v253, v136
    v_mul_f32 v137, v253, v137
    v_cvt_pk_bf16_f32 v110, v136, v137
    v_mul_f32 v138, v253, v138
    v_mul_f32 v139, v253, v139
    v_cvt_pk_bf16_f32 v111, v138, v139
    v_mul_f32 v140, v253, v140
    v_mul_f32 v141, v253, v141
    v_cvt_pk_bf16_f32 v252, v140, v141
    v_mul_f32 v142, v253, v142
    v_mul_f32 v143, v253, v143
    v_cvt_pk_bf16_f32 v253, v142, v143
    buffer_store_dwordx4 v[108:111], v255, s[12:15], 0 offen
    buffer_store_dwordx2 v[252:253], v254, s[12:15], 0 offen
    s_endpgm
L_done:
    s_endpgm
.section .rodata,"a"
.p2align 6
.amdhsa_kernel standalone__window_attn_swin_v2__vision_kernel
  .amdhsa_next_free_vgpr 512
  .amdhsa_next_free_sgpr 102
  .amdhsa_accum_offset 256
  .amdhsa_group_segment_fixed_size 0
  .amdhsa_kernarg_size 96
  .amdhsa_user_sgpr_count 2
  .amdhsa_user_sgpr_kernarg_segment_ptr 1
  .amdhsa_system_sgpr_workgroup_id_x 1
  .amdhsa_float_denorm_mode_32 3
.end_amdhsa_kernel
```

```asm
; @launch grid=(256,1,1) block=(256,1,1) lds=163840
.amdgcn_target "amdgcn-amd-amdhsa--gfx950"
.text
.globl standalone__window_attn_swin_v2__vision_kernel
.p2align 8
.type standalone__window_attn_swin_v2__vision_kernel,@function
standalone__window_attn_swin_v2__vision_kernel:
    s_cmp_ge_u32 s2, 256
    s_cbranch_scc1 L_done
    s_load_dwordx2 s[44:45], s[0:1], 16
    s_load_dwordx2 s[40:41], s[0:1], 8
    s_load_dwordx2 s[52:53], s[0:1], 32
    s_load_dwordx2 s[56:57], s[0:1], 40
    s_load_dwordx2 s[48:49], s[0:1], 48
    s_load_dwordx2 s[8:9], s[0:1], 0
    s_load_dwordx2 s[12:13], s[0:1], 72
    s_load_dwordx2 s[60:61], s[0:1], 24
    s_cmp_ge_u32 s2, 247
    s_cbranch_scc1 L_edge
    v_lshrrev_b32 v108, 6, v0
    s_getpc_b64 s[4:5]
    s_add_u32 s4, s4, 2048
    s_addc_u32 s5, s5, 0
    v_lshlrev_b32 v110, 7, v0
    v_mov_b32 v111, 0
    v_lshl_add_u64 v[110:111], s[4:5], 0, v[110:111]
    global_load_dword a255, v[110:111], off
    v_readfirstlane_b32 s16, v108
    v_mov_b32 v109, v0
    v_and_b32 v110, 63, v0
    v_lshrrev_b32 v111, 4, v110
    v_and_b32 v112, 15, v110
    v_mov_b32 v113, 0x40000000
    s_lshr_b32 s3, s2, 3
    s_and_b32 s3, s3, 31
    s_cmp_eq_u32 s16, 0
    s_cselect_b32 s4, 54, 18
    s_mul_i32 s3, s3, s4
    s_cmp_ge_u32 s16, 2
    s_cselect_b32 s3, 0, s3
    s_cselect_b32 s4, 6, s4
    s_cmp_eq_u32 s16, 3
    s_cselect_b32 s4, 1, s4
    s_sub_u32 s4, s4, 1
    v_min_u32 v114, s4, v110
    v_add_u32 v114, s3, v114
    v_lshlrev_b32 v114, 7, v114
    v_mov_b32 v115, 0
    s_mov_b32 s66, 193536
    s_mov_b32 s36, 100270464
    s_mov_b32 s22, 1180032
    s_mul_i32 s3, s2, 911
    s_lshr_b32 s3, s3, 16
    s_mul_i32 s4, s3, 72
    s_sub_u32 s38, s2, s4
    s_mul_i32 s3, s3, 1373568
    s_mul_i32 s4, s38, 2688
    s_add_u32 s3, s3, s4
    s_add_u32 s25, s3, 589824
    s_add_u32 s7, s3, 1769472
    s_mov_b32 s20, 31
    s_mov_b32 s21, 4204032
    s_cmp_lt_u32 s2, 244
    s_cselect_b32 s17, 21, 20
    s_mov_b32 s46, 73728
    s_mov_b32 s47, 0x00020000
    s_mov_b32 s42, 221184
    s_mov_b32 s43, 0x00020000
    s_mov_b32 s54, 64
    s_mov_b32 s55, 0x00020000
    s_mov_b32 s58, 128
    s_mov_b32 s59, 0x00020000
    s_mov_b32 s50, 676
    s_mov_b32 s51, 0x00020000
    s_mov_b32 s10, 100270464
    s_mov_b32 s11, 0x00020000
    s_mov_b32 s14, 0
    s_mov_b32 s15, 0x00020000
    s_waitcnt lgkmcnt(0)
    s_cmp_eq_u32 s16, 0
    s_cselect_b64 s[98:99], s[40:41], s[44:45]
    s_cmp_eq_u32 s16, 2
    s_cselect_b64 s[98:99], s[48:49], s[98:99]
    s_cmp_eq_u32 s16, 3
    s_cselect_b64 s[98:99], s[52:53], s[98:99]
    v_lshl_add_u64 v[114:115], s[98:99], 0, v[114:115]
    v_writelane_b32 v114, s56, 62
    v_writelane_b32 v115, s57, 62
    v_writelane_b32 v114, s60, 63
    v_writelane_b32 v115, s61, 63
    global_load_dword a254, v[114:115], off
    v_mul_u32_u24 v108, 2731, v109
    v_bfe_u32 v114, v108, 17, 3
    v_lshrrev_b32 v108, 16, v108
    v_xor_b32 v115, v114, v109
    v_mul_u32_u24 v114, 37, v108
    v_lshrrev_b32 v114, 8, v114
    v_lshlrev_b32 v115, 4, v115
    v_mad_u32_u24 v10, v114, s66, v115
    v_mul_u32_u24 v114, s20, v108
    v_add_u32 v114, s38, v114
    v_mul_u32_u24 v114, 911, v114
    v_lshrrev_b32 v114, 16, v114
    v_mul_u32_u24 v114, s22, v114
    v_mad_u32_u24 v114, v108, s21, v114
    v_cmp_gt_u32 vcc, s17, v108
    v_add_u32 v114, s7, v114
    s_nop 0
    v_cndmask_b32 v114, v113, v114, vcc
    v_mul_u32_u24 v108, 384, v108
    v_sub_u32 v108, v115, v108
    v_add_u32 v114, v114, v108
    v_add_u32 v108, 256, v109
    v_mul_u32_u24 v115, 2731, v108
    v_bfe_u32 v116, v115, 17, 3
    v_lshrrev_b32 v115, 16, v115
    v_xor_b32 v108, v116, v108
    v_mul_u32_u24 v116, 37, v115
    v_lshrrev_b32 v116, 8, v116
    v_lshlrev_b32 v108, 4, v108
    v_mad_u32_u24 v11, v116, s66, v108
    v_mul_u32_u24 v116, s20, v115
    v_add_u32 v116, s38, v116
    v_mul_u32_u24 v116, 911, v116
    v_lshrrev_b32 v116, 16, v116
    v_mul_u32_u24 v116, s22, v116
    v_mad_u32_u24 v116, v115, s21, v116
    v_cmp_gt_u32 vcc, s17, v115
    v_add_u32 v116, s7, v116
    s_nop 0
    v_cndmask_b32 v116, v113, v116, vcc
    v_mul_u32_u24 v115, 384, v115
    v_sub_u32 v115, v108, v115
    v_add_u32 v116, v116, v115
    v_mul_u32_u24 v108, 2731, v110
    v_bfe_u32 v108, v108, 17, 3
    v_xor_b32 v108, v108, v110
    v_lshlrev_b32 v115, 4, v108
    v_xor_b32 v117, 64, v115
    v_add_u32 v108, 64, v110
    v_mul_u32_u24 v108, 2731, v108
    v_bfe_u32 v108, v108, 17, 3
    v_xor_b32 v108, v108, v110
    v_lshlrev_b32 v118, 4, v108
    v_xor_b32 v119, 64, v118
    v_add_u32 v108, 128, v110
    v_mul_u32_u24 v108, 2731, v108
    v_bfe_u32 v108, v108, 17, 3
    v_xor_b32 v108, v108, v110
    v_lshlrev_b32 v108, 4, v108
    v_xor_b32 v132, 64, v108
    s_mul_i32 s65, s16, 18432
    s_cmp_eq_u32 s16, 0
    s_cselect_b32 s63, 0, 20480
    s_cmp_ge_u32 s16, 2
    s_cselect_b32 s64, 61440, s63
    s_cmp_eq_u32 s16, 3
    s_cselect_b32 s63, s64, s63
    s_add_u32 s63, s63, s65
    s_add_u32 s64, s64, s65
    s_lshl_b32 s28, s16, 10
    s_add_u32 s28, s28, 20480
    s_add_u32 m0, s28, 128512
    s_add_u32 s4, s65, 3072
    buffer_load_dwordx4 v114, s[8:11], 0 offen nt lds
    s_add_u32 m0, s28, 132608
    v_mov_b32 v135, 0
    v_cmp_lt_u32 s[88:89], 7, v112
    v_mov_b32 v133, 0
    v_mov_b32 v121, 0
    v_mov_b32 v123, 0
    v_lshlrev_b32 v114, 1, v110
    v_mul_u32_u24 v120, 12, v112
    s_mul_i32 s67, s16, 192
    v_add_u32 v120, s67, v120
    v_lshlrev_b32 v122, 5, v111
    v_mul_u32_u24 v134, 171, v110
    v_lshrrev_b32 v134, 10, v134
    v_lshrrev_b32 v124, 1, v134
    s_mul_i32 s68, s16, 12288
    s_add_u32 s68, s68, 65536
    buffer_load_dwordx4 v116, s[8:11], 0 offen nt lds
    s_add_u32 m0, s28, 0
    v_xor_b32 v124, v124, v134
    v_and_b32 v124, 4, v124
    v_mul_u32_u24 v124, 3, v124
    v_xor_b32 v124, v124, v134
    v_mul_u32_u24 v124, 1152, v124
    v_mul_u32_u24 v134, 96, v134
    v_sub_u32 v124, v124, v134
    v_lshl_add_u32 v116, v110, 4, v124
    v_add_u32 v134, 64, v110
    v_mul_u32_u24 v134, 171, v134
    v_lshrrev_b32 v134, 10, v134
    v_lshrrev_b32 v124, 1, v134
    v_xor_b32 v124, v124, v134
    s_cmp_eq_u32 s16, 3
    s_cselect_b32 s68, 136704, s68
    buffer_load_dwordx4 v10, s[8:11], s25 offen nt lds
    s_add_u32 m0, s28, 4096
    v_and_b32 v124, 4, v124
    v_mul_u32_u24 v124, 3, v124
    v_xor_b32 v124, v124, v134
    v_mul_u32_u24 v124, 1152, v124
    v_mul_u32_u24 v134, 96, v134
    v_sub_u32 v124, v124, v134
    v_lshl_add_u32 v124, v110, 4, v124
    v_add_u32 v134, 128, v110
    v_mul_u32_u24 v134, 171, v134
    v_lshrrev_b32 v134, 10, v134
    v_lshrrev_b32 v125, 1, v134
    v_xor_b32 v125, v125, v134
    v_and_b32 v125, 4, v125
    s_mul_i32 s69, s16, 96
    s_mov_b32 s72, 0x3f80
    buffer_load_dwordx4 v11, s[8:11], s25 offen nt lds
    s_add_u32 m0, s63, 0
    v_mul_u32_u24 v125, 3, v125
    v_xor_b32 v125, v125, v134
    v_mul_u32_u24 v125, 1152, v125
    v_mul_u32_u24 v134, 96, v134
    v_sub_u32 v125, v125, v134
    v_lshl_add_u32 v125, v110, 4, v125
    v_lshrrev_b32 v126, 2, v112
    v_and_b32 v127, 1, v126
    v_mul_u32_u24 v127, 0x020202, v127
    v_lshl_or_b32 v127, v127, 8, v127
    v_add_u32 v127, 0x05040100, v127
    v_and_b32 v128, 3, v112
    v_lshrrev_b32 v134, 1, v112
    s_mul_i32 s73, s16, 192
    s_add_u32 s73, s73, 162048
    buffer_load_dwordx4 v115, s[44:47], s65 offen lds
    v_xor_b32 v129, v134, v111
    v_mul_u32_u24 v130, 384, v112
    v_lshl_add_u32 v0, v129, 4, v130
    v_xor_b32 v1, 64, v0
    v_add_u32 v129, s63, v0
    v_add_u32 v131, s63, v1
    v_add_u32 v136, s64, v0
    v_add_u32 v137, s64, v1
    v_and_b32 v138, 2, v111
    v_add_u32 v138, v138, v111
    v_lshl_add_u32 v138, v138, 2, v126
    v_mul_u32_u24 v138, 96, v138
    v_lshl_add_u32 v138, v128, 3, v138
    v_add_u32 v138, s68, v138
    s_mov_b32 s19, s38
    s_mov_b32 s23, s25
    buffer_load_dwordx4 v118, s[44:47], s65 offen offset:1024 lds
    v_mov_b32 v28, 0x3f803f80
    v_mov_b32 v29, 0x3f803f80
    v_mov_b32 v30, 0x3f803f80
    v_mov_b32 v31, 0x3f803f80
    v_mul_u32_u24 v139, 768, v111
    v_add_u32 v139, v120, v139
    v_add_u32 v139, 157184, v139
    v_and_b32 v140, 1, v112
    v_lshlrev_b32 v140, 4, v140
    v_lshlrev_b32 v141, v140, s72
    v_lshlrev_b32 v142, 4, v111
    v_lshl_add_u32 v143, v112, 2, s73
    v_add_u32 v144, 162048, v142
    v_lshl_add_u32 v145, s16, 2, v111
    s_mov_b32 s26, 0
    s_mov_b32 s27, 0
    buffer_load_dwordx4 v108, s[44:47], s65 offen offset:2048 lds
    s_add_u32 m0, s63, 3072
    v_add_u32 v146, 32, v145
    v_xor_b32 v145, v145, v134
    v_lshl_add_u32 v145, v145, 4, v130
    v_and_b32 v134, 14, v112
    v_xor_b32 v146, v146, v134
    v_lshl_add_u32 v146, v146, 3, v130
    v_add_u32 v147, 104448, v145
    v_add_u32 v130, 104448, v146
    s_mov_b32 s18, 0
    s_add_u32 s19, s19, s20
    s_add_u32 s23, s23, s21
    s_cmp_ge_u32 s19, 72
    s_cselect_b32 s34, 72, 0
    s_cselect_b32 s35, s22, 0
    s_sub_u32 s19, s19, s34
    buffer_load_dwordx4 v117, s[44:47], s4 offen lds
    s_add_u32 s23, s23, s35
    s_mov_b32 s24, s23
    s_add_u32 s19, s19, s20
    s_add_u32 s23, s23, s21
    s_cmp_ge_u32 s19, 72
    s_cselect_b32 s34, 72, 0
    s_cselect_b32 s35, s22, 0
    s_sub_u32 s19, s19, s34
    s_add_u32 s23, s23, s35
    s_mul_i32 s74, s16, 64
    v_lshl_add_u32 v134, v111, 4, s74
    s_mul_i32 s75, s16, 32
    s_add_u32 s75, s75, 256
    v_lshl_add_u32 v148, v111, 3, s75
    s_mul_i32 s76, s16, 768
    s_add_u32 s76, s76, 157184
    buffer_load_dwordx4 v119, s[44:47], s4 offen offset:1024 lds
    v_add_u32 v149, 0, v112
    v_mul_u32_u24 v150, 37, v149
    v_mul_u32_u24 v151, 384, v149
    v_lshrrev_b32 v150, 8, v150
    v_mad_u32_u24 v151, v150, s66, v151
    v_add_u32 v15, v151, v134
    v_add_u32 v18, v151, v148
    v_add_u32 v151, 16, v112
    v_mul_u32_u24 v152, 37, v151
    v_mul_u32_u24 v153, 384, v151
    v_lshrrev_b32 v152, 8, v152
    v_mad_u32_u24 v153, v152, s66, v153
    v_add_u32 v16, v153, v134
    v_add_u32 v19, v153, v148
    s_mov_b32 s77, -24
    s_lshr_b32 s78, s16, 1
    buffer_load_dwordx4 v132, s[44:47], s4 offen offset:2048 lds
    s_add_u32 m0, s64, 6144
    s_add_u32 s4, s65, 6144
    v_add_u32 v153, 32, v112
    v_mul_u32_u24 v154, 37, v153
    v_mul_u32_u24 v155, 384, v153
    v_lshrrev_b32 v154, 8, v154
    v_mad_u32_u24 v155, v154, s66, v155
    v_add_u32 v17, v155, v134
    v_add_u32 v20, v155, v148
    v_mul_u32_u24 v134, 24, v150
    v_lshl_add_u32 v134, v149, 2, v134
    v_add_u32 v22, s76, v134
    v_sub_u32 v23, s76, v134
    v_sub_u32 v134, v22, v142
    s_and_b32 s79, s16, 1
    s_lshl_b32 s79, s79, 3
    buffer_load_dwordx4 v115, s[44:47], s4 offen lds
    v_mul_u32_u24 v152, 24, v152
    v_lshl_add_u32 v152, v151, 2, v152
    v_add_u32 v24, s76, v152
    v_sub_u32 v25, s76, v152
    v_sub_u32 v152, v24, v142
    v_mul_u32_u24 v154, 24, v154
    v_lshl_add_u32 v154, v153, 2, v154
    v_add_u32 v26, s76, v154
    v_sub_u32 v27, s76, v154
    v_sub_u32 v153, v26, v142
    v_mul_u32_u24 v154, 148, v111
    v_add_u32 v155, 0, v154
    v_lshrrev_b32 v155, 8, v155
    v_mad_i32_i24 v40, v155, s77, v134
    s_lshl_b32 s80, s78, 10
    s_add_u32 s80, s80, s79
    buffer_load_dwordx4 v118, s[44:47], s4 offen offset:1024 lds
    v_mad_i32_i24 v52, v155, s77, v152
    v_mad_i32_i24 v64, v155, s77, v153
    v_add_u32 v155, 37, v154
    v_lshrrev_b32 v155, 8, v155
    v_mad_i32_i24 v41, v155, s77, v134
    v_mad_i32_i24 v53, v155, s77, v152
    v_mad_i32_i24 v65, v155, s77, v153
    v_add_u32 v155, 74, v154
    v_lshrrev_b32 v155, 8, v155
    v_mad_i32_i24 v42, v155, s77, v134
    v_mad_i32_i24 v54, v155, s77, v152
    v_mad_i32_i24 v66, v155, s77, v153
    v_add_u32 v155, 111, v154
    v_lshrrev_b32 v155, 8, v155
    s_lshl_b32 s78, s78, 11
    s_add_u32 s78, s78, s79
    buffer_load_dwordx4 v108, s[44:47], s4 offen offset:2048 lds
    s_add_u32 m0, s64, 9216
    s_add_u32 s4, s65, 9216
    v_mad_i32_i24 v43, v155, s77, v134
    v_mad_i32_i24 v55, v155, s77, v152
    v_mad_i32_i24 v67, v155, s77, v153
    v_add_u32 v155, 592, v154
    v_lshrrev_b32 v155, 8, v155
    v_mad_i32_i24 v44, v155, s77, v134
    v_mad_i32_i24 v56, v155, s77, v152
    v_mad_i32_i24 v68, v155, s77, v153
    v_add_u32 v155, 629, v154
    v_lshrrev_b32 v155, 8, v155
    v_mad_i32_i24 v45, v155, s77, v134
    v_mad_i32_i24 v57, v155, s77, v152
    s_add_u32 s78, s78, 144896
    s_mul_i32 s81, s16, 2048
    buffer_load_dwordx4 v117, s[44:47], s4 offen lds
    v_mad_i32_i24 v69, v155, s77, v153
    v_add_u32 v155, 666, v154
    v_lshrrev_b32 v155, 8, v155
    v_mad_i32_i24 v46, v155, s77, v134
    v_mad_i32_i24 v58, v155, s77, v152
    v_mad_i32_i24 v70, v155, s77, v153
    v_add_u32 v155, 703, v154
    v_lshrrev_b32 v155, 8, v155
    v_mad_i32_i24 v47, v155, s77, v134
    v_mad_i32_i24 v59, v155, s77, v152
    v_mad_i32_i24 v71, v155, s77, v153
    v_add_u32 v155, 1184, v154
    v_lshrrev_b32 v155, 8, v155
    v_mad_i32_i24 v48, v155, s77, v134
    s_add_u32 s81, s81, 136704
    s_mul_i32 s82, s16, 8064
    buffer_load_dwordx4 v119, s[44:47], s4 offen offset:1024 lds
    v_mad_i32_i24 v60, v155, s77, v152
    v_mad_i32_i24 v72, v155, s77, v153
    v_add_u32 v155, 1221, v154
    v_lshrrev_b32 v155, 8, v155
    v_mad_i32_i24 v49, v155, s77, v134
    v_mad_i32_i24 v61, v155, s77, v152
    v_mad_i32_i24 v73, v155, s77, v153
    v_add_u32 v155, 1258, v154
    v_lshrrev_b32 v155, 8, v155
    v_mad_i32_i24 v50, v155, s77, v134
    v_mad_i32_i24 v62, v155, s77, v152
    v_mad_i32_i24 v74, v155, s77, v153
    v_add_u32 v154, 1295, v154
    v_lshrrev_b32 v154, 8, v154
    s_add_u32 s82, s82, 104448
    s_mul_i32 s83, s16, 6528
    buffer_load_dwordx4 v132, s[44:47], s4 offen offset:2048 lds
    s_add_u32 m0, s64, 12288
    s_add_u32 s4, s65, 12288
    v_mov_b32 v155, s16
    v_lshlrev_b32 v155, 1, v155
    v_mad_i32_i24 v51, v154, s77, v134
    v_mad_i32_i24 v63, v154, s77, v152
    v_mad_i32_i24 v75, v154, s77, v153
    v_mov_b32 v152, s76
    v_lshlrev_b32 v134, 4, v110
    v_xor_b32 v2, 65536, v134
    v_lshl_add_u32 v3, s16, 10, v134
    v_add_u32 v4, s80, v134
    v_lshl_add_u32 v153, v111, 3, s81
    v_mov_b32 v154, s78
    s_add_u32 s83, s83, 38912
    s_mul_i32 s84, s16, 128
    buffer_load_dwordx4 v115, s[44:47], s4 offen lds
    v_mov_b32 v115, 161536
    v_mul_u32_u24 v134, 80, v111
    v_add3_u32 v5, v134, v140, s82
    v_lshl_add_u32 v6, v112, 2, s83
    s_add_u32 s84, s84, 65024
    v_add_u32 v9, s84, v142
    v_lshrrev_b32 v140, 1, v111
    v_mul_u32_u24 v140, 48, v140
    v_lshl_add_u32 v140, v111, 3, v140
    v_lshl_add_u32 v140, v126, 4, v140
    v_lshl_add_u32 v140, v128, 1, v140
    v_add_u32 v8, s84, v140
    v_mov_b32 v39, 0
    s_mov_b32 s32, 0x2a8cbccc
    s_mov_b32 s33, 0x38fba882
    s_add_u32 s70, s28, 16384
    buffer_load_dwordx4 v118, s[44:47], s4 offen offset:1024 lds
    v_add_u32 v118, 148992, v0
    v_add_u32 v140, 148992, v1
    v_lshlrev_b32 v148, 4, v112
    v_add_u32 v148, 160256, v148
    v_mul_u32_u24 v149, 336, v112
    v_add3_u32 v149, v149, v134, s82
    v_mul_u32_u24 v150, 272, v112
    v_add3_u32 v150, v150, v142, s83
    v_mul_u32_u24 v151, 1088, v111
    v_add_u32 v151, v151, v6
    v_add_u32 v156, 5376, v149
    s_waitcnt vmcnt(8)
    s_cmp_lt_u32 s16, 2
    ds_read_b128 v[160:163], v129 offset:0
    ds_read_b128 v[164:167], v131 offset:0
    ds_read_b128 v[168:171], v129 offset:128
    buffer_load_dwordx4 v108, s[44:47], s4 offen offset:2048 lds
    ds_read_b128 v[172:175], v131 offset:128
    ds_read_b128 v[176:179], v129 offset:256
    ds_read_b128 v[180:183], v131 offset:256
    v_add_u32 v157, 4352, v150
    v_add_u32 v158, 4352, v151
    v_cmp_gt_u32 s[86:87], 16, v110
    v_mov_b32 v159, 0xf149f2ca
    v_add_u32 v108, 512, v109
    v_mul_u32_u24 v110, 2731, v108
    v_bfe_u32 v129, v110, 17, 3
    v_lshrrev_b32 v110, 16, v110
    v_xor_b32 v108, v129, v108
    v_mul_u32_u24 v129, 37, v110
    v_lshrrev_b32 v129, 8, v129
    s_cselect_b32 s29, s70, 160256
    s_cselect_b32 s30, 65536, 0
    buffer_load_ushort v134, v114, s[52:55], 0 offen
    s_add_u32 m0, s64, 15360
    s_add_u32 s4, s65, 15360
    s_xor_b32 s71, s29, s30
    buffer_load_dwordx4 v117, s[44:47], s4 offen lds
    v_lshlrev_b32 v108, 4, v108
    v_mad_u32_u24 v12, v129, s66, v108
    v_add_u32 v114, 768, v109
    s_waitcnt lgkmcnt(5)
    v_mfma_f32_16x16x32_bf16 v[184:187], v[28:31], v[160:163], 0
    s_waitcnt lgkmcnt(3)
    v_mul_u32_u24 v117, 2731, v114
    v_bfe_u32 v108, v117, 17, 3
    v_mfma_f32_16x16x32_bf16 v[184:187], v[28:31], v[164:167], v[184:187]
    s_waitcnt lgkmcnt(0)
    v_lshrrev_b32 v117, 16, v117
    v_xor_b32 v114, v108, v114
    v_mfma_f32_16x16x32_bf16 v[184:187], v[28:31], v[168:171], v[184:187]
    v_mul_u32_u24 v108, 37, v117
    v_lshrrev_b32 v108, 8, v108
    v_mfma_f32_16x16x32_bf16 v[184:187], v[28:31], v[172:175], v[184:187]
    buffer_load_dwordx4 v119, s[44:47], s4 offen offset:1024 lds
    v_lshlrev_b32 v114, 4, v114
    v_mfma_f32_16x16x32_bf16 v[184:187], v[28:31], v[176:179], v[184:187]
    v_mad_u32_u24 v13, v108, s66, v114
    v_add_u32 v114, 1024, v109
    v_mfma_f32_16x16x32_bf16 v[184:187], v[28:31], v[180:183], v[184:187]
    v_mul_u32_u24 v117, 2731, v114
    v_bfe_u32 v119, v117, 17, 3
    v_lshrrev_b32 v117, 16, v117
    v_xor_b32 v114, v119, v114
    v_mul_u32_u24 v119, 37, v117
    v_lshrrev_b32 v119, 8, v119
    v_lshlrev_b32 v114, 4, v114
    buffer_load_dwordx4 v132, s[44:47], s4 offen offset:2048 lds
    s_add_u32 m0, s68, 0
    s_add_u32 s4, s69, 384
    v_mul_f32 v184, 0xbbaaaaab, v184
    ds_write_b32 v143, v184 offset:0
    v_mad_u32_u24 v14, v119, s66, v114
    v_cmp_gt_u32 vcc, 48, v117
    s_nop 0
    s_nop 0
    v_cndmask_b32 v14, v113, v14, vcc
    v_cmp_gt_u32 vcc, 2, v128
    s_nop 0
    buffer_load_dwordx3 v[108:110], v120, s[48:51], 0 offen
    v_cndmask_b32 v32, 0, v141, vcc
    v_cndmask_b32 v33, v141, 0, vcc
    v_cndmask_b32 v34, 0, v141, vcc
    buffer_load_dwordx4 v[160:163], v122, s[56:59], 0 offen
    v_cndmask_b32 v35, v141, 0, vcc
    v_cmp_eq_u32 vcc, v111, v126
    s_nop 0
    s_nop 0
    v_cndmask_b32 v164, 0, v32, vcc
    v_cndmask_b32 v165, 0, v33, vcc
    v_cmp_gt_u32 vcc, 2, v111
    s_nop 0
    s_nop 0
    v_cndmask_b32 v153, v154, v153, vcc
    v_lshl_add_u32 v153, v126, 9, v153
    v_lshl_add_u32 v153, v128, 1, v153
    v_cmp_gt_u32 vcc, 3, v111
    s_nop 0
    buffer_load_dwordx4 v[168:171], v122, s[56:59], 0 offen offset:16
    s_waitcnt vmcnt(10)
    ds_read_b128 v[172:175], v136 offset:6144
    ds_read_b128 v[176:179], v137 offset:6144
    ds_read_b128 v[180:183], v136 offset:6272
    ds_read_b128 v[184:187], v137 offset:6272
    ds_read_b128 v[188:191], v136 offset:6400
    ds_read_b128 v[192:195], v137 offset:6400
    v_cndmask_b32 v7, v115, v153, vcc
    v_cmp_gt_u32 vcc, 8, v112
    s_nop 0
    s_nop 0
    v_cndmask_b32 v156, v148, v156, vcc
    v_cndmask_b32 v157, v148, v157, vcc
    v_cmp_gt_u32 vcc, 2, v111
    global_load_ushort v155, v155, s[60:61]
    s_nop 0
    v_cndmask_b32 v158, v148, v158, vcc
    s_waitcnt lgkmcnt(5)
    v_mfma_f32_16x16x32_bf16 v[112:115], v[28:31], v[172:175], 0
    s_waitcnt lgkmcnt(4)
    v_mfma_f32_16x16x32_bf16 v[112:115], v[28:31], v[176:179], v[112:115]
    s_waitcnt lgkmcnt(0)
    buffer_load_dwordx4 v116, s[40:43], s4 offen lds
    v_mfma_f32_16x16x32_bf16 v[112:115], v[28:31], v[180:183], v[112:115]
    v_mfma_f32_16x16x32_bf16 v[112:115], v[28:31], v[184:187], v[112:115]
    v_mfma_f32_16x16x32_bf16 v[112:115], v[28:31], v[188:191], v[112:115]
    v_mfma_f32_16x16x32_bf16 v[112:115], v[28:31], v[192:195], v[112:115]
    buffer_load_dwordx4 v124, s[40:43], s4 offen offset:1024 lds
    s_nop 0
    s_nop 0
    s_nop 0
    s_nop 0
    s_nop 0
    s_nop 0
    s_nop 0
    v_mul_f32 v112, 0xbbaaaaab, v112
    ds_write_b32 v143, v112 offset:64
    buffer_load_dwordx4 v125, s[40:43], s4 offen offset:2048 lds
    s_add_u32 m0, s68, 3072
    s_add_u32 s4, s69, 37248
    buffer_load_dwordx4 v116, s[40:43], s4 offen lds
    buffer_load_dwordx4 v124, s[40:43], s4 offen offset:1024 lds
    s_waitcnt vmcnt(9)
    s_waitcnt vmcnt(8)
    ds_read_b128 v[112:115], v136 offset:12288
    s_waitcnt vmcnt(7)
    ds_read_b128 v[172:175], v137 offset:12288
    ds_read_b128 v[176:179], v136 offset:12416
    ds_read_b128 v[180:183], v137 offset:12416
    ds_read_b128 v[184:187], v136 offset:12544
    ds_read_b128 v[188:191], v137 offset:12544
    v_cndmask_b32 v160, v160, v161, s[88:89]
    v_cndmask_b32 v162, v162, v163, s[88:89]
    v_perm_b32 v126, v162, v160, v127
    v_bfe_u32 v132, v108, v142, 16
    v_bfe_u32 v120, v109, v142, 16
    buffer_load_dwordx4 v125, s[40:43], s4 offen offset:2048 lds
    v_mfma_f32_16x16x16_bf16 v[160:163], v[134:135], v[132:133], 0
    s_add_u32 m0, s68, 6144
    v_bfe_u32 v122, v110, v142, 16
    s_waitcnt vmcnt(7)
    v_mfma_f32_16x16x16_bf16 v[108:111], v[134:135], v[120:121], 0
    s_add_u32 s4, s69, 74112
    v_cndmask_b32 v168, v168, v169, s[88:89]
    v_cndmask_b32 v170, v170, v171, s[88:89]
    v_mfma_f32_16x16x16_bf16 v[192:195], v[134:135], v[122:123], 0
    v_perm_b32 v127, v170, v168, v127
    v_max_f32 v160, 0, v160
    v_max_f32 v161, 0, v161
    s_waitcnt lgkmcnt(5)
    v_mfma_f32_16x16x32_bf16 v[120:123], v[28:31], v[112:115], 0
    s_waitcnt lgkmcnt(4)
    buffer_load_dwordx4 v116, s[40:43], s4 offen lds
    v_max_f32 v162, 0, v162
    v_mfma_f32_16x16x32_bf16 v[120:123], v[28:31], v[172:175], v[120:123]
    s_waitcnt lgkmcnt(0)
    s_waitcnt vmcnt(7)
    v_max_f32 v163, 0, v163
    v_mfma_f32_16x16x32_bf16 v[120:123], v[28:31], v[176:179], v[120:123]
    v_cvt_pk_bf16_f32 v136, v160, v161
    v_cvt_pk_bf16_f32 v137, v162, v163
    v_mfma_f32_16x16x32_bf16 v[120:123], v[28:31], v[180:183], v[120:123]
    v_max_f32 v108, 0, v108
    v_max_f32 v109, 0, v109
    v_mfma_f32_16x16x32_bf16 v[120:123], v[28:31], v[184:187], v[120:123]
    v_max_f32 v110, 0, v110
    v_max_f32 v111, 0, v111
    v_mfma_f32_16x16x32_bf16 v[120:123], v[28:31], v[188:191], v[120:123]
    buffer_load_dwordx4 v124, s[40:43], s4 offen offset:1024 lds
    v_cvt_pk_bf16_f32 v166, v108, v109
    v_mfma_f32_16x16x16_bf16 v[112:115], v[126:127], v[136:137], 0
    v_cvt_pk_bf16_f32 v167, v110, v111
    v_max_f32 v192, 0, v192
    v_max_f32 v193, 0, v193
    v_mfma_f32_16x16x16_bf16 v[108:111], v[126:127], v[166:167], 0
    v_max_f32 v194, 0, v194
    v_mul_f32 v120, 0xbbaaaaab, v120
    ds_write_b32 v143, v120 offset:128
    buffer_load_dwordx4 v125, s[40:43], s4 offen offset:2048 lds
    s_add_u32 m0, s68, 9216
    s_add_u32 s4, s69, 110976
    v_cvt_pk_bf16_f32 v112, v112, v112
    v_and_b32 v112, 0xffff0000, v112
    v_mul_f32 v112, 0xbfb8aa3b, v112
    v_exp_f32 v112, v112
    v_cvt_pk_bf16_f32 v108, v108, v108
    v_add_f32 v112, 1.0, v112
    v_rcp_f32 v112, v112
    v_and_b32 v108, 0xffff0000, v108
    v_cvt_pk_bf16_f32 v112, v112, v112
    v_and_b32 v112, 0xffff0000, v112
    buffer_load_dwordx4 v116, s[40:43], s4 offen lds
    v_add_f32 v112, -0.5, v112
    v_mul_f32 v112, 0x41b8aa3b, v112
    s_waitcnt vmcnt(7)
    ds_read_b64_tr_b16 a[72:73], v138 offset:0
    ds_read_b64_tr_b16 a[74:75], v138 offset:768
    ds_read_b64_tr_b16 a[96:97], v138 offset:32
    ds_read_b64_tr_b16 a[98:99], v138 offset:800
    ds_read_b64_tr_b16 a[120:121], v138 offset:64
    ds_read_b64_tr_b16 a[122:123], v138 offset:832
    ds_write_b32 v139, v112 offset:0
    v_mul_f32 v108, 0xbfb8aa3b, v108
    v_exp_f32 v108, v108
    buffer_load_dwordx4 v124, s[40:43], s4 offen offset:1024 lds
    v_add_f32 v108, 1.0, v108
    v_rcp_f32 v108, v108
    v_max_f32 v195, 0, v195
    v_cvt_pk_bf16_f32 v108, v108, v108
    v_and_b32 v108, 0xffff0000, v108
    v_add_f32 v108, -0.5, v108
    v_mul_f32 v108, 0x41b8aa3b, v108
    ds_write_b32 v139, v108 offset:4
    v_cvt_pk_bf16_f32 v136, v192, v193
    v_cvt_pk_bf16_f32 v137, v194, v195
    buffer_load_dwordx4 v125, s[40:43], s4 offen offset:2048 lds
    s_add_u32 m0, s68, 0
    v_mfma_f32_16x16x16_bf16 v[108:111], v[126:127], v[136:137], 0
    s_add_u32 s4, s69, 147840
    s_waitcnt lgkmcnt(1)
    v_lshlrev_b32 v155, 16, v155
    v_max_f32 v155, 0xc2c80000, v155
    v_min_f32 v155, 0x40930000, v155
    v_mul_f32 v155, 0x3fb8aa3b, v155
    v_exp_f32 v155, v155
    s_nop 0
    v_cvt_pk_bf16_f32 v108, v108, v108
    v_and_b32 v108, 0xffff0000, v108
    v_mul_f32 v108, 0xbfb8aa3b, v108
    buffer_load_dwordx4 v116, s[40:43], s4 offen lds
    v_exp_f32 v108, v108
    s_waitcnt vmcnt(7)
    ds_read_b64_tr_b16 a[76:77], v138 offset:3072
    ds_read_b64_tr_b16 a[78:79], v138 offset:3840
    ds_read_b64_tr_b16 a[100:101], v138 offset:3104
    ds_read_b64_tr_b16 a[102:103], v138 offset:3872
    ds_read_b64_tr_b16 a[124:125], v138 offset:3136
    ds_read_b64_tr_b16 a[126:127], v138 offset:3904
    v_add_f32 v108, 1.0, v108
    v_rcp_f32 v108, v108
    v_cvt_pk_bf16_f32 v155, v155, v155
    buffer_load_dwordx4 v124, s[40:43], s4 offen offset:1024 lds
    v_cvt_pk_bf16_f32 v108, v108, v108
    v_and_b32 v108, 0xffff0000, v108
    v_add_f32 v108, -0.5, v108
    v_mul_f32 v108, 0x41b8aa3b, v108
    ds_write_b32 v139, v108 offset:8
    v_and_b32 v155, 0xffff0000, v155
    v_mul_f32 v148, 0x3fb8aa3b, v155
    v_readfirstlane_b32 s62, v155
    v_readfirstlane_b32 s31, v148
    buffer_load_dwordx4 v125, s[40:43], s4 offen offset:2048 lds
    s_add_u32 m0, s68, 3072
    s_add_u32 s4, s69, 184704
    s_waitcnt lgkmcnt(1)
    buffer_load_dwordx4 v116, s[40:43], s4 offen lds
    s_waitcnt lgkmcnt(0)
    s_barrier
    ds_read_b128 v[108:111], v145 offset:0
    ds_read_b64 v[126:127], v146 offset:0
    s_waitcnt vmcnt(7)
    ds_read_b64_tr_b16 a[80:81], v138 offset:6144
    ds_read_b64_tr_b16 a[82:83], v138 offset:6912
    ds_read_b64_tr_b16 a[104:105], v138 offset:6176
    ds_read_b64_tr_b16 a[106:107], v138 offset:6944
    ds_read_b64_tr_b16 a[128:129], v138 offset:6208
    ds_read_b64_tr_b16 a[130:131], v138 offset:6976
    ds_read_b128 v[112:115], v144 offset:0
    ds_read_b128 v[120:123], v145 offset:6144
    ds_read_b64 v[166:167], v146 offset:6144
    ds_read_b128 v[132:135], v144 offset:64
    ds_read_b128 v[160:163], v145 offset:12288
    buffer_load_dwordx4 v124, s[40:43], s4 offen offset:1024 lds
    ds_read_b64 v[128:129], v146 offset:12288
    ds_read_b128 v[168:171], v144 offset:128
    ds_read_b32 v22, v22 offset:0
    ds_read_b32 v23, v23 offset:672
    ds_read_b32 v24, v24 offset:0
    ds_read_b32 v25, v25 offset:672
    ds_read_b32 v26, v26 offset:0
    ds_read_b32 v27, v27 offset:672
    ds_read_b32 v40, v40 offset:336
    ds_read_b32 v52, v52 offset:336
    ds_read_b32 v64, v64 offset:336
    ds_read_b32 v41, v41 offset:332
    ds_read_b32 v53, v53 offset:332
    ds_read_b32 v65, v65 offset:332
    ds_read_b32 v42, v42 offset:328
    ds_read_b32 v54, v54 offset:328
    buffer_load_dwordx4 v125, s[40:43], s4 offen offset:2048 lds
    ds_read_b32 v66, v66 offset:328
    ds_read_b32 v43, v43 offset:324
    ds_read_b32 v55, v55 offset:324
    ds_read_b32 v67, v67 offset:324
    ds_read_b32 v44, v44 offset:272
    s_waitcnt lgkmcnt(15)
    v_mfma_f32_16x16x16_bf16 v[172:175], v[108:109], v[164:165], v[112:115]
    s_waitcnt lgkmcnt(14)
    ds_read_b32 v56, v56 offset:272
    ds_read_b32 v68, v68 offset:272
    v_mfma_f32_16x16x16_bf16 v[176:179], v[110:111], v[164:165], v[112:115]
    s_add_u32 m0, s68, 6144
    s_waitcnt vmcnt(6)
    buffer_load_dwordx4 v116, s[40:43], s69 offen lds
    v_mfma_f32_16x16x16_bf16 v[108:111], v[126:127], v[164:165], v[112:115]
    s_add_u32 s4, s69, 36864
    ds_read_b64_tr_b16 a[84:85], v138 offset:9216
    ds_read_b64_tr_b16 a[86:87], v138 offset:9984
    v_mfma_f32_16x16x16_bf16 v[180:183], v[120:121], v[164:165], v[132:135]
    s_waitcnt lgkmcnt(7)
    ds_read_b64_tr_b16 a[108:109], v138 offset:9248
    ds_read_b64_tr_b16 a[110:111], v138 offset:10016
    v_mfma_f32_16x16x16_bf16 v[112:115], v[122:123], v[164:165], v[132:135]
    s_waitcnt lgkmcnt(6)
    ds_read_b64_tr_b16 a[132:133], v138 offset:9280
    ds_read_b64_tr_b16 a[134:135], v138 offset:10048
    v_mfma_f32_16x16x16_bf16 v[120:123], v[166:167], v[164:165], v[132:135]
    ds_read_b32 v45, v45 offset:268
    ds_read_b32 v57, v57 offset:268
    v_mfma_f32_16x16x16_bf16 v[184:187], v[160:161], v[164:165], v[168:171]
    buffer_load_dwordx4 v124, s[40:43], s69 offen offset:1024 lds
    ds_read_b32 v69, v69 offset:268
    v_mfma_f32_16x16x16_bf16 v[132:135], v[162:163], v[164:165], v[168:171]
    ds_read_b32 v46, v46 offset:264
    ds_read_b32 v58, v58 offset:264
    v_mfma_f32_16x16x16_bf16 v[160:163], v[128:129], v[164:165], v[168:171]
    s_waitcnt lgkmcnt(11)
    ds_read_b32 v70, v70 offset:264
    ds_read_b32 v47, v47 offset:260
    ds_read_b32 v59, v59 offset:260
    ds_read_b32 v71, v71 offset:260
    ds_read_b32 v48, v48 offset:208
    ds_read_b32 v60, v60 offset:208
    ds_read_b32 v72, v72 offset:208
    ds_read_b32 v49, v49 offset:204
    ds_read_b32 v61, v61 offset:204
    buffer_load_dwordx4 v125, s[40:43], s69 offen offset:2048 lds
    ds_read_b32 v73, v73 offset:204
    ds_read_b32 v50, v50 offset:200
    ds_read_b32 v62, v62 offset:200
    ds_read_b32 v74, v74 offset:200
    ds_read_b32 v51, v51 offset:196
    ds_read_b32 v63, v63 offset:196
    ds_read_b32 v75, v75 offset:196
    ds_read_b32 v152, v152 offset:336
    s_add_u32 m0, s68, 9216
    s_waitcnt lgkmcnt(15)
    s_waitcnt vmcnt(6)
    buffer_load_dwordx4 v116, s[40:43], s4 offen lds
    ds_read_b64_tr_b16 a[88:89], v138 offset:0
    ds_read_b64_tr_b16 a[90:91], v138 offset:768
    ds_read_b64_tr_b16 a[112:113], v138 offset:32
    ds_read_b64_tr_b16 a[114:115], v138 offset:800
    ds_read_b64_tr_b16 a[136:137], v138 offset:64
    ds_read_b64_tr_b16 a[138:139], v138 offset:832
    v_cvt_pk_bf16_f32 v172, v172, v173
    v_accvgpr_write_b32 a216, v172
    v_cvt_pk_bf16_f32 v174, v174, v175
    v_accvgpr_write_b32 a217, v174
    v_cvt_pk_bf16_f32 v176, v176, v177
    v_accvgpr_write_b32 a240, v176
    v_cvt_pk_bf16_f32 v178, v178, v179
    v_accvgpr_write_b32 a241, v178
    s_waitcnt lgkmcnt(6)
    buffer_load_dwordx4 v124, s[40:43], s4 offen offset:1024 lds
    v_cvt_pk_bf16_f32 v84, v108, v109
    v_cvt_pk_bf16_f32 v85, v110, v111
    v_cvt_pk_bf16_f32 v180, v180, v181
    v_accvgpr_write_b32 a218, v180
    v_cvt_pk_bf16_f32 v182, v182, v183
    v_accvgpr_write_b32 a219, v182
    v_cvt_pk_bf16_f32 v112, v112, v113
    v_accvgpr_write_b32 a242, v112
    v_cvt_pk_bf16_f32 v114, v114, v115
    v_accvgpr_write_b32 a243, v114
    v_cvt_pk_bf16_f32 v86, v120, v121
    v_cvt_pk_bf16_f32 v87, v122, v123
    v_cvt_pk_bf16_f32 v184, v184, v185
    v_accvgpr_write_b32 a232, v184
    buffer_load_dwordx4 v125, s[40:43], s4 offen offset:2048 lds
    ds_read_b128 v[108:111], v145 offset:38912
    ds_read_b64 v[126:127], v146 offset:38912
    ds_read_b128 v[112:115], v144 offset:192
    ds_read_b128 v[120:123], v145 offset:45056
    ds_read_b64 v[166:167], v146 offset:45056
    ds_read_b128 v[168:171], v144 offset:256
    s_add_u32 m0, s68, 0
    s_add_u32 s4, s69, 73728
    s_waitcnt lgkmcnt(6)
    s_waitcnt vmcnt(6)
    ds_read_b64_tr_b16 a[92:93], v138 offset:3072
    ds_read_b64_tr_b16 a[94:95], v138 offset:3840
    ds_read_b64_tr_b16 a[116:117], v138 offset:3104
    ds_read_b64_tr_b16 a[118:119], v138 offset:3872
    ds_read_b64_tr_b16 a[140:141], v138 offset:3136
    ds_read_b64_tr_b16 a[142:143], v138 offset:3904
    buffer_load_dwordx4 v116, s[40:43], s4 offen lds
    v_cvt_pk_bf16_f32 v186, v186, v187
    v_accvgpr_write_b32 a233, v186
    v_cvt_pk_bf16_f32 v76, v132, v133
    v_cvt_pk_bf16_f32 v77, v134, v135
    v_cvt_pk_bf16_f32 v100, v160, v161
    v_cvt_pk_bf16_f32 v101, v162, v163
    ds_read_b128 v[132:135], v145 offset:51200
    ds_read_b64 v[128:129], v146 offset:51200
    ds_read_b128 v[160:163], v144 offset:320
    v_readfirstlane_b32 s39, v152
    v_cndmask_b32 v22, v159, v22, s[86:87]
    s_waitcnt lgkmcnt(12)
    v_mfma_f32_16x16x16_bf16 v[152:155], v[108:109], v[164:165], v[112:115]
    s_waitcnt lgkmcnt(10)
    buffer_load_dwordx4 v124, s[40:43], s4 offen offset:1024 lds
    v_cndmask_b32 v24, v159, v24, s[86:87]
    v_mfma_f32_16x16x16_bf16 v[172:175], v[110:111], v[164:165], v[112:115]
    s_waitcnt lgkmcnt(9)
    v_cndmask_b32 v26, v159, v26, s[86:87]
    v_mfma_f32_16x16x16_bf16 v[108:111], v[126:127], v[164:165], v[112:115]
    s_waitcnt lgkmcnt(6)
    v_cvt_pk_bf16_f32 v152, v152, v153
    v_accvgpr_write_b32 a220, v152
    v_mfma_f32_16x16x16_bf16 v[176:179], v[120:121], v[164:165], v[168:171]
    s_waitcnt lgkmcnt(3)
    v_cvt_pk_bf16_f32 v154, v154, v155
    v_accvgpr_write_b32 a221, v154
    v_mfma_f32_16x16x16_bf16 v[112:115], v[122:123], v[164:165], v[168:171]
    v_cvt_pk_bf16_f32 v172, v172, v173
    v_accvgpr_write_b32 a244, v172
    v_mfma_f32_16x16x16_bf16 v[120:123], v[166:167], v[164:165], v[168:171]
    buffer_load_dwordx4 v125, s[40:43], s4 offen offset:2048 lds
    s_add_u32 m0, s68, 3072
    s_waitcnt lgkmcnt(0)
    v_mfma_f32_16x16x16_bf16 v[152:155], v[132:133], v[164:165], v[160:163]
    s_add_u32 s4, s69, 110592
    v_cvt_pk_bf16_f32 v174, v174, v175
    v_accvgpr_write_b32 a245, v174
    v_mfma_f32_16x16x16_bf16 v[168:171], v[134:135], v[164:165], v[160:163]
    v_cvt_pk_bf16_f32 v88, v108, v109
    v_cvt_pk_bf16_f32 v89, v110, v111
    v_mfma_f32_16x16x16_bf16 v[108:111], v[128:129], v[164:165], v[160:163]
    ds_read_b128 v[132:135], v145 offset:57344
    ds_read_b64 v[126:127], v146 offset:57344
    ds_read_b128 v[172:175], v144 offset:384
    s_waitcnt vmcnt(6)
    buffer_load_dwordx4 v116, s[40:43], s4 offen lds
    ds_read_b64_tr_b16 a[0:1], v138 offset:6144
    ds_read_b64_tr_b16 a[2:3], v138 offset:6912
    ds_read_b64_tr_b16 a[24:25], v138 offset:6176
    ds_read_b64_tr_b16 a[26:27], v138 offset:6944
    ds_read_b64_tr_b16 a[48:49], v138 offset:6208
    ds_read_b64_tr_b16 a[50:51], v138 offset:6976
    v_cvt_pk_bf16_f32 v176, v176, v177
    v_accvgpr_write_b32 a222, v176
    v_cvt_pk_bf16_f32 v178, v178, v179
    v_accvgpr_write_b32 a223, v178
    v_cvt_pk_bf16_f32 v112, v112, v113
    v_accvgpr_write_b32 a246, v112
    v_cvt_pk_bf16_f32 v114, v114, v115
    v_accvgpr_write_b32 a247, v114
    buffer_load_dwordx4 v124, s[40:43], s4 offen offset:1024 lds
    v_cvt_pk_bf16_f32 v90, v120, v121
    v_cvt_pk_bf16_f32 v91, v122, v123
    v_cvt_pk_bf16_f32 v152, v152, v153
    v_accvgpr_write_b32 a234, v152
    v_cvt_pk_bf16_f32 v154, v154, v155
    v_accvgpr_write_b32 a235, v154
    v_cvt_pk_bf16_f32 v78, v168, v169
    v_cvt_pk_bf16_f32 v79, v170, v171
    s_waitcnt lgkmcnt(6)
    v_mfma_f32_16x16x16_bf16 v[112:115], v[132:133], v[164:165], v[172:175]
    ds_read_b128 v[120:123], v147 offset:0
    ds_read_b64 v[166:167], v130 offset:0
    v_mfma_f32_16x16x16_bf16 v[152:155], v[134:135], v[164:165], v[172:175]
    s_waitcnt lgkmcnt(4)
    ds_read_b128 v[132:135], v144 offset:448
    buffer_load_dwordx4 v125, s[40:43], s4 offen offset:2048 lds
    v_mfma_f32_16x16x16_bf16 v[160:163], v[126:127], v[164:165], v[172:175]
    s_add_u32 m0, s68, 6144
    s_add_u32 s4, s69, 147456
    s_waitcnt lgkmcnt(3)
    v_cvt_pk_bf16_f32 v102, v108, v109
    v_cvt_pk_bf16_f32 v103, v110, v111
    v_cvt_pk_bf16_f32 v112, v112, v113
    v_accvgpr_write_b32 a224, v112
    v_cvt_pk_bf16_f32 v114, v114, v115
    v_accvgpr_write_b32 a225, v114
    v_cvt_pk_bf16_f32 v152, v152, v153
    v_accvgpr_write_b32 a248, v152
    v_cvt_pk_bf16_f32 v154, v154, v155
    v_accvgpr_write_b32 a249, v154
    buffer_load_dwordx4 v116, s[40:43], s4 offen lds
    ds_read_b128 v[108:111], v147 offset:6144
    ds_read_b64 v[126:127], v130 offset:6144
    s_waitcnt vmcnt(7)
    ds_read_b64_tr_b16 a[4:5], v138 offset:9216
    ds_read_b64_tr_b16 a[6:7], v138 offset:9984
    ds_read_b64_tr_b16 a[28:29], v138 offset:9248
    ds_read_b64_tr_b16 a[30:31], v138 offset:10016
    ds_read_b64_tr_b16 a[52:53], v138 offset:9280
    ds_read_b64_tr_b16 a[54:55], v138 offset:10048
    s_waitcnt lgkmcnt(8)
    v_mfma_f32_16x16x16_bf16 v[112:115], v[120:121], v[164:165], v[132:135]
    ds_read_b128 v[152:155], v144 offset:512
    v_cvt_pk_bf16_f32 v92, v160, v161
    v_mfma_f32_16x16x16_bf16 v[168:171], v[122:123], v[164:165], v[132:135]
    buffer_load_dwordx4 v124, s[40:43], s4 offen offset:1024 lds
    v_cvt_pk_bf16_f32 v93, v162, v163
    v_mfma_f32_16x16x16_bf16 v[120:123], v[166:167], v[164:165], v[132:135]
    ds_read_b128 v[160:163], v147 offset:12288
    ds_read_b64 v[166:167], v130 offset:12288
    ds_read_b128 v[172:175], v144 offset:576
    v_cvt_pk_bf16_f32 v112, v112, v113
    v_accvgpr_write_b32 a226, v112
    v_cvt_pk_bf16_f32 v114, v114, v115
    v_accvgpr_write_b32 a227, v114
    v_cvt_pk_bf16_f32 v168, v168, v169
    v_accvgpr_write_b32 a250, v168
    v_cvt_pk_bf16_f32 v170, v170, v171
    v_accvgpr_write_b32 a251, v170
    buffer_load_dwordx4 v125, s[40:43], s4 offen offset:2048 lds
    s_add_u32 m0, s68, 9216
    s_add_u32 s4, s69, 184320
    s_waitcnt lgkmcnt(4)
    v_cvt_pk_bf16_f32 v94, v120, v121
    v_cvt_pk_bf16_f32 v95, v122, v123
    ds_read_b128 v[112:115], v147 offset:18432
    s_waitcnt lgkmcnt(4)
    v_mfma_f32_16x16x16_bf16 v[120:123], v[108:109], v[164:165], v[152:155]
    ds_read_b64 v[128:129], v130 offset:18432
    ds_read_b128 v[132:135], v144 offset:640
    v_mfma_f32_16x16x16_bf16 v[168:171], v[110:111], v[164:165], v[152:155]
    s_waitcnt lgkmcnt(5)
    v_mfma_f32_16x16x16_bf16 v[108:111], v[126:127], v[164:165], v[152:155]
    s_waitcnt lgkmcnt(3)
    buffer_load_dwordx4 v116, s[40:43], s4 offen lds
    v_mfma_f32_16x16x16_bf16 v[176:179], v[160:161], v[164:165], v[172:175]
    s_waitcnt vmcnt(7)
    ds_read_b64_tr_b16 a[8:9], v138 offset:0
    ds_read_b64_tr_b16 a[10:11], v138 offset:768
    v_mfma_f32_16x16x16_bf16 v[152:155], v[162:163], v[164:165], v[172:175]
    ds_read_b64_tr_b16 a[32:33], v138 offset:32
    ds_read_b64_tr_b16 a[34:35], v138 offset:800
    v_mfma_f32_16x16x16_bf16 v[160:163], v[166:167], v[164:165], v[172:175]
    ds_read_b64_tr_b16 a[56:57], v138 offset:64
    ds_read_b64_tr_b16 a[58:59], v138 offset:832
    ds_read_b128 v[180:183], v118 offset:0
    ds_read_b128 v[184:187], v140 offset:0
    ds_read_b128 v[172:175], v118 offset:128
    buffer_load_dwordx4 v124, s[40:43], s4 offen offset:1024 lds
    ds_read_b128 v[188:191], v140 offset:128
    ds_read_b128 v[192:195], v118 offset:256
    ds_read_b128 v[196:199], v140 offset:256
    s_waitcnt lgkmcnt(12)
    v_mfma_f32_16x16x16_bf16 v[200:203], v[112:113], v[164:165], v[132:135]
    v_cvt_pk_bf16_f32 v120, v120, v121
    v_accvgpr_write_b32 a236, v120
    v_mfma_f32_16x16x16_bf16 v[204:207], v[114:115], v[164:165], v[132:135]
    v_cvt_pk_bf16_f32 v122, v122, v123
    v_accvgpr_write_b32 a237, v122
    v_mfma_f32_16x16x16_bf16 v[112:115], v[128:129], v[164:165], v[132:135]
    buffer_load_dwordx4 v125, s[40:43], s4 offen offset:2048 lds
    s_add_u32 m0, s68, 0
    s_add_u32 s4, s69, 768
    v_cvt_pk_bf16_f32 v80, v168, v169
    v_cvt_pk_bf16_f32 v81, v170, v171
    v_cvt_pk_bf16_f32 v104, v108, v109
    v_cvt_pk_bf16_f32 v105, v110, v111
    s_waitcnt lgkmcnt(6)
    s_waitcnt lgkmcnt(5)
    v_mfma_f32_16x16x32_bf16 v[108:111], a[72:75], v[180:183], 0
    s_waitcnt lgkmcnt(3)
    ds_read_b128 v[120:123], v147 offset:24576
    ds_read_b64 v[126:127], v130 offset:24576
    v_mfma_f32_16x16x32_bf16 v[108:111], a[76:79], v[184:187], v[108:111]
    s_waitcnt lgkmcnt(2)
    ds_read_b128 v[128:131], v144 offset:704
    v_cvt_pk_bf16_f32 v176, v176, v177
    v_mfma_f32_16x16x32_bf16 v[108:111], a[80:83], v[172:175], v[108:111]
    buffer_load_dwordx4 v116, s[40:43], s4 offen lds
    s_waitcnt vmcnt(7)
    v_mfma_f32_16x16x32_bf16 v[108:111], a[84:87], v[188:191], v[108:111]
    ds_read_b64_tr_b16 a[12:13], v138 offset:3072
    ds_read_b64_tr_b16 a[14:15], v138 offset:3840
    v_mfma_f32_16x16x32_bf16 v[108:111], a[88:91], v[192:195], v[108:111]
    ds_read_b64_tr_b16 a[36:37], v138 offset:3104
    ds_read_b64_tr_b16 a[38:39], v138 offset:3872
    v_mfma_f32_16x16x32_bf16 v[108:111], a[92:95], v[196:199], v[108:111]
    ds_read_b64_tr_b16 a[60:61], v138 offset:3136
    ds_read_b64_tr_b16 a[62:63], v138 offset:3904
    v_mfma_f32_16x16x32_bf16 v[132:135], a[96:99], v[180:183], 0
    v_accvgpr_write_b32 a228, v176
    v_cvt_pk_bf16_f32 v178, v178, v179
    v_mfma_f32_16x16x32_bf16 v[132:135], a[100:103], v[184:187], v[132:135]
    buffer_load_dwordx4 v124, s[40:43], s4 offen offset:1024 lds
    v_accvgpr_write_b32 a229, v178
    v_mfma_f32_16x16x32_bf16 v[132:135], a[104:107], v[172:175], v[132:135]
    s_waitcnt lgkmcnt(7)
    v_cvt_pk_bf16_f32 v152, v152, v153
    v_accvgpr_write_b32 a252, v152
    v_mfma_f32_16x16x32_bf16 v[132:135], a[108:111], v[188:191], v[132:135]
    s_barrier
    v_cvt_pk_bf16_f32 v154, v154, v155
    v_accvgpr_write_b32 a253, v154
    v_mfma_f32_16x16x32_bf16 v[132:135], a[112:115], v[192:195], v[132:135]
    s_waitcnt lgkmcnt(6)
    v_cvt_pk_bf16_f32 v96, v160, v161
    v_cvt_pk_bf16_f32 v97, v162, v163
    v_mfma_f32_16x16x16_bf16 v[144:147], v[120:121], v[164:165], v[128:131]
    s_waitcnt lgkmcnt(4)
    v_cvt_pk_bf16_f32 v200, v200, v201
    v_accvgpr_write_b32 a230, v200
    v_mfma_f32_16x16x16_bf16 v[152:155], v[122:123], v[164:165], v[128:131]
    s_waitcnt lgkmcnt(2)
    buffer_load_dwordx4 v125, s[40:43], s4 offen offset:2048 lds
    v_cvt_pk_bf16_f32 v202, v202, v203
    v_mfma_f32_16x16x16_bf16 v[120:123], v[126:127], v[164:165], v[128:131]
    s_add_u32 m0, s68, 3072
    v_accvgpr_write_b32 a231, v202
    v_cvt_pk_bf16_f32 v204, v204, v205
    v_mfma_f32_16x16x32_bf16 v[132:135], a[116:119], v[196:199], v[132:135]
    s_add_u32 s4, s69, 37632
    v_accvgpr_write_b32 a254, v204
    v_cvt_pk_bf16_f32 v206, v206, v207
    v_mfma_f32_16x16x32_bf16 v[160:163], a[120:123], v[180:183], 0
    s_waitcnt lgkmcnt(0)
    s_waitcnt vmcnt(6)
    ds_read_b64_tr_b16 a[16:17], v138 offset:6144
    v_mfma_f32_16x16x32_bf16 v[160:163], a[124:127], v[184:187], v[160:163]
    ds_read_b64_tr_b16 a[18:19], v138 offset:6912
    buffer_load_dwordx4 v116, s[40:43], s4 offen lds
    v_mfma_f32_16x16x32_bf16 v[160:163], a[128:131], v[172:175], v[160:163]
    ds_read_b64_tr_b16 a[40:41], v138 offset:6176
    ds_read_b64_tr_b16 a[42:43], v138 offset:6944
    v_mfma_f32_16x16x32_bf16 v[160:163], a[132:135], v[188:191], v[160:163]
    ds_read_b64_tr_b16 a[64:65], v138 offset:6208
    ds_read_b64_tr_b16 a[66:67], v138 offset:6976
    v_mfma_f32_16x16x32_bf16 v[160:163], a[136:139], v[192:195], v[160:163]
    v_accvgpr_write_b32 a255, v206
    v_cvt_pk_bf16_f32 v98, v112, v113
    v_mfma_f32_16x16x32_bf16 v[160:163], a[140:143], v[196:199], v[160:163]
    v_cvt_pk_bf16_f32 v99, v114, v115
    v_cvt_pk_bf16_f32 v144, v144, v145
    v_mfma_f32_16x16x32_bf16 v[112:115], a[0:3], v[180:183], 0
    buffer_load_dwordx4 v124, s[40:43], s4 offen offset:1024 lds
    v_accvgpr_write_b32 a238, v144
    v_mfma_f32_16x16x32_bf16 v[112:115], a[4:7], v[184:187], v[112:115]
    v_cvt_pk_bf16_f32 v146, v146, v147
    v_accvgpr_write_b32 a239, v146
    v_mfma_f32_16x16x32_bf16 v[112:115], a[8:11], v[172:175], v[112:115]
    s_waitcnt lgkmcnt(5)
    v_cvt_pk_bf16_f32 v82, v152, v153
    v_cvt_pk_bf16_f32 v83, v154, v155
    v_mfma_f32_16x16x32_bf16 v[112:115], a[12:15], v[188:191], v[112:115]
    s_waitcnt lgkmcnt(4)
    v_cvt_pk_bf16_f32 v106, v120, v121
    v_cvt_pk_bf16_f32 v107, v122, v123
    v_mfma_f32_16x16x32_bf16 v[112:115], a[16:19], v[192:195], v[112:115]
    s_waitcnt lgkmcnt(2)
    v_mov_b32 v120, 0
    v_mov_b32 v121, 0
    v_mfma_f32_16x16x32_bf16 v[128:131], a[24:27], v[180:183], 0
    s_waitcnt lgkmcnt(0)
    buffer_load_dwordx4 v125, s[40:43], s4 offen offset:2048 lds
    v_mov_b32 v122, 0
    v_mfma_f32_16x16x32_bf16 v[128:131], a[28:31], v[184:187], v[128:131]
    s_add_u32 m0, s68, 6144
    ds_write_b64 v149, v[120:121] offset:56
    v_mfma_f32_16x16x32_bf16 v[128:131], a[32:35], v[172:175], v[128:131]
    s_add_u32 s4, s69, 74496
    v_mov_b32 v123, 0
    s_waitcnt vmcnt(6)
    v_mfma_f32_16x16x32_bf16 v[128:131], a[36:39], v[188:191], v[128:131]
    ds_read_b64_tr_b16 a[20:21], v138 offset:9216
    ds_read_b64_tr_b16 a[22:23], v138 offset:9984
    v_mfma_f32_16x16x32_bf16 v[128:131], a[40:43], v[192:195], v[128:131]
    buffer_load_dwordx4 v116, s[40:43], s4 offen lds
    ds_read_b64_tr_b16 a[44:45], v138 offset:9248
    v_mfma_f32_16x16x32_bf16 v[164:167], a[48:51], v[180:183], 0
    ds_read_b64_tr_b16 a[46:47], v138 offset:10016
    ds_read_b64_tr_b16 a[68:69], v138 offset:9280
    v_mfma_f32_16x16x32_bf16 v[164:167], a[52:55], v[184:187], v[164:167]
    ds_read_b64_tr_b16 a[70:71], v138 offset:10048
    ds_read_b128 v[144:147], v118 offset:6144
    v_mfma_f32_16x16x32_bf16 v[164:167], a[56:59], v[172:175], v[164:167]
    ds_read_b128 v[152:155], v140 offset:6144
    ds_read_b128 v[168:171], v140 offset:6272
    v_mfma_f32_16x16x32_bf16 v[164:167], a[60:63], v[188:191], v[164:167]
    ds_read_b128 v[172:175], v118 offset:6400
    buffer_load_dwordx4 v124, s[40:43], s4 offen offset:1024 lds
    v_mfma_f32_16x16x32_bf16 v[164:167], a[64:67], v[192:195], v[164:167]
    ds_read_b128 v[180:183], v140 offset:6400
    ds_write_b128 v149, v[120:123] offset:16
    s_waitcnt lgkmcnt(10)
    v_mfma_f32_16x16x32_bf16 v[112:115], a[20:23], v[196:199], v[112:115]
    v_fma_f32 v148, v108, v108, s32
    v_fmac_f32 v148, v109, v109
    v_fmac_f32 v148, v110, v110
    s_waitcnt lgkmcnt(8)
    v_mfma_f32_16x16x32_bf16 v[128:131], a[44:47], v[196:199], v[128:131]
    s_waitcnt lgkmcnt(7)
    buffer_load_dwordx4 v125, s[40:43], s4 offen offset:2048 lds
    s_waitcnt lgkmcnt(6)
    v_mfma_f32_16x16x32_bf16 v[164:167], a[68:71], v[196:199], v[164:167]
    s_waitcnt lgkmcnt(5)
    ds_read_b128 v[184:187], v118 offset:6272
    v_fmac_f32 v148, v111, v111
    v_mfma_f32_16x16x32_bf16 v[188:191], a[72:75], v[144:147], 0
    s_waitcnt lgkmcnt(4)
    ds_write_b64 v149, v[120:121] offset:64
    v_mfma_f32_16x16x32_bf16 v[188:191], a[76:79], v[152:155], v[188:191]
    s_add_u32 m0, s68, 9216
    v_fmac_f32 v148, v132, v132
    v_fmac_f32 v148, v133, v133
    v_mfma_f32_16x16x32_bf16 v[196:199], a[96:99], v[144:147], 0
    s_add_u32 s4, s69, 111360
    s_waitcnt vmcnt(6)
    buffer_load_dwordx4 v116, s[40:43], s4 offen lds
    v_mfma_f32_16x16x32_bf16 v[196:199], a[100:103], v[152:155], v[196:199]
    s_waitcnt lgkmcnt(2)
    ds_read_b64_tr_b16 a[144:145], v138 offset:0
    ds_read_b64_tr_b16 a[146:147], v138 offset:768
    v_mfma_f32_16x16x32_bf16 v[200:203], a[120:123], v[144:147], 0
    ds_read_b64_tr_b16 a[168:169], v138 offset:32
    ds_read_b64_tr_b16 a[170:171], v138 offset:800
    v_mfma_f32_16x16x32_bf16 v[200:203], a[124:127], v[152:155], v[200:203]
    ds_read_b64_tr_b16 a[192:193], v138 offset:64
    ds_read_b64_tr_b16 a[194:195], v138 offset:832
    v_mfma_f32_16x16x32_bf16 v[204:207], a[0:3], v[144:147], 0
    s_waitcnt lgkmcnt(7)
    ds_write_b128 v156, v[120:123] offset:16
    v_mfma_f32_16x16x32_bf16 v[188:191], a[80:83], v[184:187], v[188:191]
    buffer_load_dwordx4 v124, s[40:43], s4 offen offset:1024 lds
    v_fmac_f32 v148, v134, v134
    v_mfma_f32_16x16x32_bf16 v[188:191], a[84:87], v[168:171], v[188:191]
    v_fmac_f32 v148, v135, v135
    v_fmac_f32 v148, v160, v160
    v_mfma_f32_16x16x32_bf16 v[188:191], a[88:91], v[172:175], v[188:191]
    ds_write_b64 v156, v[120:121] offset:56
    v_mfma_f32_16x16x32_bf16 v[188:191], a[92:95], v[180:183], v[188:191]
    s_waitcnt lgkmcnt(6)
    v_fmac_f32 v148, v161, v161
    v_fmac_f32 v148, v162, v162
    v_mfma_f32_16x16x32_bf16 v[196:199], a[104:107], v[184:187], v[196:199]
    s_waitcnt lgkmcnt(4)
    buffer_load_dwordx4 v125, s[40:43], s4 offen offset:2048 lds
    v_fmac_f32 v148, v163, v163
    v_mfma_f32_16x16x32_bf16 v[196:199], a[108:111], v[168:171], v[196:199]
    s_add_u32 m0, s68, 0
    ds_write_b64 v156, v[120:121] offset:64
    v_mfma_f32_16x16x32_bf16 v[196:199], a[112:115], v[172:175], v[196:199]
    s_add_u32 s4, s69, 148224
    v_fma_f32 v117, v112, v112, s32
    v_fmac_f32 v117, v113, v113
    v_mfma_f32_16x16x32_bf16 v[196:199], a[116:119], v[180:183], v[196:199]
    s_waitcnt lgkmcnt(2)
    v_fmac_f32 v117, v114, v114
    v_fmac_f32 v117, v115, v115
    v_mfma_f32_16x16x32_bf16 v[200:203], a[128:131], v[184:187], v[200:203]
    s_waitcnt vmcnt(6)
    buffer_load_dwordx4 v116, s[40:43], s4 offen lds
    ds_read_b64_tr_b16 a[148:149], v138 offset:3072
    v_mfma_f32_16x16x32_bf16 v[200:203], a[132:135], v[168:171], v[200:203]
    ds_read_b64_tr_b16 a[150:151], v138 offset:3840
    ds_read_b64_tr_b16 a[172:173], v138 offset:3104
    v_mfma_f32_16x16x32_bf16 v[200:203], a[136:139], v[172:175], v[200:203]
    ds_read_b64_tr_b16 a[174:175], v138 offset:3872
    ds_read_b64_tr_b16 a[196:197], v138 offset:3136
    v_mfma_f32_16x16x32_bf16 v[200:203], a[140:143], v[180:183], v[200:203]
    ds_read_b64_tr_b16 a[198:199], v138 offset:3904
    v_fmac_f32 v117, v128, v128
    v_mfma_f32_16x16x32_bf16 v[204:207], a[4:7], v[152:155], v[204:207]
    v_fmac_f32 v117, v129, v129
    v_fmac_f32 v117, v130, v130
    v_mfma_f32_16x16x32_bf16 v[204:207], a[8:11], v[184:187], v[204:207]
    buffer_load_dwordx4 v124, s[40:43], s4 offen offset:1024 lds
    v_fmac_f32 v117, v131, v131
    v_mfma_f32_16x16x32_bf16 v[204:207], a[12:15], v[168:171], v[204:207]
    v_fmac_f32 v117, v164, v164
    v_fmac_f32 v117, v165, v165
    v_mfma_f32_16x16x32_bf16 v[204:207], a[16:19], v[172:175], v[204:207]
    v_fmac_f32 v117, v166, v166
    v_fmac_f32 v117, v167, v167
    v_mfma_f32_16x16x32_bf16 v[204:207], a[20:23], v[180:183], v[204:207]
    s_waitcnt lgkmcnt(5)
    v_cvt_pk_bf16_f32 v38, v117, v148
    v_fma_f32 v148, v188, v188, s32
    v_mfma_f32_16x16x32_bf16 v[208:211], a[24:27], v[144:147], 0
    s_waitcnt lgkmcnt(3)
    v_fmac_f32 v148, v189, v189
    v_fmac_f32 v148, v190, v190
    v_mfma_f32_16x16x16_bf16 v[220:223], v[32:33], v[38:39], 0
    s_waitcnt lgkmcnt(1)
    buffer_load_dwordx4 v125, s[40:43], s4 offen offset:2048 lds
    v_fmac_f32 v148, v191, v191
    v_mfma_f32_16x16x32_bf16 v[208:211], a[28:31], v[152:155], v[208:211]
    s_add_u32 m0, s68, 3072
    v_fmac_f32 v148, v196, v196
    v_fmac_f32 v148, v197, v197
    v_mfma_f32_16x16x32_bf16 v[208:211], a[32:35], v[184:187], v[208:211]
    s_add_u32 s4, s69, 185088
    v_rsq_f32 v221, v221
    v_mfma_f32_16x16x32_bf16 v[208:211], a[36:39], v[168:171], v[208:211]
    s_waitcnt vmcnt(6)
    ds_read_b64_tr_b16 a[152:153], v138 offset:6144
    ds_read_b64_tr_b16 a[154:155], v138 offset:6912
    v_mfma_f32_16x16x32_bf16 v[208:211], a[40:43], v[172:175], v[208:211]
    s_waitcnt lgkmcnt(2)
    ds_read_b64_tr_b16 a[176:177], v138 offset:6176
    buffer_load_dwordx4 v116, s[40:43], s4 offen lds
    v_mfma_f32_16x16x32_bf16 v[208:211], a[44:47], v[180:183], v[208:211]
    ds_read_b64_tr_b16 a[178:179], v138 offset:6944
    ds_read_b64_tr_b16 a[200:201], v138 offset:6208
    v_mfma_f32_16x16x32_bf16 v[228:231], a[48:51], v[144:147], 0
    ds_read_b64_tr_b16 a[202:203], v138 offset:6976
    ds_read_b128 v[212:215], v0 offset:20480
    v_mfma_f32_16x16x32_bf16 v[228:231], a[52:55], v[152:155], v[228:231]
    ds_read_b128 v[176:179], v1 offset:20480
    ds_read_b128 v[216:219], v0 offset:20608
    v_mfma_f32_16x16x32_bf16 v[228:231], a[56:59], v[184:187], v[228:231]
    ds_read_b128 v[120:123], v1 offset:20608
    ds_read_b128 v[240:243], v0 offset:20736
    v_mfma_f32_16x16x32_bf16 v[228:231], a[60:63], v[168:171], v[228:231]
    buffer_load_dwordx4 v124, s[40:43], s4 offen offset:1024 lds
    ds_read_b128 v[224:227], v1 offset:20736
    v_mfma_f32_16x16x32_bf16 v[228:231], a[64:67], v[172:175], v[228:231]
    v_rsq_f32 v220, v220
    v_mfma_f32_16x16x32_bf16 v[228:231], a[68:71], v[180:183], v[228:231]
    v_mul_f32 v220, s31, v220
    v_mul_f32 v108, v221, v108
    v_mul_f32 v109, v221, v109
    v_cvt_pk_bf16_f32 v144, v108, v109
    v_mul_f32 v110, v221, v110
    v_mul_f32 v111, v221, v111
    v_cvt_pk_bf16_f32 v145, v110, v111
    buffer_load_dwordx4 v125, s[40:43], s4 offen offset:2048 lds
    s_waitcnt lgkmcnt(5)
    v_mfma_f32_16x16x32_bf16 v[192:195], a[72:75], v[212:215], 0
    s_waitcnt lgkmcnt(4)
    v_mul_f32 v132, v221, v132
    v_mul_f32 v133, v221, v133
    v_mfma_f32_16x16x32_bf16 v[192:195], a[76:79], v[176:179], v[192:195]
    s_waitcnt lgkmcnt(2)
    v_cvt_pk_bf16_f32 v146, v132, v133
    v_mul_f32 v134, v221, v134
    v_mfma_f32_16x16x32_bf16 v[192:195], a[80:83], v[216:219], v[192:195]
    s_add_u32 m0, s28, 8192
    v_mul_f32 v135, v221, v135
    v_cvt_pk_bf16_f32 v147, v134, v135
    v_mfma_f32_16x16x32_bf16 v[192:195], a[84:87], v[120:123], v[192:195]
    s_waitcnt vmcnt(6)
    ds_read_b64_tr_b16 a[156:157], v138 offset:9216
    buffer_load_dwordx4 v12, s[8:11], s25 offen nt lds
    v_mfma_f32_16x16x32_bf16 v[152:155], a[96:99], v[212:215], 0
    s_waitcnt lgkmcnt(1)
    ds_read_b64_tr_b16 a[158:159], v138 offset:9984
    ds_read_b64_tr_b16 a[180:181], v138 offset:9248
    v_mfma_f32_16x16x32_bf16 v[192:195], a[88:91], v[240:243], v[192:195]
    s_add_u32 m0, s28, 12288
    ds_read_b64_tr_b16 a[182:183], v138 offset:10016
    ds_read_b64_tr_b16 a[204:205], v138 offset:9280
    v_mfma_f32_16x16x32_bf16 v[192:195], a[92:95], v[224:227], v[192:195]
    ds_read_b64_tr_b16 a[206:207], v138 offset:10048
    v_mul_f32 v160, v221, v160
    v_mfma_f32_16x16x32_bf16 v[152:155], a[100:103], v[176:179], v[152:155]
    ds_write_b128 v149, v[144:147]
    v_mfma_f32_16x16x32_bf16 v[152:155], a[104:107], v[216:219], v[152:155]
    buffer_load_dwordx4 v13, s[8:11], s25 offen nt lds
    v_mul_f32 v161, v221, v161
    v_mfma_f32_16x16x32_bf16 v[152:155], a[108:111], v[120:123], v[152:155]
    s_add_u32 m0, s29, 0
    v_cvt_pk_bf16_f32 v170, v160, v161
    v_mul_f32 v162, v221, v162
    v_mfma_f32_16x16x32_bf16 v[152:155], a[112:115], v[240:243], v[152:155]
    s_waitcnt lgkmcnt(6)
    v_mul_f32 v163, v221, v163
    v_cvt_pk_bf16_f32 v171, v162, v163
    v_mfma_f32_16x16x32_bf16 v[152:155], a[116:119], v[224:227], v[152:155]
    s_waitcnt lgkmcnt(4)
    ds_write_b64 v149, v[170:171] offset:48
    v_mfma_f32_16x16x32_bf16 v[144:147], a[120:123], v[212:215], 0
    s_waitcnt lgkmcnt(3)
    buffer_load_dwordx4 v14, s[8:11], s25 offen nt lds
    v_mul_f32 v112, v220, v112
    v_mfma_f32_16x16x32_bf16 v[144:147], a[124:127], v[176:179], v[144:147]
    s_add_u32 m0, s28, 65536
    v_mul_f32 v113, v220, v113
    v_cvt_pk_bf16_f32 v168, v112, v113
    v_mfma_f32_16x16x32_bf16 v[144:147], a[128:131], v[216:219], v[144:147]
    s_cmp_lt_u32 1, s17
    v_mul_f32 v114, v220, v114
    v_mul_f32 v115, v220, v115
    v_mfma_f32_16x16x32_bf16 v[144:147], a[132:135], v[120:123], v[144:147]
    s_cselect_b32 s10, s36, 0
    v_cvt_pk_bf16_f32 v169, v114, v115
    v_mul_f32 v128, v220, v128
    v_mfma_f32_16x16x32_bf16 v[144:147], a[136:139], v[240:243], v[144:147]
    s_waitcnt lgkmcnt(1)
    s_waitcnt vmcnt(6)
    ds_read_b64_tr_b16 a[160:161], v138 offset:0
    v_mfma_f32_16x16x32_bf16 v[144:147], a[140:143], v[224:227], v[144:147]
    ds_read_b64_tr_b16 a[162:163], v138 offset:768
    ds_read_b64_tr_b16 a[184:185], v138 offset:32
    v_mfma_f32_16x16x32_bf16 v[124:127], a[0:3], v[212:215], 0
    ds_read_b64_tr_b16 a[186:187], v138 offset:800
    ds_read_b64_tr_b16 a[208:209], v138 offset:64
    v_mfma_f32_16x16x32_bf16 v[124:127], a[4:7], v[176:179], v[124:127]
    ds_read_b64_tr_b16 a[210:211], v138 offset:832
    v_mul_f32 v129, v220, v129
    v_mfma_f32_16x16x32_bf16 v[124:127], a[8:11], v[216:219], v[124:127]
    v_cvt_pk_bf16_f32 v170, v128, v129
    v_mul_f32 v130, v220, v130
    v_mfma_f32_16x16x32_bf16 v[124:127], a[12:15], v[120:123], v[124:127]
    v_mul_f32 v131, v220, v131
    v_cvt_pk_bf16_f32 v171, v130, v131
    v_mfma_f32_16x16x32_bf16 v[124:127], a[16:19], v[240:243], v[124:127]
    ds_write_b128 v149, v[168:171] offset:32
    v_mfma_f32_16x16x32_bf16 v[124:127], a[20:23], v[224:227], v[124:127]
    s_waitcnt lgkmcnt(6)
    v_mul_f32 v164, v220, v164
    v_mul_f32 v165, v220, v165
    v_mfma_f32_16x16x32_bf16 v[180:183], a[24:27], v[212:215], 0
    s_waitcnt lgkmcnt(4)
    v_cvt_pk_bf16_f32 v168, v164, v165
    v_mul_f32 v166, v220, v166
    v_mfma_f32_16x16x32_bf16 v[180:183], a[28:31], v[176:179], v[180:183]
    s_waitcnt lgkmcnt(2)
    v_mul_f32 v167, v220, v167
    v_cvt_pk_bf16_f32 v169, v166, v167
    v_mfma_f32_16x16x32_bf16 v[180:183], a[32:35], v[216:219], v[180:183]
    s_waitcnt lgkmcnt(1)
    ds_write_b64 v149, v[168:169] offset:72
    v_mfma_f32_16x16x32_bf16 v[180:183], a[36:39], v[120:123], v[180:183]
    v_mul_f32 v108, v112, v108
    v_fmac_f32 v108, v113, v109
    v_mfma_f32_16x16x32_bf16 v[180:183], a[40:43], v[240:243], v[180:183]
    v_fmac_f32 v108, v114, v110
    s_waitcnt vmcnt(3)
    v_mfma_f32_16x16x32_bf16 v[180:183], a[44:47], v[224:227], v[180:183]
    ds_read_b64_tr_b16 a[164:165], v138 offset:3072
    ds_read_b64_tr_b16 a[166:167], v138 offset:3840
    v_mfma_f32_16x16x32_bf16 v[220:223], a[48:51], v[212:215], 0
    ds_read_b64_tr_b16 a[188:189], v138 offset:3104
    ds_read_b64_tr_b16 a[190:191], v138 offset:3872
    v_mfma_f32_16x16x32_bf16 v[220:223], a[52:55], v[176:179], v[220:223]
    ds_read_b64_tr_b16 a[212:213], v138 offset:3136
    ds_read_b64_tr_b16 a[214:215], v138 offset:3904
    v_mfma_f32_16x16x32_bf16 v[220:223], a[56:59], v[216:219], v[220:223]
    v_fmac_f32 v108, v115, v111
    v_fmac_f32 v108, v128, v132
    v_mfma_f32_16x16x32_bf16 v[220:223], a[60:63], v[120:123], v[220:223]
    ds_read_b128 v[112:115], v118 offset:0
    v_fmac_f32 v108, v129, v133
    v_mfma_f32_16x16x32_bf16 v[220:223], a[64:67], v[240:243], v[220:223]
    ds_read_b128 v[136:139], v140 offset:0
    v_fmac_f32 v108, v130, v134
    v_mfma_f32_16x16x32_bf16 v[220:223], a[68:71], v[224:227], v[220:223]
    ds_read_b128 v[168:171], v118 offset:128
    v_fmac_f32 v108, v131, v135
    v_mfma_f32_16x16x32_bf16 v[128:131], v[212:215], a[144:147], 0
    ds_read_b128 v[132:135], v140 offset:128
    v_fmac_f32 v108, v164, v160
    v_mfma_f32_16x16x32_bf16 v[128:131], v[176:179], a[148:151], v[128:131]
    s_waitcnt lgkmcnt(8)
    ds_read_b128 v[172:175], v118 offset:256
    v_fmac_f32 v108, v165, v161
    v_mfma_f32_16x16x32_bf16 v[128:131], v[216:219], a[152:155], v[128:131]
    s_waitcnt lgkmcnt(7)
    ds_read_b128 v[184:187], v140 offset:256
    v_fmac_f32 v108, v166, v162
    v_mfma_f32_16x16x32_bf16 v[128:131], v[120:123], a[156:159], v[128:131]
    s_waitcnt lgkmcnt(6)
    v_fmac_f32 v108, v167, v163
    v_mov_b32 v149, v108
    v_mfma_f32_16x16x32_bf16 v[128:131], v[240:243], a[160:163], v[128:131]
    s_barrier
    buffer_load_dwordx4 v10, s[8:11], s24 offen nt lds
    v_fmac_f32 v148, v198, v198
    v_mfma_f32_16x16x32_bf16 v[128:131], v[224:227], a[164:167], v[128:131]
    s_waitcnt lgkmcnt(5)
    v_permlane32_swap_b32 v108, v149
    v_mfma_f32_16x16x32_bf16 v[160:163], v[112:115], a[144:147], 0
    s_waitcnt lgkmcnt(4)
    v_add_f32 v108, v108, v149
    v_mov_b32 v149, v108
    v_mfma_f32_16x16x32_bf16 v[160:163], v[136:139], a[148:151], v[160:163]
    s_waitcnt lgkmcnt(3)
    v_permlane16_swap_b32 v108, v149
    v_mfma_f32_16x16x32_bf16 v[160:163], v[168:171], a[152:155], v[160:163]
    s_waitcnt lgkmcnt(2)
    v_add_f32 v108, v108, v149
    v_add_f32 v108, s39, v108
    v_mfma_f32_16x16x32_bf16 v[160:163], v[132:135], a[156:159], v[160:163]
    s_waitcnt lgkmcnt(1)
    v_mov_b32 v109, v159
    v_mov_b32 v110, v159
    v_mfma_f32_16x16x32_bf16 v[160:163], v[172:175], a[160:163], v[160:163]
    s_waitcnt lgkmcnt(0)
    v_mov_b32 v111, v159
    v_cndmask_b32 v108, v159, v108, s[86:87]
    v_mfma_f32_16x16x32_bf16 v[160:163], v[184:187], a[164:167], v[160:163]
    s_add_u32 m0, s28, 69632
    ds_write_b128 v150, v[108:111] offset:192
    v_mfma_f32_16x16x32_bf16 v[108:111], v[112:115], a[168:171], 0
    buffer_load_dwordx4 v11, s[8:11], s24 offen nt lds
    v_fmac_f32 v148, v199, v199
    v_mfma_f32_16x16x32_bf16 v[108:111], v[136:139], a[172:175], v[108:111]
    s_add_u32 m0, s28, 73728
    v_fmac_f32 v148, v200, v200
    v_fmac_f32 v148, v201, v201
    v_mfma_f32_16x16x32_bf16 v[108:111], v[168:171], a[176:179], v[108:111]
    v_fmac_f32 v148, v202, v202
    v_fmac_f32 v148, v203, v203
    v_mfma_f32_16x16x32_bf16 v[108:111], v[132:135], a[180:183], v[108:111]
    ds_read_b128 v[164:167], v118 offset:6144
    v_fma_f32 v149, v204, v204, s32
    v_mfma_f32_16x16x32_bf16 v[108:111], v[172:175], a[184:187], v[108:111]
    ds_read_b128 v[232:235], v140 offset:6144
    buffer_load_dwordx4 v12, s[8:11], s24 offen nt lds
    v_mfma_f32_16x16x32_bf16 v[108:111], v[184:187], a[188:191], v[108:111]
    s_add_u32 m0, s28, 77824
    ds_read_b128 v[236:239], v118 offset:6272
    v_fmac_f32 v149, v205, v205
    v_mfma_f32_16x16x32_bf16 v[244:247], v[112:115], a[192:195], 0
    ds_read_b128 v[112:115], v140 offset:6272
    v_fmac_f32 v149, v206, v206
    v_mfma_f32_16x16x32_bf16 v[244:247], v[136:139], a[196:199], v[244:247]
    ds_read_b128 v[136:139], v118 offset:6400
    v_fmac_f32 v149, v207, v207
    v_mfma_f32_16x16x32_bf16 v[244:247], v[168:171], a[200:203], v[244:247]
    ds_read_b128 v[116:119], v140 offset:6400
    v_fmac_f32 v149, v208, v208
    v_mfma_f32_16x16x32_bf16 v[244:247], v[132:135], a[204:207], v[244:247]
    buffer_load_dwordx4 v13, s[8:11], s24 offen nt lds
    v_fmac_f32 v149, v209, v209
    v_mfma_f32_16x16x32_bf16 v[244:247], v[172:175], a[208:211], v[244:247]
    s_add_u32 m0, s71, 0
    v_fmac_f32 v149, v210, v210
    v_fmac_f32 v149, v211, v211
    v_mfma_f32_16x16x32_bf16 v[244:247], v[184:187], a[212:215], v[244:247]
    s_waitcnt lgkmcnt(5)
    v_fmac_f32 v149, v228, v228
    v_fmac_f32 v149, v229, v229
    v_mfma_f32_16x16x32_bf16 v[132:135], v[164:167], a[144:147], 0
    s_waitcnt lgkmcnt(4)
    v_fmac_f32 v149, v230, v230
    v_fmac_f32 v149, v231, v231
    v_mfma_f32_16x16x32_bf16 v[132:135], v[232:235], a[148:151], v[132:135]
    s_waitcnt lgkmcnt(3)
    v_cvt_pk_bf16_f32 v38, v149, v148
    v_fma_f32 v148, v192, v192, s32
    v_mfma_f32_16x16x32_bf16 v[132:135], v[236:239], a[152:155], v[132:135]
    s_waitcnt lgkmcnt(2)
    buffer_load_dwordx4 v14, s[8:11], s24 offen nt lds
    v_fmac_f32 v148, v193, v193
    v_mfma_f32_16x16x16_bf16 v[140:143], v[32:33], v[38:39], 0
    s_waitcnt lgkmcnt(1)
    v_fmac_f32 v148, v194, v194
    v_fmac_f32 v148, v195, v195
    v_mfma_f32_16x16x32_bf16 v[132:135], v[112:115], a[156:159], v[132:135]
    s_waitcnt lgkmcnt(0)
    v_fmac_f32 v148, v152, v152
    v_fmac_f32 v148, v153, v153
    v_mfma_f32_16x16x32_bf16 v[132:135], v[136:139], a[160:163], v[132:135]
    v_rsq_f32 v141, v141
    v_mfma_f32_16x16x32_bf16 v[132:135], v[116:119], a[164:167], v[132:135]
    v_rsq_f32 v140, v140
    v_mfma_f32_16x16x32_bf16 v[168:171], v[164:167], a[168:171], 0
    v_mul_f32 v140, s31, v140
    v_mul_f32 v188, v141, v188
    v_mfma_f32_16x16x32_bf16 v[168:171], v[232:235], a[172:175], v[168:171]
    v_mul_f32 v189, v141, v189
    v_cvt_pk_bf16_f32 v172, v188, v189
    v_mfma_f32_16x16x32_bf16 v[168:171], v[236:239], a[176:179], v[168:171]
    v_mul_f32 v190, v141, v190
    v_mul_f32 v191, v141, v191
    v_mfma_f32_16x16x32_bf16 v[168:171], v[112:115], a[180:183], v[168:171]
    v_cvt_pk_bf16_f32 v173, v190, v191
    v_mul_f32 v196, v141, v196
    v_mfma_f32_16x16x32_bf16 v[168:171], v[136:139], a[184:187], v[168:171]
    v_mul_f32 v197, v141, v197
    v_cvt_pk_bf16_f32 v174, v196, v197
    v_mfma_f32_16x16x32_bf16 v[168:171], v[116:119], a[188:191], v[168:171]
    v_mul_f32 v198, v141, v198
    v_mul_f32 v199, v141, v199
    v_mfma_f32_16x16x32_bf16 v[184:187], v[164:167], a[192:195], 0
    v_cvt_pk_bf16_f32 v175, v198, v199
    v_mul_f32 v200, v141, v200
    v_mfma_f32_16x16x32_bf16 v[184:187], v[232:235], a[196:199], v[184:187]
    ds_write_b128 v156, v[172:175]
    v_mfma_f32_16x16x32_bf16 v[184:187], v[236:239], a[200:203], v[184:187]
    v_mul_f32 v201, v141, v201
    v_cvt_pk_bf16_f32 v166, v200, v201
    v_mfma_f32_16x16x32_bf16 v[184:187], v[112:115], a[204:207], v[184:187]
    v_mul_f32 v202, v141, v202
    v_mul_f32 v203, v141, v203
    v_mfma_f32_16x16x32_bf16 v[184:187], v[136:139], a[208:211], v[184:187]
    v_cvt_pk_bf16_f32 v167, v202, v203
    v_mul_f32 v204, v140, v204
    v_mfma_f32_16x16x32_bf16 v[184:187], v[116:119], a[212:215], v[184:187]
    ds_write_b64 v156, v[166:167] offset:48
    v_mul_f32 v205, v140, v205
    v_cvt_pk_bf16_f32 v112, v204, v205
    v_mul_f32 v206, v140, v206
    v_mul_f32 v207, v140, v207
    v_cvt_pk_bf16_f32 v113, v206, v207
    v_mul_f32 v208, v140, v208
    v_mul_f32 v209, v140, v209
    v_cvt_pk_bf16_f32 v114, v208, v209
    v_mul_f32 v210, v140, v210
    v_mul_f32 v211, v140, v211
    v_cvt_pk_bf16_f32 v115, v210, v211
    v_mul_f32 v228, v140, v228
    v_mul_f32 v229, v140, v229
    v_cvt_pk_bf16_f32 v164, v228, v229
    v_mul_f32 v230, v140, v230
    v_mul_f32 v231, v140, v231
    v_cvt_pk_bf16_f32 v165, v230, v231
    v_mul_f32 v116, v204, v188
    v_fmac_f32 v116, v205, v189
    v_fmac_f32 v116, v206, v190
    v_fmac_f32 v116, v207, v191
    v_fmac_f32 v116, v208, v196
    v_fmac_f32 v116, v209, v197
    v_fmac_f32 v116, v210, v198
    v_fmac_f32 v116, v211, v199
    v_fmac_f32 v116, v228, v200
    v_fmac_f32 v116, v229, v201
    v_fmac_f32 v116, v230, v202
    v_fmac_f32 v116, v231, v203
    v_mov_b32 v149, v116
    ds_write_b128 v156, v[112:115] offset:32
    v_fmac_f32 v148, v154, v154
    v_permlane32_swap_b32 v116, v149
    v_add_f32 v116, v116, v149
    v_mov_b32 v149, v116
    v_fmac_f32 v148, v155, v155
    v_fmac_f32 v148, v144, v144
    v_permlane16_swap_b32 v116, v149
    v_add_f32 v116, v116, v149
    v_add_f32 v116, s39, v116
    v_mov_b32 v117, v159
    v_mov_b32 v118, v159
    v_mov_b32 v119, v159
    v_cndmask_b32 v116, v159, v116, s[86:87]
    ds_write_b128 v157, v[116:119] offset:192
    v_fmac_f32 v148, v145, v145
    v_fmac_f32 v148, v146, v146
    v_fmac_f32 v148, v147, v147
    v_fma_f32 v149, v124, v124, s32
    v_fmac_f32 v149, v125, v125
    v_fmac_f32 v149, v126, v126
    v_fmac_f32 v149, v127, v127
    ds_write_b64 v156, v[164:165] offset:72
    v_fmac_f32 v149, v180, v180
    v_fmac_f32 v149, v181, v181
    v_fmac_f32 v149, v182, v182
    v_fmac_f32 v149, v183, v183
    v_fmac_f32 v149, v220, v220
    v_fmac_f32 v149, v221, v221
    v_fmac_f32 v149, v222, v222
    v_fmac_f32 v149, v223, v223
    v_cvt_pk_bf16_f32 v38, v149, v148
    v_cvt_pk_bf16_f32 v160, v160, v160
    ds_write_b32 v151, v160 offset:0
    v_cvt_pk_bf16_f32 v161, v161, v161
    ds_write_b32 v151, v161 offset:272
    v_cvt_pk_bf16_f32 v162, v162, v162
    ds_write_b32 v151, v162 offset:544
    v_cvt_pk_bf16_f32 v163, v163, v163
    ds_write_b32 v151, v163 offset:816
    v_cvt_pk_bf16_f32 v108, v108, v108
    ds_write_b32 v151, v108 offset:64
    v_cvt_pk_bf16_f32 v109, v109, v109
    ds_write_b32 v151, v109 offset:336
    v_cvt_pk_bf16_f32 v110, v110, v110
    ds_write_b32 v151, v110 offset:608
    v_cvt_pk_bf16_f32 v111, v111, v111
    ds_write_b32 v151, v111 offset:880
    v_cvt_pk_bf16_f32 v244, v244, v244
    ds_write_b32 v151, v244 offset:128
    v_cvt_pk_bf16_f32 v245, v245, v245
    ds_write_b32 v151, v245 offset:400
    v_cvt_pk_bf16_f32 v246, v246, v246
    ds_write_b32 v151, v246 offset:672
    v_cvt_pk_bf16_f32 v247, v247, v247
    ds_write_b32 v151, v247 offset:944
    v_cvt_pk_bf16_f32 v132, v132, v132
    ds_write_b32 v158, v132 offset:0
    v_cvt_pk_bf16_f32 v133, v133, v133
    ds_write_b32 v158, v133 offset:272
    v_cvt_pk_bf16_f32 v134, v134, v134
    ds_write_b32 v158, v134 offset:544
    v_cvt_pk_bf16_f32 v135, v135, v135
    ds_write_b32 v158, v135 offset:816
    v_cvt_pk_bf16_f32 v168, v168, v168
    ds_write_b32 v158, v168 offset:64
    v_cvt_pk_bf16_f32 v169, v169, v169
    ds_write_b32 v158, v169 offset:336
    v_cvt_pk_bf16_f32 v170, v170, v170
    ds_write_b32 v158, v170 offset:608
    v_cvt_pk_bf16_f32 v171, v171, v171
    ds_write_b32 v158, v171 offset:880
    v_cvt_pk_bf16_f32 v184, v184, v184
    ds_write_b32 v158, v184 offset:128
    v_cvt_pk_bf16_f32 v185, v185, v185
    ds_write_b32 v158, v185 offset:400
    v_cvt_pk_bf16_f32 v186, v186, v186
    ds_write_b32 v158, v186 offset:672
    v_cvt_pk_bf16_f32 v187, v187, v187
    ds_write_b32 v158, v187 offset:944
    s_waitcnt vmcnt(5)
    s_barrier
L_go:
    s_waitcnt lgkmcnt(0)
    s_cmp_gt_u32 s62, 0x42000000
    s_cbranch_scc1 L_safe
    s_cmp_eq_u32 s16, 1
    s_cbranch_scc1 L_loop_fast1
    s_cmp_eq_u32 s16, 2
    s_cbranch_scc1 L_loop_fast2
    s_cmp_eq_u32 s16, 3
    s_cbranch_scc1 L_loop_fast3
    s_branch L_loop_fast0
.p2align 6
L_loop_fast0:
    v_mfma_f32_16x16x16_bf16 v[164:167], v[32:33], v[38:39], 0
    s_cmp_ge_u32 s18, 2
    ds_read_b128 v[204:207], v2 offset:18432
    ds_read_b128 v[108:111], v2 offset:19456
    v_mfma_f32_16x16x32_bf16 v[156:159], v[212:215], a[168:171], 0
    s_cselect_b32 s14, s36, 0
    ds_read_b128 v[168:171], v0 offset:26624
    ds_read_b128 v[132:135], v1 offset:26624
    v_mfma_f32_16x16x32_bf16 v[156:159], v[176:179], a[172:175], v[156:159]
    s_add_u32 s34, s18, 2
    ds_read_b128 v[160:163], v0 offset:26752
    ds_read_b128 v[112:115], v1 offset:26752
    v_mfma_f32_16x16x32_bf16 v[156:159], v[216:219], a[176:179], v[156:159]
    s_cmp_lt_u32 s34, s17
    ds_read_b128 v[172:175], v0 offset:26880
    v_cvt_pk_bf16_f32 v128, v128, v129
    v_mfma_f32_16x16x32_bf16 v[156:159], v[120:123], a[180:183], v[156:159]
    s_cselect_b32 s10, s36, 0
    ds_read_b128 v[196:199], v1 offset:26880
    v_cvt_pk_bf16_f32 v129, v130, v131
    v_mfma_f32_16x16x32_bf16 v[156:159], v[240:243], a[184:187], v[156:159]
    s_add_u32 m0, s28, 0
    v_rsq_f32 v165, v165
    v_mfma_f32_16x16x32_bf16 v[156:159], v[224:227], a[188:191], v[156:159]
    v_rsq_f32 v164, v164
    v_mfma_f32_16x16x32_bf16 v[136:139], v[212:215], a[192:195], 0
    v_mul_f32 v164, s31, v164
    v_mul_f32 v192, v165, v192
    v_mfma_f32_16x16x32_bf16 v[136:139], v[176:179], a[196:199], v[136:139]
    s_waitcnt lgkmcnt(6)
    v_mul_f32 v193, v165, v193
    v_cvt_pk_bf16_f32 v212, v192, v193
    v_mfma_f32_16x16x32_bf16 v[176:179], v[32:35], v[204:207], 0
    s_waitcnt lgkmcnt(4)
    v_cvt_pk_bf16_f32 v156, v156, v157
    v_cvt_pk_bf16_f32 v157, v158, v159
    v_mfma_f32_16x16x32_bf16 v[176:179], v[32:35], v[108:111], v[176:179]
    s_waitcnt lgkmcnt(2)
    v_mul_f32 v194, v165, v194
    v_mul_f32 v195, v165, v195
    v_mfma_f32_16x16x32_bf16 v[136:139], v[216:219], a[200:203], v[136:139]
    s_waitcnt lgkmcnt(1)
    v_cvt_pk_bf16_f32 v213, v194, v195
    v_mul_f32 v152, v165, v152
    v_mfma_f32_16x16x32_bf16 v[136:139], v[120:123], a[204:207], v[136:139]
    s_waitcnt lgkmcnt(0)
    v_mul_f32 v153, v165, v153
    v_cvt_pk_bf16_f32 v214, v152, v153
    v_mfma_f32_16x16x32_bf16 v[136:139], v[240:243], a[208:211], v[136:139]
    v_mul_f32 v154, v165, v154
    v_mul_f32 v155, v165, v155
    v_mfma_f32_16x16x32_bf16 v[136:139], v[224:227], a[212:215], v[136:139]
    v_cvt_pk_bf16_f32 v215, v154, v155
    v_mul_f32 v144, v165, v144
    v_mfma_f32_16x16x32_bf16 v[240:243], a[72:75], v[168:171], 0
    v_mul_f32 v145, v165, v145
    v_cvt_pk_bf16_f32 v194, v144, v145
    v_mfma_f32_16x16x32_bf16 v[240:243], a[76:79], v[132:135], v[240:243]
    v_mul_f32 v146, v165, v146
    v_mul_f32 v147, v165, v147
    v_mfma_f32_16x16x32_bf16 v[240:243], a[80:83], v[160:163], v[240:243]
    v_cvt_pk_bf16_f32 v144, v136, v137
    v_cvt_pk_bf16_f32 v145, v138, v139
    v_mfma_f32_16x16x32_bf16 v[240:243], a[84:87], v[112:115], v[240:243]
    v_cvt_pk_bf16_f32 v195, v146, v147
    v_mul_f32 v124, v164, v124
    v_mfma_f32_16x16x32_bf16 v[240:243], a[88:91], v[172:175], v[240:243]
    v_mul_f32 v125, v164, v125
    v_cvt_pk_bf16_f32 v204, v124, v125
    v_mfma_f32_16x16x32_bf16 v[240:243], a[92:95], v[196:199], v[240:243]
    v_mul_f32 v126, v164, v126
    v_mul_f32 v127, v164, v127
    v_mfma_f32_16x16x32_bf16 v[120:123], a[96:99], v[168:171], 0
    v_cvt_pk_bf16_f32 v205, v126, v127
    v_mul_f32 v180, v164, v180
    v_mfma_f32_16x16x32_bf16 v[120:123], a[100:103], v[132:135], v[120:123]
    v_mul_f32 v181, v164, v181
    v_cvt_pk_bf16_f32 v206, v180, v181
    v_mfma_f32_16x16x32_bf16 v[120:123], a[104:107], v[160:163], v[120:123]
    v_mul_f32 v182, v164, v182
    v_mul_f32 v183, v164, v183
    v_mfma_f32_16x16x32_bf16 v[120:123], a[108:111], v[112:115], v[120:123]
    v_cvt_pk_bf16_f32 v207, v182, v183
    v_mul_f32 v220, v164, v220
    v_mfma_f32_16x16x32_bf16 v[120:123], a[112:115], v[172:175], v[120:123]
    v_mul_f32 v221, v164, v221
    v_cvt_pk_bf16_f32 v192, v220, v221
    v_mfma_f32_16x16x32_bf16 v[120:123], a[116:119], v[196:199], v[120:123]
    v_mul_f32 v222, v164, v222
    v_mul_f32 v223, v164, v223
    v_mfma_f32_16x16x32_bf16 v[224:227], a[120:123], v[168:171], 0
    v_cvt_pk_bf16_f32 v193, v222, v223
    v_mul_f32 v130, 0x3baaaaab, v176
    v_mfma_f32_16x16x32_bf16 v[224:227], a[124:127], v[132:135], v[224:227]
    v_rsq_f32 v130, v130
    v_mfma_f32_16x16x32_bf16 v[224:227], a[128:131], v[160:163], v[224:227]
    v_mul_f32 v146, 0x3baaaaab, v177
    v_mul_f32 v108, 0x3baaaaab, v178
    v_mfma_f32_16x16x32_bf16 v[224:227], a[132:135], v[112:115], v[224:227]
    v_rsq_f32 v146, v146
    v_mfma_f32_16x16x32_bf16 v[224:227], a[136:139], v[172:175], v[224:227]
    v_rsq_f32 v108, v108
    v_mfma_f32_16x16x32_bf16 v[224:227], a[140:143], v[196:199], v[224:227]
    v_mul_f32 v140, v130, v140
    v_mul_f32 v141, v130, v141
    v_mfma_f32_16x16x32_bf16 v[136:139], a[0:3], v[168:171], 0
    v_cvt_pk_bf16_f32 v176, v140, v141
    v_mul_f32 v142, v130, v142
    v_mfma_f32_16x16x32_bf16 v[136:139], a[4:7], v[132:135], v[136:139]
    v_mul_f32 v143, v130, v143
    v_cvt_pk_bf16_f32 v177, v142, v143
    v_mfma_f32_16x16x32_bf16 v[136:139], a[8:11], v[160:163], v[136:139]
    v_mul_f32 v188, v130, v188
    v_mul_f32 v189, v130, v189
    v_mfma_f32_16x16x32_bf16 v[136:139], a[12:15], v[112:115], v[136:139]
    v_cvt_pk_bf16_f32 v178, v188, v189
    v_mul_f32 v190, v130, v190
    v_mfma_f32_16x16x32_bf16 v[136:139], a[16:19], v[172:175], v[136:139]
    v_mul_f32 v191, v130, v191
    v_cvt_pk_bf16_f32 v179, v190, v191
    v_mfma_f32_16x16x32_bf16 v[136:139], a[20:23], v[196:199], v[136:139]
    buffer_store_dwordx4 v[176:179], v15, s[12:15], s27 offen
    v_mul_f32 v244, v130, v244
    v_mul_f32 v245, v130, v245
    v_cvt_pk_bf16_f32 v158, v244, v245
    v_mul_f32 v246, v130, v246
    v_mfma_f32_16x16x32_bf16 v[188:191], a[24:27], v[168:171], 0
    v_mul_f32 v247, v130, v247
    v_cvt_pk_bf16_f32 v159, v246, v247
    v_mfma_f32_16x16x32_bf16 v[188:191], a[28:31], v[132:135], v[188:191]
    v_fma_f32 v147, v136, v136, s32
    v_fmac_f32 v147, v137, v137
    v_mfma_f32_16x16x32_bf16 v[188:191], a[32:35], v[160:163], v[188:191]
    v_fmac_f32 v147, v138, v138
    v_fmac_f32 v147, v139, v139
    v_mfma_f32_16x16x32_bf16 v[188:191], a[36:39], v[112:115], v[188:191]
    v_fma_f32 v130, v240, v240, s32
    v_fmac_f32 v130, v241, v241
    v_mfma_f32_16x16x32_bf16 v[188:191], a[40:43], v[172:175], v[188:191]
    v_fmac_f32 v130, v242, v242
    v_fmac_f32 v130, v243, v243
    v_mfma_f32_16x16x32_bf16 v[188:191], a[44:47], v[196:199], v[188:191]
    v_fmac_f32 v130, v120, v120
    v_fmac_f32 v130, v121, v121
    v_mfma_f32_16x16x32_bf16 v[244:247], a[48:51], v[168:171], 0
    v_fmac_f32 v130, v122, v122
    v_fmac_f32 v130, v123, v123
    v_mfma_f32_16x16x32_bf16 v[244:247], a[52:55], v[132:135], v[244:247]
    v_fmac_f32 v130, v224, v224
    v_fmac_f32 v130, v225, v225
    v_mfma_f32_16x16x32_bf16 v[244:247], a[56:59], v[160:163], v[244:247]
    v_fmac_f32 v147, v188, v188
    v_fmac_f32 v147, v189, v189
    v_mfma_f32_16x16x32_bf16 v[244:247], a[60:63], v[112:115], v[244:247]
    v_fmac_f32 v147, v190, v190
    v_fmac_f32 v147, v191, v191
    v_mfma_f32_16x16x32_bf16 v[244:247], a[64:67], v[172:175], v[244:247]
    v_fmac_f32 v130, v226, v226
    v_fmac_f32 v130, v227, v227
    v_mfma_f32_16x16x32_bf16 v[244:247], a[68:71], v[196:199], v[244:247]
    v_mul_f32 v116, v146, v116
    v_mul_f32 v117, v146, v117
    v_mfma_f32_16x16x32_bf16 v[180:183], v[168:171], a[144:147], 0
    v_cvt_pk_bf16_f32 v164, v116, v117
    v_mul_f32 v118, v146, v118
    v_mfma_f32_16x16x32_bf16 v[180:183], v[132:135], a[148:151], v[180:183]
    v_mul_f32 v119, v146, v119
    v_cvt_pk_bf16_f32 v165, v118, v119
    v_mfma_f32_16x16x32_bf16 v[180:183], v[160:163], a[152:155], v[180:183]
    v_fmac_f32 v147, v244, v244
    v_fmac_f32 v147, v245, v245
    v_mfma_f32_16x16x32_bf16 v[180:183], v[112:115], a[156:159], v[180:183]
    v_fmac_f32 v147, v246, v246
    v_fmac_f32 v147, v247, v247
    v_mfma_f32_16x16x32_bf16 v[180:183], v[172:175], a[160:163], v[180:183]
    ds_read_b128 v[176:179], v0 offset:32768
    buffer_store_dwordx2 v[158:159], v18, s[12:15], s27 offen
    v_cvt_pk_bf16_f32 v38, v147, v130
    v_mul_f32 v208, v146, v208
    v_mfma_f32_16x16x32_bf16 v[180:183], v[196:199], a[164:167], v[180:183]
    ds_read_b128 v[152:155], v1 offset:32768
    v_mul_f32 v209, v146, v209
    v_mfma_f32_16x16x16_bf16 v[248:251], v[32:33], v[38:39], 0
    v_cvt_pk_bf16_f32 v166, v208, v209
    v_mul_f32 v210, v146, v210
    v_mfma_f32_16x16x32_bf16 v[184:187], v[168:171], a[168:171], 0
    ds_read_b128 v[216:219], v0 offset:32896
    v_mul_f32 v211, v146, v211
    v_mfma_f32_16x16x32_bf16 v[184:187], v[132:135], a[172:175], v[184:187]
    ds_read_b128 v[220:223], v1 offset:32896
    v_cvt_pk_bf16_f32 v130, v180, v181
    v_mfma_f32_16x16x32_bf16 v[184:187], v[160:163], a[176:179], v[184:187]
    ds_read_b128 v[124:127], v0 offset:33024
    v_cvt_pk_bf16_f32 v131, v182, v183
    v_mfma_f32_16x16x32_bf16 v[184:187], v[112:115], a[180:183], v[184:187]
    ds_read_b128 v[116:119], v1 offset:33024
    v_cvt_pk_bf16_f32 v167, v210, v211
    v_mfma_f32_16x16x32_bf16 v[184:187], v[172:175], a[184:187], v[184:187]
    s_waitcnt lgkmcnt(5)
    v_rsq_f32 v249, v249
    v_mfma_f32_16x16x32_bf16 v[184:187], v[196:199], a[188:191], v[184:187]
    v_rsq_f32 v248, v248
    v_mfma_f32_16x16x32_bf16 v[236:239], v[168:171], a[192:195], 0
    s_waitcnt lgkmcnt(4)
    v_mul_f32 v248, s31, v248
    v_mul_f32 v228, v146, v228
    v_mfma_f32_16x16x32_bf16 v[236:239], v[132:135], a[196:199], v[236:239]
    v_mul_f32 v229, v146, v229
    v_cvt_pk_bf16_f32 v140, v228, v229
    v_mfma_f32_16x16x32_bf16 v[236:239], v[160:163], a[200:203], v[236:239]
    s_waitcnt lgkmcnt(3)
    v_cvt_pk_bf16_f32 v158, v184, v185
    v_cvt_pk_bf16_f32 v159, v186, v187
    v_mfma_f32_16x16x32_bf16 v[236:239], v[112:115], a[204:207], v[236:239]
    s_waitcnt lgkmcnt(2)
    v_mul_f32 v230, v146, v230
    v_mul_f32 v231, v146, v231
    v_mfma_f32_16x16x32_bf16 v[236:239], v[172:175], a[208:211], v[236:239]
    s_waitcnt lgkmcnt(1)
    v_cvt_pk_bf16_f32 v141, v230, v231
    v_mul_f32 v240, v249, v240
    v_mfma_f32_16x16x32_bf16 v[236:239], v[196:199], a[212:215], v[236:239]
    s_waitcnt lgkmcnt(0)
    v_mul_f32 v241, v249, v241
    v_cvt_pk_bf16_f32 v180, v240, v241
    v_mfma_f32_16x16x32_bf16 v[208:211], a[72:75], v[176:179], 0
    v_mul_f32 v242, v249, v242
    v_mul_f32 v243, v249, v243
    v_mfma_f32_16x16x32_bf16 v[208:211], a[76:79], v[152:155], v[208:211]
    v_cvt_pk_bf16_f32 v181, v242, v243
    v_cvt_pk_bf16_f32 v146, v236, v237
    v_mfma_f32_16x16x32_bf16 v[208:211], a[80:83], v[216:219], v[208:211]
    buffer_store_dwordx4 v[164:167], v16, s[12:15], s27 offen
    v_cvt_pk_bf16_f32 v147, v238, v239
    v_mul_f32 v120, v249, v120
    v_mul_f32 v121, v249, v121
    v_cvt_pk_bf16_f32 v182, v120, v121
    v_mfma_f32_16x16x32_bf16 v[208:211], a[84:87], v[220:223], v[208:211]
    v_mul_f32 v122, v249, v122
    v_mul_f32 v123, v249, v123
    v_mfma_f32_16x16x32_bf16 v[208:211], a[88:91], v[124:127], v[208:211]
    v_cvt_pk_bf16_f32 v183, v122, v123
    v_mul_f32 v224, v249, v224
    v_mfma_f32_16x16x32_bf16 v[208:211], a[92:95], v[116:119], v[208:211]
    v_mul_f32 v225, v249, v225
    v_cvt_pk_bf16_f32 v170, v224, v225
    v_mfma_f32_16x16x32_bf16 v[164:167], a[96:99], v[176:179], 0
    v_mul_f32 v226, v249, v226
    v_mul_f32 v227, v249, v227
    v_mfma_f32_16x16x32_bf16 v[164:167], a[100:103], v[152:155], v[164:167]
    v_cvt_pk_bf16_f32 v171, v226, v227
    v_mul_f32 v136, v248, v136
    v_mfma_f32_16x16x32_bf16 v[164:167], a[104:107], v[216:219], v[164:167]
    s_waitcnt vmcnt(3)
    v_mul_f32 v137, v248, v137
    v_cvt_pk_bf16_f32 v132, v136, v137
    v_mfma_f32_16x16x32_bf16 v[164:167], a[108:111], v[220:223], v[164:167]
    s_barrier
    v_mul_f32 v138, v248, v138
    v_mul_f32 v139, v248, v139
    v_mfma_f32_16x16x32_bf16 v[164:167], a[112:115], v[124:127], v[164:167]
    s_nop 0
    v_cvt_pk_bf16_f32 v133, v138, v139
    v_mul_f32 v188, v248, v188
    v_mfma_f32_16x16x32_bf16 v[164:167], a[116:119], v[116:119], v[164:167]
    s_nop 0
    v_mul_f32 v189, v248, v189
    v_cvt_pk_bf16_f32 v134, v188, v189
    v_mfma_f32_16x16x32_bf16 v[112:115], a[120:123], v[176:179], 0
    s_nop 0
    v_mul_f32 v190, v248, v190
    v_mul_f32 v191, v248, v191
    v_mfma_f32_16x16x32_bf16 v[112:115], a[124:127], v[152:155], v[112:115]
    v_cvt_pk_bf16_f32 v135, v190, v191
    v_mul_f32 v244, v248, v244
    v_mfma_f32_16x16x32_bf16 v[112:115], a[128:131], v[216:219], v[112:115]
    v_mul_f32 v245, v248, v245
    v_cvt_pk_bf16_f32 v168, v244, v245
    v_mfma_f32_16x16x32_bf16 v[112:115], a[132:135], v[220:223], v[112:115]
    v_mul_f32 v246, v248, v246
    v_mul_f32 v247, v248, v247
    v_mfma_f32_16x16x32_bf16 v[112:115], a[136:139], v[124:127], v[112:115]
    v_cvt_pk_bf16_f32 v169, v246, v247
    v_fma_f32 v142, v208, v208, s32
    v_mfma_f32_16x16x32_bf16 v[112:115], a[140:143], v[116:119], v[112:115]
    v_fmac_f32 v142, v209, v209
    v_fmac_f32 v142, v210, v210
    v_mfma_f32_16x16x32_bf16 v[188:191], a[0:3], v[176:179], 0
    v_fmac_f32 v142, v211, v211
    v_fmac_f32 v142, v164, v164
    v_mfma_f32_16x16x32_bf16 v[188:191], a[4:7], v[152:155], v[188:191]
    buffer_load_dwordx4 v10, s[8:11], s23 offen nt lds
    v_fmac_f32 v142, v165, v165
    v_mfma_f32_16x16x32_bf16 v[188:191], a[8:11], v[216:219], v[188:191]
    s_add_u32 m0, s28, 4096
    v_fmac_f32 v142, v166, v166
    v_fmac_f32 v142, v167, v167
    v_mfma_f32_16x16x32_bf16 v[188:191], a[12:15], v[220:223], v[188:191]
    v_fmac_f32 v142, v112, v112
    v_fmac_f32 v142, v113, v113
    v_mfma_f32_16x16x32_bf16 v[188:191], a[16:19], v[124:127], v[188:191]
    v_fmac_f32 v142, v114, v114
    v_fmac_f32 v142, v115, v115
    v_mfma_f32_16x16x32_bf16 v[188:191], a[20:23], v[116:119], v[188:191]
    v_mul_f32 v148, v108, v148
    v_mul_f32 v149, v108, v149
    v_mfma_f32_16x16x32_bf16 v[136:139], a[24:27], v[176:179], 0
    buffer_load_dwordx4 v11, s[8:11], s23 offen nt lds
    v_cvt_pk_bf16_f32 v160, v148, v149
    v_mfma_f32_16x16x32_bf16 v[136:139], a[28:31], v[152:155], v[136:139]
    s_add_u32 m0, s28, 8192
    v_mul_f32 v150, v108, v150
    v_fma_f32 v143, v188, v188, s32
    v_mfma_f32_16x16x32_bf16 v[136:139], a[32:35], v[216:219], v[136:139]
    v_fmac_f32 v143, v189, v189
    v_fmac_f32 v143, v190, v190
    v_mfma_f32_16x16x32_bf16 v[136:139], a[36:39], v[220:223], v[136:139]
    v_fmac_f32 v143, v191, v191
    v_mul_f32 v151, v108, v151
    v_mfma_f32_16x16x32_bf16 v[136:139], a[40:43], v[124:127], v[136:139]
    v_cvt_pk_bf16_f32 v161, v150, v151
    v_mul_f32 v200, v108, v200
    v_mfma_f32_16x16x32_bf16 v[136:139], a[44:47], v[116:119], v[136:139]
    buffer_load_dwordx4 v12, s[8:11], s23 offen nt lds
    v_mul_f32 v201, v108, v201
    v_mfma_f32_16x16x32_bf16 v[148:151], a[48:51], v[176:179], 0
    s_add_u32 m0, s28, 12288
    v_cvt_pk_bf16_f32 v162, v200, v201
    v_mul_f32 v202, v108, v202
    v_mfma_f32_16x16x32_bf16 v[148:151], a[52:55], v[152:155], v[148:151]
    s_xor_b32 s28, s28, 65536
    v_fmac_f32 v143, v136, v136
    v_fmac_f32 v143, v137, v137
    v_mfma_f32_16x16x32_bf16 v[148:151], a[56:59], v[216:219], v[148:151]
    v_fmac_f32 v143, v138, v138
    v_fmac_f32 v143, v139, v139
    v_mfma_f32_16x16x32_bf16 v[148:151], a[60:63], v[220:223], v[148:151]
    v_mul_f32 v203, v108, v203
    v_cvt_pk_bf16_f32 v163, v202, v203
    v_mfma_f32_16x16x32_bf16 v[148:151], a[64:67], v[124:127], v[148:151]
    buffer_load_dwordx4 v13, s[8:11], s23 offen nt lds
    ds_read_b128 v[120:123], v5 offset:0
    v_mfma_f32_16x16x32_bf16 v[148:151], a[68:71], v[116:119], v[148:151]
    s_mov_b32 m0, s29
    ds_read_b128 v[228:231], v5 offset:16
    ds_read_b128 v[200:203], v5 offset:48
    v_mfma_f32_16x16x32_bf16 v[184:187], v[176:179], a[144:147], 0
    s_xor_b32 s29, s29, s30
    ds_read_b32 v224, v6 offset:192
    ds_read2_b32 v[110:111], v6 offset0:0 offset1:0
    v_mfma_f32_16x16x32_bf16 v[184:187], v[152:155], a[148:151], v[184:187]
    s_add_u32 s19, s19, s20
    ds_read2_b32 v[174:175], v6 offset0:16 offset1:16
    ds_read2_b32 v[198:199], v6 offset0:32 offset1:32
    v_mfma_f32_16x16x32_bf16 v[184:187], v[216:219], a[152:155], v[184:187]
    v_fmac_f32 v143, v148, v148
    v_fmac_f32 v143, v149, v149
    v_mfma_f32_16x16x32_bf16 v[184:187], v[220:223], a[156:159], v[184:187]
    buffer_store_dwordx2 v[140:141], v19, s[12:15], s27 offen
    v_fmac_f32 v143, v150, v150
    v_fmac_f32 v143, v151, v151
    v_mfma_f32_16x16x32_bf16 v[184:187], v[124:127], a[160:163], v[184:187]
    v_cvt_pk_bf16_f32 v38, v143, v142
    v_mul_f32 v232, v108, v232
    v_mfma_f32_16x16x32_bf16 v[184:187], v[116:119], a[164:167], v[184:187]
    v_mul_f32 v233, v108, v233
    v_cvt_pk_bf16_f32 v232, v232, v233
    v_mfma_f32_16x16x16_bf16 v[140:143], v[32:33], v[38:39], 0
    s_waitcnt lgkmcnt(5)
    v_mul_f32 v234, v108, v234
    v_mul_f32 v235, v108, v235
    v_mfma_f32_16x16x32_bf16 v[236:239], v[120:123], v[204:207], v[22:25]
    s_waitcnt lgkmcnt(3)
    v_cvt_pk_bf16_f32 v108, v184, v185
    v_cvt_pk_bf16_f32 v109, v186, v187
    v_mfma_f32_16x16x32_bf16 v[236:239], v[228:231], v[212:215], v[236:239]
    s_waitcnt lgkmcnt(1)
    v_rsq_f32 v141, v141
    v_mfma_f32_16x16x32_bf16 v[236:239], v[200:203], v[192:195], v[236:239]
    s_waitcnt lgkmcnt(0)
    v_rsq_f32 v140, v140
    v_mfma_f32_16x16x32_bf16 v[184:187], v[120:123], v[132:135], v[24:27]
    v_mul_f32 v140, s31, v140
    v_mul_f32 v208, v141, v208
    v_mfma_f32_16x16x32_bf16 v[184:187], v[228:231], v[180:183], v[184:187]
    v_mul_f32 v209, v141, v209
    v_cvt_pk_bf16_f32 v208, v208, v209
    v_mfma_f32_16x16x32_bf16 v[184:187], v[200:203], v[168:171], v[184:187]
    v_mov_b32_dpp v224, v237 quad_perm:[0,1,2,3] row_mask:0x1 bank_mask:0xf
    v_mul_f32 v210, v141, v210
    v_mfma_f32_16x16x32_bf16 v[240:243], v[176:179], a[168:171], 0
    v_mul_f32 v211, v141, v211
    v_cvt_pk_bf16_f32 v209, v210, v211
    v_mfma_f32_16x16x32_bf16 v[240:243], v[152:155], a[172:175], v[240:243]
    v_mul_f32 v164, v141, v164
    v_mul_f32 v165, v141, v165
    v_mfma_f32_16x16x32_bf16 v[240:243], v[216:219], a[176:179], v[240:243]
    v_cvt_pk_bf16_f32 v210, v164, v165
    v_mul_f32 v166, v141, v166
    v_mfma_f32_16x16x32_bf16 v[240:243], v[220:223], a[180:183], v[240:243]
    v_mul_f32 v167, v141, v167
    v_cvt_pk_bf16_f32 v211, v166, v167
    v_mfma_f32_16x16x32_bf16 v[240:243], v[124:127], a[184:187], v[240:243]
    v_mul_f32 v112, v141, v112
    v_mul_f32 v113, v141, v113
    v_mfma_f32_16x16x32_bf16 v[240:243], v[116:119], a[188:191], v[240:243]
    v_cvt_pk_bf16_f32 v166, v112, v113
    v_mul_f32 v114, v141, v114
    v_mfma_f32_16x16x32_bf16 v[244:247], v[176:179], a[192:195], 0
    ds_read_b128 v[176:179], v2 offset:0
    v_mul_f32 v115, v141, v115
    v_mfma_f32_16x16x32_bf16 v[244:247], v[152:155], a[196:199], v[244:247]
    ds_read_b128 v[152:155], v2 offset:1024
    buffer_store_dwordx4 v[160:163], v17, s[12:15], s27 offen
    v_cvt_pk_bf16_f32 v172, v240, v241
    v_cvt_pk_bf16_f32 v173, v242, v243
    v_cvt_pk_bf16_f32 v167, v114, v115
    v_mul_f32 v188, v140, v188
    v_mfma_f32_16x16x32_bf16 v[240:243], v[212:215], v[204:207], v[40:43]
    v_mul_f32 v189, v140, v189
    v_cvt_pk_bf16_f32 v112, v188, v189
    v_mfma_f32_16x16x32_bf16 v[248:251], v[180:183], v[204:207], v[44:47]
    v_mul_f32 v190, v140, v190
    v_mul_f32 v191, v140, v191
    v_mfma_f32_16x16x32_bf16 v[160:163], v[208:211], v[204:207], v[48:51]
    v_cvt_pk_bf16_f32 v113, v190, v191
    v_mul_f32 v136, v140, v136
    v_mfma_f32_16x16x16_bf16 v[240:243], v[194:195], v[192:193], v[240:243]
    v_mul_f32 v137, v140, v137
    v_cvt_pk_bf16_f32 v114, v136, v137
    v_mfma_f32_16x16x16_bf16 v[248:251], v[170:171], v[192:193], v[248:251]
    v_mul_f32 v138, v140, v138
    v_mul_f32 v139, v140, v139
    v_mfma_f32_16x16x16_bf16 v[160:163], v[166:167], v[192:193], v[160:163]
    s_waitcnt lgkmcnt(1)
    v_cvt_pk_bf16_f32 v115, v138, v139
    v_mul_f32 v148, v140, v148
    v_mfma_f32_16x16x32_bf16 v[244:247], v[216:219], a[200:203], v[244:247]
    s_waitcnt lgkmcnt(0)
    ds_read_b128 v[216:219], v2 offset:2048
    v_mul_f32 v149, v140, v149
    v_mfma_f32_16x16x32_bf16 v[244:247], v[220:223], a[204:207], v[244:247]
    ds_read_b128 v[204:207], v2 offset:3072
    v_cvt_pk_bf16_f32 v164, v148, v149
    v_mfma_f32_16x16x32_bf16 v[244:247], v[124:127], a[208:211], v[244:247]
    ds_read_b128 v[124:127], v2 offset:4096
    v_mul_f32 v150, v140, v150
    v_mfma_f32_16x16x32_bf16 v[244:247], v[116:119], a[212:215], v[244:247]
    ds_read_b128 v[116:119], v2 offset:5120
    v_mul_f32 v151, v140, v151
    v_mfma_f32_16x16x32_bf16 v[220:223], v[120:123], v[112:115], v[26:29]
    v_cvt_pk_bf16_f32 v165, v150, v151
    v_mov_b32_dpp v224, v185 quad_perm:[0,1,2,3] row_mask:0x2 bank_mask:0xf
    v_mfma_f32_16x16x32_bf16 v[220:223], v[228:231], v[208:211], v[220:223]
    v_cvt_pk_bf16_f32 v233, v234, v235
    v_xor_b32 v0, 65536, v0
    v_mfma_f32_16x16x32_bf16 v[220:223], v[200:203], v[164:167], v[220:223]
    v_cvt_pk_bf16_f32 v196, v244, v245
    v_cvt_pk_bf16_f32 v197, v246, v247
    v_mfma_f32_16x16x32_bf16 v[140:143], a[216:219], v[176:179], 0
    v_exp_f32 v184, v184
    v_mfma_f32_16x16x32_bf16 v[140:143], a[220:223], v[152:155], v[140:143]
    s_waitcnt lgkmcnt(3)
    v_exp_f32 v240, v240
    v_mfma_f32_16x16x32_bf16 v[140:143], a[224:227], v[216:219], v[140:143]
    s_waitcnt lgkmcnt(2)
    v_exp_f32 v220, v220
    v_mfma_f32_16x16x32_bf16 v[140:143], a[228:231], v[204:207], v[140:143]
    s_waitcnt lgkmcnt(1)
    buffer_store_dwordx2 v[232:233], v20, s[12:15], s27 offen
    v_mov_b32_dpp v224, v221 quad_perm:[0,1,2,3] row_mask:0x4 bank_mask:0xf
    v_xor_b32 v1, 65536, v1
    v_mfma_f32_16x16x32_bf16 v[140:143], a[232:235], v[124:127], v[140:143]
    s_waitcnt lgkmcnt(0)
    v_exp_f32 v224, v224
    v_mfma_f32_16x16x32_bf16 v[140:143], a[236:239], v[116:119], v[140:143]
    s_mov_b32 s27, s26
    v_cvt_pk_bf16_f32 v224, v224, v224
    v_add_u32 v5, 336, v5
    v_mfma_f32_16x16x32_bf16 v[188:191], a[240:243], v[176:179], 0
    s_mov_b32 s26, s25
    ds_write_b16 v8, v224
    v_mfma_f32_16x16x32_bf16 v[188:191], a[244:247], v[152:155], v[188:191]
    s_mov_b32 s25, s24
    v_exp_f32 v241, v241
    v_mfma_f32_16x16x32_bf16 v[188:191], a[248:251], v[216:219], v[188:191]
    s_mov_b32 s24, s23
    ds_read_b128 v[136:139], v2 offset:6144
    ds_read_b128 v[200:203], v2 offset:7168
    v_mfma_f32_16x16x32_bf16 v[188:191], a[252:255], v[204:207], v[188:191]
    ds_read_b128 v[232:235], v2 offset:8192
    ds_read_b128 v[228:231], v9
    v_mfma_f32_16x16x32_bf16 v[188:191], v[76:79], v[124:127], v[188:191]
    ds_read_b128 v[148:151], v2 offset:9216
    ds_read_b128 v[120:123], v9 offset:64
    v_mfma_f32_16x16x32_bf16 v[188:191], v[80:83], v[116:119], v[188:191]
    ds_read_b128 v[224:227], v2 offset:10240
    v_cvt_pk_bf16_f32 v240, v240, v241
    v_mfma_f32_16x16x32_bf16 v[244:247], v[84:87], v[176:179], 0
    ds_read_b128 v[176:179], v2 offset:11264
    v_fma_f32 v221, v140, v140, s33
    v_mfma_f32_16x16x32_bf16 v[244:247], v[88:91], v[152:155], v[244:247]
    v_exp_f32 v242, v242
    v_mfma_f32_16x16x32_bf16 v[244:247], v[92:95], v[216:219], v[244:247]
    v_exp_f32 v243, v243
    v_mfma_f32_16x16x32_bf16 v[244:247], v[96:99], v[204:207], v[244:247]
    v_cvt_pk_bf16_f32 v241, v242, v243
    v_fmac_f32 v221, v141, v141
    v_mfma_f32_16x16x32_bf16 v[244:247], v[100:103], v[124:127], v[244:247]
    s_waitcnt lgkmcnt(6)
    v_exp_f32 v248, v248
    v_mfma_f32_16x16x32_bf16 v[244:247], v[104:107], v[116:119], v[244:247]
    s_waitcnt lgkmcnt(4)
    v_exp_f32 v249, v249
    v_mfma_f32_16x16x32_bf16 v[204:207], v[228:231], v[28:31], 0
    s_waitcnt lgkmcnt(2)
    v_cvt_pk_bf16_f32 v242, v248, v249
    v_fmac_f32 v221, v142, v142
    v_mfma_f32_16x16x32_bf16 v[204:207], v[120:123], v[28:31], v[204:207]
    s_waitcnt lgkmcnt(1)
    v_exp_f32 v250, v250
    v_mfma_f32_16x16x32_bf16 v[152:155], v[228:231], v[128:131], 0
    s_waitcnt lgkmcnt(0)
    buffer_load_dwordx4 v14, s[8:11], s23 offen nt lds
    v_fmac_f32 v221, v143, v143
    v_mfma_f32_16x16x32_bf16 v[152:155], v[120:123], v[108:111], v[152:155]
    s_add_u32 s23, s23, s21
    v_rcp_f32 v204, v204
    v_mfma_f32_16x16x32_bf16 v[116:119], v[228:231], v[156:159], 0
    s_cmp_ge_u32 s19, 72
    v_exp_f32 v251, v251
    v_mfma_f32_16x16x32_bf16 v[116:119], v[120:123], v[172:175], v[116:119]
    s_cselect_b32 s34, 72, 0
    v_cvt_pk_bf16_f32 v243, v250, v251
    v_mul_f32 v152, v152, v204
    v_mfma_f32_16x16x32_bf16 v[124:127], v[228:231], v[144:147], 0
    s_cselect_b32 s35, s22, 0
    v_exp_f32 v160, v160
    v_mfma_f32_16x16x32_bf16 v[124:127], v[120:123], v[196:199], v[124:127]
    s_sub_u32 s19, s19, s34
    v_mul_f32_dpp v152, v116, v204 quad_perm:[0,1,2,3] row_mask:0x2 bank_mask:0xf
    v_fmac_f32 v221, v188, v188
    v_mfma_f32_16x16x32_bf16 v[116:119], a[216:219], v[136:139], 0
    s_add_u32 s23, s23, s35
    v_exp_f32 v161, v161
    v_mfma_f32_16x16x32_bf16 v[116:119], a[220:223], v[200:203], v[116:119]
    s_add_u32 s18, s18, 1
    v_mul_f32_dpp v152, v124, v204 quad_perm:[0,1,2,3] row_mask:0x4 bank_mask:0xf
    v_cvt_pk_bf16_f32 v152, v152, v152
    v_mfma_f32_16x16x32_bf16 v[116:119], a[224:227], v[232:235], v[116:119]
    s_cmp_lt_u32 s18, s17
    ds_write_b16 v7, v152
    v_mfma_f32_16x16x32_bf16 v[116:119], a[228:231], v[148:151], v[116:119]
    v_cvt_pk_bf16_f32 v36, v160, v161
    v_fmac_f32 v221, v189, v189
    v_mfma_f32_16x16x32_bf16 v[116:119], a[232:235], v[224:227], v[116:119]
    v_exp_f32 v162, v162
    v_mfma_f32_16x16x32_bf16 v[116:119], a[236:239], v[176:179], v[116:119]
    v_exp_f32 v163, v163
    v_mfma_f32_16x16x32_bf16 v[204:207], v[212:215], v[132:135], v[52:55]
    v_cvt_pk_bf16_f32 v37, v162, v163
    v_fmac_f32 v221, v190, v190
    v_mfma_f32_16x16x32_bf16 v[152:155], v[180:183], v[132:135], v[56:59]
    v_exp_f32 v236, v236
    v_mfma_f32_16x16x32_bf16 v[124:127], v[208:211], v[132:135], v[60:63]
    v_cvt_pk_bf16_f32 v38, v236, 0
    v_fma_f32 v222, v116, v116, s33
    v_mfma_f32_16x16x16_bf16 v[204:207], v[194:195], v[168:169], v[204:207]
    v_fmac_f32 v222, v117, v117
    v_fmac_f32 v222, v118, v118
    v_mfma_f32_16x16x16_bf16 v[152:155], v[170:171], v[168:169], v[152:155]
    v_fmac_f32 v222, v119, v119
    v_fmac_f32 v221, v191, v191
    v_mfma_f32_16x16x16_bf16 v[124:127], v[166:167], v[168:169], v[124:127]
    v_fmac_f32 v221, v244, v244
    v_fmac_f32 v221, v245, v245
    v_mfma_f32_16x16x32_bf16 v[216:219], v[28:31], v[36:39], 0
    v_exp_f32 v204, v204
    v_mfma_f32_16x16x32_bf16 v[216:219], v[28:31], v[240:243], v[216:219]
    v_exp_f32 v205, v205
    v_mfma_f32_16x16x32_bf16 v[132:135], v[108:111], v[36:39], 0
    v_cvt_pk_bf16_f32 v204, v204, v205
    v_fmac_f32 v221, v246, v246
    v_mfma_f32_16x16x32_bf16 v[132:135], v[128:131], v[240:243], v[132:135]
    v_exp_f32 v206, v206
    v_mfma_f32_16x16x32_bf16 v[160:163], v[172:175], v[36:39], 0
    v_exp_f32 v207, v207
    v_mfma_f32_16x16x32_bf16 v[160:163], v[156:159], v[240:243], v[160:163]
    v_rcp_f32 v216, v216
    v_mfma_f32_16x16x32_bf16 v[120:123], v[196:199], v[36:39], 0
    v_cvt_pk_bf16_f32 v205, v206, v207
    v_cvt_pk_bf16_f32 v38, v184, 0
    v_mfma_f32_16x16x32_bf16 v[120:123], v[144:147], v[240:243], v[120:123]
    v_mul_f32 v132, v216, v132
    v_mul_f32 v133, v216, v133
    v_mfma_f32_16x16x32_bf16 v[240:243], v[212:215], v[112:115], v[64:67]
    v_cvt_pk_bf16_f32 v192, v132, v133
    v_mul_f32 v134, v216, v134
    v_mfma_f32_16x16x32_bf16 v[212:215], v[180:183], v[112:115], v[68:71]
    v_mul_f32 v135, v216, v135
    v_cvt_pk_bf16_f32 v193, v134, v135
    v_mfma_f32_16x16x32_bf16 v[180:183], v[208:211], v[112:115], v[72:75]
    v_mul_f32 v160, v216, v160
    v_mul_f32 v161, v216, v161
    v_mfma_f32_16x16x16_bf16 v[240:243], v[194:195], v[164:165], v[240:243]
    v_cvt_pk_bf16_f32 v194, v160, v161
    v_mul_f32 v162, v216, v162
    v_mfma_f32_16x16x16_bf16 v[212:215], v[170:171], v[164:165], v[212:215]
    v_mul_f32 v163, v216, v163
    v_cvt_pk_bf16_f32 v195, v162, v163
    v_mfma_f32_16x16x16_bf16 v[180:183], v[166:167], v[164:165], v[180:183]
    ds_write_b128 v3, v[192:195] offset:0
    v_mfma_f32_16x16x32_bf16 v[208:211], a[240:243], v[136:139], 0
    v_exp_f32 v240, v240
    v_mfma_f32_16x16x32_bf16 v[208:211], a[244:247], v[200:203], v[208:211]
    v_exp_f32 v241, v241
    v_mfma_f32_16x16x32_bf16 v[208:211], a[248:251], v[232:235], v[208:211]
    ds_read_b128 v[164:167], v2 offset:12288
    ds_read_b128 v[132:135], v2 offset:13312
    v_mfma_f32_16x16x32_bf16 v[208:211], a[252:255], v[148:151], v[208:211]
    ds_read_b128 v[168:171], v2 offset:14336
    v_cvt_pk_bf16_f32 v160, v240, v241
    v_mfma_f32_16x16x32_bf16 v[208:211], v[76:79], v[224:227], v[208:211]
    ds_read_b128 v[192:195], v2 offset:15360
    v_mul_f32 v120, v216, v120
    v_mfma_f32_16x16x32_bf16 v[208:211], v[80:83], v[176:179], v[208:211]
    ds_read_b128 v[112:115], v2 offset:16384
    v_mul_f32 v121, v216, v121
    v_mfma_f32_16x16x32_bf16 v[228:231], v[84:87], v[136:139], 0
    ds_read_b128 v[136:139], v2 offset:17408
    v_cvt_pk_bf16_f32 v206, v120, v121
    v_mfma_f32_16x16x32_bf16 v[228:231], v[88:91], v[200:203], v[228:231]
    v_exp_f32 v242, v242
    v_mfma_f32_16x16x32_bf16 v[228:231], v[92:95], v[232:235], v[228:231]
    v_exp_f32 v243, v243
    v_mfma_f32_16x16x32_bf16 v[228:231], v[96:99], v[148:151], v[228:231]
    v_cvt_pk_bf16_f32 v161, v242, v243
    v_mul_f32 v122, v216, v122
    v_mfma_f32_16x16x32_bf16 v[228:231], v[100:103], v[224:227], v[228:231]
    s_waitcnt lgkmcnt(4)
    v_exp_f32 v212, v212
    v_mfma_f32_16x16x32_bf16 v[228:231], v[104:107], v[176:179], v[228:231]
    s_waitcnt lgkmcnt(3)
    v_exp_f32 v213, v213
    v_mfma_f32_16x16x32_bf16 v[148:151], a[216:219], v[164:167], 0
    s_waitcnt lgkmcnt(2)
    v_cvt_pk_bf16_f32 v162, v212, v213
    v_mul_f32 v123, v216, v123
    v_mfma_f32_16x16x32_bf16 v[148:151], a[220:223], v[132:135], v[148:151]
    s_waitcnt lgkmcnt(1)
    v_exp_f32 v214, v214
    v_mfma_f32_16x16x32_bf16 v[148:151], a[224:227], v[168:171], v[148:151]
    s_waitcnt lgkmcnt(0)
    v_exp_f32 v215, v215
    v_mfma_f32_16x16x32_bf16 v[148:151], a[228:231], v[192:195], v[148:151]
    v_cvt_pk_bf16_f32 v163, v214, v215
    v_cvt_pk_bf16_f32 v207, v122, v123
    v_mfma_f32_16x16x32_bf16 v[148:151], a[232:235], v[112:115], v[148:151]
    ds_write_b64 v4, v[206:207] offset:4096
    v_mfma_f32_16x16x32_bf16 v[148:151], a[236:239], v[136:139], v[148:151]
    v_exp_f32 v180, v180
    v_mfma_f32_16x16x32_bf16 v[200:203], a[240:243], v[164:167], 0
    ds_read_b128 v[212:215], v0 offset:20480
    ds_read_b128 v[176:179], v1 offset:20480
    v_mfma_f32_16x16x32_bf16 v[200:203], a[244:247], v[132:135], v[200:203]
    ds_read_b128 v[216:219], v0 offset:20608
    v_fmac_f32 v222, v208, v208
    v_mfma_f32_16x16x32_bf16 v[200:203], a[248:251], v[168:171], v[200:203]
    ds_read_b128 v[120:123], v1 offset:20608
    v_fmac_f32 v222, v209, v209
    v_mfma_f32_16x16x32_bf16 v[200:203], a[252:255], v[192:195], v[200:203]
    ds_read_b128 v[240:243], v0 offset:20736
    v_fmac_f32 v222, v210, v210
    v_mfma_f32_16x16x32_bf16 v[200:203], v[76:79], v[112:115], v[200:203]
    ds_read_b128 v[224:227], v1 offset:20736
    v_fmac_f32 v222, v211, v211
    v_mfma_f32_16x16x32_bf16 v[200:203], v[80:83], v[136:139], v[200:203]
    v_exp_f32 v181, v181
    v_mfma_f32_16x16x32_bf16 v[232:235], v[84:87], v[164:167], 0
    v_exp_f32 v182, v182
    v_mfma_f32_16x16x32_bf16 v[232:235], v[88:91], v[132:135], v[232:235]
    v_exp_f32 v183, v183
    v_mfma_f32_16x16x32_bf16 v[232:235], v[92:95], v[168:171], v[232:235]
    s_waitcnt lgkmcnt(4)
    v_exp_f32 v152, v152
    v_mfma_f32_16x16x32_bf16 v[232:235], v[96:99], v[192:195], v[232:235]
    s_waitcnt lgkmcnt(3)
    v_exp_f32 v153, v153
    v_mfma_f32_16x16x32_bf16 v[232:235], v[100:103], v[112:115], v[232:235]
    s_waitcnt lgkmcnt(2)
    v_cvt_pk_bf16_f32 v206, v152, v153
    v_fmac_f32 v222, v228, v228
    v_mfma_f32_16x16x32_bf16 v[232:235], v[104:107], v[136:139], v[232:235]
    s_waitcnt lgkmcnt(1)
    v_exp_f32 v154, v154
    v_mfma_f32_16x16x32_bf16 v[192:195], a[72:75], v[212:215], 0
    s_waitcnt lgkmcnt(0)
    v_exp_f32 v155, v155
    v_mfma_f32_16x16x32_bf16 v[192:195], a[76:79], v[176:179], v[192:195]
    v_cvt_pk_bf16_f32 v207, v154, v155
    v_fmac_f32 v222, v229, v229
    v_mfma_f32_16x16x32_bf16 v[192:195], a[80:83], v[216:219], v[192:195]
    v_exp_f32 v124, v124
    v_mfma_f32_16x16x32_bf16 v[192:195], a[84:87], v[120:123], v[192:195]
    v_exp_f32 v125, v125
    v_mfma_f32_16x16x32_bf16 v[192:195], a[88:91], v[240:243], v[192:195]
    v_cvt_pk_bf16_f32 v36, v124, v125
    v_fmac_f32 v222, v230, v230
    v_mfma_f32_16x16x32_bf16 v[192:195], a[92:95], v[224:227], v[192:195]
    v_exp_f32 v126, v126
    v_mfma_f32_16x16x32_bf16 v[152:155], a[96:99], v[212:215], 0
    v_exp_f32 v127, v127
    v_mfma_f32_16x16x32_bf16 v[152:155], a[100:103], v[176:179], v[152:155]
    v_cvt_pk_bf16_f32 v37, v126, v127
    v_fmac_f32 v222, v231, v231
    v_mfma_f32_16x16x32_bf16 v[152:155], a[104:107], v[216:219], v[152:155]
    v_fma_f32 v223, v148, v148, s33
    v_fmac_f32 v223, v149, v149
    v_mfma_f32_16x16x32_bf16 v[124:127], v[28:31], v[36:39], 0
    v_fmac_f32 v223, v150, v150
    v_fmac_f32 v223, v151, v151
    v_mfma_f32_16x16x32_bf16 v[124:127], v[28:31], v[204:207], v[124:127]
    v_fmac_f32 v223, v200, v200
    v_fmac_f32 v223, v201, v201
    v_mfma_f32_16x16x32_bf16 v[164:167], v[108:111], v[36:39], 0
    v_fmac_f32 v223, v202, v202
    v_fmac_f32 v223, v203, v203
    v_mfma_f32_16x16x32_bf16 v[164:167], v[128:131], v[204:207], v[164:167]
    v_fmac_f32 v223, v232, v232
    v_fmac_f32 v223, v233, v233
    v_mfma_f32_16x16x32_bf16 v[168:171], v[172:175], v[36:39], 0
    v_rcp_f32 v124, v124
    v_mfma_f32_16x16x32_bf16 v[168:171], v[156:159], v[204:207], v[168:171]
    v_fmac_f32 v223, v234, v234
    v_fmac_f32 v223, v235, v235
    v_mfma_f32_16x16x32_bf16 v[132:135], v[196:199], v[36:39], 0
    v_cvt_pk_bf16_f32 v36, v180, v181
    v_cvt_pk_bf16_f32 v37, v182, v183
    v_mfma_f32_16x16x32_bf16 v[132:135], v[144:147], v[204:207], v[132:135]
    v_cvt_pk_bf16_f32 v38, v220, 0
    v_mul_f32 v164, v124, v164
    v_mfma_f32_16x16x32_bf16 v[152:155], a[108:111], v[120:123], v[152:155]
    v_mul_f32 v165, v124, v165
    v_cvt_pk_bf16_f32 v204, v164, v165
    v_mfma_f32_16x16x32_bf16 v[180:183], v[28:31], v[36:39], 0
    v_mul_f32 v166, v124, v166
    v_mul_f32 v167, v124, v167
    v_mfma_f32_16x16x32_bf16 v[180:183], v[28:31], v[160:163], v[180:183]
    v_cvt_pk_bf16_f32 v205, v166, v167
    v_mul_f32 v168, v124, v168
    v_mfma_f32_16x16x32_bf16 v[164:167], v[108:111], v[36:39], 0
    v_mul_f32 v169, v124, v169
    v_cvt_pk_bf16_f32 v206, v168, v169
    v_mfma_f32_16x16x32_bf16 v[164:167], v[128:131], v[160:163], v[164:167]
    v_mul_f32 v170, v124, v170
    v_mul_f32 v171, v124, v171
    v_mfma_f32_16x16x32_bf16 v[128:131], v[172:175], v[36:39], 0
    v_cvt_pk_bf16_f32 v207, v170, v171
    v_mul_f32 v132, v124, v132
    v_mfma_f32_16x16x32_bf16 v[128:131], v[156:159], v[160:163], v[128:131]
    ds_write_b128 v3, v[204:207] offset:6144
    v_mfma_f32_16x16x32_bf16 v[156:159], v[196:199], v[36:39], 0
    v_mul_f32 v133, v124, v133
    v_cvt_pk_bf16_f32 v132, v132, v133
    v_mfma_f32_16x16x32_bf16 v[156:159], v[144:147], v[160:163], v[156:159]
    v_mul_f32 v134, v124, v134
    v_mul_f32 v135, v124, v135
    v_mfma_f32_16x16x32_bf16 v[152:155], a[112:115], v[240:243], v[152:155]
    v_cvt_pk_bf16_f32 v133, v134, v135
    v_cvt_pk_bf16_f32 v223, v223, v223
    v_mfma_f32_16x16x32_bf16 v[152:155], a[116:119], v[224:227], v[152:155]
    ds_write_b64 v4, v[132:133] offset:10240
    v_mfma_f32_16x16x32_bf16 v[144:147], a[120:123], v[212:215], 0
    v_rcp_f32 v180, v180
    v_mfma_f32_16x16x32_bf16 v[144:147], a[124:127], v[176:179], v[144:147]
    v_mul_f32 v164, v180, v164
    v_mul_f32 v165, v180, v165
    v_mfma_f32_16x16x32_bf16 v[144:147], a[128:131], v[216:219], v[144:147]
    v_cvt_pk_bf16_f32 v204, v164, v165
    v_mul_f32 v166, v180, v166
    v_mfma_f32_16x16x32_bf16 v[144:147], a[132:135], v[120:123], v[144:147]
    v_mul_f32 v167, v180, v167
    v_cvt_pk_bf16_f32 v205, v166, v167
    v_mfma_f32_16x16x32_bf16 v[144:147], a[136:139], v[240:243], v[144:147]
    v_mul_f32 v128, v180, v128
    v_mul_f32 v129, v180, v129
    v_mfma_f32_16x16x32_bf16 v[144:147], a[140:143], v[224:227], v[144:147]
    v_cvt_pk_bf16_f32 v206, v128, v129
    v_mul_f32 v130, v180, v130
    v_mfma_f32_16x16x32_bf16 v[124:127], a[0:3], v[212:215], 0
    v_mul_f32 v131, v180, v131
    v_cvt_pk_bf16_f32 v207, v130, v131
    v_mfma_f32_16x16x32_bf16 v[124:127], a[4:7], v[176:179], v[124:127]
    ds_write_b128 v3, v[204:207] offset:12288
    v_mfma_f32_16x16x32_bf16 v[124:127], a[8:11], v[216:219], v[124:127]
    v_mul_f32 v156, v180, v156
    v_mul_f32 v157, v180, v157
    v_mfma_f32_16x16x32_bf16 v[124:127], a[12:15], v[120:123], v[124:127]
    v_cvt_pk_bf16_f32 v156, v156, v157
    v_mul_f32 v158, v180, v158
    v_mfma_f32_16x16x32_bf16 v[124:127], a[16:19], v[240:243], v[124:127]
    v_mul_f32 v159, v180, v159
    v_cvt_pk_bf16_f32 v157, v158, v159
    v_mfma_f32_16x16x32_bf16 v[124:127], a[20:23], v[224:227], v[124:127]
    ds_write_b64 v4, v[156:157] offset:16384
    v_mfma_f32_16x16x32_bf16 v[180:183], a[24:27], v[212:215], 0
    v_fmac_f32 v221, v247, v247
    v_cvt_pk_bf16_f32 v222, v221, v222
    v_mfma_f32_16x16x32_bf16 v[180:183], a[28:31], v[176:179], v[180:183]
    ds_write_b64 v4, v[222:223] offset:18432
    v_mfma_f32_16x16x32_bf16 v[180:183], a[32:35], v[216:219], v[180:183]
    v_fma_f32 v108, v192, v192, s32
    v_fmac_f32 v108, v193, v193
    v_mfma_f32_16x16x32_bf16 v[180:183], a[36:39], v[120:123], v[180:183]
    v_fmac_f32 v108, v194, v194
    v_fmac_f32 v108, v195, v195
    v_mfma_f32_16x16x32_bf16 v[180:183], a[40:43], v[240:243], v[180:183]
    v_fmac_f32 v108, v152, v152
    v_fmac_f32 v108, v153, v153
    v_mfma_f32_16x16x32_bf16 v[180:183], a[44:47], v[224:227], v[180:183]
    v_fmac_f32 v108, v154, v154
    v_fmac_f32 v108, v155, v155
    v_mfma_f32_16x16x32_bf16 v[220:223], a[48:51], v[212:215], 0
    v_fmac_f32 v108, v144, v144
    v_fmac_f32 v108, v145, v145
    v_mfma_f32_16x16x32_bf16 v[220:223], a[52:55], v[176:179], v[220:223]
    v_fmac_f32 v108, v146, v146
    v_fmac_f32 v108, v147, v147
    v_mfma_f32_16x16x32_bf16 v[220:223], a[56:59], v[216:219], v[220:223]
    s_waitcnt lgkmcnt(0)
    v_fma_f32 v109, v124, v124, s32
    v_fmac_f32 v109, v125, v125
    v_mfma_f32_16x16x32_bf16 v[220:223], a[60:63], v[120:123], v[220:223]
    s_barrier
    v_fmac_f32 v109, v126, v126
    v_fmac_f32 v109, v127, v127
    v_mfma_f32_16x16x32_bf16 v[220:223], a[64:67], v[240:243], v[220:223]
    s_nop 0
    v_fmac_f32 v109, v180, v180
    v_fmac_f32 v109, v181, v181
    v_mfma_f32_16x16x32_bf16 v[220:223], a[68:71], v[224:227], v[220:223]
    s_nop 0
    v_fmac_f32 v109, v182, v182
    v_fmac_f32 v109, v183, v183
    v_mfma_f32_16x16x32_bf16 v[128:131], v[212:215], a[144:147], 0
    s_nop 0
    v_add_u32 v6, 272, v6
    v_add_u32 v7, 16, v7
    v_mfma_f32_16x16x32_bf16 v[128:131], v[176:179], a[148:151], v[128:131]
    v_fmac_f32 v109, v220, v220
    v_fmac_f32 v109, v221, v221
    v_mfma_f32_16x16x32_bf16 v[128:131], v[216:219], a[152:155], v[128:131]
    v_fmac_f32 v109, v222, v222
    v_fmac_f32 v109, v223, v223
    v_mfma_f32_16x16x32_bf16 v[128:131], v[120:123], a[156:159], v[128:131]
    v_cvt_pk_bf16_f32 v38, v109, v108
    v_xor_b32 v2, 65536, v2
    v_mfma_f32_16x16x32_bf16 v[128:131], v[240:243], a[160:163], v[128:131]
    v_xor_b32 v3, 65536, v3
    v_xor_b32 v4, 65536, v4
    v_mfma_f32_16x16x32_bf16 v[128:131], v[224:227], a[164:167], v[128:131]
    s_cbranch_scc1 L_loop_fast0
    s_branch L_drain
.p2align 6
L_loop_fast1:
    v_mfma_f32_16x16x16_bf16 v[164:167], v[32:33], v[38:39], 0
    s_cmp_ge_u32 s18, 2
    ds_read_b128 v[204:207], v2 offset:18432
    ds_read_b128 v[108:111], v2 offset:19456
    v_mfma_f32_16x16x32_bf16 v[156:159], v[212:215], a[168:171], 0
    s_cselect_b32 s14, s36, 0
    ds_read_b128 v[168:171], v0 offset:26624
    ds_read_b128 v[132:135], v1 offset:26624
    v_mfma_f32_16x16x32_bf16 v[156:159], v[176:179], a[172:175], v[156:159]
    s_add_u32 s34, s18, 2
    ds_read_b128 v[160:163], v0 offset:26752
    ds_read_b128 v[112:115], v1 offset:26752
    v_mfma_f32_16x16x32_bf16 v[156:159], v[216:219], a[176:179], v[156:159]
    s_cmp_lt_u32 s34, s17
    ds_read_b128 v[172:175], v0 offset:26880
    v_cvt_pk_bf16_f32 v128, v128, v129
    v_mfma_f32_16x16x32_bf16 v[156:159], v[120:123], a[180:183], v[156:159]
    s_cselect_b32 s10, s36, 0
    ds_read_b128 v[196:199], v1 offset:26880
    v_cvt_pk_bf16_f32 v129, v130, v131
    v_mfma_f32_16x16x32_bf16 v[156:159], v[240:243], a[184:187], v[156:159]
    s_add_u32 m0, s28, 0
    v_rsq_f32 v165, v165
    v_mfma_f32_16x16x32_bf16 v[156:159], v[224:227], a[188:191], v[156:159]
    v_rsq_f32 v164, v164
    v_mfma_f32_16x16x32_bf16 v[136:139], v[212:215], a[192:195], 0
    v_mul_f32 v164, s31, v164
    v_mul_f32 v192, v165, v192
    v_mfma_f32_16x16x32_bf16 v[136:139], v[176:179], a[196:199], v[136:139]
    s_waitcnt lgkmcnt(6)
    v_mul_f32 v193, v165, v193
    v_cvt_pk_bf16_f32 v212, v192, v193
    v_mfma_f32_16x16x32_bf16 v[176:179], v[32:35], v[204:207], 0
    s_waitcnt lgkmcnt(4)
    v_cvt_pk_bf16_f32 v156, v156, v157
    v_cvt_pk_bf16_f32 v157, v158, v159
    v_mfma_f32_16x16x32_bf16 v[176:179], v[32:35], v[108:111], v[176:179]
    s_waitcnt lgkmcnt(2)
    v_mul_f32 v194, v165, v194
    v_mul_f32 v195, v165, v195
    v_mfma_f32_16x16x32_bf16 v[136:139], v[216:219], a[200:203], v[136:139]
    s_waitcnt lgkmcnt(1)
    v_cvt_pk_bf16_f32 v213, v194, v195
    v_mul_f32 v152, v165, v152
    v_mfma_f32_16x16x32_bf16 v[136:139], v[120:123], a[204:207], v[136:139]
    s_waitcnt lgkmcnt(0)
    v_mul_f32 v153, v165, v153
    v_cvt_pk_bf16_f32 v214, v152, v153
    v_mfma_f32_16x16x32_bf16 v[136:139], v[240:243], a[208:211], v[136:139]
    v_mul_f32 v154, v165, v154
    v_mul_f32 v155, v165, v155
    v_mfma_f32_16x16x32_bf16 v[136:139], v[224:227], a[212:215], v[136:139]
    v_cvt_pk_bf16_f32 v215, v154, v155
    v_mul_f32 v144, v165, v144
    v_mfma_f32_16x16x32_bf16 v[240:243], a[72:75], v[168:171], 0
    v_mul_f32 v145, v165, v145
    v_cvt_pk_bf16_f32 v194, v144, v145
    v_mfma_f32_16x16x32_bf16 v[240:243], a[76:79], v[132:135], v[240:243]
    v_mul_f32 v146, v165, v146
    v_mul_f32 v147, v165, v147
    v_mfma_f32_16x16x32_bf16 v[240:243], a[80:83], v[160:163], v[240:243]
    v_cvt_pk_bf16_f32 v144, v136, v137
    v_cvt_pk_bf16_f32 v145, v138, v139
    v_mfma_f32_16x16x32_bf16 v[240:243], a[84:87], v[112:115], v[240:243]
    v_cvt_pk_bf16_f32 v195, v146, v147
    v_mul_f32 v124, v164, v124
    v_mfma_f32_16x16x32_bf16 v[240:243], a[88:91], v[172:175], v[240:243]
    v_mul_f32 v125, v164, v125
    v_cvt_pk_bf16_f32 v204, v124, v125
    v_mfma_f32_16x16x32_bf16 v[240:243], a[92:95], v[196:199], v[240:243]
    v_mul_f32 v126, v164, v126
    v_mul_f32 v127, v164, v127
    v_mfma_f32_16x16x32_bf16 v[120:123], a[96:99], v[168:171], 0
    v_cvt_pk_bf16_f32 v205, v126, v127
    v_mul_f32 v180, v164, v180
    v_mfma_f32_16x16x32_bf16 v[120:123], a[100:103], v[132:135], v[120:123]
    v_mul_f32 v181, v164, v181
    v_cvt_pk_bf16_f32 v206, v180, v181
    v_mfma_f32_16x16x32_bf16 v[120:123], a[104:107], v[160:163], v[120:123]
    v_mul_f32 v182, v164, v182
    v_mul_f32 v183, v164, v183
    v_mfma_f32_16x16x32_bf16 v[120:123], a[108:111], v[112:115], v[120:123]
    v_cvt_pk_bf16_f32 v207, v182, v183
    v_mul_f32 v220, v164, v220
    v_mfma_f32_16x16x32_bf16 v[120:123], a[112:115], v[172:175], v[120:123]
    v_mul_f32 v221, v164, v221
    v_cvt_pk_bf16_f32 v192, v220, v221
    v_mfma_f32_16x16x32_bf16 v[120:123], a[116:119], v[196:199], v[120:123]
    v_mul_f32 v222, v164, v222
    v_mul_f32 v223, v164, v223
    v_mfma_f32_16x16x32_bf16 v[224:227], a[120:123], v[168:171], 0
    v_cvt_pk_bf16_f32 v193, v222, v223
    v_mul_f32 v130, 0x3baaaaab, v176
    v_mfma_f32_16x16x32_bf16 v[224:227], a[124:127], v[132:135], v[224:227]
    v_rsq_f32 v130, v130
    v_mfma_f32_16x16x32_bf16 v[224:227], a[128:131], v[160:163], v[224:227]
    v_mul_f32 v146, 0x3baaaaab, v177
    v_mul_f32 v108, 0x3baaaaab, v178
    v_mfma_f32_16x16x32_bf16 v[224:227], a[132:135], v[112:115], v[224:227]
    v_rsq_f32 v146, v146
    v_mfma_f32_16x16x32_bf16 v[224:227], a[136:139], v[172:175], v[224:227]
    v_rsq_f32 v108, v108
    v_mfma_f32_16x16x32_bf16 v[224:227], a[140:143], v[196:199], v[224:227]
    v_mul_f32 v140, v130, v140
    v_mul_f32 v141, v130, v141
    v_mfma_f32_16x16x32_bf16 v[136:139], a[0:3], v[168:171], 0
    v_cvt_pk_bf16_f32 v176, v140, v141
    v_mul_f32 v142, v130, v142
    v_mfma_f32_16x16x32_bf16 v[136:139], a[4:7], v[132:135], v[136:139]
    v_mul_f32 v143, v130, v143
    v_cvt_pk_bf16_f32 v177, v142, v143
    v_mfma_f32_16x16x32_bf16 v[136:139], a[8:11], v[160:163], v[136:139]
    v_mul_f32 v188, v130, v188
    v_mul_f32 v189, v130, v189
    v_mfma_f32_16x16x32_bf16 v[136:139], a[12:15], v[112:115], v[136:139]
    v_cvt_pk_bf16_f32 v178, v188, v189
    v_mul_f32 v190, v130, v190
    v_mfma_f32_16x16x32_bf16 v[136:139], a[16:19], v[172:175], v[136:139]
    v_mul_f32 v191, v130, v191
    v_cvt_pk_bf16_f32 v179, v190, v191
    v_mfma_f32_16x16x32_bf16 v[136:139], a[20:23], v[196:199], v[136:139]
    buffer_store_dwordx4 v[176:179], v15, s[12:15], s27 offen
    v_mul_f32 v244, v130, v244
    v_mul_f32 v245, v130, v245
    v_cvt_pk_bf16_f32 v158, v244, v245
    v_mul_f32 v246, v130, v246
    v_mfma_f32_16x16x32_bf16 v[188:191], a[24:27], v[168:171], 0
    v_mul_f32 v247, v130, v247
    v_cvt_pk_bf16_f32 v159, v246, v247
    v_mfma_f32_16x16x32_bf16 v[188:191], a[28:31], v[132:135], v[188:191]
    v_fma_f32 v147, v136, v136, s32
    v_fmac_f32 v147, v137, v137
    v_mfma_f32_16x16x32_bf16 v[188:191], a[32:35], v[160:163], v[188:191]
    v_fmac_f32 v147, v138, v138
    v_fmac_f32 v147, v139, v139
    v_mfma_f32_16x16x32_bf16 v[188:191], a[36:39], v[112:115], v[188:191]
    v_fma_f32 v130, v240, v240, s32
    v_fmac_f32 v130, v241, v241
    v_mfma_f32_16x16x32_bf16 v[188:191], a[40:43], v[172:175], v[188:191]
    v_fmac_f32 v130, v242, v242
    v_fmac_f32 v130, v243, v243
    v_mfma_f32_16x16x32_bf16 v[188:191], a[44:47], v[196:199], v[188:191]
    v_fmac_f32 v130, v120, v120
    v_fmac_f32 v130, v121, v121
    v_mfma_f32_16x16x32_bf16 v[244:247], a[48:51], v[168:171], 0
    v_fmac_f32 v130, v122, v122
    v_fmac_f32 v130, v123, v123
    v_mfma_f32_16x16x32_bf16 v[244:247], a[52:55], v[132:135], v[244:247]
    v_fmac_f32 v130, v224, v224
    v_fmac_f32 v130, v225, v225
    v_mfma_f32_16x16x32_bf16 v[244:247], a[56:59], v[160:163], v[244:247]
    v_fmac_f32 v147, v188, v188
    v_fmac_f32 v147, v189, v189
    v_mfma_f32_16x16x32_bf16 v[244:247], a[60:63], v[112:115], v[244:247]
    v_fmac_f32 v147, v190, v190
    v_fmac_f32 v147, v191, v191
    v_mfma_f32_16x16x32_bf16 v[244:247], a[64:67], v[172:175], v[244:247]
    v_fmac_f32 v130, v226, v226
    v_fmac_f32 v130, v227, v227
    v_mfma_f32_16x16x32_bf16 v[244:247], a[68:71], v[196:199], v[244:247]
    v_mul_f32 v116, v146, v116
    v_mul_f32 v117, v146, v117
    v_mfma_f32_16x16x32_bf16 v[180:183], v[168:171], a[144:147], 0
    v_cvt_pk_bf16_f32 v164, v116, v117
    v_mul_f32 v118, v146, v118
    v_mfma_f32_16x16x32_bf16 v[180:183], v[132:135], a[148:151], v[180:183]
    v_mul_f32 v119, v146, v119
    v_cvt_pk_bf16_f32 v165, v118, v119
    v_mfma_f32_16x16x32_bf16 v[180:183], v[160:163], a[152:155], v[180:183]
    v_fmac_f32 v147, v244, v244
    v_fmac_f32 v147, v245, v245
    v_mfma_f32_16x16x32_bf16 v[180:183], v[112:115], a[156:159], v[180:183]
    v_fmac_f32 v147, v246, v246
    v_fmac_f32 v147, v247, v247
    v_mfma_f32_16x16x32_bf16 v[180:183], v[172:175], a[160:163], v[180:183]
    ds_read_b128 v[176:179], v0 offset:32768
    buffer_store_dwordx2 v[158:159], v18, s[12:15], s27 offen
    v_cvt_pk_bf16_f32 v38, v147, v130
    v_mul_f32 v208, v146, v208
    v_mfma_f32_16x16x32_bf16 v[180:183], v[196:199], a[164:167], v[180:183]
    ds_read_b128 v[152:155], v1 offset:32768
    v_mul_f32 v209, v146, v209
    v_mfma_f32_16x16x16_bf16 v[248:251], v[32:33], v[38:39], 0
    v_cvt_pk_bf16_f32 v166, v208, v209
    v_mul_f32 v210, v146, v210
    v_mfma_f32_16x16x32_bf16 v[184:187], v[168:171], a[168:171], 0
    ds_read_b128 v[216:219], v0 offset:32896
    v_mul_f32 v211, v146, v211
    v_mfma_f32_16x16x32_bf16 v[184:187], v[132:135], a[172:175], v[184:187]
    ds_read_b128 v[220:223], v1 offset:32896
    v_cvt_pk_bf16_f32 v130, v180, v181
    v_mfma_f32_16x16x32_bf16 v[184:187], v[160:163], a[176:179], v[184:187]
    ds_read_b128 v[124:127], v0 offset:33024
    v_cvt_pk_bf16_f32 v131, v182, v183
    v_mfma_f32_16x16x32_bf16 v[184:187], v[112:115], a[180:183], v[184:187]
    ds_read_b128 v[116:119], v1 offset:33024
    v_cvt_pk_bf16_f32 v167, v210, v211
    v_mfma_f32_16x16x32_bf16 v[184:187], v[172:175], a[184:187], v[184:187]
    s_waitcnt lgkmcnt(5)
    v_rsq_f32 v249, v249
    v_mfma_f32_16x16x32_bf16 v[184:187], v[196:199], a[188:191], v[184:187]
    v_rsq_f32 v248, v248
    v_mfma_f32_16x16x32_bf16 v[236:239], v[168:171], a[192:195], 0
    s_waitcnt lgkmcnt(4)
    v_mul_f32 v248, s31, v248
    v_mul_f32 v228, v146, v228
    v_mfma_f32_16x16x32_bf16 v[236:239], v[132:135], a[196:199], v[236:239]
    v_mul_f32 v229, v146, v229
    v_cvt_pk_bf16_f32 v140, v228, v229
    v_mfma_f32_16x16x32_bf16 v[236:239], v[160:163], a[200:203], v[236:239]
    s_waitcnt lgkmcnt(3)
    v_cvt_pk_bf16_f32 v158, v184, v185
    v_cvt_pk_bf16_f32 v159, v186, v187
    v_mfma_f32_16x16x32_bf16 v[236:239], v[112:115], a[204:207], v[236:239]
    s_waitcnt lgkmcnt(2)
    v_mul_f32 v230, v146, v230
    v_mul_f32 v231, v146, v231
    v_mfma_f32_16x16x32_bf16 v[236:239], v[172:175], a[208:211], v[236:239]
    s_waitcnt lgkmcnt(1)
    v_cvt_pk_bf16_f32 v141, v230, v231
    v_mul_f32 v240, v249, v240
    v_mfma_f32_16x16x32_bf16 v[236:239], v[196:199], a[212:215], v[236:239]
    s_waitcnt lgkmcnt(0)
    v_mul_f32 v241, v249, v241
    v_cvt_pk_bf16_f32 v180, v240, v241
    v_mfma_f32_16x16x32_bf16 v[208:211], a[72:75], v[176:179], 0
    v_mul_f32 v242, v249, v242
    v_mul_f32 v243, v249, v243
    v_mfma_f32_16x16x32_bf16 v[208:211], a[76:79], v[152:155], v[208:211]
    v_cvt_pk_bf16_f32 v181, v242, v243
    v_cvt_pk_bf16_f32 v146, v236, v237
    v_mfma_f32_16x16x32_bf16 v[208:211], a[80:83], v[216:219], v[208:211]
    buffer_store_dwordx4 v[164:167], v16, s[12:15], s27 offen
    v_cvt_pk_bf16_f32 v147, v238, v239
    v_mul_f32 v120, v249, v120
    v_mul_f32 v121, v249, v121
    v_cvt_pk_bf16_f32 v182, v120, v121
    v_mfma_f32_16x16x32_bf16 v[208:211], a[84:87], v[220:223], v[208:211]
    v_mul_f32 v122, v249, v122
    v_mul_f32 v123, v249, v123
    v_mfma_f32_16x16x32_bf16 v[208:211], a[88:91], v[124:127], v[208:211]
    v_cvt_pk_bf16_f32 v183, v122, v123
    v_mul_f32 v224, v249, v224
    v_mfma_f32_16x16x32_bf16 v[208:211], a[92:95], v[116:119], v[208:211]
    v_mul_f32 v225, v249, v225
    v_cvt_pk_bf16_f32 v170, v224, v225
    v_mfma_f32_16x16x32_bf16 v[164:167], a[96:99], v[176:179], 0
    v_mul_f32 v226, v249, v226
    v_mul_f32 v227, v249, v227
    v_mfma_f32_16x16x32_bf16 v[164:167], a[100:103], v[152:155], v[164:167]
    v_cvt_pk_bf16_f32 v171, v226, v227
    v_mul_f32 v136, v248, v136
    v_mfma_f32_16x16x32_bf16 v[164:167], a[104:107], v[216:219], v[164:167]
    s_waitcnt vmcnt(3)
    v_mul_f32 v137, v248, v137
    v_cvt_pk_bf16_f32 v132, v136, v137
    v_mfma_f32_16x16x32_bf16 v[164:167], a[108:111], v[220:223], v[164:167]
    s_nop 0
    v_mul_f32 v138, v248, v138
    v_mul_f32 v139, v248, v139
    v_mfma_f32_16x16x32_bf16 v[164:167], a[112:115], v[124:127], v[164:167]
    s_barrier
    v_cvt_pk_bf16_f32 v133, v138, v139
    v_mul_f32 v188, v248, v188
    v_mfma_f32_16x16x32_bf16 v[164:167], a[116:119], v[116:119], v[164:167]
    s_nop 0
    v_mul_f32 v189, v248, v189
    v_cvt_pk_bf16_f32 v134, v188, v189
    v_mfma_f32_16x16x32_bf16 v[112:115], a[120:123], v[176:179], 0
    s_nop 0
    v_mul_f32 v190, v248, v190
    v_mul_f32 v191, v248, v191
    v_mfma_f32_16x16x32_bf16 v[112:115], a[124:127], v[152:155], v[112:115]
    v_cvt_pk_bf16_f32 v135, v190, v191
    v_mul_f32 v244, v248, v244
    v_mfma_f32_16x16x32_bf16 v[112:115], a[128:131], v[216:219], v[112:115]
    v_mul_f32 v245, v248, v245
    v_cvt_pk_bf16_f32 v168, v244, v245
    v_mfma_f32_16x16x32_bf16 v[112:115], a[132:135], v[220:223], v[112:115]
    v_mul_f32 v246, v248, v246
    v_mul_f32 v247, v248, v247
    v_mfma_f32_16x16x32_bf16 v[112:115], a[136:139], v[124:127], v[112:115]
    v_cvt_pk_bf16_f32 v169, v246, v247
    v_fma_f32 v142, v208, v208, s32
    v_mfma_f32_16x16x32_bf16 v[112:115], a[140:143], v[116:119], v[112:115]
    v_fmac_f32 v142, v209, v209
    v_fmac_f32 v142, v210, v210
    v_mfma_f32_16x16x32_bf16 v[188:191], a[0:3], v[176:179], 0
    v_fmac_f32 v142, v211, v211
    v_fmac_f32 v142, v164, v164
    v_mfma_f32_16x16x32_bf16 v[188:191], a[4:7], v[152:155], v[188:191]
    buffer_load_dwordx4 v10, s[8:11], s23 offen nt lds
    v_fmac_f32 v142, v165, v165
    v_mfma_f32_16x16x32_bf16 v[188:191], a[8:11], v[216:219], v[188:191]
    s_add_u32 m0, s28, 4096
    v_fmac_f32 v142, v166, v166
    v_fmac_f32 v142, v167, v167
    v_mfma_f32_16x16x32_bf16 v[188:191], a[12:15], v[220:223], v[188:191]
    v_fmac_f32 v142, v112, v112
    v_fmac_f32 v142, v113, v113
    v_mfma_f32_16x16x32_bf16 v[188:191], a[16:19], v[124:127], v[188:191]
    v_fmac_f32 v142, v114, v114
    v_fmac_f32 v142, v115, v115
    v_mfma_f32_16x16x32_bf16 v[188:191], a[20:23], v[116:119], v[188:191]
    v_mul_f32 v148, v108, v148
    v_mul_f32 v149, v108, v149
    v_mfma_f32_16x16x32_bf16 v[136:139], a[24:27], v[176:179], 0
    buffer_load_dwordx4 v11, s[8:11], s23 offen nt lds
    v_cvt_pk_bf16_f32 v160, v148, v149
    v_mfma_f32_16x16x32_bf16 v[136:139], a[28:31], v[152:155], v[136:139]
    s_add_u32 m0, s28, 8192
    v_mul_f32 v150, v108, v150
    v_fma_f32 v143, v188, v188, s32
    v_mfma_f32_16x16x32_bf16 v[136:139], a[32:35], v[216:219], v[136:139]
    v_fmac_f32 v143, v189, v189
    v_fmac_f32 v143, v190, v190
    v_mfma_f32_16x16x32_bf16 v[136:139], a[36:39], v[220:223], v[136:139]
    v_fmac_f32 v143, v191, v191
    v_mul_f32 v151, v108, v151
    v_mfma_f32_16x16x32_bf16 v[136:139], a[40:43], v[124:127], v[136:139]
    v_cvt_pk_bf16_f32 v161, v150, v151
    v_mul_f32 v200, v108, v200
    v_mfma_f32_16x16x32_bf16 v[136:139], a[44:47], v[116:119], v[136:139]
    buffer_load_dwordx4 v12, s[8:11], s23 offen nt lds
    v_mul_f32 v201, v108, v201
    v_mfma_f32_16x16x32_bf16 v[148:151], a[48:51], v[176:179], 0
    s_add_u32 m0, s28, 12288
    v_cvt_pk_bf16_f32 v162, v200, v201
    v_mul_f32 v202, v108, v202
    v_mfma_f32_16x16x32_bf16 v[148:151], a[52:55], v[152:155], v[148:151]
    s_xor_b32 s28, s28, 65536
    v_fmac_f32 v143, v136, v136
    v_fmac_f32 v143, v137, v137
    v_mfma_f32_16x16x32_bf16 v[148:151], a[56:59], v[216:219], v[148:151]
    v_fmac_f32 v143, v138, v138
    v_fmac_f32 v143, v139, v139
    v_mfma_f32_16x16x32_bf16 v[148:151], a[60:63], v[220:223], v[148:151]
    v_mul_f32 v203, v108, v203
    v_cvt_pk_bf16_f32 v163, v202, v203
    v_mfma_f32_16x16x32_bf16 v[148:151], a[64:67], v[124:127], v[148:151]
    buffer_load_dwordx4 v13, s[8:11], s23 offen nt lds
    ds_read_b128 v[120:123], v5 offset:0
    v_mfma_f32_16x16x32_bf16 v[148:151], a[68:71], v[116:119], v[148:151]
    s_mov_b32 m0, s29
    ds_read_b128 v[228:231], v5 offset:16
    ds_read_b128 v[200:203], v5 offset:48
    v_mfma_f32_16x16x32_bf16 v[184:187], v[176:179], a[144:147], 0
    s_xor_b32 s29, s29, s30
    ds_read_b32 v224, v6 offset:192
    ds_read2_b32 v[110:111], v6 offset0:0 offset1:0
    v_mfma_f32_16x16x32_bf16 v[184:187], v[152:155], a[148:151], v[184:187]
    s_add_u32 s19, s19, s20
    ds_read2_b32 v[174:175], v6 offset0:16 offset1:16
    ds_read2_b32 v[198:199], v6 offset0:32 offset1:32
    v_mfma_f32_16x16x32_bf16 v[184:187], v[216:219], a[152:155], v[184:187]
    v_fmac_f32 v143, v148, v148
    v_fmac_f32 v143, v149, v149
    v_mfma_f32_16x16x32_bf16 v[184:187], v[220:223], a[156:159], v[184:187]
    buffer_store_dwordx2 v[140:141], v19, s[12:15], s27 offen
    v_fmac_f32 v143, v150, v150
    v_fmac_f32 v143, v151, v151
    v_mfma_f32_16x16x32_bf16 v[184:187], v[124:127], a[160:163], v[184:187]
    v_cvt_pk_bf16_f32 v38, v143, v142
    v_mul_f32 v232, v108, v232
    v_mfma_f32_16x16x32_bf16 v[184:187], v[116:119], a[164:167], v[184:187]
    v_mul_f32 v233, v108, v233
    v_cvt_pk_bf16_f32 v232, v232, v233
    v_mfma_f32_16x16x16_bf16 v[140:143], v[32:33], v[38:39], 0
    s_waitcnt lgkmcnt(5)
    v_mul_f32 v234, v108, v234
    v_mul_f32 v235, v108, v235
    v_mfma_f32_16x16x32_bf16 v[236:239], v[120:123], v[204:207], v[22:25]
    s_waitcnt lgkmcnt(3)
    v_cvt_pk_bf16_f32 v108, v184, v185
    v_cvt_pk_bf16_f32 v109, v186, v187
    v_mfma_f32_16x16x32_bf16 v[236:239], v[228:231], v[212:215], v[236:239]
    s_waitcnt lgkmcnt(1)
    v_rsq_f32 v141, v141
    v_mfma_f32_16x16x32_bf16 v[236:239], v[200:203], v[192:195], v[236:239]
    s_waitcnt lgkmcnt(0)
    v_rsq_f32 v140, v140
    v_mfma_f32_16x16x32_bf16 v[184:187], v[120:123], v[132:135], v[24:27]
    v_mul_f32 v140, s31, v140
    v_mul_f32 v208, v141, v208
    v_mfma_f32_16x16x32_bf16 v[184:187], v[228:231], v[180:183], v[184:187]
    v_mul_f32 v209, v141, v209
    v_cvt_pk_bf16_f32 v208, v208, v209
    v_mfma_f32_16x16x32_bf16 v[184:187], v[200:203], v[168:171], v[184:187]
    v_mov_b32_dpp v224, v237 quad_perm:[0,1,2,3] row_mask:0x1 bank_mask:0xf
    v_mul_f32 v210, v141, v210
    v_mfma_f32_16x16x32_bf16 v[240:243], v[176:179], a[168:171], 0
    v_mul_f32 v211, v141, v211
    v_cvt_pk_bf16_f32 v209, v210, v211
    v_mfma_f32_16x16x32_bf16 v[240:243], v[152:155], a[172:175], v[240:243]
    v_mul_f32 v164, v141, v164
    v_mul_f32 v165, v141, v165
    v_mfma_f32_16x16x32_bf16 v[240:243], v[216:219], a[176:179], v[240:243]
    v_cvt_pk_bf16_f32 v210, v164, v165
    v_mul_f32 v166, v141, v166
    v_mfma_f32_16x16x32_bf16 v[240:243], v[220:223], a[180:183], v[240:243]
    v_mul_f32 v167, v141, v167
    v_cvt_pk_bf16_f32 v211, v166, v167
    v_mfma_f32_16x16x32_bf16 v[240:243], v[124:127], a[184:187], v[240:243]
    v_mul_f32 v112, v141, v112
    v_mul_f32 v113, v141, v113
    v_mfma_f32_16x16x32_bf16 v[240:243], v[116:119], a[188:191], v[240:243]
    v_cvt_pk_bf16_f32 v166, v112, v113
    v_mul_f32 v114, v141, v114
    v_mfma_f32_16x16x32_bf16 v[244:247], v[176:179], a[192:195], 0
    ds_read_b128 v[176:179], v2 offset:0
    v_mul_f32 v115, v141, v115
    v_mfma_f32_16x16x32_bf16 v[244:247], v[152:155], a[196:199], v[244:247]
    ds_read_b128 v[152:155], v2 offset:1024
    buffer_store_dwordx4 v[160:163], v17, s[12:15], s27 offen
    v_cvt_pk_bf16_f32 v172, v240, v241
    v_cvt_pk_bf16_f32 v173, v242, v243
    v_cvt_pk_bf16_f32 v167, v114, v115
    v_mul_f32 v188, v140, v188
    v_mfma_f32_16x16x32_bf16 v[240:243], v[212:215], v[204:207], v[40:43]
    v_mul_f32 v189, v140, v189
    v_cvt_pk_bf16_f32 v112, v188, v189
    v_mfma_f32_16x16x32_bf16 v[248:251], v[180:183], v[204:207], v[44:47]
    v_mul_f32 v190, v140, v190
    v_mul_f32 v191, v140, v191
    v_mfma_f32_16x16x32_bf16 v[160:163], v[208:211], v[204:207], v[48:51]
    v_cvt_pk_bf16_f32 v113, v190, v191
    v_mul_f32 v136, v140, v136
    v_mfma_f32_16x16x16_bf16 v[240:243], v[194:195], v[192:193], v[240:243]
    v_mul_f32 v137, v140, v137
    v_cvt_pk_bf16_f32 v114, v136, v137
    v_mfma_f32_16x16x16_bf16 v[248:251], v[170:171], v[192:193], v[248:251]
    v_mul_f32 v138, v140, v138
    v_mul_f32 v139, v140, v139
    v_mfma_f32_16x16x16_bf16 v[160:163], v[166:167], v[192:193], v[160:163]
    s_waitcnt lgkmcnt(1)
    v_cvt_pk_bf16_f32 v115, v138, v139
    v_mul_f32 v148, v140, v148
    v_mfma_f32_16x16x32_bf16 v[244:247], v[216:219], a[200:203], v[244:247]
    s_waitcnt lgkmcnt(0)
    ds_read_b128 v[216:219], v2 offset:2048
    v_mul_f32 v149, v140, v149
    v_mfma_f32_16x16x32_bf16 v[244:247], v[220:223], a[204:207], v[244:247]
    ds_read_b128 v[204:207], v2 offset:3072
    v_cvt_pk_bf16_f32 v164, v148, v149
    v_mfma_f32_16x16x32_bf16 v[244:247], v[124:127], a[208:211], v[244:247]
    ds_read_b128 v[124:127], v2 offset:4096
    v_mul_f32 v150, v140, v150
    v_mfma_f32_16x16x32_bf16 v[244:247], v[116:119], a[212:215], v[244:247]
    ds_read_b128 v[116:119], v2 offset:5120
    v_mul_f32 v151, v140, v151
    v_mfma_f32_16x16x32_bf16 v[220:223], v[120:123], v[112:115], v[26:29]
    v_cvt_pk_bf16_f32 v165, v150, v151
    v_mov_b32_dpp v224, v185 quad_perm:[0,1,2,3] row_mask:0x2 bank_mask:0xf
    v_mfma_f32_16x16x32_bf16 v[220:223], v[228:231], v[208:211], v[220:223]
    v_cvt_pk_bf16_f32 v233, v234, v235
    v_xor_b32 v0, 65536, v0
    v_mfma_f32_16x16x32_bf16 v[220:223], v[200:203], v[164:167], v[220:223]
    v_cvt_pk_bf16_f32 v196, v244, v245
    v_cvt_pk_bf16_f32 v197, v246, v247
    v_mfma_f32_16x16x32_bf16 v[140:143], a[216:219], v[176:179], 0
    v_exp_f32 v184, v184
    v_mfma_f32_16x16x32_bf16 v[140:143], a[220:223], v[152:155], v[140:143]
    s_waitcnt lgkmcnt(3)
    v_exp_f32 v240, v240
    v_mfma_f32_16x16x32_bf16 v[140:143], a[224:227], v[216:219], v[140:143]
    s_waitcnt lgkmcnt(2)
    v_exp_f32 v220, v220
    v_mfma_f32_16x16x32_bf16 v[140:143], a[228:231], v[204:207], v[140:143]
    s_waitcnt lgkmcnt(1)
    buffer_store_dwordx2 v[232:233], v20, s[12:15], s27 offen
    v_mov_b32_dpp v224, v221 quad_perm:[0,1,2,3] row_mask:0x4 bank_mask:0xf
    v_xor_b32 v1, 65536, v1
    v_mfma_f32_16x16x32_bf16 v[140:143], a[232:235], v[124:127], v[140:143]
    s_waitcnt lgkmcnt(0)
    v_exp_f32 v224, v224
    v_mfma_f32_16x16x32_bf16 v[140:143], a[236:239], v[116:119], v[140:143]
    s_mov_b32 s27, s26
    v_cvt_pk_bf16_f32 v224, v224, v224
    v_add_u32 v5, 336, v5
    v_mfma_f32_16x16x32_bf16 v[188:191], a[240:243], v[176:179], 0
    s_mov_b32 s26, s25
    ds_write_b16 v8, v224
    v_mfma_f32_16x16x32_bf16 v[188:191], a[244:247], v[152:155], v[188:191]
    s_mov_b32 s25, s24
    v_exp_f32 v241, v241
    v_mfma_f32_16x16x32_bf16 v[188:191], a[248:251], v[216:219], v[188:191]
    s_mov_b32 s24, s23
    ds_read_b128 v[136:139], v2 offset:6144
    ds_read_b128 v[200:203], v2 offset:7168
    v_mfma_f32_16x16x32_bf16 v[188:191], a[252:255], v[204:207], v[188:191]
    ds_read_b128 v[232:235], v2 offset:8192
    ds_read_b128 v[228:231], v9
    v_mfma_f32_16x16x32_bf16 v[188:191], v[76:79], v[124:127], v[188:191]
    ds_read_b128 v[148:151], v2 offset:9216
    ds_read_b128 v[120:123], v9 offset:64
    v_mfma_f32_16x16x32_bf16 v[188:191], v[80:83], v[116:119], v[188:191]
    ds_read_b128 v[224:227], v2 offset:10240
    v_cvt_pk_bf16_f32 v240, v240, v241
    v_mfma_f32_16x16x32_bf16 v[244:247], v[84:87], v[176:179], 0
    ds_read_b128 v[176:179], v2 offset:11264
    v_fma_f32 v221, v140, v140, s33
    v_mfma_f32_16x16x32_bf16 v[244:247], v[88:91], v[152:155], v[244:247]
    v_exp_f32 v242, v242
    v_mfma_f32_16x16x32_bf16 v[244:247], v[92:95], v[216:219], v[244:247]
    v_exp_f32 v243, v243
    v_mfma_f32_16x16x32_bf16 v[244:247], v[96:99], v[204:207], v[244:247]
    v_cvt_pk_bf16_f32 v241, v242, v243
    v_fmac_f32 v221, v141, v141
    v_mfma_f32_16x16x32_bf16 v[244:247], v[100:103], v[124:127], v[244:247]
    s_waitcnt lgkmcnt(6)
    v_exp_f32 v248, v248
    v_mfma_f32_16x16x32_bf16 v[244:247], v[104:107], v[116:119], v[244:247]
    s_waitcnt lgkmcnt(4)
    v_exp_f32 v249, v249
    v_mfma_f32_16x16x32_bf16 v[204:207], v[228:231], v[28:31], 0
    s_waitcnt lgkmcnt(2)
    v_cvt_pk_bf16_f32 v242, v248, v249
    v_fmac_f32 v221, v142, v142
    v_mfma_f32_16x16x32_bf16 v[204:207], v[120:123], v[28:31], v[204:207]
    s_waitcnt lgkmcnt(1)
    v_exp_f32 v250, v250
    v_mfma_f32_16x16x32_bf16 v[152:155], v[228:231], v[128:131], 0
    s_waitcnt lgkmcnt(0)
    buffer_load_dwordx4 v14, s[8:11], s23 offen nt lds
    v_fmac_f32 v221, v143, v143
    v_mfma_f32_16x16x32_bf16 v[152:155], v[120:123], v[108:111], v[152:155]
    s_add_u32 s23, s23, s21
    v_rcp_f32 v204, v204
    v_mfma_f32_16x16x32_bf16 v[116:119], v[228:231], v[156:159], 0
    s_cmp_ge_u32 s19, 72
    v_exp_f32 v251, v251
    v_mfma_f32_16x16x32_bf16 v[116:119], v[120:123], v[172:175], v[116:119]
    s_cselect_b32 s34, 72, 0
    v_cvt_pk_bf16_f32 v243, v250, v251
    v_mul_f32 v152, v152, v204
    v_mfma_f32_16x16x32_bf16 v[124:127], v[228:231], v[144:147], 0
    s_cselect_b32 s35, s22, 0
    v_exp_f32 v160, v160
    v_mfma_f32_16x16x32_bf16 v[124:127], v[120:123], v[196:199], v[124:127]
    s_sub_u32 s19, s19, s34
    v_mul_f32_dpp v152, v116, v204 quad_perm:[0,1,2,3] row_mask:0x2 bank_mask:0xf
    v_fmac_f32 v221, v188, v188
    v_mfma_f32_16x16x32_bf16 v[116:119], a[216:219], v[136:139], 0
    s_add_u32 s23, s23, s35
    v_exp_f32 v161, v161
    v_mfma_f32_16x16x32_bf16 v[116:119], a[220:223], v[200:203], v[116:119]
    s_add_u32 s18, s18, 1
    v_mul_f32_dpp v152, v124, v204 quad_perm:[0,1,2,3] row_mask:0x4 bank_mask:0xf
    v_cvt_pk_bf16_f32 v152, v152, v152
    v_mfma_f32_16x16x32_bf16 v[116:119], a[224:227], v[232:235], v[116:119]
    s_cmp_lt_u32 s18, s17
    ds_write_b16 v7, v152
    v_mfma_f32_16x16x32_bf16 v[116:119], a[228:231], v[148:151], v[116:119]
    v_cvt_pk_bf16_f32 v36, v160, v161
    v_fmac_f32 v221, v189, v189
    v_mfma_f32_16x16x32_bf16 v[116:119], a[232:235], v[224:227], v[116:119]
    v_exp_f32 v162, v162
    v_mfma_f32_16x16x32_bf16 v[116:119], a[236:239], v[176:179], v[116:119]
    v_exp_f32 v163, v163
    v_mfma_f32_16x16x32_bf16 v[204:207], v[212:215], v[132:135], v[52:55]
    v_cvt_pk_bf16_f32 v37, v162, v163
    v_fmac_f32 v221, v190, v190
    v_mfma_f32_16x16x32_bf16 v[152:155], v[180:183], v[132:135], v[56:59]
    v_exp_f32 v236, v236
    v_mfma_f32_16x16x32_bf16 v[124:127], v[208:211], v[132:135], v[60:63]
    v_cvt_pk_bf16_f32 v38, v236, 0
    v_fma_f32 v222, v116, v116, s33
    v_mfma_f32_16x16x16_bf16 v[204:207], v[194:195], v[168:169], v[204:207]
    v_fmac_f32 v222, v117, v117
    v_fmac_f32 v222, v118, v118
    v_mfma_f32_16x16x16_bf16 v[152:155], v[170:171], v[168:169], v[152:155]
    v_fmac_f32 v222, v119, v119
    v_fmac_f32 v221, v191, v191
    v_mfma_f32_16x16x16_bf16 v[124:127], v[166:167], v[168:169], v[124:127]
    v_fmac_f32 v221, v244, v244
    v_fmac_f32 v221, v245, v245
    v_mfma_f32_16x16x32_bf16 v[216:219], v[28:31], v[36:39], 0
    v_exp_f32 v204, v204
    v_mfma_f32_16x16x32_bf16 v[216:219], v[28:31], v[240:243], v[216:219]
    v_exp_f32 v205, v205
    v_mfma_f32_16x16x32_bf16 v[132:135], v[108:111], v[36:39], 0
    v_cvt_pk_bf16_f32 v204, v204, v205
    v_fmac_f32 v221, v246, v246
    v_mfma_f32_16x16x32_bf16 v[132:135], v[128:131], v[240:243], v[132:135]
    v_exp_f32 v206, v206
    v_mfma_f32_16x16x32_bf16 v[160:163], v[172:175], v[36:39], 0
    v_exp_f32 v207, v207
    v_mfma_f32_16x16x32_bf16 v[160:163], v[156:159], v[240:243], v[160:163]
    v_rcp_f32 v216, v216
    v_mfma_f32_16x16x32_bf16 v[120:123], v[196:199], v[36:39], 0
    v_cvt_pk_bf16_f32 v205, v206, v207
    v_cvt_pk_bf16_f32 v38, v184, 0
    v_mfma_f32_16x16x32_bf16 v[120:123], v[144:147], v[240:243], v[120:123]
    v_mul_f32 v132, v216, v132
    v_mul_f32 v133, v216, v133
    v_mfma_f32_16x16x32_bf16 v[240:243], v[212:215], v[112:115], v[64:67]
    v_cvt_pk_bf16_f32 v192, v132, v133
    v_mul_f32 v134, v216, v134
    v_mfma_f32_16x16x32_bf16 v[212:215], v[180:183], v[112:115], v[68:71]
    v_mul_f32 v135, v216, v135
    v_cvt_pk_bf16_f32 v193, v134, v135
    v_mfma_f32_16x16x32_bf16 v[180:183], v[208:211], v[112:115], v[72:75]
    v_mul_f32 v160, v216, v160
    v_mul_f32 v161, v216, v161
    v_mfma_f32_16x16x16_bf16 v[240:243], v[194:195], v[164:165], v[240:243]
    v_cvt_pk_bf16_f32 v194, v160, v161
    v_mul_f32 v162, v216, v162
    v_mfma_f32_16x16x16_bf16 v[212:215], v[170:171], v[164:165], v[212:215]
    v_mul_f32 v163, v216, v163
    v_cvt_pk_bf16_f32 v195, v162, v163
    v_mfma_f32_16x16x16_bf16 v[180:183], v[166:167], v[164:165], v[180:183]
    ds_write_b128 v3, v[192:195] offset:0
    v_mfma_f32_16x16x32_bf16 v[208:211], a[240:243], v[136:139], 0
    v_exp_f32 v240, v240
    v_mfma_f32_16x16x32_bf16 v[208:211], a[244:247], v[200:203], v[208:211]
    v_exp_f32 v241, v241
    v_mfma_f32_16x16x32_bf16 v[208:211], a[248:251], v[232:235], v[208:211]
    ds_read_b128 v[164:167], v2 offset:12288
    ds_read_b128 v[132:135], v2 offset:13312
    v_mfma_f32_16x16x32_bf16 v[208:211], a[252:255], v[148:151], v[208:211]
    ds_read_b128 v[168:171], v2 offset:14336
    v_cvt_pk_bf16_f32 v160, v240, v241
    v_mfma_f32_16x16x32_bf16 v[208:211], v[76:79], v[224:227], v[208:211]
    ds_read_b128 v[192:195], v2 offset:15360
    v_mul_f32 v120, v216, v120
    v_mfma_f32_16x16x32_bf16 v[208:211], v[80:83], v[176:179], v[208:211]
    ds_read_b128 v[112:115], v2 offset:16384
    v_mul_f32 v121, v216, v121
    v_mfma_f32_16x16x32_bf16 v[228:231], v[84:87], v[136:139], 0
    ds_read_b128 v[136:139], v2 offset:17408
    v_cvt_pk_bf16_f32 v206, v120, v121
    v_mfma_f32_16x16x32_bf16 v[228:231], v[88:91], v[200:203], v[228:231]
    v_exp_f32 v242, v242
    v_mfma_f32_16x16x32_bf16 v[228:231], v[92:95], v[232:235], v[228:231]
    v_exp_f32 v243, v243
    v_mfma_f32_16x16x32_bf16 v[228:231], v[96:99], v[148:151], v[228:231]
    v_cvt_pk_bf16_f32 v161, v242, v243
    v_mul_f32 v122, v216, v122
    v_mfma_f32_16x16x32_bf16 v[228:231], v[100:103], v[224:227], v[228:231]
    s_waitcnt lgkmcnt(4)
    v_exp_f32 v212, v212
    v_mfma_f32_16x16x32_bf16 v[228:231], v[104:107], v[176:179], v[228:231]
    s_waitcnt lgkmcnt(3)
    v_exp_f32 v213, v213
    v_mfma_f32_16x16x32_bf16 v[148:151], a[216:219], v[164:167], 0
    s_waitcnt lgkmcnt(2)
    v_cvt_pk_bf16_f32 v162, v212, v213
    v_mul_f32 v123, v216, v123
    v_mfma_f32_16x16x32_bf16 v[148:151], a[220:223], v[132:135], v[148:151]
    s_waitcnt lgkmcnt(1)
    v_exp_f32 v214, v214
    v_mfma_f32_16x16x32_bf16 v[148:151], a[224:227], v[168:171], v[148:151]
    s_waitcnt lgkmcnt(0)
    v_exp_f32 v215, v215
    v_mfma_f32_16x16x32_bf16 v[148:151], a[228:231], v[192:195], v[148:151]
    v_cvt_pk_bf16_f32 v163, v214, v215
    v_cvt_pk_bf16_f32 v207, v122, v123
    v_mfma_f32_16x16x32_bf16 v[148:151], a[232:235], v[112:115], v[148:151]
    ds_write_b64 v4, v[206:207] offset:4096
    v_mfma_f32_16x16x32_bf16 v[148:151], a[236:239], v[136:139], v[148:151]
    v_exp_f32 v180, v180
    v_mfma_f32_16x16x32_bf16 v[200:203], a[240:243], v[164:167], 0
    ds_read_b128 v[212:215], v0 offset:20480
    ds_read_b128 v[176:179], v1 offset:20480
    v_mfma_f32_16x16x32_bf16 v[200:203], a[244:247], v[132:135], v[200:203]
    ds_read_b128 v[216:219], v0 offset:20608
    v_fmac_f32 v222, v208, v208
    v_mfma_f32_16x16x32_bf16 v[200:203], a[248:251], v[168:171], v[200:203]
    ds_read_b128 v[120:123], v1 offset:20608
    v_fmac_f32 v222, v209, v209
    v_mfma_f32_16x16x32_bf16 v[200:203], a[252:255], v[192:195], v[200:203]
    ds_read_b128 v[240:243], v0 offset:20736
    v_fmac_f32 v222, v210, v210
    v_mfma_f32_16x16x32_bf16 v[200:203], v[76:79], v[112:115], v[200:203]
    ds_read_b128 v[224:227], v1 offset:20736
    v_fmac_f32 v222, v211, v211
    v_mfma_f32_16x16x32_bf16 v[200:203], v[80:83], v[136:139], v[200:203]
    v_exp_f32 v181, v181
    v_mfma_f32_16x16x32_bf16 v[232:235], v[84:87], v[164:167], 0
    v_exp_f32 v182, v182
    v_mfma_f32_16x16x32_bf16 v[232:235], v[88:91], v[132:135], v[232:235]
    v_exp_f32 v183, v183
    v_mfma_f32_16x16x32_bf16 v[232:235], v[92:95], v[168:171], v[232:235]
    s_waitcnt lgkmcnt(4)
    v_exp_f32 v152, v152
    v_mfma_f32_16x16x32_bf16 v[232:235], v[96:99], v[192:195], v[232:235]
    s_waitcnt lgkmcnt(3)
    v_exp_f32 v153, v153
    v_mfma_f32_16x16x32_bf16 v[232:235], v[100:103], v[112:115], v[232:235]
    s_waitcnt lgkmcnt(2)
    v_cvt_pk_bf16_f32 v206, v152, v153
    v_fmac_f32 v222, v228, v228
    v_mfma_f32_16x16x32_bf16 v[232:235], v[104:107], v[136:139], v[232:235]
    s_waitcnt lgkmcnt(1)
    v_exp_f32 v154, v154
    v_mfma_f32_16x16x32_bf16 v[192:195], a[72:75], v[212:215], 0
    s_waitcnt lgkmcnt(0)
    v_exp_f32 v155, v155
    v_mfma_f32_16x16x32_bf16 v[192:195], a[76:79], v[176:179], v[192:195]
    v_cvt_pk_bf16_f32 v207, v154, v155
    v_fmac_f32 v222, v229, v229
    v_mfma_f32_16x16x32_bf16 v[192:195], a[80:83], v[216:219], v[192:195]
    v_exp_f32 v124, v124
    v_mfma_f32_16x16x32_bf16 v[192:195], a[84:87], v[120:123], v[192:195]
    v_exp_f32 v125, v125
    v_mfma_f32_16x16x32_bf16 v[192:195], a[88:91], v[240:243], v[192:195]
    v_cvt_pk_bf16_f32 v36, v124, v125
    v_fmac_f32 v222, v230, v230
    v_mfma_f32_16x16x32_bf16 v[192:195], a[92:95], v[224:227], v[192:195]
    v_exp_f32 v126, v126
    v_mfma_f32_16x16x32_bf16 v[152:155], a[96:99], v[212:215], 0
    v_exp_f32 v127, v127
    v_mfma_f32_16x16x32_bf16 v[152:155], a[100:103], v[176:179], v[152:155]
    v_cvt_pk_bf16_f32 v37, v126, v127
    v_fmac_f32 v222, v231, v231
    v_mfma_f32_16x16x32_bf16 v[152:155], a[104:107], v[216:219], v[152:155]
    v_fma_f32 v223, v148, v148, s33
    v_fmac_f32 v223, v149, v149
    v_mfma_f32_16x16x32_bf16 v[124:127], v[28:31], v[36:39], 0
    v_fmac_f32 v223, v150, v150
    v_fmac_f32 v223, v151, v151
    v_mfma_f32_16x16x32_bf16 v[124:127], v[28:31], v[204:207], v[124:127]
    v_fmac_f32 v223, v200, v200
    v_fmac_f32 v223, v201, v201
    v_mfma_f32_16x16x32_bf16 v[164:167], v[108:111], v[36:39], 0
    v_fmac_f32 v223, v202, v202
    v_fmac_f32 v223, v203, v203
    v_mfma_f32_16x16x32_bf16 v[164:167], v[128:131], v[204:207], v[164:167]
    v_fmac_f32 v223, v232, v232
    v_fmac_f32 v223, v233, v233
    v_mfma_f32_16x16x32_bf16 v[168:171], v[172:175], v[36:39], 0
    v_rcp_f32 v124, v124
    v_mfma_f32_16x16x32_bf16 v[168:171], v[156:159], v[204:207], v[168:171]
    v_fmac_f32 v223, v234, v234
    v_fmac_f32 v223, v235, v235
    v_mfma_f32_16x16x32_bf16 v[132:135], v[196:199], v[36:39], 0
    v_cvt_pk_bf16_f32 v36, v180, v181
    v_cvt_pk_bf16_f32 v37, v182, v183
    v_mfma_f32_16x16x32_bf16 v[132:135], v[144:147], v[204:207], v[132:135]
    v_cvt_pk_bf16_f32 v38, v220, 0
    v_mul_f32 v164, v124, v164
    v_mfma_f32_16x16x32_bf16 v[152:155], a[108:111], v[120:123], v[152:155]
    v_mul_f32 v165, v124, v165
    v_cvt_pk_bf16_f32 v204, v164, v165
    v_mfma_f32_16x16x32_bf16 v[180:183], v[28:31], v[36:39], 0
    v_mul_f32 v166, v124, v166
    v_mul_f32 v167, v124, v167
    v_mfma_f32_16x16x32_bf16 v[180:183], v[28:31], v[160:163], v[180:183]
    v_cvt_pk_bf16_f32 v205, v166, v167
    v_mul_f32 v168, v124, v168
    v_mfma_f32_16x16x32_bf16 v[164:167], v[108:111], v[36:39], 0
    v_mul_f32 v169, v124, v169
    v_cvt_pk_bf16_f32 v206, v168, v169
    v_mfma_f32_16x16x32_bf16 v[164:167], v[128:131], v[160:163], v[164:167]
    v_mul_f32 v170, v124, v170
    v_mul_f32 v171, v124, v171
    v_mfma_f32_16x16x32_bf16 v[128:131], v[172:175], v[36:39], 0
    v_cvt_pk_bf16_f32 v207, v170, v171
    v_mul_f32 v132, v124, v132
    v_mfma_f32_16x16x32_bf16 v[128:131], v[156:159], v[160:163], v[128:131]
    ds_write_b128 v3, v[204:207] offset:6144
    v_mfma_f32_16x16x32_bf16 v[156:159], v[196:199], v[36:39], 0
    v_mul_f32 v133, v124, v133
    v_cvt_pk_bf16_f32 v132, v132, v133
    v_mfma_f32_16x16x32_bf16 v[156:159], v[144:147], v[160:163], v[156:159]
    v_mul_f32 v134, v124, v134
    v_mul_f32 v135, v124, v135
    v_mfma_f32_16x16x32_bf16 v[152:155], a[112:115], v[240:243], v[152:155]
    v_cvt_pk_bf16_f32 v133, v134, v135
    v_cvt_pk_bf16_f32 v223, v223, v223
    v_mfma_f32_16x16x32_bf16 v[152:155], a[116:119], v[224:227], v[152:155]
    ds_write_b64 v4, v[132:133] offset:10240
    v_mfma_f32_16x16x32_bf16 v[144:147], a[120:123], v[212:215], 0
    v_rcp_f32 v180, v180
    v_mfma_f32_16x16x32_bf16 v[144:147], a[124:127], v[176:179], v[144:147]
    v_mul_f32 v164, v180, v164
    v_mul_f32 v165, v180, v165
    v_mfma_f32_16x16x32_bf16 v[144:147], a[128:131], v[216:219], v[144:147]
    v_cvt_pk_bf16_f32 v204, v164, v165
    v_mul_f32 v166, v180, v166
    v_mfma_f32_16x16x32_bf16 v[144:147], a[132:135], v[120:123], v[144:147]
    v_mul_f32 v167, v180, v167
    v_cvt_pk_bf16_f32 v205, v166, v167
    v_mfma_f32_16x16x32_bf16 v[144:147], a[136:139], v[240:243], v[144:147]
    v_mul_f32 v128, v180, v128
    v_mul_f32 v129, v180, v129
    v_mfma_f32_16x16x32_bf16 v[144:147], a[140:143], v[224:227], v[144:147]
    v_cvt_pk_bf16_f32 v206, v128, v129
    v_mul_f32 v130, v180, v130
    v_mfma_f32_16x16x32_bf16 v[124:127], a[0:3], v[212:215], 0
    v_mul_f32 v131, v180, v131
    v_cvt_pk_bf16_f32 v207, v130, v131
    v_mfma_f32_16x16x32_bf16 v[124:127], a[4:7], v[176:179], v[124:127]
    ds_write_b128 v3, v[204:207] offset:12288
    v_mfma_f32_16x16x32_bf16 v[124:127], a[8:11], v[216:219], v[124:127]
    v_mul_f32 v156, v180, v156
    v_mul_f32 v157, v180, v157
    v_mfma_f32_16x16x32_bf16 v[124:127], a[12:15], v[120:123], v[124:127]
    v_cvt_pk_bf16_f32 v156, v156, v157
    v_mul_f32 v158, v180, v158
    v_mfma_f32_16x16x32_bf16 v[124:127], a[16:19], v[240:243], v[124:127]
    v_mul_f32 v159, v180, v159
    v_cvt_pk_bf16_f32 v157, v158, v159
    v_mfma_f32_16x16x32_bf16 v[124:127], a[20:23], v[224:227], v[124:127]
    ds_write_b64 v4, v[156:157] offset:16384
    v_mfma_f32_16x16x32_bf16 v[180:183], a[24:27], v[212:215], 0
    v_fmac_f32 v221, v247, v247
    v_cvt_pk_bf16_f32 v222, v221, v222
    v_mfma_f32_16x16x32_bf16 v[180:183], a[28:31], v[176:179], v[180:183]
    ds_write_b64 v4, v[222:223] offset:18432
    v_mfma_f32_16x16x32_bf16 v[180:183], a[32:35], v[216:219], v[180:183]
    v_fma_f32 v108, v192, v192, s32
    v_fmac_f32 v108, v193, v193
    v_mfma_f32_16x16x32_bf16 v[180:183], a[36:39], v[120:123], v[180:183]
    v_fmac_f32 v108, v194, v194
    v_fmac_f32 v108, v195, v195
    v_mfma_f32_16x16x32_bf16 v[180:183], a[40:43], v[240:243], v[180:183]
    v_fmac_f32 v108, v152, v152
    v_fmac_f32 v108, v153, v153
    v_mfma_f32_16x16x32_bf16 v[180:183], a[44:47], v[224:227], v[180:183]
    v_fmac_f32 v108, v154, v154
    v_fmac_f32 v108, v155, v155
    v_mfma_f32_16x16x32_bf16 v[220:223], a[48:51], v[212:215], 0
    v_fmac_f32 v108, v144, v144
    v_fmac_f32 v108, v145, v145
    v_mfma_f32_16x16x32_bf16 v[220:223], a[52:55], v[176:179], v[220:223]
    v_fmac_f32 v108, v146, v146
    v_fmac_f32 v108, v147, v147
    v_mfma_f32_16x16x32_bf16 v[220:223], a[56:59], v[216:219], v[220:223]
    s_waitcnt lgkmcnt(0)
    v_fma_f32 v109, v124, v124, s32
    v_fmac_f32 v109, v125, v125
    v_mfma_f32_16x16x32_bf16 v[220:223], a[60:63], v[120:123], v[220:223]
    s_nop 0
    v_fmac_f32 v109, v126, v126
    v_fmac_f32 v109, v127, v127
    v_mfma_f32_16x16x32_bf16 v[220:223], a[64:67], v[240:243], v[220:223]
    s_barrier
    v_fmac_f32 v109, v180, v180
    v_fmac_f32 v109, v181, v181
    v_mfma_f32_16x16x32_bf16 v[220:223], a[68:71], v[224:227], v[220:223]
    s_nop 0
    v_fmac_f32 v109, v182, v182
    v_fmac_f32 v109, v183, v183
    v_mfma_f32_16x16x32_bf16 v[128:131], v[212:215], a[144:147], 0
    s_nop 0
    v_add_u32 v6, 272, v6
    v_add_u32 v7, 16, v7
    v_mfma_f32_16x16x32_bf16 v[128:131], v[176:179], a[148:151], v[128:131]
    v_fmac_f32 v109, v220, v220
    v_fmac_f32 v109, v221, v221
    v_mfma_f32_16x16x32_bf16 v[128:131], v[216:219], a[152:155], v[128:131]
    v_fmac_f32 v109, v222, v222
    v_fmac_f32 v109, v223, v223
    v_mfma_f32_16x16x32_bf16 v[128:131], v[120:123], a[156:159], v[128:131]
    v_cvt_pk_bf16_f32 v38, v109, v108
    v_xor_b32 v2, 65536, v2
    v_mfma_f32_16x16x32_bf16 v[128:131], v[240:243], a[160:163], v[128:131]
    v_xor_b32 v3, 65536, v3
    v_xor_b32 v4, 65536, v4
    v_mfma_f32_16x16x32_bf16 v[128:131], v[224:227], a[164:167], v[128:131]
    s_cbranch_scc1 L_loop_fast1
    s_branch L_drain
.p2align 6
L_loop_fast2:
    v_mfma_f32_16x16x16_bf16 v[164:167], v[32:33], v[38:39], 0
    s_cmp_ge_u32 s18, 2
    ds_read_b128 v[204:207], v2 offset:18432
    ds_read_b128 v[108:111], v2 offset:19456
    v_mfma_f32_16x16x32_bf16 v[156:159], v[212:215], a[168:171], 0
    s_cselect_b32 s14, s36, 0
    ds_read_b128 v[168:171], v0 offset:26624
    ds_read_b128 v[132:135], v1 offset:26624
    v_mfma_f32_16x16x32_bf16 v[156:159], v[176:179], a[172:175], v[156:159]
    s_add_u32 s34, s18, 2
    ds_read_b128 v[160:163], v0 offset:26752
    ds_read_b128 v[112:115], v1 offset:26752
    v_mfma_f32_16x16x32_bf16 v[156:159], v[216:219], a[176:179], v[156:159]
    s_cmp_lt_u32 s34, s17
    ds_read_b128 v[172:175], v0 offset:26880
    v_cvt_pk_bf16_f32 v128, v128, v129
    v_mfma_f32_16x16x32_bf16 v[156:159], v[120:123], a[180:183], v[156:159]
    s_cselect_b32 s10, s36, 0
    ds_read_b128 v[196:199], v1 offset:26880
    v_cvt_pk_bf16_f32 v129, v130, v131
    v_mfma_f32_16x16x32_bf16 v[156:159], v[240:243], a[184:187], v[156:159]
    s_add_u32 m0, s28, 0
    v_rsq_f32 v165, v165
    v_mfma_f32_16x16x32_bf16 v[156:159], v[224:227], a[188:191], v[156:159]
    v_rsq_f32 v164, v164
    v_mfma_f32_16x16x32_bf16 v[136:139], v[212:215], a[192:195], 0
    v_mul_f32 v164, s31, v164
    v_mul_f32 v192, v165, v192
    v_mfma_f32_16x16x32_bf16 v[136:139], v[176:179], a[196:199], v[136:139]
    s_waitcnt lgkmcnt(6)
    v_mul_f32 v193, v165, v193
    v_cvt_pk_bf16_f32 v212, v192, v193
    v_mfma_f32_16x16x32_bf16 v[176:179], v[32:35], v[204:207], 0
    s_waitcnt lgkmcnt(4)
    v_cvt_pk_bf16_f32 v156, v156, v157
    v_cvt_pk_bf16_f32 v157, v158, v159
    v_mfma_f32_16x16x32_bf16 v[176:179], v[32:35], v[108:111], v[176:179]
    s_waitcnt lgkmcnt(2)
    v_mul_f32 v194, v165, v194
    v_mul_f32 v195, v165, v195
    v_mfma_f32_16x16x32_bf16 v[136:139], v[216:219], a[200:203], v[136:139]
    s_waitcnt lgkmcnt(1)
    v_cvt_pk_bf16_f32 v213, v194, v195
    v_mul_f32 v152, v165, v152
    v_mfma_f32_16x16x32_bf16 v[136:139], v[120:123], a[204:207], v[136:139]
    s_waitcnt lgkmcnt(0)
    v_mul_f32 v153, v165, v153
    v_cvt_pk_bf16_f32 v214, v152, v153
    v_mfma_f32_16x16x32_bf16 v[136:139], v[240:243], a[208:211], v[136:139]
    v_mul_f32 v154, v165, v154
    v_mul_f32 v155, v165, v155
    v_mfma_f32_16x16x32_bf16 v[136:139], v[224:227], a[212:215], v[136:139]
    v_cvt_pk_bf16_f32 v215, v154, v155
    v_mul_f32 v144, v165, v144
    v_mfma_f32_16x16x32_bf16 v[240:243], a[72:75], v[168:171], 0
    v_mul_f32 v145, v165, v145
    v_cvt_pk_bf16_f32 v194, v144, v145
    v_mfma_f32_16x16x32_bf16 v[240:243], a[76:79], v[132:135], v[240:243]
    v_mul_f32 v146, v165, v146
    v_mul_f32 v147, v165, v147
    v_mfma_f32_16x16x32_bf16 v[240:243], a[80:83], v[160:163], v[240:243]
    v_cvt_pk_bf16_f32 v144, v136, v137
    v_cvt_pk_bf16_f32 v145, v138, v139
    v_mfma_f32_16x16x32_bf16 v[240:243], a[84:87], v[112:115], v[240:243]
    v_cvt_pk_bf16_f32 v195, v146, v147
    v_mul_f32 v124, v164, v124
    v_mfma_f32_16x16x32_bf16 v[240:243], a[88:91], v[172:175], v[240:243]
    v_mul_f32 v125, v164, v125
    v_cvt_pk_bf16_f32 v204, v124, v125
    v_mfma_f32_16x16x32_bf16 v[240:243], a[92:95], v[196:199], v[240:243]
    v_mul_f32 v126, v164, v126
    v_mul_f32 v127, v164, v127
    v_mfma_f32_16x16x32_bf16 v[120:123], a[96:99], v[168:171], 0
    v_cvt_pk_bf16_f32 v205, v126, v127
    v_mul_f32 v180, v164, v180
    v_mfma_f32_16x16x32_bf16 v[120:123], a[100:103], v[132:135], v[120:123]
    v_mul_f32 v181, v164, v181
    v_cvt_pk_bf16_f32 v206, v180, v181
    v_mfma_f32_16x16x32_bf16 v[120:123], a[104:107], v[160:163], v[120:123]
    v_mul_f32 v182, v164, v182
    v_mul_f32 v183, v164, v183
    v_mfma_f32_16x16x32_bf16 v[120:123], a[108:111], v[112:115], v[120:123]
    v_cvt_pk_bf16_f32 v207, v182, v183
    v_mul_f32 v220, v164, v220
    v_mfma_f32_16x16x32_bf16 v[120:123], a[112:115], v[172:175], v[120:123]
    v_mul_f32 v221, v164, v221
    v_cvt_pk_bf16_f32 v192, v220, v221
    v_mfma_f32_16x16x32_bf16 v[120:123], a[116:119], v[196:199], v[120:123]
    v_mul_f32 v222, v164, v222
    v_mul_f32 v223, v164, v223
    v_mfma_f32_16x16x32_bf16 v[224:227], a[120:123], v[168:171], 0
    v_cvt_pk_bf16_f32 v193, v222, v223
    v_mul_f32 v130, 0x3baaaaab, v176
    v_mfma_f32_16x16x32_bf16 v[224:227], a[124:127], v[132:135], v[224:227]
    v_rsq_f32 v130, v130
    v_mfma_f32_16x16x32_bf16 v[224:227], a[128:131], v[160:163], v[224:227]
    v_mul_f32 v146, 0x3baaaaab, v177
    v_mul_f32 v108, 0x3baaaaab, v178
    v_mfma_f32_16x16x32_bf16 v[224:227], a[132:135], v[112:115], v[224:227]
    v_rsq_f32 v146, v146
    v_mfma_f32_16x16x32_bf16 v[224:227], a[136:139], v[172:175], v[224:227]
    v_rsq_f32 v108, v108
    v_mfma_f32_16x16x32_bf16 v[224:227], a[140:143], v[196:199], v[224:227]
    v_mul_f32 v140, v130, v140
    v_mul_f32 v141, v130, v141
    v_mfma_f32_16x16x32_bf16 v[136:139], a[0:3], v[168:171], 0
    v_cvt_pk_bf16_f32 v176, v140, v141
    v_mul_f32 v142, v130, v142
    v_mfma_f32_16x16x32_bf16 v[136:139], a[4:7], v[132:135], v[136:139]
    v_mul_f32 v143, v130, v143
    v_cvt_pk_bf16_f32 v177, v142, v143
    v_mfma_f32_16x16x32_bf16 v[136:139], a[8:11], v[160:163], v[136:139]
    v_mul_f32 v188, v130, v188
    v_mul_f32 v189, v130, v189
    v_mfma_f32_16x16x32_bf16 v[136:139], a[12:15], v[112:115], v[136:139]
    v_cvt_pk_bf16_f32 v178, v188, v189
    v_mul_f32 v190, v130, v190
    v_mfma_f32_16x16x32_bf16 v[136:139], a[16:19], v[172:175], v[136:139]
    v_mul_f32 v191, v130, v191
    v_cvt_pk_bf16_f32 v179, v190, v191
    v_mfma_f32_16x16x32_bf16 v[136:139], a[20:23], v[196:199], v[136:139]
    buffer_store_dwordx4 v[176:179], v15, s[12:15], s27 offen
    v_mul_f32 v244, v130, v244
    v_mul_f32 v245, v130, v245
    v_cvt_pk_bf16_f32 v158, v244, v245
    v_mul_f32 v246, v130, v246
    v_mfma_f32_16x16x32_bf16 v[188:191], a[24:27], v[168:171], 0
    v_mul_f32 v247, v130, v247
    v_cvt_pk_bf16_f32 v159, v246, v247
    v_mfma_f32_16x16x32_bf16 v[188:191], a[28:31], v[132:135], v[188:191]
    v_fma_f32 v147, v136, v136, s32
    v_fmac_f32 v147, v137, v137
    v_mfma_f32_16x16x32_bf16 v[188:191], a[32:35], v[160:163], v[188:191]
    v_fmac_f32 v147, v138, v138
    v_fmac_f32 v147, v139, v139
    v_mfma_f32_16x16x32_bf16 v[188:191], a[36:39], v[112:115], v[188:191]
    v_fma_f32 v130, v240, v240, s32
    v_fmac_f32 v130, v241, v241
    v_mfma_f32_16x16x32_bf16 v[188:191], a[40:43], v[172:175], v[188:191]
    v_fmac_f32 v130, v242, v242
    v_fmac_f32 v130, v243, v243
    v_mfma_f32_16x16x32_bf16 v[188:191], a[44:47], v[196:199], v[188:191]
    v_fmac_f32 v130, v120, v120
    v_fmac_f32 v130, v121, v121
    v_mfma_f32_16x16x32_bf16 v[244:247], a[48:51], v[168:171], 0
    v_fmac_f32 v130, v122, v122
    v_fmac_f32 v130, v123, v123
    v_mfma_f32_16x16x32_bf16 v[244:247], a[52:55], v[132:135], v[244:247]
    v_fmac_f32 v130, v224, v224
    v_fmac_f32 v130, v225, v225
    v_mfma_f32_16x16x32_bf16 v[244:247], a[56:59], v[160:163], v[244:247]
    v_fmac_f32 v147, v188, v188
    v_fmac_f32 v147, v189, v189
    v_mfma_f32_16x16x32_bf16 v[244:247], a[60:63], v[112:115], v[244:247]
    v_fmac_f32 v147, v190, v190
    v_fmac_f32 v147, v191, v191
    v_mfma_f32_16x16x32_bf16 v[244:247], a[64:67], v[172:175], v[244:247]
    v_fmac_f32 v130, v226, v226
    v_fmac_f32 v130, v227, v227
    v_mfma_f32_16x16x32_bf16 v[244:247], a[68:71], v[196:199], v[244:247]
    v_mul_f32 v116, v146, v116
    v_mul_f32 v117, v146, v117
    v_mfma_f32_16x16x32_bf16 v[180:183], v[168:171], a[144:147], 0
    v_cvt_pk_bf16_f32 v164, v116, v117
    v_mul_f32 v118, v146, v118
    v_mfma_f32_16x16x32_bf16 v[180:183], v[132:135], a[148:151], v[180:183]
    v_mul_f32 v119, v146, v119
    v_cvt_pk_bf16_f32 v165, v118, v119
    v_mfma_f32_16x16x32_bf16 v[180:183], v[160:163], a[152:155], v[180:183]
    v_fmac_f32 v147, v244, v244
    v_fmac_f32 v147, v245, v245
    v_mfma_f32_16x16x32_bf16 v[180:183], v[112:115], a[156:159], v[180:183]
    v_fmac_f32 v147, v246, v246
    v_fmac_f32 v147, v247, v247
    v_mfma_f32_16x16x32_bf16 v[180:183], v[172:175], a[160:163], v[180:183]
    ds_read_b128 v[176:179], v0 offset:32768
    buffer_store_dwordx2 v[158:159], v18, s[12:15], s27 offen
    v_cvt_pk_bf16_f32 v38, v147, v130
    v_mul_f32 v208, v146, v208
    v_mfma_f32_16x16x32_bf16 v[180:183], v[196:199], a[164:167], v[180:183]
    ds_read_b128 v[152:155], v1 offset:32768
    v_mul_f32 v209, v146, v209
    v_mfma_f32_16x16x16_bf16 v[248:251], v[32:33], v[38:39], 0
    v_cvt_pk_bf16_f32 v166, v208, v209
    v_mul_f32 v210, v146, v210
    v_mfma_f32_16x16x32_bf16 v[184:187], v[168:171], a[168:171], 0
    ds_read_b128 v[216:219], v0 offset:32896
    v_mul_f32 v211, v146, v211
    v_mfma_f32_16x16x32_bf16 v[184:187], v[132:135], a[172:175], v[184:187]
    ds_read_b128 v[220:223], v1 offset:32896
    v_cvt_pk_bf16_f32 v130, v180, v181
    v_mfma_f32_16x16x32_bf16 v[184:187], v[160:163], a[176:179], v[184:187]
    ds_read_b128 v[124:127], v0 offset:33024
    v_cvt_pk_bf16_f32 v131, v182, v183
    v_mfma_f32_16x16x32_bf16 v[184:187], v[112:115], a[180:183], v[184:187]
    ds_read_b128 v[116:119], v1 offset:33024
    v_cvt_pk_bf16_f32 v167, v210, v211
    v_mfma_f32_16x16x32_bf16 v[184:187], v[172:175], a[184:187], v[184:187]
    s_waitcnt lgkmcnt(5)
    v_rsq_f32 v249, v249
    v_mfma_f32_16x16x32_bf16 v[184:187], v[196:199], a[188:191], v[184:187]
    v_rsq_f32 v248, v248
    v_mfma_f32_16x16x32_bf16 v[236:239], v[168:171], a[192:195], 0
    s_waitcnt lgkmcnt(4)
    v_mul_f32 v248, s31, v248
    v_mul_f32 v228, v146, v228
    v_mfma_f32_16x16x32_bf16 v[236:239], v[132:135], a[196:199], v[236:239]
    v_mul_f32 v229, v146, v229
    v_cvt_pk_bf16_f32 v140, v228, v229
    v_mfma_f32_16x16x32_bf16 v[236:239], v[160:163], a[200:203], v[236:239]
    s_waitcnt lgkmcnt(3)
    v_cvt_pk_bf16_f32 v158, v184, v185
    v_cvt_pk_bf16_f32 v159, v186, v187
    v_mfma_f32_16x16x32_bf16 v[236:239], v[112:115], a[204:207], v[236:239]
    s_waitcnt lgkmcnt(2)
    v_mul_f32 v230, v146, v230
    v_mul_f32 v231, v146, v231
    v_mfma_f32_16x16x32_bf16 v[236:239], v[172:175], a[208:211], v[236:239]
    s_waitcnt lgkmcnt(1)
    v_cvt_pk_bf16_f32 v141, v230, v231
    v_mul_f32 v240, v249, v240
    v_mfma_f32_16x16x32_bf16 v[236:239], v[196:199], a[212:215], v[236:239]
    s_waitcnt lgkmcnt(0)
    v_mul_f32 v241, v249, v241
    v_cvt_pk_bf16_f32 v180, v240, v241
    v_mfma_f32_16x16x32_bf16 v[208:211], a[72:75], v[176:179], 0
    v_mul_f32 v242, v249, v242
    v_mul_f32 v243, v249, v243
    v_mfma_f32_16x16x32_bf16 v[208:211], a[76:79], v[152:155], v[208:211]
    v_cvt_pk_bf16_f32 v181, v242, v243
    v_cvt_pk_bf16_f32 v146, v236, v237
    v_mfma_f32_16x16x32_bf16 v[208:211], a[80:83], v[216:219], v[208:211]
    buffer_store_dwordx4 v[164:167], v16, s[12:15], s27 offen
    v_cvt_pk_bf16_f32 v147, v238, v239
    v_mul_f32 v120, v249, v120
    v_mul_f32 v121, v249, v121
    v_cvt_pk_bf16_f32 v182, v120, v121
    v_mfma_f32_16x16x32_bf16 v[208:211], a[84:87], v[220:223], v[208:211]
    v_mul_f32 v122, v249, v122
    v_mul_f32 v123, v249, v123
    v_mfma_f32_16x16x32_bf16 v[208:211], a[88:91], v[124:127], v[208:211]
    v_cvt_pk_bf16_f32 v183, v122, v123
    v_mul_f32 v224, v249, v224
    v_mfma_f32_16x16x32_bf16 v[208:211], a[92:95], v[116:119], v[208:211]
    v_mul_f32 v225, v249, v225
    v_cvt_pk_bf16_f32 v170, v224, v225
    v_mfma_f32_16x16x32_bf16 v[164:167], a[96:99], v[176:179], 0
    v_mul_f32 v226, v249, v226
    v_mul_f32 v227, v249, v227
    v_mfma_f32_16x16x32_bf16 v[164:167], a[100:103], v[152:155], v[164:167]
    v_cvt_pk_bf16_f32 v171, v226, v227
    v_mul_f32 v136, v248, v136
    v_mfma_f32_16x16x32_bf16 v[164:167], a[104:107], v[216:219], v[164:167]
    s_waitcnt vmcnt(3)
    v_mul_f32 v137, v248, v137
    v_cvt_pk_bf16_f32 v132, v136, v137
    v_mfma_f32_16x16x32_bf16 v[164:167], a[108:111], v[220:223], v[164:167]
    s_nop 0
    v_mul_f32 v138, v248, v138
    v_mul_f32 v139, v248, v139
    v_mfma_f32_16x16x32_bf16 v[164:167], a[112:115], v[124:127], v[164:167]
    s_nop 0
    v_cvt_pk_bf16_f32 v133, v138, v139
    v_mul_f32 v188, v248, v188
    v_mfma_f32_16x16x32_bf16 v[164:167], a[116:119], v[116:119], v[164:167]
    s_barrier
    v_mul_f32 v189, v248, v189
    v_cvt_pk_bf16_f32 v134, v188, v189
    v_mfma_f32_16x16x32_bf16 v[112:115], a[120:123], v[176:179], 0
    s_nop 0
    v_mul_f32 v190, v248, v190
    v_mul_f32 v191, v248, v191
    v_mfma_f32_16x16x32_bf16 v[112:115], a[124:127], v[152:155], v[112:115]
    v_cvt_pk_bf16_f32 v135, v190, v191
    v_mul_f32 v244, v248, v244
    v_mfma_f32_16x16x32_bf16 v[112:115], a[128:131], v[216:219], v[112:115]
    v_mul_f32 v245, v248, v245
    v_cvt_pk_bf16_f32 v168, v244, v245
    v_mfma_f32_16x16x32_bf16 v[112:115], a[132:135], v[220:223], v[112:115]
    v_mul_f32 v246, v248, v246
    v_mul_f32 v247, v248, v247
    v_mfma_f32_16x16x32_bf16 v[112:115], a[136:139], v[124:127], v[112:115]
    v_cvt_pk_bf16_f32 v169, v246, v247
    v_fma_f32 v142, v208, v208, s32
    v_mfma_f32_16x16x32_bf16 v[112:115], a[140:143], v[116:119], v[112:115]
    v_fmac_f32 v142, v209, v209
    v_fmac_f32 v142, v210, v210
    v_mfma_f32_16x16x32_bf16 v[188:191], a[0:3], v[176:179], 0
    v_fmac_f32 v142, v211, v211
    v_fmac_f32 v142, v164, v164
    v_mfma_f32_16x16x32_bf16 v[188:191], a[4:7], v[152:155], v[188:191]
    buffer_load_dwordx4 v10, s[8:11], s23 offen nt lds
    v_fmac_f32 v142, v165, v165
    v_mfma_f32_16x16x32_bf16 v[188:191], a[8:11], v[216:219], v[188:191]
    s_add_u32 m0, s28, 4096
    v_fmac_f32 v142, v166, v166
    v_fmac_f32 v142, v167, v167
    v_mfma_f32_16x16x32_bf16 v[188:191], a[12:15], v[220:223], v[188:191]
    v_fmac_f32 v142, v112, v112
    v_fmac_f32 v142, v113, v113
    v_mfma_f32_16x16x32_bf16 v[188:191], a[16:19], v[124:127], v[188:191]
    v_fmac_f32 v142, v114, v114
    v_fmac_f32 v142, v115, v115
    v_mfma_f32_16x16x32_bf16 v[188:191], a[20:23], v[116:119], v[188:191]
    v_mul_f32 v148, v108, v148
    v_mul_f32 v149, v108, v149
    v_mfma_f32_16x16x32_bf16 v[136:139], a[24:27], v[176:179], 0
    buffer_load_dwordx4 v11, s[8:11], s23 offen nt lds
    v_cvt_pk_bf16_f32 v160, v148, v149
    v_mfma_f32_16x16x32_bf16 v[136:139], a[28:31], v[152:155], v[136:139]
    s_add_u32 m0, s28, 8192
    v_mul_f32 v150, v108, v150
    v_fma_f32 v143, v188, v188, s32
    v_mfma_f32_16x16x32_bf16 v[136:139], a[32:35], v[216:219], v[136:139]
    v_fmac_f32 v143, v189, v189
    v_fmac_f32 v143, v190, v190
    v_mfma_f32_16x16x32_bf16 v[136:139], a[36:39], v[220:223], v[136:139]
    v_fmac_f32 v143, v191, v191
    v_mul_f32 v151, v108, v151
    v_mfma_f32_16x16x32_bf16 v[136:139], a[40:43], v[124:127], v[136:139]
    v_cvt_pk_bf16_f32 v161, v150, v151
    v_mul_f32 v200, v108, v200
    v_mfma_f32_16x16x32_bf16 v[136:139], a[44:47], v[116:119], v[136:139]
    buffer_load_dwordx4 v12, s[8:11], s23 offen nt lds
    v_mul_f32 v201, v108, v201
    v_mfma_f32_16x16x32_bf16 v[148:151], a[48:51], v[176:179], 0
    s_add_u32 m0, s28, 12288
    v_cvt_pk_bf16_f32 v162, v200, v201
    v_mul_f32 v202, v108, v202
    v_mfma_f32_16x16x32_bf16 v[148:151], a[52:55], v[152:155], v[148:151]
    s_xor_b32 s28, s28, 65536
    v_fmac_f32 v143, v136, v136
    v_fmac_f32 v143, v137, v137
    v_mfma_f32_16x16x32_bf16 v[148:151], a[56:59], v[216:219], v[148:151]
    v_fmac_f32 v143, v138, v138
    v_fmac_f32 v143, v139, v139
    v_mfma_f32_16x16x32_bf16 v[148:151], a[60:63], v[220:223], v[148:151]
    v_mul_f32 v203, v108, v203
    v_cvt_pk_bf16_f32 v163, v202, v203
    v_mfma_f32_16x16x32_bf16 v[148:151], a[64:67], v[124:127], v[148:151]
    buffer_load_dwordx4 v13, s[8:11], s23 offen nt lds
    ds_read_b128 v[120:123], v5 offset:0
    v_mfma_f32_16x16x32_bf16 v[148:151], a[68:71], v[116:119], v[148:151]
    s_mov_b32 m0, s29
    ds_read_b128 v[228:231], v5 offset:16
    ds_read_b128 v[200:203], v5 offset:48
    v_mfma_f32_16x16x32_bf16 v[184:187], v[176:179], a[144:147], 0
    s_xor_b32 s29, s29, s30
    ds_read_b32 v224, v6 offset:192
    ds_read2_b32 v[110:111], v6 offset0:0 offset1:0
    v_mfma_f32_16x16x32_bf16 v[184:187], v[152:155], a[148:151], v[184:187]
    s_add_u32 s19, s19, s20
    ds_read2_b32 v[174:175], v6 offset0:16 offset1:16
    ds_read2_b32 v[198:199], v6 offset0:32 offset1:32
    v_mfma_f32_16x16x32_bf16 v[184:187], v[216:219], a[152:155], v[184:187]
    v_fmac_f32 v143, v148, v148
    v_fmac_f32 v143, v149, v149
    v_mfma_f32_16x16x32_bf16 v[184:187], v[220:223], a[156:159], v[184:187]
    buffer_store_dwordx2 v[140:141], v19, s[12:15], s27 offen
    v_fmac_f32 v143, v150, v150
    v_fmac_f32 v143, v151, v151
    v_mfma_f32_16x16x32_bf16 v[184:187], v[124:127], a[160:163], v[184:187]
    v_cvt_pk_bf16_f32 v38, v143, v142
    v_mul_f32 v232, v108, v232
    v_mfma_f32_16x16x32_bf16 v[184:187], v[116:119], a[164:167], v[184:187]
    v_mul_f32 v233, v108, v233
    v_cvt_pk_bf16_f32 v232, v232, v233
    v_mfma_f32_16x16x16_bf16 v[140:143], v[32:33], v[38:39], 0
    s_waitcnt lgkmcnt(5)
    v_mul_f32 v234, v108, v234
    v_mul_f32 v235, v108, v235
    v_mfma_f32_16x16x32_bf16 v[236:239], v[120:123], v[204:207], v[22:25]
    s_waitcnt lgkmcnt(3)
    v_cvt_pk_bf16_f32 v108, v184, v185
    v_cvt_pk_bf16_f32 v109, v186, v187
    v_mfma_f32_16x16x32_bf16 v[236:239], v[228:231], v[212:215], v[236:239]
    s_waitcnt lgkmcnt(1)
    v_rsq_f32 v141, v141
    v_mfma_f32_16x16x32_bf16 v[236:239], v[200:203], v[192:195], v[236:239]
    s_waitcnt lgkmcnt(0)
    v_rsq_f32 v140, v140
    v_mfma_f32_16x16x32_bf16 v[184:187], v[120:123], v[132:135], v[24:27]
    v_mul_f32 v140, s31, v140
    v_mul_f32 v208, v141, v208
    v_mfma_f32_16x16x32_bf16 v[184:187], v[228:231], v[180:183], v[184:187]
    v_mul_f32 v209, v141, v209
    v_cvt_pk_bf16_f32 v208, v208, v209
    v_mfma_f32_16x16x32_bf16 v[184:187], v[200:203], v[168:171], v[184:187]
    v_mov_b32_dpp v224, v237 quad_perm:[0,1,2,3] row_mask:0x1 bank_mask:0xf
    v_mul_f32 v210, v141, v210
    v_mfma_f32_16x16x32_bf16 v[240:243], v[176:179], a[168:171], 0
    v_mul_f32 v211, v141, v211
    v_cvt_pk_bf16_f32 v209, v210, v211
    v_mfma_f32_16x16x32_bf16 v[240:243], v[152:155], a[172:175], v[240:243]
    v_mul_f32 v164, v141, v164
    v_mul_f32 v165, v141, v165
    v_mfma_f32_16x16x32_bf16 v[240:243], v[216:219], a[176:179], v[240:243]
    v_cvt_pk_bf16_f32 v210, v164, v165
    v_mul_f32 v166, v141, v166
    v_mfma_f32_16x16x32_bf16 v[240:243], v[220:223], a[180:183], v[240:243]
    v_mul_f32 v167, v141, v167
    v_cvt_pk_bf16_f32 v211, v166, v167
    v_mfma_f32_16x16x32_bf16 v[240:243], v[124:127], a[184:187], v[240:243]
    v_mul_f32 v112, v141, v112
    v_mul_f32 v113, v141, v113
    v_mfma_f32_16x16x32_bf16 v[240:243], v[116:119], a[188:191], v[240:243]
    v_cvt_pk_bf16_f32 v166, v112, v113
    v_mul_f32 v114, v141, v114
    v_mfma_f32_16x16x32_bf16 v[244:247], v[176:179], a[192:195], 0
    ds_read_b128 v[176:179], v2 offset:0
    v_mul_f32 v115, v141, v115
    v_mfma_f32_16x16x32_bf16 v[244:247], v[152:155], a[196:199], v[244:247]
    ds_read_b128 v[152:155], v2 offset:1024
    buffer_store_dwordx4 v[160:163], v17, s[12:15], s27 offen
    v_cvt_pk_bf16_f32 v172, v240, v241
    v_cvt_pk_bf16_f32 v173, v242, v243
    v_cvt_pk_bf16_f32 v167, v114, v115
    v_mul_f32 v188, v140, v188
    v_mfma_f32_16x16x32_bf16 v[240:243], v[212:215], v[204:207], v[40:43]
    v_mul_f32 v189, v140, v189
    v_cvt_pk_bf16_f32 v112, v188, v189
    v_mfma_f32_16x16x32_bf16 v[248:251], v[180:183], v[204:207], v[44:47]
    v_mul_f32 v190, v140, v190
    v_mul_f32 v191, v140, v191
    v_mfma_f32_16x16x32_bf16 v[160:163], v[208:211], v[204:207], v[48:51]
    v_cvt_pk_bf16_f32 v113, v190, v191
    v_mul_f32 v136, v140, v136
    v_mfma_f32_16x16x16_bf16 v[240:243], v[194:195], v[192:193], v[240:243]
    v_mul_f32 v137, v140, v137
    v_cvt_pk_bf16_f32 v114, v136, v137
    v_mfma_f32_16x16x16_bf16 v[248:251], v[170:171], v[192:193], v[248:251]
    v_mul_f32 v138, v140, v138
    v_mul_f32 v139, v140, v139
    v_mfma_f32_16x16x16_bf16 v[160:163], v[166:167], v[192:193], v[160:163]
    s_waitcnt lgkmcnt(1)
    v_cvt_pk_bf16_f32 v115, v138, v139
    v_mul_f32 v148, v140, v148
    v_mfma_f32_16x16x32_bf16 v[244:247], v[216:219], a[200:203], v[244:247]
    s_waitcnt lgkmcnt(0)
    ds_read_b128 v[216:219], v2 offset:2048
    v_mul_f32 v149, v140, v149
    v_mfma_f32_16x16x32_bf16 v[244:247], v[220:223], a[204:207], v[244:247]
    ds_read_b128 v[204:207], v2 offset:3072
    v_cvt_pk_bf16_f32 v164, v148, v149
    v_mfma_f32_16x16x32_bf16 v[244:247], v[124:127], a[208:211], v[244:247]
    ds_read_b128 v[124:127], v2 offset:4096
    v_mul_f32 v150, v140, v150
    v_mfma_f32_16x16x32_bf16 v[244:247], v[116:119], a[212:215], v[244:247]
    ds_read_b128 v[116:119], v2 offset:5120
    v_mul_f32 v151, v140, v151
    v_mfma_f32_16x16x32_bf16 v[220:223], v[120:123], v[112:115], v[26:29]
    v_cvt_pk_bf16_f32 v165, v150, v151
    v_mov_b32_dpp v224, v185 quad_perm:[0,1,2,3] row_mask:0x2 bank_mask:0xf
    v_mfma_f32_16x16x32_bf16 v[220:223], v[228:231], v[208:211], v[220:223]
    v_cvt_pk_bf16_f32 v233, v234, v235
    v_xor_b32 v0, 65536, v0
    v_mfma_f32_16x16x32_bf16 v[220:223], v[200:203], v[164:167], v[220:223]
    v_cvt_pk_bf16_f32 v196, v244, v245
    v_cvt_pk_bf16_f32 v197, v246, v247
    v_mfma_f32_16x16x32_bf16 v[140:143], a[216:219], v[176:179], 0
    v_exp_f32 v184, v184
    v_mfma_f32_16x16x32_bf16 v[140:143], a[220:223], v[152:155], v[140:143]
    s_waitcnt lgkmcnt(3)
    v_exp_f32 v240, v240
    v_mfma_f32_16x16x32_bf16 v[140:143], a[224:227], v[216:219], v[140:143]
    s_waitcnt lgkmcnt(2)
    v_exp_f32 v220, v220
    v_mfma_f32_16x16x32_bf16 v[140:143], a[228:231], v[204:207], v[140:143]
    s_waitcnt lgkmcnt(1)
    buffer_store_dwordx2 v[232:233], v20, s[12:15], s27 offen
    v_mov_b32_dpp v224, v221 quad_perm:[0,1,2,3] row_mask:0x4 bank_mask:0xf
    v_xor_b32 v1, 65536, v1
    v_mfma_f32_16x16x32_bf16 v[140:143], a[232:235], v[124:127], v[140:143]
    s_waitcnt lgkmcnt(0)
    v_exp_f32 v224, v224
    v_mfma_f32_16x16x32_bf16 v[140:143], a[236:239], v[116:119], v[140:143]
    s_mov_b32 s27, s26
    v_cvt_pk_bf16_f32 v224, v224, v224
    v_add_u32 v5, 336, v5
    v_mfma_f32_16x16x32_bf16 v[188:191], a[240:243], v[176:179], 0
    s_mov_b32 s26, s25
    ds_write_b16 v8, v224
    v_mfma_f32_16x16x32_bf16 v[188:191], a[244:247], v[152:155], v[188:191]
    s_mov_b32 s25, s24
    v_exp_f32 v241, v241
    v_mfma_f32_16x16x32_bf16 v[188:191], a[248:251], v[216:219], v[188:191]
    s_mov_b32 s24, s23
    ds_read_b128 v[136:139], v2 offset:6144
    ds_read_b128 v[200:203], v2 offset:7168
    v_mfma_f32_16x16x32_bf16 v[188:191], a[252:255], v[204:207], v[188:191]
    ds_read_b128 v[232:235], v2 offset:8192
    ds_read_b128 v[228:231], v9
    v_mfma_f32_16x16x32_bf16 v[188:191], v[76:79], v[124:127], v[188:191]
    ds_read_b128 v[148:151], v2 offset:9216
    ds_read_b128 v[120:123], v9 offset:64
    v_mfma_f32_16x16x32_bf16 v[188:191], v[80:83], v[116:119], v[188:191]
    ds_read_b128 v[224:227], v2 offset:10240
    v_cvt_pk_bf16_f32 v240, v240, v241
    v_mfma_f32_16x16x32_bf16 v[244:247], v[84:87], v[176:179], 0
    ds_read_b128 v[176:179], v2 offset:11264
    v_fma_f32 v221, v140, v140, s33
    v_mfma_f32_16x16x32_bf16 v[244:247], v[88:91], v[152:155], v[244:247]
    v_exp_f32 v242, v242
    v_mfma_f32_16x16x32_bf16 v[244:247], v[92:95], v[216:219], v[244:247]
    v_exp_f32 v243, v243
    v_mfma_f32_16x16x32_bf16 v[244:247], v[96:99], v[204:207], v[244:247]
    v_cvt_pk_bf16_f32 v241, v242, v243
    v_fmac_f32 v221, v141, v141
    v_mfma_f32_16x16x32_bf16 v[244:247], v[100:103], v[124:127], v[244:247]
    s_waitcnt lgkmcnt(6)
    v_exp_f32 v248, v248
    v_mfma_f32_16x16x32_bf16 v[244:247], v[104:107], v[116:119], v[244:247]
    s_waitcnt lgkmcnt(4)
    v_exp_f32 v249, v249
    v_mfma_f32_16x16x32_bf16 v[204:207], v[228:231], v[28:31], 0
    s_waitcnt lgkmcnt(2)
    v_cvt_pk_bf16_f32 v242, v248, v249
    v_fmac_f32 v221, v142, v142
    v_mfma_f32_16x16x32_bf16 v[204:207], v[120:123], v[28:31], v[204:207]
    s_waitcnt lgkmcnt(1)
    v_exp_f32 v250, v250
    v_mfma_f32_16x16x32_bf16 v[152:155], v[228:231], v[128:131], 0
    s_waitcnt lgkmcnt(0)
    buffer_load_dwordx4 v14, s[8:11], s23 offen nt lds
    v_fmac_f32 v221, v143, v143
    v_mfma_f32_16x16x32_bf16 v[152:155], v[120:123], v[108:111], v[152:155]
    s_add_u32 s23, s23, s21
    v_rcp_f32 v204, v204
    v_mfma_f32_16x16x32_bf16 v[116:119], v[228:231], v[156:159], 0
    s_cmp_ge_u32 s19, 72
    v_exp_f32 v251, v251
    v_mfma_f32_16x16x32_bf16 v[116:119], v[120:123], v[172:175], v[116:119]
    s_cselect_b32 s34, 72, 0
    v_cvt_pk_bf16_f32 v243, v250, v251
    v_mul_f32 v152, v152, v204
    v_mfma_f32_16x16x32_bf16 v[124:127], v[228:231], v[144:147], 0
    s_cselect_b32 s35, s22, 0
    v_exp_f32 v160, v160
    v_mfma_f32_16x16x32_bf16 v[124:127], v[120:123], v[196:199], v[124:127]
    s_sub_u32 s19, s19, s34
    v_mul_f32_dpp v152, v116, v204 quad_perm:[0,1,2,3] row_mask:0x2 bank_mask:0xf
    v_fmac_f32 v221, v188, v188
    v_mfma_f32_16x16x32_bf16 v[116:119], a[216:219], v[136:139], 0
    s_add_u32 s23, s23, s35
    v_exp_f32 v161, v161
    v_mfma_f32_16x16x32_bf16 v[116:119], a[220:223], v[200:203], v[116:119]
    s_add_u32 s18, s18, 1
    v_mul_f32_dpp v152, v124, v204 quad_perm:[0,1,2,3] row_mask:0x4 bank_mask:0xf
    v_cvt_pk_bf16_f32 v152, v152, v152
    v_mfma_f32_16x16x32_bf16 v[116:119], a[224:227], v[232:235], v[116:119]
    s_cmp_lt_u32 s18, s17
    ds_write_b16 v7, v152
    v_mfma_f32_16x16x32_bf16 v[116:119], a[228:231], v[148:151], v[116:119]
    v_cvt_pk_bf16_f32 v36, v160, v161
    v_fmac_f32 v221, v189, v189
    v_mfma_f32_16x16x32_bf16 v[116:119], a[232:235], v[224:227], v[116:119]
    v_exp_f32 v162, v162
    v_mfma_f32_16x16x32_bf16 v[116:119], a[236:239], v[176:179], v[116:119]
    v_exp_f32 v163, v163
    v_mfma_f32_16x16x32_bf16 v[204:207], v[212:215], v[132:135], v[52:55]
    v_cvt_pk_bf16_f32 v37, v162, v163
    v_fmac_f32 v221, v190, v190
    v_mfma_f32_16x16x32_bf16 v[152:155], v[180:183], v[132:135], v[56:59]
    v_exp_f32 v236, v236
    v_mfma_f32_16x16x32_bf16 v[124:127], v[208:211], v[132:135], v[60:63]
    v_cvt_pk_bf16_f32 v38, v236, 0
    v_fma_f32 v222, v116, v116, s33
    v_mfma_f32_16x16x16_bf16 v[204:207], v[194:195], v[168:169], v[204:207]
    v_fmac_f32 v222, v117, v117
    v_fmac_f32 v222, v118, v118
    v_mfma_f32_16x16x16_bf16 v[152:155], v[170:171], v[168:169], v[152:155]
    v_fmac_f32 v222, v119, v119
    v_fmac_f32 v221, v191, v191
    v_mfma_f32_16x16x16_bf16 v[124:127], v[166:167], v[168:169], v[124:127]
    v_fmac_f32 v221, v244, v244
    v_fmac_f32 v221, v245, v245
    v_mfma_f32_16x16x32_bf16 v[216:219], v[28:31], v[36:39], 0
    v_exp_f32 v204, v204
    v_mfma_f32_16x16x32_bf16 v[216:219], v[28:31], v[240:243], v[216:219]
    v_exp_f32 v205, v205
    v_mfma_f32_16x16x32_bf16 v[132:135], v[108:111], v[36:39], 0
    v_cvt_pk_bf16_f32 v204, v204, v205
    v_fmac_f32 v221, v246, v246
    v_mfma_f32_16x16x32_bf16 v[132:135], v[128:131], v[240:243], v[132:135]
    v_exp_f32 v206, v206
    v_mfma_f32_16x16x32_bf16 v[160:163], v[172:175], v[36:39], 0
    v_exp_f32 v207, v207
    v_mfma_f32_16x16x32_bf16 v[160:163], v[156:159], v[240:243], v[160:163]
    v_rcp_f32 v216, v216
    v_mfma_f32_16x16x32_bf16 v[120:123], v[196:199], v[36:39], 0
    v_cvt_pk_bf16_f32 v205, v206, v207
    v_cvt_pk_bf16_f32 v38, v184, 0
    v_mfma_f32_16x16x32_bf16 v[120:123], v[144:147], v[240:243], v[120:123]
    v_mul_f32 v132, v216, v132
    v_mul_f32 v133, v216, v133
    v_mfma_f32_16x16x32_bf16 v[240:243], v[212:215], v[112:115], v[64:67]
    v_cvt_pk_bf16_f32 v192, v132, v133
    v_mul_f32 v134, v216, v134
    v_mfma_f32_16x16x32_bf16 v[212:215], v[180:183], v[112:115], v[68:71]
    v_mul_f32 v135, v216, v135
    v_cvt_pk_bf16_f32 v193, v134, v135
    v_mfma_f32_16x16x32_bf16 v[180:183], v[208:211], v[112:115], v[72:75]
    v_mul_f32 v160, v216, v160
    v_mul_f32 v161, v216, v161
    v_mfma_f32_16x16x16_bf16 v[240:243], v[194:195], v[164:165], v[240:243]
    v_cvt_pk_bf16_f32 v194, v160, v161
    v_mul_f32 v162, v216, v162
    v_mfma_f32_16x16x16_bf16 v[212:215], v[170:171], v[164:165], v[212:215]
    v_mul_f32 v163, v216, v163
    v_cvt_pk_bf16_f32 v195, v162, v163
    v_mfma_f32_16x16x16_bf16 v[180:183], v[166:167], v[164:165], v[180:183]
    ds_write_b128 v3, v[192:195] offset:0
    v_mfma_f32_16x16x32_bf16 v[208:211], a[240:243], v[136:139], 0
    v_exp_f32 v240, v240
    v_mfma_f32_16x16x32_bf16 v[208:211], a[244:247], v[200:203], v[208:211]
    v_exp_f32 v241, v241
    v_mfma_f32_16x16x32_bf16 v[208:211], a[248:251], v[232:235], v[208:211]
    ds_read_b128 v[164:167], v2 offset:12288
    ds_read_b128 v[132:135], v2 offset:13312
    v_mfma_f32_16x16x32_bf16 v[208:211], a[252:255], v[148:151], v[208:211]
    ds_read_b128 v[168:171], v2 offset:14336
    v_cvt_pk_bf16_f32 v160, v240, v241
    v_mfma_f32_16x16x32_bf16 v[208:211], v[76:79], v[224:227], v[208:211]
    ds_read_b128 v[192:195], v2 offset:15360
    v_mul_f32 v120, v216, v120
    v_mfma_f32_16x16x32_bf16 v[208:211], v[80:83], v[176:179], v[208:211]
    ds_read_b128 v[112:115], v2 offset:16384
    v_mul_f32 v121, v216, v121
    v_mfma_f32_16x16x32_bf16 v[228:231], v[84:87], v[136:139], 0
    ds_read_b128 v[136:139], v2 offset:17408
    v_cvt_pk_bf16_f32 v206, v120, v121
    v_mfma_f32_16x16x32_bf16 v[228:231], v[88:91], v[200:203], v[228:231]
    v_exp_f32 v242, v242
    v_mfma_f32_16x16x32_bf16 v[228:231], v[92:95], v[232:235], v[228:231]
    v_exp_f32 v243, v243
    v_mfma_f32_16x16x32_bf16 v[228:231], v[96:99], v[148:151], v[228:231]
    v_cvt_pk_bf16_f32 v161, v242, v243
    v_mul_f32 v122, v216, v122
    v_mfma_f32_16x16x32_bf16 v[228:231], v[100:103], v[224:227], v[228:231]
    s_waitcnt lgkmcnt(4)
    v_exp_f32 v212, v212
    v_mfma_f32_16x16x32_bf16 v[228:231], v[104:107], v[176:179], v[228:231]
    s_waitcnt lgkmcnt(3)
    v_exp_f32 v213, v213
    v_mfma_f32_16x16x32_bf16 v[148:151], a[216:219], v[164:167], 0
    s_waitcnt lgkmcnt(2)
    v_cvt_pk_bf16_f32 v162, v212, v213
    v_mul_f32 v123, v216, v123
    v_mfma_f32_16x16x32_bf16 v[148:151], a[220:223], v[132:135], v[148:151]
    s_waitcnt lgkmcnt(1)
    v_exp_f32 v214, v214
    v_mfma_f32_16x16x32_bf16 v[148:151], a[224:227], v[168:171], v[148:151]
    s_waitcnt lgkmcnt(0)
    v_exp_f32 v215, v215
    v_mfma_f32_16x16x32_bf16 v[148:151], a[228:231], v[192:195], v[148:151]
    v_cvt_pk_bf16_f32 v163, v214, v215
    v_cvt_pk_bf16_f32 v207, v122, v123
    v_mfma_f32_16x16x32_bf16 v[148:151], a[232:235], v[112:115], v[148:151]
    ds_write_b64 v4, v[206:207] offset:4096
    v_mfma_f32_16x16x32_bf16 v[148:151], a[236:239], v[136:139], v[148:151]
    v_exp_f32 v180, v180
    v_mfma_f32_16x16x32_bf16 v[200:203], a[240:243], v[164:167], 0
    ds_read_b128 v[212:215], v0 offset:20480
    ds_read_b128 v[176:179], v1 offset:20480
    v_mfma_f32_16x16x32_bf16 v[200:203], a[244:247], v[132:135], v[200:203]
    ds_read_b128 v[216:219], v0 offset:20608
    v_fmac_f32 v222, v208, v208
    v_mfma_f32_16x16x32_bf16 v[200:203], a[248:251], v[168:171], v[200:203]
    ds_read_b128 v[120:123], v1 offset:20608
    v_fmac_f32 v222, v209, v209
    v_mfma_f32_16x16x32_bf16 v[200:203], a[252:255], v[192:195], v[200:203]
    ds_read_b128 v[240:243], v0 offset:20736
    v_fmac_f32 v222, v210, v210
    v_mfma_f32_16x16x32_bf16 v[200:203], v[76:79], v[112:115], v[200:203]
    ds_read_b128 v[224:227], v1 offset:20736
    v_fmac_f32 v222, v211, v211
    v_mfma_f32_16x16x32_bf16 v[200:203], v[80:83], v[136:139], v[200:203]
    v_exp_f32 v181, v181
    v_mfma_f32_16x16x32_bf16 v[232:235], v[84:87], v[164:167], 0
    v_exp_f32 v182, v182
    v_mfma_f32_16x16x32_bf16 v[232:235], v[88:91], v[132:135], v[232:235]
    v_exp_f32 v183, v183
    v_mfma_f32_16x16x32_bf16 v[232:235], v[92:95], v[168:171], v[232:235]
    s_waitcnt lgkmcnt(4)
    v_exp_f32 v152, v152
    v_mfma_f32_16x16x32_bf16 v[232:235], v[96:99], v[192:195], v[232:235]
    s_waitcnt lgkmcnt(3)
    v_exp_f32 v153, v153
    v_mfma_f32_16x16x32_bf16 v[232:235], v[100:103], v[112:115], v[232:235]
    s_waitcnt lgkmcnt(2)
    v_cvt_pk_bf16_f32 v206, v152, v153
    v_fmac_f32 v222, v228, v228
    v_mfma_f32_16x16x32_bf16 v[232:235], v[104:107], v[136:139], v[232:235]
    s_waitcnt lgkmcnt(1)
    v_exp_f32 v154, v154
    v_mfma_f32_16x16x32_bf16 v[192:195], a[72:75], v[212:215], 0
    s_waitcnt lgkmcnt(0)
    v_exp_f32 v155, v155
    v_mfma_f32_16x16x32_bf16 v[192:195], a[76:79], v[176:179], v[192:195]
    v_cvt_pk_bf16_f32 v207, v154, v155
    v_fmac_f32 v222, v229, v229
    v_mfma_f32_16x16x32_bf16 v[192:195], a[80:83], v[216:219], v[192:195]
    v_exp_f32 v124, v124
    v_mfma_f32_16x16x32_bf16 v[192:195], a[84:87], v[120:123], v[192:195]
    v_exp_f32 v125, v125
    v_mfma_f32_16x16x32_bf16 v[192:195], a[88:91], v[240:243], v[192:195]
    v_cvt_pk_bf16_f32 v36, v124, v125
    v_fmac_f32 v222, v230, v230
    v_mfma_f32_16x16x32_bf16 v[192:195], a[92:95], v[224:227], v[192:195]
    v_exp_f32 v126, v126
    v_mfma_f32_16x16x32_bf16 v[152:155], a[96:99], v[212:215], 0
    v_exp_f32 v127, v127
    v_mfma_f32_16x16x32_bf16 v[152:155], a[100:103], v[176:179], v[152:155]
    v_cvt_pk_bf16_f32 v37, v126, v127
    v_fmac_f32 v222, v231, v231
    v_mfma_f32_16x16x32_bf16 v[152:155], a[104:107], v[216:219], v[152:155]
    v_fma_f32 v223, v148, v148, s33
    v_fmac_f32 v223, v149, v149
    v_mfma_f32_16x16x32_bf16 v[124:127], v[28:31], v[36:39], 0
    v_fmac_f32 v223, v150, v150
    v_fmac_f32 v223, v151, v151
    v_mfma_f32_16x16x32_bf16 v[124:127], v[28:31], v[204:207], v[124:127]
    v_fmac_f32 v223, v200, v200
    v_fmac_f32 v223, v201, v201
    v_mfma_f32_16x16x32_bf16 v[164:167], v[108:111], v[36:39], 0
    v_fmac_f32 v223, v202, v202
    v_fmac_f32 v223, v203, v203
    v_mfma_f32_16x16x32_bf16 v[164:167], v[128:131], v[204:207], v[164:167]
    v_fmac_f32 v223, v232, v232
    v_fmac_f32 v223, v233, v233
    v_mfma_f32_16x16x32_bf16 v[168:171], v[172:175], v[36:39], 0
    v_rcp_f32 v124, v124
    v_mfma_f32_16x16x32_bf16 v[168:171], v[156:159], v[204:207], v[168:171]
    v_fmac_f32 v223, v234, v234
    v_fmac_f32 v223, v235, v235
    v_mfma_f32_16x16x32_bf16 v[132:135], v[196:199], v[36:39], 0
    v_cvt_pk_bf16_f32 v36, v180, v181
    v_cvt_pk_bf16_f32 v37, v182, v183
    v_mfma_f32_16x16x32_bf16 v[132:135], v[144:147], v[204:207], v[132:135]
    v_cvt_pk_bf16_f32 v38, v220, 0
    v_mul_f32 v164, v124, v164
    v_mfma_f32_16x16x32_bf16 v[152:155], a[108:111], v[120:123], v[152:155]
    v_mul_f32 v165, v124, v165
    v_cvt_pk_bf16_f32 v204, v164, v165
    v_mfma_f32_16x16x32_bf16 v[180:183], v[28:31], v[36:39], 0
    v_mul_f32 v166, v124, v166
    v_mul_f32 v167, v124, v167
    v_mfma_f32_16x16x32_bf16 v[180:183], v[28:31], v[160:163], v[180:183]
    v_cvt_pk_bf16_f32 v205, v166, v167
    v_mul_f32 v168, v124, v168
    v_mfma_f32_16x16x32_bf16 v[164:167], v[108:111], v[36:39], 0
    v_mul_f32 v169, v124, v169
    v_cvt_pk_bf16_f32 v206, v168, v169
    v_mfma_f32_16x16x32_bf16 v[164:167], v[128:131], v[160:163], v[164:167]
    v_mul_f32 v170, v124, v170
    v_mul_f32 v171, v124, v171
    v_mfma_f32_16x16x32_bf16 v[128:131], v[172:175], v[36:39], 0
    v_cvt_pk_bf16_f32 v207, v170, v171
    v_mul_f32 v132, v124, v132
    v_mfma_f32_16x16x32_bf16 v[128:131], v[156:159], v[160:163], v[128:131]
    ds_write_b128 v3, v[204:207] offset:6144
    v_mfma_f32_16x16x32_bf16 v[156:159], v[196:199], v[36:39], 0
    v_mul_f32 v133, v124, v133
    v_cvt_pk_bf16_f32 v132, v132, v133
    v_mfma_f32_16x16x32_bf16 v[156:159], v[144:147], v[160:163], v[156:159]
    v_mul_f32 v134, v124, v134
    v_mul_f32 v135, v124, v135
    v_mfma_f32_16x16x32_bf16 v[152:155], a[112:115], v[240:243], v[152:155]
    v_cvt_pk_bf16_f32 v133, v134, v135
    v_cvt_pk_bf16_f32 v223, v223, v223
    v_mfma_f32_16x16x32_bf16 v[152:155], a[116:119], v[224:227], v[152:155]
    ds_write_b64 v4, v[132:133] offset:10240
    v_mfma_f32_16x16x32_bf16 v[144:147], a[120:123], v[212:215], 0
    v_rcp_f32 v180, v180
    v_mfma_f32_16x16x32_bf16 v[144:147], a[124:127], v[176:179], v[144:147]
    v_mul_f32 v164, v180, v164
    v_mul_f32 v165, v180, v165
    v_mfma_f32_16x16x32_bf16 v[144:147], a[128:131], v[216:219], v[144:147]
    v_cvt_pk_bf16_f32 v204, v164, v165
    v_mul_f32 v166, v180, v166
    v_mfma_f32_16x16x32_bf16 v[144:147], a[132:135], v[120:123], v[144:147]
    v_mul_f32 v167, v180, v167
    v_cvt_pk_bf16_f32 v205, v166, v167
    v_mfma_f32_16x16x32_bf16 v[144:147], a[136:139], v[240:243], v[144:147]
    v_mul_f32 v128, v180, v128
    v_mul_f32 v129, v180, v129
    v_mfma_f32_16x16x32_bf16 v[144:147], a[140:143], v[224:227], v[144:147]
    v_cvt_pk_bf16_f32 v206, v128, v129
    v_mul_f32 v130, v180, v130
    v_mfma_f32_16x16x32_bf16 v[124:127], a[0:3], v[212:215], 0
    v_mul_f32 v131, v180, v131
    v_cvt_pk_bf16_f32 v207, v130, v131
    v_mfma_f32_16x16x32_bf16 v[124:127], a[4:7], v[176:179], v[124:127]
    ds_write_b128 v3, v[204:207] offset:12288
    v_mfma_f32_16x16x32_bf16 v[124:127], a[8:11], v[216:219], v[124:127]
    v_mul_f32 v156, v180, v156
    v_mul_f32 v157, v180, v157
    v_mfma_f32_16x16x32_bf16 v[124:127], a[12:15], v[120:123], v[124:127]
    v_cvt_pk_bf16_f32 v156, v156, v157
    v_mul_f32 v158, v180, v158
    v_mfma_f32_16x16x32_bf16 v[124:127], a[16:19], v[240:243], v[124:127]
    v_mul_f32 v159, v180, v159
    v_cvt_pk_bf16_f32 v157, v158, v159
    v_mfma_f32_16x16x32_bf16 v[124:127], a[20:23], v[224:227], v[124:127]
    ds_write_b64 v4, v[156:157] offset:16384
    v_mfma_f32_16x16x32_bf16 v[180:183], a[24:27], v[212:215], 0
    v_fmac_f32 v221, v247, v247
    v_cvt_pk_bf16_f32 v222, v221, v222
    v_mfma_f32_16x16x32_bf16 v[180:183], a[28:31], v[176:179], v[180:183]
    ds_write_b64 v4, v[222:223] offset:18432
    v_mfma_f32_16x16x32_bf16 v[180:183], a[32:35], v[216:219], v[180:183]
    v_fma_f32 v108, v192, v192, s32
    v_fmac_f32 v108, v193, v193
    v_mfma_f32_16x16x32_bf16 v[180:183], a[36:39], v[120:123], v[180:183]
    v_fmac_f32 v108, v194, v194
    v_fmac_f32 v108, v195, v195
    v_mfma_f32_16x16x32_bf16 v[180:183], a[40:43], v[240:243], v[180:183]
    v_fmac_f32 v108, v152, v152
    v_fmac_f32 v108, v153, v153
    v_mfma_f32_16x16x32_bf16 v[180:183], a[44:47], v[224:227], v[180:183]
    v_fmac_f32 v108, v154, v154
    v_fmac_f32 v108, v155, v155
    v_mfma_f32_16x16x32_bf16 v[220:223], a[48:51], v[212:215], 0
    v_fmac_f32 v108, v144, v144
    v_fmac_f32 v108, v145, v145
    v_mfma_f32_16x16x32_bf16 v[220:223], a[52:55], v[176:179], v[220:223]
    v_fmac_f32 v108, v146, v146
    v_fmac_f32 v108, v147, v147
    v_mfma_f32_16x16x32_bf16 v[220:223], a[56:59], v[216:219], v[220:223]
    s_waitcnt lgkmcnt(0)
    v_fma_f32 v109, v124, v124, s32
    v_fmac_f32 v109, v125, v125
    v_mfma_f32_16x16x32_bf16 v[220:223], a[60:63], v[120:123], v[220:223]
    s_nop 0
    v_fmac_f32 v109, v126, v126
    v_fmac_f32 v109, v127, v127
    v_mfma_f32_16x16x32_bf16 v[220:223], a[64:67], v[240:243], v[220:223]
    s_nop 0
    v_fmac_f32 v109, v180, v180
    v_fmac_f32 v109, v181, v181
    v_mfma_f32_16x16x32_bf16 v[220:223], a[68:71], v[224:227], v[220:223]
    s_barrier
    v_fmac_f32 v109, v182, v182
    v_fmac_f32 v109, v183, v183
    v_mfma_f32_16x16x32_bf16 v[128:131], v[212:215], a[144:147], 0
    s_nop 0
    v_add_u32 v6, 272, v6
    v_add_u32 v7, 16, v7
    v_mfma_f32_16x16x32_bf16 v[128:131], v[176:179], a[148:151], v[128:131]
    v_fmac_f32 v109, v220, v220
    v_fmac_f32 v109, v221, v221
    v_mfma_f32_16x16x32_bf16 v[128:131], v[216:219], a[152:155], v[128:131]
    v_fmac_f32 v109, v222, v222
    v_fmac_f32 v109, v223, v223
    v_mfma_f32_16x16x32_bf16 v[128:131], v[120:123], a[156:159], v[128:131]
    v_cvt_pk_bf16_f32 v38, v109, v108
    v_xor_b32 v2, 65536, v2
    v_mfma_f32_16x16x32_bf16 v[128:131], v[240:243], a[160:163], v[128:131]
    v_xor_b32 v3, 65536, v3
    v_xor_b32 v4, 65536, v4
    v_mfma_f32_16x16x32_bf16 v[128:131], v[224:227], a[164:167], v[128:131]
    s_cbranch_scc1 L_loop_fast2
    s_branch L_drain
.p2align 6
L_loop_fast3:
    v_mfma_f32_16x16x16_bf16 v[164:167], v[32:33], v[38:39], 0
    s_cmp_ge_u32 s18, 2
    ds_read_b128 v[204:207], v2 offset:18432
    ds_read_b128 v[108:111], v2 offset:19456
    v_mfma_f32_16x16x32_bf16 v[156:159], v[212:215], a[168:171], 0
    s_cselect_b32 s14, s36, 0
    ds_read_b128 v[168:171], v0 offset:26624
    ds_read_b128 v[132:135], v1 offset:26624
    v_mfma_f32_16x16x32_bf16 v[156:159], v[176:179], a[172:175], v[156:159]
    s_add_u32 s34, s18, 2
    ds_read_b128 v[160:163], v0 offset:26752
    ds_read_b128 v[112:115], v1 offset:26752
    v_mfma_f32_16x16x32_bf16 v[156:159], v[216:219], a[176:179], v[156:159]
    s_cmp_lt_u32 s34, s17
    ds_read_b128 v[172:175], v0 offset:26880
    v_cvt_pk_bf16_f32 v128, v128, v129
    v_mfma_f32_16x16x32_bf16 v[156:159], v[120:123], a[180:183], v[156:159]
    s_cselect_b32 s10, s36, 0
    ds_read_b128 v[196:199], v1 offset:26880
    v_cvt_pk_bf16_f32 v129, v130, v131
    v_mfma_f32_16x16x32_bf16 v[156:159], v[240:243], a[184:187], v[156:159]
    s_add_u32 m0, s28, 0
    v_rsq_f32 v165, v165
    v_mfma_f32_16x16x32_bf16 v[156:159], v[224:227], a[188:191], v[156:159]
    v_rsq_f32 v164, v164
    v_mfma_f32_16x16x32_bf16 v[136:139], v[212:215], a[192:195], 0
    v_mul_f32 v164, s31, v164
    v_mul_f32 v192, v165, v192
    v_mfma_f32_16x16x32_bf16 v[136:139], v[176:179], a[196:199], v[136:139]
    s_waitcnt lgkmcnt(6)
    v_mul_f32 v193, v165, v193
    v_cvt_pk_bf16_f32 v212, v192, v193
    v_mfma_f32_16x16x32_bf16 v[176:179], v[32:35], v[204:207], 0
    s_waitcnt lgkmcnt(4)
    v_cvt_pk_bf16_f32 v156, v156, v157
    v_cvt_pk_bf16_f32 v157, v158, v159
    v_mfma_f32_16x16x32_bf16 v[176:179], v[32:35], v[108:111], v[176:179]
    s_waitcnt lgkmcnt(2)
    v_mul_f32 v194, v165, v194
    v_mul_f32 v195, v165, v195
    v_mfma_f32_16x16x32_bf16 v[136:139], v[216:219], a[200:203], v[136:139]
    s_waitcnt lgkmcnt(1)
    v_cvt_pk_bf16_f32 v213, v194, v195
    v_mul_f32 v152, v165, v152
    v_mfma_f32_16x16x32_bf16 v[136:139], v[120:123], a[204:207], v[136:139]
    s_waitcnt lgkmcnt(0)
    v_mul_f32 v153, v165, v153
    v_cvt_pk_bf16_f32 v214, v152, v153
    v_mfma_f32_16x16x32_bf16 v[136:139], v[240:243], a[208:211], v[136:139]
    v_mul_f32 v154, v165, v154
    v_mul_f32 v155, v165, v155
    v_mfma_f32_16x16x32_bf16 v[136:139], v[224:227], a[212:215], v[136:139]
    v_cvt_pk_bf16_f32 v215, v154, v155
    v_mul_f32 v144, v165, v144
    v_mfma_f32_16x16x32_bf16 v[240:243], a[72:75], v[168:171], 0
    v_mul_f32 v145, v165, v145
    v_cvt_pk_bf16_f32 v194, v144, v145
    v_mfma_f32_16x16x32_bf16 v[240:243], a[76:79], v[132:135], v[240:243]
    v_mul_f32 v146, v165, v146
    v_mul_f32 v147, v165, v147
    v_mfma_f32_16x16x32_bf16 v[240:243], a[80:83], v[160:163], v[240:243]
    v_cvt_pk_bf16_f32 v144, v136, v137
    v_cvt_pk_bf16_f32 v145, v138, v139
    v_mfma_f32_16x16x32_bf16 v[240:243], a[84:87], v[112:115], v[240:243]
    v_cvt_pk_bf16_f32 v195, v146, v147
    v_mul_f32 v124, v164, v124
    v_mfma_f32_16x16x32_bf16 v[240:243], a[88:91], v[172:175], v[240:243]
    v_mul_f32 v125, v164, v125
    v_cvt_pk_bf16_f32 v204, v124, v125
    v_mfma_f32_16x16x32_bf16 v[240:243], a[92:95], v[196:199], v[240:243]
    v_mul_f32 v126, v164, v126
    v_mul_f32 v127, v164, v127
    v_mfma_f32_16x16x32_bf16 v[120:123], a[96:99], v[168:171], 0
    v_cvt_pk_bf16_f32 v205, v126, v127
    v_mul_f32 v180, v164, v180
    v_mfma_f32_16x16x32_bf16 v[120:123], a[100:103], v[132:135], v[120:123]
    v_mul_f32 v181, v164, v181
    v_cvt_pk_bf16_f32 v206, v180, v181
    v_mfma_f32_16x16x32_bf16 v[120:123], a[104:107], v[160:163], v[120:123]
    v_mul_f32 v182, v164, v182
    v_mul_f32 v183, v164, v183
    v_mfma_f32_16x16x32_bf16 v[120:123], a[108:111], v[112:115], v[120:123]
    v_cvt_pk_bf16_f32 v207, v182, v183
    v_mul_f32 v220, v164, v220
    v_mfma_f32_16x16x32_bf16 v[120:123], a[112:115], v[172:175], v[120:123]
    v_mul_f32 v221, v164, v221
    v_cvt_pk_bf16_f32 v192, v220, v221
    v_mfma_f32_16x16x32_bf16 v[120:123], a[116:119], v[196:199], v[120:123]
    v_mul_f32 v222, v164, v222
    v_mul_f32 v223, v164, v223
    v_mfma_f32_16x16x32_bf16 v[224:227], a[120:123], v[168:171], 0
    v_cvt_pk_bf16_f32 v193, v222, v223
    v_mul_f32 v130, 0x3baaaaab, v176
    v_mfma_f32_16x16x32_bf16 v[224:227], a[124:127], v[132:135], v[224:227]
    v_rsq_f32 v130, v130
    v_mfma_f32_16x16x32_bf16 v[224:227], a[128:131], v[160:163], v[224:227]
    v_mul_f32 v146, 0x3baaaaab, v177
    v_mul_f32 v108, 0x3baaaaab, v178
    v_mfma_f32_16x16x32_bf16 v[224:227], a[132:135], v[112:115], v[224:227]
    v_rsq_f32 v146, v146
    v_mfma_f32_16x16x32_bf16 v[224:227], a[136:139], v[172:175], v[224:227]
    v_rsq_f32 v108, v108
    v_mfma_f32_16x16x32_bf16 v[224:227], a[140:143], v[196:199], v[224:227]
    v_mul_f32 v140, v130, v140
    v_mul_f32 v141, v130, v141
    v_mfma_f32_16x16x32_bf16 v[136:139], a[0:3], v[168:171], 0
    v_cvt_pk_bf16_f32 v176, v140, v141
    v_mul_f32 v142, v130, v142
    v_mfma_f32_16x16x32_bf16 v[136:139], a[4:7], v[132:135], v[136:139]
    v_mul_f32 v143, v130, v143
    v_cvt_pk_bf16_f32 v177, v142, v143
    v_mfma_f32_16x16x32_bf16 v[136:139], a[8:11], v[160:163], v[136:139]
    v_mul_f32 v188, v130, v188
    v_mul_f32 v189, v130, v189
    v_mfma_f32_16x16x32_bf16 v[136:139], a[12:15], v[112:115], v[136:139]
    v_cvt_pk_bf16_f32 v178, v188, v189
    v_mul_f32 v190, v130, v190
    v_mfma_f32_16x16x32_bf16 v[136:139], a[16:19], v[172:175], v[136:139]
    v_mul_f32 v191, v130, v191
    v_cvt_pk_bf16_f32 v179, v190, v191
    v_mfma_f32_16x16x32_bf16 v[136:139], a[20:23], v[196:199], v[136:139]
    buffer_store_dwordx4 v[176:179], v15, s[12:15], s27 offen
    v_mul_f32 v244, v130, v244
    v_mul_f32 v245, v130, v245
    v_cvt_pk_bf16_f32 v158, v244, v245
    v_mul_f32 v246, v130, v246
    v_mfma_f32_16x16x32_bf16 v[188:191], a[24:27], v[168:171], 0
    v_mul_f32 v247, v130, v247
    v_cvt_pk_bf16_f32 v159, v246, v247
    v_mfma_f32_16x16x32_bf16 v[188:191], a[28:31], v[132:135], v[188:191]
    v_fma_f32 v147, v136, v136, s32
    v_fmac_f32 v147, v137, v137
    v_mfma_f32_16x16x32_bf16 v[188:191], a[32:35], v[160:163], v[188:191]
    v_fmac_f32 v147, v138, v138
    v_fmac_f32 v147, v139, v139
    v_mfma_f32_16x16x32_bf16 v[188:191], a[36:39], v[112:115], v[188:191]
    v_fma_f32 v130, v240, v240, s32
    v_fmac_f32 v130, v241, v241
    v_mfma_f32_16x16x32_bf16 v[188:191], a[40:43], v[172:175], v[188:191]
    v_fmac_f32 v130, v242, v242
    v_fmac_f32 v130, v243, v243
    v_mfma_f32_16x16x32_bf16 v[188:191], a[44:47], v[196:199], v[188:191]
    v_fmac_f32 v130, v120, v120
    v_fmac_f32 v130, v121, v121
    v_mfma_f32_16x16x32_bf16 v[244:247], a[48:51], v[168:171], 0
    v_fmac_f32 v130, v122, v122
    v_fmac_f32 v130, v123, v123
    v_mfma_f32_16x16x32_bf16 v[244:247], a[52:55], v[132:135], v[244:247]
    v_fmac_f32 v130, v224, v224
    v_fmac_f32 v130, v225, v225
    v_mfma_f32_16x16x32_bf16 v[244:247], a[56:59], v[160:163], v[244:247]
    v_fmac_f32 v147, v188, v188
    v_fmac_f32 v147, v189, v189
    v_mfma_f32_16x16x32_bf16 v[244:247], a[60:63], v[112:115], v[244:247]
    v_fmac_f32 v147, v190, v190
    v_fmac_f32 v147, v191, v191
    v_mfma_f32_16x16x32_bf16 v[244:247], a[64:67], v[172:175], v[244:247]
    v_fmac_f32 v130, v226, v226
    v_fmac_f32 v130, v227, v227
    v_mfma_f32_16x16x32_bf16 v[244:247], a[68:71], v[196:199], v[244:247]
    v_mul_f32 v116, v146, v116
    v_mul_f32 v117, v146, v117
    v_mfma_f32_16x16x32_bf16 v[180:183], v[168:171], a[144:147], 0
    v_cvt_pk_bf16_f32 v164, v116, v117
    v_mul_f32 v118, v146, v118
    v_mfma_f32_16x16x32_bf16 v[180:183], v[132:135], a[148:151], v[180:183]
    v_mul_f32 v119, v146, v119
    v_cvt_pk_bf16_f32 v165, v118, v119
    v_mfma_f32_16x16x32_bf16 v[180:183], v[160:163], a[152:155], v[180:183]
    v_fmac_f32 v147, v244, v244
    v_fmac_f32 v147, v245, v245
    v_mfma_f32_16x16x32_bf16 v[180:183], v[112:115], a[156:159], v[180:183]
    v_fmac_f32 v147, v246, v246
    v_fmac_f32 v147, v247, v247
    v_mfma_f32_16x16x32_bf16 v[180:183], v[172:175], a[160:163], v[180:183]
    ds_read_b128 v[176:179], v0 offset:32768
    buffer_store_dwordx2 v[158:159], v18, s[12:15], s27 offen
    v_cvt_pk_bf16_f32 v38, v147, v130
    v_mul_f32 v208, v146, v208
    v_mfma_f32_16x16x32_bf16 v[180:183], v[196:199], a[164:167], v[180:183]
    ds_read_b128 v[152:155], v1 offset:32768
    v_mul_f32 v209, v146, v209
    v_mfma_f32_16x16x16_bf16 v[248:251], v[32:33], v[38:39], 0
    v_cvt_pk_bf16_f32 v166, v208, v209
    v_mul_f32 v210, v146, v210
    v_mfma_f32_16x16x32_bf16 v[184:187], v[168:171], a[168:171], 0
    ds_read_b128 v[216:219], v0 offset:32896
    v_mul_f32 v211, v146, v211
    v_mfma_f32_16x16x32_bf16 v[184:187], v[132:135], a[172:175], v[184:187]
    ds_read_b128 v[220:223], v1 offset:32896
    v_cvt_pk_bf16_f32 v130, v180, v181
    v_mfma_f32_16x16x32_bf16 v[184:187], v[160:163], a[176:179], v[184:187]
    ds_read_b128 v[124:127], v0 offset:33024
    v_cvt_pk_bf16_f32 v131, v182, v183
    v_mfma_f32_16x16x32_bf16 v[184:187], v[112:115], a[180:183], v[184:187]
    ds_read_b128 v[116:119], v1 offset:33024
    v_cvt_pk_bf16_f32 v167, v210, v211
    v_mfma_f32_16x16x32_bf16 v[184:187], v[172:175], a[184:187], v[184:187]
    s_waitcnt lgkmcnt(5)
    v_rsq_f32 v249, v249
    v_mfma_f32_16x16x32_bf16 v[184:187], v[196:199], a[188:191], v[184:187]
    v_rsq_f32 v248, v248
    v_mfma_f32_16x16x32_bf16 v[236:239], v[168:171], a[192:195], 0
    s_waitcnt lgkmcnt(4)
    v_mul_f32 v248, s31, v248
    v_mul_f32 v228, v146, v228
    v_mfma_f32_16x16x32_bf16 v[236:239], v[132:135], a[196:199], v[236:239]
    v_mul_f32 v229, v146, v229
    v_cvt_pk_bf16_f32 v140, v228, v229
    v_mfma_f32_16x16x32_bf16 v[236:239], v[160:163], a[200:203], v[236:239]
    s_waitcnt lgkmcnt(3)
    v_cvt_pk_bf16_f32 v158, v184, v185
    v_cvt_pk_bf16_f32 v159, v186, v187
    v_mfma_f32_16x16x32_bf16 v[236:239], v[112:115], a[204:207], v[236:239]
    s_waitcnt lgkmcnt(2)
    v_mul_f32 v230, v146, v230
    v_mul_f32 v231, v146, v231
    v_mfma_f32_16x16x32_bf16 v[236:239], v[172:175], a[208:211], v[236:239]
    s_waitcnt lgkmcnt(1)
    v_cvt_pk_bf16_f32 v141, v230, v231
    v_mul_f32 v240, v249, v240
    v_mfma_f32_16x16x32_bf16 v[236:239], v[196:199], a[212:215], v[236:239]
    s_waitcnt lgkmcnt(0)
    v_mul_f32 v241, v249, v241
    v_cvt_pk_bf16_f32 v180, v240, v241
    v_mfma_f32_16x16x32_bf16 v[208:211], a[72:75], v[176:179], 0
    v_mul_f32 v242, v249, v242
    v_mul_f32 v243, v249, v243
    v_mfma_f32_16x16x32_bf16 v[208:211], a[76:79], v[152:155], v[208:211]
    v_cvt_pk_bf16_f32 v181, v242, v243
    v_cvt_pk_bf16_f32 v146, v236, v237
    v_mfma_f32_16x16x32_bf16 v[208:211], a[80:83], v[216:219], v[208:211]
    buffer_store_dwordx4 v[164:167], v16, s[12:15], s27 offen
    v_cvt_pk_bf16_f32 v147, v238, v239
    v_mul_f32 v120, v249, v120
    v_mul_f32 v121, v249, v121
    v_cvt_pk_bf16_f32 v182, v120, v121
    v_mfma_f32_16x16x32_bf16 v[208:211], a[84:87], v[220:223], v[208:211]
    v_mul_f32 v122, v249, v122
    v_mul_f32 v123, v249, v123
    v_mfma_f32_16x16x32_bf16 v[208:211], a[88:91], v[124:127], v[208:211]
    v_cvt_pk_bf16_f32 v183, v122, v123
    v_mul_f32 v224, v249, v224
    v_mfma_f32_16x16x32_bf16 v[208:211], a[92:95], v[116:119], v[208:211]
    v_mul_f32 v225, v249, v225
    v_cvt_pk_bf16_f32 v170, v224, v225
    v_mfma_f32_16x16x32_bf16 v[164:167], a[96:99], v[176:179], 0
    v_mul_f32 v226, v249, v226
    v_mul_f32 v227, v249, v227
    v_mfma_f32_16x16x32_bf16 v[164:167], a[100:103], v[152:155], v[164:167]
    v_cvt_pk_bf16_f32 v171, v226, v227
    v_mul_f32 v136, v248, v136
    v_mfma_f32_16x16x32_bf16 v[164:167], a[104:107], v[216:219], v[164:167]
    s_waitcnt vmcnt(3)
    v_mul_f32 v137, v248, v137
    v_cvt_pk_bf16_f32 v132, v136, v137
    v_mfma_f32_16x16x32_bf16 v[164:167], a[108:111], v[220:223], v[164:167]
    s_nop 0
    v_mul_f32 v138, v248, v138
    v_mul_f32 v139, v248, v139
    v_mfma_f32_16x16x32_bf16 v[164:167], a[112:115], v[124:127], v[164:167]
    s_nop 0
    v_cvt_pk_bf16_f32 v133, v138, v139
    v_mul_f32 v188, v248, v188
    v_mfma_f32_16x16x32_bf16 v[164:167], a[116:119], v[116:119], v[164:167]
    s_nop 0
    v_mul_f32 v189, v248, v189
    v_cvt_pk_bf16_f32 v134, v188, v189
    v_mfma_f32_16x16x32_bf16 v[112:115], a[120:123], v[176:179], 0
    s_barrier
    v_mul_f32 v190, v248, v190
    v_mul_f32 v191, v248, v191
    v_mfma_f32_16x16x32_bf16 v[112:115], a[124:127], v[152:155], v[112:115]
    v_cvt_pk_bf16_f32 v135, v190, v191
    v_mul_f32 v244, v248, v244
    v_mfma_f32_16x16x32_bf16 v[112:115], a[128:131], v[216:219], v[112:115]
    v_mul_f32 v245, v248, v245
    v_cvt_pk_bf16_f32 v168, v244, v245
    v_mfma_f32_16x16x32_bf16 v[112:115], a[132:135], v[220:223], v[112:115]
    v_mul_f32 v246, v248, v246
    v_mul_f32 v247, v248, v247
    v_mfma_f32_16x16x32_bf16 v[112:115], a[136:139], v[124:127], v[112:115]
    v_cvt_pk_bf16_f32 v169, v246, v247
    v_fma_f32 v142, v208, v208, s32
    v_mfma_f32_16x16x32_bf16 v[112:115], a[140:143], v[116:119], v[112:115]
    v_fmac_f32 v142, v209, v209
    v_fmac_f32 v142, v210, v210
    v_mfma_f32_16x16x32_bf16 v[188:191], a[0:3], v[176:179], 0
    v_fmac_f32 v142, v211, v211
    v_fmac_f32 v142, v164, v164
    v_mfma_f32_16x16x32_bf16 v[188:191], a[4:7], v[152:155], v[188:191]
    buffer_load_dwordx4 v10, s[8:11], s23 offen nt lds
    v_fmac_f32 v142, v165, v165
    v_mfma_f32_16x16x32_bf16 v[188:191], a[8:11], v[216:219], v[188:191]
    s_add_u32 m0, s28, 4096
    v_fmac_f32 v142, v166, v166
    v_fmac_f32 v142, v167, v167
    v_mfma_f32_16x16x32_bf16 v[188:191], a[12:15], v[220:223], v[188:191]
    v_fmac_f32 v142, v112, v112
    v_fmac_f32 v142, v113, v113
    v_mfma_f32_16x16x32_bf16 v[188:191], a[16:19], v[124:127], v[188:191]
    v_fmac_f32 v142, v114, v114
    v_fmac_f32 v142, v115, v115
    v_mfma_f32_16x16x32_bf16 v[188:191], a[20:23], v[116:119], v[188:191]
    v_mul_f32 v148, v108, v148
    v_mul_f32 v149, v108, v149
    v_mfma_f32_16x16x32_bf16 v[136:139], a[24:27], v[176:179], 0
    buffer_load_dwordx4 v11, s[8:11], s23 offen nt lds
    v_cvt_pk_bf16_f32 v160, v148, v149
    v_mfma_f32_16x16x32_bf16 v[136:139], a[28:31], v[152:155], v[136:139]
    s_add_u32 m0, s28, 8192
    v_mul_f32 v150, v108, v150
    v_fma_f32 v143, v188, v188, s32
    v_mfma_f32_16x16x32_bf16 v[136:139], a[32:35], v[216:219], v[136:139]
    v_fmac_f32 v143, v189, v189
    v_fmac_f32 v143, v190, v190
    v_mfma_f32_16x16x32_bf16 v[136:139], a[36:39], v[220:223], v[136:139]
    v_fmac_f32 v143, v191, v191
    v_mul_f32 v151, v108, v151
    v_mfma_f32_16x16x32_bf16 v[136:139], a[40:43], v[124:127], v[136:139]
    v_cvt_pk_bf16_f32 v161, v150, v151
    v_mul_f32 v200, v108, v200
    v_mfma_f32_16x16x32_bf16 v[136:139], a[44:47], v[116:119], v[136:139]
    buffer_load_dwordx4 v12, s[8:11], s23 offen nt lds
    v_mul_f32 v201, v108, v201
    v_mfma_f32_16x16x32_bf16 v[148:151], a[48:51], v[176:179], 0
    s_add_u32 m0, s28, 12288
    v_cvt_pk_bf16_f32 v162, v200, v201
    v_mul_f32 v202, v108, v202
    v_mfma_f32_16x16x32_bf16 v[148:151], a[52:55], v[152:155], v[148:151]
    s_xor_b32 s28, s28, 65536
    v_fmac_f32 v143, v136, v136
    v_fmac_f32 v143, v137, v137
    v_mfma_f32_16x16x32_bf16 v[148:151], a[56:59], v[216:219], v[148:151]
    v_fmac_f32 v143, v138, v138
    v_fmac_f32 v143, v139, v139
    v_mfma_f32_16x16x32_bf16 v[148:151], a[60:63], v[220:223], v[148:151]
    v_mul_f32 v203, v108, v203
    v_cvt_pk_bf16_f32 v163, v202, v203
    v_mfma_f32_16x16x32_bf16 v[148:151], a[64:67], v[124:127], v[148:151]
    buffer_load_dwordx4 v13, s[8:11], s23 offen nt lds
    ds_read_b128 v[120:123], v5 offset:0
    v_mfma_f32_16x16x32_bf16 v[148:151], a[68:71], v[116:119], v[148:151]
    s_mov_b32 m0, s29
    ds_read_b128 v[228:231], v5 offset:16
    ds_read_b128 v[200:203], v5 offset:48
    v_mfma_f32_16x16x32_bf16 v[184:187], v[176:179], a[144:147], 0
    s_xor_b32 s29, s29, s30
    ds_read_b32 v224, v6 offset:192
    ds_read2_b32 v[110:111], v6 offset0:0 offset1:0
    v_mfma_f32_16x16x32_bf16 v[184:187], v[152:155], a[148:151], v[184:187]
    s_add_u32 s19, s19, s20
    ds_read2_b32 v[174:175], v6 offset0:16 offset1:16
    ds_read2_b32 v[198:199], v6 offset0:32 offset1:32
    v_mfma_f32_16x16x32_bf16 v[184:187], v[216:219], a[152:155], v[184:187]
    v_fmac_f32 v143, v148, v148
    v_fmac_f32 v143, v149, v149
    v_mfma_f32_16x16x32_bf16 v[184:187], v[220:223], a[156:159], v[184:187]
    buffer_store_dwordx2 v[140:141], v19, s[12:15], s27 offen
    v_fmac_f32 v143, v150, v150
    v_fmac_f32 v143, v151, v151
    v_mfma_f32_16x16x32_bf16 v[184:187], v[124:127], a[160:163], v[184:187]
    v_cvt_pk_bf16_f32 v38, v143, v142
    v_mul_f32 v232, v108, v232
    v_mfma_f32_16x16x32_bf16 v[184:187], v[116:119], a[164:167], v[184:187]
    v_mul_f32 v233, v108, v233
    v_cvt_pk_bf16_f32 v232, v232, v233
    v_mfma_f32_16x16x16_bf16 v[140:143], v[32:33], v[38:39], 0
    s_waitcnt lgkmcnt(5)
    v_mul_f32 v234, v108, v234
    v_mul_f32 v235, v108, v235
    v_mfma_f32_16x16x32_bf16 v[236:239], v[120:123], v[204:207], v[22:25]
    s_waitcnt lgkmcnt(3)
    v_cvt_pk_bf16_f32 v108, v184, v185
    v_cvt_pk_bf16_f32 v109, v186, v187
    v_mfma_f32_16x16x32_bf16 v[236:239], v[228:231], v[212:215], v[236:239]
    s_waitcnt lgkmcnt(1)
    v_rsq_f32 v141, v141
    v_mfma_f32_16x16x32_bf16 v[236:239], v[200:203], v[192:195], v[236:239]
    s_waitcnt lgkmcnt(0)
    v_rsq_f32 v140, v140
    v_mfma_f32_16x16x32_bf16 v[184:187], v[120:123], v[132:135], v[24:27]
    v_mul_f32 v140, s31, v140
    v_mul_f32 v208, v141, v208
    v_mfma_f32_16x16x32_bf16 v[184:187], v[228:231], v[180:183], v[184:187]
    v_mul_f32 v209, v141, v209
    v_cvt_pk_bf16_f32 v208, v208, v209
    v_mfma_f32_16x16x32_bf16 v[184:187], v[200:203], v[168:171], v[184:187]
    v_mov_b32_dpp v224, v237 quad_perm:[0,1,2,3] row_mask:0x1 bank_mask:0xf
    v_mul_f32 v210, v141, v210
    v_mfma_f32_16x16x32_bf16 v[240:243], v[176:179], a[168:171], 0
    v_mul_f32 v211, v141, v211
    v_cvt_pk_bf16_f32 v209, v210, v211
    v_mfma_f32_16x16x32_bf16 v[240:243], v[152:155], a[172:175], v[240:243]
    v_mul_f32 v164, v141, v164
    v_mul_f32 v165, v141, v165
    v_mfma_f32_16x16x32_bf16 v[240:243], v[216:219], a[176:179], v[240:243]
    v_cvt_pk_bf16_f32 v210, v164, v165
    v_mul_f32 v166, v141, v166
    v_mfma_f32_16x16x32_bf16 v[240:243], v[220:223], a[180:183], v[240:243]
    v_mul_f32 v167, v141, v167
    v_cvt_pk_bf16_f32 v211, v166, v167
    v_mfma_f32_16x16x32_bf16 v[240:243], v[124:127], a[184:187], v[240:243]
    v_mul_f32 v112, v141, v112
    v_mul_f32 v113, v141, v113
    v_mfma_f32_16x16x32_bf16 v[240:243], v[116:119], a[188:191], v[240:243]
    v_cvt_pk_bf16_f32 v166, v112, v113
    v_mul_f32 v114, v141, v114
    v_mfma_f32_16x16x32_bf16 v[244:247], v[176:179], a[192:195], 0
    ds_read_b128 v[176:179], v2 offset:0
    v_mul_f32 v115, v141, v115
    v_mfma_f32_16x16x32_bf16 v[244:247], v[152:155], a[196:199], v[244:247]
    ds_read_b128 v[152:155], v2 offset:1024
    buffer_store_dwordx4 v[160:163], v17, s[12:15], s27 offen
    v_cvt_pk_bf16_f32 v172, v240, v241
    v_cvt_pk_bf16_f32 v173, v242, v243
    v_cvt_pk_bf16_f32 v167, v114, v115
    v_mul_f32 v188, v140, v188
    v_mfma_f32_16x16x32_bf16 v[240:243], v[212:215], v[204:207], v[40:43]
    v_mul_f32 v189, v140, v189
    v_cvt_pk_bf16_f32 v112, v188, v189
    v_mfma_f32_16x16x32_bf16 v[248:251], v[180:183], v[204:207], v[44:47]
    v_mul_f32 v190, v140, v190
    v_mul_f32 v191, v140, v191
    v_mfma_f32_16x16x32_bf16 v[160:163], v[208:211], v[204:207], v[48:51]
    v_cvt_pk_bf16_f32 v113, v190, v191
    v_mul_f32 v136, v140, v136
    v_mfma_f32_16x16x16_bf16 v[240:243], v[194:195], v[192:193], v[240:243]
    v_mul_f32 v137, v140, v137
    v_cvt_pk_bf16_f32 v114, v136, v137
    v_mfma_f32_16x16x16_bf16 v[248:251], v[170:171], v[192:193], v[248:251]
    v_mul_f32 v138, v140, v138
    v_mul_f32 v139, v140, v139
    v_mfma_f32_16x16x16_bf16 v[160:163], v[166:167], v[192:193], v[160:163]
    s_waitcnt lgkmcnt(1)
    v_cvt_pk_bf16_f32 v115, v138, v139
    v_mul_f32 v148, v140, v148
    v_mfma_f32_16x16x32_bf16 v[244:247], v[216:219], a[200:203], v[244:247]
    s_waitcnt lgkmcnt(0)
    ds_read_b128 v[216:219], v2 offset:2048
    v_mul_f32 v149, v140, v149
    v_mfma_f32_16x16x32_bf16 v[244:247], v[220:223], a[204:207], v[244:247]
    ds_read_b128 v[204:207], v2 offset:3072
    v_cvt_pk_bf16_f32 v164, v148, v149
    v_mfma_f32_16x16x32_bf16 v[244:247], v[124:127], a[208:211], v[244:247]
    ds_read_b128 v[124:127], v2 offset:4096
    v_mul_f32 v150, v140, v150
    v_mfma_f32_16x16x32_bf16 v[244:247], v[116:119], a[212:215], v[244:247]
    ds_read_b128 v[116:119], v2 offset:5120
    v_mul_f32 v151, v140, v151
    v_mfma_f32_16x16x32_bf16 v[220:223], v[120:123], v[112:115], v[26:29]
    v_cvt_pk_bf16_f32 v165, v150, v151
    v_mov_b32_dpp v224, v185 quad_perm:[0,1,2,3] row_mask:0x2 bank_mask:0xf
    v_mfma_f32_16x16x32_bf16 v[220:223], v[228:231], v[208:211], v[220:223]
    v_cvt_pk_bf16_f32 v233, v234, v235
    v_xor_b32 v0, 65536, v0
    v_mfma_f32_16x16x32_bf16 v[220:223], v[200:203], v[164:167], v[220:223]
    v_cvt_pk_bf16_f32 v196, v244, v245
    v_cvt_pk_bf16_f32 v197, v246, v247
    v_mfma_f32_16x16x32_bf16 v[140:143], a[216:219], v[176:179], 0
    v_exp_f32 v184, v184
    v_mfma_f32_16x16x32_bf16 v[140:143], a[220:223], v[152:155], v[140:143]
    s_waitcnt lgkmcnt(3)
    v_exp_f32 v240, v240
    v_mfma_f32_16x16x32_bf16 v[140:143], a[224:227], v[216:219], v[140:143]
    s_waitcnt lgkmcnt(2)
    v_exp_f32 v220, v220
    v_mfma_f32_16x16x32_bf16 v[140:143], a[228:231], v[204:207], v[140:143]
    s_waitcnt lgkmcnt(1)
    buffer_store_dwordx2 v[232:233], v20, s[12:15], s27 offen
    v_mov_b32_dpp v224, v221 quad_perm:[0,1,2,3] row_mask:0x4 bank_mask:0xf
    v_xor_b32 v1, 65536, v1
    v_mfma_f32_16x16x32_bf16 v[140:143], a[232:235], v[124:127], v[140:143]
    s_waitcnt lgkmcnt(0)
    v_exp_f32 v224, v224
    v_mfma_f32_16x16x32_bf16 v[140:143], a[236:239], v[116:119], v[140:143]
    s_mov_b32 s27, s26
    v_cvt_pk_bf16_f32 v224, v224, v224
    v_add_u32 v5, 336, v5
    v_mfma_f32_16x16x32_bf16 v[188:191], a[240:243], v[176:179], 0
    s_mov_b32 s26, s25
    ds_write_b16 v8, v224
    v_mfma_f32_16x16x32_bf16 v[188:191], a[244:247], v[152:155], v[188:191]
    s_mov_b32 s25, s24
    v_exp_f32 v241, v241
    v_mfma_f32_16x16x32_bf16 v[188:191], a[248:251], v[216:219], v[188:191]
    s_mov_b32 s24, s23
    ds_read_b128 v[136:139], v2 offset:6144
    ds_read_b128 v[200:203], v2 offset:7168
    v_mfma_f32_16x16x32_bf16 v[188:191], a[252:255], v[204:207], v[188:191]
    ds_read_b128 v[232:235], v2 offset:8192
    ds_read_b128 v[228:231], v9
    v_mfma_f32_16x16x32_bf16 v[188:191], v[76:79], v[124:127], v[188:191]
    ds_read_b128 v[148:151], v2 offset:9216
    ds_read_b128 v[120:123], v9 offset:64
    v_mfma_f32_16x16x32_bf16 v[188:191], v[80:83], v[116:119], v[188:191]
    ds_read_b128 v[224:227], v2 offset:10240
    v_cvt_pk_bf16_f32 v240, v240, v241
    v_mfma_f32_16x16x32_bf16 v[244:247], v[84:87], v[176:179], 0
    ds_read_b128 v[176:179], v2 offset:11264
    v_fma_f32 v221, v140, v140, s33
    v_mfma_f32_16x16x32_bf16 v[244:247], v[88:91], v[152:155], v[244:247]
    v_exp_f32 v242, v242
    v_mfma_f32_16x16x32_bf16 v[244:247], v[92:95], v[216:219], v[244:247]
    v_exp_f32 v243, v243
    v_mfma_f32_16x16x32_bf16 v[244:247], v[96:99], v[204:207], v[244:247]
    v_cvt_pk_bf16_f32 v241, v242, v243
    v_fmac_f32 v221, v141, v141
    v_mfma_f32_16x16x32_bf16 v[244:247], v[100:103], v[124:127], v[244:247]
    s_waitcnt lgkmcnt(6)
    v_exp_f32 v248, v248
    v_mfma_f32_16x16x32_bf16 v[244:247], v[104:107], v[116:119], v[244:247]
    s_waitcnt lgkmcnt(4)
    v_exp_f32 v249, v249
    v_mfma_f32_16x16x32_bf16 v[204:207], v[228:231], v[28:31], 0
    s_waitcnt lgkmcnt(2)
    v_cvt_pk_bf16_f32 v242, v248, v249
    v_fmac_f32 v221, v142, v142
    v_mfma_f32_16x16x32_bf16 v[204:207], v[120:123], v[28:31], v[204:207]
    s_waitcnt lgkmcnt(1)
    v_exp_f32 v250, v250
    v_mfma_f32_16x16x32_bf16 v[152:155], v[228:231], v[128:131], 0
    s_waitcnt lgkmcnt(0)
    buffer_load_dwordx4 v14, s[8:11], s23 offen nt lds
    v_fmac_f32 v221, v143, v143
    v_mfma_f32_16x16x32_bf16 v[152:155], v[120:123], v[108:111], v[152:155]
    s_add_u32 s23, s23, s21
    v_rcp_f32 v204, v204
    v_mfma_f32_16x16x32_bf16 v[116:119], v[228:231], v[156:159], 0
    s_cmp_ge_u32 s19, 72
    v_exp_f32 v251, v251
    v_mfma_f32_16x16x32_bf16 v[116:119], v[120:123], v[172:175], v[116:119]
    s_cselect_b32 s34, 72, 0
    v_cvt_pk_bf16_f32 v243, v250, v251
    v_mul_f32 v152, v152, v204
    v_mfma_f32_16x16x32_bf16 v[124:127], v[228:231], v[144:147], 0
    s_cselect_b32 s35, s22, 0
    v_exp_f32 v160, v160
    v_mfma_f32_16x16x32_bf16 v[124:127], v[120:123], v[196:199], v[124:127]
    s_sub_u32 s19, s19, s34
    v_mul_f32_dpp v152, v116, v204 quad_perm:[0,1,2,3] row_mask:0x2 bank_mask:0xf
    v_fmac_f32 v221, v188, v188
    v_mfma_f32_16x16x32_bf16 v[116:119], a[216:219], v[136:139], 0
    s_add_u32 s23, s23, s35
    v_exp_f32 v161, v161
    v_mfma_f32_16x16x32_bf16 v[116:119], a[220:223], v[200:203], v[116:119]
    s_add_u32 s18, s18, 1
    v_mul_f32_dpp v152, v124, v204 quad_perm:[0,1,2,3] row_mask:0x4 bank_mask:0xf
    v_cvt_pk_bf16_f32 v152, v152, v152
    v_mfma_f32_16x16x32_bf16 v[116:119], a[224:227], v[232:235], v[116:119]
    s_cmp_lt_u32 s18, s17
    ds_write_b16 v7, v152
    v_mfma_f32_16x16x32_bf16 v[116:119], a[228:231], v[148:151], v[116:119]
    v_cvt_pk_bf16_f32 v36, v160, v161
    v_fmac_f32 v221, v189, v189
    v_mfma_f32_16x16x32_bf16 v[116:119], a[232:235], v[224:227], v[116:119]
    v_exp_f32 v162, v162
    v_mfma_f32_16x16x32_bf16 v[116:119], a[236:239], v[176:179], v[116:119]
    v_exp_f32 v163, v163
    v_mfma_f32_16x16x32_bf16 v[204:207], v[212:215], v[132:135], v[52:55]
    v_cvt_pk_bf16_f32 v37, v162, v163
    v_fmac_f32 v221, v190, v190
    v_mfma_f32_16x16x32_bf16 v[152:155], v[180:183], v[132:135], v[56:59]
    v_exp_f32 v236, v236
    v_mfma_f32_16x16x32_bf16 v[124:127], v[208:211], v[132:135], v[60:63]
    v_cvt_pk_bf16_f32 v38, v236, 0
    v_fma_f32 v222, v116, v116, s33
    v_mfma_f32_16x16x16_bf16 v[204:207], v[194:195], v[168:169], v[204:207]
    v_fmac_f32 v222, v117, v117
    v_fmac_f32 v222, v118, v118
    v_mfma_f32_16x16x16_bf16 v[152:155], v[170:171], v[168:169], v[152:155]
    v_fmac_f32 v222, v119, v119
    v_fmac_f32 v221, v191, v191
    v_mfma_f32_16x16x16_bf16 v[124:127], v[166:167], v[168:169], v[124:127]
    v_fmac_f32 v221, v244, v244
    v_fmac_f32 v221, v245, v245
    v_mfma_f32_16x16x32_bf16 v[216:219], v[28:31], v[36:39], 0
    v_exp_f32 v204, v204
    v_mfma_f32_16x16x32_bf16 v[216:219], v[28:31], v[240:243], v[216:219]
    v_exp_f32 v205, v205
    v_mfma_f32_16x16x32_bf16 v[132:135], v[108:111], v[36:39], 0
    v_cvt_pk_bf16_f32 v204, v204, v205
    v_fmac_f32 v221, v246, v246
    v_mfma_f32_16x16x32_bf16 v[132:135], v[128:131], v[240:243], v[132:135]
    v_exp_f32 v206, v206
    v_mfma_f32_16x16x32_bf16 v[160:163], v[172:175], v[36:39], 0
    v_exp_f32 v207, v207
    v_mfma_f32_16x16x32_bf16 v[160:163], v[156:159], v[240:243], v[160:163]
    v_rcp_f32 v216, v216
    v_mfma_f32_16x16x32_bf16 v[120:123], v[196:199], v[36:39], 0
    v_cvt_pk_bf16_f32 v205, v206, v207
    v_cvt_pk_bf16_f32 v38, v184, 0
    v_mfma_f32_16x16x32_bf16 v[120:123], v[144:147], v[240:243], v[120:123]
    v_mul_f32 v132, v216, v132
    v_mul_f32 v133, v216, v133
    v_mfma_f32_16x16x32_bf16 v[240:243], v[212:215], v[112:115], v[64:67]
    v_cvt_pk_bf16_f32 v192, v132, v133
    v_mul_f32 v134, v216, v134
    v_mfma_f32_16x16x32_bf16 v[212:215], v[180:183], v[112:115], v[68:71]
    v_mul_f32 v135, v216, v135
    v_cvt_pk_bf16_f32 v193, v134, v135
    v_mfma_f32_16x16x32_bf16 v[180:183], v[208:211], v[112:115], v[72:75]
    v_mul_f32 v160, v216, v160
    v_mul_f32 v161, v216, v161
    v_mfma_f32_16x16x16_bf16 v[240:243], v[194:195], v[164:165], v[240:243]
    v_cvt_pk_bf16_f32 v194, v160, v161
    v_mul_f32 v162, v216, v162
    v_mfma_f32_16x16x16_bf16 v[212:215], v[170:171], v[164:165], v[212:215]
    v_mul_f32 v163, v216, v163
    v_cvt_pk_bf16_f32 v195, v162, v163
    v_mfma_f32_16x16x16_bf16 v[180:183], v[166:167], v[164:165], v[180:183]
    ds_write_b128 v3, v[192:195] offset:0
    v_mfma_f32_16x16x32_bf16 v[208:211], a[240:243], v[136:139], 0
    v_exp_f32 v240, v240
    v_mfma_f32_16x16x32_bf16 v[208:211], a[244:247], v[200:203], v[208:211]
    v_exp_f32 v241, v241
    v_mfma_f32_16x16x32_bf16 v[208:211], a[248:251], v[232:235], v[208:211]
    ds_read_b128 v[164:167], v2 offset:12288
    ds_read_b128 v[132:135], v2 offset:13312
    v_mfma_f32_16x16x32_bf16 v[208:211], a[252:255], v[148:151], v[208:211]
    ds_read_b128 v[168:171], v2 offset:14336
    v_cvt_pk_bf16_f32 v160, v240, v241
    v_mfma_f32_16x16x32_bf16 v[208:211], v[76:79], v[224:227], v[208:211]
    ds_read_b128 v[192:195], v2 offset:15360
    v_mul_f32 v120, v216, v120
    v_mfma_f32_16x16x32_bf16 v[208:211], v[80:83], v[176:179], v[208:211]
    ds_read_b128 v[112:115], v2 offset:16384
    v_mul_f32 v121, v216, v121
    v_mfma_f32_16x16x32_bf16 v[228:231], v[84:87], v[136:139], 0
    ds_read_b128 v[136:139], v2 offset:17408
    v_cvt_pk_bf16_f32 v206, v120, v121
    v_mfma_f32_16x16x32_bf16 v[228:231], v[88:91], v[200:203], v[228:231]
    v_exp_f32 v242, v242
    v_mfma_f32_16x16x32_bf16 v[228:231], v[92:95], v[232:235], v[228:231]
    v_exp_f32 v243, v243
    v_mfma_f32_16x16x32_bf16 v[228:231], v[96:99], v[148:151], v[228:231]
    v_cvt_pk_bf16_f32 v161, v242, v243
    v_mul_f32 v122, v216, v122
    v_mfma_f32_16x16x32_bf16 v[228:231], v[100:103], v[224:227], v[228:231]
    s_waitcnt lgkmcnt(4)
    v_exp_f32 v212, v212
    v_mfma_f32_16x16x32_bf16 v[228:231], v[104:107], v[176:179], v[228:231]
    s_waitcnt lgkmcnt(3)
    v_exp_f32 v213, v213
    v_mfma_f32_16x16x32_bf16 v[148:151], a[216:219], v[164:167], 0
    s_waitcnt lgkmcnt(2)
    v_cvt_pk_bf16_f32 v162, v212, v213
    v_mul_f32 v123, v216, v123
    v_mfma_f32_16x16x32_bf16 v[148:151], a[220:223], v[132:135], v[148:151]
    s_waitcnt lgkmcnt(1)
    v_exp_f32 v214, v214
    v_mfma_f32_16x16x32_bf16 v[148:151], a[224:227], v[168:171], v[148:151]
    s_waitcnt lgkmcnt(0)
    v_exp_f32 v215, v215
    v_mfma_f32_16x16x32_bf16 v[148:151], a[228:231], v[192:195], v[148:151]
    v_cvt_pk_bf16_f32 v163, v214, v215
    v_cvt_pk_bf16_f32 v207, v122, v123
    v_mfma_f32_16x16x32_bf16 v[148:151], a[232:235], v[112:115], v[148:151]
    ds_write_b64 v4, v[206:207] offset:4096
    v_mfma_f32_16x16x32_bf16 v[148:151], a[236:239], v[136:139], v[148:151]
    v_exp_f32 v180, v180
    v_mfma_f32_16x16x32_bf16 v[200:203], a[240:243], v[164:167], 0
    ds_read_b128 v[212:215], v0 offset:20480
    ds_read_b128 v[176:179], v1 offset:20480
    v_mfma_f32_16x16x32_bf16 v[200:203], a[244:247], v[132:135], v[200:203]
    ds_read_b128 v[216:219], v0 offset:20608
    v_fmac_f32 v222, v208, v208
    v_mfma_f32_16x16x32_bf16 v[200:203], a[248:251], v[168:171], v[200:203]
    ds_read_b128 v[120:123], v1 offset:20608
    v_fmac_f32 v222, v209, v209
    v_mfma_f32_16x16x32_bf16 v[200:203], a[252:255], v[192:195], v[200:203]
    ds_read_b128 v[240:243], v0 offset:20736
    v_fmac_f32 v222, v210, v210
    v_mfma_f32_16x16x32_bf16 v[200:203], v[76:79], v[112:115], v[200:203]
    ds_read_b128 v[224:227], v1 offset:20736
    v_fmac_f32 v222, v211, v211
    v_mfma_f32_16x16x32_bf16 v[200:203], v[80:83], v[136:139], v[200:203]
    v_exp_f32 v181, v181
    v_mfma_f32_16x16x32_bf16 v[232:235], v[84:87], v[164:167], 0
    v_exp_f32 v182, v182
    v_mfma_f32_16x16x32_bf16 v[232:235], v[88:91], v[132:135], v[232:235]
    v_exp_f32 v183, v183
    v_mfma_f32_16x16x32_bf16 v[232:235], v[92:95], v[168:171], v[232:235]
    s_waitcnt lgkmcnt(4)
    v_exp_f32 v152, v152
    v_mfma_f32_16x16x32_bf16 v[232:235], v[96:99], v[192:195], v[232:235]
    s_waitcnt lgkmcnt(3)
    v_exp_f32 v153, v153
    v_mfma_f32_16x16x32_bf16 v[232:235], v[100:103], v[112:115], v[232:235]
    s_waitcnt lgkmcnt(2)
    v_cvt_pk_bf16_f32 v206, v152, v153
    v_fmac_f32 v222, v228, v228
    v_mfma_f32_16x16x32_bf16 v[232:235], v[104:107], v[136:139], v[232:235]
    s_waitcnt lgkmcnt(1)
    v_exp_f32 v154, v154
    v_mfma_f32_16x16x32_bf16 v[192:195], a[72:75], v[212:215], 0
    s_waitcnt lgkmcnt(0)
    v_exp_f32 v155, v155
    v_mfma_f32_16x16x32_bf16 v[192:195], a[76:79], v[176:179], v[192:195]
    v_cvt_pk_bf16_f32 v207, v154, v155
    v_fmac_f32 v222, v229, v229
    v_mfma_f32_16x16x32_bf16 v[192:195], a[80:83], v[216:219], v[192:195]
    v_exp_f32 v124, v124
    v_mfma_f32_16x16x32_bf16 v[192:195], a[84:87], v[120:123], v[192:195]
    v_exp_f32 v125, v125
    v_mfma_f32_16x16x32_bf16 v[192:195], a[88:91], v[240:243], v[192:195]
    v_cvt_pk_bf16_f32 v36, v124, v125
    v_fmac_f32 v222, v230, v230
    v_mfma_f32_16x16x32_bf16 v[192:195], a[92:95], v[224:227], v[192:195]
    v_exp_f32 v126, v126
    v_mfma_f32_16x16x32_bf16 v[152:155], a[96:99], v[212:215], 0
    v_exp_f32 v127, v127
    v_mfma_f32_16x16x32_bf16 v[152:155], a[100:103], v[176:179], v[152:155]
    v_cvt_pk_bf16_f32 v37, v126, v127
    v_fmac_f32 v222, v231, v231
    v_mfma_f32_16x16x32_bf16 v[152:155], a[104:107], v[216:219], v[152:155]
    v_fma_f32 v223, v148, v148, s33
    v_fmac_f32 v223, v149, v149
    v_mfma_f32_16x16x32_bf16 v[124:127], v[28:31], v[36:39], 0
    v_fmac_f32 v223, v150, v150
    v_fmac_f32 v223, v151, v151
    v_mfma_f32_16x16x32_bf16 v[124:127], v[28:31], v[204:207], v[124:127]
    v_fmac_f32 v223, v200, v200
    v_fmac_f32 v223, v201, v201
    v_mfma_f32_16x16x32_bf16 v[164:167], v[108:111], v[36:39], 0
    v_fmac_f32 v223, v202, v202
    v_fmac_f32 v223, v203, v203
    v_mfma_f32_16x16x32_bf16 v[164:167], v[128:131], v[204:207], v[164:167]
    v_fmac_f32 v223, v232, v232
    v_fmac_f32 v223, v233, v233
    v_mfma_f32_16x16x32_bf16 v[168:171], v[172:175], v[36:39], 0
    v_rcp_f32 v124, v124
    v_mfma_f32_16x16x32_bf16 v[168:171], v[156:159], v[204:207], v[168:171]
    v_fmac_f32 v223, v234, v234
    v_fmac_f32 v223, v235, v235
    v_mfma_f32_16x16x32_bf16 v[132:135], v[196:199], v[36:39], 0
    v_cvt_pk_bf16_f32 v36, v180, v181
    v_cvt_pk_bf16_f32 v37, v182, v183
    v_mfma_f32_16x16x32_bf16 v[132:135], v[144:147], v[204:207], v[132:135]
    v_cvt_pk_bf16_f32 v38, v220, 0
    v_mul_f32 v164, v124, v164
    v_mfma_f32_16x16x32_bf16 v[152:155], a[108:111], v[120:123], v[152:155]
    v_mul_f32 v165, v124, v165
    v_cvt_pk_bf16_f32 v204, v164, v165
    v_mfma_f32_16x16x32_bf16 v[180:183], v[28:31], v[36:39], 0
    v_mul_f32 v166, v124, v166
    v_mul_f32 v167, v124, v167
    v_mfma_f32_16x16x32_bf16 v[180:183], v[28:31], v[160:163], v[180:183]
    v_cvt_pk_bf16_f32 v205, v166, v167
    v_mul_f32 v168, v124, v168
    v_mfma_f32_16x16x32_bf16 v[164:167], v[108:111], v[36:39], 0
    v_mul_f32 v169, v124, v169
    v_cvt_pk_bf16_f32 v206, v168, v169
    v_mfma_f32_16x16x32_bf16 v[164:167], v[128:131], v[160:163], v[164:167]
    v_mul_f32 v170, v124, v170
    v_mul_f32 v171, v124, v171
    v_mfma_f32_16x16x32_bf16 v[128:131], v[172:175], v[36:39], 0
    v_cvt_pk_bf16_f32 v207, v170, v171
    v_mul_f32 v132, v124, v132
    v_mfma_f32_16x16x32_bf16 v[128:131], v[156:159], v[160:163], v[128:131]
    ds_write_b128 v3, v[204:207] offset:6144
    v_mfma_f32_16x16x32_bf16 v[156:159], v[196:199], v[36:39], 0
    v_mul_f32 v133, v124, v133
    v_cvt_pk_bf16_f32 v132, v132, v133
    v_mfma_f32_16x16x32_bf16 v[156:159], v[144:147], v[160:163], v[156:159]
    v_mul_f32 v134, v124, v134
    v_mul_f32 v135, v124, v135
    v_mfma_f32_16x16x32_bf16 v[152:155], a[112:115], v[240:243], v[152:155]
    v_cvt_pk_bf16_f32 v133, v134, v135
    v_cvt_pk_bf16_f32 v223, v223, v223
    v_mfma_f32_16x16x32_bf16 v[152:155], a[116:119], v[224:227], v[152:155]
    ds_write_b64 v4, v[132:133] offset:10240
    v_mfma_f32_16x16x32_bf16 v[144:147], a[120:123], v[212:215], 0
    v_rcp_f32 v180, v180
    v_mfma_f32_16x16x32_bf16 v[144:147], a[124:127], v[176:179], v[144:147]
    v_mul_f32 v164, v180, v164
    v_mul_f32 v165, v180, v165
    v_mfma_f32_16x16x32_bf16 v[144:147], a[128:131], v[216:219], v[144:147]
    v_cvt_pk_bf16_f32 v204, v164, v165
    v_mul_f32 v166, v180, v166
    v_mfma_f32_16x16x32_bf16 v[144:147], a[132:135], v[120:123], v[144:147]
    v_mul_f32 v167, v180, v167
    v_cvt_pk_bf16_f32 v205, v166, v167
    v_mfma_f32_16x16x32_bf16 v[144:147], a[136:139], v[240:243], v[144:147]
    v_mul_f32 v128, v180, v128
    v_mul_f32 v129, v180, v129
    v_mfma_f32_16x16x32_bf16 v[144:147], a[140:143], v[224:227], v[144:147]
    v_cvt_pk_bf16_f32 v206, v128, v129
    v_mul_f32 v130, v180, v130
    v_mfma_f32_16x16x32_bf16 v[124:127], a[0:3], v[212:215], 0
    v_mul_f32 v131, v180, v131
    v_cvt_pk_bf16_f32 v207, v130, v131
    v_mfma_f32_16x16x32_bf16 v[124:127], a[4:7], v[176:179], v[124:127]
    ds_write_b128 v3, v[204:207] offset:12288
    v_mfma_f32_16x16x32_bf16 v[124:127], a[8:11], v[216:219], v[124:127]
    v_mul_f32 v156, v180, v156
    v_mul_f32 v157, v180, v157
    v_mfma_f32_16x16x32_bf16 v[124:127], a[12:15], v[120:123], v[124:127]
    v_cvt_pk_bf16_f32 v156, v156, v157
    v_mul_f32 v158, v180, v158
    v_mfma_f32_16x16x32_bf16 v[124:127], a[16:19], v[240:243], v[124:127]
    v_mul_f32 v159, v180, v159
    v_cvt_pk_bf16_f32 v157, v158, v159
    v_mfma_f32_16x16x32_bf16 v[124:127], a[20:23], v[224:227], v[124:127]
    ds_write_b64 v4, v[156:157] offset:16384
    v_mfma_f32_16x16x32_bf16 v[180:183], a[24:27], v[212:215], 0
    v_fmac_f32 v221, v247, v247
    v_cvt_pk_bf16_f32 v222, v221, v222
    v_mfma_f32_16x16x32_bf16 v[180:183], a[28:31], v[176:179], v[180:183]
    ds_write_b64 v4, v[222:223] offset:18432
    v_mfma_f32_16x16x32_bf16 v[180:183], a[32:35], v[216:219], v[180:183]
    v_fma_f32 v108, v192, v192, s32
    v_fmac_f32 v108, v193, v193
    v_mfma_f32_16x16x32_bf16 v[180:183], a[36:39], v[120:123], v[180:183]
    v_fmac_f32 v108, v194, v194
    v_fmac_f32 v108, v195, v195
    v_mfma_f32_16x16x32_bf16 v[180:183], a[40:43], v[240:243], v[180:183]
    v_fmac_f32 v108, v152, v152
    v_fmac_f32 v108, v153, v153
    v_mfma_f32_16x16x32_bf16 v[180:183], a[44:47], v[224:227], v[180:183]
    v_fmac_f32 v108, v154, v154
    v_fmac_f32 v108, v155, v155
    v_mfma_f32_16x16x32_bf16 v[220:223], a[48:51], v[212:215], 0
    v_fmac_f32 v108, v144, v144
    v_fmac_f32 v108, v145, v145
    v_mfma_f32_16x16x32_bf16 v[220:223], a[52:55], v[176:179], v[220:223]
    v_fmac_f32 v108, v146, v146
    v_fmac_f32 v108, v147, v147
    v_mfma_f32_16x16x32_bf16 v[220:223], a[56:59], v[216:219], v[220:223]
    s_waitcnt lgkmcnt(0)
    v_fma_f32 v109, v124, v124, s32
    v_fmac_f32 v109, v125, v125
    v_mfma_f32_16x16x32_bf16 v[220:223], a[60:63], v[120:123], v[220:223]
    s_nop 0
    v_fmac_f32 v109, v126, v126
    v_fmac_f32 v109, v127, v127
    v_mfma_f32_16x16x32_bf16 v[220:223], a[64:67], v[240:243], v[220:223]
    s_nop 0
    v_fmac_f32 v109, v180, v180
    v_fmac_f32 v109, v181, v181
    v_mfma_f32_16x16x32_bf16 v[220:223], a[68:71], v[224:227], v[220:223]
    s_nop 0
    v_fmac_f32 v109, v182, v182
    v_fmac_f32 v109, v183, v183
    v_mfma_f32_16x16x32_bf16 v[128:131], v[212:215], a[144:147], 0
    s_barrier
    v_add_u32 v6, 272, v6
    v_add_u32 v7, 16, v7
    v_mfma_f32_16x16x32_bf16 v[128:131], v[176:179], a[148:151], v[128:131]
    v_fmac_f32 v109, v220, v220
    v_fmac_f32 v109, v221, v221
    v_mfma_f32_16x16x32_bf16 v[128:131], v[216:219], a[152:155], v[128:131]
    v_fmac_f32 v109, v222, v222
    v_fmac_f32 v109, v223, v223
    v_mfma_f32_16x16x32_bf16 v[128:131], v[120:123], a[156:159], v[128:131]
    v_cvt_pk_bf16_f32 v38, v109, v108
    v_xor_b32 v2, 65536, v2
    v_mfma_f32_16x16x32_bf16 v[128:131], v[240:243], a[160:163], v[128:131]
    v_xor_b32 v3, 65536, v3
    v_xor_b32 v4, 65536, v4
    v_mfma_f32_16x16x32_bf16 v[128:131], v[224:227], a[164:167], v[128:131]
    s_cbranch_scc1 L_loop_fast3
L_drain:
    ds_read_b128 v[108:111], v2 offset:18432
    ds_read_b128 v[112:115], v2 offset:19456
    ds_read_b128 v[120:123], v2 offset:0
    ds_read_b128 v[124:127], v2 offset:1024
    s_nop 2
    ds_read_b128 v[128:131], v2 offset:2048
    ds_read_b128 v[132:135], v2 offset:3072
    ds_read_b128 v[136:139], v2 offset:4096
    ds_read_b128 v[144:147], v2 offset:5120
    v_bfe_u32 v152, v2, 4, 6
    v_lshrrev_b32 v153, 4, v152
    v_and_b32 v152, 15, v152
    v_lshlrev_b32 v154, 9, v153
    v_lshl_add_u32 v154, v152, 4, v154
    v_add_u32 v154, 136704, v154
    v_mov_b32 v155, 0
    v_mov_b32 v157, 0
    v_mov_b32 v156, 0x40000000
    v_add_u32 v158, 0, v152
    v_mul_u32_u24 v159, s20, v158
    v_add_u32 v159, s38, v159
    v_mul_u32_u24 v159, 911, v159
    v_lshrrev_b32 v159, 16, v159
    v_mul_u32_u24 v159, s22, v159
    v_mad_u32_u24 v159, v158, s21, v159
    v_cmp_gt_u32 vcc, s17, v158
    v_add_u32 v158, s7, v159
    v_add_u32 v152, 16, v152
    v_cndmask_b32 v158, v156, v158, vcc
    s_waitcnt lgkmcnt(7)
    v_mfma_f32_16x16x32_bf16 v[160:163], v[32:35], v[108:111], 0
    s_waitcnt lgkmcnt(5)
    v_lshl_add_u32 v159, v153, 4, v158
    v_lshl_add_u32 v158, v153, 3, v158
    v_mfma_f32_16x16x32_bf16 v[160:163], v[32:35], v[112:115], v[160:163]
    s_cmp_ge_u32 s18, 2
    v_mul_u32_u24 v108, s20, v152
    v_add_u32 v108, s38, v108
    v_mfma_f32_16x16x32_bf16 v[112:115], a[216:219], v[120:123], 0
    s_waitcnt lgkmcnt(0)
    v_mul_u32_u24 v108, 911, v108
    v_lshrrev_b32 v108, 16, v108
    v_mfma_f32_16x16x32_bf16 v[112:115], a[220:223], v[124:127], v[112:115]
    s_cselect_b32 s14, s36, 0
    v_mul_f32 v160, 0x3baaaaab, v160
    v_mul_f32 v161, 0x3baaaaab, v161
    v_mfma_f32_16x16x32_bf16 v[112:115], a[224:227], v[128:131], v[112:115]
    s_lshl_b32 s3, s16, 6
    v_rsq_f32 v160, v160
    v_mfma_f32_16x16x32_bf16 v[112:115], a[228:231], v[132:135], v[112:115]
    s_lshl_b32 s4, s16, 5
    v_mul_f32 v140, v160, v140
    v_mul_f32 v141, v160, v141
    v_mfma_f32_16x16x32_bf16 v[112:115], a[232:235], v[136:139], v[112:115]
    s_add_u32 s4, s4, 256
    ds_read_b128 v[164:167], v2 offset:6144
    v_cvt_pk_bf16_f32 v140, v140, v141
    v_mfma_f32_16x16x32_bf16 v[112:115], a[236:239], v[144:147], v[112:115]
    ds_read_b128 v[168:171], v2 offset:7168
    v_mul_f32 v142, v160, v142
    v_mfma_f32_16x16x32_bf16 v[172:175], a[240:243], v[120:123], 0
    ds_read_b128 v[176:179], v2 offset:8192
    v_mul_f32 v143, v160, v143
    v_mfma_f32_16x16x32_bf16 v[172:175], a[244:247], v[124:127], v[172:175]
    ds_read_b128 v[180:183], v2 offset:9216
    v_cvt_pk_bf16_f32 v141, v142, v143
    v_mfma_f32_16x16x32_bf16 v[172:175], a[248:251], v[128:131], v[172:175]
    ds_read_b128 v[184:187], v2 offset:10240
    v_fma_f32 v163, v112, v112, s33
    v_mfma_f32_16x16x32_bf16 v[172:175], a[252:255], v[132:135], v[172:175]
    ds_read_b128 v[192:195], v2 offset:11264
    v_fmac_f32 v163, v113, v113
    v_mfma_f32_16x16x32_bf16 v[172:175], v[76:79], v[136:139], v[172:175]
    v_fmac_f32 v163, v114, v114
    v_fmac_f32 v163, v115, v115
    v_mfma_f32_16x16x32_bf16 v[172:175], v[80:83], v[144:147], v[172:175]
    v_mul_f32 v188, v160, v188
    v_mul_f32 v189, v160, v189
    v_mfma_f32_16x16x32_bf16 v[196:199], v[84:87], v[120:123], 0
    s_waitcnt lgkmcnt(5)
    v_cvt_pk_bf16_f32 v142, v188, v189
    v_mul_f32 v190, v160, v190
    v_mfma_f32_16x16x32_bf16 v[196:199], v[88:91], v[124:127], v[196:199]
    s_waitcnt lgkmcnt(4)
    v_fmac_f32 v163, v172, v172
    v_fmac_f32 v163, v173, v173
    v_mfma_f32_16x16x32_bf16 v[196:199], v[92:95], v[128:131], v[196:199]
    s_waitcnt lgkmcnt(3)
    v_fmac_f32 v163, v174, v174
    v_fmac_f32 v163, v175, v175
    v_mfma_f32_16x16x32_bf16 v[196:199], v[96:99], v[132:135], v[196:199]
    s_waitcnt lgkmcnt(2)
    v_mul_f32 v191, v160, v191
    v_cvt_pk_bf16_f32 v143, v190, v191
    v_mfma_f32_16x16x32_bf16 v[196:199], v[100:103], v[136:139], v[196:199]
    s_waitcnt lgkmcnt(1)
    buffer_store_dwordx4 v[140:143], v15, s[12:15], s27 offen
    v_mul_f32 v244, v160, v244
    v_mul_f32 v245, v160, v245
    v_cvt_pk_bf16_f32 v110, v244, v245
    v_mul_f32 v246, v160, v246
    v_mfma_f32_16x16x32_bf16 v[196:199], v[104:107], v[144:147], v[196:199]
    s_waitcnt lgkmcnt(0)
    v_mul_f32 v247, v160, v247
    v_cvt_pk_bf16_f32 v111, v246, v247
    v_mfma_f32_16x16x32_bf16 v[120:123], a[216:219], v[164:167], 0
    buffer_store_dwordx2 v[110:111], v18, s[12:15], s27 offen
    v_rsq_f32 v161, v161
    v_mfma_f32_16x16x32_bf16 v[120:123], a[220:223], v[168:171], v[120:123]
    v_mul_f32 v116, v161, v116
    v_fmac_f32 v163, v196, v196
    v_mfma_f32_16x16x32_bf16 v[120:123], a[224:227], v[176:179], v[120:123]
    v_fmac_f32 v163, v197, v197
    v_fmac_f32 v163, v198, v198
    v_mfma_f32_16x16x32_bf16 v[120:123], a[228:231], v[180:183], v[120:123]
    v_fmac_f32 v163, v199, v199
    v_mul_f32 v117, v161, v117
    v_mfma_f32_16x16x32_bf16 v[120:123], a[232:235], v[184:187], v[120:123]
    ds_read_b128 v[124:127], v2 offset:12288
    v_cvt_pk_bf16_f32 v116, v116, v117
    v_mfma_f32_16x16x32_bf16 v[120:123], a[236:239], v[192:195], v[120:123]
    ds_read_b128 v[128:131], v2 offset:13312
    v_mul_f32 v118, v161, v118
    v_mfma_f32_16x16x32_bf16 v[132:135], a[240:243], v[164:167], 0
    ds_read_b128 v[136:139], v2 offset:14336
    v_mul_f32 v119, v161, v119
    v_mfma_f32_16x16x32_bf16 v[132:135], a[244:247], v[168:171], v[132:135]
    ds_read_b128 v[140:143], v2 offset:15360
    v_cvt_pk_bf16_f32 v117, v118, v119
    v_mfma_f32_16x16x32_bf16 v[132:135], a[248:251], v[176:179], v[132:135]
    ds_read_b128 v[144:147], v2 offset:16384
    v_fma_f32 v160, v120, v120, s33
    v_mfma_f32_16x16x32_bf16 v[132:135], a[252:255], v[180:183], v[132:135]
    ds_read_b128 v[188:191], v2 offset:17408
    v_fmac_f32 v160, v121, v121
    v_mfma_f32_16x16x32_bf16 v[132:135], v[76:79], v[184:187], v[132:135]
    v_fmac_f32 v160, v122, v122
    v_fmac_f32 v160, v123, v123
    v_mfma_f32_16x16x32_bf16 v[132:135], v[80:83], v[192:195], v[132:135]
    v_xor_b32 v2, 65536, v2
    v_mul_f32 v208, v161, v208
    v_mfma_f32_16x16x32_bf16 v[204:207], v[84:87], v[164:167], 0
    s_waitcnt lgkmcnt(5)
    v_mul_f32 v209, v161, v209
    v_cvt_pk_bf16_f32 v118, v208, v209
    v_mfma_f32_16x16x32_bf16 v[204:207], v[88:91], v[168:171], v[204:207]
    s_waitcnt lgkmcnt(4)
    v_fmac_f32 v160, v132, v132
    v_fmac_f32 v160, v133, v133
    v_mfma_f32_16x16x32_bf16 v[204:207], v[92:95], v[176:179], v[204:207]
    s_waitcnt lgkmcnt(3)
    v_fmac_f32 v160, v134, v134
    v_fmac_f32 v160, v135, v135
    v_mfma_f32_16x16x32_bf16 v[204:207], v[96:99], v[180:183], v[204:207]
    s_waitcnt lgkmcnt(2)
    v_mul_f32 v210, v161, v210
    v_mul_f32 v211, v161, v211
    v_mfma_f32_16x16x32_bf16 v[204:207], v[100:103], v[184:187], v[204:207]
    s_waitcnt lgkmcnt(1)
    v_cvt_pk_bf16_f32 v119, v210, v211
    v_mul_f32 v228, v161, v228
    v_mfma_f32_16x16x32_bf16 v[204:207], v[104:107], v[192:195], v[204:207]
    s_waitcnt lgkmcnt(0)
    buffer_store_dwordx4 v[116:119], v16, s[12:15], s27 offen
    v_mul_f32 v229, v161, v229
    v_cvt_pk_bf16_f32 v110, v228, v229
    v_mul_f32 v230, v161, v230
    v_mul_f32 v231, v161, v231
    v_mfma_f32_16x16x32_bf16 v[116:119], a[216:219], v[124:127], 0
    v_cvt_pk_bf16_f32 v111, v230, v231
    v_fmac_f32 v160, v204, v204
    v_mfma_f32_16x16x32_bf16 v[116:119], a[220:223], v[128:131], v[116:119]
    buffer_store_dwordx2 v[110:111], v19, s[12:15], s27 offen
    v_fmac_f32 v160, v205, v205
    v_fmac_f32 v160, v206, v206
    v_mfma_f32_16x16x32_bf16 v[116:119], a[224:227], v[136:139], v[116:119]
    v_fmac_f32 v160, v207, v207
    v_cvt_pk_bf16_f32 v110, v163, v160
    v_mfma_f32_16x16x32_bf16 v[116:119], a[228:231], v[140:143], v[116:119]
    v_mul_f32 v109, 0x3baaaaab, v162
    v_add_u32 v159, s3, v159
    v_mfma_f32_16x16x32_bf16 v[116:119], a[232:235], v[144:147], v[116:119]
    s_lshl_b32 s3, s16, 6
    ds_read_b128 v[160:163], v154 offset:0
    v_add_u32 v158, s4, v158
    v_mfma_f32_16x16x32_bf16 v[116:119], a[236:239], v[188:191], v[116:119]
    s_lshl_b32 s4, s16, 5
    ds_read_b128 v[164:167], v154 offset:2048
    v_mul_u32_u24 v108, s22, v108
    v_mfma_f32_16x16x32_bf16 v[168:171], a[240:243], v[124:127], 0
    s_add_u32 s4, s4, 256
    ds_read_b128 v[176:179], v154 offset:4096
    v_mad_u32_u24 v108, v152, s21, v108
    v_mfma_f32_16x16x32_bf16 v[168:171], a[244:247], v[128:131], v[168:171]
    ds_read_b128 v[180:183], v154 offset:6144
    v_fma_f32 v111, v116, v116, s33
    v_mfma_f32_16x16x32_bf16 v[168:171], a[248:251], v[136:139], v[168:171]
    ds_read_b128 v[184:187], v154 offset:8192
    v_fmac_f32 v111, v117, v117
    v_mfma_f32_16x16x32_bf16 v[168:171], a[252:255], v[140:143], v[168:171]
    ds_read_b128 v[192:195], v154 offset:10240
    v_fmac_f32 v111, v118, v118
    v_mfma_f32_16x16x32_bf16 v[168:171], v[76:79], v[144:147], v[168:171]
    v_fmac_f32 v111, v119, v119
    v_cmp_gt_u32 vcc, s17, v152
    v_mfma_f32_16x16x32_bf16 v[168:171], v[80:83], v[188:191], v[168:171]
    v_rsq_f32 v109, v109
    v_mfma_f32_16x16x32_bf16 v[208:211], v[84:87], v[124:127], 0
    s_waitcnt lgkmcnt(5)
    v_mul_f32 v148, v109, v148
    v_mul_f32 v149, v109, v149
    v_mfma_f32_16x16x32_bf16 v[208:211], v[88:91], v[128:131], v[208:211]
    s_waitcnt lgkmcnt(4)
    v_cvt_pk_bf16_f32 v124, v148, v149
    v_fmac_f32 v111, v168, v168
    v_mfma_f32_16x16x32_bf16 v[208:211], v[92:95], v[136:139], v[208:211]
    s_waitcnt lgkmcnt(3)
    v_fmac_f32 v111, v169, v169
    v_fmac_f32 v111, v170, v170
    v_mfma_f32_16x16x32_bf16 v[208:211], v[96:99], v[140:143], v[208:211]
    s_waitcnt lgkmcnt(2)
    v_fmac_f32 v111, v171, v171
    v_mul_f32 v150, v109, v150
    v_mfma_f32_16x16x32_bf16 v[208:211], v[100:103], v[144:147], v[208:211]
    s_waitcnt lgkmcnt(1)
    v_mul_f32 v151, v109, v151
    v_cvt_pk_bf16_f32 v125, v150, v151
    v_mfma_f32_16x16x32_bf16 v[208:211], v[104:107], v[188:191], v[208:211]
    s_waitcnt lgkmcnt(0)
    v_mul_f32 v200, v109, v200
    v_mul_f32 v201, v109, v201
    v_mfma_f32_16x16x32_bf16 v[128:131], a[216:219], v[160:163], 0
    v_cvt_pk_bf16_f32 v126, v200, v201
    v_mul_f32 v202, v109, v202
    v_mfma_f32_16x16x32_bf16 v[128:131], a[220:223], v[164:167], v[128:131]
    v_mul_f32 v203, v109, v203
    v_fmac_f32 v111, v208, v208
    v_mfma_f32_16x16x32_bf16 v[128:131], a[224:227], v[176:179], v[128:131]
    v_fmac_f32 v111, v209, v209
    v_fmac_f32 v111, v210, v210
    v_mfma_f32_16x16x32_bf16 v[128:131], a[228:231], v[180:183], v[128:131]
    v_fmac_f32 v111, v211, v211
    v_cvt_pk_bf16_f32 v111, v111, v111
    v_mfma_f32_16x16x32_bf16 v[128:131], a[232:235], v[184:187], v[128:131]
    ds_read_b128 v[136:139], v154 offset:256
    v_cvt_pk_bf16_f32 v127, v202, v203
    v_mfma_f32_16x16x32_bf16 v[128:131], a[236:239], v[192:195], v[128:131]
    ds_read_b128 v[140:143], v154 offset:2304
    buffer_store_dwordx4 v[124:127], v17, s[12:15], s27 offen
    ds_write_b64 v4, v[110:111] offset:18432
    v_mul_f32 v232, v109, v232
    v_mfma_f32_16x16x32_bf16 v[144:147], a[240:243], v[160:163], 0
    v_mul_f32 v233, v109, v233
    v_cvt_pk_bf16_f32 v232, v232, v233
    v_mfma_f32_16x16x32_bf16 v[144:147], a[244:247], v[164:167], v[144:147]
    ds_read_b128 v[124:127], v154 offset:4352
    ds_read_b128 v[148:151], v154 offset:6400
    v_mfma_f32_16x16x32_bf16 v[144:147], a[248:251], v[176:179], v[144:147]
    ds_read_b128 v[188:191], v154 offset:8448
    v_fma_f32 v152, v128, v128, s33
    v_mfma_f32_16x16x32_bf16 v[144:147], a[252:255], v[180:183], v[144:147]
    ds_read_b128 v[200:203], v154 offset:10496
    v_fmac_f32 v152, v129, v129
    v_mfma_f32_16x16x32_bf16 v[144:147], v[76:79], v[184:187], v[144:147]
    v_fmac_f32 v152, v130, v130
    v_fmac_f32 v152, v131, v131
    v_mfma_f32_16x16x32_bf16 v[144:147], v[80:83], v[192:195], v[144:147]
    s_waitcnt lgkmcnt(6)
    v_mul_f32 v234, v109, v234
    v_mul_f32 v235, v109, v235
    v_mfma_f32_16x16x32_bf16 v[212:215], v[84:87], v[160:163], 0
    s_waitcnt lgkmcnt(4)
    v_cvt_pk_bf16_f32 v233, v234, v235
    v_add_u32 v154, s7, v108
    v_mfma_f32_16x16x32_bf16 v[212:215], v[88:91], v[164:167], v[212:215]
    buffer_store_dwordx2 v[232:233], v20, s[12:15], s27 offen
    v_fmac_f32 v152, v144, v144
    v_fmac_f32 v152, v145, v145
    v_mfma_f32_16x16x32_bf16 v[212:215], v[92:95], v[176:179], v[212:215]
    s_mov_b32 s14, s36
    v_fmac_f32 v152, v146, v146
    v_fmac_f32 v152, v147, v147
    v_mfma_f32_16x16x32_bf16 v[212:215], v[96:99], v[180:183], v[212:215]
    s_waitcnt lgkmcnt(1)
    v_cndmask_b32 v154, v156, v154, vcc
    v_lshl_add_u32 v108, v153, 4, v154
    v_mfma_f32_16x16x32_bf16 v[212:215], v[100:103], v[184:187], v[212:215]
    s_waitcnt lgkmcnt(0)
    v_add_u32 v108, s3, v108
    v_lshl_add_u32 v109, v153, 3, v154
    v_mfma_f32_16x16x32_bf16 v[212:215], v[104:107], v[192:195], v[212:215]
    v_add_u32 v109, s4, v109
    v_mfma_f32_16x16x32_bf16 v[160:163], a[216:219], v[136:139], 0
    v_mfma_f32_16x16x32_bf16 v[160:163], a[220:223], v[140:143], v[160:163]
    v_mfma_f32_16x16x32_bf16 v[160:163], a[224:227], v[124:127], v[160:163]
    v_mfma_f32_16x16x32_bf16 v[160:163], a[228:231], v[148:151], v[160:163]
    v_mfma_f32_16x16x32_bf16 v[160:163], a[232:235], v[188:191], v[160:163]
    v_mfma_f32_16x16x32_bf16 v[160:163], a[236:239], v[200:203], v[160:163]
    v_mfma_f32_16x16x32_bf16 v[164:167], a[240:243], v[136:139], 0
    v_fmac_f32 v152, v212, v212
    v_fmac_f32 v152, v213, v213
    v_mfma_f32_16x16x32_bf16 v[164:167], a[244:247], v[140:143], v[164:167]
    v_fmac_f32 v152, v214, v214
    v_fmac_f32 v152, v215, v215
    v_mfma_f32_16x16x32_bf16 v[164:167], a[248:251], v[124:127], v[164:167]
    v_cvt_pk_bf16_f32 v154, v152, v152
    v_fma_f32 v156, v160, v160, s33
    v_mfma_f32_16x16x32_bf16 v[164:167], a[252:255], v[148:151], v[164:167]
    ds_write_b64 v4, v[154:155] offset:0
    v_mfma_f32_16x16x32_bf16 v[164:167], v[76:79], v[188:191], v[164:167]
    v_fmac_f32 v156, v161, v161
    v_fmac_f32 v156, v162, v162
    v_mfma_f32_16x16x32_bf16 v[164:167], v[80:83], v[200:203], v[164:167]
    v_fmac_f32 v156, v163, v163
    v_mfma_f32_16x16x32_bf16 v[152:155], v[84:87], v[136:139], 0
    v_mfma_f32_16x16x32_bf16 v[152:155], v[88:91], v[140:143], v[152:155]
    v_mfma_f32_16x16x32_bf16 v[152:155], v[92:95], v[124:127], v[152:155]
    v_mfma_f32_16x16x32_bf16 v[152:155], v[96:99], v[148:151], v[152:155]
    v_mfma_f32_16x16x32_bf16 v[152:155], v[100:103], v[188:191], v[152:155]
    v_mfma_f32_16x16x32_bf16 v[152:155], v[104:107], v[200:203], v[152:155]
    s_nop 0
    v_fmac_f32 v156, v164, v164
    v_fmac_f32 v156, v165, v165
    v_fmac_f32 v156, v166, v166
    v_fmac_f32 v156, v167, v167
    s_nop 0
    s_nop 0
    s_nop 0
    v_fmac_f32 v156, v152, v152
    v_fmac_f32 v156, v153, v153
    v_fmac_f32 v156, v154, v154
    v_fmac_f32 v156, v155, v155
    v_cvt_pk_bf16_f32 v156, v156, v156
    ds_write_b64 v4, v[156:157] offset:2048
    s_waitcnt lgkmcnt(0)
    s_barrier
    ds_read_b128 v[124:127], v2 offset:18432
    ds_read_b128 v[136:139], v2 offset:19456
    ds_read_b128 v[140:143], v2 offset:0
    ds_read_b128 v[148:151], v2 offset:1024
    ds_read_b128 v[176:179], v2 offset:2048
    ds_read_b128 v[180:183], v2 offset:3072
    s_waitcnt lgkmcnt(5)
    v_mfma_f32_16x16x32_bf16 v[184:187], v[32:35], v[124:127], 0
    s_waitcnt lgkmcnt(4)
    v_mfma_f32_16x16x32_bf16 v[184:187], v[32:35], v[136:139], v[184:187]
    s_waitcnt lgkmcnt(0)
    v_mfma_f32_16x16x32_bf16 v[124:127], v[32:35], v[140:143], 0
    v_mfma_f32_16x16x32_bf16 v[124:127], v[32:35], v[148:151], v[124:127]
    v_mfma_f32_16x16x32_bf16 v[136:139], v[32:35], v[176:179], 0
    v_mfma_f32_16x16x32_bf16 v[136:139], v[32:35], v[180:183], v[136:139]
    s_nop 0
    s_nop 0
    s_nop 0
    v_mul_f32 v110, 0x3baaaaab, v184
    v_rsq_f32 v110, v110
    v_mul_f32 v111, 0x3baaaaab, v185
    v_mul_f32 v112, v110, v112
    v_mul_f32 v113, v110, v113
    v_cvt_pk_bf16_f32 v112, v112, v113
    v_mul_f32 v114, v110, v114
    v_mul_f32 v115, v110, v115
    v_cvt_pk_bf16_f32 v113, v114, v115
    v_mul_f32 v172, v110, v172
    v_mul_f32 v173, v110, v173
    v_cvt_pk_bf16_f32 v114, v172, v173
    v_mul_f32 v174, v110, v174
    v_mul_f32 v175, v110, v175
    v_cvt_pk_bf16_f32 v115, v174, v175
    v_mul_f32 v196, v110, v196
    v_mul_f32 v197, v110, v197
    v_cvt_pk_bf16_f32 v156, v196, v197
    v_mul_f32 v198, v110, v198
    v_mul_f32 v199, v110, v199
    v_cvt_pk_bf16_f32 v157, v198, v199
    v_rsq_f32 v111, v111
    v_mul_f32 v110, 0x3baaaaab, v186
    v_mul_f32 v120, v111, v120
    v_mul_f32 v121, v111, v121
    v_cvt_pk_bf16_f32 v120, v120, v121
    v_mul_f32 v122, v111, v122
    v_mul_f32 v123, v111, v123
    v_cvt_pk_bf16_f32 v121, v122, v123
    v_mul_f32 v132, v111, v132
    v_mul_f32 v133, v111, v133
    v_cvt_pk_bf16_f32 v122, v132, v133
    v_mul_f32 v134, v111, v134
    v_mul_f32 v135, v111, v135
    v_cvt_pk_bf16_f32 v123, v134, v135
    v_mul_f32 v204, v111, v204
    v_mul_f32 v205, v111, v205
    v_cvt_pk_bf16_f32 v138, v204, v205
    v_mul_f32 v206, v111, v206
    v_mul_f32 v207, v111, v207
    v_cvt_pk_bf16_f32 v139, v206, v207
    v_rsq_f32 v110, v110
    v_mul_f32 v137, 0x3baaaaab, v124
    v_mul_f32 v116, v110, v116
    v_mul_f32 v117, v110, v117
    v_cvt_pk_bf16_f32 v116, v116, v117
    v_mul_f32 v118, v110, v118
    v_mul_f32 v119, v110, v119
    v_cvt_pk_bf16_f32 v117, v118, v119
    v_mul_f32 v168, v110, v168
    v_mul_f32 v169, v110, v169
    v_cvt_pk_bf16_f32 v118, v168, v169
    v_mul_f32 v170, v110, v170
    v_mul_f32 v171, v110, v171
    v_cvt_pk_bf16_f32 v119, v170, v171
    v_mul_f32 v208, v110, v208
    v_mul_f32 v209, v110, v209
    v_cvt_pk_bf16_f32 v208, v208, v209
    v_mul_f32 v210, v110, v210
    v_mul_f32 v211, v110, v211
    v_cvt_pk_bf16_f32 v209, v210, v211
    v_rsq_f32 v137, v137
    v_mul_f32 v136, 0x3baaaaab, v136
    v_mul_f32 v128, v137, v128
    v_mul_f32 v129, v137, v129
    v_cvt_pk_bf16_f32 v124, v128, v129
    v_mul_f32 v130, v137, v130
    v_mul_f32 v131, v137, v131
    v_cvt_pk_bf16_f32 v125, v130, v131
    v_mul_f32 v144, v137, v144
    v_mul_f32 v145, v137, v145
    v_cvt_pk_bf16_f32 v126, v144, v145
    v_mul_f32 v146, v137, v146
    v_mul_f32 v147, v137, v147
    v_cvt_pk_bf16_f32 v127, v146, v147
    v_mul_f32 v212, v137, v212
    v_mul_f32 v213, v137, v213
    v_cvt_pk_bf16_f32 v110, v212, v213
    v_mul_f32 v214, v137, v214
    v_mul_f32 v215, v137, v215
    v_cvt_pk_bf16_f32 v111, v214, v215
    v_rsq_f32 v136, v136
    s_nop 0
    v_mul_f32 v160, v136, v160
    v_mul_f32 v161, v136, v161
    v_cvt_pk_bf16_f32 v128, v160, v161
    v_mul_f32 v162, v136, v162
    v_mul_f32 v163, v136, v163
    v_cvt_pk_bf16_f32 v129, v162, v163
    v_mul_f32 v164, v136, v164
    v_mul_f32 v165, v136, v165
    v_cvt_pk_bf16_f32 v130, v164, v165
    v_mul_f32 v166, v136, v166
    v_mul_f32 v167, v136, v167
    v_cvt_pk_bf16_f32 v131, v166, v167
    v_mul_f32 v152, v136, v152
    v_mul_f32 v153, v136, v153
    v_cvt_pk_bf16_f32 v210, v152, v153
    v_mul_f32 v154, v136, v154
    v_mul_f32 v155, v136, v155
    v_cvt_pk_bf16_f32 v211, v154, v155
    buffer_store_dwordx4 v[112:115], v15, s[12:15], s26 offen
    buffer_store_dwordx2 v[156:157], v18, s[12:15], s26 offen
    buffer_store_dwordx4 v[120:123], v16, s[12:15], s26 offen
    buffer_store_dwordx2 v[138:139], v19, s[12:15], s26 offen
    buffer_store_dwordx4 v[116:119], v17, s[12:15], s26 offen
    buffer_store_dwordx2 v[208:209], v20, s[12:15], s26 offen
    buffer_store_dwordx4 v[124:127], v159, s[12:15], 0 offen
    buffer_store_dwordx2 v[110:111], v158, s[12:15], 0 offen
    buffer_store_dwordx4 v[128:131], v108, s[12:15], 0 offen
    buffer_store_dwordx2 v[210:211], v109, s[12:15], 0 offen
L_done:
    s_endpgm
L_safe:
    s_cmp_eq_u32 s16, 1
    s_cbranch_scc1 L_loop_safe1
    s_cmp_eq_u32 s16, 2
    s_cbranch_scc1 L_loop_safe2
    s_cmp_eq_u32 s16, 3
    s_cbranch_scc1 L_loop_safe3
    s_branch L_loop_safe0
.p2align 6
L_loop_safe0:
    v_mfma_f32_16x16x16_bf16 v[160:163], v[32:33], v[38:39], 0
    s_cmp_ge_u32 s18, 2
    ds_read_b128 v[172:175], v2 offset:18432
    ds_read_b128 v[196:199], v2 offset:19456
    v_mfma_f32_16x16x32_bf16 v[108:111], v[212:215], a[168:171], 0
    s_cselect_b32 s14, s36, 0
    s_add_u32 s34, s18, 2
    v_cvt_pk_bf16_f32 v128, v128, v129
    v_mfma_f32_16x16x32_bf16 v[108:111], v[176:179], a[172:175], v[108:111]
    s_cmp_lt_u32 s34, s17
    v_rsq_f32 v161, v161
    v_mfma_f32_16x16x32_bf16 v[108:111], v[216:219], a[176:179], v[108:111]
    s_cselect_b32 s10, s36, 0
    v_rsq_f32 v160, v160
    v_mfma_f32_16x16x32_bf16 v[108:111], v[120:123], a[180:183], v[108:111]
    s_add_u32 m0, s28, 0
    ds_read_b128 v[112:115], v0 offset:26624
    v_mul_f32 v160, s31, v160
    v_mfma_f32_16x16x32_bf16 v[108:111], v[240:243], a[184:187], v[108:111]
    ds_read_b128 v[132:135], v1 offset:26624
    v_cvt_pk_bf16_f32 v129, v130, v131
    v_mfma_f32_16x16x32_bf16 v[108:111], v[224:227], a[188:191], v[108:111]
    ds_read_b128 v[136:139], v0 offset:26752
    v_mul_f32 v192, v161, v192
    v_mfma_f32_16x16x32_bf16 v[164:167], v[212:215], a[192:195], 0
    ds_read_b128 v[212:215], v1 offset:26752
    v_mul_f32 v193, v161, v193
    v_mfma_f32_16x16x32_bf16 v[164:167], v[176:179], a[196:199], v[164:167]
    s_waitcnt lgkmcnt(4)
    ds_read_b128 v[156:159], v0 offset:26880
    v_cvt_pk_bf16_f32 v108, v108, v109
    v_mfma_f32_16x16x32_bf16 v[168:171], v[32:35], v[172:175], 0
    v_cvt_pk_bf16_f32 v109, v110, v111
    v_cvt_pk_bf16_f32 v176, v192, v193
    v_mfma_f32_16x16x32_bf16 v[168:171], v[32:35], v[196:199], v[168:171]
    v_mul_f32 v194, v161, v194
    v_mul_f32 v195, v161, v195
    v_mfma_f32_16x16x32_bf16 v[164:167], v[216:219], a[200:203], v[164:167]
    ds_read_b128 v[216:219], v1 offset:26880
    v_cvt_pk_bf16_f32 v177, v194, v195
    v_mfma_f32_16x16x32_bf16 v[164:167], v[120:123], a[204:207], v[164:167]
    s_waitcnt lgkmcnt(5)
    v_mul_f32 v152, v161, v152
    v_mul_f32 v110, 0x3baaaaab, v168
    v_mfma_f32_16x16x32_bf16 v[164:167], v[240:243], a[208:211], v[164:167]
    s_waitcnt lgkmcnt(4)
    v_rsq_f32 v110, v110
    v_mfma_f32_16x16x32_bf16 v[164:167], v[224:227], a[212:215], v[164:167]
    s_waitcnt lgkmcnt(3)
    v_mul_f32 v162, 0x3baaaaab, v169
    v_mul_f32 v163, 0x3baaaaab, v170
    v_mfma_f32_16x16x32_bf16 v[224:227], a[72:75], v[112:115], 0
    s_waitcnt lgkmcnt(2)
    v_rsq_f32 v162, v162
    v_mfma_f32_16x16x32_bf16 v[224:227], a[76:79], v[132:135], v[224:227]
    s_waitcnt lgkmcnt(1)
    v_cvt_pk_bf16_f32 v192, v164, v165
    v_cvt_pk_bf16_f32 v193, v166, v167
    v_mfma_f32_16x16x32_bf16 v[224:227], a[80:83], v[136:139], v[224:227]
    v_rsq_f32 v163, v163
    v_mfma_f32_16x16x32_bf16 v[224:227], a[84:87], v[212:215], v[224:227]
    v_mul_f32 v140, v110, v140
    v_mul_f32 v141, v110, v141
    v_mfma_f32_16x16x32_bf16 v[224:227], a[88:91], v[156:159], v[224:227]
    s_waitcnt lgkmcnt(0)
    v_cvt_pk_bf16_f32 v140, v140, v141
    v_mul_f32 v142, v110, v142
    v_mfma_f32_16x16x32_bf16 v[224:227], a[92:95], v[216:219], v[224:227]
    v_mul_f32 v143, v110, v143
    v_cvt_pk_bf16_f32 v141, v142, v143
    v_mfma_f32_16x16x32_bf16 v[240:243], a[96:99], v[112:115], 0
    v_mul_f32 v188, v110, v188
    v_mul_f32 v189, v110, v189
    v_mfma_f32_16x16x32_bf16 v[240:243], a[100:103], v[132:135], v[240:243]
    v_cvt_pk_bf16_f32 v142, v188, v189
    v_mul_f32 v190, v110, v190
    v_mfma_f32_16x16x32_bf16 v[240:243], a[104:107], v[136:139], v[240:243]
    v_mul_f32 v191, v110, v191
    v_cvt_pk_bf16_f32 v143, v190, v191
    v_mfma_f32_16x16x32_bf16 v[240:243], a[108:111], v[212:215], v[240:243]
    buffer_store_dwordx4 v[140:143], v15, s[12:15], s27 offen
    v_mul_f32 v244, v110, v244
    v_mul_f32 v245, v110, v245
    v_cvt_pk_bf16_f32 v130, v244, v245
    v_mul_f32 v246, v110, v246
    v_mfma_f32_16x16x32_bf16 v[240:243], a[112:115], v[156:159], v[240:243]
    v_mul_f32 v247, v110, v247
    v_cvt_pk_bf16_f32 v131, v246, v247
    v_mfma_f32_16x16x32_bf16 v[240:243], a[116:119], v[216:219], v[240:243]
    v_mul_f32 v153, v161, v153
    v_cvt_pk_bf16_f32 v178, v152, v153
    v_mfma_f32_16x16x32_bf16 v[140:143], a[120:123], v[112:115], 0
    v_mul_f32 v154, v161, v154
    v_mul_f32 v155, v161, v155
    v_mfma_f32_16x16x32_bf16 v[140:143], a[124:127], v[132:135], v[140:143]
    v_cvt_pk_bf16_f32 v179, v154, v155
    v_mul_f32 v144, v161, v144
    v_mfma_f32_16x16x32_bf16 v[140:143], a[128:131], v[136:139], v[140:143]
    v_mul_f32 v145, v161, v145
    v_cvt_pk_bf16_f32 v154, v144, v145
    v_mfma_f32_16x16x32_bf16 v[140:143], a[132:135], v[212:215], v[140:143]
    v_mul_f32 v146, v161, v146
    v_mul_f32 v147, v161, v147
    v_mfma_f32_16x16x32_bf16 v[140:143], a[136:139], v[156:159], v[140:143]
    v_cvt_pk_bf16_f32 v155, v146, v147
    v_mul_f32 v124, v160, v124
    v_mfma_f32_16x16x32_bf16 v[140:143], a[140:143], v[216:219], v[140:143]
    v_mul_f32 v125, v160, v125
    v_cvt_pk_bf16_f32 v188, v124, v125
    v_mfma_f32_16x16x32_bf16 v[244:247], a[0:3], v[112:115], 0
    v_mul_f32 v126, v160, v126
    v_mul_f32 v127, v160, v127
    v_mfma_f32_16x16x32_bf16 v[244:247], a[4:7], v[132:135], v[244:247]
    v_cvt_pk_bf16_f32 v189, v126, v127
    v_mul_f32 v180, v160, v180
    v_mfma_f32_16x16x32_bf16 v[244:247], a[8:11], v[136:139], v[244:247]
    v_mul_f32 v181, v160, v181
    v_cvt_pk_bf16_f32 v190, v180, v181
    v_mfma_f32_16x16x32_bf16 v[244:247], a[12:15], v[212:215], v[244:247]
    v_mul_f32 v182, v160, v182
    v_mul_f32 v183, v160, v183
    v_mfma_f32_16x16x32_bf16 v[244:247], a[16:19], v[156:159], v[244:247]
    v_cvt_pk_bf16_f32 v191, v182, v183
    v_mul_f32 v220, v160, v220
    v_mfma_f32_16x16x32_bf16 v[244:247], a[20:23], v[216:219], v[244:247]
    v_mul_f32 v221, v160, v221
    v_cvt_pk_bf16_f32 v152, v220, v221
    v_mfma_f32_16x16x32_bf16 v[120:123], a[24:27], v[112:115], 0
    v_mul_f32 v222, v160, v222
    v_mul_f32 v223, v160, v223
    v_mfma_f32_16x16x32_bf16 v[120:123], a[28:31], v[132:135], v[120:123]
    v_cvt_pk_bf16_f32 v153, v222, v223
    v_fma_f32 v110, v224, v224, s32
    v_mfma_f32_16x16x32_bf16 v[120:123], a[32:35], v[136:139], v[120:123]
    buffer_store_dwordx2 v[130:131], v18, s[12:15], s27 offen
    v_fma_f32 v111, v244, v244, s32
    v_fmac_f32 v111, v245, v245
    v_mfma_f32_16x16x32_bf16 v[120:123], a[36:39], v[212:215], v[120:123]
    v_fmac_f32 v111, v246, v246
    v_fmac_f32 v111, v247, v247
    v_mfma_f32_16x16x32_bf16 v[120:123], a[40:43], v[156:159], v[120:123]
    v_fmac_f32 v110, v225, v225
    v_fmac_f32 v110, v226, v226
    v_mfma_f32_16x16x32_bf16 v[120:123], a[44:47], v[216:219], v[120:123]
    v_fmac_f32 v110, v227, v227
    v_fmac_f32 v110, v240, v240
    v_mfma_f32_16x16x32_bf16 v[144:147], a[48:51], v[112:115], 0
    v_fmac_f32 v110, v241, v241
    v_fmac_f32 v110, v242, v242
    v_mfma_f32_16x16x32_bf16 v[144:147], a[52:55], v[132:135], v[144:147]
    v_fmac_f32 v110, v243, v243
    v_fmac_f32 v110, v140, v140
    v_mfma_f32_16x16x32_bf16 v[144:147], a[56:59], v[136:139], v[144:147]
    v_fmac_f32 v111, v120, v120
    v_fmac_f32 v111, v121, v121
    v_mfma_f32_16x16x32_bf16 v[144:147], a[60:63], v[212:215], v[144:147]
    v_fmac_f32 v111, v122, v122
    v_fmac_f32 v111, v123, v123
    v_mfma_f32_16x16x32_bf16 v[144:147], a[64:67], v[156:159], v[144:147]
    v_fmac_f32 v110, v141, v141
    v_fmac_f32 v110, v142, v142
    v_mfma_f32_16x16x32_bf16 v[144:147], a[68:71], v[216:219], v[144:147]
    v_fmac_f32 v110, v143, v143
    v_mul_f32 v148, v163, v148
    v_mfma_f32_16x16x32_bf16 v[124:127], v[112:115], a[144:147], 0
    v_mul_f32 v149, v163, v149
    v_cvt_pk_bf16_f32 v148, v148, v149
    v_mfma_f32_16x16x32_bf16 v[124:127], v[132:135], a[148:151], v[124:127]
    v_mul_f32 v150, v163, v150
    v_mul_f32 v151, v163, v151
    v_mfma_f32_16x16x32_bf16 v[124:127], v[136:139], a[152:155], v[124:127]
    v_fmac_f32 v111, v144, v144
    v_fmac_f32 v111, v145, v145
    v_mfma_f32_16x16x32_bf16 v[124:127], v[212:215], a[156:159], v[124:127]
    v_fmac_f32 v111, v146, v146
    v_fmac_f32 v111, v147, v147
    v_mfma_f32_16x16x32_bf16 v[124:127], v[156:159], a[160:163], v[124:127]
    v_cvt_pk_bf16_f32 v38, v111, v110
    v_cvt_pk_bf16_f32 v149, v150, v151
    v_mfma_f32_16x16x32_bf16 v[124:127], v[216:219], a[164:167], v[124:127]
    v_mul_f32 v200, v163, v200
    v_mul_f32 v201, v163, v201
    v_mfma_f32_16x16x16_bf16 v[180:183], v[32:33], v[38:39], 0
    v_cvt_pk_bf16_f32 v150, v200, v201
    v_mul_f32 v202, v163, v202
    v_mfma_f32_16x16x32_bf16 v[220:223], v[112:115], a[168:171], 0
    v_mul_f32 v203, v163, v203
    v_cvt_pk_bf16_f32 v151, v202, v203
    v_mfma_f32_16x16x32_bf16 v[220:223], v[132:135], a[172:175], v[220:223]
    buffer_store_dwordx4 v[148:151], v17, s[12:15], s27 offen
    v_cvt_pk_bf16_f32 v130, v124, v125
    v_cvt_pk_bf16_f32 v131, v126, v127
    v_rsq_f32 v181, v181
    v_mfma_f32_16x16x32_bf16 v[220:223], v[136:139], a[176:179], v[220:223]
    v_rsq_f32 v180, v180
    v_mfma_f32_16x16x32_bf16 v[220:223], v[212:215], a[180:183], v[220:223]
    ds_read_b128 v[148:151], v0 offset:32768
    v_mul_f32 v180, s31, v180
    v_mfma_f32_16x16x32_bf16 v[220:223], v[156:159], a[184:187], v[220:223]
    ds_read_b128 v[200:203], v1 offset:32768
    v_mul_f32 v224, v181, v224
    v_mfma_f32_16x16x32_bf16 v[220:223], v[216:219], a[188:191], v[220:223]
    ds_read_b128 v[124:127], v0 offset:32896
    v_mul_f32 v225, v181, v225
    v_mfma_f32_16x16x32_bf16 v[164:167], v[112:115], a[192:195], 0
    ds_read_b128 v[112:115], v1 offset:32896
    v_cvt_pk_bf16_f32 v224, v224, v225
    v_mfma_f32_16x16x32_bf16 v[164:167], v[132:135], a[196:199], v[164:167]
    ds_read_b128 v[132:135], v0 offset:33024
    v_mul_f32 v226, v181, v226
    v_mfma_f32_16x16x32_bf16 v[164:167], v[136:139], a[200:203], v[164:167]
    ds_read_b128 v[136:139], v1 offset:33024
    v_cvt_pk_bf16_f32 v110, v220, v221
    v_mfma_f32_16x16x32_bf16 v[164:167], v[212:215], a[204:207], v[164:167]
    v_cvt_pk_bf16_f32 v111, v222, v223
    v_mul_f32 v227, v181, v227
    v_mfma_f32_16x16x32_bf16 v[164:167], v[156:159], a[208:211], v[164:167]
    v_cvt_pk_bf16_f32 v225, v226, v227
    v_mul_f32 v240, v181, v240
    v_mfma_f32_16x16x32_bf16 v[164:167], v[216:219], a[212:215], v[164:167]
    s_waitcnt lgkmcnt(5)
    v_mul_f32 v241, v181, v241
    v_cvt_pk_bf16_f32 v226, v240, v241
    v_mfma_f32_16x16x32_bf16 v[216:219], a[72:75], v[148:151], 0
    s_waitcnt lgkmcnt(4)
    v_mul_f32 v242, v181, v242
    v_mul_f32 v243, v181, v243
    v_mfma_f32_16x16x32_bf16 v[216:219], a[76:79], v[200:203], v[216:219]
    s_waitcnt lgkmcnt(3)
    v_cvt_pk_bf16_f32 v194, v164, v165
    v_cvt_pk_bf16_f32 v195, v166, v167
    v_mfma_f32_16x16x32_bf16 v[216:219], a[80:83], v[124:127], v[216:219]
    s_waitcnt lgkmcnt(2)
    v_cvt_pk_bf16_f32 v227, v242, v243
    v_mul_f32 v140, v181, v140
    v_mfma_f32_16x16x32_bf16 v[216:219], a[84:87], v[112:115], v[216:219]
    s_waitcnt lgkmcnt(1)
    v_mul_f32 v141, v181, v141
    v_cvt_pk_bf16_f32 v214, v140, v141
    v_mfma_f32_16x16x32_bf16 v[216:219], a[88:91], v[132:135], v[216:219]
    s_waitcnt lgkmcnt(0)
    v_mul_f32 v142, v181, v142
    v_mul_f32 v143, v181, v143
    v_mfma_f32_16x16x32_bf16 v[216:219], a[92:95], v[136:139], v[216:219]
    v_cvt_pk_bf16_f32 v215, v142, v143
    v_mul_f32 v244, v180, v244
    v_mfma_f32_16x16x32_bf16 v[140:143], a[96:99], v[148:151], 0
    v_mul_f32 v245, v180, v245
    v_cvt_pk_bf16_f32 v240, v244, v245
    v_mfma_f32_16x16x32_bf16 v[140:143], a[100:103], v[200:203], v[140:143]
    v_mul_f32 v246, v180, v246
    v_mul_f32 v247, v180, v247
    v_mfma_f32_16x16x32_bf16 v[140:143], a[104:107], v[124:127], v[140:143]
    v_cvt_pk_bf16_f32 v241, v246, v247
    v_mul_f32 v120, v180, v120
    v_mfma_f32_16x16x32_bf16 v[140:143], a[108:111], v[112:115], v[140:143]
    v_mul_f32 v121, v180, v121
    v_cvt_pk_bf16_f32 v242, v120, v121
    v_mfma_f32_16x16x32_bf16 v[140:143], a[112:115], v[132:135], v[140:143]
    v_mul_f32 v122, v180, v122
    v_mul_f32 v123, v180, v123
    v_mfma_f32_16x16x32_bf16 v[140:143], a[116:119], v[136:139], v[140:143]
    v_cvt_pk_bf16_f32 v243, v122, v123
    v_mul_f32 v144, v180, v144
    v_mfma_f32_16x16x32_bf16 v[244:247], a[120:123], v[148:151], 0
    v_mul_f32 v145, v180, v145
    v_cvt_pk_bf16_f32 v212, v144, v145
    v_mfma_f32_16x16x32_bf16 v[244:247], a[124:127], v[200:203], v[244:247]
    v_mul_f32 v146, v180, v146
    v_mul_f32 v147, v180, v147
    v_mfma_f32_16x16x32_bf16 v[244:247], a[128:131], v[124:127], v[244:247]
    v_cvt_pk_bf16_f32 v213, v146, v147
    v_fma_f32 v160, v216, v216, s32
    v_mfma_f32_16x16x32_bf16 v[244:247], a[132:135], v[112:115], v[244:247]
    v_fmac_f32 v160, v217, v217
    v_fmac_f32 v160, v218, v218
    v_mfma_f32_16x16x32_bf16 v[244:247], a[136:139], v[132:135], v[244:247]
    v_fmac_f32 v160, v219, v219
    v_fmac_f32 v160, v140, v140
    v_mfma_f32_16x16x32_bf16 v[244:247], a[140:143], v[136:139], v[244:247]
    s_waitcnt vmcnt(3)
    v_fmac_f32 v160, v141, v141
    v_fmac_f32 v160, v142, v142
    v_mfma_f32_16x16x32_bf16 v[120:123], a[0:3], v[148:151], 0
    s_barrier
    v_fmac_f32 v160, v143, v143
    v_mul_f32 v232, v163, v232
    v_mfma_f32_16x16x32_bf16 v[120:123], a[4:7], v[200:203], v[120:123]
    s_nop 0
    v_fmac_f32 v160, v244, v244
    v_fmac_f32 v160, v245, v245
    v_mfma_f32_16x16x32_bf16 v[120:123], a[8:11], v[124:127], v[120:123]
    s_nop 0
    v_fmac_f32 v160, v246, v246
    v_fmac_f32 v160, v247, v247
    v_mfma_f32_16x16x32_bf16 v[120:123], a[12:15], v[112:115], v[120:123]
    s_nop 0
    buffer_load_dwordx4 v10, s[8:11], s23 offen nt lds
    v_mul_f32 v233, v163, v233
    v_mfma_f32_16x16x32_bf16 v[120:123], a[16:19], v[132:135], v[120:123]
    s_add_u32 m0, s28, 4096
    v_cvt_pk_bf16_f32 v232, v232, v233
    v_mul_f32 v234, v163, v234
    v_mfma_f32_16x16x32_bf16 v[120:123], a[20:23], v[136:139], v[120:123]
    v_mul_f32 v235, v163, v235
    v_cvt_pk_bf16_f32 v233, v234, v235
    v_mfma_f32_16x16x32_bf16 v[144:147], a[24:27], v[148:151], 0
    v_mul_f32 v116, v162, v116
    v_mul_f32 v117, v162, v117
    v_mfma_f32_16x16x32_bf16 v[144:147], a[28:31], v[200:203], v[144:147]
    v_cvt_pk_bf16_f32 v116, v116, v117
    v_mul_f32 v118, v162, v118
    v_mfma_f32_16x16x32_bf16 v[144:147], a[32:35], v[124:127], v[144:147]
    buffer_load_dwordx4 v11, s[8:11], s23 offen nt lds
    v_fma_f32 v161, v120, v120, s32
    v_mfma_f32_16x16x32_bf16 v[144:147], a[36:39], v[112:115], v[144:147]
    s_add_u32 m0, s28, 8192
    v_fmac_f32 v161, v121, v121
    v_fmac_f32 v161, v122, v122
    v_mfma_f32_16x16x32_bf16 v[144:147], a[40:43], v[132:135], v[144:147]
    v_fmac_f32 v161, v123, v123
    v_mul_f32 v119, v162, v119
    v_mfma_f32_16x16x32_bf16 v[144:147], a[44:47], v[136:139], v[144:147]
    v_cvt_pk_bf16_f32 v117, v118, v119
    v_mul_f32 v208, v162, v208
    v_mfma_f32_16x16x32_bf16 v[180:183], a[48:51], v[148:151], 0
    v_mul_f32 v209, v162, v209
    v_cvt_pk_bf16_f32 v118, v208, v209
    v_mfma_f32_16x16x32_bf16 v[180:183], a[52:55], v[200:203], v[180:183]
    buffer_load_dwordx4 v12, s[8:11], s23 offen nt lds
    v_mul_f32 v210, v162, v210
    v_mfma_f32_16x16x32_bf16 v[180:183], a[56:59], v[124:127], v[180:183]
    s_add_u32 m0, s28, 12288
    v_fmac_f32 v161, v144, v144
    v_fmac_f32 v161, v145, v145
    v_mfma_f32_16x16x32_bf16 v[180:183], a[60:63], v[112:115], v[180:183]
    s_xor_b32 s28, s28, 65536
    ds_read_b128 v[220:223], v5 offset:0
    ds_read_b128 v[156:159], v5 offset:16
    v_mfma_f32_16x16x32_bf16 v[180:183], a[64:67], v[132:135], v[180:183]
    ds_read_b128 v[164:167], v5 offset:48
    ds_read_b32 v163, v6 offset:192
    v_mfma_f32_16x16x32_bf16 v[180:183], a[68:71], v[136:139], v[180:183]
    ds_read2_b32 v[170:171], v6 offset0:0 offset1:0
    ds_read2_b32 v[174:175], v6 offset0:16 offset1:16
    v_mfma_f32_16x16x32_bf16 v[184:187], v[148:151], a[144:147], 0
    buffer_load_dwordx4 v13, s[8:11], s23 offen nt lds
    ds_read2_b32 v[198:199], v6 offset0:32 offset1:32
    v_mfma_f32_16x16x32_bf16 v[184:187], v[200:203], a[148:151], v[184:187]
    s_mov_b32 m0, s29
    v_fmac_f32 v161, v146, v146
    v_fmac_f32 v161, v147, v147
    v_mfma_f32_16x16x32_bf16 v[184:187], v[124:127], a[152:155], v[184:187]
    s_xor_b32 s29, s29, s30
    v_fmac_f32 v161, v180, v180
    v_fmac_f32 v161, v181, v181
    v_mfma_f32_16x16x32_bf16 v[184:187], v[112:115], a[156:159], v[184:187]
    s_add_u32 s19, s19, s20
    v_fmac_f32 v161, v182, v182
    v_fmac_f32 v161, v183, v183
    v_mfma_f32_16x16x32_bf16 v[184:187], v[132:135], a[160:163], v[184:187]
    v_cvt_pk_bf16_f32 v38, v161, v160
    v_mul_f32 v211, v162, v211
    v_mfma_f32_16x16x32_bf16 v[184:187], v[136:139], a[164:167], v[184:187]
    s_waitcnt lgkmcnt(5)
    buffer_store_dwordx2 v[232:233], v20, s[12:15], s27 offen
    v_cvt_pk_bf16_f32 v119, v210, v211
    v_mul_f32 v228, v162, v228
    v_mfma_f32_16x16x16_bf16 v[208:211], v[32:33], v[38:39], 0
    s_waitcnt lgkmcnt(2)
    v_mul_f32 v229, v162, v229
    v_cvt_pk_bf16_f32 v228, v228, v229
    v_mfma_f32_16x16x32_bf16 v[232:235], v[220:223], v[188:191], v[22:25]
    s_waitcnt lgkmcnt(1)
    v_cvt_pk_bf16_f32 v168, v184, v185
    v_cvt_pk_bf16_f32 v169, v186, v187
    v_mfma_f32_16x16x32_bf16 v[232:235], v[156:159], v[176:179], v[232:235]
    s_waitcnt lgkmcnt(0)
    v_rsq_f32 v209, v209
    v_mfma_f32_16x16x32_bf16 v[232:235], v[164:167], v[152:155], v[232:235]
    v_rsq_f32 v208, v208
    v_mfma_f32_16x16x32_bf16 v[184:187], v[148:151], a[168:171], 0
    v_mul_f32 v208, s31, v208
    v_mul_f32 v216, v209, v216
    v_mfma_f32_16x16x32_bf16 v[184:187], v[200:203], a[172:175], v[184:187]
    v_mul_f32 v217, v209, v217
    v_cvt_pk_bf16_f32 v216, v216, v217
    v_mfma_f32_16x16x32_bf16 v[184:187], v[124:127], a[176:179], v[184:187]
    v_mov_b32_dpp v163, v233 quad_perm:[0,1,2,3] row_mask:0x1 bank_mask:0xf
    v_mul_f32 v218, v209, v218
    v_mfma_f32_16x16x32_bf16 v[184:187], v[112:115], a[180:183], v[184:187]
    v_mul_f32 v219, v209, v219
    v_cvt_pk_bf16_f32 v217, v218, v219
    v_mfma_f32_16x16x32_bf16 v[184:187], v[132:135], a[184:187], v[184:187]
    v_mul_f32 v140, v209, v140
    v_mul_f32 v141, v209, v141
    v_mfma_f32_16x16x32_bf16 v[184:187], v[136:139], a[188:191], v[184:187]
    v_cvt_pk_bf16_f32 v218, v140, v141
    v_mul_f32 v142, v209, v142
    v_mfma_f32_16x16x32_bf16 v[204:207], v[148:151], a[192:195], 0
    v_mul_f32 v143, v209, v143
    v_cvt_pk_bf16_f32 v219, v142, v143
    v_mfma_f32_16x16x32_bf16 v[204:207], v[200:203], a[196:199], v[204:207]
    v_mul_f32 v244, v209, v244
    v_mul_f32 v245, v209, v245
    v_mfma_f32_16x16x32_bf16 v[204:207], v[124:127], a[200:203], v[204:207]
    ds_read_b128 v[148:151], v2 offset:0
    v_cvt_pk_bf16_f32 v172, v184, v185
    v_mfma_f32_16x16x32_bf16 v[204:207], v[112:115], a[204:207], v[204:207]
    ds_read_b128 v[200:203], v2 offset:1024
    v_cvt_pk_bf16_f32 v173, v186, v187
    v_mfma_f32_16x16x32_bf16 v[204:207], v[132:135], a[208:211], v[204:207]
    ds_read_b128 v[124:127], v2 offset:2048
    v_cvt_pk_bf16_f32 v114, v244, v245
    v_mfma_f32_16x16x32_bf16 v[204:207], v[136:139], a[212:215], v[204:207]
    ds_read_b128 v[132:135], v2 offset:3072
    ds_read_b128 v[136:139], v2 offset:4096
    v_mfma_f32_16x16x32_bf16 v[184:187], v[176:179], v[188:191], v[40:43]
    ds_read_b128 v[236:239], v2 offset:5120
    buffer_store_dwordx4 v[116:119], v16, s[12:15], s27 offen
    v_mul_f32 v246, v209, v246
    v_mul_f32 v247, v209, v247
    v_cvt_pk_bf16_f32 v115, v246, v247
    v_cvt_pk_bf16_f32 v196, v204, v205
    v_mfma_f32_16x16x32_bf16 v[248:251], v[224:227], v[188:191], v[44:47]
    v_cvt_pk_bf16_f32 v197, v206, v207
    v_mul_f32 v120, v208, v120
    v_mfma_f32_16x16x32_bf16 v[204:207], v[216:219], v[188:191], v[48:51]
    v_mul_f32 v121, v208, v121
    v_cvt_pk_bf16_f32 v120, v120, v121
    v_mfma_f32_16x16x16_bf16 v[184:187], v[154:155], v[152:153], v[184:187]
    s_waitcnt lgkmcnt(5)
    v_mul_f32 v122, v208, v122
    v_mul_f32 v123, v208, v123
    v_mfma_f32_16x16x16_bf16 v[248:251], v[214:215], v[152:153], v[248:251]
    s_waitcnt lgkmcnt(4)
    v_cvt_pk_bf16_f32 v121, v122, v123
    v_mul_f32 v144, v208, v144
    v_mfma_f32_16x16x16_bf16 v[204:207], v[114:115], v[152:153], v[204:207]
    s_waitcnt lgkmcnt(3)
    v_mul_f32 v145, v208, v145
    v_cvt_pk_bf16_f32 v122, v144, v145
    v_mfma_f32_16x16x32_bf16 v[252:255], v[220:223], v[240:243], v[24:27]
    s_waitcnt lgkmcnt(1)
    v_mul_f32 v146, v208, v146
    v_mul_f32 v147, v208, v147
    v_mfma_f32_16x16x32_bf16 v[252:255], v[156:159], v[224:227], v[252:255]
    s_waitcnt lgkmcnt(0)
    v_cvt_pk_bf16_f32 v123, v146, v147
    v_mul_f32 v180, v208, v180
    v_mfma_f32_16x16x32_bf16 v[252:255], v[164:167], v[212:215], v[252:255]
    v_mul_f32 v181, v208, v181
    v_cvt_pk_bf16_f32 v112, v180, v181
    v_mfma_f32_16x16x32_bf16 v[144:147], v[220:223], v[120:123], v[26:29]
    v_mul_f32 v182, v208, v182
    v_mul_f32 v183, v208, v183
    v_mfma_f32_16x16x32_bf16 v[144:147], v[156:159], v[216:219], v[144:147]
    v_cvt_pk_bf16_f32 v113, v182, v183
    v_max3_f32 v152, v232, v184, v185
    v_mfma_f32_16x16x32_bf16 v[140:143], a[216:219], v[148:151], 0
    v_max3_f32 v152, v152, v186, v187
    v_max3_f32 v152, v152, v248, v249
    v_mfma_f32_16x16x32_bf16 v[144:147], v[164:167], v[112:115], v[144:147]
    v_max3_f32 v152, v152, v250, v251
    v_max3_f32 v152, v152, v204, v205
    v_mfma_f32_16x16x32_bf16 v[140:143], a[220:223], v[200:203], v[140:143]
    v_max3_f32 v152, v152, v206, v207
    v_mov_b32 v153, v152
    v_mfma_f32_16x16x32_bf16 v[140:143], a[224:227], v[124:127], v[140:143]
    v_mov_b32_dpp v163, v253 quad_perm:[0,1,2,3] row_mask:0x2 bank_mask:0xf
    v_mul_f32 v230, v162, v230
    v_mfma_f32_16x16x32_bf16 v[140:143], a[228:231], v[132:135], v[140:143]
    v_mov_b32_dpp v163, v145 quad_perm:[0,1,2,3] row_mask:0x4 bank_mask:0xf
    v_mul_f32 v231, v162, v231
    v_mfma_f32_16x16x32_bf16 v[140:143], a[232:235], v[136:139], v[140:143]
    v_permlane32_swap_b32 v152, v153
    v_mfma_f32_16x16x32_bf16 v[140:143], a[236:239], v[236:239], v[140:143]
    v_max_f32 v152, v152, v153
    v_mov_b32 v153, v152
    v_mfma_f32_16x16x32_bf16 v[188:191], a[240:243], v[148:151], 0
    v_cvt_pk_bf16_f32 v229, v230, v231
    v_mov_b32 v145, v163
    v_mfma_f32_16x16x32_bf16 v[188:191], a[244:247], v[200:203], v[188:191]
    buffer_store_dwordx2 v[228:229], v19, s[12:15], s27 offen
    v_permlane16_swap_b32 v152, v153
    v_mfma_f32_16x16x32_bf16 v[188:191], a[248:251], v[124:127], v[188:191]
    s_mov_b32 s27, s26
    v_max_f32 v152, v152, v153
    v_sub_f32 v184, v184, v152
    v_mfma_f32_16x16x32_bf16 v[188:191], a[252:255], v[132:135], v[188:191]
    s_mov_b32 s26, s25
    ds_read_b128 v[180:183], v2 offset:6144
    v_sub_f32 v185, v185, v152
    v_mfma_f32_16x16x32_bf16 v[188:191], v[76:79], v[136:139], v[188:191]
    s_mov_b32 s25, s24
    ds_read_b128 v[220:223], v2 offset:7168
    v_sub_f32 v186, v186, v152
    v_mfma_f32_16x16x32_bf16 v[188:191], v[80:83], v[236:239], v[188:191]
    s_mov_b32 s24, s23
    ds_read_b128 v[156:159], v2 offset:8192
    v_sub_f32 v187, v187, v152
    v_mfma_f32_16x16x32_bf16 v[244:247], v[84:87], v[148:151], 0
    ds_read_b128 v[148:151], v2 offset:9216
    v_sub_f32 v248, v248, v152
    v_mfma_f32_16x16x32_bf16 v[244:247], v[88:91], v[200:203], v[244:247]
    ds_read_b128 v[200:203], v2 offset:10240
    v_sub_f32 v249, v249, v152
    v_mfma_f32_16x16x32_bf16 v[244:247], v[92:95], v[124:127], v[244:247]
    ds_read_b128 v[124:127], v2 offset:11264
    v_sub_f32 v250, v250, v152
    v_mfma_f32_16x16x32_bf16 v[244:247], v[96:99], v[132:135], v[244:247]
    v_exp_f32 v184, v184
    v_mfma_f32_16x16x32_bf16 v[244:247], v[100:103], v[136:139], v[244:247]
    v_exp_f32 v185, v185
    v_mfma_f32_16x16x32_bf16 v[244:247], v[104:107], v[236:239], v[244:247]
    s_waitcnt lgkmcnt(5)
    v_cvt_pk_bf16_f32 v136, v184, v185
    v_sub_f32 v251, v251, v152
    v_mfma_f32_16x16x32_bf16 v[116:119], a[216:219], v[180:183], 0
    s_waitcnt lgkmcnt(4)
    v_exp_f32 v186, v186
    v_mfma_f32_16x16x32_bf16 v[116:119], a[220:223], v[220:223], v[116:119]
    s_waitcnt lgkmcnt(3)
    v_exp_f32 v187, v187
    v_mfma_f32_16x16x32_bf16 v[116:119], a[224:227], v[156:159], v[116:119]
    s_waitcnt lgkmcnt(2)
    v_cvt_pk_bf16_f32 v137, v186, v187
    v_sub_f32 v204, v204, v152
    v_mfma_f32_16x16x32_bf16 v[116:119], a[228:231], v[148:151], v[116:119]
    s_waitcnt lgkmcnt(1)
    v_exp_f32 v248, v248
    v_mfma_f32_16x16x32_bf16 v[132:135], v[176:179], v[240:243], v[52:55]
    s_waitcnt lgkmcnt(0)
    v_exp_f32 v249, v249
    v_mfma_f32_16x16x32_bf16 v[164:167], v[224:227], v[240:243], v[56:59]
    v_cvt_pk_bf16_f32 v138, v248, v249
    v_sub_f32 v205, v205, v152
    v_mfma_f32_16x16x32_bf16 v[184:187], v[216:219], v[240:243], v[60:63]
    buffer_load_dwordx4 v14, s[8:11], s23 offen nt lds
    v_sub_f32 v206, v206, v152
    v_mfma_f32_16x16x16_bf16 v[132:135], v[154:155], v[212:213], v[132:135]
    s_add_u32 s23, s23, s21
    v_exp_f32 v250, v250
    v_mfma_f32_16x16x16_bf16 v[164:167], v[214:215], v[212:213], v[164:167]
    s_cmp_ge_u32 s19, 72
    v_exp_f32 v251, v251
    v_mfma_f32_16x16x16_bf16 v[184:187], v[114:115], v[212:213], v[184:187]
    s_cselect_b32 s34, 72, 0
    v_cvt_pk_bf16_f32 v139, v250, v251
    v_sub_f32 v207, v207, v152
    v_mfma_f32_16x16x32_bf16 v[116:119], a[232:235], v[200:203], v[116:119]
    s_cselect_b32 s35, s22, 0
    v_exp_f32 v204, v204
    v_mfma_f32_16x16x32_bf16 v[116:119], a[236:239], v[124:127], v[116:119]
    s_sub_u32 s19, s19, s34
    v_exp_f32 v205, v205
    v_mfma_f32_16x16x32_bf16 v[208:211], a[240:243], v[180:183], 0
    s_add_u32 s23, s23, s35
    v_cvt_pk_bf16_f32 v36, v204, v205
    v_sub_f32 v232, v232, v152
    v_mfma_f32_16x16x32_bf16 v[208:211], a[244:247], v[220:223], v[208:211]
    s_add_u32 s18, s18, 1
    v_exp_f32 v206, v206
    v_mfma_f32_16x16x32_bf16 v[208:211], a[248:251], v[156:159], v[208:211]
    s_cmp_lt_u32 s18, s17
    v_exp_f32 v207, v207
    v_mfma_f32_16x16x32_bf16 v[208:211], a[252:255], v[148:151], v[208:211]
    ds_read_b128 v[240:243], v2 offset:12288
    v_cvt_pk_bf16_f32 v37, v206, v207
    v_mfma_f32_16x16x32_bf16 v[208:211], v[76:79], v[200:203], v[208:211]
    ds_read_b128 v[204:207], v2 offset:13312
    v_max3_f32 v146, v252, v132, v133
    v_mfma_f32_16x16x32_bf16 v[208:211], v[80:83], v[124:127], v[208:211]
    ds_read_b128 v[248:251], v2 offset:14336
    v_max3_f32 v146, v146, v134, v135
    v_mfma_f32_16x16x32_bf16 v[228:231], v[84:87], v[180:183], 0
    ds_read_b128 v[180:183], v2 offset:15360
    v_max3_f32 v146, v146, v164, v165
    v_mfma_f32_16x16x32_bf16 v[228:231], v[88:91], v[220:223], v[228:231]
    ds_read_b128 v[220:223], v2 offset:16384
    v_max3_f32 v146, v146, v166, v167
    v_mfma_f32_16x16x32_bf16 v[228:231], v[92:95], v[156:159], v[228:231]
    ds_read_b128 v[156:159], v2 offset:17408
    v_max3_f32 v146, v146, v184, v185
    v_mfma_f32_16x16x32_bf16 v[228:231], v[96:99], v[148:151], v[228:231]
    v_exp_f32 v232, v232
    v_mfma_f32_16x16x32_bf16 v[228:231], v[100:103], v[200:203], v[228:231]
    v_cvt_pk_bf16_f32 v38, v232, 0
    v_max3_f32 v146, v146, v186, v187
    v_mfma_f32_16x16x32_bf16 v[228:231], v[104:107], v[124:127], v[228:231]
    s_waitcnt lgkmcnt(5)
    v_mov_b32 v147, v146
    v_max_f32_dpp v145, v145, v145 quad_perm:[1,0,3,2] row_mask:0xf bank_mask:0xf
    v_mfma_f32_16x16x32_bf16 v[232:235], v[28:31], v[36:39], 0
    s_waitcnt lgkmcnt(4)
    v_permlane32_swap_b32 v146, v147
    v_mfma_f32_16x16x32_bf16 v[232:235], v[28:31], v[136:139], v[232:235]
    s_waitcnt lgkmcnt(3)
    v_max_f32 v146, v146, v147
    v_mov_b32 v147, v146
    v_mfma_f32_16x16x32_bf16 v[200:203], v[168:171], v[36:39], 0
    s_waitcnt lgkmcnt(2)
    v_permlane16_swap_b32 v146, v147
    v_mfma_f32_16x16x32_bf16 v[200:203], v[128:131], v[136:139], v[200:203]
    s_waitcnt lgkmcnt(1)
    v_rcp_f32 v232, v232
    v_mfma_f32_16x16x32_bf16 v[124:127], v[172:175], v[36:39], 0
    s_waitcnt lgkmcnt(0)
    v_max_f32 v146, v146, v147
    v_sub_f32 v132, v132, v146
    v_mfma_f32_16x16x32_bf16 v[124:127], v[108:111], v[136:139], v[124:127]
    v_exp_f32 v132, v132
    v_mfma_f32_16x16x32_bf16 v[236:239], v[196:199], v[36:39], 0
    v_mul_f32 v200, v232, v200
    v_mul_f32 v201, v232, v201
    v_mfma_f32_16x16x32_bf16 v[236:239], v[192:195], v[136:139], v[236:239]
    v_cvt_pk_bf16_f32 v200, v200, v201
    v_mul_f32 v202, v232, v202
    v_mfma_f32_16x16x32_bf16 v[148:151], a[216:219], v[240:243], 0
    v_mul_f32 v203, v232, v203
    v_cvt_pk_bf16_f32 v201, v202, v203
    v_mfma_f32_16x16x32_bf16 v[148:151], a[220:223], v[204:207], v[148:151]
    v_mul_f32 v124, v232, v124
    v_mul_f32 v125, v232, v125
    v_mfma_f32_16x16x32_bf16 v[148:151], a[224:227], v[248:251], v[148:151]
    v_cvt_pk_bf16_f32 v202, v124, v125
    v_mul_f32 v126, v232, v126
    v_mfma_f32_16x16x32_bf16 v[148:151], a[228:231], v[180:183], v[148:151]
    v_mul_f32 v127, v232, v127
    v_cvt_pk_bf16_f32 v203, v126, v127
    v_mfma_f32_16x16x32_bf16 v[148:151], a[232:235], v[220:223], v[148:151]
    ds_write_b128 v3, v[200:203] offset:0
    v_mfma_f32_16x16x32_bf16 v[148:151], a[236:239], v[156:159], v[148:151]
    v_mul_f32 v236, v232, v236
    v_mul_f32 v237, v232, v237
    v_mfma_f32_16x16x32_bf16 v[200:203], a[240:243], v[240:243], 0
    v_cvt_pk_bf16_f32 v152, v236, v237
    v_mul_f32 v238, v232, v238
    v_mfma_f32_16x16x32_bf16 v[200:203], a[244:247], v[204:207], v[200:203]
    v_mul_f32 v239, v232, v239
    v_cvt_pk_bf16_f32 v153, v238, v239
    v_mfma_f32_16x16x32_bf16 v[200:203], a[248:251], v[248:251], v[200:203]
    ds_write_b64 v4, v[152:153] offset:4096
    v_mfma_f32_16x16x32_bf16 v[200:203], a[252:255], v[180:183], v[200:203]
    v_fma_f32 v147, v148, v148, s33
    v_fmac_f32 v147, v149, v149
    v_mfma_f32_16x16x32_bf16 v[200:203], v[76:79], v[220:223], v[200:203]
    v_fmac_f32 v147, v150, v150
    v_fmac_f32 v147, v151, v151
    v_mfma_f32_16x16x32_bf16 v[200:203], v[80:83], v[156:159], v[200:203]
    v_sub_f32 v133, v133, v146
    v_sub_f32 v134, v134, v146
    v_mfma_f32_16x16x32_bf16 v[232:235], v[84:87], v[240:243], 0
    v_exp_f32 v133, v133
    v_mfma_f32_16x16x32_bf16 v[232:235], v[88:91], v[204:207], v[232:235]
    v_cvt_pk_bf16_f32 v240, v132, v133
    v_sub_f32 v135, v135, v146
    v_mfma_f32_16x16x32_bf16 v[232:235], v[92:95], v[248:251], v[232:235]
    v_fmac_f32 v147, v200, v200
    v_fmac_f32 v147, v201, v201
    v_mfma_f32_16x16x32_bf16 v[232:235], v[96:99], v[180:183], v[232:235]
    v_fmac_f32 v147, v202, v202
    v_fmac_f32 v147, v203, v203
    v_mfma_f32_16x16x32_bf16 v[232:235], v[100:103], v[220:223], v[232:235]
    v_exp_f32 v134, v134
    v_mfma_f32_16x16x32_bf16 v[232:235], v[104:107], v[156:159], v[232:235]
    v_exp_f32 v135, v135
    v_sub_f32 v164, v164, v146
    v_cvt_pk_bf16_f32 v241, v134, v135
    v_exp_f32 v164, v164
    v_sub_f32 v165, v165, v146
    v_exp_f32 v165, v165
    v_sub_f32 v166, v166, v146
    v_cvt_pk_bf16_f32 v242, v164, v165
    v_fmac_f32 v147, v232, v232
    v_fmac_f32 v147, v233, v233
    v_fmac_f32 v147, v234, v234
    v_fmac_f32 v147, v235, v235
    v_cvt_pk_bf16_f32 v161, v147, v147
    v_exp_f32 v166, v166
    v_sub_f32 v167, v167, v146
    v_exp_f32 v167, v167
    v_sub_f32 v184, v184, v146
    v_cvt_pk_bf16_f32 v243, v166, v167
    v_exp_f32 v184, v184
    v_sub_f32 v185, v185, v146
    v_exp_f32 v185, v185
    v_sub_f32 v186, v186, v146
    v_cvt_pk_bf16_f32 v36, v184, v185
    v_exp_f32 v186, v186
    v_sub_f32 v187, v187, v146
    v_exp_f32 v187, v187
    v_mfma_f32_16x16x32_bf16 v[132:135], v[176:179], v[120:123], v[64:67]
    v_cvt_pk_bf16_f32 v37, v186, v187
    v_sub_f32 v252, v252, v146
    v_mfma_f32_16x16x32_bf16 v[176:179], v[224:227], v[120:123], v[68:71]
    v_exp_f32 v252, v252
    v_mfma_f32_16x16x32_bf16 v[224:227], v[216:219], v[120:123], v[72:75]
    v_cvt_pk_bf16_f32 v38, v252, 0
    v_max_f32_dpp v145, v145, v145 quad_perm:[2,3,0,1] row_mask:0xf bank_mask:0xf
    v_mfma_f32_16x16x16_bf16 v[132:135], v[154:155], v[112:113], v[132:135]
    v_fma_f32 v160, v116, v116, s33
    v_max_f32_dpp v145, v145, v145 row_half_mirror row_mask:0xf bank_mask:0xf
    v_mfma_f32_16x16x16_bf16 v[176:179], v[214:215], v[112:113], v[176:179]
    v_fmac_f32 v160, v117, v117
    v_max_f32_dpp v145, v145, v145 row_mirror row_mask:0xf bank_mask:0xf
    v_mfma_f32_16x16x16_bf16 v[224:227], v[114:115], v[112:113], v[224:227]
    v_mov_b32 v162, v145
    v_fmac_f32 v160, v118, v118
    v_mfma_f32_16x16x32_bf16 v[152:155], v[28:31], v[36:39], 0
    v_permlane32_swap_b32 v145, v162
    v_mfma_f32_16x16x32_bf16 v[152:155], v[28:31], v[240:243], v[152:155]
    v_max_f32 v145, v145, v162
    v_mov_b32 v162, v145
    v_mfma_f32_16x16x32_bf16 v[112:115], v[168:171], v[36:39], 0
    v_max3_f32 v146, v144, v132, v133
    v_max3_f32 v146, v146, v134, v135
    v_mfma_f32_16x16x32_bf16 v[112:115], v[128:131], v[240:243], v[112:115]
    v_permlane16_swap_b32 v145, v162
    v_mfma_f32_16x16x32_bf16 v[124:127], v[172:175], v[36:39], 0
    v_max_f32 v145, v145, v162
    v_sub_f32 v163, v163, v145
    v_mfma_f32_16x16x32_bf16 v[124:127], v[108:111], v[240:243], v[124:127]
    v_exp_f32 v163, v163
    v_mfma_f32_16x16x32_bf16 v[136:139], v[196:199], v[36:39], 0
    v_cvt_pk_bf16_f32 v163, v163, v163
    v_max3_f32 v146, v146, v176, v177
    v_mfma_f32_16x16x32_bf16 v[136:139], v[192:195], v[240:243], v[136:139]
    ds_write_b16 v8, v163
    v_max3_f32 v146, v146, v178, v179
    v_max3_f32 v146, v146, v224, v225
    v_max3_f32 v146, v146, v226, v227
    v_mov_b32 v145, v146
    v_fmac_f32 v160, v119, v119
    v_fmac_f32 v160, v208, v208
    v_permlane32_swap_b32 v146, v145
    v_max_f32 v146, v146, v145
    v_mov_b32 v145, v146
    v_fmac_f32 v160, v209, v209
    v_fmac_f32 v160, v210, v210
    v_permlane16_swap_b32 v146, v145
    v_max_f32 v146, v146, v145
    v_sub_f32 v132, v132, v146
    v_exp_f32 v132, v132
    v_sub_f32 v133, v133, v146
    v_exp_f32 v133, v133
    v_sub_f32 v134, v134, v146
    v_cvt_pk_bf16_f32 v132, v132, v133
    v_exp_f32 v134, v134
    v_sub_f32 v135, v135, v146
    v_exp_f32 v135, v135
    v_sub_f32 v176, v176, v146
    v_cvt_pk_bf16_f32 v133, v134, v135
    v_exp_f32 v176, v176
    v_sub_f32 v177, v177, v146
    v_exp_f32 v177, v177
    v_sub_f32 v178, v178, v146
    v_cvt_pk_bf16_f32 v134, v176, v177
    v_exp_f32 v178, v178
    v_sub_f32 v179, v179, v146
    v_exp_f32 v179, v179
    v_sub_f32 v224, v224, v146
    v_cvt_pk_bf16_f32 v135, v178, v179
    v_exp_f32 v224, v224
    v_sub_f32 v225, v225, v146
    v_exp_f32 v225, v225
    v_sub_f32 v226, v226, v146
    v_cvt_pk_bf16_f32 v36, v224, v225
    v_exp_f32 v226, v226
    v_sub_f32 v227, v227, v146
    v_exp_f32 v227, v227
    v_sub_f32 v144, v144, v146
    v_cvt_pk_bf16_f32 v37, v226, v227
    v_exp_f32 v144, v144
    v_fmac_f32 v160, v211, v211
    v_cvt_pk_bf16_f32 v38, v144, 0
    v_fmac_f32 v160, v228, v228
    v_fmac_f32 v160, v229, v229
    v_mfma_f32_16x16x32_bf16 v[180:183], v[28:31], v[36:39], 0
    ds_read_b128 v[144:147], v9
    ds_read_b128 v[220:223], v9 offset:64
    v_mfma_f32_16x16x32_bf16 v[180:183], v[28:31], v[132:135], v[180:183]
    v_fmac_f32 v160, v230, v230
    v_fmac_f32 v160, v231, v231
    v_mfma_f32_16x16x32_bf16 v[156:159], v[168:171], v[36:39], 0
    v_xor_b32 v0, 65536, v0
    v_xor_b32 v1, 65536, v1
    v_mfma_f32_16x16x32_bf16 v[156:159], v[128:131], v[132:135], v[156:159]
    ds_read_b128 v[212:215], v0 offset:20480
    ds_read_b128 v[176:179], v1 offset:20480
    v_mfma_f32_16x16x32_bf16 v[164:167], v[172:175], v[36:39], 0
    ds_read_b128 v[216:219], v0 offset:20608
    ds_read_b128 v[120:123], v1 offset:20608
    v_mfma_f32_16x16x32_bf16 v[164:167], v[108:111], v[132:135], v[164:167]
    ds_read_b128 v[240:243], v0 offset:20736
    ds_read_b128 v[224:227], v1 offset:20736
    v_mfma_f32_16x16x32_bf16 v[184:187], v[196:199], v[36:39], 0
    v_rcp_f32 v152, v152
    v_mfma_f32_16x16x32_bf16 v[184:187], v[192:195], v[132:135], v[184:187]
    v_mul_f32 v112, v152, v112
    v_mul_f32 v113, v152, v113
    s_waitcnt lgkmcnt(6)
    v_mfma_f32_16x16x32_bf16 v[132:135], v[144:147], v[28:31], 0
    v_cvt_pk_bf16_f32 v112, v112, v113
    v_mul_f32 v114, v152, v114
    v_mfma_f32_16x16x32_bf16 v[132:135], v[220:223], v[28:31], v[132:135]
    v_mul_f32 v115, v152, v115
    v_cvt_pk_bf16_f32 v113, v114, v115
    v_mfma_f32_16x16x32_bf16 v[204:207], v[144:147], v[128:131], 0
    s_waitcnt lgkmcnt(5)
    v_mul_f32 v124, v152, v124
    v_mul_f32 v125, v152, v125
    v_mfma_f32_16x16x32_bf16 v[204:207], v[220:223], v[168:171], v[204:207]
    s_waitcnt lgkmcnt(3)
    v_rcp_f32 v132, v132
    v_mfma_f32_16x16x32_bf16 v[128:131], v[144:147], v[108:111], 0
    s_waitcnt lgkmcnt(1)
    v_cvt_pk_bf16_f32 v114, v124, v125
    v_mul_f32 v126, v152, v126
    v_mfma_f32_16x16x32_bf16 v[128:131], v[220:223], v[172:175], v[128:131]
    s_waitcnt lgkmcnt(0)
    v_mul_f32 v204, v204, v132
    v_mul_f32 v127, v152, v127
    v_mfma_f32_16x16x32_bf16 v[108:111], v[144:147], v[192:195], 0
    v_cvt_pk_bf16_f32 v115, v126, v127
    v_mul_f32 v136, v152, v136
    v_mfma_f32_16x16x32_bf16 v[108:111], v[220:223], v[196:199], v[108:111]
    ds_write_b128 v3, v[112:115] offset:6144
    v_mfma_f32_16x16x32_bf16 v[192:195], a[72:75], v[212:215], 0
    v_mul_f32_dpp v204, v128, v132 quad_perm:[0,1,2,3] row_mask:0x2 bank_mask:0xf
    v_mul_f32 v137, v152, v137
    v_mfma_f32_16x16x32_bf16 v[192:195], a[76:79], v[176:179], v[192:195]
    v_cvt_pk_bf16_f32 v162, v136, v137
    v_mul_f32 v138, v152, v138
    v_mfma_f32_16x16x32_bf16 v[192:195], a[80:83], v[216:219], v[192:195]
    v_mul_f32_dpp v204, v108, v132 quad_perm:[0,1,2,3] row_mask:0x4 bank_mask:0xf
    v_cvt_pk_bf16_f32 v204, v204, v204
    v_mfma_f32_16x16x32_bf16 v[192:195], a[84:87], v[120:123], v[192:195]
    ds_write_b16 v7, v204
    v_mfma_f32_16x16x32_bf16 v[192:195], a[88:91], v[240:243], v[192:195]
    v_mul_f32 v139, v152, v139
    v_cvt_pk_bf16_f32 v163, v138, v139
    v_mfma_f32_16x16x32_bf16 v[192:195], a[92:95], v[224:227], v[192:195]
    ds_write_b64 v4, v[162:163] offset:10240
    v_mfma_f32_16x16x32_bf16 v[152:155], a[96:99], v[212:215], 0
    v_rcp_f32 v180, v180
    v_mfma_f32_16x16x32_bf16 v[152:155], a[100:103], v[176:179], v[152:155]
    v_mul_f32 v156, v180, v156
    v_mul_f32 v157, v180, v157
    v_mfma_f32_16x16x32_bf16 v[152:155], a[104:107], v[216:219], v[152:155]
    v_cvt_pk_bf16_f32 v128, v156, v157
    v_mul_f32 v158, v180, v158
    v_mfma_f32_16x16x32_bf16 v[152:155], a[108:111], v[120:123], v[152:155]
    v_mul_f32 v159, v180, v159
    v_cvt_pk_bf16_f32 v129, v158, v159
    v_mfma_f32_16x16x32_bf16 v[152:155], a[112:115], v[240:243], v[152:155]
    v_mul_f32 v164, v180, v164
    v_mul_f32 v165, v180, v165
    v_mfma_f32_16x16x32_bf16 v[152:155], a[116:119], v[224:227], v[152:155]
    v_cvt_pk_bf16_f32 v130, v164, v165
    v_mul_f32 v166, v180, v166
    v_mfma_f32_16x16x32_bf16 v[144:147], a[120:123], v[212:215], 0
    v_mul_f32 v167, v180, v167
    v_cvt_pk_bf16_f32 v131, v166, v167
    v_mfma_f32_16x16x32_bf16 v[144:147], a[124:127], v[176:179], v[144:147]
    ds_write_b128 v3, v[128:131] offset:12288
    v_mfma_f32_16x16x32_bf16 v[144:147], a[128:131], v[216:219], v[144:147]
    v_mul_f32 v184, v180, v184
    v_mul_f32 v185, v180, v185
    v_mfma_f32_16x16x32_bf16 v[144:147], a[132:135], v[120:123], v[144:147]
    v_cvt_pk_bf16_f32 v162, v184, v185
    v_mul_f32 v186, v180, v186
    v_mfma_f32_16x16x32_bf16 v[144:147], a[136:139], v[240:243], v[144:147]
    v_mul_f32 v187, v180, v187
    v_cvt_pk_bf16_f32 v163, v186, v187
    v_mfma_f32_16x16x32_bf16 v[144:147], a[140:143], v[224:227], v[144:147]
    ds_write_b64 v4, v[162:163] offset:16384
    v_mfma_f32_16x16x32_bf16 v[124:127], a[0:3], v[212:215], 0
    v_fma_f32 v162, v140, v140, s33
    v_fmac_f32 v162, v141, v141
    v_mfma_f32_16x16x32_bf16 v[124:127], a[4:7], v[176:179], v[124:127]
    v_fmac_f32 v162, v142, v142
    v_fmac_f32 v162, v143, v143
    v_mfma_f32_16x16x32_bf16 v[124:127], a[8:11], v[216:219], v[124:127]
    v_fmac_f32 v162, v188, v188
    v_fmac_f32 v162, v189, v189
    v_mfma_f32_16x16x32_bf16 v[124:127], a[12:15], v[120:123], v[124:127]
    v_fmac_f32 v162, v190, v190
    v_fmac_f32 v162, v191, v191
    v_mfma_f32_16x16x32_bf16 v[124:127], a[16:19], v[240:243], v[124:127]
    v_fmac_f32 v162, v244, v244
    v_fmac_f32 v162, v245, v245
    v_mfma_f32_16x16x32_bf16 v[124:127], a[20:23], v[224:227], v[124:127]
    v_fmac_f32 v162, v246, v246
    v_fmac_f32 v162, v247, v247
    v_mfma_f32_16x16x32_bf16 v[180:183], a[24:27], v[212:215], 0
    v_cvt_pk_bf16_f32 v160, v162, v160
    v_fma_f32 v162, v192, v192, s32
    v_mfma_f32_16x16x32_bf16 v[180:183], a[28:31], v[176:179], v[180:183]
    ds_write_b64 v4, v[160:161] offset:18432
    v_mfma_f32_16x16x32_bf16 v[180:183], a[32:35], v[216:219], v[180:183]
    v_fmac_f32 v162, v193, v193
    v_fmac_f32 v162, v194, v194
    v_mfma_f32_16x16x32_bf16 v[180:183], a[36:39], v[120:123], v[180:183]
    v_fmac_f32 v162, v195, v195
    v_fmac_f32 v162, v152, v152
    v_mfma_f32_16x16x32_bf16 v[180:183], a[40:43], v[240:243], v[180:183]
    v_fmac_f32 v162, v153, v153
    v_fmac_f32 v162, v154, v154
    v_mfma_f32_16x16x32_bf16 v[180:183], a[44:47], v[224:227], v[180:183]
    v_fmac_f32 v162, v155, v155
    v_fmac_f32 v162, v144, v144
    v_mfma_f32_16x16x32_bf16 v[220:223], a[48:51], v[212:215], 0
    v_fmac_f32 v162, v145, v145
    v_fmac_f32 v162, v146, v146
    v_mfma_f32_16x16x32_bf16 v[220:223], a[52:55], v[176:179], v[220:223]
    v_fmac_f32 v162, v147, v147
    v_fma_f32 v160, v124, v124, s32
    v_mfma_f32_16x16x32_bf16 v[220:223], a[56:59], v[216:219], v[220:223]
    s_waitcnt lgkmcnt(0)
    v_fmac_f32 v160, v125, v125
    v_fmac_f32 v160, v126, v126
    v_mfma_f32_16x16x32_bf16 v[220:223], a[60:63], v[120:123], v[220:223]
    s_barrier
    v_fmac_f32 v160, v127, v127
    v_fmac_f32 v160, v180, v180
    v_mfma_f32_16x16x32_bf16 v[220:223], a[64:67], v[240:243], v[220:223]
    s_nop 0
    v_fmac_f32 v160, v181, v181
    v_fmac_f32 v160, v182, v182
    v_mfma_f32_16x16x32_bf16 v[220:223], a[68:71], v[224:227], v[220:223]
    s_nop 0
    v_fmac_f32 v160, v183, v183
    v_add_u32 v5, 336, v5
    v_mfma_f32_16x16x32_bf16 v[128:131], v[212:215], a[144:147], 0
    s_nop 0
    v_add_u32 v6, 272, v6
    v_add_u32 v7, 16, v7
    v_mfma_f32_16x16x32_bf16 v[128:131], v[176:179], a[148:151], v[128:131]
    v_fmac_f32 v160, v220, v220
    v_fmac_f32 v160, v221, v221
    v_mfma_f32_16x16x32_bf16 v[128:131], v[216:219], a[152:155], v[128:131]
    v_fmac_f32 v160, v222, v222
    v_fmac_f32 v160, v223, v223
    v_mfma_f32_16x16x32_bf16 v[128:131], v[120:123], a[156:159], v[128:131]
    v_cvt_pk_bf16_f32 v38, v160, v162
    v_xor_b32 v2, 65536, v2
    v_mfma_f32_16x16x32_bf16 v[128:131], v[240:243], a[160:163], v[128:131]
    v_xor_b32 v3, 65536, v3
    v_xor_b32 v4, 65536, v4
    v_mfma_f32_16x16x32_bf16 v[128:131], v[224:227], a[164:167], v[128:131]
    s_cbranch_scc1 L_loop_safe0
    s_branch L_drain
.p2align 6
L_loop_safe1:
    v_mfma_f32_16x16x16_bf16 v[160:163], v[32:33], v[38:39], 0
    s_cmp_ge_u32 s18, 2
    ds_read_b128 v[172:175], v2 offset:18432
    ds_read_b128 v[196:199], v2 offset:19456
    v_mfma_f32_16x16x32_bf16 v[108:111], v[212:215], a[168:171], 0
    s_cselect_b32 s14, s36, 0
    s_add_u32 s34, s18, 2
    v_cvt_pk_bf16_f32 v128, v128, v129
    v_mfma_f32_16x16x32_bf16 v[108:111], v[176:179], a[172:175], v[108:111]
    s_cmp_lt_u32 s34, s17
    v_rsq_f32 v161, v161
    v_mfma_f32_16x16x32_bf16 v[108:111], v[216:219], a[176:179], v[108:111]
    s_cselect_b32 s10, s36, 0
    v_rsq_f32 v160, v160
    v_mfma_f32_16x16x32_bf16 v[108:111], v[120:123], a[180:183], v[108:111]
    s_add_u32 m0, s28, 0
    ds_read_b128 v[112:115], v0 offset:26624
    v_mul_f32 v160, s31, v160
    v_mfma_f32_16x16x32_bf16 v[108:111], v[240:243], a[184:187], v[108:111]
    ds_read_b128 v[132:135], v1 offset:26624
    v_cvt_pk_bf16_f32 v129, v130, v131
    v_mfma_f32_16x16x32_bf16 v[108:111], v[224:227], a[188:191], v[108:111]
    ds_read_b128 v[136:139], v0 offset:26752
    v_mul_f32 v192, v161, v192
    v_mfma_f32_16x16x32_bf16 v[164:167], v[212:215], a[192:195], 0
    ds_read_b128 v[212:215], v1 offset:26752
    v_mul_f32 v193, v161, v193
    v_mfma_f32_16x16x32_bf16 v[164:167], v[176:179], a[196:199], v[164:167]
    s_waitcnt lgkmcnt(4)
    ds_read_b128 v[156:159], v0 offset:26880
    v_cvt_pk_bf16_f32 v108, v108, v109
    v_mfma_f32_16x16x32_bf16 v[168:171], v[32:35], v[172:175], 0
    v_cvt_pk_bf16_f32 v109, v110, v111
    v_cvt_pk_bf16_f32 v176, v192, v193
    v_mfma_f32_16x16x32_bf16 v[168:171], v[32:35], v[196:199], v[168:171]
    v_mul_f32 v194, v161, v194
    v_mul_f32 v195, v161, v195
    v_mfma_f32_16x16x32_bf16 v[164:167], v[216:219], a[200:203], v[164:167]
    ds_read_b128 v[216:219], v1 offset:26880
    v_cvt_pk_bf16_f32 v177, v194, v195
    v_mfma_f32_16x16x32_bf16 v[164:167], v[120:123], a[204:207], v[164:167]
    s_waitcnt lgkmcnt(5)
    v_mul_f32 v152, v161, v152
    v_mul_f32 v110, 0x3baaaaab, v168
    v_mfma_f32_16x16x32_bf16 v[164:167], v[240:243], a[208:211], v[164:167]
    s_waitcnt lgkmcnt(4)
    v_rsq_f32 v110, v110
    v_mfma_f32_16x16x32_bf16 v[164:167], v[224:227], a[212:215], v[164:167]
    s_waitcnt lgkmcnt(3)
    v_mul_f32 v162, 0x3baaaaab, v169
    v_mul_f32 v163, 0x3baaaaab, v170
    v_mfma_f32_16x16x32_bf16 v[224:227], a[72:75], v[112:115], 0
    s_waitcnt lgkmcnt(2)
    v_rsq_f32 v162, v162
    v_mfma_f32_16x16x32_bf16 v[224:227], a[76:79], v[132:135], v[224:227]
    s_waitcnt lgkmcnt(1)
    v_cvt_pk_bf16_f32 v192, v164, v165
    v_cvt_pk_bf16_f32 v193, v166, v167
    v_mfma_f32_16x16x32_bf16 v[224:227], a[80:83], v[136:139], v[224:227]
    v_rsq_f32 v163, v163
    v_mfma_f32_16x16x32_bf16 v[224:227], a[84:87], v[212:215], v[224:227]
    v_mul_f32 v140, v110, v140
    v_mul_f32 v141, v110, v141
    v_mfma_f32_16x16x32_bf16 v[224:227], a[88:91], v[156:159], v[224:227]
    s_waitcnt lgkmcnt(0)
    v_cvt_pk_bf16_f32 v140, v140, v141
    v_mul_f32 v142, v110, v142
    v_mfma_f32_16x16x32_bf16 v[224:227], a[92:95], v[216:219], v[224:227]
    v_mul_f32 v143, v110, v143
    v_cvt_pk_bf16_f32 v141, v142, v143
    v_mfma_f32_16x16x32_bf16 v[240:243], a[96:99], v[112:115], 0
    v_mul_f32 v188, v110, v188
    v_mul_f32 v189, v110, v189
    v_mfma_f32_16x16x32_bf16 v[240:243], a[100:103], v[132:135], v[240:243]
    v_cvt_pk_bf16_f32 v142, v188, v189
    v_mul_f32 v190, v110, v190
    v_mfma_f32_16x16x32_bf16 v[240:243], a[104:107], v[136:139], v[240:243]
    v_mul_f32 v191, v110, v191
    v_cvt_pk_bf16_f32 v143, v190, v191
    v_mfma_f32_16x16x32_bf16 v[240:243], a[108:111], v[212:215], v[240:243]
    buffer_store_dwordx4 v[140:143], v15, s[12:15], s27 offen
    v_mul_f32 v244, v110, v244
    v_mul_f32 v245, v110, v245
    v_cvt_pk_bf16_f32 v130, v244, v245
    v_mul_f32 v246, v110, v246
    v_mfma_f32_16x16x32_bf16 v[240:243], a[112:115], v[156:159], v[240:243]
    v_mul_f32 v247, v110, v247
    v_cvt_pk_bf16_f32 v131, v246, v247
    v_mfma_f32_16x16x32_bf16 v[240:243], a[116:119], v[216:219], v[240:243]
    v_mul_f32 v153, v161, v153
    v_cvt_pk_bf16_f32 v178, v152, v153
    v_mfma_f32_16x16x32_bf16 v[140:143], a[120:123], v[112:115], 0
    v_mul_f32 v154, v161, v154
    v_mul_f32 v155, v161, v155
    v_mfma_f32_16x16x32_bf16 v[140:143], a[124:127], v[132:135], v[140:143]
    v_cvt_pk_bf16_f32 v179, v154, v155
    v_mul_f32 v144, v161, v144
    v_mfma_f32_16x16x32_bf16 v[140:143], a[128:131], v[136:139], v[140:143]
    v_mul_f32 v145, v161, v145
    v_cvt_pk_bf16_f32 v154, v144, v145
    v_mfma_f32_16x16x32_bf16 v[140:143], a[132:135], v[212:215], v[140:143]
    v_mul_f32 v146, v161, v146
    v_mul_f32 v147, v161, v147
    v_mfma_f32_16x16x32_bf16 v[140:143], a[136:139], v[156:159], v[140:143]
    v_cvt_pk_bf16_f32 v155, v146, v147
    v_mul_f32 v124, v160, v124
    v_mfma_f32_16x16x32_bf16 v[140:143], a[140:143], v[216:219], v[140:143]
    v_mul_f32 v125, v160, v125
    v_cvt_pk_bf16_f32 v188, v124, v125
    v_mfma_f32_16x16x32_bf16 v[244:247], a[0:3], v[112:115], 0
    v_mul_f32 v126, v160, v126
    v_mul_f32 v127, v160, v127
    v_mfma_f32_16x16x32_bf16 v[244:247], a[4:7], v[132:135], v[244:247]
    v_cvt_pk_bf16_f32 v189, v126, v127
    v_mul_f32 v180, v160, v180
    v_mfma_f32_16x16x32_bf16 v[244:247], a[8:11], v[136:139], v[244:247]
    v_mul_f32 v181, v160, v181
    v_cvt_pk_bf16_f32 v190, v180, v181
    v_mfma_f32_16x16x32_bf16 v[244:247], a[12:15], v[212:215], v[244:247]
    v_mul_f32 v182, v160, v182
    v_mul_f32 v183, v160, v183
    v_mfma_f32_16x16x32_bf16 v[244:247], a[16:19], v[156:159], v[244:247]
    v_cvt_pk_bf16_f32 v191, v182, v183
    v_mul_f32 v220, v160, v220
    v_mfma_f32_16x16x32_bf16 v[244:247], a[20:23], v[216:219], v[244:247]
    v_mul_f32 v221, v160, v221
    v_cvt_pk_bf16_f32 v152, v220, v221
    v_mfma_f32_16x16x32_bf16 v[120:123], a[24:27], v[112:115], 0
    v_mul_f32 v222, v160, v222
    v_mul_f32 v223, v160, v223
    v_mfma_f32_16x16x32_bf16 v[120:123], a[28:31], v[132:135], v[120:123]
    v_cvt_pk_bf16_f32 v153, v222, v223
    v_fma_f32 v110, v224, v224, s32
    v_mfma_f32_16x16x32_bf16 v[120:123], a[32:35], v[136:139], v[120:123]
    buffer_store_dwordx2 v[130:131], v18, s[12:15], s27 offen
    v_fma_f32 v111, v244, v244, s32
    v_fmac_f32 v111, v245, v245
    v_mfma_f32_16x16x32_bf16 v[120:123], a[36:39], v[212:215], v[120:123]
    v_fmac_f32 v111, v246, v246
    v_fmac_f32 v111, v247, v247
    v_mfma_f32_16x16x32_bf16 v[120:123], a[40:43], v[156:159], v[120:123]
    v_fmac_f32 v110, v225, v225
    v_fmac_f32 v110, v226, v226
    v_mfma_f32_16x16x32_bf16 v[120:123], a[44:47], v[216:219], v[120:123]
    v_fmac_f32 v110, v227, v227
    v_fmac_f32 v110, v240, v240
    v_mfma_f32_16x16x32_bf16 v[144:147], a[48:51], v[112:115], 0
    v_fmac_f32 v110, v241, v241
    v_fmac_f32 v110, v242, v242
    v_mfma_f32_16x16x32_bf16 v[144:147], a[52:55], v[132:135], v[144:147]
    v_fmac_f32 v110, v243, v243
    v_fmac_f32 v110, v140, v140
    v_mfma_f32_16x16x32_bf16 v[144:147], a[56:59], v[136:139], v[144:147]
    v_fmac_f32 v111, v120, v120
    v_fmac_f32 v111, v121, v121
    v_mfma_f32_16x16x32_bf16 v[144:147], a[60:63], v[212:215], v[144:147]
    v_fmac_f32 v111, v122, v122
    v_fmac_f32 v111, v123, v123
    v_mfma_f32_16x16x32_bf16 v[144:147], a[64:67], v[156:159], v[144:147]
    v_fmac_f32 v110, v141, v141
    v_fmac_f32 v110, v142, v142
    v_mfma_f32_16x16x32_bf16 v[144:147], a[68:71], v[216:219], v[144:147]
    v_fmac_f32 v110, v143, v143
    v_mul_f32 v148, v163, v148
    v_mfma_f32_16x16x32_bf16 v[124:127], v[112:115], a[144:147], 0
    v_mul_f32 v149, v163, v149
    v_cvt_pk_bf16_f32 v148, v148, v149
    v_mfma_f32_16x16x32_bf16 v[124:127], v[132:135], a[148:151], v[124:127]
    v_mul_f32 v150, v163, v150
    v_mul_f32 v151, v163, v151
    v_mfma_f32_16x16x32_bf16 v[124:127], v[136:139], a[152:155], v[124:127]
    v_fmac_f32 v111, v144, v144
    v_fmac_f32 v111, v145, v145
    v_mfma_f32_16x16x32_bf16 v[124:127], v[212:215], a[156:159], v[124:127]
    v_fmac_f32 v111, v146, v146
    v_fmac_f32 v111, v147, v147
    v_mfma_f32_16x16x32_bf16 v[124:127], v[156:159], a[160:163], v[124:127]
    v_cvt_pk_bf16_f32 v38, v111, v110
    v_cvt_pk_bf16_f32 v149, v150, v151
    v_mfma_f32_16x16x32_bf16 v[124:127], v[216:219], a[164:167], v[124:127]
    v_mul_f32 v200, v163, v200
    v_mul_f32 v201, v163, v201
    v_mfma_f32_16x16x16_bf16 v[180:183], v[32:33], v[38:39], 0
    v_cvt_pk_bf16_f32 v150, v200, v201
    v_mul_f32 v202, v163, v202
    v_mfma_f32_16x16x32_bf16 v[220:223], v[112:115], a[168:171], 0
    v_mul_f32 v203, v163, v203
    v_cvt_pk_bf16_f32 v151, v202, v203
    v_mfma_f32_16x16x32_bf16 v[220:223], v[132:135], a[172:175], v[220:223]
    buffer_store_dwordx4 v[148:151], v17, s[12:15], s27 offen
    v_cvt_pk_bf16_f32 v130, v124, v125
    v_cvt_pk_bf16_f32 v131, v126, v127
    v_rsq_f32 v181, v181
    v_mfma_f32_16x16x32_bf16 v[220:223], v[136:139], a[176:179], v[220:223]
    v_rsq_f32 v180, v180
    v_mfma_f32_16x16x32_bf16 v[220:223], v[212:215], a[180:183], v[220:223]
    ds_read_b128 v[148:151], v0 offset:32768
    v_mul_f32 v180, s31, v180
    v_mfma_f32_16x16x32_bf16 v[220:223], v[156:159], a[184:187], v[220:223]
    ds_read_b128 v[200:203], v1 offset:32768
    v_mul_f32 v224, v181, v224
    v_mfma_f32_16x16x32_bf16 v[220:223], v[216:219], a[188:191], v[220:223]
    ds_read_b128 v[124:127], v0 offset:32896
    v_mul_f32 v225, v181, v225
    v_mfma_f32_16x16x32_bf16 v[164:167], v[112:115], a[192:195], 0
    ds_read_b128 v[112:115], v1 offset:32896
    v_cvt_pk_bf16_f32 v224, v224, v225
    v_mfma_f32_16x16x32_bf16 v[164:167], v[132:135], a[196:199], v[164:167]
    ds_read_b128 v[132:135], v0 offset:33024
    v_mul_f32 v226, v181, v226
    v_mfma_f32_16x16x32_bf16 v[164:167], v[136:139], a[200:203], v[164:167]
    ds_read_b128 v[136:139], v1 offset:33024
    v_cvt_pk_bf16_f32 v110, v220, v221
    v_mfma_f32_16x16x32_bf16 v[164:167], v[212:215], a[204:207], v[164:167]
    v_cvt_pk_bf16_f32 v111, v222, v223
    v_mul_f32 v227, v181, v227
    v_mfma_f32_16x16x32_bf16 v[164:167], v[156:159], a[208:211], v[164:167]
    v_cvt_pk_bf16_f32 v225, v226, v227
    v_mul_f32 v240, v181, v240
    v_mfma_f32_16x16x32_bf16 v[164:167], v[216:219], a[212:215], v[164:167]
    s_waitcnt lgkmcnt(5)
    v_mul_f32 v241, v181, v241
    v_cvt_pk_bf16_f32 v226, v240, v241
    v_mfma_f32_16x16x32_bf16 v[216:219], a[72:75], v[148:151], 0
    s_waitcnt lgkmcnt(4)
    v_mul_f32 v242, v181, v242
    v_mul_f32 v243, v181, v243
    v_mfma_f32_16x16x32_bf16 v[216:219], a[76:79], v[200:203], v[216:219]
    s_waitcnt lgkmcnt(3)
    v_cvt_pk_bf16_f32 v194, v164, v165
    v_cvt_pk_bf16_f32 v195, v166, v167
    v_mfma_f32_16x16x32_bf16 v[216:219], a[80:83], v[124:127], v[216:219]
    s_waitcnt lgkmcnt(2)
    v_cvt_pk_bf16_f32 v227, v242, v243
    v_mul_f32 v140, v181, v140
    v_mfma_f32_16x16x32_bf16 v[216:219], a[84:87], v[112:115], v[216:219]
    s_waitcnt lgkmcnt(1)
    v_mul_f32 v141, v181, v141
    v_cvt_pk_bf16_f32 v214, v140, v141
    v_mfma_f32_16x16x32_bf16 v[216:219], a[88:91], v[132:135], v[216:219]
    s_waitcnt lgkmcnt(0)
    v_mul_f32 v142, v181, v142
    v_mul_f32 v143, v181, v143
    v_mfma_f32_16x16x32_bf16 v[216:219], a[92:95], v[136:139], v[216:219]
    v_cvt_pk_bf16_f32 v215, v142, v143
    v_mul_f32 v244, v180, v244
    v_mfma_f32_16x16x32_bf16 v[140:143], a[96:99], v[148:151], 0
    v_mul_f32 v245, v180, v245
    v_cvt_pk_bf16_f32 v240, v244, v245
    v_mfma_f32_16x16x32_bf16 v[140:143], a[100:103], v[200:203], v[140:143]
    v_mul_f32 v246, v180, v246
    v_mul_f32 v247, v180, v247
    v_mfma_f32_16x16x32_bf16 v[140:143], a[104:107], v[124:127], v[140:143]
    v_cvt_pk_bf16_f32 v241, v246, v247
    v_mul_f32 v120, v180, v120
    v_mfma_f32_16x16x32_bf16 v[140:143], a[108:111], v[112:115], v[140:143]
    v_mul_f32 v121, v180, v121
    v_cvt_pk_bf16_f32 v242, v120, v121
    v_mfma_f32_16x16x32_bf16 v[140:143], a[112:115], v[132:135], v[140:143]
    v_mul_f32 v122, v180, v122
    v_mul_f32 v123, v180, v123
    v_mfma_f32_16x16x32_bf16 v[140:143], a[116:119], v[136:139], v[140:143]
    v_cvt_pk_bf16_f32 v243, v122, v123
    v_mul_f32 v144, v180, v144
    v_mfma_f32_16x16x32_bf16 v[244:247], a[120:123], v[148:151], 0
    v_mul_f32 v145, v180, v145
    v_cvt_pk_bf16_f32 v212, v144, v145
    v_mfma_f32_16x16x32_bf16 v[244:247], a[124:127], v[200:203], v[244:247]
    v_mul_f32 v146, v180, v146
    v_mul_f32 v147, v180, v147
    v_mfma_f32_16x16x32_bf16 v[244:247], a[128:131], v[124:127], v[244:247]
    v_cvt_pk_bf16_f32 v213, v146, v147
    v_fma_f32 v160, v216, v216, s32
    v_mfma_f32_16x16x32_bf16 v[244:247], a[132:135], v[112:115], v[244:247]
    v_fmac_f32 v160, v217, v217
    v_fmac_f32 v160, v218, v218
    v_mfma_f32_16x16x32_bf16 v[244:247], a[136:139], v[132:135], v[244:247]
    v_fmac_f32 v160, v219, v219
    v_fmac_f32 v160, v140, v140
    v_mfma_f32_16x16x32_bf16 v[244:247], a[140:143], v[136:139], v[244:247]
    s_waitcnt vmcnt(3)
    v_fmac_f32 v160, v141, v141
    v_fmac_f32 v160, v142, v142
    v_mfma_f32_16x16x32_bf16 v[120:123], a[0:3], v[148:151], 0
    s_nop 0
    v_fmac_f32 v160, v143, v143
    v_mul_f32 v232, v163, v232
    v_mfma_f32_16x16x32_bf16 v[120:123], a[4:7], v[200:203], v[120:123]
    s_barrier
    v_fmac_f32 v160, v244, v244
    v_fmac_f32 v160, v245, v245
    v_mfma_f32_16x16x32_bf16 v[120:123], a[8:11], v[124:127], v[120:123]
    s_nop 0
    v_fmac_f32 v160, v246, v246
    v_fmac_f32 v160, v247, v247
    v_mfma_f32_16x16x32_bf16 v[120:123], a[12:15], v[112:115], v[120:123]
    s_nop 0
    buffer_load_dwordx4 v10, s[8:11], s23 offen nt lds
    v_mul_f32 v233, v163, v233
    v_mfma_f32_16x16x32_bf16 v[120:123], a[16:19], v[132:135], v[120:123]
    s_add_u32 m0, s28, 4096
    v_cvt_pk_bf16_f32 v232, v232, v233
    v_mul_f32 v234, v163, v234
    v_mfma_f32_16x16x32_bf16 v[120:123], a[20:23], v[136:139], v[120:123]
    v_mul_f32 v235, v163, v235
    v_cvt_pk_bf16_f32 v233, v234, v235
    v_mfma_f32_16x16x32_bf16 v[144:147], a[24:27], v[148:151], 0
    v_mul_f32 v116, v162, v116
    v_mul_f32 v117, v162, v117
    v_mfma_f32_16x16x32_bf16 v[144:147], a[28:31], v[200:203], v[144:147]
    v_cvt_pk_bf16_f32 v116, v116, v117
    v_mul_f32 v118, v162, v118
    v_mfma_f32_16x16x32_bf16 v[144:147], a[32:35], v[124:127], v[144:147]
    buffer_load_dwordx4 v11, s[8:11], s23 offen nt lds
    v_fma_f32 v161, v120, v120, s32
    v_mfma_f32_16x16x32_bf16 v[144:147], a[36:39], v[112:115], v[144:147]
    s_add_u32 m0, s28, 8192
    v_fmac_f32 v161, v121, v121
    v_fmac_f32 v161, v122, v122
    v_mfma_f32_16x16x32_bf16 v[144:147], a[40:43], v[132:135], v[144:147]
    v_fmac_f32 v161, v123, v123
    v_mul_f32 v119, v162, v119
    v_mfma_f32_16x16x32_bf16 v[144:147], a[44:47], v[136:139], v[144:147]
    v_cvt_pk_bf16_f32 v117, v118, v119
    v_mul_f32 v208, v162, v208
    v_mfma_f32_16x16x32_bf16 v[180:183], a[48:51], v[148:151], 0
    v_mul_f32 v209, v162, v209
    v_cvt_pk_bf16_f32 v118, v208, v209
    v_mfma_f32_16x16x32_bf16 v[180:183], a[52:55], v[200:203], v[180:183]
    buffer_load_dwordx4 v12, s[8:11], s23 offen nt lds
    v_mul_f32 v210, v162, v210
    v_mfma_f32_16x16x32_bf16 v[180:183], a[56:59], v[124:127], v[180:183]
    s_add_u32 m0, s28, 12288
    v_fmac_f32 v161, v144, v144
    v_fmac_f32 v161, v145, v145
    v_mfma_f32_16x16x32_bf16 v[180:183], a[60:63], v[112:115], v[180:183]
    s_xor_b32 s28, s28, 65536
    ds_read_b128 v[220:223], v5 offset:0
    ds_read_b128 v[156:159], v5 offset:16
    v_mfma_f32_16x16x32_bf16 v[180:183], a[64:67], v[132:135], v[180:183]
    ds_read_b128 v[164:167], v5 offset:48
    ds_read_b32 v163, v6 offset:192
    v_mfma_f32_16x16x32_bf16 v[180:183], a[68:71], v[136:139], v[180:183]
    ds_read2_b32 v[170:171], v6 offset0:0 offset1:0
    ds_read2_b32 v[174:175], v6 offset0:16 offset1:16
    v_mfma_f32_16x16x32_bf16 v[184:187], v[148:151], a[144:147], 0
    buffer_load_dwordx4 v13, s[8:11], s23 offen nt lds
    ds_read2_b32 v[198:199], v6 offset0:32 offset1:32
    v_mfma_f32_16x16x32_bf16 v[184:187], v[200:203], a[148:151], v[184:187]
    s_mov_b32 m0, s29
    v_fmac_f32 v161, v146, v146
    v_fmac_f32 v161, v147, v147
    v_mfma_f32_16x16x32_bf16 v[184:187], v[124:127], a[152:155], v[184:187]
    s_xor_b32 s29, s29, s30
    v_fmac_f32 v161, v180, v180
    v_fmac_f32 v161, v181, v181
    v_mfma_f32_16x16x32_bf16 v[184:187], v[112:115], a[156:159], v[184:187]
    s_add_u32 s19, s19, s20
    v_fmac_f32 v161, v182, v182
    v_fmac_f32 v161, v183, v183
    v_mfma_f32_16x16x32_bf16 v[184:187], v[132:135], a[160:163], v[184:187]
    v_cvt_pk_bf16_f32 v38, v161, v160
    v_mul_f32 v211, v162, v211
    v_mfma_f32_16x16x32_bf16 v[184:187], v[136:139], a[164:167], v[184:187]
    s_waitcnt lgkmcnt(5)
    buffer_store_dwordx2 v[232:233], v20, s[12:15], s27 offen
    v_cvt_pk_bf16_f32 v119, v210, v211
    v_mul_f32 v228, v162, v228
    v_mfma_f32_16x16x16_bf16 v[208:211], v[32:33], v[38:39], 0
    s_waitcnt lgkmcnt(2)
    v_mul_f32 v229, v162, v229
    v_cvt_pk_bf16_f32 v228, v228, v229
    v_mfma_f32_16x16x32_bf16 v[232:235], v[220:223], v[188:191], v[22:25]
    s_waitcnt lgkmcnt(1)
    v_cvt_pk_bf16_f32 v168, v184, v185
    v_cvt_pk_bf16_f32 v169, v186, v187
    v_mfma_f32_16x16x32_bf16 v[232:235], v[156:159], v[176:179], v[232:235]
    s_waitcnt lgkmcnt(0)
    v_rsq_f32 v209, v209
    v_mfma_f32_16x16x32_bf16 v[232:235], v[164:167], v[152:155], v[232:235]
    v_rsq_f32 v208, v208
    v_mfma_f32_16x16x32_bf16 v[184:187], v[148:151], a[168:171], 0
    v_mul_f32 v208, s31, v208
    v_mul_f32 v216, v209, v216
    v_mfma_f32_16x16x32_bf16 v[184:187], v[200:203], a[172:175], v[184:187]
    v_mul_f32 v217, v209, v217
    v_cvt_pk_bf16_f32 v216, v216, v217
    v_mfma_f32_16x16x32_bf16 v[184:187], v[124:127], a[176:179], v[184:187]
    v_mov_b32_dpp v163, v233 quad_perm:[0,1,2,3] row_mask:0x1 bank_mask:0xf
    v_mul_f32 v218, v209, v218
    v_mfma_f32_16x16x32_bf16 v[184:187], v[112:115], a[180:183], v[184:187]
    v_mul_f32 v219, v209, v219
    v_cvt_pk_bf16_f32 v217, v218, v219
    v_mfma_f32_16x16x32_bf16 v[184:187], v[132:135], a[184:187], v[184:187]
    v_mul_f32 v140, v209, v140
    v_mul_f32 v141, v209, v141
    v_mfma_f32_16x16x32_bf16 v[184:187], v[136:139], a[188:191], v[184:187]
    v_cvt_pk_bf16_f32 v218, v140, v141
    v_mul_f32 v142, v209, v142
    v_mfma_f32_16x16x32_bf16 v[204:207], v[148:151], a[192:195], 0
    v_mul_f32 v143, v209, v143
    v_cvt_pk_bf16_f32 v219, v142, v143
    v_mfma_f32_16x16x32_bf16 v[204:207], v[200:203], a[196:199], v[204:207]
    v_mul_f32 v244, v209, v244
    v_mul_f32 v245, v209, v245
    v_mfma_f32_16x16x32_bf16 v[204:207], v[124:127], a[200:203], v[204:207]
    ds_read_b128 v[148:151], v2 offset:0
    v_cvt_pk_bf16_f32 v172, v184, v185
    v_mfma_f32_16x16x32_bf16 v[204:207], v[112:115], a[204:207], v[204:207]
    ds_read_b128 v[200:203], v2 offset:1024
    v_cvt_pk_bf16_f32 v173, v186, v187
    v_mfma_f32_16x16x32_bf16 v[204:207], v[132:135], a[208:211], v[204:207]
    ds_read_b128 v[124:127], v2 offset:2048
    v_cvt_pk_bf16_f32 v114, v244, v245
    v_mfma_f32_16x16x32_bf16 v[204:207], v[136:139], a[212:215], v[204:207]
    ds_read_b128 v[132:135], v2 offset:3072
    ds_read_b128 v[136:139], v2 offset:4096
    v_mfma_f32_16x16x32_bf16 v[184:187], v[176:179], v[188:191], v[40:43]
    ds_read_b128 v[236:239], v2 offset:5120
    buffer_store_dwordx4 v[116:119], v16, s[12:15], s27 offen
    v_mul_f32 v246, v209, v246
    v_mul_f32 v247, v209, v247
    v_cvt_pk_bf16_f32 v115, v246, v247
    v_cvt_pk_bf16_f32 v196, v204, v205
    v_mfma_f32_16x16x32_bf16 v[248:251], v[224:227], v[188:191], v[44:47]
    v_cvt_pk_bf16_f32 v197, v206, v207
    v_mul_f32 v120, v208, v120
    v_mfma_f32_16x16x32_bf16 v[204:207], v[216:219], v[188:191], v[48:51]
    v_mul_f32 v121, v208, v121
    v_cvt_pk_bf16_f32 v120, v120, v121
    v_mfma_f32_16x16x16_bf16 v[184:187], v[154:155], v[152:153], v[184:187]
    s_waitcnt lgkmcnt(5)
    v_mul_f32 v122, v208, v122
    v_mul_f32 v123, v208, v123
    v_mfma_f32_16x16x16_bf16 v[248:251], v[214:215], v[152:153], v[248:251]
    s_waitcnt lgkmcnt(4)
    v_cvt_pk_bf16_f32 v121, v122, v123
    v_mul_f32 v144, v208, v144
    v_mfma_f32_16x16x16_bf16 v[204:207], v[114:115], v[152:153], v[204:207]
    s_waitcnt lgkmcnt(3)
    v_mul_f32 v145, v208, v145
    v_cvt_pk_bf16_f32 v122, v144, v145
    v_mfma_f32_16x16x32_bf16 v[252:255], v[220:223], v[240:243], v[24:27]
    s_waitcnt lgkmcnt(1)
    v_mul_f32 v146, v208, v146
    v_mul_f32 v147, v208, v147
    v_mfma_f32_16x16x32_bf16 v[252:255], v[156:159], v[224:227], v[252:255]
    s_waitcnt lgkmcnt(0)
    v_cvt_pk_bf16_f32 v123, v146, v147
    v_mul_f32 v180, v208, v180
    v_mfma_f32_16x16x32_bf16 v[252:255], v[164:167], v[212:215], v[252:255]
    v_mul_f32 v181, v208, v181
    v_cvt_pk_bf16_f32 v112, v180, v181
    v_mfma_f32_16x16x32_bf16 v[144:147], v[220:223], v[120:123], v[26:29]
    v_mul_f32 v182, v208, v182
    v_mul_f32 v183, v208, v183
    v_mfma_f32_16x16x32_bf16 v[144:147], v[156:159], v[216:219], v[144:147]
    v_cvt_pk_bf16_f32 v113, v182, v183
    v_max3_f32 v152, v232, v184, v185
    v_mfma_f32_16x16x32_bf16 v[140:143], a[216:219], v[148:151], 0
    v_max3_f32 v152, v152, v186, v187
    v_max3_f32 v152, v152, v248, v249
    v_mfma_f32_16x16x32_bf16 v[144:147], v[164:167], v[112:115], v[144:147]
    v_max3_f32 v152, v152, v250, v251
    v_max3_f32 v152, v152, v204, v205
    v_mfma_f32_16x16x32_bf16 v[140:143], a[220:223], v[200:203], v[140:143]
    v_max3_f32 v152, v152, v206, v207
    v_mov_b32 v153, v152
    v_mfma_f32_16x16x32_bf16 v[140:143], a[224:227], v[124:127], v[140:143]
    v_mov_b32_dpp v163, v253 quad_perm:[0,1,2,3] row_mask:0x2 bank_mask:0xf
    v_mul_f32 v230, v162, v230
    v_mfma_f32_16x16x32_bf16 v[140:143], a[228:231], v[132:135], v[140:143]
    v_mov_b32_dpp v163, v145 quad_perm:[0,1,2,3] row_mask:0x4 bank_mask:0xf
    v_mul_f32 v231, v162, v231
    v_mfma_f32_16x16x32_bf16 v[140:143], a[232:235], v[136:139], v[140:143]
    v_permlane32_swap_b32 v152, v153
    v_mfma_f32_16x16x32_bf16 v[140:143], a[236:239], v[236:239], v[140:143]
    v_max_f32 v152, v152, v153
    v_mov_b32 v153, v152
    v_mfma_f32_16x16x32_bf16 v[188:191], a[240:243], v[148:151], 0
    v_cvt_pk_bf16_f32 v229, v230, v231
    v_mov_b32 v145, v163
    v_mfma_f32_16x16x32_bf16 v[188:191], a[244:247], v[200:203], v[188:191]
    buffer_store_dwordx2 v[228:229], v19, s[12:15], s27 offen
    v_permlane16_swap_b32 v152, v153
    v_mfma_f32_16x16x32_bf16 v[188:191], a[248:251], v[124:127], v[188:191]
    s_mov_b32 s27, s26
    v_max_f32 v152, v152, v153
    v_sub_f32 v184, v184, v152
    v_mfma_f32_16x16x32_bf16 v[188:191], a[252:255], v[132:135], v[188:191]
    s_mov_b32 s26, s25
    ds_read_b128 v[180:183], v2 offset:6144
    v_sub_f32 v185, v185, v152
    v_mfma_f32_16x16x32_bf16 v[188:191], v[76:79], v[136:139], v[188:191]
    s_mov_b32 s25, s24
    ds_read_b128 v[220:223], v2 offset:7168
    v_sub_f32 v186, v186, v152
    v_mfma_f32_16x16x32_bf16 v[188:191], v[80:83], v[236:239], v[188:191]
    s_mov_b32 s24, s23
    ds_read_b128 v[156:159], v2 offset:8192
    v_sub_f32 v187, v187, v152
    v_mfma_f32_16x16x32_bf16 v[244:247], v[84:87], v[148:151], 0
    ds_read_b128 v[148:151], v2 offset:9216
    v_sub_f32 v248, v248, v152
    v_mfma_f32_16x16x32_bf16 v[244:247], v[88:91], v[200:203], v[244:247]
    ds_read_b128 v[200:203], v2 offset:10240
    v_sub_f32 v249, v249, v152
    v_mfma_f32_16x16x32_bf16 v[244:247], v[92:95], v[124:127], v[244:247]
    ds_read_b128 v[124:127], v2 offset:11264
    v_sub_f32 v250, v250, v152
    v_mfma_f32_16x16x32_bf16 v[244:247], v[96:99], v[132:135], v[244:247]
    v_exp_f32 v184, v184
    v_mfma_f32_16x16x32_bf16 v[244:247], v[100:103], v[136:139], v[244:247]
    v_exp_f32 v185, v185
    v_mfma_f32_16x16x32_bf16 v[244:247], v[104:107], v[236:239], v[244:247]
    s_waitcnt lgkmcnt(5)
    v_cvt_pk_bf16_f32 v136, v184, v185
    v_sub_f32 v251, v251, v152
    v_mfma_f32_16x16x32_bf16 v[116:119], a[216:219], v[180:183], 0
    s_waitcnt lgkmcnt(4)
    v_exp_f32 v186, v186
    v_mfma_f32_16x16x32_bf16 v[116:119], a[220:223], v[220:223], v[116:119]
    s_waitcnt lgkmcnt(3)
    v_exp_f32 v187, v187
    v_mfma_f32_16x16x32_bf16 v[116:119], a[224:227], v[156:159], v[116:119]
    s_waitcnt lgkmcnt(2)
    v_cvt_pk_bf16_f32 v137, v186, v187
    v_sub_f32 v204, v204, v152
    v_mfma_f32_16x16x32_bf16 v[116:119], a[228:231], v[148:151], v[116:119]
    s_waitcnt lgkmcnt(1)
    v_exp_f32 v248, v248
    v_mfma_f32_16x16x32_bf16 v[132:135], v[176:179], v[240:243], v[52:55]
    s_waitcnt lgkmcnt(0)
    v_exp_f32 v249, v249
    v_mfma_f32_16x16x32_bf16 v[164:167], v[224:227], v[240:243], v[56:59]
    v_cvt_pk_bf16_f32 v138, v248, v249
    v_sub_f32 v205, v205, v152
    v_mfma_f32_16x16x32_bf16 v[184:187], v[216:219], v[240:243], v[60:63]
    buffer_load_dwordx4 v14, s[8:11], s23 offen nt lds
    v_sub_f32 v206, v206, v152
    v_mfma_f32_16x16x16_bf16 v[132:135], v[154:155], v[212:213], v[132:135]
    s_add_u32 s23, s23, s21
    v_exp_f32 v250, v250
    v_mfma_f32_16x16x16_bf16 v[164:167], v[214:215], v[212:213], v[164:167]
    s_cmp_ge_u32 s19, 72
    v_exp_f32 v251, v251
    v_mfma_f32_16x16x16_bf16 v[184:187], v[114:115], v[212:213], v[184:187]
    s_cselect_b32 s34, 72, 0
    v_cvt_pk_bf16_f32 v139, v250, v251
    v_sub_f32 v207, v207, v152
    v_mfma_f32_16x16x32_bf16 v[116:119], a[232:235], v[200:203], v[116:119]
    s_cselect_b32 s35, s22, 0
    v_exp_f32 v204, v204
    v_mfma_f32_16x16x32_bf16 v[116:119], a[236:239], v[124:127], v[116:119]
    s_sub_u32 s19, s19, s34
    v_exp_f32 v205, v205
    v_mfma_f32_16x16x32_bf16 v[208:211], a[240:243], v[180:183], 0
    s_add_u32 s23, s23, s35
    v_cvt_pk_bf16_f32 v36, v204, v205
    v_sub_f32 v232, v232, v152
    v_mfma_f32_16x16x32_bf16 v[208:211], a[244:247], v[220:223], v[208:211]
    s_add_u32 s18, s18, 1
    v_exp_f32 v206, v206
    v_mfma_f32_16x16x32_bf16 v[208:211], a[248:251], v[156:159], v[208:211]
    s_cmp_lt_u32 s18, s17
    v_exp_f32 v207, v207
    v_mfma_f32_16x16x32_bf16 v[208:211], a[252:255], v[148:151], v[208:211]
    ds_read_b128 v[240:243], v2 offset:12288
    v_cvt_pk_bf16_f32 v37, v206, v207
    v_mfma_f32_16x16x32_bf16 v[208:211], v[76:79], v[200:203], v[208:211]
    ds_read_b128 v[204:207], v2 offset:13312
    v_max3_f32 v146, v252, v132, v133
    v_mfma_f32_16x16x32_bf16 v[208:211], v[80:83], v[124:127], v[208:211]
    ds_read_b128 v[248:251], v2 offset:14336
    v_max3_f32 v146, v146, v134, v135
    v_mfma_f32_16x16x32_bf16 v[228:231], v[84:87], v[180:183], 0
    ds_read_b128 v[180:183], v2 offset:15360
    v_max3_f32 v146, v146, v164, v165
    v_mfma_f32_16x16x32_bf16 v[228:231], v[88:91], v[220:223], v[228:231]
    ds_read_b128 v[220:223], v2 offset:16384
    v_max3_f32 v146, v146, v166, v167
    v_mfma_f32_16x16x32_bf16 v[228:231], v[92:95], v[156:159], v[228:231]
    ds_read_b128 v[156:159], v2 offset:17408
    v_max3_f32 v146, v146, v184, v185
    v_mfma_f32_16x16x32_bf16 v[228:231], v[96:99], v[148:151], v[228:231]
    v_exp_f32 v232, v232
    v_mfma_f32_16x16x32_bf16 v[228:231], v[100:103], v[200:203], v[228:231]
    v_cvt_pk_bf16_f32 v38, v232, 0
    v_max3_f32 v146, v146, v186, v187
    v_mfma_f32_16x16x32_bf16 v[228:231], v[104:107], v[124:127], v[228:231]
    s_waitcnt lgkmcnt(5)
    v_mov_b32 v147, v146
    v_max_f32_dpp v145, v145, v145 quad_perm:[1,0,3,2] row_mask:0xf bank_mask:0xf
    v_mfma_f32_16x16x32_bf16 v[232:235], v[28:31], v[36:39], 0
    s_waitcnt lgkmcnt(4)
    v_permlane32_swap_b32 v146, v147
    v_mfma_f32_16x16x32_bf16 v[232:235], v[28:31], v[136:139], v[232:235]
    s_waitcnt lgkmcnt(3)
    v_max_f32 v146, v146, v147
    v_mov_b32 v147, v146
    v_mfma_f32_16x16x32_bf16 v[200:203], v[168:171], v[36:39], 0
    s_waitcnt lgkmcnt(2)
    v_permlane16_swap_b32 v146, v147
    v_mfma_f32_16x16x32_bf16 v[200:203], v[128:131], v[136:139], v[200:203]
    s_waitcnt lgkmcnt(1)
    v_rcp_f32 v232, v232
    v_mfma_f32_16x16x32_bf16 v[124:127], v[172:175], v[36:39], 0
    s_waitcnt lgkmcnt(0)
    v_max_f32 v146, v146, v147
    v_sub_f32 v132, v132, v146
    v_mfma_f32_16x16x32_bf16 v[124:127], v[108:111], v[136:139], v[124:127]
    v_exp_f32 v132, v132
    v_mfma_f32_16x16x32_bf16 v[236:239], v[196:199], v[36:39], 0
    v_mul_f32 v200, v232, v200
    v_mul_f32 v201, v232, v201
    v_mfma_f32_16x16x32_bf16 v[236:239], v[192:195], v[136:139], v[236:239]
    v_cvt_pk_bf16_f32 v200, v200, v201
    v_mul_f32 v202, v232, v202
    v_mfma_f32_16x16x32_bf16 v[148:151], a[216:219], v[240:243], 0
    v_mul_f32 v203, v232, v203
    v_cvt_pk_bf16_f32 v201, v202, v203
    v_mfma_f32_16x16x32_bf16 v[148:151], a[220:223], v[204:207], v[148:151]
    v_mul_f32 v124, v232, v124
    v_mul_f32 v125, v232, v125
    v_mfma_f32_16x16x32_bf16 v[148:151], a[224:227], v[248:251], v[148:151]
    v_cvt_pk_bf16_f32 v202, v124, v125
    v_mul_f32 v126, v232, v126
    v_mfma_f32_16x16x32_bf16 v[148:151], a[228:231], v[180:183], v[148:151]
    v_mul_f32 v127, v232, v127
    v_cvt_pk_bf16_f32 v203, v126, v127
    v_mfma_f32_16x16x32_bf16 v[148:151], a[232:235], v[220:223], v[148:151]
    ds_write_b128 v3, v[200:203] offset:0
    v_mfma_f32_16x16x32_bf16 v[148:151], a[236:239], v[156:159], v[148:151]
    v_mul_f32 v236, v232, v236
    v_mul_f32 v237, v232, v237
    v_mfma_f32_16x16x32_bf16 v[200:203], a[240:243], v[240:243], 0
    v_cvt_pk_bf16_f32 v152, v236, v237
    v_mul_f32 v238, v232, v238
    v_mfma_f32_16x16x32_bf16 v[200:203], a[244:247], v[204:207], v[200:203]
    v_mul_f32 v239, v232, v239
    v_cvt_pk_bf16_f32 v153, v238, v239
    v_mfma_f32_16x16x32_bf16 v[200:203], a[248:251], v[248:251], v[200:203]
    ds_write_b64 v4, v[152:153] offset:4096
    v_mfma_f32_16x16x32_bf16 v[200:203], a[252:255], v[180:183], v[200:203]
    v_fma_f32 v147, v148, v148, s33
    v_fmac_f32 v147, v149, v149
    v_mfma_f32_16x16x32_bf16 v[200:203], v[76:79], v[220:223], v[200:203]
    v_fmac_f32 v147, v150, v150
    v_fmac_f32 v147, v151, v151
    v_mfma_f32_16x16x32_bf16 v[200:203], v[80:83], v[156:159], v[200:203]
    v_sub_f32 v133, v133, v146
    v_sub_f32 v134, v134, v146
    v_mfma_f32_16x16x32_bf16 v[232:235], v[84:87], v[240:243], 0
    v_exp_f32 v133, v133
    v_mfma_f32_16x16x32_bf16 v[232:235], v[88:91], v[204:207], v[232:235]
    v_cvt_pk_bf16_f32 v240, v132, v133
    v_sub_f32 v135, v135, v146
    v_mfma_f32_16x16x32_bf16 v[232:235], v[92:95], v[248:251], v[232:235]
    v_fmac_f32 v147, v200, v200
    v_fmac_f32 v147, v201, v201
    v_mfma_f32_16x16x32_bf16 v[232:235], v[96:99], v[180:183], v[232:235]
    v_fmac_f32 v147, v202, v202
    v_fmac_f32 v147, v203, v203
    v_mfma_f32_16x16x32_bf16 v[232:235], v[100:103], v[220:223], v[232:235]
    v_exp_f32 v134, v134
    v_mfma_f32_16x16x32_bf16 v[232:235], v[104:107], v[156:159], v[232:235]
    v_exp_f32 v135, v135
    v_sub_f32 v164, v164, v146
    v_cvt_pk_bf16_f32 v241, v134, v135
    v_exp_f32 v164, v164
    v_sub_f32 v165, v165, v146
    v_exp_f32 v165, v165
    v_sub_f32 v166, v166, v146
    v_cvt_pk_bf16_f32 v242, v164, v165
    v_fmac_f32 v147, v232, v232
    v_fmac_f32 v147, v233, v233
    v_fmac_f32 v147, v234, v234
    v_fmac_f32 v147, v235, v235
    v_cvt_pk_bf16_f32 v161, v147, v147
    v_exp_f32 v166, v166
    v_sub_f32 v167, v167, v146
    v_exp_f32 v167, v167
    v_sub_f32 v184, v184, v146
    v_cvt_pk_bf16_f32 v243, v166, v167
    v_exp_f32 v184, v184
    v_sub_f32 v185, v185, v146
    v_exp_f32 v185, v185
    v_sub_f32 v186, v186, v146
    v_cvt_pk_bf16_f32 v36, v184, v185
    v_exp_f32 v186, v186
    v_sub_f32 v187, v187, v146
    v_exp_f32 v187, v187
    v_mfma_f32_16x16x32_bf16 v[132:135], v[176:179], v[120:123], v[64:67]
    v_cvt_pk_bf16_f32 v37, v186, v187
    v_sub_f32 v252, v252, v146
    v_mfma_f32_16x16x32_bf16 v[176:179], v[224:227], v[120:123], v[68:71]
    v_exp_f32 v252, v252
    v_mfma_f32_16x16x32_bf16 v[224:227], v[216:219], v[120:123], v[72:75]
    v_cvt_pk_bf16_f32 v38, v252, 0
    v_max_f32_dpp v145, v145, v145 quad_perm:[2,3,0,1] row_mask:0xf bank_mask:0xf
    v_mfma_f32_16x16x16_bf16 v[132:135], v[154:155], v[112:113], v[132:135]
    v_fma_f32 v160, v116, v116, s33
    v_max_f32_dpp v145, v145, v145 row_half_mirror row_mask:0xf bank_mask:0xf
    v_mfma_f32_16x16x16_bf16 v[176:179], v[214:215], v[112:113], v[176:179]
    v_fmac_f32 v160, v117, v117
    v_max_f32_dpp v145, v145, v145 row_mirror row_mask:0xf bank_mask:0xf
    v_mfma_f32_16x16x16_bf16 v[224:227], v[114:115], v[112:113], v[224:227]
    v_mov_b32 v162, v145
    v_fmac_f32 v160, v118, v118
    v_mfma_f32_16x16x32_bf16 v[152:155], v[28:31], v[36:39], 0
    v_permlane32_swap_b32 v145, v162
    v_mfma_f32_16x16x32_bf16 v[152:155], v[28:31], v[240:243], v[152:155]
    v_max_f32 v145, v145, v162
    v_mov_b32 v162, v145
    v_mfma_f32_16x16x32_bf16 v[112:115], v[168:171], v[36:39], 0
    v_max3_f32 v146, v144, v132, v133
    v_max3_f32 v146, v146, v134, v135
    v_mfma_f32_16x16x32_bf16 v[112:115], v[128:131], v[240:243], v[112:115]
    v_permlane16_swap_b32 v145, v162
    v_mfma_f32_16x16x32_bf16 v[124:127], v[172:175], v[36:39], 0
    v_max_f32 v145, v145, v162
    v_sub_f32 v163, v163, v145
    v_mfma_f32_16x16x32_bf16 v[124:127], v[108:111], v[240:243], v[124:127]
    v_exp_f32 v163, v163
    v_mfma_f32_16x16x32_bf16 v[136:139], v[196:199], v[36:39], 0
    v_cvt_pk_bf16_f32 v163, v163, v163
    v_max3_f32 v146, v146, v176, v177
    v_mfma_f32_16x16x32_bf16 v[136:139], v[192:195], v[240:243], v[136:139]
    ds_write_b16 v8, v163
    v_max3_f32 v146, v146, v178, v179
    v_max3_f32 v146, v146, v224, v225
    v_max3_f32 v146, v146, v226, v227
    v_mov_b32 v145, v146
    v_fmac_f32 v160, v119, v119
    v_fmac_f32 v160, v208, v208
    v_permlane32_swap_b32 v146, v145
    v_max_f32 v146, v146, v145
    v_mov_b32 v145, v146
    v_fmac_f32 v160, v209, v209
    v_fmac_f32 v160, v210, v210
    v_permlane16_swap_b32 v146, v145
    v_max_f32 v146, v146, v145
    v_sub_f32 v132, v132, v146
    v_exp_f32 v132, v132
    v_sub_f32 v133, v133, v146
    v_exp_f32 v133, v133
    v_sub_f32 v134, v134, v146
    v_cvt_pk_bf16_f32 v132, v132, v133
    v_exp_f32 v134, v134
    v_sub_f32 v135, v135, v146
    v_exp_f32 v135, v135
    v_sub_f32 v176, v176, v146
    v_cvt_pk_bf16_f32 v133, v134, v135
    v_exp_f32 v176, v176
    v_sub_f32 v177, v177, v146
    v_exp_f32 v177, v177
    v_sub_f32 v178, v178, v146
    v_cvt_pk_bf16_f32 v134, v176, v177
    v_exp_f32 v178, v178
    v_sub_f32 v179, v179, v146
    v_exp_f32 v179, v179
    v_sub_f32 v224, v224, v146
    v_cvt_pk_bf16_f32 v135, v178, v179
    v_exp_f32 v224, v224
    v_sub_f32 v225, v225, v146
    v_exp_f32 v225, v225
    v_sub_f32 v226, v226, v146
    v_cvt_pk_bf16_f32 v36, v224, v225
    v_exp_f32 v226, v226
    v_sub_f32 v227, v227, v146
    v_exp_f32 v227, v227
    v_sub_f32 v144, v144, v146
    v_cvt_pk_bf16_f32 v37, v226, v227
    v_exp_f32 v144, v144
    v_fmac_f32 v160, v211, v211
    v_cvt_pk_bf16_f32 v38, v144, 0
    v_fmac_f32 v160, v228, v228
    v_fmac_f32 v160, v229, v229
    v_mfma_f32_16x16x32_bf16 v[180:183], v[28:31], v[36:39], 0
    ds_read_b128 v[144:147], v9
    ds_read_b128 v[220:223], v9 offset:64
    v_mfma_f32_16x16x32_bf16 v[180:183], v[28:31], v[132:135], v[180:183]
    v_fmac_f32 v160, v230, v230
    v_fmac_f32 v160, v231, v231
    v_mfma_f32_16x16x32_bf16 v[156:159], v[168:171], v[36:39], 0
    v_xor_b32 v0, 65536, v0
    v_xor_b32 v1, 65536, v1
    v_mfma_f32_16x16x32_bf16 v[156:159], v[128:131], v[132:135], v[156:159]
    ds_read_b128 v[212:215], v0 offset:20480
    ds_read_b128 v[176:179], v1 offset:20480
    v_mfma_f32_16x16x32_bf16 v[164:167], v[172:175], v[36:39], 0
    ds_read_b128 v[216:219], v0 offset:20608
    ds_read_b128 v[120:123], v1 offset:20608
    v_mfma_f32_16x16x32_bf16 v[164:167], v[108:111], v[132:135], v[164:167]
    ds_read_b128 v[240:243], v0 offset:20736
    ds_read_b128 v[224:227], v1 offset:20736
    v_mfma_f32_16x16x32_bf16 v[184:187], v[196:199], v[36:39], 0
    v_rcp_f32 v152, v152
    v_mfma_f32_16x16x32_bf16 v[184:187], v[192:195], v[132:135], v[184:187]
    v_mul_f32 v112, v152, v112
    v_mul_f32 v113, v152, v113
    s_waitcnt lgkmcnt(6)
    v_mfma_f32_16x16x32_bf16 v[132:135], v[144:147], v[28:31], 0
    v_cvt_pk_bf16_f32 v112, v112, v113
    v_mul_f32 v114, v152, v114
    v_mfma_f32_16x16x32_bf16 v[132:135], v[220:223], v[28:31], v[132:135]
    v_mul_f32 v115, v152, v115
    v_cvt_pk_bf16_f32 v113, v114, v115
    v_mfma_f32_16x16x32_bf16 v[204:207], v[144:147], v[128:131], 0
    s_waitcnt lgkmcnt(5)
    v_mul_f32 v124, v152, v124
    v_mul_f32 v125, v152, v125
    v_mfma_f32_16x16x32_bf16 v[204:207], v[220:223], v[168:171], v[204:207]
    s_waitcnt lgkmcnt(3)
    v_rcp_f32 v132, v132
    v_mfma_f32_16x16x32_bf16 v[128:131], v[144:147], v[108:111], 0
    s_waitcnt lgkmcnt(1)
    v_cvt_pk_bf16_f32 v114, v124, v125
    v_mul_f32 v126, v152, v126
    v_mfma_f32_16x16x32_bf16 v[128:131], v[220:223], v[172:175], v[128:131]
    s_waitcnt lgkmcnt(0)
    v_mul_f32 v204, v204, v132
    v_mul_f32 v127, v152, v127
    v_mfma_f32_16x16x32_bf16 v[108:111], v[144:147], v[192:195], 0
    v_cvt_pk_bf16_f32 v115, v126, v127
    v_mul_f32 v136, v152, v136
    v_mfma_f32_16x16x32_bf16 v[108:111], v[220:223], v[196:199], v[108:111]
    ds_write_b128 v3, v[112:115] offset:6144
    v_mfma_f32_16x16x32_bf16 v[192:195], a[72:75], v[212:215], 0
    v_mul_f32_dpp v204, v128, v132 quad_perm:[0,1,2,3] row_mask:0x2 bank_mask:0xf
    v_mul_f32 v137, v152, v137
    v_mfma_f32_16x16x32_bf16 v[192:195], a[76:79], v[176:179], v[192:195]
    v_cvt_pk_bf16_f32 v162, v136, v137
    v_mul_f32 v138, v152, v138
    v_mfma_f32_16x16x32_bf16 v[192:195], a[80:83], v[216:219], v[192:195]
    v_mul_f32_dpp v204, v108, v132 quad_perm:[0,1,2,3] row_mask:0x4 bank_mask:0xf
    v_cvt_pk_bf16_f32 v204, v204, v204
    v_mfma_f32_16x16x32_bf16 v[192:195], a[84:87], v[120:123], v[192:195]
    ds_write_b16 v7, v204
    v_mfma_f32_16x16x32_bf16 v[192:195], a[88:91], v[240:243], v[192:195]
    v_mul_f32 v139, v152, v139
    v_cvt_pk_bf16_f32 v163, v138, v139
    v_mfma_f32_16x16x32_bf16 v[192:195], a[92:95], v[224:227], v[192:195]
    ds_write_b64 v4, v[162:163] offset:10240
    v_mfma_f32_16x16x32_bf16 v[152:155], a[96:99], v[212:215], 0
    v_rcp_f32 v180, v180
    v_mfma_f32_16x16x32_bf16 v[152:155], a[100:103], v[176:179], v[152:155]
    v_mul_f32 v156, v180, v156
    v_mul_f32 v157, v180, v157
    v_mfma_f32_16x16x32_bf16 v[152:155], a[104:107], v[216:219], v[152:155]
    v_cvt_pk_bf16_f32 v128, v156, v157
    v_mul_f32 v158, v180, v158
    v_mfma_f32_16x16x32_bf16 v[152:155], a[108:111], v[120:123], v[152:155]
    v_mul_f32 v159, v180, v159
    v_cvt_pk_bf16_f32 v129, v158, v159
    v_mfma_f32_16x16x32_bf16 v[152:155], a[112:115], v[240:243], v[152:155]
    v_mul_f32 v164, v180, v164
    v_mul_f32 v165, v180, v165
    v_mfma_f32_16x16x32_bf16 v[152:155], a[116:119], v[224:227], v[152:155]
    v_cvt_pk_bf16_f32 v130, v164, v165
    v_mul_f32 v166, v180, v166
    v_mfma_f32_16x16x32_bf16 v[144:147], a[120:123], v[212:215], 0
    v_mul_f32 v167, v180, v167
    v_cvt_pk_bf16_f32 v131, v166, v167
    v_mfma_f32_16x16x32_bf16 v[144:147], a[124:127], v[176:179], v[144:147]
    ds_write_b128 v3, v[128:131] offset:12288
    v_mfma_f32_16x16x32_bf16 v[144:147], a[128:131], v[216:219], v[144:147]
    v_mul_f32 v184, v180, v184
    v_mul_f32 v185, v180, v185
    v_mfma_f32_16x16x32_bf16 v[144:147], a[132:135], v[120:123], v[144:147]
    v_cvt_pk_bf16_f32 v162, v184, v185
    v_mul_f32 v186, v180, v186
    v_mfma_f32_16x16x32_bf16 v[144:147], a[136:139], v[240:243], v[144:147]
    v_mul_f32 v187, v180, v187
    v_cvt_pk_bf16_f32 v163, v186, v187
    v_mfma_f32_16x16x32_bf16 v[144:147], a[140:143], v[224:227], v[144:147]
    ds_write_b64 v4, v[162:163] offset:16384
    v_mfma_f32_16x16x32_bf16 v[124:127], a[0:3], v[212:215], 0
    v_fma_f32 v162, v140, v140, s33
    v_fmac_f32 v162, v141, v141
    v_mfma_f32_16x16x32_bf16 v[124:127], a[4:7], v[176:179], v[124:127]
    v_fmac_f32 v162, v142, v142
    v_fmac_f32 v162, v143, v143
    v_mfma_f32_16x16x32_bf16 v[124:127], a[8:11], v[216:219], v[124:127]
    v_fmac_f32 v162, v188, v188
    v_fmac_f32 v162, v189, v189
    v_mfma_f32_16x16x32_bf16 v[124:127], a[12:15], v[120:123], v[124:127]
    v_fmac_f32 v162, v190, v190
    v_fmac_f32 v162, v191, v191
    v_mfma_f32_16x16x32_bf16 v[124:127], a[16:19], v[240:243], v[124:127]
    v_fmac_f32 v162, v244, v244
    v_fmac_f32 v162, v245, v245
    v_mfma_f32_16x16x32_bf16 v[124:127], a[20:23], v[224:227], v[124:127]
    v_fmac_f32 v162, v246, v246
    v_fmac_f32 v162, v247, v247
    v_mfma_f32_16x16x32_bf16 v[180:183], a[24:27], v[212:215], 0
    v_cvt_pk_bf16_f32 v160, v162, v160
    v_fma_f32 v162, v192, v192, s32
    v_mfma_f32_16x16x32_bf16 v[180:183], a[28:31], v[176:179], v[180:183]
    ds_write_b64 v4, v[160:161] offset:18432
    v_mfma_f32_16x16x32_bf16 v[180:183], a[32:35], v[216:219], v[180:183]
    v_fmac_f32 v162, v193, v193
    v_fmac_f32 v162, v194, v194
    v_mfma_f32_16x16x32_bf16 v[180:183], a[36:39], v[120:123], v[180:183]
    v_fmac_f32 v162, v195, v195
    v_fmac_f32 v162, v152, v152
    v_mfma_f32_16x16x32_bf16 v[180:183], a[40:43], v[240:243], v[180:183]
    v_fmac_f32 v162, v153, v153
    v_fmac_f32 v162, v154, v154
    v_mfma_f32_16x16x32_bf16 v[180:183], a[44:47], v[224:227], v[180:183]
    v_fmac_f32 v162, v155, v155
    v_fmac_f32 v162, v144, v144
    v_mfma_f32_16x16x32_bf16 v[220:223], a[48:51], v[212:215], 0
    v_fmac_f32 v162, v145, v145
    v_fmac_f32 v162, v146, v146
    v_mfma_f32_16x16x32_bf16 v[220:223], a[52:55], v[176:179], v[220:223]
    v_fmac_f32 v162, v147, v147
    v_fma_f32 v160, v124, v124, s32
    v_mfma_f32_16x16x32_bf16 v[220:223], a[56:59], v[216:219], v[220:223]
    s_waitcnt lgkmcnt(0)
    v_fmac_f32 v160, v125, v125
    v_fmac_f32 v160, v126, v126
    v_mfma_f32_16x16x32_bf16 v[220:223], a[60:63], v[120:123], v[220:223]
    s_nop 0
    v_fmac_f32 v160, v127, v127
    v_fmac_f32 v160, v180, v180
    v_mfma_f32_16x16x32_bf16 v[220:223], a[64:67], v[240:243], v[220:223]
    s_barrier
    v_fmac_f32 v160, v181, v181
    v_fmac_f32 v160, v182, v182
    v_mfma_f32_16x16x32_bf16 v[220:223], a[68:71], v[224:227], v[220:223]
    s_nop 0
    v_fmac_f32 v160, v183, v183
    v_add_u32 v5, 336, v5
    v_mfma_f32_16x16x32_bf16 v[128:131], v[212:215], a[144:147], 0
    s_nop 0
    v_add_u32 v6, 272, v6
    v_add_u32 v7, 16, v7
    v_mfma_f32_16x16x32_bf16 v[128:131], v[176:179], a[148:151], v[128:131]
    v_fmac_f32 v160, v220, v220
    v_fmac_f32 v160, v221, v221
    v_mfma_f32_16x16x32_bf16 v[128:131], v[216:219], a[152:155], v[128:131]
    v_fmac_f32 v160, v222, v222
    v_fmac_f32 v160, v223, v223
    v_mfma_f32_16x16x32_bf16 v[128:131], v[120:123], a[156:159], v[128:131]
    v_cvt_pk_bf16_f32 v38, v160, v162
    v_xor_b32 v2, 65536, v2
    v_mfma_f32_16x16x32_bf16 v[128:131], v[240:243], a[160:163], v[128:131]
    v_xor_b32 v3, 65536, v3
    v_xor_b32 v4, 65536, v4
    v_mfma_f32_16x16x32_bf16 v[128:131], v[224:227], a[164:167], v[128:131]
    s_cbranch_scc1 L_loop_safe1
    s_branch L_drain
.p2align 6
L_loop_safe2:
    v_mfma_f32_16x16x16_bf16 v[160:163], v[32:33], v[38:39], 0
    s_cmp_ge_u32 s18, 2
    ds_read_b128 v[172:175], v2 offset:18432
    ds_read_b128 v[196:199], v2 offset:19456
    v_mfma_f32_16x16x32_bf16 v[108:111], v[212:215], a[168:171], 0
    s_cselect_b32 s14, s36, 0
    s_add_u32 s34, s18, 2
    v_cvt_pk_bf16_f32 v128, v128, v129
    v_mfma_f32_16x16x32_bf16 v[108:111], v[176:179], a[172:175], v[108:111]
    s_cmp_lt_u32 s34, s17
    v_rsq_f32 v161, v161
    v_mfma_f32_16x16x32_bf16 v[108:111], v[216:219], a[176:179], v[108:111]
    s_cselect_b32 s10, s36, 0
    v_rsq_f32 v160, v160
    v_mfma_f32_16x16x32_bf16 v[108:111], v[120:123], a[180:183], v[108:111]
    s_add_u32 m0, s28, 0
    ds_read_b128 v[112:115], v0 offset:26624
    v_mul_f32 v160, s31, v160
    v_mfma_f32_16x16x32_bf16 v[108:111], v[240:243], a[184:187], v[108:111]
    ds_read_b128 v[132:135], v1 offset:26624
    v_cvt_pk_bf16_f32 v129, v130, v131
    v_mfma_f32_16x16x32_bf16 v[108:111], v[224:227], a[188:191], v[108:111]
    ds_read_b128 v[136:139], v0 offset:26752
    v_mul_f32 v192, v161, v192
    v_mfma_f32_16x16x32_bf16 v[164:167], v[212:215], a[192:195], 0
    ds_read_b128 v[212:215], v1 offset:26752
    v_mul_f32 v193, v161, v193
    v_mfma_f32_16x16x32_bf16 v[164:167], v[176:179], a[196:199], v[164:167]
    s_waitcnt lgkmcnt(4)
    ds_read_b128 v[156:159], v0 offset:26880
    v_cvt_pk_bf16_f32 v108, v108, v109
    v_mfma_f32_16x16x32_bf16 v[168:171], v[32:35], v[172:175], 0
    v_cvt_pk_bf16_f32 v109, v110, v111
    v_cvt_pk_bf16_f32 v176, v192, v193
    v_mfma_f32_16x16x32_bf16 v[168:171], v[32:35], v[196:199], v[168:171]
    v_mul_f32 v194, v161, v194
    v_mul_f32 v195, v161, v195
    v_mfma_f32_16x16x32_bf16 v[164:167], v[216:219], a[200:203], v[164:167]
    ds_read_b128 v[216:219], v1 offset:26880
    v_cvt_pk_bf16_f32 v177, v194, v195
    v_mfma_f32_16x16x32_bf16 v[164:167], v[120:123], a[204:207], v[164:167]
    s_waitcnt lgkmcnt(5)
    v_mul_f32 v152, v161, v152
    v_mul_f32 v110, 0x3baaaaab, v168
    v_mfma_f32_16x16x32_bf16 v[164:167], v[240:243], a[208:211], v[164:167]
    s_waitcnt lgkmcnt(4)
    v_rsq_f32 v110, v110
    v_mfma_f32_16x16x32_bf16 v[164:167], v[224:227], a[212:215], v[164:167]
    s_waitcnt lgkmcnt(3)
    v_mul_f32 v162, 0x3baaaaab, v169
    v_mul_f32 v163, 0x3baaaaab, v170
    v_mfma_f32_16x16x32_bf16 v[224:227], a[72:75], v[112:115], 0
    s_waitcnt lgkmcnt(2)
    v_rsq_f32 v162, v162
    v_mfma_f32_16x16x32_bf16 v[224:227], a[76:79], v[132:135], v[224:227]
    s_waitcnt lgkmcnt(1)
    v_cvt_pk_bf16_f32 v192, v164, v165
    v_cvt_pk_bf16_f32 v193, v166, v167
    v_mfma_f32_16x16x32_bf16 v[224:227], a[80:83], v[136:139], v[224:227]
    v_rsq_f32 v163, v163
    v_mfma_f32_16x16x32_bf16 v[224:227], a[84:87], v[212:215], v[224:227]
    v_mul_f32 v140, v110, v140
    v_mul_f32 v141, v110, v141
    v_mfma_f32_16x16x32_bf16 v[224:227], a[88:91], v[156:159], v[224:227]
    s_waitcnt lgkmcnt(0)
    v_cvt_pk_bf16_f32 v140, v140, v141
    v_mul_f32 v142, v110, v142
    v_mfma_f32_16x16x32_bf16 v[224:227], a[92:95], v[216:219], v[224:227]
    v_mul_f32 v143, v110, v143
    v_cvt_pk_bf16_f32 v141, v142, v143
    v_mfma_f32_16x16x32_bf16 v[240:243], a[96:99], v[112:115], 0
    v_mul_f32 v188, v110, v188
    v_mul_f32 v189, v110, v189
    v_mfma_f32_16x16x32_bf16 v[240:243], a[100:103], v[132:135], v[240:243]
    v_cvt_pk_bf16_f32 v142, v188, v189
    v_mul_f32 v190, v110, v190
    v_mfma_f32_16x16x32_bf16 v[240:243], a[104:107], v[136:139], v[240:243]
    v_mul_f32 v191, v110, v191
    v_cvt_pk_bf16_f32 v143, v190, v191
    v_mfma_f32_16x16x32_bf16 v[240:243], a[108:111], v[212:215], v[240:243]
    buffer_store_dwordx4 v[140:143], v15, s[12:15], s27 offen
    v_mul_f32 v244, v110, v244
    v_mul_f32 v245, v110, v245
    v_cvt_pk_bf16_f32 v130, v244, v245
    v_mul_f32 v246, v110, v246
    v_mfma_f32_16x16x32_bf16 v[240:243], a[112:115], v[156:159], v[240:243]
    v_mul_f32 v247, v110, v247
    v_cvt_pk_bf16_f32 v131, v246, v247
    v_mfma_f32_16x16x32_bf16 v[240:243], a[116:119], v[216:219], v[240:243]
    v_mul_f32 v153, v161, v153
    v_cvt_pk_bf16_f32 v178, v152, v153
    v_mfma_f32_16x16x32_bf16 v[140:143], a[120:123], v[112:115], 0
    v_mul_f32 v154, v161, v154
    v_mul_f32 v155, v161, v155
    v_mfma_f32_16x16x32_bf16 v[140:143], a[124:127], v[132:135], v[140:143]
    v_cvt_pk_bf16_f32 v179, v154, v155
    v_mul_f32 v144, v161, v144
    v_mfma_f32_16x16x32_bf16 v[140:143], a[128:131], v[136:139], v[140:143]
    v_mul_f32 v145, v161, v145
    v_cvt_pk_bf16_f32 v154, v144, v145
    v_mfma_f32_16x16x32_bf16 v[140:143], a[132:135], v[212:215], v[140:143]
    v_mul_f32 v146, v161, v146
    v_mul_f32 v147, v161, v147
    v_mfma_f32_16x16x32_bf16 v[140:143], a[136:139], v[156:159], v[140:143]
    v_cvt_pk_bf16_f32 v155, v146, v147
    v_mul_f32 v124, v160, v124
    v_mfma_f32_16x16x32_bf16 v[140:143], a[140:143], v[216:219], v[140:143]
    v_mul_f32 v125, v160, v125
    v_cvt_pk_bf16_f32 v188, v124, v125
    v_mfma_f32_16x16x32_bf16 v[244:247], a[0:3], v[112:115], 0
    v_mul_f32 v126, v160, v126
    v_mul_f32 v127, v160, v127
    v_mfma_f32_16x16x32_bf16 v[244:247], a[4:7], v[132:135], v[244:247]
    v_cvt_pk_bf16_f32 v189, v126, v127
    v_mul_f32 v180, v160, v180
    v_mfma_f32_16x16x32_bf16 v[244:247], a[8:11], v[136:139], v[244:247]
    v_mul_f32 v181, v160, v181
    v_cvt_pk_bf16_f32 v190, v180, v181
    v_mfma_f32_16x16x32_bf16 v[244:247], a[12:15], v[212:215], v[244:247]
    v_mul_f32 v182, v160, v182
    v_mul_f32 v183, v160, v183
    v_mfma_f32_16x16x32_bf16 v[244:247], a[16:19], v[156:159], v[244:247]
    v_cvt_pk_bf16_f32 v191, v182, v183
    v_mul_f32 v220, v160, v220
    v_mfma_f32_16x16x32_bf16 v[244:247], a[20:23], v[216:219], v[244:247]
    v_mul_f32 v221, v160, v221
    v_cvt_pk_bf16_f32 v152, v220, v221
    v_mfma_f32_16x16x32_bf16 v[120:123], a[24:27], v[112:115], 0
    v_mul_f32 v222, v160, v222
    v_mul_f32 v223, v160, v223
    v_mfma_f32_16x16x32_bf16 v[120:123], a[28:31], v[132:135], v[120:123]
    v_cvt_pk_bf16_f32 v153, v222, v223
    v_fma_f32 v110, v224, v224, s32
    v_mfma_f32_16x16x32_bf16 v[120:123], a[32:35], v[136:139], v[120:123]
    buffer_store_dwordx2 v[130:131], v18, s[12:15], s27 offen
    v_fma_f32 v111, v244, v244, s32
    v_fmac_f32 v111, v245, v245
    v_mfma_f32_16x16x32_bf16 v[120:123], a[36:39], v[212:215], v[120:123]
    v_fmac_f32 v111, v246, v246
    v_fmac_f32 v111, v247, v247
    v_mfma_f32_16x16x32_bf16 v[120:123], a[40:43], v[156:159], v[120:123]
    v_fmac_f32 v110, v225, v225
    v_fmac_f32 v110, v226, v226
    v_mfma_f32_16x16x32_bf16 v[120:123], a[44:47], v[216:219], v[120:123]
    v_fmac_f32 v110, v227, v227
    v_fmac_f32 v110, v240, v240
    v_mfma_f32_16x16x32_bf16 v[144:147], a[48:51], v[112:115], 0
    v_fmac_f32 v110, v241, v241
    v_fmac_f32 v110, v242, v242
    v_mfma_f32_16x16x32_bf16 v[144:147], a[52:55], v[132:135], v[144:147]
    v_fmac_f32 v110, v243, v243
    v_fmac_f32 v110, v140, v140
    v_mfma_f32_16x16x32_bf16 v[144:147], a[56:59], v[136:139], v[144:147]
    v_fmac_f32 v111, v120, v120
    v_fmac_f32 v111, v121, v121
    v_mfma_f32_16x16x32_bf16 v[144:147], a[60:63], v[212:215], v[144:147]
    v_fmac_f32 v111, v122, v122
    v_fmac_f32 v111, v123, v123
    v_mfma_f32_16x16x32_bf16 v[144:147], a[64:67], v[156:159], v[144:147]
    v_fmac_f32 v110, v141, v141
    v_fmac_f32 v110, v142, v142
    v_mfma_f32_16x16x32_bf16 v[144:147], a[68:71], v[216:219], v[144:147]
    v_fmac_f32 v110, v143, v143
    v_mul_f32 v148, v163, v148
    v_mfma_f32_16x16x32_bf16 v[124:127], v[112:115], a[144:147], 0
    v_mul_f32 v149, v163, v149
    v_cvt_pk_bf16_f32 v148, v148, v149
    v_mfma_f32_16x16x32_bf16 v[124:127], v[132:135], a[148:151], v[124:127]
    v_mul_f32 v150, v163, v150
    v_mul_f32 v151, v163, v151
    v_mfma_f32_16x16x32_bf16 v[124:127], v[136:139], a[152:155], v[124:127]
    v_fmac_f32 v111, v144, v144
    v_fmac_f32 v111, v145, v145
    v_mfma_f32_16x16x32_bf16 v[124:127], v[212:215], a[156:159], v[124:127]
    v_fmac_f32 v111, v146, v146
    v_fmac_f32 v111, v147, v147
    v_mfma_f32_16x16x32_bf16 v[124:127], v[156:159], a[160:163], v[124:127]
    v_cvt_pk_bf16_f32 v38, v111, v110
    v_cvt_pk_bf16_f32 v149, v150, v151
    v_mfma_f32_16x16x32_bf16 v[124:127], v[216:219], a[164:167], v[124:127]
    v_mul_f32 v200, v163, v200
    v_mul_f32 v201, v163, v201
    v_mfma_f32_16x16x16_bf16 v[180:183], v[32:33], v[38:39], 0
    v_cvt_pk_bf16_f32 v150, v200, v201
    v_mul_f32 v202, v163, v202
    v_mfma_f32_16x16x32_bf16 v[220:223], v[112:115], a[168:171], 0
    v_mul_f32 v203, v163, v203
    v_cvt_pk_bf16_f32 v151, v202, v203
    v_mfma_f32_16x16x32_bf16 v[220:223], v[132:135], a[172:175], v[220:223]
    buffer_store_dwordx4 v[148:151], v17, s[12:15], s27 offen
    v_cvt_pk_bf16_f32 v130, v124, v125
    v_cvt_pk_bf16_f32 v131, v126, v127
    v_rsq_f32 v181, v181
    v_mfma_f32_16x16x32_bf16 v[220:223], v[136:139], a[176:179], v[220:223]
    v_rsq_f32 v180, v180
    v_mfma_f32_16x16x32_bf16 v[220:223], v[212:215], a[180:183], v[220:223]
    ds_read_b128 v[148:151], v0 offset:32768
    v_mul_f32 v180, s31, v180
    v_mfma_f32_16x16x32_bf16 v[220:223], v[156:159], a[184:187], v[220:223]
    ds_read_b128 v[200:203], v1 offset:32768
    v_mul_f32 v224, v181, v224
    v_mfma_f32_16x16x32_bf16 v[220:223], v[216:219], a[188:191], v[220:223]
    ds_read_b128 v[124:127], v0 offset:32896
    v_mul_f32 v225, v181, v225
    v_mfma_f32_16x16x32_bf16 v[164:167], v[112:115], a[192:195], 0
    ds_read_b128 v[112:115], v1 offset:32896
    v_cvt_pk_bf16_f32 v224, v224, v225
    v_mfma_f32_16x16x32_bf16 v[164:167], v[132:135], a[196:199], v[164:167]
    ds_read_b128 v[132:135], v0 offset:33024
    v_mul_f32 v226, v181, v226
    v_mfma_f32_16x16x32_bf16 v[164:167], v[136:139], a[200:203], v[164:167]
    ds_read_b128 v[136:139], v1 offset:33024
    v_cvt_pk_bf16_f32 v110, v220, v221
    v_mfma_f32_16x16x32_bf16 v[164:167], v[212:215], a[204:207], v[164:167]
    v_cvt_pk_bf16_f32 v111, v222, v223
    v_mul_f32 v227, v181, v227
    v_mfma_f32_16x16x32_bf16 v[164:167], v[156:159], a[208:211], v[164:167]
    v_cvt_pk_bf16_f32 v225, v226, v227
    v_mul_f32 v240, v181, v240
    v_mfma_f32_16x16x32_bf16 v[164:167], v[216:219], a[212:215], v[164:167]
    s_waitcnt lgkmcnt(5)
    v_mul_f32 v241, v181, v241
    v_cvt_pk_bf16_f32 v226, v240, v241
    v_mfma_f32_16x16x32_bf16 v[216:219], a[72:75], v[148:151], 0
    s_waitcnt lgkmcnt(4)
    v_mul_f32 v242, v181, v242
    v_mul_f32 v243, v181, v243
    v_mfma_f32_16x16x32_bf16 v[216:219], a[76:79], v[200:203], v[216:219]
    s_waitcnt lgkmcnt(3)
    v_cvt_pk_bf16_f32 v194, v164, v165
    v_cvt_pk_bf16_f32 v195, v166, v167
    v_mfma_f32_16x16x32_bf16 v[216:219], a[80:83], v[124:127], v[216:219]
    s_waitcnt lgkmcnt(2)
    v_cvt_pk_bf16_f32 v227, v242, v243
    v_mul_f32 v140, v181, v140
    v_mfma_f32_16x16x32_bf16 v[216:219], a[84:87], v[112:115], v[216:219]
    s_waitcnt lgkmcnt(1)
    v_mul_f32 v141, v181, v141
    v_cvt_pk_bf16_f32 v214, v140, v141
    v_mfma_f32_16x16x32_bf16 v[216:219], a[88:91], v[132:135], v[216:219]
    s_waitcnt lgkmcnt(0)
    v_mul_f32 v142, v181, v142
    v_mul_f32 v143, v181, v143
    v_mfma_f32_16x16x32_bf16 v[216:219], a[92:95], v[136:139], v[216:219]
    v_cvt_pk_bf16_f32 v215, v142, v143
    v_mul_f32 v244, v180, v244
    v_mfma_f32_16x16x32_bf16 v[140:143], a[96:99], v[148:151], 0
    v_mul_f32 v245, v180, v245
    v_cvt_pk_bf16_f32 v240, v244, v245
    v_mfma_f32_16x16x32_bf16 v[140:143], a[100:103], v[200:203], v[140:143]
    v_mul_f32 v246, v180, v246
    v_mul_f32 v247, v180, v247
    v_mfma_f32_16x16x32_bf16 v[140:143], a[104:107], v[124:127], v[140:143]
    v_cvt_pk_bf16_f32 v241, v246, v247
    v_mul_f32 v120, v180, v120
    v_mfma_f32_16x16x32_bf16 v[140:143], a[108:111], v[112:115], v[140:143]
    v_mul_f32 v121, v180, v121
    v_cvt_pk_bf16_f32 v242, v120, v121
    v_mfma_f32_16x16x32_bf16 v[140:143], a[112:115], v[132:135], v[140:143]
    v_mul_f32 v122, v180, v122
    v_mul_f32 v123, v180, v123
    v_mfma_f32_16x16x32_bf16 v[140:143], a[116:119], v[136:139], v[140:143]
    v_cvt_pk_bf16_f32 v243, v122, v123
    v_mul_f32 v144, v180, v144
    v_mfma_f32_16x16x32_bf16 v[244:247], a[120:123], v[148:151], 0
    v_mul_f32 v145, v180, v145
    v_cvt_pk_bf16_f32 v212, v144, v145
    v_mfma_f32_16x16x32_bf16 v[244:247], a[124:127], v[200:203], v[244:247]
    v_mul_f32 v146, v180, v146
    v_mul_f32 v147, v180, v147
    v_mfma_f32_16x16x32_bf16 v[244:247], a[128:131], v[124:127], v[244:247]
    v_cvt_pk_bf16_f32 v213, v146, v147
    v_fma_f32 v160, v216, v216, s32
    v_mfma_f32_16x16x32_bf16 v[244:247], a[132:135], v[112:115], v[244:247]
    v_fmac_f32 v160, v217, v217
    v_fmac_f32 v160, v218, v218
    v_mfma_f32_16x16x32_bf16 v[244:247], a[136:139], v[132:135], v[244:247]
    v_fmac_f32 v160, v219, v219
    v_fmac_f32 v160, v140, v140
    v_mfma_f32_16x16x32_bf16 v[244:247], a[140:143], v[136:139], v[244:247]
    s_waitcnt vmcnt(3)
    v_fmac_f32 v160, v141, v141
    v_fmac_f32 v160, v142, v142
    v_mfma_f32_16x16x32_bf16 v[120:123], a[0:3], v[148:151], 0
    s_nop 0
    v_fmac_f32 v160, v143, v143
    v_mul_f32 v232, v163, v232
    v_mfma_f32_16x16x32_bf16 v[120:123], a[4:7], v[200:203], v[120:123]
    s_nop 0
    v_fmac_f32 v160, v244, v244
    v_fmac_f32 v160, v245, v245
    v_mfma_f32_16x16x32_bf16 v[120:123], a[8:11], v[124:127], v[120:123]
    s_barrier
    v_fmac_f32 v160, v246, v246
    v_fmac_f32 v160, v247, v247
    v_mfma_f32_16x16x32_bf16 v[120:123], a[12:15], v[112:115], v[120:123]
    s_nop 0
    buffer_load_dwordx4 v10, s[8:11], s23 offen nt lds
    v_mul_f32 v233, v163, v233
    v_mfma_f32_16x16x32_bf16 v[120:123], a[16:19], v[132:135], v[120:123]
    s_add_u32 m0, s28, 4096
    v_cvt_pk_bf16_f32 v232, v232, v233
    v_mul_f32 v234, v163, v234
    v_mfma_f32_16x16x32_bf16 v[120:123], a[20:23], v[136:139], v[120:123]
    v_mul_f32 v235, v163, v235
    v_cvt_pk_bf16_f32 v233, v234, v235
    v_mfma_f32_16x16x32_bf16 v[144:147], a[24:27], v[148:151], 0
    v_mul_f32 v116, v162, v116
    v_mul_f32 v117, v162, v117
    v_mfma_f32_16x16x32_bf16 v[144:147], a[28:31], v[200:203], v[144:147]
    v_cvt_pk_bf16_f32 v116, v116, v117
    v_mul_f32 v118, v162, v118
    v_mfma_f32_16x16x32_bf16 v[144:147], a[32:35], v[124:127], v[144:147]
    buffer_load_dwordx4 v11, s[8:11], s23 offen nt lds
    v_fma_f32 v161, v120, v120, s32
    v_mfma_f32_16x16x32_bf16 v[144:147], a[36:39], v[112:115], v[144:147]
    s_add_u32 m0, s28, 8192
    v_fmac_f32 v161, v121, v121
    v_fmac_f32 v161, v122, v122
    v_mfma_f32_16x16x32_bf16 v[144:147], a[40:43], v[132:135], v[144:147]
    v_fmac_f32 v161, v123, v123
    v_mul_f32 v119, v162, v119
    v_mfma_f32_16x16x32_bf16 v[144:147], a[44:47], v[136:139], v[144:147]
    v_cvt_pk_bf16_f32 v117, v118, v119
    v_mul_f32 v208, v162, v208
    v_mfma_f32_16x16x32_bf16 v[180:183], a[48:51], v[148:151], 0
    v_mul_f32 v209, v162, v209
    v_cvt_pk_bf16_f32 v118, v208, v209
    v_mfma_f32_16x16x32_bf16 v[180:183], a[52:55], v[200:203], v[180:183]
    buffer_load_dwordx4 v12, s[8:11], s23 offen nt lds
    v_mul_f32 v210, v162, v210
    v_mfma_f32_16x16x32_bf16 v[180:183], a[56:59], v[124:127], v[180:183]
    s_add_u32 m0, s28, 12288
    v_fmac_f32 v161, v144, v144
    v_fmac_f32 v161, v145, v145
    v_mfma_f32_16x16x32_bf16 v[180:183], a[60:63], v[112:115], v[180:183]
    s_xor_b32 s28, s28, 65536
    ds_read_b128 v[220:223], v5 offset:0
    ds_read_b128 v[156:159], v5 offset:16
    v_mfma_f32_16x16x32_bf16 v[180:183], a[64:67], v[132:135], v[180:183]
    ds_read_b128 v[164:167], v5 offset:48
    ds_read_b32 v163, v6 offset:192
    v_mfma_f32_16x16x32_bf16 v[180:183], a[68:71], v[136:139], v[180:183]
    ds_read2_b32 v[170:171], v6 offset0:0 offset1:0
    ds_read2_b32 v[174:175], v6 offset0:16 offset1:16
    v_mfma_f32_16x16x32_bf16 v[184:187], v[148:151], a[144:147], 0
    buffer_load_dwordx4 v13, s[8:11], s23 offen nt lds
    ds_read2_b32 v[198:199], v6 offset0:32 offset1:32
    v_mfma_f32_16x16x32_bf16 v[184:187], v[200:203], a[148:151], v[184:187]
    s_mov_b32 m0, s29
    v_fmac_f32 v161, v146, v146
    v_fmac_f32 v161, v147, v147
    v_mfma_f32_16x16x32_bf16 v[184:187], v[124:127], a[152:155], v[184:187]
    s_xor_b32 s29, s29, s30
    v_fmac_f32 v161, v180, v180
    v_fmac_f32 v161, v181, v181
    v_mfma_f32_16x16x32_bf16 v[184:187], v[112:115], a[156:159], v[184:187]
    s_add_u32 s19, s19, s20
    v_fmac_f32 v161, v182, v182
    v_fmac_f32 v161, v183, v183
    v_mfma_f32_16x16x32_bf16 v[184:187], v[132:135], a[160:163], v[184:187]
    v_cvt_pk_bf16_f32 v38, v161, v160
    v_mul_f32 v211, v162, v211
    v_mfma_f32_16x16x32_bf16 v[184:187], v[136:139], a[164:167], v[184:187]
    s_waitcnt lgkmcnt(5)
    buffer_store_dwordx2 v[232:233], v20, s[12:15], s27 offen
    v_cvt_pk_bf16_f32 v119, v210, v211
    v_mul_f32 v228, v162, v228
    v_mfma_f32_16x16x16_bf16 v[208:211], v[32:33], v[38:39], 0
    s_waitcnt lgkmcnt(2)
    v_mul_f32 v229, v162, v229
    v_cvt_pk_bf16_f32 v228, v228, v229
    v_mfma_f32_16x16x32_bf16 v[232:235], v[220:223], v[188:191], v[22:25]
    s_waitcnt lgkmcnt(1)
    v_cvt_pk_bf16_f32 v168, v184, v185
    v_cvt_pk_bf16_f32 v169, v186, v187
    v_mfma_f32_16x16x32_bf16 v[232:235], v[156:159], v[176:179], v[232:235]
    s_waitcnt lgkmcnt(0)
    v_rsq_f32 v209, v209
    v_mfma_f32_16x16x32_bf16 v[232:235], v[164:167], v[152:155], v[232:235]
    v_rsq_f32 v208, v208
    v_mfma_f32_16x16x32_bf16 v[184:187], v[148:151], a[168:171], 0
    v_mul_f32 v208, s31, v208
    v_mul_f32 v216, v209, v216
    v_mfma_f32_16x16x32_bf16 v[184:187], v[200:203], a[172:175], v[184:187]
    v_mul_f32 v217, v209, v217
    v_cvt_pk_bf16_f32 v216, v216, v217
    v_mfma_f32_16x16x32_bf16 v[184:187], v[124:127], a[176:179], v[184:187]
    v_mov_b32_dpp v163, v233 quad_perm:[0,1,2,3] row_mask:0x1 bank_mask:0xf
    v_mul_f32 v218, v209, v218
    v_mfma_f32_16x16x32_bf16 v[184:187], v[112:115], a[180:183], v[184:187]
    v_mul_f32 v219, v209, v219
    v_cvt_pk_bf16_f32 v217, v218, v219
    v_mfma_f32_16x16x32_bf16 v[184:187], v[132:135], a[184:187], v[184:187]
    v_mul_f32 v140, v209, v140
    v_mul_f32 v141, v209, v141
    v_mfma_f32_16x16x32_bf16 v[184:187], v[136:139], a[188:191], v[184:187]
    v_cvt_pk_bf16_f32 v218, v140, v141
    v_mul_f32 v142, v209, v142
    v_mfma_f32_16x16x32_bf16 v[204:207], v[148:151], a[192:195], 0
    v_mul_f32 v143, v209, v143
    v_cvt_pk_bf16_f32 v219, v142, v143
    v_mfma_f32_16x16x32_bf16 v[204:207], v[200:203], a[196:199], v[204:207]
    v_mul_f32 v244, v209, v244
    v_mul_f32 v245, v209, v245
    v_mfma_f32_16x16x32_bf16 v[204:207], v[124:127], a[200:203], v[204:207]
    ds_read_b128 v[148:151], v2 offset:0
    v_cvt_pk_bf16_f32 v172, v184, v185
    v_mfma_f32_16x16x32_bf16 v[204:207], v[112:115], a[204:207], v[204:207]
    ds_read_b128 v[200:203], v2 offset:1024
    v_cvt_pk_bf16_f32 v173, v186, v187
    v_mfma_f32_16x16x32_bf16 v[204:207], v[132:135], a[208:211], v[204:207]
    ds_read_b128 v[124:127], v2 offset:2048
    v_cvt_pk_bf16_f32 v114, v244, v245
    v_mfma_f32_16x16x32_bf16 v[204:207], v[136:139], a[212:215], v[204:207]
    ds_read_b128 v[132:135], v2 offset:3072
    ds_read_b128 v[136:139], v2 offset:4096
    v_mfma_f32_16x16x32_bf16 v[184:187], v[176:179], v[188:191], v[40:43]
    ds_read_b128 v[236:239], v2 offset:5120
    buffer_store_dwordx4 v[116:119], v16, s[12:15], s27 offen
    v_mul_f32 v246, v209, v246
    v_mul_f32 v247, v209, v247
    v_cvt_pk_bf16_f32 v115, v246, v247
    v_cvt_pk_bf16_f32 v196, v204, v205
    v_mfma_f32_16x16x32_bf16 v[248:251], v[224:227], v[188:191], v[44:47]
    v_cvt_pk_bf16_f32 v197, v206, v207
    v_mul_f32 v120, v208, v120
    v_mfma_f32_16x16x32_bf16 v[204:207], v[216:219], v[188:191], v[48:51]
    v_mul_f32 v121, v208, v121
    v_cvt_pk_bf16_f32 v120, v120, v121
    v_mfma_f32_16x16x16_bf16 v[184:187], v[154:155], v[152:153], v[184:187]
    s_waitcnt lgkmcnt(5)
    v_mul_f32 v122, v208, v122
    v_mul_f32 v123, v208, v123
    v_mfma_f32_16x16x16_bf16 v[248:251], v[214:215], v[152:153], v[248:251]
    s_waitcnt lgkmcnt(4)
    v_cvt_pk_bf16_f32 v121, v122, v123
    v_mul_f32 v144, v208, v144
    v_mfma_f32_16x16x16_bf16 v[204:207], v[114:115], v[152:153], v[204:207]
    s_waitcnt lgkmcnt(3)
    v_mul_f32 v145, v208, v145
    v_cvt_pk_bf16_f32 v122, v144, v145
    v_mfma_f32_16x16x32_bf16 v[252:255], v[220:223], v[240:243], v[24:27]
    s_waitcnt lgkmcnt(1)
    v_mul_f32 v146, v208, v146
    v_mul_f32 v147, v208, v147
    v_mfma_f32_16x16x32_bf16 v[252:255], v[156:159], v[224:227], v[252:255]
    s_waitcnt lgkmcnt(0)
    v_cvt_pk_bf16_f32 v123, v146, v147
    v_mul_f32 v180, v208, v180
    v_mfma_f32_16x16x32_bf16 v[252:255], v[164:167], v[212:215], v[252:255]
    v_mul_f32 v181, v208, v181
    v_cvt_pk_bf16_f32 v112, v180, v181
    v_mfma_f32_16x16x32_bf16 v[144:147], v[220:223], v[120:123], v[26:29]
    v_mul_f32 v182, v208, v182
    v_mul_f32 v183, v208, v183
    v_mfma_f32_16x16x32_bf16 v[144:147], v[156:159], v[216:219], v[144:147]
    v_cvt_pk_bf16_f32 v113, v182, v183
    v_max3_f32 v152, v232, v184, v185
    v_mfma_f32_16x16x32_bf16 v[140:143], a[216:219], v[148:151], 0
    v_max3_f32 v152, v152, v186, v187
    v_max3_f32 v152, v152, v248, v249
    v_mfma_f32_16x16x32_bf16 v[144:147], v[164:167], v[112:115], v[144:147]
    v_max3_f32 v152, v152, v250, v251
    v_max3_f32 v152, v152, v204, v205
    v_mfma_f32_16x16x32_bf16 v[140:143], a[220:223], v[200:203], v[140:143]
    v_max3_f32 v152, v152, v206, v207
    v_mov_b32 v153, v152
    v_mfma_f32_16x16x32_bf16 v[140:143], a[224:227], v[124:127], v[140:143]
    v_mov_b32_dpp v163, v253 quad_perm:[0,1,2,3] row_mask:0x2 bank_mask:0xf
    v_mul_f32 v230, v162, v230
    v_mfma_f32_16x16x32_bf16 v[140:143], a[228:231], v[132:135], v[140:143]
    v_mov_b32_dpp v163, v145 quad_perm:[0,1,2,3] row_mask:0x4 bank_mask:0xf
    v_mul_f32 v231, v162, v231
    v_mfma_f32_16x16x32_bf16 v[140:143], a[232:235], v[136:139], v[140:143]
    v_permlane32_swap_b32 v152, v153
    v_mfma_f32_16x16x32_bf16 v[140:143], a[236:239], v[236:239], v[140:143]
    v_max_f32 v152, v152, v153
    v_mov_b32 v153, v152
    v_mfma_f32_16x16x32_bf16 v[188:191], a[240:243], v[148:151], 0
    v_cvt_pk_bf16_f32 v229, v230, v231
    v_mov_b32 v145, v163
    v_mfma_f32_16x16x32_bf16 v[188:191], a[244:247], v[200:203], v[188:191]
    buffer_store_dwordx2 v[228:229], v19, s[12:15], s27 offen
    v_permlane16_swap_b32 v152, v153
    v_mfma_f32_16x16x32_bf16 v[188:191], a[248:251], v[124:127], v[188:191]
    s_mov_b32 s27, s26
    v_max_f32 v152, v152, v153
    v_sub_f32 v184, v184, v152
    v_mfma_f32_16x16x32_bf16 v[188:191], a[252:255], v[132:135], v[188:191]
    s_mov_b32 s26, s25
    ds_read_b128 v[180:183], v2 offset:6144
    v_sub_f32 v185, v185, v152
    v_mfma_f32_16x16x32_bf16 v[188:191], v[76:79], v[136:139], v[188:191]
    s_mov_b32 s25, s24
    ds_read_b128 v[220:223], v2 offset:7168
    v_sub_f32 v186, v186, v152
    v_mfma_f32_16x16x32_bf16 v[188:191], v[80:83], v[236:239], v[188:191]
    s_mov_b32 s24, s23
    ds_read_b128 v[156:159], v2 offset:8192
    v_sub_f32 v187, v187, v152
    v_mfma_f32_16x16x32_bf16 v[244:247], v[84:87], v[148:151], 0
    ds_read_b128 v[148:151], v2 offset:9216
    v_sub_f32 v248, v248, v152
    v_mfma_f32_16x16x32_bf16 v[244:247], v[88:91], v[200:203], v[244:247]
    ds_read_b128 v[200:203], v2 offset:10240
    v_sub_f32 v249, v249, v152
    v_mfma_f32_16x16x32_bf16 v[244:247], v[92:95], v[124:127], v[244:247]
    ds_read_b128 v[124:127], v2 offset:11264
    v_sub_f32 v250, v250, v152
    v_mfma_f32_16x16x32_bf16 v[244:247], v[96:99], v[132:135], v[244:247]
    v_exp_f32 v184, v184
    v_mfma_f32_16x16x32_bf16 v[244:247], v[100:103], v[136:139], v[244:247]
    v_exp_f32 v185, v185
    v_mfma_f32_16x16x32_bf16 v[244:247], v[104:107], v[236:239], v[244:247]
    s_waitcnt lgkmcnt(5)
    v_cvt_pk_bf16_f32 v136, v184, v185
    v_sub_f32 v251, v251, v152
    v_mfma_f32_16x16x32_bf16 v[116:119], a[216:219], v[180:183], 0
    s_waitcnt lgkmcnt(4)
    v_exp_f32 v186, v186
    v_mfma_f32_16x16x32_bf16 v[116:119], a[220:223], v[220:223], v[116:119]
    s_waitcnt lgkmcnt(3)
    v_exp_f32 v187, v187
    v_mfma_f32_16x16x32_bf16 v[116:119], a[224:227], v[156:159], v[116:119]
    s_waitcnt lgkmcnt(2)
    v_cvt_pk_bf16_f32 v137, v186, v187
    v_sub_f32 v204, v204, v152
    v_mfma_f32_16x16x32_bf16 v[116:119], a[228:231], v[148:151], v[116:119]
    s_waitcnt lgkmcnt(1)
    v_exp_f32 v248, v248
    v_mfma_f32_16x16x32_bf16 v[132:135], v[176:179], v[240:243], v[52:55]
    s_waitcnt lgkmcnt(0)
    v_exp_f32 v249, v249
    v_mfma_f32_16x16x32_bf16 v[164:167], v[224:227], v[240:243], v[56:59]
    v_cvt_pk_bf16_f32 v138, v248, v249
    v_sub_f32 v205, v205, v152
    v_mfma_f32_16x16x32_bf16 v[184:187], v[216:219], v[240:243], v[60:63]
    buffer_load_dwordx4 v14, s[8:11], s23 offen nt lds
    v_sub_f32 v206, v206, v152
    v_mfma_f32_16x16x16_bf16 v[132:135], v[154:155], v[212:213], v[132:135]
    s_add_u32 s23, s23, s21
    v_exp_f32 v250, v250
    v_mfma_f32_16x16x16_bf16 v[164:167], v[214:215], v[212:213], v[164:167]
    s_cmp_ge_u32 s19, 72
    v_exp_f32 v251, v251
    v_mfma_f32_16x16x16_bf16 v[184:187], v[114:115], v[212:213], v[184:187]
    s_cselect_b32 s34, 72, 0
    v_cvt_pk_bf16_f32 v139, v250, v251
    v_sub_f32 v207, v207, v152
    v_mfma_f32_16x16x32_bf16 v[116:119], a[232:235], v[200:203], v[116:119]
    s_cselect_b32 s35, s22, 0
    v_exp_f32 v204, v204
    v_mfma_f32_16x16x32_bf16 v[116:119], a[236:239], v[124:127], v[116:119]
    s_sub_u32 s19, s19, s34
    v_exp_f32 v205, v205
    v_mfma_f32_16x16x32_bf16 v[208:211], a[240:243], v[180:183], 0
    s_add_u32 s23, s23, s35
    v_cvt_pk_bf16_f32 v36, v204, v205
    v_sub_f32 v232, v232, v152
    v_mfma_f32_16x16x32_bf16 v[208:211], a[244:247], v[220:223], v[208:211]
    s_add_u32 s18, s18, 1
    v_exp_f32 v206, v206
    v_mfma_f32_16x16x32_bf16 v[208:211], a[248:251], v[156:159], v[208:211]
    s_cmp_lt_u32 s18, s17
    v_exp_f32 v207, v207
    v_mfma_f32_16x16x32_bf16 v[208:211], a[252:255], v[148:151], v[208:211]
    ds_read_b128 v[240:243], v2 offset:12288
    v_cvt_pk_bf16_f32 v37, v206, v207
    v_mfma_f32_16x16x32_bf16 v[208:211], v[76:79], v[200:203], v[208:211]
    ds_read_b128 v[204:207], v2 offset:13312
    v_max3_f32 v146, v252, v132, v133
    v_mfma_f32_16x16x32_bf16 v[208:211], v[80:83], v[124:127], v[208:211]
    ds_read_b128 v[248:251], v2 offset:14336
    v_max3_f32 v146, v146, v134, v135
    v_mfma_f32_16x16x32_bf16 v[228:231], v[84:87], v[180:183], 0
    ds_read_b128 v[180:183], v2 offset:15360
    v_max3_f32 v146, v146, v164, v165
    v_mfma_f32_16x16x32_bf16 v[228:231], v[88:91], v[220:223], v[228:231]
    ds_read_b128 v[220:223], v2 offset:16384
    v_max3_f32 v146, v146, v166, v167
    v_mfma_f32_16x16x32_bf16 v[228:231], v[92:95], v[156:159], v[228:231]
    ds_read_b128 v[156:159], v2 offset:17408
    v_max3_f32 v146, v146, v184, v185
    v_mfma_f32_16x16x32_bf16 v[228:231], v[96:99], v[148:151], v[228:231]
    v_exp_f32 v232, v232
    v_mfma_f32_16x16x32_bf16 v[228:231], v[100:103], v[200:203], v[228:231]
    v_cvt_pk_bf16_f32 v38, v232, 0
    v_max3_f32 v146, v146, v186, v187
    v_mfma_f32_16x16x32_bf16 v[228:231], v[104:107], v[124:127], v[228:231]
    s_waitcnt lgkmcnt(5)
    v_mov_b32 v147, v146
    v_max_f32_dpp v145, v145, v145 quad_perm:[1,0,3,2] row_mask:0xf bank_mask:0xf
    v_mfma_f32_16x16x32_bf16 v[232:235], v[28:31], v[36:39], 0
    s_waitcnt lgkmcnt(4)
    v_permlane32_swap_b32 v146, v147
    v_mfma_f32_16x16x32_bf16 v[232:235], v[28:31], v[136:139], v[232:235]
    s_waitcnt lgkmcnt(3)
    v_max_f32 v146, v146, v147
    v_mov_b32 v147, v146
    v_mfma_f32_16x16x32_bf16 v[200:203], v[168:171], v[36:39], 0
    s_waitcnt lgkmcnt(2)
    v_permlane16_swap_b32 v146, v147
    v_mfma_f32_16x16x32_bf16 v[200:203], v[128:131], v[136:139], v[200:203]
    s_waitcnt lgkmcnt(1)
    v_rcp_f32 v232, v232
    v_mfma_f32_16x16x32_bf16 v[124:127], v[172:175], v[36:39], 0
    s_waitcnt lgkmcnt(0)
    v_max_f32 v146, v146, v147
    v_sub_f32 v132, v132, v146
    v_mfma_f32_16x16x32_bf16 v[124:127], v[108:111], v[136:139], v[124:127]
    v_exp_f32 v132, v132
    v_mfma_f32_16x16x32_bf16 v[236:239], v[196:199], v[36:39], 0
    v_mul_f32 v200, v232, v200
    v_mul_f32 v201, v232, v201
    v_mfma_f32_16x16x32_bf16 v[236:239], v[192:195], v[136:139], v[236:239]
    v_cvt_pk_bf16_f32 v200, v200, v201
    v_mul_f32 v202, v232, v202
    v_mfma_f32_16x16x32_bf16 v[148:151], a[216:219], v[240:243], 0
    v_mul_f32 v203, v232, v203
    v_cvt_pk_bf16_f32 v201, v202, v203
    v_mfma_f32_16x16x32_bf16 v[148:151], a[220:223], v[204:207], v[148:151]
    v_mul_f32 v124, v232, v124
    v_mul_f32 v125, v232, v125
    v_mfma_f32_16x16x32_bf16 v[148:151], a[224:227], v[248:251], v[148:151]
    v_cvt_pk_bf16_f32 v202, v124, v125
    v_mul_f32 v126, v232, v126
    v_mfma_f32_16x16x32_bf16 v[148:151], a[228:231], v[180:183], v[148:151]
    v_mul_f32 v127, v232, v127
    v_cvt_pk_bf16_f32 v203, v126, v127
    v_mfma_f32_16x16x32_bf16 v[148:151], a[232:235], v[220:223], v[148:151]
    ds_write_b128 v3, v[200:203] offset:0
    v_mfma_f32_16x16x32_bf16 v[148:151], a[236:239], v[156:159], v[148:151]
    v_mul_f32 v236, v232, v236
    v_mul_f32 v237, v232, v237
    v_mfma_f32_16x16x32_bf16 v[200:203], a[240:243], v[240:243], 0
    v_cvt_pk_bf16_f32 v152, v236, v237
    v_mul_f32 v238, v232, v238
    v_mfma_f32_16x16x32_bf16 v[200:203], a[244:247], v[204:207], v[200:203]
    v_mul_f32 v239, v232, v239
    v_cvt_pk_bf16_f32 v153, v238, v239
    v_mfma_f32_16x16x32_bf16 v[200:203], a[248:251], v[248:251], v[200:203]
    ds_write_b64 v4, v[152:153] offset:4096
    v_mfma_f32_16x16x32_bf16 v[200:203], a[252:255], v[180:183], v[200:203]
    v_fma_f32 v147, v148, v148, s33
    v_fmac_f32 v147, v149, v149
    v_mfma_f32_16x16x32_bf16 v[200:203], v[76:79], v[220:223], v[200:203]
    v_fmac_f32 v147, v150, v150
    v_fmac_f32 v147, v151, v151
    v_mfma_f32_16x16x32_bf16 v[200:203], v[80:83], v[156:159], v[200:203]
    v_sub_f32 v133, v133, v146
    v_sub_f32 v134, v134, v146
    v_mfma_f32_16x16x32_bf16 v[232:235], v[84:87], v[240:243], 0
    v_exp_f32 v133, v133
    v_mfma_f32_16x16x32_bf16 v[232:235], v[88:91], v[204:207], v[232:235]
    v_cvt_pk_bf16_f32 v240, v132, v133
    v_sub_f32 v135, v135, v146
    v_mfma_f32_16x16x32_bf16 v[232:235], v[92:95], v[248:251], v[232:235]
    v_fmac_f32 v147, v200, v200
    v_fmac_f32 v147, v201, v201
    v_mfma_f32_16x16x32_bf16 v[232:235], v[96:99], v[180:183], v[232:235]
    v_fmac_f32 v147, v202, v202
    v_fmac_f32 v147, v203, v203
    v_mfma_f32_16x16x32_bf16 v[232:235], v[100:103], v[220:223], v[232:235]
    v_exp_f32 v134, v134
    v_mfma_f32_16x16x32_bf16 v[232:235], v[104:107], v[156:159], v[232:235]
    v_exp_f32 v135, v135
    v_sub_f32 v164, v164, v146
    v_cvt_pk_bf16_f32 v241, v134, v135
    v_exp_f32 v164, v164
    v_sub_f32 v165, v165, v146
    v_exp_f32 v165, v165
    v_sub_f32 v166, v166, v146
    v_cvt_pk_bf16_f32 v242, v164, v165
    v_fmac_f32 v147, v232, v232
    v_fmac_f32 v147, v233, v233
    v_fmac_f32 v147, v234, v234
    v_fmac_f32 v147, v235, v235
    v_cvt_pk_bf16_f32 v161, v147, v147
    v_exp_f32 v166, v166
    v_sub_f32 v167, v167, v146
    v_exp_f32 v167, v167
    v_sub_f32 v184, v184, v146
    v_cvt_pk_bf16_f32 v243, v166, v167
    v_exp_f32 v184, v184
    v_sub_f32 v185, v185, v146
    v_exp_f32 v185, v185
    v_sub_f32 v186, v186, v146
    v_cvt_pk_bf16_f32 v36, v184, v185
    v_exp_f32 v186, v186
    v_sub_f32 v187, v187, v146
    v_exp_f32 v187, v187
    v_mfma_f32_16x16x32_bf16 v[132:135], v[176:179], v[120:123], v[64:67]
    v_cvt_pk_bf16_f32 v37, v186, v187
    v_sub_f32 v252, v252, v146
    v_mfma_f32_16x16x32_bf16 v[176:179], v[224:227], v[120:123], v[68:71]
    v_exp_f32 v252, v252
    v_mfma_f32_16x16x32_bf16 v[224:227], v[216:219], v[120:123], v[72:75]
    v_cvt_pk_bf16_f32 v38, v252, 0
    v_max_f32_dpp v145, v145, v145 quad_perm:[2,3,0,1] row_mask:0xf bank_mask:0xf
    v_mfma_f32_16x16x16_bf16 v[132:135], v[154:155], v[112:113], v[132:135]
    v_fma_f32 v160, v116, v116, s33
    v_max_f32_dpp v145, v145, v145 row_half_mirror row_mask:0xf bank_mask:0xf
    v_mfma_f32_16x16x16_bf16 v[176:179], v[214:215], v[112:113], v[176:179]
    v_fmac_f32 v160, v117, v117
    v_max_f32_dpp v145, v145, v145 row_mirror row_mask:0xf bank_mask:0xf
    v_mfma_f32_16x16x16_bf16 v[224:227], v[114:115], v[112:113], v[224:227]
    v_mov_b32 v162, v145
    v_fmac_f32 v160, v118, v118
    v_mfma_f32_16x16x32_bf16 v[152:155], v[28:31], v[36:39], 0
    v_permlane32_swap_b32 v145, v162
    v_mfma_f32_16x16x32_bf16 v[152:155], v[28:31], v[240:243], v[152:155]
    v_max_f32 v145, v145, v162
    v_mov_b32 v162, v145
    v_mfma_f32_16x16x32_bf16 v[112:115], v[168:171], v[36:39], 0
    v_max3_f32 v146, v144, v132, v133
    v_max3_f32 v146, v146, v134, v135
    v_mfma_f32_16x16x32_bf16 v[112:115], v[128:131], v[240:243], v[112:115]
    v_permlane16_swap_b32 v145, v162
    v_mfma_f32_16x16x32_bf16 v[124:127], v[172:175], v[36:39], 0
    v_max_f32 v145, v145, v162
    v_sub_f32 v163, v163, v145
    v_mfma_f32_16x16x32_bf16 v[124:127], v[108:111], v[240:243], v[124:127]
    v_exp_f32 v163, v163
    v_mfma_f32_16x16x32_bf16 v[136:139], v[196:199], v[36:39], 0
    v_cvt_pk_bf16_f32 v163, v163, v163
    v_max3_f32 v146, v146, v176, v177
    v_mfma_f32_16x16x32_bf16 v[136:139], v[192:195], v[240:243], v[136:139]
    ds_write_b16 v8, v163
    v_max3_f32 v146, v146, v178, v179
    v_max3_f32 v146, v146, v224, v225
    v_max3_f32 v146, v146, v226, v227
    v_mov_b32 v145, v146
    v_fmac_f32 v160, v119, v119
    v_fmac_f32 v160, v208, v208
    v_permlane32_swap_b32 v146, v145
    v_max_f32 v146, v146, v145
    v_mov_b32 v145, v146
    v_fmac_f32 v160, v209, v209
    v_fmac_f32 v160, v210, v210
    v_permlane16_swap_b32 v146, v145
    v_max_f32 v146, v146, v145
    v_sub_f32 v132, v132, v146
    v_exp_f32 v132, v132
    v_sub_f32 v133, v133, v146
    v_exp_f32 v133, v133
    v_sub_f32 v134, v134, v146
    v_cvt_pk_bf16_f32 v132, v132, v133
    v_exp_f32 v134, v134
    v_sub_f32 v135, v135, v146
    v_exp_f32 v135, v135
    v_sub_f32 v176, v176, v146
    v_cvt_pk_bf16_f32 v133, v134, v135
    v_exp_f32 v176, v176
    v_sub_f32 v177, v177, v146
    v_exp_f32 v177, v177
    v_sub_f32 v178, v178, v146
    v_cvt_pk_bf16_f32 v134, v176, v177
    v_exp_f32 v178, v178
    v_sub_f32 v179, v179, v146
    v_exp_f32 v179, v179
    v_sub_f32 v224, v224, v146
    v_cvt_pk_bf16_f32 v135, v178, v179
    v_exp_f32 v224, v224
    v_sub_f32 v225, v225, v146
    v_exp_f32 v225, v225
    v_sub_f32 v226, v226, v146
    v_cvt_pk_bf16_f32 v36, v224, v225
    v_exp_f32 v226, v226
    v_sub_f32 v227, v227, v146
    v_exp_f32 v227, v227
    v_sub_f32 v144, v144, v146
    v_cvt_pk_bf16_f32 v37, v226, v227
    v_exp_f32 v144, v144
    v_fmac_f32 v160, v211, v211
    v_cvt_pk_bf16_f32 v38, v144, 0
    v_fmac_f32 v160, v228, v228
    v_fmac_f32 v160, v229, v229
    v_mfma_f32_16x16x32_bf16 v[180:183], v[28:31], v[36:39], 0
    ds_read_b128 v[144:147], v9
    ds_read_b128 v[220:223], v9 offset:64
    v_mfma_f32_16x16x32_bf16 v[180:183], v[28:31], v[132:135], v[180:183]
    v_fmac_f32 v160, v230, v230
    v_fmac_f32 v160, v231, v231
    v_mfma_f32_16x16x32_bf16 v[156:159], v[168:171], v[36:39], 0
    v_xor_b32 v0, 65536, v0
    v_xor_b32 v1, 65536, v1
    v_mfma_f32_16x16x32_bf16 v[156:159], v[128:131], v[132:135], v[156:159]
    ds_read_b128 v[212:215], v0 offset:20480
    ds_read_b128 v[176:179], v1 offset:20480
    v_mfma_f32_16x16x32_bf16 v[164:167], v[172:175], v[36:39], 0
    ds_read_b128 v[216:219], v0 offset:20608
    ds_read_b128 v[120:123], v1 offset:20608
    v_mfma_f32_16x16x32_bf16 v[164:167], v[108:111], v[132:135], v[164:167]
    ds_read_b128 v[240:243], v0 offset:20736
    ds_read_b128 v[224:227], v1 offset:20736
    v_mfma_f32_16x16x32_bf16 v[184:187], v[196:199], v[36:39], 0
    v_rcp_f32 v152, v152
    v_mfma_f32_16x16x32_bf16 v[184:187], v[192:195], v[132:135], v[184:187]
    v_mul_f32 v112, v152, v112
    v_mul_f32 v113, v152, v113
    s_waitcnt lgkmcnt(6)
    v_mfma_f32_16x16x32_bf16 v[132:135], v[144:147], v[28:31], 0
    v_cvt_pk_bf16_f32 v112, v112, v113
    v_mul_f32 v114, v152, v114
    v_mfma_f32_16x16x32_bf16 v[132:135], v[220:223], v[28:31], v[132:135]
    v_mul_f32 v115, v152, v115
    v_cvt_pk_bf16_f32 v113, v114, v115
    v_mfma_f32_16x16x32_bf16 v[204:207], v[144:147], v[128:131], 0
    s_waitcnt lgkmcnt(5)
    v_mul_f32 v124, v152, v124
    v_mul_f32 v125, v152, v125
    v_mfma_f32_16x16x32_bf16 v[204:207], v[220:223], v[168:171], v[204:207]
    s_waitcnt lgkmcnt(3)
    v_rcp_f32 v132, v132
    v_mfma_f32_16x16x32_bf16 v[128:131], v[144:147], v[108:111], 0
    s_waitcnt lgkmcnt(1)
    v_cvt_pk_bf16_f32 v114, v124, v125
    v_mul_f32 v126, v152, v126
    v_mfma_f32_16x16x32_bf16 v[128:131], v[220:223], v[172:175], v[128:131]
    s_waitcnt lgkmcnt(0)
    v_mul_f32 v204, v204, v132
    v_mul_f32 v127, v152, v127
    v_mfma_f32_16x16x32_bf16 v[108:111], v[144:147], v[192:195], 0
    v_cvt_pk_bf16_f32 v115, v126, v127
    v_mul_f32 v136, v152, v136
    v_mfma_f32_16x16x32_bf16 v[108:111], v[220:223], v[196:199], v[108:111]
    ds_write_b128 v3, v[112:115] offset:6144
    v_mfma_f32_16x16x32_bf16 v[192:195], a[72:75], v[212:215], 0
    v_mul_f32_dpp v204, v128, v132 quad_perm:[0,1,2,3] row_mask:0x2 bank_mask:0xf
    v_mul_f32 v137, v152, v137
    v_mfma_f32_16x16x32_bf16 v[192:195], a[76:79], v[176:179], v[192:195]
    v_cvt_pk_bf16_f32 v162, v136, v137
    v_mul_f32 v138, v152, v138
    v_mfma_f32_16x16x32_bf16 v[192:195], a[80:83], v[216:219], v[192:195]
    v_mul_f32_dpp v204, v108, v132 quad_perm:[0,1,2,3] row_mask:0x4 bank_mask:0xf
    v_cvt_pk_bf16_f32 v204, v204, v204
    v_mfma_f32_16x16x32_bf16 v[192:195], a[84:87], v[120:123], v[192:195]
    ds_write_b16 v7, v204
    v_mfma_f32_16x16x32_bf16 v[192:195], a[88:91], v[240:243], v[192:195]
    v_mul_f32 v139, v152, v139
    v_cvt_pk_bf16_f32 v163, v138, v139
    v_mfma_f32_16x16x32_bf16 v[192:195], a[92:95], v[224:227], v[192:195]
    ds_write_b64 v4, v[162:163] offset:10240
    v_mfma_f32_16x16x32_bf16 v[152:155], a[96:99], v[212:215], 0
    v_rcp_f32 v180, v180
    v_mfma_f32_16x16x32_bf16 v[152:155], a[100:103], v[176:179], v[152:155]
    v_mul_f32 v156, v180, v156
    v_mul_f32 v157, v180, v157
    v_mfma_f32_16x16x32_bf16 v[152:155], a[104:107], v[216:219], v[152:155]
    v_cvt_pk_bf16_f32 v128, v156, v157
    v_mul_f32 v158, v180, v158
    v_mfma_f32_16x16x32_bf16 v[152:155], a[108:111], v[120:123], v[152:155]
    v_mul_f32 v159, v180, v159
    v_cvt_pk_bf16_f32 v129, v158, v159
    v_mfma_f32_16x16x32_bf16 v[152:155], a[112:115], v[240:243], v[152:155]
    v_mul_f32 v164, v180, v164
    v_mul_f32 v165, v180, v165
    v_mfma_f32_16x16x32_bf16 v[152:155], a[116:119], v[224:227], v[152:155]
    v_cvt_pk_bf16_f32 v130, v164, v165
    v_mul_f32 v166, v180, v166
    v_mfma_f32_16x16x32_bf16 v[144:147], a[120:123], v[212:215], 0
    v_mul_f32 v167, v180, v167
    v_cvt_pk_bf16_f32 v131, v166, v167
    v_mfma_f32_16x16x32_bf16 v[144:147], a[124:127], v[176:179], v[144:147]
    ds_write_b128 v3, v[128:131] offset:12288
    v_mfma_f32_16x16x32_bf16 v[144:147], a[128:131], v[216:219], v[144:147]
    v_mul_f32 v184, v180, v184
    v_mul_f32 v185, v180, v185
    v_mfma_f32_16x16x32_bf16 v[144:147], a[132:135], v[120:123], v[144:147]
    v_cvt_pk_bf16_f32 v162, v184, v185
    v_mul_f32 v186, v180, v186
    v_mfma_f32_16x16x32_bf16 v[144:147], a[136:139], v[240:243], v[144:147]
    v_mul_f32 v187, v180, v187
    v_cvt_pk_bf16_f32 v163, v186, v187
    v_mfma_f32_16x16x32_bf16 v[144:147], a[140:143], v[224:227], v[144:147]
    ds_write_b64 v4, v[162:163] offset:16384
    v_mfma_f32_16x16x32_bf16 v[124:127], a[0:3], v[212:215], 0
    v_fma_f32 v162, v140, v140, s33
    v_fmac_f32 v162, v141, v141
    v_mfma_f32_16x16x32_bf16 v[124:127], a[4:7], v[176:179], v[124:127]
    v_fmac_f32 v162, v142, v142
    v_fmac_f32 v162, v143, v143
    v_mfma_f32_16x16x32_bf16 v[124:127], a[8:11], v[216:219], v[124:127]
    v_fmac_f32 v162, v188, v188
    v_fmac_f32 v162, v189, v189
    v_mfma_f32_16x16x32_bf16 v[124:127], a[12:15], v[120:123], v[124:127]
    v_fmac_f32 v162, v190, v190
    v_fmac_f32 v162, v191, v191
    v_mfma_f32_16x16x32_bf16 v[124:127], a[16:19], v[240:243], v[124:127]
    v_fmac_f32 v162, v244, v244
    v_fmac_f32 v162, v245, v245
    v_mfma_f32_16x16x32_bf16 v[124:127], a[20:23], v[224:227], v[124:127]
    v_fmac_f32 v162, v246, v246
    v_fmac_f32 v162, v247, v247
    v_mfma_f32_16x16x32_bf16 v[180:183], a[24:27], v[212:215], 0
    v_cvt_pk_bf16_f32 v160, v162, v160
    v_fma_f32 v162, v192, v192, s32
    v_mfma_f32_16x16x32_bf16 v[180:183], a[28:31], v[176:179], v[180:183]
    ds_write_b64 v4, v[160:161] offset:18432
    v_mfma_f32_16x16x32_bf16 v[180:183], a[32:35], v[216:219], v[180:183]
    v_fmac_f32 v162, v193, v193
    v_fmac_f32 v162, v194, v194
    v_mfma_f32_16x16x32_bf16 v[180:183], a[36:39], v[120:123], v[180:183]
    v_fmac_f32 v162, v195, v195
    v_fmac_f32 v162, v152, v152
    v_mfma_f32_16x16x32_bf16 v[180:183], a[40:43], v[240:243], v[180:183]
    v_fmac_f32 v162, v153, v153
    v_fmac_f32 v162, v154, v154
    v_mfma_f32_16x16x32_bf16 v[180:183], a[44:47], v[224:227], v[180:183]
    v_fmac_f32 v162, v155, v155
    v_fmac_f32 v162, v144, v144
    v_mfma_f32_16x16x32_bf16 v[220:223], a[48:51], v[212:215], 0
    v_fmac_f32 v162, v145, v145
    v_fmac_f32 v162, v146, v146
    v_mfma_f32_16x16x32_bf16 v[220:223], a[52:55], v[176:179], v[220:223]
    v_fmac_f32 v162, v147, v147
    v_fma_f32 v160, v124, v124, s32
    v_mfma_f32_16x16x32_bf16 v[220:223], a[56:59], v[216:219], v[220:223]
    s_waitcnt lgkmcnt(0)
    v_fmac_f32 v160, v125, v125
    v_fmac_f32 v160, v126, v126
    v_mfma_f32_16x16x32_bf16 v[220:223], a[60:63], v[120:123], v[220:223]
    s_nop 0
    v_fmac_f32 v160, v127, v127
    v_fmac_f32 v160, v180, v180
    v_mfma_f32_16x16x32_bf16 v[220:223], a[64:67], v[240:243], v[220:223]
    s_nop 0
    v_fmac_f32 v160, v181, v181
    v_fmac_f32 v160, v182, v182
    v_mfma_f32_16x16x32_bf16 v[220:223], a[68:71], v[224:227], v[220:223]
    s_barrier
    v_fmac_f32 v160, v183, v183
    v_add_u32 v5, 336, v5
    v_mfma_f32_16x16x32_bf16 v[128:131], v[212:215], a[144:147], 0
    s_nop 0
    v_add_u32 v6, 272, v6
    v_add_u32 v7, 16, v7
    v_mfma_f32_16x16x32_bf16 v[128:131], v[176:179], a[148:151], v[128:131]
    v_fmac_f32 v160, v220, v220
    v_fmac_f32 v160, v221, v221
    v_mfma_f32_16x16x32_bf16 v[128:131], v[216:219], a[152:155], v[128:131]
    v_fmac_f32 v160, v222, v222
    v_fmac_f32 v160, v223, v223
    v_mfma_f32_16x16x32_bf16 v[128:131], v[120:123], a[156:159], v[128:131]
    v_cvt_pk_bf16_f32 v38, v160, v162
    v_xor_b32 v2, 65536, v2
    v_mfma_f32_16x16x32_bf16 v[128:131], v[240:243], a[160:163], v[128:131]
    v_xor_b32 v3, 65536, v3
    v_xor_b32 v4, 65536, v4
    v_mfma_f32_16x16x32_bf16 v[128:131], v[224:227], a[164:167], v[128:131]
    s_cbranch_scc1 L_loop_safe2
    s_branch L_drain
.p2align 6
L_loop_safe3:
    v_mfma_f32_16x16x16_bf16 v[160:163], v[32:33], v[38:39], 0
    s_cmp_ge_u32 s18, 2
    ds_read_b128 v[172:175], v2 offset:18432
    ds_read_b128 v[196:199], v2 offset:19456
    v_mfma_f32_16x16x32_bf16 v[108:111], v[212:215], a[168:171], 0
    s_cselect_b32 s14, s36, 0
    s_add_u32 s34, s18, 2
    v_cvt_pk_bf16_f32 v128, v128, v129
    v_mfma_f32_16x16x32_bf16 v[108:111], v[176:179], a[172:175], v[108:111]
    s_cmp_lt_u32 s34, s17
    v_rsq_f32 v161, v161
    v_mfma_f32_16x16x32_bf16 v[108:111], v[216:219], a[176:179], v[108:111]
    s_cselect_b32 s10, s36, 0
    v_rsq_f32 v160, v160
    v_mfma_f32_16x16x32_bf16 v[108:111], v[120:123], a[180:183], v[108:111]
    s_add_u32 m0, s28, 0
    ds_read_b128 v[112:115], v0 offset:26624
    v_mul_f32 v160, s31, v160
    v_mfma_f32_16x16x32_bf16 v[108:111], v[240:243], a[184:187], v[108:111]
    ds_read_b128 v[132:135], v1 offset:26624
    v_cvt_pk_bf16_f32 v129, v130, v131
    v_mfma_f32_16x16x32_bf16 v[108:111], v[224:227], a[188:191], v[108:111]
    ds_read_b128 v[136:139], v0 offset:26752
    v_mul_f32 v192, v161, v192
    v_mfma_f32_16x16x32_bf16 v[164:167], v[212:215], a[192:195], 0
    ds_read_b128 v[212:215], v1 offset:26752
    v_mul_f32 v193, v161, v193
    v_mfma_f32_16x16x32_bf16 v[164:167], v[176:179], a[196:199], v[164:167]
    s_waitcnt lgkmcnt(4)
    ds_read_b128 v[156:159], v0 offset:26880
    v_cvt_pk_bf16_f32 v108, v108, v109
    v_mfma_f32_16x16x32_bf16 v[168:171], v[32:35], v[172:175], 0
    v_cvt_pk_bf16_f32 v109, v110, v111
    v_cvt_pk_bf16_f32 v176, v192, v193
    v_mfma_f32_16x16x32_bf16 v[168:171], v[32:35], v[196:199], v[168:171]
    v_mul_f32 v194, v161, v194
    v_mul_f32 v195, v161, v195
    v_mfma_f32_16x16x32_bf16 v[164:167], v[216:219], a[200:203], v[164:167]
    ds_read_b128 v[216:219], v1 offset:26880
    v_cvt_pk_bf16_f32 v177, v194, v195
    v_mfma_f32_16x16x32_bf16 v[164:167], v[120:123], a[204:207], v[164:167]
    s_waitcnt lgkmcnt(5)
    v_mul_f32 v152, v161, v152
    v_mul_f32 v110, 0x3baaaaab, v168
    v_mfma_f32_16x16x32_bf16 v[164:167], v[240:243], a[208:211], v[164:167]
    s_waitcnt lgkmcnt(4)
    v_rsq_f32 v110, v110
    v_mfma_f32_16x16x32_bf16 v[164:167], v[224:227], a[212:215], v[164:167]
    s_waitcnt lgkmcnt(3)
    v_mul_f32 v162, 0x3baaaaab, v169
    v_mul_f32 v163, 0x3baaaaab, v170
    v_mfma_f32_16x16x32_bf16 v[224:227], a[72:75], v[112:115], 0
    s_waitcnt lgkmcnt(2)
    v_rsq_f32 v162, v162
    v_mfma_f32_16x16x32_bf16 v[224:227], a[76:79], v[132:135], v[224:227]
    s_waitcnt lgkmcnt(1)
    v_cvt_pk_bf16_f32 v192, v164, v165
    v_cvt_pk_bf16_f32 v193, v166, v167
    v_mfma_f32_16x16x32_bf16 v[224:227], a[80:83], v[136:139], v[224:227]
    v_rsq_f32 v163, v163
    v_mfma_f32_16x16x32_bf16 v[224:227], a[84:87], v[212:215], v[224:227]
    v_mul_f32 v140, v110, v140
    v_mul_f32 v141, v110, v141
    v_mfma_f32_16x16x32_bf16 v[224:227], a[88:91], v[156:159], v[224:227]
    s_waitcnt lgkmcnt(0)
    v_cvt_pk_bf16_f32 v140, v140, v141
    v_mul_f32 v142, v110, v142
    v_mfma_f32_16x16x32_bf16 v[224:227], a[92:95], v[216:219], v[224:227]
    v_mul_f32 v143, v110, v143
    v_cvt_pk_bf16_f32 v141, v142, v143
    v_mfma_f32_16x16x32_bf16 v[240:243], a[96:99], v[112:115], 0
    v_mul_f32 v188, v110, v188
    v_mul_f32 v189, v110, v189
    v_mfma_f32_16x16x32_bf16 v[240:243], a[100:103], v[132:135], v[240:243]
    v_cvt_pk_bf16_f32 v142, v188, v189
    v_mul_f32 v190, v110, v190
    v_mfma_f32_16x16x32_bf16 v[240:243], a[104:107], v[136:139], v[240:243]
    v_mul_f32 v191, v110, v191
    v_cvt_pk_bf16_f32 v143, v190, v191
    v_mfma_f32_16x16x32_bf16 v[240:243], a[108:111], v[212:215], v[240:243]
    buffer_store_dwordx4 v[140:143], v15, s[12:15], s27 offen
    v_mul_f32 v244, v110, v244
    v_mul_f32 v245, v110, v245
    v_cvt_pk_bf16_f32 v130, v244, v245
    v_mul_f32 v246, v110, v246
    v_mfma_f32_16x16x32_bf16 v[240:243], a[112:115], v[156:159], v[240:243]
    v_mul_f32 v247, v110, v247
    v_cvt_pk_bf16_f32 v131, v246, v247
    v_mfma_f32_16x16x32_bf16 v[240:243], a[116:119], v[216:219], v[240:243]
    v_mul_f32 v153, v161, v153
    v_cvt_pk_bf16_f32 v178, v152, v153
    v_mfma_f32_16x16x32_bf16 v[140:143], a[120:123], v[112:115], 0
    v_mul_f32 v154, v161, v154
    v_mul_f32 v155, v161, v155
    v_mfma_f32_16x16x32_bf16 v[140:143], a[124:127], v[132:135], v[140:143]
    v_cvt_pk_bf16_f32 v179, v154, v155
    v_mul_f32 v144, v161, v144
    v_mfma_f32_16x16x32_bf16 v[140:143], a[128:131], v[136:139], v[140:143]
    v_mul_f32 v145, v161, v145
    v_cvt_pk_bf16_f32 v154, v144, v145
    v_mfma_f32_16x16x32_bf16 v[140:143], a[132:135], v[212:215], v[140:143]
    v_mul_f32 v146, v161, v146
    v_mul_f32 v147, v161, v147
    v_mfma_f32_16x16x32_bf16 v[140:143], a[136:139], v[156:159], v[140:143]
    v_cvt_pk_bf16_f32 v155, v146, v147
    v_mul_f32 v124, v160, v124
    v_mfma_f32_16x16x32_bf16 v[140:143], a[140:143], v[216:219], v[140:143]
    v_mul_f32 v125, v160, v125
    v_cvt_pk_bf16_f32 v188, v124, v125
    v_mfma_f32_16x16x32_bf16 v[244:247], a[0:3], v[112:115], 0
    v_mul_f32 v126, v160, v126
    v_mul_f32 v127, v160, v127
    v_mfma_f32_16x16x32_bf16 v[244:247], a[4:7], v[132:135], v[244:247]
    v_cvt_pk_bf16_f32 v189, v126, v127
    v_mul_f32 v180, v160, v180
    v_mfma_f32_16x16x32_bf16 v[244:247], a[8:11], v[136:139], v[244:247]
    v_mul_f32 v181, v160, v181
    v_cvt_pk_bf16_f32 v190, v180, v181
    v_mfma_f32_16x16x32_bf16 v[244:247], a[12:15], v[212:215], v[244:247]
    v_mul_f32 v182, v160, v182
    v_mul_f32 v183, v160, v183
    v_mfma_f32_16x16x32_bf16 v[244:247], a[16:19], v[156:159], v[244:247]
    v_cvt_pk_bf16_f32 v191, v182, v183
    v_mul_f32 v220, v160, v220
    v_mfma_f32_16x16x32_bf16 v[244:247], a[20:23], v[216:219], v[244:247]
    v_mul_f32 v221, v160, v221
    v_cvt_pk_bf16_f32 v152, v220, v221
    v_mfma_f32_16x16x32_bf16 v[120:123], a[24:27], v[112:115], 0
    v_mul_f32 v222, v160, v222
    v_mul_f32 v223, v160, v223
    v_mfma_f32_16x16x32_bf16 v[120:123], a[28:31], v[132:135], v[120:123]
    v_cvt_pk_bf16_f32 v153, v222, v223
    v_fma_f32 v110, v224, v224, s32
    v_mfma_f32_16x16x32_bf16 v[120:123], a[32:35], v[136:139], v[120:123]
    buffer_store_dwordx2 v[130:131], v18, s[12:15], s27 offen
    v_fma_f32 v111, v244, v244, s32
    v_fmac_f32 v111, v245, v245
    v_mfma_f32_16x16x32_bf16 v[120:123], a[36:39], v[212:215], v[120:123]
    v_fmac_f32 v111, v246, v246
    v_fmac_f32 v111, v247, v247
    v_mfma_f32_16x16x32_bf16 v[120:123], a[40:43], v[156:159], v[120:123]
    v_fmac_f32 v110, v225, v225
    v_fmac_f32 v110, v226, v226
    v_mfma_f32_16x16x32_bf16 v[120:123], a[44:47], v[216:219], v[120:123]
    v_fmac_f32 v110, v227, v227
    v_fmac_f32 v110, v240, v240
    v_mfma_f32_16x16x32_bf16 v[144:147], a[48:51], v[112:115], 0
    v_fmac_f32 v110, v241, v241
    v_fmac_f32 v110, v242, v242
    v_mfma_f32_16x16x32_bf16 v[144:147], a[52:55], v[132:135], v[144:147]
    v_fmac_f32 v110, v243, v243
    v_fmac_f32 v110, v140, v140
    v_mfma_f32_16x16x32_bf16 v[144:147], a[56:59], v[136:139], v[144:147]
    v_fmac_f32 v111, v120, v120
    v_fmac_f32 v111, v121, v121
    v_mfma_f32_16x16x32_bf16 v[144:147], a[60:63], v[212:215], v[144:147]
    v_fmac_f32 v111, v122, v122
    v_fmac_f32 v111, v123, v123
    v_mfma_f32_16x16x32_bf16 v[144:147], a[64:67], v[156:159], v[144:147]
    v_fmac_f32 v110, v141, v141
    v_fmac_f32 v110, v142, v142
    v_mfma_f32_16x16x32_bf16 v[144:147], a[68:71], v[216:219], v[144:147]
    v_fmac_f32 v110, v143, v143
    v_mul_f32 v148, v163, v148
    v_mfma_f32_16x16x32_bf16 v[124:127], v[112:115], a[144:147], 0
    v_mul_f32 v149, v163, v149
    v_cvt_pk_bf16_f32 v148, v148, v149
    v_mfma_f32_16x16x32_bf16 v[124:127], v[132:135], a[148:151], v[124:127]
    v_mul_f32 v150, v163, v150
    v_mul_f32 v151, v163, v151
    v_mfma_f32_16x16x32_bf16 v[124:127], v[136:139], a[152:155], v[124:127]
    v_fmac_f32 v111, v144, v144
    v_fmac_f32 v111, v145, v145
    v_mfma_f32_16x16x32_bf16 v[124:127], v[212:215], a[156:159], v[124:127]
    v_fmac_f32 v111, v146, v146
    v_fmac_f32 v111, v147, v147
    v_mfma_f32_16x16x32_bf16 v[124:127], v[156:159], a[160:163], v[124:127]
    v_cvt_pk_bf16_f32 v38, v111, v110
    v_cvt_pk_bf16_f32 v149, v150, v151
    v_mfma_f32_16x16x32_bf16 v[124:127], v[216:219], a[164:167], v[124:127]
    v_mul_f32 v200, v163, v200
    v_mul_f32 v201, v163, v201
    v_mfma_f32_16x16x16_bf16 v[180:183], v[32:33], v[38:39], 0
    v_cvt_pk_bf16_f32 v150, v200, v201
    v_mul_f32 v202, v163, v202
    v_mfma_f32_16x16x32_bf16 v[220:223], v[112:115], a[168:171], 0
    v_mul_f32 v203, v163, v203
    v_cvt_pk_bf16_f32 v151, v202, v203
    v_mfma_f32_16x16x32_bf16 v[220:223], v[132:135], a[172:175], v[220:223]
    buffer_store_dwordx4 v[148:151], v17, s[12:15], s27 offen
    v_cvt_pk_bf16_f32 v130, v124, v125
    v_cvt_pk_bf16_f32 v131, v126, v127
    v_rsq_f32 v181, v181
    v_mfma_f32_16x16x32_bf16 v[220:223], v[136:139], a[176:179], v[220:223]
    v_rsq_f32 v180, v180
    v_mfma_f32_16x16x32_bf16 v[220:223], v[212:215], a[180:183], v[220:223]
    ds_read_b128 v[148:151], v0 offset:32768
    v_mul_f32 v180, s31, v180
    v_mfma_f32_16x16x32_bf16 v[220:223], v[156:159], a[184:187], v[220:223]
    ds_read_b128 v[200:203], v1 offset:32768
    v_mul_f32 v224, v181, v224
    v_mfma_f32_16x16x32_bf16 v[220:223], v[216:219], a[188:191], v[220:223]
    ds_read_b128 v[124:127], v0 offset:32896
    v_mul_f32 v225, v181, v225
    v_mfma_f32_16x16x32_bf16 v[164:167], v[112:115], a[192:195], 0
    ds_read_b128 v[112:115], v1 offset:32896
    v_cvt_pk_bf16_f32 v224, v224, v225
    v_mfma_f32_16x16x32_bf16 v[164:167], v[132:135], a[196:199], v[164:167]
    ds_read_b128 v[132:135], v0 offset:33024
    v_mul_f32 v226, v181, v226
    v_mfma_f32_16x16x32_bf16 v[164:167], v[136:139], a[200:203], v[164:167]
    ds_read_b128 v[136:139], v1 offset:33024
    v_cvt_pk_bf16_f32 v110, v220, v221
    v_mfma_f32_16x16x32_bf16 v[164:167], v[212:215], a[204:207], v[164:167]
    v_cvt_pk_bf16_f32 v111, v222, v223
    v_mul_f32 v227, v181, v227
    v_mfma_f32_16x16x32_bf16 v[164:167], v[156:159], a[208:211], v[164:167]
    v_cvt_pk_bf16_f32 v225, v226, v227
    v_mul_f32 v240, v181, v240
    v_mfma_f32_16x16x32_bf16 v[164:167], v[216:219], a[212:215], v[164:167]
    s_waitcnt lgkmcnt(5)
    v_mul_f32 v241, v181, v241
    v_cvt_pk_bf16_f32 v226, v240, v241
    v_mfma_f32_16x16x32_bf16 v[216:219], a[72:75], v[148:151], 0
    s_waitcnt lgkmcnt(4)
    v_mul_f32 v242, v181, v242
    v_mul_f32 v243, v181, v243
    v_mfma_f32_16x16x32_bf16 v[216:219], a[76:79], v[200:203], v[216:219]
    s_waitcnt lgkmcnt(3)
    v_cvt_pk_bf16_f32 v194, v164, v165
    v_cvt_pk_bf16_f32 v195, v166, v167
    v_mfma_f32_16x16x32_bf16 v[216:219], a[80:83], v[124:127], v[216:219]
    s_waitcnt lgkmcnt(2)
    v_cvt_pk_bf16_f32 v227, v242, v243
    v_mul_f32 v140, v181, v140
    v_mfma_f32_16x16x32_bf16 v[216:219], a[84:87], v[112:115], v[216:219]
    s_waitcnt lgkmcnt(1)
    v_mul_f32 v141, v181, v141
    v_cvt_pk_bf16_f32 v214, v140, v141
    v_mfma_f32_16x16x32_bf16 v[216:219], a[88:91], v[132:135], v[216:219]
    s_waitcnt lgkmcnt(0)
    v_mul_f32 v142, v181, v142
    v_mul_f32 v143, v181, v143
    v_mfma_f32_16x16x32_bf16 v[216:219], a[92:95], v[136:139], v[216:219]
    v_cvt_pk_bf16_f32 v215, v142, v143
    v_mul_f32 v244, v180, v244
    v_mfma_f32_16x16x32_bf16 v[140:143], a[96:99], v[148:151], 0
    v_mul_f32 v245, v180, v245
    v_cvt_pk_bf16_f32 v240, v244, v245
    v_mfma_f32_16x16x32_bf16 v[140:143], a[100:103], v[200:203], v[140:143]
    v_mul_f32 v246, v180, v246
    v_mul_f32 v247, v180, v247
    v_mfma_f32_16x16x32_bf16 v[140:143], a[104:107], v[124:127], v[140:143]
    v_cvt_pk_bf16_f32 v241, v246, v247
    v_mul_f32 v120, v180, v120
    v_mfma_f32_16x16x32_bf16 v[140:143], a[108:111], v[112:115], v[140:143]
    v_mul_f32 v121, v180, v121
    v_cvt_pk_bf16_f32 v242, v120, v121
    v_mfma_f32_16x16x32_bf16 v[140:143], a[112:115], v[132:135], v[140:143]
    v_mul_f32 v122, v180, v122
    v_mul_f32 v123, v180, v123
    v_mfma_f32_16x16x32_bf16 v[140:143], a[116:119], v[136:139], v[140:143]
    v_cvt_pk_bf16_f32 v243, v122, v123
    v_mul_f32 v144, v180, v144
    v_mfma_f32_16x16x32_bf16 v[244:247], a[120:123], v[148:151], 0
    v_mul_f32 v145, v180, v145
    v_cvt_pk_bf16_f32 v212, v144, v145
    v_mfma_f32_16x16x32_bf16 v[244:247], a[124:127], v[200:203], v[244:247]
    v_mul_f32 v146, v180, v146
    v_mul_f32 v147, v180, v147
    v_mfma_f32_16x16x32_bf16 v[244:247], a[128:131], v[124:127], v[244:247]
    v_cvt_pk_bf16_f32 v213, v146, v147
    v_fma_f32 v160, v216, v216, s32
    v_mfma_f32_16x16x32_bf16 v[244:247], a[132:135], v[112:115], v[244:247]
    v_fmac_f32 v160, v217, v217
    v_fmac_f32 v160, v218, v218
    v_mfma_f32_16x16x32_bf16 v[244:247], a[136:139], v[132:135], v[244:247]
    v_fmac_f32 v160, v219, v219
    v_fmac_f32 v160, v140, v140
    v_mfma_f32_16x16x32_bf16 v[244:247], a[140:143], v[136:139], v[244:247]
    s_waitcnt vmcnt(3)
    v_fmac_f32 v160, v141, v141
    v_fmac_f32 v160, v142, v142
    v_mfma_f32_16x16x32_bf16 v[120:123], a[0:3], v[148:151], 0
    s_nop 0
    v_fmac_f32 v160, v143, v143
    v_mul_f32 v232, v163, v232
    v_mfma_f32_16x16x32_bf16 v[120:123], a[4:7], v[200:203], v[120:123]
    s_nop 0
    v_fmac_f32 v160, v244, v244
    v_fmac_f32 v160, v245, v245
    v_mfma_f32_16x16x32_bf16 v[120:123], a[8:11], v[124:127], v[120:123]
    s_nop 0
    v_fmac_f32 v160, v246, v246
    v_fmac_f32 v160, v247, v247
    v_mfma_f32_16x16x32_bf16 v[120:123], a[12:15], v[112:115], v[120:123]
    s_barrier
    buffer_load_dwordx4 v10, s[8:11], s23 offen nt lds
    v_mul_f32 v233, v163, v233
    v_mfma_f32_16x16x32_bf16 v[120:123], a[16:19], v[132:135], v[120:123]
    s_add_u32 m0, s28, 4096
    v_cvt_pk_bf16_f32 v232, v232, v233
    v_mul_f32 v234, v163, v234
    v_mfma_f32_16x16x32_bf16 v[120:123], a[20:23], v[136:139], v[120:123]
    v_mul_f32 v235, v163, v235
    v_cvt_pk_bf16_f32 v233, v234, v235
    v_mfma_f32_16x16x32_bf16 v[144:147], a[24:27], v[148:151], 0
    v_mul_f32 v116, v162, v116
    v_mul_f32 v117, v162, v117
    v_mfma_f32_16x16x32_bf16 v[144:147], a[28:31], v[200:203], v[144:147]
    v_cvt_pk_bf16_f32 v116, v116, v117
    v_mul_f32 v118, v162, v118
    v_mfma_f32_16x16x32_bf16 v[144:147], a[32:35], v[124:127], v[144:147]
    buffer_load_dwordx4 v11, s[8:11], s23 offen nt lds
    v_fma_f32 v161, v120, v120, s32
    v_mfma_f32_16x16x32_bf16 v[144:147], a[36:39], v[112:115], v[144:147]
    s_add_u32 m0, s28, 8192
    v_fmac_f32 v161, v121, v121
    v_fmac_f32 v161, v122, v122
    v_mfma_f32_16x16x32_bf16 v[144:147], a[40:43], v[132:135], v[144:147]
    v_fmac_f32 v161, v123, v123
    v_mul_f32 v119, v162, v119
    v_mfma_f32_16x16x32_bf16 v[144:147], a[44:47], v[136:139], v[144:147]
    v_cvt_pk_bf16_f32 v117, v118, v119
    v_mul_f32 v208, v162, v208
    v_mfma_f32_16x16x32_bf16 v[180:183], a[48:51], v[148:151], 0
    v_mul_f32 v209, v162, v209
    v_cvt_pk_bf16_f32 v118, v208, v209
    v_mfma_f32_16x16x32_bf16 v[180:183], a[52:55], v[200:203], v[180:183]
    buffer_load_dwordx4 v12, s[8:11], s23 offen nt lds
    v_mul_f32 v210, v162, v210
    v_mfma_f32_16x16x32_bf16 v[180:183], a[56:59], v[124:127], v[180:183]
    s_add_u32 m0, s28, 12288
    v_fmac_f32 v161, v144, v144
    v_fmac_f32 v161, v145, v145
    v_mfma_f32_16x16x32_bf16 v[180:183], a[60:63], v[112:115], v[180:183]
    s_xor_b32 s28, s28, 65536
    ds_read_b128 v[220:223], v5 offset:0
    ds_read_b128 v[156:159], v5 offset:16
    v_mfma_f32_16x16x32_bf16 v[180:183], a[64:67], v[132:135], v[180:183]
    ds_read_b128 v[164:167], v5 offset:48
    ds_read_b32 v163, v6 offset:192
    v_mfma_f32_16x16x32_bf16 v[180:183], a[68:71], v[136:139], v[180:183]
    ds_read2_b32 v[170:171], v6 offset0:0 offset1:0
    ds_read2_b32 v[174:175], v6 offset0:16 offset1:16
    v_mfma_f32_16x16x32_bf16 v[184:187], v[148:151], a[144:147], 0
    buffer_load_dwordx4 v13, s[8:11], s23 offen nt lds
    ds_read2_b32 v[198:199], v6 offset0:32 offset1:32
    v_mfma_f32_16x16x32_bf16 v[184:187], v[200:203], a[148:151], v[184:187]
    s_mov_b32 m0, s29
    v_fmac_f32 v161, v146, v146
    v_fmac_f32 v161, v147, v147
    v_mfma_f32_16x16x32_bf16 v[184:187], v[124:127], a[152:155], v[184:187]
    s_xor_b32 s29, s29, s30
    v_fmac_f32 v161, v180, v180
    v_fmac_f32 v161, v181, v181
    v_mfma_f32_16x16x32_bf16 v[184:187], v[112:115], a[156:159], v[184:187]
    s_add_u32 s19, s19, s20
    v_fmac_f32 v161, v182, v182
    v_fmac_f32 v161, v183, v183
    v_mfma_f32_16x16x32_bf16 v[184:187], v[132:135], a[160:163], v[184:187]
    v_cvt_pk_bf16_f32 v38, v161, v160
    v_mul_f32 v211, v162, v211
    v_mfma_f32_16x16x32_bf16 v[184:187], v[136:139], a[164:167], v[184:187]
    s_waitcnt lgkmcnt(5)
    buffer_store_dwordx2 v[232:233], v20, s[12:15], s27 offen
    v_cvt_pk_bf16_f32 v119, v210, v211
    v_mul_f32 v228, v162, v228
    v_mfma_f32_16x16x16_bf16 v[208:211], v[32:33], v[38:39], 0
    s_waitcnt lgkmcnt(2)
    v_mul_f32 v229, v162, v229
    v_cvt_pk_bf16_f32 v228, v228, v229
    v_mfma_f32_16x16x32_bf16 v[232:235], v[220:223], v[188:191], v[22:25]
    s_waitcnt lgkmcnt(1)
    v_cvt_pk_bf16_f32 v168, v184, v185
    v_cvt_pk_bf16_f32 v169, v186, v187
    v_mfma_f32_16x16x32_bf16 v[232:235], v[156:159], v[176:179], v[232:235]
    s_waitcnt lgkmcnt(0)
    v_rsq_f32 v209, v209
    v_mfma_f32_16x16x32_bf16 v[232:235], v[164:167], v[152:155], v[232:235]
    v_rsq_f32 v208, v208
    v_mfma_f32_16x16x32_bf16 v[184:187], v[148:151], a[168:171], 0
    v_mul_f32 v208, s31, v208
    v_mul_f32 v216, v209, v216
    v_mfma_f32_16x16x32_bf16 v[184:187], v[200:203], a[172:175], v[184:187]
    v_mul_f32 v217, v209, v217
    v_cvt_pk_bf16_f32 v216, v216, v217
    v_mfma_f32_16x16x32_bf16 v[184:187], v[124:127], a[176:179], v[184:187]
    v_mov_b32_dpp v163, v233 quad_perm:[0,1,2,3] row_mask:0x1 bank_mask:0xf
    v_mul_f32 v218, v209, v218
    v_mfma_f32_16x16x32_bf16 v[184:187], v[112:115], a[180:183], v[184:187]
    v_mul_f32 v219, v209, v219
    v_cvt_pk_bf16_f32 v217, v218, v219
    v_mfma_f32_16x16x32_bf16 v[184:187], v[132:135], a[184:187], v[184:187]
    v_mul_f32 v140, v209, v140
    v_mul_f32 v141, v209, v141
    v_mfma_f32_16x16x32_bf16 v[184:187], v[136:139], a[188:191], v[184:187]
    v_cvt_pk_bf16_f32 v218, v140, v141
    v_mul_f32 v142, v209, v142
    v_mfma_f32_16x16x32_bf16 v[204:207], v[148:151], a[192:195], 0
    v_mul_f32 v143, v209, v143
    v_cvt_pk_bf16_f32 v219, v142, v143
    v_mfma_f32_16x16x32_bf16 v[204:207], v[200:203], a[196:199], v[204:207]
    v_mul_f32 v244, v209, v244
    v_mul_f32 v245, v209, v245
    v_mfma_f32_16x16x32_bf16 v[204:207], v[124:127], a[200:203], v[204:207]
    ds_read_b128 v[148:151], v2 offset:0
    v_cvt_pk_bf16_f32 v172, v184, v185
    v_mfma_f32_16x16x32_bf16 v[204:207], v[112:115], a[204:207], v[204:207]
    ds_read_b128 v[200:203], v2 offset:1024
    v_cvt_pk_bf16_f32 v173, v186, v187
    v_mfma_f32_16x16x32_bf16 v[204:207], v[132:135], a[208:211], v[204:207]
    ds_read_b128 v[124:127], v2 offset:2048
    v_cvt_pk_bf16_f32 v114, v244, v245
    v_mfma_f32_16x16x32_bf16 v[204:207], v[136:139], a[212:215], v[204:207]
    ds_read_b128 v[132:135], v2 offset:3072
    ds_read_b128 v[136:139], v2 offset:4096
    v_mfma_f32_16x16x32_bf16 v[184:187], v[176:179], v[188:191], v[40:43]
    ds_read_b128 v[236:239], v2 offset:5120
    buffer_store_dwordx4 v[116:119], v16, s[12:15], s27 offen
    v_mul_f32 v246, v209, v246
    v_mul_f32 v247, v209, v247
    v_cvt_pk_bf16_f32 v115, v246, v247
    v_cvt_pk_bf16_f32 v196, v204, v205
    v_mfma_f32_16x16x32_bf16 v[248:251], v[224:227], v[188:191], v[44:47]
    v_cvt_pk_bf16_f32 v197, v206, v207
    v_mul_f32 v120, v208, v120
    v_mfma_f32_16x16x32_bf16 v[204:207], v[216:219], v[188:191], v[48:51]
    v_mul_f32 v121, v208, v121
    v_cvt_pk_bf16_f32 v120, v120, v121
    v_mfma_f32_16x16x16_bf16 v[184:187], v[154:155], v[152:153], v[184:187]
    s_waitcnt lgkmcnt(5)
    v_mul_f32 v122, v208, v122
    v_mul_f32 v123, v208, v123
    v_mfma_f32_16x16x16_bf16 v[248:251], v[214:215], v[152:153], v[248:251]
    s_waitcnt lgkmcnt(4)
    v_cvt_pk_bf16_f32 v121, v122, v123
    v_mul_f32 v144, v208, v144
    v_mfma_f32_16x16x16_bf16 v[204:207], v[114:115], v[152:153], v[204:207]
    s_waitcnt lgkmcnt(3)
    v_mul_f32 v145, v208, v145
    v_cvt_pk_bf16_f32 v122, v144, v145
    v_mfma_f32_16x16x32_bf16 v[252:255], v[220:223], v[240:243], v[24:27]
    s_waitcnt lgkmcnt(1)
    v_mul_f32 v146, v208, v146
    v_mul_f32 v147, v208, v147
    v_mfma_f32_16x16x32_bf16 v[252:255], v[156:159], v[224:227], v[252:255]
    s_waitcnt lgkmcnt(0)
    v_cvt_pk_bf16_f32 v123, v146, v147
    v_mul_f32 v180, v208, v180
    v_mfma_f32_16x16x32_bf16 v[252:255], v[164:167], v[212:215], v[252:255]
    v_mul_f32 v181, v208, v181
    v_cvt_pk_bf16_f32 v112, v180, v181
    v_mfma_f32_16x16x32_bf16 v[144:147], v[220:223], v[120:123], v[26:29]
    v_mul_f32 v182, v208, v182
    v_mul_f32 v183, v208, v183
    v_mfma_f32_16x16x32_bf16 v[144:147], v[156:159], v[216:219], v[144:147]
    v_cvt_pk_bf16_f32 v113, v182, v183
    v_max3_f32 v152, v232, v184, v185
    v_mfma_f32_16x16x32_bf16 v[140:143], a[216:219], v[148:151], 0
    v_max3_f32 v152, v152, v186, v187
    v_max3_f32 v152, v152, v248, v249
    v_mfma_f32_16x16x32_bf16 v[144:147], v[164:167], v[112:115], v[144:147]
    v_max3_f32 v152, v152, v250, v251
    v_max3_f32 v152, v152, v204, v205
    v_mfma_f32_16x16x32_bf16 v[140:143], a[220:223], v[200:203], v[140:143]
    v_max3_f32 v152, v152, v206, v207
    v_mov_b32 v153, v152
    v_mfma_f32_16x16x32_bf16 v[140:143], a[224:227], v[124:127], v[140:143]
    v_mov_b32_dpp v163, v253 quad_perm:[0,1,2,3] row_mask:0x2 bank_mask:0xf
    v_mul_f32 v230, v162, v230
    v_mfma_f32_16x16x32_bf16 v[140:143], a[228:231], v[132:135], v[140:143]
    v_mov_b32_dpp v163, v145 quad_perm:[0,1,2,3] row_mask:0x4 bank_mask:0xf
    v_mul_f32 v231, v162, v231
    v_mfma_f32_16x16x32_bf16 v[140:143], a[232:235], v[136:139], v[140:143]
    v_permlane32_swap_b32 v152, v153
    v_mfma_f32_16x16x32_bf16 v[140:143], a[236:239], v[236:239], v[140:143]
    v_max_f32 v152, v152, v153
    v_mov_b32 v153, v152
    v_mfma_f32_16x16x32_bf16 v[188:191], a[240:243], v[148:151], 0
    v_cvt_pk_bf16_f32 v229, v230, v231
    v_mov_b32 v145, v163
    v_mfma_f32_16x16x32_bf16 v[188:191], a[244:247], v[200:203], v[188:191]
    buffer_store_dwordx2 v[228:229], v19, s[12:15], s27 offen
    v_permlane16_swap_b32 v152, v153
    v_mfma_f32_16x16x32_bf16 v[188:191], a[248:251], v[124:127], v[188:191]
    s_mov_b32 s27, s26
    v_max_f32 v152, v152, v153
    v_sub_f32 v184, v184, v152
    v_mfma_f32_16x16x32_bf16 v[188:191], a[252:255], v[132:135], v[188:191]
    s_mov_b32 s26, s25
    ds_read_b128 v[180:183], v2 offset:6144
    v_sub_f32 v185, v185, v152
    v_mfma_f32_16x16x32_bf16 v[188:191], v[76:79], v[136:139], v[188:191]
    s_mov_b32 s25, s24
    ds_read_b128 v[220:223], v2 offset:7168
    v_sub_f32 v186, v186, v152
    v_mfma_f32_16x16x32_bf16 v[188:191], v[80:83], v[236:239], v[188:191]
    s_mov_b32 s24, s23
    ds_read_b128 v[156:159], v2 offset:8192
    v_sub_f32 v187, v187, v152
    v_mfma_f32_16x16x32_bf16 v[244:247], v[84:87], v[148:151], 0
    ds_read_b128 v[148:151], v2 offset:9216
    v_sub_f32 v248, v248, v152
    v_mfma_f32_16x16x32_bf16 v[244:247], v[88:91], v[200:203], v[244:247]
    ds_read_b128 v[200:203], v2 offset:10240
    v_sub_f32 v249, v249, v152
    v_mfma_f32_16x16x32_bf16 v[244:247], v[92:95], v[124:127], v[244:247]
    ds_read_b128 v[124:127], v2 offset:11264
    v_sub_f32 v250, v250, v152
    v_mfma_f32_16x16x32_bf16 v[244:247], v[96:99], v[132:135], v[244:247]
    v_exp_f32 v184, v184
    v_mfma_f32_16x16x32_bf16 v[244:247], v[100:103], v[136:139], v[244:247]
    v_exp_f32 v185, v185
    v_mfma_f32_16x16x32_bf16 v[244:247], v[104:107], v[236:239], v[244:247]
    s_waitcnt lgkmcnt(5)
    v_cvt_pk_bf16_f32 v136, v184, v185
    v_sub_f32 v251, v251, v152
    v_mfma_f32_16x16x32_bf16 v[116:119], a[216:219], v[180:183], 0
    s_waitcnt lgkmcnt(4)
    v_exp_f32 v186, v186
    v_mfma_f32_16x16x32_bf16 v[116:119], a[220:223], v[220:223], v[116:119]
    s_waitcnt lgkmcnt(3)
    v_exp_f32 v187, v187
    v_mfma_f32_16x16x32_bf16 v[116:119], a[224:227], v[156:159], v[116:119]
    s_waitcnt lgkmcnt(2)
    v_cvt_pk_bf16_f32 v137, v186, v187
    v_sub_f32 v204, v204, v152
    v_mfma_f32_16x16x32_bf16 v[116:119], a[228:231], v[148:151], v[116:119]
    s_waitcnt lgkmcnt(1)
    v_exp_f32 v248, v248
    v_mfma_f32_16x16x32_bf16 v[132:135], v[176:179], v[240:243], v[52:55]
    s_waitcnt lgkmcnt(0)
    v_exp_f32 v249, v249
    v_mfma_f32_16x16x32_bf16 v[164:167], v[224:227], v[240:243], v[56:59]
    v_cvt_pk_bf16_f32 v138, v248, v249
    v_sub_f32 v205, v205, v152
    v_mfma_f32_16x16x32_bf16 v[184:187], v[216:219], v[240:243], v[60:63]
    buffer_load_dwordx4 v14, s[8:11], s23 offen nt lds
    v_sub_f32 v206, v206, v152
    v_mfma_f32_16x16x16_bf16 v[132:135], v[154:155], v[212:213], v[132:135]
    s_add_u32 s23, s23, s21
    v_exp_f32 v250, v250
    v_mfma_f32_16x16x16_bf16 v[164:167], v[214:215], v[212:213], v[164:167]
    s_cmp_ge_u32 s19, 72
    v_exp_f32 v251, v251
    v_mfma_f32_16x16x16_bf16 v[184:187], v[114:115], v[212:213], v[184:187]
    s_cselect_b32 s34, 72, 0
    v_cvt_pk_bf16_f32 v139, v250, v251
    v_sub_f32 v207, v207, v152
    v_mfma_f32_16x16x32_bf16 v[116:119], a[232:235], v[200:203], v[116:119]
    s_cselect_b32 s35, s22, 0
    v_exp_f32 v204, v204
    v_mfma_f32_16x16x32_bf16 v[116:119], a[236:239], v[124:127], v[116:119]
    s_sub_u32 s19, s19, s34
    v_exp_f32 v205, v205
    v_mfma_f32_16x16x32_bf16 v[208:211], a[240:243], v[180:183], 0
    s_add_u32 s23, s23, s35
    v_cvt_pk_bf16_f32 v36, v204, v205
    v_sub_f32 v232, v232, v152
    v_mfma_f32_16x16x32_bf16 v[208:211], a[244:247], v[220:223], v[208:211]
    s_add_u32 s18, s18, 1
    v_exp_f32 v206, v206
    v_mfma_f32_16x16x32_bf16 v[208:211], a[248:251], v[156:159], v[208:211]
    s_cmp_lt_u32 s18, s17
    v_exp_f32 v207, v207
    v_mfma_f32_16x16x32_bf16 v[208:211], a[252:255], v[148:151], v[208:211]
    ds_read_b128 v[240:243], v2 offset:12288
    v_cvt_pk_bf16_f32 v37, v206, v207
    v_mfma_f32_16x16x32_bf16 v[208:211], v[76:79], v[200:203], v[208:211]
    ds_read_b128 v[204:207], v2 offset:13312
    v_max3_f32 v146, v252, v132, v133
    v_mfma_f32_16x16x32_bf16 v[208:211], v[80:83], v[124:127], v[208:211]
    ds_read_b128 v[248:251], v2 offset:14336
    v_max3_f32 v146, v146, v134, v135
    v_mfma_f32_16x16x32_bf16 v[228:231], v[84:87], v[180:183], 0
    ds_read_b128 v[180:183], v2 offset:15360
    v_max3_f32 v146, v146, v164, v165
    v_mfma_f32_16x16x32_bf16 v[228:231], v[88:91], v[220:223], v[228:231]
    ds_read_b128 v[220:223], v2 offset:16384
    v_max3_f32 v146, v146, v166, v167
    v_mfma_f32_16x16x32_bf16 v[228:231], v[92:95], v[156:159], v[228:231]
    ds_read_b128 v[156:159], v2 offset:17408
    v_max3_f32 v146, v146, v184, v185
    v_mfma_f32_16x16x32_bf16 v[228:231], v[96:99], v[148:151], v[228:231]
    v_exp_f32 v232, v232
    v_mfma_f32_16x16x32_bf16 v[228:231], v[100:103], v[200:203], v[228:231]
    v_cvt_pk_bf16_f32 v38, v232, 0
    v_max3_f32 v146, v146, v186, v187
    v_mfma_f32_16x16x32_bf16 v[228:231], v[104:107], v[124:127], v[228:231]
    s_waitcnt lgkmcnt(5)
    v_mov_b32 v147, v146
    v_max_f32_dpp v145, v145, v145 quad_perm:[1,0,3,2] row_mask:0xf bank_mask:0xf
    v_mfma_f32_16x16x32_bf16 v[232:235], v[28:31], v[36:39], 0
    s_waitcnt lgkmcnt(4)
    v_permlane32_swap_b32 v146, v147
    v_mfma_f32_16x16x32_bf16 v[232:235], v[28:31], v[136:139], v[232:235]
    s_waitcnt lgkmcnt(3)
    v_max_f32 v146, v146, v147
    v_mov_b32 v147, v146
    v_mfma_f32_16x16x32_bf16 v[200:203], v[168:171], v[36:39], 0
    s_waitcnt lgkmcnt(2)
    v_permlane16_swap_b32 v146, v147
    v_mfma_f32_16x16x32_bf16 v[200:203], v[128:131], v[136:139], v[200:203]
    s_waitcnt lgkmcnt(1)
    v_rcp_f32 v232, v232
    v_mfma_f32_16x16x32_bf16 v[124:127], v[172:175], v[36:39], 0
    s_waitcnt lgkmcnt(0)
    v_max_f32 v146, v146, v147
    v_sub_f32 v132, v132, v146
    v_mfma_f32_16x16x32_bf16 v[124:127], v[108:111], v[136:139], v[124:127]
    v_exp_f32 v132, v132
    v_mfma_f32_16x16x32_bf16 v[236:239], v[196:199], v[36:39], 0
    v_mul_f32 v200, v232, v200
    v_mul_f32 v201, v232, v201
    v_mfma_f32_16x16x32_bf16 v[236:239], v[192:195], v[136:139], v[236:239]
    v_cvt_pk_bf16_f32 v200, v200, v201
    v_mul_f32 v202, v232, v202
    v_mfma_f32_16x16x32_bf16 v[148:151], a[216:219], v[240:243], 0
    v_mul_f32 v203, v232, v203
    v_cvt_pk_bf16_f32 v201, v202, v203
    v_mfma_f32_16x16x32_bf16 v[148:151], a[220:223], v[204:207], v[148:151]
    v_mul_f32 v124, v232, v124
    v_mul_f32 v125, v232, v125
    v_mfma_f32_16x16x32_bf16 v[148:151], a[224:227], v[248:251], v[148:151]
    v_cvt_pk_bf16_f32 v202, v124, v125
    v_mul_f32 v126, v232, v126
    v_mfma_f32_16x16x32_bf16 v[148:151], a[228:231], v[180:183], v[148:151]
    v_mul_f32 v127, v232, v127
    v_cvt_pk_bf16_f32 v203, v126, v127
    v_mfma_f32_16x16x32_bf16 v[148:151], a[232:235], v[220:223], v[148:151]
    ds_write_b128 v3, v[200:203] offset:0
    v_mfma_f32_16x16x32_bf16 v[148:151], a[236:239], v[156:159], v[148:151]
    v_mul_f32 v236, v232, v236
    v_mul_f32 v237, v232, v237
    v_mfma_f32_16x16x32_bf16 v[200:203], a[240:243], v[240:243], 0
    v_cvt_pk_bf16_f32 v152, v236, v237
    v_mul_f32 v238, v232, v238
    v_mfma_f32_16x16x32_bf16 v[200:203], a[244:247], v[204:207], v[200:203]
    v_mul_f32 v239, v232, v239
    v_cvt_pk_bf16_f32 v153, v238, v239
    v_mfma_f32_16x16x32_bf16 v[200:203], a[248:251], v[248:251], v[200:203]
    ds_write_b64 v4, v[152:153] offset:4096
    v_mfma_f32_16x16x32_bf16 v[200:203], a[252:255], v[180:183], v[200:203]
    v_fma_f32 v147, v148, v148, s33
    v_fmac_f32 v147, v149, v149
    v_mfma_f32_16x16x32_bf16 v[200:203], v[76:79], v[220:223], v[200:203]
    v_fmac_f32 v147, v150, v150
    v_fmac_f32 v147, v151, v151
    v_mfma_f32_16x16x32_bf16 v[200:203], v[80:83], v[156:159], v[200:203]
    v_sub_f32 v133, v133, v146
    v_sub_f32 v134, v134, v146
    v_mfma_f32_16x16x32_bf16 v[232:235], v[84:87], v[240:243], 0
    v_exp_f32 v133, v133
    v_mfma_f32_16x16x32_bf16 v[232:235], v[88:91], v[204:207], v[232:235]
    v_cvt_pk_bf16_f32 v240, v132, v133
    v_sub_f32 v135, v135, v146
    v_mfma_f32_16x16x32_bf16 v[232:235], v[92:95], v[248:251], v[232:235]
    v_fmac_f32 v147, v200, v200
    v_fmac_f32 v147, v201, v201
    v_mfma_f32_16x16x32_bf16 v[232:235], v[96:99], v[180:183], v[232:235]
    v_fmac_f32 v147, v202, v202
    v_fmac_f32 v147, v203, v203
    v_mfma_f32_16x16x32_bf16 v[232:235], v[100:103], v[220:223], v[232:235]
    v_exp_f32 v134, v134
    v_mfma_f32_16x16x32_bf16 v[232:235], v[104:107], v[156:159], v[232:235]
    v_exp_f32 v135, v135
    v_sub_f32 v164, v164, v146
    v_cvt_pk_bf16_f32 v241, v134, v135
    v_exp_f32 v164, v164
    v_sub_f32 v165, v165, v146
    v_exp_f32 v165, v165
    v_sub_f32 v166, v166, v146
    v_cvt_pk_bf16_f32 v242, v164, v165
    v_fmac_f32 v147, v232, v232
    v_fmac_f32 v147, v233, v233
    v_fmac_f32 v147, v234, v234
    v_fmac_f32 v147, v235, v235
    v_cvt_pk_bf16_f32 v161, v147, v147
    v_exp_f32 v166, v166
    v_sub_f32 v167, v167, v146
    v_exp_f32 v167, v167
    v_sub_f32 v184, v184, v146
    v_cvt_pk_bf16_f32 v243, v166, v167
    v_exp_f32 v184, v184
    v_sub_f32 v185, v185, v146
    v_exp_f32 v185, v185
    v_sub_f32 v186, v186, v146
    v_cvt_pk_bf16_f32 v36, v184, v185
    v_exp_f32 v186, v186
    v_sub_f32 v187, v187, v146
    v_exp_f32 v187, v187
    v_mfma_f32_16x16x32_bf16 v[132:135], v[176:179], v[120:123], v[64:67]
    v_cvt_pk_bf16_f32 v37, v186, v187
    v_sub_f32 v252, v252, v146
    v_mfma_f32_16x16x32_bf16 v[176:179], v[224:227], v[120:123], v[68:71]
    v_exp_f32 v252, v252
    v_mfma_f32_16x16x32_bf16 v[224:227], v[216:219], v[120:123], v[72:75]
    v_cvt_pk_bf16_f32 v38, v252, 0
    v_max_f32_dpp v145, v145, v145 quad_perm:[2,3,0,1] row_mask:0xf bank_mask:0xf
    v_mfma_f32_16x16x16_bf16 v[132:135], v[154:155], v[112:113], v[132:135]
    v_fma_f32 v160, v116, v116, s33
    v_max_f32_dpp v145, v145, v145 row_half_mirror row_mask:0xf bank_mask:0xf
    v_mfma_f32_16x16x16_bf16 v[176:179], v[214:215], v[112:113], v[176:179]
    v_fmac_f32 v160, v117, v117
    v_max_f32_dpp v145, v145, v145 row_mirror row_mask:0xf bank_mask:0xf
    v_mfma_f32_16x16x16_bf16 v[224:227], v[114:115], v[112:113], v[224:227]
    v_mov_b32 v162, v145
    v_fmac_f32 v160, v118, v118
    v_mfma_f32_16x16x32_bf16 v[152:155], v[28:31], v[36:39], 0
    v_permlane32_swap_b32 v145, v162
    v_mfma_f32_16x16x32_bf16 v[152:155], v[28:31], v[240:243], v[152:155]
    v_max_f32 v145, v145, v162
    v_mov_b32 v162, v145
    v_mfma_f32_16x16x32_bf16 v[112:115], v[168:171], v[36:39], 0
    v_max3_f32 v146, v144, v132, v133
    v_max3_f32 v146, v146, v134, v135
    v_mfma_f32_16x16x32_bf16 v[112:115], v[128:131], v[240:243], v[112:115]
    v_permlane16_swap_b32 v145, v162
    v_mfma_f32_16x16x32_bf16 v[124:127], v[172:175], v[36:39], 0
    v_max_f32 v145, v145, v162
    v_sub_f32 v163, v163, v145
    v_mfma_f32_16x16x32_bf16 v[124:127], v[108:111], v[240:243], v[124:127]
    v_exp_f32 v163, v163
    v_mfma_f32_16x16x32_bf16 v[136:139], v[196:199], v[36:39], 0
    v_cvt_pk_bf16_f32 v163, v163, v163
    v_max3_f32 v146, v146, v176, v177
    v_mfma_f32_16x16x32_bf16 v[136:139], v[192:195], v[240:243], v[136:139]
    ds_write_b16 v8, v163
    v_max3_f32 v146, v146, v178, v179
    v_max3_f32 v146, v146, v224, v225
    v_max3_f32 v146, v146, v226, v227
    v_mov_b32 v145, v146
    v_fmac_f32 v160, v119, v119
    v_fmac_f32 v160, v208, v208
    v_permlane32_swap_b32 v146, v145
    v_max_f32 v146, v146, v145
    v_mov_b32 v145, v146
    v_fmac_f32 v160, v209, v209
    v_fmac_f32 v160, v210, v210
    v_permlane16_swap_b32 v146, v145
    v_max_f32 v146, v146, v145
    v_sub_f32 v132, v132, v146
    v_exp_f32 v132, v132
    v_sub_f32 v133, v133, v146
    v_exp_f32 v133, v133
    v_sub_f32 v134, v134, v146
    v_cvt_pk_bf16_f32 v132, v132, v133
    v_exp_f32 v134, v134
    v_sub_f32 v135, v135, v146
    v_exp_f32 v135, v135
    v_sub_f32 v176, v176, v146
    v_cvt_pk_bf16_f32 v133, v134, v135
    v_exp_f32 v176, v176
    v_sub_f32 v177, v177, v146
    v_exp_f32 v177, v177
    v_sub_f32 v178, v178, v146
    v_cvt_pk_bf16_f32 v134, v176, v177
    v_exp_f32 v178, v178
    v_sub_f32 v179, v179, v146
    v_exp_f32 v179, v179
    v_sub_f32 v224, v224, v146
    v_cvt_pk_bf16_f32 v135, v178, v179
    v_exp_f32 v224, v224
    v_sub_f32 v225, v225, v146
    v_exp_f32 v225, v225
    v_sub_f32 v226, v226, v146
    v_cvt_pk_bf16_f32 v36, v224, v225
    v_exp_f32 v226, v226
    v_sub_f32 v227, v227, v146
    v_exp_f32 v227, v227
    v_sub_f32 v144, v144, v146
    v_cvt_pk_bf16_f32 v37, v226, v227
    v_exp_f32 v144, v144
    v_fmac_f32 v160, v211, v211
    v_cvt_pk_bf16_f32 v38, v144, 0
    v_fmac_f32 v160, v228, v228
    v_fmac_f32 v160, v229, v229
    v_mfma_f32_16x16x32_bf16 v[180:183], v[28:31], v[36:39], 0
    ds_read_b128 v[144:147], v9
    ds_read_b128 v[220:223], v9 offset:64
    v_mfma_f32_16x16x32_bf16 v[180:183], v[28:31], v[132:135], v[180:183]
    v_fmac_f32 v160, v230, v230
    v_fmac_f32 v160, v231, v231
    v_mfma_f32_16x16x32_bf16 v[156:159], v[168:171], v[36:39], 0
    v_xor_b32 v0, 65536, v0
    v_xor_b32 v1, 65536, v1
    v_mfma_f32_16x16x32_bf16 v[156:159], v[128:131], v[132:135], v[156:159]
    ds_read_b128 v[212:215], v0 offset:20480
    ds_read_b128 v[176:179], v1 offset:20480
    v_mfma_f32_16x16x32_bf16 v[164:167], v[172:175], v[36:39], 0
    ds_read_b128 v[216:219], v0 offset:20608
    ds_read_b128 v[120:123], v1 offset:20608
    v_mfma_f32_16x16x32_bf16 v[164:167], v[108:111], v[132:135], v[164:167]
    ds_read_b128 v[240:243], v0 offset:20736
    ds_read_b128 v[224:227], v1 offset:20736
    v_mfma_f32_16x16x32_bf16 v[184:187], v[196:199], v[36:39], 0
    v_rcp_f32 v152, v152
    v_mfma_f32_16x16x32_bf16 v[184:187], v[192:195], v[132:135], v[184:187]
    v_mul_f32 v112, v152, v112
    v_mul_f32 v113, v152, v113
    s_waitcnt lgkmcnt(6)
    v_mfma_f32_16x16x32_bf16 v[132:135], v[144:147], v[28:31], 0
    v_cvt_pk_bf16_f32 v112, v112, v113
    v_mul_f32 v114, v152, v114
    v_mfma_f32_16x16x32_bf16 v[132:135], v[220:223], v[28:31], v[132:135]
    v_mul_f32 v115, v152, v115
    v_cvt_pk_bf16_f32 v113, v114, v115
    v_mfma_f32_16x16x32_bf16 v[204:207], v[144:147], v[128:131], 0
    s_waitcnt lgkmcnt(5)
    v_mul_f32 v124, v152, v124
    v_mul_f32 v125, v152, v125
    v_mfma_f32_16x16x32_bf16 v[204:207], v[220:223], v[168:171], v[204:207]
    s_waitcnt lgkmcnt(3)
    v_rcp_f32 v132, v132
    v_mfma_f32_16x16x32_bf16 v[128:131], v[144:147], v[108:111], 0
    s_waitcnt lgkmcnt(1)
    v_cvt_pk_bf16_f32 v114, v124, v125
    v_mul_f32 v126, v152, v126
    v_mfma_f32_16x16x32_bf16 v[128:131], v[220:223], v[172:175], v[128:131]
    s_waitcnt lgkmcnt(0)
    v_mul_f32 v204, v204, v132
    v_mul_f32 v127, v152, v127
    v_mfma_f32_16x16x32_bf16 v[108:111], v[144:147], v[192:195], 0
    v_cvt_pk_bf16_f32 v115, v126, v127
    v_mul_f32 v136, v152, v136
    v_mfma_f32_16x16x32_bf16 v[108:111], v[220:223], v[196:199], v[108:111]
    ds_write_b128 v3, v[112:115] offset:6144
    v_mfma_f32_16x16x32_bf16 v[192:195], a[72:75], v[212:215], 0
    v_mul_f32_dpp v204, v128, v132 quad_perm:[0,1,2,3] row_mask:0x2 bank_mask:0xf
    v_mul_f32 v137, v152, v137
    v_mfma_f32_16x16x32_bf16 v[192:195], a[76:79], v[176:179], v[192:195]
    v_cvt_pk_bf16_f32 v162, v136, v137
    v_mul_f32 v138, v152, v138
    v_mfma_f32_16x16x32_bf16 v[192:195], a[80:83], v[216:219], v[192:195]
    v_mul_f32_dpp v204, v108, v132 quad_perm:[0,1,2,3] row_mask:0x4 bank_mask:0xf
    v_cvt_pk_bf16_f32 v204, v204, v204
    v_mfma_f32_16x16x32_bf16 v[192:195], a[84:87], v[120:123], v[192:195]
    ds_write_b16 v7, v204
    v_mfma_f32_16x16x32_bf16 v[192:195], a[88:91], v[240:243], v[192:195]
    v_mul_f32 v139, v152, v139
    v_cvt_pk_bf16_f32 v163, v138, v139
    v_mfma_f32_16x16x32_bf16 v[192:195], a[92:95], v[224:227], v[192:195]
    ds_write_b64 v4, v[162:163] offset:10240
    v_mfma_f32_16x16x32_bf16 v[152:155], a[96:99], v[212:215], 0
    v_rcp_f32 v180, v180
    v_mfma_f32_16x16x32_bf16 v[152:155], a[100:103], v[176:179], v[152:155]
    v_mul_f32 v156, v180, v156
    v_mul_f32 v157, v180, v157
    v_mfma_f32_16x16x32_bf16 v[152:155], a[104:107], v[216:219], v[152:155]
    v_cvt_pk_bf16_f32 v128, v156, v157
    v_mul_f32 v158, v180, v158
    v_mfma_f32_16x16x32_bf16 v[152:155], a[108:111], v[120:123], v[152:155]
    v_mul_f32 v159, v180, v159
    v_cvt_pk_bf16_f32 v129, v158, v159
    v_mfma_f32_16x16x32_bf16 v[152:155], a[112:115], v[240:243], v[152:155]
    v_mul_f32 v164, v180, v164
    v_mul_f32 v165, v180, v165
    v_mfma_f32_16x16x32_bf16 v[152:155], a[116:119], v[224:227], v[152:155]
    v_cvt_pk_bf16_f32 v130, v164, v165
    v_mul_f32 v166, v180, v166
    v_mfma_f32_16x16x32_bf16 v[144:147], a[120:123], v[212:215], 0
    v_mul_f32 v167, v180, v167
    v_cvt_pk_bf16_f32 v131, v166, v167
    v_mfma_f32_16x16x32_bf16 v[144:147], a[124:127], v[176:179], v[144:147]
    ds_write_b128 v3, v[128:131] offset:12288
    v_mfma_f32_16x16x32_bf16 v[144:147], a[128:131], v[216:219], v[144:147]
    v_mul_f32 v184, v180, v184
    v_mul_f32 v185, v180, v185
    v_mfma_f32_16x16x32_bf16 v[144:147], a[132:135], v[120:123], v[144:147]
    v_cvt_pk_bf16_f32 v162, v184, v185
    v_mul_f32 v186, v180, v186
    v_mfma_f32_16x16x32_bf16 v[144:147], a[136:139], v[240:243], v[144:147]
    v_mul_f32 v187, v180, v187
    v_cvt_pk_bf16_f32 v163, v186, v187
    v_mfma_f32_16x16x32_bf16 v[144:147], a[140:143], v[224:227], v[144:147]
    ds_write_b64 v4, v[162:163] offset:16384
    v_mfma_f32_16x16x32_bf16 v[124:127], a[0:3], v[212:215], 0
    v_fma_f32 v162, v140, v140, s33
    v_fmac_f32 v162, v141, v141
    v_mfma_f32_16x16x32_bf16 v[124:127], a[4:7], v[176:179], v[124:127]
    v_fmac_f32 v162, v142, v142
    v_fmac_f32 v162, v143, v143
    v_mfma_f32_16x16x32_bf16 v[124:127], a[8:11], v[216:219], v[124:127]
    v_fmac_f32 v162, v188, v188
    v_fmac_f32 v162, v189, v189
    v_mfma_f32_16x16x32_bf16 v[124:127], a[12:15], v[120:123], v[124:127]
    v_fmac_f32 v162, v190, v190
    v_fmac_f32 v162, v191, v191
    v_mfma_f32_16x16x32_bf16 v[124:127], a[16:19], v[240:243], v[124:127]
    v_fmac_f32 v162, v244, v244
    v_fmac_f32 v162, v245, v245
    v_mfma_f32_16x16x32_bf16 v[124:127], a[20:23], v[224:227], v[124:127]
    v_fmac_f32 v162, v246, v246
    v_fmac_f32 v162, v247, v247
    v_mfma_f32_16x16x32_bf16 v[180:183], a[24:27], v[212:215], 0
    v_cvt_pk_bf16_f32 v160, v162, v160
    v_fma_f32 v162, v192, v192, s32
    v_mfma_f32_16x16x32_bf16 v[180:183], a[28:31], v[176:179], v[180:183]
    ds_write_b64 v4, v[160:161] offset:18432
    v_mfma_f32_16x16x32_bf16 v[180:183], a[32:35], v[216:219], v[180:183]
    v_fmac_f32 v162, v193, v193
    v_fmac_f32 v162, v194, v194
    v_mfma_f32_16x16x32_bf16 v[180:183], a[36:39], v[120:123], v[180:183]
    v_fmac_f32 v162, v195, v195
    v_fmac_f32 v162, v152, v152
    v_mfma_f32_16x16x32_bf16 v[180:183], a[40:43], v[240:243], v[180:183]
    v_fmac_f32 v162, v153, v153
    v_fmac_f32 v162, v154, v154
    v_mfma_f32_16x16x32_bf16 v[180:183], a[44:47], v[224:227], v[180:183]
    v_fmac_f32 v162, v155, v155
    v_fmac_f32 v162, v144, v144
    v_mfma_f32_16x16x32_bf16 v[220:223], a[48:51], v[212:215], 0
    v_fmac_f32 v162, v145, v145
    v_fmac_f32 v162, v146, v146
    v_mfma_f32_16x16x32_bf16 v[220:223], a[52:55], v[176:179], v[220:223]
    v_fmac_f32 v162, v147, v147
    v_fma_f32 v160, v124, v124, s32
    v_mfma_f32_16x16x32_bf16 v[220:223], a[56:59], v[216:219], v[220:223]
    s_waitcnt lgkmcnt(0)
    v_fmac_f32 v160, v125, v125
    v_fmac_f32 v160, v126, v126
    v_mfma_f32_16x16x32_bf16 v[220:223], a[60:63], v[120:123], v[220:223]
    s_nop 0
    v_fmac_f32 v160, v127, v127
    v_fmac_f32 v160, v180, v180
    v_mfma_f32_16x16x32_bf16 v[220:223], a[64:67], v[240:243], v[220:223]
    s_nop 0
    v_fmac_f32 v160, v181, v181
    v_fmac_f32 v160, v182, v182
    v_mfma_f32_16x16x32_bf16 v[220:223], a[68:71], v[224:227], v[220:223]
    s_nop 0
    v_fmac_f32 v160, v183, v183
    v_add_u32 v5, 336, v5
    v_mfma_f32_16x16x32_bf16 v[128:131], v[212:215], a[144:147], 0
    s_barrier
    v_add_u32 v6, 272, v6
    v_add_u32 v7, 16, v7
    v_mfma_f32_16x16x32_bf16 v[128:131], v[176:179], a[148:151], v[128:131]
    v_fmac_f32 v160, v220, v220
    v_fmac_f32 v160, v221, v221
    v_mfma_f32_16x16x32_bf16 v[128:131], v[216:219], a[152:155], v[128:131]
    v_fmac_f32 v160, v222, v222
    v_fmac_f32 v160, v223, v223
    v_mfma_f32_16x16x32_bf16 v[128:131], v[120:123], a[156:159], v[128:131]
    v_cvt_pk_bf16_f32 v38, v160, v162
    v_xor_b32 v2, 65536, v2
    v_mfma_f32_16x16x32_bf16 v[128:131], v[240:243], a[160:163], v[128:131]
    v_xor_b32 v3, 65536, v3
    v_xor_b32 v4, 65536, v4
    v_mfma_f32_16x16x32_bf16 v[128:131], v[224:227], a[164:167], v[128:131]
    s_cbranch_scc1 L_loop_safe3
    s_branch L_drain
L_edge:
    v_lshrrev_b32 v108, 6, v0
    s_nop 0
    v_readfirstlane_b32 s16, v108
    v_mov_b32 v109, v0
    v_and_b32 v110, 63, v0
    v_lshrrev_b32 v111, 4, v110
    v_and_b32 v112, 15, v110
    v_mov_b32 v113, 0x40000000
    s_lshr_b32 s3, s2, 3
    s_and_b32 s3, s3, 31
    s_cmp_eq_u32 s16, 0
    s_cselect_b32 s4, 54, 18
    s_mul_i32 s3, s3, s4
    s_cmp_ge_u32 s16, 2
    s_cselect_b32 s3, 0, s3
    s_cselect_b32 s4, 6, s4
    s_cmp_eq_u32 s16, 3
    s_cselect_b32 s4, 1, s4
    s_sub_u32 s4, s4, 1
    v_min_u32 v114, s4, v110
    v_add_u32 v114, s3, v114
    v_lshlrev_b32 v114, 7, v114
    v_mov_b32 v115, 0
    s_mov_b32 s66, 193536
    s_mov_b32 s36, 100270464
    s_mov_b32 s22, 1180032
    s_mov_b32 s20, 0
    s_mov_b32 s38, 0
    s_sub_u32 s3, s2, 247
    s_and_b32 s3, s3, 3
    s_mul_i32 s3, s3, 7
    s_add_u32 s3, s3, 3
    s_mov_b32 s4, 196224
    s_cmp_lt_u32 s2, 251
    s_cselect_b32 s4, s4, 384
    s_cselect_b32 s6, 1, 0
    s_cselect_b32 s5, 0, 1
    s_mul_i32 s25, s3, s4
    s_mul_i32 s21, s4, 28
    s_cmp_lt_u32 s2, 255
    s_cselect_b32 s17, 18, 1
    s_cselect_b32 s25, s25, 0
    s_cselect_b32 s6, s6, 1
    s_add_u32 s7, s25, 1179648
    s_mul_i32 s3, s5, 99485568
    s_mul_i32 s4, s5, -784896
    v_mov_b32 v116, s3
    v_mov_b32 v117, s4
    s_add_u32 s7, s7, s4
    s_mul_i32 s3, s6, 194688
    s_mul_i32 s4, s6, -1536
    v_mov_b32 v118, s3
    v_mov_b32 v119, s4
    s_add_u32 s7, s7, s4
    s_mov_b32 s46, 73728
    s_mov_b32 s47, 0x00020000
    s_mov_b32 s42, 221184
    s_mov_b32 s43, 0x00020000
    s_mov_b32 s54, 64
    s_mov_b32 s55, 0x00020000
    s_mov_b32 s58, 128
    s_mov_b32 s59, 0x00020000
    s_mov_b32 s50, 676
    s_mov_b32 s51, 0x00020000
    s_mov_b32 s10, 100270464
    s_mov_b32 s11, 0x00020000
    s_mov_b32 s14, 0
    s_mov_b32 s15, 0x00020000
    s_waitcnt lgkmcnt(0)
    s_cmp_eq_u32 s16, 0
    s_cselect_b64 s[98:99], s[40:41], s[44:45]
    s_cmp_eq_u32 s16, 2
    s_cselect_b64 s[98:99], s[48:49], s[98:99]
    s_cmp_eq_u32 s16, 3
    s_cselect_b64 s[98:99], s[52:53], s[98:99]
    v_lshl_add_u64 v[114:115], s[98:99], 0, v[114:115]
    v_writelane_b32 v114, s56, 62
    v_writelane_b32 v115, s57, 62
    v_writelane_b32 v114, s60, 63
    v_writelane_b32 v115, s61, 63
    global_load_dword a254, v[114:115], off
    v_mul_u32_u24 v108, 2731, v109
    v_bfe_u32 v114, v108, 17, 3
    v_lshrrev_b32 v108, 16, v108
    v_xor_b32 v115, v114, v109
    v_mul_u32_u24 v114, 37, v108
    v_lshrrev_b32 v114, 8, v114
    v_lshlrev_b32 v115, 4, v115
    v_mad_u32_u24 v10, v114, s66, v115
    v_mul_u32_u24 v114, 37, v108
    v_lshrrev_b32 v114, 8, v114
    v_mul_u32_u24 v132, 7, v114
    v_sub_u32 v132, v108, v132
    v_cmp_gt_u32 vcc, 4, v114
    s_nop 1
    v_cndmask_b32 v114, v117, v116, vcc
    v_cmp_gt_u32 vcc, 4, v132
    s_nop 1
    v_cndmask_b32 v132, v119, v118, vcc
    v_add3_u32 v10, v10, v114, v132
    v_mul_u32_u24 v114, s20, v108
    v_add_u32 v114, s38, v114
    v_mul_u32_u24 v114, 911, v114
    v_lshrrev_b32 v114, 16, v114
    v_mul_u32_u24 v114, s22, v114
    v_mad_u32_u24 v114, v108, s21, v114
    v_cmp_gt_u32 vcc, s17, v108
    v_add_u32 v114, s7, v114
    s_nop 0
    v_cndmask_b32 v114, v113, v114, vcc
    v_mul_u32_u24 v108, 384, v108
    v_sub_u32 v108, v115, v108
    v_add_u32 v114, v114, v108
    v_add_u32 v108, 256, v109
    v_mul_u32_u24 v115, 2731, v108
    v_bfe_u32 v132, v115, 17, 3
    v_lshrrev_b32 v115, 16, v115
    v_xor_b32 v108, v132, v108
    v_mul_u32_u24 v132, 37, v115
    v_lshrrev_b32 v132, 8, v132
    v_lshlrev_b32 v108, 4, v108
    v_mad_u32_u24 v11, v132, s66, v108
    v_mul_u32_u24 v132, 37, v115
    v_lshrrev_b32 v132, 8, v132
    v_mul_u32_u24 v133, 7, v132
    v_sub_u32 v133, v115, v133
    v_cmp_gt_u32 vcc, 4, v132
    s_nop 1
    v_cndmask_b32 v132, v117, v116, vcc
    v_cmp_gt_u32 vcc, 4, v133
    s_nop 1
    v_cndmask_b32 v133, v119, v118, vcc
    v_add3_u32 v11, v11, v132, v133
    v_mul_u32_u24 v132, s20, v115
    v_add_u32 v132, s38, v132
    v_mul_u32_u24 v132, 911, v132
    v_lshrrev_b32 v132, 16, v132
    v_mul_u32_u24 v132, s22, v132
    v_mad_u32_u24 v132, v115, s21, v132
    v_cmp_gt_u32 vcc, s17, v115
    v_add_u32 v132, s7, v132
    s_nop 0
    v_cndmask_b32 v132, v113, v132, vcc
    v_mul_u32_u24 v115, 384, v115
    v_sub_u32 v115, v108, v115
    v_add_u32 v132, v132, v115
    v_mul_u32_u24 v108, 2731, v110
    v_bfe_u32 v108, v108, 17, 3
    v_xor_b32 v108, v108, v110
    v_lshlrev_b32 v115, 4, v108
    v_xor_b32 v133, 64, v115
    v_add_u32 v108, 64, v110
    v_mul_u32_u24 v108, 2731, v108
    v_bfe_u32 v108, v108, 17, 3
    v_xor_b32 v108, v108, v110
    v_lshlrev_b32 v134, 4, v108
    v_xor_b32 v135, 64, v134
    v_add_u32 v108, 128, v110
    v_mul_u32_u24 v108, 2731, v108
    v_bfe_u32 v108, v108, 17, 3
    v_xor_b32 v108, v108, v110
    v_lshlrev_b32 v108, 4, v108
    v_xor_b32 v136, 64, v108
    s_mul_i32 s65, s16, 18432
    s_cmp_eq_u32 s16, 0
    s_cselect_b32 s63, 0, 20480
    s_cmp_ge_u32 s16, 2
    s_cselect_b32 s64, 61440, s63
    s_cmp_eq_u32 s16, 3
    s_cselect_b32 s63, s64, s63
    s_add_u32 s63, s63, s65
    s_add_u32 s64, s64, s65
    s_lshl_b32 s28, s16, 10
    s_add_u32 s28, s28, 20480
    s_add_u32 m0, s28, 128512
    s_add_u32 s4, s65, 3072
    buffer_load_dwordx4 v114, s[8:11], 0 offen nt lds
    s_add_u32 m0, s28, 132608
    v_mov_b32 v137, 0
    v_cmp_lt_u32 s[88:89], 7, v112
    v_mov_b32 v139, 0
    v_mov_b32 v121, 0
    v_mov_b32 v123, 0
    v_lshlrev_b32 v138, 1, v110
    v_mul_u32_u24 v114, 12, v112
    s_mul_i32 s67, s16, 192
    v_add_u32 v114, s67, v114
    v_lshlrev_b32 v120, 5, v111
    v_mul_u32_u24 v122, 171, v110
    v_lshrrev_b32 v122, 10, v122
    v_lshrrev_b32 v124, 1, v122
    s_mul_i32 s68, s16, 12288
    s_add_u32 s68, s68, 65536
    buffer_load_dwordx4 v132, s[8:11], 0 offen nt lds
    s_add_u32 m0, s28, 0
    v_xor_b32 v124, v124, v122
    v_and_b32 v124, 4, v124
    v_mul_u32_u24 v124, 3, v124
    v_xor_b32 v124, v124, v122
    v_mul_u32_u24 v124, 1152, v124
    v_mul_u32_u24 v122, 96, v122
    v_sub_u32 v124, v124, v122
    v_lshl_add_u32 v132, v110, 4, v124
    v_add_u32 v122, 64, v110
    v_mul_u32_u24 v122, 171, v122
    v_lshrrev_b32 v122, 10, v122
    v_lshrrev_b32 v124, 1, v122
    v_xor_b32 v124, v124, v122
    s_cmp_eq_u32 s16, 3
    s_cselect_b32 s68, 136704, s68
    buffer_load_dwordx4 v10, s[8:11], s25 offen nt lds
    s_add_u32 m0, s28, 4096
    v_and_b32 v124, 4, v124
    v_mul_u32_u24 v124, 3, v124
    v_xor_b32 v124, v124, v122
    v_mul_u32_u24 v124, 1152, v124
    v_mul_u32_u24 v122, 96, v122
    v_sub_u32 v124, v124, v122
    v_lshl_add_u32 v124, v110, 4, v124
    v_add_u32 v122, 128, v110
    v_mul_u32_u24 v122, 171, v122
    v_lshrrev_b32 v122, 10, v122
    v_lshrrev_b32 v125, 1, v122
    v_xor_b32 v125, v125, v122
    v_and_b32 v125, 4, v125
    s_mul_i32 s69, s16, 96
    s_mov_b32 s72, 0x3f80
    buffer_load_dwordx4 v11, s[8:11], s25 offen nt lds
    s_add_u32 m0, s63, 0
    v_mul_u32_u24 v125, 3, v125
    v_xor_b32 v125, v125, v122
    v_mul_u32_u24 v125, 1152, v125
    v_mul_u32_u24 v122, 96, v122
    v_sub_u32 v125, v125, v122
    v_lshl_add_u32 v125, v110, 4, v125
    v_lshrrev_b32 v122, 2, v112
    v_and_b32 v126, 1, v122
    v_mul_u32_u24 v126, 0x020202, v126
    v_lshl_or_b32 v126, v126, 8, v126
    v_add_u32 v126, 0x05040100, v126
    v_and_b32 v127, 3, v112
    v_lshrrev_b32 v128, 1, v112
    s_mul_i32 s73, s16, 192
    s_add_u32 s73, s73, 162048
    buffer_load_dwordx4 v115, s[44:47], s65 offen lds
    v_xor_b32 v129, v128, v111
    v_mul_u32_u24 v130, 384, v112
    v_lshl_add_u32 v0, v129, 4, v130
    v_xor_b32 v1, 64, v0
    v_add_u32 v129, s63, v0
    v_add_u32 v131, s63, v1
    v_add_u32 v140, s64, v0
    v_add_u32 v141, s64, v1
    v_and_b32 v142, 2, v111
    v_add_u32 v142, v142, v111
    v_lshl_add_u32 v142, v142, 2, v122
    v_mul_u32_u24 v142, 96, v142
    v_lshl_add_u32 v142, v127, 3, v142
    v_add_u32 v142, s68, v142
    s_mov_b32 s19, s38
    s_mov_b32 s23, s25
    buffer_load_dwordx4 v134, s[44:47], s65 offen offset:1024 lds
    v_mov_b32 v28, 0x3f803f80
    v_mov_b32 v29, 0x3f803f80
    v_mov_b32 v30, 0x3f803f80
    v_mov_b32 v31, 0x3f803f80
    v_mul_u32_u24 v143, 768, v111
    v_add_u32 v143, v114, v143
    v_add_u32 v143, 157184, v143
    v_and_b32 v144, 1, v112
    v_lshlrev_b32 v144, 4, v144
    v_lshlrev_b32 v145, v144, s72
    v_lshlrev_b32 v146, 4, v111
    v_lshl_add_u32 v147, v112, 2, s73
    v_add_u32 v148, 162048, v146
    v_lshl_add_u32 v149, s16, 2, v111
    s_mov_b32 s26, 0
    s_mov_b32 s27, 0
    buffer_load_dwordx4 v108, s[44:47], s65 offen offset:2048 lds
    s_add_u32 m0, s63, 3072
    v_add_u32 v150, 32, v149
    v_xor_b32 v149, v149, v128
    v_lshl_add_u32 v149, v149, 4, v130
    v_and_b32 v128, 14, v112
    v_xor_b32 v150, v150, v128
    v_lshl_add_u32 v150, v150, 3, v130
    v_add_u32 v151, 104448, v149
    v_add_u32 v128, 104448, v150
    s_mov_b32 s18, 0
    s_add_u32 s19, s19, s20
    s_add_u32 s23, s23, s21
    s_cmp_ge_u32 s19, 72
    s_cselect_b32 s34, 72, 0
    s_cselect_b32 s35, s22, 0
    s_sub_u32 s19, s19, s34
    buffer_load_dwordx4 v133, s[44:47], s4 offen lds
    s_add_u32 s23, s23, s35
    s_mov_b32 s24, s23
    s_add_u32 s19, s19, s20
    s_add_u32 s23, s23, s21
    s_cmp_ge_u32 s19, 72
    s_cselect_b32 s34, 72, 0
    s_cselect_b32 s35, s22, 0
    s_sub_u32 s19, s19, s34
    s_add_u32 s23, s23, s35
    s_mul_i32 s74, s16, 64
    v_lshl_add_u32 v130, v111, 4, s74
    s_mul_i32 s75, s16, 32
    s_add_u32 s75, s75, 256
    v_lshl_add_u32 v152, v111, 3, s75
    v_add_u32 v153, 0, v112
    v_mul_u32_u24 v154, 37, v153
    v_mul_u32_u24 v155, 384, v153
    v_lshrrev_b32 v154, 8, v154
    v_mad_u32_u24 v155, v154, s66, v155
    v_add_u32 v15, v155, v130
    v_add_u32 v18, v155, v152
    v_mul_u32_u24 v155, 37, v153
    v_lshrrev_b32 v155, 8, v155
    v_mul_u32_u24 v156, 7, v155
    v_sub_u32 v156, v153, v156
    v_add_u32 v157, 16, v112
    v_mul_u32_u24 v158, 37, v157
    v_mul_u32_u24 v159, 384, v157
    v_lshrrev_b32 v158, 8, v158
    v_mad_u32_u24 v159, v158, s66, v159
    v_add_u32 v16, v159, v130
    v_add_u32 v19, v159, v152
    v_mul_u32_u24 v159, 37, v157
    v_lshrrev_b32 v159, 8, v159
    v_mul_u32_u24 v160, 7, v159
    v_sub_u32 v160, v157, v160
    v_add_u32 v161, 32, v112
    v_mul_u32_u24 v162, 37, v161
    v_mul_u32_u24 v163, 384, v161
    v_lshrrev_b32 v162, 8, v162
    v_mad_u32_u24 v163, v162, s66, v163
    v_add_u32 v17, v163, v130
    v_add_u32 v20, v163, v152
    v_mul_u32_u24 v130, 37, v161
    v_lshrrev_b32 v130, 8, v130
    v_mul_u32_u24 v163, 7, v130
    v_sub_u32 v163, v161, v163
    s_mul_i32 s76, s16, 768
    s_add_u32 s76, s76, 157184
    v_mul_u32_u24 v152, 24, v154
    v_lshl_add_u32 v152, v153, 2, v152
    v_add_u32 v22, s76, v152
    v_sub_u32 v23, s76, v152
    v_sub_u32 v152, v22, v146
    v_mul_u32_u24 v154, 24, v158
    v_lshl_add_u32 v154, v157, 2, v154
    v_add_u32 v24, s76, v154
    v_sub_u32 v25, s76, v154
    v_sub_u32 v158, v24, v146
    v_mul_u32_u24 v154, 24, v162
    v_lshl_add_u32 v154, v161, 2, v154
    v_add_u32 v26, s76, v154
    v_sub_u32 v27, s76, v154
    v_sub_u32 v162, v26, v146
    v_mul_u32_u24 v154, 148, v111
    s_mov_b32 s77, -24
    v_add_u32 v164, 0, v154
    v_lshrrev_b32 v164, 8, v164
    v_mad_i32_i24 v40, v164, s77, v152
    v_mad_i32_i24 v52, v164, s77, v158
    v_mad_i32_i24 v64, v164, s77, v162
    v_add_u32 v164, 37, v154
    v_lshrrev_b32 v164, 8, v164
    v_mad_i32_i24 v41, v164, s77, v152
    v_mad_i32_i24 v53, v164, s77, v158
    v_mad_i32_i24 v65, v164, s77, v162
    v_add_u32 v164, 74, v154
    v_lshrrev_b32 v164, 8, v164
    v_mad_i32_i24 v42, v164, s77, v152
    v_mad_i32_i24 v54, v164, s77, v158
    v_mad_i32_i24 v66, v164, s77, v162
    v_add_u32 v164, 111, v154
    v_lshrrev_b32 v164, 8, v164
    v_mad_i32_i24 v43, v164, s77, v152
    v_mad_i32_i24 v55, v164, s77, v158
    v_mad_i32_i24 v67, v164, s77, v162
    v_add_u32 v164, 592, v154
    v_lshrrev_b32 v164, 8, v164
    v_mad_i32_i24 v44, v164, s77, v152
    v_mad_i32_i24 v56, v164, s77, v158
    v_mad_i32_i24 v68, v164, s77, v162
    v_add_u32 v164, 629, v154
    v_lshrrev_b32 v164, 8, v164
    v_mad_i32_i24 v45, v164, s77, v152
    v_mad_i32_i24 v57, v164, s77, v158
    v_mad_i32_i24 v69, v164, s77, v162
    v_add_u32 v164, 666, v154
    v_lshrrev_b32 v164, 8, v164
    v_mad_i32_i24 v46, v164, s77, v152
    v_mad_i32_i24 v58, v164, s77, v158
    v_mad_i32_i24 v70, v164, s77, v162
    v_add_u32 v164, 703, v154
    v_lshrrev_b32 v164, 8, v164
    v_mad_i32_i24 v47, v164, s77, v152
    v_mad_i32_i24 v59, v164, s77, v158
    v_mad_i32_i24 v71, v164, s77, v162
    v_add_u32 v164, 1184, v154
    v_lshrrev_b32 v164, 8, v164
    v_mad_i32_i24 v48, v164, s77, v152
    v_mad_i32_i24 v60, v164, s77, v158
    v_mad_i32_i24 v72, v164, s77, v162
    v_add_u32 v164, 1221, v154
    v_lshrrev_b32 v164, 8, v164
    v_mad_i32_i24 v49, v164, s77, v152
    v_mad_i32_i24 v61, v164, s77, v158
    v_mad_i32_i24 v73, v164, s77, v162
    v_add_u32 v164, 1258, v154
    v_lshrrev_b32 v164, 8, v164
    v_mad_i32_i24 v50, v164, s77, v152
    v_mad_i32_i24 v62, v164, s77, v158
    v_mad_i32_i24 v74, v164, s77, v162
    v_add_u32 v154, 1295, v154
    v_lshrrev_b32 v154, 8, v154
    v_mad_i32_i24 v51, v154, s77, v152
    v_mad_i32_i24 v63, v154, s77, v158
    v_mad_i32_i24 v75, v154, s77, v162
    v_mov_b32 v162, s76
    v_lshlrev_b32 v158, 4, v110
    v_xor_b32 v2, 65536, v158
    v_lshl_add_u32 v3, s16, 10, v158
    s_lshr_b32 s78, s16, 1
    s_and_b32 s79, s16, 1
    s_lshl_b32 s79, s79, 3
    s_lshl_b32 s80, s78, 10
    s_add_u32 s80, s80, s79
    v_add_u32 v4, s80, v158
    s_lshl_b32 s78, s78, 11
    s_add_u32 s78, s78, s79
    s_add_u32 s78, s78, 144896
    s_mul_i32 s81, s16, 2048
    s_add_u32 s81, s81, 136704
    v_lshl_add_u32 v158, v111, 3, s81
    v_mov_b32 v152, s78
    v_mov_b32 v154, 161536
    s_mul_i32 s82, s16, 8064
    s_add_u32 s82, s82, 104448
    s_mul_i32 s83, s16, 6528
    s_add_u32 s83, s83, 38912
    v_mul_u32_u24 v164, 80, v111
    v_add3_u32 v5, v164, v144, s82
    v_lshl_add_u32 v6, v112, 2, s83
    s_mul_i32 s84, s16, 128
    s_add_u32 s84, s84, 65024
    v_add_u32 v9, s84, v146
    v_lshrrev_b32 v144, 1, v111
    v_mul_u32_u24 v144, 48, v144
    v_lshl_add_u32 v144, v111, 3, v144
    v_lshl_add_u32 v144, v122, 4, v144
    v_lshl_add_u32 v144, v127, 1, v144
    v_add_u32 v8, s84, v144
    v_mov_b32 v39, 0
    s_mov_b32 s32, 0x2a8cbccc
    s_mov_b32 s33, 0x38fba882
    v_add_u32 v165, 148992, v0
    v_add_u32 v166, 148992, v1
    v_lshlrev_b32 v144, 4, v112
    v_add_u32 v144, 160256, v144
    v_mul_u32_u24 v167, 336, v112
    v_add3_u32 v167, v167, v164, s82
    v_mul_u32_u24 v164, 272, v112
    v_add3_u32 v164, v164, v146, s83
    v_mul_u32_u24 v168, 1088, v111
    v_add_u32 v168, v168, v6
    v_add_u32 v169, 5376, v167
    v_add_u32 v170, 4352, v164
    v_add_u32 v171, 4352, v168
    v_cmp_gt_u32 s[86:87], 16, v110
    v_mov_b32 v110, 0xf149f2ca
    v_add_u32 v172, 512, v109
    v_mul_u32_u24 v173, 2731, v172
    v_bfe_u32 v174, v173, 17, 3
    v_lshrrev_b32 v173, 16, v173
    v_xor_b32 v172, v174, v172
    v_mul_u32_u24 v174, 37, v173
    v_lshrrev_b32 v174, 8, v174
    v_lshlrev_b32 v172, 4, v172
    v_mad_u32_u24 v12, v174, s66, v172
    v_mul_u32_u24 v172, 37, v173
    v_lshrrev_b32 v172, 8, v172
    v_mul_u32_u24 v174, 7, v172
    v_sub_u32 v174, v173, v174
    v_cmp_gt_u32 vcc, 4, v172
    v_add_u32 v173, 768, v109
    v_mul_u32_u24 v175, 2731, v173
    v_cndmask_b32 v172, v117, v116, vcc
    v_cmp_gt_u32 vcc, 4, v174
    v_bfe_u32 v176, v175, 17, 3
    v_lshrrev_b32 v175, 16, v175
    v_cndmask_b32 v174, v119, v118, vcc
    v_add3_u32 v12, v12, v172, v174
    v_xor_b32 v173, v176, v173
    v_mul_u32_u24 v176, 37, v175
    v_lshrrev_b32 v176, 8, v176
    v_lshlrev_b32 v173, 4, v173
    v_mad_u32_u24 v13, v176, s66, v173
    v_mul_u32_u24 v172, 37, v175
    v_lshrrev_b32 v172, 8, v172
    v_mul_u32_u24 v173, 7, v172
    v_sub_u32 v173, v175, v173
    v_cmp_gt_u32 vcc, 4, v172
    v_add_u32 v109, 1024, v109
    v_mul_u32_u24 v174, 2731, v109
    v_cndmask_b32 v172, v117, v116, vcc
    v_cmp_gt_u32 vcc, 4, v173
    v_bfe_u32 v175, v174, 17, 3
    v_lshrrev_b32 v174, 16, v174
    v_cndmask_b32 v173, v119, v118, vcc
    v_add3_u32 v13, v13, v172, v173
    v_xor_b32 v109, v175, v109
    v_mul_u32_u24 v175, 37, v174
    v_lshrrev_b32 v175, 8, v175
    v_lshlrev_b32 v109, 4, v109
    v_mad_u32_u24 v14, v175, s66, v109
    v_mul_u32_u24 v109, 37, v174
    v_lshrrev_b32 v109, 8, v109
    v_mul_u32_u24 v172, 7, v109
    v_sub_u32 v172, v174, v172
    v_cmp_gt_u32 vcc, 4, v109
    s_add_u32 s70, s28, 16384
    s_cmp_lt_u32 s16, 2
    v_cndmask_b32 v109, v117, v116, vcc
    v_cmp_gt_u32 vcc, 4, v172
    s_cselect_b32 s29, s70, 160256
    s_cselect_b32 s30, 65536, 0
    v_cndmask_b32 v172, v119, v118, vcc
    v_add3_u32 v14, v14, v109, v172
    v_cmp_gt_u32 vcc, 48, v174
    s_xor_b32 s71, s29, s30
    s_lshl_b32 s90, s5, 1
    v_cndmask_b32 v14, v113, v14, vcc
    v_cmp_gt_u32 vcc, 2, v127
    s_or_b32 s90, s90, s6
    v_mov_b32 v109, 0xc31044fe
    v_cndmask_b32 v32, 0, v145, vcc
    v_cndmask_b32 v33, v145, 0, vcc
    v_cndmask_b32 v34, 0, v145, vcc
    v_cndmask_b32 v35, v145, 0, vcc
    v_cmp_eq_u32 vcc, v111, v122
    v_mul_u32_u24 v145, 37, v153
    v_lshrrev_b32 v145, 8, v145
    v_cndmask_b32 v172, 0, v32, vcc
    v_cndmask_b32 v173, 0, v33, vcc
    v_cmp_gt_u32 vcc, 4, v155
    v_mul_u32_u24 v113, 7, v145
    v_sub_u32 v113, v153, v113
    v_cndmask_b32 v155, v117, v116, vcc
    v_cmp_gt_u32 vcc, 4, v156
    v_lshrrev_b32 v145, 2, v145
    v_lshrrev_b32 v113, 2, v113
    v_cndmask_b32 v156, v119, v118, vcc
    v_add3_u32 v15, v15, v155, v156
    v_add3_u32 v18, v18, v155, v156
    v_cmp_gt_u32 vcc, 4, v159
    v_and_b32 v145, s5, v145
    v_and_b32 v113, s6, v113
    v_cndmask_b32 v159, v117, v116, vcc
    v_cmp_gt_u32 vcc, 4, v160
    v_lshl_or_b32 v145, v145, 1, v113
    v_mul_u32_u24 v174, 37, v157
    v_cndmask_b32 v160, v119, v118, vcc
    v_add3_u32 v16, v16, v159, v160
    v_add3_u32 v19, v19, v159, v160
    v_cmp_gt_u32 vcc, 4, v130
    v_lshrrev_b32 v174, 8, v174
    v_mul_u32_u24 v113, 7, v174
    v_cndmask_b32 v130, v117, v116, vcc
    v_cmp_gt_u32 vcc, 4, v163
    v_sub_u32 v113, v157, v113
    v_lshrrev_b32 v174, 2, v174
    v_cndmask_b32 v163, v119, v118, vcc
    v_add3_u32 v17, v17, v130, v163
    v_add3_u32 v20, v20, v130, v163
    v_cmp_gt_u32 vcc, 2, v111
    v_lshrrev_b32 v113, 2, v113
    v_and_b32 v174, s5, v174
    v_cndmask_b32 v158, v152, v158, vcc
    v_lshl_add_u32 v158, v122, 9, v158
    v_lshl_add_u32 v158, v127, 1, v158
    v_cmp_gt_u32 vcc, 3, v111
    v_and_b32 v113, s6, v113
    v_lshl_or_b32 v174, v174, 1, v113
    v_cndmask_b32 v7, v154, v158, vcc
    v_cmp_gt_u32 vcc, 8, v112
    v_mul_u32_u24 v175, 37, v161
    v_lshrrev_b32 v175, 8, v175
    v_cndmask_b32 v169, v144, v169, vcc
    v_cndmask_b32 v170, v144, v170, vcc
    v_cmp_gt_u32 vcc, 2, v111
    v_mul_u32_u24 v122, 7, v175
    v_sub_u32 v122, v161, v122
    v_cndmask_b32 v171, v144, v171, vcc
    v_lshrrev_b32 v175, 2, v175
    v_lshrrev_b32 v122, 2, v122
    v_and_b32 v175, s5, v175
    v_and_b32 v122, s6, v122
    v_lshl_or_b32 v175, v175, 1, v122
    v_cmp_ne_u32 vcc, s90, v145
    s_nop 0
    s_nop 0
    v_cndmask_b32 v127, 0, v109, vcc
    v_cmp_ne_u32 vcc, s90, v145
    s_nop 0
    s_nop 0
    v_cndmask_b32 v144, 0, v109, vcc
    v_cmp_ne_u32 vcc, s90, v174
    s_nop 0
    s_nop 0
    v_cndmask_b32 v130, 0, v109, vcc
    v_cmp_ne_u32 vcc, s90, v174
    s_nop 0
    s_nop 0
    v_cndmask_b32 v160, 0, v109, vcc
    v_cmp_ne_u32 vcc, s90, v175
    s_nop 0
    s_nop 0
    v_cndmask_b32 v161, 0, v109, vcc
    buffer_load_dwordx4 v135, s[44:47], s4 offen offset:1024 lds
    v_cmp_ne_u32 vcc, s90, v175
    s_nop 0
    s_nop 0
    v_cndmask_b32 v163, 0, v109, vcc
    buffer_load_dwordx4 v136, s[44:47], s4 offen offset:2048 lds
    s_add_u32 m0, s64, 6144
    s_add_u32 s4, s65, 6144
    buffer_load_dwordx4 v115, s[44:47], s4 offen lds
    buffer_load_dwordx4 v134, s[44:47], s4 offen offset:1024 lds
    buffer_load_dwordx4 v108, s[44:47], s4 offen offset:2048 lds
    s_add_u32 m0, s64, 9216
    s_add_u32 s4, s65, 9216
    buffer_load_dwordx4 v133, s[44:47], s4 offen lds
    buffer_load_dwordx4 v135, s[44:47], s4 offen offset:1024 lds
    buffer_load_dwordx4 v136, s[44:47], s4 offen offset:2048 lds
    s_add_u32 m0, s64, 12288
    s_add_u32 s4, s65, 12288
    v_mov_b32 v112, s16
    v_lshlrev_b32 v112, 1, v112
    buffer_load_dwordx4 v115, s[44:47], s4 offen lds
    buffer_load_dwordx4 v134, s[44:47], s4 offen offset:1024 lds
    s_waitcnt vmcnt(8)
    ds_read_b128 v[116:119], v129 offset:0
    ds_read_b128 v[152:155], v131 offset:0
    ds_read_b128 v[156:159], v129 offset:128
    ds_read_b128 v[176:179], v131 offset:128
    ds_read_b128 v[180:183], v129 offset:256
    ds_read_b128 v[184:187], v131 offset:256
    buffer_load_dwordx4 v108, s[44:47], s4 offen offset:2048 lds
    s_add_u32 m0, s64, 15360
    s_add_u32 s4, s65, 15360
    s_waitcnt lgkmcnt(5)
    v_mfma_f32_16x16x32_bf16 v[188:191], v[28:31], v[116:119], 0
    s_waitcnt lgkmcnt(4)
    v_mfma_f32_16x16x32_bf16 v[188:191], v[28:31], v[152:155], v[188:191]
    s_waitcnt lgkmcnt(0)
    buffer_load_dwordx4 v133, s[44:47], s4 offen lds
    v_mfma_f32_16x16x32_bf16 v[188:191], v[28:31], v[156:159], v[188:191]
    v_mfma_f32_16x16x32_bf16 v[188:191], v[28:31], v[176:179], v[188:191]
    v_mfma_f32_16x16x32_bf16 v[188:191], v[28:31], v[180:183], v[188:191]
    v_mfma_f32_16x16x32_bf16 v[188:191], v[28:31], v[184:187], v[188:191]
    buffer_load_dwordx4 v135, s[44:47], s4 offen offset:1024 lds
    s_nop 0
    s_nop 0
    s_nop 0
    s_nop 0
    s_nop 0
    s_nop 0
    s_nop 0
    v_mul_f32 v188, 0xbbaaaaab, v188
    ds_write_b32 v147, v188 offset:0
    buffer_load_dwordx4 v136, s[44:47], s4 offen offset:2048 lds
    s_add_u32 m0, s68, 0
    s_add_u32 s4, s69, 384
    buffer_load_ushort v136, v138, s[52:55], 0 offen
    buffer_load_dwordx3 v[116:118], v114, s[48:51], 0 offen
    s_waitcnt vmcnt(8)
    ds_read_b128 v[152:155], v140 offset:6144
    ds_read_b128 v[156:159], v141 offset:6144
    ds_read_b128 v[176:179], v140 offset:6272
    ds_read_b128 v[180:183], v141 offset:6272
    ds_read_b128 v[184:187], v140 offset:6400
    ds_read_b128 v[188:191], v141 offset:6400
    buffer_load_dwordx4 v[192:195], v120, s[56:59], 0 offen
    s_waitcnt lgkmcnt(5)
    v_mfma_f32_16x16x32_bf16 v[196:199], v[28:31], v[152:155], 0
    s_waitcnt lgkmcnt(4)
    v_mfma_f32_16x16x32_bf16 v[196:199], v[28:31], v[156:159], v[196:199]
    s_waitcnt lgkmcnt(0)
    buffer_load_dwordx4 v[152:155], v120, s[56:59], 0 offen offset:16
    v_mfma_f32_16x16x32_bf16 v[196:199], v[28:31], v[176:179], v[196:199]
    v_mfma_f32_16x16x32_bf16 v[196:199], v[28:31], v[180:183], v[196:199]
    v_mfma_f32_16x16x32_bf16 v[196:199], v[28:31], v[184:187], v[196:199]
    v_mfma_f32_16x16x32_bf16 v[196:199], v[28:31], v[188:191], v[196:199]
    global_load_ushort v112, v112, s[60:61]
    s_nop 0
    s_nop 0
    s_nop 0
    s_nop 0
    s_nop 0
    s_nop 0
    s_nop 0
    v_mul_f32 v196, 0xbbaaaaab, v196
    ds_write_b32 v147, v196 offset:64
    buffer_load_dwordx4 v132, s[40:43], s4 offen lds
    buffer_load_dwordx4 v124, s[40:43], s4 offen offset:1024 lds
    buffer_load_dwordx4 v125, s[40:43], s4 offen offset:2048 lds
    s_waitcnt vmcnt(8)
    ds_read_b128 v[156:159], v140 offset:12288
    ds_read_b128 v[176:179], v141 offset:12288
    ds_read_b128 v[180:183], v140 offset:12416
    ds_read_b128 v[184:187], v141 offset:12416
    ds_read_b128 v[188:191], v140 offset:12544
    ds_read_b128 v[196:199], v141 offset:12544
    s_add_u32 m0, s68, 3072
    s_add_u32 s4, s69, 37248
    buffer_load_dwordx4 v132, s[40:43], s4 offen lds
    s_waitcnt vmcnt(7)
    v_bfe_u32 v138, v116, v146, 16
    v_bfe_u32 v120, v117, v146, 16
    v_bfe_u32 v122, v118, v146, 16
    v_mfma_f32_16x16x16_bf16 v[116:119], v[136:137], v[138:139], 0
    v_mfma_f32_16x16x16_bf16 v[200:203], v[136:137], v[120:121], 0
    s_waitcnt lgkmcnt(4)
    v_mfma_f32_16x16x32_bf16 v[204:207], v[28:31], v[156:159], 0
    s_waitcnt lgkmcnt(0)
    buffer_load_dwordx4 v124, s[40:43], s4 offen offset:1024 lds
    v_mfma_f32_16x16x32_bf16 v[204:207], v[28:31], v[176:179], v[204:207]
    v_mfma_f32_16x16x32_bf16 v[204:207], v[28:31], v[180:183], v[204:207]
    s_waitcnt vmcnt(7)
    v_cndmask_b32 v192, v192, v193, s[88:89]
    v_cndmask_b32 v194, v194, v195, s[88:89]
    v_mfma_f32_16x16x32_bf16 v[204:207], v[28:31], v[184:187], v[204:207]
    v_perm_b32 v146, v194, v192, v126
    v_max_f32 v116, 0, v116
    v_mfma_f32_16x16x32_bf16 v[204:207], v[28:31], v[188:191], v[204:207]
    v_max_f32 v117, 0, v117
    v_max_f32 v118, 0, v118
    v_mfma_f32_16x16x32_bf16 v[204:207], v[28:31], v[196:199], v[204:207]
    buffer_load_dwordx4 v125, s[40:43], s4 offen offset:2048 lds
    v_max_f32 v119, 0, v119
    v_mfma_f32_16x16x16_bf16 v[156:159], v[136:137], v[122:123], 0
    s_waitcnt vmcnt(7)
    s_add_u32 m0, s68, 6144
    s_add_u32 s4, s69, 74112
    v_cndmask_b32 v152, v152, v153, s[88:89]
    v_cndmask_b32 v154, v154, v155, s[88:89]
    v_mul_f32 v204, 0xbbaaaaab, v204
    ds_write_b32 v147, v204 offset:128
    v_perm_b32 v147, v154, v152, v126
    v_cvt_pk_bf16_f32 v140, v116, v117
    buffer_load_dwordx4 v132, s[40:43], s4 offen lds
    v_cvt_pk_bf16_f32 v141, v118, v119
    s_waitcnt vmcnt(7)
    v_max_f32 v200, 0, v200
    v_mfma_f32_16x16x16_bf16 v[116:119], v[146:147], v[140:141], 0
    v_max_f32 v201, 0, v201
    v_max_f32 v202, 0, v202
    v_max_f32 v203, 0, v203
    v_cvt_pk_bf16_f32 v140, v200, v201
    v_cvt_pk_bf16_f32 v141, v202, v203
    v_max_f32 v156, 0, v156
    v_max_f32 v157, 0, v157
    v_mfma_f32_16x16x16_bf16 v[120:123], v[146:147], v[140:141], 0
    buffer_load_dwordx4 v124, s[40:43], s4 offen offset:1024 lds
    v_cvt_pk_bf16_f32 v116, v116, v116
    v_and_b32 v116, 0xffff0000, v116
    v_mul_f32 v116, 0xbfb8aa3b, v116
    v_exp_f32 v116, v116
    v_max_f32 v158, 0, v158
    v_add_f32 v116, 1.0, v116
    v_rcp_f32 v116, v116
    v_cvt_pk_bf16_f32 v120, v120, v120
    v_cvt_pk_bf16_f32 v116, v116, v116
    v_and_b32 v116, 0xffff0000, v116
    v_add_f32 v116, -0.5, v116
    v_mul_f32 v116, 0x41b8aa3b, v116
    buffer_load_dwordx4 v125, s[40:43], s4 offen offset:2048 lds
    ds_write_b32 v143, v116 offset:0
    s_add_u32 m0, s68, 9216
    s_add_u32 s4, s69, 110976
    v_and_b32 v120, 0xffff0000, v120
    v_mul_f32 v120, 0xbfb8aa3b, v120
    v_exp_f32 v120, v120
    v_max_f32 v159, 0, v159
    v_add_f32 v120, 1.0, v120
    v_rcp_f32 v120, v120
    v_cvt_pk_bf16_f32 v140, v156, v157
    v_cvt_pk_bf16_f32 v120, v120, v120
    buffer_load_dwordx4 v132, s[40:43], s4 offen lds
    v_and_b32 v120, 0xffff0000, v120
    s_waitcnt vmcnt(7)
    ds_read_b64_tr_b16 a[72:73], v142 offset:0
    ds_read_b64_tr_b16 a[74:75], v142 offset:768
    ds_read_b64_tr_b16 a[96:97], v142 offset:32
    ds_read_b64_tr_b16 a[98:99], v142 offset:800
    ds_read_b64_tr_b16 a[120:121], v142 offset:64
    ds_read_b64_tr_b16 a[122:123], v142 offset:832
    v_add_f32 v120, -0.5, v120
    v_mul_f32 v120, 0x41b8aa3b, v120
    ds_write_b32 v143, v120 offset:4
    buffer_load_dwordx4 v124, s[40:43], s4 offen offset:1024 lds
    v_cvt_pk_bf16_f32 v141, v158, v159
    v_lshlrev_b32 v112, 16, v112
    v_max_f32 v112, 0xc2c80000, v112
    v_mfma_f32_16x16x16_bf16 v[116:119], v[146:147], v[140:141], 0
    v_min_f32 v112, 0x40930000, v112
    v_mul_f32 v112, 0x3fb8aa3b, v112
    v_exp_f32 v112, v112
    s_nop 0
    v_cvt_pk_bf16_f32 v112, v112, v112
    v_and_b32 v112, 0xffff0000, v112
    v_mul_f32 v108, 0x3fb8aa3b, v112
    v_readfirstlane_b32 s62, v112
    buffer_load_dwordx4 v125, s[40:43], s4 offen offset:2048 lds
    s_add_u32 m0, s68, 0
    s_add_u32 s4, s69, 147840
    s_waitcnt lgkmcnt(1)
    v_cvt_pk_bf16_f32 v116, v116, v116
    v_and_b32 v116, 0xffff0000, v116
    v_mul_f32 v116, 0xbfb8aa3b, v116
    v_exp_f32 v116, v116
    v_readfirstlane_b32 s31, v108
    v_add_f32 v116, 1.0, v116
    v_rcp_f32 v116, v116
    s_nop 0
    v_cvt_pk_bf16_f32 v116, v116, v116
    buffer_load_dwordx4 v132, s[40:43], s4 offen lds
    v_and_b32 v116, 0xffff0000, v116
    v_add_f32 v116, -0.5, v116
    v_mul_f32 v116, 0x41b8aa3b, v116
    ds_write_b32 v143, v116 offset:8
    s_waitcnt vmcnt(7)
    ds_read_b64_tr_b16 a[76:77], v142 offset:3072
    ds_read_b64_tr_b16 a[78:79], v142 offset:3840
    ds_read_b64_tr_b16 a[100:101], v142 offset:3104
    ds_read_b64_tr_b16 a[102:103], v142 offset:3872
    ds_read_b64_tr_b16 a[124:125], v142 offset:3136
    ds_read_b64_tr_b16 a[126:127], v142 offset:3904
    buffer_load_dwordx4 v124, s[40:43], s4 offen offset:1024 lds
    buffer_load_dwordx4 v125, s[40:43], s4 offen offset:2048 lds
    s_waitcnt lgkmcnt(6)
    s_barrier
    ds_read_b128 v[112:115], v149 offset:0
    ds_read_b64 v[146:147], v150 offset:0
    ds_read_b128 v[116:119], v148 offset:0
    ds_read_b128 v[120:123], v149 offset:6144
    ds_read_b64 v[134:135], v150 offset:6144
    ds_read_b128 v[136:139], v148 offset:64
    ds_read_b128 v[152:155], v149 offset:12288
    ds_read_b64 v[140:141], v150 offset:12288
    ds_read_b128 v[156:159], v148 offset:128
    ds_read_b32 v22, v22 offset:0
    ds_read_b32 v23, v23 offset:672
    ds_read_b32 v24, v24 offset:0
    ds_read_b32 v25, v25 offset:672
    ds_read_b32 v26, v26 offset:0
    ds_read_b32 v27, v27 offset:672
    ds_read_b32 v40, v40 offset:336
    ds_read_b32 v52, v52 offset:336
    ds_read_b32 v64, v64 offset:336
    ds_read_b32 v41, v41 offset:332
    ds_read_b32 v53, v53 offset:332
    s_waitcnt vmcnt(6)
    ds_read_b64_tr_b16 a[80:81], v142 offset:6144
    ds_read_b64_tr_b16 a[82:83], v142 offset:6912
    ds_read_b64_tr_b16 a[104:105], v142 offset:6176
    ds_read_b64_tr_b16 a[106:107], v142 offset:6944
    ds_read_b64_tr_b16 a[128:129], v142 offset:6208
    ds_read_b64_tr_b16 a[130:131], v142 offset:6976
    ds_read_b32 v65, v65 offset:332
    ds_read_b32 v42, v42 offset:328
    ds_read_b32 v54, v54 offset:328
    s_waitcnt lgkmcnt(15)
    v_mfma_f32_16x16x16_bf16 v[176:179], v[112:113], v[172:173], v[116:119]
    s_waitcnt lgkmcnt(14)
    ds_read_b32 v66, v66 offset:328
    ds_read_b32 v43, v43 offset:324
    v_mfma_f32_16x16x16_bf16 v[180:183], v[114:115], v[172:173], v[116:119]
    s_add_u32 m0, s68, 3072
    ds_read_b32 v55, v55 offset:324
    ds_read_b32 v67, v67 offset:324
    v_mfma_f32_16x16x16_bf16 v[112:115], v[146:147], v[172:173], v[116:119]
    s_add_u32 s4, s69, 184704
    buffer_load_dwordx4 v132, s[40:43], s4 offen lds
    ds_read_b32 v44, v44 offset:272
    v_mfma_f32_16x16x16_bf16 v[184:187], v[120:121], v[172:173], v[136:139]
    s_waitcnt lgkmcnt(8)
    ds_read_b32 v56, v56 offset:272
    ds_read_b32 v68, v68 offset:272
    v_mfma_f32_16x16x16_bf16 v[116:119], v[122:123], v[172:173], v[136:139]
    s_waitcnt lgkmcnt(7)
    ds_read_b32 v45, v45 offset:268
    ds_read_b32 v57, v57 offset:268
    v_mfma_f32_16x16x16_bf16 v[120:123], v[134:135], v[172:173], v[136:139]
    ds_read_b32 v69, v69 offset:268
    ds_read_b32 v46, v46 offset:264
    v_mfma_f32_16x16x16_bf16 v[188:191], v[152:153], v[172:173], v[156:159]
    ds_read_b32 v58, v58 offset:264
    buffer_load_dwordx4 v124, s[40:43], s4 offen offset:1024 lds
    v_mfma_f32_16x16x16_bf16 v[136:139], v[154:155], v[172:173], v[156:159]
    ds_read_b32 v70, v70 offset:264
    s_waitcnt vmcnt(5)
    v_mfma_f32_16x16x16_bf16 v[152:155], v[140:141], v[172:173], v[156:159]
    s_waitcnt lgkmcnt(11)
    ds_read_b64_tr_b16 a[84:85], v142 offset:9216
    ds_read_b64_tr_b16 a[86:87], v142 offset:9984
    ds_read_b64_tr_b16 a[108:109], v142 offset:9248
    ds_read_b64_tr_b16 a[110:111], v142 offset:10016
    ds_read_b64_tr_b16 a[132:133], v142 offset:9280
    ds_read_b64_tr_b16 a[134:135], v142 offset:10048
    ds_read_b32 v47, v47 offset:260
    ds_read_b32 v59, v59 offset:260
    ds_read_b32 v71, v71 offset:260
    ds_read_b32 v48, v48 offset:208
    buffer_load_dwordx4 v125, s[40:43], s4 offen offset:2048 lds
    ds_read_b32 v60, v60 offset:208
    ds_read_b32 v72, v72 offset:208
    ds_read_b32 v49, v49 offset:204
    ds_read_b32 v61, v61 offset:204
    ds_read_b32 v73, v73 offset:204
    ds_read_b32 v50, v50 offset:200
    ds_read_b32 v62, v62 offset:200
    ds_read_b32 v74, v74 offset:200
    ds_read_b32 v51, v51 offset:196
    ds_read_b32 v63, v63 offset:196
    ds_read_b32 v75, v75 offset:196
    ds_read_b32 v162, v162 offset:336
    s_add_u32 m0, s68, 6144
    s_add_u32 s4, s69, 36864
    buffer_load_dwordx4 v132, s[40:43], s69 offen lds
    v_cvt_pk_bf16_f32 v176, v176, v177
    v_accvgpr_write_b32 a216, v176
    v_cvt_pk_bf16_f32 v178, v178, v179
    v_accvgpr_write_b32 a217, v178
    v_cvt_pk_bf16_f32 v180, v180, v181
    v_accvgpr_write_b32 a240, v180
    v_cvt_pk_bf16_f32 v182, v182, v183
    v_accvgpr_write_b32 a241, v182
    v_cvt_pk_bf16_f32 v84, v112, v113
    v_cvt_pk_bf16_f32 v85, v114, v115
    v_cvt_pk_bf16_f32 v184, v184, v185
    v_accvgpr_write_b32 a218, v184
    v_cvt_pk_bf16_f32 v186, v186, v187
    v_accvgpr_write_b32 a219, v186
    buffer_load_dwordx4 v124, s[40:43], s69 offen offset:1024 lds
    ds_read_b128 v[112:115], v149 offset:38912
    ds_read_b64 v[146:147], v150 offset:38912
    s_waitcnt vmcnt(5)
    ds_read_b64_tr_b16 a[88:89], v142 offset:0
    ds_read_b64_tr_b16 a[90:91], v142 offset:768
    s_waitcnt lgkmcnt(4)
    ds_read_b64_tr_b16 a[112:113], v142 offset:32
    ds_read_b64_tr_b16 a[114:115], v142 offset:800
    ds_read_b64_tr_b16 a[136:137], v142 offset:64
    ds_read_b64_tr_b16 a[138:139], v142 offset:832
    ds_read_b128 v[156:159], v148 offset:192
    v_cvt_pk_bf16_f32 v116, v116, v117
    v_accvgpr_write_b32 a242, v116
    v_cvt_pk_bf16_f32 v118, v118, v119
    buffer_load_dwordx4 v125, s[40:43], s69 offen offset:2048 lds
    s_add_u32 m0, s68, 9216
    v_accvgpr_write_b32 a243, v118
    v_cvt_pk_bf16_f32 v86, v120, v121
    v_cvt_pk_bf16_f32 v87, v122, v123
    v_cvt_pk_bf16_f32 v188, v188, v189
    v_accvgpr_write_b32 a232, v188
    v_cvt_pk_bf16_f32 v190, v190, v191
    v_accvgpr_write_b32 a233, v190
    v_cvt_pk_bf16_f32 v76, v136, v137
    v_cvt_pk_bf16_f32 v77, v138, v139
    v_cvt_pk_bf16_f32 v100, v152, v153
    v_cvt_pk_bf16_f32 v101, v154, v155
    ds_read_b128 v[116:119], v149 offset:45056
    ds_read_b64 v[134:135], v150 offset:45056
    buffer_load_dwordx4 v132, s[40:43], s4 offen lds
    ds_read_b128 v[120:123], v148 offset:256
    ds_read_b128 v[136:139], v149 offset:51200
    ds_read_b64 v[140:141], v150 offset:51200
    ds_read_b128 v[152:155], v148 offset:320
    s_waitcnt lgkmcnt(6)
    v_mfma_f32_16x16x16_bf16 v[176:179], v[112:113], v[172:173], v[156:159]
    v_readfirstlane_b32 s39, v162
    v_add_f32 v22, v22, v127
    v_mfma_f32_16x16x16_bf16 v[180:183], v[114:115], v[172:173], v[156:159]
    v_add_f32 v23, v23, v144
    v_add_f32 v24, v24, v130
    v_mfma_f32_16x16x16_bf16 v[112:115], v[146:147], v[172:173], v[156:159]
    buffer_load_dwordx4 v124, s[40:43], s4 offen offset:1024 lds
    v_add_f32 v25, v25, v160
    v_cvt_pk_bf16_f32 v176, v176, v177
    v_accvgpr_write_b32 a220, v176
    v_cvt_pk_bf16_f32 v178, v178, v179
    v_accvgpr_write_b32 a221, v178
    v_cvt_pk_bf16_f32 v180, v180, v181
    v_accvgpr_write_b32 a244, v180
    v_cvt_pk_bf16_f32 v182, v182, v183
    v_accvgpr_write_b32 a245, v182
    v_cvt_pk_bf16_f32 v88, v112, v113
    v_cvt_pk_bf16_f32 v89, v114, v115
    s_waitcnt lgkmcnt(3)
    v_mfma_f32_16x16x16_bf16 v[112:115], v[116:117], v[172:173], v[120:123]
    s_waitcnt lgkmcnt(1)
    ds_read_b128 v[156:159], v149 offset:57344
    ds_read_b64 v[126:127], v150 offset:57344
    v_mfma_f32_16x16x16_bf16 v[176:179], v[118:119], v[172:173], v[120:123]
    s_waitcnt lgkmcnt(2)
    buffer_load_dwordx4 v125, s[40:43], s4 offen offset:2048 lds
    ds_read_b128 v[116:119], v148 offset:384
    v_mfma_f32_16x16x16_bf16 v[180:183], v[134:135], v[172:173], v[120:123]
    s_add_u32 m0, s68, 0
    v_cvt_pk_bf16_f32 v112, v112, v113
    v_accvgpr_write_b32 a222, v112
    v_mfma_f32_16x16x16_bf16 v[184:187], v[136:137], v[172:173], v[152:155]
    s_add_u32 s4, s69, 73728
    v_cvt_pk_bf16_f32 v114, v114, v115
    v_accvgpr_write_b32 a223, v114
    v_mfma_f32_16x16x16_bf16 v[112:115], v[138:139], v[172:173], v[152:155]
    v_cvt_pk_bf16_f32 v176, v176, v177
    v_accvgpr_write_b32 a246, v176
    v_mfma_f32_16x16x16_bf16 v[120:123], v[140:141], v[172:173], v[152:155]
    buffer_load_dwordx4 v132, s[40:43], s4 offen lds
    v_cvt_pk_bf16_f32 v178, v178, v179
    v_accvgpr_write_b32 a247, v178
    v_cvt_pk_bf16_f32 v90, v180, v181
    s_waitcnt vmcnt(7)
    ds_read_b64_tr_b16 a[92:93], v142 offset:3072
    ds_read_b64_tr_b16 a[94:95], v142 offset:3840
    ds_read_b64_tr_b16 a[116:117], v142 offset:3104
    ds_read_b64_tr_b16 a[118:119], v142 offset:3872
    ds_read_b64_tr_b16 a[140:141], v142 offset:3136
    ds_read_b64_tr_b16 a[142:143], v142 offset:3904
    s_waitcnt lgkmcnt(6)
    v_mfma_f32_16x16x16_bf16 v[136:139], v[156:157], v[172:173], v[116:119]
    v_cvt_pk_bf16_f32 v91, v182, v183
    v_cvt_pk_bf16_f32 v184, v184, v185
    v_mfma_f32_16x16x16_bf16 v[152:155], v[158:159], v[172:173], v[116:119]
    buffer_load_dwordx4 v124, s[40:43], s4 offen offset:1024 lds
    ds_read_b128 v[156:159], v151 offset:0
    v_mfma_f32_16x16x16_bf16 v[176:179], v[126:127], v[172:173], v[116:119]
    ds_read_b64 v[126:127], v128 offset:0
    ds_read_b128 v[180:183], v148 offset:448
    v_accvgpr_write_b32 a234, v184
    v_cvt_pk_bf16_f32 v186, v186, v187
    v_accvgpr_write_b32 a235, v186
    v_cvt_pk_bf16_f32 v78, v112, v113
    v_cvt_pk_bf16_f32 v79, v114, v115
    v_cvt_pk_bf16_f32 v102, v120, v121
    v_cvt_pk_bf16_f32 v103, v122, v123
    v_cvt_pk_bf16_f32 v136, v136, v137
    v_accvgpr_write_b32 a224, v136
    buffer_load_dwordx4 v125, s[40:43], s4 offen offset:2048 lds
    ds_read_b128 v[112:115], v151 offset:6144
    ds_read_b64 v[130:131], v128 offset:6144
    ds_read_b128 v[116:119], v148 offset:512
    s_add_u32 m0, s68, 3072
    s_add_u32 s4, s69, 110592
    s_waitcnt lgkmcnt(6)
    v_cvt_pk_bf16_f32 v138, v138, v139
    v_accvgpr_write_b32 a225, v138
    v_cvt_pk_bf16_f32 v152, v152, v153
    v_accvgpr_write_b32 a248, v152
    v_cvt_pk_bf16_f32 v154, v154, v155
    v_accvgpr_write_b32 a249, v154
    v_cvt_pk_bf16_f32 v92, v176, v177
    v_cvt_pk_bf16_f32 v93, v178, v179
    buffer_load_dwordx4 v132, s[40:43], s4 offen lds
    s_waitcnt lgkmcnt(3)
    s_waitcnt vmcnt(7)
    v_mfma_f32_16x16x16_bf16 v[120:123], v[156:157], v[172:173], v[180:183]
    ds_read_b64_tr_b16 a[0:1], v142 offset:6144
    ds_read_b64_tr_b16 a[2:3], v142 offset:6912
    v_mfma_f32_16x16x16_bf16 v[136:139], v[158:159], v[172:173], v[180:183]
    ds_read_b64_tr_b16 a[24:25], v142 offset:6176
    ds_read_b64_tr_b16 a[26:27], v142 offset:6944
    v_mfma_f32_16x16x16_bf16 v[152:155], v[126:127], v[172:173], v[180:183]
    s_waitcnt lgkmcnt(6)
    ds_read_b64_tr_b16 a[48:49], v142 offset:6208
    s_waitcnt lgkmcnt(5)
    v_mfma_f32_16x16x16_bf16 v[156:159], v[112:113], v[172:173], v[116:119]
    buffer_load_dwordx4 v124, s[40:43], s4 offen offset:1024 lds
    ds_read_b64_tr_b16 a[50:51], v142 offset:6976
    v_mfma_f32_16x16x16_bf16 v[176:179], v[114:115], v[172:173], v[116:119]
    ds_read_b128 v[112:115], v151 offset:12288
    ds_read_b64 v[126:127], v128 offset:12288
    v_mfma_f32_16x16x16_bf16 v[180:183], v[130:131], v[172:173], v[116:119]
    ds_read_b128 v[184:187], v148 offset:576
    v_cvt_pk_bf16_f32 v120, v120, v121
    v_accvgpr_write_b32 a226, v120
    v_cvt_pk_bf16_f32 v122, v122, v123
    v_accvgpr_write_b32 a227, v122
    v_cvt_pk_bf16_f32 v136, v136, v137
    v_accvgpr_write_b32 a250, v136
    buffer_load_dwordx4 v125, s[40:43], s4 offen offset:2048 lds
    s_add_u32 m0, s68, 6144
    s_add_u32 s4, s69, 147456
    v_cvt_pk_bf16_f32 v138, v138, v139
    v_accvgpr_write_b32 a251, v138
    v_cvt_pk_bf16_f32 v94, v152, v153
    v_cvt_pk_bf16_f32 v95, v154, v155
    v_cvt_pk_bf16_f32 v156, v156, v157
    v_accvgpr_write_b32 a236, v156
    v_cvt_pk_bf16_f32 v158, v158, v159
    v_accvgpr_write_b32 a237, v158
    v_cvt_pk_bf16_f32 v80, v176, v177
    s_waitcnt lgkmcnt(3)
    v_cvt_pk_bf16_f32 v81, v178, v179
    v_cvt_pk_bf16_f32 v104, v180, v181
    buffer_load_dwordx4 v132, s[40:43], s4 offen lds
    ds_read_b128 v[116:119], v151 offset:18432
    s_waitcnt lgkmcnt(1)
    v_mfma_f32_16x16x16_bf16 v[120:123], v[112:113], v[172:173], v[184:187]
    s_waitcnt vmcnt(7)
    ds_read_b64_tr_b16 a[4:5], v142 offset:9216
    ds_read_b64_tr_b16 a[6:7], v142 offset:9984
    v_mfma_f32_16x16x16_bf16 v[136:139], v[114:115], v[172:173], v[184:187]
    ds_read_b64_tr_b16 a[28:29], v142 offset:9248
    ds_read_b64_tr_b16 a[30:31], v142 offset:10016
    v_mfma_f32_16x16x16_bf16 v[112:115], v[126:127], v[172:173], v[184:187]
    ds_read_b64_tr_b16 a[52:53], v142 offset:9280
    ds_read_b64_tr_b16 a[54:55], v142 offset:10048
    ds_read_b64 v[126:127], v128 offset:18432
    ds_read_b128 v[152:155], v148 offset:640
    buffer_load_dwordx4 v124, s[40:43], s4 offen offset:1024 lds
    v_cvt_pk_bf16_f32 v105, v182, v183
    v_cvt_pk_bf16_f32 v120, v120, v121
    v_accvgpr_write_b32 a228, v120
    v_cvt_pk_bf16_f32 v122, v122, v123
    v_accvgpr_write_b32 a229, v122
    v_cvt_pk_bf16_f32 v136, v136, v137
    v_accvgpr_write_b32 a252, v136
    v_cvt_pk_bf16_f32 v138, v138, v139
    v_accvgpr_write_b32 a253, v138
    v_cvt_pk_bf16_f32 v96, v112, v113
    v_cvt_pk_bf16_f32 v97, v114, v115
    ds_read_b128 v[112:115], v151 offset:24576
    ds_read_b64 v[134:135], v128 offset:24576
    ds_read_b128 v[120:123], v148 offset:704
    buffer_load_dwordx4 v125, s[40:43], s4 offen offset:2048 lds
    s_add_u32 m0, s68, 9216
    s_add_u32 s4, s69, 184320
    v_add_f32 v26, v26, v161
    v_add_f32 v27, v27, v163
    v_cndmask_b32 v22, v110, v22, s[86:87]
    v_cndmask_b32 v24, v110, v24, s[86:87]
    v_cndmask_b32 v26, v110, v26, s[86:87]
    s_waitcnt lgkmcnt(5)
    s_waitcnt lgkmcnt(3)
    v_mfma_f32_16x16x16_bf16 v[128:131], v[116:117], v[172:173], v[152:155]
    v_mfma_f32_16x16x16_bf16 v[136:139], v[118:119], v[172:173], v[152:155]
    v_mfma_f32_16x16x16_bf16 v[116:119], v[126:127], v[172:173], v[152:155]
    buffer_load_dwordx4 v132, s[40:43], s4 offen lds
    s_nop 0
    s_nop 0
    s_waitcnt vmcnt(7)
    ds_read_b64_tr_b16 a[8:9], v142 offset:0
    ds_read_b64_tr_b16 a[10:11], v142 offset:768
    s_waitcnt lgkmcnt(3)
    s_barrier
    s_waitcnt lgkmcnt(2)
    v_mfma_f32_16x16x16_bf16 v[148:151], v[112:113], v[172:173], v[120:123]
    ds_read_b64_tr_b16 a[32:33], v142 offset:32
    ds_read_b64_tr_b16 a[34:35], v142 offset:800
    v_mfma_f32_16x16x16_bf16 v[152:155], v[114:115], v[172:173], v[120:123]
    ds_read_b64_tr_b16 a[56:57], v142 offset:64
    ds_read_b64_tr_b16 a[58:59], v142 offset:832
    v_mfma_f32_16x16x16_bf16 v[112:115], v[134:135], v[172:173], v[120:123]
    buffer_load_dwordx4 v124, s[40:43], s4 offen offset:1024 lds
    v_cvt_pk_bf16_f32 v128, v128, v129
    v_accvgpr_write_b32 a230, v128
    v_cvt_pk_bf16_f32 v130, v130, v131
    v_accvgpr_write_b32 a231, v130
    v_cvt_pk_bf16_f32 v136, v136, v137
    v_accvgpr_write_b32 a254, v136
    v_cvt_pk_bf16_f32 v138, v138, v139
    v_accvgpr_write_b32 a255, v138
    v_cvt_pk_bf16_f32 v98, v116, v117
    v_cvt_pk_bf16_f32 v99, v118, v119
    v_cvt_pk_bf16_f32 v148, v148, v149
    v_accvgpr_write_b32 a238, v148
    v_cvt_pk_bf16_f32 v150, v150, v151
    v_accvgpr_write_b32 a239, v150
    buffer_load_dwordx4 v125, s[40:43], s4 offen offset:2048 lds
    s_add_u32 m0, s68, 0
    s_add_u32 s4, s69, 768
    v_cvt_pk_bf16_f32 v82, v152, v153
    v_cvt_pk_bf16_f32 v83, v154, v155
    v_cvt_pk_bf16_f32 v106, v112, v113
    v_cvt_pk_bf16_f32 v107, v114, v115
    v_lshl_add_u32 v108, v111, 2, 0
    s_waitcnt lgkmcnt(0)
    v_mul_u32_u24 v126, 37, v108
    v_lshrrev_b32 v126, 8, v126
    v_mul_u32_u24 v127, 7, v126
    v_sub_u32 v127, v108, v127
    v_lshrrev_b32 v126, 2, v126
    v_lshrrev_b32 v127, 2, v127
    buffer_load_dwordx4 v132, s[40:43], s4 offen lds
    s_waitcnt vmcnt(7)
    ds_read_b64_tr_b16 a[12:13], v142 offset:3072
    ds_read_b64_tr_b16 a[14:15], v142 offset:3840
    ds_read_b64_tr_b16 a[36:37], v142 offset:3104
    ds_read_b64_tr_b16 a[38:39], v142 offset:3872
    ds_read_b64_tr_b16 a[60:61], v142 offset:3136
    ds_read_b64_tr_b16 a[62:63], v142 offset:3904
    v_and_b32 v126, s5, v126
    v_and_b32 v127, s6, v127
    v_lshl_or_b32 v126, v126, 1, v127
    v_cmp_ne_u32 vcc, v126, v145
    v_lshl_add_u32 v108, v111, 2, 1
    v_mul_u32_u24 v127, 37, v108
    v_cndmask_b32 v172, 0, v109, vcc
    buffer_load_dwordx4 v124, s[40:43], s4 offen offset:1024 lds
    v_add_f32 v40, v40, v172
    v_cmp_ne_u32 vcc, v126, v174
    v_lshrrev_b32 v127, 8, v127
    v_mul_u32_u24 v172, 7, v127
    v_cndmask_b32 v173, 0, v109, vcc
    v_add_f32 v52, v52, v173
    v_cmp_ne_u32 vcc, v126, v175
    v_sub_u32 v172, v108, v172
    v_lshrrev_b32 v127, 2, v127
    v_cndmask_b32 v108, 0, v109, vcc
    v_add_f32 v64, v64, v108
    v_lshrrev_b32 v172, 2, v172
    v_and_b32 v127, s5, v127
    v_and_b32 v172, s6, v172
    buffer_load_dwordx4 v125, s[40:43], s4 offen offset:2048 lds
    s_add_u32 m0, s68, 3072
    s_add_u32 s4, s69, 37632
    s_waitcnt lgkmcnt(0)
    v_lshl_or_b32 v127, v127, 1, v172
    v_cmp_ne_u32 vcc, v127, v145
    v_lshl_add_u32 v108, v111, 2, 2
    v_mul_u32_u24 v126, 37, v108
    v_cndmask_b32 v172, 0, v109, vcc
    v_add_f32 v41, v41, v172
    v_cmp_ne_u32 vcc, v127, v174
    v_lshrrev_b32 v126, 8, v126
    v_mul_u32_u24 v172, 7, v126
    v_cndmask_b32 v173, 0, v109, vcc
    v_add_f32 v53, v53, v173
    buffer_load_dwordx4 v132, s[40:43], s4 offen lds
    s_waitcnt vmcnt(7)
    ds_read_b64_tr_b16 a[16:17], v142 offset:6144
    ds_read_b64_tr_b16 a[18:19], v142 offset:6912
    ds_read_b64_tr_b16 a[40:41], v142 offset:6176
    ds_read_b64_tr_b16 a[42:43], v142 offset:6944
    ds_read_b64_tr_b16 a[64:65], v142 offset:6208
    ds_read_b64_tr_b16 a[66:67], v142 offset:6976
    v_cmp_ne_u32 vcc, v127, v175
    v_sub_u32 v172, v108, v172
    v_lshrrev_b32 v126, 2, v126
    v_cndmask_b32 v108, 0, v109, vcc
    v_add_f32 v65, v65, v108
    v_lshrrev_b32 v172, 2, v172
    v_and_b32 v126, s5, v126
    buffer_load_dwordx4 v124, s[40:43], s4 offen offset:1024 lds
    v_and_b32 v172, s6, v172
    v_lshl_or_b32 v126, v126, 1, v172
    v_cmp_ne_u32 vcc, v126, v145
    v_lshl_add_u32 v108, v111, 2, 3
    v_mul_u32_u24 v127, 37, v108
    v_cndmask_b32 v172, 0, v109, vcc
    v_add_f32 v42, v42, v172
    v_cmp_ne_u32 vcc, v126, v174
    v_lshrrev_b32 v127, 8, v127
    v_mul_u32_u24 v172, 7, v127
    v_cndmask_b32 v173, 0, v109, vcc
    v_add_f32 v54, v54, v173
    v_cmp_ne_u32 vcc, v126, v175
    v_sub_u32 v172, v108, v172
    buffer_load_dwordx4 v125, s[40:43], s4 offen offset:2048 lds
    s_add_u32 m0, s68, 6144
    s_add_u32 s4, s69, 74496
    s_waitcnt lgkmcnt(0)
    v_cndmask_b32 v108, 0, v109, vcc
    v_add_f32 v66, v66, v108
    v_lshrrev_b32 v127, 2, v127
    v_lshrrev_b32 v172, 2, v172
    v_and_b32 v127, s5, v127
    v_and_b32 v172, s6, v172
    v_lshl_or_b32 v127, v127, 1, v172
    v_cmp_ne_u32 vcc, v127, v145
    v_lshl_add_u32 v108, v111, 2, 16
    v_mul_u32_u24 v126, 37, v108
    v_cndmask_b32 v172, 0, v109, vcc
    buffer_load_dwordx4 v132, s[40:43], s4 offen lds
    v_add_f32 v43, v43, v172
    v_cmp_ne_u32 vcc, v127, v174
    v_lshrrev_b32 v126, 8, v126
    v_mul_u32_u24 v172, 7, v126
    v_cndmask_b32 v173, 0, v109, vcc
    s_waitcnt vmcnt(7)
    ds_read_b64_tr_b16 a[20:21], v142 offset:9216
    ds_read_b64_tr_b16 a[22:23], v142 offset:9984
    ds_read_b64_tr_b16 a[44:45], v142 offset:9248
    ds_read_b64_tr_b16 a[46:47], v142 offset:10016
    ds_read_b64_tr_b16 a[68:69], v142 offset:9280
    ds_read_b64_tr_b16 a[70:71], v142 offset:10048
    v_add_f32 v55, v55, v173
    buffer_load_dwordx4 v124, s[40:43], s4 offen offset:1024 lds
    v_cmp_ne_u32 vcc, v127, v175
    v_sub_u32 v172, v108, v172
    v_lshrrev_b32 v126, 2, v126
    v_cndmask_b32 v108, 0, v109, vcc
    v_add_f32 v67, v67, v108
    v_lshrrev_b32 v172, 2, v172
    v_and_b32 v126, s5, v126
    v_and_b32 v172, s6, v172
    v_lshl_or_b32 v126, v126, 1, v172
    v_cmp_ne_u32 vcc, v126, v145
    v_lshl_add_u32 v108, v111, 2, 17
    v_mul_u32_u24 v127, 37, v108
    v_cndmask_b32 v172, 0, v109, vcc
    v_add_f32 v44, v44, v172
    buffer_load_dwordx4 v125, s[40:43], s4 offen offset:2048 lds
    s_add_u32 m0, s68, 9216
    s_add_u32 s4, s69, 111360
    v_cmp_ne_u32 vcc, v126, v174
    v_lshrrev_b32 v127, 8, v127
    v_mul_u32_u24 v172, 7, v127
    v_cndmask_b32 v173, 0, v109, vcc
    s_waitcnt lgkmcnt(0)
    v_add_f32 v56, v56, v173
    v_cmp_ne_u32 vcc, v126, v175
    v_sub_u32 v172, v108, v172
    v_lshrrev_b32 v127, 2, v127
    v_cndmask_b32 v108, 0, v109, vcc
    v_add_f32 v68, v68, v108
    v_lshrrev_b32 v172, 2, v172
    buffer_load_dwordx4 v132, s[40:43], s4 offen lds
    v_and_b32 v127, s5, v127
    v_and_b32 v172, s6, v172
    v_lshl_or_b32 v127, v127, 1, v172
    v_cmp_ne_u32 vcc, v127, v145
    v_lshl_add_u32 v108, v111, 2, 18
    s_waitcnt vmcnt(7)
    ds_read_b64_tr_b16 a[144:145], v142 offset:0
    ds_read_b64_tr_b16 a[146:147], v142 offset:768
    ds_read_b64_tr_b16 a[168:169], v142 offset:32
    ds_read_b64_tr_b16 a[170:171], v142 offset:800
    ds_read_b64_tr_b16 a[192:193], v142 offset:64
    ds_read_b64_tr_b16 a[194:195], v142 offset:832
    v_cndmask_b32 v126, 0, v109, vcc
    buffer_load_dwordx4 v124, s[40:43], s4 offen offset:1024 lds
    v_add_f32 v45, v45, v126
    v_cmp_ne_u32 vcc, v127, v174
    v_mul_u32_u24 v126, 37, v108
    v_lshrrev_b32 v126, 8, v126
    v_cndmask_b32 v172, 0, v109, vcc
    v_add_f32 v57, v57, v172
    v_cmp_ne_u32 vcc, v127, v175
    v_mul_u32_u24 v127, 7, v126
    v_sub_u32 v127, v108, v127
    v_cndmask_b32 v108, 0, v109, vcc
    v_add_f32 v69, v69, v108
    v_lshrrev_b32 v126, 2, v126
    v_lshrrev_b32 v127, 2, v127
    v_and_b32 v126, s5, v126
    buffer_load_dwordx4 v125, s[40:43], s4 offen offset:2048 lds
    s_add_u32 m0, s68, 0
    s_add_u32 s4, s69, 148224
    v_and_b32 v127, s6, v127
    v_lshl_or_b32 v126, v126, 1, v127
    v_cmp_ne_u32 vcc, v126, v145
    v_lshl_add_u32 v108, v111, 2, 19
    s_waitcnt lgkmcnt(0)
    v_cndmask_b32 v127, 0, v109, vcc
    v_add_f32 v46, v46, v127
    v_cmp_ne_u32 vcc, v126, v174
    v_mul_u32_u24 v127, 37, v108
    v_lshrrev_b32 v127, 8, v127
    v_cndmask_b32 v172, 0, v109, vcc
    v_add_f32 v58, v58, v172
    buffer_load_dwordx4 v132, s[40:43], s4 offen lds
    v_cmp_ne_u32 vcc, v126, v175
    v_mul_u32_u24 v126, 7, v127
    v_sub_u32 v126, v108, v126
    v_cndmask_b32 v108, 0, v109, vcc
    v_add_f32 v70, v70, v108
    s_waitcnt vmcnt(7)
    ds_read_b64_tr_b16 a[148:149], v142 offset:3072
    ds_read_b64_tr_b16 a[150:151], v142 offset:3840
    ds_read_b64_tr_b16 a[172:173], v142 offset:3104
    ds_read_b64_tr_b16 a[174:175], v142 offset:3872
    ds_read_b64_tr_b16 a[196:197], v142 offset:3136
    ds_read_b64_tr_b16 a[198:199], v142 offset:3904
    v_lshrrev_b32 v127, 2, v127
    buffer_load_dwordx4 v124, s[40:43], s4 offen offset:1024 lds
    v_lshrrev_b32 v126, 2, v126
    v_and_b32 v127, s5, v127
    v_and_b32 v126, s6, v126
    v_lshl_or_b32 v127, v127, 1, v126
    v_cmp_ne_u32 vcc, v127, v145
    v_lshl_add_u32 v108, v111, 2, 32
    v_mul_u32_u24 v126, 37, v108
    v_cndmask_b32 v172, 0, v109, vcc
    v_add_f32 v47, v47, v172
    v_cmp_ne_u32 vcc, v127, v174
    v_lshrrev_b32 v126, 8, v126
    v_mul_u32_u24 v172, 7, v126
    v_cndmask_b32 v173, 0, v109, vcc
    v_add_f32 v59, v59, v173
    buffer_load_dwordx4 v125, s[40:43], s4 offen offset:2048 lds
    s_add_u32 m0, s68, 3072
    s_add_u32 s4, s69, 185088
    v_cmp_ne_u32 vcc, v127, v175
    v_sub_u32 v172, v108, v172
    v_lshrrev_b32 v126, 2, v126
    v_cndmask_b32 v108, 0, v109, vcc
    s_waitcnt lgkmcnt(0)
    v_add_f32 v71, v71, v108
    v_lshrrev_b32 v172, 2, v172
    v_and_b32 v126, s5, v126
    v_and_b32 v172, s6, v172
    v_lshl_or_b32 v126, v126, 1, v172
    v_cmp_ne_u32 vcc, v126, v145
    v_lshl_add_u32 v108, v111, 2, 33
    buffer_load_dwordx4 v132, s[40:43], s4 offen lds
    v_cndmask_b32 v127, 0, v109, vcc
    v_add_f32 v48, v48, v127
    v_cmp_ne_u32 vcc, v126, v174
    v_mul_u32_u24 v172, 37, v108
    v_lshrrev_b32 v172, 8, v172
    s_waitcnt vmcnt(7)
    ds_read_b64_tr_b16 a[152:153], v142 offset:6144
    ds_read_b64_tr_b16 a[154:155], v142 offset:6912
    ds_read_b64_tr_b16 a[176:177], v142 offset:6176
    ds_read_b64_tr_b16 a[178:179], v142 offset:6944
    ds_read_b64_tr_b16 a[200:201], v142 offset:6208
    ds_read_b64_tr_b16 a[202:203], v142 offset:6976
    v_cndmask_b32 v173, 0, v109, vcc
    buffer_load_dwordx4 v124, s[40:43], s4 offen offset:1024 lds
    v_add_f32 v60, v60, v173
    v_cmp_ne_u32 vcc, v126, v175
    v_mul_u32_u24 v173, 7, v172
    v_sub_u32 v173, v108, v173
    v_cndmask_b32 v108, 0, v109, vcc
    v_add_f32 v72, v72, v108
    v_lshrrev_b32 v172, 2, v172
    v_lshrrev_b32 v173, 2, v173
    v_and_b32 v172, s5, v172
    v_and_b32 v173, s6, v173
    v_lshl_or_b32 v172, v172, 1, v173
    v_cmp_ne_u32 vcc, v172, v145
    v_lshl_add_u32 v108, v111, 2, 34
    v_mul_u32_u24 v173, 37, v108
    buffer_load_dwordx4 v125, s[40:43], s4 offen offset:2048 lds
    s_add_u32 m0, s28, 8192
    v_cndmask_b32 v140, 0, v109, vcc
    v_add_f32 v49, v49, v140
    v_cmp_ne_u32 vcc, v172, v174
    v_lshrrev_b32 v173, 8, v173
    v_mul_u32_u24 v140, 7, v173
    v_cndmask_b32 v141, 0, v109, vcc
    v_add_f32 v61, v61, v141
    v_cmp_ne_u32 vcc, v172, v175
    v_sub_u32 v140, v108, v140
    v_lshrrev_b32 v173, 2, v173
    v_cndmask_b32 v108, 0, v109, vcc
    v_add_f32 v73, v73, v108
    v_lshrrev_b32 v140, 2, v140
    buffer_load_dwordx4 v12, s[8:11], s25 offen nt lds
    s_add_u32 m0, s28, 12288
    v_and_b32 v173, s5, v173
    v_and_b32 v140, s6, v140
    v_lshl_or_b32 v173, v173, 1, v140
    v_cmp_ne_u32 vcc, v173, v145
    s_waitcnt vmcnt(7)
    ds_read_b64_tr_b16 a[156:157], v142 offset:9216
    ds_read_b64_tr_b16 a[158:159], v142 offset:9984
    ds_read_b64_tr_b16 a[180:181], v142 offset:9248
    ds_read_b64_tr_b16 a[182:183], v142 offset:10016
    ds_read_b64_tr_b16 a[204:205], v142 offset:9280
    ds_read_b64_tr_b16 a[206:207], v142 offset:10048
    v_cndmask_b32 v108, 0, v109, vcc
    buffer_load_dwordx4 v13, s[8:11], s25 offen nt lds
    s_add_u32 m0, s29, 0
    v_add_f32 v50, v50, v108
    v_cmp_ne_u32 vcc, v173, v174
    v_lshl_add_u32 v172, v111, 2, 35
    v_mul_u32_u24 v108, 37, v172
    v_cndmask_b32 v111, 0, v109, vcc
    v_add_f32 v62, v62, v111
    v_cmp_ne_u32 vcc, v173, v175
    v_lshrrev_b32 v108, 8, v108
    v_mul_u32_u24 v111, 7, v108
    v_cndmask_b32 v173, 0, v109, vcc
    v_add_f32 v74, v74, v173
    v_sub_u32 v111, v172, v111
    v_lshrrev_b32 v108, 2, v108
    buffer_load_dwordx4 v14, s[8:11], s25 offen nt lds
    s_add_u32 m0, s28, 65536
    v_lshrrev_b32 v111, 2, v111
    v_and_b32 v108, s5, v108
    v_and_b32 v111, s6, v111
    v_lshl_or_b32 v108, v108, 1, v111
    v_cmp_ne_u32 vcc, v108, v145
    s_cmp_lt_u32 1, s17
    s_cselect_b32 s10, s36, 0
    v_cndmask_b32 v111, 0, v109, vcc
    v_add_f32 v51, v51, v111
    v_cmp_ne_u32 vcc, v108, v174
    v_mov_b32 v112, 0
    v_mov_b32 v113, 0
    v_cndmask_b32 v111, 0, v109, vcc
    v_add_f32 v63, v63, v111
    v_cmp_ne_u32 vcc, v108, v175
    v_mov_b32 v114, 0
    v_mov_b32 v115, 0
    v_cndmask_b32 v108, 0, v109, vcc
    v_add_f32 v75, v75, v108
    ds_read_b128 v[116:119], v165 offset:0
    s_waitcnt vmcnt(6)
    ds_read_b64_tr_b16 a[160:161], v142 offset:0
    ds_read_b64_tr_b16 a[162:163], v142 offset:768
    ds_read_b64_tr_b16 a[184:185], v142 offset:32
    ds_read_b64_tr_b16 a[186:187], v142 offset:800
    ds_read_b64_tr_b16 a[208:209], v142 offset:64
    ds_read_b64_tr_b16 a[210:211], v142 offset:832
    ds_read_b128 v[120:123], v166 offset:0
    ds_read_b128 v[124:127], v165 offset:128
    ds_read_b128 v[128:131], v166 offset:128
    ds_read_b128 v[132:135], v165 offset:256
    ds_read_b128 v[136:139], v166 offset:256
    ds_write_b128 v167, v[112:115] offset:16
    ds_write_b64 v167, v[112:113] offset:56
    s_waitcnt lgkmcnt(12)
    v_mfma_f32_16x16x32_bf16 v[144:147], a[72:75], v[116:119], 0
    s_waitcnt lgkmcnt(10)
    v_mfma_f32_16x16x32_bf16 v[148:151], a[96:99], v[116:119], 0
    s_waitcnt lgkmcnt(6)
    ds_write_b64 v167, v[112:113] offset:64
    v_mfma_f32_16x16x32_bf16 v[144:147], a[76:79], v[120:123], v[144:147]
    s_waitcnt lgkmcnt(2)
    v_mfma_f32_16x16x32_bf16 v[144:147], a[80:83], v[124:127], v[144:147]
    ds_write_b128 v169, v[112:115] offset:16
    s_waitcnt vmcnt(3)
    v_mfma_f32_16x16x32_bf16 v[144:147], a[84:87], v[128:131], v[144:147]
    v_mfma_f32_16x16x32_bf16 v[144:147], a[88:91], v[132:135], v[144:147]
    v_mfma_f32_16x16x32_bf16 v[144:147], a[92:95], v[136:139], v[144:147]
    ds_read_b64_tr_b16 a[164:165], v142 offset:3072
    ds_read_b64_tr_b16 a[166:167], v142 offset:3840
    v_mfma_f32_16x16x32_bf16 v[148:151], a[100:103], v[120:123], v[148:151]
    ds_read_b64_tr_b16 a[188:189], v142 offset:3104
    ds_read_b64_tr_b16 a[190:191], v142 offset:3872
    v_mfma_f32_16x16x32_bf16 v[148:151], a[104:107], v[124:127], v[148:151]
    ds_read_b64_tr_b16 a[212:213], v142 offset:3136
    ds_read_b64_tr_b16 a[214:215], v142 offset:3904
    v_mfma_f32_16x16x32_bf16 v[148:151], a[108:111], v[128:131], v[148:151]
    ds_write_b64 v169, v[112:113] offset:56
    v_mfma_f32_16x16x32_bf16 v[148:151], a[112:115], v[132:135], v[148:151]
    v_fma_f32 v108, v144, v144, s32
    v_fmac_f32 v108, v145, v145
    v_mfma_f32_16x16x32_bf16 v[148:151], a[116:119], v[136:139], v[148:151]
    ds_write_b64 v169, v[112:113] offset:64
    v_mfma_f32_16x16x32_bf16 v[112:115], a[120:123], v[116:119], 0
    v_fmac_f32 v108, v146, v146
    v_fmac_f32 v108, v147, v147
    v_mfma_f32_16x16x32_bf16 v[112:115], a[124:127], v[120:123], v[112:115]
    s_waitcnt lgkmcnt(6)
    v_mfma_f32_16x16x32_bf16 v[112:115], a[128:131], v[124:127], v[112:115]
    s_waitcnt lgkmcnt(4)
    v_fmac_f32 v108, v148, v148
    v_fmac_f32 v108, v149, v149
    v_mfma_f32_16x16x32_bf16 v[112:115], a[132:135], v[128:131], v[112:115]
    s_waitcnt lgkmcnt(2)
    v_fmac_f32 v108, v150, v150
    v_fmac_f32 v108, v151, v151
    v_mfma_f32_16x16x32_bf16 v[112:115], a[136:139], v[132:135], v[112:115]
    s_barrier
    buffer_load_dwordx4 v10, s[8:11], s24 offen nt lds
    s_add_u32 m0, s28, 69632
    v_mfma_f32_16x16x32_bf16 v[112:115], a[140:143], v[136:139], v[112:115]
    v_mfma_f32_16x16x32_bf16 v[140:143], a[0:3], v[116:119], 0
    v_mfma_f32_16x16x32_bf16 v[140:143], a[4:7], v[120:123], v[140:143]
    v_mfma_f32_16x16x32_bf16 v[140:143], a[8:11], v[124:127], v[140:143]
    v_mfma_f32_16x16x32_bf16 v[140:143], a[12:15], v[128:131], v[140:143]
    buffer_load_dwordx4 v11, s[8:11], s24 offen nt lds
    s_add_u32 m0, s28, 73728
    v_mfma_f32_16x16x32_bf16 v[140:143], a[16:19], v[132:135], v[140:143]
    v_mfma_f32_16x16x32_bf16 v[140:143], a[20:23], v[136:139], v[140:143]
    v_fmac_f32 v108, v112, v112
    v_fmac_f32 v108, v113, v113
    v_mfma_f32_16x16x32_bf16 v[156:159], a[24:27], v[116:119], 0
    v_fmac_f32 v108, v114, v114
    v_fmac_f32 v108, v115, v115
    v_mfma_f32_16x16x32_bf16 v[156:159], a[28:31], v[120:123], v[156:159]
    v_mfma_f32_16x16x32_bf16 v[156:159], a[32:35], v[124:127], v[156:159]
    buffer_load_dwordx4 v12, s[8:11], s24 offen nt lds
    v_fma_f32 v109, v140, v140, s32
    v_mfma_f32_16x16x32_bf16 v[156:159], a[36:39], v[128:131], v[156:159]
    s_add_u32 m0, s28, 77824
    ds_read_b128 v[152:155], v165 offset:6144
    v_fmac_f32 v109, v141, v141
    v_mfma_f32_16x16x32_bf16 v[156:159], a[40:43], v[132:135], v[156:159]
    ds_read_b128 v[160:163], v166 offset:6144
    v_fmac_f32 v109, v142, v142
    v_mfma_f32_16x16x32_bf16 v[156:159], a[44:47], v[136:139], v[156:159]
    ds_read_b128 v[172:175], v165 offset:6272
    v_fmac_f32 v109, v143, v143
    v_mfma_f32_16x16x32_bf16 v[180:183], a[48:51], v[116:119], 0
    ds_read_b128 v[116:119], v166 offset:6272
    buffer_load_dwordx4 v13, s[8:11], s24 offen nt lds
    v_mfma_f32_16x16x32_bf16 v[180:183], a[52:55], v[120:123], v[180:183]
    s_add_u32 m0, s71, 0
    ds_read_b128 v[184:187], v165 offset:6400
    v_fmac_f32 v109, v156, v156
    v_mfma_f32_16x16x32_bf16 v[180:183], a[56:59], v[124:127], v[180:183]
    ds_read_b128 v[124:127], v166 offset:6400
    v_fmac_f32 v109, v157, v157
    v_mfma_f32_16x16x32_bf16 v[180:183], a[60:63], v[128:131], v[180:183]
    v_fmac_f32 v109, v158, v158
    v_fmac_f32 v109, v159, v159
    v_mfma_f32_16x16x32_bf16 v[180:183], a[64:67], v[132:135], v[180:183]
    v_mfma_f32_16x16x32_bf16 v[180:183], a[68:71], v[136:139], v[180:183]
    s_waitcnt lgkmcnt(5)
    buffer_load_dwordx4 v14, s[8:11], s24 offen nt lds
    v_mfma_f32_16x16x32_bf16 v[132:135], a[72:75], v[152:155], 0
    s_waitcnt lgkmcnt(4)
    v_mfma_f32_16x16x32_bf16 v[132:135], a[76:79], v[160:163], v[132:135]
    s_waitcnt lgkmcnt(3)
    v_mfma_f32_16x16x32_bf16 v[132:135], a[80:83], v[172:175], v[132:135]
    s_waitcnt lgkmcnt(2)
    v_fmac_f32 v109, v180, v180
    v_fmac_f32 v109, v181, v181
    v_mfma_f32_16x16x32_bf16 v[132:135], a[84:87], v[116:119], v[132:135]
    s_waitcnt lgkmcnt(1)
    v_fmac_f32 v109, v182, v182
    v_fmac_f32 v109, v183, v183
    v_mfma_f32_16x16x32_bf16 v[132:135], a[88:91], v[184:187], v[132:135]
    s_waitcnt lgkmcnt(0)
    v_cvt_pk_bf16_f32 v38, v109, v108
    v_mfma_f32_16x16x32_bf16 v[132:135], a[92:95], v[124:127], v[132:135]
    v_mfma_f32_16x16x32_bf16 v[136:139], a[96:99], v[152:155], 0
    v_mfma_f32_16x16x16_bf16 v[128:131], v[32:33], v[38:39], 0
    v_mfma_f32_16x16x32_bf16 v[136:139], a[100:103], v[160:163], v[136:139]
    v_mfma_f32_16x16x32_bf16 v[136:139], a[104:107], v[172:175], v[136:139]
    v_mfma_f32_16x16x32_bf16 v[136:139], a[108:111], v[116:119], v[136:139]
    v_mfma_f32_16x16x32_bf16 v[136:139], a[112:115], v[184:187], v[136:139]
    v_mfma_f32_16x16x32_bf16 v[136:139], a[116:119], v[124:127], v[136:139]
    v_mfma_f32_16x16x32_bf16 v[188:191], a[120:123], v[152:155], 0
    v_fma_f32 v108, v132, v132, s32
    v_fmac_f32 v108, v133, v133
    v_mfma_f32_16x16x32_bf16 v[188:191], a[124:127], v[160:163], v[188:191]
    v_rsq_f32 v129, v129
    v_mfma_f32_16x16x32_bf16 v[188:191], a[128:131], v[172:175], v[188:191]
    v_rsq_f32 v128, v128
    v_mfma_f32_16x16x32_bf16 v[188:191], a[132:135], v[116:119], v[188:191]
    v_mul_f32 v128, s31, v128
    v_mul_f32 v144, v129, v144
    v_mfma_f32_16x16x32_bf16 v[188:191], a[136:139], v[184:187], v[188:191]
    v_mul_f32 v145, v129, v145
    v_cvt_pk_bf16_f32 v120, v144, v145
    v_mfma_f32_16x16x32_bf16 v[188:191], a[140:143], v[124:127], v[188:191]
    v_mul_f32 v146, v129, v146
    v_mul_f32 v147, v129, v147
    v_mfma_f32_16x16x32_bf16 v[196:199], a[0:3], v[152:155], 0
    v_cvt_pk_bf16_f32 v121, v146, v147
    v_mul_f32 v148, v129, v148
    v_mfma_f32_16x16x32_bf16 v[196:199], a[4:7], v[160:163], v[196:199]
    v_mul_f32 v149, v129, v149
    v_cvt_pk_bf16_f32 v122, v148, v149
    v_mfma_f32_16x16x32_bf16 v[196:199], a[8:11], v[172:175], v[196:199]
    v_mul_f32 v150, v129, v150
    v_mul_f32 v151, v129, v151
    v_mfma_f32_16x16x32_bf16 v[196:199], a[12:15], v[116:119], v[196:199]
    v_cvt_pk_bf16_f32 v123, v150, v151
    v_mul_f32 v112, v129, v112
    v_mfma_f32_16x16x32_bf16 v[196:199], a[16:19], v[184:187], v[196:199]
    ds_write_b128 v167, v[120:123]
    v_mfma_f32_16x16x32_bf16 v[196:199], a[20:23], v[124:127], v[196:199]
    v_mul_f32 v113, v129, v113
    v_cvt_pk_bf16_f32 v202, v112, v113
    v_mfma_f32_16x16x32_bf16 v[204:207], a[24:27], v[152:155], 0
    v_mul_f32 v114, v129, v114
    v_mul_f32 v115, v129, v115
    v_mfma_f32_16x16x32_bf16 v[204:207], a[28:31], v[160:163], v[204:207]
    v_cvt_pk_bf16_f32 v203, v114, v115
    v_mul_f32 v140, v128, v140
    v_mfma_f32_16x16x32_bf16 v[204:207], a[32:35], v[172:175], v[204:207]
    ds_write_b64 v167, v[202:203] offset:48
    v_mfma_f32_16x16x32_bf16 v[204:207], a[36:39], v[116:119], v[204:207]
    v_mul_f32 v141, v128, v141
    v_cvt_pk_bf16_f32 v200, v140, v141
    v_mfma_f32_16x16x32_bf16 v[204:207], a[40:43], v[184:187], v[204:207]
    ds_read_b128 v[212:215], v0 offset:20480
    ds_read_b128 v[176:179], v1 offset:20480
    v_mfma_f32_16x16x32_bf16 v[204:207], a[44:47], v[124:127], v[204:207]
    ds_read_b128 v[216:219], v0 offset:20608
    v_mul_f32 v142, v128, v142
    v_mfma_f32_16x16x32_bf16 v[208:211], a[48:51], v[152:155], 0
    ds_read_b128 v[120:123], v1 offset:20608
    v_mul_f32 v143, v128, v143
    v_mfma_f32_16x16x32_bf16 v[208:211], a[52:55], v[160:163], v[208:211]
    ds_read_b128 v[240:243], v0 offset:20736
    v_cvt_pk_bf16_f32 v201, v142, v143
    v_mfma_f32_16x16x32_bf16 v[208:211], a[56:59], v[172:175], v[208:211]
    ds_read_b128 v[224:227], v1 offset:20736
    v_mul_f32 v156, v128, v156
    v_mfma_f32_16x16x32_bf16 v[208:211], a[60:63], v[116:119], v[208:211]
    v_mul_f32 v157, v128, v157
    v_cvt_pk_bf16_f32 v202, v156, v157
    v_mfma_f32_16x16x32_bf16 v[208:211], a[64:67], v[184:187], v[208:211]
    v_mul_f32 v158, v128, v158
    v_mul_f32 v159, v128, v159
    v_mfma_f32_16x16x32_bf16 v[208:211], a[68:71], v[124:127], v[208:211]
    v_cvt_pk_bf16_f32 v203, v158, v159
    s_waitcnt lgkmcnt(4)
    v_mfma_f32_16x16x32_bf16 v[192:195], a[72:75], v[212:215], 0
    ds_write_b128 v167, v[200:203] offset:32
    v_mfma_f32_16x16x32_bf16 v[192:195], a[76:79], v[176:179], v[192:195]
    s_waitcnt lgkmcnt(3)
    v_mul_f32 v180, v128, v180
    v_mul_f32 v181, v128, v181
    v_mfma_f32_16x16x32_bf16 v[192:195], a[80:83], v[216:219], v[192:195]
    s_waitcnt lgkmcnt(2)
    v_cvt_pk_bf16_f32 v200, v180, v181
    v_mul_f32 v182, v128, v182
    v_mfma_f32_16x16x32_bf16 v[192:195], a[84:87], v[120:123], v[192:195]
    s_waitcnt lgkmcnt(1)
    v_mul_f32 v183, v128, v183
    v_cvt_pk_bf16_f32 v201, v182, v183
    v_mfma_f32_16x16x32_bf16 v[192:195], a[88:91], v[240:243], v[192:195]
    ds_write_b64 v167, v[200:201] offset:72
    v_mfma_f32_16x16x32_bf16 v[192:195], a[92:95], v[224:227], v[192:195]
    v_mul_f32 v116, v140, v144
    v_fmac_f32 v116, v141, v145
    v_mfma_f32_16x16x32_bf16 v[152:155], a[96:99], v[212:215], 0
    v_fmac_f32 v116, v142, v146
    v_fmac_f32 v116, v143, v147
    v_mfma_f32_16x16x32_bf16 v[152:155], a[100:103], v[176:179], v[152:155]
    v_fmac_f32 v116, v156, v148
    v_fmac_f32 v116, v157, v149
    v_mfma_f32_16x16x32_bf16 v[152:155], a[104:107], v[216:219], v[152:155]
    v_fmac_f32 v116, v158, v150
    v_fmac_f32 v116, v159, v151
    v_mfma_f32_16x16x32_bf16 v[152:155], a[108:111], v[120:123], v[152:155]
    v_fmac_f32 v116, v180, v112
    v_fmac_f32 v116, v181, v113
    v_mfma_f32_16x16x32_bf16 v[152:155], a[112:115], v[240:243], v[152:155]
    v_fmac_f32 v116, v182, v114
    v_fmac_f32 v116, v183, v115
    v_mfma_f32_16x16x32_bf16 v[152:155], a[116:119], v[224:227], v[152:155]
    v_mov_b32 v167, v116
    v_fmac_f32 v108, v134, v134
    v_mfma_f32_16x16x32_bf16 v[144:147], a[120:123], v[212:215], 0
    v_permlane32_swap_b32 v116, v167
    v_mfma_f32_16x16x32_bf16 v[144:147], a[124:127], v[176:179], v[144:147]
    v_add_f32 v116, v116, v167
    v_mov_b32 v167, v116
    v_mfma_f32_16x16x32_bf16 v[144:147], a[128:131], v[216:219], v[144:147]
    v_fmac_f32 v108, v135, v135
    v_fmac_f32 v108, v136, v136
    v_mfma_f32_16x16x32_bf16 v[144:147], a[132:135], v[120:123], v[144:147]
    v_permlane16_swap_b32 v116, v167
    v_mfma_f32_16x16x32_bf16 v[144:147], a[136:139], v[240:243], v[144:147]
    v_add_f32 v116, v116, v167
    v_add_f32 v116, s39, v116
    v_mfma_f32_16x16x32_bf16 v[144:147], a[140:143], v[224:227], v[144:147]
    v_mov_b32 v117, v110
    v_mov_b32 v118, v110
    v_mfma_f32_16x16x32_bf16 v[124:127], a[0:3], v[212:215], 0
    v_mov_b32 v119, v110
    v_cndmask_b32 v116, v110, v116, s[86:87]
    v_mfma_f32_16x16x32_bf16 v[124:127], a[4:7], v[176:179], v[124:127]
    ds_write_b128 v164, v[116:119] offset:192
    v_mfma_f32_16x16x32_bf16 v[124:127], a[8:11], v[216:219], v[124:127]
    v_fmac_f32 v108, v137, v137
    v_fmac_f32 v108, v138, v138
    v_mfma_f32_16x16x32_bf16 v[124:127], a[12:15], v[120:123], v[124:127]
    v_fmac_f32 v108, v139, v139
    v_fmac_f32 v108, v188, v188
    v_mfma_f32_16x16x32_bf16 v[124:127], a[16:19], v[240:243], v[124:127]
    v_fmac_f32 v108, v189, v189
    v_fmac_f32 v108, v190, v190
    v_mfma_f32_16x16x32_bf16 v[124:127], a[20:23], v[224:227], v[124:127]
    v_fmac_f32 v108, v191, v191
    v_fma_f32 v109, v196, v196, s32
    v_mfma_f32_16x16x32_bf16 v[180:183], a[24:27], v[212:215], 0
    v_fmac_f32 v109, v197, v197
    v_fmac_f32 v109, v198, v198
    v_mfma_f32_16x16x32_bf16 v[180:183], a[28:31], v[176:179], v[180:183]
    v_fmac_f32 v109, v199, v199
    v_fmac_f32 v109, v204, v204
    v_mfma_f32_16x16x32_bf16 v[180:183], a[32:35], v[216:219], v[180:183]
    v_fmac_f32 v109, v205, v205
    v_fmac_f32 v109, v206, v206
    v_mfma_f32_16x16x32_bf16 v[180:183], a[36:39], v[120:123], v[180:183]
    v_fmac_f32 v109, v207, v207
    v_fmac_f32 v109, v208, v208
    v_mfma_f32_16x16x32_bf16 v[180:183], a[40:43], v[240:243], v[180:183]
    v_fmac_f32 v109, v209, v209
    v_fmac_f32 v109, v210, v210
    v_mfma_f32_16x16x32_bf16 v[180:183], a[44:47], v[224:227], v[180:183]
    v_fmac_f32 v109, v211, v211
    v_cvt_pk_bf16_f32 v38, v109, v108
    v_mfma_f32_16x16x32_bf16 v[220:223], a[48:51], v[212:215], 0
    v_fma_f32 v164, v192, v192, s32
    v_fmac_f32 v164, v193, v193
    v_mfma_f32_16x16x16_bf16 v[112:115], v[32:33], v[38:39], 0
    v_fmac_f32 v164, v194, v194
    v_fmac_f32 v164, v195, v195
    v_mfma_f32_16x16x32_bf16 v[220:223], a[52:55], v[176:179], v[220:223]
    v_fmac_f32 v164, v152, v152
    v_fmac_f32 v164, v153, v153
    v_mfma_f32_16x16x32_bf16 v[220:223], a[56:59], v[216:219], v[220:223]
    v_fmac_f32 v164, v154, v154
    v_fmac_f32 v164, v155, v155
    v_mfma_f32_16x16x32_bf16 v[220:223], a[60:63], v[120:123], v[220:223]
    ds_read_b128 v[116:119], v165 offset:0
    v_fmac_f32 v164, v144, v144
    v_mfma_f32_16x16x32_bf16 v[220:223], a[64:67], v[240:243], v[220:223]
    ds_read_b128 v[140:143], v166 offset:0
    v_fmac_f32 v164, v145, v145
    v_mfma_f32_16x16x32_bf16 v[220:223], a[68:71], v[224:227], v[220:223]
    ds_read_b128 v[148:151], v165 offset:128
    v_fmac_f32 v164, v146, v146
    v_mfma_f32_16x16x32_bf16 v[128:131], v[212:215], a[144:147], 0
    ds_read_b128 v[156:159], v166 offset:128
    v_fmac_f32 v164, v147, v147
    v_mfma_f32_16x16x32_bf16 v[128:131], v[176:179], a[148:151], v[128:131]
    ds_read_b128 v[160:163], v165 offset:256
    v_fma_f32 v167, v124, v124, s32
    v_mfma_f32_16x16x32_bf16 v[128:131], v[216:219], a[152:155], v[128:131]
    ds_read_b128 v[172:175], v166 offset:256
    v_fmac_f32 v167, v125, v125
    v_mfma_f32_16x16x32_bf16 v[128:131], v[120:123], a[156:159], v[128:131]
    v_rsq_f32 v113, v113
    v_mfma_f32_16x16x32_bf16 v[128:131], v[240:243], a[160:163], v[128:131]
    v_rsq_f32 v112, v112
    v_mfma_f32_16x16x32_bf16 v[128:131], v[224:227], a[164:167], v[128:131]
    s_waitcnt lgkmcnt(5)
    v_mul_f32 v112, s31, v112
    v_mul_f32 v132, v113, v132
    v_mfma_f32_16x16x32_bf16 v[184:187], v[116:119], a[144:147], 0
    s_waitcnt lgkmcnt(4)
    v_mul_f32 v133, v113, v133
    v_cvt_pk_bf16_f32 v200, v132, v133
    v_mfma_f32_16x16x32_bf16 v[184:187], v[140:143], a[148:151], v[184:187]
    s_waitcnt lgkmcnt(3)
    v_mul_f32 v134, v113, v134
    v_mul_f32 v135, v113, v135
    v_mfma_f32_16x16x32_bf16 v[184:187], v[148:151], a[152:155], v[184:187]
    s_waitcnt lgkmcnt(2)
    v_cvt_pk_bf16_f32 v201, v134, v135
    v_mul_f32 v136, v113, v136
    v_mfma_f32_16x16x32_bf16 v[184:187], v[156:159], a[156:159], v[184:187]
    s_waitcnt lgkmcnt(1)
    v_mul_f32 v137, v113, v137
    v_cvt_pk_bf16_f32 v202, v136, v137
    v_mfma_f32_16x16x32_bf16 v[184:187], v[160:163], a[160:163], v[184:187]
    s_waitcnt lgkmcnt(0)
    v_mul_f32 v138, v113, v138
    v_mul_f32 v139, v113, v139
    v_mfma_f32_16x16x32_bf16 v[184:187], v[172:175], a[164:167], v[184:187]
    v_cvt_pk_bf16_f32 v203, v138, v139
    v_mul_f32 v188, v113, v188
    v_mfma_f32_16x16x32_bf16 v[228:231], v[116:119], a[168:171], 0
    ds_write_b128 v169, v[200:203]
    v_mfma_f32_16x16x32_bf16 v[228:231], v[140:143], a[172:175], v[228:231]
    v_mul_f32 v189, v113, v189
    v_cvt_pk_bf16_f32 v202, v188, v189
    v_mfma_f32_16x16x32_bf16 v[228:231], v[148:151], a[176:179], v[228:231]
    v_mul_f32 v190, v113, v190
    v_mul_f32 v191, v113, v191
    v_mfma_f32_16x16x32_bf16 v[228:231], v[156:159], a[180:183], v[228:231]
    ds_read_b128 v[232:235], v165 offset:6144
    v_cvt_pk_bf16_f32 v203, v190, v191
    v_mfma_f32_16x16x32_bf16 v[228:231], v[160:163], a[184:187], v[228:231]
    ds_read_b128 v[236:239], v166 offset:6144
    v_mul_f32 v196, v112, v196
    v_mfma_f32_16x16x32_bf16 v[228:231], v[172:175], a[188:191], v[228:231]
    ds_read_b128 v[244:247], v165 offset:6272
    v_mul_f32 v197, v112, v197
    v_mfma_f32_16x16x32_bf16 v[248:251], v[116:119], a[192:195], 0
    ds_read_b128 v[116:119], v166 offset:6272
    v_cvt_pk_bf16_f32 v200, v196, v197
    v_mfma_f32_16x16x32_bf16 v[248:251], v[140:143], a[196:199], v[248:251]
    ds_read_b128 v[140:143], v165 offset:6400
    v_mul_f32 v198, v112, v198
    v_mfma_f32_16x16x32_bf16 v[248:251], v[148:151], a[200:203], v[248:251]
    ds_read_b128 v[148:151], v166 offset:6400
    v_mul_f32 v199, v112, v199
    v_mfma_f32_16x16x32_bf16 v[248:251], v[156:159], a[204:207], v[248:251]
    ds_write_b64 v169, v[202:203] offset:48
    v_mfma_f32_16x16x32_bf16 v[248:251], v[160:163], a[208:211], v[248:251]
    s_waitcnt lgkmcnt(6)
    v_cvt_pk_bf16_f32 v201, v198, v199
    v_mul_f32 v204, v112, v204
    v_mfma_f32_16x16x32_bf16 v[248:251], v[172:175], a[212:215], v[248:251]
    s_waitcnt lgkmcnt(5)
    v_mul_f32 v205, v112, v205
    v_cvt_pk_bf16_f32 v202, v204, v205
    v_mfma_f32_16x16x32_bf16 v[156:159], v[232:235], a[144:147], 0
    s_waitcnt lgkmcnt(4)
    v_mul_f32 v206, v112, v206
    v_mul_f32 v207, v112, v207
    v_mfma_f32_16x16x32_bf16 v[156:159], v[236:239], a[148:151], v[156:159]
    s_waitcnt lgkmcnt(3)
    v_cvt_pk_bf16_f32 v203, v206, v207
    v_mul_f32 v208, v112, v208
    v_mfma_f32_16x16x32_bf16 v[156:159], v[244:247], a[152:155], v[156:159]
    s_waitcnt lgkmcnt(2)
    ds_write_b128 v169, v[200:203] offset:32
    v_mfma_f32_16x16x32_bf16 v[156:159], v[116:119], a[156:159], v[156:159]
    s_waitcnt lgkmcnt(2)
    v_mul_f32 v209, v112, v209
    v_cvt_pk_bf16_f32 v200, v208, v209
    v_mfma_f32_16x16x32_bf16 v[156:159], v[140:143], a[160:163], v[156:159]
    v_mul_f32 v210, v112, v210
    v_mul_f32 v211, v112, v211
    v_mfma_f32_16x16x32_bf16 v[156:159], v[148:151], a[164:167], v[156:159]
    v_cvt_pk_bf16_f32 v201, v210, v211
    v_mul_f32 v112, v196, v132
    v_mfma_f32_16x16x32_bf16 v[160:163], v[232:235], a[168:171], 0
    ds_write_b64 v169, v[200:201] offset:72
    v_mfma_f32_16x16x32_bf16 v[160:163], v[236:239], a[172:175], v[160:163]
    v_fmac_f32 v112, v197, v133
    v_fmac_f32 v112, v198, v134
    v_mfma_f32_16x16x32_bf16 v[160:163], v[244:247], a[176:179], v[160:163]
    v_fmac_f32 v112, v199, v135
    v_fmac_f32 v112, v204, v136
    v_mfma_f32_16x16x32_bf16 v[160:163], v[116:119], a[180:183], v[160:163]
    v_fmac_f32 v112, v205, v137
    v_fmac_f32 v112, v206, v138
    v_mfma_f32_16x16x32_bf16 v[160:163], v[140:143], a[184:187], v[160:163]
    v_fmac_f32 v112, v207, v139
    v_fmac_f32 v112, v208, v188
    v_mfma_f32_16x16x32_bf16 v[160:163], v[148:151], a[188:191], v[160:163]
    v_fmac_f32 v112, v209, v189
    v_fmac_f32 v112, v210, v190
    v_mfma_f32_16x16x32_bf16 v[132:135], v[232:235], a[192:195], 0
    v_fmac_f32 v112, v211, v191
    v_mov_b32 v169, v112
    v_mfma_f32_16x16x32_bf16 v[132:135], v[236:239], a[196:199], v[132:135]
    v_fmac_f32 v167, v126, v126
    v_fmac_f32 v167, v127, v127
    v_mfma_f32_16x16x32_bf16 v[132:135], v[244:247], a[200:203], v[132:135]
    v_permlane32_swap_b32 v112, v169
    v_mfma_f32_16x16x32_bf16 v[132:135], v[116:119], a[204:207], v[132:135]
    v_add_f32 v112, v112, v169
    v_mov_b32 v169, v112
    v_mfma_f32_16x16x32_bf16 v[132:135], v[140:143], a[208:211], v[132:135]
    s_waitcnt vmcnt(5)
    v_permlane16_swap_b32 v112, v169
    v_mfma_f32_16x16x32_bf16 v[132:135], v[148:151], a[212:215], v[132:135]
    s_barrier
    v_add_f32 v112, v112, v169
    v_add_f32 v112, s39, v112
    v_mov_b32 v113, v110
    v_mov_b32 v114, v110
    v_mov_b32 v115, v110
    v_cndmask_b32 v112, v110, v112, s[86:87]
    ds_write_b128 v170, v[112:115] offset:192
    v_fmac_f32 v167, v180, v180
    v_fmac_f32 v167, v181, v181
    v_fmac_f32 v167, v182, v182
    v_fmac_f32 v167, v183, v183
    v_fmac_f32 v167, v220, v220
    v_fmac_f32 v167, v221, v221
    v_fmac_f32 v167, v222, v222
    v_fmac_f32 v167, v223, v223
    v_cvt_pk_bf16_f32 v38, v167, v164
    v_cvt_pk_bf16_f32 v184, v184, v184
    ds_write_b32 v168, v184 offset:0
    v_cvt_pk_bf16_f32 v185, v185, v185
    ds_write_b32 v168, v185 offset:272
    v_cvt_pk_bf16_f32 v186, v186, v186
    ds_write_b32 v168, v186 offset:544
    v_cvt_pk_bf16_f32 v187, v187, v187
    ds_write_b32 v168, v187 offset:816
    v_cvt_pk_bf16_f32 v228, v228, v228
    ds_write_b32 v168, v228 offset:64
    v_cvt_pk_bf16_f32 v229, v229, v229
    ds_write_b32 v168, v229 offset:336
    v_cvt_pk_bf16_f32 v230, v230, v230
    ds_write_b32 v168, v230 offset:608
    v_cvt_pk_bf16_f32 v231, v231, v231
    ds_write_b32 v168, v231 offset:880
    v_cvt_pk_bf16_f32 v248, v248, v248
    ds_write_b32 v168, v248 offset:128
    v_cvt_pk_bf16_f32 v249, v249, v249
    ds_write_b32 v168, v249 offset:400
    v_cvt_pk_bf16_f32 v250, v250, v250
    ds_write_b32 v168, v250 offset:672
    v_cvt_pk_bf16_f32 v251, v251, v251
    ds_write_b32 v168, v251 offset:944
    v_cvt_pk_bf16_f32 v156, v156, v156
    ds_write_b32 v171, v156 offset:0
    v_cvt_pk_bf16_f32 v157, v157, v157
    ds_write_b32 v171, v157 offset:272
    v_cvt_pk_bf16_f32 v158, v158, v158
    ds_write_b32 v171, v158 offset:544
    v_cvt_pk_bf16_f32 v159, v159, v159
    ds_write_b32 v171, v159 offset:816
    v_cvt_pk_bf16_f32 v160, v160, v160
    ds_write_b32 v171, v160 offset:64
    v_cvt_pk_bf16_f32 v161, v161, v161
    ds_write_b32 v171, v161 offset:336
    v_cvt_pk_bf16_f32 v162, v162, v162
    ds_write_b32 v171, v162 offset:608
    v_cvt_pk_bf16_f32 v163, v163, v163
    ds_write_b32 v171, v163 offset:880
    v_cvt_pk_bf16_f32 v132, v132, v132
    ds_write_b32 v171, v132 offset:128
    v_cvt_pk_bf16_f32 v133, v133, v133
    ds_write_b32 v171, v133 offset:400
    v_cvt_pk_bf16_f32 v134, v134, v134
    ds_write_b32 v171, v134 offset:672
    v_cvt_pk_bf16_f32 v135, v135, v135
    ds_write_b32 v171, v135 offset:944
    s_branch L_go
.section .rodata,"a"
.p2align 6
.amdhsa_kernel standalone__window_attn_swin_v2__vision_kernel
  .amdhsa_next_free_vgpr 512
  .amdhsa_next_free_sgpr 102
  .amdhsa_accum_offset 256
  .amdhsa_group_segment_fixed_size 0
  .amdhsa_kernarg_size 96
  .amdhsa_user_sgpr_count 2
  .amdhsa_user_sgpr_kernarg_segment_ptr 1
  .amdhsa_system_sgpr_workgroup_id_x 1
  .amdhsa_float_denorm_mode_32 3
.end_amdhsa_kernel
```

```asm
; @launch grid=(256,1,1) block=(256,1,1) lds=163840
.amdgcn_target "amdgcn-amd-amdhsa--gfx950"
.text
.globl standalone__window_attn_swin_v2__vision_kernel
.p2align 8
.type standalone__window_attn_swin_v2__vision_kernel,@function
standalone__window_attn_swin_v2__vision_kernel:
    s_getpc_b64 s[96:97]
    s_bfe_u32 s3, s2, 0x30003
    s_mul_i32 s3, s3, 36
    v_min_u32 v170, 67, v0
    v_cmp_gt_u32 vcc, 32, v0
    v_add_u32 v171, s3, v170
    s_cmp_ge_u32 s2, 256
    v_cndmask_b32 v170, v171, v170, vcc
    v_mov_b32 v171, 0
    v_lshlrev_b32 v170, 7, v170
    v_lshl_add_u64 v[170:171], s[96:97], 0, v[170:171]
    s_cbranch_scc1 L_done
    global_load_dword a255, v[170:171], off offset:124
    s_load_dwordx2 s[8:9], s[0:1], 0
    s_load_dwordx2 s[44:45], s[0:1], 8
    s_load_dwordx2 s[48:49], s[0:1], 16
    s_load_dwordx2 s[56:57], s[0:1], 32
    s_load_dwordx2 s[60:61], s[0:1], 40
    s_load_dwordx2 s[52:53], s[0:1], 48
    s_load_dwordx2 s[12:13], s[0:1], 72
    s_load_dwordx2 s[64:65], s[0:1], 24
    s_cmp_ge_u32 s2, 247
    s_cbranch_scc1 L_edge
    v_lshrrev_b32 v170, 6, v0
    v_mov_b32 v171, v0
    v_readfirstlane_b32 s16, v170
    v_mov_b32 v170, 0x40000000
    s_mov_b32 s69, 193536
    s_mov_b32 s10, 100270464
    s_mov_b32 s11, 0x00020000
    s_mov_b32 s36, 100270464
    s_mov_b32 s22, 1180032
    s_mul_i32 s3, s2, 911
    s_lshr_b32 s3, s3, 16
    s_mul_i32 s4, s3, 72
    s_sub_u32 s38, s2, s4
    s_mul_i32 s3, s3, 1373568
    s_mul_i32 s4, s38, 2688
    s_add_u32 s3, s3, s4
    s_add_u32 s25, s3, 589824
    s_add_u32 s7, s3, 1769472
    s_mov_b32 s20, 31
    s_mov_b32 s21, 4204032
    s_cmp_lt_u32 s2, 244
    s_cselect_b32 s17, 21, 20
    v_mul_u32_u24 v108, 2731, v171
    v_bfe_u32 v109, v108, 17, 3
    v_lshrrev_b32 v108, 16, v108
    v_xor_b32 v110, v109, v171
    v_mul_u32_u24 v109, 37, v108
    v_lshrrev_b32 v109, 8, v109
    v_lshlrev_b32 v110, 4, v110
    v_mad_u32_u24 v10, v109, s69, v110
    v_mul_u32_u24 v109, s20, v108
    v_add_u32 v109, s38, v109
    v_mul_u32_u24 v109, 911, v109
    v_lshrrev_b32 v109, 16, v109
    v_mul_u32_u24 v109, s22, v109
    v_mad_u32_u24 v109, v108, s21, v109
    v_cmp_gt_u32 vcc, s17, v108
    v_add_u32 v109, s7, v109
    s_nop 0
    v_cndmask_b32 v109, v170, v109, vcc
    v_mul_u32_u24 v108, 384, v108
    v_sub_u32 v108, v110, v108
    v_add_u32 v109, v109, v108
    v_add_u32 v108, 256, v171
    v_mul_u32_u24 v110, 2731, v108
    v_bfe_u32 v111, v110, 17, 3
    v_lshrrev_b32 v110, 16, v110
    v_xor_b32 v108, v111, v108
    v_mul_u32_u24 v111, 37, v110
    v_lshrrev_b32 v111, 8, v111
    v_lshlrev_b32 v108, 4, v108
    v_mad_u32_u24 v11, v111, s69, v108
    v_mul_u32_u24 v111, s20, v110
    v_add_u32 v111, s38, v111
    v_mul_u32_u24 v111, 911, v111
    v_lshrrev_b32 v111, 16, v111
    v_mul_u32_u24 v111, s22, v111
    v_mad_u32_u24 v111, v110, s21, v111
    v_cmp_gt_u32 vcc, s17, v110
    v_add_u32 v111, s7, v111
    s_nop 0
    v_cndmask_b32 v111, v170, v111, vcc
    v_mul_u32_u24 v110, 384, v110
    v_sub_u32 v110, v108, v110
    v_add_u32 v111, v111, v110
    s_lshl_b32 s28, s16, 10
    s_add_u32 s28, s28, 20480
    v_and_b32 v108, 63, v0
    s_bfe_u32 s3, s2, 0x50003
    s_lshl_b32 s4, s16, 3
    s_lshr_b32 s98, 0x00001236, s4
    s_and_b32 s98, s98, 0xff
    s_mul_i32 s3, s3, s98
    s_lshr_b32 s4, 0x00051135, s4
    s_and_b32 s4, s4, 0xff
    v_min_u32 v120, s4, v108
    v_add_lshl_u32 v120, v120, s3, 7
    v_mov_b32 v121, 0
    s_add_u32 m0, s28, 128512
    s_waitcnt lgkmcnt(0)
    buffer_load_dwordx4 v109, s[8:11], 0 offen nt lds
    s_add_u32 m0, s28, 132608
    s_cmp_eq_u32 s16, 0
    s_cselect_b64 s[98:99], s[44:45], s[48:49]
    buffer_load_dwordx4 v111, s[8:11], 0 offen nt lds
    s_add_u32 m0, s28, 0
    s_cmp_eq_u32 s16, 2
    s_cselect_b64 s[98:99], s[52:53], s[98:99]
    buffer_load_dwordx4 v10, s[8:11], s25 offen nt lds
    s_add_u32 m0, s28, 4096
    s_cmp_eq_u32 s16, 3
    s_cselect_b64 s[98:99], s[56:57], s[98:99]
    buffer_load_dwordx4 v11, s[8:11], s25 offen nt lds
    v_lshl_add_u64 v[120:121], s[98:99], 0, v[120:121]
    v_writelane_b32 v120, s60, 62
    v_writelane_b32 v121, s61, 62
    v_writelane_b32 v120, s64, 63
    v_writelane_b32 v121, s65, 63
    global_load_dword a254, v[120:121], off
    v_lshrrev_b32 v109, 4, v108
    v_and_b32 v110, 15, v108
    s_mov_b32 s46, 221184
    s_mov_b32 s47, 0x00020000
    s_mov_b32 s50, 73728
    s_mov_b32 s51, 0x00020000
    s_mov_b32 s58, 64
    s_mov_b32 s59, 0x00020000
    s_mov_b32 s62, 128
    s_mov_b32 s63, 0x00020000
    s_mov_b32 s54, 676
    s_mov_b32 s55, 0x00020000
    s_mov_b32 s14, 0
    s_mov_b32 s15, 0x00020000
    v_mul_u32_u24 v111, 171, v108
    v_lshrrev_b32 v111, 10, v111
    v_lshrrev_b32 v120, 1, v111
    v_xor_b32 v120, v120, v111
    v_and_b32 v120, 4, v120
    v_mul_u32_u24 v120, 3, v120
    v_xor_b32 v120, v120, v111
    v_mul_u32_u24 v120, 1152, v120
    v_mul_u32_u24 v121, 96, v111
    v_sub_u32 v120, v120, v121
    v_lshl_add_u32 v121, v108, 4, v120
    v_add_u32 v120, 64, v108
    v_mul_u32_u24 v120, 171, v120
    v_lshrrev_b32 v120, 10, v120
    v_lshrrev_b32 v122, 1, v120
    v_xor_b32 v122, v122, v120
    v_and_b32 v122, 4, v122
    v_mul_u32_u24 v122, 3, v122
    v_xor_b32 v122, v122, v120
    v_mul_u32_u24 v122, 1152, v122
    v_mul_u32_u24 v123, 96, v120
    v_sub_u32 v122, v122, v123
    v_lshl_add_u32 v123, v108, 4, v122
    v_add_u32 v122, 128, v108
    v_mul_u32_u24 v122, 171, v122
    v_lshrrev_b32 v122, 10, v122
    v_lshrrev_b32 v132, 1, v122
    v_xor_b32 v132, v132, v122
    v_and_b32 v132, 4, v132
    v_mul_u32_u24 v132, 3, v132
    v_xor_b32 v132, v132, v122
    v_mul_u32_u24 v132, 1152, v132
    v_mul_u32_u24 v133, 96, v122
    v_sub_u32 v132, v132, v133
    v_lshl_add_u32 v133, v108, 4, v132
    s_mul_i32 s66, s16, 6144
    s_add_u32 s67, s66, 65536
    s_cmp_eq_u32 s16, 3
    s_cselect_b32 s66, 136704, s66
    s_cselect_b32 s67, 142848, s67
    s_mul_i32 s68, s16, 96
    s_add_u32 m0, s66, 0
    s_add_u32 s4, s68, 384
    buffer_load_dwordx4 v121, s[44:47], s4 offen lds
    v_mov_b32 v169, 0
    v_cmp_lt_u32 s[90:91], 7, v110
    v_mov_b32 v135, 0
    v_mov_b32 v113, 0
    v_mov_b32 v115, 0
    v_lshlrev_b32 v112, 1, v108
    v_mul_u32_u24 v114, 12, v110
    s_mul_i32 s70, s16, 192
    v_add_u32 v114, s70, v114
    v_lshlrev_b32 v132, 5, v109
    v_lshrrev_b32 v116, 2, v110
    v_and_b32 v117, 1, v116
    v_mul_u32_u24 v117, 0x020202, v117
    v_lshl_or_b32 v117, v117, 8, v117
    s_mov_b32 s73, 0x3f80
    s_mov_b32 s19, s38
    buffer_load_dwordx4 v123, s[44:47], s4 offen offset:1024 lds
    v_add_u32 v117, 0x05040100, v117
    v_and_b32 v118, 3, v110
    v_lshrrev_b32 v119, 1, v110
    v_xor_b32 v119, v119, v109
    v_mul_u32_u24 v134, 384, v110
    v_lshl_add_u32 v0, v119, 4, v134
    v_xor_b32 v1, 64, v0
    v_and_b32 v119, 2, v109
    v_add_u32 v119, v119, v109
    v_lshl_add_u32 v119, v119, 2, v116
    v_mul_u32_u24 v119, 96, v119
    v_lshl_add_u32 v119, v118, 3, v119
    v_add_u32 v136, s66, v119
    v_add_u32 v137, s67, v119
    s_mov_b32 s23, s25
    s_mov_b32 s26, 0
    buffer_load_dwordx4 v133, s[44:47], s4 offen offset:2048 lds
    s_add_u32 m0, s66, 3072
    s_add_u32 s4, s68, 37248
    v_mov_b32 v28, 0x3f803f80
    v_mov_b32 v29, 0x3f803f80
    v_mov_b32 v30, 0x3f803f80
    v_mov_b32 v31, 0x3f803f80
    v_mul_u32_u24 v119, 768, v109
    v_add_u32 v119, v114, v119
    v_add_u32 v119, 157184, v119
    v_and_b32 v134, 1, v110
    v_lshlrev_b32 v134, 4, v134
    v_lshlrev_b32 v138, v134, s73
    v_lshlrev_b32 v139, 4, v109
    s_mov_b32 s27, 0
    s_mov_b32 s18, 0
    s_add_u32 s19, s19, s20
    buffer_load_dwordx4 v121, s[44:47], s4 offen lds
    s_add_u32 s23, s23, s21
    s_cmp_ge_u32 s19, 72
    s_cselect_b32 s34, 72, 0
    s_cselect_b32 s35, s22, 0
    s_sub_u32 s19, s19, s34
    s_add_u32 s23, s23, s35
    s_mov_b32 s24, s23
    s_add_u32 s19, s19, s20
    s_add_u32 s23, s23, s21
    s_cmp_ge_u32 s19, 72
    s_cselect_b32 s34, 72, 0
    s_cselect_b32 s35, s22, 0
    s_sub_u32 s19, s19, s34
    s_add_u32 s23, s23, s35
    s_mul_i32 s76, s16, 64
    s_mul_i32 s77, s16, 32
    buffer_load_dwordx4 v123, s[44:47], s4 offen offset:1024 lds
    v_lshl_add_u32 v168, v109, 4, s76
    s_add_u32 s77, s77, 256
    v_lshl_add_u32 v124, v109, 3, s77
    v_add_u32 v125, 0, v110
    v_mul_u32_u24 v126, 37, v125
    v_mul_u32_u24 v127, 384, v125
    v_lshrrev_b32 v126, 8, v126
    v_mad_u32_u24 v127, v126, s69, v127
    v_add_u32 v15, v127, v168
    v_add_u32 v18, v127, v124
    v_add_u32 v127, 16, v110
    v_mul_u32_u24 v128, 37, v127
    v_mul_u32_u24 v129, 384, v127
    v_lshrrev_b32 v128, 8, v128
    s_mul_i32 s78, s16, 768
    s_add_u32 s78, s78, 157184
    buffer_load_dwordx4 v133, s[44:47], s4 offen offset:2048 lds
    s_add_u32 m0, s67, 0
    s_add_u32 s4, s68, 74112
    v_mov_b32 v130, s16
    v_lshlrev_b32 v130, 1, v130
    v_mad_u32_u24 v129, v128, s69, v129
    v_add_u32 v16, v129, v168
    v_add_u32 v19, v129, v124
    v_add_u32 v129, 32, v110
    v_mul_u32_u24 v131, 37, v129
    v_mul_u32_u24 v140, 384, v129
    v_lshrrev_b32 v131, 8, v131
    v_mad_u32_u24 v140, v131, s69, v140
    v_add_u32 v17, v140, v168
    v_add_u32 v20, v140, v124
    s_mov_b32 s79, -24
    s_lshr_b32 s80, s16, 1
    buffer_load_dwordx4 v121, s[44:47], s4 offen lds
    v_mul_u32_u24 v168, 24, v126
    v_lshl_add_u32 v168, v125, 2, v168
    v_add_u32 v22, s78, v168
    v_sub_u32 v23, s78, v168
    v_sub_u32 v124, v22, v139
    v_mul_u32_u24 v128, 24, v128
    v_lshl_add_u32 v128, v127, 2, v128
    v_add_u32 v24, s78, v128
    v_sub_u32 v25, s78, v128
    v_sub_u32 v128, v24, v139
    v_mul_u32_u24 v168, 24, v131
    v_lshl_add_u32 v168, v129, 2, v168
    v_add_u32 v26, s78, v168
    v_sub_u32 v27, s78, v168
    s_and_b32 s81, s16, 1
    s_lshl_b32 s81, s81, 3
    buffer_load_dwordx4 v123, s[44:47], s4 offen offset:1024 lds
    v_sub_u32 v129, v26, v139
    v_mul_u32_u24 v131, 148, v109
    v_add_u32 v168, 0, v131
    v_lshrrev_b32 v168, 8, v168
    v_mad_i32_i24 v40, v168, s79, v124
    v_mad_i32_i24 v52, v168, s79, v128
    v_mad_i32_i24 v64, v168, s79, v129
    v_add_u32 v168, 37, v131
    v_lshrrev_b32 v168, 8, v168
    v_mad_i32_i24 v41, v168, s79, v124
    v_mad_i32_i24 v53, v168, s79, v128
    v_mad_i32_i24 v65, v168, s79, v129
    v_add_u32 v168, 74, v131
    v_lshrrev_b32 v168, 8, v168
    s_lshl_b32 s82, s80, 10
    s_add_u32 s82, s82, s81
    buffer_load_dwordx4 v133, s[44:47], s4 offen offset:2048 lds
    s_add_u32 m0, s67, 3072
    s_add_u32 s4, s68, 110976
    s_waitcnt vmcnt(8)
    s_barrier
    v_mad_i32_i24 v42, v168, s79, v124
    v_mad_i32_i24 v54, v168, s79, v128
    v_mad_i32_i24 v66, v168, s79, v129
    v_add_u32 v168, 111, v131
    v_lshrrev_b32 v168, 8, v168
    v_mad_i32_i24 v43, v168, s79, v124
    v_mad_i32_i24 v55, v168, s79, v128
    v_mad_i32_i24 v67, v168, s79, v129
    v_add_u32 v168, 592, v131
    v_lshrrev_b32 v168, 8, v168
    s_lshl_b32 s80, s80, 11
    s_add_u32 s80, s80, s81
    buffer_load_dwordx4 v121, s[44:47], s4 offen lds
    v_mad_i32_i24 v44, v168, s79, v124
    v_mad_i32_i24 v56, v168, s79, v128
    v_mad_i32_i24 v68, v168, s79, v129
    v_add_u32 v168, 629, v131
    v_lshrrev_b32 v168, 8, v168
    v_mad_i32_i24 v45, v168, s79, v124
    v_mad_i32_i24 v57, v168, s79, v128
    v_mad_i32_i24 v69, v168, s79, v129
    v_add_u32 v168, 666, v131
    v_lshrrev_b32 v168, 8, v168
    v_mad_i32_i24 v46, v168, s79, v124
    v_mad_i32_i24 v58, v168, s79, v128
    v_mad_i32_i24 v70, v168, s79, v129
    v_add_u32 v168, 703, v131
    s_add_u32 s80, s80, 144896
    s_mul_i32 s83, s16, 2048
    buffer_load_dwordx4 v123, s[44:47], s4 offen offset:1024 lds
    s_waitcnt vmcnt(8)
    ds_read_b64_tr_b16 a[72:73], v136 offset:0
    ds_read_b64_tr_b16 a[74:75], v136 offset:768
    ds_read_b64_tr_b16 a[96:97], v136 offset:32
    ds_read_b64_tr_b16 a[98:99], v136 offset:800
    ds_read_b64_tr_b16 a[120:121], v136 offset:64
    ds_read_b64_tr_b16 a[122:123], v136 offset:832
    v_lshrrev_b32 v168, 8, v168
    v_mad_i32_i24 v47, v168, s79, v124
    v_mad_i32_i24 v59, v168, s79, v128
    v_mad_i32_i24 v71, v168, s79, v129
    v_add_u32 v168, 1184, v131
    v_lshrrev_b32 v168, 8, v168
    v_mad_i32_i24 v48, v168, s79, v124
    s_add_u32 s83, s83, 136704
    s_mul_i32 s84, s16, 8064
    buffer_load_dwordx4 v133, s[44:47], s4 offen offset:2048 lds
    s_add_u32 m0, s66, 0
    s_add_u32 s4, s68, 147840
    v_mad_i32_i24 v60, v168, s79, v128
    v_mad_i32_i24 v72, v168, s79, v129
    v_add_u32 v168, 1221, v131
    v_lshrrev_b32 v168, 8, v168
    v_mad_i32_i24 v49, v168, s79, v124
    v_mad_i32_i24 v61, v168, s79, v128
    v_mad_i32_i24 v73, v168, s79, v129
    v_add_u32 v168, 1258, v131
    v_lshrrev_b32 v168, 8, v168
    v_mad_i32_i24 v50, v168, s79, v124
    v_mad_i32_i24 v62, v168, s79, v128
    v_mad_i32_i24 v74, v168, s79, v129
    s_add_u32 s84, s84, 104448
    s_mul_i32 s85, s16, 6528
    s_waitcnt lgkmcnt(0)
    buffer_load_ushort v168, v112, s[56:59], 0 offen
    v_add_u32 v131, 1295, v131
    s_add_u32 s85, s85, 38912
    s_mul_i32 s86, s16, 128
    buffer_load_dwordx3 v[140:142], v114, s[52:55], 0 offen
    v_lshrrev_b32 v131, 8, v131
    s_add_u32 s86, s86, 65024
    s_mov_b32 s40, s8
    buffer_load_dwordx4 v[144:147], v132, s[60:63], 0 offen
    v_mad_i32_i24 v51, v131, s79, v124
    v_mad_i32_i24 v63, v131, s79, v128
    v_mad_i32_i24 v75, v131, s79, v129
    v_mov_b32 v143, s78
    v_lshlrev_b32 v112, 4, v108
    s_mov_b32 s42, s12
    s_mov_b32 s41, s9
    s_waitcnt vmcnt(9)
    buffer_load_dwordx4 v[124:127], v132, s[60:63], 0 offen offset:16
    ds_read_b64_tr_b16 a[76:77], v136 offset:3072
    ds_read_b64_tr_b16 a[78:79], v136 offset:3840
    ds_read_b64_tr_b16 a[100:101], v136 offset:3104
    ds_read_b64_tr_b16 a[102:103], v136 offset:3872
    ds_read_b64_tr_b16 a[124:125], v136 offset:3136
    ds_read_b64_tr_b16 a[126:127], v136 offset:3904
    v_xor_b32 v2, 65536, v112
    v_lshl_add_u32 v3, s16, 10, v112
    v_add_u32 v4, s82, v112
    v_lshl_add_u32 v132, v109, 3, s83
    v_mov_b32 v128, s80
    v_mov_b32 v129, 161536
    v_mul_u32_u24 v131, 80, v109
    s_mov_b32 s43, s13
    s_mov_b32 s32, 0x2a8cbccc
    global_load_ushort v130, v130, s[64:65]
    v_add3_u32 v5, v131, v134, s84
    v_lshl_add_u32 v6, v110, 2, s85
    v_add_u32 v9, s86, v139
    v_lshrrev_b32 v134, 1, v109
    v_mul_u32_u24 v134, 48, v134
    v_lshl_add_u32 v134, v109, 3, v134
    v_lshl_add_u32 v134, v116, 4, v134
    v_lshl_add_u32 v134, v118, 1, v134
    v_add_u32 v8, s86, v134
    v_mov_b32 v37, 0
    v_mov_b32 v38, 0
    v_mov_b32 v39, 0
    s_mov_b32 s33, 0x38fba882
    v_add_u32 v152, 148992, v0
    s_add_u32 s71, s28, 16384
    s_cmp_lt_u32 s16, 2
    buffer_load_dwordx4 v121, s[44:47], s4 offen lds
    ds_read_b128 v[148:151], v152 offset:0
    ds_read_b128 v[156:159], v152 offset:128
    ds_read_b128 v[164:167], v152 offset:256
    v_add_u32 v153, 148992, v1
    v_lshlrev_b32 v154, 4, v110
    v_add_u32 v154, 160256, v154
    v_mul_u32_u24 v155, 336, v110
    v_add3_u32 v155, v155, v131, s84
    v_mul_u32_u24 v180, 272, v110
    v_add3_u32 v180, v180, v139, s85
    v_mul_u32_u24 v181, 1088, v109
    v_add_u32 v181, v181, v6
    v_add_u32 v182, 5376, v155
    v_add_u32 v183, 4352, v180
    s_cselect_b32 s29, s71, 160256
    s_waitcnt vmcnt(9)
    buffer_load_dwordx4 v123, s[44:47], s4 offen offset:1024 lds
    ds_read_b64_tr_b16 a[80:81], v137 offset:0
    ds_read_b64_tr_b16 a[82:83], v137 offset:768
    ds_read_b64_tr_b16 a[104:105], v137 offset:32
    ds_read_b64_tr_b16 a[106:107], v137 offset:800
    ds_read_b64_tr_b16 a[128:129], v137 offset:64
    ds_read_b64_tr_b16 a[130:131], v137 offset:832
    ds_read_b128 v[160:163], v153 offset:0
    v_add_u32 v188, 4352, v181
    v_cmp_gt_u32 s[88:89], 16, v108
    v_mov_b32 v189, 0xf149f2ca
    s_waitcnt lgkmcnt(9)
    v_mfma_f32_16x16x32_bf16 v[192:195], a[72:75], v[148:151], 0
    s_cselect_b32 s30, 65536, 0
    ds_read_b128 v[172:175], v153 offset:128
    ds_read_b128 v[200:203], v153 offset:256
    v_mfma_f32_16x16x32_bf16 v[208:211], a[96:99], v[148:151], 0
    s_xor_b32 s72, s29, s30
    buffer_load_dwordx4 v133, s[44:47], s4 offen offset:2048 lds
    v_mfma_f32_16x16x32_bf16 v[212:215], a[120:123], v[148:151], 0
    s_add_u32 m0, s66, 3072
    ds_read_b128 v[176:179], v153 offset:6272
    s_add_u32 s4, s68, 184704
    v_add_u32 v131, 512, v171
    v_mul_u32_u24 v134, 2731, v131
    v_bfe_u32 v112, v134, 17, 3
    v_lshrrev_b32 v134, 16, v134
    v_xor_b32 v131, v112, v131
    v_mul_u32_u24 v112, 37, v134
    v_lshrrev_b32 v112, 8, v112
    v_lshlrev_b32 v131, 4, v131
    v_mad_u32_u24 v12, v112, s69, v131
    v_add_u32 v131, 768, v171
    s_mul_i32 s74, s16, 64
    s_waitcnt lgkmcnt(3)
    v_mfma_f32_16x16x32_bf16 v[192:195], a[76:79], v[160:163], v[192:195]
    s_mul_i32 s75, s16, 32
    buffer_load_dwordx4 v121, s[44:47], s4 offen lds
    v_mfma_f32_16x16x32_bf16 v[192:195], a[80:83], v[156:159], v[192:195]
    s_add_u32 s75, s75, 192
    v_mul_u32_u24 v190, 2731, v131
    v_bfe_u32 v134, v190, 17, 3
    v_mfma_f32_16x16x32_bf16 v[208:211], a[100:103], v[160:163], v[208:211]
    s_add_u32 s34, s18, 2
    v_lshrrev_b32 v190, 16, v190
    v_xor_b32 v131, v134, v131
    v_mfma_f32_16x16x32_bf16 v[208:211], a[104:107], v[156:159], v[208:211]
    s_waitcnt vmcnt(9)
    ds_read_b64_tr_b16 a[84:85], v137 offset:3072
    ds_read_b64_tr_b16 a[86:87], v137 offset:3840
    v_mfma_f32_16x16x32_bf16 v[212:215], a[124:127], v[160:163], v[212:215]
    s_mov_b32 s27, s26
    ds_read_b64_tr_b16 a[108:109], v137 offset:3104
    ds_read_b64_tr_b16 a[110:111], v137 offset:3872
    v_mfma_f32_16x16x32_bf16 v[212:215], a[128:131], v[156:159], v[212:215]
    s_mov_b32 s26, s25
    buffer_load_dwordx4 v123, s[44:47], s4 offen offset:1024 lds
    s_waitcnt vmcnt(8)
    ds_read_b64_tr_b16 a[132:133], v137 offset:3136
    ds_read_b64_tr_b16 a[134:135], v137 offset:3904
    ds_read_b128 v[184:187], v152 offset:6400
    s_waitcnt vmcnt(7)
    ds_read_b128 v[204:207], v153 offset:6400
    v_cndmask_b32 v144, v144, v145, s[90:91]
    v_cndmask_b32 v146, v146, v147, s[90:91]
    v_perm_b32 v144, v146, v144, v117
    v_bfe_u32 v134, v140, v139, 16
    v_bfe_u32 v112, v141, v139, 16
    v_bfe_u32 v114, v142, v139, 16
    v_mfma_f32_16x16x16_bf16 v[196:199], v[168:169], v[134:135], 0
    s_waitcnt vmcnt(6)
    v_cndmask_b32 v124, v124, v125, s[90:91]
    v_cndmask_b32 v126, v126, v127, s[90:91]
    v_mfma_f32_16x16x16_bf16 v[216:219], v[168:169], v[112:113], 0
    v_perm_b32 v145, v126, v124, v117
    v_mul_u32_u24 v134, 37, v190
    v_lshrrev_b32 v134, 8, v134
    v_mfma_f32_16x16x16_bf16 v[124:127], v[168:169], v[114:115], 0
    s_waitcnt lgkmcnt(6)
    buffer_load_dwordx4 v133, s[44:47], s4 offen offset:2048 lds
    v_max_f32 v196, 0, v196
    v_mfma_f32_16x16x32_bf16 v[192:195], a[84:87], v[172:175], v[192:195]
    s_waitcnt lgkmcnt(4)
    v_max_f32 v197, 0, v197
    v_max_f32 v198, 0, v198
    s_waitcnt vmcnt(6)
    v_mfma_f32_16x16x32_bf16 v[208:211], a[108:111], v[172:175], v[208:211]
    s_waitcnt lgkmcnt(1)
    ds_read_b128 v[112:115], v152 offset:6144
    v_max_f32 v199, 0, v199
    v_mfma_f32_16x16x32_bf16 v[212:215], a[132:135], v[172:175], v[212:215]
    s_add_u32 m0, s67, 0
    s_add_u32 s4, s68, 36864
    v_cvt_pk_bf16_f32 v146, v196, v197
    s_add_u32 s19, s19, s20
    s_mov_b32 s18, 1
    buffer_load_dwordx4 v121, s[44:47], s68 offen lds
    v_cvt_pk_bf16_f32 v147, v198, v199
    v_max_f32 v216, 0, v216
    v_max_f32 v217, 0, v217
    v_mfma_f32_16x16x16_bf16 v[196:199], v[144:145], v[146:147], 0
    v_max_f32 v218, 0, v218
    v_max_f32 v219, 0, v219
    v_cvt_pk_bf16_f32 v146, v216, v217
    v_cvt_pk_bf16_f32 v147, v218, v219
    v_max_f32 v124, 0, v124
    v_max_f32 v125, 0, v125
    v_mfma_f32_16x16x16_bf16 v[216:219], v[144:145], v[146:147], 0
    v_max_f32 v126, 0, v126
    v_cvt_pk_bf16_f32 v196, v196, v196
    v_and_b32 v196, 0xffff0000, v196
    buffer_load_dwordx4 v123, s[44:47], s68 offen offset:1024 lds
    s_waitcnt lgkmcnt(0)
    v_mfma_f32_16x16x32_bf16 v[220:223], a[72:75], v[112:115], 0
    v_mul_f32 v196, 0xbfb8aa3b, v196
    v_max_f32 v127, 0, v127
    v_mfma_f32_16x16x32_bf16 v[224:227], a[96:99], v[112:115], 0
    v_exp_f32 v196, v196
    v_mfma_f32_16x16x32_bf16 v[232:235], a[120:123], v[112:115], 0
    v_add_f32 v196, 1.0, v196
    v_rcp_f32 v196, v196
    buffer_load_dwordx4 v133, s[44:47], s68 offen offset:2048 lds
    s_add_u32 m0, s67, 3072
    v_cvt_pk_bf16_f32 v196, v196, v196
    v_and_b32 v196, 0xffff0000, v196
    v_add_f32 v196, -0.5, v196
    v_mul_f32 v196, 0x41b8aa3b, v196
    s_waitcnt vmcnt(6)
    ds_read_b64_tr_b16 a[88:89], v136 offset:0
    ds_read_b64_tr_b16 a[90:91], v136 offset:768
    ds_read_b64_tr_b16 a[112:113], v136 offset:32
    ds_read_b64_tr_b16 a[114:115], v136 offset:800
    ds_read_b64_tr_b16 a[136:137], v136 offset:64
    ds_read_b64_tr_b16 a[138:139], v136 offset:832
    ds_write_b32 v119, v196 offset:0
    buffer_load_dwordx4 v121, s[44:47], s4 offen lds
    v_cvt_pk_bf16_f32 v216, v216, v216
    v_and_b32 v216, 0xffff0000, v216
    v_mul_f32 v216, 0xbfb8aa3b, v216
    v_exp_f32 v216, v216
    v_cvt_pk_bf16_f32 v146, v124, v125
    v_add_f32 v216, 1.0, v216
    v_rcp_f32 v216, v216
    v_cvt_pk_bf16_f32 v147, v126, v127
    v_cvt_pk_bf16_f32 v216, v216, v216
    v_and_b32 v216, 0xffff0000, v216
    v_mfma_f32_16x16x16_bf16 v[124:127], v[144:145], v[146:147], 0
    v_add_f32 v216, -0.5, v216
    buffer_load_dwordx4 v123, s[44:47], s4 offen offset:1024 lds
    s_waitcnt lgkmcnt(5)
    v_mfma_f32_16x16x32_bf16 v[192:195], a[88:91], v[164:167], v[192:195]
    s_waitcnt lgkmcnt(3)
    v_mul_f32 v216, 0x41b8aa3b, v216
    v_lshlrev_b32 v130, 16, v130
    v_mfma_f32_16x16x32_bf16 v[208:211], a[112:115], v[164:167], v[208:211]
    s_waitcnt lgkmcnt(0)
    ds_write_b32 v119, v216 offset:4
    v_mfma_f32_16x16x32_bf16 v[212:215], a[136:139], v[164:167], v[212:215]
    v_cvt_pk_bf16_f32 v124, v124, v124
    v_and_b32 v124, 0xffff0000, v124
    v_mul_f32 v124, 0xbfb8aa3b, v124
    buffer_load_dwordx4 v133, s[44:47], s4 offen offset:2048 lds
    ds_read_b128 v[144:147], v153 offset:6144
    s_add_u32 m0, s66, 0
    s_add_u32 s4, s68, 73728
    v_exp_f32 v124, v124
    v_max_f32 v130, 0xc2c80000, v130
    v_add_f32 v124, 1.0, v124
    v_rcp_f32 v124, v124
    v_min_f32 v130, 0x40930000, v130
    v_cvt_pk_bf16_f32 v124, v124, v124
    v_and_b32 v124, 0xffff0000, v124
    v_add_f32 v124, -0.5, v124
    v_mul_f32 v124, 0x41b8aa3b, v124
    buffer_load_dwordx4 v121, s[44:47], s4 offen lds
    s_waitcnt vmcnt(7)
    ds_read_b64_tr_b16 a[92:93], v136 offset:3072
    ds_read_b64_tr_b16 a[94:95], v136 offset:3840
    ds_read_b64_tr_b16 a[116:117], v136 offset:3104
    ds_read_b64_tr_b16 a[118:119], v136 offset:3872
    ds_read_b64_tr_b16 a[140:141], v136 offset:3136
    ds_read_b64_tr_b16 a[142:143], v136 offset:3904
    ds_write_b32 v119, v124 offset:8
    v_mul_f32 v130, 0x3fb8aa3b, v130
    s_waitcnt lgkmcnt(7)
    v_mfma_f32_16x16x32_bf16 v[220:223], a[76:79], v[144:147], v[220:223]
    v_exp_f32 v130, v130
    v_mfma_f32_16x16x32_bf16 v[224:227], a[100:103], v[144:147], v[224:227]
    buffer_load_dwordx4 v123, s[44:47], s4 offen offset:1024 lds
    v_mfma_f32_16x16x32_bf16 v[232:235], a[124:127], v[144:147], v[232:235]
    v_cvt_pk_bf16_f32 v130, v130, v130
    v_and_b32 v130, 0xffff0000, v130
    v_mul_f32 v135, 0x3fb8aa3b, v130
    v_readfirstlane_b32 s37, v130
    v_readfirstlane_b32 s31, v135
    v_lshlrev_b32 v131, 4, v131
    v_mad_u32_u24 v13, v134, s69, v131
    v_add_u32 v117, 1024, v171
    v_mul_u32_u24 v119, 2731, v117
    s_waitcnt lgkmcnt(5)
    v_mfma_f32_16x16x32_bf16 v[192:195], a[92:95], v[200:203], v[192:195]
    s_waitcnt lgkmcnt(3)
    v_bfe_u32 v130, v119, 17, 3
    v_lshrrev_b32 v119, 16, v119
    v_mfma_f32_16x16x32_bf16 v[208:211], a[116:119], v[200:203], v[208:211]
    s_waitcnt lgkmcnt(0)
    buffer_load_dwordx4 v133, s[44:47], s4 offen offset:2048 lds
    v_mfma_f32_16x16x32_bf16 v[212:215], a[140:143], v[200:203], v[212:215]
    s_barrier
    ds_read_b128 v[124:127], v152 offset:6272
    ds_read_b32 v22, v22 offset:0
    ds_read_b32 v23, v23 offset:672
    ds_read_b32 v24, v24 offset:0
    ds_read_b32 v25, v25 offset:672
    ds_read_b32 v26, v26 offset:0
    s_add_u32 m0, s66, 3072
    ds_read_b32 v27, v27 offset:672
    s_add_u32 s4, s68, 110592
    ds_read_b32 v40, v40 offset:336
    s_waitcnt vmcnt(6)
    ds_read_b64_tr_b16 a[0:1], v137 offset:0
    buffer_load_dwordx4 v121, s[44:47], s4 offen lds
    ds_read_b64_tr_b16 a[2:3], v137 offset:768
    ds_read_b64_tr_b16 a[24:25], v137 offset:32
    ds_read_b64_tr_b16 a[26:27], v137 offset:800
    ds_read_b64_tr_b16 a[48:49], v137 offset:64
    ds_read_b64_tr_b16 a[50:51], v137 offset:832
    v_xor_b32 v117, v130, v117
    v_mul_u32_u24 v130, 37, v119
    v_lshrrev_b32 v130, 8, v130
    v_lshlrev_b32 v117, 4, v117
    v_mad_u32_u24 v14, v130, s69, v117
    v_cmp_gt_u32 vcc, 48, v119
    s_waitcnt lgkmcnt(13)
    v_mfma_f32_16x16x32_bf16 v[220:223], a[80:83], v[124:127], v[220:223]
    s_waitcnt lgkmcnt(11)
    ds_read_b32 v52, v52 offset:336
    ds_read_b32 v64, v64 offset:336
    v_mfma_f32_16x16x32_bf16 v[220:223], a[84:87], v[176:179], v[220:223]
    s_waitcnt lgkmcnt(10)
    buffer_load_dwordx4 v123, s[44:47], s4 offen offset:1024 lds
    v_mfma_f32_16x16x32_bf16 v[220:223], a[88:91], v[184:187], v[220:223]
    s_waitcnt lgkmcnt(8)
    ds_read_b32 v41, v41 offset:332
    ds_read_b32 v53, v53 offset:332
    v_mfma_f32_16x16x32_bf16 v[220:223], a[92:95], v[204:207], v[220:223]
    s_waitcnt lgkmcnt(9)
    ds_read_b32 v65, v65 offset:332
    ds_read_b32 v42, v42 offset:328
    v_mfma_f32_16x16x32_bf16 v[224:227], a[104:107], v[124:127], v[224:227]
    s_waitcnt lgkmcnt(8)
    ds_read_b32 v54, v54 offset:328
    ds_read_b32 v66, v66 offset:328
    v_mfma_f32_16x16x32_bf16 v[224:227], a[108:111], v[176:179], v[224:227]
    s_waitcnt lgkmcnt(8)
    ds_read_b32 v43, v43 offset:324
    ds_read_b32 v55, v55 offset:324
    v_mfma_f32_16x16x32_bf16 v[224:227], a[112:115], v[184:187], v[224:227]
    buffer_load_dwordx4 v133, s[44:47], s4 offen offset:2048 lds
    v_mfma_f32_16x16x32_bf16 v[224:227], a[116:119], v[204:207], v[224:227]
    s_add_u32 m0, s67, 0
    ds_read_b32 v67, v67 offset:324
    ds_read_b32 v44, v44 offset:272
    v_mfma_f32_16x16x32_bf16 v[232:235], a[128:131], v[124:127], v[232:235]
    s_add_u32 s4, s68, 147456
    ds_read_b32 v56, v56 offset:272
    s_waitcnt vmcnt(6)
    v_mfma_f32_16x16x32_bf16 v[232:235], a[132:135], v[176:179], v[232:235]
    s_waitcnt lgkmcnt(11)
    ds_read_b64_tr_b16 a[4:5], v137 offset:3072
    ds_read_b64_tr_b16 a[6:7], v137 offset:3840
    v_mfma_f32_16x16x32_bf16 v[232:235], a[136:139], v[184:187], v[232:235]
    s_waitcnt lgkmcnt(11)
    ds_read_b64_tr_b16 a[28:29], v137 offset:3104
    ds_read_b64_tr_b16 a[30:31], v137 offset:3872
    v_mfma_f32_16x16x32_bf16 v[232:235], a[140:143], v[204:207], v[232:235]
    s_waitcnt lgkmcnt(11)
    buffer_load_dwordx4 v121, s[44:47], s4 offen lds
    v_mfma_f32_16x16x32_bf16 v[216:219], a[0:3], v[148:151], 0
    s_waitcnt lgkmcnt(9)
    ds_read_b64_tr_b16 a[52:53], v137 offset:3136
    ds_read_b64_tr_b16 a[54:55], v137 offset:3904
    v_mfma_f32_16x16x32_bf16 v[236:239], a[24:27], v[148:151], 0
    s_waitcnt lgkmcnt(9)
    ds_read_b32 v68, v68 offset:272
    ds_read_b32 v45, v45 offset:268
    v_mfma_f32_16x16x32_bf16 v[240:243], a[48:51], v[148:151], 0
    ds_read_b32 v57, v57 offset:268
    ds_read_b32 v69, v69 offset:268
    v_mfma_f32_16x16x32_bf16 v[244:247], a[0:3], v[112:115], 0
    s_waitcnt lgkmcnt(11)
    ds_read_b32 v46, v46 offset:264
    ds_read_b32 v58, v58 offset:264
    v_mfma_f32_16x16x32_bf16 v[248:251], a[24:27], v[112:115], 0
    s_waitcnt lgkmcnt(12)
    buffer_load_dwordx4 v123, s[44:47], s4 offen offset:1024 lds
    v_mfma_f32_16x16x32_bf16 v[252:255], a[48:51], v[112:115], 0
    s_waitcnt lgkmcnt(10)
    ds_read_b128 v[148:151], v1 offset:20608
    ds_read_b32 v70, v70 offset:264
    v_mfma_f32_16x16x32_bf16 v[216:219], a[4:7], v[160:163], v[216:219]
    s_waitcnt lgkmcnt(10)
    ds_read_b32 v47, v47 offset:260
    ds_read_b32 v59, v59 offset:260
    v_mfma_f32_16x16x32_bf16 v[236:239], a[28:31], v[160:163], v[236:239]
    ds_read_b32 v71, v71 offset:260
    ds_read_b32 v48, v48 offset:208
    v_mfma_f32_16x16x32_bf16 v[244:247], a[4:7], v[144:147], v[244:247]
    s_waitcnt lgkmcnt(12)
    ds_read_b32 v60, v60 offset:208
    ds_read_b32 v72, v72 offset:208
    v_mfma_f32_16x16x32_bf16 v[240:243], a[52:55], v[160:163], v[240:243]
    s_waitcnt lgkmcnt(12)
    buffer_load_dwordx4 v133, s[44:47], s4 offen offset:2048 lds
    v_mfma_f32_16x16x32_bf16 v[248:251], a[28:31], v[144:147], v[248:251]
    s_add_u32 m0, s67, 3072
    ds_read_b32 v49, v49 offset:204
    ds_read_b32 v61, v61 offset:204
    s_waitcnt vmcnt(6)
    v_mfma_f32_16x16x32_bf16 v[252:255], a[52:55], v[144:147], v[252:255]
    s_add_u32 s4, s68, 184320
    ds_read_b64_tr_b16 a[8:9], v136 offset:0
    ds_read_b64_tr_b16 a[10:11], v136 offset:768
    ds_read_b64_tr_b16 a[32:33], v136 offset:32
    ds_read_b64_tr_b16 a[34:35], v136 offset:800
    ds_read_b64_tr_b16 a[56:57], v136 offset:64
    ds_read_b64_tr_b16 a[58:59], v136 offset:832
    ds_read_b128 v[112:115], v0 offset:20736
    buffer_load_dwordx4 v121, s[44:47], s4 offen lds
    ds_read_b32 v73, v73 offset:204
    ds_read_b32 v50, v50 offset:200
    ds_read_b32 v62, v62 offset:200
    v_cndmask_b32 v14, v170, v14, vcc
    v_cmp_gt_u32 vcc, 2, v118
    ds_read_b32 v74, v74 offset:200
    ds_read_b32 v51, v51 offset:196
    ds_read_b32 v63, v63 offset:196
    ds_read_b32 v75, v75 offset:196
    v_cndmask_b32 v32, 0, v138, vcc
    v_cndmask_b32 v33, v138, 0, vcc
    v_cndmask_b32 v34, 0, v138, vcc
    buffer_load_dwordx4 v123, s[44:47], s4 offen offset:1024 lds
    s_waitcnt lgkmcnt(12)
    v_mfma_f32_16x16x32_bf16 v[216:219], a[8:11], v[156:159], v[216:219]
    s_waitcnt lgkmcnt(10)
    ds_read_b32 v143, v143 offset:336
    v_cndmask_b32 v35, v138, 0, vcc
    v_mfma_f32_16x16x32_bf16 v[236:239], a[32:35], v[156:159], v[236:239]
    s_waitcnt lgkmcnt(8)
    v_cmp_eq_u32 vcc, v109, v116
    v_cndmask_b32 v22, v189, v22, s[88:89]
    v_mfma_f32_16x16x32_bf16 v[240:243], a[56:59], v[156:159], v[240:243]
    s_waitcnt lgkmcnt(7)
    v_cndmask_b32 v190, 0, v32, vcc
    v_cndmask_b32 v191, 0, v33, vcc
    v_mfma_f32_16x16x32_bf16 v[244:247], a[8:11], v[124:127], v[244:247]
    s_waitcnt lgkmcnt(5)
    v_cndmask_b32 v24, v189, v24, s[88:89]
    v_cndmask_b32 v26, v189, v26, s[88:89]
    v_mfma_f32_16x16x32_bf16 v[248:251], a[32:35], v[124:127], v[248:251]
    s_waitcnt lgkmcnt(3)
    buffer_load_dwordx4 v133, s[44:47], s4 offen offset:2048 lds
    v_mfma_f32_16x16x32_bf16 v[252:255], a[56:59], v[124:127], v[252:255]
    s_add_u32 m0, s66, 0
    ds_read_b128 v[228:231], v1 offset:20736
    s_add_u32 s4, s68, 768
    v_mul_u32_u24 v138, 6, v111
    v_sub_u32 v117, v108, v138
    s_waitcnt vmcnt(6)
    ds_read_b64_tr_b16 a[12:13], v136 offset:3072
    ds_read_b64_tr_b16 a[14:15], v136 offset:3840
    s_waitcnt lgkmcnt(3)
    ds_read_b64_tr_b16 a[36:37], v136 offset:3104
    ds_read_b64_tr_b16 a[38:39], v136 offset:3872
    ds_read_b64_tr_b16 a[60:61], v136 offset:3136
    ds_read_b64_tr_b16 a[62:63], v136 offset:3904
    buffer_load_dwordx4 v121, s[44:47], s4 offen lds
    v_readfirstlane_b32 s39, v143
    v_mul_u32_u24 v138, 384, v111
    v_lshl_add_u32 v138, v117, 4, v138
    v_add_u32 v111, s75, v138
    v_add_u32 v138, s74, v138
    v_cmp_gt_i32 vcc, 4, v117
    v_mul_u32_u24 v117, 6, v120
    v_sub_u32 v119, v108, v117
    v_cndmask_b32 v138, v111, v138, vcc
    v_mul_u32_u24 v117, 384, v120
    v_lshl_add_u32 v117, v119, 4, v117
    v_add_u32 v111, s75, v117
    v_add_u32 v117, s74, v117
    v_cmp_gt_i32 vcc, -60, v119
    buffer_load_dwordx4 v123, s[44:47], s4 offen offset:1024 lds
    v_mul_u32_u24 v120, 6, v122
    s_waitcnt lgkmcnt(4)
    v_mfma_f32_16x16x32_bf16 v[216:219], a[12:15], v[172:175], v[216:219]
    s_waitcnt lgkmcnt(3)
    v_cndmask_b32 v134, v111, v117, vcc
    v_sub_u32 v135, v108, v120
    v_mfma_f32_16x16x32_bf16 v[244:247], a[12:15], v[176:179], v[244:247]
    s_waitcnt lgkmcnt(0)
    v_mul_u32_u24 v120, 384, v122
    v_lshl_add_u32 v120, v135, 4, v120
    v_mfma_f32_16x16x32_bf16 v[236:239], a[36:39], v[172:175], v[236:239]
    v_add_u32 v122, s75, v120
    v_add_u32 v120, s74, v120
    v_mfma_f32_16x16x32_bf16 v[240:243], a[60:63], v[172:175], v[240:243]
    buffer_load_dwordx4 v133, s[44:47], s4 offen offset:2048 lds
    v_mfma_f32_16x16x32_bf16 v[248:251], a[36:39], v[176:179], v[248:251]
    s_add_u32 m0, s66, 3072
    ds_read_b128 v[196:199], v0 offset:20480
    v_cmp_gt_i32 vcc, -124, v135
    v_mfma_f32_16x16x32_bf16 v[252:255], a[60:63], v[176:179], v[252:255]
    s_add_u32 s4, s68, 37632
    v_cndmask_b32 v135, v122, v120, vcc
    v_cmp_gt_u32 vcc, 2, v109
    v_mul_u32_u24 v120, 96, v110
    v_add3_u32 v122, v120, v139, s66
    v_cndmask_b32 v132, v128, v132, vcc
    v_lshl_add_u32 v132, v116, 9, v132
    s_waitcnt vmcnt(6)
    ds_read_b64_tr_b16 a[16:17], v137 offset:0
    ds_read_b64_tr_b16 a[18:19], v137 offset:768
    buffer_load_dwordx4 v121, s[44:47], s4 offen lds
    ds_read_b64_tr_b16 a[40:41], v137 offset:32
    ds_read_b64_tr_b16 a[42:43], v137 offset:800
    ds_read_b64_tr_b16 a[64:65], v137 offset:64
    ds_read_b64_tr_b16 a[66:67], v137 offset:832
    v_lshl_add_u32 v132, v118, 1, v132
    v_cmp_gt_u32 vcc, 3, v109
    v_lshl_add_u32 v170, v109, 3, v120
    v_add3_u32 v170, v170, 64, s66
    v_cndmask_b32 v7, v129, v132, vcc
    v_cmp_gt_u32 vcc, 8, v110
    v_add3_u32 v132, v120, v139, s67
    v_lshl_add_u32 v139, v109, 3, v120
    s_waitcnt lgkmcnt(6)
    v_mfma_f32_16x16x32_bf16 v[176:179], a[96:99], v[196:199], 0
    v_cndmask_b32 v182, v154, v182, vcc
    v_cndmask_b32 v183, v154, v183, vcc
    v_mfma_f32_16x16x32_bf16 v[124:127], a[120:123], v[196:199], 0
    buffer_load_dwordx4 v123, s[44:47], s4 offen offset:1024 lds
    v_mfma_f32_16x16x32_bf16 v[160:163], a[24:27], v[196:199], 0
    v_cmp_gt_u32 vcc, 2, v109
    v_add3_u32 v139, v139, 64, s67
    v_mfma_f32_16x16x32_bf16 v[116:119], a[48:51], v[196:199], 0
    s_waitcnt lgkmcnt(4)
    v_cndmask_b32 v188, v154, v188, vcc
    v_mov_b32 v108, 0
    v_mfma_f32_16x16x32_bf16 v[216:219], a[16:19], v[164:167], v[216:219]
    s_waitcnt lgkmcnt(1)
    v_mov_b32 v109, 0
    v_mov_b32 v110, 0
    v_mfma_f32_16x16x32_bf16 v[236:239], a[40:43], v[164:167], v[236:239]
    s_waitcnt lgkmcnt(0)
    ds_write_b64 v155, v[108:109] offset:56
    v_mfma_f32_16x16x32_bf16 v[240:243], a[64:67], v[164:167], v[240:243]
    buffer_load_dwordx4 v133, s[44:47], s4 offen offset:2048 lds
    v_mfma_f32_16x16x32_bf16 v[244:247], a[16:19], v[184:187], v[244:247]
    s_add_u32 m0, s67, 0
    ds_write_b64 v155, v[108:109] offset:64
    v_mfma_f32_16x16x32_bf16 v[248:251], a[40:43], v[184:187], v[248:251]
    s_add_u32 s4, s68, 74496
    v_mov_b32 v111, 0
    v_fma_f32 v120, v192, v192, s32
    s_waitcnt vmcnt(6)
    v_mfma_f32_16x16x32_bf16 v[252:255], a[64:67], v[184:187], v[252:255]
    ds_read_b64_tr_b16 a[20:21], v137 offset:3072
    ds_read_b64_tr_b16 a[22:23], v137 offset:3840
    ds_read_b64_tr_b16 a[44:45], v137 offset:3104
    ds_read_b64_tr_b16 a[46:47], v137 offset:3872
    buffer_load_dwordx4 v121, s[44:47], s4 offen lds
    ds_read_b64_tr_b16 a[68:69], v137 offset:3136
    ds_read_b64_tr_b16 a[70:71], v137 offset:3904
    ds_read_b128 v[184:187], v1 offset:20480
    ds_write_b128 v155, v[108:111] offset:16
    v_fmac_f32 v120, v193, v193
    v_fmac_f32 v120, v194, v194
    v_fmac_f32 v120, v195, v195
    v_fmac_f32 v120, v208, v208
    v_fmac_f32 v120, v209, v209
    v_fmac_f32 v120, v210, v210
    buffer_load_dwordx4 v123, s[44:47], s4 offen offset:1024 lds
    ds_write_b128 v182, v[108:111] offset:16
    s_waitcnt lgkmcnt(7)
    v_mfma_f32_16x16x32_bf16 v[216:219], a[20:23], v[200:203], v[216:219]
    s_waitcnt lgkmcnt(5)
    v_fmac_f32 v120, v211, v211
    v_fmac_f32 v120, v212, v212
    v_mfma_f32_16x16x32_bf16 v[236:239], a[44:47], v[200:203], v[236:239]
    s_waitcnt lgkmcnt(3)
    v_fmac_f32 v120, v213, v213
    v_fmac_f32 v120, v214, v214
    v_mfma_f32_16x16x32_bf16 v[240:243], a[68:71], v[200:203], v[240:243]
    s_waitcnt lgkmcnt(1)
    buffer_load_dwordx4 v133, s[44:47], s4 offen offset:2048 lds
    v_mfma_f32_16x16x32_bf16 v[244:247], a[20:23], v[204:207], v[244:247]
    s_add_u32 m0, s67, 3072
    ds_write_b64 v182, v[108:109] offset:56
    v_mfma_f32_16x16x32_bf16 v[248:251], a[44:47], v[204:207], v[248:251]
    s_add_u32 s4, s68, 111360
    v_fmac_f32 v120, v215, v215
    v_fma_f32 v154, v220, v220, s32
    s_waitcnt vmcnt(6)
    v_mfma_f32_16x16x32_bf16 v[252:255], a[68:71], v[204:207], v[252:255]
    ds_read_b64_tr_b16 a[144:145], v136 offset:0
    ds_read_b64_tr_b16 a[146:147], v136 offset:768
    v_mfma_f32_16x16x32_bf16 v[176:179], a[100:103], v[184:187], v[176:179]
    buffer_load_dwordx4 v121, s[44:47], s4 offen lds
    v_mfma_f32_16x16x32_bf16 v[124:127], a[124:127], v[184:187], v[124:127]
    ds_read_b64_tr_b16 a[168:169], v136 offset:32
    ds_read_b64_tr_b16 a[170:171], v136 offset:800
    v_mfma_f32_16x16x32_bf16 v[160:163], a[28:31], v[184:187], v[160:163]
    ds_read_b64_tr_b16 a[192:193], v136 offset:64
    ds_read_b64_tr_b16 a[194:195], v136 offset:832
    v_mfma_f32_16x16x32_bf16 v[116:119], a[52:55], v[184:187], v[116:119]
    ds_read_b128 v[172:175], v0 offset:20608
    ds_write_b64 v182, v[108:109] offset:64
    buffer_load_dwordx4 v123, s[44:47], s4 offen offset:1024 lds
    v_fmac_f32 v154, v221, v221
    v_fmac_f32 v154, v222, v222
    v_fmac_f32 v154, v223, v223
    v_fmac_f32 v154, v224, v224
    v_fmac_f32 v154, v225, v225
    s_waitcnt lgkmcnt(6)
    v_mfma_f32_16x16x32_bf16 v[128:131], v[196:199], a[144:147], 0
    v_fmac_f32 v154, v226, v226
    v_fmac_f32 v154, v227, v227
    v_fmac_f32 v154, v232, v232
    v_fmac_f32 v154, v233, v233
    v_fmac_f32 v154, v234, v234
    s_waitcnt lgkmcnt(4)
    v_mfma_f32_16x16x32_bf16 v[108:111], v[196:199], a[168:171], 0
    buffer_load_dwordx4 v133, s[44:47], s4 offen offset:2048 lds
    s_add_u32 m0, s66, 0
    s_add_u32 s4, s68, 148224
    s_waitcnt lgkmcnt(1)
    v_mfma_f32_16x16x32_bf16 v[176:179], a[104:107], v[172:175], v[176:179]
    v_fmac_f32 v154, v235, v235
    v_fma_f32 v168, v216, v216, s32
    v_mfma_f32_16x16x32_bf16 v[176:179], a[108:111], v[148:151], v[176:179]
    v_fmac_f32 v168, v217, v217
    v_fmac_f32 v168, v218, v218
    v_mfma_f32_16x16x32_bf16 v[176:179], a[112:115], v[112:115], v[176:179]
    v_fmac_f32 v168, v219, v219
    v_fmac_f32 v168, v236, v236
    s_waitcnt vmcnt(6)
    v_mfma_f32_16x16x32_bf16 v[176:179], a[116:119], v[228:231], v[176:179]
    buffer_load_dwordx4 v121, s[44:47], s4 offen lds
    v_mfma_f32_16x16x32_bf16 v[124:127], a[128:131], v[172:175], v[124:127]
    ds_read_b64_tr_b16 a[148:149], v136 offset:3072
    ds_read_b64_tr_b16 a[150:151], v136 offset:3840
    v_mfma_f32_16x16x32_bf16 v[124:127], a[132:135], v[148:151], v[124:127]
    ds_read_b64_tr_b16 a[172:173], v136 offset:3104
    ds_read_b64_tr_b16 a[174:175], v136 offset:3872
    v_mfma_f32_16x16x32_bf16 v[124:127], a[136:139], v[112:115], v[124:127]
    ds_read_b64_tr_b16 a[196:197], v136 offset:3136
    ds_read_b64_tr_b16 a[198:199], v136 offset:3904
    v_mfma_f32_16x16x32_bf16 v[124:127], a[140:143], v[228:231], v[124:127]
    v_fmac_f32 v168, v237, v237
    v_fmac_f32 v168, v238, v238
    v_mfma_f32_16x16x32_bf16 v[160:163], a[32:35], v[172:175], v[160:163]
    buffer_load_dwordx4 v123, s[44:47], s4 offen offset:1024 lds
    v_mfma_f32_16x16x32_bf16 v[160:163], a[36:39], v[148:151], v[160:163]
    v_fmac_f32 v168, v239, v239
    v_fmac_f32 v168, v240, v240
    v_mfma_f32_16x16x32_bf16 v[160:163], a[40:43], v[112:115], v[160:163]
    v_fmac_f32 v168, v241, v241
    v_fmac_f32 v168, v242, v242
    v_mfma_f32_16x16x32_bf16 v[160:163], a[44:47], v[228:231], v[160:163]
    v_fmac_f32 v168, v243, v243
    v_cvt_pk_bf16_f32 v36, v168, v120
    v_mfma_f32_16x16x32_bf16 v[116:119], a[56:59], v[172:175], v[116:119]
    s_waitcnt lgkmcnt(4)
    v_fma_f32 v120, v244, v244, s32
    v_fmac_f32 v120, v245, v245
    v_mfma_f32_16x16x32_bf16 v[116:119], a[60:63], v[148:151], v[116:119]
    s_waitcnt lgkmcnt(2)
    buffer_load_dwordx4 v133, s[44:47], s4 offen offset:2048 lds
    v_mfma_f32_16x16x32_bf16 v[116:119], a[64:67], v[112:115], v[116:119]
    s_add_u32 m0, s66, 3072
    v_fmac_f32 v120, v246, v246
    v_fmac_f32 v120, v247, v247
    v_mfma_f32_16x16x32_bf16 v[116:119], a[68:71], v[228:231], v[116:119]
    s_add_u32 s4, s68, 185088
    v_fmac_f32 v120, v248, v248
    v_fmac_f32 v120, v249, v249
    v_mfma_f32_16x16x32_bf16 v[128:131], v[184:187], a[148:151], v[128:131]
    s_waitcnt vmcnt(6)
    ds_read_b64_tr_b16 a[152:153], v137 offset:0
    ds_read_b64_tr_b16 a[154:155], v137 offset:768
    v_mfma_f32_16x16x32_bf16 v[108:111], v[184:187], a[172:175], v[108:111]
    s_waitcnt lgkmcnt(2)
    ds_read_b64_tr_b16 a[176:177], v137 offset:32
    ds_read_b64_tr_b16 a[178:179], v137 offset:800
    buffer_load_dwordx4 v121, s[44:47], s4 offen lds
    v_mfma_f32_16x16x32_bf16 v[140:143], v[32:35], v[36:39], 0
    ds_read_b64_tr_b16 a[200:201], v137 offset:64
    ds_read_b64_tr_b16 a[202:203], v137 offset:832
    v_fmac_f32 v120, v250, v250
    v_fmac_f32 v120, v251, v251
    v_fmac_f32 v120, v252, v252
    v_fmac_f32 v120, v253, v253
    v_fmac_f32 v120, v254, v254
    v_fmac_f32 v120, v255, v255
    v_rsq_f32 v141, v141
    v_rsq_f32 v140, v140
    buffer_load_dwordx4 v123, s[44:47], s4 offen offset:1024 lds
    v_mul_f32 v140, s31, v140
    v_mul_f32 v192, v141, v192
    v_mul_f32 v193, v141, v193
    s_waitcnt lgkmcnt(4)
    v_mfma_f32_16x16x32_bf16 v[128:131], v[172:175], a[152:155], v[128:131]
    v_cvt_pk_bf16_f32 v144, v192, v193
    s_waitcnt lgkmcnt(2)
    v_mfma_f32_16x16x32_bf16 v[108:111], v[172:175], a[176:179], v[108:111]
    v_mul_f32 v194, v141, v194
    v_mul_f32 v195, v141, v195
    v_cvt_pk_bf16_f32 v145, v194, v195
    v_mul_f32 v208, v141, v208
    buffer_load_dwordx4 v133, s[44:47], s4 offen offset:2048 lds
    s_add_u32 m0, s28, 8192
    s_add_u32 s4, 0, 12288
    v_mul_f32 v209, v141, v209
    v_cvt_pk_bf16_f32 v146, v208, v209
    v_mul_f32 v210, v141, v210
    v_mul_f32 v211, v141, v211
    v_cvt_pk_bf16_f32 v147, v210, v211
    v_mul_f32 v212, v141, v212
    v_mul_f32 v213, v141, v213
    s_waitcnt vmcnt(6)
    ds_read_b64_tr_b16 a[156:157], v137 offset:3072
    ds_read_b64_tr_b16 a[158:159], v137 offset:3840
    ds_read_b64_tr_b16 a[180:181], v137 offset:3104
    ds_read_b64_tr_b16 a[182:183], v137 offset:3872
    ds_read_b64_tr_b16 a[204:205], v137 offset:3136
    buffer_load_dwordx4 v12, s[8:11], s25 offen nt lds
    ds_read_b64_tr_b16 a[206:207], v137 offset:3904
    ds_write_b128 v155, v[144:147]
    v_mfma_f32_16x16x32_bf16 v[144:147], v[196:199], a[192:195], 0
    s_add_u32 m0, s28, 12288
    v_cvt_pk_bf16_f32 v158, v212, v213
    v_mul_f32 v214, v141, v214
    v_mfma_f32_16x16x32_bf16 v[144:147], v[184:187], a[196:199], v[144:147]
    s_waitcnt lgkmcnt(7)
    v_mul_f32 v215, v141, v215
    v_cvt_pk_bf16_f32 v159, v214, v215
    v_mfma_f32_16x16x32_bf16 v[144:147], v[172:175], a[200:203], v[144:147]
    buffer_load_dwordx4 v13, s[8:11], s25 offen nt lds
    ds_write_b64 v155, v[158:159] offset:48
    s_add_u32 m0, s29, 0
    s_waitcnt lgkmcnt(6)
    v_mfma_f32_16x16x32_bf16 v[128:131], v[148:151], a[156:159], v[128:131]
    s_waitcnt lgkmcnt(4)
    v_mul_f32 v216, v140, v216
    v_mul_f32 v217, v140, v217
    v_mfma_f32_16x16x32_bf16 v[108:111], v[148:151], a[180:183], v[108:111]
    s_waitcnt lgkmcnt(2)
    v_cvt_pk_bf16_f32 v164, v216, v217
    v_mul_f32 v218, v140, v218
    v_mfma_f32_16x16x32_bf16 v[144:147], v[148:151], a[204:207], v[144:147]
    buffer_load_dwordx4 v14, s[8:11], s25 offen nt lds
    s_add_u32 m0, s67, 0
    s_cmp_lt_u32 1, s17
    s_cselect_b32 s10, s36, 0
    v_mul_f32 v219, v140, v219
    v_cvt_pk_bf16_f32 v165, v218, v219
    v_mul_f32 v236, v140, v236
    v_mul_f32 v237, v140, v237
    v_cvt_pk_bf16_f32 v166, v236, v237
    v_mul_f32 v238, v140, v238
    v_mul_f32 v239, v140, v239
    v_cvt_pk_bf16_f32 v167, v238, v239
    v_mul_f32 v240, v140, v240
    v_mul_f32 v241, v140, v241
    v_cvt_pk_bf16_f32 v156, v240, v241
    s_mov_b32 s25, s24
    s_waitcnt vmcnt(6)
    buffer_load_dwordx4 v138, s[48:51], 0 offen lds
    ds_read_b64_tr_b16 a[160:161], v136 offset:0
    ds_read_b64_tr_b16 a[162:163], v136 offset:768
    ds_read_b64_tr_b16 a[184:185], v136 offset:32
    ds_read_b64_tr_b16 a[186:187], v136 offset:800
    ds_read_b64_tr_b16 a[208:209], v136 offset:64
    ds_read_b64_tr_b16 a[210:211], v136 offset:832
    ds_write_b128 v155, v[164:167] offset:32
    v_mul_f32 v242, v140, v242
    v_mul_f32 v243, v140, v243
    v_cvt_pk_bf16_f32 v157, v242, v243
    v_mul_f32 v140, v216, v192
    buffer_load_dwordx4 v134, s[48:51], 0 offen offset:1024 lds
    v_fmac_f32 v140, v217, v193
    v_mfma_f32_16x16x32_bf16 v[204:207], a[72:75], v[196:199], 0
    ds_write_b64 v155, v[156:157] offset:72
    v_mfma_f32_16x16x32_bf16 v[204:207], a[76:79], v[184:187], v[204:207]
    v_fmac_f32 v140, v218, v194
    v_fmac_f32 v140, v219, v195
    v_mfma_f32_16x16x32_bf16 v[204:207], a[80:83], v[172:175], v[204:207]
    s_waitcnt lgkmcnt(6)
    ds_read_b128 v[156:159], v152 offset:0
    v_fmac_f32 v140, v236, v208
    v_mfma_f32_16x16x32_bf16 v[204:207], a[84:87], v[148:151], v[204:207]
    s_waitcnt lgkmcnt(3)
    ds_read_b128 v[164:167], v153 offset:128
    buffer_load_dwordx4 v135, s[48:51], 0 offen offset:2048 lds
    v_mfma_f32_16x16x32_bf16 v[204:207], a[88:91], v[112:115], v[204:207]
    s_add_u32 m0, s67, 3072
    v_fmac_f32 v140, v237, v209
    v_fmac_f32 v140, v238, v210
    v_mfma_f32_16x16x32_bf16 v[204:207], a[92:95], v[228:231], v[204:207]
    ds_read_b128 v[192:195], v152 offset:256
    v_fmac_f32 v140, v239, v211
    v_mfma_f32_16x16x32_bf16 v[128:131], v[112:115], a[160:163], v[128:131]
    v_fmac_f32 v140, v240, v212
    v_fmac_f32 v140, v241, v213
    v_mfma_f32_16x16x32_bf16 v[108:111], v[112:115], a[184:187], v[108:111]
    ds_read_b128 v[200:203], v153 offset:0
    v_fmac_f32 v140, v242, v214
    s_waitcnt vmcnt(6)
    v_mfma_f32_16x16x32_bf16 v[144:147], v[112:115], a[208:211], v[144:147]
    buffer_load_dwordx4 v138, s[48:51], s4 offen lds
    ds_read_b64_tr_b16 a[164:165], v136 offset:3072
    s_waitcnt lgkmcnt(4)
    v_mfma_f32_16x16x32_bf16 v[208:211], v[156:159], a[144:147], 0
    ds_read_b64_tr_b16 a[166:167], v136 offset:3840
    ds_read_b64_tr_b16 a[188:189], v136 offset:3104
    ds_read_b64_tr_b16 a[190:191], v136 offset:3872
    ds_read_b64_tr_b16 a[212:213], v136 offset:3136
    ds_read_b64_tr_b16 a[214:215], v136 offset:3904
    v_fmac_f32 v140, v243, v215
    v_mfma_f32_16x16x32_bf16 v[212:215], v[156:159], a[168:171], 0
    v_mov_b32 v133, v140
    v_cvt_pk_bf16_f32 v36, v120, v154
    buffer_load_dwordx4 v134, s[48:51], s4 offen offset:1024 lds
    v_permlane32_swap_b32 v140, v133
    v_add_f32 v140, v140, v133
    s_waitcnt lgkmcnt(6)
    v_mfma_f32_16x16x32_bf16 v[208:211], v[200:203], a[148:151], v[208:211]
    v_mov_b32 v133, v140
    v_fma_f32 v169, v204, v204, s32
    v_mfma_f32_16x16x32_bf16 v[212:215], v[200:203], a[172:175], v[212:215]
    v_permlane16_swap_b32 v140, v133
    v_add_f32 v140, v140, v133
    v_add_f32 v140, s39, v140
    s_waitcnt lgkmcnt(4)
    v_mfma_f32_16x16x32_bf16 v[128:131], v[228:231], a[164:167], v[128:131]
    s_waitcnt lgkmcnt(2)
    buffer_load_dwordx4 v135, s[48:51], s4 offen offset:2048 lds
    v_mfma_f32_16x16x32_bf16 v[108:111], v[228:231], a[188:191], v[108:111]
    s_waitcnt lgkmcnt(0)
    v_mov_b32 v141, v189
    v_mov_b32 v142, v189
    v_mfma_f32_16x16x32_bf16 v[144:147], v[228:231], a[212:215], v[144:147]
    s_add_u32 m0, s66, 0
    s_add_u32 s4, 0, 24576
    v_mov_b32 v143, v189
    v_cndmask_b32 v140, v189, v140, s[88:89]
    ds_write_b128 v180, v[140:143] offset:192
    buffer_load_dwordx4 v138, s[48:51], s4 offen lds
    v_fmac_f32 v169, v205, v205
    v_fmac_f32 v169, v206, v206
    v_fmac_f32 v169, v207, v207
    v_fmac_f32 v169, v176, v176
    v_fmac_f32 v169, v177, v177
    v_fmac_f32 v169, v178, v178
    v_fmac_f32 v169, v179, v179
    v_fmac_f32 v169, v124, v124
    v_fmac_f32 v169, v125, v125
    v_fmac_f32 v169, v126, v126
    v_fmac_f32 v169, v127, v127
    v_cvt_pk_bf16_f32 v120, v128, v129
    v_mfma_f32_16x16x32_bf16 v[140:143], v[32:35], v[36:39], 0
    v_cvt_pk_bf16_f32 v121, v130, v131
    v_cvt_pk_bf16_f32 v108, v108, v109
    v_mfma_f32_16x16x32_bf16 v[128:131], v[156:159], a[192:195], 0
    ds_read_b128 v[156:159], v152 offset:128
    v_cvt_pk_bf16_f32 v109, v110, v111
    v_mfma_f32_16x16x32_bf16 v[128:131], v[200:203], a[196:199], v[128:131]
    ds_read_b128 v[200:203], v153 offset:256
    v_cvt_pk_bf16_f32 v136, v144, v145
    v_rsq_f32 v141, v141
    v_rsq_f32 v140, v140
    v_mul_f32 v220, v141, v220
    v_mul_f32 v140, s31, v140
    v_mul_f32 v221, v141, v221
    v_cvt_pk_bf16_f32 v216, v220, v221
    v_mul_f32 v222, v141, v222
    v_mul_f32 v223, v141, v223
    v_cvt_pk_bf16_f32 v217, v222, v223
    v_mul_f32 v224, v141, v224
    v_mul_f32 v225, v141, v225
    v_cvt_pk_bf16_f32 v218, v224, v225
    v_mul_f32 v226, v141, v226
    v_mul_f32 v227, v141, v227
    v_cvt_pk_bf16_f32 v219, v226, v227
    v_mul_f32 v232, v141, v232
    v_mul_f32 v233, v141, v233
    v_cvt_pk_bf16_f32 v238, v232, v233
    v_mul_f32 v234, v141, v234
    v_mul_f32 v235, v141, v235
    s_waitcnt lgkmcnt(1)
    v_mfma_f32_16x16x32_bf16 v[208:211], v[156:159], a[152:155], v[208:211]
    ds_write_b128 v182, v[216:219]
    v_mfma_f32_16x16x32_bf16 v[208:211], v[164:167], a[156:159], v[208:211]
    s_waitcnt lgkmcnt(1)
    v_cvt_pk_bf16_f32 v239, v234, v235
    v_mul_f32 v244, v140, v244
    v_mfma_f32_16x16x32_bf16 v[208:211], v[192:195], a[160:163], v[208:211]
    v_mul_f32 v245, v140, v245
    v_cvt_pk_bf16_f32 v216, v244, v245
    v_mfma_f32_16x16x32_bf16 v[208:211], v[200:203], a[164:167], v[208:211]
    ds_write_b64 v182, v[238:239] offset:48
    v_mfma_f32_16x16x32_bf16 v[212:215], v[156:159], a[176:179], v[212:215]
    v_mul_f32 v246, v140, v246
    v_mul_f32 v247, v140, v247
    v_mfma_f32_16x16x32_bf16 v[212:215], v[164:167], a[180:183], v[212:215]
    v_cvt_pk_bf16_f32 v217, v246, v247
    v_mul_f32 v248, v140, v248
    v_mfma_f32_16x16x32_bf16 v[212:215], v[192:195], a[184:187], v[212:215]
    v_mul_f32 v249, v140, v249
    v_cvt_pk_bf16_f32 v218, v248, v249
    v_mfma_f32_16x16x32_bf16 v[212:215], v[200:203], a[188:191], v[212:215]
    v_mul_f32 v250, v140, v250
    v_mul_f32 v251, v140, v251
    v_mfma_f32_16x16x32_bf16 v[128:131], v[156:159], a[200:203], v[128:131]
    ds_read_b128 v[156:159], v152 offset:6144
    v_cvt_pk_bf16_f32 v219, v250, v251
    v_mfma_f32_16x16x32_bf16 v[128:131], v[164:167], a[204:207], v[128:131]
    ds_write_b128 v182, v[216:219] offset:32
    v_mfma_f32_16x16x32_bf16 v[216:219], a[0:3], v[196:199], 0
    v_mul_f32 v252, v140, v252
    v_mul_f32 v253, v140, v253
    v_mfma_f32_16x16x32_bf16 v[216:219], a[4:7], v[184:187], v[216:219]
    v_cvt_pk_bf16_f32 v236, v252, v253
    v_mul_f32 v254, v140, v254
    v_mfma_f32_16x16x32_bf16 v[216:219], a[8:11], v[172:175], v[216:219]
    ds_read_b128 v[164:167], v153 offset:6144
    ds_read_b128 v[172:175], v152 offset:6272
    v_mfma_f32_16x16x32_bf16 v[216:219], a[12:15], v[148:151], v[216:219]
    ds_read_b128 v[148:151], v153 offset:6272
    ds_read_b128 v[184:187], v152 offset:6400
    v_mfma_f32_16x16x32_bf16 v[216:219], a[16:19], v[112:115], v[216:219]
    v_mul_f32 v255, v140, v255
    v_cvt_pk_bf16_f32 v237, v254, v255
    v_mfma_f32_16x16x32_bf16 v[216:219], a[20:23], v[228:231], v[216:219]
    s_waitcnt lgkmcnt(5)
    ds_read_b128 v[112:115], v153 offset:6400
    v_mul_f32 v140, v244, v220
    v_mfma_f32_16x16x32_bf16 v[128:131], v[192:195], a[208:211], v[128:131]
    ds_write_b64 v182, v[236:237] offset:72
    v_mfma_f32_16x16x32_bf16 v[128:131], v[200:203], a[212:215], v[128:131]
    v_fmac_f32 v140, v245, v221
    v_fmac_f32 v140, v246, v222
    v_mfma_f32_16x16x32_bf16 v[152:155], v[156:159], a[144:147], 0
    v_fmac_f32 v140, v247, v223
    v_fmac_f32 v140, v248, v224
    v_mfma_f32_16x16x32_bf16 v[192:195], v[156:159], a[168:171], 0
    s_waitcnt lgkmcnt(5)
    v_fmac_f32 v140, v249, v225
    v_fmac_f32 v140, v250, v226
    v_mfma_f32_16x16x32_bf16 v[152:155], v[164:167], a[148:151], v[152:155]
    s_waitcnt lgkmcnt(3)
    v_fmac_f32 v140, v251, v227
    v_fmac_f32 v140, v252, v232
    v_mfma_f32_16x16x32_bf16 v[152:155], v[172:175], a[152:155], v[152:155]
    s_waitcnt lgkmcnt(2)
    v_fmac_f32 v140, v253, v233
    v_fmac_f32 v140, v254, v234
    v_mfma_f32_16x16x32_bf16 v[152:155], v[148:151], a[156:159], v[152:155]
    s_waitcnt lgkmcnt(1)
    v_fmac_f32 v140, v255, v235
    v_mov_b32 v123, v140
    v_mfma_f32_16x16x32_bf16 v[152:155], v[184:187], a[160:163], v[152:155]
    v_fma_f32 v168, v216, v216, s32
    v_fmac_f32 v168, v217, v217
    v_mfma_f32_16x16x32_bf16 v[152:155], v[112:115], a[164:167], v[152:155]
    v_permlane32_swap_b32 v140, v123
    v_mfma_f32_16x16x32_bf16 v[192:195], v[164:167], a[172:175], v[192:195]
    v_add_f32 v140, v140, v123
    v_mov_b32 v123, v140
    v_mfma_f32_16x16x32_bf16 v[192:195], v[172:175], a[176:179], v[192:195]
    v_fmac_f32 v168, v218, v218
    v_fmac_f32 v168, v219, v219
    v_mfma_f32_16x16x32_bf16 v[192:195], v[148:151], a[180:183], v[192:195]
    v_permlane16_swap_b32 v140, v123
    v_mfma_f32_16x16x32_bf16 v[192:195], v[184:187], a[184:187], v[192:195]
    v_add_f32 v140, v140, v123
    v_add_f32 v140, s39, v140
    v_mfma_f32_16x16x32_bf16 v[192:195], v[112:115], a[188:191], v[192:195]
    v_mov_b32 v141, v189
    v_mov_b32 v142, v189
    v_mfma_f32_16x16x32_bf16 v[196:199], v[156:159], a[192:195], 0
    v_mov_b32 v143, v189
    v_cndmask_b32 v140, v189, v140, s[88:89]
    v_mfma_f32_16x16x32_bf16 v[196:199], v[164:167], a[196:199], v[196:199]
    ds_write_b128 v183, v[140:143] offset:192
    v_mfma_f32_16x16x32_bf16 v[196:199], v[172:175], a[200:203], v[196:199]
    v_fmac_f32 v168, v160, v160
    v_fmac_f32 v168, v161, v161
    v_mfma_f32_16x16x32_bf16 v[196:199], v[148:151], a[204:207], v[196:199]
    v_fmac_f32 v168, v162, v162
    v_fmac_f32 v168, v163, v163
    v_mfma_f32_16x16x32_bf16 v[196:199], v[184:187], a[208:211], v[196:199]
    v_fmac_f32 v168, v116, v116
    v_fmac_f32 v168, v117, v117
    v_mfma_f32_16x16x32_bf16 v[196:199], v[112:115], a[212:215], v[196:199]
    v_fmac_f32 v168, v118, v118
    v_fmac_f32 v168, v119, v119
    v_cvt_pk_bf16_f32 v36, v168, v169
    v_cvt_pk_bf16_f32 v137, v146, v147
    v_cvt_pk_bf16_f32 v208, v208, v208
    v_mfma_f32_16x16x32_bf16 v[112:115], v[32:35], v[36:39], 0
    v_cvt_pk_bf16_f32 v209, v209, v209
    v_cvt_pk_bf16_f32 v210, v210, v210
    v_cvt_pk_bf16_f32 v211, v211, v211
    ds_write2_b32 v181, v208, v209 offset0:0 offset1:68
    v_cvt_pk_bf16_f32 v212, v212, v212
    v_cvt_pk_bf16_f32 v213, v213, v213
    ds_write2_b32 v181, v210, v211 offset0:136 offset1:204
    v_cvt_pk_bf16_f32 v214, v214, v214
    v_rsq_f32 v113, v113
    v_rsq_f32 v112, v112
    v_mul_f32 v204, v113, v204
    v_mul_f32 v112, s31, v112
    v_mul_f32 v205, v113, v205
    v_cvt_pk_bf16_f32 v140, v204, v205
    v_mul_f32 v206, v113, v206
    v_mul_f32 v207, v113, v207
    v_cvt_pk_bf16_f32 v141, v206, v207
    v_mul_f32 v176, v113, v176
    v_mul_f32 v177, v113, v177
    v_cvt_pk_bf16_f32 v142, v176, v177
    v_mul_f32 v178, v113, v178
    v_mul_f32 v179, v113, v179
    v_cvt_pk_bf16_f32 v143, v178, v179
    v_mul_f32 v124, v113, v124
    v_mul_f32 v125, v113, v125
    v_cvt_pk_bf16_f32 v146, v124, v125
    v_mul_f32 v126, v113, v126
    v_mul_f32 v127, v113, v127
    v_cvt_pk_bf16_f32 v147, v126, v127
    v_mul_f32 v216, v112, v216
    v_mul_f32 v217, v112, v217
    v_cvt_pk_bf16_f32 v124, v216, v217
    v_mul_f32 v218, v112, v218
    v_mul_f32 v219, v112, v219
    v_cvt_pk_bf16_f32 v125, v218, v219
    v_mul_f32 v160, v112, v160
    v_mul_f32 v161, v112, v161
    v_cvt_pk_bf16_f32 v126, v160, v161
    v_mul_f32 v162, v112, v162
    v_mul_f32 v163, v112, v163
    v_cvt_pk_bf16_f32 v127, v162, v163
    v_mul_f32 v116, v112, v116
    v_mul_f32 v117, v112, v117
    v_mfma_f32_16x16x32_bf16 v[148:151], v[140:143], v[124:127], v[40:43]
    ds_write2_b32 v181, v212, v213 offset0:16 offset1:84
    v_cvt_pk_bf16_f32 v144, v116, v117
    v_mul_f32 v118, v112, v118
    v_mul_f32 v119, v112, v119
    v_cvt_pk_bf16_f32 v145, v118, v119
    v_cvt_pk_bf16_f32 v215, v215, v215
    ds_write2_b32 v181, v214, v215 offset0:152 offset1:220
    v_mfma_f32_16x16x16_bf16 v[148:151], v[146:147], v[144:145], v[148:151]
    v_cvt_pk_bf16_f32 v128, v128, v128
    v_cvt_pk_bf16_f32 v129, v129, v129
    v_cvt_pk_bf16_f32 v130, v130, v130
    v_cvt_pk_bf16_f32 v131, v131, v131
    ds_write2_b32 v181, v128, v129 offset0:32 offset1:100
    buffer_load_dwordx4 v134, s[48:51], s4 offen offset:1024 lds
    ds_write2_b32 v181, v130, v131 offset0:168 offset1:236
    v_cvt_pk_bf16_f32 v152, v152, v152
    v_cvt_pk_bf16_f32 v153, v153, v153
    v_cvt_pk_bf16_f32 v154, v154, v154
    v_cvt_pk_bf16_f32 v155, v155, v155
    ds_write2_b32 v188, v152, v153 offset0:0 offset1:68
    buffer_load_dwordx4 v135, s[48:51], s4 offen offset:2048 lds
    ds_write2_b32 v188, v154, v155 offset0:136 offset1:204
    s_add_u32 m0, s66, 3072
    s_add_u32 s4, 0, 36864
    v_cvt_pk_bf16_f32 v192, v192, v192
    v_cvt_pk_bf16_f32 v193, v193, v193
    v_cvt_pk_bf16_f32 v194, v194, v194
    v_cvt_pk_bf16_f32 v195, v195, v195
    ds_write2_b32 v188, v192, v193 offset0:16 offset1:84
    s_waitcnt vmcnt(9)
    s_barrier
    buffer_load_dwordx4 v138, s[48:51], s4 offen lds
    ds_read_b128 v[112:115], v0 offset:26624
    ds_read_b128 v[116:119], v1 offset:26624
    ds_read_b128 v[128:131], v0 offset:26752
    ds_read_b128 v[152:155], v1 offset:26752
    ds_read_b128 v[156:159], v0 offset:26880
    ds_read_b128 v[160:163], v1 offset:26880
    buffer_load_dwordx4 v134, s[48:51], s4 offen offset:1024 lds
    ds_write2_b32 v188, v194, v195 offset0:152 offset1:220
    v_xor_b32 v189, 65536, v2
    v_lshrrev_b32 v133, 2, v189
    v_lshrrev_b32 v168, 8, v189
    v_add_u32 v189, 148992, v189
    v_lshl_add_u32 v111, s16, 2, v189
    v_add_u32 v133, 162048, v133
    v_lshlrev_b32 v168, 4, v168
    s_waitcnt lgkmcnt(6)
    v_mfma_f32_16x16x32_bf16 v[164:167], a[72:75], v[112:115], 0
    s_waitcnt lgkmcnt(4)
    v_add_u32 v168, 162048, v168
    v_cvt_pk_bf16_f32 v196, v196, v196
    v_mfma_f32_16x16x32_bf16 v[164:167], a[76:79], v[116:119], v[164:167]
    s_waitcnt lgkmcnt(3)
    buffer_load_dwordx4 v135, s[48:51], s4 offen offset:2048 lds
    v_mfma_f32_16x16x32_bf16 v[164:167], a[80:83], v[128:131], v[164:167]
    s_add_u32 m0, s67, 0
    v_cvt_pk_bf16_f32 v197, v197, v197
    v_cvt_pk_bf16_f32 v198, v198, v198
    v_mfma_f32_16x16x32_bf16 v[164:167], a[84:87], v[152:155], v[164:167]
    s_waitcnt lgkmcnt(1)
    ds_write2_b32 v188, v196, v197 offset0:32 offset1:100
    v_mfma_f32_16x16x32_bf16 v[164:167], a[88:91], v[156:159], v[164:167]
    s_waitcnt vmcnt(9)
    v_cvt_pk_bf16_f32 v199, v199, v199
    v_xor_b32 v2, 65536, v2
    v_mfma_f32_16x16x32_bf16 v[164:167], a[92:95], v[160:163], v[164:167]
    s_add_u32 s4, 0, 49152
    ds_read_b64 a[216:217], v132 offset:0
    ds_read_b64 a[218:219], v132 offset:1536
    v_mfma_f32_16x16x32_bf16 v[172:175], a[96:99], v[112:115], 0
    ds_read_b64 a[240:241], v132 offset:8
    ds_read_b64 a[242:243], v132 offset:1544
    v_mfma_f32_16x16x32_bf16 v[172:175], a[100:103], v[116:119], v[172:175]
    ds_read_b64 v[84:85], v139 offset:0
    ds_read_b64 v[86:87], v139 offset:1536
    v_mfma_f32_16x16x32_bf16 v[172:175], a[104:107], v[128:131], v[172:175]
    ds_write2_b32 v188, v198, v199 offset0:168 offset1:236
    v_mfma_f32_16x16x32_bf16 v[172:175], a[108:111], v[152:155], v[172:175]
    v_fma_f32 v110, v164, v164, s32
    v_fmac_f32 v110, v165, v165
    v_mfma_f32_16x16x32_bf16 v[172:175], a[112:115], v[156:159], v[172:175]
    v_fmac_f32 v110, v166, v166
    v_fmac_f32 v110, v167, v167
    v_mfma_f32_16x16x32_bf16 v[172:175], a[116:119], v[160:163], v[172:175]
    v_mfma_f32_16x16x32_bf16 v[176:179], a[120:123], v[112:115], 0
    s_waitcnt lgkmcnt(6)
    v_mfma_f32_16x16x16_bf16 v[180:183], v[28:29], a[216:217], 0
    v_mfma_f32_16x16x32_bf16 v[176:179], a[124:127], v[116:119], v[176:179]
    s_waitcnt lgkmcnt(1)
    buffer_load_dwordx4 v138, s[48:51], s4 offen lds
    v_mfma_f32_16x16x16_bf16 v[180:183], v[28:29], a[240:241], v[180:183]
    v_mfma_f32_16x16x16_bf16 v[180:183], v[28:29], v[84:85], v[180:183]
    s_waitcnt vmcnt(7)
    ds_read_b64 a[232:233], v132 offset:3072
    ds_read_b64 a[220:221], v132 offset:4608
    v_mfma_f32_16x16x16_bf16 v[184:187], v[28:29], a[218:219], 0
    ds_read_b64 v[76:77], v132 offset:3080
    ds_read_b64 a[244:245], v132 offset:4616
    ds_read_b64 v[100:101], v139 offset:3072
    v_mfma_f32_16x16x16_bf16 v[184:187], v[28:29], a[242:243], v[184:187]
    ds_read_b64 v[88:89], v139 offset:4608
    v_fmac_f32 v110, v172, v172
    v_fmac_f32 v110, v173, v173
    v_mfma_f32_16x16x16_bf16 v[184:187], v[28:29], v[86:87], v[184:187]
    v_fmac_f32 v110, v174, v174
    v_fmac_f32 v110, v175, v175
    v_mfma_f32_16x16x32_bf16 v[176:179], a[128:131], v[128:131], v[176:179]
    buffer_load_dwordx4 v134, s[48:51], s4 offen offset:1024 lds
    v_mfma_f32_16x16x32_bf16 v[176:179], a[132:135], v[152:155], v[176:179]
    v_mfma_f32_16x16x32_bf16 v[176:179], a[136:139], v[156:159], v[176:179]
    v_mfma_f32_16x16x32_bf16 v[176:179], a[140:143], v[160:163], v[176:179]
    s_waitcnt lgkmcnt(5)
    v_mov_b32_dpp v180, v184 quad_perm:[0,1,2,3] row_mask:0x2 bank_mask:0xf
    v_mfma_f32_16x16x16_bf16 v[184:187], v[28:29], a[232:233], 0
    v_mfma_f32_16x16x32_bf16 v[192:195], a[0:3], v[112:115], 0
    s_waitcnt lgkmcnt(0)
    buffer_load_dwordx4 v135, s[48:51], s4 offen offset:2048 lds
    s_add_u32 m0, s67, 3072
    v_mfma_f32_16x16x16_bf16 v[184:187], v[28:29], v[76:77], v[184:187]
    v_fmac_f32 v110, v176, v176
    v_fmac_f32 v110, v177, v177
    v_fmac_f32 v110, v178, v178
    v_mfma_f32_16x16x16_bf16 v[184:187], v[28:29], v[100:101], v[184:187]
    v_fmac_f32 v110, v179, v179
    s_add_u32 s4, 0, 61440
    s_waitcnt vmcnt(6)
    v_mfma_f32_16x16x16_bf16 v[196:199], v[28:29], a[220:221], 0
    ds_read_b64 a[222:223], v122 offset:0
    ds_read_b64 a[234:235], v122 offset:1536
    ds_read_b64 a[246:247], v122 offset:8
    v_mfma_f32_16x16x16_bf16 v[196:199], v[28:29], a[244:245], v[196:199]
    ds_read_b64 v[78:79], v122 offset:1544
    ds_read_b64 v[90:91], v170 offset:0
    ds_read_b64 v[102:103], v170 offset:1536
    v_mfma_f32_16x16x16_bf16 v[196:199], v[28:29], v[88:89], v[196:199]
    buffer_load_dwordx4 v138, s[48:51], s4 offen lds
    v_mov_b32_dpp v180, v184 quad_perm:[0,1,2,3] row_mask:0x4 bank_mask:0xf
    v_mfma_f32_16x16x32_bf16 v[192:195], a[4:7], v[116:119], v[192:195]
    v_mfma_f32_16x16x32_bf16 v[192:195], a[8:11], v[128:131], v[192:195]
    v_mfma_f32_16x16x32_bf16 v[192:195], a[12:15], v[152:155], v[192:195]
    v_mfma_f32_16x16x32_bf16 v[192:195], a[16:19], v[156:159], v[192:195]
    buffer_load_dwordx4 v134, s[48:51], s4 offen offset:1024 lds
    v_mfma_f32_16x16x32_bf16 v[192:195], a[20:23], v[160:163], v[192:195]
    s_waitcnt lgkmcnt(4)
    v_mov_b32_dpp v180, v196 quad_perm:[0,1,2,3] row_mask:0x8 bank_mask:0xf
    v_mfma_f32_16x16x16_bf16 v[184:187], v[28:29], a[222:223], 0
    ds_write_b32 v111, v180 offset:0
    v_mfma_f32_16x16x16_bf16 v[180:183], v[28:29], a[234:235], 0
    v_mfma_f32_16x16x32_bf16 v[196:199], a[24:27], v[112:115], 0
    s_waitcnt lgkmcnt(1)
    buffer_load_dwordx4 v135, s[48:51], s4 offen offset:2048 lds
    v_fma_f32 v138, v192, v192, s32
    v_mfma_f32_16x16x16_bf16 v[184:187], v[28:29], a[246:247], v[184:187]
    v_fmac_f32 v138, v193, v193
    s_waitcnt vmcnt(6)
    v_fmac_f32 v138, v194, v194
    v_mfma_f32_16x16x16_bf16 v[184:187], v[28:29], v[90:91], v[184:187]
    v_fmac_f32 v138, v195, v195
    s_add_u32 m0, s28, 65536
    v_mfma_f32_16x16x16_bf16 v[180:183], v[28:29], v[78:79], v[180:183]
    ds_read_b64 a[224:225], v122 offset:3072
    ds_read_b64 a[226:227], v122 offset:4608
    ds_read_b64 a[248:249], v122 offset:3080
    v_mfma_f32_16x16x16_bf16 v[180:183], v[28:29], v[102:103], v[180:183]
    ds_read_b64 a[250:251], v122 offset:4616
    ds_read_b64 v[92:93], v170 offset:3072
    buffer_load_dwordx4 v10, s[8:11], s24 offen nt lds
    v_mfma_f32_16x16x32_bf16 v[196:199], a[28:31], v[116:119], v[196:199]
    s_add_u32 m0, s28, 69632
    ds_read_b64 v[94:95], v170 offset:4608
    v_mfma_f32_16x16x32_bf16 v[196:199], a[32:35], v[128:131], v[196:199]
    v_mfma_f32_16x16x32_bf16 v[196:199], a[36:39], v[152:155], v[196:199]
    v_mov_b32_dpp v184, v180 quad_perm:[0,1,2,3] row_mask:0x2 bank_mask:0xf
    v_mfma_f32_16x16x32_bf16 v[196:199], a[40:43], v[156:159], v[196:199]
    v_mfma_f32_16x16x32_bf16 v[196:199], a[44:47], v[160:163], v[196:199]
    buffer_load_dwordx4 v11, s[8:11], s24 offen nt lds
    v_mfma_f32_16x16x32_bf16 v[180:183], a[48:51], v[112:115], 0
    s_waitcnt lgkmcnt(4)
    s_add_u32 m0, s28, 73728
    v_mfma_f32_16x16x16_bf16 v[200:203], v[28:29], a[224:225], 0
    v_mfma_f32_16x16x16_bf16 v[204:207], v[28:29], a[226:227], 0
    v_mfma_f32_16x16x32_bf16 v[180:183], a[52:55], v[116:119], v[180:183]
    s_waitcnt lgkmcnt(0)
    buffer_load_dwordx4 v12, s[8:11], s24 offen nt lds
    v_fmac_f32 v138, v196, v196
    v_mfma_f32_16x16x16_bf16 v[200:203], v[28:29], a[248:249], v[200:203]
    v_fmac_f32 v138, v197, v197
    v_fmac_f32 v138, v198, v198
    v_fmac_f32 v138, v199, v199
    v_mfma_f32_16x16x16_bf16 v[200:203], v[28:29], v[92:93], v[200:203]
    s_add_u32 m0, s28, 77824
    v_mfma_f32_16x16x16_bf16 v[204:207], v[28:29], a[250:251], v[204:207]
    v_mfma_f32_16x16x16_bf16 v[204:207], v[28:29], v[94:95], v[204:207]
    s_waitcnt vmcnt(6)
    ds_read_b64 a[236:237], v132 offset:0
    buffer_load_dwordx4 v13, s[8:11], s24 offen nt lds
    v_mfma_f32_16x16x32_bf16 v[180:183], a[56:59], v[128:131], v[180:183]
    s_add_u32 m0, s72, 0
    ds_read_b64 a[228:229], v132 offset:1536
    ds_read_b64 v[80:81], v132 offset:8
    v_mfma_f32_16x16x32_bf16 v[180:183], a[60:63], v[152:155], v[180:183]
    ds_read_b64 a[252:253], v132 offset:1544
    ds_read_b64 v[104:105], v139 offset:0
    v_mfma_f32_16x16x32_bf16 v[180:183], a[64:67], v[156:159], v[180:183]
    ds_read_b64 v[96:97], v139 offset:1536
    v_mov_b32_dpp v184, v200 quad_perm:[0,1,2,3] row_mask:0x4 bank_mask:0xf
    v_mfma_f32_16x16x32_bf16 v[180:183], a[68:71], v[160:163], v[180:183]
    v_mov_b32_dpp v184, v204 quad_perm:[0,1,2,3] row_mask:0x8 bank_mask:0xf
    v_mfma_f32_16x16x32_bf16 v[200:203], v[112:115], a[144:147], 0
    buffer_load_dwordx4 v14, s[8:11], s24 offen nt lds
    v_mfma_f32_16x16x32_bf16 v[200:203], v[116:119], a[148:151], v[200:203]
    s_add_u32 s8, s40, s23
    ds_write_b32 v111, v184 offset:1024
    v_mfma_f32_16x16x32_bf16 v[200:203], v[128:131], a[152:155], v[200:203]
    s_waitcnt lgkmcnt(6)
    v_fmac_f32 v138, v180, v180
    v_fmac_f32 v138, v181, v181
    v_fmac_f32 v138, v182, v182
    v_mfma_f32_16x16x16_bf16 v[184:187], v[28:29], a[236:237], 0
    v_fmac_f32 v138, v183, v183
    v_cvt_pk_bf16_f32 v36, v138, v110
    s_addc_u32 s9, s41, 0
    s_sub_u32 s10, s36, s23
    v_mfma_f32_16x16x32_bf16 v[204:207], v[32:35], v[36:39], 0
    s_waitcnt lgkmcnt(2)
    s_cmp_lt_u32 s34, s17
    s_cselect_b32 s10, s10, 0
    s_add_u32 m0, s28, 0
    v_mfma_f32_16x16x16_bf16 v[184:187], v[28:29], v[80:81], v[184:187]
    s_mov_b32 s24, s23
    s_add_u32 s23, s23, s21
    s_cmp_ge_u32 s19, 72
    v_mfma_f32_16x16x16_bf16 v[184:187], v[28:29], v[104:105], v[184:187]
    v_rsq_f32 v205, v205
    s_cselect_b32 s34, 72, 0
    v_mfma_f32_16x16x16_bf16 v[208:211], v[28:29], a[228:229], 0
    v_rsq_f32 v204, v204
    s_waitcnt vmcnt(5)
    v_mfma_f32_16x16x16_bf16 v[208:211], v[28:29], a[252:253], v[208:211]
    ds_read_b64 a[230:231], v132 offset:3072
    ds_read_b64 a[238:239], v132 offset:4608
    ds_read_b64 a[254:255], v132 offset:3080
    ds_read_b64 v[82:83], v132 offset:4616
    v_mfma_f32_16x16x32_bf16 v[200:203], v[152:155], a[156:159], v[200:203]
    s_waitcnt lgkmcnt(4)
    ds_read_b64 v[98:99], v139 offset:3072
    ds_read_b64 v[106:107], v139 offset:4608
    v_mul_f32 v204, s31, v204
    v_mfma_f32_16x16x16_bf16 v[208:211], v[28:29], v[96:97], v[208:211]
    v_mul_f32 v164, v205, v164
    v_mul_f32 v165, v205, v165
    v_cvt_pk_bf16_f32 v164, v164, v165
    v_mul_f32 v166, v205, v166
    v_mfma_f32_16x16x32_bf16 v[200:203], v[156:159], a[160:163], v[200:203]
    s_cselect_b32 s35, s22, 0
    v_mul_f32 v167, v205, v167
    v_cvt_pk_bf16_f32 v165, v166, v167
    v_mfma_f32_16x16x32_bf16 v[200:203], v[160:163], a[164:167], v[200:203]
    s_sub_u32 s19, s19, s34
    v_mov_b32_dpp v184, v208 quad_perm:[0,1,2,3] row_mask:0x2 bank_mask:0xf
    v_mul_f32 v172, v205, v172
    v_mfma_f32_16x16x32_bf16 v[208:211], v[112:115], a[168:171], 0
    s_add_u32 s23, s23, s35
    v_mul_f32 v173, v205, v173
    v_cvt_pk_bf16_f32 v166, v172, v173
    v_mfma_f32_16x16x32_bf16 v[208:211], v[116:119], a[172:175], v[208:211]
    v_cvt_pk_bf16_f32 v122, v200, v201
    v_cvt_pk_bf16_f32 v123, v202, v203
    v_mfma_f32_16x16x32_bf16 v[208:211], v[128:131], a[176:179], v[208:211]
    s_waitcnt lgkmcnt(2)
    v_mul_f32 v174, v205, v174
    v_mul_f32 v175, v205, v175
    v_cvt_pk_bf16_f32 v167, v174, v175
    v_mfma_f32_16x16x16_bf16 v[172:175], v[28:29], a[230:231], 0
    v_mul_f32 v176, v205, v176
    v_mul_f32 v177, v205, v177
    v_cvt_pk_bf16_f32 v202, v176, v177
    v_mfma_f32_16x16x16_bf16 v[172:175], v[28:29], a[254:255], v[172:175]
    v_mul_f32 v178, v205, v178
    v_mul_f32 v179, v205, v179
    v_cvt_pk_bf16_f32 v203, v178, v179
    v_mfma_f32_16x16x16_bf16 v[176:179], v[28:29], a[238:239], 0
    v_mul_f32 v192, v204, v192
    v_mul_f32 v193, v204, v193
    v_cvt_pk_bf16_f32 v192, v192, v193
    v_mfma_f32_16x16x16_bf16 v[176:179], v[28:29], v[82:83], v[176:179]
    v_mul_f32 v194, v204, v194
    v_mul_f32 v195, v204, v195
    v_cvt_pk_bf16_f32 v193, v194, v195
    v_mul_f32 v196, v204, v196
    v_mfma_f32_16x16x32_bf16 v[208:211], v[152:155], a[180:183], v[208:211]
    s_waitcnt lgkmcnt(0)
    ds_read_b128 v[212:215], v0 offset:32768
    v_mul_f32 v197, v204, v197
    v_cvt_pk_bf16_f32 v194, v196, v197
    v_mfma_f32_16x16x16_bf16 v[172:175], v[28:29], v[98:99], v[172:175]
    v_mul_f32 v198, v204, v198
    v_mul_f32 v199, v204, v199
    v_cvt_pk_bf16_f32 v195, v198, v199
    v_mfma_f32_16x16x16_bf16 v[176:179], v[28:29], v[106:107], v[176:179]
    v_mul_f32 v180, v204, v180
    v_mul_f32 v181, v204, v181
    v_cvt_pk_bf16_f32 v200, v180, v181
    v_mul_f32 v182, v204, v182
    v_mfma_f32_16x16x32_bf16 v[208:211], v[156:159], a[184:187], v[208:211]
    ds_read_b128 v[196:199], v1 offset:32768
    v_mov_b32_dpp v184, v172 quad_perm:[0,1,2,3] row_mask:0x4 bank_mask:0xf
    v_mfma_f32_16x16x32_bf16 v[208:211], v[160:163], a[188:191], v[208:211]
    ds_read_b128 v[172:175], v0 offset:32896
    v_mov_b32_dpp v184, v176 quad_perm:[0,1,2,3] row_mask:0x8 bank_mask:0xf
    v_mfma_f32_16x16x32_bf16 v[176:179], v[112:115], a[192:195], 0
    ds_read_b128 v[112:115], v1 offset:32896
    v_mul_f32 v183, v204, v183
    v_mfma_f32_16x16x32_bf16 v[176:179], v[116:119], a[196:199], v[176:179]
    ds_read_b128 v[116:119], v0 offset:33024
    v_cvt_pk_bf16_f32 v201, v182, v183
    v_mfma_f32_16x16x32_bf16 v[176:179], v[128:131], a[200:203], v[176:179]
    s_waitcnt lgkmcnt(4)
    ds_read_b128 v[128:131], v1 offset:33024
    v_cvt_pk_bf16_f32 v110, v208, v209
    v_mfma_f32_16x16x32_bf16 v[176:179], v[152:155], a[204:207], v[176:179]
    ds_write_b32 v111, v184 offset:2048
    v_mfma_f32_16x16x32_bf16 v[176:179], v[156:159], a[208:211], v[176:179]
    v_cvt_pk_bf16_f32 v111, v210, v211
    v_xor_b32 v0, 65536, v0
    v_mfma_f32_16x16x32_bf16 v[176:179], v[160:163], a[212:215], v[176:179]
    v_xor_b32 v1, 65536, v1
    v_mfma_f32_16x16x32_bf16 v[152:155], a[72:75], v[212:215], 0
    s_waitcnt lgkmcnt(5)
    v_mfma_f32_16x16x32_bf16 v[152:155], a[76:79], v[196:199], v[152:155]
    s_waitcnt lgkmcnt(4)
    v_mfma_f32_16x16x32_bf16 v[152:155], a[80:83], v[172:175], v[152:155]
    s_waitcnt lgkmcnt(3)
    v_mfma_f32_16x16x32_bf16 v[152:155], a[84:87], v[112:115], v[152:155]
    s_waitcnt lgkmcnt(2)
    v_cvt_pk_bf16_f32 v138, v176, v177
    v_cvt_pk_bf16_f32 v139, v178, v179
    v_mfma_f32_16x16x32_bf16 v[152:155], a[88:91], v[116:119], v[152:155]
    s_waitcnt lgkmcnt(1)
    v_mfma_f32_16x16x32_bf16 v[152:155], a[92:95], v[128:131], v[152:155]
    s_waitcnt lgkmcnt(0)
    v_mfma_f32_16x16x32_bf16 v[156:159], a[96:99], v[212:215], 0
    s_barrier
    ds_read_b128 v[160:163], v189 offset:0
    ds_read_b128 v[176:179], v189 offset:1024
    v_mfma_f32_16x16x32_bf16 v[156:159], a[100:103], v[196:199], v[156:159]
    ds_read_b128 v[180:183], v189 offset:2048
    v_mfma_f32_16x16x32_bf16 v[156:159], a[104:107], v[172:175], v[156:159]
    v_fma_f32 v188, v152, v152, s32
    v_fmac_f32 v188, v153, v153
    v_mfma_f32_16x16x32_bf16 v[156:159], a[108:111], v[112:115], v[156:159]
    v_fmac_f32 v188, v154, v154
    v_fmac_f32 v188, v155, v155
    v_mfma_f32_16x16x32_bf16 v[156:159], a[112:115], v[116:119], v[156:159]
    v_mfma_f32_16x16x32_bf16 v[156:159], a[116:119], v[128:131], v[156:159]
    v_mfma_f32_16x16x32_bf16 v[184:187], a[120:123], v[212:215], 0
    v_mfma_f32_16x16x32_bf16 v[184:187], a[124:127], v[196:199], v[184:187]
    v_mfma_f32_16x16x32_bf16 v[184:187], a[128:131], v[172:175], v[184:187]
    s_waitcnt lgkmcnt(1)
    v_add_f32 v160, v160, v161
    v_add_f32 v162, v162, v163
    v_mfma_f32_16x16x32_bf16 v[184:187], a[132:135], v[112:115], v[184:187]
    s_waitcnt lgkmcnt(0)
    v_add_f32 v160, v160, v162
    v_mul_f32 v160, 0xbbaaaaab, v160
    v_mfma_f32_16x16x32_bf16 v[184:187], a[136:139], v[116:119], v[184:187]
    ds_write_b32 v133, v160 offset:0
    v_mfma_f32_16x16x32_bf16 v[184:187], a[140:143], v[128:131], v[184:187]
    v_add_f32 v176, v176, v177
    v_add_f32 v178, v178, v179
    v_mfma_f32_16x16x32_bf16 v[160:163], a[0:3], v[212:215], 0
    ds_read_b128 v[204:207], v168 offset:0
    ds_read_b128 v[208:211], v168 offset:64
    v_mfma_f32_16x16x32_bf16 v[160:163], a[4:7], v[196:199], v[160:163]
    v_add_f32 v176, v176, v178
    v_mul_f32 v176, 0xbbaaaaab, v176
    v_mfma_f32_16x16x32_bf16 v[160:163], a[8:11], v[172:175], v[160:163]
    ds_write_b32 v133, v176 offset:256
    v_mfma_f32_16x16x32_bf16 v[160:163], a[12:15], v[112:115], v[160:163]
    v_add_f32 v180, v180, v181
    v_add_f32 v182, v182, v183
    v_mfma_f32_16x16x32_bf16 v[160:163], a[16:19], v[116:119], v[160:163]
    v_add_f32 v180, v180, v182
    v_mul_f32 v180, 0xbbaaaaab, v180
    v_mfma_f32_16x16x32_bf16 v[160:163], a[20:23], v[128:131], v[160:163]
    ds_write_b32 v133, v180 offset:512
    v_mfma_f32_16x16x32_bf16 v[132:135], a[24:27], v[212:215], 0
    v_fmac_f32 v188, v156, v156
    v_fmac_f32 v188, v157, v157
    v_mfma_f32_16x16x32_bf16 v[132:135], a[28:31], v[196:199], v[132:135]
    v_fmac_f32 v188, v158, v158
    v_fmac_f32 v188, v159, v159
    v_mfma_f32_16x16x32_bf16 v[132:135], a[32:35], v[172:175], v[132:135]
    s_waitcnt lgkmcnt(2)
    v_fma_f32 v189, v160, v160, s32
    v_fmac_f32 v189, v161, v161
    v_mfma_f32_16x16x32_bf16 v[132:135], a[36:39], v[112:115], v[132:135]
    v_fmac_f32 v189, v162, v162
    v_fmac_f32 v189, v163, v163
    v_mfma_f32_16x16x32_bf16 v[132:135], a[40:43], v[116:119], v[132:135]
    v_fmac_f32 v188, v184, v184
    v_fmac_f32 v188, v185, v185
    v_mfma_f32_16x16x32_bf16 v[132:135], a[44:47], v[128:131], v[132:135]
    v_fmac_f32 v188, v186, v186
    v_fmac_f32 v188, v187, v187
    v_mfma_f32_16x16x32_bf16 v[176:179], a[48:51], v[212:215], 0
    v_mfma_f32_16x16x32_bf16 v[176:179], a[52:55], v[196:199], v[176:179]
    v_mfma_f32_16x16x32_bf16 v[176:179], a[56:59], v[172:175], v[176:179]
    v_mfma_f32_16x16x32_bf16 v[176:179], a[60:63], v[112:115], v[176:179]
    v_mfma_f32_16x16x32_bf16 v[176:179], a[64:67], v[116:119], v[176:179]
    v_mfma_f32_16x16x32_bf16 v[176:179], a[68:71], v[128:131], v[176:179]
    v_fmac_f32 v189, v132, v132
    v_fmac_f32 v189, v133, v133
    v_mfma_f32_16x16x32_bf16 v[180:183], v[212:215], a[144:147], 0
    ds_read_b128 v[216:219], v5 offset:0
    ds_read_b128 v[220:223], v5 offset:16
    v_mfma_f32_16x16x32_bf16 v[180:183], v[196:199], a[148:151], v[180:183]
    ds_read_b128 v[224:227], v5 offset:48
    ds_read_b32 v169, v6 offset:192
    v_mfma_f32_16x16x32_bf16 v[180:183], v[172:175], a[152:155], v[180:183]
    v_fmac_f32 v189, v134, v134
    v_fmac_f32 v189, v135, v135
    v_mfma_f32_16x16x32_bf16 v[180:183], v[112:115], a[156:159], v[180:183]
    v_fmac_f32 v189, v176, v176
    v_fmac_f32 v189, v177, v177
    v_mfma_f32_16x16x32_bf16 v[180:183], v[116:119], a[160:163], v[180:183]
    v_fmac_f32 v189, v178, v178
    v_fmac_f32 v189, v179, v179
    v_mfma_f32_16x16x32_bf16 v[180:183], v[128:131], a[164:167], v[180:183]
    v_cvt_pk_bf16_f32 v36, v189, v188
    v_add_u32 v5, 336, v5
    v_mfma_f32_16x16x32_bf16 v[228:231], v[212:215], a[168:171], 0
    v_mfma_f32_16x16x32_bf16 v[232:235], v[32:35], v[36:39], 0
    v_mfma_f32_16x16x32_bf16 v[228:231], v[196:199], a[172:175], v[228:231]
    s_waitcnt lgkmcnt(2)
    v_mfma_f32_16x16x32_bf16 v[228:231], v[172:175], a[176:179], v[228:231]
    s_waitcnt lgkmcnt(0)
    v_cvt_pk_bf16_f32 v180, v180, v181
    v_cvt_pk_bf16_f32 v181, v182, v183
    v_mfma_f32_16x16x32_bf16 v[236:239], v[216:219], v[124:127], v[22:25]
    v_mfma_f32_16x16x32_bf16 v[236:239], v[220:223], v[140:143], v[236:239]
    v_rsq_f32 v233, v233
    v_mfma_f32_16x16x32_bf16 v[236:239], v[224:227], v[144:147], v[236:239]
    v_rsq_f32 v232, v232
    v_mfma_f32_16x16x32_bf16 v[228:231], v[112:115], a[180:183], v[228:231]
    v_mul_f32 v232, s31, v232
    v_mul_f32 v152, v233, v152
    v_mfma_f32_16x16x32_bf16 v[228:231], v[116:119], a[184:187], v[228:231]
    v_mul_f32 v153, v233, v153
    v_cvt_pk_bf16_f32 v152, v152, v153
    v_mfma_f32_16x16x32_bf16 v[228:231], v[128:131], a[188:191], v[228:231]
    v_mov_b32_dpp v169, v237 quad_perm:[0,1,2,3] row_mask:0x1 bank_mask:0xf
    v_mul_f32 v154, v233, v154
    v_mfma_f32_16x16x32_bf16 v[240:243], v[212:215], a[192:195], 0
    v_mul_f32 v155, v233, v155
    v_cvt_pk_bf16_f32 v153, v154, v155
    v_mfma_f32_16x16x32_bf16 v[240:243], v[196:199], a[196:199], v[240:243]
    v_mul_f32 v156, v233, v156
    v_mul_f32 v157, v233, v157
    v_mfma_f32_16x16x32_bf16 v[240:243], v[172:175], a[200:203], v[240:243]
    v_cvt_pk_bf16_f32 v212, v228, v229
    v_cvt_pk_bf16_f32 v213, v230, v231
    v_mfma_f32_16x16x32_bf16 v[240:243], v[112:115], a[204:207], v[240:243]
    v_cvt_pk_bf16_f32 v154, v156, v157
    v_mul_f32 v158, v233, v158
    v_mfma_f32_16x16x32_bf16 v[240:243], v[116:119], a[208:211], v[240:243]
    ds_read2_b32 v[182:183], v6 offset0:0 offset1:0
    ds_read2_b32 v[214:215], v6 offset0:16 offset1:16
    v_mfma_f32_16x16x32_bf16 v[240:243], v[128:131], a[212:215], v[240:243]
    ds_read2_b32 v[118:119], v6 offset0:32 offset1:32
    v_mul_f32 v159, v233, v159
    v_mfma_f32_16x16x32_bf16 v[112:115], v[164:167], v[124:127], v[44:47]
    v_cvt_pk_bf16_f32 v155, v158, v159
    v_mul_f32 v184, v233, v184
    v_mfma_f32_16x16x32_bf16 v[128:131], v[216:219], v[192:195], v[24:27]
    v_mul_f32 v185, v233, v185
    v_cvt_pk_bf16_f32 v158, v184, v185
    v_mfma_f32_16x16x32_bf16 v[172:175], v[152:155], v[124:127], v[48:51]
    v_cvt_pk_bf16_f32 v116, v240, v241
    v_cvt_pk_bf16_f32 v117, v242, v243
    v_mul_f32 v186, v233, v186
    v_mfma_f32_16x16x16_bf16 v[112:115], v[202:203], v[144:145], v[112:115]
    v_mul_f32 v187, v233, v187
    v_cvt_pk_bf16_f32 v159, v186, v187
    v_mul_f32 v160, v232, v160
    v_mul_f32 v161, v232, v161
    v_mfma_f32_16x16x16_bf16 v[172:175], v[158:159], v[144:145], v[172:175]
    v_cvt_pk_bf16_f32 v124, v160, v161
    v_mul_f32 v162, v232, v162
    v_mul_f32 v163, v232, v163
    v_cvt_pk_bf16_f32 v125, v162, v163
    v_mfma_f32_16x16x32_bf16 v[128:131], v[220:223], v[164:167], v[128:131]
    s_waitcnt lgkmcnt(1)
    v_mul_f32 v132, v232, v132
    v_mul_f32 v133, v232, v133
    v_mfma_f32_16x16x32_bf16 v[128:131], v[224:227], v[200:203], v[128:131]
    s_waitcnt lgkmcnt(0)
    v_cvt_pk_bf16_f32 v126, v132, v133
    v_mul_f32 v134, v232, v134
    v_mul_f32 v135, v232, v135
    v_mfma_f32_16x16x16_bf16 v[160:163], a[216:217], v[190:191], v[204:207]
    v_cvt_pk_bf16_f32 v127, v134, v135
    v_mul_f32 v176, v232, v176
    v_mul_f32 v177, v232, v177
    v_cvt_pk_bf16_f32 v156, v176, v177
    v_mfma_f32_16x16x32_bf16 v[132:135], v[216:219], v[124:127], v[26:29]
    v_mul_f32 v178, v232, v178
    v_mul_f32 v179, v232, v179
    v_mfma_f32_16x16x32_bf16 v[132:135], v[220:223], v[152:155], v[132:135]
    v_cvt_pk_bf16_f32 v157, v178, v179
    v_max3_f32 v144, v236, v148, v149
    v_max3_f32 v144, v144, v150, v151
    v_mfma_f32_16x16x32_bf16 v[132:135], v[224:227], v[156:159], v[132:135]
    v_max3_f32 v144, v144, v112, v113
    v_max3_f32 v144, v144, v114, v115
    v_max3_f32 v144, v144, v172, v173
    v_mfma_f32_16x16x16_bf16 v[176:179], a[240:241], v[190:191], v[204:207]
    v_max3_f32 v144, v144, v174, v175
    v_mov_b32 v145, v144
    v_mov_b32_dpp v169, v129 quad_perm:[0,1,2,3] row_mask:0x2 bank_mask:0xf
    v_mfma_f32_16x16x16_bf16 v[184:187], v[84:85], v[190:191], v[204:207]
    v_permlane32_swap_b32 v144, v145
    v_max_f32 v144, v144, v145
    v_mfma_f32_16x16x16_bf16 v[196:199], a[218:219], v[190:191], v[208:211]
    v_mov_b32 v145, v144
    v_mov_b32_dpp v169, v133 quad_perm:[0,1,2,3] row_mask:0x4 bank_mask:0xf
    v_mov_b32 v170, v169
    v_mfma_f32_16x16x16_bf16 v[204:207], a[242:243], v[190:191], v[208:211]
    v_permlane16_swap_b32 v144, v145
    v_max_f32 v144, v144, v145
    v_mfma_f32_16x16x16_bf16 v[216:219], v[86:87], v[190:191], v[208:211]
    v_sub_f32 v148, v148, v144
    v_exp_f32 v148, v148
    v_sub_f32 v149, v149, v144
    v_exp_f32 v149, v149
    v_sub_f32 v150, v150, v144
    v_cvt_pk_bf16_f32 v148, v148, v149
    v_exp_f32 v150, v150
    v_sub_f32 v151, v151, v144
    v_exp_f32 v151, v151
    v_sub_f32 v112, v112, v144
    v_cvt_pk_bf16_f32 v149, v150, v151
    v_exp_f32 v112, v112
    v_sub_f32 v113, v113, v144
    s_waitcnt vmcnt(0)
    s_barrier
    buffer_load_dwordx4 v10, s[8:11], 0 offen nt lds
    s_add_u32 m0, s28, 4096
    v_exp_f32 v113, v113
    v_mfma_f32_16x16x32_bf16 v[208:211], v[140:143], v[192:195], v[52:55]
    v_cvt_pk_bf16_f32 v150, v112, v113
    v_sub_f32 v114, v114, v144
    v_exp_f32 v114, v114
    v_sub_f32 v115, v115, v144
    v_exp_f32 v115, v115
    v_sub_f32 v172, v172, v144
    v_mfma_f32_16x16x16_bf16 v[208:211], v[146:147], v[200:201], v[208:211]
    v_cvt_pk_bf16_f32 v151, v114, v115
    buffer_load_dwordx4 v11, s[8:11], 0 offen nt lds
    s_add_u32 m0, s28, 8192
    v_exp_f32 v172, v172
    v_sub_f32 v173, v173, v144
    v_exp_f32 v173, v173
    v_mfma_f32_16x16x32_bf16 v[112:115], v[164:167], v[192:195], v[56:59]
    v_cvt_pk_bf16_f32 v36, v172, v173
    v_sub_f32 v174, v174, v144
    v_exp_f32 v174, v174
    v_sub_f32 v175, v175, v144
    v_exp_f32 v175, v175
    v_mfma_f32_16x16x32_bf16 v[220:223], v[152:155], v[192:195], v[60:63]
    buffer_load_dwordx4 v12, s[8:11], 0 offen nt lds
    v_cvt_pk_bf16_f32 v37, v174, v175
    v_sub_f32 v236, v236, v144
    v_mfma_f32_16x16x16_bf16 v[112:115], v[202:203], v[200:201], v[112:115]
    s_add_u32 m0, s28, 12288
    s_xor_b32 s28, s28, 65536
    v_max3_f32 v171, v128, v208, v209
    v_mfma_f32_16x16x16_bf16 v[220:223], v[158:159], v[200:201], v[220:223]
    v_exp_f32 v236, v236
    v_max3_f32 v171, v171, v210, v211
    v_cvt_pk_bf16_f32 v39, v236, 0
    v_max_f32_dpp v170, v170, v170 quad_perm:[1,0,3,2] row_mask:0xf bank_mask:0xf
    v_max3_f32 v171, v171, v112, v113
    v_mfma_f32_16x16x32_bf16 v[172:175], v[28:31], v[36:39], 0
    v_max3_f32 v171, v171, v114, v115
    v_max_f32_dpp v170, v170, v170 quad_perm:[2,3,0,1] row_mask:0xf bank_mask:0xf
    v_mfma_f32_16x16x32_bf16 v[172:175], v[28:31], v[148:151], v[172:175]
    buffer_load_dwordx4 v13, s[8:11], 0 offen nt lds
    v_max3_f32 v171, v171, v220, v221
    v_mfma_f32_16x16x32_bf16 v[192:195], v[180:183], v[36:39], 0
    s_mov_b32 m0, s29
    v_max3_f32 v171, v171, v222, v223
    v_mov_b32 v144, v171
    v_mfma_f32_16x16x32_bf16 v[192:195], v[120:123], v[148:151], v[192:195]
    s_xor_b32 s29, s29, s30
    v_permlane32_swap_b32 v171, v144
    v_mfma_f32_16x16x32_bf16 v[224:227], v[212:215], v[36:39], 0
    v_max_f32 v171, v171, v144
    v_mov_b32 v144, v171
    v_mfma_f32_16x16x32_bf16 v[224:227], v[108:111], v[148:151], v[224:227]
    v_rcp_f32 v172, v172
    v_mfma_f32_16x16x32_bf16 v[228:231], v[116:119], v[36:39], 0
    buffer_load_dwordx4 v14, s[8:11], 0 offen nt lds
    v_mul_f32 v192, v172, v192
    v_mfma_f32_16x16x32_bf16 v[228:231], v[136:139], v[148:151], v[228:231]
    v_permlane16_swap_b32 v171, v144
    v_max_f32 v171, v171, v144
    v_sub_f32 v208, v208, v171
    v_exp_f32 v208, v208
    v_sub_f32 v209, v209, v171
    v_exp_f32 v209, v209
    v_sub_f32 v210, v210, v171
    v_cvt_pk_bf16_f32 v148, v208, v209
    v_exp_f32 v210, v210
    v_sub_f32 v211, v211, v171
    v_exp_f32 v211, v211
    v_sub_f32 v112, v112, v171
    v_cvt_pk_bf16_f32 v149, v210, v211
    v_exp_f32 v112, v112
    v_sub_f32 v113, v113, v171
    v_exp_f32 v113, v113
    v_sub_f32 v114, v114, v171
    v_cvt_pk_bf16_f32 v150, v112, v113
    v_exp_f32 v114, v114
    v_sub_f32 v115, v115, v171
    v_exp_f32 v115, v115
    v_sub_f32 v220, v220, v171
    v_cvt_pk_bf16_f32 v151, v114, v115
    v_exp_f32 v220, v220
    v_sub_f32 v221, v221, v171
    v_exp_f32 v221, v221
    v_sub_f32 v222, v222, v171
    v_cvt_pk_bf16_f32 v36, v220, v221
    v_exp_f32 v222, v222
    v_sub_f32 v223, v223, v171
    v_exp_f32 v223, v223
    v_mfma_f32_16x16x32_bf16 v[208:211], v[140:143], v[124:127], v[64:67]
    v_cvt_pk_bf16_f32 v37, v222, v223
    v_sub_f32 v128, v128, v171
    v_mfma_f32_16x16x32_bf16 v[140:143], v[164:167], v[124:127], v[68:71]
    v_exp_f32 v128, v128
    v_mfma_f32_16x16x32_bf16 v[164:167], v[152:155], v[124:127], v[72:75]
    v_cvt_pk_bf16_f32 v39, v128, 0
    v_mul_f32 v193, v172, v193
    v_cvt_pk_bf16_f32 v112, v192, v193
    v_mfma_f32_16x16x32_bf16 v[128:131], v[28:31], v[36:39], 0
    v_mul_f32 v194, v172, v194
    v_mul_f32 v195, v172, v195
    v_mfma_f32_16x16x32_bf16 v[128:131], v[28:31], v[148:151], v[128:131]
    v_cvt_pk_bf16_f32 v113, v194, v195
    v_mul_f32 v224, v172, v224
    v_mfma_f32_16x16x32_bf16 v[152:155], v[180:183], v[36:39], 0
    v_mul_f32 v225, v172, v225
    v_cvt_pk_bf16_f32 v114, v224, v225
    v_mfma_f32_16x16x32_bf16 v[152:155], v[120:123], v[148:151], v[152:155]
    v_mul_f32 v226, v172, v226
    v_mul_f32 v227, v172, v227
    v_mfma_f32_16x16x32_bf16 v[192:195], v[212:215], v[36:39], 0
    v_cvt_pk_bf16_f32 v115, v226, v227
    v_mul_f32 v228, v172, v228
    v_mfma_f32_16x16x32_bf16 v[192:195], v[108:111], v[148:151], v[192:195]
    ds_write_b128 v3, v[112:115] offset:0
    v_mfma_f32_16x16x32_bf16 v[220:223], v[116:119], v[36:39], 0
    v_mul_f32 v229, v172, v229
    v_cvt_pk_bf16_f32 v188, v228, v229
    v_mfma_f32_16x16x32_bf16 v[220:223], v[136:139], v[148:151], v[220:223]
    v_mul_f32 v230, v172, v230
    v_mul_f32 v231, v172, v231
    v_cvt_pk_bf16_f32 v189, v230, v231
    v_mfma_f32_16x16x16_bf16 v[208:211], v[146:147], v[156:157], v[208:211]
    v_max_f32_dpp v170, v170, v170 row_half_mirror row_mask:0xf bank_mask:0xf
    v_cvt_pk_bf16_f32 v160, v160, v161
    v_accvgpr_write_b32 a216, v160
    v_mfma_f32_16x16x16_bf16 v[140:143], v[202:203], v[156:157], v[140:143]
    v_max_f32_dpp v170, v170, v170 row_mirror row_mask:0xf bank_mask:0xf
    v_mov_b32 v171, v170
    v_cvt_pk_bf16_f32 v162, v162, v163
    v_mfma_f32_16x16x16_bf16 v[164:167], v[158:159], v[156:157], v[164:167]
    ds_write_b64 v4, v[188:189] offset:4096
    v_permlane32_swap_b32 v170, v171
    v_max_f32 v170, v170, v171
    v_mov_b32 v171, v170
    v_accvgpr_write_b32 a217, v162
    v_cvt_pk_bf16_f32 v176, v176, v177
    v_permlane16_swap_b32 v170, v171
    v_max_f32 v170, v170, v171
    v_sub_f32 v169, v169, v170
    v_exp_f32 v169, v169
    v_accvgpr_write_b32 a240, v176
    v_cvt_pk_bf16_f32 v169, v169, v169
    ds_write_b16 v8, v169
    v_cvt_pk_bf16_f32 v178, v178, v179
    v_accvgpr_write_b32 a241, v178
    v_cvt_pk_bf16_f32 v84, v184, v185
    v_cvt_pk_bf16_f32 v85, v186, v187
    ds_read_b128 v[112:115], v168 offset:128
    v_cvt_pk_bf16_f32 v196, v196, v197
    v_accvgpr_write_b32 a218, v196
    v_cvt_pk_bf16_f32 v198, v198, v199
    v_accvgpr_write_b32 a219, v198
    v_cvt_pk_bf16_f32 v204, v204, v205
    v_accvgpr_write_b32 a242, v204
    v_cvt_pk_bf16_f32 v206, v206, v207
    v_accvgpr_write_b32 a243, v206
    v_cvt_pk_bf16_f32 v86, v216, v217
    v_cvt_pk_bf16_f32 v87, v218, v219
    ds_read_b128 v[124:127], v168 offset:192
    v_max3_f32 v188, v132, v208, v209
    v_max3_f32 v188, v188, v210, v211
    v_max3_f32 v188, v188, v140, v141
    v_max3_f32 v188, v188, v142, v143
    v_max3_f32 v188, v188, v164, v165
    v_max3_f32 v188, v188, v166, v167
    v_mov_b32 v189, v188
    v_rcp_f32 v128, v128
    v_add_u32 v6, 272, v6
    v_permlane32_swap_b32 v188, v189
    v_max_f32 v188, v188, v189
    v_mov_b32 v189, v188
    s_waitcnt lgkmcnt(1)
    v_mfma_f32_16x16x16_bf16 v[144:147], a[232:233], v[190:191], v[112:115]
    v_permlane16_swap_b32 v188, v189
    v_max_f32 v188, v188, v189
    v_mfma_f32_16x16x16_bf16 v[148:151], v[76:77], v[190:191], v[112:115]
    v_sub_f32 v208, v208, v188
    v_exp_f32 v208, v208
    v_mfma_f32_16x16x16_bf16 v[156:159], v[100:101], v[190:191], v[112:115]
    v_sub_f32 v209, v209, v188
    v_exp_f32 v209, v209
    s_waitcnt lgkmcnt(0)
    v_mfma_f32_16x16x16_bf16 v[160:163], a[220:221], v[190:191], v[124:127]
    v_cvt_pk_bf16_f32 v144, v144, v145
    v_accvgpr_write_b32 a232, v144
    v_cvt_pk_bf16_f32 v146, v146, v147
    v_mfma_f32_16x16x16_bf16 v[112:115], a[244:245], v[190:191], v[124:127]
    v_accvgpr_write_b32 a233, v146
    v_cvt_pk_bf16_f32 v76, v148, v149
    v_cvt_pk_bf16_f32 v77, v150, v151
    v_mfma_f32_16x16x16_bf16 v[144:147], v[88:89], v[190:191], v[124:127]
    v_cvt_pk_bf16_f32 v100, v156, v157
    v_cvt_pk_bf16_f32 v101, v158, v159
    ds_read_b128 v[156:159], v168 offset:256
    v_cvt_pk_bf16_f32 v160, v160, v161
    v_accvgpr_write_b32 a220, v160
    v_cvt_pk_bf16_f32 v162, v162, v163
    v_accvgpr_write_b32 a221, v162
    v_cvt_pk_bf16_f32 v112, v112, v113
    v_accvgpr_write_b32 a244, v112
    v_cvt_pk_bf16_f32 v114, v114, v115
    v_accvgpr_write_b32 a245, v114
    v_cvt_pk_bf16_f32 v88, v144, v145
    v_cvt_pk_bf16_f32 v89, v146, v147
    ds_read_b128 v[124:127], v168 offset:320
    v_cvt_pk_bf16_f32 v144, v208, v209
    v_sub_f32 v210, v210, v188
    v_exp_f32 v210, v210
    ds_read_b128 v[196:199], v0 offset:20480
    ds_read_b128 v[184:187], v1 offset:20480
    ds_read_b128 v[172:175], v0 offset:20608
    ds_read_b128 v[148:151], v1 offset:20608
    ds_read_b128 v[112:115], v0 offset:20736
    s_waitcnt lgkmcnt(6)
    v_mfma_f32_16x16x16_bf16 v[160:163], a[222:223], v[190:191], v[156:159]
    v_sub_f32 v211, v211, v188
    v_exp_f32 v211, v211
    v_mfma_f32_16x16x16_bf16 v[176:179], a[246:247], v[190:191], v[156:159]
    v_cvt_pk_bf16_f32 v145, v210, v211
    v_sub_f32 v140, v140, v188
    v_sub_f32 v141, v141, v188
    v_mfma_f32_16x16x16_bf16 v[200:203], v[90:91], v[190:191], v[156:159]
    ds_read_b128 v[228:231], v1 offset:20736
    s_waitcnt lgkmcnt(6)
    v_mfma_f32_16x16x16_bf16 v[208:211], a[234:235], v[190:191], v[124:127]
    v_cvt_pk_bf16_f32 v160, v160, v161
    v_accvgpr_write_b32 a222, v160
    v_cvt_pk_bf16_f32 v162, v162, v163
    v_mfma_f32_16x16x16_bf16 v[156:159], v[78:79], v[190:191], v[124:127]
    v_accvgpr_write_b32 a223, v162
    v_cvt_pk_bf16_f32 v176, v176, v177
    v_accvgpr_write_b32 a246, v176
    v_mfma_f32_16x16x16_bf16 v[160:163], v[102:103], v[190:191], v[124:127]
    s_waitcnt lgkmcnt(3)
    v_cvt_pk_bf16_f32 v178, v178, v179
    v_accvgpr_write_b32 a247, v178
    v_cvt_pk_bf16_f32 v90, v200, v201
    v_mfma_f32_16x16x32_bf16 v[204:207], a[72:75], v[196:199], 0
    s_waitcnt lgkmcnt(1)
    v_cvt_pk_bf16_f32 v91, v202, v203
    v_cvt_pk_bf16_f32 v208, v208, v209
    v_mfma_f32_16x16x32_bf16 v[204:207], a[76:79], v[184:187], v[204:207]
    ds_read_b128 v[124:127], v168 offset:384
    v_accvgpr_write_b32 a234, v208
    v_mfma_f32_16x16x32_bf16 v[204:207], a[80:83], v[172:175], v[204:207]
    v_cvt_pk_bf16_f32 v210, v210, v211
    v_accvgpr_write_b32 a235, v210
    v_mfma_f32_16x16x32_bf16 v[204:207], a[84:87], v[148:151], v[204:207]
    s_waitcnt lgkmcnt(1)
    v_cvt_pk_bf16_f32 v78, v156, v157
    v_cvt_pk_bf16_f32 v79, v158, v159
    v_mfma_f32_16x16x32_bf16 v[204:207], a[88:91], v[112:115], v[204:207]
    v_cvt_pk_bf16_f32 v102, v160, v161
    v_cvt_pk_bf16_f32 v103, v162, v163
    v_mfma_f32_16x16x32_bf16 v[204:207], a[92:95], v[228:231], v[204:207]
    ds_read_b128 v[156:159], v168 offset:448
    v_sub_f32 v142, v142, v188
    v_mfma_f32_16x16x32_bf16 v[176:179], a[96:99], v[196:199], 0
    v_exp_f32 v140, v140
    v_mfma_f32_16x16x32_bf16 v[176:179], a[100:103], v[184:187], v[176:179]
    v_exp_f32 v141, v141
    v_mfma_f32_16x16x32_bf16 v[176:179], a[104:107], v[172:175], v[176:179]
    v_cvt_pk_bf16_f32 v146, v140, v141
    v_sub_f32 v143, v143, v188
    v_mfma_f32_16x16x32_bf16 v[176:179], a[108:111], v[148:151], v[176:179]
    s_waitcnt lgkmcnt(1)
    v_exp_f32 v142, v142
    v_sub_f32 v164, v164, v188
    v_mfma_f32_16x16x16_bf16 v[160:163], a[224:225], v[190:191], v[124:127]
    v_exp_f32 v143, v143
    v_sub_f32 v165, v165, v188
    v_mfma_f32_16x16x16_bf16 v[200:203], a[248:249], v[190:191], v[124:127]
    v_cvt_pk_bf16_f32 v147, v142, v143
    v_exp_f32 v164, v164
    v_mfma_f32_16x16x16_bf16 v[140:143], v[92:93], v[190:191], v[124:127]
    v_exp_f32 v165, v165
    v_sub_f32 v166, v166, v188
    v_cvt_pk_bf16_f32 v160, v160, v161
    v_mfma_f32_16x16x32_bf16 v[176:179], a[112:115], v[112:115], v[176:179]
    s_waitcnt lgkmcnt(0)
    v_accvgpr_write_b32 a224, v160
    v_cvt_pk_bf16_f32 v162, v162, v163
    v_accvgpr_write_b32 a225, v162
    v_mfma_f32_16x16x16_bf16 v[124:127], a[226:227], v[190:191], v[156:159]
    v_cvt_pk_bf16_f32 v200, v200, v201
    v_accvgpr_write_b32 a248, v200
    v_cvt_pk_bf16_f32 v202, v202, v203
    v_mfma_f32_16x16x16_bf16 v[160:163], a[250:251], v[190:191], v[156:159]
    v_accvgpr_write_b32 a249, v202
    v_cvt_pk_bf16_f32 v92, v140, v141
    v_cvt_pk_bf16_f32 v93, v142, v143
    v_mfma_f32_16x16x16_bf16 v[140:143], v[94:95], v[190:191], v[156:159]
    v_cvt_pk_bf16_f32 v124, v124, v125
    v_accvgpr_write_b32 a226, v124
    v_cvt_pk_bf16_f32 v126, v126, v127
    v_accvgpr_write_b32 a227, v126
    v_mfma_f32_16x16x32_bf16 v[176:179], a[116:119], v[228:231], v[176:179]
    ds_read_b128 v[156:159], v168 offset:512
    v_cvt_pk_bf16_f32 v160, v160, v161
    v_mfma_f32_16x16x32_bf16 v[124:127], a[120:123], v[196:199], 0
    v_accvgpr_write_b32 a250, v160
    v_cvt_pk_bf16_f32 v162, v162, v163
    v_mfma_f32_16x16x32_bf16 v[124:127], a[124:127], v[184:187], v[124:127]
    v_accvgpr_write_b32 a251, v162
    v_cvt_pk_bf16_f32 v94, v140, v141
    v_mfma_f32_16x16x32_bf16 v[124:127], a[128:131], v[172:175], v[124:127]
    v_cvt_pk_bf16_f32 v95, v142, v143
    v_cvt_pk_bf16_f32 v36, v164, v165
    v_mfma_f32_16x16x32_bf16 v[124:127], a[132:135], v[148:151], v[124:127]
    ds_read_b128 v[140:143], v168 offset:576
    v_sub_f32 v167, v167, v188
    v_mfma_f32_16x16x32_bf16 v[124:127], a[136:139], v[112:115], v[124:127]
    v_exp_f32 v166, v166
    v_mfma_f32_16x16x32_bf16 v[124:127], a[140:143], v[228:231], v[124:127]
    v_exp_f32 v167, v167
    v_mfma_f32_16x16x32_bf16 v[216:219], a[0:3], v[196:199], 0
    ds_read_b128 v[160:163], v9
    ds_read_b128 v[200:203], v9 offset:64
    v_mfma_f32_16x16x32_bf16 v[216:219], a[4:7], v[184:187], v[216:219]
    s_waitcnt lgkmcnt(3)
    v_cvt_pk_bf16_f32 v37, v166, v167
    v_sub_f32 v132, v132, v188
    v_mul_f32 v152, v128, v152
    v_mfma_f32_16x16x16_bf16 v[164:167], a[236:237], v[190:191], v[156:159]
    v_exp_f32 v132, v132
    v_mul_f32 v153, v128, v153
    v_mfma_f32_16x16x16_bf16 v[208:211], v[80:81], v[190:191], v[156:159]
    v_cvt_pk_bf16_f32 v39, v132, 0
    v_cvt_pk_bf16_f32 v132, v152, v153
    v_mul_f32 v154, v128, v154
    v_mul_f32 v155, v128, v155
    v_mfma_f32_16x16x32_bf16 v[224:227], v[28:31], v[36:39], 0
    s_waitcnt lgkmcnt(2)
    v_cvt_pk_bf16_f32 v164, v164, v165
    v_accvgpr_write_b32 a236, v164
    v_mfma_f32_16x16x32_bf16 v[224:227], v[28:31], v[144:147], v[224:227]
    v_cvt_pk_bf16_f32 v166, v166, v167
    v_accvgpr_write_b32 a237, v166
    v_mfma_f32_16x16x32_bf16 v[164:167], v[180:183], v[36:39], 0
    v_cvt_pk_bf16_f32 v80, v208, v209
    v_cvt_pk_bf16_f32 v81, v210, v211
    v_mfma_f32_16x16x32_bf16 v[164:167], v[120:123], v[144:147], v[164:167]
    s_waitcnt lgkmcnt(0)
    v_cvt_pk_bf16_f32 v133, v154, v155
    v_mul_f32 v192, v128, v192
    v_mfma_f32_16x16x32_bf16 v[152:155], v[212:215], v[36:39], 0
    v_mul_f32 v193, v128, v193
    v_cvt_pk_bf16_f32 v134, v192, v193
    v_mfma_f32_16x16x32_bf16 v[152:155], v[108:111], v[144:147], v[152:155]
    v_mul_f32 v194, v128, v194
    v_mul_f32 v195, v128, v195
    v_mfma_f32_16x16x32_bf16 v[208:211], v[116:119], v[36:39], 0
    v_cvt_pk_bf16_f32 v135, v194, v195
    v_mul_f32 v220, v128, v220
    v_mfma_f32_16x16x32_bf16 v[208:211], v[136:139], v[144:147], v[208:211]
    ds_write_b128 v3, v[132:135] offset:6144
    v_mfma_f32_16x16x16_bf16 v[132:135], v[104:105], v[190:191], v[156:159]
    v_mul_f32 v221, v128, v221
    v_cvt_pk_bf16_f32 v188, v220, v221
    v_mul_f32 v222, v128, v222
    v_mfma_f32_16x16x16_bf16 v[144:147], a[228:229], v[190:191], v[140:143]
    v_mul_f32 v223, v128, v223
    v_cvt_pk_bf16_f32 v189, v222, v223
    v_fma_f32 v169, v204, v204, s32
    v_mfma_f32_16x16x16_bf16 v[128:131], a[252:253], v[190:191], v[140:143]
    v_cvt_pk_bf16_f32 v104, v132, v133
    v_cvt_pk_bf16_f32 v105, v134, v135
    v_fmac_f32 v169, v205, v205
    v_mfma_f32_16x16x16_bf16 v[132:135], v[96:97], v[190:191], v[140:143]
    v_cvt_pk_bf16_f32 v144, v144, v145
    v_accvgpr_write_b32 a228, v144
    v_cvt_pk_bf16_f32 v146, v146, v147
    v_accvgpr_write_b32 a229, v146
    v_mfma_f32_16x16x32_bf16 v[140:143], v[160:163], v[28:31], 0
    ds_read_b128 v[144:147], v168 offset:640
    v_cvt_pk_bf16_f32 v128, v128, v129
    v_mfma_f32_16x16x32_bf16 v[140:143], v[200:203], v[28:31], v[140:143]
    ds_write_b64 v4, v[188:189] offset:10240
    v_mfma_f32_16x16x32_bf16 v[156:159], v[160:163], v[120:123], 0
    v_accvgpr_write_b32 a252, v128
    v_cvt_pk_bf16_f32 v130, v130, v131
    v_mfma_f32_16x16x32_bf16 v[156:159], v[200:203], v[180:183], v[156:159]
    v_accvgpr_write_b32 a253, v130
    v_cvt_pk_bf16_f32 v96, v132, v133
    v_mfma_f32_16x16x32_bf16 v[120:123], v[160:163], v[108:111], 0
    v_cvt_pk_bf16_f32 v97, v134, v135
    v_fmac_f32 v169, v206, v206
    v_mfma_f32_16x16x32_bf16 v[120:123], v[200:203], v[212:215], v[120:123]
    ds_read_b128 v[108:111], v168 offset:704
    v_fmac_f32 v169, v207, v207
    v_mfma_f32_16x16x32_bf16 v[128:131], v[160:163], v[136:139], 0
    v_rcp_f32 v140, v140
    v_mfma_f32_16x16x32_bf16 v[128:131], v[200:203], v[116:119], v[128:131]
    s_waitcnt lgkmcnt(2)
    v_mul_f32 v156, v156, v140
    v_rcp_f32 v224, v224
    v_mfma_f32_16x16x16_bf16 v[116:119], a[230:231], v[190:191], v[144:147]
    v_mul_f32_dpp v156, v120, v140 quad_perm:[0,1,2,3] row_mask:0x2 bank_mask:0xf
    v_mul_f32 v164, v224, v164
    v_mul_f32 v165, v224, v165
    v_mfma_f32_16x16x16_bf16 v[120:123], a[254:255], v[190:191], v[144:147]
    v_mul_f32_dpp v156, v128, v140 quad_perm:[0,1,2,3] row_mask:0x4 bank_mask:0xf
    v_cvt_pk_bf16_f32 v156, v156, v156
    v_cvt_pk_bf16_f32 v128, v164, v165
    v_mfma_f32_16x16x16_bf16 v[132:135], v[98:99], v[190:191], v[144:147]
    v_cvt_pk_bf16_f32 v116, v116, v117
    v_accvgpr_write_b32 a230, v116
    v_cvt_pk_bf16_f32 v118, v118, v119
    v_accvgpr_write_b32 a231, v118
    v_mfma_f32_16x16x32_bf16 v[216:219], a[8:11], v[172:175], v[216:219]
    ds_write_b16 v7, v156
    v_mfma_f32_16x16x32_bf16 v[216:219], a[12:15], v[148:151], v[216:219]
    s_waitcnt lgkmcnt(1)
    v_cvt_pk_bf16_f32 v120, v120, v121
    v_accvgpr_write_b32 a254, v120
    v_cvt_pk_bf16_f32 v122, v122, v123
    v_mfma_f32_16x16x16_bf16 v[116:119], a[238:239], v[190:191], v[108:111]
    v_accvgpr_write_b32 a255, v122
    v_cvt_pk_bf16_f32 v98, v132, v133
    v_cvt_pk_bf16_f32 v99, v134, v135
    v_mfma_f32_16x16x16_bf16 v[120:123], v[82:83], v[190:191], v[108:111]
    v_mul_f32 v166, v224, v166
    v_mul_f32 v167, v224, v167
    v_cvt_pk_bf16_f32 v129, v166, v167
    v_mfma_f32_16x16x16_bf16 v[132:135], v[106:107], v[190:191], v[108:111]
    v_cvt_pk_bf16_f32 v116, v116, v117
    v_accvgpr_write_b32 a238, v116
    v_cvt_pk_bf16_f32 v118, v118, v119
    v_accvgpr_write_b32 a239, v118
    v_mfma_f32_16x16x32_bf16 v[216:219], a[16:19], v[112:115], v[216:219]
    v_cvt_pk_bf16_f32 v82, v120, v121
    v_cvt_pk_bf16_f32 v83, v122, v123
    v_mfma_f32_16x16x32_bf16 v[216:219], a[20:23], v[228:231], v[216:219]
    v_cvt_pk_bf16_f32 v106, v132, v133
    v_cvt_pk_bf16_f32 v107, v134, v135
    v_mfma_f32_16x16x32_bf16 v[160:163], a[24:27], v[196:199], 0
    v_mul_f32 v152, v224, v152
    v_mul_f32 v153, v224, v153
    v_mfma_f32_16x16x32_bf16 v[160:163], a[28:31], v[184:187], v[160:163]
    v_cvt_pk_bf16_f32 v130, v152, v153
    v_mul_f32 v154, v224, v154
    v_mfma_f32_16x16x32_bf16 v[160:163], a[32:35], v[172:175], v[160:163]
    v_mul_f32 v155, v224, v155
    v_cvt_pk_bf16_f32 v131, v154, v155
    v_mfma_f32_16x16x32_bf16 v[160:163], a[36:39], v[148:151], v[160:163]
    ds_write_b128 v3, v[128:131] offset:12288
    v_mfma_f32_16x16x32_bf16 v[160:163], a[40:43], v[112:115], v[160:163]
    v_mul_f32 v208, v224, v208
    v_mul_f32 v209, v224, v209
    v_mfma_f32_16x16x32_bf16 v[160:163], a[44:47], v[228:231], v[160:163]
    v_cvt_pk_bf16_f32 v208, v208, v209
    v_mul_f32 v210, v224, v210
    v_mfma_f32_16x16x32_bf16 v[116:119], a[48:51], v[196:199], 0
    v_mul_f32 v211, v224, v211
    v_cvt_pk_bf16_f32 v209, v210, v211
    v_mfma_f32_16x16x32_bf16 v[116:119], a[52:55], v[184:187], v[116:119]
    ds_write_b64 v4, v[208:209] offset:16384
    v_mfma_f32_16x16x32_bf16 v[116:119], a[56:59], v[172:175], v[116:119]
    v_add_u32 v7, 16, v7
    v_fmac_f32 v169, v176, v176
    v_mfma_f32_16x16x32_bf16 v[116:119], a[60:63], v[148:151], v[116:119]
    v_fmac_f32 v169, v177, v177
    v_fmac_f32 v169, v178, v178
    v_mfma_f32_16x16x32_bf16 v[116:119], a[64:67], v[112:115], v[116:119]
    v_fmac_f32 v169, v179, v179
    v_fmac_f32 v169, v124, v124
    v_mfma_f32_16x16x32_bf16 v[116:119], a[68:71], v[228:231], v[116:119]
    v_fmac_f32 v169, v125, v125
    v_fmac_f32 v169, v126, v126
    v_mfma_f32_16x16x32_bf16 v[128:131], v[196:199], a[144:147], 0
    v_fmac_f32 v169, v127, v127
    v_fma_f32 v168, v216, v216, s32
    v_mfma_f32_16x16x32_bf16 v[128:131], v[184:187], a[148:151], v[128:131]
    v_fmac_f32 v168, v217, v217
    v_fmac_f32 v168, v218, v218
    v_mfma_f32_16x16x32_bf16 v[128:131], v[172:175], a[152:155], v[128:131]
    s_waitcnt lgkmcnt(0)
    v_fmac_f32 v168, v219, v219
    v_xor_b32 v3, 65536, v3
    v_mfma_f32_16x16x32_bf16 v[128:131], v[148:151], a[156:159], v[128:131]
    s_barrier
    v_xor_b32 v4, 65536, v4
    v_mfma_f32_16x16x32_bf16 v[128:131], v[112:115], a[160:163], v[128:131]
    v_mfma_f32_16x16x32_bf16 v[128:131], v[228:231], a[164:167], v[128:131]
L_go:
    s_waitcnt lgkmcnt(0)
    s_cmp_eq_u32 s17, 1
    s_cbranch_scc1 L_drain
    s_cmp_gt_u32 s37, 0x42000000
    s_cbranch_scc1 L_safe
    s_cmp_eq_u32 s16, 1
    s_cbranch_scc1 L_loop_fast1
    s_cmp_eq_u32 s16, 2
    s_cbranch_scc1 L_loop_fast2
    s_cmp_eq_u32 s16, 3
    s_cbranch_scc1 L_loop_fast3
    s_branch L_loop_fast0
.p2align 6
L_loop_fast0:
    v_mfma_f32_16x16x32_bf16 v[164:167], v[196:199], a[168:171], 0
    s_add_u32 s12, s42, s27
    ds_read_b128 v[144:147], v2 offset:18432
    ds_read_b128 v[192:195], v2 offset:19456
    v_mfma_f32_16x16x32_bf16 v[164:167], v[184:187], a[172:175], v[164:167]
    s_addc_u32 s13, s43, 0
    v_fmac_f32 v168, v160, v160
    v_fmac_f32 v168, v161, v161
    v_mfma_f32_16x16x32_bf16 v[164:167], v[172:175], a[176:179], v[164:167]
    s_sub_u32 s14, s36, s27
    v_fmac_f32 v168, v162, v162
    v_fmac_f32 v168, v163, v163
    v_mfma_f32_16x16x32_bf16 v[164:167], v[148:151], a[180:183], v[164:167]
    s_cmp_ge_u32 s18, 2
    ds_read_b128 v[120:123], v0 offset:26624
    v_fmac_f32 v168, v116, v116
    v_mfma_f32_16x16x32_bf16 v[164:167], v[112:115], a[184:187], v[164:167]
    s_cselect_b32 s14, s14, 0
    ds_read_b128 v[188:191], v1 offset:26624
    v_fmac_f32 v168, v117, v117
    v_mfma_f32_16x16x32_bf16 v[164:167], v[228:231], a[188:191], v[164:167]
    s_add_u32 s34, s18, 2
    ds_read_b128 v[248:251], v0 offset:26752
    v_fmac_f32 v168, v118, v118
    v_mfma_f32_16x16x32_bf16 v[140:143], v[196:199], a[192:195], 0
    s_add_u32 s8, s40, s23
    ds_read_b128 v[224:227], v1 offset:26752
    v_fmac_f32 v168, v119, v119
    v_mfma_f32_16x16x32_bf16 v[140:143], v[184:187], a[196:199], v[140:143]
    s_addc_u32 s9, s41, 0
    ds_read_b128 v[184:187], v0 offset:26880
    v_cvt_pk_bf16_f32 v36, v168, v169
    v_mfma_f32_16x16x32_bf16 v[140:143], v[172:175], a[200:203], v[140:143]
    s_waitcnt lgkmcnt(5)
    ds_read_b128 v[172:175], v1 offset:26880
    v_cvt_pk_bf16_f32 v128, v128, v129
    v_mfma_f32_16x16x32_bf16 v[168:171], v[32:35], v[36:39], 0
    s_sub_u32 s10, s36, s23
    v_cvt_pk_bf16_f32 v129, v130, v131
    v_cvt_pk_bf16_f32 v164, v164, v165
    v_mfma_f32_16x16x32_bf16 v[240:243], v[32:35], v[144:147], 0
    s_cmp_lt_u32 s34, s17
    v_cvt_pk_bf16_f32 v165, v166, v167
    s_cselect_b32 s10, s10, 0
    v_mfma_f32_16x16x32_bf16 v[240:243], v[32:35], v[192:195], v[240:243]
    s_waitcnt lgkmcnt(5)
    v_rsq_f32 v169, v169
    v_mfma_f32_16x16x32_bf16 v[140:143], v[148:151], a[204:207], v[140:143]
    s_add_u32 m0, s28, 0
    v_rsq_f32 v168, v168
    v_mfma_f32_16x16x32_bf16 v[140:143], v[112:115], a[208:211], v[140:143]
    s_mov_b32 s27, s26
    v_mul_f32 v168, s31, v168
    v_mul_f32 v204, v169, v204
    v_mfma_f32_16x16x32_bf16 v[140:143], v[228:231], a[212:215], v[140:143]
    s_mov_b32 s26, s25
    v_mul_f32 v205, v169, v205
    v_cvt_pk_bf16_f32 v204, v204, v205
    v_mfma_f32_16x16x32_bf16 v[112:115], a[72:75], v[120:123], 0
    s_waitcnt lgkmcnt(1)
    v_mul_f32 v206, v169, v206
    v_mul_f32 v207, v169, v207
    v_mfma_f32_16x16x32_bf16 v[112:115], a[76:79], v[188:191], v[112:115]
    s_mov_b32 s25, s24
    v_cvt_pk_bf16_f32 v144, v140, v141
    v_cvt_pk_bf16_f32 v145, v142, v143
    v_mfma_f32_16x16x32_bf16 v[112:115], a[80:83], v[248:251], v[112:115]
    s_mov_b32 s24, s23
    v_cvt_pk_bf16_f32 v205, v206, v207
    v_mul_f32 v176, v169, v176
    v_mfma_f32_16x16x32_bf16 v[112:115], a[84:87], v[224:227], v[112:115]
    s_waitcnt lgkmcnt(0)
    v_mul_f32 v177, v169, v177
    v_cvt_pk_bf16_f32 v206, v176, v177
    v_mfma_f32_16x16x32_bf16 v[112:115], a[88:91], v[184:187], v[112:115]
    v_mul_f32 v178, v169, v178
    v_mul_f32 v179, v169, v179
    v_mfma_f32_16x16x32_bf16 v[112:115], a[92:95], v[172:175], v[112:115]
    v_cvt_pk_bf16_f32 v207, v178, v179
    v_mul_f32 v124, v169, v124
    v_mfma_f32_16x16x32_bf16 v[148:151], a[96:99], v[120:123], 0
    v_mul_f32 v125, v169, v125
    v_cvt_pk_bf16_f32 v194, v124, v125
    v_mfma_f32_16x16x32_bf16 v[148:151], a[100:103], v[188:191], v[148:151]
    v_mul_f32 v126, v169, v126
    v_mul_f32 v127, v169, v127
    v_mfma_f32_16x16x32_bf16 v[148:151], a[104:107], v[248:251], v[148:151]
    v_cvt_pk_bf16_f32 v195, v126, v127
    v_mul_f32 v216, v168, v216
    v_mfma_f32_16x16x32_bf16 v[148:151], a[108:111], v[224:227], v[148:151]
    v_mul_f32 v217, v168, v217
    v_cvt_pk_bf16_f32 v196, v216, v217
    v_mfma_f32_16x16x32_bf16 v[148:151], a[112:115], v[184:187], v[148:151]
    v_mul_f32 v218, v168, v218
    v_mul_f32 v219, v168, v219
    v_mfma_f32_16x16x32_bf16 v[148:151], a[116:119], v[172:175], v[148:151]
    v_cvt_pk_bf16_f32 v197, v218, v219
    v_mul_f32 v160, v168, v160
    v_mfma_f32_16x16x32_bf16 v[228:231], a[120:123], v[120:123], 0
    v_mul_f32 v161, v168, v161
    v_cvt_pk_bf16_f32 v198, v160, v161
    v_mfma_f32_16x16x32_bf16 v[228:231], a[124:127], v[188:191], v[228:231]
    v_mul_f32 v162, v168, v162
    v_mul_f32 v163, v168, v163
    v_mfma_f32_16x16x32_bf16 v[228:231], a[128:131], v[248:251], v[228:231]
    v_cvt_pk_bf16_f32 v199, v162, v163
    v_mul_f32 v116, v168, v116
    v_mfma_f32_16x16x32_bf16 v[228:231], a[132:135], v[224:227], v[228:231]
    v_mul_f32 v117, v168, v117
    v_cvt_pk_bf16_f32 v192, v116, v117
    v_mfma_f32_16x16x32_bf16 v[228:231], a[136:139], v[184:187], v[228:231]
    v_mul_f32 v118, v168, v118
    v_mul_f32 v119, v168, v119
    v_mfma_f32_16x16x32_bf16 v[228:231], a[140:143], v[172:175], v[228:231]
    v_cvt_pk_bf16_f32 v193, v118, v119
    v_fma_f32 v130, v112, v112, s32
    v_mfma_f32_16x16x32_bf16 v[212:215], a[0:3], v[120:123], 0
    v_fmac_f32 v130, v113, v113
    v_fmac_f32 v130, v114, v114
    v_mfma_f32_16x16x32_bf16 v[212:215], a[4:7], v[188:191], v[212:215]
    v_fmac_f32 v130, v115, v115
    v_fmac_f32 v130, v148, v148
    v_mfma_f32_16x16x32_bf16 v[212:215], a[8:11], v[248:251], v[212:215]
    v_fmac_f32 v130, v149, v149
    v_fmac_f32 v130, v150, v150
    v_mfma_f32_16x16x32_bf16 v[212:215], a[12:15], v[224:227], v[212:215]
    v_fmac_f32 v130, v151, v151
    v_fmac_f32 v130, v228, v228
    v_mfma_f32_16x16x32_bf16 v[212:215], a[16:19], v[184:187], v[212:215]
    v_fmac_f32 v130, v229, v229
    v_fmac_f32 v130, v230, v230
    v_mfma_f32_16x16x32_bf16 v[212:215], a[20:23], v[172:175], v[212:215]
    v_fmac_f32 v130, v231, v231
    v_mul_f32 v142, 0x3baaaaab, v240
    v_mfma_f32_16x16x32_bf16 v[232:235], a[24:27], v[120:123], 0
    v_rsq_f32 v142, v142
    v_mfma_f32_16x16x32_bf16 v[232:235], a[28:31], v[188:191], v[232:235]
    v_mul_f32 v147, 0x3baaaaab, v241
    v_mul_f32 v146, 0x3baaaaab, v242
    v_mfma_f32_16x16x32_bf16 v[232:235], a[32:35], v[248:251], v[232:235]
    v_fma_f32 v131, v212, v212, s32
    v_fmac_f32 v131, v213, v213
    v_mfma_f32_16x16x32_bf16 v[232:235], a[36:39], v[224:227], v[232:235]
    v_fmac_f32 v131, v214, v214
    v_fmac_f32 v131, v215, v215
    v_mfma_f32_16x16x32_bf16 v[232:235], a[40:43], v[184:187], v[232:235]
    v_rsq_f32 v147, v147
    v_mfma_f32_16x16x32_bf16 v[232:235], a[44:47], v[172:175], v[232:235]
    v_mul_f32 v136, v147, v136
    v_mul_f32 v137, v147, v137
    v_mfma_f32_16x16x32_bf16 v[240:243], a[48:51], v[120:123], 0
    v_cvt_pk_bf16_f32 v176, v136, v137
    v_mul_f32 v138, v147, v138
    v_mfma_f32_16x16x32_bf16 v[240:243], a[52:55], v[188:191], v[240:243]
    v_mul_f32 v139, v147, v139
    v_cvt_pk_bf16_f32 v177, v138, v139
    v_mfma_f32_16x16x32_bf16 v[240:243], a[56:59], v[248:251], v[240:243]
    v_fmac_f32 v131, v232, v232
    v_fmac_f32 v131, v233, v233
    v_mfma_f32_16x16x32_bf16 v[240:243], a[60:63], v[224:227], v[240:243]
    v_fmac_f32 v131, v234, v234
    v_fmac_f32 v131, v235, v235
    v_mfma_f32_16x16x32_bf16 v[240:243], a[64:67], v[184:187], v[240:243]
    v_mul_f32 v208, v147, v208
    v_mul_f32 v209, v147, v209
    v_mfma_f32_16x16x32_bf16 v[240:243], a[68:71], v[172:175], v[240:243]
    v_cvt_pk_bf16_f32 v178, v208, v209
    v_mul_f32 v210, v147, v210
    v_mfma_f32_16x16x32_bf16 v[216:219], v[120:123], a[144:147], 0
    v_mul_f32 v211, v147, v211
    v_cvt_pk_bf16_f32 v179, v210, v211
    v_mfma_f32_16x16x32_bf16 v[216:219], v[188:191], a[148:151], v[216:219]
    buffer_store_dwordx4 v[176:179], v16, s[12:15], 0 offen
    v_mul_f32 v156, v147, v156
    v_fmac_f32 v131, v240, v240
    v_fmac_f32 v131, v241, v241
    v_fmac_f32 v131, v242, v242
    v_mfma_f32_16x16x32_bf16 v[216:219], v[248:251], a[152:155], v[216:219]
    v_fmac_f32 v131, v243, v243
    v_cvt_pk_bf16_f32 v36, v131, v130
    v_mfma_f32_16x16x32_bf16 v[216:219], v[224:227], a[156:159], v[216:219]
    v_mul_f32 v157, v147, v157
    v_cvt_pk_bf16_f32 v118, v156, v157
    v_mfma_f32_16x16x32_bf16 v[136:139], v[32:35], v[36:39], 0
    v_mul_f32 v158, v147, v158
    v_mul_f32 v159, v147, v159
    v_mfma_f32_16x16x32_bf16 v[216:219], v[184:187], a[160:163], v[216:219]
    v_cvt_pk_bf16_f32 v119, v158, v159
    v_mul_f32 v180, v142, v180
    v_mfma_f32_16x16x32_bf16 v[216:219], v[172:175], a[164:167], v[216:219]
    v_rsq_f32 v146, v146
    v_mfma_f32_16x16x32_bf16 v[168:171], v[120:123], a[168:171], 0
    v_mul_f32 v200, v146, v200
    v_mul_f32 v201, v146, v201
    v_mfma_f32_16x16x32_bf16 v[168:171], v[188:191], a[172:175], v[168:171]
    v_cvt_pk_bf16_f32 v200, v200, v201
    v_mul_f32 v202, v146, v202
    v_mfma_f32_16x16x32_bf16 v[168:171], v[248:251], a[176:179], v[168:171]
    v_cvt_pk_bf16_f32 v130, v216, v217
    v_cvt_pk_bf16_f32 v131, v218, v219
    v_mfma_f32_16x16x32_bf16 v[168:171], v[224:227], a[180:183], v[168:171]
    ds_read_b128 v[176:179], v0 offset:32768
    v_mul_f32 v203, v146, v203
    v_mfma_f32_16x16x32_bf16 v[168:171], v[184:187], a[184:187], v[168:171]
    ds_read_b128 v[160:163], v1 offset:32768
    v_cvt_pk_bf16_f32 v201, v202, v203
    v_mfma_f32_16x16x32_bf16 v[168:171], v[172:175], a[188:191], v[168:171]
    ds_read_b128 v[208:211], v0 offset:32896
    v_mul_f32 v244, v146, v244
    v_mfma_f32_16x16x32_bf16 v[156:159], v[120:123], a[192:195], 0
    ds_read_b128 v[216:219], v1 offset:32896
    v_mul_f32 v245, v146, v245
    v_mfma_f32_16x16x32_bf16 v[156:159], v[188:191], a[196:199], v[156:159]
    ds_read_b128 v[124:127], v0 offset:33024
    v_cvt_pk_bf16_f32 v202, v244, v245
    v_mfma_f32_16x16x32_bf16 v[156:159], v[248:251], a[200:203], v[156:159]
    ds_read_b128 v[120:123], v1 offset:33024
    v_mul_f32 v246, v146, v246
    v_mfma_f32_16x16x32_bf16 v[156:159], v[224:227], a[204:207], v[156:159]
    v_mul_f32 v247, v146, v247
    v_cvt_pk_bf16_f32 v203, v246, v247
    v_mfma_f32_16x16x32_bf16 v[156:159], v[184:187], a[208:211], v[156:159]
    v_mul_f32 v132, v146, v132
    v_mul_f32 v133, v146, v133
    v_mfma_f32_16x16x32_bf16 v[156:159], v[172:175], a[212:215], v[156:159]
    s_waitcnt lgkmcnt(5)
    buffer_store_dwordx4 v[200:203], v17, s[12:15], 0 offen
    v_cvt_pk_bf16_f32 v116, v132, v133
    v_mul_f32 v134, v146, v134
    v_mul_f32 v135, v146, v135
    v_cvt_pk_bf16_f32 v117, v134, v135
    v_mfma_f32_16x16x32_bf16 v[200:203], a[72:75], v[176:179], 0
    s_waitcnt lgkmcnt(3)
    v_rsq_f32 v137, v137
    v_mfma_f32_16x16x32_bf16 v[200:203], a[76:79], v[160:163], v[200:203]
    s_waitcnt lgkmcnt(2)
    v_rsq_f32 v136, v136
    v_mfma_f32_16x16x32_bf16 v[200:203], a[80:83], v[208:211], v[200:203]
    s_waitcnt lgkmcnt(1)
    v_mul_f32 v136, s31, v136
    v_cvt_pk_bf16_f32 v166, v168, v169
    v_mfma_f32_16x16x32_bf16 v[200:203], a[84:87], v[216:219], v[200:203]
    s_waitcnt lgkmcnt(0)
    v_cvt_pk_bf16_f32 v167, v170, v171
    v_cvt_pk_bf16_f32 v146, v156, v157
    v_mfma_f32_16x16x32_bf16 v[200:203], a[88:91], v[124:127], v[200:203]
    v_cvt_pk_bf16_f32 v147, v158, v159
    v_mul_f32 v112, v137, v112
    v_mfma_f32_16x16x32_bf16 v[200:203], a[92:95], v[120:123], v[200:203]
    v_mul_f32 v113, v137, v113
    v_cvt_pk_bf16_f32 v184, v112, v113
    v_mfma_f32_16x16x32_bf16 v[168:171], a[96:99], v[176:179], 0
    v_mul_f32 v114, v137, v114
    v_mul_f32 v115, v137, v115
    v_mfma_f32_16x16x32_bf16 v[168:171], a[100:103], v[160:163], v[168:171]
    v_cvt_pk_bf16_f32 v185, v114, v115
    v_mul_f32 v148, v137, v148
    v_mfma_f32_16x16x32_bf16 v[168:171], a[104:107], v[208:211], v[168:171]
    v_mul_f32 v149, v137, v149
    v_cvt_pk_bf16_f32 v186, v148, v149
    v_mfma_f32_16x16x32_bf16 v[168:171], a[108:111], v[216:219], v[168:171]
    v_mul_f32 v150, v137, v150
    v_mul_f32 v151, v137, v151
    v_mfma_f32_16x16x32_bf16 v[168:171], a[112:115], v[124:127], v[168:171]
    s_waitcnt vmcnt(2)
    v_cvt_pk_bf16_f32 v187, v150, v151
    v_mul_f32 v228, v137, v228
    v_mfma_f32_16x16x32_bf16 v[168:171], a[116:119], v[120:123], v[168:171]
    s_barrier
    v_mul_f32 v229, v137, v229
    v_cvt_pk_bf16_f32 v174, v228, v229
    v_mfma_f32_16x16x32_bf16 v[112:115], a[120:123], v[176:179], 0
    s_nop 0
    v_mul_f32 v230, v137, v230
    v_mul_f32 v231, v137, v231
    v_mfma_f32_16x16x32_bf16 v[112:115], a[124:127], v[160:163], v[112:115]
    s_nop 0
    v_cvt_pk_bf16_f32 v175, v230, v231
    v_mul_f32 v212, v136, v212
    v_mfma_f32_16x16x32_bf16 v[112:115], a[128:131], v[208:211], v[112:115]
    s_nop 0
    v_mul_f32 v213, v136, v213
    v_cvt_pk_bf16_f32 v132, v212, v213
    v_mfma_f32_16x16x32_bf16 v[112:115], a[132:135], v[216:219], v[112:115]
    v_mul_f32 v214, v136, v214
    v_mul_f32 v215, v136, v215
    v_mfma_f32_16x16x32_bf16 v[112:115], a[136:139], v[124:127], v[112:115]
    buffer_load_dwordx4 v10, s[8:11], 0 offen nt lds
    v_cvt_pk_bf16_f32 v133, v214, v215
    v_mfma_f32_16x16x32_bf16 v[112:115], a[140:143], v[120:123], v[112:115]
    s_add_u32 m0, s28, 4096
    v_mul_f32 v232, v136, v232
    v_mul_f32 v233, v136, v233
    v_mfma_f32_16x16x32_bf16 v[188:191], a[0:3], v[176:179], 0
    v_cvt_pk_bf16_f32 v134, v232, v233
    v_mul_f32 v234, v136, v234
    v_mfma_f32_16x16x32_bf16 v[188:191], a[4:7], v[160:163], v[188:191]
    v_mul_f32 v235, v136, v235
    v_cvt_pk_bf16_f32 v135, v234, v235
    v_mfma_f32_16x16x32_bf16 v[188:191], a[8:11], v[208:211], v[188:191]
    v_mul_f32 v240, v136, v240
    v_mul_f32 v241, v136, v241
    v_mfma_f32_16x16x32_bf16 v[188:191], a[12:15], v[216:219], v[188:191]
    buffer_load_dwordx4 v11, s[8:11], 0 offen nt lds
    v_cvt_pk_bf16_f32 v172, v240, v241
    v_mfma_f32_16x16x32_bf16 v[188:191], a[16:19], v[124:127], v[188:191]
    s_add_u32 m0, s28, 8192
    v_mul_f32 v242, v136, v242
    v_mul_f32 v243, v136, v243
    v_mfma_f32_16x16x32_bf16 v[188:191], a[20:23], v[120:123], v[188:191]
    v_cvt_pk_bf16_f32 v173, v242, v243
    v_fma_f32 v140, v200, v200, s32
    v_mfma_f32_16x16x32_bf16 v[136:139], a[24:27], v[176:179], 0
    v_fmac_f32 v140, v201, v201
    v_fmac_f32 v140, v202, v202
    v_mfma_f32_16x16x32_bf16 v[136:139], a[28:31], v[160:163], v[136:139]
    v_fmac_f32 v140, v203, v203
    v_fmac_f32 v140, v168, v168
    v_mfma_f32_16x16x32_bf16 v[136:139], a[32:35], v[208:211], v[136:139]
    buffer_load_dwordx4 v12, s[8:11], 0 offen nt lds
    v_fma_f32 v141, v188, v188, s32
    v_mfma_f32_16x16x32_bf16 v[136:139], a[36:39], v[216:219], v[136:139]
    s_add_u32 m0, s28, 12288
    v_fmac_f32 v141, v189, v189
    v_fmac_f32 v141, v190, v190
    v_mfma_f32_16x16x32_bf16 v[136:139], a[40:43], v[124:127], v[136:139]
    s_xor_b32 s28, s28, 65536
    v_fmac_f32 v141, v191, v191
    v_fmac_f32 v140, v169, v169
    v_mfma_f32_16x16x32_bf16 v[136:139], a[44:47], v[120:123], v[136:139]
    v_fmac_f32 v140, v170, v170
    v_fmac_f32 v140, v171, v171
    v_mfma_f32_16x16x32_bf16 v[148:151], a[48:51], v[176:179], 0
    v_fmac_f32 v140, v112, v112
    v_fmac_f32 v140, v113, v113
    v_mfma_f32_16x16x32_bf16 v[148:151], a[52:55], v[160:163], v[148:151]
    buffer_load_dwordx4 v13, s[8:11], 0 offen nt lds
    v_fmac_f32 v140, v114, v114
    v_mfma_f32_16x16x32_bf16 v[148:151], a[56:59], v[208:211], v[148:151]
    s_mov_b32 m0, s29
    v_fmac_f32 v141, v136, v136
    v_fmac_f32 v141, v137, v137
    v_mfma_f32_16x16x32_bf16 v[148:151], a[60:63], v[216:219], v[148:151]
    s_xor_b32 s29, s29, s30
    v_fmac_f32 v141, v138, v138
    v_fmac_f32 v141, v139, v139
    v_mfma_f32_16x16x32_bf16 v[148:151], a[64:67], v[124:127], v[148:151]
    s_add_u32 s19, s19, s20
    v_fmac_f32 v140, v115, v115
    v_mul_f32 v181, v142, v181
    v_mfma_f32_16x16x32_bf16 v[148:151], a[68:71], v[120:123], v[148:151]
    s_add_u32 s23, s23, s21
    v_cvt_pk_bf16_f32 v156, v180, v181
    v_mul_f32 v182, v142, v182
    v_mfma_f32_16x16x32_bf16 v[220:223], v[176:179], a[144:147], 0
    s_cmp_ge_u32 s19, 72
    ds_read_b128 v[212:215], v5 offset:0
    ds_read_b128 v[224:227], v5 offset:16
    v_mfma_f32_16x16x32_bf16 v[220:223], v[160:163], a[148:151], v[220:223]
    s_cselect_b32 s34, 72, 0
    ds_read_b128 v[228:231], v5 offset:48
    ds_read_b32 v143, v6 offset:192
    v_mfma_f32_16x16x32_bf16 v[220:223], v[208:211], a[152:155], v[220:223]
    s_cselect_b32 s35, s22, 0
    buffer_store_dwordx2 v[116:117], v20, s[12:15], 0 offen
    v_fmac_f32 v141, v148, v148
    v_fmac_f32 v141, v149, v149
    v_mfma_f32_16x16x32_bf16 v[220:223], v[216:219], a[156:159], v[220:223]
    s_sub_u32 s19, s19, s34
    v_fmac_f32 v141, v150, v150
    v_fmac_f32 v141, v151, v151
    v_mfma_f32_16x16x32_bf16 v[220:223], v[124:127], a[160:163], v[220:223]
    s_add_u32 s23, s23, s35
    v_cvt_pk_bf16_f32 v36, v141, v140
    v_mul_f32 v183, v142, v183
    v_mfma_f32_16x16x32_bf16 v[220:223], v[120:123], a[164:167], v[220:223]
    s_add_u32 s18, s18, 1
    v_cvt_pk_bf16_f32 v157, v182, v183
    v_mul_f32 v108, v142, v108
    v_mfma_f32_16x16x32_bf16 v[180:183], v[32:35], v[36:39], 0
    s_cmp_lt_u32 s18, s17
    v_mul_f32 v109, v142, v109
    v_cvt_pk_bf16_f32 v158, v108, v109
    v_mfma_f32_16x16x32_bf16 v[232:235], v[176:179], a[168:171], 0
    s_waitcnt lgkmcnt(3)
    v_cvt_pk_bf16_f32 v116, v220, v221
    v_cvt_pk_bf16_f32 v117, v222, v223
    v_mfma_f32_16x16x32_bf16 v[220:223], v[212:215], v[196:199], v[22:25]
    s_waitcnt lgkmcnt(1)
    v_rsq_f32 v181, v181
    v_mfma_f32_16x16x32_bf16 v[220:223], v[224:227], v[204:207], v[220:223]
    s_waitcnt lgkmcnt(0)
    v_rsq_f32 v180, v180
    v_mfma_f32_16x16x32_bf16 v[220:223], v[228:231], v[192:195], v[220:223]
    v_mul_f32 v180, s31, v180
    v_mul_f32 v200, v181, v200
    v_mfma_f32_16x16x32_bf16 v[236:239], v[212:215], v[132:135], v[24:27]
    v_mul_f32 v201, v181, v201
    v_cvt_pk_bf16_f32 v200, v200, v201
    v_mfma_f32_16x16x32_bf16 v[236:239], v[224:227], v[184:187], v[236:239]
    v_mul_f32 v202, v181, v202
    v_mul_f32 v203, v181, v203
    v_mfma_f32_16x16x32_bf16 v[236:239], v[228:231], v[172:175], v[236:239]
    v_mov_b32_dpp v143, v221 quad_perm:[0,1,2,3] row_mask:0x1 bank_mask:0xf
    v_cvt_pk_bf16_f32 v201, v202, v203
    v_mfma_f32_16x16x32_bf16 v[232:235], v[160:163], a[172:175], v[232:235]
    v_mul_f32 v168, v181, v168
    v_mul_f32 v169, v181, v169
    v_mfma_f32_16x16x32_bf16 v[232:235], v[208:211], a[176:179], v[232:235]
    v_cvt_pk_bf16_f32 v202, v168, v169
    v_mul_f32 v170, v181, v170
    v_mfma_f32_16x16x32_bf16 v[232:235], v[216:219], a[180:183], v[232:235]
    v_mul_f32 v171, v181, v171
    v_cvt_pk_bf16_f32 v203, v170, v171
    v_mfma_f32_16x16x32_bf16 v[240:243], v[204:207], v[196:199], v[40:43]
    v_mul_f32 v112, v181, v112
    v_mul_f32 v113, v181, v113
    v_mfma_f32_16x16x32_bf16 v[248:251], v[184:187], v[196:199], v[44:47]
    v_cvt_pk_bf16_f32 v246, v112, v113
    v_mul_f32 v114, v181, v114
    v_mfma_f32_16x16x32_bf16 v[168:171], v[200:203], v[196:199], v[48:51]
    buffer_store_dwordx2 v[118:119], v19, s[12:15], 0 offen
    v_mul_f32 v115, v181, v115
    v_cvt_pk_bf16_f32 v247, v114, v115
    v_mfma_f32_16x16x16_bf16 v[240:243], v[194:195], v[192:193], v[240:243]
    v_mul_f32 v188, v180, v188
    v_mul_f32 v189, v180, v189
    v_cvt_pk_bf16_f32 v196, v188, v189
    v_mfma_f32_16x16x16_bf16 v[248:251], v[174:175], v[192:193], v[248:251]
    v_mul_f32 v190, v180, v190
    v_mul_f32 v191, v180, v191
    v_cvt_pk_bf16_f32 v197, v190, v191
    v_mfma_f32_16x16x16_bf16 v[168:171], v[246:247], v[192:193], v[168:171]
    v_mul_f32 v136, v180, v136
    v_mul_f32 v137, v180, v137
    v_cvt_pk_bf16_f32 v198, v136, v137
    v_mul_f32 v138, v180, v138
    v_mfma_f32_16x16x32_bf16 v[232:235], v[124:127], a[184:187], v[232:235]
    v_mul_f32 v139, v180, v139
    v_cvt_pk_bf16_f32 v199, v138, v139
    v_mfma_f32_16x16x32_bf16 v[232:235], v[120:123], a[188:191], v[232:235]
    v_mul_f32 v148, v180, v148
    v_mul_f32 v149, v180, v149
    v_mfma_f32_16x16x32_bf16 v[112:115], v[176:179], a[192:195], 0
    ds_read_b128 v[176:179], v2 offset:0
    v_cvt_pk_bf16_f32 v244, v148, v149
    v_mfma_f32_16x16x32_bf16 v[112:115], v[160:163], a[196:199], v[112:115]
    ds_read_b128 v[160:163], v2 offset:1024
    v_mul_f32 v150, v180, v150
    v_mfma_f32_16x16x32_bf16 v[112:115], v[208:211], a[200:203], v[112:115]
    ds_read_b128 v[136:139], v2 offset:2048
    v_cvt_pk_bf16_f32 v188, v232, v233
    v_mfma_f32_16x16x32_bf16 v[112:115], v[216:219], a[204:207], v[112:115]
    ds_read_b128 v[208:211], v2 offset:3072
    v_cvt_pk_bf16_f32 v189, v234, v235
    v_mfma_f32_16x16x32_bf16 v[112:115], v[124:127], a[208:211], v[112:115]
    ds_read_b128 v[124:127], v2 offset:4096
    ds_read2_b32 v[118:119], v6 offset0:0 offset1:0
    v_mfma_f32_16x16x32_bf16 v[112:115], v[120:123], a[212:215], v[112:115]
    ds_read_b128 v[120:123], v2 offset:5120
    ds_read2_b32 v[190:191], v6 offset0:16 offset1:16
    v_mfma_f32_16x16x32_bf16 v[232:235], v[212:215], v[196:199], v[26:29]
    v_mul_f32 v151, v180, v151
    v_cvt_pk_bf16_f32 v245, v150, v151
    v_mfma_f32_16x16x32_bf16 v[232:235], v[224:227], v[200:203], v[232:235]
    ds_read2_b32 v[218:219], v6 offset0:32 offset1:32
    v_mov_b32_dpp v143, v237 quad_perm:[0,1,2,3] row_mask:0x2 bank_mask:0xf
    v_mfma_f32_16x16x32_bf16 v[232:235], v[228:231], v[244:247], v[232:235]
    s_waitcnt lgkmcnt(8)
    v_cvt_pk_bf16_f32 v216, v112, v113
    v_cvt_pk_bf16_f32 v217, v114, v115
    v_mfma_f32_16x16x32_bf16 v[180:183], a[216:219], v[176:179], 0
    s_waitcnt lgkmcnt(7)
    v_mul_f32 v110, v142, v110
    v_mul_f32 v111, v142, v111
    v_mfma_f32_16x16x32_bf16 v[180:183], a[220:223], v[160:163], v[180:183]
    s_waitcnt lgkmcnt(6)
    v_cvt_pk_bf16_f32 v159, v110, v111
    v_mul_f32 v152, v142, v152
    v_mfma_f32_16x16x32_bf16 v[180:183], a[224:227], v[136:139], v[180:183]
    s_waitcnt lgkmcnt(5)
    buffer_store_dwordx4 v[156:159], v15, s[12:15], 0 offen
    v_mul_f32 v153, v142, v153
    v_cvt_pk_bf16_f32 v192, v152, v153
    v_mul_f32 v154, v142, v154
    v_mul_f32 v155, v142, v155
    v_mfma_f32_16x16x32_bf16 v[180:183], a[228:231], v[208:211], v[180:183]
    s_waitcnt lgkmcnt(1)
    v_cvt_pk_bf16_f32 v193, v154, v155
    v_mov_b32_dpp v143, v233 quad_perm:[0,1,2,3] row_mask:0x4 bank_mask:0xf
    v_mfma_f32_16x16x32_bf16 v[180:183], a[232:235], v[124:127], v[180:183]
    v_exp_f32 v232, v232
    v_mfma_f32_16x16x32_bf16 v[180:183], a[236:239], v[120:123], v[180:183]
    s_waitcnt lgkmcnt(0)
    v_exp_f32 v143, v143
    v_mfma_f32_16x16x32_bf16 v[108:111], a[240:243], v[176:179], 0
    v_cvt_pk_bf16_f32 v143, v143, v143
    v_add_u32 v5, 336, v5
    v_mfma_f32_16x16x32_bf16 v[108:111], a[244:247], v[160:163], v[108:111]
    ds_write_b16 v8, v143
    v_mfma_f32_16x16x32_bf16 v[108:111], a[248:251], v[136:139], v[108:111]
    v_exp_f32 v236, v236
    v_mfma_f32_16x16x32_bf16 v[108:111], a[252:255], v[208:211], v[108:111]
    ds_read_b128 v[140:143], v2 offset:6144
    ds_read_b128 v[224:227], v2 offset:7168
    v_mfma_f32_16x16x32_bf16 v[108:111], v[76:79], v[124:127], v[108:111]
    ds_read_b128 v[112:115], v2 offset:8192
    v_fma_f32 v221, v180, v180, s33
    v_mfma_f32_16x16x32_bf16 v[108:111], v[80:83], v[120:123], v[108:111]
    ds_read_b128 v[148:151], v2 offset:9216
    v_fmac_f32 v221, v181, v181
    v_mfma_f32_16x16x32_bf16 v[152:155], v[84:87], v[176:179], 0
    ds_read_b128 v[176:179], v2 offset:10240
    v_fmac_f32 v221, v182, v182
    v_mfma_f32_16x16x32_bf16 v[152:155], v[88:91], v[160:163], v[152:155]
    ds_read_b128 v[160:163], v2 offset:11264
    v_fmac_f32 v221, v183, v183
    v_mfma_f32_16x16x32_bf16 v[152:155], v[92:95], v[136:139], v[152:155]
    v_exp_f32 v240, v240
    v_mfma_f32_16x16x32_bf16 v[152:155], v[96:99], v[208:211], v[152:155]
    v_exp_f32 v241, v241
    v_mfma_f32_16x16x32_bf16 v[152:155], v[100:103], v[124:127], v[152:155]
    ds_read_b128 v[124:127], v9
    ds_read_b128 v[208:211], v9 offset:64
    v_mfma_f32_16x16x32_bf16 v[152:155], v[104:107], v[120:123], v[152:155]
    s_waitcnt lgkmcnt(6)
    v_cvt_pk_bf16_f32 v120, v240, v241
    v_fmac_f32 v221, v108, v108
    v_mfma_f32_16x16x32_bf16 v[136:139], a[216:219], v[140:143], 0
    s_waitcnt lgkmcnt(5)
    v_exp_f32 v242, v242
    v_mfma_f32_16x16x32_bf16 v[136:139], a[220:223], v[224:227], v[136:139]
    s_waitcnt lgkmcnt(4)
    buffer_store_dwordx2 v[192:193], v18, s[12:15], 0 offen
    v_exp_f32 v243, v243
    v_mfma_f32_16x16x32_bf16 v[136:139], a[224:227], v[112:115], v[136:139]
    s_waitcnt lgkmcnt(2)
    v_cvt_pk_bf16_f32 v121, v242, v243
    v_fmac_f32 v221, v109, v109
    v_mfma_f32_16x16x32_bf16 v[136:139], a[228:231], v[148:151], v[136:139]
    v_exp_f32 v248, v248
    v_mfma_f32_16x16x32_bf16 v[136:139], a[232:235], v[176:179], v[136:139]
    v_exp_f32 v249, v249
    v_mfma_f32_16x16x32_bf16 v[136:139], a[236:239], v[160:163], v[136:139]
    s_waitcnt lgkmcnt(1)
    v_cvt_pk_bf16_f32 v122, v248, v249
    v_fmac_f32 v221, v110, v110
    v_mfma_f32_16x16x32_bf16 v[240:243], v[124:127], v[28:31], 0
    s_waitcnt lgkmcnt(0)
    v_exp_f32 v250, v250
    v_mfma_f32_16x16x32_bf16 v[240:243], v[208:211], v[28:31], v[240:243]
    v_exp_f32 v251, v251
    v_mfma_f32_16x16x32_bf16 v[228:231], v[124:127], v[128:131], 0
    v_fma_f32 v192, v136, v136, s33
    v_fmac_f32 v192, v137, v137
    v_mfma_f32_16x16x32_bf16 v[228:231], v[208:211], v[116:119], v[228:231]
    v_fmac_f32 v192, v138, v138
    v_fmac_f32 v192, v139, v139
    v_mfma_f32_16x16x32_bf16 v[212:215], v[124:127], v[164:167], 0
    v_rcp_f32 v240, v240
    v_mfma_f32_16x16x32_bf16 v[212:215], v[208:211], v[188:191], v[212:215]
    v_cvt_pk_bf16_f32 v123, v250, v251
    v_fmac_f32 v221, v111, v111
    v_mfma_f32_16x16x32_bf16 v[248:251], v[124:127], v[144:147], 0
    v_mul_f32 v228, v228, v240
    v_fmac_f32 v221, v152, v152
    v_mfma_f32_16x16x32_bf16 v[248:251], v[208:211], v[216:219], v[248:251]
    v_exp_f32 v168, v168
    v_mfma_f32_16x16x32_bf16 v[208:211], a[240:243], v[140:143], 0
    v_mul_f32_dpp v228, v212, v240 quad_perm:[0,1,2,3] row_mask:0x2 bank_mask:0xf
    v_fmac_f32 v221, v153, v153
    v_mfma_f32_16x16x32_bf16 v[208:211], a[244:247], v[224:227], v[208:211]
    v_exp_f32 v169, v169
    v_mfma_f32_16x16x32_bf16 v[208:211], a[248:251], v[112:115], v[208:211]
    ds_read_b128 v[124:127], v2 offset:12288
    v_mul_f32_dpp v228, v248, v240 quad_perm:[0,1,2,3] row_mask:0x4 bank_mask:0xf
    v_mfma_f32_16x16x32_bf16 v[208:211], a[252:255], v[148:151], v[208:211]
    ds_read_b128 v[240:243], v2 offset:13312
    v_cvt_pk_bf16_f32 v228, v228, v228
    v_mfma_f32_16x16x32_bf16 v[208:211], v[76:79], v[176:179], v[208:211]
    ds_read_b128 v[212:215], v2 offset:14336
    buffer_load_dwordx4 v14, s[8:11], 0 offen nt lds
    v_mfma_f32_16x16x32_bf16 v[208:211], v[80:83], v[160:163], v[208:211]
    ds_read_b128 v[248:251], v2 offset:15360
    v_cvt_pk_bf16_f32 v36, v168, v169
    v_mfma_f32_16x16x32_bf16 v[156:159], v[84:87], v[140:143], 0
    ds_read_b128 v[140:143], v2 offset:16384
    v_fmac_f32 v221, v154, v154
    v_mfma_f32_16x16x32_bf16 v[156:159], v[88:91], v[224:227], v[156:159]
    ds_read_b128 v[224:227], v2 offset:17408
    v_fmac_f32 v221, v155, v155
    v_mfma_f32_16x16x32_bf16 v[156:159], v[92:95], v[112:115], v[156:159]
    ds_write_b16 v7, v228
    v_mfma_f32_16x16x32_bf16 v[156:159], v[96:99], v[148:151], v[156:159]
    v_fmac_f32 v192, v208, v208
    v_fmac_f32 v192, v209, v209
    v_mfma_f32_16x16x32_bf16 v[156:159], v[100:103], v[176:179], v[156:159]
    s_waitcnt lgkmcnt(6)
    v_fmac_f32 v192, v210, v210
    v_fmac_f32 v192, v211, v211
    v_mfma_f32_16x16x32_bf16 v[156:159], v[104:107], v[160:163], v[156:159]
    s_waitcnt lgkmcnt(5)
    v_exp_f32 v170, v170
    v_mfma_f32_16x16x32_bf16 v[160:163], v[204:207], v[132:135], v[52:55]
    s_waitcnt lgkmcnt(4)
    v_exp_f32 v171, v171
    v_mfma_f32_16x16x32_bf16 v[176:179], v[184:187], v[132:135], v[56:59]
    s_waitcnt lgkmcnt(3)
    v_cvt_pk_bf16_f32 v37, v170, v171
    v_fmac_f32 v192, v156, v156
    v_mfma_f32_16x16x32_bf16 v[168:171], v[200:203], v[132:135], v[60:63]
    s_waitcnt lgkmcnt(2)
    v_fmac_f32 v192, v157, v157
    v_fmac_f32 v192, v158, v158
    v_fmac_f32 v192, v159, v159
    v_mfma_f32_16x16x16_bf16 v[160:163], v[194:195], v[172:173], v[160:163]
    v_cvt_pk_bf16_f32 v234, v221, v192
    v_exp_f32 v220, v220
    v_mfma_f32_16x16x16_bf16 v[176:179], v[174:175], v[172:173], v[176:179]
    v_cvt_pk_bf16_f32 v39, v220, 0
    v_add_u32 v6, 272, v6
    v_add_u32 v7, 16, v7
    v_mfma_f32_16x16x16_bf16 v[168:171], v[246:247], v[172:173], v[168:171]
    v_xor_b32 v0, 65536, v0
    v_exp_f32 v160, v160
    v_xor_b32 v1, 65536, v1
    v_mfma_f32_16x16x32_bf16 v[132:135], v[28:31], v[36:39], 0
    s_waitcnt lgkmcnt(0)
    v_exp_f32 v161, v161
    v_mfma_f32_16x16x32_bf16 v[132:135], v[28:31], v[120:123], v[132:135]
    v_cvt_pk_bf16_f32 v192, v160, v161
    v_xor_b32 v2, 65536, v2
    v_mfma_f32_16x16x32_bf16 v[112:115], v[116:119], v[36:39], 0
    v_exp_f32 v162, v162
    v_mfma_f32_16x16x32_bf16 v[112:115], v[128:131], v[120:123], v[112:115]
    v_exp_f32 v163, v163
    v_mfma_f32_16x16x32_bf16 v[148:151], v[188:191], v[36:39], 0
    v_exp_f32 v176, v176
    v_mfma_f32_16x16x32_bf16 v[148:151], v[164:167], v[120:123], v[148:151]
    v_rcp_f32 v132, v132
    v_mfma_f32_16x16x32_bf16 v[220:223], v[216:219], v[36:39], 0
    v_cvt_pk_bf16_f32 v193, v162, v163
    v_cvt_pk_bf16_f32 v39, v236, 0
    v_mfma_f32_16x16x32_bf16 v[220:223], v[144:147], v[120:123], v[220:223]
    v_mul_f32 v112, v132, v112
    v_mul_f32 v113, v132, v113
    v_mfma_f32_16x16x32_bf16 v[160:163], v[204:207], v[196:199], v[64:67]
    v_cvt_pk_bf16_f32 v112, v112, v113
    v_mul_f32 v114, v132, v114
    v_mfma_f32_16x16x32_bf16 v[204:207], v[184:187], v[196:199], v[68:71]
    v_mul_f32 v115, v132, v115
    v_cvt_pk_bf16_f32 v113, v114, v115
    v_mfma_f32_16x16x32_bf16 v[120:123], v[200:203], v[196:199], v[72:75]
    v_mul_f32 v148, v132, v148
    v_mul_f32 v149, v132, v149
    v_cvt_pk_bf16_f32 v114, v148, v149
    v_mfma_f32_16x16x16_bf16 v[160:163], v[194:195], v[244:245], v[160:163]
    v_mul_f32 v150, v132, v150
    v_mul_f32 v151, v132, v151
    v_cvt_pk_bf16_f32 v115, v150, v151
    v_mfma_f32_16x16x16_bf16 v[204:207], v[174:175], v[244:245], v[204:207]
    v_mul_f32 v220, v132, v220
    v_mul_f32 v221, v132, v221
    v_cvt_pk_bf16_f32 v194, v220, v221
    v_mfma_f32_16x16x16_bf16 v[120:123], v[246:247], v[244:245], v[120:123]
    v_exp_f32 v160, v160
    v_exp_f32 v161, v161
    v_mfma_f32_16x16x32_bf16 v[200:203], a[216:219], v[124:127], 0
    ds_write_b128 v3, v[112:115] offset:0
    v_mfma_f32_16x16x32_bf16 v[200:203], a[220:223], v[240:243], v[200:203]
    v_cvt_pk_bf16_f32 v160, v160, v161
    v_mul_f32 v222, v132, v222
    v_mfma_f32_16x16x32_bf16 v[200:203], a[224:227], v[212:215], v[200:203]
    v_exp_f32 v162, v162
    v_mfma_f32_16x16x32_bf16 v[200:203], a[228:231], v[248:251], v[200:203]
    ds_read_b128 v[196:199], v0 offset:20480
    ds_read_b128 v[184:187], v1 offset:20480
    v_mfma_f32_16x16x32_bf16 v[200:203], a[232:235], v[140:143], v[200:203]
    ds_read_b128 v[172:175], v0 offset:20608
    ds_read_b128 v[148:151], v1 offset:20608
    v_mfma_f32_16x16x32_bf16 v[200:203], a[236:239], v[224:227], v[200:203]
    v_exp_f32 v163, v163
    v_mfma_f32_16x16x32_bf16 v[244:247], a[240:243], v[124:127], 0
    ds_read_b128 v[112:115], v0 offset:20736
    ds_read_b128 v[228:231], v1 offset:20736
    v_mfma_f32_16x16x32_bf16 v[244:247], a[244:247], v[240:243], v[244:247]
    v_cvt_pk_bf16_f32 v161, v162, v163
    v_mul_f32 v223, v132, v223
    v_mfma_f32_16x16x32_bf16 v[244:247], a[248:251], v[212:215], v[244:247]
    v_exp_f32 v204, v204
    v_mfma_f32_16x16x32_bf16 v[244:247], a[252:255], v[248:251], v[244:247]
    v_exp_f32 v205, v205
    v_mfma_f32_16x16x32_bf16 v[244:247], v[76:79], v[140:143], v[244:247]
    v_cvt_pk_bf16_f32 v162, v204, v205
    v_cvt_pk_bf16_f32 v195, v222, v223
    v_mfma_f32_16x16x32_bf16 v[244:247], v[80:83], v[224:227], v[244:247]
    s_waitcnt lgkmcnt(4)
    ds_write_b64 v4, v[194:195] offset:4096
    v_mfma_f32_16x16x32_bf16 v[132:135], v[84:87], v[124:127], 0
    s_waitcnt lgkmcnt(3)
    v_exp_f32 v206, v206
    v_mfma_f32_16x16x32_bf16 v[132:135], v[88:91], v[240:243], v[132:135]
    s_waitcnt lgkmcnt(2)
    v_exp_f32 v207, v207
    v_mfma_f32_16x16x32_bf16 v[132:135], v[92:95], v[212:215], v[132:135]
    s_waitcnt lgkmcnt(1)
    v_cvt_pk_bf16_f32 v163, v206, v207
    v_fma_f32 v233, v200, v200, s33
    v_mfma_f32_16x16x32_bf16 v[132:135], v[96:99], v[248:251], v[132:135]
    v_exp_f32 v120, v120
    v_mfma_f32_16x16x32_bf16 v[132:135], v[100:103], v[140:143], v[132:135]
    v_exp_f32 v121, v121
    v_mfma_f32_16x16x32_bf16 v[132:135], v[104:107], v[224:227], v[132:135]
    v_exp_f32 v122, v122
    v_mfma_f32_16x16x32_bf16 v[204:207], a[72:75], v[196:199], 0
    v_exp_f32 v123, v123
    v_mfma_f32_16x16x32_bf16 v[204:207], a[76:79], v[184:187], v[204:207]
    v_exp_f32 v177, v177
    v_mfma_f32_16x16x32_bf16 v[204:207], a[80:83], v[172:175], v[204:207]
    v_cvt_pk_bf16_f32 v194, v176, v177
    v_fmac_f32 v233, v201, v201
    v_mfma_f32_16x16x32_bf16 v[204:207], a[84:87], v[148:151], v[204:207]
    v_exp_f32 v178, v178
    v_mfma_f32_16x16x32_bf16 v[204:207], a[88:91], v[112:115], v[204:207]
    v_exp_f32 v179, v179
    v_mfma_f32_16x16x32_bf16 v[204:207], a[92:95], v[228:231], v[204:207]
    v_cvt_pk_bf16_f32 v195, v178, v179
    v_fmac_f32 v233, v202, v202
    v_mfma_f32_16x16x32_bf16 v[176:179], a[96:99], v[196:199], 0
    v_exp_f32 v168, v168
    v_mfma_f32_16x16x32_bf16 v[176:179], a[100:103], v[184:187], v[176:179]
    v_exp_f32 v169, v169
    v_mfma_f32_16x16x32_bf16 v[176:179], a[104:107], v[172:175], v[176:179]
    v_cvt_pk_bf16_f32 v36, v168, v169
    v_fmac_f32 v233, v203, v203
    v_mfma_f32_16x16x32_bf16 v[176:179], a[108:111], v[148:151], v[176:179]
    v_exp_f32 v170, v170
    v_mfma_f32_16x16x32_bf16 v[176:179], a[112:115], v[112:115], v[176:179]
    v_exp_f32 v171, v171
    v_mfma_f32_16x16x32_bf16 v[176:179], a[116:119], v[228:231], v[176:179]
    v_cvt_pk_bf16_f32 v37, v170, v171
    v_fmac_f32 v233, v244, v244
    v_mfma_f32_16x16x32_bf16 v[124:127], a[120:123], v[196:199], 0
    v_fmac_f32 v233, v245, v245
    v_fmac_f32 v233, v246, v246
    v_mfma_f32_16x16x32_bf16 v[168:171], v[28:31], v[36:39], 0
    v_fmac_f32 v233, v247, v247
    v_fmac_f32 v233, v132, v132
    v_mfma_f32_16x16x32_bf16 v[168:171], v[28:31], v[192:195], v[168:171]
    v_fmac_f32 v233, v133, v133
    v_fmac_f32 v233, v134, v134
    v_mfma_f32_16x16x32_bf16 v[140:143], v[116:119], v[36:39], 0
    v_fmac_f32 v233, v135, v135
    v_cvt_pk_bf16_f32 v235, v233, v233
    v_mfma_f32_16x16x32_bf16 v[140:143], v[128:131], v[192:195], v[140:143]
    ds_write_b64 v4, v[234:235] offset:18432
    v_mfma_f32_16x16x32_bf16 v[224:227], v[188:191], v[36:39], 0
    v_rcp_f32 v168, v168
    v_mfma_f32_16x16x32_bf16 v[224:227], v[164:167], v[192:195], v[224:227]
    v_fma_f32 v169, v204, v204, s32
    v_fmac_f32 v169, v205, v205
    v_mfma_f32_16x16x32_bf16 v[248:251], v[216:219], v[36:39], 0
    v_cvt_pk_bf16_f32 v36, v120, v121
    v_cvt_pk_bf16_f32 v37, v122, v123
    v_mfma_f32_16x16x32_bf16 v[248:251], v[144:147], v[192:195], v[248:251]
    v_cvt_pk_bf16_f32 v39, v232, 0
    v_mul_f32 v140, v168, v140
    v_mfma_f32_16x16x32_bf16 v[124:127], a[124:127], v[184:187], v[124:127]
    v_mul_f32 v141, v168, v141
    v_cvt_pk_bf16_f32 v192, v140, v141
    v_mfma_f32_16x16x32_bf16 v[120:123], v[28:31], v[36:39], 0
    v_mul_f32 v142, v168, v142
    v_mul_f32 v143, v168, v143
    v_mfma_f32_16x16x32_bf16 v[120:123], v[28:31], v[160:163], v[120:123]
    v_cvt_pk_bf16_f32 v193, v142, v143
    v_mul_f32 v224, v168, v224
    v_mfma_f32_16x16x32_bf16 v[140:143], v[116:119], v[36:39], 0
    v_mul_f32 v225, v168, v225
    v_cvt_pk_bf16_f32 v194, v224, v225
    v_mfma_f32_16x16x32_bf16 v[140:143], v[128:131], v[160:163], v[140:143]
    v_mul_f32 v226, v168, v226
    v_mul_f32 v227, v168, v227
    v_mfma_f32_16x16x32_bf16 v[128:131], v[188:191], v[36:39], 0
    v_cvt_pk_bf16_f32 v195, v226, v227
    v_mul_f32 v248, v168, v248
    v_mfma_f32_16x16x32_bf16 v[128:131], v[164:167], v[160:163], v[128:131]
    ds_write_b128 v3, v[192:195] offset:6144
    v_mfma_f32_16x16x32_bf16 v[164:167], v[216:219], v[36:39], 0
    v_mul_f32 v249, v168, v249
    v_cvt_pk_bf16_f32 v170, v248, v249
    v_mfma_f32_16x16x32_bf16 v[164:167], v[144:147], v[160:163], v[164:167]
    v_mul_f32 v250, v168, v250
    v_mul_f32 v251, v168, v251
    v_mfma_f32_16x16x32_bf16 v[124:127], a[128:131], v[172:175], v[124:127]
    v_cvt_pk_bf16_f32 v171, v250, v251
    v_fmac_f32 v169, v206, v206
    v_mfma_f32_16x16x32_bf16 v[124:127], a[132:135], v[148:151], v[124:127]
    ds_write_b64 v4, v[170:171] offset:10240
    v_mfma_f32_16x16x32_bf16 v[124:127], a[136:139], v[112:115], v[124:127]
    v_rcp_f32 v120, v120
    v_mfma_f32_16x16x32_bf16 v[124:127], a[140:143], v[228:231], v[124:127]
    v_mul_f32 v140, v120, v140
    v_mul_f32 v141, v120, v141
    v_mfma_f32_16x16x32_bf16 v[216:219], a[0:3], v[196:199], 0
    v_cvt_pk_bf16_f32 v144, v140, v141
    v_mul_f32 v142, v120, v142
    v_mfma_f32_16x16x32_bf16 v[216:219], a[4:7], v[184:187], v[216:219]
    v_mul_f32 v143, v120, v143
    v_cvt_pk_bf16_f32 v145, v142, v143
    v_mfma_f32_16x16x32_bf16 v[216:219], a[8:11], v[172:175], v[216:219]
    v_mul_f32 v128, v120, v128
    v_mul_f32 v129, v120, v129
    v_mfma_f32_16x16x32_bf16 v[216:219], a[12:15], v[148:151], v[216:219]
    v_cvt_pk_bf16_f32 v146, v128, v129
    v_mul_f32 v130, v120, v130
    v_mfma_f32_16x16x32_bf16 v[216:219], a[16:19], v[112:115], v[216:219]
    v_mul_f32 v131, v120, v131
    v_cvt_pk_bf16_f32 v147, v130, v131
    v_mfma_f32_16x16x32_bf16 v[216:219], a[20:23], v[228:231], v[216:219]
    ds_write_b128 v3, v[144:147] offset:12288
    v_mfma_f32_16x16x32_bf16 v[160:163], a[24:27], v[196:199], 0
    v_mul_f32 v164, v120, v164
    v_mul_f32 v165, v120, v165
    v_mfma_f32_16x16x32_bf16 v[160:163], a[28:31], v[184:187], v[160:163]
    v_cvt_pk_bf16_f32 v164, v164, v165
    v_mul_f32 v166, v120, v166
    v_mfma_f32_16x16x32_bf16 v[160:163], a[32:35], v[172:175], v[160:163]
    v_mul_f32 v167, v120, v167
    v_cvt_pk_bf16_f32 v165, v166, v167
    v_mfma_f32_16x16x32_bf16 v[160:163], a[36:39], v[148:151], v[160:163]
    ds_write_b64 v4, v[164:165] offset:16384
    v_mfma_f32_16x16x32_bf16 v[160:163], a[40:43], v[112:115], v[160:163]
    v_fmac_f32 v169, v207, v207
    v_fmac_f32 v169, v176, v176
    v_mfma_f32_16x16x32_bf16 v[160:163], a[44:47], v[228:231], v[160:163]
    v_fmac_f32 v169, v177, v177
    v_fmac_f32 v169, v178, v178
    v_mfma_f32_16x16x32_bf16 v[116:119], a[48:51], v[196:199], 0
    v_fmac_f32 v169, v179, v179
    v_fmac_f32 v169, v124, v124
    v_mfma_f32_16x16x32_bf16 v[116:119], a[52:55], v[184:187], v[116:119]
    v_fmac_f32 v169, v125, v125
    v_fmac_f32 v169, v126, v126
    v_mfma_f32_16x16x32_bf16 v[116:119], a[56:59], v[172:175], v[116:119]
    v_fmac_f32 v169, v127, v127
    v_fma_f32 v168, v216, v216, s32
    v_mfma_f32_16x16x32_bf16 v[116:119], a[60:63], v[148:151], v[116:119]
    v_fmac_f32 v168, v217, v217
    v_fmac_f32 v168, v218, v218
    v_mfma_f32_16x16x32_bf16 v[116:119], a[64:67], v[112:115], v[116:119]
    s_waitcnt lgkmcnt(0)
    v_fmac_f32 v168, v219, v219
    v_xor_b32 v3, 65536, v3
    v_mfma_f32_16x16x32_bf16 v[116:119], a[68:71], v[228:231], v[116:119]
    s_barrier
    v_xor_b32 v4, 65536, v4
    v_mfma_f32_16x16x32_bf16 v[128:131], v[196:199], a[144:147], 0
    s_nop 0
    v_mfma_f32_16x16x32_bf16 v[128:131], v[184:187], a[148:151], v[128:131]
    s_nop 0
    v_mfma_f32_16x16x32_bf16 v[128:131], v[172:175], a[152:155], v[128:131]
    s_nop 0
    v_mfma_f32_16x16x32_bf16 v[128:131], v[148:151], a[156:159], v[128:131]
    v_mfma_f32_16x16x32_bf16 v[128:131], v[112:115], a[160:163], v[128:131]
    v_mfma_f32_16x16x32_bf16 v[128:131], v[228:231], a[164:167], v[128:131]
    s_cbranch_scc1 L_loop_fast0
    s_branch L_drain
.p2align 6
L_loop_fast1:
    v_mfma_f32_16x16x32_bf16 v[164:167], v[196:199], a[168:171], 0
    s_add_u32 s12, s42, s27
    ds_read_b128 v[144:147], v2 offset:18432
    ds_read_b128 v[192:195], v2 offset:19456
    v_mfma_f32_16x16x32_bf16 v[164:167], v[184:187], a[172:175], v[164:167]
    s_addc_u32 s13, s43, 0
    v_fmac_f32 v168, v160, v160
    v_fmac_f32 v168, v161, v161
    v_mfma_f32_16x16x32_bf16 v[164:167], v[172:175], a[176:179], v[164:167]
    s_sub_u32 s14, s36, s27
    v_fmac_f32 v168, v162, v162
    v_fmac_f32 v168, v163, v163
    v_mfma_f32_16x16x32_bf16 v[164:167], v[148:151], a[180:183], v[164:167]
    s_cmp_ge_u32 s18, 2
    ds_read_b128 v[120:123], v0 offset:26624
    v_fmac_f32 v168, v116, v116
    v_mfma_f32_16x16x32_bf16 v[164:167], v[112:115], a[184:187], v[164:167]
    s_cselect_b32 s14, s14, 0
    ds_read_b128 v[188:191], v1 offset:26624
    v_fmac_f32 v168, v117, v117
    v_mfma_f32_16x16x32_bf16 v[164:167], v[228:231], a[188:191], v[164:167]
    s_add_u32 s34, s18, 2
    ds_read_b128 v[248:251], v0 offset:26752
    v_fmac_f32 v168, v118, v118
    v_mfma_f32_16x16x32_bf16 v[140:143], v[196:199], a[192:195], 0
    s_add_u32 s8, s40, s23
    ds_read_b128 v[224:227], v1 offset:26752
    v_fmac_f32 v168, v119, v119
    v_mfma_f32_16x16x32_bf16 v[140:143], v[184:187], a[196:199], v[140:143]
    s_addc_u32 s9, s41, 0
    ds_read_b128 v[184:187], v0 offset:26880
    v_cvt_pk_bf16_f32 v36, v168, v169
    v_mfma_f32_16x16x32_bf16 v[140:143], v[172:175], a[200:203], v[140:143]
    s_waitcnt lgkmcnt(5)
    ds_read_b128 v[172:175], v1 offset:26880
    v_cvt_pk_bf16_f32 v128, v128, v129
    v_mfma_f32_16x16x32_bf16 v[168:171], v[32:35], v[36:39], 0
    s_sub_u32 s10, s36, s23
    v_cvt_pk_bf16_f32 v129, v130, v131
    v_cvt_pk_bf16_f32 v164, v164, v165
    v_mfma_f32_16x16x32_bf16 v[240:243], v[32:35], v[144:147], 0
    s_cmp_lt_u32 s34, s17
    v_cvt_pk_bf16_f32 v165, v166, v167
    s_cselect_b32 s10, s10, 0
    v_mfma_f32_16x16x32_bf16 v[240:243], v[32:35], v[192:195], v[240:243]
    s_waitcnt lgkmcnt(5)
    v_rsq_f32 v169, v169
    v_mfma_f32_16x16x32_bf16 v[140:143], v[148:151], a[204:207], v[140:143]
    s_add_u32 m0, s28, 0
    v_rsq_f32 v168, v168
    v_mfma_f32_16x16x32_bf16 v[140:143], v[112:115], a[208:211], v[140:143]
    s_mov_b32 s27, s26
    v_mul_f32 v168, s31, v168
    v_mul_f32 v204, v169, v204
    v_mfma_f32_16x16x32_bf16 v[140:143], v[228:231], a[212:215], v[140:143]
    s_mov_b32 s26, s25
    v_mul_f32 v205, v169, v205
    v_cvt_pk_bf16_f32 v204, v204, v205
    v_mfma_f32_16x16x32_bf16 v[112:115], a[72:75], v[120:123], 0
    s_waitcnt lgkmcnt(1)
    v_mul_f32 v206, v169, v206
    v_mul_f32 v207, v169, v207
    v_mfma_f32_16x16x32_bf16 v[112:115], a[76:79], v[188:191], v[112:115]
    s_mov_b32 s25, s24
    v_cvt_pk_bf16_f32 v144, v140, v141
    v_cvt_pk_bf16_f32 v145, v142, v143
    v_mfma_f32_16x16x32_bf16 v[112:115], a[80:83], v[248:251], v[112:115]
    s_mov_b32 s24, s23
    v_cvt_pk_bf16_f32 v205, v206, v207
    v_mul_f32 v176, v169, v176
    v_mfma_f32_16x16x32_bf16 v[112:115], a[84:87], v[224:227], v[112:115]
    s_waitcnt lgkmcnt(0)
    v_mul_f32 v177, v169, v177
    v_cvt_pk_bf16_f32 v206, v176, v177
    v_mfma_f32_16x16x32_bf16 v[112:115], a[88:91], v[184:187], v[112:115]
    v_mul_f32 v178, v169, v178
    v_mul_f32 v179, v169, v179
    v_mfma_f32_16x16x32_bf16 v[112:115], a[92:95], v[172:175], v[112:115]
    v_cvt_pk_bf16_f32 v207, v178, v179
    v_mul_f32 v124, v169, v124
    v_mfma_f32_16x16x32_bf16 v[148:151], a[96:99], v[120:123], 0
    v_mul_f32 v125, v169, v125
    v_cvt_pk_bf16_f32 v194, v124, v125
    v_mfma_f32_16x16x32_bf16 v[148:151], a[100:103], v[188:191], v[148:151]
    v_mul_f32 v126, v169, v126
    v_mul_f32 v127, v169, v127
    v_mfma_f32_16x16x32_bf16 v[148:151], a[104:107], v[248:251], v[148:151]
    v_cvt_pk_bf16_f32 v195, v126, v127
    v_mul_f32 v216, v168, v216
    v_mfma_f32_16x16x32_bf16 v[148:151], a[108:111], v[224:227], v[148:151]
    v_mul_f32 v217, v168, v217
    v_cvt_pk_bf16_f32 v196, v216, v217
    v_mfma_f32_16x16x32_bf16 v[148:151], a[112:115], v[184:187], v[148:151]
    v_mul_f32 v218, v168, v218
    v_mul_f32 v219, v168, v219
    v_mfma_f32_16x16x32_bf16 v[148:151], a[116:119], v[172:175], v[148:151]
    v_cvt_pk_bf16_f32 v197, v218, v219
    v_mul_f32 v160, v168, v160
    v_mfma_f32_16x16x32_bf16 v[228:231], a[120:123], v[120:123], 0
    v_mul_f32 v161, v168, v161
    v_cvt_pk_bf16_f32 v198, v160, v161
    v_mfma_f32_16x16x32_bf16 v[228:231], a[124:127], v[188:191], v[228:231]
    v_mul_f32 v162, v168, v162
    v_mul_f32 v163, v168, v163
    v_mfma_f32_16x16x32_bf16 v[228:231], a[128:131], v[248:251], v[228:231]
    v_cvt_pk_bf16_f32 v199, v162, v163
    v_mul_f32 v116, v168, v116
    v_mfma_f32_16x16x32_bf16 v[228:231], a[132:135], v[224:227], v[228:231]
    v_mul_f32 v117, v168, v117
    v_cvt_pk_bf16_f32 v192, v116, v117
    v_mfma_f32_16x16x32_bf16 v[228:231], a[136:139], v[184:187], v[228:231]
    v_mul_f32 v118, v168, v118
    v_mul_f32 v119, v168, v119
    v_mfma_f32_16x16x32_bf16 v[228:231], a[140:143], v[172:175], v[228:231]
    v_cvt_pk_bf16_f32 v193, v118, v119
    v_fma_f32 v130, v112, v112, s32
    v_mfma_f32_16x16x32_bf16 v[212:215], a[0:3], v[120:123], 0
    v_fmac_f32 v130, v113, v113
    v_fmac_f32 v130, v114, v114
    v_mfma_f32_16x16x32_bf16 v[212:215], a[4:7], v[188:191], v[212:215]
    v_fmac_f32 v130, v115, v115
    v_fmac_f32 v130, v148, v148
    v_mfma_f32_16x16x32_bf16 v[212:215], a[8:11], v[248:251], v[212:215]
    v_fmac_f32 v130, v149, v149
    v_fmac_f32 v130, v150, v150
    v_mfma_f32_16x16x32_bf16 v[212:215], a[12:15], v[224:227], v[212:215]
    v_fmac_f32 v130, v151, v151
    v_fmac_f32 v130, v228, v228
    v_mfma_f32_16x16x32_bf16 v[212:215], a[16:19], v[184:187], v[212:215]
    v_fmac_f32 v130, v229, v229
    v_fmac_f32 v130, v230, v230
    v_mfma_f32_16x16x32_bf16 v[212:215], a[20:23], v[172:175], v[212:215]
    v_fmac_f32 v130, v231, v231
    v_mul_f32 v142, 0x3baaaaab, v240
    v_mfma_f32_16x16x32_bf16 v[232:235], a[24:27], v[120:123], 0
    v_rsq_f32 v142, v142
    v_mfma_f32_16x16x32_bf16 v[232:235], a[28:31], v[188:191], v[232:235]
    v_mul_f32 v147, 0x3baaaaab, v241
    v_mul_f32 v146, 0x3baaaaab, v242
    v_mfma_f32_16x16x32_bf16 v[232:235], a[32:35], v[248:251], v[232:235]
    v_fma_f32 v131, v212, v212, s32
    v_fmac_f32 v131, v213, v213
    v_mfma_f32_16x16x32_bf16 v[232:235], a[36:39], v[224:227], v[232:235]
    v_fmac_f32 v131, v214, v214
    v_fmac_f32 v131, v215, v215
    v_mfma_f32_16x16x32_bf16 v[232:235], a[40:43], v[184:187], v[232:235]
    v_rsq_f32 v147, v147
    v_mfma_f32_16x16x32_bf16 v[232:235], a[44:47], v[172:175], v[232:235]
    v_mul_f32 v136, v147, v136
    v_mul_f32 v137, v147, v137
    v_mfma_f32_16x16x32_bf16 v[240:243], a[48:51], v[120:123], 0
    v_cvt_pk_bf16_f32 v176, v136, v137
    v_mul_f32 v138, v147, v138
    v_mfma_f32_16x16x32_bf16 v[240:243], a[52:55], v[188:191], v[240:243]
    v_mul_f32 v139, v147, v139
    v_cvt_pk_bf16_f32 v177, v138, v139
    v_mfma_f32_16x16x32_bf16 v[240:243], a[56:59], v[248:251], v[240:243]
    v_fmac_f32 v131, v232, v232
    v_fmac_f32 v131, v233, v233
    v_mfma_f32_16x16x32_bf16 v[240:243], a[60:63], v[224:227], v[240:243]
    v_fmac_f32 v131, v234, v234
    v_fmac_f32 v131, v235, v235
    v_mfma_f32_16x16x32_bf16 v[240:243], a[64:67], v[184:187], v[240:243]
    v_mul_f32 v208, v147, v208
    v_mul_f32 v209, v147, v209
    v_mfma_f32_16x16x32_bf16 v[240:243], a[68:71], v[172:175], v[240:243]
    v_cvt_pk_bf16_f32 v178, v208, v209
    v_mul_f32 v210, v147, v210
    v_mfma_f32_16x16x32_bf16 v[216:219], v[120:123], a[144:147], 0
    v_mul_f32 v211, v147, v211
    v_cvt_pk_bf16_f32 v179, v210, v211
    v_mfma_f32_16x16x32_bf16 v[216:219], v[188:191], a[148:151], v[216:219]
    buffer_store_dwordx4 v[176:179], v16, s[12:15], 0 offen
    v_mul_f32 v156, v147, v156
    v_fmac_f32 v131, v240, v240
    v_fmac_f32 v131, v241, v241
    v_fmac_f32 v131, v242, v242
    v_mfma_f32_16x16x32_bf16 v[216:219], v[248:251], a[152:155], v[216:219]
    v_fmac_f32 v131, v243, v243
    v_cvt_pk_bf16_f32 v36, v131, v130
    v_mfma_f32_16x16x32_bf16 v[216:219], v[224:227], a[156:159], v[216:219]
    v_mul_f32 v157, v147, v157
    v_cvt_pk_bf16_f32 v118, v156, v157
    v_mfma_f32_16x16x32_bf16 v[136:139], v[32:35], v[36:39], 0
    v_mul_f32 v158, v147, v158
    v_mul_f32 v159, v147, v159
    v_mfma_f32_16x16x32_bf16 v[216:219], v[184:187], a[160:163], v[216:219]
    v_cvt_pk_bf16_f32 v119, v158, v159
    v_mul_f32 v180, v142, v180
    v_mfma_f32_16x16x32_bf16 v[216:219], v[172:175], a[164:167], v[216:219]
    v_rsq_f32 v146, v146
    v_mfma_f32_16x16x32_bf16 v[168:171], v[120:123], a[168:171], 0
    v_mul_f32 v200, v146, v200
    v_mul_f32 v201, v146, v201
    v_mfma_f32_16x16x32_bf16 v[168:171], v[188:191], a[172:175], v[168:171]
    v_cvt_pk_bf16_f32 v200, v200, v201
    v_mul_f32 v202, v146, v202
    v_mfma_f32_16x16x32_bf16 v[168:171], v[248:251], a[176:179], v[168:171]
    v_cvt_pk_bf16_f32 v130, v216, v217
    v_cvt_pk_bf16_f32 v131, v218, v219
    v_mfma_f32_16x16x32_bf16 v[168:171], v[224:227], a[180:183], v[168:171]
    ds_read_b128 v[176:179], v0 offset:32768
    v_mul_f32 v203, v146, v203
    v_mfma_f32_16x16x32_bf16 v[168:171], v[184:187], a[184:187], v[168:171]
    ds_read_b128 v[160:163], v1 offset:32768
    v_cvt_pk_bf16_f32 v201, v202, v203
    v_mfma_f32_16x16x32_bf16 v[168:171], v[172:175], a[188:191], v[168:171]
    ds_read_b128 v[208:211], v0 offset:32896
    v_mul_f32 v244, v146, v244
    v_mfma_f32_16x16x32_bf16 v[156:159], v[120:123], a[192:195], 0
    ds_read_b128 v[216:219], v1 offset:32896
    v_mul_f32 v245, v146, v245
    v_mfma_f32_16x16x32_bf16 v[156:159], v[188:191], a[196:199], v[156:159]
    ds_read_b128 v[124:127], v0 offset:33024
    v_cvt_pk_bf16_f32 v202, v244, v245
    v_mfma_f32_16x16x32_bf16 v[156:159], v[248:251], a[200:203], v[156:159]
    ds_read_b128 v[120:123], v1 offset:33024
    v_mul_f32 v246, v146, v246
    v_mfma_f32_16x16x32_bf16 v[156:159], v[224:227], a[204:207], v[156:159]
    v_mul_f32 v247, v146, v247
    v_cvt_pk_bf16_f32 v203, v246, v247
    v_mfma_f32_16x16x32_bf16 v[156:159], v[184:187], a[208:211], v[156:159]
    v_mul_f32 v132, v146, v132
    v_mul_f32 v133, v146, v133
    v_mfma_f32_16x16x32_bf16 v[156:159], v[172:175], a[212:215], v[156:159]
    s_waitcnt lgkmcnt(5)
    buffer_store_dwordx4 v[200:203], v17, s[12:15], 0 offen
    v_cvt_pk_bf16_f32 v116, v132, v133
    v_mul_f32 v134, v146, v134
    v_mul_f32 v135, v146, v135
    v_cvt_pk_bf16_f32 v117, v134, v135
    v_mfma_f32_16x16x32_bf16 v[200:203], a[72:75], v[176:179], 0
    s_waitcnt lgkmcnt(3)
    v_rsq_f32 v137, v137
    v_mfma_f32_16x16x32_bf16 v[200:203], a[76:79], v[160:163], v[200:203]
    s_waitcnt lgkmcnt(2)
    v_rsq_f32 v136, v136
    v_mfma_f32_16x16x32_bf16 v[200:203], a[80:83], v[208:211], v[200:203]
    s_waitcnt lgkmcnt(1)
    v_mul_f32 v136, s31, v136
    v_cvt_pk_bf16_f32 v166, v168, v169
    v_mfma_f32_16x16x32_bf16 v[200:203], a[84:87], v[216:219], v[200:203]
    s_waitcnt lgkmcnt(0)
    v_cvt_pk_bf16_f32 v167, v170, v171
    v_cvt_pk_bf16_f32 v146, v156, v157
    v_mfma_f32_16x16x32_bf16 v[200:203], a[88:91], v[124:127], v[200:203]
    v_cvt_pk_bf16_f32 v147, v158, v159
    v_mul_f32 v112, v137, v112
    v_mfma_f32_16x16x32_bf16 v[200:203], a[92:95], v[120:123], v[200:203]
    v_mul_f32 v113, v137, v113
    v_cvt_pk_bf16_f32 v184, v112, v113
    v_mfma_f32_16x16x32_bf16 v[168:171], a[96:99], v[176:179], 0
    v_mul_f32 v114, v137, v114
    v_mul_f32 v115, v137, v115
    v_mfma_f32_16x16x32_bf16 v[168:171], a[100:103], v[160:163], v[168:171]
    v_cvt_pk_bf16_f32 v185, v114, v115
    v_mul_f32 v148, v137, v148
    v_mfma_f32_16x16x32_bf16 v[168:171], a[104:107], v[208:211], v[168:171]
    v_mul_f32 v149, v137, v149
    v_cvt_pk_bf16_f32 v186, v148, v149
    v_mfma_f32_16x16x32_bf16 v[168:171], a[108:111], v[216:219], v[168:171]
    v_mul_f32 v150, v137, v150
    v_mul_f32 v151, v137, v151
    v_mfma_f32_16x16x32_bf16 v[168:171], a[112:115], v[124:127], v[168:171]
    s_waitcnt vmcnt(2)
    v_cvt_pk_bf16_f32 v187, v150, v151
    v_mul_f32 v228, v137, v228
    v_mfma_f32_16x16x32_bf16 v[168:171], a[116:119], v[120:123], v[168:171]
    s_nop 0
    v_mul_f32 v229, v137, v229
    v_cvt_pk_bf16_f32 v174, v228, v229
    v_mfma_f32_16x16x32_bf16 v[112:115], a[120:123], v[176:179], 0
    s_barrier
    v_mul_f32 v230, v137, v230
    v_mul_f32 v231, v137, v231
    v_mfma_f32_16x16x32_bf16 v[112:115], a[124:127], v[160:163], v[112:115]
    s_nop 0
    v_cvt_pk_bf16_f32 v175, v230, v231
    v_mul_f32 v212, v136, v212
    v_mfma_f32_16x16x32_bf16 v[112:115], a[128:131], v[208:211], v[112:115]
    s_nop 0
    v_mul_f32 v213, v136, v213
    v_cvt_pk_bf16_f32 v132, v212, v213
    v_mfma_f32_16x16x32_bf16 v[112:115], a[132:135], v[216:219], v[112:115]
    v_mul_f32 v214, v136, v214
    v_mul_f32 v215, v136, v215
    v_mfma_f32_16x16x32_bf16 v[112:115], a[136:139], v[124:127], v[112:115]
    buffer_load_dwordx4 v10, s[8:11], 0 offen nt lds
    v_cvt_pk_bf16_f32 v133, v214, v215
    v_mfma_f32_16x16x32_bf16 v[112:115], a[140:143], v[120:123], v[112:115]
    s_add_u32 m0, s28, 4096
    v_mul_f32 v232, v136, v232
    v_mul_f32 v233, v136, v233
    v_mfma_f32_16x16x32_bf16 v[188:191], a[0:3], v[176:179], 0
    v_cvt_pk_bf16_f32 v134, v232, v233
    v_mul_f32 v234, v136, v234
    v_mfma_f32_16x16x32_bf16 v[188:191], a[4:7], v[160:163], v[188:191]
    v_mul_f32 v235, v136, v235
    v_cvt_pk_bf16_f32 v135, v234, v235
    v_mfma_f32_16x16x32_bf16 v[188:191], a[8:11], v[208:211], v[188:191]
    v_mul_f32 v240, v136, v240
    v_mul_f32 v241, v136, v241
    v_mfma_f32_16x16x32_bf16 v[188:191], a[12:15], v[216:219], v[188:191]
    buffer_load_dwordx4 v11, s[8:11], 0 offen nt lds
    v_cvt_pk_bf16_f32 v172, v240, v241
    v_mfma_f32_16x16x32_bf16 v[188:191], a[16:19], v[124:127], v[188:191]
    s_add_u32 m0, s28, 8192
    v_mul_f32 v242, v136, v242
    v_mul_f32 v243, v136, v243
    v_mfma_f32_16x16x32_bf16 v[188:191], a[20:23], v[120:123], v[188:191]
    v_cvt_pk_bf16_f32 v173, v242, v243
    v_fma_f32 v140, v200, v200, s32
    v_mfma_f32_16x16x32_bf16 v[136:139], a[24:27], v[176:179], 0
    v_fmac_f32 v140, v201, v201
    v_fmac_f32 v140, v202, v202
    v_mfma_f32_16x16x32_bf16 v[136:139], a[28:31], v[160:163], v[136:139]
    v_fmac_f32 v140, v203, v203
    v_fmac_f32 v140, v168, v168
    v_mfma_f32_16x16x32_bf16 v[136:139], a[32:35], v[208:211], v[136:139]
    buffer_load_dwordx4 v12, s[8:11], 0 offen nt lds
    v_fma_f32 v141, v188, v188, s32
    v_mfma_f32_16x16x32_bf16 v[136:139], a[36:39], v[216:219], v[136:139]
    s_add_u32 m0, s28, 12288
    v_fmac_f32 v141, v189, v189
    v_fmac_f32 v141, v190, v190
    v_mfma_f32_16x16x32_bf16 v[136:139], a[40:43], v[124:127], v[136:139]
    s_xor_b32 s28, s28, 65536
    v_fmac_f32 v141, v191, v191
    v_fmac_f32 v140, v169, v169
    v_mfma_f32_16x16x32_bf16 v[136:139], a[44:47], v[120:123], v[136:139]
    v_fmac_f32 v140, v170, v170
    v_fmac_f32 v140, v171, v171
    v_mfma_f32_16x16x32_bf16 v[148:151], a[48:51], v[176:179], 0
    v_fmac_f32 v140, v112, v112
    v_fmac_f32 v140, v113, v113
    v_mfma_f32_16x16x32_bf16 v[148:151], a[52:55], v[160:163], v[148:151]
    buffer_load_dwordx4 v13, s[8:11], 0 offen nt lds
    v_fmac_f32 v140, v114, v114
    v_mfma_f32_16x16x32_bf16 v[148:151], a[56:59], v[208:211], v[148:151]
    s_mov_b32 m0, s29
    v_fmac_f32 v141, v136, v136
    v_fmac_f32 v141, v137, v137
    v_mfma_f32_16x16x32_bf16 v[148:151], a[60:63], v[216:219], v[148:151]
    s_xor_b32 s29, s29, s30
    v_fmac_f32 v141, v138, v138
    v_fmac_f32 v141, v139, v139
    v_mfma_f32_16x16x32_bf16 v[148:151], a[64:67], v[124:127], v[148:151]
    s_add_u32 s19, s19, s20
    v_fmac_f32 v140, v115, v115
    v_mul_f32 v181, v142, v181
    v_mfma_f32_16x16x32_bf16 v[148:151], a[68:71], v[120:123], v[148:151]
    s_add_u32 s23, s23, s21
    v_cvt_pk_bf16_f32 v156, v180, v181
    v_mul_f32 v182, v142, v182
    v_mfma_f32_16x16x32_bf16 v[220:223], v[176:179], a[144:147], 0
    s_cmp_ge_u32 s19, 72
    ds_read_b128 v[212:215], v5 offset:0
    ds_read_b128 v[224:227], v5 offset:16
    v_mfma_f32_16x16x32_bf16 v[220:223], v[160:163], a[148:151], v[220:223]
    s_cselect_b32 s34, 72, 0
    ds_read_b128 v[228:231], v5 offset:48
    ds_read_b32 v143, v6 offset:192
    v_mfma_f32_16x16x32_bf16 v[220:223], v[208:211], a[152:155], v[220:223]
    s_cselect_b32 s35, s22, 0
    buffer_store_dwordx2 v[116:117], v20, s[12:15], 0 offen
    v_fmac_f32 v141, v148, v148
    v_fmac_f32 v141, v149, v149
    v_mfma_f32_16x16x32_bf16 v[220:223], v[216:219], a[156:159], v[220:223]
    s_sub_u32 s19, s19, s34
    v_fmac_f32 v141, v150, v150
    v_fmac_f32 v141, v151, v151
    v_mfma_f32_16x16x32_bf16 v[220:223], v[124:127], a[160:163], v[220:223]
    s_add_u32 s23, s23, s35
    v_cvt_pk_bf16_f32 v36, v141, v140
    v_mul_f32 v183, v142, v183
    v_mfma_f32_16x16x32_bf16 v[220:223], v[120:123], a[164:167], v[220:223]
    s_add_u32 s18, s18, 1
    v_cvt_pk_bf16_f32 v157, v182, v183
    v_mul_f32 v108, v142, v108
    v_mfma_f32_16x16x32_bf16 v[180:183], v[32:35], v[36:39], 0
    s_cmp_lt_u32 s18, s17
    v_mul_f32 v109, v142, v109
    v_cvt_pk_bf16_f32 v158, v108, v109
    v_mfma_f32_16x16x32_bf16 v[232:235], v[176:179], a[168:171], 0
    s_waitcnt lgkmcnt(3)
    v_cvt_pk_bf16_f32 v116, v220, v221
    v_cvt_pk_bf16_f32 v117, v222, v223
    v_mfma_f32_16x16x32_bf16 v[220:223], v[212:215], v[196:199], v[22:25]
    s_waitcnt lgkmcnt(1)
    v_rsq_f32 v181, v181
    v_mfma_f32_16x16x32_bf16 v[220:223], v[224:227], v[204:207], v[220:223]
    s_waitcnt lgkmcnt(0)
    v_rsq_f32 v180, v180
    v_mfma_f32_16x16x32_bf16 v[220:223], v[228:231], v[192:195], v[220:223]
    v_mul_f32 v180, s31, v180
    v_mul_f32 v200, v181, v200
    v_mfma_f32_16x16x32_bf16 v[236:239], v[212:215], v[132:135], v[24:27]
    v_mul_f32 v201, v181, v201
    v_cvt_pk_bf16_f32 v200, v200, v201
    v_mfma_f32_16x16x32_bf16 v[236:239], v[224:227], v[184:187], v[236:239]
    v_mul_f32 v202, v181, v202
    v_mul_f32 v203, v181, v203
    v_mfma_f32_16x16x32_bf16 v[236:239], v[228:231], v[172:175], v[236:239]
    v_mov_b32_dpp v143, v221 quad_perm:[0,1,2,3] row_mask:0x1 bank_mask:0xf
    v_cvt_pk_bf16_f32 v201, v202, v203
    v_mfma_f32_16x16x32_bf16 v[232:235], v[160:163], a[172:175], v[232:235]
    v_mul_f32 v168, v181, v168
    v_mul_f32 v169, v181, v169
    v_mfma_f32_16x16x32_bf16 v[232:235], v[208:211], a[176:179], v[232:235]
    v_cvt_pk_bf16_f32 v202, v168, v169
    v_mul_f32 v170, v181, v170
    v_mfma_f32_16x16x32_bf16 v[232:235], v[216:219], a[180:183], v[232:235]
    v_mul_f32 v171, v181, v171
    v_cvt_pk_bf16_f32 v203, v170, v171
    v_mfma_f32_16x16x32_bf16 v[240:243], v[204:207], v[196:199], v[40:43]
    v_mul_f32 v112, v181, v112
    v_mul_f32 v113, v181, v113
    v_mfma_f32_16x16x32_bf16 v[248:251], v[184:187], v[196:199], v[44:47]
    v_cvt_pk_bf16_f32 v246, v112, v113
    v_mul_f32 v114, v181, v114
    v_mfma_f32_16x16x32_bf16 v[168:171], v[200:203], v[196:199], v[48:51]
    buffer_store_dwordx2 v[118:119], v19, s[12:15], 0 offen
    v_mul_f32 v115, v181, v115
    v_cvt_pk_bf16_f32 v247, v114, v115
    v_mfma_f32_16x16x16_bf16 v[240:243], v[194:195], v[192:193], v[240:243]
    v_mul_f32 v188, v180, v188
    v_mul_f32 v189, v180, v189
    v_cvt_pk_bf16_f32 v196, v188, v189
    v_mfma_f32_16x16x16_bf16 v[248:251], v[174:175], v[192:193], v[248:251]
    v_mul_f32 v190, v180, v190
    v_mul_f32 v191, v180, v191
    v_cvt_pk_bf16_f32 v197, v190, v191
    v_mfma_f32_16x16x16_bf16 v[168:171], v[246:247], v[192:193], v[168:171]
    v_mul_f32 v136, v180, v136
    v_mul_f32 v137, v180, v137
    v_cvt_pk_bf16_f32 v198, v136, v137
    v_mul_f32 v138, v180, v138
    v_mfma_f32_16x16x32_bf16 v[232:235], v[124:127], a[184:187], v[232:235]
    v_mul_f32 v139, v180, v139
    v_cvt_pk_bf16_f32 v199, v138, v139
    v_mfma_f32_16x16x32_bf16 v[232:235], v[120:123], a[188:191], v[232:235]
    v_mul_f32 v148, v180, v148
    v_mul_f32 v149, v180, v149
    v_mfma_f32_16x16x32_bf16 v[112:115], v[176:179], a[192:195], 0
    ds_read_b128 v[176:179], v2 offset:0
    v_cvt_pk_bf16_f32 v244, v148, v149
    v_mfma_f32_16x16x32_bf16 v[112:115], v[160:163], a[196:199], v[112:115]
    ds_read_b128 v[160:163], v2 offset:1024
    v_mul_f32 v150, v180, v150
    v_mfma_f32_16x16x32_bf16 v[112:115], v[208:211], a[200:203], v[112:115]
    ds_read_b128 v[136:139], v2 offset:2048
    v_cvt_pk_bf16_f32 v188, v232, v233
    v_mfma_f32_16x16x32_bf16 v[112:115], v[216:219], a[204:207], v[112:115]
    ds_read_b128 v[208:211], v2 offset:3072
    v_cvt_pk_bf16_f32 v189, v234, v235
    v_mfma_f32_16x16x32_bf16 v[112:115], v[124:127], a[208:211], v[112:115]
    ds_read_b128 v[124:127], v2 offset:4096
    ds_read2_b32 v[118:119], v6 offset0:0 offset1:0
    v_mfma_f32_16x16x32_bf16 v[112:115], v[120:123], a[212:215], v[112:115]
    ds_read_b128 v[120:123], v2 offset:5120
    ds_read2_b32 v[190:191], v6 offset0:16 offset1:16
    v_mfma_f32_16x16x32_bf16 v[232:235], v[212:215], v[196:199], v[26:29]
    v_mul_f32 v151, v180, v151
    v_cvt_pk_bf16_f32 v245, v150, v151
    v_mfma_f32_16x16x32_bf16 v[232:235], v[224:227], v[200:203], v[232:235]
    ds_read2_b32 v[218:219], v6 offset0:32 offset1:32
    v_mov_b32_dpp v143, v237 quad_perm:[0,1,2,3] row_mask:0x2 bank_mask:0xf
    v_mfma_f32_16x16x32_bf16 v[232:235], v[228:231], v[244:247], v[232:235]
    s_waitcnt lgkmcnt(8)
    v_cvt_pk_bf16_f32 v216, v112, v113
    v_cvt_pk_bf16_f32 v217, v114, v115
    v_mfma_f32_16x16x32_bf16 v[180:183], a[216:219], v[176:179], 0
    s_waitcnt lgkmcnt(7)
    v_mul_f32 v110, v142, v110
    v_mul_f32 v111, v142, v111
    v_mfma_f32_16x16x32_bf16 v[180:183], a[220:223], v[160:163], v[180:183]
    s_waitcnt lgkmcnt(6)
    v_cvt_pk_bf16_f32 v159, v110, v111
    v_mul_f32 v152, v142, v152
    v_mfma_f32_16x16x32_bf16 v[180:183], a[224:227], v[136:139], v[180:183]
    s_waitcnt lgkmcnt(5)
    buffer_store_dwordx4 v[156:159], v15, s[12:15], 0 offen
    v_mul_f32 v153, v142, v153
    v_cvt_pk_bf16_f32 v192, v152, v153
    v_mul_f32 v154, v142, v154
    v_mul_f32 v155, v142, v155
    v_mfma_f32_16x16x32_bf16 v[180:183], a[228:231], v[208:211], v[180:183]
    s_waitcnt lgkmcnt(1)
    v_cvt_pk_bf16_f32 v193, v154, v155
    v_mov_b32_dpp v143, v233 quad_perm:[0,1,2,3] row_mask:0x4 bank_mask:0xf
    v_mfma_f32_16x16x32_bf16 v[180:183], a[232:235], v[124:127], v[180:183]
    v_exp_f32 v232, v232
    v_mfma_f32_16x16x32_bf16 v[180:183], a[236:239], v[120:123], v[180:183]
    s_waitcnt lgkmcnt(0)
    v_exp_f32 v143, v143
    v_mfma_f32_16x16x32_bf16 v[108:111], a[240:243], v[176:179], 0
    v_cvt_pk_bf16_f32 v143, v143, v143
    v_add_u32 v5, 336, v5
    v_mfma_f32_16x16x32_bf16 v[108:111], a[244:247], v[160:163], v[108:111]
    ds_write_b16 v8, v143
    v_mfma_f32_16x16x32_bf16 v[108:111], a[248:251], v[136:139], v[108:111]
    v_exp_f32 v236, v236
    v_mfma_f32_16x16x32_bf16 v[108:111], a[252:255], v[208:211], v[108:111]
    ds_read_b128 v[140:143], v2 offset:6144
    ds_read_b128 v[224:227], v2 offset:7168
    v_mfma_f32_16x16x32_bf16 v[108:111], v[76:79], v[124:127], v[108:111]
    ds_read_b128 v[112:115], v2 offset:8192
    v_fma_f32 v221, v180, v180, s33
    v_mfma_f32_16x16x32_bf16 v[108:111], v[80:83], v[120:123], v[108:111]
    ds_read_b128 v[148:151], v2 offset:9216
    v_fmac_f32 v221, v181, v181
    v_mfma_f32_16x16x32_bf16 v[152:155], v[84:87], v[176:179], 0
    ds_read_b128 v[176:179], v2 offset:10240
    v_fmac_f32 v221, v182, v182
    v_mfma_f32_16x16x32_bf16 v[152:155], v[88:91], v[160:163], v[152:155]
    ds_read_b128 v[160:163], v2 offset:11264
    v_fmac_f32 v221, v183, v183
    v_mfma_f32_16x16x32_bf16 v[152:155], v[92:95], v[136:139], v[152:155]
    v_exp_f32 v240, v240
    v_mfma_f32_16x16x32_bf16 v[152:155], v[96:99], v[208:211], v[152:155]
    v_exp_f32 v241, v241
    v_mfma_f32_16x16x32_bf16 v[152:155], v[100:103], v[124:127], v[152:155]
    ds_read_b128 v[124:127], v9
    ds_read_b128 v[208:211], v9 offset:64
    v_mfma_f32_16x16x32_bf16 v[152:155], v[104:107], v[120:123], v[152:155]
    s_waitcnt lgkmcnt(6)
    v_cvt_pk_bf16_f32 v120, v240, v241
    v_fmac_f32 v221, v108, v108
    v_mfma_f32_16x16x32_bf16 v[136:139], a[216:219], v[140:143], 0
    s_waitcnt lgkmcnt(5)
    v_exp_f32 v242, v242
    v_mfma_f32_16x16x32_bf16 v[136:139], a[220:223], v[224:227], v[136:139]
    s_waitcnt lgkmcnt(4)
    buffer_store_dwordx2 v[192:193], v18, s[12:15], 0 offen
    v_exp_f32 v243, v243
    v_mfma_f32_16x16x32_bf16 v[136:139], a[224:227], v[112:115], v[136:139]
    s_waitcnt lgkmcnt(2)
    v_cvt_pk_bf16_f32 v121, v242, v243
    v_fmac_f32 v221, v109, v109
    v_mfma_f32_16x16x32_bf16 v[136:139], a[228:231], v[148:151], v[136:139]
    v_exp_f32 v248, v248
    v_mfma_f32_16x16x32_bf16 v[136:139], a[232:235], v[176:179], v[136:139]
    v_exp_f32 v249, v249
    v_mfma_f32_16x16x32_bf16 v[136:139], a[236:239], v[160:163], v[136:139]
    s_waitcnt lgkmcnt(1)
    v_cvt_pk_bf16_f32 v122, v248, v249
    v_fmac_f32 v221, v110, v110
    v_mfma_f32_16x16x32_bf16 v[240:243], v[124:127], v[28:31], 0
    s_waitcnt lgkmcnt(0)
    v_exp_f32 v250, v250
    v_mfma_f32_16x16x32_bf16 v[240:243], v[208:211], v[28:31], v[240:243]
    v_exp_f32 v251, v251
    v_mfma_f32_16x16x32_bf16 v[228:231], v[124:127], v[128:131], 0
    v_fma_f32 v192, v136, v136, s33
    v_fmac_f32 v192, v137, v137
    v_mfma_f32_16x16x32_bf16 v[228:231], v[208:211], v[116:119], v[228:231]
    v_fmac_f32 v192, v138, v138
    v_fmac_f32 v192, v139, v139
    v_mfma_f32_16x16x32_bf16 v[212:215], v[124:127], v[164:167], 0
    v_rcp_f32 v240, v240
    v_mfma_f32_16x16x32_bf16 v[212:215], v[208:211], v[188:191], v[212:215]
    v_cvt_pk_bf16_f32 v123, v250, v251
    v_fmac_f32 v221, v111, v111
    v_mfma_f32_16x16x32_bf16 v[248:251], v[124:127], v[144:147], 0
    v_mul_f32 v228, v228, v240
    v_fmac_f32 v221, v152, v152
    v_mfma_f32_16x16x32_bf16 v[248:251], v[208:211], v[216:219], v[248:251]
    v_exp_f32 v168, v168
    v_mfma_f32_16x16x32_bf16 v[208:211], a[240:243], v[140:143], 0
    v_mul_f32_dpp v228, v212, v240 quad_perm:[0,1,2,3] row_mask:0x2 bank_mask:0xf
    v_fmac_f32 v221, v153, v153
    v_mfma_f32_16x16x32_bf16 v[208:211], a[244:247], v[224:227], v[208:211]
    v_exp_f32 v169, v169
    v_mfma_f32_16x16x32_bf16 v[208:211], a[248:251], v[112:115], v[208:211]
    ds_read_b128 v[124:127], v2 offset:12288
    v_mul_f32_dpp v228, v248, v240 quad_perm:[0,1,2,3] row_mask:0x4 bank_mask:0xf
    v_mfma_f32_16x16x32_bf16 v[208:211], a[252:255], v[148:151], v[208:211]
    ds_read_b128 v[240:243], v2 offset:13312
    v_cvt_pk_bf16_f32 v228, v228, v228
    v_mfma_f32_16x16x32_bf16 v[208:211], v[76:79], v[176:179], v[208:211]
    ds_read_b128 v[212:215], v2 offset:14336
    buffer_load_dwordx4 v14, s[8:11], 0 offen nt lds
    v_mfma_f32_16x16x32_bf16 v[208:211], v[80:83], v[160:163], v[208:211]
    ds_read_b128 v[248:251], v2 offset:15360
    v_cvt_pk_bf16_f32 v36, v168, v169
    v_mfma_f32_16x16x32_bf16 v[156:159], v[84:87], v[140:143], 0
    ds_read_b128 v[140:143], v2 offset:16384
    v_fmac_f32 v221, v154, v154
    v_mfma_f32_16x16x32_bf16 v[156:159], v[88:91], v[224:227], v[156:159]
    ds_read_b128 v[224:227], v2 offset:17408
    v_fmac_f32 v221, v155, v155
    v_mfma_f32_16x16x32_bf16 v[156:159], v[92:95], v[112:115], v[156:159]
    ds_write_b16 v7, v228
    v_mfma_f32_16x16x32_bf16 v[156:159], v[96:99], v[148:151], v[156:159]
    v_fmac_f32 v192, v208, v208
    v_fmac_f32 v192, v209, v209
    v_mfma_f32_16x16x32_bf16 v[156:159], v[100:103], v[176:179], v[156:159]
    s_waitcnt lgkmcnt(6)
    v_fmac_f32 v192, v210, v210
    v_fmac_f32 v192, v211, v211
    v_mfma_f32_16x16x32_bf16 v[156:159], v[104:107], v[160:163], v[156:159]
    s_waitcnt lgkmcnt(5)
    v_exp_f32 v170, v170
    v_mfma_f32_16x16x32_bf16 v[160:163], v[204:207], v[132:135], v[52:55]
    s_waitcnt lgkmcnt(4)
    v_exp_f32 v171, v171
    v_mfma_f32_16x16x32_bf16 v[176:179], v[184:187], v[132:135], v[56:59]
    s_waitcnt lgkmcnt(3)
    v_cvt_pk_bf16_f32 v37, v170, v171
    v_fmac_f32 v192, v156, v156
    v_mfma_f32_16x16x32_bf16 v[168:171], v[200:203], v[132:135], v[60:63]
    s_waitcnt lgkmcnt(2)
    v_fmac_f32 v192, v157, v157
    v_fmac_f32 v192, v158, v158
    v_fmac_f32 v192, v159, v159
    v_mfma_f32_16x16x16_bf16 v[160:163], v[194:195], v[172:173], v[160:163]
    v_cvt_pk_bf16_f32 v234, v221, v192
    v_exp_f32 v220, v220
    v_mfma_f32_16x16x16_bf16 v[176:179], v[174:175], v[172:173], v[176:179]
    v_cvt_pk_bf16_f32 v39, v220, 0
    v_add_u32 v6, 272, v6
    v_add_u32 v7, 16, v7
    v_mfma_f32_16x16x16_bf16 v[168:171], v[246:247], v[172:173], v[168:171]
    v_xor_b32 v0, 65536, v0
    v_exp_f32 v160, v160
    v_xor_b32 v1, 65536, v1
    v_mfma_f32_16x16x32_bf16 v[132:135], v[28:31], v[36:39], 0
    s_waitcnt lgkmcnt(0)
    v_exp_f32 v161, v161
    v_mfma_f32_16x16x32_bf16 v[132:135], v[28:31], v[120:123], v[132:135]
    v_cvt_pk_bf16_f32 v192, v160, v161
    v_xor_b32 v2, 65536, v2
    v_mfma_f32_16x16x32_bf16 v[112:115], v[116:119], v[36:39], 0
    v_exp_f32 v162, v162
    v_mfma_f32_16x16x32_bf16 v[112:115], v[128:131], v[120:123], v[112:115]
    v_exp_f32 v163, v163
    v_mfma_f32_16x16x32_bf16 v[148:151], v[188:191], v[36:39], 0
    v_exp_f32 v176, v176
    v_mfma_f32_16x16x32_bf16 v[148:151], v[164:167], v[120:123], v[148:151]
    v_rcp_f32 v132, v132
    v_mfma_f32_16x16x32_bf16 v[220:223], v[216:219], v[36:39], 0
    v_cvt_pk_bf16_f32 v193, v162, v163
    v_cvt_pk_bf16_f32 v39, v236, 0
    v_mfma_f32_16x16x32_bf16 v[220:223], v[144:147], v[120:123], v[220:223]
    v_mul_f32 v112, v132, v112
    v_mul_f32 v113, v132, v113
    v_mfma_f32_16x16x32_bf16 v[160:163], v[204:207], v[196:199], v[64:67]
    v_cvt_pk_bf16_f32 v112, v112, v113
    v_mul_f32 v114, v132, v114
    v_mfma_f32_16x16x32_bf16 v[204:207], v[184:187], v[196:199], v[68:71]
    v_mul_f32 v115, v132, v115
    v_cvt_pk_bf16_f32 v113, v114, v115
    v_mfma_f32_16x16x32_bf16 v[120:123], v[200:203], v[196:199], v[72:75]
    v_mul_f32 v148, v132, v148
    v_mul_f32 v149, v132, v149
    v_cvt_pk_bf16_f32 v114, v148, v149
    v_mfma_f32_16x16x16_bf16 v[160:163], v[194:195], v[244:245], v[160:163]
    v_mul_f32 v150, v132, v150
    v_mul_f32 v151, v132, v151
    v_cvt_pk_bf16_f32 v115, v150, v151
    v_mfma_f32_16x16x16_bf16 v[204:207], v[174:175], v[244:245], v[204:207]
    v_mul_f32 v220, v132, v220
    v_mul_f32 v221, v132, v221
    v_cvt_pk_bf16_f32 v194, v220, v221
    v_mfma_f32_16x16x16_bf16 v[120:123], v[246:247], v[244:245], v[120:123]
    v_exp_f32 v160, v160
    v_exp_f32 v161, v161
    v_mfma_f32_16x16x32_bf16 v[200:203], a[216:219], v[124:127], 0
    ds_write_b128 v3, v[112:115] offset:0
    v_mfma_f32_16x16x32_bf16 v[200:203], a[220:223], v[240:243], v[200:203]
    v_cvt_pk_bf16_f32 v160, v160, v161
    v_mul_f32 v222, v132, v222
    v_mfma_f32_16x16x32_bf16 v[200:203], a[224:227], v[212:215], v[200:203]
    v_exp_f32 v162, v162
    v_mfma_f32_16x16x32_bf16 v[200:203], a[228:231], v[248:251], v[200:203]
    ds_read_b128 v[196:199], v0 offset:20480
    ds_read_b128 v[184:187], v1 offset:20480
    v_mfma_f32_16x16x32_bf16 v[200:203], a[232:235], v[140:143], v[200:203]
    ds_read_b128 v[172:175], v0 offset:20608
    ds_read_b128 v[148:151], v1 offset:20608
    v_mfma_f32_16x16x32_bf16 v[200:203], a[236:239], v[224:227], v[200:203]
    v_exp_f32 v163, v163
    v_mfma_f32_16x16x32_bf16 v[244:247], a[240:243], v[124:127], 0
    ds_read_b128 v[112:115], v0 offset:20736
    ds_read_b128 v[228:231], v1 offset:20736
    v_mfma_f32_16x16x32_bf16 v[244:247], a[244:247], v[240:243], v[244:247]
    v_cvt_pk_bf16_f32 v161, v162, v163
    v_mul_f32 v223, v132, v223
    v_mfma_f32_16x16x32_bf16 v[244:247], a[248:251], v[212:215], v[244:247]
    v_exp_f32 v204, v204
    v_mfma_f32_16x16x32_bf16 v[244:247], a[252:255], v[248:251], v[244:247]
    v_exp_f32 v205, v205
    v_mfma_f32_16x16x32_bf16 v[244:247], v[76:79], v[140:143], v[244:247]
    v_cvt_pk_bf16_f32 v162, v204, v205
    v_cvt_pk_bf16_f32 v195, v222, v223
    v_mfma_f32_16x16x32_bf16 v[244:247], v[80:83], v[224:227], v[244:247]
    s_waitcnt lgkmcnt(4)
    ds_write_b64 v4, v[194:195] offset:4096
    v_mfma_f32_16x16x32_bf16 v[132:135], v[84:87], v[124:127], 0
    s_waitcnt lgkmcnt(3)
    v_exp_f32 v206, v206
    v_mfma_f32_16x16x32_bf16 v[132:135], v[88:91], v[240:243], v[132:135]
    s_waitcnt lgkmcnt(2)
    v_exp_f32 v207, v207
    v_mfma_f32_16x16x32_bf16 v[132:135], v[92:95], v[212:215], v[132:135]
    s_waitcnt lgkmcnt(1)
    v_cvt_pk_bf16_f32 v163, v206, v207
    v_fma_f32 v233, v200, v200, s33
    v_mfma_f32_16x16x32_bf16 v[132:135], v[96:99], v[248:251], v[132:135]
    v_exp_f32 v120, v120
    v_mfma_f32_16x16x32_bf16 v[132:135], v[100:103], v[140:143], v[132:135]
    v_exp_f32 v121, v121
    v_mfma_f32_16x16x32_bf16 v[132:135], v[104:107], v[224:227], v[132:135]
    v_exp_f32 v122, v122
    v_mfma_f32_16x16x32_bf16 v[204:207], a[72:75], v[196:199], 0
    v_exp_f32 v123, v123
    v_mfma_f32_16x16x32_bf16 v[204:207], a[76:79], v[184:187], v[204:207]
    v_exp_f32 v177, v177
    v_mfma_f32_16x16x32_bf16 v[204:207], a[80:83], v[172:175], v[204:207]
    v_cvt_pk_bf16_f32 v194, v176, v177
    v_fmac_f32 v233, v201, v201
    v_mfma_f32_16x16x32_bf16 v[204:207], a[84:87], v[148:151], v[204:207]
    v_exp_f32 v178, v178
    v_mfma_f32_16x16x32_bf16 v[204:207], a[88:91], v[112:115], v[204:207]
    v_exp_f32 v179, v179
    v_mfma_f32_16x16x32_bf16 v[204:207], a[92:95], v[228:231], v[204:207]
    v_cvt_pk_bf16_f32 v195, v178, v179
    v_fmac_f32 v233, v202, v202
    v_mfma_f32_16x16x32_bf16 v[176:179], a[96:99], v[196:199], 0
    v_exp_f32 v168, v168
    v_mfma_f32_16x16x32_bf16 v[176:179], a[100:103], v[184:187], v[176:179]
    v_exp_f32 v169, v169
    v_mfma_f32_16x16x32_bf16 v[176:179], a[104:107], v[172:175], v[176:179]
    v_cvt_pk_bf16_f32 v36, v168, v169
    v_fmac_f32 v233, v203, v203
    v_mfma_f32_16x16x32_bf16 v[176:179], a[108:111], v[148:151], v[176:179]
    v_exp_f32 v170, v170
    v_mfma_f32_16x16x32_bf16 v[176:179], a[112:115], v[112:115], v[176:179]
    v_exp_f32 v171, v171
    v_mfma_f32_16x16x32_bf16 v[176:179], a[116:119], v[228:231], v[176:179]
    v_cvt_pk_bf16_f32 v37, v170, v171
    v_fmac_f32 v233, v244, v244
    v_mfma_f32_16x16x32_bf16 v[124:127], a[120:123], v[196:199], 0
    v_fmac_f32 v233, v245, v245
    v_fmac_f32 v233, v246, v246
    v_mfma_f32_16x16x32_bf16 v[168:171], v[28:31], v[36:39], 0
    v_fmac_f32 v233, v247, v247
    v_fmac_f32 v233, v132, v132
    v_mfma_f32_16x16x32_bf16 v[168:171], v[28:31], v[192:195], v[168:171]
    v_fmac_f32 v233, v133, v133
    v_fmac_f32 v233, v134, v134
    v_mfma_f32_16x16x32_bf16 v[140:143], v[116:119], v[36:39], 0
    v_fmac_f32 v233, v135, v135
    v_cvt_pk_bf16_f32 v235, v233, v233
    v_mfma_f32_16x16x32_bf16 v[140:143], v[128:131], v[192:195], v[140:143]
    ds_write_b64 v4, v[234:235] offset:18432
    v_mfma_f32_16x16x32_bf16 v[224:227], v[188:191], v[36:39], 0
    v_rcp_f32 v168, v168
    v_mfma_f32_16x16x32_bf16 v[224:227], v[164:167], v[192:195], v[224:227]
    v_fma_f32 v169, v204, v204, s32
    v_fmac_f32 v169, v205, v205
    v_mfma_f32_16x16x32_bf16 v[248:251], v[216:219], v[36:39], 0
    v_cvt_pk_bf16_f32 v36, v120, v121
    v_cvt_pk_bf16_f32 v37, v122, v123
    v_mfma_f32_16x16x32_bf16 v[248:251], v[144:147], v[192:195], v[248:251]
    v_cvt_pk_bf16_f32 v39, v232, 0
    v_mul_f32 v140, v168, v140
    v_mfma_f32_16x16x32_bf16 v[124:127], a[124:127], v[184:187], v[124:127]
    v_mul_f32 v141, v168, v141
    v_cvt_pk_bf16_f32 v192, v140, v141
    v_mfma_f32_16x16x32_bf16 v[120:123], v[28:31], v[36:39], 0
    v_mul_f32 v142, v168, v142
    v_mul_f32 v143, v168, v143
    v_mfma_f32_16x16x32_bf16 v[120:123], v[28:31], v[160:163], v[120:123]
    v_cvt_pk_bf16_f32 v193, v142, v143
    v_mul_f32 v224, v168, v224
    v_mfma_f32_16x16x32_bf16 v[140:143], v[116:119], v[36:39], 0
    v_mul_f32 v225, v168, v225
    v_cvt_pk_bf16_f32 v194, v224, v225
    v_mfma_f32_16x16x32_bf16 v[140:143], v[128:131], v[160:163], v[140:143]
    v_mul_f32 v226, v168, v226
    v_mul_f32 v227, v168, v227
    v_mfma_f32_16x16x32_bf16 v[128:131], v[188:191], v[36:39], 0
    v_cvt_pk_bf16_f32 v195, v226, v227
    v_mul_f32 v248, v168, v248
    v_mfma_f32_16x16x32_bf16 v[128:131], v[164:167], v[160:163], v[128:131]
    ds_write_b128 v3, v[192:195] offset:6144
    v_mfma_f32_16x16x32_bf16 v[164:167], v[216:219], v[36:39], 0
    v_mul_f32 v249, v168, v249
    v_cvt_pk_bf16_f32 v170, v248, v249
    v_mfma_f32_16x16x32_bf16 v[164:167], v[144:147], v[160:163], v[164:167]
    v_mul_f32 v250, v168, v250
    v_mul_f32 v251, v168, v251
    v_mfma_f32_16x16x32_bf16 v[124:127], a[128:131], v[172:175], v[124:127]
    v_cvt_pk_bf16_f32 v171, v250, v251
    v_fmac_f32 v169, v206, v206
    v_mfma_f32_16x16x32_bf16 v[124:127], a[132:135], v[148:151], v[124:127]
    ds_write_b64 v4, v[170:171] offset:10240
    v_mfma_f32_16x16x32_bf16 v[124:127], a[136:139], v[112:115], v[124:127]
    v_rcp_f32 v120, v120
    v_mfma_f32_16x16x32_bf16 v[124:127], a[140:143], v[228:231], v[124:127]
    v_mul_f32 v140, v120, v140
    v_mul_f32 v141, v120, v141
    v_mfma_f32_16x16x32_bf16 v[216:219], a[0:3], v[196:199], 0
    v_cvt_pk_bf16_f32 v144, v140, v141
    v_mul_f32 v142, v120, v142
    v_mfma_f32_16x16x32_bf16 v[216:219], a[4:7], v[184:187], v[216:219]
    v_mul_f32 v143, v120, v143
    v_cvt_pk_bf16_f32 v145, v142, v143
    v_mfma_f32_16x16x32_bf16 v[216:219], a[8:11], v[172:175], v[216:219]
    v_mul_f32 v128, v120, v128
    v_mul_f32 v129, v120, v129
    v_mfma_f32_16x16x32_bf16 v[216:219], a[12:15], v[148:151], v[216:219]
    v_cvt_pk_bf16_f32 v146, v128, v129
    v_mul_f32 v130, v120, v130
    v_mfma_f32_16x16x32_bf16 v[216:219], a[16:19], v[112:115], v[216:219]
    v_mul_f32 v131, v120, v131
    v_cvt_pk_bf16_f32 v147, v130, v131
    v_mfma_f32_16x16x32_bf16 v[216:219], a[20:23], v[228:231], v[216:219]
    ds_write_b128 v3, v[144:147] offset:12288
    v_mfma_f32_16x16x32_bf16 v[160:163], a[24:27], v[196:199], 0
    v_mul_f32 v164, v120, v164
    v_mul_f32 v165, v120, v165
    v_mfma_f32_16x16x32_bf16 v[160:163], a[28:31], v[184:187], v[160:163]
    v_cvt_pk_bf16_f32 v164, v164, v165
    v_mul_f32 v166, v120, v166
    v_mfma_f32_16x16x32_bf16 v[160:163], a[32:35], v[172:175], v[160:163]
    v_mul_f32 v167, v120, v167
    v_cvt_pk_bf16_f32 v165, v166, v167
    v_mfma_f32_16x16x32_bf16 v[160:163], a[36:39], v[148:151], v[160:163]
    ds_write_b64 v4, v[164:165] offset:16384
    v_mfma_f32_16x16x32_bf16 v[160:163], a[40:43], v[112:115], v[160:163]
    v_fmac_f32 v169, v207, v207
    v_fmac_f32 v169, v176, v176
    v_mfma_f32_16x16x32_bf16 v[160:163], a[44:47], v[228:231], v[160:163]
    v_fmac_f32 v169, v177, v177
    v_fmac_f32 v169, v178, v178
    v_mfma_f32_16x16x32_bf16 v[116:119], a[48:51], v[196:199], 0
    v_fmac_f32 v169, v179, v179
    v_fmac_f32 v169, v124, v124
    v_mfma_f32_16x16x32_bf16 v[116:119], a[52:55], v[184:187], v[116:119]
    v_fmac_f32 v169, v125, v125
    v_fmac_f32 v169, v126, v126
    v_mfma_f32_16x16x32_bf16 v[116:119], a[56:59], v[172:175], v[116:119]
    v_fmac_f32 v169, v127, v127
    v_fma_f32 v168, v216, v216, s32
    v_mfma_f32_16x16x32_bf16 v[116:119], a[60:63], v[148:151], v[116:119]
    v_fmac_f32 v168, v217, v217
    v_fmac_f32 v168, v218, v218
    v_mfma_f32_16x16x32_bf16 v[116:119], a[64:67], v[112:115], v[116:119]
    s_waitcnt lgkmcnt(0)
    v_fmac_f32 v168, v219, v219
    v_xor_b32 v3, 65536, v3
    v_mfma_f32_16x16x32_bf16 v[116:119], a[68:71], v[228:231], v[116:119]
    s_nop 0
    v_xor_b32 v4, 65536, v4
    v_mfma_f32_16x16x32_bf16 v[128:131], v[196:199], a[144:147], 0
    s_barrier
    v_mfma_f32_16x16x32_bf16 v[128:131], v[184:187], a[148:151], v[128:131]
    s_nop 0
    v_mfma_f32_16x16x32_bf16 v[128:131], v[172:175], a[152:155], v[128:131]
    s_nop 0
    v_mfma_f32_16x16x32_bf16 v[128:131], v[148:151], a[156:159], v[128:131]
    v_mfma_f32_16x16x32_bf16 v[128:131], v[112:115], a[160:163], v[128:131]
    v_mfma_f32_16x16x32_bf16 v[128:131], v[228:231], a[164:167], v[128:131]
    s_cbranch_scc1 L_loop_fast1
    s_branch L_drain
.p2align 6
L_loop_fast2:
    v_mfma_f32_16x16x32_bf16 v[164:167], v[196:199], a[168:171], 0
    s_add_u32 s12, s42, s27
    ds_read_b128 v[144:147], v2 offset:18432
    ds_read_b128 v[192:195], v2 offset:19456
    v_mfma_f32_16x16x32_bf16 v[164:167], v[184:187], a[172:175], v[164:167]
    s_addc_u32 s13, s43, 0
    v_fmac_f32 v168, v160, v160
    v_fmac_f32 v168, v161, v161
    v_mfma_f32_16x16x32_bf16 v[164:167], v[172:175], a[176:179], v[164:167]
    s_sub_u32 s14, s36, s27
    v_fmac_f32 v168, v162, v162
    v_fmac_f32 v168, v163, v163
    v_mfma_f32_16x16x32_bf16 v[164:167], v[148:151], a[180:183], v[164:167]
    s_cmp_ge_u32 s18, 2
    ds_read_b128 v[120:123], v0 offset:26624
    v_fmac_f32 v168, v116, v116
    v_mfma_f32_16x16x32_bf16 v[164:167], v[112:115], a[184:187], v[164:167]
    s_cselect_b32 s14, s14, 0
    ds_read_b128 v[188:191], v1 offset:26624
    v_fmac_f32 v168, v117, v117
    v_mfma_f32_16x16x32_bf16 v[164:167], v[228:231], a[188:191], v[164:167]
    s_add_u32 s34, s18, 2
    ds_read_b128 v[248:251], v0 offset:26752
    v_fmac_f32 v168, v118, v118
    v_mfma_f32_16x16x32_bf16 v[140:143], v[196:199], a[192:195], 0
    s_add_u32 s8, s40, s23
    ds_read_b128 v[224:227], v1 offset:26752
    v_fmac_f32 v168, v119, v119
    v_mfma_f32_16x16x32_bf16 v[140:143], v[184:187], a[196:199], v[140:143]
    s_addc_u32 s9, s41, 0
    ds_read_b128 v[184:187], v0 offset:26880
    v_cvt_pk_bf16_f32 v36, v168, v169
    v_mfma_f32_16x16x32_bf16 v[140:143], v[172:175], a[200:203], v[140:143]
    s_waitcnt lgkmcnt(5)
    ds_read_b128 v[172:175], v1 offset:26880
    v_cvt_pk_bf16_f32 v128, v128, v129
    v_mfma_f32_16x16x32_bf16 v[168:171], v[32:35], v[36:39], 0
    s_sub_u32 s10, s36, s23
    v_cvt_pk_bf16_f32 v129, v130, v131
    v_cvt_pk_bf16_f32 v164, v164, v165
    v_mfma_f32_16x16x32_bf16 v[240:243], v[32:35], v[144:147], 0
    s_cmp_lt_u32 s34, s17
    v_cvt_pk_bf16_f32 v165, v166, v167
    s_cselect_b32 s10, s10, 0
    v_mfma_f32_16x16x32_bf16 v[240:243], v[32:35], v[192:195], v[240:243]
    s_waitcnt lgkmcnt(5)
    v_rsq_f32 v169, v169
    v_mfma_f32_16x16x32_bf16 v[140:143], v[148:151], a[204:207], v[140:143]
    s_add_u32 m0, s28, 0
    v_rsq_f32 v168, v168
    v_mfma_f32_16x16x32_bf16 v[140:143], v[112:115], a[208:211], v[140:143]
    s_mov_b32 s27, s26
    v_mul_f32 v168, s31, v168
    v_mul_f32 v204, v169, v204
    v_mfma_f32_16x16x32_bf16 v[140:143], v[228:231], a[212:215], v[140:143]
    s_mov_b32 s26, s25
    v_mul_f32 v205, v169, v205
    v_cvt_pk_bf16_f32 v204, v204, v205
    v_mfma_f32_16x16x32_bf16 v[112:115], a[72:75], v[120:123], 0
    s_waitcnt lgkmcnt(1)
    v_mul_f32 v206, v169, v206
    v_mul_f32 v207, v169, v207
    v_mfma_f32_16x16x32_bf16 v[112:115], a[76:79], v[188:191], v[112:115]
    s_mov_b32 s25, s24
    v_cvt_pk_bf16_f32 v144, v140, v141
    v_cvt_pk_bf16_f32 v145, v142, v143
    v_mfma_f32_16x16x32_bf16 v[112:115], a[80:83], v[248:251], v[112:115]
    s_mov_b32 s24, s23
    v_cvt_pk_bf16_f32 v205, v206, v207
    v_mul_f32 v176, v169, v176
    v_mfma_f32_16x16x32_bf16 v[112:115], a[84:87], v[224:227], v[112:115]
    s_waitcnt lgkmcnt(0)
    v_mul_f32 v177, v169, v177
    v_cvt_pk_bf16_f32 v206, v176, v177
    v_mfma_f32_16x16x32_bf16 v[112:115], a[88:91], v[184:187], v[112:115]
    v_mul_f32 v178, v169, v178
    v_mul_f32 v179, v169, v179
    v_mfma_f32_16x16x32_bf16 v[112:115], a[92:95], v[172:175], v[112:115]
    v_cvt_pk_bf16_f32 v207, v178, v179
    v_mul_f32 v124, v169, v124
    v_mfma_f32_16x16x32_bf16 v[148:151], a[96:99], v[120:123], 0
    v_mul_f32 v125, v169, v125
    v_cvt_pk_bf16_f32 v194, v124, v125
    v_mfma_f32_16x16x32_bf16 v[148:151], a[100:103], v[188:191], v[148:151]
    v_mul_f32 v126, v169, v126
    v_mul_f32 v127, v169, v127
    v_mfma_f32_16x16x32_bf16 v[148:151], a[104:107], v[248:251], v[148:151]
    v_cvt_pk_bf16_f32 v195, v126, v127
    v_mul_f32 v216, v168, v216
    v_mfma_f32_16x16x32_bf16 v[148:151], a[108:111], v[224:227], v[148:151]
    v_mul_f32 v217, v168, v217
    v_cvt_pk_bf16_f32 v196, v216, v217
    v_mfma_f32_16x16x32_bf16 v[148:151], a[112:115], v[184:187], v[148:151]
    v_mul_f32 v218, v168, v218
    v_mul_f32 v219, v168, v219
    v_mfma_f32_16x16x32_bf16 v[148:151], a[116:119], v[172:175], v[148:151]
    v_cvt_pk_bf16_f32 v197, v218, v219
    v_mul_f32 v160, v168, v160
    v_mfma_f32_16x16x32_bf16 v[228:231], a[120:123], v[120:123], 0
    v_mul_f32 v161, v168, v161
    v_cvt_pk_bf16_f32 v198, v160, v161
    v_mfma_f32_16x16x32_bf16 v[228:231], a[124:127], v[188:191], v[228:231]
    v_mul_f32 v162, v168, v162
    v_mul_f32 v163, v168, v163
    v_mfma_f32_16x16x32_bf16 v[228:231], a[128:131], v[248:251], v[228:231]
    v_cvt_pk_bf16_f32 v199, v162, v163
    v_mul_f32 v116, v168, v116
    v_mfma_f32_16x16x32_bf16 v[228:231], a[132:135], v[224:227], v[228:231]
    v_mul_f32 v117, v168, v117
    v_cvt_pk_bf16_f32 v192, v116, v117
    v_mfma_f32_16x16x32_bf16 v[228:231], a[136:139], v[184:187], v[228:231]
    v_mul_f32 v118, v168, v118
    v_mul_f32 v119, v168, v119
    v_mfma_f32_16x16x32_bf16 v[228:231], a[140:143], v[172:175], v[228:231]
    v_cvt_pk_bf16_f32 v193, v118, v119
    v_fma_f32 v130, v112, v112, s32
    v_mfma_f32_16x16x32_bf16 v[212:215], a[0:3], v[120:123], 0
    v_fmac_f32 v130, v113, v113
    v_fmac_f32 v130, v114, v114
    v_mfma_f32_16x16x32_bf16 v[212:215], a[4:7], v[188:191], v[212:215]
    v_fmac_f32 v130, v115, v115
    v_fmac_f32 v130, v148, v148
    v_mfma_f32_16x16x32_bf16 v[212:215], a[8:11], v[248:251], v[212:215]
    v_fmac_f32 v130, v149, v149
    v_fmac_f32 v130, v150, v150
    v_mfma_f32_16x16x32_bf16 v[212:215], a[12:15], v[224:227], v[212:215]
    v_fmac_f32 v130, v151, v151
    v_fmac_f32 v130, v228, v228
    v_mfma_f32_16x16x32_bf16 v[212:215], a[16:19], v[184:187], v[212:215]
    v_fmac_f32 v130, v229, v229
    v_fmac_f32 v130, v230, v230
    v_mfma_f32_16x16x32_bf16 v[212:215], a[20:23], v[172:175], v[212:215]
    v_fmac_f32 v130, v231, v231
    v_mul_f32 v142, 0x3baaaaab, v240
    v_mfma_f32_16x16x32_bf16 v[232:235], a[24:27], v[120:123], 0
    v_rsq_f32 v142, v142
    v_mfma_f32_16x16x32_bf16 v[232:235], a[28:31], v[188:191], v[232:235]
    v_mul_f32 v147, 0x3baaaaab, v241
    v_mul_f32 v146, 0x3baaaaab, v242
    v_mfma_f32_16x16x32_bf16 v[232:235], a[32:35], v[248:251], v[232:235]
    v_fma_f32 v131, v212, v212, s32
    v_fmac_f32 v131, v213, v213
    v_mfma_f32_16x16x32_bf16 v[232:235], a[36:39], v[224:227], v[232:235]
    v_fmac_f32 v131, v214, v214
    v_fmac_f32 v131, v215, v215
    v_mfma_f32_16x16x32_bf16 v[232:235], a[40:43], v[184:187], v[232:235]
    v_rsq_f32 v147, v147
    v_mfma_f32_16x16x32_bf16 v[232:235], a[44:47], v[172:175], v[232:235]
    v_mul_f32 v136, v147, v136
    v_mul_f32 v137, v147, v137
    v_mfma_f32_16x16x32_bf16 v[240:243], a[48:51], v[120:123], 0
    v_cvt_pk_bf16_f32 v176, v136, v137
    v_mul_f32 v138, v147, v138
    v_mfma_f32_16x16x32_bf16 v[240:243], a[52:55], v[188:191], v[240:243]
    v_mul_f32 v139, v147, v139
    v_cvt_pk_bf16_f32 v177, v138, v139
    v_mfma_f32_16x16x32_bf16 v[240:243], a[56:59], v[248:251], v[240:243]
    v_fmac_f32 v131, v232, v232
    v_fmac_f32 v131, v233, v233
    v_mfma_f32_16x16x32_bf16 v[240:243], a[60:63], v[224:227], v[240:243]
    v_fmac_f32 v131, v234, v234
    v_fmac_f32 v131, v235, v235
    v_mfma_f32_16x16x32_bf16 v[240:243], a[64:67], v[184:187], v[240:243]
    v_mul_f32 v208, v147, v208
    v_mul_f32 v209, v147, v209
    v_mfma_f32_16x16x32_bf16 v[240:243], a[68:71], v[172:175], v[240:243]
    v_cvt_pk_bf16_f32 v178, v208, v209
    v_mul_f32 v210, v147, v210
    v_mfma_f32_16x16x32_bf16 v[216:219], v[120:123], a[144:147], 0
    v_mul_f32 v211, v147, v211
    v_cvt_pk_bf16_f32 v179, v210, v211
    v_mfma_f32_16x16x32_bf16 v[216:219], v[188:191], a[148:151], v[216:219]
    buffer_store_dwordx4 v[176:179], v16, s[12:15], 0 offen
    v_mul_f32 v156, v147, v156
    v_fmac_f32 v131, v240, v240
    v_fmac_f32 v131, v241, v241
    v_fmac_f32 v131, v242, v242
    v_mfma_f32_16x16x32_bf16 v[216:219], v[248:251], a[152:155], v[216:219]
    v_fmac_f32 v131, v243, v243
    v_cvt_pk_bf16_f32 v36, v131, v130
    v_mfma_f32_16x16x32_bf16 v[216:219], v[224:227], a[156:159], v[216:219]
    v_mul_f32 v157, v147, v157
    v_cvt_pk_bf16_f32 v118, v156, v157
    v_mfma_f32_16x16x32_bf16 v[136:139], v[32:35], v[36:39], 0
    v_mul_f32 v158, v147, v158
    v_mul_f32 v159, v147, v159
    v_mfma_f32_16x16x32_bf16 v[216:219], v[184:187], a[160:163], v[216:219]
    v_cvt_pk_bf16_f32 v119, v158, v159
    v_mul_f32 v180, v142, v180
    v_mfma_f32_16x16x32_bf16 v[216:219], v[172:175], a[164:167], v[216:219]
    v_rsq_f32 v146, v146
    v_mfma_f32_16x16x32_bf16 v[168:171], v[120:123], a[168:171], 0
    v_mul_f32 v200, v146, v200
    v_mul_f32 v201, v146, v201
    v_mfma_f32_16x16x32_bf16 v[168:171], v[188:191], a[172:175], v[168:171]
    v_cvt_pk_bf16_f32 v200, v200, v201
    v_mul_f32 v202, v146, v202
    v_mfma_f32_16x16x32_bf16 v[168:171], v[248:251], a[176:179], v[168:171]
    v_cvt_pk_bf16_f32 v130, v216, v217
    v_cvt_pk_bf16_f32 v131, v218, v219
    v_mfma_f32_16x16x32_bf16 v[168:171], v[224:227], a[180:183], v[168:171]
    ds_read_b128 v[176:179], v0 offset:32768
    v_mul_f32 v203, v146, v203
    v_mfma_f32_16x16x32_bf16 v[168:171], v[184:187], a[184:187], v[168:171]
    ds_read_b128 v[160:163], v1 offset:32768
    v_cvt_pk_bf16_f32 v201, v202, v203
    v_mfma_f32_16x16x32_bf16 v[168:171], v[172:175], a[188:191], v[168:171]
    ds_read_b128 v[208:211], v0 offset:32896
    v_mul_f32 v244, v146, v244
    v_mfma_f32_16x16x32_bf16 v[156:159], v[120:123], a[192:195], 0
    ds_read_b128 v[216:219], v1 offset:32896
    v_mul_f32 v245, v146, v245
    v_mfma_f32_16x16x32_bf16 v[156:159], v[188:191], a[196:199], v[156:159]
    ds_read_b128 v[124:127], v0 offset:33024
    v_cvt_pk_bf16_f32 v202, v244, v245
    v_mfma_f32_16x16x32_bf16 v[156:159], v[248:251], a[200:203], v[156:159]
    ds_read_b128 v[120:123], v1 offset:33024
    v_mul_f32 v246, v146, v246
    v_mfma_f32_16x16x32_bf16 v[156:159], v[224:227], a[204:207], v[156:159]
    v_mul_f32 v247, v146, v247
    v_cvt_pk_bf16_f32 v203, v246, v247
    v_mfma_f32_16x16x32_bf16 v[156:159], v[184:187], a[208:211], v[156:159]
    v_mul_f32 v132, v146, v132
    v_mul_f32 v133, v146, v133
    v_mfma_f32_16x16x32_bf16 v[156:159], v[172:175], a[212:215], v[156:159]
    s_waitcnt lgkmcnt(5)
    buffer_store_dwordx4 v[200:203], v17, s[12:15], 0 offen
    v_cvt_pk_bf16_f32 v116, v132, v133
    v_mul_f32 v134, v146, v134
    v_mul_f32 v135, v146, v135
    v_cvt_pk_bf16_f32 v117, v134, v135
    v_mfma_f32_16x16x32_bf16 v[200:203], a[72:75], v[176:179], 0
    s_waitcnt lgkmcnt(3)
    v_rsq_f32 v137, v137
    v_mfma_f32_16x16x32_bf16 v[200:203], a[76:79], v[160:163], v[200:203]
    s_waitcnt lgkmcnt(2)
    v_rsq_f32 v136, v136
    v_mfma_f32_16x16x32_bf16 v[200:203], a[80:83], v[208:211], v[200:203]
    s_waitcnt lgkmcnt(1)
    v_mul_f32 v136, s31, v136
    v_cvt_pk_bf16_f32 v166, v168, v169
    v_mfma_f32_16x16x32_bf16 v[200:203], a[84:87], v[216:219], v[200:203]
    s_waitcnt lgkmcnt(0)
    v_cvt_pk_bf16_f32 v167, v170, v171
    v_cvt_pk_bf16_f32 v146, v156, v157
    v_mfma_f32_16x16x32_bf16 v[200:203], a[88:91], v[124:127], v[200:203]
    v_cvt_pk_bf16_f32 v147, v158, v159
    v_mul_f32 v112, v137, v112
    v_mfma_f32_16x16x32_bf16 v[200:203], a[92:95], v[120:123], v[200:203]
    v_mul_f32 v113, v137, v113
    v_cvt_pk_bf16_f32 v184, v112, v113
    v_mfma_f32_16x16x32_bf16 v[168:171], a[96:99], v[176:179], 0
    v_mul_f32 v114, v137, v114
    v_mul_f32 v115, v137, v115
    v_mfma_f32_16x16x32_bf16 v[168:171], a[100:103], v[160:163], v[168:171]
    v_cvt_pk_bf16_f32 v185, v114, v115
    v_mul_f32 v148, v137, v148
    v_mfma_f32_16x16x32_bf16 v[168:171], a[104:107], v[208:211], v[168:171]
    v_mul_f32 v149, v137, v149
    v_cvt_pk_bf16_f32 v186, v148, v149
    v_mfma_f32_16x16x32_bf16 v[168:171], a[108:111], v[216:219], v[168:171]
    v_mul_f32 v150, v137, v150
    v_mul_f32 v151, v137, v151
    v_mfma_f32_16x16x32_bf16 v[168:171], a[112:115], v[124:127], v[168:171]
    s_waitcnt vmcnt(2)
    v_cvt_pk_bf16_f32 v187, v150, v151
    v_mul_f32 v228, v137, v228
    v_mfma_f32_16x16x32_bf16 v[168:171], a[116:119], v[120:123], v[168:171]
    s_nop 0
    v_mul_f32 v229, v137, v229
    v_cvt_pk_bf16_f32 v174, v228, v229
    v_mfma_f32_16x16x32_bf16 v[112:115], a[120:123], v[176:179], 0
    s_nop 0
    v_mul_f32 v230, v137, v230
    v_mul_f32 v231, v137, v231
    v_mfma_f32_16x16x32_bf16 v[112:115], a[124:127], v[160:163], v[112:115]
    s_barrier
    v_cvt_pk_bf16_f32 v175, v230, v231
    v_mul_f32 v212, v136, v212
    v_mfma_f32_16x16x32_bf16 v[112:115], a[128:131], v[208:211], v[112:115]
    s_nop 0
    v_mul_f32 v213, v136, v213
    v_cvt_pk_bf16_f32 v132, v212, v213
    v_mfma_f32_16x16x32_bf16 v[112:115], a[132:135], v[216:219], v[112:115]
    v_mul_f32 v214, v136, v214
    v_mul_f32 v215, v136, v215
    v_mfma_f32_16x16x32_bf16 v[112:115], a[136:139], v[124:127], v[112:115]
    buffer_load_dwordx4 v10, s[8:11], 0 offen nt lds
    v_cvt_pk_bf16_f32 v133, v214, v215
    v_mfma_f32_16x16x32_bf16 v[112:115], a[140:143], v[120:123], v[112:115]
    s_add_u32 m0, s28, 4096
    v_mul_f32 v232, v136, v232
    v_mul_f32 v233, v136, v233
    v_mfma_f32_16x16x32_bf16 v[188:191], a[0:3], v[176:179], 0
    v_cvt_pk_bf16_f32 v134, v232, v233
    v_mul_f32 v234, v136, v234
    v_mfma_f32_16x16x32_bf16 v[188:191], a[4:7], v[160:163], v[188:191]
    v_mul_f32 v235, v136, v235
    v_cvt_pk_bf16_f32 v135, v234, v235
    v_mfma_f32_16x16x32_bf16 v[188:191], a[8:11], v[208:211], v[188:191]
    v_mul_f32 v240, v136, v240
    v_mul_f32 v241, v136, v241
    v_mfma_f32_16x16x32_bf16 v[188:191], a[12:15], v[216:219], v[188:191]
    buffer_load_dwordx4 v11, s[8:11], 0 offen nt lds
    v_cvt_pk_bf16_f32 v172, v240, v241
    v_mfma_f32_16x16x32_bf16 v[188:191], a[16:19], v[124:127], v[188:191]
    s_add_u32 m0, s28, 8192
    v_mul_f32 v242, v136, v242
    v_mul_f32 v243, v136, v243
    v_mfma_f32_16x16x32_bf16 v[188:191], a[20:23], v[120:123], v[188:191]
    v_cvt_pk_bf16_f32 v173, v242, v243
    v_fma_f32 v140, v200, v200, s32
    v_mfma_f32_16x16x32_bf16 v[136:139], a[24:27], v[176:179], 0
    v_fmac_f32 v140, v201, v201
    v_fmac_f32 v140, v202, v202
    v_mfma_f32_16x16x32_bf16 v[136:139], a[28:31], v[160:163], v[136:139]
    v_fmac_f32 v140, v203, v203
    v_fmac_f32 v140, v168, v168
    v_mfma_f32_16x16x32_bf16 v[136:139], a[32:35], v[208:211], v[136:139]
    buffer_load_dwordx4 v12, s[8:11], 0 offen nt lds
    v_fma_f32 v141, v188, v188, s32
    v_mfma_f32_16x16x32_bf16 v[136:139], a[36:39], v[216:219], v[136:139]
    s_add_u32 m0, s28, 12288
    v_fmac_f32 v141, v189, v189
    v_fmac_f32 v141, v190, v190
    v_mfma_f32_16x16x32_bf16 v[136:139], a[40:43], v[124:127], v[136:139]
    s_xor_b32 s28, s28, 65536
    v_fmac_f32 v141, v191, v191
    v_fmac_f32 v140, v169, v169
    v_mfma_f32_16x16x32_bf16 v[136:139], a[44:47], v[120:123], v[136:139]
    v_fmac_f32 v140, v170, v170
    v_fmac_f32 v140, v171, v171
    v_mfma_f32_16x16x32_bf16 v[148:151], a[48:51], v[176:179], 0
    v_fmac_f32 v140, v112, v112
    v_fmac_f32 v140, v113, v113
    v_mfma_f32_16x16x32_bf16 v[148:151], a[52:55], v[160:163], v[148:151]
    buffer_load_dwordx4 v13, s[8:11], 0 offen nt lds
    v_fmac_f32 v140, v114, v114
    v_mfma_f32_16x16x32_bf16 v[148:151], a[56:59], v[208:211], v[148:151]
    s_mov_b32 m0, s29
    v_fmac_f32 v141, v136, v136
    v_fmac_f32 v141, v137, v137
    v_mfma_f32_16x16x32_bf16 v[148:151], a[60:63], v[216:219], v[148:151]
    s_xor_b32 s29, s29, s30
    v_fmac_f32 v141, v138, v138
    v_fmac_f32 v141, v139, v139
    v_mfma_f32_16x16x32_bf16 v[148:151], a[64:67], v[124:127], v[148:151]
    s_add_u32 s19, s19, s20
    v_fmac_f32 v140, v115, v115
    v_mul_f32 v181, v142, v181
    v_mfma_f32_16x16x32_bf16 v[148:151], a[68:71], v[120:123], v[148:151]
    s_add_u32 s23, s23, s21
    v_cvt_pk_bf16_f32 v156, v180, v181
    v_mul_f32 v182, v142, v182
    v_mfma_f32_16x16x32_bf16 v[220:223], v[176:179], a[144:147], 0
    s_cmp_ge_u32 s19, 72
    ds_read_b128 v[212:215], v5 offset:0
    ds_read_b128 v[224:227], v5 offset:16
    v_mfma_f32_16x16x32_bf16 v[220:223], v[160:163], a[148:151], v[220:223]
    s_cselect_b32 s34, 72, 0
    ds_read_b128 v[228:231], v5 offset:48
    ds_read_b32 v143, v6 offset:192
    v_mfma_f32_16x16x32_bf16 v[220:223], v[208:211], a[152:155], v[220:223]
    s_cselect_b32 s35, s22, 0
    buffer_store_dwordx2 v[116:117], v20, s[12:15], 0 offen
    v_fmac_f32 v141, v148, v148
    v_fmac_f32 v141, v149, v149
    v_mfma_f32_16x16x32_bf16 v[220:223], v[216:219], a[156:159], v[220:223]
    s_sub_u32 s19, s19, s34
    v_fmac_f32 v141, v150, v150
    v_fmac_f32 v141, v151, v151
    v_mfma_f32_16x16x32_bf16 v[220:223], v[124:127], a[160:163], v[220:223]
    s_add_u32 s23, s23, s35
    v_cvt_pk_bf16_f32 v36, v141, v140
    v_mul_f32 v183, v142, v183
    v_mfma_f32_16x16x32_bf16 v[220:223], v[120:123], a[164:167], v[220:223]
    s_add_u32 s18, s18, 1
    v_cvt_pk_bf16_f32 v157, v182, v183
    v_mul_f32 v108, v142, v108
    v_mfma_f32_16x16x32_bf16 v[180:183], v[32:35], v[36:39], 0
    s_cmp_lt_u32 s18, s17
    v_mul_f32 v109, v142, v109
    v_cvt_pk_bf16_f32 v158, v108, v109
    v_mfma_f32_16x16x32_bf16 v[232:235], v[176:179], a[168:171], 0
    s_waitcnt lgkmcnt(3)
    v_cvt_pk_bf16_f32 v116, v220, v221
    v_cvt_pk_bf16_f32 v117, v222, v223
    v_mfma_f32_16x16x32_bf16 v[220:223], v[212:215], v[196:199], v[22:25]
    s_waitcnt lgkmcnt(1)
    v_rsq_f32 v181, v181
    v_mfma_f32_16x16x32_bf16 v[220:223], v[224:227], v[204:207], v[220:223]
    s_waitcnt lgkmcnt(0)
    v_rsq_f32 v180, v180
    v_mfma_f32_16x16x32_bf16 v[220:223], v[228:231], v[192:195], v[220:223]
    v_mul_f32 v180, s31, v180
    v_mul_f32 v200, v181, v200
    v_mfma_f32_16x16x32_bf16 v[236:239], v[212:215], v[132:135], v[24:27]
    v_mul_f32 v201, v181, v201
    v_cvt_pk_bf16_f32 v200, v200, v201
    v_mfma_f32_16x16x32_bf16 v[236:239], v[224:227], v[184:187], v[236:239]
    v_mul_f32 v202, v181, v202
    v_mul_f32 v203, v181, v203
    v_mfma_f32_16x16x32_bf16 v[236:239], v[228:231], v[172:175], v[236:239]
    v_mov_b32_dpp v143, v221 quad_perm:[0,1,2,3] row_mask:0x1 bank_mask:0xf
    v_cvt_pk_bf16_f32 v201, v202, v203
    v_mfma_f32_16x16x32_bf16 v[232:235], v[160:163], a[172:175], v[232:235]
    v_mul_f32 v168, v181, v168
    v_mul_f32 v169, v181, v169
    v_mfma_f32_16x16x32_bf16 v[232:235], v[208:211], a[176:179], v[232:235]
    v_cvt_pk_bf16_f32 v202, v168, v169
    v_mul_f32 v170, v181, v170
    v_mfma_f32_16x16x32_bf16 v[232:235], v[216:219], a[180:183], v[232:235]
    v_mul_f32 v171, v181, v171
    v_cvt_pk_bf16_f32 v203, v170, v171
    v_mfma_f32_16x16x32_bf16 v[240:243], v[204:207], v[196:199], v[40:43]
    v_mul_f32 v112, v181, v112
    v_mul_f32 v113, v181, v113
    v_mfma_f32_16x16x32_bf16 v[248:251], v[184:187], v[196:199], v[44:47]
    v_cvt_pk_bf16_f32 v246, v112, v113
    v_mul_f32 v114, v181, v114
    v_mfma_f32_16x16x32_bf16 v[168:171], v[200:203], v[196:199], v[48:51]
    buffer_store_dwordx2 v[118:119], v19, s[12:15], 0 offen
    v_mul_f32 v115, v181, v115
    v_cvt_pk_bf16_f32 v247, v114, v115
    v_mfma_f32_16x16x16_bf16 v[240:243], v[194:195], v[192:193], v[240:243]
    v_mul_f32 v188, v180, v188
    v_mul_f32 v189, v180, v189
    v_cvt_pk_bf16_f32 v196, v188, v189
    v_mfma_f32_16x16x16_bf16 v[248:251], v[174:175], v[192:193], v[248:251]
    v_mul_f32 v190, v180, v190
    v_mul_f32 v191, v180, v191
    v_cvt_pk_bf16_f32 v197, v190, v191
    v_mfma_f32_16x16x16_bf16 v[168:171], v[246:247], v[192:193], v[168:171]
    v_mul_f32 v136, v180, v136
    v_mul_f32 v137, v180, v137
    v_cvt_pk_bf16_f32 v198, v136, v137
    v_mul_f32 v138, v180, v138
    v_mfma_f32_16x16x32_bf16 v[232:235], v[124:127], a[184:187], v[232:235]
    v_mul_f32 v139, v180, v139
    v_cvt_pk_bf16_f32 v199, v138, v139
    v_mfma_f32_16x16x32_bf16 v[232:235], v[120:123], a[188:191], v[232:235]
    v_mul_f32 v148, v180, v148
    v_mul_f32 v149, v180, v149
    v_mfma_f32_16x16x32_bf16 v[112:115], v[176:179], a[192:195], 0
    ds_read_b128 v[176:179], v2 offset:0
    v_cvt_pk_bf16_f32 v244, v148, v149
    v_mfma_f32_16x16x32_bf16 v[112:115], v[160:163], a[196:199], v[112:115]
    ds_read_b128 v[160:163], v2 offset:1024
    v_mul_f32 v150, v180, v150
    v_mfma_f32_16x16x32_bf16 v[112:115], v[208:211], a[200:203], v[112:115]
    ds_read_b128 v[136:139], v2 offset:2048
    v_cvt_pk_bf16_f32 v188, v232, v233
    v_mfma_f32_16x16x32_bf16 v[112:115], v[216:219], a[204:207], v[112:115]
    ds_read_b128 v[208:211], v2 offset:3072
    v_cvt_pk_bf16_f32 v189, v234, v235
    v_mfma_f32_16x16x32_bf16 v[112:115], v[124:127], a[208:211], v[112:115]
    ds_read_b128 v[124:127], v2 offset:4096
    ds_read2_b32 v[118:119], v6 offset0:0 offset1:0
    v_mfma_f32_16x16x32_bf16 v[112:115], v[120:123], a[212:215], v[112:115]
    ds_read_b128 v[120:123], v2 offset:5120
    ds_read2_b32 v[190:191], v6 offset0:16 offset1:16
    v_mfma_f32_16x16x32_bf16 v[232:235], v[212:215], v[196:199], v[26:29]
    v_mul_f32 v151, v180, v151
    v_cvt_pk_bf16_f32 v245, v150, v151
    v_mfma_f32_16x16x32_bf16 v[232:235], v[224:227], v[200:203], v[232:235]
    ds_read2_b32 v[218:219], v6 offset0:32 offset1:32
    v_mov_b32_dpp v143, v237 quad_perm:[0,1,2,3] row_mask:0x2 bank_mask:0xf
    v_mfma_f32_16x16x32_bf16 v[232:235], v[228:231], v[244:247], v[232:235]
    s_waitcnt lgkmcnt(8)
    v_cvt_pk_bf16_f32 v216, v112, v113
    v_cvt_pk_bf16_f32 v217, v114, v115
    v_mfma_f32_16x16x32_bf16 v[180:183], a[216:219], v[176:179], 0
    s_waitcnt lgkmcnt(7)
    v_mul_f32 v110, v142, v110
    v_mul_f32 v111, v142, v111
    v_mfma_f32_16x16x32_bf16 v[180:183], a[220:223], v[160:163], v[180:183]
    s_waitcnt lgkmcnt(6)
    v_cvt_pk_bf16_f32 v159, v110, v111
    v_mul_f32 v152, v142, v152
    v_mfma_f32_16x16x32_bf16 v[180:183], a[224:227], v[136:139], v[180:183]
    s_waitcnt lgkmcnt(5)
    buffer_store_dwordx4 v[156:159], v15, s[12:15], 0 offen
    v_mul_f32 v153, v142, v153
    v_cvt_pk_bf16_f32 v192, v152, v153
    v_mul_f32 v154, v142, v154
    v_mul_f32 v155, v142, v155
    v_mfma_f32_16x16x32_bf16 v[180:183], a[228:231], v[208:211], v[180:183]
    s_waitcnt lgkmcnt(1)
    v_cvt_pk_bf16_f32 v193, v154, v155
    v_mov_b32_dpp v143, v233 quad_perm:[0,1,2,3] row_mask:0x4 bank_mask:0xf
    v_mfma_f32_16x16x32_bf16 v[180:183], a[232:235], v[124:127], v[180:183]
    v_exp_f32 v232, v232
    v_mfma_f32_16x16x32_bf16 v[180:183], a[236:239], v[120:123], v[180:183]
    s_waitcnt lgkmcnt(0)
    v_exp_f32 v143, v143
    v_mfma_f32_16x16x32_bf16 v[108:111], a[240:243], v[176:179], 0
    v_cvt_pk_bf16_f32 v143, v143, v143
    v_add_u32 v5, 336, v5
    v_mfma_f32_16x16x32_bf16 v[108:111], a[244:247], v[160:163], v[108:111]
    ds_write_b16 v8, v143
    v_mfma_f32_16x16x32_bf16 v[108:111], a[248:251], v[136:139], v[108:111]
    v_exp_f32 v236, v236
    v_mfma_f32_16x16x32_bf16 v[108:111], a[252:255], v[208:211], v[108:111]
    ds_read_b128 v[140:143], v2 offset:6144
    ds_read_b128 v[224:227], v2 offset:7168
    v_mfma_f32_16x16x32_bf16 v[108:111], v[76:79], v[124:127], v[108:111]
    ds_read_b128 v[112:115], v2 offset:8192
    v_fma_f32 v221, v180, v180, s33
    v_mfma_f32_16x16x32_bf16 v[108:111], v[80:83], v[120:123], v[108:111]
    ds_read_b128 v[148:151], v2 offset:9216
    v_fmac_f32 v221, v181, v181
    v_mfma_f32_16x16x32_bf16 v[152:155], v[84:87], v[176:179], 0
    ds_read_b128 v[176:179], v2 offset:10240
    v_fmac_f32 v221, v182, v182
    v_mfma_f32_16x16x32_bf16 v[152:155], v[88:91], v[160:163], v[152:155]
    ds_read_b128 v[160:163], v2 offset:11264
    v_fmac_f32 v221, v183, v183
    v_mfma_f32_16x16x32_bf16 v[152:155], v[92:95], v[136:139], v[152:155]
    v_exp_f32 v240, v240
    v_mfma_f32_16x16x32_bf16 v[152:155], v[96:99], v[208:211], v[152:155]
    v_exp_f32 v241, v241
    v_mfma_f32_16x16x32_bf16 v[152:155], v[100:103], v[124:127], v[152:155]
    ds_read_b128 v[124:127], v9
    ds_read_b128 v[208:211], v9 offset:64
    v_mfma_f32_16x16x32_bf16 v[152:155], v[104:107], v[120:123], v[152:155]
    s_waitcnt lgkmcnt(6)
    v_cvt_pk_bf16_f32 v120, v240, v241
    v_fmac_f32 v221, v108, v108
    v_mfma_f32_16x16x32_bf16 v[136:139], a[216:219], v[140:143], 0
    s_waitcnt lgkmcnt(5)
    v_exp_f32 v242, v242
    v_mfma_f32_16x16x32_bf16 v[136:139], a[220:223], v[224:227], v[136:139]
    s_waitcnt lgkmcnt(4)
    buffer_store_dwordx2 v[192:193], v18, s[12:15], 0 offen
    v_exp_f32 v243, v243
    v_mfma_f32_16x16x32_bf16 v[136:139], a[224:227], v[112:115], v[136:139]
    s_waitcnt lgkmcnt(2)
    v_cvt_pk_bf16_f32 v121, v242, v243
    v_fmac_f32 v221, v109, v109
    v_mfma_f32_16x16x32_bf16 v[136:139], a[228:231], v[148:151], v[136:139]
    v_exp_f32 v248, v248
    v_mfma_f32_16x16x32_bf16 v[136:139], a[232:235], v[176:179], v[136:139]
    v_exp_f32 v249, v249
    v_mfma_f32_16x16x32_bf16 v[136:139], a[236:239], v[160:163], v[136:139]
    s_waitcnt lgkmcnt(1)
    v_cvt_pk_bf16_f32 v122, v248, v249
    v_fmac_f32 v221, v110, v110
    v_mfma_f32_16x16x32_bf16 v[240:243], v[124:127], v[28:31], 0
    s_waitcnt lgkmcnt(0)
    v_exp_f32 v250, v250
    v_mfma_f32_16x16x32_bf16 v[240:243], v[208:211], v[28:31], v[240:243]
    v_exp_f32 v251, v251
    v_mfma_f32_16x16x32_bf16 v[228:231], v[124:127], v[128:131], 0
    v_fma_f32 v192, v136, v136, s33
    v_fmac_f32 v192, v137, v137
    v_mfma_f32_16x16x32_bf16 v[228:231], v[208:211], v[116:119], v[228:231]
    v_fmac_f32 v192, v138, v138
    v_fmac_f32 v192, v139, v139
    v_mfma_f32_16x16x32_bf16 v[212:215], v[124:127], v[164:167], 0
    v_rcp_f32 v240, v240
    v_mfma_f32_16x16x32_bf16 v[212:215], v[208:211], v[188:191], v[212:215]
    v_cvt_pk_bf16_f32 v123, v250, v251
    v_fmac_f32 v221, v111, v111
    v_mfma_f32_16x16x32_bf16 v[248:251], v[124:127], v[144:147], 0
    v_mul_f32 v228, v228, v240
    v_fmac_f32 v221, v152, v152
    v_mfma_f32_16x16x32_bf16 v[248:251], v[208:211], v[216:219], v[248:251]
    v_exp_f32 v168, v168
    v_mfma_f32_16x16x32_bf16 v[208:211], a[240:243], v[140:143], 0
    v_mul_f32_dpp v228, v212, v240 quad_perm:[0,1,2,3] row_mask:0x2 bank_mask:0xf
    v_fmac_f32 v221, v153, v153
    v_mfma_f32_16x16x32_bf16 v[208:211], a[244:247], v[224:227], v[208:211]
    v_exp_f32 v169, v169
    v_mfma_f32_16x16x32_bf16 v[208:211], a[248:251], v[112:115], v[208:211]
    ds_read_b128 v[124:127], v2 offset:12288
    v_mul_f32_dpp v228, v248, v240 quad_perm:[0,1,2,3] row_mask:0x4 bank_mask:0xf
    v_mfma_f32_16x16x32_bf16 v[208:211], a[252:255], v[148:151], v[208:211]
    ds_read_b128 v[240:243], v2 offset:13312
    v_cvt_pk_bf16_f32 v228, v228, v228
    v_mfma_f32_16x16x32_bf16 v[208:211], v[76:79], v[176:179], v[208:211]
    ds_read_b128 v[212:215], v2 offset:14336
    buffer_load_dwordx4 v14, s[8:11], 0 offen nt lds
    v_mfma_f32_16x16x32_bf16 v[208:211], v[80:83], v[160:163], v[208:211]
    ds_read_b128 v[248:251], v2 offset:15360
    v_cvt_pk_bf16_f32 v36, v168, v169
    v_mfma_f32_16x16x32_bf16 v[156:159], v[84:87], v[140:143], 0
    ds_read_b128 v[140:143], v2 offset:16384
    v_fmac_f32 v221, v154, v154
    v_mfma_f32_16x16x32_bf16 v[156:159], v[88:91], v[224:227], v[156:159]
    ds_read_b128 v[224:227], v2 offset:17408
    v_fmac_f32 v221, v155, v155
    v_mfma_f32_16x16x32_bf16 v[156:159], v[92:95], v[112:115], v[156:159]
    ds_write_b16 v7, v228
    v_mfma_f32_16x16x32_bf16 v[156:159], v[96:99], v[148:151], v[156:159]
    v_fmac_f32 v192, v208, v208
    v_fmac_f32 v192, v209, v209
    v_mfma_f32_16x16x32_bf16 v[156:159], v[100:103], v[176:179], v[156:159]
    s_waitcnt lgkmcnt(6)
    v_fmac_f32 v192, v210, v210
    v_fmac_f32 v192, v211, v211
    v_mfma_f32_16x16x32_bf16 v[156:159], v[104:107], v[160:163], v[156:159]
    s_waitcnt lgkmcnt(5)
    v_exp_f32 v170, v170
    v_mfma_f32_16x16x32_bf16 v[160:163], v[204:207], v[132:135], v[52:55]
    s_waitcnt lgkmcnt(4)
    v_exp_f32 v171, v171
    v_mfma_f32_16x16x32_bf16 v[176:179], v[184:187], v[132:135], v[56:59]
    s_waitcnt lgkmcnt(3)
    v_cvt_pk_bf16_f32 v37, v170, v171
    v_fmac_f32 v192, v156, v156
    v_mfma_f32_16x16x32_bf16 v[168:171], v[200:203], v[132:135], v[60:63]
    s_waitcnt lgkmcnt(2)
    v_fmac_f32 v192, v157, v157
    v_fmac_f32 v192, v158, v158
    v_fmac_f32 v192, v159, v159
    v_mfma_f32_16x16x16_bf16 v[160:163], v[194:195], v[172:173], v[160:163]
    v_cvt_pk_bf16_f32 v234, v221, v192
    v_exp_f32 v220, v220
    v_mfma_f32_16x16x16_bf16 v[176:179], v[174:175], v[172:173], v[176:179]
    v_cvt_pk_bf16_f32 v39, v220, 0
    v_add_u32 v6, 272, v6
    v_add_u32 v7, 16, v7
    v_mfma_f32_16x16x16_bf16 v[168:171], v[246:247], v[172:173], v[168:171]
    v_xor_b32 v0, 65536, v0
    v_exp_f32 v160, v160
    v_xor_b32 v1, 65536, v1
    v_mfma_f32_16x16x32_bf16 v[132:135], v[28:31], v[36:39], 0
    s_waitcnt lgkmcnt(0)
    v_exp_f32 v161, v161
    v_mfma_f32_16x16x32_bf16 v[132:135], v[28:31], v[120:123], v[132:135]
    v_cvt_pk_bf16_f32 v192, v160, v161
    v_xor_b32 v2, 65536, v2
    v_mfma_f32_16x16x32_bf16 v[112:115], v[116:119], v[36:39], 0
    v_exp_f32 v162, v162
    v_mfma_f32_16x16x32_bf16 v[112:115], v[128:131], v[120:123], v[112:115]
    v_exp_f32 v163, v163
    v_mfma_f32_16x16x32_bf16 v[148:151], v[188:191], v[36:39], 0
    v_exp_f32 v176, v176
    v_mfma_f32_16x16x32_bf16 v[148:151], v[164:167], v[120:123], v[148:151]
    v_rcp_f32 v132, v132
    v_mfma_f32_16x16x32_bf16 v[220:223], v[216:219], v[36:39], 0
    v_cvt_pk_bf16_f32 v193, v162, v163
    v_cvt_pk_bf16_f32 v39, v236, 0
    v_mfma_f32_16x16x32_bf16 v[220:223], v[144:147], v[120:123], v[220:223]
    v_mul_f32 v112, v132, v112
    v_mul_f32 v113, v132, v113
    v_mfma_f32_16x16x32_bf16 v[160:163], v[204:207], v[196:199], v[64:67]
    v_cvt_pk_bf16_f32 v112, v112, v113
    v_mul_f32 v114, v132, v114
    v_mfma_f32_16x16x32_bf16 v[204:207], v[184:187], v[196:199], v[68:71]
    v_mul_f32 v115, v132, v115
    v_cvt_pk_bf16_f32 v113, v114, v115
    v_mfma_f32_16x16x32_bf16 v[120:123], v[200:203], v[196:199], v[72:75]
    v_mul_f32 v148, v132, v148
    v_mul_f32 v149, v132, v149
    v_cvt_pk_bf16_f32 v114, v148, v149
    v_mfma_f32_16x16x16_bf16 v[160:163], v[194:195], v[244:245], v[160:163]
    v_mul_f32 v150, v132, v150
    v_mul_f32 v151, v132, v151
    v_cvt_pk_bf16_f32 v115, v150, v151
    v_mfma_f32_16x16x16_bf16 v[204:207], v[174:175], v[244:245], v[204:207]
    v_mul_f32 v220, v132, v220
    v_mul_f32 v221, v132, v221
    v_cvt_pk_bf16_f32 v194, v220, v221
    v_mfma_f32_16x16x16_bf16 v[120:123], v[246:247], v[244:245], v[120:123]
    v_exp_f32 v160, v160
    v_exp_f32 v161, v161
    v_mfma_f32_16x16x32_bf16 v[200:203], a[216:219], v[124:127], 0
    ds_write_b128 v3, v[112:115] offset:0
    v_mfma_f32_16x16x32_bf16 v[200:203], a[220:223], v[240:243], v[200:203]
    v_cvt_pk_bf16_f32 v160, v160, v161
    v_mul_f32 v222, v132, v222
    v_mfma_f32_16x16x32_bf16 v[200:203], a[224:227], v[212:215], v[200:203]
    v_exp_f32 v162, v162
    v_mfma_f32_16x16x32_bf16 v[200:203], a[228:231], v[248:251], v[200:203]
    ds_read_b128 v[196:199], v0 offset:20480
    ds_read_b128 v[184:187], v1 offset:20480
    v_mfma_f32_16x16x32_bf16 v[200:203], a[232:235], v[140:143], v[200:203]
    ds_read_b128 v[172:175], v0 offset:20608
    ds_read_b128 v[148:151], v1 offset:20608
    v_mfma_f32_16x16x32_bf16 v[200:203], a[236:239], v[224:227], v[200:203]
    v_exp_f32 v163, v163
    v_mfma_f32_16x16x32_bf16 v[244:247], a[240:243], v[124:127], 0
    ds_read_b128 v[112:115], v0 offset:20736
    ds_read_b128 v[228:231], v1 offset:20736
    v_mfma_f32_16x16x32_bf16 v[244:247], a[244:247], v[240:243], v[244:247]
    v_cvt_pk_bf16_f32 v161, v162, v163
    v_mul_f32 v223, v132, v223
    v_mfma_f32_16x16x32_bf16 v[244:247], a[248:251], v[212:215], v[244:247]
    v_exp_f32 v204, v204
    v_mfma_f32_16x16x32_bf16 v[244:247], a[252:255], v[248:251], v[244:247]
    v_exp_f32 v205, v205
    v_mfma_f32_16x16x32_bf16 v[244:247], v[76:79], v[140:143], v[244:247]
    v_cvt_pk_bf16_f32 v162, v204, v205
    v_cvt_pk_bf16_f32 v195, v222, v223
    v_mfma_f32_16x16x32_bf16 v[244:247], v[80:83], v[224:227], v[244:247]
    s_waitcnt lgkmcnt(4)
    ds_write_b64 v4, v[194:195] offset:4096
    v_mfma_f32_16x16x32_bf16 v[132:135], v[84:87], v[124:127], 0
    s_waitcnt lgkmcnt(3)
    v_exp_f32 v206, v206
    v_mfma_f32_16x16x32_bf16 v[132:135], v[88:91], v[240:243], v[132:135]
    s_waitcnt lgkmcnt(2)
    v_exp_f32 v207, v207
    v_mfma_f32_16x16x32_bf16 v[132:135], v[92:95], v[212:215], v[132:135]
    s_waitcnt lgkmcnt(1)
    v_cvt_pk_bf16_f32 v163, v206, v207
    v_fma_f32 v233, v200, v200, s33
    v_mfma_f32_16x16x32_bf16 v[132:135], v[96:99], v[248:251], v[132:135]
    v_exp_f32 v120, v120
    v_mfma_f32_16x16x32_bf16 v[132:135], v[100:103], v[140:143], v[132:135]
    v_exp_f32 v121, v121
    v_mfma_f32_16x16x32_bf16 v[132:135], v[104:107], v[224:227], v[132:135]
    v_exp_f32 v122, v122
    v_mfma_f32_16x16x32_bf16 v[204:207], a[72:75], v[196:199], 0
    v_exp_f32 v123, v123
    v_mfma_f32_16x16x32_bf16 v[204:207], a[76:79], v[184:187], v[204:207]
    v_exp_f32 v177, v177
    v_mfma_f32_16x16x32_bf16 v[204:207], a[80:83], v[172:175], v[204:207]
    v_cvt_pk_bf16_f32 v194, v176, v177
    v_fmac_f32 v233, v201, v201
    v_mfma_f32_16x16x32_bf16 v[204:207], a[84:87], v[148:151], v[204:207]
    v_exp_f32 v178, v178
    v_mfma_f32_16x16x32_bf16 v[204:207], a[88:91], v[112:115], v[204:207]
    v_exp_f32 v179, v179
    v_mfma_f32_16x16x32_bf16 v[204:207], a[92:95], v[228:231], v[204:207]
    v_cvt_pk_bf16_f32 v195, v178, v179
    v_fmac_f32 v233, v202, v202
    v_mfma_f32_16x16x32_bf16 v[176:179], a[96:99], v[196:199], 0
    v_exp_f32 v168, v168
    v_mfma_f32_16x16x32_bf16 v[176:179], a[100:103], v[184:187], v[176:179]
    v_exp_f32 v169, v169
    v_mfma_f32_16x16x32_bf16 v[176:179], a[104:107], v[172:175], v[176:179]
    v_cvt_pk_bf16_f32 v36, v168, v169
    v_fmac_f32 v233, v203, v203
    v_mfma_f32_16x16x32_bf16 v[176:179], a[108:111], v[148:151], v[176:179]
    v_exp_f32 v170, v170
    v_mfma_f32_16x16x32_bf16 v[176:179], a[112:115], v[112:115], v[176:179]
    v_exp_f32 v171, v171
    v_mfma_f32_16x16x32_bf16 v[176:179], a[116:119], v[228:231], v[176:179]
    v_cvt_pk_bf16_f32 v37, v170, v171
    v_fmac_f32 v233, v244, v244
    v_mfma_f32_16x16x32_bf16 v[124:127], a[120:123], v[196:199], 0
    v_fmac_f32 v233, v245, v245
    v_fmac_f32 v233, v246, v246
    v_mfma_f32_16x16x32_bf16 v[168:171], v[28:31], v[36:39], 0
    v_fmac_f32 v233, v247, v247
    v_fmac_f32 v233, v132, v132
    v_mfma_f32_16x16x32_bf16 v[168:171], v[28:31], v[192:195], v[168:171]
    v_fmac_f32 v233, v133, v133
    v_fmac_f32 v233, v134, v134
    v_mfma_f32_16x16x32_bf16 v[140:143], v[116:119], v[36:39], 0
    v_fmac_f32 v233, v135, v135
    v_cvt_pk_bf16_f32 v235, v233, v233
    v_mfma_f32_16x16x32_bf16 v[140:143], v[128:131], v[192:195], v[140:143]
    ds_write_b64 v4, v[234:235] offset:18432
    v_mfma_f32_16x16x32_bf16 v[224:227], v[188:191], v[36:39], 0
    v_rcp_f32 v168, v168
    v_mfma_f32_16x16x32_bf16 v[224:227], v[164:167], v[192:195], v[224:227]
    v_fma_f32 v169, v204, v204, s32
    v_fmac_f32 v169, v205, v205
    v_mfma_f32_16x16x32_bf16 v[248:251], v[216:219], v[36:39], 0
    v_cvt_pk_bf16_f32 v36, v120, v121
    v_cvt_pk_bf16_f32 v37, v122, v123
    v_mfma_f32_16x16x32_bf16 v[248:251], v[144:147], v[192:195], v[248:251]
    v_cvt_pk_bf16_f32 v39, v232, 0
    v_mul_f32 v140, v168, v140
    v_mfma_f32_16x16x32_bf16 v[124:127], a[124:127], v[184:187], v[124:127]
    v_mul_f32 v141, v168, v141
    v_cvt_pk_bf16_f32 v192, v140, v141
    v_mfma_f32_16x16x32_bf16 v[120:123], v[28:31], v[36:39], 0
    v_mul_f32 v142, v168, v142
    v_mul_f32 v143, v168, v143
    v_mfma_f32_16x16x32_bf16 v[120:123], v[28:31], v[160:163], v[120:123]
    v_cvt_pk_bf16_f32 v193, v142, v143
    v_mul_f32 v224, v168, v224
    v_mfma_f32_16x16x32_bf16 v[140:143], v[116:119], v[36:39], 0
    v_mul_f32 v225, v168, v225
    v_cvt_pk_bf16_f32 v194, v224, v225
    v_mfma_f32_16x16x32_bf16 v[140:143], v[128:131], v[160:163], v[140:143]
    v_mul_f32 v226, v168, v226
    v_mul_f32 v227, v168, v227
    v_mfma_f32_16x16x32_bf16 v[128:131], v[188:191], v[36:39], 0
    v_cvt_pk_bf16_f32 v195, v226, v227
    v_mul_f32 v248, v168, v248
    v_mfma_f32_16x16x32_bf16 v[128:131], v[164:167], v[160:163], v[128:131]
    ds_write_b128 v3, v[192:195] offset:6144
    v_mfma_f32_16x16x32_bf16 v[164:167], v[216:219], v[36:39], 0
    v_mul_f32 v249, v168, v249
    v_cvt_pk_bf16_f32 v170, v248, v249
    v_mfma_f32_16x16x32_bf16 v[164:167], v[144:147], v[160:163], v[164:167]
    v_mul_f32 v250, v168, v250
    v_mul_f32 v251, v168, v251
    v_mfma_f32_16x16x32_bf16 v[124:127], a[128:131], v[172:175], v[124:127]
    v_cvt_pk_bf16_f32 v171, v250, v251
    v_fmac_f32 v169, v206, v206
    v_mfma_f32_16x16x32_bf16 v[124:127], a[132:135], v[148:151], v[124:127]
    ds_write_b64 v4, v[170:171] offset:10240
    v_mfma_f32_16x16x32_bf16 v[124:127], a[136:139], v[112:115], v[124:127]
    v_rcp_f32 v120, v120
    v_mfma_f32_16x16x32_bf16 v[124:127], a[140:143], v[228:231], v[124:127]
    v_mul_f32 v140, v120, v140
    v_mul_f32 v141, v120, v141
    v_mfma_f32_16x16x32_bf16 v[216:219], a[0:3], v[196:199], 0
    v_cvt_pk_bf16_f32 v144, v140, v141
    v_mul_f32 v142, v120, v142
    v_mfma_f32_16x16x32_bf16 v[216:219], a[4:7], v[184:187], v[216:219]
    v_mul_f32 v143, v120, v143
    v_cvt_pk_bf16_f32 v145, v142, v143
    v_mfma_f32_16x16x32_bf16 v[216:219], a[8:11], v[172:175], v[216:219]
    v_mul_f32 v128, v120, v128
    v_mul_f32 v129, v120, v129
    v_mfma_f32_16x16x32_bf16 v[216:219], a[12:15], v[148:151], v[216:219]
    v_cvt_pk_bf16_f32 v146, v128, v129
    v_mul_f32 v130, v120, v130
    v_mfma_f32_16x16x32_bf16 v[216:219], a[16:19], v[112:115], v[216:219]
    v_mul_f32 v131, v120, v131
    v_cvt_pk_bf16_f32 v147, v130, v131
    v_mfma_f32_16x16x32_bf16 v[216:219], a[20:23], v[228:231], v[216:219]
    ds_write_b128 v3, v[144:147] offset:12288
    v_mfma_f32_16x16x32_bf16 v[160:163], a[24:27], v[196:199], 0
    v_mul_f32 v164, v120, v164
    v_mul_f32 v165, v120, v165
    v_mfma_f32_16x16x32_bf16 v[160:163], a[28:31], v[184:187], v[160:163]
    v_cvt_pk_bf16_f32 v164, v164, v165
    v_mul_f32 v166, v120, v166
    v_mfma_f32_16x16x32_bf16 v[160:163], a[32:35], v[172:175], v[160:163]
    v_mul_f32 v167, v120, v167
    v_cvt_pk_bf16_f32 v165, v166, v167
    v_mfma_f32_16x16x32_bf16 v[160:163], a[36:39], v[148:151], v[160:163]
    ds_write_b64 v4, v[164:165] offset:16384
    v_mfma_f32_16x16x32_bf16 v[160:163], a[40:43], v[112:115], v[160:163]
    v_fmac_f32 v169, v207, v207
    v_fmac_f32 v169, v176, v176
    v_mfma_f32_16x16x32_bf16 v[160:163], a[44:47], v[228:231], v[160:163]
    v_fmac_f32 v169, v177, v177
    v_fmac_f32 v169, v178, v178
    v_mfma_f32_16x16x32_bf16 v[116:119], a[48:51], v[196:199], 0
    v_fmac_f32 v169, v179, v179
    v_fmac_f32 v169, v124, v124
    v_mfma_f32_16x16x32_bf16 v[116:119], a[52:55], v[184:187], v[116:119]
    v_fmac_f32 v169, v125, v125
    v_fmac_f32 v169, v126, v126
    v_mfma_f32_16x16x32_bf16 v[116:119], a[56:59], v[172:175], v[116:119]
    v_fmac_f32 v169, v127, v127
    v_fma_f32 v168, v216, v216, s32
    v_mfma_f32_16x16x32_bf16 v[116:119], a[60:63], v[148:151], v[116:119]
    v_fmac_f32 v168, v217, v217
    v_fmac_f32 v168, v218, v218
    v_mfma_f32_16x16x32_bf16 v[116:119], a[64:67], v[112:115], v[116:119]
    s_waitcnt lgkmcnt(0)
    v_fmac_f32 v168, v219, v219
    v_xor_b32 v3, 65536, v3
    v_mfma_f32_16x16x32_bf16 v[116:119], a[68:71], v[228:231], v[116:119]
    s_nop 0
    v_xor_b32 v4, 65536, v4
    v_mfma_f32_16x16x32_bf16 v[128:131], v[196:199], a[144:147], 0
    s_nop 0
    v_mfma_f32_16x16x32_bf16 v[128:131], v[184:187], a[148:151], v[128:131]
    s_barrier
    v_mfma_f32_16x16x32_bf16 v[128:131], v[172:175], a[152:155], v[128:131]
    s_nop 0
    v_mfma_f32_16x16x32_bf16 v[128:131], v[148:151], a[156:159], v[128:131]
    v_mfma_f32_16x16x32_bf16 v[128:131], v[112:115], a[160:163], v[128:131]
    v_mfma_f32_16x16x32_bf16 v[128:131], v[228:231], a[164:167], v[128:131]
    s_cbranch_scc1 L_loop_fast2
    s_branch L_drain
.p2align 6
L_loop_fast3:
    v_mfma_f32_16x16x32_bf16 v[164:167], v[196:199], a[168:171], 0
    s_add_u32 s12, s42, s27
    ds_read_b128 v[144:147], v2 offset:18432
    ds_read_b128 v[192:195], v2 offset:19456
    v_mfma_f32_16x16x32_bf16 v[164:167], v[184:187], a[172:175], v[164:167]
    s_addc_u32 s13, s43, 0
    v_fmac_f32 v168, v160, v160
    v_fmac_f32 v168, v161, v161
    v_mfma_f32_16x16x32_bf16 v[164:167], v[172:175], a[176:179], v[164:167]
    s_sub_u32 s14, s36, s27
    v_fmac_f32 v168, v162, v162
    v_fmac_f32 v168, v163, v163
    v_mfma_f32_16x16x32_bf16 v[164:167], v[148:151], a[180:183], v[164:167]
    s_cmp_ge_u32 s18, 2
    ds_read_b128 v[120:123], v0 offset:26624
    v_fmac_f32 v168, v116, v116
    v_mfma_f32_16x16x32_bf16 v[164:167], v[112:115], a[184:187], v[164:167]
    s_cselect_b32 s14, s14, 0
    ds_read_b128 v[188:191], v1 offset:26624
    v_fmac_f32 v168, v117, v117
    v_mfma_f32_16x16x32_bf16 v[164:167], v[228:231], a[188:191], v[164:167]
    s_add_u32 s34, s18, 2
    ds_read_b128 v[248:251], v0 offset:26752
    v_fmac_f32 v168, v118, v118
    v_mfma_f32_16x16x32_bf16 v[140:143], v[196:199], a[192:195], 0
    s_add_u32 s8, s40, s23
    ds_read_b128 v[224:227], v1 offset:26752
    v_fmac_f32 v168, v119, v119
    v_mfma_f32_16x16x32_bf16 v[140:143], v[184:187], a[196:199], v[140:143]
    s_addc_u32 s9, s41, 0
    ds_read_b128 v[184:187], v0 offset:26880
    v_cvt_pk_bf16_f32 v36, v168, v169
    v_mfma_f32_16x16x32_bf16 v[140:143], v[172:175], a[200:203], v[140:143]
    s_waitcnt lgkmcnt(5)
    ds_read_b128 v[172:175], v1 offset:26880
    v_cvt_pk_bf16_f32 v128, v128, v129
    v_mfma_f32_16x16x32_bf16 v[168:171], v[32:35], v[36:39], 0
    s_sub_u32 s10, s36, s23
    v_cvt_pk_bf16_f32 v129, v130, v131
    v_cvt_pk_bf16_f32 v164, v164, v165
    v_mfma_f32_16x16x32_bf16 v[240:243], v[32:35], v[144:147], 0
    s_cmp_lt_u32 s34, s17
    v_cvt_pk_bf16_f32 v165, v166, v167
    s_cselect_b32 s10, s10, 0
    v_mfma_f32_16x16x32_bf16 v[240:243], v[32:35], v[192:195], v[240:243]
    s_waitcnt lgkmcnt(5)
    v_rsq_f32 v169, v169
    v_mfma_f32_16x16x32_bf16 v[140:143], v[148:151], a[204:207], v[140:143]
    s_add_u32 m0, s28, 0
    v_rsq_f32 v168, v168
    v_mfma_f32_16x16x32_bf16 v[140:143], v[112:115], a[208:211], v[140:143]
    s_mov_b32 s27, s26
    v_mul_f32 v168, s31, v168
    v_mul_f32 v204, v169, v204
    v_mfma_f32_16x16x32_bf16 v[140:143], v[228:231], a[212:215], v[140:143]
    s_mov_b32 s26, s25
    v_mul_f32 v205, v169, v205
    v_cvt_pk_bf16_f32 v204, v204, v205
    v_mfma_f32_16x16x32_bf16 v[112:115], a[72:75], v[120:123], 0
    s_waitcnt lgkmcnt(1)
    v_mul_f32 v206, v169, v206
    v_mul_f32 v207, v169, v207
    v_mfma_f32_16x16x32_bf16 v[112:115], a[76:79], v[188:191], v[112:115]
    s_mov_b32 s25, s24
    v_cvt_pk_bf16_f32 v144, v140, v141
    v_cvt_pk_bf16_f32 v145, v142, v143
    v_mfma_f32_16x16x32_bf16 v[112:115], a[80:83], v[248:251], v[112:115]
    s_mov_b32 s24, s23
    v_cvt_pk_bf16_f32 v205, v206, v207
    v_mul_f32 v176, v169, v176
    v_mfma_f32_16x16x32_bf16 v[112:115], a[84:87], v[224:227], v[112:115]
    s_waitcnt lgkmcnt(0)
    v_mul_f32 v177, v169, v177
    v_cvt_pk_bf16_f32 v206, v176, v177
    v_mfma_f32_16x16x32_bf16 v[112:115], a[88:91], v[184:187], v[112:115]
    v_mul_f32 v178, v169, v178
    v_mul_f32 v179, v169, v179
    v_mfma_f32_16x16x32_bf16 v[112:115], a[92:95], v[172:175], v[112:115]
    v_cvt_pk_bf16_f32 v207, v178, v179
    v_mul_f32 v124, v169, v124
    v_mfma_f32_16x16x32_bf16 v[148:151], a[96:99], v[120:123], 0
    v_mul_f32 v125, v169, v125
    v_cvt_pk_bf16_f32 v194, v124, v125
    v_mfma_f32_16x16x32_bf16 v[148:151], a[100:103], v[188:191], v[148:151]
    v_mul_f32 v126, v169, v126
    v_mul_f32 v127, v169, v127
    v_mfma_f32_16x16x32_bf16 v[148:151], a[104:107], v[248:251], v[148:151]
    v_cvt_pk_bf16_f32 v195, v126, v127
    v_mul_f32 v216, v168, v216
    v_mfma_f32_16x16x32_bf16 v[148:151], a[108:111], v[224:227], v[148:151]
    v_mul_f32 v217, v168, v217
    v_cvt_pk_bf16_f32 v196, v216, v217
    v_mfma_f32_16x16x32_bf16 v[148:151], a[112:115], v[184:187], v[148:151]
    v_mul_f32 v218, v168, v218
    v_mul_f32 v219, v168, v219
    v_mfma_f32_16x16x32_bf16 v[148:151], a[116:119], v[172:175], v[148:151]
    v_cvt_pk_bf16_f32 v197, v218, v219
    v_mul_f32 v160, v168, v160
    v_mfma_f32_16x16x32_bf16 v[228:231], a[120:123], v[120:123], 0
    v_mul_f32 v161, v168, v161
    v_cvt_pk_bf16_f32 v198, v160, v161
    v_mfma_f32_16x16x32_bf16 v[228:231], a[124:127], v[188:191], v[228:231]
    v_mul_f32 v162, v168, v162
    v_mul_f32 v163, v168, v163
    v_mfma_f32_16x16x32_bf16 v[228:231], a[128:131], v[248:251], v[228:231]
    v_cvt_pk_bf16_f32 v199, v162, v163
    v_mul_f32 v116, v168, v116
    v_mfma_f32_16x16x32_bf16 v[228:231], a[132:135], v[224:227], v[228:231]
    v_mul_f32 v117, v168, v117
    v_cvt_pk_bf16_f32 v192, v116, v117
    v_mfma_f32_16x16x32_bf16 v[228:231], a[136:139], v[184:187], v[228:231]
    v_mul_f32 v118, v168, v118
    v_mul_f32 v119, v168, v119
    v_mfma_f32_16x16x32_bf16 v[228:231], a[140:143], v[172:175], v[228:231]
    v_cvt_pk_bf16_f32 v193, v118, v119
    v_fma_f32 v130, v112, v112, s32
    v_mfma_f32_16x16x32_bf16 v[212:215], a[0:3], v[120:123], 0
    v_fmac_f32 v130, v113, v113
    v_fmac_f32 v130, v114, v114
    v_mfma_f32_16x16x32_bf16 v[212:215], a[4:7], v[188:191], v[212:215]
    v_fmac_f32 v130, v115, v115
    v_fmac_f32 v130, v148, v148
    v_mfma_f32_16x16x32_bf16 v[212:215], a[8:11], v[248:251], v[212:215]
    v_fmac_f32 v130, v149, v149
    v_fmac_f32 v130, v150, v150
    v_mfma_f32_16x16x32_bf16 v[212:215], a[12:15], v[224:227], v[212:215]
    v_fmac_f32 v130, v151, v151
    v_fmac_f32 v130, v228, v228
    v_mfma_f32_16x16x32_bf16 v[212:215], a[16:19], v[184:187], v[212:215]
    v_fmac_f32 v130, v229, v229
    v_fmac_f32 v130, v230, v230
    v_mfma_f32_16x16x32_bf16 v[212:215], a[20:23], v[172:175], v[212:215]
    v_fmac_f32 v130, v231, v231
    v_mul_f32 v142, 0x3baaaaab, v240
    v_mfma_f32_16x16x32_bf16 v[232:235], a[24:27], v[120:123], 0
    v_rsq_f32 v142, v142
    v_mfma_f32_16x16x32_bf16 v[232:235], a[28:31], v[188:191], v[232:235]
    v_mul_f32 v147, 0x3baaaaab, v241
    v_mul_f32 v146, 0x3baaaaab, v242
    v_mfma_f32_16x16x32_bf16 v[232:235], a[32:35], v[248:251], v[232:235]
    v_fma_f32 v131, v212, v212, s32
    v_fmac_f32 v131, v213, v213
    v_mfma_f32_16x16x32_bf16 v[232:235], a[36:39], v[224:227], v[232:235]
    v_fmac_f32 v131, v214, v214
    v_fmac_f32 v131, v215, v215
    v_mfma_f32_16x16x32_bf16 v[232:235], a[40:43], v[184:187], v[232:235]
    v_rsq_f32 v147, v147
    v_mfma_f32_16x16x32_bf16 v[232:235], a[44:47], v[172:175], v[232:235]
    v_mul_f32 v136, v147, v136
    v_mul_f32 v137, v147, v137
    v_mfma_f32_16x16x32_bf16 v[240:243], a[48:51], v[120:123], 0
    v_cvt_pk_bf16_f32 v176, v136, v137
    v_mul_f32 v138, v147, v138
    v_mfma_f32_16x16x32_bf16 v[240:243], a[52:55], v[188:191], v[240:243]
    v_mul_f32 v139, v147, v139
    v_cvt_pk_bf16_f32 v177, v138, v139
    v_mfma_f32_16x16x32_bf16 v[240:243], a[56:59], v[248:251], v[240:243]
    v_fmac_f32 v131, v232, v232
    v_fmac_f32 v131, v233, v233
    v_mfma_f32_16x16x32_bf16 v[240:243], a[60:63], v[224:227], v[240:243]
    v_fmac_f32 v131, v234, v234
    v_fmac_f32 v131, v235, v235
    v_mfma_f32_16x16x32_bf16 v[240:243], a[64:67], v[184:187], v[240:243]
    v_mul_f32 v208, v147, v208
    v_mul_f32 v209, v147, v209
    v_mfma_f32_16x16x32_bf16 v[240:243], a[68:71], v[172:175], v[240:243]
    v_cvt_pk_bf16_f32 v178, v208, v209
    v_mul_f32 v210, v147, v210
    v_mfma_f32_16x16x32_bf16 v[216:219], v[120:123], a[144:147], 0
    v_mul_f32 v211, v147, v211
    v_cvt_pk_bf16_f32 v179, v210, v211
    v_mfma_f32_16x16x32_bf16 v[216:219], v[188:191], a[148:151], v[216:219]
    buffer_store_dwordx4 v[176:179], v16, s[12:15], 0 offen
    v_mul_f32 v156, v147, v156
    v_fmac_f32 v131, v240, v240
    v_fmac_f32 v131, v241, v241
    v_fmac_f32 v131, v242, v242
    v_mfma_f32_16x16x32_bf16 v[216:219], v[248:251], a[152:155], v[216:219]
    v_fmac_f32 v131, v243, v243
    v_cvt_pk_bf16_f32 v36, v131, v130
    v_mfma_f32_16x16x32_bf16 v[216:219], v[224:227], a[156:159], v[216:219]
    v_mul_f32 v157, v147, v157
    v_cvt_pk_bf16_f32 v118, v156, v157
    v_mfma_f32_16x16x32_bf16 v[136:139], v[32:35], v[36:39], 0
    v_mul_f32 v158, v147, v158
    v_mul_f32 v159, v147, v159
    v_mfma_f32_16x16x32_bf16 v[216:219], v[184:187], a[160:163], v[216:219]
    v_cvt_pk_bf16_f32 v119, v158, v159
    v_mul_f32 v180, v142, v180
    v_mfma_f32_16x16x32_bf16 v[216:219], v[172:175], a[164:167], v[216:219]
    v_rsq_f32 v146, v146
    v_mfma_f32_16x16x32_bf16 v[168:171], v[120:123], a[168:171], 0
    v_mul_f32 v200, v146, v200
    v_mul_f32 v201, v146, v201
    v_mfma_f32_16x16x32_bf16 v[168:171], v[188:191], a[172:175], v[168:171]
    v_cvt_pk_bf16_f32 v200, v200, v201
    v_mul_f32 v202, v146, v202
    v_mfma_f32_16x16x32_bf16 v[168:171], v[248:251], a[176:179], v[168:171]
    v_cvt_pk_bf16_f32 v130, v216, v217
    v_cvt_pk_bf16_f32 v131, v218, v219
    v_mfma_f32_16x16x32_bf16 v[168:171], v[224:227], a[180:183], v[168:171]
    ds_read_b128 v[176:179], v0 offset:32768
    v_mul_f32 v203, v146, v203
    v_mfma_f32_16x16x32_bf16 v[168:171], v[184:187], a[184:187], v[168:171]
    ds_read_b128 v[160:163], v1 offset:32768
    v_cvt_pk_bf16_f32 v201, v202, v203
    v_mfma_f32_16x16x32_bf16 v[168:171], v[172:175], a[188:191], v[168:171]
    ds_read_b128 v[208:211], v0 offset:32896
    v_mul_f32 v244, v146, v244
    v_mfma_f32_16x16x32_bf16 v[156:159], v[120:123], a[192:195], 0
    ds_read_b128 v[216:219], v1 offset:32896
    v_mul_f32 v245, v146, v245
    v_mfma_f32_16x16x32_bf16 v[156:159], v[188:191], a[196:199], v[156:159]
    ds_read_b128 v[124:127], v0 offset:33024
    v_cvt_pk_bf16_f32 v202, v244, v245
    v_mfma_f32_16x16x32_bf16 v[156:159], v[248:251], a[200:203], v[156:159]
    ds_read_b128 v[120:123], v1 offset:33024
    v_mul_f32 v246, v146, v246
    v_mfma_f32_16x16x32_bf16 v[156:159], v[224:227], a[204:207], v[156:159]
    v_mul_f32 v247, v146, v247
    v_cvt_pk_bf16_f32 v203, v246, v247
    v_mfma_f32_16x16x32_bf16 v[156:159], v[184:187], a[208:211], v[156:159]
    v_mul_f32 v132, v146, v132
    v_mul_f32 v133, v146, v133
    v_mfma_f32_16x16x32_bf16 v[156:159], v[172:175], a[212:215], v[156:159]
    s_waitcnt lgkmcnt(5)
    buffer_store_dwordx4 v[200:203], v17, s[12:15], 0 offen
    v_cvt_pk_bf16_f32 v116, v132, v133
    v_mul_f32 v134, v146, v134
    v_mul_f32 v135, v146, v135
    v_cvt_pk_bf16_f32 v117, v134, v135
    v_mfma_f32_16x16x32_bf16 v[200:203], a[72:75], v[176:179], 0
    s_waitcnt lgkmcnt(3)
    v_rsq_f32 v137, v137
    v_mfma_f32_16x16x32_bf16 v[200:203], a[76:79], v[160:163], v[200:203]
    s_waitcnt lgkmcnt(2)
    v_rsq_f32 v136, v136
    v_mfma_f32_16x16x32_bf16 v[200:203], a[80:83], v[208:211], v[200:203]
    s_waitcnt lgkmcnt(1)
    v_mul_f32 v136, s31, v136
    v_cvt_pk_bf16_f32 v166, v168, v169
    v_mfma_f32_16x16x32_bf16 v[200:203], a[84:87], v[216:219], v[200:203]
    s_waitcnt lgkmcnt(0)
    v_cvt_pk_bf16_f32 v167, v170, v171
    v_cvt_pk_bf16_f32 v146, v156, v157
    v_mfma_f32_16x16x32_bf16 v[200:203], a[88:91], v[124:127], v[200:203]
    v_cvt_pk_bf16_f32 v147, v158, v159
    v_mul_f32 v112, v137, v112
    v_mfma_f32_16x16x32_bf16 v[200:203], a[92:95], v[120:123], v[200:203]
    v_mul_f32 v113, v137, v113
    v_cvt_pk_bf16_f32 v184, v112, v113
    v_mfma_f32_16x16x32_bf16 v[168:171], a[96:99], v[176:179], 0
    v_mul_f32 v114, v137, v114
    v_mul_f32 v115, v137, v115
    v_mfma_f32_16x16x32_bf16 v[168:171], a[100:103], v[160:163], v[168:171]
    v_cvt_pk_bf16_f32 v185, v114, v115
    v_mul_f32 v148, v137, v148
    v_mfma_f32_16x16x32_bf16 v[168:171], a[104:107], v[208:211], v[168:171]
    v_mul_f32 v149, v137, v149
    v_cvt_pk_bf16_f32 v186, v148, v149
    v_mfma_f32_16x16x32_bf16 v[168:171], a[108:111], v[216:219], v[168:171]
    v_mul_f32 v150, v137, v150
    v_mul_f32 v151, v137, v151
    v_mfma_f32_16x16x32_bf16 v[168:171], a[112:115], v[124:127], v[168:171]
    s_waitcnt vmcnt(2)
    v_cvt_pk_bf16_f32 v187, v150, v151
    v_mul_f32 v228, v137, v228
    v_mfma_f32_16x16x32_bf16 v[168:171], a[116:119], v[120:123], v[168:171]
    s_nop 0
    v_mul_f32 v229, v137, v229
    v_cvt_pk_bf16_f32 v174, v228, v229
    v_mfma_f32_16x16x32_bf16 v[112:115], a[120:123], v[176:179], 0
    s_nop 0
    v_mul_f32 v230, v137, v230
    v_mul_f32 v231, v137, v231
    v_mfma_f32_16x16x32_bf16 v[112:115], a[124:127], v[160:163], v[112:115]
    s_nop 0
    v_cvt_pk_bf16_f32 v175, v230, v231
    v_mul_f32 v212, v136, v212
    v_mfma_f32_16x16x32_bf16 v[112:115], a[128:131], v[208:211], v[112:115]
    s_barrier
    v_mul_f32 v213, v136, v213
    v_cvt_pk_bf16_f32 v132, v212, v213
    v_mfma_f32_16x16x32_bf16 v[112:115], a[132:135], v[216:219], v[112:115]
    v_mul_f32 v214, v136, v214
    v_mul_f32 v215, v136, v215
    v_mfma_f32_16x16x32_bf16 v[112:115], a[136:139], v[124:127], v[112:115]
    buffer_load_dwordx4 v10, s[8:11], 0 offen nt lds
    v_cvt_pk_bf16_f32 v133, v214, v215
    v_mfma_f32_16x16x32_bf16 v[112:115], a[140:143], v[120:123], v[112:115]
    s_add_u32 m0, s28, 4096
    v_mul_f32 v232, v136, v232
    v_mul_f32 v233, v136, v233
    v_mfma_f32_16x16x32_bf16 v[188:191], a[0:3], v[176:179], 0
    v_cvt_pk_bf16_f32 v134, v232, v233
    v_mul_f32 v234, v136, v234
    v_mfma_f32_16x16x32_bf16 v[188:191], a[4:7], v[160:163], v[188:191]
    v_mul_f32 v235, v136, v235
    v_cvt_pk_bf16_f32 v135, v234, v235
    v_mfma_f32_16x16x32_bf16 v[188:191], a[8:11], v[208:211], v[188:191]
    v_mul_f32 v240, v136, v240
    v_mul_f32 v241, v136, v241
    v_mfma_f32_16x16x32_bf16 v[188:191], a[12:15], v[216:219], v[188:191]
    buffer_load_dwordx4 v11, s[8:11], 0 offen nt lds
    v_cvt_pk_bf16_f32 v172, v240, v241
    v_mfma_f32_16x16x32_bf16 v[188:191], a[16:19], v[124:127], v[188:191]
    s_add_u32 m0, s28, 8192
    v_mul_f32 v242, v136, v242
    v_mul_f32 v243, v136, v243
    v_mfma_f32_16x16x32_bf16 v[188:191], a[20:23], v[120:123], v[188:191]
    v_cvt_pk_bf16_f32 v173, v242, v243
    v_fma_f32 v140, v200, v200, s32
    v_mfma_f32_16x16x32_bf16 v[136:139], a[24:27], v[176:179], 0
    v_fmac_f32 v140, v201, v201
    v_fmac_f32 v140, v202, v202
    v_mfma_f32_16x16x32_bf16 v[136:139], a[28:31], v[160:163], v[136:139]
    v_fmac_f32 v140, v203, v203
    v_fmac_f32 v140, v168, v168
    v_mfma_f32_16x16x32_bf16 v[136:139], a[32:35], v[208:211], v[136:139]
    buffer_load_dwordx4 v12, s[8:11], 0 offen nt lds
    v_fma_f32 v141, v188, v188, s32
    v_mfma_f32_16x16x32_bf16 v[136:139], a[36:39], v[216:219], v[136:139]
    s_add_u32 m0, s28, 12288
    v_fmac_f32 v141, v189, v189
    v_fmac_f32 v141, v190, v190
    v_mfma_f32_16x16x32_bf16 v[136:139], a[40:43], v[124:127], v[136:139]
    s_xor_b32 s28, s28, 65536
    v_fmac_f32 v141, v191, v191
    v_fmac_f32 v140, v169, v169
    v_mfma_f32_16x16x32_bf16 v[136:139], a[44:47], v[120:123], v[136:139]
    v_fmac_f32 v140, v170, v170
    v_fmac_f32 v140, v171, v171
    v_mfma_f32_16x16x32_bf16 v[148:151], a[48:51], v[176:179], 0
    v_fmac_f32 v140, v112, v112
    v_fmac_f32 v140, v113, v113
    v_mfma_f32_16x16x32_bf16 v[148:151], a[52:55], v[160:163], v[148:151]
    buffer_load_dwordx4 v13, s[8:11], 0 offen nt lds
    v_fmac_f32 v140, v114, v114
    v_mfma_f32_16x16x32_bf16 v[148:151], a[56:59], v[208:211], v[148:151]
    s_mov_b32 m0, s29
    v_fmac_f32 v141, v136, v136
    v_fmac_f32 v141, v137, v137
    v_mfma_f32_16x16x32_bf16 v[148:151], a[60:63], v[216:219], v[148:151]
    s_xor_b32 s29, s29, s30
    v_fmac_f32 v141, v138, v138
    v_fmac_f32 v141, v139, v139
    v_mfma_f32_16x16x32_bf16 v[148:151], a[64:67], v[124:127], v[148:151]
    s_add_u32 s19, s19, s20
    v_fmac_f32 v140, v115, v115
    v_mul_f32 v181, v142, v181
    v_mfma_f32_16x16x32_bf16 v[148:151], a[68:71], v[120:123], v[148:151]
    s_add_u32 s23, s23, s21
    v_cvt_pk_bf16_f32 v156, v180, v181
    v_mul_f32 v182, v142, v182
    v_mfma_f32_16x16x32_bf16 v[220:223], v[176:179], a[144:147], 0
    s_cmp_ge_u32 s19, 72
    ds_read_b128 v[212:215], v5 offset:0
    ds_read_b128 v[224:227], v5 offset:16
    v_mfma_f32_16x16x32_bf16 v[220:223], v[160:163], a[148:151], v[220:223]
    s_cselect_b32 s34, 72, 0
    ds_read_b128 v[228:231], v5 offset:48
    ds_read_b32 v143, v6 offset:192
    v_mfma_f32_16x16x32_bf16 v[220:223], v[208:211], a[152:155], v[220:223]
    s_cselect_b32 s35, s22, 0
    buffer_store_dwordx2 v[116:117], v20, s[12:15], 0 offen
    v_fmac_f32 v141, v148, v148
    v_fmac_f32 v141, v149, v149
    v_mfma_f32_16x16x32_bf16 v[220:223], v[216:219], a[156:159], v[220:223]
    s_sub_u32 s19, s19, s34
    v_fmac_f32 v141, v150, v150
    v_fmac_f32 v141, v151, v151
    v_mfma_f32_16x16x32_bf16 v[220:223], v[124:127], a[160:163], v[220:223]
    s_add_u32 s23, s23, s35
    v_cvt_pk_bf16_f32 v36, v141, v140
    v_mul_f32 v183, v142, v183
    v_mfma_f32_16x16x32_bf16 v[220:223], v[120:123], a[164:167], v[220:223]
    s_add_u32 s18, s18, 1
    v_cvt_pk_bf16_f32 v157, v182, v183
    v_mul_f32 v108, v142, v108
    v_mfma_f32_16x16x32_bf16 v[180:183], v[32:35], v[36:39], 0
    s_cmp_lt_u32 s18, s17
    v_mul_f32 v109, v142, v109
    v_cvt_pk_bf16_f32 v158, v108, v109
    v_mfma_f32_16x16x32_bf16 v[232:235], v[176:179], a[168:171], 0
    s_waitcnt lgkmcnt(3)
    v_cvt_pk_bf16_f32 v116, v220, v221
    v_cvt_pk_bf16_f32 v117, v222, v223
    v_mfma_f32_16x16x32_bf16 v[220:223], v[212:215], v[196:199], v[22:25]
    s_waitcnt lgkmcnt(1)
    v_rsq_f32 v181, v181
    v_mfma_f32_16x16x32_bf16 v[220:223], v[224:227], v[204:207], v[220:223]
    s_waitcnt lgkmcnt(0)
    v_rsq_f32 v180, v180
    v_mfma_f32_16x16x32_bf16 v[220:223], v[228:231], v[192:195], v[220:223]
    v_mul_f32 v180, s31, v180
    v_mul_f32 v200, v181, v200
    v_mfma_f32_16x16x32_bf16 v[236:239], v[212:215], v[132:135], v[24:27]
    v_mul_f32 v201, v181, v201
    v_cvt_pk_bf16_f32 v200, v200, v201
    v_mfma_f32_16x16x32_bf16 v[236:239], v[224:227], v[184:187], v[236:239]
    v_mul_f32 v202, v181, v202
    v_mul_f32 v203, v181, v203
    v_mfma_f32_16x16x32_bf16 v[236:239], v[228:231], v[172:175], v[236:239]
    v_mov_b32_dpp v143, v221 quad_perm:[0,1,2,3] row_mask:0x1 bank_mask:0xf
    v_cvt_pk_bf16_f32 v201, v202, v203
    v_mfma_f32_16x16x32_bf16 v[232:235], v[160:163], a[172:175], v[232:235]
    v_mul_f32 v168, v181, v168
    v_mul_f32 v169, v181, v169
    v_mfma_f32_16x16x32_bf16 v[232:235], v[208:211], a[176:179], v[232:235]
    v_cvt_pk_bf16_f32 v202, v168, v169
    v_mul_f32 v170, v181, v170
    v_mfma_f32_16x16x32_bf16 v[232:235], v[216:219], a[180:183], v[232:235]
    v_mul_f32 v171, v181, v171
    v_cvt_pk_bf16_f32 v203, v170, v171
    v_mfma_f32_16x16x32_bf16 v[240:243], v[204:207], v[196:199], v[40:43]
    v_mul_f32 v112, v181, v112
    v_mul_f32 v113, v181, v113
    v_mfma_f32_16x16x32_bf16 v[248:251], v[184:187], v[196:199], v[44:47]
    v_cvt_pk_bf16_f32 v246, v112, v113
    v_mul_f32 v114, v181, v114
    v_mfma_f32_16x16x32_bf16 v[168:171], v[200:203], v[196:199], v[48:51]
    buffer_store_dwordx2 v[118:119], v19, s[12:15], 0 offen
    v_mul_f32 v115, v181, v115
    v_cvt_pk_bf16_f32 v247, v114, v115
    v_mfma_f32_16x16x16_bf16 v[240:243], v[194:195], v[192:193], v[240:243]
    v_mul_f32 v188, v180, v188
    v_mul_f32 v189, v180, v189
    v_cvt_pk_bf16_f32 v196, v188, v189
    v_mfma_f32_16x16x16_bf16 v[248:251], v[174:175], v[192:193], v[248:251]
    v_mul_f32 v190, v180, v190
    v_mul_f32 v191, v180, v191
    v_cvt_pk_bf16_f32 v197, v190, v191
    v_mfma_f32_16x16x16_bf16 v[168:171], v[246:247], v[192:193], v[168:171]
    v_mul_f32 v136, v180, v136
    v_mul_f32 v137, v180, v137
    v_cvt_pk_bf16_f32 v198, v136, v137
    v_mul_f32 v138, v180, v138
    v_mfma_f32_16x16x32_bf16 v[232:235], v[124:127], a[184:187], v[232:235]
    v_mul_f32 v139, v180, v139
    v_cvt_pk_bf16_f32 v199, v138, v139
    v_mfma_f32_16x16x32_bf16 v[232:235], v[120:123], a[188:191], v[232:235]
    v_mul_f32 v148, v180, v148
    v_mul_f32 v149, v180, v149
    v_mfma_f32_16x16x32_bf16 v[112:115], v[176:179], a[192:195], 0
    ds_read_b128 v[176:179], v2 offset:0
    v_cvt_pk_bf16_f32 v244, v148, v149
    v_mfma_f32_16x16x32_bf16 v[112:115], v[160:163], a[196:199], v[112:115]
    ds_read_b128 v[160:163], v2 offset:1024
    v_mul_f32 v150, v180, v150
    v_mfma_f32_16x16x32_bf16 v[112:115], v[208:211], a[200:203], v[112:115]
    ds_read_b128 v[136:139], v2 offset:2048
    v_cvt_pk_bf16_f32 v188, v232, v233
    v_mfma_f32_16x16x32_bf16 v[112:115], v[216:219], a[204:207], v[112:115]
    ds_read_b128 v[208:211], v2 offset:3072
    v_cvt_pk_bf16_f32 v189, v234, v235
    v_mfma_f32_16x16x32_bf16 v[112:115], v[124:127], a[208:211], v[112:115]
    ds_read_b128 v[124:127], v2 offset:4096
    ds_read2_b32 v[118:119], v6 offset0:0 offset1:0
    v_mfma_f32_16x16x32_bf16 v[112:115], v[120:123], a[212:215], v[112:115]
    ds_read_b128 v[120:123], v2 offset:5120
    ds_read2_b32 v[190:191], v6 offset0:16 offset1:16
    v_mfma_f32_16x16x32_bf16 v[232:235], v[212:215], v[196:199], v[26:29]
    v_mul_f32 v151, v180, v151
    v_cvt_pk_bf16_f32 v245, v150, v151
    v_mfma_f32_16x16x32_bf16 v[232:235], v[224:227], v[200:203], v[232:235]
    ds_read2_b32 v[218:219], v6 offset0:32 offset1:32
    v_mov_b32_dpp v143, v237 quad_perm:[0,1,2,3] row_mask:0x2 bank_mask:0xf
    v_mfma_f32_16x16x32_bf16 v[232:235], v[228:231], v[244:247], v[232:235]
    s_waitcnt lgkmcnt(8)
    v_cvt_pk_bf16_f32 v216, v112, v113
    v_cvt_pk_bf16_f32 v217, v114, v115
    v_mfma_f32_16x16x32_bf16 v[180:183], a[216:219], v[176:179], 0
    s_waitcnt lgkmcnt(7)
    v_mul_f32 v110, v142, v110
    v_mul_f32 v111, v142, v111
    v_mfma_f32_16x16x32_bf16 v[180:183], a[220:223], v[160:163], v[180:183]
    s_waitcnt lgkmcnt(6)
    v_cvt_pk_bf16_f32 v159, v110, v111
    v_mul_f32 v152, v142, v152
    v_mfma_f32_16x16x32_bf16 v[180:183], a[224:227], v[136:139], v[180:183]
    s_waitcnt lgkmcnt(5)
    buffer_store_dwordx4 v[156:159], v15, s[12:15], 0 offen
    v_mul_f32 v153, v142, v153
    v_cvt_pk_bf16_f32 v192, v152, v153
    v_mul_f32 v154, v142, v154
    v_mul_f32 v155, v142, v155
    v_mfma_f32_16x16x32_bf16 v[180:183], a[228:231], v[208:211], v[180:183]
    s_waitcnt lgkmcnt(1)
    v_cvt_pk_bf16_f32 v193, v154, v155
    v_mov_b32_dpp v143, v233 quad_perm:[0,1,2,3] row_mask:0x4 bank_mask:0xf
    v_mfma_f32_16x16x32_bf16 v[180:183], a[232:235], v[124:127], v[180:183]
    v_exp_f32 v232, v232
    v_mfma_f32_16x16x32_bf16 v[180:183], a[236:239], v[120:123], v[180:183]
    s_waitcnt lgkmcnt(0)
    v_exp_f32 v143, v143
    v_mfma_f32_16x16x32_bf16 v[108:111], a[240:243], v[176:179], 0
    v_cvt_pk_bf16_f32 v143, v143, v143
    v_add_u32 v5, 336, v5
    v_mfma_f32_16x16x32_bf16 v[108:111], a[244:247], v[160:163], v[108:111]
    ds_write_b16 v8, v143
    v_mfma_f32_16x16x32_bf16 v[108:111], a[248:251], v[136:139], v[108:111]
    v_exp_f32 v236, v236
    v_mfma_f32_16x16x32_bf16 v[108:111], a[252:255], v[208:211], v[108:111]
    ds_read_b128 v[140:143], v2 offset:6144
    ds_read_b128 v[224:227], v2 offset:7168
    v_mfma_f32_16x16x32_bf16 v[108:111], v[76:79], v[124:127], v[108:111]
    ds_read_b128 v[112:115], v2 offset:8192
    v_fma_f32 v221, v180, v180, s33
    v_mfma_f32_16x16x32_bf16 v[108:111], v[80:83], v[120:123], v[108:111]
    ds_read_b128 v[148:151], v2 offset:9216
    v_fmac_f32 v221, v181, v181
    v_mfma_f32_16x16x32_bf16 v[152:155], v[84:87], v[176:179], 0
    ds_read_b128 v[176:179], v2 offset:10240
    v_fmac_f32 v221, v182, v182
    v_mfma_f32_16x16x32_bf16 v[152:155], v[88:91], v[160:163], v[152:155]
    ds_read_b128 v[160:163], v2 offset:11264
    v_fmac_f32 v221, v183, v183
    v_mfma_f32_16x16x32_bf16 v[152:155], v[92:95], v[136:139], v[152:155]
    v_exp_f32 v240, v240
    v_mfma_f32_16x16x32_bf16 v[152:155], v[96:99], v[208:211], v[152:155]
    v_exp_f32 v241, v241
    v_mfma_f32_16x16x32_bf16 v[152:155], v[100:103], v[124:127], v[152:155]
    ds_read_b128 v[124:127], v9
    ds_read_b128 v[208:211], v9 offset:64
    v_mfma_f32_16x16x32_bf16 v[152:155], v[104:107], v[120:123], v[152:155]
    s_waitcnt lgkmcnt(6)
    v_cvt_pk_bf16_f32 v120, v240, v241
    v_fmac_f32 v221, v108, v108
    v_mfma_f32_16x16x32_bf16 v[136:139], a[216:219], v[140:143], 0
    s_waitcnt lgkmcnt(5)
    v_exp_f32 v242, v242
    v_mfma_f32_16x16x32_bf16 v[136:139], a[220:223], v[224:227], v[136:139]
    s_waitcnt lgkmcnt(4)
    buffer_store_dwordx2 v[192:193], v18, s[12:15], 0 offen
    v_exp_f32 v243, v243
    v_mfma_f32_16x16x32_bf16 v[136:139], a[224:227], v[112:115], v[136:139]
    s_waitcnt lgkmcnt(2)
    v_cvt_pk_bf16_f32 v121, v242, v243
    v_fmac_f32 v221, v109, v109
    v_mfma_f32_16x16x32_bf16 v[136:139], a[228:231], v[148:151], v[136:139]
    v_exp_f32 v248, v248
    v_mfma_f32_16x16x32_bf16 v[136:139], a[232:235], v[176:179], v[136:139]
    v_exp_f32 v249, v249
    v_mfma_f32_16x16x32_bf16 v[136:139], a[236:239], v[160:163], v[136:139]
    s_waitcnt lgkmcnt(1)
    v_cvt_pk_bf16_f32 v122, v248, v249
    v_fmac_f32 v221, v110, v110
    v_mfma_f32_16x16x32_bf16 v[240:243], v[124:127], v[28:31], 0
    s_waitcnt lgkmcnt(0)
    v_exp_f32 v250, v250
    v_mfma_f32_16x16x32_bf16 v[240:243], v[208:211], v[28:31], v[240:243]
    v_exp_f32 v251, v251
    v_mfma_f32_16x16x32_bf16 v[228:231], v[124:127], v[128:131], 0
    v_fma_f32 v192, v136, v136, s33
    v_fmac_f32 v192, v137, v137
    v_mfma_f32_16x16x32_bf16 v[228:231], v[208:211], v[116:119], v[228:231]
    v_fmac_f32 v192, v138, v138
    v_fmac_f32 v192, v139, v139
    v_mfma_f32_16x16x32_bf16 v[212:215], v[124:127], v[164:167], 0
    v_rcp_f32 v240, v240
    v_mfma_f32_16x16x32_bf16 v[212:215], v[208:211], v[188:191], v[212:215]
    v_cvt_pk_bf16_f32 v123, v250, v251
    v_fmac_f32 v221, v111, v111
    v_mfma_f32_16x16x32_bf16 v[248:251], v[124:127], v[144:147], 0
    v_mul_f32 v228, v228, v240
    v_fmac_f32 v221, v152, v152
    v_mfma_f32_16x16x32_bf16 v[248:251], v[208:211], v[216:219], v[248:251]
    v_exp_f32 v168, v168
    v_mfma_f32_16x16x32_bf16 v[208:211], a[240:243], v[140:143], 0
    v_mul_f32_dpp v228, v212, v240 quad_perm:[0,1,2,3] row_mask:0x2 bank_mask:0xf
    v_fmac_f32 v221, v153, v153
    v_mfma_f32_16x16x32_bf16 v[208:211], a[244:247], v[224:227], v[208:211]
    v_exp_f32 v169, v169
    v_mfma_f32_16x16x32_bf16 v[208:211], a[248:251], v[112:115], v[208:211]
    ds_read_b128 v[124:127], v2 offset:12288
    v_mul_f32_dpp v228, v248, v240 quad_perm:[0,1,2,3] row_mask:0x4 bank_mask:0xf
    v_mfma_f32_16x16x32_bf16 v[208:211], a[252:255], v[148:151], v[208:211]
    ds_read_b128 v[240:243], v2 offset:13312
    v_cvt_pk_bf16_f32 v228, v228, v228
    v_mfma_f32_16x16x32_bf16 v[208:211], v[76:79], v[176:179], v[208:211]
    ds_read_b128 v[212:215], v2 offset:14336
    buffer_load_dwordx4 v14, s[8:11], 0 offen nt lds
    v_mfma_f32_16x16x32_bf16 v[208:211], v[80:83], v[160:163], v[208:211]
    ds_read_b128 v[248:251], v2 offset:15360
    v_cvt_pk_bf16_f32 v36, v168, v169
    v_mfma_f32_16x16x32_bf16 v[156:159], v[84:87], v[140:143], 0
    ds_read_b128 v[140:143], v2 offset:16384
    v_fmac_f32 v221, v154, v154
    v_mfma_f32_16x16x32_bf16 v[156:159], v[88:91], v[224:227], v[156:159]
    ds_read_b128 v[224:227], v2 offset:17408
    v_fmac_f32 v221, v155, v155
    v_mfma_f32_16x16x32_bf16 v[156:159], v[92:95], v[112:115], v[156:159]
    ds_write_b16 v7, v228
    v_mfma_f32_16x16x32_bf16 v[156:159], v[96:99], v[148:151], v[156:159]
    v_fmac_f32 v192, v208, v208
    v_fmac_f32 v192, v209, v209
    v_mfma_f32_16x16x32_bf16 v[156:159], v[100:103], v[176:179], v[156:159]
    s_waitcnt lgkmcnt(6)
    v_fmac_f32 v192, v210, v210
    v_fmac_f32 v192, v211, v211
    v_mfma_f32_16x16x32_bf16 v[156:159], v[104:107], v[160:163], v[156:159]
    s_waitcnt lgkmcnt(5)
    v_exp_f32 v170, v170
    v_mfma_f32_16x16x32_bf16 v[160:163], v[204:207], v[132:135], v[52:55]
    s_waitcnt lgkmcnt(4)
    v_exp_f32 v171, v171
    v_mfma_f32_16x16x32_bf16 v[176:179], v[184:187], v[132:135], v[56:59]
    s_waitcnt lgkmcnt(3)
    v_cvt_pk_bf16_f32 v37, v170, v171
    v_fmac_f32 v192, v156, v156
    v_mfma_f32_16x16x32_bf16 v[168:171], v[200:203], v[132:135], v[60:63]
    s_waitcnt lgkmcnt(2)
    v_fmac_f32 v192, v157, v157
    v_fmac_f32 v192, v158, v158
    v_fmac_f32 v192, v159, v159
    v_mfma_f32_16x16x16_bf16 v[160:163], v[194:195], v[172:173], v[160:163]
    v_cvt_pk_bf16_f32 v234, v221, v192
    v_exp_f32 v220, v220
    v_mfma_f32_16x16x16_bf16 v[176:179], v[174:175], v[172:173], v[176:179]
    v_cvt_pk_bf16_f32 v39, v220, 0
    v_add_u32 v6, 272, v6
    v_add_u32 v7, 16, v7
    v_mfma_f32_16x16x16_bf16 v[168:171], v[246:247], v[172:173], v[168:171]
    v_xor_b32 v0, 65536, v0
    v_exp_f32 v160, v160
    v_xor_b32 v1, 65536, v1
    v_mfma_f32_16x16x32_bf16 v[132:135], v[28:31], v[36:39], 0
    s_waitcnt lgkmcnt(0)
    v_exp_f32 v161, v161
    v_mfma_f32_16x16x32_bf16 v[132:135], v[28:31], v[120:123], v[132:135]
    v_cvt_pk_bf16_f32 v192, v160, v161
    v_xor_b32 v2, 65536, v2
    v_mfma_f32_16x16x32_bf16 v[112:115], v[116:119], v[36:39], 0
    v_exp_f32 v162, v162
    v_mfma_f32_16x16x32_bf16 v[112:115], v[128:131], v[120:123], v[112:115]
    v_exp_f32 v163, v163
    v_mfma_f32_16x16x32_bf16 v[148:151], v[188:191], v[36:39], 0
    v_exp_f32 v176, v176
    v_mfma_f32_16x16x32_bf16 v[148:151], v[164:167], v[120:123], v[148:151]
    v_rcp_f32 v132, v132
    v_mfma_f32_16x16x32_bf16 v[220:223], v[216:219], v[36:39], 0
    v_cvt_pk_bf16_f32 v193, v162, v163
    v_cvt_pk_bf16_f32 v39, v236, 0
    v_mfma_f32_16x16x32_bf16 v[220:223], v[144:147], v[120:123], v[220:223]
    v_mul_f32 v112, v132, v112
    v_mul_f32 v113, v132, v113
    v_mfma_f32_16x16x32_bf16 v[160:163], v[204:207], v[196:199], v[64:67]
    v_cvt_pk_bf16_f32 v112, v112, v113
    v_mul_f32 v114, v132, v114
    v_mfma_f32_16x16x32_bf16 v[204:207], v[184:187], v[196:199], v[68:71]
    v_mul_f32 v115, v132, v115
    v_cvt_pk_bf16_f32 v113, v114, v115
    v_mfma_f32_16x16x32_bf16 v[120:123], v[200:203], v[196:199], v[72:75]
    v_mul_f32 v148, v132, v148
    v_mul_f32 v149, v132, v149
    v_cvt_pk_bf16_f32 v114, v148, v149
    v_mfma_f32_16x16x16_bf16 v[160:163], v[194:195], v[244:245], v[160:163]
    v_mul_f32 v150, v132, v150
    v_mul_f32 v151, v132, v151
    v_cvt_pk_bf16_f32 v115, v150, v151
    v_mfma_f32_16x16x16_bf16 v[204:207], v[174:175], v[244:245], v[204:207]
    v_mul_f32 v220, v132, v220
    v_mul_f32 v221, v132, v221
    v_cvt_pk_bf16_f32 v194, v220, v221
    v_mfma_f32_16x16x16_bf16 v[120:123], v[246:247], v[244:245], v[120:123]
    v_exp_f32 v160, v160
    v_exp_f32 v161, v161
    v_mfma_f32_16x16x32_bf16 v[200:203], a[216:219], v[124:127], 0
    ds_write_b128 v3, v[112:115] offset:0
    v_mfma_f32_16x16x32_bf16 v[200:203], a[220:223], v[240:243], v[200:203]
    v_cvt_pk_bf16_f32 v160, v160, v161
    v_mul_f32 v222, v132, v222
    v_mfma_f32_16x16x32_bf16 v[200:203], a[224:227], v[212:215], v[200:203]
    v_exp_f32 v162, v162
    v_mfma_f32_16x16x32_bf16 v[200:203], a[228:231], v[248:251], v[200:203]
    ds_read_b128 v[196:199], v0 offset:20480
    ds_read_b128 v[184:187], v1 offset:20480
    v_mfma_f32_16x16x32_bf16 v[200:203], a[232:235], v[140:143], v[200:203]
    ds_read_b128 v[172:175], v0 offset:20608
    ds_read_b128 v[148:151], v1 offset:20608
    v_mfma_f32_16x16x32_bf16 v[200:203], a[236:239], v[224:227], v[200:203]
    v_exp_f32 v163, v163
    v_mfma_f32_16x16x32_bf16 v[244:247], a[240:243], v[124:127], 0
    ds_read_b128 v[112:115], v0 offset:20736
    ds_read_b128 v[228:231], v1 offset:20736
    v_mfma_f32_16x16x32_bf16 v[244:247], a[244:247], v[240:243], v[244:247]
    v_cvt_pk_bf16_f32 v161, v162, v163
    v_mul_f32 v223, v132, v223
    v_mfma_f32_16x16x32_bf16 v[244:247], a[248:251], v[212:215], v[244:247]
    v_exp_f32 v204, v204
    v_mfma_f32_16x16x32_bf16 v[244:247], a[252:255], v[248:251], v[244:247]
    v_exp_f32 v205, v205
    v_mfma_f32_16x16x32_bf16 v[244:247], v[76:79], v[140:143], v[244:247]
    v_cvt_pk_bf16_f32 v162, v204, v205
    v_cvt_pk_bf16_f32 v195, v222, v223
    v_mfma_f32_16x16x32_bf16 v[244:247], v[80:83], v[224:227], v[244:247]
    s_waitcnt lgkmcnt(4)
    ds_write_b64 v4, v[194:195] offset:4096
    v_mfma_f32_16x16x32_bf16 v[132:135], v[84:87], v[124:127], 0
    s_waitcnt lgkmcnt(3)
    v_exp_f32 v206, v206
    v_mfma_f32_16x16x32_bf16 v[132:135], v[88:91], v[240:243], v[132:135]
    s_waitcnt lgkmcnt(2)
    v_exp_f32 v207, v207
    v_mfma_f32_16x16x32_bf16 v[132:135], v[92:95], v[212:215], v[132:135]
    s_waitcnt lgkmcnt(1)
    v_cvt_pk_bf16_f32 v163, v206, v207
    v_fma_f32 v233, v200, v200, s33
    v_mfma_f32_16x16x32_bf16 v[132:135], v[96:99], v[248:251], v[132:135]
    v_exp_f32 v120, v120
    v_mfma_f32_16x16x32_bf16 v[132:135], v[100:103], v[140:143], v[132:135]
    v_exp_f32 v121, v121
    v_mfma_f32_16x16x32_bf16 v[132:135], v[104:107], v[224:227], v[132:135]
    v_exp_f32 v122, v122
    v_mfma_f32_16x16x32_bf16 v[204:207], a[72:75], v[196:199], 0
    v_exp_f32 v123, v123
    v_mfma_f32_16x16x32_bf16 v[204:207], a[76:79], v[184:187], v[204:207]
    v_exp_f32 v177, v177
    v_mfma_f32_16x16x32_bf16 v[204:207], a[80:83], v[172:175], v[204:207]
    v_cvt_pk_bf16_f32 v194, v176, v177
    v_fmac_f32 v233, v201, v201
    v_mfma_f32_16x16x32_bf16 v[204:207], a[84:87], v[148:151], v[204:207]
    v_exp_f32 v178, v178
    v_mfma_f32_16x16x32_bf16 v[204:207], a[88:91], v[112:115], v[204:207]
    v_exp_f32 v179, v179
    v_mfma_f32_16x16x32_bf16 v[204:207], a[92:95], v[228:231], v[204:207]
    v_cvt_pk_bf16_f32 v195, v178, v179
    v_fmac_f32 v233, v202, v202
    v_mfma_f32_16x16x32_bf16 v[176:179], a[96:99], v[196:199], 0
    v_exp_f32 v168, v168
    v_mfma_f32_16x16x32_bf16 v[176:179], a[100:103], v[184:187], v[176:179]
    v_exp_f32 v169, v169
    v_mfma_f32_16x16x32_bf16 v[176:179], a[104:107], v[172:175], v[176:179]
    v_cvt_pk_bf16_f32 v36, v168, v169
    v_fmac_f32 v233, v203, v203
    v_mfma_f32_16x16x32_bf16 v[176:179], a[108:111], v[148:151], v[176:179]
    v_exp_f32 v170, v170
    v_mfma_f32_16x16x32_bf16 v[176:179], a[112:115], v[112:115], v[176:179]
    v_exp_f32 v171, v171
    v_mfma_f32_16x16x32_bf16 v[176:179], a[116:119], v[228:231], v[176:179]
    v_cvt_pk_bf16_f32 v37, v170, v171
    v_fmac_f32 v233, v244, v244
    v_mfma_f32_16x16x32_bf16 v[124:127], a[120:123], v[196:199], 0
    v_fmac_f32 v233, v245, v245
    v_fmac_f32 v233, v246, v246
    v_mfma_f32_16x16x32_bf16 v[168:171], v[28:31], v[36:39], 0
    v_fmac_f32 v233, v247, v247
    v_fmac_f32 v233, v132, v132
    v_mfma_f32_16x16x32_bf16 v[168:171], v[28:31], v[192:195], v[168:171]
    v_fmac_f32 v233, v133, v133
    v_fmac_f32 v233, v134, v134
    v_mfma_f32_16x16x32_bf16 v[140:143], v[116:119], v[36:39], 0
    v_fmac_f32 v233, v135, v135
    v_cvt_pk_bf16_f32 v235, v233, v233
    v_mfma_f32_16x16x32_bf16 v[140:143], v[128:131], v[192:195], v[140:143]
    ds_write_b64 v4, v[234:235] offset:18432
    v_mfma_f32_16x16x32_bf16 v[224:227], v[188:191], v[36:39], 0
    v_rcp_f32 v168, v168
    v_mfma_f32_16x16x32_bf16 v[224:227], v[164:167], v[192:195], v[224:227]
    v_fma_f32 v169, v204, v204, s32
    v_fmac_f32 v169, v205, v205
    v_mfma_f32_16x16x32_bf16 v[248:251], v[216:219], v[36:39], 0
    v_cvt_pk_bf16_f32 v36, v120, v121
    v_cvt_pk_bf16_f32 v37, v122, v123
    v_mfma_f32_16x16x32_bf16 v[248:251], v[144:147], v[192:195], v[248:251]
    v_cvt_pk_bf16_f32 v39, v232, 0
    v_mul_f32 v140, v168, v140
    v_mfma_f32_16x16x32_bf16 v[124:127], a[124:127], v[184:187], v[124:127]
    v_mul_f32 v141, v168, v141
    v_cvt_pk_bf16_f32 v192, v140, v141
    v_mfma_f32_16x16x32_bf16 v[120:123], v[28:31], v[36:39], 0
    v_mul_f32 v142, v168, v142
    v_mul_f32 v143, v168, v143
    v_mfma_f32_16x16x32_bf16 v[120:123], v[28:31], v[160:163], v[120:123]
    v_cvt_pk_bf16_f32 v193, v142, v143
    v_mul_f32 v224, v168, v224
    v_mfma_f32_16x16x32_bf16 v[140:143], v[116:119], v[36:39], 0
    v_mul_f32 v225, v168, v225
    v_cvt_pk_bf16_f32 v194, v224, v225
    v_mfma_f32_16x16x32_bf16 v[140:143], v[128:131], v[160:163], v[140:143]
    v_mul_f32 v226, v168, v226
    v_mul_f32 v227, v168, v227
    v_mfma_f32_16x16x32_bf16 v[128:131], v[188:191], v[36:39], 0
    v_cvt_pk_bf16_f32 v195, v226, v227
    v_mul_f32 v248, v168, v248
    v_mfma_f32_16x16x32_bf16 v[128:131], v[164:167], v[160:163], v[128:131]
    ds_write_b128 v3, v[192:195] offset:6144
    v_mfma_f32_16x16x32_bf16 v[164:167], v[216:219], v[36:39], 0
    v_mul_f32 v249, v168, v249
    v_cvt_pk_bf16_f32 v170, v248, v249
    v_mfma_f32_16x16x32_bf16 v[164:167], v[144:147], v[160:163], v[164:167]
    v_mul_f32 v250, v168, v250
    v_mul_f32 v251, v168, v251
    v_mfma_f32_16x16x32_bf16 v[124:127], a[128:131], v[172:175], v[124:127]
    v_cvt_pk_bf16_f32 v171, v250, v251
    v_fmac_f32 v169, v206, v206
    v_mfma_f32_16x16x32_bf16 v[124:127], a[132:135], v[148:151], v[124:127]
    ds_write_b64 v4, v[170:171] offset:10240
    v_mfma_f32_16x16x32_bf16 v[124:127], a[136:139], v[112:115], v[124:127]
    v_rcp_f32 v120, v120
    v_mfma_f32_16x16x32_bf16 v[124:127], a[140:143], v[228:231], v[124:127]
    v_mul_f32 v140, v120, v140
    v_mul_f32 v141, v120, v141
    v_mfma_f32_16x16x32_bf16 v[216:219], a[0:3], v[196:199], 0
    v_cvt_pk_bf16_f32 v144, v140, v141
    v_mul_f32 v142, v120, v142
    v_mfma_f32_16x16x32_bf16 v[216:219], a[4:7], v[184:187], v[216:219]
    v_mul_f32 v143, v120, v143
    v_cvt_pk_bf16_f32 v145, v142, v143
    v_mfma_f32_16x16x32_bf16 v[216:219], a[8:11], v[172:175], v[216:219]
    v_mul_f32 v128, v120, v128
    v_mul_f32 v129, v120, v129
    v_mfma_f32_16x16x32_bf16 v[216:219], a[12:15], v[148:151], v[216:219]
    v_cvt_pk_bf16_f32 v146, v128, v129
    v_mul_f32 v130, v120, v130
    v_mfma_f32_16x16x32_bf16 v[216:219], a[16:19], v[112:115], v[216:219]
    v_mul_f32 v131, v120, v131
    v_cvt_pk_bf16_f32 v147, v130, v131
    v_mfma_f32_16x16x32_bf16 v[216:219], a[20:23], v[228:231], v[216:219]
    ds_write_b128 v3, v[144:147] offset:12288
    v_mfma_f32_16x16x32_bf16 v[160:163], a[24:27], v[196:199], 0
    v_mul_f32 v164, v120, v164
    v_mul_f32 v165, v120, v165
    v_mfma_f32_16x16x32_bf16 v[160:163], a[28:31], v[184:187], v[160:163]
    v_cvt_pk_bf16_f32 v164, v164, v165
    v_mul_f32 v166, v120, v166
    v_mfma_f32_16x16x32_bf16 v[160:163], a[32:35], v[172:175], v[160:163]
    v_mul_f32 v167, v120, v167
    v_cvt_pk_bf16_f32 v165, v166, v167
    v_mfma_f32_16x16x32_bf16 v[160:163], a[36:39], v[148:151], v[160:163]
    ds_write_b64 v4, v[164:165] offset:16384
    v_mfma_f32_16x16x32_bf16 v[160:163], a[40:43], v[112:115], v[160:163]
    v_fmac_f32 v169, v207, v207
    v_fmac_f32 v169, v176, v176
    v_mfma_f32_16x16x32_bf16 v[160:163], a[44:47], v[228:231], v[160:163]
    v_fmac_f32 v169, v177, v177
    v_fmac_f32 v169, v178, v178
    v_mfma_f32_16x16x32_bf16 v[116:119], a[48:51], v[196:199], 0
    v_fmac_f32 v169, v179, v179
    v_fmac_f32 v169, v124, v124
    v_mfma_f32_16x16x32_bf16 v[116:119], a[52:55], v[184:187], v[116:119]
    v_fmac_f32 v169, v125, v125
    v_fmac_f32 v169, v126, v126
    v_mfma_f32_16x16x32_bf16 v[116:119], a[56:59], v[172:175], v[116:119]
    v_fmac_f32 v169, v127, v127
    v_fma_f32 v168, v216, v216, s32
    v_mfma_f32_16x16x32_bf16 v[116:119], a[60:63], v[148:151], v[116:119]
    v_fmac_f32 v168, v217, v217
    v_fmac_f32 v168, v218, v218
    v_mfma_f32_16x16x32_bf16 v[116:119], a[64:67], v[112:115], v[116:119]
    s_waitcnt lgkmcnt(0)
    v_fmac_f32 v168, v219, v219
    v_xor_b32 v3, 65536, v3
    v_mfma_f32_16x16x32_bf16 v[116:119], a[68:71], v[228:231], v[116:119]
    s_nop 0
    v_xor_b32 v4, 65536, v4
    v_mfma_f32_16x16x32_bf16 v[128:131], v[196:199], a[144:147], 0
    s_nop 0
    v_mfma_f32_16x16x32_bf16 v[128:131], v[184:187], a[148:151], v[128:131]
    s_nop 0
    v_mfma_f32_16x16x32_bf16 v[128:131], v[172:175], a[152:155], v[128:131]
    s_barrier
    v_mfma_f32_16x16x32_bf16 v[128:131], v[148:151], a[156:159], v[128:131]
    v_mfma_f32_16x16x32_bf16 v[128:131], v[112:115], a[160:163], v[128:131]
    v_mfma_f32_16x16x32_bf16 v[128:131], v[228:231], a[164:167], v[128:131]
    s_cbranch_scc1 L_loop_fast3
L_drain:
    ds_read_b128 v[112:115], v2 offset:18432
    ds_read_b128 v[116:119], v2 offset:19456
    ds_read_b128 v[120:123], v2 offset:0
    v_bfe_u32 v124, v2, 4, 6
    v_lshrrev_b32 v125, 4, v124
    v_and_b32 v124, 15, v124
    v_lshlrev_b32 v126, 9, v125
    v_lshl_add_u32 v126, v124, 4, v126
    v_add_u32 v126, 136704, v126
    v_mov_b32 v127, 0
    v_mov_b32 v129, 0
    v_mov_b32 v128, 0x40000000
    v_add_u32 v130, 0, v124
    v_mul_u32_u24 v131, s20, v130
    v_add_u32 v131, s38, v131
    v_mul_u32_u24 v131, 911, v131
    v_lshrrev_b32 v131, 16, v131
    v_mul_u32_u24 v131, s22, v131
    v_mad_u32_u24 v131, v130, s21, v131
    v_cmp_gt_u32 vcc, s17, v130
    v_add_u32 v130, s7, v131
    v_add_u32 v124, 16, v124
    v_cndmask_b32 v130, v128, v130, vcc
    v_lshl_add_u32 v131, v125, 4, v130
    v_lshl_add_u32 v130, v125, 3, v130
    v_mul_u32_u24 v140, s20, v124
    v_add_u32 v140, s38, v140
    v_mul_u32_u24 v140, 911, v140
    s_waitcnt lgkmcnt(2)
    v_mfma_f32_16x16x32_bf16 v[144:147], v[32:35], v[112:115], 0
    s_waitcnt lgkmcnt(0)
    ds_read_b128 v[112:115], v2 offset:1024
    ds_read_b128 v[148:151], v2 offset:2048
    v_mfma_f32_16x16x32_bf16 v[144:147], v[32:35], v[116:119], v[144:147]
    s_mov_b32 s12, s42
    ds_read_b128 v[116:119], v2 offset:3072
    ds_read_b128 v[160:163], v2 offset:4096
    v_mfma_f32_16x16x32_bf16 v[164:167], a[216:219], v[120:123], 0
    s_mov_b32 s13, s43
    v_lshrrev_b32 v140, 16, v140
    v_mul_u32_u24 v140, s22, v140
    v_mfma_f32_16x16x32_bf16 v[168:171], a[240:243], v[120:123], 0
    s_cmp_ge_u32 s18, 2
    ds_read_b128 v[172:175], v2 offset:5120
    v_mul_f32 v144, 0x3baaaaab, v144
    v_mfma_f32_16x16x32_bf16 v[176:179], v[84:87], v[120:123], 0
    s_cselect_b32 s14, s36, 0
    ds_read_b128 v[120:123], v2 offset:9216
    v_rsq_f32 v144, v144
    v_mul_f32 v141, 0x3baaaaab, v145
    v_mul_f32 v180, v144, v180
    v_mul_f32 v181, v144, v181
    v_cvt_pk_bf16_f32 v180, v180, v181
    v_mul_f32 v182, v144, v182
    v_mul_f32 v183, v144, v183
    v_cvt_pk_bf16_f32 v181, v182, v183
    v_mul_f32 v108, v144, v108
    v_mul_f32 v109, v144, v109
    s_waitcnt lgkmcnt(5)
    v_mfma_f32_16x16x32_bf16 v[164:167], a[220:223], v[112:115], v[164:167]
    s_waitcnt lgkmcnt(4)
    v_cvt_pk_bf16_f32 v182, v108, v109
    v_mul_f32 v110, v144, v110
    v_mfma_f32_16x16x32_bf16 v[164:167], a[224:227], v[148:151], v[164:167]
    s_waitcnt lgkmcnt(2)
    v_mul_f32 v111, v144, v111
    v_cvt_pk_bf16_f32 v183, v110, v111
    v_mfma_f32_16x16x32_bf16 v[164:167], a[228:231], v[116:119], v[164:167]
    s_lshl_b32 s3, s16, 6
    buffer_store_dwordx4 v[180:183], v15, s[12:15], s27 offen
    v_mul_f32 v152, v144, v152
    v_mul_f32 v153, v144, v153
    v_cvt_pk_bf16_f32 v142, v152, v153
    v_mfma_f32_16x16x32_bf16 v[164:167], a[232:235], v[160:163], v[164:167]
    s_waitcnt lgkmcnt(0)
    v_mul_f32 v154, v144, v154
    v_mul_f32 v155, v144, v155
    v_mfma_f32_16x16x32_bf16 v[164:167], a[236:239], v[172:175], v[164:167]
    s_lshl_b32 s4, s16, 5
    v_cvt_pk_bf16_f32 v143, v154, v155
    v_mul_f32 v108, 0x3baaaaab, v146
    v_mfma_f32_16x16x32_bf16 v[168:171], a[244:247], v[112:115], v[168:171]
    s_add_u32 s4, s4, 256
    buffer_store_dwordx2 v[142:143], v18, s[12:15], s27 offen
    v_add_u32 v131, s3, v131
    v_mfma_f32_16x16x32_bf16 v[168:171], a[248:251], v[148:151], v[168:171]
    s_lshl_b32 s3, s16, 6
    v_fma_f32 v142, v164, v164, s33
    v_fmac_f32 v142, v165, v165
    v_mfma_f32_16x16x32_bf16 v[168:171], a[252:255], v[116:119], v[168:171]
    ds_read_b128 v[144:147], v2 offset:6144
    v_fmac_f32 v142, v166, v166
    v_mfma_f32_16x16x32_bf16 v[168:171], v[76:79], v[160:163], v[168:171]
    ds_read_b128 v[152:155], v2 offset:7168
    v_fmac_f32 v142, v167, v167
    v_mfma_f32_16x16x32_bf16 v[168:171], v[80:83], v[172:175], v[168:171]
    ds_read_b128 v[180:183], v2 offset:8192
    v_add_u32 v130, s4, v130
    v_mfma_f32_16x16x32_bf16 v[176:179], v[88:91], v[112:115], v[176:179]
    s_lshl_b32 s4, s16, 5
    ds_read_b128 v[112:115], v2 offset:10240
    v_mad_u32_u24 v140, v124, s21, v140
    v_mfma_f32_16x16x32_bf16 v[176:179], v[92:95], v[148:151], v[176:179]
    s_add_u32 s4, s4, 256
    ds_read_b128 v[148:151], v2 offset:11264
    v_fmac_f32 v142, v168, v168
    v_mfma_f32_16x16x32_bf16 v[176:179], v[96:99], v[116:119], v[176:179]
    v_fmac_f32 v142, v169, v169
    v_fmac_f32 v142, v170, v170
    v_mfma_f32_16x16x32_bf16 v[176:179], v[100:103], v[160:163], v[176:179]
    v_fmac_f32 v142, v171, v171
    v_cmp_gt_u32 vcc, s17, v124
    v_mfma_f32_16x16x32_bf16 v[176:179], v[104:107], v[172:175], v[176:179]
    v_rsq_f32 v141, v141
    s_waitcnt lgkmcnt(4)
    v_mfma_f32_16x16x32_bf16 v[116:119], a[216:219], v[144:147], 0
    s_waitcnt lgkmcnt(3)
    v_mul_f32 v136, v141, v136
    v_mul_f32 v137, v141, v137
    v_mfma_f32_16x16x32_bf16 v[116:119], a[220:223], v[152:155], v[116:119]
    s_waitcnt lgkmcnt(2)
    v_fmac_f32 v142, v176, v176
    v_fmac_f32 v142, v177, v177
    v_mfma_f32_16x16x32_bf16 v[116:119], a[224:227], v[180:183], v[116:119]
    s_waitcnt lgkmcnt(1)
    v_fmac_f32 v142, v178, v178
    v_fmac_f32 v142, v179, v179
    v_mfma_f32_16x16x32_bf16 v[116:119], a[228:231], v[120:123], v[116:119]
    s_waitcnt lgkmcnt(0)
    v_cvt_pk_bf16_f32 v136, v136, v137
    v_mul_f32 v138, v141, v138
    v_mfma_f32_16x16x32_bf16 v[116:119], a[232:235], v[112:115], v[116:119]
    v_mul_f32 v139, v141, v139
    v_cvt_pk_bf16_f32 v137, v138, v139
    v_mfma_f32_16x16x32_bf16 v[116:119], a[236:239], v[148:151], v[116:119]
    v_mul_f32 v208, v141, v208
    v_mul_f32 v209, v141, v209
    v_mfma_f32_16x16x32_bf16 v[160:163], a[240:243], v[144:147], 0
    v_cvt_pk_bf16_f32 v138, v208, v209
    v_mul_f32 v210, v141, v210
    v_mfma_f32_16x16x32_bf16 v[160:163], a[244:247], v[152:155], v[160:163]
    v_mul_f32 v211, v141, v211
    v_cvt_pk_bf16_f32 v139, v210, v211
    v_mfma_f32_16x16x32_bf16 v[160:163], a[248:251], v[180:183], v[160:163]
    buffer_store_dwordx4 v[136:139], v16, s[12:15], s27 offen
    v_fma_f32 v124, v116, v116, s33
    v_fmac_f32 v124, v117, v117
    v_fmac_f32 v124, v118, v118
    v_mfma_f32_16x16x32_bf16 v[160:163], a[252:255], v[120:123], v[160:163]
    ds_read_b128 v[136:139], v2 offset:12288
    v_fmac_f32 v124, v119, v119
    v_mfma_f32_16x16x32_bf16 v[160:163], v[76:79], v[112:115], v[160:163]
    ds_read_b128 v[172:175], v2 offset:13312
    v_mul_f32 v156, v141, v156
    v_mfma_f32_16x16x32_bf16 v[160:163], v[80:83], v[148:151], v[160:163]
    ds_read_b128 v[184:187], v2 offset:14336
    v_mul_f32 v157, v141, v157
    v_mfma_f32_16x16x32_bf16 v[188:191], v[84:87], v[144:147], 0
    ds_read_b128 v[144:147], v2 offset:15360
    v_cvt_pk_bf16_f32 v156, v156, v157
    v_mfma_f32_16x16x32_bf16 v[188:191], v[88:91], v[152:155], v[188:191]
    ds_read_b128 v[152:155], v2 offset:16384
    v_mul_f32 v158, v141, v158
    v_mfma_f32_16x16x32_bf16 v[188:191], v[92:95], v[180:183], v[188:191]
    ds_read_b128 v[180:183], v2 offset:17408
    v_fmac_f32 v124, v160, v160
    v_mfma_f32_16x16x32_bf16 v[188:191], v[96:99], v[120:123], v[188:191]
    v_fmac_f32 v124, v161, v161
    v_fmac_f32 v124, v162, v162
    v_mfma_f32_16x16x32_bf16 v[188:191], v[100:103], v[112:115], v[188:191]
    v_fmac_f32 v124, v163, v163
    v_xor_b32 v2, 65536, v2
    v_mfma_f32_16x16x32_bf16 v[188:191], v[104:107], v[148:151], v[188:191]
    s_waitcnt lgkmcnt(5)
    v_mul_f32 v159, v141, v159
    v_cvt_pk_bf16_f32 v157, v158, v159
    v_mfma_f32_16x16x32_bf16 v[112:115], a[216:219], v[136:139], 0
    s_waitcnt lgkmcnt(4)
    buffer_store_dwordx2 v[156:157], v19, s[12:15], s27 offen
    v_add_u32 v109, s7, v140
    v_mfma_f32_16x16x32_bf16 v[112:115], a[220:223], v[172:175], v[112:115]
    s_waitcnt lgkmcnt(2)
    v_fmac_f32 v124, v188, v188
    v_fmac_f32 v124, v189, v189
    v_mfma_f32_16x16x32_bf16 v[112:115], a[224:227], v[184:187], v[112:115]
    s_waitcnt lgkmcnt(1)
    v_fmac_f32 v124, v190, v190
    v_fmac_f32 v124, v191, v191
    v_mfma_f32_16x16x32_bf16 v[112:115], a[228:231], v[144:147], v[112:115]
    s_waitcnt lgkmcnt(0)
    v_cvt_pk_bf16_f32 v110, v142, v124
    v_cndmask_b32 v109, v128, v109, vcc
    v_mfma_f32_16x16x32_bf16 v[112:115], a[232:235], v[152:155], v[112:115]
    v_rsq_f32 v108, v108
    v_mfma_f32_16x16x32_bf16 v[112:115], a[236:239], v[180:183], v[112:115]
    v_mul_f32 v200, v108, v200
    v_mul_f32 v201, v108, v201
    v_mfma_f32_16x16x32_bf16 v[120:123], a[240:243], v[136:139], 0
    v_cvt_pk_bf16_f32 v140, v200, v201
    v_mul_f32 v202, v108, v202
    v_mfma_f32_16x16x32_bf16 v[120:123], a[244:247], v[172:175], v[120:123]
    v_mul_f32 v203, v108, v203
    v_cvt_pk_bf16_f32 v141, v202, v203
    v_mfma_f32_16x16x32_bf16 v[120:123], a[248:251], v[184:187], v[120:123]
    v_fma_f32 v111, v112, v112, s33
    v_fmac_f32 v111, v113, v113
    v_mfma_f32_16x16x32_bf16 v[120:123], a[252:255], v[144:147], v[120:123]
    ds_read_b128 v[148:151], v126 offset:0
    v_fmac_f32 v111, v114, v114
    v_mfma_f32_16x16x32_bf16 v[120:123], v[76:79], v[152:155], v[120:123]
    ds_read_b128 v[156:159], v126 offset:2048
    v_fmac_f32 v111, v115, v115
    v_mfma_f32_16x16x32_bf16 v[120:123], v[80:83], v[180:183], v[120:123]
    ds_read_b128 v[192:195], v126 offset:4096
    v_mul_f32 v244, v108, v244
    v_mfma_f32_16x16x32_bf16 v[196:199], v[84:87], v[136:139], 0
    ds_read_b128 v[136:139], v126 offset:6144
    v_mul_f32 v245, v108, v245
    v_mfma_f32_16x16x32_bf16 v[196:199], v[88:91], v[172:175], v[196:199]
    ds_read_b128 v[172:175], v126 offset:8192
    v_cvt_pk_bf16_f32 v142, v244, v245
    v_mfma_f32_16x16x32_bf16 v[196:199], v[92:95], v[184:187], v[196:199]
    ds_read_b128 v[184:187], v126 offset:10240
    v_fmac_f32 v111, v120, v120
    v_mfma_f32_16x16x32_bf16 v[196:199], v[96:99], v[144:147], v[196:199]
    v_fmac_f32 v111, v121, v121
    v_fmac_f32 v111, v122, v122
    v_mfma_f32_16x16x32_bf16 v[196:199], v[100:103], v[152:155], v[196:199]
    v_fmac_f32 v111, v123, v123
    v_mul_f32 v246, v108, v246
    v_mfma_f32_16x16x32_bf16 v[196:199], v[104:107], v[180:183], v[196:199]
    s_waitcnt lgkmcnt(5)
    v_mul_f32 v247, v108, v247
    v_cvt_pk_bf16_f32 v143, v246, v247
    v_mfma_f32_16x16x32_bf16 v[144:147], a[216:219], v[148:151], 0
    s_waitcnt lgkmcnt(4)
    buffer_store_dwordx4 v[140:143], v17, s[12:15], s27 offen
    v_mul_f32 v132, v108, v132
    v_mul_f32 v133, v108, v133
    v_fmac_f32 v111, v196, v196
    v_mfma_f32_16x16x32_bf16 v[144:147], a[220:223], v[156:159], v[144:147]
    s_waitcnt lgkmcnt(2)
    v_fmac_f32 v111, v197, v197
    v_fmac_f32 v111, v198, v198
    v_mfma_f32_16x16x32_bf16 v[144:147], a[224:227], v[192:195], v[144:147]
    s_waitcnt lgkmcnt(1)
    v_fmac_f32 v111, v199, v199
    v_cvt_pk_bf16_f32 v111, v111, v111
    v_mfma_f32_16x16x32_bf16 v[144:147], a[228:231], v[136:139], v[144:147]
    s_waitcnt lgkmcnt(0)
    ds_write_b64 v4, v[110:111] offset:18432
    v_mfma_f32_16x16x32_bf16 v[144:147], a[232:235], v[172:175], v[144:147]
    v_cvt_pk_bf16_f32 v110, v132, v133
    v_mul_f32 v134, v108, v134
    v_mfma_f32_16x16x32_bf16 v[144:147], a[236:239], v[184:187], v[144:147]
    v_mul_f32 v135, v108, v135
    v_cvt_pk_bf16_f32 v111, v134, v135
    v_mfma_f32_16x16x32_bf16 v[132:135], a[240:243], v[148:151], 0
    buffer_store_dwordx2 v[110:111], v20, s[12:15], s27 offen
    v_lshl_add_u32 v124, v125, 4, v109
    v_mfma_f32_16x16x32_bf16 v[132:135], a[244:247], v[156:159], v[132:135]
    s_mov_b32 s14, s36
    v_add_u32 v124, s3, v124
    v_fma_f32 v128, v144, v144, s33
    v_mfma_f32_16x16x32_bf16 v[132:135], a[248:251], v[192:195], v[132:135]
    v_fmac_f32 v128, v145, v145
    v_fmac_f32 v128, v146, v146
    v_mfma_f32_16x16x32_bf16 v[132:135], a[252:255], v[136:139], v[132:135]
    ds_read_b128 v[140:143], v126 offset:256
    v_fmac_f32 v128, v147, v147
    v_mfma_f32_16x16x32_bf16 v[132:135], v[76:79], v[172:175], v[132:135]
    ds_read_b128 v[152:155], v126 offset:2304
    v_lshl_add_u32 v125, v125, 3, v109
    v_mfma_f32_16x16x32_bf16 v[132:135], v[80:83], v[184:187], v[132:135]
    ds_read_b128 v[108:111], v126 offset:4352
    v_add_u32 v125, s4, v125
    v_mfma_f32_16x16x32_bf16 v[180:183], v[84:87], v[148:151], 0
    ds_read_b128 v[148:151], v126 offset:6400
    v_mfma_f32_16x16x32_bf16 v[180:183], v[88:91], v[156:159], v[180:183]
    ds_read_b128 v[156:159], v126 offset:8448
    v_mfma_f32_16x16x32_bf16 v[180:183], v[92:95], v[192:195], v[180:183]
    ds_read_b128 v[192:195], v126 offset:10496
    v_fmac_f32 v128, v132, v132
    v_mfma_f32_16x16x32_bf16 v[180:183], v[96:99], v[136:139], v[180:183]
    v_fmac_f32 v128, v133, v133
    v_fmac_f32 v128, v134, v134
    v_mfma_f32_16x16x32_bf16 v[180:183], v[100:103], v[172:175], v[180:183]
    v_fmac_f32 v128, v135, v135
    v_mfma_f32_16x16x32_bf16 v[180:183], v[104:107], v[184:187], v[180:183]
    s_waitcnt lgkmcnt(5)
    v_mfma_f32_16x16x32_bf16 v[136:139], a[216:219], v[140:143], 0
    s_waitcnt lgkmcnt(4)
    v_mfma_f32_16x16x32_bf16 v[136:139], a[220:223], v[152:155], v[136:139]
    s_waitcnt lgkmcnt(3)
    v_mfma_f32_16x16x32_bf16 v[136:139], a[224:227], v[108:111], v[136:139]
    s_waitcnt lgkmcnt(2)
    v_mfma_f32_16x16x32_bf16 v[136:139], a[228:231], v[148:151], v[136:139]
    s_waitcnt lgkmcnt(1)
    v_fmac_f32 v128, v180, v180
    v_fmac_f32 v128, v181, v181
    v_mfma_f32_16x16x32_bf16 v[136:139], a[232:235], v[156:159], v[136:139]
    s_waitcnt lgkmcnt(0)
    v_fmac_f32 v128, v182, v182
    v_fmac_f32 v128, v183, v183
    v_mfma_f32_16x16x32_bf16 v[136:139], a[236:239], v[192:195], v[136:139]
    v_cvt_pk_bf16_f32 v126, v128, v128
    v_mfma_f32_16x16x32_bf16 v[172:175], a[240:243], v[140:143], 0
    ds_write_b64 v4, v[126:127] offset:0
    v_mfma_f32_16x16x32_bf16 v[172:175], a[244:247], v[152:155], v[172:175]
    v_mfma_f32_16x16x32_bf16 v[172:175], a[248:251], v[108:111], v[172:175]
    v_mfma_f32_16x16x32_bf16 v[172:175], a[252:255], v[148:151], v[172:175]
    v_mfma_f32_16x16x32_bf16 v[172:175], v[76:79], v[156:159], v[172:175]
    v_mfma_f32_16x16x32_bf16 v[172:175], v[80:83], v[192:195], v[172:175]
    v_fma_f32 v128, v136, v136, s33
    v_fmac_f32 v128, v137, v137
    v_mfma_f32_16x16x32_bf16 v[184:187], v[84:87], v[140:143], 0
    v_fmac_f32 v128, v138, v138
    v_fmac_f32 v128, v139, v139
    v_mfma_f32_16x16x32_bf16 v[184:187], v[88:91], v[152:155], v[184:187]
    v_mfma_f32_16x16x32_bf16 v[184:187], v[92:95], v[108:111], v[184:187]
    v_mfma_f32_16x16x32_bf16 v[184:187], v[96:99], v[148:151], v[184:187]
    v_fmac_f32 v128, v172, v172
    v_fmac_f32 v128, v173, v173
    v_mfma_f32_16x16x32_bf16 v[184:187], v[100:103], v[156:159], v[184:187]
    v_fmac_f32 v128, v174, v174
    v_fmac_f32 v128, v175, v175
    v_mfma_f32_16x16x32_bf16 v[184:187], v[104:107], v[192:195], v[184:187]
    s_nop 0
    s_nop 0
    s_nop 0
    s_nop 0
    s_nop 0
    s_nop 0
    s_nop 0
    s_nop 0
    v_fmac_f32 v128, v184, v184
    v_fmac_f32 v128, v185, v185
    v_fmac_f32 v128, v186, v186
    v_fmac_f32 v128, v187, v187
    v_cvt_pk_bf16_f32 v128, v128, v128
    ds_write_b64 v4, v[128:129] offset:2048
    s_waitcnt lgkmcnt(0)
    s_barrier
    ds_read_b128 v[108:111], v2 offset:18432
    ds_read_b128 v[140:143], v2 offset:19456
    ds_read_b128 v[148:151], v2 offset:0
    ds_read_b128 v[152:155], v2 offset:1024
    ds_read_b128 v[156:159], v2 offset:2048
    ds_read_b128 v[192:195], v2 offset:3072
    s_waitcnt lgkmcnt(5)
    v_mfma_f32_16x16x32_bf16 v[200:203], v[32:35], v[108:111], 0
    s_waitcnt lgkmcnt(4)
    v_mfma_f32_16x16x32_bf16 v[200:203], v[32:35], v[140:143], v[200:203]
    s_waitcnt lgkmcnt(2)
    v_mfma_f32_16x16x32_bf16 v[108:111], v[32:35], v[148:151], 0
    s_waitcnt lgkmcnt(1)
    v_mfma_f32_16x16x32_bf16 v[108:111], v[32:35], v[152:155], v[108:111]
    s_waitcnt lgkmcnt(0)
    v_mfma_f32_16x16x32_bf16 v[140:143], v[32:35], v[156:159], 0
    v_mfma_f32_16x16x32_bf16 v[140:143], v[32:35], v[192:195], v[140:143]
    s_nop 0
    v_mul_f32 v126, 0x3baaaaab, v200
    v_rsq_f32 v126, v126
    v_mul_f32 v127, 0x3baaaaab, v201
    v_mul_f32 v164, v126, v164
    v_mul_f32 v165, v126, v165
    v_cvt_pk_bf16_f32 v148, v164, v165
    v_mul_f32 v166, v126, v166
    v_mul_f32 v167, v126, v167
    v_cvt_pk_bf16_f32 v149, v166, v167
    v_mul_f32 v168, v126, v168
    v_mul_f32 v169, v126, v169
    v_cvt_pk_bf16_f32 v150, v168, v169
    v_mul_f32 v170, v126, v170
    v_mul_f32 v171, v126, v171
    v_cvt_pk_bf16_f32 v151, v170, v171
    v_mul_f32 v176, v126, v176
    v_mul_f32 v177, v126, v177
    v_cvt_pk_bf16_f32 v128, v176, v177
    v_mul_f32 v178, v126, v178
    v_mul_f32 v179, v126, v179
    v_cvt_pk_bf16_f32 v129, v178, v179
    v_rsq_f32 v127, v127
    v_mul_f32 v126, 0x3baaaaab, v202
    v_mul_f32 v116, v127, v116
    v_mul_f32 v117, v127, v117
    v_cvt_pk_bf16_f32 v116, v116, v117
    v_mul_f32 v118, v127, v118
    v_mul_f32 v119, v127, v119
    v_cvt_pk_bf16_f32 v117, v118, v119
    v_mul_f32 v160, v127, v160
    v_mul_f32 v161, v127, v161
    v_cvt_pk_bf16_f32 v118, v160, v161
    v_mul_f32 v162, v127, v162
    v_mul_f32 v163, v127, v163
    v_cvt_pk_bf16_f32 v119, v162, v163
    v_mul_f32 v188, v127, v188
    v_mul_f32 v189, v127, v189
    v_cvt_pk_bf16_f32 v142, v188, v189
    v_mul_f32 v190, v127, v190
    v_mul_f32 v191, v127, v191
    v_cvt_pk_bf16_f32 v143, v190, v191
    v_rsq_f32 v126, v126
    v_mul_f32 v141, 0x3baaaaab, v108
    v_mul_f32 v112, v126, v112
    v_mul_f32 v113, v126, v113
    v_cvt_pk_bf16_f32 v108, v112, v113
    v_mul_f32 v114, v126, v114
    v_mul_f32 v115, v126, v115
    v_cvt_pk_bf16_f32 v109, v114, v115
    v_mul_f32 v120, v126, v120
    v_mul_f32 v121, v126, v121
    v_cvt_pk_bf16_f32 v110, v120, v121
    v_mul_f32 v122, v126, v122
    v_mul_f32 v123, v126, v123
    v_cvt_pk_bf16_f32 v111, v122, v123
    v_mul_f32 v196, v126, v196
    v_mul_f32 v197, v126, v197
    v_cvt_pk_bf16_f32 v196, v196, v197
    v_mul_f32 v198, v126, v198
    v_mul_f32 v199, v126, v199
    v_cvt_pk_bf16_f32 v197, v198, v199
    v_rsq_f32 v141, v141
    v_mul_f32 v140, 0x3baaaaab, v140
    v_mul_f32 v144, v141, v144
    v_mul_f32 v145, v141, v145
    v_cvt_pk_bf16_f32 v112, v144, v145
    v_mul_f32 v146, v141, v146
    v_mul_f32 v147, v141, v147
    v_cvt_pk_bf16_f32 v113, v146, v147
    v_mul_f32 v132, v141, v132
    v_mul_f32 v133, v141, v133
    v_cvt_pk_bf16_f32 v114, v132, v133
    v_mul_f32 v134, v141, v134
    v_mul_f32 v135, v141, v135
    v_cvt_pk_bf16_f32 v115, v134, v135
    v_mul_f32 v180, v141, v180
    v_mul_f32 v181, v141, v181
    v_cvt_pk_bf16_f32 v126, v180, v181
    v_mul_f32 v182, v141, v182
    v_mul_f32 v183, v141, v183
    v_cvt_pk_bf16_f32 v127, v182, v183
    v_rsq_f32 v140, v140
    s_nop 0
    v_mul_f32 v136, v140, v136
    v_mul_f32 v137, v140, v137
    v_cvt_pk_bf16_f32 v120, v136, v137
    v_mul_f32 v138, v140, v138
    v_mul_f32 v139, v140, v139
    v_cvt_pk_bf16_f32 v121, v138, v139
    v_mul_f32 v172, v140, v172
    v_mul_f32 v173, v140, v173
    v_cvt_pk_bf16_f32 v122, v172, v173
    v_mul_f32 v174, v140, v174
    v_mul_f32 v175, v140, v175
    v_cvt_pk_bf16_f32 v123, v174, v175
    v_mul_f32 v184, v140, v184
    v_mul_f32 v185, v140, v185
    v_cvt_pk_bf16_f32 v198, v184, v185
    v_mul_f32 v186, v140, v186
    v_mul_f32 v187, v140, v187
    v_cvt_pk_bf16_f32 v199, v186, v187
    buffer_store_dwordx4 v[148:151], v15, s[12:15], s26 offen
    buffer_store_dwordx2 v[128:129], v18, s[12:15], s26 offen
    buffer_store_dwordx4 v[116:119], v16, s[12:15], s26 offen
    buffer_store_dwordx2 v[142:143], v19, s[12:15], s26 offen
    buffer_store_dwordx4 v[108:111], v17, s[12:15], s26 offen
    buffer_store_dwordx2 v[196:197], v20, s[12:15], s26 offen
    buffer_store_dwordx4 v[112:115], v131, s[12:15], 0 offen
    buffer_store_dwordx2 v[126:127], v130, s[12:15], 0 offen
    buffer_store_dwordx4 v[120:123], v124, s[12:15], 0 offen
    buffer_store_dwordx2 v[198:199], v125, s[12:15], 0 offen
L_done:
    s_endpgm
L_safe:
    s_cmp_eq_u32 s16, 1
    s_cbranch_scc1 L_loop_safe1
    s_cmp_eq_u32 s16, 2
    s_cbranch_scc1 L_loop_safe2
    s_cmp_eq_u32 s16, 3
    s_cbranch_scc1 L_loop_safe3
    s_branch L_loop_safe0
.p2align 6
L_loop_safe0:
    v_mfma_f32_16x16x32_bf16 v[188:191], v[196:199], a[168:171], 0
    s_add_u32 s12, s42, s27
    ds_read_b128 v[192:195], v2 offset:18432
    ds_read_b128 v[164:167], v2 offset:19456
    v_mfma_f32_16x16x32_bf16 v[188:191], v[184:187], a[172:175], v[188:191]
    s_addc_u32 s13, s43, 0
    ds_read_b128 v[120:123], v0 offset:26624
    ds_read_b128 v[140:143], v1 offset:26624
    v_mfma_f32_16x16x32_bf16 v[188:191], v[172:175], a[176:179], v[188:191]
    s_sub_u32 s14, s36, s27
    v_fmac_f32 v168, v160, v160
    v_fmac_f32 v168, v161, v161
    v_mfma_f32_16x16x32_bf16 v[188:191], v[148:151], a[180:183], v[188:191]
    s_cmp_ge_u32 s18, 2
    ds_read_b128 v[232:235], v0 offset:26752
    ds_read_b128 v[224:227], v1 offset:26752
    v_mfma_f32_16x16x32_bf16 v[188:191], v[112:115], a[184:187], v[188:191]
    s_cselect_b32 s14, s14, 0
    v_fmac_f32 v168, v162, v162
    v_fmac_f32 v168, v163, v163
    v_mfma_f32_16x16x32_bf16 v[188:191], v[228:231], a[188:191], v[188:191]
    s_add_u32 s34, s18, 2
    ds_read_b128 v[212:215], v0 offset:26880
    ds_read_b128 v[144:147], v1 offset:26880
    v_mfma_f32_16x16x32_bf16 v[220:223], v[196:199], a[192:195], 0
    s_add_u32 s8, s40, s23
    v_fmac_f32 v168, v116, v116
    v_fmac_f32 v168, v117, v117
    v_mfma_f32_16x16x32_bf16 v[220:223], v[184:187], a[196:199], v[220:223]
    s_addc_u32 s9, s41, 0
    v_fmac_f32 v168, v118, v118
    v_fmac_f32 v168, v119, v119
    v_mfma_f32_16x16x32_bf16 v[220:223], v[172:175], a[200:203], v[220:223]
    s_waitcnt lgkmcnt(6)
    v_cvt_pk_bf16_f32 v36, v168, v169
    v_cvt_pk_bf16_f32 v236, v128, v129
    v_mfma_f32_16x16x32_bf16 v[172:175], v[32:35], v[192:195], 0
    s_waitcnt lgkmcnt(4)
    v_cvt_pk_bf16_f32 v237, v130, v131
    v_cvt_pk_bf16_f32 v128, v188, v189
    v_mfma_f32_16x16x32_bf16 v[168:171], v[32:35], v[36:39], 0
    s_sub_u32 s10, s36, s23
    v_cvt_pk_bf16_f32 v129, v190, v191
    s_cmp_lt_u32 s34, s17
    v_mfma_f32_16x16x32_bf16 v[172:175], v[32:35], v[164:167], v[172:175]
    s_cselect_b32 s10, s10, 0
    s_add_u32 m0, s28, 0
    s_mov_b32 s27, s26
    v_mfma_f32_16x16x32_bf16 v[220:223], v[148:151], a[204:207], v[220:223]
    s_mov_b32 s26, s25
    v_rsq_f32 v169, v169
    v_mfma_f32_16x16x32_bf16 v[220:223], v[112:115], a[208:211], v[220:223]
    s_mov_b32 s25, s24
    v_rsq_f32 v168, v168
    v_mfma_f32_16x16x32_bf16 v[220:223], v[228:231], a[212:215], v[220:223]
    s_mov_b32 s24, s23
    v_mul_f32 v168, s31, v168
    v_mul_f32 v171, 0x3baaaaab, v172
    v_mfma_f32_16x16x32_bf16 v[112:115], a[72:75], v[120:123], 0
    s_waitcnt lgkmcnt(0)
    v_rsq_f32 v171, v171
    v_mfma_f32_16x16x32_bf16 v[112:115], a[76:79], v[140:143], v[112:115]
    v_mul_f32 v172, 0x3baaaaab, v173
    v_cvt_pk_bf16_f32 v164, v220, v221
    v_mfma_f32_16x16x32_bf16 v[112:115], a[80:83], v[232:235], v[112:115]
    v_cvt_pk_bf16_f32 v165, v222, v223
    v_mul_f32 v170, 0x3baaaaab, v174
    v_mfma_f32_16x16x32_bf16 v[112:115], a[84:87], v[224:227], v[112:115]
    v_rsq_f32 v172, v172
    v_mfma_f32_16x16x32_bf16 v[112:115], a[88:91], v[212:215], v[112:115]
    v_rsq_f32 v170, v170
    v_mfma_f32_16x16x32_bf16 v[112:115], a[92:95], v[144:147], v[112:115]
    v_mul_f32 v180, v171, v180
    v_mul_f32 v181, v171, v181
    v_mfma_f32_16x16x32_bf16 v[148:151], a[96:99], v[120:123], 0
    v_cvt_pk_bf16_f32 v180, v180, v181
    v_mul_f32 v182, v171, v182
    v_mfma_f32_16x16x32_bf16 v[148:151], a[100:103], v[140:143], v[148:151]
    v_mul_f32 v183, v171, v183
    v_cvt_pk_bf16_f32 v181, v182, v183
    v_mfma_f32_16x16x32_bf16 v[148:151], a[104:107], v[232:235], v[148:151]
    v_mul_f32 v108, v171, v108
    v_mul_f32 v109, v171, v109
    v_mfma_f32_16x16x32_bf16 v[148:151], a[108:111], v[224:227], v[148:151]
    v_cvt_pk_bf16_f32 v182, v108, v109
    v_mul_f32 v110, v171, v110
    v_mfma_f32_16x16x32_bf16 v[148:151], a[112:115], v[212:215], v[148:151]
    v_mul_f32 v111, v171, v111
    v_cvt_pk_bf16_f32 v183, v110, v111
    v_mfma_f32_16x16x32_bf16 v[148:151], a[116:119], v[144:147], v[148:151]
    buffer_store_dwordx4 v[180:183], v15, s[12:15], 0 offen
    v_mul_f32 v152, v171, v152
    v_mul_f32 v153, v171, v153
    v_cvt_pk_bf16_f32 v130, v152, v153
    v_mul_f32 v154, v171, v154
    v_mfma_f32_16x16x32_bf16 v[180:183], a[120:123], v[120:123], 0
    v_mul_f32 v155, v171, v155
    v_cvt_pk_bf16_f32 v131, v154, v155
    v_mfma_f32_16x16x32_bf16 v[180:183], a[124:127], v[140:143], v[180:183]
    v_mul_f32 v204, v169, v204
    v_mul_f32 v205, v169, v205
    v_mfma_f32_16x16x32_bf16 v[180:183], a[128:131], v[232:235], v[180:183]
    v_cvt_pk_bf16_f32 v184, v204, v205
    v_mul_f32 v206, v169, v206
    v_mfma_f32_16x16x32_bf16 v[180:183], a[132:135], v[224:227], v[180:183]
    v_mul_f32 v207, v169, v207
    v_cvt_pk_bf16_f32 v185, v206, v207
    v_mfma_f32_16x16x32_bf16 v[180:183], a[136:139], v[212:215], v[180:183]
    v_mul_f32 v176, v169, v176
    v_mul_f32 v177, v169, v177
    v_mfma_f32_16x16x32_bf16 v[180:183], a[140:143], v[144:147], v[180:183]
    v_cvt_pk_bf16_f32 v186, v176, v177
    v_mul_f32 v178, v169, v178
    v_mfma_f32_16x16x32_bf16 v[108:111], a[0:3], v[120:123], 0
    v_mul_f32 v179, v169, v179
    v_cvt_pk_bf16_f32 v187, v178, v179
    v_mfma_f32_16x16x32_bf16 v[108:111], a[4:7], v[140:143], v[108:111]
    v_mul_f32 v124, v169, v124
    v_mul_f32 v125, v169, v125
    v_mfma_f32_16x16x32_bf16 v[108:111], a[8:11], v[232:235], v[108:111]
    v_cvt_pk_bf16_f32 v178, v124, v125
    v_mul_f32 v126, v169, v126
    v_mfma_f32_16x16x32_bf16 v[108:111], a[12:15], v[224:227], v[108:111]
    v_mul_f32 v127, v169, v127
    v_cvt_pk_bf16_f32 v179, v126, v127
    v_mfma_f32_16x16x32_bf16 v[108:111], a[16:19], v[212:215], v[108:111]
    v_mul_f32 v216, v168, v216
    v_mul_f32 v217, v168, v217
    v_mfma_f32_16x16x32_bf16 v[108:111], a[20:23], v[144:147], v[108:111]
    v_cvt_pk_bf16_f32 v124, v216, v217
    v_mul_f32 v218, v168, v218
    v_mfma_f32_16x16x32_bf16 v[152:155], a[24:27], v[120:123], 0
    v_mul_f32 v219, v168, v219
    v_cvt_pk_bf16_f32 v125, v218, v219
    v_mfma_f32_16x16x32_bf16 v[152:155], a[28:31], v[140:143], v[152:155]
    v_mul_f32 v160, v168, v160
    v_mul_f32 v161, v168, v161
    v_mfma_f32_16x16x32_bf16 v[152:155], a[32:35], v[232:235], v[152:155]
    v_cvt_pk_bf16_f32 v126, v160, v161
    v_mul_f32 v162, v168, v162
    v_mfma_f32_16x16x32_bf16 v[152:155], a[36:39], v[224:227], v[152:155]
    v_mul_f32 v163, v168, v163
    v_cvt_pk_bf16_f32 v127, v162, v163
    v_mfma_f32_16x16x32_bf16 v[152:155], a[40:43], v[212:215], v[152:155]
    buffer_store_dwordx2 v[130:131], v18, s[12:15], 0 offen
    v_mul_f32 v116, v168, v116
    v_mul_f32 v117, v168, v117
    v_mfma_f32_16x16x32_bf16 v[152:155], a[44:47], v[144:147], v[152:155]
    v_cvt_pk_bf16_f32 v176, v116, v117
    v_mul_f32 v118, v168, v118
    v_mfma_f32_16x16x32_bf16 v[160:163], a[48:51], v[120:123], 0
    v_mul_f32 v119, v168, v119
    v_cvt_pk_bf16_f32 v177, v118, v119
    v_mfma_f32_16x16x32_bf16 v[160:163], a[52:55], v[140:143], v[160:163]
    v_fma_f32 v130, v108, v108, s32
    v_fmac_f32 v130, v109, v109
    v_mfma_f32_16x16x32_bf16 v[160:163], a[56:59], v[232:235], v[160:163]
    v_fmac_f32 v130, v110, v110
    v_fmac_f32 v130, v111, v111
    v_mfma_f32_16x16x32_bf16 v[160:163], a[60:63], v[224:227], v[160:163]
    v_fmac_f32 v130, v152, v152
    v_fmac_f32 v130, v153, v153
    v_mfma_f32_16x16x32_bf16 v[160:163], a[64:67], v[212:215], v[160:163]
    v_fmac_f32 v130, v154, v154
    v_fmac_f32 v130, v155, v155
    v_mfma_f32_16x16x32_bf16 v[160:163], a[68:71], v[144:147], v[160:163]
    v_fma_f32 v131, v112, v112, s32
    v_fmac_f32 v131, v113, v113
    v_mfma_f32_16x16x32_bf16 v[188:191], v[120:123], a[144:147], 0
    v_fmac_f32 v131, v114, v114
    v_fmac_f32 v131, v115, v115
    v_mfma_f32_16x16x32_bf16 v[188:191], v[140:143], a[148:151], v[188:191]
    v_fmac_f32 v131, v148, v148
    v_fmac_f32 v131, v149, v149
    v_mfma_f32_16x16x32_bf16 v[188:191], v[232:235], a[152:155], v[188:191]
    v_fmac_f32 v130, v160, v160
    v_fmac_f32 v130, v161, v161
    v_mfma_f32_16x16x32_bf16 v[188:191], v[224:227], a[156:159], v[188:191]
    v_fmac_f32 v130, v162, v162
    v_fmac_f32 v130, v163, v163
    v_mfma_f32_16x16x32_bf16 v[188:191], v[212:215], a[160:163], v[188:191]
    v_fmac_f32 v131, v150, v150
    v_fmac_f32 v131, v151, v151
    v_mfma_f32_16x16x32_bf16 v[188:191], v[144:147], a[164:167], v[188:191]
    v_fmac_f32 v131, v180, v180
    v_fmac_f32 v131, v181, v181
    v_mfma_f32_16x16x32_bf16 v[196:199], v[120:123], a[168:171], 0
    ds_read_b128 v[116:119], v0 offset:32768
    v_fmac_f32 v131, v182, v182
    v_mfma_f32_16x16x32_bf16 v[196:199], v[140:143], a[172:175], v[196:199]
    ds_read_b128 v[204:207], v1 offset:32768
    v_fmac_f32 v131, v183, v183
    v_mfma_f32_16x16x32_bf16 v[196:199], v[232:235], a[176:179], v[196:199]
    ds_read_b128 v[192:195], v0 offset:32896
    v_cvt_pk_bf16_f32 v238, v188, v189
    v_mfma_f32_16x16x32_bf16 v[196:199], v[224:227], a[180:183], v[196:199]
    ds_read_b128 v[220:223], v1 offset:32896
    v_cvt_pk_bf16_f32 v239, v190, v191
    v_mfma_f32_16x16x32_bf16 v[196:199], v[212:215], a[184:187], v[196:199]
    ds_read_b128 v[188:191], v0 offset:33024
    v_cvt_pk_bf16_f32 v36, v130, v131
    v_mfma_f32_16x16x32_bf16 v[196:199], v[144:147], a[188:191], v[196:199]
    ds_read_b128 v[240:243], v1 offset:33024
    v_mul_f32 v200, v170, v200
    v_mfma_f32_16x16x32_bf16 v[216:219], v[32:35], v[36:39], 0
    v_mul_f32 v201, v170, v201
    v_cvt_pk_bf16_f32 v200, v200, v201
    v_mfma_f32_16x16x32_bf16 v[228:231], v[120:123], a[192:195], 0
    v_mul_f32 v202, v170, v202
    v_mul_f32 v203, v170, v203
    v_mfma_f32_16x16x32_bf16 v[228:231], v[140:143], a[196:199], v[228:231]
    s_waitcnt lgkmcnt(5)
    v_cvt_pk_bf16_f32 v130, v196, v197
    v_cvt_pk_bf16_f32 v131, v198, v199
    v_mfma_f32_16x16x32_bf16 v[228:231], v[232:235], a[200:203], v[228:231]
    s_waitcnt lgkmcnt(4)
    v_rsq_f32 v217, v217
    v_mfma_f32_16x16x32_bf16 v[228:231], v[224:227], a[204:207], v[228:231]
    s_waitcnt lgkmcnt(3)
    v_rsq_f32 v216, v216
    v_mfma_f32_16x16x32_bf16 v[228:231], v[212:215], a[208:211], v[228:231]
    s_waitcnt lgkmcnt(2)
    v_mul_f32 v216, s31, v216
    v_mul_f32 v112, v217, v112
    v_mfma_f32_16x16x32_bf16 v[228:231], v[144:147], a[212:215], v[228:231]
    s_waitcnt lgkmcnt(1)
    v_mul_f32 v113, v217, v113
    v_cvt_pk_bf16_f32 v112, v112, v113
    v_mfma_f32_16x16x32_bf16 v[120:123], a[72:75], v[116:119], 0
    s_waitcnt lgkmcnt(0)
    v_mul_f32 v114, v217, v114
    v_mul_f32 v115, v217, v115
    v_mfma_f32_16x16x32_bf16 v[120:123], a[76:79], v[204:207], v[120:123]
    v_cvt_pk_bf16_f32 v166, v228, v229
    v_cvt_pk_bf16_f32 v167, v230, v231
    v_mfma_f32_16x16x32_bf16 v[120:123], a[80:83], v[192:195], v[120:123]
    v_cvt_pk_bf16_f32 v113, v114, v115
    v_mul_f32 v148, v217, v148
    v_mfma_f32_16x16x32_bf16 v[120:123], a[84:87], v[220:223], v[120:123]
    v_mul_f32 v149, v217, v149
    v_cvt_pk_bf16_f32 v114, v148, v149
    v_mfma_f32_16x16x32_bf16 v[120:123], a[88:91], v[188:191], v[120:123]
    v_mul_f32 v150, v217, v150
    v_mul_f32 v151, v217, v151
    v_mfma_f32_16x16x32_bf16 v[120:123], a[92:95], v[240:243], v[120:123]
    v_cvt_pk_bf16_f32 v115, v150, v151
    v_mul_f32 v180, v217, v180
    v_mfma_f32_16x16x32_bf16 v[140:143], a[96:99], v[116:119], 0
    v_mul_f32 v181, v217, v181
    v_cvt_pk_bf16_f32 v146, v180, v181
    v_mfma_f32_16x16x32_bf16 v[140:143], a[100:103], v[204:207], v[140:143]
    v_mul_f32 v182, v217, v182
    v_mul_f32 v183, v217, v183
    v_mfma_f32_16x16x32_bf16 v[140:143], a[104:107], v[192:195], v[140:143]
    v_cvt_pk_bf16_f32 v147, v182, v183
    v_mul_f32 v108, v216, v108
    v_mfma_f32_16x16x32_bf16 v[140:143], a[108:111], v[220:223], v[140:143]
    v_mul_f32 v109, v216, v109
    v_cvt_pk_bf16_f32 v148, v108, v109
    v_mfma_f32_16x16x32_bf16 v[140:143], a[112:115], v[188:191], v[140:143]
    v_mul_f32 v110, v216, v110
    v_mul_f32 v111, v216, v111
    v_mfma_f32_16x16x32_bf16 v[140:143], a[116:119], v[240:243], v[140:143]
    v_cvt_pk_bf16_f32 v149, v110, v111
    v_mul_f32 v152, v216, v152
    v_mfma_f32_16x16x32_bf16 v[108:111], a[120:123], v[116:119], 0
    v_mul_f32 v153, v216, v153
    v_cvt_pk_bf16_f32 v150, v152, v153
    v_mfma_f32_16x16x32_bf16 v[108:111], a[124:127], v[204:207], v[108:111]
    v_mul_f32 v154, v216, v154
    v_mul_f32 v155, v216, v155
    v_mfma_f32_16x16x32_bf16 v[108:111], a[128:131], v[192:195], v[108:111]
    v_cvt_pk_bf16_f32 v151, v154, v155
    v_mul_f32 v160, v216, v160
    v_mfma_f32_16x16x32_bf16 v[108:111], a[132:135], v[220:223], v[108:111]
    v_mul_f32 v161, v216, v161
    v_cvt_pk_bf16_f32 v144, v160, v161
    v_mfma_f32_16x16x32_bf16 v[108:111], a[136:139], v[188:191], v[108:111]
    v_mul_f32 v162, v216, v162
    v_mul_f32 v163, v216, v163
    v_mfma_f32_16x16x32_bf16 v[108:111], a[140:143], v[240:243], v[108:111]
    s_waitcnt vmcnt(2)
    v_cvt_pk_bf16_f32 v145, v162, v163
    v_fma_f32 v168, v120, v120, s32
    v_mfma_f32_16x16x32_bf16 v[152:155], a[0:3], v[116:119], 0
    s_barrier
    v_fmac_f32 v168, v121, v121
    v_fmac_f32 v168, v122, v122
    v_mfma_f32_16x16x32_bf16 v[152:155], a[4:7], v[204:207], v[152:155]
    s_nop 0
    v_fmac_f32 v168, v123, v123
    v_fmac_f32 v168, v140, v140
    v_mfma_f32_16x16x32_bf16 v[152:155], a[8:11], v[192:195], v[152:155]
    s_nop 0
    v_fmac_f32 v168, v141, v141
    v_fmac_f32 v168, v142, v142
    v_mfma_f32_16x16x32_bf16 v[152:155], a[12:15], v[220:223], v[152:155]
    s_nop 0
    buffer_load_dwordx4 v10, s[8:11], 0 offen nt lds
    v_fmac_f32 v168, v143, v143
    v_mfma_f32_16x16x32_bf16 v[152:155], a[16:19], v[188:191], v[152:155]
    s_add_u32 m0, s28, 4096
    v_fmac_f32 v168, v108, v108
    v_fmac_f32 v168, v109, v109
    v_mfma_f32_16x16x32_bf16 v[152:155], a[20:23], v[240:243], v[152:155]
    v_fmac_f32 v168, v110, v110
    v_fmac_f32 v168, v111, v111
    v_mfma_f32_16x16x32_bf16 v[160:163], a[24:27], v[116:119], 0
    v_cvt_pk_bf16_f32 v201, v202, v203
    v_mul_f32 v244, v170, v244
    v_mfma_f32_16x16x32_bf16 v[160:163], a[28:31], v[204:207], v[160:163]
    v_mul_f32 v245, v170, v245
    v_cvt_pk_bf16_f32 v202, v244, v245
    v_mfma_f32_16x16x32_bf16 v[160:163], a[32:35], v[192:195], v[160:163]
    buffer_load_dwordx4 v11, s[8:11], 0 offen nt lds
    v_fma_f32 v169, v152, v152, s32
    v_mfma_f32_16x16x32_bf16 v[160:163], a[36:39], v[220:223], v[160:163]
    s_add_u32 m0, s28, 8192
    v_fmac_f32 v169, v153, v153
    v_fmac_f32 v169, v154, v154
    v_mfma_f32_16x16x32_bf16 v[160:163], a[40:43], v[188:191], v[160:163]
    v_fmac_f32 v169, v155, v155
    v_mul_f32 v246, v170, v246
    v_mfma_f32_16x16x32_bf16 v[160:163], a[44:47], v[240:243], v[160:163]
    v_mul_f32 v247, v170, v247
    v_cvt_pk_bf16_f32 v203, v246, v247
    v_mfma_f32_16x16x32_bf16 v[196:199], a[48:51], v[116:119], 0
    v_mul_f32 v132, v170, v132
    v_mul_f32 v133, v170, v133
    v_mfma_f32_16x16x32_bf16 v[196:199], a[52:55], v[204:207], v[196:199]
    buffer_load_dwordx4 v12, s[8:11], 0 offen nt lds
    v_cvt_pk_bf16_f32 v216, v132, v133
    v_mfma_f32_16x16x32_bf16 v[196:199], a[56:59], v[192:195], v[196:199]
    s_add_u32 m0, s28, 12288
    ds_read2_b32 v[250:251], v6 offset0:0 offset1:0
    ds_read2_b32 v[234:235], v6 offset0:16 offset1:16
    v_mfma_f32_16x16x32_bf16 v[196:199], a[60:63], v[220:223], v[196:199]
    s_xor_b32 s28, s28, 65536
    ds_read_b128 v[224:227], v5 offset:0
    ds_read_b128 v[180:183], v5 offset:16
    v_mfma_f32_16x16x32_bf16 v[196:199], a[64:67], v[188:191], v[196:199]
    v_fmac_f32 v169, v160, v160
    v_fmac_f32 v169, v161, v161
    v_mfma_f32_16x16x32_bf16 v[196:199], a[68:71], v[240:243], v[196:199]
    ds_read_b128 v[212:215], v5 offset:48
    ds_read_b32 v173, v6 offset:192
    v_mfma_f32_16x16x32_bf16 v[228:231], v[116:119], a[144:147], 0
    buffer_load_dwordx4 v13, s[8:11], 0 offen nt lds
    ds_read2_b32 v[218:219], v6 offset0:32 offset1:32
    v_mfma_f32_16x16x32_bf16 v[228:231], v[204:207], a[148:151], v[228:231]
    s_mov_b32 m0, s29
    v_fmac_f32 v169, v162, v162
    v_fmac_f32 v169, v163, v163
    v_mfma_f32_16x16x32_bf16 v[228:231], v[192:195], a[152:155], v[228:231]
    s_xor_b32 s29, s29, s30
    v_fmac_f32 v169, v196, v196
    v_fmac_f32 v169, v197, v197
    v_mfma_f32_16x16x32_bf16 v[228:231], v[220:223], a[156:159], v[228:231]
    s_add_u32 s19, s19, s20
    v_fmac_f32 v169, v198, v198
    v_fmac_f32 v169, v199, v199
    v_mfma_f32_16x16x32_bf16 v[228:231], v[188:191], a[160:163], v[228:231]
    s_add_u32 s23, s23, s21
    v_cvt_pk_bf16_f32 v36, v169, v168
    v_mul_f32 v134, v170, v134
    v_mfma_f32_16x16x32_bf16 v[228:231], v[240:243], a[164:167], v[228:231]
    s_waitcnt lgkmcnt(3)
    buffer_store_dwordx4 v[200:203], v17, s[12:15], 0 offen
    v_mul_f32 v135, v170, v135
    v_cvt_pk_bf16_f32 v217, v134, v135
    v_mul_f32 v136, v172, v136
    v_mul_f32 v137, v172, v137
    v_mfma_f32_16x16x32_bf16 v[168:171], v[32:35], v[36:39], 0
    s_cmp_ge_u32 s19, 72
    v_cvt_pk_bf16_f32 v248, v228, v229
    v_cvt_pk_bf16_f32 v249, v230, v231
    v_mfma_f32_16x16x32_bf16 v[132:135], v[224:227], v[124:127], v[22:25]
    s_cselect_b32 s34, 72, 0
    v_cvt_pk_bf16_f32 v200, v136, v137
    v_mul_f32 v138, v172, v138
    v_mfma_f32_16x16x32_bf16 v[132:135], v[180:183], v[184:187], v[132:135]
    s_waitcnt lgkmcnt(0)
    v_rsq_f32 v169, v169
    v_mfma_f32_16x16x32_bf16 v[132:135], v[212:215], v[176:179], v[132:135]
    s_cselect_b32 s35, s22, 0
    v_rsq_f32 v168, v168
    v_mfma_f32_16x16x32_bf16 v[228:231], v[116:119], a[168:171], 0
    s_sub_u32 s19, s19, s34
    v_mul_f32 v168, s31, v168
    v_mul_f32 v120, v169, v120
    v_mfma_f32_16x16x32_bf16 v[228:231], v[204:207], a[172:175], v[228:231]
    s_add_u32 s23, s23, s35
    v_mov_b32_dpp v173, v133 quad_perm:[0,1,2,3] row_mask:0x1 bank_mask:0xf
    v_mul_f32 v121, v169, v121
    v_mfma_f32_16x16x32_bf16 v[228:231], v[192:195], a[176:179], v[228:231]
    s_add_u32 s18, s18, 1
    v_cvt_pk_bf16_f32 v120, v120, v121
    v_mul_f32 v122, v169, v122
    v_mfma_f32_16x16x32_bf16 v[228:231], v[220:223], a[180:183], v[228:231]
    s_cmp_lt_u32 s18, s17
    v_mul_f32 v123, v169, v123
    v_cvt_pk_bf16_f32 v121, v122, v123
    v_mfma_f32_16x16x32_bf16 v[228:231], v[188:191], a[184:187], v[228:231]
    v_mul_f32 v140, v169, v140
    v_mul_f32 v141, v169, v141
    v_mfma_f32_16x16x32_bf16 v[228:231], v[240:243], a[188:191], v[228:231]
    v_cvt_pk_bf16_f32 v122, v140, v141
    v_mul_f32 v142, v169, v142
    v_mfma_f32_16x16x32_bf16 v[244:247], v[116:119], a[192:195], 0
    v_mul_f32 v143, v169, v143
    v_cvt_pk_bf16_f32 v123, v142, v143
    v_mfma_f32_16x16x32_bf16 v[244:247], v[204:207], a[196:199], v[244:247]
    v_mul_f32 v108, v169, v108
    v_mul_f32 v109, v169, v109
    v_mfma_f32_16x16x32_bf16 v[244:247], v[192:195], a[200:203], v[244:247]
    ds_read_b128 v[116:119], v2 offset:0
    v_cvt_pk_bf16_f32 v232, v228, v229
    v_mfma_f32_16x16x32_bf16 v[244:247], v[220:223], a[204:207], v[244:247]
    ds_read_b128 v[204:207], v2 offset:1024
    v_cvt_pk_bf16_f32 v233, v230, v231
    v_mfma_f32_16x16x32_bf16 v[244:247], v[188:191], a[208:211], v[244:247]
    ds_read_b128 v[140:143], v2 offset:2048
    v_cvt_pk_bf16_f32 v190, v108, v109
    v_mfma_f32_16x16x32_bf16 v[244:247], v[240:243], a[212:215], v[244:247]
    ds_read_b128 v[252:255], v2 offset:3072
    ds_read_b128 v[192:195], v2 offset:4096
    v_mfma_f32_16x16x32_bf16 v[220:223], v[184:187], v[124:127], v[40:43]
    ds_read_b128 v[134:137], v2 offset:5120
    buffer_store_dwordx2 v[216:217], v20, s[12:15], 0 offen
    v_mul_f32 v110, v169, v110
    v_mul_f32 v111, v169, v111
    v_mfma_f32_16x16x32_bf16 v[240:243], v[112:115], v[124:127], v[44:47]
    v_cvt_pk_bf16_f32 v216, v244, v245
    v_cvt_pk_bf16_f32 v217, v246, v247
    v_mfma_f32_16x16x32_bf16 v[228:231], v[120:123], v[124:127], v[48:51]
    v_cvt_pk_bf16_f32 v191, v110, v111
    v_mul_f32 v152, v168, v152
    v_mul_f32 v153, v168, v153
    v_mfma_f32_16x16x16_bf16 v[220:223], v[178:179], v[176:177], v[220:223]
    v_cvt_pk_bf16_f32 v244, v152, v153
    v_mul_f32 v154, v168, v154
    v_mul_f32 v155, v168, v155
    v_mfma_f32_16x16x16_bf16 v[240:243], v[146:147], v[176:177], v[240:243]
    v_cvt_pk_bf16_f32 v245, v154, v155
    v_mul_f32 v160, v168, v160
    v_mul_f32 v161, v168, v161
    v_mfma_f32_16x16x16_bf16 v[228:231], v[190:191], v[176:177], v[228:231]
    v_cvt_pk_bf16_f32 v246, v160, v161
    v_mul_f32 v162, v168, v162
    v_mul_f32 v163, v168, v163
    v_cvt_pk_bf16_f32 v247, v162, v163
    v_mfma_f32_16x16x32_bf16 v[124:127], v[224:227], v[148:151], v[24:27]
    s_waitcnt lgkmcnt(1)
    v_mul_f32 v196, v168, v196
    v_mul_f32 v197, v168, v197
    v_mfma_f32_16x16x32_bf16 v[124:127], v[180:183], v[112:115], v[124:127]
    s_waitcnt lgkmcnt(0)
    v_cvt_pk_bf16_f32 v188, v196, v197
    v_mul_f32 v198, v168, v198
    v_mfma_f32_16x16x32_bf16 v[124:127], v[212:215], v[144:147], v[124:127]
    v_mul_f32 v199, v168, v199
    v_cvt_pk_bf16_f32 v189, v198, v199
    v_mfma_f32_16x16x32_bf16 v[160:163], v[224:227], v[244:247], v[26:29]
    v_max3_f32 v133, v132, v220, v221
    v_max3_f32 v133, v133, v222, v223
    v_mfma_f32_16x16x32_bf16 v[160:163], v[180:183], v[120:123], v[160:163]
    v_max3_f32 v133, v133, v240, v241
    v_max3_f32 v133, v133, v242, v243
    v_mfma_f32_16x16x32_bf16 v[160:163], v[212:215], v[188:191], v[160:163]
    v_max3_f32 v133, v133, v228, v229
    v_max3_f32 v133, v133, v230, v231
    v_mfma_f32_16x16x32_bf16 v[180:183], a[216:219], v[116:119], 0
    v_mov_b32 v174, v133
    v_mov_b32_dpp v173, v125 quad_perm:[0,1,2,3] row_mask:0x2 bank_mask:0xf
    v_mfma_f32_16x16x32_bf16 v[180:183], a[220:223], v[204:207], v[180:183]
    v_permlane32_swap_b32 v133, v174
    v_mfma_f32_16x16x32_bf16 v[180:183], a[224:227], v[140:143], v[180:183]
    v_max_f32 v133, v133, v174
    v_mov_b32 v174, v133
    v_mfma_f32_16x16x32_bf16 v[180:183], a[228:231], v[252:255], v[180:183]
    v_mov_b32_dpp v173, v161 quad_perm:[0,1,2,3] row_mask:0x4 bank_mask:0xf
    v_mul_f32 v139, v172, v139
    v_mfma_f32_16x16x32_bf16 v[180:183], a[232:235], v[192:195], v[180:183]
    v_permlane16_swap_b32 v133, v174
    v_mfma_f32_16x16x32_bf16 v[180:183], a[236:239], v[134:137], v[180:183]
    v_max_f32 v133, v133, v174
    v_sub_f32 v220, v220, v133
    v_mfma_f32_16x16x32_bf16 v[108:111], a[240:243], v[116:119], 0
    v_exp_f32 v220, v220
    v_mfma_f32_16x16x32_bf16 v[108:111], a[244:247], v[204:207], v[108:111]
    v_sub_f32 v221, v221, v133
    v_sub_f32 v222, v222, v133
    v_mfma_f32_16x16x32_bf16 v[108:111], a[248:251], v[140:143], v[108:111]
    v_exp_f32 v221, v221
    v_mfma_f32_16x16x32_bf16 v[108:111], a[252:255], v[252:255], v[108:111]
    ds_read_b128 v[168:171], v2 offset:6144
    v_cvt_pk_bf16_f32 v212, v220, v221
    v_mfma_f32_16x16x32_bf16 v[108:111], v[76:79], v[192:195], v[108:111]
    ds_read_b128 v[196:199], v2 offset:7168
    v_sub_f32 v223, v223, v133
    v_mfma_f32_16x16x32_bf16 v[108:111], v[80:83], v[134:137], v[108:111]
    ds_read_b128 v[224:227], v2 offset:8192
    v_sub_f32 v240, v240, v133
    v_mfma_f32_16x16x32_bf16 v[152:155], v[84:87], v[116:119], 0
    ds_read_b128 v[174:177], v2 offset:9216
    v_sub_f32 v241, v241, v133
    v_mfma_f32_16x16x32_bf16 v[152:155], v[88:91], v[204:207], v[152:155]
    ds_read_b128 v[116:119], v2 offset:10240
    v_sub_f32 v242, v242, v133
    v_mfma_f32_16x16x32_bf16 v[152:155], v[92:95], v[140:143], v[152:155]
    ds_read_b128 v[204:207], v2 offset:11264
    v_sub_f32 v243, v243, v133
    v_mfma_f32_16x16x32_bf16 v[152:155], v[96:99], v[252:255], v[152:155]
    v_exp_f32 v222, v222
    v_mfma_f32_16x16x32_bf16 v[152:155], v[100:103], v[192:195], v[152:155]
    v_exp_f32 v223, v223
    v_mfma_f32_16x16x32_bf16 v[152:155], v[104:107], v[134:137], v[152:155]
    s_waitcnt lgkmcnt(5)
    v_cvt_pk_bf16_f32 v213, v222, v223
    v_exp_f32 v240, v240
    v_exp_f32 v241, v241
    v_mfma_f32_16x16x32_bf16 v[140:143], v[184:187], v[148:151], v[52:55]
    s_waitcnt lgkmcnt(3)
    v_cvt_pk_bf16_f32 v214, v240, v241
    v_exp_f32 v242, v242
    v_exp_f32 v243, v243
    v_sub_f32 v228, v228, v133
    v_cvt_pk_bf16_f32 v215, v242, v243
    v_mfma_f32_16x16x16_bf16 v[140:143], v[178:179], v[144:145], v[140:143]
    v_exp_f32 v228, v228
    v_sub_f32 v229, v229, v133
    v_exp_f32 v229, v229
    v_mfma_f32_16x16x32_bf16 v[192:195], v[112:115], v[148:151], v[56:59]
    s_waitcnt lgkmcnt(0)
    v_cvt_pk_bf16_f32 v36, v228, v229
    v_sub_f32 v230, v230, v133
    v_exp_f32 v230, v230
    v_sub_f32 v231, v231, v133
    v_exp_f32 v231, v231
    v_mfma_f32_16x16x32_bf16 v[220:223], v[120:123], v[148:151], v[60:63]
    v_cvt_pk_bf16_f32 v37, v230, v231
    v_sub_f32 v132, v132, v133
    v_max3_f32 v203, v124, v140, v141
    v_mfma_f32_16x16x16_bf16 v[192:195], v[146:147], v[144:145], v[192:195]
    v_exp_f32 v132, v132
    v_max3_f32 v203, v203, v142, v143
    v_mfma_f32_16x16x16_bf16 v[220:223], v[190:191], v[144:145], v[220:223]
    v_cvt_pk_bf16_f32 v39, v132, 0
    v_cvt_pk_bf16_f32 v201, v138, v139
    v_mul_f32 v208, v172, v208
    v_mul_f32 v209, v172, v209
    v_mfma_f32_16x16x32_bf16 v[132:135], v[28:31], v[36:39], 0
    v_max3_f32 v203, v203, v192, v193
    v_max3_f32 v203, v203, v194, v195
    v_mfma_f32_16x16x32_bf16 v[132:135], v[28:31], v[212:215], v[132:135]
    v_max3_f32 v203, v203, v220, v221
    v_max3_f32 v203, v203, v222, v223
    v_mfma_f32_16x16x32_bf16 v[148:151], v[248:251], v[36:39], 0
    v_mov_b32 v144, v203
    v_cvt_pk_bf16_f32 v202, v208, v209
    v_mfma_f32_16x16x32_bf16 v[148:151], v[236:239], v[212:215], v[148:151]
    v_permlane32_swap_b32 v203, v144
    v_mfma_f32_16x16x32_bf16 v[228:231], v[232:235], v[36:39], 0
    v_max_f32 v203, v203, v144
    v_mov_b32 v144, v203
    v_mfma_f32_16x16x32_bf16 v[228:231], v[128:131], v[212:215], v[228:231]
    v_rcp_f32 v132, v132
    v_mfma_f32_16x16x32_bf16 v[240:243], v[216:219], v[36:39], 0
    v_permlane16_swap_b32 v203, v144
    v_mfma_f32_16x16x32_bf16 v[240:243], v[164:167], v[212:215], v[240:243]
    v_max_f32 v203, v203, v144
    v_sub_f32 v140, v140, v203
    v_mfma_f32_16x16x32_bf16 v[136:139], a[216:219], v[168:171], 0
    v_exp_f32 v140, v140
    v_mfma_f32_16x16x32_bf16 v[136:139], a[220:223], v[196:199], v[136:139]
    v_sub_f32 v141, v141, v203
    v_sub_f32 v142, v142, v203
    v_mfma_f32_16x16x32_bf16 v[136:139], a[224:227], v[224:227], v[136:139]
    v_exp_f32 v141, v141
    v_mfma_f32_16x16x32_bf16 v[136:139], a[228:231], v[174:177], v[136:139]
    v_cvt_pk_bf16_f32 v140, v140, v141
    v_sub_f32 v143, v143, v203
    v_mfma_f32_16x16x32_bf16 v[136:139], a[232:235], v[116:119], v[136:139]
    v_exp_f32 v142, v142
    v_mfma_f32_16x16x32_bf16 v[136:139], a[236:239], v[204:207], v[136:139]
    v_exp_f32 v143, v143
    v_sub_f32 v192, v192, v203
    v_cvt_pk_bf16_f32 v141, v142, v143
    v_exp_f32 v192, v192
    v_sub_f32 v193, v193, v203
    v_exp_f32 v193, v193
    v_sub_f32 v194, v194, v203
    v_cvt_pk_bf16_f32 v142, v192, v193
    v_exp_f32 v194, v194
    v_sub_f32 v195, v195, v203
    v_exp_f32 v195, v195
    v_sub_f32 v220, v220, v203
    v_cvt_pk_bf16_f32 v143, v194, v195
    v_exp_f32 v220, v220
    v_sub_f32 v221, v221, v203
    v_exp_f32 v221, v221
    v_sub_f32 v222, v222, v203
    v_cvt_pk_bf16_f32 v36, v220, v221
    v_exp_f32 v222, v222
    v_sub_f32 v223, v223, v203
    v_exp_f32 v223, v223
    v_mfma_f32_16x16x32_bf16 v[192:195], v[184:187], v[244:247], v[64:67]
    v_cvt_pk_bf16_f32 v37, v222, v223
    v_sub_f32 v124, v124, v203
    v_mfma_f32_16x16x32_bf16 v[184:187], v[112:115], v[244:247], v[68:71]
    v_exp_f32 v124, v124
    v_mfma_f32_16x16x32_bf16 v[212:215], v[120:123], v[244:247], v[72:75]
    v_cvt_pk_bf16_f32 v39, v124, 0
    v_mul_f32 v148, v132, v148
    v_mul_f32 v149, v132, v149
    v_mfma_f32_16x16x32_bf16 v[120:123], v[28:31], v[36:39], 0
    v_cvt_pk_bf16_f32 v112, v148, v149
    v_mul_f32 v150, v132, v150
    v_mfma_f32_16x16x32_bf16 v[120:123], v[28:31], v[140:143], v[120:123]
    v_mul_f32 v151, v132, v151
    v_cvt_pk_bf16_f32 v113, v150, v151
    v_mfma_f32_16x16x32_bf16 v[124:127], v[248:251], v[36:39], 0
    v_mul_f32 v228, v132, v228
    v_mul_f32 v229, v132, v229
    v_mfma_f32_16x16x32_bf16 v[124:127], v[236:239], v[140:143], v[124:127]
    v_cvt_pk_bf16_f32 v114, v228, v229
    v_mul_f32 v230, v132, v230
    v_mfma_f32_16x16x32_bf16 v[220:223], v[232:235], v[36:39], 0
    v_mul_f32 v231, v132, v231
    v_cvt_pk_bf16_f32 v115, v230, v231
    v_mfma_f32_16x16x32_bf16 v[220:223], v[128:131], v[140:143], v[220:223]
    ds_write_b128 v3, v[112:115] offset:0
    v_mfma_f32_16x16x32_bf16 v[252:255], v[216:219], v[36:39], 0
    v_mul_f32 v240, v132, v240
    v_mul_f32 v241, v132, v241
    v_mfma_f32_16x16x32_bf16 v[252:255], v[164:167], v[140:143], v[252:255]
    v_cvt_pk_bf16_f32 v122, v240, v241
    v_mul_f32 v242, v132, v242
    v_mul_f32 v243, v132, v243
    v_mfma_f32_16x16x16_bf16 v[192:195], v[178:179], v[188:189], v[192:195]
    v_cvt_pk_bf16_f32 v123, v242, v243
    v_mul_f32 v210, v172, v210
    v_mul_f32 v211, v172, v211
    v_mfma_f32_16x16x16_bf16 v[184:187], v[146:147], v[188:189], v[184:187]
    v_cvt_pk_bf16_f32 v203, v210, v211
    v_mul_f32 v156, v172, v156
    v_mul_f32 v157, v172, v157
    v_mfma_f32_16x16x16_bf16 v[212:215], v[190:191], v[188:189], v[212:215]
    v_cvt_pk_bf16_f32 v178, v156, v157
    v_mul_f32 v158, v172, v158
    v_mul_f32 v159, v172, v159
    v_cvt_pk_bf16_f32 v179, v158, v159
    v_mfma_f32_16x16x32_bf16 v[208:211], a[240:243], v[168:171], 0
    ds_write_b64 v4, v[122:123] offset:4096
    v_mfma_f32_16x16x32_bf16 v[208:211], a[244:247], v[196:199], v[208:211]
    buffer_store_dwordx4 v[200:203], v16, s[12:15], 0 offen
    v_mov_b32 v172, v173
    v_max3_f32 v121, v160, v192, v193
    v_max3_f32 v121, v121, v194, v195
    v_max_f32_dpp v172, v172, v172 quad_perm:[1,0,3,2] row_mask:0xf bank_mask:0xf
    v_mfma_f32_16x16x32_bf16 v[208:211], a[248:251], v[224:227], v[208:211]
    v_max3_f32 v121, v121, v184, v185
    v_max_f32_dpp v172, v172, v172 quad_perm:[2,3,0,1] row_mask:0xf bank_mask:0xf
    v_mfma_f32_16x16x32_bf16 v[208:211], a[252:255], v[174:177], v[208:211]
    ds_read_b128 v[112:115], v2 offset:12288
    v_max_f32_dpp v172, v172, v172 row_half_mirror row_mask:0xf bank_mask:0xf
    v_mfma_f32_16x16x32_bf16 v[208:211], v[76:79], v[116:119], v[208:211]
    ds_read_b128 v[188:191], v2 offset:13312
    v_max_f32_dpp v172, v172, v172 row_mirror row_mask:0xf bank_mask:0xf
    v_mfma_f32_16x16x32_bf16 v[208:211], v[80:83], v[204:207], v[208:211]
    ds_read_b128 v[144:147], v2 offset:14336
    v_mov_b32 v122, v172
    v_mfma_f32_16x16x32_bf16 v[156:159], v[84:87], v[168:171], 0
    ds_read_b128 v[140:143], v2 offset:15360
    v_max3_f32 v121, v121, v186, v187
    v_mfma_f32_16x16x32_bf16 v[156:159], v[88:91], v[196:199], v[156:159]
    ds_read_b128 v[168:171], v2 offset:16384
    v_max3_f32 v121, v121, v212, v213
    v_mfma_f32_16x16x32_bf16 v[156:159], v[92:95], v[224:227], v[156:159]
    ds_read_b128 v[148:151], v2 offset:17408
    v_max3_f32 v121, v121, v214, v215
    v_mfma_f32_16x16x32_bf16 v[156:159], v[96:99], v[174:177], v[156:159]
    v_permlane32_swap_b32 v172, v122
    v_mfma_f32_16x16x32_bf16 v[156:159], v[100:103], v[116:119], v[156:159]
    v_max_f32 v172, v172, v122
    v_mov_b32 v122, v172
    v_mfma_f32_16x16x32_bf16 v[156:159], v[104:107], v[204:207], v[156:159]
    s_waitcnt lgkmcnt(5)
    v_permlane16_swap_b32 v172, v122
    v_mfma_f32_16x16x32_bf16 v[200:203], a[216:219], v[112:115], 0
    s_waitcnt lgkmcnt(4)
    v_max_f32 v172, v172, v122
    v_sub_f32 v173, v173, v172
    v_mfma_f32_16x16x32_bf16 v[200:203], a[220:223], v[188:191], v[200:203]
    s_waitcnt lgkmcnt(3)
    v_exp_f32 v173, v173
    v_mfma_f32_16x16x32_bf16 v[200:203], a[224:227], v[144:147], v[200:203]
    s_waitcnt lgkmcnt(2)
    v_cvt_pk_bf16_f32 v173, v173, v173
    v_mov_b32 v122, v121
    v_mfma_f32_16x16x32_bf16 v[200:203], a[228:231], v[140:143], v[200:203]
    s_waitcnt lgkmcnt(1)
    ds_write_b16 v8, v173
    v_mfma_f32_16x16x32_bf16 v[200:203], a[232:235], v[168:171], v[200:203]
    s_waitcnt lgkmcnt(1)
    v_permlane32_swap_b32 v121, v122
    v_mfma_f32_16x16x32_bf16 v[200:203], a[236:239], v[148:151], v[200:203]
    v_max_f32 v121, v121, v122
    v_mov_b32 v122, v121
    v_mfma_f32_16x16x32_bf16 v[244:247], a[240:243], v[112:115], 0
    buffer_store_dwordx2 v[178:179], v19, s[12:15], 0 offen
    v_permlane16_swap_b32 v121, v122
    v_mfma_f32_16x16x32_bf16 v[244:247], a[244:247], v[188:191], v[244:247]
    v_max_f32 v121, v121, v122
    v_sub_f32 v192, v192, v121
    v_mfma_f32_16x16x32_bf16 v[244:247], a[248:251], v[144:147], v[244:247]
    v_fma_f32 v122, v200, v200, s33
    v_fmac_f32 v122, v201, v201
    v_mfma_f32_16x16x32_bf16 v[244:247], a[252:255], v[140:143], v[244:247]
    v_fmac_f32 v122, v202, v202
    v_fmac_f32 v122, v203, v203
    v_mfma_f32_16x16x32_bf16 v[244:247], v[76:79], v[168:171], v[244:247]
    v_exp_f32 v192, v192
    v_mfma_f32_16x16x32_bf16 v[244:247], v[80:83], v[148:151], v[244:247]
    v_sub_f32 v193, v193, v121
    v_sub_f32 v194, v194, v121
    v_mfma_f32_16x16x32_bf16 v[132:135], v[84:87], v[112:115], 0
    v_exp_f32 v193, v193
    v_mfma_f32_16x16x32_bf16 v[132:135], v[88:91], v[188:191], v[132:135]
    v_cvt_pk_bf16_f32 v116, v192, v193
    v_sub_f32 v195, v195, v121
    v_mfma_f32_16x16x32_bf16 v[132:135], v[92:95], v[144:147], v[132:135]
    v_fmac_f32 v122, v244, v244
    v_fmac_f32 v122, v245, v245
    v_mfma_f32_16x16x32_bf16 v[132:135], v[96:99], v[140:143], v[132:135]
    v_fmac_f32 v122, v246, v246
    v_fmac_f32 v122, v247, v247
    v_mfma_f32_16x16x32_bf16 v[132:135], v[100:103], v[168:171], v[132:135]
    v_exp_f32 v194, v194
    v_mfma_f32_16x16x32_bf16 v[132:135], v[104:107], v[148:151], v[132:135]
    v_exp_f32 v195, v195
    v_sub_f32 v184, v184, v121
    v_cvt_pk_bf16_f32 v117, v194, v195
    v_exp_f32 v184, v184
    v_sub_f32 v185, v185, v121
    v_exp_f32 v185, v185
    v_sub_f32 v186, v186, v121
    v_cvt_pk_bf16_f32 v118, v184, v185
    v_fmac_f32 v122, v132, v132
    v_fmac_f32 v122, v133, v133
    v_fmac_f32 v122, v134, v134
    v_fmac_f32 v122, v135, v135
    v_cvt_pk_bf16_f32 v123, v122, v122
    v_exp_f32 v186, v186
    v_sub_f32 v187, v187, v121
    v_exp_f32 v187, v187
    v_sub_f32 v212, v212, v121
    v_cvt_pk_bf16_f32 v119, v186, v187
    v_exp_f32 v212, v212
    v_sub_f32 v213, v213, v121
    v_exp_f32 v213, v213
    v_sub_f32 v214, v214, v121
    v_cvt_pk_bf16_f32 v36, v212, v213
    v_exp_f32 v214, v214
    v_sub_f32 v215, v215, v121
    v_exp_f32 v215, v215
    v_sub_f32 v160, v160, v121
    v_cvt_pk_bf16_f32 v37, v214, v215
    v_exp_f32 v160, v160
    v_xor_b32 v0, 65536, v0
    v_cvt_pk_bf16_f32 v39, v160, 0
    v_xor_b32 v1, 65536, v1
    v_fma_f32 v121, v136, v136, s33
    v_mfma_f32_16x16x32_bf16 v[140:143], v[28:31], v[36:39], 0
    ds_read_b128 v[196:199], v0 offset:20480
    ds_read_b128 v[184:187], v1 offset:20480
    v_mfma_f32_16x16x32_bf16 v[140:143], v[28:31], v[116:119], v[140:143]
    ds_read_b128 v[172:175], v0 offset:20608
    ds_read_b128 v[148:151], v1 offset:20608
    v_mfma_f32_16x16x32_bf16 v[144:147], v[248:251], v[36:39], 0
    buffer_load_dwordx4 v14, s[8:11], 0 offen nt lds
    ds_read_b128 v[112:115], v0 offset:20736
    v_mfma_f32_16x16x32_bf16 v[144:147], v[236:239], v[116:119], v[144:147]
    v_fmac_f32 v121, v137, v137
    v_fmac_f32 v121, v138, v138
    v_mfma_f32_16x16x32_bf16 v[168:171], v[232:235], v[36:39], 0
    ds_read_b128 v[228:231], v1 offset:20736
    ds_read_b128 v[176:179], v9
    v_mfma_f32_16x16x32_bf16 v[168:171], v[128:131], v[116:119], v[168:171]
    v_fmac_f32 v121, v139, v139
    v_fmac_f32 v121, v208, v208
    v_mfma_f32_16x16x32_bf16 v[188:191], v[216:219], v[36:39], 0
    ds_read_b128 v[160:163], v9 offset:64
    v_fmac_f32 v121, v209, v209
    v_mfma_f32_16x16x32_bf16 v[188:191], v[164:167], v[116:119], v[188:191]
    v_fmac_f32 v121, v210, v210
    v_fmac_f32 v121, v211, v211
    s_waitcnt lgkmcnt(6)
    v_mfma_f32_16x16x32_bf16 v[204:207], a[72:75], v[196:199], 0
    s_waitcnt lgkmcnt(5)
    v_fmac_f32 v121, v156, v156
    v_fmac_f32 v121, v157, v157
    v_mfma_f32_16x16x32_bf16 v[204:207], a[76:79], v[184:187], v[204:207]
    s_waitcnt lgkmcnt(4)
    v_fmac_f32 v121, v158, v158
    v_fmac_f32 v121, v159, v159
    v_mfma_f32_16x16x32_bf16 v[204:207], a[80:83], v[172:175], v[204:207]
    s_waitcnt lgkmcnt(3)
    v_rcp_f32 v120, v120
    v_mfma_f32_16x16x32_bf16 v[204:207], a[84:87], v[148:151], v[204:207]
    s_waitcnt lgkmcnt(2)
    v_mul_f32 v124, v120, v124
    v_mul_f32 v125, v120, v125
    v_mfma_f32_16x16x32_bf16 v[204:207], a[88:91], v[112:115], v[204:207]
    s_waitcnt lgkmcnt(1)
    v_cvt_pk_bf16_f32 v192, v124, v125
    v_mul_f32 v126, v120, v126
    v_mfma_f32_16x16x32_bf16 v[212:215], v[176:179], v[28:31], 0
    s_waitcnt lgkmcnt(0)
    v_mul_f32 v127, v120, v127
    v_cvt_pk_bf16_f32 v193, v126, v127
    v_mfma_f32_16x16x32_bf16 v[212:215], v[160:163], v[28:31], v[212:215]
    v_mul_f32 v220, v120, v220
    v_mul_f32 v221, v120, v221
    v_mfma_f32_16x16x32_bf16 v[116:119], v[176:179], v[236:239], 0
    v_cvt_pk_bf16_f32 v194, v220, v221
    v_mul_f32 v222, v120, v222
    v_mfma_f32_16x16x32_bf16 v[116:119], v[160:163], v[248:251], v[116:119]
    v_mul_f32 v223, v120, v223
    v_cvt_pk_bf16_f32 v195, v222, v223
    v_mfma_f32_16x16x32_bf16 v[124:127], v[176:179], v[128:131], 0
    ds_write_b128 v3, v[192:195] offset:6144
    v_mfma_f32_16x16x32_bf16 v[124:127], v[160:163], v[232:235], v[124:127]
    v_mul_f32 v252, v120, v252
    v_mul_f32 v253, v120, v253
    v_mfma_f32_16x16x32_bf16 v[128:131], v[176:179], v[164:167], 0
    v_cvt_pk_bf16_f32 v252, v252, v253
    v_mul_f32 v254, v120, v254
    v_mfma_f32_16x16x32_bf16 v[128:131], v[160:163], v[216:219], v[128:131]
    v_mul_f32 v255, v120, v255
    v_cvt_pk_bf16_f32 v253, v254, v255
    v_mfma_f32_16x16x32_bf16 v[204:207], a[92:95], v[228:231], v[204:207]
    ds_write_b64 v4, v[252:253] offset:10240
    v_mfma_f32_16x16x32_bf16 v[176:179], a[96:99], v[196:199], 0
    v_rcp_f32 v212, v212
    v_mfma_f32_16x16x32_bf16 v[176:179], a[100:103], v[184:187], v[176:179]
    v_mul_f32 v116, v116, v212
    v_mul_f32_dpp v116, v124, v212 quad_perm:[0,1,2,3] row_mask:0x2 bank_mask:0xf
    v_mfma_f32_16x16x32_bf16 v[176:179], a[104:107], v[172:175], v[176:179]
    v_mul_f32_dpp v116, v128, v212 quad_perm:[0,1,2,3] row_mask:0x4 bank_mask:0xf
    v_cvt_pk_bf16_f32 v116, v116, v116
    v_mfma_f32_16x16x32_bf16 v[176:179], a[108:111], v[148:151], v[176:179]
    ds_write_b16 v7, v116
    v_mfma_f32_16x16x32_bf16 v[176:179], a[112:115], v[112:115], v[176:179]
    v_rcp_f32 v140, v140
    v_mfma_f32_16x16x32_bf16 v[176:179], a[116:119], v[228:231], v[176:179]
    v_mul_f32 v144, v140, v144
    v_mul_f32 v145, v140, v145
    v_mfma_f32_16x16x32_bf16 v[124:127], a[120:123], v[196:199], 0
    v_cvt_pk_bf16_f32 v116, v144, v145
    v_mul_f32 v146, v140, v146
    v_mfma_f32_16x16x32_bf16 v[124:127], a[124:127], v[184:187], v[124:127]
    v_mul_f32 v147, v140, v147
    v_cvt_pk_bf16_f32 v117, v146, v147
    v_mfma_f32_16x16x32_bf16 v[124:127], a[128:131], v[172:175], v[124:127]
    v_mul_f32 v168, v140, v168
    v_mul_f32 v169, v140, v169
    v_mfma_f32_16x16x32_bf16 v[124:127], a[132:135], v[148:151], v[124:127]
    v_cvt_pk_bf16_f32 v118, v168, v169
    v_mul_f32 v170, v140, v170
    v_mfma_f32_16x16x32_bf16 v[124:127], a[136:139], v[112:115], v[124:127]
    v_mul_f32 v171, v140, v171
    v_cvt_pk_bf16_f32 v119, v170, v171
    v_mfma_f32_16x16x32_bf16 v[124:127], a[140:143], v[228:231], v[124:127]
    ds_write_b128 v3, v[116:119] offset:12288
    v_mfma_f32_16x16x32_bf16 v[216:219], a[0:3], v[196:199], 0
    v_mul_f32 v188, v140, v188
    v_mul_f32 v189, v140, v189
    v_mfma_f32_16x16x32_bf16 v[216:219], a[4:7], v[184:187], v[216:219]
    v_cvt_pk_bf16_f32 v188, v188, v189
    v_mul_f32 v190, v140, v190
    v_mfma_f32_16x16x32_bf16 v[216:219], a[8:11], v[172:175], v[216:219]
    v_mul_f32 v191, v140, v191
    v_cvt_pk_bf16_f32 v189, v190, v191
    v_mfma_f32_16x16x32_bf16 v[216:219], a[12:15], v[148:151], v[216:219]
    ds_write_b64 v4, v[188:189] offset:16384
    v_mfma_f32_16x16x32_bf16 v[216:219], a[16:19], v[112:115], v[216:219]
    v_fma_f32 v120, v180, v180, s33
    v_fmac_f32 v120, v181, v181
    v_mfma_f32_16x16x32_bf16 v[216:219], a[20:23], v[228:231], v[216:219]
    v_fmac_f32 v120, v182, v182
    v_fmac_f32 v120, v183, v183
    v_mfma_f32_16x16x32_bf16 v[160:163], a[24:27], v[196:199], 0
    v_fmac_f32 v120, v108, v108
    v_fmac_f32 v120, v109, v109
    v_mfma_f32_16x16x32_bf16 v[160:163], a[28:31], v[184:187], v[160:163]
    v_fmac_f32 v120, v110, v110
    v_fmac_f32 v120, v111, v111
    v_mfma_f32_16x16x32_bf16 v[160:163], a[32:35], v[172:175], v[160:163]
    v_fmac_f32 v120, v152, v152
    v_fmac_f32 v120, v153, v153
    v_mfma_f32_16x16x32_bf16 v[160:163], a[36:39], v[148:151], v[160:163]
    v_fmac_f32 v120, v154, v154
    v_fmac_f32 v120, v155, v155
    v_mfma_f32_16x16x32_bf16 v[160:163], a[40:43], v[112:115], v[160:163]
    v_cvt_pk_bf16_f32 v122, v120, v121
    v_add_u32 v5, 336, v5
    v_mfma_f32_16x16x32_bf16 v[160:163], a[44:47], v[228:231], v[160:163]
    ds_write_b64 v4, v[122:123] offset:18432
    v_mfma_f32_16x16x32_bf16 v[116:119], a[48:51], v[196:199], 0
    v_add_u32 v6, 272, v6
    v_add_u32 v7, 16, v7
    v_mfma_f32_16x16x32_bf16 v[116:119], a[52:55], v[184:187], v[116:119]
    v_xor_b32 v2, 65536, v2
    v_xor_b32 v3, 65536, v3
    v_mfma_f32_16x16x32_bf16 v[116:119], a[56:59], v[172:175], v[116:119]
    v_xor_b32 v4, 65536, v4
    v_fma_f32 v169, v204, v204, s32
    v_mfma_f32_16x16x32_bf16 v[116:119], a[60:63], v[148:151], v[116:119]
    v_fmac_f32 v169, v205, v205
    v_fmac_f32 v169, v206, v206
    v_mfma_f32_16x16x32_bf16 v[116:119], a[64:67], v[112:115], v[116:119]
    v_fmac_f32 v169, v207, v207
    v_fmac_f32 v169, v176, v176
    v_mfma_f32_16x16x32_bf16 v[116:119], a[68:71], v[228:231], v[116:119]
    v_fmac_f32 v169, v177, v177
    v_fmac_f32 v169, v178, v178
    v_mfma_f32_16x16x32_bf16 v[128:131], v[196:199], a[144:147], 0
    s_waitcnt lgkmcnt(0)
    v_fmac_f32 v169, v179, v179
    v_fmac_f32 v169, v124, v124
    v_mfma_f32_16x16x32_bf16 v[128:131], v[184:187], a[148:151], v[128:131]
    s_barrier
    v_fmac_f32 v169, v125, v125
    v_fmac_f32 v169, v126, v126
    v_mfma_f32_16x16x32_bf16 v[128:131], v[172:175], a[152:155], v[128:131]
    s_nop 0
    v_fmac_f32 v169, v127, v127
    v_fma_f32 v168, v216, v216, s32
    v_mfma_f32_16x16x32_bf16 v[128:131], v[148:151], a[156:159], v[128:131]
    s_nop 0
    v_fmac_f32 v168, v217, v217
    v_fmac_f32 v168, v218, v218
    v_mfma_f32_16x16x32_bf16 v[128:131], v[112:115], a[160:163], v[128:131]
    s_nop 0
    v_fmac_f32 v168, v219, v219
    v_mfma_f32_16x16x32_bf16 v[128:131], v[228:231], a[164:167], v[128:131]
    s_cbranch_scc1 L_loop_safe0
    s_branch L_drain
.p2align 6
L_loop_safe1:
    v_mfma_f32_16x16x32_bf16 v[188:191], v[196:199], a[168:171], 0
    s_add_u32 s12, s42, s27
    ds_read_b128 v[192:195], v2 offset:18432
    ds_read_b128 v[164:167], v2 offset:19456
    v_mfma_f32_16x16x32_bf16 v[188:191], v[184:187], a[172:175], v[188:191]
    s_addc_u32 s13, s43, 0
    ds_read_b128 v[120:123], v0 offset:26624
    ds_read_b128 v[140:143], v1 offset:26624
    v_mfma_f32_16x16x32_bf16 v[188:191], v[172:175], a[176:179], v[188:191]
    s_sub_u32 s14, s36, s27
    v_fmac_f32 v168, v160, v160
    v_fmac_f32 v168, v161, v161
    v_mfma_f32_16x16x32_bf16 v[188:191], v[148:151], a[180:183], v[188:191]
    s_cmp_ge_u32 s18, 2
    ds_read_b128 v[232:235], v0 offset:26752
    ds_read_b128 v[224:227], v1 offset:26752
    v_mfma_f32_16x16x32_bf16 v[188:191], v[112:115], a[184:187], v[188:191]
    s_cselect_b32 s14, s14, 0
    v_fmac_f32 v168, v162, v162
    v_fmac_f32 v168, v163, v163
    v_mfma_f32_16x16x32_bf16 v[188:191], v[228:231], a[188:191], v[188:191]
    s_add_u32 s34, s18, 2
    ds_read_b128 v[212:215], v0 offset:26880
    ds_read_b128 v[144:147], v1 offset:26880
    v_mfma_f32_16x16x32_bf16 v[220:223], v[196:199], a[192:195], 0
    s_add_u32 s8, s40, s23
    v_fmac_f32 v168, v116, v116
    v_fmac_f32 v168, v117, v117
    v_mfma_f32_16x16x32_bf16 v[220:223], v[184:187], a[196:199], v[220:223]
    s_addc_u32 s9, s41, 0
    v_fmac_f32 v168, v118, v118
    v_fmac_f32 v168, v119, v119
    v_mfma_f32_16x16x32_bf16 v[220:223], v[172:175], a[200:203], v[220:223]
    s_waitcnt lgkmcnt(6)
    v_cvt_pk_bf16_f32 v36, v168, v169
    v_cvt_pk_bf16_f32 v236, v128, v129
    v_mfma_f32_16x16x32_bf16 v[172:175], v[32:35], v[192:195], 0
    s_waitcnt lgkmcnt(4)
    v_cvt_pk_bf16_f32 v237, v130, v131
    v_cvt_pk_bf16_f32 v128, v188, v189
    v_mfma_f32_16x16x32_bf16 v[168:171], v[32:35], v[36:39], 0
    s_sub_u32 s10, s36, s23
    v_cvt_pk_bf16_f32 v129, v190, v191
    s_cmp_lt_u32 s34, s17
    v_mfma_f32_16x16x32_bf16 v[172:175], v[32:35], v[164:167], v[172:175]
    s_cselect_b32 s10, s10, 0
    s_add_u32 m0, s28, 0
    s_mov_b32 s27, s26
    v_mfma_f32_16x16x32_bf16 v[220:223], v[148:151], a[204:207], v[220:223]
    s_mov_b32 s26, s25
    v_rsq_f32 v169, v169
    v_mfma_f32_16x16x32_bf16 v[220:223], v[112:115], a[208:211], v[220:223]
    s_mov_b32 s25, s24
    v_rsq_f32 v168, v168
    v_mfma_f32_16x16x32_bf16 v[220:223], v[228:231], a[212:215], v[220:223]
    s_mov_b32 s24, s23
    v_mul_f32 v168, s31, v168
    v_mul_f32 v171, 0x3baaaaab, v172
    v_mfma_f32_16x16x32_bf16 v[112:115], a[72:75], v[120:123], 0
    s_waitcnt lgkmcnt(0)
    v_rsq_f32 v171, v171
    v_mfma_f32_16x16x32_bf16 v[112:115], a[76:79], v[140:143], v[112:115]
    v_mul_f32 v172, 0x3baaaaab, v173
    v_cvt_pk_bf16_f32 v164, v220, v221
    v_mfma_f32_16x16x32_bf16 v[112:115], a[80:83], v[232:235], v[112:115]
    v_cvt_pk_bf16_f32 v165, v222, v223
    v_mul_f32 v170, 0x3baaaaab, v174
    v_mfma_f32_16x16x32_bf16 v[112:115], a[84:87], v[224:227], v[112:115]
    v_rsq_f32 v172, v172
    v_mfma_f32_16x16x32_bf16 v[112:115], a[88:91], v[212:215], v[112:115]
    v_rsq_f32 v170, v170
    v_mfma_f32_16x16x32_bf16 v[112:115], a[92:95], v[144:147], v[112:115]
    v_mul_f32 v180, v171, v180
    v_mul_f32 v181, v171, v181
    v_mfma_f32_16x16x32_bf16 v[148:151], a[96:99], v[120:123], 0
    v_cvt_pk_bf16_f32 v180, v180, v181
    v_mul_f32 v182, v171, v182
    v_mfma_f32_16x16x32_bf16 v[148:151], a[100:103], v[140:143], v[148:151]
    v_mul_f32 v183, v171, v183
    v_cvt_pk_bf16_f32 v181, v182, v183
    v_mfma_f32_16x16x32_bf16 v[148:151], a[104:107], v[232:235], v[148:151]
    v_mul_f32 v108, v171, v108
    v_mul_f32 v109, v171, v109
    v_mfma_f32_16x16x32_bf16 v[148:151], a[108:111], v[224:227], v[148:151]
    v_cvt_pk_bf16_f32 v182, v108, v109
    v_mul_f32 v110, v171, v110
    v_mfma_f32_16x16x32_bf16 v[148:151], a[112:115], v[212:215], v[148:151]
    v_mul_f32 v111, v171, v111
    v_cvt_pk_bf16_f32 v183, v110, v111
    v_mfma_f32_16x16x32_bf16 v[148:151], a[116:119], v[144:147], v[148:151]
    buffer_store_dwordx4 v[180:183], v15, s[12:15], 0 offen
    v_mul_f32 v152, v171, v152
    v_mul_f32 v153, v171, v153
    v_cvt_pk_bf16_f32 v130, v152, v153
    v_mul_f32 v154, v171, v154
    v_mfma_f32_16x16x32_bf16 v[180:183], a[120:123], v[120:123], 0
    v_mul_f32 v155, v171, v155
    v_cvt_pk_bf16_f32 v131, v154, v155
    v_mfma_f32_16x16x32_bf16 v[180:183], a[124:127], v[140:143], v[180:183]
    v_mul_f32 v204, v169, v204
    v_mul_f32 v205, v169, v205
    v_mfma_f32_16x16x32_bf16 v[180:183], a[128:131], v[232:235], v[180:183]
    v_cvt_pk_bf16_f32 v184, v204, v205
    v_mul_f32 v206, v169, v206
    v_mfma_f32_16x16x32_bf16 v[180:183], a[132:135], v[224:227], v[180:183]
    v_mul_f32 v207, v169, v207
    v_cvt_pk_bf16_f32 v185, v206, v207
    v_mfma_f32_16x16x32_bf16 v[180:183], a[136:139], v[212:215], v[180:183]
    v_mul_f32 v176, v169, v176
    v_mul_f32 v177, v169, v177
    v_mfma_f32_16x16x32_bf16 v[180:183], a[140:143], v[144:147], v[180:183]
    v_cvt_pk_bf16_f32 v186, v176, v177
    v_mul_f32 v178, v169, v178
    v_mfma_f32_16x16x32_bf16 v[108:111], a[0:3], v[120:123], 0
    v_mul_f32 v179, v169, v179
    v_cvt_pk_bf16_f32 v187, v178, v179
    v_mfma_f32_16x16x32_bf16 v[108:111], a[4:7], v[140:143], v[108:111]
    v_mul_f32 v124, v169, v124
    v_mul_f32 v125, v169, v125
    v_mfma_f32_16x16x32_bf16 v[108:111], a[8:11], v[232:235], v[108:111]
    v_cvt_pk_bf16_f32 v178, v124, v125
    v_mul_f32 v126, v169, v126
    v_mfma_f32_16x16x32_bf16 v[108:111], a[12:15], v[224:227], v[108:111]
    v_mul_f32 v127, v169, v127
    v_cvt_pk_bf16_f32 v179, v126, v127
    v_mfma_f32_16x16x32_bf16 v[108:111], a[16:19], v[212:215], v[108:111]
    v_mul_f32 v216, v168, v216
    v_mul_f32 v217, v168, v217
    v_mfma_f32_16x16x32_bf16 v[108:111], a[20:23], v[144:147], v[108:111]
    v_cvt_pk_bf16_f32 v124, v216, v217
    v_mul_f32 v218, v168, v218
    v_mfma_f32_16x16x32_bf16 v[152:155], a[24:27], v[120:123], 0
    v_mul_f32 v219, v168, v219
    v_cvt_pk_bf16_f32 v125, v218, v219
    v_mfma_f32_16x16x32_bf16 v[152:155], a[28:31], v[140:143], v[152:155]
    v_mul_f32 v160, v168, v160
    v_mul_f32 v161, v168, v161
    v_mfma_f32_16x16x32_bf16 v[152:155], a[32:35], v[232:235], v[152:155]
    v_cvt_pk_bf16_f32 v126, v160, v161
    v_mul_f32 v162, v168, v162
    v_mfma_f32_16x16x32_bf16 v[152:155], a[36:39], v[224:227], v[152:155]
    v_mul_f32 v163, v168, v163
    v_cvt_pk_bf16_f32 v127, v162, v163
    v_mfma_f32_16x16x32_bf16 v[152:155], a[40:43], v[212:215], v[152:155]
    buffer_store_dwordx2 v[130:131], v18, s[12:15], 0 offen
    v_mul_f32 v116, v168, v116
    v_mul_f32 v117, v168, v117
    v_mfma_f32_16x16x32_bf16 v[152:155], a[44:47], v[144:147], v[152:155]
    v_cvt_pk_bf16_f32 v176, v116, v117
    v_mul_f32 v118, v168, v118
    v_mfma_f32_16x16x32_bf16 v[160:163], a[48:51], v[120:123], 0
    v_mul_f32 v119, v168, v119
    v_cvt_pk_bf16_f32 v177, v118, v119
    v_mfma_f32_16x16x32_bf16 v[160:163], a[52:55], v[140:143], v[160:163]
    v_fma_f32 v130, v108, v108, s32
    v_fmac_f32 v130, v109, v109
    v_mfma_f32_16x16x32_bf16 v[160:163], a[56:59], v[232:235], v[160:163]
    v_fmac_f32 v130, v110, v110
    v_fmac_f32 v130, v111, v111
    v_mfma_f32_16x16x32_bf16 v[160:163], a[60:63], v[224:227], v[160:163]
    v_fmac_f32 v130, v152, v152
    v_fmac_f32 v130, v153, v153
    v_mfma_f32_16x16x32_bf16 v[160:163], a[64:67], v[212:215], v[160:163]
    v_fmac_f32 v130, v154, v154
    v_fmac_f32 v130, v155, v155
    v_mfma_f32_16x16x32_bf16 v[160:163], a[68:71], v[144:147], v[160:163]
    v_fma_f32 v131, v112, v112, s32
    v_fmac_f32 v131, v113, v113
    v_mfma_f32_16x16x32_bf16 v[188:191], v[120:123], a[144:147], 0
    v_fmac_f32 v131, v114, v114
    v_fmac_f32 v131, v115, v115
    v_mfma_f32_16x16x32_bf16 v[188:191], v[140:143], a[148:151], v[188:191]
    v_fmac_f32 v131, v148, v148
    v_fmac_f32 v131, v149, v149
    v_mfma_f32_16x16x32_bf16 v[188:191], v[232:235], a[152:155], v[188:191]
    v_fmac_f32 v130, v160, v160
    v_fmac_f32 v130, v161, v161
    v_mfma_f32_16x16x32_bf16 v[188:191], v[224:227], a[156:159], v[188:191]
    v_fmac_f32 v130, v162, v162
    v_fmac_f32 v130, v163, v163
    v_mfma_f32_16x16x32_bf16 v[188:191], v[212:215], a[160:163], v[188:191]
    v_fmac_f32 v131, v150, v150
    v_fmac_f32 v131, v151, v151
    v_mfma_f32_16x16x32_bf16 v[188:191], v[144:147], a[164:167], v[188:191]
    v_fmac_f32 v131, v180, v180
    v_fmac_f32 v131, v181, v181
    v_mfma_f32_16x16x32_bf16 v[196:199], v[120:123], a[168:171], 0
    ds_read_b128 v[116:119], v0 offset:32768
    v_fmac_f32 v131, v182, v182
    v_mfma_f32_16x16x32_bf16 v[196:199], v[140:143], a[172:175], v[196:199]
    ds_read_b128 v[204:207], v1 offset:32768
    v_fmac_f32 v131, v183, v183
    v_mfma_f32_16x16x32_bf16 v[196:199], v[232:235], a[176:179], v[196:199]
    ds_read_b128 v[192:195], v0 offset:32896
    v_cvt_pk_bf16_f32 v238, v188, v189
    v_mfma_f32_16x16x32_bf16 v[196:199], v[224:227], a[180:183], v[196:199]
    ds_read_b128 v[220:223], v1 offset:32896
    v_cvt_pk_bf16_f32 v239, v190, v191
    v_mfma_f32_16x16x32_bf16 v[196:199], v[212:215], a[184:187], v[196:199]
    ds_read_b128 v[188:191], v0 offset:33024
    v_cvt_pk_bf16_f32 v36, v130, v131
    v_mfma_f32_16x16x32_bf16 v[196:199], v[144:147], a[188:191], v[196:199]
    ds_read_b128 v[240:243], v1 offset:33024
    v_mul_f32 v200, v170, v200
    v_mfma_f32_16x16x32_bf16 v[216:219], v[32:35], v[36:39], 0
    v_mul_f32 v201, v170, v201
    v_cvt_pk_bf16_f32 v200, v200, v201
    v_mfma_f32_16x16x32_bf16 v[228:231], v[120:123], a[192:195], 0
    v_mul_f32 v202, v170, v202
    v_mul_f32 v203, v170, v203
    v_mfma_f32_16x16x32_bf16 v[228:231], v[140:143], a[196:199], v[228:231]
    s_waitcnt lgkmcnt(5)
    v_cvt_pk_bf16_f32 v130, v196, v197
    v_cvt_pk_bf16_f32 v131, v198, v199
    v_mfma_f32_16x16x32_bf16 v[228:231], v[232:235], a[200:203], v[228:231]
    s_waitcnt lgkmcnt(4)
    v_rsq_f32 v217, v217
    v_mfma_f32_16x16x32_bf16 v[228:231], v[224:227], a[204:207], v[228:231]
    s_waitcnt lgkmcnt(3)
    v_rsq_f32 v216, v216
    v_mfma_f32_16x16x32_bf16 v[228:231], v[212:215], a[208:211], v[228:231]
    s_waitcnt lgkmcnt(2)
    v_mul_f32 v216, s31, v216
    v_mul_f32 v112, v217, v112
    v_mfma_f32_16x16x32_bf16 v[228:231], v[144:147], a[212:215], v[228:231]
    s_waitcnt lgkmcnt(1)
    v_mul_f32 v113, v217, v113
    v_cvt_pk_bf16_f32 v112, v112, v113
    v_mfma_f32_16x16x32_bf16 v[120:123], a[72:75], v[116:119], 0
    s_waitcnt lgkmcnt(0)
    v_mul_f32 v114, v217, v114
    v_mul_f32 v115, v217, v115
    v_mfma_f32_16x16x32_bf16 v[120:123], a[76:79], v[204:207], v[120:123]
    v_cvt_pk_bf16_f32 v166, v228, v229
    v_cvt_pk_bf16_f32 v167, v230, v231
    v_mfma_f32_16x16x32_bf16 v[120:123], a[80:83], v[192:195], v[120:123]
    v_cvt_pk_bf16_f32 v113, v114, v115
    v_mul_f32 v148, v217, v148
    v_mfma_f32_16x16x32_bf16 v[120:123], a[84:87], v[220:223], v[120:123]
    v_mul_f32 v149, v217, v149
    v_cvt_pk_bf16_f32 v114, v148, v149
    v_mfma_f32_16x16x32_bf16 v[120:123], a[88:91], v[188:191], v[120:123]
    v_mul_f32 v150, v217, v150
    v_mul_f32 v151, v217, v151
    v_mfma_f32_16x16x32_bf16 v[120:123], a[92:95], v[240:243], v[120:123]
    v_cvt_pk_bf16_f32 v115, v150, v151
    v_mul_f32 v180, v217, v180
    v_mfma_f32_16x16x32_bf16 v[140:143], a[96:99], v[116:119], 0
    v_mul_f32 v181, v217, v181
    v_cvt_pk_bf16_f32 v146, v180, v181
    v_mfma_f32_16x16x32_bf16 v[140:143], a[100:103], v[204:207], v[140:143]
    v_mul_f32 v182, v217, v182
    v_mul_f32 v183, v217, v183
    v_mfma_f32_16x16x32_bf16 v[140:143], a[104:107], v[192:195], v[140:143]
    v_cvt_pk_bf16_f32 v147, v182, v183
    v_mul_f32 v108, v216, v108
    v_mfma_f32_16x16x32_bf16 v[140:143], a[108:111], v[220:223], v[140:143]
    v_mul_f32 v109, v216, v109
    v_cvt_pk_bf16_f32 v148, v108, v109
    v_mfma_f32_16x16x32_bf16 v[140:143], a[112:115], v[188:191], v[140:143]
    v_mul_f32 v110, v216, v110
    v_mul_f32 v111, v216, v111
    v_mfma_f32_16x16x32_bf16 v[140:143], a[116:119], v[240:243], v[140:143]
    v_cvt_pk_bf16_f32 v149, v110, v111
    v_mul_f32 v152, v216, v152
    v_mfma_f32_16x16x32_bf16 v[108:111], a[120:123], v[116:119], 0
    v_mul_f32 v153, v216, v153
    v_cvt_pk_bf16_f32 v150, v152, v153
    v_mfma_f32_16x16x32_bf16 v[108:111], a[124:127], v[204:207], v[108:111]
    v_mul_f32 v154, v216, v154
    v_mul_f32 v155, v216, v155
    v_mfma_f32_16x16x32_bf16 v[108:111], a[128:131], v[192:195], v[108:111]
    v_cvt_pk_bf16_f32 v151, v154, v155
    v_mul_f32 v160, v216, v160
    v_mfma_f32_16x16x32_bf16 v[108:111], a[132:135], v[220:223], v[108:111]
    v_mul_f32 v161, v216, v161
    v_cvt_pk_bf16_f32 v144, v160, v161
    v_mfma_f32_16x16x32_bf16 v[108:111], a[136:139], v[188:191], v[108:111]
    v_mul_f32 v162, v216, v162
    v_mul_f32 v163, v216, v163
    v_mfma_f32_16x16x32_bf16 v[108:111], a[140:143], v[240:243], v[108:111]
    s_waitcnt vmcnt(2)
    v_cvt_pk_bf16_f32 v145, v162, v163
    v_fma_f32 v168, v120, v120, s32
    v_mfma_f32_16x16x32_bf16 v[152:155], a[0:3], v[116:119], 0
    s_nop 0
    v_fmac_f32 v168, v121, v121
    v_fmac_f32 v168, v122, v122
    v_mfma_f32_16x16x32_bf16 v[152:155], a[4:7], v[204:207], v[152:155]
    s_barrier
    v_fmac_f32 v168, v123, v123
    v_fmac_f32 v168, v140, v140
    v_mfma_f32_16x16x32_bf16 v[152:155], a[8:11], v[192:195], v[152:155]
    s_nop 0
    v_fmac_f32 v168, v141, v141
    v_fmac_f32 v168, v142, v142
    v_mfma_f32_16x16x32_bf16 v[152:155], a[12:15], v[220:223], v[152:155]
    s_nop 0
    buffer_load_dwordx4 v10, s[8:11], 0 offen nt lds
    v_fmac_f32 v168, v143, v143
    v_mfma_f32_16x16x32_bf16 v[152:155], a[16:19], v[188:191], v[152:155]
    s_add_u32 m0, s28, 4096
    v_fmac_f32 v168, v108, v108
    v_fmac_f32 v168, v109, v109
    v_mfma_f32_16x16x32_bf16 v[152:155], a[20:23], v[240:243], v[152:155]
    v_fmac_f32 v168, v110, v110
    v_fmac_f32 v168, v111, v111
    v_mfma_f32_16x16x32_bf16 v[160:163], a[24:27], v[116:119], 0
    v_cvt_pk_bf16_f32 v201, v202, v203
    v_mul_f32 v244, v170, v244
    v_mfma_f32_16x16x32_bf16 v[160:163], a[28:31], v[204:207], v[160:163]
    v_mul_f32 v245, v170, v245
    v_cvt_pk_bf16_f32 v202, v244, v245
    v_mfma_f32_16x16x32_bf16 v[160:163], a[32:35], v[192:195], v[160:163]
    buffer_load_dwordx4 v11, s[8:11], 0 offen nt lds
    v_fma_f32 v169, v152, v152, s32
    v_mfma_f32_16x16x32_bf16 v[160:163], a[36:39], v[220:223], v[160:163]
    s_add_u32 m0, s28, 8192
    v_fmac_f32 v169, v153, v153
    v_fmac_f32 v169, v154, v154
    v_mfma_f32_16x16x32_bf16 v[160:163], a[40:43], v[188:191], v[160:163]
    v_fmac_f32 v169, v155, v155
    v_mul_f32 v246, v170, v246
    v_mfma_f32_16x16x32_bf16 v[160:163], a[44:47], v[240:243], v[160:163]
    v_mul_f32 v247, v170, v247
    v_cvt_pk_bf16_f32 v203, v246, v247
    v_mfma_f32_16x16x32_bf16 v[196:199], a[48:51], v[116:119], 0
    v_mul_f32 v132, v170, v132
    v_mul_f32 v133, v170, v133
    v_mfma_f32_16x16x32_bf16 v[196:199], a[52:55], v[204:207], v[196:199]
    buffer_load_dwordx4 v12, s[8:11], 0 offen nt lds
    v_cvt_pk_bf16_f32 v216, v132, v133
    v_mfma_f32_16x16x32_bf16 v[196:199], a[56:59], v[192:195], v[196:199]
    s_add_u32 m0, s28, 12288
    ds_read2_b32 v[250:251], v6 offset0:0 offset1:0
    ds_read2_b32 v[234:235], v6 offset0:16 offset1:16
    v_mfma_f32_16x16x32_bf16 v[196:199], a[60:63], v[220:223], v[196:199]
    s_xor_b32 s28, s28, 65536
    ds_read_b128 v[224:227], v5 offset:0
    ds_read_b128 v[180:183], v5 offset:16
    v_mfma_f32_16x16x32_bf16 v[196:199], a[64:67], v[188:191], v[196:199]
    v_fmac_f32 v169, v160, v160
    v_fmac_f32 v169, v161, v161
    v_mfma_f32_16x16x32_bf16 v[196:199], a[68:71], v[240:243], v[196:199]
    ds_read_b128 v[212:215], v5 offset:48
    ds_read_b32 v173, v6 offset:192
    v_mfma_f32_16x16x32_bf16 v[228:231], v[116:119], a[144:147], 0
    buffer_load_dwordx4 v13, s[8:11], 0 offen nt lds
    ds_read2_b32 v[218:219], v6 offset0:32 offset1:32
    v_mfma_f32_16x16x32_bf16 v[228:231], v[204:207], a[148:151], v[228:231]
    s_mov_b32 m0, s29
    v_fmac_f32 v169, v162, v162
    v_fmac_f32 v169, v163, v163
    v_mfma_f32_16x16x32_bf16 v[228:231], v[192:195], a[152:155], v[228:231]
    s_xor_b32 s29, s29, s30
    v_fmac_f32 v169, v196, v196
    v_fmac_f32 v169, v197, v197
    v_mfma_f32_16x16x32_bf16 v[228:231], v[220:223], a[156:159], v[228:231]
    s_add_u32 s19, s19, s20
    v_fmac_f32 v169, v198, v198
    v_fmac_f32 v169, v199, v199
    v_mfma_f32_16x16x32_bf16 v[228:231], v[188:191], a[160:163], v[228:231]
    s_add_u32 s23, s23, s21
    v_cvt_pk_bf16_f32 v36, v169, v168
    v_mul_f32 v134, v170, v134
    v_mfma_f32_16x16x32_bf16 v[228:231], v[240:243], a[164:167], v[228:231]
    s_waitcnt lgkmcnt(3)
    buffer_store_dwordx4 v[200:203], v17, s[12:15], 0 offen
    v_mul_f32 v135, v170, v135
    v_cvt_pk_bf16_f32 v217, v134, v135
    v_mul_f32 v136, v172, v136
    v_mul_f32 v137, v172, v137
    v_mfma_f32_16x16x32_bf16 v[168:171], v[32:35], v[36:39], 0
    s_cmp_ge_u32 s19, 72
    v_cvt_pk_bf16_f32 v248, v228, v229
    v_cvt_pk_bf16_f32 v249, v230, v231
    v_mfma_f32_16x16x32_bf16 v[132:135], v[224:227], v[124:127], v[22:25]
    s_cselect_b32 s34, 72, 0
    v_cvt_pk_bf16_f32 v200, v136, v137
    v_mul_f32 v138, v172, v138
    v_mfma_f32_16x16x32_bf16 v[132:135], v[180:183], v[184:187], v[132:135]
    s_waitcnt lgkmcnt(0)
    v_rsq_f32 v169, v169
    v_mfma_f32_16x16x32_bf16 v[132:135], v[212:215], v[176:179], v[132:135]
    s_cselect_b32 s35, s22, 0
    v_rsq_f32 v168, v168
    v_mfma_f32_16x16x32_bf16 v[228:231], v[116:119], a[168:171], 0
    s_sub_u32 s19, s19, s34
    v_mul_f32 v168, s31, v168
    v_mul_f32 v120, v169, v120
    v_mfma_f32_16x16x32_bf16 v[228:231], v[204:207], a[172:175], v[228:231]
    s_add_u32 s23, s23, s35
    v_mov_b32_dpp v173, v133 quad_perm:[0,1,2,3] row_mask:0x1 bank_mask:0xf
    v_mul_f32 v121, v169, v121
    v_mfma_f32_16x16x32_bf16 v[228:231], v[192:195], a[176:179], v[228:231]
    s_add_u32 s18, s18, 1
    v_cvt_pk_bf16_f32 v120, v120, v121
    v_mul_f32 v122, v169, v122
    v_mfma_f32_16x16x32_bf16 v[228:231], v[220:223], a[180:183], v[228:231]
    s_cmp_lt_u32 s18, s17
    v_mul_f32 v123, v169, v123
    v_cvt_pk_bf16_f32 v121, v122, v123
    v_mfma_f32_16x16x32_bf16 v[228:231], v[188:191], a[184:187], v[228:231]
    v_mul_f32 v140, v169, v140
    v_mul_f32 v141, v169, v141
    v_mfma_f32_16x16x32_bf16 v[228:231], v[240:243], a[188:191], v[228:231]
    v_cvt_pk_bf16_f32 v122, v140, v141
    v_mul_f32 v142, v169, v142
    v_mfma_f32_16x16x32_bf16 v[244:247], v[116:119], a[192:195], 0
    v_mul_f32 v143, v169, v143
    v_cvt_pk_bf16_f32 v123, v142, v143
    v_mfma_f32_16x16x32_bf16 v[244:247], v[204:207], a[196:199], v[244:247]
    v_mul_f32 v108, v169, v108
    v_mul_f32 v109, v169, v109
    v_mfma_f32_16x16x32_bf16 v[244:247], v[192:195], a[200:203], v[244:247]
    ds_read_b128 v[116:119], v2 offset:0
    v_cvt_pk_bf16_f32 v232, v228, v229
    v_mfma_f32_16x16x32_bf16 v[244:247], v[220:223], a[204:207], v[244:247]
    ds_read_b128 v[204:207], v2 offset:1024
    v_cvt_pk_bf16_f32 v233, v230, v231
    v_mfma_f32_16x16x32_bf16 v[244:247], v[188:191], a[208:211], v[244:247]
    ds_read_b128 v[140:143], v2 offset:2048
    v_cvt_pk_bf16_f32 v190, v108, v109
    v_mfma_f32_16x16x32_bf16 v[244:247], v[240:243], a[212:215], v[244:247]
    ds_read_b128 v[252:255], v2 offset:3072
    ds_read_b128 v[192:195], v2 offset:4096
    v_mfma_f32_16x16x32_bf16 v[220:223], v[184:187], v[124:127], v[40:43]
    ds_read_b128 v[134:137], v2 offset:5120
    buffer_store_dwordx2 v[216:217], v20, s[12:15], 0 offen
    v_mul_f32 v110, v169, v110
    v_mul_f32 v111, v169, v111
    v_mfma_f32_16x16x32_bf16 v[240:243], v[112:115], v[124:127], v[44:47]
    v_cvt_pk_bf16_f32 v216, v244, v245
    v_cvt_pk_bf16_f32 v217, v246, v247
    v_mfma_f32_16x16x32_bf16 v[228:231], v[120:123], v[124:127], v[48:51]
    v_cvt_pk_bf16_f32 v191, v110, v111
    v_mul_f32 v152, v168, v152
    v_mul_f32 v153, v168, v153
    v_mfma_f32_16x16x16_bf16 v[220:223], v[178:179], v[176:177], v[220:223]
    v_cvt_pk_bf16_f32 v244, v152, v153
    v_mul_f32 v154, v168, v154
    v_mul_f32 v155, v168, v155
    v_mfma_f32_16x16x16_bf16 v[240:243], v[146:147], v[176:177], v[240:243]
    v_cvt_pk_bf16_f32 v245, v154, v155
    v_mul_f32 v160, v168, v160
    v_mul_f32 v161, v168, v161
    v_mfma_f32_16x16x16_bf16 v[228:231], v[190:191], v[176:177], v[228:231]
    v_cvt_pk_bf16_f32 v246, v160, v161
    v_mul_f32 v162, v168, v162
    v_mul_f32 v163, v168, v163
    v_cvt_pk_bf16_f32 v247, v162, v163
    v_mfma_f32_16x16x32_bf16 v[124:127], v[224:227], v[148:151], v[24:27]
    s_waitcnt lgkmcnt(1)
    v_mul_f32 v196, v168, v196
    v_mul_f32 v197, v168, v197
    v_mfma_f32_16x16x32_bf16 v[124:127], v[180:183], v[112:115], v[124:127]
    s_waitcnt lgkmcnt(0)
    v_cvt_pk_bf16_f32 v188, v196, v197
    v_mul_f32 v198, v168, v198
    v_mfma_f32_16x16x32_bf16 v[124:127], v[212:215], v[144:147], v[124:127]
    v_mul_f32 v199, v168, v199
    v_cvt_pk_bf16_f32 v189, v198, v199
    v_mfma_f32_16x16x32_bf16 v[160:163], v[224:227], v[244:247], v[26:29]
    v_max3_f32 v133, v132, v220, v221
    v_max3_f32 v133, v133, v222, v223
    v_mfma_f32_16x16x32_bf16 v[160:163], v[180:183], v[120:123], v[160:163]
    v_max3_f32 v133, v133, v240, v241
    v_max3_f32 v133, v133, v242, v243
    v_mfma_f32_16x16x32_bf16 v[160:163], v[212:215], v[188:191], v[160:163]
    v_max3_f32 v133, v133, v228, v229
    v_max3_f32 v133, v133, v230, v231
    v_mfma_f32_16x16x32_bf16 v[180:183], a[216:219], v[116:119], 0
    v_mov_b32 v174, v133
    v_mov_b32_dpp v173, v125 quad_perm:[0,1,2,3] row_mask:0x2 bank_mask:0xf
    v_mfma_f32_16x16x32_bf16 v[180:183], a[220:223], v[204:207], v[180:183]
    v_permlane32_swap_b32 v133, v174
    v_mfma_f32_16x16x32_bf16 v[180:183], a[224:227], v[140:143], v[180:183]
    v_max_f32 v133, v133, v174
    v_mov_b32 v174, v133
    v_mfma_f32_16x16x32_bf16 v[180:183], a[228:231], v[252:255], v[180:183]
    v_mov_b32_dpp v173, v161 quad_perm:[0,1,2,3] row_mask:0x4 bank_mask:0xf
    v_mul_f32 v139, v172, v139
    v_mfma_f32_16x16x32_bf16 v[180:183], a[232:235], v[192:195], v[180:183]
    v_permlane16_swap_b32 v133, v174
    v_mfma_f32_16x16x32_bf16 v[180:183], a[236:239], v[134:137], v[180:183]
    v_max_f32 v133, v133, v174
    v_sub_f32 v220, v220, v133
    v_mfma_f32_16x16x32_bf16 v[108:111], a[240:243], v[116:119], 0
    v_exp_f32 v220, v220
    v_mfma_f32_16x16x32_bf16 v[108:111], a[244:247], v[204:207], v[108:111]
    v_sub_f32 v221, v221, v133
    v_sub_f32 v222, v222, v133
    v_mfma_f32_16x16x32_bf16 v[108:111], a[248:251], v[140:143], v[108:111]
    v_exp_f32 v221, v221
    v_mfma_f32_16x16x32_bf16 v[108:111], a[252:255], v[252:255], v[108:111]
    ds_read_b128 v[168:171], v2 offset:6144
    v_cvt_pk_bf16_f32 v212, v220, v221
    v_mfma_f32_16x16x32_bf16 v[108:111], v[76:79], v[192:195], v[108:111]
    ds_read_b128 v[196:199], v2 offset:7168
    v_sub_f32 v223, v223, v133
    v_mfma_f32_16x16x32_bf16 v[108:111], v[80:83], v[134:137], v[108:111]
    ds_read_b128 v[224:227], v2 offset:8192
    v_sub_f32 v240, v240, v133
    v_mfma_f32_16x16x32_bf16 v[152:155], v[84:87], v[116:119], 0
    ds_read_b128 v[174:177], v2 offset:9216
    v_sub_f32 v241, v241, v133
    v_mfma_f32_16x16x32_bf16 v[152:155], v[88:91], v[204:207], v[152:155]
    ds_read_b128 v[116:119], v2 offset:10240
    v_sub_f32 v242, v242, v133
    v_mfma_f32_16x16x32_bf16 v[152:155], v[92:95], v[140:143], v[152:155]
    ds_read_b128 v[204:207], v2 offset:11264
    v_sub_f32 v243, v243, v133
    v_mfma_f32_16x16x32_bf16 v[152:155], v[96:99], v[252:255], v[152:155]
    v_exp_f32 v222, v222
    v_mfma_f32_16x16x32_bf16 v[152:155], v[100:103], v[192:195], v[152:155]
    v_exp_f32 v223, v223
    v_mfma_f32_16x16x32_bf16 v[152:155], v[104:107], v[134:137], v[152:155]
    s_waitcnt lgkmcnt(5)
    v_cvt_pk_bf16_f32 v213, v222, v223
    v_exp_f32 v240, v240
    v_exp_f32 v241, v241
    v_mfma_f32_16x16x32_bf16 v[140:143], v[184:187], v[148:151], v[52:55]
    s_waitcnt lgkmcnt(3)
    v_cvt_pk_bf16_f32 v214, v240, v241
    v_exp_f32 v242, v242
    v_exp_f32 v243, v243
    v_sub_f32 v228, v228, v133
    v_cvt_pk_bf16_f32 v215, v242, v243
    v_mfma_f32_16x16x16_bf16 v[140:143], v[178:179], v[144:145], v[140:143]
    v_exp_f32 v228, v228
    v_sub_f32 v229, v229, v133
    v_exp_f32 v229, v229
    v_mfma_f32_16x16x32_bf16 v[192:195], v[112:115], v[148:151], v[56:59]
    s_waitcnt lgkmcnt(0)
    v_cvt_pk_bf16_f32 v36, v228, v229
    v_sub_f32 v230, v230, v133
    v_exp_f32 v230, v230
    v_sub_f32 v231, v231, v133
    v_exp_f32 v231, v231
    v_mfma_f32_16x16x32_bf16 v[220:223], v[120:123], v[148:151], v[60:63]
    v_cvt_pk_bf16_f32 v37, v230, v231
    v_sub_f32 v132, v132, v133
    v_max3_f32 v203, v124, v140, v141
    v_mfma_f32_16x16x16_bf16 v[192:195], v[146:147], v[144:145], v[192:195]
    v_exp_f32 v132, v132
    v_max3_f32 v203, v203, v142, v143
    v_mfma_f32_16x16x16_bf16 v[220:223], v[190:191], v[144:145], v[220:223]
    v_cvt_pk_bf16_f32 v39, v132, 0
    v_cvt_pk_bf16_f32 v201, v138, v139
    v_mul_f32 v208, v172, v208
    v_mul_f32 v209, v172, v209
    v_mfma_f32_16x16x32_bf16 v[132:135], v[28:31], v[36:39], 0
    v_max3_f32 v203, v203, v192, v193
    v_max3_f32 v203, v203, v194, v195
    v_mfma_f32_16x16x32_bf16 v[132:135], v[28:31], v[212:215], v[132:135]
    v_max3_f32 v203, v203, v220, v221
    v_max3_f32 v203, v203, v222, v223
    v_mfma_f32_16x16x32_bf16 v[148:151], v[248:251], v[36:39], 0
    v_mov_b32 v144, v203
    v_cvt_pk_bf16_f32 v202, v208, v209
    v_mfma_f32_16x16x32_bf16 v[148:151], v[236:239], v[212:215], v[148:151]
    v_permlane32_swap_b32 v203, v144
    v_mfma_f32_16x16x32_bf16 v[228:231], v[232:235], v[36:39], 0
    v_max_f32 v203, v203, v144
    v_mov_b32 v144, v203
    v_mfma_f32_16x16x32_bf16 v[228:231], v[128:131], v[212:215], v[228:231]
    v_rcp_f32 v132, v132
    v_mfma_f32_16x16x32_bf16 v[240:243], v[216:219], v[36:39], 0
    v_permlane16_swap_b32 v203, v144
    v_mfma_f32_16x16x32_bf16 v[240:243], v[164:167], v[212:215], v[240:243]
    v_max_f32 v203, v203, v144
    v_sub_f32 v140, v140, v203
    v_mfma_f32_16x16x32_bf16 v[136:139], a[216:219], v[168:171], 0
    v_exp_f32 v140, v140
    v_mfma_f32_16x16x32_bf16 v[136:139], a[220:223], v[196:199], v[136:139]
    v_sub_f32 v141, v141, v203
    v_sub_f32 v142, v142, v203
    v_mfma_f32_16x16x32_bf16 v[136:139], a[224:227], v[224:227], v[136:139]
    v_exp_f32 v141, v141
    v_mfma_f32_16x16x32_bf16 v[136:139], a[228:231], v[174:177], v[136:139]
    v_cvt_pk_bf16_f32 v140, v140, v141
    v_sub_f32 v143, v143, v203
    v_mfma_f32_16x16x32_bf16 v[136:139], a[232:235], v[116:119], v[136:139]
    v_exp_f32 v142, v142
    v_mfma_f32_16x16x32_bf16 v[136:139], a[236:239], v[204:207], v[136:139]
    v_exp_f32 v143, v143
    v_sub_f32 v192, v192, v203
    v_cvt_pk_bf16_f32 v141, v142, v143
    v_exp_f32 v192, v192
    v_sub_f32 v193, v193, v203
    v_exp_f32 v193, v193
    v_sub_f32 v194, v194, v203
    v_cvt_pk_bf16_f32 v142, v192, v193
    v_exp_f32 v194, v194
    v_sub_f32 v195, v195, v203
    v_exp_f32 v195, v195
    v_sub_f32 v220, v220, v203
    v_cvt_pk_bf16_f32 v143, v194, v195
    v_exp_f32 v220, v220
    v_sub_f32 v221, v221, v203
    v_exp_f32 v221, v221
    v_sub_f32 v222, v222, v203
    v_cvt_pk_bf16_f32 v36, v220, v221
    v_exp_f32 v222, v222
    v_sub_f32 v223, v223, v203
    v_exp_f32 v223, v223
    v_mfma_f32_16x16x32_bf16 v[192:195], v[184:187], v[244:247], v[64:67]
    v_cvt_pk_bf16_f32 v37, v222, v223
    v_sub_f32 v124, v124, v203
    v_mfma_f32_16x16x32_bf16 v[184:187], v[112:115], v[244:247], v[68:71]
    v_exp_f32 v124, v124
    v_mfma_f32_16x16x32_bf16 v[212:215], v[120:123], v[244:247], v[72:75]
    v_cvt_pk_bf16_f32 v39, v124, 0
    v_mul_f32 v148, v132, v148
    v_mul_f32 v149, v132, v149
    v_mfma_f32_16x16x32_bf16 v[120:123], v[28:31], v[36:39], 0
    v_cvt_pk_bf16_f32 v112, v148, v149
    v_mul_f32 v150, v132, v150
    v_mfma_f32_16x16x32_bf16 v[120:123], v[28:31], v[140:143], v[120:123]
    v_mul_f32 v151, v132, v151
    v_cvt_pk_bf16_f32 v113, v150, v151
    v_mfma_f32_16x16x32_bf16 v[124:127], v[248:251], v[36:39], 0
    v_mul_f32 v228, v132, v228
    v_mul_f32 v229, v132, v229
    v_mfma_f32_16x16x32_bf16 v[124:127], v[236:239], v[140:143], v[124:127]
    v_cvt_pk_bf16_f32 v114, v228, v229
    v_mul_f32 v230, v132, v230
    v_mfma_f32_16x16x32_bf16 v[220:223], v[232:235], v[36:39], 0
    v_mul_f32 v231, v132, v231
    v_cvt_pk_bf16_f32 v115, v230, v231
    v_mfma_f32_16x16x32_bf16 v[220:223], v[128:131], v[140:143], v[220:223]
    ds_write_b128 v3, v[112:115] offset:0
    v_mfma_f32_16x16x32_bf16 v[252:255], v[216:219], v[36:39], 0
    v_mul_f32 v240, v132, v240
    v_mul_f32 v241, v132, v241
    v_mfma_f32_16x16x32_bf16 v[252:255], v[164:167], v[140:143], v[252:255]
    v_cvt_pk_bf16_f32 v122, v240, v241
    v_mul_f32 v242, v132, v242
    v_mul_f32 v243, v132, v243
    v_mfma_f32_16x16x16_bf16 v[192:195], v[178:179], v[188:189], v[192:195]
    v_cvt_pk_bf16_f32 v123, v242, v243
    v_mul_f32 v210, v172, v210
    v_mul_f32 v211, v172, v211
    v_mfma_f32_16x16x16_bf16 v[184:187], v[146:147], v[188:189], v[184:187]
    v_cvt_pk_bf16_f32 v203, v210, v211
    v_mul_f32 v156, v172, v156
    v_mul_f32 v157, v172, v157
    v_mfma_f32_16x16x16_bf16 v[212:215], v[190:191], v[188:189], v[212:215]
    v_cvt_pk_bf16_f32 v178, v156, v157
    v_mul_f32 v158, v172, v158
    v_mul_f32 v159, v172, v159
    v_cvt_pk_bf16_f32 v179, v158, v159
    v_mfma_f32_16x16x32_bf16 v[208:211], a[240:243], v[168:171], 0
    ds_write_b64 v4, v[122:123] offset:4096
    v_mfma_f32_16x16x32_bf16 v[208:211], a[244:247], v[196:199], v[208:211]
    buffer_store_dwordx4 v[200:203], v16, s[12:15], 0 offen
    v_mov_b32 v172, v173
    v_max3_f32 v121, v160, v192, v193
    v_max3_f32 v121, v121, v194, v195
    v_max_f32_dpp v172, v172, v172 quad_perm:[1,0,3,2] row_mask:0xf bank_mask:0xf
    v_mfma_f32_16x16x32_bf16 v[208:211], a[248:251], v[224:227], v[208:211]
    v_max3_f32 v121, v121, v184, v185
    v_max_f32_dpp v172, v172, v172 quad_perm:[2,3,0,1] row_mask:0xf bank_mask:0xf
    v_mfma_f32_16x16x32_bf16 v[208:211], a[252:255], v[174:177], v[208:211]
    ds_read_b128 v[112:115], v2 offset:12288
    v_max_f32_dpp v172, v172, v172 row_half_mirror row_mask:0xf bank_mask:0xf
    v_mfma_f32_16x16x32_bf16 v[208:211], v[76:79], v[116:119], v[208:211]
    ds_read_b128 v[188:191], v2 offset:13312
    v_max_f32_dpp v172, v172, v172 row_mirror row_mask:0xf bank_mask:0xf
    v_mfma_f32_16x16x32_bf16 v[208:211], v[80:83], v[204:207], v[208:211]
    ds_read_b128 v[144:147], v2 offset:14336
    v_mov_b32 v122, v172
    v_mfma_f32_16x16x32_bf16 v[156:159], v[84:87], v[168:171], 0
    ds_read_b128 v[140:143], v2 offset:15360
    v_max3_f32 v121, v121, v186, v187
    v_mfma_f32_16x16x32_bf16 v[156:159], v[88:91], v[196:199], v[156:159]
    ds_read_b128 v[168:171], v2 offset:16384
    v_max3_f32 v121, v121, v212, v213
    v_mfma_f32_16x16x32_bf16 v[156:159], v[92:95], v[224:227], v[156:159]
    ds_read_b128 v[148:151], v2 offset:17408
    v_max3_f32 v121, v121, v214, v215
    v_mfma_f32_16x16x32_bf16 v[156:159], v[96:99], v[174:177], v[156:159]
    v_permlane32_swap_b32 v172, v122
    v_mfma_f32_16x16x32_bf16 v[156:159], v[100:103], v[116:119], v[156:159]
    v_max_f32 v172, v172, v122
    v_mov_b32 v122, v172
    v_mfma_f32_16x16x32_bf16 v[156:159], v[104:107], v[204:207], v[156:159]
    s_waitcnt lgkmcnt(5)
    v_permlane16_swap_b32 v172, v122
    v_mfma_f32_16x16x32_bf16 v[200:203], a[216:219], v[112:115], 0
    s_waitcnt lgkmcnt(4)
    v_max_f32 v172, v172, v122
    v_sub_f32 v173, v173, v172
    v_mfma_f32_16x16x32_bf16 v[200:203], a[220:223], v[188:191], v[200:203]
    s_waitcnt lgkmcnt(3)
    v_exp_f32 v173, v173
    v_mfma_f32_16x16x32_bf16 v[200:203], a[224:227], v[144:147], v[200:203]
    s_waitcnt lgkmcnt(2)
    v_cvt_pk_bf16_f32 v173, v173, v173
    v_mov_b32 v122, v121
    v_mfma_f32_16x16x32_bf16 v[200:203], a[228:231], v[140:143], v[200:203]
    s_waitcnt lgkmcnt(1)
    ds_write_b16 v8, v173
    v_mfma_f32_16x16x32_bf16 v[200:203], a[232:235], v[168:171], v[200:203]
    s_waitcnt lgkmcnt(1)
    v_permlane32_swap_b32 v121, v122
    v_mfma_f32_16x16x32_bf16 v[200:203], a[236:239], v[148:151], v[200:203]
    v_max_f32 v121, v121, v122
    v_mov_b32 v122, v121
    v_mfma_f32_16x16x32_bf16 v[244:247], a[240:243], v[112:115], 0
    buffer_store_dwordx2 v[178:179], v19, s[12:15], 0 offen
    v_permlane16_swap_b32 v121, v122
    v_mfma_f32_16x16x32_bf16 v[244:247], a[244:247], v[188:191], v[244:247]
    v_max_f32 v121, v121, v122
    v_sub_f32 v192, v192, v121
    v_mfma_f32_16x16x32_bf16 v[244:247], a[248:251], v[144:147], v[244:247]
    v_fma_f32 v122, v200, v200, s33
    v_fmac_f32 v122, v201, v201
    v_mfma_f32_16x16x32_bf16 v[244:247], a[252:255], v[140:143], v[244:247]
    v_fmac_f32 v122, v202, v202
    v_fmac_f32 v122, v203, v203
    v_mfma_f32_16x16x32_bf16 v[244:247], v[76:79], v[168:171], v[244:247]
    v_exp_f32 v192, v192
    v_mfma_f32_16x16x32_bf16 v[244:247], v[80:83], v[148:151], v[244:247]
    v_sub_f32 v193, v193, v121
    v_sub_f32 v194, v194, v121
    v_mfma_f32_16x16x32_bf16 v[132:135], v[84:87], v[112:115], 0
    v_exp_f32 v193, v193
    v_mfma_f32_16x16x32_bf16 v[132:135], v[88:91], v[188:191], v[132:135]
    v_cvt_pk_bf16_f32 v116, v192, v193
    v_sub_f32 v195, v195, v121
    v_mfma_f32_16x16x32_bf16 v[132:135], v[92:95], v[144:147], v[132:135]
    v_fmac_f32 v122, v244, v244
    v_fmac_f32 v122, v245, v245
    v_mfma_f32_16x16x32_bf16 v[132:135], v[96:99], v[140:143], v[132:135]
    v_fmac_f32 v122, v246, v246
    v_fmac_f32 v122, v247, v247
    v_mfma_f32_16x16x32_bf16 v[132:135], v[100:103], v[168:171], v[132:135]
    v_exp_f32 v194, v194
    v_mfma_f32_16x16x32_bf16 v[132:135], v[104:107], v[148:151], v[132:135]
    v_exp_f32 v195, v195
    v_sub_f32 v184, v184, v121
    v_cvt_pk_bf16_f32 v117, v194, v195
    v_exp_f32 v184, v184
    v_sub_f32 v185, v185, v121
    v_exp_f32 v185, v185
    v_sub_f32 v186, v186, v121
    v_cvt_pk_bf16_f32 v118, v184, v185
    v_fmac_f32 v122, v132, v132
    v_fmac_f32 v122, v133, v133
    v_fmac_f32 v122, v134, v134
    v_fmac_f32 v122, v135, v135
    v_cvt_pk_bf16_f32 v123, v122, v122
    v_exp_f32 v186, v186
    v_sub_f32 v187, v187, v121
    v_exp_f32 v187, v187
    v_sub_f32 v212, v212, v121
    v_cvt_pk_bf16_f32 v119, v186, v187
    v_exp_f32 v212, v212
    v_sub_f32 v213, v213, v121
    v_exp_f32 v213, v213
    v_sub_f32 v214, v214, v121
    v_cvt_pk_bf16_f32 v36, v212, v213
    v_exp_f32 v214, v214
    v_sub_f32 v215, v215, v121
    v_exp_f32 v215, v215
    v_sub_f32 v160, v160, v121
    v_cvt_pk_bf16_f32 v37, v214, v215
    v_exp_f32 v160, v160
    v_xor_b32 v0, 65536, v0
    v_cvt_pk_bf16_f32 v39, v160, 0
    v_xor_b32 v1, 65536, v1
    v_fma_f32 v121, v136, v136, s33
    v_mfma_f32_16x16x32_bf16 v[140:143], v[28:31], v[36:39], 0
    ds_read_b128 v[196:199], v0 offset:20480
    ds_read_b128 v[184:187], v1 offset:20480
    v_mfma_f32_16x16x32_bf16 v[140:143], v[28:31], v[116:119], v[140:143]
    ds_read_b128 v[172:175], v0 offset:20608
    ds_read_b128 v[148:151], v1 offset:20608
    v_mfma_f32_16x16x32_bf16 v[144:147], v[248:251], v[36:39], 0
    buffer_load_dwordx4 v14, s[8:11], 0 offen nt lds
    ds_read_b128 v[112:115], v0 offset:20736
    v_mfma_f32_16x16x32_bf16 v[144:147], v[236:239], v[116:119], v[144:147]
    v_fmac_f32 v121, v137, v137
    v_fmac_f32 v121, v138, v138
    v_mfma_f32_16x16x32_bf16 v[168:171], v[232:235], v[36:39], 0
    ds_read_b128 v[228:231], v1 offset:20736
    ds_read_b128 v[176:179], v9
    v_mfma_f32_16x16x32_bf16 v[168:171], v[128:131], v[116:119], v[168:171]
    v_fmac_f32 v121, v139, v139
    v_fmac_f32 v121, v208, v208
    v_mfma_f32_16x16x32_bf16 v[188:191], v[216:219], v[36:39], 0
    ds_read_b128 v[160:163], v9 offset:64
    v_fmac_f32 v121, v209, v209
    v_mfma_f32_16x16x32_bf16 v[188:191], v[164:167], v[116:119], v[188:191]
    v_fmac_f32 v121, v210, v210
    v_fmac_f32 v121, v211, v211
    s_waitcnt lgkmcnt(6)
    v_mfma_f32_16x16x32_bf16 v[204:207], a[72:75], v[196:199], 0
    s_waitcnt lgkmcnt(5)
    v_fmac_f32 v121, v156, v156
    v_fmac_f32 v121, v157, v157
    v_mfma_f32_16x16x32_bf16 v[204:207], a[76:79], v[184:187], v[204:207]
    s_waitcnt lgkmcnt(4)
    v_fmac_f32 v121, v158, v158
    v_fmac_f32 v121, v159, v159
    v_mfma_f32_16x16x32_bf16 v[204:207], a[80:83], v[172:175], v[204:207]
    s_waitcnt lgkmcnt(3)
    v_rcp_f32 v120, v120
    v_mfma_f32_16x16x32_bf16 v[204:207], a[84:87], v[148:151], v[204:207]
    s_waitcnt lgkmcnt(2)
    v_mul_f32 v124, v120, v124
    v_mul_f32 v125, v120, v125
    v_mfma_f32_16x16x32_bf16 v[204:207], a[88:91], v[112:115], v[204:207]
    s_waitcnt lgkmcnt(1)
    v_cvt_pk_bf16_f32 v192, v124, v125
    v_mul_f32 v126, v120, v126
    v_mfma_f32_16x16x32_bf16 v[212:215], v[176:179], v[28:31], 0
    s_waitcnt lgkmcnt(0)
    v_mul_f32 v127, v120, v127
    v_cvt_pk_bf16_f32 v193, v126, v127
    v_mfma_f32_16x16x32_bf16 v[212:215], v[160:163], v[28:31], v[212:215]
    v_mul_f32 v220, v120, v220
    v_mul_f32 v221, v120, v221
    v_mfma_f32_16x16x32_bf16 v[116:119], v[176:179], v[236:239], 0
    v_cvt_pk_bf16_f32 v194, v220, v221
    v_mul_f32 v222, v120, v222
    v_mfma_f32_16x16x32_bf16 v[116:119], v[160:163], v[248:251], v[116:119]
    v_mul_f32 v223, v120, v223
    v_cvt_pk_bf16_f32 v195, v222, v223
    v_mfma_f32_16x16x32_bf16 v[124:127], v[176:179], v[128:131], 0
    ds_write_b128 v3, v[192:195] offset:6144
    v_mfma_f32_16x16x32_bf16 v[124:127], v[160:163], v[232:235], v[124:127]
    v_mul_f32 v252, v120, v252
    v_mul_f32 v253, v120, v253
    v_mfma_f32_16x16x32_bf16 v[128:131], v[176:179], v[164:167], 0
    v_cvt_pk_bf16_f32 v252, v252, v253
    v_mul_f32 v254, v120, v254
    v_mfma_f32_16x16x32_bf16 v[128:131], v[160:163], v[216:219], v[128:131]
    v_mul_f32 v255, v120, v255
    v_cvt_pk_bf16_f32 v253, v254, v255
    v_mfma_f32_16x16x32_bf16 v[204:207], a[92:95], v[228:231], v[204:207]
    ds_write_b64 v4, v[252:253] offset:10240
    v_mfma_f32_16x16x32_bf16 v[176:179], a[96:99], v[196:199], 0
    v_rcp_f32 v212, v212
    v_mfma_f32_16x16x32_bf16 v[176:179], a[100:103], v[184:187], v[176:179]
    v_mul_f32 v116, v116, v212
    v_mul_f32_dpp v116, v124, v212 quad_perm:[0,1,2,3] row_mask:0x2 bank_mask:0xf
    v_mfma_f32_16x16x32_bf16 v[176:179], a[104:107], v[172:175], v[176:179]
    v_mul_f32_dpp v116, v128, v212 quad_perm:[0,1,2,3] row_mask:0x4 bank_mask:0xf
    v_cvt_pk_bf16_f32 v116, v116, v116
    v_mfma_f32_16x16x32_bf16 v[176:179], a[108:111], v[148:151], v[176:179]
    ds_write_b16 v7, v116
    v_mfma_f32_16x16x32_bf16 v[176:179], a[112:115], v[112:115], v[176:179]
    v_rcp_f32 v140, v140
    v_mfma_f32_16x16x32_bf16 v[176:179], a[116:119], v[228:231], v[176:179]
    v_mul_f32 v144, v140, v144
    v_mul_f32 v145, v140, v145
    v_mfma_f32_16x16x32_bf16 v[124:127], a[120:123], v[196:199], 0
    v_cvt_pk_bf16_f32 v116, v144, v145
    v_mul_f32 v146, v140, v146
    v_mfma_f32_16x16x32_bf16 v[124:127], a[124:127], v[184:187], v[124:127]
    v_mul_f32 v147, v140, v147
    v_cvt_pk_bf16_f32 v117, v146, v147
    v_mfma_f32_16x16x32_bf16 v[124:127], a[128:131], v[172:175], v[124:127]
    v_mul_f32 v168, v140, v168
    v_mul_f32 v169, v140, v169
    v_mfma_f32_16x16x32_bf16 v[124:127], a[132:135], v[148:151], v[124:127]
    v_cvt_pk_bf16_f32 v118, v168, v169
    v_mul_f32 v170, v140, v170
    v_mfma_f32_16x16x32_bf16 v[124:127], a[136:139], v[112:115], v[124:127]
    v_mul_f32 v171, v140, v171
    v_cvt_pk_bf16_f32 v119, v170, v171
    v_mfma_f32_16x16x32_bf16 v[124:127], a[140:143], v[228:231], v[124:127]
    ds_write_b128 v3, v[116:119] offset:12288
    v_mfma_f32_16x16x32_bf16 v[216:219], a[0:3], v[196:199], 0
    v_mul_f32 v188, v140, v188
    v_mul_f32 v189, v140, v189
    v_mfma_f32_16x16x32_bf16 v[216:219], a[4:7], v[184:187], v[216:219]
    v_cvt_pk_bf16_f32 v188, v188, v189
    v_mul_f32 v190, v140, v190
    v_mfma_f32_16x16x32_bf16 v[216:219], a[8:11], v[172:175], v[216:219]
    v_mul_f32 v191, v140, v191
    v_cvt_pk_bf16_f32 v189, v190, v191
    v_mfma_f32_16x16x32_bf16 v[216:219], a[12:15], v[148:151], v[216:219]
    ds_write_b64 v4, v[188:189] offset:16384
    v_mfma_f32_16x16x32_bf16 v[216:219], a[16:19], v[112:115], v[216:219]
    v_fma_f32 v120, v180, v180, s33
    v_fmac_f32 v120, v181, v181
    v_mfma_f32_16x16x32_bf16 v[216:219], a[20:23], v[228:231], v[216:219]
    v_fmac_f32 v120, v182, v182
    v_fmac_f32 v120, v183, v183
    v_mfma_f32_16x16x32_bf16 v[160:163], a[24:27], v[196:199], 0
    v_fmac_f32 v120, v108, v108
    v_fmac_f32 v120, v109, v109
    v_mfma_f32_16x16x32_bf16 v[160:163], a[28:31], v[184:187], v[160:163]
    v_fmac_f32 v120, v110, v110
    v_fmac_f32 v120, v111, v111
    v_mfma_f32_16x16x32_bf16 v[160:163], a[32:35], v[172:175], v[160:163]
    v_fmac_f32 v120, v152, v152
    v_fmac_f32 v120, v153, v153
    v_mfma_f32_16x16x32_bf16 v[160:163], a[36:39], v[148:151], v[160:163]
    v_fmac_f32 v120, v154, v154
    v_fmac_f32 v120, v155, v155
    v_mfma_f32_16x16x32_bf16 v[160:163], a[40:43], v[112:115], v[160:163]
    v_cvt_pk_bf16_f32 v122, v120, v121
    v_add_u32 v5, 336, v5
    v_mfma_f32_16x16x32_bf16 v[160:163], a[44:47], v[228:231], v[160:163]
    ds_write_b64 v4, v[122:123] offset:18432
    v_mfma_f32_16x16x32_bf16 v[116:119], a[48:51], v[196:199], 0
    v_add_u32 v6, 272, v6
    v_add_u32 v7, 16, v7
    v_mfma_f32_16x16x32_bf16 v[116:119], a[52:55], v[184:187], v[116:119]
    v_xor_b32 v2, 65536, v2
    v_xor_b32 v3, 65536, v3
    v_mfma_f32_16x16x32_bf16 v[116:119], a[56:59], v[172:175], v[116:119]
    v_xor_b32 v4, 65536, v4
    v_fma_f32 v169, v204, v204, s32
    v_mfma_f32_16x16x32_bf16 v[116:119], a[60:63], v[148:151], v[116:119]
    v_fmac_f32 v169, v205, v205
    v_fmac_f32 v169, v206, v206
    v_mfma_f32_16x16x32_bf16 v[116:119], a[64:67], v[112:115], v[116:119]
    v_fmac_f32 v169, v207, v207
    v_fmac_f32 v169, v176, v176
    v_mfma_f32_16x16x32_bf16 v[116:119], a[68:71], v[228:231], v[116:119]
    v_fmac_f32 v169, v177, v177
    v_fmac_f32 v169, v178, v178
    v_mfma_f32_16x16x32_bf16 v[128:131], v[196:199], a[144:147], 0
    s_waitcnt lgkmcnt(0)
    v_fmac_f32 v169, v179, v179
    v_fmac_f32 v169, v124, v124
    v_mfma_f32_16x16x32_bf16 v[128:131], v[184:187], a[148:151], v[128:131]
    s_nop 0
    v_fmac_f32 v169, v125, v125
    v_fmac_f32 v169, v126, v126
    v_mfma_f32_16x16x32_bf16 v[128:131], v[172:175], a[152:155], v[128:131]
    s_barrier
    v_fmac_f32 v169, v127, v127
    v_fma_f32 v168, v216, v216, s32
    v_mfma_f32_16x16x32_bf16 v[128:131], v[148:151], a[156:159], v[128:131]
    s_nop 0
    v_fmac_f32 v168, v217, v217
    v_fmac_f32 v168, v218, v218
    v_mfma_f32_16x16x32_bf16 v[128:131], v[112:115], a[160:163], v[128:131]
    s_nop 0
    v_fmac_f32 v168, v219, v219
    v_mfma_f32_16x16x32_bf16 v[128:131], v[228:231], a[164:167], v[128:131]
    s_cbranch_scc1 L_loop_safe1
    s_branch L_drain
.p2align 6
L_loop_safe2:
    v_mfma_f32_16x16x32_bf16 v[188:191], v[196:199], a[168:171], 0
    s_add_u32 s12, s42, s27
    ds_read_b128 v[192:195], v2 offset:18432
    ds_read_b128 v[164:167], v2 offset:19456
    v_mfma_f32_16x16x32_bf16 v[188:191], v[184:187], a[172:175], v[188:191]
    s_addc_u32 s13, s43, 0
    ds_read_b128 v[120:123], v0 offset:26624
    ds_read_b128 v[140:143], v1 offset:26624
    v_mfma_f32_16x16x32_bf16 v[188:191], v[172:175], a[176:179], v[188:191]
    s_sub_u32 s14, s36, s27
    v_fmac_f32 v168, v160, v160
    v_fmac_f32 v168, v161, v161
    v_mfma_f32_16x16x32_bf16 v[188:191], v[148:151], a[180:183], v[188:191]
    s_cmp_ge_u32 s18, 2
    ds_read_b128 v[232:235], v0 offset:26752
    ds_read_b128 v[224:227], v1 offset:26752
    v_mfma_f32_16x16x32_bf16 v[188:191], v[112:115], a[184:187], v[188:191]
    s_cselect_b32 s14, s14, 0
    v_fmac_f32 v168, v162, v162
    v_fmac_f32 v168, v163, v163
    v_mfma_f32_16x16x32_bf16 v[188:191], v[228:231], a[188:191], v[188:191]
    s_add_u32 s34, s18, 2
    ds_read_b128 v[212:215], v0 offset:26880
    ds_read_b128 v[144:147], v1 offset:26880
    v_mfma_f32_16x16x32_bf16 v[220:223], v[196:199], a[192:195], 0
    s_add_u32 s8, s40, s23
    v_fmac_f32 v168, v116, v116
    v_fmac_f32 v168, v117, v117
    v_mfma_f32_16x16x32_bf16 v[220:223], v[184:187], a[196:199], v[220:223]
    s_addc_u32 s9, s41, 0
    v_fmac_f32 v168, v118, v118
    v_fmac_f32 v168, v119, v119
    v_mfma_f32_16x16x32_bf16 v[220:223], v[172:175], a[200:203], v[220:223]
    s_waitcnt lgkmcnt(6)
    v_cvt_pk_bf16_f32 v36, v168, v169
    v_cvt_pk_bf16_f32 v236, v128, v129
    v_mfma_f32_16x16x32_bf16 v[172:175], v[32:35], v[192:195], 0
    s_waitcnt lgkmcnt(4)
    v_cvt_pk_bf16_f32 v237, v130, v131
    v_cvt_pk_bf16_f32 v128, v188, v189
    v_mfma_f32_16x16x32_bf16 v[168:171], v[32:35], v[36:39], 0
    s_sub_u32 s10, s36, s23
    v_cvt_pk_bf16_f32 v129, v190, v191
    s_cmp_lt_u32 s34, s17
    v_mfma_f32_16x16x32_bf16 v[172:175], v[32:35], v[164:167], v[172:175]
    s_cselect_b32 s10, s10, 0
    s_add_u32 m0, s28, 0
    s_mov_b32 s27, s26
    v_mfma_f32_16x16x32_bf16 v[220:223], v[148:151], a[204:207], v[220:223]
    s_mov_b32 s26, s25
    v_rsq_f32 v169, v169
    v_mfma_f32_16x16x32_bf16 v[220:223], v[112:115], a[208:211], v[220:223]
    s_mov_b32 s25, s24
    v_rsq_f32 v168, v168
    v_mfma_f32_16x16x32_bf16 v[220:223], v[228:231], a[212:215], v[220:223]
    s_mov_b32 s24, s23
    v_mul_f32 v168, s31, v168
    v_mul_f32 v171, 0x3baaaaab, v172
    v_mfma_f32_16x16x32_bf16 v[112:115], a[72:75], v[120:123], 0
    s_waitcnt lgkmcnt(0)
    v_rsq_f32 v171, v171
    v_mfma_f32_16x16x32_bf16 v[112:115], a[76:79], v[140:143], v[112:115]
    v_mul_f32 v172, 0x3baaaaab, v173
    v_cvt_pk_bf16_f32 v164, v220, v221
    v_mfma_f32_16x16x32_bf16 v[112:115], a[80:83], v[232:235], v[112:115]
    v_cvt_pk_bf16_f32 v165, v222, v223
    v_mul_f32 v170, 0x3baaaaab, v174
    v_mfma_f32_16x16x32_bf16 v[112:115], a[84:87], v[224:227], v[112:115]
    v_rsq_f32 v172, v172
    v_mfma_f32_16x16x32_bf16 v[112:115], a[88:91], v[212:215], v[112:115]
    v_rsq_f32 v170, v170
    v_mfma_f32_16x16x32_bf16 v[112:115], a[92:95], v[144:147], v[112:115]
    v_mul_f32 v180, v171, v180
    v_mul_f32 v181, v171, v181
    v_mfma_f32_16x16x32_bf16 v[148:151], a[96:99], v[120:123], 0
    v_cvt_pk_bf16_f32 v180, v180, v181
    v_mul_f32 v182, v171, v182
    v_mfma_f32_16x16x32_bf16 v[148:151], a[100:103], v[140:143], v[148:151]
    v_mul_f32 v183, v171, v183
    v_cvt_pk_bf16_f32 v181, v182, v183
    v_mfma_f32_16x16x32_bf16 v[148:151], a[104:107], v[232:235], v[148:151]
    v_mul_f32 v108, v171, v108
    v_mul_f32 v109, v171, v109
    v_mfma_f32_16x16x32_bf16 v[148:151], a[108:111], v[224:227], v[148:151]
    v_cvt_pk_bf16_f32 v182, v108, v109
    v_mul_f32 v110, v171, v110
    v_mfma_f32_16x16x32_bf16 v[148:151], a[112:115], v[212:215], v[148:151]
    v_mul_f32 v111, v171, v111
    v_cvt_pk_bf16_f32 v183, v110, v111
    v_mfma_f32_16x16x32_bf16 v[148:151], a[116:119], v[144:147], v[148:151]
    buffer_store_dwordx4 v[180:183], v15, s[12:15], 0 offen
    v_mul_f32 v152, v171, v152
    v_mul_f32 v153, v171, v153
    v_cvt_pk_bf16_f32 v130, v152, v153
    v_mul_f32 v154, v171, v154
    v_mfma_f32_16x16x32_bf16 v[180:183], a[120:123], v[120:123], 0
    v_mul_f32 v155, v171, v155
    v_cvt_pk_bf16_f32 v131, v154, v155
    v_mfma_f32_16x16x32_bf16 v[180:183], a[124:127], v[140:143], v[180:183]
    v_mul_f32 v204, v169, v204
    v_mul_f32 v205, v169, v205
    v_mfma_f32_16x16x32_bf16 v[180:183], a[128:131], v[232:235], v[180:183]
    v_cvt_pk_bf16_f32 v184, v204, v205
    v_mul_f32 v206, v169, v206
    v_mfma_f32_16x16x32_bf16 v[180:183], a[132:135], v[224:227], v[180:183]
    v_mul_f32 v207, v169, v207
    v_cvt_pk_bf16_f32 v185, v206, v207
    v_mfma_f32_16x16x32_bf16 v[180:183], a[136:139], v[212:215], v[180:183]
    v_mul_f32 v176, v169, v176
    v_mul_f32 v177, v169, v177
    v_mfma_f32_16x16x32_bf16 v[180:183], a[140:143], v[144:147], v[180:183]
    v_cvt_pk_bf16_f32 v186, v176, v177
    v_mul_f32 v178, v169, v178
    v_mfma_f32_16x16x32_bf16 v[108:111], a[0:3], v[120:123], 0
    v_mul_f32 v179, v169, v179
    v_cvt_pk_bf16_f32 v187, v178, v179
    v_mfma_f32_16x16x32_bf16 v[108:111], a[4:7], v[140:143], v[108:111]
    v_mul_f32 v124, v169, v124
    v_mul_f32 v125, v169, v125
    v_mfma_f32_16x16x32_bf16 v[108:111], a[8:11], v[232:235], v[108:111]
    v_cvt_pk_bf16_f32 v178, v124, v125
    v_mul_f32 v126, v169, v126
    v_mfma_f32_16x16x32_bf16 v[108:111], a[12:15], v[224:227], v[108:111]
    v_mul_f32 v127, v169, v127
    v_cvt_pk_bf16_f32 v179, v126, v127
    v_mfma_f32_16x16x32_bf16 v[108:111], a[16:19], v[212:215], v[108:111]
    v_mul_f32 v216, v168, v216
    v_mul_f32 v217, v168, v217
    v_mfma_f32_16x16x32_bf16 v[108:111], a[20:23], v[144:147], v[108:111]
    v_cvt_pk_bf16_f32 v124, v216, v217
    v_mul_f32 v218, v168, v218
    v_mfma_f32_16x16x32_bf16 v[152:155], a[24:27], v[120:123], 0
    v_mul_f32 v219, v168, v219
    v_cvt_pk_bf16_f32 v125, v218, v219
    v_mfma_f32_16x16x32_bf16 v[152:155], a[28:31], v[140:143], v[152:155]
    v_mul_f32 v160, v168, v160
    v_mul_f32 v161, v168, v161
    v_mfma_f32_16x16x32_bf16 v[152:155], a[32:35], v[232:235], v[152:155]
    v_cvt_pk_bf16_f32 v126, v160, v161
    v_mul_f32 v162, v168, v162
    v_mfma_f32_16x16x32_bf16 v[152:155], a[36:39], v[224:227], v[152:155]
    v_mul_f32 v163, v168, v163
    v_cvt_pk_bf16_f32 v127, v162, v163
    v_mfma_f32_16x16x32_bf16 v[152:155], a[40:43], v[212:215], v[152:155]
    buffer_store_dwordx2 v[130:131], v18, s[12:15], 0 offen
    v_mul_f32 v116, v168, v116
    v_mul_f32 v117, v168, v117
    v_mfma_f32_16x16x32_bf16 v[152:155], a[44:47], v[144:147], v[152:155]
    v_cvt_pk_bf16_f32 v176, v116, v117
    v_mul_f32 v118, v168, v118
    v_mfma_f32_16x16x32_bf16 v[160:163], a[48:51], v[120:123], 0
    v_mul_f32 v119, v168, v119
    v_cvt_pk_bf16_f32 v177, v118, v119
    v_mfma_f32_16x16x32_bf16 v[160:163], a[52:55], v[140:143], v[160:163]
    v_fma_f32 v130, v108, v108, s32
    v_fmac_f32 v130, v109, v109
    v_mfma_f32_16x16x32_bf16 v[160:163], a[56:59], v[232:235], v[160:163]
    v_fmac_f32 v130, v110, v110
    v_fmac_f32 v130, v111, v111
    v_mfma_f32_16x16x32_bf16 v[160:163], a[60:63], v[224:227], v[160:163]
    v_fmac_f32 v130, v152, v152
    v_fmac_f32 v130, v153, v153
    v_mfma_f32_16x16x32_bf16 v[160:163], a[64:67], v[212:215], v[160:163]
    v_fmac_f32 v130, v154, v154
    v_fmac_f32 v130, v155, v155
    v_mfma_f32_16x16x32_bf16 v[160:163], a[68:71], v[144:147], v[160:163]
    v_fma_f32 v131, v112, v112, s32
    v_fmac_f32 v131, v113, v113
    v_mfma_f32_16x16x32_bf16 v[188:191], v[120:123], a[144:147], 0
    v_fmac_f32 v131, v114, v114
    v_fmac_f32 v131, v115, v115
    v_mfma_f32_16x16x32_bf16 v[188:191], v[140:143], a[148:151], v[188:191]
    v_fmac_f32 v131, v148, v148
    v_fmac_f32 v131, v149, v149
    v_mfma_f32_16x16x32_bf16 v[188:191], v[232:235], a[152:155], v[188:191]
    v_fmac_f32 v130, v160, v160
    v_fmac_f32 v130, v161, v161
    v_mfma_f32_16x16x32_bf16 v[188:191], v[224:227], a[156:159], v[188:191]
    v_fmac_f32 v130, v162, v162
    v_fmac_f32 v130, v163, v163
    v_mfma_f32_16x16x32_bf16 v[188:191], v[212:215], a[160:163], v[188:191]
    v_fmac_f32 v131, v150, v150
    v_fmac_f32 v131, v151, v151
    v_mfma_f32_16x16x32_bf16 v[188:191], v[144:147], a[164:167], v[188:191]
    v_fmac_f32 v131, v180, v180
    v_fmac_f32 v131, v181, v181
    v_mfma_f32_16x16x32_bf16 v[196:199], v[120:123], a[168:171], 0
    ds_read_b128 v[116:119], v0 offset:32768
    v_fmac_f32 v131, v182, v182
    v_mfma_f32_16x16x32_bf16 v[196:199], v[140:143], a[172:175], v[196:199]
    ds_read_b128 v[204:207], v1 offset:32768
    v_fmac_f32 v131, v183, v183
    v_mfma_f32_16x16x32_bf16 v[196:199], v[232:235], a[176:179], v[196:199]
    ds_read_b128 v[192:195], v0 offset:32896
    v_cvt_pk_bf16_f32 v238, v188, v189
    v_mfma_f32_16x16x32_bf16 v[196:199], v[224:227], a[180:183], v[196:199]
    ds_read_b128 v[220:223], v1 offset:32896
    v_cvt_pk_bf16_f32 v239, v190, v191
    v_mfma_f32_16x16x32_bf16 v[196:199], v[212:215], a[184:187], v[196:199]
    ds_read_b128 v[188:191], v0 offset:33024
    v_cvt_pk_bf16_f32 v36, v130, v131
    v_mfma_f32_16x16x32_bf16 v[196:199], v[144:147], a[188:191], v[196:199]
    ds_read_b128 v[240:243], v1 offset:33024
    v_mul_f32 v200, v170, v200
    v_mfma_f32_16x16x32_bf16 v[216:219], v[32:35], v[36:39], 0
    v_mul_f32 v201, v170, v201
    v_cvt_pk_bf16_f32 v200, v200, v201
    v_mfma_f32_16x16x32_bf16 v[228:231], v[120:123], a[192:195], 0
    v_mul_f32 v202, v170, v202
    v_mul_f32 v203, v170, v203
    v_mfma_f32_16x16x32_bf16 v[228:231], v[140:143], a[196:199], v[228:231]
    s_waitcnt lgkmcnt(5)
    v_cvt_pk_bf16_f32 v130, v196, v197
    v_cvt_pk_bf16_f32 v131, v198, v199
    v_mfma_f32_16x16x32_bf16 v[228:231], v[232:235], a[200:203], v[228:231]
    s_waitcnt lgkmcnt(4)
    v_rsq_f32 v217, v217
    v_mfma_f32_16x16x32_bf16 v[228:231], v[224:227], a[204:207], v[228:231]
    s_waitcnt lgkmcnt(3)
    v_rsq_f32 v216, v216
    v_mfma_f32_16x16x32_bf16 v[228:231], v[212:215], a[208:211], v[228:231]
    s_waitcnt lgkmcnt(2)
    v_mul_f32 v216, s31, v216
    v_mul_f32 v112, v217, v112
    v_mfma_f32_16x16x32_bf16 v[228:231], v[144:147], a[212:215], v[228:231]
    s_waitcnt lgkmcnt(1)
    v_mul_f32 v113, v217, v113
    v_cvt_pk_bf16_f32 v112, v112, v113
    v_mfma_f32_16x16x32_bf16 v[120:123], a[72:75], v[116:119], 0
    s_waitcnt lgkmcnt(0)
    v_mul_f32 v114, v217, v114
    v_mul_f32 v115, v217, v115
    v_mfma_f32_16x16x32_bf16 v[120:123], a[76:79], v[204:207], v[120:123]
    v_cvt_pk_bf16_f32 v166, v228, v229
    v_cvt_pk_bf16_f32 v167, v230, v231
    v_mfma_f32_16x16x32_bf16 v[120:123], a[80:83], v[192:195], v[120:123]
    v_cvt_pk_bf16_f32 v113, v114, v115
    v_mul_f32 v148, v217, v148
    v_mfma_f32_16x16x32_bf16 v[120:123], a[84:87], v[220:223], v[120:123]
    v_mul_f32 v149, v217, v149
    v_cvt_pk_bf16_f32 v114, v148, v149
    v_mfma_f32_16x16x32_bf16 v[120:123], a[88:91], v[188:191], v[120:123]
    v_mul_f32 v150, v217, v150
    v_mul_f32 v151, v217, v151
    v_mfma_f32_16x16x32_bf16 v[120:123], a[92:95], v[240:243], v[120:123]
    v_cvt_pk_bf16_f32 v115, v150, v151
    v_mul_f32 v180, v217, v180
    v_mfma_f32_16x16x32_bf16 v[140:143], a[96:99], v[116:119], 0
    v_mul_f32 v181, v217, v181
    v_cvt_pk_bf16_f32 v146, v180, v181
    v_mfma_f32_16x16x32_bf16 v[140:143], a[100:103], v[204:207], v[140:143]
    v_mul_f32 v182, v217, v182
    v_mul_f32 v183, v217, v183
    v_mfma_f32_16x16x32_bf16 v[140:143], a[104:107], v[192:195], v[140:143]
    v_cvt_pk_bf16_f32 v147, v182, v183
    v_mul_f32 v108, v216, v108
    v_mfma_f32_16x16x32_bf16 v[140:143], a[108:111], v[220:223], v[140:143]
    v_mul_f32 v109, v216, v109
    v_cvt_pk_bf16_f32 v148, v108, v109
    v_mfma_f32_16x16x32_bf16 v[140:143], a[112:115], v[188:191], v[140:143]
    v_mul_f32 v110, v216, v110
    v_mul_f32 v111, v216, v111
    v_mfma_f32_16x16x32_bf16 v[140:143], a[116:119], v[240:243], v[140:143]
    v_cvt_pk_bf16_f32 v149, v110, v111
    v_mul_f32 v152, v216, v152
    v_mfma_f32_16x16x32_bf16 v[108:111], a[120:123], v[116:119], 0
    v_mul_f32 v153, v216, v153
    v_cvt_pk_bf16_f32 v150, v152, v153
    v_mfma_f32_16x16x32_bf16 v[108:111], a[124:127], v[204:207], v[108:111]
    v_mul_f32 v154, v216, v154
    v_mul_f32 v155, v216, v155
    v_mfma_f32_16x16x32_bf16 v[108:111], a[128:131], v[192:195], v[108:111]
    v_cvt_pk_bf16_f32 v151, v154, v155
    v_mul_f32 v160, v216, v160
    v_mfma_f32_16x16x32_bf16 v[108:111], a[132:135], v[220:223], v[108:111]
    v_mul_f32 v161, v216, v161
    v_cvt_pk_bf16_f32 v144, v160, v161
    v_mfma_f32_16x16x32_bf16 v[108:111], a[136:139], v[188:191], v[108:111]
    v_mul_f32 v162, v216, v162
    v_mul_f32 v163, v216, v163
    v_mfma_f32_16x16x32_bf16 v[108:111], a[140:143], v[240:243], v[108:111]
    s_waitcnt vmcnt(2)
    v_cvt_pk_bf16_f32 v145, v162, v163
    v_fma_f32 v168, v120, v120, s32
    v_mfma_f32_16x16x32_bf16 v[152:155], a[0:3], v[116:119], 0
    s_nop 0
    v_fmac_f32 v168, v121, v121
    v_fmac_f32 v168, v122, v122
    v_mfma_f32_16x16x32_bf16 v[152:155], a[4:7], v[204:207], v[152:155]
    s_nop 0
    v_fmac_f32 v168, v123, v123
    v_fmac_f32 v168, v140, v140
    v_mfma_f32_16x16x32_bf16 v[152:155], a[8:11], v[192:195], v[152:155]
    s_barrier
    v_fmac_f32 v168, v141, v141
    v_fmac_f32 v168, v142, v142
    v_mfma_f32_16x16x32_bf16 v[152:155], a[12:15], v[220:223], v[152:155]
    s_nop 0
    buffer_load_dwordx4 v10, s[8:11], 0 offen nt lds
    v_fmac_f32 v168, v143, v143
    v_mfma_f32_16x16x32_bf16 v[152:155], a[16:19], v[188:191], v[152:155]
    s_add_u32 m0, s28, 4096
    v_fmac_f32 v168, v108, v108
    v_fmac_f32 v168, v109, v109
    v_mfma_f32_16x16x32_bf16 v[152:155], a[20:23], v[240:243], v[152:155]
    v_fmac_f32 v168, v110, v110
    v_fmac_f32 v168, v111, v111
    v_mfma_f32_16x16x32_bf16 v[160:163], a[24:27], v[116:119], 0
    v_cvt_pk_bf16_f32 v201, v202, v203
    v_mul_f32 v244, v170, v244
    v_mfma_f32_16x16x32_bf16 v[160:163], a[28:31], v[204:207], v[160:163]
    v_mul_f32 v245, v170, v245
    v_cvt_pk_bf16_f32 v202, v244, v245
    v_mfma_f32_16x16x32_bf16 v[160:163], a[32:35], v[192:195], v[160:163]
    buffer_load_dwordx4 v11, s[8:11], 0 offen nt lds
    v_fma_f32 v169, v152, v152, s32
    v_mfma_f32_16x16x32_bf16 v[160:163], a[36:39], v[220:223], v[160:163]
    s_add_u32 m0, s28, 8192
    v_fmac_f32 v169, v153, v153
    v_fmac_f32 v169, v154, v154
    v_mfma_f32_16x16x32_bf16 v[160:163], a[40:43], v[188:191], v[160:163]
    v_fmac_f32 v169, v155, v155
    v_mul_f32 v246, v170, v246
    v_mfma_f32_16x16x32_bf16 v[160:163], a[44:47], v[240:243], v[160:163]
    v_mul_f32 v247, v170, v247
    v_cvt_pk_bf16_f32 v203, v246, v247
    v_mfma_f32_16x16x32_bf16 v[196:199], a[48:51], v[116:119], 0
    v_mul_f32 v132, v170, v132
    v_mul_f32 v133, v170, v133
    v_mfma_f32_16x16x32_bf16 v[196:199], a[52:55], v[204:207], v[196:199]
    buffer_load_dwordx4 v12, s[8:11], 0 offen nt lds
    v_cvt_pk_bf16_f32 v216, v132, v133
    v_mfma_f32_16x16x32_bf16 v[196:199], a[56:59], v[192:195], v[196:199]
    s_add_u32 m0, s28, 12288
    ds_read2_b32 v[250:251], v6 offset0:0 offset1:0
    ds_read2_b32 v[234:235], v6 offset0:16 offset1:16
    v_mfma_f32_16x16x32_bf16 v[196:199], a[60:63], v[220:223], v[196:199]
    s_xor_b32 s28, s28, 65536
    ds_read_b128 v[224:227], v5 offset:0
    ds_read_b128 v[180:183], v5 offset:16
    v_mfma_f32_16x16x32_bf16 v[196:199], a[64:67], v[188:191], v[196:199]
    v_fmac_f32 v169, v160, v160
    v_fmac_f32 v169, v161, v161
    v_mfma_f32_16x16x32_bf16 v[196:199], a[68:71], v[240:243], v[196:199]
    ds_read_b128 v[212:215], v5 offset:48
    ds_read_b32 v173, v6 offset:192
    v_mfma_f32_16x16x32_bf16 v[228:231], v[116:119], a[144:147], 0
    buffer_load_dwordx4 v13, s[8:11], 0 offen nt lds
    ds_read2_b32 v[218:219], v6 offset0:32 offset1:32
    v_mfma_f32_16x16x32_bf16 v[228:231], v[204:207], a[148:151], v[228:231]
    s_mov_b32 m0, s29
    v_fmac_f32 v169, v162, v162
    v_fmac_f32 v169, v163, v163
    v_mfma_f32_16x16x32_bf16 v[228:231], v[192:195], a[152:155], v[228:231]
    s_xor_b32 s29, s29, s30
    v_fmac_f32 v169, v196, v196
    v_fmac_f32 v169, v197, v197
    v_mfma_f32_16x16x32_bf16 v[228:231], v[220:223], a[156:159], v[228:231]
    s_add_u32 s19, s19, s20
    v_fmac_f32 v169, v198, v198
    v_fmac_f32 v169, v199, v199
    v_mfma_f32_16x16x32_bf16 v[228:231], v[188:191], a[160:163], v[228:231]
    s_add_u32 s23, s23, s21
    v_cvt_pk_bf16_f32 v36, v169, v168
    v_mul_f32 v134, v170, v134
    v_mfma_f32_16x16x32_bf16 v[228:231], v[240:243], a[164:167], v[228:231]
    s_waitcnt lgkmcnt(3)
    buffer_store_dwordx4 v[200:203], v17, s[12:15], 0 offen
    v_mul_f32 v135, v170, v135
    v_cvt_pk_bf16_f32 v217, v134, v135
    v_mul_f32 v136, v172, v136
    v_mul_f32 v137, v172, v137
    v_mfma_f32_16x16x32_bf16 v[168:171], v[32:35], v[36:39], 0
    s_cmp_ge_u32 s19, 72
    v_cvt_pk_bf16_f32 v248, v228, v229
    v_cvt_pk_bf16_f32 v249, v230, v231
    v_mfma_f32_16x16x32_bf16 v[132:135], v[224:227], v[124:127], v[22:25]
    s_cselect_b32 s34, 72, 0
    v_cvt_pk_bf16_f32 v200, v136, v137
    v_mul_f32 v138, v172, v138
    v_mfma_f32_16x16x32_bf16 v[132:135], v[180:183], v[184:187], v[132:135]
    s_waitcnt lgkmcnt(0)
    v_rsq_f32 v169, v169
    v_mfma_f32_16x16x32_bf16 v[132:135], v[212:215], v[176:179], v[132:135]
    s_cselect_b32 s35, s22, 0
    v_rsq_f32 v168, v168
    v_mfma_f32_16x16x32_bf16 v[228:231], v[116:119], a[168:171], 0
    s_sub_u32 s19, s19, s34
    v_mul_f32 v168, s31, v168
    v_mul_f32 v120, v169, v120
    v_mfma_f32_16x16x32_bf16 v[228:231], v[204:207], a[172:175], v[228:231]
    s_add_u32 s23, s23, s35
    v_mov_b32_dpp v173, v133 quad_perm:[0,1,2,3] row_mask:0x1 bank_mask:0xf
    v_mul_f32 v121, v169, v121
    v_mfma_f32_16x16x32_bf16 v[228:231], v[192:195], a[176:179], v[228:231]
    s_add_u32 s18, s18, 1
    v_cvt_pk_bf16_f32 v120, v120, v121
    v_mul_f32 v122, v169, v122
    v_mfma_f32_16x16x32_bf16 v[228:231], v[220:223], a[180:183], v[228:231]
    s_cmp_lt_u32 s18, s17
    v_mul_f32 v123, v169, v123
    v_cvt_pk_bf16_f32 v121, v122, v123
    v_mfma_f32_16x16x32_bf16 v[228:231], v[188:191], a[184:187], v[228:231]
    v_mul_f32 v140, v169, v140
    v_mul_f32 v141, v169, v141
    v_mfma_f32_16x16x32_bf16 v[228:231], v[240:243], a[188:191], v[228:231]
    v_cvt_pk_bf16_f32 v122, v140, v141
    v_mul_f32 v142, v169, v142
    v_mfma_f32_16x16x32_bf16 v[244:247], v[116:119], a[192:195], 0
    v_mul_f32 v143, v169, v143
    v_cvt_pk_bf16_f32 v123, v142, v143
    v_mfma_f32_16x16x32_bf16 v[244:247], v[204:207], a[196:199], v[244:247]
    v_mul_f32 v108, v169, v108
    v_mul_f32 v109, v169, v109
    v_mfma_f32_16x16x32_bf16 v[244:247], v[192:195], a[200:203], v[244:247]
    ds_read_b128 v[116:119], v2 offset:0
    v_cvt_pk_bf16_f32 v232, v228, v229
    v_mfma_f32_16x16x32_bf16 v[244:247], v[220:223], a[204:207], v[244:247]
    ds_read_b128 v[204:207], v2 offset:1024
    v_cvt_pk_bf16_f32 v233, v230, v231
    v_mfma_f32_16x16x32_bf16 v[244:247], v[188:191], a[208:211], v[244:247]
    ds_read_b128 v[140:143], v2 offset:2048
    v_cvt_pk_bf16_f32 v190, v108, v109
    v_mfma_f32_16x16x32_bf16 v[244:247], v[240:243], a[212:215], v[244:247]
    ds_read_b128 v[252:255], v2 offset:3072
    ds_read_b128 v[192:195], v2 offset:4096
    v_mfma_f32_16x16x32_bf16 v[220:223], v[184:187], v[124:127], v[40:43]
    ds_read_b128 v[134:137], v2 offset:5120
    buffer_store_dwordx2 v[216:217], v20, s[12:15], 0 offen
    v_mul_f32 v110, v169, v110
    v_mul_f32 v111, v169, v111
    v_mfma_f32_16x16x32_bf16 v[240:243], v[112:115], v[124:127], v[44:47]
    v_cvt_pk_bf16_f32 v216, v244, v245
    v_cvt_pk_bf16_f32 v217, v246, v247
    v_mfma_f32_16x16x32_bf16 v[228:231], v[120:123], v[124:127], v[48:51]
    v_cvt_pk_bf16_f32 v191, v110, v111
    v_mul_f32 v152, v168, v152
    v_mul_f32 v153, v168, v153
    v_mfma_f32_16x16x16_bf16 v[220:223], v[178:179], v[176:177], v[220:223]
    v_cvt_pk_bf16_f32 v244, v152, v153
    v_mul_f32 v154, v168, v154
    v_mul_f32 v155, v168, v155
    v_mfma_f32_16x16x16_bf16 v[240:243], v[146:147], v[176:177], v[240:243]
    v_cvt_pk_bf16_f32 v245, v154, v155
    v_mul_f32 v160, v168, v160
    v_mul_f32 v161, v168, v161
    v_mfma_f32_16x16x16_bf16 v[228:231], v[190:191], v[176:177], v[228:231]
    v_cvt_pk_bf16_f32 v246, v160, v161
    v_mul_f32 v162, v168, v162
    v_mul_f32 v163, v168, v163
    v_cvt_pk_bf16_f32 v247, v162, v163
    v_mfma_f32_16x16x32_bf16 v[124:127], v[224:227], v[148:151], v[24:27]
    s_waitcnt lgkmcnt(1)
    v_mul_f32 v196, v168, v196
    v_mul_f32 v197, v168, v197
    v_mfma_f32_16x16x32_bf16 v[124:127], v[180:183], v[112:115], v[124:127]
    s_waitcnt lgkmcnt(0)
    v_cvt_pk_bf16_f32 v188, v196, v197
    v_mul_f32 v198, v168, v198
    v_mfma_f32_16x16x32_bf16 v[124:127], v[212:215], v[144:147], v[124:127]
    v_mul_f32 v199, v168, v199
    v_cvt_pk_bf16_f32 v189, v198, v199
    v_mfma_f32_16x16x32_bf16 v[160:163], v[224:227], v[244:247], v[26:29]
    v_max3_f32 v133, v132, v220, v221
    v_max3_f32 v133, v133, v222, v223
    v_mfma_f32_16x16x32_bf16 v[160:163], v[180:183], v[120:123], v[160:163]
    v_max3_f32 v133, v133, v240, v241
    v_max3_f32 v133, v133, v242, v243
    v_mfma_f32_16x16x32_bf16 v[160:163], v[212:215], v[188:191], v[160:163]
    v_max3_f32 v133, v133, v228, v229
    v_max3_f32 v133, v133, v230, v231
    v_mfma_f32_16x16x32_bf16 v[180:183], a[216:219], v[116:119], 0
    v_mov_b32 v174, v133
    v_mov_b32_dpp v173, v125 quad_perm:[0,1,2,3] row_mask:0x2 bank_mask:0xf
    v_mfma_f32_16x16x32_bf16 v[180:183], a[220:223], v[204:207], v[180:183]
    v_permlane32_swap_b32 v133, v174
    v_mfma_f32_16x16x32_bf16 v[180:183], a[224:227], v[140:143], v[180:183]
    v_max_f32 v133, v133, v174
    v_mov_b32 v174, v133
    v_mfma_f32_16x16x32_bf16 v[180:183], a[228:231], v[252:255], v[180:183]
    v_mov_b32_dpp v173, v161 quad_perm:[0,1,2,3] row_mask:0x4 bank_mask:0xf
    v_mul_f32 v139, v172, v139
    v_mfma_f32_16x16x32_bf16 v[180:183], a[232:235], v[192:195], v[180:183]
    v_permlane16_swap_b32 v133, v174
    v_mfma_f32_16x16x32_bf16 v[180:183], a[236:239], v[134:137], v[180:183]
    v_max_f32 v133, v133, v174
    v_sub_f32 v220, v220, v133
    v_mfma_f32_16x16x32_bf16 v[108:111], a[240:243], v[116:119], 0
    v_exp_f32 v220, v220
    v_mfma_f32_16x16x32_bf16 v[108:111], a[244:247], v[204:207], v[108:111]
    v_sub_f32 v221, v221, v133
    v_sub_f32 v222, v222, v133
    v_mfma_f32_16x16x32_bf16 v[108:111], a[248:251], v[140:143], v[108:111]
    v_exp_f32 v221, v221
    v_mfma_f32_16x16x32_bf16 v[108:111], a[252:255], v[252:255], v[108:111]
    ds_read_b128 v[168:171], v2 offset:6144
    v_cvt_pk_bf16_f32 v212, v220, v221
    v_mfma_f32_16x16x32_bf16 v[108:111], v[76:79], v[192:195], v[108:111]
    ds_read_b128 v[196:199], v2 offset:7168
    v_sub_f32 v223, v223, v133
    v_mfma_f32_16x16x32_bf16 v[108:111], v[80:83], v[134:137], v[108:111]
    ds_read_b128 v[224:227], v2 offset:8192
    v_sub_f32 v240, v240, v133
    v_mfma_f32_16x16x32_bf16 v[152:155], v[84:87], v[116:119], 0
    ds_read_b128 v[174:177], v2 offset:9216
    v_sub_f32 v241, v241, v133
    v_mfma_f32_16x16x32_bf16 v[152:155], v[88:91], v[204:207], v[152:155]
    ds_read_b128 v[116:119], v2 offset:10240
    v_sub_f32 v242, v242, v133
    v_mfma_f32_16x16x32_bf16 v[152:155], v[92:95], v[140:143], v[152:155]
    ds_read_b128 v[204:207], v2 offset:11264
    v_sub_f32 v243, v243, v133
    v_mfma_f32_16x16x32_bf16 v[152:155], v[96:99], v[252:255], v[152:155]
    v_exp_f32 v222, v222
    v_mfma_f32_16x16x32_bf16 v[152:155], v[100:103], v[192:195], v[152:155]
    v_exp_f32 v223, v223
    v_mfma_f32_16x16x32_bf16 v[152:155], v[104:107], v[134:137], v[152:155]
    s_waitcnt lgkmcnt(5)
    v_cvt_pk_bf16_f32 v213, v222, v223
    v_exp_f32 v240, v240
    v_exp_f32 v241, v241
    v_mfma_f32_16x16x32_bf16 v[140:143], v[184:187], v[148:151], v[52:55]
    s_waitcnt lgkmcnt(3)
    v_cvt_pk_bf16_f32 v214, v240, v241
    v_exp_f32 v242, v242
    v_exp_f32 v243, v243
    v_sub_f32 v228, v228, v133
    v_cvt_pk_bf16_f32 v215, v242, v243
    v_mfma_f32_16x16x16_bf16 v[140:143], v[178:179], v[144:145], v[140:143]
    v_exp_f32 v228, v228
    v_sub_f32 v229, v229, v133
    v_exp_f32 v229, v229
    v_mfma_f32_16x16x32_bf16 v[192:195], v[112:115], v[148:151], v[56:59]
    s_waitcnt lgkmcnt(0)
    v_cvt_pk_bf16_f32 v36, v228, v229
    v_sub_f32 v230, v230, v133
    v_exp_f32 v230, v230
    v_sub_f32 v231, v231, v133
    v_exp_f32 v231, v231
    v_mfma_f32_16x16x32_bf16 v[220:223], v[120:123], v[148:151], v[60:63]
    v_cvt_pk_bf16_f32 v37, v230, v231
    v_sub_f32 v132, v132, v133
    v_max3_f32 v203, v124, v140, v141
    v_mfma_f32_16x16x16_bf16 v[192:195], v[146:147], v[144:145], v[192:195]
    v_exp_f32 v132, v132
    v_max3_f32 v203, v203, v142, v143
    v_mfma_f32_16x16x16_bf16 v[220:223], v[190:191], v[144:145], v[220:223]
    v_cvt_pk_bf16_f32 v39, v132, 0
    v_cvt_pk_bf16_f32 v201, v138, v139
    v_mul_f32 v208, v172, v208
    v_mul_f32 v209, v172, v209
    v_mfma_f32_16x16x32_bf16 v[132:135], v[28:31], v[36:39], 0
    v_max3_f32 v203, v203, v192, v193
    v_max3_f32 v203, v203, v194, v195
    v_mfma_f32_16x16x32_bf16 v[132:135], v[28:31], v[212:215], v[132:135]
    v_max3_f32 v203, v203, v220, v221
    v_max3_f32 v203, v203, v222, v223
    v_mfma_f32_16x16x32_bf16 v[148:151], v[248:251], v[36:39], 0
    v_mov_b32 v144, v203
    v_cvt_pk_bf16_f32 v202, v208, v209
    v_mfma_f32_16x16x32_bf16 v[148:151], v[236:239], v[212:215], v[148:151]
    v_permlane32_swap_b32 v203, v144
    v_mfma_f32_16x16x32_bf16 v[228:231], v[232:235], v[36:39], 0
    v_max_f32 v203, v203, v144
    v_mov_b32 v144, v203
    v_mfma_f32_16x16x32_bf16 v[228:231], v[128:131], v[212:215], v[228:231]
    v_rcp_f32 v132, v132
    v_mfma_f32_16x16x32_bf16 v[240:243], v[216:219], v[36:39], 0
    v_permlane16_swap_b32 v203, v144
    v_mfma_f32_16x16x32_bf16 v[240:243], v[164:167], v[212:215], v[240:243]
    v_max_f32 v203, v203, v144
    v_sub_f32 v140, v140, v203
    v_mfma_f32_16x16x32_bf16 v[136:139], a[216:219], v[168:171], 0
    v_exp_f32 v140, v140
    v_mfma_f32_16x16x32_bf16 v[136:139], a[220:223], v[196:199], v[136:139]
    v_sub_f32 v141, v141, v203
    v_sub_f32 v142, v142, v203
    v_mfma_f32_16x16x32_bf16 v[136:139], a[224:227], v[224:227], v[136:139]
    v_exp_f32 v141, v141
    v_mfma_f32_16x16x32_bf16 v[136:139], a[228:231], v[174:177], v[136:139]
    v_cvt_pk_bf16_f32 v140, v140, v141
    v_sub_f32 v143, v143, v203
    v_mfma_f32_16x16x32_bf16 v[136:139], a[232:235], v[116:119], v[136:139]
    v_exp_f32 v142, v142
    v_mfma_f32_16x16x32_bf16 v[136:139], a[236:239], v[204:207], v[136:139]
    v_exp_f32 v143, v143
    v_sub_f32 v192, v192, v203
    v_cvt_pk_bf16_f32 v141, v142, v143
    v_exp_f32 v192, v192
    v_sub_f32 v193, v193, v203
    v_exp_f32 v193, v193
    v_sub_f32 v194, v194, v203
    v_cvt_pk_bf16_f32 v142, v192, v193
    v_exp_f32 v194, v194
    v_sub_f32 v195, v195, v203
    v_exp_f32 v195, v195
    v_sub_f32 v220, v220, v203
    v_cvt_pk_bf16_f32 v143, v194, v195
    v_exp_f32 v220, v220
    v_sub_f32 v221, v221, v203
    v_exp_f32 v221, v221
    v_sub_f32 v222, v222, v203
    v_cvt_pk_bf16_f32 v36, v220, v221
    v_exp_f32 v222, v222
    v_sub_f32 v223, v223, v203
    v_exp_f32 v223, v223
    v_mfma_f32_16x16x32_bf16 v[192:195], v[184:187], v[244:247], v[64:67]
    v_cvt_pk_bf16_f32 v37, v222, v223
    v_sub_f32 v124, v124, v203
    v_mfma_f32_16x16x32_bf16 v[184:187], v[112:115], v[244:247], v[68:71]
    v_exp_f32 v124, v124
    v_mfma_f32_16x16x32_bf16 v[212:215], v[120:123], v[244:247], v[72:75]
    v_cvt_pk_bf16_f32 v39, v124, 0
    v_mul_f32 v148, v132, v148
    v_mul_f32 v149, v132, v149
    v_mfma_f32_16x16x32_bf16 v[120:123], v[28:31], v[36:39], 0
    v_cvt_pk_bf16_f32 v112, v148, v149
    v_mul_f32 v150, v132, v150
    v_mfma_f32_16x16x32_bf16 v[120:123], v[28:31], v[140:143], v[120:123]
    v_mul_f32 v151, v132, v151
    v_cvt_pk_bf16_f32 v113, v150, v151
    v_mfma_f32_16x16x32_bf16 v[124:127], v[248:251], v[36:39], 0
    v_mul_f32 v228, v132, v228
    v_mul_f32 v229, v132, v229
    v_mfma_f32_16x16x32_bf16 v[124:127], v[236:239], v[140:143], v[124:127]
    v_cvt_pk_bf16_f32 v114, v228, v229
    v_mul_f32 v230, v132, v230
    v_mfma_f32_16x16x32_bf16 v[220:223], v[232:235], v[36:39], 0
    v_mul_f32 v231, v132, v231
    v_cvt_pk_bf16_f32 v115, v230, v231
    v_mfma_f32_16x16x32_bf16 v[220:223], v[128:131], v[140:143], v[220:223]
    ds_write_b128 v3, v[112:115] offset:0
    v_mfma_f32_16x16x32_bf16 v[252:255], v[216:219], v[36:39], 0
    v_mul_f32 v240, v132, v240
    v_mul_f32 v241, v132, v241
    v_mfma_f32_16x16x32_bf16 v[252:255], v[164:167], v[140:143], v[252:255]
    v_cvt_pk_bf16_f32 v122, v240, v241
    v_mul_f32 v242, v132, v242
    v_mul_f32 v243, v132, v243
    v_mfma_f32_16x16x16_bf16 v[192:195], v[178:179], v[188:189], v[192:195]
    v_cvt_pk_bf16_f32 v123, v242, v243
    v_mul_f32 v210, v172, v210
    v_mul_f32 v211, v172, v211
    v_mfma_f32_16x16x16_bf16 v[184:187], v[146:147], v[188:189], v[184:187]
    v_cvt_pk_bf16_f32 v203, v210, v211
    v_mul_f32 v156, v172, v156
    v_mul_f32 v157, v172, v157
    v_mfma_f32_16x16x16_bf16 v[212:215], v[190:191], v[188:189], v[212:215]
    v_cvt_pk_bf16_f32 v178, v156, v157
    v_mul_f32 v158, v172, v158
    v_mul_f32 v159, v172, v159
    v_cvt_pk_bf16_f32 v179, v158, v159
    v_mfma_f32_16x16x32_bf16 v[208:211], a[240:243], v[168:171], 0
    ds_write_b64 v4, v[122:123] offset:4096
    v_mfma_f32_16x16x32_bf16 v[208:211], a[244:247], v[196:199], v[208:211]
    buffer_store_dwordx4 v[200:203], v16, s[12:15], 0 offen
    v_mov_b32 v172, v173
    v_max3_f32 v121, v160, v192, v193
    v_max3_f32 v121, v121, v194, v195
    v_max_f32_dpp v172, v172, v172 quad_perm:[1,0,3,2] row_mask:0xf bank_mask:0xf
    v_mfma_f32_16x16x32_bf16 v[208:211], a[248:251], v[224:227], v[208:211]
    v_max3_f32 v121, v121, v184, v185
    v_max_f32_dpp v172, v172, v172 quad_perm:[2,3,0,1] row_mask:0xf bank_mask:0xf
    v_mfma_f32_16x16x32_bf16 v[208:211], a[252:255], v[174:177], v[208:211]
    ds_read_b128 v[112:115], v2 offset:12288
    v_max_f32_dpp v172, v172, v172 row_half_mirror row_mask:0xf bank_mask:0xf
    v_mfma_f32_16x16x32_bf16 v[208:211], v[76:79], v[116:119], v[208:211]
    ds_read_b128 v[188:191], v2 offset:13312
    v_max_f32_dpp v172, v172, v172 row_mirror row_mask:0xf bank_mask:0xf
    v_mfma_f32_16x16x32_bf16 v[208:211], v[80:83], v[204:207], v[208:211]
    ds_read_b128 v[144:147], v2 offset:14336
    v_mov_b32 v122, v172
    v_mfma_f32_16x16x32_bf16 v[156:159], v[84:87], v[168:171], 0
    ds_read_b128 v[140:143], v2 offset:15360
    v_max3_f32 v121, v121, v186, v187
    v_mfma_f32_16x16x32_bf16 v[156:159], v[88:91], v[196:199], v[156:159]
    ds_read_b128 v[168:171], v2 offset:16384
    v_max3_f32 v121, v121, v212, v213
    v_mfma_f32_16x16x32_bf16 v[156:159], v[92:95], v[224:227], v[156:159]
    ds_read_b128 v[148:151], v2 offset:17408
    v_max3_f32 v121, v121, v214, v215
    v_mfma_f32_16x16x32_bf16 v[156:159], v[96:99], v[174:177], v[156:159]
    v_permlane32_swap_b32 v172, v122
    v_mfma_f32_16x16x32_bf16 v[156:159], v[100:103], v[116:119], v[156:159]
    v_max_f32 v172, v172, v122
    v_mov_b32 v122, v172
    v_mfma_f32_16x16x32_bf16 v[156:159], v[104:107], v[204:207], v[156:159]
    s_waitcnt lgkmcnt(5)
    v_permlane16_swap_b32 v172, v122
    v_mfma_f32_16x16x32_bf16 v[200:203], a[216:219], v[112:115], 0
    s_waitcnt lgkmcnt(4)
    v_max_f32 v172, v172, v122
    v_sub_f32 v173, v173, v172
    v_mfma_f32_16x16x32_bf16 v[200:203], a[220:223], v[188:191], v[200:203]
    s_waitcnt lgkmcnt(3)
    v_exp_f32 v173, v173
    v_mfma_f32_16x16x32_bf16 v[200:203], a[224:227], v[144:147], v[200:203]
    s_waitcnt lgkmcnt(2)
    v_cvt_pk_bf16_f32 v173, v173, v173
    v_mov_b32 v122, v121
    v_mfma_f32_16x16x32_bf16 v[200:203], a[228:231], v[140:143], v[200:203]
    s_waitcnt lgkmcnt(1)
    ds_write_b16 v8, v173
    v_mfma_f32_16x16x32_bf16 v[200:203], a[232:235], v[168:171], v[200:203]
    s_waitcnt lgkmcnt(1)
    v_permlane32_swap_b32 v121, v122
    v_mfma_f32_16x16x32_bf16 v[200:203], a[236:239], v[148:151], v[200:203]
    v_max_f32 v121, v121, v122
    v_mov_b32 v122, v121
    v_mfma_f32_16x16x32_bf16 v[244:247], a[240:243], v[112:115], 0
    buffer_store_dwordx2 v[178:179], v19, s[12:15], 0 offen
    v_permlane16_swap_b32 v121, v122
    v_mfma_f32_16x16x32_bf16 v[244:247], a[244:247], v[188:191], v[244:247]
    v_max_f32 v121, v121, v122
    v_sub_f32 v192, v192, v121
    v_mfma_f32_16x16x32_bf16 v[244:247], a[248:251], v[144:147], v[244:247]
    v_fma_f32 v122, v200, v200, s33
    v_fmac_f32 v122, v201, v201
    v_mfma_f32_16x16x32_bf16 v[244:247], a[252:255], v[140:143], v[244:247]
    v_fmac_f32 v122, v202, v202
    v_fmac_f32 v122, v203, v203
    v_mfma_f32_16x16x32_bf16 v[244:247], v[76:79], v[168:171], v[244:247]
    v_exp_f32 v192, v192
    v_mfma_f32_16x16x32_bf16 v[244:247], v[80:83], v[148:151], v[244:247]
    v_sub_f32 v193, v193, v121
    v_sub_f32 v194, v194, v121
    v_mfma_f32_16x16x32_bf16 v[132:135], v[84:87], v[112:115], 0
    v_exp_f32 v193, v193
    v_mfma_f32_16x16x32_bf16 v[132:135], v[88:91], v[188:191], v[132:135]
    v_cvt_pk_bf16_f32 v116, v192, v193
    v_sub_f32 v195, v195, v121
    v_mfma_f32_16x16x32_bf16 v[132:135], v[92:95], v[144:147], v[132:135]
    v_fmac_f32 v122, v244, v244
    v_fmac_f32 v122, v245, v245
    v_mfma_f32_16x16x32_bf16 v[132:135], v[96:99], v[140:143], v[132:135]
    v_fmac_f32 v122, v246, v246
    v_fmac_f32 v122, v247, v247
    v_mfma_f32_16x16x32_bf16 v[132:135], v[100:103], v[168:171], v[132:135]
    v_exp_f32 v194, v194
    v_mfma_f32_16x16x32_bf16 v[132:135], v[104:107], v[148:151], v[132:135]
    v_exp_f32 v195, v195
    v_sub_f32 v184, v184, v121
    v_cvt_pk_bf16_f32 v117, v194, v195
    v_exp_f32 v184, v184
    v_sub_f32 v185, v185, v121
    v_exp_f32 v185, v185
    v_sub_f32 v186, v186, v121
    v_cvt_pk_bf16_f32 v118, v184, v185
    v_fmac_f32 v122, v132, v132
    v_fmac_f32 v122, v133, v133
    v_fmac_f32 v122, v134, v134
    v_fmac_f32 v122, v135, v135
    v_cvt_pk_bf16_f32 v123, v122, v122
    v_exp_f32 v186, v186
    v_sub_f32 v187, v187, v121
    v_exp_f32 v187, v187
    v_sub_f32 v212, v212, v121
    v_cvt_pk_bf16_f32 v119, v186, v187
    v_exp_f32 v212, v212
    v_sub_f32 v213, v213, v121
    v_exp_f32 v213, v213
    v_sub_f32 v214, v214, v121
    v_cvt_pk_bf16_f32 v36, v212, v213
    v_exp_f32 v214, v214
    v_sub_f32 v215, v215, v121
    v_exp_f32 v215, v215
    v_sub_f32 v160, v160, v121
    v_cvt_pk_bf16_f32 v37, v214, v215
    v_exp_f32 v160, v160
    v_xor_b32 v0, 65536, v0
    v_cvt_pk_bf16_f32 v39, v160, 0
    v_xor_b32 v1, 65536, v1
    v_fma_f32 v121, v136, v136, s33
    v_mfma_f32_16x16x32_bf16 v[140:143], v[28:31], v[36:39], 0
    ds_read_b128 v[196:199], v0 offset:20480
    ds_read_b128 v[184:187], v1 offset:20480
    v_mfma_f32_16x16x32_bf16 v[140:143], v[28:31], v[116:119], v[140:143]
    ds_read_b128 v[172:175], v0 offset:20608
    ds_read_b128 v[148:151], v1 offset:20608
    v_mfma_f32_16x16x32_bf16 v[144:147], v[248:251], v[36:39], 0
    buffer_load_dwordx4 v14, s[8:11], 0 offen nt lds
    ds_read_b128 v[112:115], v0 offset:20736
    v_mfma_f32_16x16x32_bf16 v[144:147], v[236:239], v[116:119], v[144:147]
    v_fmac_f32 v121, v137, v137
    v_fmac_f32 v121, v138, v138
    v_mfma_f32_16x16x32_bf16 v[168:171], v[232:235], v[36:39], 0
    ds_read_b128 v[228:231], v1 offset:20736
    ds_read_b128 v[176:179], v9
    v_mfma_f32_16x16x32_bf16 v[168:171], v[128:131], v[116:119], v[168:171]
    v_fmac_f32 v121, v139, v139
    v_fmac_f32 v121, v208, v208
    v_mfma_f32_16x16x32_bf16 v[188:191], v[216:219], v[36:39], 0
    ds_read_b128 v[160:163], v9 offset:64
    v_fmac_f32 v121, v209, v209
    v_mfma_f32_16x16x32_bf16 v[188:191], v[164:167], v[116:119], v[188:191]
    v_fmac_f32 v121, v210, v210
    v_fmac_f32 v121, v211, v211
    s_waitcnt lgkmcnt(6)
    v_mfma_f32_16x16x32_bf16 v[204:207], a[72:75], v[196:199], 0
    s_waitcnt lgkmcnt(5)
    v_fmac_f32 v121, v156, v156
    v_fmac_f32 v121, v157, v157
    v_mfma_f32_16x16x32_bf16 v[204:207], a[76:79], v[184:187], v[204:207]
    s_waitcnt lgkmcnt(4)
    v_fmac_f32 v121, v158, v158
    v_fmac_f32 v121, v159, v159
    v_mfma_f32_16x16x32_bf16 v[204:207], a[80:83], v[172:175], v[204:207]
    s_waitcnt lgkmcnt(3)
    v_rcp_f32 v120, v120
    v_mfma_f32_16x16x32_bf16 v[204:207], a[84:87], v[148:151], v[204:207]
    s_waitcnt lgkmcnt(2)
    v_mul_f32 v124, v120, v124
    v_mul_f32 v125, v120, v125
    v_mfma_f32_16x16x32_bf16 v[204:207], a[88:91], v[112:115], v[204:207]
    s_waitcnt lgkmcnt(1)
    v_cvt_pk_bf16_f32 v192, v124, v125
    v_mul_f32 v126, v120, v126
    v_mfma_f32_16x16x32_bf16 v[212:215], v[176:179], v[28:31], 0
    s_waitcnt lgkmcnt(0)
    v_mul_f32 v127, v120, v127
    v_cvt_pk_bf16_f32 v193, v126, v127
    v_mfma_f32_16x16x32_bf16 v[212:215], v[160:163], v[28:31], v[212:215]
    v_mul_f32 v220, v120, v220
    v_mul_f32 v221, v120, v221
    v_mfma_f32_16x16x32_bf16 v[116:119], v[176:179], v[236:239], 0
    v_cvt_pk_bf16_f32 v194, v220, v221
    v_mul_f32 v222, v120, v222
    v_mfma_f32_16x16x32_bf16 v[116:119], v[160:163], v[248:251], v[116:119]
    v_mul_f32 v223, v120, v223
    v_cvt_pk_bf16_f32 v195, v222, v223
    v_mfma_f32_16x16x32_bf16 v[124:127], v[176:179], v[128:131], 0
    ds_write_b128 v3, v[192:195] offset:6144
    v_mfma_f32_16x16x32_bf16 v[124:127], v[160:163], v[232:235], v[124:127]
    v_mul_f32 v252, v120, v252
    v_mul_f32 v253, v120, v253
    v_mfma_f32_16x16x32_bf16 v[128:131], v[176:179], v[164:167], 0
    v_cvt_pk_bf16_f32 v252, v252, v253
    v_mul_f32 v254, v120, v254
    v_mfma_f32_16x16x32_bf16 v[128:131], v[160:163], v[216:219], v[128:131]
    v_mul_f32 v255, v120, v255
    v_cvt_pk_bf16_f32 v253, v254, v255
    v_mfma_f32_16x16x32_bf16 v[204:207], a[92:95], v[228:231], v[204:207]
    ds_write_b64 v4, v[252:253] offset:10240
    v_mfma_f32_16x16x32_bf16 v[176:179], a[96:99], v[196:199], 0
    v_rcp_f32 v212, v212
    v_mfma_f32_16x16x32_bf16 v[176:179], a[100:103], v[184:187], v[176:179]
    v_mul_f32 v116, v116, v212
    v_mul_f32_dpp v116, v124, v212 quad_perm:[0,1,2,3] row_mask:0x2 bank_mask:0xf
    v_mfma_f32_16x16x32_bf16 v[176:179], a[104:107], v[172:175], v[176:179]
    v_mul_f32_dpp v116, v128, v212 quad_perm:[0,1,2,3] row_mask:0x4 bank_mask:0xf
    v_cvt_pk_bf16_f32 v116, v116, v116
    v_mfma_f32_16x16x32_bf16 v[176:179], a[108:111], v[148:151], v[176:179]
    ds_write_b16 v7, v116
    v_mfma_f32_16x16x32_bf16 v[176:179], a[112:115], v[112:115], v[176:179]
    v_rcp_f32 v140, v140
    v_mfma_f32_16x16x32_bf16 v[176:179], a[116:119], v[228:231], v[176:179]
    v_mul_f32 v144, v140, v144
    v_mul_f32 v145, v140, v145
    v_mfma_f32_16x16x32_bf16 v[124:127], a[120:123], v[196:199], 0
    v_cvt_pk_bf16_f32 v116, v144, v145
    v_mul_f32 v146, v140, v146
    v_mfma_f32_16x16x32_bf16 v[124:127], a[124:127], v[184:187], v[124:127]
    v_mul_f32 v147, v140, v147
    v_cvt_pk_bf16_f32 v117, v146, v147
    v_mfma_f32_16x16x32_bf16 v[124:127], a[128:131], v[172:175], v[124:127]
    v_mul_f32 v168, v140, v168
    v_mul_f32 v169, v140, v169
    v_mfma_f32_16x16x32_bf16 v[124:127], a[132:135], v[148:151], v[124:127]
    v_cvt_pk_bf16_f32 v118, v168, v169
    v_mul_f32 v170, v140, v170
    v_mfma_f32_16x16x32_bf16 v[124:127], a[136:139], v[112:115], v[124:127]
    v_mul_f32 v171, v140, v171
    v_cvt_pk_bf16_f32 v119, v170, v171
    v_mfma_f32_16x16x32_bf16 v[124:127], a[140:143], v[228:231], v[124:127]
    ds_write_b128 v3, v[116:119] offset:12288
    v_mfma_f32_16x16x32_bf16 v[216:219], a[0:3], v[196:199], 0
    v_mul_f32 v188, v140, v188
    v_mul_f32 v189, v140, v189
    v_mfma_f32_16x16x32_bf16 v[216:219], a[4:7], v[184:187], v[216:219]
    v_cvt_pk_bf16_f32 v188, v188, v189
    v_mul_f32 v190, v140, v190
    v_mfma_f32_16x16x32_bf16 v[216:219], a[8:11], v[172:175], v[216:219]
    v_mul_f32 v191, v140, v191
    v_cvt_pk_bf16_f32 v189, v190, v191
    v_mfma_f32_16x16x32_bf16 v[216:219], a[12:15], v[148:151], v[216:219]
    ds_write_b64 v4, v[188:189] offset:16384
    v_mfma_f32_16x16x32_bf16 v[216:219], a[16:19], v[112:115], v[216:219]
    v_fma_f32 v120, v180, v180, s33
    v_fmac_f32 v120, v181, v181
    v_mfma_f32_16x16x32_bf16 v[216:219], a[20:23], v[228:231], v[216:219]
    v_fmac_f32 v120, v182, v182
    v_fmac_f32 v120, v183, v183
    v_mfma_f32_16x16x32_bf16 v[160:163], a[24:27], v[196:199], 0
    v_fmac_f32 v120, v108, v108
    v_fmac_f32 v120, v109, v109
    v_mfma_f32_16x16x32_bf16 v[160:163], a[28:31], v[184:187], v[160:163]
    v_fmac_f32 v120, v110, v110
    v_fmac_f32 v120, v111, v111
    v_mfma_f32_16x16x32_bf16 v[160:163], a[32:35], v[172:175], v[160:163]
    v_fmac_f32 v120, v152, v152
    v_fmac_f32 v120, v153, v153
    v_mfma_f32_16x16x32_bf16 v[160:163], a[36:39], v[148:151], v[160:163]
    v_fmac_f32 v120, v154, v154
    v_fmac_f32 v120, v155, v155
    v_mfma_f32_16x16x32_bf16 v[160:163], a[40:43], v[112:115], v[160:163]
    v_cvt_pk_bf16_f32 v122, v120, v121
    v_add_u32 v5, 336, v5
    v_mfma_f32_16x16x32_bf16 v[160:163], a[44:47], v[228:231], v[160:163]
    ds_write_b64 v4, v[122:123] offset:18432
    v_mfma_f32_16x16x32_bf16 v[116:119], a[48:51], v[196:199], 0
    v_add_u32 v6, 272, v6
    v_add_u32 v7, 16, v7
    v_mfma_f32_16x16x32_bf16 v[116:119], a[52:55], v[184:187], v[116:119]
    v_xor_b32 v2, 65536, v2
    v_xor_b32 v3, 65536, v3
    v_mfma_f32_16x16x32_bf16 v[116:119], a[56:59], v[172:175], v[116:119]
    v_xor_b32 v4, 65536, v4
    v_fma_f32 v169, v204, v204, s32
    v_mfma_f32_16x16x32_bf16 v[116:119], a[60:63], v[148:151], v[116:119]
    v_fmac_f32 v169, v205, v205
    v_fmac_f32 v169, v206, v206
    v_mfma_f32_16x16x32_bf16 v[116:119], a[64:67], v[112:115], v[116:119]
    v_fmac_f32 v169, v207, v207
    v_fmac_f32 v169, v176, v176
    v_mfma_f32_16x16x32_bf16 v[116:119], a[68:71], v[228:231], v[116:119]
    v_fmac_f32 v169, v177, v177
    v_fmac_f32 v169, v178, v178
    v_mfma_f32_16x16x32_bf16 v[128:131], v[196:199], a[144:147], 0
    s_waitcnt lgkmcnt(0)
    v_fmac_f32 v169, v179, v179
    v_fmac_f32 v169, v124, v124
    v_mfma_f32_16x16x32_bf16 v[128:131], v[184:187], a[148:151], v[128:131]
    s_nop 0
    v_fmac_f32 v169, v125, v125
    v_fmac_f32 v169, v126, v126
    v_mfma_f32_16x16x32_bf16 v[128:131], v[172:175], a[152:155], v[128:131]
    s_nop 0
    v_fmac_f32 v169, v127, v127
    v_fma_f32 v168, v216, v216, s32
    v_mfma_f32_16x16x32_bf16 v[128:131], v[148:151], a[156:159], v[128:131]
    s_barrier
    v_fmac_f32 v168, v217, v217
    v_fmac_f32 v168, v218, v218
    v_mfma_f32_16x16x32_bf16 v[128:131], v[112:115], a[160:163], v[128:131]
    s_nop 0
    v_fmac_f32 v168, v219, v219
    v_mfma_f32_16x16x32_bf16 v[128:131], v[228:231], a[164:167], v[128:131]
    s_cbranch_scc1 L_loop_safe2
    s_branch L_drain
.p2align 6
L_loop_safe3:
    v_mfma_f32_16x16x32_bf16 v[188:191], v[196:199], a[168:171], 0
    s_add_u32 s12, s42, s27
    ds_read_b128 v[192:195], v2 offset:18432
    ds_read_b128 v[164:167], v2 offset:19456
    v_mfma_f32_16x16x32_bf16 v[188:191], v[184:187], a[172:175], v[188:191]
    s_addc_u32 s13, s43, 0
    ds_read_b128 v[120:123], v0 offset:26624
    ds_read_b128 v[140:143], v1 offset:26624
    v_mfma_f32_16x16x32_bf16 v[188:191], v[172:175], a[176:179], v[188:191]
    s_sub_u32 s14, s36, s27
    v_fmac_f32 v168, v160, v160
    v_fmac_f32 v168, v161, v161
    v_mfma_f32_16x16x32_bf16 v[188:191], v[148:151], a[180:183], v[188:191]
    s_cmp_ge_u32 s18, 2
    ds_read_b128 v[232:235], v0 offset:26752
    ds_read_b128 v[224:227], v1 offset:26752
    v_mfma_f32_16x16x32_bf16 v[188:191], v[112:115], a[184:187], v[188:191]
    s_cselect_b32 s14, s14, 0
    v_fmac_f32 v168, v162, v162
    v_fmac_f32 v168, v163, v163
    v_mfma_f32_16x16x32_bf16 v[188:191], v[228:231], a[188:191], v[188:191]
    s_add_u32 s34, s18, 2
    ds_read_b128 v[212:215], v0 offset:26880
    ds_read_b128 v[144:147], v1 offset:26880
    v_mfma_f32_16x16x32_bf16 v[220:223], v[196:199], a[192:195], 0
    s_add_u32 s8, s40, s23
    v_fmac_f32 v168, v116, v116
    v_fmac_f32 v168, v117, v117
    v_mfma_f32_16x16x32_bf16 v[220:223], v[184:187], a[196:199], v[220:223]
    s_addc_u32 s9, s41, 0
    v_fmac_f32 v168, v118, v118
    v_fmac_f32 v168, v119, v119
    v_mfma_f32_16x16x32_bf16 v[220:223], v[172:175], a[200:203], v[220:223]
    s_waitcnt lgkmcnt(6)
    v_cvt_pk_bf16_f32 v36, v168, v169
    v_cvt_pk_bf16_f32 v236, v128, v129
    v_mfma_f32_16x16x32_bf16 v[172:175], v[32:35], v[192:195], 0
    s_waitcnt lgkmcnt(4)
    v_cvt_pk_bf16_f32 v237, v130, v131
    v_cvt_pk_bf16_f32 v128, v188, v189
    v_mfma_f32_16x16x32_bf16 v[168:171], v[32:35], v[36:39], 0
    s_sub_u32 s10, s36, s23
    v_cvt_pk_bf16_f32 v129, v190, v191
    s_cmp_lt_u32 s34, s17
    v_mfma_f32_16x16x32_bf16 v[172:175], v[32:35], v[164:167], v[172:175]
    s_cselect_b32 s10, s10, 0
    s_add_u32 m0, s28, 0
    s_mov_b32 s27, s26
    v_mfma_f32_16x16x32_bf16 v[220:223], v[148:151], a[204:207], v[220:223]
    s_mov_b32 s26, s25
    v_rsq_f32 v169, v169
    v_mfma_f32_16x16x32_bf16 v[220:223], v[112:115], a[208:211], v[220:223]
    s_mov_b32 s25, s24
    v_rsq_f32 v168, v168
    v_mfma_f32_16x16x32_bf16 v[220:223], v[228:231], a[212:215], v[220:223]
    s_mov_b32 s24, s23
    v_mul_f32 v168, s31, v168
    v_mul_f32 v171, 0x3baaaaab, v172
    v_mfma_f32_16x16x32_bf16 v[112:115], a[72:75], v[120:123], 0
    s_waitcnt lgkmcnt(0)
    v_rsq_f32 v171, v171
    v_mfma_f32_16x16x32_bf16 v[112:115], a[76:79], v[140:143], v[112:115]
    v_mul_f32 v172, 0x3baaaaab, v173
    v_cvt_pk_bf16_f32 v164, v220, v221
    v_mfma_f32_16x16x32_bf16 v[112:115], a[80:83], v[232:235], v[112:115]
    v_cvt_pk_bf16_f32 v165, v222, v223
    v_mul_f32 v170, 0x3baaaaab, v174
    v_mfma_f32_16x16x32_bf16 v[112:115], a[84:87], v[224:227], v[112:115]
    v_rsq_f32 v172, v172
    v_mfma_f32_16x16x32_bf16 v[112:115], a[88:91], v[212:215], v[112:115]
    v_rsq_f32 v170, v170
    v_mfma_f32_16x16x32_bf16 v[112:115], a[92:95], v[144:147], v[112:115]
    v_mul_f32 v180, v171, v180
    v_mul_f32 v181, v171, v181
    v_mfma_f32_16x16x32_bf16 v[148:151], a[96:99], v[120:123], 0
    v_cvt_pk_bf16_f32 v180, v180, v181
    v_mul_f32 v182, v171, v182
    v_mfma_f32_16x16x32_bf16 v[148:151], a[100:103], v[140:143], v[148:151]
    v_mul_f32 v183, v171, v183
    v_cvt_pk_bf16_f32 v181, v182, v183
    v_mfma_f32_16x16x32_bf16 v[148:151], a[104:107], v[232:235], v[148:151]
    v_mul_f32 v108, v171, v108
    v_mul_f32 v109, v171, v109
    v_mfma_f32_16x16x32_bf16 v[148:151], a[108:111], v[224:227], v[148:151]
    v_cvt_pk_bf16_f32 v182, v108, v109
    v_mul_f32 v110, v171, v110
    v_mfma_f32_16x16x32_bf16 v[148:151], a[112:115], v[212:215], v[148:151]
    v_mul_f32 v111, v171, v111
    v_cvt_pk_bf16_f32 v183, v110, v111
    v_mfma_f32_16x16x32_bf16 v[148:151], a[116:119], v[144:147], v[148:151]
    buffer_store_dwordx4 v[180:183], v15, s[12:15], 0 offen
    v_mul_f32 v152, v171, v152
    v_mul_f32 v153, v171, v153
    v_cvt_pk_bf16_f32 v130, v152, v153
    v_mul_f32 v154, v171, v154
    v_mfma_f32_16x16x32_bf16 v[180:183], a[120:123], v[120:123], 0
    v_mul_f32 v155, v171, v155
    v_cvt_pk_bf16_f32 v131, v154, v155
    v_mfma_f32_16x16x32_bf16 v[180:183], a[124:127], v[140:143], v[180:183]
    v_mul_f32 v204, v169, v204
    v_mul_f32 v205, v169, v205
    v_mfma_f32_16x16x32_bf16 v[180:183], a[128:131], v[232:235], v[180:183]
    v_cvt_pk_bf16_f32 v184, v204, v205
    v_mul_f32 v206, v169, v206
    v_mfma_f32_16x16x32_bf16 v[180:183], a[132:135], v[224:227], v[180:183]
    v_mul_f32 v207, v169, v207
    v_cvt_pk_bf16_f32 v185, v206, v207
    v_mfma_f32_16x16x32_bf16 v[180:183], a[136:139], v[212:215], v[180:183]
    v_mul_f32 v176, v169, v176
    v_mul_f32 v177, v169, v177
    v_mfma_f32_16x16x32_bf16 v[180:183], a[140:143], v[144:147], v[180:183]
    v_cvt_pk_bf16_f32 v186, v176, v177
    v_mul_f32 v178, v169, v178
    v_mfma_f32_16x16x32_bf16 v[108:111], a[0:3], v[120:123], 0
    v_mul_f32 v179, v169, v179
    v_cvt_pk_bf16_f32 v187, v178, v179
    v_mfma_f32_16x16x32_bf16 v[108:111], a[4:7], v[140:143], v[108:111]
    v_mul_f32 v124, v169, v124
    v_mul_f32 v125, v169, v125
    v_mfma_f32_16x16x32_bf16 v[108:111], a[8:11], v[232:235], v[108:111]
    v_cvt_pk_bf16_f32 v178, v124, v125
    v_mul_f32 v126, v169, v126
    v_mfma_f32_16x16x32_bf16 v[108:111], a[12:15], v[224:227], v[108:111]
    v_mul_f32 v127, v169, v127
    v_cvt_pk_bf16_f32 v179, v126, v127
    v_mfma_f32_16x16x32_bf16 v[108:111], a[16:19], v[212:215], v[108:111]
    v_mul_f32 v216, v168, v216
    v_mul_f32 v217, v168, v217
    v_mfma_f32_16x16x32_bf16 v[108:111], a[20:23], v[144:147], v[108:111]
    v_cvt_pk_bf16_f32 v124, v216, v217
    v_mul_f32 v218, v168, v218
    v_mfma_f32_16x16x32_bf16 v[152:155], a[24:27], v[120:123], 0
    v_mul_f32 v219, v168, v219
    v_cvt_pk_bf16_f32 v125, v218, v219
    v_mfma_f32_16x16x32_bf16 v[152:155], a[28:31], v[140:143], v[152:155]
    v_mul_f32 v160, v168, v160
    v_mul_f32 v161, v168, v161
    v_mfma_f32_16x16x32_bf16 v[152:155], a[32:35], v[232:235], v[152:155]
    v_cvt_pk_bf16_f32 v126, v160, v161
    v_mul_f32 v162, v168, v162
    v_mfma_f32_16x16x32_bf16 v[152:155], a[36:39], v[224:227], v[152:155]
    v_mul_f32 v163, v168, v163
    v_cvt_pk_bf16_f32 v127, v162, v163
    v_mfma_f32_16x16x32_bf16 v[152:155], a[40:43], v[212:215], v[152:155]
    buffer_store_dwordx2 v[130:131], v18, s[12:15], 0 offen
    v_mul_f32 v116, v168, v116
    v_mul_f32 v117, v168, v117
    v_mfma_f32_16x16x32_bf16 v[152:155], a[44:47], v[144:147], v[152:155]
    v_cvt_pk_bf16_f32 v176, v116, v117
    v_mul_f32 v118, v168, v118
    v_mfma_f32_16x16x32_bf16 v[160:163], a[48:51], v[120:123], 0
    v_mul_f32 v119, v168, v119
    v_cvt_pk_bf16_f32 v177, v118, v119
    v_mfma_f32_16x16x32_bf16 v[160:163], a[52:55], v[140:143], v[160:163]
    v_fma_f32 v130, v108, v108, s32
    v_fmac_f32 v130, v109, v109
    v_mfma_f32_16x16x32_bf16 v[160:163], a[56:59], v[232:235], v[160:163]
    v_fmac_f32 v130, v110, v110
    v_fmac_f32 v130, v111, v111
    v_mfma_f32_16x16x32_bf16 v[160:163], a[60:63], v[224:227], v[160:163]
    v_fmac_f32 v130, v152, v152
    v_fmac_f32 v130, v153, v153
    v_mfma_f32_16x16x32_bf16 v[160:163], a[64:67], v[212:215], v[160:163]
    v_fmac_f32 v130, v154, v154
    v_fmac_f32 v130, v155, v155
    v_mfma_f32_16x16x32_bf16 v[160:163], a[68:71], v[144:147], v[160:163]
    v_fma_f32 v131, v112, v112, s32
    v_fmac_f32 v131, v113, v113
    v_mfma_f32_16x16x32_bf16 v[188:191], v[120:123], a[144:147], 0
    v_fmac_f32 v131, v114, v114
    v_fmac_f32 v131, v115, v115
    v_mfma_f32_16x16x32_bf16 v[188:191], v[140:143], a[148:151], v[188:191]
    v_fmac_f32 v131, v148, v148
    v_fmac_f32 v131, v149, v149
    v_mfma_f32_16x16x32_bf16 v[188:191], v[232:235], a[152:155], v[188:191]
    v_fmac_f32 v130, v160, v160
    v_fmac_f32 v130, v161, v161
    v_mfma_f32_16x16x32_bf16 v[188:191], v[224:227], a[156:159], v[188:191]
    v_fmac_f32 v130, v162, v162
    v_fmac_f32 v130, v163, v163
    v_mfma_f32_16x16x32_bf16 v[188:191], v[212:215], a[160:163], v[188:191]
    v_fmac_f32 v131, v150, v150
    v_fmac_f32 v131, v151, v151
    v_mfma_f32_16x16x32_bf16 v[188:191], v[144:147], a[164:167], v[188:191]
    v_fmac_f32 v131, v180, v180
    v_fmac_f32 v131, v181, v181
    v_mfma_f32_16x16x32_bf16 v[196:199], v[120:123], a[168:171], 0
    ds_read_b128 v[116:119], v0 offset:32768
    v_fmac_f32 v131, v182, v182
    v_mfma_f32_16x16x32_bf16 v[196:199], v[140:143], a[172:175], v[196:199]
    ds_read_b128 v[204:207], v1 offset:32768
    v_fmac_f32 v131, v183, v183
    v_mfma_f32_16x16x32_bf16 v[196:199], v[232:235], a[176:179], v[196:199]
    ds_read_b128 v[192:195], v0 offset:32896
    v_cvt_pk_bf16_f32 v238, v188, v189
    v_mfma_f32_16x16x32_bf16 v[196:199], v[224:227], a[180:183], v[196:199]
    ds_read_b128 v[220:223], v1 offset:32896
    v_cvt_pk_bf16_f32 v239, v190, v191
    v_mfma_f32_16x16x32_bf16 v[196:199], v[212:215], a[184:187], v[196:199]
    ds_read_b128 v[188:191], v0 offset:33024
    v_cvt_pk_bf16_f32 v36, v130, v131
    v_mfma_f32_16x16x32_bf16 v[196:199], v[144:147], a[188:191], v[196:199]
    ds_read_b128 v[240:243], v1 offset:33024
    v_mul_f32 v200, v170, v200
    v_mfma_f32_16x16x32_bf16 v[216:219], v[32:35], v[36:39], 0
    v_mul_f32 v201, v170, v201
    v_cvt_pk_bf16_f32 v200, v200, v201
    v_mfma_f32_16x16x32_bf16 v[228:231], v[120:123], a[192:195], 0
    v_mul_f32 v202, v170, v202
    v_mul_f32 v203, v170, v203
    v_mfma_f32_16x16x32_bf16 v[228:231], v[140:143], a[196:199], v[228:231]
    s_waitcnt lgkmcnt(5)
    v_cvt_pk_bf16_f32 v130, v196, v197
    v_cvt_pk_bf16_f32 v131, v198, v199
    v_mfma_f32_16x16x32_bf16 v[228:231], v[232:235], a[200:203], v[228:231]
    s_waitcnt lgkmcnt(4)
    v_rsq_f32 v217, v217
    v_mfma_f32_16x16x32_bf16 v[228:231], v[224:227], a[204:207], v[228:231]
    s_waitcnt lgkmcnt(3)
    v_rsq_f32 v216, v216
    v_mfma_f32_16x16x32_bf16 v[228:231], v[212:215], a[208:211], v[228:231]
    s_waitcnt lgkmcnt(2)
    v_mul_f32 v216, s31, v216
    v_mul_f32 v112, v217, v112
    v_mfma_f32_16x16x32_bf16 v[228:231], v[144:147], a[212:215], v[228:231]
    s_waitcnt lgkmcnt(1)
    v_mul_f32 v113, v217, v113
    v_cvt_pk_bf16_f32 v112, v112, v113
    v_mfma_f32_16x16x32_bf16 v[120:123], a[72:75], v[116:119], 0
    s_waitcnt lgkmcnt(0)
    v_mul_f32 v114, v217, v114
    v_mul_f32 v115, v217, v115
    v_mfma_f32_16x16x32_bf16 v[120:123], a[76:79], v[204:207], v[120:123]
    v_cvt_pk_bf16_f32 v166, v228, v229
    v_cvt_pk_bf16_f32 v167, v230, v231
    v_mfma_f32_16x16x32_bf16 v[120:123], a[80:83], v[192:195], v[120:123]
    v_cvt_pk_bf16_f32 v113, v114, v115
    v_mul_f32 v148, v217, v148
    v_mfma_f32_16x16x32_bf16 v[120:123], a[84:87], v[220:223], v[120:123]
    v_mul_f32 v149, v217, v149
    v_cvt_pk_bf16_f32 v114, v148, v149
    v_mfma_f32_16x16x32_bf16 v[120:123], a[88:91], v[188:191], v[120:123]
    v_mul_f32 v150, v217, v150
    v_mul_f32 v151, v217, v151
    v_mfma_f32_16x16x32_bf16 v[120:123], a[92:95], v[240:243], v[120:123]
    v_cvt_pk_bf16_f32 v115, v150, v151
    v_mul_f32 v180, v217, v180
    v_mfma_f32_16x16x32_bf16 v[140:143], a[96:99], v[116:119], 0
    v_mul_f32 v181, v217, v181
    v_cvt_pk_bf16_f32 v146, v180, v181
    v_mfma_f32_16x16x32_bf16 v[140:143], a[100:103], v[204:207], v[140:143]
    v_mul_f32 v182, v217, v182
    v_mul_f32 v183, v217, v183
    v_mfma_f32_16x16x32_bf16 v[140:143], a[104:107], v[192:195], v[140:143]
    v_cvt_pk_bf16_f32 v147, v182, v183
    v_mul_f32 v108, v216, v108
    v_mfma_f32_16x16x32_bf16 v[140:143], a[108:111], v[220:223], v[140:143]
    v_mul_f32 v109, v216, v109
    v_cvt_pk_bf16_f32 v148, v108, v109
    v_mfma_f32_16x16x32_bf16 v[140:143], a[112:115], v[188:191], v[140:143]
    v_mul_f32 v110, v216, v110
    v_mul_f32 v111, v216, v111
    v_mfma_f32_16x16x32_bf16 v[140:143], a[116:119], v[240:243], v[140:143]
    v_cvt_pk_bf16_f32 v149, v110, v111
    v_mul_f32 v152, v216, v152
    v_mfma_f32_16x16x32_bf16 v[108:111], a[120:123], v[116:119], 0
    v_mul_f32 v153, v216, v153
    v_cvt_pk_bf16_f32 v150, v152, v153
    v_mfma_f32_16x16x32_bf16 v[108:111], a[124:127], v[204:207], v[108:111]
    v_mul_f32 v154, v216, v154
    v_mul_f32 v155, v216, v155
    v_mfma_f32_16x16x32_bf16 v[108:111], a[128:131], v[192:195], v[108:111]
    v_cvt_pk_bf16_f32 v151, v154, v155
    v_mul_f32 v160, v216, v160
    v_mfma_f32_16x16x32_bf16 v[108:111], a[132:135], v[220:223], v[108:111]
    v_mul_f32 v161, v216, v161
    v_cvt_pk_bf16_f32 v144, v160, v161
    v_mfma_f32_16x16x32_bf16 v[108:111], a[136:139], v[188:191], v[108:111]
    v_mul_f32 v162, v216, v162
    v_mul_f32 v163, v216, v163
    v_mfma_f32_16x16x32_bf16 v[108:111], a[140:143], v[240:243], v[108:111]
    s_waitcnt vmcnt(2)
    v_cvt_pk_bf16_f32 v145, v162, v163
    v_fma_f32 v168, v120, v120, s32
    v_mfma_f32_16x16x32_bf16 v[152:155], a[0:3], v[116:119], 0
    s_nop 0
    v_fmac_f32 v168, v121, v121
    v_fmac_f32 v168, v122, v122
    v_mfma_f32_16x16x32_bf16 v[152:155], a[4:7], v[204:207], v[152:155]
    s_nop 0
    v_fmac_f32 v168, v123, v123
    v_fmac_f32 v168, v140, v140
    v_mfma_f32_16x16x32_bf16 v[152:155], a[8:11], v[192:195], v[152:155]
    s_nop 0
    v_fmac_f32 v168, v141, v141
    v_fmac_f32 v168, v142, v142
    v_mfma_f32_16x16x32_bf16 v[152:155], a[12:15], v[220:223], v[152:155]
    s_barrier
    buffer_load_dwordx4 v10, s[8:11], 0 offen nt lds
    v_fmac_f32 v168, v143, v143
    v_mfma_f32_16x16x32_bf16 v[152:155], a[16:19], v[188:191], v[152:155]
    s_add_u32 m0, s28, 4096
    v_fmac_f32 v168, v108, v108
    v_fmac_f32 v168, v109, v109
    v_mfma_f32_16x16x32_bf16 v[152:155], a[20:23], v[240:243], v[152:155]
    v_fmac_f32 v168, v110, v110
    v_fmac_f32 v168, v111, v111
    v_mfma_f32_16x16x32_bf16 v[160:163], a[24:27], v[116:119], 0
    v_cvt_pk_bf16_f32 v201, v202, v203
    v_mul_f32 v244, v170, v244
    v_mfma_f32_16x16x32_bf16 v[160:163], a[28:31], v[204:207], v[160:163]
    v_mul_f32 v245, v170, v245
    v_cvt_pk_bf16_f32 v202, v244, v245
    v_mfma_f32_16x16x32_bf16 v[160:163], a[32:35], v[192:195], v[160:163]
    buffer_load_dwordx4 v11, s[8:11], 0 offen nt lds
    v_fma_f32 v169, v152, v152, s32
    v_mfma_f32_16x16x32_bf16 v[160:163], a[36:39], v[220:223], v[160:163]
    s_add_u32 m0, s28, 8192
    v_fmac_f32 v169, v153, v153
    v_fmac_f32 v169, v154, v154
    v_mfma_f32_16x16x32_bf16 v[160:163], a[40:43], v[188:191], v[160:163]
    v_fmac_f32 v169, v155, v155
    v_mul_f32 v246, v170, v246
    v_mfma_f32_16x16x32_bf16 v[160:163], a[44:47], v[240:243], v[160:163]
    v_mul_f32 v247, v170, v247
    v_cvt_pk_bf16_f32 v203, v246, v247
    v_mfma_f32_16x16x32_bf16 v[196:199], a[48:51], v[116:119], 0
    v_mul_f32 v132, v170, v132
    v_mul_f32 v133, v170, v133
    v_mfma_f32_16x16x32_bf16 v[196:199], a[52:55], v[204:207], v[196:199]
    buffer_load_dwordx4 v12, s[8:11], 0 offen nt lds
    v_cvt_pk_bf16_f32 v216, v132, v133
    v_mfma_f32_16x16x32_bf16 v[196:199], a[56:59], v[192:195], v[196:199]
    s_add_u32 m0, s28, 12288
    ds_read2_b32 v[250:251], v6 offset0:0 offset1:0
    ds_read2_b32 v[234:235], v6 offset0:16 offset1:16
    v_mfma_f32_16x16x32_bf16 v[196:199], a[60:63], v[220:223], v[196:199]
    s_xor_b32 s28, s28, 65536
    ds_read_b128 v[224:227], v5 offset:0
    ds_read_b128 v[180:183], v5 offset:16
    v_mfma_f32_16x16x32_bf16 v[196:199], a[64:67], v[188:191], v[196:199]
    v_fmac_f32 v169, v160, v160
    v_fmac_f32 v169, v161, v161
    v_mfma_f32_16x16x32_bf16 v[196:199], a[68:71], v[240:243], v[196:199]
    ds_read_b128 v[212:215], v5 offset:48
    ds_read_b32 v173, v6 offset:192
    v_mfma_f32_16x16x32_bf16 v[228:231], v[116:119], a[144:147], 0
    buffer_load_dwordx4 v13, s[8:11], 0 offen nt lds
    ds_read2_b32 v[218:219], v6 offset0:32 offset1:32
    v_mfma_f32_16x16x32_bf16 v[228:231], v[204:207], a[148:151], v[228:231]
    s_mov_b32 m0, s29
    v_fmac_f32 v169, v162, v162
    v_fmac_f32 v169, v163, v163
    v_mfma_f32_16x16x32_bf16 v[228:231], v[192:195], a[152:155], v[228:231]
    s_xor_b32 s29, s29, s30
    v_fmac_f32 v169, v196, v196
    v_fmac_f32 v169, v197, v197
    v_mfma_f32_16x16x32_bf16 v[228:231], v[220:223], a[156:159], v[228:231]
    s_add_u32 s19, s19, s20
    v_fmac_f32 v169, v198, v198
    v_fmac_f32 v169, v199, v199
    v_mfma_f32_16x16x32_bf16 v[228:231], v[188:191], a[160:163], v[228:231]
    s_add_u32 s23, s23, s21
    v_cvt_pk_bf16_f32 v36, v169, v168
    v_mul_f32 v134, v170, v134
    v_mfma_f32_16x16x32_bf16 v[228:231], v[240:243], a[164:167], v[228:231]
    s_waitcnt lgkmcnt(3)
    buffer_store_dwordx4 v[200:203], v17, s[12:15], 0 offen
    v_mul_f32 v135, v170, v135
    v_cvt_pk_bf16_f32 v217, v134, v135
    v_mul_f32 v136, v172, v136
    v_mul_f32 v137, v172, v137
    v_mfma_f32_16x16x32_bf16 v[168:171], v[32:35], v[36:39], 0
    s_cmp_ge_u32 s19, 72
    v_cvt_pk_bf16_f32 v248, v228, v229
    v_cvt_pk_bf16_f32 v249, v230, v231
    v_mfma_f32_16x16x32_bf16 v[132:135], v[224:227], v[124:127], v[22:25]
    s_cselect_b32 s34, 72, 0
    v_cvt_pk_bf16_f32 v200, v136, v137
    v_mul_f32 v138, v172, v138
    v_mfma_f32_16x16x32_bf16 v[132:135], v[180:183], v[184:187], v[132:135]
    s_waitcnt lgkmcnt(0)
    v_rsq_f32 v169, v169
    v_mfma_f32_16x16x32_bf16 v[132:135], v[212:215], v[176:179], v[132:135]
    s_cselect_b32 s35, s22, 0
    v_rsq_f32 v168, v168
    v_mfma_f32_16x16x32_bf16 v[228:231], v[116:119], a[168:171], 0
    s_sub_u32 s19, s19, s34
    v_mul_f32 v168, s31, v168
    v_mul_f32 v120, v169, v120
    v_mfma_f32_16x16x32_bf16 v[228:231], v[204:207], a[172:175], v[228:231]
    s_add_u32 s23, s23, s35
    v_mov_b32_dpp v173, v133 quad_perm:[0,1,2,3] row_mask:0x1 bank_mask:0xf
    v_mul_f32 v121, v169, v121
    v_mfma_f32_16x16x32_bf16 v[228:231], v[192:195], a[176:179], v[228:231]
    s_add_u32 s18, s18, 1
    v_cvt_pk_bf16_f32 v120, v120, v121
    v_mul_f32 v122, v169, v122
    v_mfma_f32_16x16x32_bf16 v[228:231], v[220:223], a[180:183], v[228:231]
    s_cmp_lt_u32 s18, s17
    v_mul_f32 v123, v169, v123
    v_cvt_pk_bf16_f32 v121, v122, v123
    v_mfma_f32_16x16x32_bf16 v[228:231], v[188:191], a[184:187], v[228:231]
    v_mul_f32 v140, v169, v140
    v_mul_f32 v141, v169, v141
    v_mfma_f32_16x16x32_bf16 v[228:231], v[240:243], a[188:191], v[228:231]
    v_cvt_pk_bf16_f32 v122, v140, v141
    v_mul_f32 v142, v169, v142
    v_mfma_f32_16x16x32_bf16 v[244:247], v[116:119], a[192:195], 0
    v_mul_f32 v143, v169, v143
    v_cvt_pk_bf16_f32 v123, v142, v143
    v_mfma_f32_16x16x32_bf16 v[244:247], v[204:207], a[196:199], v[244:247]
    v_mul_f32 v108, v169, v108
    v_mul_f32 v109, v169, v109
    v_mfma_f32_16x16x32_bf16 v[244:247], v[192:195], a[200:203], v[244:247]
    ds_read_b128 v[116:119], v2 offset:0
    v_cvt_pk_bf16_f32 v232, v228, v229
    v_mfma_f32_16x16x32_bf16 v[244:247], v[220:223], a[204:207], v[244:247]
    ds_read_b128 v[204:207], v2 offset:1024
    v_cvt_pk_bf16_f32 v233, v230, v231
    v_mfma_f32_16x16x32_bf16 v[244:247], v[188:191], a[208:211], v[244:247]
    ds_read_b128 v[140:143], v2 offset:2048
    v_cvt_pk_bf16_f32 v190, v108, v109
    v_mfma_f32_16x16x32_bf16 v[244:247], v[240:243], a[212:215], v[244:247]
    ds_read_b128 v[252:255], v2 offset:3072
    ds_read_b128 v[192:195], v2 offset:4096
    v_mfma_f32_16x16x32_bf16 v[220:223], v[184:187], v[124:127], v[40:43]
    ds_read_b128 v[134:137], v2 offset:5120
    buffer_store_dwordx2 v[216:217], v20, s[12:15], 0 offen
    v_mul_f32 v110, v169, v110
    v_mul_f32 v111, v169, v111
    v_mfma_f32_16x16x32_bf16 v[240:243], v[112:115], v[124:127], v[44:47]
    v_cvt_pk_bf16_f32 v216, v244, v245
    v_cvt_pk_bf16_f32 v217, v246, v247
    v_mfma_f32_16x16x32_bf16 v[228:231], v[120:123], v[124:127], v[48:51]
    v_cvt_pk_bf16_f32 v191, v110, v111
    v_mul_f32 v152, v168, v152
    v_mul_f32 v153, v168, v153
    v_mfma_f32_16x16x16_bf16 v[220:223], v[178:179], v[176:177], v[220:223]
    v_cvt_pk_bf16_f32 v244, v152, v153
    v_mul_f32 v154, v168, v154
    v_mul_f32 v155, v168, v155
    v_mfma_f32_16x16x16_bf16 v[240:243], v[146:147], v[176:177], v[240:243]
    v_cvt_pk_bf16_f32 v245, v154, v155
    v_mul_f32 v160, v168, v160
    v_mul_f32 v161, v168, v161
    v_mfma_f32_16x16x16_bf16 v[228:231], v[190:191], v[176:177], v[228:231]
    v_cvt_pk_bf16_f32 v246, v160, v161
    v_mul_f32 v162, v168, v162
    v_mul_f32 v163, v168, v163
    v_cvt_pk_bf16_f32 v247, v162, v163
    v_mfma_f32_16x16x32_bf16 v[124:127], v[224:227], v[148:151], v[24:27]
    s_waitcnt lgkmcnt(1)
    v_mul_f32 v196, v168, v196
    v_mul_f32 v197, v168, v197
    v_mfma_f32_16x16x32_bf16 v[124:127], v[180:183], v[112:115], v[124:127]
    s_waitcnt lgkmcnt(0)
    v_cvt_pk_bf16_f32 v188, v196, v197
    v_mul_f32 v198, v168, v198
    v_mfma_f32_16x16x32_bf16 v[124:127], v[212:215], v[144:147], v[124:127]
    v_mul_f32 v199, v168, v199
    v_cvt_pk_bf16_f32 v189, v198, v199
    v_mfma_f32_16x16x32_bf16 v[160:163], v[224:227], v[244:247], v[26:29]
    v_max3_f32 v133, v132, v220, v221
    v_max3_f32 v133, v133, v222, v223
    v_mfma_f32_16x16x32_bf16 v[160:163], v[180:183], v[120:123], v[160:163]
    v_max3_f32 v133, v133, v240, v241
    v_max3_f32 v133, v133, v242, v243
    v_mfma_f32_16x16x32_bf16 v[160:163], v[212:215], v[188:191], v[160:163]
    v_max3_f32 v133, v133, v228, v229
    v_max3_f32 v133, v133, v230, v231
    v_mfma_f32_16x16x32_bf16 v[180:183], a[216:219], v[116:119], 0
    v_mov_b32 v174, v133
    v_mov_b32_dpp v173, v125 quad_perm:[0,1,2,3] row_mask:0x2 bank_mask:0xf
    v_mfma_f32_16x16x32_bf16 v[180:183], a[220:223], v[204:207], v[180:183]
    v_permlane32_swap_b32 v133, v174
    v_mfma_f32_16x16x32_bf16 v[180:183], a[224:227], v[140:143], v[180:183]
    v_max_f32 v133, v133, v174
    v_mov_b32 v174, v133
    v_mfma_f32_16x16x32_bf16 v[180:183], a[228:231], v[252:255], v[180:183]
    v_mov_b32_dpp v173, v161 quad_perm:[0,1,2,3] row_mask:0x4 bank_mask:0xf
    v_mul_f32 v139, v172, v139
    v_mfma_f32_16x16x32_bf16 v[180:183], a[232:235], v[192:195], v[180:183]
    v_permlane16_swap_b32 v133, v174
    v_mfma_f32_16x16x32_bf16 v[180:183], a[236:239], v[134:137], v[180:183]
    v_max_f32 v133, v133, v174
    v_sub_f32 v220, v220, v133
    v_mfma_f32_16x16x32_bf16 v[108:111], a[240:243], v[116:119], 0
    v_exp_f32 v220, v220
    v_mfma_f32_16x16x32_bf16 v[108:111], a[244:247], v[204:207], v[108:111]
    v_sub_f32 v221, v221, v133
    v_sub_f32 v222, v222, v133
    v_mfma_f32_16x16x32_bf16 v[108:111], a[248:251], v[140:143], v[108:111]
    v_exp_f32 v221, v221
    v_mfma_f32_16x16x32_bf16 v[108:111], a[252:255], v[252:255], v[108:111]
    ds_read_b128 v[168:171], v2 offset:6144
    v_cvt_pk_bf16_f32 v212, v220, v221
    v_mfma_f32_16x16x32_bf16 v[108:111], v[76:79], v[192:195], v[108:111]
    ds_read_b128 v[196:199], v2 offset:7168
    v_sub_f32 v223, v223, v133
    v_mfma_f32_16x16x32_bf16 v[108:111], v[80:83], v[134:137], v[108:111]
    ds_read_b128 v[224:227], v2 offset:8192
    v_sub_f32 v240, v240, v133
    v_mfma_f32_16x16x32_bf16 v[152:155], v[84:87], v[116:119], 0
    ds_read_b128 v[174:177], v2 offset:9216
    v_sub_f32 v241, v241, v133
    v_mfma_f32_16x16x32_bf16 v[152:155], v[88:91], v[204:207], v[152:155]
    ds_read_b128 v[116:119], v2 offset:10240
    v_sub_f32 v242, v242, v133
    v_mfma_f32_16x16x32_bf16 v[152:155], v[92:95], v[140:143], v[152:155]
    ds_read_b128 v[204:207], v2 offset:11264
    v_sub_f32 v243, v243, v133
    v_mfma_f32_16x16x32_bf16 v[152:155], v[96:99], v[252:255], v[152:155]
    v_exp_f32 v222, v222
    v_mfma_f32_16x16x32_bf16 v[152:155], v[100:103], v[192:195], v[152:155]
    v_exp_f32 v223, v223
    v_mfma_f32_16x16x32_bf16 v[152:155], v[104:107], v[134:137], v[152:155]
    s_waitcnt lgkmcnt(5)
    v_cvt_pk_bf16_f32 v213, v222, v223
    v_exp_f32 v240, v240
    v_exp_f32 v241, v241
    v_mfma_f32_16x16x32_bf16 v[140:143], v[184:187], v[148:151], v[52:55]
    s_waitcnt lgkmcnt(3)
    v_cvt_pk_bf16_f32 v214, v240, v241
    v_exp_f32 v242, v242
    v_exp_f32 v243, v243
    v_sub_f32 v228, v228, v133
    v_cvt_pk_bf16_f32 v215, v242, v243
    v_mfma_f32_16x16x16_bf16 v[140:143], v[178:179], v[144:145], v[140:143]
    v_exp_f32 v228, v228
    v_sub_f32 v229, v229, v133
    v_exp_f32 v229, v229
    v_mfma_f32_16x16x32_bf16 v[192:195], v[112:115], v[148:151], v[56:59]
    s_waitcnt lgkmcnt(0)
    v_cvt_pk_bf16_f32 v36, v228, v229
    v_sub_f32 v230, v230, v133
    v_exp_f32 v230, v230
    v_sub_f32 v231, v231, v133
    v_exp_f32 v231, v231
    v_mfma_f32_16x16x32_bf16 v[220:223], v[120:123], v[148:151], v[60:63]
    v_cvt_pk_bf16_f32 v37, v230, v231
    v_sub_f32 v132, v132, v133
    v_max3_f32 v203, v124, v140, v141
    v_mfma_f32_16x16x16_bf16 v[192:195], v[146:147], v[144:145], v[192:195]
    v_exp_f32 v132, v132
    v_max3_f32 v203, v203, v142, v143
    v_mfma_f32_16x16x16_bf16 v[220:223], v[190:191], v[144:145], v[220:223]
    v_cvt_pk_bf16_f32 v39, v132, 0
    v_cvt_pk_bf16_f32 v201, v138, v139
    v_mul_f32 v208, v172, v208
    v_mul_f32 v209, v172, v209
    v_mfma_f32_16x16x32_bf16 v[132:135], v[28:31], v[36:39], 0
    v_max3_f32 v203, v203, v192, v193
    v_max3_f32 v203, v203, v194, v195
    v_mfma_f32_16x16x32_bf16 v[132:135], v[28:31], v[212:215], v[132:135]
    v_max3_f32 v203, v203, v220, v221
    v_max3_f32 v203, v203, v222, v223
    v_mfma_f32_16x16x32_bf16 v[148:151], v[248:251], v[36:39], 0
    v_mov_b32 v144, v203
    v_cvt_pk_bf16_f32 v202, v208, v209
    v_mfma_f32_16x16x32_bf16 v[148:151], v[236:239], v[212:215], v[148:151]
    v_permlane32_swap_b32 v203, v144
    v_mfma_f32_16x16x32_bf16 v[228:231], v[232:235], v[36:39], 0
    v_max_f32 v203, v203, v144
    v_mov_b32 v144, v203
    v_mfma_f32_16x16x32_bf16 v[228:231], v[128:131], v[212:215], v[228:231]
    v_rcp_f32 v132, v132
    v_mfma_f32_16x16x32_bf16 v[240:243], v[216:219], v[36:39], 0
    v_permlane16_swap_b32 v203, v144
    v_mfma_f32_16x16x32_bf16 v[240:243], v[164:167], v[212:215], v[240:243]
    v_max_f32 v203, v203, v144
    v_sub_f32 v140, v140, v203
    v_mfma_f32_16x16x32_bf16 v[136:139], a[216:219], v[168:171], 0
    v_exp_f32 v140, v140
    v_mfma_f32_16x16x32_bf16 v[136:139], a[220:223], v[196:199], v[136:139]
    v_sub_f32 v141, v141, v203
    v_sub_f32 v142, v142, v203
    v_mfma_f32_16x16x32_bf16 v[136:139], a[224:227], v[224:227], v[136:139]
    v_exp_f32 v141, v141
    v_mfma_f32_16x16x32_bf16 v[136:139], a[228:231], v[174:177], v[136:139]
    v_cvt_pk_bf16_f32 v140, v140, v141
    v_sub_f32 v143, v143, v203
    v_mfma_f32_16x16x32_bf16 v[136:139], a[232:235], v[116:119], v[136:139]
    v_exp_f32 v142, v142
    v_mfma_f32_16x16x32_bf16 v[136:139], a[236:239], v[204:207], v[136:139]
    v_exp_f32 v143, v143
    v_sub_f32 v192, v192, v203
    v_cvt_pk_bf16_f32 v141, v142, v143
    v_exp_f32 v192, v192
    v_sub_f32 v193, v193, v203
    v_exp_f32 v193, v193
    v_sub_f32 v194, v194, v203
    v_cvt_pk_bf16_f32 v142, v192, v193
    v_exp_f32 v194, v194
    v_sub_f32 v195, v195, v203
    v_exp_f32 v195, v195
    v_sub_f32 v220, v220, v203
    v_cvt_pk_bf16_f32 v143, v194, v195
    v_exp_f32 v220, v220
    v_sub_f32 v221, v221, v203
    v_exp_f32 v221, v221
    v_sub_f32 v222, v222, v203
    v_cvt_pk_bf16_f32 v36, v220, v221
    v_exp_f32 v222, v222
    v_sub_f32 v223, v223, v203
    v_exp_f32 v223, v223
    v_mfma_f32_16x16x32_bf16 v[192:195], v[184:187], v[244:247], v[64:67]
    v_cvt_pk_bf16_f32 v37, v222, v223
    v_sub_f32 v124, v124, v203
    v_mfma_f32_16x16x32_bf16 v[184:187], v[112:115], v[244:247], v[68:71]
    v_exp_f32 v124, v124
    v_mfma_f32_16x16x32_bf16 v[212:215], v[120:123], v[244:247], v[72:75]
    v_cvt_pk_bf16_f32 v39, v124, 0
    v_mul_f32 v148, v132, v148
    v_mul_f32 v149, v132, v149
    v_mfma_f32_16x16x32_bf16 v[120:123], v[28:31], v[36:39], 0
    v_cvt_pk_bf16_f32 v112, v148, v149
    v_mul_f32 v150, v132, v150
    v_mfma_f32_16x16x32_bf16 v[120:123], v[28:31], v[140:143], v[120:123]
    v_mul_f32 v151, v132, v151
    v_cvt_pk_bf16_f32 v113, v150, v151
    v_mfma_f32_16x16x32_bf16 v[124:127], v[248:251], v[36:39], 0
    v_mul_f32 v228, v132, v228
    v_mul_f32 v229, v132, v229
    v_mfma_f32_16x16x32_bf16 v[124:127], v[236:239], v[140:143], v[124:127]
    v_cvt_pk_bf16_f32 v114, v228, v229
    v_mul_f32 v230, v132, v230
    v_mfma_f32_16x16x32_bf16 v[220:223], v[232:235], v[36:39], 0
    v_mul_f32 v231, v132, v231
    v_cvt_pk_bf16_f32 v115, v230, v231
    v_mfma_f32_16x16x32_bf16 v[220:223], v[128:131], v[140:143], v[220:223]
    ds_write_b128 v3, v[112:115] offset:0
    v_mfma_f32_16x16x32_bf16 v[252:255], v[216:219], v[36:39], 0
    v_mul_f32 v240, v132, v240
    v_mul_f32 v241, v132, v241
    v_mfma_f32_16x16x32_bf16 v[252:255], v[164:167], v[140:143], v[252:255]
    v_cvt_pk_bf16_f32 v122, v240, v241
    v_mul_f32 v242, v132, v242
    v_mul_f32 v243, v132, v243
    v_mfma_f32_16x16x16_bf16 v[192:195], v[178:179], v[188:189], v[192:195]
    v_cvt_pk_bf16_f32 v123, v242, v243
    v_mul_f32 v210, v172, v210
    v_mul_f32 v211, v172, v211
    v_mfma_f32_16x16x16_bf16 v[184:187], v[146:147], v[188:189], v[184:187]
    v_cvt_pk_bf16_f32 v203, v210, v211
    v_mul_f32 v156, v172, v156
    v_mul_f32 v157, v172, v157
    v_mfma_f32_16x16x16_bf16 v[212:215], v[190:191], v[188:189], v[212:215]
    v_cvt_pk_bf16_f32 v178, v156, v157
    v_mul_f32 v158, v172, v158
    v_mul_f32 v159, v172, v159
    v_cvt_pk_bf16_f32 v179, v158, v159
    v_mfma_f32_16x16x32_bf16 v[208:211], a[240:243], v[168:171], 0
    ds_write_b64 v4, v[122:123] offset:4096
    v_mfma_f32_16x16x32_bf16 v[208:211], a[244:247], v[196:199], v[208:211]
    buffer_store_dwordx4 v[200:203], v16, s[12:15], 0 offen
    v_mov_b32 v172, v173
    v_max3_f32 v121, v160, v192, v193
    v_max3_f32 v121, v121, v194, v195
    v_max_f32_dpp v172, v172, v172 quad_perm:[1,0,3,2] row_mask:0xf bank_mask:0xf
    v_mfma_f32_16x16x32_bf16 v[208:211], a[248:251], v[224:227], v[208:211]
    v_max3_f32 v121, v121, v184, v185
    v_max_f32_dpp v172, v172, v172 quad_perm:[2,3,0,1] row_mask:0xf bank_mask:0xf
    v_mfma_f32_16x16x32_bf16 v[208:211], a[252:255], v[174:177], v[208:211]
    ds_read_b128 v[112:115], v2 offset:12288
    v_max_f32_dpp v172, v172, v172 row_half_mirror row_mask:0xf bank_mask:0xf
    v_mfma_f32_16x16x32_bf16 v[208:211], v[76:79], v[116:119], v[208:211]
    ds_read_b128 v[188:191], v2 offset:13312
    v_max_f32_dpp v172, v172, v172 row_mirror row_mask:0xf bank_mask:0xf
    v_mfma_f32_16x16x32_bf16 v[208:211], v[80:83], v[204:207], v[208:211]
    ds_read_b128 v[144:147], v2 offset:14336
    v_mov_b32 v122, v172
    v_mfma_f32_16x16x32_bf16 v[156:159], v[84:87], v[168:171], 0
    ds_read_b128 v[140:143], v2 offset:15360
    v_max3_f32 v121, v121, v186, v187
    v_mfma_f32_16x16x32_bf16 v[156:159], v[88:91], v[196:199], v[156:159]
    ds_read_b128 v[168:171], v2 offset:16384
    v_max3_f32 v121, v121, v212, v213
    v_mfma_f32_16x16x32_bf16 v[156:159], v[92:95], v[224:227], v[156:159]
    ds_read_b128 v[148:151], v2 offset:17408
    v_max3_f32 v121, v121, v214, v215
    v_mfma_f32_16x16x32_bf16 v[156:159], v[96:99], v[174:177], v[156:159]
    v_permlane32_swap_b32 v172, v122
    v_mfma_f32_16x16x32_bf16 v[156:159], v[100:103], v[116:119], v[156:159]
    v_max_f32 v172, v172, v122
    v_mov_b32 v122, v172
    v_mfma_f32_16x16x32_bf16 v[156:159], v[104:107], v[204:207], v[156:159]
    s_waitcnt lgkmcnt(5)
    v_permlane16_swap_b32 v172, v122
    v_mfma_f32_16x16x32_bf16 v[200:203], a[216:219], v[112:115], 0
    s_waitcnt lgkmcnt(4)
    v_max_f32 v172, v172, v122
    v_sub_f32 v173, v173, v172
    v_mfma_f32_16x16x32_bf16 v[200:203], a[220:223], v[188:191], v[200:203]
    s_waitcnt lgkmcnt(3)
    v_exp_f32 v173, v173
    v_mfma_f32_16x16x32_bf16 v[200:203], a[224:227], v[144:147], v[200:203]
    s_waitcnt lgkmcnt(2)
    v_cvt_pk_bf16_f32 v173, v173, v173
    v_mov_b32 v122, v121
    v_mfma_f32_16x16x32_bf16 v[200:203], a[228:231], v[140:143], v[200:203]
    s_waitcnt lgkmcnt(1)
    ds_write_b16 v8, v173
    v_mfma_f32_16x16x32_bf16 v[200:203], a[232:235], v[168:171], v[200:203]
    s_waitcnt lgkmcnt(1)
    v_permlane32_swap_b32 v121, v122
    v_mfma_f32_16x16x32_bf16 v[200:203], a[236:239], v[148:151], v[200:203]
    v_max_f32 v121, v121, v122
    v_mov_b32 v122, v121
    v_mfma_f32_16x16x32_bf16 v[244:247], a[240:243], v[112:115], 0
    buffer_store_dwordx2 v[178:179], v19, s[12:15], 0 offen
    v_permlane16_swap_b32 v121, v122
    v_mfma_f32_16x16x32_bf16 v[244:247], a[244:247], v[188:191], v[244:247]
    v_max_f32 v121, v121, v122
    v_sub_f32 v192, v192, v121
    v_mfma_f32_16x16x32_bf16 v[244:247], a[248:251], v[144:147], v[244:247]
    v_fma_f32 v122, v200, v200, s33
    v_fmac_f32 v122, v201, v201
    v_mfma_f32_16x16x32_bf16 v[244:247], a[252:255], v[140:143], v[244:247]
    v_fmac_f32 v122, v202, v202
    v_fmac_f32 v122, v203, v203
    v_mfma_f32_16x16x32_bf16 v[244:247], v[76:79], v[168:171], v[244:247]
    v_exp_f32 v192, v192
    v_mfma_f32_16x16x32_bf16 v[244:247], v[80:83], v[148:151], v[244:247]
    v_sub_f32 v193, v193, v121
    v_sub_f32 v194, v194, v121
    v_mfma_f32_16x16x32_bf16 v[132:135], v[84:87], v[112:115], 0
    v_exp_f32 v193, v193
    v_mfma_f32_16x16x32_bf16 v[132:135], v[88:91], v[188:191], v[132:135]
    v_cvt_pk_bf16_f32 v116, v192, v193
    v_sub_f32 v195, v195, v121
    v_mfma_f32_16x16x32_bf16 v[132:135], v[92:95], v[144:147], v[132:135]
    v_fmac_f32 v122, v244, v244
    v_fmac_f32 v122, v245, v245
    v_mfma_f32_16x16x32_bf16 v[132:135], v[96:99], v[140:143], v[132:135]
    v_fmac_f32 v122, v246, v246
    v_fmac_f32 v122, v247, v247
    v_mfma_f32_16x16x32_bf16 v[132:135], v[100:103], v[168:171], v[132:135]
    v_exp_f32 v194, v194
    v_mfma_f32_16x16x32_bf16 v[132:135], v[104:107], v[148:151], v[132:135]
    v_exp_f32 v195, v195
    v_sub_f32 v184, v184, v121
    v_cvt_pk_bf16_f32 v117, v194, v195
    v_exp_f32 v184, v184
    v_sub_f32 v185, v185, v121
    v_exp_f32 v185, v185
    v_sub_f32 v186, v186, v121
    v_cvt_pk_bf16_f32 v118, v184, v185
    v_fmac_f32 v122, v132, v132
    v_fmac_f32 v122, v133, v133
    v_fmac_f32 v122, v134, v134
    v_fmac_f32 v122, v135, v135
    v_cvt_pk_bf16_f32 v123, v122, v122
    v_exp_f32 v186, v186
    v_sub_f32 v187, v187, v121
    v_exp_f32 v187, v187
    v_sub_f32 v212, v212, v121
    v_cvt_pk_bf16_f32 v119, v186, v187
    v_exp_f32 v212, v212
    v_sub_f32 v213, v213, v121
    v_exp_f32 v213, v213
    v_sub_f32 v214, v214, v121
    v_cvt_pk_bf16_f32 v36, v212, v213
    v_exp_f32 v214, v214
    v_sub_f32 v215, v215, v121
    v_exp_f32 v215, v215
    v_sub_f32 v160, v160, v121
    v_cvt_pk_bf16_f32 v37, v214, v215
    v_exp_f32 v160, v160
    v_xor_b32 v0, 65536, v0
    v_cvt_pk_bf16_f32 v39, v160, 0
    v_xor_b32 v1, 65536, v1
    v_fma_f32 v121, v136, v136, s33
    v_mfma_f32_16x16x32_bf16 v[140:143], v[28:31], v[36:39], 0
    ds_read_b128 v[196:199], v0 offset:20480
    ds_read_b128 v[184:187], v1 offset:20480
    v_mfma_f32_16x16x32_bf16 v[140:143], v[28:31], v[116:119], v[140:143]
    ds_read_b128 v[172:175], v0 offset:20608
    ds_read_b128 v[148:151], v1 offset:20608
    v_mfma_f32_16x16x32_bf16 v[144:147], v[248:251], v[36:39], 0
    buffer_load_dwordx4 v14, s[8:11], 0 offen nt lds
    ds_read_b128 v[112:115], v0 offset:20736
    v_mfma_f32_16x16x32_bf16 v[144:147], v[236:239], v[116:119], v[144:147]
    v_fmac_f32 v121, v137, v137
    v_fmac_f32 v121, v138, v138
    v_mfma_f32_16x16x32_bf16 v[168:171], v[232:235], v[36:39], 0
    ds_read_b128 v[228:231], v1 offset:20736
    ds_read_b128 v[176:179], v9
    v_mfma_f32_16x16x32_bf16 v[168:171], v[128:131], v[116:119], v[168:171]
    v_fmac_f32 v121, v139, v139
    v_fmac_f32 v121, v208, v208
    v_mfma_f32_16x16x32_bf16 v[188:191], v[216:219], v[36:39], 0
    ds_read_b128 v[160:163], v9 offset:64
    v_fmac_f32 v121, v209, v209
    v_mfma_f32_16x16x32_bf16 v[188:191], v[164:167], v[116:119], v[188:191]
    v_fmac_f32 v121, v210, v210
    v_fmac_f32 v121, v211, v211
    s_waitcnt lgkmcnt(6)
    v_mfma_f32_16x16x32_bf16 v[204:207], a[72:75], v[196:199], 0
    s_waitcnt lgkmcnt(5)
    v_fmac_f32 v121, v156, v156
    v_fmac_f32 v121, v157, v157
    v_mfma_f32_16x16x32_bf16 v[204:207], a[76:79], v[184:187], v[204:207]
    s_waitcnt lgkmcnt(4)
    v_fmac_f32 v121, v158, v158
    v_fmac_f32 v121, v159, v159
    v_mfma_f32_16x16x32_bf16 v[204:207], a[80:83], v[172:175], v[204:207]
    s_waitcnt lgkmcnt(3)
    v_rcp_f32 v120, v120
    v_mfma_f32_16x16x32_bf16 v[204:207], a[84:87], v[148:151], v[204:207]
    s_waitcnt lgkmcnt(2)
    v_mul_f32 v124, v120, v124
    v_mul_f32 v125, v120, v125
    v_mfma_f32_16x16x32_bf16 v[204:207], a[88:91], v[112:115], v[204:207]
    s_waitcnt lgkmcnt(1)
    v_cvt_pk_bf16_f32 v192, v124, v125
    v_mul_f32 v126, v120, v126
    v_mfma_f32_16x16x32_bf16 v[212:215], v[176:179], v[28:31], 0
    s_waitcnt lgkmcnt(0)
    v_mul_f32 v127, v120, v127
    v_cvt_pk_bf16_f32 v193, v126, v127
    v_mfma_f32_16x16x32_bf16 v[212:215], v[160:163], v[28:31], v[212:215]
    v_mul_f32 v220, v120, v220
    v_mul_f32 v221, v120, v221
    v_mfma_f32_16x16x32_bf16 v[116:119], v[176:179], v[236:239], 0
    v_cvt_pk_bf16_f32 v194, v220, v221
    v_mul_f32 v222, v120, v222
    v_mfma_f32_16x16x32_bf16 v[116:119], v[160:163], v[248:251], v[116:119]
    v_mul_f32 v223, v120, v223
    v_cvt_pk_bf16_f32 v195, v222, v223
    v_mfma_f32_16x16x32_bf16 v[124:127], v[176:179], v[128:131], 0
    ds_write_b128 v3, v[192:195] offset:6144
    v_mfma_f32_16x16x32_bf16 v[124:127], v[160:163], v[232:235], v[124:127]
    v_mul_f32 v252, v120, v252
    v_mul_f32 v253, v120, v253
    v_mfma_f32_16x16x32_bf16 v[128:131], v[176:179], v[164:167], 0
    v_cvt_pk_bf16_f32 v252, v252, v253
    v_mul_f32 v254, v120, v254
    v_mfma_f32_16x16x32_bf16 v[128:131], v[160:163], v[216:219], v[128:131]
    v_mul_f32 v255, v120, v255
    v_cvt_pk_bf16_f32 v253, v254, v255
    v_mfma_f32_16x16x32_bf16 v[204:207], a[92:95], v[228:231], v[204:207]
    ds_write_b64 v4, v[252:253] offset:10240
    v_mfma_f32_16x16x32_bf16 v[176:179], a[96:99], v[196:199], 0
    v_rcp_f32 v212, v212
    v_mfma_f32_16x16x32_bf16 v[176:179], a[100:103], v[184:187], v[176:179]
    v_mul_f32 v116, v116, v212
    v_mul_f32_dpp v116, v124, v212 quad_perm:[0,1,2,3] row_mask:0x2 bank_mask:0xf
    v_mfma_f32_16x16x32_bf16 v[176:179], a[104:107], v[172:175], v[176:179]
    v_mul_f32_dpp v116, v128, v212 quad_perm:[0,1,2,3] row_mask:0x4 bank_mask:0xf
    v_cvt_pk_bf16_f32 v116, v116, v116
    v_mfma_f32_16x16x32_bf16 v[176:179], a[108:111], v[148:151], v[176:179]
    ds_write_b16 v7, v116
    v_mfma_f32_16x16x32_bf16 v[176:179], a[112:115], v[112:115], v[176:179]
    v_rcp_f32 v140, v140
    v_mfma_f32_16x16x32_bf16 v[176:179], a[116:119], v[228:231], v[176:179]
    v_mul_f32 v144, v140, v144
    v_mul_f32 v145, v140, v145
    v_mfma_f32_16x16x32_bf16 v[124:127], a[120:123], v[196:199], 0
    v_cvt_pk_bf16_f32 v116, v144, v145
    v_mul_f32 v146, v140, v146
    v_mfma_f32_16x16x32_bf16 v[124:127], a[124:127], v[184:187], v[124:127]
    v_mul_f32 v147, v140, v147
    v_cvt_pk_bf16_f32 v117, v146, v147
    v_mfma_f32_16x16x32_bf16 v[124:127], a[128:131], v[172:175], v[124:127]
    v_mul_f32 v168, v140, v168
    v_mul_f32 v169, v140, v169
    v_mfma_f32_16x16x32_bf16 v[124:127], a[132:135], v[148:151], v[124:127]
    v_cvt_pk_bf16_f32 v118, v168, v169
    v_mul_f32 v170, v140, v170
    v_mfma_f32_16x16x32_bf16 v[124:127], a[136:139], v[112:115], v[124:127]
    v_mul_f32 v171, v140, v171
    v_cvt_pk_bf16_f32 v119, v170, v171
    v_mfma_f32_16x16x32_bf16 v[124:127], a[140:143], v[228:231], v[124:127]
    ds_write_b128 v3, v[116:119] offset:12288
    v_mfma_f32_16x16x32_bf16 v[216:219], a[0:3], v[196:199], 0
    v_mul_f32 v188, v140, v188
    v_mul_f32 v189, v140, v189
    v_mfma_f32_16x16x32_bf16 v[216:219], a[4:7], v[184:187], v[216:219]
    v_cvt_pk_bf16_f32 v188, v188, v189
    v_mul_f32 v190, v140, v190
    v_mfma_f32_16x16x32_bf16 v[216:219], a[8:11], v[172:175], v[216:219]
    v_mul_f32 v191, v140, v191
    v_cvt_pk_bf16_f32 v189, v190, v191
    v_mfma_f32_16x16x32_bf16 v[216:219], a[12:15], v[148:151], v[216:219]
    ds_write_b64 v4, v[188:189] offset:16384
    v_mfma_f32_16x16x32_bf16 v[216:219], a[16:19], v[112:115], v[216:219]
    v_fma_f32 v120, v180, v180, s33
    v_fmac_f32 v120, v181, v181
    v_mfma_f32_16x16x32_bf16 v[216:219], a[20:23], v[228:231], v[216:219]
    v_fmac_f32 v120, v182, v182
    v_fmac_f32 v120, v183, v183
    v_mfma_f32_16x16x32_bf16 v[160:163], a[24:27], v[196:199], 0
    v_fmac_f32 v120, v108, v108
    v_fmac_f32 v120, v109, v109
    v_mfma_f32_16x16x32_bf16 v[160:163], a[28:31], v[184:187], v[160:163]
    v_fmac_f32 v120, v110, v110
    v_fmac_f32 v120, v111, v111
    v_mfma_f32_16x16x32_bf16 v[160:163], a[32:35], v[172:175], v[160:163]
    v_fmac_f32 v120, v152, v152
    v_fmac_f32 v120, v153, v153
    v_mfma_f32_16x16x32_bf16 v[160:163], a[36:39], v[148:151], v[160:163]
    v_fmac_f32 v120, v154, v154
    v_fmac_f32 v120, v155, v155
    v_mfma_f32_16x16x32_bf16 v[160:163], a[40:43], v[112:115], v[160:163]
    v_cvt_pk_bf16_f32 v122, v120, v121
    v_add_u32 v5, 336, v5
    v_mfma_f32_16x16x32_bf16 v[160:163], a[44:47], v[228:231], v[160:163]
    ds_write_b64 v4, v[122:123] offset:18432
    v_mfma_f32_16x16x32_bf16 v[116:119], a[48:51], v[196:199], 0
    v_add_u32 v6, 272, v6
    v_add_u32 v7, 16, v7
    v_mfma_f32_16x16x32_bf16 v[116:119], a[52:55], v[184:187], v[116:119]
    v_xor_b32 v2, 65536, v2
    v_xor_b32 v3, 65536, v3
    v_mfma_f32_16x16x32_bf16 v[116:119], a[56:59], v[172:175], v[116:119]
    v_xor_b32 v4, 65536, v4
    v_fma_f32 v169, v204, v204, s32
    v_mfma_f32_16x16x32_bf16 v[116:119], a[60:63], v[148:151], v[116:119]
    v_fmac_f32 v169, v205, v205
    v_fmac_f32 v169, v206, v206
    v_mfma_f32_16x16x32_bf16 v[116:119], a[64:67], v[112:115], v[116:119]
    v_fmac_f32 v169, v207, v207
    v_fmac_f32 v169, v176, v176
    v_mfma_f32_16x16x32_bf16 v[116:119], a[68:71], v[228:231], v[116:119]
    v_fmac_f32 v169, v177, v177
    v_fmac_f32 v169, v178, v178
    v_mfma_f32_16x16x32_bf16 v[128:131], v[196:199], a[144:147], 0
    s_waitcnt lgkmcnt(0)
    v_fmac_f32 v169, v179, v179
    v_fmac_f32 v169, v124, v124
    v_mfma_f32_16x16x32_bf16 v[128:131], v[184:187], a[148:151], v[128:131]
    s_nop 0
    v_fmac_f32 v169, v125, v125
    v_fmac_f32 v169, v126, v126
    v_mfma_f32_16x16x32_bf16 v[128:131], v[172:175], a[152:155], v[128:131]
    s_nop 0
    v_fmac_f32 v169, v127, v127
    v_fma_f32 v168, v216, v216, s32
    v_mfma_f32_16x16x32_bf16 v[128:131], v[148:151], a[156:159], v[128:131]
    s_nop 0
    v_fmac_f32 v168, v217, v217
    v_fmac_f32 v168, v218, v218
    v_mfma_f32_16x16x32_bf16 v[128:131], v[112:115], a[160:163], v[128:131]
    s_barrier
    v_fmac_f32 v168, v219, v219
    v_mfma_f32_16x16x32_bf16 v[128:131], v[228:231], a[164:167], v[128:131]
    s_cbranch_scc1 L_loop_safe3
    s_branch L_drain
L_edge:
    v_lshrrev_b32 v170, 6, v0
    v_mov_b32 v171, v0
    v_readfirstlane_b32 s16, v170
    v_mov_b32 v170, 0x40000000
    s_mov_b32 s69, 193536
    s_mov_b32 s10, 100270464
    s_mov_b32 s11, 0x00020000
    s_mov_b32 s36, 100270464
    s_mov_b32 s22, 1180032
    s_mov_b32 s20, 0
    s_mov_b32 s38, 0
    s_sub_u32 s3, s2, 247
    s_and_b32 s3, s3, 3
    s_mul_i32 s3, s3, 7
    s_add_u32 s3, s3, 3
    s_mov_b32 s4, 196224
    s_cmp_lt_u32 s2, 251
    s_cselect_b32 s4, s4, 384
    s_cselect_b32 s6, 1, 0
    s_cselect_b32 s5, 0, 1
    s_mul_i32 s25, s3, s4
    s_mul_i32 s21, s4, 28
    s_cmp_lt_u32 s2, 255
    s_cselect_b32 s17, 18, 1
    s_cselect_b32 s25, s25, 0
    s_cselect_b32 s6, s6, 1
    s_add_u32 s7, s25, 1179648
    s_mul_i32 s3, s5, 99485568
    s_mul_i32 s4, s5, -784896
    v_mov_b32 v108, s3
    v_mov_b32 v109, s4
    s_add_u32 s7, s7, s4
    s_mul_i32 s3, s6, 194688
    s_mul_i32 s4, s6, -1536
    v_mov_b32 v110, s3
    v_mov_b32 v111, s4
    s_add_u32 s7, s7, s4
    v_mul_u32_u24 v120, 2731, v171
    v_bfe_u32 v121, v120, 17, 3
    v_lshrrev_b32 v120, 16, v120
    v_xor_b32 v122, v121, v171
    v_mul_u32_u24 v121, 37, v120
    v_lshrrev_b32 v121, 8, v121
    v_lshlrev_b32 v122, 4, v122
    v_mad_u32_u24 v10, v121, s69, v122
    v_mul_u32_u24 v121, 37, v120
    v_lshrrev_b32 v121, 8, v121
    v_mul_u32_u24 v123, 7, v121
    v_sub_u32 v123, v120, v123
    v_cmp_gt_u32 vcc, 4, v121
    s_nop 1
    v_cndmask_b32 v121, v109, v108, vcc
    v_cmp_gt_u32 vcc, 4, v123
    s_nop 1
    v_cndmask_b32 v123, v111, v110, vcc
    v_add3_u32 v10, v10, v121, v123
    v_mul_u32_u24 v121, s20, v120
    v_add_u32 v121, s38, v121
    v_mul_u32_u24 v121, 911, v121
    v_lshrrev_b32 v121, 16, v121
    v_mul_u32_u24 v121, s22, v121
    v_mad_u32_u24 v121, v120, s21, v121
    v_cmp_gt_u32 vcc, s17, v120
    v_add_u32 v121, s7, v121
    s_nop 0
    v_cndmask_b32 v121, v170, v121, vcc
    v_mul_u32_u24 v120, 384, v120
    v_sub_u32 v120, v122, v120
    v_add_u32 v121, v121, v120
    v_add_u32 v120, 256, v171
    v_mul_u32_u24 v122, 2731, v120
    v_bfe_u32 v123, v122, 17, 3
    v_lshrrev_b32 v122, 16, v122
    v_xor_b32 v120, v123, v120
    v_mul_u32_u24 v123, 37, v122
    v_lshrrev_b32 v123, 8, v123
    v_lshlrev_b32 v120, 4, v120
    v_mad_u32_u24 v11, v123, s69, v120
    v_mul_u32_u24 v123, 37, v122
    v_lshrrev_b32 v123, 8, v123
    v_mul_u32_u24 v132, 7, v123
    v_sub_u32 v132, v122, v132
    v_cmp_gt_u32 vcc, 4, v123
    s_nop 1
    v_cndmask_b32 v123, v109, v108, vcc
    v_cmp_gt_u32 vcc, 4, v132
    s_nop 1
    v_cndmask_b32 v132, v111, v110, vcc
    v_add3_u32 v11, v11, v123, v132
    v_mul_u32_u24 v123, s20, v122
    v_add_u32 v123, s38, v123
    v_mul_u32_u24 v123, 911, v123
    v_lshrrev_b32 v123, 16, v123
    v_mul_u32_u24 v123, s22, v123
    v_mad_u32_u24 v123, v122, s21, v123
    v_cmp_gt_u32 vcc, s17, v122
    v_add_u32 v123, s7, v123
    s_nop 0
    v_cndmask_b32 v123, v170, v123, vcc
    v_mul_u32_u24 v122, 384, v122
    v_sub_u32 v122, v120, v122
    v_add_u32 v123, v123, v122
    s_lshl_b32 s28, s16, 10
    s_add_u32 s28, s28, 20480
    v_and_b32 v120, 63, v0
    s_bfe_u32 s3, s2, 0x50003
    s_lshl_b32 s4, s16, 3
    s_lshr_b32 s98, 0x00001236, s4
    s_and_b32 s98, s98, 0xff
    s_mul_i32 s3, s3, s98
    s_lshr_b32 s4, 0x00051135, s4
    s_and_b32 s4, s4, 0xff
    v_min_u32 v132, s4, v120
    v_add_lshl_u32 v132, v132, s3, 7
    v_mov_b32 v133, 0
    s_add_u32 m0, s28, 128512
    s_waitcnt lgkmcnt(0)
    buffer_load_dwordx4 v121, s[8:11], 0 offen nt lds
    s_add_u32 m0, s28, 132608
    s_cmp_eq_u32 s16, 0
    s_cselect_b64 s[98:99], s[44:45], s[48:49]
    buffer_load_dwordx4 v123, s[8:11], 0 offen nt lds
    s_add_u32 m0, s28, 0
    s_cmp_eq_u32 s16, 2
    s_cselect_b64 s[98:99], s[52:53], s[98:99]
    buffer_load_dwordx4 v10, s[8:11], s25 offen nt lds
    s_add_u32 m0, s28, 4096
    s_cmp_eq_u32 s16, 3
    s_cselect_b64 s[98:99], s[56:57], s[98:99]
    buffer_load_dwordx4 v11, s[8:11], s25 offen nt lds
    v_lshl_add_u64 v[132:133], s[98:99], 0, v[132:133]
    v_writelane_b32 v132, s60, 62
    v_writelane_b32 v133, s61, 62
    v_writelane_b32 v132, s64, 63
    v_writelane_b32 v133, s65, 63
    global_load_dword a254, v[132:133], off
    v_lshrrev_b32 v121, 4, v120
    v_and_b32 v122, 15, v120
    s_mov_b32 s46, 221184
    s_mov_b32 s47, 0x00020000
    s_mov_b32 s50, 73728
    s_mov_b32 s51, 0x00020000
    s_mov_b32 s58, 64
    s_mov_b32 s59, 0x00020000
    s_mov_b32 s62, 128
    s_mov_b32 s63, 0x00020000
    s_mov_b32 s54, 676
    s_mov_b32 s55, 0x00020000
    s_mov_b32 s14, 0
    s_mov_b32 s15, 0x00020000
    v_mul_u32_u24 v123, 171, v120
    v_lshrrev_b32 v123, 10, v123
    v_lshrrev_b32 v132, 1, v123
    v_xor_b32 v132, v132, v123
    v_and_b32 v132, 4, v132
    v_mul_u32_u24 v132, 3, v132
    v_xor_b32 v132, v132, v123
    v_mul_u32_u24 v132, 1152, v132
    v_mul_u32_u24 v133, 96, v123
    v_sub_u32 v132, v132, v133
    v_lshl_add_u32 v133, v120, 4, v132
    v_add_u32 v132, 64, v120
    v_mul_u32_u24 v132, 171, v132
    v_lshrrev_b32 v132, 10, v132
    v_lshrrev_b32 v134, 1, v132
    v_xor_b32 v134, v134, v132
    v_and_b32 v134, 4, v134
    v_mul_u32_u24 v134, 3, v134
    v_xor_b32 v134, v134, v132
    v_mul_u32_u24 v134, 1152, v134
    v_mul_u32_u24 v135, 96, v132
    v_sub_u32 v134, v134, v135
    v_lshl_add_u32 v135, v120, 4, v134
    v_add_u32 v134, 128, v120
    v_mul_u32_u24 v134, 171, v134
    v_lshrrev_b32 v134, 10, v134
    v_lshrrev_b32 v136, 1, v134
    v_xor_b32 v136, v136, v134
    v_and_b32 v136, 4, v136
    v_mul_u32_u24 v136, 3, v136
    v_xor_b32 v136, v136, v134
    v_mul_u32_u24 v136, 1152, v136
    v_mul_u32_u24 v137, 96, v134
    v_sub_u32 v136, v136, v137
    v_lshl_add_u32 v137, v120, 4, v136
    s_mul_i32 s66, s16, 6144
    s_add_u32 s67, s66, 65536
    s_cmp_eq_u32 s16, 3
    s_cselect_b32 s66, 136704, s66
    s_cselect_b32 s67, 142848, s67
    s_mul_i32 s68, s16, 96
    s_add_u32 m0, s66, 0
    s_add_u32 s4, s68, 384
    buffer_load_dwordx4 v133, s[44:47], s4 offen lds
    v_mov_b32 v139, 0
    v_cmp_lt_u32 s[90:91], 7, v122
    v_mov_b32 v115, 0
    v_mov_b32 v169, 0
    v_mov_b32 v113, 0
    v_lshlrev_b32 v168, 1, v120
    v_mul_u32_u24 v136, 12, v122
    s_mul_i32 s70, s16, 192
    v_add_u32 v136, s70, v136
    v_lshlrev_b32 v116, 5, v121
    v_lshrrev_b32 v114, 2, v122
    v_and_b32 v112, 1, v114
    v_mul_u32_u24 v112, 0x020202, v112
    v_lshl_or_b32 v112, v112, 8, v112
    s_mov_b32 s73, 0x3f80
    s_mov_b32 s19, s38
    buffer_load_dwordx4 v135, s[44:47], s4 offen offset:1024 lds
    v_add_u32 v112, 0x05040100, v112
    v_and_b32 v117, 3, v122
    v_lshrrev_b32 v138, 1, v122
    v_xor_b32 v118, v138, v121
    v_mul_u32_u24 v138, 384, v122
    v_lshl_add_u32 v0, v118, 4, v138
    v_xor_b32 v1, 64, v0
    v_and_b32 v138, 2, v121
    v_add_u32 v138, v138, v121
    v_lshl_add_u32 v138, v138, 2, v114
    v_mul_u32_u24 v138, 96, v138
    v_lshl_add_u32 v138, v117, 3, v138
    v_add_u32 v118, s66, v138
    v_add_u32 v119, s67, v138
    s_mov_b32 s23, s25
    s_mov_b32 s26, 0
    buffer_load_dwordx4 v137, s[44:47], s4 offen offset:2048 lds
    s_add_u32 m0, s66, 3072
    s_add_u32 s4, s68, 37248
    v_mov_b32 v28, 0x3f803f80
    v_mov_b32 v29, 0x3f803f80
    v_mov_b32 v30, 0x3f803f80
    v_mov_b32 v31, 0x3f803f80
    v_mul_u32_u24 v124, 768, v121
    v_add_u32 v124, v136, v124
    v_add_u32 v124, 157184, v124
    v_and_b32 v138, 1, v122
    v_lshlrev_b32 v138, 4, v138
    v_lshlrev_b32 v126, v138, s73
    v_lshlrev_b32 v125, 4, v121
    s_mov_b32 s27, 0
    s_mov_b32 s18, 0
    s_add_u32 s19, s19, s20
    buffer_load_dwordx4 v133, s[44:47], s4 offen lds
    s_add_u32 s23, s23, s21
    s_cmp_ge_u32 s19, 72
    s_cselect_b32 s34, 72, 0
    s_cselect_b32 s35, s22, 0
    s_sub_u32 s19, s19, s34
    s_add_u32 s23, s23, s35
    s_mov_b32 s24, s23
    s_add_u32 s19, s19, s20
    s_add_u32 s23, s23, s21
    s_cmp_ge_u32 s19, 72
    s_cselect_b32 s34, 72, 0
    s_cselect_b32 s35, s22, 0
    s_sub_u32 s19, s19, s34
    s_add_u32 s23, s23, s35
    s_mul_i32 s76, s16, 64
    s_mul_i32 s77, s16, 32
    buffer_load_dwordx4 v135, s[44:47], s4 offen offset:1024 lds
    v_lshl_add_u32 v128, v121, 4, s76
    s_add_u32 s77, s77, 256
    v_lshl_add_u32 v127, v121, 3, s77
    v_add_u32 v131, 0, v122
    v_mul_u32_u24 v130, 37, v131
    v_mul_u32_u24 v129, 384, v131
    v_lshrrev_b32 v130, 8, v130
    v_mad_u32_u24 v129, v130, s69, v129
    v_add_u32 v15, v129, v128
    v_add_u32 v18, v129, v127
    v_mul_u32_u24 v129, 37, v131
    v_lshrrev_b32 v129, 8, v129
    v_mul_u32_u24 v140, 7, v129
    v_sub_u32 v140, v131, v140
    v_add_u32 v143, 16, v122
    v_mul_u32_u24 v141, 37, v143
    v_mul_u32_u24 v142, 384, v143
    v_lshrrev_b32 v141, 8, v141
    v_mad_u32_u24 v142, v141, s69, v142
    v_add_u32 v16, v142, v128
    v_add_u32 v19, v142, v127
    v_mul_u32_u24 v144, 37, v143
    v_lshrrev_b32 v144, 8, v144
    v_mul_u32_u24 v142, 7, v144
    v_sub_u32 v142, v143, v142
    v_add_u32 v146, 32, v122
    v_mul_u32_u24 v145, 37, v146
    v_mul_u32_u24 v147, 384, v146
    v_lshrrev_b32 v145, 8, v145
    v_mad_u32_u24 v147, v145, s69, v147
    v_add_u32 v17, v147, v128
    v_add_u32 v20, v147, v127
    v_mul_u32_u24 v127, 37, v146
    v_lshrrev_b32 v127, 8, v127
    v_mul_u32_u24 v147, 7, v127
    v_sub_u32 v147, v146, v147
    s_mul_i32 s78, s16, 768
    s_add_u32 s78, s78, 157184
    v_mul_u32_u24 v128, 24, v130
    v_lshl_add_u32 v128, v131, 2, v128
    v_add_u32 v22, s78, v128
    v_sub_u32 v23, s78, v128
    v_sub_u32 v128, v22, v125
    v_mul_u32_u24 v130, 24, v141
    v_lshl_add_u32 v130, v143, 2, v130
    v_add_u32 v24, s78, v130
    v_sub_u32 v25, s78, v130
    v_sub_u32 v141, v24, v125
    v_mul_u32_u24 v130, 24, v145
    v_lshl_add_u32 v130, v146, 2, v130
    v_add_u32 v26, s78, v130
    v_sub_u32 v27, s78, v130
    v_sub_u32 v145, v26, v125
    v_mul_u32_u24 v130, 148, v121
    s_mov_b32 s79, -24
    v_add_u32 v148, 0, v130
    v_lshrrev_b32 v148, 8, v148
    v_mad_i32_i24 v40, v148, s79, v128
    v_mad_i32_i24 v52, v148, s79, v141
    v_mad_i32_i24 v64, v148, s79, v145
    v_add_u32 v148, 37, v130
    v_lshrrev_b32 v148, 8, v148
    v_mad_i32_i24 v41, v148, s79, v128
    v_mad_i32_i24 v53, v148, s79, v141
    v_mad_i32_i24 v65, v148, s79, v145
    v_add_u32 v148, 74, v130
    v_lshrrev_b32 v148, 8, v148
    v_mad_i32_i24 v42, v148, s79, v128
    v_mad_i32_i24 v54, v148, s79, v141
    v_mad_i32_i24 v66, v148, s79, v145
    v_add_u32 v148, 111, v130
    v_lshrrev_b32 v148, 8, v148
    v_mad_i32_i24 v43, v148, s79, v128
    v_mad_i32_i24 v55, v148, s79, v141
    v_mad_i32_i24 v67, v148, s79, v145
    v_add_u32 v148, 592, v130
    v_lshrrev_b32 v148, 8, v148
    v_mad_i32_i24 v44, v148, s79, v128
    v_mad_i32_i24 v56, v148, s79, v141
    v_mad_i32_i24 v68, v148, s79, v145
    v_add_u32 v148, 629, v130
    v_lshrrev_b32 v148, 8, v148
    v_mad_i32_i24 v45, v148, s79, v128
    v_mad_i32_i24 v57, v148, s79, v141
    v_mad_i32_i24 v69, v148, s79, v145
    v_add_u32 v148, 666, v130
    v_lshrrev_b32 v148, 8, v148
    v_mad_i32_i24 v46, v148, s79, v128
    v_mad_i32_i24 v58, v148, s79, v141
    v_mad_i32_i24 v70, v148, s79, v145
    v_add_u32 v148, 703, v130
    v_lshrrev_b32 v148, 8, v148
    v_mad_i32_i24 v47, v148, s79, v128
    v_mad_i32_i24 v59, v148, s79, v141
    v_mad_i32_i24 v71, v148, s79, v145
    v_add_u32 v148, 1184, v130
    v_lshrrev_b32 v148, 8, v148
    v_mad_i32_i24 v48, v148, s79, v128
    v_mad_i32_i24 v60, v148, s79, v141
    v_mad_i32_i24 v72, v148, s79, v145
    v_add_u32 v148, 1221, v130
    v_lshrrev_b32 v148, 8, v148
    v_mad_i32_i24 v49, v148, s79, v128
    v_mad_i32_i24 v61, v148, s79, v141
    v_mad_i32_i24 v73, v148, s79, v145
    v_add_u32 v148, 1258, v130
    v_lshrrev_b32 v148, 8, v148
    v_mad_i32_i24 v50, v148, s79, v128
    v_mad_i32_i24 v62, v148, s79, v141
    v_mad_i32_i24 v74, v148, s79, v145
    v_add_u32 v130, 1295, v130
    v_lshrrev_b32 v130, 8, v130
    v_mad_i32_i24 v51, v130, s79, v128
    v_mad_i32_i24 v63, v130, s79, v141
    v_mad_i32_i24 v75, v130, s79, v145
    v_mov_b32 v145, s78
    v_lshlrev_b32 v141, 4, v120
    v_xor_b32 v2, 65536, v141
    v_lshl_add_u32 v3, s16, 10, v141
    s_lshr_b32 s80, s16, 1
    s_and_b32 s81, s16, 1
    s_lshl_b32 s81, s81, 3
    s_lshl_b32 s82, s80, 10
    s_add_u32 s82, s82, s81
    v_add_u32 v4, s82, v141
    s_lshl_b32 s80, s80, 11
    s_add_u32 s80, s80, s81
    s_add_u32 s80, s80, 144896
    s_mul_i32 s83, s16, 2048
    s_add_u32 s83, s83, 136704
    v_lshl_add_u32 v141, v121, 3, s83
    v_mov_b32 v130, s80
    v_mov_b32 v128, 161536
    s_mul_i32 s84, s16, 8064
    s_add_u32 s84, s84, 104448
    s_mul_i32 s85, s16, 6528
    s_add_u32 s85, s85, 38912
    v_mul_u32_u24 v148, 80, v121
    v_add3_u32 v5, v148, v138, s84
    v_lshl_add_u32 v6, v122, 2, s85
    s_mul_i32 s86, s16, 128
    s_add_u32 s86, s86, 65024
    v_add_u32 v9, s86, v125
    v_lshrrev_b32 v138, 1, v121
    v_mul_u32_u24 v138, 48, v138
    v_lshl_add_u32 v138, v121, 3, v138
    v_lshl_add_u32 v138, v114, 4, v138
    v_lshl_add_u32 v138, v117, 1, v138
    v_add_u32 v8, s86, v138
    v_mov_b32 v37, 0
    v_mov_b32 v38, 0
    v_mov_b32 v39, 0
    s_mov_b32 s40, s8
    s_mov_b32 s42, s12
    s_mov_b32 s41, s9
    s_mov_b32 s43, s13
    s_mov_b32 s32, 0x2a8cbccc
    s_mov_b32 s33, 0x38fba882
    v_add_u32 v152, 148992, v0
    v_add_u32 v155, 148992, v1
    v_lshlrev_b32 v149, 4, v122
    v_add_u32 v149, 160256, v149
    v_mul_u32_u24 v153, 336, v122
    v_add3_u32 v153, v153, v148, s84
    v_mul_u32_u24 v156, 272, v122
    v_add3_u32 v156, v156, v125, s85
    v_mul_u32_u24 v154, 1088, v121
    v_add_u32 v154, v154, v6
    v_add_u32 v157, 5376, v153
    v_add_u32 v159, 4352, v156
    v_add_u32 v158, 4352, v154
    v_cmp_gt_u32 s[88:89], 16, v120
    v_mov_b32 v164, 0xf149f2ca
    v_add_u32 v138, 512, v171
    v_mul_u32_u24 v150, 2731, v138
    v_bfe_u32 v148, v150, 17, 3
    v_lshrrev_b32 v150, 16, v150
    v_xor_b32 v138, v148, v138
    v_mul_u32_u24 v148, 37, v150
    v_lshrrev_b32 v148, 8, v148
    v_lshlrev_b32 v138, 4, v138
    v_mad_u32_u24 v12, v148, s69, v138
    v_mul_u32_u24 v148, 37, v150
    v_lshrrev_b32 v148, 8, v148
    v_mul_u32_u24 v138, 7, v148
    v_sub_u32 v138, v150, v138
    v_cmp_gt_u32 vcc, 4, v148
    v_add_u32 v150, 768, v171
    v_mul_u32_u24 v151, 2731, v150
    v_cndmask_b32 v148, v109, v108, vcc
    v_cmp_gt_u32 vcc, 4, v138
    v_bfe_u32 v165, v151, 17, 3
    v_lshrrev_b32 v151, 16, v151
    v_cndmask_b32 v138, v111, v110, vcc
    v_add3_u32 v12, v12, v148, v138
    v_xor_b32 v150, v165, v150
    v_mul_u32_u24 v165, 37, v151
    v_lshrrev_b32 v165, 8, v165
    v_lshlrev_b32 v150, 4, v150
    v_mad_u32_u24 v13, v165, s69, v150
    v_mul_u32_u24 v138, 37, v151
    v_lshrrev_b32 v138, 8, v138
    v_mul_u32_u24 v148, 7, v138
    v_sub_u32 v148, v151, v148
    v_cmp_gt_u32 vcc, 4, v138
    v_add_u32 v151, 1024, v171
    v_mul_u32_u24 v171, 2731, v151
    v_cndmask_b32 v138, v109, v108, vcc
    v_cmp_gt_u32 vcc, 4, v148
    v_bfe_u32 v150, v171, 17, 3
    v_lshrrev_b32 v171, 16, v171
    v_cndmask_b32 v148, v111, v110, vcc
    v_add3_u32 v13, v13, v138, v148
    v_xor_b32 v151, v150, v151
    v_mul_u32_u24 v150, 37, v171
    v_lshrrev_b32 v150, 8, v150
    v_lshlrev_b32 v151, 4, v151
    v_mad_u32_u24 v14, v150, s69, v151
    v_mul_u32_u24 v138, 37, v171
    v_lshrrev_b32 v138, 8, v138
    v_mul_u32_u24 v148, 7, v138
    v_sub_u32 v148, v171, v148
    s_add_u32 s71, s28, 16384
    s_cmp_lt_u32 s16, 2
    s_waitcnt vmcnt(4)
    s_barrier
    buffer_load_dwordx4 v137, s[44:47], s4 offen offset:2048 lds
    v_mov_b32 v165, s16
    v_lshlrev_b32 v165, 1, v165
    v_cmp_gt_u32 vcc, 4, v138
    s_cselect_b32 s29, s71, 160256
    s_cselect_b32 s30, 65536, 0
    s_add_u32 m0, s67, 0
    s_add_u32 s4, s68, 74112
    v_cndmask_b32 v138, v109, v108, vcc
    v_cmp_gt_u32 vcc, 4, v148
    s_xor_b32 s72, s29, s30
    s_lshl_b32 s92, s5, 1
    v_cndmask_b32 v148, v111, v110, vcc
    v_add3_u32 v14, v14, v138, v148
    v_cmp_gt_u32 vcc, 48, v171
    s_or_b32 s92, s92, s6
    s_mul_i32 s74, s16, 64
    buffer_load_dwordx4 v133, s[44:47], s4 offen lds
    v_cndmask_b32 v14, v170, v14, vcc
    v_cmp_gt_u32 vcc, 2, v117
    v_mov_b32 v167, 0xc31044fe
    v_mul_u32_u24 v166, 37, v131
    v_cndmask_b32 v32, 0, v126, vcc
    v_cndmask_b32 v33, v126, 0, vcc
    v_cndmask_b32 v34, 0, v126, vcc
    v_cndmask_b32 v35, v126, 0, vcc
    v_cmp_eq_u32 vcc, v121, v114
    v_lshrrev_b32 v166, 8, v166
    v_mul_u32_u24 v126, 7, v166
    v_cndmask_b32 v170, 0, v32, vcc
    s_waitcnt vmcnt(4)
    s_mul_i32 s75, s16, 32
    ds_read_b64_tr_b16 a[72:73], v118 offset:0
    ds_read_b64_tr_b16 a[74:75], v118 offset:768
    buffer_load_dwordx4 v135, s[44:47], s4 offen offset:1024 lds
    ds_read_b64_tr_b16 a[96:97], v118 offset:32
    ds_read_b64_tr_b16 a[98:99], v118 offset:800
    ds_read_b64_tr_b16 a[120:121], v118 offset:64
    ds_read_b64_tr_b16 a[122:123], v118 offset:832
    v_cndmask_b32 v171, 0, v33, vcc
    v_sub_u32 v126, v131, v126
    v_lshrrev_b32 v166, 2, v166
    v_lshrrev_b32 v126, 2, v126
    v_and_b32 v166, s5, v166
    v_and_b32 v126, s6, v126
    v_lshl_or_b32 v166, v166, 1, v126
    v_mul_u32_u24 v126, 37, v143
    v_lshrrev_b32 v126, 8, v126
    v_mul_u32_u24 v131, 7, v126
    s_add_u32 s75, s75, 192
    s_add_u32 s34, s18, 2
    buffer_load_dwordx4 v137, s[44:47], s4 offen offset:2048 lds
    s_add_u32 m0, s67, 3072
    s_add_u32 s4, s68, 110976
    v_sub_u32 v131, v143, v131
    v_lshrrev_b32 v126, 2, v126
    v_lshrrev_b32 v131, 2, v131
    v_and_b32 v126, s5, v126
    v_and_b32 v131, s6, v131
    v_lshl_or_b32 v126, v126, 1, v131
    v_mul_u32_u24 v131, 37, v146
    v_lshrrev_b32 v131, 8, v131
    v_mul_u32_u24 v138, 7, v131
    v_sub_u32 v138, v146, v138
    v_lshrrev_b32 v131, 2, v131
    v_lshrrev_b32 v138, 2, v138
    s_mov_b32 s27, s26
    s_mov_b32 s26, s25
    buffer_load_dwordx4 v133, s[44:47], s4 offen lds
    v_and_b32 v131, s5, v131
    v_and_b32 v138, s6, v138
    v_lshl_or_b32 v131, v131, 1, v138
    v_mul_u32_u24 v143, 6, v123
    v_sub_u32 v138, v120, v143
    v_mul_u32_u24 v143, 384, v123
    v_lshl_add_u32 v143, v138, 4, v143
    v_add_u32 v123, s75, v143
    v_add_u32 v143, s74, v143
    v_cmp_gt_i32 vcc, 4, v138
    v_mul_u32_u24 v146, 6, v132
    v_sub_u32 v138, v120, v146
    v_cndmask_b32 v123, v123, v143, vcc
    v_mul_u32_u24 v146, 384, v132
    s_add_u32 s19, s19, s20
    s_mov_b32 s18, 1
    buffer_load_dwordx4 v135, s[44:47], s4 offen offset:1024 lds
    v_lshl_add_u32 v146, v138, 4, v146
    v_add_u32 v132, s75, v146
    v_add_u32 v146, s74, v146
    v_cmp_gt_i32 vcc, -60, v138
    v_mul_u32_u24 v138, 6, v134
    v_sub_u32 v143, v120, v138
    v_cndmask_b32 v120, v132, v146, vcc
    v_mul_u32_u24 v138, 384, v134
    v_lshl_add_u32 v138, v143, 4, v138
    v_add_u32 v146, s75, v138
    v_add_u32 v138, s74, v138
    v_cmp_gt_i32 vcc, -124, v143
    v_mul_u32_u24 v143, 96, v122
    v_add3_u32 v132, v143, v125, s66
    buffer_load_dwordx4 v137, s[44:47], s4 offen offset:2048 lds
    s_add_u32 m0, s66, 0
    s_add_u32 s4, s68, 147840
    s_waitcnt lgkmcnt(0)
    v_cndmask_b32 v134, v146, v138, vcc
    v_cmp_gt_u32 vcc, 4, v129
    v_lshl_add_u32 v146, v121, 3, v143
    v_add3_u32 v146, v146, 64, s66
    v_cndmask_b32 v129, v109, v108, vcc
    v_cmp_gt_u32 vcc, 4, v140
    v_add3_u32 v180, v143, v125, s67
    v_lshl_add_u32 v143, v121, 3, v143
    v_cndmask_b32 v140, v111, v110, vcc
    v_add3_u32 v15, v15, v129, v140
    v_add3_u32 v18, v18, v129, v140
    buffer_load_ushort v138, v168, s[56:59], 0 offen
    s_waitcnt vmcnt(7)
    ds_read_b64_tr_b16 a[76:77], v118 offset:3072
    ds_read_b64_tr_b16 a[78:79], v118 offset:3840
    buffer_load_dwordx3 v[176:178], v136, s[52:55], 0 offen
    ds_read_b64_tr_b16 a[100:101], v118 offset:3104
    ds_read_b64_tr_b16 a[102:103], v118 offset:3872
    ds_read_b64_tr_b16 a[124:125], v118 offset:3136
    buffer_load_dwordx4 v[204:207], v116, s[60:63], 0 offen
    ds_read_b64_tr_b16 a[126:127], v118 offset:3904
    buffer_load_dwordx4 v[184:187], v116, s[60:63], 0 offen offset:16
    v_cmp_gt_u32 vcc, 4, v144
    v_add3_u32 v143, v143, 64, s67
    global_load_ushort v165, v165, s[64:65]
    v_cndmask_b32 v144, v109, v108, vcc
    v_cmp_gt_u32 vcc, 4, v142
    v_mov_b32 v196, 0
    v_mov_b32 v197, 0
    v_cndmask_b32 v142, v111, v110, vcc
    v_add3_u32 v16, v16, v144, v142
    v_add3_u32 v19, v19, v144, v142
    v_cmp_gt_u32 vcc, 4, v127
    v_mov_b32 v198, 0
    v_mov_b32 v199, 0
    v_cndmask_b32 v127, v109, v108, vcc
    v_cmp_gt_u32 vcc, 4, v147
    ds_write_b128 v153, v[196:199] offset:16
    buffer_load_dwordx4 v133, s[44:47], s4 offen lds
    v_cndmask_b32 v147, v111, v110, vcc
    v_add3_u32 v17, v17, v127, v147
    v_add3_u32 v20, v20, v127, v147
    v_cmp_gt_u32 vcc, 2, v121
    s_nop 0
    ds_write_b64 v153, v[196:197] offset:56
    v_cndmask_b32 v141, v130, v141, vcc
    v_lshl_add_u32 v141, v114, 9, v141
    v_lshl_add_u32 v141, v117, 1, v141
    v_cmp_gt_u32 vcc, 3, v121
    s_waitcnt vmcnt(9)
    buffer_load_dwordx4 v135, s[44:47], s4 offen offset:1024 lds
    ds_read_b64_tr_b16 a[80:81], v119 offset:0
    ds_read_b64_tr_b16 a[82:83], v119 offset:768
    ds_read_b64_tr_b16 a[104:105], v119 offset:32
    ds_read_b64_tr_b16 a[106:107], v119 offset:800
    ds_read_b64_tr_b16 a[128:129], v119 offset:64
    ds_read_b64_tr_b16 a[130:131], v119 offset:832
    ds_write_b64 v153, v[196:197] offset:64
    v_cndmask_b32 v7, v128, v141, vcc
    v_cmp_gt_u32 vcc, 8, v122
    s_nop 0
    s_nop 0
    v_cndmask_b32 v157, v149, v157, vcc
    buffer_load_dwordx4 v137, s[44:47], s4 offen offset:2048 lds
    ds_write_b128 v157, v[196:199] offset:16
    s_add_u32 m0, s66, 3072
    s_add_u32 s4, s68, 184704
    s_waitcnt lgkmcnt(8)
    v_cndmask_b32 v159, v149, v159, vcc
    v_cmp_gt_u32 vcc, 2, v121
    s_nop 0
    s_nop 0
    v_cndmask_b32 v158, v149, v158, vcc
    v_cmp_ne_u32 vcc, s92, v166
    buffer_load_dwordx4 v133, s[44:47], s4 offen lds
    ds_write_b64 v157, v[196:197] offset:56
    v_cndmask_b32 v122, 0, v167, vcc
    v_cmp_ne_u32 vcc, s92, v166
    ds_write_b64 v157, v[196:197] offset:64
    s_nop 0
    v_cndmask_b32 v116, 0, v167, vcc
    v_cmp_ne_u32 vcc, s92, v126
    s_nop 0
    s_waitcnt vmcnt(9)
    ds_read_b64_tr_b16 a[84:85], v119 offset:3072
    buffer_load_dwordx4 v135, s[44:47], s4 offen offset:1024 lds
    ds_read_b64_tr_b16 a[86:87], v119 offset:3840
    ds_read_b64_tr_b16 a[108:109], v119 offset:3104
    ds_read_b64_tr_b16 a[110:111], v119 offset:3872
    ds_read_b64_tr_b16 a[132:133], v119 offset:3136
    ds_read_b64_tr_b16 a[134:135], v119 offset:3904
    v_cndmask_b32 v144, 0, v167, vcc
    v_cmp_ne_u32 vcc, s92, v126
    s_nop 0
    s_nop 0
    v_cndmask_b32 v117, 0, v167, vcc
    v_cmp_ne_u32 vcc, s92, v131
    s_nop 0
    s_nop 0
    v_cndmask_b32 v147, 0, v167, vcc
    buffer_load_dwordx4 v137, s[44:47], s4 offen offset:2048 lds
    s_waitcnt vmcnt(9)
    s_add_u32 m0, s67, 0
    s_waitcnt lgkmcnt(6)
    s_add_u32 s4, s68, 36864
    s_waitcnt vmcnt(8)
    v_cndmask_b32 v204, v204, v205, s[90:91]
    v_cndmask_b32 v206, v206, v207, s[90:91]
    v_perm_b32 v128, v206, v204, v112
    s_waitcnt vmcnt(7)
    v_cndmask_b32 v184, v184, v185, s[90:91]
    v_cndmask_b32 v186, v186, v187, s[90:91]
    v_perm_b32 v129, v186, v184, v112
    v_bfe_u32 v114, v176, v125, 16
    s_waitcnt vmcnt(6)
    buffer_load_dwordx4 v133, s[44:47], s68 offen lds
    v_mfma_f32_16x16x16_bf16 v[204:207], v[138:139], v[114:115], 0
    v_bfe_u32 v168, v177, v125, 16
    v_bfe_u32 v112, v178, v125, 16
    v_lshlrev_b32 v165, 16, v165
    v_mfma_f32_16x16x16_bf16 v[176:179], v[138:139], v[168:169], 0
    v_max_f32 v165, 0xc2c80000, v165
    v_min_f32 v165, 0x40930000, v165
    v_mul_f32 v165, 0x3fb8aa3b, v165
    v_mfma_f32_16x16x16_bf16 v[148:151], v[138:139], v[112:113], 0
    v_max_f32 v204, 0, v204
    v_max_f32 v205, 0, v205
    v_max_f32 v206, 0, v206
    v_max_f32 v207, 0, v207
    v_cvt_pk_bf16_f32 v168, v204, v205
    buffer_load_dwordx4 v135, s[44:47], s68 offen offset:1024 lds
    v_cvt_pk_bf16_f32 v169, v206, v207
    v_max_f32 v176, 0, v176
    v_max_f32 v177, 0, v177
    v_mfma_f32_16x16x16_bf16 v[112:115], v[128:129], v[168:169], 0
    v_max_f32 v178, 0, v178
    v_max_f32 v179, 0, v179
    v_cvt_pk_bf16_f32 v168, v176, v177
    v_cvt_pk_bf16_f32 v169, v178, v179
    v_max_f32 v148, 0, v148
    v_max_f32 v149, 0, v149
    v_mfma_f32_16x16x16_bf16 v[176:179], v[128:129], v[168:169], 0
    v_max_f32 v150, 0, v150
    v_cvt_pk_bf16_f32 v112, v112, v112
    v_and_b32 v112, 0xffff0000, v112
    buffer_load_dwordx4 v137, s[44:47], s68 offen offset:2048 lds
    s_add_u32 m0, s67, 3072
    s_waitcnt lgkmcnt(0)
    v_mul_f32 v112, 0xbfb8aa3b, v112
    v_exp_f32 v112, v112
    v_cvt_pk_bf16_f32 v176, v176, v176
    v_add_f32 v112, 1.0, v112
    v_rcp_f32 v112, v112
    v_and_b32 v176, 0xffff0000, v176
    v_cvt_pk_bf16_f32 v112, v112, v112
    v_and_b32 v112, 0xffff0000, v112
    v_add_f32 v112, -0.5, v112
    v_mul_f32 v112, 0x41b8aa3b, v112
    buffer_load_dwordx4 v133, s[44:47], s4 offen lds
    s_waitcnt vmcnt(7)
    ds_read_b64_tr_b16 a[88:89], v118 offset:0
    ds_read_b64_tr_b16 a[90:91], v118 offset:768
    ds_read_b64_tr_b16 a[112:113], v118 offset:32
    ds_read_b64_tr_b16 a[114:115], v118 offset:800
    ds_read_b64_tr_b16 a[136:137], v118 offset:64
    ds_read_b64_tr_b16 a[138:139], v118 offset:832
    ds_write_b32 v124, v112 offset:0
    v_mul_f32 v176, 0xbfb8aa3b, v176
    v_exp_f32 v176, v176
    v_max_f32 v151, 0, v151
    v_add_f32 v176, 1.0, v176
    buffer_load_dwordx4 v135, s[44:47], s4 offen offset:1024 lds
    v_rcp_f32 v176, v176
    v_cvt_pk_bf16_f32 v168, v148, v149
    v_cvt_pk_bf16_f32 v176, v176, v176
    v_and_b32 v176, 0xffff0000, v176
    v_add_f32 v176, -0.5, v176
    v_mul_f32 v176, 0x41b8aa3b, v176
    ds_write_b32 v124, v176 offset:4
    v_cvt_pk_bf16_f32 v169, v150, v151
    v_exp_f32 v165, v165
    buffer_load_dwordx4 v137, s[44:47], s4 offen offset:2048 lds
    v_mfma_f32_16x16x16_bf16 v[112:115], v[128:129], v[168:169], 0
    s_add_u32 m0, s66, 0
    s_add_u32 s4, s68, 73728
    s_waitcnt lgkmcnt(1)
    v_cvt_pk_bf16_f32 v165, v165, v165
    v_and_b32 v165, 0xffff0000, v165
    v_mul_f32 v125, 0x3fb8aa3b, v165
    v_readfirstlane_b32 s37, v165
    v_readfirstlane_b32 s31, v125
    v_cvt_pk_bf16_f32 v112, v112, v112
    v_and_b32 v112, 0xffff0000, v112
    v_mul_f32 v112, 0xbfb8aa3b, v112
    v_exp_f32 v112, v112
    buffer_load_dwordx4 v133, s[44:47], s4 offen lds
    s_waitcnt vmcnt(7)
    ds_read_b64_tr_b16 a[92:93], v118 offset:3072
    ds_read_b64_tr_b16 a[94:95], v118 offset:3840
    ds_read_b64_tr_b16 a[116:117], v118 offset:3104
    ds_read_b64_tr_b16 a[118:119], v118 offset:3872
    ds_read_b64_tr_b16 a[140:141], v118 offset:3136
    ds_read_b64_tr_b16 a[142:143], v118 offset:3904
    v_add_f32 v112, 1.0, v112
    v_rcp_f32 v112, v112
    v_cmp_ne_u32 vcc, s92, v131
    v_cvt_pk_bf16_f32 v112, v112, v112
    v_and_b32 v112, 0xffff0000, v112
    v_add_f32 v112, -0.5, v112
    buffer_load_dwordx4 v135, s[44:47], s4 offen offset:1024 lds
    v_mul_f32 v112, 0x41b8aa3b, v112
    ds_write_b32 v124, v112 offset:8
    v_cndmask_b32 v165, 0, v167, vcc
    buffer_load_dwordx4 v137, s[44:47], s4 offen offset:2048 lds
    s_add_u32 m0, s66, 3072
    s_add_u32 s4, s68, 110592
    s_waitcnt lgkmcnt(1)
    s_waitcnt lgkmcnt(0)
    s_barrier
    ds_read_b32 v22, v22 offset:0
    s_waitcnt vmcnt(6)
    buffer_load_dwordx4 v133, s[44:47], s4 offen lds
    ds_read_b64_tr_b16 a[0:1], v119 offset:0
    ds_read_b64_tr_b16 a[2:3], v119 offset:768
    ds_read_b64_tr_b16 a[24:25], v119 offset:32
    ds_read_b64_tr_b16 a[26:27], v119 offset:800
    ds_read_b64_tr_b16 a[48:49], v119 offset:64
    ds_read_b64_tr_b16 a[50:51], v119 offset:832
    ds_read_b32 v23, v23 offset:672
    ds_read_b32 v24, v24 offset:0
    ds_read_b32 v25, v25 offset:672
    ds_read_b32 v26, v26 offset:0
    ds_read_b32 v27, v27 offset:672
    buffer_load_dwordx4 v135, s[44:47], s4 offen offset:1024 lds
    ds_read_b32 v40, v40 offset:336
    ds_read_b32 v52, v52 offset:336
    ds_read_b32 v64, v64 offset:336
    ds_read_b32 v41, v41 offset:332
    ds_read_b32 v53, v53 offset:332
    s_waitcnt lgkmcnt(15)
    ds_read_b32 v65, v65 offset:332
    ds_read_b32 v42, v42 offset:328
    ds_read_b32 v54, v54 offset:328
    ds_read_b32 v66, v66 offset:328
    buffer_load_dwordx4 v137, s[44:47], s4 offen offset:2048 lds
    s_waitcnt lgkmcnt(12)
    s_waitcnt lgkmcnt(11)
    ds_read_b32 v43, v43 offset:324
    s_waitcnt lgkmcnt(11)
    ds_read_b32 v55, v55 offset:324
    s_waitcnt lgkmcnt(11)
    ds_read_b32 v67, v67 offset:324
    ds_read_b32 v44, v44 offset:272
    ds_read_b32 v56, v56 offset:272
    ds_read_b32 v68, v68 offset:272
    ds_read_b32 v45, v45 offset:268
    ds_read_b32 v57, v57 offset:268
    s_add_u32 m0, s67, 0
    ds_read_b32 v69, v69 offset:268
    s_add_u32 s4, s68, 147456
    s_waitcnt vmcnt(6)
    buffer_load_dwordx4 v133, s[44:47], s4 offen lds
    ds_read_b64_tr_b16 a[4:5], v119 offset:3072
    ds_read_b64_tr_b16 a[6:7], v119 offset:3840
    ds_read_b64_tr_b16 a[28:29], v119 offset:3104
    ds_read_b64_tr_b16 a[30:31], v119 offset:3872
    ds_read_b64_tr_b16 a[52:53], v119 offset:3136
    ds_read_b64_tr_b16 a[54:55], v119 offset:3904
    ds_read_b32 v46, v46 offset:264
    ds_read_b32 v58, v58 offset:264
    ds_read_b32 v70, v70 offset:264
    buffer_load_dwordx4 v135, s[44:47], s4 offen offset:1024 lds
    ds_read_b32 v47, v47 offset:260
    ds_read_b32 v59, v59 offset:260
    ds_read_b32 v71, v71 offset:260
    ds_read_b32 v48, v48 offset:208
    ds_read_b32 v60, v60 offset:208
    ds_read_b32 v72, v72 offset:208
    ds_read_b32 v49, v49 offset:204
    ds_read_b32 v61, v61 offset:204
    ds_read_b32 v73, v73 offset:204
    buffer_load_dwordx4 v137, s[44:47], s4 offen offset:2048 lds
    ds_read_b32 v50, v50 offset:200
    ds_read_b32 v62, v62 offset:200
    ds_read_b32 v74, v74 offset:200
    ds_read_b32 v51, v51 offset:196
    s_add_u32 m0, s67, 3072
    ds_read_b32 v63, v63 offset:196
    s_add_u32 s4, s68, 184320
    s_waitcnt lgkmcnt(14)
    ds_read_b32 v75, v75 offset:196
    ds_read_b32 v145, v145 offset:336
    v_add_f32 v22, v22, v122
    v_add_f32 v23, v23, v116
    v_add_f32 v24, v24, v144
    v_add_f32 v25, v25, v117
    buffer_load_dwordx4 v133, s[44:47], s4 offen lds
    s_waitcnt vmcnt(7)
    ds_read_b64_tr_b16 a[8:9], v118 offset:0
    ds_read_b64_tr_b16 a[10:11], v118 offset:768
    ds_read_b64_tr_b16 a[32:33], v118 offset:32
    ds_read_b64_tr_b16 a[34:35], v118 offset:800
    ds_read_b64_tr_b16 a[56:57], v118 offset:64
    ds_read_b64_tr_b16 a[58:59], v118 offset:832
    v_add_f32 v26, v26, v147
    v_add_f32 v27, v27, v165
    v_lshl_add_u32 v122, v121, 2, 0
    v_mul_u32_u24 v165, 37, v122
    v_lshrrev_b32 v165, 8, v165
    v_mul_u32_u24 v116, 7, v165
    v_sub_u32 v116, v122, v116
    buffer_load_dwordx4 v135, s[44:47], s4 offen offset:1024 lds
    v_lshrrev_b32 v165, 2, v165
    s_waitcnt lgkmcnt(6)
    v_readfirstlane_b32 s39, v145
    v_lshrrev_b32 v116, 2, v116
    v_and_b32 v165, s5, v165
    v_and_b32 v116, s6, v116
    v_lshl_or_b32 v165, v165, 1, v116
    v_cmp_ne_u32 vcc, v165, v166
    v_lshl_add_u32 v122, v121, 2, 1
    v_mul_u32_u24 v116, 37, v122
    v_cndmask_b32 v117, 0, v167, vcc
    v_add_f32 v40, v40, v117
    v_cmp_ne_u32 vcc, v165, v126
    v_lshrrev_b32 v116, 8, v116
    buffer_load_dwordx4 v137, s[44:47], s4 offen offset:2048 lds
    s_add_u32 m0, s66, 0
    s_add_u32 s4, s68, 768
    s_waitcnt lgkmcnt(0)
    v_cndmask_b32 v117, 0, v167, vcc
    v_add_f32 v52, v52, v117
    v_cmp_ne_u32 vcc, v165, v131
    v_mul_u32_u24 v117, 7, v116
    v_sub_u32 v117, v122, v117
    v_cndmask_b32 v122, 0, v167, vcc
    v_add_f32 v64, v64, v122
    v_lshrrev_b32 v116, 2, v116
    v_lshrrev_b32 v117, 2, v117
    v_and_b32 v116, s5, v116
    v_and_b32 v117, s6, v117
    buffer_load_dwordx4 v133, s[44:47], s4 offen lds
    s_waitcnt vmcnt(7)
    ds_read_b64_tr_b16 a[12:13], v118 offset:3072
    ds_read_b64_tr_b16 a[14:15], v118 offset:3840
    ds_read_b64_tr_b16 a[36:37], v118 offset:3104
    ds_read_b64_tr_b16 a[38:39], v118 offset:3872
    ds_read_b64_tr_b16 a[60:61], v118 offset:3136
    ds_read_b64_tr_b16 a[62:63], v118 offset:3904
    v_lshl_or_b32 v116, v116, 1, v117
    v_cmp_ne_u32 vcc, v116, v166
    v_lshl_add_u32 v122, v121, 2, 2
    v_mul_u32_u24 v165, 37, v122
    v_cndmask_b32 v117, 0, v167, vcc
    v_add_f32 v41, v41, v117
    v_cmp_ne_u32 vcc, v116, v126
    buffer_load_dwordx4 v135, s[44:47], s4 offen offset:1024 lds
    v_lshrrev_b32 v165, 8, v165
    v_cndmask_b32 v117, 0, v167, vcc
    v_add_f32 v53, v53, v117
    v_cmp_ne_u32 vcc, v116, v131
    v_mul_u32_u24 v116, 7, v165
    v_sub_u32 v116, v122, v116
    v_cndmask_b32 v122, 0, v167, vcc
    v_add_f32 v65, v65, v122
    v_lshrrev_b32 v165, 2, v165
    v_lshrrev_b32 v116, 2, v116
    v_and_b32 v165, s5, v165
    v_and_b32 v116, s6, v116
    v_lshl_or_b32 v165, v165, 1, v116
    v_cmp_ne_u32 vcc, v165, v166
    buffer_load_dwordx4 v137, s[44:47], s4 offen offset:2048 lds
    s_add_u32 m0, s66, 3072
    s_add_u32 s4, s68, 37632
    s_waitcnt lgkmcnt(0)
    v_cndmask_b32 v122, 0, v167, vcc
    v_add_f32 v42, v42, v122
    v_cmp_ne_u32 vcc, v165, v126
    v_lshl_add_u32 v116, v121, 2, 3
    v_mul_u32_u24 v117, 37, v116
    v_cndmask_b32 v122, 0, v167, vcc
    v_add_f32 v54, v54, v122
    v_cmp_ne_u32 vcc, v165, v131
    v_lshrrev_b32 v117, 8, v117
    v_mul_u32_u24 v122, 7, v117
    v_cndmask_b32 v165, 0, v167, vcc
    buffer_load_dwordx4 v133, s[44:47], s4 offen lds
    s_waitcnt vmcnt(7)
    ds_read_b64_tr_b16 a[16:17], v119 offset:0
    ds_read_b64_tr_b16 a[18:19], v119 offset:768
    ds_read_b64_tr_b16 a[40:41], v119 offset:32
    ds_read_b64_tr_b16 a[42:43], v119 offset:800
    ds_read_b64_tr_b16 a[64:65], v119 offset:64
    ds_read_b64_tr_b16 a[66:67], v119 offset:832
    v_add_f32 v66, v66, v165
    v_sub_u32 v122, v116, v122
    v_lshrrev_b32 v117, 2, v117
    v_lshrrev_b32 v122, 2, v122
    v_and_b32 v117, s5, v117
    v_and_b32 v122, s6, v122
    v_lshl_or_b32 v117, v117, 1, v122
    buffer_load_dwordx4 v135, s[44:47], s4 offen offset:1024 lds
    v_cmp_ne_u32 vcc, v117, v166
    v_lshl_add_u32 v122, v121, 2, 16
    v_mul_u32_u24 v165, 37, v122
    v_cndmask_b32 v116, 0, v167, vcc
    v_add_f32 v43, v43, v116
    v_cmp_ne_u32 vcc, v117, v126
    v_lshrrev_b32 v165, 8, v165
    v_mul_u32_u24 v116, 7, v165
    v_cndmask_b32 v168, 0, v167, vcc
    v_add_f32 v55, v55, v168
    v_cmp_ne_u32 vcc, v117, v131
    v_sub_u32 v116, v122, v116
    v_lshrrev_b32 v165, 2, v165
    v_cndmask_b32 v117, 0, v167, vcc
    buffer_load_dwordx4 v137, s[44:47], s4 offen offset:2048 lds
    s_add_u32 m0, s67, 0
    s_add_u32 s4, s68, 74496
    s_waitcnt lgkmcnt(0)
    v_add_f32 v67, v67, v117
    v_lshrrev_b32 v116, 2, v116
    v_and_b32 v165, s5, v165
    v_and_b32 v116, s6, v116
    v_lshl_or_b32 v165, v165, 1, v116
    v_cmp_ne_u32 vcc, v165, v166
    v_lshl_add_u32 v117, v121, 2, 17
    v_mul_u32_u24 v122, 37, v117
    v_cndmask_b32 v116, 0, v167, vcc
    v_add_f32 v44, v44, v116
    v_cmp_ne_u32 vcc, v165, v126
    buffer_load_dwordx4 v133, s[44:47], s4 offen lds
    s_waitcnt vmcnt(7)
    ds_read_b64_tr_b16 a[20:21], v119 offset:3072
    ds_read_b64_tr_b16 a[22:23], v119 offset:3840
    ds_read_b64_tr_b16 a[44:45], v119 offset:3104
    ds_read_b64_tr_b16 a[46:47], v119 offset:3872
    ds_read_b64_tr_b16 a[68:69], v119 offset:3136
    ds_read_b64_tr_b16 a[70:71], v119 offset:3904
    v_cndmask_b32 v116, 0, v167, vcc
    v_add_f32 v56, v56, v116
    v_cmp_ne_u32 vcc, v165, v131
    v_lshrrev_b32 v122, 8, v122
    v_mul_u32_u24 v165, 7, v122
    v_cndmask_b32 v116, 0, v167, vcc
    v_add_f32 v68, v68, v116
    buffer_load_dwordx4 v135, s[44:47], s4 offen offset:1024 lds
    v_sub_u32 v165, v117, v165
    v_lshrrev_b32 v122, 2, v122
    v_lshrrev_b32 v165, 2, v165
    v_and_b32 v122, s5, v122
    v_and_b32 v165, s6, v165
    v_lshl_or_b32 v122, v122, 1, v165
    v_cmp_ne_u32 vcc, v122, v166
    v_lshl_add_u32 v165, v121, 2, 18
    v_mul_u32_u24 v116, 37, v165
    v_cndmask_b32 v117, 0, v167, vcc
    v_add_f32 v45, v45, v117
    v_cmp_ne_u32 vcc, v122, v126
    v_lshrrev_b32 v116, 8, v116
    v_mul_u32_u24 v117, 7, v116
    buffer_load_dwordx4 v137, s[44:47], s4 offen offset:2048 lds
    s_add_u32 m0, s67, 3072
    s_add_u32 s4, s68, 111360
    s_waitcnt lgkmcnt(0)
    v_cndmask_b32 v168, 0, v167, vcc
    v_add_f32 v57, v57, v168
    v_cmp_ne_u32 vcc, v122, v131
    v_sub_u32 v117, v165, v117
    v_lshrrev_b32 v116, 2, v116
    v_cndmask_b32 v122, 0, v167, vcc
    v_add_f32 v69, v69, v122
    v_lshrrev_b32 v117, 2, v117
    v_and_b32 v116, s5, v116
    v_and_b32 v117, s6, v117
    v_lshl_or_b32 v116, v116, 1, v117
    buffer_load_dwordx4 v133, s[44:47], s4 offen lds
    s_waitcnt vmcnt(7)
    ds_read_b64_tr_b16 a[144:145], v118 offset:0
    ds_read_b64_tr_b16 a[146:147], v118 offset:768
    ds_read_b64_tr_b16 a[168:169], v118 offset:32
    ds_read_b64_tr_b16 a[170:171], v118 offset:800
    ds_read_b64_tr_b16 a[192:193], v118 offset:64
    ds_read_b64_tr_b16 a[194:195], v118 offset:832
    v_cmp_ne_u32 vcc, v116, v166
    v_lshl_add_u32 v122, v121, 2, 19
    v_mul_u32_u24 v165, 37, v122
    v_cndmask_b32 v117, 0, v167, vcc
    v_add_f32 v46, v46, v117
    v_cmp_ne_u32 vcc, v116, v126
    v_lshrrev_b32 v165, 8, v165
    buffer_load_dwordx4 v135, s[44:47], s4 offen offset:1024 lds
    v_cndmask_b32 v117, 0, v167, vcc
    v_add_f32 v58, v58, v117
    v_cmp_ne_u32 vcc, v116, v131
    v_mul_u32_u24 v116, 7, v165
    v_sub_u32 v116, v122, v116
    v_cndmask_b32 v117, 0, v167, vcc
    v_add_f32 v70, v70, v117
    v_lshrrev_b32 v165, 2, v165
    v_lshrrev_b32 v116, 2, v116
    v_and_b32 v165, s5, v165
    v_and_b32 v116, s6, v116
    v_lshl_or_b32 v165, v165, 1, v116
    v_cmp_ne_u32 vcc, v165, v166
    v_lshl_add_u32 v122, v121, 2, 32
    buffer_load_dwordx4 v137, s[44:47], s4 offen offset:2048 lds
    s_add_u32 m0, s66, 0
    s_add_u32 s4, s68, 148224
    s_waitcnt lgkmcnt(0)
    v_cndmask_b32 v116, 0, v167, vcc
    v_add_f32 v47, v47, v116
    v_cmp_ne_u32 vcc, v165, v126
    v_mul_u32_u24 v116, 37, v122
    v_lshrrev_b32 v116, 8, v116
    v_cndmask_b32 v117, 0, v167, vcc
    v_add_f32 v59, v59, v117
    v_cmp_ne_u32 vcc, v165, v131
    v_mul_u32_u24 v117, 7, v116
    v_sub_u32 v117, v122, v117
    v_cndmask_b32 v122, 0, v167, vcc
    buffer_load_dwordx4 v133, s[44:47], s4 offen lds
    s_waitcnt vmcnt(7)
    ds_read_b64_tr_b16 a[148:149], v118 offset:3072
    ds_read_b64_tr_b16 a[150:151], v118 offset:3840
    ds_read_b64_tr_b16 a[172:173], v118 offset:3104
    ds_read_b64_tr_b16 a[174:175], v118 offset:3872
    ds_read_b64_tr_b16 a[196:197], v118 offset:3136
    ds_read_b64_tr_b16 a[198:199], v118 offset:3904
    v_add_f32 v71, v71, v122
    v_lshrrev_b32 v116, 2, v116
    v_lshrrev_b32 v117, 2, v117
    v_and_b32 v116, s5, v116
    v_and_b32 v117, s6, v117
    v_lshl_or_b32 v116, v116, 1, v117
    v_cmp_ne_u32 vcc, v116, v166
    buffer_load_dwordx4 v135, s[44:47], s4 offen offset:1024 lds
    v_lshl_add_u32 v122, v121, 2, 33
    v_cndmask_b32 v117, 0, v167, vcc
    v_add_f32 v48, v48, v117
    v_cmp_ne_u32 vcc, v116, v126
    v_mul_u32_u24 v165, 37, v122
    v_lshrrev_b32 v165, 8, v165
    v_cndmask_b32 v117, 0, v167, vcc
    v_add_f32 v60, v60, v117
    v_cmp_ne_u32 vcc, v116, v131
    v_mul_u32_u24 v116, 7, v165
    v_sub_u32 v116, v122, v116
    v_cndmask_b32 v117, 0, v167, vcc
    v_add_f32 v72, v72, v117
    v_lshrrev_b32 v165, 2, v165
    buffer_load_dwordx4 v137, s[44:47], s4 offen offset:2048 lds
    s_add_u32 m0, s66, 3072
    s_add_u32 s4, s68, 185088
    s_waitcnt lgkmcnt(0)
    v_lshrrev_b32 v116, 2, v116
    v_and_b32 v165, s5, v165
    v_and_b32 v116, s6, v116
    v_lshl_or_b32 v165, v165, 1, v116
    v_cmp_ne_u32 vcc, v165, v166
    v_lshl_add_u32 v117, v121, 2, 34
    v_mul_u32_u24 v116, 37, v117
    v_cndmask_b32 v122, 0, v167, vcc
    v_add_f32 v49, v49, v122
    v_cmp_ne_u32 vcc, v165, v126
    v_lshrrev_b32 v116, 8, v116
    buffer_load_dwordx4 v133, s[44:47], s4 offen lds
    s_waitcnt vmcnt(7)
    ds_read_b64_tr_b16 a[152:153], v119 offset:0
    ds_read_b64_tr_b16 a[154:155], v119 offset:768
    ds_read_b64_tr_b16 a[176:177], v119 offset:32
    ds_read_b64_tr_b16 a[178:179], v119 offset:800
    ds_read_b64_tr_b16 a[200:201], v119 offset:64
    ds_read_b64_tr_b16 a[202:203], v119 offset:832
    v_cndmask_b32 v122, 0, v167, vcc
    v_add_f32 v61, v61, v122
    v_cmp_ne_u32 vcc, v165, v131
    v_mul_u32_u24 v122, 7, v116
    v_sub_u32 v122, v117, v122
    v_cndmask_b32 v117, 0, v167, vcc
    v_add_f32 v73, v73, v117
    buffer_load_dwordx4 v135, s[44:47], s4 offen offset:1024 lds
    v_lshrrev_b32 v116, 2, v116
    v_lshrrev_b32 v122, 2, v122
    v_and_b32 v116, s5, v116
    v_and_b32 v122, s6, v122
    v_lshl_or_b32 v116, v116, 1, v122
    v_cmp_ne_u32 vcc, v116, v166
    v_lshl_add_u32 v165, v121, 2, 35
    v_mul_u32_u24 v121, 37, v165
    v_cndmask_b32 v117, 0, v167, vcc
    v_add_f32 v50, v50, v117
    v_cmp_ne_u32 vcc, v116, v126
    v_lshrrev_b32 v121, 8, v121
    v_mul_u32_u24 v122, 7, v121
    v_cndmask_b32 v117, 0, v167, vcc
    buffer_load_dwordx4 v137, s[44:47], s4 offen offset:2048 lds
    s_add_u32 m0, s28, 8192
    s_add_u32 s4, 0, 12288
    v_add_f32 v62, v62, v117
    v_cmp_ne_u32 vcc, v116, v131
    v_sub_u32 v122, v165, v122
    v_lshrrev_b32 v121, 2, v121
    v_cndmask_b32 v165, 0, v167, vcc
    v_add_f32 v74, v74, v165
    v_lshrrev_b32 v122, 2, v122
    v_and_b32 v121, s5, v121
    v_and_b32 v122, s6, v122
    v_lshl_or_b32 v121, v121, 1, v122
    v_cmp_ne_u32 vcc, v121, v166
    v_cndmask_b32 v22, v164, v22, s[88:89]
    buffer_load_dwordx4 v12, s[8:11], s25 offen nt lds
    s_waitcnt vmcnt(7)
    ds_read_b64_tr_b16 a[156:157], v119 offset:3072
    ds_read_b64_tr_b16 a[158:159], v119 offset:3840
    ds_read_b64_tr_b16 a[180:181], v119 offset:3104
    ds_read_b64_tr_b16 a[182:183], v119 offset:3872
    ds_read_b64_tr_b16 a[204:205], v119 offset:3136
    ds_read_b64_tr_b16 a[206:207], v119 offset:3904
    s_add_u32 m0, s28, 12288
    v_cndmask_b32 v122, 0, v167, vcc
    v_add_f32 v51, v51, v122
    v_cmp_ne_u32 vcc, v121, v126
    v_cndmask_b32 v24, v164, v24, s[88:89]
    v_cndmask_b32 v26, v164, v26, s[88:89]
    v_cndmask_b32 v122, 0, v167, vcc
    buffer_load_dwordx4 v13, s[8:11], s25 offen nt lds
    s_add_u32 m0, s29, 0
    v_add_f32 v63, v63, v122
    v_cmp_ne_u32 vcc, v121, v131
    s_nop 0
    s_nop 0
    v_cndmask_b32 v121, 0, v167, vcc
    v_add_f32 v75, v75, v121
    ds_read_b128 v[124:127], v152 offset:0
    ds_read_b128 v[204:207], v155 offset:0
    ds_read_b128 v[112:115], v152 offset:128
    ds_read_b128 v[148:151], v155 offset:128
    buffer_load_dwordx4 v14, s[8:11], s25 offen nt lds
    ds_read_b128 v[176:179], v152 offset:256
    s_add_u32 m0, s67, 0
    s_waitcnt lgkmcnt(5)
    s_cmp_lt_u32 1, s17
    ds_read_b128 v[184:187], v155 offset:256
    s_cselect_b32 s10, s36, 0
    s_mov_b32 s25, s24
    s_waitcnt vmcnt(6)
    ds_read_b64_tr_b16 a[160:161], v118 offset:0
    buffer_load_dwordx4 v123, s[48:51], 0 offen lds
    ds_read_b64_tr_b16 a[162:163], v118 offset:768
    ds_read_b64_tr_b16 a[184:185], v118 offset:32
    s_waitcnt lgkmcnt(8)
    v_mfma_f32_16x16x32_bf16 v[128:131], a[72:75], v[124:127], 0
    s_waitcnt lgkmcnt(6)
    ds_read_b64_tr_b16 a[186:187], v118 offset:800
    ds_read_b64_tr_b16 a[208:209], v118 offset:64
    v_mfma_f32_16x16x32_bf16 v[128:131], a[76:79], v[204:207], v[128:131]
    s_waitcnt lgkmcnt(7)
    ds_read_b64_tr_b16 a[210:211], v118 offset:832
    v_mfma_f32_16x16x32_bf16 v[128:131], a[80:83], v[112:115], v[128:131]
    s_waitcnt lgkmcnt(7)
    v_mfma_f32_16x16x32_bf16 v[128:131], a[84:87], v[148:151], v[128:131]
    s_waitcnt lgkmcnt(6)
    buffer_load_dwordx4 v120, s[48:51], 0 offen offset:1024 lds
    v_mfma_f32_16x16x32_bf16 v[128:131], a[88:91], v[176:179], v[128:131]
    v_mfma_f32_16x16x32_bf16 v[128:131], a[92:95], v[184:187], v[128:131]
    v_mfma_f32_16x16x32_bf16 v[136:139], a[96:99], v[124:127], 0
    s_waitcnt lgkmcnt(4)
    v_mfma_f32_16x16x32_bf16 v[136:139], a[100:103], v[204:207], v[136:139]
    s_waitcnt lgkmcnt(3)
    v_mfma_f32_16x16x32_bf16 v[136:139], a[104:107], v[112:115], v[136:139]
    s_waitcnt lgkmcnt(1)
    buffer_load_dwordx4 v134, s[48:51], 0 offen offset:2048 lds
    s_add_u32 m0, s67, 3072
    v_mfma_f32_16x16x32_bf16 v[136:139], a[108:111], v[148:151], v[136:139]
    s_waitcnt lgkmcnt(0)
    ds_read_b128 v[228:231], v152 offset:6144
    v_fma_f32 v121, v128, v128, s32
    v_mfma_f32_16x16x32_bf16 v[136:139], a[112:115], v[176:179], v[136:139]
    ds_read_b128 v[160:163], v155 offset:6144
    v_fmac_f32 v121, v129, v129
    v_mfma_f32_16x16x32_bf16 v[136:139], a[116:119], v[184:187], v[136:139]
    ds_read_b128 v[108:111], v152 offset:6272
    v_fmac_f32 v121, v130, v130
    v_mfma_f32_16x16x32_bf16 v[216:219], a[120:123], v[124:127], 0
    s_waitcnt vmcnt(6)
    ds_read_b64_tr_b16 a[164:165], v118 offset:3072
    ds_read_b64_tr_b16 a[166:167], v118 offset:3840
    v_mfma_f32_16x16x32_bf16 v[216:219], a[124:127], v[204:207], v[216:219]
    buffer_load_dwordx4 v123, s[48:51], s4 offen lds
    v_mfma_f32_16x16x32_bf16 v[216:219], a[128:131], v[112:115], v[216:219]
    ds_read_b64_tr_b16 a[188:189], v118 offset:3104
    ds_read_b64_tr_b16 a[190:191], v118 offset:3872
    v_mfma_f32_16x16x32_bf16 v[216:219], a[132:135], v[148:151], v[216:219]
    ds_read_b64_tr_b16 a[212:213], v118 offset:3136
    ds_read_b64_tr_b16 a[214:215], v118 offset:3904
    v_mfma_f32_16x16x32_bf16 v[216:219], a[136:139], v[176:179], v[216:219]
    ds_read_b128 v[116:119], v155 offset:6272
    ds_read_b128 v[188:191], v152 offset:6400
    v_mfma_f32_16x16x32_bf16 v[216:219], a[140:143], v[184:187], v[216:219]
    s_waitcnt lgkmcnt(10)
    ds_read_b128 v[192:195], v155 offset:6400
    v_fmac_f32 v121, v131, v131
    v_mfma_f32_16x16x32_bf16 v[200:203], a[72:75], v[228:231], 0
    s_waitcnt lgkmcnt(10)
    buffer_load_dwordx4 v120, s[48:51], s4 offen offset:1024 lds
    v_mfma_f32_16x16x32_bf16 v[200:203], a[76:79], v[160:163], v[200:203]
    s_waitcnt lgkmcnt(9)
    v_fmac_f32 v121, v136, v136
    v_fmac_f32 v121, v137, v137
    v_mfma_f32_16x16x32_bf16 v[200:203], a[80:83], v[108:111], v[200:203]
    s_waitcnt lgkmcnt(7)
    v_fmac_f32 v121, v138, v138
    v_fmac_f32 v121, v139, v139
    v_mfma_f32_16x16x32_bf16 v[208:211], a[96:99], v[228:231], 0
    v_fmac_f32 v121, v216, v216
    v_fmac_f32 v121, v217, v217
    v_mfma_f32_16x16x32_bf16 v[208:211], a[100:103], v[160:163], v[208:211]
    s_waitcnt lgkmcnt(5)
    v_fmac_f32 v121, v218, v218
    v_fmac_f32 v121, v219, v219
    v_mfma_f32_16x16x32_bf16 v[208:211], a[104:107], v[108:111], v[208:211]
    s_waitcnt lgkmcnt(3)
    buffer_load_dwordx4 v134, s[48:51], s4 offen offset:2048 lds
    v_mfma_f32_16x16x32_bf16 v[212:215], a[120:123], v[228:231], 0
    s_waitcnt lgkmcnt(1)
    s_add_u32 m0, s66, 0
    s_add_u32 s4, 0, 24576
    v_mfma_f32_16x16x32_bf16 v[200:203], a[84:87], v[116:119], v[200:203]
    s_waitcnt lgkmcnt(0)
    v_mfma_f32_16x16x32_bf16 v[200:203], a[88:91], v[188:191], v[200:203]
    v_mfma_f32_16x16x32_bf16 v[200:203], a[92:95], v[192:195], v[200:203]
    v_mfma_f32_16x16x32_bf16 v[208:211], a[108:111], v[116:119], v[208:211]
    buffer_load_dwordx4 v123, s[48:51], s4 offen lds
    v_mfma_f32_16x16x32_bf16 v[208:211], a[112:115], v[188:191], v[208:211]
    v_mfma_f32_16x16x32_bf16 v[208:211], a[116:119], v[192:195], v[208:211]
    v_mfma_f32_16x16x32_bf16 v[212:215], a[124:127], v[160:163], v[212:215]
    v_mfma_f32_16x16x32_bf16 v[212:215], a[128:131], v[108:111], v[212:215]
    v_mfma_f32_16x16x32_bf16 v[212:215], a[132:135], v[116:119], v[212:215]
    v_mfma_f32_16x16x32_bf16 v[212:215], a[136:139], v[188:191], v[212:215]
    v_fma_f32 v122, v200, v200, s32
    v_fmac_f32 v122, v201, v201
    v_mfma_f32_16x16x32_bf16 v[212:215], a[140:143], v[192:195], v[212:215]
    v_fmac_f32 v122, v202, v202
    v_fmac_f32 v122, v203, v203
    v_mfma_f32_16x16x32_bf16 v[220:223], a[0:3], v[124:127], 0
    v_fmac_f32 v122, v208, v208
    v_fmac_f32 v122, v209, v209
    v_mfma_f32_16x16x32_bf16 v[220:223], a[4:7], v[204:207], v[220:223]
    v_fmac_f32 v122, v210, v210
    v_fmac_f32 v122, v211, v211
    v_mfma_f32_16x16x32_bf16 v[220:223], a[8:11], v[112:115], v[220:223]
    v_fmac_f32 v122, v212, v212
    v_fmac_f32 v122, v213, v213
    v_mfma_f32_16x16x32_bf16 v[220:223], a[12:15], v[148:151], v[220:223]
    v_fmac_f32 v122, v214, v214
    v_fmac_f32 v122, v215, v215
    v_mfma_f32_16x16x32_bf16 v[220:223], a[16:19], v[176:179], v[220:223]
    v_mfma_f32_16x16x32_bf16 v[220:223], a[20:23], v[184:187], v[220:223]
    v_mfma_f32_16x16x32_bf16 v[224:227], a[24:27], v[124:127], 0
    v_mfma_f32_16x16x32_bf16 v[224:227], a[28:31], v[204:207], v[224:227]
    v_mfma_f32_16x16x32_bf16 v[224:227], a[32:35], v[112:115], v[224:227]
    v_mfma_f32_16x16x32_bf16 v[224:227], a[36:39], v[148:151], v[224:227]
    v_mfma_f32_16x16x32_bf16 v[224:227], a[40:43], v[176:179], v[224:227]
    v_mfma_f32_16x16x32_bf16 v[224:227], a[44:47], v[184:187], v[224:227]
    v_mfma_f32_16x16x32_bf16 v[232:235], a[48:51], v[124:127], 0
    v_mfma_f32_16x16x32_bf16 v[232:235], a[52:55], v[204:207], v[232:235]
    v_fma_f32 v133, v220, v220, s32
    v_fmac_f32 v133, v221, v221
    v_mfma_f32_16x16x32_bf16 v[232:235], a[56:59], v[112:115], v[232:235]
    v_fmac_f32 v133, v222, v222
    v_fmac_f32 v133, v223, v223
    v_mfma_f32_16x16x32_bf16 v[232:235], a[60:63], v[148:151], v[232:235]
    v_fmac_f32 v133, v224, v224
    v_fmac_f32 v133, v225, v225
    v_mfma_f32_16x16x32_bf16 v[232:235], a[64:67], v[176:179], v[232:235]
    v_fmac_f32 v133, v226, v226
    v_fmac_f32 v133, v227, v227
    v_mfma_f32_16x16x32_bf16 v[232:235], a[68:71], v[184:187], v[232:235]
    v_mfma_f32_16x16x32_bf16 v[236:239], a[0:3], v[228:231], 0
    v_mfma_f32_16x16x32_bf16 v[236:239], a[4:7], v[160:163], v[236:239]
    v_mfma_f32_16x16x32_bf16 v[236:239], a[8:11], v[108:111], v[236:239]
    v_mfma_f32_16x16x32_bf16 v[236:239], a[12:15], v[116:119], v[236:239]
    v_mfma_f32_16x16x32_bf16 v[236:239], a[16:19], v[188:191], v[236:239]
    v_mfma_f32_16x16x32_bf16 v[236:239], a[20:23], v[192:195], v[236:239]
    v_mfma_f32_16x16x32_bf16 v[240:243], a[24:27], v[228:231], 0
    v_mfma_f32_16x16x32_bf16 v[240:243], a[28:31], v[160:163], v[240:243]
    v_fmac_f32 v133, v232, v232
    v_fmac_f32 v133, v233, v233
    v_mfma_f32_16x16x32_bf16 v[240:243], a[32:35], v[108:111], v[240:243]
    v_fmac_f32 v133, v234, v234
    v_fmac_f32 v133, v235, v235
    v_mfma_f32_16x16x32_bf16 v[240:243], a[36:39], v[116:119], v[240:243]
    ds_read_b128 v[196:199], v0 offset:20480
    v_cvt_pk_bf16_f32 v36, v133, v121
    v_mfma_f32_16x16x32_bf16 v[240:243], a[40:43], v[188:191], v[240:243]
    ds_read_b128 v[184:187], v1 offset:20480
    v_fma_f32 v121, v236, v236, s32
    v_mfma_f32_16x16x32_bf16 v[244:247], v[32:35], v[36:39], 0
    v_fmac_f32 v121, v237, v237
    v_fmac_f32 v121, v238, v238
    v_mfma_f32_16x16x32_bf16 v[240:243], a[44:47], v[192:195], v[240:243]
    ds_read_b128 v[172:175], v0 offset:20608
    v_fmac_f32 v121, v239, v239
    v_mfma_f32_16x16x32_bf16 v[248:251], a[48:51], v[228:231], 0
    ds_read_b128 v[148:151], v1 offset:20608
    v_mfma_f32_16x16x32_bf16 v[248:251], a[52:55], v[160:163], v[248:251]
    ds_read_b128 v[112:115], v0 offset:20736
    v_mfma_f32_16x16x32_bf16 v[248:251], a[56:59], v[108:111], v[248:251]
    ds_read_b128 v[228:231], v1 offset:20736
    v_fmac_f32 v121, v240, v240
    v_mfma_f32_16x16x32_bf16 v[248:251], a[60:63], v[116:119], v[248:251]
    v_rsq_f32 v245, v245
    v_mfma_f32_16x16x32_bf16 v[248:251], a[64:67], v[188:191], v[248:251]
    s_waitcnt lgkmcnt(5)
    v_rsq_f32 v244, v244
    v_mfma_f32_16x16x32_bf16 v[248:251], a[68:71], v[192:195], v[248:251]
    s_waitcnt lgkmcnt(4)
    v_mul_f32 v244, s31, v244
    v_mul_f32 v128, v245, v128
    v_mfma_f32_16x16x32_bf16 v[176:179], a[96:99], v[196:199], 0
    v_mul_f32 v129, v245, v129
    v_cvt_pk_bf16_f32 v116, v128, v129
    v_mfma_f32_16x16x32_bf16 v[176:179], a[100:103], v[184:187], v[176:179]
    s_waitcnt lgkmcnt(3)
    v_mul_f32 v130, v245, v130
    v_mul_f32 v131, v245, v131
    v_mfma_f32_16x16x32_bf16 v[176:179], a[104:107], v[172:175], v[176:179]
    s_waitcnt lgkmcnt(2)
    v_cvt_pk_bf16_f32 v117, v130, v131
    v_mul_f32 v136, v245, v136
    v_mfma_f32_16x16x32_bf16 v[176:179], a[108:111], v[148:151], v[176:179]
    s_waitcnt lgkmcnt(1)
    v_mul_f32 v137, v245, v137
    v_cvt_pk_bf16_f32 v118, v136, v137
    v_mfma_f32_16x16x32_bf16 v[176:179], a[112:115], v[112:115], v[176:179]
    s_waitcnt lgkmcnt(0)
    v_mul_f32 v138, v245, v138
    v_mul_f32 v139, v245, v139
    v_mfma_f32_16x16x32_bf16 v[176:179], a[116:119], v[228:231], v[176:179]
    v_cvt_pk_bf16_f32 v119, v138, v139
    v_mul_f32 v216, v245, v216
    v_mfma_f32_16x16x32_bf16 v[124:127], a[120:123], v[196:199], 0
    ds_write_b128 v153, v[116:119]
    v_mfma_f32_16x16x32_bf16 v[124:127], a[124:127], v[184:187], v[124:127]
    v_mul_f32 v217, v245, v217
    v_cvt_pk_bf16_f32 v118, v216, v217
    v_mfma_f32_16x16x32_bf16 v[124:127], a[128:131], v[172:175], v[124:127]
    v_mul_f32 v218, v245, v218
    v_mul_f32 v219, v245, v219
    v_mfma_f32_16x16x32_bf16 v[124:127], a[132:135], v[148:151], v[124:127]
    v_cvt_pk_bf16_f32 v119, v218, v219
    v_mul_f32 v220, v244, v220
    v_mfma_f32_16x16x32_bf16 v[124:127], a[136:139], v[112:115], v[124:127]
    ds_write_b64 v153, v[118:119] offset:48
    v_mfma_f32_16x16x32_bf16 v[124:127], a[140:143], v[228:231], v[124:127]
    v_mul_f32 v221, v244, v221
    v_cvt_pk_bf16_f32 v116, v220, v221
    v_mfma_f32_16x16x32_bf16 v[160:163], a[24:27], v[196:199], 0
    v_mul_f32 v222, v244, v222
    v_mul_f32 v223, v244, v223
    v_mfma_f32_16x16x32_bf16 v[160:163], a[28:31], v[184:187], v[160:163]
    v_cvt_pk_bf16_f32 v117, v222, v223
    v_mul_f32 v224, v244, v224
    v_mfma_f32_16x16x32_bf16 v[160:163], a[32:35], v[172:175], v[160:163]
    v_mul_f32 v225, v244, v225
    v_cvt_pk_bf16_f32 v118, v224, v225
    v_mfma_f32_16x16x32_bf16 v[160:163], a[36:39], v[148:151], v[160:163]
    v_mul_f32 v226, v244, v226
    v_mul_f32 v227, v244, v227
    v_mfma_f32_16x16x32_bf16 v[160:163], a[40:43], v[112:115], v[160:163]
    v_cvt_pk_bf16_f32 v119, v226, v227
    v_mul_f32 v232, v244, v232
    v_mfma_f32_16x16x32_bf16 v[160:163], a[44:47], v[228:231], v[160:163]
    ds_write_b128 v153, v[116:119] offset:32
    v_mfma_f32_16x16x32_bf16 v[204:207], a[72:75], v[196:199], 0
    v_mul_f32 v233, v244, v233
    v_cvt_pk_bf16_f32 v116, v232, v233
    v_mfma_f32_16x16x32_bf16 v[204:207], a[76:79], v[184:187], v[204:207]
    v_mul_f32 v234, v244, v234
    v_mul_f32 v235, v244, v235
    v_mfma_f32_16x16x32_bf16 v[204:207], a[80:83], v[172:175], v[204:207]
    v_cvt_pk_bf16_f32 v117, v234, v235
    v_mul_f32 v108, v220, v128
    v_mfma_f32_16x16x32_bf16 v[204:207], a[84:87], v[148:151], v[204:207]
    ds_write_b64 v153, v[116:117] offset:72
    v_mfma_f32_16x16x32_bf16 v[204:207], a[88:91], v[112:115], v[204:207]
    v_fmac_f32 v108, v221, v129
    v_fmac_f32 v108, v222, v130
    v_mfma_f32_16x16x32_bf16 v[204:207], a[92:95], v[228:231], v[204:207]
    buffer_load_dwordx4 v120, s[48:51], s4 offen offset:1024 lds
    v_mfma_f32_16x16x32_bf16 v[116:119], a[48:51], v[196:199], 0
    v_fmac_f32 v108, v223, v131
    v_fmac_f32 v108, v224, v136
    v_mfma_f32_16x16x32_bf16 v[116:119], a[52:55], v[184:187], v[116:119]
    v_fmac_f32 v108, v225, v137
    v_fmac_f32 v108, v226, v138
    v_mfma_f32_16x16x32_bf16 v[116:119], a[56:59], v[172:175], v[116:119]
    v_fmac_f32 v108, v227, v139
    v_fmac_f32 v108, v232, v216
    v_mfma_f32_16x16x32_bf16 v[116:119], a[60:63], v[148:151], v[116:119]
    v_fmac_f32 v108, v233, v217
    v_fmac_f32 v108, v234, v218
    v_mfma_f32_16x16x32_bf16 v[116:119], a[64:67], v[112:115], v[116:119]
    buffer_load_dwordx4 v134, s[48:51], s4 offen offset:2048 lds
    v_mfma_f32_16x16x32_bf16 v[116:119], a[68:71], v[228:231], v[116:119]
    s_add_u32 m0, s66, 3072
    v_fmac_f32 v108, v235, v219
    v_mov_b32 v153, v108
    v_mfma_f32_16x16x32_bf16 v[128:131], v[196:199], a[144:147], 0
    s_add_u32 s4, 0, 36864
    v_permlane32_swap_b32 v108, v153
    v_mfma_f32_16x16x32_bf16 v[128:131], v[184:187], a[148:151], v[128:131]
    v_add_f32 v108, v108, v153
    v_mov_b32 v153, v108
    v_mfma_f32_16x16x32_bf16 v[128:131], v[172:175], a[152:155], v[128:131]
    v_fmac_f32 v121, v241, v241
    v_fmac_f32 v121, v242, v242
    v_mfma_f32_16x16x32_bf16 v[128:131], v[148:151], a[156:159], v[128:131]
    buffer_load_dwordx4 v123, s[48:51], s4 offen lds
    v_mfma_f32_16x16x32_bf16 v[128:131], v[112:115], a[160:163], v[128:131]
    v_permlane16_swap_b32 v108, v153
    v_mfma_f32_16x16x32_bf16 v[128:131], v[228:231], a[164:167], v[128:131]
    v_add_f32 v108, v108, v153
    v_add_f32 v108, s39, v108
    v_mfma_f32_16x16x32_bf16 v[136:139], v[196:199], a[168:171], 0
    v_mov_b32 v109, v164
    v_mov_b32 v110, v164
    v_mfma_f32_16x16x32_bf16 v[136:139], v[184:187], a[172:175], v[136:139]
    v_mov_b32 v111, v164
    v_cndmask_b32 v108, v164, v108, s[88:89]
    v_mfma_f32_16x16x32_bf16 v[136:139], v[172:175], a[176:179], v[136:139]
    buffer_load_dwordx4 v120, s[48:51], s4 offen offset:1024 lds
    v_mfma_f32_16x16x32_bf16 v[136:139], v[148:151], a[180:183], v[136:139]
    ds_read_b128 v[220:223], v152 offset:0
    v_fmac_f32 v121, v243, v243
    v_mfma_f32_16x16x32_bf16 v[136:139], v[112:115], a[184:187], v[136:139]
    ds_read_b128 v[232:235], v155 offset:0
    v_fmac_f32 v121, v248, v248
    v_mfma_f32_16x16x32_bf16 v[136:139], v[228:231], a[188:191], v[136:139]
    ds_read_b128 v[224:227], v152 offset:128
    v_fmac_f32 v121, v249, v249
    v_mfma_f32_16x16x32_bf16 v[188:191], v[196:199], a[192:195], 0
    ds_read_b128 v[192:195], v155 offset:128
    v_fmac_f32 v121, v250, v250
    v_mfma_f32_16x16x32_bf16 v[188:191], v[184:187], a[196:199], v[188:191]
    buffer_load_dwordx4 v134, s[48:51], s4 offen offset:2048 lds
    v_mfma_f32_16x16x32_bf16 v[188:191], v[172:175], a[200:203], v[188:191]
    s_add_u32 m0, s67, 0
    ds_read_b128 v[244:247], v152 offset:256
    s_waitcnt vmcnt(9)
    v_mfma_f32_16x16x32_bf16 v[188:191], v[148:151], a[204:207], v[188:191]
    s_add_u32 s4, 0, 49152
    ds_read_b64 a[216:217], v180 offset:0
    ds_read_b64 a[218:219], v180 offset:1536
    v_mfma_f32_16x16x32_bf16 v[188:191], v[112:115], a[208:211], v[188:191]
    ds_read_b64 a[240:241], v180 offset:8
    ds_read_b64 a[242:243], v180 offset:1544
    v_mfma_f32_16x16x32_bf16 v[188:191], v[228:231], a[212:215], v[188:191]
    s_waitcnt lgkmcnt(8)
    ds_read_b64 v[84:85], v143 offset:0
    ds_read_b64 v[86:87], v143 offset:1536
    ds_write_b128 v156, v[108:111] offset:192
    v_mfma_f32_16x16x32_bf16 v[108:111], v[220:223], a[144:147], 0
    s_waitcnt lgkmcnt(8)
    v_fmac_f32 v121, v251, v251
    v_cvt_pk_bf16_f32 v36, v121, v122
    v_mfma_f32_16x16x32_bf16 v[108:111], v[232:235], a[148:151], v[108:111]
    v_fma_f32 v169, v204, v204, s32
    v_fmac_f32 v169, v205, v205
    v_mfma_f32_16x16x32_bf16 v[108:111], v[224:227], a[152:155], v[108:111]
    s_waitcnt lgkmcnt(7)
    v_fmac_f32 v169, v206, v206
    v_fmac_f32 v169, v207, v207
    v_mfma_f32_16x16x32_bf16 v[108:111], v[192:195], a[156:159], v[108:111]
    s_waitcnt lgkmcnt(6)
    v_fmac_f32 v169, v176, v176
    v_fmac_f32 v169, v177, v177
    v_mfma_f32_16x16x32_bf16 v[108:111], v[244:247], a[160:163], v[108:111]
    v_fmac_f32 v169, v178, v178
    v_fmac_f32 v169, v179, v179
    v_fmac_f32 v169, v124, v124
    v_fmac_f32 v169, v125, v125
    s_waitcnt lgkmcnt(1)
    buffer_load_dwordx4 v123, s[48:51], s4 offen lds
    v_fmac_f32 v169, v126, v126
    v_fmac_f32 v169, v127, v127
    v_cvt_pk_bf16_f32 v144, v128, v129
    v_mfma_f32_16x16x32_bf16 v[216:219], v[32:35], v[36:39], 0
    v_cvt_pk_bf16_f32 v145, v130, v131
    v_cvt_pk_bf16_f32 v156, v136, v137
    s_waitcnt vmcnt(7)
    v_mfma_f32_16x16x32_bf16 v[128:131], v[220:223], a[168:171], 0
    ds_read_b64 a[232:233], v180 offset:3072
    ds_read_b64 a[220:221], v180 offset:4608
    v_mfma_f32_16x16x32_bf16 v[128:131], v[232:235], a[172:175], v[128:131]
    ds_read_b64 v[76:77], v180 offset:3080
    ds_read_b64 a[244:245], v180 offset:4616
    v_mfma_f32_16x16x32_bf16 v[128:131], v[224:227], a[176:179], v[128:131]
    buffer_load_dwordx4 v120, s[48:51], s4 offen offset:1024 lds
    v_mfma_f32_16x16x32_bf16 v[128:131], v[192:195], a[180:183], v[128:131]
    ds_read_b64 v[100:101], v143 offset:3072
    ds_read_b64 v[88:89], v143 offset:4608
    v_mfma_f32_16x16x32_bf16 v[128:131], v[244:247], a[184:187], v[128:131]
    v_rsq_f32 v217, v217
    v_rsq_f32 v216, v216
    v_mul_f32 v200, v217, v200
    v_mul_f32 v216, s31, v216
    v_mul_f32 v201, v217, v201
    v_cvt_pk_bf16_f32 v252, v200, v201
    buffer_load_dwordx4 v134, s[48:51], s4 offen offset:2048 lds
    s_add_u32 m0, s67, 3072
    s_add_u32 s4, 0, 61440
    v_mul_f32 v202, v217, v202
    v_mul_f32 v203, v217, v203
    v_cvt_pk_bf16_f32 v253, v202, v203
    v_mul_f32 v208, v217, v208
    v_mul_f32 v209, v217, v209
    v_cvt_pk_bf16_f32 v254, v208, v209
    v_mul_f32 v210, v217, v210
    v_mul_f32 v211, v217, v211
    v_cvt_pk_bf16_f32 v255, v210, v211
    v_mul_f32 v212, v217, v212
    v_mul_f32 v213, v217, v213
    s_waitcnt lgkmcnt(0)
    buffer_load_dwordx4 v123, s[48:51], s4 offen lds
    ds_write_b128 v157, v[252:255]
    s_waitcnt vmcnt(7)
    v_cvt_pk_bf16_f32 v122, v212, v213
    v_mul_f32 v214, v217, v214
    v_mul_f32 v215, v217, v215
    v_cvt_pk_bf16_f32 v123, v214, v215
    v_mul_f32 v236, v216, v236
    v_mul_f32 v237, v216, v237
    ds_read_b64 a[222:223], v132 offset:0
    ds_read_b64 a[234:235], v132 offset:1536
    buffer_load_dwordx4 v120, s[48:51], s4 offen offset:1024 lds
    ds_read_b64 a[246:247], v132 offset:8
    ds_read_b64 v[78:79], v132 offset:1544
    ds_read_b64 v[90:91], v146 offset:0
    ds_read_b64 v[102:103], v146 offset:1536
    ds_write_b64 v157, v[122:123] offset:48
    v_cvt_pk_bf16_f32 v252, v236, v237
    v_mul_f32 v238, v216, v238
    v_mul_f32 v239, v216, v239
    v_cvt_pk_bf16_f32 v253, v238, v239
    v_mul_f32 v240, v216, v240
    v_mul_f32 v241, v216, v241
    v_cvt_pk_bf16_f32 v254, v240, v241
    buffer_load_dwordx4 v134, s[48:51], s4 offen offset:2048 lds
    s_add_u32 m0, s28, 65536
    v_mul_f32 v242, v216, v242
    v_mul_f32 v243, v216, v243
    v_cvt_pk_bf16_f32 v255, v242, v243
    v_mul_f32 v248, v216, v248
    v_mul_f32 v249, v216, v249
    v_cvt_pk_bf16_f32 v120, v248, v249
    v_mul_f32 v250, v216, v250
    v_mul_f32 v251, v216, v251
    v_cvt_pk_bf16_f32 v121, v250, v251
    v_mul_f32 v140, v236, v200
    v_fmac_f32 v140, v237, v201
    v_fmac_f32 v140, v238, v202
    v_mfma_f32_16x16x32_bf16 v[216:219], a[0:3], v[196:199], 0
    s_waitcnt lgkmcnt(0)
    ds_read_b128 v[196:199], v155 offset:256
    v_fmac_f32 v140, v239, v203
    s_waitcnt vmcnt(6)
    v_mfma_f32_16x16x32_bf16 v[216:219], a[4:7], v[184:187], v[216:219]
    buffer_load_dwordx4 v10, s[8:11], s24 offen nt lds
    v_mfma_f32_16x16x32_bf16 v[216:219], a[8:11], v[172:175], v[216:219]
    s_add_u32 m0, s28, 69632
    ds_read_b64 a[224:225], v132 offset:3072
    ds_read_b64 a[226:227], v132 offset:4608
    v_mfma_f32_16x16x32_bf16 v[216:219], a[12:15], v[148:151], v[216:219]
    ds_read_b64 a[248:249], v132 offset:3080
    ds_read_b64 a[250:251], v132 offset:4616
    v_mfma_f32_16x16x32_bf16 v[216:219], a[16:19], v[112:115], v[216:219]
    ds_read_b64 v[92:93], v146 offset:3072
    ds_read_b64 v[94:95], v146 offset:4608
    v_mfma_f32_16x16x32_bf16 v[216:219], a[20:23], v[228:231], v[216:219]
    ds_read_b128 v[132:135], v152 offset:6144
    ds_read_b128 v[112:115], v155 offset:6144
    v_mfma_f32_16x16x32_bf16 v[148:151], v[220:223], a[192:195], 0
    buffer_load_dwordx4 v11, s[8:11], s24 offen nt lds
    v_mfma_f32_16x16x32_bf16 v[148:151], v[232:235], a[196:199], v[148:151]
    s_waitcnt lgkmcnt(8)
    ds_read_b128 v[228:231], v155 offset:6272
    ds_read_b128 v[184:187], v152 offset:6400
    v_mfma_f32_16x16x32_bf16 v[108:111], v[196:199], a[164:167], v[108:111]
    s_add_u32 m0, s28, 73728
    ds_write_b128 v157, v[252:255] offset:32
    v_mfma_f32_16x16x32_bf16 v[128:131], v[196:199], a[188:191], v[128:131]
    s_waitcnt lgkmcnt(9)
    v_fmac_f32 v140, v240, v208
    v_fmac_f32 v140, v241, v209
    v_mfma_f32_16x16x32_bf16 v[148:151], v[224:227], a[200:203], v[148:151]
    s_waitcnt lgkmcnt(7)
    buffer_load_dwordx4 v12, s[8:11], s24 offen nt lds
    v_mfma_f32_16x16x32_bf16 v[148:151], v[192:195], a[204:207], v[148:151]
    s_add_u32 m0, s28, 77824
    ds_read_b128 v[172:175], v152 offset:6272
    ds_read_b128 v[200:203], v155 offset:6400
    v_mfma_f32_16x16x32_bf16 v[148:151], v[244:247], a[208:211], v[148:151]
    s_waitcnt lgkmcnt(5)
    ds_write_b64 v157, v[120:121] offset:72
    s_waitcnt vmcnt(6)
    v_mfma_f32_16x16x32_bf16 v[148:151], v[196:199], a[212:215], v[148:151]
    s_waitcnt lgkmcnt(5)
    v_fmac_f32 v140, v242, v210
    v_fmac_f32 v140, v243, v211
    v_mfma_f32_16x16x32_bf16 v[120:123], v[132:135], a[144:147], 0
    s_waitcnt lgkmcnt(3)
    buffer_load_dwordx4 v13, s[8:11], s24 offen nt lds
    v_mfma_f32_16x16x32_bf16 v[120:123], v[112:115], a[148:151], v[120:123]
    s_add_u32 m0, s72, 0
    ds_read_b64 a[236:237], v180 offset:0
    ds_read_b64 a[228:229], v180 offset:1536
    v_mfma_f32_16x16x32_bf16 v[196:199], v[132:135], a[168:171], 0
    ds_read_b64 v[80:81], v180 offset:8
    ds_read_b64 a[252:253], v180 offset:1544
    v_mfma_f32_16x16x32_bf16 v[196:199], v[112:115], a[172:175], v[196:199]
    ds_read_b64 v[104:105], v143 offset:0
    ds_read_b64 v[96:97], v143 offset:1536
    v_mfma_f32_16x16x32_bf16 v[208:211], v[132:135], a[192:195], 0
    s_waitcnt lgkmcnt(7)
    v_fmac_f32 v140, v248, v212
    v_fmac_f32 v140, v249, v213
    v_mfma_f32_16x16x32_bf16 v[120:123], v[172:175], a[152:155], v[120:123]
    s_barrier
    buffer_load_dwordx4 v14, s[8:11], s24 offen nt lds
    ds_read_b128 v[240:243], v1 offset:26752
    v_mfma_f32_16x16x16_bf16 v[132:135], v[28:29], a[216:217], 0
    v_xor_b32 v146, 65536, v2
    v_lshrrev_b32 v147, 2, v146
    v_lshrrev_b32 v152, 8, v146
    v_mfma_f32_16x16x16_bf16 v[132:135], v[28:29], a[240:241], v[132:135]
    v_add_u32 v146, 148992, v146
    v_lshl_add_u32 v153, s16, 2, v146
    v_add_u32 v147, 162048, v147
    v_mfma_f32_16x16x16_bf16 v[132:135], v[28:29], v[84:85], v[132:135]
    v_lshlrev_b32 v152, 4, v152
    v_add_u32 v152, 162048, v152
    v_fmac_f32 v140, v250, v214
    v_mfma_f32_16x16x16_bf16 v[224:227], v[28:29], a[218:219], 0
    v_fmac_f32 v140, v251, v215
    v_mov_b32 v155, v140
    v_fma_f32 v168, v216, v216, s32
    v_mfma_f32_16x16x16_bf16 v[224:227], v[28:29], a[242:243], v[224:227]
    v_permlane32_swap_b32 v140, v155
    v_add_f32 v140, v140, v155
    v_mfma_f32_16x16x16_bf16 v[224:227], v[28:29], v[86:87], v[224:227]
    v_mov_b32 v155, v140
    v_fmac_f32 v168, v217, v217
    s_waitcnt vmcnt(5)
    v_mfma_f32_16x16x16_bf16 v[212:215], v[28:29], a[232:233], 0
    ds_read_b64 a[230:231], v180 offset:3072
    ds_read_b64 a[238:239], v180 offset:4608
    ds_read_b64 a[254:255], v180 offset:3080
    v_mfma_f32_16x16x16_bf16 v[212:215], v[28:29], v[76:77], v[212:215]
    ds_read_b64 v[82:83], v180 offset:4616
    ds_read_b64 v[98:99], v143 offset:3072
    ds_read_b64 v[106:107], v143 offset:4608
    v_mfma_f32_16x16x16_bf16 v[212:215], v[28:29], v[100:101], v[212:215]
    v_mov_b32_dpp v132, v224 quad_perm:[0,1,2,3] row_mask:0x2 bank_mask:0xf
    v_permlane16_swap_b32 v140, v155
    v_mfma_f32_16x16x16_bf16 v[248:251], v[28:29], a[220:221], 0
    v_add_f32 v140, v140, v155
    v_add_f32 v140, s39, v140
    v_mov_b32 v141, v164
    v_mfma_f32_16x16x16_bf16 v[248:251], v[28:29], a[244:245], v[248:251]
    v_mov_b32 v142, v164
    v_mov_b32_dpp v132, v212 quad_perm:[0,1,2,3] row_mask:0x4 bank_mask:0xf
    v_mov_b32 v143, v164
    v_mfma_f32_16x16x16_bf16 v[248:251], v[28:29], v[88:89], v[248:251]
    v_cndmask_b32 v140, v164, v140, s[88:89]
    v_fmac_f32 v168, v218, v218
    v_fmac_f32 v168, v219, v219
    v_mfma_f32_16x16x16_bf16 v[164:167], v[28:29], a[222:223], 0
    v_fmac_f32 v168, v160, v160
    v_fmac_f32 v168, v161, v161
    v_fmac_f32 v168, v162, v162
    v_mfma_f32_16x16x16_bf16 v[164:167], v[28:29], a[246:247], v[164:167]
    v_mov_b32_dpp v132, v248 quad_perm:[0,1,2,3] row_mask:0x8 bank_mask:0xf
    v_fmac_f32 v168, v163, v163
    v_fmac_f32 v168, v116, v116
    v_mfma_f32_16x16x16_bf16 v[164:167], v[28:29], v[90:91], v[164:167]
    v_fmac_f32 v168, v117, v117
    v_fmac_f32 v168, v118, v118
    v_fmac_f32 v168, v119, v119
    v_mfma_f32_16x16x16_bf16 v[212:215], v[28:29], a[234:235], 0
    v_cvt_pk_bf16_f32 v36, v168, v169
    v_cvt_pk_bf16_f32 v157, v138, v139
    v_cvt_pk_bf16_f32 v188, v188, v189
    v_cvt_pk_bf16_f32 v189, v190, v191
    v_mfma_f32_16x16x32_bf16 v[136:139], v[32:35], v[36:39], 0
    s_add_u32 s8, s40, s23
    ds_write_b32 v153, v132 offset:0
    v_cvt_pk_bf16_f32 v108, v108, v108
    v_mfma_f32_16x16x16_bf16 v[212:215], v[28:29], v[78:79], v[212:215]
    v_cvt_pk_bf16_f32 v109, v109, v109
    v_cvt_pk_bf16_f32 v110, v110, v110
    v_cvt_pk_bf16_f32 v111, v111, v111
    v_mfma_f32_16x16x16_bf16 v[212:215], v[28:29], v[102:103], v[212:215]
    v_rsq_f32 v137, v137
    v_cvt_pk_bf16_f32 v128, v128, v128
    v_mfma_f32_16x16x16_bf16 v[132:135], v[28:29], a[224:225], 0
    v_rsq_f32 v136, v136
    v_mul_f32 v204, v137, v204
    v_mfma_f32_16x16x16_bf16 v[132:135], v[28:29], a[248:249], v[132:135]
    v_mul_f32 v136, s31, v136
    v_mul_f32 v205, v137, v205
    v_mov_b32_dpp v164, v212 quad_perm:[0,1,2,3] row_mask:0x2 bank_mask:0xf
    v_mfma_f32_16x16x16_bf16 v[132:135], v[28:29], v[92:93], v[132:135]
    v_cvt_pk_bf16_f32 v204, v204, v205
    v_mul_f32 v206, v137, v206
    v_mul_f32 v207, v137, v207
    v_mfma_f32_16x16x16_bf16 v[212:215], v[28:29], a[226:227], 0
    v_cvt_pk_bf16_f32 v205, v206, v207
    v_mul_f32 v176, v137, v176
    v_mul_f32 v177, v137, v177
    v_mfma_f32_16x16x16_bf16 v[212:215], v[28:29], a[250:251], v[212:215]
    v_mov_b32_dpp v164, v132 quad_perm:[0,1,2,3] row_mask:0x4 bank_mask:0xf
    v_cvt_pk_bf16_f32 v206, v176, v177
    v_mul_f32 v178, v137, v178
    v_mfma_f32_16x16x16_bf16 v[212:215], v[28:29], v[94:95], v[212:215]
    v_mul_f32 v179, v137, v179
    v_cvt_pk_bf16_f32 v207, v178, v179
    v_mul_f32 v124, v137, v124
    v_mul_f32 v125, v137, v125
    v_mfma_f32_16x16x32_bf16 v[120:123], v[228:231], a[156:159], v[120:123]
    s_waitcnt lgkmcnt(0)
    ds_write_b128 v159, v[140:143] offset:192
    v_mfma_f32_16x16x16_bf16 v[132:135], v[28:29], a[236:237], 0
    v_mov_b32_dpp v164, v212 quad_perm:[0,1,2,3] row_mask:0x8 bank_mask:0xf
    v_cvt_pk_bf16_f32 v178, v124, v125
    v_mul_f32 v126, v137, v126
    v_mfma_f32_16x16x16_bf16 v[132:135], v[28:29], v[80:81], v[132:135]
    v_mul_f32 v127, v137, v127
    v_cvt_pk_bf16_f32 v179, v126, v127
    v_mul_f32 v216, v136, v216
    v_mfma_f32_16x16x16_bf16 v[132:135], v[28:29], v[104:105], v[132:135]
    v_mul_f32 v217, v136, v217
    v_cvt_pk_bf16_f32 v124, v216, v217
    v_mul_f32 v218, v136, v218
    v_mfma_f32_16x16x16_bf16 v[140:143], v[28:29], a[228:229], 0
    v_mul_f32 v219, v136, v219
    v_cvt_pk_bf16_f32 v125, v218, v219
    v_mul_f32 v160, v136, v160
    v_mfma_f32_16x16x16_bf16 v[140:143], v[28:29], a[252:253], v[140:143]
    v_mul_f32 v161, v136, v161
    v_cvt_pk_bf16_f32 v126, v160, v161
    v_mul_f32 v162, v136, v162
    v_mfma_f32_16x16x16_bf16 v[140:143], v[28:29], v[96:97], v[140:143]
    v_mul_f32 v163, v136, v163
    v_cvt_pk_bf16_f32 v127, v162, v163
    v_mul_f32 v116, v136, v116
    v_mfma_f32_16x16x16_bf16 v[216:219], v[28:29], a[230:231], 0
    v_mul_f32 v117, v136, v117
    v_cvt_pk_bf16_f32 v176, v116, v117
    v_mul_f32 v118, v136, v118
    v_mfma_f32_16x16x16_bf16 v[216:219], v[28:29], a[254:255], v[216:219]
    v_mov_b32_dpp v132, v140 quad_perm:[0,1,2,3] row_mask:0x2 bank_mask:0xf
    v_mul_f32 v119, v136, v119
    v_cvt_pk_bf16_f32 v177, v118, v119
    v_mfma_f32_16x16x16_bf16 v[216:219], v[28:29], v[98:99], v[216:219]
    v_cvt_pk_bf16_f32 v129, v129, v129
    v_cvt_pk_bf16_f32 v130, v130, v130
    v_cvt_pk_bf16_f32 v131, v131, v131
    v_mfma_f32_16x16x16_bf16 v[116:119], v[28:29], a[238:239], 0
    v_cvt_pk_bf16_f32 v148, v148, v148
    v_cvt_pk_bf16_f32 v149, v149, v149
    v_cvt_pk_bf16_f32 v150, v150, v150
    v_mfma_f32_16x16x16_bf16 v[116:119], v[28:29], v[82:83], v[116:119]
    v_mov_b32_dpp v132, v216 quad_perm:[0,1,2,3] row_mask:0x4 bank_mask:0xf
    v_cvt_pk_bf16_f32 v151, v151, v151
    v_xor_b32 v2, 65536, v2
    v_mfma_f32_16x16x16_bf16 v[116:119], v[28:29], v[106:107], v[116:119]
    s_addc_u32 s9, s41, 0
    ds_write_b32 v153, v164 offset:1024
    s_sub_u32 s10, s36, s23
    v_mfma_f32_16x16x32_bf16 v[120:123], v[184:187], a[160:163], v[120:123]
    s_cmp_lt_u32 s34, s17
    ds_write2_b32 v154, v108, v109 offset0:0 offset1:68
    v_mfma_f32_16x16x32_bf16 v[120:123], v[200:203], a[164:167], v[120:123]
    s_cselect_b32 s10, s10, 0
    v_mov_b32_dpp v132, v116 quad_perm:[0,1,2,3] row_mask:0x8 bank_mask:0xf
    s_add_u32 m0, s28, 0
    v_mfma_f32_16x16x32_bf16 v[196:199], v[172:175], a[176:179], v[196:199]
    s_mov_b32 s24, s23
    ds_write_b32 v153, v132 offset:2048
    v_mfma_f32_16x16x32_bf16 v[196:199], v[228:231], a[180:183], v[196:199]
    s_add_u32 s23, s23, s21
    v_cvt_pk_bf16_f32 v120, v120, v120
    v_cvt_pk_bf16_f32 v121, v121, v121
    v_mfma_f32_16x16x32_bf16 v[196:199], v[184:187], a[184:187], v[196:199]
    s_cmp_ge_u32 s19, 72
    ds_read_b128 v[116:119], v0 offset:26624
    ds_read_b128 v[132:135], v1 offset:26624
    v_mfma_f32_16x16x32_bf16 v[196:199], v[200:203], a[188:191], v[196:199]
    s_cselect_b32 s34, 72, 0
    ds_read_b128 v[136:139], v0 offset:26752
    v_cvt_pk_bf16_f32 v122, v122, v122
    v_mfma_f32_16x16x32_bf16 v[208:211], v[112:115], a[196:199], v[208:211]
    s_cselect_b32 s35, s22, 0
    ds_read_b128 v[112:115], v0 offset:26880
    v_cvt_pk_bf16_f32 v123, v123, v123
    v_mfma_f32_16x16x32_bf16 v[208:211], v[172:175], a[200:203], v[208:211]
    s_sub_u32 s19, s19, s34
    ds_read_b128 v[164:167], v1 offset:26880
    v_cvt_pk_bf16_f32 v196, v196, v196
    v_mfma_f32_16x16x32_bf16 v[208:211], v[228:231], a[204:207], v[208:211]
    s_add_u32 s23, s23, s35
    ds_write2_b32 v154, v110, v111 offset0:136 offset1:204
    v_mfma_f32_16x16x32_bf16 v[208:211], v[184:187], a[208:211], v[208:211]
    s_waitcnt lgkmcnt(6)
    v_cvt_pk_bf16_f32 v197, v197, v197
    v_cvt_pk_bf16_f32 v198, v198, v198
    v_mfma_f32_16x16x32_bf16 v[208:211], v[200:203], a[212:215], v[208:211]
    s_barrier
    ds_read_b128 v[108:111], v146 offset:0
    ds_read_b128 v[184:187], v146 offset:1024
    v_mfma_f32_16x16x32_bf16 v[172:175], v[204:207], v[124:127], v[40:43]
    s_waitcnt lgkmcnt(7)
    ds_read_b128 v[228:231], v146 offset:2048
    v_cvt_pk_bf16_f32 v199, v199, v199
    v_mfma_f32_16x16x32_bf16 v[140:143], a[72:75], v[116:119], 0
    s_waitcnt lgkmcnt(6)
    ds_write2_b32 v154, v128, v129 offset0:16 offset1:84
    v_mfma_f32_16x16x32_bf16 v[140:143], a[76:79], v[132:135], v[140:143]
    s_waitcnt lgkmcnt(6)
    v_cvt_pk_bf16_f32 v208, v208, v208
    v_cvt_pk_bf16_f32 v209, v209, v209
    v_mfma_f32_16x16x32_bf16 v[140:143], a[80:83], v[136:139], v[140:143]
    s_waitcnt lgkmcnt(5)
    ds_write2_b32 v154, v130, v131 offset0:152 offset1:220
    v_mfma_f32_16x16x32_bf16 v[140:143], a[84:87], v[240:243], v[140:143]
    v_cvt_pk_bf16_f32 v210, v210, v210
    v_cvt_pk_bf16_f32 v211, v211, v211
    v_mfma_f32_16x16x32_bf16 v[140:143], a[88:91], v[112:115], v[140:143]
    ds_write2_b32 v154, v148, v149 offset0:32 offset1:100
    v_mfma_f32_16x16x32_bf16 v[140:143], a[92:95], v[164:167], v[140:143]
    s_waitcnt lgkmcnt(4)
    v_add_f32 v108, v108, v109
    v_add_f32 v110, v110, v111
    v_mfma_f32_16x16x32_bf16 v[128:131], a[96:99], v[116:119], 0
    s_waitcnt lgkmcnt(3)
    ds_write2_b32 v154, v150, v151 offset0:168 offset1:236
    v_mfma_f32_16x16x32_bf16 v[128:131], a[100:103], v[132:135], v[128:131]
    v_add_f32 v108, v108, v110
    v_mul_f32 v108, 0xbbaaaaab, v108
    v_mfma_f32_16x16x32_bf16 v[128:131], a[104:107], v[136:139], v[128:131]
    ds_write_b32 v147, v108 offset:0
    v_mfma_f32_16x16x32_bf16 v[128:131], a[108:111], v[240:243], v[128:131]
    v_add_f32 v184, v184, v185
    v_add_f32 v186, v186, v187
    v_mfma_f32_16x16x32_bf16 v[128:131], a[112:115], v[112:115], v[128:131]
    ds_read_b128 v[148:151], v152 offset:0
    ds_read_b128 v[108:111], v152 offset:64
    v_mfma_f32_16x16x32_bf16 v[128:131], a[116:119], v[164:167], v[128:131]
    ds_write2_b32 v158, v120, v121 offset0:0 offset1:68
    v_mfma_f32_16x16x32_bf16 v[216:219], a[120:123], v[116:119], 0
    v_add_f32 v184, v184, v186
    v_mul_f32 v184, 0xbbaaaaab, v184
    v_mfma_f32_16x16x32_bf16 v[216:219], a[124:127], v[132:135], v[216:219]
    ds_write_b32 v147, v184 offset:256
    v_mfma_f32_16x16x32_bf16 v[216:219], a[128:131], v[136:139], v[216:219]
    v_add_f32 v228, v228, v229
    v_add_f32 v230, v230, v231
    v_mfma_f32_16x16x32_bf16 v[216:219], a[132:135], v[240:243], v[216:219]
    ds_write2_b32 v158, v122, v123 offset0:136 offset1:204
    v_mfma_f32_16x16x32_bf16 v[216:219], a[136:139], v[112:115], v[216:219]
    v_add_f32 v228, v228, v230
    v_mul_f32 v228, 0xbbaaaaab, v228
    v_mfma_f32_16x16x32_bf16 v[216:219], a[140:143], v[164:167], v[216:219]
    s_waitcnt lgkmcnt(3)
    ds_write_b32 v147, v228 offset:512
    v_mfma_f32_16x16x32_bf16 v[120:123], a[0:3], v[116:119], 0
    v_fma_f32 v159, v140, v140, s32
    v_fmac_f32 v159, v141, v141
    v_mfma_f32_16x16x32_bf16 v[120:123], a[4:7], v[132:135], v[120:123]
    ds_write2_b32 v158, v196, v197 offset0:16 offset1:84
    v_mfma_f32_16x16x32_bf16 v[120:123], a[8:11], v[136:139], v[120:123]
    v_fmac_f32 v159, v142, v142
    v_fmac_f32 v159, v143, v143
    v_mfma_f32_16x16x32_bf16 v[120:123], a[12:15], v[240:243], v[120:123]
    ds_write2_b32 v158, v198, v199 offset0:152 offset1:220
    v_mfma_f32_16x16x32_bf16 v[120:123], a[16:19], v[112:115], v[120:123]
    v_fmac_f32 v159, v128, v128
    v_fmac_f32 v159, v129, v129
    v_mfma_f32_16x16x32_bf16 v[120:123], a[20:23], v[164:167], v[120:123]
    ds_write2_b32 v158, v208, v209 offset0:32 offset1:100
    v_mfma_f32_16x16x32_bf16 v[184:187], a[24:27], v[116:119], 0
    v_fmac_f32 v159, v130, v130
    v_fmac_f32 v159, v131, v131
    v_mfma_f32_16x16x32_bf16 v[184:187], a[28:31], v[132:135], v[184:187]
    ds_write2_b32 v158, v210, v211 offset0:168 offset1:236
    v_mfma_f32_16x16x32_bf16 v[184:187], a[32:35], v[136:139], v[184:187]
    v_fmac_f32 v159, v216, v216
    v_fma_f32 v158, v120, v120, s32
    v_mfma_f32_16x16x32_bf16 v[184:187], a[36:39], v[240:243], v[184:187]
    v_fmac_f32 v158, v121, v121
    v_fmac_f32 v158, v122, v122
    v_mfma_f32_16x16x32_bf16 v[184:187], a[40:43], v[112:115], v[184:187]
    v_fmac_f32 v158, v123, v123
    v_fmac_f32 v159, v217, v217
    v_mfma_f32_16x16x32_bf16 v[184:187], a[44:47], v[164:167], v[184:187]
    v_fmac_f32 v159, v218, v218
    v_fmac_f32 v159, v219, v219
    v_mfma_f32_16x16x32_bf16 v[228:231], a[48:51], v[116:119], 0
    v_mfma_f32_16x16x32_bf16 v[228:231], a[52:55], v[132:135], v[228:231]
    v_mfma_f32_16x16x32_bf16 v[228:231], a[56:59], v[136:139], v[228:231]
    v_mfma_f32_16x16x32_bf16 v[228:231], a[60:63], v[240:243], v[228:231]
    v_mfma_f32_16x16x32_bf16 v[228:231], a[64:67], v[112:115], v[228:231]
    v_mfma_f32_16x16x32_bf16 v[228:231], a[68:71], v[164:167], v[228:231]
    v_fmac_f32 v158, v184, v184
    v_fmac_f32 v158, v185, v185
    v_mfma_f32_16x16x32_bf16 v[196:199], v[116:119], a[144:147], 0
    v_fmac_f32 v158, v186, v186
    v_fmac_f32 v158, v187, v187
    v_mfma_f32_16x16x32_bf16 v[196:199], v[132:135], a[148:151], v[196:199]
    v_mfma_f32_16x16x32_bf16 v[196:199], v[136:139], a[152:155], v[196:199]
    v_mfma_f32_16x16x32_bf16 v[196:199], v[240:243], a[156:159], v[196:199]
    v_fmac_f32 v158, v228, v228
    v_fmac_f32 v158, v229, v229
    v_mfma_f32_16x16x32_bf16 v[196:199], v[112:115], a[160:163], v[196:199]
    v_fmac_f32 v158, v230, v230
    v_fmac_f32 v158, v231, v231
    v_mfma_f32_16x16x32_bf16 v[196:199], v[164:167], a[164:167], v[196:199]
    v_cvt_pk_bf16_f32 v36, v158, v159
    v_mfma_f32_16x16x32_bf16 v[200:203], v[116:119], a[168:171], 0
    v_mfma_f32_16x16x32_bf16 v[200:203], v[132:135], a[172:175], v[200:203]
    v_mfma_f32_16x16x32_bf16 v[208:211], v[32:35], v[36:39], 0
    v_mfma_f32_16x16x32_bf16 v[200:203], v[136:139], a[176:179], v[200:203]
    v_mfma_f32_16x16x32_bf16 v[200:203], v[240:243], a[180:183], v[200:203]
    ds_read_b128 v[160:163], v0 offset:32768
    v_mfma_f32_16x16x32_bf16 v[200:203], v[112:115], a[184:187], v[200:203]
    ds_read_b128 v[212:215], v1 offset:32768
    v_cvt_pk_bf16_f32 v146, v196, v197
    v_mfma_f32_16x16x32_bf16 v[200:203], v[164:167], a[188:191], v[200:203]
    ds_read_b128 v[248:251], v0 offset:32896
    v_cvt_pk_bf16_f32 v147, v198, v199
    v_mfma_f32_16x16x32_bf16 v[196:199], v[116:119], a[192:195], 0
    ds_read_b128 v[116:119], v1 offset:32896
    v_mfma_f32_16x16x32_bf16 v[196:199], v[132:135], a[196:199], v[196:199]
    ds_read_b128 v[224:227], v0 offset:33024
    v_xor_b32 v0, 65536, v0
    v_mfma_f32_16x16x32_bf16 v[196:199], v[136:139], a[200:203], v[196:199]
    ds_read_b128 v[132:135], v1 offset:33024
    v_cvt_pk_bf16_f32 v158, v200, v201
    v_mfma_f32_16x16x32_bf16 v[196:199], v[240:243], a[204:207], v[196:199]
    v_rsq_f32 v209, v209
    v_mfma_f32_16x16x32_bf16 v[196:199], v[112:115], a[208:211], v[196:199]
    v_rsq_f32 v208, v208
    v_mfma_f32_16x16x32_bf16 v[196:199], v[164:167], a[212:215], v[196:199]
    s_waitcnt lgkmcnt(5)
    v_mul_f32 v208, s31, v208
    v_cvt_pk_bf16_f32 v159, v202, v203
    v_mfma_f32_16x16x32_bf16 v[112:115], a[72:75], v[160:163], 0
    s_waitcnt lgkmcnt(4)
    v_mul_f32 v140, v209, v140
    v_mul_f32 v141, v209, v141
    v_mfma_f32_16x16x32_bf16 v[112:115], a[76:79], v[212:215], v[112:115]
    s_waitcnt lgkmcnt(3)
    v_cvt_pk_bf16_f32 v190, v196, v197
    v_cvt_pk_bf16_f32 v191, v198, v199
    v_mfma_f32_16x16x32_bf16 v[112:115], a[80:83], v[248:251], v[112:115]
    s_waitcnt lgkmcnt(2)
    v_cvt_pk_bf16_f32 v136, v140, v141
    v_mul_f32 v142, v209, v142
    v_mfma_f32_16x16x32_bf16 v[112:115], a[84:87], v[116:119], v[112:115]
    s_waitcnt lgkmcnt(1)
    v_mul_f32 v143, v209, v143
    v_cvt_pk_bf16_f32 v137, v142, v143
    v_mfma_f32_16x16x32_bf16 v[112:115], a[88:91], v[224:227], v[112:115]
    s_waitcnt lgkmcnt(0)
    v_mul_f32 v128, v209, v128
    v_mul_f32 v129, v209, v129
    v_mfma_f32_16x16x32_bf16 v[112:115], a[92:95], v[132:135], v[112:115]
    v_cvt_pk_bf16_f32 v138, v128, v129
    v_mul_f32 v130, v209, v130
    v_mfma_f32_16x16x32_bf16 v[164:167], a[96:99], v[160:163], 0
    v_mul_f32 v131, v209, v131
    v_cvt_pk_bf16_f32 v139, v130, v131
    v_mfma_f32_16x16x32_bf16 v[164:167], a[100:103], v[212:215], v[164:167]
    v_mul_f32 v216, v209, v216
    v_mul_f32 v217, v209, v217
    v_mfma_f32_16x16x32_bf16 v[164:167], a[104:107], v[248:251], v[164:167]
    v_cvt_pk_bf16_f32 v130, v216, v217
    v_mul_f32 v218, v209, v218
    v_mfma_f32_16x16x32_bf16 v[164:167], a[108:111], v[116:119], v[164:167]
    v_mul_f32 v219, v209, v219
    v_cvt_pk_bf16_f32 v131, v218, v219
    v_mfma_f32_16x16x32_bf16 v[164:167], a[112:115], v[224:227], v[164:167]
    v_mul_f32 v120, v208, v120
    v_mul_f32 v121, v208, v121
    v_mfma_f32_16x16x32_bf16 v[164:167], a[116:119], v[132:135], v[164:167]
    v_cvt_pk_bf16_f32 v120, v120, v121
    v_mul_f32 v122, v208, v122
    v_mfma_f32_16x16x32_bf16 v[196:199], a[120:123], v[160:163], 0
    v_mul_f32 v123, v208, v123
    v_cvt_pk_bf16_f32 v121, v122, v123
    v_mfma_f32_16x16x32_bf16 v[196:199], a[124:127], v[212:215], v[196:199]
    v_mul_f32 v184, v208, v184
    v_mul_f32 v185, v208, v185
    v_mfma_f32_16x16x32_bf16 v[196:199], a[128:131], v[248:251], v[196:199]
    v_cvt_pk_bf16_f32 v122, v184, v185
    v_mul_f32 v186, v208, v186
    v_mfma_f32_16x16x32_bf16 v[196:199], a[132:135], v[116:119], v[196:199]
    v_mul_f32 v187, v208, v187
    v_cvt_pk_bf16_f32 v123, v186, v187
    v_mfma_f32_16x16x32_bf16 v[196:199], a[136:139], v[224:227], v[196:199]
    v_mul_f32 v228, v208, v228
    v_mul_f32 v229, v208, v229
    v_mfma_f32_16x16x32_bf16 v[196:199], a[140:143], v[132:135], v[196:199]
    v_cvt_pk_bf16_f32 v128, v228, v229
    v_mul_f32 v230, v208, v230
    v_mfma_f32_16x16x32_bf16 v[184:187], a[0:3], v[160:163], 0
    v_mul_f32 v231, v208, v231
    v_cvt_pk_bf16_f32 v129, v230, v231
    v_mfma_f32_16x16x32_bf16 v[184:187], a[4:7], v[212:215], v[184:187]
    v_fma_f32 v168, v112, v112, s32
    v_fmac_f32 v168, v113, v113
    v_mfma_f32_16x16x32_bf16 v[184:187], a[8:11], v[248:251], v[184:187]
    v_fmac_f32 v168, v114, v114
    v_fmac_f32 v168, v115, v115
    v_mfma_f32_16x16x32_bf16 v[184:187], a[12:15], v[116:119], v[184:187]
    v_fmac_f32 v168, v164, v164
    v_fmac_f32 v168, v165, v165
    v_mfma_f32_16x16x32_bf16 v[184:187], a[16:19], v[224:227], v[184:187]
    v_fmac_f32 v168, v166, v166
    v_fmac_f32 v168, v167, v167
    v_mfma_f32_16x16x32_bf16 v[184:187], a[20:23], v[132:135], v[184:187]
    v_fmac_f32 v168, v196, v196
    v_fmac_f32 v168, v197, v197
    v_mfma_f32_16x16x32_bf16 v[228:231], a[24:27], v[160:163], 0
    v_fmac_f32 v168, v198, v198
    v_fmac_f32 v168, v199, v199
    v_mfma_f32_16x16x32_bf16 v[228:231], a[28:31], v[212:215], v[228:231]
    v_xor_b32 v1, 65536, v1
    v_mfma_f32_16x16x32_bf16 v[228:231], a[32:35], v[248:251], v[228:231]
    v_fma_f32 v169, v184, v184, s32
    v_fmac_f32 v169, v185, v185
    v_mfma_f32_16x16x32_bf16 v[228:231], a[36:39], v[116:119], v[228:231]
    v_fmac_f32 v169, v186, v186
    v_fmac_f32 v169, v187, v187
    v_mfma_f32_16x16x32_bf16 v[228:231], a[40:43], v[224:227], v[228:231]
    v_mfma_f32_16x16x32_bf16 v[228:231], a[44:47], v[132:135], v[228:231]
    v_mfma_f32_16x16x32_bf16 v[140:143], a[48:51], v[160:163], 0
    v_mfma_f32_16x16x32_bf16 v[140:143], a[52:55], v[212:215], v[140:143]
    v_mfma_f32_16x16x32_bf16 v[140:143], a[56:59], v[248:251], v[140:143]
    v_mfma_f32_16x16x32_bf16 v[140:143], a[60:63], v[116:119], v[140:143]
    v_mfma_f32_16x16x32_bf16 v[140:143], a[64:67], v[224:227], v[140:143]
    v_mfma_f32_16x16x32_bf16 v[140:143], a[68:71], v[132:135], v[140:143]
    v_mfma_f32_16x16x32_bf16 v[240:243], v[160:163], a[144:147], 0
    ds_read_b128 v[216:219], v5 offset:0
    ds_read_b128 v[208:211], v5 offset:16
    v_mfma_f32_16x16x32_bf16 v[240:243], v[212:215], a[148:151], v[240:243]
    ds_read_b128 v[200:203], v5 offset:48
    ds_read_b32 v153, v6 offset:192
    v_mfma_f32_16x16x32_bf16 v[240:243], v[248:251], a[152:155], v[240:243]
    v_fmac_f32 v169, v228, v228
    v_fmac_f32 v169, v229, v229
    v_mfma_f32_16x16x32_bf16 v[240:243], v[116:119], a[156:159], v[240:243]
    v_fmac_f32 v169, v230, v230
    v_fmac_f32 v169, v231, v231
    v_mfma_f32_16x16x32_bf16 v[240:243], v[224:227], a[160:163], v[240:243]
    v_fmac_f32 v169, v140, v140
    v_fmac_f32 v169, v141, v141
    v_mfma_f32_16x16x32_bf16 v[240:243], v[132:135], a[164:167], v[240:243]
    v_fmac_f32 v169, v142, v142
    v_fmac_f32 v169, v143, v143
    v_mfma_f32_16x16x32_bf16 v[220:223], v[160:163], a[168:171], 0
    v_cvt_pk_bf16_f32 v36, v169, v168
    v_add_u32 v5, 336, v5
    v_mfma_f32_16x16x32_bf16 v[220:223], v[212:215], a[172:175], v[220:223]
    v_mfma_f32_16x16x32_bf16 v[180:183], v[32:35], v[36:39], 0
    s_waitcnt lgkmcnt(2)
    v_cvt_pk_bf16_f32 v240, v240, v241
    v_cvt_pk_bf16_f32 v241, v242, v243
    v_mfma_f32_16x16x32_bf16 v[232:235], v[216:219], v[124:127], v[22:25]
    s_waitcnt lgkmcnt(0)
    v_mfma_f32_16x16x32_bf16 v[232:235], v[208:211], v[204:207], v[232:235]
    v_mfma_f32_16x16x32_bf16 v[232:235], v[200:203], v[176:179], v[232:235]
    v_mfma_f32_16x16x32_bf16 v[220:223], v[248:251], a[176:179], v[220:223]
    v_rsq_f32 v181, v181
    v_mfma_f32_16x16x32_bf16 v[220:223], v[116:119], a[180:183], v[220:223]
    v_rsq_f32 v180, v180
    v_mfma_f32_16x16x32_bf16 v[220:223], v[224:227], a[184:187], v[220:223]
    v_mul_f32 v180, s31, v180
    v_mul_f32 v112, v181, v112
    v_mfma_f32_16x16x32_bf16 v[220:223], v[132:135], a[188:191], v[220:223]
    v_mov_b32_dpp v153, v233 quad_perm:[0,1,2,3] row_mask:0x1 bank_mask:0xf
    v_mul_f32 v113, v181, v113
    v_cvt_pk_bf16_f32 v112, v112, v113
    v_mfma_f32_16x16x32_bf16 v[236:239], v[160:163], a[192:195], 0
    v_mul_f32 v114, v181, v114
    v_mul_f32 v115, v181, v115
    v_mfma_f32_16x16x32_bf16 v[236:239], v[212:215], a[196:199], v[236:239]
    v_cvt_pk_bf16_f32 v113, v114, v115
    v_cvt_pk_bf16_f32 v160, v220, v221
    v_mfma_f32_16x16x32_bf16 v[236:239], v[248:251], a[200:203], v[236:239]
    v_cvt_pk_bf16_f32 v161, v222, v223
    v_mul_f32 v164, v181, v164
    v_mfma_f32_16x16x32_bf16 v[236:239], v[116:119], a[204:207], v[236:239]
    v_mul_f32 v165, v181, v165
    v_cvt_pk_bf16_f32 v114, v164, v165
    v_mfma_f32_16x16x32_bf16 v[236:239], v[224:227], a[208:211], v[236:239]
    ds_read2_b32 v[242:243], v6 offset0:0 offset1:0
    ds_read2_b32 v[162:163], v6 offset0:16 offset1:16
    v_mfma_f32_16x16x32_bf16 v[236:239], v[132:135], a[212:215], v[236:239]
    s_waitcnt vmcnt(0)
    ds_read2_b32 v[118:119], v6 offset0:32 offset1:32
    v_mul_f32 v166, v181, v166
    v_mfma_f32_16x16x32_bf16 v[132:135], v[136:139], v[124:127], v[44:47]
    s_barrier
    buffer_load_dwordx4 v10, s[8:11], 0 offen nt lds
    v_mul_f32 v167, v181, v167
    v_cvt_pk_bf16_f32 v115, v166, v167
    v_mfma_f32_16x16x16_bf16 v[172:175], v[178:179], v[176:177], v[172:175]
    v_cvt_pk_bf16_f32 v116, v236, v237
    v_cvt_pk_bf16_f32 v117, v238, v239
    v_mul_f32 v196, v181, v196
    v_mul_f32 v197, v181, v197
    v_mfma_f32_16x16x32_bf16 v[164:167], v[112:115], v[124:127], v[48:51]
    s_add_u32 m0, s28, 4096
    v_cvt_pk_bf16_f32 v126, v196, v197
    v_mul_f32 v198, v181, v198
    v_mul_f32 v199, v181, v199
    v_mfma_f32_16x16x16_bf16 v[132:135], v[130:131], v[176:177], v[132:135]
    v_cvt_pk_bf16_f32 v127, v198, v199
    v_mul_f32 v184, v180, v184
    v_mul_f32 v185, v180, v185
    v_mfma_f32_16x16x16_bf16 v[164:167], v[126:127], v[176:177], v[164:167]
    v_cvt_pk_bf16_f32 v184, v184, v185
    v_mul_f32 v186, v180, v186
    v_mul_f32 v187, v180, v187
    v_cvt_pk_bf16_f32 v185, v186, v187
    v_mfma_f32_16x16x32_bf16 v[196:199], v[216:219], v[120:123], v[24:27]
    s_waitcnt lgkmcnt(1)
    buffer_load_dwordx4 v11, s[8:11], 0 offen nt lds
    v_mul_f32 v228, v180, v228
    v_mfma_f32_16x16x32_bf16 v[196:199], v[208:211], v[136:139], v[196:199]
    s_add_u32 m0, s28, 8192
    v_mul_f32 v229, v180, v229
    v_cvt_pk_bf16_f32 v186, v228, v229
    v_mfma_f32_16x16x32_bf16 v[196:199], v[200:203], v[128:131], v[196:199]
    s_waitcnt lgkmcnt(0)
    v_mul_f32 v230, v180, v230
    v_mul_f32 v231, v180, v231
    v_cvt_pk_bf16_f32 v187, v230, v231
    v_mfma_f32_16x16x16_bf16 v[228:231], a[216:217], v[170:171], v[148:151]
    v_mul_f32 v140, v180, v140
    v_mul_f32 v141, v180, v141
    v_cvt_pk_bf16_f32 v124, v140, v141
    v_mul_f32 v142, v180, v142
    v_mfma_f32_16x16x32_bf16 v[212:215], v[216:219], v[184:187], v[26:29]
    buffer_load_dwordx4 v12, s[8:11], 0 offen nt lds
    v_mul_f32 v143, v180, v143
    v_mfma_f32_16x16x32_bf16 v[212:215], v[208:211], v[112:115], v[212:215]
    s_add_u32 m0, s28, 12288
    v_cvt_pk_bf16_f32 v125, v142, v143
    v_max3_f32 v154, v232, v172, v173
    v_max3_f32 v154, v154, v174, v175
    v_mfma_f32_16x16x32_bf16 v[212:215], v[200:203], v[124:127], v[212:215]
    s_xor_b32 s28, s28, 65536
    v_max3_f32 v154, v154, v132, v133
    v_max3_f32 v154, v154, v134, v135
    v_max3_f32 v154, v154, v164, v165
    v_mfma_f32_16x16x16_bf16 v[140:143], a[240:241], v[170:171], v[148:151]
    v_max3_f32 v154, v154, v166, v167
    v_mov_b32 v155, v154
    v_mov_b32_dpp v153, v197 quad_perm:[0,1,2,3] row_mask:0x2 bank_mask:0xf
    v_mfma_f32_16x16x16_bf16 v[216:219], v[84:85], v[170:171], v[148:151]
    v_permlane32_swap_b32 v154, v155
    v_max_f32 v154, v154, v155
    v_mfma_f32_16x16x16_bf16 v[208:211], a[218:219], v[170:171], v[108:111]
    v_mov_b32 v155, v154
    v_mov_b32_dpp v153, v213 quad_perm:[0,1,2,3] row_mask:0x4 bank_mask:0xf
    v_mov_b32 v168, v153
    v_mfma_f32_16x16x16_bf16 v[148:151], a[242:243], v[170:171], v[108:111]
    v_permlane16_swap_b32 v154, v155
    v_max_f32 v154, v154, v155
    v_mfma_f32_16x16x16_bf16 v[200:203], v[86:87], v[170:171], v[108:111]
    buffer_load_dwordx4 v13, s[8:11], 0 offen nt lds
    s_mov_b32 m0, s29
    s_xor_b32 s29, s29, s30
    v_sub_f32 v172, v172, v154
    v_exp_f32 v172, v172
    v_sub_f32 v173, v173, v154
    v_exp_f32 v173, v173
    v_sub_f32 v174, v174, v154
    v_cvt_pk_bf16_f32 v108, v172, v173
    v_exp_f32 v174, v174
    v_sub_f32 v175, v175, v154
    v_exp_f32 v175, v175
    buffer_load_dwordx4 v14, s[8:11], 0 offen nt lds
    v_cvt_pk_bf16_f32 v109, v174, v175
    v_sub_f32 v132, v132, v154
    v_exp_f32 v132, v132
    v_sub_f32 v133, v133, v154
    v_exp_f32 v133, v133
    v_mfma_f32_16x16x32_bf16 v[172:175], v[204:207], v[120:123], v[52:55]
    v_cvt_pk_bf16_f32 v110, v132, v133
    v_sub_f32 v134, v134, v154
    v_exp_f32 v134, v134
    v_sub_f32 v135, v135, v154
    v_exp_f32 v135, v135
    v_sub_f32 v164, v164, v154
    v_mfma_f32_16x16x16_bf16 v[172:175], v[178:179], v[128:129], v[172:175]
    v_cvt_pk_bf16_f32 v111, v134, v135
    v_exp_f32 v164, v164
    v_sub_f32 v165, v165, v154
    v_exp_f32 v165, v165
    v_mfma_f32_16x16x32_bf16 v[132:135], v[136:139], v[120:123], v[56:59]
    v_cvt_pk_bf16_f32 v36, v164, v165
    v_sub_f32 v166, v166, v154
    v_exp_f32 v166, v166
    v_sub_f32 v167, v167, v154
    v_exp_f32 v167, v167
    v_mfma_f32_16x16x32_bf16 v[248:251], v[112:115], v[120:123], v[60:63]
    v_cvt_pk_bf16_f32 v37, v166, v167
    v_sub_f32 v232, v232, v154
    v_max3_f32 v169, v196, v172, v173
    v_mfma_f32_16x16x16_bf16 v[132:135], v[130:131], v[128:129], v[132:135]
    v_exp_f32 v232, v232
    v_max3_f32 v169, v169, v174, v175
    v_mfma_f32_16x16x16_bf16 v[248:251], v[126:127], v[128:129], v[248:251]
    v_cvt_pk_bf16_f32 v39, v232, 0
    v_max_f32_dpp v168, v168, v168 quad_perm:[1,0,3,2] row_mask:0xf bank_mask:0xf
    v_cvt_pk_bf16_f32 v228, v228, v229
    v_accvgpr_write_b32 a216, v228
    v_mfma_f32_16x16x32_bf16 v[120:123], v[28:31], v[36:39], 0
    v_max3_f32 v169, v169, v132, v133
    v_max3_f32 v169, v169, v134, v135
    v_mfma_f32_16x16x32_bf16 v[120:123], v[28:31], v[108:111], v[120:123]
    v_max3_f32 v169, v169, v248, v249
    v_max3_f32 v169, v169, v250, v251
    v_mfma_f32_16x16x32_bf16 v[164:167], v[240:243], v[36:39], 0
    v_mov_b32 v128, v169
    v_max_f32_dpp v168, v168, v168 quad_perm:[2,3,0,1] row_mask:0xf bank_mask:0xf
    v_mfma_f32_16x16x32_bf16 v[164:167], v[144:147], v[108:111], v[164:167]
    v_permlane32_swap_b32 v169, v128
    v_mfma_f32_16x16x32_bf16 v[224:227], v[160:163], v[36:39], 0
    v_max_f32 v169, v169, v128
    v_mov_b32 v128, v169
    v_mfma_f32_16x16x32_bf16 v[224:227], v[156:159], v[108:111], v[224:227]
    v_rcp_f32 v120, v120
    v_mfma_f32_16x16x32_bf16 v[232:235], v[116:119], v[36:39], 0
    v_permlane16_swap_b32 v169, v128
    v_mfma_f32_16x16x32_bf16 v[232:235], v[188:191], v[108:111], v[232:235]
    v_max_f32 v169, v169, v128
    v_sub_f32 v172, v172, v169
    v_exp_f32 v172, v172
    v_sub_f32 v173, v173, v169
    v_exp_f32 v173, v173
    v_sub_f32 v174, v174, v169
    v_cvt_pk_bf16_f32 v108, v172, v173
    v_exp_f32 v174, v174
    v_sub_f32 v175, v175, v169
    v_exp_f32 v175, v175
    v_sub_f32 v132, v132, v169
    v_cvt_pk_bf16_f32 v109, v174, v175
    v_exp_f32 v132, v132
    v_sub_f32 v133, v133, v169
    v_exp_f32 v133, v133
    v_sub_f32 v134, v134, v169
    v_cvt_pk_bf16_f32 v110, v132, v133
    v_exp_f32 v134, v134
    v_sub_f32 v135, v135, v169
    v_exp_f32 v135, v135
    v_sub_f32 v248, v248, v169
    v_cvt_pk_bf16_f32 v111, v134, v135
    v_exp_f32 v248, v248
    v_sub_f32 v249, v249, v169
    v_exp_f32 v249, v249
    v_sub_f32 v250, v250, v169
    v_cvt_pk_bf16_f32 v36, v248, v249
    v_exp_f32 v250, v250
    v_sub_f32 v251, v251, v169
    v_exp_f32 v251, v251
    v_mfma_f32_16x16x32_bf16 v[132:135], v[204:207], v[184:187], v[64:67]
    v_cvt_pk_bf16_f32 v37, v250, v251
    v_sub_f32 v196, v196, v169
    v_mfma_f32_16x16x32_bf16 v[248:251], v[136:139], v[184:187], v[68:71]
    v_exp_f32 v196, v196
    v_mfma_f32_16x16x32_bf16 v[136:139], v[112:115], v[184:187], v[72:75]
    v_cvt_pk_bf16_f32 v39, v196, 0
    v_mul_f32 v164, v120, v164
    v_mul_f32 v165, v120, v165
    v_mfma_f32_16x16x32_bf16 v[180:183], v[28:31], v[36:39], 0
    v_cvt_pk_bf16_f32 v112, v164, v165
    v_mul_f32 v166, v120, v166
    v_mfma_f32_16x16x32_bf16 v[180:183], v[28:31], v[108:111], v[180:183]
    v_mul_f32 v167, v120, v167
    v_cvt_pk_bf16_f32 v113, v166, v167
    v_mfma_f32_16x16x32_bf16 v[164:167], v[240:243], v[36:39], 0
    v_mul_f32 v224, v120, v224
    v_mul_f32 v225, v120, v225
    v_mfma_f32_16x16x32_bf16 v[164:167], v[144:147], v[108:111], v[164:167]
    v_cvt_pk_bf16_f32 v114, v224, v225
    v_mul_f32 v226, v120, v226
    v_mfma_f32_16x16x32_bf16 v[220:223], v[160:163], v[36:39], 0
    v_mul_f32 v227, v120, v227
    v_cvt_pk_bf16_f32 v115, v226, v227
    v_mfma_f32_16x16x32_bf16 v[220:223], v[156:159], v[108:111], v[220:223]
    ds_write_b128 v3, v[112:115] offset:0
    v_mfma_f32_16x16x32_bf16 v[224:227], v[116:119], v[36:39], 0
    v_mul_f32 v232, v120, v232
    v_mul_f32 v233, v120, v233
    v_mfma_f32_16x16x32_bf16 v[224:227], v[188:191], v[108:111], v[224:227]
    v_cvt_pk_bf16_f32 v154, v232, v233
    v_mul_f32 v234, v120, v234
    v_mul_f32 v235, v120, v235
    v_mfma_f32_16x16x16_bf16 v[132:135], v[178:179], v[124:125], v[132:135]
    v_cvt_pk_bf16_f32 v155, v234, v235
    v_max_f32_dpp v168, v168, v168 row_half_mirror row_mask:0xf bank_mask:0xf
    v_cvt_pk_bf16_f32 v230, v230, v231
    v_mfma_f32_16x16x16_bf16 v[248:251], v[130:131], v[124:125], v[248:251]
    v_max_f32_dpp v168, v168, v168 row_mirror row_mask:0xf bank_mask:0xf
    v_mov_b32 v169, v168
    v_accvgpr_write_b32 a217, v230
    v_mfma_f32_16x16x16_bf16 v[136:139], v[126:127], v[124:125], v[136:139]
    ds_write_b64 v4, v[154:155] offset:4096
    v_permlane32_swap_b32 v168, v169
    v_max_f32 v168, v168, v169
    v_mov_b32 v169, v168
    v_cvt_pk_bf16_f32 v140, v140, v141
    v_accvgpr_write_b32 a240, v140
    v_permlane16_swap_b32 v168, v169
    v_max_f32 v168, v168, v169
    v_sub_f32 v153, v153, v168
    v_exp_f32 v153, v153
    v_cvt_pk_bf16_f32 v142, v142, v143
    v_cvt_pk_bf16_f32 v153, v153, v153
    ds_write_b16 v8, v153
    v_accvgpr_write_b32 a241, v142
    v_cvt_pk_bf16_f32 v84, v216, v217
    v_cvt_pk_bf16_f32 v85, v218, v219
    ds_read_b128 v[120:123], v152 offset:128
    v_cvt_pk_bf16_f32 v208, v208, v209
    v_accvgpr_write_b32 a218, v208
    v_cvt_pk_bf16_f32 v210, v210, v211
    v_accvgpr_write_b32 a219, v210
    v_cvt_pk_bf16_f32 v148, v148, v149
    v_accvgpr_write_b32 a242, v148
    v_cvt_pk_bf16_f32 v150, v150, v151
    v_accvgpr_write_b32 a243, v150
    v_cvt_pk_bf16_f32 v86, v200, v201
    v_cvt_pk_bf16_f32 v87, v202, v203
    ds_read_b128 v[112:115], v152 offset:192
    v_max3_f32 v168, v212, v132, v133
    v_max3_f32 v168, v168, v134, v135
    v_max3_f32 v168, v168, v248, v249
    v_max3_f32 v168, v168, v250, v251
    v_max3_f32 v168, v168, v136, v137
    v_max3_f32 v168, v168, v138, v139
    v_mov_b32 v169, v168
    v_rcp_f32 v180, v180
    v_add_u32 v6, 272, v6
    v_permlane32_swap_b32 v168, v169
    v_max_f32 v168, v168, v169
    v_mov_b32 v169, v168
    s_waitcnt lgkmcnt(1)
    v_mfma_f32_16x16x16_bf16 v[128:131], a[232:233], v[170:171], v[120:123]
    v_permlane16_swap_b32 v168, v169
    v_max_f32 v168, v168, v169
    v_mfma_f32_16x16x16_bf16 v[124:127], v[76:77], v[170:171], v[120:123]
    v_sub_f32 v132, v132, v168
    v_exp_f32 v132, v132
    v_mfma_f32_16x16x16_bf16 v[148:151], v[100:101], v[170:171], v[120:123]
    v_sub_f32 v133, v133, v168
    v_exp_f32 v133, v133
    s_waitcnt lgkmcnt(0)
    v_mfma_f32_16x16x16_bf16 v[184:187], a[220:221], v[170:171], v[112:115]
    v_cvt_pk_bf16_f32 v128, v128, v129
    v_accvgpr_write_b32 a232, v128
    v_cvt_pk_bf16_f32 v130, v130, v131
    v_mfma_f32_16x16x16_bf16 v[120:123], a[244:245], v[170:171], v[112:115]
    v_accvgpr_write_b32 a233, v130
    v_cvt_pk_bf16_f32 v76, v124, v125
    v_cvt_pk_bf16_f32 v77, v126, v127
    v_mfma_f32_16x16x16_bf16 v[124:127], v[88:89], v[170:171], v[112:115]
    v_cvt_pk_bf16_f32 v100, v148, v149
    v_cvt_pk_bf16_f32 v101, v150, v151
    ds_read_b128 v[128:131], v152 offset:256
    v_cvt_pk_bf16_f32 v184, v184, v185
    v_accvgpr_write_b32 a220, v184
    v_cvt_pk_bf16_f32 v186, v186, v187
    v_accvgpr_write_b32 a221, v186
    v_cvt_pk_bf16_f32 v120, v120, v121
    v_accvgpr_write_b32 a244, v120
    v_cvt_pk_bf16_f32 v122, v122, v123
    v_accvgpr_write_b32 a245, v122
    v_cvt_pk_bf16_f32 v88, v124, v125
    v_cvt_pk_bf16_f32 v89, v126, v127
    ds_read_b128 v[120:123], v152 offset:320
    v_cvt_pk_bf16_f32 v132, v132, v133
    v_sub_f32 v134, v134, v168
    v_exp_f32 v134, v134
    ds_read_b128 v[196:199], v0 offset:20480
    ds_read_b128 v[184:187], v1 offset:20480
    ds_read_b128 v[172:175], v0 offset:20608
    ds_read_b128 v[148:151], v1 offset:20608
    ds_read_b128 v[112:115], v0 offset:20736
    s_waitcnt lgkmcnt(6)
    v_mfma_f32_16x16x16_bf16 v[124:127], a[222:223], v[170:171], v[128:131]
    v_sub_f32 v135, v135, v168
    v_exp_f32 v135, v135
    v_mfma_f32_16x16x16_bf16 v[108:111], a[246:247], v[170:171], v[128:131]
    v_cvt_pk_bf16_f32 v133, v134, v135
    v_sub_f32 v248, v248, v168
    v_sub_f32 v249, v249, v168
    v_mfma_f32_16x16x16_bf16 v[176:179], v[90:91], v[170:171], v[128:131]
    ds_read_b128 v[228:231], v1 offset:20736
    s_waitcnt lgkmcnt(6)
    v_mfma_f32_16x16x16_bf16 v[140:143], a[234:235], v[170:171], v[120:123]
    v_cvt_pk_bf16_f32 v124, v124, v125
    v_accvgpr_write_b32 a222, v124
    v_cvt_pk_bf16_f32 v126, v126, v127
    v_mfma_f32_16x16x16_bf16 v[128:131], v[78:79], v[170:171], v[120:123]
    v_accvgpr_write_b32 a223, v126
    v_cvt_pk_bf16_f32 v108, v108, v109
    v_accvgpr_write_b32 a246, v108
    v_mfma_f32_16x16x16_bf16 v[124:127], v[102:103], v[170:171], v[120:123]
    s_waitcnt lgkmcnt(3)
    v_cvt_pk_bf16_f32 v110, v110, v111
    v_accvgpr_write_b32 a247, v110
    v_cvt_pk_bf16_f32 v90, v176, v177
    v_mfma_f32_16x16x32_bf16 v[204:207], a[72:75], v[196:199], 0
    s_waitcnt lgkmcnt(1)
    v_cvt_pk_bf16_f32 v91, v178, v179
    v_cvt_pk_bf16_f32 v140, v140, v141
    v_mfma_f32_16x16x32_bf16 v[204:207], a[76:79], v[184:187], v[204:207]
    ds_read_b128 v[120:123], v152 offset:384
    v_accvgpr_write_b32 a234, v140
    v_mfma_f32_16x16x32_bf16 v[204:207], a[80:83], v[172:175], v[204:207]
    v_cvt_pk_bf16_f32 v142, v142, v143
    v_accvgpr_write_b32 a235, v142
    v_mfma_f32_16x16x32_bf16 v[204:207], a[84:87], v[148:151], v[204:207]
    s_waitcnt lgkmcnt(1)
    v_cvt_pk_bf16_f32 v78, v128, v129
    v_cvt_pk_bf16_f32 v79, v130, v131
    v_mfma_f32_16x16x32_bf16 v[204:207], a[88:91], v[112:115], v[204:207]
    v_cvt_pk_bf16_f32 v102, v124, v125
    v_cvt_pk_bf16_f32 v103, v126, v127
    v_mfma_f32_16x16x32_bf16 v[204:207], a[92:95], v[228:231], v[204:207]
    ds_read_b128 v[124:127], v152 offset:448
    v_sub_f32 v250, v250, v168
    v_mfma_f32_16x16x32_bf16 v[176:179], a[96:99], v[196:199], 0
    v_exp_f32 v248, v248
    v_mfma_f32_16x16x32_bf16 v[176:179], a[100:103], v[184:187], v[176:179]
    v_exp_f32 v249, v249
    v_mfma_f32_16x16x32_bf16 v[176:179], a[104:107], v[172:175], v[176:179]
    v_cvt_pk_bf16_f32 v134, v248, v249
    v_sub_f32 v251, v251, v168
    v_mfma_f32_16x16x32_bf16 v[176:179], a[108:111], v[148:151], v[176:179]
    s_waitcnt lgkmcnt(1)
    v_exp_f32 v250, v250
    v_sub_f32 v136, v136, v168
    v_mfma_f32_16x16x16_bf16 v[128:131], a[224:225], v[170:171], v[120:123]
    v_exp_f32 v251, v251
    v_sub_f32 v137, v137, v168
    v_mfma_f32_16x16x16_bf16 v[108:111], a[248:249], v[170:171], v[120:123]
    v_cvt_pk_bf16_f32 v135, v250, v251
    v_exp_f32 v136, v136
    v_mfma_f32_16x16x16_bf16 v[140:143], v[92:93], v[170:171], v[120:123]
    v_exp_f32 v137, v137
    v_sub_f32 v138, v138, v168
    v_cvt_pk_bf16_f32 v128, v128, v129
    v_mfma_f32_16x16x32_bf16 v[176:179], a[112:115], v[112:115], v[176:179]
    s_waitcnt lgkmcnt(0)
    v_accvgpr_write_b32 a224, v128
    v_cvt_pk_bf16_f32 v130, v130, v131
    v_accvgpr_write_b32 a225, v130
    v_mfma_f32_16x16x16_bf16 v[120:123], a[226:227], v[170:171], v[124:127]
    v_cvt_pk_bf16_f32 v108, v108, v109
    v_accvgpr_write_b32 a248, v108
    v_cvt_pk_bf16_f32 v110, v110, v111
    v_mfma_f32_16x16x16_bf16 v[128:131], a[250:251], v[170:171], v[124:127]
    v_accvgpr_write_b32 a249, v110
    v_cvt_pk_bf16_f32 v92, v140, v141
    v_cvt_pk_bf16_f32 v93, v142, v143
    v_mfma_f32_16x16x16_bf16 v[108:111], v[94:95], v[170:171], v[124:127]
    v_cvt_pk_bf16_f32 v120, v120, v121
    v_accvgpr_write_b32 a226, v120
    v_cvt_pk_bf16_f32 v122, v122, v123
    v_accvgpr_write_b32 a227, v122
    v_mfma_f32_16x16x32_bf16 v[176:179], a[116:119], v[228:231], v[176:179]
    ds_read_b128 v[120:123], v152 offset:512
    v_cvt_pk_bf16_f32 v128, v128, v129
    v_mfma_f32_16x16x32_bf16 v[124:127], a[120:123], v[196:199], 0
    v_accvgpr_write_b32 a250, v128
    v_cvt_pk_bf16_f32 v130, v130, v131
    v_mfma_f32_16x16x32_bf16 v[124:127], a[124:127], v[184:187], v[124:127]
    v_accvgpr_write_b32 a251, v130
    v_cvt_pk_bf16_f32 v94, v108, v109
    v_mfma_f32_16x16x32_bf16 v[124:127], a[128:131], v[172:175], v[124:127]
    v_cvt_pk_bf16_f32 v95, v110, v111
    v_cvt_pk_bf16_f32 v36, v136, v137
    v_mfma_f32_16x16x32_bf16 v[124:127], a[132:135], v[148:151], v[124:127]
    ds_read_b128 v[128:131], v152 offset:576
    v_sub_f32 v139, v139, v168
    v_mfma_f32_16x16x32_bf16 v[124:127], a[136:139], v[112:115], v[124:127]
    v_exp_f32 v138, v138
    v_mfma_f32_16x16x32_bf16 v[124:127], a[140:143], v[228:231], v[124:127]
    v_exp_f32 v139, v139
    v_mfma_f32_16x16x32_bf16 v[216:219], a[0:3], v[196:199], 0
    ds_read_b128 v[108:111], v9
    ds_read_b128 v[140:143], v9 offset:64
    v_mfma_f32_16x16x32_bf16 v[216:219], a[4:7], v[184:187], v[216:219]
    s_waitcnt lgkmcnt(3)
    v_cvt_pk_bf16_f32 v37, v138, v139
    v_sub_f32 v212, v212, v168
    v_mul_f32 v164, v180, v164
    v_mfma_f32_16x16x16_bf16 v[136:139], a[236:237], v[170:171], v[120:123]
    v_exp_f32 v212, v212
    v_mul_f32 v165, v180, v165
    v_mfma_f32_16x16x16_bf16 v[208:211], v[80:81], v[170:171], v[120:123]
    v_cvt_pk_bf16_f32 v39, v212, 0
    v_cvt_pk_bf16_f32 v164, v164, v165
    v_mul_f32 v166, v180, v166
    v_mul_f32 v167, v180, v167
    v_mfma_f32_16x16x32_bf16 v[200:203], v[28:31], v[36:39], 0
    s_waitcnt lgkmcnt(2)
    v_cvt_pk_bf16_f32 v136, v136, v137
    v_accvgpr_write_b32 a236, v136
    v_mfma_f32_16x16x32_bf16 v[200:203], v[28:31], v[132:135], v[200:203]
    v_cvt_pk_bf16_f32 v138, v138, v139
    v_accvgpr_write_b32 a237, v138
    v_mfma_f32_16x16x32_bf16 v[136:139], v[240:243], v[36:39], 0
    v_cvt_pk_bf16_f32 v80, v208, v209
    v_cvt_pk_bf16_f32 v81, v210, v211
    v_mfma_f32_16x16x32_bf16 v[136:139], v[144:147], v[132:135], v[136:139]
    s_waitcnt lgkmcnt(0)
    v_cvt_pk_bf16_f32 v165, v166, v167
    v_mul_f32 v220, v180, v220
    v_mfma_f32_16x16x32_bf16 v[208:211], v[160:163], v[36:39], 0
    v_mul_f32 v221, v180, v221
    v_cvt_pk_bf16_f32 v166, v220, v221
    v_mfma_f32_16x16x32_bf16 v[208:211], v[156:159], v[132:135], v[208:211]
    v_mul_f32 v222, v180, v222
    v_mul_f32 v223, v180, v223
    v_mfma_f32_16x16x32_bf16 v[248:251], v[116:119], v[36:39], 0
    v_cvt_pk_bf16_f32 v167, v222, v223
    v_mul_f32 v224, v180, v224
    v_mfma_f32_16x16x32_bf16 v[248:251], v[188:191], v[132:135], v[248:251]
    ds_write_b128 v3, v[164:167] offset:6144
    v_mfma_f32_16x16x16_bf16 v[164:167], v[104:105], v[170:171], v[120:123]
    v_mul_f32 v225, v180, v225
    v_cvt_pk_bf16_f32 v154, v224, v225
    v_mul_f32 v226, v180, v226
    v_mfma_f32_16x16x16_bf16 v[132:135], a[228:229], v[170:171], v[128:131]
    v_mul_f32 v227, v180, v227
    v_cvt_pk_bf16_f32 v155, v226, v227
    v_fma_f32 v169, v204, v204, s32
    v_mfma_f32_16x16x16_bf16 v[120:123], a[252:253], v[170:171], v[128:131]
    v_cvt_pk_bf16_f32 v104, v164, v165
    v_cvt_pk_bf16_f32 v105, v166, v167
    v_fmac_f32 v169, v205, v205
    v_mfma_f32_16x16x16_bf16 v[164:167], v[96:97], v[170:171], v[128:131]
    v_cvt_pk_bf16_f32 v132, v132, v133
    v_accvgpr_write_b32 a228, v132
    v_cvt_pk_bf16_f32 v134, v134, v135
    v_accvgpr_write_b32 a229, v134
    v_mfma_f32_16x16x32_bf16 v[128:131], v[108:111], v[28:31], 0
    ds_read_b128 v[132:135], v152 offset:640
    v_cvt_pk_bf16_f32 v120, v120, v121
    v_mfma_f32_16x16x32_bf16 v[128:131], v[140:143], v[28:31], v[128:131]
    ds_write_b64 v4, v[154:155] offset:10240
    v_mfma_f32_16x16x32_bf16 v[224:227], v[108:111], v[144:147], 0
    v_accvgpr_write_b32 a252, v120
    v_cvt_pk_bf16_f32 v122, v122, v123
    v_mfma_f32_16x16x32_bf16 v[224:227], v[140:143], v[240:243], v[224:227]
    v_accvgpr_write_b32 a253, v122
    v_cvt_pk_bf16_f32 v96, v164, v165
    v_mfma_f32_16x16x32_bf16 v[120:123], v[108:111], v[156:159], 0
    v_cvt_pk_bf16_f32 v97, v166, v167
    v_fmac_f32 v169, v206, v206
    v_mfma_f32_16x16x32_bf16 v[120:123], v[140:143], v[160:163], v[120:123]
    ds_read_b128 v[144:147], v152 offset:704
    v_fmac_f32 v169, v207, v207
    v_mfma_f32_16x16x32_bf16 v[156:159], v[108:111], v[188:191], 0
    v_rcp_f32 v128, v128
    v_mfma_f32_16x16x32_bf16 v[156:159], v[140:143], v[116:119], v[156:159]
    s_waitcnt lgkmcnt(2)
    v_mul_f32 v224, v224, v128
    v_rcp_f32 v200, v200
    v_mfma_f32_16x16x16_bf16 v[152:155], a[230:231], v[170:171], v[132:135]
    v_mul_f32_dpp v224, v120, v128 quad_perm:[0,1,2,3] row_mask:0x2 bank_mask:0xf
    v_mul_f32 v136, v200, v136
    v_mul_f32 v137, v200, v137
    v_mfma_f32_16x16x16_bf16 v[116:119], a[254:255], v[170:171], v[132:135]
    v_mul_f32_dpp v224, v156, v128 quad_perm:[0,1,2,3] row_mask:0x4 bank_mask:0xf
    v_cvt_pk_bf16_f32 v224, v224, v224
    v_cvt_pk_bf16_f32 v120, v136, v137
    v_mfma_f32_16x16x16_bf16 v[156:159], v[98:99], v[170:171], v[132:135]
    v_cvt_pk_bf16_f32 v152, v152, v153
    v_accvgpr_write_b32 a230, v152
    v_cvt_pk_bf16_f32 v154, v154, v155
    v_accvgpr_write_b32 a231, v154
    v_mfma_f32_16x16x32_bf16 v[216:219], a[8:11], v[172:175], v[216:219]
    ds_write_b16 v7, v224
    v_mfma_f32_16x16x32_bf16 v[216:219], a[12:15], v[148:151], v[216:219]
    s_waitcnt lgkmcnt(1)
    v_cvt_pk_bf16_f32 v116, v116, v117
    v_accvgpr_write_b32 a254, v116
    v_cvt_pk_bf16_f32 v118, v118, v119
    v_mfma_f32_16x16x16_bf16 v[132:135], a[238:239], v[170:171], v[144:147]
    v_accvgpr_write_b32 a255, v118
    v_cvt_pk_bf16_f32 v98, v156, v157
    v_cvt_pk_bf16_f32 v99, v158, v159
    v_mfma_f32_16x16x16_bf16 v[116:119], v[82:83], v[170:171], v[144:147]
    v_mul_f32 v138, v200, v138
    v_mul_f32 v139, v200, v139
    v_cvt_pk_bf16_f32 v121, v138, v139
    v_mfma_f32_16x16x16_bf16 v[156:159], v[106:107], v[170:171], v[144:147]
    v_cvt_pk_bf16_f32 v132, v132, v133
    v_accvgpr_write_b32 a238, v132
    v_cvt_pk_bf16_f32 v134, v134, v135
    v_accvgpr_write_b32 a239, v134
    v_mfma_f32_16x16x32_bf16 v[216:219], a[16:19], v[112:115], v[216:219]
    v_cvt_pk_bf16_f32 v82, v116, v117
    v_cvt_pk_bf16_f32 v83, v118, v119
    v_mfma_f32_16x16x32_bf16 v[216:219], a[20:23], v[228:231], v[216:219]
    v_cvt_pk_bf16_f32 v106, v156, v157
    v_cvt_pk_bf16_f32 v107, v158, v159
    v_mfma_f32_16x16x32_bf16 v[160:163], a[24:27], v[196:199], 0
    v_mul_f32 v208, v200, v208
    v_mul_f32 v209, v200, v209
    v_mfma_f32_16x16x32_bf16 v[160:163], a[28:31], v[184:187], v[160:163]
    v_cvt_pk_bf16_f32 v122, v208, v209
    v_mul_f32 v210, v200, v210
    v_mfma_f32_16x16x32_bf16 v[160:163], a[32:35], v[172:175], v[160:163]
    v_mul_f32 v211, v200, v211
    v_cvt_pk_bf16_f32 v123, v210, v211
    v_mfma_f32_16x16x32_bf16 v[160:163], a[36:39], v[148:151], v[160:163]
    ds_write_b128 v3, v[120:123] offset:12288
    v_mfma_f32_16x16x32_bf16 v[160:163], a[40:43], v[112:115], v[160:163]
    v_mul_f32 v248, v200, v248
    v_mul_f32 v249, v200, v249
    v_mfma_f32_16x16x32_bf16 v[160:163], a[44:47], v[228:231], v[160:163]
    v_cvt_pk_bf16_f32 v248, v248, v249
    v_mul_f32 v250, v200, v250
    v_mfma_f32_16x16x32_bf16 v[116:119], a[48:51], v[196:199], 0
    v_mul_f32 v251, v200, v251
    v_cvt_pk_bf16_f32 v249, v250, v251
    v_mfma_f32_16x16x32_bf16 v[116:119], a[52:55], v[184:187], v[116:119]
    ds_write_b64 v4, v[248:249] offset:16384
    v_mfma_f32_16x16x32_bf16 v[116:119], a[56:59], v[172:175], v[116:119]
    v_add_u32 v7, 16, v7
    v_fmac_f32 v169, v176, v176
    v_mfma_f32_16x16x32_bf16 v[116:119], a[60:63], v[148:151], v[116:119]
    v_fmac_f32 v169, v177, v177
    v_fmac_f32 v169, v178, v178
    v_mfma_f32_16x16x32_bf16 v[116:119], a[64:67], v[112:115], v[116:119]
    v_fmac_f32 v169, v179, v179
    v_fmac_f32 v169, v124, v124
    v_mfma_f32_16x16x32_bf16 v[116:119], a[68:71], v[228:231], v[116:119]
    v_fmac_f32 v169, v125, v125
    v_fmac_f32 v169, v126, v126
    v_mfma_f32_16x16x32_bf16 v[128:131], v[196:199], a[144:147], 0
    v_fmac_f32 v169, v127, v127
    v_fma_f32 v168, v216, v216, s32
    v_mfma_f32_16x16x32_bf16 v[128:131], v[184:187], a[148:151], v[128:131]
    v_fmac_f32 v168, v217, v217
    v_fmac_f32 v168, v218, v218
    v_mfma_f32_16x16x32_bf16 v[128:131], v[172:175], a[152:155], v[128:131]
    s_waitcnt lgkmcnt(0)
    v_fmac_f32 v168, v219, v219
    v_xor_b32 v3, 65536, v3
    v_mfma_f32_16x16x32_bf16 v[128:131], v[148:151], a[156:159], v[128:131]
    s_barrier
    v_xor_b32 v4, 65536, v4
    v_mfma_f32_16x16x32_bf16 v[128:131], v[112:115], a[160:163], v[128:131]
    v_mfma_f32_16x16x32_bf16 v[128:131], v[228:231], a[164:167], v[128:131]
    s_branch L_go
.section .rodata,"a"
.p2align 6
.amdhsa_kernel standalone__window_attn_swin_v2__vision_kernel
  .amdhsa_next_free_vgpr 512
  .amdhsa_next_free_sgpr 102
  .amdhsa_accum_offset 256
  .amdhsa_group_segment_fixed_size 0
  .amdhsa_kernarg_size 96
  .amdhsa_user_sgpr_count 2
  .amdhsa_user_sgpr_kernarg_segment_ptr 1
  .amdhsa_system_sgpr_workgroup_id_x 1
  .amdhsa_float_denorm_mode_32 3
.end_amdhsa_kernel
```

```asm
; @launch grid=(256,1,1) block=(256,1,1) lds=163840
.amdgcn_target "amdgcn-amd-amdhsa--gfx950"
.text
.globl standalone__window_attn_swin_v2__vision_kernel
.p2align 12
.p2align 8
.type standalone__window_attn_swin_v2__vision_kernel,@function
standalone__window_attn_swin_v2__vision_kernel:
    s_load_dwordx2 s[8:9], s[0:1], 0
    s_load_dwordx2 s[44:45], s[0:1], 8
    s_load_dwordx2 s[48:49], s[0:1], 16
    s_load_dwordx2 s[56:57], s[0:1], 32
    s_load_dwordx2 s[60:61], s[0:1], 40
    s_load_dwordx2 s[52:53], s[0:1], 48
    s_load_dwordx2 s[64:65], s[0:1], 24
    s_getpc_b64 s[96:97]
    s_bfe_u32 s3, s2, 0x30003
    s_mul_i32 s3, s3, 36
    v_min_u32 v170, 67, v0
    v_cmp_gt_u32 vcc, 32, v0
    v_add_u32 v171, s3, v170
    s_cmp_ge_u32 s2, 256
    v_cndmask_b32 v170, v171, v170, vcc
    v_mov_b32 v171, 0
    v_lshlrev_b32 v170, 7, v170
    v_lshl_add_u64 v[170:171], s[96:97], 0, v[170:171]
    s_cbranch_scc1 L_done
    global_load_dword a255, v[170:171], off offset:964
    s_cmp_ge_u32 s2, 247
    s_cbranch_scc1 L_edge
    v_lshrrev_b32 v170, 6, v0
    v_mov_b32 v171, v0
    v_readfirstlane_b32 s16, v170
    v_mov_b32 v170, 0x40000000
    v_and_b32 v108, 63, v0
    s_bfe_u32 s3, s2, 0x50003
    s_lshl_b32 s4, s16, 3
    s_lshr_b32 s98, 0x00001236, s4
    s_and_b32 s98, s98, 0xff
    s_mul_i32 s3, s3, s98
    s_lshr_b32 s4, 0x00051135, s4
    s_and_b32 s4, s4, 0xff
    v_min_u32 v110, s4, v108
    v_add_lshl_u32 v110, v110, s3, 7
    v_mov_b32 v111, 0
    v_lshrrev_b32 v109, 4, v108
    v_and_b32 v120, 15, v108
    s_mov_b32 s10, 100270464
    s_mov_b32 s11, 0x00020000
    s_mov_b32 s46, 221184
    s_mov_b32 s47, 0x00020000
    v_mul_u32_u24 v121, 171, v108
    v_lshrrev_b32 v121, 10, v121
    v_lshrrev_b32 v122, 1, v121
    v_xor_b32 v122, v122, v121
    v_and_b32 v122, 4, v122
    v_mul_u32_u24 v122, 3, v122
    v_xor_b32 v122, v122, v121
    v_mul_u32_u24 v122, 1152, v122
    v_mul_u32_u24 v123, 96, v121
    v_sub_u32 v122, v122, v123
    v_lshl_add_u32 v123, v108, 4, v122
    v_add_u32 v122, 64, v108
    v_mul_u32_u24 v122, 171, v122
    v_lshrrev_b32 v122, 10, v122
    v_lshrrev_b32 v132, 1, v122
    v_xor_b32 v132, v132, v122
    v_and_b32 v132, 4, v132
    v_mul_u32_u24 v132, 3, v132
    v_xor_b32 v132, v132, v122
    v_mul_u32_u24 v132, 1152, v132
    v_mul_u32_u24 v133, 96, v122
    v_sub_u32 v132, v132, v133
    v_lshl_add_u32 v133, v108, 4, v132
    v_add_u32 v132, 128, v108
    v_mul_u32_u24 v132, 171, v132
    v_lshrrev_b32 v132, 10, v132
    v_lshrrev_b32 v134, 1, v132
    v_xor_b32 v134, v134, v132
    v_and_b32 v134, 4, v134
    v_mul_u32_u24 v134, 3, v134
    v_xor_b32 v134, v134, v132
    v_mul_u32_u24 v134, 1152, v134
    v_mul_u32_u24 v135, 96, v132
    v_sub_u32 v134, v134, v135
    v_lshl_add_u32 v135, v108, 4, v134
    s_mul_i32 s66, s16, 6144
    s_add_u32 s67, s66, 65536
    s_cmp_eq_u32 s16, 3
    s_cselect_b32 s66, 136704, s66
    s_cselect_b32 s67, 142848, s67
    s_mul_i32 s68, s16, 96
    s_mov_b32 s69, 193536
    s_mov_b32 s36, 100270464
    s_mov_b32 s22, 1180032
    s_mul_i32 s3, s2, 911
    s_lshr_b32 s3, s3, 16
    s_mul_i32 s99, s3, 72
    s_sub_u32 s38, s2, s99
    s_mul_i32 s3, s3, 1373568
    s_mul_i32 s99, s38, 2688
    s_add_u32 s3, s3, s99
    s_add_u32 s25, s3, 589824
    s_add_u32 s7, s3, 1769472
    s_mov_b32 s20, 31
    s_mov_b32 s21, 4204032
    s_cmp_lt_u32 s2, 244
    s_cselect_b32 s17, 21, 20
    v_mul_u32_u24 v134, 2731, v171
    v_bfe_u32 v136, v134, 17, 3
    v_lshrrev_b32 v134, 16, v134
    v_xor_b32 v137, v136, v171
    v_mul_u32_u24 v136, 37, v134
    v_lshrrev_b32 v136, 8, v136
    v_lshlrev_b32 v137, 4, v137
    v_mad_u32_u24 v10, v136, s69, v137
    v_mul_u32_u24 v136, s20, v134
    v_add_u32 v136, s38, v136
    v_mul_u32_u24 v136, 911, v136
    v_lshrrev_b32 v136, 16, v136
    v_mul_u32_u24 v136, s22, v136
    v_mad_u32_u24 v136, v134, s21, v136
    v_cmp_gt_u32 vcc, s17, v134
    v_add_u32 v136, s7, v136
    s_nop 0
    v_cndmask_b32 v136, v170, v136, vcc
    v_mul_u32_u24 v134, 384, v134
    v_sub_u32 v134, v137, v134
    v_add_u32 v136, v136, v134
    v_add_u32 v134, 256, v171
    v_mul_u32_u24 v137, 2731, v134
    v_bfe_u32 v138, v137, 17, 3
    v_lshrrev_b32 v137, 16, v137
    v_xor_b32 v134, v138, v134
    v_mul_u32_u24 v138, 37, v137
    v_lshrrev_b32 v138, 8, v138
    v_lshlrev_b32 v134, 4, v134
    v_mad_u32_u24 v11, v138, s69, v134
    v_mul_u32_u24 v138, s20, v137
    v_add_u32 v138, s38, v138
    v_mul_u32_u24 v138, 911, v138
    v_lshrrev_b32 v138, 16, v138
    v_mul_u32_u24 v138, s22, v138
    v_mad_u32_u24 v138, v137, s21, v138
    v_cmp_gt_u32 vcc, s17, v137
    v_add_u32 v138, s7, v138
    s_nop 0
    v_cndmask_b32 v138, v170, v138, vcc
    v_mul_u32_u24 v137, 384, v137
    v_sub_u32 v137, v134, v137
    v_add_u32 v138, v138, v137
    s_lshl_b32 s28, s16, 10
    s_add_u32 s28, s28, 20480
    s_waitcnt lgkmcnt(0)
    s_load_dwordx2 s[42:43], s[0:1], 72
    s_cmp_eq_u32 s16, 0
    s_cselect_b64 s[98:99], s[44:45], s[48:49]
    s_cmp_eq_u32 s16, 2
    s_cselect_b64 s[98:99], s[52:53], s[98:99]
    s_cmp_eq_u32 s16, 3
    s_cselect_b64 s[98:99], s[56:57], s[98:99]
    v_lshl_add_u64 v[110:111], s[98:99], 0, v[110:111]
    v_writelane_b32 v110, s60, 62
    v_writelane_b32 v111, s61, 62
    v_writelane_b32 v110, s64, 63
    v_writelane_b32 v111, s65, 63
    global_load_dword a254, v[110:111], off
    s_add_u32 m0, s66, 0
    s_add_u32 s4, s68, 384
    buffer_load_dwordx4 v123, s[44:47], s4 offen lds
    s_mov_b32 s50, 73728
    s_mov_b32 s51, 0x00020000
    s_mov_b32 s58, 64
    s_mov_b32 s59, 0x00020000
    buffer_load_dwordx4 v133, s[44:47], s4 offen offset:1024 lds
    s_mov_b32 s62, 128
    s_mov_b32 s63, 0x00020000
    s_mov_b32 s54, 676
    s_mov_b32 s55, 0x00020000
    buffer_load_dwordx4 v135, s[44:47], s4 offen offset:2048 lds
    s_add_u32 m0, s28, 128512
    s_add_u32 s4, s68, 37248
    s_mov_b32 s14, 0
    s_mov_b32 s15, 0x00020000
    buffer_load_dwordx4 v136, s[8:11], 0 offen nt lds
    s_add_u32 m0, s28, 132608
    v_mov_b32 v111, 0
    v_cmp_lt_u32 s[90:91], 7, v120
    s_mul_i32 s70, s16, 192
    s_mov_b32 s73, 0x3f80
    buffer_load_dwordx4 v138, s[8:11], 0 offen nt lds
    s_add_u32 m0, s28, 0
    v_mov_b32 v169, 0
    v_mov_b32 v113, 0
    s_mov_b32 s19, s38
    s_mov_b32 s23, s25
    buffer_load_dwordx4 v10, s[8:11], s25 offen nt lds
    s_add_u32 m0, s28, 4096
    v_mov_b32 v115, 0
    s_mov_b32 s26, 0
    s_mov_b32 s27, 0
    buffer_load_dwordx4 v11, s[8:11], s25 offen nt lds
    s_add_u32 m0, s66, 3072
    v_lshlrev_b32 v134, 1, v108
    s_mov_b32 s18, 0
    s_add_u32 s19, s19, s20
    buffer_load_dwordx4 v123, s[44:47], s4 offen lds
    v_mul_u32_u24 v168, 12, v120
    v_add_u32 v168, s70, v168
    s_add_u32 s23, s23, s21
    s_cmp_ge_u32 s19, 72
    buffer_load_dwordx4 v133, s[44:47], s4 offen offset:1024 lds
    v_lshlrev_b32 v112, 5, v109
    v_lshrrev_b32 v110, 2, v120
    v_and_b32 v116, 1, v110
    v_mul_u32_u24 v116, 0x020202, v116
    v_lshl_or_b32 v116, v116, 8, v116
    v_add_u32 v116, 0x05040100, v116
    v_and_b32 v114, 3, v120
    v_lshrrev_b32 v117, 1, v120
    v_xor_b32 v118, v117, v109
    v_mul_u32_u24 v117, 384, v120
    v_lshl_add_u32 v0, v118, 4, v117
    v_xor_b32 v1, 64, v0
    v_and_b32 v117, 2, v109
    v_add_u32 v117, v117, v109
    v_lshl_add_u32 v117, v117, 2, v110
    v_mul_u32_u24 v117, 96, v117
    v_lshl_add_u32 v117, v114, 3, v117
    v_add_u32 v136, s66, v117
    v_add_u32 v137, s67, v117
    v_mov_b32 v28, 0x3f803f80
    v_mov_b32 v29, 0x3f803f80
    v_mov_b32 v30, 0x3f803f80
    v_mov_b32 v31, 0x3f803f80
    v_mul_u32_u24 v138, 768, v109
    v_add_u32 v138, v168, v138
    v_add_u32 v138, 157184, v138
    v_and_b32 v117, 1, v120
    v_lshlrev_b32 v117, 4, v117
    v_lshlrev_b32 v139, v117, s73
    v_lshlrev_b32 v118, 4, v109
    s_cselect_b32 s34, 72, 0
    s_cselect_b32 s35, s22, 0
    s_sub_u32 s19, s19, s34
    s_add_u32 s23, s23, s35
    s_mov_b32 s24, s23
    s_add_u32 s19, s19, s20
    s_add_u32 s23, s23, s21
    s_cmp_ge_u32 s19, 72
    s_cselect_b32 s34, 72, 0
    s_cselect_b32 s35, s22, 0
    s_sub_u32 s19, s19, s34
    s_add_u32 s23, s23, s35
    s_mul_i32 s76, s16, 64
    v_lshl_add_u32 v119, v109, 4, s76
    s_mul_i32 s77, s16, 32
    s_add_u32 s77, s77, 256
    v_lshl_add_u32 v126, v109, 3, s77
    v_add_u32 v124, 0, v120
    v_mul_u32_u24 v127, 37, v124
    v_mul_u32_u24 v125, 384, v124
    v_lshrrev_b32 v127, 8, v127
    v_mad_u32_u24 v125, v127, s69, v125
    v_add_u32 v15, v125, v119
    v_add_u32 v18, v125, v126
    v_add_u32 v128, 16, v120
    v_mul_u32_u24 v125, 37, v128
    v_mul_u32_u24 v129, 384, v128
    v_lshrrev_b32 v125, 8, v125
    v_mad_u32_u24 v129, v125, s69, v129
    v_add_u32 v16, v129, v119
    v_add_u32 v19, v129, v126
    v_add_u32 v129, 32, v120
    v_mul_u32_u24 v131, 37, v129
    v_mul_u32_u24 v130, 384, v129
    v_lshrrev_b32 v131, 8, v131
    v_mad_u32_u24 v130, v131, s69, v130
    v_add_u32 v17, v130, v119
    v_add_u32 v20, v130, v126
    s_mul_i32 s78, s16, 768
    s_add_u32 s78, s78, 157184
    v_mul_u32_u24 v119, 24, v127
    v_lshl_add_u32 v119, v124, 2, v119
    v_add_u32 v22, s78, v119
    v_sub_u32 v23, s78, v119
    v_sub_u32 v119, v22, v118
    v_mul_u32_u24 v130, 24, v125
    v_lshl_add_u32 v130, v128, 2, v130
    v_add_u32 v24, s78, v130
    v_sub_u32 v25, s78, v130
    v_sub_u32 v130, v24, v118
    v_mul_u32_u24 v128, 24, v131
    v_lshl_add_u32 v128, v129, 2, v128
    v_add_u32 v26, s78, v128
    v_sub_u32 v27, s78, v128
    v_sub_u32 v129, v26, v118
    v_mul_u32_u24 v128, 148, v109
    s_mov_b32 s79, -24
    v_add_u32 v131, 0, v128
    v_lshrrev_b32 v131, 8, v131
    v_mad_i32_i24 v40, v131, s79, v119
    v_mad_i32_i24 v52, v131, s79, v130
    v_mad_i32_i24 v64, v131, s79, v129
    v_add_u32 v131, 37, v128
    v_lshrrev_b32 v131, 8, v131
    v_mad_i32_i24 v41, v131, s79, v119
    v_mad_i32_i24 v53, v131, s79, v130
    v_mad_i32_i24 v65, v131, s79, v129
    v_add_u32 v131, 74, v128
    v_lshrrev_b32 v131, 8, v131
    v_mad_i32_i24 v42, v131, s79, v119
    v_mad_i32_i24 v54, v131, s79, v130
    v_mad_i32_i24 v66, v131, s79, v129
    v_add_u32 v131, 111, v128
    v_lshrrev_b32 v131, 8, v131
    v_mad_i32_i24 v43, v131, s79, v119
    v_mad_i32_i24 v55, v131, s79, v130
    v_mad_i32_i24 v67, v131, s79, v129
    v_add_u32 v131, 592, v128
    v_lshrrev_b32 v131, 8, v131
    v_mad_i32_i24 v44, v131, s79, v119
    v_mad_i32_i24 v56, v131, s79, v130
    v_mad_i32_i24 v68, v131, s79, v129
    v_add_u32 v131, 629, v128
    v_lshrrev_b32 v131, 8, v131
    v_mad_i32_i24 v45, v131, s79, v119
    v_mad_i32_i24 v57, v131, s79, v130
    v_mad_i32_i24 v69, v131, s79, v129
    v_add_u32 v131, 666, v128
    v_lshrrev_b32 v131, 8, v131
    v_mad_i32_i24 v46, v131, s79, v119
    v_mad_i32_i24 v58, v131, s79, v130
    v_mad_i32_i24 v70, v131, s79, v129
    v_add_u32 v131, 703, v128
    v_lshrrev_b32 v131, 8, v131
    v_mad_i32_i24 v47, v131, s79, v119
    v_mad_i32_i24 v59, v131, s79, v130
    v_mad_i32_i24 v71, v131, s79, v129
    v_add_u32 v131, 1184, v128
    v_lshrrev_b32 v131, 8, v131
    v_mad_i32_i24 v48, v131, s79, v119
    v_mad_i32_i24 v60, v131, s79, v130
    v_mad_i32_i24 v72, v131, s79, v129
    v_add_u32 v131, 1221, v128
    v_lshrrev_b32 v131, 8, v131
    v_mad_i32_i24 v49, v131, s79, v119
    v_mad_i32_i24 v61, v131, s79, v130
    v_mad_i32_i24 v73, v131, s79, v129
    v_add_u32 v131, 1258, v128
    v_lshrrev_b32 v131, 8, v131
    v_mad_i32_i24 v50, v131, s79, v119
    v_mad_i32_i24 v62, v131, s79, v130
    v_mad_i32_i24 v74, v131, s79, v129
    v_add_u32 v128, 1295, v128
    v_lshrrev_b32 v128, 8, v128
    v_mad_i32_i24 v51, v128, s79, v119
    v_mad_i32_i24 v63, v128, s79, v130
    v_mad_i32_i24 v75, v128, s79, v129
    v_mov_b32 v119, s78
    v_lshlrev_b32 v124, 4, v108
    v_xor_b32 v2, 65536, v124
    v_lshl_add_u32 v3, s16, 10, v124
    s_lshr_b32 s80, s16, 1
    s_and_b32 s81, s16, 1
    s_lshl_b32 s81, s81, 3
    s_lshl_b32 s82, s80, 10
    s_add_u32 s82, s82, s81
    v_add_u32 v4, s82, v124
    s_lshl_b32 s80, s80, 11
    s_add_u32 s80, s80, s81
    s_add_u32 s80, s80, 144896
    s_mul_i32 s83, s16, 2048
    s_add_u32 s83, s83, 136704
    v_lshl_add_u32 v124, v109, 3, s83
    v_mov_b32 v125, s80
    v_mov_b32 v126, 161536
    s_mul_i32 s84, s16, 8064
    s_add_u32 s84, s84, 104448
    s_mul_i32 s85, s16, 6528
    s_add_u32 s85, s85, 38912
    v_mul_u32_u24 v127, 80, v109
    v_add3_u32 v5, v127, v117, s84
    v_lshl_add_u32 v6, v120, 2, s85
    s_mul_i32 s86, s16, 128
    s_add_u32 s86, s86, 65024
    v_add_u32 v9, s86, v118
    v_lshrrev_b32 v117, 1, v109
    v_mul_u32_u24 v117, 48, v117
    v_lshl_add_u32 v117, v109, 3, v117
    v_lshl_add_u32 v117, v110, 4, v117
    v_lshl_add_u32 v117, v114, 1, v117
    v_add_u32 v8, s86, v117
    v_mov_b32 v37, 0
    v_mov_b32 v38, 0
    v_mov_b32 v39, 0
    s_mov_b32 s40, s8
    s_mov_b32 s41, s9
    s_mov_b32 s32, 0x2a8cbccc
    s_mov_b32 s33, 0x38fba882
    v_add_u32 v140, 148992, v0
    v_add_u32 v141, 148992, v1
    v_lshlrev_b32 v117, 4, v120
    v_add_u32 v117, 160256, v117
    v_mul_u32_u24 v143, 336, v120
    v_add3_u32 v143, v143, v127, s84
    v_mul_u32_u24 v145, 272, v120
    v_add3_u32 v145, v145, v118, s85
    v_mul_u32_u24 v142, 1088, v109
    v_add_u32 v142, v142, v6
    v_add_u32 v144, 5376, v143
    v_add_u32 v152, 4352, v145
    v_add_u32 v153, 4352, v142
    v_cmp_gt_u32 s[88:89], 16, v108
    v_mov_b32 v146, 0xf149f2ca
    v_add_u32 v127, 512, v171
    v_mul_u32_u24 v147, 2731, v127
    v_bfe_u32 v154, v147, 17, 3
    v_lshrrev_b32 v147, 16, v147
    v_xor_b32 v127, v154, v127
    v_mul_u32_u24 v154, 37, v147
    v_lshrrev_b32 v154, 8, v154
    v_lshlrev_b32 v127, 4, v127
    v_mad_u32_u24 v12, v154, s69, v127
    v_add_u32 v127, 768, v171
    v_mul_u32_u24 v147, 2731, v127
    v_bfe_u32 v154, v147, 17, 3
    v_lshrrev_b32 v147, 16, v147
    v_xor_b32 v127, v154, v127
    v_mul_u32_u24 v154, 37, v147
    v_lshrrev_b32 v154, 8, v154
    v_lshlrev_b32 v127, 4, v127
    v_mad_u32_u24 v13, v154, s69, v127
    v_add_u32 v127, 1024, v171
    v_mul_u32_u24 v171, 2731, v127
    v_bfe_u32 v147, v171, 17, 3
    v_lshrrev_b32 v171, 16, v171
    v_xor_b32 v127, v147, v127
    v_mul_u32_u24 v147, 37, v171
    v_lshrrev_b32 v147, 8, v147
    v_lshlrev_b32 v127, 4, v127
    v_mad_u32_u24 v14, v147, s69, v127
    v_cmp_gt_u32 vcc, 48, v171
    s_add_u32 s71, s28, 16384
    s_cmp_lt_u32 s16, 2
    v_cndmask_b32 v14, v170, v14, vcc
    v_cmp_gt_u32 vcc, 2, v114
    s_cselect_b32 s29, s71, 160256
    s_cselect_b32 s30, 65536, 0
    v_cndmask_b32 v32, 0, v139, vcc
    v_cndmask_b32 v33, v139, 0, vcc
    v_cndmask_b32 v34, 0, v139, vcc
    v_cndmask_b32 v35, v139, 0, vcc
    v_cmp_eq_u32 vcc, v109, v110
    s_xor_b32 s72, s29, s30
    s_mul_i32 s74, s16, 64
    v_cndmask_b32 v154, 0, v32, vcc
    v_cndmask_b32 v155, 0, v33, vcc
    s_mul_i32 s75, s16, 32
    s_add_u32 s75, s75, 192
    v_mul_u32_u24 v139, 6, v121
    v_sub_u32 v127, v108, v139
    v_mul_u32_u24 v139, 384, v121
    v_lshl_add_u32 v139, v127, 4, v139
    v_add_u32 v121, s75, v139
    v_add_u32 v139, s74, v139
    v_cmp_gt_i32 vcc, 4, v127
    v_mul_u32_u24 v147, 6, v122
    v_sub_u32 v127, v108, v147
    v_cndmask_b32 v139, v121, v139, vcc
    v_mul_u32_u24 v147, 384, v122
    v_lshl_add_u32 v147, v127, 4, v147
    v_add_u32 v121, s75, v147
    v_add_u32 v147, s74, v147
    v_cmp_gt_i32 vcc, -60, v127
    v_mul_u32_u24 v127, 6, v132
    v_sub_u32 v122, v108, v127
    v_cndmask_b32 v147, v121, v147, vcc
    v_mul_u32_u24 v127, 384, v132
    v_lshl_add_u32 v127, v122, 4, v127
    v_add_u32 v108, s75, v127
    v_add_u32 v127, s74, v127
    v_cmp_gt_i32 vcc, -124, v122
    v_mul_u32_u24 v122, 96, v120
    v_add3_u32 v121, v122, v118, s66
    v_cndmask_b32 v132, v108, v127, vcc
    v_cmp_gt_u32 vcc, 2, v109
    v_lshl_add_u32 v170, v109, 3, v122
    v_add3_u32 v170, v170, 64, s66
    v_cndmask_b32 v124, v125, v124, vcc
    v_lshl_add_u32 v124, v110, 9, v124
    v_lshl_add_u32 v124, v114, 1, v124
    v_cmp_gt_u32 vcc, 3, v109
    v_add3_u32 v171, v122, v118, s67
    v_lshl_add_u32 v122, v109, 3, v122
    v_cndmask_b32 v7, v126, v124, vcc
    v_cmp_gt_u32 vcc, 8, v120
    v_add3_u32 v122, v122, 64, s67
    v_mov_b32 v124, 0
    v_cndmask_b32 v144, v117, v144, vcc
    v_cndmask_b32 v152, v117, v152, vcc
    v_cmp_gt_u32 vcc, 2, v109
    v_mov_b32 v125, 0
    v_mov_b32 v126, 0
    v_cndmask_b32 v153, v117, v153, vcc
    v_mov_b32 v127, 0
    s_add_u32 s34, s18, 2
    s_mov_b32 s27, s26
    ds_write_b128 v143, v[124:127] offset:16
    s_mov_b32 s26, s25
    s_add_u32 s19, s19, s20
    s_mov_b32 s18, 1
    buffer_load_dwordx4 v135, s[44:47], s4 offen offset:2048 lds
    ds_write_b64 v143, v[124:125] offset:56
    s_add_u32 m0, s67, 0
    s_add_u32 s4, s68, 74112
    ds_write_b64 v143, v[124:125] offset:64
    buffer_load_dwordx4 v123, s[44:47], s4 offen lds
    ds_write_b128 v144, v[124:127] offset:16
    s_waitcnt vmcnt(8)
    ds_read_b64_tr_b16 a[72:73], v136 offset:0
    ds_read_b64_tr_b16 a[74:75], v136 offset:768
    buffer_load_dwordx4 v133, s[44:47], s4 offen offset:1024 lds
    ds_read_b64_tr_b16 a[96:97], v136 offset:32
    ds_read_b64_tr_b16 a[98:99], v136 offset:800
    ds_read_b64_tr_b16 a[120:121], v136 offset:64
    ds_read_b64_tr_b16 a[122:123], v136 offset:832
    ds_write_b64 v144, v[124:125] offset:56
    buffer_load_dwordx4 v135, s[44:47], s4 offen offset:2048 lds
    ds_write_b64 v144, v[124:125] offset:64
    s_add_u32 m0, s67, 3072
    s_add_u32 s4, s68, 110976
    buffer_load_dwordx4 v123, s[44:47], s4 offen lds
    buffer_load_dwordx4 v133, s[44:47], s4 offen offset:1024 lds
    buffer_load_dwordx4 v135, s[44:47], s4 offen offset:2048 lds
    v_mov_b32 v120, s16
    v_lshlrev_b32 v120, 1, v120
    s_add_u32 m0, s66, 0
    s_add_u32 s4, s68, 147840
    s_waitcnt lgkmcnt(0)
    s_waitcnt vmcnt(9)
    s_barrier
    ds_read_b128 v[124:127], v140 offset:0
    ds_read_b128 v[228:231], v141 offset:0
    buffer_load_ushort v110, v134, s[56:59], 0 offen
    ds_read_b128 v[196:199], v140 offset:128
    ds_read_b128 v[176:179], v141 offset:128
    ds_read_b128 v[184:187], v140 offset:256
    ds_read_b128 v[172:175], v141 offset:256
    buffer_load_dwordx3 v[148:150], v168, s[52:55], 0 offen
    s_waitcnt lgkmcnt(5)
    v_mfma_f32_16x16x32_bf16 v[204:207], a[72:75], v[124:127], 0
    s_waitcnt lgkmcnt(4)
    v_mfma_f32_16x16x32_bf16 v[156:159], a[96:99], v[124:127], 0
    s_waitcnt lgkmcnt(2)
    v_mfma_f32_16x16x32_bf16 v[216:219], a[120:123], v[124:127], 0
    s_waitcnt lgkmcnt(1)
    buffer_load_dwordx4 v[128:131], v112, s[60:63], 0 offen
    ds_read_b128 v[164:167], v141 offset:6272
    buffer_load_dwordx4 v[160:163], v112, s[60:63], 0 offen offset:16
    s_waitcnt vmcnt(10)
    ds_read_b64_tr_b16 a[76:77], v136 offset:3072
    ds_read_b64_tr_b16 a[78:79], v136 offset:3840
    ds_read_b64_tr_b16 a[100:101], v136 offset:3104
    ds_read_b64_tr_b16 a[102:103], v136 offset:3872
    ds_read_b64_tr_b16 a[124:125], v136 offset:3136
    ds_read_b64_tr_b16 a[126:127], v136 offset:3904
    global_load_ushort v120, v120, s[64:65]
    s_waitcnt lgkmcnt(4)
    v_mfma_f32_16x16x32_bf16 v[204:207], a[76:79], v[228:231], v[204:207]
    s_waitcnt lgkmcnt(3)
    s_waitcnt lgkmcnt(2)
    v_mfma_f32_16x16x32_bf16 v[156:159], a[100:103], v[228:231], v[156:159]
    s_waitcnt lgkmcnt(0)
    buffer_load_dwordx4 v123, s[44:47], s4 offen lds
    v_mfma_f32_16x16x32_bf16 v[216:219], a[124:127], v[228:231], v[216:219]
    ds_read_b128 v[180:183], v140 offset:6400
    s_waitcnt vmcnt(9)
    ds_read_b64_tr_b16 a[80:81], v137 offset:0
    ds_read_b64_tr_b16 a[82:83], v137 offset:768
    buffer_load_dwordx4 v133, s[44:47], s4 offen offset:1024 lds
    ds_read_b64_tr_b16 a[104:105], v137 offset:32
    ds_read_b64_tr_b16 a[106:107], v137 offset:800
    ds_read_b64_tr_b16 a[128:129], v137 offset:64
    ds_read_b64_tr_b16 a[130:131], v137 offset:832
    buffer_load_dwordx4 v135, s[44:47], s4 offen offset:2048 lds
    s_add_u32 m0, s66, 3072
    s_add_u32 s4, s68, 184704
    s_waitcnt lgkmcnt(4)
    v_mfma_f32_16x16x32_bf16 v[204:207], a[80:83], v[196:199], v[204:207]
    s_waitcnt lgkmcnt(2)
    v_mfma_f32_16x16x32_bf16 v[156:159], a[104:107], v[196:199], v[156:159]
    s_waitcnt lgkmcnt(1)
    s_waitcnt lgkmcnt(0)
    v_mfma_f32_16x16x32_bf16 v[216:219], a[128:131], v[196:199], v[216:219]
    ds_read_b128 v[188:191], v141 offset:6400
    buffer_load_dwordx4 v123, s[44:47], s4 offen lds
    s_waitcnt vmcnt(9)
    ds_read_b64_tr_b16 a[84:85], v137 offset:3072
    ds_read_b64_tr_b16 a[86:87], v137 offset:3840
    ds_read_b64_tr_b16 a[108:109], v137 offset:3104
    ds_read_b64_tr_b16 a[110:111], v137 offset:3872
    s_waitcnt vmcnt(7)
    buffer_load_dwordx4 v133, s[44:47], s4 offen offset:1024 lds
    s_waitcnt vmcnt(7)
    ds_read_b64_tr_b16 a[132:133], v137 offset:3136
    ds_read_b64_tr_b16 a[134:135], v137 offset:3904
    v_cndmask_b32 v128, v128, v129, s[90:91]
    v_cndmask_b32 v130, v130, v131, s[90:91]
    v_perm_b32 v108, v130, v128, v116
    v_bfe_u32 v168, v148, v118, 16
    v_bfe_u32 v112, v149, v118, 16
    v_bfe_u32 v114, v150, v118, 16
    v_mfma_f32_16x16x16_bf16 v[148:151], v[110:111], v[168:169], 0
    s_waitcnt vmcnt(6)
    v_cndmask_b32 v160, v160, v161, s[90:91]
    v_cndmask_b32 v162, v162, v163, s[90:91]
    v_mfma_f32_16x16x16_bf16 v[128:131], v[110:111], v[112:113], 0
    v_perm_b32 v109, v162, v160, v116
    v_mfma_f32_16x16x16_bf16 v[160:163], v[110:111], v[114:115], 0
    buffer_load_dwordx4 v135, s[44:47], s4 offen offset:2048 lds
    s_add_u32 m0, s67, 0
    s_add_u32 s4, s68, 36864
    s_waitcnt lgkmcnt(4)
    v_mfma_f32_16x16x32_bf16 v[204:207], a[84:87], v[176:179], v[204:207]
    s_waitcnt lgkmcnt(2)
    v_max_f32 v148, 0, v148
    v_max_f32 v149, 0, v149
    v_mfma_f32_16x16x32_bf16 v[156:159], a[108:111], v[176:179], v[156:159]
    s_waitcnt vmcnt(6)
    ds_read_b128 v[112:115], v140 offset:6144
    s_waitcnt lgkmcnt(1)
    v_mfma_f32_16x16x32_bf16 v[216:219], a[132:135], v[176:179], v[216:219]
    v_max_f32 v150, 0, v150
    v_max_f32 v151, 0, v151
    buffer_load_dwordx4 v123, s[44:47], s68 offen lds
    v_cvt_pk_bf16_f32 v110, v148, v149
    v_cvt_pk_bf16_f32 v111, v150, v151
    v_max_f32 v128, 0, v128
    v_max_f32 v129, 0, v129
    v_mfma_f32_16x16x16_bf16 v[148:151], v[108:109], v[110:111], 0
    v_max_f32 v130, 0, v130
    v_max_f32 v131, 0, v131
    v_cvt_pk_bf16_f32 v110, v128, v129
    v_cvt_pk_bf16_f32 v111, v130, v131
    v_max_f32 v160, 0, v160
    v_max_f32 v161, 0, v161
    v_mfma_f32_16x16x16_bf16 v[128:131], v[108:109], v[110:111], 0
    v_max_f32 v162, 0, v162
    v_cvt_pk_bf16_f32 v148, v148, v148
    v_and_b32 v148, 0xffff0000, v148
    buffer_load_dwordx4 v133, s[44:47], s68 offen offset:1024 lds
    s_waitcnt lgkmcnt(0)
    v_mfma_f32_16x16x32_bf16 v[192:195], a[72:75], v[112:115], 0
    v_mul_f32 v148, 0xbfb8aa3b, v148
    v_max_f32 v163, 0, v163
    v_mfma_f32_16x16x32_bf16 v[200:203], a[96:99], v[112:115], 0
    v_exp_f32 v148, v148
    v_mfma_f32_16x16x32_bf16 v[208:211], a[120:123], v[112:115], 0
    v_add_f32 v148, 1.0, v148
    v_rcp_f32 v148, v148
    v_cvt_pk_bf16_f32 v128, v128, v128
    buffer_load_dwordx4 v135, s[44:47], s68 offen offset:2048 lds
    s_add_u32 m0, s67, 3072
    v_cvt_pk_bf16_f32 v148, v148, v148
    v_and_b32 v148, 0xffff0000, v148
    v_add_f32 v148, -0.5, v148
    v_mul_f32 v148, 0x41b8aa3b, v148
    ds_write_b32 v138, v148 offset:0
    s_waitcnt vmcnt(6)
    ds_read_b64_tr_b16 a[88:89], v136 offset:0
    ds_read_b64_tr_b16 a[90:91], v136 offset:768
    ds_read_b64_tr_b16 a[112:113], v136 offset:32
    ds_read_b64_tr_b16 a[114:115], v136 offset:800
    ds_read_b64_tr_b16 a[136:137], v136 offset:64
    buffer_load_dwordx4 v123, s[44:47], s4 offen lds
    ds_read_b64_tr_b16 a[138:139], v136 offset:832
    v_and_b32 v128, 0xffff0000, v128
    v_mul_f32 v128, 0xbfb8aa3b, v128
    v_exp_f32 v128, v128
    v_cvt_pk_bf16_f32 v110, v160, v161
    v_add_f32 v128, 1.0, v128
    v_rcp_f32 v128, v128
    v_cvt_pk_bf16_f32 v111, v162, v163
    v_cvt_pk_bf16_f32 v128, v128, v128
    v_and_b32 v128, 0xffff0000, v128
    v_mfma_f32_16x16x16_bf16 v[148:151], v[108:109], v[110:111], 0
    v_add_f32 v128, -0.5, v128
    v_mul_f32 v128, 0x41b8aa3b, v128
    buffer_load_dwordx4 v133, s[44:47], s4 offen offset:1024 lds
    ds_write_b32 v138, v128 offset:4
    v_lshlrev_b32 v120, 16, v120
    s_waitcnt lgkmcnt(5)
    v_mfma_f32_16x16x32_bf16 v[204:207], a[88:91], v[184:187], v[204:207]
    s_waitcnt lgkmcnt(3)
    v_cvt_pk_bf16_f32 v148, v148, v148
    v_and_b32 v148, 0xffff0000, v148
    v_mfma_f32_16x16x32_bf16 v[156:159], a[112:115], v[184:187], v[156:159]
    s_waitcnt lgkmcnt(1)
    ds_read_b128 v[160:163], v141 offset:6144
    v_mul_f32 v148, 0xbfb8aa3b, v148
    v_mfma_f32_16x16x32_bf16 v[216:219], a[136:139], v[184:187], v[216:219]
    v_exp_f32 v148, v148
    buffer_load_dwordx4 v135, s[44:47], s4 offen offset:2048 lds
    s_add_u32 m0, s66, 0
    s_add_u32 s4, s68, 73728
    v_add_f32 v148, 1.0, v148
    v_rcp_f32 v148, v148
    v_max_f32 v120, 0xc2c80000, v120
    v_cvt_pk_bf16_f32 v148, v148, v148
    v_and_b32 v148, 0xffff0000, v148
    s_waitcnt vmcnt(6)
    ds_read_b64_tr_b16 a[92:93], v136 offset:3072
    ds_read_b64_tr_b16 a[94:95], v136 offset:3840
    ds_read_b64_tr_b16 a[116:117], v136 offset:3104
    ds_read_b64_tr_b16 a[118:119], v136 offset:3872
    ds_read_b64_tr_b16 a[140:141], v136 offset:3136
    ds_read_b64_tr_b16 a[142:143], v136 offset:3904
    buffer_load_dwordx4 v123, s[44:47], s4 offen lds
    s_waitcnt lgkmcnt(6)
    v_mfma_f32_16x16x32_bf16 v[192:195], a[76:79], v[160:163], v[192:195]
    v_add_f32 v148, -0.5, v148
    v_mul_f32 v148, 0x41b8aa3b, v148
    v_mfma_f32_16x16x32_bf16 v[200:203], a[100:103], v[160:163], v[200:203]
    ds_write_b32 v138, v148 offset:8
    v_mfma_f32_16x16x32_bf16 v[208:211], a[124:127], v[160:163], v[208:211]
    v_min_f32 v120, 0x40930000, v120
    v_mul_f32 v120, 0x3fb8aa3b, v120
    v_exp_f32 v120, v120
    buffer_load_dwordx4 v133, s[44:47], s4 offen offset:1024 lds
    v_cvt_pk_bf16_f32 v120, v120, v120
    s_waitcnt lgkmcnt(5)
    v_mfma_f32_16x16x32_bf16 v[204:207], a[92:95], v[172:175], v[204:207]
    s_waitcnt lgkmcnt(3)
    v_and_b32 v120, 0xffff0000, v120
    v_mul_f32 v134, 0x3fb8aa3b, v120
    v_mfma_f32_16x16x32_bf16 v[156:159], a[116:119], v[172:175], v[156:159]
    s_waitcnt lgkmcnt(1)
    ds_read_b128 v[128:131], v140 offset:6272
    v_readfirstlane_b32 s37, v120
    v_mfma_f32_16x16x32_bf16 v[216:219], a[140:143], v[172:175], v[216:219]
    v_readfirstlane_b32 s31, v134
    v_fma_f32 v120, v204, v204, s32
    v_fmac_f32 v120, v205, v205
    buffer_load_dwordx4 v135, s[44:47], s4 offen offset:2048 lds
    s_waitcnt lgkmcnt(1)
    s_barrier
    ds_read_b32 v22, v22 offset:0
    ds_read_b32 v23, v23 offset:672
    ds_read_b32 v24, v24 offset:0
    ds_read_b32 v25, v25 offset:672
    ds_read_b32 v26, v26 offset:0
    ds_read_b32 v27, v27 offset:672
    s_waitcnt vmcnt(6)
    ds_read_b64_tr_b16 a[0:1], v137 offset:0
    ds_read_b64_tr_b16 a[2:3], v137 offset:768
    ds_read_b64_tr_b16 a[24:25], v137 offset:32
    s_add_u32 m0, s66, 3072
    ds_read_b64_tr_b16 a[26:27], v137 offset:800
    s_add_u32 s4, s68, 110592
    ds_read_b64_tr_b16 a[48:49], v137 offset:64
    buffer_load_dwordx4 v123, s[44:47], s4 offen lds
    s_waitcnt lgkmcnt(11)
    v_mfma_f32_16x16x32_bf16 v[192:195], a[80:83], v[128:131], v[192:195]
    ds_read_b64_tr_b16 a[50:51], v137 offset:832
    ds_read_b32 v40, v40 offset:336
    v_mfma_f32_16x16x32_bf16 v[192:195], a[84:87], v[164:167], v[192:195]
    ds_read_b32 v52, v52 offset:336
    ds_read_b32 v64, v64 offset:336
    v_mfma_f32_16x16x32_bf16 v[192:195], a[88:91], v[180:183], v[192:195]
    ds_read_b32 v41, v41 offset:332
    ds_read_b32 v53, v53 offset:332
    v_mfma_f32_16x16x32_bf16 v[192:195], a[92:95], v[188:191], v[192:195]
    s_waitcnt lgkmcnt(13)
    ds_read_b32 v65, v65 offset:332
    ds_read_b32 v42, v42 offset:328
    v_mfma_f32_16x16x32_bf16 v[200:203], a[104:107], v[128:131], v[200:203]
    s_waitcnt lgkmcnt(12)
    buffer_load_dwordx4 v133, s[44:47], s4 offen offset:1024 lds
    v_mfma_f32_16x16x32_bf16 v[200:203], a[108:111], v[164:167], v[200:203]
    s_waitcnt lgkmcnt(9)
    ds_read_b32 v54, v54 offset:328
    ds_read_b32 v66, v66 offset:328
    v_mfma_f32_16x16x32_bf16 v[200:203], a[112:115], v[180:183], v[200:203]
    s_waitcnt lgkmcnt(10)
    ds_read_b32 v43, v43 offset:324
    ds_read_b32 v55, v55 offset:324
    v_mfma_f32_16x16x32_bf16 v[200:203], a[116:119], v[188:191], v[200:203]
    ds_read_b32 v67, v67 offset:324
    ds_read_b32 v44, v44 offset:272
    v_mfma_f32_16x16x32_bf16 v[208:211], a[128:131], v[128:131], v[208:211]
    s_waitcnt lgkmcnt(12)
    ds_read_b32 v56, v56 offset:272
    ds_read_b32 v68, v68 offset:272
    v_mfma_f32_16x16x32_bf16 v[208:211], a[132:135], v[164:167], v[208:211]
    s_waitcnt lgkmcnt(12)
    buffer_load_dwordx4 v135, s[44:47], s4 offen offset:2048 lds
    v_mfma_f32_16x16x32_bf16 v[208:211], a[136:139], v[180:183], v[208:211]
    s_add_u32 m0, s67, 0
    ds_read_b32 v45, v45 offset:268
    ds_read_b32 v57, v57 offset:268
    v_mfma_f32_16x16x32_bf16 v[208:211], a[140:143], v[188:191], v[208:211]
    s_add_u32 s4, s68, 147456
    s_waitcnt vmcnt(6)
    ds_read_b64_tr_b16 a[4:5], v137 offset:3072
    v_mfma_f32_16x16x32_bf16 v[108:111], a[0:3], v[124:127], 0
    s_waitcnt lgkmcnt(11)
    ds_read_b64_tr_b16 a[6:7], v137 offset:3840
    ds_read_b64_tr_b16 a[28:29], v137 offset:3104
    v_mfma_f32_16x16x32_bf16 v[220:223], a[24:27], v[124:127], 0
    s_waitcnt lgkmcnt(11)
    ds_read_b64_tr_b16 a[30:31], v137 offset:3872
    ds_read_b64_tr_b16 a[52:53], v137 offset:3136
    v_mfma_f32_16x16x32_bf16 v[212:215], a[48:51], v[124:127], 0
    s_waitcnt lgkmcnt(11)
    buffer_load_dwordx4 v123, s[44:47], s4 offen lds
    v_mfma_f32_16x16x32_bf16 v[224:227], a[0:3], v[112:115], 0
    s_waitcnt lgkmcnt(9)
    ds_read_b64_tr_b16 a[54:55], v137 offset:3904
    ds_read_b32 v69, v69 offset:268
    v_mfma_f32_16x16x32_bf16 v[232:235], a[24:27], v[112:115], 0
    s_waitcnt lgkmcnt(9)
    ds_read_b32 v46, v46 offset:264
    ds_read_b32 v58, v58 offset:264
    v_mfma_f32_16x16x32_bf16 v[236:239], a[48:51], v[112:115], 0
    ds_read_b128 v[148:151], v1 offset:20608
    ds_read_b32 v70, v70 offset:264
    ds_read_b32 v47, v47 offset:260
    ds_read_b32 v59, v59 offset:260
    ds_read_b32 v71, v71 offset:260
    ds_read_b32 v48, v48 offset:208
    buffer_load_dwordx4 v133, s[44:47], s4 offen offset:1024 lds
    s_waitcnt lgkmcnt(12)
    v_mfma_f32_16x16x32_bf16 v[108:111], a[4:7], v[228:231], v[108:111]
    ds_read_b32 v60, v60 offset:208
    ds_read_b32 v72, v72 offset:208
    v_mfma_f32_16x16x32_bf16 v[224:227], a[4:7], v[160:163], v[224:227]
    s_waitcnt lgkmcnt(12)
    ds_read_b32 v49, v49 offset:204
    ds_read_b32 v61, v61 offset:204
    v_mfma_f32_16x16x32_bf16 v[220:223], a[28:31], v[228:231], v[220:223]
    ds_read_b32 v73, v73 offset:204
    ds_read_b32 v50, v50 offset:200
    v_mfma_f32_16x16x32_bf16 v[232:235], a[28:31], v[160:163], v[232:235]
    s_waitcnt lgkmcnt(14)
    ds_read_b32 v62, v62 offset:200
    ds_read_b32 v74, v74 offset:200
    v_mfma_f32_16x16x32_bf16 v[212:215], a[52:55], v[228:231], v[212:215]
    s_waitcnt lgkmcnt(14)
    buffer_load_dwordx4 v135, s[44:47], s4 offen offset:2048 lds
    v_mfma_f32_16x16x32_bf16 v[236:239], a[52:55], v[160:163], v[236:239]
    s_add_u32 m0, s67, 3072
    ds_read_b128 v[112:115], v0 offset:20736
    s_waitcnt vmcnt(6)
    ds_read_b64_tr_b16 a[8:9], v136 offset:0
    ds_read_b64_tr_b16 a[10:11], v136 offset:768
    ds_read_b64_tr_b16 a[32:33], v136 offset:32
    ds_read_b64_tr_b16 a[34:35], v136 offset:800
    ds_read_b64_tr_b16 a[56:57], v136 offset:64
    ds_read_b64_tr_b16 a[58:59], v136 offset:832
    s_add_u32 s4, s68, 184320
    ds_read_b32 v51, v51 offset:196
    ds_read_b32 v63, v63 offset:196
    ds_read_b32 v75, v75 offset:196
    buffer_load_dwordx4 v123, s[44:47], s4 offen lds
    ds_read_b32 v119, v119 offset:336
    v_cndmask_b32 v22, v146, v22, s[88:89]
    v_cndmask_b32 v24, v146, v24, s[88:89]
    v_cndmask_b32 v26, v146, v26, s[88:89]
    v_fmac_f32 v120, v206, v206
    v_fmac_f32 v120, v207, v207
    v_fmac_f32 v120, v156, v156
    v_fmac_f32 v120, v157, v157
    v_fmac_f32 v120, v158, v158
    v_fmac_f32 v120, v159, v159
    v_fmac_f32 v120, v216, v216
    v_fmac_f32 v120, v217, v217
    v_fmac_f32 v120, v218, v218
    v_fmac_f32 v120, v219, v219
    s_waitcnt lgkmcnt(8)
    v_mfma_f32_16x16x32_bf16 v[108:111], a[8:11], v[196:199], v[108:111]
    s_waitcnt lgkmcnt(6)
    buffer_load_dwordx4 v133, s[44:47], s4 offen offset:1024 lds
    v_mfma_f32_16x16x32_bf16 v[220:223], a[32:35], v[196:199], v[220:223]
    s_waitcnt lgkmcnt(3)
    v_fma_f32 v138, v192, v192, s32
    v_fmac_f32 v138, v193, v193
    v_mfma_f32_16x16x32_bf16 v[212:215], a[56:59], v[196:199], v[212:215]
    s_waitcnt lgkmcnt(1)
    v_fmac_f32 v138, v194, v194
    v_fmac_f32 v138, v195, v195
    v_mfma_f32_16x16x32_bf16 v[224:227], a[8:11], v[128:131], v[224:227]
    s_waitcnt lgkmcnt(0)
    v_readfirstlane_b32 s39, v119
    v_fmac_f32 v138, v200, v200
    v_mfma_f32_16x16x32_bf16 v[232:235], a[32:35], v[128:131], v[232:235]
    v_fmac_f32 v138, v201, v201
    v_fmac_f32 v138, v202, v202
    v_mfma_f32_16x16x32_bf16 v[236:239], a[56:59], v[128:131], v[236:239]
    buffer_load_dwordx4 v135, s[44:47], s4 offen offset:2048 lds
    ds_read_b128 v[228:231], v1 offset:20736
    s_add_u32 m0, s66, 0
    s_add_u32 s4, s68, 768
    v_fmac_f32 v138, v203, v203
    v_fmac_f32 v138, v208, v208
    s_waitcnt vmcnt(6)
    ds_read_b64_tr_b16 a[12:13], v136 offset:3072
    ds_read_b64_tr_b16 a[14:15], v136 offset:3840
    ds_read_b64_tr_b16 a[36:37], v136 offset:3104
    ds_read_b64_tr_b16 a[38:39], v136 offset:3872
    ds_read_b64_tr_b16 a[60:61], v136 offset:3136
    ds_read_b64_tr_b16 a[62:63], v136 offset:3904
    v_fmac_f32 v138, v209, v209
    v_fmac_f32 v138, v210, v210
    buffer_load_dwordx4 v123, s[44:47], s4 offen lds
    v_fmac_f32 v138, v211, v211
    buffer_load_dwordx4 v133, s[44:47], s4 offen offset:1024 lds
    s_waitcnt lgkmcnt(2)
    v_mfma_f32_16x16x32_bf16 v[108:111], a[12:15], v[176:179], v[108:111]
    s_waitcnt lgkmcnt(0)
    v_mfma_f32_16x16x32_bf16 v[220:223], a[36:39], v[176:179], v[220:223]
    v_mfma_f32_16x16x32_bf16 v[212:215], a[60:63], v[176:179], v[212:215]
    v_mfma_f32_16x16x32_bf16 v[224:227], a[12:15], v[164:167], v[224:227]
    v_mfma_f32_16x16x32_bf16 v[232:235], a[36:39], v[164:167], v[232:235]
    buffer_load_dwordx4 v135, s[44:47], s4 offen offset:2048 lds
    v_mfma_f32_16x16x32_bf16 v[236:239], a[60:63], v[164:167], v[236:239]
    s_add_u32 m0, s66, 3072
    ds_read_b128 v[196:199], v0 offset:20480
    s_add_u32 s4, s68, 37632
    s_waitcnt vmcnt(6)
    ds_read_b64_tr_b16 a[16:17], v137 offset:0
    ds_read_b64_tr_b16 a[18:19], v137 offset:768
    ds_read_b64_tr_b16 a[40:41], v137 offset:32
    ds_read_b64_tr_b16 a[42:43], v137 offset:800
    ds_read_b64_tr_b16 a[64:65], v137 offset:64
    ds_read_b64_tr_b16 a[66:67], v137 offset:832
    buffer_load_dwordx4 v123, s[44:47], s4 offen lds
    s_waitcnt lgkmcnt(6)
    v_mfma_f32_16x16x32_bf16 v[176:179], a[96:99], v[196:199], 0
    v_mfma_f32_16x16x32_bf16 v[124:127], a[120:123], v[196:199], 0
    s_waitcnt lgkmcnt(4)
    buffer_load_dwordx4 v133, s[44:47], s4 offen offset:1024 lds
    v_mfma_f32_16x16x32_bf16 v[108:111], a[16:19], v[184:187], v[108:111]
    s_waitcnt lgkmcnt(0)
    v_mfma_f32_16x16x32_bf16 v[220:223], a[40:43], v[184:187], v[220:223]
    v_mfma_f32_16x16x32_bf16 v[212:215], a[64:67], v[184:187], v[212:215]
    v_mfma_f32_16x16x32_bf16 v[224:227], a[16:19], v[180:183], v[224:227]
    v_mfma_f32_16x16x32_bf16 v[232:235], a[40:43], v[180:183], v[232:235]
    buffer_load_dwordx4 v135, s[44:47], s4 offen offset:2048 lds
    v_mfma_f32_16x16x32_bf16 v[236:239], a[64:67], v[180:183], v[236:239]
    s_add_u32 m0, s67, 0
    ds_read_b128 v[184:187], v1 offset:20480
    s_add_u32 s4, s68, 74496
    v_mfma_f32_16x16x32_bf16 v[160:163], a[24:27], v[196:199], 0
    v_mfma_f32_16x16x32_bf16 v[116:119], a[48:51], v[196:199], 0
    s_waitcnt vmcnt(6)
    ds_read_b64_tr_b16 a[20:21], v137 offset:3072
    ds_read_b64_tr_b16 a[22:23], v137 offset:3840
    ds_read_b64_tr_b16 a[44:45], v137 offset:3104
    ds_read_b64_tr_b16 a[46:47], v137 offset:3872
    ds_read_b64_tr_b16 a[68:69], v137 offset:3136
    ds_read_b64_tr_b16 a[70:71], v137 offset:3904
    buffer_load_dwordx4 v123, s[44:47], s4 offen lds
    s_waitcnt lgkmcnt(6)
    v_mfma_f32_16x16x32_bf16 v[176:179], a[100:103], v[184:187], v[176:179]
    v_mfma_f32_16x16x32_bf16 v[124:127], a[124:127], v[184:187], v[124:127]
    buffer_load_dwordx4 v133, s[44:47], s4 offen offset:1024 lds
    v_mfma_f32_16x16x32_bf16 v[160:163], a[28:31], v[184:187], v[160:163]
    s_waitcnt lgkmcnt(4)
    v_mfma_f32_16x16x32_bf16 v[108:111], a[20:23], v[172:175], v[108:111]
    s_waitcnt lgkmcnt(0)
    v_mfma_f32_16x16x32_bf16 v[220:223], a[44:47], v[172:175], v[220:223]
    v_mfma_f32_16x16x32_bf16 v[212:215], a[68:71], v[172:175], v[212:215]
    v_mfma_f32_16x16x32_bf16 v[224:227], a[20:23], v[188:191], v[224:227]
    buffer_load_dwordx4 v135, s[44:47], s4 offen offset:2048 lds
    v_mfma_f32_16x16x32_bf16 v[232:235], a[44:47], v[188:191], v[232:235]
    s_add_u32 m0, s67, 3072
    ds_read_b128 v[172:175], v0 offset:20608
    v_fma_f32 v134, v108, v108, s32
    v_mfma_f32_16x16x32_bf16 v[236:239], a[68:71], v[188:191], v[236:239]
    s_add_u32 s4, s68, 111360
    v_fmac_f32 v134, v109, v109
    s_waitcnt vmcnt(6)
    v_mfma_f32_16x16x32_bf16 v[116:119], a[52:55], v[184:187], v[116:119]
    ds_read_b64_tr_b16 a[144:145], v136 offset:0
    ds_read_b64_tr_b16 a[146:147], v136 offset:768
    ds_read_b64_tr_b16 a[168:169], v136 offset:32
    ds_read_b64_tr_b16 a[170:171], v136 offset:800
    ds_read_b64_tr_b16 a[192:193], v136 offset:64
    ds_read_b64_tr_b16 a[194:195], v136 offset:832
    buffer_load_dwordx4 v123, s[44:47], s4 offen lds
    v_fmac_f32 v134, v110, v110
    v_fmac_f32 v134, v111, v111
    v_fmac_f32 v134, v220, v220
    v_fmac_f32 v134, v221, v221
    v_fmac_f32 v134, v222, v222
    v_fmac_f32 v134, v223, v223
    v_fmac_f32 v134, v212, v212
    v_fmac_f32 v134, v213, v213
    v_fmac_f32 v134, v214, v214
    v_fmac_f32 v134, v215, v215
    v_cvt_pk_bf16_f32 v36, v134, v120
    s_waitcnt lgkmcnt(6)
    v_mfma_f32_16x16x32_bf16 v[176:179], a[104:107], v[172:175], v[176:179]
    v_fma_f32 v120, v224, v224, s32
    v_fmac_f32 v120, v225, v225
    v_mfma_f32_16x16x32_bf16 v[188:191], v[32:35], v[36:39], 0
    buffer_load_dwordx4 v133, s[44:47], s4 offen offset:1024 lds
    v_mfma_f32_16x16x32_bf16 v[176:179], a[108:111], v[148:151], v[176:179]
    s_waitcnt lgkmcnt(3)
    v_fmac_f32 v120, v226, v226
    v_fmac_f32 v120, v227, v227
    v_mfma_f32_16x16x32_bf16 v[176:179], a[112:115], v[112:115], v[176:179]
    s_waitcnt lgkmcnt(0)
    v_fmac_f32 v120, v232, v232
    v_fmac_f32 v120, v233, v233
    v_mfma_f32_16x16x32_bf16 v[176:179], a[116:119], v[228:231], v[176:179]
    v_rsq_f32 v189, v189
    v_mfma_f32_16x16x32_bf16 v[124:127], a[128:131], v[172:175], v[124:127]
    v_rsq_f32 v188, v188
    v_mfma_f32_16x16x32_bf16 v[124:127], a[132:135], v[148:151], v[124:127]
    buffer_load_dwordx4 v135, s[44:47], s4 offen offset:2048 lds
    v_mfma_f32_16x16x32_bf16 v[124:127], a[136:139], v[112:115], v[124:127]
    s_add_u32 m0, s66, 0
    v_mul_f32 v188, s31, v188
    v_mul_f32 v204, v189, v204
    v_mfma_f32_16x16x32_bf16 v[124:127], a[140:143], v[228:231], v[124:127]
    s_add_u32 s4, s68, 148224
    s_waitcnt vmcnt(6)
    ds_read_b64_tr_b16 a[148:149], v136 offset:3072
    v_mfma_f32_16x16x32_bf16 v[160:163], a[32:35], v[172:175], v[160:163]
    ds_read_b64_tr_b16 a[150:151], v136 offset:3840
    ds_read_b64_tr_b16 a[172:173], v136 offset:3104
    v_mfma_f32_16x16x32_bf16 v[160:163], a[36:39], v[148:151], v[160:163]
    ds_read_b64_tr_b16 a[174:175], v136 offset:3872
    ds_read_b64_tr_b16 a[196:197], v136 offset:3136
    v_mfma_f32_16x16x32_bf16 v[160:163], a[40:43], v[112:115], v[160:163]
    buffer_load_dwordx4 v123, s[44:47], s4 offen lds
    v_mfma_f32_16x16x32_bf16 v[160:163], a[44:47], v[228:231], v[160:163]
    ds_read_b64_tr_b16 a[198:199], v136 offset:3904
    v_mul_f32 v205, v189, v205
    v_mfma_f32_16x16x32_bf16 v[116:119], a[56:59], v[172:175], v[116:119]
    v_cvt_pk_bf16_f32 v180, v204, v205
    v_mul_f32 v206, v189, v206
    v_mfma_f32_16x16x32_bf16 v[116:119], a[60:63], v[148:151], v[116:119]
    v_mul_f32 v207, v189, v207
    v_cvt_pk_bf16_f32 v181, v206, v207
    v_mfma_f32_16x16x32_bf16 v[116:119], a[64:67], v[112:115], v[116:119]
    v_mul_f32 v156, v189, v156
    v_mul_f32 v157, v189, v157
    v_mfma_f32_16x16x32_bf16 v[116:119], a[68:71], v[228:231], v[116:119]
    s_waitcnt lgkmcnt(5)
    buffer_load_dwordx4 v133, s[44:47], s4 offen offset:1024 lds
    v_mfma_f32_16x16x32_bf16 v[128:131], v[196:199], a[144:147], 0
    s_waitcnt lgkmcnt(3)
    v_cvt_pk_bf16_f32 v182, v156, v157
    v_mul_f32 v158, v189, v158
    v_mfma_f32_16x16x32_bf16 v[128:131], v[184:187], a[148:151], v[128:131]
    s_waitcnt lgkmcnt(1)
    v_mul_f32 v159, v189, v159
    v_cvt_pk_bf16_f32 v183, v158, v159
    v_mfma_f32_16x16x32_bf16 v[164:167], v[196:199], a[168:171], 0
    ds_write_b128 v143, v[180:183]
    v_mfma_f32_16x16x32_bf16 v[164:167], v[184:187], a[172:175], v[164:167]
    s_waitcnt lgkmcnt(1)
    buffer_load_dwordx4 v135, s[44:47], s4 offen offset:2048 lds
    v_mfma_f32_16x16x32_bf16 v[180:183], v[196:199], a[192:195], 0
    s_add_u32 m0, s66, 3072
    v_mul_f32 v216, v189, v216
    v_mul_f32 v217, v189, v217
    v_mfma_f32_16x16x32_bf16 v[180:183], v[184:187], a[196:199], v[180:183]
    s_waitcnt vmcnt(6)
    ds_read_b64_tr_b16 a[152:153], v137 offset:0
    ds_read_b64_tr_b16 a[154:155], v137 offset:768
    ds_read_b64_tr_b16 a[176:177], v137 offset:32
    ds_read_b64_tr_b16 a[178:179], v137 offset:800
    ds_read_b64_tr_b16 a[200:201], v137 offset:64
    ds_read_b64_tr_b16 a[202:203], v137 offset:832
    s_add_u32 s4, s68, 185088
    v_cvt_pk_bf16_f32 v242, v216, v217
    v_mul_f32 v218, v189, v218
    buffer_load_dwordx4 v123, s[44:47], s4 offen lds
    v_mul_f32 v219, v189, v219
    ds_read_b128 v[244:247], v141 offset:128
    v_cvt_pk_bf16_f32 v243, v218, v219
    v_mul_f32 v108, v188, v108
    v_mul_f32 v109, v188, v109
    v_cvt_pk_bf16_f32 v248, v108, v109
    v_mul_f32 v110, v188, v110
    v_mul_f32 v111, v188, v111
    v_cvt_pk_bf16_f32 v249, v110, v111
    v_mul_f32 v220, v188, v220
    v_mul_f32 v221, v188, v221
    v_cvt_pk_bf16_f32 v250, v220, v221
    v_mul_f32 v222, v188, v222
    buffer_load_dwordx4 v133, s[44:47], s4 offen offset:1024 lds
    s_waitcnt lgkmcnt(2)
    v_mfma_f32_16x16x32_bf16 v[128:131], v[172:175], a[152:155], v[128:131]
    s_waitcnt lgkmcnt(1)
    ds_write_b64 v143, v[242:243] offset:48
    v_mfma_f32_16x16x32_bf16 v[164:167], v[172:175], a[176:179], v[164:167]
    v_mul_f32 v223, v188, v223
    v_cvt_pk_bf16_f32 v251, v222, v223
    v_mfma_f32_16x16x32_bf16 v[180:183], v[172:175], a[200:203], v[180:183]
    ds_write_b128 v143, v[248:251] offset:32
    buffer_load_dwordx4 v135, s[44:47], s4 offen offset:2048 lds
    s_add_u32 m0, s28, 8192
    s_add_u32 s4, 0, 12288
    v_mul_f32 v212, v188, v212
    v_mul_f32 v213, v188, v213
    v_cvt_pk_bf16_f32 v240, v212, v213
    v_mul_f32 v214, v188, v214
    v_mul_f32 v215, v188, v215
    s_waitcnt vmcnt(6)
    ds_read_b64_tr_b16 a[156:157], v137 offset:3072
    ds_read_b64_tr_b16 a[158:159], v137 offset:3840
    ds_read_b64_tr_b16 a[180:181], v137 offset:3104
    ds_read_b64_tr_b16 a[182:183], v137 offset:3872
    ds_read_b64_tr_b16 a[204:205], v137 offset:3136
    ds_read_b64_tr_b16 a[206:207], v137 offset:3904
    ds_read_b128 v[188:191], v140 offset:256
    buffer_load_dwordx4 v12, s[8:11], s25 offen nt lds
    s_add_u32 m0, s28, 12288
    v_cvt_pk_bf16_f32 v241, v214, v215
    v_mul_f32 v204, v108, v204
    v_fmac_f32 v204, v109, v205
    v_fmac_f32 v204, v110, v206
    ds_read_b128 v[248:251], v141 offset:256
    ds_write_b64 v143, v[240:241] offset:72
    v_fmac_f32 v204, v111, v207
    v_fmac_f32 v204, v220, v156
    v_fmac_f32 v204, v221, v157
    v_fmac_f32 v204, v222, v158
    buffer_load_dwordx4 v13, s[8:11], s25 offen nt lds
    s_waitcnt lgkmcnt(7)
    v_mfma_f32_16x16x32_bf16 v[128:131], v[148:151], a[156:159], v[128:131]
    s_waitcnt lgkmcnt(5)
    v_fmac_f32 v204, v223, v159
    v_fmac_f32 v204, v212, v216
    v_mfma_f32_16x16x32_bf16 v[164:167], v[148:151], a[180:183], v[164:167]
    s_waitcnt lgkmcnt(2)
    ds_read_b128 v[108:111], v140 offset:0
    v_fmac_f32 v204, v213, v217
    v_mfma_f32_16x16x32_bf16 v[180:183], v[148:151], a[204:207], v[180:183]
    s_add_u32 m0, s29, 0
    v_fmac_f32 v204, v214, v218
    v_fmac_f32 v204, v215, v219
    v_mov_b32 v123, v204
    v_fmac_f32 v120, v234, v234
    buffer_load_dwordx4 v14, s[8:11], s25 offen nt lds
    s_add_u32 m0, s67, 0
    s_cmp_lt_u32 1, s17
    s_cselect_b32 s10, s36, 0
    v_permlane32_swap_b32 v204, v123
    v_add_f32 v204, v204, v123
    v_mov_b32 v123, v204
    v_fmac_f32 v120, v235, v235
    v_fmac_f32 v120, v236, v236
    s_waitcnt vmcnt(6)
    s_mov_b32 s25, s24
    ds_read_b64_tr_b16 a[160:161], v136 offset:0
    ds_read_b64_tr_b16 a[162:163], v136 offset:768
    ds_read_b64_tr_b16 a[184:185], v136 offset:32
    ds_read_b64_tr_b16 a[186:187], v136 offset:800
    ds_read_b64_tr_b16 a[208:209], v136 offset:64
    s_waitcnt lgkmcnt(5)
    v_mfma_f32_16x16x32_bf16 v[212:215], v[108:111], a[144:147], 0
    buffer_load_dwordx4 v139, s[48:51], 0 offen lds
    ds_read_b64_tr_b16 a[210:211], v136 offset:832
    v_mfma_f32_16x16x32_bf16 v[156:159], v[108:111], a[168:171], 0
    v_permlane16_swap_b32 v204, v123
    v_mfma_f32_16x16x32_bf16 v[220:223], v[108:111], a[192:195], 0
    ds_read_b128 v[108:111], v141 offset:6272
    v_add_f32 v204, v204, v123
    v_add_f32 v204, s39, v204
    v_mov_b32 v205, v146
    v_mov_b32 v206, v146
    v_mov_b32 v207, v146
    v_cndmask_b32 v204, v146, v204, s[88:89]
    ds_write_b128 v145, v[204:207] offset:192
    v_mfma_f32_16x16x32_bf16 v[204:207], a[72:75], v[196:199], 0
    s_waitcnt lgkmcnt(4)
    buffer_load_dwordx4 v147, s[48:51], 0 offen offset:1024 lds
    v_fmac_f32 v120, v237, v237
    v_mfma_f32_16x16x32_bf16 v[204:207], a[76:79], v[184:187], v[204:207]
    s_waitcnt lgkmcnt(3)
    v_fmac_f32 v120, v238, v238
    v_fmac_f32 v120, v239, v239
    v_mfma_f32_16x16x32_bf16 v[204:207], a[80:83], v[172:175], v[204:207]
    s_waitcnt lgkmcnt(2)
    v_cvt_pk_bf16_f32 v36, v120, v138
    v_mfma_f32_16x16x32_bf16 v[204:207], a[84:87], v[148:151], v[204:207]
    v_mfma_f32_16x16x32_bf16 v[204:207], a[88:91], v[112:115], v[204:207]
    s_waitcnt lgkmcnt(1)
    v_mfma_f32_16x16x32_bf16 v[216:219], v[32:35], v[36:39], 0
    buffer_load_dwordx4 v132, s[48:51], 0 offen offset:2048 lds
    s_add_u32 m0, s67, 3072
    v_mfma_f32_16x16x32_bf16 v[204:207], a[92:95], v[228:231], v[204:207]
    s_waitcnt vmcnt(6)
    ds_read_b64_tr_b16 a[164:165], v136 offset:3072
    ds_read_b64_tr_b16 a[166:167], v136 offset:3840
    v_mfma_f32_16x16x32_bf16 v[128:131], v[112:115], a[160:163], v[128:131]
    ds_read_b64_tr_b16 a[188:189], v136 offset:3104
    ds_read_b64_tr_b16 a[190:191], v136 offset:3872
    v_mfma_f32_16x16x32_bf16 v[164:167], v[112:115], a[184:187], v[164:167]
    ds_read_b64_tr_b16 a[212:213], v136 offset:3136
    ds_read_b64_tr_b16 a[214:215], v136 offset:3904
    v_mfma_f32_16x16x32_bf16 v[180:183], v[112:115], a[208:211], v[180:183]
    ds_read_b128 v[240:243], v141 offset:0
    buffer_load_dwordx4 v139, s[48:51], s4 offen lds
    v_rsq_f32 v217, v217
    v_rsq_f32 v216, v216
    v_mul_f32 v192, v217, v192
    v_mul_f32 v216, s31, v216
    v_mul_f32 v193, v217, v193
    v_cvt_pk_bf16_f32 v252, v192, v193
    v_mul_f32 v194, v217, v194
    v_mul_f32 v195, v217, v195
    v_cvt_pk_bf16_f32 v253, v194, v195
    v_mul_f32 v200, v217, v200
    s_waitcnt lgkmcnt(5)
    v_mfma_f32_16x16x32_bf16 v[128:131], v[228:231], a[164:167], v[128:131]
    buffer_load_dwordx4 v147, s[48:51], s4 offen offset:1024 lds
    s_waitcnt lgkmcnt(2)
    v_mfma_f32_16x16x32_bf16 v[164:167], v[228:231], a[188:191], v[164:167]
    s_waitcnt lgkmcnt(1)
    v_mul_f32 v201, v217, v201
    v_cvt_pk_bf16_f32 v254, v200, v201
    v_mfma_f32_16x16x32_bf16 v[180:183], v[228:231], a[212:215], v[180:183]
    s_waitcnt lgkmcnt(0)
    v_mul_f32 v202, v217, v202
    v_mul_f32 v203, v217, v203
    v_mfma_f32_16x16x32_bf16 v[212:215], v[240:243], a[148:151], v[212:215]
    v_cvt_pk_bf16_f32 v255, v202, v203
    v_mul_f32 v208, v217, v208
    v_mfma_f32_16x16x32_bf16 v[156:159], v[240:243], a[172:175], v[156:159]
    ds_write_b128 v144, v[252:255]
    v_mfma_f32_16x16x32_bf16 v[220:223], v[240:243], a[196:199], v[220:223]
    buffer_load_dwordx4 v132, s[48:51], s4 offen offset:2048 lds
    s_add_u32 m0, s66, 0
    s_add_u32 s4, 0, 24576
    v_mul_f32 v209, v217, v209
    ds_read_b128 v[240:243], v140 offset:128
    v_cvt_pk_bf16_f32 v136, v208, v209
    v_mul_f32 v210, v217, v210
    v_mul_f32 v211, v217, v211
    v_cvt_pk_bf16_f32 v137, v210, v211
    v_mul_f32 v224, v216, v224
    v_mul_f32 v225, v216, v225
    v_cvt_pk_bf16_f32 v252, v224, v225
    v_mul_f32 v226, v216, v226
    v_mul_f32 v227, v216, v227
    buffer_load_dwordx4 v139, s[48:51], s4 offen lds
    ds_write_b64 v144, v[136:137] offset:48
    v_cvt_pk_bf16_f32 v253, v226, v227
    v_mul_f32 v232, v216, v232
    v_mul_f32 v233, v216, v233
    v_cvt_pk_bf16_f32 v254, v232, v233
    v_mul_f32 v234, v216, v234
    v_mul_f32 v235, v216, v235
    v_cvt_pk_bf16_f32 v255, v234, v235
    v_mul_f32 v236, v216, v236
    v_mul_f32 v237, v216, v237
    v_cvt_pk_bf16_f32 v134, v236, v237
    v_mul_f32 v238, v216, v238
    s_waitcnt lgkmcnt(1)
    v_mfma_f32_16x16x32_bf16 v[212:215], v[240:243], a[152:155], v[212:215]
    ds_write_b128 v144, v[252:255] offset:32
    v_mfma_f32_16x16x32_bf16 v[212:215], v[244:247], a[156:159], v[212:215]
    v_mul_f32 v239, v216, v239
    v_cvt_pk_bf16_f32 v135, v238, v239
    v_mfma_f32_16x16x32_bf16 v[212:215], v[188:191], a[160:163], v[212:215]
    v_mul_f32 v192, v224, v192
    v_fmac_f32 v192, v225, v193
    v_mfma_f32_16x16x32_bf16 v[212:215], v[248:251], a[164:167], v[212:215]
    ds_write_b64 v144, v[134:135] offset:72
    v_mfma_f32_16x16x32_bf16 v[216:219], a[0:3], v[196:199], 0
    v_fmac_f32 v192, v226, v194
    v_fmac_f32 v192, v227, v195
    v_mfma_f32_16x16x32_bf16 v[216:219], a[4:7], v[184:187], v[216:219]
    ds_read_b128 v[184:187], v140 offset:6400
    v_fmac_f32 v192, v232, v200
    v_mfma_f32_16x16x32_bf16 v[216:219], a[8:11], v[172:175], v[216:219]
    v_fmac_f32 v192, v233, v201
    v_fmac_f32 v192, v234, v202
    v_mfma_f32_16x16x32_bf16 v[216:219], a[12:15], v[148:151], v[216:219]
    v_fmac_f32 v192, v235, v203
    v_fmac_f32 v192, v236, v208
    v_mfma_f32_16x16x32_bf16 v[216:219], a[16:19], v[112:115], v[216:219]
    v_fmac_f32 v192, v237, v209
    v_fmac_f32 v192, v238, v210
    v_mfma_f32_16x16x32_bf16 v[216:219], a[20:23], v[228:231], v[216:219]
    v_fmac_f32 v192, v239, v211
    v_mov_b32 v168, v192
    v_mfma_f32_16x16x32_bf16 v[156:159], v[240:243], a[176:179], v[156:159]
    v_fma_f32 v169, v204, v204, s32
    v_fmac_f32 v169, v205, v205
    v_mfma_f32_16x16x32_bf16 v[156:159], v[244:247], a[180:183], v[156:159]
    ds_read_b128 v[112:115], v140 offset:6144
    v_fmac_f32 v169, v206, v206
    v_mfma_f32_16x16x32_bf16 v[156:159], v[188:191], a[184:187], v[156:159]
    ds_read_b128 v[172:175], v141 offset:6144
    v_fmac_f32 v169, v207, v207
    v_mfma_f32_16x16x32_bf16 v[156:159], v[248:251], a[188:191], v[156:159]
    s_waitcnt lgkmcnt(2)
    ds_read_b128 v[228:231], v140 offset:6272
    v_fmac_f32 v169, v176, v176
    v_mfma_f32_16x16x32_bf16 v[220:223], v[240:243], a[200:203], v[220:223]
    ds_read_b128 v[196:199], v141 offset:6400
    v_fmac_f32 v169, v177, v177
    v_mfma_f32_16x16x32_bf16 v[220:223], v[244:247], a[204:207], v[220:223]
    v_permlane32_swap_b32 v192, v168
    v_mfma_f32_16x16x32_bf16 v[220:223], v[188:191], a[208:211], v[220:223]
    v_add_f32 v192, v192, v168
    v_mov_b32 v168, v192
    v_mfma_f32_16x16x32_bf16 v[220:223], v[248:251], a[212:215], v[220:223]
    v_fmac_f32 v169, v178, v178
    v_permlane16_swap_b32 v192, v168
    v_add_f32 v192, v192, v168
    s_waitcnt lgkmcnt(3)
    v_mfma_f32_16x16x32_bf16 v[208:211], v[112:115], a[144:147], 0
    v_add_f32 v192, s39, v192
    v_mov_b32 v193, v146
    v_mfma_f32_16x16x32_bf16 v[148:151], v[112:115], a[168:171], 0
    s_waitcnt lgkmcnt(2)
    v_mov_b32 v194, v146
    v_mov_b32 v195, v146
    v_mfma_f32_16x16x32_bf16 v[208:211], v[172:175], a[148:151], v[208:211]
    s_waitcnt lgkmcnt(1)
    v_cndmask_b32 v192, v146, v192, s[88:89]
    v_fmac_f32 v169, v179, v179
    v_mfma_f32_16x16x32_bf16 v[208:211], v[228:231], a[152:155], v[208:211]
    s_waitcnt lgkmcnt(0)
    ds_write_b128 v152, v[192:195] offset:192
    v_mfma_f32_16x16x32_bf16 v[208:211], v[108:111], a[156:159], v[208:211]
    v_fmac_f32 v169, v124, v124
    v_fmac_f32 v169, v125, v125
    v_mfma_f32_16x16x32_bf16 v[208:211], v[184:187], a[160:163], v[208:211]
    v_fmac_f32 v169, v126, v126
    v_fmac_f32 v169, v127, v127
    v_mfma_f32_16x16x32_bf16 v[208:211], v[196:199], a[164:167], v[208:211]
    v_fma_f32 v168, v216, v216, s32
    v_fmac_f32 v168, v217, v217
    v_mfma_f32_16x16x32_bf16 v[148:151], v[172:175], a[172:175], v[148:151]
    v_fmac_f32 v168, v218, v218
    v_fmac_f32 v168, v219, v219
    v_mfma_f32_16x16x32_bf16 v[148:151], v[228:231], a[176:179], v[148:151]
    v_fmac_f32 v168, v160, v160
    v_fmac_f32 v168, v161, v161
    v_mfma_f32_16x16x32_bf16 v[148:151], v[108:111], a[180:183], v[148:151]
    v_fmac_f32 v168, v162, v162
    v_fmac_f32 v168, v163, v163
    v_mfma_f32_16x16x32_bf16 v[148:151], v[184:187], a[184:187], v[148:151]
    v_fmac_f32 v168, v116, v116
    v_fmac_f32 v168, v117, v117
    v_mfma_f32_16x16x32_bf16 v[148:151], v[196:199], a[188:191], v[148:151]
    v_fmac_f32 v168, v118, v118
    v_fmac_f32 v168, v119, v119
    v_mfma_f32_16x16x32_bf16 v[192:195], v[112:115], a[192:195], 0
    v_cvt_pk_bf16_f32 v36, v168, v169
    v_cvt_pk_bf16_f32 v112, v128, v129
    v_mfma_f32_16x16x32_bf16 v[192:195], v[172:175], a[196:199], v[192:195]
    v_cvt_pk_bf16_f32 v113, v130, v131
    v_cvt_pk_bf16_f32 v136, v164, v165
    v_mfma_f32_16x16x32_bf16 v[172:175], v[32:35], v[36:39], 0
    v_cvt_pk_bf16_f32 v137, v166, v167
    v_cvt_pk_bf16_f32 v144, v180, v181
    v_mfma_f32_16x16x32_bf16 v[192:195], v[228:231], a[200:203], v[192:195]
    v_cvt_pk_bf16_f32 v145, v182, v183
    v_cvt_pk_bf16_f32 v212, v212, v212
    v_mfma_f32_16x16x32_bf16 v[192:195], v[108:111], a[204:207], v[192:195]
    v_cvt_pk_bf16_f32 v213, v213, v213
    v_cvt_pk_bf16_f32 v214, v214, v214
    v_mfma_f32_16x16x32_bf16 v[192:195], v[184:187], a[208:211], v[192:195]
    ds_write2_b32 v142, v212, v213 offset0:0 offset1:68
    v_mfma_f32_16x16x32_bf16 v[192:195], v[196:199], a[212:215], v[192:195]
    v_rsq_f32 v173, v173
    v_rsq_f32 v172, v172
    v_mul_f32 v204, v173, v204
    v_mul_f32 v172, s31, v172
    v_mul_f32 v205, v173, v205
    v_cvt_pk_bf16_f32 v184, v204, v205
    v_mul_f32 v206, v173, v206
    v_mul_f32 v207, v173, v207
    v_cvt_pk_bf16_f32 v185, v206, v207
    v_mul_f32 v176, v173, v176
    v_mul_f32 v177, v173, v177
    v_cvt_pk_bf16_f32 v186, v176, v177
    v_mul_f32 v178, v173, v178
    v_mul_f32 v179, v173, v179
    v_cvt_pk_bf16_f32 v187, v178, v179
    v_mul_f32 v124, v173, v124
    v_mul_f32 v125, v173, v125
    v_cvt_pk_bf16_f32 v178, v124, v125
    v_mul_f32 v126, v173, v126
    v_mul_f32 v127, v173, v127
    v_cvt_pk_bf16_f32 v179, v126, v127
    v_mul_f32 v216, v172, v216
    v_mul_f32 v217, v172, v217
    v_cvt_pk_bf16_f32 v124, v216, v217
    v_mul_f32 v218, v172, v218
    v_mul_f32 v219, v172, v219
    v_cvt_pk_bf16_f32 v125, v218, v219
    v_mul_f32 v160, v172, v160
    v_mul_f32 v161, v172, v161
    v_cvt_pk_bf16_f32 v126, v160, v161
    v_mul_f32 v162, v172, v162
    v_mul_f32 v163, v172, v163
    v_cvt_pk_bf16_f32 v127, v162, v163
    v_mul_f32 v116, v172, v116
    v_mul_f32 v117, v172, v117
    v_mfma_f32_16x16x32_bf16 v[204:207], v[184:187], v[124:127], v[40:43]
    v_cvt_pk_bf16_f32 v176, v116, v117
    v_mul_f32 v118, v172, v118
    v_mul_f32 v119, v172, v119
    v_cvt_pk_bf16_f32 v177, v118, v119
    v_cvt_pk_bf16_f32 v215, v215, v215
    ds_write2_b32 v142, v214, v215 offset0:136 offset1:204
    v_mfma_f32_16x16x16_bf16 v[204:207], v[178:179], v[176:177], v[204:207]
    v_cvt_pk_bf16_f32 v156, v156, v156
    v_cvt_pk_bf16_f32 v157, v157, v157
    v_cvt_pk_bf16_f32 v158, v158, v158
    v_cvt_pk_bf16_f32 v159, v159, v159
    ds_write2_b32 v142, v156, v157 offset0:16 offset1:84
    v_cvt_pk_bf16_f32 v220, v220, v220
    v_cvt_pk_bf16_f32 v221, v221, v221
    ds_write2_b32 v142, v158, v159 offset0:152 offset1:220
    v_cvt_pk_bf16_f32 v222, v222, v222
    v_cvt_pk_bf16_f32 v223, v223, v223
    ds_write2_b32 v142, v220, v221 offset0:32 offset1:100
    v_cvt_pk_bf16_f32 v208, v208, v208
    v_cvt_pk_bf16_f32 v209, v209, v209
    ds_write2_b32 v142, v222, v223 offset0:168 offset1:236
    v_cvt_pk_bf16_f32 v210, v210, v210
    v_cvt_pk_bf16_f32 v211, v211, v211
    ds_write2_b32 v153, v208, v209 offset0:0 offset1:68
    v_cvt_pk_bf16_f32 v148, v148, v148
    v_cvt_pk_bf16_f32 v149, v149, v149
    ds_write2_b32 v153, v210, v211 offset0:136 offset1:204
    v_cvt_pk_bf16_f32 v150, v150, v150
    v_cvt_pk_bf16_f32 v151, v151, v151
    ds_write2_b32 v153, v148, v149 offset0:16 offset1:84
    v_cvt_pk_bf16_f32 v192, v192, v192
    v_cvt_pk_bf16_f32 v193, v193, v193
    ds_write2_b32 v153, v150, v151 offset0:152 offset1:220
    v_cvt_pk_bf16_f32 v194, v194, v194
    v_cvt_pk_bf16_f32 v195, v195, v195
    ds_write2_b32 v153, v192, v193 offset0:32 offset1:100
    buffer_load_dwordx4 v147, s[48:51], s4 offen offset:1024 lds
    ds_write2_b32 v153, v194, v195 offset0:168 offset1:236
    buffer_load_dwordx4 v132, s[48:51], s4 offen offset:2048 lds
    s_add_u32 m0, s66, 3072
    s_add_u32 s4, 0, 36864
    buffer_load_dwordx4 v139, s[48:51], s4 offen lds
    s_waitcnt vmcnt(10)
    s_barrier
    ds_read_b128 v[196:199], v0 offset:26624
    ds_read_b128 v[172:175], v1 offset:26624
    ds_read_b128 v[228:231], v0 offset:26752
    ds_read_b128 v[108:111], v1 offset:26752
    ds_read_b128 v[148:151], v0 offset:26880
    ds_read_b128 v[116:119], v1 offset:26880
    buffer_load_dwordx4 v147, s[48:51], s4 offen offset:1024 lds
    v_xor_b32 v152, 65536, v2
    v_lshrrev_b32 v120, 2, v152
    v_lshrrev_b32 v153, 8, v152
    v_add_u32 v152, 148992, v152
    v_lshl_add_u32 v123, s16, 2, v152
    v_add_u32 v120, 162048, v120
    v_lshlrev_b32 v153, 4, v153
    v_add_u32 v153, 162048, v153
    v_xor_b32 v2, 65536, v2
    s_waitcnt lgkmcnt(5)
    v_mfma_f32_16x16x32_bf16 v[216:219], a[72:75], v[196:199], 0
    s_waitcnt lgkmcnt(4)
    v_mfma_f32_16x16x32_bf16 v[216:219], a[76:79], v[172:175], v[216:219]
    s_waitcnt lgkmcnt(2)
    buffer_load_dwordx4 v132, s[48:51], s4 offen offset:2048 lds
    v_mfma_f32_16x16x32_bf16 v[216:219], a[80:83], v[228:231], v[216:219]
    s_add_u32 m0, s67, 0
    s_add_u32 s4, 0, 49152
    v_mfma_f32_16x16x32_bf16 v[216:219], a[84:87], v[108:111], v[216:219]
    s_waitcnt lgkmcnt(0)
    v_mfma_f32_16x16x32_bf16 v[216:219], a[88:91], v[148:151], v[216:219]
    v_mfma_f32_16x16x32_bf16 v[216:219], a[92:95], v[116:119], v[216:219]
    v_mfma_f32_16x16x32_bf16 v[140:143], a[96:99], v[196:199], 0
    s_waitcnt vmcnt(9)
    ds_read_b64 a[216:217], v171 offset:0
    ds_read_b64 a[218:219], v171 offset:1536
    v_mfma_f32_16x16x32_bf16 v[140:143], a[100:103], v[172:175], v[140:143]
    ds_read_b64 a[240:241], v171 offset:8
    ds_read_b64 a[242:243], v171 offset:1544
    v_mfma_f32_16x16x32_bf16 v[140:143], a[104:107], v[228:231], v[140:143]
    ds_read_b64 v[84:85], v122 offset:0
    ds_read_b64 v[86:87], v122 offset:1536
    v_mfma_f32_16x16x32_bf16 v[140:143], a[108:111], v[108:111], v[140:143]
    v_fma_f32 v146, v216, v216, s32
    v_fmac_f32 v146, v217, v217
    v_mfma_f32_16x16x32_bf16 v[140:143], a[112:115], v[148:151], v[140:143]
    v_fmac_f32 v146, v218, v218
    v_fmac_f32 v146, v219, v219
    v_mfma_f32_16x16x32_bf16 v[140:143], a[116:119], v[116:119], v[140:143]
    v_mfma_f32_16x16x32_bf16 v[160:163], a[120:123], v[196:199], 0
    v_mfma_f32_16x16x32_bf16 v[160:163], a[124:127], v[172:175], v[160:163]
    v_mfma_f32_16x16x32_bf16 v[160:163], a[128:131], v[228:231], v[160:163]
    s_waitcnt lgkmcnt(4)
    v_mfma_f32_16x16x32_bf16 v[160:163], a[132:135], v[108:111], v[160:163]
    s_waitcnt lgkmcnt(2)
    v_mfma_f32_16x16x32_bf16 v[160:163], a[136:139], v[148:151], v[160:163]
    s_waitcnt lgkmcnt(0)
    buffer_load_dwordx4 v139, s[48:51], s4 offen lds
    v_mfma_f32_16x16x32_bf16 v[160:163], a[140:143], v[116:119], v[160:163]
    v_fmac_f32 v146, v140, v140
    v_fmac_f32 v146, v141, v141
    v_mfma_f32_16x16x32_bf16 v[156:159], a[0:3], v[196:199], 0
    v_fmac_f32 v146, v142, v142
    v_fmac_f32 v146, v143, v143
    s_waitcnt vmcnt(7)
    v_mfma_f32_16x16x32_bf16 v[156:159], a[4:7], v[172:175], v[156:159]
    ds_read_b64 a[232:233], v171 offset:3072
    ds_read_b64 a[220:221], v171 offset:4608
    v_mfma_f32_16x16x32_bf16 v[156:159], a[8:11], v[228:231], v[156:159]
    ds_read_b64 v[76:77], v171 offset:3080
    ds_read_b64 a[244:245], v171 offset:4616
    v_mfma_f32_16x16x32_bf16 v[156:159], a[12:15], v[108:111], v[156:159]
    buffer_load_dwordx4 v147, s[48:51], s4 offen offset:1024 lds
    v_mfma_f32_16x16x32_bf16 v[156:159], a[16:19], v[148:151], v[156:159]
    ds_read_b64 v[100:101], v122 offset:3072
    ds_read_b64 v[88:89], v122 offset:4608
    v_mfma_f32_16x16x32_bf16 v[156:159], a[20:23], v[116:119], v[156:159]
    v_fmac_f32 v146, v160, v160
    v_fmac_f32 v146, v161, v161
    v_mfma_f32_16x16x32_bf16 v[208:211], a[24:27], v[196:199], 0
    v_fmac_f32 v146, v162, v162
    v_fmac_f32 v146, v163, v163
    v_mfma_f32_16x16x32_bf16 v[208:211], a[28:31], v[172:175], v[208:211]
    v_mfma_f32_16x16x32_bf16 v[208:211], a[32:35], v[228:231], v[208:211]
    buffer_load_dwordx4 v132, s[48:51], s4 offen offset:2048 lds
    v_mfma_f32_16x16x32_bf16 v[208:211], a[36:39], v[108:111], v[208:211]
    s_waitcnt lgkmcnt(4)
    v_fma_f32 v138, v156, v156, s32
    v_fmac_f32 v138, v157, v157
    v_mfma_f32_16x16x32_bf16 v[208:211], a[40:43], v[148:151], v[208:211]
    s_add_u32 m0, s67, 3072
    v_fmac_f32 v138, v158, v158
    v_fmac_f32 v138, v159, v159
    v_mfma_f32_16x16x32_bf16 v[208:211], a[44:47], v[116:119], v[208:211]
    s_add_u32 s4, 0, 61440
    v_mfma_f32_16x16x32_bf16 v[192:195], a[48:51], v[196:199], 0
    s_waitcnt lgkmcnt(0)
    v_mfma_f32_16x16x32_bf16 v[192:195], a[52:55], v[172:175], v[192:195]
    buffer_load_dwordx4 v139, s[48:51], s4 offen lds
    v_mfma_f32_16x16x32_bf16 v[192:195], a[56:59], v[228:231], v[192:195]
    s_waitcnt vmcnt(7)
    ds_read_b64 a[222:223], v121 offset:0
    ds_read_b64 a[234:235], v121 offset:1536
    v_mfma_f32_16x16x32_bf16 v[192:195], a[60:63], v[108:111], v[192:195]
    ds_read_b64 a[246:247], v121 offset:8
    ds_read_b64 v[78:79], v121 offset:1544
    v_mfma_f32_16x16x32_bf16 v[192:195], a[64:67], v[148:151], v[192:195]
    ds_read_b64 v[90:91], v170 offset:0
    ds_read_b64 v[102:103], v170 offset:1536
    v_mfma_f32_16x16x32_bf16 v[192:195], a[68:71], v[116:119], v[192:195]
    v_fmac_f32 v138, v208, v208
    v_fmac_f32 v138, v209, v209
    v_mfma_f32_16x16x32_bf16 v[180:183], v[196:199], a[144:147], 0
    buffer_load_dwordx4 v147, s[48:51], s4 offen offset:1024 lds
    v_mfma_f32_16x16x32_bf16 v[180:183], v[172:175], a[148:151], v[180:183]
    v_fmac_f32 v138, v210, v210
    v_fmac_f32 v138, v211, v211
    v_mfma_f32_16x16x32_bf16 v[180:183], v[228:231], a[152:155], v[180:183]
    ds_read_b128 v[128:131], v0 offset:32768
    v_fmac_f32 v138, v192, v192
    v_mfma_f32_16x16x32_bf16 v[180:183], v[108:111], a[156:159], v[180:183]
    ds_read_b128 v[164:167], v1 offset:32768
    v_fmac_f32 v138, v193, v193
    v_mfma_f32_16x16x32_bf16 v[180:183], v[148:151], a[160:163], v[180:183]
    s_waitcnt lgkmcnt(6)
    ds_read_b128 v[200:203], v0 offset:32896
    v_fmac_f32 v138, v194, v194
    v_mfma_f32_16x16x32_bf16 v[180:183], v[116:119], a[164:167], v[180:183]
    s_waitcnt lgkmcnt(5)
    buffer_load_dwordx4 v132, s[48:51], s4 offen offset:2048 lds
    v_mfma_f32_16x16x32_bf16 v[212:215], v[196:199], a[168:171], 0
    s_add_u32 m0, s28, 65536
    ds_read_b128 v[188:191], v1 offset:32896
    ds_read_b128 v[132:135], v0 offset:33024
    v_mfma_f32_16x16x32_bf16 v[212:215], v[172:175], a[172:175], v[212:215]
    s_waitcnt lgkmcnt(5)
    ds_read_b128 v[220:223], v1 offset:33024
    v_cvt_pk_bf16_f32 v114, v180, v181
    v_mfma_f32_16x16x32_bf16 v[212:215], v[228:231], a[176:179], v[212:215]
    v_cvt_pk_bf16_f32 v115, v182, v183
    v_fmac_f32 v138, v195, v195
    v_mfma_f32_16x16x32_bf16 v[212:215], v[108:111], a[180:183], v[212:215]
    v_cvt_pk_bf16_f32 v36, v138, v146
    s_waitcnt vmcnt(6)
    v_mfma_f32_16x16x32_bf16 v[212:215], v[148:151], a[184:187], v[212:215]
    s_waitcnt lgkmcnt(5)
    buffer_load_dwordx4 v10, s[8:11], s24 offen nt lds
    v_mfma_f32_16x16x32_bf16 v[180:183], v[32:35], v[36:39], 0
    s_add_u32 m0, s28, 69632
    ds_read_b64 a[224:225], v121 offset:3072
    ds_read_b64 a[226:227], v121 offset:4608
    v_mfma_f32_16x16x32_bf16 v[212:215], v[116:119], a[188:191], v[212:215]
    s_waitcnt lgkmcnt(5)
    ds_read_b64 a[248:249], v121 offset:3080
    ds_read_b64 a[250:251], v121 offset:4616
    v_mfma_f32_16x16x32_bf16 v[236:239], v[196:199], a[192:195], 0
    ds_read_b64 v[92:93], v170 offset:3072
    ds_read_b64 v[94:95], v170 offset:4608
    v_mfma_f32_16x16x32_bf16 v[236:239], v[172:175], a[196:199], v[236:239]
    s_waitcnt lgkmcnt(7)
    v_rsq_f32 v181, v181
    v_mfma_f32_16x16x32_bf16 v[236:239], v[228:231], a[200:203], v[236:239]
    s_waitcnt lgkmcnt(6)
    buffer_load_dwordx4 v11, s[8:11], s24 offen nt lds
    v_mfma_f32_16x16x32_bf16 v[236:239], v[108:111], a[204:207], v[236:239]
    s_add_u32 m0, s28, 73728
    v_rsq_f32 v180, v180
    v_mfma_f32_16x16x32_bf16 v[236:239], v[148:151], a[208:211], v[236:239]
    v_mul_f32 v180, s31, v180
    v_cvt_pk_bf16_f32 v138, v212, v213
    v_mfma_f32_16x16x32_bf16 v[236:239], v[116:119], a[212:215], v[236:239]
    v_cvt_pk_bf16_f32 v139, v214, v215
    v_mul_f32 v216, v181, v216
    v_mfma_f32_16x16x32_bf16 v[172:175], a[72:75], v[128:131], 0
    s_waitcnt lgkmcnt(4)
    v_mul_f32 v217, v181, v217
    v_cvt_pk_bf16_f32 v196, v216, v217
    v_mfma_f32_16x16x32_bf16 v[172:175], a[76:79], v[164:167], v[172:175]
    s_waitcnt lgkmcnt(2)
    buffer_load_dwordx4 v12, s[8:11], s24 offen nt lds
    v_mfma_f32_16x16x32_bf16 v[172:175], a[80:83], v[200:203], v[172:175]
    s_add_u32 m0, s28, 77824
    v_cvt_pk_bf16_f32 v146, v236, v237
    v_cvt_pk_bf16_f32 v147, v238, v239
    v_mfma_f32_16x16x32_bf16 v[172:175], a[84:87], v[188:191], v[172:175]
    s_waitcnt lgkmcnt(0)
    v_mul_f32 v218, v181, v218
    v_mul_f32 v219, v181, v219
    v_mfma_f32_16x16x32_bf16 v[172:175], a[88:91], v[132:135], v[172:175]
    s_waitcnt vmcnt(6)
    ds_read_b64 a[236:237], v171 offset:0
    ds_read_b64 a[228:229], v171 offset:1536
    v_mfma_f32_16x16x32_bf16 v[172:175], a[92:95], v[220:223], v[172:175]
    ds_read_b64 v[80:81], v171 offset:8
    ds_read_b64 a[252:253], v171 offset:1544
    v_mfma_f32_16x16x32_bf16 v[228:231], a[96:99], v[128:131], 0
    buffer_load_dwordx4 v13, s[8:11], s24 offen nt lds
    v_mfma_f32_16x16x32_bf16 v[228:231], a[100:103], v[164:167], v[228:231]
    s_add_u32 m0, s72, 0
    ds_read_b64 v[104:105], v122 offset:0
    ds_read_b64 v[96:97], v122 offset:1536
    v_mfma_f32_16x16x32_bf16 v[228:231], a[104:107], v[200:203], v[228:231]
    v_cvt_pk_bf16_f32 v197, v218, v219
    v_mul_f32 v140, v181, v140
    v_mfma_f32_16x16x32_bf16 v[228:231], a[108:111], v[188:191], v[228:231]
    ds_read_b128 v[108:111], v5 offset:0
    ds_read_b128 v[148:151], v5 offset:16
    v_mfma_f32_16x16x32_bf16 v[228:231], a[112:115], v[132:135], v[228:231]
    ds_read_b128 v[216:219], v5 offset:48
    ds_read_b32 v121, v6 offset:192
    v_mfma_f32_16x16x32_bf16 v[228:231], a[116:119], v[220:223], v[228:231]
    buffer_load_dwordx4 v14, s[8:11], s24 offen nt lds
    v_mfma_f32_16x16x32_bf16 v[116:119], a[120:123], v[128:131], 0
    s_add_u32 s8, s40, s23
    v_mul_f32 v141, v181, v141
    v_cvt_pk_bf16_f32 v198, v140, v141
    v_mfma_f32_16x16x32_bf16 v[116:119], a[124:127], v[164:167], v[116:119]
    s_addc_u32 s9, s41, 0
    v_mul_f32 v142, v181, v142
    v_mul_f32 v143, v181, v143
    v_mfma_f32_16x16x32_bf16 v[116:119], a[128:131], v[200:203], v[116:119]
    s_sub_u32 s10, s36, s23
    v_cvt_pk_bf16_f32 v199, v142, v143
    v_mul_f32 v160, v181, v160
    v_mfma_f32_16x16x32_bf16 v[116:119], a[132:135], v[188:191], v[116:119]
    s_cmp_lt_u32 s34, s17
    v_mul_f32 v161, v181, v161
    v_cvt_pk_bf16_f32 v142, v160, v161
    v_mfma_f32_16x16x32_bf16 v[116:119], a[136:139], v[132:135], v[116:119]
    s_cselect_b32 s10, s10, 0
    v_mul_f32 v162, v181, v162
    v_mul_f32 v163, v181, v163
    v_mfma_f32_16x16x32_bf16 v[116:119], a[140:143], v[220:223], v[116:119]
    s_waitcnt lgkmcnt(2)
    v_cvt_pk_bf16_f32 v143, v162, v163
    s_waitcnt vmcnt(5)
    v_mfma_f32_16x16x32_bf16 v[160:163], a[0:3], v[128:131], 0
    s_add_u32 m0, s28, 0
    ds_read_b64 a[230:231], v171 offset:3072
    ds_read_b64 a[238:239], v171 offset:4608
    v_mfma_f32_16x16x32_bf16 v[160:163], a[4:7], v[164:167], v[160:163]
    s_mov_b32 s24, s23
    ds_read_b64 a[254:255], v171 offset:3080
    ds_read_b64 v[82:83], v171 offset:4616
    v_mfma_f32_16x16x32_bf16 v[160:163], a[8:11], v[200:203], v[160:163]
    s_add_u32 s23, s23, s21
    ds_read_b64 v[98:99], v122 offset:3072
    ds_read_b64 v[106:107], v122 offset:4608
    v_mfma_f32_16x16x32_bf16 v[160:163], a[12:15], v[188:191], v[160:163]
    s_cmp_ge_u32 s19, 72
    v_mul_f32 v156, v180, v156
    v_mul_f32 v157, v180, v157
    v_mfma_f32_16x16x32_bf16 v[160:163], a[16:19], v[132:135], v[160:163]
    s_cselect_b32 s34, 72, 0
    v_cvt_pk_bf16_f32 v156, v156, v157
    v_mul_f32 v158, v180, v158
    v_mfma_f32_16x16x32_bf16 v[160:163], a[20:23], v[220:223], v[160:163]
    s_cselect_b32 s35, s22, 0
    v_mul_f32 v159, v180, v159
    v_cvt_pk_bf16_f32 v157, v158, v159
    v_mfma_f32_16x16x32_bf16 v[212:215], a[24:27], v[128:131], 0
    s_sub_u32 s19, s19, s34
    ds_read2_b32 v[170:171], v6 offset0:0 offset1:0
    ds_read2_b32 v[182:183], v6 offset0:16 offset1:16
    v_mfma_f32_16x16x32_bf16 v[236:239], v[108:111], v[124:127], v[22:25]
    s_add_u32 s23, s23, s35
    ds_read2_b32 v[234:235], v6 offset0:32 offset1:32
    v_mul_f32 v208, v180, v208
    v_mfma_f32_16x16x32_bf16 v[236:239], v[148:151], v[184:187], v[236:239]
    s_waitcnt lgkmcnt(7)
    v_mul_f32 v209, v180, v209
    v_cvt_pk_bf16_f32 v158, v208, v209
    v_mfma_f32_16x16x32_bf16 v[236:239], v[216:219], v[176:179], v[236:239]
    s_waitcnt lgkmcnt(5)
    v_mul_f32 v210, v180, v210
    v_mul_f32 v211, v180, v211
    v_mfma_f32_16x16x32_bf16 v[212:215], a[28:31], v[164:167], v[212:215]
    s_waitcnt lgkmcnt(3)
    v_cvt_pk_bf16_f32 v159, v210, v211
    v_mul_f32 v192, v180, v192
    v_mfma_f32_16x16x32_bf16 v[212:215], a[32:35], v[200:203], v[212:215]
    v_mul_f32 v193, v180, v193
    v_cvt_pk_bf16_f32 v140, v192, v193
    v_mfma_f32_16x16x32_bf16 v[212:215], a[36:39], v[188:191], v[212:215]
    v_mul_f32 v194, v180, v194
    v_mul_f32 v195, v180, v195
    v_mfma_f32_16x16x32_bf16 v[212:215], a[40:43], v[132:135], v[212:215]
    v_cvt_pk_bf16_f32 v141, v194, v195
    v_fma_f32 v122, v160, v160, s32
    v_mfma_f32_16x16x32_bf16 v[212:215], a[44:47], v[220:223], v[212:215]
    s_waitcnt lgkmcnt(1)
    v_fmac_f32 v122, v161, v161
    v_fmac_f32 v122, v162, v162
    v_mfma_f32_16x16x32_bf16 v[208:211], a[48:51], v[128:131], 0
    s_waitcnt lgkmcnt(0)
    v_fmac_f32 v122, v163, v163
    v_fma_f32 v168, v172, v172, s32
    v_mfma_f32_16x16x32_bf16 v[208:211], a[52:55], v[164:167], v[208:211]
    v_fmac_f32 v122, v212, v212
    v_fmac_f32 v122, v213, v213
    v_mfma_f32_16x16x32_bf16 v[208:211], a[56:59], v[200:203], v[208:211]
    v_fmac_f32 v122, v214, v214
    v_fmac_f32 v122, v215, v215
    v_mfma_f32_16x16x32_bf16 v[208:211], a[60:63], v[188:191], v[208:211]
    v_fmac_f32 v168, v173, v173
    v_fmac_f32 v168, v174, v174
    v_mfma_f32_16x16x32_bf16 v[208:211], a[64:67], v[132:135], v[208:211]
    v_fmac_f32 v168, v175, v175
    v_fmac_f32 v168, v228, v228
    v_mfma_f32_16x16x32_bf16 v[208:211], a[68:71], v[220:223], v[208:211]
    v_fmac_f32 v168, v229, v229
    v_fmac_f32 v168, v230, v230
    v_mfma_f32_16x16x32_bf16 v[192:195], v[128:131], a[144:147], 0
    v_fmac_f32 v168, v231, v231
    v_fmac_f32 v168, v116, v116
    v_mfma_f32_16x16x32_bf16 v[192:195], v[164:167], a[148:151], v[192:195]
    v_fmac_f32 v168, v117, v117
    v_fmac_f32 v168, v118, v118
    v_mfma_f32_16x16x32_bf16 v[192:195], v[200:203], a[152:155], v[192:195]
    v_fmac_f32 v122, v208, v208
    v_fmac_f32 v122, v209, v209
    v_mfma_f32_16x16x32_bf16 v[192:195], v[188:191], a[156:159], v[192:195]
    v_fmac_f32 v122, v210, v210
    v_fmac_f32 v122, v211, v211
    v_mfma_f32_16x16x32_bf16 v[192:195], v[132:135], a[160:163], v[192:195]
    v_fmac_f32 v168, v119, v119
    v_cvt_pk_bf16_f32 v36, v122, v168
    v_mfma_f32_16x16x32_bf16 v[192:195], v[220:223], a[164:167], v[192:195]
    v_mov_b32_dpp v121, v237 quad_perm:[0,1,2,3] row_mask:0x1 bank_mask:0xf
    v_max3_f32 v122, v236, v204, v205
    v_mfma_f32_16x16x32_bf16 v[224:227], v[32:35], v[36:39], 0
    v_max3_f32 v122, v122, v206, v207
    v_add_u32 v5, 336, v5
    v_mfma_f32_16x16x32_bf16 v[244:247], v[128:131], a[168:171], 0
    v_add_u32 v6, 272, v6
    v_xor_b32 v0, 65536, v0
    v_mfma_f32_16x16x32_bf16 v[244:247], v[164:167], a[172:175], v[244:247]
    v_cvt_pk_bf16_f32 v168, v192, v193
    v_cvt_pk_bf16_f32 v169, v194, v195
    v_mfma_f32_16x16x32_bf16 v[244:247], v[200:203], a[176:179], v[244:247]
    v_rsq_f32 v225, v225
    v_mfma_f32_16x16x32_bf16 v[244:247], v[188:191], a[180:183], v[244:247]
    v_rsq_f32 v224, v224
    v_mfma_f32_16x16x32_bf16 v[244:247], v[132:135], a[184:187], v[244:247]
    v_mul_f32 v224, s31, v224
    v_mul_f32 v172, v225, v172
    v_mfma_f32_16x16x32_bf16 v[244:247], v[220:223], a[188:191], v[244:247]
    v_mul_f32 v173, v225, v173
    v_cvt_pk_bf16_f32 v172, v172, v173
    v_mfma_f32_16x16x32_bf16 v[192:195], v[128:131], a[192:195], 0
    v_mul_f32 v174, v225, v174
    v_mul_f32 v175, v225, v175
    v_mfma_f32_16x16x32_bf16 v[192:195], v[164:167], a[196:199], v[192:195]
    v_cvt_pk_bf16_f32 v173, v174, v175
    v_mul_f32 v228, v225, v228
    v_mfma_f32_16x16x32_bf16 v[192:195], v[200:203], a[200:203], v[192:195]
    v_cvt_pk_bf16_f32 v180, v244, v245
    v_cvt_pk_bf16_f32 v181, v246, v247
    v_mfma_f32_16x16x32_bf16 v[192:195], v[188:191], a[204:207], v[192:195]
    v_mul_f32 v229, v225, v229
    v_cvt_pk_bf16_f32 v174, v228, v229
    v_mfma_f32_16x16x32_bf16 v[192:195], v[132:135], a[208:211], v[192:195]
    v_mul_f32 v230, v225, v230
    v_mul_f32 v231, v225, v231
    v_mfma_f32_16x16x32_bf16 v[192:195], v[220:223], a[212:215], v[192:195]
    v_cvt_pk_bf16_f32 v175, v230, v231
    v_mul_f32 v116, v225, v116
    v_mfma_f32_16x16x32_bf16 v[228:231], v[196:199], v[124:127], v[44:47]
    v_mul_f32 v117, v225, v117
    v_cvt_pk_bf16_f32 v134, v116, v117
    v_mfma_f32_16x16x32_bf16 v[164:167], v[172:175], v[124:127], v[48:51]
    v_mul_f32 v118, v225, v118
    v_mul_f32 v119, v225, v119
    v_mfma_f32_16x16x32_bf16 v[124:127], v[108:111], v[156:159], v[24:27]
    v_cvt_pk_bf16_f32 v232, v192, v193
    v_cvt_pk_bf16_f32 v233, v194, v195
    v_cvt_pk_bf16_f32 v135, v118, v119
    v_mfma_f32_16x16x16_bf16 v[228:231], v[142:143], v[176:177], v[228:231]
    v_mul_f32 v160, v224, v160
    v_mul_f32 v161, v224, v161
    v_cvt_pk_bf16_f32 v116, v160, v161
    v_mfma_f32_16x16x16_bf16 v[164:167], v[134:135], v[176:177], v[164:167]
    v_mul_f32 v162, v224, v162
    v_mul_f32 v163, v224, v163
    v_cvt_pk_bf16_f32 v117, v162, v163
    v_mul_f32 v212, v224, v212
    v_mfma_f32_16x16x32_bf16 v[124:127], v[148:151], v[196:199], v[124:127]
    v_mul_f32 v213, v224, v213
    v_cvt_pk_bf16_f32 v118, v212, v213
    v_mfma_f32_16x16x32_bf16 v[124:127], v[216:219], v[140:143], v[124:127]
    v_mul_f32 v214, v224, v214
    v_mul_f32 v215, v224, v215
    v_cvt_pk_bf16_f32 v119, v214, v215
    v_mfma_f32_16x16x16_bf16 v[160:163], v[28:29], a[216:217], 0
    v_mul_f32 v208, v224, v208
    v_mul_f32 v209, v224, v209
    v_cvt_pk_bf16_f32 v132, v208, v209
    v_mul_f32 v210, v224, v210
    v_mfma_f32_16x16x32_bf16 v[192:195], v[108:111], v[116:119], v[26:29]
    v_mul_f32 v211, v224, v211
    v_cvt_pk_bf16_f32 v133, v210, v211
    v_mfma_f32_16x16x32_bf16 v[192:195], v[148:151], v[172:175], v[192:195]
    v_max3_f32 v122, v122, v228, v229
    v_max3_f32 v122, v122, v230, v231
    v_mfma_f32_16x16x32_bf16 v[192:195], v[216:219], v[132:135], v[192:195]
    v_max3_f32 v122, v122, v164, v165
    v_max3_f32 v122, v122, v166, v167
    v_mov_b32 v176, v122
    v_mfma_f32_16x16x16_bf16 v[160:163], v[28:29], a[240:241], v[160:163]
    v_mov_b32_dpp v121, v125 quad_perm:[0,1,2,3] row_mask:0x2 bank_mask:0xf
    v_permlane32_swap_b32 v122, v176
    v_mfma_f32_16x16x16_bf16 v[160:163], v[28:29], v[84:85], v[160:163]
    v_max_f32 v122, v122, v176
    v_mov_b32 v176, v122
    v_mov_b32_dpp v121, v193 quad_perm:[0,1,2,3] row_mask:0x4 bank_mask:0xf
    v_mfma_f32_16x16x16_bf16 v[148:151], v[28:29], a[218:219], 0
    v_permlane16_swap_b32 v122, v176
    v_max_f32 v122, v122, v176
    v_mfma_f32_16x16x16_bf16 v[148:151], v[28:29], a[242:243], v[148:151]
    v_sub_f32 v204, v204, v122
    v_exp_f32 v204, v204
    v_mfma_f32_16x16x16_bf16 v[148:151], v[28:29], v[86:87], v[148:151]
    v_sub_f32 v205, v205, v122
    v_exp_f32 v205, v205
    v_sub_f32 v206, v206, v122
    v_mfma_f32_16x16x32_bf16 v[108:111], v[184:187], v[156:159], v[52:55]
    v_cvt_pk_bf16_f32 v204, v204, v205
    v_sub_f32 v207, v207, v122
    v_mfma_f32_16x16x32_bf16 v[216:219], v[196:199], v[156:159], v[56:59]
    v_exp_f32 v206, v206
    v_mfma_f32_16x16x32_bf16 v[208:211], v[172:175], v[156:159], v[60:63]
    v_mov_b32_dpp v160, v148 quad_perm:[0,1,2,3] row_mask:0x2 bank_mask:0xf
    v_exp_f32 v207, v207
    v_mfma_f32_16x16x16_bf16 v[108:111], v[178:179], v[140:141], v[108:111]
    v_cvt_pk_bf16_f32 v205, v206, v207
    v_sub_f32 v228, v228, v122
    v_sub_f32 v229, v229, v122
    v_mfma_f32_16x16x16_bf16 v[216:219], v[142:143], v[140:141], v[216:219]
    v_exp_f32 v228, v228
    v_sub_f32 v230, v230, v122
    v_mfma_f32_16x16x16_bf16 v[208:211], v[134:135], v[140:141], v[208:211]
    v_exp_f32 v229, v229
    v_sub_f32 v231, v231, v122
    v_mfma_f32_16x16x16_bf16 v[148:151], v[28:29], a[232:233], 0
    v_cvt_pk_bf16_f32 v206, v228, v229
    v_exp_f32 v230, v230
    v_mfma_f32_16x16x16_bf16 v[148:151], v[28:29], v[76:77], v[148:151]
    v_exp_f32 v231, v231
    v_sub_f32 v164, v164, v122
    v_mfma_f32_16x16x16_bf16 v[148:151], v[28:29], v[100:101], v[148:151]
    v_cvt_pk_bf16_f32 v207, v230, v231
    v_exp_f32 v164, v164
    v_mfma_f32_16x16x16_bf16 v[228:231], v[28:29], a[220:221], 0
    v_sub_f32 v165, v165, v122
    v_exp_f32 v165, v165
    v_mfma_f32_16x16x16_bf16 v[228:231], v[28:29], a[244:245], v[228:231]
    v_cvt_pk_bf16_f32 v36, v164, v165
    v_sub_f32 v166, v166, v122
    v_mov_b32_dpp v160, v148 quad_perm:[0,1,2,3] row_mask:0x4 bank_mask:0xf
    v_mfma_f32_16x16x16_bf16 v[228:231], v[28:29], v[88:89], v[228:231]
    v_exp_f32 v166, v166
    v_sub_f32 v167, v167, v122
    v_mfma_f32_16x16x16_bf16 v[148:151], v[28:29], a[222:223], 0
    v_exp_f32 v167, v167
    v_sub_f32 v236, v236, v122
    v_mfma_f32_16x16x16_bf16 v[148:151], v[28:29], a[246:247], v[148:151]
    v_cvt_pk_bf16_f32 v37, v166, v167
    v_exp_f32 v236, v236
    v_mfma_f32_16x16x16_bf16 v[148:151], v[28:29], v[90:91], v[148:151]
    v_mov_b32_dpp v160, v228 quad_perm:[0,1,2,3] row_mask:0x8 bank_mask:0xf
    v_cvt_pk_bf16_f32 v39, v236, 0
    v_mov_b32 v140, v121
    v_mfma_f32_16x16x16_bf16 v[228:231], v[28:29], a[234:235], 0
    v_max3_f32 v122, v124, v108, v109
    v_max_f32_dpp v140, v140, v140 quad_perm:[1,0,3,2] row_mask:0xf bank_mask:0xf
    v_max3_f32 v122, v122, v110, v111
    v_max3_f32 v122, v122, v216, v217
    v_mfma_f32_16x16x32_bf16 v[156:159], v[28:31], v[36:39], 0
    ds_write_b32 v123, v160 offset:0
    v_mfma_f32_16x16x32_bf16 v[156:159], v[28:31], v[204:207], v[156:159]
    v_max_f32_dpp v140, v140, v140 quad_perm:[2,3,0,1] row_mask:0xf bank_mask:0xf
    v_max3_f32 v122, v122, v218, v219
    v_mfma_f32_16x16x32_bf16 v[164:167], v[168:171], v[36:39], 0
    v_max_f32_dpp v140, v140, v140 row_half_mirror row_mask:0xf bank_mask:0xf
    v_max3_f32 v122, v122, v208, v209
    v_mfma_f32_16x16x32_bf16 v[164:167], v[112:115], v[204:207], v[164:167]
    v_max_f32_dpp v140, v140, v140 row_mirror row_mask:0xf bank_mask:0xf
    v_mov_b32 v141, v140
    v_mfma_f32_16x16x32_bf16 v[128:131], v[180:183], v[36:39], 0
    v_max3_f32 v122, v122, v210, v211
    v_mov_b32 v176, v122
    v_mfma_f32_16x16x32_bf16 v[128:131], v[136:139], v[204:207], v[128:131]
    v_permlane32_swap_b32 v140, v141
    v_mfma_f32_16x16x32_bf16 v[200:203], v[232:235], v[36:39], 0
    v_max_f32 v140, v140, v141
    v_mov_b32 v141, v140
    v_mfma_f32_16x16x32_bf16 v[200:203], v[144:147], v[204:207], v[200:203]
    v_permlane32_swap_b32 v122, v176
    v_max_f32 v122, v122, v176
    v_mfma_f32_16x16x16_bf16 v[228:231], v[28:29], v[78:79], v[228:231]
    v_permlane16_swap_b32 v140, v141
    v_max_f32 v140, v140, v141
    v_mfma_f32_16x16x16_bf16 v[228:231], v[28:29], v[102:103], v[228:231]
    v_sub_f32 v121, v121, v140
    v_exp_f32 v121, v121
    v_mfma_f32_16x16x16_bf16 v[204:207], v[28:29], a[224:225], 0
    v_cvt_pk_bf16_f32 v121, v121, v121
    v_mov_b32 v176, v122
    v_xor_b32 v1, 65536, v1
    v_mfma_f32_16x16x16_bf16 v[204:207], v[28:29], a[248:249], v[204:207]
    v_permlane16_swap_b32 v122, v176
    v_mov_b32_dpp v148, v228 quad_perm:[0,1,2,3] row_mask:0x2 bank_mask:0xf
    v_mfma_f32_16x16x16_bf16 v[204:207], v[28:29], v[92:93], v[204:207]
    v_max_f32 v122, v122, v176
    v_sub_f32 v108, v108, v122
    v_sub_f32 v109, v109, v122
    v_mfma_f32_16x16x16_bf16 v[228:231], v[28:29], a[226:227], 0
    v_exp_f32 v108, v108
    v_sub_f32 v110, v110, v122
    v_mfma_f32_16x16x16_bf16 v[228:231], v[28:29], a[250:251], v[228:231]
    v_exp_f32 v109, v109
    v_mov_b32_dpp v148, v204 quad_perm:[0,1,2,3] row_mask:0x4 bank_mask:0xf
    v_mfma_f32_16x16x16_bf16 v[228:231], v[28:29], v[94:95], v[228:231]
    v_cvt_pk_bf16_f32 v108, v108, v109
    v_exp_f32 v110, v110
    v_mfma_f32_16x16x16_bf16 v[204:207], v[28:29], a[236:237], 0
    v_sub_f32 v111, v111, v122
    v_exp_f32 v111, v111
    v_mfma_f32_16x16x16_bf16 v[204:207], v[28:29], v[80:81], v[204:207]
    v_cvt_pk_bf16_f32 v109, v110, v111
    v_sub_f32 v216, v216, v122
    v_mov_b32_dpp v148, v228 quad_perm:[0,1,2,3] row_mask:0x8 bank_mask:0xf
    v_mfma_f32_16x16x16_bf16 v[204:207], v[28:29], v[104:105], v[204:207]
    v_exp_f32 v216, v216
    v_sub_f32 v217, v217, v122
    v_mfma_f32_16x16x16_bf16 v[228:231], v[28:29], a[228:229], 0
    v_exp_f32 v217, v217
    v_sub_f32 v218, v218, v122
    v_mfma_f32_16x16x16_bf16 v[228:231], v[28:29], a[252:253], v[228:231]
    v_cvt_pk_bf16_f32 v110, v216, v217
    v_exp_f32 v218, v218
    v_mfma_f32_16x16x16_bf16 v[228:231], v[28:29], v[96:97], v[228:231]
    v_sub_f32 v219, v219, v122
    v_exp_f32 v219, v219
    v_sub_f32 v208, v208, v122
    v_mfma_f32_16x16x32_bf16 v[160:163], v[184:187], v[116:119], v[64:67]
    ds_write_b16 v8, v121
    v_mfma_f32_16x16x32_bf16 v[184:187], v[196:199], v[116:119], v[68:71]
    v_cvt_pk_bf16_f32 v111, v218, v219
    v_sub_f32 v209, v209, v122
    v_mfma_f32_16x16x32_bf16 v[196:199], v[172:175], v[116:119], v[72:75]
    ds_write_b32 v123, v148 offset:1024
    v_mov_b32_dpp v204, v228 quad_perm:[0,1,2,3] row_mask:0x2 bank_mask:0xf
    v_mfma_f32_16x16x16_bf16 v[160:163], v[178:179], v[132:133], v[160:163]
    v_exp_f32 v208, v208
    v_sub_f32 v210, v210, v122
    v_mfma_f32_16x16x16_bf16 v[184:187], v[142:143], v[132:133], v[184:187]
    v_exp_f32 v209, v209
    v_sub_f32 v211, v211, v122
    v_mfma_f32_16x16x16_bf16 v[196:199], v[134:135], v[132:133], v[196:199]
    v_cvt_pk_bf16_f32 v36, v208, v209
    v_exp_f32 v210, v210
    v_mfma_f32_16x16x16_bf16 v[172:175], v[28:29], a[230:231], 0
    v_exp_f32 v211, v211
    v_sub_f32 v124, v124, v122
    v_mfma_f32_16x16x16_bf16 v[172:175], v[28:29], a[254:255], v[172:175]
    v_cvt_pk_bf16_f32 v37, v210, v211
    v_exp_f32 v124, v124
    v_mfma_f32_16x16x16_bf16 v[172:175], v[28:29], v[98:99], v[172:175]
    v_cvt_pk_bf16_f32 v39, v124, 0
    v_rcp_f32 v156, v156
    v_mfma_f32_16x16x16_bf16 v[124:127], v[28:29], a[238:239], 0
    v_max3_f32 v121, v192, v160, v161
    v_max3_f32 v121, v121, v162, v163
    v_max3_f32 v121, v121, v184, v185
    v_max3_f32 v121, v121, v186, v187
    v_mfma_f32_16x16x32_bf16 v[116:119], v[28:31], v[36:39], 0
    v_mov_b32_dpp v204, v172 quad_perm:[0,1,2,3] row_mask:0x4 bank_mask:0xf
    v_max3_f32 v121, v121, v196, v197
    v_mfma_f32_16x16x32_bf16 v[116:119], v[28:31], v[108:111], v[116:119]
    v_max3_f32 v121, v121, v198, v199
    v_mov_b32 v122, v121
    v_mfma_f32_16x16x32_bf16 v[172:175], v[168:171], v[36:39], 0
    v_mul_f32 v164, v156, v164
    v_mul_f32 v165, v156, v165
    v_mfma_f32_16x16x32_bf16 v[172:175], v[112:115], v[108:111], v[172:175]
    v_permlane32_swap_b32 v121, v122
    v_mfma_f32_16x16x32_bf16 v[176:179], v[180:183], v[36:39], 0
    v_max_f32 v121, v121, v122
    v_mov_b32 v122, v121
    v_mfma_f32_16x16x32_bf16 v[176:179], v[136:139], v[108:111], v[176:179]
    v_rcp_f32 v116, v116
    v_mfma_f32_16x16x32_bf16 v[140:143], v[232:235], v[36:39], 0
    v_permlane16_swap_b32 v121, v122
    v_mfma_f32_16x16x32_bf16 v[140:143], v[144:147], v[108:111], v[140:143]
    v_max_f32 v121, v121, v122
    v_sub_f32 v160, v160, v121
    v_sub_f32 v161, v161, v121
    v_mfma_f32_16x16x16_bf16 v[124:127], v[28:29], v[82:83], v[124:127]
    v_exp_f32 v160, v160
    v_sub_f32 v162, v162, v121
    v_mfma_f32_16x16x16_bf16 v[124:127], v[28:29], v[106:107], v[124:127]
    v_exp_f32 v161, v161
    v_exp_f32 v162, v162
    v_cvt_pk_bf16_f32 v108, v160, v161
    v_sub_f32 v163, v163, v121
    v_exp_f32 v163, v163
    v_sub_f32 v184, v184, v121
    v_cvt_pk_bf16_f32 v109, v162, v163
    v_exp_f32 v184, v184
    v_mov_b32_dpp v204, v124 quad_perm:[0,1,2,3] row_mask:0x8 bank_mask:0xf
    v_sub_f32 v185, v185, v121
    v_exp_f32 v185, v185
    v_sub_f32 v186, v186, v121
    v_cvt_pk_bf16_f32 v110, v184, v185
    v_exp_f32 v186, v186
    v_sub_f32 v187, v187, v121
    v_exp_f32 v187, v187
    v_sub_f32 v196, v196, v121
    v_cvt_pk_bf16_f32 v111, v186, v187
    v_exp_f32 v196, v196
    v_sub_f32 v197, v197, v121
    v_exp_f32 v197, v197
    v_sub_f32 v198, v198, v121
    v_cvt_pk_bf16_f32 v36, v196, v197
    v_exp_f32 v198, v198
    v_sub_f32 v199, v199, v121
    v_exp_f32 v199, v199
    ds_read_b128 v[124:127], v9
    ds_read_b128 v[216:219], v9 offset:64
    ds_write_b32 v123, v204 offset:2048
    v_cvt_pk_bf16_f32 v37, v198, v199
    v_sub_f32 v192, v192, v121
    v_exp_f32 v192, v192
    v_mul_f32 v172, v116, v172
    v_cvt_pk_bf16_f32 v39, v192, 0
    v_mul_f32 v173, v116, v173
    v_cvt_pk_bf16_f32 v204, v172, v173
    v_mfma_f32_16x16x32_bf16 v[132:135], v[28:31], v[36:39], 0
    v_mul_f32 v174, v116, v174
    v_mul_f32 v175, v116, v175
    v_mfma_f32_16x16x32_bf16 v[132:135], v[28:31], v[108:111], v[132:135]
    v_cvt_pk_bf16_f32 v205, v174, v175
    v_mul_f32 v176, v116, v176
    v_mfma_f32_16x16x32_bf16 v[208:211], v[168:171], v[36:39], 0
    v_mul_f32 v177, v116, v177
    v_cvt_pk_bf16_f32 v206, v176, v177
    v_mfma_f32_16x16x32_bf16 v[208:211], v[112:115], v[108:111], v[208:211]
    v_mul_f32 v178, v116, v178
    v_mul_f32 v179, v116, v179
    v_mfma_f32_16x16x32_bf16 v[160:163], v[180:183], v[36:39], 0
    s_waitcnt lgkmcnt(1)
    v_rcp_f32 v132, v132
    v_mfma_f32_16x16x32_bf16 v[192:195], v[124:127], v[28:31], 0
    s_waitcnt lgkmcnt(0)
    v_cvt_pk_bf16_f32 v207, v178, v179
    v_mul_f32 v208, v132, v208
    v_mfma_f32_16x16x32_bf16 v[192:195], v[216:219], v[28:31], v[192:195]
    s_barrier
    s_waitcnt vmcnt(0)
    ds_read_b128 v[176:179], v152 offset:0
    v_mfma_f32_16x16x32_bf16 v[188:191], v[124:127], v[112:115], 0
    s_barrier
    ds_read_b128 v[196:199], v0 offset:20480
    ds_read_b128 v[184:187], v1 offset:20480
    v_mfma_f32_16x16x32_bf16 v[188:191], v[216:219], v[168:171], v[188:191]
    ds_read_b128 v[172:175], v0 offset:20608
    buffer_load_dwordx4 v10, s[8:11], 0 offen nt lds
    v_mfma_f32_16x16x32_bf16 v[168:171], v[124:127], v[136:139], 0
    s_add_u32 m0, s28, 4096
    ds_read_b128 v[148:151], v1 offset:20608
    v_mul_f32 v209, v132, v209
    v_mfma_f32_16x16x32_bf16 v[168:171], v[216:219], v[180:183], v[168:171]
    ds_read_b128 v[112:115], v0 offset:20736
    v_cvt_pk_bf16_f32 v208, v208, v209
    v_mfma_f32_16x16x32_bf16 v[180:183], v[124:127], v[144:147], 0
    ds_read_b128 v[228:231], v1 offset:20736
    v_mul_f32 v210, v132, v210
    v_mfma_f32_16x16x32_bf16 v[180:183], v[216:219], v[232:235], v[180:183]
    ds_read_b128 v[124:127], v152 offset:1024
    v_mul_f32 v211, v132, v211
    v_mfma_f32_16x16x32_bf16 v[160:163], v[136:139], v[108:111], v[160:163]
    buffer_load_dwordx4 v11, s[8:11], 0 offen nt lds
    ds_read_b128 v[136:139], v152 offset:2048
    v_mfma_f32_16x16x32_bf16 v[216:219], v[232:235], v[36:39], 0
    s_waitcnt lgkmcnt(8)
    ds_write_b128 v3, v[204:207] offset:6144
    v_mfma_f32_16x16x32_bf16 v[216:219], v[144:147], v[108:111], v[216:219]
    s_waitcnt lgkmcnt(6)
    v_add_f32 v176, v176, v177
    v_add_f32 v178, v178, v179
    v_mfma_f32_16x16x32_bf16 v[204:207], a[72:75], v[196:199], 0
    s_add_u32 m0, s28, 8192
    v_add_f32 v176, v176, v178
    v_mul_f32 v176, 0xbbaaaaab, v176
    v_mfma_f32_16x16x32_bf16 v[204:207], a[76:79], v[184:187], v[204:207]
    s_waitcnt lgkmcnt(4)
    buffer_load_dwordx4 v12, s[8:11], 0 offen nt lds
    v_cvt_pk_bf16_f32 v209, v210, v211
    v_mfma_f32_16x16x32_bf16 v[204:207], a[80:83], v[172:175], v[204:207]
    s_add_u32 m0, s28, 12288
    ds_write_b32 v120, v176 offset:0
    v_mfma_f32_16x16x32_bf16 v[204:207], a[84:87], v[148:151], v[204:207]
    s_waitcnt lgkmcnt(3)
    v_add_f32 v124, v124, v125
    v_add_f32 v126, v126, v127
    v_mfma_f32_16x16x32_bf16 v[204:207], a[88:91], v[112:115], v[204:207]
    s_waitcnt lgkmcnt(2)
    ds_read_b128 v[144:147], v153 offset:0
    ds_read_b128 v[108:111], v153 offset:64
    v_mfma_f32_16x16x32_bf16 v[204:207], a[92:95], v[228:231], v[204:207]
    s_xor_b32 s28, s28, 65536
    ds_read_b128 v[232:235], v153 offset:128
    v_add_f32 v124, v124, v126
    v_mfma_f32_16x16x32_bf16 v[176:179], a[96:99], v[196:199], 0
    buffer_load_dwordx4 v13, s[8:11], 0 offen nt lds
    v_mul_f32 v124, 0xbbaaaaab, v124
    v_mfma_f32_16x16x32_bf16 v[176:179], a[100:103], v[184:187], v[176:179]
    s_mov_b32 m0, s29
    ds_write_b32 v120, v124 offset:256
    v_mfma_f32_16x16x32_bf16 v[176:179], a[104:107], v[172:175], v[176:179]
    s_xor_b32 s29, s29, s30
    v_add_f32 v136, v136, v137
    v_add_f32 v138, v138, v139
    v_mfma_f32_16x16x32_bf16 v[176:179], a[108:111], v[148:151], v[176:179]
    v_add_f32 v136, v136, v138
    v_mul_f32 v136, 0xbbaaaaab, v136
    v_mfma_f32_16x16x32_bf16 v[176:179], a[112:115], v[112:115], v[176:179]
    ds_write_b32 v120, v136 offset:512
    v_mfma_f32_16x16x32_bf16 v[176:179], a[116:119], v[228:231], v[176:179]
    buffer_load_dwordx4 v14, s[8:11], 0 offen nt lds
    v_mul_f32 v160, v132, v160
    v_mfma_f32_16x16x32_bf16 v[124:127], a[120:123], v[196:199], 0
    s_waitcnt lgkmcnt(3)
    v_rcp_f32 v192, v192
    v_mul_f32 v161, v132, v161
    v_mfma_f32_16x16x16_bf16 v[120:123], a[216:217], v[154:155], v[144:147]
    v_mul_f32 v188, v188, v192
    v_mul_f32_dpp v188, v168, v192 quad_perm:[0,1,2,3] row_mask:0x2 bank_mask:0xf
    v_mul_f32_dpp v188, v180, v192 quad_perm:[0,1,2,3] row_mask:0x4 bank_mask:0xf
    v_mfma_f32_16x16x16_bf16 v[168:171], a[240:241], v[154:155], v[144:147]
    v_cvt_pk_bf16_f32 v188, v188, v188
    v_cvt_pk_bf16_f32 v210, v160, v161
    v_mul_f32 v162, v132, v162
    v_mfma_f32_16x16x16_bf16 v[136:139], v[84:85], v[154:155], v[144:147]
    v_cvt_pk_bf16_f32 v120, v120, v121
    v_accvgpr_write_b32 a216, v120
    v_cvt_pk_bf16_f32 v122, v122, v123
    v_mfma_f32_16x16x16_bf16 v[180:183], a[218:219], v[154:155], v[108:111]
    v_accvgpr_write_b32 a217, v122
    v_cvt_pk_bf16_f32 v168, v168, v169
    v_accvgpr_write_b32 a240, v168
    v_mfma_f32_16x16x16_bf16 v[120:123], a[242:243], v[154:155], v[108:111]
    v_cvt_pk_bf16_f32 v170, v170, v171
    v_accvgpr_write_b32 a241, v170
    v_cvt_pk_bf16_f32 v84, v136, v137
    v_mfma_f32_16x16x16_bf16 v[144:147], v[86:87], v[154:155], v[108:111]
    v_cvt_pk_bf16_f32 v85, v138, v139
    v_cvt_pk_bf16_f32 v180, v180, v181
    v_accvgpr_write_b32 a218, v180
    v_cvt_pk_bf16_f32 v182, v182, v183
    v_mfma_f32_16x16x32_bf16 v[124:127], a[124:127], v[184:187], v[124:127]
    s_waitcnt lgkmcnt(0)
    ds_read_b128 v[136:139], v153 offset:192
    ds_write_b16 v7, v188
    v_mfma_f32_16x16x16_bf16 v[108:111], a[232:233], v[154:155], v[232:235]
    v_accvgpr_write_b32 a219, v182
    v_cvt_pk_bf16_f32 v120, v120, v121
    v_accvgpr_write_b32 a242, v120
    v_mfma_f32_16x16x16_bf16 v[168:171], v[76:77], v[154:155], v[232:235]
    v_cvt_pk_bf16_f32 v122, v122, v123
    v_accvgpr_write_b32 a243, v122
    v_cvt_pk_bf16_f32 v86, v144, v145
    v_mfma_f32_16x16x16_bf16 v[120:123], v[100:101], v[154:155], v[232:235]
    v_cvt_pk_bf16_f32 v87, v146, v147
    v_cvt_pk_bf16_f32 v108, v108, v109
    v_accvgpr_write_b32 a232, v108
    v_cvt_pk_bf16_f32 v110, v110, v111
    v_mfma_f32_16x16x32_bf16 v[124:127], a[128:131], v[172:175], v[124:127]
    ds_read_b128 v[144:147], v153 offset:256
    v_accvgpr_write_b32 a233, v110
    v_mfma_f32_16x16x32_bf16 v[124:127], a[132:135], v[148:151], v[124:127]
    v_cvt_pk_bf16_f32 v76, v168, v169
    v_cvt_pk_bf16_f32 v77, v170, v171
    v_mfma_f32_16x16x32_bf16 v[124:127], a[136:139], v[112:115], v[124:127]
    v_cvt_pk_bf16_f32 v100, v120, v121
    v_cvt_pk_bf16_f32 v101, v122, v123
    v_mfma_f32_16x16x32_bf16 v[124:127], a[140:143], v[228:231], v[124:127]
    s_waitcnt lgkmcnt(1)
    ds_read_b128 v[120:123], v153 offset:320
    v_mul_f32 v163, v132, v163
    v_cvt_pk_bf16_f32 v211, v162, v163
    v_mfma_f32_16x16x16_bf16 v[108:111], a[220:221], v[154:155], v[136:139]
    v_mul_f32 v216, v132, v216
    v_mul_f32 v217, v132, v217
    v_cvt_pk_bf16_f32 v118, v216, v217
    v_mfma_f32_16x16x16_bf16 v[160:163], a[244:245], v[154:155], v[136:139]
    v_mul_f32 v218, v132, v218
    v_mul_f32 v219, v132, v219
    v_cvt_pk_bf16_f32 v119, v218, v219
    v_mfma_f32_16x16x16_bf16 v[168:171], v[88:89], v[154:155], v[136:139]
    v_cvt_pk_bf16_f32 v108, v108, v109
    v_accvgpr_write_b32 a220, v108
    v_cvt_pk_bf16_f32 v110, v110, v111
    v_accvgpr_write_b32 a221, v110
    v_mfma_f32_16x16x32_bf16 v[216:219], a[0:3], v[196:199], 0
    s_waitcnt lgkmcnt(1)
    ds_write_b128 v3, v[208:211] offset:12288
    v_mfma_f32_16x16x16_bf16 v[136:139], a[222:223], v[154:155], v[144:147]
    v_cvt_pk_bf16_f32 v160, v160, v161
    v_accvgpr_write_b32 a244, v160
    v_cvt_pk_bf16_f32 v162, v162, v163
    v_mfma_f32_16x16x16_bf16 v[108:111], a[246:247], v[154:155], v[144:147]
    v_accvgpr_write_b32 a245, v162
    v_cvt_pk_bf16_f32 v88, v168, v169
    v_cvt_pk_bf16_f32 v89, v170, v171
    v_mfma_f32_16x16x16_bf16 v[160:163], v[90:91], v[154:155], v[144:147]
    v_cvt_pk_bf16_f32 v136, v136, v137
    v_accvgpr_write_b32 a222, v136
    v_cvt_pk_bf16_f32 v138, v138, v139
    v_accvgpr_write_b32 a223, v138
    v_mfma_f32_16x16x32_bf16 v[216:219], a[4:7], v[184:187], v[216:219]
    s_waitcnt lgkmcnt(1)
    ds_read_b128 v[136:139], v153 offset:384
    ds_write_b64 v4, v[118:119] offset:16384
    v_mfma_f32_16x16x16_bf16 v[168:171], a[234:235], v[154:155], v[120:123]
    v_cvt_pk_bf16_f32 v108, v108, v109
    v_accvgpr_write_b32 a246, v108
    v_cvt_pk_bf16_f32 v110, v110, v111
    v_mfma_f32_16x16x16_bf16 v[144:147], v[78:79], v[154:155], v[120:123]
    v_accvgpr_write_b32 a247, v110
    v_cvt_pk_bf16_f32 v90, v160, v161
    v_cvt_pk_bf16_f32 v91, v162, v163
    v_mfma_f32_16x16x16_bf16 v[108:111], v[102:103], v[154:155], v[120:123]
    v_cvt_pk_bf16_f32 v168, v168, v169
    v_accvgpr_write_b32 a234, v168
    v_cvt_pk_bf16_f32 v170, v170, v171
    v_accvgpr_write_b32 a235, v170
    v_mfma_f32_16x16x32_bf16 v[216:219], a[8:11], v[172:175], v[216:219]
    ds_read_b128 v[120:123], v153 offset:448
    v_cvt_pk_bf16_f32 v78, v144, v145
    v_mfma_f32_16x16x32_bf16 v[216:219], a[12:15], v[148:151], v[216:219]
    v_cvt_pk_bf16_f32 v79, v146, v147
    v_cvt_pk_bf16_f32 v102, v108, v109
    v_mfma_f32_16x16x32_bf16 v[216:219], a[16:19], v[112:115], v[216:219]
    v_cvt_pk_bf16_f32 v103, v110, v111
    v_mul_f32 v140, v116, v140
    v_mfma_f32_16x16x32_bf16 v[216:219], a[20:23], v[228:231], v[216:219]
    s_waitcnt lgkmcnt(1)
    ds_read_b128 v[144:147], v153 offset:512
    v_mul_f32 v141, v116, v141
    v_cvt_pk_bf16_f32 v158, v140, v141
    v_mfma_f32_16x16x16_bf16 v[160:163], a[224:225], v[154:155], v[136:139]
    v_mul_f32 v142, v116, v142
    v_mul_f32 v143, v116, v143
    v_cvt_pk_bf16_f32 v159, v142, v143
    v_mfma_f32_16x16x16_bf16 v[108:111], a[248:249], v[154:155], v[136:139]
    v_cvt_pk_bf16_f32 v140, v164, v165
    v_mul_f32 v166, v156, v166
    v_mul_f32 v167, v156, v167
    v_mfma_f32_16x16x16_bf16 v[116:119], v[92:93], v[154:155], v[136:139]
    v_cvt_pk_bf16_f32 v160, v160, v161
    v_accvgpr_write_b32 a224, v160
    v_cvt_pk_bf16_f32 v162, v162, v163
    v_accvgpr_write_b32 a225, v162
    v_mfma_f32_16x16x32_bf16 v[160:163], a[24:27], v[196:199], 0
    s_waitcnt lgkmcnt(1)
    ds_write_b64 v4, v[158:159] offset:10240
    v_mfma_f32_16x16x16_bf16 v[136:139], a[226:227], v[154:155], v[120:123]
    v_cvt_pk_bf16_f32 v108, v108, v109
    v_accvgpr_write_b32 a248, v108
    v_cvt_pk_bf16_f32 v110, v110, v111
    v_mfma_f32_16x16x16_bf16 v[168:171], a[250:251], v[154:155], v[120:123]
    v_accvgpr_write_b32 a249, v110
    v_cvt_pk_bf16_f32 v92, v116, v117
    v_cvt_pk_bf16_f32 v93, v118, v119
    v_mfma_f32_16x16x16_bf16 v[108:111], v[94:95], v[154:155], v[120:123]
    v_cvt_pk_bf16_f32 v136, v136, v137
    v_accvgpr_write_b32 a226, v136
    v_cvt_pk_bf16_f32 v138, v138, v139
    v_accvgpr_write_b32 a227, v138
    v_mfma_f32_16x16x32_bf16 v[160:163], a[28:31], v[184:187], v[160:163]
    s_waitcnt lgkmcnt(1)
    ds_read_b128 v[136:139], v153 offset:576
    v_cvt_pk_bf16_f32 v168, v168, v169
    v_accvgpr_write_b32 a250, v168
    v_mfma_f32_16x16x16_bf16 v[120:123], a[236:237], v[154:155], v[144:147]
    v_cvt_pk_bf16_f32 v170, v170, v171
    v_accvgpr_write_b32 a251, v170
    v_cvt_pk_bf16_f32 v94, v108, v109
    v_mfma_f32_16x16x16_bf16 v[116:119], v[80:81], v[154:155], v[144:147]
    v_cvt_pk_bf16_f32 v95, v110, v111
    v_cvt_pk_bf16_f32 v141, v166, v167
    v_mul_f32 v128, v156, v128
    v_mfma_f32_16x16x16_bf16 v[108:111], v[104:105], v[154:155], v[144:147]
    v_cvt_pk_bf16_f32 v120, v120, v121
    v_accvgpr_write_b32 a236, v120
    v_cvt_pk_bf16_f32 v122, v122, v123
    v_accvgpr_write_b32 a237, v122
    v_mfma_f32_16x16x32_bf16 v[160:163], a[32:35], v[172:175], v[160:163]
    ds_read_b128 v[120:123], v153 offset:640
    v_cvt_pk_bf16_f32 v80, v116, v117
    v_mfma_f32_16x16x32_bf16 v[160:163], a[36:39], v[148:151], v[160:163]
    v_cvt_pk_bf16_f32 v81, v118, v119
    v_cvt_pk_bf16_f32 v104, v108, v109
    v_mfma_f32_16x16x32_bf16 v[160:163], a[40:43], v[112:115], v[160:163]
    v_cvt_pk_bf16_f32 v105, v110, v111
    v_mul_f32 v129, v156, v129
    v_mfma_f32_16x16x32_bf16 v[160:163], a[44:47], v[228:231], v[160:163]
    s_waitcnt lgkmcnt(1)
    ds_read_b128 v[144:147], v153 offset:704
    v_cvt_pk_bf16_f32 v142, v128, v129
    v_mul_f32 v130, v156, v130
    v_mfma_f32_16x16x16_bf16 v[108:111], a[228:229], v[154:155], v[136:139]
    v_mul_f32 v131, v156, v131
    v_cvt_pk_bf16_f32 v143, v130, v131
    v_mul_f32 v200, v156, v200
    v_mfma_f32_16x16x16_bf16 v[168:171], a[252:253], v[154:155], v[136:139]
    v_mul_f32 v201, v156, v201
    v_cvt_pk_bf16_f32 v152, v200, v201
    v_mul_f32 v202, v156, v202
    v_mfma_f32_16x16x16_bf16 v[164:167], v[96:97], v[154:155], v[136:139]
    v_cvt_pk_bf16_f32 v108, v108, v109
    v_accvgpr_write_b32 a228, v108
    v_cvt_pk_bf16_f32 v110, v110, v111
    v_accvgpr_write_b32 a229, v110
    v_mfma_f32_16x16x32_bf16 v[116:119], a[48:51], v[196:199], 0
    s_waitcnt lgkmcnt(1)
    ds_write_b128 v3, v[140:143] offset:0
    v_mfma_f32_16x16x16_bf16 v[136:139], a[230:231], v[154:155], v[120:123]
    v_cvt_pk_bf16_f32 v168, v168, v169
    v_accvgpr_write_b32 a252, v168
    v_cvt_pk_bf16_f32 v170, v170, v171
    v_mfma_f32_16x16x16_bf16 v[108:111], a[254:255], v[154:155], v[120:123]
    v_accvgpr_write_b32 a253, v170
    v_cvt_pk_bf16_f32 v96, v164, v165
    v_cvt_pk_bf16_f32 v97, v166, v167
    v_mfma_f32_16x16x16_bf16 v[140:143], v[98:99], v[154:155], v[120:123]
    v_cvt_pk_bf16_f32 v136, v136, v137
    v_accvgpr_write_b32 a230, v136
    v_cvt_pk_bf16_f32 v138, v138, v139
    v_accvgpr_write_b32 a231, v138
    v_mfma_f32_16x16x32_bf16 v[116:119], a[52:55], v[184:187], v[116:119]
    s_waitcnt lgkmcnt(1)
    v_cvt_pk_bf16_f32 v108, v108, v109
    v_accvgpr_write_b32 a254, v108
    v_cvt_pk_bf16_f32 v110, v110, v111
    v_mfma_f32_16x16x16_bf16 v[120:123], a[238:239], v[154:155], v[144:147]
    v_accvgpr_write_b32 a255, v110
    v_cvt_pk_bf16_f32 v98, v140, v141
    v_cvt_pk_bf16_f32 v99, v142, v143
    v_mfma_f32_16x16x16_bf16 v[136:139], v[82:83], v[154:155], v[144:147]
    v_mul_f32 v203, v156, v203
    v_cvt_pk_bf16_f32 v153, v202, v203
    v_add_u32 v7, 16, v7
    v_mfma_f32_16x16x16_bf16 v[108:111], v[106:107], v[154:155], v[144:147]
    v_cvt_pk_bf16_f32 v120, v120, v121
    v_accvgpr_write_b32 a238, v120
    v_cvt_pk_bf16_f32 v122, v122, v123
    v_accvgpr_write_b32 a239, v122
    v_mfma_f32_16x16x32_bf16 v[116:119], a[56:59], v[172:175], v[116:119]
    ds_write_b64 v4, v[152:153] offset:4096
    v_mfma_f32_16x16x32_bf16 v[116:119], a[60:63], v[148:151], v[116:119]
    v_cvt_pk_bf16_f32 v82, v136, v137
    v_cvt_pk_bf16_f32 v83, v138, v139
    v_mfma_f32_16x16x32_bf16 v[116:119], a[64:67], v[112:115], v[116:119]
    v_cvt_pk_bf16_f32 v106, v108, v109
    v_cvt_pk_bf16_f32 v107, v110, v111
    v_mfma_f32_16x16x32_bf16 v[116:119], a[68:71], v[228:231], v[116:119]
    v_fma_f32 v169, v204, v204, s32
    v_fmac_f32 v169, v205, v205
    v_mfma_f32_16x16x32_bf16 v[128:131], v[196:199], a[144:147], 0
    v_fmac_f32 v169, v206, v206
    v_fmac_f32 v169, v207, v207
    v_mfma_f32_16x16x32_bf16 v[128:131], v[184:187], a[148:151], v[128:131]
    v_fmac_f32 v169, v176, v176
    v_fmac_f32 v169, v177, v177
    v_mfma_f32_16x16x32_bf16 v[128:131], v[172:175], a[152:155], v[128:131]
    v_fmac_f32 v169, v178, v178
    v_fmac_f32 v169, v179, v179
    v_mfma_f32_16x16x32_bf16 v[128:131], v[148:151], a[156:159], v[128:131]
    s_waitcnt lgkmcnt(0)
    v_fmac_f32 v169, v124, v124
    v_fmac_f32 v169, v125, v125
    v_mfma_f32_16x16x32_bf16 v[128:131], v[112:115], a[160:163], v[128:131]
    s_barrier
    v_fmac_f32 v169, v126, v126
    v_fmac_f32 v169, v127, v127
    v_mfma_f32_16x16x32_bf16 v[128:131], v[228:231], a[164:167], v[128:131]
    v_fma_f32 v168, v216, v216, s32
    v_fmac_f32 v168, v217, v217
    v_fmac_f32 v168, v218, v218
    v_fmac_f32 v168, v219, v219
    v_xor_b32 v3, 65536, v3
    v_xor_b32 v4, 65536, v4
L_go:
    s_waitcnt lgkmcnt(0)
    s_cmp_eq_u32 s17, 1
    s_cbranch_scc1 L_drain
    s_cmp_gt_u32 s37, 0x42000000
    s_cbranch_scc1 L_safe
    s_cmp_eq_u32 s16, 1
    s_cbranch_scc1 L_loop_fast1
    s_cmp_eq_u32 s16, 2
    s_cbranch_scc1 L_loop_fast2
    s_cmp_eq_u32 s16, 3
    s_cbranch_scc1 L_loop_fast3
    s_branch L_loop_fast0
.p2align 6
L_loop_fast0:
    v_mfma_f32_16x16x32_bf16 v[164:167], v[196:199], a[168:171], 0
    s_add_u32 s12, s42, s27
    ds_read_b128 v[144:147], v2 offset:18432
    ds_read_b128 v[192:195], v2 offset:19456
    v_mfma_f32_16x16x32_bf16 v[164:167], v[184:187], a[172:175], v[164:167]
    s_addc_u32 s13, s43, 0
    v_fmac_f32 v168, v160, v160
    v_fmac_f32 v168, v161, v161
    v_mfma_f32_16x16x32_bf16 v[164:167], v[172:175], a[176:179], v[164:167]
    s_sub_u32 s14, s36, s27
    v_fmac_f32 v168, v162, v162
    v_fmac_f32 v168, v163, v163
    v_mfma_f32_16x16x32_bf16 v[164:167], v[148:151], a[180:183], v[164:167]
    s_cmp_ge_u32 s18, 2
    ds_read_b128 v[120:123], v0 offset:26624
    v_fmac_f32 v168, v116, v116
    v_mfma_f32_16x16x32_bf16 v[164:167], v[112:115], a[184:187], v[164:167]
    s_cselect_b32 s14, s14, 0
    ds_read_b128 v[188:191], v1 offset:26624
    v_fmac_f32 v168, v117, v117
    v_mfma_f32_16x16x32_bf16 v[164:167], v[228:231], a[188:191], v[164:167]
    s_add_u32 s34, s18, 2
    ds_read_b128 v[248:251], v0 offset:26752
    v_fmac_f32 v168, v118, v118
    v_mfma_f32_16x16x32_bf16 v[140:143], v[196:199], a[192:195], 0
    s_add_u32 s8, s40, s23
    ds_read_b128 v[224:227], v1 offset:26752
    v_fmac_f32 v168, v119, v119
    v_mfma_f32_16x16x32_bf16 v[140:143], v[184:187], a[196:199], v[140:143]
    s_addc_u32 s9, s41, 0
    ds_read_b128 v[184:187], v0 offset:26880
    v_cvt_pk_bf16_f32 v36, v168, v169
    v_mfma_f32_16x16x32_bf16 v[140:143], v[172:175], a[200:203], v[140:143]
    s_waitcnt lgkmcnt(5)
    ds_read_b128 v[172:175], v1 offset:26880
    v_cvt_pk_bf16_f32 v128, v128, v129
    v_mfma_f32_16x16x32_bf16 v[168:171], v[32:35], v[36:39], 0
    s_sub_u32 s10, s36, s23
    v_cvt_pk_bf16_f32 v129, v130, v131
    v_cvt_pk_bf16_f32 v164, v164, v165
    v_mfma_f32_16x16x32_bf16 v[240:243], v[32:35], v[144:147], 0
    s_cmp_lt_u32 s34, s17
    v_cvt_pk_bf16_f32 v165, v166, v167
    s_cselect_b32 s10, s10, 0
    v_mfma_f32_16x16x32_bf16 v[240:243], v[32:35], v[192:195], v[240:243]
    s_waitcnt lgkmcnt(5)
    v_rsq_f32 v169, v169
    v_mfma_f32_16x16x32_bf16 v[140:143], v[148:151], a[204:207], v[140:143]
    s_add_u32 m0, s28, 0
    v_rsq_f32 v168, v168
    v_mfma_f32_16x16x32_bf16 v[140:143], v[112:115], a[208:211], v[140:143]
    s_mov_b32 s27, s26
    v_mul_f32 v168, s31, v168
    v_mul_f32 v204, v169, v204
    v_mfma_f32_16x16x32_bf16 v[140:143], v[228:231], a[212:215], v[140:143]
    s_mov_b32 s26, s25
    v_mul_f32 v205, v169, v205
    v_cvt_pk_bf16_f32 v204, v204, v205
    v_mfma_f32_16x16x32_bf16 v[112:115], a[72:75], v[120:123], 0
    s_waitcnt lgkmcnt(1)
    v_mul_f32 v206, v169, v206
    v_mul_f32 v207, v169, v207
    v_mfma_f32_16x16x32_bf16 v[112:115], a[76:79], v[188:191], v[112:115]
    s_mov_b32 s25, s24
    v_cvt_pk_bf16_f32 v144, v140, v141
    v_cvt_pk_bf16_f32 v145, v142, v143
    v_mfma_f32_16x16x32_bf16 v[112:115], a[80:83], v[248:251], v[112:115]
    s_mov_b32 s24, s23
    v_cvt_pk_bf16_f32 v205, v206, v207
    v_mul_f32 v176, v169, v176
    v_mfma_f32_16x16x32_bf16 v[112:115], a[84:87], v[224:227], v[112:115]
    s_waitcnt lgkmcnt(0)
    v_mul_f32 v177, v169, v177
    v_cvt_pk_bf16_f32 v206, v176, v177
    v_mfma_f32_16x16x32_bf16 v[112:115], a[88:91], v[184:187], v[112:115]
    v_mul_f32 v178, v169, v178
    v_mul_f32 v179, v169, v179
    v_mfma_f32_16x16x32_bf16 v[112:115], a[92:95], v[172:175], v[112:115]
    v_cvt_pk_bf16_f32 v207, v178, v179
    v_mul_f32 v124, v169, v124
    v_mfma_f32_16x16x32_bf16 v[148:151], a[96:99], v[120:123], 0
    v_mul_f32 v125, v169, v125
    v_cvt_pk_bf16_f32 v194, v124, v125
    v_mfma_f32_16x16x32_bf16 v[148:151], a[100:103], v[188:191], v[148:151]
    v_mul_f32 v126, v169, v126
    v_mul_f32 v127, v169, v127
    v_mfma_f32_16x16x32_bf16 v[148:151], a[104:107], v[248:251], v[148:151]
    v_cvt_pk_bf16_f32 v195, v126, v127
    v_mul_f32 v216, v168, v216
    v_mfma_f32_16x16x32_bf16 v[148:151], a[108:111], v[224:227], v[148:151]
    v_mul_f32 v217, v168, v217
    v_cvt_pk_bf16_f32 v196, v216, v217
    v_mfma_f32_16x16x32_bf16 v[148:151], a[112:115], v[184:187], v[148:151]
    v_mul_f32 v218, v168, v218
    v_mul_f32 v219, v168, v219
    v_mfma_f32_16x16x32_bf16 v[148:151], a[116:119], v[172:175], v[148:151]
    v_cvt_pk_bf16_f32 v197, v218, v219
    v_mul_f32 v160, v168, v160
    v_mfma_f32_16x16x32_bf16 v[228:231], a[120:123], v[120:123], 0
    v_mul_f32 v161, v168, v161
    v_cvt_pk_bf16_f32 v198, v160, v161
    v_mfma_f32_16x16x32_bf16 v[228:231], a[124:127], v[188:191], v[228:231]
    v_mul_f32 v162, v168, v162
    v_mul_f32 v163, v168, v163
    v_mfma_f32_16x16x32_bf16 v[228:231], a[128:131], v[248:251], v[228:231]
    v_cvt_pk_bf16_f32 v199, v162, v163
    v_mul_f32 v116, v168, v116
    v_mfma_f32_16x16x32_bf16 v[228:231], a[132:135], v[224:227], v[228:231]
    v_mul_f32 v117, v168, v117
    v_cvt_pk_bf16_f32 v192, v116, v117
    v_mfma_f32_16x16x32_bf16 v[228:231], a[136:139], v[184:187], v[228:231]
    v_mul_f32 v118, v168, v118
    v_mul_f32 v119, v168, v119
    v_mfma_f32_16x16x32_bf16 v[228:231], a[140:143], v[172:175], v[228:231]
    v_cvt_pk_bf16_f32 v193, v118, v119
    v_fma_f32 v130, v112, v112, s32
    v_mfma_f32_16x16x32_bf16 v[212:215], a[0:3], v[120:123], 0
    v_fmac_f32 v130, v113, v113
    v_fmac_f32 v130, v114, v114
    v_mfma_f32_16x16x32_bf16 v[212:215], a[4:7], v[188:191], v[212:215]
    v_fmac_f32 v130, v115, v115
    v_fmac_f32 v130, v148, v148
    v_mfma_f32_16x16x32_bf16 v[212:215], a[8:11], v[248:251], v[212:215]
    v_fmac_f32 v130, v149, v149
    v_fmac_f32 v130, v150, v150
    v_mfma_f32_16x16x32_bf16 v[212:215], a[12:15], v[224:227], v[212:215]
    v_fmac_f32 v130, v151, v151
    v_fmac_f32 v130, v228, v228
    v_mfma_f32_16x16x32_bf16 v[212:215], a[16:19], v[184:187], v[212:215]
    v_fmac_f32 v130, v229, v229
    v_fmac_f32 v130, v230, v230
    v_mfma_f32_16x16x32_bf16 v[212:215], a[20:23], v[172:175], v[212:215]
    v_fmac_f32 v130, v231, v231
    v_mul_f32 v142, 0x3baaaaab, v240
    v_mfma_f32_16x16x32_bf16 v[232:235], a[24:27], v[120:123], 0
    v_rsq_f32 v142, v142
    v_mfma_f32_16x16x32_bf16 v[232:235], a[28:31], v[188:191], v[232:235]
    v_mul_f32 v147, 0x3baaaaab, v241
    v_mul_f32 v146, 0x3baaaaab, v242
    v_mfma_f32_16x16x32_bf16 v[232:235], a[32:35], v[248:251], v[232:235]
    v_fma_f32 v131, v212, v212, s32
    v_fmac_f32 v131, v213, v213
    v_mfma_f32_16x16x32_bf16 v[232:235], a[36:39], v[224:227], v[232:235]
    v_fmac_f32 v131, v214, v214
    v_fmac_f32 v131, v215, v215
    v_mfma_f32_16x16x32_bf16 v[232:235], a[40:43], v[184:187], v[232:235]
    v_rsq_f32 v147, v147
    v_mfma_f32_16x16x32_bf16 v[232:235], a[44:47], v[172:175], v[232:235]
    v_mul_f32 v136, v147, v136
    v_mul_f32 v137, v147, v137
    v_mfma_f32_16x16x32_bf16 v[240:243], a[48:51], v[120:123], 0
    v_cvt_pk_bf16_f32 v176, v136, v137
    v_mul_f32 v138, v147, v138
    v_mfma_f32_16x16x32_bf16 v[240:243], a[52:55], v[188:191], v[240:243]
    v_mul_f32 v139, v147, v139
    v_cvt_pk_bf16_f32 v177, v138, v139
    v_mfma_f32_16x16x32_bf16 v[240:243], a[56:59], v[248:251], v[240:243]
    v_fmac_f32 v131, v232, v232
    v_fmac_f32 v131, v233, v233
    v_mfma_f32_16x16x32_bf16 v[240:243], a[60:63], v[224:227], v[240:243]
    v_fmac_f32 v131, v234, v234
    v_fmac_f32 v131, v235, v235
    v_mfma_f32_16x16x32_bf16 v[240:243], a[64:67], v[184:187], v[240:243]
    v_mul_f32 v208, v147, v208
    v_mul_f32 v209, v147, v209
    v_mfma_f32_16x16x32_bf16 v[240:243], a[68:71], v[172:175], v[240:243]
    v_cvt_pk_bf16_f32 v178, v208, v209
    v_mul_f32 v210, v147, v210
    v_mfma_f32_16x16x32_bf16 v[216:219], v[120:123], a[144:147], 0
    v_mul_f32 v211, v147, v211
    v_cvt_pk_bf16_f32 v179, v210, v211
    v_mfma_f32_16x16x32_bf16 v[216:219], v[188:191], a[148:151], v[216:219]
    buffer_store_dwordx4 v[176:179], v16, s[12:15], 0 offen
    v_mul_f32 v156, v147, v156
    v_fmac_f32 v131, v240, v240
    v_fmac_f32 v131, v241, v241
    v_fmac_f32 v131, v242, v242
    v_mfma_f32_16x16x32_bf16 v[216:219], v[248:251], a[152:155], v[216:219]
    v_fmac_f32 v131, v243, v243
    v_cvt_pk_bf16_f32 v36, v131, v130
    v_mfma_f32_16x16x32_bf16 v[216:219], v[224:227], a[156:159], v[216:219]
    v_mul_f32 v157, v147, v157
    v_cvt_pk_bf16_f32 v118, v156, v157
    v_mfma_f32_16x16x32_bf16 v[136:139], v[32:35], v[36:39], 0
    v_mul_f32 v158, v147, v158
    v_mul_f32 v159, v147, v159
    v_mfma_f32_16x16x32_bf16 v[216:219], v[184:187], a[160:163], v[216:219]
    v_cvt_pk_bf16_f32 v119, v158, v159
    v_mul_f32 v180, v142, v180
    v_mfma_f32_16x16x32_bf16 v[216:219], v[172:175], a[164:167], v[216:219]
    v_rsq_f32 v146, v146
    v_mfma_f32_16x16x32_bf16 v[168:171], v[120:123], a[168:171], 0
    v_mul_f32 v200, v146, v200
    v_mul_f32 v201, v146, v201
    v_mfma_f32_16x16x32_bf16 v[168:171], v[188:191], a[172:175], v[168:171]
    v_cvt_pk_bf16_f32 v200, v200, v201
    v_mul_f32 v202, v146, v202
    v_mfma_f32_16x16x32_bf16 v[168:171], v[248:251], a[176:179], v[168:171]
    v_cvt_pk_bf16_f32 v130, v216, v217
    v_cvt_pk_bf16_f32 v131, v218, v219
    v_mfma_f32_16x16x32_bf16 v[168:171], v[224:227], a[180:183], v[168:171]
    ds_read_b128 v[176:179], v0 offset:32768
    v_mul_f32 v203, v146, v203
    v_mfma_f32_16x16x32_bf16 v[168:171], v[184:187], a[184:187], v[168:171]
    ds_read_b128 v[160:163], v1 offset:32768
    v_cvt_pk_bf16_f32 v201, v202, v203
    v_mfma_f32_16x16x32_bf16 v[168:171], v[172:175], a[188:191], v[168:171]
    ds_read_b128 v[208:211], v0 offset:32896
    v_mul_f32 v244, v146, v244
    v_mfma_f32_16x16x32_bf16 v[156:159], v[120:123], a[192:195], 0
    ds_read_b128 v[216:219], v1 offset:32896
    v_mul_f32 v245, v146, v245
    v_mfma_f32_16x16x32_bf16 v[156:159], v[188:191], a[196:199], v[156:159]
    ds_read_b128 v[124:127], v0 offset:33024
    v_cvt_pk_bf16_f32 v202, v244, v245
    v_mfma_f32_16x16x32_bf16 v[156:159], v[248:251], a[200:203], v[156:159]
    ds_read_b128 v[120:123], v1 offset:33024
    v_mul_f32 v246, v146, v246
    v_mfma_f32_16x16x32_bf16 v[156:159], v[224:227], a[204:207], v[156:159]
    v_mul_f32 v247, v146, v247
    v_cvt_pk_bf16_f32 v203, v246, v247
    v_mfma_f32_16x16x32_bf16 v[156:159], v[184:187], a[208:211], v[156:159]
    v_mul_f32 v132, v146, v132
    v_mul_f32 v133, v146, v133
    v_mfma_f32_16x16x32_bf16 v[156:159], v[172:175], a[212:215], v[156:159]
    s_waitcnt lgkmcnt(5)
    buffer_store_dwordx4 v[200:203], v17, s[12:15], 0 offen
    v_cvt_pk_bf16_f32 v116, v132, v133
    v_mul_f32 v134, v146, v134
    v_mul_f32 v135, v146, v135
    v_cvt_pk_bf16_f32 v117, v134, v135
    v_mfma_f32_16x16x32_bf16 v[200:203], a[72:75], v[176:179], 0
    s_waitcnt lgkmcnt(3)
    v_rsq_f32 v137, v137
    v_mfma_f32_16x16x32_bf16 v[200:203], a[76:79], v[160:163], v[200:203]
    s_waitcnt lgkmcnt(2)
    v_rsq_f32 v136, v136
    v_mfma_f32_16x16x32_bf16 v[200:203], a[80:83], v[208:211], v[200:203]
    s_waitcnt lgkmcnt(1)
    v_mul_f32 v136, s31, v136
    v_cvt_pk_bf16_f32 v166, v168, v169
    v_mfma_f32_16x16x32_bf16 v[200:203], a[84:87], v[216:219], v[200:203]
    s_waitcnt lgkmcnt(0)
    v_cvt_pk_bf16_f32 v167, v170, v171
    v_cvt_pk_bf16_f32 v146, v156, v157
    v_mfma_f32_16x16x32_bf16 v[200:203], a[88:91], v[124:127], v[200:203]
    v_cvt_pk_bf16_f32 v147, v158, v159
    v_mul_f32 v112, v137, v112
    v_mfma_f32_16x16x32_bf16 v[200:203], a[92:95], v[120:123], v[200:203]
    v_mul_f32 v113, v137, v113
    v_cvt_pk_bf16_f32 v184, v112, v113
    v_mfma_f32_16x16x32_bf16 v[168:171], a[96:99], v[176:179], 0
    v_mul_f32 v114, v137, v114
    v_mul_f32 v115, v137, v115
    v_mfma_f32_16x16x32_bf16 v[168:171], a[100:103], v[160:163], v[168:171]
    v_cvt_pk_bf16_f32 v185, v114, v115
    v_mul_f32 v148, v137, v148
    v_mfma_f32_16x16x32_bf16 v[168:171], a[104:107], v[208:211], v[168:171]
    v_mul_f32 v149, v137, v149
    v_cvt_pk_bf16_f32 v186, v148, v149
    v_mfma_f32_16x16x32_bf16 v[168:171], a[108:111], v[216:219], v[168:171]
    v_mul_f32 v150, v137, v150
    v_mul_f32 v151, v137, v151
    v_mfma_f32_16x16x32_bf16 v[168:171], a[112:115], v[124:127], v[168:171]
    s_waitcnt vmcnt(2)
    v_cvt_pk_bf16_f32 v187, v150, v151
    v_mul_f32 v228, v137, v228
    v_mfma_f32_16x16x32_bf16 v[168:171], a[116:119], v[120:123], v[168:171]
    s_barrier
    v_mul_f32 v229, v137, v229
    v_cvt_pk_bf16_f32 v174, v228, v229
    v_mfma_f32_16x16x32_bf16 v[112:115], a[120:123], v[176:179], 0
    s_nop 0
    v_mul_f32 v230, v137, v230
    v_mul_f32 v231, v137, v231
    v_mfma_f32_16x16x32_bf16 v[112:115], a[124:127], v[160:163], v[112:115]
    s_nop 0
    v_cvt_pk_bf16_f32 v175, v230, v231
    v_mul_f32 v212, v136, v212
    v_mfma_f32_16x16x32_bf16 v[112:115], a[128:131], v[208:211], v[112:115]
    s_nop 0
    v_mul_f32 v213, v136, v213
    v_cvt_pk_bf16_f32 v132, v212, v213
    v_mfma_f32_16x16x32_bf16 v[112:115], a[132:135], v[216:219], v[112:115]
    v_mul_f32 v214, v136, v214
    v_mul_f32 v215, v136, v215
    v_mfma_f32_16x16x32_bf16 v[112:115], a[136:139], v[124:127], v[112:115]
    buffer_load_dwordx4 v10, s[8:11], 0 offen nt lds
    v_cvt_pk_bf16_f32 v133, v214, v215
    v_mfma_f32_16x16x32_bf16 v[112:115], a[140:143], v[120:123], v[112:115]
    s_add_u32 m0, s28, 4096
    v_mul_f32 v232, v136, v232
    v_mul_f32 v233, v136, v233
    v_mfma_f32_16x16x32_bf16 v[188:191], a[0:3], v[176:179], 0
    v_cvt_pk_bf16_f32 v134, v232, v233
    v_mul_f32 v234, v136, v234
    v_mfma_f32_16x16x32_bf16 v[188:191], a[4:7], v[160:163], v[188:191]
    v_mul_f32 v235, v136, v235
    v_cvt_pk_bf16_f32 v135, v234, v235
    v_mfma_f32_16x16x32_bf16 v[188:191], a[8:11], v[208:211], v[188:191]
    v_mul_f32 v240, v136, v240
    v_mul_f32 v241, v136, v241
    v_mfma_f32_16x16x32_bf16 v[188:191], a[12:15], v[216:219], v[188:191]
    buffer_load_dwordx4 v11, s[8:11], 0 offen nt lds
    v_cvt_pk_bf16_f32 v172, v240, v241
    v_mfma_f32_16x16x32_bf16 v[188:191], a[16:19], v[124:127], v[188:191]
    s_add_u32 m0, s28, 8192
    v_mul_f32 v242, v136, v242
    v_mul_f32 v243, v136, v243
    v_mfma_f32_16x16x32_bf16 v[188:191], a[20:23], v[120:123], v[188:191]
    v_cvt_pk_bf16_f32 v173, v242, v243
    v_fma_f32 v140, v200, v200, s32
    v_mfma_f32_16x16x32_bf16 v[136:139], a[24:27], v[176:179], 0
    v_fmac_f32 v140, v201, v201
    v_fmac_f32 v140, v202, v202
    v_mfma_f32_16x16x32_bf16 v[136:139], a[28:31], v[160:163], v[136:139]
    v_fmac_f32 v140, v203, v203
    v_fmac_f32 v140, v168, v168
    v_mfma_f32_16x16x32_bf16 v[136:139], a[32:35], v[208:211], v[136:139]
    buffer_load_dwordx4 v12, s[8:11], 0 offen nt lds
    v_fma_f32 v141, v188, v188, s32
    v_mfma_f32_16x16x32_bf16 v[136:139], a[36:39], v[216:219], v[136:139]
    s_add_u32 m0, s28, 12288
    v_fmac_f32 v141, v189, v189
    v_fmac_f32 v141, v190, v190
    v_mfma_f32_16x16x32_bf16 v[136:139], a[40:43], v[124:127], v[136:139]
    s_xor_b32 s28, s28, 65536
    v_fmac_f32 v141, v191, v191
    v_fmac_f32 v140, v169, v169
    v_mfma_f32_16x16x32_bf16 v[136:139], a[44:47], v[120:123], v[136:139]
    v_fmac_f32 v140, v170, v170
    v_fmac_f32 v140, v171, v171
    v_mfma_f32_16x16x32_bf16 v[148:151], a[48:51], v[176:179], 0
    v_fmac_f32 v140, v112, v112
    v_fmac_f32 v140, v113, v113
    v_mfma_f32_16x16x32_bf16 v[148:151], a[52:55], v[160:163], v[148:151]
    buffer_load_dwordx4 v13, s[8:11], 0 offen nt lds
    v_fmac_f32 v140, v114, v114
    v_mfma_f32_16x16x32_bf16 v[148:151], a[56:59], v[208:211], v[148:151]
    s_mov_b32 m0, s29
    v_fmac_f32 v141, v136, v136
    v_fmac_f32 v141, v137, v137
    v_mfma_f32_16x16x32_bf16 v[148:151], a[60:63], v[216:219], v[148:151]
    s_xor_b32 s29, s29, s30
    v_fmac_f32 v141, v138, v138
    v_fmac_f32 v141, v139, v139
    v_mfma_f32_16x16x32_bf16 v[148:151], a[64:67], v[124:127], v[148:151]
    s_add_u32 s19, s19, s20
    v_fmac_f32 v140, v115, v115
    v_mul_f32 v181, v142, v181
    v_mfma_f32_16x16x32_bf16 v[148:151], a[68:71], v[120:123], v[148:151]
    s_add_u32 s23, s23, s21
    v_cvt_pk_bf16_f32 v156, v180, v181
    v_mul_f32 v182, v142, v182
    v_mfma_f32_16x16x32_bf16 v[220:223], v[176:179], a[144:147], 0
    s_cmp_ge_u32 s19, 72
    ds_read_b128 v[212:215], v5 offset:0
    ds_read_b128 v[224:227], v5 offset:16
    v_mfma_f32_16x16x32_bf16 v[220:223], v[160:163], a[148:151], v[220:223]
    s_cselect_b32 s34, 72, 0
    ds_read_b128 v[228:231], v5 offset:48
    ds_read_b32 v143, v6 offset:192
    v_mfma_f32_16x16x32_bf16 v[220:223], v[208:211], a[152:155], v[220:223]
    s_cselect_b32 s35, s22, 0
    buffer_store_dwordx2 v[116:117], v20, s[12:15], 0 offen
    v_fmac_f32 v141, v148, v148
    v_fmac_f32 v141, v149, v149
    v_mfma_f32_16x16x32_bf16 v[220:223], v[216:219], a[156:159], v[220:223]
    s_sub_u32 s19, s19, s34
    v_fmac_f32 v141, v150, v150
    v_fmac_f32 v141, v151, v151
    v_mfma_f32_16x16x32_bf16 v[220:223], v[124:127], a[160:163], v[220:223]
    s_add_u32 s23, s23, s35
    v_cvt_pk_bf16_f32 v36, v141, v140
    v_mul_f32 v183, v142, v183
    v_mfma_f32_16x16x32_bf16 v[220:223], v[120:123], a[164:167], v[220:223]
    s_add_u32 s18, s18, 1
    v_cvt_pk_bf16_f32 v157, v182, v183
    v_mul_f32 v108, v142, v108
    v_mfma_f32_16x16x32_bf16 v[180:183], v[32:35], v[36:39], 0
    s_cmp_lt_u32 s18, s17
    v_mul_f32 v109, v142, v109
    v_cvt_pk_bf16_f32 v158, v108, v109
    v_mfma_f32_16x16x32_bf16 v[232:235], v[176:179], a[168:171], 0
    s_waitcnt lgkmcnt(3)
    v_cvt_pk_bf16_f32 v116, v220, v221
    v_cvt_pk_bf16_f32 v117, v222, v223
    v_mfma_f32_16x16x32_bf16 v[220:223], v[212:215], v[196:199], v[22:25]
    s_waitcnt lgkmcnt(1)
    v_rsq_f32 v181, v181
    v_mfma_f32_16x16x32_bf16 v[220:223], v[224:227], v[204:207], v[220:223]
    s_waitcnt lgkmcnt(0)
    v_rsq_f32 v180, v180
    v_mfma_f32_16x16x32_bf16 v[220:223], v[228:231], v[192:195], v[220:223]
    v_mul_f32 v180, s31, v180
    v_mul_f32 v200, v181, v200
    v_mfma_f32_16x16x32_bf16 v[236:239], v[212:215], v[132:135], v[24:27]
    v_mul_f32 v201, v181, v201
    v_cvt_pk_bf16_f32 v200, v200, v201
    v_mfma_f32_16x16x32_bf16 v[236:239], v[224:227], v[184:187], v[236:239]
    v_mul_f32 v202, v181, v202
    v_mul_f32 v203, v181, v203
    v_mfma_f32_16x16x32_bf16 v[236:239], v[228:231], v[172:175], v[236:239]
    v_mov_b32_dpp v143, v221 quad_perm:[0,1,2,3] row_mask:0x1 bank_mask:0xf
    v_cvt_pk_bf16_f32 v201, v202, v203
    v_mfma_f32_16x16x32_bf16 v[232:235], v[160:163], a[172:175], v[232:235]
    v_mul_f32 v168, v181, v168
    v_mul_f32 v169, v181, v169
    v_mfma_f32_16x16x32_bf16 v[232:235], v[208:211], a[176:179], v[232:235]
    v_cvt_pk_bf16_f32 v202, v168, v169
    v_mul_f32 v170, v181, v170
    v_mfma_f32_16x16x32_bf16 v[232:235], v[216:219], a[180:183], v[232:235]
    v_mul_f32 v171, v181, v171
    v_cvt_pk_bf16_f32 v203, v170, v171
    v_mfma_f32_16x16x32_bf16 v[240:243], v[204:207], v[196:199], v[40:43]
    v_mul_f32 v112, v181, v112
    v_mul_f32 v113, v181, v113
    v_mfma_f32_16x16x32_bf16 v[248:251], v[184:187], v[196:199], v[44:47]
    v_cvt_pk_bf16_f32 v246, v112, v113
    v_mul_f32 v114, v181, v114
    v_mfma_f32_16x16x32_bf16 v[168:171], v[200:203], v[196:199], v[48:51]
    buffer_store_dwordx2 v[118:119], v19, s[12:15], 0 offen
    v_mul_f32 v115, v181, v115
    v_cvt_pk_bf16_f32 v247, v114, v115
    v_mfma_f32_16x16x16_bf16 v[240:243], v[194:195], v[192:193], v[240:243]
    v_mul_f32 v188, v180, v188
    v_mul_f32 v189, v180, v189
    v_cvt_pk_bf16_f32 v196, v188, v189
    v_mfma_f32_16x16x16_bf16 v[248:251], v[174:175], v[192:193], v[248:251]
    v_mul_f32 v190, v180, v190
    v_mul_f32 v191, v180, v191
    v_cvt_pk_bf16_f32 v197, v190, v191
    v_mfma_f32_16x16x16_bf16 v[168:171], v[246:247], v[192:193], v[168:171]
    v_mul_f32 v136, v180, v136
    v_mul_f32 v137, v180, v137
    v_cvt_pk_bf16_f32 v198, v136, v137
    v_mul_f32 v138, v180, v138
    v_mfma_f32_16x16x32_bf16 v[232:235], v[124:127], a[184:187], v[232:235]
    v_mul_f32 v139, v180, v139
    v_cvt_pk_bf16_f32 v199, v138, v139
    v_mfma_f32_16x16x32_bf16 v[232:235], v[120:123], a[188:191], v[232:235]
    v_mul_f32 v148, v180, v148
    v_mul_f32 v149, v180, v149
    v_mfma_f32_16x16x32_bf16 v[112:115], v[176:179], a[192:195], 0
    ds_read_b128 v[176:179], v2 offset:0
    v_cvt_pk_bf16_f32 v244, v148, v149
    v_mfma_f32_16x16x32_bf16 v[112:115], v[160:163], a[196:199], v[112:115]
    ds_read_b128 v[160:163], v2 offset:1024
    v_mul_f32 v150, v180, v150
    v_mfma_f32_16x16x32_bf16 v[112:115], v[208:211], a[200:203], v[112:115]
    ds_read_b128 v[136:139], v2 offset:2048
    v_cvt_pk_bf16_f32 v188, v232, v233
    v_mfma_f32_16x16x32_bf16 v[112:115], v[216:219], a[204:207], v[112:115]
    ds_read_b128 v[208:211], v2 offset:3072
    v_cvt_pk_bf16_f32 v189, v234, v235
    v_mfma_f32_16x16x32_bf16 v[112:115], v[124:127], a[208:211], v[112:115]
    ds_read_b128 v[124:127], v2 offset:4096
    ds_read2_b32 v[118:119], v6 offset0:0 offset1:0
    v_mfma_f32_16x16x32_bf16 v[112:115], v[120:123], a[212:215], v[112:115]
    ds_read_b128 v[120:123], v2 offset:5120
    ds_read2_b32 v[190:191], v6 offset0:16 offset1:16
    v_mfma_f32_16x16x32_bf16 v[232:235], v[212:215], v[196:199], v[26:29]
    v_mul_f32 v151, v180, v151
    v_cvt_pk_bf16_f32 v245, v150, v151
    v_mfma_f32_16x16x32_bf16 v[232:235], v[224:227], v[200:203], v[232:235]
    ds_read2_b32 v[218:219], v6 offset0:32 offset1:32
    v_mov_b32_dpp v143, v237 quad_perm:[0,1,2,3] row_mask:0x2 bank_mask:0xf
    v_mfma_f32_16x16x32_bf16 v[232:235], v[228:231], v[244:247], v[232:235]
    s_waitcnt lgkmcnt(8)
    v_cvt_pk_bf16_f32 v216, v112, v113
    v_cvt_pk_bf16_f32 v217, v114, v115
    v_mfma_f32_16x16x32_bf16 v[180:183], a[216:219], v[176:179], 0
    s_waitcnt lgkmcnt(7)
    v_mul_f32 v110, v142, v110
    v_mul_f32 v111, v142, v111
    v_mfma_f32_16x16x32_bf16 v[180:183], a[220:223], v[160:163], v[180:183]
    s_waitcnt lgkmcnt(6)
    v_cvt_pk_bf16_f32 v159, v110, v111
    v_mul_f32 v152, v142, v152
    v_mfma_f32_16x16x32_bf16 v[180:183], a[224:227], v[136:139], v[180:183]
    s_waitcnt lgkmcnt(5)
    buffer_store_dwordx4 v[156:159], v15, s[12:15], 0 offen
    v_mul_f32 v153, v142, v153
    v_cvt_pk_bf16_f32 v192, v152, v153
    v_mul_f32 v154, v142, v154
    v_mul_f32 v155, v142, v155
    v_mfma_f32_16x16x32_bf16 v[180:183], a[228:231], v[208:211], v[180:183]
    s_waitcnt lgkmcnt(1)
    v_cvt_pk_bf16_f32 v193, v154, v155
    v_mov_b32_dpp v143, v233 quad_perm:[0,1,2,3] row_mask:0x4 bank_mask:0xf
    v_mfma_f32_16x16x32_bf16 v[180:183], a[232:235], v[124:127], v[180:183]
    v_exp_f32 v232, v232
    v_mfma_f32_16x16x32_bf16 v[180:183], a[236:239], v[120:123], v[180:183]
    s_waitcnt lgkmcnt(0)
    v_exp_f32 v143, v143
    v_mfma_f32_16x16x32_bf16 v[108:111], a[240:243], v[176:179], 0
    v_cvt_pk_bf16_f32 v143, v143, v143
    v_add_u32 v5, 336, v5
    v_mfma_f32_16x16x32_bf16 v[108:111], a[244:247], v[160:163], v[108:111]
    ds_write_b16 v8, v143
    v_mfma_f32_16x16x32_bf16 v[108:111], a[248:251], v[136:139], v[108:111]
    v_exp_f32 v236, v236
    v_mfma_f32_16x16x32_bf16 v[108:111], a[252:255], v[208:211], v[108:111]
    ds_read_b128 v[140:143], v2 offset:6144
    ds_read_b128 v[224:227], v2 offset:7168
    v_mfma_f32_16x16x32_bf16 v[108:111], v[76:79], v[124:127], v[108:111]
    ds_read_b128 v[112:115], v2 offset:8192
    v_fma_f32 v221, v180, v180, s33
    v_mfma_f32_16x16x32_bf16 v[108:111], v[80:83], v[120:123], v[108:111]
    ds_read_b128 v[148:151], v2 offset:9216
    v_fmac_f32 v221, v181, v181
    v_mfma_f32_16x16x32_bf16 v[152:155], v[84:87], v[176:179], 0
    ds_read_b128 v[176:179], v2 offset:10240
    v_fmac_f32 v221, v182, v182
    v_mfma_f32_16x16x32_bf16 v[152:155], v[88:91], v[160:163], v[152:155]
    ds_read_b128 v[160:163], v2 offset:11264
    v_fmac_f32 v221, v183, v183
    v_mfma_f32_16x16x32_bf16 v[152:155], v[92:95], v[136:139], v[152:155]
    v_exp_f32 v240, v240
    v_mfma_f32_16x16x32_bf16 v[152:155], v[96:99], v[208:211], v[152:155]
    v_exp_f32 v241, v241
    v_mfma_f32_16x16x32_bf16 v[152:155], v[100:103], v[124:127], v[152:155]
    ds_read_b128 v[124:127], v9
    ds_read_b128 v[208:211], v9 offset:64
    v_mfma_f32_16x16x32_bf16 v[152:155], v[104:107], v[120:123], v[152:155]
    s_waitcnt lgkmcnt(6)
    v_cvt_pk_bf16_f32 v120, v240, v241
    v_fmac_f32 v221, v108, v108
    v_mfma_f32_16x16x32_bf16 v[136:139], a[216:219], v[140:143], 0
    s_waitcnt lgkmcnt(5)
    v_exp_f32 v242, v242
    v_mfma_f32_16x16x32_bf16 v[136:139], a[220:223], v[224:227], v[136:139]
    s_waitcnt lgkmcnt(4)
    buffer_store_dwordx2 v[192:193], v18, s[12:15], 0 offen
    v_exp_f32 v243, v243
    v_mfma_f32_16x16x32_bf16 v[136:139], a[224:227], v[112:115], v[136:139]
    s_waitcnt lgkmcnt(2)
    v_cvt_pk_bf16_f32 v121, v242, v243
    v_fmac_f32 v221, v109, v109
    v_mfma_f32_16x16x32_bf16 v[136:139], a[228:231], v[148:151], v[136:139]
    v_exp_f32 v248, v248
    v_mfma_f32_16x16x32_bf16 v[136:139], a[232:235], v[176:179], v[136:139]
    v_exp_f32 v249, v249
    v_mfma_f32_16x16x32_bf16 v[136:139], a[236:239], v[160:163], v[136:139]
    s_waitcnt lgkmcnt(1)
    v_cvt_pk_bf16_f32 v122, v248, v249
    v_fmac_f32 v221, v110, v110
    v_mfma_f32_16x16x32_bf16 v[240:243], v[124:127], v[28:31], 0
    s_waitcnt lgkmcnt(0)
    v_exp_f32 v250, v250
    v_mfma_f32_16x16x32_bf16 v[240:243], v[208:211], v[28:31], v[240:243]
    v_exp_f32 v251, v251
    v_mfma_f32_16x16x32_bf16 v[228:231], v[124:127], v[128:131], 0
    v_fma_f32 v192, v136, v136, s33
    v_fmac_f32 v192, v137, v137
    v_mfma_f32_16x16x32_bf16 v[228:231], v[208:211], v[116:119], v[228:231]
    v_fmac_f32 v192, v138, v138
    v_fmac_f32 v192, v139, v139
    v_mfma_f32_16x16x32_bf16 v[212:215], v[124:127], v[164:167], 0
    v_rcp_f32 v240, v240
    v_mfma_f32_16x16x32_bf16 v[212:215], v[208:211], v[188:191], v[212:215]
    v_cvt_pk_bf16_f32 v123, v250, v251
    v_fmac_f32 v221, v111, v111
    v_mfma_f32_16x16x32_bf16 v[248:251], v[124:127], v[144:147], 0
    v_mul_f32 v228, v228, v240
    v_fmac_f32 v221, v152, v152
    v_mfma_f32_16x16x32_bf16 v[248:251], v[208:211], v[216:219], v[248:251]
    v_exp_f32 v168, v168
    v_mfma_f32_16x16x32_bf16 v[208:211], a[240:243], v[140:143], 0
    v_mul_f32_dpp v228, v212, v240 quad_perm:[0,1,2,3] row_mask:0x2 bank_mask:0xf
    v_fmac_f32 v221, v153, v153
    v_mfma_f32_16x16x32_bf16 v[208:211], a[244:247], v[224:227], v[208:211]
    v_exp_f32 v169, v169
    v_mfma_f32_16x16x32_bf16 v[208:211], a[248:251], v[112:115], v[208:211]
    ds_read_b128 v[124:127], v2 offset:12288
    v_mul_f32_dpp v228, v248, v240 quad_perm:[0,1,2,3] row_mask:0x4 bank_mask:0xf
    v_mfma_f32_16x16x32_bf16 v[208:211], a[252:255], v[148:151], v[208:211]
    ds_read_b128 v[240:243], v2 offset:13312
    v_cvt_pk_bf16_f32 v228, v228, v228
    v_mfma_f32_16x16x32_bf16 v[208:211], v[76:79], v[176:179], v[208:211]
    ds_read_b128 v[212:215], v2 offset:14336
    buffer_load_dwordx4 v14, s[8:11], 0 offen nt lds
    v_mfma_f32_16x16x32_bf16 v[208:211], v[80:83], v[160:163], v[208:211]
    ds_read_b128 v[248:251], v2 offset:15360
    v_cvt_pk_bf16_f32 v36, v168, v169
    v_mfma_f32_16x16x32_bf16 v[156:159], v[84:87], v[140:143], 0
    ds_read_b128 v[140:143], v2 offset:16384
    v_fmac_f32 v221, v154, v154
    v_mfma_f32_16x16x32_bf16 v[156:159], v[88:91], v[224:227], v[156:159]
    ds_read_b128 v[224:227], v2 offset:17408
    v_fmac_f32 v221, v155, v155
    v_mfma_f32_16x16x32_bf16 v[156:159], v[92:95], v[112:115], v[156:159]
    ds_write_b16 v7, v228
    v_mfma_f32_16x16x32_bf16 v[156:159], v[96:99], v[148:151], v[156:159]
    v_fmac_f32 v192, v208, v208
    v_fmac_f32 v192, v209, v209
    v_mfma_f32_16x16x32_bf16 v[156:159], v[100:103], v[176:179], v[156:159]
    s_waitcnt lgkmcnt(6)
    v_fmac_f32 v192, v210, v210
    v_fmac_f32 v192, v211, v211
    v_mfma_f32_16x16x32_bf16 v[156:159], v[104:107], v[160:163], v[156:159]
    s_waitcnt lgkmcnt(5)
    v_exp_f32 v170, v170
    v_mfma_f32_16x16x32_bf16 v[160:163], v[204:207], v[132:135], v[52:55]
    s_waitcnt lgkmcnt(4)
    v_exp_f32 v171, v171
    v_mfma_f32_16x16x32_bf16 v[176:179], v[184:187], v[132:135], v[56:59]
    s_waitcnt lgkmcnt(3)
    v_cvt_pk_bf16_f32 v37, v170, v171
    v_fmac_f32 v192, v156, v156
    v_mfma_f32_16x16x32_bf16 v[168:171], v[200:203], v[132:135], v[60:63]
    s_waitcnt lgkmcnt(2)
    v_fmac_f32 v192, v157, v157
    v_fmac_f32 v192, v158, v158
    v_fmac_f32 v192, v159, v159
    v_mfma_f32_16x16x16_bf16 v[160:163], v[194:195], v[172:173], v[160:163]
    v_cvt_pk_bf16_f32 v234, v221, v192
    v_exp_f32 v220, v220
    v_mfma_f32_16x16x16_bf16 v[176:179], v[174:175], v[172:173], v[176:179]
    v_cvt_pk_bf16_f32 v39, v220, 0
    v_add_u32 v6, 272, v6
    v_add_u32 v7, 16, v7
    v_mfma_f32_16x16x16_bf16 v[168:171], v[246:247], v[172:173], v[168:171]
    v_xor_b32 v0, 65536, v0
    v_exp_f32 v160, v160
    v_xor_b32 v1, 65536, v1
    v_mfma_f32_16x16x32_bf16 v[132:135], v[28:31], v[36:39], 0
    s_waitcnt lgkmcnt(0)
    v_exp_f32 v161, v161
    v_mfma_f32_16x16x32_bf16 v[132:135], v[28:31], v[120:123], v[132:135]
    v_cvt_pk_bf16_f32 v192, v160, v161
    v_xor_b32 v2, 65536, v2
    v_mfma_f32_16x16x32_bf16 v[112:115], v[116:119], v[36:39], 0
    v_exp_f32 v162, v162
    v_mfma_f32_16x16x32_bf16 v[112:115], v[128:131], v[120:123], v[112:115]
    v_exp_f32 v163, v163
    v_mfma_f32_16x16x32_bf16 v[148:151], v[188:191], v[36:39], 0
    v_exp_f32 v176, v176
    v_mfma_f32_16x16x32_bf16 v[148:151], v[164:167], v[120:123], v[148:151]
    v_rcp_f32 v132, v132
    v_mfma_f32_16x16x32_bf16 v[220:223], v[216:219], v[36:39], 0
    v_cvt_pk_bf16_f32 v193, v162, v163
    v_cvt_pk_bf16_f32 v39, v236, 0
    v_mfma_f32_16x16x32_bf16 v[220:223], v[144:147], v[120:123], v[220:223]
    v_mul_f32 v112, v132, v112
    v_mul_f32 v113, v132, v113
    v_mfma_f32_16x16x32_bf16 v[160:163], v[204:207], v[196:199], v[64:67]
    v_cvt_pk_bf16_f32 v112, v112, v113
    v_mul_f32 v114, v132, v114
    v_mfma_f32_16x16x32_bf16 v[204:207], v[184:187], v[196:199], v[68:71]
    v_mul_f32 v115, v132, v115
    v_cvt_pk_bf16_f32 v113, v114, v115
    v_mfma_f32_16x16x32_bf16 v[120:123], v[200:203], v[196:199], v[72:75]
    v_mul_f32 v148, v132, v148
    v_mul_f32 v149, v132, v149
    v_cvt_pk_bf16_f32 v114, v148, v149
    v_mfma_f32_16x16x16_bf16 v[160:163], v[194:195], v[244:245], v[160:163]
    v_mul_f32 v150, v132, v150
    v_mul_f32 v151, v132, v151
    v_cvt_pk_bf16_f32 v115, v150, v151
    v_mfma_f32_16x16x16_bf16 v[204:207], v[174:175], v[244:245], v[204:207]
    v_mul_f32 v220, v132, v220
    v_mul_f32 v221, v132, v221
    v_cvt_pk_bf16_f32 v194, v220, v221
    v_mfma_f32_16x16x16_bf16 v[120:123], v[246:247], v[244:245], v[120:123]
    v_exp_f32 v160, v160
    v_exp_f32 v161, v161
    v_mfma_f32_16x16x32_bf16 v[200:203], a[216:219], v[124:127], 0
    ds_write_b128 v3, v[112:115] offset:0
    v_mfma_f32_16x16x32_bf16 v[200:203], a[220:223], v[240:243], v[200:203]
    v_cvt_pk_bf16_f32 v160, v160, v161
    v_mul_f32 v222, v132, v222
    v_mfma_f32_16x16x32_bf16 v[200:203], a[224:227], v[212:215], v[200:203]
    v_exp_f32 v162, v162
    v_mfma_f32_16x16x32_bf16 v[200:203], a[228:231], v[248:251], v[200:203]
    ds_read_b128 v[196:199], v0 offset:20480
    ds_read_b128 v[184:187], v1 offset:20480
    v_mfma_f32_16x16x32_bf16 v[200:203], a[232:235], v[140:143], v[200:203]
    ds_read_b128 v[172:175], v0 offset:20608
    ds_read_b128 v[148:151], v1 offset:20608
    v_mfma_f32_16x16x32_bf16 v[200:203], a[236:239], v[224:227], v[200:203]
    v_exp_f32 v163, v163
    v_mfma_f32_16x16x32_bf16 v[244:247], a[240:243], v[124:127], 0
    ds_read_b128 v[112:115], v0 offset:20736
    ds_read_b128 v[228:231], v1 offset:20736
    v_mfma_f32_16x16x32_bf16 v[244:247], a[244:247], v[240:243], v[244:247]
    v_cvt_pk_bf16_f32 v161, v162, v163
    v_mul_f32 v223, v132, v223
    v_mfma_f32_16x16x32_bf16 v[244:247], a[248:251], v[212:215], v[244:247]
    v_exp_f32 v204, v204
    v_mfma_f32_16x16x32_bf16 v[244:247], a[252:255], v[248:251], v[244:247]
    v_exp_f32 v205, v205
    v_mfma_f32_16x16x32_bf16 v[244:247], v[76:79], v[140:143], v[244:247]
    v_cvt_pk_bf16_f32 v162, v204, v205
    v_cvt_pk_bf16_f32 v195, v222, v223
    v_mfma_f32_16x16x32_bf16 v[244:247], v[80:83], v[224:227], v[244:247]
    s_waitcnt lgkmcnt(4)
    ds_write_b64 v4, v[194:195] offset:4096
    v_mfma_f32_16x16x32_bf16 v[132:135], v[84:87], v[124:127], 0
    s_waitcnt lgkmcnt(3)
    v_exp_f32 v206, v206
    v_mfma_f32_16x16x32_bf16 v[132:135], v[88:91], v[240:243], v[132:135]
    s_waitcnt lgkmcnt(2)
    v_exp_f32 v207, v207
    v_mfma_f32_16x16x32_bf16 v[132:135], v[92:95], v[212:215], v[132:135]
    s_waitcnt lgkmcnt(1)
    v_cvt_pk_bf16_f32 v163, v206, v207
    v_fma_f32 v233, v200, v200, s33
    v_mfma_f32_16x16x32_bf16 v[132:135], v[96:99], v[248:251], v[132:135]
    v_exp_f32 v120, v120
    v_mfma_f32_16x16x32_bf16 v[132:135], v[100:103], v[140:143], v[132:135]
    v_exp_f32 v121, v121
    v_mfma_f32_16x16x32_bf16 v[132:135], v[104:107], v[224:227], v[132:135]
    v_exp_f32 v122, v122
    v_mfma_f32_16x16x32_bf16 v[204:207], a[72:75], v[196:199], 0
    v_exp_f32 v123, v123
    v_mfma_f32_16x16x32_bf16 v[204:207], a[76:79], v[184:187], v[204:207]
    v_exp_f32 v177, v177
    v_mfma_f32_16x16x32_bf16 v[204:207], a[80:83], v[172:175], v[204:207]
    v_cvt_pk_bf16_f32 v194, v176, v177
    v_fmac_f32 v233, v201, v201
    v_mfma_f32_16x16x32_bf16 v[204:207], a[84:87], v[148:151], v[204:207]
    v_exp_f32 v178, v178
    v_mfma_f32_16x16x32_bf16 v[204:207], a[88:91], v[112:115], v[204:207]
    v_exp_f32 v179, v179
    v_mfma_f32_16x16x32_bf16 v[204:207], a[92:95], v[228:231], v[204:207]
    v_cvt_pk_bf16_f32 v195, v178, v179
    v_fmac_f32 v233, v202, v202
    v_mfma_f32_16x16x32_bf16 v[176:179], a[96:99], v[196:199], 0
    v_exp_f32 v168, v168
    v_mfma_f32_16x16x32_bf16 v[176:179], a[100:103], v[184:187], v[176:179]
    v_exp_f32 v169, v169
    v_mfma_f32_16x16x32_bf16 v[176:179], a[104:107], v[172:175], v[176:179]
    v_cvt_pk_bf16_f32 v36, v168, v169
    v_fmac_f32 v233, v203, v203
    v_mfma_f32_16x16x32_bf16 v[176:179], a[108:111], v[148:151], v[176:179]
    v_exp_f32 v170, v170
    v_mfma_f32_16x16x32_bf16 v[176:179], a[112:115], v[112:115], v[176:179]
    v_exp_f32 v171, v171
    v_mfma_f32_16x16x32_bf16 v[176:179], a[116:119], v[228:231], v[176:179]
    v_cvt_pk_bf16_f32 v37, v170, v171
    v_fmac_f32 v233, v244, v244
    v_mfma_f32_16x16x32_bf16 v[124:127], a[120:123], v[196:199], 0
    v_fmac_f32 v233, v245, v245
    v_fmac_f32 v233, v246, v246
    v_mfma_f32_16x16x32_bf16 v[168:171], v[28:31], v[36:39], 0
    v_fmac_f32 v233, v247, v247
    v_fmac_f32 v233, v132, v132
    v_mfma_f32_16x16x32_bf16 v[168:171], v[28:31], v[192:195], v[168:171]
    v_fmac_f32 v233, v133, v133
    v_fmac_f32 v233, v134, v134
    v_mfma_f32_16x16x32_bf16 v[140:143], v[116:119], v[36:39], 0
    v_fmac_f32 v233, v135, v135
    v_cvt_pk_bf16_f32 v235, v233, v233
    v_mfma_f32_16x16x32_bf16 v[140:143], v[128:131], v[192:195], v[140:143]
    ds_write_b64 v4, v[234:235] offset:18432
    v_mfma_f32_16x16x32_bf16 v[224:227], v[188:191], v[36:39], 0
    v_rcp_f32 v168, v168
    v_mfma_f32_16x16x32_bf16 v[224:227], v[164:167], v[192:195], v[224:227]
    v_fma_f32 v169, v204, v204, s32
    v_fmac_f32 v169, v205, v205
    v_mfma_f32_16x16x32_bf16 v[248:251], v[216:219], v[36:39], 0
    v_cvt_pk_bf16_f32 v36, v120, v121
    v_cvt_pk_bf16_f32 v37, v122, v123
    v_mfma_f32_16x16x32_bf16 v[248:251], v[144:147], v[192:195], v[248:251]
    v_cvt_pk_bf16_f32 v39, v232, 0
    v_mul_f32 v140, v168, v140
    v_mfma_f32_16x16x32_bf16 v[124:127], a[124:127], v[184:187], v[124:127]
    v_mul_f32 v141, v168, v141
    v_cvt_pk_bf16_f32 v192, v140, v141
    v_mfma_f32_16x16x32_bf16 v[120:123], v[28:31], v[36:39], 0
    v_mul_f32 v142, v168, v142
    v_mul_f32 v143, v168, v143
    v_mfma_f32_16x16x32_bf16 v[120:123], v[28:31], v[160:163], v[120:123]
    v_cvt_pk_bf16_f32 v193, v142, v143
    v_mul_f32 v224, v168, v224
    v_mfma_f32_16x16x32_bf16 v[140:143], v[116:119], v[36:39], 0
    v_mul_f32 v225, v168, v225
    v_cvt_pk_bf16_f32 v194, v224, v225
    v_mfma_f32_16x16x32_bf16 v[140:143], v[128:131], v[160:163], v[140:143]
    v_mul_f32 v226, v168, v226
    v_mul_f32 v227, v168, v227
    v_mfma_f32_16x16x32_bf16 v[128:131], v[188:191], v[36:39], 0
    v_cvt_pk_bf16_f32 v195, v226, v227
    v_mul_f32 v248, v168, v248
    v_mfma_f32_16x16x32_bf16 v[128:131], v[164:167], v[160:163], v[128:131]
    ds_write_b128 v3, v[192:195] offset:6144
    v_mfma_f32_16x16x32_bf16 v[164:167], v[216:219], v[36:39], 0
    v_mul_f32 v249, v168, v249
    v_cvt_pk_bf16_f32 v170, v248, v249
    v_mfma_f32_16x16x32_bf16 v[164:167], v[144:147], v[160:163], v[164:167]
    v_mul_f32 v250, v168, v250
    v_mul_f32 v251, v168, v251
    v_mfma_f32_16x16x32_bf16 v[124:127], a[128:131], v[172:175], v[124:127]
    v_cvt_pk_bf16_f32 v171, v250, v251
    v_fmac_f32 v169, v206, v206
    v_mfma_f32_16x16x32_bf16 v[124:127], a[132:135], v[148:151], v[124:127]
    ds_write_b64 v4, v[170:171] offset:10240
    v_mfma_f32_16x16x32_bf16 v[124:127], a[136:139], v[112:115], v[124:127]
    v_rcp_f32 v120, v120
    v_mfma_f32_16x16x32_bf16 v[124:127], a[140:143], v[228:231], v[124:127]
    v_mul_f32 v140, v120, v140
    v_mul_f32 v141, v120, v141
    v_mfma_f32_16x16x32_bf16 v[216:219], a[0:3], v[196:199], 0
    v_cvt_pk_bf16_f32 v144, v140, v141
    v_mul_f32 v142, v120, v142
    v_mfma_f32_16x16x32_bf16 v[216:219], a[4:7], v[184:187], v[216:219]
    v_mul_f32 v143, v120, v143
    v_cvt_pk_bf16_f32 v145, v142, v143
    v_mfma_f32_16x16x32_bf16 v[216:219], a[8:11], v[172:175], v[216:219]
    v_mul_f32 v128, v120, v128
    v_mul_f32 v129, v120, v129
    v_mfma_f32_16x16x32_bf16 v[216:219], a[12:15], v[148:151], v[216:219]
    v_cvt_pk_bf16_f32 v146, v128, v129
    v_mul_f32 v130, v120, v130
    v_mfma_f32_16x16x32_bf16 v[216:219], a[16:19], v[112:115], v[216:219]
    v_mul_f32 v131, v120, v131
    v_cvt_pk_bf16_f32 v147, v130, v131
    v_mfma_f32_16x16x32_bf16 v[216:219], a[20:23], v[228:231], v[216:219]
    ds_write_b128 v3, v[144:147] offset:12288
    v_mfma_f32_16x16x32_bf16 v[160:163], a[24:27], v[196:199], 0
    v_mul_f32 v164, v120, v164
    v_mul_f32 v165, v120, v165
    v_mfma_f32_16x16x32_bf16 v[160:163], a[28:31], v[184:187], v[160:163]
    v_cvt_pk_bf16_f32 v164, v164, v165
    v_mul_f32 v166, v120, v166
    v_mfma_f32_16x16x32_bf16 v[160:163], a[32:35], v[172:175], v[160:163]
    v_mul_f32 v167, v120, v167
    v_cvt_pk_bf16_f32 v165, v166, v167
    v_mfma_f32_16x16x32_bf16 v[160:163], a[36:39], v[148:151], v[160:163]
    ds_write_b64 v4, v[164:165] offset:16384
    v_mfma_f32_16x16x32_bf16 v[160:163], a[40:43], v[112:115], v[160:163]
    v_fmac_f32 v169, v207, v207
    v_fmac_f32 v169, v176, v176
    v_mfma_f32_16x16x32_bf16 v[160:163], a[44:47], v[228:231], v[160:163]
    v_fmac_f32 v169, v177, v177
    v_fmac_f32 v169, v178, v178
    v_mfma_f32_16x16x32_bf16 v[116:119], a[48:51], v[196:199], 0
    v_fmac_f32 v169, v179, v179
    v_fmac_f32 v169, v124, v124
    v_mfma_f32_16x16x32_bf16 v[116:119], a[52:55], v[184:187], v[116:119]
    v_fmac_f32 v169, v125, v125
    v_fmac_f32 v169, v126, v126
    v_mfma_f32_16x16x32_bf16 v[116:119], a[56:59], v[172:175], v[116:119]
    v_fmac_f32 v169, v127, v127
    v_fma_f32 v168, v216, v216, s32
    v_mfma_f32_16x16x32_bf16 v[116:119], a[60:63], v[148:151], v[116:119]
    v_fmac_f32 v168, v217, v217
    v_fmac_f32 v168, v218, v218
    v_mfma_f32_16x16x32_bf16 v[116:119], a[64:67], v[112:115], v[116:119]
    s_waitcnt lgkmcnt(0)
    v_fmac_f32 v168, v219, v219
    v_xor_b32 v3, 65536, v3
    v_mfma_f32_16x16x32_bf16 v[116:119], a[68:71], v[228:231], v[116:119]
    s_barrier
    v_xor_b32 v4, 65536, v4
    v_mfma_f32_16x16x32_bf16 v[128:131], v[196:199], a[144:147], 0
    s_nop 0
    v_mfma_f32_16x16x32_bf16 v[128:131], v[184:187], a[148:151], v[128:131]
    s_nop 0
    v_mfma_f32_16x16x32_bf16 v[128:131], v[172:175], a[152:155], v[128:131]
    s_nop 0
    v_mfma_f32_16x16x32_bf16 v[128:131], v[148:151], a[156:159], v[128:131]
    v_mfma_f32_16x16x32_bf16 v[128:131], v[112:115], a[160:163], v[128:131]
    v_mfma_f32_16x16x32_bf16 v[128:131], v[228:231], a[164:167], v[128:131]
    s_cbranch_scc1 L_loop_fast0
    s_branch L_drain
.p2align 6
L_loop_fast1:
    v_mfma_f32_16x16x32_bf16 v[164:167], v[196:199], a[168:171], 0
    s_add_u32 s12, s42, s27
    ds_read_b128 v[144:147], v2 offset:18432
    ds_read_b128 v[192:195], v2 offset:19456
    v_mfma_f32_16x16x32_bf16 v[164:167], v[184:187], a[172:175], v[164:167]
    s_addc_u32 s13, s43, 0
    v_fmac_f32 v168, v160, v160
    v_fmac_f32 v168, v161, v161
    v_mfma_f32_16x16x32_bf16 v[164:167], v[172:175], a[176:179], v[164:167]
    s_sub_u32 s14, s36, s27
    v_fmac_f32 v168, v162, v162
    v_fmac_f32 v168, v163, v163
    v_mfma_f32_16x16x32_bf16 v[164:167], v[148:151], a[180:183], v[164:167]
    s_cmp_ge_u32 s18, 2
    ds_read_b128 v[120:123], v0 offset:26624
    v_fmac_f32 v168, v116, v116
    v_mfma_f32_16x16x32_bf16 v[164:167], v[112:115], a[184:187], v[164:167]
    s_cselect_b32 s14, s14, 0
    ds_read_b128 v[188:191], v1 offset:26624
    v_fmac_f32 v168, v117, v117
    v_mfma_f32_16x16x32_bf16 v[164:167], v[228:231], a[188:191], v[164:167]
    s_add_u32 s34, s18, 2
    ds_read_b128 v[248:251], v0 offset:26752
    v_fmac_f32 v168, v118, v118
    v_mfma_f32_16x16x32_bf16 v[140:143], v[196:199], a[192:195], 0
    s_add_u32 s8, s40, s23
    ds_read_b128 v[224:227], v1 offset:26752
    v_fmac_f32 v168, v119, v119
    v_mfma_f32_16x16x32_bf16 v[140:143], v[184:187], a[196:199], v[140:143]
    s_addc_u32 s9, s41, 0
    ds_read_b128 v[184:187], v0 offset:26880
    v_cvt_pk_bf16_f32 v36, v168, v169
    v_mfma_f32_16x16x32_bf16 v[140:143], v[172:175], a[200:203], v[140:143]
    s_waitcnt lgkmcnt(5)
    ds_read_b128 v[172:175], v1 offset:26880
    v_cvt_pk_bf16_f32 v128, v128, v129
    v_mfma_f32_16x16x32_bf16 v[168:171], v[32:35], v[36:39], 0
    s_sub_u32 s10, s36, s23
    v_cvt_pk_bf16_f32 v129, v130, v131
    v_cvt_pk_bf16_f32 v164, v164, v165
    v_mfma_f32_16x16x32_bf16 v[240:243], v[32:35], v[144:147], 0
    s_cmp_lt_u32 s34, s17
    v_cvt_pk_bf16_f32 v165, v166, v167
    s_cselect_b32 s10, s10, 0
    v_mfma_f32_16x16x32_bf16 v[240:243], v[32:35], v[192:195], v[240:243]
    s_waitcnt lgkmcnt(5)
    v_rsq_f32 v169, v169
    v_mfma_f32_16x16x32_bf16 v[140:143], v[148:151], a[204:207], v[140:143]
    s_add_u32 m0, s28, 0
    v_rsq_f32 v168, v168
    v_mfma_f32_16x16x32_bf16 v[140:143], v[112:115], a[208:211], v[140:143]
    s_mov_b32 s27, s26
    v_mul_f32 v168, s31, v168
    v_mul_f32 v204, v169, v204
    v_mfma_f32_16x16x32_bf16 v[140:143], v[228:231], a[212:215], v[140:143]
    s_mov_b32 s26, s25
    v_mul_f32 v205, v169, v205
    v_cvt_pk_bf16_f32 v204, v204, v205
    v_mfma_f32_16x16x32_bf16 v[112:115], a[72:75], v[120:123], 0
    s_waitcnt lgkmcnt(1)
    v_mul_f32 v206, v169, v206
    v_mul_f32 v207, v169, v207
    v_mfma_f32_16x16x32_bf16 v[112:115], a[76:79], v[188:191], v[112:115]
    s_mov_b32 s25, s24
    v_cvt_pk_bf16_f32 v144, v140, v141
    v_cvt_pk_bf16_f32 v145, v142, v143
    v_mfma_f32_16x16x32_bf16 v[112:115], a[80:83], v[248:251], v[112:115]
    s_mov_b32 s24, s23
    v_cvt_pk_bf16_f32 v205, v206, v207
    v_mul_f32 v176, v169, v176
    v_mfma_f32_16x16x32_bf16 v[112:115], a[84:87], v[224:227], v[112:115]
    s_waitcnt lgkmcnt(0)
    v_mul_f32 v177, v169, v177
    v_cvt_pk_bf16_f32 v206, v176, v177
    v_mfma_f32_16x16x32_bf16 v[112:115], a[88:91], v[184:187], v[112:115]
    v_mul_f32 v178, v169, v178
    v_mul_f32 v179, v169, v179
    v_mfma_f32_16x16x32_bf16 v[112:115], a[92:95], v[172:175], v[112:115]
    v_cvt_pk_bf16_f32 v207, v178, v179
    v_mul_f32 v124, v169, v124
    v_mfma_f32_16x16x32_bf16 v[148:151], a[96:99], v[120:123], 0
    v_mul_f32 v125, v169, v125
    v_cvt_pk_bf16_f32 v194, v124, v125
    v_mfma_f32_16x16x32_bf16 v[148:151], a[100:103], v[188:191], v[148:151]
    v_mul_f32 v126, v169, v126
    v_mul_f32 v127, v169, v127
    v_mfma_f32_16x16x32_bf16 v[148:151], a[104:107], v[248:251], v[148:151]
    v_cvt_pk_bf16_f32 v195, v126, v127
    v_mul_f32 v216, v168, v216
    v_mfma_f32_16x16x32_bf16 v[148:151], a[108:111], v[224:227], v[148:151]
    v_mul_f32 v217, v168, v217
    v_cvt_pk_bf16_f32 v196, v216, v217
    v_mfma_f32_16x16x32_bf16 v[148:151], a[112:115], v[184:187], v[148:151]
    v_mul_f32 v218, v168, v218
    v_mul_f32 v219, v168, v219
    v_mfma_f32_16x16x32_bf16 v[148:151], a[116:119], v[172:175], v[148:151]
    v_cvt_pk_bf16_f32 v197, v218, v219
    v_mul_f32 v160, v168, v160
    v_mfma_f32_16x16x32_bf16 v[228:231], a[120:123], v[120:123], 0
    v_mul_f32 v161, v168, v161
    v_cvt_pk_bf16_f32 v198, v160, v161
    v_mfma_f32_16x16x32_bf16 v[228:231], a[124:127], v[188:191], v[228:231]
    v_mul_f32 v162, v168, v162
    v_mul_f32 v163, v168, v163
    v_mfma_f32_16x16x32_bf16 v[228:231], a[128:131], v[248:251], v[228:231]
    v_cvt_pk_bf16_f32 v199, v162, v163
    v_mul_f32 v116, v168, v116
    v_mfma_f32_16x16x32_bf16 v[228:231], a[132:135], v[224:227], v[228:231]
    v_mul_f32 v117, v168, v117
    v_cvt_pk_bf16_f32 v192, v116, v117
    v_mfma_f32_16x16x32_bf16 v[228:231], a[136:139], v[184:187], v[228:231]
    v_mul_f32 v118, v168, v118
    v_mul_f32 v119, v168, v119
    v_mfma_f32_16x16x32_bf16 v[228:231], a[140:143], v[172:175], v[228:231]
    v_cvt_pk_bf16_f32 v193, v118, v119
    v_fma_f32 v130, v112, v112, s32
    v_mfma_f32_16x16x32_bf16 v[212:215], a[0:3], v[120:123], 0
    v_fmac_f32 v130, v113, v113
    v_fmac_f32 v130, v114, v114
    v_mfma_f32_16x16x32_bf16 v[212:215], a[4:7], v[188:191], v[212:215]
    v_fmac_f32 v130, v115, v115
    v_fmac_f32 v130, v148, v148
    v_mfma_f32_16x16x32_bf16 v[212:215], a[8:11], v[248:251], v[212:215]
    v_fmac_f32 v130, v149, v149
    v_fmac_f32 v130, v150, v150
    v_mfma_f32_16x16x32_bf16 v[212:215], a[12:15], v[224:227], v[212:215]
    v_fmac_f32 v130, v151, v151
    v_fmac_f32 v130, v228, v228
    v_mfma_f32_16x16x32_bf16 v[212:215], a[16:19], v[184:187], v[212:215]
    v_fmac_f32 v130, v229, v229
    v_fmac_f32 v130, v230, v230
    v_mfma_f32_16x16x32_bf16 v[212:215], a[20:23], v[172:175], v[212:215]
    v_fmac_f32 v130, v231, v231
    v_mul_f32 v142, 0x3baaaaab, v240
    v_mfma_f32_16x16x32_bf16 v[232:235], a[24:27], v[120:123], 0
    v_rsq_f32 v142, v142
    v_mfma_f32_16x16x32_bf16 v[232:235], a[28:31], v[188:191], v[232:235]
    v_mul_f32 v147, 0x3baaaaab, v241
    v_mul_f32 v146, 0x3baaaaab, v242
    v_mfma_f32_16x16x32_bf16 v[232:235], a[32:35], v[248:251], v[232:235]
    v_fma_f32 v131, v212, v212, s32
    v_fmac_f32 v131, v213, v213
    v_mfma_f32_16x16x32_bf16 v[232:235], a[36:39], v[224:227], v[232:235]
    v_fmac_f32 v131, v214, v214
    v_fmac_f32 v131, v215, v215
    v_mfma_f32_16x16x32_bf16 v[232:235], a[40:43], v[184:187], v[232:235]
    v_rsq_f32 v147, v147
    v_mfma_f32_16x16x32_bf16 v[232:235], a[44:47], v[172:175], v[232:235]
    v_mul_f32 v136, v147, v136
    v_mul_f32 v137, v147, v137
    v_mfma_f32_16x16x32_bf16 v[240:243], a[48:51], v[120:123], 0
    v_cvt_pk_bf16_f32 v176, v136, v137
    v_mul_f32 v138, v147, v138
    v_mfma_f32_16x16x32_bf16 v[240:243], a[52:55], v[188:191], v[240:243]
    v_mul_f32 v139, v147, v139
    v_cvt_pk_bf16_f32 v177, v138, v139
    v_mfma_f32_16x16x32_bf16 v[240:243], a[56:59], v[248:251], v[240:243]
    v_fmac_f32 v131, v232, v232
    v_fmac_f32 v131, v233, v233
    v_mfma_f32_16x16x32_bf16 v[240:243], a[60:63], v[224:227], v[240:243]
    v_fmac_f32 v131, v234, v234
    v_fmac_f32 v131, v235, v235
    v_mfma_f32_16x16x32_bf16 v[240:243], a[64:67], v[184:187], v[240:243]
    v_mul_f32 v208, v147, v208
    v_mul_f32 v209, v147, v209
    v_mfma_f32_16x16x32_bf16 v[240:243], a[68:71], v[172:175], v[240:243]
    v_cvt_pk_bf16_f32 v178, v208, v209
    v_mul_f32 v210, v147, v210
    v_mfma_f32_16x16x32_bf16 v[216:219], v[120:123], a[144:147], 0
    v_mul_f32 v211, v147, v211
    v_cvt_pk_bf16_f32 v179, v210, v211
    v_mfma_f32_16x16x32_bf16 v[216:219], v[188:191], a[148:151], v[216:219]
    buffer_store_dwordx4 v[176:179], v16, s[12:15], 0 offen
    v_mul_f32 v156, v147, v156
    v_fmac_f32 v131, v240, v240
    v_fmac_f32 v131, v241, v241
    v_fmac_f32 v131, v242, v242
    v_mfma_f32_16x16x32_bf16 v[216:219], v[248:251], a[152:155], v[216:219]
    v_fmac_f32 v131, v243, v243
    v_cvt_pk_bf16_f32 v36, v131, v130
    v_mfma_f32_16x16x32_bf16 v[216:219], v[224:227], a[156:159], v[216:219]
    v_mul_f32 v157, v147, v157
    v_cvt_pk_bf16_f32 v118, v156, v157
    v_mfma_f32_16x16x32_bf16 v[136:139], v[32:35], v[36:39], 0
    v_mul_f32 v158, v147, v158
    v_mul_f32 v159, v147, v159
    v_mfma_f32_16x16x32_bf16 v[216:219], v[184:187], a[160:163], v[216:219]
    v_cvt_pk_bf16_f32 v119, v158, v159
    v_mul_f32 v180, v142, v180
    v_mfma_f32_16x16x32_bf16 v[216:219], v[172:175], a[164:167], v[216:219]
    v_rsq_f32 v146, v146
    v_mfma_f32_16x16x32_bf16 v[168:171], v[120:123], a[168:171], 0
    v_mul_f32 v200, v146, v200
    v_mul_f32 v201, v146, v201
    v_mfma_f32_16x16x32_bf16 v[168:171], v[188:191], a[172:175], v[168:171]
    v_cvt_pk_bf16_f32 v200, v200, v201
    v_mul_f32 v202, v146, v202
    v_mfma_f32_16x16x32_bf16 v[168:171], v[248:251], a[176:179], v[168:171]
    v_cvt_pk_bf16_f32 v130, v216, v217
    v_cvt_pk_bf16_f32 v131, v218, v219
    v_mfma_f32_16x16x32_bf16 v[168:171], v[224:227], a[180:183], v[168:171]
    ds_read_b128 v[176:179], v0 offset:32768
    v_mul_f32 v203, v146, v203
    v_mfma_f32_16x16x32_bf16 v[168:171], v[184:187], a[184:187], v[168:171]
    ds_read_b128 v[160:163], v1 offset:32768
    v_cvt_pk_bf16_f32 v201, v202, v203
    v_mfma_f32_16x16x32_bf16 v[168:171], v[172:175], a[188:191], v[168:171]
    ds_read_b128 v[208:211], v0 offset:32896
    v_mul_f32 v244, v146, v244
    v_mfma_f32_16x16x32_bf16 v[156:159], v[120:123], a[192:195], 0
    ds_read_b128 v[216:219], v1 offset:32896
    v_mul_f32 v245, v146, v245
    v_mfma_f32_16x16x32_bf16 v[156:159], v[188:191], a[196:199], v[156:159]
    ds_read_b128 v[124:127], v0 offset:33024
    v_cvt_pk_bf16_f32 v202, v244, v245
    v_mfma_f32_16x16x32_bf16 v[156:159], v[248:251], a[200:203], v[156:159]
    ds_read_b128 v[120:123], v1 offset:33024
    v_mul_f32 v246, v146, v246
    v_mfma_f32_16x16x32_bf16 v[156:159], v[224:227], a[204:207], v[156:159]
    v_mul_f32 v247, v146, v247
    v_cvt_pk_bf16_f32 v203, v246, v247
    v_mfma_f32_16x16x32_bf16 v[156:159], v[184:187], a[208:211], v[156:159]
    v_mul_f32 v132, v146, v132
    v_mul_f32 v133, v146, v133
    v_mfma_f32_16x16x32_bf16 v[156:159], v[172:175], a[212:215], v[156:159]
    s_waitcnt lgkmcnt(5)
    buffer_store_dwordx4 v[200:203], v17, s[12:15], 0 offen
    v_cvt_pk_bf16_f32 v116, v132, v133
    v_mul_f32 v134, v146, v134
    v_mul_f32 v135, v146, v135
    v_cvt_pk_bf16_f32 v117, v134, v135
    v_mfma_f32_16x16x32_bf16 v[200:203], a[72:75], v[176:179], 0
    s_waitcnt lgkmcnt(3)
    v_rsq_f32 v137, v137
    v_mfma_f32_16x16x32_bf16 v[200:203], a[76:79], v[160:163], v[200:203]
    s_waitcnt lgkmcnt(2)
    v_rsq_f32 v136, v136
    v_mfma_f32_16x16x32_bf16 v[200:203], a[80:83], v[208:211], v[200:203]
    s_waitcnt lgkmcnt(1)
    v_mul_f32 v136, s31, v136
    v_cvt_pk_bf16_f32 v166, v168, v169
    v_mfma_f32_16x16x32_bf16 v[200:203], a[84:87], v[216:219], v[200:203]
    s_waitcnt lgkmcnt(0)
    v_cvt_pk_bf16_f32 v167, v170, v171
    v_cvt_pk_bf16_f32 v146, v156, v157
    v_mfma_f32_16x16x32_bf16 v[200:203], a[88:91], v[124:127], v[200:203]
    v_cvt_pk_bf16_f32 v147, v158, v159
    v_mul_f32 v112, v137, v112
    v_mfma_f32_16x16x32_bf16 v[200:203], a[92:95], v[120:123], v[200:203]
    v_mul_f32 v113, v137, v113
    v_cvt_pk_bf16_f32 v184, v112, v113
    v_mfma_f32_16x16x32_bf16 v[168:171], a[96:99], v[176:179], 0
    v_mul_f32 v114, v137, v114
    v_mul_f32 v115, v137, v115
    v_mfma_f32_16x16x32_bf16 v[168:171], a[100:103], v[160:163], v[168:171]
    v_cvt_pk_bf16_f32 v185, v114, v115
    v_mul_f32 v148, v137, v148
    v_mfma_f32_16x16x32_bf16 v[168:171], a[104:107], v[208:211], v[168:171]
    v_mul_f32 v149, v137, v149
    v_cvt_pk_bf16_f32 v186, v148, v149
    v_mfma_f32_16x16x32_bf16 v[168:171], a[108:111], v[216:219], v[168:171]
    v_mul_f32 v150, v137, v150
    v_mul_f32 v151, v137, v151
    v_mfma_f32_16x16x32_bf16 v[168:171], a[112:115], v[124:127], v[168:171]
    s_waitcnt vmcnt(2)
    v_cvt_pk_bf16_f32 v187, v150, v151
    v_mul_f32 v228, v137, v228
    v_mfma_f32_16x16x32_bf16 v[168:171], a[116:119], v[120:123], v[168:171]
    s_nop 0
    v_mul_f32 v229, v137, v229
    v_cvt_pk_bf16_f32 v174, v228, v229
    v_mfma_f32_16x16x32_bf16 v[112:115], a[120:123], v[176:179], 0
    s_barrier
    v_mul_f32 v230, v137, v230
    v_mul_f32 v231, v137, v231
    v_mfma_f32_16x16x32_bf16 v[112:115], a[124:127], v[160:163], v[112:115]
    s_nop 0
    v_cvt_pk_bf16_f32 v175, v230, v231
    v_mul_f32 v212, v136, v212
    v_mfma_f32_16x16x32_bf16 v[112:115], a[128:131], v[208:211], v[112:115]
    s_nop 0
    v_mul_f32 v213, v136, v213
    v_cvt_pk_bf16_f32 v132, v212, v213
    v_mfma_f32_16x16x32_bf16 v[112:115], a[132:135], v[216:219], v[112:115]
    v_mul_f32 v214, v136, v214
    v_mul_f32 v215, v136, v215
    v_mfma_f32_16x16x32_bf16 v[112:115], a[136:139], v[124:127], v[112:115]
    buffer_load_dwordx4 v10, s[8:11], 0 offen nt lds
    v_cvt_pk_bf16_f32 v133, v214, v215
    v_mfma_f32_16x16x32_bf16 v[112:115], a[140:143], v[120:123], v[112:115]
    s_add_u32 m0, s28, 4096
    v_mul_f32 v232, v136, v232
    v_mul_f32 v233, v136, v233
    v_mfma_f32_16x16x32_bf16 v[188:191], a[0:3], v[176:179], 0
    v_cvt_pk_bf16_f32 v134, v232, v233
    v_mul_f32 v234, v136, v234
    v_mfma_f32_16x16x32_bf16 v[188:191], a[4:7], v[160:163], v[188:191]
    v_mul_f32 v235, v136, v235
    v_cvt_pk_bf16_f32 v135, v234, v235
    v_mfma_f32_16x16x32_bf16 v[188:191], a[8:11], v[208:211], v[188:191]
    v_mul_f32 v240, v136, v240
    v_mul_f32 v241, v136, v241
    v_mfma_f32_16x16x32_bf16 v[188:191], a[12:15], v[216:219], v[188:191]
    buffer_load_dwordx4 v11, s[8:11], 0 offen nt lds
    v_cvt_pk_bf16_f32 v172, v240, v241
    v_mfma_f32_16x16x32_bf16 v[188:191], a[16:19], v[124:127], v[188:191]
    s_add_u32 m0, s28, 8192
    v_mul_f32 v242, v136, v242
    v_mul_f32 v243, v136, v243
    v_mfma_f32_16x16x32_bf16 v[188:191], a[20:23], v[120:123], v[188:191]
    v_cvt_pk_bf16_f32 v173, v242, v243
    v_fma_f32 v140, v200, v200, s32
    v_mfma_f32_16x16x32_bf16 v[136:139], a[24:27], v[176:179], 0
    v_fmac_f32 v140, v201, v201
    v_fmac_f32 v140, v202, v202
    v_mfma_f32_16x16x32_bf16 v[136:139], a[28:31], v[160:163], v[136:139]
    v_fmac_f32 v140, v203, v203
    v_fmac_f32 v140, v168, v168
    v_mfma_f32_16x16x32_bf16 v[136:139], a[32:35], v[208:211], v[136:139]
    buffer_load_dwordx4 v12, s[8:11], 0 offen nt lds
    v_fma_f32 v141, v188, v188, s32
    v_mfma_f32_16x16x32_bf16 v[136:139], a[36:39], v[216:219], v[136:139]
    s_add_u32 m0, s28, 12288
    v_fmac_f32 v141, v189, v189
    v_fmac_f32 v141, v190, v190
    v_mfma_f32_16x16x32_bf16 v[136:139], a[40:43], v[124:127], v[136:139]
    s_xor_b32 s28, s28, 65536
    v_fmac_f32 v141, v191, v191
    v_fmac_f32 v140, v169, v169
    v_mfma_f32_16x16x32_bf16 v[136:139], a[44:47], v[120:123], v[136:139]
    v_fmac_f32 v140, v170, v170
    v_fmac_f32 v140, v171, v171
    v_mfma_f32_16x16x32_bf16 v[148:151], a[48:51], v[176:179], 0
    v_fmac_f32 v140, v112, v112
    v_fmac_f32 v140, v113, v113
    v_mfma_f32_16x16x32_bf16 v[148:151], a[52:55], v[160:163], v[148:151]
    buffer_load_dwordx4 v13, s[8:11], 0 offen nt lds
    v_fmac_f32 v140, v114, v114
    v_mfma_f32_16x16x32_bf16 v[148:151], a[56:59], v[208:211], v[148:151]
    s_mov_b32 m0, s29
    v_fmac_f32 v141, v136, v136
    v_fmac_f32 v141, v137, v137
    v_mfma_f32_16x16x32_bf16 v[148:151], a[60:63], v[216:219], v[148:151]
    s_xor_b32 s29, s29, s30
    v_fmac_f32 v141, v138, v138
    v_fmac_f32 v141, v139, v139
    v_mfma_f32_16x16x32_bf16 v[148:151], a[64:67], v[124:127], v[148:151]
    s_add_u32 s19, s19, s20
    v_fmac_f32 v140, v115, v115
    v_mul_f32 v181, v142, v181
    v_mfma_f32_16x16x32_bf16 v[148:151], a[68:71], v[120:123], v[148:151]
    s_add_u32 s23, s23, s21
    v_cvt_pk_bf16_f32 v156, v180, v181
    v_mul_f32 v182, v142, v182
    v_mfma_f32_16x16x32_bf16 v[220:223], v[176:179], a[144:147], 0
    s_cmp_ge_u32 s19, 72
    ds_read_b128 v[212:215], v5 offset:0
    ds_read_b128 v[224:227], v5 offset:16
    v_mfma_f32_16x16x32_bf16 v[220:223], v[160:163], a[148:151], v[220:223]
    s_cselect_b32 s34, 72, 0
    ds_read_b128 v[228:231], v5 offset:48
    ds_read_b32 v143, v6 offset:192
    v_mfma_f32_16x16x32_bf16 v[220:223], v[208:211], a[152:155], v[220:223]
    s_cselect_b32 s35, s22, 0
    buffer_store_dwordx2 v[116:117], v20, s[12:15], 0 offen
    v_fmac_f32 v141, v148, v148
    v_fmac_f32 v141, v149, v149
    v_mfma_f32_16x16x32_bf16 v[220:223], v[216:219], a[156:159], v[220:223]
    s_sub_u32 s19, s19, s34
    v_fmac_f32 v141, v150, v150
    v_fmac_f32 v141, v151, v151
    v_mfma_f32_16x16x32_bf16 v[220:223], v[124:127], a[160:163], v[220:223]
    s_add_u32 s23, s23, s35
    v_cvt_pk_bf16_f32 v36, v141, v140
    v_mul_f32 v183, v142, v183
    v_mfma_f32_16x16x32_bf16 v[220:223], v[120:123], a[164:167], v[220:223]
    s_add_u32 s18, s18, 1
    v_cvt_pk_bf16_f32 v157, v182, v183
    v_mul_f32 v108, v142, v108
    v_mfma_f32_16x16x32_bf16 v[180:183], v[32:35], v[36:39], 0
    s_cmp_lt_u32 s18, s17
    v_mul_f32 v109, v142, v109
    v_cvt_pk_bf16_f32 v158, v108, v109
    v_mfma_f32_16x16x32_bf16 v[232:235], v[176:179], a[168:171], 0
    s_waitcnt lgkmcnt(3)
    v_cvt_pk_bf16_f32 v116, v220, v221
    v_cvt_pk_bf16_f32 v117, v222, v223
    v_mfma_f32_16x16x32_bf16 v[220:223], v[212:215], v[196:199], v[22:25]
    s_waitcnt lgkmcnt(1)
    v_rsq_f32 v181, v181
    v_mfma_f32_16x16x32_bf16 v[220:223], v[224:227], v[204:207], v[220:223]
    s_waitcnt lgkmcnt(0)
    v_rsq_f32 v180, v180
    v_mfma_f32_16x16x32_bf16 v[220:223], v[228:231], v[192:195], v[220:223]
    v_mul_f32 v180, s31, v180
    v_mul_f32 v200, v181, v200
    v_mfma_f32_16x16x32_bf16 v[236:239], v[212:215], v[132:135], v[24:27]
    v_mul_f32 v201, v181, v201
    v_cvt_pk_bf16_f32 v200, v200, v201
    v_mfma_f32_16x16x32_bf16 v[236:239], v[224:227], v[184:187], v[236:239]
    v_mul_f32 v202, v181, v202
    v_mul_f32 v203, v181, v203
    v_mfma_f32_16x16x32_bf16 v[236:239], v[228:231], v[172:175], v[236:239]
    v_mov_b32_dpp v143, v221 quad_perm:[0,1,2,3] row_mask:0x1 bank_mask:0xf
    v_cvt_pk_bf16_f32 v201, v202, v203
    v_mfma_f32_16x16x32_bf16 v[232:235], v[160:163], a[172:175], v[232:235]
    v_mul_f32 v168, v181, v168
    v_mul_f32 v169, v181, v169
    v_mfma_f32_16x16x32_bf16 v[232:235], v[208:211], a[176:179], v[232:235]
    v_cvt_pk_bf16_f32 v202, v168, v169
    v_mul_f32 v170, v181, v170
    v_mfma_f32_16x16x32_bf16 v[232:235], v[216:219], a[180:183], v[232:235]
    v_mul_f32 v171, v181, v171
    v_cvt_pk_bf16_f32 v203, v170, v171
    v_mfma_f32_16x16x32_bf16 v[240:243], v[204:207], v[196:199], v[40:43]
    v_mul_f32 v112, v181, v112
    v_mul_f32 v113, v181, v113
    v_mfma_f32_16x16x32_bf16 v[248:251], v[184:187], v[196:199], v[44:47]
    v_cvt_pk_bf16_f32 v246, v112, v113
    v_mul_f32 v114, v181, v114
    v_mfma_f32_16x16x32_bf16 v[168:171], v[200:203], v[196:199], v[48:51]
    buffer_store_dwordx2 v[118:119], v19, s[12:15], 0 offen
    v_mul_f32 v115, v181, v115
    v_cvt_pk_bf16_f32 v247, v114, v115
    v_mfma_f32_16x16x16_bf16 v[240:243], v[194:195], v[192:193], v[240:243]
    v_mul_f32 v188, v180, v188
    v_mul_f32 v189, v180, v189
    v_cvt_pk_bf16_f32 v196, v188, v189
    v_mfma_f32_16x16x16_bf16 v[248:251], v[174:175], v[192:193], v[248:251]
    v_mul_f32 v190, v180, v190
    v_mul_f32 v191, v180, v191
    v_cvt_pk_bf16_f32 v197, v190, v191
    v_mfma_f32_16x16x16_bf16 v[168:171], v[246:247], v[192:193], v[168:171]
    v_mul_f32 v136, v180, v136
    v_mul_f32 v137, v180, v137
    v_cvt_pk_bf16_f32 v198, v136, v137
    v_mul_f32 v138, v180, v138
    v_mfma_f32_16x16x32_bf16 v[232:235], v[124:127], a[184:187], v[232:235]
    v_mul_f32 v139, v180, v139
    v_cvt_pk_bf16_f32 v199, v138, v139
    v_mfma_f32_16x16x32_bf16 v[232:235], v[120:123], a[188:191], v[232:235]
    v_mul_f32 v148, v180, v148
    v_mul_f32 v149, v180, v149
    v_mfma_f32_16x16x32_bf16 v[112:115], v[176:179], a[192:195], 0
    ds_read_b128 v[176:179], v2 offset:0
    v_cvt_pk_bf16_f32 v244, v148, v149
    v_mfma_f32_16x16x32_bf16 v[112:115], v[160:163], a[196:199], v[112:115]
    ds_read_b128 v[160:163], v2 offset:1024
    v_mul_f32 v150, v180, v150
    v_mfma_f32_16x16x32_bf16 v[112:115], v[208:211], a[200:203], v[112:115]
    ds_read_b128 v[136:139], v2 offset:2048
    v_cvt_pk_bf16_f32 v188, v232, v233
    v_mfma_f32_16x16x32_bf16 v[112:115], v[216:219], a[204:207], v[112:115]
    ds_read_b128 v[208:211], v2 offset:3072
    v_cvt_pk_bf16_f32 v189, v234, v235
    v_mfma_f32_16x16x32_bf16 v[112:115], v[124:127], a[208:211], v[112:115]
    ds_read_b128 v[124:127], v2 offset:4096
    ds_read2_b32 v[118:119], v6 offset0:0 offset1:0
    v_mfma_f32_16x16x32_bf16 v[112:115], v[120:123], a[212:215], v[112:115]
    ds_read_b128 v[120:123], v2 offset:5120
    ds_read2_b32 v[190:191], v6 offset0:16 offset1:16
    v_mfma_f32_16x16x32_bf16 v[232:235], v[212:215], v[196:199], v[26:29]
    v_mul_f32 v151, v180, v151
    v_cvt_pk_bf16_f32 v245, v150, v151
    v_mfma_f32_16x16x32_bf16 v[232:235], v[224:227], v[200:203], v[232:235]
    ds_read2_b32 v[218:219], v6 offset0:32 offset1:32
    v_mov_b32_dpp v143, v237 quad_perm:[0,1,2,3] row_mask:0x2 bank_mask:0xf
    v_mfma_f32_16x16x32_bf16 v[232:235], v[228:231], v[244:247], v[232:235]
    s_waitcnt lgkmcnt(8)
    v_cvt_pk_bf16_f32 v216, v112, v113
    v_cvt_pk_bf16_f32 v217, v114, v115
    v_mfma_f32_16x16x32_bf16 v[180:183], a[216:219], v[176:179], 0
    s_waitcnt lgkmcnt(7)
    v_mul_f32 v110, v142, v110
    v_mul_f32 v111, v142, v111
    v_mfma_f32_16x16x32_bf16 v[180:183], a[220:223], v[160:163], v[180:183]
    s_waitcnt lgkmcnt(6)
    v_cvt_pk_bf16_f32 v159, v110, v111
    v_mul_f32 v152, v142, v152
    v_mfma_f32_16x16x32_bf16 v[180:183], a[224:227], v[136:139], v[180:183]
    s_waitcnt lgkmcnt(5)
    buffer_store_dwordx4 v[156:159], v15, s[12:15], 0 offen
    v_mul_f32 v153, v142, v153
    v_cvt_pk_bf16_f32 v192, v152, v153
    v_mul_f32 v154, v142, v154
    v_mul_f32 v155, v142, v155
    v_mfma_f32_16x16x32_bf16 v[180:183], a[228:231], v[208:211], v[180:183]
    s_waitcnt lgkmcnt(1)
    v_cvt_pk_bf16_f32 v193, v154, v155
    v_mov_b32_dpp v143, v233 quad_perm:[0,1,2,3] row_mask:0x4 bank_mask:0xf
    v_mfma_f32_16x16x32_bf16 v[180:183], a[232:235], v[124:127], v[180:183]
    v_exp_f32 v232, v232
    v_mfma_f32_16x16x32_bf16 v[180:183], a[236:239], v[120:123], v[180:183]
    s_waitcnt lgkmcnt(0)
    v_exp_f32 v143, v143
    v_mfma_f32_16x16x32_bf16 v[108:111], a[240:243], v[176:179], 0
    v_cvt_pk_bf16_f32 v143, v143, v143
    v_add_u32 v5, 336, v5
    v_mfma_f32_16x16x32_bf16 v[108:111], a[244:247], v[160:163], v[108:111]
    ds_write_b16 v8, v143
    v_mfma_f32_16x16x32_bf16 v[108:111], a[248:251], v[136:139], v[108:111]
    v_exp_f32 v236, v236
    v_mfma_f32_16x16x32_bf16 v[108:111], a[252:255], v[208:211], v[108:111]
    ds_read_b128 v[140:143], v2 offset:6144
    ds_read_b128 v[224:227], v2 offset:7168
    v_mfma_f32_16x16x32_bf16 v[108:111], v[76:79], v[124:127], v[108:111]
    ds_read_b128 v[112:115], v2 offset:8192
    v_fma_f32 v221, v180, v180, s33
    v_mfma_f32_16x16x32_bf16 v[108:111], v[80:83], v[120:123], v[108:111]
    ds_read_b128 v[148:151], v2 offset:9216
    v_fmac_f32 v221, v181, v181
    v_mfma_f32_16x16x32_bf16 v[152:155], v[84:87], v[176:179], 0
    ds_read_b128 v[176:179], v2 offset:10240
    v_fmac_f32 v221, v182, v182
    v_mfma_f32_16x16x32_bf16 v[152:155], v[88:91], v[160:163], v[152:155]
    ds_read_b128 v[160:163], v2 offset:11264
    v_fmac_f32 v221, v183, v183
    v_mfma_f32_16x16x32_bf16 v[152:155], v[92:95], v[136:139], v[152:155]
    v_exp_f32 v240, v240
    v_mfma_f32_16x16x32_bf16 v[152:155], v[96:99], v[208:211], v[152:155]
    v_exp_f32 v241, v241
    v_mfma_f32_16x16x32_bf16 v[152:155], v[100:103], v[124:127], v[152:155]
    ds_read_b128 v[124:127], v9
    ds_read_b128 v[208:211], v9 offset:64
    v_mfma_f32_16x16x32_bf16 v[152:155], v[104:107], v[120:123], v[152:155]
    s_waitcnt lgkmcnt(6)
    v_cvt_pk_bf16_f32 v120, v240, v241
    v_fmac_f32 v221, v108, v108
    v_mfma_f32_16x16x32_bf16 v[136:139], a[216:219], v[140:143], 0
    s_waitcnt lgkmcnt(5)
    v_exp_f32 v242, v242
    v_mfma_f32_16x16x32_bf16 v[136:139], a[220:223], v[224:227], v[136:139]
    s_waitcnt lgkmcnt(4)
    buffer_store_dwordx2 v[192:193], v18, s[12:15], 0 offen
    v_exp_f32 v243, v243
    v_mfma_f32_16x16x32_bf16 v[136:139], a[224:227], v[112:115], v[136:139]
    s_waitcnt lgkmcnt(2)
    v_cvt_pk_bf16_f32 v121, v242, v243
    v_fmac_f32 v221, v109, v109
    v_mfma_f32_16x16x32_bf16 v[136:139], a[228:231], v[148:151], v[136:139]
    v_exp_f32 v248, v248
    v_mfma_f32_16x16x32_bf16 v[136:139], a[232:235], v[176:179], v[136:139]
    v_exp_f32 v249, v249
    v_mfma_f32_16x16x32_bf16 v[136:139], a[236:239], v[160:163], v[136:139]
    s_waitcnt lgkmcnt(1)
    v_cvt_pk_bf16_f32 v122, v248, v249
    v_fmac_f32 v221, v110, v110
    v_mfma_f32_16x16x32_bf16 v[240:243], v[124:127], v[28:31], 0
    s_waitcnt lgkmcnt(0)
    v_exp_f32 v250, v250
    v_mfma_f32_16x16x32_bf16 v[240:243], v[208:211], v[28:31], v[240:243]
    v_exp_f32 v251, v251
    v_mfma_f32_16x16x32_bf16 v[228:231], v[124:127], v[128:131], 0
    v_fma_f32 v192, v136, v136, s33
    v_fmac_f32 v192, v137, v137
    v_mfma_f32_16x16x32_bf16 v[228:231], v[208:211], v[116:119], v[228:231]
    v_fmac_f32 v192, v138, v138
    v_fmac_f32 v192, v139, v139
    v_mfma_f32_16x16x32_bf16 v[212:215], v[124:127], v[164:167], 0
    v_rcp_f32 v240, v240
    v_mfma_f32_16x16x32_bf16 v[212:215], v[208:211], v[188:191], v[212:215]
    v_cvt_pk_bf16_f32 v123, v250, v251
    v_fmac_f32 v221, v111, v111
    v_mfma_f32_16x16x32_bf16 v[248:251], v[124:127], v[144:147], 0
    v_mul_f32 v228, v228, v240
    v_fmac_f32 v221, v152, v152
    v_mfma_f32_16x16x32_bf16 v[248:251], v[208:211], v[216:219], v[248:251]
    v_exp_f32 v168, v168
    v_mfma_f32_16x16x32_bf16 v[208:211], a[240:243], v[140:143], 0
    v_mul_f32_dpp v228, v212, v240 quad_perm:[0,1,2,3] row_mask:0x2 bank_mask:0xf
    v_fmac_f32 v221, v153, v153
    v_mfma_f32_16x16x32_bf16 v[208:211], a[244:247], v[224:227], v[208:211]
    v_exp_f32 v169, v169
    v_mfma_f32_16x16x32_bf16 v[208:211], a[248:251], v[112:115], v[208:211]
    ds_read_b128 v[124:127], v2 offset:12288
    v_mul_f32_dpp v228, v248, v240 quad_perm:[0,1,2,3] row_mask:0x4 bank_mask:0xf
    v_mfma_f32_16x16x32_bf16 v[208:211], a[252:255], v[148:151], v[208:211]
    ds_read_b128 v[240:243], v2 offset:13312
    v_cvt_pk_bf16_f32 v228, v228, v228
    v_mfma_f32_16x16x32_bf16 v[208:211], v[76:79], v[176:179], v[208:211]
    ds_read_b128 v[212:215], v2 offset:14336
    buffer_load_dwordx4 v14, s[8:11], 0 offen nt lds
    v_mfma_f32_16x16x32_bf16 v[208:211], v[80:83], v[160:163], v[208:211]
    ds_read_b128 v[248:251], v2 offset:15360
    v_cvt_pk_bf16_f32 v36, v168, v169
    v_mfma_f32_16x16x32_bf16 v[156:159], v[84:87], v[140:143], 0
    ds_read_b128 v[140:143], v2 offset:16384
    v_fmac_f32 v221, v154, v154
    v_mfma_f32_16x16x32_bf16 v[156:159], v[88:91], v[224:227], v[156:159]
    ds_read_b128 v[224:227], v2 offset:17408
    v_fmac_f32 v221, v155, v155
    v_mfma_f32_16x16x32_bf16 v[156:159], v[92:95], v[112:115], v[156:159]
    ds_write_b16 v7, v228
    v_mfma_f32_16x16x32_bf16 v[156:159], v[96:99], v[148:151], v[156:159]
    v_fmac_f32 v192, v208, v208
    v_fmac_f32 v192, v209, v209
    v_mfma_f32_16x16x32_bf16 v[156:159], v[100:103], v[176:179], v[156:159]
    s_waitcnt lgkmcnt(6)
    v_fmac_f32 v192, v210, v210
    v_fmac_f32 v192, v211, v211
    v_mfma_f32_16x16x32_bf16 v[156:159], v[104:107], v[160:163], v[156:159]
    s_waitcnt lgkmcnt(5)
    v_exp_f32 v170, v170
    v_mfma_f32_16x16x32_bf16 v[160:163], v[204:207], v[132:135], v[52:55]
    s_waitcnt lgkmcnt(4)
    v_exp_f32 v171, v171
    v_mfma_f32_16x16x32_bf16 v[176:179], v[184:187], v[132:135], v[56:59]
    s_waitcnt lgkmcnt(3)
    v_cvt_pk_bf16_f32 v37, v170, v171
    v_fmac_f32 v192, v156, v156
    v_mfma_f32_16x16x32_bf16 v[168:171], v[200:203], v[132:135], v[60:63]
    s_waitcnt lgkmcnt(2)
    v_fmac_f32 v192, v157, v157
    v_fmac_f32 v192, v158, v158
    v_fmac_f32 v192, v159, v159
    v_mfma_f32_16x16x16_bf16 v[160:163], v[194:195], v[172:173], v[160:163]
    v_cvt_pk_bf16_f32 v234, v221, v192
    v_exp_f32 v220, v220
    v_mfma_f32_16x16x16_bf16 v[176:179], v[174:175], v[172:173], v[176:179]
    v_cvt_pk_bf16_f32 v39, v220, 0
    v_add_u32 v6, 272, v6
    v_add_u32 v7, 16, v7
    v_mfma_f32_16x16x16_bf16 v[168:171], v[246:247], v[172:173], v[168:171]
    v_xor_b32 v0, 65536, v0
    v_exp_f32 v160, v160
    v_xor_b32 v1, 65536, v1
    v_mfma_f32_16x16x32_bf16 v[132:135], v[28:31], v[36:39], 0
    s_waitcnt lgkmcnt(0)
    v_exp_f32 v161, v161
    v_mfma_f32_16x16x32_bf16 v[132:135], v[28:31], v[120:123], v[132:135]
    v_cvt_pk_bf16_f32 v192, v160, v161
    v_xor_b32 v2, 65536, v2
    v_mfma_f32_16x16x32_bf16 v[112:115], v[116:119], v[36:39], 0
    v_exp_f32 v162, v162
    v_mfma_f32_16x16x32_bf16 v[112:115], v[128:131], v[120:123], v[112:115]
    v_exp_f32 v163, v163
    v_mfma_f32_16x16x32_bf16 v[148:151], v[188:191], v[36:39], 0
    v_exp_f32 v176, v176
    v_mfma_f32_16x16x32_bf16 v[148:151], v[164:167], v[120:123], v[148:151]
    v_rcp_f32 v132, v132
    v_mfma_f32_16x16x32_bf16 v[220:223], v[216:219], v[36:39], 0
    v_cvt_pk_bf16_f32 v193, v162, v163
    v_cvt_pk_bf16_f32 v39, v236, 0
    v_mfma_f32_16x16x32_bf16 v[220:223], v[144:147], v[120:123], v[220:223]
    v_mul_f32 v112, v132, v112
    v_mul_f32 v113, v132, v113
    v_mfma_f32_16x16x32_bf16 v[160:163], v[204:207], v[196:199], v[64:67]
    v_cvt_pk_bf16_f32 v112, v112, v113
    v_mul_f32 v114, v132, v114
    v_mfma_f32_16x16x32_bf16 v[204:207], v[184:187], v[196:199], v[68:71]
    v_mul_f32 v115, v132, v115
    v_cvt_pk_bf16_f32 v113, v114, v115
    v_mfma_f32_16x16x32_bf16 v[120:123], v[200:203], v[196:199], v[72:75]
    v_mul_f32 v148, v132, v148
    v_mul_f32 v149, v132, v149
    v_cvt_pk_bf16_f32 v114, v148, v149
    v_mfma_f32_16x16x16_bf16 v[160:163], v[194:195], v[244:245], v[160:163]
    v_mul_f32 v150, v132, v150
    v_mul_f32 v151, v132, v151
    v_cvt_pk_bf16_f32 v115, v150, v151
    v_mfma_f32_16x16x16_bf16 v[204:207], v[174:175], v[244:245], v[204:207]
    v_mul_f32 v220, v132, v220
    v_mul_f32 v221, v132, v221
    v_cvt_pk_bf16_f32 v194, v220, v221
    v_mfma_f32_16x16x16_bf16 v[120:123], v[246:247], v[244:245], v[120:123]
    v_exp_f32 v160, v160
    v_exp_f32 v161, v161
    v_mfma_f32_16x16x32_bf16 v[200:203], a[216:219], v[124:127], 0
    ds_write_b128 v3, v[112:115] offset:0
    v_mfma_f32_16x16x32_bf16 v[200:203], a[220:223], v[240:243], v[200:203]
    v_cvt_pk_bf16_f32 v160, v160, v161
    v_mul_f32 v222, v132, v222
    v_mfma_f32_16x16x32_bf16 v[200:203], a[224:227], v[212:215], v[200:203]
    v_exp_f32 v162, v162
    v_mfma_f32_16x16x32_bf16 v[200:203], a[228:231], v[248:251], v[200:203]
    ds_read_b128 v[196:199], v0 offset:20480
    ds_read_b128 v[184:187], v1 offset:20480
    v_mfma_f32_16x16x32_bf16 v[200:203], a[232:235], v[140:143], v[200:203]
    ds_read_b128 v[172:175], v0 offset:20608
    ds_read_b128 v[148:151], v1 offset:20608
    v_mfma_f32_16x16x32_bf16 v[200:203], a[236:239], v[224:227], v[200:203]
    v_exp_f32 v163, v163
    v_mfma_f32_16x16x32_bf16 v[244:247], a[240:243], v[124:127], 0
    ds_read_b128 v[112:115], v0 offset:20736
    ds_read_b128 v[228:231], v1 offset:20736
    v_mfma_f32_16x16x32_bf16 v[244:247], a[244:247], v[240:243], v[244:247]
    v_cvt_pk_bf16_f32 v161, v162, v163
    v_mul_f32 v223, v132, v223
    v_mfma_f32_16x16x32_bf16 v[244:247], a[248:251], v[212:215], v[244:247]
    v_exp_f32 v204, v204
    v_mfma_f32_16x16x32_bf16 v[244:247], a[252:255], v[248:251], v[244:247]
    v_exp_f32 v205, v205
    v_mfma_f32_16x16x32_bf16 v[244:247], v[76:79], v[140:143], v[244:247]
    v_cvt_pk_bf16_f32 v162, v204, v205
    v_cvt_pk_bf16_f32 v195, v222, v223
    v_mfma_f32_16x16x32_bf16 v[244:247], v[80:83], v[224:227], v[244:247]
    s_waitcnt lgkmcnt(4)
    ds_write_b64 v4, v[194:195] offset:4096
    v_mfma_f32_16x16x32_bf16 v[132:135], v[84:87], v[124:127], 0
    s_waitcnt lgkmcnt(3)
    v_exp_f32 v206, v206
    v_mfma_f32_16x16x32_bf16 v[132:135], v[88:91], v[240:243], v[132:135]
    s_waitcnt lgkmcnt(2)
    v_exp_f32 v207, v207
    v_mfma_f32_16x16x32_bf16 v[132:135], v[92:95], v[212:215], v[132:135]
    s_waitcnt lgkmcnt(1)
    v_cvt_pk_bf16_f32 v163, v206, v207
    v_fma_f32 v233, v200, v200, s33
    v_mfma_f32_16x16x32_bf16 v[132:135], v[96:99], v[248:251], v[132:135]
    v_exp_f32 v120, v120
    v_mfma_f32_16x16x32_bf16 v[132:135], v[100:103], v[140:143], v[132:135]
    v_exp_f32 v121, v121
    v_mfma_f32_16x16x32_bf16 v[132:135], v[104:107], v[224:227], v[132:135]
    v_exp_f32 v122, v122
    v_mfma_f32_16x16x32_bf16 v[204:207], a[72:75], v[196:199], 0
    v_exp_f32 v123, v123
    v_mfma_f32_16x16x32_bf16 v[204:207], a[76:79], v[184:187], v[204:207]
    v_exp_f32 v177, v177
    v_mfma_f32_16x16x32_bf16 v[204:207], a[80:83], v[172:175], v[204:207]
    v_cvt_pk_bf16_f32 v194, v176, v177
    v_fmac_f32 v233, v201, v201
    v_mfma_f32_16x16x32_bf16 v[204:207], a[84:87], v[148:151], v[204:207]
    v_exp_f32 v178, v178
    v_mfma_f32_16x16x32_bf16 v[204:207], a[88:91], v[112:115], v[204:207]
    v_exp_f32 v179, v179
    v_mfma_f32_16x16x32_bf16 v[204:207], a[92:95], v[228:231], v[204:207]
    v_cvt_pk_bf16_f32 v195, v178, v179
    v_fmac_f32 v233, v202, v202
    v_mfma_f32_16x16x32_bf16 v[176:179], a[96:99], v[196:199], 0
    v_exp_f32 v168, v168
    v_mfma_f32_16x16x32_bf16 v[176:179], a[100:103], v[184:187], v[176:179]
    v_exp_f32 v169, v169
    v_mfma_f32_16x16x32_bf16 v[176:179], a[104:107], v[172:175], v[176:179]
    v_cvt_pk_bf16_f32 v36, v168, v169
    v_fmac_f32 v233, v203, v203
    v_mfma_f32_16x16x32_bf16 v[176:179], a[108:111], v[148:151], v[176:179]
    v_exp_f32 v170, v170
    v_mfma_f32_16x16x32_bf16 v[176:179], a[112:115], v[112:115], v[176:179]
    v_exp_f32 v171, v171
    v_mfma_f32_16x16x32_bf16 v[176:179], a[116:119], v[228:231], v[176:179]
    v_cvt_pk_bf16_f32 v37, v170, v171
    v_fmac_f32 v233, v244, v244
    v_mfma_f32_16x16x32_bf16 v[124:127], a[120:123], v[196:199], 0
    v_fmac_f32 v233, v245, v245
    v_fmac_f32 v233, v246, v246
    v_mfma_f32_16x16x32_bf16 v[168:171], v[28:31], v[36:39], 0
    v_fmac_f32 v233, v247, v247
    v_fmac_f32 v233, v132, v132
    v_mfma_f32_16x16x32_bf16 v[168:171], v[28:31], v[192:195], v[168:171]
    v_fmac_f32 v233, v133, v133
    v_fmac_f32 v233, v134, v134
    v_mfma_f32_16x16x32_bf16 v[140:143], v[116:119], v[36:39], 0
    v_fmac_f32 v233, v135, v135
    v_cvt_pk_bf16_f32 v235, v233, v233
    v_mfma_f32_16x16x32_bf16 v[140:143], v[128:131], v[192:195], v[140:143]
    ds_write_b64 v4, v[234:235] offset:18432
    v_mfma_f32_16x16x32_bf16 v[224:227], v[188:191], v[36:39], 0
    v_rcp_f32 v168, v168
    v_mfma_f32_16x16x32_bf16 v[224:227], v[164:167], v[192:195], v[224:227]
    v_fma_f32 v169, v204, v204, s32
    v_fmac_f32 v169, v205, v205
    v_mfma_f32_16x16x32_bf16 v[248:251], v[216:219], v[36:39], 0
    v_cvt_pk_bf16_f32 v36, v120, v121
    v_cvt_pk_bf16_f32 v37, v122, v123
    v_mfma_f32_16x16x32_bf16 v[248:251], v[144:147], v[192:195], v[248:251]
    v_cvt_pk_bf16_f32 v39, v232, 0
    v_mul_f32 v140, v168, v140
    v_mfma_f32_16x16x32_bf16 v[124:127], a[124:127], v[184:187], v[124:127]
    v_mul_f32 v141, v168, v141
    v_cvt_pk_bf16_f32 v192, v140, v141
    v_mfma_f32_16x16x32_bf16 v[120:123], v[28:31], v[36:39], 0
    v_mul_f32 v142, v168, v142
    v_mul_f32 v143, v168, v143
    v_mfma_f32_16x16x32_bf16 v[120:123], v[28:31], v[160:163], v[120:123]
    v_cvt_pk_bf16_f32 v193, v142, v143
    v_mul_f32 v224, v168, v224
    v_mfma_f32_16x16x32_bf16 v[140:143], v[116:119], v[36:39], 0
    v_mul_f32 v225, v168, v225
    v_cvt_pk_bf16_f32 v194, v224, v225
    v_mfma_f32_16x16x32_bf16 v[140:143], v[128:131], v[160:163], v[140:143]
    v_mul_f32 v226, v168, v226
    v_mul_f32 v227, v168, v227
    v_mfma_f32_16x16x32_bf16 v[128:131], v[188:191], v[36:39], 0
    v_cvt_pk_bf16_f32 v195, v226, v227
    v_mul_f32 v248, v168, v248
    v_mfma_f32_16x16x32_bf16 v[128:131], v[164:167], v[160:163], v[128:131]
    ds_write_b128 v3, v[192:195] offset:6144
    v_mfma_f32_16x16x32_bf16 v[164:167], v[216:219], v[36:39], 0
    v_mul_f32 v249, v168, v249
    v_cvt_pk_bf16_f32 v170, v248, v249
    v_mfma_f32_16x16x32_bf16 v[164:167], v[144:147], v[160:163], v[164:167]
    v_mul_f32 v250, v168, v250
    v_mul_f32 v251, v168, v251
    v_mfma_f32_16x16x32_bf16 v[124:127], a[128:131], v[172:175], v[124:127]
    v_cvt_pk_bf16_f32 v171, v250, v251
    v_fmac_f32 v169, v206, v206
    v_mfma_f32_16x16x32_bf16 v[124:127], a[132:135], v[148:151], v[124:127]
    ds_write_b64 v4, v[170:171] offset:10240
    v_mfma_f32_16x16x32_bf16 v[124:127], a[136:139], v[112:115], v[124:127]
    v_rcp_f32 v120, v120
    v_mfma_f32_16x16x32_bf16 v[124:127], a[140:143], v[228:231], v[124:127]
    v_mul_f32 v140, v120, v140
    v_mul_f32 v141, v120, v141
    v_mfma_f32_16x16x32_bf16 v[216:219], a[0:3], v[196:199], 0
    v_cvt_pk_bf16_f32 v144, v140, v141
    v_mul_f32 v142, v120, v142
    v_mfma_f32_16x16x32_bf16 v[216:219], a[4:7], v[184:187], v[216:219]
    v_mul_f32 v143, v120, v143
    v_cvt_pk_bf16_f32 v145, v142, v143
    v_mfma_f32_16x16x32_bf16 v[216:219], a[8:11], v[172:175], v[216:219]
    v_mul_f32 v128, v120, v128
    v_mul_f32 v129, v120, v129
    v_mfma_f32_16x16x32_bf16 v[216:219], a[12:15], v[148:151], v[216:219]
    v_cvt_pk_bf16_f32 v146, v128, v129
    v_mul_f32 v130, v120, v130
    v_mfma_f32_16x16x32_bf16 v[216:219], a[16:19], v[112:115], v[216:219]
    v_mul_f32 v131, v120, v131
    v_cvt_pk_bf16_f32 v147, v130, v131
    v_mfma_f32_16x16x32_bf16 v[216:219], a[20:23], v[228:231], v[216:219]
    ds_write_b128 v3, v[144:147] offset:12288
    v_mfma_f32_16x16x32_bf16 v[160:163], a[24:27], v[196:199], 0
    v_mul_f32 v164, v120, v164
    v_mul_f32 v165, v120, v165
    v_mfma_f32_16x16x32_bf16 v[160:163], a[28:31], v[184:187], v[160:163]
    v_cvt_pk_bf16_f32 v164, v164, v165
    v_mul_f32 v166, v120, v166
    v_mfma_f32_16x16x32_bf16 v[160:163], a[32:35], v[172:175], v[160:163]
    v_mul_f32 v167, v120, v167
    v_cvt_pk_bf16_f32 v165, v166, v167
    v_mfma_f32_16x16x32_bf16 v[160:163], a[36:39], v[148:151], v[160:163]
    ds_write_b64 v4, v[164:165] offset:16384
    v_mfma_f32_16x16x32_bf16 v[160:163], a[40:43], v[112:115], v[160:163]
    v_fmac_f32 v169, v207, v207
    v_fmac_f32 v169, v176, v176
    v_mfma_f32_16x16x32_bf16 v[160:163], a[44:47], v[228:231], v[160:163]
    v_fmac_f32 v169, v177, v177
    v_fmac_f32 v169, v178, v178
    v_mfma_f32_16x16x32_bf16 v[116:119], a[48:51], v[196:199], 0
    v_fmac_f32 v169, v179, v179
    v_fmac_f32 v169, v124, v124
    v_mfma_f32_16x16x32_bf16 v[116:119], a[52:55], v[184:187], v[116:119]
    v_fmac_f32 v169, v125, v125
    v_fmac_f32 v169, v126, v126
    v_mfma_f32_16x16x32_bf16 v[116:119], a[56:59], v[172:175], v[116:119]
    v_fmac_f32 v169, v127, v127
    v_fma_f32 v168, v216, v216, s32
    v_mfma_f32_16x16x32_bf16 v[116:119], a[60:63], v[148:151], v[116:119]
    v_fmac_f32 v168, v217, v217
    v_fmac_f32 v168, v218, v218
    v_mfma_f32_16x16x32_bf16 v[116:119], a[64:67], v[112:115], v[116:119]
    s_waitcnt lgkmcnt(0)
    v_fmac_f32 v168, v219, v219
    v_xor_b32 v3, 65536, v3
    v_mfma_f32_16x16x32_bf16 v[116:119], a[68:71], v[228:231], v[116:119]
    s_nop 0
    v_xor_b32 v4, 65536, v4
    v_mfma_f32_16x16x32_bf16 v[128:131], v[196:199], a[144:147], 0
    s_barrier
    v_mfma_f32_16x16x32_bf16 v[128:131], v[184:187], a[148:151], v[128:131]
    s_nop 0
    v_mfma_f32_16x16x32_bf16 v[128:131], v[172:175], a[152:155], v[128:131]
    s_nop 0
    v_mfma_f32_16x16x32_bf16 v[128:131], v[148:151], a[156:159], v[128:131]
    v_mfma_f32_16x16x32_bf16 v[128:131], v[112:115], a[160:163], v[128:131]
    v_mfma_f32_16x16x32_bf16 v[128:131], v[228:231], a[164:167], v[128:131]
    s_cbranch_scc1 L_loop_fast1
    s_branch L_drain
.p2align 6
L_loop_fast2:
    v_mfma_f32_16x16x32_bf16 v[164:167], v[196:199], a[168:171], 0
    s_add_u32 s12, s42, s27
    ds_read_b128 v[144:147], v2 offset:18432
    ds_read_b128 v[192:195], v2 offset:19456
    v_mfma_f32_16x16x32_bf16 v[164:167], v[184:187], a[172:175], v[164:167]
    s_addc_u32 s13, s43, 0
    v_fmac_f32 v168, v160, v160
    v_fmac_f32 v168, v161, v161
    v_mfma_f32_16x16x32_bf16 v[164:167], v[172:175], a[176:179], v[164:167]
    s_sub_u32 s14, s36, s27
    v_fmac_f32 v168, v162, v162
    v_fmac_f32 v168, v163, v163
    v_mfma_f32_16x16x32_bf16 v[164:167], v[148:151], a[180:183], v[164:167]
    s_cmp_ge_u32 s18, 2
    ds_read_b128 v[120:123], v0 offset:26624
    v_fmac_f32 v168, v116, v116
    v_mfma_f32_16x16x32_bf16 v[164:167], v[112:115], a[184:187], v[164:167]
    s_cselect_b32 s14, s14, 0
    ds_read_b128 v[188:191], v1 offset:26624
    v_fmac_f32 v168, v117, v117
    v_mfma_f32_16x16x32_bf16 v[164:167], v[228:231], a[188:191], v[164:167]
    s_add_u32 s34, s18, 2
    ds_read_b128 v[248:251], v0 offset:26752
    v_fmac_f32 v168, v118, v118
    v_mfma_f32_16x16x32_bf16 v[140:143], v[196:199], a[192:195], 0
    s_add_u32 s8, s40, s23
    ds_read_b128 v[224:227], v1 offset:26752
    v_fmac_f32 v168, v119, v119
    v_mfma_f32_16x16x32_bf16 v[140:143], v[184:187], a[196:199], v[140:143]
    s_addc_u32 s9, s41, 0
    ds_read_b128 v[184:187], v0 offset:26880
    v_cvt_pk_bf16_f32 v36, v168, v169
    v_mfma_f32_16x16x32_bf16 v[140:143], v[172:175], a[200:203], v[140:143]
    s_waitcnt lgkmcnt(5)
    ds_read_b128 v[172:175], v1 offset:26880
    v_cvt_pk_bf16_f32 v128, v128, v129
    v_mfma_f32_16x16x32_bf16 v[168:171], v[32:35], v[36:39], 0
    s_sub_u32 s10, s36, s23
    v_cvt_pk_bf16_f32 v129, v130, v131
    v_cvt_pk_bf16_f32 v164, v164, v165
    v_mfma_f32_16x16x32_bf16 v[240:243], v[32:35], v[144:147], 0
    s_cmp_lt_u32 s34, s17
    v_cvt_pk_bf16_f32 v165, v166, v167
    s_cselect_b32 s10, s10, 0
    v_mfma_f32_16x16x32_bf16 v[240:243], v[32:35], v[192:195], v[240:243]
    s_waitcnt lgkmcnt(5)
    v_rsq_f32 v169, v169
    v_mfma_f32_16x16x32_bf16 v[140:143], v[148:151], a[204:207], v[140:143]
    s_add_u32 m0, s28, 0
    v_rsq_f32 v168, v168
    v_mfma_f32_16x16x32_bf16 v[140:143], v[112:115], a[208:211], v[140:143]
    s_mov_b32 s27, s26
    v_mul_f32 v168, s31, v168
    v_mul_f32 v204, v169, v204
    v_mfma_f32_16x16x32_bf16 v[140:143], v[228:231], a[212:215], v[140:143]
    s_mov_b32 s26, s25
    v_mul_f32 v205, v169, v205
    v_cvt_pk_bf16_f32 v204, v204, v205
    v_mfma_f32_16x16x32_bf16 v[112:115], a[72:75], v[120:123], 0
    s_waitcnt lgkmcnt(1)
    v_mul_f32 v206, v169, v206
    v_mul_f32 v207, v169, v207
    v_mfma_f32_16x16x32_bf16 v[112:115], a[76:79], v[188:191], v[112:115]
    s_mov_b32 s25, s24
    v_cvt_pk_bf16_f32 v144, v140, v141
    v_cvt_pk_bf16_f32 v145, v142, v143
    v_mfma_f32_16x16x32_bf16 v[112:115], a[80:83], v[248:251], v[112:115]
    s_mov_b32 s24, s23
    v_cvt_pk_bf16_f32 v205, v206, v207
    v_mul_f32 v176, v169, v176
    v_mfma_f32_16x16x32_bf16 v[112:115], a[84:87], v[224:227], v[112:115]
    s_waitcnt lgkmcnt(0)
    v_mul_f32 v177, v169, v177
    v_cvt_pk_bf16_f32 v206, v176, v177
    v_mfma_f32_16x16x32_bf16 v[112:115], a[88:91], v[184:187], v[112:115]
    v_mul_f32 v178, v169, v178
    v_mul_f32 v179, v169, v179
    v_mfma_f32_16x16x32_bf16 v[112:115], a[92:95], v[172:175], v[112:115]
    v_cvt_pk_bf16_f32 v207, v178, v179
    v_mul_f32 v124, v169, v124
    v_mfma_f32_16x16x32_bf16 v[148:151], a[96:99], v[120:123], 0
    v_mul_f32 v125, v169, v125
    v_cvt_pk_bf16_f32 v194, v124, v125
    v_mfma_f32_16x16x32_bf16 v[148:151], a[100:103], v[188:191], v[148:151]
    v_mul_f32 v126, v169, v126
    v_mul_f32 v127, v169, v127
    v_mfma_f32_16x16x32_bf16 v[148:151], a[104:107], v[248:251], v[148:151]
    v_cvt_pk_bf16_f32 v195, v126, v127
    v_mul_f32 v216, v168, v216
    v_mfma_f32_16x16x32_bf16 v[148:151], a[108:111], v[224:227], v[148:151]
    v_mul_f32 v217, v168, v217
    v_cvt_pk_bf16_f32 v196, v216, v217
    v_mfma_f32_16x16x32_bf16 v[148:151], a[112:115], v[184:187], v[148:151]
    v_mul_f32 v218, v168, v218
    v_mul_f32 v219, v168, v219
    v_mfma_f32_16x16x32_bf16 v[148:151], a[116:119], v[172:175], v[148:151]
    v_cvt_pk_bf16_f32 v197, v218, v219
    v_mul_f32 v160, v168, v160
    v_mfma_f32_16x16x32_bf16 v[228:231], a[120:123], v[120:123], 0
    v_mul_f32 v161, v168, v161
    v_cvt_pk_bf16_f32 v198, v160, v161
    v_mfma_f32_16x16x32_bf16 v[228:231], a[124:127], v[188:191], v[228:231]
    v_mul_f32 v162, v168, v162
    v_mul_f32 v163, v168, v163
    v_mfma_f32_16x16x32_bf16 v[228:231], a[128:131], v[248:251], v[228:231]
    v_cvt_pk_bf16_f32 v199, v162, v163
    v_mul_f32 v116, v168, v116
    v_mfma_f32_16x16x32_bf16 v[228:231], a[132:135], v[224:227], v[228:231]
    v_mul_f32 v117, v168, v117
    v_cvt_pk_bf16_f32 v192, v116, v117
    v_mfma_f32_16x16x32_bf16 v[228:231], a[136:139], v[184:187], v[228:231]
    v_mul_f32 v118, v168, v118
    v_mul_f32 v119, v168, v119
    v_mfma_f32_16x16x32_bf16 v[228:231], a[140:143], v[172:175], v[228:231]
    v_cvt_pk_bf16_f32 v193, v118, v119
    v_fma_f32 v130, v112, v112, s32
    v_mfma_f32_16x16x32_bf16 v[212:215], a[0:3], v[120:123], 0
    v_fmac_f32 v130, v113, v113
    v_fmac_f32 v130, v114, v114
    v_mfma_f32_16x16x32_bf16 v[212:215], a[4:7], v[188:191], v[212:215]
    v_fmac_f32 v130, v115, v115
    v_fmac_f32 v130, v148, v148
    v_mfma_f32_16x16x32_bf16 v[212:215], a[8:11], v[248:251], v[212:215]
    v_fmac_f32 v130, v149, v149
    v_fmac_f32 v130, v150, v150
    v_mfma_f32_16x16x32_bf16 v[212:215], a[12:15], v[224:227], v[212:215]
    v_fmac_f32 v130, v151, v151
    v_fmac_f32 v130, v228, v228
    v_mfma_f32_16x16x32_bf16 v[212:215], a[16:19], v[184:187], v[212:215]
    v_fmac_f32 v130, v229, v229
    v_fmac_f32 v130, v230, v230
    v_mfma_f32_16x16x32_bf16 v[212:215], a[20:23], v[172:175], v[212:215]
    v_fmac_f32 v130, v231, v231
    v_mul_f32 v142, 0x3baaaaab, v240
    v_mfma_f32_16x16x32_bf16 v[232:235], a[24:27], v[120:123], 0
    v_rsq_f32 v142, v142
    v_mfma_f32_16x16x32_bf16 v[232:235], a[28:31], v[188:191], v[232:235]
    v_mul_f32 v147, 0x3baaaaab, v241
    v_mul_f32 v146, 0x3baaaaab, v242
    v_mfma_f32_16x16x32_bf16 v[232:235], a[32:35], v[248:251], v[232:235]
    v_fma_f32 v131, v212, v212, s32
    v_fmac_f32 v131, v213, v213
    v_mfma_f32_16x16x32_bf16 v[232:235], a[36:39], v[224:227], v[232:235]
    v_fmac_f32 v131, v214, v214
    v_fmac_f32 v131, v215, v215
    v_mfma_f32_16x16x32_bf16 v[232:235], a[40:43], v[184:187], v[232:235]
    v_rsq_f32 v147, v147
    v_mfma_f32_16x16x32_bf16 v[232:235], a[44:47], v[172:175], v[232:235]
    v_mul_f32 v136, v147, v136
    v_mul_f32 v137, v147, v137
    v_mfma_f32_16x16x32_bf16 v[240:243], a[48:51], v[120:123], 0
    v_cvt_pk_bf16_f32 v176, v136, v137
    v_mul_f32 v138, v147, v138
    v_mfma_f32_16x16x32_bf16 v[240:243], a[52:55], v[188:191], v[240:243]
    v_mul_f32 v139, v147, v139
    v_cvt_pk_bf16_f32 v177, v138, v139
    v_mfma_f32_16x16x32_bf16 v[240:243], a[56:59], v[248:251], v[240:243]
    v_fmac_f32 v131, v232, v232
    v_fmac_f32 v131, v233, v233
    v_mfma_f32_16x16x32_bf16 v[240:243], a[60:63], v[224:227], v[240:243]
    v_fmac_f32 v131, v234, v234
    v_fmac_f32 v131, v235, v235
    v_mfma_f32_16x16x32_bf16 v[240:243], a[64:67], v[184:187], v[240:243]
    v_mul_f32 v208, v147, v208
    v_mul_f32 v209, v147, v209
    v_mfma_f32_16x16x32_bf16 v[240:243], a[68:71], v[172:175], v[240:243]
    v_cvt_pk_bf16_f32 v178, v208, v209
    v_mul_f32 v210, v147, v210
    v_mfma_f32_16x16x32_bf16 v[216:219], v[120:123], a[144:147], 0
    v_mul_f32 v211, v147, v211
    v_cvt_pk_bf16_f32 v179, v210, v211
    v_mfma_f32_16x16x32_bf16 v[216:219], v[188:191], a[148:151], v[216:219]
    buffer_store_dwordx4 v[176:179], v16, s[12:15], 0 offen
    v_mul_f32 v156, v147, v156
    v_fmac_f32 v131, v240, v240
    v_fmac_f32 v131, v241, v241
    v_fmac_f32 v131, v242, v242
    v_mfma_f32_16x16x32_bf16 v[216:219], v[248:251], a[152:155], v[216:219]
    v_fmac_f32 v131, v243, v243
    v_cvt_pk_bf16_f32 v36, v131, v130
    v_mfma_f32_16x16x32_bf16 v[216:219], v[224:227], a[156:159], v[216:219]
    v_mul_f32 v157, v147, v157
    v_cvt_pk_bf16_f32 v118, v156, v157
    v_mfma_f32_16x16x32_bf16 v[136:139], v[32:35], v[36:39], 0
    v_mul_f32 v158, v147, v158
    v_mul_f32 v159, v147, v159
    v_mfma_f32_16x16x32_bf16 v[216:219], v[184:187], a[160:163], v[216:219]
    v_cvt_pk_bf16_f32 v119, v158, v159
    v_mul_f32 v180, v142, v180
    v_mfma_f32_16x16x32_bf16 v[216:219], v[172:175], a[164:167], v[216:219]
    v_rsq_f32 v146, v146
    v_mfma_f32_16x16x32_bf16 v[168:171], v[120:123], a[168:171], 0
    v_mul_f32 v200, v146, v200
    v_mul_f32 v201, v146, v201
    v_mfma_f32_16x16x32_bf16 v[168:171], v[188:191], a[172:175], v[168:171]
    v_cvt_pk_bf16_f32 v200, v200, v201
    v_mul_f32 v202, v146, v202
    v_mfma_f32_16x16x32_bf16 v[168:171], v[248:251], a[176:179], v[168:171]
    v_cvt_pk_bf16_f32 v130, v216, v217
    v_cvt_pk_bf16_f32 v131, v218, v219
    v_mfma_f32_16x16x32_bf16 v[168:171], v[224:227], a[180:183], v[168:171]
    ds_read_b128 v[176:179], v0 offset:32768
    v_mul_f32 v203, v146, v203
    v_mfma_f32_16x16x32_bf16 v[168:171], v[184:187], a[184:187], v[168:171]
    ds_read_b128 v[160:163], v1 offset:32768
    v_cvt_pk_bf16_f32 v201, v202, v203
    v_mfma_f32_16x16x32_bf16 v[168:171], v[172:175], a[188:191], v[168:171]
    ds_read_b128 v[208:211], v0 offset:32896
    v_mul_f32 v244, v146, v244
    v_mfma_f32_16x16x32_bf16 v[156:159], v[120:123], a[192:195], 0
    ds_read_b128 v[216:219], v1 offset:32896
    v_mul_f32 v245, v146, v245
    v_mfma_f32_16x16x32_bf16 v[156:159], v[188:191], a[196:199], v[156:159]
    ds_read_b128 v[124:127], v0 offset:33024
    v_cvt_pk_bf16_f32 v202, v244, v245
    v_mfma_f32_16x16x32_bf16 v[156:159], v[248:251], a[200:203], v[156:159]
    ds_read_b128 v[120:123], v1 offset:33024
    v_mul_f32 v246, v146, v246
    v_mfma_f32_16x16x32_bf16 v[156:159], v[224:227], a[204:207], v[156:159]
    v_mul_f32 v247, v146, v247
    v_cvt_pk_bf16_f32 v203, v246, v247
    v_mfma_f32_16x16x32_bf16 v[156:159], v[184:187], a[208:211], v[156:159]
    v_mul_f32 v132, v146, v132
    v_mul_f32 v133, v146, v133
    v_mfma_f32_16x16x32_bf16 v[156:159], v[172:175], a[212:215], v[156:159]
    s_waitcnt lgkmcnt(5)
    buffer_store_dwordx4 v[200:203], v17, s[12:15], 0 offen
    v_cvt_pk_bf16_f32 v116, v132, v133
    v_mul_f32 v134, v146, v134
    v_mul_f32 v135, v146, v135
    v_cvt_pk_bf16_f32 v117, v134, v135
    v_mfma_f32_16x16x32_bf16 v[200:203], a[72:75], v[176:179], 0
    s_waitcnt lgkmcnt(3)
    v_rsq_f32 v137, v137
    v_mfma_f32_16x16x32_bf16 v[200:203], a[76:79], v[160:163], v[200:203]
    s_waitcnt lgkmcnt(2)
    v_rsq_f32 v136, v136
    v_mfma_f32_16x16x32_bf16 v[200:203], a[80:83], v[208:211], v[200:203]
    s_waitcnt lgkmcnt(1)
    v_mul_f32 v136, s31, v136
    v_cvt_pk_bf16_f32 v166, v168, v169
    v_mfma_f32_16x16x32_bf16 v[200:203], a[84:87], v[216:219], v[200:203]
    s_waitcnt lgkmcnt(0)
    v_cvt_pk_bf16_f32 v167, v170, v171
    v_cvt_pk_bf16_f32 v146, v156, v157
    v_mfma_f32_16x16x32_bf16 v[200:203], a[88:91], v[124:127], v[200:203]
    v_cvt_pk_bf16_f32 v147, v158, v159
    v_mul_f32 v112, v137, v112
    v_mfma_f32_16x16x32_bf16 v[200:203], a[92:95], v[120:123], v[200:203]
    v_mul_f32 v113, v137, v113
    v_cvt_pk_bf16_f32 v184, v112, v113
    v_mfma_f32_16x16x32_bf16 v[168:171], a[96:99], v[176:179], 0
    v_mul_f32 v114, v137, v114
    v_mul_f32 v115, v137, v115
    v_mfma_f32_16x16x32_bf16 v[168:171], a[100:103], v[160:163], v[168:171]
    v_cvt_pk_bf16_f32 v185, v114, v115
    v_mul_f32 v148, v137, v148
    v_mfma_f32_16x16x32_bf16 v[168:171], a[104:107], v[208:211], v[168:171]
    v_mul_f32 v149, v137, v149
    v_cvt_pk_bf16_f32 v186, v148, v149
    v_mfma_f32_16x16x32_bf16 v[168:171], a[108:111], v[216:219], v[168:171]
    v_mul_f32 v150, v137, v150
    v_mul_f32 v151, v137, v151
    v_mfma_f32_16x16x32_bf16 v[168:171], a[112:115], v[124:127], v[168:171]
    s_waitcnt vmcnt(2)
    v_cvt_pk_bf16_f32 v187, v150, v151
    v_mul_f32 v228, v137, v228
    v_mfma_f32_16x16x32_bf16 v[168:171], a[116:119], v[120:123], v[168:171]
    s_nop 0
    v_mul_f32 v229, v137, v229
    v_cvt_pk_bf16_f32 v174, v228, v229
    v_mfma_f32_16x16x32_bf16 v[112:115], a[120:123], v[176:179], 0
    s_nop 0
    v_mul_f32 v230, v137, v230
    v_mul_f32 v231, v137, v231
    v_mfma_f32_16x16x32_bf16 v[112:115], a[124:127], v[160:163], v[112:115]
    s_barrier
    v_cvt_pk_bf16_f32 v175, v230, v231
    v_mul_f32 v212, v136, v212
    v_mfma_f32_16x16x32_bf16 v[112:115], a[128:131], v[208:211], v[112:115]
    s_nop 0
    v_mul_f32 v213, v136, v213
    v_cvt_pk_bf16_f32 v132, v212, v213
    v_mfma_f32_16x16x32_bf16 v[112:115], a[132:135], v[216:219], v[112:115]
    v_mul_f32 v214, v136, v214
    v_mul_f32 v215, v136, v215
    v_mfma_f32_16x16x32_bf16 v[112:115], a[136:139], v[124:127], v[112:115]
    buffer_load_dwordx4 v10, s[8:11], 0 offen nt lds
    v_cvt_pk_bf16_f32 v133, v214, v215
    v_mfma_f32_16x16x32_bf16 v[112:115], a[140:143], v[120:123], v[112:115]
    s_add_u32 m0, s28, 4096
    v_mul_f32 v232, v136, v232
    v_mul_f32 v233, v136, v233
    v_mfma_f32_16x16x32_bf16 v[188:191], a[0:3], v[176:179], 0
    v_cvt_pk_bf16_f32 v134, v232, v233
    v_mul_f32 v234, v136, v234
    v_mfma_f32_16x16x32_bf16 v[188:191], a[4:7], v[160:163], v[188:191]
    v_mul_f32 v235, v136, v235
    v_cvt_pk_bf16_f32 v135, v234, v235
    v_mfma_f32_16x16x32_bf16 v[188:191], a[8:11], v[208:211], v[188:191]
    v_mul_f32 v240, v136, v240
    v_mul_f32 v241, v136, v241
    v_mfma_f32_16x16x32_bf16 v[188:191], a[12:15], v[216:219], v[188:191]
    buffer_load_dwordx4 v11, s[8:11], 0 offen nt lds
    v_cvt_pk_bf16_f32 v172, v240, v241
    v_mfma_f32_16x16x32_bf16 v[188:191], a[16:19], v[124:127], v[188:191]
    s_add_u32 m0, s28, 8192
    v_mul_f32 v242, v136, v242
    v_mul_f32 v243, v136, v243
    v_mfma_f32_16x16x32_bf16 v[188:191], a[20:23], v[120:123], v[188:191]
    v_cvt_pk_bf16_f32 v173, v242, v243
    v_fma_f32 v140, v200, v200, s32
    v_mfma_f32_16x16x32_bf16 v[136:139], a[24:27], v[176:179], 0
    v_fmac_f32 v140, v201, v201
    v_fmac_f32 v140, v202, v202
    v_mfma_f32_16x16x32_bf16 v[136:139], a[28:31], v[160:163], v[136:139]
    v_fmac_f32 v140, v203, v203
    v_fmac_f32 v140, v168, v168
    v_mfma_f32_16x16x32_bf16 v[136:139], a[32:35], v[208:211], v[136:139]
    buffer_load_dwordx4 v12, s[8:11], 0 offen nt lds
    v_fma_f32 v141, v188, v188, s32
    v_mfma_f32_16x16x32_bf16 v[136:139], a[36:39], v[216:219], v[136:139]
    s_add_u32 m0, s28, 12288
    v_fmac_f32 v141, v189, v189
    v_fmac_f32 v141, v190, v190
    v_mfma_f32_16x16x32_bf16 v[136:139], a[40:43], v[124:127], v[136:139]
    s_xor_b32 s28, s28, 65536
    v_fmac_f32 v141, v191, v191
    v_fmac_f32 v140, v169, v169
    v_mfma_f32_16x16x32_bf16 v[136:139], a[44:47], v[120:123], v[136:139]
    v_fmac_f32 v140, v170, v170
    v_fmac_f32 v140, v171, v171
    v_mfma_f32_16x16x32_bf16 v[148:151], a[48:51], v[176:179], 0
    v_fmac_f32 v140, v112, v112
    v_fmac_f32 v140, v113, v113
    v_mfma_f32_16x16x32_bf16 v[148:151], a[52:55], v[160:163], v[148:151]
    buffer_load_dwordx4 v13, s[8:11], 0 offen nt lds
    v_fmac_f32 v140, v114, v114
    v_mfma_f32_16x16x32_bf16 v[148:151], a[56:59], v[208:211], v[148:151]
    s_mov_b32 m0, s29
    v_fmac_f32 v141, v136, v136
    v_fmac_f32 v141, v137, v137
    v_mfma_f32_16x16x32_bf16 v[148:151], a[60:63], v[216:219], v[148:151]
    s_xor_b32 s29, s29, s30
    v_fmac_f32 v141, v138, v138
    v_fmac_f32 v141, v139, v139
    v_mfma_f32_16x16x32_bf16 v[148:151], a[64:67], v[124:127], v[148:151]
    s_add_u32 s19, s19, s20
    v_fmac_f32 v140, v115, v115
    v_mul_f32 v181, v142, v181
    v_mfma_f32_16x16x32_bf16 v[148:151], a[68:71], v[120:123], v[148:151]
    s_add_u32 s23, s23, s21
    v_cvt_pk_bf16_f32 v156, v180, v181
    v_mul_f32 v182, v142, v182
    v_mfma_f32_16x16x32_bf16 v[220:223], v[176:179], a[144:147], 0
    s_cmp_ge_u32 s19, 72
    ds_read_b128 v[212:215], v5 offset:0
    ds_read_b128 v[224:227], v5 offset:16
    v_mfma_f32_16x16x32_bf16 v[220:223], v[160:163], a[148:151], v[220:223]
    s_cselect_b32 s34, 72, 0
    ds_read_b128 v[228:231], v5 offset:48
    ds_read_b32 v143, v6 offset:192
    v_mfma_f32_16x16x32_bf16 v[220:223], v[208:211], a[152:155], v[220:223]
    s_cselect_b32 s35, s22, 0
    buffer_store_dwordx2 v[116:117], v20, s[12:15], 0 offen
    v_fmac_f32 v141, v148, v148
    v_fmac_f32 v141, v149, v149
    v_mfma_f32_16x16x32_bf16 v[220:223], v[216:219], a[156:159], v[220:223]
    s_sub_u32 s19, s19, s34
    v_fmac_f32 v141, v150, v150
    v_fmac_f32 v141, v151, v151
    v_mfma_f32_16x16x32_bf16 v[220:223], v[124:127], a[160:163], v[220:223]
    s_add_u32 s23, s23, s35
    v_cvt_pk_bf16_f32 v36, v141, v140
    v_mul_f32 v183, v142, v183
    v_mfma_f32_16x16x32_bf16 v[220:223], v[120:123], a[164:167], v[220:223]
    s_add_u32 s18, s18, 1
    v_cvt_pk_bf16_f32 v157, v182, v183
    v_mul_f32 v108, v142, v108
    v_mfma_f32_16x16x32_bf16 v[180:183], v[32:35], v[36:39], 0
    s_cmp_lt_u32 s18, s17
    v_mul_f32 v109, v142, v109
    v_cvt_pk_bf16_f32 v158, v108, v109
    v_mfma_f32_16x16x32_bf16 v[232:235], v[176:179], a[168:171], 0
    s_waitcnt lgkmcnt(3)
    v_cvt_pk_bf16_f32 v116, v220, v221
    v_cvt_pk_bf16_f32 v117, v222, v223
    v_mfma_f32_16x16x32_bf16 v[220:223], v[212:215], v[196:199], v[22:25]
    s_waitcnt lgkmcnt(1)
    v_rsq_f32 v181, v181
    v_mfma_f32_16x16x32_bf16 v[220:223], v[224:227], v[204:207], v[220:223]
    s_waitcnt lgkmcnt(0)
    v_rsq_f32 v180, v180
    v_mfma_f32_16x16x32_bf16 v[220:223], v[228:231], v[192:195], v[220:223]
    v_mul_f32 v180, s31, v180
    v_mul_f32 v200, v181, v200
    v_mfma_f32_16x16x32_bf16 v[236:239], v[212:215], v[132:135], v[24:27]
    v_mul_f32 v201, v181, v201
    v_cvt_pk_bf16_f32 v200, v200, v201
    v_mfma_f32_16x16x32_bf16 v[236:239], v[224:227], v[184:187], v[236:239]
    v_mul_f32 v202, v181, v202
    v_mul_f32 v203, v181, v203
    v_mfma_f32_16x16x32_bf16 v[236:239], v[228:231], v[172:175], v[236:239]
    v_mov_b32_dpp v143, v221 quad_perm:[0,1,2,3] row_mask:0x1 bank_mask:0xf
    v_cvt_pk_bf16_f32 v201, v202, v203
    v_mfma_f32_16x16x32_bf16 v[232:235], v[160:163], a[172:175], v[232:235]
    v_mul_f32 v168, v181, v168
    v_mul_f32 v169, v181, v169
    v_mfma_f32_16x16x32_bf16 v[232:235], v[208:211], a[176:179], v[232:235]
    v_cvt_pk_bf16_f32 v202, v168, v169
    v_mul_f32 v170, v181, v170
    v_mfma_f32_16x16x32_bf16 v[232:235], v[216:219], a[180:183], v[232:235]
    v_mul_f32 v171, v181, v171
    v_cvt_pk_bf16_f32 v203, v170, v171
    v_mfma_f32_16x16x32_bf16 v[240:243], v[204:207], v[196:199], v[40:43]
    v_mul_f32 v112, v181, v112
    v_mul_f32 v113, v181, v113
    v_mfma_f32_16x16x32_bf16 v[248:251], v[184:187], v[196:199], v[44:47]
    v_cvt_pk_bf16_f32 v246, v112, v113
    v_mul_f32 v114, v181, v114
    v_mfma_f32_16x16x32_bf16 v[168:171], v[200:203], v[196:199], v[48:51]
    buffer_store_dwordx2 v[118:119], v19, s[12:15], 0 offen
    v_mul_f32 v115, v181, v115
    v_cvt_pk_bf16_f32 v247, v114, v115
    v_mfma_f32_16x16x16_bf16 v[240:243], v[194:195], v[192:193], v[240:243]
    v_mul_f32 v188, v180, v188
    v_mul_f32 v189, v180, v189
    v_cvt_pk_bf16_f32 v196, v188, v189
    v_mfma_f32_16x16x16_bf16 v[248:251], v[174:175], v[192:193], v[248:251]
    v_mul_f32 v190, v180, v190
    v_mul_f32 v191, v180, v191
    v_cvt_pk_bf16_f32 v197, v190, v191
    v_mfma_f32_16x16x16_bf16 v[168:171], v[246:247], v[192:193], v[168:171]
    v_mul_f32 v136, v180, v136
    v_mul_f32 v137, v180, v137
    v_cvt_pk_bf16_f32 v198, v136, v137
    v_mul_f32 v138, v180, v138
    v_mfma_f32_16x16x32_bf16 v[232:235], v[124:127], a[184:187], v[232:235]
    v_mul_f32 v139, v180, v139
    v_cvt_pk_bf16_f32 v199, v138, v139
    v_mfma_f32_16x16x32_bf16 v[232:235], v[120:123], a[188:191], v[232:235]
    v_mul_f32 v148, v180, v148
    v_mul_f32 v149, v180, v149
    v_mfma_f32_16x16x32_bf16 v[112:115], v[176:179], a[192:195], 0
    ds_read_b128 v[176:179], v2 offset:0
    v_cvt_pk_bf16_f32 v244, v148, v149
    v_mfma_f32_16x16x32_bf16 v[112:115], v[160:163], a[196:199], v[112:115]
    ds_read_b128 v[160:163], v2 offset:1024
    v_mul_f32 v150, v180, v150
    v_mfma_f32_16x16x32_bf16 v[112:115], v[208:211], a[200:203], v[112:115]
    ds_read_b128 v[136:139], v2 offset:2048
    v_cvt_pk_bf16_f32 v188, v232, v233
    v_mfma_f32_16x16x32_bf16 v[112:115], v[216:219], a[204:207], v[112:115]
    ds_read_b128 v[208:211], v2 offset:3072
    v_cvt_pk_bf16_f32 v189, v234, v235
    v_mfma_f32_16x16x32_bf16 v[112:115], v[124:127], a[208:211], v[112:115]
    ds_read_b128 v[124:127], v2 offset:4096
    ds_read2_b32 v[118:119], v6 offset0:0 offset1:0
    v_mfma_f32_16x16x32_bf16 v[112:115], v[120:123], a[212:215], v[112:115]
    ds_read_b128 v[120:123], v2 offset:5120
    ds_read2_b32 v[190:191], v6 offset0:16 offset1:16
    v_mfma_f32_16x16x32_bf16 v[232:235], v[212:215], v[196:199], v[26:29]
    v_mul_f32 v151, v180, v151
    v_cvt_pk_bf16_f32 v245, v150, v151
    v_mfma_f32_16x16x32_bf16 v[232:235], v[224:227], v[200:203], v[232:235]
    ds_read2_b32 v[218:219], v6 offset0:32 offset1:32
    v_mov_b32_dpp v143, v237 quad_perm:[0,1,2,3] row_mask:0x2 bank_mask:0xf
    v_mfma_f32_16x16x32_bf16 v[232:235], v[228:231], v[244:247], v[232:235]
    s_waitcnt lgkmcnt(8)
    v_cvt_pk_bf16_f32 v216, v112, v113
    v_cvt_pk_bf16_f32 v217, v114, v115
    v_mfma_f32_16x16x32_bf16 v[180:183], a[216:219], v[176:179], 0
    s_waitcnt lgkmcnt(7)
    v_mul_f32 v110, v142, v110
    v_mul_f32 v111, v142, v111
    v_mfma_f32_16x16x32_bf16 v[180:183], a[220:223], v[160:163], v[180:183]
    s_waitcnt lgkmcnt(6)
    v_cvt_pk_bf16_f32 v159, v110, v111
    v_mul_f32 v152, v142, v152
    v_mfma_f32_16x16x32_bf16 v[180:183], a[224:227], v[136:139], v[180:183]
    s_waitcnt lgkmcnt(5)
    buffer_store_dwordx4 v[156:159], v15, s[12:15], 0 offen
    v_mul_f32 v153, v142, v153
    v_cvt_pk_bf16_f32 v192, v152, v153
    v_mul_f32 v154, v142, v154
    v_mul_f32 v155, v142, v155
    v_mfma_f32_16x16x32_bf16 v[180:183], a[228:231], v[208:211], v[180:183]
    s_waitcnt lgkmcnt(1)
    v_cvt_pk_bf16_f32 v193, v154, v155
    v_mov_b32_dpp v143, v233 quad_perm:[0,1,2,3] row_mask:0x4 bank_mask:0xf
    v_mfma_f32_16x16x32_bf16 v[180:183], a[232:235], v[124:127], v[180:183]
    v_exp_f32 v232, v232
    v_mfma_f32_16x16x32_bf16 v[180:183], a[236:239], v[120:123], v[180:183]
    s_waitcnt lgkmcnt(0)
    v_exp_f32 v143, v143
    v_mfma_f32_16x16x32_bf16 v[108:111], a[240:243], v[176:179], 0
    v_cvt_pk_bf16_f32 v143, v143, v143
    v_add_u32 v5, 336, v5
    v_mfma_f32_16x16x32_bf16 v[108:111], a[244:247], v[160:163], v[108:111]
    ds_write_b16 v8, v143
    v_mfma_f32_16x16x32_bf16 v[108:111], a[248:251], v[136:139], v[108:111]
    v_exp_f32 v236, v236
    v_mfma_f32_16x16x32_bf16 v[108:111], a[252:255], v[208:211], v[108:111]
    ds_read_b128 v[140:143], v2 offset:6144
    ds_read_b128 v[224:227], v2 offset:7168
    v_mfma_f32_16x16x32_bf16 v[108:111], v[76:79], v[124:127], v[108:111]
    ds_read_b128 v[112:115], v2 offset:8192
    v_fma_f32 v221, v180, v180, s33
    v_mfma_f32_16x16x32_bf16 v[108:111], v[80:83], v[120:123], v[108:111]
    ds_read_b128 v[148:151], v2 offset:9216
    v_fmac_f32 v221, v181, v181
    v_mfma_f32_16x16x32_bf16 v[152:155], v[84:87], v[176:179], 0
    ds_read_b128 v[176:179], v2 offset:10240
    v_fmac_f32 v221, v182, v182
    v_mfma_f32_16x16x32_bf16 v[152:155], v[88:91], v[160:163], v[152:155]
    ds_read_b128 v[160:163], v2 offset:11264
    v_fmac_f32 v221, v183, v183
    v_mfma_f32_16x16x32_bf16 v[152:155], v[92:95], v[136:139], v[152:155]
    v_exp_f32 v240, v240
    v_mfma_f32_16x16x32_bf16 v[152:155], v[96:99], v[208:211], v[152:155]
    v_exp_f32 v241, v241
    v_mfma_f32_16x16x32_bf16 v[152:155], v[100:103], v[124:127], v[152:155]
    ds_read_b128 v[124:127], v9
    ds_read_b128 v[208:211], v9 offset:64
    v_mfma_f32_16x16x32_bf16 v[152:155], v[104:107], v[120:123], v[152:155]
    s_waitcnt lgkmcnt(6)
    v_cvt_pk_bf16_f32 v120, v240, v241
    v_fmac_f32 v221, v108, v108
    v_mfma_f32_16x16x32_bf16 v[136:139], a[216:219], v[140:143], 0
    s_waitcnt lgkmcnt(5)
    v_exp_f32 v242, v242
    v_mfma_f32_16x16x32_bf16 v[136:139], a[220:223], v[224:227], v[136:139]
    s_waitcnt lgkmcnt(4)
    buffer_store_dwordx2 v[192:193], v18, s[12:15], 0 offen
    v_exp_f32 v243, v243
    v_mfma_f32_16x16x32_bf16 v[136:139], a[224:227], v[112:115], v[136:139]
    s_waitcnt lgkmcnt(2)
    v_cvt_pk_bf16_f32 v121, v242, v243
    v_fmac_f32 v221, v109, v109
    v_mfma_f32_16x16x32_bf16 v[136:139], a[228:231], v[148:151], v[136:139]
    v_exp_f32 v248, v248
    v_mfma_f32_16x16x32_bf16 v[136:139], a[232:235], v[176:179], v[136:139]
    v_exp_f32 v249, v249
    v_mfma_f32_16x16x32_bf16 v[136:139], a[236:239], v[160:163], v[136:139]
    s_waitcnt lgkmcnt(1)
    v_cvt_pk_bf16_f32 v122, v248, v249
    v_fmac_f32 v221, v110, v110
    v_mfma_f32_16x16x32_bf16 v[240:243], v[124:127], v[28:31], 0
    s_waitcnt lgkmcnt(0)
    v_exp_f32 v250, v250
    v_mfma_f32_16x16x32_bf16 v[240:243], v[208:211], v[28:31], v[240:243]
    v_exp_f32 v251, v251
    v_mfma_f32_16x16x32_bf16 v[228:231], v[124:127], v[128:131], 0
    v_fma_f32 v192, v136, v136, s33
    v_fmac_f32 v192, v137, v137
    v_mfma_f32_16x16x32_bf16 v[228:231], v[208:211], v[116:119], v[228:231]
    v_fmac_f32 v192, v138, v138
    v_fmac_f32 v192, v139, v139
    v_mfma_f32_16x16x32_bf16 v[212:215], v[124:127], v[164:167], 0
    v_rcp_f32 v240, v240
    v_mfma_f32_16x16x32_bf16 v[212:215], v[208:211], v[188:191], v[212:215]
    v_cvt_pk_bf16_f32 v123, v250, v251
    v_fmac_f32 v221, v111, v111
    v_mfma_f32_16x16x32_bf16 v[248:251], v[124:127], v[144:147], 0
    v_mul_f32 v228, v228, v240
    v_fmac_f32 v221, v152, v152
    v_mfma_f32_16x16x32_bf16 v[248:251], v[208:211], v[216:219], v[248:251]
    v_exp_f32 v168, v168
    v_mfma_f32_16x16x32_bf16 v[208:211], a[240:243], v[140:143], 0
    v_mul_f32_dpp v228, v212, v240 quad_perm:[0,1,2,3] row_mask:0x2 bank_mask:0xf
    v_fmac_f32 v221, v153, v153
    v_mfma_f32_16x16x32_bf16 v[208:211], a[244:247], v[224:227], v[208:211]
    v_exp_f32 v169, v169
    v_mfma_f32_16x16x32_bf16 v[208:211], a[248:251], v[112:115], v[208:211]
    ds_read_b128 v[124:127], v2 offset:12288
    v_mul_f32_dpp v228, v248, v240 quad_perm:[0,1,2,3] row_mask:0x4 bank_mask:0xf
    v_mfma_f32_16x16x32_bf16 v[208:211], a[252:255], v[148:151], v[208:211]
    ds_read_b128 v[240:243], v2 offset:13312
    v_cvt_pk_bf16_f32 v228, v228, v228
    v_mfma_f32_16x16x32_bf16 v[208:211], v[76:79], v[176:179], v[208:211]
    ds_read_b128 v[212:215], v2 offset:14336
    buffer_load_dwordx4 v14, s[8:11], 0 offen nt lds
    v_mfma_f32_16x16x32_bf16 v[208:211], v[80:83], v[160:163], v[208:211]
    ds_read_b128 v[248:251], v2 offset:15360
    v_cvt_pk_bf16_f32 v36, v168, v169
    v_mfma_f32_16x16x32_bf16 v[156:159], v[84:87], v[140:143], 0
    ds_read_b128 v[140:143], v2 offset:16384
    v_fmac_f32 v221, v154, v154
    v_mfma_f32_16x16x32_bf16 v[156:159], v[88:91], v[224:227], v[156:159]
    ds_read_b128 v[224:227], v2 offset:17408
    v_fmac_f32 v221, v155, v155
    v_mfma_f32_16x16x32_bf16 v[156:159], v[92:95], v[112:115], v[156:159]
    ds_write_b16 v7, v228
    v_mfma_f32_16x16x32_bf16 v[156:159], v[96:99], v[148:151], v[156:159]
    v_fmac_f32 v192, v208, v208
    v_fmac_f32 v192, v209, v209
    v_mfma_f32_16x16x32_bf16 v[156:159], v[100:103], v[176:179], v[156:159]
    s_waitcnt lgkmcnt(6)
    v_fmac_f32 v192, v210, v210
    v_fmac_f32 v192, v211, v211
    v_mfma_f32_16x16x32_bf16 v[156:159], v[104:107], v[160:163], v[156:159]
    s_waitcnt lgkmcnt(5)
    v_exp_f32 v170, v170
    v_mfma_f32_16x16x32_bf16 v[160:163], v[204:207], v[132:135], v[52:55]
    s_waitcnt lgkmcnt(4)
    v_exp_f32 v171, v171
    v_mfma_f32_16x16x32_bf16 v[176:179], v[184:187], v[132:135], v[56:59]
    s_waitcnt lgkmcnt(3)
    v_cvt_pk_bf16_f32 v37, v170, v171
    v_fmac_f32 v192, v156, v156
    v_mfma_f32_16x16x32_bf16 v[168:171], v[200:203], v[132:135], v[60:63]
    s_waitcnt lgkmcnt(2)
    v_fmac_f32 v192, v157, v157
    v_fmac_f32 v192, v158, v158
    v_fmac_f32 v192, v159, v159
    v_mfma_f32_16x16x16_bf16 v[160:163], v[194:195], v[172:173], v[160:163]
    v_cvt_pk_bf16_f32 v234, v221, v192
    v_exp_f32 v220, v220
    v_mfma_f32_16x16x16_bf16 v[176:179], v[174:175], v[172:173], v[176:179]
    v_cvt_pk_bf16_f32 v39, v220, 0
    v_add_u32 v6, 272, v6
    v_add_u32 v7, 16, v7
    v_mfma_f32_16x16x16_bf16 v[168:171], v[246:247], v[172:173], v[168:171]
    v_xor_b32 v0, 65536, v0
    v_exp_f32 v160, v160
    v_xor_b32 v1, 65536, v1
    v_mfma_f32_16x16x32_bf16 v[132:135], v[28:31], v[36:39], 0
    s_waitcnt lgkmcnt(0)
    v_exp_f32 v161, v161
    v_mfma_f32_16x16x32_bf16 v[132:135], v[28:31], v[120:123], v[132:135]
    v_cvt_pk_bf16_f32 v192, v160, v161
    v_xor_b32 v2, 65536, v2
    v_mfma_f32_16x16x32_bf16 v[112:115], v[116:119], v[36:39], 0
    v_exp_f32 v162, v162
    v_mfma_f32_16x16x32_bf16 v[112:115], v[128:131], v[120:123], v[112:115]
    v_exp_f32 v163, v163
    v_mfma_f32_16x16x32_bf16 v[148:151], v[188:191], v[36:39], 0
    v_exp_f32 v176, v176
    v_mfma_f32_16x16x32_bf16 v[148:151], v[164:167], v[120:123], v[148:151]
    v_rcp_f32 v132, v132
    v_mfma_f32_16x16x32_bf16 v[220:223], v[216:219], v[36:39], 0
    v_cvt_pk_bf16_f32 v193, v162, v163
    v_cvt_pk_bf16_f32 v39, v236, 0
    v_mfma_f32_16x16x32_bf16 v[220:223], v[144:147], v[120:123], v[220:223]
    v_mul_f32 v112, v132, v112
    v_mul_f32 v113, v132, v113
    v_mfma_f32_16x16x32_bf16 v[160:163], v[204:207], v[196:199], v[64:67]
    v_cvt_pk_bf16_f32 v112, v112, v113
    v_mul_f32 v114, v132, v114
    v_mfma_f32_16x16x32_bf16 v[204:207], v[184:187], v[196:199], v[68:71]
    v_mul_f32 v115, v132, v115
    v_cvt_pk_bf16_f32 v113, v114, v115
    v_mfma_f32_16x16x32_bf16 v[120:123], v[200:203], v[196:199], v[72:75]
    v_mul_f32 v148, v132, v148
    v_mul_f32 v149, v132, v149
    v_cvt_pk_bf16_f32 v114, v148, v149
    v_mfma_f32_16x16x16_bf16 v[160:163], v[194:195], v[244:245], v[160:163]
    v_mul_f32 v150, v132, v150
    v_mul_f32 v151, v132, v151
    v_cvt_pk_bf16_f32 v115, v150, v151
    v_mfma_f32_16x16x16_bf16 v[204:207], v[174:175], v[244:245], v[204:207]
    v_mul_f32 v220, v132, v220
    v_mul_f32 v221, v132, v221
    v_cvt_pk_bf16_f32 v194, v220, v221
    v_mfma_f32_16x16x16_bf16 v[120:123], v[246:247], v[244:245], v[120:123]
    v_exp_f32 v160, v160
    v_exp_f32 v161, v161
    v_mfma_f32_16x16x32_bf16 v[200:203], a[216:219], v[124:127], 0
    ds_write_b128 v3, v[112:115] offset:0
    v_mfma_f32_16x16x32_bf16 v[200:203], a[220:223], v[240:243], v[200:203]
    v_cvt_pk_bf16_f32 v160, v160, v161
    v_mul_f32 v222, v132, v222
    v_mfma_f32_16x16x32_bf16 v[200:203], a[224:227], v[212:215], v[200:203]
    v_exp_f32 v162, v162
    v_mfma_f32_16x16x32_bf16 v[200:203], a[228:231], v[248:251], v[200:203]
    ds_read_b128 v[196:199], v0 offset:20480
    ds_read_b128 v[184:187], v1 offset:20480
    v_mfma_f32_16x16x32_bf16 v[200:203], a[232:235], v[140:143], v[200:203]
    ds_read_b128 v[172:175], v0 offset:20608
    ds_read_b128 v[148:151], v1 offset:20608
    v_mfma_f32_16x16x32_bf16 v[200:203], a[236:239], v[224:227], v[200:203]
    v_exp_f32 v163, v163
    v_mfma_f32_16x16x32_bf16 v[244:247], a[240:243], v[124:127], 0
    ds_read_b128 v[112:115], v0 offset:20736
    ds_read_b128 v[228:231], v1 offset:20736
    v_mfma_f32_16x16x32_bf16 v[244:247], a[244:247], v[240:243], v[244:247]
    v_cvt_pk_bf16_f32 v161, v162, v163
    v_mul_f32 v223, v132, v223
    v_mfma_f32_16x16x32_bf16 v[244:247], a[248:251], v[212:215], v[244:247]
    v_exp_f32 v204, v204
    v_mfma_f32_16x16x32_bf16 v[244:247], a[252:255], v[248:251], v[244:247]
    v_exp_f32 v205, v205
    v_mfma_f32_16x16x32_bf16 v[244:247], v[76:79], v[140:143], v[244:247]
    v_cvt_pk_bf16_f32 v162, v204, v205
    v_cvt_pk_bf16_f32 v195, v222, v223
    v_mfma_f32_16x16x32_bf16 v[244:247], v[80:83], v[224:227], v[244:247]
    s_waitcnt lgkmcnt(4)
    ds_write_b64 v4, v[194:195] offset:4096
    v_mfma_f32_16x16x32_bf16 v[132:135], v[84:87], v[124:127], 0
    s_waitcnt lgkmcnt(3)
    v_exp_f32 v206, v206
    v_mfma_f32_16x16x32_bf16 v[132:135], v[88:91], v[240:243], v[132:135]
    s_waitcnt lgkmcnt(2)
    v_exp_f32 v207, v207
    v_mfma_f32_16x16x32_bf16 v[132:135], v[92:95], v[212:215], v[132:135]
    s_waitcnt lgkmcnt(1)
    v_cvt_pk_bf16_f32 v163, v206, v207
    v_fma_f32 v233, v200, v200, s33
    v_mfma_f32_16x16x32_bf16 v[132:135], v[96:99], v[248:251], v[132:135]
    v_exp_f32 v120, v120
    v_mfma_f32_16x16x32_bf16 v[132:135], v[100:103], v[140:143], v[132:135]
    v_exp_f32 v121, v121
    v_mfma_f32_16x16x32_bf16 v[132:135], v[104:107], v[224:227], v[132:135]
    v_exp_f32 v122, v122
    v_mfma_f32_16x16x32_bf16 v[204:207], a[72:75], v[196:199], 0
    v_exp_f32 v123, v123
    v_mfma_f32_16x16x32_bf16 v[204:207], a[76:79], v[184:187], v[204:207]
    v_exp_f32 v177, v177
    v_mfma_f32_16x16x32_bf16 v[204:207], a[80:83], v[172:175], v[204:207]
    v_cvt_pk_bf16_f32 v194, v176, v177
    v_fmac_f32 v233, v201, v201
    v_mfma_f32_16x16x32_bf16 v[204:207], a[84:87], v[148:151], v[204:207]
    v_exp_f32 v178, v178
    v_mfma_f32_16x16x32_bf16 v[204:207], a[88:91], v[112:115], v[204:207]
    v_exp_f32 v179, v179
    v_mfma_f32_16x16x32_bf16 v[204:207], a[92:95], v[228:231], v[204:207]
    v_cvt_pk_bf16_f32 v195, v178, v179
    v_fmac_f32 v233, v202, v202
    v_mfma_f32_16x16x32_bf16 v[176:179], a[96:99], v[196:199], 0
    v_exp_f32 v168, v168
    v_mfma_f32_16x16x32_bf16 v[176:179], a[100:103], v[184:187], v[176:179]
    v_exp_f32 v169, v169
    v_mfma_f32_16x16x32_bf16 v[176:179], a[104:107], v[172:175], v[176:179]
    v_cvt_pk_bf16_f32 v36, v168, v169
    v_fmac_f32 v233, v203, v203
    v_mfma_f32_16x16x32_bf16 v[176:179], a[108:111], v[148:151], v[176:179]
    v_exp_f32 v170, v170
    v_mfma_f32_16x16x32_bf16 v[176:179], a[112:115], v[112:115], v[176:179]
    v_exp_f32 v171, v171
    v_mfma_f32_16x16x32_bf16 v[176:179], a[116:119], v[228:231], v[176:179]
    v_cvt_pk_bf16_f32 v37, v170, v171
    v_fmac_f32 v233, v244, v244
    v_mfma_f32_16x16x32_bf16 v[124:127], a[120:123], v[196:199], 0
    v_fmac_f32 v233, v245, v245
    v_fmac_f32 v233, v246, v246
    v_mfma_f32_16x16x32_bf16 v[168:171], v[28:31], v[36:39], 0
    v_fmac_f32 v233, v247, v247
    v_fmac_f32 v233, v132, v132
    v_mfma_f32_16x16x32_bf16 v[168:171], v[28:31], v[192:195], v[168:171]
    v_fmac_f32 v233, v133, v133
    v_fmac_f32 v233, v134, v134
    v_mfma_f32_16x16x32_bf16 v[140:143], v[116:119], v[36:39], 0
    v_fmac_f32 v233, v135, v135
    v_cvt_pk_bf16_f32 v235, v233, v233
    v_mfma_f32_16x16x32_bf16 v[140:143], v[128:131], v[192:195], v[140:143]
    ds_write_b64 v4, v[234:235] offset:18432
    v_mfma_f32_16x16x32_bf16 v[224:227], v[188:191], v[36:39], 0
    v_rcp_f32 v168, v168
    v_mfma_f32_16x16x32_bf16 v[224:227], v[164:167], v[192:195], v[224:227]
    v_fma_f32 v169, v204, v204, s32
    v_fmac_f32 v169, v205, v205
    v_mfma_f32_16x16x32_bf16 v[248:251], v[216:219], v[36:39], 0
    v_cvt_pk_bf16_f32 v36, v120, v121
    v_cvt_pk_bf16_f32 v37, v122, v123
    v_mfma_f32_16x16x32_bf16 v[248:251], v[144:147], v[192:195], v[248:251]
    v_cvt_pk_bf16_f32 v39, v232, 0
    v_mul_f32 v140, v168, v140
    v_mfma_f32_16x16x32_bf16 v[124:127], a[124:127], v[184:187], v[124:127]
    v_mul_f32 v141, v168, v141
    v_cvt_pk_bf16_f32 v192, v140, v141
    v_mfma_f32_16x16x32_bf16 v[120:123], v[28:31], v[36:39], 0
    v_mul_f32 v142, v168, v142
    v_mul_f32 v143, v168, v143
    v_mfma_f32_16x16x32_bf16 v[120:123], v[28:31], v[160:163], v[120:123]
    v_cvt_pk_bf16_f32 v193, v142, v143
    v_mul_f32 v224, v168, v224
    v_mfma_f32_16x16x32_bf16 v[140:143], v[116:119], v[36:39], 0
    v_mul_f32 v225, v168, v225
    v_cvt_pk_bf16_f32 v194, v224, v225
    v_mfma_f32_16x16x32_bf16 v[140:143], v[128:131], v[160:163], v[140:143]
    v_mul_f32 v226, v168, v226
    v_mul_f32 v227, v168, v227
    v_mfma_f32_16x16x32_bf16 v[128:131], v[188:191], v[36:39], 0
    v_cvt_pk_bf16_f32 v195, v226, v227
    v_mul_f32 v248, v168, v248
    v_mfma_f32_16x16x32_bf16 v[128:131], v[164:167], v[160:163], v[128:131]
    ds_write_b128 v3, v[192:195] offset:6144
    v_mfma_f32_16x16x32_bf16 v[164:167], v[216:219], v[36:39], 0
    v_mul_f32 v249, v168, v249
    v_cvt_pk_bf16_f32 v170, v248, v249
    v_mfma_f32_16x16x32_bf16 v[164:167], v[144:147], v[160:163], v[164:167]
    v_mul_f32 v250, v168, v250
    v_mul_f32 v251, v168, v251
    v_mfma_f32_16x16x32_bf16 v[124:127], a[128:131], v[172:175], v[124:127]
    v_cvt_pk_bf16_f32 v171, v250, v251
    v_fmac_f32 v169, v206, v206
    v_mfma_f32_16x16x32_bf16 v[124:127], a[132:135], v[148:151], v[124:127]
    ds_write_b64 v4, v[170:171] offset:10240
    v_mfma_f32_16x16x32_bf16 v[124:127], a[136:139], v[112:115], v[124:127]
    v_rcp_f32 v120, v120
    v_mfma_f32_16x16x32_bf16 v[124:127], a[140:143], v[228:231], v[124:127]
    v_mul_f32 v140, v120, v140
    v_mul_f32 v141, v120, v141
    v_mfma_f32_16x16x32_bf16 v[216:219], a[0:3], v[196:199], 0
    v_cvt_pk_bf16_f32 v144, v140, v141
    v_mul_f32 v142, v120, v142
    v_mfma_f32_16x16x32_bf16 v[216:219], a[4:7], v[184:187], v[216:219]
    v_mul_f32 v143, v120, v143
    v_cvt_pk_bf16_f32 v145, v142, v143
    v_mfma_f32_16x16x32_bf16 v[216:219], a[8:11], v[172:175], v[216:219]
    v_mul_f32 v128, v120, v128
    v_mul_f32 v129, v120, v129
    v_mfma_f32_16x16x32_bf16 v[216:219], a[12:15], v[148:151], v[216:219]
    v_cvt_pk_bf16_f32 v146, v128, v129
    v_mul_f32 v130, v120, v130
    v_mfma_f32_16x16x32_bf16 v[216:219], a[16:19], v[112:115], v[216:219]
    v_mul_f32 v131, v120, v131
    v_cvt_pk_bf16_f32 v147, v130, v131
    v_mfma_f32_16x16x32_bf16 v[216:219], a[20:23], v[228:231], v[216:219]
    ds_write_b128 v3, v[144:147] offset:12288
    v_mfma_f32_16x16x32_bf16 v[160:163], a[24:27], v[196:199], 0
    v_mul_f32 v164, v120, v164
    v_mul_f32 v165, v120, v165
    v_mfma_f32_16x16x32_bf16 v[160:163], a[28:31], v[184:187], v[160:163]
    v_cvt_pk_bf16_f32 v164, v164, v165
    v_mul_f32 v166, v120, v166
    v_mfma_f32_16x16x32_bf16 v[160:163], a[32:35], v[172:175], v[160:163]
    v_mul_f32 v167, v120, v167
    v_cvt_pk_bf16_f32 v165, v166, v167
    v_mfma_f32_16x16x32_bf16 v[160:163], a[36:39], v[148:151], v[160:163]
    ds_write_b64 v4, v[164:165] offset:16384
    v_mfma_f32_16x16x32_bf16 v[160:163], a[40:43], v[112:115], v[160:163]
    v_fmac_f32 v169, v207, v207
    v_fmac_f32 v169, v176, v176
    v_mfma_f32_16x16x32_bf16 v[160:163], a[44:47], v[228:231], v[160:163]
    v_fmac_f32 v169, v177, v177
    v_fmac_f32 v169, v178, v178
    v_mfma_f32_16x16x32_bf16 v[116:119], a[48:51], v[196:199], 0
    v_fmac_f32 v169, v179, v179
    v_fmac_f32 v169, v124, v124
    v_mfma_f32_16x16x32_bf16 v[116:119], a[52:55], v[184:187], v[116:119]
    v_fmac_f32 v169, v125, v125
    v_fmac_f32 v169, v126, v126
    v_mfma_f32_16x16x32_bf16 v[116:119], a[56:59], v[172:175], v[116:119]
    v_fmac_f32 v169, v127, v127
    v_fma_f32 v168, v216, v216, s32
    v_mfma_f32_16x16x32_bf16 v[116:119], a[60:63], v[148:151], v[116:119]
    v_fmac_f32 v168, v217, v217
    v_fmac_f32 v168, v218, v218
    v_mfma_f32_16x16x32_bf16 v[116:119], a[64:67], v[112:115], v[116:119]
    s_waitcnt lgkmcnt(0)
    v_fmac_f32 v168, v219, v219
    v_xor_b32 v3, 65536, v3
    v_mfma_f32_16x16x32_bf16 v[116:119], a[68:71], v[228:231], v[116:119]
    s_nop 0
    v_xor_b32 v4, 65536, v4
    v_mfma_f32_16x16x32_bf16 v[128:131], v[196:199], a[144:147], 0
    s_nop 0
    v_mfma_f32_16x16x32_bf16 v[128:131], v[184:187], a[148:151], v[128:131]
    s_barrier
    v_mfma_f32_16x16x32_bf16 v[128:131], v[172:175], a[152:155], v[128:131]
    s_nop 0
    v_mfma_f32_16x16x32_bf16 v[128:131], v[148:151], a[156:159], v[128:131]
    v_mfma_f32_16x16x32_bf16 v[128:131], v[112:115], a[160:163], v[128:131]
    v_mfma_f32_16x16x32_bf16 v[128:131], v[228:231], a[164:167], v[128:131]
    s_cbranch_scc1 L_loop_fast2
    s_branch L_drain
.p2align 6
L_loop_fast3:
    v_mfma_f32_16x16x32_bf16 v[164:167], v[196:199], a[168:171], 0
    s_add_u32 s12, s42, s27
    ds_read_b128 v[144:147], v2 offset:18432
    ds_read_b128 v[192:195], v2 offset:19456
    v_mfma_f32_16x16x32_bf16 v[164:167], v[184:187], a[172:175], v[164:167]
    s_addc_u32 s13, s43, 0
    v_fmac_f32 v168, v160, v160
    v_fmac_f32 v168, v161, v161
    v_mfma_f32_16x16x32_bf16 v[164:167], v[172:175], a[176:179], v[164:167]
    s_sub_u32 s14, s36, s27
    v_fmac_f32 v168, v162, v162
    v_fmac_f32 v168, v163, v163
    v_mfma_f32_16x16x32_bf16 v[164:167], v[148:151], a[180:183], v[164:167]
    s_cmp_ge_u32 s18, 2
    ds_read_b128 v[120:123], v0 offset:26624
    v_fmac_f32 v168, v116, v116
    v_mfma_f32_16x16x32_bf16 v[164:167], v[112:115], a[184:187], v[164:167]
    s_cselect_b32 s14, s14, 0
    ds_read_b128 v[188:191], v1 offset:26624
    v_fmac_f32 v168, v117, v117
    v_mfma_f32_16x16x32_bf16 v[164:167], v[228:231], a[188:191], v[164:167]
    s_add_u32 s34, s18, 2
    ds_read_b128 v[248:251], v0 offset:26752
    v_fmac_f32 v168, v118, v118
    v_mfma_f32_16x16x32_bf16 v[140:143], v[196:199], a[192:195], 0
    s_add_u32 s8, s40, s23
    ds_read_b128 v[224:227], v1 offset:26752
    v_fmac_f32 v168, v119, v119
    v_mfma_f32_16x16x32_bf16 v[140:143], v[184:187], a[196:199], v[140:143]
    s_addc_u32 s9, s41, 0
    ds_read_b128 v[184:187], v0 offset:26880
    v_cvt_pk_bf16_f32 v36, v168, v169
    v_mfma_f32_16x16x32_bf16 v[140:143], v[172:175], a[200:203], v[140:143]
    s_waitcnt lgkmcnt(5)
    ds_read_b128 v[172:175], v1 offset:26880
    v_cvt_pk_bf16_f32 v128, v128, v129
    v_mfma_f32_16x16x32_bf16 v[168:171], v[32:35], v[36:39], 0
    s_sub_u32 s10, s36, s23
    v_cvt_pk_bf16_f32 v129, v130, v131
    v_cvt_pk_bf16_f32 v164, v164, v165
    v_mfma_f32_16x16x32_bf16 v[240:243], v[32:35], v[144:147], 0
    s_cmp_lt_u32 s34, s17
    v_cvt_pk_bf16_f32 v165, v166, v167
    s_cselect_b32 s10, s10, 0
    v_mfma_f32_16x16x32_bf16 v[240:243], v[32:35], v[192:195], v[240:243]
    s_waitcnt lgkmcnt(5)
    v_rsq_f32 v169, v169
    v_mfma_f32_16x16x32_bf16 v[140:143], v[148:151], a[204:207], v[140:143]
    s_add_u32 m0, s28, 0
    v_rsq_f32 v168, v168
    v_mfma_f32_16x16x32_bf16 v[140:143], v[112:115], a[208:211], v[140:143]
    s_mov_b32 s27, s26
    v_mul_f32 v168, s31, v168
    v_mul_f32 v204, v169, v204
    v_mfma_f32_16x16x32_bf16 v[140:143], v[228:231], a[212:215], v[140:143]
    s_mov_b32 s26, s25
    v_mul_f32 v205, v169, v205
    v_cvt_pk_bf16_f32 v204, v204, v205
    v_mfma_f32_16x16x32_bf16 v[112:115], a[72:75], v[120:123], 0
    s_waitcnt lgkmcnt(1)
    v_mul_f32 v206, v169, v206
    v_mul_f32 v207, v169, v207
    v_mfma_f32_16x16x32_bf16 v[112:115], a[76:79], v[188:191], v[112:115]
    s_mov_b32 s25, s24
    v_cvt_pk_bf16_f32 v144, v140, v141
    v_cvt_pk_bf16_f32 v145, v142, v143
    v_mfma_f32_16x16x32_bf16 v[112:115], a[80:83], v[248:251], v[112:115]
    s_mov_b32 s24, s23
    v_cvt_pk_bf16_f32 v205, v206, v207
    v_mul_f32 v176, v169, v176
    v_mfma_f32_16x16x32_bf16 v[112:115], a[84:87], v[224:227], v[112:115]
    s_waitcnt lgkmcnt(0)
    v_mul_f32 v177, v169, v177
    v_cvt_pk_bf16_f32 v206, v176, v177
    v_mfma_f32_16x16x32_bf16 v[112:115], a[88:91], v[184:187], v[112:115]
    v_mul_f32 v178, v169, v178
    v_mul_f32 v179, v169, v179
    v_mfma_f32_16x16x32_bf16 v[112:115], a[92:95], v[172:175], v[112:115]
    v_cvt_pk_bf16_f32 v207, v178, v179
    v_mul_f32 v124, v169, v124
    v_mfma_f32_16x16x32_bf16 v[148:151], a[96:99], v[120:123], 0
    v_mul_f32 v125, v169, v125
    v_cvt_pk_bf16_f32 v194, v124, v125
    v_mfma_f32_16x16x32_bf16 v[148:151], a[100:103], v[188:191], v[148:151]
    v_mul_f32 v126, v169, v126
    v_mul_f32 v127, v169, v127
    v_mfma_f32_16x16x32_bf16 v[148:151], a[104:107], v[248:251], v[148:151]
    v_cvt_pk_bf16_f32 v195, v126, v127
    v_mul_f32 v216, v168, v216
    v_mfma_f32_16x16x32_bf16 v[148:151], a[108:111], v[224:227], v[148:151]
    v_mul_f32 v217, v168, v217
    v_cvt_pk_bf16_f32 v196, v216, v217
    v_mfma_f32_16x16x32_bf16 v[148:151], a[112:115], v[184:187], v[148:151]
    v_mul_f32 v218, v168, v218
    v_mul_f32 v219, v168, v219
    v_mfma_f32_16x16x32_bf16 v[148:151], a[116:119], v[172:175], v[148:151]
    v_cvt_pk_bf16_f32 v197, v218, v219
    v_mul_f32 v160, v168, v160
    v_mfma_f32_16x16x32_bf16 v[228:231], a[120:123], v[120:123], 0
    v_mul_f32 v161, v168, v161
    v_cvt_pk_bf16_f32 v198, v160, v161
    v_mfma_f32_16x16x32_bf16 v[228:231], a[124:127], v[188:191], v[228:231]
    v_mul_f32 v162, v168, v162
    v_mul_f32 v163, v168, v163
    v_mfma_f32_16x16x32_bf16 v[228:231], a[128:131], v[248:251], v[228:231]
    v_cvt_pk_bf16_f32 v199, v162, v163
    v_mul_f32 v116, v168, v116
    v_mfma_f32_16x16x32_bf16 v[228:231], a[132:135], v[224:227], v[228:231]
    v_mul_f32 v117, v168, v117
    v_cvt_pk_bf16_f32 v192, v116, v117
    v_mfma_f32_16x16x32_bf16 v[228:231], a[136:139], v[184:187], v[228:231]
    v_mul_f32 v118, v168, v118
    v_mul_f32 v119, v168, v119
    v_mfma_f32_16x16x32_bf16 v[228:231], a[140:143], v[172:175], v[228:231]
    v_cvt_pk_bf16_f32 v193, v118, v119
    v_fma_f32 v130, v112, v112, s32
    v_mfma_f32_16x16x32_bf16 v[212:215], a[0:3], v[120:123], 0
    v_fmac_f32 v130, v113, v113
    v_fmac_f32 v130, v114, v114
    v_mfma_f32_16x16x32_bf16 v[212:215], a[4:7], v[188:191], v[212:215]
    v_fmac_f32 v130, v115, v115
    v_fmac_f32 v130, v148, v148
    v_mfma_f32_16x16x32_bf16 v[212:215], a[8:11], v[248:251], v[212:215]
    v_fmac_f32 v130, v149, v149
    v_fmac_f32 v130, v150, v150
    v_mfma_f32_16x16x32_bf16 v[212:215], a[12:15], v[224:227], v[212:215]
    v_fmac_f32 v130, v151, v151
    v_fmac_f32 v130, v228, v228
    v_mfma_f32_16x16x32_bf16 v[212:215], a[16:19], v[184:187], v[212:215]
    v_fmac_f32 v130, v229, v229
    v_fmac_f32 v130, v230, v230
    v_mfma_f32_16x16x32_bf16 v[212:215], a[20:23], v[172:175], v[212:215]
    v_fmac_f32 v130, v231, v231
    v_mul_f32 v142, 0x3baaaaab, v240
    v_mfma_f32_16x16x32_bf16 v[232:235], a[24:27], v[120:123], 0
    v_rsq_f32 v142, v142
    v_mfma_f32_16x16x32_bf16 v[232:235], a[28:31], v[188:191], v[232:235]
    v_mul_f32 v147, 0x3baaaaab, v241
    v_mul_f32 v146, 0x3baaaaab, v242
    v_mfma_f32_16x16x32_bf16 v[232:235], a[32:35], v[248:251], v[232:235]
    v_fma_f32 v131, v212, v212, s32
    v_fmac_f32 v131, v213, v213
    v_mfma_f32_16x16x32_bf16 v[232:235], a[36:39], v[224:227], v[232:235]
    v_fmac_f32 v131, v214, v214
    v_fmac_f32 v131, v215, v215
    v_mfma_f32_16x16x32_bf16 v[232:235], a[40:43], v[184:187], v[232:235]
    v_rsq_f32 v147, v147
    v_mfma_f32_16x16x32_bf16 v[232:235], a[44:47], v[172:175], v[232:235]
    v_mul_f32 v136, v147, v136
    v_mul_f32 v137, v147, v137
    v_mfma_f32_16x16x32_bf16 v[240:243], a[48:51], v[120:123], 0
    v_cvt_pk_bf16_f32 v176, v136, v137
    v_mul_f32 v138, v147, v138
    v_mfma_f32_16x16x32_bf16 v[240:243], a[52:55], v[188:191], v[240:243]
    v_mul_f32 v139, v147, v139
    v_cvt_pk_bf16_f32 v177, v138, v139
    v_mfma_f32_16x16x32_bf16 v[240:243], a[56:59], v[248:251], v[240:243]
    v_fmac_f32 v131, v232, v232
    v_fmac_f32 v131, v233, v233
    v_mfma_f32_16x16x32_bf16 v[240:243], a[60:63], v[224:227], v[240:243]
    v_fmac_f32 v131, v234, v234
    v_fmac_f32 v131, v235, v235
    v_mfma_f32_16x16x32_bf16 v[240:243], a[64:67], v[184:187], v[240:243]
    v_mul_f32 v208, v147, v208
    v_mul_f32 v209, v147, v209
    v_mfma_f32_16x16x32_bf16 v[240:243], a[68:71], v[172:175], v[240:243]
    v_cvt_pk_bf16_f32 v178, v208, v209
    v_mul_f32 v210, v147, v210
    v_mfma_f32_16x16x32_bf16 v[216:219], v[120:123], a[144:147], 0
    v_mul_f32 v211, v147, v211
    v_cvt_pk_bf16_f32 v179, v210, v211
    v_mfma_f32_16x16x32_bf16 v[216:219], v[188:191], a[148:151], v[216:219]
    buffer_store_dwordx4 v[176:179], v16, s[12:15], 0 offen
    v_mul_f32 v156, v147, v156
    v_fmac_f32 v131, v240, v240
    v_fmac_f32 v131, v241, v241
    v_fmac_f32 v131, v242, v242
    v_mfma_f32_16x16x32_bf16 v[216:219], v[248:251], a[152:155], v[216:219]
    v_fmac_f32 v131, v243, v243
    v_cvt_pk_bf16_f32 v36, v131, v130
    v_mfma_f32_16x16x32_bf16 v[216:219], v[224:227], a[156:159], v[216:219]
    v_mul_f32 v157, v147, v157
    v_cvt_pk_bf16_f32 v118, v156, v157
    v_mfma_f32_16x16x32_bf16 v[136:139], v[32:35], v[36:39], 0
    v_mul_f32 v158, v147, v158
    v_mul_f32 v159, v147, v159
    v_mfma_f32_16x16x32_bf16 v[216:219], v[184:187], a[160:163], v[216:219]
    v_cvt_pk_bf16_f32 v119, v158, v159
    v_mul_f32 v180, v142, v180
    v_mfma_f32_16x16x32_bf16 v[216:219], v[172:175], a[164:167], v[216:219]
    v_rsq_f32 v146, v146
    v_mfma_f32_16x16x32_bf16 v[168:171], v[120:123], a[168:171], 0
    v_mul_f32 v200, v146, v200
    v_mul_f32 v201, v146, v201
    v_mfma_f32_16x16x32_bf16 v[168:171], v[188:191], a[172:175], v[168:171]
    v_cvt_pk_bf16_f32 v200, v200, v201
    v_mul_f32 v202, v146, v202
    v_mfma_f32_16x16x32_bf16 v[168:171], v[248:251], a[176:179], v[168:171]
    v_cvt_pk_bf16_f32 v130, v216, v217
    v_cvt_pk_bf16_f32 v131, v218, v219
    v_mfma_f32_16x16x32_bf16 v[168:171], v[224:227], a[180:183], v[168:171]
    ds_read_b128 v[176:179], v0 offset:32768
    v_mul_f32 v203, v146, v203
    v_mfma_f32_16x16x32_bf16 v[168:171], v[184:187], a[184:187], v[168:171]
    ds_read_b128 v[160:163], v1 offset:32768
    v_cvt_pk_bf16_f32 v201, v202, v203
    v_mfma_f32_16x16x32_bf16 v[168:171], v[172:175], a[188:191], v[168:171]
    ds_read_b128 v[208:211], v0 offset:32896
    v_mul_f32 v244, v146, v244
    v_mfma_f32_16x16x32_bf16 v[156:159], v[120:123], a[192:195], 0
    ds_read_b128 v[216:219], v1 offset:32896
    v_mul_f32 v245, v146, v245
    v_mfma_f32_16x16x32_bf16 v[156:159], v[188:191], a[196:199], v[156:159]
    ds_read_b128 v[124:127], v0 offset:33024
    v_cvt_pk_bf16_f32 v202, v244, v245
    v_mfma_f32_16x16x32_bf16 v[156:159], v[248:251], a[200:203], v[156:159]
    ds_read_b128 v[120:123], v1 offset:33024
    v_mul_f32 v246, v146, v246
    v_mfma_f32_16x16x32_bf16 v[156:159], v[224:227], a[204:207], v[156:159]
    v_mul_f32 v247, v146, v247
    v_cvt_pk_bf16_f32 v203, v246, v247
    v_mfma_f32_16x16x32_bf16 v[156:159], v[184:187], a[208:211], v[156:159]
    v_mul_f32 v132, v146, v132
    v_mul_f32 v133, v146, v133
    v_mfma_f32_16x16x32_bf16 v[156:159], v[172:175], a[212:215], v[156:159]
    s_waitcnt lgkmcnt(5)
    buffer_store_dwordx4 v[200:203], v17, s[12:15], 0 offen
    v_cvt_pk_bf16_f32 v116, v132, v133
    v_mul_f32 v134, v146, v134
    v_mul_f32 v135, v146, v135
    v_cvt_pk_bf16_f32 v117, v134, v135
    v_mfma_f32_16x16x32_bf16 v[200:203], a[72:75], v[176:179], 0
    s_waitcnt lgkmcnt(3)
    v_rsq_f32 v137, v137
    v_mfma_f32_16x16x32_bf16 v[200:203], a[76:79], v[160:163], v[200:203]
    s_waitcnt lgkmcnt(2)
    v_rsq_f32 v136, v136
    v_mfma_f32_16x16x32_bf16 v[200:203], a[80:83], v[208:211], v[200:203]
    s_waitcnt lgkmcnt(1)
    v_mul_f32 v136, s31, v136
    v_cvt_pk_bf16_f32 v166, v168, v169
    v_mfma_f32_16x16x32_bf16 v[200:203], a[84:87], v[216:219], v[200:203]
    s_waitcnt lgkmcnt(0)
    v_cvt_pk_bf16_f32 v167, v170, v171
    v_cvt_pk_bf16_f32 v146, v156, v157
    v_mfma_f32_16x16x32_bf16 v[200:203], a[88:91], v[124:127], v[200:203]
    v_cvt_pk_bf16_f32 v147, v158, v159
    v_mul_f32 v112, v137, v112
    v_mfma_f32_16x16x32_bf16 v[200:203], a[92:95], v[120:123], v[200:203]
    v_mul_f32 v113, v137, v113
    v_cvt_pk_bf16_f32 v184, v112, v113
    v_mfma_f32_16x16x32_bf16 v[168:171], a[96:99], v[176:179], 0
    v_mul_f32 v114, v137, v114
    v_mul_f32 v115, v137, v115
    v_mfma_f32_16x16x32_bf16 v[168:171], a[100:103], v[160:163], v[168:171]
    v_cvt_pk_bf16_f32 v185, v114, v115
    v_mul_f32 v148, v137, v148
    v_mfma_f32_16x16x32_bf16 v[168:171], a[104:107], v[208:211], v[168:171]
    v_mul_f32 v149, v137, v149
    v_cvt_pk_bf16_f32 v186, v148, v149
    v_mfma_f32_16x16x32_bf16 v[168:171], a[108:111], v[216:219], v[168:171]
    v_mul_f32 v150, v137, v150
    v_mul_f32 v151, v137, v151
    v_mfma_f32_16x16x32_bf16 v[168:171], a[112:115], v[124:127], v[168:171]
    s_waitcnt vmcnt(2)
    v_cvt_pk_bf16_f32 v187, v150, v151
    v_mul_f32 v228, v137, v228
    v_mfma_f32_16x16x32_bf16 v[168:171], a[116:119], v[120:123], v[168:171]
    s_nop 0
    v_mul_f32 v229, v137, v229
    v_cvt_pk_bf16_f32 v174, v228, v229
    v_mfma_f32_16x16x32_bf16 v[112:115], a[120:123], v[176:179], 0
    s_nop 0
    v_mul_f32 v230, v137, v230
    v_mul_f32 v231, v137, v231
    v_mfma_f32_16x16x32_bf16 v[112:115], a[124:127], v[160:163], v[112:115]
    s_nop 0
    v_cvt_pk_bf16_f32 v175, v230, v231
    v_mul_f32 v212, v136, v212
    v_mfma_f32_16x16x32_bf16 v[112:115], a[128:131], v[208:211], v[112:115]
    s_barrier
    v_mul_f32 v213, v136, v213
    v_cvt_pk_bf16_f32 v132, v212, v213
    v_mfma_f32_16x16x32_bf16 v[112:115], a[132:135], v[216:219], v[112:115]
    v_mul_f32 v214, v136, v214
    v_mul_f32 v215, v136, v215
    v_mfma_f32_16x16x32_bf16 v[112:115], a[136:139], v[124:127], v[112:115]
    buffer_load_dwordx4 v10, s[8:11], 0 offen nt lds
    v_cvt_pk_bf16_f32 v133, v214, v215
    v_mfma_f32_16x16x32_bf16 v[112:115], a[140:143], v[120:123], v[112:115]
    s_add_u32 m0, s28, 4096
    v_mul_f32 v232, v136, v232
    v_mul_f32 v233, v136, v233
    v_mfma_f32_16x16x32_bf16 v[188:191], a[0:3], v[176:179], 0
    v_cvt_pk_bf16_f32 v134, v232, v233
    v_mul_f32 v234, v136, v234
    v_mfma_f32_16x16x32_bf16 v[188:191], a[4:7], v[160:163], v[188:191]
    v_mul_f32 v235, v136, v235
    v_cvt_pk_bf16_f32 v135, v234, v235
    v_mfma_f32_16x16x32_bf16 v[188:191], a[8:11], v[208:211], v[188:191]
    v_mul_f32 v240, v136, v240
    v_mul_f32 v241, v136, v241
    v_mfma_f32_16x16x32_bf16 v[188:191], a[12:15], v[216:219], v[188:191]
    buffer_load_dwordx4 v11, s[8:11], 0 offen nt lds
    v_cvt_pk_bf16_f32 v172, v240, v241
    v_mfma_f32_16x16x32_bf16 v[188:191], a[16:19], v[124:127], v[188:191]
    s_add_u32 m0, s28, 8192
    v_mul_f32 v242, v136, v242
    v_mul_f32 v243, v136, v243
    v_mfma_f32_16x16x32_bf16 v[188:191], a[20:23], v[120:123], v[188:191]
    v_cvt_pk_bf16_f32 v173, v242, v243
    v_fma_f32 v140, v200, v200, s32
    v_mfma_f32_16x16x32_bf16 v[136:139], a[24:27], v[176:179], 0
    v_fmac_f32 v140, v201, v201
    v_fmac_f32 v140, v202, v202
    v_mfma_f32_16x16x32_bf16 v[136:139], a[28:31], v[160:163], v[136:139]
    v_fmac_f32 v140, v203, v203
    v_fmac_f32 v140, v168, v168
    v_mfma_f32_16x16x32_bf16 v[136:139], a[32:35], v[208:211], v[136:139]
    buffer_load_dwordx4 v12, s[8:11], 0 offen nt lds
    v_fma_f32 v141, v188, v188, s32
    v_mfma_f32_16x16x32_bf16 v[136:139], a[36:39], v[216:219], v[136:139]
    s_add_u32 m0, s28, 12288
    v_fmac_f32 v141, v189, v189
    v_fmac_f32 v141, v190, v190
    v_mfma_f32_16x16x32_bf16 v[136:139], a[40:43], v[124:127], v[136:139]
    s_xor_b32 s28, s28, 65536
    v_fmac_f32 v141, v191, v191
    v_fmac_f32 v140, v169, v169
    v_mfma_f32_16x16x32_bf16 v[136:139], a[44:47], v[120:123], v[136:139]
    v_fmac_f32 v140, v170, v170
    v_fmac_f32 v140, v171, v171
    v_mfma_f32_16x16x32_bf16 v[148:151], a[48:51], v[176:179], 0
    v_fmac_f32 v140, v112, v112
    v_fmac_f32 v140, v113, v113
    v_mfma_f32_16x16x32_bf16 v[148:151], a[52:55], v[160:163], v[148:151]
    buffer_load_dwordx4 v13, s[8:11], 0 offen nt lds
    v_fmac_f32 v140, v114, v114
    v_mfma_f32_16x16x32_bf16 v[148:151], a[56:59], v[208:211], v[148:151]
    s_mov_b32 m0, s29
    v_fmac_f32 v141, v136, v136
    v_fmac_f32 v141, v137, v137
    v_mfma_f32_16x16x32_bf16 v[148:151], a[60:63], v[216:219], v[148:151]
    s_xor_b32 s29, s29, s30
    v_fmac_f32 v141, v138, v138
    v_fmac_f32 v141, v139, v139
    v_mfma_f32_16x16x32_bf16 v[148:151], a[64:67], v[124:127], v[148:151]
    s_add_u32 s19, s19, s20
    v_fmac_f32 v140, v115, v115
    v_mul_f32 v181, v142, v181
    v_mfma_f32_16x16x32_bf16 v[148:151], a[68:71], v[120:123], v[148:151]
    s_add_u32 s23, s23, s21
    v_cvt_pk_bf16_f32 v156, v180, v181
    v_mul_f32 v182, v142, v182
    v_mfma_f32_16x16x32_bf16 v[220:223], v[176:179], a[144:147], 0
    s_cmp_ge_u32 s19, 72
    ds_read_b128 v[212:215], v5 offset:0
    ds_read_b128 v[224:227], v5 offset:16
    v_mfma_f32_16x16x32_bf16 v[220:223], v[160:163], a[148:151], v[220:223]
    s_cselect_b32 s34, 72, 0
    ds_read_b128 v[228:231], v5 offset:48
    ds_read_b32 v143, v6 offset:192
    v_mfma_f32_16x16x32_bf16 v[220:223], v[208:211], a[152:155], v[220:223]
    s_cselect_b32 s35, s22, 0
    buffer_store_dwordx2 v[116:117], v20, s[12:15], 0 offen
    v_fmac_f32 v141, v148, v148
    v_fmac_f32 v141, v149, v149
    v_mfma_f32_16x16x32_bf16 v[220:223], v[216:219], a[156:159], v[220:223]
    s_sub_u32 s19, s19, s34
    v_fmac_f32 v141, v150, v150
    v_fmac_f32 v141, v151, v151
    v_mfma_f32_16x16x32_bf16 v[220:223], v[124:127], a[160:163], v[220:223]
    s_add_u32 s23, s23, s35
    v_cvt_pk_bf16_f32 v36, v141, v140
    v_mul_f32 v183, v142, v183
    v_mfma_f32_16x16x32_bf16 v[220:223], v[120:123], a[164:167], v[220:223]
    s_add_u32 s18, s18, 1
    v_cvt_pk_bf16_f32 v157, v182, v183
    v_mul_f32 v108, v142, v108
    v_mfma_f32_16x16x32_bf16 v[180:183], v[32:35], v[36:39], 0
    s_cmp_lt_u32 s18, s17
    v_mul_f32 v109, v142, v109
    v_cvt_pk_bf16_f32 v158, v108, v109
    v_mfma_f32_16x16x32_bf16 v[232:235], v[176:179], a[168:171], 0
    s_waitcnt lgkmcnt(3)
    v_cvt_pk_bf16_f32 v116, v220, v221
    v_cvt_pk_bf16_f32 v117, v222, v223
    v_mfma_f32_16x16x32_bf16 v[220:223], v[212:215], v[196:199], v[22:25]
    s_waitcnt lgkmcnt(1)
    v_rsq_f32 v181, v181
    v_mfma_f32_16x16x32_bf16 v[220:223], v[224:227], v[204:207], v[220:223]
    s_waitcnt lgkmcnt(0)
    v_rsq_f32 v180, v180
    v_mfma_f32_16x16x32_bf16 v[220:223], v[228:231], v[192:195], v[220:223]
    v_mul_f32 v180, s31, v180
    v_mul_f32 v200, v181, v200
    v_mfma_f32_16x16x32_bf16 v[236:239], v[212:215], v[132:135], v[24:27]
    v_mul_f32 v201, v181, v201
    v_cvt_pk_bf16_f32 v200, v200, v201
    v_mfma_f32_16x16x32_bf16 v[236:239], v[224:227], v[184:187], v[236:239]
    v_mul_f32 v202, v181, v202
    v_mul_f32 v203, v181, v203
    v_mfma_f32_16x16x32_bf16 v[236:239], v[228:231], v[172:175], v[236:239]
    v_mov_b32_dpp v143, v221 quad_perm:[0,1,2,3] row_mask:0x1 bank_mask:0xf
    v_cvt_pk_bf16_f32 v201, v202, v203
    v_mfma_f32_16x16x32_bf16 v[232:235], v[160:163], a[172:175], v[232:235]
    v_mul_f32 v168, v181, v168
    v_mul_f32 v169, v181, v169
    v_mfma_f32_16x16x32_bf16 v[232:235], v[208:211], a[176:179], v[232:235]
    v_cvt_pk_bf16_f32 v202, v168, v169
    v_mul_f32 v170, v181, v170
    v_mfma_f32_16x16x32_bf16 v[232:235], v[216:219], a[180:183], v[232:235]
    v_mul_f32 v171, v181, v171
    v_cvt_pk_bf16_f32 v203, v170, v171
    v_mfma_f32_16x16x32_bf16 v[240:243], v[204:207], v[196:199], v[40:43]
    v_mul_f32 v112, v181, v112
    v_mul_f32 v113, v181, v113
    v_mfma_f32_16x16x32_bf16 v[248:251], v[184:187], v[196:199], v[44:47]
    v_cvt_pk_bf16_f32 v246, v112, v113
    v_mul_f32 v114, v181, v114
    v_mfma_f32_16x16x32_bf16 v[168:171], v[200:203], v[196:199], v[48:51]
    buffer_store_dwordx2 v[118:119], v19, s[12:15], 0 offen
    v_mul_f32 v115, v181, v115
    v_cvt_pk_bf16_f32 v247, v114, v115
    v_mfma_f32_16x16x16_bf16 v[240:243], v[194:195], v[192:193], v[240:243]
    v_mul_f32 v188, v180, v188
    v_mul_f32 v189, v180, v189
    v_cvt_pk_bf16_f32 v196, v188, v189
    v_mfma_f32_16x16x16_bf16 v[248:251], v[174:175], v[192:193], v[248:251]
    v_mul_f32 v190, v180, v190
    v_mul_f32 v191, v180, v191
    v_cvt_pk_bf16_f32 v197, v190, v191
    v_mfma_f32_16x16x16_bf16 v[168:171], v[246:247], v[192:193], v[168:171]
    v_mul_f32 v136, v180, v136
    v_mul_f32 v137, v180, v137
    v_cvt_pk_bf16_f32 v198, v136, v137
    v_mul_f32 v138, v180, v138
    v_mfma_f32_16x16x32_bf16 v[232:235], v[124:127], a[184:187], v[232:235]
    v_mul_f32 v139, v180, v139
    v_cvt_pk_bf16_f32 v199, v138, v139
    v_mfma_f32_16x16x32_bf16 v[232:235], v[120:123], a[188:191], v[232:235]
    v_mul_f32 v148, v180, v148
    v_mul_f32 v149, v180, v149
    v_mfma_f32_16x16x32_bf16 v[112:115], v[176:179], a[192:195], 0
    ds_read_b128 v[176:179], v2 offset:0
    v_cvt_pk_bf16_f32 v244, v148, v149
    v_mfma_f32_16x16x32_bf16 v[112:115], v[160:163], a[196:199], v[112:115]
    ds_read_b128 v[160:163], v2 offset:1024
    v_mul_f32 v150, v180, v150
    v_mfma_f32_16x16x32_bf16 v[112:115], v[208:211], a[200:203], v[112:115]
    ds_read_b128 v[136:139], v2 offset:2048
    v_cvt_pk_bf16_f32 v188, v232, v233
    v_mfma_f32_16x16x32_bf16 v[112:115], v[216:219], a[204:207], v[112:115]
    ds_read_b128 v[208:211], v2 offset:3072
    v_cvt_pk_bf16_f32 v189, v234, v235
    v_mfma_f32_16x16x32_bf16 v[112:115], v[124:127], a[208:211], v[112:115]
    ds_read_b128 v[124:127], v2 offset:4096
    ds_read2_b32 v[118:119], v6 offset0:0 offset1:0
    v_mfma_f32_16x16x32_bf16 v[112:115], v[120:123], a[212:215], v[112:115]
    ds_read_b128 v[120:123], v2 offset:5120
    ds_read2_b32 v[190:191], v6 offset0:16 offset1:16
    v_mfma_f32_16x16x32_bf16 v[232:235], v[212:215], v[196:199], v[26:29]
    v_mul_f32 v151, v180, v151
    v_cvt_pk_bf16_f32 v245, v150, v151
    v_mfma_f32_16x16x32_bf16 v[232:235], v[224:227], v[200:203], v[232:235]
    ds_read2_b32 v[218:219], v6 offset0:32 offset1:32
    v_mov_b32_dpp v143, v237 quad_perm:[0,1,2,3] row_mask:0x2 bank_mask:0xf
    v_mfma_f32_16x16x32_bf16 v[232:235], v[228:231], v[244:247], v[232:235]
    s_waitcnt lgkmcnt(8)
    v_cvt_pk_bf16_f32 v216, v112, v113
    v_cvt_pk_bf16_f32 v217, v114, v115
    v_mfma_f32_16x16x32_bf16 v[180:183], a[216:219], v[176:179], 0
    s_waitcnt lgkmcnt(7)
    v_mul_f32 v110, v142, v110
    v_mul_f32 v111, v142, v111
    v_mfma_f32_16x16x32_bf16 v[180:183], a[220:223], v[160:163], v[180:183]
    s_waitcnt lgkmcnt(6)
    v_cvt_pk_bf16_f32 v159, v110, v111
    v_mul_f32 v152, v142, v152
    v_mfma_f32_16x16x32_bf16 v[180:183], a[224:227], v[136:139], v[180:183]
    s_waitcnt lgkmcnt(5)
    buffer_store_dwordx4 v[156:159], v15, s[12:15], 0 offen
    v_mul_f32 v153, v142, v153
    v_cvt_pk_bf16_f32 v192, v152, v153
    v_mul_f32 v154, v142, v154
    v_mul_f32 v155, v142, v155
    v_mfma_f32_16x16x32_bf16 v[180:183], a[228:231], v[208:211], v[180:183]
    s_waitcnt lgkmcnt(1)
    v_cvt_pk_bf16_f32 v193, v154, v155
    v_mov_b32_dpp v143, v233 quad_perm:[0,1,2,3] row_mask:0x4 bank_mask:0xf
    v_mfma_f32_16x16x32_bf16 v[180:183], a[232:235], v[124:127], v[180:183]
    v_exp_f32 v232, v232
    v_mfma_f32_16x16x32_bf16 v[180:183], a[236:239], v[120:123], v[180:183]
    s_waitcnt lgkmcnt(0)
    v_exp_f32 v143, v143
    v_mfma_f32_16x16x32_bf16 v[108:111], a[240:243], v[176:179], 0
    v_cvt_pk_bf16_f32 v143, v143, v143
    v_add_u32 v5, 336, v5
    v_mfma_f32_16x16x32_bf16 v[108:111], a[244:247], v[160:163], v[108:111]
    ds_write_b16 v8, v143
    v_mfma_f32_16x16x32_bf16 v[108:111], a[248:251], v[136:139], v[108:111]
    v_exp_f32 v236, v236
    v_mfma_f32_16x16x32_bf16 v[108:111], a[252:255], v[208:211], v[108:111]
    ds_read_b128 v[140:143], v2 offset:6144
    ds_read_b128 v[224:227], v2 offset:7168
    v_mfma_f32_16x16x32_bf16 v[108:111], v[76:79], v[124:127], v[108:111]
    ds_read_b128 v[112:115], v2 offset:8192
    v_fma_f32 v221, v180, v180, s33
    v_mfma_f32_16x16x32_bf16 v[108:111], v[80:83], v[120:123], v[108:111]
    ds_read_b128 v[148:151], v2 offset:9216
    v_fmac_f32 v221, v181, v181
    v_mfma_f32_16x16x32_bf16 v[152:155], v[84:87], v[176:179], 0
    ds_read_b128 v[176:179], v2 offset:10240
    v_fmac_f32 v221, v182, v182
    v_mfma_f32_16x16x32_bf16 v[152:155], v[88:91], v[160:163], v[152:155]
    ds_read_b128 v[160:163], v2 offset:11264
    v_fmac_f32 v221, v183, v183
    v_mfma_f32_16x16x32_bf16 v[152:155], v[92:95], v[136:139], v[152:155]
    v_exp_f32 v240, v240
    v_mfma_f32_16x16x32_bf16 v[152:155], v[96:99], v[208:211], v[152:155]
    v_exp_f32 v241, v241
    v_mfma_f32_16x16x32_bf16 v[152:155], v[100:103], v[124:127], v[152:155]
    ds_read_b128 v[124:127], v9
    ds_read_b128 v[208:211], v9 offset:64
    v_mfma_f32_16x16x32_bf16 v[152:155], v[104:107], v[120:123], v[152:155]
    s_waitcnt lgkmcnt(6)
    v_cvt_pk_bf16_f32 v120, v240, v241
    v_fmac_f32 v221, v108, v108
    v_mfma_f32_16x16x32_bf16 v[136:139], a[216:219], v[140:143], 0
    s_waitcnt lgkmcnt(5)
    v_exp_f32 v242, v242
    v_mfma_f32_16x16x32_bf16 v[136:139], a[220:223], v[224:227], v[136:139]
    s_waitcnt lgkmcnt(4)
    buffer_store_dwordx2 v[192:193], v18, s[12:15], 0 offen
    v_exp_f32 v243, v243
    v_mfma_f32_16x16x32_bf16 v[136:139], a[224:227], v[112:115], v[136:139]
    s_waitcnt lgkmcnt(2)
    v_cvt_pk_bf16_f32 v121, v242, v243
    v_fmac_f32 v221, v109, v109
    v_mfma_f32_16x16x32_bf16 v[136:139], a[228:231], v[148:151], v[136:139]
    v_exp_f32 v248, v248
    v_mfma_f32_16x16x32_bf16 v[136:139], a[232:235], v[176:179], v[136:139]
    v_exp_f32 v249, v249
    v_mfma_f32_16x16x32_bf16 v[136:139], a[236:239], v[160:163], v[136:139]
    s_waitcnt lgkmcnt(1)
    v_cvt_pk_bf16_f32 v122, v248, v249
    v_fmac_f32 v221, v110, v110
    v_mfma_f32_16x16x32_bf16 v[240:243], v[124:127], v[28:31], 0
    s_waitcnt lgkmcnt(0)
    v_exp_f32 v250, v250
    v_mfma_f32_16x16x32_bf16 v[240:243], v[208:211], v[28:31], v[240:243]
    v_exp_f32 v251, v251
    v_mfma_f32_16x16x32_bf16 v[228:231], v[124:127], v[128:131], 0
    v_fma_f32 v192, v136, v136, s33
    v_fmac_f32 v192, v137, v137
    v_mfma_f32_16x16x32_bf16 v[228:231], v[208:211], v[116:119], v[228:231]
    v_fmac_f32 v192, v138, v138
    v_fmac_f32 v192, v139, v139
    v_mfma_f32_16x16x32_bf16 v[212:215], v[124:127], v[164:167], 0
    v_rcp_f32 v240, v240
    v_mfma_f32_16x16x32_bf16 v[212:215], v[208:211], v[188:191], v[212:215]
    v_cvt_pk_bf16_f32 v123, v250, v251
    v_fmac_f32 v221, v111, v111
    v_mfma_f32_16x16x32_bf16 v[248:251], v[124:127], v[144:147], 0
    v_mul_f32 v228, v228, v240
    v_fmac_f32 v221, v152, v152
    v_mfma_f32_16x16x32_bf16 v[248:251], v[208:211], v[216:219], v[248:251]
    v_exp_f32 v168, v168
    v_mfma_f32_16x16x32_bf16 v[208:211], a[240:243], v[140:143], 0
    v_mul_f32_dpp v228, v212, v240 quad_perm:[0,1,2,3] row_mask:0x2 bank_mask:0xf
    v_fmac_f32 v221, v153, v153
    v_mfma_f32_16x16x32_bf16 v[208:211], a[244:247], v[224:227], v[208:211]
    v_exp_f32 v169, v169
    v_mfma_f32_16x16x32_bf16 v[208:211], a[248:251], v[112:115], v[208:211]
    ds_read_b128 v[124:127], v2 offset:12288
    v_mul_f32_dpp v228, v248, v240 quad_perm:[0,1,2,3] row_mask:0x4 bank_mask:0xf
    v_mfma_f32_16x16x32_bf16 v[208:211], a[252:255], v[148:151], v[208:211]
    ds_read_b128 v[240:243], v2 offset:13312
    v_cvt_pk_bf16_f32 v228, v228, v228
    v_mfma_f32_16x16x32_bf16 v[208:211], v[76:79], v[176:179], v[208:211]
    ds_read_b128 v[212:215], v2 offset:14336
    buffer_load_dwordx4 v14, s[8:11], 0 offen nt lds
    v_mfma_f32_16x16x32_bf16 v[208:211], v[80:83], v[160:163], v[208:211]
    ds_read_b128 v[248:251], v2 offset:15360
    v_cvt_pk_bf16_f32 v36, v168, v169
    v_mfma_f32_16x16x32_bf16 v[156:159], v[84:87], v[140:143], 0
    ds_read_b128 v[140:143], v2 offset:16384
    v_fmac_f32 v221, v154, v154
    v_mfma_f32_16x16x32_bf16 v[156:159], v[88:91], v[224:227], v[156:159]
    ds_read_b128 v[224:227], v2 offset:17408
    v_fmac_f32 v221, v155, v155
    v_mfma_f32_16x16x32_bf16 v[156:159], v[92:95], v[112:115], v[156:159]
    ds_write_b16 v7, v228
    v_mfma_f32_16x16x32_bf16 v[156:159], v[96:99], v[148:151], v[156:159]
    v_fmac_f32 v192, v208, v208
    v_fmac_f32 v192, v209, v209
    v_mfma_f32_16x16x32_bf16 v[156:159], v[100:103], v[176:179], v[156:159]
    s_waitcnt lgkmcnt(6)
    v_fmac_f32 v192, v210, v210
    v_fmac_f32 v192, v211, v211
    v_mfma_f32_16x16x32_bf16 v[156:159], v[104:107], v[160:163], v[156:159]
    s_waitcnt lgkmcnt(5)
    v_exp_f32 v170, v170
    v_mfma_f32_16x16x32_bf16 v[160:163], v[204:207], v[132:135], v[52:55]
    s_waitcnt lgkmcnt(4)
    v_exp_f32 v171, v171
    v_mfma_f32_16x16x32_bf16 v[176:179], v[184:187], v[132:135], v[56:59]
    s_waitcnt lgkmcnt(3)
    v_cvt_pk_bf16_f32 v37, v170, v171
    v_fmac_f32 v192, v156, v156
    v_mfma_f32_16x16x32_bf16 v[168:171], v[200:203], v[132:135], v[60:63]
    s_waitcnt lgkmcnt(2)
    v_fmac_f32 v192, v157, v157
    v_fmac_f32 v192, v158, v158
    v_fmac_f32 v192, v159, v159
    v_mfma_f32_16x16x16_bf16 v[160:163], v[194:195], v[172:173], v[160:163]
    v_cvt_pk_bf16_f32 v234, v221, v192
    v_exp_f32 v220, v220
    v_mfma_f32_16x16x16_bf16 v[176:179], v[174:175], v[172:173], v[176:179]
    v_cvt_pk_bf16_f32 v39, v220, 0
    v_add_u32 v6, 272, v6
    v_add_u32 v7, 16, v7
    v_mfma_f32_16x16x16_bf16 v[168:171], v[246:247], v[172:173], v[168:171]
    v_xor_b32 v0, 65536, v0
    v_exp_f32 v160, v160
    v_xor_b32 v1, 65536, v1
    v_mfma_f32_16x16x32_bf16 v[132:135], v[28:31], v[36:39], 0
    s_waitcnt lgkmcnt(0)
    v_exp_f32 v161, v161
    v_mfma_f32_16x16x32_bf16 v[132:135], v[28:31], v[120:123], v[132:135]
    v_cvt_pk_bf16_f32 v192, v160, v161
    v_xor_b32 v2, 65536, v2
    v_mfma_f32_16x16x32_bf16 v[112:115], v[116:119], v[36:39], 0
    v_exp_f32 v162, v162
    v_mfma_f32_16x16x32_bf16 v[112:115], v[128:131], v[120:123], v[112:115]
    v_exp_f32 v163, v163
    v_mfma_f32_16x16x32_bf16 v[148:151], v[188:191], v[36:39], 0
    v_exp_f32 v176, v176
    v_mfma_f32_16x16x32_bf16 v[148:151], v[164:167], v[120:123], v[148:151]
    v_rcp_f32 v132, v132
    v_mfma_f32_16x16x32_bf16 v[220:223], v[216:219], v[36:39], 0
    v_cvt_pk_bf16_f32 v193, v162, v163
    v_cvt_pk_bf16_f32 v39, v236, 0
    v_mfma_f32_16x16x32_bf16 v[220:223], v[144:147], v[120:123], v[220:223]
    v_mul_f32 v112, v132, v112
    v_mul_f32 v113, v132, v113
    v_mfma_f32_16x16x32_bf16 v[160:163], v[204:207], v[196:199], v[64:67]
    v_cvt_pk_bf16_f32 v112, v112, v113
    v_mul_f32 v114, v132, v114
    v_mfma_f32_16x16x32_bf16 v[204:207], v[184:187], v[196:199], v[68:71]
    v_mul_f32 v115, v132, v115
    v_cvt_pk_bf16_f32 v113, v114, v115
    v_mfma_f32_16x16x32_bf16 v[120:123], v[200:203], v[196:199], v[72:75]
    v_mul_f32 v148, v132, v148
    v_mul_f32 v149, v132, v149
    v_cvt_pk_bf16_f32 v114, v148, v149
    v_mfma_f32_16x16x16_bf16 v[160:163], v[194:195], v[244:245], v[160:163]
    v_mul_f32 v150, v132, v150
    v_mul_f32 v151, v132, v151
    v_cvt_pk_bf16_f32 v115, v150, v151
    v_mfma_f32_16x16x16_bf16 v[204:207], v[174:175], v[244:245], v[204:207]
    v_mul_f32 v220, v132, v220
    v_mul_f32 v221, v132, v221
    v_cvt_pk_bf16_f32 v194, v220, v221
    v_mfma_f32_16x16x16_bf16 v[120:123], v[246:247], v[244:245], v[120:123]
    v_exp_f32 v160, v160
    v_exp_f32 v161, v161
    v_mfma_f32_16x16x32_bf16 v[200:203], a[216:219], v[124:127], 0
    ds_write_b128 v3, v[112:115] offset:0
    v_mfma_f32_16x16x32_bf16 v[200:203], a[220:223], v[240:243], v[200:203]
    v_cvt_pk_bf16_f32 v160, v160, v161
    v_mul_f32 v222, v132, v222
    v_mfma_f32_16x16x32_bf16 v[200:203], a[224:227], v[212:215], v[200:203]
    v_exp_f32 v162, v162
    v_mfma_f32_16x16x32_bf16 v[200:203], a[228:231], v[248:251], v[200:203]
    ds_read_b128 v[196:199], v0 offset:20480
    ds_read_b128 v[184:187], v1 offset:20480
    v_mfma_f32_16x16x32_bf16 v[200:203], a[232:235], v[140:143], v[200:203]
    ds_read_b128 v[172:175], v0 offset:20608
    ds_read_b128 v[148:151], v1 offset:20608
    v_mfma_f32_16x16x32_bf16 v[200:203], a[236:239], v[224:227], v[200:203]
    v_exp_f32 v163, v163
    v_mfma_f32_16x16x32_bf16 v[244:247], a[240:243], v[124:127], 0
    ds_read_b128 v[112:115], v0 offset:20736
    ds_read_b128 v[228:231], v1 offset:20736
    v_mfma_f32_16x16x32_bf16 v[244:247], a[244:247], v[240:243], v[244:247]
    v_cvt_pk_bf16_f32 v161, v162, v163
    v_mul_f32 v223, v132, v223
    v_mfma_f32_16x16x32_bf16 v[244:247], a[248:251], v[212:215], v[244:247]
    v_exp_f32 v204, v204
    v_mfma_f32_16x16x32_bf16 v[244:247], a[252:255], v[248:251], v[244:247]
    v_exp_f32 v205, v205
    v_mfma_f32_16x16x32_bf16 v[244:247], v[76:79], v[140:143], v[244:247]
    v_cvt_pk_bf16_f32 v162, v204, v205
    v_cvt_pk_bf16_f32 v195, v222, v223
    v_mfma_f32_16x16x32_bf16 v[244:247], v[80:83], v[224:227], v[244:247]
    s_waitcnt lgkmcnt(4)
    ds_write_b64 v4, v[194:195] offset:4096
    v_mfma_f32_16x16x32_bf16 v[132:135], v[84:87], v[124:127], 0
    s_waitcnt lgkmcnt(3)
    v_exp_f32 v206, v206
    v_mfma_f32_16x16x32_bf16 v[132:135], v[88:91], v[240:243], v[132:135]
    s_waitcnt lgkmcnt(2)
    v_exp_f32 v207, v207
    v_mfma_f32_16x16x32_bf16 v[132:135], v[92:95], v[212:215], v[132:135]
    s_waitcnt lgkmcnt(1)
    v_cvt_pk_bf16_f32 v163, v206, v207
    v_fma_f32 v233, v200, v200, s33
    v_mfma_f32_16x16x32_bf16 v[132:135], v[96:99], v[248:251], v[132:135]
    v_exp_f32 v120, v120
    v_mfma_f32_16x16x32_bf16 v[132:135], v[100:103], v[140:143], v[132:135]
    v_exp_f32 v121, v121
    v_mfma_f32_16x16x32_bf16 v[132:135], v[104:107], v[224:227], v[132:135]
    v_exp_f32 v122, v122
    v_mfma_f32_16x16x32_bf16 v[204:207], a[72:75], v[196:199], 0
    v_exp_f32 v123, v123
    v_mfma_f32_16x16x32_bf16 v[204:207], a[76:79], v[184:187], v[204:207]
    v_exp_f32 v177, v177
    v_mfma_f32_16x16x32_bf16 v[204:207], a[80:83], v[172:175], v[204:207]
    v_cvt_pk_bf16_f32 v194, v176, v177
    v_fmac_f32 v233, v201, v201
    v_mfma_f32_16x16x32_bf16 v[204:207], a[84:87], v[148:151], v[204:207]
    v_exp_f32 v178, v178
    v_mfma_f32_16x16x32_bf16 v[204:207], a[88:91], v[112:115], v[204:207]
    v_exp_f32 v179, v179
    v_mfma_f32_16x16x32_bf16 v[204:207], a[92:95], v[228:231], v[204:207]
    v_cvt_pk_bf16_f32 v195, v178, v179
    v_fmac_f32 v233, v202, v202
    v_mfma_f32_16x16x32_bf16 v[176:179], a[96:99], v[196:199], 0
    v_exp_f32 v168, v168
    v_mfma_f32_16x16x32_bf16 v[176:179], a[100:103], v[184:187], v[176:179]
    v_exp_f32 v169, v169
    v_mfma_f32_16x16x32_bf16 v[176:179], a[104:107], v[172:175], v[176:179]
    v_cvt_pk_bf16_f32 v36, v168, v169
    v_fmac_f32 v233, v203, v203
    v_mfma_f32_16x16x32_bf16 v[176:179], a[108:111], v[148:151], v[176:179]
    v_exp_f32 v170, v170
    v_mfma_f32_16x16x32_bf16 v[176:179], a[112:115], v[112:115], v[176:179]
    v_exp_f32 v171, v171
    v_mfma_f32_16x16x32_bf16 v[176:179], a[116:119], v[228:231], v[176:179]
    v_cvt_pk_bf16_f32 v37, v170, v171
    v_fmac_f32 v233, v244, v244
    v_mfma_f32_16x16x32_bf16 v[124:127], a[120:123], v[196:199], 0
    v_fmac_f32 v233, v245, v245
    v_fmac_f32 v233, v246, v246
    v_mfma_f32_16x16x32_bf16 v[168:171], v[28:31], v[36:39], 0
    v_fmac_f32 v233, v247, v247
    v_fmac_f32 v233, v132, v132
    v_mfma_f32_16x16x32_bf16 v[168:171], v[28:31], v[192:195], v[168:171]
    v_fmac_f32 v233, v133, v133
    v_fmac_f32 v233, v134, v134
    v_mfma_f32_16x16x32_bf16 v[140:143], v[116:119], v[36:39], 0
    v_fmac_f32 v233, v135, v135
    v_cvt_pk_bf16_f32 v235, v233, v233
    v_mfma_f32_16x16x32_bf16 v[140:143], v[128:131], v[192:195], v[140:143]
    ds_write_b64 v4, v[234:235] offset:18432
    v_mfma_f32_16x16x32_bf16 v[224:227], v[188:191], v[36:39], 0
    v_rcp_f32 v168, v168
    v_mfma_f32_16x16x32_bf16 v[224:227], v[164:167], v[192:195], v[224:227]
    v_fma_f32 v169, v204, v204, s32
    v_fmac_f32 v169, v205, v205
    v_mfma_f32_16x16x32_bf16 v[248:251], v[216:219], v[36:39], 0
    v_cvt_pk_bf16_f32 v36, v120, v121
    v_cvt_pk_bf16_f32 v37, v122, v123
    v_mfma_f32_16x16x32_bf16 v[248:251], v[144:147], v[192:195], v[248:251]
    v_cvt_pk_bf16_f32 v39, v232, 0
    v_mul_f32 v140, v168, v140
    v_mfma_f32_16x16x32_bf16 v[124:127], a[124:127], v[184:187], v[124:127]
    v_mul_f32 v141, v168, v141
    v_cvt_pk_bf16_f32 v192, v140, v141
    v_mfma_f32_16x16x32_bf16 v[120:123], v[28:31], v[36:39], 0
    v_mul_f32 v142, v168, v142
    v_mul_f32 v143, v168, v143
    v_mfma_f32_16x16x32_bf16 v[120:123], v[28:31], v[160:163], v[120:123]
    v_cvt_pk_bf16_f32 v193, v142, v143
    v_mul_f32 v224, v168, v224
    v_mfma_f32_16x16x32_bf16 v[140:143], v[116:119], v[36:39], 0
    v_mul_f32 v225, v168, v225
    v_cvt_pk_bf16_f32 v194, v224, v225
    v_mfma_f32_16x16x32_bf16 v[140:143], v[128:131], v[160:163], v[140:143]
    v_mul_f32 v226, v168, v226
    v_mul_f32 v227, v168, v227
    v_mfma_f32_16x16x32_bf16 v[128:131], v[188:191], v[36:39], 0
    v_cvt_pk_bf16_f32 v195, v226, v227
    v_mul_f32 v248, v168, v248
    v_mfma_f32_16x16x32_bf16 v[128:131], v[164:167], v[160:163], v[128:131]
    ds_write_b128 v3, v[192:195] offset:6144
    v_mfma_f32_16x16x32_bf16 v[164:167], v[216:219], v[36:39], 0
    v_mul_f32 v249, v168, v249
    v_cvt_pk_bf16_f32 v170, v248, v249
    v_mfma_f32_16x16x32_bf16 v[164:167], v[144:147], v[160:163], v[164:167]
    v_mul_f32 v250, v168, v250
    v_mul_f32 v251, v168, v251
    v_mfma_f32_16x16x32_bf16 v[124:127], a[128:131], v[172:175], v[124:127]
    v_cvt_pk_bf16_f32 v171, v250, v251
    v_fmac_f32 v169, v206, v206
    v_mfma_f32_16x16x32_bf16 v[124:127], a[132:135], v[148:151], v[124:127]
    ds_write_b64 v4, v[170:171] offset:10240
    v_mfma_f32_16x16x32_bf16 v[124:127], a[136:139], v[112:115], v[124:127]
    v_rcp_f32 v120, v120
    v_mfma_f32_16x16x32_bf16 v[124:127], a[140:143], v[228:231], v[124:127]
    v_mul_f32 v140, v120, v140
    v_mul_f32 v141, v120, v141
    v_mfma_f32_16x16x32_bf16 v[216:219], a[0:3], v[196:199], 0
    v_cvt_pk_bf16_f32 v144, v140, v141
    v_mul_f32 v142, v120, v142
    v_mfma_f32_16x16x32_bf16 v[216:219], a[4:7], v[184:187], v[216:219]
    v_mul_f32 v143, v120, v143
    v_cvt_pk_bf16_f32 v145, v142, v143
    v_mfma_f32_16x16x32_bf16 v[216:219], a[8:11], v[172:175], v[216:219]
    v_mul_f32 v128, v120, v128
    v_mul_f32 v129, v120, v129
    v_mfma_f32_16x16x32_bf16 v[216:219], a[12:15], v[148:151], v[216:219]
    v_cvt_pk_bf16_f32 v146, v128, v129
    v_mul_f32 v130, v120, v130
    v_mfma_f32_16x16x32_bf16 v[216:219], a[16:19], v[112:115], v[216:219]
    v_mul_f32 v131, v120, v131
    v_cvt_pk_bf16_f32 v147, v130, v131
    v_mfma_f32_16x16x32_bf16 v[216:219], a[20:23], v[228:231], v[216:219]
    ds_write_b128 v3, v[144:147] offset:12288
    v_mfma_f32_16x16x32_bf16 v[160:163], a[24:27], v[196:199], 0
    v_mul_f32 v164, v120, v164
    v_mul_f32 v165, v120, v165
    v_mfma_f32_16x16x32_bf16 v[160:163], a[28:31], v[184:187], v[160:163]
    v_cvt_pk_bf16_f32 v164, v164, v165
    v_mul_f32 v166, v120, v166
    v_mfma_f32_16x16x32_bf16 v[160:163], a[32:35], v[172:175], v[160:163]
    v_mul_f32 v167, v120, v167
    v_cvt_pk_bf16_f32 v165, v166, v167
    v_mfma_f32_16x16x32_bf16 v[160:163], a[36:39], v[148:151], v[160:163]
    ds_write_b64 v4, v[164:165] offset:16384
    v_mfma_f32_16x16x32_bf16 v[160:163], a[40:43], v[112:115], v[160:163]
    v_fmac_f32 v169, v207, v207
    v_fmac_f32 v169, v176, v176
    v_mfma_f32_16x16x32_bf16 v[160:163], a[44:47], v[228:231], v[160:163]
    v_fmac_f32 v169, v177, v177
    v_fmac_f32 v169, v178, v178
    v_mfma_f32_16x16x32_bf16 v[116:119], a[48:51], v[196:199], 0
    v_fmac_f32 v169, v179, v179
    v_fmac_f32 v169, v124, v124
    v_mfma_f32_16x16x32_bf16 v[116:119], a[52:55], v[184:187], v[116:119]
    v_fmac_f32 v169, v125, v125
    v_fmac_f32 v169, v126, v126
    v_mfma_f32_16x16x32_bf16 v[116:119], a[56:59], v[172:175], v[116:119]
    v_fmac_f32 v169, v127, v127
    v_fma_f32 v168, v216, v216, s32
    v_mfma_f32_16x16x32_bf16 v[116:119], a[60:63], v[148:151], v[116:119]
    v_fmac_f32 v168, v217, v217
    v_fmac_f32 v168, v218, v218
    v_mfma_f32_16x16x32_bf16 v[116:119], a[64:67], v[112:115], v[116:119]
    s_waitcnt lgkmcnt(0)
    v_fmac_f32 v168, v219, v219
    v_xor_b32 v3, 65536, v3
    v_mfma_f32_16x16x32_bf16 v[116:119], a[68:71], v[228:231], v[116:119]
    s_nop 0
    v_xor_b32 v4, 65536, v4
    v_mfma_f32_16x16x32_bf16 v[128:131], v[196:199], a[144:147], 0
    s_nop 0
    v_mfma_f32_16x16x32_bf16 v[128:131], v[184:187], a[148:151], v[128:131]
    s_nop 0
    v_mfma_f32_16x16x32_bf16 v[128:131], v[172:175], a[152:155], v[128:131]
    s_barrier
    v_mfma_f32_16x16x32_bf16 v[128:131], v[148:151], a[156:159], v[128:131]
    v_mfma_f32_16x16x32_bf16 v[128:131], v[112:115], a[160:163], v[128:131]
    v_mfma_f32_16x16x32_bf16 v[128:131], v[228:231], a[164:167], v[128:131]
    s_cbranch_scc1 L_loop_fast3
L_drain:
    ds_read_b128 v[112:115], v2 offset:18432
    ds_read_b128 v[116:119], v2 offset:19456
    ds_read_b128 v[120:123], v2 offset:0
    s_mul_i32 s5, s16, 8064
    s_mov_b32 s12, s42
    ds_read_b128 v[124:127], v2 offset:1024
    s_mov_b32 s13, s43
    s_cmp_ge_u32 s18, 2
    s_cselect_b32 s14, s36, 0
    ds_read_b128 v[128:131], v2 offset:2048
    s_add_u32 s5, s5, 104448
    s_lshl_b32 s3, s16, 6
    s_lshl_b32 s4, s16, 5
    ds_read_b128 v[140:143], v2 offset:3072
    s_add_u32 s4, s4, 256
    ds_read_b128 v[144:147], v2 offset:4096
    ds_read_b128 v[148:151], v2 offset:5120
    v_bfe_u32 v160, v2, 4, 6
    v_lshrrev_b32 v161, 4, v160
    v_and_b32 v162, 15, v160
    v_lshlrev_b32 v163, 9, v161
    v_lshl_add_u32 v163, v162, 4, v163
    v_add_u32 v163, 136704, v163
    s_waitcnt lgkmcnt(7)
    v_mfma_f32_16x16x32_bf16 v[164:167], v[32:35], v[112:115], 0
    s_waitcnt lgkmcnt(5)
    v_xor_b32 v112, 65536, v2
    v_bfe_u32 v113, v162, 1, 2
    v_mfma_f32_16x16x32_bf16 v[164:167], v[32:35], v[116:119], v[164:167]
    s_waitcnt lgkmcnt(4)
    v_xor_b32 v113, v113, v161
    v_lshl_add_u32 v113, v162, 2, v113
    v_lshl_add_u32 v114, v113, 4, s5
    v_mfma_f32_16x16x32_bf16 v[116:119], a[216:219], v[120:123], 0
    s_waitcnt lgkmcnt(3)
    v_lshl_add_u32 v115, v113, 3, s5
    v_lshl_add_u32 v168, v160, 4, s5
    v_lshl_add_u32 v169, v160, 3, s5
    v_mfma_f32_16x16x32_bf16 v[116:119], a[220:223], v[124:127], v[116:119]
    s_waitcnt lgkmcnt(2)
    v_lshlrev_b32 v113, 2, v113
    v_mul_f32 v164, 0x3baaaaab, v164
    v_rsq_f32 v164, v164
    v_mfma_f32_16x16x32_bf16 v[116:119], a[224:227], v[128:131], v[116:119]
    s_waitcnt lgkmcnt(0)
    ds_permute_b32 v170, v113, v15
    ds_permute_b32 v171, v113, v18
    v_mul_f32 v180, v164, v180
    v_mfma_f32_16x16x32_bf16 v[116:119], a[228:231], v[140:143], v[116:119]
    ds_permute_b32 v167, v113, v16
    ds_permute_b32 v172, v113, v19
    v_mul_f32 v181, v164, v181
    v_mfma_f32_16x16x32_bf16 v[116:119], a[232:235], v[144:147], v[116:119]
    ds_permute_b32 v173, v113, v17
    ds_permute_b32 v174, v113, v20
    v_cvt_pk_bf16_f32 v176, v180, v181
    v_mfma_f32_16x16x32_bf16 v[116:119], a[236:239], v[148:151], v[116:119]
    v_mul_f32 v182, v164, v182
    v_mul_f32 v183, v164, v183
    v_cvt_pk_bf16_f32 v177, v182, v183
    v_mfma_f32_16x16x32_bf16 v[180:183], a[240:243], v[120:123], 0
    v_mul_f32 v108, v164, v108
    v_mul_f32 v109, v164, v109
    v_cvt_pk_bf16_f32 v178, v108, v109
    v_mfma_f32_16x16x32_bf16 v[180:183], a[244:247], v[124:127], v[180:183]
    v_mul_f32 v110, v164, v110
    v_mul_f32 v111, v164, v111
    v_cvt_pk_bf16_f32 v179, v110, v111
    v_mfma_f32_16x16x32_bf16 v[180:183], a[248:251], v[128:131], v[180:183]
    s_waitcnt lgkmcnt(4)
    ds_read_b128 v[108:111], v2 offset:6144
    v_mul_f32 v152, v164, v152
    v_mul_f32 v153, v164, v153
    v_mfma_f32_16x16x32_bf16 v[180:183], a[252:255], v[140:143], v[180:183]
    s_waitcnt lgkmcnt(3)
    ds_read_b128 v[184:187], v2 offset:7168
    v_cvt_pk_bf16_f32 v152, v152, v153
    v_mul_f32 v154, v164, v154
    v_mfma_f32_16x16x32_bf16 v[180:183], v[76:79], v[144:147], v[180:183]
    s_waitcnt lgkmcnt(2)
    ds_read_b128 v[188:191], v2 offset:8192
    v_mul_f32 v155, v164, v155
    v_cvt_pk_bf16_f32 v153, v154, v155
    v_mfma_f32_16x16x32_bf16 v[180:183], v[80:83], v[148:151], v[180:183]
    ds_read_b128 v[192:195], v2 offset:9216
    v_fma_f32 v113, v116, v116, s33
    v_fmac_f32 v113, v117, v117
    v_mfma_f32_16x16x32_bf16 v[196:199], v[84:87], v[120:123], 0
    ds_read_b128 v[120:123], v2 offset:10240
    v_fmac_f32 v113, v118, v118
    v_fmac_f32 v113, v119, v119
    v_mfma_f32_16x16x32_bf16 v[196:199], v[88:91], v[124:127], v[196:199]
    ds_read_b128 v[124:127], v2 offset:11264
    v_fmac_f32 v113, v180, v180
    v_fmac_f32 v113, v181, v181
    v_mfma_f32_16x16x32_bf16 v[196:199], v[92:95], v[128:131], v[196:199]
    s_waitcnt lgkmcnt(5)
    buffer_store_dwordx4 v[176:179], v15, s[12:15], s27 offen
    v_fmac_f32 v113, v182, v182
    v_fmac_f32 v113, v183, v183
    v_mul_f32 v175, 0x3baaaaab, v165
    v_mfma_f32_16x16x32_bf16 v[196:199], v[96:99], v[140:143], v[196:199]
    s_waitcnt lgkmcnt(4)
    v_rsq_f32 v175, v175
    v_mul_f32 v154, 0x3baaaaab, v166
    v_mfma_f32_16x16x32_bf16 v[196:199], v[100:103], v[144:147], v[196:199]
    s_waitcnt lgkmcnt(3)
    v_mul_f32 v136, v175, v136
    v_mul_f32 v137, v175, v137
    v_cvt_pk_bf16_f32 v128, v136, v137
    v_mfma_f32_16x16x32_bf16 v[196:199], v[104:107], v[148:151], v[196:199]
    s_waitcnt lgkmcnt(2)
    v_mul_f32 v138, v175, v138
    v_mul_f32 v139, v175, v139
    v_cvt_pk_bf16_f32 v129, v138, v139
    v_mfma_f32_16x16x32_bf16 v[136:139], a[216:219], v[108:111], 0
    s_waitcnt lgkmcnt(1)
    v_mul_f32 v208, v175, v208
    v_mul_f32 v209, v175, v209
    v_fmac_f32 v113, v196, v196
    v_mfma_f32_16x16x32_bf16 v[136:139], a[220:223], v[184:187], v[136:139]
    s_waitcnt lgkmcnt(0)
    v_fmac_f32 v113, v197, v197
    v_fmac_f32 v113, v198, v198
    v_fmac_f32 v113, v199, v199
    v_mfma_f32_16x16x32_bf16 v[136:139], a[224:227], v[188:191], v[136:139]
    v_cvt_pk_bf16_f32 v130, v208, v209
    v_mul_f32 v210, v175, v210
    v_mul_f32 v211, v175, v211
    v_mfma_f32_16x16x32_bf16 v[136:139], a[228:231], v[192:195], v[136:139]
    v_cvt_pk_bf16_f32 v131, v210, v211
    v_mul_f32 v156, v175, v156
    v_mul_f32 v157, v175, v157
    v_mfma_f32_16x16x32_bf16 v[136:139], a[232:235], v[120:123], v[136:139]
    v_cvt_pk_bf16_f32 v164, v156, v157
    v_mul_f32 v158, v175, v158
    v_mul_f32 v159, v175, v159
    v_mfma_f32_16x16x32_bf16 v[136:139], a[236:239], v[124:127], v[136:139]
    v_cvt_pk_bf16_f32 v165, v158, v159
    v_mov_b32 v166, 0x40000000
    v_rsq_f32 v154, v154
    v_mfma_f32_16x16x32_bf16 v[140:143], a[240:243], v[108:111], 0
    v_mul_f32 v200, v154, v200
    v_mul_f32 v201, v154, v201
    v_cvt_pk_bf16_f32 v144, v200, v201
    v_mfma_f32_16x16x32_bf16 v[140:143], a[244:247], v[184:187], v[140:143]
    v_fma_f32 v175, v136, v136, s33
    v_fmac_f32 v175, v137, v137
    v_fmac_f32 v175, v138, v138
    v_mfma_f32_16x16x32_bf16 v[140:143], a[248:251], v[188:191], v[140:143]
    ds_read_b128 v[148:151], v2 offset:12288
    v_fmac_f32 v175, v139, v139
    v_mul_f32 v202, v154, v202
    v_mfma_f32_16x16x32_bf16 v[140:143], a[252:255], v[192:195], v[140:143]
    ds_read_b128 v[156:159], v2 offset:13312
    v_mul_f32 v203, v154, v203
    v_cvt_pk_bf16_f32 v145, v202, v203
    v_mfma_f32_16x16x32_bf16 v[140:143], v[76:79], v[120:123], v[140:143]
    ds_read_b128 v[176:179], v2 offset:14336
    v_mul_f32 v244, v154, v244
    v_mul_f32 v245, v154, v245
    v_mfma_f32_16x16x32_bf16 v[140:143], v[80:83], v[124:127], v[140:143]
    ds_read_b128 v[200:203], v2 offset:15360
    v_cvt_pk_bf16_f32 v146, v244, v245
    v_mul_f32 v246, v154, v246
    v_mfma_f32_16x16x32_bf16 v[204:207], v[84:87], v[108:111], 0
    ds_read_b128 v[108:111], v2 offset:16384
    v_mul_f32 v247, v154, v247
    v_cvt_pk_bf16_f32 v147, v246, v247
    v_mfma_f32_16x16x32_bf16 v[204:207], v[88:91], v[184:187], v[204:207]
    ds_read_b128 v[184:187], v2 offset:17408
    v_fmac_f32 v175, v140, v140
    v_fmac_f32 v175, v141, v141
    v_mfma_f32_16x16x32_bf16 v[204:207], v[92:95], v[188:191], v[204:207]
    s_waitcnt lgkmcnt(5)
    buffer_store_dwordx2 v[152:153], v18, s[12:15], s27 offen
    v_fmac_f32 v175, v142, v142
    v_mfma_f32_16x16x32_bf16 v[204:207], v[96:99], v[192:195], v[204:207]
    s_waitcnt lgkmcnt(4)
    ds_write_b128 v114, v[144:147] offset:3072
    v_mfma_f32_16x16x32_bf16 v[204:207], v[100:103], v[120:123], v[204:207]
    s_waitcnt lgkmcnt(4)
    v_fmac_f32 v175, v143, v143
    v_mul_f32 v132, v154, v132
    v_mul_f32 v133, v154, v133
    v_mfma_f32_16x16x32_bf16 v[204:207], v[104:107], v[124:127], v[204:207]
    s_waitcnt lgkmcnt(3)
    v_cvt_pk_bf16_f32 v132, v132, v133
    v_mul_f32 v134, v154, v134
    v_mul_f32 v135, v154, v135
    v_mfma_f32_16x16x32_bf16 v[120:123], a[216:219], v[148:151], 0
    s_waitcnt lgkmcnt(2)
    ds_read_b128 v[124:127], v168 offset:3072
    v_cvt_pk_bf16_f32 v133, v134, v135
    v_fmac_f32 v175, v204, v204
    v_mfma_f32_16x16x32_bf16 v[120:123], a[220:223], v[156:159], v[120:123]
    s_waitcnt lgkmcnt(2)
    ds_write_b64 v115, v[132:133] offset:4096
    v_mfma_f32_16x16x32_bf16 v[120:123], a[224:227], v[176:179], v[120:123]
    v_fmac_f32 v175, v205, v205
    v_fmac_f32 v175, v206, v206
    v_fmac_f32 v175, v207, v207
    v_mfma_f32_16x16x32_bf16 v[120:123], a[228:231], v[200:203], v[120:123]
    ds_read_b64 v[132:133], v169 offset:4096
    v_cvt_pk_bf16_f32 v134, v113, v175
    v_cvt_pk_bf16_f32 v135, v175, v175
    v_mfma_f32_16x16x32_bf16 v[120:123], a[232:235], v[108:111], v[120:123]
    ds_write_b64 v4, v[134:135] offset:0
    v_mfma_f32_16x16x32_bf16 v[120:123], a[236:239], v[184:187], v[120:123]
    v_lshrrev_b32 v113, 2, v160
    v_lshrrev_b32 v175, 3, v160
    v_xor_b32 v175, v175, v160
    v_mfma_f32_16x16x32_bf16 v[144:147], a[240:243], v[148:151], 0
    s_waitcnt lgkmcnt(3)
    v_and_b32 v175, 3, v175
    v_add_u32 v113, 0, v113
    v_mul_u32_u24 v160, s20, v113
    v_mfma_f32_16x16x32_bf16 v[144:147], a[244:247], v[156:159], v[144:147]
    v_fma_f32 v134, v120, v120, s33
    v_fmac_f32 v134, v121, v121
    v_fmac_f32 v134, v122, v122
    v_mfma_f32_16x16x32_bf16 v[144:147], a[248:251], v[176:179], v[144:147]
    ds_read_b128 v[152:155], v163 offset:0
    v_fmac_f32 v134, v123, v123
    v_add_u32 v160, s38, v160
    v_mfma_f32_16x16x32_bf16 v[144:147], a[252:255], v[200:203], v[144:147]
    s_waitcnt lgkmcnt(2)
    ds_read_b128 v[188:191], v163 offset:2048
    v_mul_u32_u24 v135, 911, v160
    v_lshrrev_b32 v135, 16, v135
    v_mfma_f32_16x16x32_bf16 v[144:147], v[76:79], v[108:111], v[144:147]
    s_waitcnt lgkmcnt(2)
    ds_read_b128 v[192:195], v163 offset:4096
    v_mul_u32_u24 v135, s22, v135
    v_mad_u32_u24 v135, v113, s21, v135
    v_mfma_f32_16x16x32_bf16 v[144:147], v[80:83], v[184:187], v[144:147]
    s_barrier
    ds_read_b128 v[208:211], v112 offset:0
    ds_read_b128 v[212:215], v112 offset:1024
    v_cmp_gt_u32 vcc, s17, v113
    v_mfma_f32_16x16x32_bf16 v[216:219], v[84:87], v[148:151], 0
    ds_read_b128 v[148:151], v163 offset:6144
    ds_read_b128 v[220:223], v163 offset:8192
    v_add_u32 v113, s7, v135
    v_mfma_f32_16x16x32_bf16 v[216:219], v[88:91], v[156:159], v[216:219]
    ds_read_b128 v[156:159], v163 offset:10240
    v_fmac_f32 v134, v144, v144
    v_fmac_f32 v134, v145, v145
    v_mfma_f32_16x16x32_bf16 v[216:219], v[92:95], v[176:179], v[216:219]
    s_waitcnt lgkmcnt(7)
    buffer_store_dwordx4 v[128:131], v16, s[12:15], s27 offen
    v_fmac_f32 v134, v146, v146
    v_fmac_f32 v134, v147, v147
    v_cndmask_b32 v113, v166, v113, vcc
    v_mfma_f32_16x16x32_bf16 v[216:219], v[96:99], v[200:203], v[216:219]
    s_waitcnt lgkmcnt(6)
    v_lshl_add_u32 v135, v175, 4, v113
    v_add_u32 v135, s3, v135
    v_lshl_add_u32 v113, v175, 3, v113
    v_mfma_f32_16x16x32_bf16 v[216:219], v[100:103], v[108:111], v[216:219]
    s_waitcnt lgkmcnt(5)
    v_add_u32 v113, s4, v113
    v_add_u32 v175, 16, v162
    v_mul_u32_u24 v160, s20, v175
    v_mfma_f32_16x16x32_bf16 v[216:219], v[104:107], v[184:187], v[216:219]
    s_waitcnt lgkmcnt(3)
    v_add_u32 v160, s38, v160
    v_mul_u32_u24 v160, 911, v160
    v_mfma_f32_16x16x32_bf16 v[108:111], v[32:35], v[208:211], 0
    s_waitcnt lgkmcnt(1)
    v_lshrrev_b32 v160, 16, v160
    v_mul_u32_u24 v160, s22, v160
    v_mfma_f32_16x16x32_bf16 v[108:111], v[32:35], v[212:215], v[108:111]
    s_waitcnt lgkmcnt(0)
    v_fmac_f32 v134, v216, v216
    v_fmac_f32 v134, v217, v217
    v_fmac_f32 v134, v218, v218
    v_mfma_f32_16x16x32_bf16 v[128:131], a[216:219], v[152:155], 0
    v_fmac_f32 v134, v219, v219
    v_cvt_pk_bf16_f32 v176, v134, v134
    v_cvt_pk_bf16_f32 v177, v134, v134
    v_mfma_f32_16x16x32_bf16 v[128:131], a[220:223], v[188:191], v[128:131]
    ds_write_b64 v4, v[176:177] offset:2048
    v_mfma_f32_16x16x32_bf16 v[128:131], a[224:227], v[192:195], v[128:131]
    v_mad_u32_u24 v160, v175, s21, v160
    v_cmp_gt_u32 vcc, s17, v175
    v_add_u32 v134, s7, v160
    v_mfma_f32_16x16x32_bf16 v[128:131], a[228:231], v[148:151], v[128:131]
    v_cndmask_b32 v134, v166, v134, vcc
    v_lshl_add_u32 v175, v161, 4, v134
    v_add_u32 v175, s3, v175
    v_mfma_f32_16x16x32_bf16 v[128:131], a[232:235], v[220:223], v[128:131]
    v_lshl_add_u32 v134, v161, 3, v134
    v_add_u32 v134, s4, v134
    v_mul_f32 v166, 0x3baaaaab, v108
    v_mfma_f32_16x16x32_bf16 v[128:131], a[236:239], v[156:159], v[128:131]
    v_rsq_f32 v166, v166
    v_mul_f32 v160, 0x3baaaaab, v109
    v_mfma_f32_16x16x32_bf16 v[108:111], a[240:243], v[152:155], 0
    v_mul_f32 v116, v166, v116
    v_mul_f32 v117, v166, v117
    v_cvt_pk_bf16_f32 v116, v116, v117
    v_mfma_f32_16x16x32_bf16 v[108:111], a[244:247], v[188:191], v[108:111]
    buffer_store_dwordx2 v[164:165], v19, s[12:15], s27 offen
    v_fma_f32 v161, v128, v128, s33
    v_mfma_f32_16x16x32_bf16 v[108:111], a[248:251], v[192:195], v[108:111]
    ds_read_b128 v[176:179], v163 offset:256
    v_fmac_f32 v161, v129, v129
    v_fmac_f32 v161, v130, v130
    v_mfma_f32_16x16x32_bf16 v[108:111], a[252:255], v[148:151], v[108:111]
    ds_read_b128 v[184:187], v163 offset:2304
    v_fmac_f32 v161, v131, v131
    v_mul_f32 v118, v166, v118
    v_mfma_f32_16x16x32_bf16 v[108:111], v[76:79], v[220:223], v[108:111]
    ds_read_b128 v[200:203], v163 offset:4352
    v_mul_f32 v119, v166, v119
    v_cvt_pk_bf16_f32 v117, v118, v119
    v_mfma_f32_16x16x32_bf16 v[108:111], v[80:83], v[156:159], v[108:111]
    ds_read_b128 v[208:211], v163 offset:6400
    v_mul_f32 v180, v166, v180
    v_mul_f32 v181, v166, v181
    v_mfma_f32_16x16x32_bf16 v[212:215], v[84:87], v[152:155], 0
    ds_read_b128 v[152:155], v163 offset:8448
    v_cvt_pk_bf16_f32 v118, v180, v181
    v_mul_f32 v182, v166, v182
    v_mfma_f32_16x16x32_bf16 v[212:215], v[88:91], v[188:191], v[212:215]
    ds_read_b128 v[188:191], v163 offset:10496
    v_fmac_f32 v161, v108, v108
    v_fmac_f32 v161, v109, v109
    v_mfma_f32_16x16x32_bf16 v[212:215], v[92:95], v[192:195], v[212:215]
    s_waitcnt lgkmcnt(5)
    v_fmac_f32 v161, v110, v110
    v_fmac_f32 v161, v111, v111
    v_mul_f32 v183, v166, v183
    v_mfma_f32_16x16x32_bf16 v[212:215], v[96:99], v[148:151], v[212:215]
    s_waitcnt lgkmcnt(4)
    v_cvt_pk_bf16_f32 v119, v182, v183
    v_mul_f32 v196, v166, v196
    v_mul_f32 v197, v166, v197
    v_mfma_f32_16x16x32_bf16 v[212:215], v[100:103], v[220:223], v[212:215]
    s_waitcnt lgkmcnt(3)
    ds_write_b128 v114, v[116:119] offset:4608
    v_mfma_f32_16x16x32_bf16 v[212:215], v[104:107], v[156:159], v[212:215]
    s_waitcnt lgkmcnt(3)
    v_cvt_pk_bf16_f32 v162, v196, v197
    v_mul_f32 v198, v166, v198
    v_mul_f32 v199, v166, v199
    v_mfma_f32_16x16x32_bf16 v[116:119], a[216:219], v[176:179], 0
    s_waitcnt lgkmcnt(2)
    v_rsq_f32 v160, v160
    v_cvt_pk_bf16_f32 v163, v198, v199
    v_mfma_f32_16x16x32_bf16 v[116:119], a[220:223], v[184:187], v[116:119]
    s_waitcnt lgkmcnt(1)
    ds_read_b128 v[148:151], v168 offset:4608
    v_fmac_f32 v161, v212, v212
    v_fmac_f32 v161, v213, v213
    v_mfma_f32_16x16x32_bf16 v[116:119], a[224:227], v[200:203], v[116:119]
    buffer_store_dwordx4 v[124:127], v173, s[12:15], s27 offen
    ds_write_b64 v115, v[162:163] offset:5632
    v_mfma_f32_16x16x32_bf16 v[116:119], a[228:231], v[208:211], v[116:119]
    v_fmac_f32 v161, v214, v214
    v_fmac_f32 v161, v215, v215
    v_cvt_pk_bf16_f32 v162, v161, v161
    v_mfma_f32_16x16x32_bf16 v[116:119], a[232:235], v[152:155], v[116:119]
    ds_read_b64 v[164:165], v169 offset:5632
    v_cvt_pk_bf16_f32 v163, v161, v161
    v_mul_f32 v136, v160, v136
    v_mfma_f32_16x16x32_bf16 v[116:119], a[236:239], v[188:191], v[116:119]
    ds_write_b64 v4, v[162:163] offset:4096
    v_mfma_f32_16x16x32_bf16 v[124:127], a[240:243], v[176:179], 0
    buffer_store_dwordx2 v[132:133], v174, s[12:15], s27 offen
    v_mul_f32 v137, v160, v137
    v_mfma_f32_16x16x32_bf16 v[124:127], a[244:247], v[184:187], v[124:127]
    s_mov_b32 s14, s36
    v_cvt_pk_bf16_f32 v136, v136, v137
    v_mul_f32 v138, v160, v138
    v_fma_f32 v166, v116, v116, s33
    v_mfma_f32_16x16x32_bf16 v[124:127], a[248:251], v[200:203], v[124:127]
    s_waitcnt lgkmcnt(2)
    v_fmac_f32 v166, v117, v117
    v_fmac_f32 v166, v118, v118
    v_fmac_f32 v166, v119, v119
    v_mfma_f32_16x16x32_bf16 v[124:127], a[252:255], v[208:211], v[124:127]
    v_mul_f32 v139, v160, v139
    v_cvt_pk_bf16_f32 v137, v138, v139
    v_mul_f32 v140, v160, v140
    v_mfma_f32_16x16x32_bf16 v[124:127], v[76:79], v[152:155], v[124:127]
    s_waitcnt lgkmcnt(1)
    buffer_store_dwordx4 v[148:151], v170, s[12:15], s26 offen
    v_mul_f32 v141, v160, v141
    v_cvt_pk_bf16_f32 v138, v140, v141
    v_mul_f32 v142, v160, v142
    v_mfma_f32_16x16x32_bf16 v[124:127], v[80:83], v[188:191], v[124:127]
    s_waitcnt lgkmcnt(0)
    v_mul_f32 v143, v160, v143
    v_cvt_pk_bf16_f32 v139, v142, v143
    v_mul_f32 v204, v160, v204
    v_mfma_f32_16x16x32_bf16 v[140:143], v[84:87], v[176:179], 0
    s_barrier
    ds_read_b128 v[148:151], v112 offset:2048
    ds_read_b128 v[156:159], v112 offset:3072
    v_fmac_f32 v166, v124, v124
    v_mfma_f32_16x16x32_bf16 v[140:143], v[88:91], v[184:187], v[140:143]
    ds_read_b128 v[176:179], v112 offset:4096
    ds_read_b128 v[180:183], v112 offset:5120
    v_fmac_f32 v166, v125, v125
    v_mfma_f32_16x16x32_bf16 v[140:143], v[92:95], v[200:203], v[140:143]
    buffer_store_dwordx2 v[164:165], v171, s[12:15], s26 offen
    v_fmac_f32 v166, v126, v126
    v_mfma_f32_16x16x32_bf16 v[140:143], v[96:99], v[208:211], v[140:143]
    ds_write_b128 v114, v[136:139] offset:6144
    v_mfma_f32_16x16x32_bf16 v[140:143], v[100:103], v[152:155], v[140:143]
    v_fmac_f32 v166, v127, v127
    v_mul_f32 v205, v160, v205
    v_cvt_pk_bf16_f32 v132, v204, v205
    v_mfma_f32_16x16x32_bf16 v[140:143], v[104:107], v[188:191], v[140:143]
    ds_read_b128 v[136:139], v168 offset:6144
    s_waitcnt lgkmcnt(4)
    v_mfma_f32_16x16x32_bf16 v[152:155], v[32:35], v[148:151], 0
    v_mul_f32 v206, v160, v206
    v_mul_f32 v207, v160, v207
    v_mfma_f32_16x16x32_bf16 v[152:155], v[32:35], v[156:159], v[152:155]
    s_waitcnt lgkmcnt(2)
    v_cvt_pk_bf16_f32 v133, v206, v207
    v_fmac_f32 v166, v140, v140
    v_mfma_f32_16x16x32_bf16 v[148:151], v[32:35], v[176:179], 0
    ds_write_b64 v115, v[132:133] offset:7168
    v_mfma_f32_16x16x32_bf16 v[148:151], v[32:35], v[180:183], v[148:151]
    v_fmac_f32 v166, v141, v141
    v_fmac_f32 v166, v142, v142
    v_fmac_f32 v166, v143, v143
    v_cvt_pk_bf16_f32 v132, v166, v166
    v_cvt_pk_bf16_f32 v133, v166, v166
    ds_write_b64 v4, v[132:133] offset:6144
    v_mul_f32 v132, 0x3baaaaab, v152
    s_waitcnt lgkmcnt(2)
    buffer_store_dwordx4 v[136:139], v167, s[12:15], s26 offen
    ds_read_b64 v[170:171], v169 offset:7168
    v_rsq_f32 v132, v132
    v_mul_f32 v133, 0x3baaaaab, v148
    v_mul_f32 v120, v132, v120
    v_mul_f32 v121, v132, v121
    v_cvt_pk_bf16_f32 v120, v120, v121
    v_mul_f32 v122, v132, v122
    v_mul_f32 v123, v132, v123
    v_cvt_pk_bf16_f32 v121, v122, v123
    v_mul_f32 v144, v132, v144
    v_mul_f32 v145, v132, v145
    v_cvt_pk_bf16_f32 v122, v144, v145
    v_mul_f32 v146, v132, v146
    v_mul_f32 v147, v132, v147
    v_cvt_pk_bf16_f32 v123, v146, v147
    ds_write_b128 v114, v[120:123] offset:0
    s_waitcnt lgkmcnt(2)
    s_barrier
    v_mul_f32 v216, v132, v216
    v_mul_f32 v217, v132, v217
    v_cvt_pk_bf16_f32 v216, v216, v217
    s_waitcnt lgkmcnt(1)
    buffer_store_dwordx2 v[170:171], v172, s[12:15], s26 offen
    ds_read_b128 v[120:123], v112 offset:6144
    ds_read_b128 v[136:139], v112 offset:7168
    ds_read_b128 v[144:147], v168 offset:0
    v_mul_f32 v218, v132, v218
    v_mul_f32 v219, v132, v219
    v_cvt_pk_bf16_f32 v217, v218, v219
    ds_write_b64 v115, v[216:217] offset:1024
    v_rsq_f32 v133, v133
    ds_read_b64 v[170:171], v169 offset:1024
    v_mul_f32 v128, v133, v128
    v_mul_f32 v129, v133, v129
    v_cvt_pk_bf16_f32 v128, v128, v129
    v_mul_f32 v130, v133, v130
    v_mul_f32 v131, v133, v131
    v_cvt_pk_bf16_f32 v129, v130, v131
    v_mul_f32 v108, v133, v108
    v_mul_f32 v109, v133, v109
    v_cvt_pk_bf16_f32 v130, v108, v109
    v_mul_f32 v110, v133, v110
    v_mul_f32 v111, v133, v111
    v_cvt_pk_bf16_f32 v131, v110, v111
    s_waitcnt lgkmcnt(4)
    v_mfma_f32_16x16x32_bf16 v[108:111], v[32:35], v[120:123], 0
    s_waitcnt lgkmcnt(2)
    buffer_store_dwordx4 v[144:147], v173, s[12:15], s26 offen
    ds_write_b128 v114, v[128:131] offset:1536
    v_mfma_f32_16x16x32_bf16 v[108:111], v[32:35], v[136:139], v[108:111]
    v_mul_f32 v212, v133, v212
    v_mul_f32 v213, v133, v213
    v_cvt_pk_bf16_f32 v132, v212, v213
    s_waitcnt lgkmcnt(1)
    v_mul_f32 v214, v133, v214
    ds_read_b128 v[120:123], v168 offset:1536
    v_mul_f32 v215, v133, v215
    buffer_store_dwordx2 v[170:171], v174, s[12:15], s26 offen
    v_cvt_pk_bf16_f32 v133, v214, v215
    ds_write_b64 v115, v[132:133] offset:2560
    v_mul_f32 v132, 0x3baaaaab, v108
    v_rsq_f32 v132, v132
    ds_read_b64 v[172:173], v169 offset:2560
    v_mul_f32 v116, v132, v116
    v_mul_f32 v117, v132, v117
    v_cvt_pk_bf16_f32 v108, v116, v117
    v_mul_f32 v118, v132, v118
    v_mul_f32 v119, v132, v119
    v_cvt_pk_bf16_f32 v109, v118, v119
    v_mul_f32 v124, v132, v124
    v_mul_f32 v125, v132, v125
    v_cvt_pk_bf16_f32 v110, v124, v125
    v_mul_f32 v126, v132, v126
    s_waitcnt lgkmcnt(2)
    buffer_store_dwordx4 v[120:123], v135, s[12:15], 0 offen
    v_mul_f32 v127, v132, v127
    v_cvt_pk_bf16_f32 v111, v126, v127
    v_mul_f32 v140, v132, v140
    v_mul_f32 v141, v132, v141
    v_cvt_pk_bf16_f32 v140, v140, v141
    v_mul_f32 v142, v132, v142
    v_mul_f32 v143, v132, v143
    v_cvt_pk_bf16_f32 v141, v142, v143
    s_waitcnt lgkmcnt(0)
    buffer_store_dwordx2 v[172:173], v113, s[12:15], 0 offen
    buffer_store_dwordx4 v[108:111], v175, s[12:15], 0 offen
    buffer_store_dwordx2 v[140:141], v134, s[12:15], 0 offen
L_done:
    s_endpgm
L_safe:
    s_cmp_eq_u32 s16, 1
    s_cbranch_scc1 L_loop_safe1
    s_cmp_eq_u32 s16, 2
    s_cbranch_scc1 L_loop_safe2
    s_cmp_eq_u32 s16, 3
    s_cbranch_scc1 L_loop_safe3
    s_branch L_loop_safe0
.p2align 6
L_loop_safe0:
    v_mfma_f32_16x16x32_bf16 v[188:191], v[196:199], a[168:171], 0
    s_add_u32 s12, s42, s27
    ds_read_b128 v[192:195], v2 offset:18432
    ds_read_b128 v[164:167], v2 offset:19456
    v_mfma_f32_16x16x32_bf16 v[188:191], v[184:187], a[172:175], v[188:191]
    s_addc_u32 s13, s43, 0
    ds_read_b128 v[120:123], v0 offset:26624
    ds_read_b128 v[140:143], v1 offset:26624
    v_mfma_f32_16x16x32_bf16 v[188:191], v[172:175], a[176:179], v[188:191]
    s_sub_u32 s14, s36, s27
    v_fmac_f32 v168, v160, v160
    v_fmac_f32 v168, v161, v161
    v_mfma_f32_16x16x32_bf16 v[188:191], v[148:151], a[180:183], v[188:191]
    s_cmp_ge_u32 s18, 2
    ds_read_b128 v[232:235], v0 offset:26752
    ds_read_b128 v[224:227], v1 offset:26752
    v_mfma_f32_16x16x32_bf16 v[188:191], v[112:115], a[184:187], v[188:191]
    s_cselect_b32 s14, s14, 0
    v_fmac_f32 v168, v162, v162
    v_fmac_f32 v168, v163, v163
    v_mfma_f32_16x16x32_bf16 v[188:191], v[228:231], a[188:191], v[188:191]
    s_add_u32 s34, s18, 2
    ds_read_b128 v[212:215], v0 offset:26880
    ds_read_b128 v[144:147], v1 offset:26880
    v_mfma_f32_16x16x32_bf16 v[220:223], v[196:199], a[192:195], 0
    s_add_u32 s8, s40, s23
    v_fmac_f32 v168, v116, v116
    v_fmac_f32 v168, v117, v117
    v_mfma_f32_16x16x32_bf16 v[220:223], v[184:187], a[196:199], v[220:223]
    s_addc_u32 s9, s41, 0
    v_fmac_f32 v168, v118, v118
    v_fmac_f32 v168, v119, v119
    v_mfma_f32_16x16x32_bf16 v[220:223], v[172:175], a[200:203], v[220:223]
    s_waitcnt lgkmcnt(6)
    v_cvt_pk_bf16_f32 v36, v168, v169
    v_cvt_pk_bf16_f32 v236, v128, v129
    v_mfma_f32_16x16x32_bf16 v[172:175], v[32:35], v[192:195], 0
    s_waitcnt lgkmcnt(4)
    v_cvt_pk_bf16_f32 v237, v130, v131
    v_cvt_pk_bf16_f32 v128, v188, v189
    v_mfma_f32_16x16x32_bf16 v[168:171], v[32:35], v[36:39], 0
    s_sub_u32 s10, s36, s23
    v_cvt_pk_bf16_f32 v129, v190, v191
    s_cmp_lt_u32 s34, s17
    v_mfma_f32_16x16x32_bf16 v[172:175], v[32:35], v[164:167], v[172:175]
    s_cselect_b32 s10, s10, 0
    s_add_u32 m0, s28, 0
    s_mov_b32 s27, s26
    v_mfma_f32_16x16x32_bf16 v[220:223], v[148:151], a[204:207], v[220:223]
    s_mov_b32 s26, s25
    v_rsq_f32 v169, v169
    v_mfma_f32_16x16x32_bf16 v[220:223], v[112:115], a[208:211], v[220:223]
    s_mov_b32 s25, s24
    v_rsq_f32 v168, v168
    v_mfma_f32_16x16x32_bf16 v[220:223], v[228:231], a[212:215], v[220:223]
    s_mov_b32 s24, s23
    v_mul_f32 v168, s31, v168
    v_mul_f32 v171, 0x3baaaaab, v172
    v_mfma_f32_16x16x32_bf16 v[112:115], a[72:75], v[120:123], 0
    s_waitcnt lgkmcnt(0)
    v_rsq_f32 v171, v171
    v_mfma_f32_16x16x32_bf16 v[112:115], a[76:79], v[140:143], v[112:115]
    v_mul_f32 v172, 0x3baaaaab, v173
    v_cvt_pk_bf16_f32 v164, v220, v221
    v_mfma_f32_16x16x32_bf16 v[112:115], a[80:83], v[232:235], v[112:115]
    v_cvt_pk_bf16_f32 v165, v222, v223
    v_mul_f32 v170, 0x3baaaaab, v174
    v_mfma_f32_16x16x32_bf16 v[112:115], a[84:87], v[224:227], v[112:115]
    v_rsq_f32 v172, v172
    v_mfma_f32_16x16x32_bf16 v[112:115], a[88:91], v[212:215], v[112:115]
    v_rsq_f32 v170, v170
    v_mfma_f32_16x16x32_bf16 v[112:115], a[92:95], v[144:147], v[112:115]
    v_mul_f32 v180, v171, v180
    v_mul_f32 v181, v171, v181
    v_mfma_f32_16x16x32_bf16 v[148:151], a[96:99], v[120:123], 0
    v_cvt_pk_bf16_f32 v180, v180, v181
    v_mul_f32 v182, v171, v182
    v_mfma_f32_16x16x32_bf16 v[148:151], a[100:103], v[140:143], v[148:151]
    v_mul_f32 v183, v171, v183
    v_cvt_pk_bf16_f32 v181, v182, v183
    v_mfma_f32_16x16x32_bf16 v[148:151], a[104:107], v[232:235], v[148:151]
    v_mul_f32 v108, v171, v108
    v_mul_f32 v109, v171, v109
    v_mfma_f32_16x16x32_bf16 v[148:151], a[108:111], v[224:227], v[148:151]
    v_cvt_pk_bf16_f32 v182, v108, v109
    v_mul_f32 v110, v171, v110
    v_mfma_f32_16x16x32_bf16 v[148:151], a[112:115], v[212:215], v[148:151]
    v_mul_f32 v111, v171, v111
    v_cvt_pk_bf16_f32 v183, v110, v111
    v_mfma_f32_16x16x32_bf16 v[148:151], a[116:119], v[144:147], v[148:151]
    buffer_store_dwordx4 v[180:183], v15, s[12:15], 0 offen
    v_mul_f32 v152, v171, v152
    v_mul_f32 v153, v171, v153
    v_cvt_pk_bf16_f32 v130, v152, v153
    v_mul_f32 v154, v171, v154
    v_mfma_f32_16x16x32_bf16 v[180:183], a[120:123], v[120:123], 0
    v_mul_f32 v155, v171, v155
    v_cvt_pk_bf16_f32 v131, v154, v155
    v_mfma_f32_16x16x32_bf16 v[180:183], a[124:127], v[140:143], v[180:183]
    v_mul_f32 v204, v169, v204
    v_mul_f32 v205, v169, v205
    v_mfma_f32_16x16x32_bf16 v[180:183], a[128:131], v[232:235], v[180:183]
    v_cvt_pk_bf16_f32 v184, v204, v205
    v_mul_f32 v206, v169, v206
    v_mfma_f32_16x16x32_bf16 v[180:183], a[132:135], v[224:227], v[180:183]
    v_mul_f32 v207, v169, v207
    v_cvt_pk_bf16_f32 v185, v206, v207
    v_mfma_f32_16x16x32_bf16 v[180:183], a[136:139], v[212:215], v[180:183]
    v_mul_f32 v176, v169, v176
    v_mul_f32 v177, v169, v177
    v_mfma_f32_16x16x32_bf16 v[180:183], a[140:143], v[144:147], v[180:183]
    v_cvt_pk_bf16_f32 v186, v176, v177
    v_mul_f32 v178, v169, v178
    v_mfma_f32_16x16x32_bf16 v[108:111], a[0:3], v[120:123], 0
    v_mul_f32 v179, v169, v179
    v_cvt_pk_bf16_f32 v187, v178, v179
    v_mfma_f32_16x16x32_bf16 v[108:111], a[4:7], v[140:143], v[108:111]
    v_mul_f32 v124, v169, v124
    v_mul_f32 v125, v169, v125
    v_mfma_f32_16x16x32_bf16 v[108:111], a[8:11], v[232:235], v[108:111]
    v_cvt_pk_bf16_f32 v178, v124, v125
    v_mul_f32 v126, v169, v126
    v_mfma_f32_16x16x32_bf16 v[108:111], a[12:15], v[224:227], v[108:111]
    v_mul_f32 v127, v169, v127
    v_cvt_pk_bf16_f32 v179, v126, v127
    v_mfma_f32_16x16x32_bf16 v[108:111], a[16:19], v[212:215], v[108:111]
    v_mul_f32 v216, v168, v216
    v_mul_f32 v217, v168, v217
    v_mfma_f32_16x16x32_bf16 v[108:111], a[20:23], v[144:147], v[108:111]
    v_cvt_pk_bf16_f32 v124, v216, v217
    v_mul_f32 v218, v168, v218
    v_mfma_f32_16x16x32_bf16 v[152:155], a[24:27], v[120:123], 0
    v_mul_f32 v219, v168, v219
    v_cvt_pk_bf16_f32 v125, v218, v219
    v_mfma_f32_16x16x32_bf16 v[152:155], a[28:31], v[140:143], v[152:155]
    v_mul_f32 v160, v168, v160
    v_mul_f32 v161, v168, v161
    v_mfma_f32_16x16x32_bf16 v[152:155], a[32:35], v[232:235], v[152:155]
    v_cvt_pk_bf16_f32 v126, v160, v161
    v_mul_f32 v162, v168, v162
    v_mfma_f32_16x16x32_bf16 v[152:155], a[36:39], v[224:227], v[152:155]
    v_mul_f32 v163, v168, v163
    v_cvt_pk_bf16_f32 v127, v162, v163
    v_mfma_f32_16x16x32_bf16 v[152:155], a[40:43], v[212:215], v[152:155]
    buffer_store_dwordx2 v[130:131], v18, s[12:15], 0 offen
    v_mul_f32 v116, v168, v116
    v_mul_f32 v117, v168, v117
    v_mfma_f32_16x16x32_bf16 v[152:155], a[44:47], v[144:147], v[152:155]
    v_cvt_pk_bf16_f32 v176, v116, v117
    v_mul_f32 v118, v168, v118
    v_mfma_f32_16x16x32_bf16 v[160:163], a[48:51], v[120:123], 0
    v_mul_f32 v119, v168, v119
    v_cvt_pk_bf16_f32 v177, v118, v119
    v_mfma_f32_16x16x32_bf16 v[160:163], a[52:55], v[140:143], v[160:163]
    v_fma_f32 v130, v108, v108, s32
    v_fmac_f32 v130, v109, v109
    v_mfma_f32_16x16x32_bf16 v[160:163], a[56:59], v[232:235], v[160:163]
    v_fmac_f32 v130, v110, v110
    v_fmac_f32 v130, v111, v111
    v_mfma_f32_16x16x32_bf16 v[160:163], a[60:63], v[224:227], v[160:163]
    v_fmac_f32 v130, v152, v152
    v_fmac_f32 v130, v153, v153
    v_mfma_f32_16x16x32_bf16 v[160:163], a[64:67], v[212:215], v[160:163]
    v_fmac_f32 v130, v154, v154
    v_fmac_f32 v130, v155, v155
    v_mfma_f32_16x16x32_bf16 v[160:163], a[68:71], v[144:147], v[160:163]
    v_fma_f32 v131, v112, v112, s32
    v_fmac_f32 v131, v113, v113
    v_mfma_f32_16x16x32_bf16 v[188:191], v[120:123], a[144:147], 0
    v_fmac_f32 v131, v114, v114
    v_fmac_f32 v131, v115, v115
    v_mfma_f32_16x16x32_bf16 v[188:191], v[140:143], a[148:151], v[188:191]
    v_fmac_f32 v131, v148, v148
    v_fmac_f32 v131, v149, v149
    v_mfma_f32_16x16x32_bf16 v[188:191], v[232:235], a[152:155], v[188:191]
    v_fmac_f32 v130, v160, v160
    v_fmac_f32 v130, v161, v161
    v_mfma_f32_16x16x32_bf16 v[188:191], v[224:227], a[156:159], v[188:191]
    v_fmac_f32 v130, v162, v162
    v_fmac_f32 v130, v163, v163
    v_mfma_f32_16x16x32_bf16 v[188:191], v[212:215], a[160:163], v[188:191]
    v_fmac_f32 v131, v150, v150
    v_fmac_f32 v131, v151, v151
    v_mfma_f32_16x16x32_bf16 v[188:191], v[144:147], a[164:167], v[188:191]
    v_fmac_f32 v131, v180, v180
    v_fmac_f32 v131, v181, v181
    v_mfma_f32_16x16x32_bf16 v[196:199], v[120:123], a[168:171], 0
    ds_read_b128 v[116:119], v0 offset:32768
    v_fmac_f32 v131, v182, v182
    v_mfma_f32_16x16x32_bf16 v[196:199], v[140:143], a[172:175], v[196:199]
    ds_read_b128 v[204:207], v1 offset:32768
    v_fmac_f32 v131, v183, v183
    v_mfma_f32_16x16x32_bf16 v[196:199], v[232:235], a[176:179], v[196:199]
    ds_read_b128 v[192:195], v0 offset:32896
    v_cvt_pk_bf16_f32 v238, v188, v189
    v_mfma_f32_16x16x32_bf16 v[196:199], v[224:227], a[180:183], v[196:199]
    ds_read_b128 v[220:223], v1 offset:32896
    v_cvt_pk_bf16_f32 v239, v190, v191
    v_mfma_f32_16x16x32_bf16 v[196:199], v[212:215], a[184:187], v[196:199]
    ds_read_b128 v[188:191], v0 offset:33024
    v_cvt_pk_bf16_f32 v36, v130, v131
    v_mfma_f32_16x16x32_bf16 v[196:199], v[144:147], a[188:191], v[196:199]
    ds_read_b128 v[240:243], v1 offset:33024
    v_mul_f32 v200, v170, v200
    v_mfma_f32_16x16x32_bf16 v[216:219], v[32:35], v[36:39], 0
    v_mul_f32 v201, v170, v201
    v_cvt_pk_bf16_f32 v200, v200, v201
    v_mfma_f32_16x16x32_bf16 v[228:231], v[120:123], a[192:195], 0
    v_mul_f32 v202, v170, v202
    v_mul_f32 v203, v170, v203
    v_mfma_f32_16x16x32_bf16 v[228:231], v[140:143], a[196:199], v[228:231]
    s_waitcnt lgkmcnt(5)
    v_cvt_pk_bf16_f32 v130, v196, v197
    v_cvt_pk_bf16_f32 v131, v198, v199
    v_mfma_f32_16x16x32_bf16 v[228:231], v[232:235], a[200:203], v[228:231]
    s_waitcnt lgkmcnt(4)
    v_rsq_f32 v217, v217
    v_mfma_f32_16x16x32_bf16 v[228:231], v[224:227], a[204:207], v[228:231]
    s_waitcnt lgkmcnt(3)
    v_rsq_f32 v216, v216
    v_mfma_f32_16x16x32_bf16 v[228:231], v[212:215], a[208:211], v[228:231]
    s_waitcnt lgkmcnt(2)
    v_mul_f32 v216, s31, v216
    v_mul_f32 v112, v217, v112
    v_mfma_f32_16x16x32_bf16 v[228:231], v[144:147], a[212:215], v[228:231]
    s_waitcnt lgkmcnt(1)
    v_mul_f32 v113, v217, v113
    v_cvt_pk_bf16_f32 v112, v112, v113
    v_mfma_f32_16x16x32_bf16 v[120:123], a[72:75], v[116:119], 0
    s_waitcnt lgkmcnt(0)
    v_mul_f32 v114, v217, v114
    v_mul_f32 v115, v217, v115
    v_mfma_f32_16x16x32_bf16 v[120:123], a[76:79], v[204:207], v[120:123]
    v_cvt_pk_bf16_f32 v166, v228, v229
    v_cvt_pk_bf16_f32 v167, v230, v231
    v_mfma_f32_16x16x32_bf16 v[120:123], a[80:83], v[192:195], v[120:123]
    v_cvt_pk_bf16_f32 v113, v114, v115
    v_mul_f32 v148, v217, v148
    v_mfma_f32_16x16x32_bf16 v[120:123], a[84:87], v[220:223], v[120:123]
    v_mul_f32 v149, v217, v149
    v_cvt_pk_bf16_f32 v114, v148, v149
    v_mfma_f32_16x16x32_bf16 v[120:123], a[88:91], v[188:191], v[120:123]
    v_mul_f32 v150, v217, v150
    v_mul_f32 v151, v217, v151
    v_mfma_f32_16x16x32_bf16 v[120:123], a[92:95], v[240:243], v[120:123]
    v_cvt_pk_bf16_f32 v115, v150, v151
    v_mul_f32 v180, v217, v180
    v_mfma_f32_16x16x32_bf16 v[140:143], a[96:99], v[116:119], 0
    v_mul_f32 v181, v217, v181
    v_cvt_pk_bf16_f32 v146, v180, v181
    v_mfma_f32_16x16x32_bf16 v[140:143], a[100:103], v[204:207], v[140:143]
    v_mul_f32 v182, v217, v182
    v_mul_f32 v183, v217, v183
    v_mfma_f32_16x16x32_bf16 v[140:143], a[104:107], v[192:195], v[140:143]
    v_cvt_pk_bf16_f32 v147, v182, v183
    v_mul_f32 v108, v216, v108
    v_mfma_f32_16x16x32_bf16 v[140:143], a[108:111], v[220:223], v[140:143]
    v_mul_f32 v109, v216, v109
    v_cvt_pk_bf16_f32 v148, v108, v109
    v_mfma_f32_16x16x32_bf16 v[140:143], a[112:115], v[188:191], v[140:143]
    v_mul_f32 v110, v216, v110
    v_mul_f32 v111, v216, v111
    v_mfma_f32_16x16x32_bf16 v[140:143], a[116:119], v[240:243], v[140:143]
    v_cvt_pk_bf16_f32 v149, v110, v111
    v_mul_f32 v152, v216, v152
    v_mfma_f32_16x16x32_bf16 v[108:111], a[120:123], v[116:119], 0
    v_mul_f32 v153, v216, v153
    v_cvt_pk_bf16_f32 v150, v152, v153
    v_mfma_f32_16x16x32_bf16 v[108:111], a[124:127], v[204:207], v[108:111]
    v_mul_f32 v154, v216, v154
    v_mul_f32 v155, v216, v155
    v_mfma_f32_16x16x32_bf16 v[108:111], a[128:131], v[192:195], v[108:111]
    v_cvt_pk_bf16_f32 v151, v154, v155
    v_mul_f32 v160, v216, v160
    v_mfma_f32_16x16x32_bf16 v[108:111], a[132:135], v[220:223], v[108:111]
    v_mul_f32 v161, v216, v161
    v_cvt_pk_bf16_f32 v144, v160, v161
    v_mfma_f32_16x16x32_bf16 v[108:111], a[136:139], v[188:191], v[108:111]
    v_mul_f32 v162, v216, v162
    v_mul_f32 v163, v216, v163
    v_mfma_f32_16x16x32_bf16 v[108:111], a[140:143], v[240:243], v[108:111]
    s_waitcnt vmcnt(2)
    v_cvt_pk_bf16_f32 v145, v162, v163
    v_fma_f32 v168, v120, v120, s32
    v_mfma_f32_16x16x32_bf16 v[152:155], a[0:3], v[116:119], 0
    s_barrier
    v_fmac_f32 v168, v121, v121
    v_fmac_f32 v168, v122, v122
    v_mfma_f32_16x16x32_bf16 v[152:155], a[4:7], v[204:207], v[152:155]
    s_nop 0
    v_fmac_f32 v168, v123, v123
    v_fmac_f32 v168, v140, v140
    v_mfma_f32_16x16x32_bf16 v[152:155], a[8:11], v[192:195], v[152:155]
    s_nop 0
    v_fmac_f32 v168, v141, v141
    v_fmac_f32 v168, v142, v142
    v_mfma_f32_16x16x32_bf16 v[152:155], a[12:15], v[220:223], v[152:155]
    s_nop 0
    buffer_load_dwordx4 v10, s[8:11], 0 offen nt lds
    v_fmac_f32 v168, v143, v143
    v_mfma_f32_16x16x32_bf16 v[152:155], a[16:19], v[188:191], v[152:155]
    s_add_u32 m0, s28, 4096
    v_fmac_f32 v168, v108, v108
    v_fmac_f32 v168, v109, v109
    v_mfma_f32_16x16x32_bf16 v[152:155], a[20:23], v[240:243], v[152:155]
    v_fmac_f32 v168, v110, v110
    v_fmac_f32 v168, v111, v111
    v_mfma_f32_16x16x32_bf16 v[160:163], a[24:27], v[116:119], 0
    v_cvt_pk_bf16_f32 v201, v202, v203
    v_mul_f32 v244, v170, v244
    v_mfma_f32_16x16x32_bf16 v[160:163], a[28:31], v[204:207], v[160:163]
    v_mul_f32 v245, v170, v245
    v_cvt_pk_bf16_f32 v202, v244, v245
    v_mfma_f32_16x16x32_bf16 v[160:163], a[32:35], v[192:195], v[160:163]
    buffer_load_dwordx4 v11, s[8:11], 0 offen nt lds
    v_fma_f32 v169, v152, v152, s32
    v_mfma_f32_16x16x32_bf16 v[160:163], a[36:39], v[220:223], v[160:163]
    s_add_u32 m0, s28, 8192
    v_fmac_f32 v169, v153, v153
    v_fmac_f32 v169, v154, v154
    v_mfma_f32_16x16x32_bf16 v[160:163], a[40:43], v[188:191], v[160:163]
    v_fmac_f32 v169, v155, v155
    v_mul_f32 v246, v170, v246
    v_mfma_f32_16x16x32_bf16 v[160:163], a[44:47], v[240:243], v[160:163]
    v_mul_f32 v247, v170, v247
    v_cvt_pk_bf16_f32 v203, v246, v247
    v_mfma_f32_16x16x32_bf16 v[196:199], a[48:51], v[116:119], 0
    v_mul_f32 v132, v170, v132
    v_mul_f32 v133, v170, v133
    v_mfma_f32_16x16x32_bf16 v[196:199], a[52:55], v[204:207], v[196:199]
    buffer_load_dwordx4 v12, s[8:11], 0 offen nt lds
    v_cvt_pk_bf16_f32 v216, v132, v133
    v_mfma_f32_16x16x32_bf16 v[196:199], a[56:59], v[192:195], v[196:199]
    s_add_u32 m0, s28, 12288
    ds_read2_b32 v[250:251], v6 offset0:0 offset1:0
    ds_read2_b32 v[234:235], v6 offset0:16 offset1:16
    v_mfma_f32_16x16x32_bf16 v[196:199], a[60:63], v[220:223], v[196:199]
    s_xor_b32 s28, s28, 65536
    ds_read_b128 v[224:227], v5 offset:0
    ds_read_b128 v[180:183], v5 offset:16
    v_mfma_f32_16x16x32_bf16 v[196:199], a[64:67], v[188:191], v[196:199]
    v_fmac_f32 v169, v160, v160
    v_fmac_f32 v169, v161, v161
    v_mfma_f32_16x16x32_bf16 v[196:199], a[68:71], v[240:243], v[196:199]
    ds_read_b128 v[212:215], v5 offset:48
    ds_read_b32 v173, v6 offset:192
    v_mfma_f32_16x16x32_bf16 v[228:231], v[116:119], a[144:147], 0
    buffer_load_dwordx4 v13, s[8:11], 0 offen nt lds
    ds_read2_b32 v[218:219], v6 offset0:32 offset1:32
    v_mfma_f32_16x16x32_bf16 v[228:231], v[204:207], a[148:151], v[228:231]
    s_mov_b32 m0, s29
    v_fmac_f32 v169, v162, v162
    v_fmac_f32 v169, v163, v163
    v_mfma_f32_16x16x32_bf16 v[228:231], v[192:195], a[152:155], v[228:231]
    s_xor_b32 s29, s29, s30
    v_fmac_f32 v169, v196, v196
    v_fmac_f32 v169, v197, v197
    v_mfma_f32_16x16x32_bf16 v[228:231], v[220:223], a[156:159], v[228:231]
    s_add_u32 s19, s19, s20
    v_fmac_f32 v169, v198, v198
    v_fmac_f32 v169, v199, v199
    v_mfma_f32_16x16x32_bf16 v[228:231], v[188:191], a[160:163], v[228:231]
    s_add_u32 s23, s23, s21
    v_cvt_pk_bf16_f32 v36, v169, v168
    v_mul_f32 v134, v170, v134
    v_mfma_f32_16x16x32_bf16 v[228:231], v[240:243], a[164:167], v[228:231]
    s_waitcnt lgkmcnt(3)
    buffer_store_dwordx4 v[200:203], v17, s[12:15], 0 offen
    v_mul_f32 v135, v170, v135
    v_cvt_pk_bf16_f32 v217, v134, v135
    v_mul_f32 v136, v172, v136
    v_mul_f32 v137, v172, v137
    v_mfma_f32_16x16x32_bf16 v[168:171], v[32:35], v[36:39], 0
    s_cmp_ge_u32 s19, 72
    v_cvt_pk_bf16_f32 v248, v228, v229
    v_cvt_pk_bf16_f32 v249, v230, v231
    v_mfma_f32_16x16x32_bf16 v[132:135], v[224:227], v[124:127], v[22:25]
    s_cselect_b32 s34, 72, 0
    v_cvt_pk_bf16_f32 v200, v136, v137
    v_mul_f32 v138, v172, v138
    v_mfma_f32_16x16x32_bf16 v[132:135], v[180:183], v[184:187], v[132:135]
    s_waitcnt lgkmcnt(0)
    v_rsq_f32 v169, v169
    v_mfma_f32_16x16x32_bf16 v[132:135], v[212:215], v[176:179], v[132:135]
    s_cselect_b32 s35, s22, 0
    v_rsq_f32 v168, v168
    v_mfma_f32_16x16x32_bf16 v[228:231], v[116:119], a[168:171], 0
    s_sub_u32 s19, s19, s34
    v_mul_f32 v168, s31, v168
    v_mul_f32 v120, v169, v120
    v_mfma_f32_16x16x32_bf16 v[228:231], v[204:207], a[172:175], v[228:231]
    s_add_u32 s23, s23, s35
    v_mov_b32_dpp v173, v133 quad_perm:[0,1,2,3] row_mask:0x1 bank_mask:0xf
    v_mul_f32 v121, v169, v121
    v_mfma_f32_16x16x32_bf16 v[228:231], v[192:195], a[176:179], v[228:231]
    s_add_u32 s18, s18, 1
    v_cvt_pk_bf16_f32 v120, v120, v121
    v_mul_f32 v122, v169, v122
    v_mfma_f32_16x16x32_bf16 v[228:231], v[220:223], a[180:183], v[228:231]
    s_cmp_lt_u32 s18, s17
    v_mul_f32 v123, v169, v123
    v_cvt_pk_bf16_f32 v121, v122, v123
    v_mfma_f32_16x16x32_bf16 v[228:231], v[188:191], a[184:187], v[228:231]
    v_mul_f32 v140, v169, v140
    v_mul_f32 v141, v169, v141
    v_mfma_f32_16x16x32_bf16 v[228:231], v[240:243], a[188:191], v[228:231]
    v_cvt_pk_bf16_f32 v122, v140, v141
    v_mul_f32 v142, v169, v142
    v_mfma_f32_16x16x32_bf16 v[244:247], v[116:119], a[192:195], 0
    v_mul_f32 v143, v169, v143
    v_cvt_pk_bf16_f32 v123, v142, v143
    v_mfma_f32_16x16x32_bf16 v[244:247], v[204:207], a[196:199], v[244:247]
    v_mul_f32 v108, v169, v108
    v_mul_f32 v109, v169, v109
    v_mfma_f32_16x16x32_bf16 v[244:247], v[192:195], a[200:203], v[244:247]
    ds_read_b128 v[116:119], v2 offset:0
    v_cvt_pk_bf16_f32 v232, v228, v229
    v_mfma_f32_16x16x32_bf16 v[244:247], v[220:223], a[204:207], v[244:247]
    ds_read_b128 v[204:207], v2 offset:1024
    v_cvt_pk_bf16_f32 v233, v230, v231
    v_mfma_f32_16x16x32_bf16 v[244:247], v[188:191], a[208:211], v[244:247]
    ds_read_b128 v[140:143], v2 offset:2048
    v_cvt_pk_bf16_f32 v190, v108, v109
    v_mfma_f32_16x16x32_bf16 v[244:247], v[240:243], a[212:215], v[244:247]
    ds_read_b128 v[252:255], v2 offset:3072
    ds_read_b128 v[192:195], v2 offset:4096
    v_mfma_f32_16x16x32_bf16 v[220:223], v[184:187], v[124:127], v[40:43]
    ds_read_b128 v[134:137], v2 offset:5120
    buffer_store_dwordx2 v[216:217], v20, s[12:15], 0 offen
    v_mul_f32 v110, v169, v110
    v_mul_f32 v111, v169, v111
    v_mfma_f32_16x16x32_bf16 v[240:243], v[112:115], v[124:127], v[44:47]
    v_cvt_pk_bf16_f32 v216, v244, v245
    v_cvt_pk_bf16_f32 v217, v246, v247
    v_mfma_f32_16x16x32_bf16 v[228:231], v[120:123], v[124:127], v[48:51]
    v_cvt_pk_bf16_f32 v191, v110, v111
    v_mul_f32 v152, v168, v152
    v_mul_f32 v153, v168, v153
    v_mfma_f32_16x16x16_bf16 v[220:223], v[178:179], v[176:177], v[220:223]
    v_cvt_pk_bf16_f32 v244, v152, v153
    v_mul_f32 v154, v168, v154
    v_mul_f32 v155, v168, v155
    v_mfma_f32_16x16x16_bf16 v[240:243], v[146:147], v[176:177], v[240:243]
    v_cvt_pk_bf16_f32 v245, v154, v155
    v_mul_f32 v160, v168, v160
    v_mul_f32 v161, v168, v161
    v_mfma_f32_16x16x16_bf16 v[228:231], v[190:191], v[176:177], v[228:231]
    v_cvt_pk_bf16_f32 v246, v160, v161
    v_mul_f32 v162, v168, v162
    v_mul_f32 v163, v168, v163
    v_cvt_pk_bf16_f32 v247, v162, v163
    v_mfma_f32_16x16x32_bf16 v[124:127], v[224:227], v[148:151], v[24:27]
    s_waitcnt lgkmcnt(1)
    v_mul_f32 v196, v168, v196
    v_mul_f32 v197, v168, v197
    v_mfma_f32_16x16x32_bf16 v[124:127], v[180:183], v[112:115], v[124:127]
    s_waitcnt lgkmcnt(0)
    v_cvt_pk_bf16_f32 v188, v196, v197
    v_mul_f32 v198, v168, v198
    v_mfma_f32_16x16x32_bf16 v[124:127], v[212:215], v[144:147], v[124:127]
    v_mul_f32 v199, v168, v199
    v_cvt_pk_bf16_f32 v189, v198, v199
    v_mfma_f32_16x16x32_bf16 v[160:163], v[224:227], v[244:247], v[26:29]
    v_max3_f32 v133, v132, v220, v221
    v_max3_f32 v133, v133, v222, v223
    v_mfma_f32_16x16x32_bf16 v[160:163], v[180:183], v[120:123], v[160:163]
    v_max3_f32 v133, v133, v240, v241
    v_max3_f32 v133, v133, v242, v243
    v_mfma_f32_16x16x32_bf16 v[160:163], v[212:215], v[188:191], v[160:163]
    v_max3_f32 v133, v133, v228, v229
    v_max3_f32 v133, v133, v230, v231
    v_mfma_f32_16x16x32_bf16 v[180:183], a[216:219], v[116:119], 0
    v_mov_b32 v174, v133
    v_mov_b32_dpp v173, v125 quad_perm:[0,1,2,3] row_mask:0x2 bank_mask:0xf
    v_mfma_f32_16x16x32_bf16 v[180:183], a[220:223], v[204:207], v[180:183]
    v_permlane32_swap_b32 v133, v174
    v_mfma_f32_16x16x32_bf16 v[180:183], a[224:227], v[140:143], v[180:183]
    v_max_f32 v133, v133, v174
    v_mov_b32 v174, v133
    v_mfma_f32_16x16x32_bf16 v[180:183], a[228:231], v[252:255], v[180:183]
    v_mov_b32_dpp v173, v161 quad_perm:[0,1,2,3] row_mask:0x4 bank_mask:0xf
    v_mul_f32 v139, v172, v139
    v_mfma_f32_16x16x32_bf16 v[180:183], a[232:235], v[192:195], v[180:183]
    v_permlane16_swap_b32 v133, v174
    v_mfma_f32_16x16x32_bf16 v[180:183], a[236:239], v[134:137], v[180:183]
    v_max_f32 v133, v133, v174
    v_sub_f32 v220, v220, v133
    v_mfma_f32_16x16x32_bf16 v[108:111], a[240:243], v[116:119], 0
    v_exp_f32 v220, v220
    v_mfma_f32_16x16x32_bf16 v[108:111], a[244:247], v[204:207], v[108:111]
    v_sub_f32 v221, v221, v133
    v_sub_f32 v222, v222, v133
    v_mfma_f32_16x16x32_bf16 v[108:111], a[248:251], v[140:143], v[108:111]
    v_exp_f32 v221, v221
    v_mfma_f32_16x16x32_bf16 v[108:111], a[252:255], v[252:255], v[108:111]
    ds_read_b128 v[168:171], v2 offset:6144
    v_cvt_pk_bf16_f32 v212, v220, v221
    v_mfma_f32_16x16x32_bf16 v[108:111], v[76:79], v[192:195], v[108:111]
    ds_read_b128 v[196:199], v2 offset:7168
    v_sub_f32 v223, v223, v133
    v_mfma_f32_16x16x32_bf16 v[108:111], v[80:83], v[134:137], v[108:111]
    ds_read_b128 v[224:227], v2 offset:8192
    v_sub_f32 v240, v240, v133
    v_mfma_f32_16x16x32_bf16 v[152:155], v[84:87], v[116:119], 0
    ds_read_b128 v[174:177], v2 offset:9216
    v_sub_f32 v241, v241, v133
    v_mfma_f32_16x16x32_bf16 v[152:155], v[88:91], v[204:207], v[152:155]
    ds_read_b128 v[116:119], v2 offset:10240
    v_sub_f32 v242, v242, v133
    v_mfma_f32_16x16x32_bf16 v[152:155], v[92:95], v[140:143], v[152:155]
    ds_read_b128 v[204:207], v2 offset:11264
    v_sub_f32 v243, v243, v133
    v_mfma_f32_16x16x32_bf16 v[152:155], v[96:99], v[252:255], v[152:155]
    v_exp_f32 v222, v222
    v_mfma_f32_16x16x32_bf16 v[152:155], v[100:103], v[192:195], v[152:155]
    v_exp_f32 v223, v223
    v_mfma_f32_16x16x32_bf16 v[152:155], v[104:107], v[134:137], v[152:155]
    s_waitcnt lgkmcnt(5)
    v_cvt_pk_bf16_f32 v213, v222, v223
    v_exp_f32 v240, v240
    v_exp_f32 v241, v241
    v_mfma_f32_16x16x32_bf16 v[140:143], v[184:187], v[148:151], v[52:55]
    s_waitcnt lgkmcnt(3)
    v_cvt_pk_bf16_f32 v214, v240, v241
    v_exp_f32 v242, v242
    v_exp_f32 v243, v243
    v_sub_f32 v228, v228, v133
    v_cvt_pk_bf16_f32 v215, v242, v243
    v_mfma_f32_16x16x16_bf16 v[140:143], v[178:179], v[144:145], v[140:143]
    v_exp_f32 v228, v228
    v_sub_f32 v229, v229, v133
    v_exp_f32 v229, v229
    v_mfma_f32_16x16x32_bf16 v[192:195], v[112:115], v[148:151], v[56:59]
    s_waitcnt lgkmcnt(0)
    v_cvt_pk_bf16_f32 v36, v228, v229
    v_sub_f32 v230, v230, v133
    v_exp_f32 v230, v230
    v_sub_f32 v231, v231, v133
    v_exp_f32 v231, v231
    v_mfma_f32_16x16x32_bf16 v[220:223], v[120:123], v[148:151], v[60:63]
    v_cvt_pk_bf16_f32 v37, v230, v231
    v_sub_f32 v132, v132, v133
    v_max3_f32 v203, v124, v140, v141
    v_mfma_f32_16x16x16_bf16 v[192:195], v[146:147], v[144:145], v[192:195]
    v_exp_f32 v132, v132
    v_max3_f32 v203, v203, v142, v143
    v_mfma_f32_16x16x16_bf16 v[220:223], v[190:191], v[144:145], v[220:223]
    v_cvt_pk_bf16_f32 v39, v132, 0
    v_cvt_pk_bf16_f32 v201, v138, v139
    v_mul_f32 v208, v172, v208
    v_mul_f32 v209, v172, v209
    v_mfma_f32_16x16x32_bf16 v[132:135], v[28:31], v[36:39], 0
    v_max3_f32 v203, v203, v192, v193
    v_max3_f32 v203, v203, v194, v195
    v_mfma_f32_16x16x32_bf16 v[132:135], v[28:31], v[212:215], v[132:135]
    v_max3_f32 v203, v203, v220, v221
    v_max3_f32 v203, v203, v222, v223
    v_mfma_f32_16x16x32_bf16 v[148:151], v[248:251], v[36:39], 0
    v_mov_b32 v144, v203
    v_cvt_pk_bf16_f32 v202, v208, v209
    v_mfma_f32_16x16x32_bf16 v[148:151], v[236:239], v[212:215], v[148:151]
    v_permlane32_swap_b32 v203, v144
    v_mfma_f32_16x16x32_bf16 v[228:231], v[232:235], v[36:39], 0
    v_max_f32 v203, v203, v144
    v_mov_b32 v144, v203
    v_mfma_f32_16x16x32_bf16 v[228:231], v[128:131], v[212:215], v[228:231]
    v_rcp_f32 v132, v132
    v_mfma_f32_16x16x32_bf16 v[240:243], v[216:219], v[36:39], 0
    v_permlane16_swap_b32 v203, v144
    v_mfma_f32_16x16x32_bf16 v[240:243], v[164:167], v[212:215], v[240:243]
    v_max_f32 v203, v203, v144
    v_sub_f32 v140, v140, v203
    v_mfma_f32_16x16x32_bf16 v[136:139], a[216:219], v[168:171], 0
    v_exp_f32 v140, v140
    v_mfma_f32_16x16x32_bf16 v[136:139], a[220:223], v[196:199], v[136:139]
    v_sub_f32 v141, v141, v203
    v_sub_f32 v142, v142, v203
    v_mfma_f32_16x16x32_bf16 v[136:139], a[224:227], v[224:227], v[136:139]
    v_exp_f32 v141, v141
    v_mfma_f32_16x16x32_bf16 v[136:139], a[228:231], v[174:177], v[136:139]
    v_cvt_pk_bf16_f32 v140, v140, v141
    v_sub_f32 v143, v143, v203
    v_mfma_f32_16x16x32_bf16 v[136:139], a[232:235], v[116:119], v[136:139]
    v_exp_f32 v142, v142
    v_mfma_f32_16x16x32_bf16 v[136:139], a[236:239], v[204:207], v[136:139]
    v_exp_f32 v143, v143
    v_sub_f32 v192, v192, v203
    v_cvt_pk_bf16_f32 v141, v142, v143
    v_exp_f32 v192, v192
    v_sub_f32 v193, v193, v203
    v_exp_f32 v193, v193
    v_sub_f32 v194, v194, v203
    v_cvt_pk_bf16_f32 v142, v192, v193
    v_exp_f32 v194, v194
    v_sub_f32 v195, v195, v203
    v_exp_f32 v195, v195
    v_sub_f32 v220, v220, v203
    v_cvt_pk_bf16_f32 v143, v194, v195
    v_exp_f32 v220, v220
    v_sub_f32 v221, v221, v203
    v_exp_f32 v221, v221
    v_sub_f32 v222, v222, v203
    v_cvt_pk_bf16_f32 v36, v220, v221
    v_exp_f32 v222, v222
    v_sub_f32 v223, v223, v203
    v_exp_f32 v223, v223
    v_mfma_f32_16x16x32_bf16 v[192:195], v[184:187], v[244:247], v[64:67]
    v_cvt_pk_bf16_f32 v37, v222, v223
    v_sub_f32 v124, v124, v203
    v_mfma_f32_16x16x32_bf16 v[184:187], v[112:115], v[244:247], v[68:71]
    v_exp_f32 v124, v124
    v_mfma_f32_16x16x32_bf16 v[212:215], v[120:123], v[244:247], v[72:75]
    v_cvt_pk_bf16_f32 v39, v124, 0
    v_mul_f32 v148, v132, v148
    v_mul_f32 v149, v132, v149
    v_mfma_f32_16x16x32_bf16 v[120:123], v[28:31], v[36:39], 0
    v_cvt_pk_bf16_f32 v112, v148, v149
    v_mul_f32 v150, v132, v150
    v_mfma_f32_16x16x32_bf16 v[120:123], v[28:31], v[140:143], v[120:123]
    v_mul_f32 v151, v132, v151
    v_cvt_pk_bf16_f32 v113, v150, v151
    v_mfma_f32_16x16x32_bf16 v[124:127], v[248:251], v[36:39], 0
    v_mul_f32 v228, v132, v228
    v_mul_f32 v229, v132, v229
    v_mfma_f32_16x16x32_bf16 v[124:127], v[236:239], v[140:143], v[124:127]
    v_cvt_pk_bf16_f32 v114, v228, v229
    v_mul_f32 v230, v132, v230
    v_mfma_f32_16x16x32_bf16 v[220:223], v[232:235], v[36:39], 0
    v_mul_f32 v231, v132, v231
    v_cvt_pk_bf16_f32 v115, v230, v231
    v_mfma_f32_16x16x32_bf16 v[220:223], v[128:131], v[140:143], v[220:223]
    ds_write_b128 v3, v[112:115] offset:0
    v_mfma_f32_16x16x32_bf16 v[252:255], v[216:219], v[36:39], 0
    v_mul_f32 v240, v132, v240
    v_mul_f32 v241, v132, v241
    v_mfma_f32_16x16x32_bf16 v[252:255], v[164:167], v[140:143], v[252:255]
    v_cvt_pk_bf16_f32 v122, v240, v241
    v_mul_f32 v242, v132, v242
    v_mul_f32 v243, v132, v243
    v_mfma_f32_16x16x16_bf16 v[192:195], v[178:179], v[188:189], v[192:195]
    v_cvt_pk_bf16_f32 v123, v242, v243
    v_mul_f32 v210, v172, v210
    v_mul_f32 v211, v172, v211
    v_mfma_f32_16x16x16_bf16 v[184:187], v[146:147], v[188:189], v[184:187]
    v_cvt_pk_bf16_f32 v203, v210, v211
    v_mul_f32 v156, v172, v156
    v_mul_f32 v157, v172, v157
    v_mfma_f32_16x16x16_bf16 v[212:215], v[190:191], v[188:189], v[212:215]
    v_cvt_pk_bf16_f32 v178, v156, v157
    v_mul_f32 v158, v172, v158
    v_mul_f32 v159, v172, v159
    v_cvt_pk_bf16_f32 v179, v158, v159
    v_mfma_f32_16x16x32_bf16 v[208:211], a[240:243], v[168:171], 0
    ds_write_b64 v4, v[122:123] offset:4096
    v_mfma_f32_16x16x32_bf16 v[208:211], a[244:247], v[196:199], v[208:211]
    buffer_store_dwordx4 v[200:203], v16, s[12:15], 0 offen
    v_mov_b32 v172, v173
    v_max3_f32 v121, v160, v192, v193
    v_max3_f32 v121, v121, v194, v195
    v_max_f32_dpp v172, v172, v172 quad_perm:[1,0,3,2] row_mask:0xf bank_mask:0xf
    v_mfma_f32_16x16x32_bf16 v[208:211], a[248:251], v[224:227], v[208:211]
    v_max3_f32 v121, v121, v184, v185
    v_max_f32_dpp v172, v172, v172 quad_perm:[2,3,0,1] row_mask:0xf bank_mask:0xf
    v_mfma_f32_16x16x32_bf16 v[208:211], a[252:255], v[174:177], v[208:211]
    ds_read_b128 v[112:115], v2 offset:12288
    v_max_f32_dpp v172, v172, v172 row_half_mirror row_mask:0xf bank_mask:0xf
    v_mfma_f32_16x16x32_bf16 v[208:211], v[76:79], v[116:119], v[208:211]
    ds_read_b128 v[188:191], v2 offset:13312
    v_max_f32_dpp v172, v172, v172 row_mirror row_mask:0xf bank_mask:0xf
    v_mfma_f32_16x16x32_bf16 v[208:211], v[80:83], v[204:207], v[208:211]
    ds_read_b128 v[144:147], v2 offset:14336
    v_mov_b32 v122, v172
    v_mfma_f32_16x16x32_bf16 v[156:159], v[84:87], v[168:171], 0
    ds_read_b128 v[140:143], v2 offset:15360
    v_max3_f32 v121, v121, v186, v187
    v_mfma_f32_16x16x32_bf16 v[156:159], v[88:91], v[196:199], v[156:159]
    ds_read_b128 v[168:171], v2 offset:16384
    v_max3_f32 v121, v121, v212, v213
    v_mfma_f32_16x16x32_bf16 v[156:159], v[92:95], v[224:227], v[156:159]
    ds_read_b128 v[148:151], v2 offset:17408
    v_max3_f32 v121, v121, v214, v215
    v_mfma_f32_16x16x32_bf16 v[156:159], v[96:99], v[174:177], v[156:159]
    v_permlane32_swap_b32 v172, v122
    v_mfma_f32_16x16x32_bf16 v[156:159], v[100:103], v[116:119], v[156:159]
    v_max_f32 v172, v172, v122
    v_mov_b32 v122, v172
    v_mfma_f32_16x16x32_bf16 v[156:159], v[104:107], v[204:207], v[156:159]
    s_waitcnt lgkmcnt(5)
    v_permlane16_swap_b32 v172, v122
    v_mfma_f32_16x16x32_bf16 v[200:203], a[216:219], v[112:115], 0
    s_waitcnt lgkmcnt(4)
    v_max_f32 v172, v172, v122
    v_sub_f32 v173, v173, v172
    v_mfma_f32_16x16x32_bf16 v[200:203], a[220:223], v[188:191], v[200:203]
    s_waitcnt lgkmcnt(3)
    v_exp_f32 v173, v173
    v_mfma_f32_16x16x32_bf16 v[200:203], a[224:227], v[144:147], v[200:203]
    s_waitcnt lgkmcnt(2)
    v_cvt_pk_bf16_f32 v173, v173, v173
    v_mov_b32 v122, v121
    v_mfma_f32_16x16x32_bf16 v[200:203], a[228:231], v[140:143], v[200:203]
    s_waitcnt lgkmcnt(1)
    ds_write_b16 v8, v173
    v_mfma_f32_16x16x32_bf16 v[200:203], a[232:235], v[168:171], v[200:203]
    s_waitcnt lgkmcnt(1)
    v_permlane32_swap_b32 v121, v122
    v_mfma_f32_16x16x32_bf16 v[200:203], a[236:239], v[148:151], v[200:203]
    v_max_f32 v121, v121, v122
    v_mov_b32 v122, v121
    v_mfma_f32_16x16x32_bf16 v[244:247], a[240:243], v[112:115], 0
    buffer_store_dwordx2 v[178:179], v19, s[12:15], 0 offen
    v_permlane16_swap_b32 v121, v122
    v_mfma_f32_16x16x32_bf16 v[244:247], a[244:247], v[188:191], v[244:247]
    v_max_f32 v121, v121, v122
    v_sub_f32 v192, v192, v121
    v_mfma_f32_16x16x32_bf16 v[244:247], a[248:251], v[144:147], v[244:247]
    v_fma_f32 v122, v200, v200, s33
    v_fmac_f32 v122, v201, v201
    v_mfma_f32_16x16x32_bf16 v[244:247], a[252:255], v[140:143], v[244:247]
    v_fmac_f32 v122, v202, v202
    v_fmac_f32 v122, v203, v203
    v_mfma_f32_16x16x32_bf16 v[244:247], v[76:79], v[168:171], v[244:247]
    v_exp_f32 v192, v192
    v_mfma_f32_16x16x32_bf16 v[244:247], v[80:83], v[148:151], v[244:247]
    v_sub_f32 v193, v193, v121
    v_sub_f32 v194, v194, v121
    v_mfma_f32_16x16x32_bf16 v[132:135], v[84:87], v[112:115], 0
    v_exp_f32 v193, v193
    v_mfma_f32_16x16x32_bf16 v[132:135], v[88:91], v[188:191], v[132:135]
    v_cvt_pk_bf16_f32 v116, v192, v193
    v_sub_f32 v195, v195, v121
    v_mfma_f32_16x16x32_bf16 v[132:135], v[92:95], v[144:147], v[132:135]
    v_fmac_f32 v122, v244, v244
    v_fmac_f32 v122, v245, v245
    v_mfma_f32_16x16x32_bf16 v[132:135], v[96:99], v[140:143], v[132:135]
    v_fmac_f32 v122, v246, v246
    v_fmac_f32 v122, v247, v247
    v_mfma_f32_16x16x32_bf16 v[132:135], v[100:103], v[168:171], v[132:135]
    v_exp_f32 v194, v194
    v_mfma_f32_16x16x32_bf16 v[132:135], v[104:107], v[148:151], v[132:135]
    v_exp_f32 v195, v195
    v_sub_f32 v184, v184, v121
    v_cvt_pk_bf16_f32 v117, v194, v195
    v_exp_f32 v184, v184
    v_sub_f32 v185, v185, v121
    v_exp_f32 v185, v185
    v_sub_f32 v186, v186, v121
    v_cvt_pk_bf16_f32 v118, v184, v185
    v_fmac_f32 v122, v132, v132
    v_fmac_f32 v122, v133, v133
    v_fmac_f32 v122, v134, v134
    v_fmac_f32 v122, v135, v135
    v_cvt_pk_bf16_f32 v123, v122, v122
    v_exp_f32 v186, v186
    v_sub_f32 v187, v187, v121
    v_exp_f32 v187, v187
    v_sub_f32 v212, v212, v121
    v_cvt_pk_bf16_f32 v119, v186, v187
    v_exp_f32 v212, v212
    v_sub_f32 v213, v213, v121
    v_exp_f32 v213, v213
    v_sub_f32 v214, v214, v121
    v_cvt_pk_bf16_f32 v36, v212, v213
    v_exp_f32 v214, v214
    v_sub_f32 v215, v215, v121
    v_exp_f32 v215, v215
    v_sub_f32 v160, v160, v121
    v_cvt_pk_bf16_f32 v37, v214, v215
    v_exp_f32 v160, v160
    v_xor_b32 v0, 65536, v0
    v_cvt_pk_bf16_f32 v39, v160, 0
    v_xor_b32 v1, 65536, v1
    v_fma_f32 v121, v136, v136, s33
    v_mfma_f32_16x16x32_bf16 v[140:143], v[28:31], v[36:39], 0
    ds_read_b128 v[196:199], v0 offset:20480
    ds_read_b128 v[184:187], v1 offset:20480
    v_mfma_f32_16x16x32_bf16 v[140:143], v[28:31], v[116:119], v[140:143]
    ds_read_b128 v[172:175], v0 offset:20608
    ds_read_b128 v[148:151], v1 offset:20608
    v_mfma_f32_16x16x32_bf16 v[144:147], v[248:251], v[36:39], 0
    buffer_load_dwordx4 v14, s[8:11], 0 offen nt lds
    ds_read_b128 v[112:115], v0 offset:20736
    v_mfma_f32_16x16x32_bf16 v[144:147], v[236:239], v[116:119], v[144:147]
    v_fmac_f32 v121, v137, v137
    v_fmac_f32 v121, v138, v138
    v_mfma_f32_16x16x32_bf16 v[168:171], v[232:235], v[36:39], 0
    ds_read_b128 v[228:231], v1 offset:20736
    ds_read_b128 v[176:179], v9
    v_mfma_f32_16x16x32_bf16 v[168:171], v[128:131], v[116:119], v[168:171]
    v_fmac_f32 v121, v139, v139
    v_fmac_f32 v121, v208, v208
    v_mfma_f32_16x16x32_bf16 v[188:191], v[216:219], v[36:39], 0
    ds_read_b128 v[160:163], v9 offset:64
    v_fmac_f32 v121, v209, v209
    v_mfma_f32_16x16x32_bf16 v[188:191], v[164:167], v[116:119], v[188:191]
    v_fmac_f32 v121, v210, v210
    v_fmac_f32 v121, v211, v211
    s_waitcnt lgkmcnt(6)
    v_mfma_f32_16x16x32_bf16 v[204:207], a[72:75], v[196:199], 0
    s_waitcnt lgkmcnt(5)
    v_fmac_f32 v121, v156, v156
    v_fmac_f32 v121, v157, v157
    v_mfma_f32_16x16x32_bf16 v[204:207], a[76:79], v[184:187], v[204:207]
    s_waitcnt lgkmcnt(4)
    v_fmac_f32 v121, v158, v158
    v_fmac_f32 v121, v159, v159
    v_mfma_f32_16x16x32_bf16 v[204:207], a[80:83], v[172:175], v[204:207]
    s_waitcnt lgkmcnt(3)
    v_rcp_f32 v120, v120
    v_mfma_f32_16x16x32_bf16 v[204:207], a[84:87], v[148:151], v[204:207]
    s_waitcnt lgkmcnt(2)
    v_mul_f32 v124, v120, v124
    v_mul_f32 v125, v120, v125
    v_mfma_f32_16x16x32_bf16 v[204:207], a[88:91], v[112:115], v[204:207]
    s_waitcnt lgkmcnt(1)
    v_cvt_pk_bf16_f32 v192, v124, v125
    v_mul_f32 v126, v120, v126
    v_mfma_f32_16x16x32_bf16 v[212:215], v[176:179], v[28:31], 0
    s_waitcnt lgkmcnt(0)
    v_mul_f32 v127, v120, v127
    v_cvt_pk_bf16_f32 v193, v126, v127
    v_mfma_f32_16x16x32_bf16 v[212:215], v[160:163], v[28:31], v[212:215]
    v_mul_f32 v220, v120, v220
    v_mul_f32 v221, v120, v221
    v_mfma_f32_16x16x32_bf16 v[116:119], v[176:179], v[236:239], 0
    v_cvt_pk_bf16_f32 v194, v220, v221
    v_mul_f32 v222, v120, v222
    v_mfma_f32_16x16x32_bf16 v[116:119], v[160:163], v[248:251], v[116:119]
    v_mul_f32 v223, v120, v223
    v_cvt_pk_bf16_f32 v195, v222, v223
    v_mfma_f32_16x16x32_bf16 v[124:127], v[176:179], v[128:131], 0
    ds_write_b128 v3, v[192:195] offset:6144
    v_mfma_f32_16x16x32_bf16 v[124:127], v[160:163], v[232:235], v[124:127]
    v_mul_f32 v252, v120, v252
    v_mul_f32 v253, v120, v253
    v_mfma_f32_16x16x32_bf16 v[128:131], v[176:179], v[164:167], 0
    v_cvt_pk_bf16_f32 v252, v252, v253
    v_mul_f32 v254, v120, v254
    v_mfma_f32_16x16x32_bf16 v[128:131], v[160:163], v[216:219], v[128:131]
    v_mul_f32 v255, v120, v255
    v_cvt_pk_bf16_f32 v253, v254, v255
    v_mfma_f32_16x16x32_bf16 v[204:207], a[92:95], v[228:231], v[204:207]
    ds_write_b64 v4, v[252:253] offset:10240
    v_mfma_f32_16x16x32_bf16 v[176:179], a[96:99], v[196:199], 0
    v_rcp_f32 v212, v212
    v_mfma_f32_16x16x32_bf16 v[176:179], a[100:103], v[184:187], v[176:179]
    v_mul_f32 v116, v116, v212
    v_mul_f32_dpp v116, v124, v212 quad_perm:[0,1,2,3] row_mask:0x2 bank_mask:0xf
    v_mfma_f32_16x16x32_bf16 v[176:179], a[104:107], v[172:175], v[176:179]
    v_mul_f32_dpp v116, v128, v212 quad_perm:[0,1,2,3] row_mask:0x4 bank_mask:0xf
    v_cvt_pk_bf16_f32 v116, v116, v116
    v_mfma_f32_16x16x32_bf16 v[176:179], a[108:111], v[148:151], v[176:179]
    ds_write_b16 v7, v116
    v_mfma_f32_16x16x32_bf16 v[176:179], a[112:115], v[112:115], v[176:179]
    v_rcp_f32 v140, v140
    v_mfma_f32_16x16x32_bf16 v[176:179], a[116:119], v[228:231], v[176:179]
    v_mul_f32 v144, v140, v144
    v_mul_f32 v145, v140, v145
    v_mfma_f32_16x16x32_bf16 v[124:127], a[120:123], v[196:199], 0
    v_cvt_pk_bf16_f32 v116, v144, v145
    v_mul_f32 v146, v140, v146
    v_mfma_f32_16x16x32_bf16 v[124:127], a[124:127], v[184:187], v[124:127]
    v_mul_f32 v147, v140, v147
    v_cvt_pk_bf16_f32 v117, v146, v147
    v_mfma_f32_16x16x32_bf16 v[124:127], a[128:131], v[172:175], v[124:127]
    v_mul_f32 v168, v140, v168
    v_mul_f32 v169, v140, v169
    v_mfma_f32_16x16x32_bf16 v[124:127], a[132:135], v[148:151], v[124:127]
    v_cvt_pk_bf16_f32 v118, v168, v169
    v_mul_f32 v170, v140, v170
    v_mfma_f32_16x16x32_bf16 v[124:127], a[136:139], v[112:115], v[124:127]
    v_mul_f32 v171, v140, v171
    v_cvt_pk_bf16_f32 v119, v170, v171
    v_mfma_f32_16x16x32_bf16 v[124:127], a[140:143], v[228:231], v[124:127]
    ds_write_b128 v3, v[116:119] offset:12288
    v_mfma_f32_16x16x32_bf16 v[216:219], a[0:3], v[196:199], 0
    v_mul_f32 v188, v140, v188
    v_mul_f32 v189, v140, v189
    v_mfma_f32_16x16x32_bf16 v[216:219], a[4:7], v[184:187], v[216:219]
    v_cvt_pk_bf16_f32 v188, v188, v189
    v_mul_f32 v190, v140, v190
    v_mfma_f32_16x16x32_bf16 v[216:219], a[8:11], v[172:175], v[216:219]
    v_mul_f32 v191, v140, v191
    v_cvt_pk_bf16_f32 v189, v190, v191
    v_mfma_f32_16x16x32_bf16 v[216:219], a[12:15], v[148:151], v[216:219]
    ds_write_b64 v4, v[188:189] offset:16384
    v_mfma_f32_16x16x32_bf16 v[216:219], a[16:19], v[112:115], v[216:219]
    v_fma_f32 v120, v180, v180, s33
    v_fmac_f32 v120, v181, v181
    v_mfma_f32_16x16x32_bf16 v[216:219], a[20:23], v[228:231], v[216:219]
    v_fmac_f32 v120, v182, v182
    v_fmac_f32 v120, v183, v183
    v_mfma_f32_16x16x32_bf16 v[160:163], a[24:27], v[196:199], 0
    v_fmac_f32 v120, v108, v108
    v_fmac_f32 v120, v109, v109
    v_mfma_f32_16x16x32_bf16 v[160:163], a[28:31], v[184:187], v[160:163]
    v_fmac_f32 v120, v110, v110
    v_fmac_f32 v120, v111, v111
    v_mfma_f32_16x16x32_bf16 v[160:163], a[32:35], v[172:175], v[160:163]
    v_fmac_f32 v120, v152, v152
    v_fmac_f32 v120, v153, v153
    v_mfma_f32_16x16x32_bf16 v[160:163], a[36:39], v[148:151], v[160:163]
    v_fmac_f32 v120, v154, v154
    v_fmac_f32 v120, v155, v155
    v_mfma_f32_16x16x32_bf16 v[160:163], a[40:43], v[112:115], v[160:163]
    v_cvt_pk_bf16_f32 v122, v120, v121
    v_add_u32 v5, 336, v5
    v_mfma_f32_16x16x32_bf16 v[160:163], a[44:47], v[228:231], v[160:163]
    ds_write_b64 v4, v[122:123] offset:18432
    v_mfma_f32_16x16x32_bf16 v[116:119], a[48:51], v[196:199], 0
    v_add_u32 v6, 272, v6
    v_add_u32 v7, 16, v7
    v_mfma_f32_16x16x32_bf16 v[116:119], a[52:55], v[184:187], v[116:119]
    v_xor_b32 v2, 65536, v2
    v_xor_b32 v3, 65536, v3
    v_mfma_f32_16x16x32_bf16 v[116:119], a[56:59], v[172:175], v[116:119]
    v_xor_b32 v4, 65536, v4
    v_fma_f32 v169, v204, v204, s32
    v_mfma_f32_16x16x32_bf16 v[116:119], a[60:63], v[148:151], v[116:119]
    v_fmac_f32 v169, v205, v205
    v_fmac_f32 v169, v206, v206
    v_mfma_f32_16x16x32_bf16 v[116:119], a[64:67], v[112:115], v[116:119]
    v_fmac_f32 v169, v207, v207
    v_fmac_f32 v169, v176, v176
    v_mfma_f32_16x16x32_bf16 v[116:119], a[68:71], v[228:231], v[116:119]
    v_fmac_f32 v169, v177, v177
    v_fmac_f32 v169, v178, v178
    v_mfma_f32_16x16x32_bf16 v[128:131], v[196:199], a[144:147], 0
    s_waitcnt lgkmcnt(0)
    v_fmac_f32 v169, v179, v179
    v_fmac_f32 v169, v124, v124
    v_mfma_f32_16x16x32_bf16 v[128:131], v[184:187], a[148:151], v[128:131]
    s_barrier
    v_fmac_f32 v169, v125, v125
    v_fmac_f32 v169, v126, v126
    v_mfma_f32_16x16x32_bf16 v[128:131], v[172:175], a[152:155], v[128:131]
    s_nop 0
    v_fmac_f32 v169, v127, v127
    v_fma_f32 v168, v216, v216, s32
    v_mfma_f32_16x16x32_bf16 v[128:131], v[148:151], a[156:159], v[128:131]
    s_nop 0
    v_fmac_f32 v168, v217, v217
    v_fmac_f32 v168, v218, v218
    v_mfma_f32_16x16x32_bf16 v[128:131], v[112:115], a[160:163], v[128:131]
    s_nop 0
    v_fmac_f32 v168, v219, v219
    v_mfma_f32_16x16x32_bf16 v[128:131], v[228:231], a[164:167], v[128:131]
    s_cbranch_scc1 L_loop_safe0
    s_branch L_drain
.p2align 6
L_loop_safe1:
    v_mfma_f32_16x16x32_bf16 v[188:191], v[196:199], a[168:171], 0
    s_add_u32 s12, s42, s27
    ds_read_b128 v[192:195], v2 offset:18432
    ds_read_b128 v[164:167], v2 offset:19456
    v_mfma_f32_16x16x32_bf16 v[188:191], v[184:187], a[172:175], v[188:191]
    s_addc_u32 s13, s43, 0
    ds_read_b128 v[120:123], v0 offset:26624
    ds_read_b128 v[140:143], v1 offset:26624
    v_mfma_f32_16x16x32_bf16 v[188:191], v[172:175], a[176:179], v[188:191]
    s_sub_u32 s14, s36, s27
    v_fmac_f32 v168, v160, v160
    v_fmac_f32 v168, v161, v161
    v_mfma_f32_16x16x32_bf16 v[188:191], v[148:151], a[180:183], v[188:191]
    s_cmp_ge_u32 s18, 2
    ds_read_b128 v[232:235], v0 offset:26752
    ds_read_b128 v[224:227], v1 offset:26752
    v_mfma_f32_16x16x32_bf16 v[188:191], v[112:115], a[184:187], v[188:191]
    s_cselect_b32 s14, s14, 0
    v_fmac_f32 v168, v162, v162
    v_fmac_f32 v168, v163, v163
    v_mfma_f32_16x16x32_bf16 v[188:191], v[228:231], a[188:191], v[188:191]
    s_add_u32 s34, s18, 2
    ds_read_b128 v[212:215], v0 offset:26880
    ds_read_b128 v[144:147], v1 offset:26880
    v_mfma_f32_16x16x32_bf16 v[220:223], v[196:199], a[192:195], 0
    s_add_u32 s8, s40, s23
    v_fmac_f32 v168, v116, v116
    v_fmac_f32 v168, v117, v117
    v_mfma_f32_16x16x32_bf16 v[220:223], v[184:187], a[196:199], v[220:223]
    s_addc_u32 s9, s41, 0
    v_fmac_f32 v168, v118, v118
    v_fmac_f32 v168, v119, v119
    v_mfma_f32_16x16x32_bf16 v[220:223], v[172:175], a[200:203], v[220:223]
    s_waitcnt lgkmcnt(6)
    v_cvt_pk_bf16_f32 v36, v168, v169
    v_cvt_pk_bf16_f32 v236, v128, v129
    v_mfma_f32_16x16x32_bf16 v[172:175], v[32:35], v[192:195], 0
    s_waitcnt lgkmcnt(4)
    v_cvt_pk_bf16_f32 v237, v130, v131
    v_cvt_pk_bf16_f32 v128, v188, v189
    v_mfma_f32_16x16x32_bf16 v[168:171], v[32:35], v[36:39], 0
    s_sub_u32 s10, s36, s23
    v_cvt_pk_bf16_f32 v129, v190, v191
    s_cmp_lt_u32 s34, s17
    v_mfma_f32_16x16x32_bf16 v[172:175], v[32:35], v[164:167], v[172:175]
    s_cselect_b32 s10, s10, 0
    s_add_u32 m0, s28, 0
    s_mov_b32 s27, s26
    v_mfma_f32_16x16x32_bf16 v[220:223], v[148:151], a[204:207], v[220:223]
    s_mov_b32 s26, s25
    v_rsq_f32 v169, v169
    v_mfma_f32_16x16x32_bf16 v[220:223], v[112:115], a[208:211], v[220:223]
    s_mov_b32 s25, s24
    v_rsq_f32 v168, v168
    v_mfma_f32_16x16x32_bf16 v[220:223], v[228:231], a[212:215], v[220:223]
    s_mov_b32 s24, s23
    v_mul_f32 v168, s31, v168
    v_mul_f32 v171, 0x3baaaaab, v172
    v_mfma_f32_16x16x32_bf16 v[112:115], a[72:75], v[120:123], 0
    s_waitcnt lgkmcnt(0)
    v_rsq_f32 v171, v171
    v_mfma_f32_16x16x32_bf16 v[112:115], a[76:79], v[140:143], v[112:115]
    v_mul_f32 v172, 0x3baaaaab, v173
    v_cvt_pk_bf16_f32 v164, v220, v221
    v_mfma_f32_16x16x32_bf16 v[112:115], a[80:83], v[232:235], v[112:115]
    v_cvt_pk_bf16_f32 v165, v222, v223
    v_mul_f32 v170, 0x3baaaaab, v174
    v_mfma_f32_16x16x32_bf16 v[112:115], a[84:87], v[224:227], v[112:115]
    v_rsq_f32 v172, v172
    v_mfma_f32_16x16x32_bf16 v[112:115], a[88:91], v[212:215], v[112:115]
    v_rsq_f32 v170, v170
    v_mfma_f32_16x16x32_bf16 v[112:115], a[92:95], v[144:147], v[112:115]
    v_mul_f32 v180, v171, v180
    v_mul_f32 v181, v171, v181
    v_mfma_f32_16x16x32_bf16 v[148:151], a[96:99], v[120:123], 0
    v_cvt_pk_bf16_f32 v180, v180, v181
    v_mul_f32 v182, v171, v182
    v_mfma_f32_16x16x32_bf16 v[148:151], a[100:103], v[140:143], v[148:151]
    v_mul_f32 v183, v171, v183
    v_cvt_pk_bf16_f32 v181, v182, v183
    v_mfma_f32_16x16x32_bf16 v[148:151], a[104:107], v[232:235], v[148:151]
    v_mul_f32 v108, v171, v108
    v_mul_f32 v109, v171, v109
    v_mfma_f32_16x16x32_bf16 v[148:151], a[108:111], v[224:227], v[148:151]
    v_cvt_pk_bf16_f32 v182, v108, v109
    v_mul_f32 v110, v171, v110
    v_mfma_f32_16x16x32_bf16 v[148:151], a[112:115], v[212:215], v[148:151]
    v_mul_f32 v111, v171, v111
    v_cvt_pk_bf16_f32 v183, v110, v111
    v_mfma_f32_16x16x32_bf16 v[148:151], a[116:119], v[144:147], v[148:151]
    buffer_store_dwordx4 v[180:183], v15, s[12:15], 0 offen
    v_mul_f32 v152, v171, v152
    v_mul_f32 v153, v171, v153
    v_cvt_pk_bf16_f32 v130, v152, v153
    v_mul_f32 v154, v171, v154
    v_mfma_f32_16x16x32_bf16 v[180:183], a[120:123], v[120:123], 0
    v_mul_f32 v155, v171, v155
    v_cvt_pk_bf16_f32 v131, v154, v155
    v_mfma_f32_16x16x32_bf16 v[180:183], a[124:127], v[140:143], v[180:183]
    v_mul_f32 v204, v169, v204
    v_mul_f32 v205, v169, v205
    v_mfma_f32_16x16x32_bf16 v[180:183], a[128:131], v[232:235], v[180:183]
    v_cvt_pk_bf16_f32 v184, v204, v205
    v_mul_f32 v206, v169, v206
    v_mfma_f32_16x16x32_bf16 v[180:183], a[132:135], v[224:227], v[180:183]
    v_mul_f32 v207, v169, v207
    v_cvt_pk_bf16_f32 v185, v206, v207
    v_mfma_f32_16x16x32_bf16 v[180:183], a[136:139], v[212:215], v[180:183]
    v_mul_f32 v176, v169, v176
    v_mul_f32 v177, v169, v177
    v_mfma_f32_16x16x32_bf16 v[180:183], a[140:143], v[144:147], v[180:183]
    v_cvt_pk_bf16_f32 v186, v176, v177
    v_mul_f32 v178, v169, v178
    v_mfma_f32_16x16x32_bf16 v[108:111], a[0:3], v[120:123], 0
    v_mul_f32 v179, v169, v179
    v_cvt_pk_bf16_f32 v187, v178, v179
    v_mfma_f32_16x16x32_bf16 v[108:111], a[4:7], v[140:143], v[108:111]
    v_mul_f32 v124, v169, v124
    v_mul_f32 v125, v169, v125
    v_mfma_f32_16x16x32_bf16 v[108:111], a[8:11], v[232:235], v[108:111]
    v_cvt_pk_bf16_f32 v178, v124, v125
    v_mul_f32 v126, v169, v126
    v_mfma_f32_16x16x32_bf16 v[108:111], a[12:15], v[224:227], v[108:111]
    v_mul_f32 v127, v169, v127
    v_cvt_pk_bf16_f32 v179, v126, v127
    v_mfma_f32_16x16x32_bf16 v[108:111], a[16:19], v[212:215], v[108:111]
    v_mul_f32 v216, v168, v216
    v_mul_f32 v217, v168, v217
    v_mfma_f32_16x16x32_bf16 v[108:111], a[20:23], v[144:147], v[108:111]
    v_cvt_pk_bf16_f32 v124, v216, v217
    v_mul_f32 v218, v168, v218
    v_mfma_f32_16x16x32_bf16 v[152:155], a[24:27], v[120:123], 0
    v_mul_f32 v219, v168, v219
    v_cvt_pk_bf16_f32 v125, v218, v219
    v_mfma_f32_16x16x32_bf16 v[152:155], a[28:31], v[140:143], v[152:155]
    v_mul_f32 v160, v168, v160
    v_mul_f32 v161, v168, v161
    v_mfma_f32_16x16x32_bf16 v[152:155], a[32:35], v[232:235], v[152:155]
    v_cvt_pk_bf16_f32 v126, v160, v161
    v_mul_f32 v162, v168, v162
    v_mfma_f32_16x16x32_bf16 v[152:155], a[36:39], v[224:227], v[152:155]
    v_mul_f32 v163, v168, v163
    v_cvt_pk_bf16_f32 v127, v162, v163
    v_mfma_f32_16x16x32_bf16 v[152:155], a[40:43], v[212:215], v[152:155]
    buffer_store_dwordx2 v[130:131], v18, s[12:15], 0 offen
    v_mul_f32 v116, v168, v116
    v_mul_f32 v117, v168, v117
    v_mfma_f32_16x16x32_bf16 v[152:155], a[44:47], v[144:147], v[152:155]
    v_cvt_pk_bf16_f32 v176, v116, v117
    v_mul_f32 v118, v168, v118
    v_mfma_f32_16x16x32_bf16 v[160:163], a[48:51], v[120:123], 0
    v_mul_f32 v119, v168, v119
    v_cvt_pk_bf16_f32 v177, v118, v119
    v_mfma_f32_16x16x32_bf16 v[160:163], a[52:55], v[140:143], v[160:163]
    v_fma_f32 v130, v108, v108, s32
    v_fmac_f32 v130, v109, v109
    v_mfma_f32_16x16x32_bf16 v[160:163], a[56:59], v[232:235], v[160:163]
    v_fmac_f32 v130, v110, v110
    v_fmac_f32 v130, v111, v111
    v_mfma_f32_16x16x32_bf16 v[160:163], a[60:63], v[224:227], v[160:163]
    v_fmac_f32 v130, v152, v152
    v_fmac_f32 v130, v153, v153
    v_mfma_f32_16x16x32_bf16 v[160:163], a[64:67], v[212:215], v[160:163]
    v_fmac_f32 v130, v154, v154
    v_fmac_f32 v130, v155, v155
    v_mfma_f32_16x16x32_bf16 v[160:163], a[68:71], v[144:147], v[160:163]
    v_fma_f32 v131, v112, v112, s32
    v_fmac_f32 v131, v113, v113
    v_mfma_f32_16x16x32_bf16 v[188:191], v[120:123], a[144:147], 0
    v_fmac_f32 v131, v114, v114
    v_fmac_f32 v131, v115, v115
    v_mfma_f32_16x16x32_bf16 v[188:191], v[140:143], a[148:151], v[188:191]
    v_fmac_f32 v131, v148, v148
    v_fmac_f32 v131, v149, v149
    v_mfma_f32_16x16x32_bf16 v[188:191], v[232:235], a[152:155], v[188:191]
    v_fmac_f32 v130, v160, v160
    v_fmac_f32 v130, v161, v161
    v_mfma_f32_16x16x32_bf16 v[188:191], v[224:227], a[156:159], v[188:191]
    v_fmac_f32 v130, v162, v162
    v_fmac_f32 v130, v163, v163
    v_mfma_f32_16x16x32_bf16 v[188:191], v[212:215], a[160:163], v[188:191]
    v_fmac_f32 v131, v150, v150
    v_fmac_f32 v131, v151, v151
    v_mfma_f32_16x16x32_bf16 v[188:191], v[144:147], a[164:167], v[188:191]
    v_fmac_f32 v131, v180, v180
    v_fmac_f32 v131, v181, v181
    v_mfma_f32_16x16x32_bf16 v[196:199], v[120:123], a[168:171], 0
    ds_read_b128 v[116:119], v0 offset:32768
    v_fmac_f32 v131, v182, v182
    v_mfma_f32_16x16x32_bf16 v[196:199], v[140:143], a[172:175], v[196:199]
    ds_read_b128 v[204:207], v1 offset:32768
    v_fmac_f32 v131, v183, v183
    v_mfma_f32_16x16x32_bf16 v[196:199], v[232:235], a[176:179], v[196:199]
    ds_read_b128 v[192:195], v0 offset:32896
    v_cvt_pk_bf16_f32 v238, v188, v189
    v_mfma_f32_16x16x32_bf16 v[196:199], v[224:227], a[180:183], v[196:199]
    ds_read_b128 v[220:223], v1 offset:32896
    v_cvt_pk_bf16_f32 v239, v190, v191
    v_mfma_f32_16x16x32_bf16 v[196:199], v[212:215], a[184:187], v[196:199]
    ds_read_b128 v[188:191], v0 offset:33024
    v_cvt_pk_bf16_f32 v36, v130, v131
    v_mfma_f32_16x16x32_bf16 v[196:199], v[144:147], a[188:191], v[196:199]
    ds_read_b128 v[240:243], v1 offset:33024
    v_mul_f32 v200, v170, v200
    v_mfma_f32_16x16x32_bf16 v[216:219], v[32:35], v[36:39], 0
    v_mul_f32 v201, v170, v201
    v_cvt_pk_bf16_f32 v200, v200, v201
    v_mfma_f32_16x16x32_bf16 v[228:231], v[120:123], a[192:195], 0
    v_mul_f32 v202, v170, v202
    v_mul_f32 v203, v170, v203
    v_mfma_f32_16x16x32_bf16 v[228:231], v[140:143], a[196:199], v[228:231]
    s_waitcnt lgkmcnt(5)
    v_cvt_pk_bf16_f32 v130, v196, v197
    v_cvt_pk_bf16_f32 v131, v198, v199
    v_mfma_f32_16x16x32_bf16 v[228:231], v[232:235], a[200:203], v[228:231]
    s_waitcnt lgkmcnt(4)
    v_rsq_f32 v217, v217
    v_mfma_f32_16x16x32_bf16 v[228:231], v[224:227], a[204:207], v[228:231]
    s_waitcnt lgkmcnt(3)
    v_rsq_f32 v216, v216
    v_mfma_f32_16x16x32_bf16 v[228:231], v[212:215], a[208:211], v[228:231]
    s_waitcnt lgkmcnt(2)
    v_mul_f32 v216, s31, v216
    v_mul_f32 v112, v217, v112
    v_mfma_f32_16x16x32_bf16 v[228:231], v[144:147], a[212:215], v[228:231]
    s_waitcnt lgkmcnt(1)
    v_mul_f32 v113, v217, v113
    v_cvt_pk_bf16_f32 v112, v112, v113
    v_mfma_f32_16x16x32_bf16 v[120:123], a[72:75], v[116:119], 0
    s_waitcnt lgkmcnt(0)
    v_mul_f32 v114, v217, v114
    v_mul_f32 v115, v217, v115
    v_mfma_f32_16x16x32_bf16 v[120:123], a[76:79], v[204:207], v[120:123]
    v_cvt_pk_bf16_f32 v166, v228, v229
    v_cvt_pk_bf16_f32 v167, v230, v231
    v_mfma_f32_16x16x32_bf16 v[120:123], a[80:83], v[192:195], v[120:123]
    v_cvt_pk_bf16_f32 v113, v114, v115
    v_mul_f32 v148, v217, v148
    v_mfma_f32_16x16x32_bf16 v[120:123], a[84:87], v[220:223], v[120:123]
    v_mul_f32 v149, v217, v149
    v_cvt_pk_bf16_f32 v114, v148, v149
    v_mfma_f32_16x16x32_bf16 v[120:123], a[88:91], v[188:191], v[120:123]
    v_mul_f32 v150, v217, v150
    v_mul_f32 v151, v217, v151
    v_mfma_f32_16x16x32_bf16 v[120:123], a[92:95], v[240:243], v[120:123]
    v_cvt_pk_bf16_f32 v115, v150, v151
    v_mul_f32 v180, v217, v180
    v_mfma_f32_16x16x32_bf16 v[140:143], a[96:99], v[116:119], 0
    v_mul_f32 v181, v217, v181
    v_cvt_pk_bf16_f32 v146, v180, v181
    v_mfma_f32_16x16x32_bf16 v[140:143], a[100:103], v[204:207], v[140:143]
    v_mul_f32 v182, v217, v182
    v_mul_f32 v183, v217, v183
    v_mfma_f32_16x16x32_bf16 v[140:143], a[104:107], v[192:195], v[140:143]
    v_cvt_pk_bf16_f32 v147, v182, v183
    v_mul_f32 v108, v216, v108
    v_mfma_f32_16x16x32_bf16 v[140:143], a[108:111], v[220:223], v[140:143]
    v_mul_f32 v109, v216, v109
    v_cvt_pk_bf16_f32 v148, v108, v109
    v_mfma_f32_16x16x32_bf16 v[140:143], a[112:115], v[188:191], v[140:143]
    v_mul_f32 v110, v216, v110
    v_mul_f32 v111, v216, v111
    v_mfma_f32_16x16x32_bf16 v[140:143], a[116:119], v[240:243], v[140:143]
    v_cvt_pk_bf16_f32 v149, v110, v111
    v_mul_f32 v152, v216, v152
    v_mfma_f32_16x16x32_bf16 v[108:111], a[120:123], v[116:119], 0
    v_mul_f32 v153, v216, v153
    v_cvt_pk_bf16_f32 v150, v152, v153
    v_mfma_f32_16x16x32_bf16 v[108:111], a[124:127], v[204:207], v[108:111]
    v_mul_f32 v154, v216, v154
    v_mul_f32 v155, v216, v155
    v_mfma_f32_16x16x32_bf16 v[108:111], a[128:131], v[192:195], v[108:111]
    v_cvt_pk_bf16_f32 v151, v154, v155
    v_mul_f32 v160, v216, v160
    v_mfma_f32_16x16x32_bf16 v[108:111], a[132:135], v[220:223], v[108:111]
    v_mul_f32 v161, v216, v161
    v_cvt_pk_bf16_f32 v144, v160, v161
    v_mfma_f32_16x16x32_bf16 v[108:111], a[136:139], v[188:191], v[108:111]
    v_mul_f32 v162, v216, v162
    v_mul_f32 v163, v216, v163
    v_mfma_f32_16x16x32_bf16 v[108:111], a[140:143], v[240:243], v[108:111]
    s_waitcnt vmcnt(2)
    v_cvt_pk_bf16_f32 v145, v162, v163
    v_fma_f32 v168, v120, v120, s32
    v_mfma_f32_16x16x32_bf16 v[152:155], a[0:3], v[116:119], 0
    s_nop 0
    v_fmac_f32 v168, v121, v121
    v_fmac_f32 v168, v122, v122
    v_mfma_f32_16x16x32_bf16 v[152:155], a[4:7], v[204:207], v[152:155]
    s_barrier
    v_fmac_f32 v168, v123, v123
    v_fmac_f32 v168, v140, v140
    v_mfma_f32_16x16x32_bf16 v[152:155], a[8:11], v[192:195], v[152:155]
    s_nop 0
    v_fmac_f32 v168, v141, v141
    v_fmac_f32 v168, v142, v142
    v_mfma_f32_16x16x32_bf16 v[152:155], a[12:15], v[220:223], v[152:155]
    s_nop 0
    buffer_load_dwordx4 v10, s[8:11], 0 offen nt lds
    v_fmac_f32 v168, v143, v143
    v_mfma_f32_16x16x32_bf16 v[152:155], a[16:19], v[188:191], v[152:155]
    s_add_u32 m0, s28, 4096
    v_fmac_f32 v168, v108, v108
    v_fmac_f32 v168, v109, v109
    v_mfma_f32_16x16x32_bf16 v[152:155], a[20:23], v[240:243], v[152:155]
    v_fmac_f32 v168, v110, v110
    v_fmac_f32 v168, v111, v111
    v_mfma_f32_16x16x32_bf16 v[160:163], a[24:27], v[116:119], 0
    v_cvt_pk_bf16_f32 v201, v202, v203
    v_mul_f32 v244, v170, v244
    v_mfma_f32_16x16x32_bf16 v[160:163], a[28:31], v[204:207], v[160:163]
    v_mul_f32 v245, v170, v245
    v_cvt_pk_bf16_f32 v202, v244, v245
    v_mfma_f32_16x16x32_bf16 v[160:163], a[32:35], v[192:195], v[160:163]
    buffer_load_dwordx4 v11, s[8:11], 0 offen nt lds
    v_fma_f32 v169, v152, v152, s32
    v_mfma_f32_16x16x32_bf16 v[160:163], a[36:39], v[220:223], v[160:163]
    s_add_u32 m0, s28, 8192
    v_fmac_f32 v169, v153, v153
    v_fmac_f32 v169, v154, v154
    v_mfma_f32_16x16x32_bf16 v[160:163], a[40:43], v[188:191], v[160:163]
    v_fmac_f32 v169, v155, v155
    v_mul_f32 v246, v170, v246
    v_mfma_f32_16x16x32_bf16 v[160:163], a[44:47], v[240:243], v[160:163]
    v_mul_f32 v247, v170, v247
    v_cvt_pk_bf16_f32 v203, v246, v247
    v_mfma_f32_16x16x32_bf16 v[196:199], a[48:51], v[116:119], 0
    v_mul_f32 v132, v170, v132
    v_mul_f32 v133, v170, v133
    v_mfma_f32_16x16x32_bf16 v[196:199], a[52:55], v[204:207], v[196:199]
    buffer_load_dwordx4 v12, s[8:11], 0 offen nt lds
    v_cvt_pk_bf16_f32 v216, v132, v133
    v_mfma_f32_16x16x32_bf16 v[196:199], a[56:59], v[192:195], v[196:199]
    s_add_u32 m0, s28, 12288
    ds_read2_b32 v[250:251], v6 offset0:0 offset1:0
    ds_read2_b32 v[234:235], v6 offset0:16 offset1:16
    v_mfma_f32_16x16x32_bf16 v[196:199], a[60:63], v[220:223], v[196:199]
    s_xor_b32 s28, s28, 65536
    ds_read_b128 v[224:227], v5 offset:0
    ds_read_b128 v[180:183], v5 offset:16
    v_mfma_f32_16x16x32_bf16 v[196:199], a[64:67], v[188:191], v[196:199]
    v_fmac_f32 v169, v160, v160
    v_fmac_f32 v169, v161, v161
    v_mfma_f32_16x16x32_bf16 v[196:199], a[68:71], v[240:243], v[196:199]
    ds_read_b128 v[212:215], v5 offset:48
    ds_read_b32 v173, v6 offset:192
    v_mfma_f32_16x16x32_bf16 v[228:231], v[116:119], a[144:147], 0
    buffer_load_dwordx4 v13, s[8:11], 0 offen nt lds
    ds_read2_b32 v[218:219], v6 offset0:32 offset1:32
    v_mfma_f32_16x16x32_bf16 v[228:231], v[204:207], a[148:151], v[228:231]
    s_mov_b32 m0, s29
    v_fmac_f32 v169, v162, v162
    v_fmac_f32 v169, v163, v163
    v_mfma_f32_16x16x32_bf16 v[228:231], v[192:195], a[152:155], v[228:231]
    s_xor_b32 s29, s29, s30
    v_fmac_f32 v169, v196, v196
    v_fmac_f32 v169, v197, v197
    v_mfma_f32_16x16x32_bf16 v[228:231], v[220:223], a[156:159], v[228:231]
    s_add_u32 s19, s19, s20
    v_fmac_f32 v169, v198, v198
    v_fmac_f32 v169, v199, v199
    v_mfma_f32_16x16x32_bf16 v[228:231], v[188:191], a[160:163], v[228:231]
    s_add_u32 s23, s23, s21
    v_cvt_pk_bf16_f32 v36, v169, v168
    v_mul_f32 v134, v170, v134
    v_mfma_f32_16x16x32_bf16 v[228:231], v[240:243], a[164:167], v[228:231]
    s_waitcnt lgkmcnt(3)
    buffer_store_dwordx4 v[200:203], v17, s[12:15], 0 offen
    v_mul_f32 v135, v170, v135
    v_cvt_pk_bf16_f32 v217, v134, v135
    v_mul_f32 v136, v172, v136
    v_mul_f32 v137, v172, v137
    v_mfma_f32_16x16x32_bf16 v[168:171], v[32:35], v[36:39], 0
    s_cmp_ge_u32 s19, 72
    v_cvt_pk_bf16_f32 v248, v228, v229
    v_cvt_pk_bf16_f32 v249, v230, v231
    v_mfma_f32_16x16x32_bf16 v[132:135], v[224:227], v[124:127], v[22:25]
    s_cselect_b32 s34, 72, 0
    v_cvt_pk_bf16_f32 v200, v136, v137
    v_mul_f32 v138, v172, v138
    v_mfma_f32_16x16x32_bf16 v[132:135], v[180:183], v[184:187], v[132:135]
    s_waitcnt lgkmcnt(0)
    v_rsq_f32 v169, v169
    v_mfma_f32_16x16x32_bf16 v[132:135], v[212:215], v[176:179], v[132:135]
    s_cselect_b32 s35, s22, 0
    v_rsq_f32 v168, v168
    v_mfma_f32_16x16x32_bf16 v[228:231], v[116:119], a[168:171], 0
    s_sub_u32 s19, s19, s34
    v_mul_f32 v168, s31, v168
    v_mul_f32 v120, v169, v120
    v_mfma_f32_16x16x32_bf16 v[228:231], v[204:207], a[172:175], v[228:231]
    s_add_u32 s23, s23, s35
    v_mov_b32_dpp v173, v133 quad_perm:[0,1,2,3] row_mask:0x1 bank_mask:0xf
    v_mul_f32 v121, v169, v121
    v_mfma_f32_16x16x32_bf16 v[228:231], v[192:195], a[176:179], v[228:231]
    s_add_u32 s18, s18, 1
    v_cvt_pk_bf16_f32 v120, v120, v121
    v_mul_f32 v122, v169, v122
    v_mfma_f32_16x16x32_bf16 v[228:231], v[220:223], a[180:183], v[228:231]
    s_cmp_lt_u32 s18, s17
    v_mul_f32 v123, v169, v123
    v_cvt_pk_bf16_f32 v121, v122, v123
    v_mfma_f32_16x16x32_bf16 v[228:231], v[188:191], a[184:187], v[228:231]
    v_mul_f32 v140, v169, v140
    v_mul_f32 v141, v169, v141
    v_mfma_f32_16x16x32_bf16 v[228:231], v[240:243], a[188:191], v[228:231]
    v_cvt_pk_bf16_f32 v122, v140, v141
    v_mul_f32 v142, v169, v142
    v_mfma_f32_16x16x32_bf16 v[244:247], v[116:119], a[192:195], 0
    v_mul_f32 v143, v169, v143
    v_cvt_pk_bf16_f32 v123, v142, v143
    v_mfma_f32_16x16x32_bf16 v[244:247], v[204:207], a[196:199], v[244:247]
    v_mul_f32 v108, v169, v108
    v_mul_f32 v109, v169, v109
    v_mfma_f32_16x16x32_bf16 v[244:247], v[192:195], a[200:203], v[244:247]
    ds_read_b128 v[116:119], v2 offset:0
    v_cvt_pk_bf16_f32 v232, v228, v229
    v_mfma_f32_16x16x32_bf16 v[244:247], v[220:223], a[204:207], v[244:247]
    ds_read_b128 v[204:207], v2 offset:1024
    v_cvt_pk_bf16_f32 v233, v230, v231
    v_mfma_f32_16x16x32_bf16 v[244:247], v[188:191], a[208:211], v[244:247]
    ds_read_b128 v[140:143], v2 offset:2048
    v_cvt_pk_bf16_f32 v190, v108, v109
    v_mfma_f32_16x16x32_bf16 v[244:247], v[240:243], a[212:215], v[244:247]
    ds_read_b128 v[252:255], v2 offset:3072
    ds_read_b128 v[192:195], v2 offset:4096
    v_mfma_f32_16x16x32_bf16 v[220:223], v[184:187], v[124:127], v[40:43]
    ds_read_b128 v[134:137], v2 offset:5120
    buffer_store_dwordx2 v[216:217], v20, s[12:15], 0 offen
    v_mul_f32 v110, v169, v110
    v_mul_f32 v111, v169, v111
    v_mfma_f32_16x16x32_bf16 v[240:243], v[112:115], v[124:127], v[44:47]
    v_cvt_pk_bf16_f32 v216, v244, v245
    v_cvt_pk_bf16_f32 v217, v246, v247
    v_mfma_f32_16x16x32_bf16 v[228:231], v[120:123], v[124:127], v[48:51]
    v_cvt_pk_bf16_f32 v191, v110, v111
    v_mul_f32 v152, v168, v152
    v_mul_f32 v153, v168, v153
    v_mfma_f32_16x16x16_bf16 v[220:223], v[178:179], v[176:177], v[220:223]
    v_cvt_pk_bf16_f32 v244, v152, v153
    v_mul_f32 v154, v168, v154
    v_mul_f32 v155, v168, v155
    v_mfma_f32_16x16x16_bf16 v[240:243], v[146:147], v[176:177], v[240:243]
    v_cvt_pk_bf16_f32 v245, v154, v155
    v_mul_f32 v160, v168, v160
    v_mul_f32 v161, v168, v161
    v_mfma_f32_16x16x16_bf16 v[228:231], v[190:191], v[176:177], v[228:231]
    v_cvt_pk_bf16_f32 v246, v160, v161
    v_mul_f32 v162, v168, v162
    v_mul_f32 v163, v168, v163
    v_cvt_pk_bf16_f32 v247, v162, v163
    v_mfma_f32_16x16x32_bf16 v[124:127], v[224:227], v[148:151], v[24:27]
    s_waitcnt lgkmcnt(1)
    v_mul_f32 v196, v168, v196
    v_mul_f32 v197, v168, v197
    v_mfma_f32_16x16x32_bf16 v[124:127], v[180:183], v[112:115], v[124:127]
    s_waitcnt lgkmcnt(0)
    v_cvt_pk_bf16_f32 v188, v196, v197
    v_mul_f32 v198, v168, v198
    v_mfma_f32_16x16x32_bf16 v[124:127], v[212:215], v[144:147], v[124:127]
    v_mul_f32 v199, v168, v199
    v_cvt_pk_bf16_f32 v189, v198, v199
    v_mfma_f32_16x16x32_bf16 v[160:163], v[224:227], v[244:247], v[26:29]
    v_max3_f32 v133, v132, v220, v221
    v_max3_f32 v133, v133, v222, v223
    v_mfma_f32_16x16x32_bf16 v[160:163], v[180:183], v[120:123], v[160:163]
    v_max3_f32 v133, v133, v240, v241
    v_max3_f32 v133, v133, v242, v243
    v_mfma_f32_16x16x32_bf16 v[160:163], v[212:215], v[188:191], v[160:163]
    v_max3_f32 v133, v133, v228, v229
    v_max3_f32 v133, v133, v230, v231
    v_mfma_f32_16x16x32_bf16 v[180:183], a[216:219], v[116:119], 0
    v_mov_b32 v174, v133
    v_mov_b32_dpp v173, v125 quad_perm:[0,1,2,3] row_mask:0x2 bank_mask:0xf
    v_mfma_f32_16x16x32_bf16 v[180:183], a[220:223], v[204:207], v[180:183]
    v_permlane32_swap_b32 v133, v174
    v_mfma_f32_16x16x32_bf16 v[180:183], a[224:227], v[140:143], v[180:183]
    v_max_f32 v133, v133, v174
    v_mov_b32 v174, v133
    v_mfma_f32_16x16x32_bf16 v[180:183], a[228:231], v[252:255], v[180:183]
    v_mov_b32_dpp v173, v161 quad_perm:[0,1,2,3] row_mask:0x4 bank_mask:0xf
    v_mul_f32 v139, v172, v139
    v_mfma_f32_16x16x32_bf16 v[180:183], a[232:235], v[192:195], v[180:183]
    v_permlane16_swap_b32 v133, v174
    v_mfma_f32_16x16x32_bf16 v[180:183], a[236:239], v[134:137], v[180:183]
    v_max_f32 v133, v133, v174
    v_sub_f32 v220, v220, v133
    v_mfma_f32_16x16x32_bf16 v[108:111], a[240:243], v[116:119], 0
    v_exp_f32 v220, v220
    v_mfma_f32_16x16x32_bf16 v[108:111], a[244:247], v[204:207], v[108:111]
    v_sub_f32 v221, v221, v133
    v_sub_f32 v222, v222, v133
    v_mfma_f32_16x16x32_bf16 v[108:111], a[248:251], v[140:143], v[108:111]
    v_exp_f32 v221, v221
    v_mfma_f32_16x16x32_bf16 v[108:111], a[252:255], v[252:255], v[108:111]
    ds_read_b128 v[168:171], v2 offset:6144
    v_cvt_pk_bf16_f32 v212, v220, v221
    v_mfma_f32_16x16x32_bf16 v[108:111], v[76:79], v[192:195], v[108:111]
    ds_read_b128 v[196:199], v2 offset:7168
    v_sub_f32 v223, v223, v133
    v_mfma_f32_16x16x32_bf16 v[108:111], v[80:83], v[134:137], v[108:111]
    ds_read_b128 v[224:227], v2 offset:8192
    v_sub_f32 v240, v240, v133
    v_mfma_f32_16x16x32_bf16 v[152:155], v[84:87], v[116:119], 0
    ds_read_b128 v[174:177], v2 offset:9216
    v_sub_f32 v241, v241, v133
    v_mfma_f32_16x16x32_bf16 v[152:155], v[88:91], v[204:207], v[152:155]
    ds_read_b128 v[116:119], v2 offset:10240
    v_sub_f32 v242, v242, v133
    v_mfma_f32_16x16x32_bf16 v[152:155], v[92:95], v[140:143], v[152:155]
    ds_read_b128 v[204:207], v2 offset:11264
    v_sub_f32 v243, v243, v133
    v_mfma_f32_16x16x32_bf16 v[152:155], v[96:99], v[252:255], v[152:155]
    v_exp_f32 v222, v222
    v_mfma_f32_16x16x32_bf16 v[152:155], v[100:103], v[192:195], v[152:155]
    v_exp_f32 v223, v223
    v_mfma_f32_16x16x32_bf16 v[152:155], v[104:107], v[134:137], v[152:155]
    s_waitcnt lgkmcnt(5)
    v_cvt_pk_bf16_f32 v213, v222, v223
    v_exp_f32 v240, v240
    v_exp_f32 v241, v241
    v_mfma_f32_16x16x32_bf16 v[140:143], v[184:187], v[148:151], v[52:55]
    s_waitcnt lgkmcnt(3)
    v_cvt_pk_bf16_f32 v214, v240, v241
    v_exp_f32 v242, v242
    v_exp_f32 v243, v243
    v_sub_f32 v228, v228, v133
    v_cvt_pk_bf16_f32 v215, v242, v243
    v_mfma_f32_16x16x16_bf16 v[140:143], v[178:179], v[144:145], v[140:143]
    v_exp_f32 v228, v228
    v_sub_f32 v229, v229, v133
    v_exp_f32 v229, v229
    v_mfma_f32_16x16x32_bf16 v[192:195], v[112:115], v[148:151], v[56:59]
    s_waitcnt lgkmcnt(0)
    v_cvt_pk_bf16_f32 v36, v228, v229
    v_sub_f32 v230, v230, v133
    v_exp_f32 v230, v230
    v_sub_f32 v231, v231, v133
    v_exp_f32 v231, v231
    v_mfma_f32_16x16x32_bf16 v[220:223], v[120:123], v[148:151], v[60:63]
    v_cvt_pk_bf16_f32 v37, v230, v231
    v_sub_f32 v132, v132, v133
    v_max3_f32 v203, v124, v140, v141
    v_mfma_f32_16x16x16_bf16 v[192:195], v[146:147], v[144:145], v[192:195]
    v_exp_f32 v132, v132
    v_max3_f32 v203, v203, v142, v143
    v_mfma_f32_16x16x16_bf16 v[220:223], v[190:191], v[144:145], v[220:223]
    v_cvt_pk_bf16_f32 v39, v132, 0
    v_cvt_pk_bf16_f32 v201, v138, v139
    v_mul_f32 v208, v172, v208
    v_mul_f32 v209, v172, v209
    v_mfma_f32_16x16x32_bf16 v[132:135], v[28:31], v[36:39], 0
    v_max3_f32 v203, v203, v192, v193
    v_max3_f32 v203, v203, v194, v195
    v_mfma_f32_16x16x32_bf16 v[132:135], v[28:31], v[212:215], v[132:135]
    v_max3_f32 v203, v203, v220, v221
    v_max3_f32 v203, v203, v222, v223
    v_mfma_f32_16x16x32_bf16 v[148:151], v[248:251], v[36:39], 0
    v_mov_b32 v144, v203
    v_cvt_pk_bf16_f32 v202, v208, v209
    v_mfma_f32_16x16x32_bf16 v[148:151], v[236:239], v[212:215], v[148:151]
    v_permlane32_swap_b32 v203, v144
    v_mfma_f32_16x16x32_bf16 v[228:231], v[232:235], v[36:39], 0
    v_max_f32 v203, v203, v144
    v_mov_b32 v144, v203
    v_mfma_f32_16x16x32_bf16 v[228:231], v[128:131], v[212:215], v[228:231]
    v_rcp_f32 v132, v132
    v_mfma_f32_16x16x32_bf16 v[240:243], v[216:219], v[36:39], 0
    v_permlane16_swap_b32 v203, v144
    v_mfma_f32_16x16x32_bf16 v[240:243], v[164:167], v[212:215], v[240:243]
    v_max_f32 v203, v203, v144
    v_sub_f32 v140, v140, v203
    v_mfma_f32_16x16x32_bf16 v[136:139], a[216:219], v[168:171], 0
    v_exp_f32 v140, v140
    v_mfma_f32_16x16x32_bf16 v[136:139], a[220:223], v[196:199], v[136:139]
    v_sub_f32 v141, v141, v203
    v_sub_f32 v142, v142, v203
    v_mfma_f32_16x16x32_bf16 v[136:139], a[224:227], v[224:227], v[136:139]
    v_exp_f32 v141, v141
    v_mfma_f32_16x16x32_bf16 v[136:139], a[228:231], v[174:177], v[136:139]
    v_cvt_pk_bf16_f32 v140, v140, v141
    v_sub_f32 v143, v143, v203
    v_mfma_f32_16x16x32_bf16 v[136:139], a[232:235], v[116:119], v[136:139]
    v_exp_f32 v142, v142
    v_mfma_f32_16x16x32_bf16 v[136:139], a[236:239], v[204:207], v[136:139]
    v_exp_f32 v143, v143
    v_sub_f32 v192, v192, v203
    v_cvt_pk_bf16_f32 v141, v142, v143
    v_exp_f32 v192, v192
    v_sub_f32 v193, v193, v203
    v_exp_f32 v193, v193
    v_sub_f32 v194, v194, v203
    v_cvt_pk_bf16_f32 v142, v192, v193
    v_exp_f32 v194, v194
    v_sub_f32 v195, v195, v203
    v_exp_f32 v195, v195
    v_sub_f32 v220, v220, v203
    v_cvt_pk_bf16_f32 v143, v194, v195
    v_exp_f32 v220, v220
    v_sub_f32 v221, v221, v203
    v_exp_f32 v221, v221
    v_sub_f32 v222, v222, v203
    v_cvt_pk_bf16_f32 v36, v220, v221
    v_exp_f32 v222, v222
    v_sub_f32 v223, v223, v203
    v_exp_f32 v223, v223
    v_mfma_f32_16x16x32_bf16 v[192:195], v[184:187], v[244:247], v[64:67]
    v_cvt_pk_bf16_f32 v37, v222, v223
    v_sub_f32 v124, v124, v203
    v_mfma_f32_16x16x32_bf16 v[184:187], v[112:115], v[244:247], v[68:71]
    v_exp_f32 v124, v124
    v_mfma_f32_16x16x32_bf16 v[212:215], v[120:123], v[244:247], v[72:75]
    v_cvt_pk_bf16_f32 v39, v124, 0
    v_mul_f32 v148, v132, v148
    v_mul_f32 v149, v132, v149
    v_mfma_f32_16x16x32_bf16 v[120:123], v[28:31], v[36:39], 0
    v_cvt_pk_bf16_f32 v112, v148, v149
    v_mul_f32 v150, v132, v150
    v_mfma_f32_16x16x32_bf16 v[120:123], v[28:31], v[140:143], v[120:123]
    v_mul_f32 v151, v132, v151
    v_cvt_pk_bf16_f32 v113, v150, v151
    v_mfma_f32_16x16x32_bf16 v[124:127], v[248:251], v[36:39], 0
    v_mul_f32 v228, v132, v228
    v_mul_f32 v229, v132, v229
    v_mfma_f32_16x16x32_bf16 v[124:127], v[236:239], v[140:143], v[124:127]
    v_cvt_pk_bf16_f32 v114, v228, v229
    v_mul_f32 v230, v132, v230
    v_mfma_f32_16x16x32_bf16 v[220:223], v[232:235], v[36:39], 0
    v_mul_f32 v231, v132, v231
    v_cvt_pk_bf16_f32 v115, v230, v231
    v_mfma_f32_16x16x32_bf16 v[220:223], v[128:131], v[140:143], v[220:223]
    ds_write_b128 v3, v[112:115] offset:0
    v_mfma_f32_16x16x32_bf16 v[252:255], v[216:219], v[36:39], 0
    v_mul_f32 v240, v132, v240
    v_mul_f32 v241, v132, v241
    v_mfma_f32_16x16x32_bf16 v[252:255], v[164:167], v[140:143], v[252:255]
    v_cvt_pk_bf16_f32 v122, v240, v241
    v_mul_f32 v242, v132, v242
    v_mul_f32 v243, v132, v243
    v_mfma_f32_16x16x16_bf16 v[192:195], v[178:179], v[188:189], v[192:195]
    v_cvt_pk_bf16_f32 v123, v242, v243
    v_mul_f32 v210, v172, v210
    v_mul_f32 v211, v172, v211
    v_mfma_f32_16x16x16_bf16 v[184:187], v[146:147], v[188:189], v[184:187]
    v_cvt_pk_bf16_f32 v203, v210, v211
    v_mul_f32 v156, v172, v156
    v_mul_f32 v157, v172, v157
    v_mfma_f32_16x16x16_bf16 v[212:215], v[190:191], v[188:189], v[212:215]
    v_cvt_pk_bf16_f32 v178, v156, v157
    v_mul_f32 v158, v172, v158
    v_mul_f32 v159, v172, v159
    v_cvt_pk_bf16_f32 v179, v158, v159
    v_mfma_f32_16x16x32_bf16 v[208:211], a[240:243], v[168:171], 0
    ds_write_b64 v4, v[122:123] offset:4096
    v_mfma_f32_16x16x32_bf16 v[208:211], a[244:247], v[196:199], v[208:211]
    buffer_store_dwordx4 v[200:203], v16, s[12:15], 0 offen
    v_mov_b32 v172, v173
    v_max3_f32 v121, v160, v192, v193
    v_max3_f32 v121, v121, v194, v195
    v_max_f32_dpp v172, v172, v172 quad_perm:[1,0,3,2] row_mask:0xf bank_mask:0xf
    v_mfma_f32_16x16x32_bf16 v[208:211], a[248:251], v[224:227], v[208:211]
    v_max3_f32 v121, v121, v184, v185
    v_max_f32_dpp v172, v172, v172 quad_perm:[2,3,0,1] row_mask:0xf bank_mask:0xf
    v_mfma_f32_16x16x32_bf16 v[208:211], a[252:255], v[174:177], v[208:211]
    ds_read_b128 v[112:115], v2 offset:12288
    v_max_f32_dpp v172, v172, v172 row_half_mirror row_mask:0xf bank_mask:0xf
    v_mfma_f32_16x16x32_bf16 v[208:211], v[76:79], v[116:119], v[208:211]
    ds_read_b128 v[188:191], v2 offset:13312
    v_max_f32_dpp v172, v172, v172 row_mirror row_mask:0xf bank_mask:0xf
    v_mfma_f32_16x16x32_bf16 v[208:211], v[80:83], v[204:207], v[208:211]
    ds_read_b128 v[144:147], v2 offset:14336
    v_mov_b32 v122, v172
    v_mfma_f32_16x16x32_bf16 v[156:159], v[84:87], v[168:171], 0
    ds_read_b128 v[140:143], v2 offset:15360
    v_max3_f32 v121, v121, v186, v187
    v_mfma_f32_16x16x32_bf16 v[156:159], v[88:91], v[196:199], v[156:159]
    ds_read_b128 v[168:171], v2 offset:16384
    v_max3_f32 v121, v121, v212, v213
    v_mfma_f32_16x16x32_bf16 v[156:159], v[92:95], v[224:227], v[156:159]
    ds_read_b128 v[148:151], v2 offset:17408
    v_max3_f32 v121, v121, v214, v215
    v_mfma_f32_16x16x32_bf16 v[156:159], v[96:99], v[174:177], v[156:159]
    v_permlane32_swap_b32 v172, v122
    v_mfma_f32_16x16x32_bf16 v[156:159], v[100:103], v[116:119], v[156:159]
    v_max_f32 v172, v172, v122
    v_mov_b32 v122, v172
    v_mfma_f32_16x16x32_bf16 v[156:159], v[104:107], v[204:207], v[156:159]
    s_waitcnt lgkmcnt(5)
    v_permlane16_swap_b32 v172, v122
    v_mfma_f32_16x16x32_bf16 v[200:203], a[216:219], v[112:115], 0
    s_waitcnt lgkmcnt(4)
    v_max_f32 v172, v172, v122
    v_sub_f32 v173, v173, v172
    v_mfma_f32_16x16x32_bf16 v[200:203], a[220:223], v[188:191], v[200:203]
    s_waitcnt lgkmcnt(3)
    v_exp_f32 v173, v173
    v_mfma_f32_16x16x32_bf16 v[200:203], a[224:227], v[144:147], v[200:203]
    s_waitcnt lgkmcnt(2)
    v_cvt_pk_bf16_f32 v173, v173, v173
    v_mov_b32 v122, v121
    v_mfma_f32_16x16x32_bf16 v[200:203], a[228:231], v[140:143], v[200:203]
    s_waitcnt lgkmcnt(1)
    ds_write_b16 v8, v173
    v_mfma_f32_16x16x32_bf16 v[200:203], a[232:235], v[168:171], v[200:203]
    s_waitcnt lgkmcnt(1)
    v_permlane32_swap_b32 v121, v122
    v_mfma_f32_16x16x32_bf16 v[200:203], a[236:239], v[148:151], v[200:203]
    v_max_f32 v121, v121, v122
    v_mov_b32 v122, v121
    v_mfma_f32_16x16x32_bf16 v[244:247], a[240:243], v[112:115], 0
    buffer_store_dwordx2 v[178:179], v19, s[12:15], 0 offen
    v_permlane16_swap_b32 v121, v122
    v_mfma_f32_16x16x32_bf16 v[244:247], a[244:247], v[188:191], v[244:247]
    v_max_f32 v121, v121, v122
    v_sub_f32 v192, v192, v121
    v_mfma_f32_16x16x32_bf16 v[244:247], a[248:251], v[144:147], v[244:247]
    v_fma_f32 v122, v200, v200, s33
    v_fmac_f32 v122, v201, v201
    v_mfma_f32_16x16x32_bf16 v[244:247], a[252:255], v[140:143], v[244:247]
    v_fmac_f32 v122, v202, v202
    v_fmac_f32 v122, v203, v203
    v_mfma_f32_16x16x32_bf16 v[244:247], v[76:79], v[168:171], v[244:247]
    v_exp_f32 v192, v192
    v_mfma_f32_16x16x32_bf16 v[244:247], v[80:83], v[148:151], v[244:247]
    v_sub_f32 v193, v193, v121
    v_sub_f32 v194, v194, v121
    v_mfma_f32_16x16x32_bf16 v[132:135], v[84:87], v[112:115], 0
    v_exp_f32 v193, v193
    v_mfma_f32_16x16x32_bf16 v[132:135], v[88:91], v[188:191], v[132:135]
    v_cvt_pk_bf16_f32 v116, v192, v193
    v_sub_f32 v195, v195, v121
    v_mfma_f32_16x16x32_bf16 v[132:135], v[92:95], v[144:147], v[132:135]
    v_fmac_f32 v122, v244, v244
    v_fmac_f32 v122, v245, v245
    v_mfma_f32_16x16x32_bf16 v[132:135], v[96:99], v[140:143], v[132:135]
    v_fmac_f32 v122, v246, v246
    v_fmac_f32 v122, v247, v247
    v_mfma_f32_16x16x32_bf16 v[132:135], v[100:103], v[168:171], v[132:135]
    v_exp_f32 v194, v194
    v_mfma_f32_16x16x32_bf16 v[132:135], v[104:107], v[148:151], v[132:135]
    v_exp_f32 v195, v195
    v_sub_f32 v184, v184, v121
    v_cvt_pk_bf16_f32 v117, v194, v195
    v_exp_f32 v184, v184
    v_sub_f32 v185, v185, v121
    v_exp_f32 v185, v185
    v_sub_f32 v186, v186, v121
    v_cvt_pk_bf16_f32 v118, v184, v185
    v_fmac_f32 v122, v132, v132
    v_fmac_f32 v122, v133, v133
    v_fmac_f32 v122, v134, v134
    v_fmac_f32 v122, v135, v135
    v_cvt_pk_bf16_f32 v123, v122, v122
    v_exp_f32 v186, v186
    v_sub_f32 v187, v187, v121
    v_exp_f32 v187, v187
    v_sub_f32 v212, v212, v121
    v_cvt_pk_bf16_f32 v119, v186, v187
    v_exp_f32 v212, v212
    v_sub_f32 v213, v213, v121
    v_exp_f32 v213, v213
    v_sub_f32 v214, v214, v121
    v_cvt_pk_bf16_f32 v36, v212, v213
    v_exp_f32 v214, v214
    v_sub_f32 v215, v215, v121
    v_exp_f32 v215, v215
    v_sub_f32 v160, v160, v121
    v_cvt_pk_bf16_f32 v37, v214, v215
    v_exp_f32 v160, v160
    v_xor_b32 v0, 65536, v0
    v_cvt_pk_bf16_f32 v39, v160, 0
    v_xor_b32 v1, 65536, v1
    v_fma_f32 v121, v136, v136, s33
    v_mfma_f32_16x16x32_bf16 v[140:143], v[28:31], v[36:39], 0
    ds_read_b128 v[196:199], v0 offset:20480
    ds_read_b128 v[184:187], v1 offset:20480
    v_mfma_f32_16x16x32_bf16 v[140:143], v[28:31], v[116:119], v[140:143]
    ds_read_b128 v[172:175], v0 offset:20608
    ds_read_b128 v[148:151], v1 offset:20608
    v_mfma_f32_16x16x32_bf16 v[144:147], v[248:251], v[36:39], 0
    buffer_load_dwordx4 v14, s[8:11], 0 offen nt lds
    ds_read_b128 v[112:115], v0 offset:20736
    v_mfma_f32_16x16x32_bf16 v[144:147], v[236:239], v[116:119], v[144:147]
    v_fmac_f32 v121, v137, v137
    v_fmac_f32 v121, v138, v138
    v_mfma_f32_16x16x32_bf16 v[168:171], v[232:235], v[36:39], 0
    ds_read_b128 v[228:231], v1 offset:20736
    ds_read_b128 v[176:179], v9
    v_mfma_f32_16x16x32_bf16 v[168:171], v[128:131], v[116:119], v[168:171]
    v_fmac_f32 v121, v139, v139
    v_fmac_f32 v121, v208, v208
    v_mfma_f32_16x16x32_bf16 v[188:191], v[216:219], v[36:39], 0
    ds_read_b128 v[160:163], v9 offset:64
    v_fmac_f32 v121, v209, v209
    v_mfma_f32_16x16x32_bf16 v[188:191], v[164:167], v[116:119], v[188:191]
    v_fmac_f32 v121, v210, v210
    v_fmac_f32 v121, v211, v211
    s_waitcnt lgkmcnt(6)
    v_mfma_f32_16x16x32_bf16 v[204:207], a[72:75], v[196:199], 0
    s_waitcnt lgkmcnt(5)
    v_fmac_f32 v121, v156, v156
    v_fmac_f32 v121, v157, v157
    v_mfma_f32_16x16x32_bf16 v[204:207], a[76:79], v[184:187], v[204:207]
    s_waitcnt lgkmcnt(4)
    v_fmac_f32 v121, v158, v158
    v_fmac_f32 v121, v159, v159
    v_mfma_f32_16x16x32_bf16 v[204:207], a[80:83], v[172:175], v[204:207]
    s_waitcnt lgkmcnt(3)
    v_rcp_f32 v120, v120
    v_mfma_f32_16x16x32_bf16 v[204:207], a[84:87], v[148:151], v[204:207]
    s_waitcnt lgkmcnt(2)
    v_mul_f32 v124, v120, v124
    v_mul_f32 v125, v120, v125
    v_mfma_f32_16x16x32_bf16 v[204:207], a[88:91], v[112:115], v[204:207]
    s_waitcnt lgkmcnt(1)
    v_cvt_pk_bf16_f32 v192, v124, v125
    v_mul_f32 v126, v120, v126
    v_mfma_f32_16x16x32_bf16 v[212:215], v[176:179], v[28:31], 0
    s_waitcnt lgkmcnt(0)
    v_mul_f32 v127, v120, v127
    v_cvt_pk_bf16_f32 v193, v126, v127
    v_mfma_f32_16x16x32_bf16 v[212:215], v[160:163], v[28:31], v[212:215]
    v_mul_f32 v220, v120, v220
    v_mul_f32 v221, v120, v221
    v_mfma_f32_16x16x32_bf16 v[116:119], v[176:179], v[236:239], 0
    v_cvt_pk_bf16_f32 v194, v220, v221
    v_mul_f32 v222, v120, v222
    v_mfma_f32_16x16x32_bf16 v[116:119], v[160:163], v[248:251], v[116:119]
    v_mul_f32 v223, v120, v223
    v_cvt_pk_bf16_f32 v195, v222, v223
    v_mfma_f32_16x16x32_bf16 v[124:127], v[176:179], v[128:131], 0
    ds_write_b128 v3, v[192:195] offset:6144
    v_mfma_f32_16x16x32_bf16 v[124:127], v[160:163], v[232:235], v[124:127]
    v_mul_f32 v252, v120, v252
    v_mul_f32 v253, v120, v253
    v_mfma_f32_16x16x32_bf16 v[128:131], v[176:179], v[164:167], 0
    v_cvt_pk_bf16_f32 v252, v252, v253
    v_mul_f32 v254, v120, v254
    v_mfma_f32_16x16x32_bf16 v[128:131], v[160:163], v[216:219], v[128:131]
    v_mul_f32 v255, v120, v255
    v_cvt_pk_bf16_f32 v253, v254, v255
    v_mfma_f32_16x16x32_bf16 v[204:207], a[92:95], v[228:231], v[204:207]
    ds_write_b64 v4, v[252:253] offset:10240
    v_mfma_f32_16x16x32_bf16 v[176:179], a[96:99], v[196:199], 0
    v_rcp_f32 v212, v212
    v_mfma_f32_16x16x32_bf16 v[176:179], a[100:103], v[184:187], v[176:179]
    v_mul_f32 v116, v116, v212
    v_mul_f32_dpp v116, v124, v212 quad_perm:[0,1,2,3] row_mask:0x2 bank_mask:0xf
    v_mfma_f32_16x16x32_bf16 v[176:179], a[104:107], v[172:175], v[176:179]
    v_mul_f32_dpp v116, v128, v212 quad_perm:[0,1,2,3] row_mask:0x4 bank_mask:0xf
    v_cvt_pk_bf16_f32 v116, v116, v116
    v_mfma_f32_16x16x32_bf16 v[176:179], a[108:111], v[148:151], v[176:179]
    ds_write_b16 v7, v116
    v_mfma_f32_16x16x32_bf16 v[176:179], a[112:115], v[112:115], v[176:179]
    v_rcp_f32 v140, v140
    v_mfma_f32_16x16x32_bf16 v[176:179], a[116:119], v[228:231], v[176:179]
    v_mul_f32 v144, v140, v144
    v_mul_f32 v145, v140, v145
    v_mfma_f32_16x16x32_bf16 v[124:127], a[120:123], v[196:199], 0
    v_cvt_pk_bf16_f32 v116, v144, v145
    v_mul_f32 v146, v140, v146
    v_mfma_f32_16x16x32_bf16 v[124:127], a[124:127], v[184:187], v[124:127]
    v_mul_f32 v147, v140, v147
    v_cvt_pk_bf16_f32 v117, v146, v147
    v_mfma_f32_16x16x32_bf16 v[124:127], a[128:131], v[172:175], v[124:127]
    v_mul_f32 v168, v140, v168
    v_mul_f32 v169, v140, v169
    v_mfma_f32_16x16x32_bf16 v[124:127], a[132:135], v[148:151], v[124:127]
    v_cvt_pk_bf16_f32 v118, v168, v169
    v_mul_f32 v170, v140, v170
    v_mfma_f32_16x16x32_bf16 v[124:127], a[136:139], v[112:115], v[124:127]
    v_mul_f32 v171, v140, v171
    v_cvt_pk_bf16_f32 v119, v170, v171
    v_mfma_f32_16x16x32_bf16 v[124:127], a[140:143], v[228:231], v[124:127]
    ds_write_b128 v3, v[116:119] offset:12288
    v_mfma_f32_16x16x32_bf16 v[216:219], a[0:3], v[196:199], 0
    v_mul_f32 v188, v140, v188
    v_mul_f32 v189, v140, v189
    v_mfma_f32_16x16x32_bf16 v[216:219], a[4:7], v[184:187], v[216:219]
    v_cvt_pk_bf16_f32 v188, v188, v189
    v_mul_f32 v190, v140, v190
    v_mfma_f32_16x16x32_bf16 v[216:219], a[8:11], v[172:175], v[216:219]
    v_mul_f32 v191, v140, v191
    v_cvt_pk_bf16_f32 v189, v190, v191
    v_mfma_f32_16x16x32_bf16 v[216:219], a[12:15], v[148:151], v[216:219]
    ds_write_b64 v4, v[188:189] offset:16384
    v_mfma_f32_16x16x32_bf16 v[216:219], a[16:19], v[112:115], v[216:219]
    v_fma_f32 v120, v180, v180, s33
    v_fmac_f32 v120, v181, v181
    v_mfma_f32_16x16x32_bf16 v[216:219], a[20:23], v[228:231], v[216:219]
    v_fmac_f32 v120, v182, v182
    v_fmac_f32 v120, v183, v183
    v_mfma_f32_16x16x32_bf16 v[160:163], a[24:27], v[196:199], 0
    v_fmac_f32 v120, v108, v108
    v_fmac_f32 v120, v109, v109
    v_mfma_f32_16x16x32_bf16 v[160:163], a[28:31], v[184:187], v[160:163]
    v_fmac_f32 v120, v110, v110
    v_fmac_f32 v120, v111, v111
    v_mfma_f32_16x16x32_bf16 v[160:163], a[32:35], v[172:175], v[160:163]
    v_fmac_f32 v120, v152, v152
    v_fmac_f32 v120, v153, v153
    v_mfma_f32_16x16x32_bf16 v[160:163], a[36:39], v[148:151], v[160:163]
    v_fmac_f32 v120, v154, v154
    v_fmac_f32 v120, v155, v155
    v_mfma_f32_16x16x32_bf16 v[160:163], a[40:43], v[112:115], v[160:163]
    v_cvt_pk_bf16_f32 v122, v120, v121
    v_add_u32 v5, 336, v5
    v_mfma_f32_16x16x32_bf16 v[160:163], a[44:47], v[228:231], v[160:163]
    ds_write_b64 v4, v[122:123] offset:18432
    v_mfma_f32_16x16x32_bf16 v[116:119], a[48:51], v[196:199], 0
    v_add_u32 v6, 272, v6
    v_add_u32 v7, 16, v7
    v_mfma_f32_16x16x32_bf16 v[116:119], a[52:55], v[184:187], v[116:119]
    v_xor_b32 v2, 65536, v2
    v_xor_b32 v3, 65536, v3
    v_mfma_f32_16x16x32_bf16 v[116:119], a[56:59], v[172:175], v[116:119]
    v_xor_b32 v4, 65536, v4
    v_fma_f32 v169, v204, v204, s32
    v_mfma_f32_16x16x32_bf16 v[116:119], a[60:63], v[148:151], v[116:119]
    v_fmac_f32 v169, v205, v205
    v_fmac_f32 v169, v206, v206
    v_mfma_f32_16x16x32_bf16 v[116:119], a[64:67], v[112:115], v[116:119]
    v_fmac_f32 v169, v207, v207
    v_fmac_f32 v169, v176, v176
    v_mfma_f32_16x16x32_bf16 v[116:119], a[68:71], v[228:231], v[116:119]
    v_fmac_f32 v169, v177, v177
    v_fmac_f32 v169, v178, v178
    v_mfma_f32_16x16x32_bf16 v[128:131], v[196:199], a[144:147], 0
    s_waitcnt lgkmcnt(0)
    v_fmac_f32 v169, v179, v179
    v_fmac_f32 v169, v124, v124
    v_mfma_f32_16x16x32_bf16 v[128:131], v[184:187], a[148:151], v[128:131]
    s_nop 0
    v_fmac_f32 v169, v125, v125
    v_fmac_f32 v169, v126, v126
    v_mfma_f32_16x16x32_bf16 v[128:131], v[172:175], a[152:155], v[128:131]
    s_barrier
    v_fmac_f32 v169, v127, v127
    v_fma_f32 v168, v216, v216, s32
    v_mfma_f32_16x16x32_bf16 v[128:131], v[148:151], a[156:159], v[128:131]
    s_nop 0
    v_fmac_f32 v168, v217, v217
    v_fmac_f32 v168, v218, v218
    v_mfma_f32_16x16x32_bf16 v[128:131], v[112:115], a[160:163], v[128:131]
    s_nop 0
    v_fmac_f32 v168, v219, v219
    v_mfma_f32_16x16x32_bf16 v[128:131], v[228:231], a[164:167], v[128:131]
    s_cbranch_scc1 L_loop_safe1
    s_branch L_drain
.p2align 6
L_loop_safe2:
    v_mfma_f32_16x16x32_bf16 v[188:191], v[196:199], a[168:171], 0
    s_add_u32 s12, s42, s27
    ds_read_b128 v[192:195], v2 offset:18432
    ds_read_b128 v[164:167], v2 offset:19456
    v_mfma_f32_16x16x32_bf16 v[188:191], v[184:187], a[172:175], v[188:191]
    s_addc_u32 s13, s43, 0
    ds_read_b128 v[120:123], v0 offset:26624
    ds_read_b128 v[140:143], v1 offset:26624
    v_mfma_f32_16x16x32_bf16 v[188:191], v[172:175], a[176:179], v[188:191]
    s_sub_u32 s14, s36, s27
    v_fmac_f32 v168, v160, v160
    v_fmac_f32 v168, v161, v161
    v_mfma_f32_16x16x32_bf16 v[188:191], v[148:151], a[180:183], v[188:191]
    s_cmp_ge_u32 s18, 2
    ds_read_b128 v[232:235], v0 offset:26752
    ds_read_b128 v[224:227], v1 offset:26752
    v_mfma_f32_16x16x32_bf16 v[188:191], v[112:115], a[184:187], v[188:191]
    s_cselect_b32 s14, s14, 0
    v_fmac_f32 v168, v162, v162
    v_fmac_f32 v168, v163, v163
    v_mfma_f32_16x16x32_bf16 v[188:191], v[228:231], a[188:191], v[188:191]
    s_add_u32 s34, s18, 2
    ds_read_b128 v[212:215], v0 offset:26880
    ds_read_b128 v[144:147], v1 offset:26880
    v_mfma_f32_16x16x32_bf16 v[220:223], v[196:199], a[192:195], 0
    s_add_u32 s8, s40, s23
    v_fmac_f32 v168, v116, v116
    v_fmac_f32 v168, v117, v117
    v_mfma_f32_16x16x32_bf16 v[220:223], v[184:187], a[196:199], v[220:223]
    s_addc_u32 s9, s41, 0
    v_fmac_f32 v168, v118, v118
    v_fmac_f32 v168, v119, v119
    v_mfma_f32_16x16x32_bf16 v[220:223], v[172:175], a[200:203], v[220:223]
    s_waitcnt lgkmcnt(6)
    v_cvt_pk_bf16_f32 v36, v168, v169
    v_cvt_pk_bf16_f32 v236, v128, v129
    v_mfma_f32_16x16x32_bf16 v[172:175], v[32:35], v[192:195], 0
    s_waitcnt lgkmcnt(4)
    v_cvt_pk_bf16_f32 v237, v130, v131
    v_cvt_pk_bf16_f32 v128, v188, v189
    v_mfma_f32_16x16x32_bf16 v[168:171], v[32:35], v[36:39], 0
    s_sub_u32 s10, s36, s23
    v_cvt_pk_bf16_f32 v129, v190, v191
    s_cmp_lt_u32 s34, s17
    v_mfma_f32_16x16x32_bf16 v[172:175], v[32:35], v[164:167], v[172:175]
    s_cselect_b32 s10, s10, 0
    s_add_u32 m0, s28, 0
    s_mov_b32 s27, s26
    v_mfma_f32_16x16x32_bf16 v[220:223], v[148:151], a[204:207], v[220:223]
    s_mov_b32 s26, s25
    v_rsq_f32 v169, v169
    v_mfma_f32_16x16x32_bf16 v[220:223], v[112:115], a[208:211], v[220:223]
    s_mov_b32 s25, s24
    v_rsq_f32 v168, v168
    v_mfma_f32_16x16x32_bf16 v[220:223], v[228:231], a[212:215], v[220:223]
    s_mov_b32 s24, s23
    v_mul_f32 v168, s31, v168
    v_mul_f32 v171, 0x3baaaaab, v172
    v_mfma_f32_16x16x32_bf16 v[112:115], a[72:75], v[120:123], 0
    s_waitcnt lgkmcnt(0)
    v_rsq_f32 v171, v171
    v_mfma_f32_16x16x32_bf16 v[112:115], a[76:79], v[140:143], v[112:115]
    v_mul_f32 v172, 0x3baaaaab, v173
    v_cvt_pk_bf16_f32 v164, v220, v221
    v_mfma_f32_16x16x32_bf16 v[112:115], a[80:83], v[232:235], v[112:115]
    v_cvt_pk_bf16_f32 v165, v222, v223
    v_mul_f32 v170, 0x3baaaaab, v174
    v_mfma_f32_16x16x32_bf16 v[112:115], a[84:87], v[224:227], v[112:115]
    v_rsq_f32 v172, v172
    v_mfma_f32_16x16x32_bf16 v[112:115], a[88:91], v[212:215], v[112:115]
    v_rsq_f32 v170, v170
    v_mfma_f32_16x16x32_bf16 v[112:115], a[92:95], v[144:147], v[112:115]
    v_mul_f32 v180, v171, v180
    v_mul_f32 v181, v171, v181
    v_mfma_f32_16x16x32_bf16 v[148:151], a[96:99], v[120:123], 0
    v_cvt_pk_bf16_f32 v180, v180, v181
    v_mul_f32 v182, v171, v182
    v_mfma_f32_16x16x32_bf16 v[148:151], a[100:103], v[140:143], v[148:151]
    v_mul_f32 v183, v171, v183
    v_cvt_pk_bf16_f32 v181, v182, v183
    v_mfma_f32_16x16x32_bf16 v[148:151], a[104:107], v[232:235], v[148:151]
    v_mul_f32 v108, v171, v108
    v_mul_f32 v109, v171, v109
    v_mfma_f32_16x16x32_bf16 v[148:151], a[108:111], v[224:227], v[148:151]
    v_cvt_pk_bf16_f32 v182, v108, v109
    v_mul_f32 v110, v171, v110
    v_mfma_f32_16x16x32_bf16 v[148:151], a[112:115], v[212:215], v[148:151]
    v_mul_f32 v111, v171, v111
    v_cvt_pk_bf16_f32 v183, v110, v111
    v_mfma_f32_16x16x32_bf16 v[148:151], a[116:119], v[144:147], v[148:151]
    buffer_store_dwordx4 v[180:183], v15, s[12:15], 0 offen
    v_mul_f32 v152, v171, v152
    v_mul_f32 v153, v171, v153
    v_cvt_pk_bf16_f32 v130, v152, v153
    v_mul_f32 v154, v171, v154
    v_mfma_f32_16x16x32_bf16 v[180:183], a[120:123], v[120:123], 0
    v_mul_f32 v155, v171, v155
    v_cvt_pk_bf16_f32 v131, v154, v155
    v_mfma_f32_16x16x32_bf16 v[180:183], a[124:127], v[140:143], v[180:183]
    v_mul_f32 v204, v169, v204
    v_mul_f32 v205, v169, v205
    v_mfma_f32_16x16x32_bf16 v[180:183], a[128:131], v[232:235], v[180:183]
    v_cvt_pk_bf16_f32 v184, v204, v205
    v_mul_f32 v206, v169, v206
    v_mfma_f32_16x16x32_bf16 v[180:183], a[132:135], v[224:227], v[180:183]
    v_mul_f32 v207, v169, v207
    v_cvt_pk_bf16_f32 v185, v206, v207
    v_mfma_f32_16x16x32_bf16 v[180:183], a[136:139], v[212:215], v[180:183]
    v_mul_f32 v176, v169, v176
    v_mul_f32 v177, v169, v177
    v_mfma_f32_16x16x32_bf16 v[180:183], a[140:143], v[144:147], v[180:183]
    v_cvt_pk_bf16_f32 v186, v176, v177
    v_mul_f32 v178, v169, v178
    v_mfma_f32_16x16x32_bf16 v[108:111], a[0:3], v[120:123], 0
    v_mul_f32 v179, v169, v179
    v_cvt_pk_bf16_f32 v187, v178, v179
    v_mfma_f32_16x16x32_bf16 v[108:111], a[4:7], v[140:143], v[108:111]
    v_mul_f32 v124, v169, v124
    v_mul_f32 v125, v169, v125
    v_mfma_f32_16x16x32_bf16 v[108:111], a[8:11], v[232:235], v[108:111]
    v_cvt_pk_bf16_f32 v178, v124, v125
    v_mul_f32 v126, v169, v126
    v_mfma_f32_16x16x32_bf16 v[108:111], a[12:15], v[224:227], v[108:111]
    v_mul_f32 v127, v169, v127
    v_cvt_pk_bf16_f32 v179, v126, v127
    v_mfma_f32_16x16x32_bf16 v[108:111], a[16:19], v[212:215], v[108:111]
    v_mul_f32 v216, v168, v216
    v_mul_f32 v217, v168, v217
    v_mfma_f32_16x16x32_bf16 v[108:111], a[20:23], v[144:147], v[108:111]
    v_cvt_pk_bf16_f32 v124, v216, v217
    v_mul_f32 v218, v168, v218
    v_mfma_f32_16x16x32_bf16 v[152:155], a[24:27], v[120:123], 0
    v_mul_f32 v219, v168, v219
    v_cvt_pk_bf16_f32 v125, v218, v219
    v_mfma_f32_16x16x32_bf16 v[152:155], a[28:31], v[140:143], v[152:155]
    v_mul_f32 v160, v168, v160
    v_mul_f32 v161, v168, v161
    v_mfma_f32_16x16x32_bf16 v[152:155], a[32:35], v[232:235], v[152:155]
    v_cvt_pk_bf16_f32 v126, v160, v161
    v_mul_f32 v162, v168, v162
    v_mfma_f32_16x16x32_bf16 v[152:155], a[36:39], v[224:227], v[152:155]
    v_mul_f32 v163, v168, v163
    v_cvt_pk_bf16_f32 v127, v162, v163
    v_mfma_f32_16x16x32_bf16 v[152:155], a[40:43], v[212:215], v[152:155]
    buffer_store_dwordx2 v[130:131], v18, s[12:15], 0 offen
    v_mul_f32 v116, v168, v116
    v_mul_f32 v117, v168, v117
    v_mfma_f32_16x16x32_bf16 v[152:155], a[44:47], v[144:147], v[152:155]
    v_cvt_pk_bf16_f32 v176, v116, v117
    v_mul_f32 v118, v168, v118
    v_mfma_f32_16x16x32_bf16 v[160:163], a[48:51], v[120:123], 0
    v_mul_f32 v119, v168, v119
    v_cvt_pk_bf16_f32 v177, v118, v119
    v_mfma_f32_16x16x32_bf16 v[160:163], a[52:55], v[140:143], v[160:163]
    v_fma_f32 v130, v108, v108, s32
    v_fmac_f32 v130, v109, v109
    v_mfma_f32_16x16x32_bf16 v[160:163], a[56:59], v[232:235], v[160:163]
    v_fmac_f32 v130, v110, v110
    v_fmac_f32 v130, v111, v111
    v_mfma_f32_16x16x32_bf16 v[160:163], a[60:63], v[224:227], v[160:163]
    v_fmac_f32 v130, v152, v152
    v_fmac_f32 v130, v153, v153
    v_mfma_f32_16x16x32_bf16 v[160:163], a[64:67], v[212:215], v[160:163]
    v_fmac_f32 v130, v154, v154
    v_fmac_f32 v130, v155, v155
    v_mfma_f32_16x16x32_bf16 v[160:163], a[68:71], v[144:147], v[160:163]
    v_fma_f32 v131, v112, v112, s32
    v_fmac_f32 v131, v113, v113
    v_mfma_f32_16x16x32_bf16 v[188:191], v[120:123], a[144:147], 0
    v_fmac_f32 v131, v114, v114
    v_fmac_f32 v131, v115, v115
    v_mfma_f32_16x16x32_bf16 v[188:191], v[140:143], a[148:151], v[188:191]
    v_fmac_f32 v131, v148, v148
    v_fmac_f32 v131, v149, v149
    v_mfma_f32_16x16x32_bf16 v[188:191], v[232:235], a[152:155], v[188:191]
    v_fmac_f32 v130, v160, v160
    v_fmac_f32 v130, v161, v161
    v_mfma_f32_16x16x32_bf16 v[188:191], v[224:227], a[156:159], v[188:191]
    v_fmac_f32 v130, v162, v162
    v_fmac_f32 v130, v163, v163
    v_mfma_f32_16x16x32_bf16 v[188:191], v[212:215], a[160:163], v[188:191]
    v_fmac_f32 v131, v150, v150
    v_fmac_f32 v131, v151, v151
    v_mfma_f32_16x16x32_bf16 v[188:191], v[144:147], a[164:167], v[188:191]
    v_fmac_f32 v131, v180, v180
    v_fmac_f32 v131, v181, v181
    v_mfma_f32_16x16x32_bf16 v[196:199], v[120:123], a[168:171], 0
    ds_read_b128 v[116:119], v0 offset:32768
    v_fmac_f32 v131, v182, v182
    v_mfma_f32_16x16x32_bf16 v[196:199], v[140:143], a[172:175], v[196:199]
    ds_read_b128 v[204:207], v1 offset:32768
    v_fmac_f32 v131, v183, v183
    v_mfma_f32_16x16x32_bf16 v[196:199], v[232:235], a[176:179], v[196:199]
    ds_read_b128 v[192:195], v0 offset:32896
    v_cvt_pk_bf16_f32 v238, v188, v189
    v_mfma_f32_16x16x32_bf16 v[196:199], v[224:227], a[180:183], v[196:199]
    ds_read_b128 v[220:223], v1 offset:32896
    v_cvt_pk_bf16_f32 v239, v190, v191
    v_mfma_f32_16x16x32_bf16 v[196:199], v[212:215], a[184:187], v[196:199]
    ds_read_b128 v[188:191], v0 offset:33024
    v_cvt_pk_bf16_f32 v36, v130, v131
    v_mfma_f32_16x16x32_bf16 v[196:199], v[144:147], a[188:191], v[196:199]
    ds_read_b128 v[240:243], v1 offset:33024
    v_mul_f32 v200, v170, v200
    v_mfma_f32_16x16x32_bf16 v[216:219], v[32:35], v[36:39], 0
    v_mul_f32 v201, v170, v201
    v_cvt_pk_bf16_f32 v200, v200, v201
    v_mfma_f32_16x16x32_bf16 v[228:231], v[120:123], a[192:195], 0
    v_mul_f32 v202, v170, v202
    v_mul_f32 v203, v170, v203
    v_mfma_f32_16x16x32_bf16 v[228:231], v[140:143], a[196:199], v[228:231]
    s_waitcnt lgkmcnt(5)
    v_cvt_pk_bf16_f32 v130, v196, v197
    v_cvt_pk_bf16_f32 v131, v198, v199
    v_mfma_f32_16x16x32_bf16 v[228:231], v[232:235], a[200:203], v[228:231]
    s_waitcnt lgkmcnt(4)
    v_rsq_f32 v217, v217
    v_mfma_f32_16x16x32_bf16 v[228:231], v[224:227], a[204:207], v[228:231]
    s_waitcnt lgkmcnt(3)
    v_rsq_f32 v216, v216
    v_mfma_f32_16x16x32_bf16 v[228:231], v[212:215], a[208:211], v[228:231]
    s_waitcnt lgkmcnt(2)
    v_mul_f32 v216, s31, v216
    v_mul_f32 v112, v217, v112
    v_mfma_f32_16x16x32_bf16 v[228:231], v[144:147], a[212:215], v[228:231]
    s_waitcnt lgkmcnt(1)
    v_mul_f32 v113, v217, v113
    v_cvt_pk_bf16_f32 v112, v112, v113
    v_mfma_f32_16x16x32_bf16 v[120:123], a[72:75], v[116:119], 0
    s_waitcnt lgkmcnt(0)
    v_mul_f32 v114, v217, v114
    v_mul_f32 v115, v217, v115
    v_mfma_f32_16x16x32_bf16 v[120:123], a[76:79], v[204:207], v[120:123]
    v_cvt_pk_bf16_f32 v166, v228, v229
    v_cvt_pk_bf16_f32 v167, v230, v231
    v_mfma_f32_16x16x32_bf16 v[120:123], a[80:83], v[192:195], v[120:123]
    v_cvt_pk_bf16_f32 v113, v114, v115
    v_mul_f32 v148, v217, v148
    v_mfma_f32_16x16x32_bf16 v[120:123], a[84:87], v[220:223], v[120:123]
    v_mul_f32 v149, v217, v149
    v_cvt_pk_bf16_f32 v114, v148, v149
    v_mfma_f32_16x16x32_bf16 v[120:123], a[88:91], v[188:191], v[120:123]
    v_mul_f32 v150, v217, v150
    v_mul_f32 v151, v217, v151
    v_mfma_f32_16x16x32_bf16 v[120:123], a[92:95], v[240:243], v[120:123]
    v_cvt_pk_bf16_f32 v115, v150, v151
    v_mul_f32 v180, v217, v180
    v_mfma_f32_16x16x32_bf16 v[140:143], a[96:99], v[116:119], 0
    v_mul_f32 v181, v217, v181
    v_cvt_pk_bf16_f32 v146, v180, v181
    v_mfma_f32_16x16x32_bf16 v[140:143], a[100:103], v[204:207], v[140:143]
    v_mul_f32 v182, v217, v182
    v_mul_f32 v183, v217, v183
    v_mfma_f32_16x16x32_bf16 v[140:143], a[104:107], v[192:195], v[140:143]
    v_cvt_pk_bf16_f32 v147, v182, v183
    v_mul_f32 v108, v216, v108
    v_mfma_f32_16x16x32_bf16 v[140:143], a[108:111], v[220:223], v[140:143]
    v_mul_f32 v109, v216, v109
    v_cvt_pk_bf16_f32 v148, v108, v109
    v_mfma_f32_16x16x32_bf16 v[140:143], a[112:115], v[188:191], v[140:143]
    v_mul_f32 v110, v216, v110
    v_mul_f32 v111, v216, v111
    v_mfma_f32_16x16x32_bf16 v[140:143], a[116:119], v[240:243], v[140:143]
    v_cvt_pk_bf16_f32 v149, v110, v111
    v_mul_f32 v152, v216, v152
    v_mfma_f32_16x16x32_bf16 v[108:111], a[120:123], v[116:119], 0
    v_mul_f32 v153, v216, v153
    v_cvt_pk_bf16_f32 v150, v152, v153
    v_mfma_f32_16x16x32_bf16 v[108:111], a[124:127], v[204:207], v[108:111]
    v_mul_f32 v154, v216, v154
    v_mul_f32 v155, v216, v155
    v_mfma_f32_16x16x32_bf16 v[108:111], a[128:131], v[192:195], v[108:111]
    v_cvt_pk_bf16_f32 v151, v154, v155
    v_mul_f32 v160, v216, v160
    v_mfma_f32_16x16x32_bf16 v[108:111], a[132:135], v[220:223], v[108:111]
    v_mul_f32 v161, v216, v161
    v_cvt_pk_bf16_f32 v144, v160, v161
    v_mfma_f32_16x16x32_bf16 v[108:111], a[136:139], v[188:191], v[108:111]
    v_mul_f32 v162, v216, v162
    v_mul_f32 v163, v216, v163
    v_mfma_f32_16x16x32_bf16 v[108:111], a[140:143], v[240:243], v[108:111]
    s_waitcnt vmcnt(2)
    v_cvt_pk_bf16_f32 v145, v162, v163
    v_fma_f32 v168, v120, v120, s32
    v_mfma_f32_16x16x32_bf16 v[152:155], a[0:3], v[116:119], 0
    s_nop 0
    v_fmac_f32 v168, v121, v121
    v_fmac_f32 v168, v122, v122
    v_mfma_f32_16x16x32_bf16 v[152:155], a[4:7], v[204:207], v[152:155]
    s_nop 0
    v_fmac_f32 v168, v123, v123
    v_fmac_f32 v168, v140, v140
    v_mfma_f32_16x16x32_bf16 v[152:155], a[8:11], v[192:195], v[152:155]
    s_barrier
    v_fmac_f32 v168, v141, v141
    v_fmac_f32 v168, v142, v142
    v_mfma_f32_16x16x32_bf16 v[152:155], a[12:15], v[220:223], v[152:155]
    s_nop 0
    buffer_load_dwordx4 v10, s[8:11], 0 offen nt lds
    v_fmac_f32 v168, v143, v143
    v_mfma_f32_16x16x32_bf16 v[152:155], a[16:19], v[188:191], v[152:155]
    s_add_u32 m0, s28, 4096
    v_fmac_f32 v168, v108, v108
    v_fmac_f32 v168, v109, v109
    v_mfma_f32_16x16x32_bf16 v[152:155], a[20:23], v[240:243], v[152:155]
    v_fmac_f32 v168, v110, v110
    v_fmac_f32 v168, v111, v111
    v_mfma_f32_16x16x32_bf16 v[160:163], a[24:27], v[116:119], 0
    v_cvt_pk_bf16_f32 v201, v202, v203
    v_mul_f32 v244, v170, v244
    v_mfma_f32_16x16x32_bf16 v[160:163], a[28:31], v[204:207], v[160:163]
    v_mul_f32 v245, v170, v245
    v_cvt_pk_bf16_f32 v202, v244, v245
    v_mfma_f32_16x16x32_bf16 v[160:163], a[32:35], v[192:195], v[160:163]
    buffer_load_dwordx4 v11, s[8:11], 0 offen nt lds
    v_fma_f32 v169, v152, v152, s32
    v_mfma_f32_16x16x32_bf16 v[160:163], a[36:39], v[220:223], v[160:163]
    s_add_u32 m0, s28, 8192
    v_fmac_f32 v169, v153, v153
    v_fmac_f32 v169, v154, v154
    v_mfma_f32_16x16x32_bf16 v[160:163], a[40:43], v[188:191], v[160:163]
    v_fmac_f32 v169, v155, v155
    v_mul_f32 v246, v170, v246
    v_mfma_f32_16x16x32_bf16 v[160:163], a[44:47], v[240:243], v[160:163]
    v_mul_f32 v247, v170, v247
    v_cvt_pk_bf16_f32 v203, v246, v247
    v_mfma_f32_16x16x32_bf16 v[196:199], a[48:51], v[116:119], 0
    v_mul_f32 v132, v170, v132
    v_mul_f32 v133, v170, v133
    v_mfma_f32_16x16x32_bf16 v[196:199], a[52:55], v[204:207], v[196:199]
    buffer_load_dwordx4 v12, s[8:11], 0 offen nt lds
    v_cvt_pk_bf16_f32 v216, v132, v133
    v_mfma_f32_16x16x32_bf16 v[196:199], a[56:59], v[192:195], v[196:199]
    s_add_u32 m0, s28, 12288
    ds_read2_b32 v[250:251], v6 offset0:0 offset1:0
    ds_read2_b32 v[234:235], v6 offset0:16 offset1:16
    v_mfma_f32_16x16x32_bf16 v[196:199], a[60:63], v[220:223], v[196:199]
    s_xor_b32 s28, s28, 65536
    ds_read_b128 v[224:227], v5 offset:0
    ds_read_b128 v[180:183], v5 offset:16
    v_mfma_f32_16x16x32_bf16 v[196:199], a[64:67], v[188:191], v[196:199]
    v_fmac_f32 v169, v160, v160
    v_fmac_f32 v169, v161, v161
    v_mfma_f32_16x16x32_bf16 v[196:199], a[68:71], v[240:243], v[196:199]
    ds_read_b128 v[212:215], v5 offset:48
    ds_read_b32 v173, v6 offset:192
    v_mfma_f32_16x16x32_bf16 v[228:231], v[116:119], a[144:147], 0
    buffer_load_dwordx4 v13, s[8:11], 0 offen nt lds
    ds_read2_b32 v[218:219], v6 offset0:32 offset1:32
    v_mfma_f32_16x16x32_bf16 v[228:231], v[204:207], a[148:151], v[228:231]
    s_mov_b32 m0, s29
    v_fmac_f32 v169, v162, v162
    v_fmac_f32 v169, v163, v163
    v_mfma_f32_16x16x32_bf16 v[228:231], v[192:195], a[152:155], v[228:231]
    s_xor_b32 s29, s29, s30
    v_fmac_f32 v169, v196, v196
    v_fmac_f32 v169, v197, v197
    v_mfma_f32_16x16x32_bf16 v[228:231], v[220:223], a[156:159], v[228:231]
    s_add_u32 s19, s19, s20
    v_fmac_f32 v169, v198, v198
    v_fmac_f32 v169, v199, v199
    v_mfma_f32_16x16x32_bf16 v[228:231], v[188:191], a[160:163], v[228:231]
    s_add_u32 s23, s23, s21
    v_cvt_pk_bf16_f32 v36, v169, v168
    v_mul_f32 v134, v170, v134
    v_mfma_f32_16x16x32_bf16 v[228:231], v[240:243], a[164:167], v[228:231]
    s_waitcnt lgkmcnt(3)
    buffer_store_dwordx4 v[200:203], v17, s[12:15], 0 offen
    v_mul_f32 v135, v170, v135
    v_cvt_pk_bf16_f32 v217, v134, v135
    v_mul_f32 v136, v172, v136
    v_mul_f32 v137, v172, v137
    v_mfma_f32_16x16x32_bf16 v[168:171], v[32:35], v[36:39], 0
    s_cmp_ge_u32 s19, 72
    v_cvt_pk_bf16_f32 v248, v228, v229
    v_cvt_pk_bf16_f32 v249, v230, v231
    v_mfma_f32_16x16x32_bf16 v[132:135], v[224:227], v[124:127], v[22:25]
    s_cselect_b32 s34, 72, 0
    v_cvt_pk_bf16_f32 v200, v136, v137
    v_mul_f32 v138, v172, v138
    v_mfma_f32_16x16x32_bf16 v[132:135], v[180:183], v[184:187], v[132:135]
    s_waitcnt lgkmcnt(0)
    v_rsq_f32 v169, v169
    v_mfma_f32_16x16x32_bf16 v[132:135], v[212:215], v[176:179], v[132:135]
    s_cselect_b32 s35, s22, 0
    v_rsq_f32 v168, v168
    v_mfma_f32_16x16x32_bf16 v[228:231], v[116:119], a[168:171], 0
    s_sub_u32 s19, s19, s34
    v_mul_f32 v168, s31, v168
    v_mul_f32 v120, v169, v120
    v_mfma_f32_16x16x32_bf16 v[228:231], v[204:207], a[172:175], v[228:231]
    s_add_u32 s23, s23, s35
    v_mov_b32_dpp v173, v133 quad_perm:[0,1,2,3] row_mask:0x1 bank_mask:0xf
    v_mul_f32 v121, v169, v121
    v_mfma_f32_16x16x32_bf16 v[228:231], v[192:195], a[176:179], v[228:231]
    s_add_u32 s18, s18, 1
    v_cvt_pk_bf16_f32 v120, v120, v121
    v_mul_f32 v122, v169, v122
    v_mfma_f32_16x16x32_bf16 v[228:231], v[220:223], a[180:183], v[228:231]
    s_cmp_lt_u32 s18, s17
    v_mul_f32 v123, v169, v123
    v_cvt_pk_bf16_f32 v121, v122, v123
    v_mfma_f32_16x16x32_bf16 v[228:231], v[188:191], a[184:187], v[228:231]
    v_mul_f32 v140, v169, v140
    v_mul_f32 v141, v169, v141
    v_mfma_f32_16x16x32_bf16 v[228:231], v[240:243], a[188:191], v[228:231]
    v_cvt_pk_bf16_f32 v122, v140, v141
    v_mul_f32 v142, v169, v142
    v_mfma_f32_16x16x32_bf16 v[244:247], v[116:119], a[192:195], 0
    v_mul_f32 v143, v169, v143
    v_cvt_pk_bf16_f32 v123, v142, v143
    v_mfma_f32_16x16x32_bf16 v[244:247], v[204:207], a[196:199], v[244:247]
    v_mul_f32 v108, v169, v108
    v_mul_f32 v109, v169, v109
    v_mfma_f32_16x16x32_bf16 v[244:247], v[192:195], a[200:203], v[244:247]
    ds_read_b128 v[116:119], v2 offset:0
    v_cvt_pk_bf16_f32 v232, v228, v229
    v_mfma_f32_16x16x32_bf16 v[244:247], v[220:223], a[204:207], v[244:247]
    ds_read_b128 v[204:207], v2 offset:1024
    v_cvt_pk_bf16_f32 v233, v230, v231
    v_mfma_f32_16x16x32_bf16 v[244:247], v[188:191], a[208:211], v[244:247]
    ds_read_b128 v[140:143], v2 offset:2048
    v_cvt_pk_bf16_f32 v190, v108, v109
    v_mfma_f32_16x16x32_bf16 v[244:247], v[240:243], a[212:215], v[244:247]
    ds_read_b128 v[252:255], v2 offset:3072
    ds_read_b128 v[192:195], v2 offset:4096
    v_mfma_f32_16x16x32_bf16 v[220:223], v[184:187], v[124:127], v[40:43]
    ds_read_b128 v[134:137], v2 offset:5120
    buffer_store_dwordx2 v[216:217], v20, s[12:15], 0 offen
    v_mul_f32 v110, v169, v110
    v_mul_f32 v111, v169, v111
    v_mfma_f32_16x16x32_bf16 v[240:243], v[112:115], v[124:127], v[44:47]
    v_cvt_pk_bf16_f32 v216, v244, v245
    v_cvt_pk_bf16_f32 v217, v246, v247
    v_mfma_f32_16x16x32_bf16 v[228:231], v[120:123], v[124:127], v[48:51]
    v_cvt_pk_bf16_f32 v191, v110, v111
    v_mul_f32 v152, v168, v152
    v_mul_f32 v153, v168, v153
    v_mfma_f32_16x16x16_bf16 v[220:223], v[178:179], v[176:177], v[220:223]
    v_cvt_pk_bf16_f32 v244, v152, v153
    v_mul_f32 v154, v168, v154
    v_mul_f32 v155, v168, v155
    v_mfma_f32_16x16x16_bf16 v[240:243], v[146:147], v[176:177], v[240:243]
    v_cvt_pk_bf16_f32 v245, v154, v155
    v_mul_f32 v160, v168, v160
    v_mul_f32 v161, v168, v161
    v_mfma_f32_16x16x16_bf16 v[228:231], v[190:191], v[176:177], v[228:231]
    v_cvt_pk_bf16_f32 v246, v160, v161
    v_mul_f32 v162, v168, v162
    v_mul_f32 v163, v168, v163
    v_cvt_pk_bf16_f32 v247, v162, v163
    v_mfma_f32_16x16x32_bf16 v[124:127], v[224:227], v[148:151], v[24:27]
    s_waitcnt lgkmcnt(1)
    v_mul_f32 v196, v168, v196
    v_mul_f32 v197, v168, v197
    v_mfma_f32_16x16x32_bf16 v[124:127], v[180:183], v[112:115], v[124:127]
    s_waitcnt lgkmcnt(0)
    v_cvt_pk_bf16_f32 v188, v196, v197
    v_mul_f32 v198, v168, v198
    v_mfma_f32_16x16x32_bf16 v[124:127], v[212:215], v[144:147], v[124:127]
    v_mul_f32 v199, v168, v199
    v_cvt_pk_bf16_f32 v189, v198, v199
    v_mfma_f32_16x16x32_bf16 v[160:163], v[224:227], v[244:247], v[26:29]
    v_max3_f32 v133, v132, v220, v221
    v_max3_f32 v133, v133, v222, v223
    v_mfma_f32_16x16x32_bf16 v[160:163], v[180:183], v[120:123], v[160:163]
    v_max3_f32 v133, v133, v240, v241
    v_max3_f32 v133, v133, v242, v243
    v_mfma_f32_16x16x32_bf16 v[160:163], v[212:215], v[188:191], v[160:163]
    v_max3_f32 v133, v133, v228, v229
    v_max3_f32 v133, v133, v230, v231
    v_mfma_f32_16x16x32_bf16 v[180:183], a[216:219], v[116:119], 0
    v_mov_b32 v174, v133
    v_mov_b32_dpp v173, v125 quad_perm:[0,1,2,3] row_mask:0x2 bank_mask:0xf
    v_mfma_f32_16x16x32_bf16 v[180:183], a[220:223], v[204:207], v[180:183]
    v_permlane32_swap_b32 v133, v174
    v_mfma_f32_16x16x32_bf16 v[180:183], a[224:227], v[140:143], v[180:183]
    v_max_f32 v133, v133, v174
    v_mov_b32 v174, v133
    v_mfma_f32_16x16x32_bf16 v[180:183], a[228:231], v[252:255], v[180:183]
    v_mov_b32_dpp v173, v161 quad_perm:[0,1,2,3] row_mask:0x4 bank_mask:0xf
    v_mul_f32 v139, v172, v139
    v_mfma_f32_16x16x32_bf16 v[180:183], a[232:235], v[192:195], v[180:183]
    v_permlane16_swap_b32 v133, v174
    v_mfma_f32_16x16x32_bf16 v[180:183], a[236:239], v[134:137], v[180:183]
    v_max_f32 v133, v133, v174
    v_sub_f32 v220, v220, v133
    v_mfma_f32_16x16x32_bf16 v[108:111], a[240:243], v[116:119], 0
    v_exp_f32 v220, v220
    v_mfma_f32_16x16x32_bf16 v[108:111], a[244:247], v[204:207], v[108:111]
    v_sub_f32 v221, v221, v133
    v_sub_f32 v222, v222, v133
    v_mfma_f32_16x16x32_bf16 v[108:111], a[248:251], v[140:143], v[108:111]
    v_exp_f32 v221, v221
    v_mfma_f32_16x16x32_bf16 v[108:111], a[252:255], v[252:255], v[108:111]
    ds_read_b128 v[168:171], v2 offset:6144
    v_cvt_pk_bf16_f32 v212, v220, v221
    v_mfma_f32_16x16x32_bf16 v[108:111], v[76:79], v[192:195], v[108:111]
    ds_read_b128 v[196:199], v2 offset:7168
    v_sub_f32 v223, v223, v133
    v_mfma_f32_16x16x32_bf16 v[108:111], v[80:83], v[134:137], v[108:111]
    ds_read_b128 v[224:227], v2 offset:8192
    v_sub_f32 v240, v240, v133
    v_mfma_f32_16x16x32_bf16 v[152:155], v[84:87], v[116:119], 0
    ds_read_b128 v[174:177], v2 offset:9216
    v_sub_f32 v241, v241, v133
    v_mfma_f32_16x16x32_bf16 v[152:155], v[88:91], v[204:207], v[152:155]
    ds_read_b128 v[116:119], v2 offset:10240
    v_sub_f32 v242, v242, v133
    v_mfma_f32_16x16x32_bf16 v[152:155], v[92:95], v[140:143], v[152:155]
    ds_read_b128 v[204:207], v2 offset:11264
    v_sub_f32 v243, v243, v133
    v_mfma_f32_16x16x32_bf16 v[152:155], v[96:99], v[252:255], v[152:155]
    v_exp_f32 v222, v222
    v_mfma_f32_16x16x32_bf16 v[152:155], v[100:103], v[192:195], v[152:155]
    v_exp_f32 v223, v223
    v_mfma_f32_16x16x32_bf16 v[152:155], v[104:107], v[134:137], v[152:155]
    s_waitcnt lgkmcnt(5)
    v_cvt_pk_bf16_f32 v213, v222, v223
    v_exp_f32 v240, v240
    v_exp_f32 v241, v241
    v_mfma_f32_16x16x32_bf16 v[140:143], v[184:187], v[148:151], v[52:55]
    s_waitcnt lgkmcnt(3)
    v_cvt_pk_bf16_f32 v214, v240, v241
    v_exp_f32 v242, v242
    v_exp_f32 v243, v243
    v_sub_f32 v228, v228, v133
    v_cvt_pk_bf16_f32 v215, v242, v243
    v_mfma_f32_16x16x16_bf16 v[140:143], v[178:179], v[144:145], v[140:143]
    v_exp_f32 v228, v228
    v_sub_f32 v229, v229, v133
    v_exp_f32 v229, v229
    v_mfma_f32_16x16x32_bf16 v[192:195], v[112:115], v[148:151], v[56:59]
    s_waitcnt lgkmcnt(0)
    v_cvt_pk_bf16_f32 v36, v228, v229
    v_sub_f32 v230, v230, v133
    v_exp_f32 v230, v230
    v_sub_f32 v231, v231, v133
    v_exp_f32 v231, v231
    v_mfma_f32_16x16x32_bf16 v[220:223], v[120:123], v[148:151], v[60:63]
    v_cvt_pk_bf16_f32 v37, v230, v231
    v_sub_f32 v132, v132, v133
    v_max3_f32 v203, v124, v140, v141
    v_mfma_f32_16x16x16_bf16 v[192:195], v[146:147], v[144:145], v[192:195]
    v_exp_f32 v132, v132
    v_max3_f32 v203, v203, v142, v143
    v_mfma_f32_16x16x16_bf16 v[220:223], v[190:191], v[144:145], v[220:223]
    v_cvt_pk_bf16_f32 v39, v132, 0
    v_cvt_pk_bf16_f32 v201, v138, v139
    v_mul_f32 v208, v172, v208
    v_mul_f32 v209, v172, v209
    v_mfma_f32_16x16x32_bf16 v[132:135], v[28:31], v[36:39], 0
    v_max3_f32 v203, v203, v192, v193
    v_max3_f32 v203, v203, v194, v195
    v_mfma_f32_16x16x32_bf16 v[132:135], v[28:31], v[212:215], v[132:135]
    v_max3_f32 v203, v203, v220, v221
    v_max3_f32 v203, v203, v222, v223
    v_mfma_f32_16x16x32_bf16 v[148:151], v[248:251], v[36:39], 0
    v_mov_b32 v144, v203
    v_cvt_pk_bf16_f32 v202, v208, v209
    v_mfma_f32_16x16x32_bf16 v[148:151], v[236:239], v[212:215], v[148:151]
    v_permlane32_swap_b32 v203, v144
    v_mfma_f32_16x16x32_bf16 v[228:231], v[232:235], v[36:39], 0
    v_max_f32 v203, v203, v144
    v_mov_b32 v144, v203
    v_mfma_f32_16x16x32_bf16 v[228:231], v[128:131], v[212:215], v[228:231]
    v_rcp_f32 v132, v132
    v_mfma_f32_16x16x32_bf16 v[240:243], v[216:219], v[36:39], 0
    v_permlane16_swap_b32 v203, v144
    v_mfma_f32_16x16x32_bf16 v[240:243], v[164:167], v[212:215], v[240:243]
    v_max_f32 v203, v203, v144
    v_sub_f32 v140, v140, v203
    v_mfma_f32_16x16x32_bf16 v[136:139], a[216:219], v[168:171], 0
    v_exp_f32 v140, v140
    v_mfma_f32_16x16x32_bf16 v[136:139], a[220:223], v[196:199], v[136:139]
    v_sub_f32 v141, v141, v203
    v_sub_f32 v142, v142, v203
    v_mfma_f32_16x16x32_bf16 v[136:139], a[224:227], v[224:227], v[136:139]
    v_exp_f32 v141, v141
    v_mfma_f32_16x16x32_bf16 v[136:139], a[228:231], v[174:177], v[136:139]
    v_cvt_pk_bf16_f32 v140, v140, v141
    v_sub_f32 v143, v143, v203
    v_mfma_f32_16x16x32_bf16 v[136:139], a[232:235], v[116:119], v[136:139]
    v_exp_f32 v142, v142
    v_mfma_f32_16x16x32_bf16 v[136:139], a[236:239], v[204:207], v[136:139]
    v_exp_f32 v143, v143
    v_sub_f32 v192, v192, v203
    v_cvt_pk_bf16_f32 v141, v142, v143
    v_exp_f32 v192, v192
    v_sub_f32 v193, v193, v203
    v_exp_f32 v193, v193
    v_sub_f32 v194, v194, v203
    v_cvt_pk_bf16_f32 v142, v192, v193
    v_exp_f32 v194, v194
    v_sub_f32 v195, v195, v203
    v_exp_f32 v195, v195
    v_sub_f32 v220, v220, v203
    v_cvt_pk_bf16_f32 v143, v194, v195
    v_exp_f32 v220, v220
    v_sub_f32 v221, v221, v203
    v_exp_f32 v221, v221
    v_sub_f32 v222, v222, v203
    v_cvt_pk_bf16_f32 v36, v220, v221
    v_exp_f32 v222, v222
    v_sub_f32 v223, v223, v203
    v_exp_f32 v223, v223
    v_mfma_f32_16x16x32_bf16 v[192:195], v[184:187], v[244:247], v[64:67]
    v_cvt_pk_bf16_f32 v37, v222, v223
    v_sub_f32 v124, v124, v203
    v_mfma_f32_16x16x32_bf16 v[184:187], v[112:115], v[244:247], v[68:71]
    v_exp_f32 v124, v124
    v_mfma_f32_16x16x32_bf16 v[212:215], v[120:123], v[244:247], v[72:75]
    v_cvt_pk_bf16_f32 v39, v124, 0
    v_mul_f32 v148, v132, v148
    v_mul_f32 v149, v132, v149
    v_mfma_f32_16x16x32_bf16 v[120:123], v[28:31], v[36:39], 0
    v_cvt_pk_bf16_f32 v112, v148, v149
    v_mul_f32 v150, v132, v150
    v_mfma_f32_16x16x32_bf16 v[120:123], v[28:31], v[140:143], v[120:123]
    v_mul_f32 v151, v132, v151
    v_cvt_pk_bf16_f32 v113, v150, v151
    v_mfma_f32_16x16x32_bf16 v[124:127], v[248:251], v[36:39], 0
    v_mul_f32 v228, v132, v228
    v_mul_f32 v229, v132, v229
    v_mfma_f32_16x16x32_bf16 v[124:127], v[236:239], v[140:143], v[124:127]
    v_cvt_pk_bf16_f32 v114, v228, v229
    v_mul_f32 v230, v132, v230
    v_mfma_f32_16x16x32_bf16 v[220:223], v[232:235], v[36:39], 0
    v_mul_f32 v231, v132, v231
    v_cvt_pk_bf16_f32 v115, v230, v231
    v_mfma_f32_16x16x32_bf16 v[220:223], v[128:131], v[140:143], v[220:223]
    ds_write_b128 v3, v[112:115] offset:0
    v_mfma_f32_16x16x32_bf16 v[252:255], v[216:219], v[36:39], 0
    v_mul_f32 v240, v132, v240
    v_mul_f32 v241, v132, v241
    v_mfma_f32_16x16x32_bf16 v[252:255], v[164:167], v[140:143], v[252:255]
    v_cvt_pk_bf16_f32 v122, v240, v241
    v_mul_f32 v242, v132, v242
    v_mul_f32 v243, v132, v243
    v_mfma_f32_16x16x16_bf16 v[192:195], v[178:179], v[188:189], v[192:195]
    v_cvt_pk_bf16_f32 v123, v242, v243
    v_mul_f32 v210, v172, v210
    v_mul_f32 v211, v172, v211
    v_mfma_f32_16x16x16_bf16 v[184:187], v[146:147], v[188:189], v[184:187]
    v_cvt_pk_bf16_f32 v203, v210, v211
    v_mul_f32 v156, v172, v156
    v_mul_f32 v157, v172, v157
    v_mfma_f32_16x16x16_bf16 v[212:215], v[190:191], v[188:189], v[212:215]
    v_cvt_pk_bf16_f32 v178, v156, v157
    v_mul_f32 v158, v172, v158
    v_mul_f32 v159, v172, v159
    v_cvt_pk_bf16_f32 v179, v158, v159
    v_mfma_f32_16x16x32_bf16 v[208:211], a[240:243], v[168:171], 0
    ds_write_b64 v4, v[122:123] offset:4096
    v_mfma_f32_16x16x32_bf16 v[208:211], a[244:247], v[196:199], v[208:211]
    buffer_store_dwordx4 v[200:203], v16, s[12:15], 0 offen
    v_mov_b32 v172, v173
    v_max3_f32 v121, v160, v192, v193
    v_max3_f32 v121, v121, v194, v195
    v_max_f32_dpp v172, v172, v172 quad_perm:[1,0,3,2] row_mask:0xf bank_mask:0xf
    v_mfma_f32_16x16x32_bf16 v[208:211], a[248:251], v[224:227], v[208:211]
    v_max3_f32 v121, v121, v184, v185
    v_max_f32_dpp v172, v172, v172 quad_perm:[2,3,0,1] row_mask:0xf bank_mask:0xf
    v_mfma_f32_16x16x32_bf16 v[208:211], a[252:255], v[174:177], v[208:211]
    ds_read_b128 v[112:115], v2 offset:12288
    v_max_f32_dpp v172, v172, v172 row_half_mirror row_mask:0xf bank_mask:0xf
    v_mfma_f32_16x16x32_bf16 v[208:211], v[76:79], v[116:119], v[208:211]
    ds_read_b128 v[188:191], v2 offset:13312
    v_max_f32_dpp v172, v172, v172 row_mirror row_mask:0xf bank_mask:0xf
    v_mfma_f32_16x16x32_bf16 v[208:211], v[80:83], v[204:207], v[208:211]
    ds_read_b128 v[144:147], v2 offset:14336
    v_mov_b32 v122, v172
    v_mfma_f32_16x16x32_bf16 v[156:159], v[84:87], v[168:171], 0
    ds_read_b128 v[140:143], v2 offset:15360
    v_max3_f32 v121, v121, v186, v187
    v_mfma_f32_16x16x32_bf16 v[156:159], v[88:91], v[196:199], v[156:159]
    ds_read_b128 v[168:171], v2 offset:16384
    v_max3_f32 v121, v121, v212, v213
    v_mfma_f32_16x16x32_bf16 v[156:159], v[92:95], v[224:227], v[156:159]
    ds_read_b128 v[148:151], v2 offset:17408
    v_max3_f32 v121, v121, v214, v215
    v_mfma_f32_16x16x32_bf16 v[156:159], v[96:99], v[174:177], v[156:159]
    v_permlane32_swap_b32 v172, v122
    v_mfma_f32_16x16x32_bf16 v[156:159], v[100:103], v[116:119], v[156:159]
    v_max_f32 v172, v172, v122
    v_mov_b32 v122, v172
    v_mfma_f32_16x16x32_bf16 v[156:159], v[104:107], v[204:207], v[156:159]
    s_waitcnt lgkmcnt(5)
    v_permlane16_swap_b32 v172, v122
    v_mfma_f32_16x16x32_bf16 v[200:203], a[216:219], v[112:115], 0
    s_waitcnt lgkmcnt(4)
    v_max_f32 v172, v172, v122
    v_sub_f32 v173, v173, v172
    v_mfma_f32_16x16x32_bf16 v[200:203], a[220:223], v[188:191], v[200:203]
    s_waitcnt lgkmcnt(3)
    v_exp_f32 v173, v173
    v_mfma_f32_16x16x32_bf16 v[200:203], a[224:227], v[144:147], v[200:203]
    s_waitcnt lgkmcnt(2)
    v_cvt_pk_bf16_f32 v173, v173, v173
    v_mov_b32 v122, v121
    v_mfma_f32_16x16x32_bf16 v[200:203], a[228:231], v[140:143], v[200:203]
    s_waitcnt lgkmcnt(1)
    ds_write_b16 v8, v173
    v_mfma_f32_16x16x32_bf16 v[200:203], a[232:235], v[168:171], v[200:203]
    s_waitcnt lgkmcnt(1)
    v_permlane32_swap_b32 v121, v122
    v_mfma_f32_16x16x32_bf16 v[200:203], a[236:239], v[148:151], v[200:203]
    v_max_f32 v121, v121, v122
    v_mov_b32 v122, v121
    v_mfma_f32_16x16x32_bf16 v[244:247], a[240:243], v[112:115], 0
    buffer_store_dwordx2 v[178:179], v19, s[12:15], 0 offen
    v_permlane16_swap_b32 v121, v122
    v_mfma_f32_16x16x32_bf16 v[244:247], a[244:247], v[188:191], v[244:247]
    v_max_f32 v121, v121, v122
    v_sub_f32 v192, v192, v121
    v_mfma_f32_16x16x32_bf16 v[244:247], a[248:251], v[144:147], v[244:247]
    v_fma_f32 v122, v200, v200, s33
    v_fmac_f32 v122, v201, v201
    v_mfma_f32_16x16x32_bf16 v[244:247], a[252:255], v[140:143], v[244:247]
    v_fmac_f32 v122, v202, v202
    v_fmac_f32 v122, v203, v203
    v_mfma_f32_16x16x32_bf16 v[244:247], v[76:79], v[168:171], v[244:247]
    v_exp_f32 v192, v192
    v_mfma_f32_16x16x32_bf16 v[244:247], v[80:83], v[148:151], v[244:247]
    v_sub_f32 v193, v193, v121
    v_sub_f32 v194, v194, v121
    v_mfma_f32_16x16x32_bf16 v[132:135], v[84:87], v[112:115], 0
    v_exp_f32 v193, v193
    v_mfma_f32_16x16x32_bf16 v[132:135], v[88:91], v[188:191], v[132:135]
    v_cvt_pk_bf16_f32 v116, v192, v193
    v_sub_f32 v195, v195, v121
    v_mfma_f32_16x16x32_bf16 v[132:135], v[92:95], v[144:147], v[132:135]
    v_fmac_f32 v122, v244, v244
    v_fmac_f32 v122, v245, v245
    v_mfma_f32_16x16x32_bf16 v[132:135], v[96:99], v[140:143], v[132:135]
    v_fmac_f32 v122, v246, v246
    v_fmac_f32 v122, v247, v247
    v_mfma_f32_16x16x32_bf16 v[132:135], v[100:103], v[168:171], v[132:135]
    v_exp_f32 v194, v194
    v_mfma_f32_16x16x32_bf16 v[132:135], v[104:107], v[148:151], v[132:135]
    v_exp_f32 v195, v195
    v_sub_f32 v184, v184, v121
    v_cvt_pk_bf16_f32 v117, v194, v195
    v_exp_f32 v184, v184
    v_sub_f32 v185, v185, v121
    v_exp_f32 v185, v185
    v_sub_f32 v186, v186, v121
    v_cvt_pk_bf16_f32 v118, v184, v185
    v_fmac_f32 v122, v132, v132
    v_fmac_f32 v122, v133, v133
    v_fmac_f32 v122, v134, v134
    v_fmac_f32 v122, v135, v135
    v_cvt_pk_bf16_f32 v123, v122, v122
    v_exp_f32 v186, v186
    v_sub_f32 v187, v187, v121
    v_exp_f32 v187, v187
    v_sub_f32 v212, v212, v121
    v_cvt_pk_bf16_f32 v119, v186, v187
    v_exp_f32 v212, v212
    v_sub_f32 v213, v213, v121
    v_exp_f32 v213, v213
    v_sub_f32 v214, v214, v121
    v_cvt_pk_bf16_f32 v36, v212, v213
    v_exp_f32 v214, v214
    v_sub_f32 v215, v215, v121
    v_exp_f32 v215, v215
    v_sub_f32 v160, v160, v121
    v_cvt_pk_bf16_f32 v37, v214, v215
    v_exp_f32 v160, v160
    v_xor_b32 v0, 65536, v0
    v_cvt_pk_bf16_f32 v39, v160, 0
    v_xor_b32 v1, 65536, v1
    v_fma_f32 v121, v136, v136, s33
    v_mfma_f32_16x16x32_bf16 v[140:143], v[28:31], v[36:39], 0
    ds_read_b128 v[196:199], v0 offset:20480
    ds_read_b128 v[184:187], v1 offset:20480
    v_mfma_f32_16x16x32_bf16 v[140:143], v[28:31], v[116:119], v[140:143]
    ds_read_b128 v[172:175], v0 offset:20608
    ds_read_b128 v[148:151], v1 offset:20608
    v_mfma_f32_16x16x32_bf16 v[144:147], v[248:251], v[36:39], 0
    buffer_load_dwordx4 v14, s[8:11], 0 offen nt lds
    ds_read_b128 v[112:115], v0 offset:20736
    v_mfma_f32_16x16x32_bf16 v[144:147], v[236:239], v[116:119], v[144:147]
    v_fmac_f32 v121, v137, v137
    v_fmac_f32 v121, v138, v138
    v_mfma_f32_16x16x32_bf16 v[168:171], v[232:235], v[36:39], 0
    ds_read_b128 v[228:231], v1 offset:20736
    ds_read_b128 v[176:179], v9
    v_mfma_f32_16x16x32_bf16 v[168:171], v[128:131], v[116:119], v[168:171]
    v_fmac_f32 v121, v139, v139
    v_fmac_f32 v121, v208, v208
    v_mfma_f32_16x16x32_bf16 v[188:191], v[216:219], v[36:39], 0
    ds_read_b128 v[160:163], v9 offset:64
    v_fmac_f32 v121, v209, v209
    v_mfma_f32_16x16x32_bf16 v[188:191], v[164:167], v[116:119], v[188:191]
    v_fmac_f32 v121, v210, v210
    v_fmac_f32 v121, v211, v211
    s_waitcnt lgkmcnt(6)
    v_mfma_f32_16x16x32_bf16 v[204:207], a[72:75], v[196:199], 0
    s_waitcnt lgkmcnt(5)
    v_fmac_f32 v121, v156, v156
    v_fmac_f32 v121, v157, v157
    v_mfma_f32_16x16x32_bf16 v[204:207], a[76:79], v[184:187], v[204:207]
    s_waitcnt lgkmcnt(4)
    v_fmac_f32 v121, v158, v158
    v_fmac_f32 v121, v159, v159
    v_mfma_f32_16x16x32_bf16 v[204:207], a[80:83], v[172:175], v[204:207]
    s_waitcnt lgkmcnt(3)
    v_rcp_f32 v120, v120
    v_mfma_f32_16x16x32_bf16 v[204:207], a[84:87], v[148:151], v[204:207]
    s_waitcnt lgkmcnt(2)
    v_mul_f32 v124, v120, v124
    v_mul_f32 v125, v120, v125
    v_mfma_f32_16x16x32_bf16 v[204:207], a[88:91], v[112:115], v[204:207]
    s_waitcnt lgkmcnt(1)
    v_cvt_pk_bf16_f32 v192, v124, v125
    v_mul_f32 v126, v120, v126
    v_mfma_f32_16x16x32_bf16 v[212:215], v[176:179], v[28:31], 0
    s_waitcnt lgkmcnt(0)
    v_mul_f32 v127, v120, v127
    v_cvt_pk_bf16_f32 v193, v126, v127
    v_mfma_f32_16x16x32_bf16 v[212:215], v[160:163], v[28:31], v[212:215]
    v_mul_f32 v220, v120, v220
    v_mul_f32 v221, v120, v221
    v_mfma_f32_16x16x32_bf16 v[116:119], v[176:179], v[236:239], 0
    v_cvt_pk_bf16_f32 v194, v220, v221
    v_mul_f32 v222, v120, v222
    v_mfma_f32_16x16x32_bf16 v[116:119], v[160:163], v[248:251], v[116:119]
    v_mul_f32 v223, v120, v223
    v_cvt_pk_bf16_f32 v195, v222, v223
    v_mfma_f32_16x16x32_bf16 v[124:127], v[176:179], v[128:131], 0
    ds_write_b128 v3, v[192:195] offset:6144
    v_mfma_f32_16x16x32_bf16 v[124:127], v[160:163], v[232:235], v[124:127]
    v_mul_f32 v252, v120, v252
    v_mul_f32 v253, v120, v253
    v_mfma_f32_16x16x32_bf16 v[128:131], v[176:179], v[164:167], 0
    v_cvt_pk_bf16_f32 v252, v252, v253
    v_mul_f32 v254, v120, v254
    v_mfma_f32_16x16x32_bf16 v[128:131], v[160:163], v[216:219], v[128:131]
    v_mul_f32 v255, v120, v255
    v_cvt_pk_bf16_f32 v253, v254, v255
    v_mfma_f32_16x16x32_bf16 v[204:207], a[92:95], v[228:231], v[204:207]
    ds_write_b64 v4, v[252:253] offset:10240
    v_mfma_f32_16x16x32_bf16 v[176:179], a[96:99], v[196:199], 0
    v_rcp_f32 v212, v212
    v_mfma_f32_16x16x32_bf16 v[176:179], a[100:103], v[184:187], v[176:179]
    v_mul_f32 v116, v116, v212
    v_mul_f32_dpp v116, v124, v212 quad_perm:[0,1,2,3] row_mask:0x2 bank_mask:0xf
    v_mfma_f32_16x16x32_bf16 v[176:179], a[104:107], v[172:175], v[176:179]
    v_mul_f32_dpp v116, v128, v212 quad_perm:[0,1,2,3] row_mask:0x4 bank_mask:0xf
    v_cvt_pk_bf16_f32 v116, v116, v116
    v_mfma_f32_16x16x32_bf16 v[176:179], a[108:111], v[148:151], v[176:179]
    ds_write_b16 v7, v116
    v_mfma_f32_16x16x32_bf16 v[176:179], a[112:115], v[112:115], v[176:179]
    v_rcp_f32 v140, v140
    v_mfma_f32_16x16x32_bf16 v[176:179], a[116:119], v[228:231], v[176:179]
    v_mul_f32 v144, v140, v144
    v_mul_f32 v145, v140, v145
    v_mfma_f32_16x16x32_bf16 v[124:127], a[120:123], v[196:199], 0
    v_cvt_pk_bf16_f32 v116, v144, v145
    v_mul_f32 v146, v140, v146
    v_mfma_f32_16x16x32_bf16 v[124:127], a[124:127], v[184:187], v[124:127]
    v_mul_f32 v147, v140, v147
    v_cvt_pk_bf16_f32 v117, v146, v147
    v_mfma_f32_16x16x32_bf16 v[124:127], a[128:131], v[172:175], v[124:127]
    v_mul_f32 v168, v140, v168
    v_mul_f32 v169, v140, v169
    v_mfma_f32_16x16x32_bf16 v[124:127], a[132:135], v[148:151], v[124:127]
    v_cvt_pk_bf16_f32 v118, v168, v169
    v_mul_f32 v170, v140, v170
    v_mfma_f32_16x16x32_bf16 v[124:127], a[136:139], v[112:115], v[124:127]
    v_mul_f32 v171, v140, v171
    v_cvt_pk_bf16_f32 v119, v170, v171
    v_mfma_f32_16x16x32_bf16 v[124:127], a[140:143], v[228:231], v[124:127]
    ds_write_b128 v3, v[116:119] offset:12288
    v_mfma_f32_16x16x32_bf16 v[216:219], a[0:3], v[196:199], 0
    v_mul_f32 v188, v140, v188
    v_mul_f32 v189, v140, v189
    v_mfma_f32_16x16x32_bf16 v[216:219], a[4:7], v[184:187], v[216:219]
    v_cvt_pk_bf16_f32 v188, v188, v189
    v_mul_f32 v190, v140, v190
    v_mfma_f32_16x16x32_bf16 v[216:219], a[8:11], v[172:175], v[216:219]
    v_mul_f32 v191, v140, v191
    v_cvt_pk_bf16_f32 v189, v190, v191
    v_mfma_f32_16x16x32_bf16 v[216:219], a[12:15], v[148:151], v[216:219]
    ds_write_b64 v4, v[188:189] offset:16384
    v_mfma_f32_16x16x32_bf16 v[216:219], a[16:19], v[112:115], v[216:219]
    v_fma_f32 v120, v180, v180, s33
    v_fmac_f32 v120, v181, v181
    v_mfma_f32_16x16x32_bf16 v[216:219], a[20:23], v[228:231], v[216:219]
    v_fmac_f32 v120, v182, v182
    v_fmac_f32 v120, v183, v183
    v_mfma_f32_16x16x32_bf16 v[160:163], a[24:27], v[196:199], 0
    v_fmac_f32 v120, v108, v108
    v_fmac_f32 v120, v109, v109
    v_mfma_f32_16x16x32_bf16 v[160:163], a[28:31], v[184:187], v[160:163]
    v_fmac_f32 v120, v110, v110
    v_fmac_f32 v120, v111, v111
    v_mfma_f32_16x16x32_bf16 v[160:163], a[32:35], v[172:175], v[160:163]
    v_fmac_f32 v120, v152, v152
    v_fmac_f32 v120, v153, v153
    v_mfma_f32_16x16x32_bf16 v[160:163], a[36:39], v[148:151], v[160:163]
    v_fmac_f32 v120, v154, v154
    v_fmac_f32 v120, v155, v155
    v_mfma_f32_16x16x32_bf16 v[160:163], a[40:43], v[112:115], v[160:163]
    v_cvt_pk_bf16_f32 v122, v120, v121
    v_add_u32 v5, 336, v5
    v_mfma_f32_16x16x32_bf16 v[160:163], a[44:47], v[228:231], v[160:163]
    ds_write_b64 v4, v[122:123] offset:18432
    v_mfma_f32_16x16x32_bf16 v[116:119], a[48:51], v[196:199], 0
    v_add_u32 v6, 272, v6
    v_add_u32 v7, 16, v7
    v_mfma_f32_16x16x32_bf16 v[116:119], a[52:55], v[184:187], v[116:119]
    v_xor_b32 v2, 65536, v2
    v_xor_b32 v3, 65536, v3
    v_mfma_f32_16x16x32_bf16 v[116:119], a[56:59], v[172:175], v[116:119]
    v_xor_b32 v4, 65536, v4
    v_fma_f32 v169, v204, v204, s32
    v_mfma_f32_16x16x32_bf16 v[116:119], a[60:63], v[148:151], v[116:119]
    v_fmac_f32 v169, v205, v205
    v_fmac_f32 v169, v206, v206
    v_mfma_f32_16x16x32_bf16 v[116:119], a[64:67], v[112:115], v[116:119]
    v_fmac_f32 v169, v207, v207
    v_fmac_f32 v169, v176, v176
    v_mfma_f32_16x16x32_bf16 v[116:119], a[68:71], v[228:231], v[116:119]
    v_fmac_f32 v169, v177, v177
    v_fmac_f32 v169, v178, v178
    v_mfma_f32_16x16x32_bf16 v[128:131], v[196:199], a[144:147], 0
    s_waitcnt lgkmcnt(0)
    v_fmac_f32 v169, v179, v179
    v_fmac_f32 v169, v124, v124
    v_mfma_f32_16x16x32_bf16 v[128:131], v[184:187], a[148:151], v[128:131]
    s_nop 0
    v_fmac_f32 v169, v125, v125
    v_fmac_f32 v169, v126, v126
    v_mfma_f32_16x16x32_bf16 v[128:131], v[172:175], a[152:155], v[128:131]
    s_nop 0
    v_fmac_f32 v169, v127, v127
    v_fma_f32 v168, v216, v216, s32
    v_mfma_f32_16x16x32_bf16 v[128:131], v[148:151], a[156:159], v[128:131]
    s_barrier
    v_fmac_f32 v168, v217, v217
    v_fmac_f32 v168, v218, v218
    v_mfma_f32_16x16x32_bf16 v[128:131], v[112:115], a[160:163], v[128:131]
    s_nop 0
    v_fmac_f32 v168, v219, v219
    v_mfma_f32_16x16x32_bf16 v[128:131], v[228:231], a[164:167], v[128:131]
    s_cbranch_scc1 L_loop_safe2
    s_branch L_drain
.p2align 6
L_loop_safe3:
    v_mfma_f32_16x16x32_bf16 v[188:191], v[196:199], a[168:171], 0
    s_add_u32 s12, s42, s27
    ds_read_b128 v[192:195], v2 offset:18432
    ds_read_b128 v[164:167], v2 offset:19456
    v_mfma_f32_16x16x32_bf16 v[188:191], v[184:187], a[172:175], v[188:191]
    s_addc_u32 s13, s43, 0
    ds_read_b128 v[120:123], v0 offset:26624
    ds_read_b128 v[140:143], v1 offset:26624
    v_mfma_f32_16x16x32_bf16 v[188:191], v[172:175], a[176:179], v[188:191]
    s_sub_u32 s14, s36, s27
    v_fmac_f32 v168, v160, v160
    v_fmac_f32 v168, v161, v161
    v_mfma_f32_16x16x32_bf16 v[188:191], v[148:151], a[180:183], v[188:191]
    s_cmp_ge_u32 s18, 2
    ds_read_b128 v[232:235], v0 offset:26752
    ds_read_b128 v[224:227], v1 offset:26752
    v_mfma_f32_16x16x32_bf16 v[188:191], v[112:115], a[184:187], v[188:191]
    s_cselect_b32 s14, s14, 0
    v_fmac_f32 v168, v162, v162
    v_fmac_f32 v168, v163, v163
    v_mfma_f32_16x16x32_bf16 v[188:191], v[228:231], a[188:191], v[188:191]
    s_add_u32 s34, s18, 2
    ds_read_b128 v[212:215], v0 offset:26880
    ds_read_b128 v[144:147], v1 offset:26880
    v_mfma_f32_16x16x32_bf16 v[220:223], v[196:199], a[192:195], 0
    s_add_u32 s8, s40, s23
    v_fmac_f32 v168, v116, v116
    v_fmac_f32 v168, v117, v117
    v_mfma_f32_16x16x32_bf16 v[220:223], v[184:187], a[196:199], v[220:223]
    s_addc_u32 s9, s41, 0
    v_fmac_f32 v168, v118, v118
    v_fmac_f32 v168, v119, v119
    v_mfma_f32_16x16x32_bf16 v[220:223], v[172:175], a[200:203], v[220:223]
    s_waitcnt lgkmcnt(6)
    v_cvt_pk_bf16_f32 v36, v168, v169
    v_cvt_pk_bf16_f32 v236, v128, v129
    v_mfma_f32_16x16x32_bf16 v[172:175], v[32:35], v[192:195], 0
    s_waitcnt lgkmcnt(4)
    v_cvt_pk_bf16_f32 v237, v130, v131
    v_cvt_pk_bf16_f32 v128, v188, v189
    v_mfma_f32_16x16x32_bf16 v[168:171], v[32:35], v[36:39], 0
    s_sub_u32 s10, s36, s23
    v_cvt_pk_bf16_f32 v129, v190, v191
    s_cmp_lt_u32 s34, s17
    v_mfma_f32_16x16x32_bf16 v[172:175], v[32:35], v[164:167], v[172:175]
    s_cselect_b32 s10, s10, 0
    s_add_u32 m0, s28, 0
    s_mov_b32 s27, s26
    v_mfma_f32_16x16x32_bf16 v[220:223], v[148:151], a[204:207], v[220:223]
    s_mov_b32 s26, s25
    v_rsq_f32 v169, v169
    v_mfma_f32_16x16x32_bf16 v[220:223], v[112:115], a[208:211], v[220:223]
    s_mov_b32 s25, s24
    v_rsq_f32 v168, v168
    v_mfma_f32_16x16x32_bf16 v[220:223], v[228:231], a[212:215], v[220:223]
    s_mov_b32 s24, s23
    v_mul_f32 v168, s31, v168
    v_mul_f32 v171, 0x3baaaaab, v172
    v_mfma_f32_16x16x32_bf16 v[112:115], a[72:75], v[120:123], 0
    s_waitcnt lgkmcnt(0)
    v_rsq_f32 v171, v171
    v_mfma_f32_16x16x32_bf16 v[112:115], a[76:79], v[140:143], v[112:115]
    v_mul_f32 v172, 0x3baaaaab, v173
    v_cvt_pk_bf16_f32 v164, v220, v221
    v_mfma_f32_16x16x32_bf16 v[112:115], a[80:83], v[232:235], v[112:115]
    v_cvt_pk_bf16_f32 v165, v222, v223
    v_mul_f32 v170, 0x3baaaaab, v174
    v_mfma_f32_16x16x32_bf16 v[112:115], a[84:87], v[224:227], v[112:115]
    v_rsq_f32 v172, v172
    v_mfma_f32_16x16x32_bf16 v[112:115], a[88:91], v[212:215], v[112:115]
    v_rsq_f32 v170, v170
    v_mfma_f32_16x16x32_bf16 v[112:115], a[92:95], v[144:147], v[112:115]
    v_mul_f32 v180, v171, v180
    v_mul_f32 v181, v171, v181
    v_mfma_f32_16x16x32_bf16 v[148:151], a[96:99], v[120:123], 0
    v_cvt_pk_bf16_f32 v180, v180, v181
    v_mul_f32 v182, v171, v182
    v_mfma_f32_16x16x32_bf16 v[148:151], a[100:103], v[140:143], v[148:151]
    v_mul_f32 v183, v171, v183
    v_cvt_pk_bf16_f32 v181, v182, v183
    v_mfma_f32_16x16x32_bf16 v[148:151], a[104:107], v[232:235], v[148:151]
    v_mul_f32 v108, v171, v108
    v_mul_f32 v109, v171, v109
    v_mfma_f32_16x16x32_bf16 v[148:151], a[108:111], v[224:227], v[148:151]
    v_cvt_pk_bf16_f32 v182, v108, v109
    v_mul_f32 v110, v171, v110
    v_mfma_f32_16x16x32_bf16 v[148:151], a[112:115], v[212:215], v[148:151]
    v_mul_f32 v111, v171, v111
    v_cvt_pk_bf16_f32 v183, v110, v111
    v_mfma_f32_16x16x32_bf16 v[148:151], a[116:119], v[144:147], v[148:151]
    buffer_store_dwordx4 v[180:183], v15, s[12:15], 0 offen
    v_mul_f32 v152, v171, v152
    v_mul_f32 v153, v171, v153
    v_cvt_pk_bf16_f32 v130, v152, v153
    v_mul_f32 v154, v171, v154
    v_mfma_f32_16x16x32_bf16 v[180:183], a[120:123], v[120:123], 0
    v_mul_f32 v155, v171, v155
    v_cvt_pk_bf16_f32 v131, v154, v155
    v_mfma_f32_16x16x32_bf16 v[180:183], a[124:127], v[140:143], v[180:183]
    v_mul_f32 v204, v169, v204
    v_mul_f32 v205, v169, v205
    v_mfma_f32_16x16x32_bf16 v[180:183], a[128:131], v[232:235], v[180:183]
    v_cvt_pk_bf16_f32 v184, v204, v205
    v_mul_f32 v206, v169, v206
    v_mfma_f32_16x16x32_bf16 v[180:183], a[132:135], v[224:227], v[180:183]
    v_mul_f32 v207, v169, v207
    v_cvt_pk_bf16_f32 v185, v206, v207
    v_mfma_f32_16x16x32_bf16 v[180:183], a[136:139], v[212:215], v[180:183]
    v_mul_f32 v176, v169, v176
    v_mul_f32 v177, v169, v177
    v_mfma_f32_16x16x32_bf16 v[180:183], a[140:143], v[144:147], v[180:183]
    v_cvt_pk_bf16_f32 v186, v176, v177
    v_mul_f32 v178, v169, v178
    v_mfma_f32_16x16x32_bf16 v[108:111], a[0:3], v[120:123], 0
    v_mul_f32 v179, v169, v179
    v_cvt_pk_bf16_f32 v187, v178, v179
    v_mfma_f32_16x16x32_bf16 v[108:111], a[4:7], v[140:143], v[108:111]
    v_mul_f32 v124, v169, v124
    v_mul_f32 v125, v169, v125
    v_mfma_f32_16x16x32_bf16 v[108:111], a[8:11], v[232:235], v[108:111]
    v_cvt_pk_bf16_f32 v178, v124, v125
    v_mul_f32 v126, v169, v126
    v_mfma_f32_16x16x32_bf16 v[108:111], a[12:15], v[224:227], v[108:111]
    v_mul_f32 v127, v169, v127
    v_cvt_pk_bf16_f32 v179, v126, v127
    v_mfma_f32_16x16x32_bf16 v[108:111], a[16:19], v[212:215], v[108:111]
    v_mul_f32 v216, v168, v216
    v_mul_f32 v217, v168, v217
    v_mfma_f32_16x16x32_bf16 v[108:111], a[20:23], v[144:147], v[108:111]
    v_cvt_pk_bf16_f32 v124, v216, v217
    v_mul_f32 v218, v168, v218
    v_mfma_f32_16x16x32_bf16 v[152:155], a[24:27], v[120:123], 0
    v_mul_f32 v219, v168, v219
    v_cvt_pk_bf16_f32 v125, v218, v219
    v_mfma_f32_16x16x32_bf16 v[152:155], a[28:31], v[140:143], v[152:155]
    v_mul_f32 v160, v168, v160
    v_mul_f32 v161, v168, v161
    v_mfma_f32_16x16x32_bf16 v[152:155], a[32:35], v[232:235], v[152:155]
    v_cvt_pk_bf16_f32 v126, v160, v161
    v_mul_f32 v162, v168, v162
    v_mfma_f32_16x16x32_bf16 v[152:155], a[36:39], v[224:227], v[152:155]
    v_mul_f32 v163, v168, v163
    v_cvt_pk_bf16_f32 v127, v162, v163
    v_mfma_f32_16x16x32_bf16 v[152:155], a[40:43], v[212:215], v[152:155]
    buffer_store_dwordx2 v[130:131], v18, s[12:15], 0 offen
    v_mul_f32 v116, v168, v116
    v_mul_f32 v117, v168, v117
    v_mfma_f32_16x16x32_bf16 v[152:155], a[44:47], v[144:147], v[152:155]
    v_cvt_pk_bf16_f32 v176, v116, v117
    v_mul_f32 v118, v168, v118
    v_mfma_f32_16x16x32_bf16 v[160:163], a[48:51], v[120:123], 0
    v_mul_f32 v119, v168, v119
    v_cvt_pk_bf16_f32 v177, v118, v119
    v_mfma_f32_16x16x32_bf16 v[160:163], a[52:55], v[140:143], v[160:163]
    v_fma_f32 v130, v108, v108, s32
    v_fmac_f32 v130, v109, v109
    v_mfma_f32_16x16x32_bf16 v[160:163], a[56:59], v[232:235], v[160:163]
    v_fmac_f32 v130, v110, v110
    v_fmac_f32 v130, v111, v111
    v_mfma_f32_16x16x32_bf16 v[160:163], a[60:63], v[224:227], v[160:163]
    v_fmac_f32 v130, v152, v152
    v_fmac_f32 v130, v153, v153
    v_mfma_f32_16x16x32_bf16 v[160:163], a[64:67], v[212:215], v[160:163]
    v_fmac_f32 v130, v154, v154
    v_fmac_f32 v130, v155, v155
    v_mfma_f32_16x16x32_bf16 v[160:163], a[68:71], v[144:147], v[160:163]
    v_fma_f32 v131, v112, v112, s32
    v_fmac_f32 v131, v113, v113
    v_mfma_f32_16x16x32_bf16 v[188:191], v[120:123], a[144:147], 0
    v_fmac_f32 v131, v114, v114
    v_fmac_f32 v131, v115, v115
    v_mfma_f32_16x16x32_bf16 v[188:191], v[140:143], a[148:151], v[188:191]
    v_fmac_f32 v131, v148, v148
    v_fmac_f32 v131, v149, v149
    v_mfma_f32_16x16x32_bf16 v[188:191], v[232:235], a[152:155], v[188:191]
    v_fmac_f32 v130, v160, v160
    v_fmac_f32 v130, v161, v161
    v_mfma_f32_16x16x32_bf16 v[188:191], v[224:227], a[156:159], v[188:191]
    v_fmac_f32 v130, v162, v162
    v_fmac_f32 v130, v163, v163
    v_mfma_f32_16x16x32_bf16 v[188:191], v[212:215], a[160:163], v[188:191]
    v_fmac_f32 v131, v150, v150
    v_fmac_f32 v131, v151, v151
    v_mfma_f32_16x16x32_bf16 v[188:191], v[144:147], a[164:167], v[188:191]
    v_fmac_f32 v131, v180, v180
    v_fmac_f32 v131, v181, v181
    v_mfma_f32_16x16x32_bf16 v[196:199], v[120:123], a[168:171], 0
    ds_read_b128 v[116:119], v0 offset:32768
    v_fmac_f32 v131, v182, v182
    v_mfma_f32_16x16x32_bf16 v[196:199], v[140:143], a[172:175], v[196:199]
    ds_read_b128 v[204:207], v1 offset:32768
    v_fmac_f32 v131, v183, v183
    v_mfma_f32_16x16x32_bf16 v[196:199], v[232:235], a[176:179], v[196:199]
    ds_read_b128 v[192:195], v0 offset:32896
    v_cvt_pk_bf16_f32 v238, v188, v189
    v_mfma_f32_16x16x32_bf16 v[196:199], v[224:227], a[180:183], v[196:199]
    ds_read_b128 v[220:223], v1 offset:32896
    v_cvt_pk_bf16_f32 v239, v190, v191
    v_mfma_f32_16x16x32_bf16 v[196:199], v[212:215], a[184:187], v[196:199]
    ds_read_b128 v[188:191], v0 offset:33024
    v_cvt_pk_bf16_f32 v36, v130, v131
    v_mfma_f32_16x16x32_bf16 v[196:199], v[144:147], a[188:191], v[196:199]
    ds_read_b128 v[240:243], v1 offset:33024
    v_mul_f32 v200, v170, v200
    v_mfma_f32_16x16x32_bf16 v[216:219], v[32:35], v[36:39], 0
    v_mul_f32 v201, v170, v201
    v_cvt_pk_bf16_f32 v200, v200, v201
    v_mfma_f32_16x16x32_bf16 v[228:231], v[120:123], a[192:195], 0
    v_mul_f32 v202, v170, v202
    v_mul_f32 v203, v170, v203
    v_mfma_f32_16x16x32_bf16 v[228:231], v[140:143], a[196:199], v[228:231]
    s_waitcnt lgkmcnt(5)
    v_cvt_pk_bf16_f32 v130, v196, v197
    v_cvt_pk_bf16_f32 v131, v198, v199
    v_mfma_f32_16x16x32_bf16 v[228:231], v[232:235], a[200:203], v[228:231]
    s_waitcnt lgkmcnt(4)
    v_rsq_f32 v217, v217
    v_mfma_f32_16x16x32_bf16 v[228:231], v[224:227], a[204:207], v[228:231]
    s_waitcnt lgkmcnt(3)
    v_rsq_f32 v216, v216
    v_mfma_f32_16x16x32_bf16 v[228:231], v[212:215], a[208:211], v[228:231]
    s_waitcnt lgkmcnt(2)
    v_mul_f32 v216, s31, v216
    v_mul_f32 v112, v217, v112
    v_mfma_f32_16x16x32_bf16 v[228:231], v[144:147], a[212:215], v[228:231]
    s_waitcnt lgkmcnt(1)
    v_mul_f32 v113, v217, v113
    v_cvt_pk_bf16_f32 v112, v112, v113
    v_mfma_f32_16x16x32_bf16 v[120:123], a[72:75], v[116:119], 0
    s_waitcnt lgkmcnt(0)
    v_mul_f32 v114, v217, v114
    v_mul_f32 v115, v217, v115
    v_mfma_f32_16x16x32_bf16 v[120:123], a[76:79], v[204:207], v[120:123]
    v_cvt_pk_bf16_f32 v166, v228, v229
    v_cvt_pk_bf16_f32 v167, v230, v231
    v_mfma_f32_16x16x32_bf16 v[120:123], a[80:83], v[192:195], v[120:123]
    v_cvt_pk_bf16_f32 v113, v114, v115
    v_mul_f32 v148, v217, v148
    v_mfma_f32_16x16x32_bf16 v[120:123], a[84:87], v[220:223], v[120:123]
    v_mul_f32 v149, v217, v149
    v_cvt_pk_bf16_f32 v114, v148, v149
    v_mfma_f32_16x16x32_bf16 v[120:123], a[88:91], v[188:191], v[120:123]
    v_mul_f32 v150, v217, v150
    v_mul_f32 v151, v217, v151
    v_mfma_f32_16x16x32_bf16 v[120:123], a[92:95], v[240:243], v[120:123]
    v_cvt_pk_bf16_f32 v115, v150, v151
    v_mul_f32 v180, v217, v180
    v_mfma_f32_16x16x32_bf16 v[140:143], a[96:99], v[116:119], 0
    v_mul_f32 v181, v217, v181
    v_cvt_pk_bf16_f32 v146, v180, v181
    v_mfma_f32_16x16x32_bf16 v[140:143], a[100:103], v[204:207], v[140:143]
    v_mul_f32 v182, v217, v182
    v_mul_f32 v183, v217, v183
    v_mfma_f32_16x16x32_bf16 v[140:143], a[104:107], v[192:195], v[140:143]
    v_cvt_pk_bf16_f32 v147, v182, v183
    v_mul_f32 v108, v216, v108
    v_mfma_f32_16x16x32_bf16 v[140:143], a[108:111], v[220:223], v[140:143]
    v_mul_f32 v109, v216, v109
    v_cvt_pk_bf16_f32 v148, v108, v109
    v_mfma_f32_16x16x32_bf16 v[140:143], a[112:115], v[188:191], v[140:143]
    v_mul_f32 v110, v216, v110
    v_mul_f32 v111, v216, v111
    v_mfma_f32_16x16x32_bf16 v[140:143], a[116:119], v[240:243], v[140:143]
    v_cvt_pk_bf16_f32 v149, v110, v111
    v_mul_f32 v152, v216, v152
    v_mfma_f32_16x16x32_bf16 v[108:111], a[120:123], v[116:119], 0
    v_mul_f32 v153, v216, v153
    v_cvt_pk_bf16_f32 v150, v152, v153
    v_mfma_f32_16x16x32_bf16 v[108:111], a[124:127], v[204:207], v[108:111]
    v_mul_f32 v154, v216, v154
    v_mul_f32 v155, v216, v155
    v_mfma_f32_16x16x32_bf16 v[108:111], a[128:131], v[192:195], v[108:111]
    v_cvt_pk_bf16_f32 v151, v154, v155
    v_mul_f32 v160, v216, v160
    v_mfma_f32_16x16x32_bf16 v[108:111], a[132:135], v[220:223], v[108:111]
    v_mul_f32 v161, v216, v161
    v_cvt_pk_bf16_f32 v144, v160, v161
    v_mfma_f32_16x16x32_bf16 v[108:111], a[136:139], v[188:191], v[108:111]
    v_mul_f32 v162, v216, v162
    v_mul_f32 v163, v216, v163
    v_mfma_f32_16x16x32_bf16 v[108:111], a[140:143], v[240:243], v[108:111]
    s_waitcnt vmcnt(2)
    v_cvt_pk_bf16_f32 v145, v162, v163
    v_fma_f32 v168, v120, v120, s32
    v_mfma_f32_16x16x32_bf16 v[152:155], a[0:3], v[116:119], 0
    s_nop 0
    v_fmac_f32 v168, v121, v121
    v_fmac_f32 v168, v122, v122
    v_mfma_f32_16x16x32_bf16 v[152:155], a[4:7], v[204:207], v[152:155]
    s_nop 0
    v_fmac_f32 v168, v123, v123
    v_fmac_f32 v168, v140, v140
    v_mfma_f32_16x16x32_bf16 v[152:155], a[8:11], v[192:195], v[152:155]
    s_nop 0
    v_fmac_f32 v168, v141, v141
    v_fmac_f32 v168, v142, v142
    v_mfma_f32_16x16x32_bf16 v[152:155], a[12:15], v[220:223], v[152:155]
    s_barrier
    buffer_load_dwordx4 v10, s[8:11], 0 offen nt lds
    v_fmac_f32 v168, v143, v143
    v_mfma_f32_16x16x32_bf16 v[152:155], a[16:19], v[188:191], v[152:155]
    s_add_u32 m0, s28, 4096
    v_fmac_f32 v168, v108, v108
    v_fmac_f32 v168, v109, v109
    v_mfma_f32_16x16x32_bf16 v[152:155], a[20:23], v[240:243], v[152:155]
    v_fmac_f32 v168, v110, v110
    v_fmac_f32 v168, v111, v111
    v_mfma_f32_16x16x32_bf16 v[160:163], a[24:27], v[116:119], 0
    v_cvt_pk_bf16_f32 v201, v202, v203
    v_mul_f32 v244, v170, v244
    v_mfma_f32_16x16x32_bf16 v[160:163], a[28:31], v[204:207], v[160:163]
    v_mul_f32 v245, v170, v245
    v_cvt_pk_bf16_f32 v202, v244, v245
    v_mfma_f32_16x16x32_bf16 v[160:163], a[32:35], v[192:195], v[160:163]
    buffer_load_dwordx4 v11, s[8:11], 0 offen nt lds
    v_fma_f32 v169, v152, v152, s32
    v_mfma_f32_16x16x32_bf16 v[160:163], a[36:39], v[220:223], v[160:163]
    s_add_u32 m0, s28, 8192
    v_fmac_f32 v169, v153, v153
    v_fmac_f32 v169, v154, v154
    v_mfma_f32_16x16x32_bf16 v[160:163], a[40:43], v[188:191], v[160:163]
    v_fmac_f32 v169, v155, v155
    v_mul_f32 v246, v170, v246
    v_mfma_f32_16x16x32_bf16 v[160:163], a[44:47], v[240:243], v[160:163]
    v_mul_f32 v247, v170, v247
    v_cvt_pk_bf16_f32 v203, v246, v247
    v_mfma_f32_16x16x32_bf16 v[196:199], a[48:51], v[116:119], 0
    v_mul_f32 v132, v170, v132
    v_mul_f32 v133, v170, v133
    v_mfma_f32_16x16x32_bf16 v[196:199], a[52:55], v[204:207], v[196:199]
    buffer_load_dwordx4 v12, s[8:11], 0 offen nt lds
    v_cvt_pk_bf16_f32 v216, v132, v133
    v_mfma_f32_16x16x32_bf16 v[196:199], a[56:59], v[192:195], v[196:199]
    s_add_u32 m0, s28, 12288
    ds_read2_b32 v[250:251], v6 offset0:0 offset1:0
    ds_read2_b32 v[234:235], v6 offset0:16 offset1:16
    v_mfma_f32_16x16x32_bf16 v[196:199], a[60:63], v[220:223], v[196:199]
    s_xor_b32 s28, s28, 65536
    ds_read_b128 v[224:227], v5 offset:0
    ds_read_b128 v[180:183], v5 offset:16
    v_mfma_f32_16x16x32_bf16 v[196:199], a[64:67], v[188:191], v[196:199]
    v_fmac_f32 v169, v160, v160
    v_fmac_f32 v169, v161, v161
    v_mfma_f32_16x16x32_bf16 v[196:199], a[68:71], v[240:243], v[196:199]
    ds_read_b128 v[212:215], v5 offset:48
    ds_read_b32 v173, v6 offset:192
    v_mfma_f32_16x16x32_bf16 v[228:231], v[116:119], a[144:147], 0
    buffer_load_dwordx4 v13, s[8:11], 0 offen nt lds
    ds_read2_b32 v[218:219], v6 offset0:32 offset1:32
    v_mfma_f32_16x16x32_bf16 v[228:231], v[204:207], a[148:151], v[228:231]
    s_mov_b32 m0, s29
    v_fmac_f32 v169, v162, v162
    v_fmac_f32 v169, v163, v163
    v_mfma_f32_16x16x32_bf16 v[228:231], v[192:195], a[152:155], v[228:231]
    s_xor_b32 s29, s29, s30
    v_fmac_f32 v169, v196, v196
    v_fmac_f32 v169, v197, v197
    v_mfma_f32_16x16x32_bf16 v[228:231], v[220:223], a[156:159], v[228:231]
    s_add_u32 s19, s19, s20
    v_fmac_f32 v169, v198, v198
    v_fmac_f32 v169, v199, v199
    v_mfma_f32_16x16x32_bf16 v[228:231], v[188:191], a[160:163], v[228:231]
    s_add_u32 s23, s23, s21
    v_cvt_pk_bf16_f32 v36, v169, v168
    v_mul_f32 v134, v170, v134
    v_mfma_f32_16x16x32_bf16 v[228:231], v[240:243], a[164:167], v[228:231]
    s_waitcnt lgkmcnt(3)
    buffer_store_dwordx4 v[200:203], v17, s[12:15], 0 offen
    v_mul_f32 v135, v170, v135
    v_cvt_pk_bf16_f32 v217, v134, v135
    v_mul_f32 v136, v172, v136
    v_mul_f32 v137, v172, v137
    v_mfma_f32_16x16x32_bf16 v[168:171], v[32:35], v[36:39], 0
    s_cmp_ge_u32 s19, 72
    v_cvt_pk_bf16_f32 v248, v228, v229
    v_cvt_pk_bf16_f32 v249, v230, v231
    v_mfma_f32_16x16x32_bf16 v[132:135], v[224:227], v[124:127], v[22:25]
    s_cselect_b32 s34, 72, 0
    v_cvt_pk_bf16_f32 v200, v136, v137
    v_mul_f32 v138, v172, v138
    v_mfma_f32_16x16x32_bf16 v[132:135], v[180:183], v[184:187], v[132:135]
    s_waitcnt lgkmcnt(0)
    v_rsq_f32 v169, v169
    v_mfma_f32_16x16x32_bf16 v[132:135], v[212:215], v[176:179], v[132:135]
    s_cselect_b32 s35, s22, 0
    v_rsq_f32 v168, v168
    v_mfma_f32_16x16x32_bf16 v[228:231], v[116:119], a[168:171], 0
    s_sub_u32 s19, s19, s34
    v_mul_f32 v168, s31, v168
    v_mul_f32 v120, v169, v120
    v_mfma_f32_16x16x32_bf16 v[228:231], v[204:207], a[172:175], v[228:231]
    s_add_u32 s23, s23, s35
    v_mov_b32_dpp v173, v133 quad_perm:[0,1,2,3] row_mask:0x1 bank_mask:0xf
    v_mul_f32 v121, v169, v121
    v_mfma_f32_16x16x32_bf16 v[228:231], v[192:195], a[176:179], v[228:231]
    s_add_u32 s18, s18, 1
    v_cvt_pk_bf16_f32 v120, v120, v121
    v_mul_f32 v122, v169, v122
    v_mfma_f32_16x16x32_bf16 v[228:231], v[220:223], a[180:183], v[228:231]
    s_cmp_lt_u32 s18, s17
    v_mul_f32 v123, v169, v123
    v_cvt_pk_bf16_f32 v121, v122, v123
    v_mfma_f32_16x16x32_bf16 v[228:231], v[188:191], a[184:187], v[228:231]
    v_mul_f32 v140, v169, v140
    v_mul_f32 v141, v169, v141
    v_mfma_f32_16x16x32_bf16 v[228:231], v[240:243], a[188:191], v[228:231]
    v_cvt_pk_bf16_f32 v122, v140, v141
    v_mul_f32 v142, v169, v142
    v_mfma_f32_16x16x32_bf16 v[244:247], v[116:119], a[192:195], 0
    v_mul_f32 v143, v169, v143
    v_cvt_pk_bf16_f32 v123, v142, v143
    v_mfma_f32_16x16x32_bf16 v[244:247], v[204:207], a[196:199], v[244:247]
    v_mul_f32 v108, v169, v108
    v_mul_f32 v109, v169, v109
    v_mfma_f32_16x16x32_bf16 v[244:247], v[192:195], a[200:203], v[244:247]
    ds_read_b128 v[116:119], v2 offset:0
    v_cvt_pk_bf16_f32 v232, v228, v229
    v_mfma_f32_16x16x32_bf16 v[244:247], v[220:223], a[204:207], v[244:247]
    ds_read_b128 v[204:207], v2 offset:1024
    v_cvt_pk_bf16_f32 v233, v230, v231
    v_mfma_f32_16x16x32_bf16 v[244:247], v[188:191], a[208:211], v[244:247]
    ds_read_b128 v[140:143], v2 offset:2048
    v_cvt_pk_bf16_f32 v190, v108, v109
    v_mfma_f32_16x16x32_bf16 v[244:247], v[240:243], a[212:215], v[244:247]
    ds_read_b128 v[252:255], v2 offset:3072
    ds_read_b128 v[192:195], v2 offset:4096
    v_mfma_f32_16x16x32_bf16 v[220:223], v[184:187], v[124:127], v[40:43]
    ds_read_b128 v[134:137], v2 offset:5120
    buffer_store_dwordx2 v[216:217], v20, s[12:15], 0 offen
    v_mul_f32 v110, v169, v110
    v_mul_f32 v111, v169, v111
    v_mfma_f32_16x16x32_bf16 v[240:243], v[112:115], v[124:127], v[44:47]
    v_cvt_pk_bf16_f32 v216, v244, v245
    v_cvt_pk_bf16_f32 v217, v246, v247
    v_mfma_f32_16x16x32_bf16 v[228:231], v[120:123], v[124:127], v[48:51]
    v_cvt_pk_bf16_f32 v191, v110, v111
    v_mul_f32 v152, v168, v152
    v_mul_f32 v153, v168, v153
    v_mfma_f32_16x16x16_bf16 v[220:223], v[178:179], v[176:177], v[220:223]
    v_cvt_pk_bf16_f32 v244, v152, v153
    v_mul_f32 v154, v168, v154
    v_mul_f32 v155, v168, v155
    v_mfma_f32_16x16x16_bf16 v[240:243], v[146:147], v[176:177], v[240:243]
    v_cvt_pk_bf16_f32 v245, v154, v155
    v_mul_f32 v160, v168, v160
    v_mul_f32 v161, v168, v161
    v_mfma_f32_16x16x16_bf16 v[228:231], v[190:191], v[176:177], v[228:231]
    v_cvt_pk_bf16_f32 v246, v160, v161
    v_mul_f32 v162, v168, v162
    v_mul_f32 v163, v168, v163
    v_cvt_pk_bf16_f32 v247, v162, v163
    v_mfma_f32_16x16x32_bf16 v[124:127], v[224:227], v[148:151], v[24:27]
    s_waitcnt lgkmcnt(1)
    v_mul_f32 v196, v168, v196
    v_mul_f32 v197, v168, v197
    v_mfma_f32_16x16x32_bf16 v[124:127], v[180:183], v[112:115], v[124:127]
    s_waitcnt lgkmcnt(0)
    v_cvt_pk_bf16_f32 v188, v196, v197
    v_mul_f32 v198, v168, v198
    v_mfma_f32_16x16x32_bf16 v[124:127], v[212:215], v[144:147], v[124:127]
    v_mul_f32 v199, v168, v199
    v_cvt_pk_bf16_f32 v189, v198, v199
    v_mfma_f32_16x16x32_bf16 v[160:163], v[224:227], v[244:247], v[26:29]
    v_max3_f32 v133, v132, v220, v221
    v_max3_f32 v133, v133, v222, v223
    v_mfma_f32_16x16x32_bf16 v[160:163], v[180:183], v[120:123], v[160:163]
    v_max3_f32 v133, v133, v240, v241
    v_max3_f32 v133, v133, v242, v243
    v_mfma_f32_16x16x32_bf16 v[160:163], v[212:215], v[188:191], v[160:163]
    v_max3_f32 v133, v133, v228, v229
    v_max3_f32 v133, v133, v230, v231
    v_mfma_f32_16x16x32_bf16 v[180:183], a[216:219], v[116:119], 0
    v_mov_b32 v174, v133
    v_mov_b32_dpp v173, v125 quad_perm:[0,1,2,3] row_mask:0x2 bank_mask:0xf
    v_mfma_f32_16x16x32_bf16 v[180:183], a[220:223], v[204:207], v[180:183]
    v_permlane32_swap_b32 v133, v174
    v_mfma_f32_16x16x32_bf16 v[180:183], a[224:227], v[140:143], v[180:183]
    v_max_f32 v133, v133, v174
    v_mov_b32 v174, v133
    v_mfma_f32_16x16x32_bf16 v[180:183], a[228:231], v[252:255], v[180:183]
    v_mov_b32_dpp v173, v161 quad_perm:[0,1,2,3] row_mask:0x4 bank_mask:0xf
    v_mul_f32 v139, v172, v139
    v_mfma_f32_16x16x32_bf16 v[180:183], a[232:235], v[192:195], v[180:183]
    v_permlane16_swap_b32 v133, v174
    v_mfma_f32_16x16x32_bf16 v[180:183], a[236:239], v[134:137], v[180:183]
    v_max_f32 v133, v133, v174
    v_sub_f32 v220, v220, v133
    v_mfma_f32_16x16x32_bf16 v[108:111], a[240:243], v[116:119], 0
    v_exp_f32 v220, v220
    v_mfma_f32_16x16x32_bf16 v[108:111], a[244:247], v[204:207], v[108:111]
    v_sub_f32 v221, v221, v133
    v_sub_f32 v222, v222, v133
    v_mfma_f32_16x16x32_bf16 v[108:111], a[248:251], v[140:143], v[108:111]
    v_exp_f32 v221, v221
    v_mfma_f32_16x16x32_bf16 v[108:111], a[252:255], v[252:255], v[108:111]
    ds_read_b128 v[168:171], v2 offset:6144
    v_cvt_pk_bf16_f32 v212, v220, v221
    v_mfma_f32_16x16x32_bf16 v[108:111], v[76:79], v[192:195], v[108:111]
    ds_read_b128 v[196:199], v2 offset:7168
    v_sub_f32 v223, v223, v133
    v_mfma_f32_16x16x32_bf16 v[108:111], v[80:83], v[134:137], v[108:111]
    ds_read_b128 v[224:227], v2 offset:8192
    v_sub_f32 v240, v240, v133
    v_mfma_f32_16x16x32_bf16 v[152:155], v[84:87], v[116:119], 0
    ds_read_b128 v[174:177], v2 offset:9216
    v_sub_f32 v241, v241, v133
    v_mfma_f32_16x16x32_bf16 v[152:155], v[88:91], v[204:207], v[152:155]
    ds_read_b128 v[116:119], v2 offset:10240
    v_sub_f32 v242, v242, v133
    v_mfma_f32_16x16x32_bf16 v[152:155], v[92:95], v[140:143], v[152:155]
    ds_read_b128 v[204:207], v2 offset:11264
    v_sub_f32 v243, v243, v133
    v_mfma_f32_16x16x32_bf16 v[152:155], v[96:99], v[252:255], v[152:155]
    v_exp_f32 v222, v222
    v_mfma_f32_16x16x32_bf16 v[152:155], v[100:103], v[192:195], v[152:155]
    v_exp_f32 v223, v223
    v_mfma_f32_16x16x32_bf16 v[152:155], v[104:107], v[134:137], v[152:155]
    s_waitcnt lgkmcnt(5)
    v_cvt_pk_bf16_f32 v213, v222, v223
    v_exp_f32 v240, v240
    v_exp_f32 v241, v241
    v_mfma_f32_16x16x32_bf16 v[140:143], v[184:187], v[148:151], v[52:55]
    s_waitcnt lgkmcnt(3)
    v_cvt_pk_bf16_f32 v214, v240, v241
    v_exp_f32 v242, v242
    v_exp_f32 v243, v243
    v_sub_f32 v228, v228, v133
    v_cvt_pk_bf16_f32 v215, v242, v243
    v_mfma_f32_16x16x16_bf16 v[140:143], v[178:179], v[144:145], v[140:143]
    v_exp_f32 v228, v228
    v_sub_f32 v229, v229, v133
    v_exp_f32 v229, v229
    v_mfma_f32_16x16x32_bf16 v[192:195], v[112:115], v[148:151], v[56:59]
    s_waitcnt lgkmcnt(0)
    v_cvt_pk_bf16_f32 v36, v228, v229
    v_sub_f32 v230, v230, v133
    v_exp_f32 v230, v230
    v_sub_f32 v231, v231, v133
    v_exp_f32 v231, v231
    v_mfma_f32_16x16x32_bf16 v[220:223], v[120:123], v[148:151], v[60:63]
    v_cvt_pk_bf16_f32 v37, v230, v231
    v_sub_f32 v132, v132, v133
    v_max3_f32 v203, v124, v140, v141
    v_mfma_f32_16x16x16_bf16 v[192:195], v[146:147], v[144:145], v[192:195]
    v_exp_f32 v132, v132
    v_max3_f32 v203, v203, v142, v143
    v_mfma_f32_16x16x16_bf16 v[220:223], v[190:191], v[144:145], v[220:223]
    v_cvt_pk_bf16_f32 v39, v132, 0
    v_cvt_pk_bf16_f32 v201, v138, v139
    v_mul_f32 v208, v172, v208
    v_mul_f32 v209, v172, v209
    v_mfma_f32_16x16x32_bf16 v[132:135], v[28:31], v[36:39], 0
    v_max3_f32 v203, v203, v192, v193
    v_max3_f32 v203, v203, v194, v195
    v_mfma_f32_16x16x32_bf16 v[132:135], v[28:31], v[212:215], v[132:135]
    v_max3_f32 v203, v203, v220, v221
    v_max3_f32 v203, v203, v222, v223
    v_mfma_f32_16x16x32_bf16 v[148:151], v[248:251], v[36:39], 0
    v_mov_b32 v144, v203
    v_cvt_pk_bf16_f32 v202, v208, v209
    v_mfma_f32_16x16x32_bf16 v[148:151], v[236:239], v[212:215], v[148:151]
    v_permlane32_swap_b32 v203, v144
    v_mfma_f32_16x16x32_bf16 v[228:231], v[232:235], v[36:39], 0
    v_max_f32 v203, v203, v144
    v_mov_b32 v144, v203
    v_mfma_f32_16x16x32_bf16 v[228:231], v[128:131], v[212:215], v[228:231]
    v_rcp_f32 v132, v132
    v_mfma_f32_16x16x32_bf16 v[240:243], v[216:219], v[36:39], 0
    v_permlane16_swap_b32 v203, v144
    v_mfma_f32_16x16x32_bf16 v[240:243], v[164:167], v[212:215], v[240:243]
    v_max_f32 v203, v203, v144
    v_sub_f32 v140, v140, v203
    v_mfma_f32_16x16x32_bf16 v[136:139], a[216:219], v[168:171], 0
    v_exp_f32 v140, v140
    v_mfma_f32_16x16x32_bf16 v[136:139], a[220:223], v[196:199], v[136:139]
    v_sub_f32 v141, v141, v203
    v_sub_f32 v142, v142, v203
    v_mfma_f32_16x16x32_bf16 v[136:139], a[224:227], v[224:227], v[136:139]
    v_exp_f32 v141, v141
    v_mfma_f32_16x16x32_bf16 v[136:139], a[228:231], v[174:177], v[136:139]
    v_cvt_pk_bf16_f32 v140, v140, v141
    v_sub_f32 v143, v143, v203
    v_mfma_f32_16x16x32_bf16 v[136:139], a[232:235], v[116:119], v[136:139]
    v_exp_f32 v142, v142
    v_mfma_f32_16x16x32_bf16 v[136:139], a[236:239], v[204:207], v[136:139]
    v_exp_f32 v143, v143
    v_sub_f32 v192, v192, v203
    v_cvt_pk_bf16_f32 v141, v142, v143
    v_exp_f32 v192, v192
    v_sub_f32 v193, v193, v203
    v_exp_f32 v193, v193
    v_sub_f32 v194, v194, v203
    v_cvt_pk_bf16_f32 v142, v192, v193
    v_exp_f32 v194, v194
    v_sub_f32 v195, v195, v203
    v_exp_f32 v195, v195
    v_sub_f32 v220, v220, v203
    v_cvt_pk_bf16_f32 v143, v194, v195
    v_exp_f32 v220, v220
    v_sub_f32 v221, v221, v203
    v_exp_f32 v221, v221
    v_sub_f32 v222, v222, v203
    v_cvt_pk_bf16_f32 v36, v220, v221
    v_exp_f32 v222, v222
    v_sub_f32 v223, v223, v203
    v_exp_f32 v223, v223
    v_mfma_f32_16x16x32_bf16 v[192:195], v[184:187], v[244:247], v[64:67]
    v_cvt_pk_bf16_f32 v37, v222, v223
    v_sub_f32 v124, v124, v203
    v_mfma_f32_16x16x32_bf16 v[184:187], v[112:115], v[244:247], v[68:71]
    v_exp_f32 v124, v124
    v_mfma_f32_16x16x32_bf16 v[212:215], v[120:123], v[244:247], v[72:75]
    v_cvt_pk_bf16_f32 v39, v124, 0
    v_mul_f32 v148, v132, v148
    v_mul_f32 v149, v132, v149
    v_mfma_f32_16x16x32_bf16 v[120:123], v[28:31], v[36:39], 0
    v_cvt_pk_bf16_f32 v112, v148, v149
    v_mul_f32 v150, v132, v150
    v_mfma_f32_16x16x32_bf16 v[120:123], v[28:31], v[140:143], v[120:123]
    v_mul_f32 v151, v132, v151
    v_cvt_pk_bf16_f32 v113, v150, v151
    v_mfma_f32_16x16x32_bf16 v[124:127], v[248:251], v[36:39], 0
    v_mul_f32 v228, v132, v228
    v_mul_f32 v229, v132, v229
    v_mfma_f32_16x16x32_bf16 v[124:127], v[236:239], v[140:143], v[124:127]
    v_cvt_pk_bf16_f32 v114, v228, v229
    v_mul_f32 v230, v132, v230
    v_mfma_f32_16x16x32_bf16 v[220:223], v[232:235], v[36:39], 0
    v_mul_f32 v231, v132, v231
    v_cvt_pk_bf16_f32 v115, v230, v231
    v_mfma_f32_16x16x32_bf16 v[220:223], v[128:131], v[140:143], v[220:223]
    ds_write_b128 v3, v[112:115] offset:0
    v_mfma_f32_16x16x32_bf16 v[252:255], v[216:219], v[36:39], 0
    v_mul_f32 v240, v132, v240
    v_mul_f32 v241, v132, v241
    v_mfma_f32_16x16x32_bf16 v[252:255], v[164:167], v[140:143], v[252:255]
    v_cvt_pk_bf16_f32 v122, v240, v241
    v_mul_f32 v242, v132, v242
    v_mul_f32 v243, v132, v243
    v_mfma_f32_16x16x16_bf16 v[192:195], v[178:179], v[188:189], v[192:195]
    v_cvt_pk_bf16_f32 v123, v242, v243
    v_mul_f32 v210, v172, v210
    v_mul_f32 v211, v172, v211
    v_mfma_f32_16x16x16_bf16 v[184:187], v[146:147], v[188:189], v[184:187]
    v_cvt_pk_bf16_f32 v203, v210, v211
    v_mul_f32 v156, v172, v156
    v_mul_f32 v157, v172, v157
    v_mfma_f32_16x16x16_bf16 v[212:215], v[190:191], v[188:189], v[212:215]
    v_cvt_pk_bf16_f32 v178, v156, v157
    v_mul_f32 v158, v172, v158
    v_mul_f32 v159, v172, v159
    v_cvt_pk_bf16_f32 v179, v158, v159
    v_mfma_f32_16x16x32_bf16 v[208:211], a[240:243], v[168:171], 0
    ds_write_b64 v4, v[122:123] offset:4096
    v_mfma_f32_16x16x32_bf16 v[208:211], a[244:247], v[196:199], v[208:211]
    buffer_store_dwordx4 v[200:203], v16, s[12:15], 0 offen
    v_mov_b32 v172, v173
    v_max3_f32 v121, v160, v192, v193
    v_max3_f32 v121, v121, v194, v195
    v_max_f32_dpp v172, v172, v172 quad_perm:[1,0,3,2] row_mask:0xf bank_mask:0xf
    v_mfma_f32_16x16x32_bf16 v[208:211], a[248:251], v[224:227], v[208:211]
    v_max3_f32 v121, v121, v184, v185
    v_max_f32_dpp v172, v172, v172 quad_perm:[2,3,0,1] row_mask:0xf bank_mask:0xf
    v_mfma_f32_16x16x32_bf16 v[208:211], a[252:255], v[174:177], v[208:211]
    ds_read_b128 v[112:115], v2 offset:12288
    v_max_f32_dpp v172, v172, v172 row_half_mirror row_mask:0xf bank_mask:0xf
    v_mfma_f32_16x16x32_bf16 v[208:211], v[76:79], v[116:119], v[208:211]
    ds_read_b128 v[188:191], v2 offset:13312
    v_max_f32_dpp v172, v172, v172 row_mirror row_mask:0xf bank_mask:0xf
    v_mfma_f32_16x16x32_bf16 v[208:211], v[80:83], v[204:207], v[208:211]
    ds_read_b128 v[144:147], v2 offset:14336
    v_mov_b32 v122, v172
    v_mfma_f32_16x16x32_bf16 v[156:159], v[84:87], v[168:171], 0
    ds_read_b128 v[140:143], v2 offset:15360
    v_max3_f32 v121, v121, v186, v187
    v_mfma_f32_16x16x32_bf16 v[156:159], v[88:91], v[196:199], v[156:159]
    ds_read_b128 v[168:171], v2 offset:16384
    v_max3_f32 v121, v121, v212, v213
    v_mfma_f32_16x16x32_bf16 v[156:159], v[92:95], v[224:227], v[156:159]
    ds_read_b128 v[148:151], v2 offset:17408
    v_max3_f32 v121, v121, v214, v215
    v_mfma_f32_16x16x32_bf16 v[156:159], v[96:99], v[174:177], v[156:159]
    v_permlane32_swap_b32 v172, v122
    v_mfma_f32_16x16x32_bf16 v[156:159], v[100:103], v[116:119], v[156:159]
    v_max_f32 v172, v172, v122
    v_mov_b32 v122, v172
    v_mfma_f32_16x16x32_bf16 v[156:159], v[104:107], v[204:207], v[156:159]
    s_waitcnt lgkmcnt(5)
    v_permlane16_swap_b32 v172, v122
    v_mfma_f32_16x16x32_bf16 v[200:203], a[216:219], v[112:115], 0
    s_waitcnt lgkmcnt(4)
    v_max_f32 v172, v172, v122
    v_sub_f32 v173, v173, v172
    v_mfma_f32_16x16x32_bf16 v[200:203], a[220:223], v[188:191], v[200:203]
    s_waitcnt lgkmcnt(3)
    v_exp_f32 v173, v173
    v_mfma_f32_16x16x32_bf16 v[200:203], a[224:227], v[144:147], v[200:203]
    s_waitcnt lgkmcnt(2)
    v_cvt_pk_bf16_f32 v173, v173, v173
    v_mov_b32 v122, v121
    v_mfma_f32_16x16x32_bf16 v[200:203], a[228:231], v[140:143], v[200:203]
    s_waitcnt lgkmcnt(1)
    ds_write_b16 v8, v173
    v_mfma_f32_16x16x32_bf16 v[200:203], a[232:235], v[168:171], v[200:203]
    s_waitcnt lgkmcnt(1)
    v_permlane32_swap_b32 v121, v122
    v_mfma_f32_16x16x32_bf16 v[200:203], a[236:239], v[148:151], v[200:203]
    v_max_f32 v121, v121, v122
    v_mov_b32 v122, v121
    v_mfma_f32_16x16x32_bf16 v[244:247], a[240:243], v[112:115], 0
    buffer_store_dwordx2 v[178:179], v19, s[12:15], 0 offen
    v_permlane16_swap_b32 v121, v122
    v_mfma_f32_16x16x32_bf16 v[244:247], a[244:247], v[188:191], v[244:247]
    v_max_f32 v121, v121, v122
    v_sub_f32 v192, v192, v121
    v_mfma_f32_16x16x32_bf16 v[244:247], a[248:251], v[144:147], v[244:247]
    v_fma_f32 v122, v200, v200, s33
    v_fmac_f32 v122, v201, v201
    v_mfma_f32_16x16x32_bf16 v[244:247], a[252:255], v[140:143], v[244:247]
    v_fmac_f32 v122, v202, v202
    v_fmac_f32 v122, v203, v203
    v_mfma_f32_16x16x32_bf16 v[244:247], v[76:79], v[168:171], v[244:247]
    v_exp_f32 v192, v192
    v_mfma_f32_16x16x32_bf16 v[244:247], v[80:83], v[148:151], v[244:247]
    v_sub_f32 v193, v193, v121
    v_sub_f32 v194, v194, v121
    v_mfma_f32_16x16x32_bf16 v[132:135], v[84:87], v[112:115], 0
    v_exp_f32 v193, v193
    v_mfma_f32_16x16x32_bf16 v[132:135], v[88:91], v[188:191], v[132:135]
    v_cvt_pk_bf16_f32 v116, v192, v193
    v_sub_f32 v195, v195, v121
    v_mfma_f32_16x16x32_bf16 v[132:135], v[92:95], v[144:147], v[132:135]
    v_fmac_f32 v122, v244, v244
    v_fmac_f32 v122, v245, v245
    v_mfma_f32_16x16x32_bf16 v[132:135], v[96:99], v[140:143], v[132:135]
    v_fmac_f32 v122, v246, v246
    v_fmac_f32 v122, v247, v247
    v_mfma_f32_16x16x32_bf16 v[132:135], v[100:103], v[168:171], v[132:135]
    v_exp_f32 v194, v194
    v_mfma_f32_16x16x32_bf16 v[132:135], v[104:107], v[148:151], v[132:135]
    v_exp_f32 v195, v195
    v_sub_f32 v184, v184, v121
    v_cvt_pk_bf16_f32 v117, v194, v195
    v_exp_f32 v184, v184
    v_sub_f32 v185, v185, v121
    v_exp_f32 v185, v185
    v_sub_f32 v186, v186, v121
    v_cvt_pk_bf16_f32 v118, v184, v185
    v_fmac_f32 v122, v132, v132
    v_fmac_f32 v122, v133, v133
    v_fmac_f32 v122, v134, v134
    v_fmac_f32 v122, v135, v135
    v_cvt_pk_bf16_f32 v123, v122, v122
    v_exp_f32 v186, v186
    v_sub_f32 v187, v187, v121
    v_exp_f32 v187, v187
    v_sub_f32 v212, v212, v121
    v_cvt_pk_bf16_f32 v119, v186, v187
    v_exp_f32 v212, v212
    v_sub_f32 v213, v213, v121
    v_exp_f32 v213, v213
    v_sub_f32 v214, v214, v121
    v_cvt_pk_bf16_f32 v36, v212, v213
    v_exp_f32 v214, v214
    v_sub_f32 v215, v215, v121
    v_exp_f32 v215, v215
    v_sub_f32 v160, v160, v121
    v_cvt_pk_bf16_f32 v37, v214, v215
    v_exp_f32 v160, v160
    v_xor_b32 v0, 65536, v0
    v_cvt_pk_bf16_f32 v39, v160, 0
    v_xor_b32 v1, 65536, v1
    v_fma_f32 v121, v136, v136, s33
    v_mfma_f32_16x16x32_bf16 v[140:143], v[28:31], v[36:39], 0
    ds_read_b128 v[196:199], v0 offset:20480
    ds_read_b128 v[184:187], v1 offset:20480
    v_mfma_f32_16x16x32_bf16 v[140:143], v[28:31], v[116:119], v[140:143]
    ds_read_b128 v[172:175], v0 offset:20608
    ds_read_b128 v[148:151], v1 offset:20608
    v_mfma_f32_16x16x32_bf16 v[144:147], v[248:251], v[36:39], 0
    buffer_load_dwordx4 v14, s[8:11], 0 offen nt lds
    ds_read_b128 v[112:115], v0 offset:20736
    v_mfma_f32_16x16x32_bf16 v[144:147], v[236:239], v[116:119], v[144:147]
    v_fmac_f32 v121, v137, v137
    v_fmac_f32 v121, v138, v138
    v_mfma_f32_16x16x32_bf16 v[168:171], v[232:235], v[36:39], 0
    ds_read_b128 v[228:231], v1 offset:20736
    ds_read_b128 v[176:179], v9
    v_mfma_f32_16x16x32_bf16 v[168:171], v[128:131], v[116:119], v[168:171]
    v_fmac_f32 v121, v139, v139
    v_fmac_f32 v121, v208, v208
    v_mfma_f32_16x16x32_bf16 v[188:191], v[216:219], v[36:39], 0
    ds_read_b128 v[160:163], v9 offset:64
    v_fmac_f32 v121, v209, v209
    v_mfma_f32_16x16x32_bf16 v[188:191], v[164:167], v[116:119], v[188:191]
    v_fmac_f32 v121, v210, v210
    v_fmac_f32 v121, v211, v211
    s_waitcnt lgkmcnt(6)
    v_mfma_f32_16x16x32_bf16 v[204:207], a[72:75], v[196:199], 0
    s_waitcnt lgkmcnt(5)
    v_fmac_f32 v121, v156, v156
    v_fmac_f32 v121, v157, v157
    v_mfma_f32_16x16x32_bf16 v[204:207], a[76:79], v[184:187], v[204:207]
    s_waitcnt lgkmcnt(4)
    v_fmac_f32 v121, v158, v158
    v_fmac_f32 v121, v159, v159
    v_mfma_f32_16x16x32_bf16 v[204:207], a[80:83], v[172:175], v[204:207]
    s_waitcnt lgkmcnt(3)
    v_rcp_f32 v120, v120
    v_mfma_f32_16x16x32_bf16 v[204:207], a[84:87], v[148:151], v[204:207]
    s_waitcnt lgkmcnt(2)
    v_mul_f32 v124, v120, v124
    v_mul_f32 v125, v120, v125
    v_mfma_f32_16x16x32_bf16 v[204:207], a[88:91], v[112:115], v[204:207]
    s_waitcnt lgkmcnt(1)
    v_cvt_pk_bf16_f32 v192, v124, v125
    v_mul_f32 v126, v120, v126
    v_mfma_f32_16x16x32_bf16 v[212:215], v[176:179], v[28:31], 0
    s_waitcnt lgkmcnt(0)
    v_mul_f32 v127, v120, v127
    v_cvt_pk_bf16_f32 v193, v126, v127
    v_mfma_f32_16x16x32_bf16 v[212:215], v[160:163], v[28:31], v[212:215]
    v_mul_f32 v220, v120, v220
    v_mul_f32 v221, v120, v221
    v_mfma_f32_16x16x32_bf16 v[116:119], v[176:179], v[236:239], 0
    v_cvt_pk_bf16_f32 v194, v220, v221
    v_mul_f32 v222, v120, v222
    v_mfma_f32_16x16x32_bf16 v[116:119], v[160:163], v[248:251], v[116:119]
    v_mul_f32 v223, v120, v223
    v_cvt_pk_bf16_f32 v195, v222, v223
    v_mfma_f32_16x16x32_bf16 v[124:127], v[176:179], v[128:131], 0
    ds_write_b128 v3, v[192:195] offset:6144
    v_mfma_f32_16x16x32_bf16 v[124:127], v[160:163], v[232:235], v[124:127]
    v_mul_f32 v252, v120, v252
    v_mul_f32 v253, v120, v253
    v_mfma_f32_16x16x32_bf16 v[128:131], v[176:179], v[164:167], 0
    v_cvt_pk_bf16_f32 v252, v252, v253
    v_mul_f32 v254, v120, v254
    v_mfma_f32_16x16x32_bf16 v[128:131], v[160:163], v[216:219], v[128:131]
    v_mul_f32 v255, v120, v255
    v_cvt_pk_bf16_f32 v253, v254, v255
    v_mfma_f32_16x16x32_bf16 v[204:207], a[92:95], v[228:231], v[204:207]
    ds_write_b64 v4, v[252:253] offset:10240
    v_mfma_f32_16x16x32_bf16 v[176:179], a[96:99], v[196:199], 0
    v_rcp_f32 v212, v212
    v_mfma_f32_16x16x32_bf16 v[176:179], a[100:103], v[184:187], v[176:179]
    v_mul_f32 v116, v116, v212
    v_mul_f32_dpp v116, v124, v212 quad_perm:[0,1,2,3] row_mask:0x2 bank_mask:0xf
    v_mfma_f32_16x16x32_bf16 v[176:179], a[104:107], v[172:175], v[176:179]
    v_mul_f32_dpp v116, v128, v212 quad_perm:[0,1,2,3] row_mask:0x4 bank_mask:0xf
    v_cvt_pk_bf16_f32 v116, v116, v116
    v_mfma_f32_16x16x32_bf16 v[176:179], a[108:111], v[148:151], v[176:179]
    ds_write_b16 v7, v116
    v_mfma_f32_16x16x32_bf16 v[176:179], a[112:115], v[112:115], v[176:179]
    v_rcp_f32 v140, v140
    v_mfma_f32_16x16x32_bf16 v[176:179], a[116:119], v[228:231], v[176:179]
    v_mul_f32 v144, v140, v144
    v_mul_f32 v145, v140, v145
    v_mfma_f32_16x16x32_bf16 v[124:127], a[120:123], v[196:199], 0
    v_cvt_pk_bf16_f32 v116, v144, v145
    v_mul_f32 v146, v140, v146
    v_mfma_f32_16x16x32_bf16 v[124:127], a[124:127], v[184:187], v[124:127]
    v_mul_f32 v147, v140, v147
    v_cvt_pk_bf16_f32 v117, v146, v147
    v_mfma_f32_16x16x32_bf16 v[124:127], a[128:131], v[172:175], v[124:127]
    v_mul_f32 v168, v140, v168
    v_mul_f32 v169, v140, v169
    v_mfma_f32_16x16x32_bf16 v[124:127], a[132:135], v[148:151], v[124:127]
    v_cvt_pk_bf16_f32 v118, v168, v169
    v_mul_f32 v170, v140, v170
    v_mfma_f32_16x16x32_bf16 v[124:127], a[136:139], v[112:115], v[124:127]
    v_mul_f32 v171, v140, v171
    v_cvt_pk_bf16_f32 v119, v170, v171
    v_mfma_f32_16x16x32_bf16 v[124:127], a[140:143], v[228:231], v[124:127]
    ds_write_b128 v3, v[116:119] offset:12288
    v_mfma_f32_16x16x32_bf16 v[216:219], a[0:3], v[196:199], 0
    v_mul_f32 v188, v140, v188
    v_mul_f32 v189, v140, v189
    v_mfma_f32_16x16x32_bf16 v[216:219], a[4:7], v[184:187], v[216:219]
    v_cvt_pk_bf16_f32 v188, v188, v189
    v_mul_f32 v190, v140, v190
    v_mfma_f32_16x16x32_bf16 v[216:219], a[8:11], v[172:175], v[216:219]
    v_mul_f32 v191, v140, v191
    v_cvt_pk_bf16_f32 v189, v190, v191
    v_mfma_f32_16x16x32_bf16 v[216:219], a[12:15], v[148:151], v[216:219]
    ds_write_b64 v4, v[188:189] offset:16384
    v_mfma_f32_16x16x32_bf16 v[216:219], a[16:19], v[112:115], v[216:219]
    v_fma_f32 v120, v180, v180, s33
    v_fmac_f32 v120, v181, v181
    v_mfma_f32_16x16x32_bf16 v[216:219], a[20:23], v[228:231], v[216:219]
    v_fmac_f32 v120, v182, v182
    v_fmac_f32 v120, v183, v183
    v_mfma_f32_16x16x32_bf16 v[160:163], a[24:27], v[196:199], 0
    v_fmac_f32 v120, v108, v108
    v_fmac_f32 v120, v109, v109
    v_mfma_f32_16x16x32_bf16 v[160:163], a[28:31], v[184:187], v[160:163]
    v_fmac_f32 v120, v110, v110
    v_fmac_f32 v120, v111, v111
    v_mfma_f32_16x16x32_bf16 v[160:163], a[32:35], v[172:175], v[160:163]
    v_fmac_f32 v120, v152, v152
    v_fmac_f32 v120, v153, v153
    v_mfma_f32_16x16x32_bf16 v[160:163], a[36:39], v[148:151], v[160:163]
    v_fmac_f32 v120, v154, v154
    v_fmac_f32 v120, v155, v155
    v_mfma_f32_16x16x32_bf16 v[160:163], a[40:43], v[112:115], v[160:163]
    v_cvt_pk_bf16_f32 v122, v120, v121
    v_add_u32 v5, 336, v5
    v_mfma_f32_16x16x32_bf16 v[160:163], a[44:47], v[228:231], v[160:163]
    ds_write_b64 v4, v[122:123] offset:18432
    v_mfma_f32_16x16x32_bf16 v[116:119], a[48:51], v[196:199], 0
    v_add_u32 v6, 272, v6
    v_add_u32 v7, 16, v7
    v_mfma_f32_16x16x32_bf16 v[116:119], a[52:55], v[184:187], v[116:119]
    v_xor_b32 v2, 65536, v2
    v_xor_b32 v3, 65536, v3
    v_mfma_f32_16x16x32_bf16 v[116:119], a[56:59], v[172:175], v[116:119]
    v_xor_b32 v4, 65536, v4
    v_fma_f32 v169, v204, v204, s32
    v_mfma_f32_16x16x32_bf16 v[116:119], a[60:63], v[148:151], v[116:119]
    v_fmac_f32 v169, v205, v205
    v_fmac_f32 v169, v206, v206
    v_mfma_f32_16x16x32_bf16 v[116:119], a[64:67], v[112:115], v[116:119]
    v_fmac_f32 v169, v207, v207
    v_fmac_f32 v169, v176, v176
    v_mfma_f32_16x16x32_bf16 v[116:119], a[68:71], v[228:231], v[116:119]
    v_fmac_f32 v169, v177, v177
    v_fmac_f32 v169, v178, v178
    v_mfma_f32_16x16x32_bf16 v[128:131], v[196:199], a[144:147], 0
    s_waitcnt lgkmcnt(0)
    v_fmac_f32 v169, v179, v179
    v_fmac_f32 v169, v124, v124
    v_mfma_f32_16x16x32_bf16 v[128:131], v[184:187], a[148:151], v[128:131]
    s_nop 0
    v_fmac_f32 v169, v125, v125
    v_fmac_f32 v169, v126, v126
    v_mfma_f32_16x16x32_bf16 v[128:131], v[172:175], a[152:155], v[128:131]
    s_nop 0
    v_fmac_f32 v169, v127, v127
    v_fma_f32 v168, v216, v216, s32
    v_mfma_f32_16x16x32_bf16 v[128:131], v[148:151], a[156:159], v[128:131]
    s_nop 0
    v_fmac_f32 v168, v217, v217
    v_fmac_f32 v168, v218, v218
    v_mfma_f32_16x16x32_bf16 v[128:131], v[112:115], a[160:163], v[128:131]
    s_barrier
    v_fmac_f32 v168, v219, v219
    v_mfma_f32_16x16x32_bf16 v[128:131], v[228:231], a[164:167], v[128:131]
    s_cbranch_scc1 L_loop_safe3
    s_branch L_drain
L_edge:
    v_lshrrev_b32 v170, 6, v0
    v_mov_b32 v171, v0
    v_readfirstlane_b32 s16, v170
    v_mov_b32 v170, 0x40000000
    v_and_b32 v108, 63, v0
    s_bfe_u32 s3, s2, 0x50003
    s_lshl_b32 s4, s16, 3
    s_lshr_b32 s98, 0x00001236, s4
    s_and_b32 s98, s98, 0xff
    s_mul_i32 s3, s3, s98
    s_lshr_b32 s4, 0x00051135, s4
    s_and_b32 s4, s4, 0xff
    v_min_u32 v110, s4, v108
    v_add_lshl_u32 v110, v110, s3, 7
    v_mov_b32 v111, 0
    v_lshrrev_b32 v109, 4, v108
    v_and_b32 v120, 15, v108
    s_mov_b32 s10, 100270464
    s_mov_b32 s11, 0x00020000
    s_mov_b32 s46, 221184
    s_mov_b32 s47, 0x00020000
    v_mul_u32_u24 v121, 171, v108
    v_lshrrev_b32 v121, 10, v121
    v_lshrrev_b32 v122, 1, v121
    v_xor_b32 v122, v122, v121
    v_and_b32 v122, 4, v122
    v_mul_u32_u24 v122, 3, v122
    v_xor_b32 v122, v122, v121
    v_mul_u32_u24 v122, 1152, v122
    v_mul_u32_u24 v123, 96, v121
    v_sub_u32 v122, v122, v123
    v_lshl_add_u32 v123, v108, 4, v122
    v_add_u32 v122, 64, v108
    v_mul_u32_u24 v122, 171, v122
    v_lshrrev_b32 v122, 10, v122
    v_lshrrev_b32 v132, 1, v122
    v_xor_b32 v132, v132, v122
    v_and_b32 v132, 4, v132
    v_mul_u32_u24 v132, 3, v132
    v_xor_b32 v132, v132, v122
    v_mul_u32_u24 v132, 1152, v132
    v_mul_u32_u24 v133, 96, v122
    v_sub_u32 v132, v132, v133
    v_lshl_add_u32 v133, v108, 4, v132
    v_add_u32 v132, 128, v108
    v_mul_u32_u24 v132, 171, v132
    v_lshrrev_b32 v132, 10, v132
    v_lshrrev_b32 v134, 1, v132
    v_xor_b32 v134, v134, v132
    v_and_b32 v134, 4, v134
    v_mul_u32_u24 v134, 3, v134
    v_xor_b32 v134, v134, v132
    v_mul_u32_u24 v134, 1152, v134
    v_mul_u32_u24 v135, 96, v132
    v_sub_u32 v134, v134, v135
    v_lshl_add_u32 v135, v108, 4, v134
    s_mul_i32 s66, s16, 6144
    s_add_u32 s67, s66, 65536
    s_cmp_eq_u32 s16, 3
    s_cselect_b32 s66, 136704, s66
    s_cselect_b32 s67, 142848, s67
    s_mul_i32 s68, s16, 96
    s_mov_b32 s69, 193536
    s_mov_b32 s36, 100270464
    s_mov_b32 s22, 1180032
    s_mov_b32 s20, 0
    s_mov_b32 s38, 0
    s_sub_u32 s3, s2, 247
    s_and_b32 s3, s3, 3
    s_mul_i32 s3, s3, 7
    s_add_u32 s3, s3, 3
    s_mov_b32 s99, 196224
    s_cmp_lt_u32 s2, 251
    s_cselect_b32 s99, s99, 384
    s_cselect_b32 s6, 1, 0
    s_cselect_b32 s5, 0, 1
    s_mul_i32 s25, s3, s99
    s_mul_i32 s21, s99, 28
    s_cmp_lt_u32 s2, 255
    s_cselect_b32 s17, 18, 1
    s_cselect_b32 s25, s25, 0
    s_cselect_b32 s6, s6, 1
    s_add_u32 s7, s25, 1179648
    s_mul_i32 s3, s5, 99485568
    s_mul_i32 s99, s5, -784896
    v_mov_b32 v134, s3
    v_mov_b32 v136, s99
    s_add_u32 s7, s7, s99
    s_mul_i32 s3, s6, 194688
    s_mul_i32 s99, s6, -1536
    v_mov_b32 v137, s3
    v_mov_b32 v138, s99
    s_add_u32 s7, s7, s99
    v_mul_u32_u24 v139, 2731, v171
    v_bfe_u32 v140, v139, 17, 3
    v_lshrrev_b32 v139, 16, v139
    v_xor_b32 v141, v140, v171
    v_mul_u32_u24 v140, 37, v139
    v_lshrrev_b32 v140, 8, v140
    v_lshlrev_b32 v141, 4, v141
    v_mad_u32_u24 v10, v140, s69, v141
    v_mul_u32_u24 v140, 37, v139
    v_lshrrev_b32 v140, 8, v140
    v_mul_u32_u24 v142, 7, v140
    v_sub_u32 v142, v139, v142
    v_cmp_gt_u32 vcc, 4, v140
    s_nop 1
    v_cndmask_b32 v140, v136, v134, vcc
    v_cmp_gt_u32 vcc, 4, v142
    s_nop 1
    v_cndmask_b32 v142, v138, v137, vcc
    v_add3_u32 v10, v10, v140, v142
    v_mul_u32_u24 v140, s20, v139
    v_add_u32 v140, s38, v140
    v_mul_u32_u24 v140, 911, v140
    v_lshrrev_b32 v140, 16, v140
    v_mul_u32_u24 v140, s22, v140
    v_mad_u32_u24 v140, v139, s21, v140
    v_cmp_gt_u32 vcc, s17, v139
    v_add_u32 v140, s7, v140
    s_nop 0
    v_cndmask_b32 v140, v170, v140, vcc
    v_mul_u32_u24 v139, 384, v139
    v_sub_u32 v139, v141, v139
    v_add_u32 v140, v140, v139
    v_add_u32 v139, 256, v171
    v_mul_u32_u24 v141, 2731, v139
    v_bfe_u32 v142, v141, 17, 3
    v_lshrrev_b32 v141, 16, v141
    v_xor_b32 v139, v142, v139
    v_mul_u32_u24 v142, 37, v141
    v_lshrrev_b32 v142, 8, v142
    v_lshlrev_b32 v139, 4, v139
    v_mad_u32_u24 v11, v142, s69, v139
    v_mul_u32_u24 v142, 37, v141
    v_lshrrev_b32 v142, 8, v142
    v_mul_u32_u24 v143, 7, v142
    v_sub_u32 v143, v141, v143
    v_cmp_gt_u32 vcc, 4, v142
    s_nop 1
    v_cndmask_b32 v142, v136, v134, vcc
    v_cmp_gt_u32 vcc, 4, v143
    s_nop 1
    v_cndmask_b32 v143, v138, v137, vcc
    v_add3_u32 v11, v11, v142, v143
    v_mul_u32_u24 v142, s20, v141
    v_add_u32 v142, s38, v142
    v_mul_u32_u24 v142, 911, v142
    v_lshrrev_b32 v142, 16, v142
    v_mul_u32_u24 v142, s22, v142
    v_mad_u32_u24 v142, v141, s21, v142
    v_cmp_gt_u32 vcc, s17, v141
    v_add_u32 v142, s7, v142
    s_nop 0
    v_cndmask_b32 v142, v170, v142, vcc
    v_mul_u32_u24 v141, 384, v141
    v_sub_u32 v141, v139, v141
    v_add_u32 v142, v142, v141
    s_lshl_b32 s28, s16, 10
    s_add_u32 s28, s28, 20480
    s_waitcnt lgkmcnt(0)
    s_load_dwordx2 s[42:43], s[0:1], 72
    s_cmp_eq_u32 s16, 0
    s_cselect_b64 s[98:99], s[44:45], s[48:49]
    s_cmp_eq_u32 s16, 2
    s_cselect_b64 s[98:99], s[52:53], s[98:99]
    s_cmp_eq_u32 s16, 3
    s_cselect_b64 s[98:99], s[56:57], s[98:99]
    v_lshl_add_u64 v[110:111], s[98:99], 0, v[110:111]
    v_writelane_b32 v110, s60, 62
    v_writelane_b32 v111, s61, 62
    v_writelane_b32 v110, s64, 63
    v_writelane_b32 v111, s65, 63
    global_load_dword a254, v[110:111], off
    s_add_u32 m0, s66, 0
    s_add_u32 s4, s68, 384
    buffer_load_dwordx4 v123, s[44:47], s4 offen lds
    s_mov_b32 s50, 73728
    s_mov_b32 s51, 0x00020000
    s_mov_b32 s58, 64
    s_mov_b32 s59, 0x00020000
    buffer_load_dwordx4 v133, s[44:47], s4 offen offset:1024 lds
    s_mov_b32 s62, 128
    s_mov_b32 s63, 0x00020000
    s_mov_b32 s54, 676
    s_mov_b32 s55, 0x00020000
    buffer_load_dwordx4 v135, s[44:47], s4 offen offset:2048 lds
    s_add_u32 m0, s66, 3072
    s_add_u32 s4, s68, 37248
    s_mov_b32 s14, 0
    s_mov_b32 s15, 0x00020000
    buffer_load_dwordx4 v123, s[44:47], s4 offen lds
    v_mov_b32 v111, 0
    v_cmp_lt_u32 s[90:91], 7, v120
    s_mul_i32 s70, s16, 192
    s_mov_b32 s73, 0x3f80
    buffer_load_dwordx4 v133, s[44:47], s4 offen offset:1024 lds
    v_mov_b32 v139, 0
    v_mov_b32 v169, 0
    s_mov_b32 s19, s38
    s_mov_b32 s23, s25
    buffer_load_dwordx4 v135, s[44:47], s4 offen offset:2048 lds
    s_add_u32 m0, s28, 128512
    s_add_u32 s4, s68, 74112
    s_mov_b32 s26, 0
    s_mov_b32 s27, 0
    buffer_load_dwordx4 v140, s[8:11], 0 offen nt lds
    s_add_u32 m0, s28, 132608
    v_mov_b32 v140, s16
    v_lshlrev_b32 v140, 1, v140
    s_mov_b32 s18, 0
    s_add_u32 s19, s19, s20
    buffer_load_dwordx4 v142, s[8:11], 0 offen nt lds
    s_add_u32 m0, s28, 0
    v_mov_b32 v143, 0
    v_lshlrev_b32 v168, 1, v108
    s_add_u32 s23, s23, s21
    s_cmp_ge_u32 s19, 72
    buffer_load_dwordx4 v10, s[8:11], s25 offen nt lds
    v_mul_u32_u24 v141, 12, v120
    v_add_u32 v141, s70, v141
    v_lshlrev_b32 v142, 5, v109
    v_lshrrev_b32 v112, 2, v120
    v_and_b32 v113, 1, v112
    v_mul_u32_u24 v113, 0x020202, v113
    v_lshl_or_b32 v113, v113, 8, v113
    v_add_u32 v113, 0x05040100, v113
    v_and_b32 v114, 3, v120
    v_lshrrev_b32 v110, 1, v120
    v_xor_b32 v110, v110, v109
    v_mul_u32_u24 v115, 384, v120
    v_lshl_add_u32 v0, v110, 4, v115
    v_xor_b32 v1, 64, v0
    v_and_b32 v110, 2, v109
    v_add_u32 v110, v110, v109
    v_lshl_add_u32 v110, v110, 2, v112
    v_mul_u32_u24 v110, 96, v110
    v_lshl_add_u32 v110, v114, 3, v110
    v_add_u32 v115, s66, v110
    v_add_u32 v116, s67, v110
    v_mov_b32 v28, 0x3f803f80
    v_mov_b32 v29, 0x3f803f80
    v_mov_b32 v30, 0x3f803f80
    v_mov_b32 v31, 0x3f803f80
    v_mul_u32_u24 v117, 768, v109
    v_add_u32 v117, v141, v117
    v_add_u32 v117, 157184, v117
    v_and_b32 v110, 1, v120
    v_lshlrev_b32 v110, 4, v110
    v_lshlrev_b32 v118, v110, s73
    v_lshlrev_b32 v119, 4, v109
    s_cselect_b32 s34, 72, 0
    s_cselect_b32 s35, s22, 0
    s_add_u32 m0, s28, 4096
    s_sub_u32 s19, s19, s34
    s_add_u32 s23, s23, s35
    s_mov_b32 s24, s23
    s_add_u32 s19, s19, s20
    s_add_u32 s23, s23, s21
    s_cmp_ge_u32 s19, 72
    s_cselect_b32 s34, 72, 0
    s_cselect_b32 s35, s22, 0
    s_sub_u32 s19, s19, s34
    s_add_u32 s23, s23, s35
    s_mul_i32 s76, s16, 64
    v_lshl_add_u32 v124, v109, 4, s76
    s_mul_i32 s77, s16, 32
    s_add_u32 s77, s77, 256
    v_lshl_add_u32 v125, v109, 3, s77
    v_add_u32 v126, 0, v120
    v_mul_u32_u24 v127, 37, v126
    v_mul_u32_u24 v128, 384, v126
    v_lshrrev_b32 v127, 8, v127
    v_mad_u32_u24 v128, v127, s69, v128
    v_add_u32 v15, v128, v124
    v_add_u32 v18, v128, v125
    v_mul_u32_u24 v128, 37, v126
    v_lshrrev_b32 v128, 8, v128
    v_mul_u32_u24 v129, 7, v128
    v_sub_u32 v129, v126, v129
    v_add_u32 v130, 16, v120
    v_mul_u32_u24 v131, 37, v130
    v_mul_u32_u24 v144, 384, v130
    v_lshrrev_b32 v131, 8, v131
    v_mad_u32_u24 v144, v131, s69, v144
    v_add_u32 v16, v144, v124
    v_add_u32 v19, v144, v125
    v_mul_u32_u24 v144, 37, v130
    v_lshrrev_b32 v144, 8, v144
    v_mul_u32_u24 v145, 7, v144
    v_sub_u32 v145, v130, v145
    v_add_u32 v146, 32, v120
    v_mul_u32_u24 v147, 37, v146
    v_mul_u32_u24 v148, 384, v146
    v_lshrrev_b32 v147, 8, v147
    v_mad_u32_u24 v148, v147, s69, v148
    v_add_u32 v17, v148, v124
    v_add_u32 v20, v148, v125
    v_mul_u32_u24 v124, 37, v146
    v_lshrrev_b32 v124, 8, v124
    v_mul_u32_u24 v125, 7, v124
    v_sub_u32 v125, v146, v125
    s_mul_i32 s78, s16, 768
    s_add_u32 s78, s78, 157184
    v_mul_u32_u24 v127, 24, v127
    v_lshl_add_u32 v127, v126, 2, v127
    v_add_u32 v22, s78, v127
    v_sub_u32 v23, s78, v127
    v_sub_u32 v127, v22, v119
    v_mul_u32_u24 v131, 24, v131
    v_lshl_add_u32 v131, v130, 2, v131
    v_add_u32 v24, s78, v131
    v_sub_u32 v25, s78, v131
    v_sub_u32 v131, v24, v119
    v_mul_u32_u24 v147, 24, v147
    v_lshl_add_u32 v147, v146, 2, v147
    v_add_u32 v26, s78, v147
    v_sub_u32 v27, s78, v147
    v_sub_u32 v147, v26, v119
    v_mul_u32_u24 v148, 148, v109
    s_mov_b32 s79, -24
    v_add_u32 v149, 0, v148
    v_lshrrev_b32 v149, 8, v149
    v_mad_i32_i24 v40, v149, s79, v127
    v_mad_i32_i24 v52, v149, s79, v131
    v_mad_i32_i24 v64, v149, s79, v147
    v_add_u32 v149, 37, v148
    v_lshrrev_b32 v149, 8, v149
    v_mad_i32_i24 v41, v149, s79, v127
    v_mad_i32_i24 v53, v149, s79, v131
    v_mad_i32_i24 v65, v149, s79, v147
    v_add_u32 v149, 74, v148
    v_lshrrev_b32 v149, 8, v149
    v_mad_i32_i24 v42, v149, s79, v127
    v_mad_i32_i24 v54, v149, s79, v131
    v_mad_i32_i24 v66, v149, s79, v147
    v_add_u32 v149, 111, v148
    v_lshrrev_b32 v149, 8, v149
    v_mad_i32_i24 v43, v149, s79, v127
    v_mad_i32_i24 v55, v149, s79, v131
    v_mad_i32_i24 v67, v149, s79, v147
    v_add_u32 v149, 592, v148
    v_lshrrev_b32 v149, 8, v149
    v_mad_i32_i24 v44, v149, s79, v127
    v_mad_i32_i24 v56, v149, s79, v131
    v_mad_i32_i24 v68, v149, s79, v147
    v_add_u32 v149, 629, v148
    v_lshrrev_b32 v149, 8, v149
    v_mad_i32_i24 v45, v149, s79, v127
    v_mad_i32_i24 v57, v149, s79, v131
    v_mad_i32_i24 v69, v149, s79, v147
    v_add_u32 v149, 666, v148
    v_lshrrev_b32 v149, 8, v149
    v_mad_i32_i24 v46, v149, s79, v127
    v_mad_i32_i24 v58, v149, s79, v131
    v_mad_i32_i24 v70, v149, s79, v147
    v_add_u32 v149, 703, v148
    v_lshrrev_b32 v149, 8, v149
    v_mad_i32_i24 v47, v149, s79, v127
    v_mad_i32_i24 v59, v149, s79, v131
    v_mad_i32_i24 v71, v149, s79, v147
    v_add_u32 v149, 1184, v148
    v_lshrrev_b32 v149, 8, v149
    v_mad_i32_i24 v48, v149, s79, v127
    v_mad_i32_i24 v60, v149, s79, v131
    v_mad_i32_i24 v72, v149, s79, v147
    v_add_u32 v149, 1221, v148
    v_lshrrev_b32 v149, 8, v149
    v_mad_i32_i24 v49, v149, s79, v127
    v_mad_i32_i24 v61, v149, s79, v131
    v_mad_i32_i24 v73, v149, s79, v147
    v_add_u32 v149, 1258, v148
    v_lshrrev_b32 v149, 8, v149
    v_mad_i32_i24 v50, v149, s79, v127
    v_mad_i32_i24 v62, v149, s79, v131
    v_mad_i32_i24 v74, v149, s79, v147
    v_add_u32 v148, 1295, v148
    v_lshrrev_b32 v148, 8, v148
    v_mad_i32_i24 v51, v148, s79, v127
    v_mad_i32_i24 v63, v148, s79, v131
    v_mad_i32_i24 v75, v148, s79, v147
    v_mov_b32 v147, s78
    v_lshlrev_b32 v127, 4, v108
    v_xor_b32 v2, 65536, v127
    v_lshl_add_u32 v3, s16, 10, v127
    s_lshr_b32 s80, s16, 1
    s_and_b32 s81, s16, 1
    s_lshl_b32 s81, s81, 3
    s_lshl_b32 s82, s80, 10
    s_add_u32 s82, s82, s81
    v_add_u32 v4, s82, v127
    s_lshl_b32 s80, s80, 11
    s_add_u32 s80, s80, s81
    s_add_u32 s80, s80, 144896
    s_mul_i32 s83, s16, 2048
    s_add_u32 s83, s83, 136704
    v_lshl_add_u32 v127, v109, 3, s83
    v_mov_b32 v131, s80
    v_mov_b32 v148, 161536
    s_mul_i32 s84, s16, 8064
    s_add_u32 s84, s84, 104448
    s_mul_i32 s85, s16, 6528
    s_add_u32 s85, s85, 38912
    v_mul_u32_u24 v149, 80, v109
    v_add3_u32 v5, v149, v110, s84
    v_lshl_add_u32 v6, v120, 2, s85
    s_mul_i32 s86, s16, 128
    s_add_u32 s86, s86, 65024
    v_add_u32 v9, s86, v119
    v_lshrrev_b32 v110, 1, v109
    v_mul_u32_u24 v110, 48, v110
    v_lshl_add_u32 v110, v109, 3, v110
    v_lshl_add_u32 v110, v112, 4, v110
    v_lshl_add_u32 v110, v114, 1, v110
    v_add_u32 v8, s86, v110
    v_mov_b32 v37, 0
    v_mov_b32 v38, 0
    v_mov_b32 v39, 0
    s_mov_b32 s40, s8
    s_mov_b32 s41, s9
    s_mov_b32 s32, 0x2a8cbccc
    s_mov_b32 s33, 0x38fba882
    v_add_u32 v152, 148992, v0
    v_add_u32 v153, 148992, v1
    v_lshlrev_b32 v154, 4, v120
    v_add_u32 v154, 160256, v154
    v_mul_u32_u24 v155, 336, v120
    v_add3_u32 v155, v155, v149, s84
    v_mul_u32_u24 v156, 272, v120
    v_add3_u32 v156, v156, v119, s85
    v_mul_u32_u24 v157, 1088, v109
    v_add_u32 v157, v157, v6
    v_add_u32 v158, 5376, v155
    v_add_u32 v159, 4352, v156
    v_add_u32 v164, 4352, v157
    v_cmp_gt_u32 s[88:89], 16, v108
    v_mov_b32 v165, 0xf149f2ca
    v_add_u32 v110, 512, v171
    v_mul_u32_u24 v166, 2731, v110
    v_bfe_u32 v167, v166, 17, 3
    v_lshrrev_b32 v166, 16, v166
    v_xor_b32 v110, v167, v110
    v_mul_u32_u24 v167, 37, v166
    v_lshrrev_b32 v167, 8, v167
    v_lshlrev_b32 v110, 4, v110
    v_mad_u32_u24 v12, v167, s69, v110
    v_mul_u32_u24 v110, 37, v166
    v_lshrrev_b32 v110, 8, v110
    v_mul_u32_u24 v167, 7, v110
    v_sub_u32 v167, v166, v167
    v_cmp_gt_u32 vcc, 4, v110
    v_add_u32 v166, 768, v171
    v_mul_u32_u24 v149, 2731, v166
    v_cndmask_b32 v110, v136, v134, vcc
    v_cmp_gt_u32 vcc, 4, v167
    v_bfe_u32 v150, v149, 17, 3
    v_lshrrev_b32 v149, 16, v149
    v_cndmask_b32 v167, v138, v137, vcc
    v_add3_u32 v12, v12, v110, v167
    v_xor_b32 v166, v150, v166
    v_mul_u32_u24 v150, 37, v149
    v_lshrrev_b32 v150, 8, v150
    v_lshlrev_b32 v166, 4, v166
    v_mad_u32_u24 v13, v150, s69, v166
    v_mul_u32_u24 v110, 37, v149
    s_add_u32 s71, s28, 16384
    s_cmp_lt_u32 s16, 2
    buffer_load_dwordx4 v11, s[8:11], s25 offen nt lds
    v_lshrrev_b32 v110, 8, v110
    v_mul_u32_u24 v166, 7, v110
    v_sub_u32 v166, v149, v166
    v_cmp_gt_u32 vcc, 4, v110
    v_add_u32 v171, 1024, v171
    v_mul_u32_u24 v167, 2731, v171
    v_cndmask_b32 v110, v136, v134, vcc
    v_cmp_gt_u32 vcc, 4, v166
    v_bfe_u32 v149, v167, 17, 3
    v_lshrrev_b32 v167, 16, v167
    v_cndmask_b32 v166, v138, v137, vcc
    v_add3_u32 v13, v13, v110, v166
    v_xor_b32 v171, v149, v171
    v_mul_u32_u24 v149, 37, v167
    s_cselect_b32 s29, s71, 160256
    s_cselect_b32 s30, 65536, 0
    buffer_load_ushort v110, v168, s[56:59], 0 offen
    s_add_u32 m0, s67, 0
    s_xor_b32 s72, s29, s30
    s_lshl_b32 s92, s5, 1
    buffer_load_dwordx4 v123, s[44:47], s4 offen lds
    v_lshrrev_b32 v149, 8, v149
    v_lshlrev_b32 v171, 4, v171
    v_mad_u32_u24 v14, v149, s69, v171
    v_mul_u32_u24 v166, 37, v167
    v_lshrrev_b32 v166, 8, v166
    v_mul_u32_u24 v168, 7, v166
    v_sub_u32 v168, v167, v168
    v_cmp_gt_u32 vcc, 4, v166
    s_or_b32 s92, s92, s6
    v_mov_b32 v171, 0xc31044fe
    s_waitcnt vmcnt(9)
    s_mul_i32 s74, s16, 64
    ds_read_b64_tr_b16 a[72:73], v115 offset:0
    ds_read_b64_tr_b16 a[74:75], v115 offset:768
    ds_read_b64_tr_b16 a[96:97], v115 offset:32
    ds_read_b64_tr_b16 a[98:99], v115 offset:800
    buffer_load_dwordx4 v133, s[44:47], s4 offen offset:1024 lds
    ds_read_b64_tr_b16 a[120:121], v115 offset:64
    ds_read_b64_tr_b16 a[122:123], v115 offset:832
    v_cndmask_b32 v166, v136, v134, vcc
    v_cmp_gt_u32 vcc, 4, v168
    v_mul_u32_u24 v149, 37, v126
    v_lshrrev_b32 v149, 8, v149
    v_cndmask_b32 v168, v138, v137, vcc
    v_add3_u32 v14, v14, v166, v168
    v_cmp_gt_u32 vcc, 48, v167
    v_mul_u32_u24 v168, 7, v149
    v_sub_u32 v168, v126, v168
    v_cndmask_b32 v14, v170, v14, vcc
    v_cmp_gt_u32 vcc, 2, v114
    v_lshrrev_b32 v149, 2, v149
    s_mul_i32 s75, s16, 32
    s_add_u32 s75, s75, 192
    buffer_load_dwordx4 v135, s[44:47], s4 offen offset:2048 lds
    s_add_u32 m0, s67, 3072
    s_add_u32 s4, s68, 110976
    v_cndmask_b32 v32, 0, v118, vcc
    v_cndmask_b32 v33, v118, 0, vcc
    v_cndmask_b32 v34, 0, v118, vcc
    v_cndmask_b32 v35, v118, 0, vcc
    v_cmp_eq_u32 vcc, v109, v112
    v_lshrrev_b32 v168, 2, v168
    v_and_b32 v149, s5, v149
    v_cndmask_b32 v166, 0, v32, vcc
    v_cndmask_b32 v167, 0, v33, vcc
    v_and_b32 v168, s6, v168
    v_lshl_or_b32 v149, v149, 1, v168
    v_mul_u32_u24 v118, 37, v130
    s_add_u32 s34, s18, 2
    s_mov_b32 s27, s26
    buffer_load_dwordx4 v123, s[44:47], s4 offen lds
    v_lshrrev_b32 v118, 8, v118
    v_mul_u32_u24 v126, 7, v118
    v_sub_u32 v126, v130, v126
    v_lshrrev_b32 v118, 2, v118
    v_lshrrev_b32 v126, 2, v126
    v_and_b32 v118, s5, v118
    v_and_b32 v126, s6, v126
    s_waitcnt vmcnt(9)
    s_mov_b32 s26, s25
    ds_read_b64_tr_b16 a[76:77], v115 offset:3072
    ds_read_b64_tr_b16 a[78:79], v115 offset:3840
    ds_read_b64_tr_b16 a[100:101], v115 offset:3104
    ds_read_b64_tr_b16 a[102:103], v115 offset:3872
    ds_read_b64_tr_b16 a[124:125], v115 offset:3136
    ds_read_b64_tr_b16 a[126:127], v115 offset:3904
    s_add_u32 s19, s19, s20
    buffer_load_dwordx4 v133, s[44:47], s4 offen offset:1024 lds
    v_lshl_or_b32 v118, v118, 1, v126
    v_mul_u32_u24 v170, 37, v146
    v_lshrrev_b32 v170, 8, v170
    v_mul_u32_u24 v126, 7, v170
    v_sub_u32 v126, v146, v126
    v_lshrrev_b32 v170, 2, v170
    v_lshrrev_b32 v126, 2, v126
    v_and_b32 v170, s5, v170
    v_and_b32 v126, s6, v126
    v_lshl_or_b32 v170, v170, 1, v126
    v_mul_u32_u24 v126, 6, v121
    v_sub_u32 v130, v108, v126
    v_mul_u32_u24 v126, 384, v121
    v_lshl_add_u32 v126, v130, 4, v126
    v_add_u32 v121, s75, v126
    v_add_u32 v126, s74, v126
    v_cmp_gt_i32 vcc, 4, v130
    v_mul_u32_u24 v130, 6, v122
    v_sub_u32 v146, v108, v130
    v_cndmask_b32 v121, v121, v126, vcc
    v_mul_u32_u24 v130, 384, v122
    v_lshl_add_u32 v130, v146, 4, v130
    v_add_u32 v122, s75, v130
    v_add_u32 v130, s74, v130
    v_cmp_gt_i32 vcc, -60, v146
    v_mul_u32_u24 v126, 6, v132
    v_sub_u32 v108, v108, v126
    v_cndmask_b32 v122, v122, v130, vcc
    v_mul_u32_u24 v126, 384, v132
    v_lshl_add_u32 v126, v108, 4, v126
    v_add_u32 v130, s75, v126
    v_add_u32 v126, s74, v126
    v_cmp_gt_i32 vcc, -124, v108
    v_mul_u32_u24 v108, 96, v120
    v_add3_u32 v132, v108, v119, s66
    v_cndmask_b32 v146, v130, v126, vcc
    v_cmp_gt_u32 vcc, 4, v128
    v_lshl_add_u32 v180, v109, 3, v108
    v_add3_u32 v180, v180, 64, s66
    v_cndmask_b32 v128, v136, v134, vcc
    v_cmp_gt_u32 vcc, 4, v129
    v_add3_u32 v181, v108, v119, s67
    v_lshl_add_u32 v182, v109, 3, v108
    v_cndmask_b32 v129, v138, v137, vcc
    v_add3_u32 v15, v15, v128, v129
    v_add3_u32 v18, v18, v128, v129
    v_cmp_gt_u32 vcc, 4, v144
    v_add3_u32 v182, v182, 64, s67
    v_mov_b32 v160, 0
    v_cndmask_b32 v144, v136, v134, vcc
    v_cmp_gt_u32 vcc, 4, v145
    v_mov_b32 v161, 0
    v_mov_b32 v162, 0
    v_cndmask_b32 v145, v138, v137, vcc
    v_add3_u32 v16, v16, v144, v145
    v_add3_u32 v19, v19, v144, v145
    v_cmp_gt_u32 vcc, 4, v124
    v_mov_b32 v163, 0
    s_mov_b32 s18, 1
    v_cndmask_b32 v124, v136, v134, vcc
    v_cmp_gt_u32 vcc, 4, v125
    ds_write_b128 v155, v[160:163] offset:16
    s_nop 0
    v_cndmask_b32 v125, v138, v137, vcc
    v_add3_u32 v17, v17, v124, v125
    v_add3_u32 v20, v20, v124, v125
    v_cmp_gt_u32 vcc, 2, v109
    s_nop 0
    s_nop 0
    v_cndmask_b32 v127, v131, v127, vcc
    v_lshl_add_u32 v127, v112, 9, v127
    v_lshl_add_u32 v127, v114, 1, v127
    v_cmp_gt_u32 vcc, 3, v109
    ds_write_b64 v155, v[160:161] offset:56
    s_nop 0
    v_cndmask_b32 v7, v148, v127, vcc
    v_cmp_gt_u32 vcc, 8, v120
    ds_write_b64 v155, v[160:161] offset:64
    s_nop 0
    v_cndmask_b32 v158, v154, v158, vcc
    v_cndmask_b32 v159, v154, v159, vcc
    v_cmp_gt_u32 vcc, 2, v109
    ds_write_b128 v158, v[160:163] offset:16
    s_nop 0
    v_cndmask_b32 v164, v154, v164, vcc
    v_cmp_ne_u32 vcc, s92, v149
    s_nop 0
    s_nop 0
    v_cndmask_b32 v120, 0, v171, vcc
    v_cmp_ne_u32 vcc, s92, v149
    ds_write_b64 v158, v[160:161] offset:56
    s_nop 0
    v_cndmask_b32 v134, 0, v171, vcc
    v_cmp_ne_u32 vcc, s92, v118
    ds_write_b64 v158, v[160:161] offset:64
    s_nop 0
    v_cndmask_b32 v154, 0, v171, vcc
    v_cmp_ne_u32 vcc, s92, v118
    s_nop 0
    s_nop 0
    v_cndmask_b32 v183, 0, v171, vcc
    v_cmp_ne_u32 vcc, s92, v170
    s_nop 0
    s_nop 0
    v_cndmask_b32 v144, 0, v171, vcc
    v_cmp_ne_u32 vcc, s92, v170
    s_nop 0
    s_nop 0
    v_cndmask_b32 v145, 0, v171, vcc
    buffer_load_dwordx4 v135, s[44:47], s4 offen offset:2048 lds
    s_add_u32 m0, s66, 0
    s_add_u32 s4, s68, 147840
    s_waitcnt lgkmcnt(0)
    buffer_load_dwordx3 v[124:126], v141, s[52:55], 0 offen
    buffer_load_dwordx4 v[128:131], v142, s[60:63], 0 offen
    buffer_load_dwordx4 v[160:163], v142, s[60:63], 0 offen offset:16
    s_waitcnt vmcnt(10)
    s_barrier
    global_load_ushort v140, v140, s[64:65]
    buffer_load_dwordx4 v123, s[44:47], s4 offen lds
    buffer_load_dwordx4 v133, s[44:47], s4 offen offset:1024 lds
    s_waitcnt vmcnt(9)
    ds_read_b64_tr_b16 a[80:81], v116 offset:0
    ds_read_b64_tr_b16 a[82:83], v116 offset:768
    buffer_load_dwordx4 v135, s[44:47], s4 offen offset:2048 lds
    ds_read_b64_tr_b16 a[104:105], v116 offset:32
    ds_read_b64_tr_b16 a[106:107], v116 offset:800
    ds_read_b64_tr_b16 a[128:129], v116 offset:64
    ds_read_b64_tr_b16 a[130:131], v116 offset:832
    s_add_u32 m0, s66, 3072
    s_add_u32 s4, s68, 184704
    buffer_load_dwordx4 v123, s[44:47], s4 offen lds
    buffer_load_dwordx4 v133, s[44:47], s4 offen offset:1024 lds
    s_waitcnt vmcnt(9)
    ds_read_b64_tr_b16 a[84:85], v116 offset:3072
    ds_read_b64_tr_b16 a[86:87], v116 offset:3840
    s_waitcnt vmcnt(8)
    ds_read_b64_tr_b16 a[108:109], v116 offset:3104
    s_waitcnt vmcnt(7)
    buffer_load_dwordx4 v135, s[44:47], s4 offen offset:2048 lds
    ds_read_b64_tr_b16 a[110:111], v116 offset:3872
    ds_read_b64_tr_b16 a[132:133], v116 offset:3136
    ds_read_b64_tr_b16 a[134:135], v116 offset:3904
    s_add_u32 m0, s67, 0
    s_waitcnt lgkmcnt(6)
    s_add_u32 s4, s68, 36864
    v_cndmask_b32 v128, v128, v129, s[90:91]
    v_cndmask_b32 v130, v130, v131, s[90:91]
    v_perm_b32 v112, v130, v128, v113
    v_bfe_u32 v138, v124, v119, 16
    v_bfe_u32 v168, v125, v119, 16
    v_bfe_u32 v142, v126, v119, 16
    v_mfma_f32_16x16x16_bf16 v[124:127], v[110:111], v[138:139], 0
    v_mfma_f32_16x16x16_bf16 v[128:131], v[110:111], v[168:169], 0
    s_waitcnt vmcnt(7)
    s_waitcnt vmcnt(6)
    v_cndmask_b32 v160, v160, v161, s[90:91]
    v_mfma_f32_16x16x16_bf16 v[136:139], v[110:111], v[142:143], 0
    buffer_load_dwordx4 v123, s[44:47], s68 offen lds
    v_cndmask_b32 v162, v162, v163, s[90:91]
    v_perm_b32 v113, v162, v160, v113
    v_max_f32 v124, 0, v124
    v_max_f32 v125, 0, v125
    v_max_f32 v126, 0, v126
    v_max_f32 v127, 0, v127
    v_cvt_pk_bf16_f32 v168, v124, v125
    v_cvt_pk_bf16_f32 v169, v126, v127
    v_max_f32 v128, 0, v128
    v_max_f32 v129, 0, v129
    v_mfma_f32_16x16x16_bf16 v[124:127], v[112:113], v[168:169], 0
    v_max_f32 v130, 0, v130
    v_max_f32 v131, 0, v131
    v_cvt_pk_bf16_f32 v168, v128, v129
    buffer_load_dwordx4 v133, s[44:47], s68 offen offset:1024 lds
    v_cvt_pk_bf16_f32 v169, v130, v131
    v_max_f32 v136, 0, v136
    v_max_f32 v137, 0, v137
    v_mfma_f32_16x16x16_bf16 v[128:131], v[112:113], v[168:169], 0
    v_cvt_pk_bf16_f32 v124, v124, v124
    v_and_b32 v124, 0xffff0000, v124
    v_mul_f32 v124, 0xbfb8aa3b, v124
    v_exp_f32 v124, v124
    v_max_f32 v138, 0, v138
    v_add_f32 v124, 1.0, v124
    v_rcp_f32 v124, v124
    v_max_f32 v139, 0, v139
    buffer_load_dwordx4 v135, s[44:47], s68 offen offset:2048 lds
    s_add_u32 m0, s67, 3072
    s_waitcnt lgkmcnt(0)
    v_cvt_pk_bf16_f32 v124, v124, v124
    v_and_b32 v124, 0xffff0000, v124
    v_add_f32 v124, -0.5, v124
    v_mul_f32 v124, 0x41b8aa3b, v124
    ds_write_b32 v117, v124 offset:0
    s_waitcnt vmcnt(6)
    ds_read_b64_tr_b16 a[88:89], v115 offset:0
    ds_read_b64_tr_b16 a[90:91], v115 offset:768
    ds_read_b64_tr_b16 a[112:113], v115 offset:32
    buffer_load_dwordx4 v123, s[44:47], s4 offen lds
    ds_read_b64_tr_b16 a[114:115], v115 offset:800
    ds_read_b64_tr_b16 a[136:137], v115 offset:64
    ds_read_b64_tr_b16 a[138:139], v115 offset:832
    v_cvt_pk_bf16_f32 v128, v128, v128
    v_and_b32 v128, 0xffff0000, v128
    v_mul_f32 v128, 0xbfb8aa3b, v128
    v_exp_f32 v128, v128
    v_cvt_pk_bf16_f32 v168, v136, v137
    v_add_f32 v128, 1.0, v128
    v_rcp_f32 v128, v128
    v_cvt_pk_bf16_f32 v169, v138, v139
    v_cvt_pk_bf16_f32 v128, v128, v128
    buffer_load_dwordx4 v133, s[44:47], s4 offen offset:1024 lds
    v_mfma_f32_16x16x16_bf16 v[124:127], v[112:113], v[168:169], 0
    v_and_b32 v128, 0xffff0000, v128
    v_add_f32 v128, -0.5, v128
    v_mul_f32 v128, 0x41b8aa3b, v128
    ds_write_b32 v117, v128 offset:4
    v_lshlrev_b32 v140, 16, v140
    v_max_f32 v140, 0xc2c80000, v140
    v_min_f32 v140, 0x40930000, v140
    v_mul_f32 v140, 0x3fb8aa3b, v140
    v_cvt_pk_bf16_f32 v124, v124, v124
    v_and_b32 v124, 0xffff0000, v124
    buffer_load_dwordx4 v135, s[44:47], s4 offen offset:2048 lds
    s_add_u32 m0, s66, 0
    s_add_u32 s4, s68, 73728
    s_waitcnt lgkmcnt(1)
    v_mul_f32 v124, 0xbfb8aa3b, v124
    v_exp_f32 v124, v124
    v_exp_f32 v140, v140
    v_add_f32 v124, 1.0, v124
    s_waitcnt vmcnt(6)
    ds_read_b64_tr_b16 a[92:93], v115 offset:3072
    ds_read_b64_tr_b16 a[94:95], v115 offset:3840
    ds_read_b64_tr_b16 a[116:117], v115 offset:3104
    ds_read_b64_tr_b16 a[118:119], v115 offset:3872
    ds_read_b64_tr_b16 a[140:141], v115 offset:3136
    buffer_load_dwordx4 v123, s[44:47], s4 offen lds
    ds_read_b64_tr_b16 a[142:143], v115 offset:3904
    v_rcp_f32 v124, v124
    v_cvt_pk_bf16_f32 v140, v140, v140
    v_cvt_pk_bf16_f32 v124, v124, v124
    v_and_b32 v124, 0xffff0000, v124
    v_add_f32 v124, -0.5, v124
    v_mul_f32 v124, 0x41b8aa3b, v124
    ds_write_b32 v117, v124 offset:8
    v_and_b32 v140, 0xffff0000, v140
    v_mul_f32 v117, 0x3fb8aa3b, v140
    buffer_load_dwordx4 v133, s[44:47], s4 offen offset:1024 lds
    v_readfirstlane_b32 s37, v140
    v_readfirstlane_b32 s31, v117
    buffer_load_dwordx4 v135, s[44:47], s4 offen offset:2048 lds
    s_add_u32 m0, s66, 3072
    s_add_u32 s4, s68, 110592
    s_waitcnt lgkmcnt(0)
    s_barrier
    ds_read_b32 v22, v22 offset:0
    ds_read_b32 v23, v23 offset:672
    ds_read_b32 v24, v24 offset:0
    ds_read_b32 v25, v25 offset:672
    ds_read_b32 v26, v26 offset:0
    ds_read_b32 v27, v27 offset:672
    ds_read_b32 v40, v40 offset:336
    ds_read_b32 v52, v52 offset:336
    ds_read_b32 v64, v64 offset:336
    buffer_load_dwordx4 v123, s[44:47], s4 offen lds
    s_waitcnt vmcnt(7)
    ds_read_b64_tr_b16 a[0:1], v116 offset:0
    ds_read_b64_tr_b16 a[2:3], v116 offset:768
    ds_read_b64_tr_b16 a[24:25], v116 offset:32
    ds_read_b64_tr_b16 a[26:27], v116 offset:800
    ds_read_b64_tr_b16 a[48:49], v116 offset:64
    ds_read_b64_tr_b16 a[50:51], v116 offset:832
    ds_read_b32 v41, v41 offset:332
    ds_read_b32 v53, v53 offset:332
    ds_read_b32 v65, v65 offset:332
    s_waitcnt lgkmcnt(15)
    buffer_load_dwordx4 v133, s[44:47], s4 offen offset:1024 lds
    s_waitcnt lgkmcnt(13)
    s_waitcnt lgkmcnt(12)
    ds_read_b32 v42, v42 offset:328
    ds_read_b32 v54, v54 offset:328
    ds_read_b32 v66, v66 offset:328
    ds_read_b32 v43, v43 offset:324
    ds_read_b32 v55, v55 offset:324
    ds_read_b32 v67, v67 offset:324
    ds_read_b32 v44, v44 offset:272
    ds_read_b32 v56, v56 offset:272
    ds_read_b32 v68, v68 offset:272
    buffer_load_dwordx4 v135, s[44:47], s4 offen offset:2048 lds
    ds_read_b32 v45, v45 offset:268
    ds_read_b32 v57, v57 offset:268
    ds_read_b32 v69, v69 offset:268
    ds_read_b32 v46, v46 offset:264
    s_add_u32 m0, s67, 0
    ds_read_b32 v58, v58 offset:264
    s_add_u32 s4, s68, 147456
    s_waitcnt lgkmcnt(14)
    ds_read_b32 v70, v70 offset:264
    ds_read_b32 v47, v47 offset:260
    ds_read_b32 v59, v59 offset:260
    ds_read_b32 v71, v71 offset:260
    buffer_load_dwordx4 v123, s[44:47], s4 offen lds
    s_waitcnt vmcnt(7)
    ds_read_b64_tr_b16 a[4:5], v116 offset:3072
    ds_read_b64_tr_b16 a[6:7], v116 offset:3840
    ds_read_b64_tr_b16 a[28:29], v116 offset:3104
    ds_read_b64_tr_b16 a[30:31], v116 offset:3872
    ds_read_b64_tr_b16 a[52:53], v116 offset:3136
    ds_read_b64_tr_b16 a[54:55], v116 offset:3904
    ds_read_b32 v48, v48 offset:208
    ds_read_b32 v60, v60 offset:208
    ds_read_b32 v72, v72 offset:208
    buffer_load_dwordx4 v133, s[44:47], s4 offen offset:1024 lds
    ds_read_b32 v49, v49 offset:204
    ds_read_b32 v61, v61 offset:204
    ds_read_b32 v73, v73 offset:204
    ds_read_b32 v50, v50 offset:200
    ds_read_b32 v62, v62 offset:200
    ds_read_b32 v74, v74 offset:200
    ds_read_b32 v51, v51 offset:196
    ds_read_b32 v63, v63 offset:196
    ds_read_b32 v75, v75 offset:196
    buffer_load_dwordx4 v135, s[44:47], s4 offen offset:2048 lds
    ds_read_b32 v147, v147 offset:336
    s_add_u32 m0, s67, 3072
    s_add_u32 s4, s68, 184320
    s_waitcnt lgkmcnt(11)
    v_add_f32 v22, v22, v120
    v_add_f32 v23, v23, v134
    v_add_f32 v24, v24, v154
    v_add_f32 v25, v25, v183
    v_add_f32 v26, v26, v144
    v_add_f32 v27, v27, v145
    v_lshl_add_u32 v120, v109, 2, 0
    v_mul_u32_u24 v134, 37, v120
    v_lshrrev_b32 v134, 8, v134
    v_mul_u32_u24 v154, 7, v134
    buffer_load_dwordx4 v123, s[44:47], s4 offen lds
    s_waitcnt vmcnt(7)
    ds_read_b64_tr_b16 a[8:9], v115 offset:0
    ds_read_b64_tr_b16 a[10:11], v115 offset:768
    ds_read_b64_tr_b16 a[32:33], v115 offset:32
    ds_read_b64_tr_b16 a[34:35], v115 offset:800
    ds_read_b64_tr_b16 a[56:57], v115 offset:64
    ds_read_b64_tr_b16 a[58:59], v115 offset:832
    v_sub_u32 v154, v120, v154
    v_lshrrev_b32 v134, 2, v134
    v_lshrrev_b32 v154, 2, v154
    s_waitcnt lgkmcnt(6)
    v_readfirstlane_b32 s39, v147
    v_and_b32 v134, s5, v134
    v_and_b32 v154, s6, v154
    buffer_load_dwordx4 v133, s[44:47], s4 offen offset:1024 lds
    v_lshl_or_b32 v134, v134, 1, v154
    v_cmp_ne_u32 vcc, v134, v149
    v_lshl_add_u32 v120, v109, 2, 1
    v_mul_u32_u24 v154, 37, v120
    v_cndmask_b32 v183, 0, v171, vcc
    v_add_f32 v40, v40, v183
    v_cmp_ne_u32 vcc, v134, v118
    v_lshrrev_b32 v154, 8, v154
    v_mul_u32_u24 v183, 7, v154
    v_cndmask_b32 v117, 0, v171, vcc
    v_add_f32 v52, v52, v117
    v_cmp_ne_u32 vcc, v134, v170
    v_sub_u32 v183, v120, v183
    v_lshrrev_b32 v154, 2, v154
    buffer_load_dwordx4 v135, s[44:47], s4 offen offset:2048 lds
    s_add_u32 m0, s66, 0
    s_add_u32 s4, s68, 768
    s_waitcnt lgkmcnt(0)
    v_cndmask_b32 v120, 0, v171, vcc
    v_add_f32 v64, v64, v120
    v_lshrrev_b32 v183, 2, v183
    v_and_b32 v154, s5, v154
    v_and_b32 v183, s6, v183
    v_lshl_or_b32 v154, v154, 1, v183
    v_cmp_ne_u32 vcc, v154, v149
    v_lshl_add_u32 v120, v109, 2, 2
    v_mul_u32_u24 v134, 37, v120
    v_cndmask_b32 v183, 0, v171, vcc
    v_add_f32 v41, v41, v183
    buffer_load_dwordx4 v123, s[44:47], s4 offen lds
    s_waitcnt vmcnt(7)
    ds_read_b64_tr_b16 a[12:13], v115 offset:3072
    ds_read_b64_tr_b16 a[14:15], v115 offset:3840
    ds_read_b64_tr_b16 a[36:37], v115 offset:3104
    ds_read_b64_tr_b16 a[38:39], v115 offset:3872
    ds_read_b64_tr_b16 a[60:61], v115 offset:3136
    ds_read_b64_tr_b16 a[62:63], v115 offset:3904
    v_cmp_ne_u32 vcc, v154, v118
    v_lshrrev_b32 v134, 8, v134
    v_mul_u32_u24 v183, 7, v134
    v_cndmask_b32 v117, 0, v171, vcc
    v_add_f32 v53, v53, v117
    v_cmp_ne_u32 vcc, v154, v170
    v_sub_u32 v183, v120, v183
    buffer_load_dwordx4 v133, s[44:47], s4 offen offset:1024 lds
    v_cndmask_b32 v120, 0, v171, vcc
    v_add_f32 v65, v65, v120
    v_lshrrev_b32 v134, 2, v134
    v_lshrrev_b32 v183, 2, v183
    v_and_b32 v134, s5, v134
    v_and_b32 v183, s6, v183
    v_lshl_or_b32 v134, v134, 1, v183
    v_cmp_ne_u32 vcc, v134, v149
    v_lshl_add_u32 v120, v109, 2, 3
    v_mul_u32_u24 v154, 37, v120
    v_cndmask_b32 v183, 0, v171, vcc
    v_add_f32 v42, v42, v183
    v_cmp_ne_u32 vcc, v134, v118
    v_lshrrev_b32 v154, 8, v154
    buffer_load_dwordx4 v135, s[44:47], s4 offen offset:2048 lds
    s_add_u32 m0, s66, 3072
    s_add_u32 s4, s68, 37632
    s_waitcnt lgkmcnt(0)
    v_cndmask_b32 v183, 0, v171, vcc
    v_add_f32 v54, v54, v183
    v_cmp_ne_u32 vcc, v134, v170
    v_mul_u32_u24 v134, 7, v154
    v_sub_u32 v134, v120, v134
    v_cndmask_b32 v120, 0, v171, vcc
    v_add_f32 v66, v66, v120
    v_lshrrev_b32 v154, 2, v154
    v_lshrrev_b32 v134, 2, v134
    v_and_b32 v154, s5, v154
    v_and_b32 v134, s6, v134
    buffer_load_dwordx4 v123, s[44:47], s4 offen lds
    s_waitcnt vmcnt(7)
    ds_read_b64_tr_b16 a[16:17], v116 offset:0
    ds_read_b64_tr_b16 a[18:19], v116 offset:768
    ds_read_b64_tr_b16 a[40:41], v116 offset:32
    ds_read_b64_tr_b16 a[42:43], v116 offset:800
    ds_read_b64_tr_b16 a[64:65], v116 offset:64
    ds_read_b64_tr_b16 a[66:67], v116 offset:832
    v_lshl_or_b32 v154, v154, 1, v134
    v_cmp_ne_u32 vcc, v154, v149
    v_lshl_add_u32 v120, v109, 2, 16
    v_mul_u32_u24 v134, 37, v120
    v_cndmask_b32 v183, 0, v171, vcc
    v_add_f32 v43, v43, v183
    v_cmp_ne_u32 vcc, v154, v118
    buffer_load_dwordx4 v133, s[44:47], s4 offen offset:1024 lds
    v_lshrrev_b32 v134, 8, v134
    v_cndmask_b32 v183, 0, v171, vcc
    v_add_f32 v55, v55, v183
    v_cmp_ne_u32 vcc, v154, v170
    v_mul_u32_u24 v154, 7, v134
    v_sub_u32 v154, v120, v154
    v_cndmask_b32 v120, 0, v171, vcc
    v_add_f32 v67, v67, v120
    v_lshrrev_b32 v134, 2, v134
    v_lshrrev_b32 v154, 2, v154
    v_and_b32 v134, s5, v134
    v_and_b32 v154, s6, v154
    v_lshl_or_b32 v134, v134, 1, v154
    v_cmp_ne_u32 vcc, v134, v149
    buffer_load_dwordx4 v135, s[44:47], s4 offen offset:2048 lds
    s_add_u32 m0, s67, 0
    s_add_u32 s4, s68, 74496
    s_waitcnt lgkmcnt(0)
    v_cndmask_b32 v120, 0, v171, vcc
    v_add_f32 v44, v44, v120
    v_cmp_ne_u32 vcc, v134, v118
    v_lshl_add_u32 v120, v109, 2, 17
    v_mul_u32_u24 v154, 37, v120
    v_cndmask_b32 v183, 0, v171, vcc
    v_add_f32 v56, v56, v183
    v_cmp_ne_u32 vcc, v134, v170
    v_lshrrev_b32 v154, 8, v154
    v_mul_u32_u24 v134, 7, v154
    v_cndmask_b32 v183, 0, v171, vcc
    buffer_load_dwordx4 v123, s[44:47], s4 offen lds
    s_waitcnt vmcnt(7)
    ds_read_b64_tr_b16 a[20:21], v116 offset:3072
    ds_read_b64_tr_b16 a[22:23], v116 offset:3840
    ds_read_b64_tr_b16 a[44:45], v116 offset:3104
    ds_read_b64_tr_b16 a[46:47], v116 offset:3872
    ds_read_b64_tr_b16 a[68:69], v116 offset:3136
    ds_read_b64_tr_b16 a[70:71], v116 offset:3904
    v_add_f32 v68, v68, v183
    v_sub_u32 v134, v120, v134
    v_lshrrev_b32 v154, 2, v154
    v_lshrrev_b32 v134, 2, v134
    v_and_b32 v154, s5, v154
    v_and_b32 v134, s6, v134
    v_lshl_or_b32 v154, v154, 1, v134
    buffer_load_dwordx4 v133, s[44:47], s4 offen offset:1024 lds
    v_cmp_ne_u32 vcc, v154, v149
    v_lshl_add_u32 v120, v109, 2, 18
    v_mul_u32_u24 v134, 37, v120
    v_cndmask_b32 v183, 0, v171, vcc
    v_add_f32 v45, v45, v183
    v_cmp_ne_u32 vcc, v154, v118
    v_lshrrev_b32 v134, 8, v134
    v_mul_u32_u24 v183, 7, v134
    v_cndmask_b32 v117, 0, v171, vcc
    v_add_f32 v57, v57, v117
    v_cmp_ne_u32 vcc, v154, v170
    v_sub_u32 v183, v120, v183
    v_lshrrev_b32 v134, 2, v134
    v_cndmask_b32 v120, 0, v171, vcc
    buffer_load_dwordx4 v135, s[44:47], s4 offen offset:2048 lds
    s_add_u32 m0, s67, 3072
    s_add_u32 s4, s68, 111360
    s_waitcnt lgkmcnt(0)
    v_add_f32 v69, v69, v120
    v_lshrrev_b32 v183, 2, v183
    v_and_b32 v134, s5, v134
    v_and_b32 v183, s6, v183
    v_lshl_or_b32 v134, v134, 1, v183
    v_cmp_ne_u32 vcc, v134, v149
    v_lshl_add_u32 v120, v109, 2, 19
    v_mul_u32_u24 v154, 37, v120
    v_cndmask_b32 v183, 0, v171, vcc
    v_add_f32 v46, v46, v183
    v_cmp_ne_u32 vcc, v134, v118
    buffer_load_dwordx4 v123, s[44:47], s4 offen lds
    s_waitcnt vmcnt(7)
    ds_read_b64_tr_b16 a[144:145], v115 offset:0
    ds_read_b64_tr_b16 a[146:147], v115 offset:768
    ds_read_b64_tr_b16 a[168:169], v115 offset:32
    ds_read_b64_tr_b16 a[170:171], v115 offset:800
    ds_read_b64_tr_b16 a[192:193], v115 offset:64
    ds_read_b64_tr_b16 a[194:195], v115 offset:832
    v_cndmask_b32 v183, 0, v171, vcc
    v_add_f32 v58, v58, v183
    v_cmp_ne_u32 vcc, v134, v170
    v_lshrrev_b32 v154, 8, v154
    v_mul_u32_u24 v134, 7, v154
    v_cndmask_b32 v183, 0, v171, vcc
    v_add_f32 v70, v70, v183
    buffer_load_dwordx4 v133, s[44:47], s4 offen offset:1024 lds
    v_sub_u32 v134, v120, v134
    v_lshrrev_b32 v154, 2, v154
    v_lshrrev_b32 v134, 2, v134
    v_and_b32 v154, s5, v154
    v_and_b32 v134, s6, v134
    v_lshl_or_b32 v154, v154, 1, v134
    v_cmp_ne_u32 vcc, v154, v149
    v_lshl_add_u32 v120, v109, 2, 32
    v_mul_u32_u24 v134, 37, v120
    v_cndmask_b32 v183, 0, v171, vcc
    v_add_f32 v47, v47, v183
    v_cmp_ne_u32 vcc, v154, v118
    v_lshrrev_b32 v134, 8, v134
    v_mul_u32_u24 v183, 7, v134
    buffer_load_dwordx4 v135, s[44:47], s4 offen offset:2048 lds
    s_add_u32 m0, s66, 0
    s_add_u32 s4, s68, 148224
    s_waitcnt lgkmcnt(0)
    v_cndmask_b32 v117, 0, v171, vcc
    v_add_f32 v59, v59, v117
    v_cmp_ne_u32 vcc, v154, v170
    v_sub_u32 v183, v120, v183
    v_lshrrev_b32 v134, 2, v134
    v_cndmask_b32 v120, 0, v171, vcc
    v_add_f32 v71, v71, v120
    v_lshrrev_b32 v183, 2, v183
    v_and_b32 v134, s5, v134
    v_and_b32 v183, s6, v183
    v_lshl_or_b32 v134, v134, 1, v183
    buffer_load_dwordx4 v123, s[44:47], s4 offen lds
    s_waitcnt vmcnt(7)
    ds_read_b64_tr_b16 a[148:149], v115 offset:3072
    ds_read_b64_tr_b16 a[150:151], v115 offset:3840
    ds_read_b64_tr_b16 a[172:173], v115 offset:3104
    ds_read_b64_tr_b16 a[174:175], v115 offset:3872
    ds_read_b64_tr_b16 a[196:197], v115 offset:3136
    ds_read_b64_tr_b16 a[198:199], v115 offset:3904
    v_cmp_ne_u32 vcc, v134, v149
    v_lshl_add_u32 v120, v109, 2, 33
    v_mul_u32_u24 v154, 37, v120
    v_cndmask_b32 v183, 0, v171, vcc
    v_add_f32 v48, v48, v183
    v_cmp_ne_u32 vcc, v134, v118
    v_lshrrev_b32 v154, 8, v154
    buffer_load_dwordx4 v133, s[44:47], s4 offen offset:1024 lds
    v_cndmask_b32 v183, 0, v171, vcc
    v_add_f32 v60, v60, v183
    v_cmp_ne_u32 vcc, v134, v170
    v_mul_u32_u24 v134, 7, v154
    v_sub_u32 v134, v120, v134
    v_cndmask_b32 v120, 0, v171, vcc
    v_add_f32 v72, v72, v120
    v_lshrrev_b32 v154, 2, v154
    v_lshrrev_b32 v134, 2, v134
    v_and_b32 v154, s5, v154
    v_and_b32 v134, s6, v134
    v_lshl_or_b32 v154, v154, 1, v134
    v_cmp_ne_u32 vcc, v154, v149
    v_lshl_add_u32 v120, v109, 2, 34
    buffer_load_dwordx4 v135, s[44:47], s4 offen offset:2048 lds
    s_add_u32 m0, s66, 3072
    s_add_u32 s4, s68, 185088
    s_waitcnt lgkmcnt(0)
    v_cndmask_b32 v134, 0, v171, vcc
    v_add_f32 v49, v49, v134
    v_cmp_ne_u32 vcc, v154, v118
    v_mul_u32_u24 v183, 37, v120
    v_lshrrev_b32 v183, 8, v183
    v_cndmask_b32 v134, 0, v171, vcc
    v_add_f32 v61, v61, v134
    v_cmp_ne_u32 vcc, v154, v170
    v_mul_u32_u24 v134, 7, v183
    v_sub_u32 v134, v120, v134
    v_cndmask_b32 v154, 0, v171, vcc
    buffer_load_dwordx4 v123, s[44:47], s4 offen lds
    s_waitcnt vmcnt(7)
    ds_read_b64_tr_b16 a[152:153], v116 offset:0
    ds_read_b64_tr_b16 a[154:155], v116 offset:768
    ds_read_b64_tr_b16 a[176:177], v116 offset:32
    ds_read_b64_tr_b16 a[178:179], v116 offset:800
    ds_read_b64_tr_b16 a[200:201], v116 offset:64
    ds_read_b64_tr_b16 a[202:203], v116 offset:832
    v_add_f32 v73, v73, v154
    v_lshrrev_b32 v183, 2, v183
    v_lshrrev_b32 v134, 2, v134
    v_and_b32 v183, s5, v183
    v_and_b32 v134, s6, v134
    v_lshl_or_b32 v183, v183, 1, v134
    v_cmp_ne_u32 vcc, v183, v149
    buffer_load_dwordx4 v133, s[44:47], s4 offen offset:1024 lds
    v_lshl_add_u32 v154, v109, 2, 35
    v_cndmask_b32 v117, 0, v171, vcc
    v_add_f32 v50, v50, v117
    v_cmp_ne_u32 vcc, v183, v118
    v_mul_u32_u24 v120, 37, v154
    v_lshrrev_b32 v120, 8, v120
    v_cndmask_b32 v123, 0, v171, vcc
    v_add_f32 v62, v62, v123
    v_cmp_ne_u32 vcc, v183, v170
    v_mul_u32_u24 v123, 7, v120
    v_sub_u32 v123, v154, v123
    v_cndmask_b32 v154, 0, v171, vcc
    v_add_f32 v74, v74, v154
    v_lshrrev_b32 v120, 2, v120
    buffer_load_dwordx4 v135, s[44:47], s4 offen offset:2048 lds
    s_add_u32 m0, s28, 8192
    s_add_u32 s4, 0, 12288
    v_lshrrev_b32 v123, 2, v123
    v_and_b32 v120, s5, v120
    v_and_b32 v123, s6, v123
    v_lshl_or_b32 v120, v120, 1, v123
    v_cmp_ne_u32 vcc, v120, v149
    v_cndmask_b32 v22, v165, v22, s[88:89]
    v_cndmask_b32 v24, v165, v24, s[88:89]
    v_cndmask_b32 v123, 0, v171, vcc
    v_add_f32 v51, v51, v123
    v_cmp_ne_u32 vcc, v120, v118
    v_cndmask_b32 v26, v165, v26, s[88:89]
    s_nop 0
    buffer_load_dwordx4 v12, s[8:11], s25 offen nt lds
    s_waitcnt vmcnt(7)
    ds_read_b64_tr_b16 a[156:157], v116 offset:3072
    ds_read_b64_tr_b16 a[158:159], v116 offset:3840
    ds_read_b64_tr_b16 a[180:181], v116 offset:3104
    ds_read_b64_tr_b16 a[182:183], v116 offset:3872
    ds_read_b64_tr_b16 a[204:205], v116 offset:3136
    ds_read_b64_tr_b16 a[206:207], v116 offset:3904
    s_add_u32 m0, s28, 12288
    v_cndmask_b32 v123, 0, v171, vcc
    v_add_f32 v63, v63, v123
    v_cmp_ne_u32 vcc, v120, v170
    s_nop 0
    s_nop 0
    v_cndmask_b32 v154, 0, v171, vcc
    buffer_load_dwordx4 v13, s[8:11], s25 offen nt lds
    s_add_u32 m0, s29, 0
    v_add_f32 v75, v75, v154
    ds_read_b128 v[108:111], v152 offset:0
    ds_read_b128 v[116:119], v153 offset:0
    ds_read_b128 v[124:127], v152 offset:128
    ds_read_b128 v[128:131], v153 offset:128
    ds_read_b128 v[136:139], v152 offset:256
    buffer_load_dwordx4 v14, s[8:11], s25 offen nt lds
    ds_read_b128 v[140:143], v153 offset:256
    s_add_u32 m0, s67, 0
    s_waitcnt lgkmcnt(6)
    s_cmp_lt_u32 1, s17
    s_cselect_b32 s10, s36, 0
    s_mov_b32 s25, s24
    s_waitcnt lgkmcnt(5)
    v_mfma_f32_16x16x32_bf16 v[168:171], a[72:75], v[108:111], 0
    s_waitcnt vmcnt(6)
    buffer_load_dwordx4 v121, s[48:51], 0 offen lds
    ds_read_b64_tr_b16 a[160:161], v115 offset:0
    v_mfma_f32_16x16x32_bf16 v[188:191], a[96:99], v[108:111], 0
    s_waitcnt lgkmcnt(3)
    ds_read_b64_tr_b16 a[162:163], v115 offset:768
    ds_read_b64_tr_b16 a[184:185], v115 offset:32
    v_mfma_f32_16x16x32_bf16 v[168:171], a[76:79], v[116:119], v[168:171]
    s_waitcnt lgkmcnt(4)
    ds_read_b64_tr_b16 a[186:187], v115 offset:800
    ds_read_b64_tr_b16 a[208:209], v115 offset:64
    v_mfma_f32_16x16x32_bf16 v[168:171], a[80:83], v[124:127], v[168:171]
    ds_read_b64_tr_b16 a[210:211], v115 offset:832
    v_mfma_f32_16x16x32_bf16 v[168:171], a[84:87], v[128:131], v[168:171]
    s_waitcnt lgkmcnt(6)
    v_mfma_f32_16x16x32_bf16 v[168:171], a[88:91], v[136:139], v[168:171]
    buffer_load_dwordx4 v122, s[48:51], 0 offen offset:1024 lds
    v_mfma_f32_16x16x32_bf16 v[168:171], a[92:95], v[140:143], v[168:171]
    v_mfma_f32_16x16x32_bf16 v[188:191], a[100:103], v[116:119], v[188:191]
    v_mfma_f32_16x16x32_bf16 v[188:191], a[104:107], v[124:127], v[188:191]
    s_waitcnt lgkmcnt(5)
    v_mfma_f32_16x16x32_bf16 v[188:191], a[108:111], v[128:131], v[188:191]
    s_waitcnt lgkmcnt(3)
    ds_read_b128 v[148:151], v152 offset:6144
    v_mfma_f32_16x16x32_bf16 v[188:191], a[112:115], v[136:139], v[188:191]
    s_waitcnt lgkmcnt(2)
    buffer_load_dwordx4 v146, s[48:51], 0 offen offset:2048 lds
    ds_read_b128 v[160:163], v153 offset:6144
    v_mfma_f32_16x16x32_bf16 v[188:191], a[116:119], v[140:143], v[188:191]
    s_add_u32 m0, s67, 3072
    ds_read_b128 v[176:179], v152 offset:6272
    v_fma_f32 v154, v168, v168, s32
    v_mfma_f32_16x16x32_bf16 v[192:195], a[120:123], v[108:111], 0
    s_waitcnt lgkmcnt(3)
    ds_read_b128 v[200:203], v153 offset:6272
    v_fmac_f32 v154, v169, v169
    v_mfma_f32_16x16x32_bf16 v[192:195], a[124:127], v[116:119], v[192:195]
    ds_read_b128 v[204:207], v152 offset:6400
    s_waitcnt vmcnt(6)
    v_mfma_f32_16x16x32_bf16 v[192:195], a[128:131], v[124:127], v[192:195]
    ds_read_b64_tr_b16 a[164:165], v115 offset:3072
    ds_read_b64_tr_b16 a[166:167], v115 offset:3840
    v_mfma_f32_16x16x32_bf16 v[192:195], a[132:135], v[128:131], v[192:195]
    buffer_load_dwordx4 v121, s[48:51], s4 offen lds
    v_mfma_f32_16x16x32_bf16 v[192:195], a[136:139], v[136:139], v[192:195]
    ds_read_b64_tr_b16 a[188:189], v115 offset:3104
    ds_read_b64_tr_b16 a[190:191], v115 offset:3872
    v_mfma_f32_16x16x32_bf16 v[192:195], a[140:143], v[140:143], v[192:195]
    s_waitcnt lgkmcnt(8)
    ds_read_b64_tr_b16 a[212:213], v115 offset:3136
    ds_read_b64_tr_b16 a[214:215], v115 offset:3904
    v_mfma_f32_16x16x32_bf16 v[208:211], a[72:75], v[148:151], 0
    s_waitcnt lgkmcnt(9)
    ds_read_b128 v[212:215], v153 offset:6400
    v_fmac_f32 v154, v170, v170
    v_mfma_f32_16x16x32_bf16 v[208:211], a[76:79], v[160:163], v[208:211]
    s_waitcnt lgkmcnt(9)
    v_fmac_f32 v154, v171, v171
    v_fmac_f32 v154, v188, v188
    v_mfma_f32_16x16x32_bf16 v[208:211], a[80:83], v[176:179], v[208:211]
    s_waitcnt lgkmcnt(8)
    buffer_load_dwordx4 v122, s[48:51], s4 offen offset:1024 lds
    v_mfma_f32_16x16x32_bf16 v[208:211], a[84:87], v[200:203], v[208:211]
    s_waitcnt lgkmcnt(7)
    v_fmac_f32 v154, v189, v189
    v_fmac_f32 v154, v190, v190
    v_mfma_f32_16x16x32_bf16 v[208:211], a[88:91], v[204:207], v[208:211]
    s_waitcnt lgkmcnt(5)
    v_fmac_f32 v154, v191, v191
    v_fmac_f32 v154, v192, v192
    v_mfma_f32_16x16x32_bf16 v[220:223], a[96:99], v[148:151], 0
    v_fmac_f32 v154, v193, v193
    v_fmac_f32 v154, v194, v194
    v_mfma_f32_16x16x32_bf16 v[220:223], a[100:103], v[160:163], v[220:223]
    s_waitcnt lgkmcnt(3)
    v_fmac_f32 v154, v195, v195
    v_mfma_f32_16x16x32_bf16 v[220:223], a[104:107], v[176:179], v[220:223]
    s_waitcnt lgkmcnt(1)
    buffer_load_dwordx4 v146, s[48:51], s4 offen offset:2048 lds
    v_mfma_f32_16x16x32_bf16 v[220:223], a[108:111], v[200:203], v[220:223]
    s_waitcnt lgkmcnt(0)
    s_add_u32 m0, s66, 0
    s_add_u32 s4, 0, 24576
    v_mfma_f32_16x16x32_bf16 v[208:211], a[92:95], v[212:215], v[208:211]
    v_mfma_f32_16x16x32_bf16 v[220:223], a[112:115], v[204:207], v[220:223]
    v_mfma_f32_16x16x32_bf16 v[220:223], a[116:119], v[212:215], v[220:223]
    v_mfma_f32_16x16x32_bf16 v[224:227], a[120:123], v[148:151], 0
    buffer_load_dwordx4 v121, s[48:51], s4 offen lds
    v_mfma_f32_16x16x32_bf16 v[224:227], a[124:127], v[160:163], v[224:227]
    v_mfma_f32_16x16x32_bf16 v[224:227], a[128:131], v[176:179], v[224:227]
    v_mfma_f32_16x16x32_bf16 v[224:227], a[132:135], v[200:203], v[224:227]
    v_mfma_f32_16x16x32_bf16 v[224:227], a[136:139], v[204:207], v[224:227]
    v_fma_f32 v183, v208, v208, s32
    v_fmac_f32 v183, v209, v209
    v_mfma_f32_16x16x32_bf16 v[224:227], a[140:143], v[212:215], v[224:227]
    v_fmac_f32 v183, v210, v210
    v_fmac_f32 v183, v211, v211
    v_mfma_f32_16x16x32_bf16 v[216:219], a[0:3], v[108:111], 0
    v_fmac_f32 v183, v220, v220
    v_fmac_f32 v183, v221, v221
    v_mfma_f32_16x16x32_bf16 v[216:219], a[4:7], v[116:119], v[216:219]
    v_fmac_f32 v183, v222, v222
    v_fmac_f32 v183, v223, v223
    v_mfma_f32_16x16x32_bf16 v[216:219], a[8:11], v[124:127], v[216:219]
    v_fmac_f32 v183, v224, v224
    v_fmac_f32 v183, v225, v225
    v_mfma_f32_16x16x32_bf16 v[216:219], a[12:15], v[128:131], v[216:219]
    v_fmac_f32 v183, v226, v226
    v_fmac_f32 v183, v227, v227
    v_mfma_f32_16x16x32_bf16 v[216:219], a[16:19], v[136:139], v[216:219]
    v_mfma_f32_16x16x32_bf16 v[216:219], a[20:23], v[140:143], v[216:219]
    v_mfma_f32_16x16x32_bf16 v[232:235], a[24:27], v[108:111], 0
    v_mfma_f32_16x16x32_bf16 v[232:235], a[28:31], v[116:119], v[232:235]
    v_mfma_f32_16x16x32_bf16 v[232:235], a[32:35], v[124:127], v[232:235]
    v_mfma_f32_16x16x32_bf16 v[232:235], a[36:39], v[128:131], v[232:235]
    v_mfma_f32_16x16x32_bf16 v[232:235], a[40:43], v[136:139], v[232:235]
    v_mfma_f32_16x16x32_bf16 v[232:235], a[44:47], v[140:143], v[232:235]
    v_mfma_f32_16x16x32_bf16 v[236:239], a[48:51], v[108:111], 0
    v_mfma_f32_16x16x32_bf16 v[236:239], a[52:55], v[116:119], v[236:239]
    v_fma_f32 v120, v216, v216, s32
    v_fmac_f32 v120, v217, v217
    v_mfma_f32_16x16x32_bf16 v[236:239], a[56:59], v[124:127], v[236:239]
    v_fmac_f32 v120, v218, v218
    v_fmac_f32 v120, v219, v219
    v_mfma_f32_16x16x32_bf16 v[236:239], a[60:63], v[128:131], v[236:239]
    v_fmac_f32 v120, v232, v232
    v_fmac_f32 v120, v233, v233
    v_mfma_f32_16x16x32_bf16 v[236:239], a[64:67], v[136:139], v[236:239]
    v_fmac_f32 v120, v234, v234
    v_fmac_f32 v120, v235, v235
    v_mfma_f32_16x16x32_bf16 v[236:239], a[68:71], v[140:143], v[236:239]
    v_mfma_f32_16x16x32_bf16 v[108:111], a[0:3], v[148:151], 0
    v_mfma_f32_16x16x32_bf16 v[108:111], a[4:7], v[160:163], v[108:111]
    v_mfma_f32_16x16x32_bf16 v[108:111], a[8:11], v[176:179], v[108:111]
    v_mfma_f32_16x16x32_bf16 v[108:111], a[12:15], v[200:203], v[108:111]
    v_mfma_f32_16x16x32_bf16 v[108:111], a[16:19], v[204:207], v[108:111]
    v_mfma_f32_16x16x32_bf16 v[108:111], a[20:23], v[212:215], v[108:111]
    v_mfma_f32_16x16x32_bf16 v[136:139], a[24:27], v[148:151], 0
    v_mfma_f32_16x16x32_bf16 v[136:139], a[28:31], v[160:163], v[136:139]
    v_fmac_f32 v120, v236, v236
    v_fmac_f32 v120, v237, v237
    v_mfma_f32_16x16x32_bf16 v[136:139], a[32:35], v[176:179], v[136:139]
    v_fmac_f32 v120, v238, v238
    v_fmac_f32 v120, v239, v239
    v_mfma_f32_16x16x32_bf16 v[136:139], a[36:39], v[200:203], v[136:139]
    ds_read_b128 v[196:199], v0 offset:20480
    v_cvt_pk_bf16_f32 v36, v120, v154
    v_mfma_f32_16x16x32_bf16 v[136:139], a[40:43], v[204:207], v[136:139]
    ds_read_b128 v[184:187], v1 offset:20480
    v_fma_f32 v154, v108, v108, s32
    v_mfma_f32_16x16x32_bf16 v[116:119], v[32:35], v[36:39], 0
    v_fmac_f32 v154, v109, v109
    v_fmac_f32 v154, v110, v110
    v_mfma_f32_16x16x32_bf16 v[136:139], a[44:47], v[212:215], v[136:139]
    ds_read_b128 v[172:175], v0 offset:20608
    v_fmac_f32 v154, v111, v111
    v_mfma_f32_16x16x32_bf16 v[140:143], a[48:51], v[148:151], 0
    ds_read_b128 v[148:151], v1 offset:20608
    v_mfma_f32_16x16x32_bf16 v[140:143], a[52:55], v[160:163], v[140:143]
    ds_read_b128 v[112:115], v0 offset:20736
    v_mfma_f32_16x16x32_bf16 v[140:143], a[56:59], v[176:179], v[140:143]
    ds_read_b128 v[228:231], v1 offset:20736
    v_fmac_f32 v154, v136, v136
    v_mfma_f32_16x16x32_bf16 v[140:143], a[60:63], v[200:203], v[140:143]
    v_rsq_f32 v117, v117
    v_mfma_f32_16x16x32_bf16 v[140:143], a[64:67], v[204:207], v[140:143]
    s_waitcnt lgkmcnt(5)
    v_rsq_f32 v116, v116
    v_mfma_f32_16x16x32_bf16 v[140:143], a[68:71], v[212:215], v[140:143]
    s_waitcnt lgkmcnt(4)
    v_mul_f32 v116, s31, v116
    v_mul_f32 v168, v117, v168
    v_mfma_f32_16x16x32_bf16 v[176:179], a[96:99], v[196:199], 0
    v_mul_f32 v169, v117, v169
    v_cvt_pk_bf16_f32 v128, v168, v169
    v_mfma_f32_16x16x32_bf16 v[176:179], a[100:103], v[184:187], v[176:179]
    s_waitcnt lgkmcnt(3)
    v_mul_f32 v170, v117, v170
    v_mul_f32 v171, v117, v171
    v_mfma_f32_16x16x32_bf16 v[176:179], a[104:107], v[172:175], v[176:179]
    s_waitcnt lgkmcnt(2)
    v_cvt_pk_bf16_f32 v129, v170, v171
    v_mul_f32 v188, v117, v188
    v_mfma_f32_16x16x32_bf16 v[176:179], a[108:111], v[148:151], v[176:179]
    s_waitcnt lgkmcnt(1)
    v_mul_f32 v189, v117, v189
    v_cvt_pk_bf16_f32 v130, v188, v189
    v_mfma_f32_16x16x32_bf16 v[176:179], a[112:115], v[112:115], v[176:179]
    s_waitcnt lgkmcnt(0)
    v_mul_f32 v190, v117, v190
    v_mul_f32 v191, v117, v191
    v_mfma_f32_16x16x32_bf16 v[176:179], a[116:119], v[228:231], v[176:179]
    v_cvt_pk_bf16_f32 v131, v190, v191
    v_mul_f32 v192, v117, v192
    v_mfma_f32_16x16x32_bf16 v[124:127], a[120:123], v[196:199], 0
    ds_write_b128 v155, v[128:131]
    v_mfma_f32_16x16x32_bf16 v[124:127], a[124:127], v[184:187], v[124:127]
    v_mul_f32 v193, v117, v193
    v_cvt_pk_bf16_f32 v130, v192, v193
    v_mfma_f32_16x16x32_bf16 v[124:127], a[128:131], v[172:175], v[124:127]
    v_mul_f32 v194, v117, v194
    v_mul_f32 v195, v117, v195
    v_mfma_f32_16x16x32_bf16 v[124:127], a[132:135], v[148:151], v[124:127]
    v_cvt_pk_bf16_f32 v131, v194, v195
    v_mul_f32 v216, v116, v216
    v_mfma_f32_16x16x32_bf16 v[124:127], a[136:139], v[112:115], v[124:127]
    ds_write_b64 v155, v[130:131] offset:48
    v_mfma_f32_16x16x32_bf16 v[124:127], a[140:143], v[228:231], v[124:127]
    v_mul_f32 v217, v116, v217
    v_cvt_pk_bf16_f32 v128, v216, v217
    v_mfma_f32_16x16x32_bf16 v[160:163], a[24:27], v[196:199], 0
    v_mul_f32 v218, v116, v218
    v_mul_f32 v219, v116, v219
    v_mfma_f32_16x16x32_bf16 v[160:163], a[28:31], v[184:187], v[160:163]
    v_cvt_pk_bf16_f32 v129, v218, v219
    v_mul_f32 v232, v116, v232
    v_mfma_f32_16x16x32_bf16 v[160:163], a[32:35], v[172:175], v[160:163]
    v_mul_f32 v233, v116, v233
    v_cvt_pk_bf16_f32 v130, v232, v233
    v_mfma_f32_16x16x32_bf16 v[160:163], a[36:39], v[148:151], v[160:163]
    v_mul_f32 v234, v116, v234
    v_mul_f32 v235, v116, v235
    v_mfma_f32_16x16x32_bf16 v[160:163], a[40:43], v[112:115], v[160:163]
    v_cvt_pk_bf16_f32 v131, v234, v235
    v_mul_f32 v236, v116, v236
    v_mfma_f32_16x16x32_bf16 v[160:163], a[44:47], v[228:231], v[160:163]
    ds_write_b128 v155, v[128:131] offset:32
    v_mfma_f32_16x16x32_bf16 v[204:207], a[72:75], v[196:199], 0
    v_mul_f32 v237, v116, v237
    v_cvt_pk_bf16_f32 v128, v236, v237
    v_mfma_f32_16x16x32_bf16 v[204:207], a[76:79], v[184:187], v[204:207]
    v_mul_f32 v238, v116, v238
    v_mul_f32 v239, v116, v239
    v_mfma_f32_16x16x32_bf16 v[204:207], a[80:83], v[172:175], v[204:207]
    v_cvt_pk_bf16_f32 v129, v238, v239
    v_mul_f32 v168, v216, v168
    v_mfma_f32_16x16x32_bf16 v[204:207], a[84:87], v[148:151], v[204:207]
    ds_write_b64 v155, v[128:129] offset:72
    v_mfma_f32_16x16x32_bf16 v[204:207], a[88:91], v[112:115], v[204:207]
    v_fmac_f32 v168, v217, v169
    v_fmac_f32 v168, v218, v170
    v_mfma_f32_16x16x32_bf16 v[204:207], a[92:95], v[228:231], v[204:207]
    v_fmac_f32 v168, v219, v171
    v_fmac_f32 v168, v232, v188
    v_mfma_f32_16x16x32_bf16 v[116:119], a[48:51], v[196:199], 0
    buffer_load_dwordx4 v122, s[48:51], s4 offen offset:1024 lds
    v_mfma_f32_16x16x32_bf16 v[116:119], a[52:55], v[184:187], v[116:119]
    v_fmac_f32 v168, v233, v189
    v_fmac_f32 v168, v234, v190
    v_mfma_f32_16x16x32_bf16 v[116:119], a[56:59], v[172:175], v[116:119]
    v_fmac_f32 v168, v235, v191
    v_fmac_f32 v168, v236, v192
    v_mfma_f32_16x16x32_bf16 v[116:119], a[60:63], v[148:151], v[116:119]
    v_fmac_f32 v168, v237, v193
    v_fmac_f32 v168, v238, v194
    v_mfma_f32_16x16x32_bf16 v[116:119], a[64:67], v[112:115], v[116:119]
    v_fmac_f32 v168, v239, v195
    v_mov_b32 v155, v168
    v_mfma_f32_16x16x32_bf16 v[116:119], a[68:71], v[228:231], v[116:119]
    buffer_load_dwordx4 v146, s[48:51], s4 offen offset:2048 lds
    v_mfma_f32_16x16x32_bf16 v[128:131], v[196:199], a[144:147], 0
    s_add_u32 m0, s66, 3072
    v_permlane32_swap_b32 v168, v155
    v_mfma_f32_16x16x32_bf16 v[128:131], v[184:187], a[148:151], v[128:131]
    s_add_u32 s4, 0, 36864
    v_add_f32 v168, v168, v155
    v_mov_b32 v155, v168
    v_mfma_f32_16x16x32_bf16 v[128:131], v[172:175], a[152:155], v[128:131]
    v_fmac_f32 v154, v137, v137
    v_fmac_f32 v154, v138, v138
    v_mfma_f32_16x16x32_bf16 v[128:131], v[148:151], a[156:159], v[128:131]
    v_permlane16_swap_b32 v168, v155
    v_mfma_f32_16x16x32_bf16 v[128:131], v[112:115], a[160:163], v[128:131]
    buffer_load_dwordx4 v121, s[48:51], s4 offen lds
    v_mfma_f32_16x16x32_bf16 v[128:131], v[228:231], a[164:167], v[128:131]
    v_add_f32 v168, v168, v155
    v_add_f32 v168, s39, v168
    v_mfma_f32_16x16x32_bf16 v[188:191], v[196:199], a[168:171], 0
    v_mov_b32 v169, v165
    v_mov_b32 v170, v165
    v_mfma_f32_16x16x32_bf16 v[188:191], v[184:187], a[172:175], v[188:191]
    v_mov_b32 v171, v165
    v_cndmask_b32 v168, v165, v168, s[88:89]
    v_mfma_f32_16x16x32_bf16 v[188:191], v[172:175], a[176:179], v[188:191]
    ds_write_b128 v156, v[168:171] offset:192
    v_mfma_f32_16x16x32_bf16 v[188:191], v[148:151], a[180:183], v[188:191]
    buffer_load_dwordx4 v122, s[48:51], s4 offen offset:1024 lds
    v_mfma_f32_16x16x32_bf16 v[188:191], v[112:115], a[184:187], v[188:191]
    v_fmac_f32 v154, v139, v139
    v_fmac_f32 v154, v140, v140
    v_mfma_f32_16x16x32_bf16 v[188:191], v[228:231], a[188:191], v[188:191]
    ds_read_b128 v[192:195], v152 offset:0
    ds_read_b128 v[200:203], v153 offset:0
    v_mfma_f32_16x16x32_bf16 v[212:215], v[196:199], a[192:195], 0
    ds_read_b128 v[232:235], v152 offset:128
    ds_read_b128 v[236:239], v153 offset:128
    v_mfma_f32_16x16x32_bf16 v[212:215], v[184:187], a[196:199], v[212:215]
    v_fmac_f32 v154, v141, v141
    v_fmac_f32 v154, v142, v142
    v_mfma_f32_16x16x32_bf16 v[212:215], v[172:175], a[200:203], v[212:215]
    buffer_load_dwordx4 v146, s[48:51], s4 offen offset:2048 lds
    v_mfma_f32_16x16x32_bf16 v[212:215], v[148:151], a[204:207], v[212:215]
    s_add_u32 m0, s67, 0
    s_waitcnt vmcnt(9)
    ds_read_b64 a[216:217], v181 offset:0
    v_mfma_f32_16x16x32_bf16 v[212:215], v[112:115], a[208:211], v[212:215]
    s_add_u32 s4, 0, 49152
    ds_read_b64 a[218:219], v181 offset:1536
    ds_read_b64 a[240:241], v181 offset:8
    v_mfma_f32_16x16x32_bf16 v[212:215], v[228:231], a[212:215], v[212:215]
    ds_read_b64 a[242:243], v181 offset:1544
    ds_read_b64 v[84:85], v182 offset:0
    ds_read_b64 v[86:87], v182 offset:1536
    ds_read_b128 v[240:243], v152 offset:256
    s_waitcnt lgkmcnt(10)
    v_mfma_f32_16x16x32_bf16 v[244:247], v[192:195], a[144:147], 0
    s_waitcnt lgkmcnt(9)
    v_fmac_f32 v154, v143, v143
    v_cvt_pk_bf16_f32 v36, v154, v183
    v_mfma_f32_16x16x32_bf16 v[244:247], v[200:203], a[148:151], v[244:247]
    s_waitcnt lgkmcnt(7)
    ds_read_b128 v[248:251], v153 offset:256
    v_fma_f32 v169, v204, v204, s32
    v_mfma_f32_16x16x32_bf16 v[244:247], v[232:235], a[152:155], v[244:247]
    v_fmac_f32 v169, v205, v205
    v_fmac_f32 v169, v206, v206
    v_mfma_f32_16x16x32_bf16 v[244:247], v[236:239], a[156:159], v[244:247]
    v_fmac_f32 v169, v207, v207
    v_fmac_f32 v169, v176, v176
    v_fmac_f32 v169, v177, v177
    v_fmac_f32 v169, v178, v178
    v_fmac_f32 v169, v179, v179
    v_fmac_f32 v169, v124, v124
    v_fmac_f32 v169, v125, v125
    v_fmac_f32 v169, v126, v126
    v_fmac_f32 v169, v127, v127
    v_cvt_pk_bf16_f32 v128, v128, v129
    v_cvt_pk_bf16_f32 v129, v130, v131
    s_waitcnt lgkmcnt(2)
    s_waitcnt lgkmcnt(1)
    v_mfma_f32_16x16x32_bf16 v[244:247], v[240:243], a[160:163], v[244:247]
    buffer_load_dwordx4 v121, s[48:51], s4 offen lds
    v_cvt_pk_bf16_f32 v144, v188, v189
    v_cvt_pk_bf16_f32 v145, v190, v191
    v_cvt_pk_bf16_f32 v188, v212, v213
    v_mfma_f32_16x16x32_bf16 v[252:255], v[32:35], v[36:39], 0
    s_waitcnt lgkmcnt(0)
    v_cvt_pk_bf16_f32 v189, v214, v215
    v_mfma_f32_16x16x32_bf16 v[244:247], v[248:251], a[164:167], v[244:247]
    s_waitcnt vmcnt(7)
    ds_read_b64 a[232:233], v181 offset:3072
    ds_read_b64 a[220:221], v181 offset:4608
    ds_read_b64 v[76:77], v181 offset:3080
    ds_read_b64 a[244:245], v181 offset:4616
    ds_read_b64 v[100:101], v182 offset:3072
    ds_read_b64 v[88:89], v182 offset:4608
    buffer_load_dwordx4 v122, s[48:51], s4 offen offset:1024 lds
    v_rsq_f32 v253, v253
    v_rsq_f32 v252, v252
    v_mul_f32 v208, v253, v208
    v_mul_f32 v252, s31, v252
    v_mul_f32 v209, v253, v209
    v_cvt_pk_bf16_f32 v212, v208, v209
    v_mul_f32 v210, v253, v210
    v_mul_f32 v211, v253, v211
    v_cvt_pk_bf16_f32 v213, v210, v211
    v_mul_f32 v220, v253, v220
    v_mul_f32 v221, v253, v221
    v_cvt_pk_bf16_f32 v214, v220, v221
    buffer_load_dwordx4 v146, s[48:51], s4 offen offset:2048 lds
    s_add_u32 m0, s67, 3072
    s_add_u32 s4, 0, 61440
    v_mul_f32 v222, v253, v222
    v_mul_f32 v223, v253, v223
    v_cvt_pk_bf16_f32 v215, v222, v223
    v_mul_f32 v224, v253, v224
    s_waitcnt lgkmcnt(0)
    v_mul_f32 v225, v253, v225
    v_cvt_pk_bf16_f32 v216, v224, v225
    v_mul_f32 v226, v253, v226
    v_mul_f32 v227, v253, v227
    v_cvt_pk_bf16_f32 v217, v226, v227
    v_mul_f32 v108, v252, v108
    v_mul_f32 v109, v252, v109
    buffer_load_dwordx4 v121, s[48:51], s4 offen lds
    ds_write_b128 v158, v[212:215]
    s_waitcnt vmcnt(7)
    v_cvt_pk_bf16_f32 v120, v108, v109
    v_mul_f32 v110, v252, v110
    v_mul_f32 v111, v252, v111
    v_cvt_pk_bf16_f32 v121, v110, v111
    v_mul_f32 v136, v252, v136
    v_mul_f32 v137, v252, v137
    ds_read_b64 a[222:223], v132 offset:0
    ds_read_b64 a[234:235], v132 offset:1536
    buffer_load_dwordx4 v122, s[48:51], s4 offen offset:1024 lds
    ds_read_b64 a[246:247], v132 offset:8
    ds_read_b64 v[78:79], v132 offset:1544
    ds_read_b64 v[90:91], v180 offset:0
    ds_read_b64 v[102:103], v180 offset:1536
    ds_write_b64 v158, v[216:217] offset:48
    v_mfma_f32_16x16x32_bf16 v[216:219], a[0:3], v[196:199], 0
    v_cvt_pk_bf16_f32 v122, v136, v137
    v_mul_f32 v138, v252, v138
    v_mfma_f32_16x16x32_bf16 v[216:219], a[4:7], v[184:187], v[216:219]
    v_mul_f32 v139, v252, v139
    v_cvt_pk_bf16_f32 v123, v138, v139
    v_mfma_f32_16x16x32_bf16 v[216:219], a[8:11], v[172:175], v[216:219]
    buffer_load_dwordx4 v146, s[48:51], s4 offen offset:2048 lds
    v_mfma_f32_16x16x32_bf16 v[216:219], a[12:15], v[148:151], v[216:219]
    s_add_u32 m0, s28, 65536
    ds_write_b128 v158, v[120:123] offset:32
    v_mfma_f32_16x16x32_bf16 v[216:219], a[16:19], v[112:115], v[216:219]
    s_waitcnt lgkmcnt(6)
    v_mul_f32 v140, v252, v140
    v_mul_f32 v141, v252, v141
    v_mfma_f32_16x16x32_bf16 v[216:219], a[20:23], v[228:231], v[216:219]
    s_waitcnt lgkmcnt(2)
    v_cvt_pk_bf16_f32 v214, v140, v141
    v_mul_f32 v142, v252, v142
    v_mfma_f32_16x16x32_bf16 v[112:115], v[192:195], a[168:171], 0
    buffer_load_dwordx4 v10, s[8:11], s24 offen nt lds
    s_waitcnt vmcnt(7)
    v_mfma_f32_16x16x32_bf16 v[112:115], v[200:203], a[172:175], v[112:115]
    s_add_u32 m0, s28, 69632
    ds_read_b64 a[224:225], v132 offset:3072
    ds_read_b64 a[226:227], v132 offset:4608
    v_mfma_f32_16x16x32_bf16 v[112:115], v[232:235], a[176:179], v[112:115]
    ds_read_b64 a[248:249], v132 offset:3080
    ds_read_b64 a[250:251], v132 offset:4616
    v_mfma_f32_16x16x32_bf16 v[112:115], v[236:239], a[180:183], v[112:115]
    ds_read_b64 v[92:93], v180 offset:3072
    ds_read_b64 v[94:95], v180 offset:4608
    v_mfma_f32_16x16x32_bf16 v[112:115], v[240:243], a[184:187], v[112:115]
    ds_read_b128 v[120:123], v152 offset:6144
    ds_read_b128 v[132:135], v153 offset:6144
    v_mfma_f32_16x16x32_bf16 v[112:115], v[248:251], a[188:191], v[112:115]
    buffer_load_dwordx4 v11, s[8:11], s24 offen nt lds
    v_mfma_f32_16x16x32_bf16 v[148:151], v[192:195], a[192:195], 0
    s_add_u32 m0, s28, 73728
    ds_read_b128 v[172:175], v152 offset:6272
    ds_read_b128 v[184:187], v153 offset:6272
    v_mfma_f32_16x16x32_bf16 v[148:151], v[200:203], a[196:199], v[148:151]
    ds_read_b128 v[192:195], v152 offset:6400
    v_mul_f32 v143, v252, v143
    v_mfma_f32_16x16x32_bf16 v[148:151], v[232:235], a[200:203], v[148:151]
    ds_read_b128 v[196:199], v153 offset:6400
    v_cvt_pk_bf16_f32 v215, v142, v143
    v_mfma_f32_16x16x32_bf16 v[148:151], v[236:239], a[204:207], v[148:151]
    s_waitcnt lgkmcnt(10)
    ds_write_b64 v158, v[214:215] offset:72
    v_mfma_f32_16x16x32_bf16 v[148:151], v[240:243], a[208:211], v[148:151]
    s_waitcnt lgkmcnt(8)
    buffer_load_dwordx4 v12, s[8:11], s24 offen nt lds
    v_mfma_f32_16x16x32_bf16 v[148:151], v[248:251], a[212:215], v[148:151]
    s_waitcnt lgkmcnt(6)
    v_mul_f32 v108, v108, v208
    v_fmac_f32 v108, v109, v209
    v_mfma_f32_16x16x32_bf16 v[152:155], v[120:123], a[144:147], 0
    s_waitcnt lgkmcnt(5)
    v_fmac_f32 v108, v110, v210
    v_fmac_f32 v108, v111, v211
    s_waitcnt vmcnt(6)
    v_mfma_f32_16x16x32_bf16 v[152:155], v[132:135], a[148:151], v[152:155]
    s_waitcnt lgkmcnt(3)
    ds_read_b64 a[236:237], v181 offset:0
    ds_read_b64 a[228:229], v181 offset:1536
    v_mfma_f32_16x16x32_bf16 v[152:155], v[172:175], a[152:155], v[152:155]
    s_add_u32 m0, s28, 77824
    ds_read_b64 v[80:81], v181 offset:8
    ds_read_b64 a[252:253], v181 offset:1544
    v_mfma_f32_16x16x32_bf16 v[152:155], v[184:187], a[156:159], v[152:155]
    s_waitcnt lgkmcnt(5)
    buffer_load_dwordx4 v13, s[8:11], s24 offen nt lds
    v_mfma_f32_16x16x32_bf16 v[152:155], v[192:195], a[160:163], v[152:155]
    s_barrier
    ds_read_b64 v[104:105], v182 offset:0
    ds_read_b64 v[96:97], v182 offset:1536
    v_xor_b32 v130, 65536, v2
    v_mfma_f32_16x16x16_bf16 v[200:203], v[28:29], a[216:217], 0
    v_lshrrev_b32 v131, 2, v130
    v_lshrrev_b32 v156, 8, v130
    v_add_u32 v130, 148992, v130
    v_mfma_f32_16x16x16_bf16 v[200:203], v[28:29], a[240:241], v[200:203]
    v_lshl_add_u32 v158, s16, 2, v130
    v_add_u32 v131, 162048, v131
    v_lshlrev_b32 v156, 4, v156
    v_mfma_f32_16x16x16_bf16 v[200:203], v[28:29], v[84:85], v[200:203]
    v_add_u32 v156, 162048, v156
    v_fmac_f32 v108, v136, v220
    v_fmac_f32 v108, v137, v221
    v_mfma_f32_16x16x16_bf16 v[208:211], v[28:29], a[218:219], 0
    v_fmac_f32 v108, v138, v222
    v_fmac_f32 v108, v139, v223
    v_fmac_f32 v108, v140, v224
    v_mfma_f32_16x16x16_bf16 v[208:211], v[28:29], a[242:243], v[208:211]
    v_fmac_f32 v108, v141, v225
    v_fmac_f32 v108, v142, v226
    v_fmac_f32 v108, v143, v227
    v_mfma_f32_16x16x16_bf16 v[208:211], v[28:29], v[86:87], v[208:211]
    v_mov_b32 v146, v108
    v_fma_f32 v168, v216, v216, s32
    v_fmac_f32 v168, v217, v217
    v_mfma_f32_16x16x16_bf16 v[136:139], v[28:29], a[232:233], 0
    v_permlane32_swap_b32 v108, v146
    v_add_f32 v108, v108, v146
    v_mfma_f32_16x16x16_bf16 v[136:139], v[28:29], v[76:77], v[136:139]
    v_mov_b32 v146, v108
    v_mov_b32_dpp v200, v208 quad_perm:[0,1,2,3] row_mask:0x2 bank_mask:0xf
    v_fmac_f32 v168, v218, v218
    v_mfma_f32_16x16x16_bf16 v[136:139], v[28:29], v[100:101], v[136:139]
    v_permlane16_swap_b32 v108, v146
    v_add_f32 v108, v108, v146
    s_waitcnt vmcnt(4)
    v_mfma_f32_16x16x16_bf16 v[140:143], v[28:29], a[220:221], 0
    ds_read_b64 a[230:231], v181 offset:3072
    ds_read_b64 a[238:239], v181 offset:4608
    ds_read_b64 a[254:255], v181 offset:3080
    v_mfma_f32_16x16x16_bf16 v[140:143], v[28:29], a[244:245], v[140:143]
    ds_read_b64 v[82:83], v181 offset:4616
    ds_read_b64 v[98:99], v182 offset:3072
    ds_read_b64 v[106:107], v182 offset:4608
    v_mfma_f32_16x16x16_bf16 v[140:143], v[28:29], v[88:89], v[140:143]
    v_mov_b32_dpp v200, v136 quad_perm:[0,1,2,3] row_mask:0x4 bank_mask:0xf
    v_add_f32 v108, s39, v108
    v_mov_b32 v109, v165
    v_mfma_f32_16x16x16_bf16 v[136:139], v[28:29], a[222:223], 0
    v_mov_b32 v110, v165
    v_mov_b32 v111, v165
    v_cndmask_b32 v108, v165, v108, s[88:89]
    v_mfma_f32_16x16x16_bf16 v[136:139], v[28:29], a[246:247], v[136:139]
    v_mov_b32_dpp v200, v140 quad_perm:[0,1,2,3] row_mask:0x8 bank_mask:0xf
    v_fmac_f32 v168, v219, v219
    v_fmac_f32 v168, v160, v160
    v_mfma_f32_16x16x16_bf16 v[136:139], v[28:29], v[90:91], v[136:139]
    v_fmac_f32 v168, v161, v161
    v_fmac_f32 v168, v162, v162
    v_fmac_f32 v168, v163, v163
    v_mfma_f32_16x16x16_bf16 v[140:143], v[28:29], a[234:235], 0
    v_fmac_f32 v168, v116, v116
    v_fmac_f32 v168, v117, v117
    v_fmac_f32 v168, v118, v118
    v_mfma_f32_16x16x16_bf16 v[140:143], v[28:29], v[78:79], v[140:143]
    v_fmac_f32 v168, v119, v119
    v_cvt_pk_bf16_f32 v36, v168, v169
    v_cvt_pk_bf16_f32 v244, v244, v244
    v_mfma_f32_16x16x16_bf16 v[140:143], v[28:29], v[102:103], v[140:143]
    v_cvt_pk_bf16_f32 v245, v245, v245
    v_cvt_pk_bf16_f32 v246, v246, v246
    v_cvt_pk_bf16_f32 v247, v247, v247
    v_cvt_pk_bf16_f32 v112, v112, v112
    v_mfma_f32_16x16x32_bf16 v[168:171], v[32:35], v[36:39], 0
    s_add_u32 m0, s72, 0
    ds_write_b32 v158, v200 offset:0
    v_cvt_pk_bf16_f32 v113, v113, v113
    v_mfma_f32_16x16x16_bf16 v[180:183], v[28:29], a[224:225], 0
    v_mov_b32_dpp v136, v140 quad_perm:[0,1,2,3] row_mask:0x2 bank_mask:0xf
    v_cvt_pk_bf16_f32 v114, v114, v114
    v_cvt_pk_bf16_f32 v115, v115, v115
    v_mfma_f32_16x16x16_bf16 v[180:183], v[28:29], a[248:249], v[180:183]
    v_rsq_f32 v169, v169
    v_cvt_pk_bf16_f32 v148, v148, v148
    v_mfma_f32_16x16x16_bf16 v[180:183], v[28:29], v[92:93], v[180:183]
    v_rsq_f32 v168, v168
    v_mul_f32 v204, v169, v204
    v_mfma_f32_16x16x16_bf16 v[140:143], v[28:29], a[226:227], 0
    v_mul_f32 v168, s31, v168
    v_mul_f32 v205, v169, v205
    v_cvt_pk_bf16_f32 v200, v204, v205
    v_mfma_f32_16x16x16_bf16 v[140:143], v[28:29], a[250:251], v[140:143]
    v_mul_f32 v206, v169, v206
    v_mov_b32_dpp v136, v180 quad_perm:[0,1,2,3] row_mask:0x4 bank_mask:0xf
    v_mul_f32 v207, v169, v207
    v_mfma_f32_16x16x16_bf16 v[140:143], v[28:29], v[94:95], v[140:143]
    v_cvt_pk_bf16_f32 v201, v206, v207
    v_mul_f32 v176, v169, v176
    v_mul_f32 v177, v169, v177
    v_cvt_pk_bf16_f32 v202, v176, v177
    v_mfma_f32_16x16x32_bf16 v[152:155], v[196:199], a[164:167], v[152:155]
    s_waitcnt lgkmcnt(0)
    buffer_load_dwordx4 v14, s[8:11], s24 offen nt lds
    v_mul_f32 v178, v169, v178
    v_mfma_f32_16x16x16_bf16 v[180:183], v[28:29], a[236:237], 0
    v_mov_b32_dpp v136, v140 quad_perm:[0,1,2,3] row_mask:0x8 bank_mask:0xf
    v_mul_f32 v179, v169, v179
    v_cvt_pk_bf16_f32 v203, v178, v179
    v_mfma_f32_16x16x16_bf16 v[180:183], v[28:29], v[80:81], v[180:183]
    v_mul_f32 v124, v169, v124
    v_mul_f32 v125, v169, v125
    v_cvt_pk_bf16_f32 v142, v124, v125
    v_mfma_f32_16x16x16_bf16 v[180:183], v[28:29], v[104:105], v[180:183]
    v_mul_f32 v126, v169, v126
    v_mul_f32 v127, v169, v127
    v_cvt_pk_bf16_f32 v143, v126, v127
    v_mfma_f32_16x16x16_bf16 v[124:127], v[28:29], a[228:229], 0
    v_mul_f32 v216, v168, v216
    v_mul_f32 v217, v168, v217
    v_cvt_pk_bf16_f32 v176, v216, v217
    v_mfma_f32_16x16x16_bf16 v[124:127], v[28:29], a[252:253], v[124:127]
    v_mul_f32 v218, v168, v218
    v_mul_f32 v219, v168, v219
    v_cvt_pk_bf16_f32 v177, v218, v219
    v_mfma_f32_16x16x16_bf16 v[124:127], v[28:29], v[96:97], v[124:127]
    v_mul_f32 v160, v168, v160
    v_mul_f32 v161, v168, v161
    v_cvt_pk_bf16_f32 v178, v160, v161
    v_mfma_f32_16x16x16_bf16 v[204:207], v[28:29], a[230:231], 0
    v_mul_f32 v162, v168, v162
    v_mul_f32 v163, v168, v163
    v_cvt_pk_bf16_f32 v179, v162, v163
    v_mfma_f32_16x16x16_bf16 v[204:207], v[28:29], a[254:255], v[204:207]
    v_mov_b32_dpp v180, v124 quad_perm:[0,1,2,3] row_mask:0x2 bank_mask:0xf
    v_mul_f32 v116, v168, v116
    v_mul_f32 v117, v168, v117
    v_mfma_f32_16x16x16_bf16 v[204:207], v[28:29], v[98:99], v[204:207]
    v_cvt_pk_bf16_f32 v140, v116, v117
    v_mul_f32 v118, v168, v118
    v_mul_f32 v119, v168, v119
    v_mfma_f32_16x16x16_bf16 v[124:127], v[28:29], a[238:239], 0
    v_cvt_pk_bf16_f32 v141, v118, v119
    v_cvt_pk_bf16_f32 v149, v149, v149
    v_cvt_pk_bf16_f32 v150, v150, v150
    v_mfma_f32_16x16x16_bf16 v[124:127], v[28:29], v[82:83], v[124:127]
    v_mov_b32_dpp v180, v204 quad_perm:[0,1,2,3] row_mask:0x4 bank_mask:0xf
    v_cvt_pk_bf16_f32 v151, v151, v151
    v_cvt_pk_bf16_f32 v152, v152, v152
    v_mfma_f32_16x16x16_bf16 v[124:127], v[28:29], v[106:107], v[124:127]
    v_cvt_pk_bf16_f32 v153, v153, v153
    v_cvt_pk_bf16_f32 v154, v154, v154
    v_cvt_pk_bf16_f32 v155, v155, v155
    v_xor_b32 v2, 65536, v2
    v_mfma_f32_16x16x32_bf16 v[116:119], v[120:123], a[168:171], 0
    s_add_u32 s8, s40, s23
    ds_write_b32 v158, v136 offset:1024
    v_mfma_f32_16x16x32_bf16 v[116:119], v[132:135], a[172:175], v[116:119]
    s_addc_u32 s9, s41, 0
    v_mov_b32_dpp v180, v124 quad_perm:[0,1,2,3] row_mask:0x8 bank_mask:0xf
    s_sub_u32 s10, s36, s23
    v_mfma_f32_16x16x32_bf16 v[116:119], v[172:175], a[176:179], v[116:119]
    s_cmp_lt_u32 s34, s17
    ds_write_b32 v158, v180 offset:2048
    v_mfma_f32_16x16x32_bf16 v[116:119], v[184:187], a[180:183], v[116:119]
    s_cselect_b32 s10, s10, 0
    s_add_u32 m0, s28, 0
    ds_read_b128 v[124:127], v0 offset:26624
    v_mfma_f32_16x16x32_bf16 v[116:119], v[192:195], a[184:187], v[116:119]
    s_mov_b32 s24, s23
    ds_read_b128 v[136:139], v1 offset:26624
    s_add_u32 s23, s23, s21
    v_mfma_f32_16x16x32_bf16 v[116:119], v[196:199], a[188:191], v[116:119]
    s_cmp_ge_u32 s19, 72
    ds_read_b128 v[160:163], v0 offset:26752
    s_cselect_b32 s34, 72, 0
    v_mfma_f32_16x16x32_bf16 v[168:171], v[120:123], a[192:195], 0
    s_cselect_b32 s35, s22, 0
    ds_read_b128 v[120:123], v1 offset:26752
    s_sub_u32 s19, s19, s34
    v_mfma_f32_16x16x32_bf16 v[168:171], v[132:135], a[196:199], v[168:171]
    s_add_u32 s23, s23, s35
    ds_read_b128 v[132:135], v0 offset:26880
    v_cvt_pk_bf16_f32 v116, v116, v116
    v_mfma_f32_16x16x32_bf16 v[168:171], v[172:175], a[200:203], v[168:171]
    ds_read_b128 v[172:175], v1 offset:26880
    v_cvt_pk_bf16_f32 v117, v117, v117
    v_mfma_f32_16x16x32_bf16 v[168:171], v[184:187], a[204:207], v[168:171]
    ds_write_b128 v159, v[108:111] offset:192
    v_mfma_f32_16x16x32_bf16 v[168:171], v[192:195], a[208:211], v[168:171]
    s_waitcnt lgkmcnt(6)
    v_cvt_pk_bf16_f32 v118, v118, v118
    v_cvt_pk_bf16_f32 v119, v119, v119
    v_mfma_f32_16x16x32_bf16 v[168:171], v[196:199], a[212:215], v[168:171]
    s_barrier
    v_mfma_f32_16x16x32_bf16 v[108:111], a[72:75], v[124:127], 0
    s_waitcnt lgkmcnt(4)
    ds_read_b128 v[180:183], v130 offset:0
    ds_read_b128 v[184:187], v130 offset:1024
    v_mfma_f32_16x16x32_bf16 v[108:111], a[76:79], v[136:139], v[108:111]
    s_waitcnt lgkmcnt(5)
    ds_read_b128 v[192:195], v130 offset:2048
    v_cvt_pk_bf16_f32 v168, v168, v168
    v_mfma_f32_16x16x32_bf16 v[108:111], a[80:83], v[160:163], v[108:111]
    s_waitcnt lgkmcnt(5)
    ds_write2_b32 v157, v244, v245 offset0:0 offset1:68
    v_mfma_f32_16x16x32_bf16 v[108:111], a[84:87], v[120:123], v[108:111]
    s_waitcnt lgkmcnt(5)
    v_cvt_pk_bf16_f32 v169, v169, v169
    v_cvt_pk_bf16_f32 v170, v170, v170
    v_mfma_f32_16x16x32_bf16 v[108:111], a[88:91], v[132:135], v[108:111]
    ds_write2_b32 v157, v246, v247 offset0:136 offset1:204
    v_mfma_f32_16x16x32_bf16 v[108:111], a[92:95], v[172:175], v[108:111]
    v_cvt_pk_bf16_f32 v171, v171, v171
    v_mfma_f32_16x16x32_bf16 v[196:199], a[96:99], v[124:127], 0
    ds_write2_b32 v157, v112, v113 offset0:16 offset1:84
    v_mfma_f32_16x16x32_bf16 v[196:199], a[100:103], v[136:139], v[196:199]
    s_waitcnt lgkmcnt(4)
    v_add_f32 v180, v180, v181
    v_add_f32 v182, v182, v183
    v_mfma_f32_16x16x32_bf16 v[196:199], a[104:107], v[160:163], v[196:199]
    s_waitcnt lgkmcnt(3)
    ds_write2_b32 v157, v114, v115 offset0:152 offset1:220
    v_mfma_f32_16x16x32_bf16 v[196:199], a[108:111], v[120:123], v[196:199]
    v_add_f32 v180, v180, v182
    v_mul_f32 v180, 0xbbaaaaab, v180
    v_mfma_f32_16x16x32_bf16 v[196:199], a[112:115], v[132:135], v[196:199]
    ds_write_b32 v131, v180 offset:0
    v_mfma_f32_16x16x32_bf16 v[196:199], a[116:119], v[172:175], v[196:199]
    v_add_f32 v184, v184, v185
    v_add_f32 v186, v186, v187
    v_mfma_f32_16x16x32_bf16 v[112:115], a[120:123], v[124:127], 0
    ds_read_b128 v[180:183], v156 offset:0
    ds_read_b128 v[204:207], v156 offset:64
    v_mfma_f32_16x16x32_bf16 v[112:115], a[124:127], v[136:139], v[112:115]
    ds_write2_b32 v157, v148, v149 offset0:32 offset1:100
    v_mfma_f32_16x16x32_bf16 v[112:115], a[128:131], v[160:163], v[112:115]
    v_add_f32 v184, v184, v186
    v_mul_f32 v184, 0xbbaaaaab, v184
    v_mfma_f32_16x16x32_bf16 v[112:115], a[132:135], v[120:123], v[112:115]
    ds_write_b32 v131, v184 offset:256
    v_mfma_f32_16x16x32_bf16 v[112:115], a[136:139], v[132:135], v[112:115]
    v_add_f32 v192, v192, v193
    v_add_f32 v194, v194, v195
    v_mfma_f32_16x16x32_bf16 v[112:115], a[140:143], v[172:175], v[112:115]
    ds_write2_b32 v157, v150, v151 offset0:168 offset1:236
    v_mfma_f32_16x16x32_bf16 v[148:151], a[0:3], v[124:127], 0
    v_add_f32 v192, v192, v194
    v_mul_f32 v192, 0xbbaaaaab, v192
    v_mfma_f32_16x16x32_bf16 v[148:151], a[4:7], v[136:139], v[148:151]
    s_waitcnt lgkmcnt(3)
    ds_write_b32 v131, v192 offset:512
    v_mfma_f32_16x16x32_bf16 v[148:151], a[8:11], v[160:163], v[148:151]
    v_fma_f32 v165, v108, v108, s32
    v_fmac_f32 v165, v109, v109
    v_mfma_f32_16x16x32_bf16 v[148:151], a[12:15], v[120:123], v[148:151]
    ds_write2_b32 v164, v152, v153 offset0:0 offset1:68
    v_mfma_f32_16x16x32_bf16 v[148:151], a[16:19], v[132:135], v[148:151]
    v_fmac_f32 v165, v110, v110
    v_fmac_f32 v165, v111, v111
    v_mfma_f32_16x16x32_bf16 v[148:151], a[20:23], v[172:175], v[148:151]
    ds_write2_b32 v164, v154, v155 offset0:136 offset1:204
    v_mfma_f32_16x16x32_bf16 v[152:155], a[24:27], v[124:127], 0
    v_fmac_f32 v165, v196, v196
    v_fmac_f32 v165, v197, v197
    v_mfma_f32_16x16x32_bf16 v[152:155], a[28:31], v[136:139], v[152:155]
    ds_write2_b32 v164, v116, v117 offset0:16 offset1:84
    v_mfma_f32_16x16x32_bf16 v[152:155], a[32:35], v[160:163], v[152:155]
    v_fmac_f32 v165, v198, v198
    v_fma_f32 v130, v148, v148, s32
    v_mfma_f32_16x16x32_bf16 v[152:155], a[36:39], v[120:123], v[152:155]
    ds_write2_b32 v164, v118, v119 offset0:152 offset1:220
    v_mfma_f32_16x16x32_bf16 v[152:155], a[40:43], v[132:135], v[152:155]
    v_fmac_f32 v130, v149, v149
    v_fmac_f32 v130, v150, v150
    v_mfma_f32_16x16x32_bf16 v[152:155], a[44:47], v[172:175], v[152:155]
    ds_write2_b32 v164, v168, v169 offset0:32 offset1:100
    v_mfma_f32_16x16x32_bf16 v[116:119], a[48:51], v[124:127], 0
    v_fmac_f32 v130, v151, v151
    v_fmac_f32 v165, v199, v199
    v_mfma_f32_16x16x32_bf16 v[116:119], a[52:55], v[136:139], v[116:119]
    ds_write2_b32 v164, v170, v171 offset0:168 offset1:236
    v_mfma_f32_16x16x32_bf16 v[116:119], a[56:59], v[160:163], v[116:119]
    v_fmac_f32 v165, v112, v112
    v_fmac_f32 v130, v152, v152
    v_mfma_f32_16x16x32_bf16 v[116:119], a[60:63], v[120:123], v[116:119]
    v_fmac_f32 v130, v153, v153
    v_fmac_f32 v130, v154, v154
    v_mfma_f32_16x16x32_bf16 v[116:119], a[64:67], v[132:135], v[116:119]
    v_fmac_f32 v130, v155, v155
    v_fmac_f32 v165, v113, v113
    v_mfma_f32_16x16x32_bf16 v[116:119], a[68:71], v[172:175], v[116:119]
    v_fmac_f32 v165, v114, v114
    v_fmac_f32 v165, v115, v115
    v_mfma_f32_16x16x32_bf16 v[168:171], v[124:127], a[144:147], 0
    v_mfma_f32_16x16x32_bf16 v[168:171], v[136:139], a[148:151], v[168:171]
    v_mfma_f32_16x16x32_bf16 v[168:171], v[160:163], a[152:155], v[168:171]
    v_mfma_f32_16x16x32_bf16 v[168:171], v[120:123], a[156:159], v[168:171]
    v_mfma_f32_16x16x32_bf16 v[168:171], v[132:135], a[160:163], v[168:171]
    v_mfma_f32_16x16x32_bf16 v[168:171], v[172:175], a[164:167], v[168:171]
    v_fmac_f32 v130, v116, v116
    v_fmac_f32 v130, v117, v117
    v_mfma_f32_16x16x32_bf16 v[184:187], v[124:127], a[168:171], 0
    v_fmac_f32 v130, v118, v118
    v_fmac_f32 v130, v119, v119
    v_mfma_f32_16x16x32_bf16 v[184:187], v[136:139], a[172:175], v[184:187]
    v_cvt_pk_bf16_f32 v36, v130, v165
    v_mfma_f32_16x16x32_bf16 v[184:187], v[160:163], a[176:179], v[184:187]
    v_cvt_pk_bf16_f32 v130, v168, v169
    v_cvt_pk_bf16_f32 v131, v170, v171
    v_mfma_f32_16x16x32_bf16 v[168:171], v[32:35], v[36:39], 0
    v_mfma_f32_16x16x32_bf16 v[184:187], v[120:123], a[180:183], v[184:187]
    ds_read_b128 v[192:195], v0 offset:32768
    v_mfma_f32_16x16x32_bf16 v[184:187], v[132:135], a[184:187], v[184:187]
    ds_read_b128 v[208:211], v1 offset:32768
    v_mfma_f32_16x16x32_bf16 v[184:187], v[172:175], a[188:191], v[184:187]
    ds_read_b128 v[212:215], v0 offset:32896
    v_mfma_f32_16x16x32_bf16 v[216:219], v[124:127], a[192:195], 0
    ds_read_b128 v[124:127], v1 offset:32896
    v_mfma_f32_16x16x32_bf16 v[216:219], v[136:139], a[196:199], v[216:219]
    ds_read_b128 v[136:139], v0 offset:33024
    v_xor_b32 v0, 65536, v0
    v_mfma_f32_16x16x32_bf16 v[216:219], v[160:163], a[200:203], v[216:219]
    ds_read_b128 v[160:163], v1 offset:33024
    v_cvt_pk_bf16_f32 v146, v184, v185
    v_mfma_f32_16x16x32_bf16 v[216:219], v[120:123], a[204:207], v[216:219]
    v_rsq_f32 v169, v169
    v_mfma_f32_16x16x32_bf16 v[216:219], v[132:135], a[208:211], v[216:219]
    v_rsq_f32 v168, v168
    v_mfma_f32_16x16x32_bf16 v[216:219], v[172:175], a[212:215], v[216:219]
    s_waitcnt lgkmcnt(5)
    v_mul_f32 v168, s31, v168
    v_cvt_pk_bf16_f32 v147, v186, v187
    v_mfma_f32_16x16x32_bf16 v[120:123], a[72:75], v[192:195], 0
    s_waitcnt lgkmcnt(4)
    v_mul_f32 v108, v169, v108
    v_mul_f32 v109, v169, v109
    v_mfma_f32_16x16x32_bf16 v[120:123], a[76:79], v[208:211], v[120:123]
    s_waitcnt lgkmcnt(3)
    v_cvt_pk_bf16_f32 v190, v216, v217
    v_cvt_pk_bf16_f32 v191, v218, v219
    v_mfma_f32_16x16x32_bf16 v[120:123], a[80:83], v[212:215], v[120:123]
    s_waitcnt lgkmcnt(2)
    v_cvt_pk_bf16_f32 v108, v108, v109
    v_mul_f32 v110, v169, v110
    v_mfma_f32_16x16x32_bf16 v[120:123], a[84:87], v[124:127], v[120:123]
    s_waitcnt lgkmcnt(1)
    v_mul_f32 v111, v169, v111
    v_cvt_pk_bf16_f32 v109, v110, v111
    v_mfma_f32_16x16x32_bf16 v[120:123], a[88:91], v[136:139], v[120:123]
    s_waitcnt lgkmcnt(0)
    v_mul_f32 v196, v169, v196
    v_mul_f32 v197, v169, v197
    v_mfma_f32_16x16x32_bf16 v[120:123], a[92:95], v[160:163], v[120:123]
    v_cvt_pk_bf16_f32 v110, v196, v197
    v_mul_f32 v198, v169, v198
    v_mfma_f32_16x16x32_bf16 v[132:135], a[96:99], v[192:195], 0
    v_mul_f32 v199, v169, v199
    v_cvt_pk_bf16_f32 v111, v198, v199
    v_mfma_f32_16x16x32_bf16 v[132:135], a[100:103], v[208:211], v[132:135]
    v_mul_f32 v112, v169, v112
    v_mul_f32 v113, v169, v113
    v_mfma_f32_16x16x32_bf16 v[132:135], a[104:107], v[212:215], v[132:135]
    v_cvt_pk_bf16_f32 v174, v112, v113
    v_mul_f32 v114, v169, v114
    v_mfma_f32_16x16x32_bf16 v[132:135], a[108:111], v[124:127], v[132:135]
    v_mul_f32 v115, v169, v115
    v_cvt_pk_bf16_f32 v175, v114, v115
    v_mfma_f32_16x16x32_bf16 v[132:135], a[112:115], v[136:139], v[132:135]
    v_mul_f32 v148, v168, v148
    v_mul_f32 v149, v168, v149
    v_mfma_f32_16x16x32_bf16 v[132:135], a[116:119], v[160:163], v[132:135]
    v_cvt_pk_bf16_f32 v112, v148, v149
    v_mul_f32 v150, v168, v150
    v_mfma_f32_16x16x32_bf16 v[184:187], a[120:123], v[192:195], 0
    v_mul_f32 v151, v168, v151
    v_cvt_pk_bf16_f32 v113, v150, v151
    v_mfma_f32_16x16x32_bf16 v[184:187], a[124:127], v[208:211], v[184:187]
    v_mul_f32 v152, v168, v152
    v_mul_f32 v153, v168, v153
    v_mfma_f32_16x16x32_bf16 v[184:187], a[128:131], v[212:215], v[184:187]
    v_cvt_pk_bf16_f32 v114, v152, v153
    v_mul_f32 v154, v168, v154
    v_mfma_f32_16x16x32_bf16 v[184:187], a[132:135], v[124:127], v[184:187]
    v_mul_f32 v155, v168, v155
    v_cvt_pk_bf16_f32 v115, v154, v155
    v_mfma_f32_16x16x32_bf16 v[184:187], a[136:139], v[136:139], v[184:187]
    v_mul_f32 v116, v168, v116
    v_mul_f32 v117, v168, v117
    v_mfma_f32_16x16x32_bf16 v[184:187], a[140:143], v[160:163], v[184:187]
    v_cvt_pk_bf16_f32 v172, v116, v117
    v_mul_f32 v118, v168, v118
    v_mfma_f32_16x16x32_bf16 v[148:151], a[0:3], v[192:195], 0
    v_mul_f32 v119, v168, v119
    v_cvt_pk_bf16_f32 v173, v118, v119
    v_mfma_f32_16x16x32_bf16 v[148:151], a[4:7], v[208:211], v[148:151]
    v_fma_f32 v164, v120, v120, s32
    v_fmac_f32 v164, v121, v121
    v_mfma_f32_16x16x32_bf16 v[148:151], a[8:11], v[212:215], v[148:151]
    v_fmac_f32 v164, v122, v122
    v_fmac_f32 v164, v123, v123
    v_mfma_f32_16x16x32_bf16 v[148:151], a[12:15], v[124:127], v[148:151]
    v_fmac_f32 v164, v132, v132
    v_fmac_f32 v164, v133, v133
    v_mfma_f32_16x16x32_bf16 v[148:151], a[16:19], v[136:139], v[148:151]
    v_fmac_f32 v164, v134, v134
    v_fmac_f32 v164, v135, v135
    v_mfma_f32_16x16x32_bf16 v[148:151], a[20:23], v[160:163], v[148:151]
    v_fmac_f32 v164, v184, v184
    v_fmac_f32 v164, v185, v185
    v_mfma_f32_16x16x32_bf16 v[116:119], a[24:27], v[192:195], 0
    v_fmac_f32 v164, v186, v186
    v_fmac_f32 v164, v187, v187
    v_mfma_f32_16x16x32_bf16 v[116:119], a[28:31], v[208:211], v[116:119]
    v_xor_b32 v1, 65536, v1
    v_mfma_f32_16x16x32_bf16 v[116:119], a[32:35], v[212:215], v[116:119]
    v_fma_f32 v165, v148, v148, s32
    v_fmac_f32 v165, v149, v149
    v_mfma_f32_16x16x32_bf16 v[116:119], a[36:39], v[124:127], v[116:119]
    v_fmac_f32 v165, v150, v150
    v_fmac_f32 v165, v151, v151
    v_mfma_f32_16x16x32_bf16 v[116:119], a[40:43], v[136:139], v[116:119]
    v_mfma_f32_16x16x32_bf16 v[116:119], a[44:47], v[160:163], v[116:119]
    v_mfma_f32_16x16x32_bf16 v[152:155], a[48:51], v[192:195], 0
    v_mfma_f32_16x16x32_bf16 v[152:155], a[52:55], v[208:211], v[152:155]
    v_mfma_f32_16x16x32_bf16 v[152:155], a[56:59], v[212:215], v[152:155]
    v_mfma_f32_16x16x32_bf16 v[152:155], a[60:63], v[124:127], v[152:155]
    v_mfma_f32_16x16x32_bf16 v[152:155], a[64:67], v[136:139], v[152:155]
    v_mfma_f32_16x16x32_bf16 v[152:155], a[68:71], v[160:163], v[152:155]
    v_mfma_f32_16x16x32_bf16 v[168:171], v[192:195], a[144:147], 0
    ds_read_b128 v[196:199], v5 offset:0
    ds_read_b128 v[216:219], v5 offset:16
    v_mfma_f32_16x16x32_bf16 v[168:171], v[208:211], a[148:151], v[168:171]
    ds_read_b128 v[220:223], v5 offset:48
    ds_read_b32 v157, v6 offset:192
    v_mfma_f32_16x16x32_bf16 v[168:171], v[212:215], a[152:155], v[168:171]
    v_fmac_f32 v165, v116, v116
    v_fmac_f32 v165, v117, v117
    v_mfma_f32_16x16x32_bf16 v[168:171], v[124:127], a[156:159], v[168:171]
    v_fmac_f32 v165, v118, v118
    v_fmac_f32 v165, v119, v119
    v_mfma_f32_16x16x32_bf16 v[168:171], v[136:139], a[160:163], v[168:171]
    v_fmac_f32 v165, v152, v152
    v_fmac_f32 v165, v153, v153
    v_mfma_f32_16x16x32_bf16 v[168:171], v[160:163], a[164:167], v[168:171]
    v_fmac_f32 v165, v154, v154
    v_fmac_f32 v165, v155, v155
    v_mfma_f32_16x16x32_bf16 v[224:227], v[192:195], a[168:171], 0
    v_cvt_pk_bf16_f32 v36, v165, v164
    v_add_u32 v5, 336, v5
    v_mfma_f32_16x16x32_bf16 v[224:227], v[208:211], a[172:175], v[224:227]
    v_mfma_f32_16x16x32_bf16 v[228:231], v[32:35], v[36:39], 0
    s_waitcnt lgkmcnt(2)
    v_cvt_pk_bf16_f32 v232, v168, v169
    v_cvt_pk_bf16_f32 v233, v170, v171
    v_mfma_f32_16x16x32_bf16 v[168:171], v[196:199], v[176:179], v[22:25]
    s_waitcnt lgkmcnt(0)
    v_mfma_f32_16x16x32_bf16 v[168:171], v[216:219], v[200:203], v[168:171]
    v_mfma_f32_16x16x32_bf16 v[168:171], v[220:223], v[140:143], v[168:171]
    v_mfma_f32_16x16x32_bf16 v[224:227], v[212:215], a[176:179], v[224:227]
    v_rsq_f32 v229, v229
    v_mfma_f32_16x16x32_bf16 v[224:227], v[124:127], a[180:183], v[224:227]
    v_rsq_f32 v228, v228
    v_mfma_f32_16x16x32_bf16 v[224:227], v[136:139], a[184:187], v[224:227]
    v_mul_f32 v228, s31, v228
    v_mul_f32 v120, v229, v120
    v_mfma_f32_16x16x32_bf16 v[224:227], v[160:163], a[188:191], v[224:227]
    v_mov_b32_dpp v157, v169 quad_perm:[0,1,2,3] row_mask:0x1 bank_mask:0xf
    v_mul_f32 v121, v229, v121
    v_mfma_f32_16x16x32_bf16 v[236:239], v[192:195], a[192:195], 0
    v_cvt_pk_bf16_f32 v120, v120, v121
    v_mul_f32 v122, v229, v122
    v_mfma_f32_16x16x32_bf16 v[236:239], v[208:211], a[196:199], v[236:239]
    v_mul_f32 v123, v229, v123
    v_cvt_pk_bf16_f32 v121, v122, v123
    v_mfma_f32_16x16x32_bf16 v[236:239], v[212:215], a[200:203], v[236:239]
    v_cvt_pk_bf16_f32 v192, v224, v225
    v_cvt_pk_bf16_f32 v193, v226, v227
    v_mfma_f32_16x16x32_bf16 v[236:239], v[124:127], a[204:207], v[236:239]
    v_mul_f32 v132, v229, v132
    v_mul_f32 v133, v229, v133
    v_mfma_f32_16x16x32_bf16 v[236:239], v[136:139], a[208:211], v[236:239]
    ds_read2_b32 v[234:235], v6 offset0:0 offset1:0
    ds_read2_b32 v[194:195], v6 offset0:16 offset1:16
    v_mfma_f32_16x16x32_bf16 v[236:239], v[160:163], a[212:215], v[236:239]
    s_waitcnt vmcnt(0)
    ds_read2_b32 v[138:139], v6 offset0:32 offset1:32
    v_cvt_pk_bf16_f32 v122, v132, v133
    v_mfma_f32_16x16x32_bf16 v[124:127], v[200:203], v[176:179], v[40:43]
    s_barrier
    buffer_load_dwordx4 v10, s[8:11], 0 offen nt lds
    v_mul_f32 v134, v229, v134
    v_mfma_f32_16x16x32_bf16 v[160:163], v[108:111], v[176:179], v[44:47]
    s_add_u32 m0, s28, 4096
    v_cvt_pk_bf16_f32 v136, v236, v237
    v_cvt_pk_bf16_f32 v137, v238, v239
    v_mul_f32 v135, v229, v135
    v_mfma_f32_16x16x16_bf16 v[124:127], v[142:143], v[140:141], v[124:127]
    v_cvt_pk_bf16_f32 v123, v134, v135
    v_mul_f32 v184, v229, v184
    v_mul_f32 v185, v229, v185
    v_cvt_pk_bf16_f32 v134, v184, v185
    v_mfma_f32_16x16x32_bf16 v[208:211], v[120:123], v[176:179], v[48:51]
    v_mul_f32 v186, v229, v186
    v_mul_f32 v187, v229, v187
    v_cvt_pk_bf16_f32 v135, v186, v187
    v_mfma_f32_16x16x16_bf16 v[160:163], v[174:175], v[140:141], v[160:163]
    v_mul_f32 v148, v228, v148
    v_mul_f32 v149, v228, v149
    v_cvt_pk_bf16_f32 v148, v148, v149
    v_mfma_f32_16x16x16_bf16 v[208:211], v[134:135], v[140:141], v[208:211]
    v_mul_f32 v150, v228, v150
    v_mul_f32 v151, v228, v151
    v_cvt_pk_bf16_f32 v149, v150, v151
    v_mul_f32 v116, v228, v116
    v_mfma_f32_16x16x32_bf16 v[176:179], v[196:199], v[112:115], v[24:27]
    s_waitcnt lgkmcnt(0)
    buffer_load_dwordx4 v11, s[8:11], 0 offen nt lds
    v_mul_f32 v117, v228, v117
    v_mfma_f32_16x16x32_bf16 v[176:179], v[216:219], v[108:111], v[176:179]
    s_add_u32 m0, s28, 8192
    v_cvt_pk_bf16_f32 v150, v116, v117
    v_mul_f32 v118, v228, v118
    v_mfma_f32_16x16x32_bf16 v[176:179], v[220:223], v[172:175], v[176:179]
    v_mul_f32 v119, v228, v119
    v_cvt_pk_bf16_f32 v151, v118, v119
    v_mul_f32 v152, v228, v152
    v_mfma_f32_16x16x16_bf16 v[116:119], a[216:217], v[166:167], v[180:183]
    v_mul_f32 v153, v228, v153
    v_cvt_pk_bf16_f32 v132, v152, v153
    v_mul_f32 v154, v228, v154
    v_mul_f32 v155, v228, v155
    v_mfma_f32_16x16x32_bf16 v[212:215], v[196:199], v[148:151], v[26:29]
    buffer_load_dwordx4 v12, s[8:11], 0 offen nt lds
    v_cvt_pk_bf16_f32 v133, v154, v155
    v_mfma_f32_16x16x32_bf16 v[212:215], v[216:219], v[120:123], v[212:215]
    s_add_u32 m0, s28, 12288
    v_max3_f32 v140, v168, v124, v125
    v_max3_f32 v140, v140, v126, v127
    v_mfma_f32_16x16x32_bf16 v[212:215], v[220:223], v[132:135], v[212:215]
    s_xor_b32 s28, s28, 65536
    v_max3_f32 v140, v140, v160, v161
    v_max3_f32 v140, v140, v162, v163
    v_max3_f32 v140, v140, v208, v209
    v_mfma_f32_16x16x16_bf16 v[152:155], a[240:241], v[166:167], v[180:183]
    v_max3_f32 v140, v140, v210, v211
    v_mov_b32 v141, v140
    v_mov_b32_dpp v157, v177 quad_perm:[0,1,2,3] row_mask:0x2 bank_mask:0xf
    v_mfma_f32_16x16x16_bf16 v[184:187], v[84:85], v[166:167], v[180:183]
    v_permlane32_swap_b32 v140, v141
    v_max_f32 v140, v140, v141
    v_mfma_f32_16x16x16_bf16 v[196:199], a[218:219], v[166:167], v[204:207]
    v_mov_b32 v141, v140
    v_mov_b32_dpp v157, v213 quad_perm:[0,1,2,3] row_mask:0x4 bank_mask:0xf
    v_mov_b32 v158, v157
    v_mfma_f32_16x16x16_bf16 v[180:183], a[242:243], v[166:167], v[204:207]
    v_permlane16_swap_b32 v140, v141
    v_max_f32 v140, v140, v141
    v_mfma_f32_16x16x16_bf16 v[216:219], v[86:87], v[166:167], v[204:207]
    buffer_load_dwordx4 v13, s[8:11], 0 offen nt lds
    s_mov_b32 m0, s29
    s_xor_b32 s29, s29, s30
    v_sub_f32 v124, v124, v140
    v_exp_f32 v124, v124
    v_sub_f32 v125, v125, v140
    v_exp_f32 v125, v125
    v_sub_f32 v126, v126, v140
    v_cvt_pk_bf16_f32 v124, v124, v125
    v_exp_f32 v126, v126
    v_sub_f32 v127, v127, v140
    v_exp_f32 v127, v127
    buffer_load_dwordx4 v14, s[8:11], 0 offen nt lds
    v_cvt_pk_bf16_f32 v125, v126, v127
    v_sub_f32 v160, v160, v140
    v_exp_f32 v160, v160
    v_sub_f32 v161, v161, v140
    v_exp_f32 v161, v161
    v_mfma_f32_16x16x32_bf16 v[204:207], v[200:203], v[112:115], v[52:55]
    v_cvt_pk_bf16_f32 v126, v160, v161
    v_sub_f32 v162, v162, v140
    v_exp_f32 v162, v162
    v_sub_f32 v163, v163, v140
    v_exp_f32 v163, v163
    v_sub_f32 v208, v208, v140
    v_mfma_f32_16x16x16_bf16 v[204:207], v[142:143], v[172:173], v[204:207]
    v_cvt_pk_bf16_f32 v127, v162, v163
    v_exp_f32 v208, v208
    v_sub_f32 v209, v209, v140
    v_exp_f32 v209, v209
    v_mfma_f32_16x16x32_bf16 v[160:163], v[108:111], v[112:115], v[56:59]
    v_cvt_pk_bf16_f32 v36, v208, v209
    v_sub_f32 v210, v210, v140
    v_exp_f32 v210, v210
    v_sub_f32 v211, v211, v140
    v_exp_f32 v211, v211
    v_mfma_f32_16x16x32_bf16 v[220:223], v[120:123], v[112:115], v[60:63]
    v_cvt_pk_bf16_f32 v37, v210, v211
    v_sub_f32 v168, v168, v140
    v_max3_f32 v159, v176, v204, v205
    v_mfma_f32_16x16x16_bf16 v[160:163], v[174:175], v[172:173], v[160:163]
    v_exp_f32 v168, v168
    v_max3_f32 v159, v159, v206, v207
    v_mfma_f32_16x16x16_bf16 v[220:223], v[134:135], v[172:173], v[220:223]
    v_cvt_pk_bf16_f32 v39, v168, 0
    v_max_f32_dpp v158, v158, v158 quad_perm:[1,0,3,2] row_mask:0xf bank_mask:0xf
    v_cvt_pk_bf16_f32 v116, v116, v117
    v_accvgpr_write_b32 a216, v116
    v_mfma_f32_16x16x32_bf16 v[112:115], v[28:31], v[36:39], 0
    v_max3_f32 v159, v159, v160, v161
    v_max3_f32 v159, v159, v162, v163
    v_mfma_f32_16x16x32_bf16 v[112:115], v[28:31], v[124:127], v[112:115]
    v_max3_f32 v159, v159, v220, v221
    v_max3_f32 v159, v159, v222, v223
    v_mfma_f32_16x16x32_bf16 v[168:171], v[232:235], v[36:39], 0
    v_mov_b32 v116, v159
    v_max_f32_dpp v158, v158, v158 quad_perm:[2,3,0,1] row_mask:0xf bank_mask:0xf
    v_mfma_f32_16x16x32_bf16 v[168:171], v[128:131], v[124:127], v[168:171]
    v_permlane32_swap_b32 v159, v116
    v_mfma_f32_16x16x32_bf16 v[208:211], v[192:195], v[36:39], 0
    v_max_f32 v159, v159, v116
    v_mov_b32 v116, v159
    v_mfma_f32_16x16x32_bf16 v[208:211], v[144:147], v[124:127], v[208:211]
    v_rcp_f32 v112, v112
    v_mfma_f32_16x16x32_bf16 v[224:227], v[136:139], v[36:39], 0
    v_permlane16_swap_b32 v159, v116
    v_mfma_f32_16x16x32_bf16 v[224:227], v[188:191], v[124:127], v[224:227]
    v_max_f32 v159, v159, v116
    v_sub_f32 v204, v204, v159
    v_exp_f32 v204, v204
    v_sub_f32 v205, v205, v159
    v_exp_f32 v205, v205
    v_sub_f32 v206, v206, v159
    v_cvt_pk_bf16_f32 v124, v204, v205
    v_exp_f32 v206, v206
    v_sub_f32 v207, v207, v159
    v_exp_f32 v207, v207
    v_sub_f32 v160, v160, v159
    v_cvt_pk_bf16_f32 v125, v206, v207
    v_exp_f32 v160, v160
    v_sub_f32 v161, v161, v159
    v_exp_f32 v161, v161
    v_sub_f32 v162, v162, v159
    v_cvt_pk_bf16_f32 v126, v160, v161
    v_exp_f32 v162, v162
    v_sub_f32 v163, v163, v159
    v_exp_f32 v163, v163
    v_sub_f32 v220, v220, v159
    v_cvt_pk_bf16_f32 v127, v162, v163
    v_exp_f32 v220, v220
    v_sub_f32 v221, v221, v159
    v_exp_f32 v221, v221
    v_sub_f32 v222, v222, v159
    v_cvt_pk_bf16_f32 v36, v220, v221
    v_exp_f32 v222, v222
    v_sub_f32 v223, v223, v159
    v_exp_f32 v223, v223
    v_mfma_f32_16x16x32_bf16 v[160:163], v[200:203], v[148:151], v[64:67]
    v_cvt_pk_bf16_f32 v37, v222, v223
    v_sub_f32 v176, v176, v159
    v_mfma_f32_16x16x32_bf16 v[200:203], v[108:111], v[148:151], v[68:71]
    v_exp_f32 v176, v176
    v_mfma_f32_16x16x32_bf16 v[108:111], v[120:123], v[148:151], v[72:75]
    v_cvt_pk_bf16_f32 v39, v176, 0
    v_mul_f32 v168, v112, v168
    v_mul_f32 v169, v112, v169
    v_mfma_f32_16x16x32_bf16 v[120:123], v[28:31], v[36:39], 0
    v_cvt_pk_bf16_f32 v148, v168, v169
    v_mul_f32 v170, v112, v170
    v_mfma_f32_16x16x32_bf16 v[120:123], v[28:31], v[124:127], v[120:123]
    v_mul_f32 v171, v112, v171
    v_cvt_pk_bf16_f32 v149, v170, v171
    v_mfma_f32_16x16x32_bf16 v[168:171], v[232:235], v[36:39], 0
    v_mul_f32 v208, v112, v208
    v_mul_f32 v209, v112, v209
    v_mfma_f32_16x16x32_bf16 v[168:171], v[128:131], v[124:127], v[168:171]
    v_cvt_pk_bf16_f32 v150, v208, v209
    v_mul_f32 v210, v112, v210
    v_mfma_f32_16x16x32_bf16 v[220:223], v[192:195], v[36:39], 0
    v_mul_f32 v211, v112, v211
    v_cvt_pk_bf16_f32 v151, v210, v211
    v_mfma_f32_16x16x32_bf16 v[220:223], v[144:147], v[124:127], v[220:223]
    ds_write_b128 v3, v[148:151] offset:0
    v_mfma_f32_16x16x32_bf16 v[208:211], v[136:139], v[36:39], 0
    v_mul_f32 v224, v112, v224
    v_mul_f32 v225, v112, v225
    v_mfma_f32_16x16x32_bf16 v[208:211], v[188:191], v[124:127], v[208:211]
    v_cvt_pk_bf16_f32 v164, v224, v225
    v_mul_f32 v226, v112, v226
    v_mul_f32 v227, v112, v227
    v_mfma_f32_16x16x16_bf16 v[160:163], v[142:143], v[132:133], v[160:163]
    v_cvt_pk_bf16_f32 v165, v226, v227
    v_max_f32_dpp v158, v158, v158 row_half_mirror row_mask:0xf bank_mask:0xf
    v_cvt_pk_bf16_f32 v118, v118, v119
    v_mfma_f32_16x16x16_bf16 v[200:203], v[174:175], v[132:133], v[200:203]
    v_max_f32_dpp v158, v158, v158 row_mirror row_mask:0xf bank_mask:0xf
    v_mov_b32 v159, v158
    v_accvgpr_write_b32 a217, v118
    v_mfma_f32_16x16x16_bf16 v[108:111], v[134:135], v[132:133], v[108:111]
    ds_write_b64 v4, v[164:165] offset:4096
    v_permlane32_swap_b32 v158, v159
    v_max_f32 v158, v158, v159
    v_mov_b32 v159, v158
    v_cvt_pk_bf16_f32 v152, v152, v153
    v_accvgpr_write_b32 a240, v152
    v_permlane16_swap_b32 v158, v159
    v_max_f32 v158, v158, v159
    v_sub_f32 v157, v157, v158
    v_exp_f32 v157, v157
    v_cvt_pk_bf16_f32 v154, v154, v155
    v_cvt_pk_bf16_f32 v157, v157, v157
    ds_write_b16 v8, v157
    v_accvgpr_write_b32 a241, v154
    v_cvt_pk_bf16_f32 v84, v184, v185
    v_cvt_pk_bf16_f32 v85, v186, v187
    ds_read_b128 v[112:115], v156 offset:128
    v_cvt_pk_bf16_f32 v196, v196, v197
    v_accvgpr_write_b32 a218, v196
    v_cvt_pk_bf16_f32 v198, v198, v199
    v_accvgpr_write_b32 a219, v198
    v_cvt_pk_bf16_f32 v180, v180, v181
    v_accvgpr_write_b32 a242, v180
    v_cvt_pk_bf16_f32 v182, v182, v183
    v_accvgpr_write_b32 a243, v182
    v_cvt_pk_bf16_f32 v86, v216, v217
    v_cvt_pk_bf16_f32 v87, v218, v219
    ds_read_b128 v[116:119], v156 offset:192
    v_max3_f32 v164, v212, v160, v161
    v_max3_f32 v164, v164, v162, v163
    v_max3_f32 v164, v164, v200, v201
    v_max3_f32 v164, v164, v202, v203
    v_max3_f32 v164, v164, v108, v109
    v_max3_f32 v164, v164, v110, v111
    v_mov_b32 v165, v164
    v_rcp_f32 v120, v120
    v_add_u32 v6, 272, v6
    v_permlane32_swap_b32 v164, v165
    v_max_f32 v164, v164, v165
    v_mov_b32 v165, v164
    s_waitcnt lgkmcnt(1)
    v_mfma_f32_16x16x16_bf16 v[124:127], a[232:233], v[166:167], v[112:115]
    v_permlane16_swap_b32 v164, v165
    v_max_f32 v164, v164, v165
    v_mfma_f32_16x16x16_bf16 v[132:135], v[76:77], v[166:167], v[112:115]
    v_sub_f32 v160, v160, v164
    v_exp_f32 v160, v160
    v_mfma_f32_16x16x16_bf16 v[140:143], v[100:101], v[166:167], v[112:115]
    v_sub_f32 v161, v161, v164
    v_exp_f32 v161, v161
    s_waitcnt lgkmcnt(0)
    v_mfma_f32_16x16x16_bf16 v[148:151], a[220:221], v[166:167], v[116:119]
    v_cvt_pk_bf16_f32 v124, v124, v125
    v_accvgpr_write_b32 a232, v124
    v_cvt_pk_bf16_f32 v126, v126, v127
    v_mfma_f32_16x16x16_bf16 v[112:115], a[244:245], v[166:167], v[116:119]
    v_accvgpr_write_b32 a233, v126
    v_cvt_pk_bf16_f32 v76, v132, v133
    v_cvt_pk_bf16_f32 v77, v134, v135
    v_mfma_f32_16x16x16_bf16 v[124:127], v[88:89], v[166:167], v[116:119]
    v_cvt_pk_bf16_f32 v100, v140, v141
    v_cvt_pk_bf16_f32 v101, v142, v143
    ds_read_b128 v[132:135], v156 offset:256
    v_cvt_pk_bf16_f32 v148, v148, v149
    v_accvgpr_write_b32 a220, v148
    v_cvt_pk_bf16_f32 v150, v150, v151
    v_accvgpr_write_b32 a221, v150
    v_cvt_pk_bf16_f32 v112, v112, v113
    v_accvgpr_write_b32 a244, v112
    v_cvt_pk_bf16_f32 v114, v114, v115
    v_accvgpr_write_b32 a245, v114
    v_cvt_pk_bf16_f32 v88, v124, v125
    v_cvt_pk_bf16_f32 v89, v126, v127
    ds_read_b128 v[116:119], v156 offset:320
    v_cvt_pk_bf16_f32 v140, v160, v161
    v_sub_f32 v162, v162, v164
    v_exp_f32 v162, v162
    ds_read_b128 v[196:199], v0 offset:20480
    ds_read_b128 v[184:187], v1 offset:20480
    ds_read_b128 v[172:175], v0 offset:20608
    ds_read_b128 v[148:151], v1 offset:20608
    ds_read_b128 v[112:115], v0 offset:20736
    s_waitcnt lgkmcnt(6)
    v_mfma_f32_16x16x16_bf16 v[124:127], a[222:223], v[166:167], v[132:135]
    v_sub_f32 v163, v163, v164
    v_exp_f32 v163, v163
    v_mfma_f32_16x16x16_bf16 v[152:155], a[246:247], v[166:167], v[132:135]
    v_cvt_pk_bf16_f32 v141, v162, v163
    v_sub_f32 v200, v200, v164
    v_sub_f32 v201, v201, v164
    v_mfma_f32_16x16x16_bf16 v[160:163], v[90:91], v[166:167], v[132:135]
    ds_read_b128 v[228:231], v1 offset:20736
    s_waitcnt lgkmcnt(6)
    v_mfma_f32_16x16x16_bf16 v[176:179], a[234:235], v[166:167], v[116:119]
    v_cvt_pk_bf16_f32 v124, v124, v125
    v_accvgpr_write_b32 a222, v124
    v_cvt_pk_bf16_f32 v126, v126, v127
    v_mfma_f32_16x16x16_bf16 v[132:135], v[78:79], v[166:167], v[116:119]
    v_accvgpr_write_b32 a223, v126
    v_cvt_pk_bf16_f32 v152, v152, v153
    v_accvgpr_write_b32 a246, v152
    v_mfma_f32_16x16x16_bf16 v[124:127], v[102:103], v[166:167], v[116:119]
    s_waitcnt lgkmcnt(3)
    v_cvt_pk_bf16_f32 v154, v154, v155
    v_accvgpr_write_b32 a247, v154
    v_cvt_pk_bf16_f32 v90, v160, v161
    v_mfma_f32_16x16x32_bf16 v[204:207], a[72:75], v[196:199], 0
    s_waitcnt lgkmcnt(1)
    v_cvt_pk_bf16_f32 v91, v162, v163
    v_cvt_pk_bf16_f32 v176, v176, v177
    v_mfma_f32_16x16x32_bf16 v[204:207], a[76:79], v[184:187], v[204:207]
    ds_read_b128 v[116:119], v156 offset:384
    v_accvgpr_write_b32 a234, v176
    v_mfma_f32_16x16x32_bf16 v[204:207], a[80:83], v[172:175], v[204:207]
    v_cvt_pk_bf16_f32 v178, v178, v179
    v_accvgpr_write_b32 a235, v178
    v_mfma_f32_16x16x32_bf16 v[204:207], a[84:87], v[148:151], v[204:207]
    s_waitcnt lgkmcnt(1)
    v_cvt_pk_bf16_f32 v78, v132, v133
    v_cvt_pk_bf16_f32 v79, v134, v135
    v_mfma_f32_16x16x32_bf16 v[204:207], a[88:91], v[112:115], v[204:207]
    v_cvt_pk_bf16_f32 v102, v124, v125
    v_cvt_pk_bf16_f32 v103, v126, v127
    v_mfma_f32_16x16x32_bf16 v[204:207], a[92:95], v[228:231], v[204:207]
    ds_read_b128 v[124:127], v156 offset:448
    v_sub_f32 v202, v202, v164
    v_mfma_f32_16x16x32_bf16 v[176:179], a[96:99], v[196:199], 0
    v_exp_f32 v200, v200
    v_mfma_f32_16x16x32_bf16 v[176:179], a[100:103], v[184:187], v[176:179]
    v_exp_f32 v201, v201
    v_mfma_f32_16x16x32_bf16 v[176:179], a[104:107], v[172:175], v[176:179]
    v_cvt_pk_bf16_f32 v142, v200, v201
    v_sub_f32 v203, v203, v164
    v_mfma_f32_16x16x32_bf16 v[176:179], a[108:111], v[148:151], v[176:179]
    s_waitcnt lgkmcnt(1)
    v_exp_f32 v202, v202
    v_sub_f32 v108, v108, v164
    v_mfma_f32_16x16x16_bf16 v[132:135], a[224:225], v[166:167], v[116:119]
    v_exp_f32 v203, v203
    v_sub_f32 v109, v109, v164
    v_mfma_f32_16x16x16_bf16 v[152:155], a[248:249], v[166:167], v[116:119]
    v_cvt_pk_bf16_f32 v143, v202, v203
    v_exp_f32 v108, v108
    v_mfma_f32_16x16x16_bf16 v[160:163], v[92:93], v[166:167], v[116:119]
    v_exp_f32 v109, v109
    v_sub_f32 v110, v110, v164
    v_cvt_pk_bf16_f32 v132, v132, v133
    v_mfma_f32_16x16x32_bf16 v[176:179], a[112:115], v[112:115], v[176:179]
    s_waitcnt lgkmcnt(0)
    v_accvgpr_write_b32 a224, v132
    v_cvt_pk_bf16_f32 v134, v134, v135
    v_accvgpr_write_b32 a225, v134
    v_mfma_f32_16x16x16_bf16 v[116:119], a[226:227], v[166:167], v[124:127]
    v_cvt_pk_bf16_f32 v152, v152, v153
    v_accvgpr_write_b32 a248, v152
    v_cvt_pk_bf16_f32 v154, v154, v155
    v_mfma_f32_16x16x16_bf16 v[132:135], a[250:251], v[166:167], v[124:127]
    v_accvgpr_write_b32 a249, v154
    v_cvt_pk_bf16_f32 v92, v160, v161
    v_cvt_pk_bf16_f32 v93, v162, v163
    v_mfma_f32_16x16x16_bf16 v[152:155], v[94:95], v[166:167], v[124:127]
    v_cvt_pk_bf16_f32 v116, v116, v117
    v_accvgpr_write_b32 a226, v116
    v_cvt_pk_bf16_f32 v118, v118, v119
    v_accvgpr_write_b32 a227, v118
    v_mfma_f32_16x16x32_bf16 v[176:179], a[116:119], v[228:231], v[176:179]
    ds_read_b128 v[116:119], v156 offset:512
    v_cvt_pk_bf16_f32 v132, v132, v133
    v_mfma_f32_16x16x32_bf16 v[124:127], a[120:123], v[196:199], 0
    v_accvgpr_write_b32 a250, v132
    v_cvt_pk_bf16_f32 v134, v134, v135
    v_mfma_f32_16x16x32_bf16 v[124:127], a[124:127], v[184:187], v[124:127]
    v_accvgpr_write_b32 a251, v134
    v_cvt_pk_bf16_f32 v94, v152, v153
    v_mfma_f32_16x16x32_bf16 v[124:127], a[128:131], v[172:175], v[124:127]
    v_cvt_pk_bf16_f32 v95, v154, v155
    v_cvt_pk_bf16_f32 v36, v108, v109
    v_mfma_f32_16x16x32_bf16 v[124:127], a[132:135], v[148:151], v[124:127]
    ds_read_b128 v[132:135], v156 offset:576
    v_sub_f32 v111, v111, v164
    v_mfma_f32_16x16x32_bf16 v[124:127], a[136:139], v[112:115], v[124:127]
    v_exp_f32 v110, v110
    v_mfma_f32_16x16x32_bf16 v[124:127], a[140:143], v[228:231], v[124:127]
    v_exp_f32 v111, v111
    v_mfma_f32_16x16x32_bf16 v[216:219], a[0:3], v[196:199], 0
    ds_read_b128 v[152:155], v9
    ds_read_b128 v[160:163], v9 offset:64
    v_mfma_f32_16x16x32_bf16 v[216:219], a[4:7], v[184:187], v[216:219]
    s_waitcnt lgkmcnt(3)
    v_cvt_pk_bf16_f32 v37, v110, v111
    v_sub_f32 v212, v212, v164
    v_mul_f32 v168, v120, v168
    v_mfma_f32_16x16x16_bf16 v[108:111], a[236:237], v[166:167], v[116:119]
    v_exp_f32 v212, v212
    v_mul_f32 v169, v120, v169
    v_mfma_f32_16x16x16_bf16 v[180:183], v[80:81], v[166:167], v[116:119]
    v_cvt_pk_bf16_f32 v39, v212, 0
    v_cvt_pk_bf16_f32 v168, v168, v169
    v_mul_f32 v170, v120, v170
    v_mul_f32 v171, v120, v171
    v_mfma_f32_16x16x32_bf16 v[200:203], v[28:31], v[36:39], 0
    s_waitcnt lgkmcnt(2)
    v_cvt_pk_bf16_f32 v108, v108, v109
    v_accvgpr_write_b32 a236, v108
    v_mfma_f32_16x16x32_bf16 v[200:203], v[28:31], v[140:143], v[200:203]
    v_cvt_pk_bf16_f32 v110, v110, v111
    v_accvgpr_write_b32 a237, v110
    v_mfma_f32_16x16x32_bf16 v[108:111], v[232:235], v[36:39], 0
    v_cvt_pk_bf16_f32 v80, v180, v181
    v_cvt_pk_bf16_f32 v81, v182, v183
    v_mfma_f32_16x16x32_bf16 v[108:111], v[128:131], v[140:143], v[108:111]
    s_waitcnt lgkmcnt(0)
    v_cvt_pk_bf16_f32 v169, v170, v171
    v_mul_f32 v220, v120, v220
    v_mfma_f32_16x16x32_bf16 v[180:183], v[192:195], v[36:39], 0
    v_mul_f32 v221, v120, v221
    v_cvt_pk_bf16_f32 v170, v220, v221
    v_mfma_f32_16x16x32_bf16 v[180:183], v[144:147], v[140:143], v[180:183]
    v_mul_f32 v222, v120, v222
    v_mul_f32 v223, v120, v223
    v_mfma_f32_16x16x32_bf16 v[212:215], v[136:139], v[36:39], 0
    v_cvt_pk_bf16_f32 v171, v222, v223
    v_mul_f32 v208, v120, v208
    v_mfma_f32_16x16x32_bf16 v[212:215], v[188:191], v[140:143], v[212:215]
    ds_write_b128 v3, v[168:171] offset:6144
    v_mfma_f32_16x16x16_bf16 v[140:143], v[104:105], v[166:167], v[116:119]
    v_mul_f32 v209, v120, v209
    v_cvt_pk_bf16_f32 v164, v208, v209
    v_mul_f32 v210, v120, v210
    v_mfma_f32_16x16x16_bf16 v[220:223], a[228:229], v[166:167], v[132:135]
    v_mul_f32 v211, v120, v211
    v_cvt_pk_bf16_f32 v165, v210, v211
    v_fma_f32 v169, v204, v204, s32
    v_mfma_f32_16x16x16_bf16 v[116:119], a[252:253], v[166:167], v[132:135]
    v_cvt_pk_bf16_f32 v104, v140, v141
    v_cvt_pk_bf16_f32 v105, v142, v143
    v_fmac_f32 v169, v205, v205
    v_mfma_f32_16x16x16_bf16 v[120:123], v[96:97], v[166:167], v[132:135]
    v_cvt_pk_bf16_f32 v220, v220, v221
    v_accvgpr_write_b32 a228, v220
    v_cvt_pk_bf16_f32 v222, v222, v223
    v_accvgpr_write_b32 a229, v222
    v_mfma_f32_16x16x32_bf16 v[132:135], v[152:155], v[28:31], 0
    ds_read_b128 v[140:143], v156 offset:640
    v_cvt_pk_bf16_f32 v116, v116, v117
    v_mfma_f32_16x16x32_bf16 v[132:135], v[160:163], v[28:31], v[132:135]
    ds_write_b64 v4, v[164:165] offset:10240
    v_mfma_f32_16x16x32_bf16 v[208:211], v[152:155], v[128:131], 0
    v_accvgpr_write_b32 a252, v116
    v_cvt_pk_bf16_f32 v118, v118, v119
    v_mfma_f32_16x16x32_bf16 v[208:211], v[160:163], v[232:235], v[208:211]
    v_accvgpr_write_b32 a253, v118
    v_cvt_pk_bf16_f32 v96, v120, v121
    v_mfma_f32_16x16x32_bf16 v[116:119], v[152:155], v[144:147], 0
    v_cvt_pk_bf16_f32 v97, v122, v123
    v_fmac_f32 v169, v206, v206
    v_mfma_f32_16x16x32_bf16 v[116:119], v[160:163], v[192:195], v[116:119]
    ds_read_b128 v[120:123], v156 offset:704
    v_fmac_f32 v169, v207, v207
    v_mfma_f32_16x16x32_bf16 v[128:131], v[152:155], v[188:191], 0
    v_rcp_f32 v132, v132
    v_mfma_f32_16x16x32_bf16 v[128:131], v[160:163], v[136:139], v[128:131]
    s_waitcnt lgkmcnt(2)
    v_mul_f32 v208, v208, v132
    v_rcp_f32 v200, v200
    v_mfma_f32_16x16x16_bf16 v[136:139], a[230:231], v[166:167], v[140:143]
    v_mul_f32_dpp v208, v116, v132 quad_perm:[0,1,2,3] row_mask:0x2 bank_mask:0xf
    v_mul_f32 v108, v200, v108
    v_mul_f32 v109, v200, v109
    v_mfma_f32_16x16x16_bf16 v[116:119], a[254:255], v[166:167], v[140:143]
    v_mul_f32_dpp v208, v128, v132 quad_perm:[0,1,2,3] row_mask:0x4 bank_mask:0xf
    v_cvt_pk_bf16_f32 v208, v208, v208
    v_cvt_pk_bf16_f32 v108, v108, v109
    v_mfma_f32_16x16x16_bf16 v[128:131], v[98:99], v[166:167], v[140:143]
    v_cvt_pk_bf16_f32 v136, v136, v137
    v_accvgpr_write_b32 a230, v136
    v_cvt_pk_bf16_f32 v138, v138, v139
    v_accvgpr_write_b32 a231, v138
    v_mfma_f32_16x16x32_bf16 v[216:219], a[8:11], v[172:175], v[216:219]
    ds_write_b16 v7, v208
    v_mfma_f32_16x16x32_bf16 v[216:219], a[12:15], v[148:151], v[216:219]
    s_waitcnt lgkmcnt(1)
    v_cvt_pk_bf16_f32 v116, v116, v117
    v_accvgpr_write_b32 a254, v116
    v_cvt_pk_bf16_f32 v118, v118, v119
    v_mfma_f32_16x16x16_bf16 v[132:135], a[238:239], v[166:167], v[120:123]
    v_accvgpr_write_b32 a255, v118
    v_cvt_pk_bf16_f32 v98, v128, v129
    v_cvt_pk_bf16_f32 v99, v130, v131
    v_mfma_f32_16x16x16_bf16 v[116:119], v[82:83], v[166:167], v[120:123]
    v_mul_f32 v110, v200, v110
    v_mul_f32 v111, v200, v111
    v_cvt_pk_bf16_f32 v109, v110, v111
    v_mfma_f32_16x16x16_bf16 v[128:131], v[106:107], v[166:167], v[120:123]
    v_cvt_pk_bf16_f32 v132, v132, v133
    v_accvgpr_write_b32 a238, v132
    v_cvt_pk_bf16_f32 v134, v134, v135
    v_accvgpr_write_b32 a239, v134
    v_mfma_f32_16x16x32_bf16 v[216:219], a[16:19], v[112:115], v[216:219]
    v_cvt_pk_bf16_f32 v82, v116, v117
    v_cvt_pk_bf16_f32 v83, v118, v119
    v_mfma_f32_16x16x32_bf16 v[216:219], a[20:23], v[228:231], v[216:219]
    v_cvt_pk_bf16_f32 v106, v128, v129
    v_cvt_pk_bf16_f32 v107, v130, v131
    v_mfma_f32_16x16x32_bf16 v[160:163], a[24:27], v[196:199], 0
    v_mul_f32 v180, v200, v180
    v_mul_f32 v181, v200, v181
    v_mfma_f32_16x16x32_bf16 v[160:163], a[28:31], v[184:187], v[160:163]
    v_cvt_pk_bf16_f32 v110, v180, v181
    v_mul_f32 v182, v200, v182
    v_mfma_f32_16x16x32_bf16 v[160:163], a[32:35], v[172:175], v[160:163]
    v_mul_f32 v183, v200, v183
    v_cvt_pk_bf16_f32 v111, v182, v183
    v_mfma_f32_16x16x32_bf16 v[160:163], a[36:39], v[148:151], v[160:163]
    ds_write_b128 v3, v[108:111] offset:12288
    v_mfma_f32_16x16x32_bf16 v[160:163], a[40:43], v[112:115], v[160:163]
    v_mul_f32 v212, v200, v212
    v_mul_f32 v213, v200, v213
    v_mfma_f32_16x16x32_bf16 v[160:163], a[44:47], v[228:231], v[160:163]
    v_cvt_pk_bf16_f32 v212, v212, v213
    v_mul_f32 v214, v200, v214
    v_mfma_f32_16x16x32_bf16 v[116:119], a[48:51], v[196:199], 0
    v_mul_f32 v215, v200, v215
    v_cvt_pk_bf16_f32 v213, v214, v215
    v_mfma_f32_16x16x32_bf16 v[116:119], a[52:55], v[184:187], v[116:119]
    ds_write_b64 v4, v[212:213] offset:16384
    v_mfma_f32_16x16x32_bf16 v[116:119], a[56:59], v[172:175], v[116:119]
    v_add_u32 v7, 16, v7
    v_fmac_f32 v169, v176, v176
    v_mfma_f32_16x16x32_bf16 v[116:119], a[60:63], v[148:151], v[116:119]
    v_fmac_f32 v169, v177, v177
    v_fmac_f32 v169, v178, v178
    v_mfma_f32_16x16x32_bf16 v[116:119], a[64:67], v[112:115], v[116:119]
    v_fmac_f32 v169, v179, v179
    v_fmac_f32 v169, v124, v124
    v_mfma_f32_16x16x32_bf16 v[116:119], a[68:71], v[228:231], v[116:119]
    v_fmac_f32 v169, v125, v125
    v_fmac_f32 v169, v126, v126
    v_mfma_f32_16x16x32_bf16 v[128:131], v[196:199], a[144:147], 0
    v_fmac_f32 v169, v127, v127
    v_fma_f32 v168, v216, v216, s32
    v_mfma_f32_16x16x32_bf16 v[128:131], v[184:187], a[148:151], v[128:131]
    v_fmac_f32 v168, v217, v217
    v_fmac_f32 v168, v218, v218
    v_mfma_f32_16x16x32_bf16 v[128:131], v[172:175], a[152:155], v[128:131]
    s_waitcnt lgkmcnt(0)
    v_fmac_f32 v168, v219, v219
    v_xor_b32 v3, 65536, v3
    v_mfma_f32_16x16x32_bf16 v[128:131], v[148:151], a[156:159], v[128:131]
    s_barrier
    v_xor_b32 v4, 65536, v4
    v_mfma_f32_16x16x32_bf16 v[128:131], v[112:115], a[160:163], v[128:131]
    v_mfma_f32_16x16x32_bf16 v[128:131], v[228:231], a[164:167], v[128:131]
    s_branch L_go
.section .rodata,"a"
.p2align 6
.amdhsa_kernel standalone__window_attn_swin_v2__vision_kernel
  .amdhsa_next_free_vgpr 512
  .amdhsa_next_free_sgpr 102
  .amdhsa_accum_offset 256
  .amdhsa_group_segment_fixed_size 0
  .amdhsa_kernarg_size 96
  .amdhsa_user_sgpr_count 2
  .amdhsa_user_sgpr_kernarg_segment_ptr 1
  .amdhsa_system_sgpr_workgroup_id_x 1
  .amdhsa_float_denorm_mode_32 3
.end_amdhsa_kernel
```

```asm
; @launch grid=(256,1,1) block=(256,1,1) lds=163840
.amdgcn_target "amdgcn-amd-amdhsa--gfx950"
.text
.globl standalone__window_attn_swin_v2__vision_kernel
.p2align 12
.p2align 8
.type standalone__window_attn_swin_v2__vision_kernel,@function
standalone__window_attn_swin_v2__vision_kernel:
    s_mov_b32 s44, 0
L_again:
    s_load_dwordx16 s[76:91], s[0:1], 0
    v_readfirstlane_b32 s16, v0
    s_cmp_ge_u32 s2, 256
    s_cbranch_scc1 L_done
    s_lshr_b32 s16, s16, 6
    s_cbranch_scc1 L_nopf
    s_getpc_b64 s[96:97]
    s_bfe_u32 s3, s2, 0x30003
    s_mul_i32 s3, s3, 38
    v_cmp_gt_u32 vcc, 26, v0
    v_add_u32 v190, s3, v0
    v_mov_b32 v191, 0
    v_cndmask_b32 v190, v190, v0, vcc
    v_lshlrev_b32 v190, 7, v190
    v_lshl_add_u64 v[190:191], s[96:97], 0, v[190:191]
    global_load_dword a255, v[190:191], off offset:992
L_nopf:
    s_max_u32 s3, s2, s44
    s_cmp_ge_u32 s3, 247
    s_cbranch_scc1 L_edge
    v_mov_b32 v190, v0
    v_mov_b32 v191, 0x40000000
    v_and_b32 v254, 63, v0
    s_bfe_u32 s3, s2, 0x50003
    s_lshl_b32 s4, s16, 3
    s_lshr_b32 s98, 0x00123600, s4
    s_and_b32 s98, s98, 0xff
    s_mul_i32 s3, s3, s98
    s_lshr_b32 s4, 0x05113500, s4
    s_and_b32 s4, s4, 0xff
    v_min_u32 v114, s4, v254
    v_add_lshl_u32 v114, v114, s3, 7
    v_mov_b32 v115, 0
    v_lshrrev_b32 v255, 4, v254
    v_and_b32 v116, 15, v254
    s_mov_b32 s10, 100270464
    s_mov_b32 s11, 0x00020000
    s_mov_b32 s50, 221184
    s_mov_b32 s51, 0x00020000
    v_mul_u32_u24 v117, 171, v254
    v_lshrrev_b32 v117, 10, v117
    v_lshrrev_b32 v122, 1, v117
    v_xor_b32 v122, v122, v117
    v_and_b32 v122, 4, v122
    v_mul_u32_u24 v122, 3, v122
    v_xor_b32 v122, v122, v117
    v_mul_u32_u24 v122, 1152, v122
    v_mul_u32_u24 v123, 96, v117
    v_sub_u32 v122, v122, v123
    v_lshl_add_u32 v123, v254, 4, v122
    v_add_u32 v122, 64, v254
    v_mul_u32_u24 v122, 171, v122
    v_lshrrev_b32 v122, 10, v122
    v_lshrrev_b32 v124, 1, v122
    v_xor_b32 v124, v124, v122
    v_and_b32 v124, 4, v124
    v_mul_u32_u24 v124, 3, v124
    v_xor_b32 v124, v124, v122
    v_mul_u32_u24 v124, 1152, v124
    v_mul_u32_u24 v125, 96, v122
    v_sub_u32 v124, v124, v125
    v_lshl_add_u32 v125, v254, 4, v124
    v_add_u32 v124, 128, v254
    v_mul_u32_u24 v124, 171, v124
    v_lshrrev_b32 v124, 10, v124
    v_lshrrev_b32 v126, 1, v124
    v_xor_b32 v126, v126, v124
    v_and_b32 v126, 4, v126
    v_mul_u32_u24 v126, 3, v126
    v_xor_b32 v126, v126, v124
    v_mul_u32_u24 v126, 1152, v126
    v_mul_u32_u24 v127, 96, v124
    v_sub_u32 v126, v126, v127
    v_lshl_add_u32 v127, v254, 4, v126
    s_mul_i32 s68, s16, 6144
    s_add_u32 s69, s68, 65536
    s_cmp_eq_u32 s16, 3
    s_cselect_b32 s68, 136704, s68
    s_cselect_b32 s69, 142848, s69
    s_mul_i32 s45, s16, 96
    s_mov_b32 s70, 193536
    s_mov_b32 s36, 100270464
    s_mov_b32 s22, 1180032
    s_mul_i32 s3, s2, 911
    s_lshr_b32 s3, s3, 16
    s_mul_i32 s99, s3, 72
    s_sub_u32 s38, s2, s99
    s_mul_i32 s3, s3, 1373568
    s_mul_i32 s99, s38, 2688
    s_add_u32 s3, s3, s99
    s_add_u32 s25, s3, 589824
    s_add_u32 s7, s3, 1769472
    s_mov_b32 s20, 31
    s_mov_b32 s21, 4204032
    s_cmp_lt_u32 s2, 244
    s_cselect_b32 s17, 21, 20
    v_mul_u32_u24 v126, 2731, v190
    v_bfe_u32 v128, v126, 17, 3
    v_lshrrev_b32 v126, 16, v126
    v_xor_b32 v129, v128, v190
    v_mul_u32_u24 v128, 37, v126
    v_lshrrev_b32 v128, 8, v128
    v_lshlrev_b32 v129, 4, v129
    v_mad_u32_u24 v10, v128, s70, v129
    v_mul_u32_u24 v128, s20, v126
    v_add_u32 v128, s38, v128
    v_mul_u32_u24 v128, 911, v128
    v_lshrrev_b32 v128, 16, v128
    v_mul_u32_u24 v128, s22, v128
    v_mad_u32_u24 v128, v126, s21, v128
    v_cmp_gt_u32 vcc, s17, v126
    v_add_u32 v128, s7, v128
    s_nop 0
    v_cndmask_b32 v128, v191, v128, vcc
    v_mul_u32_u24 v126, 384, v126
    v_sub_u32 v126, v129, v126
    v_add_u32 v128, v128, v126
    v_add_u32 v126, 256, v190
    v_mul_u32_u24 v129, 2731, v126
    v_bfe_u32 v130, v129, 17, 3
    v_lshrrev_b32 v129, 16, v129
    v_xor_b32 v126, v130, v126
    v_mul_u32_u24 v130, 37, v129
    v_lshrrev_b32 v130, 8, v130
    v_lshlrev_b32 v126, 4, v126
    v_mad_u32_u24 v11, v130, s70, v126
    v_mul_u32_u24 v130, s20, v129
    v_add_u32 v130, s38, v130
    v_mul_u32_u24 v130, 911, v130
    v_lshrrev_b32 v130, 16, v130
    v_mul_u32_u24 v130, s22, v130
    v_mad_u32_u24 v130, v129, s21, v130
    v_cmp_gt_u32 vcc, s17, v129
    v_add_u32 v130, s7, v130
    s_nop 0
    v_cndmask_b32 v130, v191, v130, vcc
    v_mul_u32_u24 v129, 384, v129
    v_sub_u32 v129, v126, v129
    v_add_u32 v130, v130, v129
    s_lshl_b32 s28, s16, 10
    s_add_u32 s28, s28, 20480
    s_waitcnt lgkmcnt(0)
    s_cmp_eq_u32 s16, 2
    s_cselect_b64 s[98:99], s[80:81], s[78:79]
    s_cmp_eq_u32 s16, 3
    s_cselect_b64 s[98:99], s[88:89], s[98:99]
    s_mov_b64 s[8:9], s[76:77]
    v_lshl_add_u64 v[114:115], s[98:99], 0, v[114:115]
    s_cmp_eq_u32 s16, 2
    s_cselect_b64 s[98:99], s[84:85], s[82:83]
    s_cmp_eq_u32 s16, 3
    s_cselect_b64 s[98:99], s[86:87], s[98:99]
    v_writelane_b32 v114, s98, 63
    v_writelane_b32 v115, s99, 63
    s_cmp_eq_u32 s16, 0
    s_cbranch_scc1 L_nowu
    global_load_dword a254, v[114:115], off
L_nowu:
    s_add_u32 m0, s28, 128512
    s_nop 0
    buffer_load_dwordx4 v128, s[8:11], 0 offen lds
    s_add_u32 m0, s28, 132608
    s_nop 0
    buffer_load_dwordx4 v130, s[8:11], 0 offen lds
    s_add_u32 m0, s28, 0
    s_nop 0
    buffer_load_dwordx4 v10, s[8:11], s25 offen lds
    s_add_u32 m0, s28, 4096
    s_nop 0
    buffer_load_dwordx4 v11, s[8:11], s25 offen lds
    s_mov_b64 s[48:49], s[78:79]
    s_mov_b64 s[52:53], s[80:81]
    s_mov_b64 s[60:61], s[84:85]
    s_mov_b64 s[64:65], s[86:87]
    s_mov_b64 s[56:57], s[88:89]
    s_mov_b64 s[46:47], s[82:83]
    s_load_dwordx2 s[42:43], s[0:1], 72
    s_add_u32 m0, s68, 0
    s_add_u32 s4, s45, 384
    v_add_u32 v114, s16, v254
    v_and_b32 v114, 3, v114
    v_lshlrev_b32 v114, 1, v114
    s_mov_b32 s54, 73728
    s_mov_b32 s55, 0x00020000
    s_mov_b32 s62, 64
    s_mov_b32 s63, 0x00020000
    s_mov_b32 s66, 128
    s_mov_b32 s67, 0x00020000
    s_mov_b32 s58, 676
    s_mov_b32 s59, 0x00020000
    s_mov_b32 s14, 0
    s_mov_b32 s15, 0x00020000
    v_mov_b32 v193, 0
    v_cmp_lt_u32 s[92:93], 7, v116
    v_mov_b32 v119, 0
    v_mov_b32 v129, 0
    v_mov_b32 v121, 0
    v_lshlrev_b32 v115, 1, v254
    v_mul_u32_u24 v126, 12, v116
    s_mul_i32 s71, s16, 192
    v_add_u32 v126, s71, v126
    v_lshlrev_b32 v128, 5, v255
    s_mul_i32 s72, s16, 8064
    s_add_u32 s72, s72, 104448
    s_mul_i32 s73, s16, 6528
    s_add_u32 s73, s73, 38912
    v_lshrrev_b32 v120, 2, v116
    v_and_b32 v118, 1, v120
    v_mul_u32_u24 v118, 0x020202, v118
    v_lshl_or_b32 v118, v118, 8, v118
    v_add_u32 v118, 0x05040100, v118
    v_and_b32 v131, 3, v116
    v_lshrrev_b32 v192, 1, v116
    v_xor_b32 v192, v192, v255
    v_mul_u32_u24 v130, 384, v116
    v_lshl_add_u32 v0, v192, 4, v130
    v_xor_b32 v1, 64, v0
    v_and_b32 v192, 2, v255
    v_add_u32 v192, v192, v255
    v_lshl_add_u32 v192, v192, 2, v120
    v_mul_u32_u24 v192, 96, v192
    v_lshl_add_u32 v192, v131, 3, v192
    v_add_u32 v133, s68, v192
    v_add_u32 v130, s69, v192
    v_add_u32 v132, s72, v192
    v_add_u32 v134, s73, v192
    v_mov_b32 v28, 0x3f803f80
    v_mov_b32 v29, 0x3f803f80
    v_mov_b32 v30, 0x3f803f80
    v_mov_b32 v31, 0x3f803f80
    v_mul_u32_u24 v135, 768, v255
    v_add_u32 v135, v126, v135
    v_add_u32 v135, 157184, v135
    s_mov_b32 s76, 0x3f80
    v_and_b32 v137, 1, v116
    v_lshlrev_b32 v137, 4, v137
    v_lshlrev_b32 v136, v137, s76
    v_mov_b32 v139, 0x3c003c00
    v_mov_b32 v44, 1.0
    v_mov_b32 v45, 1.0
    v_lshlrev_b32 v138, 4, v255
    s_mov_b32 s19, s38
    s_mov_b32 s23, s25
    s_mov_b32 s26, 0
    s_mov_b32 s27, 0
    s_mov_b32 s18, 0
    s_add_u32 s19, s19, s20
    s_add_u32 s23, s23, s21
    s_cmp_ge_u32 s19, 72
    s_cselect_b32 s34, 72, 0
    s_cselect_b32 s35, s22, 0
    s_sub_u32 s19, s19, s34
    s_add_u32 s23, s23, s35
    s_mov_b32 s24, s23
    s_add_u32 s19, s19, s20
    s_add_u32 s23, s23, s21
    s_cmp_ge_u32 s19, 72
    s_cselect_b32 s34, 72, 0
    s_cselect_b32 s35, s22, 0
    s_sub_u32 s19, s19, s34
    s_add_u32 s23, s23, s35
    s_mul_i32 s79, s16, 64
    v_lshl_add_u32 v141, v255, 4, s79
    s_mul_i32 s80, s16, 32
    s_add_u32 s80, s80, 256
    v_lshl_add_u32 v140, v255, 3, s80
    v_add_u32 v192, 0, v116
    v_mul_u32_u24 v142, 37, v192
    v_mul_u32_u24 v143, 384, v192
    v_lshrrev_b32 v142, 8, v142
    v_mad_u32_u24 v143, v142, s70, v143
    v_add_u32 v15, v143, v141
    v_add_u32 v18, v143, v140
    v_add_u32 v144, 16, v116
    v_mul_u32_u24 v143, 37, v144
    v_mul_u32_u24 v145, 384, v144
    v_lshrrev_b32 v143, 8, v143
    v_mad_u32_u24 v145, v143, s70, v145
    v_add_u32 v16, v145, v141
    v_add_u32 v19, v145, v140
    v_add_u32 v146, 32, v116
    v_mul_u32_u24 v145, 37, v146
    v_mul_u32_u24 v147, 384, v146
    v_lshrrev_b32 v145, 8, v145
    v_mad_u32_u24 v147, v145, s70, v147
    v_add_u32 v17, v147, v141
    v_add_u32 v20, v147, v140
    s_mul_i32 s81, s16, 768
    s_add_u32 s81, s81, 157184
    v_mul_u32_u24 v142, 24, v142
    v_lshl_add_u32 v142, v192, 2, v142
    v_add_u32 v22, s81, v142
    v_sub_u32 v23, s81, v142
    v_sub_u32 v192, v22, v138
    v_mul_u32_u24 v140, 24, v143
    v_lshl_add_u32 v140, v144, 2, v140
    v_add_u32 v24, s81, v140
    v_sub_u32 v25, s81, v140
    v_sub_u32 v141, v24, v138
    v_mul_u32_u24 v140, 24, v145
    v_lshl_add_u32 v140, v146, 2, v140
    v_add_u32 v26, s81, v140
    v_sub_u32 v27, s81, v140
    v_sub_u32 v140, v26, v138
    v_mul_u32_u24 v142, 148, v255
    s_mov_b32 s82, -24
    v_add_u32 v143, 0, v142
    v_lshrrev_b32 v143, 8, v143
    v_mad_i32_i24 v46, v143, s82, v192
    v_mad_i32_i24 v58, v143, s82, v141
    v_mad_i32_i24 v70, v143, s82, v140
    v_add_u32 v143, 37, v142
    v_lshrrev_b32 v143, 8, v143
    v_mad_i32_i24 v47, v143, s82, v192
    v_mad_i32_i24 v59, v143, s82, v141
    v_mad_i32_i24 v71, v143, s82, v140
    v_add_u32 v143, 74, v142
    v_lshrrev_b32 v143, 8, v143
    v_mad_i32_i24 v48, v143, s82, v192
    v_mad_i32_i24 v60, v143, s82, v141
    v_mad_i32_i24 v72, v143, s82, v140
    v_add_u32 v143, 111, v142
    v_lshrrev_b32 v143, 8, v143
    v_mad_i32_i24 v49, v143, s82, v192
    v_mad_i32_i24 v61, v143, s82, v141
    v_mad_i32_i24 v73, v143, s82, v140
    v_add_u32 v143, 592, v142
    v_lshrrev_b32 v143, 8, v143
    v_mad_i32_i24 v50, v143, s82, v192
    v_mad_i32_i24 v62, v143, s82, v141
    v_mad_i32_i24 v74, v143, s82, v140
    v_add_u32 v143, 629, v142
    v_lshrrev_b32 v143, 8, v143
    v_mad_i32_i24 v51, v143, s82, v192
    v_mad_i32_i24 v63, v143, s82, v141
    v_mad_i32_i24 v75, v143, s82, v140
    v_add_u32 v143, 666, v142
    v_lshrrev_b32 v143, 8, v143
    v_mad_i32_i24 v52, v143, s82, v192
    v_mad_i32_i24 v64, v143, s82, v141
    v_mad_i32_i24 v76, v143, s82, v140
    v_add_u32 v143, 703, v142
    v_lshrrev_b32 v143, 8, v143
    v_mad_i32_i24 v53, v143, s82, v192
    v_mad_i32_i24 v65, v143, s82, v141
    v_mad_i32_i24 v77, v143, s82, v140
    v_add_u32 v143, 1184, v142
    v_lshrrev_b32 v143, 8, v143
    v_mad_i32_i24 v54, v143, s82, v192
    v_mad_i32_i24 v66, v143, s82, v141
    s_lshr_b32 s83, s16, 1
    s_and_b32 s84, s16, 1
    buffer_load_dwordx4 v123, s[48:51], s4 offen lds
    v_mad_i32_i24 v78, v143, s82, v140
    v_add_u32 v143, 1221, v142
    v_lshrrev_b32 v143, 8, v143
    v_mad_i32_i24 v55, v143, s82, v192
    v_mad_i32_i24 v67, v143, s82, v141
    v_mad_i32_i24 v79, v143, s82, v140
    v_add_u32 v143, 1258, v142
    v_lshrrev_b32 v143, 8, v143
    v_mad_i32_i24 v56, v143, s82, v192
    v_mad_i32_i24 v68, v143, s82, v141
    v_mad_i32_i24 v80, v143, s82, v140
    s_lshl_b32 s84, s84, 3
    s_lshl_b32 s85, s83, 10
    buffer_load_dwordx4 v125, s[48:51], s4 offen offset:1024 lds
    v_add_u32 v142, 1295, v142
    v_lshrrev_b32 v142, 8, v142
    v_mad_i32_i24 v57, v142, s82, v192
    v_mad_i32_i24 v69, v142, s82, v141
    v_mad_i32_i24 v81, v142, s82, v140
    v_mov_b32 v140, s81
    v_lshlrev_b32 v141, 4, v254
    v_xor_b32 v2, 65536, v141
    v_lshl_add_u32 v3, s16, 10, v141
    s_add_u32 s85, s85, s84
    v_add_u32 v4, s85, v141
    s_lshl_b32 s83, s83, 11
    s_add_u32 s83, s83, s84
    buffer_load_dwordx4 v127, s[48:51], s4 offen offset:2048 lds
    s_add_u32 m0, s68, 3072
    s_add_u32 s4, s45, 37248
    s_add_u32 s83, s83, 144896
    s_mul_i32 s86, s16, 2048
    s_add_u32 s86, s86, 136704
    v_lshl_add_u32 v142, v255, 3, s86
    v_mov_b32 v141, s83
    v_mov_b32 v143, 161536
    v_mul_u32_u24 v144, 80, v255
    v_add3_u32 v5, v144, v137, s72
    v_lshl_add_u32 v6, v116, 2, s73
    s_mul_i32 s87, s16, 128
    s_add_u32 s87, s87, 65024
    buffer_load_ushort v192, v115, s[60:63], 0 offen
    v_add_u32 v9, s87, v138
    s_mov_b32 s40, s8
    s_mov_b32 s41, s9
    buffer_load_dwordx3 v[206:208], v126, s[56:59], 0 offen
    v_lshrrev_b32 v115, 1, v255
    s_mov_b32 s32, 0x2a8cbccc
    s_mov_b32 s33, 0x38fba882
    buffer_load_dwordx4 v[182:185], v128, s[64:67], 0 offen
    v_mul_u32_u24 v115, 48, v115
    s_add_u32 s75, s28, 16384
    s_cmp_lt_u32 s16, 2
    buffer_load_dwordx4 v[194:197], v128, s[64:67], 0 offen offset:16
    v_lshl_add_u32 v115, v255, 3, v115
    s_cselect_b32 s29, s75, 160256
    s_cselect_b32 s30, 65536, 0
    global_load_ushort v114, v114, s[46:47]
    v_lshl_add_u32 v115, v120, 4, v115
    s_xor_b32 s74, s29, s30
    s_mul_i32 s77, s16, 64
    buffer_load_dwordx4 v123, s[48:51], s4 offen lds
    v_lshl_add_u32 v115, v131, 1, v115
    v_add_u32 v8, s87, v115
    v_mov_b32 v37, 0
    v_mov_b32 v38, 0
    v_mov_b32 v39, 0
    v_add_u32 v126, 148992, v0
    v_add_u32 v145, 148992, v1
    v_lshlrev_b32 v128, 4, v116
    v_add_u32 v128, 160256, v128
    v_mul_u32_u24 v115, 336, v116
    v_add3_u32 v115, v115, v144, s72
    s_mul_i32 s78, s16, 32
    s_add_u32 s78, s78, 192
    buffer_load_dwordx4 v125, s[48:51], s4 offen offset:1024 lds
    v_mul_u32_u24 v144, 272, v116
    v_add3_u32 v144, v144, v138, s73
    v_mul_u32_u24 v147, 1088, v255
    v_add_u32 v147, v147, v6
    v_add_u32 v146, 5376, v115
    v_add_u32 v162, 4352, v144
    v_add_u32 v148, 4352, v147
    v_cmp_gt_u32 s[88:89], 16, v254
    v_mov_b32 v149, 0xf149f2ca
    v_add_u32 v209, 512, v190
    v_mul_u32_u24 v163, 2731, v209
    s_add_u32 s34, s18, 2
    s_mov_b32 s18, 1
    buffer_load_dwordx4 v127, s[48:51], s4 offen offset:2048 lds
    s_add_u32 m0, s69, 0
    s_add_u32 s4, s45, 74112
    v_bfe_u32 v164, v163, 17, 3
    v_lshrrev_b32 v163, 16, v163
    v_xor_b32 v209, v164, v209
    v_mul_u32_u24 v164, 37, v163
    v_lshrrev_b32 v164, 8, v164
    v_lshlrev_b32 v209, 4, v209
    v_mad_u32_u24 v12, v164, s70, v209
    v_add_u32 v209, 768, v190
    v_mul_u32_u24 v163, 2731, v209
    s_mov_b32 s27, s26
    s_mov_b32 s26, s25
    buffer_load_dwordx4 v123, s[48:51], s4 offen lds
    v_bfe_u32 v164, v163, 17, 3
    v_lshrrev_b32 v163, 16, v163
    v_xor_b32 v209, v164, v209
    v_mul_u32_u24 v164, 37, v163
    v_lshrrev_b32 v164, 8, v164
    v_lshlrev_b32 v209, 4, v209
    v_mad_u32_u24 v13, v164, s70, v209
    v_add_u32 v190, 1024, v190
    v_mul_u32_u24 v163, 2731, v190
    v_bfe_u32 v209, v163, 17, 3
    v_lshrrev_b32 v163, 16, v163
    v_xor_b32 v190, v209, v190
    v_mul_u32_u24 v209, 37, v163
    v_lshrrev_b32 v209, 8, v209
    v_lshlrev_b32 v190, 4, v190
    v_mad_u32_u24 v14, v209, s70, v190
    v_cmp_gt_u32 vcc, 48, v163
    v_mul_u32_u24 v190, 6, v117
    v_sub_u32 v209, v254, v190
    v_cndmask_b32 v14, v191, v14, vcc
    v_cmp_gt_u32 vcc, 2, v131
    v_mul_u32_u24 v190, 384, v117
    v_lshl_add_u32 v190, v209, 4, v190
    v_cndmask_b32 v32, 0, v136, vcc
    v_cndmask_b32 v33, v136, 0, vcc
    v_cndmask_b32 v34, 0, v136, vcc
    v_cndmask_b32 v35, v136, 0, vcc
    v_cmp_eq_u32 vcc, 0, v137
    v_add_u32 v117, s78, v190
    v_add_u32 v190, s77, v190
    v_cndmask_b32 v40, 0, v139, vcc
    v_cndmask_b32 v41, v139, 0, vcc
    v_cndmask_b32 v42, 0, v139, vcc
    v_cndmask_b32 v43, v139, 0, vcc
    v_cmp_eq_u32 vcc, v255, v120
    v_mul_u32_u24 v139, 6, v122
    v_sub_u32 v136, v254, v139
    v_cndmask_b32 v150, 0, v32, vcc
    v_cndmask_b32 v151, 0, v33, vcc
    v_cmp_gt_i32 vcc, 4, v209
    v_mul_u32_u24 v139, 384, v122
    v_lshl_add_u32 v139, v136, 4, v139
    v_cndmask_b32 v152, v117, v190, vcc
    v_add_u32 v122, s78, v139
    v_add_u32 v139, s77, v139
    v_cmp_gt_i32 vcc, -60, v136
    v_mul_u32_u24 v117, 6, v124
    v_sub_u32 v136, v254, v117
    v_cndmask_b32 v153, v122, v139, vcc
    v_mul_u32_u24 v117, 384, v124
    v_lshl_add_u32 v117, v136, 4, v117
    v_add_u32 v139, s78, v117
    v_add_u32 v117, s77, v117
    v_cmp_gt_i32 vcc, -124, v136
    v_mul_u32_u24 v136, 96, v116
    v_add3_u32 v254, v136, v138, s68
    v_cndmask_b32 v122, v139, v117, vcc
    v_cmp_gt_u32 vcc, 2, v255
    v_lshl_add_u32 v124, v255, 3, v136
    v_add3_u32 v124, v124, 64, s68
    v_cndmask_b32 v142, v141, v142, vcc
    v_lshl_add_u32 v142, v120, 9, v142
    v_lshl_add_u32 v142, v131, 1, v142
    v_cmp_gt_u32 vcc, 3, v255
    v_add3_u32 v139, v136, v138, s69
    v_lshl_add_u32 v117, v255, 3, v136
    v_cndmask_b32 v7, v143, v142, vcc
    v_cmp_gt_u32 vcc, 8, v116
    v_add3_u32 v117, v117, 64, s69
    v_add_u32 v116, 16, v116
    v_cndmask_b32 v146, v128, v146, vcc
    v_cndmask_b32 v162, v128, v162, vcc
    v_cmp_gt_u32 vcc, 2, v255
    v_cmp_gt_u32 s[94:95], s17, v116
    v_cmp_ne_u32 s[96:97], 0, v137
    v_cndmask_b32 v148, v128, v148, vcc
    v_cmp_lt_u32 s[98:99], 1, v131
    v_cmp_eq_u32 vcc, v255, v120
    v_sub_u32 v255, v144, v138
    v_sub_u32 v131, v162, v138
    v_cndmask_b32 v255, v128, v255, vcc
    v_cndmask_b32 v131, v128, v131, vcc
    s_add_u32 s19, s19, s20
    buffer_load_dwordx4 v125, s[48:51], s4 offen offset:1024 lds
    s_waitcnt vmcnt(12)
    s_barrier
    ds_read_b128 v[198:201], v0 offset:20480
    ds_read_b128 v[226:229], v1 offset:20480
    ds_read_b128 v[222:225], v0 offset:20608
    ds_read_b128 v[170:173], v1 offset:20608
    ds_read_b128 v[242:245], v0 offset:20736
    buffer_load_dwordx4 v127, s[48:51], s4 offen offset:2048 lds
    ds_read_b128 v[210:213], v1 offset:20736
    s_add_u32 m0, s69, 3072
    s_add_u32 s4, s45, 110976
    buffer_load_dwordx4 v123, s[48:51], s4 offen lds
    s_waitcnt vmcnt(12)
    ds_read_b64_tr_b16 a[72:73], v133 offset:0
    s_waitcnt vmcnt(10)
    ds_read_b64_tr_b16 a[74:75], v133 offset:768
    s_waitcnt vmcnt(9)
    ds_read_b64_tr_b16 a[96:97], v133 offset:32
    s_waitcnt vmcnt(8)
    ds_read_b64_tr_b16 a[98:99], v133 offset:800
    s_waitcnt vmcnt(7)
    ds_read_b64_tr_b16 a[120:121], v133 offset:64
    ds_read_b64_tr_b16 a[122:123], v133 offset:832
    buffer_load_dwordx4 v125, s[48:51], s4 offen offset:1024 lds
    v_cndmask_b32 v182, v182, v183, s[92:93]
    v_cndmask_b32 v184, v184, v185, s[92:93]
    v_perm_b32 v136, v184, v182, v118
    v_cndmask_b32 v194, v194, v195, s[92:93]
    v_cndmask_b32 v196, v196, v197, s[92:93]
    v_perm_b32 v137, v196, v194, v118
    v_bfe_u32 v118, v206, v138, 16
    v_bfe_u32 v128, v207, v138, 16
    v_bfe_u32 v120, v208, v138, 16
    v_mfma_f32_16x16x16_bf16 v[206:209], v[192:193], v[118:119], 0
    v_lshlrev_b32 v114, 16, v114
    v_max_f32 v114, 0xc2c80000, v114
    v_min_f32 v114, 0x40930000, v114
    v_mfma_f32_16x16x16_bf16 v[194:197], v[192:193], v[128:129], 0
    v_mul_f32 v114, 0x3fb8aa3b, v114
    v_exp_f32 v114, v114
    v_mfma_f32_16x16x16_bf16 v[182:185], v[192:193], v[120:121], 0
    s_waitcnt lgkmcnt(3)
    buffer_load_dwordx4 v127, s[48:51], s4 offen offset:2048 lds
    v_max_f32 v206, 0, v206
    v_mfma_f32_16x16x32_bf16 v[118:121], a[72:75], v[198:201], 0
    s_waitcnt lgkmcnt(0)
    v_max_f32 v207, 0, v207
    v_max_f32 v208, 0, v208
    v_mfma_f32_16x16x32_bf16 v[190:193], a[96:99], v[198:201], 0
    s_add_u32 m0, s72, 0
    v_max_f32 v209, 0, v209
    v_cvt_pk_bf16_f32 v128, v206, v207
    v_mfma_f32_16x16x32_bf16 v[158:161], a[120:123], v[198:201], 0
    s_add_u32 s4, s45, 147840
    ds_read_b128 v[154:157], v126 offset:6272
    buffer_load_dwordx4 v123, s[48:51], s4 offen lds
    v_cvt_pk_bf16_f32 v129, v208, v209
    v_max_f32 v194, 0, v194
    s_waitcnt vmcnt(7)
    v_mfma_f32_16x16x16_bf16 v[206:209], v[136:137], v[128:129], 0
    ds_read_b64_tr_b16 a[76:77], v133 offset:3072
    ds_read_b64_tr_b16 a[78:79], v133 offset:3840
    ds_read_b64_tr_b16 a[100:101], v133 offset:3104
    ds_read_b64_tr_b16 a[102:103], v133 offset:3872
    ds_read_b64_tr_b16 a[124:125], v133 offset:3136
    ds_read_b64_tr_b16 a[126:127], v133 offset:3904
    v_max_f32 v195, 0, v195
    buffer_load_dwordx4 v125, s[48:51], s4 offen offset:1024 lds
    v_cvt_pk_bf16_f32 v206, v206, v206
    v_and_b32 v206, 0xffff0000, v206
    v_mul_f32 v206, 0xbfb8aa3b, v206
    v_exp_f32 v206, v206
    v_max_f32 v196, 0, v196
    v_add_f32 v206, 1.0, v206
    v_rcp_f32 v206, v206
    v_max_f32 v197, 0, v197
    v_cvt_pk_bf16_f32 v206, v206, v206
    buffer_load_dwordx4 v127, s[48:51], s4 offen offset:2048 lds
    s_add_u32 m0, s72, 3072
    s_add_u32 s4, s45, 184704
    v_and_b32 v206, 0xffff0000, v206
    s_waitcnt lgkmcnt(4)
    v_mfma_f32_16x16x32_bf16 v[118:121], a[76:79], v[226:229], v[118:121]
    s_waitcnt lgkmcnt(2)
    v_add_f32 v206, -0.5, v206
    v_mul_f32 v206, 0x41b8aa3b, v206
    v_mfma_f32_16x16x32_bf16 v[190:193], a[100:103], v[226:229], v[190:193]
    s_waitcnt lgkmcnt(0)
    ds_write_b32 v135, v206 offset:0
    v_mfma_f32_16x16x32_bf16 v[158:161], a[124:127], v[226:229], v[158:161]
    buffer_load_dwordx4 v123, s[48:51], s4 offen lds
    v_cvt_pk_bf16_f32 v128, v194, v195
    v_cvt_pk_bf16_f32 v129, v196, v197
    v_max_f32 v182, 0, v182
    v_max_f32 v183, 0, v183
    v_mfma_f32_16x16x16_bf16 v[206:209], v[136:137], v[128:129], 0
    v_max_f32 v184, 0, v184
    v_max_f32 v185, 0, v185
    v_cvt_pk_bf16_f32 v128, v182, v183
    v_cvt_pk_bf16_f32 v129, v184, v185
    v_cvt_pk_bf16_f32 v114, v114, v114
    v_and_b32 v114, 0xffff0000, v114
    s_waitcnt vmcnt(7)
    v_mfma_f32_16x16x16_bf16 v[194:197], v[136:137], v[128:129], 0
    buffer_load_dwordx4 v125, s[48:51], s4 offen offset:1024 lds
    ds_read_b64_tr_b16 a[80:81], v130 offset:0
    ds_read_b64_tr_b16 a[82:83], v130 offset:768
    ds_read_b64_tr_b16 a[104:105], v130 offset:32
    ds_read_b64_tr_b16 a[106:107], v130 offset:800
    ds_read_b64_tr_b16 a[128:129], v130 offset:64
    ds_read_b64_tr_b16 a[130:131], v130 offset:832
    ds_read_b128 v[182:185], v145 offset:6272
    v_cvt_pk_bf16_f32 v206, v206, v206
    v_and_b32 v206, 0xffff0000, v206
    v_mul_f32 v206, 0xbfb8aa3b, v206
    v_exp_f32 v206, v206
    buffer_load_dwordx4 v127, s[48:51], s4 offen offset:2048 lds
    s_add_u32 m0, s73, 0
    s_add_u32 s4, s45, 36864
    v_add_f32 v206, 1.0, v206
    v_rcp_f32 v206, v206
    v_cvt_pk_bf16_f32 v194, v194, v194
    v_cvt_pk_bf16_f32 v206, v206, v206
    v_and_b32 v206, 0xffff0000, v206
    v_add_f32 v206, -0.5, v206
    v_mul_f32 v206, 0x41b8aa3b, v206
    ds_write_b32 v135, v206 offset:4
    s_waitcnt lgkmcnt(5)
    v_mfma_f32_16x16x32_bf16 v[118:121], a[80:83], v[222:225], v[118:121]
    s_waitcnt lgkmcnt(3)
    buffer_load_dwordx4 v123, s[48:51], s45 offen lds
    v_mfma_f32_16x16x32_bf16 v[190:193], a[104:107], v[222:225], v[190:193]
    s_waitcnt lgkmcnt(1)
    v_and_b32 v194, 0xffff0000, v194
    v_mul_f32 v194, 0xbfb8aa3b, v194
    v_mfma_f32_16x16x32_bf16 v[158:161], a[128:131], v[222:225], v[158:161]
    ds_read_b128 v[166:169], v126 offset:6400
    v_exp_f32 v194, v194
    v_mul_f32 v116, 0x3fb8aa3b, v114
    v_add_f32 v194, 1.0, v194
    buffer_load_dwordx4 v125, s[48:51], s45 offen offset:1024 lds
    s_waitcnt vmcnt(8)
    ds_read_b64_tr_b16 a[84:85], v130 offset:3072
    ds_read_b64_tr_b16 a[86:87], v130 offset:3840
    ds_read_b64_tr_b16 a[108:109], v130 offset:3104
    ds_read_b64_tr_b16 a[110:111], v130 offset:3872
    ds_read_b64_tr_b16 a[132:133], v130 offset:3136
    ds_read_b64_tr_b16 a[134:135], v130 offset:3904
    v_rcp_f32 v194, v194
    v_readfirstlane_b32 s37, v114
    v_cvt_pk_bf16_f32 v194, v194, v194
    buffer_load_dwordx4 v127, s[48:51], s45 offen offset:2048 lds
    s_add_u32 m0, s73, 3072
    v_and_b32 v194, 0xffff0000, v194
    v_add_f32 v194, -0.5, v194
    v_mul_f32 v194, 0x41b8aa3b, v194
    ds_write_b32 v135, v194 offset:8
    v_readfirstlane_b32 s31, v116
    v_mul_f32 v114, 0x3e000000, v114
    v_cmp_lt_f32 s[90:91], 4.0, v114
    buffer_load_dwordx4 v123, s[48:51], s4 offen lds
    s_waitcnt lgkmcnt(5)
    v_mfma_f32_16x16x32_bf16 v[118:121], a[84:87], v[170:173], v[118:121]
    s_waitcnt lgkmcnt(3)
    s_cmp_lg_u64 s[90:91], 0
    s_cbranch_scc1 L_slow
    v_mfma_f32_16x16x32_bf16 v[190:193], a[108:111], v[170:173], v[190:193]
    s_waitcnt lgkmcnt(1)
    v_mfma_f32_16x16x32_bf16 v[158:161], a[132:135], v[170:173], v[158:161]
    ds_read_b128 v[194:197], v145 offset:6400
    s_waitcnt vmcnt(7)
    buffer_load_dwordx4 v125, s[48:51], s4 offen offset:1024 lds
    ds_read_b64_tr_b16 a[88:89], v132 offset:0
    ds_read_b64_tr_b16 a[90:91], v132 offset:768
    ds_read_b64_tr_b16 a[112:113], v132 offset:32
    ds_read_b64_tr_b16 a[114:115], v132 offset:800
    s_waitcnt lgkmcnt(5)
    s_barrier
    ds_read_b64_tr_b16 a[136:137], v132 offset:64
    ds_read_b64_tr_b16 a[138:139], v132 offset:832
    ds_read_b32 v22, v22 offset:0
    ds_read_b32 v23, v23 offset:672
    ds_read_b32 v24, v24 offset:0
    ds_read_b32 v25, v25 offset:672
    buffer_load_dwordx4 v127, s[48:51], s4 offen offset:2048 lds
    ds_read_b32 v26, v26 offset:0
    ds_read_b32 v27, v27 offset:672
    ds_read_b32 v46, v46 offset:336
    s_add_u32 m0, s68, 0
    ds_read_b32 v58, v58 offset:336
    s_add_u32 s4, s45, 73728
    ds_read_b32 v70, v70 offset:336
    ds_read_b32 v47, v47 offset:332
    ds_read_b32 v59, v59 offset:332
    buffer_load_dwordx4 v123, s[48:51], s4 offen lds
    s_waitcnt lgkmcnt(14)
    v_mfma_f32_16x16x32_bf16 v[118:121], a[88:91], v[242:245], v[118:121]
    s_waitcnt lgkmcnt(13)
    ds_read_b32 v71, v71 offset:332
    ds_read_b32 v48, v48 offset:328
    v_mfma_f32_16x16x32_bf16 v[190:193], a[112:115], v[242:245], v[190:193]
    s_waitcnt lgkmcnt(12)
    ds_read_b128 v[206:209], v126 offset:6144
    ds_read_b32 v60, v60 offset:328
    v_mfma_f32_16x16x32_bf16 v[158:161], a[136:139], v[242:245], v[158:161]
    s_waitcnt lgkmcnt(11)
    ds_read_b32 v72, v72 offset:328
    ds_read_b32 v49, v49 offset:324
    s_waitcnt lgkmcnt(12)
    s_waitcnt vmcnt(7)
    buffer_load_dwordx4 v125, s[48:51], s4 offen offset:1024 lds
    ds_read_b64_tr_b16 a[92:93], v132 offset:3072
    ds_read_b64_tr_b16 a[94:95], v132 offset:3840
    ds_read_b64_tr_b16 a[116:117], v132 offset:3104
    ds_read_b64_tr_b16 a[118:119], v132 offset:3872
    ds_read_b64_tr_b16 a[140:141], v132 offset:3136
    ds_read_b64_tr_b16 a[142:143], v132 offset:3904
    ds_read_b32 v61, v61 offset:324
    ds_read_b32 v73, v73 offset:324
    ds_read_b32 v50, v50 offset:272
    buffer_load_dwordx4 v127, s[48:51], s4 offen offset:2048 lds
    ds_read_b32 v62, v62 offset:272
    ds_read_b32 v74, v74 offset:272
    ds_read_b32 v51, v51 offset:268
    s_waitcnt lgkmcnt(15)
    v_mfma_f32_16x16x32_bf16 v[186:189], a[72:75], v[206:209], 0
    s_add_u32 m0, s68, 3072
    ds_read_b32 v63, v63 offset:268
    ds_read_b32 v75, v75 offset:268
    v_mfma_f32_16x16x32_bf16 v[178:181], a[96:99], v[206:209], 0
    s_add_u32 s4, s45, 110592
    ds_read_b32 v52, v52 offset:264
    ds_read_b32 v64, v64 offset:264
    v_mfma_f32_16x16x32_bf16 v[202:205], a[120:123], v[206:209], 0
    s_waitcnt lgkmcnt(15)
    s_waitcnt lgkmcnt(14)
    ds_read_b32 v76, v76 offset:264
    v_mfma_f32_16x16x32_bf16 v[118:121], a[92:95], v[210:213], v[118:121]
    s_waitcnt lgkmcnt(12)
    buffer_load_dwordx4 v123, s[48:51], s4 offen lds
    v_mfma_f32_16x16x32_bf16 v[190:193], a[116:119], v[210:213], v[190:193]
    s_waitcnt lgkmcnt(9)
    ds_read_b128 v[214:217], v145 offset:6144
    ds_read_b32 v53, v53 offset:260
    v_mfma_f32_16x16x32_bf16 v[158:161], a[140:143], v[210:213], v[158:161]
    s_waitcnt lgkmcnt(10)
    ds_read_b32 v65, v65 offset:260
    ds_read_b32 v77, v77 offset:260
    ds_read_b32 v54, v54 offset:208
    ds_read_b32 v66, v66 offset:208
    ds_read_b32 v78, v78 offset:208
    s_waitcnt vmcnt(7)
    ds_read_b64_tr_b16 a[0:1], v134 offset:0
    buffer_load_dwordx4 v125, s[48:51], s4 offen offset:1024 lds
    ds_read_b64_tr_b16 a[2:3], v134 offset:768
    ds_read_b64_tr_b16 a[24:25], v134 offset:32
    ds_read_b64_tr_b16 a[26:27], v134 offset:800
    ds_read_b64_tr_b16 a[48:49], v134 offset:64
    ds_read_b64_tr_b16 a[50:51], v134 offset:832
    ds_read_b32 v55, v55 offset:204
    ds_read_b32 v67, v67 offset:204
    buffer_load_dwordx4 v127, s[48:51], s4 offen offset:2048 lds
    s_waitcnt lgkmcnt(14)
    v_mfma_f32_16x16x32_bf16 v[186:189], a[76:79], v[214:217], v[186:189]
    s_add_u32 m0, s69, 0
    ds_read_b32 v79, v79 offset:204
    ds_read_b32 v56, v56 offset:200
    v_mfma_f32_16x16x32_bf16 v[186:189], a[80:83], v[154:157], v[186:189]
    s_add_u32 s4, s45, 147456
    ds_read_b32 v68, v68 offset:200
    ds_read_b32 v80, v80 offset:200
    v_mfma_f32_16x16x32_bf16 v[186:189], a[84:87], v[182:185], v[186:189]
    s_waitcnt lgkmcnt(11)
    ds_read_b32 v57, v57 offset:196
    ds_read_b32 v69, v69 offset:196
    v_mfma_f32_16x16x32_bf16 v[186:189], a[88:91], v[166:169], v[186:189]
    s_waitcnt lgkmcnt(11)
    buffer_load_dwordx4 v123, s[48:51], s4 offen lds
    v_mfma_f32_16x16x32_bf16 v[206:209], a[0:3], v[198:201], 0
    s_waitcnt lgkmcnt(9)
    ds_read_b32 v81, v81 offset:196
    ds_read_b32 v140, v140 offset:336
    v_mfma_f32_16x16x32_bf16 v[174:177], a[24:27], v[198:201], 0
    s_waitcnt lgkmcnt(9)
    v_cndmask_b32 v22, v149, v22, s[88:89]
    v_cndmask_b32 v24, v149, v24, s[88:89]
    v_mfma_f32_16x16x32_bf16 v[218:221], a[48:51], v[198:201], 0
    s_waitcnt vmcnt(7)
    ds_read_b64_tr_b16 a[4:5], v134 offset:3072
    ds_read_b64_tr_b16 a[6:7], v134 offset:3840
    v_mfma_f32_16x16x32_bf16 v[186:189], a[92:95], v[194:197], v[186:189]
    s_waitcnt lgkmcnt(10)
    buffer_load_dwordx4 v125, s[48:51], s4 offen offset:1024 lds
    v_mfma_f32_16x16x32_bf16 v[178:181], a[100:103], v[214:217], v[178:181]
    s_waitcnt lgkmcnt(8)
    ds_read_b64_tr_b16 a[28:29], v134 offset:3104
    ds_read_b64_tr_b16 a[30:31], v134 offset:3872
    v_mfma_f32_16x16x32_bf16 v[178:181], a[104:107], v[154:157], v[178:181]
    s_waitcnt lgkmcnt(8)
    ds_read_b64_tr_b16 a[52:53], v134 offset:3136
    ds_read_b64_tr_b16 a[54:55], v134 offset:3904
    v_mfma_f32_16x16x32_bf16 v[178:181], a[108:111], v[182:185], v[178:181]
    s_waitcnt lgkmcnt(8)
    ds_read_b128 v[198:201], v126 offset:128
    v_cndmask_b32 v26, v149, v26, s[88:89]
    v_mfma_f32_16x16x32_bf16 v[178:181], a[112:115], v[166:169], v[178:181]
    buffer_load_dwordx4 v127, s[48:51], s4 offen offset:2048 lds
    v_mfma_f32_16x16x32_bf16 v[178:181], a[116:119], v[194:197], v[178:181]
    s_waitcnt lgkmcnt(7)
    v_readfirstlane_b32 s39, v140
    v_mov_b32 v134, 0
    v_mfma_f32_16x16x32_bf16 v[202:205], a[124:127], v[214:217], v[202:205]
    s_add_u32 m0, s69, 3072
    v_mov_b32 v135, 0
    v_mov_b32 v136, 0
    v_mfma_f32_16x16x32_bf16 v[202:205], a[128:131], v[154:157], v[202:205]
    s_waitcnt lgkmcnt(5)
    ds_write_b64 v115, v[134:135] offset:56
    v_mfma_f32_16x16x32_bf16 v[206:209], a[4:7], v[226:229], v[206:209]
    s_add_u32 s4, s45, 184320
    buffer_load_dwordx4 v123, s[48:51], s4 offen lds
    v_mfma_f32_16x16x32_bf16 v[202:205], a[132:135], v[182:185], v[202:205]
    s_waitcnt lgkmcnt(3)
    ds_write_b64 v115, v[134:135] offset:64
    v_mfma_f32_16x16x32_bf16 v[174:177], a[28:31], v[226:229], v[174:177]
    s_waitcnt lgkmcnt(2)
    s_waitcnt vmcnt(7)
    v_mov_b32 v137, 0
    v_mfma_f32_16x16x32_bf16 v[218:221], a[52:55], v[226:229], v[218:221]
    ds_read_b64_tr_b16 a[8:9], v133 offset:0
    ds_read_b64_tr_b16 a[10:11], v133 offset:768
    v_mfma_f32_16x16x32_bf16 v[202:205], a[136:139], v[166:169], v[202:205]
    buffer_load_dwordx4 v125, s[48:51], s4 offen offset:1024 lds
    v_mfma_f32_16x16x32_bf16 v[202:205], a[140:143], v[194:197], v[202:205]
    ds_read_b64_tr_b16 a[32:33], v133 offset:32
    ds_read_b64_tr_b16 a[34:35], v133 offset:800
    ds_read_b64_tr_b16 a[56:57], v133 offset:64
    ds_read_b64_tr_b16 a[58:59], v133 offset:832
    ds_read_b128 v[182:185], v145 offset:128
    ds_write_b128 v115, v[134:137] offset:16
    buffer_load_dwordx4 v127, s[48:51], s4 offen offset:2048 lds
    s_add_u32 m0, s28, 8192
    s_add_u32 s4, s45, 768
    v_mov_b32 v194, v149
    v_mov_b32 v195, v149
    ds_write_b128 v146, v[134:137] offset:16
    s_waitcnt lgkmcnt(7)
    v_mfma_f32_16x16x32_bf16 v[206:209], a[8:11], v[222:225], v[206:209]
    buffer_load_dwordx4 v12, s[8:11], s25 offen lds
    s_waitcnt lgkmcnt(5)
    v_mfma_f32_16x16x32_bf16 v[174:177], a[32:35], v[222:225], v[174:177]
    s_waitcnt lgkmcnt(3)
    v_mov_b32 v196, v149
    v_mov_b32 v197, v149
    v_mfma_f32_16x16x32_bf16 v[218:221], a[56:59], v[222:225], v[218:221]
    s_add_u32 m0, s28, 12288
    ds_read_b128 v[222:225], v126 offset:256
    ds_write_b64 v146, v[134:135] offset:56
    s_waitcnt vmcnt(7)
    buffer_load_dwordx4 v13, s[8:11], s25 offen lds
    s_add_u32 m0, s29, 0
    ds_read_b64_tr_b16 a[12:13], v133 offset:3072
    ds_read_b64_tr_b16 a[14:15], v133 offset:3840
    ds_read_b64_tr_b16 a[36:37], v133 offset:3104
    ds_read_b64_tr_b16 a[38:39], v133 offset:3872
    ds_read_b64_tr_b16 a[60:61], v133 offset:3136
    ds_read_b64_tr_b16 a[62:63], v133 offset:3904
    ds_write_b64 v146, v[134:135] offset:64
    v_cvt_pk_f16_f32 v118, v118, v119
    buffer_load_dwordx4 v14, s[8:11], s25 offen lds
    ds_write_b128 v144, v[194:197] offset:192
    s_add_u32 m0, s68, 0
    s_cmp_lt_u32 1, s17
    s_cselect_b32 s10, s36, 0
    v_pk_mul_f16 v163, v118, v118
    v_cvt_pk_f16_f32 v119, v120, v121
    v_pk_mul_f16 v165, v119, v119
    s_mov_b32 s25, s24
    buffer_load_dwordx4 v123, s[48:51], s4 offen lds
    s_waitcnt lgkmcnt(6)
    v_mfma_f32_16x16x32_bf16 v[206:209], a[12:15], v[170:173], v[206:209]
    s_waitcnt lgkmcnt(4)
    ds_write_b128 v162, v[194:197] offset:192
    v_mfma_f32_16x16x32_bf16 v[174:177], a[36:39], v[170:173], v[174:177]
    s_waitcnt lgkmcnt(2)
    v_cvt_pk_f16_f32 v120, v190, v191
    v_pk_fma_f16 v163, v120, v120, v163
    v_mfma_f32_16x16x32_bf16 v[218:221], a[60:63], v[170:173], v[218:221]
    s_waitcnt vmcnt(7)
    buffer_load_dwordx4 v125, s[48:51], s4 offen offset:1024 lds
    ds_read_b64_tr_b16 a[16:17], v130 offset:0
    ds_read_b64_tr_b16 a[18:19], v130 offset:768
    ds_read_b64_tr_b16 a[40:41], v130 offset:32
    ds_read_b64_tr_b16 a[42:43], v130 offset:800
    ds_read_b64_tr_b16 a[64:65], v130 offset:64
    ds_read_b64_tr_b16 a[66:67], v130 offset:832
    ds_read_b128 v[226:229], v145 offset:256
    v_cvt_pk_f16_f32 v121, v192, v193
    v_pk_fma_f16 v165, v121, v121, v165
    v_cvt_pk_f16_f32 v196, v158, v159
    buffer_load_dwordx4 v127, s[48:51], s4 offen offset:2048 lds
    s_add_u32 m0, s68, 3072
    s_add_u32 s4, s45, 37632
    v_pk_fma_f16 v163, v196, v196, v163
    v_cvt_pk_f16_f32 v197, v160, v161
    v_pk_fma_f16 v165, v197, v197, v165
    v_cvt_pk_f16_f32 v190, v186, v187
    v_pk_mul_f16 v171, v190, v190
    v_cvt_pk_f16_f32 v191, v188, v189
    v_pk_mul_f16 v173, v191, v191
    v_cvt_pk_f16_f32 v192, v178, v179
    v_pk_fma_f16 v171, v192, v192, v171
    buffer_load_dwordx4 v123, s[48:51], s4 offen lds
    s_waitcnt lgkmcnt(5)
    v_mfma_f32_16x16x32_bf16 v[206:209], a[16:19], v[242:245], v[206:209]
    s_waitcnt lgkmcnt(3)
    v_cvt_pk_f16_f32 v193, v180, v181
    v_pk_fma_f16 v173, v193, v193, v173
    v_mfma_f32_16x16x32_bf16 v[174:177], a[40:43], v[242:245], v[174:177]
    s_waitcnt lgkmcnt(0)
    ds_read_b128 v[134:137], v126 offset:0
    v_cvt_pk_f16_f32 v156, v202, v203
    v_mfma_f32_16x16x32_bf16 v[218:221], a[64:67], v[242:245], v[218:221]
    buffer_load_dwordx4 v125, s[48:51], s4 offen offset:1024 lds
    v_pk_fma_f16 v171, v156, v156, v171
    s_waitcnt vmcnt(8)
    ds_read_b64_tr_b16 a[20:21], v130 offset:3072
    ds_read_b64_tr_b16 a[22:23], v130 offset:3840
    ds_read_b64_tr_b16 a[44:45], v130 offset:3104
    ds_read_b64_tr_b16 a[46:47], v130 offset:3872
    ds_read_b64_tr_b16 a[68:69], v130 offset:3136
    ds_read_b64_tr_b16 a[70:71], v130 offset:3904
    v_cvt_pk_f16_f32 v157, v204, v205
    v_pk_fma_f16 v173, v157, v157, v173
    buffer_load_dwordx4 v127, s[48:51], s4 offen offset:2048 lds
    s_add_u32 m0, s69, 0
    s_add_u32 s4, s45, 74496
    s_waitcnt lgkmcnt(6)
    v_mfma_f32_16x16x32_bf16 v[242:245], a[72:75], v[134:137], 0
    v_mfma_f32_16x16x32_bf16 v[178:181], a[96:99], v[134:137], 0
    ds_read_b128 v[158:161], v126 offset:6144
    v_mfma_f32_16x16x32_bf16 v[202:205], a[120:123], v[134:137], 0
    buffer_load_dwordx4 v123, s[48:51], s4 offen lds
    v_mfma_f32_16x16x32_bf16 v[166:169], a[0:3], v[134:137], 0
    s_waitcnt lgkmcnt(4)
    v_mfma_f32_16x16x32_bf16 v[206:209], a[20:23], v[210:213], v[206:209]
    s_waitcnt lgkmcnt(1)
    v_mfma_f32_16x16x32_bf16 v[174:177], a[44:47], v[210:213], v[174:177]
    ds_read_b128 v[186:189], v145 offset:0
    v_mfma_f32_16x16x32_bf16 v[218:221], a[68:71], v[210:213], v[218:221]
    buffer_load_dwordx4 v125, s[48:51], s4 offen offset:1024 lds
    v_mfma_f32_16x16x32_bf16 v[210:213], a[24:27], v[134:137], 0
    v_mfma_f32_16x16x32_bf16 v[214:217], a[48:51], v[134:137], 0
    s_nop 0
    s_waitcnt lgkmcnt(1)
    v_cvt_pk_f16_f32 v206, v206, v207
    v_mfma_f32_16x16x32_bf16 v[230:233], a[0:3], v[158:161], 0
    v_pk_mul_f16 v162, v206, v206
    v_cvt_pk_f16_f32 v207, v208, v209
    v_mfma_f32_16x16x32_bf16 v[234:237], a[24:27], v[158:161], 0
    buffer_load_dwordx4 v127, s[48:51], s4 offen offset:2048 lds
    v_mfma_f32_16x16x32_bf16 v[134:137], a[48:51], v[158:161], 0
    s_add_u32 m0, s69, 3072
    s_add_u32 s4, s45, 111360
    v_pk_mul_f16 v164, v207, v207
    v_cvt_pk_f16_f32 v208, v174, v175
    v_pk_fma_f16 v162, v208, v208, v162
    s_waitcnt lgkmcnt(0)
    v_mfma_f32_16x16x32_bf16 v[242:245], a[76:79], v[186:189], v[242:245]
    v_cvt_pk_f16_f32 v209, v176, v177
    v_pk_fma_f16 v164, v209, v209, v164
    v_mfma_f32_16x16x32_bf16 v[242:245], a[80:83], v[198:201], v[242:245]
    v_cvt_pk_f16_f32 v194, v218, v219
    v_pk_fma_f16 v162, v194, v194, v162
    v_mfma_f32_16x16x32_bf16 v[242:245], a[84:87], v[182:185], v[242:245]
    v_cvt_pk_f16_f32 v195, v220, v221
    v_pk_fma_f16 v164, v195, v195, v164
    v_mfma_f32_16x16x32_bf16 v[242:245], a[88:91], v[222:225], v[242:245]
    v_mfma_f32_16x16x32_bf16 v[242:245], a[92:95], v[226:229], v[242:245]
    v_mfma_f32_16x16x32_f16 v[158:161], v[40:43], v[162:165], 0
    v_mfma_f32_16x16x32_bf16 v[178:181], a[100:103], v[186:189], v[178:181]
    ds_read_b128 v[174:177], v145 offset:6144
    v_mfma_f32_16x16x32_bf16 v[178:181], a[104:107], v[198:201], v[178:181]
    ds_read_b128 v[218:221], v126 offset:6272
    v_mfma_f32_16x16x32_bf16 v[178:181], a[108:111], v[182:185], v[178:181]
    ds_read_b128 v[162:165], v145 offset:6272
    v_mfma_f32_16x16x32_bf16 v[178:181], a[112:115], v[222:225], v[178:181]
    ds_read_b128 v[238:241], v126 offset:6400
    v_min3_u32 v44, v44, v158, v159
    v_mfma_f32_16x16x32_bf16 v[178:181], a[116:119], v[226:229], v[178:181]
    ds_read_b128 v[246:249], v145 offset:6400
    v_max3_u32 v45, v45, v158, v159
    v_mfma_f32_16x16x32_bf16 v[202:205], a[124:127], v[186:189], v[202:205]
    v_rsq_f32 v160, v158
    v_mfma_f32_16x16x32_bf16 v[202:205], a[128:131], v[198:201], v[202:205]
    v_rsq_f32 v161, v159
    v_mfma_f32_16x16x32_bf16 v[202:205], a[132:135], v[182:185], v[202:205]
    v_mul_f32 v160, s31, v160
    v_cvt_pk_f16_f32 v160, v160, v161
    v_mfma_f32_16x16x32_bf16 v[202:205], a[136:139], v[222:225], v[202:205]
    s_waitcnt lgkmcnt(4)
    v_pk_mul_f16 v118, v118, v160 op_sel:[0,1] op_sel_hi:[1,1]
    v_pk_mul_f16 v119, v119, v160 op_sel:[0,1] op_sel_hi:[1,1]
    v_mfma_f32_16x16x32_bf16 v[202:205], a[140:143], v[226:229], v[202:205]
    s_waitcnt lgkmcnt(3)
    v_pk_mul_f16 v120, v120, v160 op_sel:[0,1] op_sel_hi:[1,1]
    v_pk_mul_f16 v121, v121, v160 op_sel:[0,1] op_sel_hi:[1,1]
    v_mfma_f32_16x16x32_bf16 v[166:169], a[4:7], v[186:189], v[166:169]
    s_waitcnt lgkmcnt(2)
    v_pk_mul_f16 v196, v196, v160 op_sel:[0,1] op_sel_hi:[1,1]
    v_pk_mul_f16 v197, v197, v160 op_sel:[0,1] op_sel_hi:[1,1]
    v_mfma_f32_16x16x32_bf16 v[166:169], a[8:11], v[198:201], v[166:169]
    s_waitcnt lgkmcnt(1)
    v_pk_mul_f16 v206, v206, v160 op_sel:[0,0] op_sel_hi:[1,0]
    v_pk_mul_f16 v207, v207, v160 op_sel:[0,0] op_sel_hi:[1,0]
    v_mfma_f32_16x16x32_bf16 v[166:169], a[12:15], v[182:185], v[166:169]
    s_waitcnt lgkmcnt(0)
    v_pk_mul_f16 v208, v208, v160 op_sel:[0,0] op_sel_hi:[1,0]
    v_pk_mul_f16 v209, v209, v160 op_sel:[0,0] op_sel_hi:[1,0]
    v_mfma_f32_16x16x32_bf16 v[166:169], a[16:19], v[222:225], v[166:169]
    v_pk_mul_f16 v194, v194, v160 op_sel:[0,0] op_sel_hi:[1,0]
    v_pk_mul_f16 v195, v195, v160 op_sel:[0,0] op_sel_hi:[1,0]
    v_mfma_f32_16x16x32_bf16 v[166:169], a[20:23], v[226:229], v[166:169]
    v_cvt_pk_f16_f32 v158, v242, v243
    v_pk_mul_f16 v243, v158, v158
    v_mfma_f32_16x16x32_bf16 v[210:213], a[28:31], v[186:189], v[210:213]
    v_cvt_pk_f16_f32 v159, v244, v245
    v_pk_mul_f16 v245, v159, v159
    v_mfma_f32_16x16x32_bf16 v[210:213], a[32:35], v[198:201], v[210:213]
    v_cvt_pk_f16_f32 v160, v178, v179
    v_pk_fma_f16 v243, v160, v160, v243
    v_mfma_f32_16x16x32_bf16 v[210:213], a[36:39], v[182:185], v[210:213]
    v_cvt_pk_f16_f32 v161, v180, v181
    v_pk_fma_f16 v245, v161, v161, v245
    v_mfma_f32_16x16x32_bf16 v[210:213], a[40:43], v[222:225], v[210:213]
    v_cvt_pk_f16_f32 v180, v202, v203
    v_pk_fma_f16 v243, v180, v180, v243
    v_mfma_f32_16x16x32_bf16 v[210:213], a[44:47], v[226:229], v[210:213]
    v_cvt_pk_f16_f32 v181, v204, v205
    v_pk_fma_f16 v245, v181, v181, v245
    v_mfma_f32_16x16x32_bf16 v[214:217], a[52:55], v[186:189], v[214:217]
    v_cvt_pk_f16_f32 v166, v166, v167
    v_pk_mul_f16 v242, v166, v166
    v_mfma_f32_16x16x32_bf16 v[214:217], a[56:59], v[198:201], v[214:217]
    v_cvt_pk_f16_f32 v167, v168, v169
    v_pk_mul_f16 v244, v167, v167
    v_mfma_f32_16x16x32_bf16 v[214:217], a[60:63], v[182:185], v[214:217]
    v_cvt_pk_f16_f32 v168, v210, v211
    v_pk_fma_f16 v242, v168, v168, v242
    v_mfma_f32_16x16x32_bf16 v[214:217], a[64:67], v[222:225], v[214:217]
    v_cvt_pk_f16_f32 v169, v212, v213
    v_pk_fma_f16 v244, v169, v169, v244
    v_mfma_f32_16x16x32_bf16 v[214:217], a[68:71], v[226:229], v[214:217]
    v_mfma_f32_16x16x32_bf16 v[230:233], a[4:7], v[174:177], v[230:233]
    v_mfma_f32_16x16x32_bf16 v[230:233], a[8:11], v[218:221], v[230:233]
    v_mfma_f32_16x16x32_bf16 v[230:233], a[12:15], v[162:165], v[230:233]
    v_mfma_f32_16x16x32_bf16 v[230:233], a[16:19], v[238:241], v[230:233]
    v_mfma_f32_16x16x32_bf16 v[230:233], a[20:23], v[246:249], v[230:233]
    v_mfma_f32_16x16x32_bf16 v[234:237], a[28:31], v[174:177], v[234:237]
    v_mfma_f32_16x16x32_bf16 v[234:237], a[32:35], v[218:221], v[234:237]
    v_mfma_f32_16x16x32_bf16 v[234:237], a[36:39], v[162:165], v[234:237]
    v_cvt_pk_f16_f32 v178, v214, v215
    v_pk_fma_f16 v242, v178, v178, v242
    v_mfma_f32_16x16x32_bf16 v[234:237], a[40:43], v[238:241], v[234:237]
    v_cvt_pk_f16_f32 v179, v216, v217
    v_pk_fma_f16 v244, v179, v179, v244
    v_mfma_f32_16x16x32_bf16 v[234:237], a[44:47], v[246:249], v[234:237]
    v_cvt_pk_f16_f32 v222, v230, v231
    v_pk_mul_f16 v170, v222, v222
    v_mfma_f32_16x16x32_f16 v[182:185], v[40:43], v[242:245], 0
    v_cvt_pk_f16_f32 v223, v232, v233
    v_pk_mul_f16 v172, v223, v223
    v_mfma_f32_16x16x32_bf16 v[134:137], a[52:55], v[174:177], v[134:137]
    v_mfma_f32_16x16x32_bf16 v[134:137], a[56:59], v[218:221], v[134:137]
    v_mfma_f32_16x16x32_bf16 v[134:137], a[60:63], v[162:165], v[134:137]
    v_cvt_pk_f16_f32 v224, v234, v235
    v_pk_fma_f16 v170, v224, v224, v170
    v_mfma_f32_16x16x32_bf16 v[134:137], a[64:67], v[238:241], v[134:137]
    v_rsq_f32 v184, v182
    v_mfma_f32_16x16x32_bf16 v[134:137], a[68:71], v[246:249], v[134:137]
    v_rsq_f32 v185, v183
    v_mfma_f32_16x16x32_f16 v[210:213], v[118:121], v[206:209], v[46:49]
    v_mul_f32 v184, s31, v184
    v_cvt_pk_f16_f32 v184, v184, v185
    v_pk_mul_f16 v158, v158, v184 op_sel:[0,1] op_sel_hi:[1,1]
    v_pk_mul_f16 v159, v159, v184 op_sel:[0,1] op_sel_hi:[1,1]
    v_pk_mul_f16 v160, v160, v184 op_sel:[0,1] op_sel_hi:[1,1]
    v_pk_mul_f16 v161, v161, v184 op_sel:[0,1] op_sel_hi:[1,1]
    v_mfma_f32_16x16x16_f16 v[210:213], v[196:197], v[194:195], v[210:213]
    v_pk_mul_f16 v180, v180, v184 op_sel:[0,1] op_sel_hi:[1,1]
    v_pk_mul_f16 v181, v181, v184 op_sel:[0,1] op_sel_hi:[1,1]
    v_pk_mul_f16 v166, v166, v184 op_sel:[0,0] op_sel_hi:[1,0]
    v_pk_mul_f16 v167, v167, v184 op_sel:[0,0] op_sel_hi:[1,0]
    v_pk_mul_f16 v168, v168, v184 op_sel:[0,0] op_sel_hi:[1,0]
    v_pk_mul_f16 v169, v169, v184 op_sel:[0,0] op_sel_hi:[1,0]
    v_pk_mul_f16 v178, v178, v184 op_sel:[0,0] op_sel_hi:[1,0]
    v_pk_mul_f16 v179, v179, v184 op_sel:[0,0] op_sel_hi:[1,0]
    v_mfma_f32_16x16x32_f16 v[242:245], v[158:161], v[166:169], 0
    ds_write_b128 v115, v[158:161]
    v_min3_u32 v44, v44, v182, v183
    v_max3_u32 v45, v45, v182, v183
    v_cvt_pk_f16_f32 v225, v236, v237
    v_pk_fma_f16 v172, v225, v225, v172
    v_cvt_pk_f16_f32 v154, v134, v135
    v_mfma_f32_16x16x16_f16 v[242:245], v[180:181], v[178:179], v[242:245]
    v_pk_fma_f16 v170, v154, v154, v170
    ds_write_b64 v115, v[180:181] offset:48
    v_cvt_pk_f16_f32 v155, v136, v137
    v_pk_fma_f16 v172, v155, v155, v172
    v_exp_f32 v210, v210
    ds_write_b128 v115, v[166:169] offset:32
    v_mfma_f32_16x16x32_f16 v[182:185], v[40:43], v[170:173], 0
    v_exp_f32 v211, v211
    v_cndmask_b32 v242, v242, v243, s[96:97]
    v_cndmask_b32 v244, v244, v245, s[96:97]
    v_cndmask_b32 v242, v242, v244, s[98:99]
    v_add_f32 v242, s39, v242
    ds_write_b32 v255, v242 offset:192
    v_cvt_pk_bf16_f32 v210, v210, v211
    v_exp_f32 v212, v212
    v_rsq_f32 v184, v182
    ds_write_b64 v115, v[178:179] offset:72
    v_rsq_f32 v185, v183
    v_mul_f32 v184, s31, v184
    v_cvt_pk_f16_f32 v184, v184, v185
    v_pk_mul_f16 v190, v190, v184 op_sel:[0,1] op_sel_hi:[1,1]
    v_pk_mul_f16 v191, v191, v184 op_sel:[0,1] op_sel_hi:[1,1]
    v_pk_mul_f16 v192, v192, v184 op_sel:[0,1] op_sel_hi:[1,1]
    v_pk_mul_f16 v193, v193, v184 op_sel:[0,1] op_sel_hi:[1,1]
    v_pk_mul_f16 v156, v156, v184 op_sel:[0,1] op_sel_hi:[1,1]
    v_pk_mul_f16 v157, v157, v184 op_sel:[0,1] op_sel_hi:[1,1]
    v_pk_mul_f16 v222, v222, v184 op_sel:[0,0] op_sel_hi:[1,0]
    v_pk_mul_f16 v223, v223, v184 op_sel:[0,0] op_sel_hi:[1,0]
    v_pk_mul_f16 v224, v224, v184 op_sel:[0,0] op_sel_hi:[1,0]
    v_pk_mul_f16 v225, v225, v184 op_sel:[0,0] op_sel_hi:[1,0]
    v_pk_mul_f16 v154, v154, v184 op_sel:[0,0] op_sel_hi:[1,0]
    v_pk_mul_f16 v155, v155, v184 op_sel:[0,0] op_sel_hi:[1,0]
    v_mfma_f32_16x16x32_f16 v[242:245], v[190:193], v[222:225], 0
    ds_write_b128 v146, v[190:193]
    v_cndmask_b32 v182, 1.0, v182, s[94:95]
    v_cndmask_b32 v183, 1.0, v183, s[94:95]
    v_min3_u32 v44, v44, v182, v183
    v_max3_u32 v45, v45, v182, v183
    v_exp_f32 v213, v213
    v_mfma_f32_16x16x16_f16 v[242:245], v[156:157], v[154:155], v[242:245]
    ds_write_b64 v146, v[156:157] offset:48
    v_cvt_pk_bf16_f32 v211, v212, v213
    s_nop 0
    buffer_load_dwordx4 v123, s[48:51], s4 offen lds
    ds_write_b128 v146, v[222:225] offset:32
    s_nop 0
    s_nop 0
    s_nop 0
    v_cndmask_b32 v242, v242, v243, s[96:97]
    v_cndmask_b32 v244, v244, v245, s[96:97]
    v_cndmask_b32 v242, v242, v244, s[98:99]
    buffer_load_dwordx4 v125, s[48:51], s4 offen offset:1024 lds
    ds_write_b64 v146, v[154:155] offset:72
    v_add_f32 v242, s39, v242
    buffer_load_dwordx4 v127, s[48:51], s4 offen offset:2048 lds
    s_waitcnt vmcnt(12)
    s_barrier
    ds_read_b128 v[182:185], v0 offset:26624
    ds_read_b128 v[190:193], v1 offset:26624
    ds_read_b128 v[134:137], v0 offset:26752
    s_add_u32 m0, s68, 0
    s_add_u32 s4, s45, 148224
    ds_read_b128 v[222:225], v1 offset:26752
    ds_read_b128 v[198:201], v0 offset:26880
    ds_read_b128 v[226:229], v1 offset:26880
    ds_write_b32 v131, v242 offset:192
    s_waitcnt lgkmcnt(6)
    v_mfma_f32_16x16x32_bf16 v[242:245], a[72:75], v[182:185], 0
    s_waitcnt lgkmcnt(5)
    v_mfma_f32_16x16x32_bf16 v[242:245], a[76:79], v[190:193], v[242:245]
    s_waitcnt lgkmcnt(3)
    v_mfma_f32_16x16x32_bf16 v[242:245], a[80:83], v[134:137], v[242:245]
    s_waitcnt lgkmcnt(2)
    v_mfma_f32_16x16x32_bf16 v[242:245], a[84:87], v[222:225], v[242:245]
    s_waitcnt vmcnt(9)
    ds_read_b64_tr_b16 a[144:145], v133 offset:0
    ds_read_b64_tr_b16 a[146:147], v133 offset:768
    v_mfma_f32_16x16x32_bf16 v[242:245], a[88:91], v[198:201], v[242:245]
    s_waitcnt lgkmcnt(2)
    ds_read_b64_tr_b16 a[168:169], v133 offset:32
    ds_read_b64_tr_b16 a[170:171], v133 offset:800
    v_mfma_f32_16x16x32_bf16 v[242:245], a[92:95], v[226:229], v[242:245]
    ds_read_b64_tr_b16 a[192:193], v133 offset:64
    ds_read_b64_tr_b16 a[194:195], v133 offset:832
    v_mfma_f32_16x16x32_bf16 v[158:161], a[96:99], v[182:185], 0
    ds_read_b128 v[170:173], v0 offset:32768
    v_mfma_f32_16x16x32_bf16 v[158:161], a[100:103], v[190:193], v[158:161]
    ds_read_b128 v[154:157], v1 offset:32768
    v_mfma_f32_16x16x32_bf16 v[158:161], a[104:107], v[134:137], v[158:161]
    ds_read_b128 v[174:177], v0 offset:32896
    v_cvt_pk_f16_f32 v242, v242, v243
    v_mfma_f32_16x16x32_bf16 v[158:161], a[108:111], v[222:225], v[158:161]
    ds_read_b128 v[166:169], v1 offset:32896
    v_pk_mul_f16 v179, v242, v242
    v_mfma_f32_16x16x32_bf16 v[158:161], a[112:115], v[198:201], v[158:161]
    ds_read_b128 v[162:165], v0 offset:33024
    v_cvt_pk_f16_f32 v243, v244, v245
    v_mfma_f32_16x16x32_bf16 v[158:161], a[116:119], v[226:229], v[158:161]
    s_waitcnt lgkmcnt(9)
    ds_read_b128 v[202:205], v1 offset:33024
    v_pk_mul_f16 v181, v243, v243
    v_mfma_f32_16x16x32_bf16 v[218:221], a[120:123], v[182:185], 0
    s_waitcnt lgkmcnt(8)
    v_mfma_f32_16x16x32_bf16 v[218:221], a[124:127], v[190:193], v[218:221]
    s_waitcnt lgkmcnt(6)
    buffer_load_dwordx4 v123, s[48:51], s4 offen lds
    v_mfma_f32_16x16x32_bf16 v[218:221], a[128:131], v[134:137], v[218:221]
    s_waitcnt lgkmcnt(5)
    s_waitcnt vmcnt(7)
    ds_read_b64_tr_b16 a[148:149], v133 offset:3072
    v_mfma_f32_16x16x32_bf16 v[218:221], a[132:135], v[222:225], v[218:221]
    s_waitcnt lgkmcnt(5)
    ds_read_b64_tr_b16 a[150:151], v133 offset:3840
    ds_read_b64_tr_b16 a[172:173], v133 offset:3104
    v_mfma_f32_16x16x32_bf16 v[218:221], a[136:139], v[198:201], v[218:221]
    s_waitcnt lgkmcnt(6)
    ds_read_b64_tr_b16 a[174:175], v133 offset:3872
    ds_read_b64_tr_b16 a[196:197], v133 offset:3136
    v_mfma_f32_16x16x32_bf16 v[218:221], a[140:143], v[226:229], v[218:221]
    s_waitcnt lgkmcnt(7)
    buffer_load_dwordx4 v125, s[48:51], s4 offen offset:1024 lds
    v_mfma_f32_16x16x32_bf16 v[186:189], a[0:3], v[182:185], 0
    s_waitcnt lgkmcnt(6)
    ds_read_b64_tr_b16 a[198:199], v133 offset:3904
    v_cvt_pk_f16_f32 v244, v158, v159
    v_mfma_f32_16x16x32_bf16 v[186:189], a[4:7], v[190:193], v[186:189]
    s_waitcnt lgkmcnt(6)
    v_pk_fma_f16 v179, v244, v244, v179
    v_cvt_pk_f16_f32 v245, v160, v161
    v_mfma_f32_16x16x32_bf16 v[186:189], a[8:11], v[134:137], v[186:189]
    v_pk_fma_f16 v181, v245, v245, v181
    v_cvt_pk_f16_f32 v160, v218, v219
    v_mfma_f32_16x16x32_bf16 v[186:189], a[12:15], v[222:225], v[186:189]
    buffer_load_dwordx4 v127, s[48:51], s4 offen offset:2048 lds
    v_mfma_f32_16x16x32_bf16 v[186:189], a[16:19], v[198:201], v[186:189]
    s_add_u32 m0, s68, 3072
    v_pk_fma_f16 v179, v160, v160, v179
    v_cvt_pk_f16_f32 v161, v220, v221
    v_mfma_f32_16x16x32_bf16 v[186:189], a[20:23], v[226:229], v[186:189]
    s_add_u32 s4, s45, 185088
    v_pk_fma_f16 v181, v161, v161, v181
    v_mfma_f32_16x16x32_bf16 v[218:221], a[24:27], v[182:185], 0
    s_waitcnt lgkmcnt(1)
    v_mfma_f32_16x16x32_bf16 v[218:221], a[28:31], v[190:193], v[218:221]
    v_mfma_f32_16x16x32_bf16 v[218:221], a[32:35], v[134:137], v[218:221]
    s_waitcnt vmcnt(6)
    ds_read_b64_tr_b16 a[152:153], v130 offset:0
    ds_read_b64_tr_b16 a[154:155], v130 offset:768
    v_mfma_f32_16x16x32_bf16 v[218:221], a[36:39], v[222:225], v[218:221]
    s_waitcnt lgkmcnt(2)
    buffer_load_dwordx4 v123, s[48:51], s4 offen lds
    v_mfma_f32_16x16x32_bf16 v[218:221], a[40:43], v[198:201], v[218:221]
    ds_read_b64_tr_b16 a[176:177], v130 offset:32
    ds_read_b64_tr_b16 a[178:179], v130 offset:800
    v_mfma_f32_16x16x32_bf16 v[218:221], a[44:47], v[226:229], v[218:221]
    ds_read_b64_tr_b16 a[200:201], v130 offset:64
    ds_read_b64_tr_b16 a[202:203], v130 offset:832
    v_mfma_f32_16x16x32_bf16 v[214:217], a[48:51], v[182:185], 0
    v_cvt_pk_f16_f32 v182, v186, v187
    v_pk_mul_f16 v178, v182, v182
    v_mfma_f32_16x16x32_bf16 v[214:217], a[52:55], v[190:193], v[214:217]
    buffer_load_dwordx4 v125, s[48:51], s4 offen offset:1024 lds
    v_mfma_f32_16x16x32_bf16 v[214:217], a[56:59], v[134:137], v[214:217]
    v_cvt_pk_f16_f32 v183, v188, v189
    v_pk_mul_f16 v180, v183, v183
    v_mfma_f32_16x16x32_bf16 v[214:217], a[60:63], v[222:225], v[214:217]
    v_cvt_pk_f16_f32 v184, v218, v219
    v_pk_fma_f16 v178, v184, v184, v178
    v_mfma_f32_16x16x32_bf16 v[214:217], a[64:67], v[198:201], v[214:217]
    s_waitcnt lgkmcnt(4)
    v_cvt_pk_f16_f32 v185, v220, v221
    v_pk_fma_f16 v180, v185, v185, v180
    v_mfma_f32_16x16x32_bf16 v[214:217], a[68:71], v[226:229], v[214:217]
    buffer_load_dwordx4 v127, s[48:51], s4 offen offset:2048 lds
    v_mfma_f32_16x16x32_bf16 v[190:193], a[72:75], v[170:173], 0
    s_add_u32 m0, s69, 0
    s_add_u32 s4, 0, 12288
    v_mfma_f32_16x16x32_bf16 v[190:193], a[76:79], v[154:157], v[190:193]
    s_waitcnt vmcnt(6)
    ds_read_b64_tr_b16 a[156:157], v130 offset:3072
    ds_read_b64_tr_b16 a[158:159], v130 offset:3840
    v_mfma_f32_16x16x32_bf16 v[190:193], a[80:83], v[174:177], v[190:193]
    s_waitcnt lgkmcnt(2)
    ds_read_b64_tr_b16 a[180:181], v130 offset:3104
    ds_read_b64_tr_b16 a[182:183], v130 offset:3872
    v_mfma_f32_16x16x32_bf16 v[190:193], a[84:87], v[166:169], v[190:193]
    buffer_load_dwordx4 v152, s[52:55], 0 offen lds
    ds_read_b64_tr_b16 a[204:205], v130 offset:3136
    v_mfma_f32_16x16x32_bf16 v[190:193], a[88:91], v[162:165], v[190:193]
    ds_read_b64_tr_b16 a[206:207], v130 offset:3904
    v_cvt_pk_f16_f32 v158, v214, v215
    v_mfma_f32_16x16x32_bf16 v[190:193], a[92:95], v[202:205], v[190:193]
    v_pk_fma_f16 v178, v158, v158, v178
    v_cvt_pk_f16_f32 v159, v216, v217
    v_mfma_f32_16x16x32_bf16 v[222:225], a[96:99], v[170:173], 0
    v_pk_fma_f16 v180, v159, v159, v180
    v_mfma_f32_16x16x32_bf16 v[222:225], a[100:103], v[154:157], v[222:225]
    buffer_load_dwordx4 v153, s[52:55], 0 offen offset:1024 lds
    v_mfma_f32_16x16x32_f16 v[198:201], v[40:43], v[178:181], 0
    v_mfma_f32_16x16x32_bf16 v[222:225], a[104:107], v[174:177], v[222:225]
    s_waitcnt lgkmcnt(4)
    v_cvt_pk_f16_f32 v190, v190, v191
    v_pk_mul_f16 v227, v190, v190
    v_mfma_f32_16x16x32_bf16 v[222:225], a[108:111], v[166:169], v[222:225]
    s_waitcnt lgkmcnt(2)
    v_cvt_pk_f16_f32 v191, v192, v193
    v_pk_mul_f16 v229, v191, v191
    v_mfma_f32_16x16x32_bf16 v[222:225], a[112:115], v[162:165], v[222:225]
    s_waitcnt lgkmcnt(1)
    buffer_load_dwordx4 v122, s[52:55], 0 offen offset:2048 lds
    v_min3_u32 v44, v44, v198, v199
    v_mfma_f32_16x16x32_bf16 v[222:225], a[116:119], v[202:205], v[222:225]
    s_add_u32 m0, s69, 3072
    v_rsq_f32 v200, v198
    v_mfma_f32_16x16x32_bf16 v[134:137], a[120:123], v[170:173], 0
    s_waitcnt lgkmcnt(0)
    v_rsq_f32 v201, v199
    v_mfma_f32_16x16x32_bf16 v[134:137], a[124:127], v[154:157], v[134:137]
    v_mul_f32 v200, s31, v200
    v_cvt_pk_f16_f32 v200, v200, v201
    v_mfma_f32_16x16x32_bf16 v[134:137], a[128:131], v[174:177], v[134:137]
    buffer_load_dwordx4 v152, s[52:55], s4 offen lds
    v_mfma_f32_16x16x32_bf16 v[134:137], a[132:135], v[166:169], v[134:137]
    v_pk_mul_f16 v242, v242, v200 op_sel:[0,1] op_sel_hi:[1,1]
    s_waitcnt vmcnt(7)
    v_mfma_f32_16x16x32_bf16 v[134:137], a[136:139], v[162:165], v[134:137]
    ds_read_b64_tr_b16 a[160:161], v133 offset:0
    ds_read_b64_tr_b16 a[162:163], v133 offset:768
    v_mfma_f32_16x16x32_bf16 v[134:137], a[140:143], v[202:205], v[134:137]
    ds_read_b64_tr_b16 a[184:185], v133 offset:32
    ds_read_b64_tr_b16 a[186:187], v133 offset:800
    v_mfma_f32_16x16x32_bf16 v[178:181], a[0:3], v[170:173], 0
    buffer_load_dwordx4 v153, s[52:55], s4 offen offset:1024 lds
    v_mfma_f32_16x16x32_bf16 v[178:181], a[4:7], v[154:157], v[178:181]
    ds_read_b64_tr_b16 a[208:209], v133 offset:64
    ds_read_b64_tr_b16 a[210:211], v133 offset:832
    v_mfma_f32_16x16x32_bf16 v[178:181], a[8:11], v[174:177], v[178:181]
    v_pk_mul_f16 v243, v243, v200 op_sel:[0,1] op_sel_hi:[1,1]
    v_pk_mul_f16 v244, v244, v200 op_sel:[0,1] op_sel_hi:[1,1]
    v_mfma_f32_16x16x32_bf16 v[178:181], a[12:15], v[166:169], v[178:181]
    v_pk_mul_f16 v245, v245, v200 op_sel:[0,1] op_sel_hi:[1,1]
    v_pk_mul_f16 v160, v160, v200 op_sel:[0,1] op_sel_hi:[1,1]
    v_mfma_f32_16x16x32_bf16 v[178:181], a[16:19], v[162:165], v[178:181]
    buffer_load_dwordx4 v122, s[52:55], s4 offen offset:2048 lds
    v_mfma_f32_16x16x32_bf16 v[178:181], a[20:23], v[202:205], v[178:181]
    s_add_u32 m0, s68, 0
    v_pk_mul_f16 v161, v161, v200 op_sel:[0,1] op_sel_hi:[1,1]
    v_pk_mul_f16 v182, v182, v200 op_sel:[0,0] op_sel_hi:[1,0]
    v_mfma_f32_16x16x32_bf16 v[218:221], a[24:27], v[170:173], 0
    s_add_u32 s4, 0, 24576
    ds_read_b128 v[186:189], v126 offset:0
    v_pk_mul_f16 v183, v183, v200 op_sel:[0,0] op_sel_hi:[1,0]
    v_mfma_f32_16x16x32_bf16 v[218:221], a[28:31], v[154:157], v[218:221]
    s_waitcnt lgkmcnt(3)
    ds_read_b128 v[214:217], v145 offset:0
    v_pk_mul_f16 v184, v184, v200 op_sel:[0,0] op_sel_hi:[1,0]
    v_mfma_f32_16x16x32_bf16 v[218:221], a[32:35], v[174:177], v[218:221]
    ds_read_b128 v[234:237], v126 offset:128
    v_pk_mul_f16 v185, v185, v200 op_sel:[0,0] op_sel_hi:[1,0]
    v_mfma_f32_16x16x32_bf16 v[218:221], a[36:39], v[166:169], v[218:221]
    s_waitcnt lgkmcnt(3)
    buffer_load_dwordx4 v152, s[52:55], s4 offen lds
    v_mfma_f32_16x16x32_bf16 v[218:221], a[40:43], v[162:165], v[218:221]
    ds_read_b128 v[238:241], v145 offset:128
    ds_read_b128 v[250:253], v126 offset:256
    v_mfma_f32_16x16x32_bf16 v[218:221], a[44:47], v[202:205], v[218:221]
    ds_read_b128 v[230:233], v145 offset:256
    s_waitcnt vmcnt(7)
    v_mfma_f32_16x16x32_bf16 v[246:249], a[48:51], v[170:173], 0
    ds_read_b64_tr_b16 a[164:165], v133 offset:3072
    ds_read_b64_tr_b16 a[166:167], v133 offset:3840
    v_mfma_f32_16x16x32_bf16 v[246:249], a[52:55], v[154:157], v[246:249]
    buffer_load_dwordx4 v153, s[52:55], s4 offen offset:1024 lds
    v_mfma_f32_16x16x32_bf16 v[246:249], a[56:59], v[174:177], v[246:249]
    s_waitcnt lgkmcnt(7)
    ds_read_b64_tr_b16 a[188:189], v133 offset:3104
    ds_read_b64_tr_b16 a[190:191], v133 offset:3872
    v_mfma_f32_16x16x32_bf16 v[246:249], a[60:63], v[166:169], v[246:249]
    s_waitcnt lgkmcnt(8)
    ds_read_b64_tr_b16 a[212:213], v133 offset:3136
    ds_read_b64_tr_b16 a[214:215], v133 offset:3904
    v_mfma_f32_16x16x32_bf16 v[246:249], a[64:67], v[162:165], v[246:249]
    s_waitcnt lgkmcnt(9)
    v_pk_mul_f16 v158, v158, v200 op_sel:[0,0] op_sel_hi:[1,0]
    v_pk_mul_f16 v159, v159, v200 op_sel:[0,0] op_sel_hi:[1,0]
    v_mfma_f32_16x16x32_bf16 v[246:249], a[68:71], v[202:205], v[246:249]
    buffer_load_dwordx4 v122, s[52:55], s4 offen offset:2048 lds
    v_mfma_f32_16x16x32_bf16 v[130:133], v[170:173], a[144:147], 0
    s_add_u32 m0, s68, 3072
    v_max3_u32 v45, v45, v198, v199
    v_cvt_pk_f16_f32 v192, v222, v223
    v_mfma_f32_16x16x32_bf16 v[130:133], v[154:157], a[148:151], v[130:133]
    s_add_u32 s4, 0, 36864
    v_pk_fma_f16 v227, v192, v192, v227
    v_cvt_pk_f16_f32 v193, v224, v225
    v_mfma_f32_16x16x32_bf16 v[130:133], v[174:177], a[152:155], v[130:133]
    s_waitcnt lgkmcnt(4)
    v_pk_fma_f16 v229, v193, v193, v229
    v_cvt_pk_f16_f32 v200, v134, v135
    v_mfma_f32_16x16x32_bf16 v[130:133], v[166:169], a[156:159], v[130:133]
    v_pk_fma_f16 v227, v200, v200, v227
    v_cvt_pk_f16_f32 v201, v136, v137
    v_mfma_f32_16x16x32_bf16 v[130:133], v[162:165], a[160:163], v[130:133]
    s_waitcnt lgkmcnt(2)
    v_pk_fma_f16 v229, v201, v201, v229
    v_cvt_pk_f16_f32 v222, v178, v179
    v_mfma_f32_16x16x32_bf16 v[130:133], v[202:205], a[164:167], v[130:133]
    s_waitcnt lgkmcnt(0)
    buffer_load_dwordx4 v152, s[52:55], s4 offen lds
    s_waitcnt vmcnt(7)
    v_mfma_f32_16x16x32_bf16 v[134:137], v[170:173], a[168:171], 0
    ds_read_b64 a[216:217], v139 offset:0
    ds_read_b64 a[218:219], v139 offset:1536
    v_mfma_f32_16x16x32_bf16 v[134:137], v[154:157], a[172:175], v[134:137]
    ds_read_b64 a[240:241], v139 offset:8
    ds_read_b64 a[242:243], v139 offset:1544
    v_mfma_f32_16x16x32_bf16 v[134:137], v[174:177], a[176:179], v[134:137]
    ds_read_b64 v[90:91], v117 offset:0
    ds_read_b64 v[92:93], v117 offset:1536
    v_mfma_f32_16x16x32_bf16 v[134:137], v[166:169], a[180:183], v[134:137]
    buffer_load_dwordx4 v153, s[52:55], s4 offen offset:1024 lds
    v_mfma_f32_16x16x32_bf16 v[134:137], v[162:165], a[184:187], v[134:137]
    ds_read_b128 v[140:143], v0 offset:20480
    v_pk_mul_f16 v226, v222, v222
    v_mfma_f32_16x16x32_bf16 v[134:137], v[202:205], a[188:191], v[134:137]
    v_cvt_pk_f16_f32 v223, v180, v181
    v_pk_mul_f16 v228, v223, v223
    v_cvt_pk_f16_f32 v224, v218, v219
    v_pk_fma_f16 v226, v224, v224, v226
    v_cvt_pk_f16_f32 v225, v220, v221
    buffer_load_dwordx4 v122, s[52:55], s4 offen offset:2048 lds
    s_add_u32 m0, s69, 0
    s_add_u32 s4, 0, 49152
    v_pk_fma_f16 v228, v225, v225, v228
    v_cvt_pk_f16_f32 v198, v246, v247
    v_mfma_f32_16x16x32_bf16 v[178:181], v[170:173], a[192:195], 0
    s_waitcnt lgkmcnt(3)
    ds_read_b128 v[218:221], v1 offset:20480
    v_pk_fma_f16 v226, v198, v198, v226
    v_mfma_f32_16x16x32_bf16 v[178:181], v[154:157], a[196:199], v[178:181]
    s_waitcnt lgkmcnt(2)
    ds_read_b128 v[154:157], v0 offset:20608
    v_cvt_pk_f16_f32 v199, v248, v249
    v_mfma_f32_16x16x32_bf16 v[178:181], v[174:177], a[200:203], v[178:181]
    buffer_load_dwordx4 v152, s[52:55], s4 offen lds
    s_waitcnt vmcnt(7)
    v_mfma_f32_16x16x32_bf16 v[178:181], v[166:169], a[204:207], v[178:181]
    s_waitcnt lgkmcnt(2)
    ds_read_b64 a[232:233], v139 offset:3072
    ds_read_b64 a[220:221], v139 offset:4608
    v_mfma_f32_16x16x32_bf16 v[178:181], v[162:165], a[208:211], v[178:181]
    ds_read_b64 v[82:83], v139 offset:3080
    ds_read_b64 a[244:245], v139 offset:4616
    v_mfma_f32_16x16x32_bf16 v[178:181], v[202:205], a[212:215], v[178:181]
    ds_read_b64 v[106:107], v117 offset:3072
    ds_read_b64 v[94:95], v117 offset:4608
    v_mfma_f32_16x16x32_bf16 v[166:169], v[186:189], a[144:147], 0
    buffer_load_dwordx4 v153, s[52:55], s4 offen offset:1024 lds
    v_mfma_f32_16x16x32_bf16 v[166:169], v[214:217], a[148:151], v[166:169]
    s_waitcnt lgkmcnt(7)
    ds_read_b128 v[162:165], v1 offset:20608
    ds_read_b128 v[202:205], v0 offset:20736
    v_mfma_f32_16x16x32_bf16 v[166:169], v[234:237], a[152:155], v[166:169]
    s_waitcnt lgkmcnt(8)
    ds_read_b128 v[174:177], v1 offset:20736
    v_pk_fma_f16 v228, v199, v199, v228
    v_mfma_f32_16x16x32_bf16 v[166:169], v[238:241], a[156:159], v[166:169]
    v_cvt_pk_bf16_f32 v130, v130, v131
    v_cvt_pk_bf16_f32 v131, v132, v133
    v_mfma_f32_16x16x32_bf16 v[166:169], v[250:253], a[160:163], v[166:169]
    buffer_load_dwordx4 v122, s[52:55], s4 offen offset:2048 lds
    v_mfma_f32_16x16x32_bf16 v[166:169], v[230:233], a[164:167], v[166:169]
    s_add_u32 m0, s69, 3072
    s_add_u32 s4, 0, 61440
    v_cvt_pk_bf16_f32 v134, v134, v135
    v_mfma_f32_16x16x32_f16 v[170:173], v[40:43], v[226:229], 0
    s_waitcnt lgkmcnt(5)
    v_cvt_pk_bf16_f32 v135, v136, v137
    v_cvt_pk_bf16_f32 v114, v178, v179
    v_mfma_f32_16x16x32_bf16 v[226:229], v[186:189], a[168:171], 0
    s_waitcnt lgkmcnt(3)
    ds_read_b128 v[246:249], v0 offset:26624
    v_cvt_pk_bf16_f32 v115, v180, v181
    v_mfma_f32_16x16x32_bf16 v[226:229], v[214:217], a[172:175], v[226:229]
    buffer_load_dwordx4 v152, s[52:55], s4 offen lds
    v_mfma_f32_16x16x32_bf16 v[226:229], v[234:237], a[176:179], v[226:229]
    s_waitcnt lgkmcnt(2)
    s_waitcnt vmcnt(7)
    ds_read_b64 a[222:223], v254 offset:0
    v_mfma_f32_16x16x32_bf16 v[226:229], v[238:241], a[180:183], v[226:229]
    s_waitcnt lgkmcnt(2)
    ds_read_b64 a[234:235], v254 offset:1536
    ds_read_b64 a[246:247], v254 offset:8
    v_mfma_f32_16x16x32_bf16 v[226:229], v[250:253], a[184:187], v[226:229]
    ds_read_b64 v[84:85], v254 offset:1544
    ds_read_b64 v[96:97], v124 offset:0
    v_mfma_f32_16x16x32_bf16 v[226:229], v[230:233], a[188:191], v[226:229]
    buffer_load_dwordx4 v153, s[52:55], s4 offen offset:1024 lds
    ds_read_b64 v[108:109], v124 offset:1536
    v_rsq_f32 v172, v170
    v_rsq_f32 v173, v171
    v_mul_f32 v172, s31, v172
    v_cvt_pk_f16_f32 v172, v172, v173
    v_pk_mul_f16 v190, v190, v172 op_sel:[0,1] op_sel_hi:[1,1]
    v_pk_mul_f16 v191, v191, v172 op_sel:[0,1] op_sel_hi:[1,1]
    v_pk_mul_f16 v192, v192, v172 op_sel:[0,1] op_sel_hi:[1,1]
    v_pk_mul_f16 v193, v193, v172 op_sel:[0,1] op_sel_hi:[1,1]
    buffer_load_dwordx4 v122, s[52:55], s4 offen offset:2048 lds
    s_add_u32 m0, s28, 65536
    v_pk_mul_f16 v200, v200, v172 op_sel:[0,1] op_sel_hi:[1,1]
    v_pk_mul_f16 v201, v201, v172 op_sel:[0,1] op_sel_hi:[1,1]
    v_pk_mul_f16 v222, v222, v172 op_sel:[0,0] op_sel_hi:[1,0]
    v_pk_mul_f16 v223, v223, v172 op_sel:[0,0] op_sel_hi:[1,0]
    v_pk_mul_f16 v224, v224, v172 op_sel:[0,0] op_sel_hi:[1,0]
    v_pk_mul_f16 v225, v225, v172 op_sel:[0,0] op_sel_hi:[1,0]
    v_pk_mul_f16 v198, v198, v172 op_sel:[0,0] op_sel_hi:[1,0]
    v_pk_mul_f16 v199, v199, v172 op_sel:[0,0] op_sel_hi:[1,0]
    v_mfma_f32_16x16x32_bf16 v[178:181], v[186:189], a[192:195], 0
    s_waitcnt lgkmcnt(1)
    ds_read_b128 v[186:189], v1 offset:26624
    v_min3_u32 v44, v44, v170, v171
    v_mfma_f32_16x16x32_bf16 v[178:181], v[214:217], a[196:199], v[178:181]
    s_waitcnt lgkmcnt(1)
    buffer_load_dwordx4 v10, s[8:11], s24 offen lds
    v_mfma_f32_16x16x32_bf16 v[178:181], v[234:237], a[200:203], v[178:181]
    s_add_u32 m0, s28, 69632
    ds_read_b128 v[214:217], v0 offset:26752
    ds_read_b128 v[234:237], v1 offset:26752
    v_mfma_f32_16x16x32_bf16 v[178:181], v[238:241], a[204:207], v[178:181]
    ds_read_b128 v[238:241], v0 offset:26880
    v_max3_u32 v45, v45, v170, v171
    v_mfma_f32_16x16x32_bf16 v[178:181], v[250:253], a[208:211], v[178:181]
    ds_read_b128 v[250:253], v1 offset:26880
    s_waitcnt vmcnt(7)
    v_mfma_f32_16x16x32_bf16 v[178:181], v[230:233], a[212:215], v[178:181]
    buffer_load_dwordx4 v11, s[8:11], s24 offen lds
    v_mfma_f32_16x16x32_bf16 v[170:173], v[140:143], a[144:147], 0
    s_add_u32 m0, s28, 73728
    ds_read_b64 a[224:225], v254 offset:3072
    ds_read_b64 a[226:227], v254 offset:4608
    v_mfma_f32_16x16x32_bf16 v[170:173], v[218:221], a[148:151], v[170:173]
    ds_read_b64 a[248:249], v254 offset:3080
    ds_read_b64 a[250:251], v254 offset:4616
    v_mfma_f32_16x16x32_bf16 v[170:173], v[154:157], a[152:155], v[170:173]
    s_waitcnt lgkmcnt(8)
    ds_read_b64 v[98:99], v124 offset:3072
    ds_read_b64 v[100:101], v124 offset:4608
    v_mfma_f32_16x16x32_bf16 v[170:173], v[162:165], a[156:159], v[170:173]
    buffer_load_dwordx4 v12, s[8:11], s24 offen lds
    v_mfma_f32_16x16x32_bf16 v[170:173], v[202:205], a[160:163], v[170:173]
    s_add_u32 m0, s28, 77824
    v_cvt_pk_bf16_f32 v166, v166, v166
    v_cvt_pk_bf16_f32 v167, v167, v167
    v_mfma_f32_16x16x32_bf16 v[170:173], v[174:177], a[164:167], v[170:173]
    s_waitcnt lgkmcnt(7)
    ds_write2_b32 v147, v166, v167 offset0:0 offset1:68
    v_mfma_f32_16x16x32_bf16 v[122:125], v[140:143], a[168:171], 0
    s_waitcnt lgkmcnt(7)
    v_cvt_pk_bf16_f32 v168, v168, v168
    v_cvt_pk_bf16_f32 v169, v169, v169
    v_mfma_f32_16x16x32_bf16 v[122:125], v[218:221], a[172:175], v[122:125]
    s_waitcnt lgkmcnt(6)
    buffer_load_dwordx4 v13, s[8:11], s24 offen lds
    v_mfma_f32_16x16x32_bf16 v[122:125], v[154:157], a[176:179], v[122:125]
    s_add_u32 m0, s74, 0
    ds_write2_b32 v147, v168, v169 offset0:136 offset1:204
    v_mfma_f32_16x16x32_bf16 v[122:125], v[162:165], a[180:183], v[122:125]
    s_waitcnt lgkmcnt(2)
    v_cvt_pk_bf16_f32 v226, v226, v226
    v_cvt_pk_bf16_f32 v227, v227, v227
    v_mfma_f32_16x16x32_bf16 v[122:125], v[202:205], a[184:187], v[122:125]
    s_waitcnt vmcnt(7)
    ds_read_b64 a[236:237], v139 offset:0
    ds_read_b64 a[228:229], v139 offset:1536
    v_mfma_f32_16x16x32_bf16 v[122:125], v[174:177], a[188:191], v[122:125]
    buffer_load_dwordx4 v14, s[8:11], s24 offen lds
    v_mfma_f32_16x16x32_bf16 v[166:169], v[140:143], a[192:195], 0
    s_add_u32 s8, s40, s23
    ds_read_b64 v[86:87], v139 offset:8
    ds_read_b64 a[252:253], v139 offset:1544
    v_mfma_f32_16x16x32_bf16 v[166:169], v[218:221], a[196:199], v[166:169]
    s_addc_u32 s9, s41, 0
    ds_read_b64 v[110:111], v117 offset:0
    ds_read_b64 v[102:103], v117 offset:1536
    v_mfma_f32_16x16x32_bf16 v[166:169], v[154:157], a[200:203], v[166:169]
    s_sub_u32 s10, s36, s23
    ds_read_b128 v[218:221], v126 offset:6144
    ds_read_b128 v[154:157], v145 offset:6144
    v_mfma_f32_16x16x32_bf16 v[166:169], v[162:165], a[204:207], v[166:169]
    s_cmp_lt_u32 s34, s17
    ds_read_b128 v[162:165], v126 offset:6272
    ds_read_b128 v[230:233], v145 offset:6272
    v_mfma_f32_16x16x32_bf16 v[166:169], v[202:205], a[208:211], v[166:169]
    s_cselect_b32 s10, s10, 0
    v_cvt_pk_bf16_f32 v228, v228, v228
    v_cvt_pk_bf16_f32 v229, v229, v229
    v_mfma_f32_16x16x32_bf16 v[166:169], v[174:177], a[212:215], v[166:169]
    s_add_u32 m0, s28, 0
    ds_read_b128 v[174:177], v126 offset:6400
    ds_read_b128 v[126:129], v145 offset:6400
    s_mov_b32 s24, s23
    s_add_u32 s23, s23, s21
    s_cmp_ge_u32 s19, 72
    ds_write2_b32 v147, v226, v227 offset0:16 offset1:84
    v_mfma_f32_16x16x32_bf16 v[202:205], v[246:249], a[144:147], 0
    s_cselect_b32 s34, 72, 0
    v_cvt_pk_bf16_f32 v178, v178, v178
    v_cvt_pk_bf16_f32 v179, v179, v179
    v_mfma_f32_16x16x32_bf16 v[202:205], v[186:189], a[148:151], v[202:205]
    s_cselect_b32 s35, s22, 0
    ds_write2_b32 v147, v228, v229 offset0:152 offset1:220
    v_mfma_f32_16x16x32_bf16 v[202:205], v[214:217], a[152:155], v[202:205]
    s_waitcnt vmcnt(5)
    v_cvt_pk_bf16_f32 v180, v180, v180
    v_cvt_pk_bf16_f32 v181, v181, v181
    v_mfma_f32_16x16x32_bf16 v[202:205], v[234:237], a[156:159], v[202:205]
    s_sub_u32 s19, s19, s34
    ds_read_b64 a[230:231], v139 offset:3072
    ds_read_b64 a[238:239], v139 offset:4608
    v_mfma_f32_16x16x32_bf16 v[202:205], v[238:241], a[160:163], v[202:205]
    s_add_u32 s23, s23, s35
    ds_read_b64 a[254:255], v139 offset:3080
    ds_read_b64 v[88:89], v139 offset:4616
    v_mfma_f32_16x16x32_bf16 v[202:205], v[250:253], a[164:167], v[202:205]
    s_waitcnt lgkmcnt(6)
    ds_read_b64 v[104:105], v117 offset:3072
    ds_read_b64 v[112:113], v117 offset:4608
    v_mfma_f32_16x16x32_bf16 v[226:229], v[246:249], a[168:171], 0
    ds_write2_b32 v147, v178, v179 offset0:32 offset1:100
    v_mfma_f32_16x16x32_bf16 v[226:229], v[186:189], a[172:175], v[226:229]
    v_cvt_pk_bf16_f32 v138, v170, v171
    v_cvt_pk_bf16_f32 v139, v172, v173
    v_mfma_f32_16x16x32_bf16 v[226:229], v[214:217], a[176:179], v[226:229]
    ds_write2_b32 v147, v180, v181 offset0:168 offset1:236
    v_mfma_f32_16x16x32_bf16 v[226:229], v[234:237], a[180:183], v[226:229]
    v_cvt_pk_bf16_f32 v122, v122, v123
    v_cvt_pk_bf16_f32 v123, v124, v125
    v_mfma_f32_16x16x32_bf16 v[226:229], v[238:241], a[184:187], v[226:229]
    s_waitcnt lgkmcnt(6)
    v_cvt_pk_bf16_f32 v166, v166, v167
    v_cvt_pk_bf16_f32 v167, v168, v169
    v_mfma_f32_16x16x32_bf16 v[226:229], v[250:253], a[188:191], v[226:229]
    s_waitcnt lgkmcnt(4)
    v_cvt_pk_bf16_f32 v140, v202, v203
    v_cvt_pk_bf16_f32 v141, v204, v205
    v_mfma_f32_16x16x32_bf16 v[170:173], v[246:249], a[192:195], 0
    s_waitcnt lgkmcnt(2)
    v_xor_b32 v0, 65536, v0
    v_xor_b32 v1, 65536, v1
    v_mfma_f32_16x16x32_bf16 v[170:173], v[186:189], a[196:199], v[170:173]
    v_cvt_pk_bf16_f32 v124, v226, v227
    v_cvt_pk_bf16_f32 v125, v228, v229
    v_mfma_f32_16x16x32_bf16 v[170:173], v[214:217], a[200:203], v[170:173]
    v_xor_b32 v152, 65536, v2
    v_lshrrev_b32 v153, 2, v152
    v_mfma_f32_16x16x32_bf16 v[170:173], v[234:237], a[204:207], v[170:173]
    v_lshrrev_b32 v254, 8, v152
    v_add_u32 v152, 157184, v152
    v_mfma_f32_16x16x32_bf16 v[170:173], v[238:241], a[208:211], v[170:173]
    v_lshl_add_u32 v255, s16, 2, v152
    v_add_u32 v153, 162048, v153
    v_mfma_f32_16x16x32_bf16 v[170:173], v[250:253], a[212:215], v[170:173]
    v_lshlrev_b32 v254, 4, v254
    v_add_u32 v254, 162048, v254
    v_mfma_f32_16x16x32_bf16 v[226:229], v[218:221], a[144:147], 0
    v_or_b32 v202, v32, v33
    v_and_b32 v202, 0xffff, v202
    v_mfma_f32_16x16x32_bf16 v[226:229], v[154:157], a[148:151], v[226:229]
    v_lshl_or_b32 v202, v202, 16, v202
    v_or_b32 v203, v32, v33
    v_mfma_f32_16x16x32_bf16 v[226:229], v[162:165], a[152:155], v[226:229]
    v_cvt_pk_bf16_f32 v168, v170, v171
    v_cvt_pk_bf16_f32 v169, v172, v173
    v_mfma_f32_16x16x32_bf16 v[226:229], v[230:233], a[156:159], v[226:229]
    v_and_b32 v203, 0xffff, v203
    v_lshl_or_b32 v203, v203, 16, v203
    v_mfma_f32_16x16x32_bf16 v[226:229], v[174:177], a[160:163], v[226:229]
    v_or_b32 v204, v32, v33
    v_lshrrev_b32 v204, 16, v204
    v_mfma_f32_16x16x32_bf16 v[226:229], v[126:129], a[164:167], v[226:229]
    v_lshl_or_b32 v204, v204, 16, v204
    v_or_b32 v205, v32, v33
    v_mfma_f32_16x16x32_f16 v[170:173], v[242:245], v[206:209], v[50:53]
    v_lshrrev_b32 v205, 16, v205
    v_lshl_or_b32 v205, v205, 16, v205
    v_mfma_f32_16x16x32_f16 v[142:145], v[190:193], v[206:209], v[54:57]
    v_xor_b32 v2, 65536, v2
    v_mfma_f32_16x16x32_bf16 v[178:181], v[218:221], a[168:171], 0
    v_cvt_pk_bf16_f32 v226, v226, v226
    v_cvt_pk_bf16_f32 v227, v227, v227
    v_cvt_pk_bf16_f32 v228, v228, v228
    v_mfma_f32_16x16x16_f16 v[170:173], v[160:161], v[194:195], v[170:173]
    v_cvt_pk_bf16_f32 v229, v229, v229
    v_mfma_f32_16x16x16_f16 v[142:145], v[200:201], v[194:195], v[142:145]
    ds_write2_b32 v148, v226, v227 offset0:0 offset1:68
    v_mfma_f32_16x16x32_bf16 v[178:181], v[154:157], a[172:175], v[178:181]
    v_mfma_f32_16x16x32_bf16 v[178:181], v[162:165], a[176:179], v[178:181]
    ds_write2_b32 v148, v228, v229 offset0:136 offset1:204
    v_mfma_f32_16x16x32_bf16 v[178:181], v[230:233], a[180:183], v[178:181]
    v_mfma_f32_16x16x32_bf16 v[178:181], v[174:177], a[184:187], v[178:181]
    v_exp_f32 v170, v170
    v_mfma_f32_16x16x32_bf16 v[178:181], v[126:129], a[188:191], v[178:181]
    v_exp_f32 v171, v171
    v_mfma_f32_16x16x32_bf16 v[226:229], v[218:221], a[192:195], 0
    v_exp_f32 v172, v172
    v_mfma_f32_16x16x32_bf16 v[226:229], v[154:157], a[196:199], v[226:229]
    v_exp_f32 v173, v173
    v_mfma_f32_16x16x32_bf16 v[226:229], v[162:165], a[200:203], v[226:229]
    v_cvt_pk_bf16_f32 v212, v170, v171
    v_cvt_pk_bf16_f32 v213, v172, v173
    v_mfma_f32_16x16x32_bf16 v[226:229], v[230:233], a[204:207], v[226:229]
    v_cvt_pk_bf16_f32 v178, v178, v178
    v_cvt_pk_bf16_f32 v179, v179, v179
    v_mfma_f32_16x16x32_bf16 v[226:229], v[174:177], a[208:211], v[226:229]
    ds_write2_b32 v148, v178, v179 offset0:16 offset1:84
    v_mfma_f32_16x16x32_bf16 v[226:229], v[126:129], a[212:215], v[226:229]
    v_cvt_pk_bf16_f32 v180, v180, v180
    v_cvt_pk_bf16_f32 v181, v181, v181
    v_mfma_f32_16x16x32_bf16 v[170:173], v[202:205], a[216:219], 0
    ds_write2_b32 v148, v180, v181 offset0:152 offset1:220
    v_mfma_f32_16x16x32_bf16 v[170:173], v[202:205], a[240:243], v[170:173]
    v_exp_f32 v142, v142
    v_mfma_f32_16x16x32_bf16 v[170:173], v[202:205], v[90:93], v[170:173]
    v_exp_f32 v143, v143
    v_mfma_f32_16x16x32_f16 v[126:129], v[118:121], v[182:185], v[58:61]
    v_cvt_pk_bf16_f32 v226, v226, v226
    v_cvt_pk_bf16_f32 v227, v227, v227
    v_mfma_f32_16x16x32_bf16 v[154:157], v[202:205], a[220:223], 0
    ds_write2_b32 v148, v226, v227 offset0:32 offset1:100
    v_mfma_f32_16x16x32_bf16 v[154:157], v[202:205], a[244:247], v[154:157]
    v_cvt_pk_bf16_f32 v228, v228, v228
    v_mov_b32 v226, v170
    v_mov_b32_dpp v226, v171 quad_perm:[0,1,2,3] row_mask:0x2 bank_mask:0xf
    v_mfma_f32_16x16x16_f16 v[126:129], v[196:197], v[158:159], v[126:129]
    v_cvt_pk_bf16_f32 v229, v229, v229
    v_cvt_pk_bf16_f32 v36, v142, v143
    v_exp_f32 v144, v144
    v_mfma_f32_16x16x32_bf16 v[154:157], v[202:205], v[94:97], v[154:157]
    ds_write2_b32 v148, v228, v229 offset0:168 offset1:236
    v_mfma_f32_16x16x32_bf16 v[170:173], v[202:205], a[232:235], 0
    v_exp_f32 v145, v145
    v_mfma_f32_16x16x32_f16 v[218:221], v[242:245], v[182:185], v[62:65]
    ds_read_b128 v[146:149], v5 offset:0
    ds_read_b128 v[162:165], v5 offset:16
    v_mfma_f32_16x16x32_f16 v[174:177], v[190:193], v[182:185], v[66:69]
    ds_read_b128 v[178:181], v5 offset:48
    ds_read_b32 v142, v6 offset:192
    v_mfma_f32_16x16x32_bf16 v[170:173], v[202:205], v[82:85], v[170:173]
    ds_read2_b32 v[132:133], v6 offset0:0 offset1:0
    v_mov_b32 v143, v155
    v_cvt_pk_bf16_f32 v37, v144, v145
    v_mfma_f32_16x16x16_f16 v[218:221], v[160:161], v[158:159], v[218:221]
    v_exp_f32 v126, v126
    v_add_u32 v5, 336, v5
    v_mfma_f32_16x16x16_f16 v[174:177], v[200:201], v[158:159], v[174:177]
    v_exp_f32 v127, v127
    v_exp_f32 v128, v128
    v_mfma_f32_16x16x32_f16 v[186:189], v[118:121], v[222:225], v[70:73]
    ds_read2_b32 v[136:137], v6 offset0:16 offset1:16
    ds_read2_b32 v[116:117], v6 offset0:32 offset1:32
    v_mfma_f32_16x16x32_bf16 v[170:173], v[202:205], v[106:109], v[170:173]
    v_cvt_pk_bf16_f32 v126, v126, v127
    v_add_u32 v6, 272, v6
    v_mfma_f32_16x16x32_bf16 v[234:237], v[202:205], a[224:227], 0
    s_waitcnt lgkmcnt(5)
    v_exp_f32 v129, v129
    v_mfma_f32_16x16x32_f16 v[214:217], v[146:149], v[182:185], v[24:27]
    s_waitcnt lgkmcnt(3)
    v_exp_f32 v218, v218
    v_mfma_f32_16x16x32_f16 v[214:217], v[162:165], v[242:245], v[214:217]
    s_waitcnt lgkmcnt(2)
    v_mov_b32_dpp v226, v170 quad_perm:[0,1,2,3] row_mask:0x4 bank_mask:0xf
    v_mov_b32_dpp v226, v154 quad_perm:[0,1,2,3] row_mask:0x8 bank_mask:0xf
    v_mfma_f32_16x16x32_f16 v[214:217], v[178:181], v[158:161], v[214:217]
    ds_write_b32 v255, v226 offset:0
    v_mfma_f32_16x16x32_f16 v[182:185], v[146:149], v[206:209], v[22:25]
    v_mov_b32_dpp v143, v171 quad_perm:[0,1,2,3] row_mask:0x2 bank_mask:0xf
    v_cvt_pk_bf16_f32 v127, v128, v129
    v_mfma_f32_16x16x32_f16 v[182:185], v[162:165], v[118:121], v[182:185]
    v_exp_f32 v219, v219
    v_mfma_f32_16x16x32_f16 v[182:185], v[178:181], v[194:197], v[182:185]
    s_waitcnt lgkmcnt(1)
    v_exp_f32 v220, v220
    v_mfma_f32_16x16x32_f16 v[118:121], v[146:149], v[222:225], v[26:29]
    v_exp_f32 v221, v221
    v_mfma_f32_16x16x32_f16 v[118:121], v[162:165], v[190:193], v[118:121]
    v_cvt_pk_bf16_f32 v128, v218, v219
    v_cvt_pk_bf16_f32 v129, v220, v221
    v_mfma_f32_16x16x32_f16 v[118:121], v[178:181], v[198:201], v[118:121]
    v_exp_f32 v174, v174
    v_mfma_f32_16x16x32_f16 v[206:209], v[242:245], v[222:225], v[74:77]
    v_exp_f32 v175, v175
    v_mfma_f32_16x16x32_f16 v[242:245], v[190:193], v[222:225], v[78:81]
    v_mov_b32_dpp v142, v183 quad_perm:[0,1,2,3] row_mask:0x1 bank_mask:0xf
    v_exp_f32 v176, v176
    v_mfma_f32_16x16x16_f16 v[186:189], v[196:197], v[198:199], v[186:189]
    v_mov_b32_dpp v142, v215 quad_perm:[0,1,2,3] row_mask:0x2 bank_mask:0xf
    v_exp_f32 v118, v118
    v_mfma_f32_16x16x16_f16 v[206:209], v[160:161], v[198:199], v[206:209]
    v_exp_f32 v177, v177
    v_mov_b32_dpp v142, v119 quad_perm:[0,1,2,3] row_mask:0x4 bank_mask:0xf
    v_mfma_f32_16x16x16_f16 v[242:245], v[200:201], v[198:199], v[242:245]
    v_exp_f32 v214, v214
    v_exp_f32 v182, v182
    v_mfma_f32_16x16x32_bf16 v[234:237], v[202:205], a[248:251], v[234:237]
    v_exp_f32 v186, v186
    v_mfma_f32_16x16x32_bf16 v[234:237], v[202:205], v[98:101], v[234:237]
    v_exp_f32 v187, v187
    v_mfma_f32_16x16x32_bf16 v[222:225], v[202:205], a[228:231], 0
    v_cvt_pk_bf16_f32 v190, v186, v187
    v_cvt_pk_bf16_f32 v39, v182, 0
    v_mfma_f32_16x16x32_bf16 v[222:225], v[202:205], a[252:255], v[222:225]
    v_exp_f32 v188, v188
    v_mfma_f32_16x16x32_bf16 v[194:197], v[28:31], v[36:39], 0
    v_exp_f32 v189, v189
    v_mfma_f32_16x16x32_bf16 v[194:197], v[28:31], v[210:213], v[194:197]
    v_mov_b32_dpp v143, v234 quad_perm:[0,1,2,3] row_mask:0x4 bank_mask:0xf
    v_mov_b32_dpp v143, v235 quad_perm:[0,1,2,3] row_mask:0x8 bank_mask:0xf
    v_mfma_f32_16x16x32_bf16 v[198:201], v[130:133], v[36:39], 0
    ds_write_b32 v255, v143 offset:1024
    v_mfma_f32_16x16x32_bf16 v[198:201], v[138:141], v[210:213], v[198:201]
    v_exp_f32 v206, v206
    v_mfma_f32_16x16x32_bf16 v[182:185], v[134:137], v[36:39], 0
    v_exp_f32 v207, v207
    v_mfma_f32_16x16x32_bf16 v[182:185], v[122:125], v[210:213], v[182:185]
    v_cvt_pk_bf16_f32 v191, v188, v189
    v_cvt_pk_bf16_f32 v192, v206, v207
    v_mfma_f32_16x16x32_bf16 v[158:161], v[114:117], v[36:39], 0
    v_exp_f32 v208, v208
    v_mfma_f32_16x16x32_bf16 v[158:161], v[166:169], v[210:213], v[158:161]
    v_exp_f32 v209, v209
    v_mfma_f32_16x16x32_bf16 v[222:225], v[202:205], v[102:105], v[222:225]
    v_cvt_pk_bf16_f32 v193, v208, v209
    v_cvt_pk_bf16_f32 v36, v174, v175
    v_mfma_f32_16x16x32_bf16 v[206:209], v[202:205], a[236:239], 0
    v_exp_f32 v242, v242
    v_mfma_f32_16x16x32_bf16 v[206:209], v[202:205], v[86:89], v[206:209]
    v_exp_f32 v243, v243
    v_mfma_f32_16x16x32_bf16 v[206:209], v[202:205], v[110:113], v[206:209]
    v_exp_f32 v244, v244
    v_exp_f32 v245, v245
    v_cvt_pk_bf16_f32 v37, v176, v177
    v_cvt_pk_bf16_f32 v39, v214, 0
    v_rcp_f32 v194, v194
    v_exp_f32 v142, v142
    v_mfma_f32_16x16x32_bf16 v[170:173], v[28:31], v[36:39], 0
    v_mul_f32 v198, v194, v198
    v_mov_b32 v119, v206
    v_mfma_f32_16x16x32_bf16 v[170:173], v[28:31], v[126:129], v[170:173]
    v_mov_b32_dpp v119, v222 quad_perm:[0,1,2,3] row_mask:0x2 bank_mask:0xf
    v_mov_b32_dpp v119, v223 quad_perm:[0,1,2,3] row_mask:0x4 bank_mask:0xf
    v_mfma_f32_16x16x32_bf16 v[146:149], v[130:133], v[36:39], 0
    v_mov_b32_dpp v119, v207 quad_perm:[0,1,2,3] row_mask:0x8 bank_mask:0xf
    v_mul_f32 v199, v194, v199
    v_mfma_f32_16x16x32_bf16 v[146:149], v[138:141], v[126:129], v[146:149]
    ds_write_b32 v255, v119 offset:2048
    v_mfma_f32_16x16x32_bf16 v[206:209], v[134:137], v[36:39], 0
    v_cvt_pk_bf16_f32 v222, v198, v199
    v_mul_f32 v200, v194, v200
    v_mfma_f32_16x16x32_bf16 v[206:209], v[122:125], v[126:129], v[206:209]
    v_mul_f32 v201, v194, v201
    v_cvt_pk_bf16_f32 v223, v200, v201
    v_mfma_f32_16x16x32_bf16 v[154:157], v[114:117], v[36:39], 0
    v_cvt_pk_bf16_f32 v36, v242, v243
    v_cvt_pk_bf16_f32 v37, v244, v245
    v_mfma_f32_16x16x32_bf16 v[154:157], v[166:169], v[126:129], v[154:157]
    v_cvt_pk_bf16_f32 v39, v118, 0
    v_mul_f32 v182, v194, v182
    v_mul_f32 v183, v194, v183
    v_mfma_f32_16x16x32_bf16 v[126:129], v[28:31], v[36:39], 0
    v_cvt_pk_bf16_f32 v224, v182, v183
    v_mul_f32 v184, v194, v184
    v_mfma_f32_16x16x32_bf16 v[126:129], v[28:31], v[190:193], v[126:129]
    v_mul_f32 v185, v194, v185
    v_cvt_pk_bf16_f32 v225, v184, v185
    v_mfma_f32_16x16x32_bf16 v[118:121], v[130:133], v[36:39], 0
    s_waitcnt lgkmcnt(0)
    v_mul_f32 v158, v194, v158
    v_mul_f32 v159, v194, v159
    v_mfma_f32_16x16x32_bf16 v[118:121], v[138:141], v[190:193], v[118:121]
    s_barrier
    ds_read_b128 v[182:185], v152 offset:0
    ds_read_b128 v[242:245], v152 offset:1024
    v_mfma_f32_16x16x32_bf16 v[174:177], v[134:137], v[36:39], 0
    ds_read_b128 v[162:165], v152 offset:2048
    v_cvt_pk_bf16_f32 v152, v158, v159
    v_mfma_f32_16x16x32_bf16 v[174:177], v[122:125], v[190:193], v[174:177]
    ds_write_b128 v3, v[222:225] offset:0
    v_mfma_f32_16x16x32_bf16 v[202:205], v[114:117], v[36:39], 0
    v_rcp_f32 v126, v126
    v_mfma_f32_16x16x32_bf16 v[202:205], v[166:169], v[190:193], v[202:205]
    v_mul_f32 v118, v126, v118
    v_mul_f32 v119, v126, v119
    v_cvt_pk_bf16_f32 v190, v118, v119
    v_mul_f32 v120, v126, v120
    v_mul_f32 v121, v126, v121
    v_cvt_pk_bf16_f32 v191, v120, v121
    v_mul_f32 v174, v126, v174
    v_mul_f32 v175, v126, v175
    v_cvt_pk_bf16_f32 v192, v174, v175
    s_waitcnt lgkmcnt(3)
    s_waitcnt lgkmcnt(2)
    v_add_f32 v182, v182, v183
    v_add_f32 v184, v184, v185
    s_waitcnt lgkmcnt(1)
    v_add_f32 v182, v182, v184
    v_mul_f32 v182, 0xbbaaaaab, v182
    ds_write_b32 v153, v182 offset:0
    v_add_f32 v242, v242, v243
    v_add_f32 v244, v244, v245
    v_add_f32 v242, v242, v244
    v_mul_f32 v242, 0xbbaaaaab, v242
    ds_write_b32 v153, v242 offset:256
    v_add_f32 v162, v162, v163
    v_add_f32 v164, v164, v165
    s_waitcnt vmcnt(0)
    s_barrier
    buffer_load_dwordx4 v10, s[8:11], 0 offen lds
    s_add_u32 m0, s28, 4096
    ds_read_b128 v[182:185], v0 offset:20480
    ds_read_b128 v[198:201], v1 offset:20480
    ds_read_b128 v[210:213], v0 offset:20608
    ds_read_b128 v[222:225], v1 offset:20608
    ds_read_b128 v[226:229], v0 offset:20736
    ds_read_b128 v[242:245], v1 offset:20736
    buffer_load_dwordx4 v11, s[8:11], 0 offen lds
    v_add_f32 v162, v162, v164
    v_mul_f32 v162, 0xbbaaaaab, v162
    s_add_u32 m0, s28, 8192
    ds_write_b32 v153, v162 offset:512
    v_mul_f32 v176, v126, v176
    v_mul_f32 v177, v126, v177
    v_cvt_pk_bf16_f32 v193, v176, v177
    v_mul_f32 v202, v126, v202
    ds_read_b128 v[174:177], v254 offset:0
    s_waitcnt lgkmcnt(7)
    v_mfma_f32_16x16x32_bf16 v[118:121], a[72:75], v[182:185], 0
    s_waitcnt lgkmcnt(5)
    buffer_load_dwordx4 v12, s[8:11], 0 offen lds
    ds_read_b128 v[218:221], v254 offset:64
    v_mfma_f32_16x16x32_bf16 v[118:121], a[76:79], v[198:201], v[118:121]
    s_add_u32 m0, s28, 12288
    ds_read_b128 v[178:181], v254 offset:128
    ds_read_b128 v[162:165], v254 offset:192
    v_mfma_f32_16x16x32_bf16 v[118:121], a[80:83], v[210:213], v[118:121]
    s_waitcnt lgkmcnt(6)
    ds_read_b128 v[186:189], v254 offset:256
    v_mul_f32 v203, v126, v203
    v_mfma_f32_16x16x32_bf16 v[118:121], a[84:87], v[222:225], v[118:121]
    s_xor_b32 s28, s28, 65536
    ds_write_b128 v3, v[190:193] offset:12288
    v_mfma_f32_16x16x32_bf16 v[118:121], a[88:91], v[226:229], v[118:121]
    s_waitcnt lgkmcnt(6)
    buffer_load_dwordx4 v13, s[8:11], 0 offen lds
    v_cvt_pk_bf16_f32 v144, v202, v203
    v_mfma_f32_16x16x32_bf16 v[118:121], a[92:95], v[242:245], v[118:121]
    s_mov_b32 m0, s29
    v_mul_f32 v204, v126, v204
    v_mul_f32 v205, v126, v205
    v_mfma_f32_16x16x32_bf16 v[190:193], a[96:99], v[182:185], 0
    s_waitcnt lgkmcnt(5)
    v_cvt_pk_bf16_f32 v145, v204, v205
    v_mul_f32 v160, v194, v160
    v_mul_f32 v161, v194, v161
    v_mfma_f32_16x16x16_bf16 v[194:197], a[216:217], v[150:151], v[174:177]
    v_cvt_pk_bf16_f32 v153, v160, v161
    v_rcp_f32 v170, v170
    v_mfma_f32_16x16x16_bf16 v[158:161], a[240:241], v[150:151], v[174:177]
    v_mul_f32 v146, v170, v146
    v_mul_f32 v147, v170, v147
    v_cvt_pk_bf16_f32 v146, v146, v147
    v_mfma_f32_16x16x16_bf16 v[126:129], v[90:91], v[150:151], v[174:177]
    v_mul_f32 v148, v170, v148
    v_cvt_pk_bf16_f32 v194, v194, v195
    v_accvgpr_write_b32 a216, v194
    v_cvt_pk_bf16_f32 v196, v196, v197
    v_mfma_f32_16x16x32_bf16 v[190:193], a[100:103], v[198:201], v[190:193]
    s_waitcnt lgkmcnt(0)
    buffer_load_dwordx4 v14, s[8:11], 0 offen lds
    ds_write_b64 v4, v[152:153] offset:4096
    v_mfma_f32_16x16x16_bf16 v[174:177], a[218:219], v[150:151], v[218:221]
    v_accvgpr_write_b32 a217, v196
    v_cvt_pk_bf16_f32 v158, v158, v159
    v_accvgpr_write_b32 a240, v158
    v_mfma_f32_16x16x16_bf16 v[194:197], a[242:243], v[150:151], v[218:221]
    v_cvt_pk_bf16_f32 v160, v160, v161
    v_accvgpr_write_b32 a241, v160
    v_cvt_pk_bf16_f32 v90, v126, v127
    v_mfma_f32_16x16x16_bf16 v[158:161], v[92:93], v[150:151], v[218:221]
    v_cvt_pk_bf16_f32 v91, v128, v129
    v_cvt_pk_bf16_f32 v174, v174, v175
    v_accvgpr_write_b32 a218, v174
    v_mfma_f32_16x16x16_bf16 v[126:129], a[232:233], v[150:151], v[178:181]
    v_cvt_pk_bf16_f32 v176, v176, v177
    v_accvgpr_write_b32 a219, v176
    v_cvt_pk_bf16_f32 v194, v194, v195
    v_mfma_f32_16x16x16_bf16 v[174:177], v[82:83], v[150:151], v[178:181]
    v_accvgpr_write_b32 a242, v194
    v_cvt_pk_bf16_f32 v196, v196, v197
    v_accvgpr_write_b32 a243, v196
    v_mfma_f32_16x16x16_bf16 v[194:197], v[106:107], v[150:151], v[178:181]
    v_cvt_pk_bf16_f32 v92, v158, v159
    v_cvt_pk_bf16_f32 v93, v160, v161
    v_cvt_pk_bf16_f32 v126, v126, v127
    v_mfma_f32_16x16x16_bf16 v[158:161], a[220:221], v[150:151], v[162:165]
    v_accvgpr_write_b32 a232, v126
    v_cvt_pk_bf16_f32 v128, v128, v129
    v_accvgpr_write_b32 a233, v128
    v_mfma_f32_16x16x16_bf16 v[202:205], a[244:245], v[150:151], v[162:165]
    v_cvt_pk_bf16_f32 v82, v174, v175
    v_cvt_pk_bf16_f32 v83, v176, v177
    v_cvt_pk_bf16_f32 v106, v194, v195
    v_mfma_f32_16x16x16_bf16 v[126:129], v[94:95], v[150:151], v[162:165]
    v_cvt_pk_bf16_f32 v107, v196, v197
    v_cvt_pk_bf16_f32 v158, v158, v159
    v_accvgpr_write_b32 a220, v158
    v_mfma_f32_16x16x16_bf16 v[174:177], a[222:223], v[150:151], v[186:189]
    v_cvt_pk_bf16_f32 v160, v160, v161
    v_accvgpr_write_b32 a221, v160
    v_cvt_pk_bf16_f32 v202, v202, v203
    v_mfma_f32_16x16x16_bf16 v[194:197], a[246:247], v[150:151], v[186:189]
    v_accvgpr_write_b32 a244, v202
    v_cvt_pk_bf16_f32 v204, v204, v205
    v_accvgpr_write_b32 a245, v204
    v_mfma_f32_16x16x16_bf16 v[162:165], v[96:97], v[150:151], v[186:189]
    v_cvt_pk_bf16_f32 v94, v126, v127
    v_cvt_pk_bf16_f32 v95, v128, v129
    v_cvt_pk_bf16_f32 v174, v174, v175
    v_accvgpr_write_b32 a222, v174
    v_mfma_f32_16x16x32_bf16 v[190:193], a[104:107], v[210:213], v[190:193]
    s_xor_b32 s29, s29, s30
    ds_read_b128 v[126:129], v254 offset:320
    ds_read_b128 v[202:205], v254 offset:384
    v_mfma_f32_16x16x32_bf16 v[190:193], a[108:111], v[222:225], v[190:193]
    ds_read_b128 v[218:221], v254 offset:448
    ds_read_b128 v[178:181], v254 offset:512
    v_mfma_f32_16x16x32_bf16 v[190:193], a[112:115], v[226:229], v[190:193]
    v_cvt_pk_bf16_f32 v176, v176, v177
    v_accvgpr_write_b32 a223, v176
    v_mfma_f32_16x16x32_bf16 v[190:193], a[116:119], v[242:245], v[190:193]
    ds_write_b64 v4, v[144:145] offset:16384
    v_mfma_f32_16x16x32_bf16 v[158:161], a[120:123], v[182:185], 0
    v_cvt_pk_bf16_f32 v194, v194, v195
    v_accvgpr_write_b32 a246, v194
    v_mfma_f32_16x16x32_bf16 v[158:161], a[124:127], v[198:201], v[158:161]
    v_cvt_pk_bf16_f32 v196, v196, v197
    v_accvgpr_write_b32 a247, v196
    v_mfma_f32_16x16x32_bf16 v[158:161], a[128:131], v[210:213], v[158:161]
    v_cvt_pk_bf16_f32 v96, v162, v163
    v_cvt_pk_bf16_f32 v97, v164, v165
    v_mfma_f32_16x16x32_bf16 v[158:161], a[132:135], v[222:225], v[158:161]
    s_waitcnt lgkmcnt(4)
    ds_read_b128 v[194:197], v254 offset:576
    v_mul_f32 v149, v170, v149
    v_cvt_pk_bf16_f32 v147, v148, v149
    v_mfma_f32_16x16x16_bf16 v[174:177], a[234:235], v[150:151], v[126:129]
    v_mul_f32 v206, v170, v206
    v_mul_f32 v207, v170, v207
    v_cvt_pk_bf16_f32 v148, v206, v207
    v_mfma_f32_16x16x16_bf16 v[162:165], v[84:85], v[150:151], v[126:129]
    v_mul_f32 v208, v170, v208
    v_mul_f32 v209, v170, v209
    v_cvt_pk_bf16_f32 v149, v208, v209
    v_mfma_f32_16x16x16_bf16 v[206:209], v[108:109], v[150:151], v[126:129]
    v_cvt_pk_bf16_f32 v174, v174, v175
    v_accvgpr_write_b32 a234, v174
    v_cvt_pk_bf16_f32 v176, v176, v177
    v_accvgpr_write_b32 a235, v176
    v_mfma_f32_16x16x32_bf16 v[158:161], a[136:139], v[226:229], v[158:161]
    s_waitcnt lgkmcnt(1)
    ds_write_b128 v3, v[146:149] offset:6144
    v_mfma_f32_16x16x16_bf16 v[146:149], a[224:225], v[150:151], v[202:205]
    v_cvt_pk_bf16_f32 v84, v162, v163
    v_cvt_pk_bf16_f32 v85, v164, v165
    v_cvt_pk_bf16_f32 v108, v206, v207
    v_mfma_f32_16x16x16_bf16 v[126:129], a[248:249], v[150:151], v[202:205]
    v_cvt_pk_bf16_f32 v109, v208, v209
    v_mul_f32 v154, v170, v154
    v_mul_f32 v155, v170, v155
    v_mfma_f32_16x16x16_bf16 v[206:209], v[98:99], v[150:151], v[202:205]
    v_cvt_pk_bf16_f32 v146, v146, v147
    v_accvgpr_write_b32 a224, v146
    v_cvt_pk_bf16_f32 v148, v148, v149
    v_mfma_f32_16x16x16_bf16 v[174:177], a[226:227], v[150:151], v[218:221]
    v_accvgpr_write_b32 a225, v148
    v_cvt_pk_bf16_f32 v126, v126, v127
    v_accvgpr_write_b32 a248, v126
    v_mfma_f32_16x16x16_bf16 v[146:149], a[250:251], v[150:151], v[218:221]
    v_cvt_pk_bf16_f32 v128, v128, v129
    v_accvgpr_write_b32 a249, v128
    v_cvt_pk_bf16_f32 v98, v206, v207
    v_mfma_f32_16x16x16_bf16 v[126:129], v[100:101], v[150:151], v[218:221]
    v_cvt_pk_bf16_f32 v99, v208, v209
    v_cvt_pk_bf16_f32 v174, v174, v175
    v_accvgpr_write_b32 a226, v174
    v_mfma_f32_16x16x16_bf16 v[206:209], a[236:237], v[150:151], v[178:181]
    v_cvt_pk_bf16_f32 v176, v176, v177
    v_accvgpr_write_b32 a227, v176
    v_cvt_pk_bf16_f32 v146, v146, v147
    v_mfma_f32_16x16x16_bf16 v[174:177], v[86:87], v[150:151], v[178:181]
    v_accvgpr_write_b32 a250, v146
    v_cvt_pk_bf16_f32 v148, v148, v149
    v_accvgpr_write_b32 a251, v148
    v_mfma_f32_16x16x16_bf16 v[146:149], v[110:111], v[150:151], v[178:181]
    v_cvt_pk_bf16_f32 v100, v126, v127
    v_cvt_pk_bf16_f32 v101, v128, v129
    v_cvt_pk_bf16_f32 v206, v206, v207
    v_accvgpr_write_b32 a236, v206
    v_mfma_f32_16x16x32_bf16 v[158:161], a[140:143], v[242:245], v[158:161]
    s_waitcnt lgkmcnt(0)
    ds_read_b128 v[126:129], v254 offset:640
    ds_read_b128 v[218:221], v254 offset:704
    v_cvt_pk_bf16_f32 v208, v208, v209
    v_mfma_f32_16x16x16_bf16 v[202:205], a[228:229], v[150:151], v[194:197]
    v_accvgpr_write_b32 a237, v208
    v_cvt_pk_bf16_f32 v86, v174, v175
    v_cvt_pk_bf16_f32 v87, v176, v177
    v_mfma_f32_16x16x16_bf16 v[174:177], a[252:253], v[150:151], v[194:197]
    v_cvt_pk_bf16_f32 v110, v146, v147
    v_cvt_pk_bf16_f32 v111, v148, v149
    v_cvt_pk_bf16_f32 v254, v154, v155
    v_mfma_f32_16x16x16_bf16 v[146:149], v[102:103], v[150:151], v[194:197]
    v_cvt_pk_bf16_f32 v202, v202, v203
    v_accvgpr_write_b32 a228, v202
    v_cvt_pk_bf16_f32 v204, v204, v205
    v_accvgpr_write_b32 a229, v204
    v_mfma_f32_16x16x32_bf16 v[206:209], a[0:3], v[182:185], 0
    v_cvt_pk_bf16_f32 v174, v174, v175
    v_accvgpr_write_b32 a252, v174
    v_mfma_f32_16x16x32_bf16 v[206:209], a[4:7], v[198:201], v[206:209]
    v_cvt_pk_bf16_f32 v176, v176, v177
    v_accvgpr_write_b32 a253, v176
    v_mfma_f32_16x16x32_bf16 v[206:209], a[8:11], v[210:213], v[206:209]
    v_cvt_pk_bf16_f32 v102, v146, v147
    v_cvt_pk_bf16_f32 v103, v148, v149
    v_mfma_f32_16x16x32_bf16 v[206:209], a[12:15], v[222:225], v[206:209]
    s_waitcnt lgkmcnt(0)
    v_mul_f32 v156, v170, v156
    v_mul_f32 v157, v170, v157
    v_cvt_pk_bf16_f32 v255, v156, v157
    v_mfma_f32_16x16x16_bf16 v[194:197], a[230:231], v[150:151], v[126:129]
    v_cvt_pk_f16_f32 v118, v118, v119
    v_pk_mul_f16 v163, v118, v118
    v_cvt_pk_f16_f32 v119, v120, v121
    v_mfma_f32_16x16x16_bf16 v[146:149], a[254:255], v[150:151], v[126:129]
    v_pk_mul_f16 v165, v119, v119
    v_cvt_pk_f16_f32 v120, v190, v191
    v_pk_fma_f16 v163, v120, v120, v163
    v_mfma_f32_16x16x16_bf16 v[154:157], v[104:105], v[150:151], v[126:129]
    v_cvt_pk_bf16_f32 v194, v194, v195
    v_accvgpr_write_b32 a230, v194
    v_cvt_pk_bf16_f32 v196, v196, v197
    v_mfma_f32_16x16x16_bf16 v[174:177], a[238:239], v[150:151], v[218:221]
    v_accvgpr_write_b32 a231, v196
    v_cvt_pk_bf16_f32 v146, v146, v147
    v_accvgpr_write_b32 a254, v146
    v_mfma_f32_16x16x16_bf16 v[194:197], v[88:89], v[150:151], v[218:221]
    v_cvt_pk_bf16_f32 v148, v148, v149
    v_accvgpr_write_b32 a255, v148
    v_cvt_pk_bf16_f32 v104, v154, v155
    v_mfma_f32_16x16x16_bf16 v[146:149], v[112:113], v[150:151], v[218:221]
    v_cvt_pk_bf16_f32 v105, v156, v157
    v_cvt_pk_bf16_f32 v174, v174, v175
    v_accvgpr_write_b32 a238, v174
    v_cvt_pk_bf16_f32 v176, v176, v177
    v_mfma_f32_16x16x32_bf16 v[206:209], a[16:19], v[226:229], v[206:209]
    ds_write_b64 v4, v[254:255] offset:10240
    v_mfma_f32_16x16x32_bf16 v[206:209], a[20:23], v[242:245], v[206:209]
    v_accvgpr_write_b32 a239, v176
    v_cvt_pk_bf16_f32 v88, v194, v195
    v_mfma_f32_16x16x32_bf16 v[174:177], a[24:27], v[182:185], 0
    v_cvt_pk_bf16_f32 v89, v196, v197
    v_cvt_pk_bf16_f32 v112, v146, v147
    v_mfma_f32_16x16x32_bf16 v[174:177], a[28:31], v[198:201], v[174:177]
    v_cvt_pk_bf16_f32 v113, v148, v149
    v_cvt_pk_f16_f32 v121, v192, v193
    v_mfma_f32_16x16x32_bf16 v[174:177], a[32:35], v[210:213], v[174:177]
    v_pk_fma_f16 v165, v121, v121, v165
    v_cvt_pk_f16_f32 v196, v158, v159
    v_mfma_f32_16x16x32_bf16 v[174:177], a[36:39], v[222:225], v[174:177]
    v_pk_fma_f16 v163, v196, v196, v163
    v_cvt_pk_f16_f32 v197, v160, v161
    v_mfma_f32_16x16x32_bf16 v[174:177], a[40:43], v[226:229], v[174:177]
    v_pk_fma_f16 v165, v197, v197, v165
    v_cvt_pk_f16_f32 v206, v206, v207
    v_mfma_f32_16x16x32_bf16 v[174:177], a[44:47], v[242:245], v[174:177]
    v_cvt_pk_bf16_f32 v142, v142, v142
    v_xor_b32 v3, 65536, v3
    v_mfma_f32_16x16x32_bf16 v[218:221], a[48:51], v[182:185], 0
    ds_write_b16 v8, v142
    v_mfma_f32_16x16x32_bf16 v[218:221], a[52:55], v[198:201], v[218:221]
    v_xor_b32 v4, 65536, v4
    v_mfma_f32_16x16x32_bf16 v[218:221], a[56:59], v[210:213], v[218:221]
    ds_read_b128 v[190:193], v9
    ds_read_b128 v[150:153], v9 offset:64
    v_mfma_f32_16x16x32_bf16 v[218:221], a[60:63], v[222:225], v[218:221]
    v_mfma_f32_16x16x32_bf16 v[218:221], a[64:67], v[226:229], v[218:221]
    v_mfma_f32_16x16x32_bf16 v[218:221], a[68:71], v[242:245], v[218:221]
    v_mfma_f32_16x16x32_bf16 v[170:173], v[182:185], a[144:147], 0
    v_mfma_f32_16x16x32_bf16 v[170:173], v[198:201], a[148:151], v[170:173]
    v_mfma_f32_16x16x32_bf16 v[170:173], v[210:213], a[152:155], v[170:173]
    v_mfma_f32_16x16x32_bf16 v[170:173], v[222:225], a[156:159], v[170:173]
    v_mfma_f32_16x16x32_bf16 v[170:173], v[226:229], a[160:163], v[170:173]
    s_waitcnt lgkmcnt(0)
    v_mfma_f32_16x16x32_bf16 v[158:161], v[190:193], v[28:31], 0
    v_mfma_f32_16x16x32_bf16 v[158:161], v[150:153], v[28:31], v[158:161]
    v_mfma_f32_16x16x32_bf16 v[146:149], v[190:193], v[138:141], 0
    v_mfma_f32_16x16x32_bf16 v[146:149], v[150:153], v[130:133], v[146:149]
    v_mfma_f32_16x16x32_bf16 v[130:133], v[190:193], v[122:125], 0
    v_mfma_f32_16x16x32_bf16 v[130:133], v[150:153], v[134:137], v[130:133]
    v_mfma_f32_16x16x32_bf16 v[122:125], v[190:193], v[166:169], 0
    v_mfma_f32_16x16x32_bf16 v[122:125], v[150:153], v[114:117], v[122:125]
    v_mfma_f32_16x16x32_bf16 v[170:173], v[242:245], a[164:167], v[170:173]
    s_nop 0
    v_rcp_f32 v158, v158
    s_nop 0
    v_mul_f32 v146, v146, v158
    s_nop 0
    v_mul_f32_dpp v146, v130, v158 quad_perm:[0,1,2,3] row_mask:0x2 bank_mask:0xf
    s_nop 0
    v_mul_f32_dpp v146, v122, v158 quad_perm:[0,1,2,3] row_mask:0x4 bank_mask:0xf
    v_cvt_pk_bf16_f32 v146, v146, v146
    ds_write_b16 v7, v146
    v_add_u32 v7, 16, v7
    s_waitcnt lgkmcnt(0)
    s_barrier
L_go:
    s_waitcnt lgkmcnt(0)
    s_cmp_eq_u32 s16, 1
    s_cbranch_scc1 L_loop_fast1
    s_cmp_eq_u32 s16, 2
    s_cbranch_scc1 L_loop_fast2
    s_cmp_eq_u32 s16, 3
    s_cbranch_scc1 L_loop_fast3
    s_branch L_loop_fast0
.p2align 6
L_loop_fast0:
    v_mfma_f32_16x16x32_bf16 v[234:237], v[182:185], a[168:171], 0
    s_add_u32 s12, s42, s27
    ds_read_b128 v[230:233], v2 offset:18432
    ds_read_b128 v[238:241], v2 offset:19456
    v_mfma_f32_16x16x32_bf16 v[234:237], v[198:201], a[172:175], v[234:237]
    s_addc_u32 s13, s43, 0
    v_pk_mul_f16 v162, v206, v206
    v_cvt_pk_f16_f32 v207, v208, v209
    v_mfma_f32_16x16x32_bf16 v[234:237], v[210:213], a[176:179], v[234:237]
    s_sub_u32 s14, s36, s27
    ds_read_b128 v[134:137], v0 offset:26624
    v_pk_mul_f16 v164, v207, v207
    v_mfma_f32_16x16x32_bf16 v[234:237], v[222:225], a[180:183], v[234:237]
    s_cmp_ge_u32 s18, 2
    ds_read_b128 v[154:157], v1 offset:26624
    v_cvt_pk_f16_f32 v208, v174, v175
    v_mfma_f32_16x16x32_bf16 v[234:237], v[226:229], a[184:187], v[234:237]
    s_cselect_b32 s14, s14, 0
    ds_read_b128 v[130:133], v0 offset:26752
    v_pk_fma_f16 v162, v208, v208, v162
    v_mfma_f32_16x16x32_bf16 v[234:237], v[242:245], a[188:191], v[234:237]
    s_add_u32 s34, s18, 2
    ds_read_b128 v[122:125], v1 offset:26752
    v_cvt_pk_f16_f32 v209, v176, v177
    v_mfma_f32_16x16x32_bf16 v[114:117], v[182:185], a[192:195], 0
    s_add_u32 s8, s40, s23
    ds_read_b128 v[126:129], v0 offset:26880
    v_pk_fma_f16 v164, v209, v209, v164
    v_mfma_f32_16x16x32_bf16 v[114:117], v[198:201], a[196:199], v[114:117]
    s_addc_u32 s9, s41, 0
    ds_read_b128 v[166:169], v1 offset:26880
    v_cvt_pk_f16_f32 v194, v218, v219
    v_mfma_f32_16x16x32_bf16 v[114:117], v[210:213], a[200:203], v[114:117]
    s_waitcnt lgkmcnt(6)
    v_pk_fma_f16 v162, v194, v194, v162
    v_cvt_pk_f16_f32 v195, v220, v221
    v_mfma_f32_16x16x32_bf16 v[198:201], v[32:35], v[230:233], 0
    s_sub_u32 s10, s36, s23
    v_pk_fma_f16 v164, v195, v195, v164
    v_cvt_pk_bf16_f32 v174, v170, v171
    v_mfma_f32_16x16x32_bf16 v[198:201], v[32:35], v[238:241], v[198:201]
    s_waitcnt lgkmcnt(5)
    v_cvt_pk_bf16_f32 v175, v172, v173
    v_cvt_pk_bf16_f32 v182, v234, v235
    v_mfma_f32_16x16x32_f16 v[170:173], v[40:43], v[162:165], 0
    s_cmp_lt_u32 s34, s17
    v_cvt_pk_bf16_f32 v183, v236, v237
    s_cselect_b32 s10, s10, 0
    v_mfma_f32_16x16x32_bf16 v[114:117], v[222:225], a[204:207], v[114:117]
    s_add_u32 m0, s28, 0
    v_mul_f32 v255, 0x3baaaaab, v198
    v_mul_f32 v254, 0x3baaaaab, v199
    v_mfma_f32_16x16x32_bf16 v[114:117], v[226:229], a[208:211], v[114:117]
    s_mov_b32 s27, s26
    v_rsq_f32 v172, v170
    v_mfma_f32_16x16x32_bf16 v[114:117], v[242:245], a[212:215], v[114:117]
    s_mov_b32 s26, s25
    v_rsq_f32 v173, v171
    v_mfma_f32_16x16x32_bf16 v[162:165], a[72:75], v[134:137], 0
    s_waitcnt lgkmcnt(0)
    v_mul_f32 v172, s31, v172
    v_cvt_pk_f16_f32 v172, v172, v173
    v_mfma_f32_16x16x32_bf16 v[162:165], a[76:79], v[154:157], v[162:165]
    s_mov_b32 s25, s24
    v_cvt_pk_bf16_f32 v114, v114, v115
    v_cvt_pk_bf16_f32 v115, v116, v117
    v_mfma_f32_16x16x32_bf16 v[162:165], a[80:83], v[130:133], v[162:165]
    s_mov_b32 s24, s23
    v_pk_mul_f16 v118, v118, v172 op_sel:[0,1] op_sel_hi:[1,1]
    v_pk_mul_f16 v119, v119, v172 op_sel:[0,1] op_sel_hi:[1,1]
    v_mfma_f32_16x16x32_bf16 v[162:165], a[84:87], v[122:125], v[162:165]
    v_pk_mul_f16 v120, v120, v172 op_sel:[0,1] op_sel_hi:[1,1]
    v_pk_mul_f16 v121, v121, v172 op_sel:[0,1] op_sel_hi:[1,1]
    v_mfma_f32_16x16x32_bf16 v[162:165], a[88:91], v[126:129], v[162:165]
    v_pk_mul_f16 v196, v196, v172 op_sel:[0,1] op_sel_hi:[1,1]
    v_pk_mul_f16 v197, v197, v172 op_sel:[0,1] op_sel_hi:[1,1]
    v_mfma_f32_16x16x32_bf16 v[162:165], a[92:95], v[166:169], v[162:165]
    v_pk_mul_f16 v206, v206, v172 op_sel:[0,0] op_sel_hi:[1,0]
    v_pk_mul_f16 v207, v207, v172 op_sel:[0,0] op_sel_hi:[1,0]
    v_mfma_f32_16x16x32_bf16 v[210:213], a[96:99], v[134:137], 0
    v_pk_mul_f16 v208, v208, v172 op_sel:[0,0] op_sel_hi:[1,0]
    v_pk_mul_f16 v209, v209, v172 op_sel:[0,0] op_sel_hi:[1,0]
    v_mfma_f32_16x16x32_bf16 v[210:213], a[100:103], v[154:157], v[210:213]
    v_pk_mul_f16 v194, v194, v172 op_sel:[0,0] op_sel_hi:[1,0]
    v_pk_mul_f16 v195, v195, v172 op_sel:[0,0] op_sel_hi:[1,0]
    v_mfma_f32_16x16x32_bf16 v[210:213], a[104:107], v[130:133], v[210:213]
    v_min3_u32 v44, v44, v170, v171
    v_max3_u32 v45, v45, v170, v171
    v_mfma_f32_16x16x32_bf16 v[210:213], a[108:111], v[122:125], v[210:213]
    v_cvt_pk_f16_f32 v170, v162, v163
    v_pk_mul_f16 v163, v170, v170
    v_mfma_f32_16x16x32_bf16 v[210:213], a[112:115], v[126:129], v[210:213]
    v_cvt_pk_f16_f32 v171, v164, v165
    v_pk_mul_f16 v165, v171, v171
    v_mfma_f32_16x16x32_bf16 v[210:213], a[116:119], v[166:169], v[210:213]
    v_rsq_f32 v255, v255
    v_mfma_f32_16x16x32_bf16 v[214:217], a[120:123], v[134:137], 0
    v_rsq_f32 v254, v254
    v_mfma_f32_16x16x32_bf16 v[214:217], a[124:127], v[154:157], v[214:217]
    v_mul_f32 v142, v254, v142
    v_mul_f32 v143, v254, v143
    v_mfma_f32_16x16x32_bf16 v[214:217], a[128:131], v[130:133], v[214:217]
    v_cvt_pk_bf16_f32 v142, v142, v143
    v_cvt_pk_f16_f32 v172, v210, v211
    v_mfma_f32_16x16x32_bf16 v[214:217], a[132:135], v[122:125], v[214:217]
    v_pk_fma_f16 v163, v172, v172, v163
    v_cvt_pk_f16_f32 v173, v212, v213
    v_mfma_f32_16x16x32_bf16 v[214:217], a[136:139], v[126:129], v[214:217]
    v_pk_fma_f16 v165, v173, v173, v165
    v_mul_f32 v144, v254, v144
    v_mfma_f32_16x16x32_bf16 v[214:217], a[140:143], v[166:169], v[214:217]
    v_mul_f32 v145, v254, v145
    v_cvt_pk_bf16_f32 v143, v144, v145
    v_mfma_f32_16x16x32_bf16 v[210:213], a[0:3], v[134:137], 0
    v_mul_f32 v158, v254, v158
    v_mul_f32 v159, v254, v159
    v_mfma_f32_16x16x32_bf16 v[210:213], a[4:7], v[154:157], v[210:213]
    v_cvt_pk_bf16_f32 v144, v158, v159
    v_mul_f32 v160, v254, v160
    v_mfma_f32_16x16x32_bf16 v[210:213], a[8:11], v[130:133], v[210:213]
    v_cvt_pk_f16_f32 v220, v214, v215
    v_pk_fma_f16 v163, v220, v220, v163
    v_mfma_f32_16x16x32_bf16 v[210:213], a[12:15], v[122:125], v[210:213]
    v_cvt_pk_f16_f32 v221, v216, v217
    v_pk_fma_f16 v165, v221, v221, v165
    v_mfma_f32_16x16x32_bf16 v[210:213], a[16:19], v[126:129], v[210:213]
    v_mul_f32 v161, v254, v161
    v_cvt_pk_bf16_f32 v145, v160, v161
    v_mfma_f32_16x16x32_bf16 v[210:213], a[20:23], v[166:169], v[210:213]
    buffer_store_dwordx4 v[142:145], v16, s[12:15], 0 offen
    v_mul_f32 v178, v254, v178
    v_mul_f32 v179, v254, v179
    v_cvt_pk_bf16_f32 v198, v178, v179
    v_mul_f32 v180, v254, v180
    v_mfma_f32_16x16x32_bf16 v[142:145], a[24:27], v[134:137], 0
    v_mul_f32 v181, v254, v181
    v_cvt_pk_bf16_f32 v199, v180, v181
    v_mfma_f32_16x16x32_bf16 v[142:145], a[28:31], v[154:157], v[142:145]
    v_cvt_pk_f16_f32 v158, v210, v211
    v_pk_mul_f16 v162, v158, v158
    v_mfma_f32_16x16x32_bf16 v[142:145], a[32:35], v[130:133], v[142:145]
    v_cvt_pk_f16_f32 v159, v212, v213
    v_pk_mul_f16 v164, v159, v159
    v_mfma_f32_16x16x32_bf16 v[142:145], a[36:39], v[122:125], v[142:145]
    v_mul_f32 v254, 0x3baaaaab, v200
    v_mul_f32 v150, v255, v150
    v_mfma_f32_16x16x32_bf16 v[142:145], a[40:43], v[126:129], v[142:145]
    v_rsq_f32 v254, v254
    v_mfma_f32_16x16x32_bf16 v[142:145], a[44:47], v[166:169], v[142:145]
    v_mul_f32 v146, v254, v146
    v_mul_f32 v147, v254, v147
    v_mfma_f32_16x16x32_bf16 v[178:181], a[48:51], v[134:137], 0
    v_cvt_pk_bf16_f32 v146, v146, v147
    v_mul_f32 v148, v254, v148
    v_mfma_f32_16x16x32_bf16 v[178:181], a[52:55], v[154:157], v[178:181]
    v_mul_f32 v149, v254, v149
    v_cvt_pk_bf16_f32 v147, v148, v149
    v_mfma_f32_16x16x32_bf16 v[178:181], a[56:59], v[130:133], v[178:181]
    v_mul_f32 v138, v254, v138
    v_mul_f32 v139, v254, v139
    v_mfma_f32_16x16x32_bf16 v[178:181], a[60:63], v[122:125], v[178:181]
    v_cvt_pk_bf16_f32 v148, v138, v139
    v_mul_f32 v140, v254, v140
    v_mfma_f32_16x16x32_bf16 v[178:181], a[64:67], v[126:129], v[178:181]
    v_mul_f32 v141, v254, v141
    v_cvt_pk_bf16_f32 v149, v140, v141
    v_mfma_f32_16x16x32_bf16 v[178:181], a[68:71], v[166:169], v[178:181]
    v_mul_f32 v186, v254, v186
    v_mul_f32 v187, v254, v187
    v_mfma_f32_16x16x32_bf16 v[138:141], v[134:137], a[144:147], 0
    v_cvt_pk_bf16_f32 v200, v186, v187
    v_mul_f32 v188, v254, v188
    v_mfma_f32_16x16x32_bf16 v[138:141], v[154:157], a[148:151], v[138:141]
    v_mul_f32 v189, v254, v189
    v_cvt_pk_bf16_f32 v201, v188, v189
    v_mfma_f32_16x16x32_bf16 v[138:141], v[130:133], a[152:155], v[138:141]
    v_cvt_pk_f16_f32 v160, v142, v143
    v_pk_fma_f16 v162, v160, v160, v162
    v_mfma_f32_16x16x32_bf16 v[138:141], v[122:125], a[156:159], v[138:141]
    v_cvt_pk_f16_f32 v161, v144, v145
    v_pk_fma_f16 v164, v161, v161, v164
    v_mfma_f32_16x16x32_bf16 v[138:141], v[126:129], a[160:163], v[138:141]
    buffer_store_dwordx4 v[146:149], v17, s[12:15], 0 offen
    v_cvt_pk_f16_f32 v218, v178, v179
    v_pk_fma_f16 v162, v218, v218, v162
    v_cvt_pk_f16_f32 v219, v180, v181
    v_pk_fma_f16 v164, v219, v219, v164
    v_mfma_f32_16x16x32_bf16 v[138:141], v[166:169], a[164:167], v[138:141]
    v_mul_f32 v151, v255, v151
    v_cvt_pk_bf16_f32 v150, v150, v151
    v_mfma_f32_16x16x32_f16 v[142:145], v[40:43], v[162:165], 0
    v_mul_f32 v152, v255, v152
    v_mul_f32 v153, v255, v153
    v_mfma_f32_16x16x32_bf16 v[178:181], v[134:137], a[168:171], 0
    v_cvt_pk_bf16_f32 v151, v152, v153
    v_mul_f32 v190, v255, v190
    v_mfma_f32_16x16x32_bf16 v[178:181], v[154:157], a[172:175], v[178:181]
    v_cvt_pk_bf16_f32 v176, v138, v139
    v_cvt_pk_bf16_f32 v177, v140, v141
    v_mfma_f32_16x16x32_bf16 v[178:181], v[130:133], a[176:179], v[178:181]
    ds_read_b128 v[146:149], v0 offset:32768
    v_min3_u32 v44, v44, v142, v143
    v_mfma_f32_16x16x32_bf16 v[178:181], v[122:125], a[180:183], v[178:181]
    ds_read_b128 v[138:141], v1 offset:32768
    v_max3_u32 v45, v45, v142, v143
    v_mfma_f32_16x16x32_bf16 v[178:181], v[126:129], a[184:187], v[178:181]
    ds_read_b128 v[186:189], v0 offset:32896
    v_mul_f32 v191, v255, v191
    v_mfma_f32_16x16x32_bf16 v[178:181], v[166:169], a[188:191], v[178:181]
    ds_read_b128 v[162:165], v1 offset:32896
    v_cvt_pk_bf16_f32 v152, v190, v191
    v_mfma_f32_16x16x32_bf16 v[210:213], v[134:137], a[192:195], 0
    ds_read_b128 v[134:137], v0 offset:33024
    v_mul_f32 v192, v255, v192
    v_mfma_f32_16x16x32_bf16 v[210:213], v[154:157], a[196:199], v[210:213]
    ds_read_b128 v[154:157], v1 offset:33024
    v_mul_f32 v193, v255, v193
    v_mfma_f32_16x16x32_bf16 v[210:213], v[130:133], a[200:203], v[210:213]
    v_rsq_f32 v144, v142
    v_mfma_f32_16x16x32_bf16 v[210:213], v[122:125], a[204:207], v[210:213]
    v_rsq_f32 v145, v143
    v_mfma_f32_16x16x32_bf16 v[210:213], v[126:129], a[208:211], v[210:213]
    s_waitcnt lgkmcnt(5)
    v_mul_f32 v144, s31, v144
    v_cvt_pk_f16_f32 v144, v144, v145
    v_mfma_f32_16x16x32_bf16 v[210:213], v[166:169], a[212:215], v[210:213]
    s_waitcnt lgkmcnt(4)
    v_cvt_pk_bf16_f32 v184, v178, v179
    v_cvt_pk_bf16_f32 v185, v180, v181
    v_mfma_f32_16x16x32_bf16 v[178:181], a[72:75], v[146:149], 0
    s_waitcnt lgkmcnt(3)
    v_pk_mul_f16 v170, v170, v144 op_sel:[0,1] op_sel_hi:[1,1]
    v_pk_mul_f16 v171, v171, v144 op_sel:[0,1] op_sel_hi:[1,1]
    v_mfma_f32_16x16x32_bf16 v[178:181], a[76:79], v[138:141], v[178:181]
    s_waitcnt lgkmcnt(2)
    v_cvt_pk_bf16_f32 v116, v210, v211
    v_cvt_pk_bf16_f32 v117, v212, v213
    v_mfma_f32_16x16x32_bf16 v[178:181], a[80:83], v[186:189], v[178:181]
    s_waitcnt lgkmcnt(1)
    buffer_store_dwordx2 v[200:201], v20, s[12:15], 0 offen
    v_pk_mul_f16 v172, v172, v144 op_sel:[0,1] op_sel_hi:[1,1]
    v_pk_mul_f16 v173, v173, v144 op_sel:[0,1] op_sel_hi:[1,1]
    v_mfma_f32_16x16x32_bf16 v[178:181], a[84:87], v[162:165], v[178:181]
    s_waitcnt lgkmcnt(0)
    v_pk_mul_f16 v220, v220, v144 op_sel:[0,1] op_sel_hi:[1,1]
    v_pk_mul_f16 v221, v221, v144 op_sel:[0,1] op_sel_hi:[1,1]
    v_mfma_f32_16x16x32_bf16 v[178:181], a[88:91], v[134:137], v[178:181]
    v_pk_mul_f16 v158, v158, v144 op_sel:[0,0] op_sel_hi:[1,0]
    v_pk_mul_f16 v159, v159, v144 op_sel:[0,0] op_sel_hi:[1,0]
    v_mfma_f32_16x16x32_bf16 v[178:181], a[92:95], v[154:157], v[178:181]
    v_pk_mul_f16 v160, v160, v144 op_sel:[0,0] op_sel_hi:[1,0]
    v_pk_mul_f16 v161, v161, v144 op_sel:[0,0] op_sel_hi:[1,0]
    v_mfma_f32_16x16x32_bf16 v[130:133], a[96:99], v[146:149], 0
    v_pk_mul_f16 v218, v218, v144 op_sel:[0,0] op_sel_hi:[1,0]
    v_pk_mul_f16 v219, v219, v144 op_sel:[0,0] op_sel_hi:[1,0]
    v_mfma_f32_16x16x32_bf16 v[130:133], a[100:103], v[138:141], v[130:133]
    s_waitcnt vmcnt(3)
    v_cvt_pk_bf16_f32 v153, v192, v193
    v_cvt_pk_f16_f32 v142, v178, v179
    v_mfma_f32_16x16x32_bf16 v[130:133], a[104:107], v[186:189], v[130:133]
    s_barrier
    v_pk_mul_f16 v191, v142, v142
    v_cvt_pk_f16_f32 v143, v180, v181
    v_mfma_f32_16x16x32_bf16 v[130:133], a[108:111], v[162:165], v[130:133]
    s_nop 0
    v_pk_mul_f16 v193, v143, v143
    v_mul_f32 v202, v255, v202
    v_mfma_f32_16x16x32_bf16 v[130:133], a[112:115], v[134:137], v[130:133]
    s_nop 0
    v_mul_f32 v203, v255, v203
    v_cvt_pk_bf16_f32 v254, v202, v203
    v_mfma_f32_16x16x32_bf16 v[130:133], a[116:119], v[154:157], v[130:133]
    s_nop 0
    v_mul_f32 v204, v255, v204
    v_mul_f32 v205, v255, v205
    v_mfma_f32_16x16x32_bf16 v[178:181], a[120:123], v[146:149], 0
    v_cvt_pk_bf16_f32 v255, v204, v205
    v_xor_b32 v0, 65536, v0
    v_mfma_f32_16x16x32_bf16 v[178:181], a[124:127], v[138:141], v[178:181]
    v_xor_b32 v1, 65536, v1
    v_cvt_pk_f16_f32 v144, v130, v131
    v_mfma_f32_16x16x32_bf16 v[178:181], a[128:131], v[186:189], v[178:181]
    v_pk_fma_f16 v191, v144, v144, v191
    v_cvt_pk_f16_f32 v145, v132, v133
    v_mfma_f32_16x16x32_bf16 v[178:181], a[132:135], v[162:165], v[178:181]
    v_pk_fma_f16 v193, v145, v145, v193
    v_mfma_f32_16x16x32_bf16 v[178:181], a[136:139], v[134:137], v[178:181]
    v_mfma_f32_16x16x32_bf16 v[178:181], a[140:143], v[154:157], v[178:181]
    v_mfma_f32_16x16x32_bf16 v[202:205], a[0:3], v[146:149], 0
    v_mfma_f32_16x16x32_bf16 v[202:205], a[4:7], v[138:141], v[202:205]
    buffer_load_dwordx4 v10, s[8:11], 0 offen lds
    s_add_u32 m0, s28, 4096
    v_mfma_f32_16x16x32_bf16 v[202:205], a[8:11], v[186:189], v[202:205]
    v_mfma_f32_16x16x32_bf16 v[202:205], a[12:15], v[162:165], v[202:205]
    v_mfma_f32_16x16x32_bf16 v[202:205], a[16:19], v[134:137], v[202:205]
    v_mfma_f32_16x16x32_bf16 v[202:205], a[20:23], v[154:157], v[202:205]
    v_cvt_pk_f16_f32 v124, v178, v179
    v_pk_fma_f16 v191, v124, v124, v191
    v_mfma_f32_16x16x32_bf16 v[130:133], a[24:27], v[146:149], 0
    buffer_load_dwordx4 v11, s[8:11], 0 offen lds
    v_cvt_pk_f16_f32 v125, v180, v181
    v_mfma_f32_16x16x32_bf16 v[130:133], a[28:31], v[138:141], v[130:133]
    s_add_u32 m0, s28, 8192
    v_pk_fma_f16 v193, v125, v125, v193
    v_cvt_pk_f16_f32 v178, v202, v203
    v_mfma_f32_16x16x32_bf16 v[130:133], a[32:35], v[186:189], v[130:133]
    v_pk_mul_f16 v190, v178, v178
    v_cvt_pk_f16_f32 v179, v204, v205
    v_mfma_f32_16x16x32_bf16 v[130:133], a[36:39], v[162:165], v[130:133]
    v_pk_mul_f16 v192, v179, v179
    v_mfma_f32_16x16x32_bf16 v[130:133], a[40:43], v[134:137], v[130:133]
    v_mfma_f32_16x16x32_bf16 v[130:133], a[44:47], v[154:157], v[130:133]
    buffer_load_dwordx4 v12, s[8:11], 0 offen lds
    s_add_u32 m0, s28, 12288
    v_mfma_f32_16x16x32_bf16 v[202:205], a[48:51], v[146:149], 0
    s_xor_b32 s28, s28, 65536
    v_mfma_f32_16x16x32_bf16 v[202:205], a[52:55], v[138:141], v[202:205]
    ds_read_b128 v[166:169], v5 offset:0
    ds_read_b128 v[126:129], v5 offset:16
    v_mfma_f32_16x16x32_bf16 v[202:205], a[56:59], v[186:189], v[202:205]
    ds_read_b128 v[210:213], v5 offset:48
    ds_read_b32 v200, v6 offset:192
    v_mfma_f32_16x16x32_bf16 v[202:205], a[60:63], v[162:165], v[202:205]
    v_cvt_pk_f16_f32 v180, v130, v131
    v_pk_fma_f16 v190, v180, v180, v190
    v_mfma_f32_16x16x32_bf16 v[202:205], a[64:67], v[134:137], v[202:205]
    buffer_load_dwordx4 v13, s[8:11], 0 offen lds
    v_cvt_pk_f16_f32 v181, v132, v133
    v_mfma_f32_16x16x32_bf16 v[202:205], a[68:71], v[154:157], v[202:205]
    s_mov_b32 m0, s29
    v_pk_fma_f16 v192, v181, v181, v192
    v_add_u32 v5, 336, v5
    v_mfma_f32_16x16x32_bf16 v[130:133], v[146:149], a[144:147], 0
    s_xor_b32 s29, s29, s30
    s_add_u32 s19, s19, s20
    s_add_u32 s23, s23, s21
    v_mfma_f32_16x16x32_bf16 v[130:133], v[138:141], a[148:151], v[130:133]
    s_cmp_ge_u32 s19, 72
    v_cvt_pk_f16_f32 v122, v202, v203
    v_pk_fma_f16 v190, v122, v122, v190
    v_mfma_f32_16x16x32_bf16 v[130:133], v[186:189], a[152:155], v[130:133]
    s_cselect_b32 s34, 72, 0
    v_cvt_pk_f16_f32 v123, v204, v205
    v_pk_fma_f16 v192, v123, v123, v192
    v_mfma_f32_16x16x32_bf16 v[130:133], v[162:165], a[156:159], v[130:133]
    s_waitcnt lgkmcnt(2)
    buffer_store_dwordx2 v[198:199], v19, s[12:15], 0 offen
    s_cselect_b32 s35, s22, 0
    s_sub_u32 s19, s19, s34
    v_mfma_f32_16x16x32_f16 v[202:205], v[40:43], v[190:193], 0
    s_add_u32 s23, s23, s35
    s_add_u32 s18, s18, 1
    s_cmp_lt_u32 s18, s17
    v_mfma_f32_16x16x32_f16 v[214:217], v[166:169], v[158:161], v[24:27]
    s_waitcnt lgkmcnt(0)
    v_mfma_f32_16x16x32_f16 v[214:217], v[126:129], v[170:173], v[214:217]
    v_mfma_f32_16x16x32_f16 v[214:217], v[210:213], v[218:221], v[214:217]
    v_mfma_f32_16x16x32_f16 v[190:193], v[166:169], v[206:209], v[22:25]
    v_rsq_f32 v204, v202
    v_mfma_f32_16x16x32_f16 v[190:193], v[126:129], v[118:121], v[190:193]
    v_rsq_f32 v205, v203
    v_mfma_f32_16x16x32_f16 v[190:193], v[210:213], v[194:197], v[190:193]
    v_mul_f32 v204, s31, v204
    v_cvt_pk_f16_f32 v204, v204, v205
    v_mfma_f32_16x16x32_bf16 v[130:133], v[134:137], a[160:163], v[130:133]
    v_pk_mul_f16 v142, v142, v204 op_sel:[0,1] op_sel_hi:[1,1]
    v_pk_mul_f16 v143, v143, v204 op_sel:[0,1] op_sel_hi:[1,1]
    v_mfma_f32_16x16x32_bf16 v[130:133], v[154:157], a[164:167], v[130:133]
    v_pk_mul_f16 v144, v144, v204 op_sel:[0,1] op_sel_hi:[1,1]
    v_pk_mul_f16 v145, v145, v204 op_sel:[0,1] op_sel_hi:[1,1]
    v_mfma_f32_16x16x32_bf16 v[222:225], v[146:149], a[168:171], 0
    v_mov_b32_dpp v200, v191 quad_perm:[0,1,2,3] row_mask:0x1 bank_mask:0xf
    v_mov_b32_dpp v200, v215 quad_perm:[0,1,2,3] row_mask:0x2 bank_mask:0xf
    v_mfma_f32_16x16x32_bf16 v[222:225], v[138:141], a[172:175], v[222:225]
    v_pk_mul_f16 v124, v124, v204 op_sel:[0,1] op_sel_hi:[1,1]
    v_pk_mul_f16 v125, v125, v204 op_sel:[0,1] op_sel_hi:[1,1]
    v_mfma_f32_16x16x32_bf16 v[222:225], v[186:189], a[176:179], v[222:225]
    v_cvt_pk_bf16_f32 v130, v130, v131
    v_cvt_pk_bf16_f32 v131, v132, v133
    v_mfma_f32_16x16x32_bf16 v[222:225], v[162:165], a[180:183], v[222:225]
    v_pk_mul_f16 v178, v178, v204 op_sel:[0,0] op_sel_hi:[1,0]
    v_pk_mul_f16 v179, v179, v204 op_sel:[0,0] op_sel_hi:[1,0]
    v_mfma_f32_16x16x32_f16 v[226:229], v[118:121], v[206:209], v[46:49]
    v_pk_mul_f16 v180, v180, v204 op_sel:[0,0] op_sel_hi:[1,0]
    v_pk_mul_f16 v181, v181, v204 op_sel:[0,0] op_sel_hi:[1,0]
    v_mfma_f32_16x16x32_f16 v[230:233], v[170:173], v[206:209], v[50:53]
    v_pk_mul_f16 v122, v122, v204 op_sel:[0,0] op_sel_hi:[1,0]
    v_pk_mul_f16 v123, v123, v204 op_sel:[0,0] op_sel_hi:[1,0]
    v_mfma_f32_16x16x32_f16 v[234:237], v[142:145], v[206:209], v[54:57]
    v_min3_u32 v44, v44, v202, v203
    v_exp_f32 v214, v214
    v_mfma_f32_16x16x16_f16 v[226:229], v[196:197], v[194:195], v[226:229]
    v_max3_u32 v45, v45, v202, v203
    v_exp_f32 v190, v190
    v_mfma_f32_16x16x16_f16 v[230:233], v[220:221], v[194:195], v[230:233]
    v_cvt_pk_bf16_f32 v39, v190, 0
    v_mfma_f32_16x16x16_f16 v[234:237], v[124:125], v[194:195], v[234:237]
    buffer_store_dwordx4 v[150:153], v15, s[12:15], 0 offen
    v_mfma_f32_16x16x32_bf16 v[222:225], v[134:137], a[184:187], v[222:225]
    v_mfma_f32_16x16x32_bf16 v[222:225], v[154:157], a[188:191], v[222:225]
    ds_read_b128 v[206:209], v2 offset:0
    v_mfma_f32_16x16x32_bf16 v[150:153], v[146:149], a[192:195], 0
    ds_read_b128 v[146:149], v2 offset:1024
    v_mfma_f32_16x16x32_bf16 v[150:153], v[138:141], a[196:199], v[150:153]
    ds_read_b128 v[138:141], v2 offset:2048
    v_mfma_f32_16x16x32_bf16 v[150:153], v[186:189], a[200:203], v[150:153]
    ds_read_b128 v[186:189], v2 offset:3072
    v_mfma_f32_16x16x32_bf16 v[150:153], v[162:165], a[204:207], v[150:153]
    ds_read_b128 v[162:165], v2 offset:4096
    v_cvt_pk_bf16_f32 v222, v222, v223
    v_mfma_f32_16x16x32_bf16 v[150:153], v[134:137], a[208:211], v[150:153]
    ds_read_b128 v[134:137], v2 offset:5120
    v_cvt_pk_bf16_f32 v223, v224, v225
    v_mfma_f32_16x16x32_bf16 v[150:153], v[154:157], a[212:215], v[150:153]
    ds_read2_b32 v[132:133], v6 offset0:0 offset1:0
    ds_read2_b32 v[224:225], v6 offset0:16 offset1:16
    v_mfma_f32_16x16x32_f16 v[154:157], v[166:169], v[178:181], v[26:29]
    ds_read2_b32 v[168:169], v6 offset0:32 offset1:32
    v_add_u32 v6, 272, v6
    v_mfma_f32_16x16x32_f16 v[154:157], v[126:129], v[142:145], v[154:157]
    s_waitcnt lgkmcnt(8)
    v_exp_f32 v226, v226
    v_mfma_f32_16x16x32_f16 v[154:157], v[210:213], v[122:125], v[154:157]
    s_waitcnt lgkmcnt(7)
    v_cvt_pk_bf16_f32 v166, v150, v151
    v_cvt_pk_bf16_f32 v167, v152, v153
    v_mfma_f32_16x16x32_bf16 v[150:153], a[216:219], v[206:209], 0
    s_waitcnt lgkmcnt(6)
    v_exp_f32 v227, v227
    v_mfma_f32_16x16x32_bf16 v[150:153], a[220:223], v[146:149], v[150:153]
    s_waitcnt lgkmcnt(5)
    v_exp_f32 v154, v154
    v_mfma_f32_16x16x32_bf16 v[150:153], a[224:227], v[138:141], v[150:153]
    s_waitcnt lgkmcnt(4)
    v_mov_b32_dpp v200, v155 quad_perm:[0,1,2,3] row_mask:0x4 bank_mask:0xf
    v_cvt_pk_bf16_f32 v126, v226, v227
    v_mfma_f32_16x16x32_bf16 v[150:153], a[228:231], v[186:189], v[150:153]
    s_waitcnt lgkmcnt(3)
    v_exp_f32 v200, v200
    v_mfma_f32_16x16x32_bf16 v[150:153], a[232:235], v[162:165], v[150:153]
    s_waitcnt lgkmcnt(1)
    v_exp_f32 v228, v228
    v_mfma_f32_16x16x32_bf16 v[150:153], a[236:239], v[134:137], v[150:153]
    s_waitcnt lgkmcnt(0)
    buffer_store_dwordx2 v[254:255], v18, s[12:15], 0 offen
    v_exp_f32 v229, v229
    v_mfma_f32_16x16x32_bf16 v[190:193], a[240:243], v[206:209], 0
    v_cvt_pk_bf16_f32 v200, v200, v200
    v_cvt_pk_bf16_f32 v127, v228, v229
    v_mfma_f32_16x16x32_bf16 v[190:193], a[244:247], v[146:149], v[190:193]
    ds_write_b16 v8, v200
    v_mfma_f32_16x16x32_bf16 v[190:193], a[248:251], v[138:141], v[190:193]
    v_exp_f32 v230, v230
    v_mfma_f32_16x16x32_bf16 v[190:193], a[252:255], v[186:189], v[190:193]
    ds_read_b128 v[198:201], v2 offset:6144
    ds_read_b128 v[210:213], v9
    v_mfma_f32_16x16x32_bf16 v[190:193], v[82:85], v[162:165], v[190:193]
    ds_read_b128 v[226:229], v2 offset:7168
    ds_read_b128 v[238:241], v9 offset:64
    v_mfma_f32_16x16x32_bf16 v[190:193], v[86:89], v[134:137], v[190:193]
    v_exp_f32 v231, v231
    v_mfma_f32_16x16x32_bf16 v[202:205], v[90:93], v[206:209], 0
    ds_read_b128 v[206:209], v2 offset:8192
    ds_read_b128 v[242:245], v2 offset:9216
    v_mfma_f32_16x16x32_bf16 v[202:205], v[94:97], v[146:149], v[202:205]
    v_cvt_pk_bf16_f32 v128, v230, v231
    v_fma_f32 v254, v150, v150, s33
    v_mfma_f32_16x16x32_bf16 v[202:205], v[98:101], v[138:141], v[202:205]
    ds_read_b128 v[146:149], v2 offset:10240
    ds_read_b128 v[138:141], v2 offset:11264
    v_mfma_f32_16x16x32_bf16 v[202:205], v[102:105], v[186:189], v[202:205]
    v_exp_f32 v232, v232
    v_mfma_f32_16x16x32_bf16 v[202:205], v[106:109], v[162:165], v[202:205]
    v_exp_f32 v233, v233
    v_mfma_f32_16x16x32_bf16 v[202:205], v[110:113], v[134:137], v[202:205]
    s_waitcnt lgkmcnt(6)
    v_cvt_pk_bf16_f32 v129, v232, v233
    v_fmac_f32 v254, v151, v151
    v_mfma_f32_16x16x32_bf16 v[186:189], v[210:213], v[28:31], 0
    s_waitcnt lgkmcnt(4)
    v_exp_f32 v234, v234
    v_mfma_f32_16x16x32_bf16 v[186:189], v[238:241], v[28:31], v[186:189]
    v_exp_f32 v235, v235
    v_mfma_f32_16x16x32_f16 v[134:137], v[118:121], v[158:161], v[58:61]
    s_waitcnt lgkmcnt(2)
    v_cvt_pk_bf16_f32 v36, v234, v235
    v_fmac_f32 v254, v152, v152
    v_mfma_f32_16x16x32_f16 v[162:165], v[170:173], v[158:161], v[62:65]
    v_exp_f32 v236, v236
    v_mfma_f32_16x16x32_f16 v[230:233], v[142:145], v[158:161], v[66:69]
    s_waitcnt lgkmcnt(0)
    buffer_load_dwordx4 v14, s[8:11], 0 offen lds
    v_rcp_f32 v186, v186
    v_mfma_f32_16x16x16_f16 v[134:137], v[196:197], v[218:219], v[134:137]
    v_exp_f32 v237, v237
    v_fmac_f32 v254, v153, v153
    v_mfma_f32_16x16x16_f16 v[162:165], v[220:221], v[218:219], v[162:165]
    v_cvt_pk_bf16_f32 v37, v236, v237
    v_fmac_f32 v254, v190, v190
    v_fmac_f32 v254, v191, v191
    v_mfma_f32_16x16x16_f16 v[230:233], v[124:125], v[218:219], v[230:233]
    v_fmac_f32 v254, v192, v192
    v_exp_f32 v134, v134
    v_fmac_f32 v254, v193, v193
    v_mfma_f32_16x16x32_bf16 v[158:161], v[210:213], v[174:177], 0
    v_exp_f32 v135, v135
    v_mfma_f32_16x16x32_bf16 v[158:161], v[238:241], v[130:133], v[158:161]
    v_cvt_pk_bf16_f32 v134, v134, v135
    v_fmac_f32 v254, v202, v202
    v_mfma_f32_16x16x32_bf16 v[234:237], v[210:213], v[182:185], 0
    v_exp_f32 v136, v136
    v_mfma_f32_16x16x32_bf16 v[234:237], v[238:241], v[222:225], v[234:237]
    v_exp_f32 v137, v137
    v_mfma_f32_16x16x32_bf16 v[246:249], v[210:213], v[114:117], 0
    v_cvt_pk_bf16_f32 v135, v136, v137
    v_mul_f32 v158, v158, v186
    v_mfma_f32_16x16x32_bf16 v[246:249], v[238:241], v[166:169], v[246:249]
    v_exp_f32 v162, v162
    v_mfma_f32_16x16x32_bf16 v[210:213], v[28:31], v[36:39], 0
    v_exp_f32 v163, v163
    v_mfma_f32_16x16x32_bf16 v[210:213], v[28:31], v[126:129], v[210:213]
    v_cvt_pk_bf16_f32 v136, v162, v163
    v_mul_f32_dpp v158, v234, v186 quad_perm:[0,1,2,3] row_mask:0x2 bank_mask:0xf
    v_mfma_f32_16x16x32_bf16 v[234:237], v[130:133], v[36:39], 0
    v_exp_f32 v164, v164
    v_mfma_f32_16x16x32_bf16 v[234:237], v[174:177], v[126:129], v[234:237]
    v_exp_f32 v165, v165
    v_mfma_f32_16x16x32_bf16 v[238:241], v[222:225], v[36:39], 0
    v_cvt_pk_bf16_f32 v137, v164, v165
    v_mul_f32_dpp v158, v246, v186 quad_perm:[0,1,2,3] row_mask:0x4 bank_mask:0xf
    v_mfma_f32_16x16x32_bf16 v[238:241], v[182:185], v[126:129], v[238:241]
    v_exp_f32 v230, v230
    v_mfma_f32_16x16x32_bf16 v[186:189], v[166:169], v[36:39], 0
    v_exp_f32 v231, v231
    v_mfma_f32_16x16x32_bf16 v[186:189], v[114:117], v[126:129], v[186:189]
    v_cvt_pk_bf16_f32 v36, v230, v231
    v_cvt_pk_bf16_f32 v39, v214, 0
    v_mfma_f32_16x16x32_f16 v[162:165], v[118:121], v[178:181], v[70:73]
    v_exp_f32 v232, v232
    v_mfma_f32_16x16x32_f16 v[118:121], v[170:173], v[178:181], v[74:77]
    v_exp_f32 v233, v233
    v_mfma_f32_16x16x32_f16 v[170:173], v[142:145], v[178:181], v[78:81]
    v_cvt_pk_bf16_f32 v37, v232, v233
    v_cvt_pk_bf16_f32 v158, v158, v158
    v_fmac_f32 v254, v203, v203
    v_mfma_f32_16x16x16_f16 v[162:165], v[196:197], v[122:123], v[162:165]
    v_rcp_f32 v210, v210
    v_fmac_f32 v254, v204, v204
    v_mfma_f32_16x16x16_f16 v[118:121], v[220:221], v[122:123], v[118:121]
    v_mul_f32 v234, v210, v234
    v_mul_f32 v235, v210, v235
    v_cvt_pk_bf16_f32 v178, v234, v235
    v_mfma_f32_16x16x16_f16 v[170:173], v[124:125], v[122:123], v[170:173]
    v_mul_f32 v236, v210, v236
    v_exp_f32 v162, v162
    v_mul_f32 v237, v210, v237
    v_mfma_f32_16x16x32_bf16 v[194:197], v[28:31], v[36:39], 0
    ds_write_b16 v7, v158
    v_mfma_f32_16x16x32_bf16 v[194:197], v[28:31], v[134:137], v[194:197]
    v_exp_f32 v163, v163
    v_mfma_f32_16x16x32_bf16 v[122:125], v[130:133], v[36:39], 0
    v_cvt_pk_bf16_f32 v162, v162, v163
    v_cvt_pk_bf16_f32 v179, v236, v237
    v_mfma_f32_16x16x32_bf16 v[122:125], v[174:177], v[134:137], v[122:125]
    v_exp_f32 v164, v164
    v_mfma_f32_16x16x32_bf16 v[126:129], v[222:225], v[36:39], 0
    v_exp_f32 v165, v165
    v_mfma_f32_16x16x32_bf16 v[126:129], v[182:185], v[134:137], v[126:129]
    v_cvt_pk_bf16_f32 v163, v164, v165
    v_mul_f32 v238, v210, v238
    v_mfma_f32_16x16x32_bf16 v[218:221], v[166:169], v[36:39], 0
    v_exp_f32 v118, v118
    v_mfma_f32_16x16x32_bf16 v[218:221], v[114:117], v[134:137], v[218:221]
    v_exp_f32 v119, v119
    v_mfma_f32_16x16x32_bf16 v[142:145], a[216:219], v[198:201], 0
    v_cvt_pk_bf16_f32 v164, v118, v119
    v_cvt_pk_bf16_f32 v39, v154, 0
    v_mfma_f32_16x16x32_bf16 v[142:145], a[220:223], v[226:229], v[142:145]
    v_exp_f32 v120, v120
    v_mfma_f32_16x16x32_bf16 v[142:145], a[224:227], v[206:209], v[142:145]
    v_exp_f32 v121, v121
    v_mfma_f32_16x16x32_bf16 v[142:145], a[228:231], v[242:245], v[142:145]
    v_cvt_pk_bf16_f32 v165, v120, v121
    v_mul_f32 v239, v210, v239
    v_mfma_f32_16x16x32_bf16 v[142:145], a[232:235], v[146:149], v[142:145]
    v_exp_f32 v170, v170
    v_mfma_f32_16x16x32_bf16 v[142:145], a[236:239], v[138:141], v[142:145]
    v_exp_f32 v171, v171
    v_mfma_f32_16x16x32_bf16 v[158:161], a[240:243], v[198:201], 0
    v_cvt_pk_bf16_f32 v36, v170, v171
    v_cvt_pk_bf16_f32 v180, v238, v239
    v_mfma_f32_16x16x32_bf16 v[158:161], a[244:247], v[226:229], v[158:161]
    v_exp_f32 v172, v172
    v_mfma_f32_16x16x32_bf16 v[158:161], a[248:251], v[206:209], v[158:161]
    v_exp_f32 v173, v173
    v_mfma_f32_16x16x32_bf16 v[158:161], a[252:255], v[242:245], v[158:161]
    ds_read_b128 v[118:121], v2 offset:12288
    v_cvt_pk_bf16_f32 v37, v172, v173
    v_mfma_f32_16x16x32_bf16 v[158:161], v[82:85], v[146:149], v[158:161]
    ds_read_b128 v[134:137], v2 offset:13312
    v_mul_f32 v240, v210, v240
    v_mfma_f32_16x16x32_bf16 v[170:173], v[28:31], v[36:39], 0
    v_mul_f32 v241, v210, v241
    v_cvt_pk_bf16_f32 v181, v240, v241
    v_mfma_f32_16x16x32_bf16 v[170:173], v[28:31], v[162:165], v[170:173]
    ds_write_b128 v3, v[178:181] offset:0
    v_mfma_f32_16x16x32_bf16 v[154:157], v[130:133], v[36:39], 0
    v_mul_f32 v186, v210, v186
    v_mul_f32 v187, v210, v187
    v_mfma_f32_16x16x32_bf16 v[154:157], v[174:177], v[162:165], v[154:157]
    v_cvt_pk_bf16_f32 v186, v186, v187
    v_mul_f32 v188, v210, v188
    v_mfma_f32_16x16x32_bf16 v[130:133], v[222:225], v[36:39], 0
    v_mul_f32 v189, v210, v189
    v_cvt_pk_bf16_f32 v187, v188, v189
    v_mfma_f32_16x16x32_bf16 v[130:133], v[182:185], v[162:165], v[130:133]
    s_waitcnt lgkmcnt(2)
    ds_write_b64 v4, v[186:187] offset:4096
    v_mfma_f32_16x16x32_bf16 v[174:177], v[166:169], v[36:39], 0
    s_waitcnt lgkmcnt(2)
    v_fma_f32 v255, v142, v142, s33
    v_fmac_f32 v255, v143, v143
    v_mfma_f32_16x16x32_bf16 v[174:177], v[114:117], v[162:165], v[174:177]
    v_fmac_f32 v255, v144, v144
    v_fmac_f32 v255, v145, v145
    v_mfma_f32_16x16x32_bf16 v[158:161], v[86:89], v[138:141], v[158:161]
    ds_read_b128 v[114:117], v2 offset:14336
    v_fmac_f32 v254, v205, v205
    v_mfma_f32_16x16x32_bf16 v[178:181], v[90:93], v[198:201], 0
    ds_read_b128 v[166:169], v2 offset:15360
    v_add_u32 v7, 16, v7
    v_mfma_f32_16x16x32_bf16 v[178:181], v[94:97], v[226:229], v[178:181]
    ds_read_b128 v[162:165], v2 offset:16384
    v_mfma_f32_16x16x32_bf16 v[178:181], v[98:101], v[206:209], v[178:181]
    ds_read_b128 v[206:209], v2 offset:17408
    v_fmac_f32 v255, v158, v158
    v_mfma_f32_16x16x32_bf16 v[178:181], v[102:105], v[242:245], v[178:181]
    v_fmac_f32 v255, v159, v159
    v_fmac_f32 v255, v160, v160
    v_mfma_f32_16x16x32_bf16 v[178:181], v[106:109], v[146:149], v[178:181]
    v_fmac_f32 v255, v161, v161
    v_xor_b32 v2, 65536, v2
    v_mfma_f32_16x16x32_bf16 v[178:181], v[110:113], v[138:141], v[178:181]
    v_rcp_f32 v170, v170
    v_mfma_f32_16x16x32_bf16 v[146:149], a[216:219], v[118:121], 0
    v_mul_f32 v154, v170, v154
    v_mul_f32 v155, v170, v155
    v_mfma_f32_16x16x32_bf16 v[146:149], a[220:223], v[134:137], v[146:149]
    s_waitcnt lgkmcnt(3)
    ds_read_b128 v[182:185], v0 offset:20480
    v_cvt_pk_bf16_f32 v154, v154, v155
    v_mfma_f32_16x16x32_bf16 v[146:149], a[224:227], v[114:117], v[146:149]
    s_waitcnt lgkmcnt(3)
    ds_read_b128 v[198:201], v1 offset:20480
    v_fmac_f32 v255, v178, v178
    v_mfma_f32_16x16x32_bf16 v[146:149], a[228:231], v[166:169], v[146:149]
    s_waitcnt lgkmcnt(3)
    ds_read_b128 v[210:213], v0 offset:20608
    v_fmac_f32 v255, v179, v179
    v_mfma_f32_16x16x32_bf16 v[146:149], a[232:235], v[162:165], v[146:149]
    s_waitcnt lgkmcnt(3)
    ds_read_b128 v[222:225], v1 offset:20608
    v_fmac_f32 v255, v180, v180
    v_mfma_f32_16x16x32_bf16 v[146:149], a[236:239], v[206:209], v[146:149]
    ds_read_b128 v[226:229], v0 offset:20736
    v_fmac_f32 v255, v181, v181
    v_mfma_f32_16x16x32_bf16 v[138:141], a[240:243], v[118:121], 0
    ds_read_b128 v[242:245], v1 offset:20736
    v_cvt_pk_bf16_f32 v254, v254, v255
    v_mfma_f32_16x16x32_bf16 v[138:141], a[244:247], v[134:137], v[138:141]
    v_mul_f32 v156, v170, v156
    v_mul_f32 v157, v170, v157
    v_mfma_f32_16x16x32_bf16 v[138:141], a[248:251], v[114:117], v[138:141]
    v_fma_f32 v255, v146, v146, s33
    v_fmac_f32 v255, v147, v147
    v_mfma_f32_16x16x32_bf16 v[138:141], a[252:255], v[166:169], v[138:141]
    s_waitcnt lgkmcnt(5)
    v_fmac_f32 v255, v148, v148
    v_fmac_f32 v255, v149, v149
    v_mfma_f32_16x16x32_bf16 v[138:141], v[82:85], v[162:165], v[138:141]
    s_waitcnt lgkmcnt(4)
    v_cvt_pk_bf16_f32 v155, v156, v157
    v_mul_f32 v130, v170, v130
    v_mfma_f32_16x16x32_bf16 v[138:141], v[86:89], v[206:209], v[138:141]
    s_waitcnt lgkmcnt(3)
    v_mul_f32 v131, v170, v131
    v_cvt_pk_bf16_f32 v156, v130, v131
    v_mfma_f32_16x16x32_bf16 v[186:189], v[90:93], v[118:121], 0
    s_waitcnt lgkmcnt(2)
    v_mul_f32 v132, v170, v132
    v_mul_f32 v133, v170, v133
    v_mfma_f32_16x16x32_bf16 v[186:189], v[94:97], v[134:137], v[186:189]
    s_waitcnt lgkmcnt(1)
    v_fmac_f32 v255, v138, v138
    v_fmac_f32 v255, v139, v139
    v_mfma_f32_16x16x32_bf16 v[186:189], v[98:101], v[114:117], v[186:189]
    s_waitcnt lgkmcnt(0)
    v_fmac_f32 v255, v140, v140
    v_fmac_f32 v255, v141, v141
    v_mfma_f32_16x16x32_bf16 v[186:189], v[102:105], v[166:169], v[186:189]
    v_cvt_pk_bf16_f32 v157, v132, v133
    v_mul_f32 v174, v170, v174
    v_mfma_f32_16x16x32_bf16 v[186:189], v[106:109], v[162:165], v[186:189]
    ds_write_b128 v3, v[154:157] offset:12288
    v_mfma_f32_16x16x32_bf16 v[186:189], v[110:113], v[206:209], v[186:189]
    v_mul_f32 v175, v170, v175
    v_cvt_pk_bf16_f32 v174, v174, v175
    v_mfma_f32_16x16x32_bf16 v[118:121], a[72:75], v[182:185], 0
    v_mul_f32 v176, v170, v176
    v_mul_f32 v177, v170, v177
    v_mfma_f32_16x16x32_bf16 v[118:121], a[76:79], v[198:201], v[118:121]
    v_rcp_f32 v194, v194
    v_mfma_f32_16x16x32_bf16 v[118:121], a[80:83], v[210:213], v[118:121]
    v_fmac_f32 v255, v186, v186
    v_fmac_f32 v255, v187, v187
    v_mfma_f32_16x16x32_bf16 v[118:121], a[84:87], v[222:225], v[118:121]
    v_fmac_f32 v255, v188, v188
    v_fmac_f32 v255, v189, v189
    v_mfma_f32_16x16x32_bf16 v[118:121], a[88:91], v[226:229], v[118:121]
    v_cvt_pk_bf16_f32 v255, v255, v255
    v_cvt_pk_bf16_f32 v175, v176, v177
    v_mfma_f32_16x16x32_bf16 v[118:121], a[92:95], v[242:245], v[118:121]
    ds_write_b64 v4, v[174:175] offset:16384
    v_mfma_f32_16x16x32_bf16 v[206:209], a[96:99], v[182:185], 0
    v_mul_f32 v122, v194, v122
    v_mul_f32 v123, v194, v123
    v_mfma_f32_16x16x32_bf16 v[206:209], a[100:103], v[198:201], v[206:209]
    ds_write_b64 v4, v[254:255] offset:18432
    v_mfma_f32_16x16x32_bf16 v[206:209], a[104:107], v[210:213], v[206:209]
    v_cvt_pk_bf16_f32 v134, v122, v123
    v_cvt_pk_f16_f32 v118, v118, v119
    v_mfma_f32_16x16x32_bf16 v[206:209], a[108:111], v[222:225], v[206:209]
    v_pk_mul_f16 v163, v118, v118
    v_cvt_pk_f16_f32 v119, v120, v121
    v_mfma_f32_16x16x32_bf16 v[206:209], a[112:115], v[226:229], v[206:209]
    v_pk_mul_f16 v165, v119, v119
    v_mul_f32 v124, v194, v124
    v_mfma_f32_16x16x32_bf16 v[206:209], a[116:119], v[242:245], v[206:209]
    v_mul_f32 v125, v194, v125
    v_cvt_pk_bf16_f32 v135, v124, v125
    v_mfma_f32_16x16x32_bf16 v[122:125], a[120:123], v[182:185], 0
    v_mul_f32 v126, v194, v126
    v_mul_f32 v127, v194, v127
    v_mfma_f32_16x16x32_bf16 v[122:125], a[124:127], v[198:201], v[122:125]
    v_cvt_pk_bf16_f32 v136, v126, v127
    v_mul_f32 v128, v194, v128
    v_mfma_f32_16x16x32_bf16 v[122:125], a[128:131], v[210:213], v[122:125]
    v_cvt_pk_f16_f32 v120, v206, v207
    v_pk_fma_f16 v163, v120, v120, v163
    v_mfma_f32_16x16x32_bf16 v[122:125], a[132:135], v[222:225], v[122:125]
    v_cvt_pk_f16_f32 v121, v208, v209
    v_pk_fma_f16 v165, v121, v121, v165
    v_mfma_f32_16x16x32_bf16 v[122:125], a[136:139], v[226:229], v[122:125]
    v_mul_f32 v129, v194, v129
    v_cvt_pk_bf16_f32 v137, v128, v129
    v_mfma_f32_16x16x32_bf16 v[122:125], a[140:143], v[242:245], v[122:125]
    ds_write_b128 v3, v[134:137] offset:6144
    v_mfma_f32_16x16x32_bf16 v[206:209], a[0:3], v[182:185], 0
    v_mul_f32 v218, v194, v218
    v_mul_f32 v219, v194, v219
    v_mfma_f32_16x16x32_bf16 v[206:209], a[4:7], v[198:201], v[206:209]
    v_cvt_pk_bf16_f32 v254, v218, v219
    v_mul_f32 v220, v194, v220
    v_mfma_f32_16x16x32_bf16 v[206:209], a[8:11], v[210:213], v[206:209]
    v_cvt_pk_f16_f32 v196, v122, v123
    v_pk_fma_f16 v163, v196, v196, v163
    v_mfma_f32_16x16x32_bf16 v[206:209], a[12:15], v[222:225], v[206:209]
    v_cvt_pk_f16_f32 v197, v124, v125
    v_pk_fma_f16 v165, v197, v197, v165
    v_mfma_f32_16x16x32_bf16 v[206:209], a[16:19], v[226:229], v[206:209]
    v_mul_f32 v221, v194, v221
    v_cvt_pk_bf16_f32 v255, v220, v221
    v_mfma_f32_16x16x32_bf16 v[206:209], a[20:23], v[242:245], v[206:209]
    ds_write_b64 v4, v[254:255] offset:10240
    v_mfma_f32_16x16x32_bf16 v[174:177], a[24:27], v[182:185], 0
    v_xor_b32 v3, 65536, v3
    v_xor_b32 v4, 65536, v4
    v_mfma_f32_16x16x32_bf16 v[174:177], a[28:31], v[198:201], v[174:177]
    v_mfma_f32_16x16x32_bf16 v[174:177], a[32:35], v[210:213], v[174:177]
    v_mfma_f32_16x16x32_bf16 v[174:177], a[36:39], v[222:225], v[174:177]
    v_mfma_f32_16x16x32_bf16 v[174:177], a[40:43], v[226:229], v[174:177]
    v_cvt_pk_f16_f32 v206, v206, v207
    v_mfma_f32_16x16x32_bf16 v[174:177], a[44:47], v[242:245], v[174:177]
    v_mfma_f32_16x16x32_bf16 v[218:221], a[48:51], v[182:185], 0
    s_waitcnt lgkmcnt(0)
    v_mfma_f32_16x16x32_bf16 v[218:221], a[52:55], v[198:201], v[218:221]
    s_barrier
    v_mfma_f32_16x16x32_bf16 v[218:221], a[56:59], v[210:213], v[218:221]
    s_nop 0
    v_mfma_f32_16x16x32_bf16 v[218:221], a[60:63], v[222:225], v[218:221]
    s_nop 0
    v_mfma_f32_16x16x32_bf16 v[218:221], a[64:67], v[226:229], v[218:221]
    s_nop 0
    v_mfma_f32_16x16x32_bf16 v[218:221], a[68:71], v[242:245], v[218:221]
    v_mfma_f32_16x16x32_bf16 v[170:173], v[182:185], a[144:147], 0
    v_mfma_f32_16x16x32_bf16 v[170:173], v[198:201], a[148:151], v[170:173]
    v_mfma_f32_16x16x32_bf16 v[170:173], v[210:213], a[152:155], v[170:173]
    v_mfma_f32_16x16x32_bf16 v[170:173], v[222:225], a[156:159], v[170:173]
    v_mfma_f32_16x16x32_bf16 v[170:173], v[226:229], a[160:163], v[170:173]
    v_mfma_f32_16x16x32_bf16 v[170:173], v[242:245], a[164:167], v[170:173]
    s_cbranch_scc1 L_loop_fast0
    s_branch L_drain
.p2align 6
L_loop_fast1:
    v_mfma_f32_16x16x32_bf16 v[234:237], v[182:185], a[168:171], 0
    s_add_u32 s12, s42, s27
    ds_read_b128 v[230:233], v2 offset:18432
    ds_read_b128 v[238:241], v2 offset:19456
    v_mfma_f32_16x16x32_bf16 v[234:237], v[198:201], a[172:175], v[234:237]
    s_addc_u32 s13, s43, 0
    v_pk_mul_f16 v162, v206, v206
    v_cvt_pk_f16_f32 v207, v208, v209
    v_mfma_f32_16x16x32_bf16 v[234:237], v[210:213], a[176:179], v[234:237]
    s_sub_u32 s14, s36, s27
    ds_read_b128 v[134:137], v0 offset:26624
    v_pk_mul_f16 v164, v207, v207
    v_mfma_f32_16x16x32_bf16 v[234:237], v[222:225], a[180:183], v[234:237]
    s_cmp_ge_u32 s18, 2
    ds_read_b128 v[154:157], v1 offset:26624
    v_cvt_pk_f16_f32 v208, v174, v175
    v_mfma_f32_16x16x32_bf16 v[234:237], v[226:229], a[184:187], v[234:237]
    s_cselect_b32 s14, s14, 0
    ds_read_b128 v[130:133], v0 offset:26752
    v_pk_fma_f16 v162, v208, v208, v162
    v_mfma_f32_16x16x32_bf16 v[234:237], v[242:245], a[188:191], v[234:237]
    s_add_u32 s34, s18, 2
    ds_read_b128 v[122:125], v1 offset:26752
    v_cvt_pk_f16_f32 v209, v176, v177
    v_mfma_f32_16x16x32_bf16 v[114:117], v[182:185], a[192:195], 0
    s_add_u32 s8, s40, s23
    ds_read_b128 v[126:129], v0 offset:26880
    v_pk_fma_f16 v164, v209, v209, v164
    v_mfma_f32_16x16x32_bf16 v[114:117], v[198:201], a[196:199], v[114:117]
    s_addc_u32 s9, s41, 0
    ds_read_b128 v[166:169], v1 offset:26880
    v_cvt_pk_f16_f32 v194, v218, v219
    v_mfma_f32_16x16x32_bf16 v[114:117], v[210:213], a[200:203], v[114:117]
    s_waitcnt lgkmcnt(6)
    v_pk_fma_f16 v162, v194, v194, v162
    v_cvt_pk_f16_f32 v195, v220, v221
    v_mfma_f32_16x16x32_bf16 v[198:201], v[32:35], v[230:233], 0
    s_sub_u32 s10, s36, s23
    v_pk_fma_f16 v164, v195, v195, v164
    v_cvt_pk_bf16_f32 v174, v170, v171
    v_mfma_f32_16x16x32_bf16 v[198:201], v[32:35], v[238:241], v[198:201]
    s_waitcnt lgkmcnt(5)
    v_cvt_pk_bf16_f32 v175, v172, v173
    v_cvt_pk_bf16_f32 v182, v234, v235
    v_mfma_f32_16x16x32_f16 v[170:173], v[40:43], v[162:165], 0
    s_cmp_lt_u32 s34, s17
    v_cvt_pk_bf16_f32 v183, v236, v237
    s_cselect_b32 s10, s10, 0
    v_mfma_f32_16x16x32_bf16 v[114:117], v[222:225], a[204:207], v[114:117]
    s_add_u32 m0, s28, 0
    v_mul_f32 v255, 0x3baaaaab, v198
    v_mul_f32 v254, 0x3baaaaab, v199
    v_mfma_f32_16x16x32_bf16 v[114:117], v[226:229], a[208:211], v[114:117]
    s_mov_b32 s27, s26
    v_rsq_f32 v172, v170
    v_mfma_f32_16x16x32_bf16 v[114:117], v[242:245], a[212:215], v[114:117]
    s_mov_b32 s26, s25
    v_rsq_f32 v173, v171
    v_mfma_f32_16x16x32_bf16 v[162:165], a[72:75], v[134:137], 0
    s_waitcnt lgkmcnt(0)
    v_mul_f32 v172, s31, v172
    v_cvt_pk_f16_f32 v172, v172, v173
    v_mfma_f32_16x16x32_bf16 v[162:165], a[76:79], v[154:157], v[162:165]
    s_mov_b32 s25, s24
    v_cvt_pk_bf16_f32 v114, v114, v115
    v_cvt_pk_bf16_f32 v115, v116, v117
    v_mfma_f32_16x16x32_bf16 v[162:165], a[80:83], v[130:133], v[162:165]
    s_mov_b32 s24, s23
    v_pk_mul_f16 v118, v118, v172 op_sel:[0,1] op_sel_hi:[1,1]
    v_pk_mul_f16 v119, v119, v172 op_sel:[0,1] op_sel_hi:[1,1]
    v_mfma_f32_16x16x32_bf16 v[162:165], a[84:87], v[122:125], v[162:165]
    v_pk_mul_f16 v120, v120, v172 op_sel:[0,1] op_sel_hi:[1,1]
    v_pk_mul_f16 v121, v121, v172 op_sel:[0,1] op_sel_hi:[1,1]
    v_mfma_f32_16x16x32_bf16 v[162:165], a[88:91], v[126:129], v[162:165]
    v_pk_mul_f16 v196, v196, v172 op_sel:[0,1] op_sel_hi:[1,1]
    v_pk_mul_f16 v197, v197, v172 op_sel:[0,1] op_sel_hi:[1,1]
    v_mfma_f32_16x16x32_bf16 v[162:165], a[92:95], v[166:169], v[162:165]
    v_pk_mul_f16 v206, v206, v172 op_sel:[0,0] op_sel_hi:[1,0]
    v_pk_mul_f16 v207, v207, v172 op_sel:[0,0] op_sel_hi:[1,0]
    v_mfma_f32_16x16x32_bf16 v[210:213], a[96:99], v[134:137], 0
    v_pk_mul_f16 v208, v208, v172 op_sel:[0,0] op_sel_hi:[1,0]
    v_pk_mul_f16 v209, v209, v172 op_sel:[0,0] op_sel_hi:[1,0]
    v_mfma_f32_16x16x32_bf16 v[210:213], a[100:103], v[154:157], v[210:213]
    v_pk_mul_f16 v194, v194, v172 op_sel:[0,0] op_sel_hi:[1,0]
    v_pk_mul_f16 v195, v195, v172 op_sel:[0,0] op_sel_hi:[1,0]
    v_mfma_f32_16x16x32_bf16 v[210:213], a[104:107], v[130:133], v[210:213]
    v_min3_u32 v44, v44, v170, v171
    v_max3_u32 v45, v45, v170, v171
    v_mfma_f32_16x16x32_bf16 v[210:213], a[108:111], v[122:125], v[210:213]
    v_cvt_pk_f16_f32 v170, v162, v163
    v_pk_mul_f16 v163, v170, v170
    v_mfma_f32_16x16x32_bf16 v[210:213], a[112:115], v[126:129], v[210:213]
    v_cvt_pk_f16_f32 v171, v164, v165
    v_pk_mul_f16 v165, v171, v171
    v_mfma_f32_16x16x32_bf16 v[210:213], a[116:119], v[166:169], v[210:213]
    v_rsq_f32 v255, v255
    v_mfma_f32_16x16x32_bf16 v[214:217], a[120:123], v[134:137], 0
    v_rsq_f32 v254, v254
    v_mfma_f32_16x16x32_bf16 v[214:217], a[124:127], v[154:157], v[214:217]
    v_mul_f32 v142, v254, v142
    v_mul_f32 v143, v254, v143
    v_mfma_f32_16x16x32_bf16 v[214:217], a[128:131], v[130:133], v[214:217]
    v_cvt_pk_bf16_f32 v142, v142, v143
    v_cvt_pk_f16_f32 v172, v210, v211
    v_mfma_f32_16x16x32_bf16 v[214:217], a[132:135], v[122:125], v[214:217]
    v_pk_fma_f16 v163, v172, v172, v163
    v_cvt_pk_f16_f32 v173, v212, v213
    v_mfma_f32_16x16x32_bf16 v[214:217], a[136:139], v[126:129], v[214:217]
    v_pk_fma_f16 v165, v173, v173, v165
    v_mul_f32 v144, v254, v144
    v_mfma_f32_16x16x32_bf16 v[214:217], a[140:143], v[166:169], v[214:217]
    v_mul_f32 v145, v254, v145
    v_cvt_pk_bf16_f32 v143, v144, v145
    v_mfma_f32_16x16x32_bf16 v[210:213], a[0:3], v[134:137], 0
    v_mul_f32 v158, v254, v158
    v_mul_f32 v159, v254, v159
    v_mfma_f32_16x16x32_bf16 v[210:213], a[4:7], v[154:157], v[210:213]
    v_cvt_pk_bf16_f32 v144, v158, v159
    v_mul_f32 v160, v254, v160
    v_mfma_f32_16x16x32_bf16 v[210:213], a[8:11], v[130:133], v[210:213]
    v_cvt_pk_f16_f32 v220, v214, v215
    v_pk_fma_f16 v163, v220, v220, v163
    v_mfma_f32_16x16x32_bf16 v[210:213], a[12:15], v[122:125], v[210:213]
    v_cvt_pk_f16_f32 v221, v216, v217
    v_pk_fma_f16 v165, v221, v221, v165
    v_mfma_f32_16x16x32_bf16 v[210:213], a[16:19], v[126:129], v[210:213]
    v_mul_f32 v161, v254, v161
    v_cvt_pk_bf16_f32 v145, v160, v161
    v_mfma_f32_16x16x32_bf16 v[210:213], a[20:23], v[166:169], v[210:213]
    buffer_store_dwordx4 v[142:145], v16, s[12:15], 0 offen
    v_mul_f32 v178, v254, v178
    v_mul_f32 v179, v254, v179
    v_cvt_pk_bf16_f32 v198, v178, v179
    v_mul_f32 v180, v254, v180
    v_mfma_f32_16x16x32_bf16 v[142:145], a[24:27], v[134:137], 0
    v_mul_f32 v181, v254, v181
    v_cvt_pk_bf16_f32 v199, v180, v181
    v_mfma_f32_16x16x32_bf16 v[142:145], a[28:31], v[154:157], v[142:145]
    v_cvt_pk_f16_f32 v158, v210, v211
    v_pk_mul_f16 v162, v158, v158
    v_mfma_f32_16x16x32_bf16 v[142:145], a[32:35], v[130:133], v[142:145]
    v_cvt_pk_f16_f32 v159, v212, v213
    v_pk_mul_f16 v164, v159, v159
    v_mfma_f32_16x16x32_bf16 v[142:145], a[36:39], v[122:125], v[142:145]
    v_mul_f32 v254, 0x3baaaaab, v200
    v_mul_f32 v150, v255, v150
    v_mfma_f32_16x16x32_bf16 v[142:145], a[40:43], v[126:129], v[142:145]
    v_rsq_f32 v254, v254
    v_mfma_f32_16x16x32_bf16 v[142:145], a[44:47], v[166:169], v[142:145]
    v_mul_f32 v146, v254, v146
    v_mul_f32 v147, v254, v147
    v_mfma_f32_16x16x32_bf16 v[178:181], a[48:51], v[134:137], 0
    v_cvt_pk_bf16_f32 v146, v146, v147
    v_mul_f32 v148, v254, v148
    v_mfma_f32_16x16x32_bf16 v[178:181], a[52:55], v[154:157], v[178:181]
    v_mul_f32 v149, v254, v149
    v_cvt_pk_bf16_f32 v147, v148, v149
    v_mfma_f32_16x16x32_bf16 v[178:181], a[56:59], v[130:133], v[178:181]
    v_mul_f32 v138, v254, v138
    v_mul_f32 v139, v254, v139
    v_mfma_f32_16x16x32_bf16 v[178:181], a[60:63], v[122:125], v[178:181]
    v_cvt_pk_bf16_f32 v148, v138, v139
    v_mul_f32 v140, v254, v140
    v_mfma_f32_16x16x32_bf16 v[178:181], a[64:67], v[126:129], v[178:181]
    v_mul_f32 v141, v254, v141
    v_cvt_pk_bf16_f32 v149, v140, v141
    v_mfma_f32_16x16x32_bf16 v[178:181], a[68:71], v[166:169], v[178:181]
    v_mul_f32 v186, v254, v186
    v_mul_f32 v187, v254, v187
    v_mfma_f32_16x16x32_bf16 v[138:141], v[134:137], a[144:147], 0
    v_cvt_pk_bf16_f32 v200, v186, v187
    v_mul_f32 v188, v254, v188
    v_mfma_f32_16x16x32_bf16 v[138:141], v[154:157], a[148:151], v[138:141]
    v_mul_f32 v189, v254, v189
    v_cvt_pk_bf16_f32 v201, v188, v189
    v_mfma_f32_16x16x32_bf16 v[138:141], v[130:133], a[152:155], v[138:141]
    v_cvt_pk_f16_f32 v160, v142, v143
    v_pk_fma_f16 v162, v160, v160, v162
    v_mfma_f32_16x16x32_bf16 v[138:141], v[122:125], a[156:159], v[138:141]
    v_cvt_pk_f16_f32 v161, v144, v145
    v_pk_fma_f16 v164, v161, v161, v164
    v_mfma_f32_16x16x32_bf16 v[138:141], v[126:129], a[160:163], v[138:141]
    buffer_store_dwordx4 v[146:149], v17, s[12:15], 0 offen
    v_cvt_pk_f16_f32 v218, v178, v179
    v_pk_fma_f16 v162, v218, v218, v162
    v_cvt_pk_f16_f32 v219, v180, v181
    v_pk_fma_f16 v164, v219, v219, v164
    v_mfma_f32_16x16x32_bf16 v[138:141], v[166:169], a[164:167], v[138:141]
    v_mul_f32 v151, v255, v151
    v_cvt_pk_bf16_f32 v150, v150, v151
    v_mfma_f32_16x16x32_f16 v[142:145], v[40:43], v[162:165], 0
    v_mul_f32 v152, v255, v152
    v_mul_f32 v153, v255, v153
    v_mfma_f32_16x16x32_bf16 v[178:181], v[134:137], a[168:171], 0
    v_cvt_pk_bf16_f32 v151, v152, v153
    v_mul_f32 v190, v255, v190
    v_mfma_f32_16x16x32_bf16 v[178:181], v[154:157], a[172:175], v[178:181]
    v_cvt_pk_bf16_f32 v176, v138, v139
    v_cvt_pk_bf16_f32 v177, v140, v141
    v_mfma_f32_16x16x32_bf16 v[178:181], v[130:133], a[176:179], v[178:181]
    ds_read_b128 v[146:149], v0 offset:32768
    v_min3_u32 v44, v44, v142, v143
    v_mfma_f32_16x16x32_bf16 v[178:181], v[122:125], a[180:183], v[178:181]
    ds_read_b128 v[138:141], v1 offset:32768
    v_max3_u32 v45, v45, v142, v143
    v_mfma_f32_16x16x32_bf16 v[178:181], v[126:129], a[184:187], v[178:181]
    ds_read_b128 v[186:189], v0 offset:32896
    v_mul_f32 v191, v255, v191
    v_mfma_f32_16x16x32_bf16 v[178:181], v[166:169], a[188:191], v[178:181]
    ds_read_b128 v[162:165], v1 offset:32896
    v_cvt_pk_bf16_f32 v152, v190, v191
    v_mfma_f32_16x16x32_bf16 v[210:213], v[134:137], a[192:195], 0
    ds_read_b128 v[134:137], v0 offset:33024
    v_mul_f32 v192, v255, v192
    v_mfma_f32_16x16x32_bf16 v[210:213], v[154:157], a[196:199], v[210:213]
    ds_read_b128 v[154:157], v1 offset:33024
    v_mul_f32 v193, v255, v193
    v_mfma_f32_16x16x32_bf16 v[210:213], v[130:133], a[200:203], v[210:213]
    v_rsq_f32 v144, v142
    v_mfma_f32_16x16x32_bf16 v[210:213], v[122:125], a[204:207], v[210:213]
    v_rsq_f32 v145, v143
    v_mfma_f32_16x16x32_bf16 v[210:213], v[126:129], a[208:211], v[210:213]
    s_waitcnt lgkmcnt(5)
    v_mul_f32 v144, s31, v144
    v_cvt_pk_f16_f32 v144, v144, v145
    v_mfma_f32_16x16x32_bf16 v[210:213], v[166:169], a[212:215], v[210:213]
    s_waitcnt lgkmcnt(4)
    v_cvt_pk_bf16_f32 v184, v178, v179
    v_cvt_pk_bf16_f32 v185, v180, v181
    v_mfma_f32_16x16x32_bf16 v[178:181], a[72:75], v[146:149], 0
    s_waitcnt lgkmcnt(3)
    v_pk_mul_f16 v170, v170, v144 op_sel:[0,1] op_sel_hi:[1,1]
    v_pk_mul_f16 v171, v171, v144 op_sel:[0,1] op_sel_hi:[1,1]
    v_mfma_f32_16x16x32_bf16 v[178:181], a[76:79], v[138:141], v[178:181]
    s_waitcnt lgkmcnt(2)
    v_cvt_pk_bf16_f32 v116, v210, v211
    v_cvt_pk_bf16_f32 v117, v212, v213
    v_mfma_f32_16x16x32_bf16 v[178:181], a[80:83], v[186:189], v[178:181]
    s_waitcnt lgkmcnt(1)
    buffer_store_dwordx2 v[200:201], v20, s[12:15], 0 offen
    v_pk_mul_f16 v172, v172, v144 op_sel:[0,1] op_sel_hi:[1,1]
    v_pk_mul_f16 v173, v173, v144 op_sel:[0,1] op_sel_hi:[1,1]
    v_mfma_f32_16x16x32_bf16 v[178:181], a[84:87], v[162:165], v[178:181]
    s_waitcnt lgkmcnt(0)
    v_pk_mul_f16 v220, v220, v144 op_sel:[0,1] op_sel_hi:[1,1]
    v_pk_mul_f16 v221, v221, v144 op_sel:[0,1] op_sel_hi:[1,1]
    v_mfma_f32_16x16x32_bf16 v[178:181], a[88:91], v[134:137], v[178:181]
    v_pk_mul_f16 v158, v158, v144 op_sel:[0,0] op_sel_hi:[1,0]
    v_pk_mul_f16 v159, v159, v144 op_sel:[0,0] op_sel_hi:[1,0]
    v_mfma_f32_16x16x32_bf16 v[178:181], a[92:95], v[154:157], v[178:181]
    v_pk_mul_f16 v160, v160, v144 op_sel:[0,0] op_sel_hi:[1,0]
    v_pk_mul_f16 v161, v161, v144 op_sel:[0,0] op_sel_hi:[1,0]
    v_mfma_f32_16x16x32_bf16 v[130:133], a[96:99], v[146:149], 0
    v_pk_mul_f16 v218, v218, v144 op_sel:[0,0] op_sel_hi:[1,0]
    v_pk_mul_f16 v219, v219, v144 op_sel:[0,0] op_sel_hi:[1,0]
    v_mfma_f32_16x16x32_bf16 v[130:133], a[100:103], v[138:141], v[130:133]
    s_waitcnt vmcnt(3)
    v_cvt_pk_bf16_f32 v153, v192, v193
    v_cvt_pk_f16_f32 v142, v178, v179
    v_mfma_f32_16x16x32_bf16 v[130:133], a[104:107], v[186:189], v[130:133]
    s_nop 0
    v_pk_mul_f16 v191, v142, v142
    v_cvt_pk_f16_f32 v143, v180, v181
    v_mfma_f32_16x16x32_bf16 v[130:133], a[108:111], v[162:165], v[130:133]
    s_barrier
    v_pk_mul_f16 v193, v143, v143
    v_mul_f32 v202, v255, v202
    v_mfma_f32_16x16x32_bf16 v[130:133], a[112:115], v[134:137], v[130:133]
    s_nop 0
    v_mul_f32 v203, v255, v203
    v_cvt_pk_bf16_f32 v254, v202, v203
    v_mfma_f32_16x16x32_bf16 v[130:133], a[116:119], v[154:157], v[130:133]
    s_nop 0
    v_mul_f32 v204, v255, v204
    v_mul_f32 v205, v255, v205
    v_mfma_f32_16x16x32_bf16 v[178:181], a[120:123], v[146:149], 0
    v_cvt_pk_bf16_f32 v255, v204, v205
    v_xor_b32 v0, 65536, v0
    v_mfma_f32_16x16x32_bf16 v[178:181], a[124:127], v[138:141], v[178:181]
    v_xor_b32 v1, 65536, v1
    v_cvt_pk_f16_f32 v144, v130, v131
    v_mfma_f32_16x16x32_bf16 v[178:181], a[128:131], v[186:189], v[178:181]
    v_pk_fma_f16 v191, v144, v144, v191
    v_cvt_pk_f16_f32 v145, v132, v133
    v_mfma_f32_16x16x32_bf16 v[178:181], a[132:135], v[162:165], v[178:181]
    v_pk_fma_f16 v193, v145, v145, v193
    v_mfma_f32_16x16x32_bf16 v[178:181], a[136:139], v[134:137], v[178:181]
    v_mfma_f32_16x16x32_bf16 v[178:181], a[140:143], v[154:157], v[178:181]
    v_mfma_f32_16x16x32_bf16 v[202:205], a[0:3], v[146:149], 0
    v_mfma_f32_16x16x32_bf16 v[202:205], a[4:7], v[138:141], v[202:205]
    buffer_load_dwordx4 v10, s[8:11], 0 offen lds
    s_add_u32 m0, s28, 4096
    v_mfma_f32_16x16x32_bf16 v[202:205], a[8:11], v[186:189], v[202:205]
    v_mfma_f32_16x16x32_bf16 v[202:205], a[12:15], v[162:165], v[202:205]
    v_mfma_f32_16x16x32_bf16 v[202:205], a[16:19], v[134:137], v[202:205]
    v_mfma_f32_16x16x32_bf16 v[202:205], a[20:23], v[154:157], v[202:205]
    v_cvt_pk_f16_f32 v124, v178, v179
    v_pk_fma_f16 v191, v124, v124, v191
    v_mfma_f32_16x16x32_bf16 v[130:133], a[24:27], v[146:149], 0
    buffer_load_dwordx4 v11, s[8:11], 0 offen lds
    v_cvt_pk_f16_f32 v125, v180, v181
    v_mfma_f32_16x16x32_bf16 v[130:133], a[28:31], v[138:141], v[130:133]
    s_add_u32 m0, s28, 8192
    v_pk_fma_f16 v193, v125, v125, v193
    v_cvt_pk_f16_f32 v178, v202, v203
    v_mfma_f32_16x16x32_bf16 v[130:133], a[32:35], v[186:189], v[130:133]
    v_pk_mul_f16 v190, v178, v178
    v_cvt_pk_f16_f32 v179, v204, v205
    v_mfma_f32_16x16x32_bf16 v[130:133], a[36:39], v[162:165], v[130:133]
    v_pk_mul_f16 v192, v179, v179
    v_mfma_f32_16x16x32_bf16 v[130:133], a[40:43], v[134:137], v[130:133]
    v_mfma_f32_16x16x32_bf16 v[130:133], a[44:47], v[154:157], v[130:133]
    buffer_load_dwordx4 v12, s[8:11], 0 offen lds
    s_add_u32 m0, s28, 12288
    v_mfma_f32_16x16x32_bf16 v[202:205], a[48:51], v[146:149], 0
    s_xor_b32 s28, s28, 65536
    v_mfma_f32_16x16x32_bf16 v[202:205], a[52:55], v[138:141], v[202:205]
    ds_read_b128 v[166:169], v5 offset:0
    ds_read_b128 v[126:129], v5 offset:16
    v_mfma_f32_16x16x32_bf16 v[202:205], a[56:59], v[186:189], v[202:205]
    ds_read_b128 v[210:213], v5 offset:48
    ds_read_b32 v200, v6 offset:192
    v_mfma_f32_16x16x32_bf16 v[202:205], a[60:63], v[162:165], v[202:205]
    v_cvt_pk_f16_f32 v180, v130, v131
    v_pk_fma_f16 v190, v180, v180, v190
    v_mfma_f32_16x16x32_bf16 v[202:205], a[64:67], v[134:137], v[202:205]
    buffer_load_dwordx4 v13, s[8:11], 0 offen lds
    v_cvt_pk_f16_f32 v181, v132, v133
    v_mfma_f32_16x16x32_bf16 v[202:205], a[68:71], v[154:157], v[202:205]
    s_mov_b32 m0, s29
    v_pk_fma_f16 v192, v181, v181, v192
    v_add_u32 v5, 336, v5
    v_mfma_f32_16x16x32_bf16 v[130:133], v[146:149], a[144:147], 0
    s_xor_b32 s29, s29, s30
    s_add_u32 s19, s19, s20
    s_add_u32 s23, s23, s21
    v_mfma_f32_16x16x32_bf16 v[130:133], v[138:141], a[148:151], v[130:133]
    s_cmp_ge_u32 s19, 72
    v_cvt_pk_f16_f32 v122, v202, v203
    v_pk_fma_f16 v190, v122, v122, v190
    v_mfma_f32_16x16x32_bf16 v[130:133], v[186:189], a[152:155], v[130:133]
    s_cselect_b32 s34, 72, 0
    v_cvt_pk_f16_f32 v123, v204, v205
    v_pk_fma_f16 v192, v123, v123, v192
    v_mfma_f32_16x16x32_bf16 v[130:133], v[162:165], a[156:159], v[130:133]
    s_waitcnt lgkmcnt(2)
    buffer_store_dwordx2 v[198:199], v19, s[12:15], 0 offen
    s_cselect_b32 s35, s22, 0
    s_sub_u32 s19, s19, s34
    v_mfma_f32_16x16x32_f16 v[202:205], v[40:43], v[190:193], 0
    s_add_u32 s23, s23, s35
    s_add_u32 s18, s18, 1
    s_cmp_lt_u32 s18, s17
    v_mfma_f32_16x16x32_f16 v[214:217], v[166:169], v[158:161], v[24:27]
    s_waitcnt lgkmcnt(0)
    v_mfma_f32_16x16x32_f16 v[214:217], v[126:129], v[170:173], v[214:217]
    v_mfma_f32_16x16x32_f16 v[214:217], v[210:213], v[218:221], v[214:217]
    v_mfma_f32_16x16x32_f16 v[190:193], v[166:169], v[206:209], v[22:25]
    v_rsq_f32 v204, v202
    v_mfma_f32_16x16x32_f16 v[190:193], v[126:129], v[118:121], v[190:193]
    v_rsq_f32 v205, v203
    v_mfma_f32_16x16x32_f16 v[190:193], v[210:213], v[194:197], v[190:193]
    v_mul_f32 v204, s31, v204
    v_cvt_pk_f16_f32 v204, v204, v205
    v_mfma_f32_16x16x32_bf16 v[130:133], v[134:137], a[160:163], v[130:133]
    v_pk_mul_f16 v142, v142, v204 op_sel:[0,1] op_sel_hi:[1,1]
    v_pk_mul_f16 v143, v143, v204 op_sel:[0,1] op_sel_hi:[1,1]
    v_mfma_f32_16x16x32_bf16 v[130:133], v[154:157], a[164:167], v[130:133]
    v_pk_mul_f16 v144, v144, v204 op_sel:[0,1] op_sel_hi:[1,1]
    v_pk_mul_f16 v145, v145, v204 op_sel:[0,1] op_sel_hi:[1,1]
    v_mfma_f32_16x16x32_bf16 v[222:225], v[146:149], a[168:171], 0
    v_mov_b32_dpp v200, v191 quad_perm:[0,1,2,3] row_mask:0x1 bank_mask:0xf
    v_mov_b32_dpp v200, v215 quad_perm:[0,1,2,3] row_mask:0x2 bank_mask:0xf
    v_mfma_f32_16x16x32_bf16 v[222:225], v[138:141], a[172:175], v[222:225]
    v_pk_mul_f16 v124, v124, v204 op_sel:[0,1] op_sel_hi:[1,1]
    v_pk_mul_f16 v125, v125, v204 op_sel:[0,1] op_sel_hi:[1,1]
    v_mfma_f32_16x16x32_bf16 v[222:225], v[186:189], a[176:179], v[222:225]
    v_cvt_pk_bf16_f32 v130, v130, v131
    v_cvt_pk_bf16_f32 v131, v132, v133
    v_mfma_f32_16x16x32_bf16 v[222:225], v[162:165], a[180:183], v[222:225]
    v_pk_mul_f16 v178, v178, v204 op_sel:[0,0] op_sel_hi:[1,0]
    v_pk_mul_f16 v179, v179, v204 op_sel:[0,0] op_sel_hi:[1,0]
    v_mfma_f32_16x16x32_f16 v[226:229], v[118:121], v[206:209], v[46:49]
    v_pk_mul_f16 v180, v180, v204 op_sel:[0,0] op_sel_hi:[1,0]
    v_pk_mul_f16 v181, v181, v204 op_sel:[0,0] op_sel_hi:[1,0]
    v_mfma_f32_16x16x32_f16 v[230:233], v[170:173], v[206:209], v[50:53]
    v_pk_mul_f16 v122, v122, v204 op_sel:[0,0] op_sel_hi:[1,0]
    v_pk_mul_f16 v123, v123, v204 op_sel:[0,0] op_sel_hi:[1,0]
    v_mfma_f32_16x16x32_f16 v[234:237], v[142:145], v[206:209], v[54:57]
    v_min3_u32 v44, v44, v202, v203
    v_exp_f32 v214, v214
    v_mfma_f32_16x16x16_f16 v[226:229], v[196:197], v[194:195], v[226:229]
    v_max3_u32 v45, v45, v202, v203
    v_exp_f32 v190, v190
    v_mfma_f32_16x16x16_f16 v[230:233], v[220:221], v[194:195], v[230:233]
    v_cvt_pk_bf16_f32 v39, v190, 0
    v_mfma_f32_16x16x16_f16 v[234:237], v[124:125], v[194:195], v[234:237]
    buffer_store_dwordx4 v[150:153], v15, s[12:15], 0 offen
    v_mfma_f32_16x16x32_bf16 v[222:225], v[134:137], a[184:187], v[222:225]
    v_mfma_f32_16x16x32_bf16 v[222:225], v[154:157], a[188:191], v[222:225]
    ds_read_b128 v[206:209], v2 offset:0
    v_mfma_f32_16x16x32_bf16 v[150:153], v[146:149], a[192:195], 0
    ds_read_b128 v[146:149], v2 offset:1024
    v_mfma_f32_16x16x32_bf16 v[150:153], v[138:141], a[196:199], v[150:153]
    ds_read_b128 v[138:141], v2 offset:2048
    v_mfma_f32_16x16x32_bf16 v[150:153], v[186:189], a[200:203], v[150:153]
    ds_read_b128 v[186:189], v2 offset:3072
    v_mfma_f32_16x16x32_bf16 v[150:153], v[162:165], a[204:207], v[150:153]
    ds_read_b128 v[162:165], v2 offset:4096
    v_cvt_pk_bf16_f32 v222, v222, v223
    v_mfma_f32_16x16x32_bf16 v[150:153], v[134:137], a[208:211], v[150:153]
    ds_read_b128 v[134:137], v2 offset:5120
    v_cvt_pk_bf16_f32 v223, v224, v225
    v_mfma_f32_16x16x32_bf16 v[150:153], v[154:157], a[212:215], v[150:153]
    ds_read2_b32 v[132:133], v6 offset0:0 offset1:0
    ds_read2_b32 v[224:225], v6 offset0:16 offset1:16
    v_mfma_f32_16x16x32_f16 v[154:157], v[166:169], v[178:181], v[26:29]
    ds_read2_b32 v[168:169], v6 offset0:32 offset1:32
    v_add_u32 v6, 272, v6
    v_mfma_f32_16x16x32_f16 v[154:157], v[126:129], v[142:145], v[154:157]
    s_waitcnt lgkmcnt(8)
    v_exp_f32 v226, v226
    v_mfma_f32_16x16x32_f16 v[154:157], v[210:213], v[122:125], v[154:157]
    s_waitcnt lgkmcnt(7)
    v_cvt_pk_bf16_f32 v166, v150, v151
    v_cvt_pk_bf16_f32 v167, v152, v153
    v_mfma_f32_16x16x32_bf16 v[150:153], a[216:219], v[206:209], 0
    s_waitcnt lgkmcnt(6)
    v_exp_f32 v227, v227
    v_mfma_f32_16x16x32_bf16 v[150:153], a[220:223], v[146:149], v[150:153]
    s_waitcnt lgkmcnt(5)
    v_exp_f32 v154, v154
    v_mfma_f32_16x16x32_bf16 v[150:153], a[224:227], v[138:141], v[150:153]
    s_waitcnt lgkmcnt(4)
    v_mov_b32_dpp v200, v155 quad_perm:[0,1,2,3] row_mask:0x4 bank_mask:0xf
    v_cvt_pk_bf16_f32 v126, v226, v227
    v_mfma_f32_16x16x32_bf16 v[150:153], a[228:231], v[186:189], v[150:153]
    s_waitcnt lgkmcnt(3)
    v_exp_f32 v200, v200
    v_mfma_f32_16x16x32_bf16 v[150:153], a[232:235], v[162:165], v[150:153]
    s_waitcnt lgkmcnt(1)
    v_exp_f32 v228, v228
    v_mfma_f32_16x16x32_bf16 v[150:153], a[236:239], v[134:137], v[150:153]
    s_waitcnt lgkmcnt(0)
    buffer_store_dwordx2 v[254:255], v18, s[12:15], 0 offen
    v_exp_f32 v229, v229
    v_mfma_f32_16x16x32_bf16 v[190:193], a[240:243], v[206:209], 0
    v_cvt_pk_bf16_f32 v200, v200, v200
    v_cvt_pk_bf16_f32 v127, v228, v229
    v_mfma_f32_16x16x32_bf16 v[190:193], a[244:247], v[146:149], v[190:193]
    ds_write_b16 v8, v200
    v_mfma_f32_16x16x32_bf16 v[190:193], a[248:251], v[138:141], v[190:193]
    v_exp_f32 v230, v230
    v_mfma_f32_16x16x32_bf16 v[190:193], a[252:255], v[186:189], v[190:193]
    ds_read_b128 v[198:201], v2 offset:6144
    ds_read_b128 v[210:213], v9
    v_mfma_f32_16x16x32_bf16 v[190:193], v[82:85], v[162:165], v[190:193]
    ds_read_b128 v[226:229], v2 offset:7168
    ds_read_b128 v[238:241], v9 offset:64
    v_mfma_f32_16x16x32_bf16 v[190:193], v[86:89], v[134:137], v[190:193]
    v_exp_f32 v231, v231
    v_mfma_f32_16x16x32_bf16 v[202:205], v[90:93], v[206:209], 0
    ds_read_b128 v[206:209], v2 offset:8192
    ds_read_b128 v[242:245], v2 offset:9216
    v_mfma_f32_16x16x32_bf16 v[202:205], v[94:97], v[146:149], v[202:205]
    v_cvt_pk_bf16_f32 v128, v230, v231
    v_fma_f32 v254, v150, v150, s33
    v_mfma_f32_16x16x32_bf16 v[202:205], v[98:101], v[138:141], v[202:205]
    ds_read_b128 v[146:149], v2 offset:10240
    ds_read_b128 v[138:141], v2 offset:11264
    v_mfma_f32_16x16x32_bf16 v[202:205], v[102:105], v[186:189], v[202:205]
    v_exp_f32 v232, v232
    v_mfma_f32_16x16x32_bf16 v[202:205], v[106:109], v[162:165], v[202:205]
    v_exp_f32 v233, v233
    v_mfma_f32_16x16x32_bf16 v[202:205], v[110:113], v[134:137], v[202:205]
    s_waitcnt lgkmcnt(6)
    v_cvt_pk_bf16_f32 v129, v232, v233
    v_fmac_f32 v254, v151, v151
    v_mfma_f32_16x16x32_bf16 v[186:189], v[210:213], v[28:31], 0
    s_waitcnt lgkmcnt(4)
    v_exp_f32 v234, v234
    v_mfma_f32_16x16x32_bf16 v[186:189], v[238:241], v[28:31], v[186:189]
    v_exp_f32 v235, v235
    v_mfma_f32_16x16x32_f16 v[134:137], v[118:121], v[158:161], v[58:61]
    s_waitcnt lgkmcnt(2)
    v_cvt_pk_bf16_f32 v36, v234, v235
    v_fmac_f32 v254, v152, v152
    v_mfma_f32_16x16x32_f16 v[162:165], v[170:173], v[158:161], v[62:65]
    v_exp_f32 v236, v236
    v_mfma_f32_16x16x32_f16 v[230:233], v[142:145], v[158:161], v[66:69]
    s_waitcnt lgkmcnt(0)
    buffer_load_dwordx4 v14, s[8:11], 0 offen lds
    v_rcp_f32 v186, v186
    v_mfma_f32_16x16x16_f16 v[134:137], v[196:197], v[218:219], v[134:137]
    v_exp_f32 v237, v237
    v_fmac_f32 v254, v153, v153
    v_mfma_f32_16x16x16_f16 v[162:165], v[220:221], v[218:219], v[162:165]
    v_cvt_pk_bf16_f32 v37, v236, v237
    v_fmac_f32 v254, v190, v190
    v_fmac_f32 v254, v191, v191
    v_mfma_f32_16x16x16_f16 v[230:233], v[124:125], v[218:219], v[230:233]
    v_fmac_f32 v254, v192, v192
    v_exp_f32 v134, v134
    v_fmac_f32 v254, v193, v193
    v_mfma_f32_16x16x32_bf16 v[158:161], v[210:213], v[174:177], 0
    v_exp_f32 v135, v135
    v_mfma_f32_16x16x32_bf16 v[158:161], v[238:241], v[130:133], v[158:161]
    v_cvt_pk_bf16_f32 v134, v134, v135
    v_fmac_f32 v254, v202, v202
    v_mfma_f32_16x16x32_bf16 v[234:237], v[210:213], v[182:185], 0
    v_exp_f32 v136, v136
    v_mfma_f32_16x16x32_bf16 v[234:237], v[238:241], v[222:225], v[234:237]
    v_exp_f32 v137, v137
    v_mfma_f32_16x16x32_bf16 v[246:249], v[210:213], v[114:117], 0
    v_cvt_pk_bf16_f32 v135, v136, v137
    v_mul_f32 v158, v158, v186
    v_mfma_f32_16x16x32_bf16 v[246:249], v[238:241], v[166:169], v[246:249]
    v_exp_f32 v162, v162
    v_mfma_f32_16x16x32_bf16 v[210:213], v[28:31], v[36:39], 0
    v_exp_f32 v163, v163
    v_mfma_f32_16x16x32_bf16 v[210:213], v[28:31], v[126:129], v[210:213]
    v_cvt_pk_bf16_f32 v136, v162, v163
    v_mul_f32_dpp v158, v234, v186 quad_perm:[0,1,2,3] row_mask:0x2 bank_mask:0xf
    v_mfma_f32_16x16x32_bf16 v[234:237], v[130:133], v[36:39], 0
    v_exp_f32 v164, v164
    v_mfma_f32_16x16x32_bf16 v[234:237], v[174:177], v[126:129], v[234:237]
    v_exp_f32 v165, v165
    v_mfma_f32_16x16x32_bf16 v[238:241], v[222:225], v[36:39], 0
    v_cvt_pk_bf16_f32 v137, v164, v165
    v_mul_f32_dpp v158, v246, v186 quad_perm:[0,1,2,3] row_mask:0x4 bank_mask:0xf
    v_mfma_f32_16x16x32_bf16 v[238:241], v[182:185], v[126:129], v[238:241]
    v_exp_f32 v230, v230
    v_mfma_f32_16x16x32_bf16 v[186:189], v[166:169], v[36:39], 0
    v_exp_f32 v231, v231
    v_mfma_f32_16x16x32_bf16 v[186:189], v[114:117], v[126:129], v[186:189]
    v_cvt_pk_bf16_f32 v36, v230, v231
    v_cvt_pk_bf16_f32 v39, v214, 0
    v_mfma_f32_16x16x32_f16 v[162:165], v[118:121], v[178:181], v[70:73]
    v_exp_f32 v232, v232
    v_mfma_f32_16x16x32_f16 v[118:121], v[170:173], v[178:181], v[74:77]
    v_exp_f32 v233, v233
    v_mfma_f32_16x16x32_f16 v[170:173], v[142:145], v[178:181], v[78:81]
    v_cvt_pk_bf16_f32 v37, v232, v233
    v_cvt_pk_bf16_f32 v158, v158, v158
    v_fmac_f32 v254, v203, v203
    v_mfma_f32_16x16x16_f16 v[162:165], v[196:197], v[122:123], v[162:165]
    v_rcp_f32 v210, v210
    v_fmac_f32 v254, v204, v204
    v_mfma_f32_16x16x16_f16 v[118:121], v[220:221], v[122:123], v[118:121]
    v_mul_f32 v234, v210, v234
    v_mul_f32 v235, v210, v235
    v_cvt_pk_bf16_f32 v178, v234, v235
    v_mfma_f32_16x16x16_f16 v[170:173], v[124:125], v[122:123], v[170:173]
    v_mul_f32 v236, v210, v236
    v_exp_f32 v162, v162
    v_mul_f32 v237, v210, v237
    v_mfma_f32_16x16x32_bf16 v[194:197], v[28:31], v[36:39], 0
    ds_write_b16 v7, v158
    v_mfma_f32_16x16x32_bf16 v[194:197], v[28:31], v[134:137], v[194:197]
    v_exp_f32 v163, v163
    v_mfma_f32_16x16x32_bf16 v[122:125], v[130:133], v[36:39], 0
    v_cvt_pk_bf16_f32 v162, v162, v163
    v_cvt_pk_bf16_f32 v179, v236, v237
    v_mfma_f32_16x16x32_bf16 v[122:125], v[174:177], v[134:137], v[122:125]
    v_exp_f32 v164, v164
    v_mfma_f32_16x16x32_bf16 v[126:129], v[222:225], v[36:39], 0
    v_exp_f32 v165, v165
    v_mfma_f32_16x16x32_bf16 v[126:129], v[182:185], v[134:137], v[126:129]
    v_cvt_pk_bf16_f32 v163, v164, v165
    v_mul_f32 v238, v210, v238
    v_mfma_f32_16x16x32_bf16 v[218:221], v[166:169], v[36:39], 0
    v_exp_f32 v118, v118
    v_mfma_f32_16x16x32_bf16 v[218:221], v[114:117], v[134:137], v[218:221]
    v_exp_f32 v119, v119
    v_mfma_f32_16x16x32_bf16 v[142:145], a[216:219], v[198:201], 0
    v_cvt_pk_bf16_f32 v164, v118, v119
    v_cvt_pk_bf16_f32 v39, v154, 0
    v_mfma_f32_16x16x32_bf16 v[142:145], a[220:223], v[226:229], v[142:145]
    v_exp_f32 v120, v120
    v_mfma_f32_16x16x32_bf16 v[142:145], a[224:227], v[206:209], v[142:145]
    v_exp_f32 v121, v121
    v_mfma_f32_16x16x32_bf16 v[142:145], a[228:231], v[242:245], v[142:145]
    v_cvt_pk_bf16_f32 v165, v120, v121
    v_mul_f32 v239, v210, v239
    v_mfma_f32_16x16x32_bf16 v[142:145], a[232:235], v[146:149], v[142:145]
    v_exp_f32 v170, v170
    v_mfma_f32_16x16x32_bf16 v[142:145], a[236:239], v[138:141], v[142:145]
    v_exp_f32 v171, v171
    v_mfma_f32_16x16x32_bf16 v[158:161], a[240:243], v[198:201], 0
    v_cvt_pk_bf16_f32 v36, v170, v171
    v_cvt_pk_bf16_f32 v180, v238, v239
    v_mfma_f32_16x16x32_bf16 v[158:161], a[244:247], v[226:229], v[158:161]
    v_exp_f32 v172, v172
    v_mfma_f32_16x16x32_bf16 v[158:161], a[248:251], v[206:209], v[158:161]
    v_exp_f32 v173, v173
    v_mfma_f32_16x16x32_bf16 v[158:161], a[252:255], v[242:245], v[158:161]
    ds_read_b128 v[118:121], v2 offset:12288
    v_cvt_pk_bf16_f32 v37, v172, v173
    v_mfma_f32_16x16x32_bf16 v[158:161], v[82:85], v[146:149], v[158:161]
    ds_read_b128 v[134:137], v2 offset:13312
    v_mul_f32 v240, v210, v240
    v_mfma_f32_16x16x32_bf16 v[170:173], v[28:31], v[36:39], 0
    v_mul_f32 v241, v210, v241
    v_cvt_pk_bf16_f32 v181, v240, v241
    v_mfma_f32_16x16x32_bf16 v[170:173], v[28:31], v[162:165], v[170:173]
    ds_write_b128 v3, v[178:181] offset:0
    v_mfma_f32_16x16x32_bf16 v[154:157], v[130:133], v[36:39], 0
    v_mul_f32 v186, v210, v186
    v_mul_f32 v187, v210, v187
    v_mfma_f32_16x16x32_bf16 v[154:157], v[174:177], v[162:165], v[154:157]
    v_cvt_pk_bf16_f32 v186, v186, v187
    v_mul_f32 v188, v210, v188
    v_mfma_f32_16x16x32_bf16 v[130:133], v[222:225], v[36:39], 0
    v_mul_f32 v189, v210, v189
    v_cvt_pk_bf16_f32 v187, v188, v189
    v_mfma_f32_16x16x32_bf16 v[130:133], v[182:185], v[162:165], v[130:133]
    s_waitcnt lgkmcnt(2)
    ds_write_b64 v4, v[186:187] offset:4096
    v_mfma_f32_16x16x32_bf16 v[174:177], v[166:169], v[36:39], 0
    s_waitcnt lgkmcnt(2)
    v_fma_f32 v255, v142, v142, s33
    v_fmac_f32 v255, v143, v143
    v_mfma_f32_16x16x32_bf16 v[174:177], v[114:117], v[162:165], v[174:177]
    v_fmac_f32 v255, v144, v144
    v_fmac_f32 v255, v145, v145
    v_mfma_f32_16x16x32_bf16 v[158:161], v[86:89], v[138:141], v[158:161]
    ds_read_b128 v[114:117], v2 offset:14336
    v_fmac_f32 v254, v205, v205
    v_mfma_f32_16x16x32_bf16 v[178:181], v[90:93], v[198:201], 0
    ds_read_b128 v[166:169], v2 offset:15360
    v_add_u32 v7, 16, v7
    v_mfma_f32_16x16x32_bf16 v[178:181], v[94:97], v[226:229], v[178:181]
    ds_read_b128 v[162:165], v2 offset:16384
    v_mfma_f32_16x16x32_bf16 v[178:181], v[98:101], v[206:209], v[178:181]
    ds_read_b128 v[206:209], v2 offset:17408
    v_fmac_f32 v255, v158, v158
    v_mfma_f32_16x16x32_bf16 v[178:181], v[102:105], v[242:245], v[178:181]
    v_fmac_f32 v255, v159, v159
    v_fmac_f32 v255, v160, v160
    v_mfma_f32_16x16x32_bf16 v[178:181], v[106:109], v[146:149], v[178:181]
    v_fmac_f32 v255, v161, v161
    v_xor_b32 v2, 65536, v2
    v_mfma_f32_16x16x32_bf16 v[178:181], v[110:113], v[138:141], v[178:181]
    v_rcp_f32 v170, v170
    v_mfma_f32_16x16x32_bf16 v[146:149], a[216:219], v[118:121], 0
    v_mul_f32 v154, v170, v154
    v_mul_f32 v155, v170, v155
    v_mfma_f32_16x16x32_bf16 v[146:149], a[220:223], v[134:137], v[146:149]
    s_waitcnt lgkmcnt(3)
    ds_read_b128 v[182:185], v0 offset:20480
    v_cvt_pk_bf16_f32 v154, v154, v155
    v_mfma_f32_16x16x32_bf16 v[146:149], a[224:227], v[114:117], v[146:149]
    s_waitcnt lgkmcnt(3)
    ds_read_b128 v[198:201], v1 offset:20480
    v_fmac_f32 v255, v178, v178
    v_mfma_f32_16x16x32_bf16 v[146:149], a[228:231], v[166:169], v[146:149]
    s_waitcnt lgkmcnt(3)
    ds_read_b128 v[210:213], v0 offset:20608
    v_fmac_f32 v255, v179, v179
    v_mfma_f32_16x16x32_bf16 v[146:149], a[232:235], v[162:165], v[146:149]
    s_waitcnt lgkmcnt(3)
    ds_read_b128 v[222:225], v1 offset:20608
    v_fmac_f32 v255, v180, v180
    v_mfma_f32_16x16x32_bf16 v[146:149], a[236:239], v[206:209], v[146:149]
    ds_read_b128 v[226:229], v0 offset:20736
    v_fmac_f32 v255, v181, v181
    v_mfma_f32_16x16x32_bf16 v[138:141], a[240:243], v[118:121], 0
    ds_read_b128 v[242:245], v1 offset:20736
    v_cvt_pk_bf16_f32 v254, v254, v255
    v_mfma_f32_16x16x32_bf16 v[138:141], a[244:247], v[134:137], v[138:141]
    v_mul_f32 v156, v170, v156
    v_mul_f32 v157, v170, v157
    v_mfma_f32_16x16x32_bf16 v[138:141], a[248:251], v[114:117], v[138:141]
    v_fma_f32 v255, v146, v146, s33
    v_fmac_f32 v255, v147, v147
    v_mfma_f32_16x16x32_bf16 v[138:141], a[252:255], v[166:169], v[138:141]
    s_waitcnt lgkmcnt(5)
    v_fmac_f32 v255, v148, v148
    v_fmac_f32 v255, v149, v149
    v_mfma_f32_16x16x32_bf16 v[138:141], v[82:85], v[162:165], v[138:141]
    s_waitcnt lgkmcnt(4)
    v_cvt_pk_bf16_f32 v155, v156, v157
    v_mul_f32 v130, v170, v130
    v_mfma_f32_16x16x32_bf16 v[138:141], v[86:89], v[206:209], v[138:141]
    s_waitcnt lgkmcnt(3)
    v_mul_f32 v131, v170, v131
    v_cvt_pk_bf16_f32 v156, v130, v131
    v_mfma_f32_16x16x32_bf16 v[186:189], v[90:93], v[118:121], 0
    s_waitcnt lgkmcnt(2)
    v_mul_f32 v132, v170, v132
    v_mul_f32 v133, v170, v133
    v_mfma_f32_16x16x32_bf16 v[186:189], v[94:97], v[134:137], v[186:189]
    s_waitcnt lgkmcnt(1)
    v_fmac_f32 v255, v138, v138
    v_fmac_f32 v255, v139, v139
    v_mfma_f32_16x16x32_bf16 v[186:189], v[98:101], v[114:117], v[186:189]
    s_waitcnt lgkmcnt(0)
    v_fmac_f32 v255, v140, v140
    v_fmac_f32 v255, v141, v141
    v_mfma_f32_16x16x32_bf16 v[186:189], v[102:105], v[166:169], v[186:189]
    v_cvt_pk_bf16_f32 v157, v132, v133
    v_mul_f32 v174, v170, v174
    v_mfma_f32_16x16x32_bf16 v[186:189], v[106:109], v[162:165], v[186:189]
    ds_write_b128 v3, v[154:157] offset:12288
    v_mfma_f32_16x16x32_bf16 v[186:189], v[110:113], v[206:209], v[186:189]
    v_mul_f32 v175, v170, v175
    v_cvt_pk_bf16_f32 v174, v174, v175
    v_mfma_f32_16x16x32_bf16 v[118:121], a[72:75], v[182:185], 0
    v_mul_f32 v176, v170, v176
    v_mul_f32 v177, v170, v177
    v_mfma_f32_16x16x32_bf16 v[118:121], a[76:79], v[198:201], v[118:121]
    v_rcp_f32 v194, v194
    v_mfma_f32_16x16x32_bf16 v[118:121], a[80:83], v[210:213], v[118:121]
    v_fmac_f32 v255, v186, v186
    v_fmac_f32 v255, v187, v187
    v_mfma_f32_16x16x32_bf16 v[118:121], a[84:87], v[222:225], v[118:121]
    v_fmac_f32 v255, v188, v188
    v_fmac_f32 v255, v189, v189
    v_mfma_f32_16x16x32_bf16 v[118:121], a[88:91], v[226:229], v[118:121]
    v_cvt_pk_bf16_f32 v255, v255, v255
    v_cvt_pk_bf16_f32 v175, v176, v177
    v_mfma_f32_16x16x32_bf16 v[118:121], a[92:95], v[242:245], v[118:121]
    ds_write_b64 v4, v[174:175] offset:16384
    v_mfma_f32_16x16x32_bf16 v[206:209], a[96:99], v[182:185], 0
    v_mul_f32 v122, v194, v122
    v_mul_f32 v123, v194, v123
    v_mfma_f32_16x16x32_bf16 v[206:209], a[100:103], v[198:201], v[206:209]
    ds_write_b64 v4, v[254:255] offset:18432
    v_mfma_f32_16x16x32_bf16 v[206:209], a[104:107], v[210:213], v[206:209]
    v_cvt_pk_bf16_f32 v134, v122, v123
    v_cvt_pk_f16_f32 v118, v118, v119
    v_mfma_f32_16x16x32_bf16 v[206:209], a[108:111], v[222:225], v[206:209]
    v_pk_mul_f16 v163, v118, v118
    v_cvt_pk_f16_f32 v119, v120, v121
    v_mfma_f32_16x16x32_bf16 v[206:209], a[112:115], v[226:229], v[206:209]
    v_pk_mul_f16 v165, v119, v119
    v_mul_f32 v124, v194, v124
    v_mfma_f32_16x16x32_bf16 v[206:209], a[116:119], v[242:245], v[206:209]
    v_mul_f32 v125, v194, v125
    v_cvt_pk_bf16_f32 v135, v124, v125
    v_mfma_f32_16x16x32_bf16 v[122:125], a[120:123], v[182:185], 0
    v_mul_f32 v126, v194, v126
    v_mul_f32 v127, v194, v127
    v_mfma_f32_16x16x32_bf16 v[122:125], a[124:127], v[198:201], v[122:125]
    v_cvt_pk_bf16_f32 v136, v126, v127
    v_mul_f32 v128, v194, v128
    v_mfma_f32_16x16x32_bf16 v[122:125], a[128:131], v[210:213], v[122:125]
    v_cvt_pk_f16_f32 v120, v206, v207
    v_pk_fma_f16 v163, v120, v120, v163
    v_mfma_f32_16x16x32_bf16 v[122:125], a[132:135], v[222:225], v[122:125]
    v_cvt_pk_f16_f32 v121, v208, v209
    v_pk_fma_f16 v165, v121, v121, v165
    v_mfma_f32_16x16x32_bf16 v[122:125], a[136:139], v[226:229], v[122:125]
    v_mul_f32 v129, v194, v129
    v_cvt_pk_bf16_f32 v137, v128, v129
    v_mfma_f32_16x16x32_bf16 v[122:125], a[140:143], v[242:245], v[122:125]
    ds_write_b128 v3, v[134:137] offset:6144
    v_mfma_f32_16x16x32_bf16 v[206:209], a[0:3], v[182:185], 0
    v_mul_f32 v218, v194, v218
    v_mul_f32 v219, v194, v219
    v_mfma_f32_16x16x32_bf16 v[206:209], a[4:7], v[198:201], v[206:209]
    v_cvt_pk_bf16_f32 v254, v218, v219
    v_mul_f32 v220, v194, v220
    v_mfma_f32_16x16x32_bf16 v[206:209], a[8:11], v[210:213], v[206:209]
    v_cvt_pk_f16_f32 v196, v122, v123
    v_pk_fma_f16 v163, v196, v196, v163
    v_mfma_f32_16x16x32_bf16 v[206:209], a[12:15], v[222:225], v[206:209]
    v_cvt_pk_f16_f32 v197, v124, v125
    v_pk_fma_f16 v165, v197, v197, v165
    v_mfma_f32_16x16x32_bf16 v[206:209], a[16:19], v[226:229], v[206:209]
    v_mul_f32 v221, v194, v221
    v_cvt_pk_bf16_f32 v255, v220, v221
    v_mfma_f32_16x16x32_bf16 v[206:209], a[20:23], v[242:245], v[206:209]
    ds_write_b64 v4, v[254:255] offset:10240
    v_mfma_f32_16x16x32_bf16 v[174:177], a[24:27], v[182:185], 0
    v_xor_b32 v3, 65536, v3
    v_xor_b32 v4, 65536, v4
    v_mfma_f32_16x16x32_bf16 v[174:177], a[28:31], v[198:201], v[174:177]
    v_mfma_f32_16x16x32_bf16 v[174:177], a[32:35], v[210:213], v[174:177]
    v_mfma_f32_16x16x32_bf16 v[174:177], a[36:39], v[222:225], v[174:177]
    v_mfma_f32_16x16x32_bf16 v[174:177], a[40:43], v[226:229], v[174:177]
    v_cvt_pk_f16_f32 v206, v206, v207
    v_mfma_f32_16x16x32_bf16 v[174:177], a[44:47], v[242:245], v[174:177]
    v_mfma_f32_16x16x32_bf16 v[218:221], a[48:51], v[182:185], 0
    s_waitcnt lgkmcnt(0)
    v_mfma_f32_16x16x32_bf16 v[218:221], a[52:55], v[198:201], v[218:221]
    s_nop 0
    v_mfma_f32_16x16x32_bf16 v[218:221], a[56:59], v[210:213], v[218:221]
    s_barrier
    v_mfma_f32_16x16x32_bf16 v[218:221], a[60:63], v[222:225], v[218:221]
    s_nop 0
    v_mfma_f32_16x16x32_bf16 v[218:221], a[64:67], v[226:229], v[218:221]
    s_nop 0
    v_mfma_f32_16x16x32_bf16 v[218:221], a[68:71], v[242:245], v[218:221]
    v_mfma_f32_16x16x32_bf16 v[170:173], v[182:185], a[144:147], 0
    v_mfma_f32_16x16x32_bf16 v[170:173], v[198:201], a[148:151], v[170:173]
    v_mfma_f32_16x16x32_bf16 v[170:173], v[210:213], a[152:155], v[170:173]
    v_mfma_f32_16x16x32_bf16 v[170:173], v[222:225], a[156:159], v[170:173]
    v_mfma_f32_16x16x32_bf16 v[170:173], v[226:229], a[160:163], v[170:173]
    v_mfma_f32_16x16x32_bf16 v[170:173], v[242:245], a[164:167], v[170:173]
    s_cbranch_scc1 L_loop_fast1
    s_branch L_drain
.p2align 6
L_loop_fast2:
    v_mfma_f32_16x16x32_bf16 v[234:237], v[182:185], a[168:171], 0
    s_add_u32 s12, s42, s27
    ds_read_b128 v[230:233], v2 offset:18432
    ds_read_b128 v[238:241], v2 offset:19456
    v_mfma_f32_16x16x32_bf16 v[234:237], v[198:201], a[172:175], v[234:237]
    s_addc_u32 s13, s43, 0
    v_pk_mul_f16 v162, v206, v206
    v_cvt_pk_f16_f32 v207, v208, v209
    v_mfma_f32_16x16x32_bf16 v[234:237], v[210:213], a[176:179], v[234:237]
    s_sub_u32 s14, s36, s27
    ds_read_b128 v[134:137], v0 offset:26624
    v_pk_mul_f16 v164, v207, v207
    v_mfma_f32_16x16x32_bf16 v[234:237], v[222:225], a[180:183], v[234:237]
    s_cmp_ge_u32 s18, 2
    ds_read_b128 v[154:157], v1 offset:26624
    v_cvt_pk_f16_f32 v208, v174, v175
    v_mfma_f32_16x16x32_bf16 v[234:237], v[226:229], a[184:187], v[234:237]
    s_cselect_b32 s14, s14, 0
    ds_read_b128 v[130:133], v0 offset:26752
    v_pk_fma_f16 v162, v208, v208, v162
    v_mfma_f32_16x16x32_bf16 v[234:237], v[242:245], a[188:191], v[234:237]
    s_add_u32 s34, s18, 2
    ds_read_b128 v[122:125], v1 offset:26752
    v_cvt_pk_f16_f32 v209, v176, v177
    v_mfma_f32_16x16x32_bf16 v[114:117], v[182:185], a[192:195], 0
    s_add_u32 s8, s40, s23
    ds_read_b128 v[126:129], v0 offset:26880
    v_pk_fma_f16 v164, v209, v209, v164
    v_mfma_f32_16x16x32_bf16 v[114:117], v[198:201], a[196:199], v[114:117]
    s_addc_u32 s9, s41, 0
    ds_read_b128 v[166:169], v1 offset:26880
    v_cvt_pk_f16_f32 v194, v218, v219
    v_mfma_f32_16x16x32_bf16 v[114:117], v[210:213], a[200:203], v[114:117]
    s_waitcnt lgkmcnt(6)
    v_pk_fma_f16 v162, v194, v194, v162
    v_cvt_pk_f16_f32 v195, v220, v221
    v_mfma_f32_16x16x32_bf16 v[198:201], v[32:35], v[230:233], 0
    s_sub_u32 s10, s36, s23
    v_pk_fma_f16 v164, v195, v195, v164
    v_cvt_pk_bf16_f32 v174, v170, v171
    v_mfma_f32_16x16x32_bf16 v[198:201], v[32:35], v[238:241], v[198:201]
    s_waitcnt lgkmcnt(5)
    v_cvt_pk_bf16_f32 v175, v172, v173
    v_cvt_pk_bf16_f32 v182, v234, v235
    v_mfma_f32_16x16x32_f16 v[170:173], v[40:43], v[162:165], 0
    s_cmp_lt_u32 s34, s17
    v_cvt_pk_bf16_f32 v183, v236, v237
    s_cselect_b32 s10, s10, 0
    v_mfma_f32_16x16x32_bf16 v[114:117], v[222:225], a[204:207], v[114:117]
    s_add_u32 m0, s28, 0
    v_mul_f32 v255, 0x3baaaaab, v198
    v_mul_f32 v254, 0x3baaaaab, v199
    v_mfma_f32_16x16x32_bf16 v[114:117], v[226:229], a[208:211], v[114:117]
    s_mov_b32 s27, s26
    v_rsq_f32 v172, v170
    v_mfma_f32_16x16x32_bf16 v[114:117], v[242:245], a[212:215], v[114:117]
    s_mov_b32 s26, s25
    v_rsq_f32 v173, v171
    v_mfma_f32_16x16x32_bf16 v[162:165], a[72:75], v[134:137], 0
    s_waitcnt lgkmcnt(0)
    v_mul_f32 v172, s31, v172
    v_cvt_pk_f16_f32 v172, v172, v173
    v_mfma_f32_16x16x32_bf16 v[162:165], a[76:79], v[154:157], v[162:165]
    s_mov_b32 s25, s24
    v_cvt_pk_bf16_f32 v114, v114, v115
    v_cvt_pk_bf16_f32 v115, v116, v117
    v_mfma_f32_16x16x32_bf16 v[162:165], a[80:83], v[130:133], v[162:165]
    s_mov_b32 s24, s23
    v_pk_mul_f16 v118, v118, v172 op_sel:[0,1] op_sel_hi:[1,1]
    v_pk_mul_f16 v119, v119, v172 op_sel:[0,1] op_sel_hi:[1,1]
    v_mfma_f32_16x16x32_bf16 v[162:165], a[84:87], v[122:125], v[162:165]
    v_pk_mul_f16 v120, v120, v172 op_sel:[0,1] op_sel_hi:[1,1]
    v_pk_mul_f16 v121, v121, v172 op_sel:[0,1] op_sel_hi:[1,1]
    v_mfma_f32_16x16x32_bf16 v[162:165], a[88:91], v[126:129], v[162:165]
    v_pk_mul_f16 v196, v196, v172 op_sel:[0,1] op_sel_hi:[1,1]
    v_pk_mul_f16 v197, v197, v172 op_sel:[0,1] op_sel_hi:[1,1]
    v_mfma_f32_16x16x32_bf16 v[162:165], a[92:95], v[166:169], v[162:165]
    v_pk_mul_f16 v206, v206, v172 op_sel:[0,0] op_sel_hi:[1,0]
    v_pk_mul_f16 v207, v207, v172 op_sel:[0,0] op_sel_hi:[1,0]
    v_mfma_f32_16x16x32_bf16 v[210:213], a[96:99], v[134:137], 0
    v_pk_mul_f16 v208, v208, v172 op_sel:[0,0] op_sel_hi:[1,0]
    v_pk_mul_f16 v209, v209, v172 op_sel:[0,0] op_sel_hi:[1,0]
    v_mfma_f32_16x16x32_bf16 v[210:213], a[100:103], v[154:157], v[210:213]
    v_pk_mul_f16 v194, v194, v172 op_sel:[0,0] op_sel_hi:[1,0]
    v_pk_mul_f16 v195, v195, v172 op_sel:[0,0] op_sel_hi:[1,0]
    v_mfma_f32_16x16x32_bf16 v[210:213], a[104:107], v[130:133], v[210:213]
    v_min3_u32 v44, v44, v170, v171
    v_max3_u32 v45, v45, v170, v171
    v_mfma_f32_16x16x32_bf16 v[210:213], a[108:111], v[122:125], v[210:213]
    v_cvt_pk_f16_f32 v170, v162, v163
    v_pk_mul_f16 v163, v170, v170
    v_mfma_f32_16x16x32_bf16 v[210:213], a[112:115], v[126:129], v[210:213]
    v_cvt_pk_f16_f32 v171, v164, v165
    v_pk_mul_f16 v165, v171, v171
    v_mfma_f32_16x16x32_bf16 v[210:213], a[116:119], v[166:169], v[210:213]
    v_rsq_f32 v255, v255
    v_mfma_f32_16x16x32_bf16 v[214:217], a[120:123], v[134:137], 0
    v_rsq_f32 v254, v254
    v_mfma_f32_16x16x32_bf16 v[214:217], a[124:127], v[154:157], v[214:217]
    v_mul_f32 v142, v254, v142
    v_mul_f32 v143, v254, v143
    v_mfma_f32_16x16x32_bf16 v[214:217], a[128:131], v[130:133], v[214:217]
    v_cvt_pk_bf16_f32 v142, v142, v143
    v_cvt_pk_f16_f32 v172, v210, v211
    v_mfma_f32_16x16x32_bf16 v[214:217], a[132:135], v[122:125], v[214:217]
    v_pk_fma_f16 v163, v172, v172, v163
    v_cvt_pk_f16_f32 v173, v212, v213
    v_mfma_f32_16x16x32_bf16 v[214:217], a[136:139], v[126:129], v[214:217]
    v_pk_fma_f16 v165, v173, v173, v165
    v_mul_f32 v144, v254, v144
    v_mfma_f32_16x16x32_bf16 v[214:217], a[140:143], v[166:169], v[214:217]
    v_mul_f32 v145, v254, v145
    v_cvt_pk_bf16_f32 v143, v144, v145
    v_mfma_f32_16x16x32_bf16 v[210:213], a[0:3], v[134:137], 0
    v_mul_f32 v158, v254, v158
    v_mul_f32 v159, v254, v159
    v_mfma_f32_16x16x32_bf16 v[210:213], a[4:7], v[154:157], v[210:213]
    v_cvt_pk_bf16_f32 v144, v158, v159
    v_mul_f32 v160, v254, v160
    v_mfma_f32_16x16x32_bf16 v[210:213], a[8:11], v[130:133], v[210:213]
    v_cvt_pk_f16_f32 v220, v214, v215
    v_pk_fma_f16 v163, v220, v220, v163
    v_mfma_f32_16x16x32_bf16 v[210:213], a[12:15], v[122:125], v[210:213]
    v_cvt_pk_f16_f32 v221, v216, v217
    v_pk_fma_f16 v165, v221, v221, v165
    v_mfma_f32_16x16x32_bf16 v[210:213], a[16:19], v[126:129], v[210:213]
    v_mul_f32 v161, v254, v161
    v_cvt_pk_bf16_f32 v145, v160, v161
    v_mfma_f32_16x16x32_bf16 v[210:213], a[20:23], v[166:169], v[210:213]
    buffer_store_dwordx4 v[142:145], v16, s[12:15], 0 offen
    v_mul_f32 v178, v254, v178
    v_mul_f32 v179, v254, v179
    v_cvt_pk_bf16_f32 v198, v178, v179
    v_mul_f32 v180, v254, v180
    v_mfma_f32_16x16x32_bf16 v[142:145], a[24:27], v[134:137], 0
    v_mul_f32 v181, v254, v181
    v_cvt_pk_bf16_f32 v199, v180, v181
    v_mfma_f32_16x16x32_bf16 v[142:145], a[28:31], v[154:157], v[142:145]
    v_cvt_pk_f16_f32 v158, v210, v211
    v_pk_mul_f16 v162, v158, v158
    v_mfma_f32_16x16x32_bf16 v[142:145], a[32:35], v[130:133], v[142:145]
    v_cvt_pk_f16_f32 v159, v212, v213
    v_pk_mul_f16 v164, v159, v159
    v_mfma_f32_16x16x32_bf16 v[142:145], a[36:39], v[122:125], v[142:145]
    v_mul_f32 v254, 0x3baaaaab, v200
    v_mul_f32 v150, v255, v150
    v_mfma_f32_16x16x32_bf16 v[142:145], a[40:43], v[126:129], v[142:145]
    v_rsq_f32 v254, v254
    v_mfma_f32_16x16x32_bf16 v[142:145], a[44:47], v[166:169], v[142:145]
    v_mul_f32 v146, v254, v146
    v_mul_f32 v147, v254, v147
    v_mfma_f32_16x16x32_bf16 v[178:181], a[48:51], v[134:137], 0
    v_cvt_pk_bf16_f32 v146, v146, v147
    v_mul_f32 v148, v254, v148
    v_mfma_f32_16x16x32_bf16 v[178:181], a[52:55], v[154:157], v[178:181]
    v_mul_f32 v149, v254, v149
    v_cvt_pk_bf16_f32 v147, v148, v149
    v_mfma_f32_16x16x32_bf16 v[178:181], a[56:59], v[130:133], v[178:181]
    v_mul_f32 v138, v254, v138
    v_mul_f32 v139, v254, v139
    v_mfma_f32_16x16x32_bf16 v[178:181], a[60:63], v[122:125], v[178:181]
    v_cvt_pk_bf16_f32 v148, v138, v139
    v_mul_f32 v140, v254, v140
    v_mfma_f32_16x16x32_bf16 v[178:181], a[64:67], v[126:129], v[178:181]
    v_mul_f32 v141, v254, v141
    v_cvt_pk_bf16_f32 v149, v140, v141
    v_mfma_f32_16x16x32_bf16 v[178:181], a[68:71], v[166:169], v[178:181]
    v_mul_f32 v186, v254, v186
    v_mul_f32 v187, v254, v187
    v_mfma_f32_16x16x32_bf16 v[138:141], v[134:137], a[144:147], 0
    v_cvt_pk_bf16_f32 v200, v186, v187
    v_mul_f32 v188, v254, v188
    v_mfma_f32_16x16x32_bf16 v[138:141], v[154:157], a[148:151], v[138:141]
    v_mul_f32 v189, v254, v189
    v_cvt_pk_bf16_f32 v201, v188, v189
    v_mfma_f32_16x16x32_bf16 v[138:141], v[130:133], a[152:155], v[138:141]
    v_cvt_pk_f16_f32 v160, v142, v143
    v_pk_fma_f16 v162, v160, v160, v162
    v_mfma_f32_16x16x32_bf16 v[138:141], v[122:125], a[156:159], v[138:141]
    v_cvt_pk_f16_f32 v161, v144, v145
    v_pk_fma_f16 v164, v161, v161, v164
    v_mfma_f32_16x16x32_bf16 v[138:141], v[126:129], a[160:163], v[138:141]
    buffer_store_dwordx4 v[146:149], v17, s[12:15], 0 offen
    v_cvt_pk_f16_f32 v218, v178, v179
    v_pk_fma_f16 v162, v218, v218, v162
    v_cvt_pk_f16_f32 v219, v180, v181
    v_pk_fma_f16 v164, v219, v219, v164
    v_mfma_f32_16x16x32_bf16 v[138:141], v[166:169], a[164:167], v[138:141]
    v_mul_f32 v151, v255, v151
    v_cvt_pk_bf16_f32 v150, v150, v151
    v_mfma_f32_16x16x32_f16 v[142:145], v[40:43], v[162:165], 0
    v_mul_f32 v152, v255, v152
    v_mul_f32 v153, v255, v153
    v_mfma_f32_16x16x32_bf16 v[178:181], v[134:137], a[168:171], 0
    v_cvt_pk_bf16_f32 v151, v152, v153
    v_mul_f32 v190, v255, v190
    v_mfma_f32_16x16x32_bf16 v[178:181], v[154:157], a[172:175], v[178:181]
    v_cvt_pk_bf16_f32 v176, v138, v139
    v_cvt_pk_bf16_f32 v177, v140, v141
    v_mfma_f32_16x16x32_bf16 v[178:181], v[130:133], a[176:179], v[178:181]
    ds_read_b128 v[146:149], v0 offset:32768
    v_min3_u32 v44, v44, v142, v143
    v_mfma_f32_16x16x32_bf16 v[178:181], v[122:125], a[180:183], v[178:181]
    ds_read_b128 v[138:141], v1 offset:32768
    v_max3_u32 v45, v45, v142, v143
    v_mfma_f32_16x16x32_bf16 v[178:181], v[126:129], a[184:187], v[178:181]
    ds_read_b128 v[186:189], v0 offset:32896
    v_mul_f32 v191, v255, v191
    v_mfma_f32_16x16x32_bf16 v[178:181], v[166:169], a[188:191], v[178:181]
    ds_read_b128 v[162:165], v1 offset:32896
    v_cvt_pk_bf16_f32 v152, v190, v191
    v_mfma_f32_16x16x32_bf16 v[210:213], v[134:137], a[192:195], 0
    ds_read_b128 v[134:137], v0 offset:33024
    v_mul_f32 v192, v255, v192
    v_mfma_f32_16x16x32_bf16 v[210:213], v[154:157], a[196:199], v[210:213]
    ds_read_b128 v[154:157], v1 offset:33024
    v_mul_f32 v193, v255, v193
    v_mfma_f32_16x16x32_bf16 v[210:213], v[130:133], a[200:203], v[210:213]
    v_rsq_f32 v144, v142
    v_mfma_f32_16x16x32_bf16 v[210:213], v[122:125], a[204:207], v[210:213]
    v_rsq_f32 v145, v143
    v_mfma_f32_16x16x32_bf16 v[210:213], v[126:129], a[208:211], v[210:213]
    s_waitcnt lgkmcnt(5)
    v_mul_f32 v144, s31, v144
    v_cvt_pk_f16_f32 v144, v144, v145
    v_mfma_f32_16x16x32_bf16 v[210:213], v[166:169], a[212:215], v[210:213]
    s_waitcnt lgkmcnt(4)
    v_cvt_pk_bf16_f32 v184, v178, v179
    v_cvt_pk_bf16_f32 v185, v180, v181
    v_mfma_f32_16x16x32_bf16 v[178:181], a[72:75], v[146:149], 0
    s_waitcnt lgkmcnt(3)
    v_pk_mul_f16 v170, v170, v144 op_sel:[0,1] op_sel_hi:[1,1]
    v_pk_mul_f16 v171, v171, v144 op_sel:[0,1] op_sel_hi:[1,1]
    v_mfma_f32_16x16x32_bf16 v[178:181], a[76:79], v[138:141], v[178:181]
    s_waitcnt lgkmcnt(2)
    v_cvt_pk_bf16_f32 v116, v210, v211
    v_cvt_pk_bf16_f32 v117, v212, v213
    v_mfma_f32_16x16x32_bf16 v[178:181], a[80:83], v[186:189], v[178:181]
    s_waitcnt lgkmcnt(1)
    buffer_store_dwordx2 v[200:201], v20, s[12:15], 0 offen
    v_pk_mul_f16 v172, v172, v144 op_sel:[0,1] op_sel_hi:[1,1]
    v_pk_mul_f16 v173, v173, v144 op_sel:[0,1] op_sel_hi:[1,1]
    v_mfma_f32_16x16x32_bf16 v[178:181], a[84:87], v[162:165], v[178:181]
    s_waitcnt lgkmcnt(0)
    v_pk_mul_f16 v220, v220, v144 op_sel:[0,1] op_sel_hi:[1,1]
    v_pk_mul_f16 v221, v221, v144 op_sel:[0,1] op_sel_hi:[1,1]
    v_mfma_f32_16x16x32_bf16 v[178:181], a[88:91], v[134:137], v[178:181]
    v_pk_mul_f16 v158, v158, v144 op_sel:[0,0] op_sel_hi:[1,0]
    v_pk_mul_f16 v159, v159, v144 op_sel:[0,0] op_sel_hi:[1,0]
    v_mfma_f32_16x16x32_bf16 v[178:181], a[92:95], v[154:157], v[178:181]
    v_pk_mul_f16 v160, v160, v144 op_sel:[0,0] op_sel_hi:[1,0]
    v_pk_mul_f16 v161, v161, v144 op_sel:[0,0] op_sel_hi:[1,0]
    v_mfma_f32_16x16x32_bf16 v[130:133], a[96:99], v[146:149], 0
    v_pk_mul_f16 v218, v218, v144 op_sel:[0,0] op_sel_hi:[1,0]
    v_pk_mul_f16 v219, v219, v144 op_sel:[0,0] op_sel_hi:[1,0]
    v_mfma_f32_16x16x32_bf16 v[130:133], a[100:103], v[138:141], v[130:133]
    s_waitcnt vmcnt(3)
    v_cvt_pk_bf16_f32 v153, v192, v193
    v_cvt_pk_f16_f32 v142, v178, v179
    v_mfma_f32_16x16x32_bf16 v[130:133], a[104:107], v[186:189], v[130:133]
    s_nop 0
    v_pk_mul_f16 v191, v142, v142
    v_cvt_pk_f16_f32 v143, v180, v181
    v_mfma_f32_16x16x32_bf16 v[130:133], a[108:111], v[162:165], v[130:133]
    s_nop 0
    v_pk_mul_f16 v193, v143, v143
    v_mul_f32 v202, v255, v202
    v_mfma_f32_16x16x32_bf16 v[130:133], a[112:115], v[134:137], v[130:133]
    s_barrier
    v_mul_f32 v203, v255, v203
    v_cvt_pk_bf16_f32 v254, v202, v203
    v_mfma_f32_16x16x32_bf16 v[130:133], a[116:119], v[154:157], v[130:133]
    s_nop 0
    v_mul_f32 v204, v255, v204
    v_mul_f32 v205, v255, v205
    v_mfma_f32_16x16x32_bf16 v[178:181], a[120:123], v[146:149], 0
    v_cvt_pk_bf16_f32 v255, v204, v205
    v_xor_b32 v0, 65536, v0
    v_mfma_f32_16x16x32_bf16 v[178:181], a[124:127], v[138:141], v[178:181]
    v_xor_b32 v1, 65536, v1
    v_cvt_pk_f16_f32 v144, v130, v131
    v_mfma_f32_16x16x32_bf16 v[178:181], a[128:131], v[186:189], v[178:181]
    v_pk_fma_f16 v191, v144, v144, v191
    v_cvt_pk_f16_f32 v145, v132, v133
    v_mfma_f32_16x16x32_bf16 v[178:181], a[132:135], v[162:165], v[178:181]
    v_pk_fma_f16 v193, v145, v145, v193
    v_mfma_f32_16x16x32_bf16 v[178:181], a[136:139], v[134:137], v[178:181]
    v_mfma_f32_16x16x32_bf16 v[178:181], a[140:143], v[154:157], v[178:181]
    v_mfma_f32_16x16x32_bf16 v[202:205], a[0:3], v[146:149], 0
    v_mfma_f32_16x16x32_bf16 v[202:205], a[4:7], v[138:141], v[202:205]
    buffer_load_dwordx4 v10, s[8:11], 0 offen lds
    s_add_u32 m0, s28, 4096
    v_mfma_f32_16x16x32_bf16 v[202:205], a[8:11], v[186:189], v[202:205]
    v_mfma_f32_16x16x32_bf16 v[202:205], a[12:15], v[162:165], v[202:205]
    v_mfma_f32_16x16x32_bf16 v[202:205], a[16:19], v[134:137], v[202:205]
    v_mfma_f32_16x16x32_bf16 v[202:205], a[20:23], v[154:157], v[202:205]
    v_cvt_pk_f16_f32 v124, v178, v179
    v_pk_fma_f16 v191, v124, v124, v191
    v_mfma_f32_16x16x32_bf16 v[130:133], a[24:27], v[146:149], 0
    buffer_load_dwordx4 v11, s[8:11], 0 offen lds
    v_cvt_pk_f16_f32 v125, v180, v181
    v_mfma_f32_16x16x32_bf16 v[130:133], a[28:31], v[138:141], v[130:133]
    s_add_u32 m0, s28, 8192
    v_pk_fma_f16 v193, v125, v125, v193
    v_cvt_pk_f16_f32 v178, v202, v203
    v_mfma_f32_16x16x32_bf16 v[130:133], a[32:35], v[186:189], v[130:133]
    v_pk_mul_f16 v190, v178, v178
    v_cvt_pk_f16_f32 v179, v204, v205
    v_mfma_f32_16x16x32_bf16 v[130:133], a[36:39], v[162:165], v[130:133]
    v_pk_mul_f16 v192, v179, v179
    v_mfma_f32_16x16x32_bf16 v[130:133], a[40:43], v[134:137], v[130:133]
    v_mfma_f32_16x16x32_bf16 v[130:133], a[44:47], v[154:157], v[130:133]
    buffer_load_dwordx4 v12, s[8:11], 0 offen lds
    s_add_u32 m0, s28, 12288
    v_mfma_f32_16x16x32_bf16 v[202:205], a[48:51], v[146:149], 0
    s_xor_b32 s28, s28, 65536
    v_mfma_f32_16x16x32_bf16 v[202:205], a[52:55], v[138:141], v[202:205]
    ds_read_b128 v[166:169], v5 offset:0
    ds_read_b128 v[126:129], v5 offset:16
    v_mfma_f32_16x16x32_bf16 v[202:205], a[56:59], v[186:189], v[202:205]
    ds_read_b128 v[210:213], v5 offset:48
    ds_read_b32 v200, v6 offset:192
    v_mfma_f32_16x16x32_bf16 v[202:205], a[60:63], v[162:165], v[202:205]
    v_cvt_pk_f16_f32 v180, v130, v131
    v_pk_fma_f16 v190, v180, v180, v190
    v_mfma_f32_16x16x32_bf16 v[202:205], a[64:67], v[134:137], v[202:205]
    buffer_load_dwordx4 v13, s[8:11], 0 offen lds
    v_cvt_pk_f16_f32 v181, v132, v133
    v_mfma_f32_16x16x32_bf16 v[202:205], a[68:71], v[154:157], v[202:205]
    s_mov_b32 m0, s29
    v_pk_fma_f16 v192, v181, v181, v192
    v_add_u32 v5, 336, v5
    v_mfma_f32_16x16x32_bf16 v[130:133], v[146:149], a[144:147], 0
    s_xor_b32 s29, s29, s30
    s_add_u32 s19, s19, s20
    s_add_u32 s23, s23, s21
    v_mfma_f32_16x16x32_bf16 v[130:133], v[138:141], a[148:151], v[130:133]
    s_cmp_ge_u32 s19, 72
    v_cvt_pk_f16_f32 v122, v202, v203
    v_pk_fma_f16 v190, v122, v122, v190
    v_mfma_f32_16x16x32_bf16 v[130:133], v[186:189], a[152:155], v[130:133]
    s_cselect_b32 s34, 72, 0
    v_cvt_pk_f16_f32 v123, v204, v205
    v_pk_fma_f16 v192, v123, v123, v192
    v_mfma_f32_16x16x32_bf16 v[130:133], v[162:165], a[156:159], v[130:133]
    s_waitcnt lgkmcnt(2)
    buffer_store_dwordx2 v[198:199], v19, s[12:15], 0 offen
    s_cselect_b32 s35, s22, 0
    s_sub_u32 s19, s19, s34
    v_mfma_f32_16x16x32_f16 v[202:205], v[40:43], v[190:193], 0
    s_add_u32 s23, s23, s35
    s_add_u32 s18, s18, 1
    s_cmp_lt_u32 s18, s17
    v_mfma_f32_16x16x32_f16 v[214:217], v[166:169], v[158:161], v[24:27]
    s_waitcnt lgkmcnt(0)
    v_mfma_f32_16x16x32_f16 v[214:217], v[126:129], v[170:173], v[214:217]
    v_mfma_f32_16x16x32_f16 v[214:217], v[210:213], v[218:221], v[214:217]
    v_mfma_f32_16x16x32_f16 v[190:193], v[166:169], v[206:209], v[22:25]
    v_rsq_f32 v204, v202
    v_mfma_f32_16x16x32_f16 v[190:193], v[126:129], v[118:121], v[190:193]
    v_rsq_f32 v205, v203
    v_mfma_f32_16x16x32_f16 v[190:193], v[210:213], v[194:197], v[190:193]
    v_mul_f32 v204, s31, v204
    v_cvt_pk_f16_f32 v204, v204, v205
    v_mfma_f32_16x16x32_bf16 v[130:133], v[134:137], a[160:163], v[130:133]
    v_pk_mul_f16 v142, v142, v204 op_sel:[0,1] op_sel_hi:[1,1]
    v_pk_mul_f16 v143, v143, v204 op_sel:[0,1] op_sel_hi:[1,1]
    v_mfma_f32_16x16x32_bf16 v[130:133], v[154:157], a[164:167], v[130:133]
    v_pk_mul_f16 v144, v144, v204 op_sel:[0,1] op_sel_hi:[1,1]
    v_pk_mul_f16 v145, v145, v204 op_sel:[0,1] op_sel_hi:[1,1]
    v_mfma_f32_16x16x32_bf16 v[222:225], v[146:149], a[168:171], 0
    v_mov_b32_dpp v200, v191 quad_perm:[0,1,2,3] row_mask:0x1 bank_mask:0xf
    v_mov_b32_dpp v200, v215 quad_perm:[0,1,2,3] row_mask:0x2 bank_mask:0xf
    v_mfma_f32_16x16x32_bf16 v[222:225], v[138:141], a[172:175], v[222:225]
    v_pk_mul_f16 v124, v124, v204 op_sel:[0,1] op_sel_hi:[1,1]
    v_pk_mul_f16 v125, v125, v204 op_sel:[0,1] op_sel_hi:[1,1]
    v_mfma_f32_16x16x32_bf16 v[222:225], v[186:189], a[176:179], v[222:225]
    v_cvt_pk_bf16_f32 v130, v130, v131
    v_cvt_pk_bf16_f32 v131, v132, v133
    v_mfma_f32_16x16x32_bf16 v[222:225], v[162:165], a[180:183], v[222:225]
    v_pk_mul_f16 v178, v178, v204 op_sel:[0,0] op_sel_hi:[1,0]
    v_pk_mul_f16 v179, v179, v204 op_sel:[0,0] op_sel_hi:[1,0]
    v_mfma_f32_16x16x32_f16 v[226:229], v[118:121], v[206:209], v[46:49]
    v_pk_mul_f16 v180, v180, v204 op_sel:[0,0] op_sel_hi:[1,0]
    v_pk_mul_f16 v181, v181, v204 op_sel:[0,0] op_sel_hi:[1,0]
    v_mfma_f32_16x16x32_f16 v[230:233], v[170:173], v[206:209], v[50:53]
    v_pk_mul_f16 v122, v122, v204 op_sel:[0,0] op_sel_hi:[1,0]
    v_pk_mul_f16 v123, v123, v204 op_sel:[0,0] op_sel_hi:[1,0]
    v_mfma_f32_16x16x32_f16 v[234:237], v[142:145], v[206:209], v[54:57]
    v_min3_u32 v44, v44, v202, v203
    v_exp_f32 v214, v214
    v_mfma_f32_16x16x16_f16 v[226:229], v[196:197], v[194:195], v[226:229]
    v_max3_u32 v45, v45, v202, v203
    v_exp_f32 v190, v190
    v_mfma_f32_16x16x16_f16 v[230:233], v[220:221], v[194:195], v[230:233]
    v_cvt_pk_bf16_f32 v39, v190, 0
    v_mfma_f32_16x16x16_f16 v[234:237], v[124:125], v[194:195], v[234:237]
    buffer_store_dwordx4 v[150:153], v15, s[12:15], 0 offen
    v_mfma_f32_16x16x32_bf16 v[222:225], v[134:137], a[184:187], v[222:225]
    v_mfma_f32_16x16x32_bf16 v[222:225], v[154:157], a[188:191], v[222:225]
    ds_read_b128 v[206:209], v2 offset:0
    v_mfma_f32_16x16x32_bf16 v[150:153], v[146:149], a[192:195], 0
    ds_read_b128 v[146:149], v2 offset:1024
    v_mfma_f32_16x16x32_bf16 v[150:153], v[138:141], a[196:199], v[150:153]
    ds_read_b128 v[138:141], v2 offset:2048
    v_mfma_f32_16x16x32_bf16 v[150:153], v[186:189], a[200:203], v[150:153]
    ds_read_b128 v[186:189], v2 offset:3072
    v_mfma_f32_16x16x32_bf16 v[150:153], v[162:165], a[204:207], v[150:153]
    ds_read_b128 v[162:165], v2 offset:4096
    v_cvt_pk_bf16_f32 v222, v222, v223
    v_mfma_f32_16x16x32_bf16 v[150:153], v[134:137], a[208:211], v[150:153]
    ds_read_b128 v[134:137], v2 offset:5120
    v_cvt_pk_bf16_f32 v223, v224, v225
    v_mfma_f32_16x16x32_bf16 v[150:153], v[154:157], a[212:215], v[150:153]
    ds_read2_b32 v[132:133], v6 offset0:0 offset1:0
    ds_read2_b32 v[224:225], v6 offset0:16 offset1:16
    v_mfma_f32_16x16x32_f16 v[154:157], v[166:169], v[178:181], v[26:29]
    ds_read2_b32 v[168:169], v6 offset0:32 offset1:32
    v_add_u32 v6, 272, v6
    v_mfma_f32_16x16x32_f16 v[154:157], v[126:129], v[142:145], v[154:157]
    s_waitcnt lgkmcnt(8)
    v_exp_f32 v226, v226
    v_mfma_f32_16x16x32_f16 v[154:157], v[210:213], v[122:125], v[154:157]
    s_waitcnt lgkmcnt(7)
    v_cvt_pk_bf16_f32 v166, v150, v151
    v_cvt_pk_bf16_f32 v167, v152, v153
    v_mfma_f32_16x16x32_bf16 v[150:153], a[216:219], v[206:209], 0
    s_waitcnt lgkmcnt(6)
    v_exp_f32 v227, v227
    v_mfma_f32_16x16x32_bf16 v[150:153], a[220:223], v[146:149], v[150:153]
    s_waitcnt lgkmcnt(5)
    v_exp_f32 v154, v154
    v_mfma_f32_16x16x32_bf16 v[150:153], a[224:227], v[138:141], v[150:153]
    s_waitcnt lgkmcnt(4)
    v_mov_b32_dpp v200, v155 quad_perm:[0,1,2,3] row_mask:0x4 bank_mask:0xf
    v_cvt_pk_bf16_f32 v126, v226, v227
    v_mfma_f32_16x16x32_bf16 v[150:153], a[228:231], v[186:189], v[150:153]
    s_waitcnt lgkmcnt(3)
    v_exp_f32 v200, v200
    v_mfma_f32_16x16x32_bf16 v[150:153], a[232:235], v[162:165], v[150:153]
    s_waitcnt lgkmcnt(1)
    v_exp_f32 v228, v228
    v_mfma_f32_16x16x32_bf16 v[150:153], a[236:239], v[134:137], v[150:153]
    s_waitcnt lgkmcnt(0)
    buffer_store_dwordx2 v[254:255], v18, s[12:15], 0 offen
    v_exp_f32 v229, v229
    v_mfma_f32_16x16x32_bf16 v[190:193], a[240:243], v[206:209], 0
    v_cvt_pk_bf16_f32 v200, v200, v200
    v_cvt_pk_bf16_f32 v127, v228, v229
    v_mfma_f32_16x16x32_bf16 v[190:193], a[244:247], v[146:149], v[190:193]
    ds_write_b16 v8, v200
    v_mfma_f32_16x16x32_bf16 v[190:193], a[248:251], v[138:141], v[190:193]
    v_exp_f32 v230, v230
    v_mfma_f32_16x16x32_bf16 v[190:193], a[252:255], v[186:189], v[190:193]
    ds_read_b128 v[198:201], v2 offset:6144
    ds_read_b128 v[210:213], v9
    v_mfma_f32_16x16x32_bf16 v[190:193], v[82:85], v[162:165], v[190:193]
    ds_read_b128 v[226:229], v2 offset:7168
    ds_read_b128 v[238:241], v9 offset:64
    v_mfma_f32_16x16x32_bf16 v[190:193], v[86:89], v[134:137], v[190:193]
    v_exp_f32 v231, v231
    v_mfma_f32_16x16x32_bf16 v[202:205], v[90:93], v[206:209], 0
    ds_read_b128 v[206:209], v2 offset:8192
    ds_read_b128 v[242:245], v2 offset:9216
    v_mfma_f32_16x16x32_bf16 v[202:205], v[94:97], v[146:149], v[202:205]
    v_cvt_pk_bf16_f32 v128, v230, v231
    v_fma_f32 v254, v150, v150, s33
    v_mfma_f32_16x16x32_bf16 v[202:205], v[98:101], v[138:141], v[202:205]
    ds_read_b128 v[146:149], v2 offset:10240
    ds_read_b128 v[138:141], v2 offset:11264
    v_mfma_f32_16x16x32_bf16 v[202:205], v[102:105], v[186:189], v[202:205]
    v_exp_f32 v232, v232
    v_mfma_f32_16x16x32_bf16 v[202:205], v[106:109], v[162:165], v[202:205]
    v_exp_f32 v233, v233
    v_mfma_f32_16x16x32_bf16 v[202:205], v[110:113], v[134:137], v[202:205]
    s_waitcnt lgkmcnt(6)
    v_cvt_pk_bf16_f32 v129, v232, v233
    v_fmac_f32 v254, v151, v151
    v_mfma_f32_16x16x32_bf16 v[186:189], v[210:213], v[28:31], 0
    s_waitcnt lgkmcnt(4)
    v_exp_f32 v234, v234
    v_mfma_f32_16x16x32_bf16 v[186:189], v[238:241], v[28:31], v[186:189]
    v_exp_f32 v235, v235
    v_mfma_f32_16x16x32_f16 v[134:137], v[118:121], v[158:161], v[58:61]
    s_waitcnt lgkmcnt(2)
    v_cvt_pk_bf16_f32 v36, v234, v235
    v_fmac_f32 v254, v152, v152
    v_mfma_f32_16x16x32_f16 v[162:165], v[170:173], v[158:161], v[62:65]
    v_exp_f32 v236, v236
    v_mfma_f32_16x16x32_f16 v[230:233], v[142:145], v[158:161], v[66:69]
    s_waitcnt lgkmcnt(0)
    buffer_load_dwordx4 v14, s[8:11], 0 offen lds
    v_rcp_f32 v186, v186
    v_mfma_f32_16x16x16_f16 v[134:137], v[196:197], v[218:219], v[134:137]
    v_exp_f32 v237, v237
    v_fmac_f32 v254, v153, v153
    v_mfma_f32_16x16x16_f16 v[162:165], v[220:221], v[218:219], v[162:165]
    v_cvt_pk_bf16_f32 v37, v236, v237
    v_fmac_f32 v254, v190, v190
    v_fmac_f32 v254, v191, v191
    v_mfma_f32_16x16x16_f16 v[230:233], v[124:125], v[218:219], v[230:233]
    v_fmac_f32 v254, v192, v192
    v_exp_f32 v134, v134
    v_fmac_f32 v254, v193, v193
    v_mfma_f32_16x16x32_bf16 v[158:161], v[210:213], v[174:177], 0
    v_exp_f32 v135, v135
    v_mfma_f32_16x16x32_bf16 v[158:161], v[238:241], v[130:133], v[158:161]
    v_cvt_pk_bf16_f32 v134, v134, v135
    v_fmac_f32 v254, v202, v202
    v_mfma_f32_16x16x32_bf16 v[234:237], v[210:213], v[182:185], 0
    v_exp_f32 v136, v136
    v_mfma_f32_16x16x32_bf16 v[234:237], v[238:241], v[222:225], v[234:237]
    v_exp_f32 v137, v137
    v_mfma_f32_16x16x32_bf16 v[246:249], v[210:213], v[114:117], 0
    v_cvt_pk_bf16_f32 v135, v136, v137
    v_mul_f32 v158, v158, v186
    v_mfma_f32_16x16x32_bf16 v[246:249], v[238:241], v[166:169], v[246:249]
    v_exp_f32 v162, v162
    v_mfma_f32_16x16x32_bf16 v[210:213], v[28:31], v[36:39], 0
    v_exp_f32 v163, v163
    v_mfma_f32_16x16x32_bf16 v[210:213], v[28:31], v[126:129], v[210:213]
    v_cvt_pk_bf16_f32 v136, v162, v163
    v_mul_f32_dpp v158, v234, v186 quad_perm:[0,1,2,3] row_mask:0x2 bank_mask:0xf
    v_mfma_f32_16x16x32_bf16 v[234:237], v[130:133], v[36:39], 0
    v_exp_f32 v164, v164
    v_mfma_f32_16x16x32_bf16 v[234:237], v[174:177], v[126:129], v[234:237]
    v_exp_f32 v165, v165
    v_mfma_f32_16x16x32_bf16 v[238:241], v[222:225], v[36:39], 0
    v_cvt_pk_bf16_f32 v137, v164, v165
    v_mul_f32_dpp v158, v246, v186 quad_perm:[0,1,2,3] row_mask:0x4 bank_mask:0xf
    v_mfma_f32_16x16x32_bf16 v[238:241], v[182:185], v[126:129], v[238:241]
    v_exp_f32 v230, v230
    v_mfma_f32_16x16x32_bf16 v[186:189], v[166:169], v[36:39], 0
    v_exp_f32 v231, v231
    v_mfma_f32_16x16x32_bf16 v[186:189], v[114:117], v[126:129], v[186:189]
    v_cvt_pk_bf16_f32 v36, v230, v231
    v_cvt_pk_bf16_f32 v39, v214, 0
    v_mfma_f32_16x16x32_f16 v[162:165], v[118:121], v[178:181], v[70:73]
    v_exp_f32 v232, v232
    v_mfma_f32_16x16x32_f16 v[118:121], v[170:173], v[178:181], v[74:77]
    v_exp_f32 v233, v233
    v_mfma_f32_16x16x32_f16 v[170:173], v[142:145], v[178:181], v[78:81]
    v_cvt_pk_bf16_f32 v37, v232, v233
    v_cvt_pk_bf16_f32 v158, v158, v158
    v_fmac_f32 v254, v203, v203
    v_mfma_f32_16x16x16_f16 v[162:165], v[196:197], v[122:123], v[162:165]
    v_rcp_f32 v210, v210
    v_fmac_f32 v254, v204, v204
    v_mfma_f32_16x16x16_f16 v[118:121], v[220:221], v[122:123], v[118:121]
    v_mul_f32 v234, v210, v234
    v_mul_f32 v235, v210, v235
    v_cvt_pk_bf16_f32 v178, v234, v235
    v_mfma_f32_16x16x16_f16 v[170:173], v[124:125], v[122:123], v[170:173]
    v_mul_f32 v236, v210, v236
    v_exp_f32 v162, v162
    v_mul_f32 v237, v210, v237
    v_mfma_f32_16x16x32_bf16 v[194:197], v[28:31], v[36:39], 0
    ds_write_b16 v7, v158
    v_mfma_f32_16x16x32_bf16 v[194:197], v[28:31], v[134:137], v[194:197]
    v_exp_f32 v163, v163
    v_mfma_f32_16x16x32_bf16 v[122:125], v[130:133], v[36:39], 0
    v_cvt_pk_bf16_f32 v162, v162, v163
    v_cvt_pk_bf16_f32 v179, v236, v237
    v_mfma_f32_16x16x32_bf16 v[122:125], v[174:177], v[134:137], v[122:125]
    v_exp_f32 v164, v164
    v_mfma_f32_16x16x32_bf16 v[126:129], v[222:225], v[36:39], 0
    v_exp_f32 v165, v165
    v_mfma_f32_16x16x32_bf16 v[126:129], v[182:185], v[134:137], v[126:129]
    v_cvt_pk_bf16_f32 v163, v164, v165
    v_mul_f32 v238, v210, v238
    v_mfma_f32_16x16x32_bf16 v[218:221], v[166:169], v[36:39], 0
    v_exp_f32 v118, v118
    v_mfma_f32_16x16x32_bf16 v[218:221], v[114:117], v[134:137], v[218:221]
    v_exp_f32 v119, v119
    v_mfma_f32_16x16x32_bf16 v[142:145], a[216:219], v[198:201], 0
    v_cvt_pk_bf16_f32 v164, v118, v119
    v_cvt_pk_bf16_f32 v39, v154, 0
    v_mfma_f32_16x16x32_bf16 v[142:145], a[220:223], v[226:229], v[142:145]
    v_exp_f32 v120, v120
    v_mfma_f32_16x16x32_bf16 v[142:145], a[224:227], v[206:209], v[142:145]
    v_exp_f32 v121, v121
    v_mfma_f32_16x16x32_bf16 v[142:145], a[228:231], v[242:245], v[142:145]
    v_cvt_pk_bf16_f32 v165, v120, v121
    v_mul_f32 v239, v210, v239
    v_mfma_f32_16x16x32_bf16 v[142:145], a[232:235], v[146:149], v[142:145]
    v_exp_f32 v170, v170
    v_mfma_f32_16x16x32_bf16 v[142:145], a[236:239], v[138:141], v[142:145]
    v_exp_f32 v171, v171
    v_mfma_f32_16x16x32_bf16 v[158:161], a[240:243], v[198:201], 0
    v_cvt_pk_bf16_f32 v36, v170, v171
    v_cvt_pk_bf16_f32 v180, v238, v239
    v_mfma_f32_16x16x32_bf16 v[158:161], a[244:247], v[226:229], v[158:161]
    v_exp_f32 v172, v172
    v_mfma_f32_16x16x32_bf16 v[158:161], a[248:251], v[206:209], v[158:161]
    v_exp_f32 v173, v173
    v_mfma_f32_16x16x32_bf16 v[158:161], a[252:255], v[242:245], v[158:161]
    ds_read_b128 v[118:121], v2 offset:12288
    v_cvt_pk_bf16_f32 v37, v172, v173
    v_mfma_f32_16x16x32_bf16 v[158:161], v[82:85], v[146:149], v[158:161]
    ds_read_b128 v[134:137], v2 offset:13312
    v_mul_f32 v240, v210, v240
    v_mfma_f32_16x16x32_bf16 v[170:173], v[28:31], v[36:39], 0
    v_mul_f32 v241, v210, v241
    v_cvt_pk_bf16_f32 v181, v240, v241
    v_mfma_f32_16x16x32_bf16 v[170:173], v[28:31], v[162:165], v[170:173]
    ds_write_b128 v3, v[178:181] offset:0
    v_mfma_f32_16x16x32_bf16 v[154:157], v[130:133], v[36:39], 0
    v_mul_f32 v186, v210, v186
    v_mul_f32 v187, v210, v187
    v_mfma_f32_16x16x32_bf16 v[154:157], v[174:177], v[162:165], v[154:157]
    v_cvt_pk_bf16_f32 v186, v186, v187
    v_mul_f32 v188, v210, v188
    v_mfma_f32_16x16x32_bf16 v[130:133], v[222:225], v[36:39], 0
    v_mul_f32 v189, v210, v189
    v_cvt_pk_bf16_f32 v187, v188, v189
    v_mfma_f32_16x16x32_bf16 v[130:133], v[182:185], v[162:165], v[130:133]
    s_waitcnt lgkmcnt(2)
    ds_write_b64 v4, v[186:187] offset:4096
    v_mfma_f32_16x16x32_bf16 v[174:177], v[166:169], v[36:39], 0
    s_waitcnt lgkmcnt(2)
    v_fma_f32 v255, v142, v142, s33
    v_fmac_f32 v255, v143, v143
    v_mfma_f32_16x16x32_bf16 v[174:177], v[114:117], v[162:165], v[174:177]
    v_fmac_f32 v255, v144, v144
    v_fmac_f32 v255, v145, v145
    v_mfma_f32_16x16x32_bf16 v[158:161], v[86:89], v[138:141], v[158:161]
    ds_read_b128 v[114:117], v2 offset:14336
    v_fmac_f32 v254, v205, v205
    v_mfma_f32_16x16x32_bf16 v[178:181], v[90:93], v[198:201], 0
    ds_read_b128 v[166:169], v2 offset:15360
    v_add_u32 v7, 16, v7
    v_mfma_f32_16x16x32_bf16 v[178:181], v[94:97], v[226:229], v[178:181]
    ds_read_b128 v[162:165], v2 offset:16384
    v_mfma_f32_16x16x32_bf16 v[178:181], v[98:101], v[206:209], v[178:181]
    ds_read_b128 v[206:209], v2 offset:17408
    v_fmac_f32 v255, v158, v158
    v_mfma_f32_16x16x32_bf16 v[178:181], v[102:105], v[242:245], v[178:181]
    v_fmac_f32 v255, v159, v159
    v_fmac_f32 v255, v160, v160
    v_mfma_f32_16x16x32_bf16 v[178:181], v[106:109], v[146:149], v[178:181]
    v_fmac_f32 v255, v161, v161
    v_xor_b32 v2, 65536, v2
    v_mfma_f32_16x16x32_bf16 v[178:181], v[110:113], v[138:141], v[178:181]
    v_rcp_f32 v170, v170
    v_mfma_f32_16x16x32_bf16 v[146:149], a[216:219], v[118:121], 0
    v_mul_f32 v154, v170, v154
    v_mul_f32 v155, v170, v155
    v_mfma_f32_16x16x32_bf16 v[146:149], a[220:223], v[134:137], v[146:149]
    s_waitcnt lgkmcnt(3)
    ds_read_b128 v[182:185], v0 offset:20480
    v_cvt_pk_bf16_f32 v154, v154, v155
    v_mfma_f32_16x16x32_bf16 v[146:149], a[224:227], v[114:117], v[146:149]
    s_waitcnt lgkmcnt(3)
    ds_read_b128 v[198:201], v1 offset:20480
    v_fmac_f32 v255, v178, v178
    v_mfma_f32_16x16x32_bf16 v[146:149], a[228:231], v[166:169], v[146:149]
    s_waitcnt lgkmcnt(3)
    ds_read_b128 v[210:213], v0 offset:20608
    v_fmac_f32 v255, v179, v179
    v_mfma_f32_16x16x32_bf16 v[146:149], a[232:235], v[162:165], v[146:149]
    s_waitcnt lgkmcnt(3)
    ds_read_b128 v[222:225], v1 offset:20608
    v_fmac_f32 v255, v180, v180
    v_mfma_f32_16x16x32_bf16 v[146:149], a[236:239], v[206:209], v[146:149]
    ds_read_b128 v[226:229], v0 offset:20736
    v_fmac_f32 v255, v181, v181
    v_mfma_f32_16x16x32_bf16 v[138:141], a[240:243], v[118:121], 0
    ds_read_b128 v[242:245], v1 offset:20736
    v_cvt_pk_bf16_f32 v254, v254, v255
    v_mfma_f32_16x16x32_bf16 v[138:141], a[244:247], v[134:137], v[138:141]
    v_mul_f32 v156, v170, v156
    v_mul_f32 v157, v170, v157
    v_mfma_f32_16x16x32_bf16 v[138:141], a[248:251], v[114:117], v[138:141]
    v_fma_f32 v255, v146, v146, s33
    v_fmac_f32 v255, v147, v147
    v_mfma_f32_16x16x32_bf16 v[138:141], a[252:255], v[166:169], v[138:141]
    s_waitcnt lgkmcnt(5)
    v_fmac_f32 v255, v148, v148
    v_fmac_f32 v255, v149, v149
    v_mfma_f32_16x16x32_bf16 v[138:141], v[82:85], v[162:165], v[138:141]
    s_waitcnt lgkmcnt(4)
    v_cvt_pk_bf16_f32 v155, v156, v157
    v_mul_f32 v130, v170, v130
    v_mfma_f32_16x16x32_bf16 v[138:141], v[86:89], v[206:209], v[138:141]
    s_waitcnt lgkmcnt(3)
    v_mul_f32 v131, v170, v131
    v_cvt_pk_bf16_f32 v156, v130, v131
    v_mfma_f32_16x16x32_bf16 v[186:189], v[90:93], v[118:121], 0
    s_waitcnt lgkmcnt(2)
    v_mul_f32 v132, v170, v132
    v_mul_f32 v133, v170, v133
    v_mfma_f32_16x16x32_bf16 v[186:189], v[94:97], v[134:137], v[186:189]
    s_waitcnt lgkmcnt(1)
    v_fmac_f32 v255, v138, v138
    v_fmac_f32 v255, v139, v139
    v_mfma_f32_16x16x32_bf16 v[186:189], v[98:101], v[114:117], v[186:189]
    s_waitcnt lgkmcnt(0)
    v_fmac_f32 v255, v140, v140
    v_fmac_f32 v255, v141, v141
    v_mfma_f32_16x16x32_bf16 v[186:189], v[102:105], v[166:169], v[186:189]
    v_cvt_pk_bf16_f32 v157, v132, v133
    v_mul_f32 v174, v170, v174
    v_mfma_f32_16x16x32_bf16 v[186:189], v[106:109], v[162:165], v[186:189]
    ds_write_b128 v3, v[154:157] offset:12288
    v_mfma_f32_16x16x32_bf16 v[186:189], v[110:113], v[206:209], v[186:189]
    v_mul_f32 v175, v170, v175
    v_cvt_pk_bf16_f32 v174, v174, v175
    v_mfma_f32_16x16x32_bf16 v[118:121], a[72:75], v[182:185], 0
    v_mul_f32 v176, v170, v176
    v_mul_f32 v177, v170, v177
    v_mfma_f32_16x16x32_bf16 v[118:121], a[76:79], v[198:201], v[118:121]
    v_rcp_f32 v194, v194
    v_mfma_f32_16x16x32_bf16 v[118:121], a[80:83], v[210:213], v[118:121]
    v_fmac_f32 v255, v186, v186
    v_fmac_f32 v255, v187, v187
    v_mfma_f32_16x16x32_bf16 v[118:121], a[84:87], v[222:225], v[118:121]
    v_fmac_f32 v255, v188, v188
    v_fmac_f32 v255, v189, v189
    v_mfma_f32_16x16x32_bf16 v[118:121], a[88:91], v[226:229], v[118:121]
    v_cvt_pk_bf16_f32 v255, v255, v255
    v_cvt_pk_bf16_f32 v175, v176, v177
    v_mfma_f32_16x16x32_bf16 v[118:121], a[92:95], v[242:245], v[118:121]
    ds_write_b64 v4, v[174:175] offset:16384
    v_mfma_f32_16x16x32_bf16 v[206:209], a[96:99], v[182:185], 0
    v_mul_f32 v122, v194, v122
    v_mul_f32 v123, v194, v123
    v_mfma_f32_16x16x32_bf16 v[206:209], a[100:103], v[198:201], v[206:209]
    ds_write_b64 v4, v[254:255] offset:18432
    v_mfma_f32_16x16x32_bf16 v[206:209], a[104:107], v[210:213], v[206:209]
    v_cvt_pk_bf16_f32 v134, v122, v123
    v_cvt_pk_f16_f32 v118, v118, v119
    v_mfma_f32_16x16x32_bf16 v[206:209], a[108:111], v[222:225], v[206:209]
    v_pk_mul_f16 v163, v118, v118
    v_cvt_pk_f16_f32 v119, v120, v121
    v_mfma_f32_16x16x32_bf16 v[206:209], a[112:115], v[226:229], v[206:209]
    v_pk_mul_f16 v165, v119, v119
    v_mul_f32 v124, v194, v124
    v_mfma_f32_16x16x32_bf16 v[206:209], a[116:119], v[242:245], v[206:209]
    v_mul_f32 v125, v194, v125
    v_cvt_pk_bf16_f32 v135, v124, v125
    v_mfma_f32_16x16x32_bf16 v[122:125], a[120:123], v[182:185], 0
    v_mul_f32 v126, v194, v126
    v_mul_f32 v127, v194, v127
    v_mfma_f32_16x16x32_bf16 v[122:125], a[124:127], v[198:201], v[122:125]
    v_cvt_pk_bf16_f32 v136, v126, v127
    v_mul_f32 v128, v194, v128
    v_mfma_f32_16x16x32_bf16 v[122:125], a[128:131], v[210:213], v[122:125]
    v_cvt_pk_f16_f32 v120, v206, v207
    v_pk_fma_f16 v163, v120, v120, v163
    v_mfma_f32_16x16x32_bf16 v[122:125], a[132:135], v[222:225], v[122:125]
    v_cvt_pk_f16_f32 v121, v208, v209
    v_pk_fma_f16 v165, v121, v121, v165
    v_mfma_f32_16x16x32_bf16 v[122:125], a[136:139], v[226:229], v[122:125]
    v_mul_f32 v129, v194, v129
    v_cvt_pk_bf16_f32 v137, v128, v129
    v_mfma_f32_16x16x32_bf16 v[122:125], a[140:143], v[242:245], v[122:125]
    ds_write_b128 v3, v[134:137] offset:6144
    v_mfma_f32_16x16x32_bf16 v[206:209], a[0:3], v[182:185], 0
    v_mul_f32 v218, v194, v218
    v_mul_f32 v219, v194, v219
    v_mfma_f32_16x16x32_bf16 v[206:209], a[4:7], v[198:201], v[206:209]
    v_cvt_pk_bf16_f32 v254, v218, v219
    v_mul_f32 v220, v194, v220
    v_mfma_f32_16x16x32_bf16 v[206:209], a[8:11], v[210:213], v[206:209]
    v_cvt_pk_f16_f32 v196, v122, v123
    v_pk_fma_f16 v163, v196, v196, v163
    v_mfma_f32_16x16x32_bf16 v[206:209], a[12:15], v[222:225], v[206:209]
    v_cvt_pk_f16_f32 v197, v124, v125
    v_pk_fma_f16 v165, v197, v197, v165
    v_mfma_f32_16x16x32_bf16 v[206:209], a[16:19], v[226:229], v[206:209]
    v_mul_f32 v221, v194, v221
    v_cvt_pk_bf16_f32 v255, v220, v221
    v_mfma_f32_16x16x32_bf16 v[206:209], a[20:23], v[242:245], v[206:209]
    ds_write_b64 v4, v[254:255] offset:10240
    v_mfma_f32_16x16x32_bf16 v[174:177], a[24:27], v[182:185], 0
    v_xor_b32 v3, 65536, v3
    v_xor_b32 v4, 65536, v4
    v_mfma_f32_16x16x32_bf16 v[174:177], a[28:31], v[198:201], v[174:177]
    v_mfma_f32_16x16x32_bf16 v[174:177], a[32:35], v[210:213], v[174:177]
    v_mfma_f32_16x16x32_bf16 v[174:177], a[36:39], v[222:225], v[174:177]
    v_mfma_f32_16x16x32_bf16 v[174:177], a[40:43], v[226:229], v[174:177]
    v_cvt_pk_f16_f32 v206, v206, v207
    v_mfma_f32_16x16x32_bf16 v[174:177], a[44:47], v[242:245], v[174:177]
    v_mfma_f32_16x16x32_bf16 v[218:221], a[48:51], v[182:185], 0
    s_waitcnt lgkmcnt(0)
    v_mfma_f32_16x16x32_bf16 v[218:221], a[52:55], v[198:201], v[218:221]
    s_nop 0
    v_mfma_f32_16x16x32_bf16 v[218:221], a[56:59], v[210:213], v[218:221]
    s_nop 0
    v_mfma_f32_16x16x32_bf16 v[218:221], a[60:63], v[222:225], v[218:221]
    s_barrier
    v_mfma_f32_16x16x32_bf16 v[218:221], a[64:67], v[226:229], v[218:221]
    s_nop 0
    v_mfma_f32_16x16x32_bf16 v[218:221], a[68:71], v[242:245], v[218:221]
    v_mfma_f32_16x16x32_bf16 v[170:173], v[182:185], a[144:147], 0
    v_mfma_f32_16x16x32_bf16 v[170:173], v[198:201], a[148:151], v[170:173]
    v_mfma_f32_16x16x32_bf16 v[170:173], v[210:213], a[152:155], v[170:173]
    v_mfma_f32_16x16x32_bf16 v[170:173], v[222:225], a[156:159], v[170:173]
    v_mfma_f32_16x16x32_bf16 v[170:173], v[226:229], a[160:163], v[170:173]
    v_mfma_f32_16x16x32_bf16 v[170:173], v[242:245], a[164:167], v[170:173]
    s_cbranch_scc1 L_loop_fast2
    s_branch L_drain
.p2align 6
L_loop_fast3:
    v_mfma_f32_16x16x32_bf16 v[234:237], v[182:185], a[168:171], 0
    s_add_u32 s12, s42, s27
    ds_read_b128 v[230:233], v2 offset:18432
    ds_read_b128 v[238:241], v2 offset:19456
    v_mfma_f32_16x16x32_bf16 v[234:237], v[198:201], a[172:175], v[234:237]
    s_addc_u32 s13, s43, 0
    v_pk_mul_f16 v162, v206, v206
    v_cvt_pk_f16_f32 v207, v208, v209
    v_mfma_f32_16x16x32_bf16 v[234:237], v[210:213], a[176:179], v[234:237]
    s_sub_u32 s14, s36, s27
    ds_read_b128 v[134:137], v0 offset:26624
    v_pk_mul_f16 v164, v207, v207
    v_mfma_f32_16x16x32_bf16 v[234:237], v[222:225], a[180:183], v[234:237]
    s_cmp_ge_u32 s18, 2
    ds_read_b128 v[154:157], v1 offset:26624
    v_cvt_pk_f16_f32 v208, v174, v175
    v_mfma_f32_16x16x32_bf16 v[234:237], v[226:229], a[184:187], v[234:237]
    s_cselect_b32 s14, s14, 0
    ds_read_b128 v[130:133], v0 offset:26752
    v_pk_fma_f16 v162, v208, v208, v162
    v_mfma_f32_16x16x32_bf16 v[234:237], v[242:245], a[188:191], v[234:237]
    s_add_u32 s34, s18, 2
    ds_read_b128 v[122:125], v1 offset:26752
    v_cvt_pk_f16_f32 v209, v176, v177
    v_mfma_f32_16x16x32_bf16 v[114:117], v[182:185], a[192:195], 0
    s_add_u32 s8, s40, s23
    ds_read_b128 v[126:129], v0 offset:26880
    v_pk_fma_f16 v164, v209, v209, v164
    v_mfma_f32_16x16x32_bf16 v[114:117], v[198:201], a[196:199], v[114:117]
    s_addc_u32 s9, s41, 0
    ds_read_b128 v[166:169], v1 offset:26880
    v_cvt_pk_f16_f32 v194, v218, v219
    v_mfma_f32_16x16x32_bf16 v[114:117], v[210:213], a[200:203], v[114:117]
    s_waitcnt lgkmcnt(6)
    v_pk_fma_f16 v162, v194, v194, v162
    v_cvt_pk_f16_f32 v195, v220, v221
    v_mfma_f32_16x16x32_bf16 v[198:201], v[32:35], v[230:233], 0
    s_sub_u32 s10, s36, s23
    v_pk_fma_f16 v164, v195, v195, v164
    v_cvt_pk_bf16_f32 v174, v170, v171
    v_mfma_f32_16x16x32_bf16 v[198:201], v[32:35], v[238:241], v[198:201]
    s_waitcnt lgkmcnt(5)
    v_cvt_pk_bf16_f32 v175, v172, v173
    v_cvt_pk_bf16_f32 v182, v234, v235
    v_mfma_f32_16x16x32_f16 v[170:173], v[40:43], v[162:165], 0
    s_cmp_lt_u32 s34, s17
    v_cvt_pk_bf16_f32 v183, v236, v237
    s_cselect_b32 s10, s10, 0
    v_mfma_f32_16x16x32_bf16 v[114:117], v[222:225], a[204:207], v[114:117]
    s_add_u32 m0, s28, 0
    v_mul_f32 v255, 0x3baaaaab, v198
    v_mul_f32 v254, 0x3baaaaab, v199
    v_mfma_f32_16x16x32_bf16 v[114:117], v[226:229], a[208:211], v[114:117]
    s_mov_b32 s27, s26
    v_rsq_f32 v172, v170
    v_mfma_f32_16x16x32_bf16 v[114:117], v[242:245], a[212:215], v[114:117]
    s_mov_b32 s26, s25
    v_rsq_f32 v173, v171
    v_mfma_f32_16x16x32_bf16 v[162:165], a[72:75], v[134:137], 0
    s_waitcnt lgkmcnt(0)
    v_mul_f32 v172, s31, v172
    v_cvt_pk_f16_f32 v172, v172, v173
    v_mfma_f32_16x16x32_bf16 v[162:165], a[76:79], v[154:157], v[162:165]
    s_mov_b32 s25, s24
    v_cvt_pk_bf16_f32 v114, v114, v115
    v_cvt_pk_bf16_f32 v115, v116, v117
    v_mfma_f32_16x16x32_bf16 v[162:165], a[80:83], v[130:133], v[162:165]
    s_mov_b32 s24, s23
    v_pk_mul_f16 v118, v118, v172 op_sel:[0,1] op_sel_hi:[1,1]
    v_pk_mul_f16 v119, v119, v172 op_sel:[0,1] op_sel_hi:[1,1]
    v_mfma_f32_16x16x32_bf16 v[162:165], a[84:87], v[122:125], v[162:165]
    v_pk_mul_f16 v120, v120, v172 op_sel:[0,1] op_sel_hi:[1,1]
    v_pk_mul_f16 v121, v121, v172 op_sel:[0,1] op_sel_hi:[1,1]
    v_mfma_f32_16x16x32_bf16 v[162:165], a[88:91], v[126:129], v[162:165]
    v_pk_mul_f16 v196, v196, v172 op_sel:[0,1] op_sel_hi:[1,1]
    v_pk_mul_f16 v197, v197, v172 op_sel:[0,1] op_sel_hi:[1,1]
    v_mfma_f32_16x16x32_bf16 v[162:165], a[92:95], v[166:169], v[162:165]
    v_pk_mul_f16 v206, v206, v172 op_sel:[0,0] op_sel_hi:[1,0]
    v_pk_mul_f16 v207, v207, v172 op_sel:[0,0] op_sel_hi:[1,0]
    v_mfma_f32_16x16x32_bf16 v[210:213], a[96:99], v[134:137], 0
    v_pk_mul_f16 v208, v208, v172 op_sel:[0,0] op_sel_hi:[1,0]
    v_pk_mul_f16 v209, v209, v172 op_sel:[0,0] op_sel_hi:[1,0]
    v_mfma_f32_16x16x32_bf16 v[210:213], a[100:103], v[154:157], v[210:213]
    v_pk_mul_f16 v194, v194, v172 op_sel:[0,0] op_sel_hi:[1,0]
    v_pk_mul_f16 v195, v195, v172 op_sel:[0,0] op_sel_hi:[1,0]
    v_mfma_f32_16x16x32_bf16 v[210:213], a[104:107], v[130:133], v[210:213]
    v_min3_u32 v44, v44, v170, v171
    v_max3_u32 v45, v45, v170, v171
    v_mfma_f32_16x16x32_bf16 v[210:213], a[108:111], v[122:125], v[210:213]
    v_cvt_pk_f16_f32 v170, v162, v163
    v_pk_mul_f16 v163, v170, v170
    v_mfma_f32_16x16x32_bf16 v[210:213], a[112:115], v[126:129], v[210:213]
    v_cvt_pk_f16_f32 v171, v164, v165
    v_pk_mul_f16 v165, v171, v171
    v_mfma_f32_16x16x32_bf16 v[210:213], a[116:119], v[166:169], v[210:213]
    v_rsq_f32 v255, v255
    v_mfma_f32_16x16x32_bf16 v[214:217], a[120:123], v[134:137], 0
    v_rsq_f32 v254, v254
    v_mfma_f32_16x16x32_bf16 v[214:217], a[124:127], v[154:157], v[214:217]
    v_mul_f32 v142, v254, v142
    v_mul_f32 v143, v254, v143
    v_mfma_f32_16x16x32_bf16 v[214:217], a[128:131], v[130:133], v[214:217]
    v_cvt_pk_bf16_f32 v142, v142, v143
    v_cvt_pk_f16_f32 v172, v210, v211
    v_mfma_f32_16x16x32_bf16 v[214:217], a[132:135], v[122:125], v[214:217]
    v_pk_fma_f16 v163, v172, v172, v163
    v_cvt_pk_f16_f32 v173, v212, v213
    v_mfma_f32_16x16x32_bf16 v[214:217], a[136:139], v[126:129], v[214:217]
    v_pk_fma_f16 v165, v173, v173, v165
    v_mul_f32 v144, v254, v144
    v_mfma_f32_16x16x32_bf16 v[214:217], a[140:143], v[166:169], v[214:217]
    v_mul_f32 v145, v254, v145
    v_cvt_pk_bf16_f32 v143, v144, v145
    v_mfma_f32_16x16x32_bf16 v[210:213], a[0:3], v[134:137], 0
    v_mul_f32 v158, v254, v158
    v_mul_f32 v159, v254, v159
    v_mfma_f32_16x16x32_bf16 v[210:213], a[4:7], v[154:157], v[210:213]
    v_cvt_pk_bf16_f32 v144, v158, v159
    v_mul_f32 v160, v254, v160
    v_mfma_f32_16x16x32_bf16 v[210:213], a[8:11], v[130:133], v[210:213]
    v_cvt_pk_f16_f32 v220, v214, v215
    v_pk_fma_f16 v163, v220, v220, v163
    v_mfma_f32_16x16x32_bf16 v[210:213], a[12:15], v[122:125], v[210:213]
    v_cvt_pk_f16_f32 v221, v216, v217
    v_pk_fma_f16 v165, v221, v221, v165
    v_mfma_f32_16x16x32_bf16 v[210:213], a[16:19], v[126:129], v[210:213]
    v_mul_f32 v161, v254, v161
    v_cvt_pk_bf16_f32 v145, v160, v161
    v_mfma_f32_16x16x32_bf16 v[210:213], a[20:23], v[166:169], v[210:213]
    buffer_store_dwordx4 v[142:145], v16, s[12:15], 0 offen
    v_mul_f32 v178, v254, v178
    v_mul_f32 v179, v254, v179
    v_cvt_pk_bf16_f32 v198, v178, v179
    v_mul_f32 v180, v254, v180
    v_mfma_f32_16x16x32_bf16 v[142:145], a[24:27], v[134:137], 0
    v_mul_f32 v181, v254, v181
    v_cvt_pk_bf16_f32 v199, v180, v181
    v_mfma_f32_16x16x32_bf16 v[142:145], a[28:31], v[154:157], v[142:145]
    v_cvt_pk_f16_f32 v158, v210, v211
    v_pk_mul_f16 v162, v158, v158
    v_mfma_f32_16x16x32_bf16 v[142:145], a[32:35], v[130:133], v[142:145]
    v_cvt_pk_f16_f32 v159, v212, v213
    v_pk_mul_f16 v164, v159, v159
    v_mfma_f32_16x16x32_bf16 v[142:145], a[36:39], v[122:125], v[142:145]
    v_mul_f32 v254, 0x3baaaaab, v200
    v_mul_f32 v150, v255, v150
    v_mfma_f32_16x16x32_bf16 v[142:145], a[40:43], v[126:129], v[142:145]
    v_rsq_f32 v254, v254
    v_mfma_f32_16x16x32_bf16 v[142:145], a[44:47], v[166:169], v[142:145]
    v_mul_f32 v146, v254, v146
    v_mul_f32 v147, v254, v147
    v_mfma_f32_16x16x32_bf16 v[178:181], a[48:51], v[134:137], 0
    v_cvt_pk_bf16_f32 v146, v146, v147
    v_mul_f32 v148, v254, v148
    v_mfma_f32_16x16x32_bf16 v[178:181], a[52:55], v[154:157], v[178:181]
    v_mul_f32 v149, v254, v149
    v_cvt_pk_bf16_f32 v147, v148, v149
    v_mfma_f32_16x16x32_bf16 v[178:181], a[56:59], v[130:133], v[178:181]
    v_mul_f32 v138, v254, v138
    v_mul_f32 v139, v254, v139
    v_mfma_f32_16x16x32_bf16 v[178:181], a[60:63], v[122:125], v[178:181]
    v_cvt_pk_bf16_f32 v148, v138, v139
    v_mul_f32 v140, v254, v140
    v_mfma_f32_16x16x32_bf16 v[178:181], a[64:67], v[126:129], v[178:181]
    v_mul_f32 v141, v254, v141
    v_cvt_pk_bf16_f32 v149, v140, v141
    v_mfma_f32_16x16x32_bf16 v[178:181], a[68:71], v[166:169], v[178:181]
    v_mul_f32 v186, v254, v186
    v_mul_f32 v187, v254, v187
    v_mfma_f32_16x16x32_bf16 v[138:141], v[134:137], a[144:147], 0
    v_cvt_pk_bf16_f32 v200, v186, v187
    v_mul_f32 v188, v254, v188
    v_mfma_f32_16x16x32_bf16 v[138:141], v[154:157], a[148:151], v[138:141]
    v_mul_f32 v189, v254, v189
    v_cvt_pk_bf16_f32 v201, v188, v189
    v_mfma_f32_16x16x32_bf16 v[138:141], v[130:133], a[152:155], v[138:141]
    v_cvt_pk_f16_f32 v160, v142, v143
    v_pk_fma_f16 v162, v160, v160, v162
    v_mfma_f32_16x16x32_bf16 v[138:141], v[122:125], a[156:159], v[138:141]
    v_cvt_pk_f16_f32 v161, v144, v145
    v_pk_fma_f16 v164, v161, v161, v164
    v_mfma_f32_16x16x32_bf16 v[138:141], v[126:129], a[160:163], v[138:141]
    buffer_store_dwordx4 v[146:149], v17, s[12:15], 0 offen
    v_cvt_pk_f16_f32 v218, v178, v179
    v_pk_fma_f16 v162, v218, v218, v162
    v_cvt_pk_f16_f32 v219, v180, v181
    v_pk_fma_f16 v164, v219, v219, v164
    v_mfma_f32_16x16x32_bf16 v[138:141], v[166:169], a[164:167], v[138:141]
    v_mul_f32 v151, v255, v151
    v_cvt_pk_bf16_f32 v150, v150, v151
    v_mfma_f32_16x16x32_f16 v[142:145], v[40:43], v[162:165], 0
    v_mul_f32 v152, v255, v152
    v_mul_f32 v153, v255, v153
    v_mfma_f32_16x16x32_bf16 v[178:181], v[134:137], a[168:171], 0
    v_cvt_pk_bf16_f32 v151, v152, v153
    v_mul_f32 v190, v255, v190
    v_mfma_f32_16x16x32_bf16 v[178:181], v[154:157], a[172:175], v[178:181]
    v_cvt_pk_bf16_f32 v176, v138, v139
    v_cvt_pk_bf16_f32 v177, v140, v141
    v_mfma_f32_16x16x32_bf16 v[178:181], v[130:133], a[176:179], v[178:181]
    ds_read_b128 v[146:149], v0 offset:32768
    v_min3_u32 v44, v44, v142, v143
    v_mfma_f32_16x16x32_bf16 v[178:181], v[122:125], a[180:183], v[178:181]
    ds_read_b128 v[138:141], v1 offset:32768
    v_max3_u32 v45, v45, v142, v143
    v_mfma_f32_16x16x32_bf16 v[178:181], v[126:129], a[184:187], v[178:181]
    ds_read_b128 v[186:189], v0 offset:32896
    v_mul_f32 v191, v255, v191
    v_mfma_f32_16x16x32_bf16 v[178:181], v[166:169], a[188:191], v[178:181]
    ds_read_b128 v[162:165], v1 offset:32896
    v_cvt_pk_bf16_f32 v152, v190, v191
    v_mfma_f32_16x16x32_bf16 v[210:213], v[134:137], a[192:195], 0
    ds_read_b128 v[134:137], v0 offset:33024
    v_mul_f32 v192, v255, v192
    v_mfma_f32_16x16x32_bf16 v[210:213], v[154:157], a[196:199], v[210:213]
    ds_read_b128 v[154:157], v1 offset:33024
    v_mul_f32 v193, v255, v193
    v_mfma_f32_16x16x32_bf16 v[210:213], v[130:133], a[200:203], v[210:213]
    v_rsq_f32 v144, v142
    v_mfma_f32_16x16x32_bf16 v[210:213], v[122:125], a[204:207], v[210:213]
    v_rsq_f32 v145, v143
    v_mfma_f32_16x16x32_bf16 v[210:213], v[126:129], a[208:211], v[210:213]
    s_waitcnt lgkmcnt(5)
    v_mul_f32 v144, s31, v144
    v_cvt_pk_f16_f32 v144, v144, v145
    v_mfma_f32_16x16x32_bf16 v[210:213], v[166:169], a[212:215], v[210:213]
    s_waitcnt lgkmcnt(4)
    v_cvt_pk_bf16_f32 v184, v178, v179
    v_cvt_pk_bf16_f32 v185, v180, v181
    v_mfma_f32_16x16x32_bf16 v[178:181], a[72:75], v[146:149], 0
    s_waitcnt lgkmcnt(3)
    v_pk_mul_f16 v170, v170, v144 op_sel:[0,1] op_sel_hi:[1,1]
    v_pk_mul_f16 v171, v171, v144 op_sel:[0,1] op_sel_hi:[1,1]
    v_mfma_f32_16x16x32_bf16 v[178:181], a[76:79], v[138:141], v[178:181]
    s_waitcnt lgkmcnt(2)
    v_cvt_pk_bf16_f32 v116, v210, v211
    v_cvt_pk_bf16_f32 v117, v212, v213
    v_mfma_f32_16x16x32_bf16 v[178:181], a[80:83], v[186:189], v[178:181]
    s_waitcnt lgkmcnt(1)
    buffer_store_dwordx2 v[200:201], v20, s[12:15], 0 offen
    v_pk_mul_f16 v172, v172, v144 op_sel:[0,1] op_sel_hi:[1,1]
    v_pk_mul_f16 v173, v173, v144 op_sel:[0,1] op_sel_hi:[1,1]
    v_mfma_f32_16x16x32_bf16 v[178:181], a[84:87], v[162:165], v[178:181]
    s_waitcnt lgkmcnt(0)
    v_pk_mul_f16 v220, v220, v144 op_sel:[0,1] op_sel_hi:[1,1]
    v_pk_mul_f16 v221, v221, v144 op_sel:[0,1] op_sel_hi:[1,1]
    v_mfma_f32_16x16x32_bf16 v[178:181], a[88:91], v[134:137], v[178:181]
    v_pk_mul_f16 v158, v158, v144 op_sel:[0,0] op_sel_hi:[1,0]
    v_pk_mul_f16 v159, v159, v144 op_sel:[0,0] op_sel_hi:[1,0]
    v_mfma_f32_16x16x32_bf16 v[178:181], a[92:95], v[154:157], v[178:181]
    v_pk_mul_f16 v160, v160, v144 op_sel:[0,0] op_sel_hi:[1,0]
    v_pk_mul_f16 v161, v161, v144 op_sel:[0,0] op_sel_hi:[1,0]
    v_mfma_f32_16x16x32_bf16 v[130:133], a[96:99], v[146:149], 0
    v_pk_mul_f16 v218, v218, v144 op_sel:[0,0] op_sel_hi:[1,0]
    v_pk_mul_f16 v219, v219, v144 op_sel:[0,0] op_sel_hi:[1,0]
    v_mfma_f32_16x16x32_bf16 v[130:133], a[100:103], v[138:141], v[130:133]
    s_waitcnt vmcnt(3)
    v_cvt_pk_bf16_f32 v153, v192, v193
    v_cvt_pk_f16_f32 v142, v178, v179
    v_mfma_f32_16x16x32_bf16 v[130:133], a[104:107], v[186:189], v[130:133]
    s_nop 0
    v_pk_mul_f16 v191, v142, v142
    v_cvt_pk_f16_f32 v143, v180, v181
    v_mfma_f32_16x16x32_bf16 v[130:133], a[108:111], v[162:165], v[130:133]
    s_nop 0
    v_pk_mul_f16 v193, v143, v143
    v_mul_f32 v202, v255, v202
    v_mfma_f32_16x16x32_bf16 v[130:133], a[112:115], v[134:137], v[130:133]
    s_nop 0
    v_mul_f32 v203, v255, v203
    v_cvt_pk_bf16_f32 v254, v202, v203
    v_mfma_f32_16x16x32_bf16 v[130:133], a[116:119], v[154:157], v[130:133]
    s_barrier
    v_mul_f32 v204, v255, v204
    v_mul_f32 v205, v255, v205
    v_mfma_f32_16x16x32_bf16 v[178:181], a[120:123], v[146:149], 0
    v_cvt_pk_bf16_f32 v255, v204, v205
    v_xor_b32 v0, 65536, v0
    v_mfma_f32_16x16x32_bf16 v[178:181], a[124:127], v[138:141], v[178:181]
    v_xor_b32 v1, 65536, v1
    v_cvt_pk_f16_f32 v144, v130, v131
    v_mfma_f32_16x16x32_bf16 v[178:181], a[128:131], v[186:189], v[178:181]
    v_pk_fma_f16 v191, v144, v144, v191
    v_cvt_pk_f16_f32 v145, v132, v133
    v_mfma_f32_16x16x32_bf16 v[178:181], a[132:135], v[162:165], v[178:181]
    v_pk_fma_f16 v193, v145, v145, v193
    v_mfma_f32_16x16x32_bf16 v[178:181], a[136:139], v[134:137], v[178:181]
    v_mfma_f32_16x16x32_bf16 v[178:181], a[140:143], v[154:157], v[178:181]
    v_mfma_f32_16x16x32_bf16 v[202:205], a[0:3], v[146:149], 0
    v_mfma_f32_16x16x32_bf16 v[202:205], a[4:7], v[138:141], v[202:205]
    buffer_load_dwordx4 v10, s[8:11], 0 offen lds
    s_add_u32 m0, s28, 4096
    v_mfma_f32_16x16x32_bf16 v[202:205], a[8:11], v[186:189], v[202:205]
    v_mfma_f32_16x16x32_bf16 v[202:205], a[12:15], v[162:165], v[202:205]
    v_mfma_f32_16x16x32_bf16 v[202:205], a[16:19], v[134:137], v[202:205]
    v_mfma_f32_16x16x32_bf16 v[202:205], a[20:23], v[154:157], v[202:205]
    v_cvt_pk_f16_f32 v124, v178, v179
    v_pk_fma_f16 v191, v124, v124, v191
    v_mfma_f32_16x16x32_bf16 v[130:133], a[24:27], v[146:149], 0
    buffer_load_dwordx4 v11, s[8:11], 0 offen lds
    v_cvt_pk_f16_f32 v125, v180, v181
    v_mfma_f32_16x16x32_bf16 v[130:133], a[28:31], v[138:141], v[130:133]
    s_add_u32 m0, s28, 8192
    v_pk_fma_f16 v193, v125, v125, v193
    v_cvt_pk_f16_f32 v178, v202, v203
    v_mfma_f32_16x16x32_bf16 v[130:133], a[32:35], v[186:189], v[130:133]
    v_pk_mul_f16 v190, v178, v178
    v_cvt_pk_f16_f32 v179, v204, v205
    v_mfma_f32_16x16x32_bf16 v[130:133], a[36:39], v[162:165], v[130:133]
    v_pk_mul_f16 v192, v179, v179
    v_mfma_f32_16x16x32_bf16 v[130:133], a[40:43], v[134:137], v[130:133]
    v_mfma_f32_16x16x32_bf16 v[130:133], a[44:47], v[154:157], v[130:133]
    buffer_load_dwordx4 v12, s[8:11], 0 offen lds
    s_add_u32 m0, s28, 12288
    v_mfma_f32_16x16x32_bf16 v[202:205], a[48:51], v[146:149], 0
    s_xor_b32 s28, s28, 65536
    v_mfma_f32_16x16x32_bf16 v[202:205], a[52:55], v[138:141], v[202:205]
    ds_read_b128 v[166:169], v5 offset:0
    ds_read_b128 v[126:129], v5 offset:16
    v_mfma_f32_16x16x32_bf16 v[202:205], a[56:59], v[186:189], v[202:205]
    ds_read_b128 v[210:213], v5 offset:48
    ds_read_b32 v200, v6 offset:192
    v_mfma_f32_16x16x32_bf16 v[202:205], a[60:63], v[162:165], v[202:205]
    v_cvt_pk_f16_f32 v180, v130, v131
    v_pk_fma_f16 v190, v180, v180, v190
    v_mfma_f32_16x16x32_bf16 v[202:205], a[64:67], v[134:137], v[202:205]
    buffer_load_dwordx4 v13, s[8:11], 0 offen lds
    v_cvt_pk_f16_f32 v181, v132, v133
    v_mfma_f32_16x16x32_bf16 v[202:205], a[68:71], v[154:157], v[202:205]
    s_mov_b32 m0, s29
    v_pk_fma_f16 v192, v181, v181, v192
    v_add_u32 v5, 336, v5
    v_mfma_f32_16x16x32_bf16 v[130:133], v[146:149], a[144:147], 0
    s_xor_b32 s29, s29, s30
    s_add_u32 s19, s19, s20
    s_add_u32 s23, s23, s21
    v_mfma_f32_16x16x32_bf16 v[130:133], v[138:141], a[148:151], v[130:133]
    s_cmp_ge_u32 s19, 72
    v_cvt_pk_f16_f32 v122, v202, v203
    v_pk_fma_f16 v190, v122, v122, v190
    v_mfma_f32_16x16x32_bf16 v[130:133], v[186:189], a[152:155], v[130:133]
    s_cselect_b32 s34, 72, 0
    v_cvt_pk_f16_f32 v123, v204, v205
    v_pk_fma_f16 v192, v123, v123, v192
    v_mfma_f32_16x16x32_bf16 v[130:133], v[162:165], a[156:159], v[130:133]
    s_waitcnt lgkmcnt(2)
    buffer_store_dwordx2 v[198:199], v19, s[12:15], 0 offen
    s_cselect_b32 s35, s22, 0
    s_sub_u32 s19, s19, s34
    v_mfma_f32_16x16x32_f16 v[202:205], v[40:43], v[190:193], 0
    s_add_u32 s23, s23, s35
    s_add_u32 s18, s18, 1
    s_cmp_lt_u32 s18, s17
    v_mfma_f32_16x16x32_f16 v[214:217], v[166:169], v[158:161], v[24:27]
    s_waitcnt lgkmcnt(0)
    v_mfma_f32_16x16x32_f16 v[214:217], v[126:129], v[170:173], v[214:217]
    v_mfma_f32_16x16x32_f16 v[214:217], v[210:213], v[218:221], v[214:217]
    v_mfma_f32_16x16x32_f16 v[190:193], v[166:169], v[206:209], v[22:25]
    v_rsq_f32 v204, v202
    v_mfma_f32_16x16x32_f16 v[190:193], v[126:129], v[118:121], v[190:193]
    v_rsq_f32 v205, v203
    v_mfma_f32_16x16x32_f16 v[190:193], v[210:213], v[194:197], v[190:193]
    v_mul_f32 v204, s31, v204
    v_cvt_pk_f16_f32 v204, v204, v205
    v_mfma_f32_16x16x32_bf16 v[130:133], v[134:137], a[160:163], v[130:133]
    v_pk_mul_f16 v142, v142, v204 op_sel:[0,1] op_sel_hi:[1,1]
    v_pk_mul_f16 v143, v143, v204 op_sel:[0,1] op_sel_hi:[1,1]
    v_mfma_f32_16x16x32_bf16 v[130:133], v[154:157], a[164:167], v[130:133]
    v_pk_mul_f16 v144, v144, v204 op_sel:[0,1] op_sel_hi:[1,1]
    v_pk_mul_f16 v145, v145, v204 op_sel:[0,1] op_sel_hi:[1,1]
    v_mfma_f32_16x16x32_bf16 v[222:225], v[146:149], a[168:171], 0
    v_mov_b32_dpp v200, v191 quad_perm:[0,1,2,3] row_mask:0x1 bank_mask:0xf
    v_mov_b32_dpp v200, v215 quad_perm:[0,1,2,3] row_mask:0x2 bank_mask:0xf
    v_mfma_f32_16x16x32_bf16 v[222:225], v[138:141], a[172:175], v[222:225]
    v_pk_mul_f16 v124, v124, v204 op_sel:[0,1] op_sel_hi:[1,1]
    v_pk_mul_f16 v125, v125, v204 op_sel:[0,1] op_sel_hi:[1,1]
    v_mfma_f32_16x16x32_bf16 v[222:225], v[186:189], a[176:179], v[222:225]
    v_cvt_pk_bf16_f32 v130, v130, v131
    v_cvt_pk_bf16_f32 v131, v132, v133
    v_mfma_f32_16x16x32_bf16 v[222:225], v[162:165], a[180:183], v[222:225]
    v_pk_mul_f16 v178, v178, v204 op_sel:[0,0] op_sel_hi:[1,0]
    v_pk_mul_f16 v179, v179, v204 op_sel:[0,0] op_sel_hi:[1,0]
    v_mfma_f32_16x16x32_f16 v[226:229], v[118:121], v[206:209], v[46:49]
    v_pk_mul_f16 v180, v180, v204 op_sel:[0,0] op_sel_hi:[1,0]
    v_pk_mul_f16 v181, v181, v204 op_sel:[0,0] op_sel_hi:[1,0]
    v_mfma_f32_16x16x32_f16 v[230:233], v[170:173], v[206:209], v[50:53]
    v_pk_mul_f16 v122, v122, v204 op_sel:[0,0] op_sel_hi:[1,0]
    v_pk_mul_f16 v123, v123, v204 op_sel:[0,0] op_sel_hi:[1,0]
    v_mfma_f32_16x16x32_f16 v[234:237], v[142:145], v[206:209], v[54:57]
    v_min3_u32 v44, v44, v202, v203
    v_exp_f32 v214, v214
    v_mfma_f32_16x16x16_f16 v[226:229], v[196:197], v[194:195], v[226:229]
    v_max3_u32 v45, v45, v202, v203
    v_exp_f32 v190, v190
    v_mfma_f32_16x16x16_f16 v[230:233], v[220:221], v[194:195], v[230:233]
    v_cvt_pk_bf16_f32 v39, v190, 0
    v_mfma_f32_16x16x16_f16 v[234:237], v[124:125], v[194:195], v[234:237]
    buffer_store_dwordx4 v[150:153], v15, s[12:15], 0 offen
    v_mfma_f32_16x16x32_bf16 v[222:225], v[134:137], a[184:187], v[222:225]
    v_mfma_f32_16x16x32_bf16 v[222:225], v[154:157], a[188:191], v[222:225]
    ds_read_b128 v[206:209], v2 offset:0
    v_mfma_f32_16x16x32_bf16 v[150:153], v[146:149], a[192:195], 0
    ds_read_b128 v[146:149], v2 offset:1024
    v_mfma_f32_16x16x32_bf16 v[150:153], v[138:141], a[196:199], v[150:153]
    ds_read_b128 v[138:141], v2 offset:2048
    v_mfma_f32_16x16x32_bf16 v[150:153], v[186:189], a[200:203], v[150:153]
    ds_read_b128 v[186:189], v2 offset:3072
    v_mfma_f32_16x16x32_bf16 v[150:153], v[162:165], a[204:207], v[150:153]
    ds_read_b128 v[162:165], v2 offset:4096
    v_cvt_pk_bf16_f32 v222, v222, v223
    v_mfma_f32_16x16x32_bf16 v[150:153], v[134:137], a[208:211], v[150:153]
    ds_read_b128 v[134:137], v2 offset:5120
    v_cvt_pk_bf16_f32 v223, v224, v225
    v_mfma_f32_16x16x32_bf16 v[150:153], v[154:157], a[212:215], v[150:153]
    ds_read2_b32 v[132:133], v6 offset0:0 offset1:0
    ds_read2_b32 v[224:225], v6 offset0:16 offset1:16
    v_mfma_f32_16x16x32_f16 v[154:157], v[166:169], v[178:181], v[26:29]
    ds_read2_b32 v[168:169], v6 offset0:32 offset1:32
    v_add_u32 v6, 272, v6
    v_mfma_f32_16x16x32_f16 v[154:157], v[126:129], v[142:145], v[154:157]
    s_waitcnt lgkmcnt(8)
    v_exp_f32 v226, v226
    v_mfma_f32_16x16x32_f16 v[154:157], v[210:213], v[122:125], v[154:157]
    s_waitcnt lgkmcnt(7)
    v_cvt_pk_bf16_f32 v166, v150, v151
    v_cvt_pk_bf16_f32 v167, v152, v153
    v_mfma_f32_16x16x32_bf16 v[150:153], a[216:219], v[206:209], 0
    s_waitcnt lgkmcnt(6)
    v_exp_f32 v227, v227
    v_mfma_f32_16x16x32_bf16 v[150:153], a[220:223], v[146:149], v[150:153]
    s_waitcnt lgkmcnt(5)
    v_exp_f32 v154, v154
    v_mfma_f32_16x16x32_bf16 v[150:153], a[224:227], v[138:141], v[150:153]
    s_waitcnt lgkmcnt(4)
    v_mov_b32_dpp v200, v155 quad_perm:[0,1,2,3] row_mask:0x4 bank_mask:0xf
    v_cvt_pk_bf16_f32 v126, v226, v227
    v_mfma_f32_16x16x32_bf16 v[150:153], a[228:231], v[186:189], v[150:153]
    s_waitcnt lgkmcnt(3)
    v_exp_f32 v200, v200
    v_mfma_f32_16x16x32_bf16 v[150:153], a[232:235], v[162:165], v[150:153]
    s_waitcnt lgkmcnt(1)
    v_exp_f32 v228, v228
    v_mfma_f32_16x16x32_bf16 v[150:153], a[236:239], v[134:137], v[150:153]
    s_waitcnt lgkmcnt(0)
    buffer_store_dwordx2 v[254:255], v18, s[12:15], 0 offen
    v_exp_f32 v229, v229
    v_mfma_f32_16x16x32_bf16 v[190:193], a[240:243], v[206:209], 0
    v_cvt_pk_bf16_f32 v200, v200, v200
    v_cvt_pk_bf16_f32 v127, v228, v229
    v_mfma_f32_16x16x32_bf16 v[190:193], a[244:247], v[146:149], v[190:193]
    ds_write_b16 v8, v200
    v_mfma_f32_16x16x32_bf16 v[190:193], a[248:251], v[138:141], v[190:193]
    v_exp_f32 v230, v230
    v_mfma_f32_16x16x32_bf16 v[190:193], a[252:255], v[186:189], v[190:193]
    ds_read_b128 v[198:201], v2 offset:6144
    ds_read_b128 v[210:213], v9
    v_mfma_f32_16x16x32_bf16 v[190:193], v[82:85], v[162:165], v[190:193]
    ds_read_b128 v[226:229], v2 offset:7168
    ds_read_b128 v[238:241], v9 offset:64
    v_mfma_f32_16x16x32_bf16 v[190:193], v[86:89], v[134:137], v[190:193]
    v_exp_f32 v231, v231
    v_mfma_f32_16x16x32_bf16 v[202:205], v[90:93], v[206:209], 0
    ds_read_b128 v[206:209], v2 offset:8192
    ds_read_b128 v[242:245], v2 offset:9216
    v_mfma_f32_16x16x32_bf16 v[202:205], v[94:97], v[146:149], v[202:205]
    v_cvt_pk_bf16_f32 v128, v230, v231
    v_fma_f32 v254, v150, v150, s33
    v_mfma_f32_16x16x32_bf16 v[202:205], v[98:101], v[138:141], v[202:205]
    ds_read_b128 v[146:149], v2 offset:10240
    ds_read_b128 v[138:141], v2 offset:11264
    v_mfma_f32_16x16x32_bf16 v[202:205], v[102:105], v[186:189], v[202:205]
    v_exp_f32 v232, v232
    v_mfma_f32_16x16x32_bf16 v[202:205], v[106:109], v[162:165], v[202:205]
    v_exp_f32 v233, v233
    v_mfma_f32_16x16x32_bf16 v[202:205], v[110:113], v[134:137], v[202:205]
    s_waitcnt lgkmcnt(6)
    v_cvt_pk_bf16_f32 v129, v232, v233
    v_fmac_f32 v254, v151, v151
    v_mfma_f32_16x16x32_bf16 v[186:189], v[210:213], v[28:31], 0
    s_waitcnt lgkmcnt(4)
    v_exp_f32 v234, v234
    v_mfma_f32_16x16x32_bf16 v[186:189], v[238:241], v[28:31], v[186:189]
    v_exp_f32 v235, v235
    v_mfma_f32_16x16x32_f16 v[134:137], v[118:121], v[158:161], v[58:61]
    s_waitcnt lgkmcnt(2)
    v_cvt_pk_bf16_f32 v36, v234, v235
    v_fmac_f32 v254, v152, v152
    v_mfma_f32_16x16x32_f16 v[162:165], v[170:173], v[158:161], v[62:65]
    v_exp_f32 v236, v236
    v_mfma_f32_16x16x32_f16 v[230:233], v[142:145], v[158:161], v[66:69]
    s_waitcnt lgkmcnt(0)
    buffer_load_dwordx4 v14, s[8:11], 0 offen lds
    v_rcp_f32 v186, v186
    v_mfma_f32_16x16x16_f16 v[134:137], v[196:197], v[218:219], v[134:137]
    v_exp_f32 v237, v237
    v_fmac_f32 v254, v153, v153
    v_mfma_f32_16x16x16_f16 v[162:165], v[220:221], v[218:219], v[162:165]
    v_cvt_pk_bf16_f32 v37, v236, v237
    v_fmac_f32 v254, v190, v190
    v_fmac_f32 v254, v191, v191
    v_mfma_f32_16x16x16_f16 v[230:233], v[124:125], v[218:219], v[230:233]
    v_fmac_f32 v254, v192, v192
    v_exp_f32 v134, v134
    v_fmac_f32 v254, v193, v193
    v_mfma_f32_16x16x32_bf16 v[158:161], v[210:213], v[174:177], 0
    v_exp_f32 v135, v135
    v_mfma_f32_16x16x32_bf16 v[158:161], v[238:241], v[130:133], v[158:161]
    v_cvt_pk_bf16_f32 v134, v134, v135
    v_fmac_f32 v254, v202, v202
    v_mfma_f32_16x16x32_bf16 v[234:237], v[210:213], v[182:185], 0
    v_exp_f32 v136, v136
    v_mfma_f32_16x16x32_bf16 v[234:237], v[238:241], v[222:225], v[234:237]
    v_exp_f32 v137, v137
    v_mfma_f32_16x16x32_bf16 v[246:249], v[210:213], v[114:117], 0
    v_cvt_pk_bf16_f32 v135, v136, v137
    v_mul_f32 v158, v158, v186
    v_mfma_f32_16x16x32_bf16 v[246:249], v[238:241], v[166:169], v[246:249]
    v_exp_f32 v162, v162
    v_mfma_f32_16x16x32_bf16 v[210:213], v[28:31], v[36:39], 0
    v_exp_f32 v163, v163
    v_mfma_f32_16x16x32_bf16 v[210:213], v[28:31], v[126:129], v[210:213]
    v_cvt_pk_bf16_f32 v136, v162, v163
    v_mul_f32_dpp v158, v234, v186 quad_perm:[0,1,2,3] row_mask:0x2 bank_mask:0xf
    v_mfma_f32_16x16x32_bf16 v[234:237], v[130:133], v[36:39], 0
    v_exp_f32 v164, v164
    v_mfma_f32_16x16x32_bf16 v[234:237], v[174:177], v[126:129], v[234:237]
    v_exp_f32 v165, v165
    v_mfma_f32_16x16x32_bf16 v[238:241], v[222:225], v[36:39], 0
    v_cvt_pk_bf16_f32 v137, v164, v165
    v_mul_f32_dpp v158, v246, v186 quad_perm:[0,1,2,3] row_mask:0x4 bank_mask:0xf
    v_mfma_f32_16x16x32_bf16 v[238:241], v[182:185], v[126:129], v[238:241]
    v_exp_f32 v230, v230
    v_mfma_f32_16x16x32_bf16 v[186:189], v[166:169], v[36:39], 0
    v_exp_f32 v231, v231
    v_mfma_f32_16x16x32_bf16 v[186:189], v[114:117], v[126:129], v[186:189]
    v_cvt_pk_bf16_f32 v36, v230, v231
    v_cvt_pk_bf16_f32 v39, v214, 0
    v_mfma_f32_16x16x32_f16 v[162:165], v[118:121], v[178:181], v[70:73]
    v_exp_f32 v232, v232
    v_mfma_f32_16x16x32_f16 v[118:121], v[170:173], v[178:181], v[74:77]
    v_exp_f32 v233, v233
    v_mfma_f32_16x16x32_f16 v[170:173], v[142:145], v[178:181], v[78:81]
    v_cvt_pk_bf16_f32 v37, v232, v233
    v_cvt_pk_bf16_f32 v158, v158, v158
    v_fmac_f32 v254, v203, v203
    v_mfma_f32_16x16x16_f16 v[162:165], v[196:197], v[122:123], v[162:165]
    v_rcp_f32 v210, v210
    v_fmac_f32 v254, v204, v204
    v_mfma_f32_16x16x16_f16 v[118:121], v[220:221], v[122:123], v[118:121]
    v_mul_f32 v234, v210, v234
    v_mul_f32 v235, v210, v235
    v_cvt_pk_bf16_f32 v178, v234, v235
    v_mfma_f32_16x16x16_f16 v[170:173], v[124:125], v[122:123], v[170:173]
    v_mul_f32 v236, v210, v236
    v_exp_f32 v162, v162
    v_mul_f32 v237, v210, v237
    v_mfma_f32_16x16x32_bf16 v[194:197], v[28:31], v[36:39], 0
    ds_write_b16 v7, v158
    v_mfma_f32_16x16x32_bf16 v[194:197], v[28:31], v[134:137], v[194:197]
    v_exp_f32 v163, v163
    v_mfma_f32_16x16x32_bf16 v[122:125], v[130:133], v[36:39], 0
    v_cvt_pk_bf16_f32 v162, v162, v163
    v_cvt_pk_bf16_f32 v179, v236, v237
    v_mfma_f32_16x16x32_bf16 v[122:125], v[174:177], v[134:137], v[122:125]
    v_exp_f32 v164, v164
    v_mfma_f32_16x16x32_bf16 v[126:129], v[222:225], v[36:39], 0
    v_exp_f32 v165, v165
    v_mfma_f32_16x16x32_bf16 v[126:129], v[182:185], v[134:137], v[126:129]
    v_cvt_pk_bf16_f32 v163, v164, v165
    v_mul_f32 v238, v210, v238
    v_mfma_f32_16x16x32_bf16 v[218:221], v[166:169], v[36:39], 0
    v_exp_f32 v118, v118
    v_mfma_f32_16x16x32_bf16 v[218:221], v[114:117], v[134:137], v[218:221]
    v_exp_f32 v119, v119
    v_mfma_f32_16x16x32_bf16 v[142:145], a[216:219], v[198:201], 0
    v_cvt_pk_bf16_f32 v164, v118, v119
    v_cvt_pk_bf16_f32 v39, v154, 0
    v_mfma_f32_16x16x32_bf16 v[142:145], a[220:223], v[226:229], v[142:145]
    v_exp_f32 v120, v120
    v_mfma_f32_16x16x32_bf16 v[142:145], a[224:227], v[206:209], v[142:145]
    v_exp_f32 v121, v121
    v_mfma_f32_16x16x32_bf16 v[142:145], a[228:231], v[242:245], v[142:145]
    v_cvt_pk_bf16_f32 v165, v120, v121
    v_mul_f32 v239, v210, v239
    v_mfma_f32_16x16x32_bf16 v[142:145], a[232:235], v[146:149], v[142:145]
    v_exp_f32 v170, v170
    v_mfma_f32_16x16x32_bf16 v[142:145], a[236:239], v[138:141], v[142:145]
    v_exp_f32 v171, v171
    v_mfma_f32_16x16x32_bf16 v[158:161], a[240:243], v[198:201], 0
    v_cvt_pk_bf16_f32 v36, v170, v171
    v_cvt_pk_bf16_f32 v180, v238, v239
    v_mfma_f32_16x16x32_bf16 v[158:161], a[244:247], v[226:229], v[158:161]
    v_exp_f32 v172, v172
    v_mfma_f32_16x16x32_bf16 v[158:161], a[248:251], v[206:209], v[158:161]
    v_exp_f32 v173, v173
    v_mfma_f32_16x16x32_bf16 v[158:161], a[252:255], v[242:245], v[158:161]
    ds_read_b128 v[118:121], v2 offset:12288
    v_cvt_pk_bf16_f32 v37, v172, v173
    v_mfma_f32_16x16x32_bf16 v[158:161], v[82:85], v[146:149], v[158:161]
    ds_read_b128 v[134:137], v2 offset:13312
    v_mul_f32 v240, v210, v240
    v_mfma_f32_16x16x32_bf16 v[170:173], v[28:31], v[36:39], 0
    v_mul_f32 v241, v210, v241
    v_cvt_pk_bf16_f32 v181, v240, v241
    v_mfma_f32_16x16x32_bf16 v[170:173], v[28:31], v[162:165], v[170:173]
    ds_write_b128 v3, v[178:181] offset:0
    v_mfma_f32_16x16x32_bf16 v[154:157], v[130:133], v[36:39], 0
    v_mul_f32 v186, v210, v186
    v_mul_f32 v187, v210, v187
    v_mfma_f32_16x16x32_bf16 v[154:157], v[174:177], v[162:165], v[154:157]
    v_cvt_pk_bf16_f32 v186, v186, v187
    v_mul_f32 v188, v210, v188
    v_mfma_f32_16x16x32_bf16 v[130:133], v[222:225], v[36:39], 0
    v_mul_f32 v189, v210, v189
    v_cvt_pk_bf16_f32 v187, v188, v189
    v_mfma_f32_16x16x32_bf16 v[130:133], v[182:185], v[162:165], v[130:133]
    s_waitcnt lgkmcnt(2)
    ds_write_b64 v4, v[186:187] offset:4096
    v_mfma_f32_16x16x32_bf16 v[174:177], v[166:169], v[36:39], 0
    s_waitcnt lgkmcnt(2)
    v_fma_f32 v255, v142, v142, s33
    v_fmac_f32 v255, v143, v143
    v_mfma_f32_16x16x32_bf16 v[174:177], v[114:117], v[162:165], v[174:177]
    v_fmac_f32 v255, v144, v144
    v_fmac_f32 v255, v145, v145
    v_mfma_f32_16x16x32_bf16 v[158:161], v[86:89], v[138:141], v[158:161]
    ds_read_b128 v[114:117], v2 offset:14336
    v_fmac_f32 v254, v205, v205
    v_mfma_f32_16x16x32_bf16 v[178:181], v[90:93], v[198:201], 0
    ds_read_b128 v[166:169], v2 offset:15360
    v_add_u32 v7, 16, v7
    v_mfma_f32_16x16x32_bf16 v[178:181], v[94:97], v[226:229], v[178:181]
    ds_read_b128 v[162:165], v2 offset:16384
    v_mfma_f32_16x16x32_bf16 v[178:181], v[98:101], v[206:209], v[178:181]
    ds_read_b128 v[206:209], v2 offset:17408
    v_fmac_f32 v255, v158, v158
    v_mfma_f32_16x16x32_bf16 v[178:181], v[102:105], v[242:245], v[178:181]
    v_fmac_f32 v255, v159, v159
    v_fmac_f32 v255, v160, v160
    v_mfma_f32_16x16x32_bf16 v[178:181], v[106:109], v[146:149], v[178:181]
    v_fmac_f32 v255, v161, v161
    v_xor_b32 v2, 65536, v2
    v_mfma_f32_16x16x32_bf16 v[178:181], v[110:113], v[138:141], v[178:181]
    v_rcp_f32 v170, v170
    v_mfma_f32_16x16x32_bf16 v[146:149], a[216:219], v[118:121], 0
    v_mul_f32 v154, v170, v154
    v_mul_f32 v155, v170, v155
    v_mfma_f32_16x16x32_bf16 v[146:149], a[220:223], v[134:137], v[146:149]
    s_waitcnt lgkmcnt(3)
    ds_read_b128 v[182:185], v0 offset:20480
    v_cvt_pk_bf16_f32 v154, v154, v155
    v_mfma_f32_16x16x32_bf16 v[146:149], a[224:227], v[114:117], v[146:149]
    s_waitcnt lgkmcnt(3)
    ds_read_b128 v[198:201], v1 offset:20480
    v_fmac_f32 v255, v178, v178
    v_mfma_f32_16x16x32_bf16 v[146:149], a[228:231], v[166:169], v[146:149]
    s_waitcnt lgkmcnt(3)
    ds_read_b128 v[210:213], v0 offset:20608
    v_fmac_f32 v255, v179, v179
    v_mfma_f32_16x16x32_bf16 v[146:149], a[232:235], v[162:165], v[146:149]
    s_waitcnt lgkmcnt(3)
    ds_read_b128 v[222:225], v1 offset:20608
    v_fmac_f32 v255, v180, v180
    v_mfma_f32_16x16x32_bf16 v[146:149], a[236:239], v[206:209], v[146:149]
    ds_read_b128 v[226:229], v0 offset:20736
    v_fmac_f32 v255, v181, v181
    v_mfma_f32_16x16x32_bf16 v[138:141], a[240:243], v[118:121], 0
    ds_read_b128 v[242:245], v1 offset:20736
    v_cvt_pk_bf16_f32 v254, v254, v255
    v_mfma_f32_16x16x32_bf16 v[138:141], a[244:247], v[134:137], v[138:141]
    v_mul_f32 v156, v170, v156
    v_mul_f32 v157, v170, v157
    v_mfma_f32_16x16x32_bf16 v[138:141], a[248:251], v[114:117], v[138:141]
    v_fma_f32 v255, v146, v146, s33
    v_fmac_f32 v255, v147, v147
    v_mfma_f32_16x16x32_bf16 v[138:141], a[252:255], v[166:169], v[138:141]
    s_waitcnt lgkmcnt(5)
    v_fmac_f32 v255, v148, v148
    v_fmac_f32 v255, v149, v149
    v_mfma_f32_16x16x32_bf16 v[138:141], v[82:85], v[162:165], v[138:141]
    s_waitcnt lgkmcnt(4)
    v_cvt_pk_bf16_f32 v155, v156, v157
    v_mul_f32 v130, v170, v130
    v_mfma_f32_16x16x32_bf16 v[138:141], v[86:89], v[206:209], v[138:141]
    s_waitcnt lgkmcnt(3)
    v_mul_f32 v131, v170, v131
    v_cvt_pk_bf16_f32 v156, v130, v131
    v_mfma_f32_16x16x32_bf16 v[186:189], v[90:93], v[118:121], 0
    s_waitcnt lgkmcnt(2)
    v_mul_f32 v132, v170, v132
    v_mul_f32 v133, v170, v133
    v_mfma_f32_16x16x32_bf16 v[186:189], v[94:97], v[134:137], v[186:189]
    s_waitcnt lgkmcnt(1)
    v_fmac_f32 v255, v138, v138
    v_fmac_f32 v255, v139, v139
    v_mfma_f32_16x16x32_bf16 v[186:189], v[98:101], v[114:117], v[186:189]
    s_waitcnt lgkmcnt(0)
    v_fmac_f32 v255, v140, v140
    v_fmac_f32 v255, v141, v141
    v_mfma_f32_16x16x32_bf16 v[186:189], v[102:105], v[166:169], v[186:189]
    v_cvt_pk_bf16_f32 v157, v132, v133
    v_mul_f32 v174, v170, v174
    v_mfma_f32_16x16x32_bf16 v[186:189], v[106:109], v[162:165], v[186:189]
    ds_write_b128 v3, v[154:157] offset:12288
    v_mfma_f32_16x16x32_bf16 v[186:189], v[110:113], v[206:209], v[186:189]
    v_mul_f32 v175, v170, v175
    v_cvt_pk_bf16_f32 v174, v174, v175
    v_mfma_f32_16x16x32_bf16 v[118:121], a[72:75], v[182:185], 0
    v_mul_f32 v176, v170, v176
    v_mul_f32 v177, v170, v177
    v_mfma_f32_16x16x32_bf16 v[118:121], a[76:79], v[198:201], v[118:121]
    v_rcp_f32 v194, v194
    v_mfma_f32_16x16x32_bf16 v[118:121], a[80:83], v[210:213], v[118:121]
    v_fmac_f32 v255, v186, v186
    v_fmac_f32 v255, v187, v187
    v_mfma_f32_16x16x32_bf16 v[118:121], a[84:87], v[222:225], v[118:121]
    v_fmac_f32 v255, v188, v188
    v_fmac_f32 v255, v189, v189
    v_mfma_f32_16x16x32_bf16 v[118:121], a[88:91], v[226:229], v[118:121]
    v_cvt_pk_bf16_f32 v255, v255, v255
    v_cvt_pk_bf16_f32 v175, v176, v177
    v_mfma_f32_16x16x32_bf16 v[118:121], a[92:95], v[242:245], v[118:121]
    ds_write_b64 v4, v[174:175] offset:16384
    v_mfma_f32_16x16x32_bf16 v[206:209], a[96:99], v[182:185], 0
    v_mul_f32 v122, v194, v122
    v_mul_f32 v123, v194, v123
    v_mfma_f32_16x16x32_bf16 v[206:209], a[100:103], v[198:201], v[206:209]
    ds_write_b64 v4, v[254:255] offset:18432
    v_mfma_f32_16x16x32_bf16 v[206:209], a[104:107], v[210:213], v[206:209]
    v_cvt_pk_bf16_f32 v134, v122, v123
    v_cvt_pk_f16_f32 v118, v118, v119
    v_mfma_f32_16x16x32_bf16 v[206:209], a[108:111], v[222:225], v[206:209]
    v_pk_mul_f16 v163, v118, v118
    v_cvt_pk_f16_f32 v119, v120, v121
    v_mfma_f32_16x16x32_bf16 v[206:209], a[112:115], v[226:229], v[206:209]
    v_pk_mul_f16 v165, v119, v119
    v_mul_f32 v124, v194, v124
    v_mfma_f32_16x16x32_bf16 v[206:209], a[116:119], v[242:245], v[206:209]
    v_mul_f32 v125, v194, v125
    v_cvt_pk_bf16_f32 v135, v124, v125
    v_mfma_f32_16x16x32_bf16 v[122:125], a[120:123], v[182:185], 0
    v_mul_f32 v126, v194, v126
    v_mul_f32 v127, v194, v127
    v_mfma_f32_16x16x32_bf16 v[122:125], a[124:127], v[198:201], v[122:125]
    v_cvt_pk_bf16_f32 v136, v126, v127
    v_mul_f32 v128, v194, v128
    v_mfma_f32_16x16x32_bf16 v[122:125], a[128:131], v[210:213], v[122:125]
    v_cvt_pk_f16_f32 v120, v206, v207
    v_pk_fma_f16 v163, v120, v120, v163
    v_mfma_f32_16x16x32_bf16 v[122:125], a[132:135], v[222:225], v[122:125]
    v_cvt_pk_f16_f32 v121, v208, v209
    v_pk_fma_f16 v165, v121, v121, v165
    v_mfma_f32_16x16x32_bf16 v[122:125], a[136:139], v[226:229], v[122:125]
    v_mul_f32 v129, v194, v129
    v_cvt_pk_bf16_f32 v137, v128, v129
    v_mfma_f32_16x16x32_bf16 v[122:125], a[140:143], v[242:245], v[122:125]
    ds_write_b128 v3, v[134:137] offset:6144
    v_mfma_f32_16x16x32_bf16 v[206:209], a[0:3], v[182:185], 0
    v_mul_f32 v218, v194, v218
    v_mul_f32 v219, v194, v219
    v_mfma_f32_16x16x32_bf16 v[206:209], a[4:7], v[198:201], v[206:209]
    v_cvt_pk_bf16_f32 v254, v218, v219
    v_mul_f32 v220, v194, v220
    v_mfma_f32_16x16x32_bf16 v[206:209], a[8:11], v[210:213], v[206:209]
    v_cvt_pk_f16_f32 v196, v122, v123
    v_pk_fma_f16 v163, v196, v196, v163
    v_mfma_f32_16x16x32_bf16 v[206:209], a[12:15], v[222:225], v[206:209]
    v_cvt_pk_f16_f32 v197, v124, v125
    v_pk_fma_f16 v165, v197, v197, v165
    v_mfma_f32_16x16x32_bf16 v[206:209], a[16:19], v[226:229], v[206:209]
    v_mul_f32 v221, v194, v221
    v_cvt_pk_bf16_f32 v255, v220, v221
    v_mfma_f32_16x16x32_bf16 v[206:209], a[20:23], v[242:245], v[206:209]
    ds_write_b64 v4, v[254:255] offset:10240
    v_mfma_f32_16x16x32_bf16 v[174:177], a[24:27], v[182:185], 0
    v_xor_b32 v3, 65536, v3
    v_xor_b32 v4, 65536, v4
    v_mfma_f32_16x16x32_bf16 v[174:177], a[28:31], v[198:201], v[174:177]
    v_mfma_f32_16x16x32_bf16 v[174:177], a[32:35], v[210:213], v[174:177]
    v_mfma_f32_16x16x32_bf16 v[174:177], a[36:39], v[222:225], v[174:177]
    v_mfma_f32_16x16x32_bf16 v[174:177], a[40:43], v[226:229], v[174:177]
    v_cvt_pk_f16_f32 v206, v206, v207
    v_mfma_f32_16x16x32_bf16 v[174:177], a[44:47], v[242:245], v[174:177]
    v_mfma_f32_16x16x32_bf16 v[218:221], a[48:51], v[182:185], 0
    s_waitcnt lgkmcnt(0)
    v_mfma_f32_16x16x32_bf16 v[218:221], a[52:55], v[198:201], v[218:221]
    s_nop 0
    v_mfma_f32_16x16x32_bf16 v[218:221], a[56:59], v[210:213], v[218:221]
    s_nop 0
    v_mfma_f32_16x16x32_bf16 v[218:221], a[60:63], v[222:225], v[218:221]
    s_nop 0
    v_mfma_f32_16x16x32_bf16 v[218:221], a[64:67], v[226:229], v[218:221]
    s_barrier
    v_mfma_f32_16x16x32_bf16 v[218:221], a[68:71], v[242:245], v[218:221]
    v_mfma_f32_16x16x32_bf16 v[170:173], v[182:185], a[144:147], 0
    v_mfma_f32_16x16x32_bf16 v[170:173], v[198:201], a[148:151], v[170:173]
    v_mfma_f32_16x16x32_bf16 v[170:173], v[210:213], a[152:155], v[170:173]
    v_mfma_f32_16x16x32_bf16 v[170:173], v[222:225], a[156:159], v[170:173]
    v_mfma_f32_16x16x32_bf16 v[170:173], v[226:229], a[160:163], v[170:173]
    v_mfma_f32_16x16x32_bf16 v[170:173], v[242:245], a[164:167], v[170:173]
    s_cbranch_scc1 L_loop_fast3
L_drain:
    ds_read_b128 v[114:117], v2 offset:18432
    ds_read_b128 v[118:121], v2 offset:19456
    ds_read_b128 v[122:125], v2 offset:0
    s_mul_i32 s5, s16, 8064
    s_mov_b32 s12, s42
    ds_read_b128 v[126:129], v2 offset:1024
    s_mov_b32 s13, s43
    s_cmp_ge_u32 s18, 2
    s_cselect_b32 s14, s36, 0
    ds_read_b128 v[130:133], v2 offset:2048
    s_add_u32 s5, s5, 104448
    s_lshl_b32 s3, s16, 6
    s_lshl_b32 s4, s16, 5
    ds_read_b128 v[134:137], v2 offset:3072
    s_add_u32 s4, s4, 256
    ds_read_b128 v[154:157], v2 offset:4096
    ds_read_b128 v[162:165], v2 offset:5120
    v_bfe_u32 v254, v2, 4, 6
    v_lshrrev_b32 v255, 4, v254
    v_and_b32 v166, 15, v254
    v_lshlrev_b32 v167, 9, v255
    v_lshl_add_u32 v167, v166, 4, v167
    v_add_u32 v167, 136704, v167
    s_waitcnt lgkmcnt(7)
    v_mfma_f32_16x16x32_bf16 v[170:173], v[32:35], v[114:117], 0
    s_waitcnt lgkmcnt(5)
    v_xor_b32 v168, 65536, v2
    v_bfe_u32 v169, v166, 1, 2
    v_mfma_f32_16x16x32_bf16 v[170:173], v[32:35], v[118:121], v[170:173]
    s_waitcnt lgkmcnt(4)
    v_xor_b32 v169, v169, v255
    v_lshl_add_u32 v169, v166, 2, v169
    v_lshl_add_u32 v114, v169, 4, s5
    v_mfma_f32_16x16x32_bf16 v[118:121], a[216:219], v[122:125], 0
    s_waitcnt lgkmcnt(3)
    v_lshl_add_u32 v115, v169, 3, s5
    v_lshl_add_u32 v116, v254, 4, s5
    v_lshl_add_u32 v117, v254, 3, s5
    v_mfma_f32_16x16x32_bf16 v[118:121], a[220:223], v[126:129], v[118:121]
    s_waitcnt lgkmcnt(2)
    v_lshlrev_b32 v169, 2, v169
    v_mul_f32 v170, 0x3baaaaab, v170
    v_rsq_f32 v170, v170
    v_mfma_f32_16x16x32_bf16 v[118:121], a[224:227], v[130:133], v[118:121]
    s_waitcnt lgkmcnt(0)
    ds_permute_b32 v173, v169, v15
    ds_permute_b32 v174, v169, v18
    v_mul_f32 v150, v170, v150
    v_mfma_f32_16x16x32_bf16 v[118:121], a[228:231], v[134:137], v[118:121]
    ds_permute_b32 v175, v169, v16
    ds_permute_b32 v176, v169, v19
    v_mul_f32 v151, v170, v151
    v_mfma_f32_16x16x32_bf16 v[118:121], a[232:235], v[154:157], v[118:121]
    ds_permute_b32 v177, v169, v17
    ds_permute_b32 v182, v169, v20
    v_cvt_pk_bf16_f32 v150, v150, v151
    v_mfma_f32_16x16x32_bf16 v[118:121], a[236:239], v[162:165], v[118:121]
    v_mul_f32 v152, v170, v152
    v_mul_f32 v153, v170, v153
    v_cvt_pk_bf16_f32 v151, v152, v153
    v_mfma_f32_16x16x32_bf16 v[194:197], a[240:243], v[122:125], 0
    v_mul_f32 v190, v170, v190
    v_mul_f32 v191, v170, v191
    v_cvt_pk_bf16_f32 v152, v190, v191
    v_mfma_f32_16x16x32_bf16 v[194:197], a[244:247], v[126:129], v[194:197]
    v_mul_f32 v192, v170, v192
    v_mul_f32 v193, v170, v193
    v_cvt_pk_bf16_f32 v153, v192, v193
    v_mfma_f32_16x16x32_bf16 v[194:197], a[248:251], v[130:133], v[194:197]
    s_waitcnt lgkmcnt(4)
    ds_read_b128 v[190:193], v2 offset:6144
    v_mul_f32 v202, v170, v202
    v_mul_f32 v203, v170, v203
    v_mfma_f32_16x16x32_bf16 v[194:197], a[252:255], v[134:137], v[194:197]
    s_waitcnt lgkmcnt(3)
    ds_read_b128 v[198:201], v2 offset:7168
    v_cvt_pk_bf16_f32 v184, v202, v203
    v_mul_f32 v204, v170, v204
    v_mfma_f32_16x16x32_bf16 v[194:197], v[82:85], v[154:157], v[194:197]
    s_waitcnt lgkmcnt(2)
    ds_read_b128 v[206:209], v2 offset:8192
    v_mul_f32 v205, v170, v205
    v_cvt_pk_bf16_f32 v185, v204, v205
    v_mfma_f32_16x16x32_bf16 v[194:197], v[86:89], v[162:165], v[194:197]
    ds_read_b128 v[202:205], v2 offset:9216
    v_fma_f32 v169, v118, v118, s33
    v_fmac_f32 v169, v119, v119
    v_mfma_f32_16x16x32_bf16 v[210:213], v[90:93], v[122:125], 0
    ds_read_b128 v[122:125], v2 offset:10240
    v_fmac_f32 v169, v120, v120
    v_fmac_f32 v169, v121, v121
    v_mfma_f32_16x16x32_bf16 v[210:213], v[94:97], v[126:129], v[210:213]
    ds_read_b128 v[126:129], v2 offset:11264
    v_fmac_f32 v169, v194, v194
    v_fmac_f32 v169, v195, v195
    v_mfma_f32_16x16x32_bf16 v[210:213], v[98:101], v[130:133], v[210:213]
    s_waitcnt lgkmcnt(5)
    buffer_store_dwordx4 v[150:153], v15, s[12:15], s27 offen
    v_fmac_f32 v169, v196, v196
    v_fmac_f32 v169, v197, v197
    v_mul_f32 v183, 0x3baaaaab, v171
    v_mfma_f32_16x16x32_bf16 v[210:213], v[102:105], v[134:137], v[210:213]
    s_waitcnt lgkmcnt(4)
    v_rsq_f32 v183, v183
    v_subrev_u32 v170, 0x3d800000, v44
    v_mfma_f32_16x16x32_bf16 v[210:213], v[106:109], v[154:157], v[210:213]
    s_waitcnt lgkmcnt(3)
    v_mul_f32 v142, v183, v142
    v_mul_f32 v143, v183, v143
    v_cvt_pk_bf16_f32 v130, v142, v143
    v_mfma_f32_16x16x32_bf16 v[210:213], v[110:113], v[162:165], v[210:213]
    s_waitcnt lgkmcnt(2)
    v_mul_f32 v144, v183, v144
    v_mul_f32 v145, v183, v145
    v_cvt_pk_bf16_f32 v131, v144, v145
    v_mfma_f32_16x16x32_bf16 v[134:137], a[216:219], v[190:193], 0
    s_waitcnt lgkmcnt(1)
    v_mul_f32 v158, v183, v158
    v_mul_f32 v159, v183, v159
    v_fmac_f32 v169, v210, v210
    v_mfma_f32_16x16x32_bf16 v[134:137], a[220:223], v[198:201], v[134:137]
    s_waitcnt lgkmcnt(0)
    v_fmac_f32 v169, v211, v211
    v_fmac_f32 v169, v212, v212
    v_fmac_f32 v169, v213, v213
    v_mfma_f32_16x16x32_bf16 v[134:137], a[224:227], v[206:209], v[134:137]
    v_cvt_pk_bf16_f32 v132, v158, v159
    v_mul_f32 v160, v183, v160
    v_mul_f32 v161, v183, v161
    v_mfma_f32_16x16x32_bf16 v[134:137], a[228:231], v[202:205], v[134:137]
    v_cvt_pk_bf16_f32 v133, v160, v161
    v_mul_f32 v178, v183, v178
    v_mul_f32 v179, v183, v179
    v_mfma_f32_16x16x32_bf16 v[134:137], a[232:235], v[122:125], v[134:137]
    v_cvt_pk_bf16_f32 v178, v178, v179
    v_mul_f32 v180, v183, v180
    v_mul_f32 v181, v183, v181
    v_mfma_f32_16x16x32_bf16 v[134:137], a[236:239], v[126:129], v[134:137]
    v_cvt_pk_bf16_f32 v179, v180, v181
    v_sub_u32 v183, 0x4a000000, v45
    v_or3_b32 v170, v170, v183, v45
    v_mfma_f32_16x16x32_bf16 v[142:145], a[240:243], v[190:193], 0
    v_lshl_add_u32 v183, s16, 2, v168
    v_mul_f32 v180, 0x3baaaaab, v172
    v_rsq_f32 v180, v180
    v_mfma_f32_16x16x32_bf16 v[142:145], a[244:247], v[198:201], v[142:145]
    ds_write_b32 v183, v170 offset:18432
    v_fma_f32 v181, v134, v134, s33
    v_mfma_f32_16x16x32_bf16 v[142:145], a[248:251], v[206:209], v[142:145]
    v_fmac_f32 v181, v135, v135
    v_fmac_f32 v181, v136, v136
    v_fmac_f32 v181, v137, v137
    v_mfma_f32_16x16x32_bf16 v[142:145], a[252:255], v[202:205], v[142:145]
    ds_read_b128 v[150:153], v2 offset:12288
    ds_read_b128 v[154:157], v2 offset:13312
    v_mul_f32 v146, v180, v146
    v_mfma_f32_16x16x32_bf16 v[142:145], v[82:85], v[122:125], v[142:145]
    ds_read_b128 v[158:161], v2 offset:14336
    v_mul_f32 v147, v180, v147
    v_cvt_pk_bf16_f32 v146, v146, v147
    v_mfma_f32_16x16x32_bf16 v[142:145], v[86:89], v[126:129], v[142:145]
    ds_read_b128 v[162:165], v2 offset:15360
    v_mul_f32 v148, v180, v148
    v_mul_f32 v149, v180, v149
    v_mfma_f32_16x16x32_bf16 v[214:217], v[90:93], v[190:193], 0
    ds_read_b128 v[190:193], v2 offset:16384
    v_cvt_pk_bf16_f32 v147, v148, v149
    v_mul_f32 v138, v180, v138
    v_mfma_f32_16x16x32_bf16 v[214:217], v[94:97], v[198:201], v[214:217]
    ds_read_b128 v[198:201], v2 offset:17408
    v_fmac_f32 v181, v142, v142
    v_fmac_f32 v181, v143, v143
    v_mfma_f32_16x16x32_bf16 v[214:217], v[98:101], v[206:209], v[214:217]
    buffer_store_dwordx2 v[184:185], v18, s[12:15], s27 offen
    v_fmac_f32 v181, v144, v144
    v_mfma_f32_16x16x32_bf16 v[214:217], v[102:105], v[202:205], v[214:217]
    s_waitcnt lgkmcnt(4)
    v_fmac_f32 v181, v145, v145
    v_mul_f32 v139, v180, v139
    v_cvt_pk_bf16_f32 v148, v138, v139
    v_mfma_f32_16x16x32_bf16 v[214:217], v[106:109], v[122:125], v[214:217]
    s_waitcnt lgkmcnt(3)
    v_mul_f32 v140, v180, v140
    v_mul_f32 v141, v180, v141
    v_cvt_pk_bf16_f32 v149, v140, v141
    v_mfma_f32_16x16x32_bf16 v[214:217], v[110:113], v[126:129], v[214:217]
    s_waitcnt lgkmcnt(2)
    ds_write_b128 v114, v[146:149] offset:3072
    v_mfma_f32_16x16x32_bf16 v[122:125], a[216:219], v[150:153], 0
    s_waitcnt lgkmcnt(2)
    v_mul_f32 v186, v180, v186
    v_mul_f32 v187, v180, v187
    v_cvt_pk_bf16_f32 v186, v186, v187
    v_mfma_f32_16x16x32_bf16 v[122:125], a[220:223], v[154:157], v[122:125]
    s_waitcnt lgkmcnt(1)
    v_fmac_f32 v181, v214, v214
    v_fmac_f32 v181, v215, v215
    v_fmac_f32 v181, v216, v216
    v_mfma_f32_16x16x32_bf16 v[122:125], a[224:227], v[158:161], v[122:125]
    ds_read_b128 v[126:129], v116 offset:3072
    v_fmac_f32 v181, v217, v217
    v_cvt_pk_bf16_f32 v170, v169, v181
    v_mfma_f32_16x16x32_bf16 v[122:125], a[228:231], v[162:165], v[122:125]
    v_cvt_pk_bf16_f32 v171, v181, v181
    v_mul_f32 v188, v180, v188
    v_mul_f32 v189, v180, v189
    v_mfma_f32_16x16x32_bf16 v[122:125], a[232:235], v[190:193], v[122:125]
    ds_write_b64 v4, v[170:171] offset:0
    v_mfma_f32_16x16x32_bf16 v[122:125], a[236:239], v[198:201], v[122:125]
    v_cvt_pk_bf16_f32 v187, v188, v189
    v_mov_b32 v169, 0x40000000
    v_lshrrev_b32 v180, 2, v254
    v_mfma_f32_16x16x32_bf16 v[138:141], a[240:243], v[150:153], 0
    ds_write_b64 v115, v[186:187] offset:4096
    v_mfma_f32_16x16x32_bf16 v[138:141], a[244:247], v[154:157], v[138:141]
    v_lshrrev_b32 v181, 3, v254
    v_xor_b32 v181, v181, v254
    v_fma_f32 v254, v122, v122, s33
    v_mfma_f32_16x16x32_bf16 v[138:141], a[248:251], v[158:161], v[138:141]
    s_waitcnt lgkmcnt(2)
    ds_read_b128 v[146:149], v167 offset:0
    ds_read_b64 v[170:171], v117 offset:4096
    v_fmac_f32 v254, v123, v123
    v_mfma_f32_16x16x32_bf16 v[138:141], a[252:255], v[162:165], v[138:141]
    ds_read_b128 v[186:189], v167 offset:2048
    v_fmac_f32 v254, v124, v124
    v_fmac_f32 v254, v125, v125
    v_mfma_f32_16x16x32_bf16 v[138:141], v[82:85], v[190:193], v[138:141]
    s_waitcnt lgkmcnt(4)
    ds_read_b128 v[202:205], v167 offset:4096
    v_and_b32 v181, 3, v181
    v_add_u32 v172, 0, v180
    v_mfma_f32_16x16x32_bf16 v[138:141], v[86:89], v[198:201], v[138:141]
    s_barrier
    ds_read_b128 v[206:209], v168 offset:0
    ds_read_b128 v[218:221], v168 offset:1024
    v_mul_u32_u24 v180, s20, v172
    v_mfma_f32_16x16x32_bf16 v[222:225], v[90:93], v[150:153], 0
    ds_read_b128 v[150:153], v167 offset:6144
    ds_read_b128 v[226:229], v167 offset:8192
    v_add_u32 v180, s38, v180
    v_mfma_f32_16x16x32_bf16 v[222:225], v[94:97], v[154:157], v[222:225]
    ds_read_b128 v[154:157], v167 offset:10240
    v_fmac_f32 v254, v138, v138
    v_fmac_f32 v254, v139, v139
    v_mfma_f32_16x16x32_bf16 v[222:225], v[98:101], v[158:161], v[222:225]
    s_waitcnt lgkmcnt(7)
    buffer_store_dwordx4 v[130:133], v16, s[12:15], s27 offen
    ds_read_b128 v[158:161], v168 offset:18432
    v_fmac_f32 v254, v140, v140
    v_fmac_f32 v254, v141, v141
    v_mfma_f32_16x16x32_bf16 v[222:225], v[102:105], v[162:165], v[222:225]
    s_waitcnt lgkmcnt(7)
    v_mul_u32_u24 v180, 911, v180
    v_lshrrev_b32 v180, 16, v180
    v_mul_u32_u24 v180, s22, v180
    v_mfma_f32_16x16x32_bf16 v[222:225], v[106:109], v[190:193], v[222:225]
    s_waitcnt lgkmcnt(6)
    v_mad_u32_u24 v180, v172, s21, v180
    v_cmp_gt_u32 vcc, s17, v172
    v_add_u32 v172, s7, v180
    v_mfma_f32_16x16x32_bf16 v[222:225], v[110:113], v[198:201], v[222:225]
    s_waitcnt lgkmcnt(4)
    v_cndmask_b32 v172, v169, v172, vcc
    v_lshl_add_u32 v183, v181, 4, v172
    v_mfma_f32_16x16x32_bf16 v[130:133], v[32:35], v[206:209], 0
    s_waitcnt lgkmcnt(2)
    v_add_u32 v183, s3, v183
    v_lshl_add_u32 v184, v181, 3, v172
    v_mfma_f32_16x16x32_bf16 v[130:133], v[32:35], v[218:221], v[130:133]
    s_waitcnt lgkmcnt(1)
    v_fmac_f32 v254, v222, v222
    v_fmac_f32 v254, v223, v223
    v_fmac_f32 v254, v224, v224
    v_mfma_f32_16x16x32_bf16 v[162:165], a[216:219], v[146:149], 0
    v_fmac_f32 v254, v225, v225
    v_cvt_pk_bf16_f32 v180, v254, v254
    v_cvt_pk_bf16_f32 v181, v254, v254
    v_mfma_f32_16x16x32_bf16 v[162:165], a[220:223], v[186:189], v[162:165]
    s_waitcnt lgkmcnt(0)
    ds_write_b64 v4, v[180:181] offset:2048
    v_mfma_f32_16x16x32_bf16 v[162:165], a[224:227], v[202:205], v[162:165]
    v_add_u32 v184, s4, v184
    v_add_u32 v166, 16, v166
    v_mul_u32_u24 v172, s20, v166
    v_mfma_f32_16x16x32_bf16 v[162:165], a[228:231], v[150:153], v[162:165]
    v_add_u32 v172, s38, v172
    v_mul_u32_u24 v172, 911, v172
    v_lshrrev_b32 v172, 16, v172
    v_mfma_f32_16x16x32_bf16 v[162:165], a[232:235], v[226:229], v[162:165]
    v_mul_u32_u24 v172, s22, v172
    v_mad_u32_u24 v172, v166, s21, v172
    v_cmp_gt_u32 vcc, s17, v166
    v_mfma_f32_16x16x32_bf16 v[162:165], a[236:239], v[154:157], v[162:165]
    v_add_u32 v172, s7, v172
    v_cndmask_b32 v172, v169, v172, vcc
    v_lshl_add_u32 v185, v255, 4, v172
    v_mfma_f32_16x16x32_bf16 v[190:193], a[240:243], v[146:149], 0
    v_add_u32 v185, s3, v185
    v_lshl_add_u32 v254, v255, 3, v172
    v_add_u32 v254, s4, v254
    v_mfma_f32_16x16x32_bf16 v[190:193], a[244:247], v[186:189], v[190:193]
    buffer_store_dwordx2 v[178:179], v19, s[12:15], s27 offen
    v_fma_f32 v172, v162, v162, s33
    v_mfma_f32_16x16x32_bf16 v[190:193], a[248:251], v[202:205], v[190:193]
    ds_read_b128 v[198:201], v167 offset:256
    v_fmac_f32 v172, v163, v163
    v_fmac_f32 v172, v164, v164
    v_mfma_f32_16x16x32_bf16 v[190:193], a[252:255], v[150:153], v[190:193]
    ds_read_b128 v[178:181], v167 offset:2304
    v_fmac_f32 v172, v165, v165
    v_mul_f32 v255, 0x3baaaaab, v130
    v_mfma_f32_16x16x32_bf16 v[190:193], v[82:85], v[226:229], v[190:193]
    ds_read_b128 v[206:209], v167 offset:4352
    v_mul_f32 v166, 0x3baaaaab, v131
    v_rsq_f32 v255, v255
    v_mfma_f32_16x16x32_bf16 v[190:193], v[86:89], v[154:157], v[190:193]
    ds_read_b128 v[130:133], v167 offset:6400
    v_mul_f32 v118, v255, v118
    v_mul_f32 v119, v255, v119
    v_mfma_f32_16x16x32_bf16 v[218:221], v[90:93], v[146:149], 0
    ds_read_b128 v[146:149], v167 offset:8448
    v_cvt_pk_bf16_f32 v118, v118, v119
    v_mul_f32 v120, v255, v120
    v_mfma_f32_16x16x32_bf16 v[218:221], v[94:97], v[186:189], v[218:221]
    ds_read_b128 v[186:189], v167 offset:10496
    v_fmac_f32 v172, v190, v190
    v_fmac_f32 v172, v191, v191
    v_mfma_f32_16x16x32_bf16 v[218:221], v[98:101], v[202:205], v[218:221]
    s_waitcnt lgkmcnt(5)
    v_fmac_f32 v172, v192, v192
    v_fmac_f32 v172, v193, v193
    v_mul_f32 v121, v255, v121
    v_mfma_f32_16x16x32_bf16 v[218:221], v[102:105], v[150:153], v[218:221]
    s_waitcnt lgkmcnt(4)
    v_cvt_pk_bf16_f32 v119, v120, v121
    v_mul_f32 v194, v255, v194
    v_mul_f32 v195, v255, v195
    v_mfma_f32_16x16x32_bf16 v[218:221], v[106:109], v[226:229], v[218:221]
    s_waitcnt lgkmcnt(3)
    v_cvt_pk_bf16_f32 v120, v194, v195
    v_mul_f32 v196, v255, v196
    v_mul_f32 v197, v255, v197
    v_mfma_f32_16x16x32_bf16 v[218:221], v[110:113], v[154:157], v[218:221]
    s_waitcnt lgkmcnt(2)
    v_cvt_pk_bf16_f32 v121, v196, v197
    v_mul_f32 v210, v255, v210
    v_mul_f32 v211, v255, v211
    v_mfma_f32_16x16x32_bf16 v[150:153], a[216:219], v[198:201], 0
    s_waitcnt lgkmcnt(1)
    ds_write_b128 v114, v[118:121] offset:4608
    v_mfma_f32_16x16x32_bf16 v[150:153], a[220:223], v[178:181], v[150:153]
    s_waitcnt lgkmcnt(1)
    v_fmac_f32 v172, v218, v218
    v_fmac_f32 v172, v219, v219
    v_fmac_f32 v172, v220, v220
    v_mfma_f32_16x16x32_bf16 v[150:153], a[224:227], v[206:209], v[150:153]
    buffer_store_dwordx4 v[126:129], v177, s[12:15], s27 offen
    ds_read_b128 v[118:121], v116 offset:4608
    v_fmac_f32 v172, v221, v221
    v_cvt_pk_bf16_f32 v126, v172, v172
    v_mfma_f32_16x16x32_bf16 v[150:153], a[228:231], v[130:133], v[150:153]
    v_cvt_pk_bf16_f32 v127, v172, v172
    v_cvt_pk_bf16_f32 v210, v210, v211
    v_mul_f32 v212, v255, v212
    v_mfma_f32_16x16x32_bf16 v[150:153], a[232:235], v[146:149], v[150:153]
    ds_write_b64 v4, v[126:127] offset:4096
    v_mfma_f32_16x16x32_bf16 v[150:153], a[236:239], v[186:189], v[150:153]
    v_mul_f32 v213, v255, v213
    v_cvt_pk_bf16_f32 v211, v212, v213
    v_rsq_f32 v166, v166
    v_mfma_f32_16x16x32_bf16 v[126:129], a[240:243], v[198:201], 0
    buffer_store_dwordx2 v[170:171], v182, s[12:15], s27 offen
    v_mul_f32 v134, v166, v134
    v_mfma_f32_16x16x32_bf16 v[126:129], a[244:247], v[178:181], v[126:129]
    s_mov_b32 s14, s36
    ds_write_b64 v115, v[210:211] offset:5632
    v_mfma_f32_16x16x32_bf16 v[126:129], a[248:251], v[206:209], v[126:129]
    s_waitcnt lgkmcnt(2)
    v_fma_f32 v255, v150, v150, s33
    v_fmac_f32 v255, v151, v151
    v_fmac_f32 v255, v152, v152
    v_mfma_f32_16x16x32_bf16 v[126:129], a[252:255], v[130:133], v[126:129]
    ds_read_b64 v[170:171], v117 offset:5632
    v_fmac_f32 v255, v153, v153
    v_mul_f32 v135, v166, v135
    v_mfma_f32_16x16x32_bf16 v[126:129], v[82:85], v[146:149], v[126:129]
    s_waitcnt lgkmcnt(2)
    buffer_store_dwordx4 v[118:121], v173, s[12:15], s26 offen
    v_cvt_pk_bf16_f32 v134, v134, v135
    v_mul_f32 v136, v166, v136
    v_mul_f32 v137, v166, v137
    v_mfma_f32_16x16x32_bf16 v[126:129], v[86:89], v[186:189], v[126:129]
    s_barrier
    ds_read_b128 v[118:121], v168 offset:2048
    ds_read_b128 v[154:157], v168 offset:3072
    v_cvt_pk_bf16_f32 v135, v136, v137
    v_mfma_f32_16x16x32_bf16 v[194:197], v[90:93], v[198:201], 0
    ds_read_b128 v[198:201], v168 offset:4096
    ds_read_b128 v[202:205], v168 offset:5120
    v_mul_f32 v142, v166, v142
    v_mfma_f32_16x16x32_bf16 v[194:197], v[94:97], v[178:181], v[194:197]
    v_fmac_f32 v255, v126, v126
    v_fmac_f32 v255, v127, v127
    v_fmac_f32 v255, v128, v128
    v_mfma_f32_16x16x32_bf16 v[194:197], v[98:101], v[206:209], v[194:197]
    v_fmac_f32 v255, v129, v129
    v_mul_f32 v143, v166, v143
    v_cvt_pk_bf16_f32 v136, v142, v143
    v_mfma_f32_16x16x32_bf16 v[194:197], v[102:105], v[130:133], v[194:197]
    s_waitcnt lgkmcnt(4)
    buffer_store_dwordx2 v[170:171], v174, s[12:15], s26 offen
    v_mul_f32 v144, v166, v144
    v_mfma_f32_16x16x32_bf16 v[194:197], v[106:109], v[146:149], v[194:197]
    v_mul_f32 v145, v166, v145
    v_cvt_pk_bf16_f32 v137, v144, v145
    v_mul_f32 v214, v166, v214
    v_mfma_f32_16x16x32_bf16 v[194:197], v[110:113], v[186:189], v[194:197]
    s_waitcnt lgkmcnt(2)
    ds_write_b128 v114, v[134:137] offset:6144
    v_mfma_f32_16x16x32_bf16 v[130:133], v[32:35], v[118:121], 0
    s_waitcnt lgkmcnt(1)
    v_mul_f32 v215, v166, v215
    v_cvt_pk_bf16_f32 v214, v214, v215
    v_mfma_f32_16x16x32_bf16 v[130:133], v[32:35], v[154:157], v[130:133]
    v_mul_f32 v216, v166, v216
    v_fmac_f32 v255, v194, v194
    v_mfma_f32_16x16x32_bf16 v[118:121], v[32:35], v[198:201], 0
    ds_read_b128 v[134:137], v116 offset:6144
    v_fmac_f32 v255, v195, v195
    v_mfma_f32_16x16x32_bf16 v[118:121], v[32:35], v[202:205], v[118:121]
    v_fmac_f32 v255, v196, v196
    v_fmac_f32 v255, v197, v197
    v_cvt_pk_bf16_f32 v132, v255, v255
    v_cvt_pk_bf16_f32 v133, v255, v255
    ds_write_b64 v4, v[132:133] offset:6144
    v_mul_f32 v217, v166, v217
    v_cvt_pk_bf16_f32 v215, v216, v217
    v_mul_f32 v255, 0x3baaaaab, v130
    ds_write_b64 v115, v[214:215] offset:7168
    v_rsq_f32 v255, v255
    v_mul_f32 v174, 0x3baaaaab, v118
    ds_read_b64 v[166:167], v117 offset:7168
    v_mul_f32 v122, v255, v122
    s_waitcnt lgkmcnt(3)
    buffer_store_dwordx4 v[134:137], v175, s[12:15], s26 offen
    v_mul_f32 v123, v255, v123
    v_cvt_pk_bf16_f32 v118, v122, v123
    v_mul_f32 v124, v255, v124
    v_mul_f32 v125, v255, v125
    v_cvt_pk_bf16_f32 v119, v124, v125
    v_mul_f32 v138, v255, v138
    s_waitcnt lgkmcnt(2)
    s_barrier
    ds_read_b128 v[122:125], v168 offset:6144
    ds_read_b128 v[130:133], v168 offset:7168
    v_mul_f32 v139, v255, v139
    v_cvt_pk_bf16_f32 v120, v138, v139
    v_mul_f32 v140, v255, v140
    v_mul_f32 v141, v255, v141
    v_cvt_pk_bf16_f32 v121, v140, v141
    ds_write_b128 v114, v[118:121] offset:0
    s_waitcnt lgkmcnt(3)
    buffer_store_dwordx2 v[166:167], v176, s[12:15], s26 offen
    v_mul_f32 v222, v255, v222
    v_mul_f32 v223, v255, v223
    v_cvt_pk_bf16_f32 v222, v222, v223
    v_mul_f32 v224, v255, v224
    ds_read_b128 v[118:121], v116 offset:0
    v_mul_f32 v225, v255, v225
    v_cvt_pk_bf16_f32 v223, v224, v225
    ds_write_b64 v115, v[222:223] offset:1024
    s_waitcnt lgkmcnt(3)
    v_mfma_f32_16x16x32_bf16 v[134:137], v[32:35], v[122:125], 0
    v_rsq_f32 v174, v174
    v_mfma_f32_16x16x32_bf16 v[134:137], v[32:35], v[130:133], v[134:137]
    ds_read_b64 v[122:123], v117 offset:1024
    v_mul_f32 v162, v174, v162
    v_mul_f32 v163, v174, v163
    v_cvt_pk_bf16_f32 v130, v162, v163
    v_mul_f32 v164, v174, v164
    v_mul_f32 v165, v174, v165
    v_cvt_pk_bf16_f32 v131, v164, v165
    v_mul_f32 v190, v174, v190
    v_mul_f32 v191, v174, v191
    v_cvt_pk_bf16_f32 v132, v190, v191
    v_mul_f32 v192, v174, v192
    v_mul_f32 v193, v174, v193
    v_cvt_pk_bf16_f32 v133, v192, v193
    s_waitcnt lgkmcnt(2)
    buffer_store_dwordx4 v[118:121], v177, s[12:15], s26 offen
    ds_write_b128 v114, v[130:133] offset:1536
    v_mul_f32 v218, v174, v218
    v_mul_f32 v219, v174, v219
    v_cvt_pk_bf16_f32 v124, v218, v219
    v_mul_f32 v220, v174, v220
    v_mul_f32 v221, v174, v221
    v_cvt_pk_bf16_f32 v125, v220, v221
    s_waitcnt lgkmcnt(1)
    ds_read_b128 v[118:121], v116 offset:1536
    ds_write_b64 v115, v[124:125] offset:2560
    buffer_store_dwordx2 v[122:123], v182, s[12:15], s26 offen
    v_mul_f32 v255, 0x3baaaaab, v134
    ds_read_b64 v[124:125], v117 offset:2560
    v_rsq_f32 v255, v255
    v_or3_b32 v158, v158, v159, v160
    v_mul_f32 v150, v255, v150
    v_mul_f32 v151, v255, v151
    v_cvt_pk_bf16_f32 v114, v150, v151
    v_mul_f32 v152, v255, v152
    v_mul_f32 v153, v255, v153
    v_cvt_pk_bf16_f32 v115, v152, v153
    v_mul_f32 v126, v255, v126
    v_mul_f32 v127, v255, v127
    v_cvt_pk_bf16_f32 v116, v126, v127
    v_mul_f32 v128, v255, v128
    v_mul_f32 v129, v255, v129
    v_cvt_pk_bf16_f32 v117, v128, v129
    buffer_store_dwordx4 v[114:117], v185, s[12:15], 0 offen
    s_waitcnt lgkmcnt(2)
    v_mul_f32 v194, v255, v194
    v_mul_f32 v195, v255, v195
    v_cvt_pk_bf16_f32 v122, v194, v195
    v_mul_f32 v196, v255, v196
    v_mul_f32 v197, v255, v197
    v_cvt_pk_bf16_f32 v123, v196, v197
    v_or_b32 v158, v158, v161
    v_cmp_gt_i32 s[46:47], 0, v158
    s_waitcnt lgkmcnt(0)
    buffer_store_dwordx4 v[118:121], v183, s[12:15], 0 offen
    buffer_store_dwordx2 v[124:125], v184, s[12:15], 0 offen
    buffer_store_dwordx2 v[122:123], v254, s[12:15], 0 offen
    s_nop 1
    s_cmp_lg_u64 s[46:47], 0
    s_cbranch_scc1 L_rerun
L_done:
    s_endpgm
L_slow:
    s_mov_b32 s44, 0xff
    s_branch L_redo
L_rerun:
    s_mov_b32 s44, 0x7f000000
L_redo:
    s_waitcnt vmcnt(0) lgkmcnt(0)
    s_barrier
    v_mbcnt_lo_u32_b32 v0, -1, 0
    v_mbcnt_hi_u32_b32 v0, -1, v0
    v_lshl_add_u32 v0, s16, 6, v0
    s_nop 7
    s_branch L_again
L_edge:
    v_mov_b32 v254, v0
    v_mov_b32 v255, 0x40000000
    v_and_b32 v118, 63, v0
    s_bfe_u32 s3, s2, 0x50003
    s_lshl_b32 s4, s16, 3
    s_lshr_b32 s98, 0x00123600, s4
    s_and_b32 s98, s98, 0xff
    s_mul_i32 s3, s3, s98
    s_lshr_b32 s4, 0x05113500, s4
    s_and_b32 s4, s4, 0xff
    v_min_u32 v120, s4, v118
    v_add_lshl_u32 v120, v120, s3, 7
    v_mov_b32 v121, 0
    v_lshrrev_b32 v119, 4, v118
    v_and_b32 v130, 15, v118
    s_mov_b32 s10, 100270464
    s_mov_b32 s11, 0x00020000
    s_mov_b32 s50, 221184
    s_mov_b32 s51, 0x00020000
    v_mul_u32_u24 v131, 171, v118
    v_lshrrev_b32 v131, 10, v131
    v_lshrrev_b32 v132, 1, v131
    v_xor_b32 v132, v132, v131
    v_and_b32 v132, 4, v132
    v_mul_u32_u24 v132, 3, v132
    v_xor_b32 v132, v132, v131
    v_mul_u32_u24 v132, 1152, v132
    v_mul_u32_u24 v133, 96, v131
    v_sub_u32 v132, v132, v133
    v_lshl_add_u32 v133, v118, 4, v132
    v_add_u32 v132, 64, v118
    v_mul_u32_u24 v132, 171, v132
    v_lshrrev_b32 v132, 10, v132
    v_lshrrev_b32 v134, 1, v132
    v_xor_b32 v134, v134, v132
    v_and_b32 v134, 4, v134
    v_mul_u32_u24 v134, 3, v134
    v_xor_b32 v134, v134, v132
    v_mul_u32_u24 v134, 1152, v134
    v_mul_u32_u24 v135, 96, v132
    v_sub_u32 v134, v134, v135
    v_lshl_add_u32 v135, v118, 4, v134
    v_add_u32 v134, 128, v118
    v_mul_u32_u24 v134, 171, v134
    v_lshrrev_b32 v134, 10, v134
    v_lshrrev_b32 v136, 1, v134
    v_xor_b32 v136, v136, v134
    v_and_b32 v136, 4, v136
    v_mul_u32_u24 v136, 3, v136
    v_xor_b32 v136, v136, v134
    v_mul_u32_u24 v136, 1152, v136
    v_mul_u32_u24 v137, 96, v134
    v_sub_u32 v136, v136, v137
    v_lshl_add_u32 v137, v118, 4, v136
    s_mul_i32 s68, s16, 6144
    s_add_u32 s69, s68, 65536
    s_cmp_eq_u32 s16, 3
    s_cselect_b32 s68, 136704, s68
    s_cselect_b32 s69, 142848, s69
    s_mul_i32 s45, s16, 96
    s_mov_b32 s70, 193536
    s_mov_b32 s36, 100270464
    s_mov_b32 s22, 1180032
    s_mul_i32 s3, s2, 911
    s_lshr_b32 s3, s3, 16
    s_mul_i32 s99, s3, 72
    s_sub_u32 s38, s2, s99
    s_mul_i32 s3, s3, 1373568
    s_mul_i32 s99, s38, 2688
    s_add_u32 s3, s3, s99
    s_add_u32 s25, s3, 589824
    s_add_u32 s7, s3, 1769472
    s_mov_b32 s20, 31
    s_mov_b32 s21, 4204032
    s_cmp_lt_u32 s2, 244
    s_cselect_b32 s17, 21, 20
    s_mov_b32 s5, 0
    s_mov_b32 s6, 0
    s_cmp_lt_u32 s2, 247
    s_cbranch_scc1 L_inner
    s_mov_b32 s20, 0
    s_mov_b32 s38, 0
    s_sub_u32 s3, s2, 247
    s_and_b32 s3, s3, 3
    s_mul_i32 s3, s3, 7
    s_add_u32 s3, s3, 3
    s_mov_b32 s99, 196224
    s_cmp_lt_u32 s2, 251
    s_cselect_b32 s99, s99, 384
    s_cselect_b32 s6, 1, 0
    s_cselect_b32 s5, 0, 1
    s_mul_i32 s25, s3, s99
    s_mul_i32 s21, s99, 28
    s_cmp_lt_u32 s2, 255
    s_cselect_b32 s17, 18, 1
    s_cselect_b32 s25, s25, 0
    s_cselect_b32 s6, s6, 1
    s_add_u32 s7, s25, 1179648
L_inner:
    s_mul_i32 s3, s5, 99485568
    s_mul_i32 s99, s5, -784896
    v_mov_b32 v136, s3
    v_mov_b32 v138, s99
    s_add_u32 s7, s7, s99
    s_mul_i32 s3, s6, 194688
    s_mul_i32 s99, s6, -1536
    v_mov_b32 v139, s3
    v_mov_b32 v140, s99
    s_add_u32 s7, s7, s99
    v_mul_u32_u24 v141, 2731, v254
    v_bfe_u32 v142, v141, 17, 3
    v_lshrrev_b32 v141, 16, v141
    v_xor_b32 v143, v142, v254
    v_mul_u32_u24 v142, 37, v141
    v_lshrrev_b32 v142, 8, v142
    v_lshlrev_b32 v143, 4, v143
    v_mad_u32_u24 v10, v142, s70, v143
    v_mul_u32_u24 v142, 37, v141
    v_lshrrev_b32 v142, 8, v142
    v_mul_u32_u24 v144, 7, v142
    v_sub_u32 v144, v141, v144
    v_cmp_gt_u32 vcc, 4, v142
    s_nop 1
    v_cndmask_b32 v142, v138, v136, vcc
    v_cmp_gt_u32 vcc, 4, v144
    s_nop 1
    v_cndmask_b32 v144, v140, v139, vcc
    v_add3_u32 v10, v10, v142, v144
    v_mul_u32_u24 v142, s20, v141
    v_add_u32 v142, s38, v142
    v_mul_u32_u24 v142, 911, v142
    v_lshrrev_b32 v142, 16, v142
    v_mul_u32_u24 v142, s22, v142
    v_mad_u32_u24 v142, v141, s21, v142
    v_cmp_gt_u32 vcc, s17, v141
    v_add_u32 v142, s7, v142
    s_nop 0
    v_cndmask_b32 v142, v255, v142, vcc
    v_mul_u32_u24 v141, 384, v141
    v_sub_u32 v141, v143, v141
    v_add_u32 v142, v142, v141
    v_add_u32 v141, 256, v254
    v_mul_u32_u24 v143, 2731, v141
    v_bfe_u32 v144, v143, 17, 3
    v_lshrrev_b32 v143, 16, v143
    v_xor_b32 v141, v144, v141
    v_mul_u32_u24 v144, 37, v143
    v_lshrrev_b32 v144, 8, v144
    v_lshlrev_b32 v141, 4, v141
    v_mad_u32_u24 v11, v144, s70, v141
    v_mul_u32_u24 v144, 37, v143
    v_lshrrev_b32 v144, 8, v144
    v_mul_u32_u24 v145, 7, v144
    v_sub_u32 v145, v143, v145
    v_cmp_gt_u32 vcc, 4, v144
    s_nop 1
    v_cndmask_b32 v144, v138, v136, vcc
    v_cmp_gt_u32 vcc, 4, v145
    s_nop 1
    v_cndmask_b32 v145, v140, v139, vcc
    v_add3_u32 v11, v11, v144, v145
    v_mul_u32_u24 v144, s20, v143
    v_add_u32 v144, s38, v144
    v_mul_u32_u24 v144, 911, v144
    v_lshrrev_b32 v144, 16, v144
    v_mul_u32_u24 v144, s22, v144
    v_mad_u32_u24 v144, v143, s21, v144
    v_cmp_gt_u32 vcc, s17, v143
    v_add_u32 v144, s7, v144
    s_nop 0
    v_cndmask_b32 v144, v255, v144, vcc
    v_mul_u32_u24 v143, 384, v143
    v_sub_u32 v143, v141, v143
    v_add_u32 v144, v144, v143
    s_lshl_b32 s28, s16, 10
    s_add_u32 s28, s28, 20480
    s_waitcnt lgkmcnt(0)
    s_cmp_eq_u32 s16, 2
    s_cselect_b64 s[98:99], s[80:81], s[78:79]
    s_cmp_eq_u32 s16, 3
    s_cselect_b64 s[98:99], s[88:89], s[98:99]
    s_mov_b64 s[8:9], s[76:77]
    v_lshl_add_u64 v[120:121], s[98:99], 0, v[120:121]
    s_cmp_eq_u32 s16, 2
    s_cselect_b64 s[98:99], s[84:85], s[82:83]
    s_cmp_eq_u32 s16, 3
    s_cselect_b64 s[98:99], s[86:87], s[98:99]
    v_writelane_b32 v120, s98, 63
    v_writelane_b32 v121, s99, 63
    s_cmp_eq_u32 s16, 0
    s_cbranch_scc1 L_nowue
    global_load_dword a254, v[120:121], off
L_nowue:
    s_add_u32 m0, s28, 128512
    s_nop 0
    buffer_load_dwordx4 v142, s[8:11], 0 offen lds
    s_add_u32 m0, s28, 132608
    s_nop 0
    buffer_load_dwordx4 v144, s[8:11], 0 offen lds
    s_add_u32 m0, s28, 0
    s_nop 0
    buffer_load_dwordx4 v10, s[8:11], s25 offen lds
    s_add_u32 m0, s28, 4096
    s_nop 0
    buffer_load_dwordx4 v11, s[8:11], s25 offen lds
    s_mov_b64 s[48:49], s[78:79]
    s_mov_b64 s[52:53], s[80:81]
    s_mov_b64 s[60:61], s[84:85]
    s_mov_b64 s[64:65], s[86:87]
    s_mov_b64 s[56:57], s[88:89]
    s_mov_b64 s[46:47], s[82:83]
    s_load_dwordx2 s[42:43], s[0:1], 72
    s_add_u32 m0, s68, 0
    s_add_u32 s4, s45, 384
    v_add_u32 v141, s16, v118
    v_and_b32 v141, 3, v141
    v_lshlrev_b32 v141, 1, v141
    s_mov_b32 s54, 73728
    s_mov_b32 s55, 0x00020000
    s_mov_b32 s62, 64
    s_mov_b32 s63, 0x00020000
    s_mov_b32 s66, 128
    s_mov_b32 s67, 0x00020000
    s_mov_b32 s58, 676
    s_mov_b32 s59, 0x00020000
    s_mov_b32 s14, 0
    s_mov_b32 s15, 0x00020000
    v_mov_b32 v117, 0
    v_cmp_lt_u32 s[90:91], 7, v130
    v_mov_b32 v115, 0
    v_mov_b32 v125, 0
    v_mov_b32 v121, 0
    v_lshlrev_b32 v120, 1, v118
    v_mul_u32_u24 v114, 12, v130
    s_mul_i32 s71, s16, 192
    v_add_u32 v114, s71, v114
    v_lshlrev_b32 v124, 5, v119
    s_mul_i32 s72, s16, 8064
    s_add_u32 s72, s72, 104448
    s_mul_i32 s73, s16, 6528
    s_add_u32 s73, s73, 38912
    v_lshrrev_b32 v127, 2, v130
    v_and_b32 v123, 1, v127
    v_mul_u32_u24 v123, 0x020202, v123
    v_lshl_or_b32 v123, v123, 8, v123
    v_add_u32 v123, 0x05040100, v123
    v_and_b32 v122, 3, v130
    v_lshrrev_b32 v116, 1, v130
    v_xor_b32 v116, v116, v119
    v_mul_u32_u24 v126, 384, v130
    v_lshl_add_u32 v0, v116, 4, v126
    v_xor_b32 v1, 64, v0
    v_and_b32 v116, 2, v119
    v_add_u32 v116, v116, v119
    v_lshl_add_u32 v116, v116, 2, v127
    v_mul_u32_u24 v116, 96, v116
    v_lshl_add_u32 v116, v122, 3, v116
    v_add_u32 v128, s68, v116
    v_add_u32 v126, s69, v116
    v_add_u32 v129, s72, v116
    v_add_u32 v142, s73, v116
    v_mov_b32 v28, 0x3f803f80
    v_mov_b32 v29, 0x3f803f80
    v_mov_b32 v30, 0x3f803f80
    v_mov_b32 v31, 0x3f803f80
    v_mul_u32_u24 v146, 768, v119
    v_add_u32 v146, v114, v146
    v_add_u32 v146, 157184, v146
    s_mov_b32 s76, 0x3f80
    v_and_b32 v143, 1, v130
    v_lshlrev_b32 v143, 4, v143
    v_lshlrev_b32 v144, v143, s76
    v_mov_b32 v145, 0x3c003c00
    v_mov_b32 v44, 1.0
    v_mov_b32 v45, 1.0
    v_lshlrev_b32 v147, 4, v119
    s_mov_b32 s19, s38
    s_mov_b32 s23, s25
    s_mov_b32 s26, 0
    s_mov_b32 s27, 0
    s_mov_b32 s18, 0
    s_add_u32 s19, s19, s20
    s_add_u32 s23, s23, s21
    s_cmp_ge_u32 s19, 72
    s_cselect_b32 s34, 72, 0
    s_cselect_b32 s35, s22, 0
    s_sub_u32 s19, s19, s34
    s_add_u32 s23, s23, s35
    s_mov_b32 s24, s23
    s_add_u32 s19, s19, s20
    s_add_u32 s23, s23, s21
    s_cmp_ge_u32 s19, 72
    s_cselect_b32 s34, 72, 0
    s_cselect_b32 s35, s22, 0
    s_sub_u32 s19, s19, s34
    s_add_u32 s23, s23, s35
    s_mul_i32 s79, s16, 64
    v_lshl_add_u32 v154, v119, 4, s79
    s_mul_i32 s80, s16, 32
    s_add_u32 s80, s80, 256
    v_lshl_add_u32 v150, v119, 3, s80
    v_add_u32 v148, 0, v130
    v_mul_u32_u24 v155, 37, v148
    v_mul_u32_u24 v116, 384, v148
    v_lshrrev_b32 v155, 8, v155
    v_mad_u32_u24 v116, v155, s70, v116
    v_add_u32 v15, v116, v154
    v_add_u32 v18, v116, v150
    v_mul_u32_u24 v149, 37, v148
    v_lshrrev_b32 v149, 8, v149
    v_mul_u32_u24 v156, 7, v149
    v_sub_u32 v156, v148, v156
    v_add_u32 v153, 16, v130
    v_mul_u32_u24 v152, 37, v153
    v_mul_u32_u24 v116, 384, v153
    v_lshrrev_b32 v152, 8, v152
    v_mad_u32_u24 v116, v152, s70, v116
    v_add_u32 v16, v116, v154
    v_add_u32 v19, v116, v150
    v_mul_u32_u24 v158, 37, v153
    v_lshrrev_b32 v158, 8, v158
    v_mul_u32_u24 v157, 7, v158
    v_sub_u32 v157, v153, v157
    v_add_u32 v151, 32, v130
    v_mul_u32_u24 v116, 37, v151
    v_mul_u32_u24 v159, 384, v151
    v_lshrrev_b32 v116, 8, v116
    v_mad_u32_u24 v159, v116, s70, v159
    v_add_u32 v17, v159, v154
    v_add_u32 v20, v159, v150
    v_mul_u32_u24 v154, 37, v151
    v_lshrrev_b32 v154, 8, v154
    v_mul_u32_u24 v150, 7, v154
    v_sub_u32 v150, v151, v150
    s_mul_i32 s81, s16, 768
    s_add_u32 s81, s81, 157184
    v_mul_u32_u24 v155, 24, v155
    v_lshl_add_u32 v155, v148, 2, v155
    v_add_u32 v22, s81, v155
    v_sub_u32 v23, s81, v155
    v_sub_u32 v155, v22, v147
    v_mul_u32_u24 v152, 24, v152
    v_lshl_add_u32 v152, v153, 2, v152
    v_add_u32 v24, s81, v152
    v_sub_u32 v25, s81, v152
    v_sub_u32 v152, v24, v147
    v_mul_u32_u24 v116, 24, v116
    v_lshl_add_u32 v116, v151, 2, v116
    v_add_u32 v26, s81, v116
    v_sub_u32 v27, s81, v116
    v_sub_u32 v116, v26, v147
    v_mul_u32_u24 v160, 148, v119
    s_mov_b32 s82, -24
    v_add_u32 v159, 0, v160
    v_lshrrev_b32 v159, 8, v159
    v_mad_i32_i24 v46, v159, s82, v155
    v_mad_i32_i24 v58, v159, s82, v152
    v_mad_i32_i24 v70, v159, s82, v116
    v_add_u32 v159, 37, v160
    v_lshrrev_b32 v159, 8, v159
    v_mad_i32_i24 v47, v159, s82, v155
    v_mad_i32_i24 v59, v159, s82, v152
    v_mad_i32_i24 v71, v159, s82, v116
    v_add_u32 v159, 74, v160
    v_lshrrev_b32 v159, 8, v159
    v_mad_i32_i24 v48, v159, s82, v155
    v_mad_i32_i24 v60, v159, s82, v152
    v_mad_i32_i24 v72, v159, s82, v116
    v_add_u32 v159, 111, v160
    v_lshrrev_b32 v159, 8, v159
    v_mad_i32_i24 v49, v159, s82, v155
    v_mad_i32_i24 v61, v159, s82, v152
    v_mad_i32_i24 v73, v159, s82, v116
    v_add_u32 v159, 592, v160
    v_lshrrev_b32 v159, 8, v159
    v_mad_i32_i24 v50, v159, s82, v155
    v_mad_i32_i24 v62, v159, s82, v152
    v_mad_i32_i24 v74, v159, s82, v116
    v_add_u32 v159, 629, v160
    v_lshrrev_b32 v159, 8, v159
    v_mad_i32_i24 v51, v159, s82, v155
    v_mad_i32_i24 v63, v159, s82, v152
    v_mad_i32_i24 v75, v159, s82, v116
    v_add_u32 v159, 666, v160
    v_lshrrev_b32 v159, 8, v159
    v_mad_i32_i24 v52, v159, s82, v155
    v_mad_i32_i24 v64, v159, s82, v152
    v_mad_i32_i24 v76, v159, s82, v116
    v_add_u32 v159, 703, v160
    v_lshrrev_b32 v159, 8, v159
    v_mad_i32_i24 v53, v159, s82, v155
    v_mad_i32_i24 v65, v159, s82, v152
    v_mad_i32_i24 v77, v159, s82, v116
    v_add_u32 v159, 1184, v160
    v_lshrrev_b32 v159, 8, v159
    v_mad_i32_i24 v54, v159, s82, v155
    v_mad_i32_i24 v66, v159, s82, v152
    v_mad_i32_i24 v78, v159, s82, v116
    v_add_u32 v159, 1221, v160
    v_lshrrev_b32 v159, 8, v159
    v_mad_i32_i24 v55, v159, s82, v155
    v_mad_i32_i24 v67, v159, s82, v152
    v_mad_i32_i24 v79, v159, s82, v116
    v_add_u32 v159, 1258, v160
    v_lshrrev_b32 v159, 8, v159
    v_mad_i32_i24 v56, v159, s82, v155
    v_mad_i32_i24 v68, v159, s82, v152
    v_mad_i32_i24 v80, v159, s82, v116
    v_add_u32 v159, 1295, v160
    v_lshrrev_b32 v159, 8, v159
    v_mad_i32_i24 v57, v159, s82, v155
    v_mad_i32_i24 v69, v159, s82, v152
    v_mad_i32_i24 v81, v159, s82, v116
    v_mov_b32 v155, s81
    v_lshlrev_b32 v116, 4, v118
    v_xor_b32 v2, 65536, v116
    v_lshl_add_u32 v3, s16, 10, v116
    s_lshr_b32 s83, s16, 1
    s_and_b32 s84, s16, 1
    s_lshl_b32 s84, s84, 3
    s_lshl_b32 s85, s83, 10
    s_add_u32 s85, s85, s84
    v_add_u32 v4, s85, v116
    s_lshl_b32 s83, s83, 11
    s_add_u32 s83, s83, s84
    s_add_u32 s83, s83, 144896
    s_mul_i32 s86, s16, 2048
    s_add_u32 s86, s86, 136704
    v_lshl_add_u32 v152, v119, 3, s86
    v_mov_b32 v160, s83
    v_mov_b32 v161, 161536
    v_mul_u32_u24 v159, 80, v119
    v_add3_u32 v5, v159, v143, s72
    v_lshl_add_u32 v6, v130, 2, s73
    s_mul_i32 s87, s16, 128
    s_add_u32 s87, s87, 65024
    s_mov_b32 s40, s8
    buffer_load_dwordx4 v133, s[48:51], s4 offen lds
    v_add_u32 v9, s87, v147
    v_lshrrev_b32 v116, 1, v119
    s_mov_b32 s41, s9
    s_mov_b32 s32, 0x2a8cbccc
    buffer_load_dwordx4 v135, s[48:51], s4 offen offset:1024 lds
    v_mul_u32_u24 v116, 48, v116
    v_lshl_add_u32 v116, v119, 3, v116
    s_mov_b32 s33, 0x38fba882
    s_add_u32 s75, s28, 16384
    buffer_load_dwordx4 v137, s[48:51], s4 offen offset:2048 lds
    s_add_u32 m0, s68, 3072
    s_add_u32 s4, s45, 37248
    s_cmp_lt_u32 s16, 2
    s_cselect_b32 s29, s75, 160256
    buffer_load_dwordx4 v133, s[48:51], s4 offen lds
    v_lshl_add_u32 v116, v127, 4, v116
    v_lshl_add_u32 v116, v122, 1, v116
    s_cselect_b32 s30, 65536, 0
    s_xor_b32 s74, s29, s30
    buffer_load_dwordx4 v135, s[48:51], s4 offen offset:1024 lds
    v_add_u32 v8, s87, v116
    v_mov_b32 v37, 0
    s_lshl_b32 s92, s5, 1
    s_or_b32 s92, s92, s6
    buffer_load_dwordx4 v137, s[48:51], s4 offen offset:2048 lds
    s_add_u32 m0, s69, 0
    s_add_u32 s4, s45, 74112
    s_mul_i32 s77, s16, 64
    s_mul_i32 s78, s16, 32
    buffer_load_ushort v116, v120, s[60:63], 0 offen
    v_mov_b32 v38, 0
    s_add_u32 s78, s78, 192
    s_add_u32 s34, s18, 2
    buffer_load_dwordx3 v[182:184], v114, s[56:59], 0 offen
    v_mov_b32 v39, 0
    s_mov_b32 s27, s26
    s_mov_b32 s26, s25
    buffer_load_dwordx4 v[174:177], v124, s[64:67], 0 offen
    v_add_u32 v164, 148992, v0
    v_add_u32 v163, 148992, v1
    v_lshlrev_b32 v185, 4, v130
    v_add_u32 v185, 160256, v185
    v_mul_u32_u24 v167, 336, v130
    v_add3_u32 v167, v167, v159, s72
    v_mul_u32_u24 v166, 272, v130
    v_add3_u32 v166, v166, v147, s73
    v_mul_u32_u24 v165, 1088, v119
    v_add_u32 v165, v165, v6
    v_add_u32 v159, 5376, v167
    v_add_u32 v169, 4352, v166
    v_add_u32 v168, 4352, v165
    v_cmp_gt_u32 s[88:89], 16, v118
    v_mov_b32 v162, 0xf149f2ca
    v_add_u32 v170, 512, v254
    v_mul_u32_u24 v114, 2731, v170
    v_bfe_u32 v120, v114, 17, 3
    v_lshrrev_b32 v114, 16, v114
    v_xor_b32 v170, v120, v170
    v_mul_u32_u24 v120, 37, v114
    v_lshrrev_b32 v120, 8, v120
    v_lshlrev_b32 v170, 4, v170
    v_mad_u32_u24 v12, v120, s70, v170
    v_mul_u32_u24 v170, 37, v114
    v_lshrrev_b32 v170, 8, v170
    v_mul_u32_u24 v171, 7, v170
    v_sub_u32 v171, v114, v171
    s_add_u32 s19, s19, s20
    s_mov_b32 s18, 1
    buffer_load_dwordx4 v[198:201], v124, s[64:67], 0 offen offset:16
    v_cmp_gt_u32 vcc, 4, v170
    v_add_u32 v124, 768, v254
    v_mul_u32_u24 v114, 2731, v124
    v_cndmask_b32 v170, v138, v136, vcc
    v_cmp_gt_u32 vcc, 4, v171
    v_bfe_u32 v120, v114, 17, 3
    v_lshrrev_b32 v114, 16, v114
    v_cndmask_b32 v171, v140, v139, vcc
    v_add3_u32 v12, v12, v170, v171
    v_xor_b32 v124, v120, v124
    v_mul_u32_u24 v120, 37, v114
    v_lshrrev_b32 v120, 8, v120
    v_lshlrev_b32 v124, 4, v124
    v_mad_u32_u24 v13, v120, s70, v124
    v_mul_u32_u24 v120, 37, v114
    v_lshrrev_b32 v120, 8, v120
    v_mul_u32_u24 v170, 7, v120
    v_sub_u32 v170, v114, v170
    v_cmp_gt_u32 vcc, 4, v120
    v_add_u32 v114, 1024, v254
    v_mul_u32_u24 v124, 2731, v114
    v_cndmask_b32 v120, v138, v136, vcc
    v_cmp_gt_u32 vcc, 4, v170
    v_bfe_u32 v254, v124, 17, 3
    v_lshrrev_b32 v124, 16, v124
    v_cndmask_b32 v170, v140, v139, vcc
    v_add3_u32 v13, v13, v120, v170
    v_xor_b32 v114, v254, v114
    v_mul_u32_u24 v254, 37, v124
    v_lshrrev_b32 v254, 8, v254
    v_lshlrev_b32 v114, 4, v114
    v_mad_u32_u24 v14, v254, s70, v114
    v_mul_u32_u24 v120, 37, v124
    v_lshrrev_b32 v120, 8, v120
    v_mul_u32_u24 v114, 7, v120
    v_sub_u32 v114, v124, v114
    v_cmp_gt_u32 vcc, 4, v120
    v_mov_b32 v254, 0xc31044fe
    v_mul_u32_u24 v170, 37, v148
    v_cndmask_b32 v120, v138, v136, vcc
    v_cmp_gt_u32 vcc, 4, v114
    v_lshrrev_b32 v170, 8, v170
    v_mul_u32_u24 v171, 7, v170
    v_cndmask_b32 v114, v140, v139, vcc
    v_add3_u32 v14, v14, v120, v114
    v_cmp_gt_u32 vcc, 48, v124
    v_sub_u32 v171, v148, v171
    global_load_ushort v141, v141, s[46:47]
    s_waitcnt vmcnt(10)
    s_barrier
    v_cndmask_b32 v14, v255, v14, vcc
    v_cmp_gt_u32 vcc, 2, v122
    v_lshrrev_b32 v170, 2, v170
    v_lshrrev_b32 v171, 2, v171
    v_cndmask_b32 v32, 0, v144, vcc
    v_cndmask_b32 v33, v144, 0, vcc
    v_cndmask_b32 v34, 0, v144, vcc
    v_cndmask_b32 v35, v144, 0, vcc
    v_cmp_eq_u32 vcc, 0, v143
    v_and_b32 v170, s5, v170
    v_and_b32 v171, s6, v171
    v_cndmask_b32 v40, 0, v145, vcc
    buffer_load_dwordx4 v133, s[48:51], s4 offen lds
    v_cndmask_b32 v41, v145, 0, vcc
    v_cndmask_b32 v42, 0, v145, vcc
    v_cndmask_b32 v43, v145, 0, vcc
    v_cmp_eq_u32 vcc, v119, v127
    v_lshl_or_b32 v170, v170, 1, v171
    v_mul_u32_u24 v255, 37, v153
    v_cndmask_b32 v144, 0, v32, vcc
    v_cndmask_b32 v145, 0, v33, vcc
    v_lshrrev_b32 v255, 8, v255
    v_mul_u32_u24 v114, 7, v255
    v_sub_u32 v114, v153, v114
    v_lshrrev_b32 v255, 2, v255
    v_lshrrev_b32 v114, 2, v114
    v_and_b32 v255, s5, v255
    buffer_load_dwordx4 v135, s[48:51], s4 offen offset:1024 lds
    s_waitcnt vmcnt(10)
    ds_read_b64_tr_b16 a[72:73], v128 offset:0
    ds_read_b64_tr_b16 a[74:75], v128 offset:768
    ds_read_b64_tr_b16 a[96:97], v128 offset:32
    ds_read_b64_tr_b16 a[98:99], v128 offset:800
    ds_read_b64_tr_b16 a[120:121], v128 offset:64
    ds_read_b64_tr_b16 a[122:123], v128 offset:832
    v_and_b32 v114, s6, v114
    v_lshl_or_b32 v255, v255, 1, v114
    v_mul_u32_u24 v171, 37, v151
    v_lshrrev_b32 v171, 8, v171
    v_mul_u32_u24 v114, 7, v171
    v_sub_u32 v114, v151, v114
    v_lshrrev_b32 v171, 2, v171
    buffer_load_dwordx4 v137, s[48:51], s4 offen offset:2048 lds
    s_add_u32 m0, s69, 3072
    s_add_u32 s4, s45, 110976
    v_lshrrev_b32 v114, 2, v114
    v_and_b32 v171, s5, v171
    v_and_b32 v114, s6, v114
    v_lshl_or_b32 v171, v171, 1, v114
    v_mul_u32_u24 v120, 6, v131
    v_sub_u32 v124, v118, v120
    v_mul_u32_u24 v120, 384, v131
    v_lshl_add_u32 v120, v124, 4, v120
    v_add_u32 v114, s78, v120
    v_add_u32 v120, s77, v120
    v_cmp_gt_i32 vcc, 4, v124
    v_mul_u32_u24 v124, 6, v132
    buffer_load_dwordx4 v133, s[48:51], s4 offen lds
    v_cndmask_b32 v143, v114, v120, vcc
    v_sub_u32 v120, v118, v124
    v_mul_u32_u24 v124, 384, v132
    v_lshl_add_u32 v124, v120, 4, v124
    v_add_u32 v114, s78, v124
    v_add_u32 v124, s77, v124
    v_cmp_gt_i32 vcc, -60, v120
    v_mul_u32_u24 v131, 6, v134
    v_sub_u32 v148, v118, v131
    v_cndmask_b32 v132, v114, v124, vcc
    v_mul_u32_u24 v131, 384, v134
    v_lshl_add_u32 v131, v148, 4, v131
    s_waitcnt vmcnt(9)
    ds_read_b64_tr_b16 a[76:77], v128 offset:3072
    ds_read_b64_tr_b16 a[78:79], v128 offset:3840
    s_waitcnt vmcnt(7)
    buffer_load_dwordx4 v135, s[48:51], s4 offen offset:1024 lds
    s_waitcnt vmcnt(7)
    s_waitcnt vmcnt(6)
    ds_read_b64_tr_b16 a[100:101], v128 offset:3104
    ds_read_b64_tr_b16 a[102:103], v128 offset:3872
    ds_read_b64_tr_b16 a[124:125], v128 offset:3136
    ds_read_b64_tr_b16 a[126:127], v128 offset:3904
    v_cndmask_b32 v174, v174, v175, s[90:91]
    v_cndmask_b32 v176, v176, v177, s[90:91]
    v_perm_b32 v172, v176, v174, v123
    v_cndmask_b32 v198, v198, v199, s[90:91]
    v_cndmask_b32 v200, v200, v201, s[90:91]
    v_perm_b32 v173, v200, v198, v123
    v_bfe_u32 v114, v182, v147, 16
    v_bfe_u32 v124, v183, v147, 16
    buffer_load_dwordx4 v137, s[48:51], s4 offen offset:2048 lds
    v_mfma_f32_16x16x16_bf16 v[174:177], v[116:117], v[114:115], 0
    v_bfe_u32 v120, v184, v147, 16
    v_add_u32 v151, s78, v131
    v_add_u32 v131, s77, v131
    v_mfma_f32_16x16x16_bf16 v[198:201], v[116:117], v[124:125], 0
    v_cmp_gt_i32 vcc, -124, v148
    v_mul_u32_u24 v148, 96, v130
    v_add3_u32 v134, v148, v147, s68
    v_mfma_f32_16x16x16_bf16 v[210:213], v[116:117], v[120:121], 0
    s_add_u32 m0, s72, 0
    s_add_u32 s4, s45, 147840
    v_max_f32 v174, 0, v174
    v_max_f32 v175, 0, v175
    v_max_f32 v176, 0, v176
    buffer_load_dwordx4 v133, s[48:51], s4 offen lds
    s_waitcnt vmcnt(7)
    v_max_f32 v177, 0, v177
    v_cvt_pk_bf16_f32 v120, v174, v175
    v_cvt_pk_bf16_f32 v121, v176, v177
    v_max_f32 v198, 0, v198
    v_max_f32 v199, 0, v199
    v_mfma_f32_16x16x16_bf16 v[114:117], v[172:173], v[120:121], 0
    v_max_f32 v200, 0, v200
    v_max_f32 v201, 0, v201
    v_cvt_pk_bf16_f32 v120, v198, v199
    v_cvt_pk_bf16_f32 v121, v200, v201
    v_max_f32 v210, 0, v210
    v_max_f32 v211, 0, v211
    v_mfma_f32_16x16x16_bf16 v[174:177], v[172:173], v[120:121], 0
    buffer_load_dwordx4 v135, s[48:51], s4 offen offset:1024 lds
    v_cvt_pk_bf16_f32 v114, v114, v114
    v_and_b32 v114, 0xffff0000, v114
    v_mul_f32 v114, 0xbfb8aa3b, v114
    v_exp_f32 v114, v114
    v_max_f32 v212, 0, v212
    v_add_f32 v114, 1.0, v114
    v_rcp_f32 v114, v114
    v_cvt_pk_bf16_f32 v174, v174, v174
    v_cvt_pk_bf16_f32 v114, v114, v114
    v_and_b32 v114, 0xffff0000, v114
    v_add_f32 v114, -0.5, v114
    v_mul_f32 v114, 0x41b8aa3b, v114
    buffer_load_dwordx4 v137, s[48:51], s4 offen offset:2048 lds
    ds_write_b32 v146, v114 offset:0
    s_add_u32 m0, s72, 3072
    s_add_u32 s4, s45, 184704
    v_and_b32 v174, 0xffff0000, v174
    v_mul_f32 v174, 0xbfb8aa3b, v174
    v_exp_f32 v174, v174
    v_max_f32 v213, 0, v213
    v_add_f32 v174, 1.0, v174
    v_rcp_f32 v174, v174
    v_cvt_pk_bf16_f32 v210, v210, v211
    v_cvt_pk_bf16_f32 v174, v174, v174
    s_waitcnt vmcnt(6)
    buffer_load_dwordx4 v133, s[48:51], s4 offen lds
    ds_read_b64_tr_b16 a[80:81], v126 offset:0
    ds_read_b64_tr_b16 a[82:83], v126 offset:768
    ds_read_b64_tr_b16 a[104:105], v126 offset:32
    ds_read_b64_tr_b16 a[106:107], v126 offset:800
    ds_read_b64_tr_b16 a[128:129], v126 offset:64
    ds_read_b64_tr_b16 a[130:131], v126 offset:832
    v_and_b32 v174, 0xffff0000, v174
    v_add_f32 v174, -0.5, v174
    v_mul_f32 v174, 0x41b8aa3b, v174
    ds_write_b32 v146, v174 offset:4
    v_cvt_pk_bf16_f32 v211, v212, v213
    buffer_load_dwordx4 v135, s[48:51], s4 offen offset:1024 lds
    v_lshlrev_b32 v141, 16, v141
    v_mfma_f32_16x16x16_bf16 v[114:117], v[172:173], v[210:211], 0
    v_max_f32 v141, 0xc2c80000, v141
    v_min_f32 v141, 0x40930000, v141
    v_mul_f32 v141, 0x3fb8aa3b, v141
    v_exp_f32 v141, v141
    v_cndmask_b32 v118, v151, v131, vcc
    v_cvt_pk_bf16_f32 v141, v141, v141
    v_and_b32 v141, 0xffff0000, v141
    v_mul_f32 v131, 0x3fb8aa3b, v141
    v_cvt_pk_bf16_f32 v114, v114, v114
    v_and_b32 v114, 0xffff0000, v114
    v_mul_f32 v114, 0xbfb8aa3b, v114
    buffer_load_dwordx4 v137, s[48:51], s4 offen offset:2048 lds
    s_add_u32 m0, s73, 0
    s_add_u32 s4, s45, 36864
    v_exp_f32 v114, v114
    v_readfirstlane_b32 s37, v141
    v_add_f32 v114, 1.0, v114
    v_rcp_f32 v114, v114
    v_readfirstlane_b32 s31, v131
    v_cvt_pk_bf16_f32 v114, v114, v114
    v_and_b32 v114, 0xffff0000, v114
    v_add_f32 v114, -0.5, v114
    v_mul_f32 v114, 0x41b8aa3b, v114
    ds_write_b32 v146, v114 offset:8
    s_waitcnt vmcnt(6)
    buffer_load_dwordx4 v133, s[48:51], s45 offen lds
    v_cmp_gt_u32 vcc, 4, v149
    ds_read_b64_tr_b16 a[84:85], v126 offset:3072
    ds_read_b64_tr_b16 a[86:87], v126 offset:3840
    ds_read_b64_tr_b16 a[108:109], v126 offset:3104
    ds_read_b64_tr_b16 a[110:111], v126 offset:3872
    ds_read_b64_tr_b16 a[132:133], v126 offset:3136
    ds_read_b64_tr_b16 a[134:135], v126 offset:3904
    v_cndmask_b32 v149, v138, v136, vcc
    v_cmp_gt_u32 vcc, 4, v156
    v_lshl_add_u32 v120, v119, 3, v148
    v_add3_u32 v120, v120, 64, s68
    v_cndmask_b32 v156, v140, v139, vcc
    buffer_load_dwordx4 v135, s[48:51], s45 offen offset:1024 lds
    v_add3_u32 v15, v15, v149, v156
    v_add3_u32 v18, v18, v149, v156
    v_cmp_gt_u32 vcc, 4, v158
    v_add3_u32 v131, v148, v147, s69
    v_lshl_add_u32 v121, v119, 3, v148
    s_waitcnt lgkmcnt(6)
    s_barrier
    ds_read_b32 v22, v22 offset:0
    ds_read_b32 v23, v23 offset:672
    ds_read_b32 v24, v24 offset:0
    ds_read_b32 v25, v25 offset:672
    ds_read_b32 v26, v26 offset:0
    ds_read_b32 v27, v27 offset:672
    ds_read_b32 v46, v46 offset:336
    ds_read_b32 v58, v58 offset:336
    buffer_load_dwordx4 v137, s[48:51], s45 offen offset:2048 lds
    ds_read_b32 v70, v70 offset:336
    ds_read_b32 v47, v47 offset:332
    ds_read_b32 v59, v59 offset:332
    s_add_u32 m0, s73, 3072
    ds_read_b32 v71, v71 offset:332
    v_cndmask_b32 v158, v138, v136, vcc
    v_cmp_gt_u32 vcc, 4, v157
    ds_read_b32 v48, v48 offset:328
    ds_read_b32 v60, v60 offset:328
    ds_read_b32 v72, v72 offset:328
    ds_read_b32 v49, v49 offset:324
    s_waitcnt vmcnt(6)
    ds_read_b64_tr_b16 a[88:89], v129 offset:0
    buffer_load_dwordx4 v133, s[48:51], s4 offen lds
    ds_read_b64_tr_b16 a[90:91], v129 offset:768
    ds_read_b64_tr_b16 a[112:113], v129 offset:32
    ds_read_b64_tr_b16 a[114:115], v129 offset:800
    ds_read_b64_tr_b16 a[136:137], v129 offset:64
    ds_read_b64_tr_b16 a[138:139], v129 offset:832
    v_cndmask_b32 v157, v140, v139, vcc
    v_add3_u32 v16, v16, v158, v157
    v_add3_u32 v19, v19, v158, v157
    v_cmp_gt_u32 vcc, 4, v154
    ds_read_b32 v61, v61 offset:324
    ds_read_b32 v73, v73 offset:324
    ds_read_b32 v50, v50 offset:272
    buffer_load_dwordx4 v135, s[48:51], s4 offen offset:1024 lds
    ds_read_b32 v62, v62 offset:272
    ds_read_b32 v74, v74 offset:272
    ds_read_b32 v51, v51 offset:268
    ds_read_b32 v63, v63 offset:268
    ds_read_b32 v75, v75 offset:268
    v_cndmask_b32 v154, v138, v136, vcc
    v_cmp_gt_u32 vcc, 4, v150
    ds_read_b32 v52, v52 offset:264
    ds_read_b32 v64, v64 offset:264
    ds_read_b32 v76, v76 offset:264
    ds_read_b32 v53, v53 offset:260
    v_cndmask_b32 v150, v140, v139, vcc
    buffer_load_dwordx4 v137, s[48:51], s4 offen offset:2048 lds
    ds_read_b32 v65, v65 offset:260
    ds_read_b32 v77, v77 offset:260
    ds_read_b32 v54, v54 offset:208
    ds_read_b32 v66, v66 offset:208
    ds_read_b32 v78, v78 offset:208
    s_add_u32 m0, s68, 0
    ds_read_b32 v55, v55 offset:204
    s_add_u32 s4, s45, 73728
    ds_read_b32 v67, v67 offset:204
    v_add3_u32 v17, v17, v154, v150
    v_add3_u32 v20, v20, v154, v150
    v_cmp_gt_u32 vcc, 2, v119
    ds_read_b32 v79, v79 offset:204
    s_waitcnt vmcnt(6)
    buffer_load_dwordx4 v133, s[48:51], s4 offen lds
    ds_read_b64_tr_b16 a[92:93], v129 offset:3072
    ds_read_b64_tr_b16 a[94:95], v129 offset:3840
    ds_read_b64_tr_b16 a[116:117], v129 offset:3104
    ds_read_b64_tr_b16 a[118:119], v129 offset:3872
    ds_read_b64_tr_b16 a[140:141], v129 offset:3136
    ds_read_b64_tr_b16 a[142:143], v129 offset:3904
    ds_read_b32 v56, v56 offset:200
    v_cndmask_b32 v152, v160, v152, vcc
    v_lshl_add_u32 v152, v127, 9, v152
    v_lshl_add_u32 v152, v122, 1, v152
    v_cmp_gt_u32 vcc, 3, v119
    ds_read_b32 v68, v68 offset:200
    ds_read_b32 v80, v80 offset:200
    ds_read_b32 v57, v57 offset:196
    buffer_load_dwordx4 v135, s[48:51], s4 offen offset:1024 lds
    ds_read_b32 v69, v69 offset:196
    ds_read_b32 v81, v81 offset:196
    ds_read_b32 v155, v155 offset:336
    v_cndmask_b32 v7, v161, v152, vcc
    v_cmp_gt_u32 vcc, 8, v130
    v_lshl_add_u32 v130, v119, 2, 0
    v_mul_u32_u24 v129, 37, v130
    v_cndmask_b32 v159, v185, v159, vcc
    v_cndmask_b32 v169, v185, v169, vcc
    v_cmp_gt_u32 vcc, 2, v119
    v_lshrrev_b32 v129, 8, v129
    v_mul_u32_u24 v127, 7, v129
    v_cndmask_b32 v168, v185, v168, vcc
    v_cmp_ne_u32 vcc, s92, v170
    buffer_load_dwordx4 v137, s[48:51], s4 offen offset:2048 lds
    s_add_u32 m0, s68, 3072
    s_add_u32 s4, s45, 110592
    v_cndmask_b32 v136, 0, v254, vcc
    s_waitcnt lgkmcnt(6)
    v_add_f32 v22, v22, v136
    v_cmp_ne_u32 vcc, s92, v170
    v_sub_u32 v127, v130, v127
    v_lshrrev_b32 v129, 2, v129
    v_cndmask_b32 v130, 0, v254, vcc
    v_add_f32 v23, v23, v130
    v_cmp_ne_u32 vcc, s92, v255
    v_lshrrev_b32 v127, 2, v127
    s_waitcnt lgkmcnt(0)
    v_readfirstlane_b32 s39, v155
    buffer_load_dwordx4 v133, s[48:51], s4 offen lds
    s_waitcnt vmcnt(7)
    ds_read_b64_tr_b16 a[0:1], v142 offset:0
    ds_read_b64_tr_b16 a[2:3], v142 offset:768
    ds_read_b64_tr_b16 a[24:25], v142 offset:32
    ds_read_b64_tr_b16 a[26:27], v142 offset:800
    ds_read_b64_tr_b16 a[48:49], v142 offset:64
    ds_read_b64_tr_b16 a[50:51], v142 offset:832
    v_cndmask_b32 v130, 0, v254, vcc
    v_add_f32 v24, v24, v130
    v_cmp_ne_u32 vcc, s92, v255
    v_and_b32 v129, s5, v129
    v_and_b32 v127, s6, v127
    v_cndmask_b32 v130, 0, v254, vcc
    v_add_f32 v25, v25, v130
    buffer_load_dwordx4 v135, s[48:51], s4 offen offset:1024 lds
    v_cmp_ne_u32 vcc, s92, v171
    v_lshl_or_b32 v129, v129, 1, v127
    v_lshl_add_u32 v127, v119, 2, 1
    v_cndmask_b32 v130, 0, v254, vcc
    v_add_f32 v26, v26, v130
    v_cmp_ne_u32 vcc, s92, v171
    v_mul_u32_u24 v130, 37, v127
    v_lshrrev_b32 v130, 8, v130
    v_cndmask_b32 v136, 0, v254, vcc
    v_add_f32 v27, v27, v136
    v_cmp_ne_u32 vcc, v129, v170
    v_mul_u32_u24 v136, 7, v130
    v_sub_u32 v136, v127, v136
    v_cndmask_b32 v127, 0, v254, vcc
    buffer_load_dwordx4 v137, s[48:51], s4 offen offset:2048 lds
    s_add_u32 m0, s69, 0
    s_add_u32 s4, s45, 147456
    v_add_f32 v46, v46, v127
    v_cmp_ne_u32 vcc, v129, v255
    v_lshrrev_b32 v130, 2, v130
    v_lshrrev_b32 v136, 2, v136
    v_cndmask_b32 v127, 0, v254, vcc
    v_add_f32 v58, v58, v127
    v_cmp_ne_u32 vcc, v129, v171
    v_and_b32 v130, s5, v130
    v_and_b32 v136, s6, v136
    v_cndmask_b32 v127, 0, v254, vcc
    v_add_f32 v70, v70, v127
    v_lshl_or_b32 v130, v130, 1, v136
    buffer_load_dwordx4 v133, s[48:51], s4 offen lds
    s_waitcnt vmcnt(7)
    ds_read_b64_tr_b16 a[4:5], v142 offset:3072
    ds_read_b64_tr_b16 a[6:7], v142 offset:3840
    ds_read_b64_tr_b16 a[28:29], v142 offset:3104
    ds_read_b64_tr_b16 a[30:31], v142 offset:3872
    ds_read_b64_tr_b16 a[52:53], v142 offset:3136
    ds_read_b64_tr_b16 a[54:55], v142 offset:3904
    v_cmp_ne_u32 vcc, v130, v170
    v_lshl_add_u32 v136, v119, 2, 2
    v_mul_u32_u24 v142, 37, v136
    v_cndmask_b32 v127, 0, v254, vcc
    v_add_f32 v47, v47, v127
    v_cmp_ne_u32 vcc, v130, v255
    v_lshrrev_b32 v142, 8, v142
    buffer_load_dwordx4 v135, s[48:51], s4 offen offset:1024 lds
    v_cndmask_b32 v127, 0, v254, vcc
    v_add_f32 v59, v59, v127
    v_cmp_ne_u32 vcc, v130, v171
    v_mul_u32_u24 v127, 7, v142
    v_sub_u32 v127, v136, v127
    v_cndmask_b32 v130, 0, v254, vcc
    v_add_f32 v71, v71, v130
    v_lshrrev_b32 v142, 2, v142
    v_lshrrev_b32 v127, 2, v127
    v_and_b32 v142, s5, v142
    v_and_b32 v127, s6, v127
    v_lshl_or_b32 v142, v142, 1, v127
    v_cmp_ne_u32 vcc, v142, v170
    v_lshl_add_u32 v130, v119, 2, 3
    buffer_load_dwordx4 v137, s[48:51], s4 offen offset:2048 lds
    s_add_u32 m0, s69, 3072
    s_add_u32 s4, s45, 184320
    v_cndmask_b32 v136, 0, v254, vcc
    v_add_f32 v48, v48, v136
    v_cmp_ne_u32 vcc, v142, v255
    v_mul_u32_u24 v127, 37, v130
    v_lshrrev_b32 v127, 8, v127
    v_cndmask_b32 v136, 0, v254, vcc
    v_add_f32 v60, v60, v136
    v_cmp_ne_u32 vcc, v142, v171
    v_mul_u32_u24 v129, 7, v127
    v_sub_u32 v129, v130, v129
    v_cndmask_b32 v130, 0, v254, vcc
    v_add_f32 v72, v72, v130
    buffer_load_dwordx4 v133, s[48:51], s4 offen lds
    s_waitcnt vmcnt(7)
    ds_read_b64_tr_b16 a[8:9], v128 offset:0
    ds_read_b64_tr_b16 a[10:11], v128 offset:768
    ds_read_b64_tr_b16 a[32:33], v128 offset:32
    ds_read_b64_tr_b16 a[34:35], v128 offset:800
    ds_read_b64_tr_b16 a[56:57], v128 offset:64
    ds_read_b64_tr_b16 a[58:59], v128 offset:832
    v_lshrrev_b32 v127, 2, v127
    v_lshrrev_b32 v129, 2, v129
    v_and_b32 v127, s5, v127
    v_and_b32 v129, s6, v129
    v_lshl_or_b32 v127, v127, 1, v129
    v_cmp_ne_u32 vcc, v127, v170
    v_lshl_add_u32 v130, v119, 2, 16
    buffer_load_dwordx4 v135, s[48:51], s4 offen offset:1024 lds
    v_cndmask_b32 v129, 0, v254, vcc
    v_add_f32 v49, v49, v129
    v_cmp_ne_u32 vcc, v127, v255
    v_mul_u32_u24 v142, 37, v130
    v_lshrrev_b32 v142, 8, v142
    v_cndmask_b32 v129, 0, v254, vcc
    v_add_f32 v61, v61, v129
    v_cmp_ne_u32 vcc, v127, v171
    v_mul_u32_u24 v136, 7, v142
    v_sub_u32 v136, v130, v136
    v_cndmask_b32 v130, 0, v254, vcc
    v_add_f32 v73, v73, v130
    v_lshrrev_b32 v142, 2, v142
    v_lshrrev_b32 v136, 2, v136
    buffer_load_dwordx4 v137, s[48:51], s4 offen offset:2048 lds
    s_add_u32 m0, s68, 0
    s_add_u32 s4, s45, 768
    s_waitcnt lgkmcnt(0)
    v_and_b32 v142, s5, v142
    v_and_b32 v136, s6, v136
    v_lshl_or_b32 v142, v142, 1, v136
    v_cmp_ne_u32 vcc, v142, v170
    v_lshl_add_u32 v127, v119, 2, 17
    v_mul_u32_u24 v130, 37, v127
    v_cndmask_b32 v136, 0, v254, vcc
    v_add_f32 v50, v50, v136
    v_cmp_ne_u32 vcc, v142, v255
    v_lshrrev_b32 v130, 8, v130
    v_mul_u32_u24 v136, 7, v130
    buffer_load_dwordx4 v133, s[48:51], s4 offen lds
    s_waitcnt vmcnt(7)
    ds_read_b64_tr_b16 a[12:13], v128 offset:3072
    ds_read_b64_tr_b16 a[14:15], v128 offset:3840
    ds_read_b64_tr_b16 a[36:37], v128 offset:3104
    ds_read_b64_tr_b16 a[38:39], v128 offset:3872
    ds_read_b64_tr_b16 a[60:61], v128 offset:3136
    ds_read_b64_tr_b16 a[62:63], v128 offset:3904
    v_cndmask_b32 v129, 0, v254, vcc
    v_add_f32 v62, v62, v129
    v_cmp_ne_u32 vcc, v142, v171
    v_sub_u32 v136, v127, v136
    v_lshrrev_b32 v130, 2, v130
    v_cndmask_b32 v142, 0, v254, vcc
    v_add_f32 v74, v74, v142
    buffer_load_dwordx4 v135, s[48:51], s4 offen offset:1024 lds
    v_lshrrev_b32 v136, 2, v136
    v_and_b32 v130, s5, v130
    v_and_b32 v136, s6, v136
    v_lshl_or_b32 v130, v130, 1, v136
    v_cmp_ne_u32 vcc, v130, v170
    v_lshl_add_u32 v127, v119, 2, 18
    v_mul_u32_u24 v142, 37, v127
    v_cndmask_b32 v136, 0, v254, vcc
    v_add_f32 v51, v51, v136
    v_cmp_ne_u32 vcc, v130, v255
    v_lshrrev_b32 v142, 8, v142
    v_mul_u32_u24 v129, 7, v142
    v_cndmask_b32 v136, 0, v254, vcc
    v_add_f32 v63, v63, v136
    buffer_load_dwordx4 v137, s[48:51], s4 offen offset:2048 lds
    s_add_u32 m0, s68, 3072
    s_add_u32 s4, s45, 37632
    s_waitcnt lgkmcnt(0)
    v_cmp_ne_u32 vcc, v130, v171
    v_sub_u32 v129, v127, v129
    v_lshrrev_b32 v142, 2, v142
    v_cndmask_b32 v130, 0, v254, vcc
    v_add_f32 v75, v75, v130
    v_lshrrev_b32 v129, 2, v129
    v_and_b32 v142, s5, v142
    v_and_b32 v129, s6, v129
    v_lshl_or_b32 v142, v142, 1, v129
    v_cmp_ne_u32 vcc, v142, v170
    v_lshl_add_u32 v136, v119, 2, 19
    buffer_load_dwordx4 v133, s[48:51], s4 offen lds
    s_waitcnt vmcnt(7)
    ds_read_b64_tr_b16 a[16:17], v126 offset:0
    ds_read_b64_tr_b16 a[18:19], v126 offset:768
    ds_read_b64_tr_b16 a[40:41], v126 offset:32
    ds_read_b64_tr_b16 a[42:43], v126 offset:800
    ds_read_b64_tr_b16 a[64:65], v126 offset:64
    ds_read_b64_tr_b16 a[66:67], v126 offset:832
    v_cndmask_b32 v130, 0, v254, vcc
    v_add_f32 v52, v52, v130
    v_cmp_ne_u32 vcc, v142, v255
    v_mul_u32_u24 v127, 37, v136
    v_lshrrev_b32 v127, 8, v127
    v_cndmask_b32 v130, 0, v254, vcc
    v_add_f32 v64, v64, v130
    buffer_load_dwordx4 v135, s[48:51], s4 offen offset:1024 lds
    v_cmp_ne_u32 vcc, v142, v171
    v_mul_u32_u24 v130, 7, v127
    v_sub_u32 v130, v136, v130
    v_cndmask_b32 v136, 0, v254, vcc
    v_add_f32 v76, v76, v136
    v_lshrrev_b32 v127, 2, v127
    v_lshrrev_b32 v130, 2, v130
    v_and_b32 v127, s5, v127
    v_and_b32 v130, s6, v130
    v_lshl_or_b32 v127, v127, 1, v130
    v_cmp_ne_u32 vcc, v127, v170
    v_lshl_add_u32 v130, v119, 2, 32
    v_mul_u32_u24 v142, 37, v130
    v_cndmask_b32 v136, 0, v254, vcc
    buffer_load_dwordx4 v137, s[48:51], s4 offen offset:2048 lds
    s_add_u32 m0, s69, 0
    s_add_u32 s4, s45, 74496
    s_waitcnt lgkmcnt(0)
    v_add_f32 v53, v53, v136
    v_cmp_ne_u32 vcc, v127, v255
    v_lshrrev_b32 v142, 8, v142
    v_mul_u32_u24 v136, 7, v142
    v_cndmask_b32 v129, 0, v254, vcc
    v_add_f32 v65, v65, v129
    v_cmp_ne_u32 vcc, v127, v171
    v_sub_u32 v136, v130, v136
    v_lshrrev_b32 v142, 2, v142
    v_cndmask_b32 v130, 0, v254, vcc
    v_add_f32 v77, v77, v130
    buffer_load_dwordx4 v133, s[48:51], s4 offen lds
    s_waitcnt vmcnt(7)
    ds_read_b64_tr_b16 a[20:21], v126 offset:3072
    ds_read_b64_tr_b16 a[22:23], v126 offset:3840
    ds_read_b64_tr_b16 a[44:45], v126 offset:3104
    ds_read_b64_tr_b16 a[46:47], v126 offset:3872
    ds_read_b64_tr_b16 a[68:69], v126 offset:3136
    ds_read_b64_tr_b16 a[70:71], v126 offset:3904
    v_lshrrev_b32 v136, 2, v136
    v_and_b32 v142, s5, v142
    v_and_b32 v136, s6, v136
    v_lshl_or_b32 v142, v142, 1, v136
    v_cmp_ne_u32 vcc, v142, v170
    v_lshl_add_u32 v130, v119, 2, 33
    v_mul_u32_u24 v136, 37, v130
    buffer_load_dwordx4 v135, s[48:51], s4 offen offset:1024 lds
    v_cndmask_b32 v127, 0, v254, vcc
    v_add_f32 v54, v54, v127
    v_cmp_ne_u32 vcc, v142, v255
    v_lshrrev_b32 v136, 8, v136
    v_mul_u32_u24 v127, 7, v136
    v_cndmask_b32 v129, 0, v254, vcc
    v_add_f32 v66, v66, v129
    v_cmp_ne_u32 vcc, v142, v171
    v_sub_u32 v127, v130, v127
    v_lshrrev_b32 v136, 2, v136
    v_cndmask_b32 v129, 0, v254, vcc
    v_add_f32 v78, v78, v129
    v_lshrrev_b32 v127, 2, v127
    v_and_b32 v136, s5, v136
    buffer_load_dwordx4 v137, s[48:51], s4 offen offset:2048 lds
    s_add_u32 m0, s69, 3072
    s_add_u32 s4, s45, 111360
    s_waitcnt lgkmcnt(0)
    v_and_b32 v127, s6, v127
    v_lshl_or_b32 v136, v136, 1, v127
    v_cmp_ne_u32 vcc, v136, v170
    v_lshl_add_u32 v130, v119, 2, 34
    v_mul_u32_u24 v129, 37, v130
    v_cndmask_b32 v127, 0, v254, vcc
    v_add_f32 v55, v55, v127
    v_cmp_ne_u32 vcc, v136, v255
    v_lshrrev_b32 v129, 8, v129
    v_mul_u32_u24 v142, 7, v129
    v_cndmask_b32 v127, 0, v254, vcc
    buffer_load_dwordx4 v133, s[48:51], s4 offen lds
    s_waitcnt vmcnt(7)
    ds_read_b64_tr_b16 a[144:145], v128 offset:0
    ds_read_b64_tr_b16 a[146:147], v128 offset:768
    ds_read_b64_tr_b16 a[168:169], v128 offset:32
    ds_read_b64_tr_b16 a[170:171], v128 offset:800
    ds_read_b64_tr_b16 a[192:193], v128 offset:64
    ds_read_b64_tr_b16 a[194:195], v128 offset:832
    v_add_f32 v67, v67, v127
    v_cmp_ne_u32 vcc, v136, v171
    v_sub_u32 v142, v130, v142
    v_lshrrev_b32 v129, 2, v129
    v_cndmask_b32 v127, 0, v254, vcc
    v_add_f32 v79, v79, v127
    v_lshrrev_b32 v142, 2, v142
    buffer_load_dwordx4 v135, s[48:51], s4 offen offset:1024 lds
    v_and_b32 v129, s5, v129
    v_and_b32 v142, s6, v142
    v_lshl_or_b32 v129, v129, 1, v142
    v_cmp_ne_u32 vcc, v129, v170
    v_lshl_add_u32 v130, v119, 2, 35
    v_mul_u32_u24 v119, 37, v130
    v_cndmask_b32 v127, 0, v254, vcc
    v_add_f32 v56, v56, v127
    v_cmp_ne_u32 vcc, v129, v255
    v_lshrrev_b32 v119, 8, v119
    v_mul_u32_u24 v136, 7, v119
    v_cndmask_b32 v127, 0, v254, vcc
    v_add_f32 v68, v68, v127
    v_cmp_ne_u32 vcc, v129, v171
    buffer_load_dwordx4 v137, s[48:51], s4 offen offset:2048 lds
    s_add_u32 m0, s68, 0
    s_add_u32 s4, s45, 148224
    s_waitcnt lgkmcnt(0)
    v_cndmask_b32 v142, 0, v254, vcc
    v_add_f32 v80, v80, v142
    v_sub_u32 v136, v130, v136
    v_lshrrev_b32 v119, 2, v119
    v_lshrrev_b32 v136, 2, v136
    v_and_b32 v119, s5, v119
    v_and_b32 v136, s6, v136
    v_lshl_or_b32 v119, v119, 1, v136
    v_cmp_ne_u32 vcc, v119, v170
    v_cndmask_b32 v22, v162, v22, s[88:89]
    v_cndmask_b32 v24, v162, v24, s[88:89]
    buffer_load_dwordx4 v133, s[48:51], s4 offen lds
    s_waitcnt vmcnt(7)
    ds_read_b64_tr_b16 a[148:149], v128 offset:3072
    ds_read_b64_tr_b16 a[150:151], v128 offset:3840
    ds_read_b64_tr_b16 a[172:173], v128 offset:3104
    ds_read_b64_tr_b16 a[174:175], v128 offset:3872
    ds_read_b64_tr_b16 a[196:197], v128 offset:3136
    ds_read_b64_tr_b16 a[198:199], v128 offset:3904
    v_cndmask_b32 v130, 0, v254, vcc
    v_add_f32 v57, v57, v130
    v_cmp_ne_u32 vcc, v119, v255
    v_cndmask_b32 v26, v162, v26, s[88:89]
    v_add3_u32 v121, v121, 64, s69
    v_cndmask_b32 v130, 0, v254, vcc
    v_add_f32 v69, v69, v130
    buffer_load_dwordx4 v135, s[48:51], s4 offen offset:1024 lds
    v_cmp_ne_u32 vcc, v119, v171
    v_mov_b32 v122, 0
    v_mov_b32 v123, 0
    v_cndmask_b32 v119, 0, v254, vcc
    v_add_f32 v81, v81, v119
    ds_read_b128 v[198:201], v164 offset:0
    ds_read_b128 v[114:117], v163 offset:0
    ds_read_b128 v[182:185], v164 offset:128
    ds_read_b128 v[138:141], v163 offset:128
    ds_read_b128 v[170:173], v164 offset:256
    buffer_load_dwordx4 v137, s[48:51], s4 offen offset:2048 lds
    s_add_u32 m0, s68, 3072
    ds_read_b128 v[174:177], v163 offset:256
    s_add_u32 s4, s45, 185088
    s_waitcnt lgkmcnt(6)
    v_mov_b32 v124, 0
    v_mov_b32 v125, 0
    ds_write_b128 v167, v[122:125] offset:16
    s_waitcnt vmcnt(6)
    buffer_load_dwordx4 v133, s[48:51], s4 offen lds
    s_waitcnt lgkmcnt(4)
    v_mfma_f32_16x16x32_bf16 v[146:149], a[72:75], v[198:201], 0
    v_mfma_f32_16x16x32_bf16 v[146:149], a[76:79], v[114:117], v[146:149]
    s_waitcnt lgkmcnt(3)
    ds_read_b64_tr_b16 a[152:153], v126 offset:0
    ds_read_b64_tr_b16 a[154:155], v126 offset:768
    v_mfma_f32_16x16x32_bf16 v[146:149], a[80:83], v[182:185], v[146:149]
    s_waitcnt lgkmcnt(4)
    ds_read_b64_tr_b16 a[176:177], v126 offset:32
    ds_read_b64_tr_b16 a[178:179], v126 offset:800
    v_mfma_f32_16x16x32_bf16 v[146:149], a[84:87], v[138:141], v[146:149]
    s_waitcnt lgkmcnt(5)
    ds_read_b64_tr_b16 a[200:201], v126 offset:64
    ds_read_b64_tr_b16 a[202:203], v126 offset:832
    v_mfma_f32_16x16x32_bf16 v[146:149], a[88:91], v[170:173], v[146:149]
    buffer_load_dwordx4 v135, s[48:51], s4 offen offset:1024 lds
    v_mfma_f32_16x16x32_bf16 v[146:149], a[92:95], v[174:177], v[146:149]
    ds_write_b64 v167, v[122:123] offset:56
    v_mfma_f32_16x16x32_bf16 v[154:157], a[96:99], v[198:201], 0
    v_mfma_f32_16x16x32_bf16 v[154:157], a[100:103], v[114:117], v[154:157]
    ds_write_b64 v167, v[122:123] offset:64
    v_mfma_f32_16x16x32_bf16 v[154:157], a[104:107], v[182:185], v[154:157]
    s_waitcnt lgkmcnt(6)
    buffer_load_dwordx4 v137, s[48:51], s4 offen offset:2048 lds
    v_mfma_f32_16x16x32_bf16 v[154:157], a[108:111], v[138:141], v[154:157]
    s_add_u32 m0, s28, 8192
    ds_read_b128 v[222:225], v164 offset:6144
    v_fma_f32 v119, v146, v146, s32
    v_mfma_f32_16x16x32_bf16 v[154:157], a[112:115], v[170:173], v[154:157]
    s_add_u32 s4, 0, 12288
    ds_read_b128 v[226:229], v163 offset:6144
    v_fmac_f32 v119, v147, v147
    v_mfma_f32_16x16x32_bf16 v[154:157], a[116:119], v[174:177], v[154:157]
    s_waitcnt lgkmcnt(4)
    ds_read_b128 v[242:245], v164 offset:6272
    s_waitcnt vmcnt(6)
    v_mfma_f32_16x16x32_bf16 v[178:181], a[120:123], v[198:201], 0
    ds_read_b64_tr_b16 a[156:157], v126 offset:3072
    ds_read_b64_tr_b16 a[158:159], v126 offset:3840
    v_mfma_f32_16x16x32_bf16 v[178:181], a[124:127], v[114:117], v[178:181]
    buffer_load_dwordx4 v12, s[8:11], s25 offen lds
    v_mfma_f32_16x16x32_bf16 v[178:181], a[128:131], v[182:185], v[178:181]
    s_add_u32 m0, s28, 12288
    ds_read_b64_tr_b16 a[180:181], v126 offset:3104
    ds_read_b64_tr_b16 a[182:183], v126 offset:3872
    v_mfma_f32_16x16x32_bf16 v[178:181], a[132:135], v[138:141], v[178:181]
    ds_read_b64_tr_b16 a[204:205], v126 offset:3136
    ds_read_b64_tr_b16 a[206:207], v126 offset:3904
    v_mfma_f32_16x16x32_bf16 v[178:181], a[136:139], v[170:173], v[178:181]
    ds_read_b128 v[190:193], v163 offset:6272
    ds_read_b128 v[218:221], v164 offset:6400
    v_mfma_f32_16x16x32_bf16 v[178:181], a[140:143], v[174:177], v[178:181]
    s_waitcnt lgkmcnt(10)
    ds_read_b128 v[206:209], v163 offset:6400
    v_fmac_f32 v119, v148, v148
    v_mfma_f32_16x16x32_bf16 v[150:153], a[72:75], v[222:225], 0
    s_waitcnt lgkmcnt(10)
    buffer_load_dwordx4 v13, s[8:11], s25 offen lds
    v_mfma_f32_16x16x32_bf16 v[150:153], a[76:79], v[226:229], v[150:153]
    s_waitcnt lgkmcnt(9)
    ds_write_b128 v159, v[122:125] offset:16
    v_mfma_f32_16x16x32_bf16 v[150:153], a[80:83], v[242:245], v[150:153]
    s_add_u32 m0, s29, 0
    v_fmac_f32 v119, v149, v149
    v_fmac_f32 v119, v154, v154
    v_mfma_f32_16x16x32_bf16 v[186:189], a[96:99], v[222:225], 0
    s_waitcnt lgkmcnt(6)
    v_fmac_f32 v119, v155, v155
    v_fmac_f32 v119, v156, v156
    v_mfma_f32_16x16x32_bf16 v[186:189], a[100:103], v[226:229], v[186:189]
    s_waitcnt lgkmcnt(4)
    buffer_load_dwordx4 v14, s[8:11], s25 offen lds
    v_mfma_f32_16x16x32_bf16 v[186:189], a[104:107], v[242:245], v[186:189]
    s_waitcnt lgkmcnt(2)
    ds_write_b64 v159, v[122:123] offset:56
    v_mfma_f32_16x16x32_bf16 v[150:153], a[84:87], v[190:193], v[150:153]
    s_add_u32 m0, s69, 0
    s_waitcnt vmcnt(6)
    v_fmac_f32 v119, v157, v157
    v_mfma_f32_16x16x32_bf16 v[150:153], a[88:91], v[218:221], v[150:153]
    s_waitcnt lgkmcnt(2)
    ds_read_b64_tr_b16 a[160:161], v128 offset:0
    ds_read_b64_tr_b16 a[162:163], v128 offset:768
    v_mfma_f32_16x16x32_bf16 v[150:153], a[92:95], v[206:209], v[150:153]
    s_cmp_lt_u32 1, s17
    ds_read_b64_tr_b16 a[184:185], v128 offset:32
    buffer_load_dwordx4 v143, s[52:55], 0 offen lds
    v_mfma_f32_16x16x32_bf16 v[186:189], a[108:111], v[190:193], v[186:189]
    s_cselect_b32 s10, s36, 0
    ds_read_b64_tr_b16 a[186:187], v128 offset:800
    ds_read_b64_tr_b16 a[208:209], v128 offset:64
    v_mfma_f32_16x16x32_bf16 v[186:189], a[112:115], v[218:221], v[186:189]
    s_mov_b32 s25, s24
    ds_read_b64_tr_b16 a[210:211], v128 offset:832
    v_fmac_f32 v119, v178, v178
    v_mfma_f32_16x16x32_bf16 v[186:189], a[116:119], v[206:209], v[186:189]
    ds_write_b64 v159, v[122:123] offset:64
    v_mfma_f32_16x16x32_bf16 v[194:197], a[120:123], v[222:225], 0
    v_fmac_f32 v119, v179, v179
    v_fmac_f32 v119, v180, v180
    v_mfma_f32_16x16x32_bf16 v[194:197], a[124:127], v[226:229], v[194:197]
    buffer_load_dwordx4 v132, s[52:55], 0 offen offset:1024 lds
    v_fmac_f32 v119, v181, v181
    v_mfma_f32_16x16x32_bf16 v[194:197], a[128:131], v[242:245], v[194:197]
    s_waitcnt lgkmcnt(6)
    v_fma_f32 v142, v150, v150, s32
    v_fmac_f32 v142, v151, v151
    v_mfma_f32_16x16x32_bf16 v[194:197], a[132:135], v[190:193], v[194:197]
    s_waitcnt lgkmcnt(4)
    v_fmac_f32 v142, v152, v152
    v_fmac_f32 v142, v153, v153
    v_mfma_f32_16x16x32_bf16 v[194:197], a[136:139], v[218:221], v[194:197]
    s_waitcnt lgkmcnt(3)
    v_fmac_f32 v142, v186, v186
    v_fmac_f32 v142, v187, v187
    v_mfma_f32_16x16x32_bf16 v[194:197], a[140:143], v[206:209], v[194:197]
    s_waitcnt lgkmcnt(1)
    v_fmac_f32 v142, v188, v188
    v_fmac_f32 v142, v189, v189
    v_mfma_f32_16x16x32_bf16 v[202:205], a[0:3], v[198:201], 0
    buffer_load_dwordx4 v118, s[52:55], 0 offen offset:2048 lds
    v_xor_b32 v254, 65536, v2
    v_mfma_f32_16x16x32_bf16 v[202:205], a[4:7], v[114:117], v[202:205]
    s_add_u32 m0, s69, 3072
    v_fmac_f32 v142, v194, v194
    v_fmac_f32 v142, v195, v195
    v_mfma_f32_16x16x32_bf16 v[202:205], a[8:11], v[182:185], v[202:205]
    v_fmac_f32 v142, v196, v196
    s_waitcnt vmcnt(6)
    v_mfma_f32_16x16x32_bf16 v[202:205], a[12:15], v[138:141], v[202:205]
    ds_read_b64_tr_b16 a[164:165], v128 offset:3072
    ds_read_b64_tr_b16 a[166:167], v128 offset:3840
    v_mfma_f32_16x16x32_bf16 v[202:205], a[16:19], v[170:173], v[202:205]
    ds_read_b64_tr_b16 a[188:189], v128 offset:3104
    ds_read_b64_tr_b16 a[190:191], v128 offset:3872
    v_mfma_f32_16x16x32_bf16 v[202:205], a[20:23], v[174:177], v[202:205]
    buffer_load_dwordx4 v143, s[52:55], s4 offen lds
    v_mfma_f32_16x16x32_bf16 v[230:233], a[24:27], v[198:201], 0
    ds_read_b64_tr_b16 a[212:213], v128 offset:3136
    ds_read_b64_tr_b16 a[214:215], v128 offset:3904
    v_mfma_f32_16x16x32_bf16 v[230:233], a[28:31], v[114:117], v[230:233]
    v_fmac_f32 v142, v197, v197
    v_lshrrev_b32 v130, 2, v254
    v_mfma_f32_16x16x32_bf16 v[230:233], a[32:35], v[182:185], v[230:233]
    v_fma_f32 v255, v202, v202, s32
    v_fmac_f32 v255, v203, v203
    v_mfma_f32_16x16x32_bf16 v[230:233], a[36:39], v[138:141], v[230:233]
    v_fmac_f32 v255, v204, v204
    v_fmac_f32 v255, v205, v205
    v_mfma_f32_16x16x32_bf16 v[230:233], a[40:43], v[170:173], v[230:233]
    buffer_load_dwordx4 v132, s[52:55], s4 offen offset:1024 lds
    v_mfma_f32_16x16x32_bf16 v[230:233], a[44:47], v[174:177], v[230:233]
    s_waitcnt lgkmcnt(4)
    v_lshrrev_b32 v133, 8, v254
    v_add_u32 v254, 157184, v254
    v_mfma_f32_16x16x32_bf16 v[214:217], a[48:51], v[198:201], 0
    s_waitcnt lgkmcnt(2)
    v_lshl_add_u32 v135, s16, 2, v254
    v_add_u32 v130, 162048, v130
    v_mfma_f32_16x16x32_bf16 v[214:217], a[52:55], v[114:117], v[214:217]
    v_fmac_f32 v255, v230, v230
    v_fmac_f32 v255, v231, v231
    v_mfma_f32_16x16x32_bf16 v[214:217], a[56:59], v[182:185], v[214:217]
    s_waitcnt lgkmcnt(0)
    v_fmac_f32 v255, v232, v232
    v_fmac_f32 v255, v233, v233
    v_mfma_f32_16x16x32_bf16 v[214:217], a[60:63], v[138:141], v[214:217]
    buffer_load_dwordx4 v118, s[52:55], s4 offen offset:2048 lds
    v_mfma_f32_16x16x32_bf16 v[214:217], a[64:67], v[170:173], v[214:217]
    s_add_u32 m0, s68, 0
    v_lshlrev_b32 v133, 4, v133
    v_add_u32 v133, 162048, v133
    v_mfma_f32_16x16x32_bf16 v[214:217], a[68:71], v[174:177], v[214:217]
    s_add_u32 s4, 0, 24576
    v_or_b32 v234, v32, v33
    v_and_b32 v234, 0xffff, v234
    v_mfma_f32_16x16x32_bf16 v[138:141], a[0:3], v[222:225], 0
    v_lshl_or_b32 v234, v234, 16, v234
    v_or_b32 v235, v32, v33
    v_mfma_f32_16x16x32_bf16 v[138:141], a[4:7], v[226:229], v[138:141]
    v_and_b32 v235, 0xffff, v235
    v_fmac_f32 v255, v214, v214
    v_mfma_f32_16x16x32_bf16 v[138:141], a[8:11], v[242:245], v[138:141]
    buffer_load_dwordx4 v143, s[52:55], s4 offen lds
    v_mfma_f32_16x16x32_bf16 v[138:141], a[12:15], v[190:193], v[138:141]
    v_fmac_f32 v255, v215, v215
    v_fmac_f32 v255, v216, v216
    v_mfma_f32_16x16x32_bf16 v[138:141], a[16:19], v[218:221], v[138:141]
    v_fmac_f32 v255, v217, v217
    v_cvt_pk_bf16_f32 v36, v255, v119
    v_mfma_f32_16x16x32_bf16 v[138:141], a[20:23], v[206:209], v[138:141]
    v_lshl_or_b32 v235, v235, 16, v235
    v_or_b32 v236, v32, v33
    v_mfma_f32_16x16x32_bf16 v[114:117], v[32:35], v[36:39], 0
    v_lshrrev_b32 v236, 16, v236
    v_lshl_or_b32 v236, v236, 16, v236
    v_mfma_f32_16x16x32_bf16 v[238:241], a[24:27], v[222:225], 0
    v_or_b32 v237, v32, v33
    v_lshrrev_b32 v237, 16, v237
    v_mfma_f32_16x16x32_bf16 v[238:241], a[28:31], v[226:229], v[238:241]
    v_lshl_or_b32 v237, v237, 16, v237
    v_fma_f32 v119, v138, v138, s32
    v_mfma_f32_16x16x32_bf16 v[238:241], a[32:35], v[242:245], v[238:241]
    v_rsq_f32 v115, v115
    v_mfma_f32_16x16x32_bf16 v[238:241], a[36:39], v[190:193], v[238:241]
    ds_read_b128 v[182:185], v0 offset:20480
    v_mul_f32 v146, v115, v146
    v_mfma_f32_16x16x32_bf16 v[238:241], a[40:43], v[218:221], v[238:241]
    ds_read_b128 v[198:201], v1 offset:20480
    v_mul_f32 v147, v115, v147
    v_mfma_f32_16x16x32_bf16 v[238:241], a[44:47], v[206:209], v[238:241]
    ds_read_b128 v[210:213], v0 offset:20608
    v_cvt_pk_f16_f32 v126, v146, v147
    v_mfma_f32_16x16x32_bf16 v[246:249], a[48:51], v[222:225], 0
    ds_read_b128 v[222:225], v1 offset:20608
    v_mul_f32 v148, v115, v148
    v_mfma_f32_16x16x32_bf16 v[246:249], a[52:55], v[226:229], v[246:249]
    ds_read_b128 v[226:229], v0 offset:20736
    v_mul_f32 v149, v115, v149
    v_mfma_f32_16x16x32_bf16 v[246:249], a[56:59], v[242:245], v[246:249]
    ds_read_b128 v[242:245], v1 offset:20736
    v_cvt_pk_f16_f32 v127, v148, v149
    v_mfma_f32_16x16x32_bf16 v[246:249], a[60:63], v[190:193], v[246:249]
    v_rsq_f32 v114, v114
    v_mfma_f32_16x16x32_bf16 v[246:249], a[64:67], v[218:221], v[246:249]
    v_mul_f32 v114, s31, v114
    v_mul_f32 v154, v115, v154
    v_mfma_f32_16x16x32_bf16 v[246:249], a[68:71], v[206:209], v[246:249]
    s_waitcnt lgkmcnt(5)
    v_mul_f32 v155, v115, v155
    v_cvt_pk_f16_f32 v128, v154, v155
    v_mfma_f32_16x16x32_bf16 v[122:125], a[96:99], v[182:185], 0
    s_waitcnt lgkmcnt(4)
    v_mul_f32 v156, v115, v156
    v_mul_f32 v157, v115, v157
    v_mfma_f32_16x16x32_bf16 v[122:125], a[100:103], v[198:201], v[122:125]
    s_waitcnt lgkmcnt(3)
    v_cvt_pk_f16_f32 v129, v156, v157
    v_mul_f32 v178, v115, v178
    v_mfma_f32_16x16x32_bf16 v[122:125], a[104:107], v[210:213], v[122:125]
    s_waitcnt lgkmcnt(2)
    ds_write_b128 v167, v[126:129]
    v_mfma_f32_16x16x32_bf16 v[122:125], a[108:111], v[222:225], v[122:125]
    s_waitcnt lgkmcnt(1)
    v_mul_f32 v179, v115, v179
    v_cvt_pk_f16_f32 v172, v178, v179
    v_mfma_f32_16x16x32_bf16 v[122:125], a[112:115], v[226:229], v[122:125]
    v_mul_f32 v180, v115, v180
    v_mul_f32 v181, v115, v181
    v_mfma_f32_16x16x32_bf16 v[122:125], a[116:119], v[242:245], v[122:125]
    v_cvt_pk_f16_f32 v173, v180, v181
    v_mul_f32 v202, v114, v202
    v_mfma_f32_16x16x32_bf16 v[126:129], a[120:123], v[182:185], 0
    ds_write_b64 v167, v[172:173] offset:48
    v_mfma_f32_16x16x32_bf16 v[126:129], a[124:127], v[198:201], v[126:129]
    v_mul_f32 v203, v114, v203
    v_cvt_pk_f16_f32 v170, v202, v203
    v_mfma_f32_16x16x32_bf16 v[126:129], a[128:131], v[210:213], v[126:129]
    v_mul_f32 v204, v114, v204
    v_mul_f32 v205, v114, v205
    v_mfma_f32_16x16x32_bf16 v[126:129], a[132:135], v[222:225], v[126:129]
    v_cvt_pk_f16_f32 v171, v204, v205
    v_mul_f32 v230, v114, v230
    v_mfma_f32_16x16x32_bf16 v[126:129], a[136:139], v[226:229], v[126:129]
    v_mul_f32 v231, v114, v231
    v_cvt_pk_f16_f32 v172, v230, v231
    v_mfma_f32_16x16x32_bf16 v[126:129], a[140:143], v[242:245], v[126:129]
    v_mul_f32 v232, v114, v232
    v_mul_f32 v233, v114, v233
    v_mfma_f32_16x16x32_bf16 v[174:177], a[24:27], v[182:185], 0
    v_cvt_pk_f16_f32 v173, v232, v233
    v_mul_f32 v214, v114, v214
    v_mfma_f32_16x16x32_bf16 v[174:177], a[28:31], v[198:201], v[174:177]
    ds_write_b128 v167, v[170:173] offset:32
    v_mfma_f32_16x16x32_bf16 v[174:177], a[32:35], v[210:213], v[174:177]
    v_mul_f32 v215, v114, v215
    v_cvt_pk_f16_f32 v170, v214, v215
    v_mfma_f32_16x16x32_bf16 v[174:177], a[36:39], v[222:225], v[174:177]
    v_mul_f32 v216, v114, v216
    v_mul_f32 v217, v114, v217
    v_mfma_f32_16x16x32_bf16 v[174:177], a[40:43], v[226:229], v[174:177]
    v_cvt_pk_f16_f32 v171, v216, v217
    v_mul_f32 v146, v202, v146
    v_mfma_f32_16x16x32_bf16 v[174:177], a[44:47], v[242:245], v[174:177]
    ds_write_b64 v167, v[170:171] offset:72
    v_mfma_f32_16x16x32_bf16 v[114:117], a[72:75], v[182:185], 0
    v_fmac_f32 v146, v203, v147
    v_fmac_f32 v146, v204, v148
    v_mfma_f32_16x16x32_bf16 v[114:117], a[76:79], v[198:201], v[114:117]
    v_fmac_f32 v146, v205, v149
    v_fmac_f32 v146, v230, v154
    v_mfma_f32_16x16x32_bf16 v[114:117], a[80:83], v[210:213], v[114:117]
    v_fmac_f32 v146, v231, v155
    v_fmac_f32 v146, v232, v156
    v_mfma_f32_16x16x32_bf16 v[114:117], a[84:87], v[222:225], v[114:117]
    v_fmac_f32 v146, v233, v157
    v_fmac_f32 v146, v214, v178
    v_mfma_f32_16x16x32_bf16 v[114:117], a[88:91], v[226:229], v[114:117]
    v_fmac_f32 v146, v215, v179
    v_fmac_f32 v146, v216, v180
    v_mfma_f32_16x16x32_bf16 v[114:117], a[92:95], v[242:245], v[114:117]
    v_fmac_f32 v146, v217, v181
    v_mov_b32 v167, v146
    v_mfma_f32_16x16x32_bf16 v[218:221], a[48:51], v[182:185], 0
    v_fmac_f32 v119, v139, v139
    v_fmac_f32 v119, v140, v140
    v_mfma_f32_16x16x32_bf16 v[218:221], a[52:55], v[198:201], v[218:221]
    v_permlane32_swap_b32 v146, v167
    v_mfma_f32_16x16x32_bf16 v[218:221], a[56:59], v[210:213], v[218:221]
    v_add_f32 v146, v146, v167
    v_mov_b32 v167, v146
    v_mfma_f32_16x16x32_bf16 v[218:221], a[60:63], v[222:225], v[218:221]
    v_fmac_f32 v119, v141, v141
    v_fmac_f32 v119, v238, v238
    v_mfma_f32_16x16x32_bf16 v[218:221], a[64:67], v[226:229], v[218:221]
    v_permlane16_swap_b32 v146, v167
    v_mfma_f32_16x16x32_bf16 v[218:221], a[68:71], v[242:245], v[218:221]
    v_add_f32 v146, v146, v167
    v_add_f32 v146, s39, v146
    v_mfma_f32_16x16x32_bf16 v[170:173], v[182:185], a[144:147], 0
    v_mov_b32 v147, v162
    v_mov_b32 v148, v162
    v_mfma_f32_16x16x32_bf16 v[170:173], v[198:201], a[148:151], v[170:173]
    v_mov_b32 v149, v162
    v_cndmask_b32 v146, v162, v146, s[88:89]
    v_mfma_f32_16x16x32_bf16 v[170:173], v[210:213], a[152:155], v[170:173]
    ds_write_b128 v166, v[146:149] offset:192
    v_mfma_f32_16x16x32_bf16 v[170:173], v[222:225], a[156:159], v[170:173]
    v_fmac_f32 v119, v239, v239
    v_fmac_f32 v119, v240, v240
    v_mfma_f32_16x16x32_bf16 v[170:173], v[226:229], a[160:163], v[170:173]
    v_fmac_f32 v119, v241, v241
    v_fmac_f32 v119, v246, v246
    v_mfma_f32_16x16x32_bf16 v[170:173], v[242:245], a[164:167], v[170:173]
    v_fmac_f32 v119, v247, v247
    v_fmac_f32 v119, v248, v248
    v_mfma_f32_16x16x32_bf16 v[154:157], v[182:185], a[168:171], 0
    v_fmac_f32 v119, v249, v249
    v_cvt_pk_bf16_f32 v36, v119, v142
    v_mfma_f32_16x16x32_bf16 v[154:157], v[198:201], a[172:175], v[154:157]
    v_fma_f32 v119, v114, v114, s32
    v_fmac_f32 v119, v115, v115
    v_mfma_f32_16x16x32_bf16 v[146:149], v[32:35], v[36:39], 0
    v_fmac_f32 v119, v116, v116
    v_fmac_f32 v119, v117, v117
    v_mfma_f32_16x16x32_bf16 v[154:157], v[210:213], a[176:179], v[154:157]
    v_fmac_f32 v119, v122, v122
    v_fmac_f32 v119, v123, v123
    v_mfma_f32_16x16x32_bf16 v[154:157], v[222:225], a[180:183], v[154:157]
    ds_read_b128 v[202:205], v164 offset:0
    v_fmac_f32 v119, v124, v124
    v_mfma_f32_16x16x32_bf16 v[154:157], v[226:229], a[184:187], v[154:157]
    ds_read_b128 v[190:193], v163 offset:0
    v_fmac_f32 v119, v125, v125
    v_mfma_f32_16x16x32_bf16 v[154:157], v[242:245], a[188:191], v[154:157]
    ds_read_b128 v[178:181], v164 offset:128
    v_rsq_f32 v147, v147
    v_rsq_f32 v146, v146
    v_mul_f32 v150, v147, v150
    v_mul_f32 v146, s31, v146
    v_mul_f32 v151, v147, v151
    v_cvt_pk_f16_f32 v206, v150, v151
    v_mul_f32 v152, v147, v152
    v_mul_f32 v153, v147, v153
    v_cvt_pk_f16_f32 v207, v152, v153
    v_mul_f32 v186, v147, v186
    v_mul_f32 v187, v147, v187
    v_cvt_pk_f16_f32 v208, v186, v187
    v_mul_f32 v188, v147, v188
    v_mul_f32 v189, v147, v189
    v_cvt_pk_f16_f32 v209, v188, v189
    v_mul_f32 v194, v147, v194
    v_mul_f32 v195, v147, v195
    v_cvt_pk_f16_f32 v232, v194, v195
    v_mul_f32 v196, v147, v196
    v_mul_f32 v197, v147, v197
    v_cvt_pk_f16_f32 v233, v196, v197
    buffer_load_dwordx4 v132, s[52:55], s4 offen offset:1024 lds
    ds_write_b128 v159, v[206:209]
    v_mul_f32 v138, v146, v138
    v_mul_f32 v139, v146, v139
    v_cvt_pk_f16_f32 v206, v138, v139
    v_mul_f32 v140, v146, v140
    v_mul_f32 v141, v146, v141
    v_cvt_pk_f16_f32 v207, v140, v141
    v_mul_f32 v238, v146, v238
    v_mul_f32 v239, v146, v239
    v_cvt_pk_f16_f32 v208, v238, v239
    v_mul_f32 v240, v146, v240
    v_mul_f32 v241, v146, v241
    buffer_load_dwordx4 v118, s[52:55], s4 offen offset:2048 lds
    ds_write_b64 v159, v[232:233] offset:48
    s_add_u32 m0, s68, 3072
    s_add_u32 s4, 0, 36864
    v_cvt_pk_f16_f32 v209, v240, v241
    v_mul_f32 v246, v146, v246
    v_mul_f32 v247, v146, v247
    v_cvt_pk_f16_f32 v230, v246, v247
    v_mul_f32 v248, v146, v248
    v_mul_f32 v249, v146, v249
    v_cvt_pk_f16_f32 v231, v248, v249
    v_mul_f32 v138, v138, v150
    v_fmac_f32 v138, v139, v151
    v_fmac_f32 v138, v140, v152
    buffer_load_dwordx4 v143, s[52:55], s4 offen lds
    ds_write_b128 v159, v[206:209] offset:32
    v_mfma_f32_16x16x32_bf16 v[206:209], a[0:3], v[182:185], 0
    s_waitcnt lgkmcnt(2)
    v_fmac_f32 v138, v141, v153
    v_fmac_f32 v138, v238, v186
    v_mfma_f32_16x16x32_bf16 v[206:209], a[4:7], v[198:201], v[206:209]
    v_fmac_f32 v138, v239, v187
    v_fmac_f32 v138, v240, v188
    v_mfma_f32_16x16x32_bf16 v[206:209], a[8:11], v[210:213], v[206:209]
    ds_write_b64 v159, v[230:231] offset:72
    v_mfma_f32_16x16x32_bf16 v[206:209], a[12:15], v[222:225], v[206:209]
    buffer_load_dwordx4 v132, s[52:55], s4 offen offset:1024 lds
    v_mfma_f32_16x16x32_bf16 v[206:209], a[16:19], v[226:229], v[206:209]
    v_fmac_f32 v138, v241, v189
    v_fmac_f32 v138, v246, v194
    v_mfma_f32_16x16x32_bf16 v[206:209], a[20:23], v[242:245], v[206:209]
    v_fmac_f32 v138, v247, v195
    v_fmac_f32 v138, v248, v196
    v_mfma_f32_16x16x32_bf16 v[146:149], v[182:185], a[192:195], 0
    ds_read_b128 v[150:153], v163 offset:128
    v_fmac_f32 v138, v249, v197
    v_mfma_f32_16x16x32_bf16 v[146:149], v[198:201], a[196:199], v[146:149]
    ds_read_b128 v[182:185], v164 offset:256
    v_mov_b32 v142, v138
    v_mfma_f32_16x16x32_bf16 v[146:149], v[210:213], a[200:203], v[146:149]
    buffer_load_dwordx4 v118, s[52:55], s4 offen offset:2048 lds
    v_mfma_f32_16x16x32_bf16 v[146:149], v[222:225], a[204:207], v[146:149]
    s_add_u32 m0, s69, 0
    ds_read_b128 v[222:225], v163 offset:256
    v_fmac_f32 v119, v126, v126
    v_mfma_f32_16x16x32_bf16 v[146:149], v[226:229], a[208:211], v[146:149]
    s_add_u32 s4, 0, 49152
    v_permlane32_swap_b32 v138, v142
    s_waitcnt vmcnt(9)
    v_mfma_f32_16x16x32_bf16 v[146:149], v[242:245], a[212:215], v[146:149]
    ds_read_b64 a[216:217], v131 offset:0
    ds_read_b64 a[218:219], v131 offset:1536
    v_mfma_f32_16x16x32_bf16 v[198:201], v[202:205], a[144:147], 0
    ds_read_b64 a[240:241], v131 offset:8
    ds_read_b64 a[242:243], v131 offset:1544
    v_mfma_f32_16x16x32_bf16 v[198:201], v[190:193], a[148:151], v[198:201]
    s_waitcnt lgkmcnt(6)
    ds_read_b64 v[90:91], v121 offset:0
    ds_read_b64 v[92:93], v121 offset:1536
    v_mfma_f32_16x16x32_bf16 v[198:201], v[178:181], a[152:155], v[198:201]
    s_waitcnt lgkmcnt(7)
    v_add_f32 v138, v138, v142
    v_mov_b32 v142, v138
    v_mfma_f32_16x16x32_bf16 v[198:201], v[150:153], a[156:159], v[198:201]
    v_fmac_f32 v119, v127, v127
    v_fmac_f32 v119, v128, v128
    v_mfma_f32_16x16x32_bf16 v[198:201], v[182:185], a[160:163], v[198:201]
    s_waitcnt lgkmcnt(6)
    v_permlane16_swap_b32 v138, v142
    v_mfma_f32_16x16x32_bf16 v[198:201], v[222:225], a[164:167], v[198:201]
    v_add_f32 v138, v138, v142
    v_add_f32 v138, s39, v138
    v_mfma_f32_16x16x32_bf16 v[242:245], v[202:205], a[168:171], 0
    v_mov_b32 v139, v162
    v_mov_b32 v140, v162
    v_mfma_f32_16x16x32_bf16 v[242:245], v[190:193], a[172:175], v[242:245]
    s_waitcnt lgkmcnt(4)
    v_mov_b32 v141, v162
    v_cndmask_b32 v138, v162, v138, s[88:89]
    v_mfma_f32_16x16x32_bf16 v[226:229], v[234:237], a[216:219], 0
    s_waitcnt lgkmcnt(2)
    ds_write_b128 v169, v[138:141] offset:192
    v_mfma_f32_16x16x32_bf16 v[226:229], v[234:237], a[240:243], v[226:229]
    s_waitcnt lgkmcnt(1)
    buffer_load_dwordx4 v143, s[52:55], s4 offen lds
    v_mfma_f32_16x16x32_bf16 v[226:229], v[234:237], v[90:93], v[226:229]
    v_fmac_f32 v119, v129, v129
    s_waitcnt vmcnt(7)
    v_mfma_f32_16x16x32_bf16 v[242:245], v[178:181], a[176:179], v[242:245]
    ds_read_b64 a[232:233], v131 offset:3072
    ds_read_b64 a[220:221], v131 offset:4608
    v_mfma_f32_16x16x32_bf16 v[242:245], v[150:153], a[180:183], v[242:245]
    ds_read_b64 v[82:83], v131 offset:3080
    ds_read_b64 a[244:245], v131 offset:4616
    v_mfma_f32_16x16x32_bf16 v[242:245], v[182:185], a[184:187], v[242:245]
    ds_read_b64 v[106:107], v121 offset:3072
    ds_read_b64 v[94:95], v121 offset:4608
    v_mfma_f32_16x16x32_bf16 v[242:245], v[222:225], a[188:191], v[242:245]
    buffer_load_dwordx4 v132, s[52:55], s4 offen offset:1024 lds
    v_mfma_f32_16x16x32_bf16 v[186:189], v[202:205], a[192:195], 0
    ds_read_b128 v[158:161], v164 offset:6144
    ds_read_b128 v[138:141], v163 offset:6144
    v_mfma_f32_16x16x32_bf16 v[186:189], v[190:193], a[196:199], v[186:189]
    ds_read_b128 v[194:197], v164 offset:6272
    ds_read_b128 v[210:213], v163 offset:6272
    v_mfma_f32_16x16x32_bf16 v[186:189], v[178:181], a[200:203], v[186:189]
    v_mov_b32 v255, v226
    v_mov_b32_dpp v255, v227 quad_perm:[0,1,2,3] row_mask:0x2 bank_mask:0xf
    v_mfma_f32_16x16x32_bf16 v[186:189], v[150:153], a[204:207], v[186:189]
    ds_read_b128 v[226:229], v164 offset:6400
    ds_read_b128 v[150:153], v163 offset:6400
    v_mfma_f32_16x16x32_bf16 v[186:189], v[182:185], a[208:211], v[186:189]
    s_waitcnt lgkmcnt(10)
    buffer_load_dwordx4 v118, s[52:55], s4 offen offset:2048 lds
    v_mfma_f32_16x16x32_bf16 v[186:189], v[222:225], a[212:215], v[186:189]
    s_add_u32 m0, s69, 3072
    s_add_u32 s4, 0, 61440
    s_waitcnt lgkmcnt(6)
    v_fma_f32 v142, v206, v206, s32
    v_fmac_f32 v142, v207, v207
    v_fmac_f32 v142, v208, v208
    v_fmac_f32 v142, v209, v209
    v_fmac_f32 v142, v174, v174
    v_fmac_f32 v142, v175, v175
    s_waitcnt lgkmcnt(5)
    v_mfma_f32_16x16x32_bf16 v[182:185], v[158:161], a[144:147], 0
    s_waitcnt lgkmcnt(4)
    s_waitcnt vmcnt(6)
    ds_read_b64 a[222:223], v134 offset:0
    v_mfma_f32_16x16x32_bf16 v[182:185], v[138:141], a[148:151], v[182:185]
    s_waitcnt lgkmcnt(3)
    buffer_load_dwordx4 v143, s[52:55], s4 offen lds
    v_mfma_f32_16x16x32_bf16 v[182:185], v[194:197], a[152:155], v[182:185]
    ds_read_b64 a[234:235], v134 offset:1536
    ds_read_b64 a[246:247], v134 offset:8
    v_mfma_f32_16x16x32_bf16 v[182:185], v[210:213], a[156:159], v[182:185]
    s_waitcnt lgkmcnt(3)
    ds_read_b64 v[84:85], v134 offset:1544
    ds_read_b64 v[96:97], v120 offset:0
    v_mfma_f32_16x16x32_bf16 v[182:185], v[226:229], a[160:163], v[182:185]
    ds_read_b64 v[108:109], v120 offset:1536
    v_fmac_f32 v142, v176, v176
    v_mfma_f32_16x16x32_bf16 v[182:185], v[150:153], a[164:167], v[182:185]
    v_fmac_f32 v142, v177, v177
    v_fmac_f32 v142, v218, v218
    v_mfma_f32_16x16x32_bf16 v[222:225], v[158:161], a[168:171], 0
    buffer_load_dwordx4 v132, s[52:55], s4 offen offset:1024 lds
    v_mfma_f32_16x16x32_bf16 v[222:225], v[138:141], a[172:175], v[222:225]
    v_fmac_f32 v142, v219, v219
    v_fmac_f32 v142, v220, v220
    v_mfma_f32_16x16x32_bf16 v[222:225], v[194:197], a[176:179], v[222:225]
    s_waitcnt lgkmcnt(5)
    v_fmac_f32 v142, v221, v221
    v_cvt_pk_bf16_f32 v36, v142, v119
    v_mfma_f32_16x16x32_bf16 v[178:181], v[234:237], a[220:223], 0
    v_cvt_pk_bf16_f32 v190, v170, v171
    v_cvt_pk_bf16_f32 v191, v172, v173
    v_mfma_f32_16x16x32_bf16 v[170:173], v[32:35], v[36:39], 0
    s_waitcnt lgkmcnt(3)
    v_cvt_pk_bf16_f32 v162, v154, v155
    v_cvt_pk_bf16_f32 v163, v156, v157
    v_mfma_f32_16x16x32_bf16 v[178:181], v[234:237], a[244:247], v[178:181]
    s_waitcnt lgkmcnt(1)
    buffer_load_dwordx4 v118, s[52:55], s4 offen offset:2048 lds
    v_mfma_f32_16x16x32_bf16 v[178:181], v[234:237], v[94:97], v[178:181]
    s_add_u32 m0, s28, 65536
    v_rsq_f32 v171, v171
    v_mfma_f32_16x16x32_bf16 v[154:157], v[234:237], a[232:235], 0
    s_waitcnt vmcnt(6)
    ds_read_b64 a[224:225], v134 offset:3072
    ds_read_b64 a[226:227], v134 offset:4608
    v_mfma_f32_16x16x32_bf16 v[154:157], v[234:237], v[82:85], v[154:157]
    s_waitcnt lgkmcnt(2)
    ds_read_b64 a[248:249], v134 offset:3080
    ds_read_b64 a[250:251], v134 offset:4616
    v_mfma_f32_16x16x32_bf16 v[154:157], v[234:237], v[106:109], v[154:157]
    ds_read_b64 v[98:99], v120 offset:3072
    ds_read_b64 v[100:101], v120 offset:4608
    v_mfma_f32_16x16x32_bf16 v[222:225], v[210:213], a[180:183], v[222:225]
    buffer_load_dwordx4 v10, s[8:11], s24 offen lds
    v_mfma_f32_16x16x32_bf16 v[222:225], v[226:229], a[184:187], v[222:225]
    s_add_u32 m0, s28, 69632
    v_mov_b32 v132, v179
    v_mul_f32 v114, v171, v114
    v_mfma_f32_16x16x32_bf16 v[222:225], v[150:153], a[188:191], v[222:225]
    v_mov_b32_dpp v255, v154 quad_perm:[0,1,2,3] row_mask:0x4 bank_mask:0xf
    v_mov_b32_dpp v255, v178 quad_perm:[0,1,2,3] row_mask:0x8 bank_mask:0xf
    v_mfma_f32_16x16x32_bf16 v[178:181], v[158:161], a[192:195], 0
    v_mov_b32_dpp v132, v155 quad_perm:[0,1,2,3] row_mask:0x2 bank_mask:0xf
    v_mul_f32 v115, v171, v115
    v_mfma_f32_16x16x32_bf16 v[178:181], v[138:141], a[196:199], v[178:181]
    v_rsq_f32 v170, v170
    v_mfma_f32_16x16x32_bf16 v[178:181], v[194:197], a[200:203], v[178:181]
    s_waitcnt lgkmcnt(4)
    buffer_load_dwordx4 v11, s[8:11], s24 offen lds
    v_mfma_f32_16x16x32_bf16 v[138:141], v[234:237], a[224:227], 0
    s_waitcnt lgkmcnt(2)
    v_mul_f32 v170, s31, v170
    v_cvt_pk_f16_f32 v114, v114, v115
    v_mfma_f32_16x16x32_bf16 v[138:141], v[234:237], a[248:251], v[138:141]
    s_waitcnt lgkmcnt(0)
    v_mul_f32 v116, v171, v116
    v_mul_f32 v117, v171, v117
    v_mfma_f32_16x16x32_bf16 v[138:141], v[234:237], v[98:101], v[138:141]
    s_add_u32 m0, s28, 73728
    v_cvt_pk_f16_f32 v115, v116, v117
    v_mul_f32 v122, v171, v122
    v_mfma_f32_16x16x32_bf16 v[178:181], v[210:213], a[204:207], v[178:181]
    v_mul_f32 v123, v171, v123
    v_cvt_pk_f16_f32 v116, v122, v123
    v_mfma_f32_16x16x32_bf16 v[178:181], v[226:229], a[208:211], v[178:181]
    buffer_load_dwordx4 v12, s[8:11], s24 offen lds
    v_mfma_f32_16x16x32_bf16 v[178:181], v[150:153], a[212:215], v[178:181]
    s_barrier
    ds_read_b128 v[154:157], v0 offset:26624
    ds_read_b128 v[158:161], v1 offset:26624
    s_waitcnt vmcnt(6)
    ds_read_b64 a[236:237], v131 offset:0
    ds_read_b64 a[228:229], v131 offset:1536
    ds_read_b64 v[86:87], v131 offset:8
    s_add_u32 m0, s28, 77824
    ds_read_b64 a[252:253], v131 offset:1544
    ds_read_b64 v[110:111], v121 offset:0
    ds_read_b64 v[102:103], v121 offset:1536
    buffer_load_dwordx4 v13, s[8:11], s24 offen lds
    ds_read_b128 v[226:229], v0 offset:26752
    ds_read_b128 v[150:153], v1 offset:26752
    s_add_u32 m0, s74, 0
    ds_read_b128 v[202:205], v0 offset:26880
    ds_read_b128 v[194:197], v1 offset:26880
    v_mov_b32_dpp v132, v138 quad_perm:[0,1,2,3] row_mask:0x4 bank_mask:0xf
    v_mov_b32_dpp v132, v139 quad_perm:[0,1,2,3] row_mask:0x8 bank_mask:0xf
    s_waitcnt lgkmcnt(11)
    v_mfma_f32_16x16x32_bf16 v[210:213], a[72:75], v[154:157], 0
    s_waitcnt lgkmcnt(10)
    ds_write_b32 v135, v255 offset:0
    v_mfma_f32_16x16x32_bf16 v[210:213], a[76:79], v[158:161], v[210:213]
    s_waitcnt lgkmcnt(8)
    buffer_load_dwordx4 v14, s[8:11], s24 offen lds
    v_mfma_f32_16x16x32_bf16 v[138:141], a[96:99], v[154:157], 0
    s_add_u32 s8, s40, s23
    ds_write_b32 v135, v132 offset:1024
    v_mfma_f32_16x16x32_bf16 v[138:141], a[100:103], v[158:161], v[138:141]
    s_addc_u32 s9, s41, 0
    v_mul_f32 v124, v171, v124
    v_mul_f32 v125, v171, v125
    v_mfma_f32_16x16x32_bf16 v[238:241], a[120:123], v[154:157], 0
    s_waitcnt lgkmcnt(4)
    v_cvt_pk_f16_f32 v117, v124, v125
    v_mul_f32 v126, v171, v126
    v_mfma_f32_16x16x32_bf16 v[210:213], a[80:83], v[226:229], v[210:213]
    s_sub_u32 s10, s36, s23
    v_mul_f32 v127, v171, v127
    v_cvt_pk_f16_f32 v124, v126, v127
    v_mfma_f32_16x16x32_bf16 v[210:213], a[84:87], v[150:153], v[210:213]
    s_waitcnt lgkmcnt(2)
    v_mul_f32 v128, v171, v128
    v_mul_f32 v129, v171, v129
    v_mfma_f32_16x16x32_bf16 v[210:213], a[88:91], v[202:205], v[210:213]
    s_cmp_lt_u32 s34, s17
    v_cvt_pk_f16_f32 v125, v128, v129
    v_mul_f32 v206, v170, v206
    s_waitcnt vmcnt(5)
    v_mfma_f32_16x16x32_bf16 v[210:213], a[92:95], v[194:197], v[210:213]
    s_cselect_b32 s10, s10, 0
    ds_read_b64 a[230:231], v131 offset:3072
    ds_read_b64 a[238:239], v131 offset:4608
    v_mfma_f32_16x16x32_bf16 v[138:141], a[104:107], v[226:229], v[138:141]
    s_add_u32 m0, s28, 0
    ds_read_b64 a[254:255], v131 offset:3080
    ds_read_b64 v[88:89], v131 offset:4616
    v_mfma_f32_16x16x32_bf16 v[138:141], a[108:111], v[150:153], v[138:141]
    s_mov_b32 s24, s23
    ds_read_b64 v[104:105], v121 offset:3072
    ds_read_b64 v[112:113], v121 offset:4608
    v_mfma_f32_16x16x32_bf16 v[138:141], a[112:115], v[202:205], v[138:141]
    s_add_u32 s23, s23, s21
    v_mul_f32 v207, v170, v207
    v_cvt_pk_f16_f32 v126, v206, v207
    v_mfma_f32_16x16x32_bf16 v[138:141], a[116:119], v[194:197], v[138:141]
    s_cmp_ge_u32 s19, 72
    v_mul_f32 v208, v170, v208
    v_mul_f32 v209, v170, v209
    v_mfma_f32_16x16x32_bf16 v[238:241], a[124:127], v[158:161], v[238:241]
    s_cselect_b32 s34, 72, 0
    v_cvt_pk_f16_f32 v127, v208, v209
    v_mul_f32 v174, v170, v174
    v_mfma_f32_16x16x32_bf16 v[238:241], a[128:131], v[226:229], v[238:241]
    s_cselect_b32 s35, s22, 0
    v_mul_f32 v175, v170, v175
    v_cvt_pk_f16_f32 v128, v174, v175
    v_mfma_f32_16x16x32_bf16 v[238:241], a[132:135], v[150:153], v[238:241]
    s_sub_u32 s19, s19, s34
    v_mul_f32 v176, v170, v176
    v_mul_f32 v177, v170, v177
    v_mfma_f32_16x16x32_bf16 v[238:241], a[136:139], v[202:205], v[238:241]
    s_waitcnt lgkmcnt(4)
    v_cvt_pk_f16_f32 v129, v176, v177
    v_mul_f32 v218, v170, v218
    v_mfma_f32_16x16x32_bf16 v[174:177], v[234:237], a[228:231], 0
    s_waitcnt lgkmcnt(2)
    v_mul_f32 v219, v170, v219
    v_cvt_pk_f16_f32 v122, v218, v219
    v_mfma_f32_16x16x32_bf16 v[174:177], v[234:237], a[252:255], v[174:177]
    s_waitcnt lgkmcnt(0)
    v_mul_f32 v220, v170, v220
    v_mul_f32 v221, v170, v221
    v_mfma_f32_16x16x32_bf16 v[174:177], v[234:237], v[102:105], v[174:177]
    s_add_u32 s23, s23, s35
    v_cvt_pk_f16_f32 v123, v220, v221
    v_cvt_pk_bf16_f32 v166, v146, v147
    v_mfma_f32_16x16x32_bf16 v[118:121], v[234:237], a[236:239], 0
    v_cvt_pk_bf16_f32 v167, v148, v149
    v_cvt_pk_bf16_f32 v198, v198, v198
    v_mfma_f32_16x16x32_bf16 v[118:121], v[234:237], v[86:89], v[118:121]
    v_cvt_pk_bf16_f32 v199, v199, v199
    v_cvt_pk_bf16_f32 v200, v200, v200
    v_mfma_f32_16x16x32_bf16 v[118:121], v[234:237], v[110:113], v[118:121]
    ds_write2_b32 v165, v198, v199 offset0:0 offset1:68
    v_mfma_f32_16x16x32_bf16 v[238:241], a[140:143], v[194:197], v[238:241]
    v_cvt_pk_bf16_f32 v201, v201, v201
    v_cvt_pk_bf16_f32 v242, v242, v242
    v_mfma_f32_16x16x32_bf16 v[146:149], a[0:3], v[154:157], 0
    ds_write2_b32 v165, v200, v201 offset0:136 offset1:204
    v_mfma_f32_16x16x32_bf16 v[146:149], a[4:7], v[158:161], v[146:149]
    v_cvt_pk_bf16_f32 v243, v243, v243
    v_mov_b32 v164, v118
    v_mfma_f32_16x16x32_bf16 v[146:149], a[8:11], v[226:229], v[146:149]
    ds_write2_b32 v165, v242, v243 offset0:16 offset1:84
    v_mfma_f32_16x16x32_bf16 v[146:149], a[12:15], v[150:153], v[146:149]
    v_mov_b32_dpp v164, v174 quad_perm:[0,1,2,3] row_mask:0x2 bank_mask:0xf
    v_mov_b32_dpp v164, v175 quad_perm:[0,1,2,3] row_mask:0x4 bank_mask:0xf
    v_mfma_f32_16x16x32_bf16 v[146:149], a[16:19], v[202:205], v[146:149]
    v_mov_b32_dpp v164, v119 quad_perm:[0,1,2,3] row_mask:0x8 bank_mask:0xf
    v_cvt_pk_bf16_f32 v244, v244, v244
    v_mfma_f32_16x16x32_bf16 v[146:149], a[20:23], v[194:197], v[146:149]
    ds_write_b32 v135, v164 offset:2048
    v_mfma_f32_16x16x32_bf16 v[118:121], a[24:27], v[154:157], 0
    v_cvt_pk_bf16_f32 v245, v245, v245
    v_cvt_pk_bf16_f32 v186, v186, v186
    v_mfma_f32_16x16x32_bf16 v[118:121], a[28:31], v[158:161], v[118:121]
    ds_write2_b32 v165, v244, v245 offset0:152 offset1:220
    v_mfma_f32_16x16x32_bf16 v[118:121], a[32:35], v[226:229], v[118:121]
    v_cvt_pk_bf16_f32 v187, v187, v187
    v_cvt_pk_bf16_f32 v188, v188, v188
    v_mfma_f32_16x16x32_bf16 v[118:121], a[36:39], v[150:153], v[118:121]
    ds_write2_b32 v165, v186, v187 offset0:32 offset1:100
    v_mfma_f32_16x16x32_bf16 v[118:121], a[40:43], v[202:205], v[118:121]
    v_cvt_pk_bf16_f32 v189, v189, v189
    v_cvt_pk_bf16_f32 v182, v182, v182
    v_mfma_f32_16x16x32_bf16 v[118:121], a[44:47], v[194:197], v[118:121]
    ds_write2_b32 v165, v188, v189 offset0:168 offset1:236
    v_mfma_f32_16x16x32_bf16 v[134:137], a[48:51], v[154:157], 0
    s_waitcnt lgkmcnt(3)
    v_cvt_pk_bf16_f32 v183, v183, v183
    v_cvt_pk_bf16_f32 v184, v184, v184
    v_mfma_f32_16x16x32_bf16 v[134:137], a[52:55], v[158:161], v[134:137]
    s_barrier
    ds_read_b128 v[174:177], v254 offset:0
    ds_read_b128 v[242:245], v254 offset:1024
    v_mfma_f32_16x16x32_bf16 v[134:137], a[56:59], v[226:229], v[134:137]
    ds_read_b128 v[198:201], v254 offset:2048
    v_cvt_pk_bf16_f32 v185, v185, v185
    v_mfma_f32_16x16x32_bf16 v[134:137], a[60:63], v[150:153], v[134:137]
    ds_write2_b32 v168, v182, v183 offset0:0 offset1:68
    v_mfma_f32_16x16x32_bf16 v[134:137], a[64:67], v[202:205], v[134:137]
    v_cvt_pk_bf16_f32 v222, v222, v222
    v_cvt_pk_bf16_f32 v223, v223, v223
    v_mfma_f32_16x16x32_bf16 v[134:137], a[68:71], v[194:197], v[134:137]
    ds_write2_b32 v168, v184, v185 offset0:136 offset1:204
    v_mfma_f32_16x16x32_bf16 v[182:185], v[154:157], a[144:147], 0
    v_cvt_pk_bf16_f32 v224, v224, v224
    v_cvt_pk_bf16_f32 v225, v225, v225
    v_mfma_f32_16x16x32_bf16 v[182:185], v[158:161], a[148:151], v[182:185]
    ds_write2_b32 v168, v222, v223 offset0:16 offset1:84
    v_mfma_f32_16x16x32_bf16 v[182:185], v[226:229], a[152:155], v[182:185]
    s_waitcnt lgkmcnt(4)
    v_add_f32 v174, v174, v175
    v_add_f32 v176, v176, v177
    v_mfma_f32_16x16x32_bf16 v[182:185], v[150:153], a[156:159], v[182:185]
    s_waitcnt lgkmcnt(3)
    ds_write2_b32 v168, v224, v225 offset0:152 offset1:220
    v_mfma_f32_16x16x32_bf16 v[182:185], v[202:205], a[160:163], v[182:185]
    v_add_f32 v174, v174, v176
    v_mul_f32 v174, 0xbbaaaaab, v174
    v_mfma_f32_16x16x32_bf16 v[182:185], v[194:197], a[164:167], v[182:185]
    ds_write_b32 v130, v174 offset:0
    v_mfma_f32_16x16x32_bf16 v[174:177], v[154:157], a[168:171], 0
    v_add_f32 v242, v242, v243
    v_add_f32 v244, v244, v245
    v_mfma_f32_16x16x32_bf16 v[174:177], v[158:161], a[172:175], v[174:177]
    ds_read_b128 v[222:225], v133 offset:0
    ds_read_b128 v[218:221], v133 offset:64
    v_mfma_f32_16x16x32_bf16 v[174:177], v[226:229], a[176:179], v[174:177]
    v_add_f32 v242, v242, v244
    v_mul_f32 v242, 0xbbaaaaab, v242
    v_mfma_f32_16x16x32_bf16 v[174:177], v[150:153], a[180:183], v[174:177]
    ds_read_b128 v[186:189], v0 offset:32768
    v_add_f32 v198, v198, v199
    v_mfma_f32_16x16x32_bf16 v[174:177], v[202:205], a[184:187], v[174:177]
    ds_read_b128 v[170:173], v1 offset:32768
    v_add_f32 v200, v200, v201
    v_mfma_f32_16x16x32_bf16 v[174:177], v[194:197], a[188:191], v[174:177]
    ds_read_b128 v[234:237], v0 offset:32896
    v_add_f32 v198, v198, v200
    v_mfma_f32_16x16x32_bf16 v[206:209], v[154:157], a[192:195], 0
    ds_read_b128 v[154:157], v1 offset:32896
    v_mul_f32 v198, 0xbbaaaaab, v198
    v_mfma_f32_16x16x32_bf16 v[206:209], v[158:161], a[196:199], v[206:209]
    ds_read_b128 v[158:161], v0 offset:33024
    v_cvt_pk_bf16_f32 v178, v178, v178
    v_mfma_f32_16x16x32_bf16 v[206:209], v[226:229], a[200:203], v[206:209]
    ds_read_b128 v[226:229], v1 offset:33024
    v_cvt_pk_bf16_f32 v179, v179, v179
    v_mfma_f32_16x16x32_bf16 v[206:209], v[150:153], a[204:207], v[206:209]
    s_waitcnt lgkmcnt(6)
    ds_write_b32 v130, v242 offset:256
    v_mfma_f32_16x16x32_bf16 v[206:209], v[202:205], a[208:211], v[206:209]
    v_cvt_pk_bf16_f32 v180, v180, v180
    v_cvt_pk_bf16_f32 v181, v181, v181
    v_mfma_f32_16x16x32_bf16 v[206:209], v[194:197], a[212:215], v[206:209]
    s_waitcnt lgkmcnt(6)
    ds_write_b32 v130, v198 offset:512
    v_mfma_f32_16x16x32_bf16 v[150:153], a[72:75], v[186:189], 0
    s_waitcnt lgkmcnt(6)
    v_cvt_pk_bf16_f32 v192, v182, v183
    v_cvt_pk_bf16_f32 v193, v184, v185
    v_mfma_f32_16x16x32_bf16 v[150:153], a[76:79], v[170:173], v[150:153]
    s_waitcnt lgkmcnt(5)
    ds_write2_b32 v168, v178, v179 offset0:32 offset1:100
    v_mfma_f32_16x16x32_bf16 v[150:153], a[80:83], v[234:237], v[150:153]
    s_waitcnt lgkmcnt(4)
    v_fma_f32 v169, v146, v146, s32
    v_fmac_f32 v169, v147, v147
    v_mfma_f32_16x16x32_bf16 v[150:153], a[84:87], v[154:157], v[150:153]
    s_waitcnt lgkmcnt(3)
    ds_write2_b32 v168, v180, v181 offset0:168 offset1:236
    v_mfma_f32_16x16x32_bf16 v[150:153], a[88:91], v[158:161], v[150:153]
    v_fmac_f32 v169, v148, v148
    v_fmac_f32 v169, v149, v149
    v_mfma_f32_16x16x32_bf16 v[150:153], a[92:95], v[226:229], v[150:153]
    v_fmac_f32 v169, v118, v118
    v_fmac_f32 v169, v119, v119
    v_mfma_f32_16x16x32_bf16 v[182:185], a[96:99], v[186:189], 0
    v_fmac_f32 v169, v120, v120
    v_fmac_f32 v169, v121, v121
    v_mfma_f32_16x16x32_bf16 v[182:185], a[100:103], v[170:173], v[182:185]
    v_fmac_f32 v169, v134, v134
    v_fmac_f32 v169, v135, v135
    v_mfma_f32_16x16x32_bf16 v[182:185], a[104:107], v[234:237], v[182:185]
    v_fmac_f32 v169, v136, v136
    v_fmac_f32 v169, v137, v137
    v_mfma_f32_16x16x32_bf16 v[182:185], a[108:111], v[154:157], v[182:185]
    v_fma_f32 v168, v210, v210, s32
    v_fmac_f32 v168, v211, v211
    v_mfma_f32_16x16x32_bf16 v[182:185], a[112:115], v[158:161], v[182:185]
    v_fmac_f32 v168, v212, v212
    v_fmac_f32 v168, v213, v213
    v_mfma_f32_16x16x32_bf16 v[182:185], a[116:119], v[226:229], v[182:185]
    v_fmac_f32 v168, v138, v138
    v_fmac_f32 v168, v139, v139
    v_mfma_f32_16x16x32_bf16 v[198:201], a[120:123], v[186:189], 0
    v_fmac_f32 v168, v140, v140
    v_fmac_f32 v168, v141, v141
    v_mfma_f32_16x16x32_bf16 v[198:201], a[124:127], v[170:173], v[198:201]
    v_fmac_f32 v168, v238, v238
    v_fmac_f32 v168, v239, v239
    v_mfma_f32_16x16x32_bf16 v[198:201], a[128:131], v[234:237], v[198:201]
    v_fmac_f32 v168, v240, v240
    v_fmac_f32 v168, v241, v241
    v_mfma_f32_16x16x32_bf16 v[198:201], a[132:135], v[154:157], v[198:201]
    v_cvt_pk_bf16_f32 v36, v169, v168
    v_cvt_pk_bf16_f32 v164, v174, v175
    v_mfma_f32_16x16x32_bf16 v[198:201], a[136:139], v[158:161], v[198:201]
    v_cvt_pk_bf16_f32 v165, v176, v177
    v_cvt_pk_bf16_f32 v168, v206, v207
    v_mfma_f32_16x16x32_bf16 v[242:245], v[32:35], v[36:39], 0
    v_cvt_pk_bf16_f32 v169, v208, v209
    v_fma_f32 v142, v150, v150, s32
    v_mfma_f32_16x16x32_bf16 v[198:201], a[140:143], v[226:229], v[198:201]
    v_fmac_f32 v142, v151, v151
    v_fmac_f32 v142, v152, v152
    v_mfma_f32_16x16x32_bf16 v[178:181], a[0:3], v[186:189], 0
    v_fmac_f32 v142, v153, v153
    v_fmac_f32 v142, v182, v182
    v_mfma_f32_16x16x32_bf16 v[178:181], a[4:7], v[170:173], v[178:181]
    v_rsq_f32 v243, v243
    v_mfma_f32_16x16x32_bf16 v[178:181], a[8:11], v[234:237], v[178:181]
    v_rsq_f32 v242, v242
    v_mfma_f32_16x16x32_bf16 v[178:181], a[12:15], v[154:157], v[178:181]
    v_mul_f32 v242, s31, v242
    v_mul_f32 v210, v243, v210
    v_mfma_f32_16x16x32_bf16 v[178:181], a[16:19], v[158:161], v[178:181]
    v_mul_f32 v211, v243, v211
    v_cvt_pk_f16_f32 v210, v210, v211
    v_mfma_f32_16x16x32_bf16 v[178:181], a[20:23], v[226:229], v[178:181]
    v_mul_f32 v212, v243, v212
    v_mul_f32 v213, v243, v213
    v_mfma_f32_16x16x32_bf16 v[174:177], a[24:27], v[186:189], 0
    v_cvt_pk_f16_f32 v211, v212, v213
    v_mul_f32 v138, v243, v138
    v_mfma_f32_16x16x32_bf16 v[174:177], a[28:31], v[170:173], v[174:177]
    v_mul_f32 v139, v243, v139
    v_cvt_pk_f16_f32 v212, v138, v139
    v_mfma_f32_16x16x32_bf16 v[174:177], a[32:35], v[234:237], v[174:177]
    v_mul_f32 v140, v243, v140
    v_mul_f32 v141, v243, v141
    v_mfma_f32_16x16x32_bf16 v[174:177], a[36:39], v[154:157], v[174:177]
    v_cvt_pk_f16_f32 v213, v140, v141
    v_mul_f32 v238, v243, v238
    v_mfma_f32_16x16x32_bf16 v[174:177], a[40:43], v[158:161], v[174:177]
    v_mul_f32 v239, v243, v239
    v_cvt_pk_f16_f32 v204, v238, v239
    v_mfma_f32_16x16x32_bf16 v[174:177], a[44:47], v[226:229], v[174:177]
    v_mul_f32 v240, v243, v240
    v_mul_f32 v241, v243, v241
    v_mfma_f32_16x16x32_bf16 v[138:141], a[48:51], v[186:189], 0
    v_cvt_pk_f16_f32 v205, v240, v241
    v_mul_f32 v146, v242, v146
    v_mfma_f32_16x16x32_bf16 v[138:141], a[52:55], v[170:173], v[138:141]
    ds_read_b128 v[206:209], v5 offset:0
    ds_read_b128 v[194:197], v5 offset:16
    v_mfma_f32_16x16x32_bf16 v[138:141], a[56:59], v[234:237], v[138:141]
    ds_read_b128 v[238:241], v5 offset:48
    ds_read_b32 v143, v6 offset:192
    v_mfma_f32_16x16x32_bf16 v[138:141], a[60:63], v[154:157], v[138:141]
    v_mul_f32 v147, v242, v147
    v_cvt_pk_f16_f32 v146, v146, v147
    v_mfma_f32_16x16x32_bf16 v[138:141], a[64:67], v[158:161], v[138:141]
    v_mul_f32 v148, v242, v148
    v_mul_f32 v149, v242, v149
    v_mfma_f32_16x16x32_bf16 v[138:141], a[68:71], v[226:229], v[138:141]
    v_cvt_pk_f16_f32 v147, v148, v149
    v_mul_f32 v118, v242, v118
    v_mul_f32 v119, v242, v119
    v_cvt_pk_f16_f32 v148, v118, v119
    v_mul_f32 v120, v242, v120
    v_mul_f32 v121, v242, v121
    v_cvt_pk_f16_f32 v149, v120, v121
    v_mfma_f32_16x16x32_bf16 v[118:121], v[186:189], a[144:147], 0
    v_mul_f32 v134, v242, v134
    v_mul_f32 v135, v242, v135
    v_mfma_f32_16x16x32_bf16 v[118:121], v[170:173], a[148:151], v[118:121]
    s_waitcnt lgkmcnt(3)
    v_cvt_pk_f16_f32 v202, v134, v135
    v_mul_f32 v136, v242, v136
    v_mfma_f32_16x16x32_bf16 v[118:121], v[234:237], a[152:155], v[118:121]
    s_waitcnt lgkmcnt(1)
    v_mul_f32 v137, v242, v137
    v_cvt_pk_f16_f32 v203, v136, v137
    v_mfma_f32_16x16x32_bf16 v[118:121], v[154:157], a[156:159], v[118:121]
    s_waitcnt lgkmcnt(0)
    v_fma_f32 v254, v178, v178, s32
    v_fmac_f32 v254, v179, v179
    v_mfma_f32_16x16x32_bf16 v[118:121], v[158:161], a[160:163], v[118:121]
    v_fmac_f32 v254, v180, v180
    v_fmac_f32 v254, v181, v181
    v_mfma_f32_16x16x32_bf16 v[118:121], v[226:229], a[164:167], v[118:121]
    v_fmac_f32 v254, v174, v174
    v_fmac_f32 v254, v175, v175
    v_fmac_f32 v254, v176, v176
    v_fmac_f32 v254, v177, v177
    v_fmac_f32 v254, v138, v138
    v_fmac_f32 v254, v139, v139
    v_fmac_f32 v254, v140, v140
    v_fmac_f32 v254, v141, v141
    v_cvt_pk_bf16_f32 v134, v118, v119
    v_cvt_pk_bf16_f32 v135, v120, v121
    v_mfma_f32_16x16x32_f16 v[118:121], v[206:209], v[126:129], v[22:25]
    v_fmac_f32 v142, v183, v183
    v_fmac_f32 v142, v184, v184
    v_mfma_f32_16x16x32_f16 v[118:121], v[194:197], v[114:117], v[118:121]
    v_fmac_f32 v142, v185, v185
    v_fmac_f32 v142, v198, v198
    v_mfma_f32_16x16x32_f16 v[118:121], v[238:241], v[122:125], v[118:121]
    v_fmac_f32 v142, v199, v199
    v_fmac_f32 v142, v200, v200
    v_fmac_f32 v142, v201, v201
    v_cvt_pk_bf16_f32 v36, v254, v142
    v_mfma_f32_16x16x32_bf16 v[242:245], v[186:189], a[168:171], 0
    v_xor_b32 v0, 65536, v0
    v_xor_b32 v1, 65536, v1
    v_mfma_f32_16x16x32_bf16 v[242:245], v[170:173], a[172:175], v[242:245]
    v_mov_b32_dpp v143, v119 quad_perm:[0,1,2,3] row_mask:0x1 bank_mask:0xf
    v_add_u32 v5, 336, v5
    v_mfma_f32_16x16x32_bf16 v[242:245], v[234:237], a[176:179], v[242:245]
    v_xor_b32 v2, 65536, v2
    v_mfma_f32_16x16x32_bf16 v[242:245], v[154:157], a[180:183], v[242:245]
    v_mfma_f32_16x16x32_bf16 v[242:245], v[158:161], a[184:187], v[242:245]
    v_mfma_f32_16x16x32_bf16 v[242:245], v[226:229], a[188:191], v[242:245]
    s_nop 0
    s_nop 0
    s_nop 0
    s_nop 0
    s_nop 0
    s_nop 0
    s_nop 0
    s_nop 0
    v_cvt_pk_bf16_f32 v246, v242, v243
    v_cvt_pk_bf16_f32 v247, v244, v245
    v_mfma_f32_16x16x32_bf16 v[242:245], v[32:35], v[36:39], 0
    s_nop 0
    s_nop 0
    s_nop 0
    s_nop 0
    s_nop 0
    s_nop 0
    s_nop 0
    s_nop 0
    v_rsq_f32 v243, v243
    v_rsq_f32 v242, v242
    v_mul_f32 v150, v243, v150
    v_mul_f32 v242, s31, v242
    v_mul_f32 v151, v243, v151
    v_cvt_pk_f16_f32 v150, v150, v151
    v_mul_f32 v152, v243, v152
    v_mul_f32 v153, v243, v153
    v_cvt_pk_f16_f32 v151, v152, v153
    v_mul_f32 v182, v243, v182
    v_mul_f32 v183, v243, v183
    v_cvt_pk_f16_f32 v152, v182, v183
    v_mfma_f32_16x16x32_f16 v[230:233], v[206:209], v[146:149], v[24:27]
    v_mul_f32 v184, v243, v184
    v_mul_f32 v185, v243, v185
    v_mfma_f32_16x16x32_f16 v[230:233], v[194:197], v[210:213], v[230:233]
    v_cvt_pk_f16_f32 v153, v184, v185
    v_mul_f32 v198, v243, v198
    v_mfma_f32_16x16x32_f16 v[230:233], v[238:241], v[202:205], v[230:233]
    v_mul_f32 v199, v243, v199
    v_cvt_pk_f16_f32 v216, v198, v199
    v_mfma_f32_16x16x32_bf16 v[182:185], v[186:189], a[192:195], 0
    v_mul_f32 v200, v243, v200
    v_mul_f32 v201, v243, v201
    v_mfma_f32_16x16x32_bf16 v[182:185], v[170:173], a[196:199], v[182:185]
    v_cvt_pk_f16_f32 v217, v200, v201
    v_mul_f32 v178, v242, v178
    v_mfma_f32_16x16x32_bf16 v[182:185], v[234:237], a[200:203], v[182:185]
    v_mul_f32 v179, v242, v179
    v_cvt_pk_f16_f32 v198, v178, v179
    v_mfma_f32_16x16x32_bf16 v[182:185], v[154:157], a[204:207], v[182:185]
    v_mul_f32 v180, v242, v180
    v_mul_f32 v181, v242, v181
    v_mfma_f32_16x16x32_bf16 v[182:185], v[158:161], a[208:211], v[182:185]
    v_cvt_pk_f16_f32 v199, v180, v181
    v_mul_f32 v174, v242, v174
    v_mfma_f32_16x16x32_bf16 v[182:185], v[226:229], a[212:215], v[182:185]
    s_waitcnt vmcnt(0)
    ds_read2_b32 v[136:137], v6 offset0:0 offset1:0
    ds_read2_b32 v[248:249], v6 offset0:16 offset1:16
    v_mfma_f32_16x16x32_f16 v[226:229], v[114:117], v[126:129], v[46:49]
    s_barrier
    buffer_load_dwordx4 v10, s[8:11], 0 offen lds
    ds_read2_b32 v[160:161], v6 offset0:32 offset1:32
    v_mfma_f32_16x16x32_f16 v[154:157], v[210:213], v[126:129], v[50:53]
    s_add_u32 m0, s28, 4096
    v_cvt_pk_bf16_f32 v158, v182, v183
    v_cvt_pk_bf16_f32 v159, v184, v185
    v_mfma_f32_16x16x32_f16 v[182:185], v[150:153], v[126:129], v[54:57]
    v_mul_f32 v175, v242, v175
    v_cvt_pk_f16_f32 v200, v174, v175
    v_mul_f32 v176, v242, v176
    v_mfma_f32_16x16x16_f16 v[226:229], v[124:125], v[122:123], v[226:229]
    v_mul_f32 v177, v242, v177
    v_cvt_pk_f16_f32 v201, v176, v177
    v_mul_f32 v138, v242, v138
    v_mfma_f32_16x16x16_f16 v[154:157], v[204:205], v[122:123], v[154:157]
    v_mul_f32 v139, v242, v139
    v_cvt_pk_f16_f32 v214, v138, v139
    v_mul_f32 v140, v242, v140
    v_mfma_f32_16x16x16_f16 v[182:185], v[216:217], v[122:123], v[182:185]
    v_mul_f32 v141, v242, v141
    v_cvt_pk_f16_f32 v215, v140, v141
    v_mov_b32_dpp v143, v231 quad_perm:[0,1,2,3] row_mask:0x2 bank_mask:0xf
    v_max3_f32 v142, v118, v226, v227
    v_mfma_f32_16x16x32_f16 v[138:141], v[206:209], v[198:201], v[26:29]
    s_waitcnt lgkmcnt(1)
    buffer_load_dwordx4 v11, s[8:11], 0 offen lds
    v_max3_f32 v142, v142, v228, v229
    v_mfma_f32_16x16x32_f16 v[138:141], v[194:197], v[150:153], v[138:141]
    s_add_u32 m0, s28, 8192
    v_max3_f32 v142, v142, v154, v155
    v_max3_f32 v142, v142, v156, v157
    v_mfma_f32_16x16x32_f16 v[138:141], v[238:241], v[214:217], v[138:141]
    s_waitcnt lgkmcnt(0)
    v_max3_f32 v142, v142, v182, v183
    v_max3_f32 v142, v142, v184, v185
    v_mov_b32 v122, v142
    v_mfma_f32_16x16x16_bf16 v[126:129], a[216:217], v[144:145], v[222:225]
    v_add_u32 v6, 272, v6
    v_permlane32_swap_b32 v142, v122
    v_mfma_f32_16x16x16_bf16 v[174:177], a[240:241], v[144:145], v[222:225]
    v_max_f32 v142, v142, v122
    v_mov_b32 v122, v142
    v_mov_b32_dpp v143, v139 quad_perm:[0,1,2,3] row_mask:0x4 bank_mask:0xf
    v_mfma_f32_16x16x16_bf16 v[242:245], v[90:91], v[144:145], v[222:225]
    v_permlane16_swap_b32 v142, v122
    v_max_f32 v142, v142, v122
    v_mfma_f32_16x16x16_bf16 v[178:181], a[218:219], v[144:145], v[218:221]
    v_sub_f32 v226, v226, v142
    v_exp_f32 v226, v226
    v_mfma_f32_16x16x16_bf16 v[170:173], a[242:243], v[144:145], v[218:221]
    v_sub_f32 v227, v227, v142
    v_exp_f32 v227, v227
    v_mfma_f32_16x16x16_bf16 v[222:225], v[92:93], v[144:145], v[218:221]
    buffer_load_dwordx4 v12, s[8:11], 0 offen lds
    s_add_u32 m0, s28, 12288
    s_xor_b32 s28, s28, 65536
    v_cvt_pk_bf16_f32 v226, v226, v227
    v_sub_f32 v228, v228, v142
    v_exp_f32 v228, v228
    v_sub_f32 v229, v229, v142
    v_exp_f32 v229, v229
    v_sub_f32 v154, v154, v142
    v_cvt_pk_bf16_f32 v227, v228, v229
    v_exp_f32 v154, v154
    v_mfma_f32_16x16x32_f16 v[218:221], v[114:117], v[146:149], v[58:61]
    buffer_load_dwordx4 v13, s[8:11], 0 offen lds
    s_mov_b32 m0, s29
    s_xor_b32 s29, s29, s30
    v_sub_f32 v155, v155, v142
    v_exp_f32 v155, v155
    v_sub_f32 v156, v156, v142
    v_mfma_f32_16x16x16_f16 v[218:221], v[124:125], v[202:203], v[218:221]
    v_cvt_pk_bf16_f32 v228, v154, v155
    v_exp_f32 v156, v156
    v_sub_f32 v157, v157, v142
    v_exp_f32 v157, v157
    v_sub_f32 v182, v182, v142
    v_cvt_pk_bf16_f32 v229, v156, v157
    buffer_load_dwordx4 v14, s[8:11], 0 offen lds
    v_exp_f32 v182, v182
    v_mfma_f32_16x16x32_f16 v[154:157], v[210:213], v[146:149], v[62:65]
    v_sub_f32 v183, v183, v142
    v_exp_f32 v183, v183
    v_sub_f32 v184, v184, v142
    v_cvt_pk_bf16_f32 v36, v182, v183
    v_exp_f32 v184, v184
    v_sub_f32 v185, v185, v142
    v_mfma_f32_16x16x16_f16 v[154:157], v[204:205], v[202:203], v[154:157]
    v_exp_f32 v185, v185
    v_sub_f32 v118, v118, v142
    v_cvt_pk_bf16_f32 v37, v184, v185
    v_mfma_f32_16x16x32_f16 v[182:185], v[150:153], v[146:149], v[66:69]
    v_exp_f32 v118, v118
    v_max3_f32 v142, v230, v218, v219
    v_cvt_pk_bf16_f32 v39, v118, 0
    v_max3_f32 v142, v142, v220, v221
    v_max3_f32 v142, v142, v154, v155
    v_mfma_f32_16x16x32_bf16 v[118:121], v[28:31], v[36:39], 0
    v_max3_f32 v142, v142, v156, v157
    v_cvt_pk_bf16_f32 v126, v126, v127
    v_mfma_f32_16x16x32_bf16 v[118:121], v[28:31], v[226:229], v[118:121]
    v_accvgpr_write_b32 a216, v126
    v_cvt_pk_bf16_f32 v128, v128, v129
    v_mfma_f32_16x16x32_bf16 v[146:149], v[134:137], v[36:39], 0
    v_accvgpr_write_b32 a217, v128
    v_cvt_pk_bf16_f32 v174, v174, v175
    v_mfma_f32_16x16x32_bf16 v[146:149], v[190:193], v[226:229], v[146:149]
    v_accvgpr_write_b32 a240, v174
    v_cvt_pk_bf16_f32 v176, v176, v177
    v_mfma_f32_16x16x32_bf16 v[126:129], v[246:249], v[36:39], 0
    v_rcp_f32 v118, v118
    v_mfma_f32_16x16x32_bf16 v[126:129], v[162:165], v[226:229], v[126:129]
    v_accvgpr_write_b32 a241, v176
    v_cvt_pk_bf16_f32 v90, v242, v243
    v_mfma_f32_16x16x32_bf16 v[174:177], v[158:161], v[36:39], 0
    v_mul_f32 v146, v118, v146
    v_mul_f32 v147, v118, v147
    v_mfma_f32_16x16x32_bf16 v[174:177], v[166:169], v[226:229], v[174:177]
    v_cvt_pk_bf16_f32 v146, v146, v147
    v_mul_f32 v148, v118, v148
    v_mul_f32 v149, v118, v149
    v_mfma_f32_16x16x16_f16 v[182:185], v[216:217], v[202:203], v[182:185]
    v_cvt_pk_bf16_f32 v147, v148, v149
    v_mul_f32 v126, v118, v126
    v_mul_f32 v127, v118, v127
    v_cvt_pk_bf16_f32 v148, v126, v127
    v_mul_f32 v128, v118, v128
    v_mul_f32 v129, v118, v129
    v_cvt_pk_bf16_f32 v149, v128, v129
    ds_write_b128 v3, v[146:149] offset:0
    v_mul_f32 v174, v118, v174
    v_mul_f32 v175, v118, v175
    v_cvt_pk_bf16_f32 v122, v174, v175
    v_mul_f32 v176, v118, v176
    v_mul_f32 v177, v118, v177
    v_cvt_pk_bf16_f32 v123, v176, v177
    v_max3_f32 v142, v142, v182, v183
    ds_write_b64 v4, v[122:123] offset:4096
    v_max3_f32 v142, v142, v184, v185
    v_mov_b32 v122, v142
    v_cvt_pk_bf16_f32 v91, v244, v245
    ds_read_b128 v[118:121], v133 offset:128
    v_permlane32_swap_b32 v142, v122
    v_max_f32 v142, v142, v122
    v_mov_b32 v122, v142
    v_cvt_pk_bf16_f32 v178, v178, v179
    v_accvgpr_write_b32 a218, v178
    v_permlane16_swap_b32 v142, v122
    v_max_f32 v142, v142, v122
    v_sub_f32 v218, v218, v142
    v_exp_f32 v218, v218
    v_sub_f32 v219, v219, v142
    v_exp_f32 v219, v219
    v_sub_f32 v220, v220, v142
    v_cvt_pk_bf16_f32 v126, v218, v219
    v_exp_f32 v220, v220
    v_sub_f32 v221, v221, v142
    v_exp_f32 v221, v221
    v_sub_f32 v154, v154, v142
    v_cvt_pk_bf16_f32 v127, v220, v221
    v_exp_f32 v154, v154
    v_sub_f32 v155, v155, v142
    s_waitcnt lgkmcnt(0)
    v_mfma_f32_16x16x16_bf16 v[174:177], a[232:233], v[144:145], v[118:121]
    v_exp_f32 v155, v155
    v_sub_f32 v156, v156, v142
    v_mfma_f32_16x16x16_bf16 v[226:229], v[82:83], v[144:145], v[118:121]
    v_cvt_pk_bf16_f32 v128, v154, v155
    v_exp_f32 v156, v156
    v_mfma_f32_16x16x16_bf16 v[146:149], v[106:107], v[144:145], v[118:121]
    v_sub_f32 v157, v157, v142
    v_exp_f32 v157, v157
    v_sub_f32 v182, v182, v142
    v_cvt_pk_bf16_f32 v129, v156, v157
    v_exp_f32 v182, v182
    v_sub_f32 v183, v183, v142
    v_exp_f32 v183, v183
    v_sub_f32 v184, v184, v142
    v_cvt_pk_bf16_f32 v36, v182, v183
    v_exp_f32 v184, v184
    v_sub_f32 v185, v185, v142
    v_exp_f32 v185, v185
    v_mfma_f32_16x16x32_f16 v[218:221], v[114:117], v[198:201], v[70:73]
    v_cvt_pk_bf16_f32 v37, v184, v185
    v_sub_f32 v230, v230, v142
    v_mfma_f32_16x16x32_f16 v[154:157], v[210:213], v[198:201], v[74:77]
    v_exp_f32 v230, v230
    v_mfma_f32_16x16x32_f16 v[118:121], v[150:153], v[198:201], v[78:81]
    v_cvt_pk_bf16_f32 v39, v230, 0
    v_cvt_pk_bf16_f32 v180, v180, v181
    v_accvgpr_write_b32 a219, v180
    v_mfma_f32_16x16x32_bf16 v[150:153], v[28:31], v[36:39], 0
    v_cvt_pk_bf16_f32 v170, v170, v171
    v_accvgpr_write_b32 a242, v170
    v_mfma_f32_16x16x32_bf16 v[150:153], v[28:31], v[126:129], v[150:153]
    v_cvt_pk_bf16_f32 v172, v172, v173
    v_accvgpr_write_b32 a243, v172
    v_mfma_f32_16x16x32_bf16 v[170:173], v[134:137], v[36:39], 0
    v_cvt_pk_bf16_f32 v92, v222, v223
    v_cvt_pk_bf16_f32 v93, v224, v225
    v_mfma_f32_16x16x32_bf16 v[170:173], v[190:193], v[126:129], v[170:173]
    ds_read_b128 v[114:117], v133 offset:192
    v_cvt_pk_bf16_f32 v174, v174, v175
    v_mfma_f32_16x16x32_bf16 v[186:189], v[246:249], v[36:39], 0
    v_accvgpr_write_b32 a232, v174
    v_cvt_pk_bf16_f32 v176, v176, v177
    v_mfma_f32_16x16x32_bf16 v[186:189], v[162:165], v[126:129], v[186:189]
    v_accvgpr_write_b32 a233, v176
    v_cvt_pk_bf16_f32 v82, v226, v227
    v_mfma_f32_16x16x32_bf16 v[178:181], v[158:161], v[36:39], 0
    v_cvt_pk_bf16_f32 v83, v228, v229
    v_cvt_pk_bf16_f32 v106, v146, v147
    v_mfma_f32_16x16x32_bf16 v[178:181], v[166:169], v[126:129], v[178:181]
    v_cvt_pk_bf16_f32 v107, v148, v149
    v_rcp_f32 v150, v150
    v_mfma_f32_16x16x16_f16 v[218:221], v[124:125], v[214:215], v[218:221]
    v_mov_b32 v142, v143
    v_mul_f32 v170, v150, v170
    v_mul_f32 v171, v150, v171
    v_mfma_f32_16x16x16_f16 v[154:157], v[204:205], v[214:215], v[154:157]
    v_max_f32_dpp v142, v142, v142 quad_perm:[1,0,3,2] row_mask:0xf bank_mask:0xf
    v_cvt_pk_bf16_f32 v130, v170, v171
    v_mul_f32 v172, v150, v172
    v_mfma_f32_16x16x16_f16 v[118:121], v[216:217], v[214:215], v[118:121]
    s_waitcnt lgkmcnt(0)
    ds_read_b128 v[126:129], v133 offset:256
    v_max3_f32 v132, v138, v218, v219
    v_mfma_f32_16x16x16_bf16 v[122:125], a[220:221], v[144:145], v[114:117]
    v_max3_f32 v132, v132, v220, v221
    v_max3_f32 v132, v132, v154, v155
    v_max3_f32 v132, v132, v156, v157
    v_mfma_f32_16x16x16_bf16 v[146:149], a[244:245], v[144:145], v[114:117]
    v_max3_f32 v132, v132, v118, v119
    v_max3_f32 v132, v132, v120, v121
    v_mov_b32 v131, v132
    v_mfma_f32_16x16x16_bf16 v[182:185], v[94:95], v[144:145], v[114:117]
    v_cvt_pk_bf16_f32 v122, v122, v123
    v_accvgpr_write_b32 a220, v122
    v_cvt_pk_bf16_f32 v124, v124, v125
    v_accvgpr_write_b32 a221, v124
    v_cvt_pk_bf16_f32 v146, v146, v147
    v_accvgpr_write_b32 a244, v146
    v_cvt_pk_bf16_f32 v148, v148, v149
    v_accvgpr_write_b32 a245, v148
    v_cvt_pk_bf16_f32 v94, v182, v183
    v_cvt_pk_bf16_f32 v95, v184, v185
    ds_read_b128 v[122:125], v133 offset:320
    v_permlane32_swap_b32 v132, v131
    v_max_f32 v132, v132, v131
    v_mov_b32 v131, v132
    s_waitcnt lgkmcnt(1)
    v_mfma_f32_16x16x16_bf16 v[114:117], a[222:223], v[144:145], v[126:129]
    v_permlane16_swap_b32 v132, v131
    v_max_f32 v132, v132, v131
    v_mfma_f32_16x16x16_bf16 v[182:185], a[246:247], v[144:145], v[126:129]
    v_sub_f32 v218, v218, v132
    v_exp_f32 v218, v218
    v_mfma_f32_16x16x16_bf16 v[146:149], v[96:97], v[144:145], v[126:129]
    v_sub_f32 v219, v219, v132
    v_exp_f32 v219, v219
    v_cvt_pk_bf16_f32 v114, v114, v115
    v_accvgpr_write_b32 a222, v114
    v_cvt_pk_bf16_f32 v116, v116, v117
    v_accvgpr_write_b32 a223, v116
    v_cvt_pk_bf16_f32 v182, v182, v183
    v_accvgpr_write_b32 a246, v182
    v_cvt_pk_bf16_f32 v184, v184, v185
    v_accvgpr_write_b32 a247, v184
    v_cvt_pk_bf16_f32 v96, v146, v147
    v_cvt_pk_bf16_f32 v97, v148, v149
    s_waitcnt lgkmcnt(0)
    v_mfma_f32_16x16x16_bf16 v[114:117], a[234:235], v[144:145], v[122:125]
    ds_read_b128 v[206:209], v133 offset:384
    v_cvt_pk_bf16_f32 v146, v218, v219
    v_sub_f32 v220, v220, v132
    v_mfma_f32_16x16x16_bf16 v[174:177], v[84:85], v[144:145], v[122:125]
    v_exp_f32 v220, v220
    v_sub_f32 v221, v221, v132
    v_mfma_f32_16x16x16_bf16 v[126:129], v[108:109], v[144:145], v[122:125]
    ds_read_b128 v[182:185], v0 offset:20480
    ds_read_b128 v[198:201], v1 offset:20480
    ds_read_b128 v[210:213], v0 offset:20608
    ds_read_b128 v[222:225], v1 offset:20608
    ds_read_b128 v[226:229], v0 offset:20736
    ds_read_b128 v[242:245], v1 offset:20736
    v_cvt_pk_bf16_f32 v114, v114, v115
    v_accvgpr_write_b32 a234, v114
    v_cvt_pk_bf16_f32 v116, v116, v117
    v_accvgpr_write_b32 a235, v116
    v_cvt_pk_bf16_f32 v84, v174, v175
    s_waitcnt lgkmcnt(6)
    v_mfma_f32_16x16x16_bf16 v[122:125], a[224:225], v[144:145], v[206:209]
    v_cvt_pk_bf16_f32 v85, v176, v177
    v_cvt_pk_bf16_f32 v108, v126, v127
    v_cvt_pk_bf16_f32 v109, v128, v129
    v_mfma_f32_16x16x16_bf16 v[174:177], a[248:249], v[144:145], v[206:209]
    v_exp_f32 v221, v221
    v_sub_f32 v154, v154, v132
    v_mfma_f32_16x16x16_bf16 v[126:129], v[98:99], v[144:145], v[206:209]
    s_waitcnt lgkmcnt(4)
    ds_read_b128 v[202:205], v133 offset:448
    v_cvt_pk_bf16_f32 v122, v122, v123
    v_accvgpr_write_b32 a224, v122
    v_mfma_f32_16x16x32_bf16 v[114:117], a[72:75], v[182:185], 0
    s_waitcnt lgkmcnt(3)
    v_cvt_pk_bf16_f32 v124, v124, v125
    v_accvgpr_write_b32 a225, v124
    v_mfma_f32_16x16x32_bf16 v[114:117], a[76:79], v[198:201], v[114:117]
    s_waitcnt lgkmcnt(2)
    v_cvt_pk_bf16_f32 v174, v174, v175
    v_accvgpr_write_b32 a248, v174
    v_mfma_f32_16x16x32_bf16 v[114:117], a[80:83], v[210:213], v[114:117]
    s_waitcnt lgkmcnt(1)
    v_cvt_pk_bf16_f32 v176, v176, v177
    v_accvgpr_write_b32 a249, v176
    v_mfma_f32_16x16x32_bf16 v[114:117], a[84:87], v[222:225], v[114:117]
    v_cvt_pk_bf16_f32 v98, v126, v127
    v_cvt_pk_bf16_f32 v99, v128, v129
    v_mfma_f32_16x16x32_bf16 v[114:117], a[88:91], v[226:229], v[114:117]
    ds_read_b128 v[126:129], v133 offset:512
    v_cvt_pk_bf16_f32 v147, v220, v221
    v_mfma_f32_16x16x32_bf16 v[114:117], a[92:95], v[242:245], v[114:117]
    v_exp_f32 v154, v154
    v_mfma_f32_16x16x32_bf16 v[122:125], a[96:99], v[182:185], 0
    s_waitcnt lgkmcnt(1)
    v_sub_f32 v155, v155, v132
    v_exp_f32 v155, v155
    v_mfma_f32_16x16x16_bf16 v[174:177], a[226:227], v[144:145], v[202:205]
    v_cvt_pk_bf16_f32 v148, v154, v155
    v_sub_f32 v156, v156, v132
    v_sub_f32 v157, v157, v132
    v_mfma_f32_16x16x16_bf16 v[218:221], a[250:251], v[144:145], v[202:205]
    v_exp_f32 v156, v156
    v_sub_f32 v118, v118, v132
    v_mfma_f32_16x16x16_bf16 v[206:209], v[100:101], v[144:145], v[202:205]
    v_exp_f32 v157, v157
    v_cvt_pk_bf16_f32 v174, v174, v175
    v_accvgpr_write_b32 a226, v174
    v_mfma_f32_16x16x32_bf16 v[122:125], a[100:103], v[198:201], v[122:125]
    v_cvt_pk_bf16_f32 v176, v176, v177
    v_accvgpr_write_b32 a227, v176
    v_mfma_f32_16x16x32_bf16 v[122:125], a[104:107], v[210:213], v[122:125]
    s_waitcnt lgkmcnt(0)
    v_cvt_pk_bf16_f32 v218, v218, v219
    v_accvgpr_write_b32 a250, v218
    v_cvt_pk_bf16_f32 v220, v220, v221
    v_mfma_f32_16x16x16_bf16 v[174:177], a[236:237], v[144:145], v[126:129]
    v_accvgpr_write_b32 a251, v220
    v_cvt_pk_bf16_f32 v100, v206, v207
    v_cvt_pk_bf16_f32 v101, v208, v209
    v_mfma_f32_16x16x16_bf16 v[218:221], v[86:87], v[144:145], v[126:129]
    v_cvt_pk_bf16_f32 v149, v156, v157
    v_exp_f32 v118, v118
    v_mfma_f32_16x16x16_bf16 v[206:209], v[110:111], v[144:145], v[126:129]
    v_sub_f32 v119, v119, v132
    v_cvt_pk_bf16_f32 v174, v174, v175
    v_accvgpr_write_b32 a236, v174
    v_cvt_pk_bf16_f32 v176, v176, v177
    v_mfma_f32_16x16x32_bf16 v[122:125], a[108:111], v[222:225], v[122:125]
    ds_read_b128 v[154:157], v133 offset:576
    v_accvgpr_write_b32 a237, v176
    v_mfma_f32_16x16x32_bf16 v[122:125], a[112:115], v[226:229], v[122:125]
    v_cvt_pk_bf16_f32 v86, v218, v219
    v_cvt_pk_bf16_f32 v87, v220, v221
    v_mfma_f32_16x16x32_bf16 v[122:125], a[116:119], v[242:245], v[122:125]
    v_cvt_pk_bf16_f32 v110, v206, v207
    v_cvt_pk_bf16_f32 v111, v208, v209
    v_mfma_f32_16x16x32_bf16 v[126:129], a[120:123], v[182:185], 0
    ds_read_b128 v[174:177], v133 offset:640
    v_sub_f32 v120, v120, v132
    v_mfma_f32_16x16x32_bf16 v[126:129], a[124:127], v[198:201], v[126:129]
    v_exp_f32 v119, v119
    v_mfma_f32_16x16x32_bf16 v[126:129], a[128:131], v[210:213], v[126:129]
    v_cvt_pk_bf16_f32 v36, v118, v119
    v_sub_f32 v121, v121, v132
    v_mfma_f32_16x16x32_bf16 v[126:129], a[132:135], v[222:225], v[126:129]
    v_exp_f32 v120, v120
    v_mfma_f32_16x16x32_bf16 v[126:129], a[136:139], v[226:229], v[126:129]
    v_exp_f32 v121, v121
    v_mfma_f32_16x16x32_bf16 v[126:129], a[140:143], v[242:245], v[126:129]
    s_waitcnt lgkmcnt(1)
    v_cvt_pk_bf16_f32 v37, v120, v121
    v_sub_f32 v138, v138, v132
    v_max_f32_dpp v142, v142, v142 quad_perm:[2,3,0,1] row_mask:0xf bank_mask:0xf
    v_mfma_f32_16x16x16_bf16 v[118:121], a[228:229], v[144:145], v[154:157]
    v_exp_f32 v138, v138
    v_max_f32_dpp v142, v142, v142 row_half_mirror row_mask:0xf bank_mask:0xf
    v_mfma_f32_16x16x16_bf16 v[218:221], a[252:253], v[144:145], v[154:157]
    v_cvt_pk_bf16_f32 v39, v138, 0
    v_max_f32_dpp v142, v142, v142 row_mirror row_mask:0xf bank_mask:0xf
    v_mov_b32 v254, v142
    v_mul_f32 v173, v150, v173
    v_mfma_f32_16x16x32_bf16 v[206:209], v[28:31], v[36:39], 0
    s_waitcnt lgkmcnt(0)
    v_cvt_pk_bf16_f32 v118, v118, v119
    v_accvgpr_write_b32 a228, v118
    v_mfma_f32_16x16x32_bf16 v[206:209], v[28:31], v[146:149], v[206:209]
    v_cvt_pk_bf16_f32 v120, v120, v121
    v_accvgpr_write_b32 a229, v120
    v_mfma_f32_16x16x32_bf16 v[138:141], v[134:137], v[36:39], 0
    v_cvt_pk_bf16_f32 v218, v218, v219
    v_accvgpr_write_b32 a252, v218
    v_mfma_f32_16x16x32_bf16 v[138:141], v[190:193], v[146:149], v[138:141]
    v_cvt_pk_bf16_f32 v220, v220, v221
    v_accvgpr_write_b32 a253, v220
    v_mfma_f32_16x16x32_bf16 v[118:121], v[246:249], v[36:39], 0
    v_rcp_f32 v206, v206
    v_mfma_f32_16x16x32_bf16 v[118:121], v[162:165], v[146:149], v[118:121]
    v_permlane32_swap_b32 v142, v254
    v_mfma_f32_16x16x32_bf16 v[218:221], v[158:161], v[36:39], 0
    v_max_f32 v142, v142, v254
    v_mul_f32 v138, v206, v138
    v_mfma_f32_16x16x32_bf16 v[218:221], v[166:169], v[146:149], v[218:221]
    v_mul_f32 v139, v206, v139
    v_cvt_pk_bf16_f32 v146, v138, v139
    v_mul_f32 v140, v206, v140
    v_mfma_f32_16x16x16_bf16 v[202:205], v[102:103], v[144:145], v[154:157]
    v_mul_f32 v141, v206, v141
    v_cvt_pk_bf16_f32 v147, v140, v141
    v_mul_f32 v118, v206, v118
    v_mfma_f32_16x16x16_bf16 v[138:141], a[230:231], v[144:145], v[174:177]
    v_mul_f32 v119, v206, v119
    v_cvt_pk_bf16_f32 v148, v118, v119
    v_mul_f32 v120, v206, v120
    v_mfma_f32_16x16x16_bf16 v[154:157], a[254:255], v[144:145], v[174:177]
    v_mul_f32 v121, v206, v121
    v_cvt_pk_bf16_f32 v149, v120, v121
    v_mul_f32 v218, v206, v218
    v_mfma_f32_16x16x16_bf16 v[118:121], v[104:105], v[144:145], v[174:177]
    v_mul_f32 v219, v206, v219
    v_cvt_pk_bf16_f32 v170, v218, v219
    v_mul_f32 v220, v206, v220
    v_mul_f32 v221, v206, v221
    v_mfma_f32_16x16x32_bf16 v[206:209], a[0:3], v[182:185], 0
    ds_write_b128 v3, v[146:149] offset:12288
    v_mfma_f32_16x16x32_bf16 v[206:209], a[4:7], v[198:201], v[206:209]
    v_cvt_pk_bf16_f32 v171, v220, v221
    v_cvt_pk_bf16_f32 v102, v202, v203
    v_mfma_f32_16x16x32_bf16 v[206:209], a[8:11], v[210:213], v[206:209]
    v_cvt_pk_bf16_f32 v103, v204, v205
    v_cvt_pk_bf16_f32 v138, v138, v139
    v_mfma_f32_16x16x32_bf16 v[206:209], a[12:15], v[222:225], v[206:209]
    ds_read_b128 v[146:149], v133 offset:704
    v_accvgpr_write_b32 a230, v138
    v_mfma_f32_16x16x32_bf16 v[206:209], a[16:19], v[226:229], v[206:209]
    ds_write_b64 v4, v[170:171] offset:16384
    v_mfma_f32_16x16x32_bf16 v[206:209], a[20:23], v[242:245], v[206:209]
    v_cvt_pk_bf16_f32 v140, v140, v141
    v_accvgpr_write_b32 a231, v140
    v_mfma_f32_16x16x32_bf16 v[174:177], a[24:27], v[182:185], 0
    v_cvt_pk_bf16_f32 v154, v154, v155
    v_accvgpr_write_b32 a254, v154
    v_mfma_f32_16x16x32_bf16 v[174:177], a[28:31], v[198:201], v[174:177]
    v_cvt_pk_bf16_f32 v156, v156, v157
    v_accvgpr_write_b32 a255, v156
    v_mfma_f32_16x16x32_bf16 v[174:177], a[32:35], v[210:213], v[174:177]
    v_cvt_pk_bf16_f32 v104, v118, v119
    v_cvt_pk_bf16_f32 v105, v120, v121
    v_mfma_f32_16x16x32_bf16 v[174:177], a[36:39], v[222:225], v[174:177]
    v_mov_b32 v254, v142
    v_cvt_pk_bf16_f32 v131, v172, v173
    v_mfma_f32_16x16x32_bf16 v[174:177], a[40:43], v[226:229], v[174:177]
    s_waitcnt lgkmcnt(1)
    v_permlane16_swap_b32 v142, v254
    v_max_f32 v142, v142, v254
    v_mfma_f32_16x16x16_bf16 v[118:121], a[238:239], v[144:145], v[146:149]
    v_sub_f32 v143, v143, v142
    v_exp_f32 v143, v143
    v_mfma_f32_16x16x16_bf16 v[154:157], v[88:89], v[144:145], v[146:149]
    v_cvt_pk_bf16_f32 v143, v143, v143
    v_mul_f32 v186, v150, v186
    v_mul_f32 v187, v150, v187
    v_mfma_f32_16x16x16_bf16 v[138:141], v[112:113], v[144:145], v[146:149]
    v_cvt_pk_bf16_f32 v132, v186, v187
    v_cvt_pk_bf16_f32 v118, v118, v119
    v_accvgpr_write_b32 a238, v118
    v_cvt_pk_bf16_f32 v120, v120, v121
    v_mfma_f32_16x16x32_bf16 v[174:177], a[44:47], v[242:245], v[174:177]
    ds_write_b16 v8, v143
    v_mfma_f32_16x16x32_bf16 v[218:221], a[48:51], v[182:185], 0
    v_accvgpr_write_b32 a239, v120
    v_cvt_pk_bf16_f32 v88, v154, v155
    v_mfma_f32_16x16x32_bf16 v[218:221], a[52:55], v[198:201], v[218:221]
    ds_read_b128 v[142:145], v9
    ds_read_b128 v[118:121], v9 offset:64
    v_mfma_f32_16x16x32_bf16 v[218:221], a[56:59], v[210:213], v[218:221]
    v_cvt_pk_bf16_f32 v89, v156, v157
    v_cvt_pk_bf16_f32 v112, v138, v139
    v_mfma_f32_16x16x32_bf16 v[218:221], a[60:63], v[222:225], v[218:221]
    v_cvt_pk_bf16_f32 v113, v140, v141
    v_mul_f32 v188, v150, v188
    v_mfma_f32_16x16x32_bf16 v[218:221], a[64:67], v[226:229], v[218:221]
    v_mul_f32 v189, v150, v189
    v_cvt_pk_bf16_f32 v133, v188, v189
    v_mfma_f32_16x16x32_bf16 v[218:221], a[68:71], v[242:245], v[218:221]
    ds_write_b128 v3, v[130:133] offset:6144
    v_mfma_f32_16x16x32_bf16 v[170:173], v[182:185], a[144:147], 0
    v_mul_f32 v178, v150, v178
    v_mul_f32 v179, v150, v179
    v_mfma_f32_16x16x32_bf16 v[170:173], v[198:201], a[148:151], v[170:173]
    v_cvt_pk_bf16_f32 v254, v178, v179
    v_mul_f32 v180, v150, v180
    v_mfma_f32_16x16x32_bf16 v[170:173], v[210:213], a[152:155], v[170:173]
    s_waitcnt lgkmcnt(1)
    v_mul_f32 v181, v150, v181
    v_cvt_pk_bf16_f32 v255, v180, v181
    v_mfma_f32_16x16x32_bf16 v[130:133], v[142:145], v[28:31], 0
    ds_write_b64 v4, v[254:255] offset:10240
    v_mfma_f32_16x16x32_bf16 v[130:133], v[118:121], v[28:31], v[130:133]
    v_xor_b32 v3, 65536, v3
    v_xor_b32 v4, 65536, v4
    v_mfma_f32_16x16x32_bf16 v[154:157], v[142:145], v[190:193], 0
    v_mfma_f32_16x16x32_bf16 v[154:157], v[118:121], v[134:137], v[154:157]
    v_mfma_f32_16x16x32_bf16 v[134:137], v[142:145], v[162:165], 0
    v_mfma_f32_16x16x32_bf16 v[134:137], v[118:121], v[246:249], v[134:137]
    v_mfma_f32_16x16x32_bf16 v[162:165], v[142:145], v[166:169], 0
    v_mfma_f32_16x16x32_bf16 v[162:165], v[118:121], v[158:161], v[162:165]
    v_rcp_f32 v130, v130
    v_mfma_f32_16x16x32_bf16 v[170:173], v[222:225], a[156:159], v[170:173]
    v_mfma_f32_16x16x32_bf16 v[170:173], v[226:229], a[160:163], v[170:173]
    v_mfma_f32_16x16x32_bf16 v[170:173], v[242:245], a[164:167], v[170:173]
    v_mul_f32 v154, v154, v130
    s_nop 0
    v_mul_f32_dpp v154, v134, v130 quad_perm:[0,1,2,3] row_mask:0x2 bank_mask:0xf
    s_nop 0
    v_mul_f32_dpp v154, v162, v130 quad_perm:[0,1,2,3] row_mask:0x4 bank_mask:0xf
    v_cvt_pk_bf16_f32 v154, v154, v154
    ds_write_b16 v7, v154
    v_add_u32 v7, 16, v7
    s_waitcnt lgkmcnt(0)
    s_barrier
    s_waitcnt lgkmcnt(0)
    s_cmp_eq_u32 s17, 1
    s_cbranch_scc1 L_drain
    s_max_u32 s3, s37, s44
    s_cmp_gt_u32 s3, 0x42000000
    s_cbranch_scc1 L_safe
    v_cvt_pk_f16_f32 v118, v114, v115
    v_pk_mul_f16 v163, v118, v118
    v_cvt_pk_f16_f32 v119, v116, v117
    v_pk_mul_f16 v165, v119, v119
    v_cvt_pk_f16_f32 v120, v122, v123
    v_pk_fma_f16 v163, v120, v120, v163
    v_cvt_pk_f16_f32 v121, v124, v125
    v_pk_fma_f16 v165, v121, v121, v165
    v_cvt_pk_f16_f32 v196, v126, v127
    v_pk_fma_f16 v163, v196, v196, v163
    v_cvt_pk_f16_f32 v197, v128, v129
    v_pk_fma_f16 v165, v197, v197, v165
    v_cvt_pk_f16_f32 v206, v206, v207
    s_branch L_go
L_safe:
    v_fma_f32 v130, v114, v114, s32
    v_fmac_f32 v130, v115, v115
    v_fmac_f32 v130, v116, v116
    v_fmac_f32 v130, v117, v117
    v_fmac_f32 v130, v122, v122
    v_fmac_f32 v130, v123, v123
    v_fmac_f32 v130, v124, v124
    v_fmac_f32 v130, v125, v125
    v_fmac_f32 v130, v126, v126
    v_fmac_f32 v130, v127, v127
    v_fmac_f32 v130, v128, v128
    v_fmac_f32 v130, v129, v129
    v_fma_f32 v131, v206, v206, s32
    v_fmac_f32 v131, v207, v207
    v_fmac_f32 v131, v208, v208
    v_fmac_f32 v131, v209, v209
    v_fmac_f32 v131, v174, v174
    s_cmp_eq_u32 s16, 1
    s_cbranch_scc1 L_loop_safe1
    s_cmp_eq_u32 s16, 2
    s_cbranch_scc1 L_loop_safe2
    s_cmp_eq_u32 s16, 3
    s_cbranch_scc1 L_loop_safe3
    s_branch L_loop_safe0
.p2align 6
L_loop_safe0:
    v_mfma_f32_16x16x32_bf16 v[162:165], v[182:185], a[168:171], 0
    s_add_u32 s12, s42, s27
    ds_read_b128 v[194:197], v2 offset:18432
    ds_read_b128 v[230:233], v2 offset:19456
    v_mfma_f32_16x16x32_bf16 v[162:165], v[198:201], a[172:175], v[162:165]
    s_addc_u32 s13, s43, 0
    v_fmac_f32 v131, v175, v175
    v_fmac_f32 v131, v176, v176
    v_mfma_f32_16x16x32_bf16 v[162:165], v[210:213], a[176:179], v[162:165]
    s_sub_u32 s14, s36, s27
    v_fmac_f32 v131, v177, v177
    v_fmac_f32 v131, v218, v218
    v_mfma_f32_16x16x32_bf16 v[162:165], v[222:225], a[180:183], v[162:165]
    s_cmp_ge_u32 s18, 2
    v_fmac_f32 v131, v219, v219
    v_fmac_f32 v131, v220, v220
    v_mfma_f32_16x16x32_bf16 v[162:165], v[226:229], a[184:187], v[162:165]
    s_cselect_b32 s14, s14, 0
    ds_read_b128 v[118:121], v0 offset:26624
    v_fmac_f32 v131, v221, v221
    v_mfma_f32_16x16x32_bf16 v[162:165], v[242:245], a[188:191], v[162:165]
    s_add_u32 s34, s18, 2
    ds_read_b128 v[134:137], v1 offset:26624
    v_cvt_pk_bf16_f32 v36, v131, v130
    v_mfma_f32_16x16x32_bf16 v[214:217], v[182:185], a[192:195], 0
    s_add_u32 s8, s40, s23
    ds_read_b128 v[154:157], v0 offset:26752
    v_cvt_pk_bf16_f32 v170, v170, v171
    v_mfma_f32_16x16x32_bf16 v[214:217], v[198:201], a[196:199], v[214:217]
    s_addc_u32 s9, s41, 0
    ds_read_b128 v[198:201], v1 offset:26752
    v_cvt_pk_bf16_f32 v171, v172, v173
    v_mfma_f32_16x16x32_bf16 v[166:169], v[32:35], v[36:39], 0
    s_sub_u32 s10, s36, s23
    v_cvt_pk_bf16_f32 v130, v162, v163
    v_cvt_pk_bf16_f32 v131, v164, v165
    v_mfma_f32_16x16x32_bf16 v[214:217], v[210:213], a[200:203], v[214:217]
    s_waitcnt lgkmcnt(4)
    ds_read_b128 v[210:213], v0 offset:26880
    s_cmp_lt_u32 s34, s17
    v_mfma_f32_16x16x32_bf16 v[234:237], v[32:35], v[194:197], 0
    s_cselect_b32 s10, s10, 0
    v_rsq_f32 v167, v167
    v_mfma_f32_16x16x32_bf16 v[234:237], v[32:35], v[230:233], v[234:237]
    s_add_u32 m0, s28, 0
    v_rsq_f32 v166, v166
    v_mfma_f32_16x16x32_bf16 v[214:217], v[222:225], a[204:207], v[214:217]
    s_waitcnt lgkmcnt(4)
    ds_read_b128 v[162:165], v1 offset:26880
    v_mul_f32 v166, s31, v166
    v_mfma_f32_16x16x32_bf16 v[214:217], v[226:229], a[208:211], v[214:217]
    s_mov_b32 s27, s26
    v_mul_f32 v114, v167, v114
    v_mul_f32 v115, v167, v115
    v_mfma_f32_16x16x32_bf16 v[214:217], v[242:245], a[212:215], v[214:217]
    s_mov_b32 s26, s25
    v_cvt_pk_f16_f32 v242, v114, v115
    v_mul_f32 v116, v167, v116
    v_mfma_f32_16x16x32_bf16 v[226:229], a[72:75], v[118:121], 0
    s_waitcnt lgkmcnt(2)
    v_mul_f32 v117, v167, v117
    v_cvt_pk_f16_f32 v243, v116, v117
    v_mfma_f32_16x16x32_bf16 v[226:229], a[76:79], v[134:137], v[226:229]
    s_mov_b32 s25, s24
    v_cvt_pk_bf16_f32 v114, v214, v215
    v_cvt_pk_bf16_f32 v115, v216, v217
    v_mfma_f32_16x16x32_bf16 v[226:229], a[80:83], v[154:157], v[226:229]
    s_mov_b32 s24, s23
    v_mul_f32 v122, v167, v122
    v_mul_f32 v123, v167, v123
    v_mfma_f32_16x16x32_bf16 v[226:229], a[84:87], v[198:201], v[226:229]
    s_waitcnt lgkmcnt(1)
    v_cvt_pk_f16_f32 v244, v122, v123
    v_mul_f32 v124, v167, v124
    v_mfma_f32_16x16x32_bf16 v[226:229], a[88:91], v[210:213], v[226:229]
    v_mul_f32 v125, v167, v125
    v_cvt_pk_f16_f32 v245, v124, v125
    v_mfma_f32_16x16x32_bf16 v[122:125], a[96:99], v[118:121], 0
    s_waitcnt lgkmcnt(0)
    v_mul_f32 v126, v167, v126
    v_mul_f32 v127, v167, v127
    v_mfma_f32_16x16x32_bf16 v[226:229], a[92:95], v[162:165], v[226:229]
    v_cvt_pk_f16_f32 v184, v126, v127
    v_mul_f32 v128, v167, v128
    v_mfma_f32_16x16x32_bf16 v[122:125], a[100:103], v[134:137], v[122:125]
    v_mul_f32 v129, v167, v129
    v_cvt_pk_f16_f32 v185, v128, v129
    v_mfma_f32_16x16x32_bf16 v[122:125], a[104:107], v[154:157], v[122:125]
    v_mul_f32 v206, v166, v206
    v_mul_f32 v207, v166, v207
    v_mfma_f32_16x16x32_bf16 v[122:125], a[108:111], v[198:201], v[122:125]
    v_cvt_pk_f16_f32 v222, v206, v207
    v_mul_f32 v208, v166, v208
    v_mfma_f32_16x16x32_bf16 v[122:125], a[112:115], v[210:213], v[122:125]
    v_mul_f32 v209, v166, v209
    v_cvt_pk_f16_f32 v223, v208, v209
    v_mfma_f32_16x16x32_bf16 v[122:125], a[116:119], v[162:165], v[122:125]
    v_mul_f32 v174, v166, v174
    v_mul_f32 v175, v166, v175
    v_mfma_f32_16x16x32_bf16 v[126:129], a[120:123], v[118:121], 0
    v_cvt_pk_f16_f32 v224, v174, v175
    v_mul_f32 v176, v166, v176
    v_mfma_f32_16x16x32_bf16 v[126:129], a[124:127], v[134:137], v[126:129]
    v_mul_f32 v177, v166, v177
    v_cvt_pk_f16_f32 v225, v176, v177
    v_mfma_f32_16x16x32_bf16 v[126:129], a[128:131], v[154:157], v[126:129]
    v_mul_f32 v218, v166, v218
    v_mul_f32 v219, v166, v219
    v_mfma_f32_16x16x32_bf16 v[126:129], a[132:135], v[198:201], v[126:129]
    v_cvt_pk_f16_f32 v182, v218, v219
    v_mul_f32 v220, v166, v220
    v_mfma_f32_16x16x32_bf16 v[126:129], a[136:139], v[210:213], v[126:129]
    v_mul_f32 v221, v166, v221
    v_cvt_pk_f16_f32 v183, v220, v221
    v_mfma_f32_16x16x32_bf16 v[126:129], a[140:143], v[162:165], v[126:129]
    v_fma_f32 v116, v226, v226, s32
    v_fmac_f32 v116, v227, v227
    v_mfma_f32_16x16x32_bf16 v[206:209], a[0:3], v[118:121], 0
    v_fmac_f32 v116, v228, v228
    v_fmac_f32 v116, v229, v229
    v_mfma_f32_16x16x32_bf16 v[206:209], a[4:7], v[134:137], v[206:209]
    v_fmac_f32 v116, v122, v122
    v_fmac_f32 v116, v123, v123
    v_mfma_f32_16x16x32_bf16 v[206:209], a[8:11], v[154:157], v[206:209]
    v_fmac_f32 v116, v124, v124
    v_fmac_f32 v116, v125, v125
    v_mfma_f32_16x16x32_bf16 v[206:209], a[12:15], v[198:201], v[206:209]
    v_fmac_f32 v116, v126, v126
    v_fmac_f32 v116, v127, v127
    v_mfma_f32_16x16x32_bf16 v[206:209], a[16:19], v[210:213], v[206:209]
    v_fmac_f32 v116, v128, v128
    v_fmac_f32 v116, v129, v129
    v_mfma_f32_16x16x32_bf16 v[206:209], a[20:23], v[162:165], v[206:209]
    v_mul_f32 v117, 0x3baaaaab, v234
    v_mul_f32 v254, 0x3baaaaab, v235
    v_mfma_f32_16x16x32_bf16 v[174:177], a[24:27], v[118:121], 0
    v_rsq_f32 v117, v117
    v_mfma_f32_16x16x32_bf16 v[174:177], a[28:31], v[134:137], v[174:177]
    v_rsq_f32 v254, v254
    v_mfma_f32_16x16x32_bf16 v[174:177], a[32:35], v[154:157], v[174:177]
    v_mul_f32 v255, 0x3baaaaab, v236
    v_fma_f32 v132, v206, v206, s32
    v_mfma_f32_16x16x32_bf16 v[174:177], a[36:39], v[198:201], v[174:177]
    v_fmac_f32 v132, v207, v207
    v_fmac_f32 v132, v208, v208
    v_mfma_f32_16x16x32_bf16 v[174:177], a[40:43], v[210:213], v[174:177]
    v_fmac_f32 v132, v209, v209
    v_mul_f32 v150, v117, v150
    v_mfma_f32_16x16x32_bf16 v[174:177], a[44:47], v[162:165], v[174:177]
    v_rsq_f32 v255, v255
    v_mfma_f32_16x16x32_bf16 v[218:221], a[48:51], v[118:121], 0
    v_mul_f32 v151, v117, v151
    v_cvt_pk_bf16_f32 v194, v150, v151
    v_mfma_f32_16x16x32_bf16 v[218:221], a[52:55], v[134:137], v[218:221]
    v_mul_f32 v152, v117, v152
    v_mul_f32 v153, v117, v153
    v_mfma_f32_16x16x32_bf16 v[218:221], a[56:59], v[154:157], v[218:221]
    v_fmac_f32 v132, v174, v174
    v_fmac_f32 v132, v175, v175
    v_mfma_f32_16x16x32_bf16 v[218:221], a[60:63], v[198:201], v[218:221]
    v_fmac_f32 v132, v176, v176
    v_fmac_f32 v132, v177, v177
    v_mfma_f32_16x16x32_bf16 v[218:221], a[64:67], v[210:213], v[218:221]
    v_cvt_pk_bf16_f32 v195, v152, v153
    v_mul_f32 v190, v117, v190
    v_mfma_f32_16x16x32_bf16 v[218:221], a[68:71], v[162:165], v[218:221]
    v_mul_f32 v191, v117, v191
    v_cvt_pk_bf16_f32 v196, v190, v191
    v_mfma_f32_16x16x32_bf16 v[150:153], v[118:121], a[144:147], 0
    v_mul_f32 v192, v117, v192
    v_mul_f32 v193, v117, v193
    v_mfma_f32_16x16x32_bf16 v[150:153], v[134:137], a[148:151], v[150:153]
    v_cvt_pk_bf16_f32 v197, v192, v193
    v_mul_f32 v202, v117, v202
    v_mfma_f32_16x16x32_bf16 v[150:153], v[154:157], a[152:155], v[150:153]
    buffer_store_dwordx4 v[194:197], v15, s[12:15], 0 offen
    v_fmac_f32 v132, v218, v218
    v_fmac_f32 v132, v219, v219
    v_fmac_f32 v132, v220, v220
    v_fmac_f32 v132, v221, v221
    v_mfma_f32_16x16x32_bf16 v[150:153], v[198:201], a[156:159], v[150:153]
    v_cvt_pk_bf16_f32 v36, v132, v116
    v_mul_f32 v203, v117, v203
    v_mfma_f32_16x16x32_bf16 v[150:153], v[210:213], a[160:163], v[150:153]
    v_cvt_pk_bf16_f32 v116, v202, v203
    v_mul_f32 v204, v117, v204
    v_mfma_f32_16x16x32_bf16 v[190:193], v[32:35], v[36:39], 0
    v_mul_f32 v205, v117, v205
    v_cvt_pk_bf16_f32 v117, v204, v205
    v_mfma_f32_16x16x32_bf16 v[150:153], v[162:165], a[164:167], v[150:153]
    v_mul_f32 v146, v255, v146
    v_mul_f32 v147, v255, v147
    v_mfma_f32_16x16x32_bf16 v[202:205], v[118:121], a[168:171], 0
    v_cvt_pk_bf16_f32 v146, v146, v147
    v_mul_f32 v148, v255, v148
    v_mfma_f32_16x16x32_bf16 v[202:205], v[134:137], a[172:175], v[202:205]
    v_rsq_f32 v191, v191
    v_mfma_f32_16x16x32_bf16 v[202:205], v[154:157], a[176:179], v[202:205]
    v_cvt_pk_bf16_f32 v172, v150, v151
    v_cvt_pk_bf16_f32 v173, v152, v153
    v_mfma_f32_16x16x32_bf16 v[202:205], v[198:201], a[180:183], v[202:205]
    v_rsq_f32 v190, v190
    v_mfma_f32_16x16x32_bf16 v[202:205], v[210:213], a[184:187], v[202:205]
    ds_read_b128 v[150:153], v0 offset:32768
    v_mul_f32 v190, s31, v190
    v_mfma_f32_16x16x32_bf16 v[202:205], v[162:165], a[188:191], v[202:205]
    ds_read_b128 v[166:169], v1 offset:32768
    v_mul_f32 v226, v191, v226
    v_mfma_f32_16x16x32_bf16 v[194:197], v[118:121], a[192:195], 0
    ds_read_b128 v[118:121], v0 offset:32896
    v_mul_f32 v227, v191, v227
    v_mfma_f32_16x16x32_bf16 v[194:197], v[134:137], a[196:199], v[194:197]
    ds_read_b128 v[134:137], v1 offset:32896
    v_cvt_pk_f16_f32 v226, v226, v227
    v_mfma_f32_16x16x32_bf16 v[194:197], v[154:157], a[200:203], v[194:197]
    ds_read_b128 v[154:157], v0 offset:33024
    v_cvt_pk_bf16_f32 v132, v202, v203
    v_mfma_f32_16x16x32_bf16 v[194:197], v[198:201], a[204:207], v[194:197]
    ds_read_b128 v[198:201], v1 offset:33024
    v_cvt_pk_bf16_f32 v133, v204, v205
    v_mfma_f32_16x16x32_bf16 v[194:197], v[210:213], a[208:211], v[194:197]
    v_mul_f32 v228, v191, v228
    v_mul_f32 v229, v191, v229
    v_mfma_f32_16x16x32_bf16 v[194:197], v[162:165], a[212:215], v[194:197]
    v_cvt_pk_f16_f32 v227, v228, v229
    v_mul_f32 v122, v191, v122
    v_mfma_f32_16x16x32_f16 v[210:213], v[242:245], v[222:225], v[46:49]
    s_waitcnt lgkmcnt(5)
    buffer_store_dwordx2 v[116:117], v18, s[12:15], 0 offen
    v_mul_f32 v123, v191, v123
    v_cvt_pk_f16_f32 v228, v122, v123
    v_mfma_f32_16x16x32_bf16 v[202:205], a[72:75], v[150:153], 0
    s_waitcnt lgkmcnt(3)
    v_cvt_pk_bf16_f32 v116, v194, v195
    v_cvt_pk_bf16_f32 v117, v196, v197
    v_mfma_f32_16x16x32_bf16 v[202:205], a[76:79], v[166:169], v[202:205]
    s_waitcnt lgkmcnt(2)
    v_mul_f32 v124, v191, v124
    v_mul_f32 v125, v191, v125
    v_mfma_f32_16x16x32_bf16 v[202:205], a[80:83], v[118:121], v[202:205]
    s_waitcnt lgkmcnt(1)
    v_cvt_pk_f16_f32 v229, v124, v125
    v_mul_f32 v126, v191, v126
    v_mfma_f32_16x16x32_bf16 v[202:205], a[84:87], v[134:137], v[202:205]
    s_waitcnt lgkmcnt(0)
    v_mul_f32 v127, v191, v127
    v_cvt_pk_f16_f32 v124, v126, v127
    v_mfma_f32_16x16x32_bf16 v[202:205], a[88:91], v[154:157], v[202:205]
    v_mul_f32 v128, v191, v128
    v_mul_f32 v129, v191, v129
    v_mfma_f32_16x16x32_bf16 v[202:205], a[92:95], v[198:201], v[202:205]
    v_cvt_pk_f16_f32 v125, v128, v129
    v_mul_f32 v206, v190, v206
    v_mfma_f32_16x16x32_bf16 v[126:129], a[96:99], v[150:153], 0
    v_mul_f32 v207, v190, v207
    v_cvt_pk_f16_f32 v206, v206, v207
    v_mfma_f32_16x16x32_bf16 v[126:129], a[100:103], v[166:169], v[126:129]
    v_mul_f32 v208, v190, v208
    v_mul_f32 v209, v190, v209
    v_mfma_f32_16x16x32_bf16 v[126:129], a[104:107], v[118:121], v[126:129]
    v_cvt_pk_f16_f32 v207, v208, v209
    v_mul_f32 v174, v190, v174
    v_mfma_f32_16x16x32_bf16 v[126:129], a[108:111], v[134:137], v[126:129]
    v_mul_f32 v175, v190, v175
    v_cvt_pk_f16_f32 v208, v174, v175
    v_mfma_f32_16x16x32_bf16 v[126:129], a[112:115], v[154:157], v[126:129]
    v_mul_f32 v176, v190, v176
    v_mul_f32 v177, v190, v177
    v_mfma_f32_16x16x32_bf16 v[126:129], a[116:119], v[198:201], v[126:129]
    v_cvt_pk_f16_f32 v209, v176, v177
    v_mul_f32 v218, v190, v218
    v_mfma_f32_16x16x32_bf16 v[174:177], a[120:123], v[150:153], 0
    v_mul_f32 v219, v190, v219
    v_cvt_pk_f16_f32 v122, v218, v219
    v_mfma_f32_16x16x32_bf16 v[174:177], a[124:127], v[166:169], v[174:177]
    v_mul_f32 v220, v190, v220
    v_mul_f32 v221, v190, v221
    v_mfma_f32_16x16x32_bf16 v[174:177], a[128:131], v[118:121], v[174:177]
    v_cvt_pk_f16_f32 v123, v220, v221
    v_fma_f32 v162, v202, v202, s32
    v_mfma_f32_16x16x32_bf16 v[174:177], a[132:135], v[134:137], v[174:177]
    v_fmac_f32 v162, v203, v203
    v_fmac_f32 v162, v204, v204
    v_mfma_f32_16x16x32_bf16 v[174:177], a[136:139], v[154:157], v[174:177]
    v_fmac_f32 v162, v205, v205
    v_fmac_f32 v162, v126, v126
    v_mfma_f32_16x16x32_bf16 v[174:177], a[140:143], v[198:201], v[174:177]
    v_fmac_f32 v162, v127, v127
    v_fmac_f32 v162, v128, v128
    v_mfma_f32_16x16x32_bf16 v[190:193], a[0:3], v[150:153], 0
    v_fmac_f32 v162, v129, v129
    v_mul_f32 v149, v255, v149
    v_mfma_f32_16x16x32_bf16 v[190:193], a[4:7], v[166:169], v[190:193]
    v_cvt_pk_bf16_f32 v147, v148, v149
    v_mul_f32 v138, v255, v138
    v_mfma_f32_16x16x32_bf16 v[190:193], a[8:11], v[118:121], v[190:193]
    v_fmac_f32 v162, v174, v174
    v_fmac_f32 v162, v175, v175
    v_mfma_f32_16x16x32_bf16 v[190:193], a[12:15], v[134:137], v[190:193]
    v_fmac_f32 v162, v176, v176
    v_fmac_f32 v162, v177, v177
    v_mfma_f32_16x16x32_bf16 v[190:193], a[16:19], v[154:157], v[190:193]
    v_mul_f32 v139, v255, v139
    v_cvt_pk_bf16_f32 v148, v138, v139
    v_mfma_f32_16x16x32_bf16 v[190:193], a[20:23], v[198:201], v[190:193]
    v_mul_f32 v140, v255, v140
    v_mul_f32 v141, v255, v141
    v_mfma_f32_16x16x32_bf16 v[218:221], a[24:27], v[150:153], 0
    v_cvt_pk_bf16_f32 v149, v140, v141
    v_mul_f32 v186, v255, v186
    v_mfma_f32_16x16x32_bf16 v[218:221], a[28:31], v[166:169], v[218:221]
    buffer_store_dwordx4 v[146:149], v17, s[12:15], 0 offen
    v_mul_f32 v187, v255, v187
    v_fma_f32 v163, v190, v190, s32
    v_fmac_f32 v163, v191, v191
    v_fmac_f32 v163, v192, v192
    v_mfma_f32_16x16x32_bf16 v[218:221], a[32:35], v[118:121], v[218:221]
    v_fmac_f32 v163, v193, v193
    v_cvt_pk_bf16_f32 v164, v186, v187
    v_mfma_f32_16x16x32_bf16 v[218:221], a[36:39], v[134:137], v[218:221]
    v_mul_f32 v188, v255, v188
    v_mul_f32 v189, v255, v189
    v_mfma_f32_16x16x32_bf16 v[218:221], a[40:43], v[154:157], v[218:221]
    v_cvt_pk_bf16_f32 v165, v188, v189
    v_mul_f32 v142, v254, v142
    v_mfma_f32_16x16x32_bf16 v[218:221], a[44:47], v[198:201], v[218:221]
    v_mul_f32 v143, v254, v143
    v_cvt_pk_bf16_f32 v142, v142, v143
    v_mfma_f32_16x16x32_bf16 v[138:141], a[48:51], v[150:153], 0
    v_mul_f32 v144, v254, v144
    v_mul_f32 v145, v254, v145
    v_mfma_f32_16x16x32_bf16 v[138:141], a[52:55], v[166:169], v[138:141]
    v_cvt_pk_bf16_f32 v143, v144, v145
    v_mul_f32 v158, v254, v158
    v_mfma_f32_16x16x32_bf16 v[138:141], a[56:59], v[118:121], v[138:141]
    v_fmac_f32 v163, v218, v218
    v_fmac_f32 v163, v219, v219
    v_mfma_f32_16x16x32_bf16 v[138:141], a[60:63], v[134:137], v[138:141]
    ds_read2_b32 v[196:197], v6 offset0:0 offset1:0
    ds_read2_b32 v[216:217], v6 offset0:16 offset1:16
    v_mfma_f32_16x16x32_bf16 v[138:141], a[64:67], v[154:157], v[138:141]
    ds_read2_b32 v[232:233], v6 offset0:32 offset1:32
    v_fmac_f32 v163, v220, v220
    v_mfma_f32_16x16x32_bf16 v[138:141], a[68:71], v[198:201], v[138:141]
    v_fmac_f32 v163, v221, v221
    v_mul_f32 v159, v254, v159
    v_mfma_f32_16x16x32_bf16 v[146:149], v[150:153], a[144:147], 0
    v_cvt_pk_bf16_f32 v144, v158, v159
    v_mul_f32 v160, v254, v160
    v_mfma_f32_16x16x32_bf16 v[146:149], v[166:169], a[148:151], v[146:149]
    v_mul_f32 v161, v254, v161
    v_cvt_pk_bf16_f32 v145, v160, v161
    v_mfma_f32_16x16x32_bf16 v[146:149], v[118:121], a[152:155], v[146:149]
    v_fmac_f32 v163, v138, v138
    v_fmac_f32 v163, v139, v139
    v_mfma_f32_16x16x32_bf16 v[146:149], v[134:137], a[156:159], v[146:149]
    v_fmac_f32 v163, v140, v140
    v_fmac_f32 v163, v141, v141
    v_mfma_f32_16x16x32_bf16 v[146:149], v[154:157], a[160:163], v[146:149]
    v_cvt_pk_bf16_f32 v36, v163, v162
    v_mul_f32 v178, v254, v178
    v_mfma_f32_16x16x32_bf16 v[146:149], v[198:201], a[164:167], v[146:149]
    s_waitcnt lgkmcnt(1)
    v_mul_f32 v179, v254, v179
    v_cvt_pk_bf16_f32 v178, v178, v179
    v_mfma_f32_16x16x32_bf16 v[158:161], v[32:35], v[36:39], 0
    s_waitcnt lgkmcnt(0)
    buffer_store_dwordx2 v[164:165], v20, s[12:15], 0 offen
    v_mul_f32 v180, v254, v180
    v_mul_f32 v181, v254, v181
    v_mfma_f32_16x16x32_bf16 v[186:189], v[150:153], a[168:171], 0
    v_cvt_pk_bf16_f32 v194, v146, v147
    v_cvt_pk_bf16_f32 v195, v148, v149
    v_mfma_f32_16x16x32_bf16 v[186:189], v[166:169], a[172:175], v[186:189]
    v_rsq_f32 v159, v159
    v_mfma_f32_16x16x32_bf16 v[186:189], v[118:121], a[176:179], v[186:189]
    v_rsq_f32 v158, v158
    v_mfma_f32_16x16x32_bf16 v[186:189], v[134:137], a[180:183], v[186:189]
    v_mul_f32 v158, s31, v158
    v_mul_f32 v202, v159, v202
    v_mfma_f32_16x16x32_bf16 v[186:189], v[154:157], a[184:187], v[186:189]
    v_mul_f32 v203, v159, v203
    v_cvt_pk_f16_f32 v146, v202, v203
    v_mfma_f32_16x16x32_bf16 v[186:189], v[198:201], a[188:191], v[186:189]
    v_mul_f32 v204, v159, v204
    v_mul_f32 v205, v159, v205
    v_mfma_f32_16x16x32_bf16 v[162:165], v[150:153], a[192:195], 0
    v_cvt_pk_f16_f32 v147, v204, v205
    v_mul_f32 v126, v159, v126
    v_mfma_f32_16x16x32_bf16 v[162:165], v[166:169], a[196:199], v[162:165]
    ds_read_b128 v[150:153], v5 offset:0
    ds_read_b128 v[202:205], v5 offset:16
    v_mfma_f32_16x16x32_bf16 v[162:165], v[118:121], a[200:203], v[162:165]
    ds_read_b128 v[118:121], v5 offset:48
    ds_read_b32 v254, v6 offset:192
    v_mfma_f32_16x16x32_bf16 v[162:165], v[134:137], a[204:207], v[162:165]
    v_cvt_pk_bf16_f32 v214, v186, v187
    v_cvt_pk_bf16_f32 v215, v188, v189
    v_mfma_f32_16x16x32_bf16 v[162:165], v[154:157], a[208:211], v[162:165]
    v_mul_f32 v127, v159, v127
    v_cvt_pk_f16_f32 v148, v126, v127
    v_mfma_f32_16x16x32_bf16 v[162:165], v[198:201], a[212:215], v[162:165]
    ds_read_b128 v[198:201], v2 offset:0
    ds_read_b128 v[186:189], v2 offset:1024
    v_mfma_f32_16x16x32_f16 v[134:137], v[226:229], v[222:225], v[50:53]
    ds_read_b128 v[154:157], v2 offset:2048
    v_mul_f32 v128, v159, v128
    v_mul_f32 v129, v159, v129
    v_mfma_f32_16x16x16_f16 v[210:213], v[184:185], v[182:183], v[210:213]
    v_cvt_pk_f16_f32 v149, v128, v129
    v_cvt_pk_bf16_f32 v230, v162, v163
    v_cvt_pk_bf16_f32 v231, v164, v165
    v_mul_f32 v174, v159, v174
    v_mfma_f32_16x16x32_f16 v[126:129], v[146:149], v[222:225], v[54:57]
    s_waitcnt lgkmcnt(5)
    v_mul_f32 v175, v159, v175
    v_cvt_pk_f16_f32 v164, v174, v175
    v_mul_f32 v176, v159, v176
    v_mfma_f32_16x16x16_f16 v[134:137], v[124:125], v[182:183], v[134:137]
    v_mul_f32 v177, v159, v177
    v_cvt_pk_f16_f32 v165, v176, v177
    v_mul_f32 v190, v158, v190
    v_mul_f32 v191, v158, v191
    v_mfma_f32_16x16x16_f16 v[126:129], v[164:165], v[182:183], v[126:129]
    v_cvt_pk_f16_f32 v174, v190, v191
    v_mul_f32 v192, v158, v192
    v_mul_f32 v193, v158, v193
    v_cvt_pk_f16_f32 v175, v192, v193
    v_mfma_f32_16x16x32_f16 v[166:169], v[150:153], v[222:225], v[22:25]
    s_waitcnt lgkmcnt(2)
    ds_read_b128 v[222:225], v2 offset:3072
    buffer_store_dwordx4 v[142:145], v16, s[12:15], 0 offen
    ds_read_b128 v[234:237], v2 offset:4096
    v_mul_f32 v218, v158, v218
    v_mul_f32 v219, v158, v219
    v_cvt_pk_f16_f32 v176, v218, v219
    v_mfma_f32_16x16x32_f16 v[166:169], v[202:205], v[242:245], v[166:169]
    s_waitcnt lgkmcnt(2)
    v_mul_f32 v220, v158, v220
    v_mul_f32 v221, v158, v221
    v_mfma_f32_16x16x32_f16 v[166:169], v[118:121], v[182:185], v[166:169]
    ds_read_b128 v[142:145], v2 offset:5120
    v_cvt_pk_f16_f32 v177, v220, v221
    v_mul_f32 v138, v158, v138
    v_mul_f32 v139, v158, v139
    v_cvt_pk_f16_f32 v162, v138, v139
    v_mfma_f32_16x16x32_f16 v[218:221], v[150:153], v[206:209], v[24:27]
    v_mul_f32 v140, v158, v140
    v_mul_f32 v141, v158, v141
    v_mfma_f32_16x16x32_f16 v[218:221], v[202:205], v[226:229], v[218:221]
    v_mov_b32_dpp v254, v167 quad_perm:[0,1,2,3] row_mask:0x1 bank_mask:0xf
    v_cvt_pk_f16_f32 v163, v140, v141
    v_mfma_f32_16x16x32_f16 v[218:221], v[118:121], v[122:125], v[218:221]
    v_max3_f32 v255, v166, v210, v211
    v_max3_f32 v255, v255, v212, v213
    v_mfma_f32_16x16x32_f16 v[238:241], v[150:153], v[174:177], v[26:29]
    s_waitcnt lgkmcnt(1)
    v_max3_f32 v255, v255, v134, v135
    v_max3_f32 v255, v255, v136, v137
    v_mfma_f32_16x16x32_f16 v[238:241], v[202:205], v[146:149], v[238:241]
    v_max3_f32 v255, v255, v126, v127
    v_mov_b32_dpp v254, v219 quad_perm:[0,1,2,3] row_mask:0x2 bank_mask:0xf
    v_mfma_f32_16x16x32_f16 v[238:241], v[118:121], v[162:165], v[238:241]
    v_max3_f32 v255, v255, v128, v129
    v_mov_b32 v182, v255
    v_mfma_f32_16x16x32_bf16 v[150:153], a[216:219], v[198:201], 0
    s_waitcnt lgkmcnt(0)
    v_permlane32_swap_b32 v255, v182
    v_mfma_f32_16x16x32_bf16 v[150:153], a[220:223], v[186:189], v[150:153]
    v_max_f32 v255, v255, v182
    v_mov_b32 v182, v255
    v_mfma_f32_16x16x32_bf16 v[150:153], a[224:227], v[154:157], v[150:153]
    v_cvt_pk_bf16_f32 v179, v180, v181
    v_xor_b32 v0, 65536, v0
    v_mfma_f32_16x16x32_bf16 v[150:153], a[228:231], v[222:225], v[150:153]
    s_waitcnt vmcnt(5)
    v_permlane16_swap_b32 v255, v182
    v_mfma_f32_16x16x32_bf16 v[150:153], a[232:235], v[234:237], v[150:153]
    s_barrier
    v_max_f32 v255, v255, v182
    v_sub_f32 v210, v210, v255
    v_mfma_f32_16x16x32_bf16 v[150:153], a[236:239], v[142:145], v[150:153]
    s_nop 0
    v_exp_f32 v210, v210
    v_mfma_f32_16x16x32_bf16 v[190:193], a[240:243], v[198:201], 0
    s_nop 0
    v_sub_f32 v211, v211, v255
    v_sub_f32 v212, v212, v255
    v_mfma_f32_16x16x32_bf16 v[190:193], a[244:247], v[186:189], v[190:193]
    s_nop 0
    buffer_load_dwordx4 v10, s[8:11], 0 offen lds
    v_sub_f32 v213, v213, v255
    v_mfma_f32_16x16x32_bf16 v[190:193], a[248:251], v[154:157], v[190:193]
    s_add_u32 m0, s28, 4096
    v_exp_f32 v211, v211
    v_mfma_f32_16x16x32_bf16 v[190:193], a[252:255], v[222:225], v[190:193]
    v_cvt_pk_bf16_f32 v158, v210, v211
    v_sub_f32 v134, v134, v255
    v_mfma_f32_16x16x32_bf16 v[190:193], v[82:85], v[234:237], v[190:193]
    v_exp_f32 v212, v212
    v_mfma_f32_16x16x32_bf16 v[190:193], v[86:89], v[142:145], v[190:193]
    v_exp_f32 v213, v213
    v_mfma_f32_16x16x32_bf16 v[202:205], v[90:93], v[198:201], 0
    ds_read_b128 v[198:201], v2 offset:6144
    buffer_load_dwordx4 v11, s[8:11], 0 offen lds
    v_mfma_f32_16x16x32_bf16 v[202:205], v[94:97], v[186:189], v[202:205]
    s_add_u32 m0, s28, 8192
    ds_read_b128 v[138:141], v2 offset:7168
    v_cvt_pk_bf16_f32 v159, v212, v213
    v_mfma_f32_16x16x32_bf16 v[202:205], v[98:101], v[154:157], v[202:205]
    ds_read_b128 v[210:213], v2 offset:8192
    v_sub_f32 v135, v135, v255
    v_mfma_f32_16x16x32_bf16 v[202:205], v[102:105], v[222:225], v[202:205]
    ds_read_b128 v[186:189], v2 offset:9216
    v_sub_f32 v136, v136, v255
    v_mfma_f32_16x16x32_bf16 v[202:205], v[106:109], v[234:237], v[202:205]
    ds_read_b128 v[222:225], v2 offset:10240
    v_sub_f32 v137, v137, v255
    v_mfma_f32_16x16x32_bf16 v[202:205], v[110:113], v[142:145], v[202:205]
    ds_read_b128 v[154:157], v2 offset:11264
    buffer_load_dwordx4 v12, s[8:11], 0 offen lds
    v_exp_f32 v134, v134
    v_mfma_f32_16x16x32_f16 v[118:121], v[242:245], v[206:209], v[58:61]
    s_add_u32 m0, s28, 12288
    v_exp_f32 v135, v135
    v_exp_f32 v136, v136
    v_cvt_pk_bf16_f32 v160, v134, v135
    v_exp_f32 v137, v137
    v_sub_f32 v126, v126, v255
    v_mfma_f32_16x16x16_f16 v[118:121], v[184:185], v[122:123], v[118:121]
    v_cvt_pk_bf16_f32 v161, v136, v137
    v_exp_f32 v126, v126
    v_sub_f32 v127, v127, v255
    v_mfma_f32_16x16x32_f16 v[134:137], v[226:229], v[206:209], v[62:65]
    s_xor_b32 s28, s28, 65536
    buffer_load_dwordx4 v13, s[8:11], 0 offen lds
    v_exp_f32 v127, v127
    v_sub_f32 v128, v128, v255
    v_cvt_pk_bf16_f32 v36, v126, v127
    v_exp_f32 v128, v128
    v_mfma_f32_16x16x16_f16 v[134:137], v[124:125], v[122:123], v[134:137]
    v_sub_f32 v129, v129, v255
    v_exp_f32 v129, v129
    v_sub_f32 v166, v166, v255
    v_cvt_pk_bf16_f32 v37, v128, v129
    v_mfma_f32_16x16x32_f16 v[126:129], v[146:149], v[206:209], v[66:69]
    s_waitcnt lgkmcnt(0)
    v_exp_f32 v166, v166
    v_mfma_f32_16x16x32_bf16 v[142:145], a[216:219], v[198:201], 0
    s_mov_b32 m0, s29
    v_cvt_pk_bf16_f32 v39, v166, 0
    v_max3_f32 v255, v218, v118, v119
    v_max3_f32 v255, v255, v120, v121
    v_mfma_f32_16x16x16_f16 v[126:129], v[164:165], v[122:123], v[126:129]
    v_max3_f32 v255, v255, v134, v135
    v_max3_f32 v255, v255, v136, v137
    v_xor_b32 v1, 65536, v1
    v_mov_b32_dpp v254, v239 quad_perm:[0,1,2,3] row_mask:0x4 bank_mask:0xf
    v_mfma_f32_16x16x32_bf16 v[206:209], v[28:31], v[36:39], 0
    s_xor_b32 s29, s29, s30
    buffer_store_dwordx2 v[178:179], v19, s[12:15], 0 offen
    v_mov_b32 v122, v254
    v_max3_f32 v255, v255, v126, v127
    v_mfma_f32_16x16x32_bf16 v[206:209], v[28:31], v[158:161], v[206:209]
    s_add_u32 s19, s19, s20
    v_max3_f32 v255, v255, v128, v129
    v_mov_b32 v123, v255
    v_mfma_f32_16x16x32_bf16 v[142:145], a[220:223], v[138:141], v[142:145]
    s_add_u32 s23, s23, s21
    v_permlane32_swap_b32 v255, v123
    v_mfma_f32_16x16x32_bf16 v[142:145], a[224:227], v[210:213], v[142:145]
    s_cmp_ge_u32 s19, 72
    v_rcp_f32 v206, v206
    v_mfma_f32_16x16x32_bf16 v[142:145], a[228:231], v[186:189], v[142:145]
    s_cselect_b32 s34, 72, 0
    v_max_f32 v255, v255, v123
    v_mov_b32 v123, v255
    v_mfma_f32_16x16x32_bf16 v[142:145], a[232:235], v[222:225], v[142:145]
    s_cselect_b32 s35, s22, 0
    v_permlane16_swap_b32 v255, v123
    v_mfma_f32_16x16x32_bf16 v[142:145], a[236:239], v[154:157], v[142:145]
    s_sub_u32 s19, s19, s34
    v_max_f32 v255, v255, v123
    v_sub_f32 v118, v118, v255
    v_mfma_f32_16x16x32_bf16 v[178:181], v[194:197], v[36:39], 0
    s_add_u32 s23, s23, s35
    v_exp_f32 v118, v118
    v_mfma_f32_16x16x32_bf16 v[178:181], v[170:173], v[158:161], v[178:181]
    s_add_u32 s18, s18, 1
    v_sub_f32 v119, v119, v255
    v_exp_f32 v119, v119
    v_sub_f32 v120, v120, v255
    v_cvt_pk_bf16_f32 v118, v118, v119
    v_exp_f32 v120, v120
    v_sub_f32 v121, v121, v255
    v_exp_f32 v121, v121
    v_mul_f32 v178, v206, v178
    v_mul_f32 v179, v206, v179
    v_cvt_pk_bf16_f32 v178, v178, v179
    v_mul_f32 v180, v206, v180
    v_mul_f32 v181, v206, v181
    v_cvt_pk_bf16_f32 v179, v180, v181
    v_cvt_pk_bf16_f32 v119, v120, v121
    v_mfma_f32_16x16x32_bf16 v[166:169], v[214:217], v[36:39], 0
    s_cmp_lt_u32 s18, s17
    v_sub_f32 v134, v134, v255
    v_sub_f32 v135, v135, v255
    v_mfma_f32_16x16x32_bf16 v[166:169], v[130:133], v[158:161], v[166:169]
    v_exp_f32 v134, v134
    v_exp_f32 v135, v135
    v_sub_f32 v136, v136, v255
    v_cvt_pk_bf16_f32 v120, v134, v135
    v_exp_f32 v136, v136
    v_sub_f32 v137, v137, v255
    v_exp_f32 v137, v137
    v_sub_f32 v126, v126, v255
    v_mul_f32 v166, v206, v166
    v_mul_f32 v167, v206, v167
    v_cvt_pk_bf16_f32 v180, v166, v167
    v_mul_f32 v168, v206, v168
    v_mul_f32 v169, v206, v169
    v_cvt_pk_bf16_f32 v181, v168, v169
    v_cvt_pk_bf16_f32 v121, v136, v137
    v_mfma_f32_16x16x32_bf16 v[134:137], v[230:233], v[36:39], 0
    buffer_load_dwordx4 v14, s[8:11], 0 offen lds
    v_sub_f32 v127, v127, v255
    v_mfma_f32_16x16x32_bf16 v[134:137], v[114:117], v[158:161], v[134:137]
    ds_write_b128 v3, v[178:181] offset:0
    v_mfma_f32_16x16x32_bf16 v[158:161], a[240:243], v[198:201], 0
    v_exp_f32 v126, v126
    v_mfma_f32_16x16x32_bf16 v[158:161], a[244:247], v[138:141], v[158:161]
    v_exp_f32 v127, v127
    v_mfma_f32_16x16x32_bf16 v[158:161], a[248:251], v[210:213], v[158:161]
    v_cvt_pk_bf16_f32 v36, v126, v127
    v_sub_f32 v128, v128, v255
    v_mfma_f32_16x16x32_bf16 v[158:161], a[252:255], v[186:189], v[158:161]
    v_mul_f32 v134, v206, v134
    v_mul_f32 v135, v206, v135
    v_mfma_f32_16x16x32_bf16 v[158:161], v[82:85], v[222:225], v[158:161]
    v_cvt_pk_bf16_f32 v126, v134, v135
    v_mul_f32 v136, v206, v136
    v_mfma_f32_16x16x32_bf16 v[158:161], v[86:89], v[154:157], v[158:161]
    v_mul_f32 v137, v206, v137
    v_cvt_pk_bf16_f32 v127, v136, v137
    v_mfma_f32_16x16x32_bf16 v[178:181], v[90:93], v[198:201], 0
    ds_read_b128 v[198:201], v2 offset:12288
    v_sub_f32 v129, v129, v255
    v_mfma_f32_16x16x32_bf16 v[178:181], v[94:97], v[138:141], v[178:181]
    ds_read_b128 v[206:209], v2 offset:13312
    v_sub_f32 v218, v218, v255
    v_mfma_f32_16x16x32_bf16 v[178:181], v[98:101], v[210:213], v[178:181]
    ds_read_b128 v[210:213], v2 offset:14336
    v_max_f32_dpp v122, v122, v122 quad_perm:[1,0,3,2] row_mask:0xf bank_mask:0xf
    v_mfma_f32_16x16x32_bf16 v[178:181], v[102:105], v[186:189], v[178:181]
    ds_read_b128 v[134:137], v2 offset:15360
    v_max_f32_dpp v122, v122, v122 quad_perm:[2,3,0,1] row_mask:0xf bank_mask:0xf
    v_mfma_f32_16x16x32_bf16 v[178:181], v[106:109], v[222:225], v[178:181]
    ds_read_b128 v[222:225], v2 offset:16384
    v_max_f32_dpp v122, v122, v122 row_half_mirror row_mask:0xf bank_mask:0xf
    v_mfma_f32_16x16x32_bf16 v[178:181], v[110:113], v[154:157], v[178:181]
    ds_read_b128 v[154:157], v2 offset:17408
    ds_write_b64 v4, v[126:127] offset:4096
    v_exp_f32 v128, v128
    v_exp_f32 v129, v129
    v_mfma_f32_16x16x32_f16 v[186:189], v[242:245], v[174:177], v[70:73]
    s_waitcnt lgkmcnt(6)
    v_cvt_pk_bf16_f32 v37, v128, v129
    v_max_f32_dpp v122, v122, v122 row_mirror row_mask:0xf bank_mask:0xf
    v_mfma_f32_16x16x32_f16 v[242:245], v[226:229], v[174:177], v[74:77]
    s_waitcnt lgkmcnt(5)
    v_exp_f32 v218, v218
    v_mfma_f32_16x16x32_f16 v[126:129], v[146:149], v[174:177], v[78:81]
    s_waitcnt lgkmcnt(4)
    v_cvt_pk_bf16_f32 v39, v218, 0
    v_mov_b32 v123, v122
    v_fma_f32 v255, v150, v150, s33
    v_mfma_f32_16x16x32_bf16 v[174:177], v[28:31], v[36:39], 0
    s_waitcnt lgkmcnt(3)
    v_permlane32_swap_b32 v122, v123
    v_mfma_f32_16x16x32_bf16 v[174:177], v[28:31], v[118:121], v[174:177]
    s_waitcnt lgkmcnt(2)
    v_max_f32 v122, v122, v123
    v_mov_b32 v123, v122
    v_mfma_f32_16x16x32_bf16 v[226:229], v[194:197], v[36:39], 0
    s_waitcnt lgkmcnt(0)
    v_permlane16_swap_b32 v122, v123
    v_mfma_f32_16x16x32_bf16 v[226:229], v[170:173], v[118:121], v[226:229]
    v_max_f32 v122, v122, v123
    v_sub_f32 v254, v254, v122
    v_mfma_f32_16x16x32_bf16 v[218:221], v[214:217], v[36:39], 0
    v_exp_f32 v254, v254
    v_mfma_f32_16x16x32_bf16 v[218:221], v[130:133], v[118:121], v[218:221]
    v_cvt_pk_bf16_f32 v254, v254, v254
    v_fmac_f32 v255, v151, v151
    v_mfma_f32_16x16x32_bf16 v[166:169], v[230:233], v[36:39], 0
    ds_write_b16 v8, v254
    v_mfma_f32_16x16x32_bf16 v[166:169], v[114:117], v[118:121], v[166:169]
    v_rcp_f32 v174, v174
    v_fmac_f32 v255, v152, v152
    v_mfma_f32_16x16x16_f16 v[186:189], v[184:185], v[162:163], v[186:189]
    v_mul_f32 v226, v174, v226
    v_mul_f32 v227, v174, v227
    v_cvt_pk_bf16_f32 v122, v226, v227
    v_mfma_f32_16x16x16_f16 v[242:245], v[124:125], v[162:163], v[242:245]
    v_mul_f32 v228, v174, v228
    v_mul_f32 v229, v174, v229
    v_cvt_pk_bf16_f32 v123, v228, v229
    v_mfma_f32_16x16x16_f16 v[126:129], v[164:165], v[162:163], v[126:129]
    v_max3_f32 v254, v238, v186, v187
    v_max3_f32 v254, v254, v188, v189
    v_mul_f32 v218, v174, v218
    v_mul_f32 v219, v174, v219
    v_mfma_f32_16x16x32_bf16 v[146:149], a[216:219], v[198:201], 0
    ds_read_b128 v[118:121], v9
    ds_read_b128 v[162:165], v9 offset:64
    v_mfma_f32_16x16x32_bf16 v[146:149], a[220:223], v[206:209], v[146:149]
    v_max3_f32 v254, v254, v242, v243
    v_max3_f32 v254, v254, v244, v245
    v_mfma_f32_16x16x32_bf16 v[146:149], a[224:227], v[210:213], v[146:149]
    v_max3_f32 v254, v254, v126, v127
    v_max3_f32 v254, v254, v128, v129
    v_mfma_f32_16x16x32_bf16 v[146:149], a[228:231], v[134:137], v[146:149]
    v_mov_b32 v125, v254
    v_cvt_pk_bf16_f32 v124, v218, v219
    v_mfma_f32_16x16x32_bf16 v[146:149], a[232:235], v[222:225], v[146:149]
    v_permlane32_swap_b32 v254, v125
    v_mfma_f32_16x16x32_bf16 v[146:149], a[236:239], v[154:157], v[146:149]
    v_max_f32 v254, v254, v125
    v_mov_b32 v125, v254
    v_mfma_f32_16x16x32_bf16 v[138:141], a[240:243], v[198:201], 0
    v_mul_f32 v220, v174, v220
    v_mul_f32 v221, v174, v221
    v_mfma_f32_16x16x32_bf16 v[138:141], a[244:247], v[206:209], v[138:141]
    v_permlane16_swap_b32 v254, v125
    v_mfma_f32_16x16x32_bf16 v[138:141], a[248:251], v[210:213], v[138:141]
    s_waitcnt lgkmcnt(0)
    v_max_f32 v254, v254, v125
    v_sub_f32 v186, v186, v254
    v_mfma_f32_16x16x32_bf16 v[138:141], a[252:255], v[134:137], v[138:141]
    v_exp_f32 v186, v186
    v_mfma_f32_16x16x32_bf16 v[138:141], v[82:85], v[222:225], v[138:141]
    v_sub_f32 v187, v187, v254
    v_sub_f32 v188, v188, v254
    v_mfma_f32_16x16x32_bf16 v[138:141], v[86:89], v[154:157], v[138:141]
    v_exp_f32 v187, v187
    v_exp_f32 v188, v188
    v_cvt_pk_bf16_f32 v234, v186, v187
    v_sub_f32 v189, v189, v254
    v_exp_f32 v189, v189
    v_sub_f32 v242, v242, v254
    v_cvt_pk_bf16_f32 v235, v188, v189
    v_exp_f32 v242, v242
    v_sub_f32 v243, v243, v254
    v_exp_f32 v243, v243
    v_sub_f32 v244, v244, v254
    v_cvt_pk_bf16_f32 v236, v242, v243
    v_mfma_f32_16x16x32_bf16 v[186:189], v[90:93], v[198:201], 0
    v_exp_f32 v244, v244
    v_mfma_f32_16x16x32_bf16 v[186:189], v[94:97], v[206:209], v[186:189]
    v_sub_f32 v245, v245, v254
    v_sub_f32 v126, v126, v254
    v_mfma_f32_16x16x32_bf16 v[186:189], v[98:101], v[210:213], v[186:189]
    v_exp_f32 v245, v245
    v_mfma_f32_16x16x32_bf16 v[186:189], v[102:105], v[134:137], v[186:189]
    v_cvt_pk_bf16_f32 v237, v244, v245
    v_sub_f32 v127, v127, v254
    v_mfma_f32_16x16x32_bf16 v[186:189], v[106:109], v[222:225], v[186:189]
    v_exp_f32 v126, v126
    v_mfma_f32_16x16x32_bf16 v[186:189], v[110:113], v[154:157], v[186:189]
    ds_read_b128 v[182:185], v0 offset:20480
    ds_read_b128 v[198:201], v1 offset:20480
    v_mfma_f32_16x16x32_bf16 v[206:209], v[118:121], v[28:31], 0
    ds_read_b128 v[210:213], v0 offset:20608
    ds_read_b128 v[222:225], v1 offset:20608
    v_mfma_f32_16x16x32_bf16 v[206:209], v[162:165], v[28:31], v[206:209]
    v_exp_f32 v127, v127
    v_mfma_f32_16x16x32_bf16 v[154:157], v[118:121], v[170:173], 0
    ds_read_b128 v[226:229], v0 offset:20736
    v_cvt_pk_bf16_f32 v36, v126, v127
    v_mfma_f32_16x16x32_bf16 v[154:157], v[162:165], v[194:197], v[154:157]
    ds_read_b128 v[242:245], v1 offset:20736
    v_sub_f32 v128, v128, v254
    v_exp_f32 v128, v128
    v_sub_f32 v129, v129, v254
    v_exp_f32 v129, v129
    v_sub_f32 v238, v238, v254
    v_cvt_pk_bf16_f32 v37, v128, v129
    v_mfma_f32_16x16x32_bf16 v[134:137], v[118:121], v[130:133], 0
    v_exp_f32 v238, v238
    v_mfma_f32_16x16x32_bf16 v[134:137], v[162:165], v[214:217], v[134:137]
    s_waitcnt lgkmcnt(4)
    v_cvt_pk_bf16_f32 v39, v238, 0
    v_cvt_pk_bf16_f32 v125, v220, v221
    v_mfma_f32_16x16x32_bf16 v[218:221], v[118:121], v[114:117], 0
    s_waitcnt lgkmcnt(2)
    ds_write_b128 v3, v[122:125] offset:6144
    v_mfma_f32_16x16x32_bf16 v[126:129], v[28:31], v[36:39], 0
    s_waitcnt lgkmcnt(2)
    v_mul_f32 v166, v174, v166
    v_mul_f32 v167, v174, v167
    v_mfma_f32_16x16x32_bf16 v[126:129], v[28:31], v[234:237], v[126:129]
    s_waitcnt lgkmcnt(1)
    v_cvt_pk_bf16_f32 v166, v166, v167
    v_mul_f32 v168, v174, v168
    v_mfma_f32_16x16x32_bf16 v[122:125], v[194:197], v[36:39], 0
    v_mul_f32 v169, v174, v169
    v_cvt_pk_bf16_f32 v167, v168, v169
    v_mfma_f32_16x16x32_bf16 v[122:125], v[170:173], v[234:237], v[122:125]
    ds_write_b64 v4, v[166:167] offset:10240
    v_mfma_f32_16x16x32_bf16 v[170:173], v[214:217], v[36:39], 0
    v_rcp_f32 v126, v126
    v_mfma_f32_16x16x32_bf16 v[170:173], v[130:133], v[234:237], v[170:173]
    v_fma_f32 v254, v146, v146, s33
    v_fmac_f32 v254, v147, v147
    v_mfma_f32_16x16x32_bf16 v[174:177], v[230:233], v[36:39], 0
    v_fmac_f32 v254, v148, v148
    v_mul_f32 v122, v126, v122
    v_mfma_f32_16x16x32_bf16 v[174:177], v[114:117], v[234:237], v[174:177]
    v_mul_f32 v123, v126, v123
    v_cvt_pk_bf16_f32 v122, v122, v123
    v_mfma_f32_16x16x32_bf16 v[218:221], v[162:165], v[230:233], v[218:221]
    v_mul_f32 v124, v126, v124
    v_mul_f32 v125, v126, v125
    v_mfma_f32_16x16x32_bf16 v[114:117], a[72:75], v[182:185], 0
    v_cvt_pk_bf16_f32 v123, v124, v125
    v_mul_f32 v170, v126, v170
    v_mfma_f32_16x16x32_bf16 v[114:117], a[76:79], v[198:201], v[114:117]
    v_mul_f32 v171, v126, v171
    v_cvt_pk_bf16_f32 v124, v170, v171
    v_mfma_f32_16x16x32_bf16 v[114:117], a[80:83], v[210:213], v[114:117]
    v_mul_f32 v172, v126, v172
    v_mul_f32 v173, v126, v173
    v_mfma_f32_16x16x32_bf16 v[114:117], a[84:87], v[222:225], v[114:117]
    v_cvt_pk_bf16_f32 v125, v172, v173
    v_mul_f32 v174, v126, v174
    v_mfma_f32_16x16x32_bf16 v[114:117], a[88:91], v[226:229], v[114:117]
    ds_write_b128 v3, v[122:125] offset:12288
    v_mfma_f32_16x16x32_bf16 v[114:117], a[92:95], v[242:245], v[114:117]
    v_mul_f32 v175, v126, v175
    v_cvt_pk_bf16_f32 v174, v174, v175
    v_mfma_f32_16x16x32_bf16 v[122:125], a[96:99], v[182:185], 0
    v_mul_f32 v176, v126, v176
    v_mul_f32 v177, v126, v177
    v_mfma_f32_16x16x32_bf16 v[122:125], a[100:103], v[198:201], v[122:125]
    v_cvt_pk_bf16_f32 v175, v176, v177
    v_fmac_f32 v254, v149, v149
    v_mfma_f32_16x16x32_bf16 v[122:125], a[104:107], v[210:213], v[122:125]
    ds_write_b64 v4, v[174:175] offset:16384
    v_mfma_f32_16x16x32_bf16 v[122:125], a[108:111], v[222:225], v[122:125]
    v_fmac_f32 v254, v138, v138
    v_fmac_f32 v254, v139, v139
    v_mfma_f32_16x16x32_bf16 v[122:125], a[112:115], v[226:229], v[122:125]
    v_fmac_f32 v254, v140, v140
    v_fmac_f32 v254, v141, v141
    v_mfma_f32_16x16x32_bf16 v[122:125], a[116:119], v[242:245], v[122:125]
    v_fmac_f32 v254, v186, v186
    v_fmac_f32 v254, v187, v187
    v_mfma_f32_16x16x32_bf16 v[126:129], a[120:123], v[182:185], 0
    v_fmac_f32 v254, v188, v188
    v_fmac_f32 v254, v189, v189
    v_mfma_f32_16x16x32_bf16 v[126:129], a[124:127], v[198:201], v[126:129]
    v_cvt_pk_bf16_f32 v155, v254, v254
    v_fmac_f32 v255, v153, v153
    v_mfma_f32_16x16x32_bf16 v[126:129], a[128:131], v[210:213], v[126:129]
    v_rcp_f32 v206, v206
    v_mfma_f32_16x16x32_bf16 v[126:129], a[132:135], v[222:225], v[126:129]
    v_mul_f32 v154, v154, v206
    v_mul_f32_dpp v154, v134, v206 quad_perm:[0,1,2,3] row_mask:0x2 bank_mask:0xf
    v_mfma_f32_16x16x32_bf16 v[126:129], a[136:139], v[226:229], v[126:129]
    v_mul_f32_dpp v154, v218, v206 quad_perm:[0,1,2,3] row_mask:0x4 bank_mask:0xf
    v_cvt_pk_bf16_f32 v154, v154, v154
    v_mfma_f32_16x16x32_bf16 v[126:129], a[140:143], v[242:245], v[126:129]
    ds_write_b16 v7, v154
    v_mfma_f32_16x16x32_bf16 v[206:209], a[0:3], v[182:185], 0
    v_fmac_f32 v255, v190, v190
    v_fmac_f32 v255, v191, v191
    v_mfma_f32_16x16x32_bf16 v[206:209], a[4:7], v[198:201], v[206:209]
    v_fmac_f32 v255, v192, v192
    v_fmac_f32 v255, v193, v193
    v_mfma_f32_16x16x32_bf16 v[206:209], a[8:11], v[210:213], v[206:209]
    v_fmac_f32 v255, v202, v202
    v_fmac_f32 v255, v203, v203
    v_mfma_f32_16x16x32_bf16 v[206:209], a[12:15], v[222:225], v[206:209]
    v_fmac_f32 v255, v204, v204
    v_fmac_f32 v255, v205, v205
    v_mfma_f32_16x16x32_bf16 v[206:209], a[16:19], v[226:229], v[206:209]
    v_fma_f32 v254, v142, v142, s33
    v_fmac_f32 v254, v143, v143
    v_mfma_f32_16x16x32_bf16 v[206:209], a[20:23], v[242:245], v[206:209]
    v_fmac_f32 v254, v144, v144
    v_fmac_f32 v254, v145, v145
    v_mfma_f32_16x16x32_bf16 v[174:177], a[24:27], v[182:185], 0
    v_fmac_f32 v254, v158, v158
    v_fmac_f32 v254, v159, v159
    v_mfma_f32_16x16x32_bf16 v[174:177], a[28:31], v[198:201], v[174:177]
    v_fmac_f32 v254, v160, v160
    v_fmac_f32 v254, v161, v161
    v_mfma_f32_16x16x32_bf16 v[174:177], a[32:35], v[210:213], v[174:177]
    v_fmac_f32 v254, v178, v178
    v_fmac_f32 v254, v179, v179
    v_mfma_f32_16x16x32_bf16 v[174:177], a[36:39], v[222:225], v[174:177]
    v_fmac_f32 v254, v180, v180
    v_fmac_f32 v254, v181, v181
    v_mfma_f32_16x16x32_bf16 v[174:177], a[40:43], v[226:229], v[174:177]
    v_cvt_pk_bf16_f32 v154, v255, v254
    v_add_u32 v5, 336, v5
    v_mfma_f32_16x16x32_bf16 v[174:177], a[44:47], v[242:245], v[174:177]
    ds_write_b64 v4, v[154:155] offset:18432
    v_mfma_f32_16x16x32_bf16 v[218:221], a[48:51], v[182:185], 0
    v_add_u32 v6, 272, v6
    v_add_u32 v7, 16, v7
    v_mfma_f32_16x16x32_bf16 v[218:221], a[52:55], v[198:201], v[218:221]
    v_fma_f32 v130, v114, v114, s32
    v_fmac_f32 v130, v115, v115
    v_mfma_f32_16x16x32_bf16 v[218:221], a[56:59], v[210:213], v[218:221]
    v_fmac_f32 v130, v116, v116
    v_fmac_f32 v130, v117, v117
    v_mfma_f32_16x16x32_bf16 v[218:221], a[60:63], v[222:225], v[218:221]
    v_fmac_f32 v130, v122, v122
    v_fmac_f32 v130, v123, v123
    v_mfma_f32_16x16x32_bf16 v[218:221], a[64:67], v[226:229], v[218:221]
    v_fmac_f32 v130, v124, v124
    v_fmac_f32 v130, v125, v125
    v_mfma_f32_16x16x32_bf16 v[218:221], a[68:71], v[242:245], v[218:221]
    v_fmac_f32 v130, v126, v126
    v_fmac_f32 v130, v127, v127
    v_mfma_f32_16x16x32_bf16 v[170:173], v[182:185], a[144:147], 0
    s_waitcnt lgkmcnt(0)
    v_fmac_f32 v130, v128, v128
    v_fmac_f32 v130, v129, v129
    v_mfma_f32_16x16x32_bf16 v[170:173], v[198:201], a[148:151], v[170:173]
    s_barrier
    v_fma_f32 v131, v206, v206, s32
    v_fmac_f32 v131, v207, v207
    v_mfma_f32_16x16x32_bf16 v[170:173], v[210:213], a[152:155], v[170:173]
    s_nop 0
    v_fmac_f32 v131, v208, v208
    v_fmac_f32 v131, v209, v209
    v_mfma_f32_16x16x32_bf16 v[170:173], v[222:225], a[156:159], v[170:173]
    s_nop 0
    v_fmac_f32 v131, v174, v174
    v_xor_b32 v2, 65536, v2
    v_mfma_f32_16x16x32_bf16 v[170:173], v[226:229], a[160:163], v[170:173]
    s_nop 0
    v_xor_b32 v3, 65536, v3
    v_xor_b32 v4, 65536, v4
    v_mfma_f32_16x16x32_bf16 v[170:173], v[242:245], a[164:167], v[170:173]
    s_cbranch_scc1 L_loop_safe0
    s_branch L_drain
.p2align 6
L_loop_safe1:
    v_mfma_f32_16x16x32_bf16 v[162:165], v[182:185], a[168:171], 0
    s_add_u32 s12, s42, s27
    ds_read_b128 v[194:197], v2 offset:18432
    ds_read_b128 v[230:233], v2 offset:19456
    v_mfma_f32_16x16x32_bf16 v[162:165], v[198:201], a[172:175], v[162:165]
    s_addc_u32 s13, s43, 0
    v_fmac_f32 v131, v175, v175
    v_fmac_f32 v131, v176, v176
    v_mfma_f32_16x16x32_bf16 v[162:165], v[210:213], a[176:179], v[162:165]
    s_sub_u32 s14, s36, s27
    v_fmac_f32 v131, v177, v177
    v_fmac_f32 v131, v218, v218
    v_mfma_f32_16x16x32_bf16 v[162:165], v[222:225], a[180:183], v[162:165]
    s_cmp_ge_u32 s18, 2
    v_fmac_f32 v131, v219, v219
    v_fmac_f32 v131, v220, v220
    v_mfma_f32_16x16x32_bf16 v[162:165], v[226:229], a[184:187], v[162:165]
    s_cselect_b32 s14, s14, 0
    ds_read_b128 v[118:121], v0 offset:26624
    v_fmac_f32 v131, v221, v221
    v_mfma_f32_16x16x32_bf16 v[162:165], v[242:245], a[188:191], v[162:165]
    s_add_u32 s34, s18, 2
    ds_read_b128 v[134:137], v1 offset:26624
    v_cvt_pk_bf16_f32 v36, v131, v130
    v_mfma_f32_16x16x32_bf16 v[214:217], v[182:185], a[192:195], 0
    s_add_u32 s8, s40, s23
    ds_read_b128 v[154:157], v0 offset:26752
    v_cvt_pk_bf16_f32 v170, v170, v171
    v_mfma_f32_16x16x32_bf16 v[214:217], v[198:201], a[196:199], v[214:217]
    s_addc_u32 s9, s41, 0
    ds_read_b128 v[198:201], v1 offset:26752
    v_cvt_pk_bf16_f32 v171, v172, v173
    v_mfma_f32_16x16x32_bf16 v[166:169], v[32:35], v[36:39], 0
    s_sub_u32 s10, s36, s23
    v_cvt_pk_bf16_f32 v130, v162, v163
    v_cvt_pk_bf16_f32 v131, v164, v165
    v_mfma_f32_16x16x32_bf16 v[214:217], v[210:213], a[200:203], v[214:217]
    s_waitcnt lgkmcnt(4)
    ds_read_b128 v[210:213], v0 offset:26880
    s_cmp_lt_u32 s34, s17
    v_mfma_f32_16x16x32_bf16 v[234:237], v[32:35], v[194:197], 0
    s_cselect_b32 s10, s10, 0
    v_rsq_f32 v167, v167
    v_mfma_f32_16x16x32_bf16 v[234:237], v[32:35], v[230:233], v[234:237]
    s_add_u32 m0, s28, 0
    v_rsq_f32 v166, v166
    v_mfma_f32_16x16x32_bf16 v[214:217], v[222:225], a[204:207], v[214:217]
    s_waitcnt lgkmcnt(4)
    ds_read_b128 v[162:165], v1 offset:26880
    v_mul_f32 v166, s31, v166
    v_mfma_f32_16x16x32_bf16 v[214:217], v[226:229], a[208:211], v[214:217]
    s_mov_b32 s27, s26
    v_mul_f32 v114, v167, v114
    v_mul_f32 v115, v167, v115
    v_mfma_f32_16x16x32_bf16 v[214:217], v[242:245], a[212:215], v[214:217]
    s_mov_b32 s26, s25
    v_cvt_pk_f16_f32 v242, v114, v115
    v_mul_f32 v116, v167, v116
    v_mfma_f32_16x16x32_bf16 v[226:229], a[72:75], v[118:121], 0
    s_waitcnt lgkmcnt(2)
    v_mul_f32 v117, v167, v117
    v_cvt_pk_f16_f32 v243, v116, v117
    v_mfma_f32_16x16x32_bf16 v[226:229], a[76:79], v[134:137], v[226:229]
    s_mov_b32 s25, s24
    v_cvt_pk_bf16_f32 v114, v214, v215
    v_cvt_pk_bf16_f32 v115, v216, v217
    v_mfma_f32_16x16x32_bf16 v[226:229], a[80:83], v[154:157], v[226:229]
    s_mov_b32 s24, s23
    v_mul_f32 v122, v167, v122
    v_mul_f32 v123, v167, v123
    v_mfma_f32_16x16x32_bf16 v[226:229], a[84:87], v[198:201], v[226:229]
    s_waitcnt lgkmcnt(1)
    v_cvt_pk_f16_f32 v244, v122, v123
    v_mul_f32 v124, v167, v124
    v_mfma_f32_16x16x32_bf16 v[226:229], a[88:91], v[210:213], v[226:229]
    v_mul_f32 v125, v167, v125
    v_cvt_pk_f16_f32 v245, v124, v125
    v_mfma_f32_16x16x32_bf16 v[122:125], a[96:99], v[118:121], 0
    s_waitcnt lgkmcnt(0)
    v_mul_f32 v126, v167, v126
    v_mul_f32 v127, v167, v127
    v_mfma_f32_16x16x32_bf16 v[226:229], a[92:95], v[162:165], v[226:229]
    v_cvt_pk_f16_f32 v184, v126, v127
    v_mul_f32 v128, v167, v128
    v_mfma_f32_16x16x32_bf16 v[122:125], a[100:103], v[134:137], v[122:125]
    v_mul_f32 v129, v167, v129
    v_cvt_pk_f16_f32 v185, v128, v129
    v_mfma_f32_16x16x32_bf16 v[122:125], a[104:107], v[154:157], v[122:125]
    v_mul_f32 v206, v166, v206
    v_mul_f32 v207, v166, v207
    v_mfma_f32_16x16x32_bf16 v[122:125], a[108:111], v[198:201], v[122:125]
    v_cvt_pk_f16_f32 v222, v206, v207
    v_mul_f32 v208, v166, v208
    v_mfma_f32_16x16x32_bf16 v[122:125], a[112:115], v[210:213], v[122:125]
    v_mul_f32 v209, v166, v209
    v_cvt_pk_f16_f32 v223, v208, v209
    v_mfma_f32_16x16x32_bf16 v[122:125], a[116:119], v[162:165], v[122:125]
    v_mul_f32 v174, v166, v174
    v_mul_f32 v175, v166, v175
    v_mfma_f32_16x16x32_bf16 v[126:129], a[120:123], v[118:121], 0
    v_cvt_pk_f16_f32 v224, v174, v175
    v_mul_f32 v176, v166, v176
    v_mfma_f32_16x16x32_bf16 v[126:129], a[124:127], v[134:137], v[126:129]
    v_mul_f32 v177, v166, v177
    v_cvt_pk_f16_f32 v225, v176, v177
    v_mfma_f32_16x16x32_bf16 v[126:129], a[128:131], v[154:157], v[126:129]
    v_mul_f32 v218, v166, v218
    v_mul_f32 v219, v166, v219
    v_mfma_f32_16x16x32_bf16 v[126:129], a[132:135], v[198:201], v[126:129]
    v_cvt_pk_f16_f32 v182, v218, v219
    v_mul_f32 v220, v166, v220
    v_mfma_f32_16x16x32_bf16 v[126:129], a[136:139], v[210:213], v[126:129]
    v_mul_f32 v221, v166, v221
    v_cvt_pk_f16_f32 v183, v220, v221
    v_mfma_f32_16x16x32_bf16 v[126:129], a[140:143], v[162:165], v[126:129]
    v_fma_f32 v116, v226, v226, s32
    v_fmac_f32 v116, v227, v227
    v_mfma_f32_16x16x32_bf16 v[206:209], a[0:3], v[118:121], 0
    v_fmac_f32 v116, v228, v228
    v_fmac_f32 v116, v229, v229
    v_mfma_f32_16x16x32_bf16 v[206:209], a[4:7], v[134:137], v[206:209]
    v_fmac_f32 v116, v122, v122
    v_fmac_f32 v116, v123, v123
    v_mfma_f32_16x16x32_bf16 v[206:209], a[8:11], v[154:157], v[206:209]
    v_fmac_f32 v116, v124, v124
    v_fmac_f32 v116, v125, v125
    v_mfma_f32_16x16x32_bf16 v[206:209], a[12:15], v[198:201], v[206:209]
    v_fmac_f32 v116, v126, v126
    v_fmac_f32 v116, v127, v127
    v_mfma_f32_16x16x32_bf16 v[206:209], a[16:19], v[210:213], v[206:209]
    v_fmac_f32 v116, v128, v128
    v_fmac_f32 v116, v129, v129
    v_mfma_f32_16x16x32_bf16 v[206:209], a[20:23], v[162:165], v[206:209]
    v_mul_f32 v117, 0x3baaaaab, v234
    v_mul_f32 v254, 0x3baaaaab, v235
    v_mfma_f32_16x16x32_bf16 v[174:177], a[24:27], v[118:121], 0
    v_rsq_f32 v117, v117
    v_mfma_f32_16x16x32_bf16 v[174:177], a[28:31], v[134:137], v[174:177]
    v_rsq_f32 v254, v254
    v_mfma_f32_16x16x32_bf16 v[174:177], a[32:35], v[154:157], v[174:177]
    v_mul_f32 v255, 0x3baaaaab, v236
    v_fma_f32 v132, v206, v206, s32
    v_mfma_f32_16x16x32_bf16 v[174:177], a[36:39], v[198:201], v[174:177]
    v_fmac_f32 v132, v207, v207
    v_fmac_f32 v132, v208, v208
    v_mfma_f32_16x16x32_bf16 v[174:177], a[40:43], v[210:213], v[174:177]
    v_fmac_f32 v132, v209, v209
    v_mul_f32 v150, v117, v150
    v_mfma_f32_16x16x32_bf16 v[174:177], a[44:47], v[162:165], v[174:177]
    v_rsq_f32 v255, v255
    v_mfma_f32_16x16x32_bf16 v[218:221], a[48:51], v[118:121], 0
    v_mul_f32 v151, v117, v151
    v_cvt_pk_bf16_f32 v194, v150, v151
    v_mfma_f32_16x16x32_bf16 v[218:221], a[52:55], v[134:137], v[218:221]
    v_mul_f32 v152, v117, v152
    v_mul_f32 v153, v117, v153
    v_mfma_f32_16x16x32_bf16 v[218:221], a[56:59], v[154:157], v[218:221]
    v_fmac_f32 v132, v174, v174
    v_fmac_f32 v132, v175, v175
    v_mfma_f32_16x16x32_bf16 v[218:221], a[60:63], v[198:201], v[218:221]
    v_fmac_f32 v132, v176, v176
    v_fmac_f32 v132, v177, v177
    v_mfma_f32_16x16x32_bf16 v[218:221], a[64:67], v[210:213], v[218:221]
    v_cvt_pk_bf16_f32 v195, v152, v153
    v_mul_f32 v190, v117, v190
    v_mfma_f32_16x16x32_bf16 v[218:221], a[68:71], v[162:165], v[218:221]
    v_mul_f32 v191, v117, v191
    v_cvt_pk_bf16_f32 v196, v190, v191
    v_mfma_f32_16x16x32_bf16 v[150:153], v[118:121], a[144:147], 0
    v_mul_f32 v192, v117, v192
    v_mul_f32 v193, v117, v193
    v_mfma_f32_16x16x32_bf16 v[150:153], v[134:137], a[148:151], v[150:153]
    v_cvt_pk_bf16_f32 v197, v192, v193
    v_mul_f32 v202, v117, v202
    v_mfma_f32_16x16x32_bf16 v[150:153], v[154:157], a[152:155], v[150:153]
    buffer_store_dwordx4 v[194:197], v15, s[12:15], 0 offen
    v_fmac_f32 v132, v218, v218
    v_fmac_f32 v132, v219, v219
    v_fmac_f32 v132, v220, v220
    v_fmac_f32 v132, v221, v221
    v_mfma_f32_16x16x32_bf16 v[150:153], v[198:201], a[156:159], v[150:153]
    v_cvt_pk_bf16_f32 v36, v132, v116
    v_mul_f32 v203, v117, v203
    v_mfma_f32_16x16x32_bf16 v[150:153], v[210:213], a[160:163], v[150:153]
    v_cvt_pk_bf16_f32 v116, v202, v203
    v_mul_f32 v204, v117, v204
    v_mfma_f32_16x16x32_bf16 v[190:193], v[32:35], v[36:39], 0
    v_mul_f32 v205, v117, v205
    v_cvt_pk_bf16_f32 v117, v204, v205
    v_mfma_f32_16x16x32_bf16 v[150:153], v[162:165], a[164:167], v[150:153]
    v_mul_f32 v146, v255, v146
    v_mul_f32 v147, v255, v147
    v_mfma_f32_16x16x32_bf16 v[202:205], v[118:121], a[168:171], 0
    v_cvt_pk_bf16_f32 v146, v146, v147
    v_mul_f32 v148, v255, v148
    v_mfma_f32_16x16x32_bf16 v[202:205], v[134:137], a[172:175], v[202:205]
    v_rsq_f32 v191, v191
    v_mfma_f32_16x16x32_bf16 v[202:205], v[154:157], a[176:179], v[202:205]
    v_cvt_pk_bf16_f32 v172, v150, v151
    v_cvt_pk_bf16_f32 v173, v152, v153
    v_mfma_f32_16x16x32_bf16 v[202:205], v[198:201], a[180:183], v[202:205]
    v_rsq_f32 v190, v190
    v_mfma_f32_16x16x32_bf16 v[202:205], v[210:213], a[184:187], v[202:205]
    ds_read_b128 v[150:153], v0 offset:32768
    v_mul_f32 v190, s31, v190
    v_mfma_f32_16x16x32_bf16 v[202:205], v[162:165], a[188:191], v[202:205]
    ds_read_b128 v[166:169], v1 offset:32768
    v_mul_f32 v226, v191, v226
    v_mfma_f32_16x16x32_bf16 v[194:197], v[118:121], a[192:195], 0
    ds_read_b128 v[118:121], v0 offset:32896
    v_mul_f32 v227, v191, v227
    v_mfma_f32_16x16x32_bf16 v[194:197], v[134:137], a[196:199], v[194:197]
    ds_read_b128 v[134:137], v1 offset:32896
    v_cvt_pk_f16_f32 v226, v226, v227
    v_mfma_f32_16x16x32_bf16 v[194:197], v[154:157], a[200:203], v[194:197]
    ds_read_b128 v[154:157], v0 offset:33024
    v_cvt_pk_bf16_f32 v132, v202, v203
    v_mfma_f32_16x16x32_bf16 v[194:197], v[198:201], a[204:207], v[194:197]
    ds_read_b128 v[198:201], v1 offset:33024
    v_cvt_pk_bf16_f32 v133, v204, v205
    v_mfma_f32_16x16x32_bf16 v[194:197], v[210:213], a[208:211], v[194:197]
    v_mul_f32 v228, v191, v228
    v_mul_f32 v229, v191, v229
    v_mfma_f32_16x16x32_bf16 v[194:197], v[162:165], a[212:215], v[194:197]
    v_cvt_pk_f16_f32 v227, v228, v229
    v_mul_f32 v122, v191, v122
    v_mfma_f32_16x16x32_f16 v[210:213], v[242:245], v[222:225], v[46:49]
    s_waitcnt lgkmcnt(5)
    buffer_store_dwordx2 v[116:117], v18, s[12:15], 0 offen
    v_mul_f32 v123, v191, v123
    v_cvt_pk_f16_f32 v228, v122, v123
    v_mfma_f32_16x16x32_bf16 v[202:205], a[72:75], v[150:153], 0
    s_waitcnt lgkmcnt(3)
    v_cvt_pk_bf16_f32 v116, v194, v195
    v_cvt_pk_bf16_f32 v117, v196, v197
    v_mfma_f32_16x16x32_bf16 v[202:205], a[76:79], v[166:169], v[202:205]
    s_waitcnt lgkmcnt(2)
    v_mul_f32 v124, v191, v124
    v_mul_f32 v125, v191, v125
    v_mfma_f32_16x16x32_bf16 v[202:205], a[80:83], v[118:121], v[202:205]
    s_waitcnt lgkmcnt(1)
    v_cvt_pk_f16_f32 v229, v124, v125
    v_mul_f32 v126, v191, v126
    v_mfma_f32_16x16x32_bf16 v[202:205], a[84:87], v[134:137], v[202:205]
    s_waitcnt lgkmcnt(0)
    v_mul_f32 v127, v191, v127
    v_cvt_pk_f16_f32 v124, v126, v127
    v_mfma_f32_16x16x32_bf16 v[202:205], a[88:91], v[154:157], v[202:205]
    v_mul_f32 v128, v191, v128
    v_mul_f32 v129, v191, v129
    v_mfma_f32_16x16x32_bf16 v[202:205], a[92:95], v[198:201], v[202:205]
    v_cvt_pk_f16_f32 v125, v128, v129
    v_mul_f32 v206, v190, v206
    v_mfma_f32_16x16x32_bf16 v[126:129], a[96:99], v[150:153], 0
    v_mul_f32 v207, v190, v207
    v_cvt_pk_f16_f32 v206, v206, v207
    v_mfma_f32_16x16x32_bf16 v[126:129], a[100:103], v[166:169], v[126:129]
    v_mul_f32 v208, v190, v208
    v_mul_f32 v209, v190, v209
    v_mfma_f32_16x16x32_bf16 v[126:129], a[104:107], v[118:121], v[126:129]
    v_cvt_pk_f16_f32 v207, v208, v209
    v_mul_f32 v174, v190, v174
    v_mfma_f32_16x16x32_bf16 v[126:129], a[108:111], v[134:137], v[126:129]
    v_mul_f32 v175, v190, v175
    v_cvt_pk_f16_f32 v208, v174, v175
    v_mfma_f32_16x16x32_bf16 v[126:129], a[112:115], v[154:157], v[126:129]
    v_mul_f32 v176, v190, v176
    v_mul_f32 v177, v190, v177
    v_mfma_f32_16x16x32_bf16 v[126:129], a[116:119], v[198:201], v[126:129]
    v_cvt_pk_f16_f32 v209, v176, v177
    v_mul_f32 v218, v190, v218
    v_mfma_f32_16x16x32_bf16 v[174:177], a[120:123], v[150:153], 0
    v_mul_f32 v219, v190, v219
    v_cvt_pk_f16_f32 v122, v218, v219
    v_mfma_f32_16x16x32_bf16 v[174:177], a[124:127], v[166:169], v[174:177]
    v_mul_f32 v220, v190, v220
    v_mul_f32 v221, v190, v221
    v_mfma_f32_16x16x32_bf16 v[174:177], a[128:131], v[118:121], v[174:177]
    v_cvt_pk_f16_f32 v123, v220, v221
    v_fma_f32 v162, v202, v202, s32
    v_mfma_f32_16x16x32_bf16 v[174:177], a[132:135], v[134:137], v[174:177]
    v_fmac_f32 v162, v203, v203
    v_fmac_f32 v162, v204, v204
    v_mfma_f32_16x16x32_bf16 v[174:177], a[136:139], v[154:157], v[174:177]
    v_fmac_f32 v162, v205, v205
    v_fmac_f32 v162, v126, v126
    v_mfma_f32_16x16x32_bf16 v[174:177], a[140:143], v[198:201], v[174:177]
    v_fmac_f32 v162, v127, v127
    v_fmac_f32 v162, v128, v128
    v_mfma_f32_16x16x32_bf16 v[190:193], a[0:3], v[150:153], 0
    v_fmac_f32 v162, v129, v129
    v_mul_f32 v149, v255, v149
    v_mfma_f32_16x16x32_bf16 v[190:193], a[4:7], v[166:169], v[190:193]
    v_cvt_pk_bf16_f32 v147, v148, v149
    v_mul_f32 v138, v255, v138
    v_mfma_f32_16x16x32_bf16 v[190:193], a[8:11], v[118:121], v[190:193]
    v_fmac_f32 v162, v174, v174
    v_fmac_f32 v162, v175, v175
    v_mfma_f32_16x16x32_bf16 v[190:193], a[12:15], v[134:137], v[190:193]
    v_fmac_f32 v162, v176, v176
    v_fmac_f32 v162, v177, v177
    v_mfma_f32_16x16x32_bf16 v[190:193], a[16:19], v[154:157], v[190:193]
    v_mul_f32 v139, v255, v139
    v_cvt_pk_bf16_f32 v148, v138, v139
    v_mfma_f32_16x16x32_bf16 v[190:193], a[20:23], v[198:201], v[190:193]
    v_mul_f32 v140, v255, v140
    v_mul_f32 v141, v255, v141
    v_mfma_f32_16x16x32_bf16 v[218:221], a[24:27], v[150:153], 0
    v_cvt_pk_bf16_f32 v149, v140, v141
    v_mul_f32 v186, v255, v186
    v_mfma_f32_16x16x32_bf16 v[218:221], a[28:31], v[166:169], v[218:221]
    buffer_store_dwordx4 v[146:149], v17, s[12:15], 0 offen
    v_mul_f32 v187, v255, v187
    v_fma_f32 v163, v190, v190, s32
    v_fmac_f32 v163, v191, v191
    v_fmac_f32 v163, v192, v192
    v_mfma_f32_16x16x32_bf16 v[218:221], a[32:35], v[118:121], v[218:221]
    v_fmac_f32 v163, v193, v193
    v_cvt_pk_bf16_f32 v164, v186, v187
    v_mfma_f32_16x16x32_bf16 v[218:221], a[36:39], v[134:137], v[218:221]
    v_mul_f32 v188, v255, v188
    v_mul_f32 v189, v255, v189
    v_mfma_f32_16x16x32_bf16 v[218:221], a[40:43], v[154:157], v[218:221]
    v_cvt_pk_bf16_f32 v165, v188, v189
    v_mul_f32 v142, v254, v142
    v_mfma_f32_16x16x32_bf16 v[218:221], a[44:47], v[198:201], v[218:221]
    v_mul_f32 v143, v254, v143
    v_cvt_pk_bf16_f32 v142, v142, v143
    v_mfma_f32_16x16x32_bf16 v[138:141], a[48:51], v[150:153], 0
    v_mul_f32 v144, v254, v144
    v_mul_f32 v145, v254, v145
    v_mfma_f32_16x16x32_bf16 v[138:141], a[52:55], v[166:169], v[138:141]
    v_cvt_pk_bf16_f32 v143, v144, v145
    v_mul_f32 v158, v254, v158
    v_mfma_f32_16x16x32_bf16 v[138:141], a[56:59], v[118:121], v[138:141]
    v_fmac_f32 v163, v218, v218
    v_fmac_f32 v163, v219, v219
    v_mfma_f32_16x16x32_bf16 v[138:141], a[60:63], v[134:137], v[138:141]
    ds_read2_b32 v[196:197], v6 offset0:0 offset1:0
    ds_read2_b32 v[216:217], v6 offset0:16 offset1:16
    v_mfma_f32_16x16x32_bf16 v[138:141], a[64:67], v[154:157], v[138:141]
    ds_read2_b32 v[232:233], v6 offset0:32 offset1:32
    v_fmac_f32 v163, v220, v220
    v_mfma_f32_16x16x32_bf16 v[138:141], a[68:71], v[198:201], v[138:141]
    v_fmac_f32 v163, v221, v221
    v_mul_f32 v159, v254, v159
    v_mfma_f32_16x16x32_bf16 v[146:149], v[150:153], a[144:147], 0
    v_cvt_pk_bf16_f32 v144, v158, v159
    v_mul_f32 v160, v254, v160
    v_mfma_f32_16x16x32_bf16 v[146:149], v[166:169], a[148:151], v[146:149]
    v_mul_f32 v161, v254, v161
    v_cvt_pk_bf16_f32 v145, v160, v161
    v_mfma_f32_16x16x32_bf16 v[146:149], v[118:121], a[152:155], v[146:149]
    v_fmac_f32 v163, v138, v138
    v_fmac_f32 v163, v139, v139
    v_mfma_f32_16x16x32_bf16 v[146:149], v[134:137], a[156:159], v[146:149]
    v_fmac_f32 v163, v140, v140
    v_fmac_f32 v163, v141, v141
    v_mfma_f32_16x16x32_bf16 v[146:149], v[154:157], a[160:163], v[146:149]
    v_cvt_pk_bf16_f32 v36, v163, v162
    v_mul_f32 v178, v254, v178
    v_mfma_f32_16x16x32_bf16 v[146:149], v[198:201], a[164:167], v[146:149]
    s_waitcnt lgkmcnt(1)
    v_mul_f32 v179, v254, v179
    v_cvt_pk_bf16_f32 v178, v178, v179
    v_mfma_f32_16x16x32_bf16 v[158:161], v[32:35], v[36:39], 0
    s_waitcnt lgkmcnt(0)
    buffer_store_dwordx2 v[164:165], v20, s[12:15], 0 offen
    v_mul_f32 v180, v254, v180
    v_mul_f32 v181, v254, v181
    v_mfma_f32_16x16x32_bf16 v[186:189], v[150:153], a[168:171], 0
    v_cvt_pk_bf16_f32 v194, v146, v147
    v_cvt_pk_bf16_f32 v195, v148, v149
    v_mfma_f32_16x16x32_bf16 v[186:189], v[166:169], a[172:175], v[186:189]
    v_rsq_f32 v159, v159
    v_mfma_f32_16x16x32_bf16 v[186:189], v[118:121], a[176:179], v[186:189]
    v_rsq_f32 v158, v158
    v_mfma_f32_16x16x32_bf16 v[186:189], v[134:137], a[180:183], v[186:189]
    v_mul_f32 v158, s31, v158
    v_mul_f32 v202, v159, v202
    v_mfma_f32_16x16x32_bf16 v[186:189], v[154:157], a[184:187], v[186:189]
    v_mul_f32 v203, v159, v203
    v_cvt_pk_f16_f32 v146, v202, v203
    v_mfma_f32_16x16x32_bf16 v[186:189], v[198:201], a[188:191], v[186:189]
    v_mul_f32 v204, v159, v204
    v_mul_f32 v205, v159, v205
    v_mfma_f32_16x16x32_bf16 v[162:165], v[150:153], a[192:195], 0
    v_cvt_pk_f16_f32 v147, v204, v205
    v_mul_f32 v126, v159, v126
    v_mfma_f32_16x16x32_bf16 v[162:165], v[166:169], a[196:199], v[162:165]
    ds_read_b128 v[150:153], v5 offset:0
    ds_read_b128 v[202:205], v5 offset:16
    v_mfma_f32_16x16x32_bf16 v[162:165], v[118:121], a[200:203], v[162:165]
    ds_read_b128 v[118:121], v5 offset:48
    ds_read_b32 v254, v6 offset:192
    v_mfma_f32_16x16x32_bf16 v[162:165], v[134:137], a[204:207], v[162:165]
    v_cvt_pk_bf16_f32 v214, v186, v187
    v_cvt_pk_bf16_f32 v215, v188, v189
    v_mfma_f32_16x16x32_bf16 v[162:165], v[154:157], a[208:211], v[162:165]
    v_mul_f32 v127, v159, v127
    v_cvt_pk_f16_f32 v148, v126, v127
    v_mfma_f32_16x16x32_bf16 v[162:165], v[198:201], a[212:215], v[162:165]
    ds_read_b128 v[198:201], v2 offset:0
    ds_read_b128 v[186:189], v2 offset:1024
    v_mfma_f32_16x16x32_f16 v[134:137], v[226:229], v[222:225], v[50:53]
    ds_read_b128 v[154:157], v2 offset:2048
    v_mul_f32 v128, v159, v128
    v_mul_f32 v129, v159, v129
    v_mfma_f32_16x16x16_f16 v[210:213], v[184:185], v[182:183], v[210:213]
    v_cvt_pk_f16_f32 v149, v128, v129
    v_cvt_pk_bf16_f32 v230, v162, v163
    v_cvt_pk_bf16_f32 v231, v164, v165
    v_mul_f32 v174, v159, v174
    v_mfma_f32_16x16x32_f16 v[126:129], v[146:149], v[222:225], v[54:57]
    s_waitcnt lgkmcnt(5)
    v_mul_f32 v175, v159, v175
    v_cvt_pk_f16_f32 v164, v174, v175
    v_mul_f32 v176, v159, v176
    v_mfma_f32_16x16x16_f16 v[134:137], v[124:125], v[182:183], v[134:137]
    v_mul_f32 v177, v159, v177
    v_cvt_pk_f16_f32 v165, v176, v177
    v_mul_f32 v190, v158, v190
    v_mul_f32 v191, v158, v191
    v_mfma_f32_16x16x16_f16 v[126:129], v[164:165], v[182:183], v[126:129]
    v_cvt_pk_f16_f32 v174, v190, v191
    v_mul_f32 v192, v158, v192
    v_mul_f32 v193, v158, v193
    v_cvt_pk_f16_f32 v175, v192, v193
    v_mfma_f32_16x16x32_f16 v[166:169], v[150:153], v[222:225], v[22:25]
    s_waitcnt lgkmcnt(2)
    ds_read_b128 v[222:225], v2 offset:3072
    buffer_store_dwordx4 v[142:145], v16, s[12:15], 0 offen
    ds_read_b128 v[234:237], v2 offset:4096
    v_mul_f32 v218, v158, v218
    v_mul_f32 v219, v158, v219
    v_cvt_pk_f16_f32 v176, v218, v219
    v_mfma_f32_16x16x32_f16 v[166:169], v[202:205], v[242:245], v[166:169]
    s_waitcnt lgkmcnt(2)
    v_mul_f32 v220, v158, v220
    v_mul_f32 v221, v158, v221
    v_mfma_f32_16x16x32_f16 v[166:169], v[118:121], v[182:185], v[166:169]
    ds_read_b128 v[142:145], v2 offset:5120
    v_cvt_pk_f16_f32 v177, v220, v221
    v_mul_f32 v138, v158, v138
    v_mul_f32 v139, v158, v139
    v_cvt_pk_f16_f32 v162, v138, v139
    v_mfma_f32_16x16x32_f16 v[218:221], v[150:153], v[206:209], v[24:27]
    v_mul_f32 v140, v158, v140
    v_mul_f32 v141, v158, v141
    v_mfma_f32_16x16x32_f16 v[218:221], v[202:205], v[226:229], v[218:221]
    v_mov_b32_dpp v254, v167 quad_perm:[0,1,2,3] row_mask:0x1 bank_mask:0xf
    v_cvt_pk_f16_f32 v163, v140, v141
    v_mfma_f32_16x16x32_f16 v[218:221], v[118:121], v[122:125], v[218:221]
    v_max3_f32 v255, v166, v210, v211
    v_max3_f32 v255, v255, v212, v213
    v_mfma_f32_16x16x32_f16 v[238:241], v[150:153], v[174:177], v[26:29]
    s_waitcnt lgkmcnt(1)
    v_max3_f32 v255, v255, v134, v135
    v_max3_f32 v255, v255, v136, v137
    v_mfma_f32_16x16x32_f16 v[238:241], v[202:205], v[146:149], v[238:241]
    v_max3_f32 v255, v255, v126, v127
    v_mov_b32_dpp v254, v219 quad_perm:[0,1,2,3] row_mask:0x2 bank_mask:0xf
    v_mfma_f32_16x16x32_f16 v[238:241], v[118:121], v[162:165], v[238:241]
    v_max3_f32 v255, v255, v128, v129
    v_mov_b32 v182, v255
    v_mfma_f32_16x16x32_bf16 v[150:153], a[216:219], v[198:201], 0
    s_waitcnt lgkmcnt(0)
    v_permlane32_swap_b32 v255, v182
    v_mfma_f32_16x16x32_bf16 v[150:153], a[220:223], v[186:189], v[150:153]
    v_max_f32 v255, v255, v182
    v_mov_b32 v182, v255
    v_mfma_f32_16x16x32_bf16 v[150:153], a[224:227], v[154:157], v[150:153]
    v_cvt_pk_bf16_f32 v179, v180, v181
    v_xor_b32 v0, 65536, v0
    v_mfma_f32_16x16x32_bf16 v[150:153], a[228:231], v[222:225], v[150:153]
    s_waitcnt vmcnt(5)
    v_permlane16_swap_b32 v255, v182
    v_mfma_f32_16x16x32_bf16 v[150:153], a[232:235], v[234:237], v[150:153]
    s_nop 0
    v_max_f32 v255, v255, v182
    v_sub_f32 v210, v210, v255
    v_mfma_f32_16x16x32_bf16 v[150:153], a[236:239], v[142:145], v[150:153]
    s_barrier
    v_exp_f32 v210, v210
    v_mfma_f32_16x16x32_bf16 v[190:193], a[240:243], v[198:201], 0
    s_nop 0
    v_sub_f32 v211, v211, v255
    v_sub_f32 v212, v212, v255
    v_mfma_f32_16x16x32_bf16 v[190:193], a[244:247], v[186:189], v[190:193]
    s_nop 0
    buffer_load_dwordx4 v10, s[8:11], 0 offen lds
    v_sub_f32 v213, v213, v255
    v_mfma_f32_16x16x32_bf16 v[190:193], a[248:251], v[154:157], v[190:193]
    s_add_u32 m0, s28, 4096
    v_exp_f32 v211, v211
    v_mfma_f32_16x16x32_bf16 v[190:193], a[252:255], v[222:225], v[190:193]
    v_cvt_pk_bf16_f32 v158, v210, v211
    v_sub_f32 v134, v134, v255
    v_mfma_f32_16x16x32_bf16 v[190:193], v[82:85], v[234:237], v[190:193]
    v_exp_f32 v212, v212
    v_mfma_f32_16x16x32_bf16 v[190:193], v[86:89], v[142:145], v[190:193]
    v_exp_f32 v213, v213
    v_mfma_f32_16x16x32_bf16 v[202:205], v[90:93], v[198:201], 0
    ds_read_b128 v[198:201], v2 offset:6144
    buffer_load_dwordx4 v11, s[8:11], 0 offen lds
    v_mfma_f32_16x16x32_bf16 v[202:205], v[94:97], v[186:189], v[202:205]
    s_add_u32 m0, s28, 8192
    ds_read_b128 v[138:141], v2 offset:7168
    v_cvt_pk_bf16_f32 v159, v212, v213
    v_mfma_f32_16x16x32_bf16 v[202:205], v[98:101], v[154:157], v[202:205]
    ds_read_b128 v[210:213], v2 offset:8192
    v_sub_f32 v135, v135, v255
    v_mfma_f32_16x16x32_bf16 v[202:205], v[102:105], v[222:225], v[202:205]
    ds_read_b128 v[186:189], v2 offset:9216
    v_sub_f32 v136, v136, v255
    v_mfma_f32_16x16x32_bf16 v[202:205], v[106:109], v[234:237], v[202:205]
    ds_read_b128 v[222:225], v2 offset:10240
    v_sub_f32 v137, v137, v255
    v_mfma_f32_16x16x32_bf16 v[202:205], v[110:113], v[142:145], v[202:205]
    ds_read_b128 v[154:157], v2 offset:11264
    buffer_load_dwordx4 v12, s[8:11], 0 offen lds
    v_exp_f32 v134, v134
    v_mfma_f32_16x16x32_f16 v[118:121], v[242:245], v[206:209], v[58:61]
    s_add_u32 m0, s28, 12288
    v_exp_f32 v135, v135
    v_exp_f32 v136, v136
    v_cvt_pk_bf16_f32 v160, v134, v135
    v_exp_f32 v137, v137
    v_sub_f32 v126, v126, v255
    v_mfma_f32_16x16x16_f16 v[118:121], v[184:185], v[122:123], v[118:121]
    v_cvt_pk_bf16_f32 v161, v136, v137
    v_exp_f32 v126, v126
    v_sub_f32 v127, v127, v255
    v_mfma_f32_16x16x32_f16 v[134:137], v[226:229], v[206:209], v[62:65]
    s_xor_b32 s28, s28, 65536
    buffer_load_dwordx4 v13, s[8:11], 0 offen lds
    v_exp_f32 v127, v127
    v_sub_f32 v128, v128, v255
    v_cvt_pk_bf16_f32 v36, v126, v127
    v_exp_f32 v128, v128
    v_mfma_f32_16x16x16_f16 v[134:137], v[124:125], v[122:123], v[134:137]
    v_sub_f32 v129, v129, v255
    v_exp_f32 v129, v129
    v_sub_f32 v166, v166, v255
    v_cvt_pk_bf16_f32 v37, v128, v129
    v_mfma_f32_16x16x32_f16 v[126:129], v[146:149], v[206:209], v[66:69]
    s_waitcnt lgkmcnt(0)
    v_exp_f32 v166, v166
    v_mfma_f32_16x16x32_bf16 v[142:145], a[216:219], v[198:201], 0
    s_mov_b32 m0, s29
    v_cvt_pk_bf16_f32 v39, v166, 0
    v_max3_f32 v255, v218, v118, v119
    v_max3_f32 v255, v255, v120, v121
    v_mfma_f32_16x16x16_f16 v[126:129], v[164:165], v[122:123], v[126:129]
    v_max3_f32 v255, v255, v134, v135
    v_max3_f32 v255, v255, v136, v137
    v_xor_b32 v1, 65536, v1
    v_mov_b32_dpp v254, v239 quad_perm:[0,1,2,3] row_mask:0x4 bank_mask:0xf
    v_mfma_f32_16x16x32_bf16 v[206:209], v[28:31], v[36:39], 0
    s_xor_b32 s29, s29, s30
    buffer_store_dwordx2 v[178:179], v19, s[12:15], 0 offen
    v_mov_b32 v122, v254
    v_max3_f32 v255, v255, v126, v127
    v_mfma_f32_16x16x32_bf16 v[206:209], v[28:31], v[158:161], v[206:209]
    s_add_u32 s19, s19, s20
    v_max3_f32 v255, v255, v128, v129
    v_mov_b32 v123, v255
    v_mfma_f32_16x16x32_bf16 v[142:145], a[220:223], v[138:141], v[142:145]
    s_add_u32 s23, s23, s21
    v_permlane32_swap_b32 v255, v123
    v_mfma_f32_16x16x32_bf16 v[142:145], a[224:227], v[210:213], v[142:145]
    s_cmp_ge_u32 s19, 72
    v_rcp_f32 v206, v206
    v_mfma_f32_16x16x32_bf16 v[142:145], a[228:231], v[186:189], v[142:145]
    s_cselect_b32 s34, 72, 0
    v_max_f32 v255, v255, v123
    v_mov_b32 v123, v255
    v_mfma_f32_16x16x32_bf16 v[142:145], a[232:235], v[222:225], v[142:145]
    s_cselect_b32 s35, s22, 0
    v_permlane16_swap_b32 v255, v123
    v_mfma_f32_16x16x32_bf16 v[142:145], a[236:239], v[154:157], v[142:145]
    s_sub_u32 s19, s19, s34
    v_max_f32 v255, v255, v123
    v_sub_f32 v118, v118, v255
    v_mfma_f32_16x16x32_bf16 v[178:181], v[194:197], v[36:39], 0
    s_add_u32 s23, s23, s35
    v_exp_f32 v118, v118
    v_mfma_f32_16x16x32_bf16 v[178:181], v[170:173], v[158:161], v[178:181]
    s_add_u32 s18, s18, 1
    v_sub_f32 v119, v119, v255
    v_exp_f32 v119, v119
    v_sub_f32 v120, v120, v255
    v_cvt_pk_bf16_f32 v118, v118, v119
    v_exp_f32 v120, v120
    v_sub_f32 v121, v121, v255
    v_exp_f32 v121, v121
    v_mul_f32 v178, v206, v178
    v_mul_f32 v179, v206, v179
    v_cvt_pk_bf16_f32 v178, v178, v179
    v_mul_f32 v180, v206, v180
    v_mul_f32 v181, v206, v181
    v_cvt_pk_bf16_f32 v179, v180, v181
    v_cvt_pk_bf16_f32 v119, v120, v121
    v_mfma_f32_16x16x32_bf16 v[166:169], v[214:217], v[36:39], 0
    s_cmp_lt_u32 s18, s17
    v_sub_f32 v134, v134, v255
    v_sub_f32 v135, v135, v255
    v_mfma_f32_16x16x32_bf16 v[166:169], v[130:133], v[158:161], v[166:169]
    v_exp_f32 v134, v134
    v_exp_f32 v135, v135
    v_sub_f32 v136, v136, v255
    v_cvt_pk_bf16_f32 v120, v134, v135
    v_exp_f32 v136, v136
    v_sub_f32 v137, v137, v255
    v_exp_f32 v137, v137
    v_sub_f32 v126, v126, v255
    v_mul_f32 v166, v206, v166
    v_mul_f32 v167, v206, v167
    v_cvt_pk_bf16_f32 v180, v166, v167
    v_mul_f32 v168, v206, v168
    v_mul_f32 v169, v206, v169
    v_cvt_pk_bf16_f32 v181, v168, v169
    v_cvt_pk_bf16_f32 v121, v136, v137
    v_mfma_f32_16x16x32_bf16 v[134:137], v[230:233], v[36:39], 0
    buffer_load_dwordx4 v14, s[8:11], 0 offen lds
    v_sub_f32 v127, v127, v255
    v_mfma_f32_16x16x32_bf16 v[134:137], v[114:117], v[158:161], v[134:137]
    ds_write_b128 v3, v[178:181] offset:0
    v_mfma_f32_16x16x32_bf16 v[158:161], a[240:243], v[198:201], 0
    v_exp_f32 v126, v126
    v_mfma_f32_16x16x32_bf16 v[158:161], a[244:247], v[138:141], v[158:161]
    v_exp_f32 v127, v127
    v_mfma_f32_16x16x32_bf16 v[158:161], a[248:251], v[210:213], v[158:161]
    v_cvt_pk_bf16_f32 v36, v126, v127
    v_sub_f32 v128, v128, v255
    v_mfma_f32_16x16x32_bf16 v[158:161], a[252:255], v[186:189], v[158:161]
    v_mul_f32 v134, v206, v134
    v_mul_f32 v135, v206, v135
    v_mfma_f32_16x16x32_bf16 v[158:161], v[82:85], v[222:225], v[158:161]
    v_cvt_pk_bf16_f32 v126, v134, v135
    v_mul_f32 v136, v206, v136
    v_mfma_f32_16x16x32_bf16 v[158:161], v[86:89], v[154:157], v[158:161]
    v_mul_f32 v137, v206, v137
    v_cvt_pk_bf16_f32 v127, v136, v137
    v_mfma_f32_16x16x32_bf16 v[178:181], v[90:93], v[198:201], 0
    ds_read_b128 v[198:201], v2 offset:12288
    v_sub_f32 v129, v129, v255
    v_mfma_f32_16x16x32_bf16 v[178:181], v[94:97], v[138:141], v[178:181]
    ds_read_b128 v[206:209], v2 offset:13312
    v_sub_f32 v218, v218, v255
    v_mfma_f32_16x16x32_bf16 v[178:181], v[98:101], v[210:213], v[178:181]
    ds_read_b128 v[210:213], v2 offset:14336
    v_max_f32_dpp v122, v122, v122 quad_perm:[1,0,3,2] row_mask:0xf bank_mask:0xf
    v_mfma_f32_16x16x32_bf16 v[178:181], v[102:105], v[186:189], v[178:181]
    ds_read_b128 v[134:137], v2 offset:15360
    v_max_f32_dpp v122, v122, v122 quad_perm:[2,3,0,1] row_mask:0xf bank_mask:0xf
    v_mfma_f32_16x16x32_bf16 v[178:181], v[106:109], v[222:225], v[178:181]
    ds_read_b128 v[222:225], v2 offset:16384
    v_max_f32_dpp v122, v122, v122 row_half_mirror row_mask:0xf bank_mask:0xf
    v_mfma_f32_16x16x32_bf16 v[178:181], v[110:113], v[154:157], v[178:181]
    ds_read_b128 v[154:157], v2 offset:17408
    ds_write_b64 v4, v[126:127] offset:4096
    v_exp_f32 v128, v128
    v_exp_f32 v129, v129
    v_mfma_f32_16x16x32_f16 v[186:189], v[242:245], v[174:177], v[70:73]
    s_waitcnt lgkmcnt(6)
    v_cvt_pk_bf16_f32 v37, v128, v129
    v_max_f32_dpp v122, v122, v122 row_mirror row_mask:0xf bank_mask:0xf
    v_mfma_f32_16x16x32_f16 v[242:245], v[226:229], v[174:177], v[74:77]
    s_waitcnt lgkmcnt(5)
    v_exp_f32 v218, v218
    v_mfma_f32_16x16x32_f16 v[126:129], v[146:149], v[174:177], v[78:81]
    s_waitcnt lgkmcnt(4)
    v_cvt_pk_bf16_f32 v39, v218, 0
    v_mov_b32 v123, v122
    v_fma_f32 v255, v150, v150, s33
    v_mfma_f32_16x16x32_bf16 v[174:177], v[28:31], v[36:39], 0
    s_waitcnt lgkmcnt(3)
    v_permlane32_swap_b32 v122, v123
    v_mfma_f32_16x16x32_bf16 v[174:177], v[28:31], v[118:121], v[174:177]
    s_waitcnt lgkmcnt(2)
    v_max_f32 v122, v122, v123
    v_mov_b32 v123, v122
    v_mfma_f32_16x16x32_bf16 v[226:229], v[194:197], v[36:39], 0
    s_waitcnt lgkmcnt(0)
    v_permlane16_swap_b32 v122, v123
    v_mfma_f32_16x16x32_bf16 v[226:229], v[170:173], v[118:121], v[226:229]
    v_max_f32 v122, v122, v123
    v_sub_f32 v254, v254, v122
    v_mfma_f32_16x16x32_bf16 v[218:221], v[214:217], v[36:39], 0
    v_exp_f32 v254, v254
    v_mfma_f32_16x16x32_bf16 v[218:221], v[130:133], v[118:121], v[218:221]
    v_cvt_pk_bf16_f32 v254, v254, v254
    v_fmac_f32 v255, v151, v151
    v_mfma_f32_16x16x32_bf16 v[166:169], v[230:233], v[36:39], 0
    ds_write_b16 v8, v254
    v_mfma_f32_16x16x32_bf16 v[166:169], v[114:117], v[118:121], v[166:169]
    v_rcp_f32 v174, v174
    v_fmac_f32 v255, v152, v152
    v_mfma_f32_16x16x16_f16 v[186:189], v[184:185], v[162:163], v[186:189]
    v_mul_f32 v226, v174, v226
    v_mul_f32 v227, v174, v227
    v_cvt_pk_bf16_f32 v122, v226, v227
    v_mfma_f32_16x16x16_f16 v[242:245], v[124:125], v[162:163], v[242:245]
    v_mul_f32 v228, v174, v228
    v_mul_f32 v229, v174, v229
    v_cvt_pk_bf16_f32 v123, v228, v229
    v_mfma_f32_16x16x16_f16 v[126:129], v[164:165], v[162:163], v[126:129]
    v_max3_f32 v254, v238, v186, v187
    v_max3_f32 v254, v254, v188, v189
    v_mul_f32 v218, v174, v218
    v_mul_f32 v219, v174, v219
    v_mfma_f32_16x16x32_bf16 v[146:149], a[216:219], v[198:201], 0
    ds_read_b128 v[118:121], v9
    ds_read_b128 v[162:165], v9 offset:64
    v_mfma_f32_16x16x32_bf16 v[146:149], a[220:223], v[206:209], v[146:149]
    v_max3_f32 v254, v254, v242, v243
    v_max3_f32 v254, v254, v244, v245
    v_mfma_f32_16x16x32_bf16 v[146:149], a[224:227], v[210:213], v[146:149]
    v_max3_f32 v254, v254, v126, v127
    v_max3_f32 v254, v254, v128, v129
    v_mfma_f32_16x16x32_bf16 v[146:149], a[228:231], v[134:137], v[146:149]
    v_mov_b32 v125, v254
    v_cvt_pk_bf16_f32 v124, v218, v219
    v_mfma_f32_16x16x32_bf16 v[146:149], a[232:235], v[222:225], v[146:149]
    v_permlane32_swap_b32 v254, v125
    v_mfma_f32_16x16x32_bf16 v[146:149], a[236:239], v[154:157], v[146:149]
    v_max_f32 v254, v254, v125
    v_mov_b32 v125, v254
    v_mfma_f32_16x16x32_bf16 v[138:141], a[240:243], v[198:201], 0
    v_mul_f32 v220, v174, v220
    v_mul_f32 v221, v174, v221
    v_mfma_f32_16x16x32_bf16 v[138:141], a[244:247], v[206:209], v[138:141]
    v_permlane16_swap_b32 v254, v125
    v_mfma_f32_16x16x32_bf16 v[138:141], a[248:251], v[210:213], v[138:141]
    s_waitcnt lgkmcnt(0)
    v_max_f32 v254, v254, v125
    v_sub_f32 v186, v186, v254
    v_mfma_f32_16x16x32_bf16 v[138:141], a[252:255], v[134:137], v[138:141]
    v_exp_f32 v186, v186
    v_mfma_f32_16x16x32_bf16 v[138:141], v[82:85], v[222:225], v[138:141]
    v_sub_f32 v187, v187, v254
    v_sub_f32 v188, v188, v254
    v_mfma_f32_16x16x32_bf16 v[138:141], v[86:89], v[154:157], v[138:141]
    v_exp_f32 v187, v187
    v_exp_f32 v188, v188
    v_cvt_pk_bf16_f32 v234, v186, v187
    v_sub_f32 v189, v189, v254
    v_exp_f32 v189, v189
    v_sub_f32 v242, v242, v254
    v_cvt_pk_bf16_f32 v235, v188, v189
    v_exp_f32 v242, v242
    v_sub_f32 v243, v243, v254
    v_exp_f32 v243, v243
    v_sub_f32 v244, v244, v254
    v_cvt_pk_bf16_f32 v236, v242, v243
    v_mfma_f32_16x16x32_bf16 v[186:189], v[90:93], v[198:201], 0
    v_exp_f32 v244, v244
    v_mfma_f32_16x16x32_bf16 v[186:189], v[94:97], v[206:209], v[186:189]
    v_sub_f32 v245, v245, v254
    v_sub_f32 v126, v126, v254
    v_mfma_f32_16x16x32_bf16 v[186:189], v[98:101], v[210:213], v[186:189]
    v_exp_f32 v245, v245
    v_mfma_f32_16x16x32_bf16 v[186:189], v[102:105], v[134:137], v[186:189]
    v_cvt_pk_bf16_f32 v237, v244, v245
    v_sub_f32 v127, v127, v254
    v_mfma_f32_16x16x32_bf16 v[186:189], v[106:109], v[222:225], v[186:189]
    v_exp_f32 v126, v126
    v_mfma_f32_16x16x32_bf16 v[186:189], v[110:113], v[154:157], v[186:189]
    ds_read_b128 v[182:185], v0 offset:20480
    ds_read_b128 v[198:201], v1 offset:20480
    v_mfma_f32_16x16x32_bf16 v[206:209], v[118:121], v[28:31], 0
    ds_read_b128 v[210:213], v0 offset:20608
    ds_read_b128 v[222:225], v1 offset:20608
    v_mfma_f32_16x16x32_bf16 v[206:209], v[162:165], v[28:31], v[206:209]
    v_exp_f32 v127, v127
    v_mfma_f32_16x16x32_bf16 v[154:157], v[118:121], v[170:173], 0
    ds_read_b128 v[226:229], v0 offset:20736
    v_cvt_pk_bf16_f32 v36, v126, v127
    v_mfma_f32_16x16x32_bf16 v[154:157], v[162:165], v[194:197], v[154:157]
    ds_read_b128 v[242:245], v1 offset:20736
    v_sub_f32 v128, v128, v254
    v_exp_f32 v128, v128
    v_sub_f32 v129, v129, v254
    v_exp_f32 v129, v129
    v_sub_f32 v238, v238, v254
    v_cvt_pk_bf16_f32 v37, v128, v129
    v_mfma_f32_16x16x32_bf16 v[134:137], v[118:121], v[130:133], 0
    v_exp_f32 v238, v238
    v_mfma_f32_16x16x32_bf16 v[134:137], v[162:165], v[214:217], v[134:137]
    s_waitcnt lgkmcnt(4)
    v_cvt_pk_bf16_f32 v39, v238, 0
    v_cvt_pk_bf16_f32 v125, v220, v221
    v_mfma_f32_16x16x32_bf16 v[218:221], v[118:121], v[114:117], 0
    s_waitcnt lgkmcnt(2)
    ds_write_b128 v3, v[122:125] offset:6144
    v_mfma_f32_16x16x32_bf16 v[126:129], v[28:31], v[36:39], 0
    s_waitcnt lgkmcnt(2)
    v_mul_f32 v166, v174, v166
    v_mul_f32 v167, v174, v167
    v_mfma_f32_16x16x32_bf16 v[126:129], v[28:31], v[234:237], v[126:129]
    s_waitcnt lgkmcnt(1)
    v_cvt_pk_bf16_f32 v166, v166, v167
    v_mul_f32 v168, v174, v168
    v_mfma_f32_16x16x32_bf16 v[122:125], v[194:197], v[36:39], 0
    v_mul_f32 v169, v174, v169
    v_cvt_pk_bf16_f32 v167, v168, v169
    v_mfma_f32_16x16x32_bf16 v[122:125], v[170:173], v[234:237], v[122:125]
    ds_write_b64 v4, v[166:167] offset:10240
    v_mfma_f32_16x16x32_bf16 v[170:173], v[214:217], v[36:39], 0
    v_rcp_f32 v126, v126
    v_mfma_f32_16x16x32_bf16 v[170:173], v[130:133], v[234:237], v[170:173]
    v_fma_f32 v254, v146, v146, s33
    v_fmac_f32 v254, v147, v147
    v_mfma_f32_16x16x32_bf16 v[174:177], v[230:233], v[36:39], 0
    v_fmac_f32 v254, v148, v148
    v_mul_f32 v122, v126, v122
    v_mfma_f32_16x16x32_bf16 v[174:177], v[114:117], v[234:237], v[174:177]
    v_mul_f32 v123, v126, v123
    v_cvt_pk_bf16_f32 v122, v122, v123
    v_mfma_f32_16x16x32_bf16 v[218:221], v[162:165], v[230:233], v[218:221]
    v_mul_f32 v124, v126, v124
    v_mul_f32 v125, v126, v125
    v_mfma_f32_16x16x32_bf16 v[114:117], a[72:75], v[182:185], 0
    v_cvt_pk_bf16_f32 v123, v124, v125
    v_mul_f32 v170, v126, v170
    v_mfma_f32_16x16x32_bf16 v[114:117], a[76:79], v[198:201], v[114:117]
    v_mul_f32 v171, v126, v171
    v_cvt_pk_bf16_f32 v124, v170, v171
    v_mfma_f32_16x16x32_bf16 v[114:117], a[80:83], v[210:213], v[114:117]
    v_mul_f32 v172, v126, v172
    v_mul_f32 v173, v126, v173
    v_mfma_f32_16x16x32_bf16 v[114:117], a[84:87], v[222:225], v[114:117]
    v_cvt_pk_bf16_f32 v125, v172, v173
    v_mul_f32 v174, v126, v174
    v_mfma_f32_16x16x32_bf16 v[114:117], a[88:91], v[226:229], v[114:117]
    ds_write_b128 v3, v[122:125] offset:12288
    v_mfma_f32_16x16x32_bf16 v[114:117], a[92:95], v[242:245], v[114:117]
    v_mul_f32 v175, v126, v175
    v_cvt_pk_bf16_f32 v174, v174, v175
    v_mfma_f32_16x16x32_bf16 v[122:125], a[96:99], v[182:185], 0
    v_mul_f32 v176, v126, v176
    v_mul_f32 v177, v126, v177
    v_mfma_f32_16x16x32_bf16 v[122:125], a[100:103], v[198:201], v[122:125]
    v_cvt_pk_bf16_f32 v175, v176, v177
    v_fmac_f32 v254, v149, v149
    v_mfma_f32_16x16x32_bf16 v[122:125], a[104:107], v[210:213], v[122:125]
    ds_write_b64 v4, v[174:175] offset:16384
    v_mfma_f32_16x16x32_bf16 v[122:125], a[108:111], v[222:225], v[122:125]
    v_fmac_f32 v254, v138, v138
    v_fmac_f32 v254, v139, v139
    v_mfma_f32_16x16x32_bf16 v[122:125], a[112:115], v[226:229], v[122:125]
    v_fmac_f32 v254, v140, v140
    v_fmac_f32 v254, v141, v141
    v_mfma_f32_16x16x32_bf16 v[122:125], a[116:119], v[242:245], v[122:125]
    v_fmac_f32 v254, v186, v186
    v_fmac_f32 v254, v187, v187
    v_mfma_f32_16x16x32_bf16 v[126:129], a[120:123], v[182:185], 0
    v_fmac_f32 v254, v188, v188
    v_fmac_f32 v254, v189, v189
    v_mfma_f32_16x16x32_bf16 v[126:129], a[124:127], v[198:201], v[126:129]
    v_cvt_pk_bf16_f32 v155, v254, v254
    v_fmac_f32 v255, v153, v153
    v_mfma_f32_16x16x32_bf16 v[126:129], a[128:131], v[210:213], v[126:129]
    v_rcp_f32 v206, v206
    v_mfma_f32_16x16x32_bf16 v[126:129], a[132:135], v[222:225], v[126:129]
    v_mul_f32 v154, v154, v206
    v_mul_f32_dpp v154, v134, v206 quad_perm:[0,1,2,3] row_mask:0x2 bank_mask:0xf
    v_mfma_f32_16x16x32_bf16 v[126:129], a[136:139], v[226:229], v[126:129]
    v_mul_f32_dpp v154, v218, v206 quad_perm:[0,1,2,3] row_mask:0x4 bank_mask:0xf
    v_cvt_pk_bf16_f32 v154, v154, v154
    v_mfma_f32_16x16x32_bf16 v[126:129], a[140:143], v[242:245], v[126:129]
    ds_write_b16 v7, v154
    v_mfma_f32_16x16x32_bf16 v[206:209], a[0:3], v[182:185], 0
    v_fmac_f32 v255, v190, v190
    v_fmac_f32 v255, v191, v191
    v_mfma_f32_16x16x32_bf16 v[206:209], a[4:7], v[198:201], v[206:209]
    v_fmac_f32 v255, v192, v192
    v_fmac_f32 v255, v193, v193
    v_mfma_f32_16x16x32_bf16 v[206:209], a[8:11], v[210:213], v[206:209]
    v_fmac_f32 v255, v202, v202
    v_fmac_f32 v255, v203, v203
    v_mfma_f32_16x16x32_bf16 v[206:209], a[12:15], v[222:225], v[206:209]
    v_fmac_f32 v255, v204, v204
    v_fmac_f32 v255, v205, v205
    v_mfma_f32_16x16x32_bf16 v[206:209], a[16:19], v[226:229], v[206:209]
    v_fma_f32 v254, v142, v142, s33
    v_fmac_f32 v254, v143, v143
    v_mfma_f32_16x16x32_bf16 v[206:209], a[20:23], v[242:245], v[206:209]
    v_fmac_f32 v254, v144, v144
    v_fmac_f32 v254, v145, v145
    v_mfma_f32_16x16x32_bf16 v[174:177], a[24:27], v[182:185], 0
    v_fmac_f32 v254, v158, v158
    v_fmac_f32 v254, v159, v159
    v_mfma_f32_16x16x32_bf16 v[174:177], a[28:31], v[198:201], v[174:177]
    v_fmac_f32 v254, v160, v160
    v_fmac_f32 v254, v161, v161
    v_mfma_f32_16x16x32_bf16 v[174:177], a[32:35], v[210:213], v[174:177]
    v_fmac_f32 v254, v178, v178
    v_fmac_f32 v254, v179, v179
    v_mfma_f32_16x16x32_bf16 v[174:177], a[36:39], v[222:225], v[174:177]
    v_fmac_f32 v254, v180, v180
    v_fmac_f32 v254, v181, v181
    v_mfma_f32_16x16x32_bf16 v[174:177], a[40:43], v[226:229], v[174:177]
    v_cvt_pk_bf16_f32 v154, v255, v254
    v_add_u32 v5, 336, v5
    v_mfma_f32_16x16x32_bf16 v[174:177], a[44:47], v[242:245], v[174:177]
    ds_write_b64 v4, v[154:155] offset:18432
    v_mfma_f32_16x16x32_bf16 v[218:221], a[48:51], v[182:185], 0
    v_add_u32 v6, 272, v6
    v_add_u32 v7, 16, v7
    v_mfma_f32_16x16x32_bf16 v[218:221], a[52:55], v[198:201], v[218:221]
    v_fma_f32 v130, v114, v114, s32
    v_fmac_f32 v130, v115, v115
    v_mfma_f32_16x16x32_bf16 v[218:221], a[56:59], v[210:213], v[218:221]
    v_fmac_f32 v130, v116, v116
    v_fmac_f32 v130, v117, v117
    v_mfma_f32_16x16x32_bf16 v[218:221], a[60:63], v[222:225], v[218:221]
    v_fmac_f32 v130, v122, v122
    v_fmac_f32 v130, v123, v123
    v_mfma_f32_16x16x32_bf16 v[218:221], a[64:67], v[226:229], v[218:221]
    v_fmac_f32 v130, v124, v124
    v_fmac_f32 v130, v125, v125
    v_mfma_f32_16x16x32_bf16 v[218:221], a[68:71], v[242:245], v[218:221]
    v_fmac_f32 v130, v126, v126
    v_fmac_f32 v130, v127, v127
    v_mfma_f32_16x16x32_bf16 v[170:173], v[182:185], a[144:147], 0
    s_waitcnt lgkmcnt(0)
    v_fmac_f32 v130, v128, v128
    v_fmac_f32 v130, v129, v129
    v_mfma_f32_16x16x32_bf16 v[170:173], v[198:201], a[148:151], v[170:173]
    s_nop 0
    v_fma_f32 v131, v206, v206, s32
    v_fmac_f32 v131, v207, v207
    v_mfma_f32_16x16x32_bf16 v[170:173], v[210:213], a[152:155], v[170:173]
    s_barrier
    v_fmac_f32 v131, v208, v208
    v_fmac_f32 v131, v209, v209
    v_mfma_f32_16x16x32_bf16 v[170:173], v[222:225], a[156:159], v[170:173]
    s_nop 0
    v_fmac_f32 v131, v174, v174
    v_xor_b32 v2, 65536, v2
    v_mfma_f32_16x16x32_bf16 v[170:173], v[226:229], a[160:163], v[170:173]
    s_nop 0
    v_xor_b32 v3, 65536, v3
    v_xor_b32 v4, 65536, v4
    v_mfma_f32_16x16x32_bf16 v[170:173], v[242:245], a[164:167], v[170:173]
    s_cbranch_scc1 L_loop_safe1
    s_branch L_drain
.p2align 6
L_loop_safe2:
    v_mfma_f32_16x16x32_bf16 v[162:165], v[182:185], a[168:171], 0
    s_add_u32 s12, s42, s27
    ds_read_b128 v[194:197], v2 offset:18432
    ds_read_b128 v[230:233], v2 offset:19456
    v_mfma_f32_16x16x32_bf16 v[162:165], v[198:201], a[172:175], v[162:165]
    s_addc_u32 s13, s43, 0
    v_fmac_f32 v131, v175, v175
    v_fmac_f32 v131, v176, v176
    v_mfma_f32_16x16x32_bf16 v[162:165], v[210:213], a[176:179], v[162:165]
    s_sub_u32 s14, s36, s27
    v_fmac_f32 v131, v177, v177
    v_fmac_f32 v131, v218, v218
    v_mfma_f32_16x16x32_bf16 v[162:165], v[222:225], a[180:183], v[162:165]
    s_cmp_ge_u32 s18, 2
    v_fmac_f32 v131, v219, v219
    v_fmac_f32 v131, v220, v220
    v_mfma_f32_16x16x32_bf16 v[162:165], v[226:229], a[184:187], v[162:165]
    s_cselect_b32 s14, s14, 0
    ds_read_b128 v[118:121], v0 offset:26624
    v_fmac_f32 v131, v221, v221
    v_mfma_f32_16x16x32_bf16 v[162:165], v[242:245], a[188:191], v[162:165]
    s_add_u32 s34, s18, 2
    ds_read_b128 v[134:137], v1 offset:26624
    v_cvt_pk_bf16_f32 v36, v131, v130
    v_mfma_f32_16x16x32_bf16 v[214:217], v[182:185], a[192:195], 0
    s_add_u32 s8, s40, s23
    ds_read_b128 v[154:157], v0 offset:26752
    v_cvt_pk_bf16_f32 v170, v170, v171
    v_mfma_f32_16x16x32_bf16 v[214:217], v[198:201], a[196:199], v[214:217]
    s_addc_u32 s9, s41, 0
    ds_read_b128 v[198:201], v1 offset:26752
    v_cvt_pk_bf16_f32 v171, v172, v173
    v_mfma_f32_16x16x32_bf16 v[166:169], v[32:35], v[36:39], 0
    s_sub_u32 s10, s36, s23
    v_cvt_pk_bf16_f32 v130, v162, v163
    v_cvt_pk_bf16_f32 v131, v164, v165
    v_mfma_f32_16x16x32_bf16 v[214:217], v[210:213], a[200:203], v[214:217]
    s_waitcnt lgkmcnt(4)
    ds_read_b128 v[210:213], v0 offset:26880
    s_cmp_lt_u32 s34, s17
    v_mfma_f32_16x16x32_bf16 v[234:237], v[32:35], v[194:197], 0
    s_cselect_b32 s10, s10, 0
    v_rsq_f32 v167, v167
    v_mfma_f32_16x16x32_bf16 v[234:237], v[32:35], v[230:233], v[234:237]
    s_add_u32 m0, s28, 0
    v_rsq_f32 v166, v166
    v_mfma_f32_16x16x32_bf16 v[214:217], v[222:225], a[204:207], v[214:217]
    s_waitcnt lgkmcnt(4)
    ds_read_b128 v[162:165], v1 offset:26880
    v_mul_f32 v166, s31, v166
    v_mfma_f32_16x16x32_bf16 v[214:217], v[226:229], a[208:211], v[214:217]
    s_mov_b32 s27, s26
    v_mul_f32 v114, v167, v114
    v_mul_f32 v115, v167, v115
    v_mfma_f32_16x16x32_bf16 v[214:217], v[242:245], a[212:215], v[214:217]
    s_mov_b32 s26, s25
    v_cvt_pk_f16_f32 v242, v114, v115
    v_mul_f32 v116, v167, v116
    v_mfma_f32_16x16x32_bf16 v[226:229], a[72:75], v[118:121], 0
    s_waitcnt lgkmcnt(2)
    v_mul_f32 v117, v167, v117
    v_cvt_pk_f16_f32 v243, v116, v117
    v_mfma_f32_16x16x32_bf16 v[226:229], a[76:79], v[134:137], v[226:229]
    s_mov_b32 s25, s24
    v_cvt_pk_bf16_f32 v114, v214, v215
    v_cvt_pk_bf16_f32 v115, v216, v217
    v_mfma_f32_16x16x32_bf16 v[226:229], a[80:83], v[154:157], v[226:229]
    s_mov_b32 s24, s23
    v_mul_f32 v122, v167, v122
    v_mul_f32 v123, v167, v123
    v_mfma_f32_16x16x32_bf16 v[226:229], a[84:87], v[198:201], v[226:229]
    s_waitcnt lgkmcnt(1)
    v_cvt_pk_f16_f32 v244, v122, v123
    v_mul_f32 v124, v167, v124
    v_mfma_f32_16x16x32_bf16 v[226:229], a[88:91], v[210:213], v[226:229]
    v_mul_f32 v125, v167, v125
    v_cvt_pk_f16_f32 v245, v124, v125
    v_mfma_f32_16x16x32_bf16 v[122:125], a[96:99], v[118:121], 0
    s_waitcnt lgkmcnt(0)
    v_mul_f32 v126, v167, v126
    v_mul_f32 v127, v167, v127
    v_mfma_f32_16x16x32_bf16 v[226:229], a[92:95], v[162:165], v[226:229]
    v_cvt_pk_f16_f32 v184, v126, v127
    v_mul_f32 v128, v167, v128
    v_mfma_f32_16x16x32_bf16 v[122:125], a[100:103], v[134:137], v[122:125]
    v_mul_f32 v129, v167, v129
    v_cvt_pk_f16_f32 v185, v128, v129
    v_mfma_f32_16x16x32_bf16 v[122:125], a[104:107], v[154:157], v[122:125]
    v_mul_f32 v206, v166, v206
    v_mul_f32 v207, v166, v207
    v_mfma_f32_16x16x32_bf16 v[122:125], a[108:111], v[198:201], v[122:125]
    v_cvt_pk_f16_f32 v222, v206, v207
    v_mul_f32 v208, v166, v208
    v_mfma_f32_16x16x32_bf16 v[122:125], a[112:115], v[210:213], v[122:125]
    v_mul_f32 v209, v166, v209
    v_cvt_pk_f16_f32 v223, v208, v209
    v_mfma_f32_16x16x32_bf16 v[122:125], a[116:119], v[162:165], v[122:125]
    v_mul_f32 v174, v166, v174
    v_mul_f32 v175, v166, v175
    v_mfma_f32_16x16x32_bf16 v[126:129], a[120:123], v[118:121], 0
    v_cvt_pk_f16_f32 v224, v174, v175
    v_mul_f32 v176, v166, v176
    v_mfma_f32_16x16x32_bf16 v[126:129], a[124:127], v[134:137], v[126:129]
    v_mul_f32 v177, v166, v177
    v_cvt_pk_f16_f32 v225, v176, v177
    v_mfma_f32_16x16x32_bf16 v[126:129], a[128:131], v[154:157], v[126:129]
    v_mul_f32 v218, v166, v218
    v_mul_f32 v219, v166, v219
    v_mfma_f32_16x16x32_bf16 v[126:129], a[132:135], v[198:201], v[126:129]
    v_cvt_pk_f16_f32 v182, v218, v219
    v_mul_f32 v220, v166, v220
    v_mfma_f32_16x16x32_bf16 v[126:129], a[136:139], v[210:213], v[126:129]
    v_mul_f32 v221, v166, v221
    v_cvt_pk_f16_f32 v183, v220, v221
    v_mfma_f32_16x16x32_bf16 v[126:129], a[140:143], v[162:165], v[126:129]
    v_fma_f32 v116, v226, v226, s32
    v_fmac_f32 v116, v227, v227
    v_mfma_f32_16x16x32_bf16 v[206:209], a[0:3], v[118:121], 0
    v_fmac_f32 v116, v228, v228
    v_fmac_f32 v116, v229, v229
    v_mfma_f32_16x16x32_bf16 v[206:209], a[4:7], v[134:137], v[206:209]
    v_fmac_f32 v116, v122, v122
    v_fmac_f32 v116, v123, v123
    v_mfma_f32_16x16x32_bf16 v[206:209], a[8:11], v[154:157], v[206:209]
    v_fmac_f32 v116, v124, v124
    v_fmac_f32 v116, v125, v125
    v_mfma_f32_16x16x32_bf16 v[206:209], a[12:15], v[198:201], v[206:209]
    v_fmac_f32 v116, v126, v126
    v_fmac_f32 v116, v127, v127
    v_mfma_f32_16x16x32_bf16 v[206:209], a[16:19], v[210:213], v[206:209]
    v_fmac_f32 v116, v128, v128
    v_fmac_f32 v116, v129, v129
    v_mfma_f32_16x16x32_bf16 v[206:209], a[20:23], v[162:165], v[206:209]
    v_mul_f32 v117, 0x3baaaaab, v234
    v_mul_f32 v254, 0x3baaaaab, v235
    v_mfma_f32_16x16x32_bf16 v[174:177], a[24:27], v[118:121], 0
    v_rsq_f32 v117, v117
    v_mfma_f32_16x16x32_bf16 v[174:177], a[28:31], v[134:137], v[174:177]
    v_rsq_f32 v254, v254
    v_mfma_f32_16x16x32_bf16 v[174:177], a[32:35], v[154:157], v[174:177]
    v_mul_f32 v255, 0x3baaaaab, v236
    v_fma_f32 v132, v206, v206, s32
    v_mfma_f32_16x16x32_bf16 v[174:177], a[36:39], v[198:201], v[174:177]
    v_fmac_f32 v132, v207, v207
    v_fmac_f32 v132, v208, v208
    v_mfma_f32_16x16x32_bf16 v[174:177], a[40:43], v[210:213], v[174:177]
    v_fmac_f32 v132, v209, v209
    v_mul_f32 v150, v117, v150
    v_mfma_f32_16x16x32_bf16 v[174:177], a[44:47], v[162:165], v[174:177]
    v_rsq_f32 v255, v255
    v_mfma_f32_16x16x32_bf16 v[218:221], a[48:51], v[118:121], 0
    v_mul_f32 v151, v117, v151
    v_cvt_pk_bf16_f32 v194, v150, v151
    v_mfma_f32_16x16x32_bf16 v[218:221], a[52:55], v[134:137], v[218:221]
    v_mul_f32 v152, v117, v152
    v_mul_f32 v153, v117, v153
    v_mfma_f32_16x16x32_bf16 v[218:221], a[56:59], v[154:157], v[218:221]
    v_fmac_f32 v132, v174, v174
    v_fmac_f32 v132, v175, v175
    v_mfma_f32_16x16x32_bf16 v[218:221], a[60:63], v[198:201], v[218:221]
    v_fmac_f32 v132, v176, v176
    v_fmac_f32 v132, v177, v177
    v_mfma_f32_16x16x32_bf16 v[218:221], a[64:67], v[210:213], v[218:221]
    v_cvt_pk_bf16_f32 v195, v152, v153
    v_mul_f32 v190, v117, v190
    v_mfma_f32_16x16x32_bf16 v[218:221], a[68:71], v[162:165], v[218:221]
    v_mul_f32 v191, v117, v191
    v_cvt_pk_bf16_f32 v196, v190, v191
    v_mfma_f32_16x16x32_bf16 v[150:153], v[118:121], a[144:147], 0
    v_mul_f32 v192, v117, v192
    v_mul_f32 v193, v117, v193
    v_mfma_f32_16x16x32_bf16 v[150:153], v[134:137], a[148:151], v[150:153]
    v_cvt_pk_bf16_f32 v197, v192, v193
    v_mul_f32 v202, v117, v202
    v_mfma_f32_16x16x32_bf16 v[150:153], v[154:157], a[152:155], v[150:153]
    buffer_store_dwordx4 v[194:197], v15, s[12:15], 0 offen
    v_fmac_f32 v132, v218, v218
    v_fmac_f32 v132, v219, v219
    v_fmac_f32 v132, v220, v220
    v_fmac_f32 v132, v221, v221
    v_mfma_f32_16x16x32_bf16 v[150:153], v[198:201], a[156:159], v[150:153]
    v_cvt_pk_bf16_f32 v36, v132, v116
    v_mul_f32 v203, v117, v203
    v_mfma_f32_16x16x32_bf16 v[150:153], v[210:213], a[160:163], v[150:153]
    v_cvt_pk_bf16_f32 v116, v202, v203
    v_mul_f32 v204, v117, v204
    v_mfma_f32_16x16x32_bf16 v[190:193], v[32:35], v[36:39], 0
    v_mul_f32 v205, v117, v205
    v_cvt_pk_bf16_f32 v117, v204, v205
    v_mfma_f32_16x16x32_bf16 v[150:153], v[162:165], a[164:167], v[150:153]
    v_mul_f32 v146, v255, v146
    v_mul_f32 v147, v255, v147
    v_mfma_f32_16x16x32_bf16 v[202:205], v[118:121], a[168:171], 0
    v_cvt_pk_bf16_f32 v146, v146, v147
    v_mul_f32 v148, v255, v148
    v_mfma_f32_16x16x32_bf16 v[202:205], v[134:137], a[172:175], v[202:205]
    v_rsq_f32 v191, v191
    v_mfma_f32_16x16x32_bf16 v[202:205], v[154:157], a[176:179], v[202:205]
    v_cvt_pk_bf16_f32 v172, v150, v151
    v_cvt_pk_bf16_f32 v173, v152, v153
    v_mfma_f32_16x16x32_bf16 v[202:205], v[198:201], a[180:183], v[202:205]
    v_rsq_f32 v190, v190
    v_mfma_f32_16x16x32_bf16 v[202:205], v[210:213], a[184:187], v[202:205]
    ds_read_b128 v[150:153], v0 offset:32768
    v_mul_f32 v190, s31, v190
    v_mfma_f32_16x16x32_bf16 v[202:205], v[162:165], a[188:191], v[202:205]
    ds_read_b128 v[166:169], v1 offset:32768
    v_mul_f32 v226, v191, v226
    v_mfma_f32_16x16x32_bf16 v[194:197], v[118:121], a[192:195], 0
    ds_read_b128 v[118:121], v0 offset:32896
    v_mul_f32 v227, v191, v227
    v_mfma_f32_16x16x32_bf16 v[194:197], v[134:137], a[196:199], v[194:197]
    ds_read_b128 v[134:137], v1 offset:32896
    v_cvt_pk_f16_f32 v226, v226, v227
    v_mfma_f32_16x16x32_bf16 v[194:197], v[154:157], a[200:203], v[194:197]
    ds_read_b128 v[154:157], v0 offset:33024
    v_cvt_pk_bf16_f32 v132, v202, v203
    v_mfma_f32_16x16x32_bf16 v[194:197], v[198:201], a[204:207], v[194:197]
    ds_read_b128 v[198:201], v1 offset:33024
    v_cvt_pk_bf16_f32 v133, v204, v205
    v_mfma_f32_16x16x32_bf16 v[194:197], v[210:213], a[208:211], v[194:197]
    v_mul_f32 v228, v191, v228
    v_mul_f32 v229, v191, v229
    v_mfma_f32_16x16x32_bf16 v[194:197], v[162:165], a[212:215], v[194:197]
    v_cvt_pk_f16_f32 v227, v228, v229
    v_mul_f32 v122, v191, v122
    v_mfma_f32_16x16x32_f16 v[210:213], v[242:245], v[222:225], v[46:49]
    s_waitcnt lgkmcnt(5)
    buffer_store_dwordx2 v[116:117], v18, s[12:15], 0 offen
    v_mul_f32 v123, v191, v123
    v_cvt_pk_f16_f32 v228, v122, v123
    v_mfma_f32_16x16x32_bf16 v[202:205], a[72:75], v[150:153], 0
    s_waitcnt lgkmcnt(3)
    v_cvt_pk_bf16_f32 v116, v194, v195
    v_cvt_pk_bf16_f32 v117, v196, v197
    v_mfma_f32_16x16x32_bf16 v[202:205], a[76:79], v[166:169], v[202:205]
    s_waitcnt lgkmcnt(2)
    v_mul_f32 v124, v191, v124
    v_mul_f32 v125, v191, v125
    v_mfma_f32_16x16x32_bf16 v[202:205], a[80:83], v[118:121], v[202:205]
    s_waitcnt lgkmcnt(1)
    v_cvt_pk_f16_f32 v229, v124, v125
    v_mul_f32 v126, v191, v126
    v_mfma_f32_16x16x32_bf16 v[202:205], a[84:87], v[134:137], v[202:205]
    s_waitcnt lgkmcnt(0)
    v_mul_f32 v127, v191, v127
    v_cvt_pk_f16_f32 v124, v126, v127
    v_mfma_f32_16x16x32_bf16 v[202:205], a[88:91], v[154:157], v[202:205]
    v_mul_f32 v128, v191, v128
    v_mul_f32 v129, v191, v129
    v_mfma_f32_16x16x32_bf16 v[202:205], a[92:95], v[198:201], v[202:205]
    v_cvt_pk_f16_f32 v125, v128, v129
    v_mul_f32 v206, v190, v206
    v_mfma_f32_16x16x32_bf16 v[126:129], a[96:99], v[150:153], 0
    v_mul_f32 v207, v190, v207
    v_cvt_pk_f16_f32 v206, v206, v207
    v_mfma_f32_16x16x32_bf16 v[126:129], a[100:103], v[166:169], v[126:129]
    v_mul_f32 v208, v190, v208
    v_mul_f32 v209, v190, v209
    v_mfma_f32_16x16x32_bf16 v[126:129], a[104:107], v[118:121], v[126:129]
    v_cvt_pk_f16_f32 v207, v208, v209
    v_mul_f32 v174, v190, v174
    v_mfma_f32_16x16x32_bf16 v[126:129], a[108:111], v[134:137], v[126:129]
    v_mul_f32 v175, v190, v175
    v_cvt_pk_f16_f32 v208, v174, v175
    v_mfma_f32_16x16x32_bf16 v[126:129], a[112:115], v[154:157], v[126:129]
    v_mul_f32 v176, v190, v176
    v_mul_f32 v177, v190, v177
    v_mfma_f32_16x16x32_bf16 v[126:129], a[116:119], v[198:201], v[126:129]
    v_cvt_pk_f16_f32 v209, v176, v177
    v_mul_f32 v218, v190, v218
    v_mfma_f32_16x16x32_bf16 v[174:177], a[120:123], v[150:153], 0
    v_mul_f32 v219, v190, v219
    v_cvt_pk_f16_f32 v122, v218, v219
    v_mfma_f32_16x16x32_bf16 v[174:177], a[124:127], v[166:169], v[174:177]
    v_mul_f32 v220, v190, v220
    v_mul_f32 v221, v190, v221
    v_mfma_f32_16x16x32_bf16 v[174:177], a[128:131], v[118:121], v[174:177]
    v_cvt_pk_f16_f32 v123, v220, v221
    v_fma_f32 v162, v202, v202, s32
    v_mfma_f32_16x16x32_bf16 v[174:177], a[132:135], v[134:137], v[174:177]
    v_fmac_f32 v162, v203, v203
    v_fmac_f32 v162, v204, v204
    v_mfma_f32_16x16x32_bf16 v[174:177], a[136:139], v[154:157], v[174:177]
    v_fmac_f32 v162, v205, v205
    v_fmac_f32 v162, v126, v126
    v_mfma_f32_16x16x32_bf16 v[174:177], a[140:143], v[198:201], v[174:177]
    v_fmac_f32 v162, v127, v127
    v_fmac_f32 v162, v128, v128
    v_mfma_f32_16x16x32_bf16 v[190:193], a[0:3], v[150:153], 0
    v_fmac_f32 v162, v129, v129
    v_mul_f32 v149, v255, v149
    v_mfma_f32_16x16x32_bf16 v[190:193], a[4:7], v[166:169], v[190:193]
    v_cvt_pk_bf16_f32 v147, v148, v149
    v_mul_f32 v138, v255, v138
    v_mfma_f32_16x16x32_bf16 v[190:193], a[8:11], v[118:121], v[190:193]
    v_fmac_f32 v162, v174, v174
    v_fmac_f32 v162, v175, v175
    v_mfma_f32_16x16x32_bf16 v[190:193], a[12:15], v[134:137], v[190:193]
    v_fmac_f32 v162, v176, v176
    v_fmac_f32 v162, v177, v177
    v_mfma_f32_16x16x32_bf16 v[190:193], a[16:19], v[154:157], v[190:193]
    v_mul_f32 v139, v255, v139
    v_cvt_pk_bf16_f32 v148, v138, v139
    v_mfma_f32_16x16x32_bf16 v[190:193], a[20:23], v[198:201], v[190:193]
    v_mul_f32 v140, v255, v140
    v_mul_f32 v141, v255, v141
    v_mfma_f32_16x16x32_bf16 v[218:221], a[24:27], v[150:153], 0
    v_cvt_pk_bf16_f32 v149, v140, v141
    v_mul_f32 v186, v255, v186
    v_mfma_f32_16x16x32_bf16 v[218:221], a[28:31], v[166:169], v[218:221]
    buffer_store_dwordx4 v[146:149], v17, s[12:15], 0 offen
    v_mul_f32 v187, v255, v187
    v_fma_f32 v163, v190, v190, s32
    v_fmac_f32 v163, v191, v191
    v_fmac_f32 v163, v192, v192
    v_mfma_f32_16x16x32_bf16 v[218:221], a[32:35], v[118:121], v[218:221]
    v_fmac_f32 v163, v193, v193
    v_cvt_pk_bf16_f32 v164, v186, v187
    v_mfma_f32_16x16x32_bf16 v[218:221], a[36:39], v[134:137], v[218:221]
    v_mul_f32 v188, v255, v188
    v_mul_f32 v189, v255, v189
    v_mfma_f32_16x16x32_bf16 v[218:221], a[40:43], v[154:157], v[218:221]
    v_cvt_pk_bf16_f32 v165, v188, v189
    v_mul_f32 v142, v254, v142
    v_mfma_f32_16x16x32_bf16 v[218:221], a[44:47], v[198:201], v[218:221]
    v_mul_f32 v143, v254, v143
    v_cvt_pk_bf16_f32 v142, v142, v143
    v_mfma_f32_16x16x32_bf16 v[138:141], a[48:51], v[150:153], 0
    v_mul_f32 v144, v254, v144
    v_mul_f32 v145, v254, v145
    v_mfma_f32_16x16x32_bf16 v[138:141], a[52:55], v[166:169], v[138:141]
    v_cvt_pk_bf16_f32 v143, v144, v145
    v_mul_f32 v158, v254, v158
    v_mfma_f32_16x16x32_bf16 v[138:141], a[56:59], v[118:121], v[138:141]
    v_fmac_f32 v163, v218, v218
    v_fmac_f32 v163, v219, v219
    v_mfma_f32_16x16x32_bf16 v[138:141], a[60:63], v[134:137], v[138:141]
    ds_read2_b32 v[196:197], v6 offset0:0 offset1:0
    ds_read2_b32 v[216:217], v6 offset0:16 offset1:16
    v_mfma_f32_16x16x32_bf16 v[138:141], a[64:67], v[154:157], v[138:141]
    ds_read2_b32 v[232:233], v6 offset0:32 offset1:32
    v_fmac_f32 v163, v220, v220
    v_mfma_f32_16x16x32_bf16 v[138:141], a[68:71], v[198:201], v[138:141]
    v_fmac_f32 v163, v221, v221
    v_mul_f32 v159, v254, v159
    v_mfma_f32_16x16x32_bf16 v[146:149], v[150:153], a[144:147], 0
    v_cvt_pk_bf16_f32 v144, v158, v159
    v_mul_f32 v160, v254, v160
    v_mfma_f32_16x16x32_bf16 v[146:149], v[166:169], a[148:151], v[146:149]
    v_mul_f32 v161, v254, v161
    v_cvt_pk_bf16_f32 v145, v160, v161
    v_mfma_f32_16x16x32_bf16 v[146:149], v[118:121], a[152:155], v[146:149]
    v_fmac_f32 v163, v138, v138
    v_fmac_f32 v163, v139, v139
    v_mfma_f32_16x16x32_bf16 v[146:149], v[134:137], a[156:159], v[146:149]
    v_fmac_f32 v163, v140, v140
    v_fmac_f32 v163, v141, v141
    v_mfma_f32_16x16x32_bf16 v[146:149], v[154:157], a[160:163], v[146:149]
    v_cvt_pk_bf16_f32 v36, v163, v162
    v_mul_f32 v178, v254, v178
    v_mfma_f32_16x16x32_bf16 v[146:149], v[198:201], a[164:167], v[146:149]
    s_waitcnt lgkmcnt(1)
    v_mul_f32 v179, v254, v179
    v_cvt_pk_bf16_f32 v178, v178, v179
    v_mfma_f32_16x16x32_bf16 v[158:161], v[32:35], v[36:39], 0
    s_waitcnt lgkmcnt(0)
    buffer_store_dwordx2 v[164:165], v20, s[12:15], 0 offen
    v_mul_f32 v180, v254, v180
    v_mul_f32 v181, v254, v181
    v_mfma_f32_16x16x32_bf16 v[186:189], v[150:153], a[168:171], 0
    v_cvt_pk_bf16_f32 v194, v146, v147
    v_cvt_pk_bf16_f32 v195, v148, v149
    v_mfma_f32_16x16x32_bf16 v[186:189], v[166:169], a[172:175], v[186:189]
    v_rsq_f32 v159, v159
    v_mfma_f32_16x16x32_bf16 v[186:189], v[118:121], a[176:179], v[186:189]
    v_rsq_f32 v158, v158
    v_mfma_f32_16x16x32_bf16 v[186:189], v[134:137], a[180:183], v[186:189]
    v_mul_f32 v158, s31, v158
    v_mul_f32 v202, v159, v202
    v_mfma_f32_16x16x32_bf16 v[186:189], v[154:157], a[184:187], v[186:189]
    v_mul_f32 v203, v159, v203
    v_cvt_pk_f16_f32 v146, v202, v203
    v_mfma_f32_16x16x32_bf16 v[186:189], v[198:201], a[188:191], v[186:189]
    v_mul_f32 v204, v159, v204
    v_mul_f32 v205, v159, v205
    v_mfma_f32_16x16x32_bf16 v[162:165], v[150:153], a[192:195], 0
    v_cvt_pk_f16_f32 v147, v204, v205
    v_mul_f32 v126, v159, v126
    v_mfma_f32_16x16x32_bf16 v[162:165], v[166:169], a[196:199], v[162:165]
    ds_read_b128 v[150:153], v5 offset:0
    ds_read_b128 v[202:205], v5 offset:16
    v_mfma_f32_16x16x32_bf16 v[162:165], v[118:121], a[200:203], v[162:165]
    ds_read_b128 v[118:121], v5 offset:48
    ds_read_b32 v254, v6 offset:192
    v_mfma_f32_16x16x32_bf16 v[162:165], v[134:137], a[204:207], v[162:165]
    v_cvt_pk_bf16_f32 v214, v186, v187
    v_cvt_pk_bf16_f32 v215, v188, v189
    v_mfma_f32_16x16x32_bf16 v[162:165], v[154:157], a[208:211], v[162:165]
    v_mul_f32 v127, v159, v127
    v_cvt_pk_f16_f32 v148, v126, v127
    v_mfma_f32_16x16x32_bf16 v[162:165], v[198:201], a[212:215], v[162:165]
    ds_read_b128 v[198:201], v2 offset:0
    ds_read_b128 v[186:189], v2 offset:1024
    v_mfma_f32_16x16x32_f16 v[134:137], v[226:229], v[222:225], v[50:53]
    ds_read_b128 v[154:157], v2 offset:2048
    v_mul_f32 v128, v159, v128
    v_mul_f32 v129, v159, v129
    v_mfma_f32_16x16x16_f16 v[210:213], v[184:185], v[182:183], v[210:213]
    v_cvt_pk_f16_f32 v149, v128, v129
    v_cvt_pk_bf16_f32 v230, v162, v163
    v_cvt_pk_bf16_f32 v231, v164, v165
    v_mul_f32 v174, v159, v174
    v_mfma_f32_16x16x32_f16 v[126:129], v[146:149], v[222:225], v[54:57]
    s_waitcnt lgkmcnt(5)
    v_mul_f32 v175, v159, v175
    v_cvt_pk_f16_f32 v164, v174, v175
    v_mul_f32 v176, v159, v176
    v_mfma_f32_16x16x16_f16 v[134:137], v[124:125], v[182:183], v[134:137]
    v_mul_f32 v177, v159, v177
    v_cvt_pk_f16_f32 v165, v176, v177
    v_mul_f32 v190, v158, v190
    v_mul_f32 v191, v158, v191
    v_mfma_f32_16x16x16_f16 v[126:129], v[164:165], v[182:183], v[126:129]
    v_cvt_pk_f16_f32 v174, v190, v191
    v_mul_f32 v192, v158, v192
    v_mul_f32 v193, v158, v193
    v_cvt_pk_f16_f32 v175, v192, v193
    v_mfma_f32_16x16x32_f16 v[166:169], v[150:153], v[222:225], v[22:25]
    s_waitcnt lgkmcnt(2)
    ds_read_b128 v[222:225], v2 offset:3072
    buffer_store_dwordx4 v[142:145], v16, s[12:15], 0 offen
    ds_read_b128 v[234:237], v2 offset:4096
    v_mul_f32 v218, v158, v218
    v_mul_f32 v219, v158, v219
    v_cvt_pk_f16_f32 v176, v218, v219
    v_mfma_f32_16x16x32_f16 v[166:169], v[202:205], v[242:245], v[166:169]
    s_waitcnt lgkmcnt(2)
    v_mul_f32 v220, v158, v220
    v_mul_f32 v221, v158, v221
    v_mfma_f32_16x16x32_f16 v[166:169], v[118:121], v[182:185], v[166:169]
    ds_read_b128 v[142:145], v2 offset:5120
    v_cvt_pk_f16_f32 v177, v220, v221
    v_mul_f32 v138, v158, v138
    v_mul_f32 v139, v158, v139
    v_cvt_pk_f16_f32 v162, v138, v139
    v_mfma_f32_16x16x32_f16 v[218:221], v[150:153], v[206:209], v[24:27]
    v_mul_f32 v140, v158, v140
    v_mul_f32 v141, v158, v141
    v_mfma_f32_16x16x32_f16 v[218:221], v[202:205], v[226:229], v[218:221]
    v_mov_b32_dpp v254, v167 quad_perm:[0,1,2,3] row_mask:0x1 bank_mask:0xf
    v_cvt_pk_f16_f32 v163, v140, v141
    v_mfma_f32_16x16x32_f16 v[218:221], v[118:121], v[122:125], v[218:221]
    v_max3_f32 v255, v166, v210, v211
    v_max3_f32 v255, v255, v212, v213
    v_mfma_f32_16x16x32_f16 v[238:241], v[150:153], v[174:177], v[26:29]
    s_waitcnt lgkmcnt(1)
    v_max3_f32 v255, v255, v134, v135
    v_max3_f32 v255, v255, v136, v137
    v_mfma_f32_16x16x32_f16 v[238:241], v[202:205], v[146:149], v[238:241]
    v_max3_f32 v255, v255, v126, v127
    v_mov_b32_dpp v254, v219 quad_perm:[0,1,2,3] row_mask:0x2 bank_mask:0xf
    v_mfma_f32_16x16x32_f16 v[238:241], v[118:121], v[162:165], v[238:241]
    v_max3_f32 v255, v255, v128, v129
    v_mov_b32 v182, v255
    v_mfma_f32_16x16x32_bf16 v[150:153], a[216:219], v[198:201], 0
    s_waitcnt lgkmcnt(0)
    v_permlane32_swap_b32 v255, v182
    v_mfma_f32_16x16x32_bf16 v[150:153], a[220:223], v[186:189], v[150:153]
    v_max_f32 v255, v255, v182
    v_mov_b32 v182, v255
    v_mfma_f32_16x16x32_bf16 v[150:153], a[224:227], v[154:157], v[150:153]
    v_cvt_pk_bf16_f32 v179, v180, v181
    v_xor_b32 v0, 65536, v0
    v_mfma_f32_16x16x32_bf16 v[150:153], a[228:231], v[222:225], v[150:153]
    s_waitcnt vmcnt(5)
    v_permlane16_swap_b32 v255, v182
    v_mfma_f32_16x16x32_bf16 v[150:153], a[232:235], v[234:237], v[150:153]
    s_nop 0
    v_max_f32 v255, v255, v182
    v_sub_f32 v210, v210, v255
    v_mfma_f32_16x16x32_bf16 v[150:153], a[236:239], v[142:145], v[150:153]
    s_nop 0
    v_exp_f32 v210, v210
    v_mfma_f32_16x16x32_bf16 v[190:193], a[240:243], v[198:201], 0
    s_barrier
    v_sub_f32 v211, v211, v255
    v_sub_f32 v212, v212, v255
    v_mfma_f32_16x16x32_bf16 v[190:193], a[244:247], v[186:189], v[190:193]
    s_nop 0
    buffer_load_dwordx4 v10, s[8:11], 0 offen lds
    v_sub_f32 v213, v213, v255
    v_mfma_f32_16x16x32_bf16 v[190:193], a[248:251], v[154:157], v[190:193]
    s_add_u32 m0, s28, 4096
    v_exp_f32 v211, v211
    v_mfma_f32_16x16x32_bf16 v[190:193], a[252:255], v[222:225], v[190:193]
    v_cvt_pk_bf16_f32 v158, v210, v211
    v_sub_f32 v134, v134, v255
    v_mfma_f32_16x16x32_bf16 v[190:193], v[82:85], v[234:237], v[190:193]
    v_exp_f32 v212, v212
    v_mfma_f32_16x16x32_bf16 v[190:193], v[86:89], v[142:145], v[190:193]
    v_exp_f32 v213, v213
    v_mfma_f32_16x16x32_bf16 v[202:205], v[90:93], v[198:201], 0
    ds_read_b128 v[198:201], v2 offset:6144
    buffer_load_dwordx4 v11, s[8:11], 0 offen lds
    v_mfma_f32_16x16x32_bf16 v[202:205], v[94:97], v[186:189], v[202:205]
    s_add_u32 m0, s28, 8192
    ds_read_b128 v[138:141], v2 offset:7168
    v_cvt_pk_bf16_f32 v159, v212, v213
    v_mfma_f32_16x16x32_bf16 v[202:205], v[98:101], v[154:157], v[202:205]
    ds_read_b128 v[210:213], v2 offset:8192
    v_sub_f32 v135, v135, v255
    v_mfma_f32_16x16x32_bf16 v[202:205], v[102:105], v[222:225], v[202:205]
    ds_read_b128 v[186:189], v2 offset:9216
    v_sub_f32 v136, v136, v255
    v_mfma_f32_16x16x32_bf16 v[202:205], v[106:109], v[234:237], v[202:205]
    ds_read_b128 v[222:225], v2 offset:10240
    v_sub_f32 v137, v137, v255
    v_mfma_f32_16x16x32_bf16 v[202:205], v[110:113], v[142:145], v[202:205]
    ds_read_b128 v[154:157], v2 offset:11264
    buffer_load_dwordx4 v12, s[8:11], 0 offen lds
    v_exp_f32 v134, v134
    v_mfma_f32_16x16x32_f16 v[118:121], v[242:245], v[206:209], v[58:61]
    s_add_u32 m0, s28, 12288
    v_exp_f32 v135, v135
    v_exp_f32 v136, v136
    v_cvt_pk_bf16_f32 v160, v134, v135
    v_exp_f32 v137, v137
    v_sub_f32 v126, v126, v255
    v_mfma_f32_16x16x16_f16 v[118:121], v[184:185], v[122:123], v[118:121]
    v_cvt_pk_bf16_f32 v161, v136, v137
    v_exp_f32 v126, v126
    v_sub_f32 v127, v127, v255
    v_mfma_f32_16x16x32_f16 v[134:137], v[226:229], v[206:209], v[62:65]
    s_xor_b32 s28, s28, 65536
    buffer_load_dwordx4 v13, s[8:11], 0 offen lds
    v_exp_f32 v127, v127
    v_sub_f32 v128, v128, v255
    v_cvt_pk_bf16_f32 v36, v126, v127
    v_exp_f32 v128, v128
    v_mfma_f32_16x16x16_f16 v[134:137], v[124:125], v[122:123], v[134:137]
    v_sub_f32 v129, v129, v255
    v_exp_f32 v129, v129
    v_sub_f32 v166, v166, v255
    v_cvt_pk_bf16_f32 v37, v128, v129
    v_mfma_f32_16x16x32_f16 v[126:129], v[146:149], v[206:209], v[66:69]
    s_waitcnt lgkmcnt(0)
    v_exp_f32 v166, v166
    v_mfma_f32_16x16x32_bf16 v[142:145], a[216:219], v[198:201], 0
    s_mov_b32 m0, s29
    v_cvt_pk_bf16_f32 v39, v166, 0
    v_max3_f32 v255, v218, v118, v119
    v_max3_f32 v255, v255, v120, v121
    v_mfma_f32_16x16x16_f16 v[126:129], v[164:165], v[122:123], v[126:129]
    v_max3_f32 v255, v255, v134, v135
    v_max3_f32 v255, v255, v136, v137
    v_xor_b32 v1, 65536, v1
    v_mov_b32_dpp v254, v239 quad_perm:[0,1,2,3] row_mask:0x4 bank_mask:0xf
    v_mfma_f32_16x16x32_bf16 v[206:209], v[28:31], v[36:39], 0
    s_xor_b32 s29, s29, s30
    buffer_store_dwordx2 v[178:179], v19, s[12:15], 0 offen
    v_mov_b32 v122, v254
    v_max3_f32 v255, v255, v126, v127
    v_mfma_f32_16x16x32_bf16 v[206:209], v[28:31], v[158:161], v[206:209]
    s_add_u32 s19, s19, s20
    v_max3_f32 v255, v255, v128, v129
    v_mov_b32 v123, v255
    v_mfma_f32_16x16x32_bf16 v[142:145], a[220:223], v[138:141], v[142:145]
    s_add_u32 s23, s23, s21
    v_permlane32_swap_b32 v255, v123
    v_mfma_f32_16x16x32_bf16 v[142:145], a[224:227], v[210:213], v[142:145]
    s_cmp_ge_u32 s19, 72
    v_rcp_f32 v206, v206
    v_mfma_f32_16x16x32_bf16 v[142:145], a[228:231], v[186:189], v[142:145]
    s_cselect_b32 s34, 72, 0
    v_max_f32 v255, v255, v123
    v_mov_b32 v123, v255
    v_mfma_f32_16x16x32_bf16 v[142:145], a[232:235], v[222:225], v[142:145]
    s_cselect_b32 s35, s22, 0
    v_permlane16_swap_b32 v255, v123
    v_mfma_f32_16x16x32_bf16 v[142:145], a[236:239], v[154:157], v[142:145]
    s_sub_u32 s19, s19, s34
    v_max_f32 v255, v255, v123
    v_sub_f32 v118, v118, v255
    v_mfma_f32_16x16x32_bf16 v[178:181], v[194:197], v[36:39], 0
    s_add_u32 s23, s23, s35
    v_exp_f32 v118, v118
    v_mfma_f32_16x16x32_bf16 v[178:181], v[170:173], v[158:161], v[178:181]
    s_add_u32 s18, s18, 1
    v_sub_f32 v119, v119, v255
    v_exp_f32 v119, v119
    v_sub_f32 v120, v120, v255
    v_cvt_pk_bf16_f32 v118, v118, v119
    v_exp_f32 v120, v120
    v_sub_f32 v121, v121, v255
    v_exp_f32 v121, v121
    v_mul_f32 v178, v206, v178
    v_mul_f32 v179, v206, v179
    v_cvt_pk_bf16_f32 v178, v178, v179
    v_mul_f32 v180, v206, v180
    v_mul_f32 v181, v206, v181
    v_cvt_pk_bf16_f32 v179, v180, v181
    v_cvt_pk_bf16_f32 v119, v120, v121
    v_mfma_f32_16x16x32_bf16 v[166:169], v[214:217], v[36:39], 0
    s_cmp_lt_u32 s18, s17
    v_sub_f32 v134, v134, v255
    v_sub_f32 v135, v135, v255
    v_mfma_f32_16x16x32_bf16 v[166:169], v[130:133], v[158:161], v[166:169]
    v_exp_f32 v134, v134
    v_exp_f32 v135, v135
    v_sub_f32 v136, v136, v255
    v_cvt_pk_bf16_f32 v120, v134, v135
    v_exp_f32 v136, v136
    v_sub_f32 v137, v137, v255
    v_exp_f32 v137, v137
    v_sub_f32 v126, v126, v255
    v_mul_f32 v166, v206, v166
    v_mul_f32 v167, v206, v167
    v_cvt_pk_bf16_f32 v180, v166, v167
    v_mul_f32 v168, v206, v168
    v_mul_f32 v169, v206, v169
    v_cvt_pk_bf16_f32 v181, v168, v169
    v_cvt_pk_bf16_f32 v121, v136, v137
    v_mfma_f32_16x16x32_bf16 v[134:137], v[230:233], v[36:39], 0
    buffer_load_dwordx4 v14, s[8:11], 0 offen lds
    v_sub_f32 v127, v127, v255
    v_mfma_f32_16x16x32_bf16 v[134:137], v[114:117], v[158:161], v[134:137]
    ds_write_b128 v3, v[178:181] offset:0
    v_mfma_f32_16x16x32_bf16 v[158:161], a[240:243], v[198:201], 0
    v_exp_f32 v126, v126
    v_mfma_f32_16x16x32_bf16 v[158:161], a[244:247], v[138:141], v[158:161]
    v_exp_f32 v127, v127
    v_mfma_f32_16x16x32_bf16 v[158:161], a[248:251], v[210:213], v[158:161]
    v_cvt_pk_bf16_f32 v36, v126, v127
    v_sub_f32 v128, v128, v255
    v_mfma_f32_16x16x32_bf16 v[158:161], a[252:255], v[186:189], v[158:161]
    v_mul_f32 v134, v206, v134
    v_mul_f32 v135, v206, v135
    v_mfma_f32_16x16x32_bf16 v[158:161], v[82:85], v[222:225], v[158:161]
    v_cvt_pk_bf16_f32 v126, v134, v135
    v_mul_f32 v136, v206, v136
    v_mfma_f32_16x16x32_bf16 v[158:161], v[86:89], v[154:157], v[158:161]
    v_mul_f32 v137, v206, v137
    v_cvt_pk_bf16_f32 v127, v136, v137
    v_mfma_f32_16x16x32_bf16 v[178:181], v[90:93], v[198:201], 0
    ds_read_b128 v[198:201], v2 offset:12288
    v_sub_f32 v129, v129, v255
    v_mfma_f32_16x16x32_bf16 v[178:181], v[94:97], v[138:141], v[178:181]
    ds_read_b128 v[206:209], v2 offset:13312
    v_sub_f32 v218, v218, v255
    v_mfma_f32_16x16x32_bf16 v[178:181], v[98:101], v[210:213], v[178:181]
    ds_read_b128 v[210:213], v2 offset:14336
    v_max_f32_dpp v122, v122, v122 quad_perm:[1,0,3,2] row_mask:0xf bank_mask:0xf
    v_mfma_f32_16x16x32_bf16 v[178:181], v[102:105], v[186:189], v[178:181]
    ds_read_b128 v[134:137], v2 offset:15360
    v_max_f32_dpp v122, v122, v122 quad_perm:[2,3,0,1] row_mask:0xf bank_mask:0xf
    v_mfma_f32_16x16x32_bf16 v[178:181], v[106:109], v[222:225], v[178:181]
    ds_read_b128 v[222:225], v2 offset:16384
    v_max_f32_dpp v122, v122, v122 row_half_mirror row_mask:0xf bank_mask:0xf
    v_mfma_f32_16x16x32_bf16 v[178:181], v[110:113], v[154:157], v[178:181]
    ds_read_b128 v[154:157], v2 offset:17408
    ds_write_b64 v4, v[126:127] offset:4096
    v_exp_f32 v128, v128
    v_exp_f32 v129, v129
    v_mfma_f32_16x16x32_f16 v[186:189], v[242:245], v[174:177], v[70:73]
    s_waitcnt lgkmcnt(6)
    v_cvt_pk_bf16_f32 v37, v128, v129
    v_max_f32_dpp v122, v122, v122 row_mirror row_mask:0xf bank_mask:0xf
    v_mfma_f32_16x16x32_f16 v[242:245], v[226:229], v[174:177], v[74:77]
    s_waitcnt lgkmcnt(5)
    v_exp_f32 v218, v218
    v_mfma_f32_16x16x32_f16 v[126:129], v[146:149], v[174:177], v[78:81]
    s_waitcnt lgkmcnt(4)
    v_cvt_pk_bf16_f32 v39, v218, 0
    v_mov_b32 v123, v122
    v_fma_f32 v255, v150, v150, s33
    v_mfma_f32_16x16x32_bf16 v[174:177], v[28:31], v[36:39], 0
    s_waitcnt lgkmcnt(3)
    v_permlane32_swap_b32 v122, v123
    v_mfma_f32_16x16x32_bf16 v[174:177], v[28:31], v[118:121], v[174:177]
    s_waitcnt lgkmcnt(2)
    v_max_f32 v122, v122, v123
    v_mov_b32 v123, v122
    v_mfma_f32_16x16x32_bf16 v[226:229], v[194:197], v[36:39], 0
    s_waitcnt lgkmcnt(0)
    v_permlane16_swap_b32 v122, v123
    v_mfma_f32_16x16x32_bf16 v[226:229], v[170:173], v[118:121], v[226:229]
    v_max_f32 v122, v122, v123
    v_sub_f32 v254, v254, v122
    v_mfma_f32_16x16x32_bf16 v[218:221], v[214:217], v[36:39], 0
    v_exp_f32 v254, v254
    v_mfma_f32_16x16x32_bf16 v[218:221], v[130:133], v[118:121], v[218:221]
    v_cvt_pk_bf16_f32 v254, v254, v254
    v_fmac_f32 v255, v151, v151
    v_mfma_f32_16x16x32_bf16 v[166:169], v[230:233], v[36:39], 0
    ds_write_b16 v8, v254
    v_mfma_f32_16x16x32_bf16 v[166:169], v[114:117], v[118:121], v[166:169]
    v_rcp_f32 v174, v174
    v_fmac_f32 v255, v152, v152
    v_mfma_f32_16x16x16_f16 v[186:189], v[184:185], v[162:163], v[186:189]
    v_mul_f32 v226, v174, v226
    v_mul_f32 v227, v174, v227
    v_cvt_pk_bf16_f32 v122, v226, v227
    v_mfma_f32_16x16x16_f16 v[242:245], v[124:125], v[162:163], v[242:245]
    v_mul_f32 v228, v174, v228
    v_mul_f32 v229, v174, v229
    v_cvt_pk_bf16_f32 v123, v228, v229
    v_mfma_f32_16x16x16_f16 v[126:129], v[164:165], v[162:163], v[126:129]
    v_max3_f32 v254, v238, v186, v187
    v_max3_f32 v254, v254, v188, v189
    v_mul_f32 v218, v174, v218
    v_mul_f32 v219, v174, v219
    v_mfma_f32_16x16x32_bf16 v[146:149], a[216:219], v[198:201], 0
    ds_read_b128 v[118:121], v9
    ds_read_b128 v[162:165], v9 offset:64
    v_mfma_f32_16x16x32_bf16 v[146:149], a[220:223], v[206:209], v[146:149]
    v_max3_f32 v254, v254, v242, v243
    v_max3_f32 v254, v254, v244, v245
    v_mfma_f32_16x16x32_bf16 v[146:149], a[224:227], v[210:213], v[146:149]
    v_max3_f32 v254, v254, v126, v127
    v_max3_f32 v254, v254, v128, v129
    v_mfma_f32_16x16x32_bf16 v[146:149], a[228:231], v[134:137], v[146:149]
    v_mov_b32 v125, v254
    v_cvt_pk_bf16_f32 v124, v218, v219
    v_mfma_f32_16x16x32_bf16 v[146:149], a[232:235], v[222:225], v[146:149]
    v_permlane32_swap_b32 v254, v125
    v_mfma_f32_16x16x32_bf16 v[146:149], a[236:239], v[154:157], v[146:149]
    v_max_f32 v254, v254, v125
    v_mov_b32 v125, v254
    v_mfma_f32_16x16x32_bf16 v[138:141], a[240:243], v[198:201], 0
    v_mul_f32 v220, v174, v220
    v_mul_f32 v221, v174, v221
    v_mfma_f32_16x16x32_bf16 v[138:141], a[244:247], v[206:209], v[138:141]
    v_permlane16_swap_b32 v254, v125
    v_mfma_f32_16x16x32_bf16 v[138:141], a[248:251], v[210:213], v[138:141]
    s_waitcnt lgkmcnt(0)
    v_max_f32 v254, v254, v125
    v_sub_f32 v186, v186, v254
    v_mfma_f32_16x16x32_bf16 v[138:141], a[252:255], v[134:137], v[138:141]
    v_exp_f32 v186, v186
    v_mfma_f32_16x16x32_bf16 v[138:141], v[82:85], v[222:225], v[138:141]
    v_sub_f32 v187, v187, v254
    v_sub_f32 v188, v188, v254
    v_mfma_f32_16x16x32_bf16 v[138:141], v[86:89], v[154:157], v[138:141]
    v_exp_f32 v187, v187
    v_exp_f32 v188, v188
    v_cvt_pk_bf16_f32 v234, v186, v187
    v_sub_f32 v189, v189, v254
    v_exp_f32 v189, v189
    v_sub_f32 v242, v242, v254
    v_cvt_pk_bf16_f32 v235, v188, v189
    v_exp_f32 v242, v242
    v_sub_f32 v243, v243, v254
    v_exp_f32 v243, v243
    v_sub_f32 v244, v244, v254
    v_cvt_pk_bf16_f32 v236, v242, v243
    v_mfma_f32_16x16x32_bf16 v[186:189], v[90:93], v[198:201], 0
    v_exp_f32 v244, v244
    v_mfma_f32_16x16x32_bf16 v[186:189], v[94:97], v[206:209], v[186:189]
    v_sub_f32 v245, v245, v254
    v_sub_f32 v126, v126, v254
    v_mfma_f32_16x16x32_bf16 v[186:189], v[98:101], v[210:213], v[186:189]
    v_exp_f32 v245, v245
    v_mfma_f32_16x16x32_bf16 v[186:189], v[102:105], v[134:137], v[186:189]
    v_cvt_pk_bf16_f32 v237, v244, v245
    v_sub_f32 v127, v127, v254
    v_mfma_f32_16x16x32_bf16 v[186:189], v[106:109], v[222:225], v[186:189]
    v_exp_f32 v126, v126
    v_mfma_f32_16x16x32_bf16 v[186:189], v[110:113], v[154:157], v[186:189]
    ds_read_b128 v[182:185], v0 offset:20480
    ds_read_b128 v[198:201], v1 offset:20480
    v_mfma_f32_16x16x32_bf16 v[206:209], v[118:121], v[28:31], 0
    ds_read_b128 v[210:213], v0 offset:20608
    ds_read_b128 v[222:225], v1 offset:20608
    v_mfma_f32_16x16x32_bf16 v[206:209], v[162:165], v[28:31], v[206:209]
    v_exp_f32 v127, v127
    v_mfma_f32_16x16x32_bf16 v[154:157], v[118:121], v[170:173], 0
    ds_read_b128 v[226:229], v0 offset:20736
    v_cvt_pk_bf16_f32 v36, v126, v127
    v_mfma_f32_16x16x32_bf16 v[154:157], v[162:165], v[194:197], v[154:157]
    ds_read_b128 v[242:245], v1 offset:20736
    v_sub_f32 v128, v128, v254
    v_exp_f32 v128, v128
    v_sub_f32 v129, v129, v254
    v_exp_f32 v129, v129
    v_sub_f32 v238, v238, v254
    v_cvt_pk_bf16_f32 v37, v128, v129
    v_mfma_f32_16x16x32_bf16 v[134:137], v[118:121], v[130:133], 0
    v_exp_f32 v238, v238
    v_mfma_f32_16x16x32_bf16 v[134:137], v[162:165], v[214:217], v[134:137]
    s_waitcnt lgkmcnt(4)
    v_cvt_pk_bf16_f32 v39, v238, 0
    v_cvt_pk_bf16_f32 v125, v220, v221
    v_mfma_f32_16x16x32_bf16 v[218:221], v[118:121], v[114:117], 0
    s_waitcnt lgkmcnt(2)
    ds_write_b128 v3, v[122:125] offset:6144
    v_mfma_f32_16x16x32_bf16 v[126:129], v[28:31], v[36:39], 0
    s_waitcnt lgkmcnt(2)
    v_mul_f32 v166, v174, v166
    v_mul_f32 v167, v174, v167
    v_mfma_f32_16x16x32_bf16 v[126:129], v[28:31], v[234:237], v[126:129]
    s_waitcnt lgkmcnt(1)
    v_cvt_pk_bf16_f32 v166, v166, v167
    v_mul_f32 v168, v174, v168
    v_mfma_f32_16x16x32_bf16 v[122:125], v[194:197], v[36:39], 0
    v_mul_f32 v169, v174, v169
    v_cvt_pk_bf16_f32 v167, v168, v169
    v_mfma_f32_16x16x32_bf16 v[122:125], v[170:173], v[234:237], v[122:125]
    ds_write_b64 v4, v[166:167] offset:10240
    v_mfma_f32_16x16x32_bf16 v[170:173], v[214:217], v[36:39], 0
    v_rcp_f32 v126, v126
    v_mfma_f32_16x16x32_bf16 v[170:173], v[130:133], v[234:237], v[170:173]
    v_fma_f32 v254, v146, v146, s33
    v_fmac_f32 v254, v147, v147
    v_mfma_f32_16x16x32_bf16 v[174:177], v[230:233], v[36:39], 0
    v_fmac_f32 v254, v148, v148
    v_mul_f32 v122, v126, v122
    v_mfma_f32_16x16x32_bf16 v[174:177], v[114:117], v[234:237], v[174:177]
    v_mul_f32 v123, v126, v123
    v_cvt_pk_bf16_f32 v122, v122, v123
    v_mfma_f32_16x16x32_bf16 v[218:221], v[162:165], v[230:233], v[218:221]
    v_mul_f32 v124, v126, v124
    v_mul_f32 v125, v126, v125
    v_mfma_f32_16x16x32_bf16 v[114:117], a[72:75], v[182:185], 0
    v_cvt_pk_bf16_f32 v123, v124, v125
    v_mul_f32 v170, v126, v170
    v_mfma_f32_16x16x32_bf16 v[114:117], a[76:79], v[198:201], v[114:117]
    v_mul_f32 v171, v126, v171
    v_cvt_pk_bf16_f32 v124, v170, v171
    v_mfma_f32_16x16x32_bf16 v[114:117], a[80:83], v[210:213], v[114:117]
    v_mul_f32 v172, v126, v172
    v_mul_f32 v173, v126, v173
    v_mfma_f32_16x16x32_bf16 v[114:117], a[84:87], v[222:225], v[114:117]
    v_cvt_pk_bf16_f32 v125, v172, v173
    v_mul_f32 v174, v126, v174
    v_mfma_f32_16x16x32_bf16 v[114:117], a[88:91], v[226:229], v[114:117]
    ds_write_b128 v3, v[122:125] offset:12288
    v_mfma_f32_16x16x32_bf16 v[114:117], a[92:95], v[242:245], v[114:117]
    v_mul_f32 v175, v126, v175
    v_cvt_pk_bf16_f32 v174, v174, v175
    v_mfma_f32_16x16x32_bf16 v[122:125], a[96:99], v[182:185], 0
    v_mul_f32 v176, v126, v176
    v_mul_f32 v177, v126, v177
    v_mfma_f32_16x16x32_bf16 v[122:125], a[100:103], v[198:201], v[122:125]
    v_cvt_pk_bf16_f32 v175, v176, v177
    v_fmac_f32 v254, v149, v149
    v_mfma_f32_16x16x32_bf16 v[122:125], a[104:107], v[210:213], v[122:125]
    ds_write_b64 v4, v[174:175] offset:16384
    v_mfma_f32_16x16x32_bf16 v[122:125], a[108:111], v[222:225], v[122:125]
    v_fmac_f32 v254, v138, v138
    v_fmac_f32 v254, v139, v139
    v_mfma_f32_16x16x32_bf16 v[122:125], a[112:115], v[226:229], v[122:125]
    v_fmac_f32 v254, v140, v140
    v_fmac_f32 v254, v141, v141
    v_mfma_f32_16x16x32_bf16 v[122:125], a[116:119], v[242:245], v[122:125]
    v_fmac_f32 v254, v186, v186
    v_fmac_f32 v254, v187, v187
    v_mfma_f32_16x16x32_bf16 v[126:129], a[120:123], v[182:185], 0
    v_fmac_f32 v254, v188, v188
    v_fmac_f32 v254, v189, v189
    v_mfma_f32_16x16x32_bf16 v[126:129], a[124:127], v[198:201], v[126:129]
    v_cvt_pk_bf16_f32 v155, v254, v254
    v_fmac_f32 v255, v153, v153
    v_mfma_f32_16x16x32_bf16 v[126:129], a[128:131], v[210:213], v[126:129]
    v_rcp_f32 v206, v206
    v_mfma_f32_16x16x32_bf16 v[126:129], a[132:135], v[222:225], v[126:129]
    v_mul_f32 v154, v154, v206
    v_mul_f32_dpp v154, v134, v206 quad_perm:[0,1,2,3] row_mask:0x2 bank_mask:0xf
    v_mfma_f32_16x16x32_bf16 v[126:129], a[136:139], v[226:229], v[126:129]
    v_mul_f32_dpp v154, v218, v206 quad_perm:[0,1,2,3] row_mask:0x4 bank_mask:0xf
    v_cvt_pk_bf16_f32 v154, v154, v154
    v_mfma_f32_16x16x32_bf16 v[126:129], a[140:143], v[242:245], v[126:129]
    ds_write_b16 v7, v154
    v_mfma_f32_16x16x32_bf16 v[206:209], a[0:3], v[182:185], 0
    v_fmac_f32 v255, v190, v190
    v_fmac_f32 v255, v191, v191
    v_mfma_f32_16x16x32_bf16 v[206:209], a[4:7], v[198:201], v[206:209]
    v_fmac_f32 v255, v192, v192
    v_fmac_f32 v255, v193, v193
    v_mfma_f32_16x16x32_bf16 v[206:209], a[8:11], v[210:213], v[206:209]
    v_fmac_f32 v255, v202, v202
    v_fmac_f32 v255, v203, v203
    v_mfma_f32_16x16x32_bf16 v[206:209], a[12:15], v[222:225], v[206:209]
    v_fmac_f32 v255, v204, v204
    v_fmac_f32 v255, v205, v205
    v_mfma_f32_16x16x32_bf16 v[206:209], a[16:19], v[226:229], v[206:209]
    v_fma_f32 v254, v142, v142, s33
    v_fmac_f32 v254, v143, v143
    v_mfma_f32_16x16x32_bf16 v[206:209], a[20:23], v[242:245], v[206:209]
    v_fmac_f32 v254, v144, v144
    v_fmac_f32 v254, v145, v145
    v_mfma_f32_16x16x32_bf16 v[174:177], a[24:27], v[182:185], 0
    v_fmac_f32 v254, v158, v158
    v_fmac_f32 v254, v159, v159
    v_mfma_f32_16x16x32_bf16 v[174:177], a[28:31], v[198:201], v[174:177]
    v_fmac_f32 v254, v160, v160
    v_fmac_f32 v254, v161, v161
    v_mfma_f32_16x16x32_bf16 v[174:177], a[32:35], v[210:213], v[174:177]
    v_fmac_f32 v254, v178, v178
    v_fmac_f32 v254, v179, v179
    v_mfma_f32_16x16x32_bf16 v[174:177], a[36:39], v[222:225], v[174:177]
    v_fmac_f32 v254, v180, v180
    v_fmac_f32 v254, v181, v181
    v_mfma_f32_16x16x32_bf16 v[174:177], a[40:43], v[226:229], v[174:177]
    v_cvt_pk_bf16_f32 v154, v255, v254
    v_add_u32 v5, 336, v5
    v_mfma_f32_16x16x32_bf16 v[174:177], a[44:47], v[242:245], v[174:177]
    ds_write_b64 v4, v[154:155] offset:18432
    v_mfma_f32_16x16x32_bf16 v[218:221], a[48:51], v[182:185], 0
    v_add_u32 v6, 272, v6
    v_add_u32 v7, 16, v7
    v_mfma_f32_16x16x32_bf16 v[218:221], a[52:55], v[198:201], v[218:221]
    v_fma_f32 v130, v114, v114, s32
    v_fmac_f32 v130, v115, v115
    v_mfma_f32_16x16x32_bf16 v[218:221], a[56:59], v[210:213], v[218:221]
    v_fmac_f32 v130, v116, v116
    v_fmac_f32 v130, v117, v117
    v_mfma_f32_16x16x32_bf16 v[218:221], a[60:63], v[222:225], v[218:221]
    v_fmac_f32 v130, v122, v122
    v_fmac_f32 v130, v123, v123
    v_mfma_f32_16x16x32_bf16 v[218:221], a[64:67], v[226:229], v[218:221]
    v_fmac_f32 v130, v124, v124
    v_fmac_f32 v130, v125, v125
    v_mfma_f32_16x16x32_bf16 v[218:221], a[68:71], v[242:245], v[218:221]
    v_fmac_f32 v130, v126, v126
    v_fmac_f32 v130, v127, v127
    v_mfma_f32_16x16x32_bf16 v[170:173], v[182:185], a[144:147], 0
    s_waitcnt lgkmcnt(0)
    v_fmac_f32 v130, v128, v128
    v_fmac_f32 v130, v129, v129
    v_mfma_f32_16x16x32_bf16 v[170:173], v[198:201], a[148:151], v[170:173]
    s_nop 0
    v_fma_f32 v131, v206, v206, s32
    v_fmac_f32 v131, v207, v207
    v_mfma_f32_16x16x32_bf16 v[170:173], v[210:213], a[152:155], v[170:173]
    s_nop 0
    v_fmac_f32 v131, v208, v208
    v_fmac_f32 v131, v209, v209
    v_mfma_f32_16x16x32_bf16 v[170:173], v[222:225], a[156:159], v[170:173]
    s_barrier
    v_fmac_f32 v131, v174, v174
    v_xor_b32 v2, 65536, v2
    v_mfma_f32_16x16x32_bf16 v[170:173], v[226:229], a[160:163], v[170:173]
    s_nop 0
    v_xor_b32 v3, 65536, v3
    v_xor_b32 v4, 65536, v4
    v_mfma_f32_16x16x32_bf16 v[170:173], v[242:245], a[164:167], v[170:173]
    s_cbranch_scc1 L_loop_safe2
    s_branch L_drain
.p2align 6
L_loop_safe3:
    v_mfma_f32_16x16x32_bf16 v[162:165], v[182:185], a[168:171], 0
    s_add_u32 s12, s42, s27
    ds_read_b128 v[194:197], v2 offset:18432
    ds_read_b128 v[230:233], v2 offset:19456
    v_mfma_f32_16x16x32_bf16 v[162:165], v[198:201], a[172:175], v[162:165]
    s_addc_u32 s13, s43, 0
    v_fmac_f32 v131, v175, v175
    v_fmac_f32 v131, v176, v176
    v_mfma_f32_16x16x32_bf16 v[162:165], v[210:213], a[176:179], v[162:165]
    s_sub_u32 s14, s36, s27
    v_fmac_f32 v131, v177, v177
    v_fmac_f32 v131, v218, v218
    v_mfma_f32_16x16x32_bf16 v[162:165], v[222:225], a[180:183], v[162:165]
    s_cmp_ge_u32 s18, 2
    v_fmac_f32 v131, v219, v219
    v_fmac_f32 v131, v220, v220
    v_mfma_f32_16x16x32_bf16 v[162:165], v[226:229], a[184:187], v[162:165]
    s_cselect_b32 s14, s14, 0
    ds_read_b128 v[118:121], v0 offset:26624
    v_fmac_f32 v131, v221, v221
    v_mfma_f32_16x16x32_bf16 v[162:165], v[242:245], a[188:191], v[162:165]
    s_add_u32 s34, s18, 2
    ds_read_b128 v[134:137], v1 offset:26624
    v_cvt_pk_bf16_f32 v36, v131, v130
    v_mfma_f32_16x16x32_bf16 v[214:217], v[182:185], a[192:195], 0
    s_add_u32 s8, s40, s23
    ds_read_b128 v[154:157], v0 offset:26752
    v_cvt_pk_bf16_f32 v170, v170, v171
    v_mfma_f32_16x16x32_bf16 v[214:217], v[198:201], a[196:199], v[214:217]
    s_addc_u32 s9, s41, 0
    ds_read_b128 v[198:201], v1 offset:26752
    v_cvt_pk_bf16_f32 v171, v172, v173
    v_mfma_f32_16x16x32_bf16 v[166:169], v[32:35], v[36:39], 0
    s_sub_u32 s10, s36, s23
    v_cvt_pk_bf16_f32 v130, v162, v163
    v_cvt_pk_bf16_f32 v131, v164, v165
    v_mfma_f32_16x16x32_bf16 v[214:217], v[210:213], a[200:203], v[214:217]
    s_waitcnt lgkmcnt(4)
    ds_read_b128 v[210:213], v0 offset:26880
    s_cmp_lt_u32 s34, s17
    v_mfma_f32_16x16x32_bf16 v[234:237], v[32:35], v[194:197], 0
    s_cselect_b32 s10, s10, 0
    v_rsq_f32 v167, v167
    v_mfma_f32_16x16x32_bf16 v[234:237], v[32:35], v[230:233], v[234:237]
    s_add_u32 m0, s28, 0
    v_rsq_f32 v166, v166
    v_mfma_f32_16x16x32_bf16 v[214:217], v[222:225], a[204:207], v[214:217]
    s_waitcnt lgkmcnt(4)
    ds_read_b128 v[162:165], v1 offset:26880
    v_mul_f32 v166, s31, v166
    v_mfma_f32_16x16x32_bf16 v[214:217], v[226:229], a[208:211], v[214:217]
    s_mov_b32 s27, s26
    v_mul_f32 v114, v167, v114
    v_mul_f32 v115, v167, v115
    v_mfma_f32_16x16x32_bf16 v[214:217], v[242:245], a[212:215], v[214:217]
    s_mov_b32 s26, s25
    v_cvt_pk_f16_f32 v242, v114, v115
    v_mul_f32 v116, v167, v116
    v_mfma_f32_16x16x32_bf16 v[226:229], a[72:75], v[118:121], 0
    s_waitcnt lgkmcnt(2)
    v_mul_f32 v117, v167, v117
    v_cvt_pk_f16_f32 v243, v116, v117
    v_mfma_f32_16x16x32_bf16 v[226:229], a[76:79], v[134:137], v[226:229]
    s_mov_b32 s25, s24
    v_cvt_pk_bf16_f32 v114, v214, v215
    v_cvt_pk_bf16_f32 v115, v216, v217
    v_mfma_f32_16x16x32_bf16 v[226:229], a[80:83], v[154:157], v[226:229]
    s_mov_b32 s24, s23
    v_mul_f32 v122, v167, v122
    v_mul_f32 v123, v167, v123
    v_mfma_f32_16x16x32_bf16 v[226:229], a[84:87], v[198:201], v[226:229]
    s_waitcnt lgkmcnt(1)
    v_cvt_pk_f16_f32 v244, v122, v123
    v_mul_f32 v124, v167, v124
    v_mfma_f32_16x16x32_bf16 v[226:229], a[88:91], v[210:213], v[226:229]
    v_mul_f32 v125, v167, v125
    v_cvt_pk_f16_f32 v245, v124, v125
    v_mfma_f32_16x16x32_bf16 v[122:125], a[96:99], v[118:121], 0
    s_waitcnt lgkmcnt(0)
    v_mul_f32 v126, v167, v126
    v_mul_f32 v127, v167, v127
    v_mfma_f32_16x16x32_bf16 v[226:229], a[92:95], v[162:165], v[226:229]
    v_cvt_pk_f16_f32 v184, v126, v127
    v_mul_f32 v128, v167, v128
    v_mfma_f32_16x16x32_bf16 v[122:125], a[100:103], v[134:137], v[122:125]
    v_mul_f32 v129, v167, v129
    v_cvt_pk_f16_f32 v185, v128, v129
    v_mfma_f32_16x16x32_bf16 v[122:125], a[104:107], v[154:157], v[122:125]
    v_mul_f32 v206, v166, v206
    v_mul_f32 v207, v166, v207
    v_mfma_f32_16x16x32_bf16 v[122:125], a[108:111], v[198:201], v[122:125]
    v_cvt_pk_f16_f32 v222, v206, v207
    v_mul_f32 v208, v166, v208
    v_mfma_f32_16x16x32_bf16 v[122:125], a[112:115], v[210:213], v[122:125]
    v_mul_f32 v209, v166, v209
    v_cvt_pk_f16_f32 v223, v208, v209
    v_mfma_f32_16x16x32_bf16 v[122:125], a[116:119], v[162:165], v[122:125]
    v_mul_f32 v174, v166, v174
    v_mul_f32 v175, v166, v175
    v_mfma_f32_16x16x32_bf16 v[126:129], a[120:123], v[118:121], 0
    v_cvt_pk_f16_f32 v224, v174, v175
    v_mul_f32 v176, v166, v176
    v_mfma_f32_16x16x32_bf16 v[126:129], a[124:127], v[134:137], v[126:129]
    v_mul_f32 v177, v166, v177
    v_cvt_pk_f16_f32 v225, v176, v177
    v_mfma_f32_16x16x32_bf16 v[126:129], a[128:131], v[154:157], v[126:129]
    v_mul_f32 v218, v166, v218
    v_mul_f32 v219, v166, v219
    v_mfma_f32_16x16x32_bf16 v[126:129], a[132:135], v[198:201], v[126:129]
    v_cvt_pk_f16_f32 v182, v218, v219
    v_mul_f32 v220, v166, v220
    v_mfma_f32_16x16x32_bf16 v[126:129], a[136:139], v[210:213], v[126:129]
    v_mul_f32 v221, v166, v221
    v_cvt_pk_f16_f32 v183, v220, v221
    v_mfma_f32_16x16x32_bf16 v[126:129], a[140:143], v[162:165], v[126:129]
    v_fma_f32 v116, v226, v226, s32
    v_fmac_f32 v116, v227, v227
    v_mfma_f32_16x16x32_bf16 v[206:209], a[0:3], v[118:121], 0
    v_fmac_f32 v116, v228, v228
    v_fmac_f32 v116, v229, v229
    v_mfma_f32_16x16x32_bf16 v[206:209], a[4:7], v[134:137], v[206:209]
    v_fmac_f32 v116, v122, v122
    v_fmac_f32 v116, v123, v123
    v_mfma_f32_16x16x32_bf16 v[206:209], a[8:11], v[154:157], v[206:209]
    v_fmac_f32 v116, v124, v124
    v_fmac_f32 v116, v125, v125
    v_mfma_f32_16x16x32_bf16 v[206:209], a[12:15], v[198:201], v[206:209]
    v_fmac_f32 v116, v126, v126
    v_fmac_f32 v116, v127, v127
    v_mfma_f32_16x16x32_bf16 v[206:209], a[16:19], v[210:213], v[206:209]
    v_fmac_f32 v116, v128, v128
    v_fmac_f32 v116, v129, v129
    v_mfma_f32_16x16x32_bf16 v[206:209], a[20:23], v[162:165], v[206:209]
    v_mul_f32 v117, 0x3baaaaab, v234
    v_mul_f32 v254, 0x3baaaaab, v235
    v_mfma_f32_16x16x32_bf16 v[174:177], a[24:27], v[118:121], 0
    v_rsq_f32 v117, v117
    v_mfma_f32_16x16x32_bf16 v[174:177], a[28:31], v[134:137], v[174:177]
    v_rsq_f32 v254, v254
    v_mfma_f32_16x16x32_bf16 v[174:177], a[32:35], v[154:157], v[174:177]
    v_mul_f32 v255, 0x3baaaaab, v236
    v_fma_f32 v132, v206, v206, s32
    v_mfma_f32_16x16x32_bf16 v[174:177], a[36:39], v[198:201], v[174:177]
    v_fmac_f32 v132, v207, v207
    v_fmac_f32 v132, v208, v208
    v_mfma_f32_16x16x32_bf16 v[174:177], a[40:43], v[210:213], v[174:177]
    v_fmac_f32 v132, v209, v209
    v_mul_f32 v150, v117, v150
    v_mfma_f32_16x16x32_bf16 v[174:177], a[44:47], v[162:165], v[174:177]
    v_rsq_f32 v255, v255
    v_mfma_f32_16x16x32_bf16 v[218:221], a[48:51], v[118:121], 0
    v_mul_f32 v151, v117, v151
    v_cvt_pk_bf16_f32 v194, v150, v151
    v_mfma_f32_16x16x32_bf16 v[218:221], a[52:55], v[134:137], v[218:221]
    v_mul_f32 v152, v117, v152
    v_mul_f32 v153, v117, v153
    v_mfma_f32_16x16x32_bf16 v[218:221], a[56:59], v[154:157], v[218:221]
    v_fmac_f32 v132, v174, v174
    v_fmac_f32 v132, v175, v175
    v_mfma_f32_16x16x32_bf16 v[218:221], a[60:63], v[198:201], v[218:221]
    v_fmac_f32 v132, v176, v176
    v_fmac_f32 v132, v177, v177
    v_mfma_f32_16x16x32_bf16 v[218:221], a[64:67], v[210:213], v[218:221]
    v_cvt_pk_bf16_f32 v195, v152, v153
    v_mul_f32 v190, v117, v190
    v_mfma_f32_16x16x32_bf16 v[218:221], a[68:71], v[162:165], v[218:221]
    v_mul_f32 v191, v117, v191
    v_cvt_pk_bf16_f32 v196, v190, v191
    v_mfma_f32_16x16x32_bf16 v[150:153], v[118:121], a[144:147], 0
    v_mul_f32 v192, v117, v192
    v_mul_f32 v193, v117, v193
    v_mfma_f32_16x16x32_bf16 v[150:153], v[134:137], a[148:151], v[150:153]
    v_cvt_pk_bf16_f32 v197, v192, v193
    v_mul_f32 v202, v117, v202
    v_mfma_f32_16x16x32_bf16 v[150:153], v[154:157], a[152:155], v[150:153]
    buffer_store_dwordx4 v[194:197], v15, s[12:15], 0 offen
    v_fmac_f32 v132, v218, v218
    v_fmac_f32 v132, v219, v219
    v_fmac_f32 v132, v220, v220
    v_fmac_f32 v132, v221, v221
    v_mfma_f32_16x16x32_bf16 v[150:153], v[198:201], a[156:159], v[150:153]
    v_cvt_pk_bf16_f32 v36, v132, v116
    v_mul_f32 v203, v117, v203
    v_mfma_f32_16x16x32_bf16 v[150:153], v[210:213], a[160:163], v[150:153]
    v_cvt_pk_bf16_f32 v116, v202, v203
    v_mul_f32 v204, v117, v204
    v_mfma_f32_16x16x32_bf16 v[190:193], v[32:35], v[36:39], 0
    v_mul_f32 v205, v117, v205
    v_cvt_pk_bf16_f32 v117, v204, v205
    v_mfma_f32_16x16x32_bf16 v[150:153], v[162:165], a[164:167], v[150:153]
    v_mul_f32 v146, v255, v146
    v_mul_f32 v147, v255, v147
    v_mfma_f32_16x16x32_bf16 v[202:205], v[118:121], a[168:171], 0
    v_cvt_pk_bf16_f32 v146, v146, v147
    v_mul_f32 v148, v255, v148
    v_mfma_f32_16x16x32_bf16 v[202:205], v[134:137], a[172:175], v[202:205]
    v_rsq_f32 v191, v191
    v_mfma_f32_16x16x32_bf16 v[202:205], v[154:157], a[176:179], v[202:205]
    v_cvt_pk_bf16_f32 v172, v150, v151
    v_cvt_pk_bf16_f32 v173, v152, v153
    v_mfma_f32_16x16x32_bf16 v[202:205], v[198:201], a[180:183], v[202:205]
    v_rsq_f32 v190, v190
    v_mfma_f32_16x16x32_bf16 v[202:205], v[210:213], a[184:187], v[202:205]
    ds_read_b128 v[150:153], v0 offset:32768
    v_mul_f32 v190, s31, v190
    v_mfma_f32_16x16x32_bf16 v[202:205], v[162:165], a[188:191], v[202:205]
    ds_read_b128 v[166:169], v1 offset:32768
    v_mul_f32 v226, v191, v226
    v_mfma_f32_16x16x32_bf16 v[194:197], v[118:121], a[192:195], 0
    ds_read_b128 v[118:121], v0 offset:32896
    v_mul_f32 v227, v191, v227
    v_mfma_f32_16x16x32_bf16 v[194:197], v[134:137], a[196:199], v[194:197]
    ds_read_b128 v[134:137], v1 offset:32896
    v_cvt_pk_f16_f32 v226, v226, v227
    v_mfma_f32_16x16x32_bf16 v[194:197], v[154:157], a[200:203], v[194:197]
    ds_read_b128 v[154:157], v0 offset:33024
    v_cvt_pk_bf16_f32 v132, v202, v203
    v_mfma_f32_16x16x32_bf16 v[194:197], v[198:201], a[204:207], v[194:197]
    ds_read_b128 v[198:201], v1 offset:33024
    v_cvt_pk_bf16_f32 v133, v204, v205
    v_mfma_f32_16x16x32_bf16 v[194:197], v[210:213], a[208:211], v[194:197]
    v_mul_f32 v228, v191, v228
    v_mul_f32 v229, v191, v229
    v_mfma_f32_16x16x32_bf16 v[194:197], v[162:165], a[212:215], v[194:197]
    v_cvt_pk_f16_f32 v227, v228, v229
    v_mul_f32 v122, v191, v122
    v_mfma_f32_16x16x32_f16 v[210:213], v[242:245], v[222:225], v[46:49]
    s_waitcnt lgkmcnt(5)
    buffer_store_dwordx2 v[116:117], v18, s[12:15], 0 offen
    v_mul_f32 v123, v191, v123
    v_cvt_pk_f16_f32 v228, v122, v123
    v_mfma_f32_16x16x32_bf16 v[202:205], a[72:75], v[150:153], 0
    s_waitcnt lgkmcnt(3)
    v_cvt_pk_bf16_f32 v116, v194, v195
    v_cvt_pk_bf16_f32 v117, v196, v197
    v_mfma_f32_16x16x32_bf16 v[202:205], a[76:79], v[166:169], v[202:205]
    s_waitcnt lgkmcnt(2)
    v_mul_f32 v124, v191, v124
    v_mul_f32 v125, v191, v125
    v_mfma_f32_16x16x32_bf16 v[202:205], a[80:83], v[118:121], v[202:205]
    s_waitcnt lgkmcnt(1)
    v_cvt_pk_f16_f32 v229, v124, v125
    v_mul_f32 v126, v191, v126
    v_mfma_f32_16x16x32_bf16 v[202:205], a[84:87], v[134:137], v[202:205]
    s_waitcnt lgkmcnt(0)
    v_mul_f32 v127, v191, v127
    v_cvt_pk_f16_f32 v124, v126, v127
    v_mfma_f32_16x16x32_bf16 v[202:205], a[88:91], v[154:157], v[202:205]
    v_mul_f32 v128, v191, v128
    v_mul_f32 v129, v191, v129
    v_mfma_f32_16x16x32_bf16 v[202:205], a[92:95], v[198:201], v[202:205]
    v_cvt_pk_f16_f32 v125, v128, v129
    v_mul_f32 v206, v190, v206
    v_mfma_f32_16x16x32_bf16 v[126:129], a[96:99], v[150:153], 0
    v_mul_f32 v207, v190, v207
    v_cvt_pk_f16_f32 v206, v206, v207
    v_mfma_f32_16x16x32_bf16 v[126:129], a[100:103], v[166:169], v[126:129]
    v_mul_f32 v208, v190, v208
    v_mul_f32 v209, v190, v209
    v_mfma_f32_16x16x32_bf16 v[126:129], a[104:107], v[118:121], v[126:129]
    v_cvt_pk_f16_f32 v207, v208, v209
    v_mul_f32 v174, v190, v174
    v_mfma_f32_16x16x32_bf16 v[126:129], a[108:111], v[134:137], v[126:129]
    v_mul_f32 v175, v190, v175
    v_cvt_pk_f16_f32 v208, v174, v175
    v_mfma_f32_16x16x32_bf16 v[126:129], a[112:115], v[154:157], v[126:129]
    v_mul_f32 v176, v190, v176
    v_mul_f32 v177, v190, v177
    v_mfma_f32_16x16x32_bf16 v[126:129], a[116:119], v[198:201], v[126:129]
    v_cvt_pk_f16_f32 v209, v176, v177
    v_mul_f32 v218, v190, v218
    v_mfma_f32_16x16x32_bf16 v[174:177], a[120:123], v[150:153], 0
    v_mul_f32 v219, v190, v219
    v_cvt_pk_f16_f32 v122, v218, v219
    v_mfma_f32_16x16x32_bf16 v[174:177], a[124:127], v[166:169], v[174:177]
    v_mul_f32 v220, v190, v220
    v_mul_f32 v221, v190, v221
    v_mfma_f32_16x16x32_bf16 v[174:177], a[128:131], v[118:121], v[174:177]
    v_cvt_pk_f16_f32 v123, v220, v221
    v_fma_f32 v162, v202, v202, s32
    v_mfma_f32_16x16x32_bf16 v[174:177], a[132:135], v[134:137], v[174:177]
    v_fmac_f32 v162, v203, v203
    v_fmac_f32 v162, v204, v204
    v_mfma_f32_16x16x32_bf16 v[174:177], a[136:139], v[154:157], v[174:177]
    v_fmac_f32 v162, v205, v205
    v_fmac_f32 v162, v126, v126
    v_mfma_f32_16x16x32_bf16 v[174:177], a[140:143], v[198:201], v[174:177]
    v_fmac_f32 v162, v127, v127
    v_fmac_f32 v162, v128, v128
    v_mfma_f32_16x16x32_bf16 v[190:193], a[0:3], v[150:153], 0
    v_fmac_f32 v162, v129, v129
    v_mul_f32 v149, v255, v149
    v_mfma_f32_16x16x32_bf16 v[190:193], a[4:7], v[166:169], v[190:193]
    v_cvt_pk_bf16_f32 v147, v148, v149
    v_mul_f32 v138, v255, v138
    v_mfma_f32_16x16x32_bf16 v[190:193], a[8:11], v[118:121], v[190:193]
    v_fmac_f32 v162, v174, v174
    v_fmac_f32 v162, v175, v175
    v_mfma_f32_16x16x32_bf16 v[190:193], a[12:15], v[134:137], v[190:193]
    v_fmac_f32 v162, v176, v176
    v_fmac_f32 v162, v177, v177
    v_mfma_f32_16x16x32_bf16 v[190:193], a[16:19], v[154:157], v[190:193]
    v_mul_f32 v139, v255, v139
    v_cvt_pk_bf16_f32 v148, v138, v139
    v_mfma_f32_16x16x32_bf16 v[190:193], a[20:23], v[198:201], v[190:193]
    v_mul_f32 v140, v255, v140
    v_mul_f32 v141, v255, v141
    v_mfma_f32_16x16x32_bf16 v[218:221], a[24:27], v[150:153], 0
    v_cvt_pk_bf16_f32 v149, v140, v141
    v_mul_f32 v186, v255, v186
    v_mfma_f32_16x16x32_bf16 v[218:221], a[28:31], v[166:169], v[218:221]
    buffer_store_dwordx4 v[146:149], v17, s[12:15], 0 offen
    v_mul_f32 v187, v255, v187
    v_fma_f32 v163, v190, v190, s32
    v_fmac_f32 v163, v191, v191
    v_fmac_f32 v163, v192, v192
    v_mfma_f32_16x16x32_bf16 v[218:221], a[32:35], v[118:121], v[218:221]
    v_fmac_f32 v163, v193, v193
    v_cvt_pk_bf16_f32 v164, v186, v187
    v_mfma_f32_16x16x32_bf16 v[218:221], a[36:39], v[134:137], v[218:221]
    v_mul_f32 v188, v255, v188
    v_mul_f32 v189, v255, v189
    v_mfma_f32_16x16x32_bf16 v[218:221], a[40:43], v[154:157], v[218:221]
    v_cvt_pk_bf16_f32 v165, v188, v189
    v_mul_f32 v142, v254, v142
    v_mfma_f32_16x16x32_bf16 v[218:221], a[44:47], v[198:201], v[218:221]
    v_mul_f32 v143, v254, v143
    v_cvt_pk_bf16_f32 v142, v142, v143
    v_mfma_f32_16x16x32_bf16 v[138:141], a[48:51], v[150:153], 0
    v_mul_f32 v144, v254, v144
    v_mul_f32 v145, v254, v145
    v_mfma_f32_16x16x32_bf16 v[138:141], a[52:55], v[166:169], v[138:141]
    v_cvt_pk_bf16_f32 v143, v144, v145
    v_mul_f32 v158, v254, v158
    v_mfma_f32_16x16x32_bf16 v[138:141], a[56:59], v[118:121], v[138:141]
    v_fmac_f32 v163, v218, v218
    v_fmac_f32 v163, v219, v219
    v_mfma_f32_16x16x32_bf16 v[138:141], a[60:63], v[134:137], v[138:141]
    ds_read2_b32 v[196:197], v6 offset0:0 offset1:0
    ds_read2_b32 v[216:217], v6 offset0:16 offset1:16
    v_mfma_f32_16x16x32_bf16 v[138:141], a[64:67], v[154:157], v[138:141]
    ds_read2_b32 v[232:233], v6 offset0:32 offset1:32
    v_fmac_f32 v163, v220, v220
    v_mfma_f32_16x16x32_bf16 v[138:141], a[68:71], v[198:201], v[138:141]
    v_fmac_f32 v163, v221, v221
    v_mul_f32 v159, v254, v159
    v_mfma_f32_16x16x32_bf16 v[146:149], v[150:153], a[144:147], 0
    v_cvt_pk_bf16_f32 v144, v158, v159
    v_mul_f32 v160, v254, v160
    v_mfma_f32_16x16x32_bf16 v[146:149], v[166:169], a[148:151], v[146:149]
    v_mul_f32 v161, v254, v161
    v_cvt_pk_bf16_f32 v145, v160, v161
    v_mfma_f32_16x16x32_bf16 v[146:149], v[118:121], a[152:155], v[146:149]
    v_fmac_f32 v163, v138, v138
    v_fmac_f32 v163, v139, v139
    v_mfma_f32_16x16x32_bf16 v[146:149], v[134:137], a[156:159], v[146:149]
    v_fmac_f32 v163, v140, v140
    v_fmac_f32 v163, v141, v141
    v_mfma_f32_16x16x32_bf16 v[146:149], v[154:157], a[160:163], v[146:149]
    v_cvt_pk_bf16_f32 v36, v163, v162
    v_mul_f32 v178, v254, v178
    v_mfma_f32_16x16x32_bf16 v[146:149], v[198:201], a[164:167], v[146:149]
    s_waitcnt lgkmcnt(1)
    v_mul_f32 v179, v254, v179
    v_cvt_pk_bf16_f32 v178, v178, v179
    v_mfma_f32_16x16x32_bf16 v[158:161], v[32:35], v[36:39], 0
    s_waitcnt lgkmcnt(0)
    buffer_store_dwordx2 v[164:165], v20, s[12:15], 0 offen
    v_mul_f32 v180, v254, v180
    v_mul_f32 v181, v254, v181
    v_mfma_f32_16x16x32_bf16 v[186:189], v[150:153], a[168:171], 0
    v_cvt_pk_bf16_f32 v194, v146, v147
    v_cvt_pk_bf16_f32 v195, v148, v149
    v_mfma_f32_16x16x32_bf16 v[186:189], v[166:169], a[172:175], v[186:189]
    v_rsq_f32 v159, v159
    v_mfma_f32_16x16x32_bf16 v[186:189], v[118:121], a[176:179], v[186:189]
    v_rsq_f32 v158, v158
    v_mfma_f32_16x16x32_bf16 v[186:189], v[134:137], a[180:183], v[186:189]
    v_mul_f32 v158, s31, v158
    v_mul_f32 v202, v159, v202
    v_mfma_f32_16x16x32_bf16 v[186:189], v[154:157], a[184:187], v[186:189]
    v_mul_f32 v203, v159, v203
    v_cvt_pk_f16_f32 v146, v202, v203
    v_mfma_f32_16x16x32_bf16 v[186:189], v[198:201], a[188:191], v[186:189]
    v_mul_f32 v204, v159, v204
    v_mul_f32 v205, v159, v205
    v_mfma_f32_16x16x32_bf16 v[162:165], v[150:153], a[192:195], 0
    v_cvt_pk_f16_f32 v147, v204, v205
    v_mul_f32 v126, v159, v126
    v_mfma_f32_16x16x32_bf16 v[162:165], v[166:169], a[196:199], v[162:165]
    ds_read_b128 v[150:153], v5 offset:0
    ds_read_b128 v[202:205], v5 offset:16
    v_mfma_f32_16x16x32_bf16 v[162:165], v[118:121], a[200:203], v[162:165]
    ds_read_b128 v[118:121], v5 offset:48
    ds_read_b32 v254, v6 offset:192
    v_mfma_f32_16x16x32_bf16 v[162:165], v[134:137], a[204:207], v[162:165]
    v_cvt_pk_bf16_f32 v214, v186, v187
    v_cvt_pk_bf16_f32 v215, v188, v189
    v_mfma_f32_16x16x32_bf16 v[162:165], v[154:157], a[208:211], v[162:165]
    v_mul_f32 v127, v159, v127
    v_cvt_pk_f16_f32 v148, v126, v127
    v_mfma_f32_16x16x32_bf16 v[162:165], v[198:201], a[212:215], v[162:165]
    ds_read_b128 v[198:201], v2 offset:0
    ds_read_b128 v[186:189], v2 offset:1024
    v_mfma_f32_16x16x32_f16 v[134:137], v[226:229], v[222:225], v[50:53]
    ds_read_b128 v[154:157], v2 offset:2048
    v_mul_f32 v128, v159, v128
    v_mul_f32 v129, v159, v129
    v_mfma_f32_16x16x16_f16 v[210:213], v[184:185], v[182:183], v[210:213]
    v_cvt_pk_f16_f32 v149, v128, v129
    v_cvt_pk_bf16_f32 v230, v162, v163
    v_cvt_pk_bf16_f32 v231, v164, v165
    v_mul_f32 v174, v159, v174
    v_mfma_f32_16x16x32_f16 v[126:129], v[146:149], v[222:225], v[54:57]
    s_waitcnt lgkmcnt(5)
    v_mul_f32 v175, v159, v175
    v_cvt_pk_f16_f32 v164, v174, v175
    v_mul_f32 v176, v159, v176
    v_mfma_f32_16x16x16_f16 v[134:137], v[124:125], v[182:183], v[134:137]
    v_mul_f32 v177, v159, v177
    v_cvt_pk_f16_f32 v165, v176, v177
    v_mul_f32 v190, v158, v190
    v_mul_f32 v191, v158, v191
    v_mfma_f32_16x16x16_f16 v[126:129], v[164:165], v[182:183], v[126:129]
    v_cvt_pk_f16_f32 v174, v190, v191
    v_mul_f32 v192, v158, v192
    v_mul_f32 v193, v158, v193
    v_cvt_pk_f16_f32 v175, v192, v193
    v_mfma_f32_16x16x32_f16 v[166:169], v[150:153], v[222:225], v[22:25]
    s_waitcnt lgkmcnt(2)
    ds_read_b128 v[222:225], v2 offset:3072
    buffer_store_dwordx4 v[142:145], v16, s[12:15], 0 offen
    ds_read_b128 v[234:237], v2 offset:4096
    v_mul_f32 v218, v158, v218
    v_mul_f32 v219, v158, v219
    v_cvt_pk_f16_f32 v176, v218, v219
    v_mfma_f32_16x16x32_f16 v[166:169], v[202:205], v[242:245], v[166:169]
    s_waitcnt lgkmcnt(2)
    v_mul_f32 v220, v158, v220
    v_mul_f32 v221, v158, v221
    v_mfma_f32_16x16x32_f16 v[166:169], v[118:121], v[182:185], v[166:169]
    ds_read_b128 v[142:145], v2 offset:5120
    v_cvt_pk_f16_f32 v177, v220, v221
    v_mul_f32 v138, v158, v138
    v_mul_f32 v139, v158, v139
    v_cvt_pk_f16_f32 v162, v138, v139
    v_mfma_f32_16x16x32_f16 v[218:221], v[150:153], v[206:209], v[24:27]
    v_mul_f32 v140, v158, v140
    v_mul_f32 v141, v158, v141
    v_mfma_f32_16x16x32_f16 v[218:221], v[202:205], v[226:229], v[218:221]
    v_mov_b32_dpp v254, v167 quad_perm:[0,1,2,3] row_mask:0x1 bank_mask:0xf
    v_cvt_pk_f16_f32 v163, v140, v141
    v_mfma_f32_16x16x32_f16 v[218:221], v[118:121], v[122:125], v[218:221]
    v_max3_f32 v255, v166, v210, v211
    v_max3_f32 v255, v255, v212, v213
    v_mfma_f32_16x16x32_f16 v[238:241], v[150:153], v[174:177], v[26:29]
    s_waitcnt lgkmcnt(1)
    v_max3_f32 v255, v255, v134, v135
    v_max3_f32 v255, v255, v136, v137
    v_mfma_f32_16x16x32_f16 v[238:241], v[202:205], v[146:149], v[238:241]
    v_max3_f32 v255, v255, v126, v127
    v_mov_b32_dpp v254, v219 quad_perm:[0,1,2,3] row_mask:0x2 bank_mask:0xf
    v_mfma_f32_16x16x32_f16 v[238:241], v[118:121], v[162:165], v[238:241]
    v_max3_f32 v255, v255, v128, v129
    v_mov_b32 v182, v255
    v_mfma_f32_16x16x32_bf16 v[150:153], a[216:219], v[198:201], 0
    s_waitcnt lgkmcnt(0)
    v_permlane32_swap_b32 v255, v182
    v_mfma_f32_16x16x32_bf16 v[150:153], a[220:223], v[186:189], v[150:153]
    v_max_f32 v255, v255, v182
    v_mov_b32 v182, v255
    v_mfma_f32_16x16x32_bf16 v[150:153], a[224:227], v[154:157], v[150:153]
    v_cvt_pk_bf16_f32 v179, v180, v181
    v_xor_b32 v0, 65536, v0
    v_mfma_f32_16x16x32_bf16 v[150:153], a[228:231], v[222:225], v[150:153]
    s_waitcnt vmcnt(5)
    v_permlane16_swap_b32 v255, v182
    v_mfma_f32_16x16x32_bf16 v[150:153], a[232:235], v[234:237], v[150:153]
    s_nop 0
    v_max_f32 v255, v255, v182
    v_sub_f32 v210, v210, v255
    v_mfma_f32_16x16x32_bf16 v[150:153], a[236:239], v[142:145], v[150:153]
    s_nop 0
    v_exp_f32 v210, v210
    v_mfma_f32_16x16x32_bf16 v[190:193], a[240:243], v[198:201], 0
    s_nop 0
    v_sub_f32 v211, v211, v255
    v_sub_f32 v212, v212, v255
    v_mfma_f32_16x16x32_bf16 v[190:193], a[244:247], v[186:189], v[190:193]
    s_barrier
    buffer_load_dwordx4 v10, s[8:11], 0 offen lds
    v_sub_f32 v213, v213, v255
    v_mfma_f32_16x16x32_bf16 v[190:193], a[248:251], v[154:157], v[190:193]
    s_add_u32 m0, s28, 4096
    v_exp_f32 v211, v211
    v_mfma_f32_16x16x32_bf16 v[190:193], a[252:255], v[222:225], v[190:193]
    v_cvt_pk_bf16_f32 v158, v210, v211
    v_sub_f32 v134, v134, v255
    v_mfma_f32_16x16x32_bf16 v[190:193], v[82:85], v[234:237], v[190:193]
    v_exp_f32 v212, v212
    v_mfma_f32_16x16x32_bf16 v[190:193], v[86:89], v[142:145], v[190:193]
    v_exp_f32 v213, v213
    v_mfma_f32_16x16x32_bf16 v[202:205], v[90:93], v[198:201], 0
    ds_read_b128 v[198:201], v2 offset:6144
    buffer_load_dwordx4 v11, s[8:11], 0 offen lds
    v_mfma_f32_16x16x32_bf16 v[202:205], v[94:97], v[186:189], v[202:205]
    s_add_u32 m0, s28, 8192
    ds_read_b128 v[138:141], v2 offset:7168
    v_cvt_pk_bf16_f32 v159, v212, v213
    v_mfma_f32_16x16x32_bf16 v[202:205], v[98:101], v[154:157], v[202:205]
    ds_read_b128 v[210:213], v2 offset:8192
    v_sub_f32 v135, v135, v255
    v_mfma_f32_16x16x32_bf16 v[202:205], v[102:105], v[222:225], v[202:205]
    ds_read_b128 v[186:189], v2 offset:9216
    v_sub_f32 v136, v136, v255
    v_mfma_f32_16x16x32_bf16 v[202:205], v[106:109], v[234:237], v[202:205]
    ds_read_b128 v[222:225], v2 offset:10240
    v_sub_f32 v137, v137, v255
    v_mfma_f32_16x16x32_bf16 v[202:205], v[110:113], v[142:145], v[202:205]
    ds_read_b128 v[154:157], v2 offset:11264
    buffer_load_dwordx4 v12, s[8:11], 0 offen lds
    v_exp_f32 v134, v134
    v_mfma_f32_16x16x32_f16 v[118:121], v[242:245], v[206:209], v[58:61]
    s_add_u32 m0, s28, 12288
    v_exp_f32 v135, v135
    v_exp_f32 v136, v136
    v_cvt_pk_bf16_f32 v160, v134, v135
    v_exp_f32 v137, v137
    v_sub_f32 v126, v126, v255
    v_mfma_f32_16x16x16_f16 v[118:121], v[184:185], v[122:123], v[118:121]
    v_cvt_pk_bf16_f32 v161, v136, v137
    v_exp_f32 v126, v126
    v_sub_f32 v127, v127, v255
    v_mfma_f32_16x16x32_f16 v[134:137], v[226:229], v[206:209], v[62:65]
    s_xor_b32 s28, s28, 65536
    buffer_load_dwordx4 v13, s[8:11], 0 offen lds
    v_exp_f32 v127, v127
    v_sub_f32 v128, v128, v255
    v_cvt_pk_bf16_f32 v36, v126, v127
    v_exp_f32 v128, v128
    v_mfma_f32_16x16x16_f16 v[134:137], v[124:125], v[122:123], v[134:137]
    v_sub_f32 v129, v129, v255
    v_exp_f32 v129, v129
    v_sub_f32 v166, v166, v255
    v_cvt_pk_bf16_f32 v37, v128, v129
    v_mfma_f32_16x16x32_f16 v[126:129], v[146:149], v[206:209], v[66:69]
    s_waitcnt lgkmcnt(0)
    v_exp_f32 v166, v166
    v_mfma_f32_16x16x32_bf16 v[142:145], a[216:219], v[198:201], 0
    s_mov_b32 m0, s29
    v_cvt_pk_bf16_f32 v39, v166, 0
    v_max3_f32 v255, v218, v118, v119
    v_max3_f32 v255, v255, v120, v121
    v_mfma_f32_16x16x16_f16 v[126:129], v[164:165], v[122:123], v[126:129]
    v_max3_f32 v255, v255, v134, v135
    v_max3_f32 v255, v255, v136, v137
    v_xor_b32 v1, 65536, v1
    v_mov_b32_dpp v254, v239 quad_perm:[0,1,2,3] row_mask:0x4 bank_mask:0xf
    v_mfma_f32_16x16x32_bf16 v[206:209], v[28:31], v[36:39], 0
    s_xor_b32 s29, s29, s30
    buffer_store_dwordx2 v[178:179], v19, s[12:15], 0 offen
    v_mov_b32 v122, v254
    v_max3_f32 v255, v255, v126, v127
    v_mfma_f32_16x16x32_bf16 v[206:209], v[28:31], v[158:161], v[206:209]
    s_add_u32 s19, s19, s20
    v_max3_f32 v255, v255, v128, v129
    v_mov_b32 v123, v255
    v_mfma_f32_16x16x32_bf16 v[142:145], a[220:223], v[138:141], v[142:145]
    s_add_u32 s23, s23, s21
    v_permlane32_swap_b32 v255, v123
    v_mfma_f32_16x16x32_bf16 v[142:145], a[224:227], v[210:213], v[142:145]
    s_cmp_ge_u32 s19, 72
    v_rcp_f32 v206, v206
    v_mfma_f32_16x16x32_bf16 v[142:145], a[228:231], v[186:189], v[142:145]
    s_cselect_b32 s34, 72, 0
    v_max_f32 v255, v255, v123
    v_mov_b32 v123, v255
    v_mfma_f32_16x16x32_bf16 v[142:145], a[232:235], v[222:225], v[142:145]
    s_cselect_b32 s35, s22, 0
    v_permlane16_swap_b32 v255, v123
    v_mfma_f32_16x16x32_bf16 v[142:145], a[236:239], v[154:157], v[142:145]
    s_sub_u32 s19, s19, s34
    v_max_f32 v255, v255, v123
    v_sub_f32 v118, v118, v255
    v_mfma_f32_16x16x32_bf16 v[178:181], v[194:197], v[36:39], 0
    s_add_u32 s23, s23, s35
    v_exp_f32 v118, v118
    v_mfma_f32_16x16x32_bf16 v[178:181], v[170:173], v[158:161], v[178:181]
    s_add_u32 s18, s18, 1
    v_sub_f32 v119, v119, v255
    v_exp_f32 v119, v119
    v_sub_f32 v120, v120, v255
    v_cvt_pk_bf16_f32 v118, v118, v119
    v_exp_f32 v120, v120
    v_sub_f32 v121, v121, v255
    v_exp_f32 v121, v121
    v_mul_f32 v178, v206, v178
    v_mul_f32 v179, v206, v179
    v_cvt_pk_bf16_f32 v178, v178, v179
    v_mul_f32 v180, v206, v180
    v_mul_f32 v181, v206, v181
    v_cvt_pk_bf16_f32 v179, v180, v181
    v_cvt_pk_bf16_f32 v119, v120, v121
    v_mfma_f32_16x16x32_bf16 v[166:169], v[214:217], v[36:39], 0
    s_cmp_lt_u32 s18, s17
    v_sub_f32 v134, v134, v255
    v_sub_f32 v135, v135, v255
    v_mfma_f32_16x16x32_bf16 v[166:169], v[130:133], v[158:161], v[166:169]
    v_exp_f32 v134, v134
    v_exp_f32 v135, v135
    v_sub_f32 v136, v136, v255
    v_cvt_pk_bf16_f32 v120, v134, v135
    v_exp_f32 v136, v136
    v_sub_f32 v137, v137, v255
    v_exp_f32 v137, v137
    v_sub_f32 v126, v126, v255
    v_mul_f32 v166, v206, v166
    v_mul_f32 v167, v206, v167
    v_cvt_pk_bf16_f32 v180, v166, v167
    v_mul_f32 v168, v206, v168
    v_mul_f32 v169, v206, v169
    v_cvt_pk_bf16_f32 v181, v168, v169
    v_cvt_pk_bf16_f32 v121, v136, v137
    v_mfma_f32_16x16x32_bf16 v[134:137], v[230:233], v[36:39], 0
    buffer_load_dwordx4 v14, s[8:11], 0 offen lds
    v_sub_f32 v127, v127, v255
    v_mfma_f32_16x16x32_bf16 v[134:137], v[114:117], v[158:161], v[134:137]
    ds_write_b128 v3, v[178:181] offset:0
    v_mfma_f32_16x16x32_bf16 v[158:161], a[240:243], v[198:201], 0
    v_exp_f32 v126, v126
    v_mfma_f32_16x16x32_bf16 v[158:161], a[244:247], v[138:141], v[158:161]
    v_exp_f32 v127, v127
    v_mfma_f32_16x16x32_bf16 v[158:161], a[248:251], v[210:213], v[158:161]
    v_cvt_pk_bf16_f32 v36, v126, v127
    v_sub_f32 v128, v128, v255
    v_mfma_f32_16x16x32_bf16 v[158:161], a[252:255], v[186:189], v[158:161]
    v_mul_f32 v134, v206, v134
    v_mul_f32 v135, v206, v135
    v_mfma_f32_16x16x32_bf16 v[158:161], v[82:85], v[222:225], v[158:161]
    v_cvt_pk_bf16_f32 v126, v134, v135
    v_mul_f32 v136, v206, v136
    v_mfma_f32_16x16x32_bf16 v[158:161], v[86:89], v[154:157], v[158:161]
    v_mul_f32 v137, v206, v137
    v_cvt_pk_bf16_f32 v127, v136, v137
    v_mfma_f32_16x16x32_bf16 v[178:181], v[90:93], v[198:201], 0
    ds_read_b128 v[198:201], v2 offset:12288
    v_sub_f32 v129, v129, v255
    v_mfma_f32_16x16x32_bf16 v[178:181], v[94:97], v[138:141], v[178:181]
    ds_read_b128 v[206:209], v2 offset:13312
    v_sub_f32 v218, v218, v255
    v_mfma_f32_16x16x32_bf16 v[178:181], v[98:101], v[210:213], v[178:181]
    ds_read_b128 v[210:213], v2 offset:14336
    v_max_f32_dpp v122, v122, v122 quad_perm:[1,0,3,2] row_mask:0xf bank_mask:0xf
    v_mfma_f32_16x16x32_bf16 v[178:181], v[102:105], v[186:189], v[178:181]
    ds_read_b128 v[134:137], v2 offset:15360
    v_max_f32_dpp v122, v122, v122 quad_perm:[2,3,0,1] row_mask:0xf bank_mask:0xf
    v_mfma_f32_16x16x32_bf16 v[178:181], v[106:109], v[222:225], v[178:181]
    ds_read_b128 v[222:225], v2 offset:16384
    v_max_f32_dpp v122, v122, v122 row_half_mirror row_mask:0xf bank_mask:0xf
    v_mfma_f32_16x16x32_bf16 v[178:181], v[110:113], v[154:157], v[178:181]
    ds_read_b128 v[154:157], v2 offset:17408
    ds_write_b64 v4, v[126:127] offset:4096
    v_exp_f32 v128, v128
    v_exp_f32 v129, v129
    v_mfma_f32_16x16x32_f16 v[186:189], v[242:245], v[174:177], v[70:73]
    s_waitcnt lgkmcnt(6)
    v_cvt_pk_bf16_f32 v37, v128, v129
    v_max_f32_dpp v122, v122, v122 row_mirror row_mask:0xf bank_mask:0xf
    v_mfma_f32_16x16x32_f16 v[242:245], v[226:229], v[174:177], v[74:77]
    s_waitcnt lgkmcnt(5)
    v_exp_f32 v218, v218
    v_mfma_f32_16x16x32_f16 v[126:129], v[146:149], v[174:177], v[78:81]
    s_waitcnt lgkmcnt(4)
    v_cvt_pk_bf16_f32 v39, v218, 0
    v_mov_b32 v123, v122
    v_fma_f32 v255, v150, v150, s33
    v_mfma_f32_16x16x32_bf16 v[174:177], v[28:31], v[36:39], 0
    s_waitcnt lgkmcnt(3)
    v_permlane32_swap_b32 v122, v123
    v_mfma_f32_16x16x32_bf16 v[174:177], v[28:31], v[118:121], v[174:177]
    s_waitcnt lgkmcnt(2)
    v_max_f32 v122, v122, v123
    v_mov_b32 v123, v122
    v_mfma_f32_16x16x32_bf16 v[226:229], v[194:197], v[36:39], 0
    s_waitcnt lgkmcnt(0)
    v_permlane16_swap_b32 v122, v123
    v_mfma_f32_16x16x32_bf16 v[226:229], v[170:173], v[118:121], v[226:229]
    v_max_f32 v122, v122, v123
    v_sub_f32 v254, v254, v122
    v_mfma_f32_16x16x32_bf16 v[218:221], v[214:217], v[36:39], 0
    v_exp_f32 v254, v254
    v_mfma_f32_16x16x32_bf16 v[218:221], v[130:133], v[118:121], v[218:221]
    v_cvt_pk_bf16_f32 v254, v254, v254
    v_fmac_f32 v255, v151, v151
    v_mfma_f32_16x16x32_bf16 v[166:169], v[230:233], v[36:39], 0
    ds_write_b16 v8, v254
    v_mfma_f32_16x16x32_bf16 v[166:169], v[114:117], v[118:121], v[166:169]
    v_rcp_f32 v174, v174
    v_fmac_f32 v255, v152, v152
    v_mfma_f32_16x16x16_f16 v[186:189], v[184:185], v[162:163], v[186:189]
    v_mul_f32 v226, v174, v226
    v_mul_f32 v227, v174, v227
    v_cvt_pk_bf16_f32 v122, v226, v227
    v_mfma_f32_16x16x16_f16 v[242:245], v[124:125], v[162:163], v[242:245]
    v_mul_f32 v228, v174, v228
    v_mul_f32 v229, v174, v229
    v_cvt_pk_bf16_f32 v123, v228, v229
    v_mfma_f32_16x16x16_f16 v[126:129], v[164:165], v[162:163], v[126:129]
    v_max3_f32 v254, v238, v186, v187
    v_max3_f32 v254, v254, v188, v189
    v_mul_f32 v218, v174, v218
    v_mul_f32 v219, v174, v219
    v_mfma_f32_16x16x32_bf16 v[146:149], a[216:219], v[198:201], 0
    ds_read_b128 v[118:121], v9
    ds_read_b128 v[162:165], v9 offset:64
    v_mfma_f32_16x16x32_bf16 v[146:149], a[220:223], v[206:209], v[146:149]
    v_max3_f32 v254, v254, v242, v243
    v_max3_f32 v254, v254, v244, v245
    v_mfma_f32_16x16x32_bf16 v[146:149], a[224:227], v[210:213], v[146:149]
    v_max3_f32 v254, v254, v126, v127
    v_max3_f32 v254, v254, v128, v129
    v_mfma_f32_16x16x32_bf16 v[146:149], a[228:231], v[134:137], v[146:149]
    v_mov_b32 v125, v254
    v_cvt_pk_bf16_f32 v124, v218, v219
    v_mfma_f32_16x16x32_bf16 v[146:149], a[232:235], v[222:225], v[146:149]
    v_permlane32_swap_b32 v254, v125
    v_mfma_f32_16x16x32_bf16 v[146:149], a[236:239], v[154:157], v[146:149]
    v_max_f32 v254, v254, v125
    v_mov_b32 v125, v254
    v_mfma_f32_16x16x32_bf16 v[138:141], a[240:243], v[198:201], 0
    v_mul_f32 v220, v174, v220
    v_mul_f32 v221, v174, v221
    v_mfma_f32_16x16x32_bf16 v[138:141], a[244:247], v[206:209], v[138:141]
    v_permlane16_swap_b32 v254, v125
    v_mfma_f32_16x16x32_bf16 v[138:141], a[248:251], v[210:213], v[138:141]
    s_waitcnt lgkmcnt(0)
    v_max_f32 v254, v254, v125
    v_sub_f32 v186, v186, v254
    v_mfma_f32_16x16x32_bf16 v[138:141], a[252:255], v[134:137], v[138:141]
    v_exp_f32 v186, v186
    v_mfma_f32_16x16x32_bf16 v[138:141], v[82:85], v[222:225], v[138:141]
    v_sub_f32 v187, v187, v254
    v_sub_f32 v188, v188, v254
    v_mfma_f32_16x16x32_bf16 v[138:141], v[86:89], v[154:157], v[138:141]
    v_exp_f32 v187, v187
    v_exp_f32 v188, v188
    v_cvt_pk_bf16_f32 v234, v186, v187
    v_sub_f32 v189, v189, v254
    v_exp_f32 v189, v189
    v_sub_f32 v242, v242, v254
    v_cvt_pk_bf16_f32 v235, v188, v189
    v_exp_f32 v242, v242
    v_sub_f32 v243, v243, v254
    v_exp_f32 v243, v243
    v_sub_f32 v244, v244, v254
    v_cvt_pk_bf16_f32 v236, v242, v243
    v_mfma_f32_16x16x32_bf16 v[186:189], v[90:93], v[198:201], 0
    v_exp_f32 v244, v244
    v_mfma_f32_16x16x32_bf16 v[186:189], v[94:97], v[206:209], v[186:189]
    v_sub_f32 v245, v245, v254
    v_sub_f32 v126, v126, v254
    v_mfma_f32_16x16x32_bf16 v[186:189], v[98:101], v[210:213], v[186:189]
    v_exp_f32 v245, v245
    v_mfma_f32_16x16x32_bf16 v[186:189], v[102:105], v[134:137], v[186:189]
    v_cvt_pk_bf16_f32 v237, v244, v245
    v_sub_f32 v127, v127, v254
    v_mfma_f32_16x16x32_bf16 v[186:189], v[106:109], v[222:225], v[186:189]
    v_exp_f32 v126, v126
    v_mfma_f32_16x16x32_bf16 v[186:189], v[110:113], v[154:157], v[186:189]
    ds_read_b128 v[182:185], v0 offset:20480
    ds_read_b128 v[198:201], v1 offset:20480
    v_mfma_f32_16x16x32_bf16 v[206:209], v[118:121], v[28:31], 0
    ds_read_b128 v[210:213], v0 offset:20608
    ds_read_b128 v[222:225], v1 offset:20608
    v_mfma_f32_16x16x32_bf16 v[206:209], v[162:165], v[28:31], v[206:209]
    v_exp_f32 v127, v127
    v_mfma_f32_16x16x32_bf16 v[154:157], v[118:121], v[170:173], 0
    ds_read_b128 v[226:229], v0 offset:20736
    v_cvt_pk_bf16_f32 v36, v126, v127
    v_mfma_f32_16x16x32_bf16 v[154:157], v[162:165], v[194:197], v[154:157]
    ds_read_b128 v[242:245], v1 offset:20736
    v_sub_f32 v128, v128, v254
    v_exp_f32 v128, v128
    v_sub_f32 v129, v129, v254
    v_exp_f32 v129, v129
    v_sub_f32 v238, v238, v254
    v_cvt_pk_bf16_f32 v37, v128, v129
    v_mfma_f32_16x16x32_bf16 v[134:137], v[118:121], v[130:133], 0
    v_exp_f32 v238, v238
    v_mfma_f32_16x16x32_bf16 v[134:137], v[162:165], v[214:217], v[134:137]
    s_waitcnt lgkmcnt(4)
    v_cvt_pk_bf16_f32 v39, v238, 0
    v_cvt_pk_bf16_f32 v125, v220, v221
    v_mfma_f32_16x16x32_bf16 v[218:221], v[118:121], v[114:117], 0
    s_waitcnt lgkmcnt(2)
    ds_write_b128 v3, v[122:125] offset:6144
    v_mfma_f32_16x16x32_bf16 v[126:129], v[28:31], v[36:39], 0
    s_waitcnt lgkmcnt(2)
    v_mul_f32 v166, v174, v166
    v_mul_f32 v167, v174, v167
    v_mfma_f32_16x16x32_bf16 v[126:129], v[28:31], v[234:237], v[126:129]
    s_waitcnt lgkmcnt(1)
    v_cvt_pk_bf16_f32 v166, v166, v167
    v_mul_f32 v168, v174, v168
    v_mfma_f32_16x16x32_bf16 v[122:125], v[194:197], v[36:39], 0
    v_mul_f32 v169, v174, v169
    v_cvt_pk_bf16_f32 v167, v168, v169
    v_mfma_f32_16x16x32_bf16 v[122:125], v[170:173], v[234:237], v[122:125]
    ds_write_b64 v4, v[166:167] offset:10240
    v_mfma_f32_16x16x32_bf16 v[170:173], v[214:217], v[36:39], 0
    v_rcp_f32 v126, v126
    v_mfma_f32_16x16x32_bf16 v[170:173], v[130:133], v[234:237], v[170:173]
    v_fma_f32 v254, v146, v146, s33
    v_fmac_f32 v254, v147, v147
    v_mfma_f32_16x16x32_bf16 v[174:177], v[230:233], v[36:39], 0
    v_fmac_f32 v254, v148, v148
    v_mul_f32 v122, v126, v122
    v_mfma_f32_16x16x32_bf16 v[174:177], v[114:117], v[234:237], v[174:177]
    v_mul_f32 v123, v126, v123
    v_cvt_pk_bf16_f32 v122, v122, v123
    v_mfma_f32_16x16x32_bf16 v[218:221], v[162:165], v[230:233], v[218:221]
    v_mul_f32 v124, v126, v124
    v_mul_f32 v125, v126, v125
    v_mfma_f32_16x16x32_bf16 v[114:117], a[72:75], v[182:185], 0
    v_cvt_pk_bf16_f32 v123, v124, v125
    v_mul_f32 v170, v126, v170
    v_mfma_f32_16x16x32_bf16 v[114:117], a[76:79], v[198:201], v[114:117]
    v_mul_f32 v171, v126, v171
    v_cvt_pk_bf16_f32 v124, v170, v171
    v_mfma_f32_16x16x32_bf16 v[114:117], a[80:83], v[210:213], v[114:117]
    v_mul_f32 v172, v126, v172
    v_mul_f32 v173, v126, v173
    v_mfma_f32_16x16x32_bf16 v[114:117], a[84:87], v[222:225], v[114:117]
    v_cvt_pk_bf16_f32 v125, v172, v173
    v_mul_f32 v174, v126, v174
    v_mfma_f32_16x16x32_bf16 v[114:117], a[88:91], v[226:229], v[114:117]
    ds_write_b128 v3, v[122:125] offset:12288
    v_mfma_f32_16x16x32_bf16 v[114:117], a[92:95], v[242:245], v[114:117]
    v_mul_f32 v175, v126, v175
    v_cvt_pk_bf16_f32 v174, v174, v175
    v_mfma_f32_16x16x32_bf16 v[122:125], a[96:99], v[182:185], 0
    v_mul_f32 v176, v126, v176
    v_mul_f32 v177, v126, v177
    v_mfma_f32_16x16x32_bf16 v[122:125], a[100:103], v[198:201], v[122:125]
    v_cvt_pk_bf16_f32 v175, v176, v177
    v_fmac_f32 v254, v149, v149
    v_mfma_f32_16x16x32_bf16 v[122:125], a[104:107], v[210:213], v[122:125]
    ds_write_b64 v4, v[174:175] offset:16384
    v_mfma_f32_16x16x32_bf16 v[122:125], a[108:111], v[222:225], v[122:125]
    v_fmac_f32 v254, v138, v138
    v_fmac_f32 v254, v139, v139
    v_mfma_f32_16x16x32_bf16 v[122:125], a[112:115], v[226:229], v[122:125]
    v_fmac_f32 v254, v140, v140
    v_fmac_f32 v254, v141, v141
    v_mfma_f32_16x16x32_bf16 v[122:125], a[116:119], v[242:245], v[122:125]
    v_fmac_f32 v254, v186, v186
    v_fmac_f32 v254, v187, v187
    v_mfma_f32_16x16x32_bf16 v[126:129], a[120:123], v[182:185], 0
    v_fmac_f32 v254, v188, v188
    v_fmac_f32 v254, v189, v189
    v_mfma_f32_16x16x32_bf16 v[126:129], a[124:127], v[198:201], v[126:129]
    v_cvt_pk_bf16_f32 v155, v254, v254
    v_fmac_f32 v255, v153, v153
    v_mfma_f32_16x16x32_bf16 v[126:129], a[128:131], v[210:213], v[126:129]
    v_rcp_f32 v206, v206
    v_mfma_f32_16x16x32_bf16 v[126:129], a[132:135], v[222:225], v[126:129]
    v_mul_f32 v154, v154, v206
    v_mul_f32_dpp v154, v134, v206 quad_perm:[0,1,2,3] row_mask:0x2 bank_mask:0xf
    v_mfma_f32_16x16x32_bf16 v[126:129], a[136:139], v[226:229], v[126:129]
    v_mul_f32_dpp v154, v218, v206 quad_perm:[0,1,2,3] row_mask:0x4 bank_mask:0xf
    v_cvt_pk_bf16_f32 v154, v154, v154
    v_mfma_f32_16x16x32_bf16 v[126:129], a[140:143], v[242:245], v[126:129]
    ds_write_b16 v7, v154
    v_mfma_f32_16x16x32_bf16 v[206:209], a[0:3], v[182:185], 0
    v_fmac_f32 v255, v190, v190
    v_fmac_f32 v255, v191, v191
    v_mfma_f32_16x16x32_bf16 v[206:209], a[4:7], v[198:201], v[206:209]
    v_fmac_f32 v255, v192, v192
    v_fmac_f32 v255, v193, v193
    v_mfma_f32_16x16x32_bf16 v[206:209], a[8:11], v[210:213], v[206:209]
    v_fmac_f32 v255, v202, v202
    v_fmac_f32 v255, v203, v203
    v_mfma_f32_16x16x32_bf16 v[206:209], a[12:15], v[222:225], v[206:209]
    v_fmac_f32 v255, v204, v204
    v_fmac_f32 v255, v205, v205
    v_mfma_f32_16x16x32_bf16 v[206:209], a[16:19], v[226:229], v[206:209]
    v_fma_f32 v254, v142, v142, s33
    v_fmac_f32 v254, v143, v143
    v_mfma_f32_16x16x32_bf16 v[206:209], a[20:23], v[242:245], v[206:209]
    v_fmac_f32 v254, v144, v144
    v_fmac_f32 v254, v145, v145
    v_mfma_f32_16x16x32_bf16 v[174:177], a[24:27], v[182:185], 0
    v_fmac_f32 v254, v158, v158
    v_fmac_f32 v254, v159, v159
    v_mfma_f32_16x16x32_bf16 v[174:177], a[28:31], v[198:201], v[174:177]
    v_fmac_f32 v254, v160, v160
    v_fmac_f32 v254, v161, v161
    v_mfma_f32_16x16x32_bf16 v[174:177], a[32:35], v[210:213], v[174:177]
    v_fmac_f32 v254, v178, v178
    v_fmac_f32 v254, v179, v179
    v_mfma_f32_16x16x32_bf16 v[174:177], a[36:39], v[222:225], v[174:177]
    v_fmac_f32 v254, v180, v180
    v_fmac_f32 v254, v181, v181
    v_mfma_f32_16x16x32_bf16 v[174:177], a[40:43], v[226:229], v[174:177]
    v_cvt_pk_bf16_f32 v154, v255, v254
    v_add_u32 v5, 336, v5
    v_mfma_f32_16x16x32_bf16 v[174:177], a[44:47], v[242:245], v[174:177]
    ds_write_b64 v4, v[154:155] offset:18432
    v_mfma_f32_16x16x32_bf16 v[218:221], a[48:51], v[182:185], 0
    v_add_u32 v6, 272, v6
    v_add_u32 v7, 16, v7
    v_mfma_f32_16x16x32_bf16 v[218:221], a[52:55], v[198:201], v[218:221]
    v_fma_f32 v130, v114, v114, s32
    v_fmac_f32 v130, v115, v115
    v_mfma_f32_16x16x32_bf16 v[218:221], a[56:59], v[210:213], v[218:221]
    v_fmac_f32 v130, v116, v116
    v_fmac_f32 v130, v117, v117
    v_mfma_f32_16x16x32_bf16 v[218:221], a[60:63], v[222:225], v[218:221]
    v_fmac_f32 v130, v122, v122
    v_fmac_f32 v130, v123, v123
    v_mfma_f32_16x16x32_bf16 v[218:221], a[64:67], v[226:229], v[218:221]
    v_fmac_f32 v130, v124, v124
    v_fmac_f32 v130, v125, v125
    v_mfma_f32_16x16x32_bf16 v[218:221], a[68:71], v[242:245], v[218:221]
    v_fmac_f32 v130, v126, v126
    v_fmac_f32 v130, v127, v127
    v_mfma_f32_16x16x32_bf16 v[170:173], v[182:185], a[144:147], 0
    s_waitcnt lgkmcnt(0)
    v_fmac_f32 v130, v128, v128
    v_fmac_f32 v130, v129, v129
    v_mfma_f32_16x16x32_bf16 v[170:173], v[198:201], a[148:151], v[170:173]
    s_nop 0
    v_fma_f32 v131, v206, v206, s32
    v_fmac_f32 v131, v207, v207
    v_mfma_f32_16x16x32_bf16 v[170:173], v[210:213], a[152:155], v[170:173]
    s_nop 0
    v_fmac_f32 v131, v208, v208
    v_fmac_f32 v131, v209, v209
    v_mfma_f32_16x16x32_bf16 v[170:173], v[222:225], a[156:159], v[170:173]
    s_nop 0
    v_fmac_f32 v131, v174, v174
    v_xor_b32 v2, 65536, v2
    v_mfma_f32_16x16x32_bf16 v[170:173], v[226:229], a[160:163], v[170:173]
    s_barrier
    v_xor_b32 v3, 65536, v3
    v_xor_b32 v4, 65536, v4
    v_mfma_f32_16x16x32_bf16 v[170:173], v[242:245], a[164:167], v[170:173]
    s_cbranch_scc1 L_loop_safe3
    s_branch L_drain
.section .rodata,"a"
.p2align 6
.amdhsa_kernel standalone__window_attn_swin_v2__vision_kernel
  .amdhsa_next_free_vgpr 512
  .amdhsa_next_free_sgpr 102
  .amdhsa_accum_offset 256
  .amdhsa_group_segment_fixed_size 0
  .amdhsa_kernarg_size 96
  .amdhsa_user_sgpr_count 2
  .amdhsa_user_sgpr_kernarg_segment_ptr 1
  .amdhsa_system_sgpr_workgroup_id_x 1
  .amdhsa_float_denorm_mode_32 3
.end_amdhsa_kernel
```

```asm
; @launch grid=(256,1,1) block=(256,1,1) lds=163840
.amdgcn_target "amdgcn-amd-amdhsa--gfx950"
.text
.globl standalone__window_attn_swin_v2__vision_kernel
.p2align 12
.p2align 8
.type standalone__window_attn_swin_v2__vision_kernel,@function
standalone__window_attn_swin_v2__vision_kernel:
    s_mov_b32 s44, 0
L_again:
    s_load_dwordx16 s[76:91], s[0:1], 0
    v_readfirstlane_b32 s16, v0
    s_cmp_ge_u32 s2, 256
    s_cbranch_scc1 L_done
    s_lshr_b32 s16, s16, 6
    s_cbranch_scc1 L_nopf
    s_getpc_b64 s[96:97]
    s_bfe_u32 s3, s2, 0x30003
    s_mul_i32 s3, s3, 38
    v_cmp_gt_u32 vcc, 26, v0
    v_add_u32 v190, s3, v0
    v_mov_b32 v191, 0
    v_cndmask_b32 v190, v190, v0, vcc
    v_lshlrev_b32 v190, 7, v190
    v_lshl_add_u64 v[190:191], s[96:97], 0, v[190:191]
    global_load_dword a255, v[190:191], off offset:992
L_nopf:
    s_max_u32 s3, s2, s44
    s_cmp_ge_u32 s3, 247
    s_cbranch_scc1 L_edge
    v_mov_b32 v190, v0
    v_mov_b32 v191, 0x40000000
    v_and_b32 v254, 63, v0
    s_bfe_u32 s3, s2, 0x50003
    s_lshl_b32 s4, s16, 3
    s_lshr_b32 s98, 0x00123600, s4
    s_and_b32 s98, s98, 0xff
    s_mul_i32 s3, s3, s98
    s_lshr_b32 s4, 0x05113500, s4
    s_and_b32 s4, s4, 0xff
    v_min_u32 v114, s4, v254
    v_add_lshl_u32 v114, v114, s3, 7
    v_mov_b32 v115, 0
    v_lshrrev_b32 v255, 4, v254
    v_and_b32 v116, 15, v254
    s_mov_b32 s10, 100270464
    s_mov_b32 s11, 0x00020000
    s_mov_b32 s50, 221184
    s_mov_b32 s51, 0x00020000
    v_mul_u32_u24 v117, 171, v254
    v_lshrrev_b32 v117, 10, v117
    v_lshrrev_b32 v122, 1, v117
    v_xor_b32 v122, v122, v117
    v_and_b32 v122, 4, v122
    v_mul_u32_u24 v122, 3, v122
    v_xor_b32 v122, v122, v117
    v_mul_u32_u24 v122, 1152, v122
    v_mul_u32_u24 v123, 96, v117
    v_sub_u32 v122, v122, v123
    v_lshl_add_u32 v123, v254, 4, v122
    v_add_u32 v122, 64, v254
    v_mul_u32_u24 v122, 171, v122
    v_lshrrev_b32 v122, 10, v122
    v_lshrrev_b32 v124, 1, v122
    v_xor_b32 v124, v124, v122
    v_and_b32 v124, 4, v124
    v_mul_u32_u24 v124, 3, v124
    v_xor_b32 v124, v124, v122
    v_mul_u32_u24 v124, 1152, v124
    v_mul_u32_u24 v125, 96, v122
    v_sub_u32 v124, v124, v125
    v_lshl_add_u32 v125, v254, 4, v124
    v_add_u32 v124, 128, v254
    v_mul_u32_u24 v124, 171, v124
    v_lshrrev_b32 v124, 10, v124
    v_lshrrev_b32 v126, 1, v124
    v_xor_b32 v126, v126, v124
    v_and_b32 v126, 4, v126
    v_mul_u32_u24 v126, 3, v126
    v_xor_b32 v126, v126, v124
    v_mul_u32_u24 v126, 1152, v126
    v_mul_u32_u24 v127, 96, v124
    v_sub_u32 v126, v126, v127
    v_lshl_add_u32 v127, v254, 4, v126
    s_mul_i32 s68, s16, 6144
    s_add_u32 s69, s68, 65536
    s_cmp_eq_u32 s16, 3
    s_cselect_b32 s68, 136704, s68
    s_cselect_b32 s69, 142848, s69
    s_mul_i32 s45, s16, 96
    s_mov_b32 s70, 193536
    s_mov_b32 s36, 100270464
    s_mov_b32 s22, 1180032
    s_mul_i32 s3, s2, 911
    s_lshr_b32 s3, s3, 16
    s_mul_i32 s99, s3, 72
    s_sub_u32 s38, s2, s99
    s_mul_i32 s3, s3, 1373568
    s_mul_i32 s99, s38, 2688
    s_add_u32 s3, s3, s99
    s_add_u32 s25, s3, 589824
    s_add_u32 s7, s3, 1769472
    s_mov_b32 s20, 31
    s_mov_b32 s21, 4204032
    s_cmp_lt_u32 s2, 244
    s_cselect_b32 s17, 21, 20
    v_mul_u32_u24 v126, 2731, v190
    v_bfe_u32 v128, v126, 17, 3
    v_lshrrev_b32 v126, 16, v126
    v_xor_b32 v129, v128, v190
    v_mul_u32_u24 v128, 37, v126
    v_lshrrev_b32 v128, 8, v128
    v_lshlrev_b32 v129, 4, v129
    v_mad_u32_u24 v10, v128, s70, v129
    v_mul_u32_u24 v128, s20, v126
    v_add_u32 v128, s38, v128
    v_mul_u32_u24 v128, 911, v128
    v_lshrrev_b32 v128, 16, v128
    v_mul_u32_u24 v128, s22, v128
    v_mad_u32_u24 v128, v126, s21, v128
    v_cmp_gt_u32 vcc, s17, v126
    v_add_u32 v128, s7, v128
    s_nop 0
    v_cndmask_b32 v128, v191, v128, vcc
    v_mul_u32_u24 v126, 384, v126
    v_sub_u32 v126, v129, v126
    v_add_u32 v128, v128, v126
    v_add_u32 v126, 256, v190
    v_mul_u32_u24 v129, 2731, v126
    v_bfe_u32 v130, v129, 17, 3
    v_lshrrev_b32 v129, 16, v129
    v_xor_b32 v126, v130, v126
    v_mul_u32_u24 v130, 37, v129
    v_lshrrev_b32 v130, 8, v130
    v_lshlrev_b32 v126, 4, v126
    v_mad_u32_u24 v11, v130, s70, v126
    v_mul_u32_u24 v130, s20, v129
    v_add_u32 v130, s38, v130
    v_mul_u32_u24 v130, 911, v130
    v_lshrrev_b32 v130, 16, v130
    v_mul_u32_u24 v130, s22, v130
    v_mad_u32_u24 v130, v129, s21, v130
    v_cmp_gt_u32 vcc, s17, v129
    v_add_u32 v130, s7, v130
    s_nop 0
    v_cndmask_b32 v130, v191, v130, vcc
    v_mul_u32_u24 v129, 384, v129
    v_sub_u32 v129, v126, v129
    v_add_u32 v130, v130, v129
    s_lshl_b32 s28, s16, 10
    s_add_u32 s28, s28, 20480
    s_waitcnt lgkmcnt(0)
    s_cmp_eq_u32 s16, 2
    s_cselect_b64 s[98:99], s[80:81], s[78:79]
    s_cmp_eq_u32 s16, 3
    s_cselect_b64 s[98:99], s[88:89], s[98:99]
    s_mov_b64 s[8:9], s[76:77]
    v_lshl_add_u64 v[114:115], s[98:99], 0, v[114:115]
    s_cmp_eq_u32 s16, 2
    s_cselect_b64 s[98:99], s[84:85], s[82:83]
    s_cmp_eq_u32 s16, 3
    s_cselect_b64 s[98:99], s[86:87], s[98:99]
    v_writelane_b32 v114, s98, 63
    v_writelane_b32 v115, s99, 63
    s_cmp_eq_u32 s16, 0
    s_cbranch_scc1 L_nowu
    global_load_dword a254, v[114:115], off
L_nowu:
    s_add_u32 m0, s28, 128512
    s_nop 0
    buffer_load_dwordx4 v128, s[8:11], 0 offen nt lds
    s_add_u32 m0, s28, 132608
    s_nop 0
    buffer_load_dwordx4 v130, s[8:11], 0 offen nt lds
    s_add_u32 m0, s28, 0
    s_nop 0
    buffer_load_dwordx4 v10, s[8:11], s25 offen nt lds
    s_add_u32 m0, s28, 4096
    s_nop 0
    buffer_load_dwordx4 v11, s[8:11], s25 offen nt lds
    s_mov_b64 s[48:49], s[78:79]
    s_mov_b64 s[52:53], s[80:81]
    s_mov_b64 s[60:61], s[84:85]
    s_mov_b64 s[64:65], s[86:87]
    s_mov_b64 s[56:57], s[88:89]
    s_mov_b64 s[46:47], s[82:83]
    s_load_dwordx2 s[42:43], s[0:1], 72
    s_add_u32 m0, s68, 0
    s_add_u32 s4, s45, 384
    v_add_u32 v114, s16, v254
    v_and_b32 v114, 3, v114
    v_lshlrev_b32 v114, 1, v114
    s_mov_b32 s54, 73728
    s_mov_b32 s55, 0x00020000
    s_mov_b32 s62, 64
    s_mov_b32 s63, 0x00020000
    s_mov_b32 s66, 128
    s_mov_b32 s67, 0x00020000
    s_mov_b32 s58, 676
    s_mov_b32 s59, 0x00020000
    s_mov_b32 s14, 0
    s_mov_b32 s15, 0x00020000
    v_mov_b32 v193, 0
    v_cmp_lt_u32 s[92:93], 7, v116
    v_mov_b32 v119, 0
    v_mov_b32 v129, 0
    v_mov_b32 v121, 0
    v_lshlrev_b32 v115, 1, v254
    v_mul_u32_u24 v126, 12, v116
    s_mul_i32 s71, s16, 192
    v_add_u32 v126, s71, v126
    v_lshlrev_b32 v128, 5, v255
    s_mul_i32 s72, s16, 8064
    s_add_u32 s72, s72, 104448
    s_mul_i32 s73, s16, 6528
    s_add_u32 s73, s73, 38912
    v_lshrrev_b32 v120, 2, v116
    v_and_b32 v118, 1, v120
    v_mul_u32_u24 v118, 0x020202, v118
    v_lshl_or_b32 v118, v118, 8, v118
    v_add_u32 v118, 0x05040100, v118
    v_and_b32 v131, 3, v116
    v_lshrrev_b32 v192, 1, v116
    v_xor_b32 v192, v192, v255
    v_mul_u32_u24 v130, 384, v116
    v_lshl_add_u32 v0, v192, 4, v130
    v_xor_b32 v1, 64, v0
    v_and_b32 v192, 2, v255
    v_add_u32 v192, v192, v255
    v_lshl_add_u32 v192, v192, 2, v120
    v_mul_u32_u24 v192, 96, v192
    v_lshl_add_u32 v192, v131, 3, v192
    v_add_u32 v133, s68, v192
    v_add_u32 v130, s69, v192
    v_add_u32 v132, s72, v192
    v_add_u32 v134, s73, v192
    v_mov_b32 v28, 0x3f803f80
    v_mov_b32 v29, 0x3f803f80
    v_mov_b32 v30, 0x3f803f80
    v_mov_b32 v31, 0x3f803f80
    v_mul_u32_u24 v135, 768, v255
    v_add_u32 v135, v126, v135
    v_add_u32 v135, 157184, v135
    s_mov_b32 s76, 0x3f80
    v_and_b32 v137, 1, v116
    v_lshlrev_b32 v137, 4, v137
    v_lshlrev_b32 v136, v137, s76
    v_mov_b32 v139, 0x3c003c00
    v_mov_b32 v44, 1.0
    v_mov_b32 v45, 1.0
    v_lshlrev_b32 v138, 4, v255
    s_mov_b32 s19, s38
    s_mov_b32 s23, s25
    s_mov_b32 s26, 0
    s_mov_b32 s27, 0
    s_mov_b32 s18, 0
    s_add_u32 s19, s19, s20
    s_add_u32 s23, s23, s21
    s_cmp_ge_u32 s19, 72
    s_cselect_b32 s34, 72, 0
    s_cselect_b32 s35, s22, 0
    s_sub_u32 s19, s19, s34
    s_add_u32 s23, s23, s35
    s_mov_b32 s24, s23
    s_add_u32 s19, s19, s20
    s_add_u32 s23, s23, s21
    s_cmp_ge_u32 s19, 72
    s_cselect_b32 s34, 72, 0
    s_cselect_b32 s35, s22, 0
    s_sub_u32 s19, s19, s34
    s_add_u32 s23, s23, s35
    s_mul_i32 s79, s16, 64
    v_lshl_add_u32 v141, v255, 4, s79
    s_mul_i32 s80, s16, 32
    s_add_u32 s80, s80, 256
    v_lshl_add_u32 v140, v255, 3, s80
    v_add_u32 v192, 0, v116
    v_mul_u32_u24 v142, 37, v192
    v_mul_u32_u24 v143, 384, v192
    v_lshrrev_b32 v142, 8, v142
    v_mad_u32_u24 v143, v142, s70, v143
    v_add_u32 v15, v143, v141
    v_add_u32 v18, v143, v140
    v_add_u32 v144, 16, v116
    v_mul_u32_u24 v143, 37, v144
    v_mul_u32_u24 v145, 384, v144
    v_lshrrev_b32 v143, 8, v143
    v_mad_u32_u24 v145, v143, s70, v145
    v_add_u32 v16, v145, v141
    v_add_u32 v19, v145, v140
    v_add_u32 v146, 32, v116
    v_mul_u32_u24 v145, 37, v146
    v_mul_u32_u24 v147, 384, v146
    v_lshrrev_b32 v145, 8, v145
    v_mad_u32_u24 v147, v145, s70, v147
    v_add_u32 v17, v147, v141
    v_add_u32 v20, v147, v140
    s_mul_i32 s81, s16, 768
    s_add_u32 s81, s81, 157184
    v_mul_u32_u24 v142, 24, v142
    v_lshl_add_u32 v142, v192, 2, v142
    v_add_u32 v22, s81, v142
    v_sub_u32 v23, s81, v142
    v_sub_u32 v192, v22, v138
    v_mul_u32_u24 v140, 24, v143
    v_lshl_add_u32 v140, v144, 2, v140
    v_add_u32 v24, s81, v140
    v_sub_u32 v25, s81, v140
    v_sub_u32 v141, v24, v138
    v_mul_u32_u24 v140, 24, v145
    v_lshl_add_u32 v140, v146, 2, v140
    v_add_u32 v26, s81, v140
    v_sub_u32 v27, s81, v140
    v_sub_u32 v140, v26, v138
    v_mul_u32_u24 v142, 148, v255
    s_mov_b32 s82, -24
    v_add_u32 v143, 0, v142
    v_lshrrev_b32 v143, 8, v143
    v_mad_i32_i24 v46, v143, s82, v192
    v_mad_i32_i24 v58, v143, s82, v141
    v_mad_i32_i24 v70, v143, s82, v140
    v_add_u32 v143, 37, v142
    v_lshrrev_b32 v143, 8, v143
    v_mad_i32_i24 v47, v143, s82, v192
    v_mad_i32_i24 v59, v143, s82, v141
    v_mad_i32_i24 v71, v143, s82, v140
    v_add_u32 v143, 74, v142
    v_lshrrev_b32 v143, 8, v143
    v_mad_i32_i24 v48, v143, s82, v192
    v_mad_i32_i24 v60, v143, s82, v141
    v_mad_i32_i24 v72, v143, s82, v140
    v_add_u32 v143, 111, v142
    v_lshrrev_b32 v143, 8, v143
    v_mad_i32_i24 v49, v143, s82, v192
    v_mad_i32_i24 v61, v143, s82, v141
    v_mad_i32_i24 v73, v143, s82, v140
    v_add_u32 v143, 592, v142
    v_lshrrev_b32 v143, 8, v143
    v_mad_i32_i24 v50, v143, s82, v192
    v_mad_i32_i24 v62, v143, s82, v141
    v_mad_i32_i24 v74, v143, s82, v140
    v_add_u32 v143, 629, v142
    v_lshrrev_b32 v143, 8, v143
    v_mad_i32_i24 v51, v143, s82, v192
    v_mad_i32_i24 v63, v143, s82, v141
    v_mad_i32_i24 v75, v143, s82, v140
    v_add_u32 v143, 666, v142
    v_lshrrev_b32 v143, 8, v143
    v_mad_i32_i24 v52, v143, s82, v192
    v_mad_i32_i24 v64, v143, s82, v141
    v_mad_i32_i24 v76, v143, s82, v140
    v_add_u32 v143, 703, v142
    v_lshrrev_b32 v143, 8, v143
    v_mad_i32_i24 v53, v143, s82, v192
    v_mad_i32_i24 v65, v143, s82, v141
    v_mad_i32_i24 v77, v143, s82, v140
    v_add_u32 v143, 1184, v142
    v_lshrrev_b32 v143, 8, v143
    v_mad_i32_i24 v54, v143, s82, v192
    v_mad_i32_i24 v66, v143, s82, v141
    s_lshr_b32 s83, s16, 1
    s_and_b32 s84, s16, 1
    buffer_load_dwordx4 v123, s[48:51], s4 offen lds
    v_mad_i32_i24 v78, v143, s82, v140
    v_add_u32 v143, 1221, v142
    v_lshrrev_b32 v143, 8, v143
    v_mad_i32_i24 v55, v143, s82, v192
    v_mad_i32_i24 v67, v143, s82, v141
    v_mad_i32_i24 v79, v143, s82, v140
    v_add_u32 v143, 1258, v142
    v_lshrrev_b32 v143, 8, v143
    v_mad_i32_i24 v56, v143, s82, v192
    v_mad_i32_i24 v68, v143, s82, v141
    v_mad_i32_i24 v80, v143, s82, v140
    s_lshl_b32 s84, s84, 3
    s_lshl_b32 s85, s83, 10
    buffer_load_dwordx4 v125, s[48:51], s4 offen offset:1024 lds
    v_add_u32 v142, 1295, v142
    v_lshrrev_b32 v142, 8, v142
    v_mad_i32_i24 v57, v142, s82, v192
    v_mad_i32_i24 v69, v142, s82, v141
    v_mad_i32_i24 v81, v142, s82, v140
    v_mov_b32 v140, s81
    v_lshlrev_b32 v141, 4, v254
    v_xor_b32 v2, 65536, v141
    v_lshl_add_u32 v3, s16, 10, v141
    s_add_u32 s85, s85, s84
    v_add_u32 v4, s85, v141
    s_lshl_b32 s83, s83, 11
    s_add_u32 s83, s83, s84
    buffer_load_dwordx4 v127, s[48:51], s4 offen offset:2048 lds
    s_add_u32 m0, s68, 3072
    s_add_u32 s4, s45, 37248
    s_add_u32 s83, s83, 144896
    s_mul_i32 s86, s16, 2048
    s_add_u32 s86, s86, 136704
    v_lshl_add_u32 v142, v255, 3, s86
    v_mov_b32 v141, s83
    v_mov_b32 v143, 161536
    v_mul_u32_u24 v144, 80, v255
    v_add3_u32 v5, v144, v137, s72
    v_lshl_add_u32 v6, v116, 2, s73
    s_mul_i32 s87, s16, 128
    s_add_u32 s87, s87, 65024
    buffer_load_ushort v192, v115, s[60:63], 0 offen
    v_add_u32 v9, s87, v138
    s_mov_b32 s40, s8
    s_mov_b32 s41, s9
    buffer_load_dwordx3 v[206:208], v126, s[56:59], 0 offen
    v_lshrrev_b32 v115, 1, v255
    s_mov_b32 s32, 0x2a8cbccc
    s_mov_b32 s33, 0x38fba882
    buffer_load_dwordx4 v[182:185], v128, s[64:67], 0 offen
    v_mul_u32_u24 v115, 48, v115
    s_add_u32 s75, s28, 16384
    s_cmp_lt_u32 s16, 2
    buffer_load_dwordx4 v[194:197], v128, s[64:67], 0 offen offset:16
    v_lshl_add_u32 v115, v255, 3, v115
    s_cselect_b32 s29, s75, 160256
    s_cselect_b32 s30, 65536, 0
    global_load_ushort v114, v114, s[46:47]
    v_lshl_add_u32 v115, v120, 4, v115
    s_xor_b32 s74, s29, s30
    s_mul_i32 s77, s16, 64
    buffer_load_dwordx4 v123, s[48:51], s4 offen lds
    v_lshl_add_u32 v115, v131, 1, v115
    v_add_u32 v8, s87, v115
    v_mov_b32 v37, 0
    v_mov_b32 v38, 0
    v_mov_b32 v39, 0
    v_add_u32 v126, 148992, v0
    v_add_u32 v145, 148992, v1
    v_lshlrev_b32 v128, 4, v116
    v_add_u32 v128, 160256, v128
    v_mul_u32_u24 v115, 336, v116
    v_add3_u32 v115, v115, v144, s72
    s_mul_i32 s78, s16, 32
    s_add_u32 s78, s78, 192
    buffer_load_dwordx4 v125, s[48:51], s4 offen offset:1024 lds
    v_mul_u32_u24 v144, 272, v116
    v_add3_u32 v144, v144, v138, s73
    v_mul_u32_u24 v147, 1088, v255
    v_add_u32 v147, v147, v6
    v_add_u32 v146, 5376, v115
    v_add_u32 v162, 4352, v144
    v_add_u32 v148, 4352, v147
    v_cmp_gt_u32 s[88:89], 16, v254
    v_mov_b32 v149, 0xf149f2ca
    v_add_u32 v209, 512, v190
    v_mul_u32_u24 v163, 2731, v209
    s_add_u32 s34, s18, 2
    s_mov_b32 s18, 1
    buffer_load_dwordx4 v127, s[48:51], s4 offen offset:2048 lds
    s_add_u32 m0, s69, 0
    s_add_u32 s4, s45, 74112
    v_bfe_u32 v164, v163, 17, 3
    v_lshrrev_b32 v163, 16, v163
    v_xor_b32 v209, v164, v209
    v_mul_u32_u24 v164, 37, v163
    v_lshrrev_b32 v164, 8, v164
    v_lshlrev_b32 v209, 4, v209
    v_mad_u32_u24 v12, v164, s70, v209
    v_add_u32 v209, 768, v190
    v_mul_u32_u24 v163, 2731, v209
    s_mov_b32 s27, s26
    s_mov_b32 s26, s25
    buffer_load_dwordx4 v123, s[48:51], s4 offen lds
    v_bfe_u32 v164, v163, 17, 3
    v_lshrrev_b32 v163, 16, v163
    v_xor_b32 v209, v164, v209
    v_mul_u32_u24 v164, 37, v163
    v_lshrrev_b32 v164, 8, v164
    v_lshlrev_b32 v209, 4, v209
    v_mad_u32_u24 v13, v164, s70, v209
    v_add_u32 v190, 1024, v190
    v_mul_u32_u24 v163, 2731, v190
    v_bfe_u32 v209, v163, 17, 3
    v_lshrrev_b32 v163, 16, v163
    v_xor_b32 v190, v209, v190
    v_mul_u32_u24 v209, 37, v163
    v_lshrrev_b32 v209, 8, v209
    v_lshlrev_b32 v190, 4, v190
    v_mad_u32_u24 v14, v209, s70, v190
    v_cmp_gt_u32 vcc, 48, v163
    v_mul_u32_u24 v190, 6, v117
    v_sub_u32 v209, v254, v190
    v_cndmask_b32 v14, v191, v14, vcc
    v_cmp_gt_u32 vcc, 2, v131
    v_mul_u32_u24 v190, 384, v117
    v_lshl_add_u32 v190, v209, 4, v190
    v_cndmask_b32 v32, 0, v136, vcc
    v_cndmask_b32 v33, v136, 0, vcc
    v_cndmask_b32 v34, 0, v136, vcc
    v_cndmask_b32 v35, v136, 0, vcc
    v_cmp_eq_u32 vcc, 0, v137
    v_add_u32 v117, s78, v190
    v_add_u32 v190, s77, v190
    v_cndmask_b32 v40, 0, v139, vcc
    v_cndmask_b32 v41, v139, 0, vcc
    v_cndmask_b32 v42, 0, v139, vcc
    v_cndmask_b32 v43, v139, 0, vcc
    v_cmp_eq_u32 vcc, v255, v120
    v_mul_u32_u24 v139, 6, v122
    v_sub_u32 v136, v254, v139
    v_cndmask_b32 v150, 0, v32, vcc
    v_cndmask_b32 v151, 0, v33, vcc
    v_cmp_gt_i32 vcc, 4, v209
    v_mul_u32_u24 v139, 384, v122
    v_lshl_add_u32 v139, v136, 4, v139
    v_cndmask_b32 v152, v117, v190, vcc
    v_add_u32 v122, s78, v139
    v_add_u32 v139, s77, v139
    v_cmp_gt_i32 vcc, -60, v136
    v_mul_u32_u24 v117, 6, v124
    v_sub_u32 v136, v254, v117
    v_cndmask_b32 v153, v122, v139, vcc
    v_mul_u32_u24 v117, 384, v124
    v_lshl_add_u32 v117, v136, 4, v117
    v_add_u32 v139, s78, v117
    v_add_u32 v117, s77, v117
    v_cmp_gt_i32 vcc, -124, v136
    v_mul_u32_u24 v136, 96, v116
    v_add3_u32 v254, v136, v138, s68
    v_cndmask_b32 v122, v139, v117, vcc
    v_cmp_gt_u32 vcc, 2, v255
    v_lshl_add_u32 v124, v255, 3, v136
    v_add3_u32 v124, v124, 64, s68
    v_cndmask_b32 v142, v141, v142, vcc
    v_lshl_add_u32 v142, v120, 9, v142
    v_lshl_add_u32 v142, v131, 1, v142
    v_cmp_gt_u32 vcc, 3, v255
    v_add3_u32 v139, v136, v138, s69
    v_lshl_add_u32 v117, v255, 3, v136
    v_cndmask_b32 v7, v143, v142, vcc
    v_cmp_gt_u32 vcc, 8, v116
    v_add3_u32 v117, v117, 64, s69
    v_add_u32 v116, 16, v116
    v_cndmask_b32 v146, v128, v146, vcc
    v_cndmask_b32 v162, v128, v162, vcc
    v_cmp_gt_u32 vcc, 2, v255
    v_cmp_gt_u32 s[94:95], s17, v116
    v_cmp_ne_u32 s[96:97], 0, v137
    v_cndmask_b32 v148, v128, v148, vcc
    v_cmp_lt_u32 s[98:99], 1, v131
    v_cmp_eq_u32 vcc, v255, v120
    v_sub_u32 v255, v144, v138
    v_sub_u32 v131, v162, v138
    v_cndmask_b32 v255, v128, v255, vcc
    v_cndmask_b32 v131, v128, v131, vcc
    s_add_u32 s19, s19, s20
    buffer_load_dwordx4 v125, s[48:51], s4 offen offset:1024 lds
    s_waitcnt vmcnt(12)
    s_barrier
    ds_read_b128 v[198:201], v0 offset:20480
    ds_read_b128 v[226:229], v1 offset:20480
    ds_read_b128 v[222:225], v0 offset:20608
    ds_read_b128 v[170:173], v1 offset:20608
    ds_read_b128 v[242:245], v0 offset:20736
    buffer_load_dwordx4 v127, s[48:51], s4 offen offset:2048 lds
    ds_read_b128 v[210:213], v1 offset:20736
    s_add_u32 m0, s69, 3072
    s_add_u32 s4, s45, 110976
    buffer_load_dwordx4 v123, s[48:51], s4 offen lds
    s_waitcnt vmcnt(12)
    ds_read_b64_tr_b16 a[72:73], v133 offset:0
    s_waitcnt vmcnt(10)
    ds_read_b64_tr_b16 a[74:75], v133 offset:768
    s_waitcnt vmcnt(9)
    ds_read_b64_tr_b16 a[96:97], v133 offset:32
    s_waitcnt vmcnt(8)
    ds_read_b64_tr_b16 a[98:99], v133 offset:800
    s_waitcnt vmcnt(7)
    ds_read_b64_tr_b16 a[120:121], v133 offset:64
    ds_read_b64_tr_b16 a[122:123], v133 offset:832
    buffer_load_dwordx4 v125, s[48:51], s4 offen offset:1024 lds
    v_cndmask_b32 v182, v182, v183, s[92:93]
    v_cndmask_b32 v184, v184, v185, s[92:93]
    v_perm_b32 v136, v184, v182, v118
    v_cndmask_b32 v194, v194, v195, s[92:93]
    v_cndmask_b32 v196, v196, v197, s[92:93]
    v_perm_b32 v137, v196, v194, v118
    v_bfe_u32 v118, v206, v138, 16
    v_bfe_u32 v128, v207, v138, 16
    v_bfe_u32 v120, v208, v138, 16
    v_mfma_f32_16x16x16_bf16 v[206:209], v[192:193], v[118:119], 0
    v_lshlrev_b32 v114, 16, v114
    v_max_f32 v114, 0xc2c80000, v114
    v_min_f32 v114, 0x40930000, v114
    v_mfma_f32_16x16x16_bf16 v[194:197], v[192:193], v[128:129], 0
    v_mul_f32 v114, 0x3fb8aa3b, v114
    v_exp_f32 v114, v114
    v_mfma_f32_16x16x16_bf16 v[182:185], v[192:193], v[120:121], 0
    s_waitcnt lgkmcnt(3)
    buffer_load_dwordx4 v127, s[48:51], s4 offen offset:2048 lds
    v_max_f32 v206, 0, v206
    v_mfma_f32_16x16x32_bf16 v[118:121], a[72:75], v[198:201], 0
    s_waitcnt lgkmcnt(0)
    v_max_f32 v207, 0, v207
    v_max_f32 v208, 0, v208
    v_mfma_f32_16x16x32_bf16 v[190:193], a[96:99], v[198:201], 0
    s_add_u32 m0, s72, 0
    v_max_f32 v209, 0, v209
    v_cvt_pk_bf16_f32 v128, v206, v207
    v_mfma_f32_16x16x32_bf16 v[158:161], a[120:123], v[198:201], 0
    s_add_u32 s4, s45, 147840
    ds_read_b128 v[154:157], v126 offset:6272
    buffer_load_dwordx4 v123, s[48:51], s4 offen lds
    v_cvt_pk_bf16_f32 v129, v208, v209
    v_max_f32 v194, 0, v194
    s_waitcnt vmcnt(7)
    v_mfma_f32_16x16x16_bf16 v[206:209], v[136:137], v[128:129], 0
    ds_read_b64_tr_b16 a[76:77], v133 offset:3072
    ds_read_b64_tr_b16 a[78:79], v133 offset:3840
    ds_read_b64_tr_b16 a[100:101], v133 offset:3104
    ds_read_b64_tr_b16 a[102:103], v133 offset:3872
    ds_read_b64_tr_b16 a[124:125], v133 offset:3136
    ds_read_b64_tr_b16 a[126:127], v133 offset:3904
    v_max_f32 v195, 0, v195
    buffer_load_dwordx4 v125, s[48:51], s4 offen offset:1024 lds
    v_cvt_pk_bf16_f32 v206, v206, v206
    v_and_b32 v206, 0xffff0000, v206
    v_mul_f32 v206, 0xbfb8aa3b, v206
    v_exp_f32 v206, v206
    v_max_f32 v196, 0, v196
    v_add_f32 v206, 1.0, v206
    v_rcp_f32 v206, v206
    v_max_f32 v197, 0, v197
    v_cvt_pk_bf16_f32 v206, v206, v206
    buffer_load_dwordx4 v127, s[48:51], s4 offen offset:2048 lds
    s_add_u32 m0, s72, 3072
    s_add_u32 s4, s45, 184704
    v_and_b32 v206, 0xffff0000, v206
    s_waitcnt lgkmcnt(4)
    v_mfma_f32_16x16x32_bf16 v[118:121], a[76:79], v[226:229], v[118:121]
    s_waitcnt lgkmcnt(2)
    v_add_f32 v206, -0.5, v206
    v_mul_f32 v206, 0x41b8aa3b, v206
    v_mfma_f32_16x16x32_bf16 v[190:193], a[100:103], v[226:229], v[190:193]
    s_waitcnt lgkmcnt(0)
    ds_write_b32 v135, v206 offset:0
    v_mfma_f32_16x16x32_bf16 v[158:161], a[124:127], v[226:229], v[158:161]
    buffer_load_dwordx4 v123, s[48:51], s4 offen lds
    v_cvt_pk_bf16_f32 v128, v194, v195
    v_cvt_pk_bf16_f32 v129, v196, v197
    v_max_f32 v182, 0, v182
    v_max_f32 v183, 0, v183
    v_mfma_f32_16x16x16_bf16 v[206:209], v[136:137], v[128:129], 0
    v_max_f32 v184, 0, v184
    v_max_f32 v185, 0, v185
    v_cvt_pk_bf16_f32 v128, v182, v183
    v_cvt_pk_bf16_f32 v129, v184, v185
    v_cvt_pk_bf16_f32 v114, v114, v114
    v_and_b32 v114, 0xffff0000, v114
    s_waitcnt vmcnt(7)
    v_mfma_f32_16x16x16_bf16 v[194:197], v[136:137], v[128:129], 0
    buffer_load_dwordx4 v125, s[48:51], s4 offen offset:1024 lds
    ds_read_b64_tr_b16 a[80:81], v130 offset:0
    ds_read_b64_tr_b16 a[82:83], v130 offset:768
    ds_read_b64_tr_b16 a[104:105], v130 offset:32
    ds_read_b64_tr_b16 a[106:107], v130 offset:800
    ds_read_b64_tr_b16 a[128:129], v130 offset:64
    ds_read_b64_tr_b16 a[130:131], v130 offset:832
    ds_read_b128 v[182:185], v145 offset:6272
    v_cvt_pk_bf16_f32 v206, v206, v206
    v_and_b32 v206, 0xffff0000, v206
    v_mul_f32 v206, 0xbfb8aa3b, v206
    v_exp_f32 v206, v206
    buffer_load_dwordx4 v127, s[48:51], s4 offen offset:2048 lds
    s_add_u32 m0, s73, 0
    s_add_u32 s4, s45, 36864
    v_add_f32 v206, 1.0, v206
    v_rcp_f32 v206, v206
    v_cvt_pk_bf16_f32 v194, v194, v194
    v_cvt_pk_bf16_f32 v206, v206, v206
    v_and_b32 v206, 0xffff0000, v206
    v_add_f32 v206, -0.5, v206
    v_mul_f32 v206, 0x41b8aa3b, v206
    ds_write_b32 v135, v206 offset:4
    s_waitcnt lgkmcnt(5)
    v_mfma_f32_16x16x32_bf16 v[118:121], a[80:83], v[222:225], v[118:121]
    s_waitcnt lgkmcnt(3)
    buffer_load_dwordx4 v123, s[48:51], s45 offen lds
    v_mfma_f32_16x16x32_bf16 v[190:193], a[104:107], v[222:225], v[190:193]
    s_waitcnt lgkmcnt(1)
    v_and_b32 v194, 0xffff0000, v194
    v_mul_f32 v194, 0xbfb8aa3b, v194
    v_mfma_f32_16x16x32_bf16 v[158:161], a[128:131], v[222:225], v[158:161]
    ds_read_b128 v[166:169], v126 offset:6400
    v_exp_f32 v194, v194
    v_mul_f32 v116, 0x3fb8aa3b, v114
    v_add_f32 v194, 1.0, v194
    buffer_load_dwordx4 v125, s[48:51], s45 offen offset:1024 lds
    s_waitcnt vmcnt(8)
    ds_read_b64_tr_b16 a[84:85], v130 offset:3072
    ds_read_b64_tr_b16 a[86:87], v130 offset:3840
    ds_read_b64_tr_b16 a[108:109], v130 offset:3104
    ds_read_b64_tr_b16 a[110:111], v130 offset:3872
    ds_read_b64_tr_b16 a[132:133], v130 offset:3136
    ds_read_b64_tr_b16 a[134:135], v130 offset:3904
    v_rcp_f32 v194, v194
    v_readfirstlane_b32 s37, v114
    v_cvt_pk_bf16_f32 v194, v194, v194
    buffer_load_dwordx4 v127, s[48:51], s45 offen offset:2048 lds
    s_add_u32 m0, s73, 3072
    v_and_b32 v194, 0xffff0000, v194
    v_add_f32 v194, -0.5, v194
    v_mul_f32 v194, 0x41b8aa3b, v194
    ds_write_b32 v135, v194 offset:8
    v_readfirstlane_b32 s31, v116
    v_mul_f32 v114, 0x3e000000, v114
    v_cmp_lt_f32 s[90:91], 4.0, v114
    buffer_load_dwordx4 v123, s[48:51], s4 offen lds
    s_waitcnt lgkmcnt(5)
    v_mfma_f32_16x16x32_bf16 v[118:121], a[84:87], v[170:173], v[118:121]
    s_waitcnt lgkmcnt(3)
    s_cmp_lg_u64 s[90:91], 0
    s_cbranch_scc1 L_slow
    v_mfma_f32_16x16x32_bf16 v[190:193], a[108:111], v[170:173], v[190:193]
    s_waitcnt lgkmcnt(1)
    v_mfma_f32_16x16x32_bf16 v[158:161], a[132:135], v[170:173], v[158:161]
    ds_read_b128 v[194:197], v145 offset:6400
    s_waitcnt vmcnt(7)
    buffer_load_dwordx4 v125, s[48:51], s4 offen offset:1024 lds
    ds_read_b64_tr_b16 a[88:89], v132 offset:0
    ds_read_b64_tr_b16 a[90:91], v132 offset:768
    ds_read_b64_tr_b16 a[112:113], v132 offset:32
    ds_read_b64_tr_b16 a[114:115], v132 offset:800
    s_waitcnt lgkmcnt(5)
    s_barrier
    ds_read_b64_tr_b16 a[136:137], v132 offset:64
    ds_read_b64_tr_b16 a[138:139], v132 offset:832
    ds_read_b32 v22, v22 offset:0
    ds_read_b32 v23, v23 offset:672
    ds_read_b32 v24, v24 offset:0
    ds_read_b32 v25, v25 offset:672
    buffer_load_dwordx4 v127, s[48:51], s4 offen offset:2048 lds
    ds_read_b32 v26, v26 offset:0
    ds_read_b32 v27, v27 offset:672
    ds_read_b32 v46, v46 offset:336
    s_add_u32 m0, s68, 0
    ds_read_b32 v58, v58 offset:336
    s_add_u32 s4, s45, 73728
    ds_read_b32 v70, v70 offset:336
    ds_read_b32 v47, v47 offset:332
    ds_read_b32 v59, v59 offset:332
    buffer_load_dwordx4 v123, s[48:51], s4 offen lds
    s_waitcnt lgkmcnt(14)
    v_mfma_f32_16x16x32_bf16 v[118:121], a[88:91], v[242:245], v[118:121]
    s_waitcnt lgkmcnt(13)
    ds_read_b32 v71, v71 offset:332
    ds_read_b32 v48, v48 offset:328
    v_mfma_f32_16x16x32_bf16 v[190:193], a[112:115], v[242:245], v[190:193]
    s_waitcnt lgkmcnt(12)
    ds_read_b128 v[206:209], v126 offset:6144
    ds_read_b32 v60, v60 offset:328
    v_mfma_f32_16x16x32_bf16 v[158:161], a[136:139], v[242:245], v[158:161]
    s_waitcnt lgkmcnt(11)
    ds_read_b32 v72, v72 offset:328
    ds_read_b32 v49, v49 offset:324
    s_waitcnt lgkmcnt(12)
    s_waitcnt vmcnt(7)
    buffer_load_dwordx4 v125, s[48:51], s4 offen offset:1024 lds
    ds_read_b64_tr_b16 a[92:93], v132 offset:3072
    ds_read_b64_tr_b16 a[94:95], v132 offset:3840
    ds_read_b64_tr_b16 a[116:117], v132 offset:3104
    ds_read_b64_tr_b16 a[118:119], v132 offset:3872
    ds_read_b64_tr_b16 a[140:141], v132 offset:3136
    ds_read_b64_tr_b16 a[142:143], v132 offset:3904
    ds_read_b32 v61, v61 offset:324
    ds_read_b32 v73, v73 offset:324
    ds_read_b32 v50, v50 offset:272
    buffer_load_dwordx4 v127, s[48:51], s4 offen offset:2048 lds
    ds_read_b32 v62, v62 offset:272
    ds_read_b32 v74, v74 offset:272
    ds_read_b32 v51, v51 offset:268
    s_waitcnt lgkmcnt(15)
    v_mfma_f32_16x16x32_bf16 v[186:189], a[72:75], v[206:209], 0
    s_add_u32 m0, s68, 3072
    ds_read_b32 v63, v63 offset:268
    ds_read_b32 v75, v75 offset:268
    v_mfma_f32_16x16x32_bf16 v[178:181], a[96:99], v[206:209], 0
    s_add_u32 s4, s45, 110592
    ds_read_b32 v52, v52 offset:264
    ds_read_b32 v64, v64 offset:264
    v_mfma_f32_16x16x32_bf16 v[202:205], a[120:123], v[206:209], 0
    s_waitcnt lgkmcnt(15)
    s_waitcnt lgkmcnt(14)
    ds_read_b32 v76, v76 offset:264
    v_mfma_f32_16x16x32_bf16 v[118:121], a[92:95], v[210:213], v[118:121]
    s_waitcnt lgkmcnt(12)
    buffer_load_dwordx4 v123, s[48:51], s4 offen lds
    v_mfma_f32_16x16x32_bf16 v[190:193], a[116:119], v[210:213], v[190:193]
    s_waitcnt lgkmcnt(9)
    ds_read_b128 v[214:217], v145 offset:6144
    ds_read_b32 v53, v53 offset:260
    v_mfma_f32_16x16x32_bf16 v[158:161], a[140:143], v[210:213], v[158:161]
    s_waitcnt lgkmcnt(10)
    ds_read_b32 v65, v65 offset:260
    ds_read_b32 v77, v77 offset:260
    ds_read_b32 v54, v54 offset:208
    ds_read_b32 v66, v66 offset:208
    ds_read_b32 v78, v78 offset:208
    s_waitcnt vmcnt(7)
    ds_read_b64_tr_b16 a[0:1], v134 offset:0
    buffer_load_dwordx4 v125, s[48:51], s4 offen offset:1024 lds
    ds_read_b64_tr_b16 a[2:3], v134 offset:768
    ds_read_b64_tr_b16 a[24:25], v134 offset:32
    ds_read_b64_tr_b16 a[26:27], v134 offset:800
    ds_read_b64_tr_b16 a[48:49], v134 offset:64
    ds_read_b64_tr_b16 a[50:51], v134 offset:832
    ds_read_b32 v55, v55 offset:204
    ds_read_b32 v67, v67 offset:204
    buffer_load_dwordx4 v127, s[48:51], s4 offen offset:2048 lds
    s_waitcnt lgkmcnt(14)
    v_mfma_f32_16x16x32_bf16 v[186:189], a[76:79], v[214:217], v[186:189]
    s_add_u32 m0, s69, 0
    ds_read_b32 v79, v79 offset:204
    ds_read_b32 v56, v56 offset:200
    v_mfma_f32_16x16x32_bf16 v[186:189], a[80:83], v[154:157], v[186:189]
    s_add_u32 s4, s45, 147456
    ds_read_b32 v68, v68 offset:200
    ds_read_b32 v80, v80 offset:200
    v_mfma_f32_16x16x32_bf16 v[186:189], a[84:87], v[182:185], v[186:189]
    s_waitcnt lgkmcnt(11)
    ds_read_b32 v57, v57 offset:196
    ds_read_b32 v69, v69 offset:196
    v_mfma_f32_16x16x32_bf16 v[186:189], a[88:91], v[166:169], v[186:189]
    s_waitcnt lgkmcnt(11)
    buffer_load_dwordx4 v123, s[48:51], s4 offen lds
    v_mfma_f32_16x16x32_bf16 v[206:209], a[0:3], v[198:201], 0
    s_waitcnt lgkmcnt(9)
    ds_read_b32 v81, v81 offset:196
    ds_read_b32 v140, v140 offset:336
    v_mfma_f32_16x16x32_bf16 v[174:177], a[24:27], v[198:201], 0
    s_waitcnt lgkmcnt(9)
    v_cndmask_b32 v22, v149, v22, s[88:89]
    v_cndmask_b32 v24, v149, v24, s[88:89]
    v_mfma_f32_16x16x32_bf16 v[218:221], a[48:51], v[198:201], 0
    s_waitcnt vmcnt(7)
    ds_read_b64_tr_b16 a[4:5], v134 offset:3072
    ds_read_b64_tr_b16 a[6:7], v134 offset:3840
    v_mfma_f32_16x16x32_bf16 v[186:189], a[92:95], v[194:197], v[186:189]
    s_waitcnt lgkmcnt(10)
    buffer_load_dwordx4 v125, s[48:51], s4 offen offset:1024 lds
    v_mfma_f32_16x16x32_bf16 v[178:181], a[100:103], v[214:217], v[178:181]
    s_waitcnt lgkmcnt(8)
    ds_read_b64_tr_b16 a[28:29], v134 offset:3104
    ds_read_b64_tr_b16 a[30:31], v134 offset:3872
    v_mfma_f32_16x16x32_bf16 v[178:181], a[104:107], v[154:157], v[178:181]
    s_waitcnt lgkmcnt(8)
    ds_read_b64_tr_b16 a[52:53], v134 offset:3136
    ds_read_b64_tr_b16 a[54:55], v134 offset:3904
    v_mfma_f32_16x16x32_bf16 v[178:181], a[108:111], v[182:185], v[178:181]
    s_waitcnt lgkmcnt(8)
    ds_read_b128 v[198:201], v126 offset:128
    v_cndmask_b32 v26, v149, v26, s[88:89]
    v_mfma_f32_16x16x32_bf16 v[178:181], a[112:115], v[166:169], v[178:181]
    buffer_load_dwordx4 v127, s[48:51], s4 offen offset:2048 lds
    v_mfma_f32_16x16x32_bf16 v[178:181], a[116:119], v[194:197], v[178:181]
    s_waitcnt lgkmcnt(7)
    v_readfirstlane_b32 s39, v140
    v_mov_b32 v134, 0
    v_mfma_f32_16x16x32_bf16 v[202:205], a[124:127], v[214:217], v[202:205]
    s_add_u32 m0, s69, 3072
    v_mov_b32 v135, 0
    v_mov_b32 v136, 0
    v_mfma_f32_16x16x32_bf16 v[202:205], a[128:131], v[154:157], v[202:205]
    s_waitcnt lgkmcnt(5)
    ds_write_b64 v115, v[134:135] offset:56
    v_mfma_f32_16x16x32_bf16 v[206:209], a[4:7], v[226:229], v[206:209]
    s_add_u32 s4, s45, 184320
    buffer_load_dwordx4 v123, s[48:51], s4 offen lds
    v_mfma_f32_16x16x32_bf16 v[202:205], a[132:135], v[182:185], v[202:205]
    s_waitcnt lgkmcnt(3)
    ds_write_b64 v115, v[134:135] offset:64
    v_mfma_f32_16x16x32_bf16 v[174:177], a[28:31], v[226:229], v[174:177]
    s_waitcnt lgkmcnt(2)
    s_waitcnt vmcnt(7)
    v_mov_b32 v137, 0
    v_mfma_f32_16x16x32_bf16 v[218:221], a[52:55], v[226:229], v[218:221]
    ds_read_b64_tr_b16 a[8:9], v133 offset:0
    ds_read_b64_tr_b16 a[10:11], v133 offset:768
    v_mfma_f32_16x16x32_bf16 v[202:205], a[136:139], v[166:169], v[202:205]
    buffer_load_dwordx4 v125, s[48:51], s4 offen offset:1024 lds
    v_mfma_f32_16x16x32_bf16 v[202:205], a[140:143], v[194:197], v[202:205]
    ds_read_b64_tr_b16 a[32:33], v133 offset:32
    ds_read_b64_tr_b16 a[34:35], v133 offset:800
    ds_read_b64_tr_b16 a[56:57], v133 offset:64
    ds_read_b64_tr_b16 a[58:59], v133 offset:832
    ds_read_b128 v[182:185], v145 offset:128
    ds_write_b128 v115, v[134:137] offset:16
    buffer_load_dwordx4 v127, s[48:51], s4 offen offset:2048 lds
    s_add_u32 m0, s28, 8192
    s_add_u32 s4, s45, 768
    v_mov_b32 v194, v149
    v_mov_b32 v195, v149
    ds_write_b128 v146, v[134:137] offset:16
    s_waitcnt lgkmcnt(7)
    v_mfma_f32_16x16x32_bf16 v[206:209], a[8:11], v[222:225], v[206:209]
    buffer_load_dwordx4 v12, s[8:11], s25 offen nt lds
    s_waitcnt lgkmcnt(5)
    v_mfma_f32_16x16x32_bf16 v[174:177], a[32:35], v[222:225], v[174:177]
    s_waitcnt lgkmcnt(3)
    v_mov_b32 v196, v149
    v_mov_b32 v197, v149
    v_mfma_f32_16x16x32_bf16 v[218:221], a[56:59], v[222:225], v[218:221]
    s_add_u32 m0, s28, 12288
    ds_read_b128 v[222:225], v126 offset:256
    ds_write_b64 v146, v[134:135] offset:56
    s_waitcnt vmcnt(7)
    buffer_load_dwordx4 v13, s[8:11], s25 offen nt lds
    s_add_u32 m0, s29, 0
    ds_read_b64_tr_b16 a[12:13], v133 offset:3072
    ds_read_b64_tr_b16 a[14:15], v133 offset:3840
    ds_read_b64_tr_b16 a[36:37], v133 offset:3104
    ds_read_b64_tr_b16 a[38:39], v133 offset:3872
    ds_read_b64_tr_b16 a[60:61], v133 offset:3136
    ds_read_b64_tr_b16 a[62:63], v133 offset:3904
    ds_write_b64 v146, v[134:135] offset:64
    v_cvt_pk_f16_f32 v118, v118, v119
    buffer_load_dwordx4 v14, s[8:11], s25 offen nt lds
    ds_write_b128 v144, v[194:197] offset:192
    s_add_u32 m0, s68, 0
    s_cmp_lt_u32 1, s17
    s_cselect_b32 s10, s36, 0
    v_pk_mul_f16 v163, v118, v118
    v_cvt_pk_f16_f32 v119, v120, v121
    v_pk_mul_f16 v165, v119, v119
    s_mov_b32 s25, s24
    buffer_load_dwordx4 v123, s[48:51], s4 offen lds
    s_waitcnt lgkmcnt(6)
    v_mfma_f32_16x16x32_bf16 v[206:209], a[12:15], v[170:173], v[206:209]
    s_waitcnt lgkmcnt(4)
    ds_write_b128 v162, v[194:197] offset:192
    v_mfma_f32_16x16x32_bf16 v[174:177], a[36:39], v[170:173], v[174:177]
    s_waitcnt lgkmcnt(2)
    v_cvt_pk_f16_f32 v120, v190, v191
    v_pk_fma_f16 v163, v120, v120, v163
    v_mfma_f32_16x16x32_bf16 v[218:221], a[60:63], v[170:173], v[218:221]
    s_waitcnt vmcnt(7)
    buffer_load_dwordx4 v125, s[48:51], s4 offen offset:1024 lds
    ds_read_b64_tr_b16 a[16:17], v130 offset:0
    ds_read_b64_tr_b16 a[18:19], v130 offset:768
    ds_read_b64_tr_b16 a[40:41], v130 offset:32
    ds_read_b64_tr_b16 a[42:43], v130 offset:800
    ds_read_b64_tr_b16 a[64:65], v130 offset:64
    ds_read_b64_tr_b16 a[66:67], v130 offset:832
    ds_read_b128 v[226:229], v145 offset:256
    v_cvt_pk_f16_f32 v121, v192, v193
    v_pk_fma_f16 v165, v121, v121, v165
    v_cvt_pk_f16_f32 v196, v158, v159
    buffer_load_dwordx4 v127, s[48:51], s4 offen offset:2048 lds
    s_add_u32 m0, s68, 3072
    s_add_u32 s4, s45, 37632
    v_pk_fma_f16 v163, v196, v196, v163
    v_cvt_pk_f16_f32 v197, v160, v161
    v_pk_fma_f16 v165, v197, v197, v165
    v_cvt_pk_f16_f32 v190, v186, v187
    v_pk_mul_f16 v171, v190, v190
    v_cvt_pk_f16_f32 v191, v188, v189
    v_pk_mul_f16 v173, v191, v191
    v_cvt_pk_f16_f32 v192, v178, v179
    v_pk_fma_f16 v171, v192, v192, v171
    buffer_load_dwordx4 v123, s[48:51], s4 offen lds
    s_waitcnt lgkmcnt(5)
    v_mfma_f32_16x16x32_bf16 v[206:209], a[16:19], v[242:245], v[206:209]
    s_waitcnt lgkmcnt(3)
    v_cvt_pk_f16_f32 v193, v180, v181
    v_pk_fma_f16 v173, v193, v193, v173
    v_mfma_f32_16x16x32_bf16 v[174:177], a[40:43], v[242:245], v[174:177]
    s_waitcnt lgkmcnt(0)
    ds_read_b128 v[134:137], v126 offset:0
    v_cvt_pk_f16_f32 v156, v202, v203
    v_mfma_f32_16x16x32_bf16 v[218:221], a[64:67], v[242:245], v[218:221]
    buffer_load_dwordx4 v125, s[48:51], s4 offen offset:1024 lds
    v_pk_fma_f16 v171, v156, v156, v171
    s_waitcnt vmcnt(8)
    ds_read_b64_tr_b16 a[20:21], v130 offset:3072
    ds_read_b64_tr_b16 a[22:23], v130 offset:3840
    ds_read_b64_tr_b16 a[44:45], v130 offset:3104
    ds_read_b64_tr_b16 a[46:47], v130 offset:3872
    ds_read_b64_tr_b16 a[68:69], v130 offset:3136
    ds_read_b64_tr_b16 a[70:71], v130 offset:3904
    v_cvt_pk_f16_f32 v157, v204, v205
    v_pk_fma_f16 v173, v157, v157, v173
    buffer_load_dwordx4 v127, s[48:51], s4 offen offset:2048 lds
    s_add_u32 m0, s69, 0
    s_add_u32 s4, s45, 74496
    s_waitcnt lgkmcnt(6)
    v_mfma_f32_16x16x32_bf16 v[242:245], a[72:75], v[134:137], 0
    v_mfma_f32_16x16x32_bf16 v[178:181], a[96:99], v[134:137], 0
    ds_read_b128 v[158:161], v126 offset:6144
    v_mfma_f32_16x16x32_bf16 v[202:205], a[120:123], v[134:137], 0
    buffer_load_dwordx4 v123, s[48:51], s4 offen lds
    v_mfma_f32_16x16x32_bf16 v[166:169], a[0:3], v[134:137], 0
    s_waitcnt lgkmcnt(4)
    v_mfma_f32_16x16x32_bf16 v[206:209], a[20:23], v[210:213], v[206:209]
    s_waitcnt lgkmcnt(1)
    v_mfma_f32_16x16x32_bf16 v[174:177], a[44:47], v[210:213], v[174:177]
    ds_read_b128 v[186:189], v145 offset:0
    v_mfma_f32_16x16x32_bf16 v[218:221], a[68:71], v[210:213], v[218:221]
    buffer_load_dwordx4 v125, s[48:51], s4 offen offset:1024 lds
    v_mfma_f32_16x16x32_bf16 v[210:213], a[24:27], v[134:137], 0
    v_mfma_f32_16x16x32_bf16 v[214:217], a[48:51], v[134:137], 0
    s_nop 0
    s_waitcnt lgkmcnt(1)
    v_cvt_pk_f16_f32 v206, v206, v207
    v_mfma_f32_16x16x32_bf16 v[230:233], a[0:3], v[158:161], 0
    v_pk_mul_f16 v162, v206, v206
    v_cvt_pk_f16_f32 v207, v208, v209
    v_mfma_f32_16x16x32_bf16 v[234:237], a[24:27], v[158:161], 0
    buffer_load_dwordx4 v127, s[48:51], s4 offen offset:2048 lds
    v_mfma_f32_16x16x32_bf16 v[134:137], a[48:51], v[158:161], 0
    s_add_u32 m0, s69, 3072
    s_add_u32 s4, s45, 111360
    v_pk_mul_f16 v164, v207, v207
    v_cvt_pk_f16_f32 v208, v174, v175
    v_pk_fma_f16 v162, v208, v208, v162
    s_waitcnt lgkmcnt(0)
    v_mfma_f32_16x16x32_bf16 v[242:245], a[76:79], v[186:189], v[242:245]
    v_cvt_pk_f16_f32 v209, v176, v177
    v_pk_fma_f16 v164, v209, v209, v164
    v_mfma_f32_16x16x32_bf16 v[242:245], a[80:83], v[198:201], v[242:245]
    v_cvt_pk_f16_f32 v194, v218, v219
    v_pk_fma_f16 v162, v194, v194, v162
    v_mfma_f32_16x16x32_bf16 v[242:245], a[84:87], v[182:185], v[242:245]
    v_cvt_pk_f16_f32 v195, v220, v221
    v_pk_fma_f16 v164, v195, v195, v164
    v_mfma_f32_16x16x32_bf16 v[242:245], a[88:91], v[222:225], v[242:245]
    v_mfma_f32_16x16x32_bf16 v[242:245], a[92:95], v[226:229], v[242:245]
    v_mfma_f32_16x16x32_f16 v[158:161], v[40:43], v[162:165], 0
    v_mfma_f32_16x16x32_bf16 v[178:181], a[100:103], v[186:189], v[178:181]
    ds_read_b128 v[174:177], v145 offset:6144
    v_mfma_f32_16x16x32_bf16 v[178:181], a[104:107], v[198:201], v[178:181]
    ds_read_b128 v[218:221], v126 offset:6272
    v_mfma_f32_16x16x32_bf16 v[178:181], a[108:111], v[182:185], v[178:181]
    ds_read_b128 v[162:165], v145 offset:6272
    v_mfma_f32_16x16x32_bf16 v[178:181], a[112:115], v[222:225], v[178:181]
    ds_read_b128 v[238:241], v126 offset:6400
    v_min3_u32 v44, v44, v158, v159
    v_mfma_f32_16x16x32_bf16 v[178:181], a[116:119], v[226:229], v[178:181]
    ds_read_b128 v[246:249], v145 offset:6400
    v_max3_u32 v45, v45, v158, v159
    v_mfma_f32_16x16x32_bf16 v[202:205], a[124:127], v[186:189], v[202:205]
    v_rsq_f32 v160, v158
    v_mfma_f32_16x16x32_bf16 v[202:205], a[128:131], v[198:201], v[202:205]
    v_rsq_f32 v161, v159
    v_mfma_f32_16x16x32_bf16 v[202:205], a[132:135], v[182:185], v[202:205]
    v_mul_f32 v160, s31, v160
    v_cvt_pk_f16_f32 v160, v160, v161
    v_mfma_f32_16x16x32_bf16 v[202:205], a[136:139], v[222:225], v[202:205]
    s_waitcnt lgkmcnt(4)
    v_pk_mul_f16 v118, v118, v160 op_sel:[0,1] op_sel_hi:[1,1]
    v_pk_mul_f16 v119, v119, v160 op_sel:[0,1] op_sel_hi:[1,1]
    v_mfma_f32_16x16x32_bf16 v[202:205], a[140:143], v[226:229], v[202:205]
    s_waitcnt lgkmcnt(3)
    v_pk_mul_f16 v120, v120, v160 op_sel:[0,1] op_sel_hi:[1,1]
    v_pk_mul_f16 v121, v121, v160 op_sel:[0,1] op_sel_hi:[1,1]
    v_mfma_f32_16x16x32_bf16 v[166:169], a[4:7], v[186:189], v[166:169]
    s_waitcnt lgkmcnt(2)
    v_pk_mul_f16 v196, v196, v160 op_sel:[0,1] op_sel_hi:[1,1]
    v_pk_mul_f16 v197, v197, v160 op_sel:[0,1] op_sel_hi:[1,1]
    v_mfma_f32_16x16x32_bf16 v[166:169], a[8:11], v[198:201], v[166:169]
    s_waitcnt lgkmcnt(1)
    v_pk_mul_f16 v206, v206, v160 op_sel:[0,0] op_sel_hi:[1,0]
    v_pk_mul_f16 v207, v207, v160 op_sel:[0,0] op_sel_hi:[1,0]
    v_mfma_f32_16x16x32_bf16 v[166:169], a[12:15], v[182:185], v[166:169]
    s_waitcnt lgkmcnt(0)
    v_pk_mul_f16 v208, v208, v160 op_sel:[0,0] op_sel_hi:[1,0]
    v_pk_mul_f16 v209, v209, v160 op_sel:[0,0] op_sel_hi:[1,0]
    v_mfma_f32_16x16x32_bf16 v[166:169], a[16:19], v[222:225], v[166:169]
    v_pk_mul_f16 v194, v194, v160 op_sel:[0,0] op_sel_hi:[1,0]
    v_pk_mul_f16 v195, v195, v160 op_sel:[0,0] op_sel_hi:[1,0]
    v_mfma_f32_16x16x32_bf16 v[166:169], a[20:23], v[226:229], v[166:169]
    v_cvt_pk_f16_f32 v158, v242, v243
    v_pk_mul_f16 v243, v158, v158
    v_mfma_f32_16x16x32_bf16 v[210:213], a[28:31], v[186:189], v[210:213]
    v_cvt_pk_f16_f32 v159, v244, v245
    v_pk_mul_f16 v245, v159, v159
    v_mfma_f32_16x16x32_bf16 v[210:213], a[32:35], v[198:201], v[210:213]
    v_cvt_pk_f16_f32 v160, v178, v179
    v_pk_fma_f16 v243, v160, v160, v243
    v_mfma_f32_16x16x32_bf16 v[210:213], a[36:39], v[182:185], v[210:213]
    v_cvt_pk_f16_f32 v161, v180, v181
    v_pk_fma_f16 v245, v161, v161, v245
    v_mfma_f32_16x16x32_bf16 v[210:213], a[40:43], v[222:225], v[210:213]
    v_cvt_pk_f16_f32 v180, v202, v203
    v_pk_fma_f16 v243, v180, v180, v243
    v_mfma_f32_16x16x32_bf16 v[210:213], a[44:47], v[226:229], v[210:213]
    v_cvt_pk_f16_f32 v181, v204, v205
    v_pk_fma_f16 v245, v181, v181, v245
    v_mfma_f32_16x16x32_bf16 v[214:217], a[52:55], v[186:189], v[214:217]
    v_cvt_pk_f16_f32 v166, v166, v167
    v_pk_mul_f16 v242, v166, v166
    v_mfma_f32_16x16x32_bf16 v[214:217], a[56:59], v[198:201], v[214:217]
    v_cvt_pk_f16_f32 v167, v168, v169
    v_pk_mul_f16 v244, v167, v167
    v_mfma_f32_16x16x32_bf16 v[214:217], a[60:63], v[182:185], v[214:217]
    v_cvt_pk_f16_f32 v168, v210, v211
    v_pk_fma_f16 v242, v168, v168, v242
    v_mfma_f32_16x16x32_bf16 v[214:217], a[64:67], v[222:225], v[214:217]
    v_cvt_pk_f16_f32 v169, v212, v213
    v_pk_fma_f16 v244, v169, v169, v244
    v_mfma_f32_16x16x32_bf16 v[214:217], a[68:71], v[226:229], v[214:217]
    v_mfma_f32_16x16x32_bf16 v[230:233], a[4:7], v[174:177], v[230:233]
    v_mfma_f32_16x16x32_bf16 v[230:233], a[8:11], v[218:221], v[230:233]
    v_mfma_f32_16x16x32_bf16 v[230:233], a[12:15], v[162:165], v[230:233]
    v_mfma_f32_16x16x32_bf16 v[230:233], a[16:19], v[238:241], v[230:233]
    v_mfma_f32_16x16x32_bf16 v[230:233], a[20:23], v[246:249], v[230:233]
    v_mfma_f32_16x16x32_bf16 v[234:237], a[28:31], v[174:177], v[234:237]
    v_mfma_f32_16x16x32_bf16 v[234:237], a[32:35], v[218:221], v[234:237]
    v_mfma_f32_16x16x32_bf16 v[234:237], a[36:39], v[162:165], v[234:237]
    v_cvt_pk_f16_f32 v178, v214, v215
    v_pk_fma_f16 v242, v178, v178, v242
    v_mfma_f32_16x16x32_bf16 v[234:237], a[40:43], v[238:241], v[234:237]
    v_cvt_pk_f16_f32 v179, v216, v217
    v_pk_fma_f16 v244, v179, v179, v244
    v_mfma_f32_16x16x32_bf16 v[234:237], a[44:47], v[246:249], v[234:237]
    v_cvt_pk_f16_f32 v222, v230, v231
    v_pk_mul_f16 v170, v222, v222
    v_mfma_f32_16x16x32_f16 v[182:185], v[40:43], v[242:245], 0
    v_cvt_pk_f16_f32 v223, v232, v233
    v_pk_mul_f16 v172, v223, v223
    v_mfma_f32_16x16x32_bf16 v[134:137], a[52:55], v[174:177], v[134:137]
    v_mfma_f32_16x16x32_bf16 v[134:137], a[56:59], v[218:221], v[134:137]
    v_mfma_f32_16x16x32_bf16 v[134:137], a[60:63], v[162:165], v[134:137]
    v_cvt_pk_f16_f32 v224, v234, v235
    v_pk_fma_f16 v170, v224, v224, v170
    v_mfma_f32_16x16x32_bf16 v[134:137], a[64:67], v[238:241], v[134:137]
    v_rsq_f32 v184, v182
    v_mfma_f32_16x16x32_bf16 v[134:137], a[68:71], v[246:249], v[134:137]
    v_rsq_f32 v185, v183
    v_mfma_f32_16x16x32_f16 v[210:213], v[118:121], v[206:209], v[46:49]
    v_mul_f32 v184, s31, v184
    v_cvt_pk_f16_f32 v184, v184, v185
    v_pk_mul_f16 v158, v158, v184 op_sel:[0,1] op_sel_hi:[1,1]
    v_pk_mul_f16 v159, v159, v184 op_sel:[0,1] op_sel_hi:[1,1]
    v_pk_mul_f16 v160, v160, v184 op_sel:[0,1] op_sel_hi:[1,1]
    v_pk_mul_f16 v161, v161, v184 op_sel:[0,1] op_sel_hi:[1,1]
    v_mfma_f32_16x16x16_f16 v[210:213], v[196:197], v[194:195], v[210:213]
    v_pk_mul_f16 v180, v180, v184 op_sel:[0,1] op_sel_hi:[1,1]
    v_pk_mul_f16 v181, v181, v184 op_sel:[0,1] op_sel_hi:[1,1]
    v_pk_mul_f16 v166, v166, v184 op_sel:[0,0] op_sel_hi:[1,0]
    v_pk_mul_f16 v167, v167, v184 op_sel:[0,0] op_sel_hi:[1,0]
    v_pk_mul_f16 v168, v168, v184 op_sel:[0,0] op_sel_hi:[1,0]
    v_pk_mul_f16 v169, v169, v184 op_sel:[0,0] op_sel_hi:[1,0]
    v_pk_mul_f16 v178, v178, v184 op_sel:[0,0] op_sel_hi:[1,0]
    v_pk_mul_f16 v179, v179, v184 op_sel:[0,0] op_sel_hi:[1,0]
    v_mfma_f32_16x16x32_f16 v[242:245], v[158:161], v[166:169], 0
    ds_write_b128 v115, v[158:161]
    v_min3_u32 v44, v44, v182, v183
    v_max3_u32 v45, v45, v182, v183
    v_cvt_pk_f16_f32 v225, v236, v237
    v_pk_fma_f16 v172, v225, v225, v172
    v_cvt_pk_f16_f32 v154, v134, v135
    v_mfma_f32_16x16x16_f16 v[242:245], v[180:181], v[178:179], v[242:245]
    v_pk_fma_f16 v170, v154, v154, v170
    ds_write_b64 v115, v[180:181] offset:48
    v_cvt_pk_f16_f32 v155, v136, v137
    v_pk_fma_f16 v172, v155, v155, v172
    v_exp_f32 v210, v210
    ds_write_b128 v115, v[166:169] offset:32
    v_mfma_f32_16x16x32_f16 v[182:185], v[40:43], v[170:173], 0
    v_exp_f32 v211, v211
    v_cndmask_b32 v242, v242, v243, s[96:97]
    v_cndmask_b32 v244, v244, v245, s[96:97]
    v_cndmask_b32 v242, v242, v244, s[98:99]
    v_add_f32 v242, s39, v242
    ds_write_b32 v255, v242 offset:192
    v_cvt_pk_bf16_f32 v210, v210, v211
    v_exp_f32 v212, v212
    v_rsq_f32 v184, v182
    ds_write_b64 v115, v[178:179] offset:72
    v_rsq_f32 v185, v183
    v_mul_f32 v184, s31, v184
    v_cvt_pk_f16_f32 v184, v184, v185
    v_pk_mul_f16 v190, v190, v184 op_sel:[0,1] op_sel_hi:[1,1]
    v_pk_mul_f16 v191, v191, v184 op_sel:[0,1] op_sel_hi:[1,1]
    v_pk_mul_f16 v192, v192, v184 op_sel:[0,1] op_sel_hi:[1,1]
    v_pk_mul_f16 v193, v193, v184 op_sel:[0,1] op_sel_hi:[1,1]
    v_pk_mul_f16 v156, v156, v184 op_sel:[0,1] op_sel_hi:[1,1]
    v_pk_mul_f16 v157, v157, v184 op_sel:[0,1] op_sel_hi:[1,1]
    v_pk_mul_f16 v222, v222, v184 op_sel:[0,0] op_sel_hi:[1,0]
    v_pk_mul_f16 v223, v223, v184 op_sel:[0,0] op_sel_hi:[1,0]
    v_pk_mul_f16 v224, v224, v184 op_sel:[0,0] op_sel_hi:[1,0]
    v_pk_mul_f16 v225, v225, v184 op_sel:[0,0] op_sel_hi:[1,0]
    v_pk_mul_f16 v154, v154, v184 op_sel:[0,0] op_sel_hi:[1,0]
    v_pk_mul_f16 v155, v155, v184 op_sel:[0,0] op_sel_hi:[1,0]
    v_mfma_f32_16x16x32_f16 v[242:245], v[190:193], v[222:225], 0
    ds_write_b128 v146, v[190:193]
    v_cndmask_b32 v182, 1.0, v182, s[94:95]
    v_cndmask_b32 v183, 1.0, v183, s[94:95]
    v_min3_u32 v44, v44, v182, v183
    v_max3_u32 v45, v45, v182, v183
    v_exp_f32 v213, v213
    v_mfma_f32_16x16x16_f16 v[242:245], v[156:157], v[154:155], v[242:245]
    ds_write_b64 v146, v[156:157] offset:48
    v_cvt_pk_bf16_f32 v211, v212, v213
    s_nop 0
    buffer_load_dwordx4 v123, s[48:51], s4 offen lds
    ds_write_b128 v146, v[222:225] offset:32
    s_nop 0
    s_nop 0
    s_nop 0
    v_cndmask_b32 v242, v242, v243, s[96:97]
    v_cndmask_b32 v244, v244, v245, s[96:97]
    v_cndmask_b32 v242, v242, v244, s[98:99]
    buffer_load_dwordx4 v125, s[48:51], s4 offen offset:1024 lds
    ds_write_b64 v146, v[154:155] offset:72
    v_add_f32 v242, s39, v242
    buffer_load_dwordx4 v127, s[48:51], s4 offen offset:2048 lds
    s_waitcnt vmcnt(12)
    s_barrier
    ds_read_b128 v[182:185], v0 offset:26624
    ds_read_b128 v[190:193], v1 offset:26624
    ds_read_b128 v[134:137], v0 offset:26752
    s_add_u32 m0, s68, 0
    s_add_u32 s4, s45, 148224
    ds_read_b128 v[222:225], v1 offset:26752
    ds_read_b128 v[198:201], v0 offset:26880
    ds_read_b128 v[226:229], v1 offset:26880
    ds_write_b32 v131, v242 offset:192
    s_waitcnt lgkmcnt(6)
    v_mfma_f32_16x16x32_bf16 v[242:245], a[72:75], v[182:185], 0
    s_waitcnt lgkmcnt(5)
    v_mfma_f32_16x16x32_bf16 v[242:245], a[76:79], v[190:193], v[242:245]
    s_waitcnt lgkmcnt(3)
    v_mfma_f32_16x16x32_bf16 v[242:245], a[80:83], v[134:137], v[242:245]
    s_waitcnt lgkmcnt(2)
    v_mfma_f32_16x16x32_bf16 v[242:245], a[84:87], v[222:225], v[242:245]
    s_waitcnt vmcnt(9)
    ds_read_b64_tr_b16 a[144:145], v133 offset:0
    ds_read_b64_tr_b16 a[146:147], v133 offset:768
    v_mfma_f32_16x16x32_bf16 v[242:245], a[88:91], v[198:201], v[242:245]
    s_waitcnt lgkmcnt(2)
    ds_read_b64_tr_b16 a[168:169], v133 offset:32
    ds_read_b64_tr_b16 a[170:171], v133 offset:800
    v_mfma_f32_16x16x32_bf16 v[242:245], a[92:95], v[226:229], v[242:245]
    ds_read_b64_tr_b16 a[192:193], v133 offset:64
    ds_read_b64_tr_b16 a[194:195], v133 offset:832
    v_mfma_f32_16x16x32_bf16 v[158:161], a[96:99], v[182:185], 0
    ds_read_b128 v[170:173], v0 offset:32768
    v_mfma_f32_16x16x32_bf16 v[158:161], a[100:103], v[190:193], v[158:161]
    ds_read_b128 v[154:157], v1 offset:32768
    v_mfma_f32_16x16x32_bf16 v[158:161], a[104:107], v[134:137], v[158:161]
    ds_read_b128 v[174:177], v0 offset:32896
    v_cvt_pk_f16_f32 v242, v242, v243
    v_mfma_f32_16x16x32_bf16 v[158:161], a[108:111], v[222:225], v[158:161]
    ds_read_b128 v[166:169], v1 offset:32896
    v_pk_mul_f16 v179, v242, v242
    v_mfma_f32_16x16x32_bf16 v[158:161], a[112:115], v[198:201], v[158:161]
    ds_read_b128 v[162:165], v0 offset:33024
    v_cvt_pk_f16_f32 v243, v244, v245
    v_mfma_f32_16x16x32_bf16 v[158:161], a[116:119], v[226:229], v[158:161]
    s_waitcnt lgkmcnt(9)
    ds_read_b128 v[202:205], v1 offset:33024
    v_pk_mul_f16 v181, v243, v243
    v_mfma_f32_16x16x32_bf16 v[218:221], a[120:123], v[182:185], 0
    s_waitcnt lgkmcnt(8)
    v_mfma_f32_16x16x32_bf16 v[218:221], a[124:127], v[190:193], v[218:221]
    s_waitcnt lgkmcnt(6)
    buffer_load_dwordx4 v123, s[48:51], s4 offen lds
    v_mfma_f32_16x16x32_bf16 v[218:221], a[128:131], v[134:137], v[218:221]
    s_waitcnt lgkmcnt(5)
    s_waitcnt vmcnt(7)
    ds_read_b64_tr_b16 a[148:149], v133 offset:3072
    v_mfma_f32_16x16x32_bf16 v[218:221], a[132:135], v[222:225], v[218:221]
    s_waitcnt lgkmcnt(5)
    ds_read_b64_tr_b16 a[150:151], v133 offset:3840
    ds_read_b64_tr_b16 a[172:173], v133 offset:3104
    v_mfma_f32_16x16x32_bf16 v[218:221], a[136:139], v[198:201], v[218:221]
    s_waitcnt lgkmcnt(6)
    ds_read_b64_tr_b16 a[174:175], v133 offset:3872
    ds_read_b64_tr_b16 a[196:197], v133 offset:3136
    v_mfma_f32_16x16x32_bf16 v[218:221], a[140:143], v[226:229], v[218:221]
    s_waitcnt lgkmcnt(7)
    buffer_load_dwordx4 v125, s[48:51], s4 offen offset:1024 lds
    v_mfma_f32_16x16x32_bf16 v[186:189], a[0:3], v[182:185], 0
    s_waitcnt lgkmcnt(6)
    ds_read_b64_tr_b16 a[198:199], v133 offset:3904
    v_cvt_pk_f16_f32 v244, v158, v159
    v_mfma_f32_16x16x32_bf16 v[186:189], a[4:7], v[190:193], v[186:189]
    s_waitcnt lgkmcnt(6)
    v_pk_fma_f16 v179, v244, v244, v179
    v_cvt_pk_f16_f32 v245, v160, v161
    v_mfma_f32_16x16x32_bf16 v[186:189], a[8:11], v[134:137], v[186:189]
    v_pk_fma_f16 v181, v245, v245, v181
    v_cvt_pk_f16_f32 v160, v218, v219
    v_mfma_f32_16x16x32_bf16 v[186:189], a[12:15], v[222:225], v[186:189]
    buffer_load_dwordx4 v127, s[48:51], s4 offen offset:2048 lds
    v_mfma_f32_16x16x32_bf16 v[186:189], a[16:19], v[198:201], v[186:189]
    s_add_u32 m0, s68, 3072
    v_pk_fma_f16 v179, v160, v160, v179
    v_cvt_pk_f16_f32 v161, v220, v221
    v_mfma_f32_16x16x32_bf16 v[186:189], a[20:23], v[226:229], v[186:189]
    s_add_u32 s4, s45, 185088
    v_pk_fma_f16 v181, v161, v161, v181
    v_mfma_f32_16x16x32_bf16 v[218:221], a[24:27], v[182:185], 0
    s_waitcnt lgkmcnt(1)
    v_mfma_f32_16x16x32_bf16 v[218:221], a[28:31], v[190:193], v[218:221]
    v_mfma_f32_16x16x32_bf16 v[218:221], a[32:35], v[134:137], v[218:221]
    s_waitcnt vmcnt(6)
    ds_read_b64_tr_b16 a[152:153], v130 offset:0
    ds_read_b64_tr_b16 a[154:155], v130 offset:768
    v_mfma_f32_16x16x32_bf16 v[218:221], a[36:39], v[222:225], v[218:221]
    s_waitcnt lgkmcnt(2)
    buffer_load_dwordx4 v123, s[48:51], s4 offen lds
    v_mfma_f32_16x16x32_bf16 v[218:221], a[40:43], v[198:201], v[218:221]
    ds_read_b64_tr_b16 a[176:177], v130 offset:32
    ds_read_b64_tr_b16 a[178:179], v130 offset:800
    v_mfma_f32_16x16x32_bf16 v[218:221], a[44:47], v[226:229], v[218:221]
    ds_read_b64_tr_b16 a[200:201], v130 offset:64
    ds_read_b64_tr_b16 a[202:203], v130 offset:832
    v_mfma_f32_16x16x32_bf16 v[214:217], a[48:51], v[182:185], 0
    v_cvt_pk_f16_f32 v182, v186, v187
    v_pk_mul_f16 v178, v182, v182
    v_mfma_f32_16x16x32_bf16 v[214:217], a[52:55], v[190:193], v[214:217]
    buffer_load_dwordx4 v125, s[48:51], s4 offen offset:1024 lds
    v_mfma_f32_16x16x32_bf16 v[214:217], a[56:59], v[134:137], v[214:217]
    v_cvt_pk_f16_f32 v183, v188, v189
    v_pk_mul_f16 v180, v183, v183
    v_mfma_f32_16x16x32_bf16 v[214:217], a[60:63], v[222:225], v[214:217]
    v_cvt_pk_f16_f32 v184, v218, v219
    v_pk_fma_f16 v178, v184, v184, v178
    v_mfma_f32_16x16x32_bf16 v[214:217], a[64:67], v[198:201], v[214:217]
    s_waitcnt lgkmcnt(4)
    v_cvt_pk_f16_f32 v185, v220, v221
    v_pk_fma_f16 v180, v185, v185, v180
    v_mfma_f32_16x16x32_bf16 v[214:217], a[68:71], v[226:229], v[214:217]
    buffer_load_dwordx4 v127, s[48:51], s4 offen offset:2048 lds
    v_mfma_f32_16x16x32_bf16 v[190:193], a[72:75], v[170:173], 0
    s_add_u32 m0, s69, 0
    s_add_u32 s4, 0, 12288
    v_mfma_f32_16x16x32_bf16 v[190:193], a[76:79], v[154:157], v[190:193]
    s_waitcnt vmcnt(6)
    ds_read_b64_tr_b16 a[156:157], v130 offset:3072
    ds_read_b64_tr_b16 a[158:159], v130 offset:3840
    v_mfma_f32_16x16x32_bf16 v[190:193], a[80:83], v[174:177], v[190:193]
    s_waitcnt lgkmcnt(2)
    ds_read_b64_tr_b16 a[180:181], v130 offset:3104
    ds_read_b64_tr_b16 a[182:183], v130 offset:3872
    v_mfma_f32_16x16x32_bf16 v[190:193], a[84:87], v[166:169], v[190:193]
    buffer_load_dwordx4 v152, s[52:55], 0 offen lds
    ds_read_b64_tr_b16 a[204:205], v130 offset:3136
    v_mfma_f32_16x16x32_bf16 v[190:193], a[88:91], v[162:165], v[190:193]
    ds_read_b64_tr_b16 a[206:207], v130 offset:3904
    v_cvt_pk_f16_f32 v158, v214, v215
    v_mfma_f32_16x16x32_bf16 v[190:193], a[92:95], v[202:205], v[190:193]
    v_pk_fma_f16 v178, v158, v158, v178
    v_cvt_pk_f16_f32 v159, v216, v217
    v_mfma_f32_16x16x32_bf16 v[222:225], a[96:99], v[170:173], 0
    v_pk_fma_f16 v180, v159, v159, v180
    v_mfma_f32_16x16x32_bf16 v[222:225], a[100:103], v[154:157], v[222:225]
    buffer_load_dwordx4 v153, s[52:55], 0 offen offset:1024 lds
    v_mfma_f32_16x16x32_f16 v[198:201], v[40:43], v[178:181], 0
    v_mfma_f32_16x16x32_bf16 v[222:225], a[104:107], v[174:177], v[222:225]
    s_waitcnt lgkmcnt(4)
    v_cvt_pk_f16_f32 v190, v190, v191
    v_pk_mul_f16 v227, v190, v190
    v_mfma_f32_16x16x32_bf16 v[222:225], a[108:111], v[166:169], v[222:225]
    s_waitcnt lgkmcnt(2)
    v_cvt_pk_f16_f32 v191, v192, v193
    v_pk_mul_f16 v229, v191, v191
    v_mfma_f32_16x16x32_bf16 v[222:225], a[112:115], v[162:165], v[222:225]
    s_waitcnt lgkmcnt(1)
    buffer_load_dwordx4 v122, s[52:55], 0 offen offset:2048 lds
    v_min3_u32 v44, v44, v198, v199
    v_mfma_f32_16x16x32_bf16 v[222:225], a[116:119], v[202:205], v[222:225]
    s_add_u32 m0, s69, 3072
    v_rsq_f32 v200, v198
    v_mfma_f32_16x16x32_bf16 v[134:137], a[120:123], v[170:173], 0
    s_waitcnt lgkmcnt(0)
    v_rsq_f32 v201, v199
    v_mfma_f32_16x16x32_bf16 v[134:137], a[124:127], v[154:157], v[134:137]
    v_mul_f32 v200, s31, v200
    v_cvt_pk_f16_f32 v200, v200, v201
    v_mfma_f32_16x16x32_bf16 v[134:137], a[128:131], v[174:177], v[134:137]
    buffer_load_dwordx4 v152, s[52:55], s4 offen lds
    v_mfma_f32_16x16x32_bf16 v[134:137], a[132:135], v[166:169], v[134:137]
    v_pk_mul_f16 v242, v242, v200 op_sel:[0,1] op_sel_hi:[1,1]
    s_waitcnt vmcnt(7)
    v_mfma_f32_16x16x32_bf16 v[134:137], a[136:139], v[162:165], v[134:137]
    ds_read_b64_tr_b16 a[160:161], v133 offset:0
    ds_read_b64_tr_b16 a[162:163], v133 offset:768
    v_mfma_f32_16x16x32_bf16 v[134:137], a[140:143], v[202:205], v[134:137]
    ds_read_b64_tr_b16 a[184:185], v133 offset:32
    ds_read_b64_tr_b16 a[186:187], v133 offset:800
    v_mfma_f32_16x16x32_bf16 v[178:181], a[0:3], v[170:173], 0
    buffer_load_dwordx4 v153, s[52:55], s4 offen offset:1024 lds
    v_mfma_f32_16x16x32_bf16 v[178:181], a[4:7], v[154:157], v[178:181]
    ds_read_b64_tr_b16 a[208:209], v133 offset:64
    ds_read_b64_tr_b16 a[210:211], v133 offset:832
    v_mfma_f32_16x16x32_bf16 v[178:181], a[8:11], v[174:177], v[178:181]
    v_pk_mul_f16 v243, v243, v200 op_sel:[0,1] op_sel_hi:[1,1]
    v_pk_mul_f16 v244, v244, v200 op_sel:[0,1] op_sel_hi:[1,1]
    v_mfma_f32_16x16x32_bf16 v[178:181], a[12:15], v[166:169], v[178:181]
    v_pk_mul_f16 v245, v245, v200 op_sel:[0,1] op_sel_hi:[1,1]
    v_pk_mul_f16 v160, v160, v200 op_sel:[0,1] op_sel_hi:[1,1]
    v_mfma_f32_16x16x32_bf16 v[178:181], a[16:19], v[162:165], v[178:181]
    buffer_load_dwordx4 v122, s[52:55], s4 offen offset:2048 lds
    v_mfma_f32_16x16x32_bf16 v[178:181], a[20:23], v[202:205], v[178:181]
    s_add_u32 m0, s68, 0
    v_pk_mul_f16 v161, v161, v200 op_sel:[0,1] op_sel_hi:[1,1]
    v_pk_mul_f16 v182, v182, v200 op_sel:[0,0] op_sel_hi:[1,0]
    v_mfma_f32_16x16x32_bf16 v[218:221], a[24:27], v[170:173], 0
    s_add_u32 s4, 0, 24576
    ds_read_b128 v[186:189], v126 offset:0
    v_pk_mul_f16 v183, v183, v200 op_sel:[0,0] op_sel_hi:[1,0]
    v_mfma_f32_16x16x32_bf16 v[218:221], a[28:31], v[154:157], v[218:221]
    s_waitcnt lgkmcnt(3)
    ds_read_b128 v[214:217], v145 offset:0
    v_pk_mul_f16 v184, v184, v200 op_sel:[0,0] op_sel_hi:[1,0]
    v_mfma_f32_16x16x32_bf16 v[218:221], a[32:35], v[174:177], v[218:221]
    ds_read_b128 v[234:237], v126 offset:128
    v_pk_mul_f16 v185, v185, v200 op_sel:[0,0] op_sel_hi:[1,0]
    v_mfma_f32_16x16x32_bf16 v[218:221], a[36:39], v[166:169], v[218:221]
    s_waitcnt lgkmcnt(3)
    buffer_load_dwordx4 v152, s[52:55], s4 offen lds
    v_mfma_f32_16x16x32_bf16 v[218:221], a[40:43], v[162:165], v[218:221]
    ds_read_b128 v[238:241], v145 offset:128
    ds_read_b128 v[250:253], v126 offset:256
    v_mfma_f32_16x16x32_bf16 v[218:221], a[44:47], v[202:205], v[218:221]
    ds_read_b128 v[230:233], v145 offset:256
    s_waitcnt vmcnt(7)
    v_mfma_f32_16x16x32_bf16 v[246:249], a[48:51], v[170:173], 0
    ds_read_b64_tr_b16 a[164:165], v133 offset:3072
    ds_read_b64_tr_b16 a[166:167], v133 offset:3840
    v_mfma_f32_16x16x32_bf16 v[246:249], a[52:55], v[154:157], v[246:249]
    buffer_load_dwordx4 v153, s[52:55], s4 offen offset:1024 lds
    v_mfma_f32_16x16x32_bf16 v[246:249], a[56:59], v[174:177], v[246:249]
    s_waitcnt lgkmcnt(7)
    ds_read_b64_tr_b16 a[188:189], v133 offset:3104
    ds_read_b64_tr_b16 a[190:191], v133 offset:3872
    v_mfma_f32_16x16x32_bf16 v[246:249], a[60:63], v[166:169], v[246:249]
    s_waitcnt lgkmcnt(8)
    ds_read_b64_tr_b16 a[212:213], v133 offset:3136
    ds_read_b64_tr_b16 a[214:215], v133 offset:3904
    v_mfma_f32_16x16x32_bf16 v[246:249], a[64:67], v[162:165], v[246:249]
    s_waitcnt lgkmcnt(9)
    v_pk_mul_f16 v158, v158, v200 op_sel:[0,0] op_sel_hi:[1,0]
    v_pk_mul_f16 v159, v159, v200 op_sel:[0,0] op_sel_hi:[1,0]
    v_mfma_f32_16x16x32_bf16 v[246:249], a[68:71], v[202:205], v[246:249]
    buffer_load_dwordx4 v122, s[52:55], s4 offen offset:2048 lds
    v_mfma_f32_16x16x32_bf16 v[130:133], v[170:173], a[144:147], 0
    s_add_u32 m0, s68, 3072
    v_max3_u32 v45, v45, v198, v199
    v_cvt_pk_f16_f32 v192, v222, v223
    v_mfma_f32_16x16x32_bf16 v[130:133], v[154:157], a[148:151], v[130:133]
    s_add_u32 s4, 0, 36864
    v_pk_fma_f16 v227, v192, v192, v227
    v_cvt_pk_f16_f32 v193, v224, v225
    v_mfma_f32_16x16x32_bf16 v[130:133], v[174:177], a[152:155], v[130:133]
    s_waitcnt lgkmcnt(4)
    v_pk_fma_f16 v229, v193, v193, v229
    v_cvt_pk_f16_f32 v200, v134, v135
    v_mfma_f32_16x16x32_bf16 v[130:133], v[166:169], a[156:159], v[130:133]
    v_pk_fma_f16 v227, v200, v200, v227
    v_cvt_pk_f16_f32 v201, v136, v137
    v_mfma_f32_16x16x32_bf16 v[130:133], v[162:165], a[160:163], v[130:133]
    s_waitcnt lgkmcnt(2)
    v_pk_fma_f16 v229, v201, v201, v229
    v_cvt_pk_f16_f32 v222, v178, v179
    v_mfma_f32_16x16x32_bf16 v[130:133], v[202:205], a[164:167], v[130:133]
    s_waitcnt lgkmcnt(0)
    buffer_load_dwordx4 v152, s[52:55], s4 offen lds
    s_waitcnt vmcnt(7)
    v_mfma_f32_16x16x32_bf16 v[134:137], v[170:173], a[168:171], 0
    ds_read_b64 a[216:217], v139 offset:0
    ds_read_b64 a[218:219], v139 offset:1536
    v_mfma_f32_16x16x32_bf16 v[134:137], v[154:157], a[172:175], v[134:137]
    ds_read_b64 a[240:241], v139 offset:8
    ds_read_b64 a[242:243], v139 offset:1544
    v_mfma_f32_16x16x32_bf16 v[134:137], v[174:177], a[176:179], v[134:137]
    ds_read_b64 v[90:91], v117 offset:0
    ds_read_b64 v[92:93], v117 offset:1536
    v_mfma_f32_16x16x32_bf16 v[134:137], v[166:169], a[180:183], v[134:137]
    buffer_load_dwordx4 v153, s[52:55], s4 offen offset:1024 lds
    v_mfma_f32_16x16x32_bf16 v[134:137], v[162:165], a[184:187], v[134:137]
    ds_read_b128 v[140:143], v0 offset:20480
    v_pk_mul_f16 v226, v222, v222
    v_mfma_f32_16x16x32_bf16 v[134:137], v[202:205], a[188:191], v[134:137]
    v_cvt_pk_f16_f32 v223, v180, v181
    v_pk_mul_f16 v228, v223, v223
    v_cvt_pk_f16_f32 v224, v218, v219
    v_pk_fma_f16 v226, v224, v224, v226
    v_cvt_pk_f16_f32 v225, v220, v221
    buffer_load_dwordx4 v122, s[52:55], s4 offen offset:2048 lds
    s_add_u32 m0, s69, 0
    s_add_u32 s4, 0, 49152
    v_pk_fma_f16 v228, v225, v225, v228
    v_cvt_pk_f16_f32 v198, v246, v247
    v_mfma_f32_16x16x32_bf16 v[178:181], v[170:173], a[192:195], 0
    s_waitcnt lgkmcnt(3)
    ds_read_b128 v[218:221], v1 offset:20480
    v_pk_fma_f16 v226, v198, v198, v226
    v_mfma_f32_16x16x32_bf16 v[178:181], v[154:157], a[196:199], v[178:181]
    s_waitcnt lgkmcnt(2)
    ds_read_b128 v[154:157], v0 offset:20608
    v_cvt_pk_f16_f32 v199, v248, v249
    v_mfma_f32_16x16x32_bf16 v[178:181], v[174:177], a[200:203], v[178:181]
    buffer_load_dwordx4 v152, s[52:55], s4 offen lds
    s_waitcnt vmcnt(7)
    v_mfma_f32_16x16x32_bf16 v[178:181], v[166:169], a[204:207], v[178:181]
    s_waitcnt lgkmcnt(2)
    ds_read_b64 a[232:233], v139 offset:3072
    ds_read_b64 a[220:221], v139 offset:4608
    v_mfma_f32_16x16x32_bf16 v[178:181], v[162:165], a[208:211], v[178:181]
    ds_read_b64 v[82:83], v139 offset:3080
    ds_read_b64 a[244:245], v139 offset:4616
    v_mfma_f32_16x16x32_bf16 v[178:181], v[202:205], a[212:215], v[178:181]
    ds_read_b64 v[106:107], v117 offset:3072
    ds_read_b64 v[94:95], v117 offset:4608
    v_mfma_f32_16x16x32_bf16 v[166:169], v[186:189], a[144:147], 0
    buffer_load_dwordx4 v153, s[52:55], s4 offen offset:1024 lds
    v_mfma_f32_16x16x32_bf16 v[166:169], v[214:217], a[148:151], v[166:169]
    s_waitcnt lgkmcnt(7)
    ds_read_b128 v[162:165], v1 offset:20608
    ds_read_b128 v[202:205], v0 offset:20736
    v_mfma_f32_16x16x32_bf16 v[166:169], v[234:237], a[152:155], v[166:169]
    s_waitcnt lgkmcnt(8)
    ds_read_b128 v[174:177], v1 offset:20736
    v_pk_fma_f16 v228, v199, v199, v228
    v_mfma_f32_16x16x32_bf16 v[166:169], v[238:241], a[156:159], v[166:169]
    v_cvt_pk_bf16_f32 v130, v130, v131
    v_cvt_pk_bf16_f32 v131, v132, v133
    v_mfma_f32_16x16x32_bf16 v[166:169], v[250:253], a[160:163], v[166:169]
    buffer_load_dwordx4 v122, s[52:55], s4 offen offset:2048 lds
    v_mfma_f32_16x16x32_bf16 v[166:169], v[230:233], a[164:167], v[166:169]
    s_add_u32 m0, s69, 3072
    s_add_u32 s4, 0, 61440
    v_cvt_pk_bf16_f32 v134, v134, v135
    v_mfma_f32_16x16x32_f16 v[170:173], v[40:43], v[226:229], 0
    s_waitcnt lgkmcnt(5)
    v_cvt_pk_bf16_f32 v135, v136, v137
    v_cvt_pk_bf16_f32 v114, v178, v179
    v_mfma_f32_16x16x32_bf16 v[226:229], v[186:189], a[168:171], 0
    s_waitcnt lgkmcnt(3)
    ds_read_b128 v[246:249], v0 offset:26624
    v_cvt_pk_bf16_f32 v115, v180, v181
    v_mfma_f32_16x16x32_bf16 v[226:229], v[214:217], a[172:175], v[226:229]
    buffer_load_dwordx4 v152, s[52:55], s4 offen lds
    v_mfma_f32_16x16x32_bf16 v[226:229], v[234:237], a[176:179], v[226:229]
    s_waitcnt lgkmcnt(2)
    s_waitcnt vmcnt(7)
    ds_read_b64 a[222:223], v254 offset:0
    v_mfma_f32_16x16x32_bf16 v[226:229], v[238:241], a[180:183], v[226:229]
    s_waitcnt lgkmcnt(2)
    ds_read_b64 a[234:235], v254 offset:1536
    ds_read_b64 a[246:247], v254 offset:8
    v_mfma_f32_16x16x32_bf16 v[226:229], v[250:253], a[184:187], v[226:229]
    ds_read_b64 v[84:85], v254 offset:1544
    ds_read_b64 v[96:97], v124 offset:0
    v_mfma_f32_16x16x32_bf16 v[226:229], v[230:233], a[188:191], v[226:229]
    buffer_load_dwordx4 v153, s[52:55], s4 offen offset:1024 lds
    ds_read_b64 v[108:109], v124 offset:1536
    v_rsq_f32 v172, v170
    v_rsq_f32 v173, v171
    v_mul_f32 v172, s31, v172
    v_cvt_pk_f16_f32 v172, v172, v173
    v_pk_mul_f16 v190, v190, v172 op_sel:[0,1] op_sel_hi:[1,1]
    v_pk_mul_f16 v191, v191, v172 op_sel:[0,1] op_sel_hi:[1,1]
    v_pk_mul_f16 v192, v192, v172 op_sel:[0,1] op_sel_hi:[1,1]
    v_pk_mul_f16 v193, v193, v172 op_sel:[0,1] op_sel_hi:[1,1]
    buffer_load_dwordx4 v122, s[52:55], s4 offen offset:2048 lds
    s_add_u32 m0, s28, 65536
    v_pk_mul_f16 v200, v200, v172 op_sel:[0,1] op_sel_hi:[1,1]
    v_pk_mul_f16 v201, v201, v172 op_sel:[0,1] op_sel_hi:[1,1]
    v_pk_mul_f16 v222, v222, v172 op_sel:[0,0] op_sel_hi:[1,0]
    v_pk_mul_f16 v223, v223, v172 op_sel:[0,0] op_sel_hi:[1,0]
    v_pk_mul_f16 v224, v224, v172 op_sel:[0,0] op_sel_hi:[1,0]
    v_pk_mul_f16 v225, v225, v172 op_sel:[0,0] op_sel_hi:[1,0]
    v_pk_mul_f16 v198, v198, v172 op_sel:[0,0] op_sel_hi:[1,0]
    v_pk_mul_f16 v199, v199, v172 op_sel:[0,0] op_sel_hi:[1,0]
    v_mfma_f32_16x16x32_bf16 v[178:181], v[186:189], a[192:195], 0
    s_waitcnt lgkmcnt(1)
    ds_read_b128 v[186:189], v1 offset:26624
    v_min3_u32 v44, v44, v170, v171
    v_mfma_f32_16x16x32_bf16 v[178:181], v[214:217], a[196:199], v[178:181]
    s_waitcnt lgkmcnt(1)
    buffer_load_dwordx4 v10, s[8:11], s24 offen nt lds
    v_mfma_f32_16x16x32_bf16 v[178:181], v[234:237], a[200:203], v[178:181]
    s_add_u32 m0, s28, 69632
    ds_read_b128 v[214:217], v0 offset:26752
    ds_read_b128 v[234:237], v1 offset:26752
    v_mfma_f32_16x16x32_bf16 v[178:181], v[238:241], a[204:207], v[178:181]
    ds_read_b128 v[238:241], v0 offset:26880
    v_max3_u32 v45, v45, v170, v171
    v_mfma_f32_16x16x32_bf16 v[178:181], v[250:253], a[208:211], v[178:181]
    ds_read_b128 v[250:253], v1 offset:26880
    s_waitcnt vmcnt(7)
    v_mfma_f32_16x16x32_bf16 v[178:181], v[230:233], a[212:215], v[178:181]
    buffer_load_dwordx4 v11, s[8:11], s24 offen nt lds
    v_mfma_f32_16x16x32_bf16 v[170:173], v[140:143], a[144:147], 0
    s_add_u32 m0, s28, 73728
    ds_read_b64 a[224:225], v254 offset:3072
    ds_read_b64 a[226:227], v254 offset:4608
    v_mfma_f32_16x16x32_bf16 v[170:173], v[218:221], a[148:151], v[170:173]
    ds_read_b64 a[248:249], v254 offset:3080
    ds_read_b64 a[250:251], v254 offset:4616
    v_mfma_f32_16x16x32_bf16 v[170:173], v[154:157], a[152:155], v[170:173]
    s_waitcnt lgkmcnt(8)
    ds_read_b64 v[98:99], v124 offset:3072
    ds_read_b64 v[100:101], v124 offset:4608
    v_mfma_f32_16x16x32_bf16 v[170:173], v[162:165], a[156:159], v[170:173]
    buffer_load_dwordx4 v12, s[8:11], s24 offen nt lds
    v_mfma_f32_16x16x32_bf16 v[170:173], v[202:205], a[160:163], v[170:173]
    s_add_u32 m0, s28, 77824
    v_cvt_pk_bf16_f32 v166, v166, v166
    v_cvt_pk_bf16_f32 v167, v167, v167
    v_mfma_f32_16x16x32_bf16 v[170:173], v[174:177], a[164:167], v[170:173]
    s_waitcnt lgkmcnt(7)
    ds_write2_b32 v147, v166, v167 offset0:0 offset1:68
    v_mfma_f32_16x16x32_bf16 v[122:125], v[140:143], a[168:171], 0
    s_waitcnt lgkmcnt(7)
    v_cvt_pk_bf16_f32 v168, v168, v168
    v_cvt_pk_bf16_f32 v169, v169, v169
    v_mfma_f32_16x16x32_bf16 v[122:125], v[218:221], a[172:175], v[122:125]
    s_waitcnt lgkmcnt(6)
    buffer_load_dwordx4 v13, s[8:11], s24 offen nt lds
    v_mfma_f32_16x16x32_bf16 v[122:125], v[154:157], a[176:179], v[122:125]
    s_add_u32 m0, s74, 0
    ds_write2_b32 v147, v168, v169 offset0:136 offset1:204
    v_mfma_f32_16x16x32_bf16 v[122:125], v[162:165], a[180:183], v[122:125]
    s_waitcnt lgkmcnt(2)
    v_cvt_pk_bf16_f32 v226, v226, v226
    v_cvt_pk_bf16_f32 v227, v227, v227
    v_mfma_f32_16x16x32_bf16 v[122:125], v[202:205], a[184:187], v[122:125]
    s_waitcnt vmcnt(7)
    ds_read_b64 a[236:237], v139 offset:0
    ds_read_b64 a[228:229], v139 offset:1536
    v_mfma_f32_16x16x32_bf16 v[122:125], v[174:177], a[188:191], v[122:125]
    buffer_load_dwordx4 v14, s[8:11], s24 offen nt lds
    v_mfma_f32_16x16x32_bf16 v[166:169], v[140:143], a[192:195], 0
    s_add_u32 s8, s40, s23
    ds_read_b64 v[86:87], v139 offset:8
    ds_read_b64 a[252:253], v139 offset:1544
    v_mfma_f32_16x16x32_bf16 v[166:169], v[218:221], a[196:199], v[166:169]
    s_addc_u32 s9, s41, 0
    ds_read_b64 v[110:111], v117 offset:0
    ds_read_b64 v[102:103], v117 offset:1536
    v_mfma_f32_16x16x32_bf16 v[166:169], v[154:157], a[200:203], v[166:169]
    s_sub_u32 s10, s36, s23
    ds_read_b128 v[218:221], v126 offset:6144
    ds_read_b128 v[154:157], v145 offset:6144
    v_mfma_f32_16x16x32_bf16 v[166:169], v[162:165], a[204:207], v[166:169]
    s_cmp_lt_u32 s34, s17
    ds_read_b128 v[162:165], v126 offset:6272
    ds_read_b128 v[230:233], v145 offset:6272
    v_mfma_f32_16x16x32_bf16 v[166:169], v[202:205], a[208:211], v[166:169]
    s_cselect_b32 s10, s10, 0
    v_cvt_pk_bf16_f32 v228, v228, v228
    v_cvt_pk_bf16_f32 v229, v229, v229
    v_mfma_f32_16x16x32_bf16 v[166:169], v[174:177], a[212:215], v[166:169]
    s_add_u32 m0, s28, 0
    ds_read_b128 v[174:177], v126 offset:6400
    ds_read_b128 v[126:129], v145 offset:6400
    s_mov_b32 s24, s23
    s_add_u32 s23, s23, s21
    s_cmp_ge_u32 s19, 72
    ds_write2_b32 v147, v226, v227 offset0:16 offset1:84
    v_mfma_f32_16x16x32_bf16 v[202:205], v[246:249], a[144:147], 0
    s_cselect_b32 s34, 72, 0
    v_cvt_pk_bf16_f32 v178, v178, v178
    v_cvt_pk_bf16_f32 v179, v179, v179
    v_mfma_f32_16x16x32_bf16 v[202:205], v[186:189], a[148:151], v[202:205]
    s_cselect_b32 s35, s22, 0
    ds_write2_b32 v147, v228, v229 offset0:152 offset1:220
    v_mfma_f32_16x16x32_bf16 v[202:205], v[214:217], a[152:155], v[202:205]
    s_waitcnt vmcnt(5)
    v_cvt_pk_bf16_f32 v180, v180, v180
    v_cvt_pk_bf16_f32 v181, v181, v181
    v_mfma_f32_16x16x32_bf16 v[202:205], v[234:237], a[156:159], v[202:205]
    s_sub_u32 s19, s19, s34
    ds_read_b64 a[230:231], v139 offset:3072
    ds_read_b64 a[238:239], v139 offset:4608
    v_mfma_f32_16x16x32_bf16 v[202:205], v[238:241], a[160:163], v[202:205]
    s_add_u32 s23, s23, s35
    ds_read_b64 a[254:255], v139 offset:3080
    ds_read_b64 v[88:89], v139 offset:4616
    v_mfma_f32_16x16x32_bf16 v[202:205], v[250:253], a[164:167], v[202:205]
    s_waitcnt lgkmcnt(6)
    ds_read_b64 v[104:105], v117 offset:3072
    ds_read_b64 v[112:113], v117 offset:4608
    v_mfma_f32_16x16x32_bf16 v[226:229], v[246:249], a[168:171], 0
    ds_write2_b32 v147, v178, v179 offset0:32 offset1:100
    v_mfma_f32_16x16x32_bf16 v[226:229], v[186:189], a[172:175], v[226:229]
    v_cvt_pk_bf16_f32 v138, v170, v171
    v_cvt_pk_bf16_f32 v139, v172, v173
    v_mfma_f32_16x16x32_bf16 v[226:229], v[214:217], a[176:179], v[226:229]
    ds_write2_b32 v147, v180, v181 offset0:168 offset1:236
    v_mfma_f32_16x16x32_bf16 v[226:229], v[234:237], a[180:183], v[226:229]
    v_cvt_pk_bf16_f32 v122, v122, v123
    v_cvt_pk_bf16_f32 v123, v124, v125
    v_mfma_f32_16x16x32_bf16 v[226:229], v[238:241], a[184:187], v[226:229]
    s_waitcnt lgkmcnt(6)
    v_cvt_pk_bf16_f32 v166, v166, v167
    v_cvt_pk_bf16_f32 v167, v168, v169
    v_mfma_f32_16x16x32_bf16 v[226:229], v[250:253], a[188:191], v[226:229]
    s_waitcnt lgkmcnt(4)
    v_cvt_pk_bf16_f32 v140, v202, v203
    v_cvt_pk_bf16_f32 v141, v204, v205
    v_mfma_f32_16x16x32_bf16 v[170:173], v[246:249], a[192:195], 0
    s_waitcnt lgkmcnt(2)
    v_xor_b32 v0, 65536, v0
    v_xor_b32 v1, 65536, v1
    v_mfma_f32_16x16x32_bf16 v[170:173], v[186:189], a[196:199], v[170:173]
    v_cvt_pk_bf16_f32 v124, v226, v227
    v_cvt_pk_bf16_f32 v125, v228, v229
    v_mfma_f32_16x16x32_bf16 v[170:173], v[214:217], a[200:203], v[170:173]
    v_xor_b32 v152, 65536, v2
    v_lshrrev_b32 v153, 2, v152
    v_mfma_f32_16x16x32_bf16 v[170:173], v[234:237], a[204:207], v[170:173]
    v_lshrrev_b32 v254, 8, v152
    v_add_u32 v152, 157184, v152
    v_mfma_f32_16x16x32_bf16 v[170:173], v[238:241], a[208:211], v[170:173]
    v_lshl_add_u32 v255, s16, 2, v152
    v_add_u32 v153, 162048, v153
    v_mfma_f32_16x16x32_bf16 v[170:173], v[250:253], a[212:215], v[170:173]
    v_lshlrev_b32 v254, 4, v254
    v_add_u32 v254, 162048, v254
    v_mfma_f32_16x16x32_bf16 v[226:229], v[218:221], a[144:147], 0
    v_or_b32 v202, v32, v33
    v_and_b32 v202, 0xffff, v202
    v_mfma_f32_16x16x32_bf16 v[226:229], v[154:157], a[148:151], v[226:229]
    v_lshl_or_b32 v202, v202, 16, v202
    v_or_b32 v203, v32, v33
    v_mfma_f32_16x16x32_bf16 v[226:229], v[162:165], a[152:155], v[226:229]
    v_cvt_pk_bf16_f32 v168, v170, v171
    v_cvt_pk_bf16_f32 v169, v172, v173
    v_mfma_f32_16x16x32_bf16 v[226:229], v[230:233], a[156:159], v[226:229]
    v_and_b32 v203, 0xffff, v203
    v_lshl_or_b32 v203, v203, 16, v203
    v_mfma_f32_16x16x32_bf16 v[226:229], v[174:177], a[160:163], v[226:229]
    v_or_b32 v204, v32, v33
    v_lshrrev_b32 v204, 16, v204
    v_mfma_f32_16x16x32_bf16 v[226:229], v[126:129], a[164:167], v[226:229]
    v_lshl_or_b32 v204, v204, 16, v204
    v_or_b32 v205, v32, v33
    v_mfma_f32_16x16x32_f16 v[170:173], v[242:245], v[206:209], v[50:53]
    v_lshrrev_b32 v205, 16, v205
    v_lshl_or_b32 v205, v205, 16, v205
    v_mfma_f32_16x16x32_f16 v[142:145], v[190:193], v[206:209], v[54:57]
    v_xor_b32 v2, 65536, v2
    v_mfma_f32_16x16x32_bf16 v[178:181], v[218:221], a[168:171], 0
    v_cvt_pk_bf16_f32 v226, v226, v226
    v_cvt_pk_bf16_f32 v227, v227, v227
    v_cvt_pk_bf16_f32 v228, v228, v228
    v_mfma_f32_16x16x16_f16 v[170:173], v[160:161], v[194:195], v[170:173]
    v_cvt_pk_bf16_f32 v229, v229, v229
    v_mfma_f32_16x16x16_f16 v[142:145], v[200:201], v[194:195], v[142:145]
    ds_write2_b32 v148, v226, v227 offset0:0 offset1:68
    v_mfma_f32_16x16x32_bf16 v[178:181], v[154:157], a[172:175], v[178:181]
    v_mfma_f32_16x16x32_bf16 v[178:181], v[162:165], a[176:179], v[178:181]
    ds_write2_b32 v148, v228, v229 offset0:136 offset1:204
    v_mfma_f32_16x16x32_bf16 v[178:181], v[230:233], a[180:183], v[178:181]
    v_mfma_f32_16x16x32_bf16 v[178:181], v[174:177], a[184:187], v[178:181]
    v_exp_f32 v170, v170
    v_mfma_f32_16x16x32_bf16 v[178:181], v[126:129], a[188:191], v[178:181]
    v_exp_f32 v171, v171
    v_mfma_f32_16x16x32_bf16 v[226:229], v[218:221], a[192:195], 0
    v_exp_f32 v172, v172
    v_mfma_f32_16x16x32_bf16 v[226:229], v[154:157], a[196:199], v[226:229]
    v_exp_f32 v173, v173
    v_mfma_f32_16x16x32_bf16 v[226:229], v[162:165], a[200:203], v[226:229]
    v_cvt_pk_bf16_f32 v212, v170, v171
    v_cvt_pk_bf16_f32 v213, v172, v173
    v_mfma_f32_16x16x32_bf16 v[226:229], v[230:233], a[204:207], v[226:229]
    v_cvt_pk_bf16_f32 v178, v178, v178
    v_cvt_pk_bf16_f32 v179, v179, v179
    v_mfma_f32_16x16x32_bf16 v[226:229], v[174:177], a[208:211], v[226:229]
    ds_write2_b32 v148, v178, v179 offset0:16 offset1:84
    v_mfma_f32_16x16x32_bf16 v[226:229], v[126:129], a[212:215], v[226:229]
    v_cvt_pk_bf16_f32 v180, v180, v180
    v_cvt_pk_bf16_f32 v181, v181, v181
    v_mfma_f32_16x16x32_bf16 v[170:173], v[202:205], a[216:219], 0
    ds_write2_b32 v148, v180, v181 offset0:152 offset1:220
    v_mfma_f32_16x16x32_bf16 v[170:173], v[202:205], a[240:243], v[170:173]
    v_exp_f32 v142, v142
    v_mfma_f32_16x16x32_bf16 v[170:173], v[202:205], v[90:93], v[170:173]
    v_exp_f32 v143, v143
    v_mfma_f32_16x16x32_f16 v[126:129], v[118:121], v[182:185], v[58:61]
    v_cvt_pk_bf16_f32 v226, v226, v226
    v_cvt_pk_bf16_f32 v227, v227, v227
    v_mfma_f32_16x16x32_bf16 v[154:157], v[202:205], a[220:223], 0
    ds_write2_b32 v148, v226, v227 offset0:32 offset1:100
    v_mfma_f32_16x16x32_bf16 v[154:157], v[202:205], a[244:247], v[154:157]
    v_cvt_pk_bf16_f32 v228, v228, v228
    v_mov_b32 v226, v170
    v_mov_b32_dpp v226, v171 quad_perm:[0,1,2,3] row_mask:0x2 bank_mask:0xf
    v_mfma_f32_16x16x16_f16 v[126:129], v[196:197], v[158:159], v[126:129]
    v_cvt_pk_bf16_f32 v229, v229, v229
    v_cvt_pk_bf16_f32 v36, v142, v143
    v_exp_f32 v144, v144
    v_mfma_f32_16x16x32_bf16 v[154:157], v[202:205], v[94:97], v[154:157]
    ds_write2_b32 v148, v228, v229 offset0:168 offset1:236
    v_mfma_f32_16x16x32_bf16 v[170:173], v[202:205], a[232:235], 0
    v_exp_f32 v145, v145
    v_mfma_f32_16x16x32_f16 v[218:221], v[242:245], v[182:185], v[62:65]
    ds_read_b128 v[146:149], v5 offset:0
    ds_read_b128 v[162:165], v5 offset:16
    v_mfma_f32_16x16x32_f16 v[174:177], v[190:193], v[182:185], v[66:69]
    ds_read_b128 v[178:181], v5 offset:48
    ds_read_b32 v142, v6 offset:192
    v_mfma_f32_16x16x32_bf16 v[170:173], v[202:205], v[82:85], v[170:173]
    ds_read2_b32 v[132:133], v6 offset0:0 offset1:0
    v_mov_b32 v143, v155
    v_cvt_pk_bf16_f32 v37, v144, v145
    v_mfma_f32_16x16x16_f16 v[218:221], v[160:161], v[158:159], v[218:221]
    v_exp_f32 v126, v126
    v_add_u32 v5, 336, v5
    v_mfma_f32_16x16x16_f16 v[174:177], v[200:201], v[158:159], v[174:177]
    v_exp_f32 v127, v127
    v_exp_f32 v128, v128
    v_mfma_f32_16x16x32_f16 v[186:189], v[118:121], v[222:225], v[70:73]
    ds_read2_b32 v[136:137], v6 offset0:16 offset1:16
    ds_read2_b32 v[116:117], v6 offset0:32 offset1:32
    v_mfma_f32_16x16x32_bf16 v[170:173], v[202:205], v[106:109], v[170:173]
    v_cvt_pk_bf16_f32 v126, v126, v127
    v_add_u32 v6, 272, v6
    v_mfma_f32_16x16x32_bf16 v[234:237], v[202:205], a[224:227], 0
    s_waitcnt lgkmcnt(5)
    v_exp_f32 v129, v129
    v_mfma_f32_16x16x32_f16 v[214:217], v[146:149], v[182:185], v[24:27]
    s_waitcnt lgkmcnt(3)
    v_exp_f32 v218, v218
    v_mfma_f32_16x16x32_f16 v[214:217], v[162:165], v[242:245], v[214:217]
    s_waitcnt lgkmcnt(2)
    v_mov_b32_dpp v226, v170 quad_perm:[0,1,2,3] row_mask:0x4 bank_mask:0xf
    v_mov_b32_dpp v226, v154 quad_perm:[0,1,2,3] row_mask:0x8 bank_mask:0xf
    v_mfma_f32_16x16x32_f16 v[214:217], v[178:181], v[158:161], v[214:217]
    ds_write_b32 v255, v226 offset:0
    v_mfma_f32_16x16x32_f16 v[182:185], v[146:149], v[206:209], v[22:25]
    v_mov_b32_dpp v143, v171 quad_perm:[0,1,2,3] row_mask:0x2 bank_mask:0xf
    v_cvt_pk_bf16_f32 v127, v128, v129
    v_mfma_f32_16x16x32_f16 v[182:185], v[162:165], v[118:121], v[182:185]
    v_exp_f32 v219, v219
    v_mfma_f32_16x16x32_f16 v[182:185], v[178:181], v[194:197], v[182:185]
    s_waitcnt lgkmcnt(1)
    v_exp_f32 v220, v220
    v_mfma_f32_16x16x32_f16 v[118:121], v[146:149], v[222:225], v[26:29]
    v_exp_f32 v221, v221
    v_mfma_f32_16x16x32_f16 v[118:121], v[162:165], v[190:193], v[118:121]
    v_cvt_pk_bf16_f32 v128, v218, v219
    v_cvt_pk_bf16_f32 v129, v220, v221
    v_mfma_f32_16x16x32_f16 v[118:121], v[178:181], v[198:201], v[118:121]
    v_exp_f32 v174, v174
    v_mfma_f32_16x16x32_f16 v[206:209], v[242:245], v[222:225], v[74:77]
    v_exp_f32 v175, v175
    v_mfma_f32_16x16x32_f16 v[242:245], v[190:193], v[222:225], v[78:81]
    v_mov_b32_dpp v142, v183 quad_perm:[0,1,2,3] row_mask:0x1 bank_mask:0xf
    v_exp_f32 v176, v176
    v_mfma_f32_16x16x16_f16 v[186:189], v[196:197], v[198:199], v[186:189]
    v_mov_b32_dpp v142, v215 quad_perm:[0,1,2,3] row_mask:0x2 bank_mask:0xf
    v_exp_f32 v118, v118
    v_mfma_f32_16x16x16_f16 v[206:209], v[160:161], v[198:199], v[206:209]
    v_exp_f32 v177, v177
    v_mov_b32_dpp v142, v119 quad_perm:[0,1,2,3] row_mask:0x4 bank_mask:0xf
    v_mfma_f32_16x16x16_f16 v[242:245], v[200:201], v[198:199], v[242:245]
    v_exp_f32 v214, v214
    v_exp_f32 v182, v182
    v_mfma_f32_16x16x32_bf16 v[234:237], v[202:205], a[248:251], v[234:237]
    v_exp_f32 v186, v186
    v_mfma_f32_16x16x32_bf16 v[234:237], v[202:205], v[98:101], v[234:237]
    v_exp_f32 v187, v187
    v_mfma_f32_16x16x32_bf16 v[222:225], v[202:205], a[228:231], 0
    v_cvt_pk_bf16_f32 v190, v186, v187
    v_cvt_pk_bf16_f32 v39, v182, 0
    v_mfma_f32_16x16x32_bf16 v[222:225], v[202:205], a[252:255], v[222:225]
    v_exp_f32 v188, v188
    v_mfma_f32_16x16x32_bf16 v[194:197], v[28:31], v[36:39], 0
    v_exp_f32 v189, v189
    v_mfma_f32_16x16x32_bf16 v[194:197], v[28:31], v[210:213], v[194:197]
    v_mov_b32_dpp v143, v234 quad_perm:[0,1,2,3] row_mask:0x4 bank_mask:0xf
    v_mov_b32_dpp v143, v235 quad_perm:[0,1,2,3] row_mask:0x8 bank_mask:0xf
    v_mfma_f32_16x16x32_bf16 v[198:201], v[130:133], v[36:39], 0
    ds_write_b32 v255, v143 offset:1024
    v_mfma_f32_16x16x32_bf16 v[198:201], v[138:141], v[210:213], v[198:201]
    v_exp_f32 v206, v206
    v_mfma_f32_16x16x32_bf16 v[182:185], v[134:137], v[36:39], 0
    v_exp_f32 v207, v207
    v_mfma_f32_16x16x32_bf16 v[182:185], v[122:125], v[210:213], v[182:185]
    v_cvt_pk_bf16_f32 v191, v188, v189
    v_cvt_pk_bf16_f32 v192, v206, v207
    v_mfma_f32_16x16x32_bf16 v[158:161], v[114:117], v[36:39], 0
    v_exp_f32 v208, v208
    v_mfma_f32_16x16x32_bf16 v[158:161], v[166:169], v[210:213], v[158:161]
    v_exp_f32 v209, v209
    v_mfma_f32_16x16x32_bf16 v[222:225], v[202:205], v[102:105], v[222:225]
    v_cvt_pk_bf16_f32 v193, v208, v209
    v_cvt_pk_bf16_f32 v36, v174, v175
    v_mfma_f32_16x16x32_bf16 v[206:209], v[202:205], a[236:239], 0
    v_exp_f32 v242, v242
    v_mfma_f32_16x16x32_bf16 v[206:209], v[202:205], v[86:89], v[206:209]
    v_exp_f32 v243, v243
    v_mfma_f32_16x16x32_bf16 v[206:209], v[202:205], v[110:113], v[206:209]
    v_exp_f32 v244, v244
    v_exp_f32 v245, v245
    v_cvt_pk_bf16_f32 v37, v176, v177
    v_cvt_pk_bf16_f32 v39, v214, 0
    v_rcp_f32 v194, v194
    v_exp_f32 v142, v142
    v_mfma_f32_16x16x32_bf16 v[170:173], v[28:31], v[36:39], 0
    v_mul_f32 v198, v194, v198
    v_mov_b32 v119, v206
    v_mfma_f32_16x16x32_bf16 v[170:173], v[28:31], v[126:129], v[170:173]
    v_mov_b32_dpp v119, v222 quad_perm:[0,1,2,3] row_mask:0x2 bank_mask:0xf
    v_mov_b32_dpp v119, v223 quad_perm:[0,1,2,3] row_mask:0x4 bank_mask:0xf
    v_mfma_f32_16x16x32_bf16 v[146:149], v[130:133], v[36:39], 0
    v_mov_b32_dpp v119, v207 quad_perm:[0,1,2,3] row_mask:0x8 bank_mask:0xf
    v_mul_f32 v199, v194, v199
    v_mfma_f32_16x16x32_bf16 v[146:149], v[138:141], v[126:129], v[146:149]
    ds_write_b32 v255, v119 offset:2048
    v_mfma_f32_16x16x32_bf16 v[206:209], v[134:137], v[36:39], 0
    v_cvt_pk_bf16_f32 v222, v198, v199
    v_mul_f32 v200, v194, v200
    v_mfma_f32_16x16x32_bf16 v[206:209], v[122:125], v[126:129], v[206:209]
    v_mul_f32 v201, v194, v201
    v_cvt_pk_bf16_f32 v223, v200, v201
    v_mfma_f32_16x16x32_bf16 v[154:157], v[114:117], v[36:39], 0
    v_cvt_pk_bf16_f32 v36, v242, v243
    v_cvt_pk_bf16_f32 v37, v244, v245
    v_mfma_f32_16x16x32_bf16 v[154:157], v[166:169], v[126:129], v[154:157]
    v_cvt_pk_bf16_f32 v39, v118, 0
    v_mul_f32 v182, v194, v182
    v_mul_f32 v183, v194, v183
    v_mfma_f32_16x16x32_bf16 v[126:129], v[28:31], v[36:39], 0
    v_cvt_pk_bf16_f32 v224, v182, v183
    v_mul_f32 v184, v194, v184
    v_mfma_f32_16x16x32_bf16 v[126:129], v[28:31], v[190:193], v[126:129]
    v_mul_f32 v185, v194, v185
    v_cvt_pk_bf16_f32 v225, v184, v185
    v_mfma_f32_16x16x32_bf16 v[118:121], v[130:133], v[36:39], 0
    s_waitcnt lgkmcnt(0)
    v_mul_f32 v158, v194, v158
    v_mul_f32 v159, v194, v159
    v_mfma_f32_16x16x32_bf16 v[118:121], v[138:141], v[190:193], v[118:121]
    s_barrier
    ds_read_b128 v[182:185], v152 offset:0
    ds_read_b128 v[242:245], v152 offset:1024
    v_mfma_f32_16x16x32_bf16 v[174:177], v[134:137], v[36:39], 0
    ds_read_b128 v[162:165], v152 offset:2048
    v_cvt_pk_bf16_f32 v152, v158, v159
    v_mfma_f32_16x16x32_bf16 v[174:177], v[122:125], v[190:193], v[174:177]
    ds_write_b128 v3, v[222:225] offset:0
    v_mfma_f32_16x16x32_bf16 v[202:205], v[114:117], v[36:39], 0
    v_rcp_f32 v126, v126
    v_mfma_f32_16x16x32_bf16 v[202:205], v[166:169], v[190:193], v[202:205]
    v_mul_f32 v118, v126, v118
    v_mul_f32 v119, v126, v119
    v_cvt_pk_bf16_f32 v190, v118, v119
    v_mul_f32 v120, v126, v120
    v_mul_f32 v121, v126, v121
    v_cvt_pk_bf16_f32 v191, v120, v121
    v_mul_f32 v174, v126, v174
    v_mul_f32 v175, v126, v175
    v_cvt_pk_bf16_f32 v192, v174, v175
    s_waitcnt lgkmcnt(3)
    s_waitcnt lgkmcnt(2)
    v_add_f32 v182, v182, v183
    v_add_f32 v184, v184, v185
    s_waitcnt lgkmcnt(1)
    v_add_f32 v182, v182, v184
    v_mul_f32 v182, 0xbbaaaaab, v182
    ds_write_b32 v153, v182 offset:0
    v_add_f32 v242, v242, v243
    v_add_f32 v244, v244, v245
    v_add_f32 v242, v242, v244
    v_mul_f32 v242, 0xbbaaaaab, v242
    ds_write_b32 v153, v242 offset:256
    v_add_f32 v162, v162, v163
    v_add_f32 v164, v164, v165
    s_waitcnt vmcnt(0)
    s_barrier
    buffer_load_dwordx4 v10, s[8:11], 0 offen nt lds
    s_add_u32 m0, s28, 4096
    ds_read_b128 v[182:185], v0 offset:20480
    ds_read_b128 v[198:201], v1 offset:20480
    ds_read_b128 v[210:213], v0 offset:20608
    ds_read_b128 v[222:225], v1 offset:20608
    ds_read_b128 v[226:229], v0 offset:20736
    ds_read_b128 v[242:245], v1 offset:20736
    buffer_load_dwordx4 v11, s[8:11], 0 offen nt lds
    v_add_f32 v162, v162, v164
    v_mul_f32 v162, 0xbbaaaaab, v162
    s_add_u32 m0, s28, 8192
    ds_write_b32 v153, v162 offset:512
    v_mul_f32 v176, v126, v176
    v_mul_f32 v177, v126, v177
    v_cvt_pk_bf16_f32 v193, v176, v177
    v_mul_f32 v202, v126, v202
    ds_read_b128 v[174:177], v254 offset:0
    s_waitcnt lgkmcnt(7)
    v_mfma_f32_16x16x32_bf16 v[118:121], a[72:75], v[182:185], 0
    s_waitcnt lgkmcnt(5)
    buffer_load_dwordx4 v12, s[8:11], 0 offen nt lds
    ds_read_b128 v[218:221], v254 offset:64
    v_mfma_f32_16x16x32_bf16 v[118:121], a[76:79], v[198:201], v[118:121]
    s_add_u32 m0, s28, 12288
    ds_read_b128 v[178:181], v254 offset:128
    ds_read_b128 v[162:165], v254 offset:192
    v_mfma_f32_16x16x32_bf16 v[118:121], a[80:83], v[210:213], v[118:121]
    s_waitcnt lgkmcnt(6)
    ds_read_b128 v[186:189], v254 offset:256
    v_mul_f32 v203, v126, v203
    v_mfma_f32_16x16x32_bf16 v[118:121], a[84:87], v[222:225], v[118:121]
    s_xor_b32 s28, s28, 65536
    ds_write_b128 v3, v[190:193] offset:12288
    v_mfma_f32_16x16x32_bf16 v[118:121], a[88:91], v[226:229], v[118:121]
    s_waitcnt lgkmcnt(6)
    buffer_load_dwordx4 v13, s[8:11], 0 offen nt lds
    v_cvt_pk_bf16_f32 v144, v202, v203
    v_mfma_f32_16x16x32_bf16 v[118:121], a[92:95], v[242:245], v[118:121]
    s_mov_b32 m0, s29
    v_mul_f32 v204, v126, v204
    v_mul_f32 v205, v126, v205
    v_mfma_f32_16x16x32_bf16 v[190:193], a[96:99], v[182:185], 0
    s_waitcnt lgkmcnt(5)
    v_cvt_pk_bf16_f32 v145, v204, v205
    v_mul_f32 v160, v194, v160
    v_mul_f32 v161, v194, v161
    v_mfma_f32_16x16x16_bf16 v[194:197], a[216:217], v[150:151], v[174:177]
    v_cvt_pk_bf16_f32 v153, v160, v161
    v_rcp_f32 v170, v170
    v_mfma_f32_16x16x16_bf16 v[158:161], a[240:241], v[150:151], v[174:177]
    v_mul_f32 v146, v170, v146
    v_mul_f32 v147, v170, v147
    v_cvt_pk_bf16_f32 v146, v146, v147
    v_mfma_f32_16x16x16_bf16 v[126:129], v[90:91], v[150:151], v[174:177]
    v_mul_f32 v148, v170, v148
    v_cvt_pk_bf16_f32 v194, v194, v195
    v_accvgpr_write_b32 a216, v194
    v_cvt_pk_bf16_f32 v196, v196, v197
    v_mfma_f32_16x16x32_bf16 v[190:193], a[100:103], v[198:201], v[190:193]
    s_waitcnt lgkmcnt(0)
    buffer_load_dwordx4 v14, s[8:11], 0 offen nt lds
    ds_write_b64 v4, v[152:153] offset:4096
    v_mfma_f32_16x16x16_bf16 v[174:177], a[218:219], v[150:151], v[218:221]
    v_accvgpr_write_b32 a217, v196
    v_cvt_pk_bf16_f32 v158, v158, v159
    v_accvgpr_write_b32 a240, v158
    v_mfma_f32_16x16x16_bf16 v[194:197], a[242:243], v[150:151], v[218:221]
    v_cvt_pk_bf16_f32 v160, v160, v161
    v_accvgpr_write_b32 a241, v160
    v_cvt_pk_bf16_f32 v90, v126, v127
    v_mfma_f32_16x16x16_bf16 v[158:161], v[92:93], v[150:151], v[218:221]
    v_cvt_pk_bf16_f32 v91, v128, v129
    v_cvt_pk_bf16_f32 v174, v174, v175
    v_accvgpr_write_b32 a218, v174
    v_mfma_f32_16x16x16_bf16 v[126:129], a[232:233], v[150:151], v[178:181]
    v_cvt_pk_bf16_f32 v176, v176, v177
    v_accvgpr_write_b32 a219, v176
    v_cvt_pk_bf16_f32 v194, v194, v195
    v_mfma_f32_16x16x16_bf16 v[174:177], v[82:83], v[150:151], v[178:181]
    v_accvgpr_write_b32 a242, v194
    v_cvt_pk_bf16_f32 v196, v196, v197
    v_accvgpr_write_b32 a243, v196
    v_mfma_f32_16x16x16_bf16 v[194:197], v[106:107], v[150:151], v[178:181]
    v_cvt_pk_bf16_f32 v92, v158, v159
    v_cvt_pk_bf16_f32 v93, v160, v161
    v_cvt_pk_bf16_f32 v126, v126, v127
    v_mfma_f32_16x16x16_bf16 v[158:161], a[220:221], v[150:151], v[162:165]
    v_accvgpr_write_b32 a232, v126
    v_cvt_pk_bf16_f32 v128, v128, v129
    v_accvgpr_write_b32 a233, v128
    v_mfma_f32_16x16x16_bf16 v[202:205], a[244:245], v[150:151], v[162:165]
    v_cvt_pk_bf16_f32 v82, v174, v175
    v_cvt_pk_bf16_f32 v83, v176, v177
    v_cvt_pk_bf16_f32 v106, v194, v195
    v_mfma_f32_16x16x16_bf16 v[126:129], v[94:95], v[150:151], v[162:165]
    v_cvt_pk_bf16_f32 v107, v196, v197
    v_cvt_pk_bf16_f32 v158, v158, v159
    v_accvgpr_write_b32 a220, v158
    v_mfma_f32_16x16x16_bf16 v[174:177], a[222:223], v[150:151], v[186:189]
    v_cvt_pk_bf16_f32 v160, v160, v161
    v_accvgpr_write_b32 a221, v160
    v_cvt_pk_bf16_f32 v202, v202, v203
    v_mfma_f32_16x16x16_bf16 v[194:197], a[246:247], v[150:151], v[186:189]
    v_accvgpr_write_b32 a244, v202
    v_cvt_pk_bf16_f32 v204, v204, v205
    v_accvgpr_write_b32 a245, v204
    v_mfma_f32_16x16x16_bf16 v[162:165], v[96:97], v[150:151], v[186:189]
    v_cvt_pk_bf16_f32 v94, v126, v127
    v_cvt_pk_bf16_f32 v95, v128, v129
    v_cvt_pk_bf16_f32 v174, v174, v175
    v_accvgpr_write_b32 a222, v174
    v_mfma_f32_16x16x32_bf16 v[190:193], a[104:107], v[210:213], v[190:193]
    s_xor_b32 s29, s29, s30
    ds_read_b128 v[126:129], v254 offset:320
    ds_read_b128 v[202:205], v254 offset:384
    v_mfma_f32_16x16x32_bf16 v[190:193], a[108:111], v[222:225], v[190:193]
    ds_read_b128 v[218:221], v254 offset:448
    ds_read_b128 v[178:181], v254 offset:512
    v_mfma_f32_16x16x32_bf16 v[190:193], a[112:115], v[226:229], v[190:193]
    v_cvt_pk_bf16_f32 v176, v176, v177
    v_accvgpr_write_b32 a223, v176
    v_mfma_f32_16x16x32_bf16 v[190:193], a[116:119], v[242:245], v[190:193]
    ds_write_b64 v4, v[144:145] offset:16384
    v_mfma_f32_16x16x32_bf16 v[158:161], a[120:123], v[182:185], 0
    v_cvt_pk_bf16_f32 v194, v194, v195
    v_accvgpr_write_b32 a246, v194
    v_mfma_f32_16x16x32_bf16 v[158:161], a[124:127], v[198:201], v[158:161]
    v_cvt_pk_bf16_f32 v196, v196, v197
    v_accvgpr_write_b32 a247, v196
    v_mfma_f32_16x16x32_bf16 v[158:161], a[128:131], v[210:213], v[158:161]
    v_cvt_pk_bf16_f32 v96, v162, v163
    v_cvt_pk_bf16_f32 v97, v164, v165
    v_mfma_f32_16x16x32_bf16 v[158:161], a[132:135], v[222:225], v[158:161]
    s_waitcnt lgkmcnt(4)
    ds_read_b128 v[194:197], v254 offset:576
    v_mul_f32 v149, v170, v149
    v_cvt_pk_bf16_f32 v147, v148, v149
    v_mfma_f32_16x16x16_bf16 v[174:177], a[234:235], v[150:151], v[126:129]
    v_mul_f32 v206, v170, v206
    v_mul_f32 v207, v170, v207
    v_cvt_pk_bf16_f32 v148, v206, v207
    v_mfma_f32_16x16x16_bf16 v[162:165], v[84:85], v[150:151], v[126:129]
    v_mul_f32 v208, v170, v208
    v_mul_f32 v209, v170, v209
    v_cvt_pk_bf16_f32 v149, v208, v209
    v_mfma_f32_16x16x16_bf16 v[206:209], v[108:109], v[150:151], v[126:129]
    v_cvt_pk_bf16_f32 v174, v174, v175
    v_accvgpr_write_b32 a234, v174
    v_cvt_pk_bf16_f32 v176, v176, v177
    v_accvgpr_write_b32 a235, v176
    v_mfma_f32_16x16x32_bf16 v[158:161], a[136:139], v[226:229], v[158:161]
    s_waitcnt lgkmcnt(1)
    ds_write_b128 v3, v[146:149] offset:6144
    v_mfma_f32_16x16x16_bf16 v[146:149], a[224:225], v[150:151], v[202:205]
    v_cvt_pk_bf16_f32 v84, v162, v163
    v_cvt_pk_bf16_f32 v85, v164, v165
    v_cvt_pk_bf16_f32 v108, v206, v207
    v_mfma_f32_16x16x16_bf16 v[126:129], a[248:249], v[150:151], v[202:205]
    v_cvt_pk_bf16_f32 v109, v208, v209
    v_mul_f32 v154, v170, v154
    v_mul_f32 v155, v170, v155
    v_mfma_f32_16x16x16_bf16 v[206:209], v[98:99], v[150:151], v[202:205]
    v_cvt_pk_bf16_f32 v146, v146, v147
    v_accvgpr_write_b32 a224, v146
    v_cvt_pk_bf16_f32 v148, v148, v149
    v_mfma_f32_16x16x16_bf16 v[174:177], a[226:227], v[150:151], v[218:221]
    v_accvgpr_write_b32 a225, v148
    v_cvt_pk_bf16_f32 v126, v126, v127
    v_accvgpr_write_b32 a248, v126
    v_mfma_f32_16x16x16_bf16 v[146:149], a[250:251], v[150:151], v[218:221]
    v_cvt_pk_bf16_f32 v128, v128, v129
    v_accvgpr_write_b32 a249, v128
    v_cvt_pk_bf16_f32 v98, v206, v207
    v_mfma_f32_16x16x16_bf16 v[126:129], v[100:101], v[150:151], v[218:221]
    v_cvt_pk_bf16_f32 v99, v208, v209
    v_cvt_pk_bf16_f32 v174, v174, v175
    v_accvgpr_write_b32 a226, v174
    v_mfma_f32_16x16x16_bf16 v[206:209], a[236:237], v[150:151], v[178:181]
    v_cvt_pk_bf16_f32 v176, v176, v177
    v_accvgpr_write_b32 a227, v176
    v_cvt_pk_bf16_f32 v146, v146, v147
    v_mfma_f32_16x16x16_bf16 v[174:177], v[86:87], v[150:151], v[178:181]
    v_accvgpr_write_b32 a250, v146
    v_cvt_pk_bf16_f32 v148, v148, v149
    v_accvgpr_write_b32 a251, v148
    v_mfma_f32_16x16x16_bf16 v[146:149], v[110:111], v[150:151], v[178:181]
    v_cvt_pk_bf16_f32 v100, v126, v127
    v_cvt_pk_bf16_f32 v101, v128, v129
    v_cvt_pk_bf16_f32 v206, v206, v207
    v_accvgpr_write_b32 a236, v206
    v_mfma_f32_16x16x32_bf16 v[158:161], a[140:143], v[242:245], v[158:161]
    s_waitcnt lgkmcnt(0)
    ds_read_b128 v[126:129], v254 offset:640
    ds_read_b128 v[218:221], v254 offset:704
    v_cvt_pk_bf16_f32 v208, v208, v209
    v_mfma_f32_16x16x16_bf16 v[202:205], a[228:229], v[150:151], v[194:197]
    v_accvgpr_write_b32 a237, v208
    v_cvt_pk_bf16_f32 v86, v174, v175
    v_cvt_pk_bf16_f32 v87, v176, v177
    v_mfma_f32_16x16x16_bf16 v[174:177], a[252:253], v[150:151], v[194:197]
    v_cvt_pk_bf16_f32 v110, v146, v147
    v_cvt_pk_bf16_f32 v111, v148, v149
    v_cvt_pk_bf16_f32 v254, v154, v155
    v_mfma_f32_16x16x16_bf16 v[146:149], v[102:103], v[150:151], v[194:197]
    v_cvt_pk_bf16_f32 v202, v202, v203
    v_accvgpr_write_b32 a228, v202
    v_cvt_pk_bf16_f32 v204, v204, v205
    v_accvgpr_write_b32 a229, v204
    v_mfma_f32_16x16x32_bf16 v[206:209], a[0:3], v[182:185], 0
    v_cvt_pk_bf16_f32 v174, v174, v175
    v_accvgpr_write_b32 a252, v174
    v_mfma_f32_16x16x32_bf16 v[206:209], a[4:7], v[198:201], v[206:209]
    v_cvt_pk_bf16_f32 v176, v176, v177
    v_accvgpr_write_b32 a253, v176
    v_mfma_f32_16x16x32_bf16 v[206:209], a[8:11], v[210:213], v[206:209]
    v_cvt_pk_bf16_f32 v102, v146, v147
    v_cvt_pk_bf16_f32 v103, v148, v149
    v_mfma_f32_16x16x32_bf16 v[206:209], a[12:15], v[222:225], v[206:209]
    s_waitcnt lgkmcnt(0)
    v_mul_f32 v156, v170, v156
    v_mul_f32 v157, v170, v157
    v_cvt_pk_bf16_f32 v255, v156, v157
    v_mfma_f32_16x16x16_bf16 v[194:197], a[230:231], v[150:151], v[126:129]
    v_cvt_pk_f16_f32 v118, v118, v119
    v_pk_mul_f16 v163, v118, v118
    v_cvt_pk_f16_f32 v119, v120, v121
    v_mfma_f32_16x16x16_bf16 v[146:149], a[254:255], v[150:151], v[126:129]
    v_pk_mul_f16 v165, v119, v119
    v_cvt_pk_f16_f32 v120, v190, v191
    v_pk_fma_f16 v163, v120, v120, v163
    v_mfma_f32_16x16x16_bf16 v[154:157], v[104:105], v[150:151], v[126:129]
    v_cvt_pk_bf16_f32 v194, v194, v195
    v_accvgpr_write_b32 a230, v194
    v_cvt_pk_bf16_f32 v196, v196, v197
    v_mfma_f32_16x16x16_bf16 v[174:177], a[238:239], v[150:151], v[218:221]
    v_accvgpr_write_b32 a231, v196
    v_cvt_pk_bf16_f32 v146, v146, v147
    v_accvgpr_write_b32 a254, v146
    v_mfma_f32_16x16x16_bf16 v[194:197], v[88:89], v[150:151], v[218:221]
    v_cvt_pk_bf16_f32 v148, v148, v149
    v_accvgpr_write_b32 a255, v148
    v_cvt_pk_bf16_f32 v104, v154, v155
    v_mfma_f32_16x16x16_bf16 v[146:149], v[112:113], v[150:151], v[218:221]
    v_cvt_pk_bf16_f32 v105, v156, v157
    v_cvt_pk_bf16_f32 v174, v174, v175
    v_accvgpr_write_b32 a238, v174
    v_cvt_pk_bf16_f32 v176, v176, v177
    v_mfma_f32_16x16x32_bf16 v[206:209], a[16:19], v[226:229], v[206:209]
    ds_write_b64 v4, v[254:255] offset:10240
    v_mfma_f32_16x16x32_bf16 v[206:209], a[20:23], v[242:245], v[206:209]
    v_accvgpr_write_b32 a239, v176
    v_cvt_pk_bf16_f32 v88, v194, v195
    v_mfma_f32_16x16x32_bf16 v[174:177], a[24:27], v[182:185], 0
    v_cvt_pk_bf16_f32 v89, v196, v197
    v_cvt_pk_bf16_f32 v112, v146, v147
    v_mfma_f32_16x16x32_bf16 v[174:177], a[28:31], v[198:201], v[174:177]
    v_cvt_pk_bf16_f32 v113, v148, v149
    v_cvt_pk_f16_f32 v121, v192, v193
    v_mfma_f32_16x16x32_bf16 v[174:177], a[32:35], v[210:213], v[174:177]
    v_pk_fma_f16 v165, v121, v121, v165
    v_cvt_pk_f16_f32 v196, v158, v159
    v_mfma_f32_16x16x32_bf16 v[174:177], a[36:39], v[222:225], v[174:177]
    v_pk_fma_f16 v163, v196, v196, v163
    v_cvt_pk_f16_f32 v197, v160, v161
    v_mfma_f32_16x16x32_bf16 v[174:177], a[40:43], v[226:229], v[174:177]
    v_pk_fma_f16 v165, v197, v197, v165
    v_cvt_pk_f16_f32 v206, v206, v207
    v_mfma_f32_16x16x32_bf16 v[174:177], a[44:47], v[242:245], v[174:177]
    v_cvt_pk_bf16_f32 v142, v142, v142
    v_xor_b32 v3, 65536, v3
    v_mfma_f32_16x16x32_bf16 v[218:221], a[48:51], v[182:185], 0
    ds_write_b16 v8, v142
    v_mfma_f32_16x16x32_bf16 v[218:221], a[52:55], v[198:201], v[218:221]
    v_xor_b32 v4, 65536, v4
    v_mfma_f32_16x16x32_bf16 v[218:221], a[56:59], v[210:213], v[218:221]
    ds_read_b128 v[190:193], v9
    ds_read_b128 v[150:153], v9 offset:64
    v_mfma_f32_16x16x32_bf16 v[218:221], a[60:63], v[222:225], v[218:221]
    v_mfma_f32_16x16x32_bf16 v[218:221], a[64:67], v[226:229], v[218:221]
    v_mfma_f32_16x16x32_bf16 v[218:221], a[68:71], v[242:245], v[218:221]
    v_mfma_f32_16x16x32_bf16 v[170:173], v[182:185], a[144:147], 0
    v_mfma_f32_16x16x32_bf16 v[170:173], v[198:201], a[148:151], v[170:173]
    v_mfma_f32_16x16x32_bf16 v[170:173], v[210:213], a[152:155], v[170:173]
    v_mfma_f32_16x16x32_bf16 v[170:173], v[222:225], a[156:159], v[170:173]
    v_mfma_f32_16x16x32_bf16 v[170:173], v[226:229], a[160:163], v[170:173]
    s_waitcnt lgkmcnt(0)
    v_mfma_f32_16x16x32_bf16 v[158:161], v[190:193], v[28:31], 0
    v_mfma_f32_16x16x32_bf16 v[158:161], v[150:153], v[28:31], v[158:161]
    v_mfma_f32_16x16x32_bf16 v[146:149], v[190:193], v[138:141], 0
    v_mfma_f32_16x16x32_bf16 v[146:149], v[150:153], v[130:133], v[146:149]
    v_mfma_f32_16x16x32_bf16 v[130:133], v[190:193], v[122:125], 0
    v_mfma_f32_16x16x32_bf16 v[130:133], v[150:153], v[134:137], v[130:133]
    v_mfma_f32_16x16x32_bf16 v[122:125], v[190:193], v[166:169], 0
    v_mfma_f32_16x16x32_bf16 v[122:125], v[150:153], v[114:117], v[122:125]
    v_mfma_f32_16x16x32_bf16 v[170:173], v[242:245], a[164:167], v[170:173]
    s_nop 0
    v_rcp_f32 v158, v158
    s_nop 0
    v_mul_f32 v146, v146, v158
    s_nop 0
    v_mul_f32_dpp v146, v130, v158 quad_perm:[0,1,2,3] row_mask:0x2 bank_mask:0xf
    s_nop 0
    v_mul_f32_dpp v146, v122, v158 quad_perm:[0,1,2,3] row_mask:0x4 bank_mask:0xf
    v_cvt_pk_bf16_f32 v146, v146, v146
    ds_write_b16 v7, v146
    v_add_u32 v7, 16, v7
    s_waitcnt lgkmcnt(0)
    s_barrier
L_go:
    s_waitcnt lgkmcnt(0)
    s_cmp_eq_u32 s16, 1
    s_cbranch_scc1 L_loop_fast1
    s_cmp_eq_u32 s16, 2
    s_cbranch_scc1 L_loop_fast2
    s_cmp_eq_u32 s16, 3
    s_cbranch_scc1 L_loop_fast3
    s_branch L_loop_fast0
.p2align 6
L_loop_fast0:
    v_mfma_f32_16x16x32_bf16 v[234:237], v[182:185], a[168:171], 0
    s_add_u32 s12, s42, s27
    ds_read_b128 v[230:233], v2 offset:18432
    ds_read_b128 v[238:241], v2 offset:19456
    v_mfma_f32_16x16x32_bf16 v[234:237], v[198:201], a[172:175], v[234:237]
    s_addc_u32 s13, s43, 0
    v_pk_mul_f16 v162, v206, v206
    v_cvt_pk_f16_f32 v207, v208, v209
    v_mfma_f32_16x16x32_bf16 v[234:237], v[210:213], a[176:179], v[234:237]
    s_sub_u32 s14, s36, s27
    ds_read_b128 v[134:137], v0 offset:26624
    v_pk_mul_f16 v164, v207, v207
    v_mfma_f32_16x16x32_bf16 v[234:237], v[222:225], a[180:183], v[234:237]
    s_cmp_ge_u32 s18, 2
    ds_read_b128 v[154:157], v1 offset:26624
    v_cvt_pk_f16_f32 v208, v174, v175
    v_mfma_f32_16x16x32_bf16 v[234:237], v[226:229], a[184:187], v[234:237]
    s_cselect_b32 s14, s14, 0
    ds_read_b128 v[130:133], v0 offset:26752
    v_pk_fma_f16 v162, v208, v208, v162
    v_mfma_f32_16x16x32_bf16 v[234:237], v[242:245], a[188:191], v[234:237]
    s_add_u32 s34, s18, 2
    ds_read_b128 v[122:125], v1 offset:26752
    v_cvt_pk_f16_f32 v209, v176, v177
    v_mfma_f32_16x16x32_bf16 v[114:117], v[182:185], a[192:195], 0
    s_add_u32 s8, s40, s23
    ds_read_b128 v[126:129], v0 offset:26880
    v_pk_fma_f16 v164, v209, v209, v164
    v_mfma_f32_16x16x32_bf16 v[114:117], v[198:201], a[196:199], v[114:117]
    s_addc_u32 s9, s41, 0
    ds_read_b128 v[166:169], v1 offset:26880
    v_cvt_pk_f16_f32 v194, v218, v219
    v_mfma_f32_16x16x32_bf16 v[114:117], v[210:213], a[200:203], v[114:117]
    s_waitcnt lgkmcnt(6)
    v_pk_fma_f16 v162, v194, v194, v162
    v_cvt_pk_f16_f32 v195, v220, v221
    v_mfma_f32_16x16x32_bf16 v[198:201], v[32:35], v[230:233], 0
    s_sub_u32 s10, s36, s23
    v_pk_fma_f16 v164, v195, v195, v164
    v_cvt_pk_bf16_f32 v174, v170, v171
    v_mfma_f32_16x16x32_bf16 v[198:201], v[32:35], v[238:241], v[198:201]
    s_waitcnt lgkmcnt(5)
    v_cvt_pk_bf16_f32 v175, v172, v173
    v_cvt_pk_bf16_f32 v182, v234, v235
    v_mfma_f32_16x16x32_f16 v[170:173], v[40:43], v[162:165], 0
    s_cmp_lt_u32 s34, s17
    v_cvt_pk_bf16_f32 v183, v236, v237
    s_cselect_b32 s10, s10, 0
    v_mfma_f32_16x16x32_bf16 v[114:117], v[222:225], a[204:207], v[114:117]
    s_add_u32 m0, s28, 0
    v_mul_f32 v255, 0x3baaaaab, v198
    v_mul_f32 v254, 0x3baaaaab, v199
    v_mfma_f32_16x16x32_bf16 v[114:117], v[226:229], a[208:211], v[114:117]
    s_mov_b32 s27, s26
    v_rsq_f32 v172, v170
    v_mfma_f32_16x16x32_bf16 v[114:117], v[242:245], a[212:215], v[114:117]
    s_mov_b32 s26, s25
    v_rsq_f32 v173, v171
    v_mfma_f32_16x16x32_bf16 v[162:165], a[72:75], v[134:137], 0
    s_waitcnt lgkmcnt(0)
    v_mul_f32 v172, s31, v172
    v_cvt_pk_f16_f32 v172, v172, v173
    v_mfma_f32_16x16x32_bf16 v[162:165], a[76:79], v[154:157], v[162:165]
    s_mov_b32 s25, s24
    v_cvt_pk_bf16_f32 v114, v114, v115
    v_cvt_pk_bf16_f32 v115, v116, v117
    v_mfma_f32_16x16x32_bf16 v[162:165], a[80:83], v[130:133], v[162:165]
    s_mov_b32 s24, s23
    v_pk_mul_f16 v118, v118, v172 op_sel:[0,1] op_sel_hi:[1,1]
    v_pk_mul_f16 v119, v119, v172 op_sel:[0,1] op_sel_hi:[1,1]
    v_mfma_f32_16x16x32_bf16 v[162:165], a[84:87], v[122:125], v[162:165]
    v_pk_mul_f16 v120, v120, v172 op_sel:[0,1] op_sel_hi:[1,1]
    v_pk_mul_f16 v121, v121, v172 op_sel:[0,1] op_sel_hi:[1,1]
    v_mfma_f32_16x16x32_bf16 v[162:165], a[88:91], v[126:129], v[162:165]
    v_pk_mul_f16 v196, v196, v172 op_sel:[0,1] op_sel_hi:[1,1]
    v_pk_mul_f16 v197, v197, v172 op_sel:[0,1] op_sel_hi:[1,1]
    v_mfma_f32_16x16x32_bf16 v[162:165], a[92:95], v[166:169], v[162:165]
    v_pk_mul_f16 v206, v206, v172 op_sel:[0,0] op_sel_hi:[1,0]
    v_pk_mul_f16 v207, v207, v172 op_sel:[0,0] op_sel_hi:[1,0]
    v_mfma_f32_16x16x32_bf16 v[210:213], a[96:99], v[134:137], 0
    v_pk_mul_f16 v208, v208, v172 op_sel:[0,0] op_sel_hi:[1,0]
    v_pk_mul_f16 v209, v209, v172 op_sel:[0,0] op_sel_hi:[1,0]
    v_mfma_f32_16x16x32_bf16 v[210:213], a[100:103], v[154:157], v[210:213]
    v_pk_mul_f16 v194, v194, v172 op_sel:[0,0] op_sel_hi:[1,0]
    v_pk_mul_f16 v195, v195, v172 op_sel:[0,0] op_sel_hi:[1,0]
    v_mfma_f32_16x16x32_bf16 v[210:213], a[104:107], v[130:133], v[210:213]
    v_min3_u32 v44, v44, v170, v171
    v_max3_u32 v45, v45, v170, v171
    v_mfma_f32_16x16x32_bf16 v[210:213], a[108:111], v[122:125], v[210:213]
    v_cvt_pk_f16_f32 v170, v162, v163
    v_pk_mul_f16 v163, v170, v170
    v_mfma_f32_16x16x32_bf16 v[210:213], a[112:115], v[126:129], v[210:213]
    v_cvt_pk_f16_f32 v171, v164, v165
    v_pk_mul_f16 v165, v171, v171
    v_mfma_f32_16x16x32_bf16 v[210:213], a[116:119], v[166:169], v[210:213]
    v_rsq_f32 v255, v255
    v_mfma_f32_16x16x32_bf16 v[214:217], a[120:123], v[134:137], 0
    v_rsq_f32 v254, v254
    v_mfma_f32_16x16x32_bf16 v[214:217], a[124:127], v[154:157], v[214:217]
    v_mul_f32 v142, v254, v142
    v_mul_f32 v143, v254, v143
    v_mfma_f32_16x16x32_bf16 v[214:217], a[128:131], v[130:133], v[214:217]
    v_cvt_pk_bf16_f32 v142, v142, v143
    v_cvt_pk_f16_f32 v172, v210, v211
    v_mfma_f32_16x16x32_bf16 v[214:217], a[132:135], v[122:125], v[214:217]
    v_pk_fma_f16 v163, v172, v172, v163
    v_cvt_pk_f16_f32 v173, v212, v213
    v_mfma_f32_16x16x32_bf16 v[214:217], a[136:139], v[126:129], v[214:217]
    v_pk_fma_f16 v165, v173, v173, v165
    v_mul_f32 v144, v254, v144
    v_mfma_f32_16x16x32_bf16 v[214:217], a[140:143], v[166:169], v[214:217]
    v_mul_f32 v145, v254, v145
    v_cvt_pk_bf16_f32 v143, v144, v145
    v_mfma_f32_16x16x32_bf16 v[210:213], a[0:3], v[134:137], 0
    v_mul_f32 v158, v254, v158
    v_mul_f32 v159, v254, v159
    v_mfma_f32_16x16x32_bf16 v[210:213], a[4:7], v[154:157], v[210:213]
    v_cvt_pk_bf16_f32 v144, v158, v159
    v_mul_f32 v160, v254, v160
    v_mfma_f32_16x16x32_bf16 v[210:213], a[8:11], v[130:133], v[210:213]
    v_cvt_pk_f16_f32 v220, v214, v215
    v_pk_fma_f16 v163, v220, v220, v163
    v_mfma_f32_16x16x32_bf16 v[210:213], a[12:15], v[122:125], v[210:213]
    v_cvt_pk_f16_f32 v221, v216, v217
    v_pk_fma_f16 v165, v221, v221, v165
    v_mfma_f32_16x16x32_bf16 v[210:213], a[16:19], v[126:129], v[210:213]
    v_mul_f32 v161, v254, v161
    v_cvt_pk_bf16_f32 v145, v160, v161
    v_mfma_f32_16x16x32_bf16 v[210:213], a[20:23], v[166:169], v[210:213]
    buffer_store_dwordx4 v[142:145], v16, s[12:15], 0 offen nt
    v_mul_f32 v178, v254, v178
    v_mul_f32 v179, v254, v179
    v_cvt_pk_bf16_f32 v198, v178, v179
    v_mul_f32 v180, v254, v180
    v_mfma_f32_16x16x32_bf16 v[142:145], a[24:27], v[134:137], 0
    v_mul_f32 v181, v254, v181
    v_cvt_pk_bf16_f32 v199, v180, v181
    v_mfma_f32_16x16x32_bf16 v[142:145], a[28:31], v[154:157], v[142:145]
    v_cvt_pk_f16_f32 v158, v210, v211
    v_pk_mul_f16 v162, v158, v158
    v_mfma_f32_16x16x32_bf16 v[142:145], a[32:35], v[130:133], v[142:145]
    v_cvt_pk_f16_f32 v159, v212, v213
    v_pk_mul_f16 v164, v159, v159
    v_mfma_f32_16x16x32_bf16 v[142:145], a[36:39], v[122:125], v[142:145]
    v_mul_f32 v254, 0x3baaaaab, v200
    v_mul_f32 v150, v255, v150
    v_mfma_f32_16x16x32_bf16 v[142:145], a[40:43], v[126:129], v[142:145]
    v_rsq_f32 v254, v254
    v_mfma_f32_16x16x32_bf16 v[142:145], a[44:47], v[166:169], v[142:145]
    v_mul_f32 v146, v254, v146
    v_mul_f32 v147, v254, v147
    v_mfma_f32_16x16x32_bf16 v[178:181], a[48:51], v[134:137], 0
    v_cvt_pk_bf16_f32 v146, v146, v147
    v_mul_f32 v148, v254, v148
    v_mfma_f32_16x16x32_bf16 v[178:181], a[52:55], v[154:157], v[178:181]
    v_mul_f32 v149, v254, v149
    v_cvt_pk_bf16_f32 v147, v148, v149
    v_mfma_f32_16x16x32_bf16 v[178:181], a[56:59], v[130:133], v[178:181]
    v_mul_f32 v138, v254, v138
    v_mul_f32 v139, v254, v139
    v_mfma_f32_16x16x32_bf16 v[178:181], a[60:63], v[122:125], v[178:181]
    v_cvt_pk_bf16_f32 v148, v138, v139
    v_mul_f32 v140, v254, v140
    v_mfma_f32_16x16x32_bf16 v[178:181], a[64:67], v[126:129], v[178:181]
    v_mul_f32 v141, v254, v141
    v_cvt_pk_bf16_f32 v149, v140, v141
    v_mfma_f32_16x16x32_bf16 v[178:181], a[68:71], v[166:169], v[178:181]
    v_mul_f32 v186, v254, v186
    v_mul_f32 v187, v254, v187
    v_mfma_f32_16x16x32_bf16 v[138:141], v[134:137], a[144:147], 0
    v_cvt_pk_bf16_f32 v200, v186, v187
    v_mul_f32 v188, v254, v188
    v_mfma_f32_16x16x32_bf16 v[138:141], v[154:157], a[148:151], v[138:141]
    v_mul_f32 v189, v254, v189
    v_cvt_pk_bf16_f32 v201, v188, v189
    v_mfma_f32_16x16x32_bf16 v[138:141], v[130:133], a[152:155], v[138:141]
    v_cvt_pk_f16_f32 v160, v142, v143
    v_pk_fma_f16 v162, v160, v160, v162
    v_mfma_f32_16x16x32_bf16 v[138:141], v[122:125], a[156:159], v[138:141]
    v_cvt_pk_f16_f32 v161, v144, v145
    v_pk_fma_f16 v164, v161, v161, v164
    v_mfma_f32_16x16x32_bf16 v[138:141], v[126:129], a[160:163], v[138:141]
    buffer_store_dwordx4 v[146:149], v17, s[12:15], 0 offen nt
    v_cvt_pk_f16_f32 v218, v178, v179
    v_pk_fma_f16 v162, v218, v218, v162
    v_cvt_pk_f16_f32 v219, v180, v181
    v_pk_fma_f16 v164, v219, v219, v164
    v_mfma_f32_16x16x32_bf16 v[138:141], v[166:169], a[164:167], v[138:141]
    v_mul_f32 v151, v255, v151
    v_cvt_pk_bf16_f32 v150, v150, v151
    v_mfma_f32_16x16x32_f16 v[142:145], v[40:43], v[162:165], 0
    v_mul_f32 v152, v255, v152
    v_mul_f32 v153, v255, v153
    v_mfma_f32_16x16x32_bf16 v[178:181], v[134:137], a[168:171], 0
    v_cvt_pk_bf16_f32 v151, v152, v153
    v_mul_f32 v190, v255, v190
    v_mfma_f32_16x16x32_bf16 v[178:181], v[154:157], a[172:175], v[178:181]
    v_cvt_pk_bf16_f32 v176, v138, v139
    v_cvt_pk_bf16_f32 v177, v140, v141
    v_mfma_f32_16x16x32_bf16 v[178:181], v[130:133], a[176:179], v[178:181]
    ds_read_b128 v[146:149], v0 offset:32768
    v_min3_u32 v44, v44, v142, v143
    v_mfma_f32_16x16x32_bf16 v[178:181], v[122:125], a[180:183], v[178:181]
    ds_read_b128 v[138:141], v1 offset:32768
    v_max3_u32 v45, v45, v142, v143
    v_mfma_f32_16x16x32_bf16 v[178:181], v[126:129], a[184:187], v[178:181]
    ds_read_b128 v[186:189], v0 offset:32896
    v_mul_f32 v191, v255, v191
    v_mfma_f32_16x16x32_bf16 v[178:181], v[166:169], a[188:191], v[178:181]
    ds_read_b128 v[162:165], v1 offset:32896
    v_cvt_pk_bf16_f32 v152, v190, v191
    v_mfma_f32_16x16x32_bf16 v[210:213], v[134:137], a[192:195], 0
    ds_read_b128 v[134:137], v0 offset:33024
    v_mul_f32 v192, v255, v192
    v_mfma_f32_16x16x32_bf16 v[210:213], v[154:157], a[196:199], v[210:213]
    ds_read_b128 v[154:157], v1 offset:33024
    v_mul_f32 v193, v255, v193
    v_mfma_f32_16x16x32_bf16 v[210:213], v[130:133], a[200:203], v[210:213]
    v_rsq_f32 v144, v142
    v_mfma_f32_16x16x32_bf16 v[210:213], v[122:125], a[204:207], v[210:213]
    v_rsq_f32 v145, v143
    v_mfma_f32_16x16x32_bf16 v[210:213], v[126:129], a[208:211], v[210:213]
    s_waitcnt lgkmcnt(5)
    v_mul_f32 v144, s31, v144
    v_cvt_pk_f16_f32 v144, v144, v145
    v_mfma_f32_16x16x32_bf16 v[210:213], v[166:169], a[212:215], v[210:213]
    s_waitcnt lgkmcnt(4)
    v_cvt_pk_bf16_f32 v184, v178, v179
    v_cvt_pk_bf16_f32 v185, v180, v181
    v_mfma_f32_16x16x32_bf16 v[178:181], a[72:75], v[146:149], 0
    s_waitcnt lgkmcnt(3)
    v_pk_mul_f16 v170, v170, v144 op_sel:[0,1] op_sel_hi:[1,1]
    v_pk_mul_f16 v171, v171, v144 op_sel:[0,1] op_sel_hi:[1,1]
    v_mfma_f32_16x16x32_bf16 v[178:181], a[76:79], v[138:141], v[178:181]
    s_waitcnt lgkmcnt(2)
    v_cvt_pk_bf16_f32 v116, v210, v211
    v_cvt_pk_bf16_f32 v117, v212, v213
    v_mfma_f32_16x16x32_bf16 v[178:181], a[80:83], v[186:189], v[178:181]
    s_waitcnt lgkmcnt(1)
    buffer_store_dwordx2 v[200:201], v20, s[12:15], 0 offen nt
    v_pk_mul_f16 v172, v172, v144 op_sel:[0,1] op_sel_hi:[1,1]
    v_pk_mul_f16 v173, v173, v144 op_sel:[0,1] op_sel_hi:[1,1]
    v_mfma_f32_16x16x32_bf16 v[178:181], a[84:87], v[162:165], v[178:181]
    s_waitcnt lgkmcnt(0)
    v_pk_mul_f16 v220, v220, v144 op_sel:[0,1] op_sel_hi:[1,1]
    v_pk_mul_f16 v221, v221, v144 op_sel:[0,1] op_sel_hi:[1,1]
    v_mfma_f32_16x16x32_bf16 v[178:181], a[88:91], v[134:137], v[178:181]
    v_pk_mul_f16 v158, v158, v144 op_sel:[0,0] op_sel_hi:[1,0]
    v_pk_mul_f16 v159, v159, v144 op_sel:[0,0] op_sel_hi:[1,0]
    v_mfma_f32_16x16x32_bf16 v[178:181], a[92:95], v[154:157], v[178:181]
    v_pk_mul_f16 v160, v160, v144 op_sel:[0,0] op_sel_hi:[1,0]
    v_pk_mul_f16 v161, v161, v144 op_sel:[0,0] op_sel_hi:[1,0]
    v_mfma_f32_16x16x32_bf16 v[130:133], a[96:99], v[146:149], 0
    v_pk_mul_f16 v218, v218, v144 op_sel:[0,0] op_sel_hi:[1,0]
    v_pk_mul_f16 v219, v219, v144 op_sel:[0,0] op_sel_hi:[1,0]
    v_mfma_f32_16x16x32_bf16 v[130:133], a[100:103], v[138:141], v[130:133]
    s_waitcnt vmcnt(3)
    v_cvt_pk_bf16_f32 v153, v192, v193
    v_cvt_pk_f16_f32 v142, v178, v179
    v_mfma_f32_16x16x32_bf16 v[130:133], a[104:107], v[186:189], v[130:133]
    s_barrier
    v_pk_mul_f16 v191, v142, v142
    v_cvt_pk_f16_f32 v143, v180, v181
    v_mfma_f32_16x16x32_bf16 v[130:133], a[108:111], v[162:165], v[130:133]
    s_nop 0
    v_pk_mul_f16 v193, v143, v143
    v_mul_f32 v202, v255, v202
    v_mfma_f32_16x16x32_bf16 v[130:133], a[112:115], v[134:137], v[130:133]
    s_nop 0
    v_mul_f32 v203, v255, v203
    v_cvt_pk_bf16_f32 v254, v202, v203
    v_mfma_f32_16x16x32_bf16 v[130:133], a[116:119], v[154:157], v[130:133]
    s_nop 0
    v_mul_f32 v204, v255, v204
    v_mul_f32 v205, v255, v205
    v_mfma_f32_16x16x32_bf16 v[178:181], a[120:123], v[146:149], 0
    v_cvt_pk_bf16_f32 v255, v204, v205
    v_xor_b32 v0, 65536, v0
    v_mfma_f32_16x16x32_bf16 v[178:181], a[124:127], v[138:141], v[178:181]
    v_xor_b32 v1, 65536, v1
    v_cvt_pk_f16_f32 v144, v130, v131
    v_mfma_f32_16x16x32_bf16 v[178:181], a[128:131], v[186:189], v[178:181]
    v_pk_fma_f16 v191, v144, v144, v191
    v_cvt_pk_f16_f32 v145, v132, v133
    v_mfma_f32_16x16x32_bf16 v[178:181], a[132:135], v[162:165], v[178:181]
    v_pk_fma_f16 v193, v145, v145, v193
    v_mfma_f32_16x16x32_bf16 v[178:181], a[136:139], v[134:137], v[178:181]
    v_mfma_f32_16x16x32_bf16 v[178:181], a[140:143], v[154:157], v[178:181]
    v_mfma_f32_16x16x32_bf16 v[202:205], a[0:3], v[146:149], 0
    v_mfma_f32_16x16x32_bf16 v[202:205], a[4:7], v[138:141], v[202:205]
    buffer_load_dwordx4 v10, s[8:11], 0 offen nt lds
    s_add_u32 m0, s28, 4096
    v_mfma_f32_16x16x32_bf16 v[202:205], a[8:11], v[186:189], v[202:205]
    v_mfma_f32_16x16x32_bf16 v[202:205], a[12:15], v[162:165], v[202:205]
    v_mfma_f32_16x16x32_bf16 v[202:205], a[16:19], v[134:137], v[202:205]
    v_mfma_f32_16x16x32_bf16 v[202:205], a[20:23], v[154:157], v[202:205]
    v_cvt_pk_f16_f32 v124, v178, v179
    v_pk_fma_f16 v191, v124, v124, v191
    v_mfma_f32_16x16x32_bf16 v[130:133], a[24:27], v[146:149], 0
    buffer_load_dwordx4 v11, s[8:11], 0 offen nt lds
    v_cvt_pk_f16_f32 v125, v180, v181
    v_mfma_f32_16x16x32_bf16 v[130:133], a[28:31], v[138:141], v[130:133]
    s_add_u32 m0, s28, 8192
    v_pk_fma_f16 v193, v125, v125, v193
    v_cvt_pk_f16_f32 v178, v202, v203
    v_mfma_f32_16x16x32_bf16 v[130:133], a[32:35], v[186:189], v[130:133]
    v_pk_mul_f16 v190, v178, v178
    v_cvt_pk_f16_f32 v179, v204, v205
    v_mfma_f32_16x16x32_bf16 v[130:133], a[36:39], v[162:165], v[130:133]
    v_pk_mul_f16 v192, v179, v179
    v_mfma_f32_16x16x32_bf16 v[130:133], a[40:43], v[134:137], v[130:133]
    v_mfma_f32_16x16x32_bf16 v[130:133], a[44:47], v[154:157], v[130:133]
    buffer_load_dwordx4 v12, s[8:11], 0 offen nt lds
    s_add_u32 m0, s28, 12288
    v_mfma_f32_16x16x32_bf16 v[202:205], a[48:51], v[146:149], 0
    s_xor_b32 s28, s28, 65536
    v_mfma_f32_16x16x32_bf16 v[202:205], a[52:55], v[138:141], v[202:205]
    ds_read_b128 v[166:169], v5 offset:0
    ds_read_b128 v[126:129], v5 offset:16
    v_mfma_f32_16x16x32_bf16 v[202:205], a[56:59], v[186:189], v[202:205]
    ds_read_b128 v[210:213], v5 offset:48
    ds_read_b32 v200, v6 offset:192
    v_mfma_f32_16x16x32_bf16 v[202:205], a[60:63], v[162:165], v[202:205]
    v_cvt_pk_f16_f32 v180, v130, v131
    v_pk_fma_f16 v190, v180, v180, v190
    v_mfma_f32_16x16x32_bf16 v[202:205], a[64:67], v[134:137], v[202:205]
    buffer_load_dwordx4 v13, s[8:11], 0 offen nt lds
    v_cvt_pk_f16_f32 v181, v132, v133
    v_mfma_f32_16x16x32_bf16 v[202:205], a[68:71], v[154:157], v[202:205]
    s_mov_b32 m0, s29
    v_pk_fma_f16 v192, v181, v181, v192
    v_add_u32 v5, 336, v5
    v_mfma_f32_16x16x32_bf16 v[130:133], v[146:149], a[144:147], 0
    s_xor_b32 s29, s29, s30
    s_add_u32 s19, s19, s20
    s_add_u32 s23, s23, s21
    v_mfma_f32_16x16x32_bf16 v[130:133], v[138:141], a[148:151], v[130:133]
    s_cmp_ge_u32 s19, 72
    v_cvt_pk_f16_f32 v122, v202, v203
    v_pk_fma_f16 v190, v122, v122, v190
    v_mfma_f32_16x16x32_bf16 v[130:133], v[186:189], a[152:155], v[130:133]
    s_cselect_b32 s34, 72, 0
    v_cvt_pk_f16_f32 v123, v204, v205
    v_pk_fma_f16 v192, v123, v123, v192
    v_mfma_f32_16x16x32_bf16 v[130:133], v[162:165], a[156:159], v[130:133]
    s_waitcnt lgkmcnt(2)
    buffer_store_dwordx2 v[198:199], v19, s[12:15], 0 offen nt
    s_cselect_b32 s35, s22, 0
    s_sub_u32 s19, s19, s34
    v_mfma_f32_16x16x32_f16 v[202:205], v[40:43], v[190:193], 0
    s_add_u32 s23, s23, s35
    s_add_u32 s18, s18, 1
    s_cmp_lt_u32 s18, s17
    v_mfma_f32_16x16x32_f16 v[214:217], v[166:169], v[158:161], v[24:27]
    s_waitcnt lgkmcnt(0)
    v_mfma_f32_16x16x32_f16 v[214:217], v[126:129], v[170:173], v[214:217]
    v_mfma_f32_16x16x32_f16 v[214:217], v[210:213], v[218:221], v[214:217]
    v_mfma_f32_16x16x32_f16 v[190:193], v[166:169], v[206:209], v[22:25]
    v_rsq_f32 v204, v202
    v_mfma_f32_16x16x32_f16 v[190:193], v[126:129], v[118:121], v[190:193]
    v_rsq_f32 v205, v203
    v_mfma_f32_16x16x32_f16 v[190:193], v[210:213], v[194:197], v[190:193]
    v_mul_f32 v204, s31, v204
    v_cvt_pk_f16_f32 v204, v204, v205
    v_mfma_f32_16x16x32_bf16 v[130:133], v[134:137], a[160:163], v[130:133]
    v_pk_mul_f16 v142, v142, v204 op_sel:[0,1] op_sel_hi:[1,1]
    v_pk_mul_f16 v143, v143, v204 op_sel:[0,1] op_sel_hi:[1,1]
    v_mfma_f32_16x16x32_bf16 v[130:133], v[154:157], a[164:167], v[130:133]
    v_pk_mul_f16 v144, v144, v204 op_sel:[0,1] op_sel_hi:[1,1]
    v_pk_mul_f16 v145, v145, v204 op_sel:[0,1] op_sel_hi:[1,1]
    v_mfma_f32_16x16x32_bf16 v[222:225], v[146:149], a[168:171], 0
    v_mov_b32_dpp v200, v191 quad_perm:[0,1,2,3] row_mask:0x1 bank_mask:0xf
    v_mov_b32_dpp v200, v215 quad_perm:[0,1,2,3] row_mask:0x2 bank_mask:0xf
    v_mfma_f32_16x16x32_bf16 v[222:225], v[138:141], a[172:175], v[222:225]
    v_pk_mul_f16 v124, v124, v204 op_sel:[0,1] op_sel_hi:[1,1]
    v_pk_mul_f16 v125, v125, v204 op_sel:[0,1] op_sel_hi:[1,1]
    v_mfma_f32_16x16x32_bf16 v[222:225], v[186:189], a[176:179], v[222:225]
    v_cvt_pk_bf16_f32 v130, v130, v131
    v_cvt_pk_bf16_f32 v131, v132, v133
    v_mfma_f32_16x16x32_bf16 v[222:225], v[162:165], a[180:183], v[222:225]
    v_pk_mul_f16 v178, v178, v204 op_sel:[0,0] op_sel_hi:[1,0]
    v_pk_mul_f16 v179, v179, v204 op_sel:[0,0] op_sel_hi:[1,0]
    v_mfma_f32_16x16x32_f16 v[226:229], v[118:121], v[206:209], v[46:49]
    v_pk_mul_f16 v180, v180, v204 op_sel:[0,0] op_sel_hi:[1,0]
    v_pk_mul_f16 v181, v181, v204 op_sel:[0,0] op_sel_hi:[1,0]
    v_mfma_f32_16x16x32_f16 v[230:233], v[170:173], v[206:209], v[50:53]
    v_pk_mul_f16 v122, v122, v204 op_sel:[0,0] op_sel_hi:[1,0]
    v_pk_mul_f16 v123, v123, v204 op_sel:[0,0] op_sel_hi:[1,0]
    v_mfma_f32_16x16x32_f16 v[234:237], v[142:145], v[206:209], v[54:57]
    v_min3_u32 v44, v44, v202, v203
    v_exp_f32 v214, v214
    v_mfma_f32_16x16x16_f16 v[226:229], v[196:197], v[194:195], v[226:229]
    v_max3_u32 v45, v45, v202, v203
    v_exp_f32 v190, v190
    v_mfma_f32_16x16x16_f16 v[230:233], v[220:221], v[194:195], v[230:233]
    v_cvt_pk_bf16_f32 v39, v190, 0
    v_mfma_f32_16x16x16_f16 v[234:237], v[124:125], v[194:195], v[234:237]
    buffer_store_dwordx4 v[150:153], v15, s[12:15], 0 offen nt
    v_mfma_f32_16x16x32_bf16 v[222:225], v[134:137], a[184:187], v[222:225]
    v_mfma_f32_16x16x32_bf16 v[222:225], v[154:157], a[188:191], v[222:225]
    ds_read_b128 v[206:209], v2 offset:0
    v_mfma_f32_16x16x32_bf16 v[150:153], v[146:149], a[192:195], 0
    ds_read_b128 v[146:149], v2 offset:1024
    v_mfma_f32_16x16x32_bf16 v[150:153], v[138:141], a[196:199], v[150:153]
    ds_read_b128 v[138:141], v2 offset:2048
    v_mfma_f32_16x16x32_bf16 v[150:153], v[186:189], a[200:203], v[150:153]
    ds_read_b128 v[186:189], v2 offset:3072
    v_mfma_f32_16x16x32_bf16 v[150:153], v[162:165], a[204:207], v[150:153]
    ds_read_b128 v[162:165], v2 offset:4096
    v_cvt_pk_bf16_f32 v222, v222, v223
    v_mfma_f32_16x16x32_bf16 v[150:153], v[134:137], a[208:211], v[150:153]
    ds_read_b128 v[134:137], v2 offset:5120
    v_cvt_pk_bf16_f32 v223, v224, v225
    v_mfma_f32_16x16x32_bf16 v[150:153], v[154:157], a[212:215], v[150:153]
    ds_read2_b32 v[132:133], v6 offset0:0 offset1:0
    ds_read2_b32 v[224:225], v6 offset0:16 offset1:16
    v_mfma_f32_16x16x32_f16 v[154:157], v[166:169], v[178:181], v[26:29]
    ds_read2_b32 v[168:169], v6 offset0:32 offset1:32
    v_add_u32 v6, 272, v6
    v_mfma_f32_16x16x32_f16 v[154:157], v[126:129], v[142:145], v[154:157]
    s_waitcnt lgkmcnt(8)
    v_exp_f32 v226, v226
    v_mfma_f32_16x16x32_f16 v[154:157], v[210:213], v[122:125], v[154:157]
    s_waitcnt lgkmcnt(7)
    v_cvt_pk_bf16_f32 v166, v150, v151
    v_cvt_pk_bf16_f32 v167, v152, v153
    v_mfma_f32_16x16x32_bf16 v[150:153], a[216:219], v[206:209], 0
    s_waitcnt lgkmcnt(6)
    v_exp_f32 v227, v227
    v_mfma_f32_16x16x32_bf16 v[150:153], a[220:223], v[146:149], v[150:153]
    s_waitcnt lgkmcnt(5)
    v_exp_f32 v154, v154
    v_mfma_f32_16x16x32_bf16 v[150:153], a[224:227], v[138:141], v[150:153]
    s_waitcnt lgkmcnt(4)
    v_mov_b32_dpp v200, v155 quad_perm:[0,1,2,3] row_mask:0x4 bank_mask:0xf
    v_cvt_pk_bf16_f32 v126, v226, v227
    v_mfma_f32_16x16x32_bf16 v[150:153], a[228:231], v[186:189], v[150:153]
    s_waitcnt lgkmcnt(3)
    v_exp_f32 v200, v200
    v_mfma_f32_16x16x32_bf16 v[150:153], a[232:235], v[162:165], v[150:153]
    s_waitcnt lgkmcnt(1)
    v_exp_f32 v228, v228
    v_mfma_f32_16x16x32_bf16 v[150:153], a[236:239], v[134:137], v[150:153]
    s_waitcnt lgkmcnt(0)
    buffer_store_dwordx2 v[254:255], v18, s[12:15], 0 offen nt
    v_exp_f32 v229, v229
    v_mfma_f32_16x16x32_bf16 v[190:193], a[240:243], v[206:209], 0
    v_cvt_pk_bf16_f32 v200, v200, v200
    v_cvt_pk_bf16_f32 v127, v228, v229
    v_mfma_f32_16x16x32_bf16 v[190:193], a[244:247], v[146:149], v[190:193]
    ds_write_b16 v8, v200
    v_mfma_f32_16x16x32_bf16 v[190:193], a[248:251], v[138:141], v[190:193]
    v_exp_f32 v230, v230
    v_mfma_f32_16x16x32_bf16 v[190:193], a[252:255], v[186:189], v[190:193]
    ds_read_b128 v[198:201], v2 offset:6144
    ds_read_b128 v[210:213], v9
    v_mfma_f32_16x16x32_bf16 v[190:193], v[82:85], v[162:165], v[190:193]
    ds_read_b128 v[226:229], v2 offset:7168
    ds_read_b128 v[238:241], v9 offset:64
    v_mfma_f32_16x16x32_bf16 v[190:193], v[86:89], v[134:137], v[190:193]
    v_exp_f32 v231, v231
    v_mfma_f32_16x16x32_bf16 v[202:205], v[90:93], v[206:209], 0
    ds_read_b128 v[206:209], v2 offset:8192
    ds_read_b128 v[242:245], v2 offset:9216
    v_mfma_f32_16x16x32_bf16 v[202:205], v[94:97], v[146:149], v[202:205]
    v_cvt_pk_bf16_f32 v128, v230, v231
    v_fma_f32 v254, v150, v150, s33
    v_mfma_f32_16x16x32_bf16 v[202:205], v[98:101], v[138:141], v[202:205]
    ds_read_b128 v[146:149], v2 offset:10240
    ds_read_b128 v[138:141], v2 offset:11264
    v_mfma_f32_16x16x32_bf16 v[202:205], v[102:105], v[186:189], v[202:205]
    v_exp_f32 v232, v232
    v_mfma_f32_16x16x32_bf16 v[202:205], v[106:109], v[162:165], v[202:205]
    v_exp_f32 v233, v233
    v_mfma_f32_16x16x32_bf16 v[202:205], v[110:113], v[134:137], v[202:205]
    s_waitcnt lgkmcnt(6)
    v_cvt_pk_bf16_f32 v129, v232, v233
    v_fmac_f32 v254, v151, v151
    v_mfma_f32_16x16x32_bf16 v[186:189], v[210:213], v[28:31], 0
    s_waitcnt lgkmcnt(4)
    v_exp_f32 v234, v234
    v_mfma_f32_16x16x32_bf16 v[186:189], v[238:241], v[28:31], v[186:189]
    v_exp_f32 v235, v235
    v_mfma_f32_16x16x32_f16 v[134:137], v[118:121], v[158:161], v[58:61]
    s_waitcnt lgkmcnt(2)
    v_cvt_pk_bf16_f32 v36, v234, v235
    v_fmac_f32 v254, v152, v152
    v_mfma_f32_16x16x32_f16 v[162:165], v[170:173], v[158:161], v[62:65]
    v_exp_f32 v236, v236
    v_mfma_f32_16x16x32_f16 v[230:233], v[142:145], v[158:161], v[66:69]
    s_waitcnt lgkmcnt(0)
    buffer_load_dwordx4 v14, s[8:11], 0 offen nt lds
    v_rcp_f32 v186, v186
    v_mfma_f32_16x16x16_f16 v[134:137], v[196:197], v[218:219], v[134:137]
    v_exp_f32 v237, v237
    v_fmac_f32 v254, v153, v153
    v_mfma_f32_16x16x16_f16 v[162:165], v[220:221], v[218:219], v[162:165]
    v_cvt_pk_bf16_f32 v37, v236, v237
    v_fmac_f32 v254, v190, v190
    v_fmac_f32 v254, v191, v191
    v_mfma_f32_16x16x16_f16 v[230:233], v[124:125], v[218:219], v[230:233]
    v_fmac_f32 v254, v192, v192
    v_exp_f32 v134, v134
    v_fmac_f32 v254, v193, v193
    v_mfma_f32_16x16x32_bf16 v[158:161], v[210:213], v[174:177], 0
    v_exp_f32 v135, v135
    v_mfma_f32_16x16x32_bf16 v[158:161], v[238:241], v[130:133], v[158:161]
    v_cvt_pk_bf16_f32 v134, v134, v135
    v_fmac_f32 v254, v202, v202
    v_mfma_f32_16x16x32_bf16 v[234:237], v[210:213], v[182:185], 0
    v_exp_f32 v136, v136
    v_mfma_f32_16x16x32_bf16 v[234:237], v[238:241], v[222:225], v[234:237]
    v_exp_f32 v137, v137
    v_mfma_f32_16x16x32_bf16 v[246:249], v[210:213], v[114:117], 0
    v_cvt_pk_bf16_f32 v135, v136, v137
    v_mul_f32 v158, v158, v186
    v_mfma_f32_16x16x32_bf16 v[246:249], v[238:241], v[166:169], v[246:249]
    v_exp_f32 v162, v162
    v_mfma_f32_16x16x32_bf16 v[210:213], v[28:31], v[36:39], 0
    v_exp_f32 v163, v163
    v_mfma_f32_16x16x32_bf16 v[210:213], v[28:31], v[126:129], v[210:213]
    v_cvt_pk_bf16_f32 v136, v162, v163
    v_mul_f32_dpp v158, v234, v186 quad_perm:[0,1,2,3] row_mask:0x2 bank_mask:0xf
    v_mfma_f32_16x16x32_bf16 v[234:237], v[130:133], v[36:39], 0
    v_exp_f32 v164, v164
    v_mfma_f32_16x16x32_bf16 v[234:237], v[174:177], v[126:129], v[234:237]
    v_exp_f32 v165, v165
    v_mfma_f32_16x16x32_bf16 v[238:241], v[222:225], v[36:39], 0
    v_cvt_pk_bf16_f32 v137, v164, v165
    v_mul_f32_dpp v158, v246, v186 quad_perm:[0,1,2,3] row_mask:0x4 bank_mask:0xf
    v_mfma_f32_16x16x32_bf16 v[238:241], v[182:185], v[126:129], v[238:241]
    v_exp_f32 v230, v230
    v_mfma_f32_16x16x32_bf16 v[186:189], v[166:169], v[36:39], 0
    v_exp_f32 v231, v231
    v_mfma_f32_16x16x32_bf16 v[186:189], v[114:117], v[126:129], v[186:189]
    v_cvt_pk_bf16_f32 v36, v230, v231
    v_cvt_pk_bf16_f32 v39, v214, 0
    v_mfma_f32_16x16x32_f16 v[162:165], v[118:121], v[178:181], v[70:73]
    v_exp_f32 v232, v232
    v_mfma_f32_16x16x32_f16 v[118:121], v[170:173], v[178:181], v[74:77]
    v_exp_f32 v233, v233
    v_mfma_f32_16x16x32_f16 v[170:173], v[142:145], v[178:181], v[78:81]
    v_cvt_pk_bf16_f32 v37, v232, v233
    v_cvt_pk_bf16_f32 v158, v158, v158
    v_fmac_f32 v254, v203, v203
    v_mfma_f32_16x16x16_f16 v[162:165], v[196:197], v[122:123], v[162:165]
    v_rcp_f32 v210, v210
    v_fmac_f32 v254, v204, v204
    v_mfma_f32_16x16x16_f16 v[118:121], v[220:221], v[122:123], v[118:121]
    v_mul_f32 v234, v210, v234
    v_mul_f32 v235, v210, v235
    v_cvt_pk_bf16_f32 v178, v234, v235
    v_mfma_f32_16x16x16_f16 v[170:173], v[124:125], v[122:123], v[170:173]
    v_mul_f32 v236, v210, v236
    v_exp_f32 v162, v162
    v_mul_f32 v237, v210, v237
    v_mfma_f32_16x16x32_bf16 v[194:197], v[28:31], v[36:39], 0
    ds_write_b16 v7, v158
    v_mfma_f32_16x16x32_bf16 v[194:197], v[28:31], v[134:137], v[194:197]
    v_exp_f32 v163, v163
    v_mfma_f32_16x16x32_bf16 v[122:125], v[130:133], v[36:39], 0
    v_cvt_pk_bf16_f32 v162, v162, v163
    v_cvt_pk_bf16_f32 v179, v236, v237
    v_mfma_f32_16x16x32_bf16 v[122:125], v[174:177], v[134:137], v[122:125]
    v_exp_f32 v164, v164
    v_mfma_f32_16x16x32_bf16 v[126:129], v[222:225], v[36:39], 0
    v_exp_f32 v165, v165
    v_mfma_f32_16x16x32_bf16 v[126:129], v[182:185], v[134:137], v[126:129]
    v_cvt_pk_bf16_f32 v163, v164, v165
    v_mul_f32 v238, v210, v238
    v_mfma_f32_16x16x32_bf16 v[218:221], v[166:169], v[36:39], 0
    v_exp_f32 v118, v118
    v_mfma_f32_16x16x32_bf16 v[218:221], v[114:117], v[134:137], v[218:221]
    v_exp_f32 v119, v119
    v_mfma_f32_16x16x32_bf16 v[142:145], a[216:219], v[198:201], 0
    v_cvt_pk_bf16_f32 v164, v118, v119
    v_cvt_pk_bf16_f32 v39, v154, 0
    v_mfma_f32_16x16x32_bf16 v[142:145], a[220:223], v[226:229], v[142:145]
    v_exp_f32 v120, v120
    v_mfma_f32_16x16x32_bf16 v[142:145], a[224:227], v[206:209], v[142:145]
    v_exp_f32 v121, v121
    v_mfma_f32_16x16x32_bf16 v[142:145], a[228:231], v[242:245], v[142:145]
    v_cvt_pk_bf16_f32 v165, v120, v121
    v_mul_f32 v239, v210, v239
    v_mfma_f32_16x16x32_bf16 v[142:145], a[232:235], v[146:149], v[142:145]
    v_exp_f32 v170, v170
    v_mfma_f32_16x16x32_bf16 v[142:145], a[236:239], v[138:141], v[142:145]
    v_exp_f32 v171, v171
    v_mfma_f32_16x16x32_bf16 v[158:161], a[240:243], v[198:201], 0
    v_cvt_pk_bf16_f32 v36, v170, v171
    v_cvt_pk_bf16_f32 v180, v238, v239
    v_mfma_f32_16x16x32_bf16 v[158:161], a[244:247], v[226:229], v[158:161]
    v_exp_f32 v172, v172
    v_mfma_f32_16x16x32_bf16 v[158:161], a[248:251], v[206:209], v[158:161]
    v_exp_f32 v173, v173
    v_mfma_f32_16x16x32_bf16 v[158:161], a[252:255], v[242:245], v[158:161]
    ds_read_b128 v[118:121], v2 offset:12288
    v_cvt_pk_bf16_f32 v37, v172, v173
    v_mfma_f32_16x16x32_bf16 v[158:161], v[82:85], v[146:149], v[158:161]
    ds_read_b128 v[134:137], v2 offset:13312
    v_mul_f32 v240, v210, v240
    v_mfma_f32_16x16x32_bf16 v[170:173], v[28:31], v[36:39], 0
    v_mul_f32 v241, v210, v241
    v_cvt_pk_bf16_f32 v181, v240, v241
    v_mfma_f32_16x16x32_bf16 v[170:173], v[28:31], v[162:165], v[170:173]
    ds_write_b128 v3, v[178:181] offset:0
    v_mfma_f32_16x16x32_bf16 v[154:157], v[130:133], v[36:39], 0
    v_mul_f32 v186, v210, v186
    v_mul_f32 v187, v210, v187
    v_mfma_f32_16x16x32_bf16 v[154:157], v[174:177], v[162:165], v[154:157]
    v_cvt_pk_bf16_f32 v186, v186, v187
    v_mul_f32 v188, v210, v188
    v_mfma_f32_16x16x32_bf16 v[130:133], v[222:225], v[36:39], 0
    v_mul_f32 v189, v210, v189
    v_cvt_pk_bf16_f32 v187, v188, v189
    v_mfma_f32_16x16x32_bf16 v[130:133], v[182:185], v[162:165], v[130:133]
    s_waitcnt lgkmcnt(2)
    ds_write_b64 v4, v[186:187] offset:4096
    v_mfma_f32_16x16x32_bf16 v[174:177], v[166:169], v[36:39], 0
    s_waitcnt lgkmcnt(2)
    v_fma_f32 v255, v142, v142, s33
    v_fmac_f32 v255, v143, v143
    v_mfma_f32_16x16x32_bf16 v[174:177], v[114:117], v[162:165], v[174:177]
    v_fmac_f32 v255, v144, v144
    v_fmac_f32 v255, v145, v145
    v_mfma_f32_16x16x32_bf16 v[158:161], v[86:89], v[138:141], v[158:161]
    ds_read_b128 v[114:117], v2 offset:14336
    v_fmac_f32 v254, v205, v205
    v_mfma_f32_16x16x32_bf16 v[178:181], v[90:93], v[198:201], 0
    ds_read_b128 v[166:169], v2 offset:15360
    v_add_u32 v7, 16, v7
    v_mfma_f32_16x16x32_bf16 v[178:181], v[94:97], v[226:229], v[178:181]
    ds_read_b128 v[162:165], v2 offset:16384
    v_mfma_f32_16x16x32_bf16 v[178:181], v[98:101], v[206:209], v[178:181]
    ds_read_b128 v[206:209], v2 offset:17408
    v_fmac_f32 v255, v158, v158
    v_mfma_f32_16x16x32_bf16 v[178:181], v[102:105], v[242:245], v[178:181]
    v_fmac_f32 v255, v159, v159
    v_fmac_f32 v255, v160, v160
    v_mfma_f32_16x16x32_bf16 v[178:181], v[106:109], v[146:149], v[178:181]
    v_fmac_f32 v255, v161, v161
    v_xor_b32 v2, 65536, v2
    v_mfma_f32_16x16x32_bf16 v[178:181], v[110:113], v[138:141], v[178:181]
    v_rcp_f32 v170, v170
    v_mfma_f32_16x16x32_bf16 v[146:149], a[216:219], v[118:121], 0
    v_mul_f32 v154, v170, v154
    v_mul_f32 v155, v170, v155
    v_mfma_f32_16x16x32_bf16 v[146:149], a[220:223], v[134:137], v[146:149]
    s_waitcnt lgkmcnt(3)
    ds_read_b128 v[182:185], v0 offset:20480
    v_cvt_pk_bf16_f32 v154, v154, v155
    v_mfma_f32_16x16x32_bf16 v[146:149], a[224:227], v[114:117], v[146:149]
    s_waitcnt lgkmcnt(3)
    ds_read_b128 v[198:201], v1 offset:20480
    v_fmac_f32 v255, v178, v178
    v_mfma_f32_16x16x32_bf16 v[146:149], a[228:231], v[166:169], v[146:149]
    s_waitcnt lgkmcnt(3)
    ds_read_b128 v[210:213], v0 offset:20608
    v_fmac_f32 v255, v179, v179
    v_mfma_f32_16x16x32_bf16 v[146:149], a[232:235], v[162:165], v[146:149]
    s_waitcnt lgkmcnt(3)
    ds_read_b128 v[222:225], v1 offset:20608
    v_fmac_f32 v255, v180, v180
    v_mfma_f32_16x16x32_bf16 v[146:149], a[236:239], v[206:209], v[146:149]
    ds_read_b128 v[226:229], v0 offset:20736
    v_fmac_f32 v255, v181, v181
    v_mfma_f32_16x16x32_bf16 v[138:141], a[240:243], v[118:121], 0
    ds_read_b128 v[242:245], v1 offset:20736
    v_cvt_pk_bf16_f32 v254, v254, v255
    v_mfma_f32_16x16x32_bf16 v[138:141], a[244:247], v[134:137], v[138:141]
    v_mul_f32 v156, v170, v156
    v_mul_f32 v157, v170, v157
    v_mfma_f32_16x16x32_bf16 v[138:141], a[248:251], v[114:117], v[138:141]
    v_fma_f32 v255, v146, v146, s33
    v_fmac_f32 v255, v147, v147
    v_mfma_f32_16x16x32_bf16 v[138:141], a[252:255], v[166:169], v[138:141]
    s_waitcnt lgkmcnt(5)
    v_fmac_f32 v255, v148, v148
    v_fmac_f32 v255, v149, v149
    v_mfma_f32_16x16x32_bf16 v[138:141], v[82:85], v[162:165], v[138:141]
    s_waitcnt lgkmcnt(4)
    v_cvt_pk_bf16_f32 v155, v156, v157
    v_mul_f32 v130, v170, v130
    v_mfma_f32_16x16x32_bf16 v[138:141], v[86:89], v[206:209], v[138:141]
    s_waitcnt lgkmcnt(3)
    v_mul_f32 v131, v170, v131
    v_cvt_pk_bf16_f32 v156, v130, v131
    v_mfma_f32_16x16x32_bf16 v[186:189], v[90:93], v[118:121], 0
    s_waitcnt lgkmcnt(2)
    v_mul_f32 v132, v170, v132
    v_mul_f32 v133, v170, v133
    v_mfma_f32_16x16x32_bf16 v[186:189], v[94:97], v[134:137], v[186:189]
    s_waitcnt lgkmcnt(1)
    v_fmac_f32 v255, v138, v138
    v_fmac_f32 v255, v139, v139
    v_mfma_f32_16x16x32_bf16 v[186:189], v[98:101], v[114:117], v[186:189]
    s_waitcnt lgkmcnt(0)
    v_fmac_f32 v255, v140, v140
    v_fmac_f32 v255, v141, v141
    v_mfma_f32_16x16x32_bf16 v[186:189], v[102:105], v[166:169], v[186:189]
    v_cvt_pk_bf16_f32 v157, v132, v133
    v_mul_f32 v174, v170, v174
    v_mfma_f32_16x16x32_bf16 v[186:189], v[106:109], v[162:165], v[186:189]
    ds_write_b128 v3, v[154:157] offset:12288
    v_mfma_f32_16x16x32_bf16 v[186:189], v[110:113], v[206:209], v[186:189]
    v_mul_f32 v175, v170, v175
    v_cvt_pk_bf16_f32 v174, v174, v175
    v_mfma_f32_16x16x32_bf16 v[118:121], a[72:75], v[182:185], 0
    v_mul_f32 v176, v170, v176
    v_mul_f32 v177, v170, v177
    v_mfma_f32_16x16x32_bf16 v[118:121], a[76:79], v[198:201], v[118:121]
    v_rcp_f32 v194, v194
    v_mfma_f32_16x16x32_bf16 v[118:121], a[80:83], v[210:213], v[118:121]
    v_fmac_f32 v255, v186, v186
    v_fmac_f32 v255, v187, v187
    v_mfma_f32_16x16x32_bf16 v[118:121], a[84:87], v[222:225], v[118:121]
    v_fmac_f32 v255, v188, v188
    v_fmac_f32 v255, v189, v189
    v_mfma_f32_16x16x32_bf16 v[118:121], a[88:91], v[226:229], v[118:121]
    v_cvt_pk_bf16_f32 v255, v255, v255
    v_cvt_pk_bf16_f32 v175, v176, v177
    v_mfma_f32_16x16x32_bf16 v[118:121], a[92:95], v[242:245], v[118:121]
    ds_write_b64 v4, v[174:175] offset:16384
    v_mfma_f32_16x16x32_bf16 v[206:209], a[96:99], v[182:185], 0
    v_mul_f32 v122, v194, v122
    v_mul_f32 v123, v194, v123
    v_mfma_f32_16x16x32_bf16 v[206:209], a[100:103], v[198:201], v[206:209]
    ds_write_b64 v4, v[254:255] offset:18432
    v_mfma_f32_16x16x32_bf16 v[206:209], a[104:107], v[210:213], v[206:209]
    v_cvt_pk_bf16_f32 v134, v122, v123
    v_cvt_pk_f16_f32 v118, v118, v119
    v_mfma_f32_16x16x32_bf16 v[206:209], a[108:111], v[222:225], v[206:209]
    v_pk_mul_f16 v163, v118, v118
    v_cvt_pk_f16_f32 v119, v120, v121
    v_mfma_f32_16x16x32_bf16 v[206:209], a[112:115], v[226:229], v[206:209]
    v_pk_mul_f16 v165, v119, v119
    v_mul_f32 v124, v194, v124
    v_mfma_f32_16x16x32_bf16 v[206:209], a[116:119], v[242:245], v[206:209]
    v_mul_f32 v125, v194, v125
    v_cvt_pk_bf16_f32 v135, v124, v125
    v_mfma_f32_16x16x32_bf16 v[122:125], a[120:123], v[182:185], 0
    v_mul_f32 v126, v194, v126
    v_mul_f32 v127, v194, v127
    v_mfma_f32_16x16x32_bf16 v[122:125], a[124:127], v[198:201], v[122:125]
    v_cvt_pk_bf16_f32 v136, v126, v127
    v_mul_f32 v128, v194, v128
    v_mfma_f32_16x16x32_bf16 v[122:125], a[128:131], v[210:213], v[122:125]
    v_cvt_pk_f16_f32 v120, v206, v207
    v_pk_fma_f16 v163, v120, v120, v163
    v_mfma_f32_16x16x32_bf16 v[122:125], a[132:135], v[222:225], v[122:125]
    v_cvt_pk_f16_f32 v121, v208, v209
    v_pk_fma_f16 v165, v121, v121, v165
    v_mfma_f32_16x16x32_bf16 v[122:125], a[136:139], v[226:229], v[122:125]
    v_mul_f32 v129, v194, v129
    v_cvt_pk_bf16_f32 v137, v128, v129
    v_mfma_f32_16x16x32_bf16 v[122:125], a[140:143], v[242:245], v[122:125]
    ds_write_b128 v3, v[134:137] offset:6144
    v_mfma_f32_16x16x32_bf16 v[206:209], a[0:3], v[182:185], 0
    v_mul_f32 v218, v194, v218
    v_mul_f32 v219, v194, v219
    v_mfma_f32_16x16x32_bf16 v[206:209], a[4:7], v[198:201], v[206:209]
    v_cvt_pk_bf16_f32 v254, v218, v219
    v_mul_f32 v220, v194, v220
    v_mfma_f32_16x16x32_bf16 v[206:209], a[8:11], v[210:213], v[206:209]
    v_cvt_pk_f16_f32 v196, v122, v123
    v_pk_fma_f16 v163, v196, v196, v163
    v_mfma_f32_16x16x32_bf16 v[206:209], a[12:15], v[222:225], v[206:209]
    v_cvt_pk_f16_f32 v197, v124, v125
    v_pk_fma_f16 v165, v197, v197, v165
    v_mfma_f32_16x16x32_bf16 v[206:209], a[16:19], v[226:229], v[206:209]
    v_mul_f32 v221, v194, v221
    v_cvt_pk_bf16_f32 v255, v220, v221
    v_mfma_f32_16x16x32_bf16 v[206:209], a[20:23], v[242:245], v[206:209]
    ds_write_b64 v4, v[254:255] offset:10240
    v_mfma_f32_16x16x32_bf16 v[174:177], a[24:27], v[182:185], 0
    v_xor_b32 v3, 65536, v3
    v_xor_b32 v4, 65536, v4
    v_mfma_f32_16x16x32_bf16 v[174:177], a[28:31], v[198:201], v[174:177]
    v_mfma_f32_16x16x32_bf16 v[174:177], a[32:35], v[210:213], v[174:177]
    v_mfma_f32_16x16x32_bf16 v[174:177], a[36:39], v[222:225], v[174:177]
    v_mfma_f32_16x16x32_bf16 v[174:177], a[40:43], v[226:229], v[174:177]
    v_cvt_pk_f16_f32 v206, v206, v207
    v_mfma_f32_16x16x32_bf16 v[174:177], a[44:47], v[242:245], v[174:177]
    v_mfma_f32_16x16x32_bf16 v[218:221], a[48:51], v[182:185], 0
    s_waitcnt lgkmcnt(0)
    v_mfma_f32_16x16x32_bf16 v[218:221], a[52:55], v[198:201], v[218:221]
    s_barrier
    v_mfma_f32_16x16x32_bf16 v[218:221], a[56:59], v[210:213], v[218:221]
    s_nop 0
    v_mfma_f32_16x16x32_bf16 v[218:221], a[60:63], v[222:225], v[218:221]
    s_nop 0
    v_mfma_f32_16x16x32_bf16 v[218:221], a[64:67], v[226:229], v[218:221]
    s_nop 0
    v_mfma_f32_16x16x32_bf16 v[218:221], a[68:71], v[242:245], v[218:221]
    v_mfma_f32_16x16x32_bf16 v[170:173], v[182:185], a[144:147], 0
    v_mfma_f32_16x16x32_bf16 v[170:173], v[198:201], a[148:151], v[170:173]
    v_mfma_f32_16x16x32_bf16 v[170:173], v[210:213], a[152:155], v[170:173]
    v_mfma_f32_16x16x32_bf16 v[170:173], v[222:225], a[156:159], v[170:173]
    v_mfma_f32_16x16x32_bf16 v[170:173], v[226:229], a[160:163], v[170:173]
    v_mfma_f32_16x16x32_bf16 v[170:173], v[242:245], a[164:167], v[170:173]
    s_cbranch_scc1 L_loop_fast0
    s_branch L_drain
.p2align 6
L_loop_fast1:
    v_mfma_f32_16x16x32_bf16 v[234:237], v[182:185], a[168:171], 0
    s_add_u32 s12, s42, s27
    ds_read_b128 v[230:233], v2 offset:18432
    ds_read_b128 v[238:241], v2 offset:19456
    v_mfma_f32_16x16x32_bf16 v[234:237], v[198:201], a[172:175], v[234:237]
    s_addc_u32 s13, s43, 0
    v_pk_mul_f16 v162, v206, v206
    v_cvt_pk_f16_f32 v207, v208, v209
    v_mfma_f32_16x16x32_bf16 v[234:237], v[210:213], a[176:179], v[234:237]
    s_sub_u32 s14, s36, s27
    ds_read_b128 v[134:137], v0 offset:26624
    v_pk_mul_f16 v164, v207, v207
    v_mfma_f32_16x16x32_bf16 v[234:237], v[222:225], a[180:183], v[234:237]
    s_cmp_ge_u32 s18, 2
    ds_read_b128 v[154:157], v1 offset:26624
    v_cvt_pk_f16_f32 v208, v174, v175
    v_mfma_f32_16x16x32_bf16 v[234:237], v[226:229], a[184:187], v[234:237]
    s_cselect_b32 s14, s14, 0
    ds_read_b128 v[130:133], v0 offset:26752
    v_pk_fma_f16 v162, v208, v208, v162
    v_mfma_f32_16x16x32_bf16 v[234:237], v[242:245], a[188:191], v[234:237]
    s_add_u32 s34, s18, 2
    ds_read_b128 v[122:125], v1 offset:26752
    v_cvt_pk_f16_f32 v209, v176, v177
    v_mfma_f32_16x16x32_bf16 v[114:117], v[182:185], a[192:195], 0
    s_add_u32 s8, s40, s23
    ds_read_b128 v[126:129], v0 offset:26880
    v_pk_fma_f16 v164, v209, v209, v164
    v_mfma_f32_16x16x32_bf16 v[114:117], v[198:201], a[196:199], v[114:117]
    s_addc_u32 s9, s41, 0
    ds_read_b128 v[166:169], v1 offset:26880
    v_cvt_pk_f16_f32 v194, v218, v219
    v_mfma_f32_16x16x32_bf16 v[114:117], v[210:213], a[200:203], v[114:117]
    s_waitcnt lgkmcnt(6)
    v_pk_fma_f16 v162, v194, v194, v162
    v_cvt_pk_f16_f32 v195, v220, v221
    v_mfma_f32_16x16x32_bf16 v[198:201], v[32:35], v[230:233], 0
    s_sub_u32 s10, s36, s23
    v_pk_fma_f16 v164, v195, v195, v164
    v_cvt_pk_bf16_f32 v174, v170, v171
    v_mfma_f32_16x16x32_bf16 v[198:201], v[32:35], v[238:241], v[198:201]
    s_waitcnt lgkmcnt(5)
    v_cvt_pk_bf16_f32 v175, v172, v173
    v_cvt_pk_bf16_f32 v182, v234, v235
    v_mfma_f32_16x16x32_f16 v[170:173], v[40:43], v[162:165], 0
    s_cmp_lt_u32 s34, s17
    v_cvt_pk_bf16_f32 v183, v236, v237
    s_cselect_b32 s10, s10, 0
    v_mfma_f32_16x16x32_bf16 v[114:117], v[222:225], a[204:207], v[114:117]
    s_add_u32 m0, s28, 0
    v_mul_f32 v255, 0x3baaaaab, v198
    v_mul_f32 v254, 0x3baaaaab, v199
    v_mfma_f32_16x16x32_bf16 v[114:117], v[226:229], a[208:211], v[114:117]
    s_mov_b32 s27, s26
    v_rsq_f32 v172, v170
    v_mfma_f32_16x16x32_bf16 v[114:117], v[242:245], a[212:215], v[114:117]
    s_mov_b32 s26, s25
    v_rsq_f32 v173, v171
    v_mfma_f32_16x16x32_bf16 v[162:165], a[72:75], v[134:137], 0
    s_waitcnt lgkmcnt(0)
    v_mul_f32 v172, s31, v172
    v_cvt_pk_f16_f32 v172, v172, v173
    v_mfma_f32_16x16x32_bf16 v[162:165], a[76:79], v[154:157], v[162:165]
    s_mov_b32 s25, s24
    v_cvt_pk_bf16_f32 v114, v114, v115
    v_cvt_pk_bf16_f32 v115, v116, v117
    v_mfma_f32_16x16x32_bf16 v[162:165], a[80:83], v[130:133], v[162:165]
    s_mov_b32 s24, s23
    v_pk_mul_f16 v118, v118, v172 op_sel:[0,1] op_sel_hi:[1,1]
    v_pk_mul_f16 v119, v119, v172 op_sel:[0,1] op_sel_hi:[1,1]
    v_mfma_f32_16x16x32_bf16 v[162:165], a[84:87], v[122:125], v[162:165]
    v_pk_mul_f16 v120, v120, v172 op_sel:[0,1] op_sel_hi:[1,1]
    v_pk_mul_f16 v121, v121, v172 op_sel:[0,1] op_sel_hi:[1,1]
    v_mfma_f32_16x16x32_bf16 v[162:165], a[88:91], v[126:129], v[162:165]
    v_pk_mul_f16 v196, v196, v172 op_sel:[0,1] op_sel_hi:[1,1]
    v_pk_mul_f16 v197, v197, v172 op_sel:[0,1] op_sel_hi:[1,1]
    v_mfma_f32_16x16x32_bf16 v[162:165], a[92:95], v[166:169], v[162:165]
    v_pk_mul_f16 v206, v206, v172 op_sel:[0,0] op_sel_hi:[1,0]
    v_pk_mul_f16 v207, v207, v172 op_sel:[0,0] op_sel_hi:[1,0]
    v_mfma_f32_16x16x32_bf16 v[210:213], a[96:99], v[134:137], 0
    v_pk_mul_f16 v208, v208, v172 op_sel:[0,0] op_sel_hi:[1,0]
    v_pk_mul_f16 v209, v209, v172 op_sel:[0,0] op_sel_hi:[1,0]
    v_mfma_f32_16x16x32_bf16 v[210:213], a[100:103], v[154:157], v[210:213]
    v_pk_mul_f16 v194, v194, v172 op_sel:[0,0] op_sel_hi:[1,0]
    v_pk_mul_f16 v195, v195, v172 op_sel:[0,0] op_sel_hi:[1,0]
    v_mfma_f32_16x16x32_bf16 v[210:213], a[104:107], v[130:133], v[210:213]
    v_min3_u32 v44, v44, v170, v171
    v_max3_u32 v45, v45, v170, v171
    v_mfma_f32_16x16x32_bf16 v[210:213], a[108:111], v[122:125], v[210:213]
    v_cvt_pk_f16_f32 v170, v162, v163
    v_pk_mul_f16 v163, v170, v170
    v_mfma_f32_16x16x32_bf16 v[210:213], a[112:115], v[126:129], v[210:213]
    v_cvt_pk_f16_f32 v171, v164, v165
    v_pk_mul_f16 v165, v171, v171
    v_mfma_f32_16x16x32_bf16 v[210:213], a[116:119], v[166:169], v[210:213]
    v_rsq_f32 v255, v255
    v_mfma_f32_16x16x32_bf16 v[214:217], a[120:123], v[134:137], 0
    v_rsq_f32 v254, v254
    v_mfma_f32_16x16x32_bf16 v[214:217], a[124:127], v[154:157], v[214:217]
    v_mul_f32 v142, v254, v142
    v_mul_f32 v143, v254, v143
    v_mfma_f32_16x16x32_bf16 v[214:217], a[128:131], v[130:133], v[214:217]
    v_cvt_pk_bf16_f32 v142, v142, v143
    v_cvt_pk_f16_f32 v172, v210, v211
    v_mfma_f32_16x16x32_bf16 v[214:217], a[132:135], v[122:125], v[214:217]
    v_pk_fma_f16 v163, v172, v172, v163
    v_cvt_pk_f16_f32 v173, v212, v213
    v_mfma_f32_16x16x32_bf16 v[214:217], a[136:139], v[126:129], v[214:217]
    v_pk_fma_f16 v165, v173, v173, v165
    v_mul_f32 v144, v254, v144
    v_mfma_f32_16x16x32_bf16 v[214:217], a[140:143], v[166:169], v[214:217]
    v_mul_f32 v145, v254, v145
    v_cvt_pk_bf16_f32 v143, v144, v145
    v_mfma_f32_16x16x32_bf16 v[210:213], a[0:3], v[134:137], 0
    v_mul_f32 v158, v254, v158
    v_mul_f32 v159, v254, v159
    v_mfma_f32_16x16x32_bf16 v[210:213], a[4:7], v[154:157], v[210:213]
    v_cvt_pk_bf16_f32 v144, v158, v159
    v_mul_f32 v160, v254, v160
    v_mfma_f32_16x16x32_bf16 v[210:213], a[8:11], v[130:133], v[210:213]
    v_cvt_pk_f16_f32 v220, v214, v215
    v_pk_fma_f16 v163, v220, v220, v163
    v_mfma_f32_16x16x32_bf16 v[210:213], a[12:15], v[122:125], v[210:213]
    v_cvt_pk_f16_f32 v221, v216, v217
    v_pk_fma_f16 v165, v221, v221, v165
    v_mfma_f32_16x16x32_bf16 v[210:213], a[16:19], v[126:129], v[210:213]
    v_mul_f32 v161, v254, v161
    v_cvt_pk_bf16_f32 v145, v160, v161
    v_mfma_f32_16x16x32_bf16 v[210:213], a[20:23], v[166:169], v[210:213]
    buffer_store_dwordx4 v[142:145], v16, s[12:15], 0 offen nt
    v_mul_f32 v178, v254, v178
    v_mul_f32 v179, v254, v179
    v_cvt_pk_bf16_f32 v198, v178, v179
    v_mul_f32 v180, v254, v180
    v_mfma_f32_16x16x32_bf16 v[142:145], a[24:27], v[134:137], 0
    v_mul_f32 v181, v254, v181
    v_cvt_pk_bf16_f32 v199, v180, v181
    v_mfma_f32_16x16x32_bf16 v[142:145], a[28:31], v[154:157], v[142:145]
    v_cvt_pk_f16_f32 v158, v210, v211
    v_pk_mul_f16 v162, v158, v158
    v_mfma_f32_16x16x32_bf16 v[142:145], a[32:35], v[130:133], v[142:145]
    v_cvt_pk_f16_f32 v159, v212, v213
    v_pk_mul_f16 v164, v159, v159
    v_mfma_f32_16x16x32_bf16 v[142:145], a[36:39], v[122:125], v[142:145]
    v_mul_f32 v254, 0x3baaaaab, v200
    v_mul_f32 v150, v255, v150
    v_mfma_f32_16x16x32_bf16 v[142:145], a[40:43], v[126:129], v[142:145]
    v_rsq_f32 v254, v254
    v_mfma_f32_16x16x32_bf16 v[142:145], a[44:47], v[166:169], v[142:145]
    v_mul_f32 v146, v254, v146
    v_mul_f32 v147, v254, v147
    v_mfma_f32_16x16x32_bf16 v[178:181], a[48:51], v[134:137], 0
    v_cvt_pk_bf16_f32 v146, v146, v147
    v_mul_f32 v148, v254, v148
    v_mfma_f32_16x16x32_bf16 v[178:181], a[52:55], v[154:157], v[178:181]
    v_mul_f32 v149, v254, v149
    v_cvt_pk_bf16_f32 v147, v148, v149
    v_mfma_f32_16x16x32_bf16 v[178:181], a[56:59], v[130:133], v[178:181]
    v_mul_f32 v138, v254, v138
    v_mul_f32 v139, v254, v139
    v_mfma_f32_16x16x32_bf16 v[178:181], a[60:63], v[122:125], v[178:181]
    v_cvt_pk_bf16_f32 v148, v138, v139
    v_mul_f32 v140, v254, v140
    v_mfma_f32_16x16x32_bf16 v[178:181], a[64:67], v[126:129], v[178:181]
    v_mul_f32 v141, v254, v141
    v_cvt_pk_bf16_f32 v149, v140, v141
    v_mfma_f32_16x16x32_bf16 v[178:181], a[68:71], v[166:169], v[178:181]
    v_mul_f32 v186, v254, v186
    v_mul_f32 v187, v254, v187
    v_mfma_f32_16x16x32_bf16 v[138:141], v[134:137], a[144:147], 0
    v_cvt_pk_bf16_f32 v200, v186, v187
    v_mul_f32 v188, v254, v188
    v_mfma_f32_16x16x32_bf16 v[138:141], v[154:157], a[148:151], v[138:141]
    v_mul_f32 v189, v254, v189
    v_cvt_pk_bf16_f32 v201, v188, v189
    v_mfma_f32_16x16x32_bf16 v[138:141], v[130:133], a[152:155], v[138:141]
    v_cvt_pk_f16_f32 v160, v142, v143
    v_pk_fma_f16 v162, v160, v160, v162
    v_mfma_f32_16x16x32_bf16 v[138:141], v[122:125], a[156:159], v[138:141]
    v_cvt_pk_f16_f32 v161, v144, v145
    v_pk_fma_f16 v164, v161, v161, v164
    v_mfma_f32_16x16x32_bf16 v[138:141], v[126:129], a[160:163], v[138:141]
    buffer_store_dwordx4 v[146:149], v17, s[12:15], 0 offen nt
    v_cvt_pk_f16_f32 v218, v178, v179
    v_pk_fma_f16 v162, v218, v218, v162
    v_cvt_pk_f16_f32 v219, v180, v181
    v_pk_fma_f16 v164, v219, v219, v164
    v_mfma_f32_16x16x32_bf16 v[138:141], v[166:169], a[164:167], v[138:141]
    v_mul_f32 v151, v255, v151
    v_cvt_pk_bf16_f32 v150, v150, v151
    v_mfma_f32_16x16x32_f16 v[142:145], v[40:43], v[162:165], 0
    v_mul_f32 v152, v255, v152
    v_mul_f32 v153, v255, v153
    v_mfma_f32_16x16x32_bf16 v[178:181], v[134:137], a[168:171], 0
    v_cvt_pk_bf16_f32 v151, v152, v153
    v_mul_f32 v190, v255, v190
    v_mfma_f32_16x16x32_bf16 v[178:181], v[154:157], a[172:175], v[178:181]
    v_cvt_pk_bf16_f32 v176, v138, v139
    v_cvt_pk_bf16_f32 v177, v140, v141
    v_mfma_f32_16x16x32_bf16 v[178:181], v[130:133], a[176:179], v[178:181]
    ds_read_b128 v[146:149], v0 offset:32768
    v_min3_u32 v44, v44, v142, v143
    v_mfma_f32_16x16x32_bf16 v[178:181], v[122:125], a[180:183], v[178:181]
    ds_read_b128 v[138:141], v1 offset:32768
    v_max3_u32 v45, v45, v142, v143
    v_mfma_f32_16x16x32_bf16 v[178:181], v[126:129], a[184:187], v[178:181]
    ds_read_b128 v[186:189], v0 offset:32896
    v_mul_f32 v191, v255, v191
    v_mfma_f32_16x16x32_bf16 v[178:181], v[166:169], a[188:191], v[178:181]
    ds_read_b128 v[162:165], v1 offset:32896
    v_cvt_pk_bf16_f32 v152, v190, v191
    v_mfma_f32_16x16x32_bf16 v[210:213], v[134:137], a[192:195], 0
    ds_read_b128 v[134:137], v0 offset:33024
    v_mul_f32 v192, v255, v192
    v_mfma_f32_16x16x32_bf16 v[210:213], v[154:157], a[196:199], v[210:213]
    ds_read_b128 v[154:157], v1 offset:33024
    v_mul_f32 v193, v255, v193
    v_mfma_f32_16x16x32_bf16 v[210:213], v[130:133], a[200:203], v[210:213]
    v_rsq_f32 v144, v142
    v_mfma_f32_16x16x32_bf16 v[210:213], v[122:125], a[204:207], v[210:213]
    v_rsq_f32 v145, v143
    v_mfma_f32_16x16x32_bf16 v[210:213], v[126:129], a[208:211], v[210:213]
    s_waitcnt lgkmcnt(5)
    v_mul_f32 v144, s31, v144
    v_cvt_pk_f16_f32 v144, v144, v145
    v_mfma_f32_16x16x32_bf16 v[210:213], v[166:169], a[212:215], v[210:213]
    s_waitcnt lgkmcnt(4)
    v_cvt_pk_bf16_f32 v184, v178, v179
    v_cvt_pk_bf16_f32 v185, v180, v181
    v_mfma_f32_16x16x32_bf16 v[178:181], a[72:75], v[146:149], 0
    s_waitcnt lgkmcnt(3)
    v_pk_mul_f16 v170, v170, v144 op_sel:[0,1] op_sel_hi:[1,1]
    v_pk_mul_f16 v171, v171, v144 op_sel:[0,1] op_sel_hi:[1,1]
    v_mfma_f32_16x16x32_bf16 v[178:181], a[76:79], v[138:141], v[178:181]
    s_waitcnt lgkmcnt(2)
    v_cvt_pk_bf16_f32 v116, v210, v211
    v_cvt_pk_bf16_f32 v117, v212, v213
    v_mfma_f32_16x16x32_bf16 v[178:181], a[80:83], v[186:189], v[178:181]
    s_waitcnt lgkmcnt(1)
    buffer_store_dwordx2 v[200:201], v20, s[12:15], 0 offen nt
    v_pk_mul_f16 v172, v172, v144 op_sel:[0,1] op_sel_hi:[1,1]
    v_pk_mul_f16 v173, v173, v144 op_sel:[0,1] op_sel_hi:[1,1]
    v_mfma_f32_16x16x32_bf16 v[178:181], a[84:87], v[162:165], v[178:181]
    s_waitcnt lgkmcnt(0)
    v_pk_mul_f16 v220, v220, v144 op_sel:[0,1] op_sel_hi:[1,1]
    v_pk_mul_f16 v221, v221, v144 op_sel:[0,1] op_sel_hi:[1,1]
    v_mfma_f32_16x16x32_bf16 v[178:181], a[88:91], v[134:137], v[178:181]
    v_pk_mul_f16 v158, v158, v144 op_sel:[0,0] op_sel_hi:[1,0]
    v_pk_mul_f16 v159, v159, v144 op_sel:[0,0] op_sel_hi:[1,0]
    v_mfma_f32_16x16x32_bf16 v[178:181], a[92:95], v[154:157], v[178:181]
    v_pk_mul_f16 v160, v160, v144 op_sel:[0,0] op_sel_hi:[1,0]
    v_pk_mul_f16 v161, v161, v144 op_sel:[0,0] op_sel_hi:[1,0]
    v_mfma_f32_16x16x32_bf16 v[130:133], a[96:99], v[146:149], 0
    v_pk_mul_f16 v218, v218, v144 op_sel:[0,0] op_sel_hi:[1,0]
    v_pk_mul_f16 v219, v219, v144 op_sel:[0,0] op_sel_hi:[1,0]
    v_mfma_f32_16x16x32_bf16 v[130:133], a[100:103], v[138:141], v[130:133]
    s_waitcnt vmcnt(3)
    v_cvt_pk_bf16_f32 v153, v192, v193
    v_cvt_pk_f16_f32 v142, v178, v179
    v_mfma_f32_16x16x32_bf16 v[130:133], a[104:107], v[186:189], v[130:133]
    s_nop 0
    v_pk_mul_f16 v191, v142, v142
    v_cvt_pk_f16_f32 v143, v180, v181
    v_mfma_f32_16x16x32_bf16 v[130:133], a[108:111], v[162:165], v[130:133]
    s_barrier
    v_pk_mul_f16 v193, v143, v143
    v_mul_f32 v202, v255, v202
    v_mfma_f32_16x16x32_bf16 v[130:133], a[112:115], v[134:137], v[130:133]
    s_nop 0
    v_mul_f32 v203, v255, v203
    v_cvt_pk_bf16_f32 v254, v202, v203
    v_mfma_f32_16x16x32_bf16 v[130:133], a[116:119], v[154:157], v[130:133]
    s_nop 0
    v_mul_f32 v204, v255, v204
    v_mul_f32 v205, v255, v205
    v_mfma_f32_16x16x32_bf16 v[178:181], a[120:123], v[146:149], 0
    v_cvt_pk_bf16_f32 v255, v204, v205
    v_xor_b32 v0, 65536, v0
    v_mfma_f32_16x16x32_bf16 v[178:181], a[124:127], v[138:141], v[178:181]
    v_xor_b32 v1, 65536, v1
    v_cvt_pk_f16_f32 v144, v130, v131
    v_mfma_f32_16x16x32_bf16 v[178:181], a[128:131], v[186:189], v[178:181]
    v_pk_fma_f16 v191, v144, v144, v191
    v_cvt_pk_f16_f32 v145, v132, v133
    v_mfma_f32_16x16x32_bf16 v[178:181], a[132:135], v[162:165], v[178:181]
    v_pk_fma_f16 v193, v145, v145, v193
    v_mfma_f32_16x16x32_bf16 v[178:181], a[136:139], v[134:137], v[178:181]
    v_mfma_f32_16x16x32_bf16 v[178:181], a[140:143], v[154:157], v[178:181]
    v_mfma_f32_16x16x32_bf16 v[202:205], a[0:3], v[146:149], 0
    v_mfma_f32_16x16x32_bf16 v[202:205], a[4:7], v[138:141], v[202:205]
    buffer_load_dwordx4 v10, s[8:11], 0 offen nt lds
    s_add_u32 m0, s28, 4096
    v_mfma_f32_16x16x32_bf16 v[202:205], a[8:11], v[186:189], v[202:205]
    v_mfma_f32_16x16x32_bf16 v[202:205], a[12:15], v[162:165], v[202:205]
    v_mfma_f32_16x16x32_bf16 v[202:205], a[16:19], v[134:137], v[202:205]
    v_mfma_f32_16x16x32_bf16 v[202:205], a[20:23], v[154:157], v[202:205]
    v_cvt_pk_f16_f32 v124, v178, v179
    v_pk_fma_f16 v191, v124, v124, v191
    v_mfma_f32_16x16x32_bf16 v[130:133], a[24:27], v[146:149], 0
    buffer_load_dwordx4 v11, s[8:11], 0 offen nt lds
    v_cvt_pk_f16_f32 v125, v180, v181
    v_mfma_f32_16x16x32_bf16 v[130:133], a[28:31], v[138:141], v[130:133]
    s_add_u32 m0, s28, 8192
    v_pk_fma_f16 v193, v125, v125, v193
    v_cvt_pk_f16_f32 v178, v202, v203
    v_mfma_f32_16x16x32_bf16 v[130:133], a[32:35], v[186:189], v[130:133]
    v_pk_mul_f16 v190, v178, v178
    v_cvt_pk_f16_f32 v179, v204, v205
    v_mfma_f32_16x16x32_bf16 v[130:133], a[36:39], v[162:165], v[130:133]
    v_pk_mul_f16 v192, v179, v179
    v_mfma_f32_16x16x32_bf16 v[130:133], a[40:43], v[134:137], v[130:133]
    v_mfma_f32_16x16x32_bf16 v[130:133], a[44:47], v[154:157], v[130:133]
    buffer_load_dwordx4 v12, s[8:11], 0 offen nt lds
    s_add_u32 m0, s28, 12288
    v_mfma_f32_16x16x32_bf16 v[202:205], a[48:51], v[146:149], 0
    s_xor_b32 s28, s28, 65536
    v_mfma_f32_16x16x32_bf16 v[202:205], a[52:55], v[138:141], v[202:205]
    ds_read_b128 v[166:169], v5 offset:0
    ds_read_b128 v[126:129], v5 offset:16
    v_mfma_f32_16x16x32_bf16 v[202:205], a[56:59], v[186:189], v[202:205]
    ds_read_b128 v[210:213], v5 offset:48
    ds_read_b32 v200, v6 offset:192
    v_mfma_f32_16x16x32_bf16 v[202:205], a[60:63], v[162:165], v[202:205]
    v_cvt_pk_f16_f32 v180, v130, v131
    v_pk_fma_f16 v190, v180, v180, v190
    v_mfma_f32_16x16x32_bf16 v[202:205], a[64:67], v[134:137], v[202:205]
    buffer_load_dwordx4 v13, s[8:11], 0 offen nt lds
    v_cvt_pk_f16_f32 v181, v132, v133
    v_mfma_f32_16x16x32_bf16 v[202:205], a[68:71], v[154:157], v[202:205]
    s_mov_b32 m0, s29
    v_pk_fma_f16 v192, v181, v181, v192
    v_add_u32 v5, 336, v5
    v_mfma_f32_16x16x32_bf16 v[130:133], v[146:149], a[144:147], 0
    s_xor_b32 s29, s29, s30
    s_add_u32 s19, s19, s20
    s_add_u32 s23, s23, s21
    v_mfma_f32_16x16x32_bf16 v[130:133], v[138:141], a[148:151], v[130:133]
    s_cmp_ge_u32 s19, 72
    v_cvt_pk_f16_f32 v122, v202, v203
    v_pk_fma_f16 v190, v122, v122, v190
    v_mfma_f32_16x16x32_bf16 v[130:133], v[186:189], a[152:155], v[130:133]
    s_cselect_b32 s34, 72, 0
    v_cvt_pk_f16_f32 v123, v204, v205
    v_pk_fma_f16 v192, v123, v123, v192
    v_mfma_f32_16x16x32_bf16 v[130:133], v[162:165], a[156:159], v[130:133]
    s_waitcnt lgkmcnt(2)
    buffer_store_dwordx2 v[198:199], v19, s[12:15], 0 offen nt
    s_cselect_b32 s35, s22, 0
    s_sub_u32 s19, s19, s34
    v_mfma_f32_16x16x32_f16 v[202:205], v[40:43], v[190:193], 0
    s_add_u32 s23, s23, s35
    s_add_u32 s18, s18, 1
    s_cmp_lt_u32 s18, s17
    v_mfma_f32_16x16x32_f16 v[214:217], v[166:169], v[158:161], v[24:27]
    s_waitcnt lgkmcnt(0)
    v_mfma_f32_16x16x32_f16 v[214:217], v[126:129], v[170:173], v[214:217]
    v_mfma_f32_16x16x32_f16 v[214:217], v[210:213], v[218:221], v[214:217]
    v_mfma_f32_16x16x32_f16 v[190:193], v[166:169], v[206:209], v[22:25]
    v_rsq_f32 v204, v202
    v_mfma_f32_16x16x32_f16 v[190:193], v[126:129], v[118:121], v[190:193]
    v_rsq_f32 v205, v203
    v_mfma_f32_16x16x32_f16 v[190:193], v[210:213], v[194:197], v[190:193]
    v_mul_f32 v204, s31, v204
    v_cvt_pk_f16_f32 v204, v204, v205
    v_mfma_f32_16x16x32_bf16 v[130:133], v[134:137], a[160:163], v[130:133]
    v_pk_mul_f16 v142, v142, v204 op_sel:[0,1] op_sel_hi:[1,1]
    v_pk_mul_f16 v143, v143, v204 op_sel:[0,1] op_sel_hi:[1,1]
    v_mfma_f32_16x16x32_bf16 v[130:133], v[154:157], a[164:167], v[130:133]
    v_pk_mul_f16 v144, v144, v204 op_sel:[0,1] op_sel_hi:[1,1]
    v_pk_mul_f16 v145, v145, v204 op_sel:[0,1] op_sel_hi:[1,1]
    v_mfma_f32_16x16x32_bf16 v[222:225], v[146:149], a[168:171], 0
    v_mov_b32_dpp v200, v191 quad_perm:[0,1,2,3] row_mask:0x1 bank_mask:0xf
    v_mov_b32_dpp v200, v215 quad_perm:[0,1,2,3] row_mask:0x2 bank_mask:0xf
    v_mfma_f32_16x16x32_bf16 v[222:225], v[138:141], a[172:175], v[222:225]
    v_pk_mul_f16 v124, v124, v204 op_sel:[0,1] op_sel_hi:[1,1]
    v_pk_mul_f16 v125, v125, v204 op_sel:[0,1] op_sel_hi:[1,1]
    v_mfma_f32_16x16x32_bf16 v[222:225], v[186:189], a[176:179], v[222:225]
    v_cvt_pk_bf16_f32 v130, v130, v131
    v_cvt_pk_bf16_f32 v131, v132, v133
    v_mfma_f32_16x16x32_bf16 v[222:225], v[162:165], a[180:183], v[222:225]
    v_pk_mul_f16 v178, v178, v204 op_sel:[0,0] op_sel_hi:[1,0]
    v_pk_mul_f16 v179, v179, v204 op_sel:[0,0] op_sel_hi:[1,0]
    v_mfma_f32_16x16x32_f16 v[226:229], v[118:121], v[206:209], v[46:49]
    v_pk_mul_f16 v180, v180, v204 op_sel:[0,0] op_sel_hi:[1,0]
    v_pk_mul_f16 v181, v181, v204 op_sel:[0,0] op_sel_hi:[1,0]
    v_mfma_f32_16x16x32_f16 v[230:233], v[170:173], v[206:209], v[50:53]
    v_pk_mul_f16 v122, v122, v204 op_sel:[0,0] op_sel_hi:[1,0]
    v_pk_mul_f16 v123, v123, v204 op_sel:[0,0] op_sel_hi:[1,0]
    v_mfma_f32_16x16x32_f16 v[234:237], v[142:145], v[206:209], v[54:57]
    v_min3_u32 v44, v44, v202, v203
    v_exp_f32 v214, v214
    v_mfma_f32_16x16x16_f16 v[226:229], v[196:197], v[194:195], v[226:229]
    v_max3_u32 v45, v45, v202, v203
    v_exp_f32 v190, v190
    v_mfma_f32_16x16x16_f16 v[230:233], v[220:221], v[194:195], v[230:233]
    v_cvt_pk_bf16_f32 v39, v190, 0
    v_mfma_f32_16x16x16_f16 v[234:237], v[124:125], v[194:195], v[234:237]
    buffer_store_dwordx4 v[150:153], v15, s[12:15], 0 offen nt
    v_mfma_f32_16x16x32_bf16 v[222:225], v[134:137], a[184:187], v[222:225]
    v_mfma_f32_16x16x32_bf16 v[222:225], v[154:157], a[188:191], v[222:225]
    ds_read_b128 v[206:209], v2 offset:0
    v_mfma_f32_16x16x32_bf16 v[150:153], v[146:149], a[192:195], 0
    ds_read_b128 v[146:149], v2 offset:1024
    v_mfma_f32_16x16x32_bf16 v[150:153], v[138:141], a[196:199], v[150:153]
    ds_read_b128 v[138:141], v2 offset:2048
    v_mfma_f32_16x16x32_bf16 v[150:153], v[186:189], a[200:203], v[150:153]
    ds_read_b128 v[186:189], v2 offset:3072
    v_mfma_f32_16x16x32_bf16 v[150:153], v[162:165], a[204:207], v[150:153]
    ds_read_b128 v[162:165], v2 offset:4096
    v_cvt_pk_bf16_f32 v222, v222, v223
    v_mfma_f32_16x16x32_bf16 v[150:153], v[134:137], a[208:211], v[150:153]
    ds_read_b128 v[134:137], v2 offset:5120
    v_cvt_pk_bf16_f32 v223, v224, v225
    v_mfma_f32_16x16x32_bf16 v[150:153], v[154:157], a[212:215], v[150:153]
    ds_read2_b32 v[132:133], v6 offset0:0 offset1:0
    ds_read2_b32 v[224:225], v6 offset0:16 offset1:16
    v_mfma_f32_16x16x32_f16 v[154:157], v[166:169], v[178:181], v[26:29]
    ds_read2_b32 v[168:169], v6 offset0:32 offset1:32
    v_add_u32 v6, 272, v6
    v_mfma_f32_16x16x32_f16 v[154:157], v[126:129], v[142:145], v[154:157]
    s_waitcnt lgkmcnt(8)
    v_exp_f32 v226, v226
    v_mfma_f32_16x16x32_f16 v[154:157], v[210:213], v[122:125], v[154:157]
    s_waitcnt lgkmcnt(7)
    v_cvt_pk_bf16_f32 v166, v150, v151
    v_cvt_pk_bf16_f32 v167, v152, v153
    v_mfma_f32_16x16x32_bf16 v[150:153], a[216:219], v[206:209], 0
    s_waitcnt lgkmcnt(6)
    v_exp_f32 v227, v227
    v_mfma_f32_16x16x32_bf16 v[150:153], a[220:223], v[146:149], v[150:153]
    s_waitcnt lgkmcnt(5)
    v_exp_f32 v154, v154
    v_mfma_f32_16x16x32_bf16 v[150:153], a[224:227], v[138:141], v[150:153]
    s_waitcnt lgkmcnt(4)
    v_mov_b32_dpp v200, v155 quad_perm:[0,1,2,3] row_mask:0x4 bank_mask:0xf
    v_cvt_pk_bf16_f32 v126, v226, v227
    v_mfma_f32_16x16x32_bf16 v[150:153], a[228:231], v[186:189], v[150:153]
    s_waitcnt lgkmcnt(3)
    v_exp_f32 v200, v200
    v_mfma_f32_16x16x32_bf16 v[150:153], a[232:235], v[162:165], v[150:153]
    s_waitcnt lgkmcnt(1)
    v_exp_f32 v228, v228
    v_mfma_f32_16x16x32_bf16 v[150:153], a[236:239], v[134:137], v[150:153]
    s_waitcnt lgkmcnt(0)
    buffer_store_dwordx2 v[254:255], v18, s[12:15], 0 offen nt
    v_exp_f32 v229, v229
    v_mfma_f32_16x16x32_bf16 v[190:193], a[240:243], v[206:209], 0
    v_cvt_pk_bf16_f32 v200, v200, v200
    v_cvt_pk_bf16_f32 v127, v228, v229
    v_mfma_f32_16x16x32_bf16 v[190:193], a[244:247], v[146:149], v[190:193]
    ds_write_b16 v8, v200
    v_mfma_f32_16x16x32_bf16 v[190:193], a[248:251], v[138:141], v[190:193]
    v_exp_f32 v230, v230
    v_mfma_f32_16x16x32_bf16 v[190:193], a[252:255], v[186:189], v[190:193]
    ds_read_b128 v[198:201], v2 offset:6144
    ds_read_b128 v[210:213], v9
    v_mfma_f32_16x16x32_bf16 v[190:193], v[82:85], v[162:165], v[190:193]
    ds_read_b128 v[226:229], v2 offset:7168
    ds_read_b128 v[238:241], v9 offset:64
    v_mfma_f32_16x16x32_bf16 v[190:193], v[86:89], v[134:137], v[190:193]
    v_exp_f32 v231, v231
    v_mfma_f32_16x16x32_bf16 v[202:205], v[90:93], v[206:209], 0
    ds_read_b128 v[206:209], v2 offset:8192
    ds_read_b128 v[242:245], v2 offset:9216
    v_mfma_f32_16x16x32_bf16 v[202:205], v[94:97], v[146:149], v[202:205]
    v_cvt_pk_bf16_f32 v128, v230, v231
    v_fma_f32 v254, v150, v150, s33
    v_mfma_f32_16x16x32_bf16 v[202:205], v[98:101], v[138:141], v[202:205]
    ds_read_b128 v[146:149], v2 offset:10240
    ds_read_b128 v[138:141], v2 offset:11264
    v_mfma_f32_16x16x32_bf16 v[202:205], v[102:105], v[186:189], v[202:205]
    v_exp_f32 v232, v232
    v_mfma_f32_16x16x32_bf16 v[202:205], v[106:109], v[162:165], v[202:205]
    v_exp_f32 v233, v233
    v_mfma_f32_16x16x32_bf16 v[202:205], v[110:113], v[134:137], v[202:205]
    s_waitcnt lgkmcnt(6)
    v_cvt_pk_bf16_f32 v129, v232, v233
    v_fmac_f32 v254, v151, v151
    v_mfma_f32_16x16x32_bf16 v[186:189], v[210:213], v[28:31], 0
    s_waitcnt lgkmcnt(4)
    v_exp_f32 v234, v234
    v_mfma_f32_16x16x32_bf16 v[186:189], v[238:241], v[28:31], v[186:189]
    v_exp_f32 v235, v235
    v_mfma_f32_16x16x32_f16 v[134:137], v[118:121], v[158:161], v[58:61]
    s_waitcnt lgkmcnt(2)
    v_cvt_pk_bf16_f32 v36, v234, v235
    v_fmac_f32 v254, v152, v152
    v_mfma_f32_16x16x32_f16 v[162:165], v[170:173], v[158:161], v[62:65]
    v_exp_f32 v236, v236
    v_mfma_f32_16x16x32_f16 v[230:233], v[142:145], v[158:161], v[66:69]
    s_waitcnt lgkmcnt(0)
    buffer_load_dwordx4 v14, s[8:11], 0 offen nt lds
    v_rcp_f32 v186, v186
    v_mfma_f32_16x16x16_f16 v[134:137], v[196:197], v[218:219], v[134:137]
    v_exp_f32 v237, v237
    v_fmac_f32 v254, v153, v153
    v_mfma_f32_16x16x16_f16 v[162:165], v[220:221], v[218:219], v[162:165]
    v_cvt_pk_bf16_f32 v37, v236, v237
    v_fmac_f32 v254, v190, v190
    v_fmac_f32 v254, v191, v191
    v_mfma_f32_16x16x16_f16 v[230:233], v[124:125], v[218:219], v[230:233]
    v_fmac_f32 v254, v192, v192
    v_exp_f32 v134, v134
    v_fmac_f32 v254, v193, v193
    v_mfma_f32_16x16x32_bf16 v[158:161], v[210:213], v[174:177], 0
    v_exp_f32 v135, v135
    v_mfma_f32_16x16x32_bf16 v[158:161], v[238:241], v[130:133], v[158:161]
    v_cvt_pk_bf16_f32 v134, v134, v135
    v_fmac_f32 v254, v202, v202
    v_mfma_f32_16x16x32_bf16 v[234:237], v[210:213], v[182:185], 0
    v_exp_f32 v136, v136
    v_mfma_f32_16x16x32_bf16 v[234:237], v[238:241], v[222:225], v[234:237]
    v_exp_f32 v137, v137
    v_mfma_f32_16x16x32_bf16 v[246:249], v[210:213], v[114:117], 0
    v_cvt_pk_bf16_f32 v135, v136, v137
    v_mul_f32 v158, v158, v186
    v_mfma_f32_16x16x32_bf16 v[246:249], v[238:241], v[166:169], v[246:249]
    v_exp_f32 v162, v162
    v_mfma_f32_16x16x32_bf16 v[210:213], v[28:31], v[36:39], 0
    v_exp_f32 v163, v163
    v_mfma_f32_16x16x32_bf16 v[210:213], v[28:31], v[126:129], v[210:213]
    v_cvt_pk_bf16_f32 v136, v162, v163
    v_mul_f32_dpp v158, v234, v186 quad_perm:[0,1,2,3] row_mask:0x2 bank_mask:0xf
    v_mfma_f32_16x16x32_bf16 v[234:237], v[130:133], v[36:39], 0
    v_exp_f32 v164, v164
    v_mfma_f32_16x16x32_bf16 v[234:237], v[174:177], v[126:129], v[234:237]
    v_exp_f32 v165, v165
    v_mfma_f32_16x16x32_bf16 v[238:241], v[222:225], v[36:39], 0
    v_cvt_pk_bf16_f32 v137, v164, v165
    v_mul_f32_dpp v158, v246, v186 quad_perm:[0,1,2,3] row_mask:0x4 bank_mask:0xf
    v_mfma_f32_16x16x32_bf16 v[238:241], v[182:185], v[126:129], v[238:241]
    v_exp_f32 v230, v230
    v_mfma_f32_16x16x32_bf16 v[186:189], v[166:169], v[36:39], 0
    v_exp_f32 v231, v231
    v_mfma_f32_16x16x32_bf16 v[186:189], v[114:117], v[126:129], v[186:189]
    v_cvt_pk_bf16_f32 v36, v230, v231
    v_cvt_pk_bf16_f32 v39, v214, 0
    v_mfma_f32_16x16x32_f16 v[162:165], v[118:121], v[178:181], v[70:73]
    v_exp_f32 v232, v232
    v_mfma_f32_16x16x32_f16 v[118:121], v[170:173], v[178:181], v[74:77]
    v_exp_f32 v233, v233
    v_mfma_f32_16x16x32_f16 v[170:173], v[142:145], v[178:181], v[78:81]
    v_cvt_pk_bf16_f32 v37, v232, v233
    v_cvt_pk_bf16_f32 v158, v158, v158
    v_fmac_f32 v254, v203, v203
    v_mfma_f32_16x16x16_f16 v[162:165], v[196:197], v[122:123], v[162:165]
    v_rcp_f32 v210, v210
    v_fmac_f32 v254, v204, v204
    v_mfma_f32_16x16x16_f16 v[118:121], v[220:221], v[122:123], v[118:121]
    v_mul_f32 v234, v210, v234
    v_mul_f32 v235, v210, v235
    v_cvt_pk_bf16_f32 v178, v234, v235
    v_mfma_f32_16x16x16_f16 v[170:173], v[124:125], v[122:123], v[170:173]
    v_mul_f32 v236, v210, v236
    v_exp_f32 v162, v162
    v_mul_f32 v237, v210, v237
    v_mfma_f32_16x16x32_bf16 v[194:197], v[28:31], v[36:39], 0
    ds_write_b16 v7, v158
    v_mfma_f32_16x16x32_bf16 v[194:197], v[28:31], v[134:137], v[194:197]
    v_exp_f32 v163, v163
    v_mfma_f32_16x16x32_bf16 v[122:125], v[130:133], v[36:39], 0
    v_cvt_pk_bf16_f32 v162, v162, v163
    v_cvt_pk_bf16_f32 v179, v236, v237
    v_mfma_f32_16x16x32_bf16 v[122:125], v[174:177], v[134:137], v[122:125]
    v_exp_f32 v164, v164
    v_mfma_f32_16x16x32_bf16 v[126:129], v[222:225], v[36:39], 0
    v_exp_f32 v165, v165
    v_mfma_f32_16x16x32_bf16 v[126:129], v[182:185], v[134:137], v[126:129]
    v_cvt_pk_bf16_f32 v163, v164, v165
    v_mul_f32 v238, v210, v238
    v_mfma_f32_16x16x32_bf16 v[218:221], v[166:169], v[36:39], 0
    v_exp_f32 v118, v118
    v_mfma_f32_16x16x32_bf16 v[218:221], v[114:117], v[134:137], v[218:221]
    v_exp_f32 v119, v119
    v_mfma_f32_16x16x32_bf16 v[142:145], a[216:219], v[198:201], 0
    v_cvt_pk_bf16_f32 v164, v118, v119
    v_cvt_pk_bf16_f32 v39, v154, 0
    v_mfma_f32_16x16x32_bf16 v[142:145], a[220:223], v[226:229], v[142:145]
    v_exp_f32 v120, v120
    v_mfma_f32_16x16x32_bf16 v[142:145], a[224:227], v[206:209], v[142:145]
    v_exp_f32 v121, v121
    v_mfma_f32_16x16x32_bf16 v[142:145], a[228:231], v[242:245], v[142:145]
    v_cvt_pk_bf16_f32 v165, v120, v121
    v_mul_f32 v239, v210, v239
    v_mfma_f32_16x16x32_bf16 v[142:145], a[232:235], v[146:149], v[142:145]
    v_exp_f32 v170, v170
    v_mfma_f32_16x16x32_bf16 v[142:145], a[236:239], v[138:141], v[142:145]
    v_exp_f32 v171, v171
    v_mfma_f32_16x16x32_bf16 v[158:161], a[240:243], v[198:201], 0
    v_cvt_pk_bf16_f32 v36, v170, v171
    v_cvt_pk_bf16_f32 v180, v238, v239
    v_mfma_f32_16x16x32_bf16 v[158:161], a[244:247], v[226:229], v[158:161]
    v_exp_f32 v172, v172
    v_mfma_f32_16x16x32_bf16 v[158:161], a[248:251], v[206:209], v[158:161]
    v_exp_f32 v173, v173
    v_mfma_f32_16x16x32_bf16 v[158:161], a[252:255], v[242:245], v[158:161]
    ds_read_b128 v[118:121], v2 offset:12288
    v_cvt_pk_bf16_f32 v37, v172, v173
    v_mfma_f32_16x16x32_bf16 v[158:161], v[82:85], v[146:149], v[158:161]
    ds_read_b128 v[134:137], v2 offset:13312
    v_mul_f32 v240, v210, v240
    v_mfma_f32_16x16x32_bf16 v[170:173], v[28:31], v[36:39], 0
    v_mul_f32 v241, v210, v241
    v_cvt_pk_bf16_f32 v181, v240, v241
    v_mfma_f32_16x16x32_bf16 v[170:173], v[28:31], v[162:165], v[170:173]
    ds_write_b128 v3, v[178:181] offset:0
    v_mfma_f32_16x16x32_bf16 v[154:157], v[130:133], v[36:39], 0
    v_mul_f32 v186, v210, v186
    v_mul_f32 v187, v210, v187
    v_mfma_f32_16x16x32_bf16 v[154:157], v[174:177], v[162:165], v[154:157]
    v_cvt_pk_bf16_f32 v186, v186, v187
    v_mul_f32 v188, v210, v188
    v_mfma_f32_16x16x32_bf16 v[130:133], v[222:225], v[36:39], 0
    v_mul_f32 v189, v210, v189
    v_cvt_pk_bf16_f32 v187, v188, v189
    v_mfma_f32_16x16x32_bf16 v[130:133], v[182:185], v[162:165], v[130:133]
    s_waitcnt lgkmcnt(2)
    ds_write_b64 v4, v[186:187] offset:4096
    v_mfma_f32_16x16x32_bf16 v[174:177], v[166:169], v[36:39], 0
    s_waitcnt lgkmcnt(2)
    v_fma_f32 v255, v142, v142, s33
    v_fmac_f32 v255, v143, v143
    v_mfma_f32_16x16x32_bf16 v[174:177], v[114:117], v[162:165], v[174:177]
    v_fmac_f32 v255, v144, v144
    v_fmac_f32 v255, v145, v145
    v_mfma_f32_16x16x32_bf16 v[158:161], v[86:89], v[138:141], v[158:161]
    ds_read_b128 v[114:117], v2 offset:14336
    v_fmac_f32 v254, v205, v205
    v_mfma_f32_16x16x32_bf16 v[178:181], v[90:93], v[198:201], 0
    ds_read_b128 v[166:169], v2 offset:15360
    v_add_u32 v7, 16, v7
    v_mfma_f32_16x16x32_bf16 v[178:181], v[94:97], v[226:229], v[178:181]
    ds_read_b128 v[162:165], v2 offset:16384
    v_mfma_f32_16x16x32_bf16 v[178:181], v[98:101], v[206:209], v[178:181]
    ds_read_b128 v[206:209], v2 offset:17408
    v_fmac_f32 v255, v158, v158
    v_mfma_f32_16x16x32_bf16 v[178:181], v[102:105], v[242:245], v[178:181]
    v_fmac_f32 v255, v159, v159
    v_fmac_f32 v255, v160, v160
    v_mfma_f32_16x16x32_bf16 v[178:181], v[106:109], v[146:149], v[178:181]
    v_fmac_f32 v255, v161, v161
    v_xor_b32 v2, 65536, v2
    v_mfma_f32_16x16x32_bf16 v[178:181], v[110:113], v[138:141], v[178:181]
    v_rcp_f32 v170, v170
    v_mfma_f32_16x16x32_bf16 v[146:149], a[216:219], v[118:121], 0
    v_mul_f32 v154, v170, v154
    v_mul_f32 v155, v170, v155
    v_mfma_f32_16x16x32_bf16 v[146:149], a[220:223], v[134:137], v[146:149]
    s_waitcnt lgkmcnt(3)
    ds_read_b128 v[182:185], v0 offset:20480
    v_cvt_pk_bf16_f32 v154, v154, v155
    v_mfma_f32_16x16x32_bf16 v[146:149], a[224:227], v[114:117], v[146:149]
    s_waitcnt lgkmcnt(3)
    ds_read_b128 v[198:201], v1 offset:20480
    v_fmac_f32 v255, v178, v178
    v_mfma_f32_16x16x32_bf16 v[146:149], a[228:231], v[166:169], v[146:149]
    s_waitcnt lgkmcnt(3)
    ds_read_b128 v[210:213], v0 offset:20608
    v_fmac_f32 v255, v179, v179
    v_mfma_f32_16x16x32_bf16 v[146:149], a[232:235], v[162:165], v[146:149]
    s_waitcnt lgkmcnt(3)
    ds_read_b128 v[222:225], v1 offset:20608
    v_fmac_f32 v255, v180, v180
    v_mfma_f32_16x16x32_bf16 v[146:149], a[236:239], v[206:209], v[146:149]
    ds_read_b128 v[226:229], v0 offset:20736
    v_fmac_f32 v255, v181, v181
    v_mfma_f32_16x16x32_bf16 v[138:141], a[240:243], v[118:121], 0
    ds_read_b128 v[242:245], v1 offset:20736
    v_cvt_pk_bf16_f32 v254, v254, v255
    v_mfma_f32_16x16x32_bf16 v[138:141], a[244:247], v[134:137], v[138:141]
    v_mul_f32 v156, v170, v156
    v_mul_f32 v157, v170, v157
    v_mfma_f32_16x16x32_bf16 v[138:141], a[248:251], v[114:117], v[138:141]
    v_fma_f32 v255, v146, v146, s33
    v_fmac_f32 v255, v147, v147
    v_mfma_f32_16x16x32_bf16 v[138:141], a[252:255], v[166:169], v[138:141]
    s_waitcnt lgkmcnt(5)
    v_fmac_f32 v255, v148, v148
    v_fmac_f32 v255, v149, v149
    v_mfma_f32_16x16x32_bf16 v[138:141], v[82:85], v[162:165], v[138:141]
    s_waitcnt lgkmcnt(4)
    v_cvt_pk_bf16_f32 v155, v156, v157
    v_mul_f32 v130, v170, v130
    v_mfma_f32_16x16x32_bf16 v[138:141], v[86:89], v[206:209], v[138:141]
    s_waitcnt lgkmcnt(3)
    v_mul_f32 v131, v170, v131
    v_cvt_pk_bf16_f32 v156, v130, v131
    v_mfma_f32_16x16x32_bf16 v[186:189], v[90:93], v[118:121], 0
    s_waitcnt lgkmcnt(2)
    v_mul_f32 v132, v170, v132
    v_mul_f32 v133, v170, v133
    v_mfma_f32_16x16x32_bf16 v[186:189], v[94:97], v[134:137], v[186:189]
    s_waitcnt lgkmcnt(1)
    v_fmac_f32 v255, v138, v138
    v_fmac_f32 v255, v139, v139
    v_mfma_f32_16x16x32_bf16 v[186:189], v[98:101], v[114:117], v[186:189]
    s_waitcnt lgkmcnt(0)
    v_fmac_f32 v255, v140, v140
    v_fmac_f32 v255, v141, v141
    v_mfma_f32_16x16x32_bf16 v[186:189], v[102:105], v[166:169], v[186:189]
    v_cvt_pk_bf16_f32 v157, v132, v133
    v_mul_f32 v174, v170, v174
    v_mfma_f32_16x16x32_bf16 v[186:189], v[106:109], v[162:165], v[186:189]
    ds_write_b128 v3, v[154:157] offset:12288
    v_mfma_f32_16x16x32_bf16 v[186:189], v[110:113], v[206:209], v[186:189]
    v_mul_f32 v175, v170, v175
    v_cvt_pk_bf16_f32 v174, v174, v175
    v_mfma_f32_16x16x32_bf16 v[118:121], a[72:75], v[182:185], 0
    v_mul_f32 v176, v170, v176
    v_mul_f32 v177, v170, v177
    v_mfma_f32_16x16x32_bf16 v[118:121], a[76:79], v[198:201], v[118:121]
    v_rcp_f32 v194, v194
    v_mfma_f32_16x16x32_bf16 v[118:121], a[80:83], v[210:213], v[118:121]
    v_fmac_f32 v255, v186, v186
    v_fmac_f32 v255, v187, v187
    v_mfma_f32_16x16x32_bf16 v[118:121], a[84:87], v[222:225], v[118:121]
    v_fmac_f32 v255, v188, v188
    v_fmac_f32 v255, v189, v189
    v_mfma_f32_16x16x32_bf16 v[118:121], a[88:91], v[226:229], v[118:121]
    v_cvt_pk_bf16_f32 v255, v255, v255
    v_cvt_pk_bf16_f32 v175, v176, v177
    v_mfma_f32_16x16x32_bf16 v[118:121], a[92:95], v[242:245], v[118:121]
    ds_write_b64 v4, v[174:175] offset:16384
    v_mfma_f32_16x16x32_bf16 v[206:209], a[96:99], v[182:185], 0
    v_mul_f32 v122, v194, v122
    v_mul_f32 v123, v194, v123
    v_mfma_f32_16x16x32_bf16 v[206:209], a[100:103], v[198:201], v[206:209]
    ds_write_b64 v4, v[254:255] offset:18432
    v_mfma_f32_16x16x32_bf16 v[206:209], a[104:107], v[210:213], v[206:209]
    v_cvt_pk_bf16_f32 v134, v122, v123
    v_cvt_pk_f16_f32 v118, v118, v119
    v_mfma_f32_16x16x32_bf16 v[206:209], a[108:111], v[222:225], v[206:209]
    v_pk_mul_f16 v163, v118, v118
    v_cvt_pk_f16_f32 v119, v120, v121
    v_mfma_f32_16x16x32_bf16 v[206:209], a[112:115], v[226:229], v[206:209]
    v_pk_mul_f16 v165, v119, v119
    v_mul_f32 v124, v194, v124
    v_mfma_f32_16x16x32_bf16 v[206:209], a[116:119], v[242:245], v[206:209]
    v_mul_f32 v125, v194, v125
    v_cvt_pk_bf16_f32 v135, v124, v125
    v_mfma_f32_16x16x32_bf16 v[122:125], a[120:123], v[182:185], 0
    v_mul_f32 v126, v194, v126
    v_mul_f32 v127, v194, v127
    v_mfma_f32_16x16x32_bf16 v[122:125], a[124:127], v[198:201], v[122:125]
    v_cvt_pk_bf16_f32 v136, v126, v127
    v_mul_f32 v128, v194, v128
    v_mfma_f32_16x16x32_bf16 v[122:125], a[128:131], v[210:213], v[122:125]
    v_cvt_pk_f16_f32 v120, v206, v207
    v_pk_fma_f16 v163, v120, v120, v163
    v_mfma_f32_16x16x32_bf16 v[122:125], a[132:135], v[222:225], v[122:125]
    v_cvt_pk_f16_f32 v121, v208, v209
    v_pk_fma_f16 v165, v121, v121, v165
    v_mfma_f32_16x16x32_bf16 v[122:125], a[136:139], v[226:229], v[122:125]
    v_mul_f32 v129, v194, v129
    v_cvt_pk_bf16_f32 v137, v128, v129
    v_mfma_f32_16x16x32_bf16 v[122:125], a[140:143], v[242:245], v[122:125]
    ds_write_b128 v3, v[134:137] offset:6144
    v_mfma_f32_16x16x32_bf16 v[206:209], a[0:3], v[182:185], 0
    v_mul_f32 v218, v194, v218
    v_mul_f32 v219, v194, v219
    v_mfma_f32_16x16x32_bf16 v[206:209], a[4:7], v[198:201], v[206:209]
    v_cvt_pk_bf16_f32 v254, v218, v219
    v_mul_f32 v220, v194, v220
    v_mfma_f32_16x16x32_bf16 v[206:209], a[8:11], v[210:213], v[206:209]
    v_cvt_pk_f16_f32 v196, v122, v123
    v_pk_fma_f16 v163, v196, v196, v163
    v_mfma_f32_16x16x32_bf16 v[206:209], a[12:15], v[222:225], v[206:209]
    v_cvt_pk_f16_f32 v197, v124, v125
    v_pk_fma_f16 v165, v197, v197, v165
    v_mfma_f32_16x16x32_bf16 v[206:209], a[16:19], v[226:229], v[206:209]
    v_mul_f32 v221, v194, v221
    v_cvt_pk_bf16_f32 v255, v220, v221
    v_mfma_f32_16x16x32_bf16 v[206:209], a[20:23], v[242:245], v[206:209]
    ds_write_b64 v4, v[254:255] offset:10240
    v_mfma_f32_16x16x32_bf16 v[174:177], a[24:27], v[182:185], 0
    v_xor_b32 v3, 65536, v3
    v_xor_b32 v4, 65536, v4
    v_mfma_f32_16x16x32_bf16 v[174:177], a[28:31], v[198:201], v[174:177]
    v_mfma_f32_16x16x32_bf16 v[174:177], a[32:35], v[210:213], v[174:177]
    v_mfma_f32_16x16x32_bf16 v[174:177], a[36:39], v[222:225], v[174:177]
    v_mfma_f32_16x16x32_bf16 v[174:177], a[40:43], v[226:229], v[174:177]
    v_cvt_pk_f16_f32 v206, v206, v207
    v_mfma_f32_16x16x32_bf16 v[174:177], a[44:47], v[242:245], v[174:177]
    v_mfma_f32_16x16x32_bf16 v[218:221], a[48:51], v[182:185], 0
    s_waitcnt lgkmcnt(0)
    v_mfma_f32_16x16x32_bf16 v[218:221], a[52:55], v[198:201], v[218:221]
    s_nop 0
    v_mfma_f32_16x16x32_bf16 v[218:221], a[56:59], v[210:213], v[218:221]
    s_barrier
    v_mfma_f32_16x16x32_bf16 v[218:221], a[60:63], v[222:225], v[218:221]
    s_nop 0
    v_mfma_f32_16x16x32_bf16 v[218:221], a[64:67], v[226:229], v[218:221]
    s_nop 0
    v_mfma_f32_16x16x32_bf16 v[218:221], a[68:71], v[242:245], v[218:221]
    v_mfma_f32_16x16x32_bf16 v[170:173], v[182:185], a[144:147], 0
    v_mfma_f32_16x16x32_bf16 v[170:173], v[198:201], a[148:151], v[170:173]
    v_mfma_f32_16x16x32_bf16 v[170:173], v[210:213], a[152:155], v[170:173]
    v_mfma_f32_16x16x32_bf16 v[170:173], v[222:225], a[156:159], v[170:173]
    v_mfma_f32_16x16x32_bf16 v[170:173], v[226:229], a[160:163], v[170:173]
    v_mfma_f32_16x16x32_bf16 v[170:173], v[242:245], a[164:167], v[170:173]
    s_cbranch_scc1 L_loop_fast1
    s_branch L_drain
.p2align 6
L_loop_fast2:
    v_mfma_f32_16x16x32_bf16 v[234:237], v[182:185], a[168:171], 0
    s_add_u32 s12, s42, s27
    ds_read_b128 v[230:233], v2 offset:18432
    ds_read_b128 v[238:241], v2 offset:19456
    v_mfma_f32_16x16x32_bf16 v[234:237], v[198:201], a[172:175], v[234:237]
    s_addc_u32 s13, s43, 0
    v_pk_mul_f16 v162, v206, v206
    v_cvt_pk_f16_f32 v207, v208, v209
    v_mfma_f32_16x16x32_bf16 v[234:237], v[210:213], a[176:179], v[234:237]
    s_sub_u32 s14, s36, s27
    ds_read_b128 v[134:137], v0 offset:26624
    v_pk_mul_f16 v164, v207, v207
    v_mfma_f32_16x16x32_bf16 v[234:237], v[222:225], a[180:183], v[234:237]
    s_cmp_ge_u32 s18, 2
    ds_read_b128 v[154:157], v1 offset:26624
    v_cvt_pk_f16_f32 v208, v174, v175
    v_mfma_f32_16x16x32_bf16 v[234:237], v[226:229], a[184:187], v[234:237]
    s_cselect_b32 s14, s14, 0
    ds_read_b128 v[130:133], v0 offset:26752
    v_pk_fma_f16 v162, v208, v208, v162
    v_mfma_f32_16x16x32_bf16 v[234:237], v[242:245], a[188:191], v[234:237]
    s_add_u32 s34, s18, 2
    ds_read_b128 v[122:125], v1 offset:26752
    v_cvt_pk_f16_f32 v209, v176, v177
    v_mfma_f32_16x16x32_bf16 v[114:117], v[182:185], a[192:195], 0
    s_add_u32 s8, s40, s23
    ds_read_b128 v[126:129], v0 offset:26880
    v_pk_fma_f16 v164, v209, v209, v164
    v_mfma_f32_16x16x32_bf16 v[114:117], v[198:201], a[196:199], v[114:117]
    s_addc_u32 s9, s41, 0
    ds_read_b128 v[166:169], v1 offset:26880
    v_cvt_pk_f16_f32 v194, v218, v219
    v_mfma_f32_16x16x32_bf16 v[114:117], v[210:213], a[200:203], v[114:117]
    s_waitcnt lgkmcnt(6)
    v_pk_fma_f16 v162, v194, v194, v162
    v_cvt_pk_f16_f32 v195, v220, v221
    v_mfma_f32_16x16x32_bf16 v[198:201], v[32:35], v[230:233], 0
    s_sub_u32 s10, s36, s23
    v_pk_fma_f16 v164, v195, v195, v164
    v_cvt_pk_bf16_f32 v174, v170, v171
    v_mfma_f32_16x16x32_bf16 v[198:201], v[32:35], v[238:241], v[198:201]
    s_waitcnt lgkmcnt(5)
    v_cvt_pk_bf16_f32 v175, v172, v173
    v_cvt_pk_bf16_f32 v182, v234, v235
    v_mfma_f32_16x16x32_f16 v[170:173], v[40:43], v[162:165], 0
    s_cmp_lt_u32 s34, s17
    v_cvt_pk_bf16_f32 v183, v236, v237
    s_cselect_b32 s10, s10, 0
    v_mfma_f32_16x16x32_bf16 v[114:117], v[222:225], a[204:207], v[114:117]
    s_add_u32 m0, s28, 0
    v_mul_f32 v255, 0x3baaaaab, v198
    v_mul_f32 v254, 0x3baaaaab, v199
    v_mfma_f32_16x16x32_bf16 v[114:117], v[226:229], a[208:211], v[114:117]
    s_mov_b32 s27, s26
    v_rsq_f32 v172, v170
    v_mfma_f32_16x16x32_bf16 v[114:117], v[242:245], a[212:215], v[114:117]
    s_mov_b32 s26, s25
    v_rsq_f32 v173, v171
    v_mfma_f32_16x16x32_bf16 v[162:165], a[72:75], v[134:137], 0
    s_waitcnt lgkmcnt(0)
    v_mul_f32 v172, s31, v172
    v_cvt_pk_f16_f32 v172, v172, v173
    v_mfma_f32_16x16x32_bf16 v[162:165], a[76:79], v[154:157], v[162:165]
    s_mov_b32 s25, s24
    v_cvt_pk_bf16_f32 v114, v114, v115
    v_cvt_pk_bf16_f32 v115, v116, v117
    v_mfma_f32_16x16x32_bf16 v[162:165], a[80:83], v[130:133], v[162:165]
    s_mov_b32 s24, s23
    v_pk_mul_f16 v118, v118, v172 op_sel:[0,1] op_sel_hi:[1,1]
    v_pk_mul_f16 v119, v119, v172 op_sel:[0,1] op_sel_hi:[1,1]
    v_mfma_f32_16x16x32_bf16 v[162:165], a[84:87], v[122:125], v[162:165]
    v_pk_mul_f16 v120, v120, v172 op_sel:[0,1] op_sel_hi:[1,1]
    v_pk_mul_f16 v121, v121, v172 op_sel:[0,1] op_sel_hi:[1,1]
    v_mfma_f32_16x16x32_bf16 v[162:165], a[88:91], v[126:129], v[162:165]
    v_pk_mul_f16 v196, v196, v172 op_sel:[0,1] op_sel_hi:[1,1]
    v_pk_mul_f16 v197, v197, v172 op_sel:[0,1] op_sel_hi:[1,1]
    v_mfma_f32_16x16x32_bf16 v[162:165], a[92:95], v[166:169], v[162:165]
    v_pk_mul_f16 v206, v206, v172 op_sel:[0,0] op_sel_hi:[1,0]
    v_pk_mul_f16 v207, v207, v172 op_sel:[0,0] op_sel_hi:[1,0]
    v_mfma_f32_16x16x32_bf16 v[210:213], a[96:99], v[134:137], 0
    v_pk_mul_f16 v208, v208, v172 op_sel:[0,0] op_sel_hi:[1,0]
    v_pk_mul_f16 v209, v209, v172 op_sel:[0,0] op_sel_hi:[1,0]
    v_mfma_f32_16x16x32_bf16 v[210:213], a[100:103], v[154:157], v[210:213]
    v_pk_mul_f16 v194, v194, v172 op_sel:[0,0] op_sel_hi:[1,0]
    v_pk_mul_f16 v195, v195, v172 op_sel:[0,0] op_sel_hi:[1,0]
    v_mfma_f32_16x16x32_bf16 v[210:213], a[104:107], v[130:133], v[210:213]
    v_min3_u32 v44, v44, v170, v171
    v_max3_u32 v45, v45, v170, v171
    v_mfma_f32_16x16x32_bf16 v[210:213], a[108:111], v[122:125], v[210:213]
    v_cvt_pk_f16_f32 v170, v162, v163
    v_pk_mul_f16 v163, v170, v170
    v_mfma_f32_16x16x32_bf16 v[210:213], a[112:115], v[126:129], v[210:213]
    v_cvt_pk_f16_f32 v171, v164, v165
    v_pk_mul_f16 v165, v171, v171
    v_mfma_f32_16x16x32_bf16 v[210:213], a[116:119], v[166:169], v[210:213]
    v_rsq_f32 v255, v255
    v_mfma_f32_16x16x32_bf16 v[214:217], a[120:123], v[134:137], 0
    v_rsq_f32 v254, v254
    v_mfma_f32_16x16x32_bf16 v[214:217], a[124:127], v[154:157], v[214:217]
    v_mul_f32 v142, v254, v142
    v_mul_f32 v143, v254, v143
    v_mfma_f32_16x16x32_bf16 v[214:217], a[128:131], v[130:133], v[214:217]
    v_cvt_pk_bf16_f32 v142, v142, v143
    v_cvt_pk_f16_f32 v172, v210, v211
    v_mfma_f32_16x16x32_bf16 v[214:217], a[132:135], v[122:125], v[214:217]
    v_pk_fma_f16 v163, v172, v172, v163
    v_cvt_pk_f16_f32 v173, v212, v213
    v_mfma_f32_16x16x32_bf16 v[214:217], a[136:139], v[126:129], v[214:217]
    v_pk_fma_f16 v165, v173, v173, v165
    v_mul_f32 v144, v254, v144
    v_mfma_f32_16x16x32_bf16 v[214:217], a[140:143], v[166:169], v[214:217]
    v_mul_f32 v145, v254, v145
    v_cvt_pk_bf16_f32 v143, v144, v145
    v_mfma_f32_16x16x32_bf16 v[210:213], a[0:3], v[134:137], 0
    v_mul_f32 v158, v254, v158
    v_mul_f32 v159, v254, v159
    v_mfma_f32_16x16x32_bf16 v[210:213], a[4:7], v[154:157], v[210:213]
    v_cvt_pk_bf16_f32 v144, v158, v159
    v_mul_f32 v160, v254, v160
    v_mfma_f32_16x16x32_bf16 v[210:213], a[8:11], v[130:133], v[210:213]
    v_cvt_pk_f16_f32 v220, v214, v215
    v_pk_fma_f16 v163, v220, v220, v163
    v_mfma_f32_16x16x32_bf16 v[210:213], a[12:15], v[122:125], v[210:213]
    v_cvt_pk_f16_f32 v221, v216, v217
    v_pk_fma_f16 v165, v221, v221, v165
    v_mfma_f32_16x16x32_bf16 v[210:213], a[16:19], v[126:129], v[210:213]
    v_mul_f32 v161, v254, v161
    v_cvt_pk_bf16_f32 v145, v160, v161
    v_mfma_f32_16x16x32_bf16 v[210:213], a[20:23], v[166:169], v[210:213]
    buffer_store_dwordx4 v[142:145], v16, s[12:15], 0 offen nt
    v_mul_f32 v178, v254, v178
    v_mul_f32 v179, v254, v179
    v_cvt_pk_bf16_f32 v198, v178, v179
    v_mul_f32 v180, v254, v180
    v_mfma_f32_16x16x32_bf16 v[142:145], a[24:27], v[134:137], 0
    v_mul_f32 v181, v254, v181
    v_cvt_pk_bf16_f32 v199, v180, v181
    v_mfma_f32_16x16x32_bf16 v[142:145], a[28:31], v[154:157], v[142:145]
    v_cvt_pk_f16_f32 v158, v210, v211
    v_pk_mul_f16 v162, v158, v158
    v_mfma_f32_16x16x32_bf16 v[142:145], a[32:35], v[130:133], v[142:145]
    v_cvt_pk_f16_f32 v159, v212, v213
    v_pk_mul_f16 v164, v159, v159
    v_mfma_f32_16x16x32_bf16 v[142:145], a[36:39], v[122:125], v[142:145]
    v_mul_f32 v254, 0x3baaaaab, v200
    v_mul_f32 v150, v255, v150
    v_mfma_f32_16x16x32_bf16 v[142:145], a[40:43], v[126:129], v[142:145]
    v_rsq_f32 v254, v254
    v_mfma_f32_16x16x32_bf16 v[142:145], a[44:47], v[166:169], v[142:145]
    v_mul_f32 v146, v254, v146
    v_mul_f32 v147, v254, v147
    v_mfma_f32_16x16x32_bf16 v[178:181], a[48:51], v[134:137], 0
    v_cvt_pk_bf16_f32 v146, v146, v147
    v_mul_f32 v148, v254, v148
    v_mfma_f32_16x16x32_bf16 v[178:181], a[52:55], v[154:157], v[178:181]
    v_mul_f32 v149, v254, v149
    v_cvt_pk_bf16_f32 v147, v148, v149
    v_mfma_f32_16x16x32_bf16 v[178:181], a[56:59], v[130:133], v[178:181]
    v_mul_f32 v138, v254, v138
    v_mul_f32 v139, v254, v139
    v_mfma_f32_16x16x32_bf16 v[178:181], a[60:63], v[122:125], v[178:181]
    v_cvt_pk_bf16_f32 v148, v138, v139
    v_mul_f32 v140, v254, v140
    v_mfma_f32_16x16x32_bf16 v[178:181], a[64:67], v[126:129], v[178:181]
    v_mul_f32 v141, v254, v141
    v_cvt_pk_bf16_f32 v149, v140, v141
    v_mfma_f32_16x16x32_bf16 v[178:181], a[68:71], v[166:169], v[178:181]
    v_mul_f32 v186, v254, v186
    v_mul_f32 v187, v254, v187
    v_mfma_f32_16x16x32_bf16 v[138:141], v[134:137], a[144:147], 0
    v_cvt_pk_bf16_f32 v200, v186, v187
    v_mul_f32 v188, v254, v188
    v_mfma_f32_16x16x32_bf16 v[138:141], v[154:157], a[148:151], v[138:141]
    v_mul_f32 v189, v254, v189
    v_cvt_pk_bf16_f32 v201, v188, v189
    v_mfma_f32_16x16x32_bf16 v[138:141], v[130:133], a[152:155], v[138:141]
    v_cvt_pk_f16_f32 v160, v142, v143
    v_pk_fma_f16 v162, v160, v160, v162
    v_mfma_f32_16x16x32_bf16 v[138:141], v[122:125], a[156:159], v[138:141]
    v_cvt_pk_f16_f32 v161, v144, v145
    v_pk_fma_f16 v164, v161, v161, v164
    v_mfma_f32_16x16x32_bf16 v[138:141], v[126:129], a[160:163], v[138:141]
    buffer_store_dwordx4 v[146:149], v17, s[12:15], 0 offen nt
    v_cvt_pk_f16_f32 v218, v178, v179
    v_pk_fma_f16 v162, v218, v218, v162
    v_cvt_pk_f16_f32 v219, v180, v181
    v_pk_fma_f16 v164, v219, v219, v164
    v_mfma_f32_16x16x32_bf16 v[138:141], v[166:169], a[164:167], v[138:141]
    v_mul_f32 v151, v255, v151
    v_cvt_pk_bf16_f32 v150, v150, v151
    v_mfma_f32_16x16x32_f16 v[142:145], v[40:43], v[162:165], 0
    v_mul_f32 v152, v255, v152
    v_mul_f32 v153, v255, v153
    v_mfma_f32_16x16x32_bf16 v[178:181], v[134:137], a[168:171], 0
    v_cvt_pk_bf16_f32 v151, v152, v153
    v_mul_f32 v190, v255, v190
    v_mfma_f32_16x16x32_bf16 v[178:181], v[154:157], a[172:175], v[178:181]
    v_cvt_pk_bf16_f32 v176, v138, v139
    v_cvt_pk_bf16_f32 v177, v140, v141
    v_mfma_f32_16x16x32_bf16 v[178:181], v[130:133], a[176:179], v[178:181]
    ds_read_b128 v[146:149], v0 offset:32768
    v_min3_u32 v44, v44, v142, v143
    v_mfma_f32_16x16x32_bf16 v[178:181], v[122:125], a[180:183], v[178:181]
    ds_read_b128 v[138:141], v1 offset:32768
    v_max3_u32 v45, v45, v142, v143
    v_mfma_f32_16x16x32_bf16 v[178:181], v[126:129], a[184:187], v[178:181]
    ds_read_b128 v[186:189], v0 offset:32896
    v_mul_f32 v191, v255, v191
    v_mfma_f32_16x16x32_bf16 v[178:181], v[166:169], a[188:191], v[178:181]
    ds_read_b128 v[162:165], v1 offset:32896
    v_cvt_pk_bf16_f32 v152, v190, v191
    v_mfma_f32_16x16x32_bf16 v[210:213], v[134:137], a[192:195], 0
    ds_read_b128 v[134:137], v0 offset:33024
    v_mul_f32 v192, v255, v192
    v_mfma_f32_16x16x32_bf16 v[210:213], v[154:157], a[196:199], v[210:213]
    ds_read_b128 v[154:157], v1 offset:33024
    v_mul_f32 v193, v255, v193
    v_mfma_f32_16x16x32_bf16 v[210:213], v[130:133], a[200:203], v[210:213]
    v_rsq_f32 v144, v142
    v_mfma_f32_16x16x32_bf16 v[210:213], v[122:125], a[204:207], v[210:213]
    v_rsq_f32 v145, v143
    v_mfma_f32_16x16x32_bf16 v[210:213], v[126:129], a[208:211], v[210:213]
    s_waitcnt lgkmcnt(5)
    v_mul_f32 v144, s31, v144
    v_cvt_pk_f16_f32 v144, v144, v145
    v_mfma_f32_16x16x32_bf16 v[210:213], v[166:169], a[212:215], v[210:213]
    s_waitcnt lgkmcnt(4)
    v_cvt_pk_bf16_f32 v184, v178, v179
    v_cvt_pk_bf16_f32 v185, v180, v181
    v_mfma_f32_16x16x32_bf16 v[178:181], a[72:75], v[146:149], 0
    s_waitcnt lgkmcnt(3)
    v_pk_mul_f16 v170, v170, v144 op_sel:[0,1] op_sel_hi:[1,1]
    v_pk_mul_f16 v171, v171, v144 op_sel:[0,1] op_sel_hi:[1,1]
    v_mfma_f32_16x16x32_bf16 v[178:181], a[76:79], v[138:141], v[178:181]
    s_waitcnt lgkmcnt(2)
    v_cvt_pk_bf16_f32 v116, v210, v211
    v_cvt_pk_bf16_f32 v117, v212, v213
    v_mfma_f32_16x16x32_bf16 v[178:181], a[80:83], v[186:189], v[178:181]
    s_waitcnt lgkmcnt(1)
    buffer_store_dwordx2 v[200:201], v20, s[12:15], 0 offen nt
    v_pk_mul_f16 v172, v172, v144 op_sel:[0,1] op_sel_hi:[1,1]
    v_pk_mul_f16 v173, v173, v144 op_sel:[0,1] op_sel_hi:[1,1]
    v_mfma_f32_16x16x32_bf16 v[178:181], a[84:87], v[162:165], v[178:181]
    s_waitcnt lgkmcnt(0)
    v_pk_mul_f16 v220, v220, v144 op_sel:[0,1] op_sel_hi:[1,1]
    v_pk_mul_f16 v221, v221, v144 op_sel:[0,1] op_sel_hi:[1,1]
    v_mfma_f32_16x16x32_bf16 v[178:181], a[88:91], v[134:137], v[178:181]
    v_pk_mul_f16 v158, v158, v144 op_sel:[0,0] op_sel_hi:[1,0]
    v_pk_mul_f16 v159, v159, v144 op_sel:[0,0] op_sel_hi:[1,0]
    v_mfma_f32_16x16x32_bf16 v[178:181], a[92:95], v[154:157], v[178:181]
    v_pk_mul_f16 v160, v160, v144 op_sel:[0,0] op_sel_hi:[1,0]
    v_pk_mul_f16 v161, v161, v144 op_sel:[0,0] op_sel_hi:[1,0]
    v_mfma_f32_16x16x32_bf16 v[130:133], a[96:99], v[146:149], 0
    v_pk_mul_f16 v218, v218, v144 op_sel:[0,0] op_sel_hi:[1,0]
    v_pk_mul_f16 v219, v219, v144 op_sel:[0,0] op_sel_hi:[1,0]
    v_mfma_f32_16x16x32_bf16 v[130:133], a[100:103], v[138:141], v[130:133]
    s_waitcnt vmcnt(3)
    v_cvt_pk_bf16_f32 v153, v192, v193
    v_cvt_pk_f16_f32 v142, v178, v179
    v_mfma_f32_16x16x32_bf16 v[130:133], a[104:107], v[186:189], v[130:133]
    s_nop 0
    v_pk_mul_f16 v191, v142, v142
    v_cvt_pk_f16_f32 v143, v180, v181
    v_mfma_f32_16x16x32_bf16 v[130:133], a[108:111], v[162:165], v[130:133]
    s_nop 0
    v_pk_mul_f16 v193, v143, v143
    v_mul_f32 v202, v255, v202
    v_mfma_f32_16x16x32_bf16 v[130:133], a[112:115], v[134:137], v[130:133]
    s_barrier
    v_mul_f32 v203, v255, v203
    v_cvt_pk_bf16_f32 v254, v202, v203
    v_mfma_f32_16x16x32_bf16 v[130:133], a[116:119], v[154:157], v[130:133]
    s_nop 0
    v_mul_f32 v204, v255, v204
    v_mul_f32 v205, v255, v205
    v_mfma_f32_16x16x32_bf16 v[178:181], a[120:123], v[146:149], 0
    v_cvt_pk_bf16_f32 v255, v204, v205
    v_xor_b32 v0, 65536, v0
    v_mfma_f32_16x16x32_bf16 v[178:181], a[124:127], v[138:141], v[178:181]
    v_xor_b32 v1, 65536, v1
    v_cvt_pk_f16_f32 v144, v130, v131
    v_mfma_f32_16x16x32_bf16 v[178:181], a[128:131], v[186:189], v[178:181]
    v_pk_fma_f16 v191, v144, v144, v191
    v_cvt_pk_f16_f32 v145, v132, v133
    v_mfma_f32_16x16x32_bf16 v[178:181], a[132:135], v[162:165], v[178:181]
    v_pk_fma_f16 v193, v145, v145, v193
    v_mfma_f32_16x16x32_bf16 v[178:181], a[136:139], v[134:137], v[178:181]
    v_mfma_f32_16x16x32_bf16 v[178:181], a[140:143], v[154:157], v[178:181]
    v_mfma_f32_16x16x32_bf16 v[202:205], a[0:3], v[146:149], 0
    v_mfma_f32_16x16x32_bf16 v[202:205], a[4:7], v[138:141], v[202:205]
    buffer_load_dwordx4 v10, s[8:11], 0 offen nt lds
    s_add_u32 m0, s28, 4096
    v_mfma_f32_16x16x32_bf16 v[202:205], a[8:11], v[186:189], v[202:205]
    v_mfma_f32_16x16x32_bf16 v[202:205], a[12:15], v[162:165], v[202:205]
    v_mfma_f32_16x16x32_bf16 v[202:205], a[16:19], v[134:137], v[202:205]
    v_mfma_f32_16x16x32_bf16 v[202:205], a[20:23], v[154:157], v[202:205]
    v_cvt_pk_f16_f32 v124, v178, v179
    v_pk_fma_f16 v191, v124, v124, v191
    v_mfma_f32_16x16x32_bf16 v[130:133], a[24:27], v[146:149], 0
    buffer_load_dwordx4 v11, s[8:11], 0 offen nt lds
    v_cvt_pk_f16_f32 v125, v180, v181
    v_mfma_f32_16x16x32_bf16 v[130:133], a[28:31], v[138:141], v[130:133]
    s_add_u32 m0, s28, 8192
    v_pk_fma_f16 v193, v125, v125, v193
    v_cvt_pk_f16_f32 v178, v202, v203
    v_mfma_f32_16x16x32_bf16 v[130:133], a[32:35], v[186:189], v[130:133]
    v_pk_mul_f16 v190, v178, v178
    v_cvt_pk_f16_f32 v179, v204, v205
    v_mfma_f32_16x16x32_bf16 v[130:133], a[36:39], v[162:165], v[130:133]
    v_pk_mul_f16 v192, v179, v179
    v_mfma_f32_16x16x32_bf16 v[130:133], a[40:43], v[134:137], v[130:133]
    v_mfma_f32_16x16x32_bf16 v[130:133], a[44:47], v[154:157], v[130:133]
    buffer_load_dwordx4 v12, s[8:11], 0 offen nt lds
    s_add_u32 m0, s28, 12288
    v_mfma_f32_16x16x32_bf16 v[202:205], a[48:51], v[146:149], 0
    s_xor_b32 s28, s28, 65536
    v_mfma_f32_16x16x32_bf16 v[202:205], a[52:55], v[138:141], v[202:205]
    ds_read_b128 v[166:169], v5 offset:0
    ds_read_b128 v[126:129], v5 offset:16
    v_mfma_f32_16x16x32_bf16 v[202:205], a[56:59], v[186:189], v[202:205]
    ds_read_b128 v[210:213], v5 offset:48
    ds_read_b32 v200, v6 offset:192
    v_mfma_f32_16x16x32_bf16 v[202:205], a[60:63], v[162:165], v[202:205]
    v_cvt_pk_f16_f32 v180, v130, v131
    v_pk_fma_f16 v190, v180, v180, v190
    v_mfma_f32_16x16x32_bf16 v[202:205], a[64:67], v[134:137], v[202:205]
    buffer_load_dwordx4 v13, s[8:11], 0 offen nt lds
    v_cvt_pk_f16_f32 v181, v132, v133
    v_mfma_f32_16x16x32_bf16 v[202:205], a[68:71], v[154:157], v[202:205]
    s_mov_b32 m0, s29
    v_pk_fma_f16 v192, v181, v181, v192
    v_add_u32 v5, 336, v5
    v_mfma_f32_16x16x32_bf16 v[130:133], v[146:149], a[144:147], 0
    s_xor_b32 s29, s29, s30
    s_add_u32 s19, s19, s20
    s_add_u32 s23, s23, s21
    v_mfma_f32_16x16x32_bf16 v[130:133], v[138:141], a[148:151], v[130:133]
    s_cmp_ge_u32 s19, 72
    v_cvt_pk_f16_f32 v122, v202, v203
    v_pk_fma_f16 v190, v122, v122, v190
    v_mfma_f32_16x16x32_bf16 v[130:133], v[186:189], a[152:155], v[130:133]
    s_cselect_b32 s34, 72, 0
    v_cvt_pk_f16_f32 v123, v204, v205
    v_pk_fma_f16 v192, v123, v123, v192
    v_mfma_f32_16x16x32_bf16 v[130:133], v[162:165], a[156:159], v[130:133]
    s_waitcnt lgkmcnt(2)
    buffer_store_dwordx2 v[198:199], v19, s[12:15], 0 offen nt
    s_cselect_b32 s35, s22, 0
    s_sub_u32 s19, s19, s34
    v_mfma_f32_16x16x32_f16 v[202:205], v[40:43], v[190:193], 0
    s_add_u32 s23, s23, s35
    s_add_u32 s18, s18, 1
    s_cmp_lt_u32 s18, s17
    v_mfma_f32_16x16x32_f16 v[214:217], v[166:169], v[158:161], v[24:27]
    s_waitcnt lgkmcnt(0)
    v_mfma_f32_16x16x32_f16 v[214:217], v[126:129], v[170:173], v[214:217]
    v_mfma_f32_16x16x32_f16 v[214:217], v[210:213], v[218:221], v[214:217]
    v_mfma_f32_16x16x32_f16 v[190:193], v[166:169], v[206:209], v[22:25]
    v_rsq_f32 v204, v202
    v_mfma_f32_16x16x32_f16 v[190:193], v[126:129], v[118:121], v[190:193]
    v_rsq_f32 v205, v203
    v_mfma_f32_16x16x32_f16 v[190:193], v[210:213], v[194:197], v[190:193]
    v_mul_f32 v204, s31, v204
    v_cvt_pk_f16_f32 v204, v204, v205
    v_mfma_f32_16x16x32_bf16 v[130:133], v[134:137], a[160:163], v[130:133]
    v_pk_mul_f16 v142, v142, v204 op_sel:[0,1] op_sel_hi:[1,1]
    v_pk_mul_f16 v143, v143, v204 op_sel:[0,1] op_sel_hi:[1,1]
    v_mfma_f32_16x16x32_bf16 v[130:133], v[154:157], a[164:167], v[130:133]
    v_pk_mul_f16 v144, v144, v204 op_sel:[0,1] op_sel_hi:[1,1]
    v_pk_mul_f16 v145, v145, v204 op_sel:[0,1] op_sel_hi:[1,1]
    v_mfma_f32_16x16x32_bf16 v[222:225], v[146:149], a[168:171], 0
    v_mov_b32_dpp v200, v191 quad_perm:[0,1,2,3] row_mask:0x1 bank_mask:0xf
    v_mov_b32_dpp v200, v215 quad_perm:[0,1,2,3] row_mask:0x2 bank_mask:0xf
    v_mfma_f32_16x16x32_bf16 v[222:225], v[138:141], a[172:175], v[222:225]
    v_pk_mul_f16 v124, v124, v204 op_sel:[0,1] op_sel_hi:[1,1]
    v_pk_mul_f16 v125, v125, v204 op_sel:[0,1] op_sel_hi:[1,1]
    v_mfma_f32_16x16x32_bf16 v[222:225], v[186:189], a[176:179], v[222:225]
    v_cvt_pk_bf16_f32 v130, v130, v131
    v_cvt_pk_bf16_f32 v131, v132, v133
    v_mfma_f32_16x16x32_bf16 v[222:225], v[162:165], a[180:183], v[222:225]
    v_pk_mul_f16 v178, v178, v204 op_sel:[0,0] op_sel_hi:[1,0]
    v_pk_mul_f16 v179, v179, v204 op_sel:[0,0] op_sel_hi:[1,0]
    v_mfma_f32_16x16x32_f16 v[226:229], v[118:121], v[206:209], v[46:49]
    v_pk_mul_f16 v180, v180, v204 op_sel:[0,0] op_sel_hi:[1,0]
    v_pk_mul_f16 v181, v181, v204 op_sel:[0,0] op_sel_hi:[1,0]
    v_mfma_f32_16x16x32_f16 v[230:233], v[170:173], v[206:209], v[50:53]
    v_pk_mul_f16 v122, v122, v204 op_sel:[0,0] op_sel_hi:[1,0]
    v_pk_mul_f16 v123, v123, v204 op_sel:[0,0] op_sel_hi:[1,0]
    v_mfma_f32_16x16x32_f16 v[234:237], v[142:145], v[206:209], v[54:57]
    v_min3_u32 v44, v44, v202, v203
    v_exp_f32 v214, v214
    v_mfma_f32_16x16x16_f16 v[226:229], v[196:197], v[194:195], v[226:229]
    v_max3_u32 v45, v45, v202, v203
    v_exp_f32 v190, v190
    v_mfma_f32_16x16x16_f16 v[230:233], v[220:221], v[194:195], v[230:233]
    v_cvt_pk_bf16_f32 v39, v190, 0
    v_mfma_f32_16x16x16_f16 v[234:237], v[124:125], v[194:195], v[234:237]
    buffer_store_dwordx4 v[150:153], v15, s[12:15], 0 offen nt
    v_mfma_f32_16x16x32_bf16 v[222:225], v[134:137], a[184:187], v[222:225]
    v_mfma_f32_16x16x32_bf16 v[222:225], v[154:157], a[188:191], v[222:225]
    ds_read_b128 v[206:209], v2 offset:0
    v_mfma_f32_16x16x32_bf16 v[150:153], v[146:149], a[192:195], 0
    ds_read_b128 v[146:149], v2 offset:1024
    v_mfma_f32_16x16x32_bf16 v[150:153], v[138:141], a[196:199], v[150:153]
    ds_read_b128 v[138:141], v2 offset:2048
    v_mfma_f32_16x16x32_bf16 v[150:153], v[186:189], a[200:203], v[150:153]
    ds_read_b128 v[186:189], v2 offset:3072
    v_mfma_f32_16x16x32_bf16 v[150:153], v[162:165], a[204:207], v[150:153]
    ds_read_b128 v[162:165], v2 offset:4096
    v_cvt_pk_bf16_f32 v222, v222, v223
    v_mfma_f32_16x16x32_bf16 v[150:153], v[134:137], a[208:211], v[150:153]
    ds_read_b128 v[134:137], v2 offset:5120
    v_cvt_pk_bf16_f32 v223, v224, v225
    v_mfma_f32_16x16x32_bf16 v[150:153], v[154:157], a[212:215], v[150:153]
    ds_read2_b32 v[132:133], v6 offset0:0 offset1:0
    ds_read2_b32 v[224:225], v6 offset0:16 offset1:16
    v_mfma_f32_16x16x32_f16 v[154:157], v[166:169], v[178:181], v[26:29]
    ds_read2_b32 v[168:169], v6 offset0:32 offset1:32
    v_add_u32 v6, 272, v6
    v_mfma_f32_16x16x32_f16 v[154:157], v[126:129], v[142:145], v[154:157]
    s_waitcnt lgkmcnt(8)
    v_exp_f32 v226, v226
    v_mfma_f32_16x16x32_f16 v[154:157], v[210:213], v[122:125], v[154:157]
    s_waitcnt lgkmcnt(7)
    v_cvt_pk_bf16_f32 v166, v150, v151
    v_cvt_pk_bf16_f32 v167, v152, v153
    v_mfma_f32_16x16x32_bf16 v[150:153], a[216:219], v[206:209], 0
    s_waitcnt lgkmcnt(6)
    v_exp_f32 v227, v227
    v_mfma_f32_16x16x32_bf16 v[150:153], a[220:223], v[146:149], v[150:153]
    s_waitcnt lgkmcnt(5)
    v_exp_f32 v154, v154
    v_mfma_f32_16x16x32_bf16 v[150:153], a[224:227], v[138:141], v[150:153]
    s_waitcnt lgkmcnt(4)
    v_mov_b32_dpp v200, v155 quad_perm:[0,1,2,3] row_mask:0x4 bank_mask:0xf
    v_cvt_pk_bf16_f32 v126, v226, v227
    v_mfma_f32_16x16x32_bf16 v[150:153], a[228:231], v[186:189], v[150:153]
    s_waitcnt lgkmcnt(3)
    v_exp_f32 v200, v200
    v_mfma_f32_16x16x32_bf16 v[150:153], a[232:235], v[162:165], v[150:153]
    s_waitcnt lgkmcnt(1)
    v_exp_f32 v228, v228
    v_mfma_f32_16x16x32_bf16 v[150:153], a[236:239], v[134:137], v[150:153]
    s_waitcnt lgkmcnt(0)
    buffer_store_dwordx2 v[254:255], v18, s[12:15], 0 offen nt
    v_exp_f32 v229, v229
    v_mfma_f32_16x16x32_bf16 v[190:193], a[240:243], v[206:209], 0
    v_cvt_pk_bf16_f32 v200, v200, v200
    v_cvt_pk_bf16_f32 v127, v228, v229
    v_mfma_f32_16x16x32_bf16 v[190:193], a[244:247], v[146:149], v[190:193]
    ds_write_b16 v8, v200
    v_mfma_f32_16x16x32_bf16 v[190:193], a[248:251], v[138:141], v[190:193]
    v_exp_f32 v230, v230
    v_mfma_f32_16x16x32_bf16 v[190:193], a[252:255], v[186:189], v[190:193]
    ds_read_b128 v[198:201], v2 offset:6144
    ds_read_b128 v[210:213], v9
    v_mfma_f32_16x16x32_bf16 v[190:193], v[82:85], v[162:165], v[190:193]
    ds_read_b128 v[226:229], v2 offset:7168
    ds_read_b128 v[238:241], v9 offset:64
    v_mfma_f32_16x16x32_bf16 v[190:193], v[86:89], v[134:137], v[190:193]
    v_exp_f32 v231, v231
    v_mfma_f32_16x16x32_bf16 v[202:205], v[90:93], v[206:209], 0
    ds_read_b128 v[206:209], v2 offset:8192
    ds_read_b128 v[242:245], v2 offset:9216
    v_mfma_f32_16x16x32_bf16 v[202:205], v[94:97], v[146:149], v[202:205]
    v_cvt_pk_bf16_f32 v128, v230, v231
    v_fma_f32 v254, v150, v150, s33
    v_mfma_f32_16x16x32_bf16 v[202:205], v[98:101], v[138:141], v[202:205]
    ds_read_b128 v[146:149], v2 offset:10240
    ds_read_b128 v[138:141], v2 offset:11264
    v_mfma_f32_16x16x32_bf16 v[202:205], v[102:105], v[186:189], v[202:205]
    v_exp_f32 v232, v232
    v_mfma_f32_16x16x32_bf16 v[202:205], v[106:109], v[162:165], v[202:205]
    v_exp_f32 v233, v233
    v_mfma_f32_16x16x32_bf16 v[202:205], v[110:113], v[134:137], v[202:205]
    s_waitcnt lgkmcnt(6)
    v_cvt_pk_bf16_f32 v129, v232, v233
    v_fmac_f32 v254, v151, v151
    v_mfma_f32_16x16x32_bf16 v[186:189], v[210:213], v[28:31], 0
    s_waitcnt lgkmcnt(4)
    v_exp_f32 v234, v234
    v_mfma_f32_16x16x32_bf16 v[186:189], v[238:241], v[28:31], v[186:189]
    v_exp_f32 v235, v235
    v_mfma_f32_16x16x32_f16 v[134:137], v[118:121], v[158:161], v[58:61]
    s_waitcnt lgkmcnt(2)
    v_cvt_pk_bf16_f32 v36, v234, v235
    v_fmac_f32 v254, v152, v152
    v_mfma_f32_16x16x32_f16 v[162:165], v[170:173], v[158:161], v[62:65]
    v_exp_f32 v236, v236
    v_mfma_f32_16x16x32_f16 v[230:233], v[142:145], v[158:161], v[66:69]
    s_waitcnt lgkmcnt(0)
    buffer_load_dwordx4 v14, s[8:11], 0 offen nt lds
    v_rcp_f32 v186, v186
    v_mfma_f32_16x16x16_f16 v[134:137], v[196:197], v[218:219], v[134:137]
    v_exp_f32 v237, v237
    v_fmac_f32 v254, v153, v153
    v_mfma_f32_16x16x16_f16 v[162:165], v[220:221], v[218:219], v[162:165]
    v_cvt_pk_bf16_f32 v37, v236, v237
    v_fmac_f32 v254, v190, v190
    v_fmac_f32 v254, v191, v191
    v_mfma_f32_16x16x16_f16 v[230:233], v[124:125], v[218:219], v[230:233]
    v_fmac_f32 v254, v192, v192
    v_exp_f32 v134, v134
    v_fmac_f32 v254, v193, v193
    v_mfma_f32_16x16x32_bf16 v[158:161], v[210:213], v[174:177], 0
    v_exp_f32 v135, v135
    v_mfma_f32_16x16x32_bf16 v[158:161], v[238:241], v[130:133], v[158:161]
    v_cvt_pk_bf16_f32 v134, v134, v135
    v_fmac_f32 v254, v202, v202
    v_mfma_f32_16x16x32_bf16 v[234:237], v[210:213], v[182:185], 0
    v_exp_f32 v136, v136
    v_mfma_f32_16x16x32_bf16 v[234:237], v[238:241], v[222:225], v[234:237]
    v_exp_f32 v137, v137
    v_mfma_f32_16x16x32_bf16 v[246:249], v[210:213], v[114:117], 0
    v_cvt_pk_bf16_f32 v135, v136, v137
    v_mul_f32 v158, v158, v186
    v_mfma_f32_16x16x32_bf16 v[246:249], v[238:241], v[166:169], v[246:249]
    v_exp_f32 v162, v162
    v_mfma_f32_16x16x32_bf16 v[210:213], v[28:31], v[36:39], 0
    v_exp_f32 v163, v163
    v_mfma_f32_16x16x32_bf16 v[210:213], v[28:31], v[126:129], v[210:213]
    v_cvt_pk_bf16_f32 v136, v162, v163
    v_mul_f32_dpp v158, v234, v186 quad_perm:[0,1,2,3] row_mask:0x2 bank_mask:0xf
    v_mfma_f32_16x16x32_bf16 v[234:237], v[130:133], v[36:39], 0
    v_exp_f32 v164, v164
    v_mfma_f32_16x16x32_bf16 v[234:237], v[174:177], v[126:129], v[234:237]
    v_exp_f32 v165, v165
    v_mfma_f32_16x16x32_bf16 v[238:241], v[222:225], v[36:39], 0
    v_cvt_pk_bf16_f32 v137, v164, v165
    v_mul_f32_dpp v158, v246, v186 quad_perm:[0,1,2,3] row_mask:0x4 bank_mask:0xf
    v_mfma_f32_16x16x32_bf16 v[238:241], v[182:185], v[126:129], v[238:241]
    v_exp_f32 v230, v230
    v_mfma_f32_16x16x32_bf16 v[186:189], v[166:169], v[36:39], 0
    v_exp_f32 v231, v231
    v_mfma_f32_16x16x32_bf16 v[186:189], v[114:117], v[126:129], v[186:189]
    v_cvt_pk_bf16_f32 v36, v230, v231
    v_cvt_pk_bf16_f32 v39, v214, 0
    v_mfma_f32_16x16x32_f16 v[162:165], v[118:121], v[178:181], v[70:73]
    v_exp_f32 v232, v232
    v_mfma_f32_16x16x32_f16 v[118:121], v[170:173], v[178:181], v[74:77]
    v_exp_f32 v233, v233
    v_mfma_f32_16x16x32_f16 v[170:173], v[142:145], v[178:181], v[78:81]
    v_cvt_pk_bf16_f32 v37, v232, v233
    v_cvt_pk_bf16_f32 v158, v158, v158
    v_fmac_f32 v254, v203, v203
    v_mfma_f32_16x16x16_f16 v[162:165], v[196:197], v[122:123], v[162:165]
    v_rcp_f32 v210, v210
    v_fmac_f32 v254, v204, v204
    v_mfma_f32_16x16x16_f16 v[118:121], v[220:221], v[122:123], v[118:121]
    v_mul_f32 v234, v210, v234
    v_mul_f32 v235, v210, v235
    v_cvt_pk_bf16_f32 v178, v234, v235
    v_mfma_f32_16x16x16_f16 v[170:173], v[124:125], v[122:123], v[170:173]
    v_mul_f32 v236, v210, v236
    v_exp_f32 v162, v162
    v_mul_f32 v237, v210, v237
    v_mfma_f32_16x16x32_bf16 v[194:197], v[28:31], v[36:39], 0
    ds_write_b16 v7, v158
    v_mfma_f32_16x16x32_bf16 v[194:197], v[28:31], v[134:137], v[194:197]
    v_exp_f32 v163, v163
    v_mfma_f32_16x16x32_bf16 v[122:125], v[130:133], v[36:39], 0
    v_cvt_pk_bf16_f32 v162, v162, v163
    v_cvt_pk_bf16_f32 v179, v236, v237
    v_mfma_f32_16x16x32_bf16 v[122:125], v[174:177], v[134:137], v[122:125]
    v_exp_f32 v164, v164
    v_mfma_f32_16x16x32_bf16 v[126:129], v[222:225], v[36:39], 0
    v_exp_f32 v165, v165
    v_mfma_f32_16x16x32_bf16 v[126:129], v[182:185], v[134:137], v[126:129]
    v_cvt_pk_bf16_f32 v163, v164, v165
    v_mul_f32 v238, v210, v238
    v_mfma_f32_16x16x32_bf16 v[218:221], v[166:169], v[36:39], 0
    v_exp_f32 v118, v118
    v_mfma_f32_16x16x32_bf16 v[218:221], v[114:117], v[134:137], v[218:221]
    v_exp_f32 v119, v119
    v_mfma_f32_16x16x32_bf16 v[142:145], a[216:219], v[198:201], 0
    v_cvt_pk_bf16_f32 v164, v118, v119
    v_cvt_pk_bf16_f32 v39, v154, 0
    v_mfma_f32_16x16x32_bf16 v[142:145], a[220:223], v[226:229], v[142:145]
    v_exp_f32 v120, v120
    v_mfma_f32_16x16x32_bf16 v[142:145], a[224:227], v[206:209], v[142:145]
    v_exp_f32 v121, v121
    v_mfma_f32_16x16x32_bf16 v[142:145], a[228:231], v[242:245], v[142:145]
    v_cvt_pk_bf16_f32 v165, v120, v121
    v_mul_f32 v239, v210, v239
    v_mfma_f32_16x16x32_bf16 v[142:145], a[232:235], v[146:149], v[142:145]
    v_exp_f32 v170, v170
    v_mfma_f32_16x16x32_bf16 v[142:145], a[236:239], v[138:141], v[142:145]
    v_exp_f32 v171, v171
    v_mfma_f32_16x16x32_bf16 v[158:161], a[240:243], v[198:201], 0
    v_cvt_pk_bf16_f32 v36, v170, v171
    v_cvt_pk_bf16_f32 v180, v238, v239
    v_mfma_f32_16x16x32_bf16 v[158:161], a[244:247], v[226:229], v[158:161]
    v_exp_f32 v172, v172
    v_mfma_f32_16x16x32_bf16 v[158:161], a[248:251], v[206:209], v[158:161]
    v_exp_f32 v173, v173
    v_mfma_f32_16x16x32_bf16 v[158:161], a[252:255], v[242:245], v[158:161]
    ds_read_b128 v[118:121], v2 offset:12288
    v_cvt_pk_bf16_f32 v37, v172, v173
    v_mfma_f32_16x16x32_bf16 v[158:161], v[82:85], v[146:149], v[158:161]
    ds_read_b128 v[134:137], v2 offset:13312
    v_mul_f32 v240, v210, v240
    v_mfma_f32_16x16x32_bf16 v[170:173], v[28:31], v[36:39], 0
    v_mul_f32 v241, v210, v241
    v_cvt_pk_bf16_f32 v181, v240, v241
    v_mfma_f32_16x16x32_bf16 v[170:173], v[28:31], v[162:165], v[170:173]
    ds_write_b128 v3, v[178:181] offset:0
    v_mfma_f32_16x16x32_bf16 v[154:157], v[130:133], v[36:39], 0
    v_mul_f32 v186, v210, v186
    v_mul_f32 v187, v210, v187
    v_mfma_f32_16x16x32_bf16 v[154:157], v[174:177], v[162:165], v[154:157]
    v_cvt_pk_bf16_f32 v186, v186, v187
    v_mul_f32 v188, v210, v188
    v_mfma_f32_16x16x32_bf16 v[130:133], v[222:225], v[36:39], 0
    v_mul_f32 v189, v210, v189
    v_cvt_pk_bf16_f32 v187, v188, v189
    v_mfma_f32_16x16x32_bf16 v[130:133], v[182:185], v[162:165], v[130:133]
    s_waitcnt lgkmcnt(2)
    ds_write_b64 v4, v[186:187] offset:4096
    v_mfma_f32_16x16x32_bf16 v[174:177], v[166:169], v[36:39], 0
    s_waitcnt lgkmcnt(2)
    v_fma_f32 v255, v142, v142, s33
    v_fmac_f32 v255, v143, v143
    v_mfma_f32_16x16x32_bf16 v[174:177], v[114:117], v[162:165], v[174:177]
    v_fmac_f32 v255, v144, v144
    v_fmac_f32 v255, v145, v145
    v_mfma_f32_16x16x32_bf16 v[158:161], v[86:89], v[138:141], v[158:161]
    ds_read_b128 v[114:117], v2 offset:14336
    v_fmac_f32 v254, v205, v205
    v_mfma_f32_16x16x32_bf16 v[178:181], v[90:93], v[198:201], 0
    ds_read_b128 v[166:169], v2 offset:15360
    v_add_u32 v7, 16, v7
    v_mfma_f32_16x16x32_bf16 v[178:181], v[94:97], v[226:229], v[178:181]
    ds_read_b128 v[162:165], v2 offset:16384
    v_mfma_f32_16x16x32_bf16 v[178:181], v[98:101], v[206:209], v[178:181]
    ds_read_b128 v[206:209], v2 offset:17408
    v_fmac_f32 v255, v158, v158
    v_mfma_f32_16x16x32_bf16 v[178:181], v[102:105], v[242:245], v[178:181]
    v_fmac_f32 v255, v159, v159
    v_fmac_f32 v255, v160, v160
    v_mfma_f32_16x16x32_bf16 v[178:181], v[106:109], v[146:149], v[178:181]
    v_fmac_f32 v255, v161, v161
    v_xor_b32 v2, 65536, v2
    v_mfma_f32_16x16x32_bf16 v[178:181], v[110:113], v[138:141], v[178:181]
    v_rcp_f32 v170, v170
    v_mfma_f32_16x16x32_bf16 v[146:149], a[216:219], v[118:121], 0
    v_mul_f32 v154, v170, v154
    v_mul_f32 v155, v170, v155
    v_mfma_f32_16x16x32_bf16 v[146:149], a[220:223], v[134:137], v[146:149]
    s_waitcnt lgkmcnt(3)
    ds_read_b128 v[182:185], v0 offset:20480
    v_cvt_pk_bf16_f32 v154, v154, v155
    v_mfma_f32_16x16x32_bf16 v[146:149], a[224:227], v[114:117], v[146:149]
    s_waitcnt lgkmcnt(3)
    ds_read_b128 v[198:201], v1 offset:20480
    v_fmac_f32 v255, v178, v178
    v_mfma_f32_16x16x32_bf16 v[146:149], a[228:231], v[166:169], v[146:149]
    s_waitcnt lgkmcnt(3)
    ds_read_b128 v[210:213], v0 offset:20608
    v_fmac_f32 v255, v179, v179
    v_mfma_f32_16x16x32_bf16 v[146:149], a[232:235], v[162:165], v[146:149]
    s_waitcnt lgkmcnt(3)
    ds_read_b128 v[222:225], v1 offset:20608
    v_fmac_f32 v255, v180, v180
    v_mfma_f32_16x16x32_bf16 v[146:149], a[236:239], v[206:209], v[146:149]
    ds_read_b128 v[226:229], v0 offset:20736
    v_fmac_f32 v255, v181, v181
    v_mfma_f32_16x16x32_bf16 v[138:141], a[240:243], v[118:121], 0
    ds_read_b128 v[242:245], v1 offset:20736
    v_cvt_pk_bf16_f32 v254, v254, v255
    v_mfma_f32_16x16x32_bf16 v[138:141], a[244:247], v[134:137], v[138:141]
    v_mul_f32 v156, v170, v156
    v_mul_f32 v157, v170, v157
    v_mfma_f32_16x16x32_bf16 v[138:141], a[248:251], v[114:117], v[138:141]
    v_fma_f32 v255, v146, v146, s33
    v_fmac_f32 v255, v147, v147
    v_mfma_f32_16x16x32_bf16 v[138:141], a[252:255], v[166:169], v[138:141]
    s_waitcnt lgkmcnt(5)
    v_fmac_f32 v255, v148, v148
    v_fmac_f32 v255, v149, v149
    v_mfma_f32_16x16x32_bf16 v[138:141], v[82:85], v[162:165], v[138:141]
    s_waitcnt lgkmcnt(4)
    v_cvt_pk_bf16_f32 v155, v156, v157
    v_mul_f32 v130, v170, v130
    v_mfma_f32_16x16x32_bf16 v[138:141], v[86:89], v[206:209], v[138:141]
    s_waitcnt lgkmcnt(3)
    v_mul_f32 v131, v170, v131
    v_cvt_pk_bf16_f32 v156, v130, v131
    v_mfma_f32_16x16x32_bf16 v[186:189], v[90:93], v[118:121], 0
    s_waitcnt lgkmcnt(2)
    v_mul_f32 v132, v170, v132
    v_mul_f32 v133, v170, v133
    v_mfma_f32_16x16x32_bf16 v[186:189], v[94:97], v[134:137], v[186:189]
    s_waitcnt lgkmcnt(1)
    v_fmac_f32 v255, v138, v138
    v_fmac_f32 v255, v139, v139
    v_mfma_f32_16x16x32_bf16 v[186:189], v[98:101], v[114:117], v[186:189]
    s_waitcnt lgkmcnt(0)
    v_fmac_f32 v255, v140, v140
    v_fmac_f32 v255, v141, v141
    v_mfma_f32_16x16x32_bf16 v[186:189], v[102:105], v[166:169], v[186:189]
    v_cvt_pk_bf16_f32 v157, v132, v133
    v_mul_f32 v174, v170, v174
    v_mfma_f32_16x16x32_bf16 v[186:189], v[106:109], v[162:165], v[186:189]
    ds_write_b128 v3, v[154:157] offset:12288
    v_mfma_f32_16x16x32_bf16 v[186:189], v[110:113], v[206:209], v[186:189]
    v_mul_f32 v175, v170, v175
    v_cvt_pk_bf16_f32 v174, v174, v175
    v_mfma_f32_16x16x32_bf16 v[118:121], a[72:75], v[182:185], 0
    v_mul_f32 v176, v170, v176
    v_mul_f32 v177, v170, v177
    v_mfma_f32_16x16x32_bf16 v[118:121], a[76:79], v[198:201], v[118:121]
    v_rcp_f32 v194, v194
    v_mfma_f32_16x16x32_bf16 v[118:121], a[80:83], v[210:213], v[118:121]
    v_fmac_f32 v255, v186, v186
    v_fmac_f32 v255, v187, v187
    v_mfma_f32_16x16x32_bf16 v[118:121], a[84:87], v[222:225], v[118:121]
    v_fmac_f32 v255, v188, v188
    v_fmac_f32 v255, v189, v189
    v_mfma_f32_16x16x32_bf16 v[118:121], a[88:91], v[226:229], v[118:121]
    v_cvt_pk_bf16_f32 v255, v255, v255
    v_cvt_pk_bf16_f32 v175, v176, v177
    v_mfma_f32_16x16x32_bf16 v[118:121], a[92:95], v[242:245], v[118:121]
    ds_write_b64 v4, v[174:175] offset:16384
    v_mfma_f32_16x16x32_bf16 v[206:209], a[96:99], v[182:185], 0
    v_mul_f32 v122, v194, v122
    v_mul_f32 v123, v194, v123
    v_mfma_f32_16x16x32_bf16 v[206:209], a[100:103], v[198:201], v[206:209]
    ds_write_b64 v4, v[254:255] offset:18432
    v_mfma_f32_16x16x32_bf16 v[206:209], a[104:107], v[210:213], v[206:209]
    v_cvt_pk_bf16_f32 v134, v122, v123
    v_cvt_pk_f16_f32 v118, v118, v119
    v_mfma_f32_16x16x32_bf16 v[206:209], a[108:111], v[222:225], v[206:209]
    v_pk_mul_f16 v163, v118, v118
    v_cvt_pk_f16_f32 v119, v120, v121
    v_mfma_f32_16x16x32_bf16 v[206:209], a[112:115], v[226:229], v[206:209]
    v_pk_mul_f16 v165, v119, v119
    v_mul_f32 v124, v194, v124
    v_mfma_f32_16x16x32_bf16 v[206:209], a[116:119], v[242:245], v[206:209]
    v_mul_f32 v125, v194, v125
    v_cvt_pk_bf16_f32 v135, v124, v125
    v_mfma_f32_16x16x32_bf16 v[122:125], a[120:123], v[182:185], 0
    v_mul_f32 v126, v194, v126
    v_mul_f32 v127, v194, v127
    v_mfma_f32_16x16x32_bf16 v[122:125], a[124:127], v[198:201], v[122:125]
    v_cvt_pk_bf16_f32 v136, v126, v127
    v_mul_f32 v128, v194, v128
    v_mfma_f32_16x16x32_bf16 v[122:125], a[128:131], v[210:213], v[122:125]
    v_cvt_pk_f16_f32 v120, v206, v207
    v_pk_fma_f16 v163, v120, v120, v163
    v_mfma_f32_16x16x32_bf16 v[122:125], a[132:135], v[222:225], v[122:125]
    v_cvt_pk_f16_f32 v121, v208, v209
    v_pk_fma_f16 v165, v121, v121, v165
    v_mfma_f32_16x16x32_bf16 v[122:125], a[136:139], v[226:229], v[122:125]
    v_mul_f32 v129, v194, v129
    v_cvt_pk_bf16_f32 v137, v128, v129
    v_mfma_f32_16x16x32_bf16 v[122:125], a[140:143], v[242:245], v[122:125]
    ds_write_b128 v3, v[134:137] offset:6144
    v_mfma_f32_16x16x32_bf16 v[206:209], a[0:3], v[182:185], 0
    v_mul_f32 v218, v194, v218
    v_mul_f32 v219, v194, v219
    v_mfma_f32_16x16x32_bf16 v[206:209], a[4:7], v[198:201], v[206:209]
    v_cvt_pk_bf16_f32 v254, v218, v219
    v_mul_f32 v220, v194, v220
    v_mfma_f32_16x16x32_bf16 v[206:209], a[8:11], v[210:213], v[206:209]
    v_cvt_pk_f16_f32 v196, v122, v123
    v_pk_fma_f16 v163, v196, v196, v163
    v_mfma_f32_16x16x32_bf16 v[206:209], a[12:15], v[222:225], v[206:209]
    v_cvt_pk_f16_f32 v197, v124, v125
    v_pk_fma_f16 v165, v197, v197, v165
    v_mfma_f32_16x16x32_bf16 v[206:209], a[16:19], v[226:229], v[206:209]
    v_mul_f32 v221, v194, v221
    v_cvt_pk_bf16_f32 v255, v220, v221
    v_mfma_f32_16x16x32_bf16 v[206:209], a[20:23], v[242:245], v[206:209]
    ds_write_b64 v4, v[254:255] offset:10240
    v_mfma_f32_16x16x32_bf16 v[174:177], a[24:27], v[182:185], 0
    v_xor_b32 v3, 65536, v3
    v_xor_b32 v4, 65536, v4
    v_mfma_f32_16x16x32_bf16 v[174:177], a[28:31], v[198:201], v[174:177]
    v_mfma_f32_16x16x32_bf16 v[174:177], a[32:35], v[210:213], v[174:177]
    v_mfma_f32_16x16x32_bf16 v[174:177], a[36:39], v[222:225], v[174:177]
    v_mfma_f32_16x16x32_bf16 v[174:177], a[40:43], v[226:229], v[174:177]
    v_cvt_pk_f16_f32 v206, v206, v207
    v_mfma_f32_16x16x32_bf16 v[174:177], a[44:47], v[242:245], v[174:177]
    v_mfma_f32_16x16x32_bf16 v[218:221], a[48:51], v[182:185], 0
    s_waitcnt lgkmcnt(0)
    v_mfma_f32_16x16x32_bf16 v[218:221], a[52:55], v[198:201], v[218:221]
    s_nop 0
    v_mfma_f32_16x16x32_bf16 v[218:221], a[56:59], v[210:213], v[218:221]
    s_nop 0
    v_mfma_f32_16x16x32_bf16 v[218:221], a[60:63], v[222:225], v[218:221]
    s_barrier
    v_mfma_f32_16x16x32_bf16 v[218:221], a[64:67], v[226:229], v[218:221]
    s_nop 0
    v_mfma_f32_16x16x32_bf16 v[218:221], a[68:71], v[242:245], v[218:221]
    v_mfma_f32_16x16x32_bf16 v[170:173], v[182:185], a[144:147], 0
    v_mfma_f32_16x16x32_bf16 v[170:173], v[198:201], a[148:151], v[170:173]
    v_mfma_f32_16x16x32_bf16 v[170:173], v[210:213], a[152:155], v[170:173]
    v_mfma_f32_16x16x32_bf16 v[170:173], v[222:225], a[156:159], v[170:173]
    v_mfma_f32_16x16x32_bf16 v[170:173], v[226:229], a[160:163], v[170:173]
    v_mfma_f32_16x16x32_bf16 v[170:173], v[242:245], a[164:167], v[170:173]
    s_cbranch_scc1 L_loop_fast2
    s_branch L_drain
.p2align 6
L_loop_fast3:
    v_mfma_f32_16x16x32_bf16 v[234:237], v[182:185], a[168:171], 0
    s_add_u32 s12, s42, s27
    ds_read_b128 v[230:233], v2 offset:18432
    ds_read_b128 v[238:241], v2 offset:19456
    v_mfma_f32_16x16x32_bf16 v[234:237], v[198:201], a[172:175], v[234:237]
    s_addc_u32 s13, s43, 0
    v_pk_mul_f16 v162, v206, v206
    v_cvt_pk_f16_f32 v207, v208, v209
    v_mfma_f32_16x16x32_bf16 v[234:237], v[210:213], a[176:179], v[234:237]
    s_sub_u32 s14, s36, s27
    ds_read_b128 v[134:137], v0 offset:26624
    v_pk_mul_f16 v164, v207, v207
    v_mfma_f32_16x16x32_bf16 v[234:237], v[222:225], a[180:183], v[234:237]
    s_cmp_ge_u32 s18, 2
    ds_read_b128 v[154:157], v1 offset:26624
    v_cvt_pk_f16_f32 v208, v174, v175
    v_mfma_f32_16x16x32_bf16 v[234:237], v[226:229], a[184:187], v[234:237]
    s_cselect_b32 s14, s14, 0
    ds_read_b128 v[130:133], v0 offset:26752
    v_pk_fma_f16 v162, v208, v208, v162
    v_mfma_f32_16x16x32_bf16 v[234:237], v[242:245], a[188:191], v[234:237]
    s_add_u32 s34, s18, 2
    ds_read_b128 v[122:125], v1 offset:26752
    v_cvt_pk_f16_f32 v209, v176, v177
    v_mfma_f32_16x16x32_bf16 v[114:117], v[182:185], a[192:195], 0
    s_add_u32 s8, s40, s23
    ds_read_b128 v[126:129], v0 offset:26880
    v_pk_fma_f16 v164, v209, v209, v164
    v_mfma_f32_16x16x32_bf16 v[114:117], v[198:201], a[196:199], v[114:117]
    s_addc_u32 s9, s41, 0
    ds_read_b128 v[166:169], v1 offset:26880
    v_cvt_pk_f16_f32 v194, v218, v219
    v_mfma_f32_16x16x32_bf16 v[114:117], v[210:213], a[200:203], v[114:117]
    s_waitcnt lgkmcnt(6)
    v_pk_fma_f16 v162, v194, v194, v162
    v_cvt_pk_f16_f32 v195, v220, v221
    v_mfma_f32_16x16x32_bf16 v[198:201], v[32:35], v[230:233], 0
    s_sub_u32 s10, s36, s23
    v_pk_fma_f16 v164, v195, v195, v164
    v_cvt_pk_bf16_f32 v174, v170, v171
    v_mfma_f32_16x16x32_bf16 v[198:201], v[32:35], v[238:241], v[198:201]
    s_waitcnt lgkmcnt(5)
    v_cvt_pk_bf16_f32 v175, v172, v173
    v_cvt_pk_bf16_f32 v182, v234, v235
    v_mfma_f32_16x16x32_f16 v[170:173], v[40:43], v[162:165], 0
    s_cmp_lt_u32 s34, s17
    v_cvt_pk_bf16_f32 v183, v236, v237
    s_cselect_b32 s10, s10, 0
    v_mfma_f32_16x16x32_bf16 v[114:117], v[222:225], a[204:207], v[114:117]
    s_add_u32 m0, s28, 0
    v_mul_f32 v255, 0x3baaaaab, v198
    v_mul_f32 v254, 0x3baaaaab, v199
    v_mfma_f32_16x16x32_bf16 v[114:117], v[226:229], a[208:211], v[114:117]
    s_mov_b32 s27, s26
    v_rsq_f32 v172, v170
    v_mfma_f32_16x16x32_bf16 v[114:117], v[242:245], a[212:215], v[114:117]
    s_mov_b32 s26, s25
    v_rsq_f32 v173, v171
    v_mfma_f32_16x16x32_bf16 v[162:165], a[72:75], v[134:137], 0
    s_waitcnt lgkmcnt(0)
    v_mul_f32 v172, s31, v172
    v_cvt_pk_f16_f32 v172, v172, v173
    v_mfma_f32_16x16x32_bf16 v[162:165], a[76:79], v[154:157], v[162:165]
    s_mov_b32 s25, s24
    v_cvt_pk_bf16_f32 v114, v114, v115
    v_cvt_pk_bf16_f32 v115, v116, v117
    v_mfma_f32_16x16x32_bf16 v[162:165], a[80:83], v[130:133], v[162:165]
    s_mov_b32 s24, s23
    v_pk_mul_f16 v118, v118, v172 op_sel:[0,1] op_sel_hi:[1,1]
    v_pk_mul_f16 v119, v119, v172 op_sel:[0,1] op_sel_hi:[1,1]
    v_mfma_f32_16x16x32_bf16 v[162:165], a[84:87], v[122:125], v[162:165]
    v_pk_mul_f16 v120, v120, v172 op_sel:[0,1] op_sel_hi:[1,1]
    v_pk_mul_f16 v121, v121, v172 op_sel:[0,1] op_sel_hi:[1,1]
    v_mfma_f32_16x16x32_bf16 v[162:165], a[88:91], v[126:129], v[162:165]
    v_pk_mul_f16 v196, v196, v172 op_sel:[0,1] op_sel_hi:[1,1]
    v_pk_mul_f16 v197, v197, v172 op_sel:[0,1] op_sel_hi:[1,1]
    v_mfma_f32_16x16x32_bf16 v[162:165], a[92:95], v[166:169], v[162:165]
    v_pk_mul_f16 v206, v206, v172 op_sel:[0,0] op_sel_hi:[1,0]
    v_pk_mul_f16 v207, v207, v172 op_sel:[0,0] op_sel_hi:[1,0]
    v_mfma_f32_16x16x32_bf16 v[210:213], a[96:99], v[134:137], 0
    v_pk_mul_f16 v208, v208, v172 op_sel:[0,0] op_sel_hi:[1,0]
    v_pk_mul_f16 v209, v209, v172 op_sel:[0,0] op_sel_hi:[1,0]
    v_mfma_f32_16x16x32_bf16 v[210:213], a[100:103], v[154:157], v[210:213]
    v_pk_mul_f16 v194, v194, v172 op_sel:[0,0] op_sel_hi:[1,0]
    v_pk_mul_f16 v195, v195, v172 op_sel:[0,0] op_sel_hi:[1,0]
    v_mfma_f32_16x16x32_bf16 v[210:213], a[104:107], v[130:133], v[210:213]
    v_min3_u32 v44, v44, v170, v171
    v_max3_u32 v45, v45, v170, v171
    v_mfma_f32_16x16x32_bf16 v[210:213], a[108:111], v[122:125], v[210:213]
    v_cvt_pk_f16_f32 v170, v162, v163
    v_pk_mul_f16 v163, v170, v170
    v_mfma_f32_16x16x32_bf16 v[210:213], a[112:115], v[126:129], v[210:213]
    v_cvt_pk_f16_f32 v171, v164, v165
    v_pk_mul_f16 v165, v171, v171
    v_mfma_f32_16x16x32_bf16 v[210:213], a[116:119], v[166:169], v[210:213]
    v_rsq_f32 v255, v255
    v_mfma_f32_16x16x32_bf16 v[214:217], a[120:123], v[134:137], 0
    v_rsq_f32 v254, v254
    v_mfma_f32_16x16x32_bf16 v[214:217], a[124:127], v[154:157], v[214:217]
    v_mul_f32 v142, v254, v142
    v_mul_f32 v143, v254, v143
    v_mfma_f32_16x16x32_bf16 v[214:217], a[128:131], v[130:133], v[214:217]
    v_cvt_pk_bf16_f32 v142, v142, v143
    v_cvt_pk_f16_f32 v172, v210, v211
    v_mfma_f32_16x16x32_bf16 v[214:217], a[132:135], v[122:125], v[214:217]
    v_pk_fma_f16 v163, v172, v172, v163
    v_cvt_pk_f16_f32 v173, v212, v213
    v_mfma_f32_16x16x32_bf16 v[214:217], a[136:139], v[126:129], v[214:217]
    v_pk_fma_f16 v165, v173, v173, v165
    v_mul_f32 v144, v254, v144
    v_mfma_f32_16x16x32_bf16 v[214:217], a[140:143], v[166:169], v[214:217]
    v_mul_f32 v145, v254, v145
    v_cvt_pk_bf16_f32 v143, v144, v145
    v_mfma_f32_16x16x32_bf16 v[210:213], a[0:3], v[134:137], 0
    v_mul_f32 v158, v254, v158
    v_mul_f32 v159, v254, v159
    v_mfma_f32_16x16x32_bf16 v[210:213], a[4:7], v[154:157], v[210:213]
    v_cvt_pk_bf16_f32 v144, v158, v159
    v_mul_f32 v160, v254, v160
    v_mfma_f32_16x16x32_bf16 v[210:213], a[8:11], v[130:133], v[210:213]
    v_cvt_pk_f16_f32 v220, v214, v215
    v_pk_fma_f16 v163, v220, v220, v163
    v_mfma_f32_16x16x32_bf16 v[210:213], a[12:15], v[122:125], v[210:213]
    v_cvt_pk_f16_f32 v221, v216, v217
    v_pk_fma_f16 v165, v221, v221, v165
    v_mfma_f32_16x16x32_bf16 v[210:213], a[16:19], v[126:129], v[210:213]
    v_mul_f32 v161, v254, v161
    v_cvt_pk_bf16_f32 v145, v160, v161
    v_mfma_f32_16x16x32_bf16 v[210:213], a[20:23], v[166:169], v[210:213]
    buffer_store_dwordx4 v[142:145], v16, s[12:15], 0 offen nt
    v_mul_f32 v178, v254, v178
    v_mul_f32 v179, v254, v179
    v_cvt_pk_bf16_f32 v198, v178, v179
    v_mul_f32 v180, v254, v180
    v_mfma_f32_16x16x32_bf16 v[142:145], a[24:27], v[134:137], 0
    v_mul_f32 v181, v254, v181
    v_cvt_pk_bf16_f32 v199, v180, v181
    v_mfma_f32_16x16x32_bf16 v[142:145], a[28:31], v[154:157], v[142:145]
    v_cvt_pk_f16_f32 v158, v210, v211
    v_pk_mul_f16 v162, v158, v158
    v_mfma_f32_16x16x32_bf16 v[142:145], a[32:35], v[130:133], v[142:145]
    v_cvt_pk_f16_f32 v159, v212, v213
    v_pk_mul_f16 v164, v159, v159
    v_mfma_f32_16x16x32_bf16 v[142:145], a[36:39], v[122:125], v[142:145]
    v_mul_f32 v254, 0x3baaaaab, v200
    v_mul_f32 v150, v255, v150
    v_mfma_f32_16x16x32_bf16 v[142:145], a[40:43], v[126:129], v[142:145]
    v_rsq_f32 v254, v254
    v_mfma_f32_16x16x32_bf16 v[142:145], a[44:47], v[166:169], v[142:145]
    v_mul_f32 v146, v254, v146
    v_mul_f32 v147, v254, v147
    v_mfma_f32_16x16x32_bf16 v[178:181], a[48:51], v[134:137], 0
    v_cvt_pk_bf16_f32 v146, v146, v147
    v_mul_f32 v148, v254, v148
    v_mfma_f32_16x16x32_bf16 v[178:181], a[52:55], v[154:157], v[178:181]
    v_mul_f32 v149, v254, v149
    v_cvt_pk_bf16_f32 v147, v148, v149
    v_mfma_f32_16x16x32_bf16 v[178:181], a[56:59], v[130:133], v[178:181]
    v_mul_f32 v138, v254, v138
    v_mul_f32 v139, v254, v139
    v_mfma_f32_16x16x32_bf16 v[178:181], a[60:63], v[122:125], v[178:181]
    v_cvt_pk_bf16_f32 v148, v138, v139
    v_mul_f32 v140, v254, v140
    v_mfma_f32_16x16x32_bf16 v[178:181], a[64:67], v[126:129], v[178:181]
    v_mul_f32 v141, v254, v141
    v_cvt_pk_bf16_f32 v149, v140, v141
    v_mfma_f32_16x16x32_bf16 v[178:181], a[68:71], v[166:169], v[178:181]
    v_mul_f32 v186, v254, v186
    v_mul_f32 v187, v254, v187
    v_mfma_f32_16x16x32_bf16 v[138:141], v[134:137], a[144:147], 0
    v_cvt_pk_bf16_f32 v200, v186, v187
    v_mul_f32 v188, v254, v188
    v_mfma_f32_16x16x32_bf16 v[138:141], v[154:157], a[148:151], v[138:141]
    v_mul_f32 v189, v254, v189
    v_cvt_pk_bf16_f32 v201, v188, v189
    v_mfma_f32_16x16x32_bf16 v[138:141], v[130:133], a[152:155], v[138:141]
    v_cvt_pk_f16_f32 v160, v142, v143
    v_pk_fma_f16 v162, v160, v160, v162
    v_mfma_f32_16x16x32_bf16 v[138:141], v[122:125], a[156:159], v[138:141]
    v_cvt_pk_f16_f32 v161, v144, v145
    v_pk_fma_f16 v164, v161, v161, v164
    v_mfma_f32_16x16x32_bf16 v[138:141], v[126:129], a[160:163], v[138:141]
    buffer_store_dwordx4 v[146:149], v17, s[12:15], 0 offen nt
    v_cvt_pk_f16_f32 v218, v178, v179
    v_pk_fma_f16 v162, v218, v218, v162
    v_cvt_pk_f16_f32 v219, v180, v181
    v_pk_fma_f16 v164, v219, v219, v164
    v_mfma_f32_16x16x32_bf16 v[138:141], v[166:169], a[164:167], v[138:141]
    v_mul_f32 v151, v255, v151
    v_cvt_pk_bf16_f32 v150, v150, v151
    v_mfma_f32_16x16x32_f16 v[142:145], v[40:43], v[162:165], 0
    v_mul_f32 v152, v255, v152
    v_mul_f32 v153, v255, v153
    v_mfma_f32_16x16x32_bf16 v[178:181], v[134:137], a[168:171], 0
    v_cvt_pk_bf16_f32 v151, v152, v153
    v_mul_f32 v190, v255, v190
    v_mfma_f32_16x16x32_bf16 v[178:181], v[154:157], a[172:175], v[178:181]
    v_cvt_pk_bf16_f32 v176, v138, v139
    v_cvt_pk_bf16_f32 v177, v140, v141
    v_mfma_f32_16x16x32_bf16 v[178:181], v[130:133], a[176:179], v[178:181]
    ds_read_b128 v[146:149], v0 offset:32768
    v_min3_u32 v44, v44, v142, v143
    v_mfma_f32_16x16x32_bf16 v[178:181], v[122:125], a[180:183], v[178:181]
    ds_read_b128 v[138:141], v1 offset:32768
    v_max3_u32 v45, v45, v142, v143
    v_mfma_f32_16x16x32_bf16 v[178:181], v[126:129], a[184:187], v[178:181]
    ds_read_b128 v[186:189], v0 offset:32896
    v_mul_f32 v191, v255, v191
    v_mfma_f32_16x16x32_bf16 v[178:181], v[166:169], a[188:191], v[178:181]
    ds_read_b128 v[162:165], v1 offset:32896
    v_cvt_pk_bf16_f32 v152, v190, v191
    v_mfma_f32_16x16x32_bf16 v[210:213], v[134:137], a[192:195], 0
    ds_read_b128 v[134:137], v0 offset:33024
    v_mul_f32 v192, v255, v192
    v_mfma_f32_16x16x32_bf16 v[210:213], v[154:157], a[196:199], v[210:213]
    ds_read_b128 v[154:157], v1 offset:33024
    v_mul_f32 v193, v255, v193
    v_mfma_f32_16x16x32_bf16 v[210:213], v[130:133], a[200:203], v[210:213]
    v_rsq_f32 v144, v142
    v_mfma_f32_16x16x32_bf16 v[210:213], v[122:125], a[204:207], v[210:213]
    v_rsq_f32 v145, v143
    v_mfma_f32_16x16x32_bf16 v[210:213], v[126:129], a[208:211], v[210:213]
    s_waitcnt lgkmcnt(5)
    v_mul_f32 v144, s31, v144
    v_cvt_pk_f16_f32 v144, v144, v145
    v_mfma_f32_16x16x32_bf16 v[210:213], v[166:169], a[212:215], v[210:213]
    s_waitcnt lgkmcnt(4)
    v_cvt_pk_bf16_f32 v184, v178, v179
    v_cvt_pk_bf16_f32 v185, v180, v181
    v_mfma_f32_16x16x32_bf16 v[178:181], a[72:75], v[146:149], 0
    s_waitcnt lgkmcnt(3)
    v_pk_mul_f16 v170, v170, v144 op_sel:[0,1] op_sel_hi:[1,1]
    v_pk_mul_f16 v171, v171, v144 op_sel:[0,1] op_sel_hi:[1,1]
    v_mfma_f32_16x16x32_bf16 v[178:181], a[76:79], v[138:141], v[178:181]
    s_waitcnt lgkmcnt(2)
    v_cvt_pk_bf16_f32 v116, v210, v211
    v_cvt_pk_bf16_f32 v117, v212, v213
    v_mfma_f32_16x16x32_bf16 v[178:181], a[80:83], v[186:189], v[178:181]
    s_waitcnt lgkmcnt(1)
    buffer_store_dwordx2 v[200:201], v20, s[12:15], 0 offen nt
    v_pk_mul_f16 v172, v172, v144 op_sel:[0,1] op_sel_hi:[1,1]
    v_pk_mul_f16 v173, v173, v144 op_sel:[0,1] op_sel_hi:[1,1]
    v_mfma_f32_16x16x32_bf16 v[178:181], a[84:87], v[162:165], v[178:181]
    s_waitcnt lgkmcnt(0)
    v_pk_mul_f16 v220, v220, v144 op_sel:[0,1] op_sel_hi:[1,1]
    v_pk_mul_f16 v221, v221, v144 op_sel:[0,1] op_sel_hi:[1,1]
    v_mfma_f32_16x16x32_bf16 v[178:181], a[88:91], v[134:137], v[178:181]
    v_pk_mul_f16 v158, v158, v144 op_sel:[0,0] op_sel_hi:[1,0]
    v_pk_mul_f16 v159, v159, v144 op_sel:[0,0] op_sel_hi:[1,0]
    v_mfma_f32_16x16x32_bf16 v[178:181], a[92:95], v[154:157], v[178:181]
    v_pk_mul_f16 v160, v160, v144 op_sel:[0,0] op_sel_hi:[1,0]
    v_pk_mul_f16 v161, v161, v144 op_sel:[0,0] op_sel_hi:[1,0]
    v_mfma_f32_16x16x32_bf16 v[130:133], a[96:99], v[146:149], 0
    v_pk_mul_f16 v218, v218, v144 op_sel:[0,0] op_sel_hi:[1,0]
    v_pk_mul_f16 v219, v219, v144 op_sel:[0,0] op_sel_hi:[1,0]
    v_mfma_f32_16x16x32_bf16 v[130:133], a[100:103], v[138:141], v[130:133]
    s_waitcnt vmcnt(3)
    v_cvt_pk_bf16_f32 v153, v192, v193
    v_cvt_pk_f16_f32 v142, v178, v179
    v_mfma_f32_16x16x32_bf16 v[130:133], a[104:107], v[186:189], v[130:133]
    s_nop 0
    v_pk_mul_f16 v191, v142, v142
    v_cvt_pk_f16_f32 v143, v180, v181
    v_mfma_f32_16x16x32_bf16 v[130:133], a[108:111], v[162:165], v[130:133]
    s_nop 0
    v_pk_mul_f16 v193, v143, v143
    v_mul_f32 v202, v255, v202
    v_mfma_f32_16x16x32_bf16 v[130:133], a[112:115], v[134:137], v[130:133]
    s_nop 0
    v_mul_f32 v203, v255, v203
    v_cvt_pk_bf16_f32 v254, v202, v203
    v_mfma_f32_16x16x32_bf16 v[130:133], a[116:119], v[154:157], v[130:133]
    s_barrier
    v_mul_f32 v204, v255, v204
    v_mul_f32 v205, v255, v205
    v_mfma_f32_16x16x32_bf16 v[178:181], a[120:123], v[146:149], 0
    v_cvt_pk_bf16_f32 v255, v204, v205
    v_xor_b32 v0, 65536, v0
    v_mfma_f32_16x16x32_bf16 v[178:181], a[124:127], v[138:141], v[178:181]
    v_xor_b32 v1, 65536, v1
    v_cvt_pk_f16_f32 v144, v130, v131
    v_mfma_f32_16x16x32_bf16 v[178:181], a[128:131], v[186:189], v[178:181]
    v_pk_fma_f16 v191, v144, v144, v191
    v_cvt_pk_f16_f32 v145, v132, v133
    v_mfma_f32_16x16x32_bf16 v[178:181], a[132:135], v[162:165], v[178:181]
    v_pk_fma_f16 v193, v145, v145, v193
    v_mfma_f32_16x16x32_bf16 v[178:181], a[136:139], v[134:137], v[178:181]
    v_mfma_f32_16x16x32_bf16 v[178:181], a[140:143], v[154:157], v[178:181]
    v_mfma_f32_16x16x32_bf16 v[202:205], a[0:3], v[146:149], 0
    v_mfma_f32_16x16x32_bf16 v[202:205], a[4:7], v[138:141], v[202:205]
    buffer_load_dwordx4 v10, s[8:11], 0 offen nt lds
    s_add_u32 m0, s28, 4096
    v_mfma_f32_16x16x32_bf16 v[202:205], a[8:11], v[186:189], v[202:205]
    v_mfma_f32_16x16x32_bf16 v[202:205], a[12:15], v[162:165], v[202:205]
    v_mfma_f32_16x16x32_bf16 v[202:205], a[16:19], v[134:137], v[202:205]
    v_mfma_f32_16x16x32_bf16 v[202:205], a[20:23], v[154:157], v[202:205]
    v_cvt_pk_f16_f32 v124, v178, v179
    v_pk_fma_f16 v191, v124, v124, v191
    v_mfma_f32_16x16x32_bf16 v[130:133], a[24:27], v[146:149], 0
    buffer_load_dwordx4 v11, s[8:11], 0 offen nt lds
    v_cvt_pk_f16_f32 v125, v180, v181
    v_mfma_f32_16x16x32_bf16 v[130:133], a[28:31], v[138:141], v[130:133]
    s_add_u32 m0, s28, 8192
    v_pk_fma_f16 v193, v125, v125, v193
    v_cvt_pk_f16_f32 v178, v202, v203
    v_mfma_f32_16x16x32_bf16 v[130:133], a[32:35], v[186:189], v[130:133]
    v_pk_mul_f16 v190, v178, v178
    v_cvt_pk_f16_f32 v179, v204, v205
    v_mfma_f32_16x16x32_bf16 v[130:133], a[36:39], v[162:165], v[130:133]
    v_pk_mul_f16 v192, v179, v179
    v_mfma_f32_16x16x32_bf16 v[130:133], a[40:43], v[134:137], v[130:133]
    v_mfma_f32_16x16x32_bf16 v[130:133], a[44:47], v[154:157], v[130:133]
    buffer_load_dwordx4 v12, s[8:11], 0 offen nt lds
    s_add_u32 m0, s28, 12288
    v_mfma_f32_16x16x32_bf16 v[202:205], a[48:51], v[146:149], 0
    s_xor_b32 s28, s28, 65536
    v_mfma_f32_16x16x32_bf16 v[202:205], a[52:55], v[138:141], v[202:205]
    ds_read_b128 v[166:169], v5 offset:0
    ds_read_b128 v[126:129], v5 offset:16
    v_mfma_f32_16x16x32_bf16 v[202:205], a[56:59], v[186:189], v[202:205]
    ds_read_b128 v[210:213], v5 offset:48
    ds_read_b32 v200, v6 offset:192
    v_mfma_f32_16x16x32_bf16 v[202:205], a[60:63], v[162:165], v[202:205]
    v_cvt_pk_f16_f32 v180, v130, v131
    v_pk_fma_f16 v190, v180, v180, v190
    v_mfma_f32_16x16x32_bf16 v[202:205], a[64:67], v[134:137], v[202:205]
    buffer_load_dwordx4 v13, s[8:11], 0 offen nt lds
    v_cvt_pk_f16_f32 v181, v132, v133
    v_mfma_f32_16x16x32_bf16 v[202:205], a[68:71], v[154:157], v[202:205]
    s_mov_b32 m0, s29
    v_pk_fma_f16 v192, v181, v181, v192
    v_add_u32 v5, 336, v5
    v_mfma_f32_16x16x32_bf16 v[130:133], v[146:149], a[144:147], 0
    s_xor_b32 s29, s29, s30
    s_add_u32 s19, s19, s20
    s_add_u32 s23, s23, s21
    v_mfma_f32_16x16x32_bf16 v[130:133], v[138:141], a[148:151], v[130:133]
    s_cmp_ge_u32 s19, 72
    v_cvt_pk_f16_f32 v122, v202, v203
    v_pk_fma_f16 v190, v122, v122, v190
    v_mfma_f32_16x16x32_bf16 v[130:133], v[186:189], a[152:155], v[130:133]
    s_cselect_b32 s34, 72, 0
    v_cvt_pk_f16_f32 v123, v204, v205
    v_pk_fma_f16 v192, v123, v123, v192
    v_mfma_f32_16x16x32_bf16 v[130:133], v[162:165], a[156:159], v[130:133]
    s_waitcnt lgkmcnt(2)
    buffer_store_dwordx2 v[198:199], v19, s[12:15], 0 offen nt
    s_cselect_b32 s35, s22, 0
    s_sub_u32 s19, s19, s34
    v_mfma_f32_16x16x32_f16 v[202:205], v[40:43], v[190:193], 0
    s_add_u32 s23, s23, s35
    s_add_u32 s18, s18, 1
    s_cmp_lt_u32 s18, s17
    v_mfma_f32_16x16x32_f16 v[214:217], v[166:169], v[158:161], v[24:27]
    s_waitcnt lgkmcnt(0)
    v_mfma_f32_16x16x32_f16 v[214:217], v[126:129], v[170:173], v[214:217]
    v_mfma_f32_16x16x32_f16 v[214:217], v[210:213], v[218:221], v[214:217]
    v_mfma_f32_16x16x32_f16 v[190:193], v[166:169], v[206:209], v[22:25]
    v_rsq_f32 v204, v202
    v_mfma_f32_16x16x32_f16 v[190:193], v[126:129], v[118:121], v[190:193]
    v_rsq_f32 v205, v203
    v_mfma_f32_16x16x32_f16 v[190:193], v[210:213], v[194:197], v[190:193]
    v_mul_f32 v204, s31, v204
    v_cvt_pk_f16_f32 v204, v204, v205
    v_mfma_f32_16x16x32_bf16 v[130:133], v[134:137], a[160:163], v[130:133]
    v_pk_mul_f16 v142, v142, v204 op_sel:[0,1] op_sel_hi:[1,1]
    v_pk_mul_f16 v143, v143, v204 op_sel:[0,1] op_sel_hi:[1,1]
    v_mfma_f32_16x16x32_bf16 v[130:133], v[154:157], a[164:167], v[130:133]
    v_pk_mul_f16 v144, v144, v204 op_sel:[0,1] op_sel_hi:[1,1]
    v_pk_mul_f16 v145, v145, v204 op_sel:[0,1] op_sel_hi:[1,1]
    v_mfma_f32_16x16x32_bf16 v[222:225], v[146:149], a[168:171], 0
    v_mov_b32_dpp v200, v191 quad_perm:[0,1,2,3] row_mask:0x1 bank_mask:0xf
    v_mov_b32_dpp v200, v215 quad_perm:[0,1,2,3] row_mask:0x2 bank_mask:0xf
    v_mfma_f32_16x16x32_bf16 v[222:225], v[138:141], a[172:175], v[222:225]
    v_pk_mul_f16 v124, v124, v204 op_sel:[0,1] op_sel_hi:[1,1]
    v_pk_mul_f16 v125, v125, v204 op_sel:[0,1] op_sel_hi:[1,1]
    v_mfma_f32_16x16x32_bf16 v[222:225], v[186:189], a[176:179], v[222:225]
    v_cvt_pk_bf16_f32 v130, v130, v131
    v_cvt_pk_bf16_f32 v131, v132, v133
    v_mfma_f32_16x16x32_bf16 v[222:225], v[162:165], a[180:183], v[222:225]
    v_pk_mul_f16 v178, v178, v204 op_sel:[0,0] op_sel_hi:[1,0]
    v_pk_mul_f16 v179, v179, v204 op_sel:[0,0] op_sel_hi:[1,0]
    v_mfma_f32_16x16x32_f16 v[226:229], v[118:121], v[206:209], v[46:49]
    v_pk_mul_f16 v180, v180, v204 op_sel:[0,0] op_sel_hi:[1,0]
    v_pk_mul_f16 v181, v181, v204 op_sel:[0,0] op_sel_hi:[1,0]
    v_mfma_f32_16x16x32_f16 v[230:233], v[170:173], v[206:209], v[50:53]
    v_pk_mul_f16 v122, v122, v204 op_sel:[0,0] op_sel_hi:[1,0]
    v_pk_mul_f16 v123, v123, v204 op_sel:[0,0] op_sel_hi:[1,0]
    v_mfma_f32_16x16x32_f16 v[234:237], v[142:145], v[206:209], v[54:57]
    v_min3_u32 v44, v44, v202, v203
    v_exp_f32 v214, v214
    v_mfma_f32_16x16x16_f16 v[226:229], v[196:197], v[194:195], v[226:229]
    v_max3_u32 v45, v45, v202, v203
    v_exp_f32 v190, v190
    v_mfma_f32_16x16x16_f16 v[230:233], v[220:221], v[194:195], v[230:233]
    v_cvt_pk_bf16_f32 v39, v190, 0
    v_mfma_f32_16x16x16_f16 v[234:237], v[124:125], v[194:195], v[234:237]
    buffer_store_dwordx4 v[150:153], v15, s[12:15], 0 offen nt
    v_mfma_f32_16x16x32_bf16 v[222:225], v[134:137], a[184:187], v[222:225]
    v_mfma_f32_16x16x32_bf16 v[222:225], v[154:157], a[188:191], v[222:225]
    ds_read_b128 v[206:209], v2 offset:0
    v_mfma_f32_16x16x32_bf16 v[150:153], v[146:149], a[192:195], 0
    ds_read_b128 v[146:149], v2 offset:1024
    v_mfma_f32_16x16x32_bf16 v[150:153], v[138:141], a[196:199], v[150:153]
    ds_read_b128 v[138:141], v2 offset:2048
    v_mfma_f32_16x16x32_bf16 v[150:153], v[186:189], a[200:203], v[150:153]
    ds_read_b128 v[186:189], v2 offset:3072
    v_mfma_f32_16x16x32_bf16 v[150:153], v[162:165], a[204:207], v[150:153]
    ds_read_b128 v[162:165], v2 offset:4096
    v_cvt_pk_bf16_f32 v222, v222, v223
    v_mfma_f32_16x16x32_bf16 v[150:153], v[134:137], a[208:211], v[150:153]
    ds_read_b128 v[134:137], v2 offset:5120
    v_cvt_pk_bf16_f32 v223, v224, v225
    v_mfma_f32_16x16x32_bf16 v[150:153], v[154:157], a[212:215], v[150:153]
    ds_read2_b32 v[132:133], v6 offset0:0 offset1:0
    ds_read2_b32 v[224:225], v6 offset0:16 offset1:16
    v_mfma_f32_16x16x32_f16 v[154:157], v[166:169], v[178:181], v[26:29]
    ds_read2_b32 v[168:169], v6 offset0:32 offset1:32
    v_add_u32 v6, 272, v6
    v_mfma_f32_16x16x32_f16 v[154:157], v[126:129], v[142:145], v[154:157]
    s_waitcnt lgkmcnt(8)
    v_exp_f32 v226, v226
    v_mfma_f32_16x16x32_f16 v[154:157], v[210:213], v[122:125], v[154:157]
    s_waitcnt lgkmcnt(7)
    v_cvt_pk_bf16_f32 v166, v150, v151
    v_cvt_pk_bf16_f32 v167, v152, v153
    v_mfma_f32_16x16x32_bf16 v[150:153], a[216:219], v[206:209], 0
    s_waitcnt lgkmcnt(6)
    v_exp_f32 v227, v227
    v_mfma_f32_16x16x32_bf16 v[150:153], a[220:223], v[146:149], v[150:153]
    s_waitcnt lgkmcnt(5)
    v_exp_f32 v154, v154
    v_mfma_f32_16x16x32_bf16 v[150:153], a[224:227], v[138:141], v[150:153]
    s_waitcnt lgkmcnt(4)
    v_mov_b32_dpp v200, v155 quad_perm:[0,1,2,3] row_mask:0x4 bank_mask:0xf
    v_cvt_pk_bf16_f32 v126, v226, v227
    v_mfma_f32_16x16x32_bf16 v[150:153], a[228:231], v[186:189], v[150:153]
    s_waitcnt lgkmcnt(3)
    v_exp_f32 v200, v200
    v_mfma_f32_16x16x32_bf16 v[150:153], a[232:235], v[162:165], v[150:153]
    s_waitcnt lgkmcnt(1)
    v_exp_f32 v228, v228
    v_mfma_f32_16x16x32_bf16 v[150:153], a[236:239], v[134:137], v[150:153]
    s_waitcnt lgkmcnt(0)
    buffer_store_dwordx2 v[254:255], v18, s[12:15], 0 offen nt
    v_exp_f32 v229, v229
    v_mfma_f32_16x16x32_bf16 v[190:193], a[240:243], v[206:209], 0
    v_cvt_pk_bf16_f32 v200, v200, v200
    v_cvt_pk_bf16_f32 v127, v228, v229
    v_mfma_f32_16x16x32_bf16 v[190:193], a[244:247], v[146:149], v[190:193]
    ds_write_b16 v8, v200
    v_mfma_f32_16x16x32_bf16 v[190:193], a[248:251], v[138:141], v[190:193]
    v_exp_f32 v230, v230
    v_mfma_f32_16x16x32_bf16 v[190:193], a[252:255], v[186:189], v[190:193]
    ds_read_b128 v[198:201], v2 offset:6144
    ds_read_b128 v[210:213], v9
    v_mfma_f32_16x16x32_bf16 v[190:193], v[82:85], v[162:165], v[190:193]
    ds_read_b128 v[226:229], v2 offset:7168
    ds_read_b128 v[238:241], v9 offset:64
    v_mfma_f32_16x16x32_bf16 v[190:193], v[86:89], v[134:137], v[190:193]
    v_exp_f32 v231, v231
    v_mfma_f32_16x16x32_bf16 v[202:205], v[90:93], v[206:209], 0
    ds_read_b128 v[206:209], v2 offset:8192
    ds_read_b128 v[242:245], v2 offset:9216
    v_mfma_f32_16x16x32_bf16 v[202:205], v[94:97], v[146:149], v[202:205]
    v_cvt_pk_bf16_f32 v128, v230, v231
    v_fma_f32 v254, v150, v150, s33
    v_mfma_f32_16x16x32_bf16 v[202:205], v[98:101], v[138:141], v[202:205]
    ds_read_b128 v[146:149], v2 offset:10240
    ds_read_b128 v[138:141], v2 offset:11264
    v_mfma_f32_16x16x32_bf16 v[202:205], v[102:105], v[186:189], v[202:205]
    v_exp_f32 v232, v232
    v_mfma_f32_16x16x32_bf16 v[202:205], v[106:109], v[162:165], v[202:205]
    v_exp_f32 v233, v233
    v_mfma_f32_16x16x32_bf16 v[202:205], v[110:113], v[134:137], v[202:205]
    s_waitcnt lgkmcnt(6)
    v_cvt_pk_bf16_f32 v129, v232, v233
    v_fmac_f32 v254, v151, v151
    v_mfma_f32_16x16x32_bf16 v[186:189], v[210:213], v[28:31], 0
    s_waitcnt lgkmcnt(4)
    v_exp_f32 v234, v234
    v_mfma_f32_16x16x32_bf16 v[186:189], v[238:241], v[28:31], v[186:189]
    v_exp_f32 v235, v235
    v_mfma_f32_16x16x32_f16 v[134:137], v[118:121], v[158:161], v[58:61]
    s_waitcnt lgkmcnt(2)
    v_cvt_pk_bf16_f32 v36, v234, v235
    v_fmac_f32 v254, v152, v152
    v_mfma_f32_16x16x32_f16 v[162:165], v[170:173], v[158:161], v[62:65]
    v_exp_f32 v236, v236
    v_mfma_f32_16x16x32_f16 v[230:233], v[142:145], v[158:161], v[66:69]
    s_waitcnt lgkmcnt(0)
    buffer_load_dwordx4 v14, s[8:11], 0 offen nt lds
    v_rcp_f32 v186, v186
    v_mfma_f32_16x16x16_f16 v[134:137], v[196:197], v[218:219], v[134:137]
    v_exp_f32 v237, v237
    v_fmac_f32 v254, v153, v153
    v_mfma_f32_16x16x16_f16 v[162:165], v[220:221], v[218:219], v[162:165]
    v_cvt_pk_bf16_f32 v37, v236, v237
    v_fmac_f32 v254, v190, v190
    v_fmac_f32 v254, v191, v191
    v_mfma_f32_16x16x16_f16 v[230:233], v[124:125], v[218:219], v[230:233]
    v_fmac_f32 v254, v192, v192
    v_exp_f32 v134, v134
    v_fmac_f32 v254, v193, v193
    v_mfma_f32_16x16x32_bf16 v[158:161], v[210:213], v[174:177], 0
    v_exp_f32 v135, v135
    v_mfma_f32_16x16x32_bf16 v[158:161], v[238:241], v[130:133], v[158:161]
    v_cvt_pk_bf16_f32 v134, v134, v135
    v_fmac_f32 v254, v202, v202
    v_mfma_f32_16x16x32_bf16 v[234:237], v[210:213], v[182:185], 0
    v_exp_f32 v136, v136
    v_mfma_f32_16x16x32_bf16 v[234:237], v[238:241], v[222:225], v[234:237]
    v_exp_f32 v137, v137
    v_mfma_f32_16x16x32_bf16 v[246:249], v[210:213], v[114:117], 0
    v_cvt_pk_bf16_f32 v135, v136, v137
    v_mul_f32 v158, v158, v186
    v_mfma_f32_16x16x32_bf16 v[246:249], v[238:241], v[166:169], v[246:249]
    v_exp_f32 v162, v162
    v_mfma_f32_16x16x32_bf16 v[210:213], v[28:31], v[36:39], 0
    v_exp_f32 v163, v163
    v_mfma_f32_16x16x32_bf16 v[210:213], v[28:31], v[126:129], v[210:213]
    v_cvt_pk_bf16_f32 v136, v162, v163
    v_mul_f32_dpp v158, v234, v186 quad_perm:[0,1,2,3] row_mask:0x2 bank_mask:0xf
    v_mfma_f32_16x16x32_bf16 v[234:237], v[130:133], v[36:39], 0
    v_exp_f32 v164, v164
    v_mfma_f32_16x16x32_bf16 v[234:237], v[174:177], v[126:129], v[234:237]
    v_exp_f32 v165, v165
    v_mfma_f32_16x16x32_bf16 v[238:241], v[222:225], v[36:39], 0
    v_cvt_pk_bf16_f32 v137, v164, v165
    v_mul_f32_dpp v158, v246, v186 quad_perm:[0,1,2,3] row_mask:0x4 bank_mask:0xf
    v_mfma_f32_16x16x32_bf16 v[238:241], v[182:185], v[126:129], v[238:241]
    v_exp_f32 v230, v230
    v_mfma_f32_16x16x32_bf16 v[186:189], v[166:169], v[36:39], 0
    v_exp_f32 v231, v231
    v_mfma_f32_16x16x32_bf16 v[186:189], v[114:117], v[126:129], v[186:189]
    v_cvt_pk_bf16_f32 v36, v230, v231
    v_cvt_pk_bf16_f32 v39, v214, 0
    v_mfma_f32_16x16x32_f16 v[162:165], v[118:121], v[178:181], v[70:73]
    v_exp_f32 v232, v232
    v_mfma_f32_16x16x32_f16 v[118:121], v[170:173], v[178:181], v[74:77]
    v_exp_f32 v233, v233
    v_mfma_f32_16x16x32_f16 v[170:173], v[142:145], v[178:181], v[78:81]
    v_cvt_pk_bf16_f32 v37, v232, v233
    v_cvt_pk_bf16_f32 v158, v158, v158
    v_fmac_f32 v254, v203, v203
    v_mfma_f32_16x16x16_f16 v[162:165], v[196:197], v[122:123], v[162:165]
    v_rcp_f32 v210, v210
    v_fmac_f32 v254, v204, v204
    v_mfma_f32_16x16x16_f16 v[118:121], v[220:221], v[122:123], v[118:121]
    v_mul_f32 v234, v210, v234
    v_mul_f32 v235, v210, v235
    v_cvt_pk_bf16_f32 v178, v234, v235
    v_mfma_f32_16x16x16_f16 v[170:173], v[124:125], v[122:123], v[170:173]
    v_mul_f32 v236, v210, v236
    v_exp_f32 v162, v162
    v_mul_f32 v237, v210, v237
    v_mfma_f32_16x16x32_bf16 v[194:197], v[28:31], v[36:39], 0
    ds_write_b16 v7, v158
    v_mfma_f32_16x16x32_bf16 v[194:197], v[28:31], v[134:137], v[194:197]
    v_exp_f32 v163, v163
    v_mfma_f32_16x16x32_bf16 v[122:125], v[130:133], v[36:39], 0
    v_cvt_pk_bf16_f32 v162, v162, v163
    v_cvt_pk_bf16_f32 v179, v236, v237
    v_mfma_f32_16x16x32_bf16 v[122:125], v[174:177], v[134:137], v[122:125]
    v_exp_f32 v164, v164
    v_mfma_f32_16x16x32_bf16 v[126:129], v[222:225], v[36:39], 0
    v_exp_f32 v165, v165
    v_mfma_f32_16x16x32_bf16 v[126:129], v[182:185], v[134:137], v[126:129]
    v_cvt_pk_bf16_f32 v163, v164, v165
    v_mul_f32 v238, v210, v238
    v_mfma_f32_16x16x32_bf16 v[218:221], v[166:169], v[36:39], 0
    v_exp_f32 v118, v118
    v_mfma_f32_16x16x32_bf16 v[218:221], v[114:117], v[134:137], v[218:221]
    v_exp_f32 v119, v119
    v_mfma_f32_16x16x32_bf16 v[142:145], a[216:219], v[198:201], 0
    v_cvt_pk_bf16_f32 v164, v118, v119
    v_cvt_pk_bf16_f32 v39, v154, 0
    v_mfma_f32_16x16x32_bf16 v[142:145], a[220:223], v[226:229], v[142:145]
    v_exp_f32 v120, v120
    v_mfma_f32_16x16x32_bf16 v[142:145], a[224:227], v[206:209], v[142:145]
    v_exp_f32 v121, v121
    v_mfma_f32_16x16x32_bf16 v[142:145], a[228:231], v[242:245], v[142:145]
    v_cvt_pk_bf16_f32 v165, v120, v121
    v_mul_f32 v239, v210, v239
    v_mfma_f32_16x16x32_bf16 v[142:145], a[232:235], v[146:149], v[142:145]
    v_exp_f32 v170, v170
    v_mfma_f32_16x16x32_bf16 v[142:145], a[236:239], v[138:141], v[142:145]
    v_exp_f32 v171, v171
    v_mfma_f32_16x16x32_bf16 v[158:161], a[240:243], v[198:201], 0
    v_cvt_pk_bf16_f32 v36, v170, v171
    v_cvt_pk_bf16_f32 v180, v238, v239
    v_mfma_f32_16x16x32_bf16 v[158:161], a[244:247], v[226:229], v[158:161]
    v_exp_f32 v172, v172
    v_mfma_f32_16x16x32_bf16 v[158:161], a[248:251], v[206:209], v[158:161]
    v_exp_f32 v173, v173
    v_mfma_f32_16x16x32_bf16 v[158:161], a[252:255], v[242:245], v[158:161]
    ds_read_b128 v[118:121], v2 offset:12288
    v_cvt_pk_bf16_f32 v37, v172, v173
    v_mfma_f32_16x16x32_bf16 v[158:161], v[82:85], v[146:149], v[158:161]
    ds_read_b128 v[134:137], v2 offset:13312
    v_mul_f32 v240, v210, v240
    v_mfma_f32_16x16x32_bf16 v[170:173], v[28:31], v[36:39], 0
    v_mul_f32 v241, v210, v241
    v_cvt_pk_bf16_f32 v181, v240, v241
    v_mfma_f32_16x16x32_bf16 v[170:173], v[28:31], v[162:165], v[170:173]
    ds_write_b128 v3, v[178:181] offset:0
    v_mfma_f32_16x16x32_bf16 v[154:157], v[130:133], v[36:39], 0
    v_mul_f32 v186, v210, v186
    v_mul_f32 v187, v210, v187
    v_mfma_f32_16x16x32_bf16 v[154:157], v[174:177], v[162:165], v[154:157]
    v_cvt_pk_bf16_f32 v186, v186, v187
    v_mul_f32 v188, v210, v188
    v_mfma_f32_16x16x32_bf16 v[130:133], v[222:225], v[36:39], 0
    v_mul_f32 v189, v210, v189
    v_cvt_pk_bf16_f32 v187, v188, v189
    v_mfma_f32_16x16x32_bf16 v[130:133], v[182:185], v[162:165], v[130:133]
    s_waitcnt lgkmcnt(2)
    ds_write_b64 v4, v[186:187] offset:4096
    v_mfma_f32_16x16x32_bf16 v[174:177], v[166:169], v[36:39], 0
    s_waitcnt lgkmcnt(2)
    v_fma_f32 v255, v142, v142, s33
    v_fmac_f32 v255, v143, v143
    v_mfma_f32_16x16x32_bf16 v[174:177], v[114:117], v[162:165], v[174:177]
    v_fmac_f32 v255, v144, v144
    v_fmac_f32 v255, v145, v145
    v_mfma_f32_16x16x32_bf16 v[158:161], v[86:89], v[138:141], v[158:161]
    ds_read_b128 v[114:117], v2 offset:14336
    v_fmac_f32 v254, v205, v205
    v_mfma_f32_16x16x32_bf16 v[178:181], v[90:93], v[198:201], 0
    ds_read_b128 v[166:169], v2 offset:15360
    v_add_u32 v7, 16, v7
    v_mfma_f32_16x16x32_bf16 v[178:181], v[94:97], v[226:229], v[178:181]
    ds_read_b128 v[162:165], v2 offset:16384
    v_mfma_f32_16x16x32_bf16 v[178:181], v[98:101], v[206:209], v[178:181]
    ds_read_b128 v[206:209], v2 offset:17408
    v_fmac_f32 v255, v158, v158
    v_mfma_f32_16x16x32_bf16 v[178:181], v[102:105], v[242:245], v[178:181]
    v_fmac_f32 v255, v159, v159
    v_fmac_f32 v255, v160, v160
    v_mfma_f32_16x16x32_bf16 v[178:181], v[106:109], v[146:149], v[178:181]
    v_fmac_f32 v255, v161, v161
    v_xor_b32 v2, 65536, v2
    v_mfma_f32_16x16x32_bf16 v[178:181], v[110:113], v[138:141], v[178:181]
    v_rcp_f32 v170, v170
    v_mfma_f32_16x16x32_bf16 v[146:149], a[216:219], v[118:121], 0
    v_mul_f32 v154, v170, v154
    v_mul_f32 v155, v170, v155
    v_mfma_f32_16x16x32_bf16 v[146:149], a[220:223], v[134:137], v[146:149]
    s_waitcnt lgkmcnt(3)
    ds_read_b128 v[182:185], v0 offset:20480
    v_cvt_pk_bf16_f32 v154, v154, v155
    v_mfma_f32_16x16x32_bf16 v[146:149], a[224:227], v[114:117], v[146:149]
    s_waitcnt lgkmcnt(3)
    ds_read_b128 v[198:201], v1 offset:20480
    v_fmac_f32 v255, v178, v178
    v_mfma_f32_16x16x32_bf16 v[146:149], a[228:231], v[166:169], v[146:149]
    s_waitcnt lgkmcnt(3)
    ds_read_b128 v[210:213], v0 offset:20608
    v_fmac_f32 v255, v179, v179
    v_mfma_f32_16x16x32_bf16 v[146:149], a[232:235], v[162:165], v[146:149]
    s_waitcnt lgkmcnt(3)
    ds_read_b128 v[222:225], v1 offset:20608
    v_fmac_f32 v255, v180, v180
    v_mfma_f32_16x16x32_bf16 v[146:149], a[236:239], v[206:209], v[146:149]
    ds_read_b128 v[226:229], v0 offset:20736
    v_fmac_f32 v255, v181, v181
    v_mfma_f32_16x16x32_bf16 v[138:141], a[240:243], v[118:121], 0
    ds_read_b128 v[242:245], v1 offset:20736
    v_cvt_pk_bf16_f32 v254, v254, v255
    v_mfma_f32_16x16x32_bf16 v[138:141], a[244:247], v[134:137], v[138:141]
    v_mul_f32 v156, v170, v156
    v_mul_f32 v157, v170, v157
    v_mfma_f32_16x16x32_bf16 v[138:141], a[248:251], v[114:117], v[138:141]
    v_fma_f32 v255, v146, v146, s33
    v_fmac_f32 v255, v147, v147
    v_mfma_f32_16x16x32_bf16 v[138:141], a[252:255], v[166:169], v[138:141]
    s_waitcnt lgkmcnt(5)
    v_fmac_f32 v255, v148, v148
    v_fmac_f32 v255, v149, v149
    v_mfma_f32_16x16x32_bf16 v[138:141], v[82:85], v[162:165], v[138:141]
    s_waitcnt lgkmcnt(4)
    v_cvt_pk_bf16_f32 v155, v156, v157
    v_mul_f32 v130, v170, v130
    v_mfma_f32_16x16x32_bf16 v[138:141], v[86:89], v[206:209], v[138:141]
    s_waitcnt lgkmcnt(3)
    v_mul_f32 v131, v170, v131
    v_cvt_pk_bf16_f32 v156, v130, v131
    v_mfma_f32_16x16x32_bf16 v[186:189], v[90:93], v[118:121], 0
    s_waitcnt lgkmcnt(2)
    v_mul_f32 v132, v170, v132
    v_mul_f32 v133, v170, v133
    v_mfma_f32_16x16x32_bf16 v[186:189], v[94:97], v[134:137], v[186:189]
    s_waitcnt lgkmcnt(1)
    v_fmac_f32 v255, v138, v138
    v_fmac_f32 v255, v139, v139
    v_mfma_f32_16x16x32_bf16 v[186:189], v[98:101], v[114:117], v[186:189]
    s_waitcnt lgkmcnt(0)
    v_fmac_f32 v255, v140, v140
    v_fmac_f32 v255, v141, v141
    v_mfma_f32_16x16x32_bf16 v[186:189], v[102:105], v[166:169], v[186:189]
    v_cvt_pk_bf16_f32 v157, v132, v133
    v_mul_f32 v174, v170, v174
    v_mfma_f32_16x16x32_bf16 v[186:189], v[106:109], v[162:165], v[186:189]
    ds_write_b128 v3, v[154:157] offset:12288
    v_mfma_f32_16x16x32_bf16 v[186:189], v[110:113], v[206:209], v[186:189]
    v_mul_f32 v175, v170, v175
    v_cvt_pk_bf16_f32 v174, v174, v175
    v_mfma_f32_16x16x32_bf16 v[118:121], a[72:75], v[182:185], 0
    v_mul_f32 v176, v170, v176
    v_mul_f32 v177, v170, v177
    v_mfma_f32_16x16x32_bf16 v[118:121], a[76:79], v[198:201], v[118:121]
    v_rcp_f32 v194, v194
    v_mfma_f32_16x16x32_bf16 v[118:121], a[80:83], v[210:213], v[118:121]
    v_fmac_f32 v255, v186, v186
    v_fmac_f32 v255, v187, v187
    v_mfma_f32_16x16x32_bf16 v[118:121], a[84:87], v[222:225], v[118:121]
    v_fmac_f32 v255, v188, v188
    v_fmac_f32 v255, v189, v189
    v_mfma_f32_16x16x32_bf16 v[118:121], a[88:91], v[226:229], v[118:121]
    v_cvt_pk_bf16_f32 v255, v255, v255
    v_cvt_pk_bf16_f32 v175, v176, v177
    v_mfma_f32_16x16x32_bf16 v[118:121], a[92:95], v[242:245], v[118:121]
    ds_write_b64 v4, v[174:175] offset:16384
    v_mfma_f32_16x16x32_bf16 v[206:209], a[96:99], v[182:185], 0
    v_mul_f32 v122, v194, v122
    v_mul_f32 v123, v194, v123
    v_mfma_f32_16x16x32_bf16 v[206:209], a[100:103], v[198:201], v[206:209]
    ds_write_b64 v4, v[254:255] offset:18432
    v_mfma_f32_16x16x32_bf16 v[206:209], a[104:107], v[210:213], v[206:209]
    v_cvt_pk_bf16_f32 v134, v122, v123
    v_cvt_pk_f16_f32 v118, v118, v119
    v_mfma_f32_16x16x32_bf16 v[206:209], a[108:111], v[222:225], v[206:209]
    v_pk_mul_f16 v163, v118, v118
    v_cvt_pk_f16_f32 v119, v120, v121
    v_mfma_f32_16x16x32_bf16 v[206:209], a[112:115], v[226:229], v[206:209]
    v_pk_mul_f16 v165, v119, v119
    v_mul_f32 v124, v194, v124
    v_mfma_f32_16x16x32_bf16 v[206:209], a[116:119], v[242:245], v[206:209]
    v_mul_f32 v125, v194, v125
    v_cvt_pk_bf16_f32 v135, v124, v125
    v_mfma_f32_16x16x32_bf16 v[122:125], a[120:123], v[182:185], 0
    v_mul_f32 v126, v194, v126
    v_mul_f32 v127, v194, v127
    v_mfma_f32_16x16x32_bf16 v[122:125], a[124:127], v[198:201], v[122:125]
    v_cvt_pk_bf16_f32 v136, v126, v127
    v_mul_f32 v128, v194, v128
    v_mfma_f32_16x16x32_bf16 v[122:125], a[128:131], v[210:213], v[122:125]
    v_cvt_pk_f16_f32 v120, v206, v207
    v_pk_fma_f16 v163, v120, v120, v163
    v_mfma_f32_16x16x32_bf16 v[122:125], a[132:135], v[222:225], v[122:125]
    v_cvt_pk_f16_f32 v121, v208, v209
    v_pk_fma_f16 v165, v121, v121, v165
    v_mfma_f32_16x16x32_bf16 v[122:125], a[136:139], v[226:229], v[122:125]
    v_mul_f32 v129, v194, v129
    v_cvt_pk_bf16_f32 v137, v128, v129
    v_mfma_f32_16x16x32_bf16 v[122:125], a[140:143], v[242:245], v[122:125]
    ds_write_b128 v3, v[134:137] offset:6144
    v_mfma_f32_16x16x32_bf16 v[206:209], a[0:3], v[182:185], 0
    v_mul_f32 v218, v194, v218
    v_mul_f32 v219, v194, v219
    v_mfma_f32_16x16x32_bf16 v[206:209], a[4:7], v[198:201], v[206:209]
    v_cvt_pk_bf16_f32 v254, v218, v219
    v_mul_f32 v220, v194, v220
    v_mfma_f32_16x16x32_bf16 v[206:209], a[8:11], v[210:213], v[206:209]
    v_cvt_pk_f16_f32 v196, v122, v123
    v_pk_fma_f16 v163, v196, v196, v163
    v_mfma_f32_16x16x32_bf16 v[206:209], a[12:15], v[222:225], v[206:209]
    v_cvt_pk_f16_f32 v197, v124, v125
    v_pk_fma_f16 v165, v197, v197, v165
    v_mfma_f32_16x16x32_bf16 v[206:209], a[16:19], v[226:229], v[206:209]
    v_mul_f32 v221, v194, v221
    v_cvt_pk_bf16_f32 v255, v220, v221
    v_mfma_f32_16x16x32_bf16 v[206:209], a[20:23], v[242:245], v[206:209]
    ds_write_b64 v4, v[254:255] offset:10240
    v_mfma_f32_16x16x32_bf16 v[174:177], a[24:27], v[182:185], 0
    v_xor_b32 v3, 65536, v3
    v_xor_b32 v4, 65536, v4
    v_mfma_f32_16x16x32_bf16 v[174:177], a[28:31], v[198:201], v[174:177]
    v_mfma_f32_16x16x32_bf16 v[174:177], a[32:35], v[210:213], v[174:177]
    v_mfma_f32_16x16x32_bf16 v[174:177], a[36:39], v[222:225], v[174:177]
    v_mfma_f32_16x16x32_bf16 v[174:177], a[40:43], v[226:229], v[174:177]
    v_cvt_pk_f16_f32 v206, v206, v207
    v_mfma_f32_16x16x32_bf16 v[174:177], a[44:47], v[242:245], v[174:177]
    v_mfma_f32_16x16x32_bf16 v[218:221], a[48:51], v[182:185], 0
    s_waitcnt lgkmcnt(0)
    v_mfma_f32_16x16x32_bf16 v[218:221], a[52:55], v[198:201], v[218:221]
    s_nop 0
    v_mfma_f32_16x16x32_bf16 v[218:221], a[56:59], v[210:213], v[218:221]
    s_nop 0
    v_mfma_f32_16x16x32_bf16 v[218:221], a[60:63], v[222:225], v[218:221]
    s_nop 0
    v_mfma_f32_16x16x32_bf16 v[218:221], a[64:67], v[226:229], v[218:221]
    s_barrier
    v_mfma_f32_16x16x32_bf16 v[218:221], a[68:71], v[242:245], v[218:221]
    v_mfma_f32_16x16x32_bf16 v[170:173], v[182:185], a[144:147], 0
    v_mfma_f32_16x16x32_bf16 v[170:173], v[198:201], a[148:151], v[170:173]
    v_mfma_f32_16x16x32_bf16 v[170:173], v[210:213], a[152:155], v[170:173]
    v_mfma_f32_16x16x32_bf16 v[170:173], v[222:225], a[156:159], v[170:173]
    v_mfma_f32_16x16x32_bf16 v[170:173], v[226:229], a[160:163], v[170:173]
    v_mfma_f32_16x16x32_bf16 v[170:173], v[242:245], a[164:167], v[170:173]
    s_cbranch_scc1 L_loop_fast3
L_drain:
    ds_read_b128 v[114:117], v2 offset:18432
    ds_read_b128 v[118:121], v2 offset:19456
    ds_read_b128 v[122:125], v2 offset:0
    s_mul_i32 s5, s16, 8064
    s_mov_b32 s12, s42
    ds_read_b128 v[126:129], v2 offset:1024
    s_mov_b32 s13, s43
    s_cmp_ge_u32 s18, 2
    s_cselect_b32 s14, s36, 0
    ds_read_b128 v[130:133], v2 offset:2048
    s_add_u32 s5, s5, 104448
    s_lshl_b32 s3, s16, 6
    s_lshl_b32 s4, s16, 5
    ds_read_b128 v[134:137], v2 offset:3072
    s_add_u32 s4, s4, 256
    ds_read_b128 v[154:157], v2 offset:4096
    ds_read_b128 v[162:165], v2 offset:5120
    v_bfe_u32 v254, v2, 4, 6
    v_lshrrev_b32 v255, 4, v254
    v_and_b32 v166, 15, v254
    v_lshlrev_b32 v167, 9, v255
    v_lshl_add_u32 v167, v166, 4, v167
    v_add_u32 v167, 136704, v167
    s_waitcnt lgkmcnt(7)
    v_mfma_f32_16x16x32_bf16 v[170:173], v[32:35], v[114:117], 0
    s_waitcnt lgkmcnt(5)
    v_xor_b32 v168, 65536, v2
    v_bfe_u32 v169, v166, 1, 2
    v_mfma_f32_16x16x32_bf16 v[170:173], v[32:35], v[118:121], v[170:173]
    s_waitcnt lgkmcnt(4)
    v_xor_b32 v169, v169, v255
    v_lshl_add_u32 v169, v166, 2, v169
    v_lshl_add_u32 v114, v169, 4, s5
    v_mfma_f32_16x16x32_bf16 v[118:121], a[216:219], v[122:125], 0
    s_waitcnt lgkmcnt(3)
    v_lshl_add_u32 v115, v169, 3, s5
    v_lshl_add_u32 v116, v254, 4, s5
    v_lshl_add_u32 v117, v254, 3, s5
    v_mfma_f32_16x16x32_bf16 v[118:121], a[220:223], v[126:129], v[118:121]
    s_waitcnt lgkmcnt(2)
    v_lshlrev_b32 v169, 2, v169
    v_mul_f32 v170, 0x3baaaaab, v170
    v_rsq_f32 v170, v170
    v_mfma_f32_16x16x32_bf16 v[118:121], a[224:227], v[130:133], v[118:121]
    s_waitcnt lgkmcnt(0)
    ds_permute_b32 v173, v169, v15
    ds_permute_b32 v174, v169, v18
    v_mul_f32 v150, v170, v150
    v_mfma_f32_16x16x32_bf16 v[118:121], a[228:231], v[134:137], v[118:121]
    ds_permute_b32 v175, v169, v16
    ds_permute_b32 v176, v169, v19
    v_mul_f32 v151, v170, v151
    v_mfma_f32_16x16x32_bf16 v[118:121], a[232:235], v[154:157], v[118:121]
    ds_permute_b32 v177, v169, v17
    ds_permute_b32 v182, v169, v20
    v_cvt_pk_bf16_f32 v150, v150, v151
    v_mfma_f32_16x16x32_bf16 v[118:121], a[236:239], v[162:165], v[118:121]
    v_mul_f32 v152, v170, v152
    v_mul_f32 v153, v170, v153
    v_cvt_pk_bf16_f32 v151, v152, v153
    v_mfma_f32_16x16x32_bf16 v[194:197], a[240:243], v[122:125], 0
    v_mul_f32 v190, v170, v190
    v_mul_f32 v191, v170, v191
    v_cvt_pk_bf16_f32 v152, v190, v191
    v_mfma_f32_16x16x32_bf16 v[194:197], a[244:247], v[126:129], v[194:197]
    v_mul_f32 v192, v170, v192
    v_mul_f32 v193, v170, v193
    v_cvt_pk_bf16_f32 v153, v192, v193
    v_mfma_f32_16x16x32_bf16 v[194:197], a[248:251], v[130:133], v[194:197]
    s_waitcnt lgkmcnt(4)
    ds_read_b128 v[190:193], v2 offset:6144
    v_mul_f32 v202, v170, v202
    v_mul_f32 v203, v170, v203
    v_mfma_f32_16x16x32_bf16 v[194:197], a[252:255], v[134:137], v[194:197]
    s_waitcnt lgkmcnt(3)
    ds_read_b128 v[198:201], v2 offset:7168
    v_cvt_pk_bf16_f32 v184, v202, v203
    v_mul_f32 v204, v170, v204
    v_mfma_f32_16x16x32_bf16 v[194:197], v[82:85], v[154:157], v[194:197]
    s_waitcnt lgkmcnt(2)
    ds_read_b128 v[206:209], v2 offset:8192
    v_mul_f32 v205, v170, v205
    v_cvt_pk_bf16_f32 v185, v204, v205
    v_mfma_f32_16x16x32_bf16 v[194:197], v[86:89], v[162:165], v[194:197]
    ds_read_b128 v[202:205], v2 offset:9216
    v_fma_f32 v169, v118, v118, s33
    v_fmac_f32 v169, v119, v119
    v_mfma_f32_16x16x32_bf16 v[210:213], v[90:93], v[122:125], 0
    ds_read_b128 v[122:125], v2 offset:10240
    v_fmac_f32 v169, v120, v120
    v_fmac_f32 v169, v121, v121
    v_mfma_f32_16x16x32_bf16 v[210:213], v[94:97], v[126:129], v[210:213]
    ds_read_b128 v[126:129], v2 offset:11264
    v_fmac_f32 v169, v194, v194
    v_fmac_f32 v169, v195, v195
    v_mfma_f32_16x16x32_bf16 v[210:213], v[98:101], v[130:133], v[210:213]
    s_waitcnt lgkmcnt(5)
    buffer_store_dwordx4 v[150:153], v15, s[12:15], s27 offen nt
    v_fmac_f32 v169, v196, v196
    v_fmac_f32 v169, v197, v197
    v_mul_f32 v183, 0x3baaaaab, v171
    v_mfma_f32_16x16x32_bf16 v[210:213], v[102:105], v[134:137], v[210:213]
    s_waitcnt lgkmcnt(4)
    v_rsq_f32 v183, v183
    v_subrev_u32 v170, 0x3d800000, v44
    v_mfma_f32_16x16x32_bf16 v[210:213], v[106:109], v[154:157], v[210:213]
    s_waitcnt lgkmcnt(3)
    v_mul_f32 v142, v183, v142
    v_mul_f32 v143, v183, v143
    v_cvt_pk_bf16_f32 v130, v142, v143
    v_mfma_f32_16x16x32_bf16 v[210:213], v[110:113], v[162:165], v[210:213]
    s_waitcnt lgkmcnt(2)
    v_mul_f32 v144, v183, v144
    v_mul_f32 v145, v183, v145
    v_cvt_pk_bf16_f32 v131, v144, v145
    v_mfma_f32_16x16x32_bf16 v[134:137], a[216:219], v[190:193], 0
    s_waitcnt lgkmcnt(1)
    v_mul_f32 v158, v183, v158
    v_mul_f32 v159, v183, v159
    v_fmac_f32 v169, v210, v210
    v_mfma_f32_16x16x32_bf16 v[134:137], a[220:223], v[198:201], v[134:137]
    s_waitcnt lgkmcnt(0)
    v_fmac_f32 v169, v211, v211
    v_fmac_f32 v169, v212, v212
    v_fmac_f32 v169, v213, v213
    v_mfma_f32_16x16x32_bf16 v[134:137], a[224:227], v[206:209], v[134:137]
    v_cvt_pk_bf16_f32 v132, v158, v159
    v_mul_f32 v160, v183, v160
    v_mul_f32 v161, v183, v161
    v_mfma_f32_16x16x32_bf16 v[134:137], a[228:231], v[202:205], v[134:137]
    v_cvt_pk_bf16_f32 v133, v160, v161
    v_mul_f32 v178, v183, v178
    v_mul_f32 v179, v183, v179
    v_mfma_f32_16x16x32_bf16 v[134:137], a[232:235], v[122:125], v[134:137]
    v_cvt_pk_bf16_f32 v178, v178, v179
    v_mul_f32 v180, v183, v180
    v_mul_f32 v181, v183, v181
    v_mfma_f32_16x16x32_bf16 v[134:137], a[236:239], v[126:129], v[134:137]
    v_cvt_pk_bf16_f32 v179, v180, v181
    v_sub_u32 v183, 0x4a000000, v45
    v_or3_b32 v170, v170, v183, v45
    v_mfma_f32_16x16x32_bf16 v[142:145], a[240:243], v[190:193], 0
    v_lshl_add_u32 v183, s16, 2, v168
    v_mul_f32 v180, 0x3baaaaab, v172
    v_rsq_f32 v180, v180
    v_mfma_f32_16x16x32_bf16 v[142:145], a[244:247], v[198:201], v[142:145]
    ds_write_b32 v183, v170 offset:18432
    v_fma_f32 v181, v134, v134, s33
    v_mfma_f32_16x16x32_bf16 v[142:145], a[248:251], v[206:209], v[142:145]
    v_fmac_f32 v181, v135, v135
    v_fmac_f32 v181, v136, v136
    v_fmac_f32 v181, v137, v137
    v_mfma_f32_16x16x32_bf16 v[142:145], a[252:255], v[202:205], v[142:145]
    ds_read_b128 v[150:153], v2 offset:12288
    ds_read_b128 v[154:157], v2 offset:13312
    v_mul_f32 v146, v180, v146
    v_mfma_f32_16x16x32_bf16 v[142:145], v[82:85], v[122:125], v[142:145]
    ds_read_b128 v[158:161], v2 offset:14336
    v_mul_f32 v147, v180, v147
    v_cvt_pk_bf16_f32 v146, v146, v147
    v_mfma_f32_16x16x32_bf16 v[142:145], v[86:89], v[126:129], v[142:145]
    ds_read_b128 v[162:165], v2 offset:15360
    v_mul_f32 v148, v180, v148
    v_mul_f32 v149, v180, v149
    v_mfma_f32_16x16x32_bf16 v[214:217], v[90:93], v[190:193], 0
    ds_read_b128 v[190:193], v2 offset:16384
    v_cvt_pk_bf16_f32 v147, v148, v149
    v_mul_f32 v138, v180, v138
    v_mfma_f32_16x16x32_bf16 v[214:217], v[94:97], v[198:201], v[214:217]
    ds_read_b128 v[198:201], v2 offset:17408
    v_fmac_f32 v181, v142, v142
    v_fmac_f32 v181, v143, v143
    v_mfma_f32_16x16x32_bf16 v[214:217], v[98:101], v[206:209], v[214:217]
    buffer_store_dwordx2 v[184:185], v18, s[12:15], s27 offen nt
    v_fmac_f32 v181, v144, v144
    v_mfma_f32_16x16x32_bf16 v[214:217], v[102:105], v[202:205], v[214:217]
    s_waitcnt lgkmcnt(4)
    v_fmac_f32 v181, v145, v145
    v_mul_f32 v139, v180, v139
    v_cvt_pk_bf16_f32 v148, v138, v139
    v_mfma_f32_16x16x32_bf16 v[214:217], v[106:109], v[122:125], v[214:217]
    s_waitcnt lgkmcnt(3)
    v_mul_f32 v140, v180, v140
    v_mul_f32 v141, v180, v141
    v_cvt_pk_bf16_f32 v149, v140, v141
    v_mfma_f32_16x16x32_bf16 v[214:217], v[110:113], v[126:129], v[214:217]
    s_waitcnt lgkmcnt(2)
    ds_write_b128 v114, v[146:149] offset:3072
    v_mfma_f32_16x16x32_bf16 v[122:125], a[216:219], v[150:153], 0
    s_waitcnt lgkmcnt(2)
    v_mul_f32 v186, v180, v186
    v_mul_f32 v187, v180, v187
    v_cvt_pk_bf16_f32 v186, v186, v187
    v_mfma_f32_16x16x32_bf16 v[122:125], a[220:223], v[154:157], v[122:125]
    s_waitcnt lgkmcnt(1)
    v_fmac_f32 v181, v214, v214
    v_fmac_f32 v181, v215, v215
    v_fmac_f32 v181, v216, v216
    v_mfma_f32_16x16x32_bf16 v[122:125], a[224:227], v[158:161], v[122:125]
    ds_read_b128 v[126:129], v116 offset:3072
    v_fmac_f32 v181, v217, v217
    v_cvt_pk_bf16_f32 v170, v169, v181
    v_mfma_f32_16x16x32_bf16 v[122:125], a[228:231], v[162:165], v[122:125]
    v_cvt_pk_bf16_f32 v171, v181, v181
    v_mul_f32 v188, v180, v188
    v_mul_f32 v189, v180, v189
    v_mfma_f32_16x16x32_bf16 v[122:125], a[232:235], v[190:193], v[122:125]
    ds_write_b64 v4, v[170:171] offset:0
    v_mfma_f32_16x16x32_bf16 v[122:125], a[236:239], v[198:201], v[122:125]
    v_cvt_pk_bf16_f32 v187, v188, v189
    v_mov_b32 v169, 0x40000000
    v_lshrrev_b32 v180, 2, v254
    v_mfma_f32_16x16x32_bf16 v[138:141], a[240:243], v[150:153], 0
    ds_write_b64 v115, v[186:187] offset:4096
    v_mfma_f32_16x16x32_bf16 v[138:141], a[244:247], v[154:157], v[138:141]
    v_lshrrev_b32 v181, 3, v254
    v_xor_b32 v181, v181, v254
    v_fma_f32 v254, v122, v122, s33
    v_mfma_f32_16x16x32_bf16 v[138:141], a[248:251], v[158:161], v[138:141]
    s_waitcnt lgkmcnt(2)
    ds_read_b128 v[146:149], v167 offset:0
    ds_read_b64 v[170:171], v117 offset:4096
    v_fmac_f32 v254, v123, v123
    v_mfma_f32_16x16x32_bf16 v[138:141], a[252:255], v[162:165], v[138:141]
    ds_read_b128 v[186:189], v167 offset:2048
    v_fmac_f32 v254, v124, v124
    v_fmac_f32 v254, v125, v125
    v_mfma_f32_16x16x32_bf16 v[138:141], v[82:85], v[190:193], v[138:141]
    s_waitcnt lgkmcnt(4)
    ds_read_b128 v[202:205], v167 offset:4096
    v_and_b32 v181, 3, v181
    v_add_u32 v172, 0, v180
    v_mfma_f32_16x16x32_bf16 v[138:141], v[86:89], v[198:201], v[138:141]
    s_barrier
    ds_read_b128 v[206:209], v168 offset:0
    ds_read_b128 v[218:221], v168 offset:1024
    v_mul_u32_u24 v180, s20, v172
    v_mfma_f32_16x16x32_bf16 v[222:225], v[90:93], v[150:153], 0
    ds_read_b128 v[150:153], v167 offset:6144
    ds_read_b128 v[226:229], v167 offset:8192
    v_add_u32 v180, s38, v180
    v_mfma_f32_16x16x32_bf16 v[222:225], v[94:97], v[154:157], v[222:225]
    ds_read_b128 v[154:157], v167 offset:10240
    v_fmac_f32 v254, v138, v138
    v_fmac_f32 v254, v139, v139
    v_mfma_f32_16x16x32_bf16 v[222:225], v[98:101], v[158:161], v[222:225]
    s_waitcnt lgkmcnt(7)
    buffer_store_dwordx4 v[130:133], v16, s[12:15], s27 offen nt
    ds_read_b128 v[158:161], v168 offset:18432
    v_fmac_f32 v254, v140, v140
    v_fmac_f32 v254, v141, v141
    v_mfma_f32_16x16x32_bf16 v[222:225], v[102:105], v[162:165], v[222:225]
    s_waitcnt lgkmcnt(7)
    v_mul_u32_u24 v180, 911, v180
    v_lshrrev_b32 v180, 16, v180
    v_mul_u32_u24 v180, s22, v180
    v_mfma_f32_16x16x32_bf16 v[222:225], v[106:109], v[190:193], v[222:225]
    s_waitcnt lgkmcnt(6)
    v_mad_u32_u24 v180, v172, s21, v180
    v_cmp_gt_u32 vcc, s17, v172
    v_add_u32 v172, s7, v180
    v_mfma_f32_16x16x32_bf16 v[222:225], v[110:113], v[198:201], v[222:225]
    s_waitcnt lgkmcnt(4)
    v_cndmask_b32 v172, v169, v172, vcc
    v_lshl_add_u32 v183, v181, 4, v172
    v_mfma_f32_16x16x32_bf16 v[130:133], v[32:35], v[206:209], 0
    s_waitcnt lgkmcnt(2)
    v_add_u32 v183, s3, v183
    v_lshl_add_u32 v184, v181, 3, v172
    v_mfma_f32_16x16x32_bf16 v[130:133], v[32:35], v[218:221], v[130:133]
    s_waitcnt lgkmcnt(1)
    v_fmac_f32 v254, v222, v222
    v_fmac_f32 v254, v223, v223
    v_fmac_f32 v254, v224, v224
    v_mfma_f32_16x16x32_bf16 v[162:165], a[216:219], v[146:149], 0
    v_fmac_f32 v254, v225, v225
    v_cvt_pk_bf16_f32 v180, v254, v254
    v_cvt_pk_bf16_f32 v181, v254, v254
    v_mfma_f32_16x16x32_bf16 v[162:165], a[220:223], v[186:189], v[162:165]
    s_waitcnt lgkmcnt(0)
    ds_write_b64 v4, v[180:181] offset:2048
    v_mfma_f32_16x16x32_bf16 v[162:165], a[224:227], v[202:205], v[162:165]
    v_add_u32 v184, s4, v184
    v_add_u32 v166, 16, v166
    v_mul_u32_u24 v172, s20, v166
    v_mfma_f32_16x16x32_bf16 v[162:165], a[228:231], v[150:153], v[162:165]
    v_add_u32 v172, s38, v172
    v_mul_u32_u24 v172, 911, v172
    v_lshrrev_b32 v172, 16, v172
    v_mfma_f32_16x16x32_bf16 v[162:165], a[232:235], v[226:229], v[162:165]
    v_mul_u32_u24 v172, s22, v172
    v_mad_u32_u24 v172, v166, s21, v172
    v_cmp_gt_u32 vcc, s17, v166
    v_mfma_f32_16x16x32_bf16 v[162:165], a[236:239], v[154:157], v[162:165]
    v_add_u32 v172, s7, v172
    v_cndmask_b32 v172, v169, v172, vcc
    v_lshl_add_u32 v185, v255, 4, v172
    v_mfma_f32_16x16x32_bf16 v[190:193], a[240:243], v[146:149], 0
    v_add_u32 v185, s3, v185
    v_lshl_add_u32 v254, v255, 3, v172
    v_add_u32 v254, s4, v254
    v_mfma_f32_16x16x32_bf16 v[190:193], a[244:247], v[186:189], v[190:193]
    buffer_store_dwordx2 v[178:179], v19, s[12:15], s27 offen nt
    v_fma_f32 v172, v162, v162, s33
    v_mfma_f32_16x16x32_bf16 v[190:193], a[248:251], v[202:205], v[190:193]
    ds_read_b128 v[198:201], v167 offset:256
    v_fmac_f32 v172, v163, v163
    v_fmac_f32 v172, v164, v164
    v_mfma_f32_16x16x32_bf16 v[190:193], a[252:255], v[150:153], v[190:193]
    ds_read_b128 v[178:181], v167 offset:2304
    v_fmac_f32 v172, v165, v165
    v_mul_f32 v255, 0x3baaaaab, v130
    v_mfma_f32_16x16x32_bf16 v[190:193], v[82:85], v[226:229], v[190:193]
    ds_read_b128 v[206:209], v167 offset:4352
    v_mul_f32 v166, 0x3baaaaab, v131
    v_rsq_f32 v255, v255
    v_mfma_f32_16x16x32_bf16 v[190:193], v[86:89], v[154:157], v[190:193]
    ds_read_b128 v[130:133], v167 offset:6400
    v_mul_f32 v118, v255, v118
    v_mul_f32 v119, v255, v119
    v_mfma_f32_16x16x32_bf16 v[218:221], v[90:93], v[146:149], 0
    ds_read_b128 v[146:149], v167 offset:8448
    v_cvt_pk_bf16_f32 v118, v118, v119
    v_mul_f32 v120, v255, v120
    v_mfma_f32_16x16x32_bf16 v[218:221], v[94:97], v[186:189], v[218:221]
    ds_read_b128 v[186:189], v167 offset:10496
    v_fmac_f32 v172, v190, v190
    v_fmac_f32 v172, v191, v191
    v_mfma_f32_16x16x32_bf16 v[218:221], v[98:101], v[202:205], v[218:221]
    s_waitcnt lgkmcnt(5)
    v_fmac_f32 v172, v192, v192
    v_fmac_f32 v172, v193, v193
    v_mul_f32 v121, v255, v121
    v_mfma_f32_16x16x32_bf16 v[218:221], v[102:105], v[150:153], v[218:221]
    s_waitcnt lgkmcnt(4)
    v_cvt_pk_bf16_f32 v119, v120, v121
    v_mul_f32 v194, v255, v194
    v_mul_f32 v195, v255, v195
    v_mfma_f32_16x16x32_bf16 v[218:221], v[106:109], v[226:229], v[218:221]
    s_waitcnt lgkmcnt(3)
    v_cvt_pk_bf16_f32 v120, v194, v195
    v_mul_f32 v196, v255, v196
    v_mul_f32 v197, v255, v197
    v_mfma_f32_16x16x32_bf16 v[218:221], v[110:113], v[154:157], v[218:221]
    s_waitcnt lgkmcnt(2)
    v_cvt_pk_bf16_f32 v121, v196, v197
    v_mul_f32 v210, v255, v210
    v_mul_f32 v211, v255, v211
    v_mfma_f32_16x16x32_bf16 v[150:153], a[216:219], v[198:201], 0
    s_waitcnt lgkmcnt(1)
    ds_write_b128 v114, v[118:121] offset:4608
    v_mfma_f32_16x16x32_bf16 v[150:153], a[220:223], v[178:181], v[150:153]
    s_waitcnt lgkmcnt(1)
    v_fmac_f32 v172, v218, v218
    v_fmac_f32 v172, v219, v219
    v_fmac_f32 v172, v220, v220
    v_mfma_f32_16x16x32_bf16 v[150:153], a[224:227], v[206:209], v[150:153]
    buffer_store_dwordx4 v[126:129], v177, s[12:15], s27 offen nt
    ds_read_b128 v[118:121], v116 offset:4608
    v_fmac_f32 v172, v221, v221
    v_cvt_pk_bf16_f32 v126, v172, v172
    v_mfma_f32_16x16x32_bf16 v[150:153], a[228:231], v[130:133], v[150:153]
    v_cvt_pk_bf16_f32 v127, v172, v172
    v_cvt_pk_bf16_f32 v210, v210, v211
    v_mul_f32 v212, v255, v212
    v_mfma_f32_16x16x32_bf16 v[150:153], a[232:235], v[146:149], v[150:153]
    ds_write_b64 v4, v[126:127] offset:4096
    v_mfma_f32_16x16x32_bf16 v[150:153], a[236:239], v[186:189], v[150:153]
    v_mul_f32 v213, v255, v213
    v_cvt_pk_bf16_f32 v211, v212, v213
    v_rsq_f32 v166, v166
    v_mfma_f32_16x16x32_bf16 v[126:129], a[240:243], v[198:201], 0
    buffer_store_dwordx2 v[170:171], v182, s[12:15], s27 offen nt
    v_mul_f32 v134, v166, v134
    v_mfma_f32_16x16x32_bf16 v[126:129], a[244:247], v[178:181], v[126:129]
    s_mov_b32 s14, s36
    ds_write_b64 v115, v[210:211] offset:5632
    v_mfma_f32_16x16x32_bf16 v[126:129], a[248:251], v[206:209], v[126:129]
    s_waitcnt lgkmcnt(2)
    v_fma_f32 v255, v150, v150, s33
    v_fmac_f32 v255, v151, v151
    v_fmac_f32 v255, v152, v152
    v_mfma_f32_16x16x32_bf16 v[126:129], a[252:255], v[130:133], v[126:129]
    ds_read_b64 v[170:171], v117 offset:5632
    v_fmac_f32 v255, v153, v153
    v_mul_f32 v135, v166, v135
    v_mfma_f32_16x16x32_bf16 v[126:129], v[82:85], v[146:149], v[126:129]
    s_waitcnt lgkmcnt(2)
    buffer_store_dwordx4 v[118:121], v173, s[12:15], s26 offen nt
    v_cvt_pk_bf16_f32 v134, v134, v135
    v_mul_f32 v136, v166, v136
    v_mul_f32 v137, v166, v137
    v_mfma_f32_16x16x32_bf16 v[126:129], v[86:89], v[186:189], v[126:129]
    s_barrier
    ds_read_b128 v[118:121], v168 offset:2048
    ds_read_b128 v[154:157], v168 offset:3072
    v_cvt_pk_bf16_f32 v135, v136, v137
    v_mfma_f32_16x16x32_bf16 v[194:197], v[90:93], v[198:201], 0
    ds_read_b128 v[198:201], v168 offset:4096
    ds_read_b128 v[202:205], v168 offset:5120
    v_mul_f32 v142, v166, v142
    v_mfma_f32_16x16x32_bf16 v[194:197], v[94:97], v[178:181], v[194:197]
    v_fmac_f32 v255, v126, v126
    v_fmac_f32 v255, v127, v127
    v_fmac_f32 v255, v128, v128
    v_mfma_f32_16x16x32_bf16 v[194:197], v[98:101], v[206:209], v[194:197]
    v_fmac_f32 v255, v129, v129
    v_mul_f32 v143, v166, v143
    v_cvt_pk_bf16_f32 v136, v142, v143
    v_mfma_f32_16x16x32_bf16 v[194:197], v[102:105], v[130:133], v[194:197]
    s_waitcnt lgkmcnt(4)
    buffer_store_dwordx2 v[170:171], v174, s[12:15], s26 offen nt
    v_mul_f32 v144, v166, v144
    v_mfma_f32_16x16x32_bf16 v[194:197], v[106:109], v[146:149], v[194:197]
    v_mul_f32 v145, v166, v145
    v_cvt_pk_bf16_f32 v137, v144, v145
    v_mul_f32 v214, v166, v214
    v_mfma_f32_16x16x32_bf16 v[194:197], v[110:113], v[186:189], v[194:197]
    s_waitcnt lgkmcnt(2)
    ds_write_b128 v114, v[134:137] offset:6144
    v_mfma_f32_16x16x32_bf16 v[130:133], v[32:35], v[118:121], 0
    s_waitcnt lgkmcnt(1)
    v_mul_f32 v215, v166, v215
    v_cvt_pk_bf16_f32 v214, v214, v215
    v_mfma_f32_16x16x32_bf16 v[130:133], v[32:35], v[154:157], v[130:133]
    v_mul_f32 v216, v166, v216
    v_fmac_f32 v255, v194, v194
    v_mfma_f32_16x16x32_bf16 v[118:121], v[32:35], v[198:201], 0
    ds_read_b128 v[134:137], v116 offset:6144
    v_fmac_f32 v255, v195, v195
    v_mfma_f32_16x16x32_bf16 v[118:121], v[32:35], v[202:205], v[118:121]
    v_fmac_f32 v255, v196, v196
    v_fmac_f32 v255, v197, v197
    v_cvt_pk_bf16_f32 v132, v255, v255
    v_cvt_pk_bf16_f32 v133, v255, v255
    ds_write_b64 v4, v[132:133] offset:6144
    v_mul_f32 v217, v166, v217
    v_cvt_pk_bf16_f32 v215, v216, v217
    v_mul_f32 v255, 0x3baaaaab, v130
    ds_write_b64 v115, v[214:215] offset:7168
    v_rsq_f32 v255, v255
    v_mul_f32 v174, 0x3baaaaab, v118
    ds_read_b64 v[166:167], v117 offset:7168
    v_mul_f32 v122, v255, v122
    s_waitcnt lgkmcnt(3)
    buffer_store_dwordx4 v[134:137], v175, s[12:15], s26 offen nt
    v_mul_f32 v123, v255, v123
    v_cvt_pk_bf16_f32 v118, v122, v123
    v_mul_f32 v124, v255, v124
    v_mul_f32 v125, v255, v125
    v_cvt_pk_bf16_f32 v119, v124, v125
    v_mul_f32 v138, v255, v138
    s_waitcnt lgkmcnt(2)
    s_barrier
    ds_read_b128 v[122:125], v168 offset:6144
    ds_read_b128 v[130:133], v168 offset:7168
    v_mul_f32 v139, v255, v139
    v_cvt_pk_bf16_f32 v120, v138, v139
    v_mul_f32 v140, v255, v140
    v_mul_f32 v141, v255, v141
    v_cvt_pk_bf16_f32 v121, v140, v141
    ds_write_b128 v114, v[118:121] offset:0
    s_waitcnt lgkmcnt(3)
    buffer_store_dwordx2 v[166:167], v176, s[12:15], s26 offen nt
    v_mul_f32 v222, v255, v222
    v_mul_f32 v223, v255, v223
    v_cvt_pk_bf16_f32 v222, v222, v223
    v_mul_f32 v224, v255, v224
    ds_read_b128 v[118:121], v116 offset:0
    v_mul_f32 v225, v255, v225
    v_cvt_pk_bf16_f32 v223, v224, v225
    ds_write_b64 v115, v[222:223] offset:1024
    s_waitcnt lgkmcnt(3)
    v_mfma_f32_16x16x32_bf16 v[134:137], v[32:35], v[122:125], 0
    v_rsq_f32 v174, v174
    v_mfma_f32_16x16x32_bf16 v[134:137], v[32:35], v[130:133], v[134:137]
    ds_read_b64 v[122:123], v117 offset:1024
    v_mul_f32 v162, v174, v162
    v_mul_f32 v163, v174, v163
    v_cvt_pk_bf16_f32 v130, v162, v163
    v_mul_f32 v164, v174, v164
    v_mul_f32 v165, v174, v165
    v_cvt_pk_bf16_f32 v131, v164, v165
    v_mul_f32 v190, v174, v190
    v_mul_f32 v191, v174, v191
    v_cvt_pk_bf16_f32 v132, v190, v191
    v_mul_f32 v192, v174, v192
    v_mul_f32 v193, v174, v193
    v_cvt_pk_bf16_f32 v133, v192, v193
    s_waitcnt lgkmcnt(2)
    buffer_store_dwordx4 v[118:121], v177, s[12:15], s26 offen nt
    ds_write_b128 v114, v[130:133] offset:1536
    v_mul_f32 v218, v174, v218
    v_mul_f32 v219, v174, v219
    v_cvt_pk_bf16_f32 v124, v218, v219
    v_mul_f32 v220, v174, v220
    v_mul_f32 v221, v174, v221
    v_cvt_pk_bf16_f32 v125, v220, v221
    s_waitcnt lgkmcnt(1)
    ds_read_b128 v[118:121], v116 offset:1536
    ds_write_b64 v115, v[124:125] offset:2560
    buffer_store_dwordx2 v[122:123], v182, s[12:15], s26 offen nt
    v_mul_f32 v255, 0x3baaaaab, v134
    ds_read_b64 v[124:125], v117 offset:2560
    v_rsq_f32 v255, v255
    v_or3_b32 v158, v158, v159, v160
    v_mul_f32 v150, v255, v150
    v_mul_f32 v151, v255, v151
    v_cvt_pk_bf16_f32 v114, v150, v151
    v_mul_f32 v152, v255, v152
    v_mul_f32 v153, v255, v153
    v_cvt_pk_bf16_f32 v115, v152, v153
    v_mul_f32 v126, v255, v126
    v_mul_f32 v127, v255, v127
    v_cvt_pk_bf16_f32 v116, v126, v127
    v_mul_f32 v128, v255, v128
    v_mul_f32 v129, v255, v129
    v_cvt_pk_bf16_f32 v117, v128, v129
    buffer_store_dwordx4 v[114:117], v185, s[12:15], 0 offen nt
    s_waitcnt lgkmcnt(2)
    v_mul_f32 v194, v255, v194
    v_mul_f32 v195, v255, v195
    v_cvt_pk_bf16_f32 v122, v194, v195
    v_mul_f32 v196, v255, v196
    v_mul_f32 v197, v255, v197
    v_cvt_pk_bf16_f32 v123, v196, v197
    v_or_b32 v158, v158, v161
    v_cmp_gt_i32 s[46:47], 0, v158
    s_waitcnt lgkmcnt(0)
    buffer_store_dwordx4 v[118:121], v183, s[12:15], 0 offen nt
    buffer_store_dwordx2 v[124:125], v184, s[12:15], 0 offen nt
    buffer_store_dwordx2 v[122:123], v254, s[12:15], 0 offen nt
    s_nop 1
    s_cmp_lg_u64 s[46:47], 0
    s_cbranch_scc1 L_rerun
L_done:
    s_endpgm
L_slow:
    s_mov_b32 s44, 0xff
    s_branch L_redo
L_rerun:
    s_mov_b32 s44, 0x7f000000
L_redo:
    s_waitcnt vmcnt(0) lgkmcnt(0)
    s_barrier
    v_mbcnt_lo_u32_b32 v0, -1, 0
    v_mbcnt_hi_u32_b32 v0, -1, v0
    v_lshl_add_u32 v0, s16, 6, v0
    s_nop 7
    s_branch L_again
L_edge:
    v_mov_b32 v254, v0
    v_mov_b32 v255, 0x40000000
    v_and_b32 v118, 63, v0
    s_bfe_u32 s3, s2, 0x50003
    s_lshl_b32 s4, s16, 3
    s_lshr_b32 s98, 0x00123600, s4
    s_and_b32 s98, s98, 0xff
    s_mul_i32 s3, s3, s98
    s_lshr_b32 s4, 0x05113500, s4
    s_and_b32 s4, s4, 0xff
    v_min_u32 v120, s4, v118
    v_add_lshl_u32 v120, v120, s3, 7
    v_mov_b32 v121, 0
    v_lshrrev_b32 v119, 4, v118
    v_and_b32 v130, 15, v118
    s_mov_b32 s10, 100270464
    s_mov_b32 s11, 0x00020000
    s_mov_b32 s50, 221184
    s_mov_b32 s51, 0x00020000
    v_mul_u32_u24 v131, 171, v118
    v_lshrrev_b32 v131, 10, v131
    v_lshrrev_b32 v132, 1, v131
    v_xor_b32 v132, v132, v131
    v_and_b32 v132, 4, v132
    v_mul_u32_u24 v132, 3, v132
    v_xor_b32 v132, v132, v131
    v_mul_u32_u24 v132, 1152, v132
    v_mul_u32_u24 v133, 96, v131
    v_sub_u32 v132, v132, v133
    v_lshl_add_u32 v133, v118, 4, v132
    v_add_u32 v132, 64, v118
    v_mul_u32_u24 v132, 171, v132
    v_lshrrev_b32 v132, 10, v132
    v_lshrrev_b32 v134, 1, v132
    v_xor_b32 v134, v134, v132
    v_and_b32 v134, 4, v134
    v_mul_u32_u24 v134, 3, v134
    v_xor_b32 v134, v134, v132
    v_mul_u32_u24 v134, 1152, v134
    v_mul_u32_u24 v135, 96, v132
    v_sub_u32 v134, v134, v135
    v_lshl_add_u32 v135, v118, 4, v134
    v_add_u32 v134, 128, v118
    v_mul_u32_u24 v134, 171, v134
    v_lshrrev_b32 v134, 10, v134
    v_lshrrev_b32 v136, 1, v134
    v_xor_b32 v136, v136, v134
    v_and_b32 v136, 4, v136
    v_mul_u32_u24 v136, 3, v136
    v_xor_b32 v136, v136, v134
    v_mul_u32_u24 v136, 1152, v136
    v_mul_u32_u24 v137, 96, v134
    v_sub_u32 v136, v136, v137
    v_lshl_add_u32 v137, v118, 4, v136
    s_mul_i32 s68, s16, 6144
    s_add_u32 s69, s68, 65536
    s_cmp_eq_u32 s16, 3
    s_cselect_b32 s68, 136704, s68
    s_cselect_b32 s69, 142848, s69
    s_mul_i32 s45, s16, 96
    s_mov_b32 s70, 193536
    s_mov_b32 s36, 100270464
    s_mov_b32 s22, 1180032
    s_mul_i32 s3, s2, 911
    s_lshr_b32 s3, s3, 16
    s_mul_i32 s99, s3, 72
    s_sub_u32 s38, s2, s99
    s_mul_i32 s3, s3, 1373568
    s_mul_i32 s99, s38, 2688
    s_add_u32 s3, s3, s99
    s_add_u32 s25, s3, 589824
    s_add_u32 s7, s3, 1769472
    s_mov_b32 s20, 31
    s_mov_b32 s21, 4204032
    s_cmp_lt_u32 s2, 244
    s_cselect_b32 s17, 21, 20
    s_mov_b32 s5, 0
    s_mov_b32 s6, 0
    s_cmp_lt_u32 s2, 247
    s_cbranch_scc1 L_inner
    s_mov_b32 s20, 0
    s_mov_b32 s38, 0
    s_sub_u32 s3, s2, 247
    s_and_b32 s3, s3, 3
    s_mul_i32 s3, s3, 7
    s_add_u32 s3, s3, 3
    s_mov_b32 s99, 196224
    s_cmp_lt_u32 s2, 251
    s_cselect_b32 s99, s99, 384
    s_cselect_b32 s6, 1, 0
    s_cselect_b32 s5, 0, 1
    s_mul_i32 s25, s3, s99
    s_mul_i32 s21, s99, 28
    s_cmp_lt_u32 s2, 255
    s_cselect_b32 s17, 18, 1
    s_cselect_b32 s25, s25, 0
    s_cselect_b32 s6, s6, 1
    s_add_u32 s7, s25, 1179648
L_inner:
    s_mul_i32 s3, s5, 99485568
    s_mul_i32 s99, s5, -784896
    v_mov_b32 v136, s3
    v_mov_b32 v138, s99
    s_add_u32 s7, s7, s99
    s_mul_i32 s3, s6, 194688
    s_mul_i32 s99, s6, -1536
    v_mov_b32 v139, s3
    v_mov_b32 v140, s99
    s_add_u32 s7, s7, s99
    v_mul_u32_u24 v141, 2731, v254
    v_bfe_u32 v142, v141, 17, 3
    v_lshrrev_b32 v141, 16, v141
    v_xor_b32 v143, v142, v254
    v_mul_u32_u24 v142, 37, v141
    v_lshrrev_b32 v142, 8, v142
    v_lshlrev_b32 v143, 4, v143
    v_mad_u32_u24 v10, v142, s70, v143
    v_mul_u32_u24 v142, 37, v141
    v_lshrrev_b32 v142, 8, v142
    v_mul_u32_u24 v144, 7, v142
    v_sub_u32 v144, v141, v144
    v_cmp_gt_u32 vcc, 4, v142
    s_nop 1
    v_cndmask_b32 v142, v138, v136, vcc
    v_cmp_gt_u32 vcc, 4, v144
    s_nop 1
    v_cndmask_b32 v144, v140, v139, vcc
    v_add3_u32 v10, v10, v142, v144
    v_mul_u32_u24 v142, s20, v141
    v_add_u32 v142, s38, v142
    v_mul_u32_u24 v142, 911, v142
    v_lshrrev_b32 v142, 16, v142
    v_mul_u32_u24 v142, s22, v142
    v_mad_u32_u24 v142, v141, s21, v142
    v_cmp_gt_u32 vcc, s17, v141
    v_add_u32 v142, s7, v142
    s_nop 0
    v_cndmask_b32 v142, v255, v142, vcc
    v_mul_u32_u24 v141, 384, v141
    v_sub_u32 v141, v143, v141
    v_add_u32 v142, v142, v141
    v_add_u32 v141, 256, v254
    v_mul_u32_u24 v143, 2731, v141
    v_bfe_u32 v144, v143, 17, 3
    v_lshrrev_b32 v143, 16, v143
    v_xor_b32 v141, v144, v141
    v_mul_u32_u24 v144, 37, v143
    v_lshrrev_b32 v144, 8, v144
    v_lshlrev_b32 v141, 4, v141
    v_mad_u32_u24 v11, v144, s70, v141
    v_mul_u32_u24 v144, 37, v143
    v_lshrrev_b32 v144, 8, v144
    v_mul_u32_u24 v145, 7, v144
    v_sub_u32 v145, v143, v145
    v_cmp_gt_u32 vcc, 4, v144
    s_nop 1
    v_cndmask_b32 v144, v138, v136, vcc
    v_cmp_gt_u32 vcc, 4, v145
    s_nop 1
    v_cndmask_b32 v145, v140, v139, vcc
    v_add3_u32 v11, v11, v144, v145
    v_mul_u32_u24 v144, s20, v143
    v_add_u32 v144, s38, v144
    v_mul_u32_u24 v144, 911, v144
    v_lshrrev_b32 v144, 16, v144
    v_mul_u32_u24 v144, s22, v144
    v_mad_u32_u24 v144, v143, s21, v144
    v_cmp_gt_u32 vcc, s17, v143
    v_add_u32 v144, s7, v144
    s_nop 0
    v_cndmask_b32 v144, v255, v144, vcc
    v_mul_u32_u24 v143, 384, v143
    v_sub_u32 v143, v141, v143
    v_add_u32 v144, v144, v143
    s_lshl_b32 s28, s16, 10
    s_add_u32 s28, s28, 20480
    s_waitcnt lgkmcnt(0)
    s_cmp_eq_u32 s16, 2
    s_cselect_b64 s[98:99], s[80:81], s[78:79]
    s_cmp_eq_u32 s16, 3
    s_cselect_b64 s[98:99], s[88:89], s[98:99]
    s_mov_b64 s[8:9], s[76:77]
    v_lshl_add_u64 v[120:121], s[98:99], 0, v[120:121]
    s_cmp_eq_u32 s16, 2
    s_cselect_b64 s[98:99], s[84:85], s[82:83]
    s_cmp_eq_u32 s16, 3
    s_cselect_b64 s[98:99], s[86:87], s[98:99]
    v_writelane_b32 v120, s98, 63
    v_writelane_b32 v121, s99, 63
    s_cmp_eq_u32 s16, 0
    s_cbranch_scc1 L_nowue
    global_load_dword a254, v[120:121], off
L_nowue:
    s_add_u32 m0, s28, 128512
    s_nop 0
    buffer_load_dwordx4 v142, s[8:11], 0 offen nt lds
    s_add_u32 m0, s28, 132608
    s_nop 0
    buffer_load_dwordx4 v144, s[8:11], 0 offen nt lds
    s_add_u32 m0, s28, 0
    s_nop 0
    buffer_load_dwordx4 v10, s[8:11], s25 offen nt lds
    s_add_u32 m0, s28, 4096
    s_nop 0
    buffer_load_dwordx4 v11, s[8:11], s25 offen nt lds
    s_mov_b64 s[48:49], s[78:79]
    s_mov_b64 s[52:53], s[80:81]
    s_mov_b64 s[60:61], s[84:85]
    s_mov_b64 s[64:65], s[86:87]
    s_mov_b64 s[56:57], s[88:89]
    s_mov_b64 s[46:47], s[82:83]
    s_load_dwordx2 s[42:43], s[0:1], 72
    s_add_u32 m0, s68, 0
    s_add_u32 s4, s45, 384
    v_add_u32 v141, s16, v118
    v_and_b32 v141, 3, v141
    v_lshlrev_b32 v141, 1, v141
    s_mov_b32 s54, 73728
    s_mov_b32 s55, 0x00020000
    s_mov_b32 s62, 64
    s_mov_b32 s63, 0x00020000
    s_mov_b32 s66, 128
    s_mov_b32 s67, 0x00020000
    s_mov_b32 s58, 676
    s_mov_b32 s59, 0x00020000
    s_mov_b32 s14, 0
    s_mov_b32 s15, 0x00020000
    v_mov_b32 v117, 0
    v_cmp_lt_u32 s[90:91], 7, v130
    v_mov_b32 v115, 0
    v_mov_b32 v125, 0
    v_mov_b32 v121, 0
    v_lshlrev_b32 v120, 1, v118
    v_mul_u32_u24 v114, 12, v130
    s_mul_i32 s71, s16, 192
    v_add_u32 v114, s71, v114
    v_lshlrev_b32 v124, 5, v119
    s_mul_i32 s72, s16, 8064
    s_add_u32 s72, s72, 104448
    s_mul_i32 s73, s16, 6528
    s_add_u32 s73, s73, 38912
    v_lshrrev_b32 v127, 2, v130
    v_and_b32 v123, 1, v127
    v_mul_u32_u24 v123, 0x020202, v123
    v_lshl_or_b32 v123, v123, 8, v123
    v_add_u32 v123, 0x05040100, v123
    v_and_b32 v122, 3, v130
    v_lshrrev_b32 v116, 1, v130
    v_xor_b32 v116, v116, v119
    v_mul_u32_u24 v126, 384, v130
    v_lshl_add_u32 v0, v116, 4, v126
    v_xor_b32 v1, 64, v0
    v_and_b32 v116, 2, v119
    v_add_u32 v116, v116, v119
    v_lshl_add_u32 v116, v116, 2, v127
    v_mul_u32_u24 v116, 96, v116
    v_lshl_add_u32 v116, v122, 3, v116
    v_add_u32 v128, s68, v116
    v_add_u32 v126, s69, v116
    v_add_u32 v129, s72, v116
    v_add_u32 v142, s73, v116
    v_mov_b32 v28, 0x3f803f80
    v_mov_b32 v29, 0x3f803f80
    v_mov_b32 v30, 0x3f803f80
    v_mov_b32 v31, 0x3f803f80
    v_mul_u32_u24 v146, 768, v119
    v_add_u32 v146, v114, v146
    v_add_u32 v146, 157184, v146
    s_mov_b32 s76, 0x3f80
    v_and_b32 v143, 1, v130
    v_lshlrev_b32 v143, 4, v143
    v_lshlrev_b32 v144, v143, s76
    v_mov_b32 v145, 0x3c003c00
    v_mov_b32 v44, 1.0
    v_mov_b32 v45, 1.0
    v_lshlrev_b32 v147, 4, v119
    s_mov_b32 s19, s38
    s_mov_b32 s23, s25
    s_mov_b32 s26, 0
    s_mov_b32 s27, 0
    s_mov_b32 s18, 0
    s_add_u32 s19, s19, s20
    s_add_u32 s23, s23, s21
    s_cmp_ge_u32 s19, 72
    s_cselect_b32 s34, 72, 0
    s_cselect_b32 s35, s22, 0
    s_sub_u32 s19, s19, s34
    s_add_u32 s23, s23, s35
    s_mov_b32 s24, s23
    s_add_u32 s19, s19, s20
    s_add_u32 s23, s23, s21
    s_cmp_ge_u32 s19, 72
    s_cselect_b32 s34, 72, 0
    s_cselect_b32 s35, s22, 0
    s_sub_u32 s19, s19, s34
    s_add_u32 s23, s23, s35
    s_mul_i32 s79, s16, 64
    v_lshl_add_u32 v154, v119, 4, s79
    s_mul_i32 s80, s16, 32
    s_add_u32 s80, s80, 256
    v_lshl_add_u32 v150, v119, 3, s80
    v_add_u32 v148, 0, v130
    v_mul_u32_u24 v155, 37, v148
    v_mul_u32_u24 v116, 384, v148
    v_lshrrev_b32 v155, 8, v155
    v_mad_u32_u24 v116, v155, s70, v116
    v_add_u32 v15, v116, v154
    v_add_u32 v18, v116, v150
    v_mul_u32_u24 v149, 37, v148
    v_lshrrev_b32 v149, 8, v149
    v_mul_u32_u24 v156, 7, v149
    v_sub_u32 v156, v148, v156
    v_add_u32 v153, 16, v130
    v_mul_u32_u24 v152, 37, v153
    v_mul_u32_u24 v116, 384, v153
    v_lshrrev_b32 v152, 8, v152
    v_mad_u32_u24 v116, v152, s70, v116
    v_add_u32 v16, v116, v154
    v_add_u32 v19, v116, v150
    v_mul_u32_u24 v158, 37, v153
    v_lshrrev_b32 v158, 8, v158
    v_mul_u32_u24 v157, 7, v158
    v_sub_u32 v157, v153, v157
    v_add_u32 v151, 32, v130
    v_mul_u32_u24 v116, 37, v151
    v_mul_u32_u24 v159, 384, v151
    v_lshrrev_b32 v116, 8, v116
    v_mad_u32_u24 v159, v116, s70, v159
    v_add_u32 v17, v159, v154
    v_add_u32 v20, v159, v150
    v_mul_u32_u24 v154, 37, v151
    v_lshrrev_b32 v154, 8, v154
    v_mul_u32_u24 v150, 7, v154
    v_sub_u32 v150, v151, v150
    s_mul_i32 s81, s16, 768
    s_add_u32 s81, s81, 157184
    v_mul_u32_u24 v155, 24, v155
    v_lshl_add_u32 v155, v148, 2, v155
    v_add_u32 v22, s81, v155
    v_sub_u32 v23, s81, v155
    v_sub_u32 v155, v22, v147
    v_mul_u32_u24 v152, 24, v152
    v_lshl_add_u32 v152, v153, 2, v152
    v_add_u32 v24, s81, v152
    v_sub_u32 v25, s81, v152
    v_sub_u32 v152, v24, v147
    v_mul_u32_u24 v116, 24, v116
    v_lshl_add_u32 v116, v151, 2, v116
    v_add_u32 v26, s81, v116
    v_sub_u32 v27, s81, v116
    v_sub_u32 v116, v26, v147
    v_mul_u32_u24 v160, 148, v119
    s_mov_b32 s82, -24
    v_add_u32 v159, 0, v160
    v_lshrrev_b32 v159, 8, v159
    v_mad_i32_i24 v46, v159, s82, v155
    v_mad_i32_i24 v58, v159, s82, v152
    v_mad_i32_i24 v70, v159, s82, v116
    v_add_u32 v159, 37, v160
    v_lshrrev_b32 v159, 8, v159
    v_mad_i32_i24 v47, v159, s82, v155
    v_mad_i32_i24 v59, v159, s82, v152
    v_mad_i32_i24 v71, v159, s82, v116
    v_add_u32 v159, 74, v160
    v_lshrrev_b32 v159, 8, v159
    v_mad_i32_i24 v48, v159, s82, v155
    v_mad_i32_i24 v60, v159, s82, v152
    v_mad_i32_i24 v72, v159, s82, v116
    v_add_u32 v159, 111, v160
    v_lshrrev_b32 v159, 8, v159
    v_mad_i32_i24 v49, v159, s82, v155
    v_mad_i32_i24 v61, v159, s82, v152
    v_mad_i32_i24 v73, v159, s82, v116
    v_add_u32 v159, 592, v160
    v_lshrrev_b32 v159, 8, v159
    v_mad_i32_i24 v50, v159, s82, v155
    v_mad_i32_i24 v62, v159, s82, v152
    v_mad_i32_i24 v74, v159, s82, v116
    v_add_u32 v159, 629, v160
    v_lshrrev_b32 v159, 8, v159
    v_mad_i32_i24 v51, v159, s82, v155
    v_mad_i32_i24 v63, v159, s82, v152
    v_mad_i32_i24 v75, v159, s82, v116
    v_add_u32 v159, 666, v160
    v_lshrrev_b32 v159, 8, v159
    v_mad_i32_i24 v52, v159, s82, v155
    v_mad_i32_i24 v64, v159, s82, v152
    v_mad_i32_i24 v76, v159, s82, v116
    v_add_u32 v159, 703, v160
    v_lshrrev_b32 v159, 8, v159
    v_mad_i32_i24 v53, v159, s82, v155
    v_mad_i32_i24 v65, v159, s82, v152
    v_mad_i32_i24 v77, v159, s82, v116
    v_add_u32 v159, 1184, v160
    v_lshrrev_b32 v159, 8, v159
    v_mad_i32_i24 v54, v159, s82, v155
    v_mad_i32_i24 v66, v159, s82, v152
    v_mad_i32_i24 v78, v159, s82, v116
    v_add_u32 v159, 1221, v160
    v_lshrrev_b32 v159, 8, v159
    v_mad_i32_i24 v55, v159, s82, v155
    v_mad_i32_i24 v67, v159, s82, v152
    v_mad_i32_i24 v79, v159, s82, v116
    v_add_u32 v159, 1258, v160
    v_lshrrev_b32 v159, 8, v159
    v_mad_i32_i24 v56, v159, s82, v155
    v_mad_i32_i24 v68, v159, s82, v152
    v_mad_i32_i24 v80, v159, s82, v116
    v_add_u32 v159, 1295, v160
    v_lshrrev_b32 v159, 8, v159
    v_mad_i32_i24 v57, v159, s82, v155
    v_mad_i32_i24 v69, v159, s82, v152
    v_mad_i32_i24 v81, v159, s82, v116
    v_mov_b32 v155, s81
    v_lshlrev_b32 v116, 4, v118
    v_xor_b32 v2, 65536, v116
    v_lshl_add_u32 v3, s16, 10, v116
    s_lshr_b32 s83, s16, 1
    s_and_b32 s84, s16, 1
    s_lshl_b32 s84, s84, 3
    s_lshl_b32 s85, s83, 10
    s_add_u32 s85, s85, s84
    v_add_u32 v4, s85, v116
    s_lshl_b32 s83, s83, 11
    s_add_u32 s83, s83, s84
    s_add_u32 s83, s83, 144896
    s_mul_i32 s86, s16, 2048
    s_add_u32 s86, s86, 136704
    v_lshl_add_u32 v152, v119, 3, s86
    v_mov_b32 v160, s83
    v_mov_b32 v161, 161536
    v_mul_u32_u24 v159, 80, v119
    v_add3_u32 v5, v159, v143, s72
    v_lshl_add_u32 v6, v130, 2, s73
    s_mul_i32 s87, s16, 128
    s_add_u32 s87, s87, 65024
    s_mov_b32 s40, s8
    buffer_load_dwordx4 v133, s[48:51], s4 offen lds
    v_add_u32 v9, s87, v147
    v_lshrrev_b32 v116, 1, v119
    s_mov_b32 s41, s9
    s_mov_b32 s32, 0x2a8cbccc
    buffer_load_dwordx4 v135, s[48:51], s4 offen offset:1024 lds
    v_mul_u32_u24 v116, 48, v116
    v_lshl_add_u32 v116, v119, 3, v116
    s_mov_b32 s33, 0x38fba882
    s_add_u32 s75, s28, 16384
    buffer_load_dwordx4 v137, s[48:51], s4 offen offset:2048 lds
    s_add_u32 m0, s68, 3072
    s_add_u32 s4, s45, 37248
    s_cmp_lt_u32 s16, 2
    s_cselect_b32 s29, s75, 160256
    buffer_load_dwordx4 v133, s[48:51], s4 offen lds
    v_lshl_add_u32 v116, v127, 4, v116
    v_lshl_add_u32 v116, v122, 1, v116
    s_cselect_b32 s30, 65536, 0
    s_xor_b32 s74, s29, s30
    buffer_load_dwordx4 v135, s[48:51], s4 offen offset:1024 lds
    v_add_u32 v8, s87, v116
    v_mov_b32 v37, 0
    s_lshl_b32 s92, s5, 1
    s_or_b32 s92, s92, s6
    buffer_load_dwordx4 v137, s[48:51], s4 offen offset:2048 lds
    s_add_u32 m0, s69, 0
    s_add_u32 s4, s45, 74112
    s_mul_i32 s77, s16, 64
    s_mul_i32 s78, s16, 32
    buffer_load_ushort v116, v120, s[60:63], 0 offen
    v_mov_b32 v38, 0
    s_add_u32 s78, s78, 192
    s_add_u32 s34, s18, 2
    buffer_load_dwordx3 v[182:184], v114, s[56:59], 0 offen
    v_mov_b32 v39, 0
    s_mov_b32 s27, s26
    s_mov_b32 s26, s25
    buffer_load_dwordx4 v[174:177], v124, s[64:67], 0 offen
    v_add_u32 v164, 148992, v0
    v_add_u32 v163, 148992, v1
    v_lshlrev_b32 v185, 4, v130
    v_add_u32 v185, 160256, v185
    v_mul_u32_u24 v167, 336, v130
    v_add3_u32 v167, v167, v159, s72
    v_mul_u32_u24 v166, 272, v130
    v_add3_u32 v166, v166, v147, s73
    v_mul_u32_u24 v165, 1088, v119
    v_add_u32 v165, v165, v6
    v_add_u32 v159, 5376, v167
    v_add_u32 v169, 4352, v166
    v_add_u32 v168, 4352, v165
    v_cmp_gt_u32 s[88:89], 16, v118
    v_mov_b32 v162, 0xf149f2ca
    v_add_u32 v170, 512, v254
    v_mul_u32_u24 v114, 2731, v170
    v_bfe_u32 v120, v114, 17, 3
    v_lshrrev_b32 v114, 16, v114
    v_xor_b32 v170, v120, v170
    v_mul_u32_u24 v120, 37, v114
    v_lshrrev_b32 v120, 8, v120
    v_lshlrev_b32 v170, 4, v170
    v_mad_u32_u24 v12, v120, s70, v170
    v_mul_u32_u24 v170, 37, v114
    v_lshrrev_b32 v170, 8, v170
    v_mul_u32_u24 v171, 7, v170
    v_sub_u32 v171, v114, v171
    s_add_u32 s19, s19, s20
    s_mov_b32 s18, 1
    buffer_load_dwordx4 v[198:201], v124, s[64:67], 0 offen offset:16
    v_cmp_gt_u32 vcc, 4, v170
    v_add_u32 v124, 768, v254
    v_mul_u32_u24 v114, 2731, v124
    v_cndmask_b32 v170, v138, v136, vcc
    v_cmp_gt_u32 vcc, 4, v171
    v_bfe_u32 v120, v114, 17, 3
    v_lshrrev_b32 v114, 16, v114
    v_cndmask_b32 v171, v140, v139, vcc
    v_add3_u32 v12, v12, v170, v171
    v_xor_b32 v124, v120, v124
    v_mul_u32_u24 v120, 37, v114
    v_lshrrev_b32 v120, 8, v120
    v_lshlrev_b32 v124, 4, v124
    v_mad_u32_u24 v13, v120, s70, v124
    v_mul_u32_u24 v120, 37, v114
    v_lshrrev_b32 v120, 8, v120
    v_mul_u32_u24 v170, 7, v120
    v_sub_u32 v170, v114, v170
    v_cmp_gt_u32 vcc, 4, v120
    v_add_u32 v114, 1024, v254
    v_mul_u32_u24 v124, 2731, v114
    v_cndmask_b32 v120, v138, v136, vcc
    v_cmp_gt_u32 vcc, 4, v170
    v_bfe_u32 v254, v124, 17, 3
    v_lshrrev_b32 v124, 16, v124
    v_cndmask_b32 v170, v140, v139, vcc
    v_add3_u32 v13, v13, v120, v170
    v_xor_b32 v114, v254, v114
    v_mul_u32_u24 v254, 37, v124
    v_lshrrev_b32 v254, 8, v254
    v_lshlrev_b32 v114, 4, v114
    v_mad_u32_u24 v14, v254, s70, v114
    v_mul_u32_u24 v120, 37, v124
    v_lshrrev_b32 v120, 8, v120
    v_mul_u32_u24 v114, 7, v120
    v_sub_u32 v114, v124, v114
    v_cmp_gt_u32 vcc, 4, v120
    v_mov_b32 v254, 0xc31044fe
    v_mul_u32_u24 v170, 37, v148
    v_cndmask_b32 v120, v138, v136, vcc
    v_cmp_gt_u32 vcc, 4, v114
    v_lshrrev_b32 v170, 8, v170
    v_mul_u32_u24 v171, 7, v170
    v_cndmask_b32 v114, v140, v139, vcc
    v_add3_u32 v14, v14, v120, v114
    v_cmp_gt_u32 vcc, 48, v124
    v_sub_u32 v171, v148, v171
    global_load_ushort v141, v141, s[46:47]
    s_waitcnt vmcnt(10)
    s_barrier
    v_cndmask_b32 v14, v255, v14, vcc
    v_cmp_gt_u32 vcc, 2, v122
    v_lshrrev_b32 v170, 2, v170
    v_lshrrev_b32 v171, 2, v171
    v_cndmask_b32 v32, 0, v144, vcc
    v_cndmask_b32 v33, v144, 0, vcc
    v_cndmask_b32 v34, 0, v144, vcc
    v_cndmask_b32 v35, v144, 0, vcc
    v_cmp_eq_u32 vcc, 0, v143
    v_and_b32 v170, s5, v170
    v_and_b32 v171, s6, v171
    v_cndmask_b32 v40, 0, v145, vcc
    buffer_load_dwordx4 v133, s[48:51], s4 offen lds
    v_cndmask_b32 v41, v145, 0, vcc
    v_cndmask_b32 v42, 0, v145, vcc
    v_cndmask_b32 v43, v145, 0, vcc
    v_cmp_eq_u32 vcc, v119, v127
    v_lshl_or_b32 v170, v170, 1, v171
    v_mul_u32_u24 v255, 37, v153
    v_cndmask_b32 v144, 0, v32, vcc
    v_cndmask_b32 v145, 0, v33, vcc
    v_lshrrev_b32 v255, 8, v255
    v_mul_u32_u24 v114, 7, v255
    v_sub_u32 v114, v153, v114
    v_lshrrev_b32 v255, 2, v255
    v_lshrrev_b32 v114, 2, v114
    v_and_b32 v255, s5, v255
    buffer_load_dwordx4 v135, s[48:51], s4 offen offset:1024 lds
    s_waitcnt vmcnt(10)
    ds_read_b64_tr_b16 a[72:73], v128 offset:0
    ds_read_b64_tr_b16 a[74:75], v128 offset:768
    ds_read_b64_tr_b16 a[96:97], v128 offset:32
    ds_read_b64_tr_b16 a[98:99], v128 offset:800
    ds_read_b64_tr_b16 a[120:121], v128 offset:64
    ds_read_b64_tr_b16 a[122:123], v128 offset:832
    v_and_b32 v114, s6, v114
    v_lshl_or_b32 v255, v255, 1, v114
    v_mul_u32_u24 v171, 37, v151
    v_lshrrev_b32 v171, 8, v171
    v_mul_u32_u24 v114, 7, v171
    v_sub_u32 v114, v151, v114
    v_lshrrev_b32 v171, 2, v171
    buffer_load_dwordx4 v137, s[48:51], s4 offen offset:2048 lds
    s_add_u32 m0, s69, 3072
    s_add_u32 s4, s45, 110976
    v_lshrrev_b32 v114, 2, v114
    v_and_b32 v171, s5, v171
    v_and_b32 v114, s6, v114
    v_lshl_or_b32 v171, v171, 1, v114
    v_mul_u32_u24 v120, 6, v131
    v_sub_u32 v124, v118, v120
    v_mul_u32_u24 v120, 384, v131
    v_lshl_add_u32 v120, v124, 4, v120
    v_add_u32 v114, s78, v120
    v_add_u32 v120, s77, v120
    v_cmp_gt_i32 vcc, 4, v124
    v_mul_u32_u24 v124, 6, v132
    buffer_load_dwordx4 v133, s[48:51], s4 offen lds
    v_cndmask_b32 v143, v114, v120, vcc
    v_sub_u32 v120, v118, v124
    v_mul_u32_u24 v124, 384, v132
    v_lshl_add_u32 v124, v120, 4, v124
    v_add_u32 v114, s78, v124
    v_add_u32 v124, s77, v124
    v_cmp_gt_i32 vcc, -60, v120
    v_mul_u32_u24 v131, 6, v134
    v_sub_u32 v148, v118, v131
    v_cndmask_b32 v132, v114, v124, vcc
    v_mul_u32_u24 v131, 384, v134
    v_lshl_add_u32 v131, v148, 4, v131
    s_waitcnt vmcnt(9)
    ds_read_b64_tr_b16 a[76:77], v128 offset:3072
    ds_read_b64_tr_b16 a[78:79], v128 offset:3840
    s_waitcnt vmcnt(7)
    buffer_load_dwordx4 v135, s[48:51], s4 offen offset:1024 lds
    s_waitcnt vmcnt(7)
    s_waitcnt vmcnt(6)
    ds_read_b64_tr_b16 a[100:101], v128 offset:3104
    ds_read_b64_tr_b16 a[102:103], v128 offset:3872
    ds_read_b64_tr_b16 a[124:125], v128 offset:3136
    ds_read_b64_tr_b16 a[126:127], v128 offset:3904
    v_cndmask_b32 v174, v174, v175, s[90:91]
    v_cndmask_b32 v176, v176, v177, s[90:91]
    v_perm_b32 v172, v176, v174, v123
    v_cndmask_b32 v198, v198, v199, s[90:91]
    v_cndmask_b32 v200, v200, v201, s[90:91]
    v_perm_b32 v173, v200, v198, v123
    v_bfe_u32 v114, v182, v147, 16
    v_bfe_u32 v124, v183, v147, 16
    buffer_load_dwordx4 v137, s[48:51], s4 offen offset:2048 lds
    v_mfma_f32_16x16x16_bf16 v[174:177], v[116:117], v[114:115], 0
    v_bfe_u32 v120, v184, v147, 16
    v_add_u32 v151, s78, v131
    v_add_u32 v131, s77, v131
    v_mfma_f32_16x16x16_bf16 v[198:201], v[116:117], v[124:125], 0
    v_cmp_gt_i32 vcc, -124, v148
    v_mul_u32_u24 v148, 96, v130
    v_add3_u32 v134, v148, v147, s68
    v_mfma_f32_16x16x16_bf16 v[210:213], v[116:117], v[120:121], 0
    s_add_u32 m0, s72, 0
    s_add_u32 s4, s45, 147840
    v_max_f32 v174, 0, v174
    v_max_f32 v175, 0, v175
    v_max_f32 v176, 0, v176
    buffer_load_dwordx4 v133, s[48:51], s4 offen lds
    s_waitcnt vmcnt(7)
    v_max_f32 v177, 0, v177
    v_cvt_pk_bf16_f32 v120, v174, v175
    v_cvt_pk_bf16_f32 v121, v176, v177
    v_max_f32 v198, 0, v198
    v_max_f32 v199, 0, v199
    v_mfma_f32_16x16x16_bf16 v[114:117], v[172:173], v[120:121], 0
    v_max_f32 v200, 0, v200
    v_max_f32 v201, 0, v201
    v_cvt_pk_bf16_f32 v120, v198, v199
    v_cvt_pk_bf16_f32 v121, v200, v201
    v_max_f32 v210, 0, v210
    v_max_f32 v211, 0, v211
    v_mfma_f32_16x16x16_bf16 v[174:177], v[172:173], v[120:121], 0
    buffer_load_dwordx4 v135, s[48:51], s4 offen offset:1024 lds
    v_cvt_pk_bf16_f32 v114, v114, v114
    v_and_b32 v114, 0xffff0000, v114
    v_mul_f32 v114, 0xbfb8aa3b, v114
    v_exp_f32 v114, v114
    v_max_f32 v212, 0, v212
    v_add_f32 v114, 1.0, v114
    v_rcp_f32 v114, v114
    v_cvt_pk_bf16_f32 v174, v174, v174
    v_cvt_pk_bf16_f32 v114, v114, v114
    v_and_b32 v114, 0xffff0000, v114
    v_add_f32 v114, -0.5, v114
    v_mul_f32 v114, 0x41b8aa3b, v114
    buffer_load_dwordx4 v137, s[48:51], s4 offen offset:2048 lds
    ds_write_b32 v146, v114 offset:0
    s_add_u32 m0, s72, 3072
    s_add_u32 s4, s45, 184704
    v_and_b32 v174, 0xffff0000, v174
    v_mul_f32 v174, 0xbfb8aa3b, v174
    v_exp_f32 v174, v174
    v_max_f32 v213, 0, v213
    v_add_f32 v174, 1.0, v174
    v_rcp_f32 v174, v174
    v_cvt_pk_bf16_f32 v210, v210, v211
    v_cvt_pk_bf16_f32 v174, v174, v174
    s_waitcnt vmcnt(6)
    buffer_load_dwordx4 v133, s[48:51], s4 offen lds
    ds_read_b64_tr_b16 a[80:81], v126 offset:0
    ds_read_b64_tr_b16 a[82:83], v126 offset:768
    ds_read_b64_tr_b16 a[104:105], v126 offset:32
    ds_read_b64_tr_b16 a[106:107], v126 offset:800
    ds_read_b64_tr_b16 a[128:129], v126 offset:64
    ds_read_b64_tr_b16 a[130:131], v126 offset:832
    v_and_b32 v174, 0xffff0000, v174
    v_add_f32 v174, -0.5, v174
    v_mul_f32 v174, 0x41b8aa3b, v174
    ds_write_b32 v146, v174 offset:4
    v_cvt_pk_bf16_f32 v211, v212, v213
    buffer_load_dwordx4 v135, s[48:51], s4 offen offset:1024 lds
    v_lshlrev_b32 v141, 16, v141
    v_mfma_f32_16x16x16_bf16 v[114:117], v[172:173], v[210:211], 0
    v_max_f32 v141, 0xc2c80000, v141
    v_min_f32 v141, 0x40930000, v141
    v_mul_f32 v141, 0x3fb8aa3b, v141
    v_exp_f32 v141, v141
    v_cndmask_b32 v118, v151, v131, vcc
    v_cvt_pk_bf16_f32 v141, v141, v141
    v_and_b32 v141, 0xffff0000, v141
    v_mul_f32 v131, 0x3fb8aa3b, v141
    v_cvt_pk_bf16_f32 v114, v114, v114
    v_and_b32 v114, 0xffff0000, v114
    v_mul_f32 v114, 0xbfb8aa3b, v114
    buffer_load_dwordx4 v137, s[48:51], s4 offen offset:2048 lds
    s_add_u32 m0, s73, 0
    s_add_u32 s4, s45, 36864
    v_exp_f32 v114, v114
    v_readfirstlane_b32 s37, v141
    v_add_f32 v114, 1.0, v114
    v_rcp_f32 v114, v114
    v_readfirstlane_b32 s31, v131
    v_cvt_pk_bf16_f32 v114, v114, v114
    v_and_b32 v114, 0xffff0000, v114
    v_add_f32 v114, -0.5, v114
    v_mul_f32 v114, 0x41b8aa3b, v114
    ds_write_b32 v146, v114 offset:8
    s_waitcnt vmcnt(6)
    buffer_load_dwordx4 v133, s[48:51], s45 offen lds
    v_cmp_gt_u32 vcc, 4, v149
    ds_read_b64_tr_b16 a[84:85], v126 offset:3072
    ds_read_b64_tr_b16 a[86:87], v126 offset:3840
    ds_read_b64_tr_b16 a[108:109], v126 offset:3104
    ds_read_b64_tr_b16 a[110:111], v126 offset:3872
    ds_read_b64_tr_b16 a[132:133], v126 offset:3136
    ds_read_b64_tr_b16 a[134:135], v126 offset:3904
    v_cndmask_b32 v149, v138, v136, vcc
    v_cmp_gt_u32 vcc, 4, v156
    v_lshl_add_u32 v120, v119, 3, v148
    v_add3_u32 v120, v120, 64, s68
    v_cndmask_b32 v156, v140, v139, vcc
    buffer_load_dwordx4 v135, s[48:51], s45 offen offset:1024 lds
    v_add3_u32 v15, v15, v149, v156
    v_add3_u32 v18, v18, v149, v156
    v_cmp_gt_u32 vcc, 4, v158
    v_add3_u32 v131, v148, v147, s69
    v_lshl_add_u32 v121, v119, 3, v148
    s_waitcnt lgkmcnt(6)
    s_barrier
    ds_read_b32 v22, v22 offset:0
    ds_read_b32 v23, v23 offset:672
    ds_read_b32 v24, v24 offset:0
    ds_read_b32 v25, v25 offset:672
    ds_read_b32 v26, v26 offset:0
    ds_read_b32 v27, v27 offset:672
    ds_read_b32 v46, v46 offset:336
    ds_read_b32 v58, v58 offset:336
    buffer_load_dwordx4 v137, s[48:51], s45 offen offset:2048 lds
    ds_read_b32 v70, v70 offset:336
    ds_read_b32 v47, v47 offset:332
    ds_read_b32 v59, v59 offset:332
    s_add_u32 m0, s73, 3072
    ds_read_b32 v71, v71 offset:332
    v_cndmask_b32 v158, v138, v136, vcc
    v_cmp_gt_u32 vcc, 4, v157
    ds_read_b32 v48, v48 offset:328
    ds_read_b32 v60, v60 offset:328
    ds_read_b32 v72, v72 offset:328
    ds_read_b32 v49, v49 offset:324
    s_waitcnt vmcnt(6)
    ds_read_b64_tr_b16 a[88:89], v129 offset:0
    buffer_load_dwordx4 v133, s[48:51], s4 offen lds
    ds_read_b64_tr_b16 a[90:91], v129 offset:768
    ds_read_b64_tr_b16 a[112:113], v129 offset:32
    ds_read_b64_tr_b16 a[114:115], v129 offset:800
    ds_read_b64_tr_b16 a[136:137], v129 offset:64
    ds_read_b64_tr_b16 a[138:139], v129 offset:832
    v_cndmask_b32 v157, v140, v139, vcc
    v_add3_u32 v16, v16, v158, v157
    v_add3_u32 v19, v19, v158, v157
    v_cmp_gt_u32 vcc, 4, v154
    ds_read_b32 v61, v61 offset:324
    ds_read_b32 v73, v73 offset:324
    ds_read_b32 v50, v50 offset:272
    buffer_load_dwordx4 v135, s[48:51], s4 offen offset:1024 lds
    ds_read_b32 v62, v62 offset:272
    ds_read_b32 v74, v74 offset:272
    ds_read_b32 v51, v51 offset:268
    ds_read_b32 v63, v63 offset:268
    ds_read_b32 v75, v75 offset:268
    v_cndmask_b32 v154, v138, v136, vcc
    v_cmp_gt_u32 vcc, 4, v150
    ds_read_b32 v52, v52 offset:264
    ds_read_b32 v64, v64 offset:264
    ds_read_b32 v76, v76 offset:264
    ds_read_b32 v53, v53 offset:260
    v_cndmask_b32 v150, v140, v139, vcc
    buffer_load_dwordx4 v137, s[48:51], s4 offen offset:2048 lds
    ds_read_b32 v65, v65 offset:260
    ds_read_b32 v77, v77 offset:260
    ds_read_b32 v54, v54 offset:208
    ds_read_b32 v66, v66 offset:208
    ds_read_b32 v78, v78 offset:208
    s_add_u32 m0, s68, 0
    ds_read_b32 v55, v55 offset:204
    s_add_u32 s4, s45, 73728
    ds_read_b32 v67, v67 offset:204
    v_add3_u32 v17, v17, v154, v150
    v_add3_u32 v20, v20, v154, v150
    v_cmp_gt_u32 vcc, 2, v119
    ds_read_b32 v79, v79 offset:204
    s_waitcnt vmcnt(6)
    buffer_load_dwordx4 v133, s[48:51], s4 offen lds
    ds_read_b64_tr_b16 a[92:93], v129 offset:3072
    ds_read_b64_tr_b16 a[94:95], v129 offset:3840
    ds_read_b64_tr_b16 a[116:117], v129 offset:3104
    ds_read_b64_tr_b16 a[118:119], v129 offset:3872
    ds_read_b64_tr_b16 a[140:141], v129 offset:3136
    ds_read_b64_tr_b16 a[142:143], v129 offset:3904
    ds_read_b32 v56, v56 offset:200
    v_cndmask_b32 v152, v160, v152, vcc
    v_lshl_add_u32 v152, v127, 9, v152
    v_lshl_add_u32 v152, v122, 1, v152
    v_cmp_gt_u32 vcc, 3, v119
    ds_read_b32 v68, v68 offset:200
    ds_read_b32 v80, v80 offset:200
    ds_read_b32 v57, v57 offset:196
    buffer_load_dwordx4 v135, s[48:51], s4 offen offset:1024 lds
    ds_read_b32 v69, v69 offset:196
    ds_read_b32 v81, v81 offset:196
    ds_read_b32 v155, v155 offset:336
    v_cndmask_b32 v7, v161, v152, vcc
    v_cmp_gt_u32 vcc, 8, v130
    v_lshl_add_u32 v130, v119, 2, 0
    v_mul_u32_u24 v129, 37, v130
    v_cndmask_b32 v159, v185, v159, vcc
    v_cndmask_b32 v169, v185, v169, vcc
    v_cmp_gt_u32 vcc, 2, v119
    v_lshrrev_b32 v129, 8, v129
    v_mul_u32_u24 v127, 7, v129
    v_cndmask_b32 v168, v185, v168, vcc
    v_cmp_ne_u32 vcc, s92, v170
    buffer_load_dwordx4 v137, s[48:51], s4 offen offset:2048 lds
    s_add_u32 m0, s68, 3072
    s_add_u32 s4, s45, 110592
    v_cndmask_b32 v136, 0, v254, vcc
    s_waitcnt lgkmcnt(6)
    v_add_f32 v22, v22, v136
    v_cmp_ne_u32 vcc, s92, v170
    v_sub_u32 v127, v130, v127
    v_lshrrev_b32 v129, 2, v129
    v_cndmask_b32 v130, 0, v254, vcc
    v_add_f32 v23, v23, v130
    v_cmp_ne_u32 vcc, s92, v255
    v_lshrrev_b32 v127, 2, v127
    s_waitcnt lgkmcnt(0)
    v_readfirstlane_b32 s39, v155
    buffer_load_dwordx4 v133, s[48:51], s4 offen lds
    s_waitcnt vmcnt(7)
    ds_read_b64_tr_b16 a[0:1], v142 offset:0
    ds_read_b64_tr_b16 a[2:3], v142 offset:768
    ds_read_b64_tr_b16 a[24:25], v142 offset:32
    ds_read_b64_tr_b16 a[26:27], v142 offset:800
    ds_read_b64_tr_b16 a[48:49], v142 offset:64
    ds_read_b64_tr_b16 a[50:51], v142 offset:832
    v_cndmask_b32 v130, 0, v254, vcc
    v_add_f32 v24, v24, v130
    v_cmp_ne_u32 vcc, s92, v255
    v_and_b32 v129, s5, v129
    v_and_b32 v127, s6, v127
    v_cndmask_b32 v130, 0, v254, vcc
    v_add_f32 v25, v25, v130
    buffer_load_dwordx4 v135, s[48:51], s4 offen offset:1024 lds
    v_cmp_ne_u32 vcc, s92, v171
    v_lshl_or_b32 v129, v129, 1, v127
    v_lshl_add_u32 v127, v119, 2, 1
    v_cndmask_b32 v130, 0, v254, vcc
    v_add_f32 v26, v26, v130
    v_cmp_ne_u32 vcc, s92, v171
    v_mul_u32_u24 v130, 37, v127
    v_lshrrev_b32 v130, 8, v130
    v_cndmask_b32 v136, 0, v254, vcc
    v_add_f32 v27, v27, v136
    v_cmp_ne_u32 vcc, v129, v170
    v_mul_u32_u24 v136, 7, v130
    v_sub_u32 v136, v127, v136
    v_cndmask_b32 v127, 0, v254, vcc
    buffer_load_dwordx4 v137, s[48:51], s4 offen offset:2048 lds
    s_add_u32 m0, s69, 0
    s_add_u32 s4, s45, 147456
    v_add_f32 v46, v46, v127
    v_cmp_ne_u32 vcc, v129, v255
    v_lshrrev_b32 v130, 2, v130
    v_lshrrev_b32 v136, 2, v136
    v_cndmask_b32 v127, 0, v254, vcc
    v_add_f32 v58, v58, v127
    v_cmp_ne_u32 vcc, v129, v171
    v_and_b32 v130, s5, v130
    v_and_b32 v136, s6, v136
    v_cndmask_b32 v127, 0, v254, vcc
    v_add_f32 v70, v70, v127
    v_lshl_or_b32 v130, v130, 1, v136
    buffer_load_dwordx4 v133, s[48:51], s4 offen lds
    s_waitcnt vmcnt(7)
    ds_read_b64_tr_b16 a[4:5], v142 offset:3072
    ds_read_b64_tr_b16 a[6:7], v142 offset:3840
    ds_read_b64_tr_b16 a[28:29], v142 offset:3104
    ds_read_b64_tr_b16 a[30:31], v142 offset:3872
    ds_read_b64_tr_b16 a[52:53], v142 offset:3136
    ds_read_b64_tr_b16 a[54:55], v142 offset:3904
    v_cmp_ne_u32 vcc, v130, v170
    v_lshl_add_u32 v136, v119, 2, 2
    v_mul_u32_u24 v142, 37, v136
    v_cndmask_b32 v127, 0, v254, vcc
    v_add_f32 v47, v47, v127
    v_cmp_ne_u32 vcc, v130, v255
    v_lshrrev_b32 v142, 8, v142
    buffer_load_dwordx4 v135, s[48:51], s4 offen offset:1024 lds
    v_cndmask_b32 v127, 0, v254, vcc
    v_add_f32 v59, v59, v127
    v_cmp_ne_u32 vcc, v130, v171
    v_mul_u32_u24 v127, 7, v142
    v_sub_u32 v127, v136, v127
    v_cndmask_b32 v130, 0, v254, vcc
    v_add_f32 v71, v71, v130
    v_lshrrev_b32 v142, 2, v142
    v_lshrrev_b32 v127, 2, v127
    v_and_b32 v142, s5, v142
    v_and_b32 v127, s6, v127
    v_lshl_or_b32 v142, v142, 1, v127
    v_cmp_ne_u32 vcc, v142, v170
    v_lshl_add_u32 v130, v119, 2, 3
    buffer_load_dwordx4 v137, s[48:51], s4 offen offset:2048 lds
    s_add_u32 m0, s69, 3072
    s_add_u32 s4, s45, 184320
    v_cndmask_b32 v136, 0, v254, vcc
    v_add_f32 v48, v48, v136
    v_cmp_ne_u32 vcc, v142, v255
    v_mul_u32_u24 v127, 37, v130
    v_lshrrev_b32 v127, 8, v127
    v_cndmask_b32 v136, 0, v254, vcc
    v_add_f32 v60, v60, v136
    v_cmp_ne_u32 vcc, v142, v171
    v_mul_u32_u24 v129, 7, v127
    v_sub_u32 v129, v130, v129
    v_cndmask_b32 v130, 0, v254, vcc
    v_add_f32 v72, v72, v130
    buffer_load_dwordx4 v133, s[48:51], s4 offen lds
    s_waitcnt vmcnt(7)
    ds_read_b64_tr_b16 a[8:9], v128 offset:0
    ds_read_b64_tr_b16 a[10:11], v128 offset:768
    ds_read_b64_tr_b16 a[32:33], v128 offset:32
    ds_read_b64_tr_b16 a[34:35], v128 offset:800
    ds_read_b64_tr_b16 a[56:57], v128 offset:64
    ds_read_b64_tr_b16 a[58:59], v128 offset:832
    v_lshrrev_b32 v127, 2, v127
    v_lshrrev_b32 v129, 2, v129
    v_and_b32 v127, s5, v127
    v_and_b32 v129, s6, v129
    v_lshl_or_b32 v127, v127, 1, v129
    v_cmp_ne_u32 vcc, v127, v170
    v_lshl_add_u32 v130, v119, 2, 16
    buffer_load_dwordx4 v135, s[48:51], s4 offen offset:1024 lds
    v_cndmask_b32 v129, 0, v254, vcc
    v_add_f32 v49, v49, v129
    v_cmp_ne_u32 vcc, v127, v255
    v_mul_u32_u24 v142, 37, v130
    v_lshrrev_b32 v142, 8, v142
    v_cndmask_b32 v129, 0, v254, vcc
    v_add_f32 v61, v61, v129
    v_cmp_ne_u32 vcc, v127, v171
    v_mul_u32_u24 v136, 7, v142
    v_sub_u32 v136, v130, v136
    v_cndmask_b32 v130, 0, v254, vcc
    v_add_f32 v73, v73, v130
    v_lshrrev_b32 v142, 2, v142
    v_lshrrev_b32 v136, 2, v136
    buffer_load_dwordx4 v137, s[48:51], s4 offen offset:2048 lds
    s_add_u32 m0, s68, 0
    s_add_u32 s4, s45, 768
    s_waitcnt lgkmcnt(0)
    v_and_b32 v142, s5, v142
    v_and_b32 v136, s6, v136
    v_lshl_or_b32 v142, v142, 1, v136
    v_cmp_ne_u32 vcc, v142, v170
    v_lshl_add_u32 v127, v119, 2, 17
    v_mul_u32_u24 v130, 37, v127
    v_cndmask_b32 v136, 0, v254, vcc
    v_add_f32 v50, v50, v136
    v_cmp_ne_u32 vcc, v142, v255
    v_lshrrev_b32 v130, 8, v130
    v_mul_u32_u24 v136, 7, v130
    buffer_load_dwordx4 v133, s[48:51], s4 offen lds
    s_waitcnt vmcnt(7)
    ds_read_b64_tr_b16 a[12:13], v128 offset:3072
    ds_read_b64_tr_b16 a[14:15], v128 offset:3840
    ds_read_b64_tr_b16 a[36:37], v128 offset:3104
    ds_read_b64_tr_b16 a[38:39], v128 offset:3872
    ds_read_b64_tr_b16 a[60:61], v128 offset:3136
    ds_read_b64_tr_b16 a[62:63], v128 offset:3904
    v_cndmask_b32 v129, 0, v254, vcc
    v_add_f32 v62, v62, v129
    v_cmp_ne_u32 vcc, v142, v171
    v_sub_u32 v136, v127, v136
    v_lshrrev_b32 v130, 2, v130
    v_cndmask_b32 v142, 0, v254, vcc
    v_add_f32 v74, v74, v142
    buffer_load_dwordx4 v135, s[48:51], s4 offen offset:1024 lds
    v_lshrrev_b32 v136, 2, v136
    v_and_b32 v130, s5, v130
    v_and_b32 v136, s6, v136
    v_lshl_or_b32 v130, v130, 1, v136
    v_cmp_ne_u32 vcc, v130, v170
    v_lshl_add_u32 v127, v119, 2, 18
    v_mul_u32_u24 v142, 37, v127
    v_cndmask_b32 v136, 0, v254, vcc
    v_add_f32 v51, v51, v136
    v_cmp_ne_u32 vcc, v130, v255
    v_lshrrev_b32 v142, 8, v142
    v_mul_u32_u24 v129, 7, v142
    v_cndmask_b32 v136, 0, v254, vcc
    v_add_f32 v63, v63, v136
    buffer_load_dwordx4 v137, s[48:51], s4 offen offset:2048 lds
    s_add_u32 m0, s68, 3072
    s_add_u32 s4, s45, 37632
    s_waitcnt lgkmcnt(0)
    v_cmp_ne_u32 vcc, v130, v171
    v_sub_u32 v129, v127, v129
    v_lshrrev_b32 v142, 2, v142
    v_cndmask_b32 v130, 0, v254, vcc
    v_add_f32 v75, v75, v130
    v_lshrrev_b32 v129, 2, v129
    v_and_b32 v142, s5, v142
    v_and_b32 v129, s6, v129
    v_lshl_or_b32 v142, v142, 1, v129
    v_cmp_ne_u32 vcc, v142, v170
    v_lshl_add_u32 v136, v119, 2, 19
    buffer_load_dwordx4 v133, s[48:51], s4 offen lds
    s_waitcnt vmcnt(7)
    ds_read_b64_tr_b16 a[16:17], v126 offset:0
    ds_read_b64_tr_b16 a[18:19], v126 offset:768
    ds_read_b64_tr_b16 a[40:41], v126 offset:32
    ds_read_b64_tr_b16 a[42:43], v126 offset:800
    ds_read_b64_tr_b16 a[64:65], v126 offset:64
    ds_read_b64_tr_b16 a[66:67], v126 offset:832
    v_cndmask_b32 v130, 0, v254, vcc
    v_add_f32 v52, v52, v130
    v_cmp_ne_u32 vcc, v142, v255
    v_mul_u32_u24 v127, 37, v136
    v_lshrrev_b32 v127, 8, v127
    v_cndmask_b32 v130, 0, v254, vcc
    v_add_f32 v64, v64, v130
    buffer_load_dwordx4 v135, s[48:51], s4 offen offset:1024 lds
    v_cmp_ne_u32 vcc, v142, v171
    v_mul_u32_u24 v130, 7, v127
    v_sub_u32 v130, v136, v130
    v_cndmask_b32 v136, 0, v254, vcc
    v_add_f32 v76, v76, v136
    v_lshrrev_b32 v127, 2, v127
    v_lshrrev_b32 v130, 2, v130
    v_and_b32 v127, s5, v127
    v_and_b32 v130, s6, v130
    v_lshl_or_b32 v127, v127, 1, v130
    v_cmp_ne_u32 vcc, v127, v170
    v_lshl_add_u32 v130, v119, 2, 32
    v_mul_u32_u24 v142, 37, v130
    v_cndmask_b32 v136, 0, v254, vcc
    buffer_load_dwordx4 v137, s[48:51], s4 offen offset:2048 lds
    s_add_u32 m0, s69, 0
    s_add_u32 s4, s45, 74496
    s_waitcnt lgkmcnt(0)
    v_add_f32 v53, v53, v136
    v_cmp_ne_u32 vcc, v127, v255
    v_lshrrev_b32 v142, 8, v142
    v_mul_u32_u24 v136, 7, v142
    v_cndmask_b32 v129, 0, v254, vcc
    v_add_f32 v65, v65, v129
    v_cmp_ne_u32 vcc, v127, v171
    v_sub_u32 v136, v130, v136
    v_lshrrev_b32 v142, 2, v142
    v_cndmask_b32 v130, 0, v254, vcc
    v_add_f32 v77, v77, v130
    buffer_load_dwordx4 v133, s[48:51], s4 offen lds
    s_waitcnt vmcnt(7)
    ds_read_b64_tr_b16 a[20:21], v126 offset:3072
    ds_read_b64_tr_b16 a[22:23], v126 offset:3840
    ds_read_b64_tr_b16 a[44:45], v126 offset:3104
    ds_read_b64_tr_b16 a[46:47], v126 offset:3872
    ds_read_b64_tr_b16 a[68:69], v126 offset:3136
    ds_read_b64_tr_b16 a[70:71], v126 offset:3904
    v_lshrrev_b32 v136, 2, v136
    v_and_b32 v142, s5, v142
    v_and_b32 v136, s6, v136
    v_lshl_or_b32 v142, v142, 1, v136
    v_cmp_ne_u32 vcc, v142, v170
    v_lshl_add_u32 v130, v119, 2, 33
    v_mul_u32_u24 v136, 37, v130
    buffer_load_dwordx4 v135, s[48:51], s4 offen offset:1024 lds
    v_cndmask_b32 v127, 0, v254, vcc
    v_add_f32 v54, v54, v127
    v_cmp_ne_u32 vcc, v142, v255
    v_lshrrev_b32 v136, 8, v136
    v_mul_u32_u24 v127, 7, v136
    v_cndmask_b32 v129, 0, v254, vcc
    v_add_f32 v66, v66, v129
    v_cmp_ne_u32 vcc, v142, v171
    v_sub_u32 v127, v130, v127
    v_lshrrev_b32 v136, 2, v136
    v_cndmask_b32 v129, 0, v254, vcc
    v_add_f32 v78, v78, v129
    v_lshrrev_b32 v127, 2, v127
    v_and_b32 v136, s5, v136
    buffer_load_dwordx4 v137, s[48:51], s4 offen offset:2048 lds
    s_add_u32 m0, s69, 3072
    s_add_u32 s4, s45, 111360
    s_waitcnt lgkmcnt(0)
    v_and_b32 v127, s6, v127
    v_lshl_or_b32 v136, v136, 1, v127
    v_cmp_ne_u32 vcc, v136, v170
    v_lshl_add_u32 v130, v119, 2, 34
    v_mul_u32_u24 v129, 37, v130
    v_cndmask_b32 v127, 0, v254, vcc
    v_add_f32 v55, v55, v127
    v_cmp_ne_u32 vcc, v136, v255
    v_lshrrev_b32 v129, 8, v129
    v_mul_u32_u24 v142, 7, v129
    v_cndmask_b32 v127, 0, v254, vcc
    buffer_load_dwordx4 v133, s[48:51], s4 offen lds
    s_waitcnt vmcnt(7)
    ds_read_b64_tr_b16 a[144:145], v128 offset:0
    ds_read_b64_tr_b16 a[146:147], v128 offset:768
    ds_read_b64_tr_b16 a[168:169], v128 offset:32
    ds_read_b64_tr_b16 a[170:171], v128 offset:800
    ds_read_b64_tr_b16 a[192:193], v128 offset:64
    ds_read_b64_tr_b16 a[194:195], v128 offset:832
    v_add_f32 v67, v67, v127
    v_cmp_ne_u32 vcc, v136, v171
    v_sub_u32 v142, v130, v142
    v_lshrrev_b32 v129, 2, v129
    v_cndmask_b32 v127, 0, v254, vcc
    v_add_f32 v79, v79, v127
    v_lshrrev_b32 v142, 2, v142
    buffer_load_dwordx4 v135, s[48:51], s4 offen offset:1024 lds
    v_and_b32 v129, s5, v129
    v_and_b32 v142, s6, v142
    v_lshl_or_b32 v129, v129, 1, v142
    v_cmp_ne_u32 vcc, v129, v170
    v_lshl_add_u32 v130, v119, 2, 35
    v_mul_u32_u24 v119, 37, v130
    v_cndmask_b32 v127, 0, v254, vcc
    v_add_f32 v56, v56, v127
    v_cmp_ne_u32 vcc, v129, v255
    v_lshrrev_b32 v119, 8, v119
    v_mul_u32_u24 v136, 7, v119
    v_cndmask_b32 v127, 0, v254, vcc
    v_add_f32 v68, v68, v127
    v_cmp_ne_u32 vcc, v129, v171
    buffer_load_dwordx4 v137, s[48:51], s4 offen offset:2048 lds
    s_add_u32 m0, s68, 0
    s_add_u32 s4, s45, 148224
    s_waitcnt lgkmcnt(0)
    v_cndmask_b32 v142, 0, v254, vcc
    v_add_f32 v80, v80, v142
    v_sub_u32 v136, v130, v136
    v_lshrrev_b32 v119, 2, v119
    v_lshrrev_b32 v136, 2, v136
    v_and_b32 v119, s5, v119
    v_and_b32 v136, s6, v136
    v_lshl_or_b32 v119, v119, 1, v136
    v_cmp_ne_u32 vcc, v119, v170
    v_cndmask_b32 v22, v162, v22, s[88:89]
    v_cndmask_b32 v24, v162, v24, s[88:89]
    buffer_load_dwordx4 v133, s[48:51], s4 offen lds
    s_waitcnt vmcnt(7)
    ds_read_b64_tr_b16 a[148:149], v128 offset:3072
    ds_read_b64_tr_b16 a[150:151], v128 offset:3840
    ds_read_b64_tr_b16 a[172:173], v128 offset:3104
    ds_read_b64_tr_b16 a[174:175], v128 offset:3872
    ds_read_b64_tr_b16 a[196:197], v128 offset:3136
    ds_read_b64_tr_b16 a[198:199], v128 offset:3904
    v_cndmask_b32 v130, 0, v254, vcc
    v_add_f32 v57, v57, v130
    v_cmp_ne_u32 vcc, v119, v255
    v_cndmask_b32 v26, v162, v26, s[88:89]
    v_add3_u32 v121, v121, 64, s69
    v_cndmask_b32 v130, 0, v254, vcc
    v_add_f32 v69, v69, v130
    buffer_load_dwordx4 v135, s[48:51], s4 offen offset:1024 lds
    v_cmp_ne_u32 vcc, v119, v171
    v_mov_b32 v122, 0
    v_mov_b32 v123, 0
    v_cndmask_b32 v119, 0, v254, vcc
    v_add_f32 v81, v81, v119
    ds_read_b128 v[198:201], v164 offset:0
    ds_read_b128 v[114:117], v163 offset:0
    ds_read_b128 v[182:185], v164 offset:128
    ds_read_b128 v[138:141], v163 offset:128
    ds_read_b128 v[170:173], v164 offset:256
    buffer_load_dwordx4 v137, s[48:51], s4 offen offset:2048 lds
    s_add_u32 m0, s68, 3072
    ds_read_b128 v[174:177], v163 offset:256
    s_add_u32 s4, s45, 185088
    s_waitcnt lgkmcnt(6)
    v_mov_b32 v124, 0
    v_mov_b32 v125, 0
    ds_write_b128 v167, v[122:125] offset:16
    s_waitcnt vmcnt(6)
    buffer_load_dwordx4 v133, s[48:51], s4 offen lds
    s_waitcnt lgkmcnt(4)
    v_mfma_f32_16x16x32_bf16 v[146:149], a[72:75], v[198:201], 0
    v_mfma_f32_16x16x32_bf16 v[146:149], a[76:79], v[114:117], v[146:149]
    s_waitcnt lgkmcnt(3)
    ds_read_b64_tr_b16 a[152:153], v126 offset:0
    ds_read_b64_tr_b16 a[154:155], v126 offset:768
    v_mfma_f32_16x16x32_bf16 v[146:149], a[80:83], v[182:185], v[146:149]
    s_waitcnt lgkmcnt(4)
    ds_read_b64_tr_b16 a[176:177], v126 offset:32
    ds_read_b64_tr_b16 a[178:179], v126 offset:800
    v_mfma_f32_16x16x32_bf16 v[146:149], a[84:87], v[138:141], v[146:149]
    s_waitcnt lgkmcnt(5)
    ds_read_b64_tr_b16 a[200:201], v126 offset:64
    ds_read_b64_tr_b16 a[202:203], v126 offset:832
    v_mfma_f32_16x16x32_bf16 v[146:149], a[88:91], v[170:173], v[146:149]
    buffer_load_dwordx4 v135, s[48:51], s4 offen offset:1024 lds
    v_mfma_f32_16x16x32_bf16 v[146:149], a[92:95], v[174:177], v[146:149]
    ds_write_b64 v167, v[122:123] offset:56
    v_mfma_f32_16x16x32_bf16 v[154:157], a[96:99], v[198:201], 0
    v_mfma_f32_16x16x32_bf16 v[154:157], a[100:103], v[114:117], v[154:157]
    ds_write_b64 v167, v[122:123] offset:64
    v_mfma_f32_16x16x32_bf16 v[154:157], a[104:107], v[182:185], v[154:157]
    s_waitcnt lgkmcnt(6)
    buffer_load_dwordx4 v137, s[48:51], s4 offen offset:2048 lds
    v_mfma_f32_16x16x32_bf16 v[154:157], a[108:111], v[138:141], v[154:157]
    s_add_u32 m0, s28, 8192
    ds_read_b128 v[222:225], v164 offset:6144
    v_fma_f32 v119, v146, v146, s32
    v_mfma_f32_16x16x32_bf16 v[154:157], a[112:115], v[170:173], v[154:157]
    s_add_u32 s4, 0, 12288
    ds_read_b128 v[226:229], v163 offset:6144
    v_fmac_f32 v119, v147, v147
    v_mfma_f32_16x16x32_bf16 v[154:157], a[116:119], v[174:177], v[154:157]
    s_waitcnt lgkmcnt(4)
    ds_read_b128 v[242:245], v164 offset:6272
    s_waitcnt vmcnt(6)
    v_mfma_f32_16x16x32_bf16 v[178:181], a[120:123], v[198:201], 0
    ds_read_b64_tr_b16 a[156:157], v126 offset:3072
    ds_read_b64_tr_b16 a[158:159], v126 offset:3840
    v_mfma_f32_16x16x32_bf16 v[178:181], a[124:127], v[114:117], v[178:181]
    buffer_load_dwordx4 v12, s[8:11], s25 offen nt lds
    v_mfma_f32_16x16x32_bf16 v[178:181], a[128:131], v[182:185], v[178:181]
    s_add_u32 m0, s28, 12288
    ds_read_b64_tr_b16 a[180:181], v126 offset:3104
    ds_read_b64_tr_b16 a[182:183], v126 offset:3872
    v_mfma_f32_16x16x32_bf16 v[178:181], a[132:135], v[138:141], v[178:181]
    ds_read_b64_tr_b16 a[204:205], v126 offset:3136
    ds_read_b64_tr_b16 a[206:207], v126 offset:3904
    v_mfma_f32_16x16x32_bf16 v[178:181], a[136:139], v[170:173], v[178:181]
    ds_read_b128 v[190:193], v163 offset:6272
    ds_read_b128 v[218:221], v164 offset:6400
    v_mfma_f32_16x16x32_bf16 v[178:181], a[140:143], v[174:177], v[178:181]
    s_waitcnt lgkmcnt(10)
    ds_read_b128 v[206:209], v163 offset:6400
    v_fmac_f32 v119, v148, v148
    v_mfma_f32_16x16x32_bf16 v[150:153], a[72:75], v[222:225], 0
    s_waitcnt lgkmcnt(10)
    buffer_load_dwordx4 v13, s[8:11], s25 offen nt lds
    v_mfma_f32_16x16x32_bf16 v[150:153], a[76:79], v[226:229], v[150:153]
    s_waitcnt lgkmcnt(9)
    ds_write_b128 v159, v[122:125] offset:16
    v_mfma_f32_16x16x32_bf16 v[150:153], a[80:83], v[242:245], v[150:153]
    s_add_u32 m0, s29, 0
    v_fmac_f32 v119, v149, v149
    v_fmac_f32 v119, v154, v154
    v_mfma_f32_16x16x32_bf16 v[186:189], a[96:99], v[222:225], 0
    s_waitcnt lgkmcnt(6)
    v_fmac_f32 v119, v155, v155
    v_fmac_f32 v119, v156, v156
    v_mfma_f32_16x16x32_bf16 v[186:189], a[100:103], v[226:229], v[186:189]
    s_waitcnt lgkmcnt(4)
    buffer_load_dwordx4 v14, s[8:11], s25 offen nt lds
    v_mfma_f32_16x16x32_bf16 v[186:189], a[104:107], v[242:245], v[186:189]
    s_waitcnt lgkmcnt(2)
    ds_write_b64 v159, v[122:123] offset:56
    v_mfma_f32_16x16x32_bf16 v[150:153], a[84:87], v[190:193], v[150:153]
    s_add_u32 m0, s69, 0
    s_waitcnt vmcnt(6)
    v_fmac_f32 v119, v157, v157
    v_mfma_f32_16x16x32_bf16 v[150:153], a[88:91], v[218:221], v[150:153]
    s_waitcnt lgkmcnt(2)
    ds_read_b64_tr_b16 a[160:161], v128 offset:0
    ds_read_b64_tr_b16 a[162:163], v128 offset:768
    v_mfma_f32_16x16x32_bf16 v[150:153], a[92:95], v[206:209], v[150:153]
    s_cmp_lt_u32 1, s17
    ds_read_b64_tr_b16 a[184:185], v128 offset:32
    buffer_load_dwordx4 v143, s[52:55], 0 offen lds
    v_mfma_f32_16x16x32_bf16 v[186:189], a[108:111], v[190:193], v[186:189]
    s_cselect_b32 s10, s36, 0
    ds_read_b64_tr_b16 a[186:187], v128 offset:800
    ds_read_b64_tr_b16 a[208:209], v128 offset:64
    v_mfma_f32_16x16x32_bf16 v[186:189], a[112:115], v[218:221], v[186:189]
    s_mov_b32 s25, s24
    ds_read_b64_tr_b16 a[210:211], v128 offset:832
    v_fmac_f32 v119, v178, v178
    v_mfma_f32_16x16x32_bf16 v[186:189], a[116:119], v[206:209], v[186:189]
    ds_write_b64 v159, v[122:123] offset:64
    v_mfma_f32_16x16x32_bf16 v[194:197], a[120:123], v[222:225], 0
    v_fmac_f32 v119, v179, v179
    v_fmac_f32 v119, v180, v180
    v_mfma_f32_16x16x32_bf16 v[194:197], a[124:127], v[226:229], v[194:197]
    buffer_load_dwordx4 v132, s[52:55], 0 offen offset:1024 lds
    v_fmac_f32 v119, v181, v181
    v_mfma_f32_16x16x32_bf16 v[194:197], a[128:131], v[242:245], v[194:197]
    s_waitcnt lgkmcnt(6)
    v_fma_f32 v142, v150, v150, s32
    v_fmac_f32 v142, v151, v151
    v_mfma_f32_16x16x32_bf16 v[194:197], a[132:135], v[190:193], v[194:197]
    s_waitcnt lgkmcnt(4)
    v_fmac_f32 v142, v152, v152
    v_fmac_f32 v142, v153, v153
    v_mfma_f32_16x16x32_bf16 v[194:197], a[136:139], v[218:221], v[194:197]
    s_waitcnt lgkmcnt(3)
    v_fmac_f32 v142, v186, v186
    v_fmac_f32 v142, v187, v187
    v_mfma_f32_16x16x32_bf16 v[194:197], a[140:143], v[206:209], v[194:197]
    s_waitcnt lgkmcnt(1)
    v_fmac_f32 v142, v188, v188
    v_fmac_f32 v142, v189, v189
    v_mfma_f32_16x16x32_bf16 v[202:205], a[0:3], v[198:201], 0
    buffer_load_dwordx4 v118, s[52:55], 0 offen offset:2048 lds
    v_xor_b32 v254, 65536, v2
    v_mfma_f32_16x16x32_bf16 v[202:205], a[4:7], v[114:117], v[202:205]
    s_add_u32 m0, s69, 3072
    v_fmac_f32 v142, v194, v194
    v_fmac_f32 v142, v195, v195
    v_mfma_f32_16x16x32_bf16 v[202:205], a[8:11], v[182:185], v[202:205]
    v_fmac_f32 v142, v196, v196
    s_waitcnt vmcnt(6)
    v_mfma_f32_16x16x32_bf16 v[202:205], a[12:15], v[138:141], v[202:205]
    ds_read_b64_tr_b16 a[164:165], v128 offset:3072
    ds_read_b64_tr_b16 a[166:167], v128 offset:3840
    v_mfma_f32_16x16x32_bf16 v[202:205], a[16:19], v[170:173], v[202:205]
    ds_read_b64_tr_b16 a[188:189], v128 offset:3104
    ds_read_b64_tr_b16 a[190:191], v128 offset:3872
    v_mfma_f32_16x16x32_bf16 v[202:205], a[20:23], v[174:177], v[202:205]
    buffer_load_dwordx4 v143, s[52:55], s4 offen lds
    v_mfma_f32_16x16x32_bf16 v[230:233], a[24:27], v[198:201], 0
    ds_read_b64_tr_b16 a[212:213], v128 offset:3136
    ds_read_b64_tr_b16 a[214:215], v128 offset:3904
    v_mfma_f32_16x16x32_bf16 v[230:233], a[28:31], v[114:117], v[230:233]
    v_fmac_f32 v142, v197, v197
    v_lshrrev_b32 v130, 2, v254
    v_mfma_f32_16x16x32_bf16 v[230:233], a[32:35], v[182:185], v[230:233]
    v_fma_f32 v255, v202, v202, s32
    v_fmac_f32 v255, v203, v203
    v_mfma_f32_16x16x32_bf16 v[230:233], a[36:39], v[138:141], v[230:233]
    v_fmac_f32 v255, v204, v204
    v_fmac_f32 v255, v205, v205
    v_mfma_f32_16x16x32_bf16 v[230:233], a[40:43], v[170:173], v[230:233]
    buffer_load_dwordx4 v132, s[52:55], s4 offen offset:1024 lds
    v_mfma_f32_16x16x32_bf16 v[230:233], a[44:47], v[174:177], v[230:233]
    s_waitcnt lgkmcnt(4)
    v_lshrrev_b32 v133, 8, v254
    v_add_u32 v254, 157184, v254
    v_mfma_f32_16x16x32_bf16 v[214:217], a[48:51], v[198:201], 0
    s_waitcnt lgkmcnt(2)
    v_lshl_add_u32 v135, s16, 2, v254
    v_add_u32 v130, 162048, v130
    v_mfma_f32_16x16x32_bf16 v[214:217], a[52:55], v[114:117], v[214:217]
    v_fmac_f32 v255, v230, v230
    v_fmac_f32 v255, v231, v231
    v_mfma_f32_16x16x32_bf16 v[214:217], a[56:59], v[182:185], v[214:217]
    s_waitcnt lgkmcnt(0)
    v_fmac_f32 v255, v232, v232
    v_fmac_f32 v255, v233, v233
    v_mfma_f32_16x16x32_bf16 v[214:217], a[60:63], v[138:141], v[214:217]
    buffer_load_dwordx4 v118, s[52:55], s4 offen offset:2048 lds
    v_mfma_f32_16x16x32_bf16 v[214:217], a[64:67], v[170:173], v[214:217]
    s_add_u32 m0, s68, 0
    v_lshlrev_b32 v133, 4, v133
    v_add_u32 v133, 162048, v133
    v_mfma_f32_16x16x32_bf16 v[214:217], a[68:71], v[174:177], v[214:217]
    s_add_u32 s4, 0, 24576
    v_or_b32 v234, v32, v33
    v_and_b32 v234, 0xffff, v234
    v_mfma_f32_16x16x32_bf16 v[138:141], a[0:3], v[222:225], 0
    v_lshl_or_b32 v234, v234, 16, v234
    v_or_b32 v235, v32, v33
    v_mfma_f32_16x16x32_bf16 v[138:141], a[4:7], v[226:229], v[138:141]
    v_and_b32 v235, 0xffff, v235
    v_fmac_f32 v255, v214, v214
    v_mfma_f32_16x16x32_bf16 v[138:141], a[8:11], v[242:245], v[138:141]
    buffer_load_dwordx4 v143, s[52:55], s4 offen lds
    v_mfma_f32_16x16x32_bf16 v[138:141], a[12:15], v[190:193], v[138:141]
    v_fmac_f32 v255, v215, v215
    v_fmac_f32 v255, v216, v216
    v_mfma_f32_16x16x32_bf16 v[138:141], a[16:19], v[218:221], v[138:141]
    v_fmac_f32 v255, v217, v217
    v_cvt_pk_bf16_f32 v36, v255, v119
    v_mfma_f32_16x16x32_bf16 v[138:141], a[20:23], v[206:209], v[138:141]
    v_lshl_or_b32 v235, v235, 16, v235
    v_or_b32 v236, v32, v33
    v_mfma_f32_16x16x32_bf16 v[114:117], v[32:35], v[36:39], 0
    v_lshrrev_b32 v236, 16, v236
    v_lshl_or_b32 v236, v236, 16, v236
    v_mfma_f32_16x16x32_bf16 v[238:241], a[24:27], v[222:225], 0
    v_or_b32 v237, v32, v33
    v_lshrrev_b32 v237, 16, v237
    v_mfma_f32_16x16x32_bf16 v[238:241], a[28:31], v[226:229], v[238:241]
    v_lshl_or_b32 v237, v237, 16, v237
    v_fma_f32 v119, v138, v138, s32
    v_mfma_f32_16x16x32_bf16 v[238:241], a[32:35], v[242:245], v[238:241]
    v_rsq_f32 v115, v115
    v_mfma_f32_16x16x32_bf16 v[238:241], a[36:39], v[190:193], v[238:241]
    ds_read_b128 v[182:185], v0 offset:20480
    v_mul_f32 v146, v115, v146
    v_mfma_f32_16x16x32_bf16 v[238:241], a[40:43], v[218:221], v[238:241]
    ds_read_b128 v[198:201], v1 offset:20480
    v_mul_f32 v147, v115, v147
    v_mfma_f32_16x16x32_bf16 v[238:241], a[44:47], v[206:209], v[238:241]
    ds_read_b128 v[210:213], v0 offset:20608
    v_cvt_pk_f16_f32 v126, v146, v147
    v_mfma_f32_16x16x32_bf16 v[246:249], a[48:51], v[222:225], 0
    ds_read_b128 v[222:225], v1 offset:20608
    v_mul_f32 v148, v115, v148
    v_mfma_f32_16x16x32_bf16 v[246:249], a[52:55], v[226:229], v[246:249]
    ds_read_b128 v[226:229], v0 offset:20736
    v_mul_f32 v149, v115, v149
    v_mfma_f32_16x16x32_bf16 v[246:249], a[56:59], v[242:245], v[246:249]
    ds_read_b128 v[242:245], v1 offset:20736
    v_cvt_pk_f16_f32 v127, v148, v149
    v_mfma_f32_16x16x32_bf16 v[246:249], a[60:63], v[190:193], v[246:249]
    v_rsq_f32 v114, v114
    v_mfma_f32_16x16x32_bf16 v[246:249], a[64:67], v[218:221], v[246:249]
    v_mul_f32 v114, s31, v114
    v_mul_f32 v154, v115, v154
    v_mfma_f32_16x16x32_bf16 v[246:249], a[68:71], v[206:209], v[246:249]
    s_waitcnt lgkmcnt(5)
    v_mul_f32 v155, v115, v155
    v_cvt_pk_f16_f32 v128, v154, v155
    v_mfma_f32_16x16x32_bf16 v[122:125], a[96:99], v[182:185], 0
    s_waitcnt lgkmcnt(4)
    v_mul_f32 v156, v115, v156
    v_mul_f32 v157, v115, v157
    v_mfma_f32_16x16x32_bf16 v[122:125], a[100:103], v[198:201], v[122:125]
    s_waitcnt lgkmcnt(3)
    v_cvt_pk_f16_f32 v129, v156, v157
    v_mul_f32 v178, v115, v178
    v_mfma_f32_16x16x32_bf16 v[122:125], a[104:107], v[210:213], v[122:125]
    s_waitcnt lgkmcnt(2)
    ds_write_b128 v167, v[126:129]
    v_mfma_f32_16x16x32_bf16 v[122:125], a[108:111], v[222:225], v[122:125]
    s_waitcnt lgkmcnt(1)
    v_mul_f32 v179, v115, v179
    v_cvt_pk_f16_f32 v172, v178, v179
    v_mfma_f32_16x16x32_bf16 v[122:125], a[112:115], v[226:229], v[122:125]
    v_mul_f32 v180, v115, v180
    v_mul_f32 v181, v115, v181
    v_mfma_f32_16x16x32_bf16 v[122:125], a[116:119], v[242:245], v[122:125]
    v_cvt_pk_f16_f32 v173, v180, v181
    v_mul_f32 v202, v114, v202
    v_mfma_f32_16x16x32_bf16 v[126:129], a[120:123], v[182:185], 0
    ds_write_b64 v167, v[172:173] offset:48
    v_mfma_f32_16x16x32_bf16 v[126:129], a[124:127], v[198:201], v[126:129]
    v_mul_f32 v203, v114, v203
    v_cvt_pk_f16_f32 v170, v202, v203
    v_mfma_f32_16x16x32_bf16 v[126:129], a[128:131], v[210:213], v[126:129]
    v_mul_f32 v204, v114, v204
    v_mul_f32 v205, v114, v205
    v_mfma_f32_16x16x32_bf16 v[126:129], a[132:135], v[222:225], v[126:129]
    v_cvt_pk_f16_f32 v171, v204, v205
    v_mul_f32 v230, v114, v230
    v_mfma_f32_16x16x32_bf16 v[126:129], a[136:139], v[226:229], v[126:129]
    v_mul_f32 v231, v114, v231
    v_cvt_pk_f16_f32 v172, v230, v231
    v_mfma_f32_16x16x32_bf16 v[126:129], a[140:143], v[242:245], v[126:129]
    v_mul_f32 v232, v114, v232
    v_mul_f32 v233, v114, v233
    v_mfma_f32_16x16x32_bf16 v[174:177], a[24:27], v[182:185], 0
    v_cvt_pk_f16_f32 v173, v232, v233
    v_mul_f32 v214, v114, v214
    v_mfma_f32_16x16x32_bf16 v[174:177], a[28:31], v[198:201], v[174:177]
    ds_write_b128 v167, v[170:173] offset:32
    v_mfma_f32_16x16x32_bf16 v[174:177], a[32:35], v[210:213], v[174:177]
    v_mul_f32 v215, v114, v215
    v_cvt_pk_f16_f32 v170, v214, v215
    v_mfma_f32_16x16x32_bf16 v[174:177], a[36:39], v[222:225], v[174:177]
    v_mul_f32 v216, v114, v216
    v_mul_f32 v217, v114, v217
    v_mfma_f32_16x16x32_bf16 v[174:177], a[40:43], v[226:229], v[174:177]
    v_cvt_pk_f16_f32 v171, v216, v217
    v_mul_f32 v146, v202, v146
    v_mfma_f32_16x16x32_bf16 v[174:177], a[44:47], v[242:245], v[174:177]
    ds_write_b64 v167, v[170:171] offset:72
    v_mfma_f32_16x16x32_bf16 v[114:117], a[72:75], v[182:185], 0
    v_fmac_f32 v146, v203, v147
    v_fmac_f32 v146, v204, v148
    v_mfma_f32_16x16x32_bf16 v[114:117], a[76:79], v[198:201], v[114:117]
    v_fmac_f32 v146, v205, v149
    v_fmac_f32 v146, v230, v154
    v_mfma_f32_16x16x32_bf16 v[114:117], a[80:83], v[210:213], v[114:117]
    v_fmac_f32 v146, v231, v155
    v_fmac_f32 v146, v232, v156
    v_mfma_f32_16x16x32_bf16 v[114:117], a[84:87], v[222:225], v[114:117]
    v_fmac_f32 v146, v233, v157
    v_fmac_f32 v146, v214, v178
    v_mfma_f32_16x16x32_bf16 v[114:117], a[88:91], v[226:229], v[114:117]
    v_fmac_f32 v146, v215, v179
    v_fmac_f32 v146, v216, v180
    v_mfma_f32_16x16x32_bf16 v[114:117], a[92:95], v[242:245], v[114:117]
    v_fmac_f32 v146, v217, v181
    v_mov_b32 v167, v146
    v_mfma_f32_16x16x32_bf16 v[218:221], a[48:51], v[182:185], 0
    v_fmac_f32 v119, v139, v139
    v_fmac_f32 v119, v140, v140
    v_mfma_f32_16x16x32_bf16 v[218:221], a[52:55], v[198:201], v[218:221]
    v_permlane32_swap_b32 v146, v167
    v_mfma_f32_16x16x32_bf16 v[218:221], a[56:59], v[210:213], v[218:221]
    v_add_f32 v146, v146, v167
    v_mov_b32 v167, v146
    v_mfma_f32_16x16x32_bf16 v[218:221], a[60:63], v[222:225], v[218:221]
    v_fmac_f32 v119, v141, v141
    v_fmac_f32 v119, v238, v238
    v_mfma_f32_16x16x32_bf16 v[218:221], a[64:67], v[226:229], v[218:221]
    v_permlane16_swap_b32 v146, v167
    v_mfma_f32_16x16x32_bf16 v[218:221], a[68:71], v[242:245], v[218:221]
    v_add_f32 v146, v146, v167
    v_add_f32 v146, s39, v146
    v_mfma_f32_16x16x32_bf16 v[170:173], v[182:185], a[144:147], 0
    v_mov_b32 v147, v162
    v_mov_b32 v148, v162
    v_mfma_f32_16x16x32_bf16 v[170:173], v[198:201], a[148:151], v[170:173]
    v_mov_b32 v149, v162
    v_cndmask_b32 v146, v162, v146, s[88:89]
    v_mfma_f32_16x16x32_bf16 v[170:173], v[210:213], a[152:155], v[170:173]
    ds_write_b128 v166, v[146:149] offset:192
    v_mfma_f32_16x16x32_bf16 v[170:173], v[222:225], a[156:159], v[170:173]
    v_fmac_f32 v119, v239, v239
    v_fmac_f32 v119, v240, v240
    v_mfma_f32_16x16x32_bf16 v[170:173], v[226:229], a[160:163], v[170:173]
    v_fmac_f32 v119, v241, v241
    v_fmac_f32 v119, v246, v246
    v_mfma_f32_16x16x32_bf16 v[170:173], v[242:245], a[164:167], v[170:173]
    v_fmac_f32 v119, v247, v247
    v_fmac_f32 v119, v248, v248
    v_mfma_f32_16x16x32_bf16 v[154:157], v[182:185], a[168:171], 0
    v_fmac_f32 v119, v249, v249
    v_cvt_pk_bf16_f32 v36, v119, v142
    v_mfma_f32_16x16x32_bf16 v[154:157], v[198:201], a[172:175], v[154:157]
    v_fma_f32 v119, v114, v114, s32
    v_fmac_f32 v119, v115, v115
    v_mfma_f32_16x16x32_bf16 v[146:149], v[32:35], v[36:39], 0
    v_fmac_f32 v119, v116, v116
    v_fmac_f32 v119, v117, v117
    v_mfma_f32_16x16x32_bf16 v[154:157], v[210:213], a[176:179], v[154:157]
    v_fmac_f32 v119, v122, v122
    v_fmac_f32 v119, v123, v123
    v_mfma_f32_16x16x32_bf16 v[154:157], v[222:225], a[180:183], v[154:157]
    ds_read_b128 v[202:205], v164 offset:0
    v_fmac_f32 v119, v124, v124
    v_mfma_f32_16x16x32_bf16 v[154:157], v[226:229], a[184:187], v[154:157]
    ds_read_b128 v[190:193], v163 offset:0
    v_fmac_f32 v119, v125, v125
    v_mfma_f32_16x16x32_bf16 v[154:157], v[242:245], a[188:191], v[154:157]
    ds_read_b128 v[178:181], v164 offset:128
    v_rsq_f32 v147, v147
    v_rsq_f32 v146, v146
    v_mul_f32 v150, v147, v150
    v_mul_f32 v146, s31, v146
    v_mul_f32 v151, v147, v151
    v_cvt_pk_f16_f32 v206, v150, v151
    v_mul_f32 v152, v147, v152
    v_mul_f32 v153, v147, v153
    v_cvt_pk_f16_f32 v207, v152, v153
    v_mul_f32 v186, v147, v186
    v_mul_f32 v187, v147, v187
    v_cvt_pk_f16_f32 v208, v186, v187
    v_mul_f32 v188, v147, v188
    v_mul_f32 v189, v147, v189
    v_cvt_pk_f16_f32 v209, v188, v189
    v_mul_f32 v194, v147, v194
    v_mul_f32 v195, v147, v195
    v_cvt_pk_f16_f32 v232, v194, v195
    v_mul_f32 v196, v147, v196
    v_mul_f32 v197, v147, v197
    v_cvt_pk_f16_f32 v233, v196, v197
    buffer_load_dwordx4 v132, s[52:55], s4 offen offset:1024 lds
    ds_write_b128 v159, v[206:209]
    v_mul_f32 v138, v146, v138
    v_mul_f32 v139, v146, v139
    v_cvt_pk_f16_f32 v206, v138, v139
    v_mul_f32 v140, v146, v140
    v_mul_f32 v141, v146, v141
    v_cvt_pk_f16_f32 v207, v140, v141
    v_mul_f32 v238, v146, v238
    v_mul_f32 v239, v146, v239
    v_cvt_pk_f16_f32 v208, v238, v239
    v_mul_f32 v240, v146, v240
    v_mul_f32 v241, v146, v241
    buffer_load_dwordx4 v118, s[52:55], s4 offen offset:2048 lds
    ds_write_b64 v159, v[232:233] offset:48
    s_add_u32 m0, s68, 3072
    s_add_u32 s4, 0, 36864
    v_cvt_pk_f16_f32 v209, v240, v241
    v_mul_f32 v246, v146, v246
    v_mul_f32 v247, v146, v247
    v_cvt_pk_f16_f32 v230, v246, v247
    v_mul_f32 v248, v146, v248
    v_mul_f32 v249, v146, v249
    v_cvt_pk_f16_f32 v231, v248, v249
    v_mul_f32 v138, v138, v150
    v_fmac_f32 v138, v139, v151
    v_fmac_f32 v138, v140, v152
    buffer_load_dwordx4 v143, s[52:55], s4 offen lds
    ds_write_b128 v159, v[206:209] offset:32
    v_mfma_f32_16x16x32_bf16 v[206:209], a[0:3], v[182:185], 0
    s_waitcnt lgkmcnt(2)
    v_fmac_f32 v138, v141, v153
    v_fmac_f32 v138, v238, v186
    v_mfma_f32_16x16x32_bf16 v[206:209], a[4:7], v[198:201], v[206:209]
    v_fmac_f32 v138, v239, v187
    v_fmac_f32 v138, v240, v188
    v_mfma_f32_16x16x32_bf16 v[206:209], a[8:11], v[210:213], v[206:209]
    ds_write_b64 v159, v[230:231] offset:72
    v_mfma_f32_16x16x32_bf16 v[206:209], a[12:15], v[222:225], v[206:209]
    buffer_load_dwordx4 v132, s[52:55], s4 offen offset:1024 lds
    v_mfma_f32_16x16x32_bf16 v[206:209], a[16:19], v[226:229], v[206:209]
    v_fmac_f32 v138, v241, v189
    v_fmac_f32 v138, v246, v194
    v_mfma_f32_16x16x32_bf16 v[206:209], a[20:23], v[242:245], v[206:209]
    v_fmac_f32 v138, v247, v195
    v_fmac_f32 v138, v248, v196
    v_mfma_f32_16x16x32_bf16 v[146:149], v[182:185], a[192:195], 0
    ds_read_b128 v[150:153], v163 offset:128
    v_fmac_f32 v138, v249, v197
    v_mfma_f32_16x16x32_bf16 v[146:149], v[198:201], a[196:199], v[146:149]
    ds_read_b128 v[182:185], v164 offset:256
    v_mov_b32 v142, v138
    v_mfma_f32_16x16x32_bf16 v[146:149], v[210:213], a[200:203], v[146:149]
    buffer_load_dwordx4 v118, s[52:55], s4 offen offset:2048 lds
    v_mfma_f32_16x16x32_bf16 v[146:149], v[222:225], a[204:207], v[146:149]
    s_add_u32 m0, s69, 0
    ds_read_b128 v[222:225], v163 offset:256
    v_fmac_f32 v119, v126, v126
    v_mfma_f32_16x16x32_bf16 v[146:149], v[226:229], a[208:211], v[146:149]
    s_add_u32 s4, 0, 49152
    v_permlane32_swap_b32 v138, v142
    s_waitcnt vmcnt(9)
    v_mfma_f32_16x16x32_bf16 v[146:149], v[242:245], a[212:215], v[146:149]
    ds_read_b64 a[216:217], v131 offset:0
    ds_read_b64 a[218:219], v131 offset:1536
    v_mfma_f32_16x16x32_bf16 v[198:201], v[202:205], a[144:147], 0
    ds_read_b64 a[240:241], v131 offset:8
    ds_read_b64 a[242:243], v131 offset:1544
    v_mfma_f32_16x16x32_bf16 v[198:201], v[190:193], a[148:151], v[198:201]
    s_waitcnt lgkmcnt(6)
    ds_read_b64 v[90:91], v121 offset:0
    ds_read_b64 v[92:93], v121 offset:1536
    v_mfma_f32_16x16x32_bf16 v[198:201], v[178:181], a[152:155], v[198:201]
    s_waitcnt lgkmcnt(7)
    v_add_f32 v138, v138, v142
    v_mov_b32 v142, v138
    v_mfma_f32_16x16x32_bf16 v[198:201], v[150:153], a[156:159], v[198:201]
    v_fmac_f32 v119, v127, v127
    v_fmac_f32 v119, v128, v128
    v_mfma_f32_16x16x32_bf16 v[198:201], v[182:185], a[160:163], v[198:201]
    s_waitcnt lgkmcnt(6)
    v_permlane16_swap_b32 v138, v142
    v_mfma_f32_16x16x32_bf16 v[198:201], v[222:225], a[164:167], v[198:201]
    v_add_f32 v138, v138, v142
    v_add_f32 v138, s39, v138
    v_mfma_f32_16x16x32_bf16 v[242:245], v[202:205], a[168:171], 0
    v_mov_b32 v139, v162
    v_mov_b32 v140, v162
    v_mfma_f32_16x16x32_bf16 v[242:245], v[190:193], a[172:175], v[242:245]
    s_waitcnt lgkmcnt(4)
    v_mov_b32 v141, v162
    v_cndmask_b32 v138, v162, v138, s[88:89]
    v_mfma_f32_16x16x32_bf16 v[226:229], v[234:237], a[216:219], 0
    s_waitcnt lgkmcnt(2)
    ds_write_b128 v169, v[138:141] offset:192
    v_mfma_f32_16x16x32_bf16 v[226:229], v[234:237], a[240:243], v[226:229]
    s_waitcnt lgkmcnt(1)
    buffer_load_dwordx4 v143, s[52:55], s4 offen lds
    v_mfma_f32_16x16x32_bf16 v[226:229], v[234:237], v[90:93], v[226:229]
    v_fmac_f32 v119, v129, v129
    s_waitcnt vmcnt(7)
    v_mfma_f32_16x16x32_bf16 v[242:245], v[178:181], a[176:179], v[242:245]
    ds_read_b64 a[232:233], v131 offset:3072
    ds_read_b64 a[220:221], v131 offset:4608
    v_mfma_f32_16x16x32_bf16 v[242:245], v[150:153], a[180:183], v[242:245]
    ds_read_b64 v[82:83], v131 offset:3080
    ds_read_b64 a[244:245], v131 offset:4616
    v_mfma_f32_16x16x32_bf16 v[242:245], v[182:185], a[184:187], v[242:245]
    ds_read_b64 v[106:107], v121 offset:3072
    ds_read_b64 v[94:95], v121 offset:4608
    v_mfma_f32_16x16x32_bf16 v[242:245], v[222:225], a[188:191], v[242:245]
    buffer_load_dwordx4 v132, s[52:55], s4 offen offset:1024 lds
    v_mfma_f32_16x16x32_bf16 v[186:189], v[202:205], a[192:195], 0
    ds_read_b128 v[158:161], v164 offset:6144
    ds_read_b128 v[138:141], v163 offset:6144
    v_mfma_f32_16x16x32_bf16 v[186:189], v[190:193], a[196:199], v[186:189]
    ds_read_b128 v[194:197], v164 offset:6272
    ds_read_b128 v[210:213], v163 offset:6272
    v_mfma_f32_16x16x32_bf16 v[186:189], v[178:181], a[200:203], v[186:189]
    v_mov_b32 v255, v226
    v_mov_b32_dpp v255, v227 quad_perm:[0,1,2,3] row_mask:0x2 bank_mask:0xf
    v_mfma_f32_16x16x32_bf16 v[186:189], v[150:153], a[204:207], v[186:189]
    ds_read_b128 v[226:229], v164 offset:6400
    ds_read_b128 v[150:153], v163 offset:6400
    v_mfma_f32_16x16x32_bf16 v[186:189], v[182:185], a[208:211], v[186:189]
    s_waitcnt lgkmcnt(10)
    buffer_load_dwordx4 v118, s[52:55], s4 offen offset:2048 lds
    v_mfma_f32_16x16x32_bf16 v[186:189], v[222:225], a[212:215], v[186:189]
    s_add_u32 m0, s69, 3072
    s_add_u32 s4, 0, 61440
    s_waitcnt lgkmcnt(6)
    v_fma_f32 v142, v206, v206, s32
    v_fmac_f32 v142, v207, v207
    v_fmac_f32 v142, v208, v208
    v_fmac_f32 v142, v209, v209
    v_fmac_f32 v142, v174, v174
    v_fmac_f32 v142, v175, v175
    s_waitcnt lgkmcnt(5)
    v_mfma_f32_16x16x32_bf16 v[182:185], v[158:161], a[144:147], 0
    s_waitcnt lgkmcnt(4)
    s_waitcnt vmcnt(6)
    ds_read_b64 a[222:223], v134 offset:0
    v_mfma_f32_16x16x32_bf16 v[182:185], v[138:141], a[148:151], v[182:185]
    s_waitcnt lgkmcnt(3)
    buffer_load_dwordx4 v143, s[52:55], s4 offen lds
    v_mfma_f32_16x16x32_bf16 v[182:185], v[194:197], a[152:155], v[182:185]
    ds_read_b64 a[234:235], v134 offset:1536
    ds_read_b64 a[246:247], v134 offset:8
    v_mfma_f32_16x16x32_bf16 v[182:185], v[210:213], a[156:159], v[182:185]
    s_waitcnt lgkmcnt(3)
    ds_read_b64 v[84:85], v134 offset:1544
    ds_read_b64 v[96:97], v120 offset:0
    v_mfma_f32_16x16x32_bf16 v[182:185], v[226:229], a[160:163], v[182:185]
    ds_read_b64 v[108:109], v120 offset:1536
    v_fmac_f32 v142, v176, v176
    v_mfma_f32_16x16x32_bf16 v[182:185], v[150:153], a[164:167], v[182:185]
    v_fmac_f32 v142, v177, v177
    v_fmac_f32 v142, v218, v218
    v_mfma_f32_16x16x32_bf16 v[222:225], v[158:161], a[168:171], 0
    buffer_load_dwordx4 v132, s[52:55], s4 offen offset:1024 lds
    v_mfma_f32_16x16x32_bf16 v[222:225], v[138:141], a[172:175], v[222:225]
    v_fmac_f32 v142, v219, v219
    v_fmac_f32 v142, v220, v220
    v_mfma_f32_16x16x32_bf16 v[222:225], v[194:197], a[176:179], v[222:225]
    s_waitcnt lgkmcnt(5)
    v_fmac_f32 v142, v221, v221
    v_cvt_pk_bf16_f32 v36, v142, v119
    v_mfma_f32_16x16x32_bf16 v[178:181], v[234:237], a[220:223], 0
    v_cvt_pk_bf16_f32 v190, v170, v171
    v_cvt_pk_bf16_f32 v191, v172, v173
    v_mfma_f32_16x16x32_bf16 v[170:173], v[32:35], v[36:39], 0
    s_waitcnt lgkmcnt(3)
    v_cvt_pk_bf16_f32 v162, v154, v155
    v_cvt_pk_bf16_f32 v163, v156, v157
    v_mfma_f32_16x16x32_bf16 v[178:181], v[234:237], a[244:247], v[178:181]
    s_waitcnt lgkmcnt(1)
    buffer_load_dwordx4 v118, s[52:55], s4 offen offset:2048 lds
    v_mfma_f32_16x16x32_bf16 v[178:181], v[234:237], v[94:97], v[178:181]
    s_add_u32 m0, s28, 65536
    v_rsq_f32 v171, v171
    v_mfma_f32_16x16x32_bf16 v[154:157], v[234:237], a[232:235], 0
    s_waitcnt vmcnt(6)
    ds_read_b64 a[224:225], v134 offset:3072
    ds_read_b64 a[226:227], v134 offset:4608
    v_mfma_f32_16x16x32_bf16 v[154:157], v[234:237], v[82:85], v[154:157]
    s_waitcnt lgkmcnt(2)
    ds_read_b64 a[248:249], v134 offset:3080
    ds_read_b64 a[250:251], v134 offset:4616
    v_mfma_f32_16x16x32_bf16 v[154:157], v[234:237], v[106:109], v[154:157]
    ds_read_b64 v[98:99], v120 offset:3072
    ds_read_b64 v[100:101], v120 offset:4608
    v_mfma_f32_16x16x32_bf16 v[222:225], v[210:213], a[180:183], v[222:225]
    buffer_load_dwordx4 v10, s[8:11], s24 offen nt lds
    v_mfma_f32_16x16x32_bf16 v[222:225], v[226:229], a[184:187], v[222:225]
    s_add_u32 m0, s28, 69632
    v_mov_b32 v132, v179
    v_mul_f32 v114, v171, v114
    v_mfma_f32_16x16x32_bf16 v[222:225], v[150:153], a[188:191], v[222:225]
    v_mov_b32_dpp v255, v154 quad_perm:[0,1,2,3] row_mask:0x4 bank_mask:0xf
    v_mov_b32_dpp v255, v178 quad_perm:[0,1,2,3] row_mask:0x8 bank_mask:0xf
    v_mfma_f32_16x16x32_bf16 v[178:181], v[158:161], a[192:195], 0
    v_mov_b32_dpp v132, v155 quad_perm:[0,1,2,3] row_mask:0x2 bank_mask:0xf
    v_mul_f32 v115, v171, v115
    v_mfma_f32_16x16x32_bf16 v[178:181], v[138:141], a[196:199], v[178:181]
    v_rsq_f32 v170, v170
    v_mfma_f32_16x16x32_bf16 v[178:181], v[194:197], a[200:203], v[178:181]
    s_waitcnt lgkmcnt(4)
    buffer_load_dwordx4 v11, s[8:11], s24 offen nt lds
    v_mfma_f32_16x16x32_bf16 v[138:141], v[234:237], a[224:227], 0
    s_waitcnt lgkmcnt(2)
    v_mul_f32 v170, s31, v170
    v_cvt_pk_f16_f32 v114, v114, v115
    v_mfma_f32_16x16x32_bf16 v[138:141], v[234:237], a[248:251], v[138:141]
    s_waitcnt lgkmcnt(0)
    v_mul_f32 v116, v171, v116
    v_mul_f32 v117, v171, v117
    v_mfma_f32_16x16x32_bf16 v[138:141], v[234:237], v[98:101], v[138:141]
    s_add_u32 m0, s28, 73728
    v_cvt_pk_f16_f32 v115, v116, v117
    v_mul_f32 v122, v171, v122
    v_mfma_f32_16x16x32_bf16 v[178:181], v[210:213], a[204:207], v[178:181]
    v_mul_f32 v123, v171, v123
    v_cvt_pk_f16_f32 v116, v122, v123
    v_mfma_f32_16x16x32_bf16 v[178:181], v[226:229], a[208:211], v[178:181]
    buffer_load_dwordx4 v12, s[8:11], s24 offen nt lds
    v_mfma_f32_16x16x32_bf16 v[178:181], v[150:153], a[212:215], v[178:181]
    s_barrier
    ds_read_b128 v[154:157], v0 offset:26624
    ds_read_b128 v[158:161], v1 offset:26624
    s_waitcnt vmcnt(6)
    ds_read_b64 a[236:237], v131 offset:0
    ds_read_b64 a[228:229], v131 offset:1536
    ds_read_b64 v[86:87], v131 offset:8
    s_add_u32 m0, s28, 77824
    ds_read_b64 a[252:253], v131 offset:1544
    ds_read_b64 v[110:111], v121 offset:0
    ds_read_b64 v[102:103], v121 offset:1536
    buffer_load_dwordx4 v13, s[8:11], s24 offen nt lds
    ds_read_b128 v[226:229], v0 offset:26752
    ds_read_b128 v[150:153], v1 offset:26752
    s_add_u32 m0, s74, 0
    ds_read_b128 v[202:205], v0 offset:26880
    ds_read_b128 v[194:197], v1 offset:26880
    v_mov_b32_dpp v132, v138 quad_perm:[0,1,2,3] row_mask:0x4 bank_mask:0xf
    v_mov_b32_dpp v132, v139 quad_perm:[0,1,2,3] row_mask:0x8 bank_mask:0xf
    s_waitcnt lgkmcnt(11)
    v_mfma_f32_16x16x32_bf16 v[210:213], a[72:75], v[154:157], 0
    s_waitcnt lgkmcnt(10)
    ds_write_b32 v135, v255 offset:0
    v_mfma_f32_16x16x32_bf16 v[210:213], a[76:79], v[158:161], v[210:213]
    s_waitcnt lgkmcnt(8)
    buffer_load_dwordx4 v14, s[8:11], s24 offen nt lds
    v_mfma_f32_16x16x32_bf16 v[138:141], a[96:99], v[154:157], 0
    s_add_u32 s8, s40, s23
    ds_write_b32 v135, v132 offset:1024
    v_mfma_f32_16x16x32_bf16 v[138:141], a[100:103], v[158:161], v[138:141]
    s_addc_u32 s9, s41, 0
    v_mul_f32 v124, v171, v124
    v_mul_f32 v125, v171, v125
    v_mfma_f32_16x16x32_bf16 v[238:241], a[120:123], v[154:157], 0
    s_waitcnt lgkmcnt(4)
    v_cvt_pk_f16_f32 v117, v124, v125
    v_mul_f32 v126, v171, v126
    v_mfma_f32_16x16x32_bf16 v[210:213], a[80:83], v[226:229], v[210:213]
    s_sub_u32 s10, s36, s23
    v_mul_f32 v127, v171, v127
    v_cvt_pk_f16_f32 v124, v126, v127
    v_mfma_f32_16x16x32_bf16 v[210:213], a[84:87], v[150:153], v[210:213]
    s_waitcnt lgkmcnt(2)
    v_mul_f32 v128, v171, v128
    v_mul_f32 v129, v171, v129
    v_mfma_f32_16x16x32_bf16 v[210:213], a[88:91], v[202:205], v[210:213]
    s_cmp_lt_u32 s34, s17
    v_cvt_pk_f16_f32 v125, v128, v129
    v_mul_f32 v206, v170, v206
    s_waitcnt vmcnt(5)
    v_mfma_f32_16x16x32_bf16 v[210:213], a[92:95], v[194:197], v[210:213]
    s_cselect_b32 s10, s10, 0
    ds_read_b64 a[230:231], v131 offset:3072
    ds_read_b64 a[238:239], v131 offset:4608
    v_mfma_f32_16x16x32_bf16 v[138:141], a[104:107], v[226:229], v[138:141]
    s_add_u32 m0, s28, 0
    ds_read_b64 a[254:255], v131 offset:3080
    ds_read_b64 v[88:89], v131 offset:4616
    v_mfma_f32_16x16x32_bf16 v[138:141], a[108:111], v[150:153], v[138:141]
    s_mov_b32 s24, s23
    ds_read_b64 v[104:105], v121 offset:3072
    ds_read_b64 v[112:113], v121 offset:4608
    v_mfma_f32_16x16x32_bf16 v[138:141], a[112:115], v[202:205], v[138:141]
    s_add_u32 s23, s23, s21
    v_mul_f32 v207, v170, v207
    v_cvt_pk_f16_f32 v126, v206, v207
    v_mfma_f32_16x16x32_bf16 v[138:141], a[116:119], v[194:197], v[138:141]
    s_cmp_ge_u32 s19, 72
    v_mul_f32 v208, v170, v208
    v_mul_f32 v209, v170, v209
    v_mfma_f32_16x16x32_bf16 v[238:241], a[124:127], v[158:161], v[238:241]
    s_cselect_b32 s34, 72, 0
    v_cvt_pk_f16_f32 v127, v208, v209
    v_mul_f32 v174, v170, v174
    v_mfma_f32_16x16x32_bf16 v[238:241], a[128:131], v[226:229], v[238:241]
    s_cselect_b32 s35, s22, 0
    v_mul_f32 v175, v170, v175
    v_cvt_pk_f16_f32 v128, v174, v175
    v_mfma_f32_16x16x32_bf16 v[238:241], a[132:135], v[150:153], v[238:241]
    s_sub_u32 s19, s19, s34
    v_mul_f32 v176, v170, v176
    v_mul_f32 v177, v170, v177
    v_mfma_f32_16x16x32_bf16 v[238:241], a[136:139], v[202:205], v[238:241]
    s_waitcnt lgkmcnt(4)
    v_cvt_pk_f16_f32 v129, v176, v177
    v_mul_f32 v218, v170, v218
    v_mfma_f32_16x16x32_bf16 v[174:177], v[234:237], a[228:231], 0
    s_waitcnt lgkmcnt(2)
    v_mul_f32 v219, v170, v219
    v_cvt_pk_f16_f32 v122, v218, v219
    v_mfma_f32_16x16x32_bf16 v[174:177], v[234:237], a[252:255], v[174:177]
    s_waitcnt lgkmcnt(0)
    v_mul_f32 v220, v170, v220
    v_mul_f32 v221, v170, v221
    v_mfma_f32_16x16x32_bf16 v[174:177], v[234:237], v[102:105], v[174:177]
    s_add_u32 s23, s23, s35
    v_cvt_pk_f16_f32 v123, v220, v221
    v_cvt_pk_bf16_f32 v166, v146, v147
    v_mfma_f32_16x16x32_bf16 v[118:121], v[234:237], a[236:239], 0
    v_cvt_pk_bf16_f32 v167, v148, v149
    v_cvt_pk_bf16_f32 v198, v198, v198
    v_mfma_f32_16x16x32_bf16 v[118:121], v[234:237], v[86:89], v[118:121]
    v_cvt_pk_bf16_f32 v199, v199, v199
    v_cvt_pk_bf16_f32 v200, v200, v200
    v_mfma_f32_16x16x32_bf16 v[118:121], v[234:237], v[110:113], v[118:121]
    ds_write2_b32 v165, v198, v199 offset0:0 offset1:68
    v_mfma_f32_16x16x32_bf16 v[238:241], a[140:143], v[194:197], v[238:241]
    v_cvt_pk_bf16_f32 v201, v201, v201
    v_cvt_pk_bf16_f32 v242, v242, v242
    v_mfma_f32_16x16x32_bf16 v[146:149], a[0:3], v[154:157], 0
    ds_write2_b32 v165, v200, v201 offset0:136 offset1:204
    v_mfma_f32_16x16x32_bf16 v[146:149], a[4:7], v[158:161], v[146:149]
    v_cvt_pk_bf16_f32 v243, v243, v243
    v_mov_b32 v164, v118
    v_mfma_f32_16x16x32_bf16 v[146:149], a[8:11], v[226:229], v[146:149]
    ds_write2_b32 v165, v242, v243 offset0:16 offset1:84
    v_mfma_f32_16x16x32_bf16 v[146:149], a[12:15], v[150:153], v[146:149]
    v_mov_b32_dpp v164, v174 quad_perm:[0,1,2,3] row_mask:0x2 bank_mask:0xf
    v_mov_b32_dpp v164, v175 quad_perm:[0,1,2,3] row_mask:0x4 bank_mask:0xf
    v_mfma_f32_16x16x32_bf16 v[146:149], a[16:19], v[202:205], v[146:149]
    v_mov_b32_dpp v164, v119 quad_perm:[0,1,2,3] row_mask:0x8 bank_mask:0xf
    v_cvt_pk_bf16_f32 v244, v244, v244
    v_mfma_f32_16x16x32_bf16 v[146:149], a[20:23], v[194:197], v[146:149]
    ds_write_b32 v135, v164 offset:2048
    v_mfma_f32_16x16x32_bf16 v[118:121], a[24:27], v[154:157], 0
    v_cvt_pk_bf16_f32 v245, v245, v245
    v_cvt_pk_bf16_f32 v186, v186, v186
    v_mfma_f32_16x16x32_bf16 v[118:121], a[28:31], v[158:161], v[118:121]
    ds_write2_b32 v165, v244, v245 offset0:152 offset1:220
    v_mfma_f32_16x16x32_bf16 v[118:121], a[32:35], v[226:229], v[118:121]
    v_cvt_pk_bf16_f32 v187, v187, v187
    v_cvt_pk_bf16_f32 v188, v188, v188
    v_mfma_f32_16x16x32_bf16 v[118:121], a[36:39], v[150:153], v[118:121]
    ds_write2_b32 v165, v186, v187 offset0:32 offset1:100
    v_mfma_f32_16x16x32_bf16 v[118:121], a[40:43], v[202:205], v[118:121]
    v_cvt_pk_bf16_f32 v189, v189, v189
    v_cvt_pk_bf16_f32 v182, v182, v182
    v_mfma_f32_16x16x32_bf16 v[118:121], a[44:47], v[194:197], v[118:121]
    ds_write2_b32 v165, v188, v189 offset0:168 offset1:236
    v_mfma_f32_16x16x32_bf16 v[134:137], a[48:51], v[154:157], 0
    s_waitcnt lgkmcnt(3)
    v_cvt_pk_bf16_f32 v183, v183, v183
    v_cvt_pk_bf16_f32 v184, v184, v184
    v_mfma_f32_16x16x32_bf16 v[134:137], a[52:55], v[158:161], v[134:137]
    s_barrier
    ds_read_b128 v[174:177], v254 offset:0
    ds_read_b128 v[242:245], v254 offset:1024
    v_mfma_f32_16x16x32_bf16 v[134:137], a[56:59], v[226:229], v[134:137]
    ds_read_b128 v[198:201], v254 offset:2048
    v_cvt_pk_bf16_f32 v185, v185, v185
    v_mfma_f32_16x16x32_bf16 v[134:137], a[60:63], v[150:153], v[134:137]
    ds_write2_b32 v168, v182, v183 offset0:0 offset1:68
    v_mfma_f32_16x16x32_bf16 v[134:137], a[64:67], v[202:205], v[134:137]
    v_cvt_pk_bf16_f32 v222, v222, v222
    v_cvt_pk_bf16_f32 v223, v223, v223
    v_mfma_f32_16x16x32_bf16 v[134:137], a[68:71], v[194:197], v[134:137]
    ds_write2_b32 v168, v184, v185 offset0:136 offset1:204
    v_mfma_f32_16x16x32_bf16 v[182:185], v[154:157], a[144:147], 0
    v_cvt_pk_bf16_f32 v224, v224, v224
    v_cvt_pk_bf16_f32 v225, v225, v225
    v_mfma_f32_16x16x32_bf16 v[182:185], v[158:161], a[148:151], v[182:185]
    ds_write2_b32 v168, v222, v223 offset0:16 offset1:84
    v_mfma_f32_16x16x32_bf16 v[182:185], v[226:229], a[152:155], v[182:185]
    s_waitcnt lgkmcnt(4)
    v_add_f32 v174, v174, v175
    v_add_f32 v176, v176, v177
    v_mfma_f32_16x16x32_bf16 v[182:185], v[150:153], a[156:159], v[182:185]
    s_waitcnt lgkmcnt(3)
    ds_write2_b32 v168, v224, v225 offset0:152 offset1:220
    v_mfma_f32_16x16x32_bf16 v[182:185], v[202:205], a[160:163], v[182:185]
    v_add_f32 v174, v174, v176
    v_mul_f32 v174, 0xbbaaaaab, v174
    v_mfma_f32_16x16x32_bf16 v[182:185], v[194:197], a[164:167], v[182:185]
    ds_write_b32 v130, v174 offset:0
    v_mfma_f32_16x16x32_bf16 v[174:177], v[154:157], a[168:171], 0
    v_add_f32 v242, v242, v243
    v_add_f32 v244, v244, v245
    v_mfma_f32_16x16x32_bf16 v[174:177], v[158:161], a[172:175], v[174:177]
    ds_read_b128 v[222:225], v133 offset:0
    ds_read_b128 v[218:221], v133 offset:64
    v_mfma_f32_16x16x32_bf16 v[174:177], v[226:229], a[176:179], v[174:177]
    v_add_f32 v242, v242, v244
    v_mul_f32 v242, 0xbbaaaaab, v242
    v_mfma_f32_16x16x32_bf16 v[174:177], v[150:153], a[180:183], v[174:177]
    ds_read_b128 v[186:189], v0 offset:32768
    v_add_f32 v198, v198, v199
    v_mfma_f32_16x16x32_bf16 v[174:177], v[202:205], a[184:187], v[174:177]
    ds_read_b128 v[170:173], v1 offset:32768
    v_add_f32 v200, v200, v201
    v_mfma_f32_16x16x32_bf16 v[174:177], v[194:197], a[188:191], v[174:177]
    ds_read_b128 v[234:237], v0 offset:32896
    v_add_f32 v198, v198, v200
    v_mfma_f32_16x16x32_bf16 v[206:209], v[154:157], a[192:195], 0
    ds_read_b128 v[154:157], v1 offset:32896
    v_mul_f32 v198, 0xbbaaaaab, v198
    v_mfma_f32_16x16x32_bf16 v[206:209], v[158:161], a[196:199], v[206:209]
    ds_read_b128 v[158:161], v0 offset:33024
    v_cvt_pk_bf16_f32 v178, v178, v178
    v_mfma_f32_16x16x32_bf16 v[206:209], v[226:229], a[200:203], v[206:209]
    ds_read_b128 v[226:229], v1 offset:33024
    v_cvt_pk_bf16_f32 v179, v179, v179
    v_mfma_f32_16x16x32_bf16 v[206:209], v[150:153], a[204:207], v[206:209]
    s_waitcnt lgkmcnt(6)
    ds_write_b32 v130, v242 offset:256
    v_mfma_f32_16x16x32_bf16 v[206:209], v[202:205], a[208:211], v[206:209]
    v_cvt_pk_bf16_f32 v180, v180, v180
    v_cvt_pk_bf16_f32 v181, v181, v181
    v_mfma_f32_16x16x32_bf16 v[206:209], v[194:197], a[212:215], v[206:209]
    s_waitcnt lgkmcnt(6)
    ds_write_b32 v130, v198 offset:512
    v_mfma_f32_16x16x32_bf16 v[150:153], a[72:75], v[186:189], 0
    s_waitcnt lgkmcnt(6)
    v_cvt_pk_bf16_f32 v192, v182, v183
    v_cvt_pk_bf16_f32 v193, v184, v185
    v_mfma_f32_16x16x32_bf16 v[150:153], a[76:79], v[170:173], v[150:153]
    s_waitcnt lgkmcnt(5)
    ds_write2_b32 v168, v178, v179 offset0:32 offset1:100
    v_mfma_f32_16x16x32_bf16 v[150:153], a[80:83], v[234:237], v[150:153]
    s_waitcnt lgkmcnt(4)
    v_fma_f32 v169, v146, v146, s32
    v_fmac_f32 v169, v147, v147
    v_mfma_f32_16x16x32_bf16 v[150:153], a[84:87], v[154:157], v[150:153]
    s_waitcnt lgkmcnt(3)
    ds_write2_b32 v168, v180, v181 offset0:168 offset1:236
    v_mfma_f32_16x16x32_bf16 v[150:153], a[88:91], v[158:161], v[150:153]
    v_fmac_f32 v169, v148, v148
    v_fmac_f32 v169, v149, v149
    v_mfma_f32_16x16x32_bf16 v[150:153], a[92:95], v[226:229], v[150:153]
    v_fmac_f32 v169, v118, v118
    v_fmac_f32 v169, v119, v119
    v_mfma_f32_16x16x32_bf16 v[182:185], a[96:99], v[186:189], 0
    v_fmac_f32 v169, v120, v120
    v_fmac_f32 v169, v121, v121
    v_mfma_f32_16x16x32_bf16 v[182:185], a[100:103], v[170:173], v[182:185]
    v_fmac_f32 v169, v134, v134
    v_fmac_f32 v169, v135, v135
    v_mfma_f32_16x16x32_bf16 v[182:185], a[104:107], v[234:237], v[182:185]
    v_fmac_f32 v169, v136, v136
    v_fmac_f32 v169, v137, v137
    v_mfma_f32_16x16x32_bf16 v[182:185], a[108:111], v[154:157], v[182:185]
    v_fma_f32 v168, v210, v210, s32
    v_fmac_f32 v168, v211, v211
    v_mfma_f32_16x16x32_bf16 v[182:185], a[112:115], v[158:161], v[182:185]
    v_fmac_f32 v168, v212, v212
    v_fmac_f32 v168, v213, v213
    v_mfma_f32_16x16x32_bf16 v[182:185], a[116:119], v[226:229], v[182:185]
    v_fmac_f32 v168, v138, v138
    v_fmac_f32 v168, v139, v139
    v_mfma_f32_16x16x32_bf16 v[198:201], a[120:123], v[186:189], 0
    v_fmac_f32 v168, v140, v140
    v_fmac_f32 v168, v141, v141
    v_mfma_f32_16x16x32_bf16 v[198:201], a[124:127], v[170:173], v[198:201]
    v_fmac_f32 v168, v238, v238
    v_fmac_f32 v168, v239, v239
    v_mfma_f32_16x16x32_bf16 v[198:201], a[128:131], v[234:237], v[198:201]
    v_fmac_f32 v168, v240, v240
    v_fmac_f32 v168, v241, v241
    v_mfma_f32_16x16x32_bf16 v[198:201], a[132:135], v[154:157], v[198:201]
    v_cvt_pk_bf16_f32 v36, v169, v168
    v_cvt_pk_bf16_f32 v164, v174, v175
    v_mfma_f32_16x16x32_bf16 v[198:201], a[136:139], v[158:161], v[198:201]
    v_cvt_pk_bf16_f32 v165, v176, v177
    v_cvt_pk_bf16_f32 v168, v206, v207
    v_mfma_f32_16x16x32_bf16 v[242:245], v[32:35], v[36:39], 0
    v_cvt_pk_bf16_f32 v169, v208, v209
    v_fma_f32 v142, v150, v150, s32
    v_mfma_f32_16x16x32_bf16 v[198:201], a[140:143], v[226:229], v[198:201]
    v_fmac_f32 v142, v151, v151
    v_fmac_f32 v142, v152, v152
    v_mfma_f32_16x16x32_bf16 v[178:181], a[0:3], v[186:189], 0
    v_fmac_f32 v142, v153, v153
    v_fmac_f32 v142, v182, v182
    v_mfma_f32_16x16x32_bf16 v[178:181], a[4:7], v[170:173], v[178:181]
    v_rsq_f32 v243, v243
    v_mfma_f32_16x16x32_bf16 v[178:181], a[8:11], v[234:237], v[178:181]
    v_rsq_f32 v242, v242
    v_mfma_f32_16x16x32_bf16 v[178:181], a[12:15], v[154:157], v[178:181]
    v_mul_f32 v242, s31, v242
    v_mul_f32 v210, v243, v210
    v_mfma_f32_16x16x32_bf16 v[178:181], a[16:19], v[158:161], v[178:181]
    v_mul_f32 v211, v243, v211
    v_cvt_pk_f16_f32 v210, v210, v211
    v_mfma_f32_16x16x32_bf16 v[178:181], a[20:23], v[226:229], v[178:181]
    v_mul_f32 v212, v243, v212
    v_mul_f32 v213, v243, v213
    v_mfma_f32_16x16x32_bf16 v[174:177], a[24:27], v[186:189], 0
    v_cvt_pk_f16_f32 v211, v212, v213
    v_mul_f32 v138, v243, v138
    v_mfma_f32_16x16x32_bf16 v[174:177], a[28:31], v[170:173], v[174:177]
    v_mul_f32 v139, v243, v139
    v_cvt_pk_f16_f32 v212, v138, v139
    v_mfma_f32_16x16x32_bf16 v[174:177], a[32:35], v[234:237], v[174:177]
    v_mul_f32 v140, v243, v140
    v_mul_f32 v141, v243, v141
    v_mfma_f32_16x16x32_bf16 v[174:177], a[36:39], v[154:157], v[174:177]
    v_cvt_pk_f16_f32 v213, v140, v141
    v_mul_f32 v238, v243, v238
    v_mfma_f32_16x16x32_bf16 v[174:177], a[40:43], v[158:161], v[174:177]
    v_mul_f32 v239, v243, v239
    v_cvt_pk_f16_f32 v204, v238, v239
    v_mfma_f32_16x16x32_bf16 v[174:177], a[44:47], v[226:229], v[174:177]
    v_mul_f32 v240, v243, v240
    v_mul_f32 v241, v243, v241
    v_mfma_f32_16x16x32_bf16 v[138:141], a[48:51], v[186:189], 0
    v_cvt_pk_f16_f32 v205, v240, v241
    v_mul_f32 v146, v242, v146
    v_mfma_f32_16x16x32_bf16 v[138:141], a[52:55], v[170:173], v[138:141]
    ds_read_b128 v[206:209], v5 offset:0
    ds_read_b128 v[194:197], v5 offset:16
    v_mfma_f32_16x16x32_bf16 v[138:141], a[56:59], v[234:237], v[138:141]
    ds_read_b128 v[238:241], v5 offset:48
    ds_read_b32 v143, v6 offset:192
    v_mfma_f32_16x16x32_bf16 v[138:141], a[60:63], v[154:157], v[138:141]
    v_mul_f32 v147, v242, v147
    v_cvt_pk_f16_f32 v146, v146, v147
    v_mfma_f32_16x16x32_bf16 v[138:141], a[64:67], v[158:161], v[138:141]
    v_mul_f32 v148, v242, v148
    v_mul_f32 v149, v242, v149
    v_mfma_f32_16x16x32_bf16 v[138:141], a[68:71], v[226:229], v[138:141]
    v_cvt_pk_f16_f32 v147, v148, v149
    v_mul_f32 v118, v242, v118
    v_mul_f32 v119, v242, v119
    v_cvt_pk_f16_f32 v148, v118, v119
    v_mul_f32 v120, v242, v120
    v_mul_f32 v121, v242, v121
    v_cvt_pk_f16_f32 v149, v120, v121
    v_mfma_f32_16x16x32_bf16 v[118:121], v[186:189], a[144:147], 0
    v_mul_f32 v134, v242, v134
    v_mul_f32 v135, v242, v135
    v_mfma_f32_16x16x32_bf16 v[118:121], v[170:173], a[148:151], v[118:121]
    s_waitcnt lgkmcnt(3)
    v_cvt_pk_f16_f32 v202, v134, v135
    v_mul_f32 v136, v242, v136
    v_mfma_f32_16x16x32_bf16 v[118:121], v[234:237], a[152:155], v[118:121]
    s_waitcnt lgkmcnt(1)
    v_mul_f32 v137, v242, v137
    v_cvt_pk_f16_f32 v203, v136, v137
    v_mfma_f32_16x16x32_bf16 v[118:121], v[154:157], a[156:159], v[118:121]
    s_waitcnt lgkmcnt(0)
    v_fma_f32 v254, v178, v178, s32
    v_fmac_f32 v254, v179, v179
    v_mfma_f32_16x16x32_bf16 v[118:121], v[158:161], a[160:163], v[118:121]
    v_fmac_f32 v254, v180, v180
    v_fmac_f32 v254, v181, v181
    v_mfma_f32_16x16x32_bf16 v[118:121], v[226:229], a[164:167], v[118:121]
    v_fmac_f32 v254, v174, v174
    v_fmac_f32 v254, v175, v175
    v_fmac_f32 v254, v176, v176
    v_fmac_f32 v254, v177, v177
    v_fmac_f32 v254, v138, v138
    v_fmac_f32 v254, v139, v139
    v_fmac_f32 v254, v140, v140
    v_fmac_f32 v254, v141, v141
    v_cvt_pk_bf16_f32 v134, v118, v119
    v_cvt_pk_bf16_f32 v135, v120, v121
    v_mfma_f32_16x16x32_f16 v[118:121], v[206:209], v[126:129], v[22:25]
    v_fmac_f32 v142, v183, v183
    v_fmac_f32 v142, v184, v184
    v_mfma_f32_16x16x32_f16 v[118:121], v[194:197], v[114:117], v[118:121]
    v_fmac_f32 v142, v185, v185
    v_fmac_f32 v142, v198, v198
    v_mfma_f32_16x16x32_f16 v[118:121], v[238:241], v[122:125], v[118:121]
    v_fmac_f32 v142, v199, v199
    v_fmac_f32 v142, v200, v200
    v_fmac_f32 v142, v201, v201
    v_cvt_pk_bf16_f32 v36, v254, v142
    v_mfma_f32_16x16x32_bf16 v[242:245], v[186:189], a[168:171], 0
    v_xor_b32 v0, 65536, v0
    v_xor_b32 v1, 65536, v1
    v_mfma_f32_16x16x32_bf16 v[242:245], v[170:173], a[172:175], v[242:245]
    v_mov_b32_dpp v143, v119 quad_perm:[0,1,2,3] row_mask:0x1 bank_mask:0xf
    v_add_u32 v5, 336, v5
    v_mfma_f32_16x16x32_bf16 v[242:245], v[234:237], a[176:179], v[242:245]
    v_xor_b32 v2, 65536, v2
    v_mfma_f32_16x16x32_bf16 v[242:245], v[154:157], a[180:183], v[242:245]
    v_mfma_f32_16x16x32_bf16 v[242:245], v[158:161], a[184:187], v[242:245]
    v_mfma_f32_16x16x32_bf16 v[242:245], v[226:229], a[188:191], v[242:245]
    s_nop 0
    s_nop 0
    s_nop 0
    s_nop 0
    s_nop 0
    s_nop 0
    s_nop 0
    s_nop 0
    v_cvt_pk_bf16_f32 v246, v242, v243
    v_cvt_pk_bf16_f32 v247, v244, v245
    v_mfma_f32_16x16x32_bf16 v[242:245], v[32:35], v[36:39], 0
    s_nop 0
    s_nop 0
    s_nop 0
    s_nop 0
    s_nop 0
    s_nop 0
    s_nop 0
    s_nop 0
    v_rsq_f32 v243, v243
    v_rsq_f32 v242, v242
    v_mul_f32 v150, v243, v150
    v_mul_f32 v242, s31, v242
    v_mul_f32 v151, v243, v151
    v_cvt_pk_f16_f32 v150, v150, v151
    v_mul_f32 v152, v243, v152
    v_mul_f32 v153, v243, v153
    v_cvt_pk_f16_f32 v151, v152, v153
    v_mul_f32 v182, v243, v182
    v_mul_f32 v183, v243, v183
    v_cvt_pk_f16_f32 v152, v182, v183
    v_mfma_f32_16x16x32_f16 v[230:233], v[206:209], v[146:149], v[24:27]
    v_mul_f32 v184, v243, v184
    v_mul_f32 v185, v243, v185
    v_mfma_f32_16x16x32_f16 v[230:233], v[194:197], v[210:213], v[230:233]
    v_cvt_pk_f16_f32 v153, v184, v185
    v_mul_f32 v198, v243, v198
    v_mfma_f32_16x16x32_f16 v[230:233], v[238:241], v[202:205], v[230:233]
    v_mul_f32 v199, v243, v199
    v_cvt_pk_f16_f32 v216, v198, v199
    v_mfma_f32_16x16x32_bf16 v[182:185], v[186:189], a[192:195], 0
    v_mul_f32 v200, v243, v200
    v_mul_f32 v201, v243, v201
    v_mfma_f32_16x16x32_bf16 v[182:185], v[170:173], a[196:199], v[182:185]
    v_cvt_pk_f16_f32 v217, v200, v201
    v_mul_f32 v178, v242, v178
    v_mfma_f32_16x16x32_bf16 v[182:185], v[234:237], a[200:203], v[182:185]
    v_mul_f32 v179, v242, v179
    v_cvt_pk_f16_f32 v198, v178, v179
    v_mfma_f32_16x16x32_bf16 v[182:185], v[154:157], a[204:207], v[182:185]
    v_mul_f32 v180, v242, v180
    v_mul_f32 v181, v242, v181
    v_mfma_f32_16x16x32_bf16 v[182:185], v[158:161], a[208:211], v[182:185]
    v_cvt_pk_f16_f32 v199, v180, v181
    v_mul_f32 v174, v242, v174
    v_mfma_f32_16x16x32_bf16 v[182:185], v[226:229], a[212:215], v[182:185]
    s_waitcnt vmcnt(0)
    ds_read2_b32 v[136:137], v6 offset0:0 offset1:0
    ds_read2_b32 v[248:249], v6 offset0:16 offset1:16
    v_mfma_f32_16x16x32_f16 v[226:229], v[114:117], v[126:129], v[46:49]
    s_barrier
    buffer_load_dwordx4 v10, s[8:11], 0 offen nt lds
    ds_read2_b32 v[160:161], v6 offset0:32 offset1:32
    v_mfma_f32_16x16x32_f16 v[154:157], v[210:213], v[126:129], v[50:53]
    s_add_u32 m0, s28, 4096
    v_cvt_pk_bf16_f32 v158, v182, v183
    v_cvt_pk_bf16_f32 v159, v184, v185
    v_mfma_f32_16x16x32_f16 v[182:185], v[150:153], v[126:129], v[54:57]
    v_mul_f32 v175, v242, v175
    v_cvt_pk_f16_f32 v200, v174, v175
    v_mul_f32 v176, v242, v176
    v_mfma_f32_16x16x16_f16 v[226:229], v[124:125], v[122:123], v[226:229]
    v_mul_f32 v177, v242, v177
    v_cvt_pk_f16_f32 v201, v176, v177
    v_mul_f32 v138, v242, v138
    v_mfma_f32_16x16x16_f16 v[154:157], v[204:205], v[122:123], v[154:157]
    v_mul_f32 v139, v242, v139
    v_cvt_pk_f16_f32 v214, v138, v139
    v_mul_f32 v140, v242, v140
    v_mfma_f32_16x16x16_f16 v[182:185], v[216:217], v[122:123], v[182:185]
    v_mul_f32 v141, v242, v141
    v_cvt_pk_f16_f32 v215, v140, v141
    v_mov_b32_dpp v143, v231 quad_perm:[0,1,2,3] row_mask:0x2 bank_mask:0xf
    v_max3_f32 v142, v118, v226, v227
    v_mfma_f32_16x16x32_f16 v[138:141], v[206:209], v[198:201], v[26:29]
    s_waitcnt lgkmcnt(1)
    buffer_load_dwordx4 v11, s[8:11], 0 offen nt lds
    v_max3_f32 v142, v142, v228, v229
    v_mfma_f32_16x16x32_f16 v[138:141], v[194:197], v[150:153], v[138:141]
    s_add_u32 m0, s28, 8192
    v_max3_f32 v142, v142, v154, v155
    v_max3_f32 v142, v142, v156, v157
    v_mfma_f32_16x16x32_f16 v[138:141], v[238:241], v[214:217], v[138:141]
    s_waitcnt lgkmcnt(0)
    v_max3_f32 v142, v142, v182, v183
    v_max3_f32 v142, v142, v184, v185
    v_mov_b32 v122, v142
    v_mfma_f32_16x16x16_bf16 v[126:129], a[216:217], v[144:145], v[222:225]
    v_add_u32 v6, 272, v6
    v_permlane32_swap_b32 v142, v122
    v_mfma_f32_16x16x16_bf16 v[174:177], a[240:241], v[144:145], v[222:225]
    v_max_f32 v142, v142, v122
    v_mov_b32 v122, v142
    v_mov_b32_dpp v143, v139 quad_perm:[0,1,2,3] row_mask:0x4 bank_mask:0xf
    v_mfma_f32_16x16x16_bf16 v[242:245], v[90:91], v[144:145], v[222:225]
    v_permlane16_swap_b32 v142, v122
    v_max_f32 v142, v142, v122
    v_mfma_f32_16x16x16_bf16 v[178:181], a[218:219], v[144:145], v[218:221]
    v_sub_f32 v226, v226, v142
    v_exp_f32 v226, v226
    v_mfma_f32_16x16x16_bf16 v[170:173], a[242:243], v[144:145], v[218:221]
    v_sub_f32 v227, v227, v142
    v_exp_f32 v227, v227
    v_mfma_f32_16x16x16_bf16 v[222:225], v[92:93], v[144:145], v[218:221]
    buffer_load_dwordx4 v12, s[8:11], 0 offen nt lds
    s_add_u32 m0, s28, 12288
    s_xor_b32 s28, s28, 65536
    v_cvt_pk_bf16_f32 v226, v226, v227
    v_sub_f32 v228, v228, v142
    v_exp_f32 v228, v228
    v_sub_f32 v229, v229, v142
    v_exp_f32 v229, v229
    v_sub_f32 v154, v154, v142
    v_cvt_pk_bf16_f32 v227, v228, v229
    v_exp_f32 v154, v154
    v_mfma_f32_16x16x32_f16 v[218:221], v[114:117], v[146:149], v[58:61]
    buffer_load_dwordx4 v13, s[8:11], 0 offen nt lds
    s_mov_b32 m0, s29
    s_xor_b32 s29, s29, s30
    v_sub_f32 v155, v155, v142
    v_exp_f32 v155, v155
    v_sub_f32 v156, v156, v142
    v_mfma_f32_16x16x16_f16 v[218:221], v[124:125], v[202:203], v[218:221]
    v_cvt_pk_bf16_f32 v228, v154, v155
    v_exp_f32 v156, v156
    v_sub_f32 v157, v157, v142
    v_exp_f32 v157, v157
    v_sub_f32 v182, v182, v142
    v_cvt_pk_bf16_f32 v229, v156, v157
    buffer_load_dwordx4 v14, s[8:11], 0 offen nt lds
    v_exp_f32 v182, v182
    v_mfma_f32_16x16x32_f16 v[154:157], v[210:213], v[146:149], v[62:65]
    v_sub_f32 v183, v183, v142
    v_exp_f32 v183, v183
    v_sub_f32 v184, v184, v142
    v_cvt_pk_bf16_f32 v36, v182, v183
    v_exp_f32 v184, v184
    v_sub_f32 v185, v185, v142
    v_mfma_f32_16x16x16_f16 v[154:157], v[204:205], v[202:203], v[154:157]
    v_exp_f32 v185, v185
    v_sub_f32 v118, v118, v142
    v_cvt_pk_bf16_f32 v37, v184, v185
    v_mfma_f32_16x16x32_f16 v[182:185], v[150:153], v[146:149], v[66:69]
    v_exp_f32 v118, v118
    v_max3_f32 v142, v230, v218, v219
    v_cvt_pk_bf16_f32 v39, v118, 0
    v_max3_f32 v142, v142, v220, v221
    v_max3_f32 v142, v142, v154, v155
    v_mfma_f32_16x16x32_bf16 v[118:121], v[28:31], v[36:39], 0
    v_max3_f32 v142, v142, v156, v157
    v_cvt_pk_bf16_f32 v126, v126, v127
    v_mfma_f32_16x16x32_bf16 v[118:121], v[28:31], v[226:229], v[118:121]
    v_accvgpr_write_b32 a216, v126
    v_cvt_pk_bf16_f32 v128, v128, v129
    v_mfma_f32_16x16x32_bf16 v[146:149], v[134:137], v[36:39], 0
    v_accvgpr_write_b32 a217, v128
    v_cvt_pk_bf16_f32 v174, v174, v175
    v_mfma_f32_16x16x32_bf16 v[146:149], v[190:193], v[226:229], v[146:149]
    v_accvgpr_write_b32 a240, v174
    v_cvt_pk_bf16_f32 v176, v176, v177
    v_mfma_f32_16x16x32_bf16 v[126:129], v[246:249], v[36:39], 0
    v_rcp_f32 v118, v118
    v_mfma_f32_16x16x32_bf16 v[126:129], v[162:165], v[226:229], v[126:129]
    v_accvgpr_write_b32 a241, v176
    v_cvt_pk_bf16_f32 v90, v242, v243
    v_mfma_f32_16x16x32_bf16 v[174:177], v[158:161], v[36:39], 0
    v_mul_f32 v146, v118, v146
    v_mul_f32 v147, v118, v147
    v_mfma_f32_16x16x32_bf16 v[174:177], v[166:169], v[226:229], v[174:177]
    v_cvt_pk_bf16_f32 v146, v146, v147
    v_mul_f32 v148, v118, v148
    v_mul_f32 v149, v118, v149
    v_mfma_f32_16x16x16_f16 v[182:185], v[216:217], v[202:203], v[182:185]
    v_cvt_pk_bf16_f32 v147, v148, v149
    v_mul_f32 v126, v118, v126
    v_mul_f32 v127, v118, v127
    v_cvt_pk_bf16_f32 v148, v126, v127
    v_mul_f32 v128, v118, v128
    v_mul_f32 v129, v118, v129
    v_cvt_pk_bf16_f32 v149, v128, v129
    ds_write_b128 v3, v[146:149] offset:0
    v_mul_f32 v174, v118, v174
    v_mul_f32 v175, v118, v175
    v_cvt_pk_bf16_f32 v122, v174, v175
    v_mul_f32 v176, v118, v176
    v_mul_f32 v177, v118, v177
    v_cvt_pk_bf16_f32 v123, v176, v177
    v_max3_f32 v142, v142, v182, v183
    ds_write_b64 v4, v[122:123] offset:4096
    v_max3_f32 v142, v142, v184, v185
    v_mov_b32 v122, v142
    v_cvt_pk_bf16_f32 v91, v244, v245
    ds_read_b128 v[118:121], v133 offset:128
    v_permlane32_swap_b32 v142, v122
    v_max_f32 v142, v142, v122
    v_mov_b32 v122, v142
    v_cvt_pk_bf16_f32 v178, v178, v179
    v_accvgpr_write_b32 a218, v178
    v_permlane16_swap_b32 v142, v122
    v_max_f32 v142, v142, v122
    v_sub_f32 v218, v218, v142
    v_exp_f32 v218, v218
    v_sub_f32 v219, v219, v142
    v_exp_f32 v219, v219
    v_sub_f32 v220, v220, v142
    v_cvt_pk_bf16_f32 v126, v218, v219
    v_exp_f32 v220, v220
    v_sub_f32 v221, v221, v142
    v_exp_f32 v221, v221
    v_sub_f32 v154, v154, v142
    v_cvt_pk_bf16_f32 v127, v220, v221
    v_exp_f32 v154, v154
    v_sub_f32 v155, v155, v142
    s_waitcnt lgkmcnt(0)
    v_mfma_f32_16x16x16_bf16 v[174:177], a[232:233], v[144:145], v[118:121]
    v_exp_f32 v155, v155
    v_sub_f32 v156, v156, v142
    v_mfma_f32_16x16x16_bf16 v[226:229], v[82:83], v[144:145], v[118:121]
    v_cvt_pk_bf16_f32 v128, v154, v155
    v_exp_f32 v156, v156
    v_mfma_f32_16x16x16_bf16 v[146:149], v[106:107], v[144:145], v[118:121]
    v_sub_f32 v157, v157, v142
    v_exp_f32 v157, v157
    v_sub_f32 v182, v182, v142
    v_cvt_pk_bf16_f32 v129, v156, v157
    v_exp_f32 v182, v182
    v_sub_f32 v183, v183, v142
    v_exp_f32 v183, v183
    v_sub_f32 v184, v184, v142
    v_cvt_pk_bf16_f32 v36, v182, v183
    v_exp_f32 v184, v184
    v_sub_f32 v185, v185, v142
    v_exp_f32 v185, v185
    v_mfma_f32_16x16x32_f16 v[218:221], v[114:117], v[198:201], v[70:73]
    v_cvt_pk_bf16_f32 v37, v184, v185
    v_sub_f32 v230, v230, v142
    v_mfma_f32_16x16x32_f16 v[154:157], v[210:213], v[198:201], v[74:77]
    v_exp_f32 v230, v230
    v_mfma_f32_16x16x32_f16 v[118:121], v[150:153], v[198:201], v[78:81]
    v_cvt_pk_bf16_f32 v39, v230, 0
    v_cvt_pk_bf16_f32 v180, v180, v181
    v_accvgpr_write_b32 a219, v180
    v_mfma_f32_16x16x32_bf16 v[150:153], v[28:31], v[36:39], 0
    v_cvt_pk_bf16_f32 v170, v170, v171
    v_accvgpr_write_b32 a242, v170
    v_mfma_f32_16x16x32_bf16 v[150:153], v[28:31], v[126:129], v[150:153]
    v_cvt_pk_bf16_f32 v172, v172, v173
    v_accvgpr_write_b32 a243, v172
    v_mfma_f32_16x16x32_bf16 v[170:173], v[134:137], v[36:39], 0
    v_cvt_pk_bf16_f32 v92, v222, v223
    v_cvt_pk_bf16_f32 v93, v224, v225
    v_mfma_f32_16x16x32_bf16 v[170:173], v[190:193], v[126:129], v[170:173]
    ds_read_b128 v[114:117], v133 offset:192
    v_cvt_pk_bf16_f32 v174, v174, v175
    v_mfma_f32_16x16x32_bf16 v[186:189], v[246:249], v[36:39], 0
    v_accvgpr_write_b32 a232, v174
    v_cvt_pk_bf16_f32 v176, v176, v177
    v_mfma_f32_16x16x32_bf16 v[186:189], v[162:165], v[126:129], v[186:189]
    v_accvgpr_write_b32 a233, v176
    v_cvt_pk_bf16_f32 v82, v226, v227
    v_mfma_f32_16x16x32_bf16 v[178:181], v[158:161], v[36:39], 0
    v_cvt_pk_bf16_f32 v83, v228, v229
    v_cvt_pk_bf16_f32 v106, v146, v147
    v_mfma_f32_16x16x32_bf16 v[178:181], v[166:169], v[126:129], v[178:181]
    v_cvt_pk_bf16_f32 v107, v148, v149
    v_rcp_f32 v150, v150
    v_mfma_f32_16x16x16_f16 v[218:221], v[124:125], v[214:215], v[218:221]
    v_mov_b32 v142, v143
    v_mul_f32 v170, v150, v170
    v_mul_f32 v171, v150, v171
    v_mfma_f32_16x16x16_f16 v[154:157], v[204:205], v[214:215], v[154:157]
    v_max_f32_dpp v142, v142, v142 quad_perm:[1,0,3,2] row_mask:0xf bank_mask:0xf
    v_cvt_pk_bf16_f32 v130, v170, v171
    v_mul_f32 v172, v150, v172
    v_mfma_f32_16x16x16_f16 v[118:121], v[216:217], v[214:215], v[118:121]
    s_waitcnt lgkmcnt(0)
    ds_read_b128 v[126:129], v133 offset:256
    v_max3_f32 v132, v138, v218, v219
    v_mfma_f32_16x16x16_bf16 v[122:125], a[220:221], v[144:145], v[114:117]
    v_max3_f32 v132, v132, v220, v221
    v_max3_f32 v132, v132, v154, v155
    v_max3_f32 v132, v132, v156, v157
    v_mfma_f32_16x16x16_bf16 v[146:149], a[244:245], v[144:145], v[114:117]
    v_max3_f32 v132, v132, v118, v119
    v_max3_f32 v132, v132, v120, v121
    v_mov_b32 v131, v132
    v_mfma_f32_16x16x16_bf16 v[182:185], v[94:95], v[144:145], v[114:117]
    v_cvt_pk_bf16_f32 v122, v122, v123
    v_accvgpr_write_b32 a220, v122
    v_cvt_pk_bf16_f32 v124, v124, v125
    v_accvgpr_write_b32 a221, v124
    v_cvt_pk_bf16_f32 v146, v146, v147
    v_accvgpr_write_b32 a244, v146
    v_cvt_pk_bf16_f32 v148, v148, v149
    v_accvgpr_write_b32 a245, v148
    v_cvt_pk_bf16_f32 v94, v182, v183
    v_cvt_pk_bf16_f32 v95, v184, v185
    ds_read_b128 v[122:125], v133 offset:320
    v_permlane32_swap_b32 v132, v131
    v_max_f32 v132, v132, v131
    v_mov_b32 v131, v132
    s_waitcnt lgkmcnt(1)
    v_mfma_f32_16x16x16_bf16 v[114:117], a[222:223], v[144:145], v[126:129]
    v_permlane16_swap_b32 v132, v131
    v_max_f32 v132, v132, v131
    v_mfma_f32_16x16x16_bf16 v[182:185], a[246:247], v[144:145], v[126:129]
    v_sub_f32 v218, v218, v132
    v_exp_f32 v218, v218
    v_mfma_f32_16x16x16_bf16 v[146:149], v[96:97], v[144:145], v[126:129]
    v_sub_f32 v219, v219, v132
    v_exp_f32 v219, v219
    v_cvt_pk_bf16_f32 v114, v114, v115
    v_accvgpr_write_b32 a222, v114
    v_cvt_pk_bf16_f32 v116, v116, v117
    v_accvgpr_write_b32 a223, v116
    v_cvt_pk_bf16_f32 v182, v182, v183
    v_accvgpr_write_b32 a246, v182
    v_cvt_pk_bf16_f32 v184, v184, v185
    v_accvgpr_write_b32 a247, v184
    v_cvt_pk_bf16_f32 v96, v146, v147
    v_cvt_pk_bf16_f32 v97, v148, v149
    s_waitcnt lgkmcnt(0)
    v_mfma_f32_16x16x16_bf16 v[114:117], a[234:235], v[144:145], v[122:125]
    ds_read_b128 v[206:209], v133 offset:384
    v_cvt_pk_bf16_f32 v146, v218, v219
    v_sub_f32 v220, v220, v132
    v_mfma_f32_16x16x16_bf16 v[174:177], v[84:85], v[144:145], v[122:125]
    v_exp_f32 v220, v220
    v_sub_f32 v221, v221, v132
    v_mfma_f32_16x16x16_bf16 v[126:129], v[108:109], v[144:145], v[122:125]
    ds_read_b128 v[182:185], v0 offset:20480
    ds_read_b128 v[198:201], v1 offset:20480
    ds_read_b128 v[210:213], v0 offset:20608
    ds_read_b128 v[222:225], v1 offset:20608
    ds_read_b128 v[226:229], v0 offset:20736
    ds_read_b128 v[242:245], v1 offset:20736
    v_cvt_pk_bf16_f32 v114, v114, v115
    v_accvgpr_write_b32 a234, v114
    v_cvt_pk_bf16_f32 v116, v116, v117
    v_accvgpr_write_b32 a235, v116
    v_cvt_pk_bf16_f32 v84, v174, v175
    s_waitcnt lgkmcnt(6)
    v_mfma_f32_16x16x16_bf16 v[122:125], a[224:225], v[144:145], v[206:209]
    v_cvt_pk_bf16_f32 v85, v176, v177
    v_cvt_pk_bf16_f32 v108, v126, v127
    v_cvt_pk_bf16_f32 v109, v128, v129
    v_mfma_f32_16x16x16_bf16 v[174:177], a[248:249], v[144:145], v[206:209]
    v_exp_f32 v221, v221
    v_sub_f32 v154, v154, v132
    v_mfma_f32_16x16x16_bf16 v[126:129], v[98:99], v[144:145], v[206:209]
    s_waitcnt lgkmcnt(4)
    ds_read_b128 v[202:205], v133 offset:448
    v_cvt_pk_bf16_f32 v122, v122, v123
    v_accvgpr_write_b32 a224, v122
    v_mfma_f32_16x16x32_bf16 v[114:117], a[72:75], v[182:185], 0
    s_waitcnt lgkmcnt(3)
    v_cvt_pk_bf16_f32 v124, v124, v125
    v_accvgpr_write_b32 a225, v124
    v_mfma_f32_16x16x32_bf16 v[114:117], a[76:79], v[198:201], v[114:117]
    s_waitcnt lgkmcnt(2)
    v_cvt_pk_bf16_f32 v174, v174, v175
    v_accvgpr_write_b32 a248, v174
    v_mfma_f32_16x16x32_bf16 v[114:117], a[80:83], v[210:213], v[114:117]
    s_waitcnt lgkmcnt(1)
    v_cvt_pk_bf16_f32 v176, v176, v177
    v_accvgpr_write_b32 a249, v176
    v_mfma_f32_16x16x32_bf16 v[114:117], a[84:87], v[222:225], v[114:117]
    v_cvt_pk_bf16_f32 v98, v126, v127
    v_cvt_pk_bf16_f32 v99, v128, v129
    v_mfma_f32_16x16x32_bf16 v[114:117], a[88:91], v[226:229], v[114:117]
    ds_read_b128 v[126:129], v133 offset:512
    v_cvt_pk_bf16_f32 v147, v220, v221
    v_mfma_f32_16x16x32_bf16 v[114:117], a[92:95], v[242:245], v[114:117]
    v_exp_f32 v154, v154
    v_mfma_f32_16x16x32_bf16 v[122:125], a[96:99], v[182:185], 0
    s_waitcnt lgkmcnt(1)
    v_sub_f32 v155, v155, v132
    v_exp_f32 v155, v155
    v_mfma_f32_16x16x16_bf16 v[174:177], a[226:227], v[144:145], v[202:205]
    v_cvt_pk_bf16_f32 v148, v154, v155
    v_sub_f32 v156, v156, v132
    v_sub_f32 v157, v157, v132
    v_mfma_f32_16x16x16_bf16 v[218:221], a[250:251], v[144:145], v[202:205]
    v_exp_f32 v156, v156
    v_sub_f32 v118, v118, v132
    v_mfma_f32_16x16x16_bf16 v[206:209], v[100:101], v[144:145], v[202:205]
    v_exp_f32 v157, v157
    v_cvt_pk_bf16_f32 v174, v174, v175
    v_accvgpr_write_b32 a226, v174
    v_mfma_f32_16x16x32_bf16 v[122:125], a[100:103], v[198:201], v[122:125]
    v_cvt_pk_bf16_f32 v176, v176, v177
    v_accvgpr_write_b32 a227, v176
    v_mfma_f32_16x16x32_bf16 v[122:125], a[104:107], v[210:213], v[122:125]
    s_waitcnt lgkmcnt(0)
    v_cvt_pk_bf16_f32 v218, v218, v219
    v_accvgpr_write_b32 a250, v218
    v_cvt_pk_bf16_f32 v220, v220, v221
    v_mfma_f32_16x16x16_bf16 v[174:177], a[236:237], v[144:145], v[126:129]
    v_accvgpr_write_b32 a251, v220
    v_cvt_pk_bf16_f32 v100, v206, v207
    v_cvt_pk_bf16_f32 v101, v208, v209
    v_mfma_f32_16x16x16_bf16 v[218:221], v[86:87], v[144:145], v[126:129]
    v_cvt_pk_bf16_f32 v149, v156, v157
    v_exp_f32 v118, v118
    v_mfma_f32_16x16x16_bf16 v[206:209], v[110:111], v[144:145], v[126:129]
    v_sub_f32 v119, v119, v132
    v_cvt_pk_bf16_f32 v174, v174, v175
    v_accvgpr_write_b32 a236, v174
    v_cvt_pk_bf16_f32 v176, v176, v177
    v_mfma_f32_16x16x32_bf16 v[122:125], a[108:111], v[222:225], v[122:125]
    ds_read_b128 v[154:157], v133 offset:576
    v_accvgpr_write_b32 a237, v176
    v_mfma_f32_16x16x32_bf16 v[122:125], a[112:115], v[226:229], v[122:125]
    v_cvt_pk_bf16_f32 v86, v218, v219
    v_cvt_pk_bf16_f32 v87, v220, v221
    v_mfma_f32_16x16x32_bf16 v[122:125], a[116:119], v[242:245], v[122:125]
    v_cvt_pk_bf16_f32 v110, v206, v207
    v_cvt_pk_bf16_f32 v111, v208, v209
    v_mfma_f32_16x16x32_bf16 v[126:129], a[120:123], v[182:185], 0
    ds_read_b128 v[174:177], v133 offset:640
    v_sub_f32 v120, v120, v132
    v_mfma_f32_16x16x32_bf16 v[126:129], a[124:127], v[198:201], v[126:129]
    v_exp_f32 v119, v119
    v_mfma_f32_16x16x32_bf16 v[126:129], a[128:131], v[210:213], v[126:129]
    v_cvt_pk_bf16_f32 v36, v118, v119
    v_sub_f32 v121, v121, v132
    v_mfma_f32_16x16x32_bf16 v[126:129], a[132:135], v[222:225], v[126:129]
    v_exp_f32 v120, v120
    v_mfma_f32_16x16x32_bf16 v[126:129], a[136:139], v[226:229], v[126:129]
    v_exp_f32 v121, v121
    v_mfma_f32_16x16x32_bf16 v[126:129], a[140:143], v[242:245], v[126:129]
    s_waitcnt lgkmcnt(1)
    v_cvt_pk_bf16_f32 v37, v120, v121
    v_sub_f32 v138, v138, v132
    v_max_f32_dpp v142, v142, v142 quad_perm:[2,3,0,1] row_mask:0xf bank_mask:0xf
    v_mfma_f32_16x16x16_bf16 v[118:121], a[228:229], v[144:145], v[154:157]
    v_exp_f32 v138, v138
    v_max_f32_dpp v142, v142, v142 row_half_mirror row_mask:0xf bank_mask:0xf
    v_mfma_f32_16x16x16_bf16 v[218:221], a[252:253], v[144:145], v[154:157]
    v_cvt_pk_bf16_f32 v39, v138, 0
    v_max_f32_dpp v142, v142, v142 row_mirror row_mask:0xf bank_mask:0xf
    v_mov_b32 v254, v142
    v_mul_f32 v173, v150, v173
    v_mfma_f32_16x16x32_bf16 v[206:209], v[28:31], v[36:39], 0
    s_waitcnt lgkmcnt(0)
    v_cvt_pk_bf16_f32 v118, v118, v119
    v_accvgpr_write_b32 a228, v118
    v_mfma_f32_16x16x32_bf16 v[206:209], v[28:31], v[146:149], v[206:209]
    v_cvt_pk_bf16_f32 v120, v120, v121
    v_accvgpr_write_b32 a229, v120
    v_mfma_f32_16x16x32_bf16 v[138:141], v[134:137], v[36:39], 0
    v_cvt_pk_bf16_f32 v218, v218, v219
    v_accvgpr_write_b32 a252, v218
    v_mfma_f32_16x16x32_bf16 v[138:141], v[190:193], v[146:149], v[138:141]
    v_cvt_pk_bf16_f32 v220, v220, v221
    v_accvgpr_write_b32 a253, v220
    v_mfma_f32_16x16x32_bf16 v[118:121], v[246:249], v[36:39], 0
    v_rcp_f32 v206, v206
    v_mfma_f32_16x16x32_bf16 v[118:121], v[162:165], v[146:149], v[118:121]
    v_permlane32_swap_b32 v142, v254
    v_mfma_f32_16x16x32_bf16 v[218:221], v[158:161], v[36:39], 0
    v_max_f32 v142, v142, v254
    v_mul_f32 v138, v206, v138
    v_mfma_f32_16x16x32_bf16 v[218:221], v[166:169], v[146:149], v[218:221]
    v_mul_f32 v139, v206, v139
    v_cvt_pk_bf16_f32 v146, v138, v139
    v_mul_f32 v140, v206, v140
    v_mfma_f32_16x16x16_bf16 v[202:205], v[102:103], v[144:145], v[154:157]
    v_mul_f32 v141, v206, v141
    v_cvt_pk_bf16_f32 v147, v140, v141
    v_mul_f32 v118, v206, v118
    v_mfma_f32_16x16x16_bf16 v[138:141], a[230:231], v[144:145], v[174:177]
    v_mul_f32 v119, v206, v119
    v_cvt_pk_bf16_f32 v148, v118, v119
    v_mul_f32 v120, v206, v120
    v_mfma_f32_16x16x16_bf16 v[154:157], a[254:255], v[144:145], v[174:177]
    v_mul_f32 v121, v206, v121
    v_cvt_pk_bf16_f32 v149, v120, v121
    v_mul_f32 v218, v206, v218
    v_mfma_f32_16x16x16_bf16 v[118:121], v[104:105], v[144:145], v[174:177]
    v_mul_f32 v219, v206, v219
    v_cvt_pk_bf16_f32 v170, v218, v219
    v_mul_f32 v220, v206, v220
    v_mul_f32 v221, v206, v221
    v_mfma_f32_16x16x32_bf16 v[206:209], a[0:3], v[182:185], 0
    ds_write_b128 v3, v[146:149] offset:12288
    v_mfma_f32_16x16x32_bf16 v[206:209], a[4:7], v[198:201], v[206:209]
    v_cvt_pk_bf16_f32 v171, v220, v221
    v_cvt_pk_bf16_f32 v102, v202, v203
    v_mfma_f32_16x16x32_bf16 v[206:209], a[8:11], v[210:213], v[206:209]
    v_cvt_pk_bf16_f32 v103, v204, v205
    v_cvt_pk_bf16_f32 v138, v138, v139
    v_mfma_f32_16x16x32_bf16 v[206:209], a[12:15], v[222:225], v[206:209]
    ds_read_b128 v[146:149], v133 offset:704
    v_accvgpr_write_b32 a230, v138
    v_mfma_f32_16x16x32_bf16 v[206:209], a[16:19], v[226:229], v[206:209]
    ds_write_b64 v4, v[170:171] offset:16384
    v_mfma_f32_16x16x32_bf16 v[206:209], a[20:23], v[242:245], v[206:209]
    v_cvt_pk_bf16_f32 v140, v140, v141
    v_accvgpr_write_b32 a231, v140
    v_mfma_f32_16x16x32_bf16 v[174:177], a[24:27], v[182:185], 0
    v_cvt_pk_bf16_f32 v154, v154, v155
    v_accvgpr_write_b32 a254, v154
    v_mfma_f32_16x16x32_bf16 v[174:177], a[28:31], v[198:201], v[174:177]
    v_cvt_pk_bf16_f32 v156, v156, v157
    v_accvgpr_write_b32 a255, v156
    v_mfma_f32_16x16x32_bf16 v[174:177], a[32:35], v[210:213], v[174:177]
    v_cvt_pk_bf16_f32 v104, v118, v119
    v_cvt_pk_bf16_f32 v105, v120, v121
    v_mfma_f32_16x16x32_bf16 v[174:177], a[36:39], v[222:225], v[174:177]
    v_mov_b32 v254, v142
    v_cvt_pk_bf16_f32 v131, v172, v173
    v_mfma_f32_16x16x32_bf16 v[174:177], a[40:43], v[226:229], v[174:177]
    s_waitcnt lgkmcnt(1)
    v_permlane16_swap_b32 v142, v254
    v_max_f32 v142, v142, v254
    v_mfma_f32_16x16x16_bf16 v[118:121], a[238:239], v[144:145], v[146:149]
    v_sub_f32 v143, v143, v142
    v_exp_f32 v143, v143
    v_mfma_f32_16x16x16_bf16 v[154:157], v[88:89], v[144:145], v[146:149]
    v_cvt_pk_bf16_f32 v143, v143, v143
    v_mul_f32 v186, v150, v186
    v_mul_f32 v187, v150, v187
    v_mfma_f32_16x16x16_bf16 v[138:141], v[112:113], v[144:145], v[146:149]
    v_cvt_pk_bf16_f32 v132, v186, v187
    v_cvt_pk_bf16_f32 v118, v118, v119
    v_accvgpr_write_b32 a238, v118
    v_cvt_pk_bf16_f32 v120, v120, v121
    v_mfma_f32_16x16x32_bf16 v[174:177], a[44:47], v[242:245], v[174:177]
    ds_write_b16 v8, v143
    v_mfma_f32_16x16x32_bf16 v[218:221], a[48:51], v[182:185], 0
    v_accvgpr_write_b32 a239, v120
    v_cvt_pk_bf16_f32 v88, v154, v155
    v_mfma_f32_16x16x32_bf16 v[218:221], a[52:55], v[198:201], v[218:221]
    ds_read_b128 v[142:145], v9
    ds_read_b128 v[118:121], v9 offset:64
    v_mfma_f32_16x16x32_bf16 v[218:221], a[56:59], v[210:213], v[218:221]
    v_cvt_pk_bf16_f32 v89, v156, v157
    v_cvt_pk_bf16_f32 v112, v138, v139
    v_mfma_f32_16x16x32_bf16 v[218:221], a[60:63], v[222:225], v[218:221]
    v_cvt_pk_bf16_f32 v113, v140, v141
    v_mul_f32 v188, v150, v188
    v_mfma_f32_16x16x32_bf16 v[218:221], a[64:67], v[226:229], v[218:221]
    v_mul_f32 v189, v150, v189
    v_cvt_pk_bf16_f32 v133, v188, v189
    v_mfma_f32_16x16x32_bf16 v[218:221], a[68:71], v[242:245], v[218:221]
    ds_write_b128 v3, v[130:133] offset:6144
    v_mfma_f32_16x16x32_bf16 v[170:173], v[182:185], a[144:147], 0
    v_mul_f32 v178, v150, v178
    v_mul_f32 v179, v150, v179
    v_mfma_f32_16x16x32_bf16 v[170:173], v[198:201], a[148:151], v[170:173]
    v_cvt_pk_bf16_f32 v254, v178, v179
    v_mul_f32 v180, v150, v180
    v_mfma_f32_16x16x32_bf16 v[170:173], v[210:213], a[152:155], v[170:173]
    s_waitcnt lgkmcnt(1)
    v_mul_f32 v181, v150, v181
    v_cvt_pk_bf16_f32 v255, v180, v181
    v_mfma_f32_16x16x32_bf16 v[130:133], v[142:145], v[28:31], 0
    ds_write_b64 v4, v[254:255] offset:10240
    v_mfma_f32_16x16x32_bf16 v[130:133], v[118:121], v[28:31], v[130:133]
    v_xor_b32 v3, 65536, v3
    v_xor_b32 v4, 65536, v4
    v_mfma_f32_16x16x32_bf16 v[154:157], v[142:145], v[190:193], 0
    v_mfma_f32_16x16x32_bf16 v[154:157], v[118:121], v[134:137], v[154:157]
    v_mfma_f32_16x16x32_bf16 v[134:137], v[142:145], v[162:165], 0
    v_mfma_f32_16x16x32_bf16 v[134:137], v[118:121], v[246:249], v[134:137]
    v_mfma_f32_16x16x32_bf16 v[162:165], v[142:145], v[166:169], 0
    v_mfma_f32_16x16x32_bf16 v[162:165], v[118:121], v[158:161], v[162:165]
    v_rcp_f32 v130, v130
    v_mfma_f32_16x16x32_bf16 v[170:173], v[222:225], a[156:159], v[170:173]
    v_mfma_f32_16x16x32_bf16 v[170:173], v[226:229], a[160:163], v[170:173]
    v_mfma_f32_16x16x32_bf16 v[170:173], v[242:245], a[164:167], v[170:173]
    v_mul_f32 v154, v154, v130
    s_nop 0
    v_mul_f32_dpp v154, v134, v130 quad_perm:[0,1,2,3] row_mask:0x2 bank_mask:0xf
    s_nop 0
    v_mul_f32_dpp v154, v162, v130 quad_perm:[0,1,2,3] row_mask:0x4 bank_mask:0xf
    v_cvt_pk_bf16_f32 v154, v154, v154
    ds_write_b16 v7, v154
    v_add_u32 v7, 16, v7
    s_waitcnt lgkmcnt(0)
    s_barrier
    s_waitcnt lgkmcnt(0)
    s_cmp_eq_u32 s17, 1
    s_cbranch_scc1 L_drain
    s_max_u32 s3, s37, s44
    s_cmp_gt_u32 s3, 0x42000000
    s_cbranch_scc1 L_safe
    v_cvt_pk_f16_f32 v118, v114, v115
    v_pk_mul_f16 v163, v118, v118
    v_cvt_pk_f16_f32 v119, v116, v117
    v_pk_mul_f16 v165, v119, v119
    v_cvt_pk_f16_f32 v120, v122, v123
    v_pk_fma_f16 v163, v120, v120, v163
    v_cvt_pk_f16_f32 v121, v124, v125
    v_pk_fma_f16 v165, v121, v121, v165
    v_cvt_pk_f16_f32 v196, v126, v127
    v_pk_fma_f16 v163, v196, v196, v163
    v_cvt_pk_f16_f32 v197, v128, v129
    v_pk_fma_f16 v165, v197, v197, v165
    v_cvt_pk_f16_f32 v206, v206, v207
    s_branch L_go
L_safe:
    v_fma_f32 v130, v114, v114, s32
    v_fmac_f32 v130, v115, v115
    v_fmac_f32 v130, v116, v116
    v_fmac_f32 v130, v117, v117
    v_fmac_f32 v130, v122, v122
    v_fmac_f32 v130, v123, v123
    v_fmac_f32 v130, v124, v124
    v_fmac_f32 v130, v125, v125
    v_fmac_f32 v130, v126, v126
    v_fmac_f32 v130, v127, v127
    v_fmac_f32 v130, v128, v128
    v_fmac_f32 v130, v129, v129
    v_fma_f32 v131, v206, v206, s32
    v_fmac_f32 v131, v207, v207
    v_fmac_f32 v131, v208, v208
    v_fmac_f32 v131, v209, v209
    v_fmac_f32 v131, v174, v174
    s_cmp_eq_u32 s16, 1
    s_cbranch_scc1 L_loop_safe1
    s_cmp_eq_u32 s16, 2
    s_cbranch_scc1 L_loop_safe2
    s_cmp_eq_u32 s16, 3
    s_cbranch_scc1 L_loop_safe3
    s_branch L_loop_safe0
.p2align 6
L_loop_safe0:
    v_mfma_f32_16x16x32_bf16 v[162:165], v[182:185], a[168:171], 0
    s_add_u32 s12, s42, s27
    ds_read_b128 v[194:197], v2 offset:18432
    ds_read_b128 v[230:233], v2 offset:19456
    v_mfma_f32_16x16x32_bf16 v[162:165], v[198:201], a[172:175], v[162:165]
    s_addc_u32 s13, s43, 0
    v_fmac_f32 v131, v175, v175
    v_fmac_f32 v131, v176, v176
    v_mfma_f32_16x16x32_bf16 v[162:165], v[210:213], a[176:179], v[162:165]
    s_sub_u32 s14, s36, s27
    v_fmac_f32 v131, v177, v177
    v_fmac_f32 v131, v218, v218
    v_mfma_f32_16x16x32_bf16 v[162:165], v[222:225], a[180:183], v[162:165]
    s_cmp_ge_u32 s18, 2
    v_fmac_f32 v131, v219, v219
    v_fmac_f32 v131, v220, v220
    v_mfma_f32_16x16x32_bf16 v[162:165], v[226:229], a[184:187], v[162:165]
    s_cselect_b32 s14, s14, 0
    ds_read_b128 v[118:121], v0 offset:26624
    v_fmac_f32 v131, v221, v221
    v_mfma_f32_16x16x32_bf16 v[162:165], v[242:245], a[188:191], v[162:165]
    s_add_u32 s34, s18, 2
    ds_read_b128 v[134:137], v1 offset:26624
    v_cvt_pk_bf16_f32 v36, v131, v130
    v_mfma_f32_16x16x32_bf16 v[214:217], v[182:185], a[192:195], 0
    s_add_u32 s8, s40, s23
    ds_read_b128 v[154:157], v0 offset:26752
    v_cvt_pk_bf16_f32 v170, v170, v171
    v_mfma_f32_16x16x32_bf16 v[214:217], v[198:201], a[196:199], v[214:217]
    s_addc_u32 s9, s41, 0
    ds_read_b128 v[198:201], v1 offset:26752
    v_cvt_pk_bf16_f32 v171, v172, v173
    v_mfma_f32_16x16x32_bf16 v[166:169], v[32:35], v[36:39], 0
    s_sub_u32 s10, s36, s23
    v_cvt_pk_bf16_f32 v130, v162, v163
    v_cvt_pk_bf16_f32 v131, v164, v165
    v_mfma_f32_16x16x32_bf16 v[214:217], v[210:213], a[200:203], v[214:217]
    s_waitcnt lgkmcnt(4)
    ds_read_b128 v[210:213], v0 offset:26880
    s_cmp_lt_u32 s34, s17
    v_mfma_f32_16x16x32_bf16 v[234:237], v[32:35], v[194:197], 0
    s_cselect_b32 s10, s10, 0
    v_rsq_f32 v167, v167
    v_mfma_f32_16x16x32_bf16 v[234:237], v[32:35], v[230:233], v[234:237]
    s_add_u32 m0, s28, 0
    v_rsq_f32 v166, v166
    v_mfma_f32_16x16x32_bf16 v[214:217], v[222:225], a[204:207], v[214:217]
    s_waitcnt lgkmcnt(4)
    ds_read_b128 v[162:165], v1 offset:26880
    v_mul_f32 v166, s31, v166
    v_mfma_f32_16x16x32_bf16 v[214:217], v[226:229], a[208:211], v[214:217]
    s_mov_b32 s27, s26
    v_mul_f32 v114, v167, v114
    v_mul_f32 v115, v167, v115
    v_mfma_f32_16x16x32_bf16 v[214:217], v[242:245], a[212:215], v[214:217]
    s_mov_b32 s26, s25
    v_cvt_pk_f16_f32 v242, v114, v115
    v_mul_f32 v116, v167, v116
    v_mfma_f32_16x16x32_bf16 v[226:229], a[72:75], v[118:121], 0
    s_waitcnt lgkmcnt(2)
    v_mul_f32 v117, v167, v117
    v_cvt_pk_f16_f32 v243, v116, v117
    v_mfma_f32_16x16x32_bf16 v[226:229], a[76:79], v[134:137], v[226:229]
    s_mov_b32 s25, s24
    v_cvt_pk_bf16_f32 v114, v214, v215
    v_cvt_pk_bf16_f32 v115, v216, v217
    v_mfma_f32_16x16x32_bf16 v[226:229], a[80:83], v[154:157], v[226:229]
    s_mov_b32 s24, s23
    v_mul_f32 v122, v167, v122
    v_mul_f32 v123, v167, v123
    v_mfma_f32_16x16x32_bf16 v[226:229], a[84:87], v[198:201], v[226:229]
    s_waitcnt lgkmcnt(1)
    v_cvt_pk_f16_f32 v244, v122, v123
    v_mul_f32 v124, v167, v124
    v_mfma_f32_16x16x32_bf16 v[226:229], a[88:91], v[210:213], v[226:229]
    v_mul_f32 v125, v167, v125
    v_cvt_pk_f16_f32 v245, v124, v125
    v_mfma_f32_16x16x32_bf16 v[122:125], a[96:99], v[118:121], 0
    s_waitcnt lgkmcnt(0)
    v_mul_f32 v126, v167, v126
    v_mul_f32 v127, v167, v127
    v_mfma_f32_16x16x32_bf16 v[226:229], a[92:95], v[162:165], v[226:229]
    v_cvt_pk_f16_f32 v184, v126, v127
    v_mul_f32 v128, v167, v128
    v_mfma_f32_16x16x32_bf16 v[122:125], a[100:103], v[134:137], v[122:125]
    v_mul_f32 v129, v167, v129
    v_cvt_pk_f16_f32 v185, v128, v129
    v_mfma_f32_16x16x32_bf16 v[122:125], a[104:107], v[154:157], v[122:125]
    v_mul_f32 v206, v166, v206
    v_mul_f32 v207, v166, v207
    v_mfma_f32_16x16x32_bf16 v[122:125], a[108:111], v[198:201], v[122:125]
    v_cvt_pk_f16_f32 v222, v206, v207
    v_mul_f32 v208, v166, v208
    v_mfma_f32_16x16x32_bf16 v[122:125], a[112:115], v[210:213], v[122:125]
    v_mul_f32 v209, v166, v209
    v_cvt_pk_f16_f32 v223, v208, v209
    v_mfma_f32_16x16x32_bf16 v[122:125], a[116:119], v[162:165], v[122:125]
    v_mul_f32 v174, v166, v174
    v_mul_f32 v175, v166, v175
    v_mfma_f32_16x16x32_bf16 v[126:129], a[120:123], v[118:121], 0
    v_cvt_pk_f16_f32 v224, v174, v175
    v_mul_f32 v176, v166, v176
    v_mfma_f32_16x16x32_bf16 v[126:129], a[124:127], v[134:137], v[126:129]
    v_mul_f32 v177, v166, v177
    v_cvt_pk_f16_f32 v225, v176, v177
    v_mfma_f32_16x16x32_bf16 v[126:129], a[128:131], v[154:157], v[126:129]
    v_mul_f32 v218, v166, v218
    v_mul_f32 v219, v166, v219
    v_mfma_f32_16x16x32_bf16 v[126:129], a[132:135], v[198:201], v[126:129]
    v_cvt_pk_f16_f32 v182, v218, v219
    v_mul_f32 v220, v166, v220
    v_mfma_f32_16x16x32_bf16 v[126:129], a[136:139], v[210:213], v[126:129]
    v_mul_f32 v221, v166, v221
    v_cvt_pk_f16_f32 v183, v220, v221
    v_mfma_f32_16x16x32_bf16 v[126:129], a[140:143], v[162:165], v[126:129]
    v_fma_f32 v116, v226, v226, s32
    v_fmac_f32 v116, v227, v227
    v_mfma_f32_16x16x32_bf16 v[206:209], a[0:3], v[118:121], 0
    v_fmac_f32 v116, v228, v228
    v_fmac_f32 v116, v229, v229
    v_mfma_f32_16x16x32_bf16 v[206:209], a[4:7], v[134:137], v[206:209]
    v_fmac_f32 v116, v122, v122
    v_fmac_f32 v116, v123, v123
    v_mfma_f32_16x16x32_bf16 v[206:209], a[8:11], v[154:157], v[206:209]
    v_fmac_f32 v116, v124, v124
    v_fmac_f32 v116, v125, v125
    v_mfma_f32_16x16x32_bf16 v[206:209], a[12:15], v[198:201], v[206:209]
    v_fmac_f32 v116, v126, v126
    v_fmac_f32 v116, v127, v127
    v_mfma_f32_16x16x32_bf16 v[206:209], a[16:19], v[210:213], v[206:209]
    v_fmac_f32 v116, v128, v128
    v_fmac_f32 v116, v129, v129
    v_mfma_f32_16x16x32_bf16 v[206:209], a[20:23], v[162:165], v[206:209]
    v_mul_f32 v117, 0x3baaaaab, v234
    v_mul_f32 v254, 0x3baaaaab, v235
    v_mfma_f32_16x16x32_bf16 v[174:177], a[24:27], v[118:121], 0
    v_rsq_f32 v117, v117
    v_mfma_f32_16x16x32_bf16 v[174:177], a[28:31], v[134:137], v[174:177]
    v_rsq_f32 v254, v254
    v_mfma_f32_16x16x32_bf16 v[174:177], a[32:35], v[154:157], v[174:177]
    v_mul_f32 v255, 0x3baaaaab, v236
    v_fma_f32 v132, v206, v206, s32
    v_mfma_f32_16x16x32_bf16 v[174:177], a[36:39], v[198:201], v[174:177]
    v_fmac_f32 v132, v207, v207
    v_fmac_f32 v132, v208, v208
    v_mfma_f32_16x16x32_bf16 v[174:177], a[40:43], v[210:213], v[174:177]
    v_fmac_f32 v132, v209, v209
    v_mul_f32 v150, v117, v150
    v_mfma_f32_16x16x32_bf16 v[174:177], a[44:47], v[162:165], v[174:177]
    v_rsq_f32 v255, v255
    v_mfma_f32_16x16x32_bf16 v[218:221], a[48:51], v[118:121], 0
    v_mul_f32 v151, v117, v151
    v_cvt_pk_bf16_f32 v194, v150, v151
    v_mfma_f32_16x16x32_bf16 v[218:221], a[52:55], v[134:137], v[218:221]
    v_mul_f32 v152, v117, v152
    v_mul_f32 v153, v117, v153
    v_mfma_f32_16x16x32_bf16 v[218:221], a[56:59], v[154:157], v[218:221]
    v_fmac_f32 v132, v174, v174
    v_fmac_f32 v132, v175, v175
    v_mfma_f32_16x16x32_bf16 v[218:221], a[60:63], v[198:201], v[218:221]
    v_fmac_f32 v132, v176, v176
    v_fmac_f32 v132, v177, v177
    v_mfma_f32_16x16x32_bf16 v[218:221], a[64:67], v[210:213], v[218:221]
    v_cvt_pk_bf16_f32 v195, v152, v153
    v_mul_f32 v190, v117, v190
    v_mfma_f32_16x16x32_bf16 v[218:221], a[68:71], v[162:165], v[218:221]
    v_mul_f32 v191, v117, v191
    v_cvt_pk_bf16_f32 v196, v190, v191
    v_mfma_f32_16x16x32_bf16 v[150:153], v[118:121], a[144:147], 0
    v_mul_f32 v192, v117, v192
    v_mul_f32 v193, v117, v193
    v_mfma_f32_16x16x32_bf16 v[150:153], v[134:137], a[148:151], v[150:153]
    v_cvt_pk_bf16_f32 v197, v192, v193
    v_mul_f32 v202, v117, v202
    v_mfma_f32_16x16x32_bf16 v[150:153], v[154:157], a[152:155], v[150:153]
    buffer_store_dwordx4 v[194:197], v15, s[12:15], 0 offen nt
    v_fmac_f32 v132, v218, v218
    v_fmac_f32 v132, v219, v219
    v_fmac_f32 v132, v220, v220
    v_fmac_f32 v132, v221, v221
    v_mfma_f32_16x16x32_bf16 v[150:153], v[198:201], a[156:159], v[150:153]
    v_cvt_pk_bf16_f32 v36, v132, v116
    v_mul_f32 v203, v117, v203
    v_mfma_f32_16x16x32_bf16 v[150:153], v[210:213], a[160:163], v[150:153]
    v_cvt_pk_bf16_f32 v116, v202, v203
    v_mul_f32 v204, v117, v204
    v_mfma_f32_16x16x32_bf16 v[190:193], v[32:35], v[36:39], 0
    v_mul_f32 v205, v117, v205
    v_cvt_pk_bf16_f32 v117, v204, v205
    v_mfma_f32_16x16x32_bf16 v[150:153], v[162:165], a[164:167], v[150:153]
    v_mul_f32 v146, v255, v146
    v_mul_f32 v147, v255, v147
    v_mfma_f32_16x16x32_bf16 v[202:205], v[118:121], a[168:171], 0
    v_cvt_pk_bf16_f32 v146, v146, v147
    v_mul_f32 v148, v255, v148
    v_mfma_f32_16x16x32_bf16 v[202:205], v[134:137], a[172:175], v[202:205]
    v_rsq_f32 v191, v191
    v_mfma_f32_16x16x32_bf16 v[202:205], v[154:157], a[176:179], v[202:205]
    v_cvt_pk_bf16_f32 v172, v150, v151
    v_cvt_pk_bf16_f32 v173, v152, v153
    v_mfma_f32_16x16x32_bf16 v[202:205], v[198:201], a[180:183], v[202:205]
    v_rsq_f32 v190, v190
    v_mfma_f32_16x16x32_bf16 v[202:205], v[210:213], a[184:187], v[202:205]
    ds_read_b128 v[150:153], v0 offset:32768
    v_mul_f32 v190, s31, v190
    v_mfma_f32_16x16x32_bf16 v[202:205], v[162:165], a[188:191], v[202:205]
    ds_read_b128 v[166:169], v1 offset:32768
    v_mul_f32 v226, v191, v226
    v_mfma_f32_16x16x32_bf16 v[194:197], v[118:121], a[192:195], 0
    ds_read_b128 v[118:121], v0 offset:32896
    v_mul_f32 v227, v191, v227
    v_mfma_f32_16x16x32_bf16 v[194:197], v[134:137], a[196:199], v[194:197]
    ds_read_b128 v[134:137], v1 offset:32896
    v_cvt_pk_f16_f32 v226, v226, v227
    v_mfma_f32_16x16x32_bf16 v[194:197], v[154:157], a[200:203], v[194:197]
    ds_read_b128 v[154:157], v0 offset:33024
    v_cvt_pk_bf16_f32 v132, v202, v203
    v_mfma_f32_16x16x32_bf16 v[194:197], v[198:201], a[204:207], v[194:197]
    ds_read_b128 v[198:201], v1 offset:33024
    v_cvt_pk_bf16_f32 v133, v204, v205
    v_mfma_f32_16x16x32_bf16 v[194:197], v[210:213], a[208:211], v[194:197]
    v_mul_f32 v228, v191, v228
    v_mul_f32 v229, v191, v229
    v_mfma_f32_16x16x32_bf16 v[194:197], v[162:165], a[212:215], v[194:197]
    v_cvt_pk_f16_f32 v227, v228, v229
    v_mul_f32 v122, v191, v122
    v_mfma_f32_16x16x32_f16 v[210:213], v[242:245], v[222:225], v[46:49]
    s_waitcnt lgkmcnt(5)
    buffer_store_dwordx2 v[116:117], v18, s[12:15], 0 offen nt
    v_mul_f32 v123, v191, v123
    v_cvt_pk_f16_f32 v228, v122, v123
    v_mfma_f32_16x16x32_bf16 v[202:205], a[72:75], v[150:153], 0
    s_waitcnt lgkmcnt(3)
    v_cvt_pk_bf16_f32 v116, v194, v195
    v_cvt_pk_bf16_f32 v117, v196, v197
    v_mfma_f32_16x16x32_bf16 v[202:205], a[76:79], v[166:169], v[202:205]
    s_waitcnt lgkmcnt(2)
    v_mul_f32 v124, v191, v124
    v_mul_f32 v125, v191, v125
    v_mfma_f32_16x16x32_bf16 v[202:205], a[80:83], v[118:121], v[202:205]
    s_waitcnt lgkmcnt(1)
    v_cvt_pk_f16_f32 v229, v124, v125
    v_mul_f32 v126, v191, v126
    v_mfma_f32_16x16x32_bf16 v[202:205], a[84:87], v[134:137], v[202:205]
    s_waitcnt lgkmcnt(0)
    v_mul_f32 v127, v191, v127
    v_cvt_pk_f16_f32 v124, v126, v127
    v_mfma_f32_16x16x32_bf16 v[202:205], a[88:91], v[154:157], v[202:205]
    v_mul_f32 v128, v191, v128
    v_mul_f32 v129, v191, v129
    v_mfma_f32_16x16x32_bf16 v[202:205], a[92:95], v[198:201], v[202:205]
    v_cvt_pk_f16_f32 v125, v128, v129
    v_mul_f32 v206, v190, v206
    v_mfma_f32_16x16x32_bf16 v[126:129], a[96:99], v[150:153], 0
    v_mul_f32 v207, v190, v207
    v_cvt_pk_f16_f32 v206, v206, v207
    v_mfma_f32_16x16x32_bf16 v[126:129], a[100:103], v[166:169], v[126:129]
    v_mul_f32 v208, v190, v208
    v_mul_f32 v209, v190, v209
    v_mfma_f32_16x16x32_bf16 v[126:129], a[104:107], v[118:121], v[126:129]
    v_cvt_pk_f16_f32 v207, v208, v209
    v_mul_f32 v174, v190, v174
    v_mfma_f32_16x16x32_bf16 v[126:129], a[108:111], v[134:137], v[126:129]
    v_mul_f32 v175, v190, v175
    v_cvt_pk_f16_f32 v208, v174, v175
    v_mfma_f32_16x16x32_bf16 v[126:129], a[112:115], v[154:157], v[126:129]
    v_mul_f32 v176, v190, v176
    v_mul_f32 v177, v190, v177
    v_mfma_f32_16x16x32_bf16 v[126:129], a[116:119], v[198:201], v[126:129]
    v_cvt_pk_f16_f32 v209, v176, v177
    v_mul_f32 v218, v190, v218
    v_mfma_f32_16x16x32_bf16 v[174:177], a[120:123], v[150:153], 0
    v_mul_f32 v219, v190, v219
    v_cvt_pk_f16_f32 v122, v218, v219
    v_mfma_f32_16x16x32_bf16 v[174:177], a[124:127], v[166:169], v[174:177]
    v_mul_f32 v220, v190, v220
    v_mul_f32 v221, v190, v221
    v_mfma_f32_16x16x32_bf16 v[174:177], a[128:131], v[118:121], v[174:177]
    v_cvt_pk_f16_f32 v123, v220, v221
    v_fma_f32 v162, v202, v202, s32
    v_mfma_f32_16x16x32_bf16 v[174:177], a[132:135], v[134:137], v[174:177]
    v_fmac_f32 v162, v203, v203
    v_fmac_f32 v162, v204, v204
    v_mfma_f32_16x16x32_bf16 v[174:177], a[136:139], v[154:157], v[174:177]
    v_fmac_f32 v162, v205, v205
    v_fmac_f32 v162, v126, v126
    v_mfma_f32_16x16x32_bf16 v[174:177], a[140:143], v[198:201], v[174:177]
    v_fmac_f32 v162, v127, v127
    v_fmac_f32 v162, v128, v128
    v_mfma_f32_16x16x32_bf16 v[190:193], a[0:3], v[150:153], 0
    v_fmac_f32 v162, v129, v129
    v_mul_f32 v149, v255, v149
    v_mfma_f32_16x16x32_bf16 v[190:193], a[4:7], v[166:169], v[190:193]
    v_cvt_pk_bf16_f32 v147, v148, v149
    v_mul_f32 v138, v255, v138
    v_mfma_f32_16x16x32_bf16 v[190:193], a[8:11], v[118:121], v[190:193]
    v_fmac_f32 v162, v174, v174
    v_fmac_f32 v162, v175, v175
    v_mfma_f32_16x16x32_bf16 v[190:193], a[12:15], v[134:137], v[190:193]
    v_fmac_f32 v162, v176, v176
    v_fmac_f32 v162, v177, v177
    v_mfma_f32_16x16x32_bf16 v[190:193], a[16:19], v[154:157], v[190:193]
    v_mul_f32 v139, v255, v139
    v_cvt_pk_bf16_f32 v148, v138, v139
    v_mfma_f32_16x16x32_bf16 v[190:193], a[20:23], v[198:201], v[190:193]
    v_mul_f32 v140, v255, v140
    v_mul_f32 v141, v255, v141
    v_mfma_f32_16x16x32_bf16 v[218:221], a[24:27], v[150:153], 0
    v_cvt_pk_bf16_f32 v149, v140, v141
    v_mul_f32 v186, v255, v186
    v_mfma_f32_16x16x32_bf16 v[218:221], a[28:31], v[166:169], v[218:221]
    buffer_store_dwordx4 v[146:149], v17, s[12:15], 0 offen nt
    v_mul_f32 v187, v255, v187
    v_fma_f32 v163, v190, v190, s32
    v_fmac_f32 v163, v191, v191
    v_fmac_f32 v163, v192, v192
    v_mfma_f32_16x16x32_bf16 v[218:221], a[32:35], v[118:121], v[218:221]
    v_fmac_f32 v163, v193, v193
    v_cvt_pk_bf16_f32 v164, v186, v187
    v_mfma_f32_16x16x32_bf16 v[218:221], a[36:39], v[134:137], v[218:221]
    v_mul_f32 v188, v255, v188
    v_mul_f32 v189, v255, v189
    v_mfma_f32_16x16x32_bf16 v[218:221], a[40:43], v[154:157], v[218:221]
    v_cvt_pk_bf16_f32 v165, v188, v189
    v_mul_f32 v142, v254, v142
    v_mfma_f32_16x16x32_bf16 v[218:221], a[44:47], v[198:201], v[218:221]
    v_mul_f32 v143, v254, v143
    v_cvt_pk_bf16_f32 v142, v142, v143
    v_mfma_f32_16x16x32_bf16 v[138:141], a[48:51], v[150:153], 0
    v_mul_f32 v144, v254, v144
    v_mul_f32 v145, v254, v145
    v_mfma_f32_16x16x32_bf16 v[138:141], a[52:55], v[166:169], v[138:141]
    v_cvt_pk_bf16_f32 v143, v144, v145
    v_mul_f32 v158, v254, v158
    v_mfma_f32_16x16x32_bf16 v[138:141], a[56:59], v[118:121], v[138:141]
    v_fmac_f32 v163, v218, v218
    v_fmac_f32 v163, v219, v219
    v_mfma_f32_16x16x32_bf16 v[138:141], a[60:63], v[134:137], v[138:141]
    ds_read2_b32 v[196:197], v6 offset0:0 offset1:0
    ds_read2_b32 v[216:217], v6 offset0:16 offset1:16
    v_mfma_f32_16x16x32_bf16 v[138:141], a[64:67], v[154:157], v[138:141]
    ds_read2_b32 v[232:233], v6 offset0:32 offset1:32
    v_fmac_f32 v163, v220, v220
    v_mfma_f32_16x16x32_bf16 v[138:141], a[68:71], v[198:201], v[138:141]
    v_fmac_f32 v163, v221, v221
    v_mul_f32 v159, v254, v159
    v_mfma_f32_16x16x32_bf16 v[146:149], v[150:153], a[144:147], 0
    v_cvt_pk_bf16_f32 v144, v158, v159
    v_mul_f32 v160, v254, v160
    v_mfma_f32_16x16x32_bf16 v[146:149], v[166:169], a[148:151], v[146:149]
    v_mul_f32 v161, v254, v161
    v_cvt_pk_bf16_f32 v145, v160, v161
    v_mfma_f32_16x16x32_bf16 v[146:149], v[118:121], a[152:155], v[146:149]
    v_fmac_f32 v163, v138, v138
    v_fmac_f32 v163, v139, v139
    v_mfma_f32_16x16x32_bf16 v[146:149], v[134:137], a[156:159], v[146:149]
    v_fmac_f32 v163, v140, v140
    v_fmac_f32 v163, v141, v141
    v_mfma_f32_16x16x32_bf16 v[146:149], v[154:157], a[160:163], v[146:149]
    v_cvt_pk_bf16_f32 v36, v163, v162
    v_mul_f32 v178, v254, v178
    v_mfma_f32_16x16x32_bf16 v[146:149], v[198:201], a[164:167], v[146:149]
    s_waitcnt lgkmcnt(1)
    v_mul_f32 v179, v254, v179
    v_cvt_pk_bf16_f32 v178, v178, v179
    v_mfma_f32_16x16x32_bf16 v[158:161], v[32:35], v[36:39], 0
    s_waitcnt lgkmcnt(0)
    buffer_store_dwordx2 v[164:165], v20, s[12:15], 0 offen nt
    v_mul_f32 v180, v254, v180
    v_mul_f32 v181, v254, v181
    v_mfma_f32_16x16x32_bf16 v[186:189], v[150:153], a[168:171], 0
    v_cvt_pk_bf16_f32 v194, v146, v147
    v_cvt_pk_bf16_f32 v195, v148, v149
    v_mfma_f32_16x16x32_bf16 v[186:189], v[166:169], a[172:175], v[186:189]
    v_rsq_f32 v159, v159
    v_mfma_f32_16x16x32_bf16 v[186:189], v[118:121], a[176:179], v[186:189]
    v_rsq_f32 v158, v158
    v_mfma_f32_16x16x32_bf16 v[186:189], v[134:137], a[180:183], v[186:189]
    v_mul_f32 v158, s31, v158
    v_mul_f32 v202, v159, v202
    v_mfma_f32_16x16x32_bf16 v[186:189], v[154:157], a[184:187], v[186:189]
    v_mul_f32 v203, v159, v203
    v_cvt_pk_f16_f32 v146, v202, v203
    v_mfma_f32_16x16x32_bf16 v[186:189], v[198:201], a[188:191], v[186:189]
    v_mul_f32 v204, v159, v204
    v_mul_f32 v205, v159, v205
    v_mfma_f32_16x16x32_bf16 v[162:165], v[150:153], a[192:195], 0
    v_cvt_pk_f16_f32 v147, v204, v205
    v_mul_f32 v126, v159, v126
    v_mfma_f32_16x16x32_bf16 v[162:165], v[166:169], a[196:199], v[162:165]
    ds_read_b128 v[150:153], v5 offset:0
    ds_read_b128 v[202:205], v5 offset:16
    v_mfma_f32_16x16x32_bf16 v[162:165], v[118:121], a[200:203], v[162:165]
    ds_read_b128 v[118:121], v5 offset:48
    ds_read_b32 v254, v6 offset:192
    v_mfma_f32_16x16x32_bf16 v[162:165], v[134:137], a[204:207], v[162:165]
    v_cvt_pk_bf16_f32 v214, v186, v187
    v_cvt_pk_bf16_f32 v215, v188, v189
    v_mfma_f32_16x16x32_bf16 v[162:165], v[154:157], a[208:211], v[162:165]
    v_mul_f32 v127, v159, v127
    v_cvt_pk_f16_f32 v148, v126, v127
    v_mfma_f32_16x16x32_bf16 v[162:165], v[198:201], a[212:215], v[162:165]
    ds_read_b128 v[198:201], v2 offset:0
    ds_read_b128 v[186:189], v2 offset:1024
    v_mfma_f32_16x16x32_f16 v[134:137], v[226:229], v[222:225], v[50:53]
    ds_read_b128 v[154:157], v2 offset:2048
    v_mul_f32 v128, v159, v128
    v_mul_f32 v129, v159, v129
    v_mfma_f32_16x16x16_f16 v[210:213], v[184:185], v[182:183], v[210:213]
    v_cvt_pk_f16_f32 v149, v128, v129
    v_cvt_pk_bf16_f32 v230, v162, v163
    v_cvt_pk_bf16_f32 v231, v164, v165
    v_mul_f32 v174, v159, v174
    v_mfma_f32_16x16x32_f16 v[126:129], v[146:149], v[222:225], v[54:57]
    s_waitcnt lgkmcnt(5)
    v_mul_f32 v175, v159, v175
    v_cvt_pk_f16_f32 v164, v174, v175
    v_mul_f32 v176, v159, v176
    v_mfma_f32_16x16x16_f16 v[134:137], v[124:125], v[182:183], v[134:137]
    v_mul_f32 v177, v159, v177
    v_cvt_pk_f16_f32 v165, v176, v177
    v_mul_f32 v190, v158, v190
    v_mul_f32 v191, v158, v191
    v_mfma_f32_16x16x16_f16 v[126:129], v[164:165], v[182:183], v[126:129]
    v_cvt_pk_f16_f32 v174, v190, v191
    v_mul_f32 v192, v158, v192
    v_mul_f32 v193, v158, v193
    v_cvt_pk_f16_f32 v175, v192, v193
    v_mfma_f32_16x16x32_f16 v[166:169], v[150:153], v[222:225], v[22:25]
    s_waitcnt lgkmcnt(2)
    ds_read_b128 v[222:225], v2 offset:3072
    buffer_store_dwordx4 v[142:145], v16, s[12:15], 0 offen nt
    ds_read_b128 v[234:237], v2 offset:4096
    v_mul_f32 v218, v158, v218
    v_mul_f32 v219, v158, v219
    v_cvt_pk_f16_f32 v176, v218, v219
    v_mfma_f32_16x16x32_f16 v[166:169], v[202:205], v[242:245], v[166:169]
    s_waitcnt lgkmcnt(2)
    v_mul_f32 v220, v158, v220
    v_mul_f32 v221, v158, v221
    v_mfma_f32_16x16x32_f16 v[166:169], v[118:121], v[182:185], v[166:169]
    ds_read_b128 v[142:145], v2 offset:5120
    v_cvt_pk_f16_f32 v177, v220, v221
    v_mul_f32 v138, v158, v138
    v_mul_f32 v139, v158, v139
    v_cvt_pk_f16_f32 v162, v138, v139
    v_mfma_f32_16x16x32_f16 v[218:221], v[150:153], v[206:209], v[24:27]
    v_mul_f32 v140, v158, v140
    v_mul_f32 v141, v158, v141
    v_mfma_f32_16x16x32_f16 v[218:221], v[202:205], v[226:229], v[218:221]
    v_mov_b32_dpp v254, v167 quad_perm:[0,1,2,3] row_mask:0x1 bank_mask:0xf
    v_cvt_pk_f16_f32 v163, v140, v141
    v_mfma_f32_16x16x32_f16 v[218:221], v[118:121], v[122:125], v[218:221]
    v_max3_f32 v255, v166, v210, v211
    v_max3_f32 v255, v255, v212, v213
    v_mfma_f32_16x16x32_f16 v[238:241], v[150:153], v[174:177], v[26:29]
    s_waitcnt lgkmcnt(1)
    v_max3_f32 v255, v255, v134, v135
    v_max3_f32 v255, v255, v136, v137
    v_mfma_f32_16x16x32_f16 v[238:241], v[202:205], v[146:149], v[238:241]
    v_max3_f32 v255, v255, v126, v127
    v_mov_b32_dpp v254, v219 quad_perm:[0,1,2,3] row_mask:0x2 bank_mask:0xf
    v_mfma_f32_16x16x32_f16 v[238:241], v[118:121], v[162:165], v[238:241]
    v_max3_f32 v255, v255, v128, v129
    v_mov_b32 v182, v255
    v_mfma_f32_16x16x32_bf16 v[150:153], a[216:219], v[198:201], 0
    s_waitcnt lgkmcnt(0)
    v_permlane32_swap_b32 v255, v182
    v_mfma_f32_16x16x32_bf16 v[150:153], a[220:223], v[186:189], v[150:153]
    v_max_f32 v255, v255, v182
    v_mov_b32 v182, v255
    v_mfma_f32_16x16x32_bf16 v[150:153], a[224:227], v[154:157], v[150:153]
    v_cvt_pk_bf16_f32 v179, v180, v181
    v_xor_b32 v0, 65536, v0
    v_mfma_f32_16x16x32_bf16 v[150:153], a[228:231], v[222:225], v[150:153]
    s_waitcnt vmcnt(5)
    v_permlane16_swap_b32 v255, v182
    v_mfma_f32_16x16x32_bf16 v[150:153], a[232:235], v[234:237], v[150:153]
    s_barrier
    v_max_f32 v255, v255, v182
    v_sub_f32 v210, v210, v255
    v_mfma_f32_16x16x32_bf16 v[150:153], a[236:239], v[142:145], v[150:153]
    s_nop 0
    v_exp_f32 v210, v210
    v_mfma_f32_16x16x32_bf16 v[190:193], a[240:243], v[198:201], 0
    s_nop 0
    v_sub_f32 v211, v211, v255
    v_sub_f32 v212, v212, v255
    v_mfma_f32_16x16x32_bf16 v[190:193], a[244:247], v[186:189], v[190:193]
    s_nop 0
    buffer_load_dwordx4 v10, s[8:11], 0 offen nt lds
    v_sub_f32 v213, v213, v255
    v_mfma_f32_16x16x32_bf16 v[190:193], a[248:251], v[154:157], v[190:193]
    s_add_u32 m0, s28, 4096
    v_exp_f32 v211, v211
    v_mfma_f32_16x16x32_bf16 v[190:193], a[252:255], v[222:225], v[190:193]
    v_cvt_pk_bf16_f32 v158, v210, v211
    v_sub_f32 v134, v134, v255
    v_mfma_f32_16x16x32_bf16 v[190:193], v[82:85], v[234:237], v[190:193]
    v_exp_f32 v212, v212
    v_mfma_f32_16x16x32_bf16 v[190:193], v[86:89], v[142:145], v[190:193]
    v_exp_f32 v213, v213
    v_mfma_f32_16x16x32_bf16 v[202:205], v[90:93], v[198:201], 0
    ds_read_b128 v[198:201], v2 offset:6144
    buffer_load_dwordx4 v11, s[8:11], 0 offen nt lds
    v_mfma_f32_16x16x32_bf16 v[202:205], v[94:97], v[186:189], v[202:205]
    s_add_u32 m0, s28, 8192
    ds_read_b128 v[138:141], v2 offset:7168
    v_cvt_pk_bf16_f32 v159, v212, v213
    v_mfma_f32_16x16x32_bf16 v[202:205], v[98:101], v[154:157], v[202:205]
    ds_read_b128 v[210:213], v2 offset:8192
    v_sub_f32 v135, v135, v255
    v_mfma_f32_16x16x32_bf16 v[202:205], v[102:105], v[222:225], v[202:205]
    ds_read_b128 v[186:189], v2 offset:9216
    v_sub_f32 v136, v136, v255
    v_mfma_f32_16x16x32_bf16 v[202:205], v[106:109], v[234:237], v[202:205]
    ds_read_b128 v[222:225], v2 offset:10240
    v_sub_f32 v137, v137, v255
    v_mfma_f32_16x16x32_bf16 v[202:205], v[110:113], v[142:145], v[202:205]
    ds_read_b128 v[154:157], v2 offset:11264
    buffer_load_dwordx4 v12, s[8:11], 0 offen nt lds
    v_exp_f32 v134, v134
    v_mfma_f32_16x16x32_f16 v[118:121], v[242:245], v[206:209], v[58:61]
    s_add_u32 m0, s28, 12288
    v_exp_f32 v135, v135
    v_exp_f32 v136, v136
    v_cvt_pk_bf16_f32 v160, v134, v135
    v_exp_f32 v137, v137
    v_sub_f32 v126, v126, v255
    v_mfma_f32_16x16x16_f16 v[118:121], v[184:185], v[122:123], v[118:121]
    v_cvt_pk_bf16_f32 v161, v136, v137
    v_exp_f32 v126, v126
    v_sub_f32 v127, v127, v255
    v_mfma_f32_16x16x32_f16 v[134:137], v[226:229], v[206:209], v[62:65]
    s_xor_b32 s28, s28, 65536
    buffer_load_dwordx4 v13, s[8:11], 0 offen nt lds
    v_exp_f32 v127, v127
    v_sub_f32 v128, v128, v255
    v_cvt_pk_bf16_f32 v36, v126, v127
    v_exp_f32 v128, v128
    v_mfma_f32_16x16x16_f16 v[134:137], v[124:125], v[122:123], v[134:137]
    v_sub_f32 v129, v129, v255
    v_exp_f32 v129, v129
    v_sub_f32 v166, v166, v255
    v_cvt_pk_bf16_f32 v37, v128, v129
    v_mfma_f32_16x16x32_f16 v[126:129], v[146:149], v[206:209], v[66:69]
    s_waitcnt lgkmcnt(0)
    v_exp_f32 v166, v166
    v_mfma_f32_16x16x32_bf16 v[142:145], a[216:219], v[198:201], 0
    s_mov_b32 m0, s29
    v_cvt_pk_bf16_f32 v39, v166, 0
    v_max3_f32 v255, v218, v118, v119
    v_max3_f32 v255, v255, v120, v121
    v_mfma_f32_16x16x16_f16 v[126:129], v[164:165], v[122:123], v[126:129]
    v_max3_f32 v255, v255, v134, v135
    v_max3_f32 v255, v255, v136, v137
    v_xor_b32 v1, 65536, v1
    v_mov_b32_dpp v254, v239 quad_perm:[0,1,2,3] row_mask:0x4 bank_mask:0xf
    v_mfma_f32_16x16x32_bf16 v[206:209], v[28:31], v[36:39], 0
    s_xor_b32 s29, s29, s30
    buffer_store_dwordx2 v[178:179], v19, s[12:15], 0 offen nt
    v_mov_b32 v122, v254
    v_max3_f32 v255, v255, v126, v127
    v_mfma_f32_16x16x32_bf16 v[206:209], v[28:31], v[158:161], v[206:209]
    s_add_u32 s19, s19, s20
    v_max3_f32 v255, v255, v128, v129
    v_mov_b32 v123, v255
    v_mfma_f32_16x16x32_bf16 v[142:145], a[220:223], v[138:141], v[142:145]
    s_add_u32 s23, s23, s21
    v_permlane32_swap_b32 v255, v123
    v_mfma_f32_16x16x32_bf16 v[142:145], a[224:227], v[210:213], v[142:145]
    s_cmp_ge_u32 s19, 72
    v_rcp_f32 v206, v206
    v_mfma_f32_16x16x32_bf16 v[142:145], a[228:231], v[186:189], v[142:145]
    s_cselect_b32 s34, 72, 0
    v_max_f32 v255, v255, v123
    v_mov_b32 v123, v255
    v_mfma_f32_16x16x32_bf16 v[142:145], a[232:235], v[222:225], v[142:145]
    s_cselect_b32 s35, s22, 0
    v_permlane16_swap_b32 v255, v123
    v_mfma_f32_16x16x32_bf16 v[142:145], a[236:239], v[154:157], v[142:145]
    s_sub_u32 s19, s19, s34
    v_max_f32 v255, v255, v123
    v_sub_f32 v118, v118, v255
    v_mfma_f32_16x16x32_bf16 v[178:181], v[194:197], v[36:39], 0
    s_add_u32 s23, s23, s35
    v_exp_f32 v118, v118
    v_mfma_f32_16x16x32_bf16 v[178:181], v[170:173], v[158:161], v[178:181]
    s_add_u32 s18, s18, 1
    v_sub_f32 v119, v119, v255
    v_exp_f32 v119, v119
    v_sub_f32 v120, v120, v255
    v_cvt_pk_bf16_f32 v118, v118, v119
    v_exp_f32 v120, v120
    v_sub_f32 v121, v121, v255
    v_exp_f32 v121, v121
    v_mul_f32 v178, v206, v178
    v_mul_f32 v179, v206, v179
    v_cvt_pk_bf16_f32 v178, v178, v179
    v_mul_f32 v180, v206, v180
    v_mul_f32 v181, v206, v181
    v_cvt_pk_bf16_f32 v179, v180, v181
    v_cvt_pk_bf16_f32 v119, v120, v121
    v_mfma_f32_16x16x32_bf16 v[166:169], v[214:217], v[36:39], 0
    s_cmp_lt_u32 s18, s17
    v_sub_f32 v134, v134, v255
    v_sub_f32 v135, v135, v255
    v_mfma_f32_16x16x32_bf16 v[166:169], v[130:133], v[158:161], v[166:169]
    v_exp_f32 v134, v134
    v_exp_f32 v135, v135
    v_sub_f32 v136, v136, v255
    v_cvt_pk_bf16_f32 v120, v134, v135
    v_exp_f32 v136, v136
    v_sub_f32 v137, v137, v255
    v_exp_f32 v137, v137
    v_sub_f32 v126, v126, v255
    v_mul_f32 v166, v206, v166
    v_mul_f32 v167, v206, v167
    v_cvt_pk_bf16_f32 v180, v166, v167
    v_mul_f32 v168, v206, v168
    v_mul_f32 v169, v206, v169
    v_cvt_pk_bf16_f32 v181, v168, v169
    v_cvt_pk_bf16_f32 v121, v136, v137
    v_mfma_f32_16x16x32_bf16 v[134:137], v[230:233], v[36:39], 0
    buffer_load_dwordx4 v14, s[8:11], 0 offen nt lds
    v_sub_f32 v127, v127, v255
    v_mfma_f32_16x16x32_bf16 v[134:137], v[114:117], v[158:161], v[134:137]
    ds_write_b128 v3, v[178:181] offset:0
    v_mfma_f32_16x16x32_bf16 v[158:161], a[240:243], v[198:201], 0
    v_exp_f32 v126, v126
    v_mfma_f32_16x16x32_bf16 v[158:161], a[244:247], v[138:141], v[158:161]
    v_exp_f32 v127, v127
    v_mfma_f32_16x16x32_bf16 v[158:161], a[248:251], v[210:213], v[158:161]
    v_cvt_pk_bf16_f32 v36, v126, v127
    v_sub_f32 v128, v128, v255
    v_mfma_f32_16x16x32_bf16 v[158:161], a[252:255], v[186:189], v[158:161]
    v_mul_f32 v134, v206, v134
    v_mul_f32 v135, v206, v135
    v_mfma_f32_16x16x32_bf16 v[158:161], v[82:85], v[222:225], v[158:161]
    v_cvt_pk_bf16_f32 v126, v134, v135
    v_mul_f32 v136, v206, v136
    v_mfma_f32_16x16x32_bf16 v[158:161], v[86:89], v[154:157], v[158:161]
    v_mul_f32 v137, v206, v137
    v_cvt_pk_bf16_f32 v127, v136, v137
    v_mfma_f32_16x16x32_bf16 v[178:181], v[90:93], v[198:201], 0
    ds_read_b128 v[198:201], v2 offset:12288
    v_sub_f32 v129, v129, v255
    v_mfma_f32_16x16x32_bf16 v[178:181], v[94:97], v[138:141], v[178:181]
    ds_read_b128 v[206:209], v2 offset:13312
    v_sub_f32 v218, v218, v255
    v_mfma_f32_16x16x32_bf16 v[178:181], v[98:101], v[210:213], v[178:181]
    ds_read_b128 v[210:213], v2 offset:14336
    v_max_f32_dpp v122, v122, v122 quad_perm:[1,0,3,2] row_mask:0xf bank_mask:0xf
    v_mfma_f32_16x16x32_bf16 v[178:181], v[102:105], v[186:189], v[178:181]
    ds_read_b128 v[134:137], v2 offset:15360
    v_max_f32_dpp v122, v122, v122 quad_perm:[2,3,0,1] row_mask:0xf bank_mask:0xf
    v_mfma_f32_16x16x32_bf16 v[178:181], v[106:109], v[222:225], v[178:181]
    ds_read_b128 v[222:225], v2 offset:16384
    v_max_f32_dpp v122, v122, v122 row_half_mirror row_mask:0xf bank_mask:0xf
    v_mfma_f32_16x16x32_bf16 v[178:181], v[110:113], v[154:157], v[178:181]
    ds_read_b128 v[154:157], v2 offset:17408
    ds_write_b64 v4, v[126:127] offset:4096
    v_exp_f32 v128, v128
    v_exp_f32 v129, v129
    v_mfma_f32_16x16x32_f16 v[186:189], v[242:245], v[174:177], v[70:73]
    s_waitcnt lgkmcnt(6)
    v_cvt_pk_bf16_f32 v37, v128, v129
    v_max_f32_dpp v122, v122, v122 row_mirror row_mask:0xf bank_mask:0xf
    v_mfma_f32_16x16x32_f16 v[242:245], v[226:229], v[174:177], v[74:77]
    s_waitcnt lgkmcnt(5)
    v_exp_f32 v218, v218
    v_mfma_f32_16x16x32_f16 v[126:129], v[146:149], v[174:177], v[78:81]
    s_waitcnt lgkmcnt(4)
    v_cvt_pk_bf16_f32 v39, v218, 0
    v_mov_b32 v123, v122
    v_fma_f32 v255, v150, v150, s33
    v_mfma_f32_16x16x32_bf16 v[174:177], v[28:31], v[36:39], 0
    s_waitcnt lgkmcnt(3)
    v_permlane32_swap_b32 v122, v123
    v_mfma_f32_16x16x32_bf16 v[174:177], v[28:31], v[118:121], v[174:177]
    s_waitcnt lgkmcnt(2)
    v_max_f32 v122, v122, v123
    v_mov_b32 v123, v122
    v_mfma_f32_16x16x32_bf16 v[226:229], v[194:197], v[36:39], 0
    s_waitcnt lgkmcnt(0)
    v_permlane16_swap_b32 v122, v123
    v_mfma_f32_16x16x32_bf16 v[226:229], v[170:173], v[118:121], v[226:229]
    v_max_f32 v122, v122, v123
    v_sub_f32 v254, v254, v122
    v_mfma_f32_16x16x32_bf16 v[218:221], v[214:217], v[36:39], 0
    v_exp_f32 v254, v254
    v_mfma_f32_16x16x32_bf16 v[218:221], v[130:133], v[118:121], v[218:221]
    v_cvt_pk_bf16_f32 v254, v254, v254
    v_fmac_f32 v255, v151, v151
    v_mfma_f32_16x16x32_bf16 v[166:169], v[230:233], v[36:39], 0
    ds_write_b16 v8, v254
    v_mfma_f32_16x16x32_bf16 v[166:169], v[114:117], v[118:121], v[166:169]
    v_rcp_f32 v174, v174
    v_fmac_f32 v255, v152, v152
    v_mfma_f32_16x16x16_f16 v[186:189], v[184:185], v[162:163], v[186:189]
    v_mul_f32 v226, v174, v226
    v_mul_f32 v227, v174, v227
    v_cvt_pk_bf16_f32 v122, v226, v227
    v_mfma_f32_16x16x16_f16 v[242:245], v[124:125], v[162:163], v[242:245]
    v_mul_f32 v228, v174, v228
    v_mul_f32 v229, v174, v229
    v_cvt_pk_bf16_f32 v123, v228, v229
    v_mfma_f32_16x16x16_f16 v[126:129], v[164:165], v[162:163], v[126:129]
    v_max3_f32 v254, v238, v186, v187
    v_max3_f32 v254, v254, v188, v189
    v_mul_f32 v218, v174, v218
    v_mul_f32 v219, v174, v219
    v_mfma_f32_16x16x32_bf16 v[146:149], a[216:219], v[198:201], 0
    ds_read_b128 v[118:121], v9
    ds_read_b128 v[162:165], v9 offset:64
    v_mfma_f32_16x16x32_bf16 v[146:149], a[220:223], v[206:209], v[146:149]
    v_max3_f32 v254, v254, v242, v243
    v_max3_f32 v254, v254, v244, v245
    v_mfma_f32_16x16x32_bf16 v[146:149], a[224:227], v[210:213], v[146:149]
    v_max3_f32 v254, v254, v126, v127
    v_max3_f32 v254, v254, v128, v129
    v_mfma_f32_16x16x32_bf16 v[146:149], a[228:231], v[134:137], v[146:149]
    v_mov_b32 v125, v254
    v_cvt_pk_bf16_f32 v124, v218, v219
    v_mfma_f32_16x16x32_bf16 v[146:149], a[232:235], v[222:225], v[146:149]
    v_permlane32_swap_b32 v254, v125
    v_mfma_f32_16x16x32_bf16 v[146:149], a[236:239], v[154:157], v[146:149]
    v_max_f32 v254, v254, v125
    v_mov_b32 v125, v254
    v_mfma_f32_16x16x32_bf16 v[138:141], a[240:243], v[198:201], 0
    v_mul_f32 v220, v174, v220
    v_mul_f32 v221, v174, v221
    v_mfma_f32_16x16x32_bf16 v[138:141], a[244:247], v[206:209], v[138:141]
    v_permlane16_swap_b32 v254, v125
    v_mfma_f32_16x16x32_bf16 v[138:141], a[248:251], v[210:213], v[138:141]
    s_waitcnt lgkmcnt(0)
    v_max_f32 v254, v254, v125
    v_sub_f32 v186, v186, v254
    v_mfma_f32_16x16x32_bf16 v[138:141], a[252:255], v[134:137], v[138:141]
    v_exp_f32 v186, v186
    v_mfma_f32_16x16x32_bf16 v[138:141], v[82:85], v[222:225], v[138:141]
    v_sub_f32 v187, v187, v254
    v_sub_f32 v188, v188, v254
    v_mfma_f32_16x16x32_bf16 v[138:141], v[86:89], v[154:157], v[138:141]
    v_exp_f32 v187, v187
    v_exp_f32 v188, v188
    v_cvt_pk_bf16_f32 v234, v186, v187
    v_sub_f32 v189, v189, v254
    v_exp_f32 v189, v189
    v_sub_f32 v242, v242, v254
    v_cvt_pk_bf16_f32 v235, v188, v189
    v_exp_f32 v242, v242
    v_sub_f32 v243, v243, v254
    v_exp_f32 v243, v243
    v_sub_f32 v244, v244, v254
    v_cvt_pk_bf16_f32 v236, v242, v243
    v_mfma_f32_16x16x32_bf16 v[186:189], v[90:93], v[198:201], 0
    v_exp_f32 v244, v244
    v_mfma_f32_16x16x32_bf16 v[186:189], v[94:97], v[206:209], v[186:189]
    v_sub_f32 v245, v245, v254
    v_sub_f32 v126, v126, v254
    v_mfma_f32_16x16x32_bf16 v[186:189], v[98:101], v[210:213], v[186:189]
    v_exp_f32 v245, v245
    v_mfma_f32_16x16x32_bf16 v[186:189], v[102:105], v[134:137], v[186:189]
    v_cvt_pk_bf16_f32 v237, v244, v245
    v_sub_f32 v127, v127, v254
    v_mfma_f32_16x16x32_bf16 v[186:189], v[106:109], v[222:225], v[186:189]
    v_exp_f32 v126, v126
    v_mfma_f32_16x16x32_bf16 v[186:189], v[110:113], v[154:157], v[186:189]
    ds_read_b128 v[182:185], v0 offset:20480
    ds_read_b128 v[198:201], v1 offset:20480
    v_mfma_f32_16x16x32_bf16 v[206:209], v[118:121], v[28:31], 0
    ds_read_b128 v[210:213], v0 offset:20608
    ds_read_b128 v[222:225], v1 offset:20608
    v_mfma_f32_16x16x32_bf16 v[206:209], v[162:165], v[28:31], v[206:209]
    v_exp_f32 v127, v127
    v_mfma_f32_16x16x32_bf16 v[154:157], v[118:121], v[170:173], 0
    ds_read_b128 v[226:229], v0 offset:20736
    v_cvt_pk_bf16_f32 v36, v126, v127
    v_mfma_f32_16x16x32_bf16 v[154:157], v[162:165], v[194:197], v[154:157]
    ds_read_b128 v[242:245], v1 offset:20736
    v_sub_f32 v128, v128, v254
    v_exp_f32 v128, v128
    v_sub_f32 v129, v129, v254
    v_exp_f32 v129, v129
    v_sub_f32 v238, v238, v254
    v_cvt_pk_bf16_f32 v37, v128, v129
    v_mfma_f32_16x16x32_bf16 v[134:137], v[118:121], v[130:133], 0
    v_exp_f32 v238, v238
    v_mfma_f32_16x16x32_bf16 v[134:137], v[162:165], v[214:217], v[134:137]
    s_waitcnt lgkmcnt(4)
    v_cvt_pk_bf16_f32 v39, v238, 0
    v_cvt_pk_bf16_f32 v125, v220, v221
    v_mfma_f32_16x16x32_bf16 v[218:221], v[118:121], v[114:117], 0
    s_waitcnt lgkmcnt(2)
    ds_write_b128 v3, v[122:125] offset:6144
    v_mfma_f32_16x16x32_bf16 v[126:129], v[28:31], v[36:39], 0
    s_waitcnt lgkmcnt(2)
    v_mul_f32 v166, v174, v166
    v_mul_f32 v167, v174, v167
    v_mfma_f32_16x16x32_bf16 v[126:129], v[28:31], v[234:237], v[126:129]
    s_waitcnt lgkmcnt(1)
    v_cvt_pk_bf16_f32 v166, v166, v167
    v_mul_f32 v168, v174, v168
    v_mfma_f32_16x16x32_bf16 v[122:125], v[194:197], v[36:39], 0
    v_mul_f32 v169, v174, v169
    v_cvt_pk_bf16_f32 v167, v168, v169
    v_mfma_f32_16x16x32_bf16 v[122:125], v[170:173], v[234:237], v[122:125]
    ds_write_b64 v4, v[166:167] offset:10240
    v_mfma_f32_16x16x32_bf16 v[170:173], v[214:217], v[36:39], 0
    v_rcp_f32 v126, v126
    v_mfma_f32_16x16x32_bf16 v[170:173], v[130:133], v[234:237], v[170:173]
    v_fma_f32 v254, v146, v146, s33
    v_fmac_f32 v254, v147, v147
    v_mfma_f32_16x16x32_bf16 v[174:177], v[230:233], v[36:39], 0
    v_fmac_f32 v254, v148, v148
    v_mul_f32 v122, v126, v122
    v_mfma_f32_16x16x32_bf16 v[174:177], v[114:117], v[234:237], v[174:177]
    v_mul_f32 v123, v126, v123
    v_cvt_pk_bf16_f32 v122, v122, v123
    v_mfma_f32_16x16x32_bf16 v[218:221], v[162:165], v[230:233], v[218:221]
    v_mul_f32 v124, v126, v124
    v_mul_f32 v125, v126, v125
    v_mfma_f32_16x16x32_bf16 v[114:117], a[72:75], v[182:185], 0
    v_cvt_pk_bf16_f32 v123, v124, v125
    v_mul_f32 v170, v126, v170
    v_mfma_f32_16x16x32_bf16 v[114:117], a[76:79], v[198:201], v[114:117]
    v_mul_f32 v171, v126, v171
    v_cvt_pk_bf16_f32 v124, v170, v171
    v_mfma_f32_16x16x32_bf16 v[114:117], a[80:83], v[210:213], v[114:117]
    v_mul_f32 v172, v126, v172
    v_mul_f32 v173, v126, v173
    v_mfma_f32_16x16x32_bf16 v[114:117], a[84:87], v[222:225], v[114:117]
    v_cvt_pk_bf16_f32 v125, v172, v173
    v_mul_f32 v174, v126, v174
    v_mfma_f32_16x16x32_bf16 v[114:117], a[88:91], v[226:229], v[114:117]
    ds_write_b128 v3, v[122:125] offset:12288
    v_mfma_f32_16x16x32_bf16 v[114:117], a[92:95], v[242:245], v[114:117]
    v_mul_f32 v175, v126, v175
    v_cvt_pk_bf16_f32 v174, v174, v175
    v_mfma_f32_16x16x32_bf16 v[122:125], a[96:99], v[182:185], 0
    v_mul_f32 v176, v126, v176
    v_mul_f32 v177, v126, v177
    v_mfma_f32_16x16x32_bf16 v[122:125], a[100:103], v[198:201], v[122:125]
    v_cvt_pk_bf16_f32 v175, v176, v177
    v_fmac_f32 v254, v149, v149
    v_mfma_f32_16x16x32_bf16 v[122:125], a[104:107], v[210:213], v[122:125]
    ds_write_b64 v4, v[174:175] offset:16384
    v_mfma_f32_16x16x32_bf16 v[122:125], a[108:111], v[222:225], v[122:125]
    v_fmac_f32 v254, v138, v138
    v_fmac_f32 v254, v139, v139
    v_mfma_f32_16x16x32_bf16 v[122:125], a[112:115], v[226:229], v[122:125]
    v_fmac_f32 v254, v140, v140
    v_fmac_f32 v254, v141, v141
    v_mfma_f32_16x16x32_bf16 v[122:125], a[116:119], v[242:245], v[122:125]
    v_fmac_f32 v254, v186, v186
    v_fmac_f32 v254, v187, v187
    v_mfma_f32_16x16x32_bf16 v[126:129], a[120:123], v[182:185], 0
    v_fmac_f32 v254, v188, v188
    v_fmac_f32 v254, v189, v189
    v_mfma_f32_16x16x32_bf16 v[126:129], a[124:127], v[198:201], v[126:129]
    v_cvt_pk_bf16_f32 v155, v254, v254
    v_fmac_f32 v255, v153, v153
    v_mfma_f32_16x16x32_bf16 v[126:129], a[128:131], v[210:213], v[126:129]
    v_rcp_f32 v206, v206
    v_mfma_f32_16x16x32_bf16 v[126:129], a[132:135], v[222:225], v[126:129]
    v_mul_f32 v154, v154, v206
    v_mul_f32_dpp v154, v134, v206 quad_perm:[0,1,2,3] row_mask:0x2 bank_mask:0xf
    v_mfma_f32_16x16x32_bf16 v[126:129], a[136:139], v[226:229], v[126:129]
    v_mul_f32_dpp v154, v218, v206 quad_perm:[0,1,2,3] row_mask:0x4 bank_mask:0xf
    v_cvt_pk_bf16_f32 v154, v154, v154
    v_mfma_f32_16x16x32_bf16 v[126:129], a[140:143], v[242:245], v[126:129]
    ds_write_b16 v7, v154
    v_mfma_f32_16x16x32_bf16 v[206:209], a[0:3], v[182:185], 0
    v_fmac_f32 v255, v190, v190
    v_fmac_f32 v255, v191, v191
    v_mfma_f32_16x16x32_bf16 v[206:209], a[4:7], v[198:201], v[206:209]
    v_fmac_f32 v255, v192, v192
    v_fmac_f32 v255, v193, v193
    v_mfma_f32_16x16x32_bf16 v[206:209], a[8:11], v[210:213], v[206:209]
    v_fmac_f32 v255, v202, v202
    v_fmac_f32 v255, v203, v203
    v_mfma_f32_16x16x32_bf16 v[206:209], a[12:15], v[222:225], v[206:209]
    v_fmac_f32 v255, v204, v204
    v_fmac_f32 v255, v205, v205
    v_mfma_f32_16x16x32_bf16 v[206:209], a[16:19], v[226:229], v[206:209]
    v_fma_f32 v254, v142, v142, s33
    v_fmac_f32 v254, v143, v143
    v_mfma_f32_16x16x32_bf16 v[206:209], a[20:23], v[242:245], v[206:209]
    v_fmac_f32 v254, v144, v144
    v_fmac_f32 v254, v145, v145
    v_mfma_f32_16x16x32_bf16 v[174:177], a[24:27], v[182:185], 0
    v_fmac_f32 v254, v158, v158
    v_fmac_f32 v254, v159, v159
    v_mfma_f32_16x16x32_bf16 v[174:177], a[28:31], v[198:201], v[174:177]
    v_fmac_f32 v254, v160, v160
    v_fmac_f32 v254, v161, v161
    v_mfma_f32_16x16x32_bf16 v[174:177], a[32:35], v[210:213], v[174:177]
    v_fmac_f32 v254, v178, v178
    v_fmac_f32 v254, v179, v179
    v_mfma_f32_16x16x32_bf16 v[174:177], a[36:39], v[222:225], v[174:177]
    v_fmac_f32 v254, v180, v180
    v_fmac_f32 v254, v181, v181
    v_mfma_f32_16x16x32_bf16 v[174:177], a[40:43], v[226:229], v[174:177]
    v_cvt_pk_bf16_f32 v154, v255, v254
    v_add_u32 v5, 336, v5
    v_mfma_f32_16x16x32_bf16 v[174:177], a[44:47], v[242:245], v[174:177]
    ds_write_b64 v4, v[154:155] offset:18432
    v_mfma_f32_16x16x32_bf16 v[218:221], a[48:51], v[182:185], 0
    v_add_u32 v6, 272, v6
    v_add_u32 v7, 16, v7
    v_mfma_f32_16x16x32_bf16 v[218:221], a[52:55], v[198:201], v[218:221]
    v_fma_f32 v130, v114, v114, s32
    v_fmac_f32 v130, v115, v115
    v_mfma_f32_16x16x32_bf16 v[218:221], a[56:59], v[210:213], v[218:221]
    v_fmac_f32 v130, v116, v116
    v_fmac_f32 v130, v117, v117
    v_mfma_f32_16x16x32_bf16 v[218:221], a[60:63], v[222:225], v[218:221]
    v_fmac_f32 v130, v122, v122
    v_fmac_f32 v130, v123, v123
    v_mfma_f32_16x16x32_bf16 v[218:221], a[64:67], v[226:229], v[218:221]
    v_fmac_f32 v130, v124, v124
    v_fmac_f32 v130, v125, v125
    v_mfma_f32_16x16x32_bf16 v[218:221], a[68:71], v[242:245], v[218:221]
    v_fmac_f32 v130, v126, v126
    v_fmac_f32 v130, v127, v127
    v_mfma_f32_16x16x32_bf16 v[170:173], v[182:185], a[144:147], 0
    s_waitcnt lgkmcnt(0)
    v_fmac_f32 v130, v128, v128
    v_fmac_f32 v130, v129, v129
    v_mfma_f32_16x16x32_bf16 v[170:173], v[198:201], a[148:151], v[170:173]
    s_barrier
    v_fma_f32 v131, v206, v206, s32
    v_fmac_f32 v131, v207, v207
    v_mfma_f32_16x16x32_bf16 v[170:173], v[210:213], a[152:155], v[170:173]
    s_nop 0
    v_fmac_f32 v131, v208, v208
    v_fmac_f32 v131, v209, v209
    v_mfma_f32_16x16x32_bf16 v[170:173], v[222:225], a[156:159], v[170:173]
    s_nop 0
    v_fmac_f32 v131, v174, v174
    v_xor_b32 v2, 65536, v2
    v_mfma_f32_16x16x32_bf16 v[170:173], v[226:229], a[160:163], v[170:173]
    s_nop 0
    v_xor_b32 v3, 65536, v3
    v_xor_b32 v4, 65536, v4
    v_mfma_f32_16x16x32_bf16 v[170:173], v[242:245], a[164:167], v[170:173]
    s_cbranch_scc1 L_loop_safe0
    s_branch L_drain
.p2align 6
L_loop_safe1:
    v_mfma_f32_16x16x32_bf16 v[162:165], v[182:185], a[168:171], 0
    s_add_u32 s12, s42, s27
    ds_read_b128 v[194:197], v2 offset:18432
    ds_read_b128 v[230:233], v2 offset:19456
    v_mfma_f32_16x16x32_bf16 v[162:165], v[198:201], a[172:175], v[162:165]
    s_addc_u32 s13, s43, 0
    v_fmac_f32 v131, v175, v175
    v_fmac_f32 v131, v176, v176
    v_mfma_f32_16x16x32_bf16 v[162:165], v[210:213], a[176:179], v[162:165]
    s_sub_u32 s14, s36, s27
    v_fmac_f32 v131, v177, v177
    v_fmac_f32 v131, v218, v218
    v_mfma_f32_16x16x32_bf16 v[162:165], v[222:225], a[180:183], v[162:165]
    s_cmp_ge_u32 s18, 2
    v_fmac_f32 v131, v219, v219
    v_fmac_f32 v131, v220, v220
    v_mfma_f32_16x16x32_bf16 v[162:165], v[226:229], a[184:187], v[162:165]
    s_cselect_b32 s14, s14, 0
    ds_read_b128 v[118:121], v0 offset:26624
    v_fmac_f32 v131, v221, v221
    v_mfma_f32_16x16x32_bf16 v[162:165], v[242:245], a[188:191], v[162:165]
    s_add_u32 s34, s18, 2
    ds_read_b128 v[134:137], v1 offset:26624
    v_cvt_pk_bf16_f32 v36, v131, v130
    v_mfma_f32_16x16x32_bf16 v[214:217], v[182:185], a[192:195], 0
    s_add_u32 s8, s40, s23
    ds_read_b128 v[154:157], v0 offset:26752
    v_cvt_pk_bf16_f32 v170, v170, v171
    v_mfma_f32_16x16x32_bf16 v[214:217], v[198:201], a[196:199], v[214:217]
    s_addc_u32 s9, s41, 0
    ds_read_b128 v[198:201], v1 offset:26752
    v_cvt_pk_bf16_f32 v171, v172, v173
    v_mfma_f32_16x16x32_bf16 v[166:169], v[32:35], v[36:39], 0
    s_sub_u32 s10, s36, s23
    v_cvt_pk_bf16_f32 v130, v162, v163
    v_cvt_pk_bf16_f32 v131, v164, v165
    v_mfma_f32_16x16x32_bf16 v[214:217], v[210:213], a[200:203], v[214:217]
    s_waitcnt lgkmcnt(4)
    ds_read_b128 v[210:213], v0 offset:26880
    s_cmp_lt_u32 s34, s17
    v_mfma_f32_16x16x32_bf16 v[234:237], v[32:35], v[194:197], 0
    s_cselect_b32 s10, s10, 0
    v_rsq_f32 v167, v167
    v_mfma_f32_16x16x32_bf16 v[234:237], v[32:35], v[230:233], v[234:237]
    s_add_u32 m0, s28, 0
    v_rsq_f32 v166, v166
    v_mfma_f32_16x16x32_bf16 v[214:217], v[222:225], a[204:207], v[214:217]
    s_waitcnt lgkmcnt(4)
    ds_read_b128 v[162:165], v1 offset:26880
    v_mul_f32 v166, s31, v166
    v_mfma_f32_16x16x32_bf16 v[214:217], v[226:229], a[208:211], v[214:217]
    s_mov_b32 s27, s26
    v_mul_f32 v114, v167, v114
    v_mul_f32 v115, v167, v115
    v_mfma_f32_16x16x32_bf16 v[214:217], v[242:245], a[212:215], v[214:217]
    s_mov_b32 s26, s25
    v_cvt_pk_f16_f32 v242, v114, v115
    v_mul_f32 v116, v167, v116
    v_mfma_f32_16x16x32_bf16 v[226:229], a[72:75], v[118:121], 0
    s_waitcnt lgkmcnt(2)
    v_mul_f32 v117, v167, v117
    v_cvt_pk_f16_f32 v243, v116, v117
    v_mfma_f32_16x16x32_bf16 v[226:229], a[76:79], v[134:137], v[226:229]
    s_mov_b32 s25, s24
    v_cvt_pk_bf16_f32 v114, v214, v215
    v_cvt_pk_bf16_f32 v115, v216, v217
    v_mfma_f32_16x16x32_bf16 v[226:229], a[80:83], v[154:157], v[226:229]
    s_mov_b32 s24, s23
    v_mul_f32 v122, v167, v122
    v_mul_f32 v123, v167, v123
    v_mfma_f32_16x16x32_bf16 v[226:229], a[84:87], v[198:201], v[226:229]
    s_waitcnt lgkmcnt(1)
    v_cvt_pk_f16_f32 v244, v122, v123
    v_mul_f32 v124, v167, v124
    v_mfma_f32_16x16x32_bf16 v[226:229], a[88:91], v[210:213], v[226:229]
    v_mul_f32 v125, v167, v125
    v_cvt_pk_f16_f32 v245, v124, v125
    v_mfma_f32_16x16x32_bf16 v[122:125], a[96:99], v[118:121], 0
    s_waitcnt lgkmcnt(0)
    v_mul_f32 v126, v167, v126
    v_mul_f32 v127, v167, v127
    v_mfma_f32_16x16x32_bf16 v[226:229], a[92:95], v[162:165], v[226:229]
    v_cvt_pk_f16_f32 v184, v126, v127
    v_mul_f32 v128, v167, v128
    v_mfma_f32_16x16x32_bf16 v[122:125], a[100:103], v[134:137], v[122:125]
    v_mul_f32 v129, v167, v129
    v_cvt_pk_f16_f32 v185, v128, v129
    v_mfma_f32_16x16x32_bf16 v[122:125], a[104:107], v[154:157], v[122:125]
    v_mul_f32 v206, v166, v206
    v_mul_f32 v207, v166, v207
    v_mfma_f32_16x16x32_bf16 v[122:125], a[108:111], v[198:201], v[122:125]
    v_cvt_pk_f16_f32 v222, v206, v207
    v_mul_f32 v208, v166, v208
    v_mfma_f32_16x16x32_bf16 v[122:125], a[112:115], v[210:213], v[122:125]
    v_mul_f32 v209, v166, v209
    v_cvt_pk_f16_f32 v223, v208, v209
    v_mfma_f32_16x16x32_bf16 v[122:125], a[116:119], v[162:165], v[122:125]
    v_mul_f32 v174, v166, v174
    v_mul_f32 v175, v166, v175
    v_mfma_f32_16x16x32_bf16 v[126:129], a[120:123], v[118:121], 0
    v_cvt_pk_f16_f32 v224, v174, v175
    v_mul_f32 v176, v166, v176
    v_mfma_f32_16x16x32_bf16 v[126:129], a[124:127], v[134:137], v[126:129]
    v_mul_f32 v177, v166, v177
    v_cvt_pk_f16_f32 v225, v176, v177
    v_mfma_f32_16x16x32_bf16 v[126:129], a[128:131], v[154:157], v[126:129]
    v_mul_f32 v218, v166, v218
    v_mul_f32 v219, v166, v219
    v_mfma_f32_16x16x32_bf16 v[126:129], a[132:135], v[198:201], v[126:129]
    v_cvt_pk_f16_f32 v182, v218, v219
    v_mul_f32 v220, v166, v220
    v_mfma_f32_16x16x32_bf16 v[126:129], a[136:139], v[210:213], v[126:129]
    v_mul_f32 v221, v166, v221
    v_cvt_pk_f16_f32 v183, v220, v221
    v_mfma_f32_16x16x32_bf16 v[126:129], a[140:143], v[162:165], v[126:129]
    v_fma_f32 v116, v226, v226, s32
    v_fmac_f32 v116, v227, v227
    v_mfma_f32_16x16x32_bf16 v[206:209], a[0:3], v[118:121], 0
    v_fmac_f32 v116, v228, v228
    v_fmac_f32 v116, v229, v229
    v_mfma_f32_16x16x32_bf16 v[206:209], a[4:7], v[134:137], v[206:209]
    v_fmac_f32 v116, v122, v122
    v_fmac_f32 v116, v123, v123
    v_mfma_f32_16x16x32_bf16 v[206:209], a[8:11], v[154:157], v[206:209]
    v_fmac_f32 v116, v124, v124
    v_fmac_f32 v116, v125, v125
    v_mfma_f32_16x16x32_bf16 v[206:209], a[12:15], v[198:201], v[206:209]
    v_fmac_f32 v116, v126, v126
    v_fmac_f32 v116, v127, v127
    v_mfma_f32_16x16x32_bf16 v[206:209], a[16:19], v[210:213], v[206:209]
    v_fmac_f32 v116, v128, v128
    v_fmac_f32 v116, v129, v129
    v_mfma_f32_16x16x32_bf16 v[206:209], a[20:23], v[162:165], v[206:209]
    v_mul_f32 v117, 0x3baaaaab, v234
    v_mul_f32 v254, 0x3baaaaab, v235
    v_mfma_f32_16x16x32_bf16 v[174:177], a[24:27], v[118:121], 0
    v_rsq_f32 v117, v117
    v_mfma_f32_16x16x32_bf16 v[174:177], a[28:31], v[134:137], v[174:177]
    v_rsq_f32 v254, v254
    v_mfma_f32_16x16x32_bf16 v[174:177], a[32:35], v[154:157], v[174:177]
    v_mul_f32 v255, 0x3baaaaab, v236
    v_fma_f32 v132, v206, v206, s32
    v_mfma_f32_16x16x32_bf16 v[174:177], a[36:39], v[198:201], v[174:177]
    v_fmac_f32 v132, v207, v207
    v_fmac_f32 v132, v208, v208
    v_mfma_f32_16x16x32_bf16 v[174:177], a[40:43], v[210:213], v[174:177]
    v_fmac_f32 v132, v209, v209
    v_mul_f32 v150, v117, v150
    v_mfma_f32_16x16x32_bf16 v[174:177], a[44:47], v[162:165], v[174:177]
    v_rsq_f32 v255, v255
    v_mfma_f32_16x16x32_bf16 v[218:221], a[48:51], v[118:121], 0
    v_mul_f32 v151, v117, v151
    v_cvt_pk_bf16_f32 v194, v150, v151
    v_mfma_f32_16x16x32_bf16 v[218:221], a[52:55], v[134:137], v[218:221]
    v_mul_f32 v152, v117, v152
    v_mul_f32 v153, v117, v153
    v_mfma_f32_16x16x32_bf16 v[218:221], a[56:59], v[154:157], v[218:221]
    v_fmac_f32 v132, v174, v174
    v_fmac_f32 v132, v175, v175
    v_mfma_f32_16x16x32_bf16 v[218:221], a[60:63], v[198:201], v[218:221]
    v_fmac_f32 v132, v176, v176
    v_fmac_f32 v132, v177, v177
    v_mfma_f32_16x16x32_bf16 v[218:221], a[64:67], v[210:213], v[218:221]
    v_cvt_pk_bf16_f32 v195, v152, v153
    v_mul_f32 v190, v117, v190
    v_mfma_f32_16x16x32_bf16 v[218:221], a[68:71], v[162:165], v[218:221]
    v_mul_f32 v191, v117, v191
    v_cvt_pk_bf16_f32 v196, v190, v191
    v_mfma_f32_16x16x32_bf16 v[150:153], v[118:121], a[144:147], 0
    v_mul_f32 v192, v117, v192
    v_mul_f32 v193, v117, v193
    v_mfma_f32_16x16x32_bf16 v[150:153], v[134:137], a[148:151], v[150:153]
    v_cvt_pk_bf16_f32 v197, v192, v193
    v_mul_f32 v202, v117, v202
    v_mfma_f32_16x16x32_bf16 v[150:153], v[154:157], a[152:155], v[150:153]
    buffer_store_dwordx4 v[194:197], v15, s[12:15], 0 offen nt
    v_fmac_f32 v132, v218, v218
    v_fmac_f32 v132, v219, v219
    v_fmac_f32 v132, v220, v220
    v_fmac_f32 v132, v221, v221
    v_mfma_f32_16x16x32_bf16 v[150:153], v[198:201], a[156:159], v[150:153]
    v_cvt_pk_bf16_f32 v36, v132, v116
    v_mul_f32 v203, v117, v203
    v_mfma_f32_16x16x32_bf16 v[150:153], v[210:213], a[160:163], v[150:153]
    v_cvt_pk_bf16_f32 v116, v202, v203
    v_mul_f32 v204, v117, v204
    v_mfma_f32_16x16x32_bf16 v[190:193], v[32:35], v[36:39], 0
    v_mul_f32 v205, v117, v205
    v_cvt_pk_bf16_f32 v117, v204, v205
    v_mfma_f32_16x16x32_bf16 v[150:153], v[162:165], a[164:167], v[150:153]
    v_mul_f32 v146, v255, v146
    v_mul_f32 v147, v255, v147
    v_mfma_f32_16x16x32_bf16 v[202:205], v[118:121], a[168:171], 0
    v_cvt_pk_bf16_f32 v146, v146, v147
    v_mul_f32 v148, v255, v148
    v_mfma_f32_16x16x32_bf16 v[202:205], v[134:137], a[172:175], v[202:205]
    v_rsq_f32 v191, v191
    v_mfma_f32_16x16x32_bf16 v[202:205], v[154:157], a[176:179], v[202:205]
    v_cvt_pk_bf16_f32 v172, v150, v151
    v_cvt_pk_bf16_f32 v173, v152, v153
    v_mfma_f32_16x16x32_bf16 v[202:205], v[198:201], a[180:183], v[202:205]
    v_rsq_f32 v190, v190
    v_mfma_f32_16x16x32_bf16 v[202:205], v[210:213], a[184:187], v[202:205]
    ds_read_b128 v[150:153], v0 offset:32768
    v_mul_f32 v190, s31, v190
    v_mfma_f32_16x16x32_bf16 v[202:205], v[162:165], a[188:191], v[202:205]
    ds_read_b128 v[166:169], v1 offset:32768
    v_mul_f32 v226, v191, v226
    v_mfma_f32_16x16x32_bf16 v[194:197], v[118:121], a[192:195], 0
    ds_read_b128 v[118:121], v0 offset:32896
    v_mul_f32 v227, v191, v227
    v_mfma_f32_16x16x32_bf16 v[194:197], v[134:137], a[196:199], v[194:197]
    ds_read_b128 v[134:137], v1 offset:32896
    v_cvt_pk_f16_f32 v226, v226, v227
    v_mfma_f32_16x16x32_bf16 v[194:197], v[154:157], a[200:203], v[194:197]
    ds_read_b128 v[154:157], v0 offset:33024
    v_cvt_pk_bf16_f32 v132, v202, v203
    v_mfma_f32_16x16x32_bf16 v[194:197], v[198:201], a[204:207], v[194:197]
    ds_read_b128 v[198:201], v1 offset:33024
    v_cvt_pk_bf16_f32 v133, v204, v205
    v_mfma_f32_16x16x32_bf16 v[194:197], v[210:213], a[208:211], v[194:197]
    v_mul_f32 v228, v191, v228
    v_mul_f32 v229, v191, v229
    v_mfma_f32_16x16x32_bf16 v[194:197], v[162:165], a[212:215], v[194:197]
    v_cvt_pk_f16_f32 v227, v228, v229
    v_mul_f32 v122, v191, v122
    v_mfma_f32_16x16x32_f16 v[210:213], v[242:245], v[222:225], v[46:49]
    s_waitcnt lgkmcnt(5)
    buffer_store_dwordx2 v[116:117], v18, s[12:15], 0 offen nt
    v_mul_f32 v123, v191, v123
    v_cvt_pk_f16_f32 v228, v122, v123
    v_mfma_f32_16x16x32_bf16 v[202:205], a[72:75], v[150:153], 0
    s_waitcnt lgkmcnt(3)
    v_cvt_pk_bf16_f32 v116, v194, v195
    v_cvt_pk_bf16_f32 v117, v196, v197
    v_mfma_f32_16x16x32_bf16 v[202:205], a[76:79], v[166:169], v[202:205]
    s_waitcnt lgkmcnt(2)
    v_mul_f32 v124, v191, v124
    v_mul_f32 v125, v191, v125
    v_mfma_f32_16x16x32_bf16 v[202:205], a[80:83], v[118:121], v[202:205]
    s_waitcnt lgkmcnt(1)
    v_cvt_pk_f16_f32 v229, v124, v125
    v_mul_f32 v126, v191, v126
    v_mfma_f32_16x16x32_bf16 v[202:205], a[84:87], v[134:137], v[202:205]
    s_waitcnt lgkmcnt(0)
    v_mul_f32 v127, v191, v127
    v_cvt_pk_f16_f32 v124, v126, v127
    v_mfma_f32_16x16x32_bf16 v[202:205], a[88:91], v[154:157], v[202:205]
    v_mul_f32 v128, v191, v128
    v_mul_f32 v129, v191, v129
    v_mfma_f32_16x16x32_bf16 v[202:205], a[92:95], v[198:201], v[202:205]
    v_cvt_pk_f16_f32 v125, v128, v129
    v_mul_f32 v206, v190, v206
    v_mfma_f32_16x16x32_bf16 v[126:129], a[96:99], v[150:153], 0
    v_mul_f32 v207, v190, v207
    v_cvt_pk_f16_f32 v206, v206, v207
    v_mfma_f32_16x16x32_bf16 v[126:129], a[100:103], v[166:169], v[126:129]
    v_mul_f32 v208, v190, v208
    v_mul_f32 v209, v190, v209
    v_mfma_f32_16x16x32_bf16 v[126:129], a[104:107], v[118:121], v[126:129]
    v_cvt_pk_f16_f32 v207, v208, v209
    v_mul_f32 v174, v190, v174
    v_mfma_f32_16x16x32_bf16 v[126:129], a[108:111], v[134:137], v[126:129]
    v_mul_f32 v175, v190, v175
    v_cvt_pk_f16_f32 v208, v174, v175
    v_mfma_f32_16x16x32_bf16 v[126:129], a[112:115], v[154:157], v[126:129]
    v_mul_f32 v176, v190, v176
    v_mul_f32 v177, v190, v177
    v_mfma_f32_16x16x32_bf16 v[126:129], a[116:119], v[198:201], v[126:129]
    v_cvt_pk_f16_f32 v209, v176, v177
    v_mul_f32 v218, v190, v218
    v_mfma_f32_16x16x32_bf16 v[174:177], a[120:123], v[150:153], 0
    v_mul_f32 v219, v190, v219
    v_cvt_pk_f16_f32 v122, v218, v219
    v_mfma_f32_16x16x32_bf16 v[174:177], a[124:127], v[166:169], v[174:177]
    v_mul_f32 v220, v190, v220
    v_mul_f32 v221, v190, v221
    v_mfma_f32_16x16x32_bf16 v[174:177], a[128:131], v[118:121], v[174:177]
    v_cvt_pk_f16_f32 v123, v220, v221
    v_fma_f32 v162, v202, v202, s32
    v_mfma_f32_16x16x32_bf16 v[174:177], a[132:135], v[134:137], v[174:177]
    v_fmac_f32 v162, v203, v203
    v_fmac_f32 v162, v204, v204
    v_mfma_f32_16x16x32_bf16 v[174:177], a[136:139], v[154:157], v[174:177]
    v_fmac_f32 v162, v205, v205
    v_fmac_f32 v162, v126, v126
    v_mfma_f32_16x16x32_bf16 v[174:177], a[140:143], v[198:201], v[174:177]
    v_fmac_f32 v162, v127, v127
    v_fmac_f32 v162, v128, v128
    v_mfma_f32_16x16x32_bf16 v[190:193], a[0:3], v[150:153], 0
    v_fmac_f32 v162, v129, v129
    v_mul_f32 v149, v255, v149
    v_mfma_f32_16x16x32_bf16 v[190:193], a[4:7], v[166:169], v[190:193]
    v_cvt_pk_bf16_f32 v147, v148, v149
    v_mul_f32 v138, v255, v138
    v_mfma_f32_16x16x32_bf16 v[190:193], a[8:11], v[118:121], v[190:193]
    v_fmac_f32 v162, v174, v174
    v_fmac_f32 v162, v175, v175
    v_mfma_f32_16x16x32_bf16 v[190:193], a[12:15], v[134:137], v[190:193]
    v_fmac_f32 v162, v176, v176
    v_fmac_f32 v162, v177, v177
    v_mfma_f32_16x16x32_bf16 v[190:193], a[16:19], v[154:157], v[190:193]
    v_mul_f32 v139, v255, v139
    v_cvt_pk_bf16_f32 v148, v138, v139
    v_mfma_f32_16x16x32_bf16 v[190:193], a[20:23], v[198:201], v[190:193]
    v_mul_f32 v140, v255, v140
    v_mul_f32 v141, v255, v141
    v_mfma_f32_16x16x32_bf16 v[218:221], a[24:27], v[150:153], 0
    v_cvt_pk_bf16_f32 v149, v140, v141
    v_mul_f32 v186, v255, v186
    v_mfma_f32_16x16x32_bf16 v[218:221], a[28:31], v[166:169], v[218:221]
    buffer_store_dwordx4 v[146:149], v17, s[12:15], 0 offen nt
    v_mul_f32 v187, v255, v187
    v_fma_f32 v163, v190, v190, s32
    v_fmac_f32 v163, v191, v191
    v_fmac_f32 v163, v192, v192
    v_mfma_f32_16x16x32_bf16 v[218:221], a[32:35], v[118:121], v[218:221]
    v_fmac_f32 v163, v193, v193
    v_cvt_pk_bf16_f32 v164, v186, v187
    v_mfma_f32_16x16x32_bf16 v[218:221], a[36:39], v[134:137], v[218:221]
    v_mul_f32 v188, v255, v188
    v_mul_f32 v189, v255, v189
    v_mfma_f32_16x16x32_bf16 v[218:221], a[40:43], v[154:157], v[218:221]
    v_cvt_pk_bf16_f32 v165, v188, v189
    v_mul_f32 v142, v254, v142
    v_mfma_f32_16x16x32_bf16 v[218:221], a[44:47], v[198:201], v[218:221]
    v_mul_f32 v143, v254, v143
    v_cvt_pk_bf16_f32 v142, v142, v143
    v_mfma_f32_16x16x32_bf16 v[138:141], a[48:51], v[150:153], 0
    v_mul_f32 v144, v254, v144
    v_mul_f32 v145, v254, v145
    v_mfma_f32_16x16x32_bf16 v[138:141], a[52:55], v[166:169], v[138:141]
    v_cvt_pk_bf16_f32 v143, v144, v145
    v_mul_f32 v158, v254, v158
    v_mfma_f32_16x16x32_bf16 v[138:141], a[56:59], v[118:121], v[138:141]
    v_fmac_f32 v163, v218, v218
    v_fmac_f32 v163, v219, v219
    v_mfma_f32_16x16x32_bf16 v[138:141], a[60:63], v[134:137], v[138:141]
    ds_read2_b32 v[196:197], v6 offset0:0 offset1:0
    ds_read2_b32 v[216:217], v6 offset0:16 offset1:16
    v_mfma_f32_16x16x32_bf16 v[138:141], a[64:67], v[154:157], v[138:141]
    ds_read2_b32 v[232:233], v6 offset0:32 offset1:32
    v_fmac_f32 v163, v220, v220
    v_mfma_f32_16x16x32_bf16 v[138:141], a[68:71], v[198:201], v[138:141]
    v_fmac_f32 v163, v221, v221
    v_mul_f32 v159, v254, v159
    v_mfma_f32_16x16x32_bf16 v[146:149], v[150:153], a[144:147], 0
    v_cvt_pk_bf16_f32 v144, v158, v159
    v_mul_f32 v160, v254, v160
    v_mfma_f32_16x16x32_bf16 v[146:149], v[166:169], a[148:151], v[146:149]
    v_mul_f32 v161, v254, v161
    v_cvt_pk_bf16_f32 v145, v160, v161
    v_mfma_f32_16x16x32_bf16 v[146:149], v[118:121], a[152:155], v[146:149]
    v_fmac_f32 v163, v138, v138
    v_fmac_f32 v163, v139, v139
    v_mfma_f32_16x16x32_bf16 v[146:149], v[134:137], a[156:159], v[146:149]
    v_fmac_f32 v163, v140, v140
    v_fmac_f32 v163, v141, v141
    v_mfma_f32_16x16x32_bf16 v[146:149], v[154:157], a[160:163], v[146:149]
    v_cvt_pk_bf16_f32 v36, v163, v162
    v_mul_f32 v178, v254, v178
    v_mfma_f32_16x16x32_bf16 v[146:149], v[198:201], a[164:167], v[146:149]
    s_waitcnt lgkmcnt(1)
    v_mul_f32 v179, v254, v179
    v_cvt_pk_bf16_f32 v178, v178, v179
    v_mfma_f32_16x16x32_bf16 v[158:161], v[32:35], v[36:39], 0
    s_waitcnt lgkmcnt(0)
    buffer_store_dwordx2 v[164:165], v20, s[12:15], 0 offen nt
    v_mul_f32 v180, v254, v180
    v_mul_f32 v181, v254, v181
    v_mfma_f32_16x16x32_bf16 v[186:189], v[150:153], a[168:171], 0
    v_cvt_pk_bf16_f32 v194, v146, v147
    v_cvt_pk_bf16_f32 v195, v148, v149
    v_mfma_f32_16x16x32_bf16 v[186:189], v[166:169], a[172:175], v[186:189]
    v_rsq_f32 v159, v159
    v_mfma_f32_16x16x32_bf16 v[186:189], v[118:121], a[176:179], v[186:189]
    v_rsq_f32 v158, v158
    v_mfma_f32_16x16x32_bf16 v[186:189], v[134:137], a[180:183], v[186:189]
    v_mul_f32 v158, s31, v158
    v_mul_f32 v202, v159, v202
    v_mfma_f32_16x16x32_bf16 v[186:189], v[154:157], a[184:187], v[186:189]
    v_mul_f32 v203, v159, v203
    v_cvt_pk_f16_f32 v146, v202, v203
    v_mfma_f32_16x16x32_bf16 v[186:189], v[198:201], a[188:191], v[186:189]
    v_mul_f32 v204, v159, v204
    v_mul_f32 v205, v159, v205
    v_mfma_f32_16x16x32_bf16 v[162:165], v[150:153], a[192:195], 0
    v_cvt_pk_f16_f32 v147, v204, v205
    v_mul_f32 v126, v159, v126
    v_mfma_f32_16x16x32_bf16 v[162:165], v[166:169], a[196:199], v[162:165]
    ds_read_b128 v[150:153], v5 offset:0
    ds_read_b128 v[202:205], v5 offset:16
    v_mfma_f32_16x16x32_bf16 v[162:165], v[118:121], a[200:203], v[162:165]
    ds_read_b128 v[118:121], v5 offset:48
    ds_read_b32 v254, v6 offset:192
    v_mfma_f32_16x16x32_bf16 v[162:165], v[134:137], a[204:207], v[162:165]
    v_cvt_pk_bf16_f32 v214, v186, v187
    v_cvt_pk_bf16_f32 v215, v188, v189
    v_mfma_f32_16x16x32_bf16 v[162:165], v[154:157], a[208:211], v[162:165]
    v_mul_f32 v127, v159, v127
    v_cvt_pk_f16_f32 v148, v126, v127
    v_mfma_f32_16x16x32_bf16 v[162:165], v[198:201], a[212:215], v[162:165]
    ds_read_b128 v[198:201], v2 offset:0
    ds_read_b128 v[186:189], v2 offset:1024
    v_mfma_f32_16x16x32_f16 v[134:137], v[226:229], v[222:225], v[50:53]
    ds_read_b128 v[154:157], v2 offset:2048
    v_mul_f32 v128, v159, v128
    v_mul_f32 v129, v159, v129
    v_mfma_f32_16x16x16_f16 v[210:213], v[184:185], v[182:183], v[210:213]
    v_cvt_pk_f16_f32 v149, v128, v129
    v_cvt_pk_bf16_f32 v230, v162, v163
    v_cvt_pk_bf16_f32 v231, v164, v165
    v_mul_f32 v174, v159, v174
    v_mfma_f32_16x16x32_f16 v[126:129], v[146:149], v[222:225], v[54:57]
    s_waitcnt lgkmcnt(5)
    v_mul_f32 v175, v159, v175
    v_cvt_pk_f16_f32 v164, v174, v175
    v_mul_f32 v176, v159, v176
    v_mfma_f32_16x16x16_f16 v[134:137], v[124:125], v[182:183], v[134:137]
    v_mul_f32 v177, v159, v177
    v_cvt_pk_f16_f32 v165, v176, v177
    v_mul_f32 v190, v158, v190
    v_mul_f32 v191, v158, v191
    v_mfma_f32_16x16x16_f16 v[126:129], v[164:165], v[182:183], v[126:129]
    v_cvt_pk_f16_f32 v174, v190, v191
    v_mul_f32 v192, v158, v192
    v_mul_f32 v193, v158, v193
    v_cvt_pk_f16_f32 v175, v192, v193
    v_mfma_f32_16x16x32_f16 v[166:169], v[150:153], v[222:225], v[22:25]
    s_waitcnt lgkmcnt(2)
    ds_read_b128 v[222:225], v2 offset:3072
    buffer_store_dwordx4 v[142:145], v16, s[12:15], 0 offen nt
    ds_read_b128 v[234:237], v2 offset:4096
    v_mul_f32 v218, v158, v218
    v_mul_f32 v219, v158, v219
    v_cvt_pk_f16_f32 v176, v218, v219
    v_mfma_f32_16x16x32_f16 v[166:169], v[202:205], v[242:245], v[166:169]
    s_waitcnt lgkmcnt(2)
    v_mul_f32 v220, v158, v220
    v_mul_f32 v221, v158, v221
    v_mfma_f32_16x16x32_f16 v[166:169], v[118:121], v[182:185], v[166:169]
    ds_read_b128 v[142:145], v2 offset:5120
    v_cvt_pk_f16_f32 v177, v220, v221
    v_mul_f32 v138, v158, v138
    v_mul_f32 v139, v158, v139
    v_cvt_pk_f16_f32 v162, v138, v139
    v_mfma_f32_16x16x32_f16 v[218:221], v[150:153], v[206:209], v[24:27]
    v_mul_f32 v140, v158, v140
    v_mul_f32 v141, v158, v141
    v_mfma_f32_16x16x32_f16 v[218:221], v[202:205], v[226:229], v[218:221]
    v_mov_b32_dpp v254, v167 quad_perm:[0,1,2,3] row_mask:0x1 bank_mask:0xf
    v_cvt_pk_f16_f32 v163, v140, v141
    v_mfma_f32_16x16x32_f16 v[218:221], v[118:121], v[122:125], v[218:221]
    v_max3_f32 v255, v166, v210, v211
    v_max3_f32 v255, v255, v212, v213
    v_mfma_f32_16x16x32_f16 v[238:241], v[150:153], v[174:177], v[26:29]
    s_waitcnt lgkmcnt(1)
    v_max3_f32 v255, v255, v134, v135
    v_max3_f32 v255, v255, v136, v137
    v_mfma_f32_16x16x32_f16 v[238:241], v[202:205], v[146:149], v[238:241]
    v_max3_f32 v255, v255, v126, v127
    v_mov_b32_dpp v254, v219 quad_perm:[0,1,2,3] row_mask:0x2 bank_mask:0xf
    v_mfma_f32_16x16x32_f16 v[238:241], v[118:121], v[162:165], v[238:241]
    v_max3_f32 v255, v255, v128, v129
    v_mov_b32 v182, v255
    v_mfma_f32_16x16x32_bf16 v[150:153], a[216:219], v[198:201], 0
    s_waitcnt lgkmcnt(0)
    v_permlane32_swap_b32 v255, v182
    v_mfma_f32_16x16x32_bf16 v[150:153], a[220:223], v[186:189], v[150:153]
    v_max_f32 v255, v255, v182
    v_mov_b32 v182, v255
    v_mfma_f32_16x16x32_bf16 v[150:153], a[224:227], v[154:157], v[150:153]
    v_cvt_pk_bf16_f32 v179, v180, v181
    v_xor_b32 v0, 65536, v0
    v_mfma_f32_16x16x32_bf16 v[150:153], a[228:231], v[222:225], v[150:153]
    s_waitcnt vmcnt(5)
    v_permlane16_swap_b32 v255, v182
    v_mfma_f32_16x16x32_bf16 v[150:153], a[232:235], v[234:237], v[150:153]
    s_nop 0
    v_max_f32 v255, v255, v182
    v_sub_f32 v210, v210, v255
    v_mfma_f32_16x16x32_bf16 v[150:153], a[236:239], v[142:145], v[150:153]
    s_barrier
    v_exp_f32 v210, v210
    v_mfma_f32_16x16x32_bf16 v[190:193], a[240:243], v[198:201], 0
    s_nop 0
    v_sub_f32 v211, v211, v255
    v_sub_f32 v212, v212, v255
    v_mfma_f32_16x16x32_bf16 v[190:193], a[244:247], v[186:189], v[190:193]
    s_nop 0
    buffer_load_dwordx4 v10, s[8:11], 0 offen nt lds
    v_sub_f32 v213, v213, v255
    v_mfma_f32_16x16x32_bf16 v[190:193], a[248:251], v[154:157], v[190:193]
    s_add_u32 m0, s28, 4096
    v_exp_f32 v211, v211
    v_mfma_f32_16x16x32_bf16 v[190:193], a[252:255], v[222:225], v[190:193]
    v_cvt_pk_bf16_f32 v158, v210, v211
    v_sub_f32 v134, v134, v255
    v_mfma_f32_16x16x32_bf16 v[190:193], v[82:85], v[234:237], v[190:193]
    v_exp_f32 v212, v212
    v_mfma_f32_16x16x32_bf16 v[190:193], v[86:89], v[142:145], v[190:193]
    v_exp_f32 v213, v213
    v_mfma_f32_16x16x32_bf16 v[202:205], v[90:93], v[198:201], 0
    ds_read_b128 v[198:201], v2 offset:6144
    buffer_load_dwordx4 v11, s[8:11], 0 offen nt lds
    v_mfma_f32_16x16x32_bf16 v[202:205], v[94:97], v[186:189], v[202:205]
    s_add_u32 m0, s28, 8192
    ds_read_b128 v[138:141], v2 offset:7168
    v_cvt_pk_bf16_f32 v159, v212, v213
    v_mfma_f32_16x16x32_bf16 v[202:205], v[98:101], v[154:157], v[202:205]
    ds_read_b128 v[210:213], v2 offset:8192
    v_sub_f32 v135, v135, v255
    v_mfma_f32_16x16x32_bf16 v[202:205], v[102:105], v[222:225], v[202:205]
    ds_read_b128 v[186:189], v2 offset:9216
    v_sub_f32 v136, v136, v255
    v_mfma_f32_16x16x32_bf16 v[202:205], v[106:109], v[234:237], v[202:205]
    ds_read_b128 v[222:225], v2 offset:10240
    v_sub_f32 v137, v137, v255
    v_mfma_f32_16x16x32_bf16 v[202:205], v[110:113], v[142:145], v[202:205]
    ds_read_b128 v[154:157], v2 offset:11264
    buffer_load_dwordx4 v12, s[8:11], 0 offen nt lds
    v_exp_f32 v134, v134
    v_mfma_f32_16x16x32_f16 v[118:121], v[242:245], v[206:209], v[58:61]
    s_add_u32 m0, s28, 12288
    v_exp_f32 v135, v135
    v_exp_f32 v136, v136
    v_cvt_pk_bf16_f32 v160, v134, v135
    v_exp_f32 v137, v137
    v_sub_f32 v126, v126, v255
    v_mfma_f32_16x16x16_f16 v[118:121], v[184:185], v[122:123], v[118:121]
    v_cvt_pk_bf16_f32 v161, v136, v137
    v_exp_f32 v126, v126
    v_sub_f32 v127, v127, v255
    v_mfma_f32_16x16x32_f16 v[134:137], v[226:229], v[206:209], v[62:65]
    s_xor_b32 s28, s28, 65536
    buffer_load_dwordx4 v13, s[8:11], 0 offen nt lds
    v_exp_f32 v127, v127
    v_sub_f32 v128, v128, v255
    v_cvt_pk_bf16_f32 v36, v126, v127
    v_exp_f32 v128, v128
    v_mfma_f32_16x16x16_f16 v[134:137], v[124:125], v[122:123], v[134:137]
    v_sub_f32 v129, v129, v255
    v_exp_f32 v129, v129
    v_sub_f32 v166, v166, v255
    v_cvt_pk_bf16_f32 v37, v128, v129
    v_mfma_f32_16x16x32_f16 v[126:129], v[146:149], v[206:209], v[66:69]
    s_waitcnt lgkmcnt(0)
    v_exp_f32 v166, v166
    v_mfma_f32_16x16x32_bf16 v[142:145], a[216:219], v[198:201], 0
    s_mov_b32 m0, s29
    v_cvt_pk_bf16_f32 v39, v166, 0
    v_max3_f32 v255, v218, v118, v119
    v_max3_f32 v255, v255, v120, v121
    v_mfma_f32_16x16x16_f16 v[126:129], v[164:165], v[122:123], v[126:129]
    v_max3_f32 v255, v255, v134, v135
    v_max3_f32 v255, v255, v136, v137
    v_xor_b32 v1, 65536, v1
    v_mov_b32_dpp v254, v239 quad_perm:[0,1,2,3] row_mask:0x4 bank_mask:0xf
    v_mfma_f32_16x16x32_bf16 v[206:209], v[28:31], v[36:39], 0
    s_xor_b32 s29, s29, s30
    buffer_store_dwordx2 v[178:179], v19, s[12:15], 0 offen nt
    v_mov_b32 v122, v254
    v_max3_f32 v255, v255, v126, v127
    v_mfma_f32_16x16x32_bf16 v[206:209], v[28:31], v[158:161], v[206:209]
    s_add_u32 s19, s19, s20
    v_max3_f32 v255, v255, v128, v129
    v_mov_b32 v123, v255
    v_mfma_f32_16x16x32_bf16 v[142:145], a[220:223], v[138:141], v[142:145]
    s_add_u32 s23, s23, s21
    v_permlane32_swap_b32 v255, v123
    v_mfma_f32_16x16x32_bf16 v[142:145], a[224:227], v[210:213], v[142:145]
    s_cmp_ge_u32 s19, 72
    v_rcp_f32 v206, v206
    v_mfma_f32_16x16x32_bf16 v[142:145], a[228:231], v[186:189], v[142:145]
    s_cselect_b32 s34, 72, 0
    v_max_f32 v255, v255, v123
    v_mov_b32 v123, v255
    v_mfma_f32_16x16x32_bf16 v[142:145], a[232:235], v[222:225], v[142:145]
    s_cselect_b32 s35, s22, 0
    v_permlane16_swap_b32 v255, v123
    v_mfma_f32_16x16x32_bf16 v[142:145], a[236:239], v[154:157], v[142:145]
    s_sub_u32 s19, s19, s34
    v_max_f32 v255, v255, v123
    v_sub_f32 v118, v118, v255
    v_mfma_f32_16x16x32_bf16 v[178:181], v[194:197], v[36:39], 0
    s_add_u32 s23, s23, s35
    v_exp_f32 v118, v118
    v_mfma_f32_16x16x32_bf16 v[178:181], v[170:173], v[158:161], v[178:181]
    s_add_u32 s18, s18, 1
    v_sub_f32 v119, v119, v255
    v_exp_f32 v119, v119
    v_sub_f32 v120, v120, v255
    v_cvt_pk_bf16_f32 v118, v118, v119
    v_exp_f32 v120, v120
    v_sub_f32 v121, v121, v255
    v_exp_f32 v121, v121
    v_mul_f32 v178, v206, v178
    v_mul_f32 v179, v206, v179
    v_cvt_pk_bf16_f32 v178, v178, v179
    v_mul_f32 v180, v206, v180
    v_mul_f32 v181, v206, v181
    v_cvt_pk_bf16_f32 v179, v180, v181
    v_cvt_pk_bf16_f32 v119, v120, v121
    v_mfma_f32_16x16x32_bf16 v[166:169], v[214:217], v[36:39], 0
    s_cmp_lt_u32 s18, s17
    v_sub_f32 v134, v134, v255
    v_sub_f32 v135, v135, v255
    v_mfma_f32_16x16x32_bf16 v[166:169], v[130:133], v[158:161], v[166:169]
    v_exp_f32 v134, v134
    v_exp_f32 v135, v135
    v_sub_f32 v136, v136, v255
    v_cvt_pk_bf16_f32 v120, v134, v135
    v_exp_f32 v136, v136
    v_sub_f32 v137, v137, v255
    v_exp_f32 v137, v137
    v_sub_f32 v126, v126, v255
    v_mul_f32 v166, v206, v166
    v_mul_f32 v167, v206, v167
    v_cvt_pk_bf16_f32 v180, v166, v167
    v_mul_f32 v168, v206, v168
    v_mul_f32 v169, v206, v169
    v_cvt_pk_bf16_f32 v181, v168, v169
    v_cvt_pk_bf16_f32 v121, v136, v137
    v_mfma_f32_16x16x32_bf16 v[134:137], v[230:233], v[36:39], 0
    buffer_load_dwordx4 v14, s[8:11], 0 offen nt lds
    v_sub_f32 v127, v127, v255
    v_mfma_f32_16x16x32_bf16 v[134:137], v[114:117], v[158:161], v[134:137]
    ds_write_b128 v3, v[178:181] offset:0
    v_mfma_f32_16x16x32_bf16 v[158:161], a[240:243], v[198:201], 0
    v_exp_f32 v126, v126
    v_mfma_f32_16x16x32_bf16 v[158:161], a[244:247], v[138:141], v[158:161]
    v_exp_f32 v127, v127
    v_mfma_f32_16x16x32_bf16 v[158:161], a[248:251], v[210:213], v[158:161]
    v_cvt_pk_bf16_f32 v36, v126, v127
    v_sub_f32 v128, v128, v255
    v_mfma_f32_16x16x32_bf16 v[158:161], a[252:255], v[186:189], v[158:161]
    v_mul_f32 v134, v206, v134
    v_mul_f32 v135, v206, v135
    v_mfma_f32_16x16x32_bf16 v[158:161], v[82:85], v[222:225], v[158:161]
    v_cvt_pk_bf16_f32 v126, v134, v135
    v_mul_f32 v136, v206, v136
    v_mfma_f32_16x16x32_bf16 v[158:161], v[86:89], v[154:157], v[158:161]
    v_mul_f32 v137, v206, v137
    v_cvt_pk_bf16_f32 v127, v136, v137
    v_mfma_f32_16x16x32_bf16 v[178:181], v[90:93], v[198:201], 0
    ds_read_b128 v[198:201], v2 offset:12288
    v_sub_f32 v129, v129, v255
    v_mfma_f32_16x16x32_bf16 v[178:181], v[94:97], v[138:141], v[178:181]
    ds_read_b128 v[206:209], v2 offset:13312
    v_sub_f32 v218, v218, v255
    v_mfma_f32_16x16x32_bf16 v[178:181], v[98:101], v[210:213], v[178:181]
    ds_read_b128 v[210:213], v2 offset:14336
    v_max_f32_dpp v122, v122, v122 quad_perm:[1,0,3,2] row_mask:0xf bank_mask:0xf
    v_mfma_f32_16x16x32_bf16 v[178:181], v[102:105], v[186:189], v[178:181]
    ds_read_b128 v[134:137], v2 offset:15360
    v_max_f32_dpp v122, v122, v122 quad_perm:[2,3,0,1] row_mask:0xf bank_mask:0xf
    v_mfma_f32_16x16x32_bf16 v[178:181], v[106:109], v[222:225], v[178:181]
    ds_read_b128 v[222:225], v2 offset:16384
    v_max_f32_dpp v122, v122, v122 row_half_mirror row_mask:0xf bank_mask:0xf
    v_mfma_f32_16x16x32_bf16 v[178:181], v[110:113], v[154:157], v[178:181]
    ds_read_b128 v[154:157], v2 offset:17408
    ds_write_b64 v4, v[126:127] offset:4096
    v_exp_f32 v128, v128
    v_exp_f32 v129, v129
    v_mfma_f32_16x16x32_f16 v[186:189], v[242:245], v[174:177], v[70:73]
    s_waitcnt lgkmcnt(6)
    v_cvt_pk_bf16_f32 v37, v128, v129
    v_max_f32_dpp v122, v122, v122 row_mirror row_mask:0xf bank_mask:0xf
    v_mfma_f32_16x16x32_f16 v[242:245], v[226:229], v[174:177], v[74:77]
    s_waitcnt lgkmcnt(5)
    v_exp_f32 v218, v218
    v_mfma_f32_16x16x32_f16 v[126:129], v[146:149], v[174:177], v[78:81]
    s_waitcnt lgkmcnt(4)
    v_cvt_pk_bf16_f32 v39, v218, 0
    v_mov_b32 v123, v122
    v_fma_f32 v255, v150, v150, s33
    v_mfma_f32_16x16x32_bf16 v[174:177], v[28:31], v[36:39], 0
    s_waitcnt lgkmcnt(3)
    v_permlane32_swap_b32 v122, v123
    v_mfma_f32_16x16x32_bf16 v[174:177], v[28:31], v[118:121], v[174:177]
    s_waitcnt lgkmcnt(2)
    v_max_f32 v122, v122, v123
    v_mov_b32 v123, v122
    v_mfma_f32_16x16x32_bf16 v[226:229], v[194:197], v[36:39], 0
    s_waitcnt lgkmcnt(0)
    v_permlane16_swap_b32 v122, v123
    v_mfma_f32_16x16x32_bf16 v[226:229], v[170:173], v[118:121], v[226:229]
    v_max_f32 v122, v122, v123
    v_sub_f32 v254, v254, v122
    v_mfma_f32_16x16x32_bf16 v[218:221], v[214:217], v[36:39], 0
    v_exp_f32 v254, v254
    v_mfma_f32_16x16x32_bf16 v[218:221], v[130:133], v[118:121], v[218:221]
    v_cvt_pk_bf16_f32 v254, v254, v254
    v_fmac_f32 v255, v151, v151
    v_mfma_f32_16x16x32_bf16 v[166:169], v[230:233], v[36:39], 0
    ds_write_b16 v8, v254
    v_mfma_f32_16x16x32_bf16 v[166:169], v[114:117], v[118:121], v[166:169]
    v_rcp_f32 v174, v174
    v_fmac_f32 v255, v152, v152
    v_mfma_f32_16x16x16_f16 v[186:189], v[184:185], v[162:163], v[186:189]
    v_mul_f32 v226, v174, v226
    v_mul_f32 v227, v174, v227
    v_cvt_pk_bf16_f32 v122, v226, v227
    v_mfma_f32_16x16x16_f16 v[242:245], v[124:125], v[162:163], v[242:245]
    v_mul_f32 v228, v174, v228
    v_mul_f32 v229, v174, v229
    v_cvt_pk_bf16_f32 v123, v228, v229
    v_mfma_f32_16x16x16_f16 v[126:129], v[164:165], v[162:163], v[126:129]
    v_max3_f32 v254, v238, v186, v187
    v_max3_f32 v254, v254, v188, v189
    v_mul_f32 v218, v174, v218
    v_mul_f32 v219, v174, v219
    v_mfma_f32_16x16x32_bf16 v[146:149], a[216:219], v[198:201], 0
    ds_read_b128 v[118:121], v9
    ds_read_b128 v[162:165], v9 offset:64
    v_mfma_f32_16x16x32_bf16 v[146:149], a[220:223], v[206:209], v[146:149]
    v_max3_f32 v254, v254, v242, v243
    v_max3_f32 v254, v254, v244, v245
    v_mfma_f32_16x16x32_bf16 v[146:149], a[224:227], v[210:213], v[146:149]
    v_max3_f32 v254, v254, v126, v127
    v_max3_f32 v254, v254, v128, v129
    v_mfma_f32_16x16x32_bf16 v[146:149], a[228:231], v[134:137], v[146:149]
    v_mov_b32 v125, v254
    v_cvt_pk_bf16_f32 v124, v218, v219
    v_mfma_f32_16x16x32_bf16 v[146:149], a[232:235], v[222:225], v[146:149]
    v_permlane32_swap_b32 v254, v125
    v_mfma_f32_16x16x32_bf16 v[146:149], a[236:239], v[154:157], v[146:149]
    v_max_f32 v254, v254, v125
    v_mov_b32 v125, v254
    v_mfma_f32_16x16x32_bf16 v[138:141], a[240:243], v[198:201], 0
    v_mul_f32 v220, v174, v220
    v_mul_f32 v221, v174, v221
    v_mfma_f32_16x16x32_bf16 v[138:141], a[244:247], v[206:209], v[138:141]
    v_permlane16_swap_b32 v254, v125
    v_mfma_f32_16x16x32_bf16 v[138:141], a[248:251], v[210:213], v[138:141]
    s_waitcnt lgkmcnt(0)
    v_max_f32 v254, v254, v125
    v_sub_f32 v186, v186, v254
    v_mfma_f32_16x16x32_bf16 v[138:141], a[252:255], v[134:137], v[138:141]
    v_exp_f32 v186, v186
    v_mfma_f32_16x16x32_bf16 v[138:141], v[82:85], v[222:225], v[138:141]
    v_sub_f32 v187, v187, v254
    v_sub_f32 v188, v188, v254
    v_mfma_f32_16x16x32_bf16 v[138:141], v[86:89], v[154:157], v[138:141]
    v_exp_f32 v187, v187
    v_exp_f32 v188, v188
    v_cvt_pk_bf16_f32 v234, v186, v187
    v_sub_f32 v189, v189, v254
    v_exp_f32 v189, v189
    v_sub_f32 v242, v242, v254
    v_cvt_pk_bf16_f32 v235, v188, v189
    v_exp_f32 v242, v242
    v_sub_f32 v243, v243, v254
    v_exp_f32 v243, v243
    v_sub_f32 v244, v244, v254
    v_cvt_pk_bf16_f32 v236, v242, v243
    v_mfma_f32_16x16x32_bf16 v[186:189], v[90:93], v[198:201], 0
    v_exp_f32 v244, v244
    v_mfma_f32_16x16x32_bf16 v[186:189], v[94:97], v[206:209], v[186:189]
    v_sub_f32 v245, v245, v254
    v_sub_f32 v126, v126, v254
    v_mfma_f32_16x16x32_bf16 v[186:189], v[98:101], v[210:213], v[186:189]
    v_exp_f32 v245, v245
    v_mfma_f32_16x16x32_bf16 v[186:189], v[102:105], v[134:137], v[186:189]
    v_cvt_pk_bf16_f32 v237, v244, v245
    v_sub_f32 v127, v127, v254
    v_mfma_f32_16x16x32_bf16 v[186:189], v[106:109], v[222:225], v[186:189]
    v_exp_f32 v126, v126
    v_mfma_f32_16x16x32_bf16 v[186:189], v[110:113], v[154:157], v[186:189]
    ds_read_b128 v[182:185], v0 offset:20480
    ds_read_b128 v[198:201], v1 offset:20480
    v_mfma_f32_16x16x32_bf16 v[206:209], v[118:121], v[28:31], 0
    ds_read_b128 v[210:213], v0 offset:20608
    ds_read_b128 v[222:225], v1 offset:20608
    v_mfma_f32_16x16x32_bf16 v[206:209], v[162:165], v[28:31], v[206:209]
    v_exp_f32 v127, v127
    v_mfma_f32_16x16x32_bf16 v[154:157], v[118:121], v[170:173], 0
    ds_read_b128 v[226:229], v0 offset:20736
    v_cvt_pk_bf16_f32 v36, v126, v127
    v_mfma_f32_16x16x32_bf16 v[154:157], v[162:165], v[194:197], v[154:157]
    ds_read_b128 v[242:245], v1 offset:20736
    v_sub_f32 v128, v128, v254
    v_exp_f32 v128, v128
    v_sub_f32 v129, v129, v254
    v_exp_f32 v129, v129
    v_sub_f32 v238, v238, v254
    v_cvt_pk_bf16_f32 v37, v128, v129
    v_mfma_f32_16x16x32_bf16 v[134:137], v[118:121], v[130:133], 0
    v_exp_f32 v238, v238
    v_mfma_f32_16x16x32_bf16 v[134:137], v[162:165], v[214:217], v[134:137]
    s_waitcnt lgkmcnt(4)
    v_cvt_pk_bf16_f32 v39, v238, 0
    v_cvt_pk_bf16_f32 v125, v220, v221
    v_mfma_f32_16x16x32_bf16 v[218:221], v[118:121], v[114:117], 0
    s_waitcnt lgkmcnt(2)
    ds_write_b128 v3, v[122:125] offset:6144
    v_mfma_f32_16x16x32_bf16 v[126:129], v[28:31], v[36:39], 0
    s_waitcnt lgkmcnt(2)
    v_mul_f32 v166, v174, v166
    v_mul_f32 v167, v174, v167
    v_mfma_f32_16x16x32_bf16 v[126:129], v[28:31], v[234:237], v[126:129]
    s_waitcnt lgkmcnt(1)
    v_cvt_pk_bf16_f32 v166, v166, v167
    v_mul_f32 v168, v174, v168
    v_mfma_f32_16x16x32_bf16 v[122:125], v[194:197], v[36:39], 0
    v_mul_f32 v169, v174, v169
    v_cvt_pk_bf16_f32 v167, v168, v169
    v_mfma_f32_16x16x32_bf16 v[122:125], v[170:173], v[234:237], v[122:125]
    ds_write_b64 v4, v[166:167] offset:10240
    v_mfma_f32_16x16x32_bf16 v[170:173], v[214:217], v[36:39], 0
    v_rcp_f32 v126, v126
    v_mfma_f32_16x16x32_bf16 v[170:173], v[130:133], v[234:237], v[170:173]
    v_fma_f32 v254, v146, v146, s33
    v_fmac_f32 v254, v147, v147
    v_mfma_f32_16x16x32_bf16 v[174:177], v[230:233], v[36:39], 0
    v_fmac_f32 v254, v148, v148
    v_mul_f32 v122, v126, v122
    v_mfma_f32_16x16x32_bf16 v[174:177], v[114:117], v[234:237], v[174:177]
    v_mul_f32 v123, v126, v123
    v_cvt_pk_bf16_f32 v122, v122, v123
    v_mfma_f32_16x16x32_bf16 v[218:221], v[162:165], v[230:233], v[218:221]
    v_mul_f32 v124, v126, v124
    v_mul_f32 v125, v126, v125
    v_mfma_f32_16x16x32_bf16 v[114:117], a[72:75], v[182:185], 0
    v_cvt_pk_bf16_f32 v123, v124, v125
    v_mul_f32 v170, v126, v170
    v_mfma_f32_16x16x32_bf16 v[114:117], a[76:79], v[198:201], v[114:117]
    v_mul_f32 v171, v126, v171
    v_cvt_pk_bf16_f32 v124, v170, v171
    v_mfma_f32_16x16x32_bf16 v[114:117], a[80:83], v[210:213], v[114:117]
    v_mul_f32 v172, v126, v172
    v_mul_f32 v173, v126, v173
    v_mfma_f32_16x16x32_bf16 v[114:117], a[84:87], v[222:225], v[114:117]
    v_cvt_pk_bf16_f32 v125, v172, v173
    v_mul_f32 v174, v126, v174
    v_mfma_f32_16x16x32_bf16 v[114:117], a[88:91], v[226:229], v[114:117]
    ds_write_b128 v3, v[122:125] offset:12288
    v_mfma_f32_16x16x32_bf16 v[114:117], a[92:95], v[242:245], v[114:117]
    v_mul_f32 v175, v126, v175
    v_cvt_pk_bf16_f32 v174, v174, v175
    v_mfma_f32_16x16x32_bf16 v[122:125], a[96:99], v[182:185], 0
    v_mul_f32 v176, v126, v176
    v_mul_f32 v177, v126, v177
    v_mfma_f32_16x16x32_bf16 v[122:125], a[100:103], v[198:201], v[122:125]
    v_cvt_pk_bf16_f32 v175, v176, v177
    v_fmac_f32 v254, v149, v149
    v_mfma_f32_16x16x32_bf16 v[122:125], a[104:107], v[210:213], v[122:125]
    ds_write_b64 v4, v[174:175] offset:16384
    v_mfma_f32_16x16x32_bf16 v[122:125], a[108:111], v[222:225], v[122:125]
    v_fmac_f32 v254, v138, v138
    v_fmac_f32 v254, v139, v139
    v_mfma_f32_16x16x32_bf16 v[122:125], a[112:115], v[226:229], v[122:125]
    v_fmac_f32 v254, v140, v140
    v_fmac_f32 v254, v141, v141
    v_mfma_f32_16x16x32_bf16 v[122:125], a[116:119], v[242:245], v[122:125]
    v_fmac_f32 v254, v186, v186
    v_fmac_f32 v254, v187, v187
    v_mfma_f32_16x16x32_bf16 v[126:129], a[120:123], v[182:185], 0
    v_fmac_f32 v254, v188, v188
    v_fmac_f32 v254, v189, v189
    v_mfma_f32_16x16x32_bf16 v[126:129], a[124:127], v[198:201], v[126:129]
    v_cvt_pk_bf16_f32 v155, v254, v254
    v_fmac_f32 v255, v153, v153
    v_mfma_f32_16x16x32_bf16 v[126:129], a[128:131], v[210:213], v[126:129]
    v_rcp_f32 v206, v206
    v_mfma_f32_16x16x32_bf16 v[126:129], a[132:135], v[222:225], v[126:129]
    v_mul_f32 v154, v154, v206
    v_mul_f32_dpp v154, v134, v206 quad_perm:[0,1,2,3] row_mask:0x2 bank_mask:0xf
    v_mfma_f32_16x16x32_bf16 v[126:129], a[136:139], v[226:229], v[126:129]
    v_mul_f32_dpp v154, v218, v206 quad_perm:[0,1,2,3] row_mask:0x4 bank_mask:0xf
    v_cvt_pk_bf16_f32 v154, v154, v154
    v_mfma_f32_16x16x32_bf16 v[126:129], a[140:143], v[242:245], v[126:129]
    ds_write_b16 v7, v154
    v_mfma_f32_16x16x32_bf16 v[206:209], a[0:3], v[182:185], 0
    v_fmac_f32 v255, v190, v190
    v_fmac_f32 v255, v191, v191
    v_mfma_f32_16x16x32_bf16 v[206:209], a[4:7], v[198:201], v[206:209]
    v_fmac_f32 v255, v192, v192
    v_fmac_f32 v255, v193, v193
    v_mfma_f32_16x16x32_bf16 v[206:209], a[8:11], v[210:213], v[206:209]
    v_fmac_f32 v255, v202, v202
    v_fmac_f32 v255, v203, v203
    v_mfma_f32_16x16x32_bf16 v[206:209], a[12:15], v[222:225], v[206:209]
    v_fmac_f32 v255, v204, v204
    v_fmac_f32 v255, v205, v205
    v_mfma_f32_16x16x32_bf16 v[206:209], a[16:19], v[226:229], v[206:209]
    v_fma_f32 v254, v142, v142, s33
    v_fmac_f32 v254, v143, v143
    v_mfma_f32_16x16x32_bf16 v[206:209], a[20:23], v[242:245], v[206:209]
    v_fmac_f32 v254, v144, v144
    v_fmac_f32 v254, v145, v145
    v_mfma_f32_16x16x32_bf16 v[174:177], a[24:27], v[182:185], 0
    v_fmac_f32 v254, v158, v158
    v_fmac_f32 v254, v159, v159
    v_mfma_f32_16x16x32_bf16 v[174:177], a[28:31], v[198:201], v[174:177]
    v_fmac_f32 v254, v160, v160
    v_fmac_f32 v254, v161, v161
    v_mfma_f32_16x16x32_bf16 v[174:177], a[32:35], v[210:213], v[174:177]
    v_fmac_f32 v254, v178, v178
    v_fmac_f32 v254, v179, v179
    v_mfma_f32_16x16x32_bf16 v[174:177], a[36:39], v[222:225], v[174:177]
    v_fmac_f32 v254, v180, v180
    v_fmac_f32 v254, v181, v181
    v_mfma_f32_16x16x32_bf16 v[174:177], a[40:43], v[226:229], v[174:177]
    v_cvt_pk_bf16_f32 v154, v255, v254
    v_add_u32 v5, 336, v5
    v_mfma_f32_16x16x32_bf16 v[174:177], a[44:47], v[242:245], v[174:177]
    ds_write_b64 v4, v[154:155] offset:18432
    v_mfma_f32_16x16x32_bf16 v[218:221], a[48:51], v[182:185], 0
    v_add_u32 v6, 272, v6
    v_add_u32 v7, 16, v7
    v_mfma_f32_16x16x32_bf16 v[218:221], a[52:55], v[198:201], v[218:221]
    v_fma_f32 v130, v114, v114, s32
    v_fmac_f32 v130, v115, v115
    v_mfma_f32_16x16x32_bf16 v[218:221], a[56:59], v[210:213], v[218:221]
    v_fmac_f32 v130, v116, v116
    v_fmac_f32 v130, v117, v117
    v_mfma_f32_16x16x32_bf16 v[218:221], a[60:63], v[222:225], v[218:221]
    v_fmac_f32 v130, v122, v122
    v_fmac_f32 v130, v123, v123
    v_mfma_f32_16x16x32_bf16 v[218:221], a[64:67], v[226:229], v[218:221]
    v_fmac_f32 v130, v124, v124
    v_fmac_f32 v130, v125, v125
    v_mfma_f32_16x16x32_bf16 v[218:221], a[68:71], v[242:245], v[218:221]
    v_fmac_f32 v130, v126, v126
    v_fmac_f32 v130, v127, v127
    v_mfma_f32_16x16x32_bf16 v[170:173], v[182:185], a[144:147], 0
    s_waitcnt lgkmcnt(0)
    v_fmac_f32 v130, v128, v128
    v_fmac_f32 v130, v129, v129
    v_mfma_f32_16x16x32_bf16 v[170:173], v[198:201], a[148:151], v[170:173]
    s_nop 0
    v_fma_f32 v131, v206, v206, s32
    v_fmac_f32 v131, v207, v207
    v_mfma_f32_16x16x32_bf16 v[170:173], v[210:213], a[152:155], v[170:173]
    s_barrier
    v_fmac_f32 v131, v208, v208
    v_fmac_f32 v131, v209, v209
    v_mfma_f32_16x16x32_bf16 v[170:173], v[222:225], a[156:159], v[170:173]
    s_nop 0
    v_fmac_f32 v131, v174, v174
    v_xor_b32 v2, 65536, v2
    v_mfma_f32_16x16x32_bf16 v[170:173], v[226:229], a[160:163], v[170:173]
    s_nop 0
    v_xor_b32 v3, 65536, v3
    v_xor_b32 v4, 65536, v4
    v_mfma_f32_16x16x32_bf16 v[170:173], v[242:245], a[164:167], v[170:173]
    s_cbranch_scc1 L_loop_safe1
    s_branch L_drain
.p2align 6
L_loop_safe2:
    v_mfma_f32_16x16x32_bf16 v[162:165], v[182:185], a[168:171], 0
    s_add_u32 s12, s42, s27
    ds_read_b128 v[194:197], v2 offset:18432
    ds_read_b128 v[230:233], v2 offset:19456
    v_mfma_f32_16x16x32_bf16 v[162:165], v[198:201], a[172:175], v[162:165]
    s_addc_u32 s13, s43, 0
    v_fmac_f32 v131, v175, v175
    v_fmac_f32 v131, v176, v176
    v_mfma_f32_16x16x32_bf16 v[162:165], v[210:213], a[176:179], v[162:165]
    s_sub_u32 s14, s36, s27
    v_fmac_f32 v131, v177, v177
    v_fmac_f32 v131, v218, v218
    v_mfma_f32_16x16x32_bf16 v[162:165], v[222:225], a[180:183], v[162:165]
    s_cmp_ge_u32 s18, 2
    v_fmac_f32 v131, v219, v219
    v_fmac_f32 v131, v220, v220
    v_mfma_f32_16x16x32_bf16 v[162:165], v[226:229], a[184:187], v[162:165]
    s_cselect_b32 s14, s14, 0
    ds_read_b128 v[118:121], v0 offset:26624
    v_fmac_f32 v131, v221, v221
    v_mfma_f32_16x16x32_bf16 v[162:165], v[242:245], a[188:191], v[162:165]
    s_add_u32 s34, s18, 2
    ds_read_b128 v[134:137], v1 offset:26624
    v_cvt_pk_bf16_f32 v36, v131, v130
    v_mfma_f32_16x16x32_bf16 v[214:217], v[182:185], a[192:195], 0
    s_add_u32 s8, s40, s23
    ds_read_b128 v[154:157], v0 offset:26752
    v_cvt_pk_bf16_f32 v170, v170, v171
    v_mfma_f32_16x16x32_bf16 v[214:217], v[198:201], a[196:199], v[214:217]
    s_addc_u32 s9, s41, 0
    ds_read_b128 v[198:201], v1 offset:26752
    v_cvt_pk_bf16_f32 v171, v172, v173
    v_mfma_f32_16x16x32_bf16 v[166:169], v[32:35], v[36:39], 0
    s_sub_u32 s10, s36, s23
    v_cvt_pk_bf16_f32 v130, v162, v163
    v_cvt_pk_bf16_f32 v131, v164, v165
    v_mfma_f32_16x16x32_bf16 v[214:217], v[210:213], a[200:203], v[214:217]
    s_waitcnt lgkmcnt(4)
    ds_read_b128 v[210:213], v0 offset:26880
    s_cmp_lt_u32 s34, s17
    v_mfma_f32_16x16x32_bf16 v[234:237], v[32:35], v[194:197], 0
    s_cselect_b32 s10, s10, 0
    v_rsq_f32 v167, v167
    v_mfma_f32_16x16x32_bf16 v[234:237], v[32:35], v[230:233], v[234:237]
    s_add_u32 m0, s28, 0
    v_rsq_f32 v166, v166
    v_mfma_f32_16x16x32_bf16 v[214:217], v[222:225], a[204:207], v[214:217]
    s_waitcnt lgkmcnt(4)
    ds_read_b128 v[162:165], v1 offset:26880
    v_mul_f32 v166, s31, v166
    v_mfma_f32_16x16x32_bf16 v[214:217], v[226:229], a[208:211], v[214:217]
    s_mov_b32 s27, s26
    v_mul_f32 v114, v167, v114
    v_mul_f32 v115, v167, v115
    v_mfma_f32_16x16x32_bf16 v[214:217], v[242:245], a[212:215], v[214:217]
    s_mov_b32 s26, s25
    v_cvt_pk_f16_f32 v242, v114, v115
    v_mul_f32 v116, v167, v116
    v_mfma_f32_16x16x32_bf16 v[226:229], a[72:75], v[118:121], 0
    s_waitcnt lgkmcnt(2)
    v_mul_f32 v117, v167, v117
    v_cvt_pk_f16_f32 v243, v116, v117
    v_mfma_f32_16x16x32_bf16 v[226:229], a[76:79], v[134:137], v[226:229]
    s_mov_b32 s25, s24
    v_cvt_pk_bf16_f32 v114, v214, v215
    v_cvt_pk_bf16_f32 v115, v216, v217
    v_mfma_f32_16x16x32_bf16 v[226:229], a[80:83], v[154:157], v[226:229]
    s_mov_b32 s24, s23
    v_mul_f32 v122, v167, v122
    v_mul_f32 v123, v167, v123
    v_mfma_f32_16x16x32_bf16 v[226:229], a[84:87], v[198:201], v[226:229]
    s_waitcnt lgkmcnt(1)
    v_cvt_pk_f16_f32 v244, v122, v123
    v_mul_f32 v124, v167, v124
    v_mfma_f32_16x16x32_bf16 v[226:229], a[88:91], v[210:213], v[226:229]
    v_mul_f32 v125, v167, v125
    v_cvt_pk_f16_f32 v245, v124, v125
    v_mfma_f32_16x16x32_bf16 v[122:125], a[96:99], v[118:121], 0
    s_waitcnt lgkmcnt(0)
    v_mul_f32 v126, v167, v126
    v_mul_f32 v127, v167, v127
    v_mfma_f32_16x16x32_bf16 v[226:229], a[92:95], v[162:165], v[226:229]
    v_cvt_pk_f16_f32 v184, v126, v127
    v_mul_f32 v128, v167, v128
    v_mfma_f32_16x16x32_bf16 v[122:125], a[100:103], v[134:137], v[122:125]
    v_mul_f32 v129, v167, v129
    v_cvt_pk_f16_f32 v185, v128, v129
    v_mfma_f32_16x16x32_bf16 v[122:125], a[104:107], v[154:157], v[122:125]
    v_mul_f32 v206, v166, v206
    v_mul_f32 v207, v166, v207
    v_mfma_f32_16x16x32_bf16 v[122:125], a[108:111], v[198:201], v[122:125]
    v_cvt_pk_f16_f32 v222, v206, v207
    v_mul_f32 v208, v166, v208
    v_mfma_f32_16x16x32_bf16 v[122:125], a[112:115], v[210:213], v[122:125]
    v_mul_f32 v209, v166, v209
    v_cvt_pk_f16_f32 v223, v208, v209
    v_mfma_f32_16x16x32_bf16 v[122:125], a[116:119], v[162:165], v[122:125]
    v_mul_f32 v174, v166, v174
    v_mul_f32 v175, v166, v175
    v_mfma_f32_16x16x32_bf16 v[126:129], a[120:123], v[118:121], 0
    v_cvt_pk_f16_f32 v224, v174, v175
    v_mul_f32 v176, v166, v176
    v_mfma_f32_16x16x32_bf16 v[126:129], a[124:127], v[134:137], v[126:129]
    v_mul_f32 v177, v166, v177
    v_cvt_pk_f16_f32 v225, v176, v177
    v_mfma_f32_16x16x32_bf16 v[126:129], a[128:131], v[154:157], v[126:129]
    v_mul_f32 v218, v166, v218
    v_mul_f32 v219, v166, v219
    v_mfma_f32_16x16x32_bf16 v[126:129], a[132:135], v[198:201], v[126:129]
    v_cvt_pk_f16_f32 v182, v218, v219
    v_mul_f32 v220, v166, v220
    v_mfma_f32_16x16x32_bf16 v[126:129], a[136:139], v[210:213], v[126:129]
    v_mul_f32 v221, v166, v221
    v_cvt_pk_f16_f32 v183, v220, v221
    v_mfma_f32_16x16x32_bf16 v[126:129], a[140:143], v[162:165], v[126:129]
    v_fma_f32 v116, v226, v226, s32
    v_fmac_f32 v116, v227, v227
    v_mfma_f32_16x16x32_bf16 v[206:209], a[0:3], v[118:121], 0
    v_fmac_f32 v116, v228, v228
    v_fmac_f32 v116, v229, v229
    v_mfma_f32_16x16x32_bf16 v[206:209], a[4:7], v[134:137], v[206:209]
    v_fmac_f32 v116, v122, v122
    v_fmac_f32 v116, v123, v123
    v_mfma_f32_16x16x32_bf16 v[206:209], a[8:11], v[154:157], v[206:209]
    v_fmac_f32 v116, v124, v124
    v_fmac_f32 v116, v125, v125
    v_mfma_f32_16x16x32_bf16 v[206:209], a[12:15], v[198:201], v[206:209]
    v_fmac_f32 v116, v126, v126
    v_fmac_f32 v116, v127, v127
    v_mfma_f32_16x16x32_bf16 v[206:209], a[16:19], v[210:213], v[206:209]
    v_fmac_f32 v116, v128, v128
    v_fmac_f32 v116, v129, v129
    v_mfma_f32_16x16x32_bf16 v[206:209], a[20:23], v[162:165], v[206:209]
    v_mul_f32 v117, 0x3baaaaab, v234
    v_mul_f32 v254, 0x3baaaaab, v235
    v_mfma_f32_16x16x32_bf16 v[174:177], a[24:27], v[118:121], 0
    v_rsq_f32 v117, v117
    v_mfma_f32_16x16x32_bf16 v[174:177], a[28:31], v[134:137], v[174:177]
    v_rsq_f32 v254, v254
    v_mfma_f32_16x16x32_bf16 v[174:177], a[32:35], v[154:157], v[174:177]
    v_mul_f32 v255, 0x3baaaaab, v236
    v_fma_f32 v132, v206, v206, s32
    v_mfma_f32_16x16x32_bf16 v[174:177], a[36:39], v[198:201], v[174:177]
    v_fmac_f32 v132, v207, v207
    v_fmac_f32 v132, v208, v208
    v_mfma_f32_16x16x32_bf16 v[174:177], a[40:43], v[210:213], v[174:177]
    v_fmac_f32 v132, v209, v209
    v_mul_f32 v150, v117, v150
    v_mfma_f32_16x16x32_bf16 v[174:177], a[44:47], v[162:165], v[174:177]
    v_rsq_f32 v255, v255
    v_mfma_f32_16x16x32_bf16 v[218:221], a[48:51], v[118:121], 0
    v_mul_f32 v151, v117, v151
    v_cvt_pk_bf16_f32 v194, v150, v151
    v_mfma_f32_16x16x32_bf16 v[218:221], a[52:55], v[134:137], v[218:221]
    v_mul_f32 v152, v117, v152
    v_mul_f32 v153, v117, v153
    v_mfma_f32_16x16x32_bf16 v[218:221], a[56:59], v[154:157], v[218:221]
    v_fmac_f32 v132, v174, v174
    v_fmac_f32 v132, v175, v175
    v_mfma_f32_16x16x32_bf16 v[218:221], a[60:63], v[198:201], v[218:221]
    v_fmac_f32 v132, v176, v176
    v_fmac_f32 v132, v177, v177
    v_mfma_f32_16x16x32_bf16 v[218:221], a[64:67], v[210:213], v[218:221]
    v_cvt_pk_bf16_f32 v195, v152, v153
    v_mul_f32 v190, v117, v190
    v_mfma_f32_16x16x32_bf16 v[218:221], a[68:71], v[162:165], v[218:221]
    v_mul_f32 v191, v117, v191
    v_cvt_pk_bf16_f32 v196, v190, v191
    v_mfma_f32_16x16x32_bf16 v[150:153], v[118:121], a[144:147], 0
    v_mul_f32 v192, v117, v192
    v_mul_f32 v193, v117, v193
    v_mfma_f32_16x16x32_bf16 v[150:153], v[134:137], a[148:151], v[150:153]
    v_cvt_pk_bf16_f32 v197, v192, v193
    v_mul_f32 v202, v117, v202
    v_mfma_f32_16x16x32_bf16 v[150:153], v[154:157], a[152:155], v[150:153]
    buffer_store_dwordx4 v[194:197], v15, s[12:15], 0 offen nt
    v_fmac_f32 v132, v218, v218
    v_fmac_f32 v132, v219, v219
    v_fmac_f32 v132, v220, v220
    v_fmac_f32 v132, v221, v221
    v_mfma_f32_16x16x32_bf16 v[150:153], v[198:201], a[156:159], v[150:153]
    v_cvt_pk_bf16_f32 v36, v132, v116
    v_mul_f32 v203, v117, v203
    v_mfma_f32_16x16x32_bf16 v[150:153], v[210:213], a[160:163], v[150:153]
    v_cvt_pk_bf16_f32 v116, v202, v203
    v_mul_f32 v204, v117, v204
    v_mfma_f32_16x16x32_bf16 v[190:193], v[32:35], v[36:39], 0
    v_mul_f32 v205, v117, v205
    v_cvt_pk_bf16_f32 v117, v204, v205
    v_mfma_f32_16x16x32_bf16 v[150:153], v[162:165], a[164:167], v[150:153]
    v_mul_f32 v146, v255, v146
    v_mul_f32 v147, v255, v147
    v_mfma_f32_16x16x32_bf16 v[202:205], v[118:121], a[168:171], 0
    v_cvt_pk_bf16_f32 v146, v146, v147
    v_mul_f32 v148, v255, v148
    v_mfma_f32_16x16x32_bf16 v[202:205], v[134:137], a[172:175], v[202:205]
    v_rsq_f32 v191, v191
    v_mfma_f32_16x16x32_bf16 v[202:205], v[154:157], a[176:179], v[202:205]
    v_cvt_pk_bf16_f32 v172, v150, v151
    v_cvt_pk_bf16_f32 v173, v152, v153
    v_mfma_f32_16x16x32_bf16 v[202:205], v[198:201], a[180:183], v[202:205]
    v_rsq_f32 v190, v190
    v_mfma_f32_16x16x32_bf16 v[202:205], v[210:213], a[184:187], v[202:205]
    ds_read_b128 v[150:153], v0 offset:32768
    v_mul_f32 v190, s31, v190
    v_mfma_f32_16x16x32_bf16 v[202:205], v[162:165], a[188:191], v[202:205]
    ds_read_b128 v[166:169], v1 offset:32768
    v_mul_f32 v226, v191, v226
    v_mfma_f32_16x16x32_bf16 v[194:197], v[118:121], a[192:195], 0
    ds_read_b128 v[118:121], v0 offset:32896
    v_mul_f32 v227, v191, v227
    v_mfma_f32_16x16x32_bf16 v[194:197], v[134:137], a[196:199], v[194:197]
    ds_read_b128 v[134:137], v1 offset:32896
    v_cvt_pk_f16_f32 v226, v226, v227
    v_mfma_f32_16x16x32_bf16 v[194:197], v[154:157], a[200:203], v[194:197]
    ds_read_b128 v[154:157], v0 offset:33024
    v_cvt_pk_bf16_f32 v132, v202, v203
    v_mfma_f32_16x16x32_bf16 v[194:197], v[198:201], a[204:207], v[194:197]
    ds_read_b128 v[198:201], v1 offset:33024
    v_cvt_pk_bf16_f32 v133, v204, v205
    v_mfma_f32_16x16x32_bf16 v[194:197], v[210:213], a[208:211], v[194:197]
    v_mul_f32 v228, v191, v228
    v_mul_f32 v229, v191, v229
    v_mfma_f32_16x16x32_bf16 v[194:197], v[162:165], a[212:215], v[194:197]
    v_cvt_pk_f16_f32 v227, v228, v229
    v_mul_f32 v122, v191, v122
    v_mfma_f32_16x16x32_f16 v[210:213], v[242:245], v[222:225], v[46:49]
    s_waitcnt lgkmcnt(5)
    buffer_store_dwordx2 v[116:117], v18, s[12:15], 0 offen nt
    v_mul_f32 v123, v191, v123
    v_cvt_pk_f16_f32 v228, v122, v123
    v_mfma_f32_16x16x32_bf16 v[202:205], a[72:75], v[150:153], 0
    s_waitcnt lgkmcnt(3)
    v_cvt_pk_bf16_f32 v116, v194, v195
    v_cvt_pk_bf16_f32 v117, v196, v197
    v_mfma_f32_16x16x32_bf16 v[202:205], a[76:79], v[166:169], v[202:205]
    s_waitcnt lgkmcnt(2)
    v_mul_f32 v124, v191, v124
    v_mul_f32 v125, v191, v125
    v_mfma_f32_16x16x32_bf16 v[202:205], a[80:83], v[118:121], v[202:205]
    s_waitcnt lgkmcnt(1)
    v_cvt_pk_f16_f32 v229, v124, v125
    v_mul_f32 v126, v191, v126
    v_mfma_f32_16x16x32_bf16 v[202:205], a[84:87], v[134:137], v[202:205]
    s_waitcnt lgkmcnt(0)
    v_mul_f32 v127, v191, v127
    v_cvt_pk_f16_f32 v124, v126, v127
    v_mfma_f32_16x16x32_bf16 v[202:205], a[88:91], v[154:157], v[202:205]
    v_mul_f32 v128, v191, v128
    v_mul_f32 v129, v191, v129
    v_mfma_f32_16x16x32_bf16 v[202:205], a[92:95], v[198:201], v[202:205]
    v_cvt_pk_f16_f32 v125, v128, v129
    v_mul_f32 v206, v190, v206
    v_mfma_f32_16x16x32_bf16 v[126:129], a[96:99], v[150:153], 0
    v_mul_f32 v207, v190, v207
    v_cvt_pk_f16_f32 v206, v206, v207
    v_mfma_f32_16x16x32_bf16 v[126:129], a[100:103], v[166:169], v[126:129]
    v_mul_f32 v208, v190, v208
    v_mul_f32 v209, v190, v209
    v_mfma_f32_16x16x32_bf16 v[126:129], a[104:107], v[118:121], v[126:129]
    v_cvt_pk_f16_f32 v207, v208, v209
    v_mul_f32 v174, v190, v174
    v_mfma_f32_16x16x32_bf16 v[126:129], a[108:111], v[134:137], v[126:129]
    v_mul_f32 v175, v190, v175
    v_cvt_pk_f16_f32 v208, v174, v175
    v_mfma_f32_16x16x32_bf16 v[126:129], a[112:115], v[154:157], v[126:129]
    v_mul_f32 v176, v190, v176
    v_mul_f32 v177, v190, v177
    v_mfma_f32_16x16x32_bf16 v[126:129], a[116:119], v[198:201], v[126:129]
    v_cvt_pk_f16_f32 v209, v176, v177
    v_mul_f32 v218, v190, v218
    v_mfma_f32_16x16x32_bf16 v[174:177], a[120:123], v[150:153], 0
    v_mul_f32 v219, v190, v219
    v_cvt_pk_f16_f32 v122, v218, v219
    v_mfma_f32_16x16x32_bf16 v[174:177], a[124:127], v[166:169], v[174:177]
    v_mul_f32 v220, v190, v220
    v_mul_f32 v221, v190, v221
    v_mfma_f32_16x16x32_bf16 v[174:177], a[128:131], v[118:121], v[174:177]
    v_cvt_pk_f16_f32 v123, v220, v221
    v_fma_f32 v162, v202, v202, s32
    v_mfma_f32_16x16x32_bf16 v[174:177], a[132:135], v[134:137], v[174:177]
    v_fmac_f32 v162, v203, v203
    v_fmac_f32 v162, v204, v204
    v_mfma_f32_16x16x32_bf16 v[174:177], a[136:139], v[154:157], v[174:177]
    v_fmac_f32 v162, v205, v205
    v_fmac_f32 v162, v126, v126
    v_mfma_f32_16x16x32_bf16 v[174:177], a[140:143], v[198:201], v[174:177]
    v_fmac_f32 v162, v127, v127
    v_fmac_f32 v162, v128, v128
    v_mfma_f32_16x16x32_bf16 v[190:193], a[0:3], v[150:153], 0
    v_fmac_f32 v162, v129, v129
    v_mul_f32 v149, v255, v149
    v_mfma_f32_16x16x32_bf16 v[190:193], a[4:7], v[166:169], v[190:193]
    v_cvt_pk_bf16_f32 v147, v148, v149
    v_mul_f32 v138, v255, v138
    v_mfma_f32_16x16x32_bf16 v[190:193], a[8:11], v[118:121], v[190:193]
    v_fmac_f32 v162, v174, v174
    v_fmac_f32 v162, v175, v175
    v_mfma_f32_16x16x32_bf16 v[190:193], a[12:15], v[134:137], v[190:193]
    v_fmac_f32 v162, v176, v176
    v_fmac_f32 v162, v177, v177
    v_mfma_f32_16x16x32_bf16 v[190:193], a[16:19], v[154:157], v[190:193]
    v_mul_f32 v139, v255, v139
    v_cvt_pk_bf16_f32 v148, v138, v139
    v_mfma_f32_16x16x32_bf16 v[190:193], a[20:23], v[198:201], v[190:193]
    v_mul_f32 v140, v255, v140
    v_mul_f32 v141, v255, v141
    v_mfma_f32_16x16x32_bf16 v[218:221], a[24:27], v[150:153], 0
    v_cvt_pk_bf16_f32 v149, v140, v141
    v_mul_f32 v186, v255, v186
    v_mfma_f32_16x16x32_bf16 v[218:221], a[28:31], v[166:169], v[218:221]
    buffer_store_dwordx4 v[146:149], v17, s[12:15], 0 offen nt
    v_mul_f32 v187, v255, v187
    v_fma_f32 v163, v190, v190, s32
    v_fmac_f32 v163, v191, v191
    v_fmac_f32 v163, v192, v192
    v_mfma_f32_16x16x32_bf16 v[218:221], a[32:35], v[118:121], v[218:221]
    v_fmac_f32 v163, v193, v193
    v_cvt_pk_bf16_f32 v164, v186, v187
    v_mfma_f32_16x16x32_bf16 v[218:221], a[36:39], v[134:137], v[218:221]
    v_mul_f32 v188, v255, v188
    v_mul_f32 v189, v255, v189
    v_mfma_f32_16x16x32_bf16 v[218:221], a[40:43], v[154:157], v[218:221]
    v_cvt_pk_bf16_f32 v165, v188, v189
    v_mul_f32 v142, v254, v142
    v_mfma_f32_16x16x32_bf16 v[218:221], a[44:47], v[198:201], v[218:221]
    v_mul_f32 v143, v254, v143
    v_cvt_pk_bf16_f32 v142, v142, v143
    v_mfma_f32_16x16x32_bf16 v[138:141], a[48:51], v[150:153], 0
    v_mul_f32 v144, v254, v144
    v_mul_f32 v145, v254, v145
    v_mfma_f32_16x16x32_bf16 v[138:141], a[52:55], v[166:169], v[138:141]
    v_cvt_pk_bf16_f32 v143, v144, v145
    v_mul_f32 v158, v254, v158
    v_mfma_f32_16x16x32_bf16 v[138:141], a[56:59], v[118:121], v[138:141]
    v_fmac_f32 v163, v218, v218
    v_fmac_f32 v163, v219, v219
    v_mfma_f32_16x16x32_bf16 v[138:141], a[60:63], v[134:137], v[138:141]
    ds_read2_b32 v[196:197], v6 offset0:0 offset1:0
    ds_read2_b32 v[216:217], v6 offset0:16 offset1:16
    v_mfma_f32_16x16x32_bf16 v[138:141], a[64:67], v[154:157], v[138:141]
    ds_read2_b32 v[232:233], v6 offset0:32 offset1:32
    v_fmac_f32 v163, v220, v220
    v_mfma_f32_16x16x32_bf16 v[138:141], a[68:71], v[198:201], v[138:141]
    v_fmac_f32 v163, v221, v221
    v_mul_f32 v159, v254, v159
    v_mfma_f32_16x16x32_bf16 v[146:149], v[150:153], a[144:147], 0
    v_cvt_pk_bf16_f32 v144, v158, v159
    v_mul_f32 v160, v254, v160
    v_mfma_f32_16x16x32_bf16 v[146:149], v[166:169], a[148:151], v[146:149]
    v_mul_f32 v161, v254, v161
    v_cvt_pk_bf16_f32 v145, v160, v161
    v_mfma_f32_16x16x32_bf16 v[146:149], v[118:121], a[152:155], v[146:149]
    v_fmac_f32 v163, v138, v138
    v_fmac_f32 v163, v139, v139
    v_mfma_f32_16x16x32_bf16 v[146:149], v[134:137], a[156:159], v[146:149]
    v_fmac_f32 v163, v140, v140
    v_fmac_f32 v163, v141, v141
    v_mfma_f32_16x16x32_bf16 v[146:149], v[154:157], a[160:163], v[146:149]
    v_cvt_pk_bf16_f32 v36, v163, v162
    v_mul_f32 v178, v254, v178
    v_mfma_f32_16x16x32_bf16 v[146:149], v[198:201], a[164:167], v[146:149]
    s_waitcnt lgkmcnt(1)
    v_mul_f32 v179, v254, v179
    v_cvt_pk_bf16_f32 v178, v178, v179
    v_mfma_f32_16x16x32_bf16 v[158:161], v[32:35], v[36:39], 0
    s_waitcnt lgkmcnt(0)
    buffer_store_dwordx2 v[164:165], v20, s[12:15], 0 offen nt
    v_mul_f32 v180, v254, v180
    v_mul_f32 v181, v254, v181
    v_mfma_f32_16x16x32_bf16 v[186:189], v[150:153], a[168:171], 0
    v_cvt_pk_bf16_f32 v194, v146, v147
    v_cvt_pk_bf16_f32 v195, v148, v149
    v_mfma_f32_16x16x32_bf16 v[186:189], v[166:169], a[172:175], v[186:189]
    v_rsq_f32 v159, v159
    v_mfma_f32_16x16x32_bf16 v[186:189], v[118:121], a[176:179], v[186:189]
    v_rsq_f32 v158, v158
    v_mfma_f32_16x16x32_bf16 v[186:189], v[134:137], a[180:183], v[186:189]
    v_mul_f32 v158, s31, v158
    v_mul_f32 v202, v159, v202
    v_mfma_f32_16x16x32_bf16 v[186:189], v[154:157], a[184:187], v[186:189]
    v_mul_f32 v203, v159, v203
    v_cvt_pk_f16_f32 v146, v202, v203
    v_mfma_f32_16x16x32_bf16 v[186:189], v[198:201], a[188:191], v[186:189]
    v_mul_f32 v204, v159, v204
    v_mul_f32 v205, v159, v205
    v_mfma_f32_16x16x32_bf16 v[162:165], v[150:153], a[192:195], 0
    v_cvt_pk_f16_f32 v147, v204, v205
    v_mul_f32 v126, v159, v126
    v_mfma_f32_16x16x32_bf16 v[162:165], v[166:169], a[196:199], v[162:165]
    ds_read_b128 v[150:153], v5 offset:0
    ds_read_b128 v[202:205], v5 offset:16
    v_mfma_f32_16x16x32_bf16 v[162:165], v[118:121], a[200:203], v[162:165]
    ds_read_b128 v[118:121], v5 offset:48
    ds_read_b32 v254, v6 offset:192
    v_mfma_f32_16x16x32_bf16 v[162:165], v[134:137], a[204:207], v[162:165]
    v_cvt_pk_bf16_f32 v214, v186, v187
    v_cvt_pk_bf16_f32 v215, v188, v189
    v_mfma_f32_16x16x32_bf16 v[162:165], v[154:157], a[208:211], v[162:165]
    v_mul_f32 v127, v159, v127
    v_cvt_pk_f16_f32 v148, v126, v127
    v_mfma_f32_16x16x32_bf16 v[162:165], v[198:201], a[212:215], v[162:165]
    ds_read_b128 v[198:201], v2 offset:0
    ds_read_b128 v[186:189], v2 offset:1024
    v_mfma_f32_16x16x32_f16 v[134:137], v[226:229], v[222:225], v[50:53]
    ds_read_b128 v[154:157], v2 offset:2048
    v_mul_f32 v128, v159, v128
    v_mul_f32 v129, v159, v129
    v_mfma_f32_16x16x16_f16 v[210:213], v[184:185], v[182:183], v[210:213]
    v_cvt_pk_f16_f32 v149, v128, v129
    v_cvt_pk_bf16_f32 v230, v162, v163
    v_cvt_pk_bf16_f32 v231, v164, v165
    v_mul_f32 v174, v159, v174
    v_mfma_f32_16x16x32_f16 v[126:129], v[146:149], v[222:225], v[54:57]
    s_waitcnt lgkmcnt(5)
    v_mul_f32 v175, v159, v175
    v_cvt_pk_f16_f32 v164, v174, v175
    v_mul_f32 v176, v159, v176
    v_mfma_f32_16x16x16_f16 v[134:137], v[124:125], v[182:183], v[134:137]
    v_mul_f32 v177, v159, v177
    v_cvt_pk_f16_f32 v165, v176, v177
    v_mul_f32 v190, v158, v190
    v_mul_f32 v191, v158, v191
    v_mfma_f32_16x16x16_f16 v[126:129], v[164:165], v[182:183], v[126:129]
    v_cvt_pk_f16_f32 v174, v190, v191
    v_mul_f32 v192, v158, v192
    v_mul_f32 v193, v158, v193
    v_cvt_pk_f16_f32 v175, v192, v193
    v_mfma_f32_16x16x32_f16 v[166:169], v[150:153], v[222:225], v[22:25]
    s_waitcnt lgkmcnt(2)
    ds_read_b128 v[222:225], v2 offset:3072
    buffer_store_dwordx4 v[142:145], v16, s[12:15], 0 offen nt
    ds_read_b128 v[234:237], v2 offset:4096
    v_mul_f32 v218, v158, v218
    v_mul_f32 v219, v158, v219
    v_cvt_pk_f16_f32 v176, v218, v219
    v_mfma_f32_16x16x32_f16 v[166:169], v[202:205], v[242:245], v[166:169]
    s_waitcnt lgkmcnt(2)
    v_mul_f32 v220, v158, v220
    v_mul_f32 v221, v158, v221
    v_mfma_f32_16x16x32_f16 v[166:169], v[118:121], v[182:185], v[166:169]
    ds_read_b128 v[142:145], v2 offset:5120
    v_cvt_pk_f16_f32 v177, v220, v221
    v_mul_f32 v138, v158, v138
    v_mul_f32 v139, v158, v139
    v_cvt_pk_f16_f32 v162, v138, v139
    v_mfma_f32_16x16x32_f16 v[218:221], v[150:153], v[206:209], v[24:27]
    v_mul_f32 v140, v158, v140
    v_mul_f32 v141, v158, v141
    v_mfma_f32_16x16x32_f16 v[218:221], v[202:205], v[226:229], v[218:221]
    v_mov_b32_dpp v254, v167 quad_perm:[0,1,2,3] row_mask:0x1 bank_mask:0xf
    v_cvt_pk_f16_f32 v163, v140, v141
    v_mfma_f32_16x16x32_f16 v[218:221], v[118:121], v[122:125], v[218:221]
    v_max3_f32 v255, v166, v210, v211
    v_max3_f32 v255, v255, v212, v213
    v_mfma_f32_16x16x32_f16 v[238:241], v[150:153], v[174:177], v[26:29]
    s_waitcnt lgkmcnt(1)
    v_max3_f32 v255, v255, v134, v135
    v_max3_f32 v255, v255, v136, v137
    v_mfma_f32_16x16x32_f16 v[238:241], v[202:205], v[146:149], v[238:241]
    v_max3_f32 v255, v255, v126, v127
    v_mov_b32_dpp v254, v219 quad_perm:[0,1,2,3] row_mask:0x2 bank_mask:0xf
    v_mfma_f32_16x16x32_f16 v[238:241], v[118:121], v[162:165], v[238:241]
    v_max3_f32 v255, v255, v128, v129
    v_mov_b32 v182, v255
    v_mfma_f32_16x16x32_bf16 v[150:153], a[216:219], v[198:201], 0
    s_waitcnt lgkmcnt(0)
    v_permlane32_swap_b32 v255, v182
    v_mfma_f32_16x16x32_bf16 v[150:153], a[220:223], v[186:189], v[150:153]
    v_max_f32 v255, v255, v182
    v_mov_b32 v182, v255
    v_mfma_f32_16x16x32_bf16 v[150:153], a[224:227], v[154:157], v[150:153]
    v_cvt_pk_bf16_f32 v179, v180, v181
    v_xor_b32 v0, 65536, v0
    v_mfma_f32_16x16x32_bf16 v[150:153], a[228:231], v[222:225], v[150:153]
    s_waitcnt vmcnt(5)
    v_permlane16_swap_b32 v255, v182
    v_mfma_f32_16x16x32_bf16 v[150:153], a[232:235], v[234:237], v[150:153]
    s_nop 0
    v_max_f32 v255, v255, v182
    v_sub_f32 v210, v210, v255
    v_mfma_f32_16x16x32_bf16 v[150:153], a[236:239], v[142:145], v[150:153]
    s_nop 0
    v_exp_f32 v210, v210
    v_mfma_f32_16x16x32_bf16 v[190:193], a[240:243], v[198:201], 0
    s_barrier
    v_sub_f32 v211, v211, v255
    v_sub_f32 v212, v212, v255
    v_mfma_f32_16x16x32_bf16 v[190:193], a[244:247], v[186:189], v[190:193]
    s_nop 0
    buffer_load_dwordx4 v10, s[8:11], 0 offen nt lds
    v_sub_f32 v213, v213, v255
    v_mfma_f32_16x16x32_bf16 v[190:193], a[248:251], v[154:157], v[190:193]
    s_add_u32 m0, s28, 4096
    v_exp_f32 v211, v211
    v_mfma_f32_16x16x32_bf16 v[190:193], a[252:255], v[222:225], v[190:193]
    v_cvt_pk_bf16_f32 v158, v210, v211
    v_sub_f32 v134, v134, v255
    v_mfma_f32_16x16x32_bf16 v[190:193], v[82:85], v[234:237], v[190:193]
    v_exp_f32 v212, v212
    v_mfma_f32_16x16x32_bf16 v[190:193], v[86:89], v[142:145], v[190:193]
    v_exp_f32 v213, v213
    v_mfma_f32_16x16x32_bf16 v[202:205], v[90:93], v[198:201], 0
    ds_read_b128 v[198:201], v2 offset:6144
    buffer_load_dwordx4 v11, s[8:11], 0 offen nt lds
    v_mfma_f32_16x16x32_bf16 v[202:205], v[94:97], v[186:189], v[202:205]
    s_add_u32 m0, s28, 8192
    ds_read_b128 v[138:141], v2 offset:7168
    v_cvt_pk_bf16_f32 v159, v212, v213
    v_mfma_f32_16x16x32_bf16 v[202:205], v[98:101], v[154:157], v[202:205]
    ds_read_b128 v[210:213], v2 offset:8192
    v_sub_f32 v135, v135, v255
    v_mfma_f32_16x16x32_bf16 v[202:205], v[102:105], v[222:225], v[202:205]
    ds_read_b128 v[186:189], v2 offset:9216
    v_sub_f32 v136, v136, v255
    v_mfma_f32_16x16x32_bf16 v[202:205], v[106:109], v[234:237], v[202:205]
    ds_read_b128 v[222:225], v2 offset:10240
    v_sub_f32 v137, v137, v255
    v_mfma_f32_16x16x32_bf16 v[202:205], v[110:113], v[142:145], v[202:205]
    ds_read_b128 v[154:157], v2 offset:11264
    buffer_load_dwordx4 v12, s[8:11], 0 offen nt lds
    v_exp_f32 v134, v134
    v_mfma_f32_16x16x32_f16 v[118:121], v[242:245], v[206:209], v[58:61]
    s_add_u32 m0, s28, 12288
    v_exp_f32 v135, v135
    v_exp_f32 v136, v136
    v_cvt_pk_bf16_f32 v160, v134, v135
    v_exp_f32 v137, v137
    v_sub_f32 v126, v126, v255
    v_mfma_f32_16x16x16_f16 v[118:121], v[184:185], v[122:123], v[118:121]
    v_cvt_pk_bf16_f32 v161, v136, v137
    v_exp_f32 v126, v126
    v_sub_f32 v127, v127, v255
    v_mfma_f32_16x16x32_f16 v[134:137], v[226:229], v[206:209], v[62:65]
    s_xor_b32 s28, s28, 65536
    buffer_load_dwordx4 v13, s[8:11], 0 offen nt lds
    v_exp_f32 v127, v127
    v_sub_f32 v128, v128, v255
    v_cvt_pk_bf16_f32 v36, v126, v127
    v_exp_f32 v128, v128
    v_mfma_f32_16x16x16_f16 v[134:137], v[124:125], v[122:123], v[134:137]
    v_sub_f32 v129, v129, v255
    v_exp_f32 v129, v129
    v_sub_f32 v166, v166, v255
    v_cvt_pk_bf16_f32 v37, v128, v129
    v_mfma_f32_16x16x32_f16 v[126:129], v[146:149], v[206:209], v[66:69]
    s_waitcnt lgkmcnt(0)
    v_exp_f32 v166, v166
    v_mfma_f32_16x16x32_bf16 v[142:145], a[216:219], v[198:201], 0
    s_mov_b32 m0, s29
    v_cvt_pk_bf16_f32 v39, v166, 0
    v_max3_f32 v255, v218, v118, v119
    v_max3_f32 v255, v255, v120, v121
    v_mfma_f32_16x16x16_f16 v[126:129], v[164:165], v[122:123], v[126:129]
    v_max3_f32 v255, v255, v134, v135
    v_max3_f32 v255, v255, v136, v137
    v_xor_b32 v1, 65536, v1
    v_mov_b32_dpp v254, v239 quad_perm:[0,1,2,3] row_mask:0x4 bank_mask:0xf
    v_mfma_f32_16x16x32_bf16 v[206:209], v[28:31], v[36:39], 0
    s_xor_b32 s29, s29, s30
    buffer_store_dwordx2 v[178:179], v19, s[12:15], 0 offen nt
    v_mov_b32 v122, v254
    v_max3_f32 v255, v255, v126, v127
    v_mfma_f32_16x16x32_bf16 v[206:209], v[28:31], v[158:161], v[206:209]
    s_add_u32 s19, s19, s20
    v_max3_f32 v255, v255, v128, v129
    v_mov_b32 v123, v255
    v_mfma_f32_16x16x32_bf16 v[142:145], a[220:223], v[138:141], v[142:145]
    s_add_u32 s23, s23, s21
    v_permlane32_swap_b32 v255, v123
    v_mfma_f32_16x16x32_bf16 v[142:145], a[224:227], v[210:213], v[142:145]
    s_cmp_ge_u32 s19, 72
    v_rcp_f32 v206, v206
    v_mfma_f32_16x16x32_bf16 v[142:145], a[228:231], v[186:189], v[142:145]
    s_cselect_b32 s34, 72, 0
    v_max_f32 v255, v255, v123
    v_mov_b32 v123, v255
    v_mfma_f32_16x16x32_bf16 v[142:145], a[232:235], v[222:225], v[142:145]
    s_cselect_b32 s35, s22, 0
    v_permlane16_swap_b32 v255, v123
    v_mfma_f32_16x16x32_bf16 v[142:145], a[236:239], v[154:157], v[142:145]
    s_sub_u32 s19, s19, s34
    v_max_f32 v255, v255, v123
    v_sub_f32 v118, v118, v255
    v_mfma_f32_16x16x32_bf16 v[178:181], v[194:197], v[36:39], 0
    s_add_u32 s23, s23, s35
    v_exp_f32 v118, v118
    v_mfma_f32_16x16x32_bf16 v[178:181], v[170:173], v[158:161], v[178:181]
    s_add_u32 s18, s18, 1
    v_sub_f32 v119, v119, v255
    v_exp_f32 v119, v119
    v_sub_f32 v120, v120, v255
    v_cvt_pk_bf16_f32 v118, v118, v119
    v_exp_f32 v120, v120
    v_sub_f32 v121, v121, v255
    v_exp_f32 v121, v121
    v_mul_f32 v178, v206, v178
    v_mul_f32 v179, v206, v179
    v_cvt_pk_bf16_f32 v178, v178, v179
    v_mul_f32 v180, v206, v180
    v_mul_f32 v181, v206, v181
    v_cvt_pk_bf16_f32 v179, v180, v181
    v_cvt_pk_bf16_f32 v119, v120, v121
    v_mfma_f32_16x16x32_bf16 v[166:169], v[214:217], v[36:39], 0
    s_cmp_lt_u32 s18, s17
    v_sub_f32 v134, v134, v255
    v_sub_f32 v135, v135, v255
    v_mfma_f32_16x16x32_bf16 v[166:169], v[130:133], v[158:161], v[166:169]
    v_exp_f32 v134, v134
    v_exp_f32 v135, v135
    v_sub_f32 v136, v136, v255
    v_cvt_pk_bf16_f32 v120, v134, v135
    v_exp_f32 v136, v136
    v_sub_f32 v137, v137, v255
    v_exp_f32 v137, v137
    v_sub_f32 v126, v126, v255
    v_mul_f32 v166, v206, v166
    v_mul_f32 v167, v206, v167
    v_cvt_pk_bf16_f32 v180, v166, v167
    v_mul_f32 v168, v206, v168
    v_mul_f32 v169, v206, v169
    v_cvt_pk_bf16_f32 v181, v168, v169
    v_cvt_pk_bf16_f32 v121, v136, v137
    v_mfma_f32_16x16x32_bf16 v[134:137], v[230:233], v[36:39], 0
    buffer_load_dwordx4 v14, s[8:11], 0 offen nt lds
    v_sub_f32 v127, v127, v255
    v_mfma_f32_16x16x32_bf16 v[134:137], v[114:117], v[158:161], v[134:137]
    ds_write_b128 v3, v[178:181] offset:0
    v_mfma_f32_16x16x32_bf16 v[158:161], a[240:243], v[198:201], 0
    v_exp_f32 v126, v126
    v_mfma_f32_16x16x32_bf16 v[158:161], a[244:247], v[138:141], v[158:161]
    v_exp_f32 v127, v127
    v_mfma_f32_16x16x32_bf16 v[158:161], a[248:251], v[210:213], v[158:161]
    v_cvt_pk_bf16_f32 v36, v126, v127
    v_sub_f32 v128, v128, v255
    v_mfma_f32_16x16x32_bf16 v[158:161], a[252:255], v[186:189], v[158:161]
    v_mul_f32 v134, v206, v134
    v_mul_f32 v135, v206, v135
    v_mfma_f32_16x16x32_bf16 v[158:161], v[82:85], v[222:225], v[158:161]
    v_cvt_pk_bf16_f32 v126, v134, v135
    v_mul_f32 v136, v206, v136
    v_mfma_f32_16x16x32_bf16 v[158:161], v[86:89], v[154:157], v[158:161]
    v_mul_f32 v137, v206, v137
    v_cvt_pk_bf16_f32 v127, v136, v137
    v_mfma_f32_16x16x32_bf16 v[178:181], v[90:93], v[198:201], 0
    ds_read_b128 v[198:201], v2 offset:12288
    v_sub_f32 v129, v129, v255
    v_mfma_f32_16x16x32_bf16 v[178:181], v[94:97], v[138:141], v[178:181]
    ds_read_b128 v[206:209], v2 offset:13312
    v_sub_f32 v218, v218, v255
    v_mfma_f32_16x16x32_bf16 v[178:181], v[98:101], v[210:213], v[178:181]
    ds_read_b128 v[210:213], v2 offset:14336
    v_max_f32_dpp v122, v122, v122 quad_perm:[1,0,3,2] row_mask:0xf bank_mask:0xf
    v_mfma_f32_16x16x32_bf16 v[178:181], v[102:105], v[186:189], v[178:181]
    ds_read_b128 v[134:137], v2 offset:15360
    v_max_f32_dpp v122, v122, v122 quad_perm:[2,3,0,1] row_mask:0xf bank_mask:0xf
    v_mfma_f32_16x16x32_bf16 v[178:181], v[106:109], v[222:225], v[178:181]
    ds_read_b128 v[222:225], v2 offset:16384
    v_max_f32_dpp v122, v122, v122 row_half_mirror row_mask:0xf bank_mask:0xf
    v_mfma_f32_16x16x32_bf16 v[178:181], v[110:113], v[154:157], v[178:181]
    ds_read_b128 v[154:157], v2 offset:17408
    ds_write_b64 v4, v[126:127] offset:4096
    v_exp_f32 v128, v128
    v_exp_f32 v129, v129
    v_mfma_f32_16x16x32_f16 v[186:189], v[242:245], v[174:177], v[70:73]
    s_waitcnt lgkmcnt(6)
    v_cvt_pk_bf16_f32 v37, v128, v129
    v_max_f32_dpp v122, v122, v122 row_mirror row_mask:0xf bank_mask:0xf
    v_mfma_f32_16x16x32_f16 v[242:245], v[226:229], v[174:177], v[74:77]
    s_waitcnt lgkmcnt(5)
    v_exp_f32 v218, v218
    v_mfma_f32_16x16x32_f16 v[126:129], v[146:149], v[174:177], v[78:81]
    s_waitcnt lgkmcnt(4)
    v_cvt_pk_bf16_f32 v39, v218, 0
    v_mov_b32 v123, v122
    v_fma_f32 v255, v150, v150, s33
    v_mfma_f32_16x16x32_bf16 v[174:177], v[28:31], v[36:39], 0
    s_waitcnt lgkmcnt(3)
    v_permlane32_swap_b32 v122, v123
    v_mfma_f32_16x16x32_bf16 v[174:177], v[28:31], v[118:121], v[174:177]
    s_waitcnt lgkmcnt(2)
    v_max_f32 v122, v122, v123
    v_mov_b32 v123, v122
    v_mfma_f32_16x16x32_bf16 v[226:229], v[194:197], v[36:39], 0
    s_waitcnt lgkmcnt(0)
    v_permlane16_swap_b32 v122, v123
    v_mfma_f32_16x16x32_bf16 v[226:229], v[170:173], v[118:121], v[226:229]
    v_max_f32 v122, v122, v123
    v_sub_f32 v254, v254, v122
    v_mfma_f32_16x16x32_bf16 v[218:221], v[214:217], v[36:39], 0
    v_exp_f32 v254, v254
    v_mfma_f32_16x16x32_bf16 v[218:221], v[130:133], v[118:121], v[218:221]
    v_cvt_pk_bf16_f32 v254, v254, v254
    v_fmac_f32 v255, v151, v151
    v_mfma_f32_16x16x32_bf16 v[166:169], v[230:233], v[36:39], 0
    ds_write_b16 v8, v254
    v_mfma_f32_16x16x32_bf16 v[166:169], v[114:117], v[118:121], v[166:169]
    v_rcp_f32 v174, v174
    v_fmac_f32 v255, v152, v152
    v_mfma_f32_16x16x16_f16 v[186:189], v[184:185], v[162:163], v[186:189]
    v_mul_f32 v226, v174, v226
    v_mul_f32 v227, v174, v227
    v_cvt_pk_bf16_f32 v122, v226, v227
    v_mfma_f32_16x16x16_f16 v[242:245], v[124:125], v[162:163], v[242:245]
    v_mul_f32 v228, v174, v228
    v_mul_f32 v229, v174, v229
    v_cvt_pk_bf16_f32 v123, v228, v229
    v_mfma_f32_16x16x16_f16 v[126:129], v[164:165], v[162:163], v[126:129]
    v_max3_f32 v254, v238, v186, v187
    v_max3_f32 v254, v254, v188, v189
    v_mul_f32 v218, v174, v218
    v_mul_f32 v219, v174, v219
    v_mfma_f32_16x16x32_bf16 v[146:149], a[216:219], v[198:201], 0
    ds_read_b128 v[118:121], v9
    ds_read_b128 v[162:165], v9 offset:64
    v_mfma_f32_16x16x32_bf16 v[146:149], a[220:223], v[206:209], v[146:149]
    v_max3_f32 v254, v254, v242, v243
    v_max3_f32 v254, v254, v244, v245
    v_mfma_f32_16x16x32_bf16 v[146:149], a[224:227], v[210:213], v[146:149]
    v_max3_f32 v254, v254, v126, v127
    v_max3_f32 v254, v254, v128, v129
    v_mfma_f32_16x16x32_bf16 v[146:149], a[228:231], v[134:137], v[146:149]
    v_mov_b32 v125, v254
    v_cvt_pk_bf16_f32 v124, v218, v219
    v_mfma_f32_16x16x32_bf16 v[146:149], a[232:235], v[222:225], v[146:149]
    v_permlane32_swap_b32 v254, v125
    v_mfma_f32_16x16x32_bf16 v[146:149], a[236:239], v[154:157], v[146:149]
    v_max_f32 v254, v254, v125
    v_mov_b32 v125, v254
    v_mfma_f32_16x16x32_bf16 v[138:141], a[240:243], v[198:201], 0
    v_mul_f32 v220, v174, v220
    v_mul_f32 v221, v174, v221
    v_mfma_f32_16x16x32_bf16 v[138:141], a[244:247], v[206:209], v[138:141]
    v_permlane16_swap_b32 v254, v125
    v_mfma_f32_16x16x32_bf16 v[138:141], a[248:251], v[210:213], v[138:141]
    s_waitcnt lgkmcnt(0)
    v_max_f32 v254, v254, v125
    v_sub_f32 v186, v186, v254
    v_mfma_f32_16x16x32_bf16 v[138:141], a[252:255], v[134:137], v[138:141]
    v_exp_f32 v186, v186
    v_mfma_f32_16x16x32_bf16 v[138:141], v[82:85], v[222:225], v[138:141]
    v_sub_f32 v187, v187, v254
    v_sub_f32 v188, v188, v254
    v_mfma_f32_16x16x32_bf16 v[138:141], v[86:89], v[154:157], v[138:141]
    v_exp_f32 v187, v187
    v_exp_f32 v188, v188
    v_cvt_pk_bf16_f32 v234, v186, v187
    v_sub_f32 v189, v189, v254
    v_exp_f32 v189, v189
    v_sub_f32 v242, v242, v254
    v_cvt_pk_bf16_f32 v235, v188, v189
    v_exp_f32 v242, v242
    v_sub_f32 v243, v243, v254
    v_exp_f32 v243, v243
    v_sub_f32 v244, v244, v254
    v_cvt_pk_bf16_f32 v236, v242, v243
    v_mfma_f32_16x16x32_bf16 v[186:189], v[90:93], v[198:201], 0
    v_exp_f32 v244, v244
    v_mfma_f32_16x16x32_bf16 v[186:189], v[94:97], v[206:209], v[186:189]
    v_sub_f32 v245, v245, v254
    v_sub_f32 v126, v126, v254
    v_mfma_f32_16x16x32_bf16 v[186:189], v[98:101], v[210:213], v[186:189]
    v_exp_f32 v245, v245
    v_mfma_f32_16x16x32_bf16 v[186:189], v[102:105], v[134:137], v[186:189]
    v_cvt_pk_bf16_f32 v237, v244, v245
    v_sub_f32 v127, v127, v254
    v_mfma_f32_16x16x32_bf16 v[186:189], v[106:109], v[222:225], v[186:189]
    v_exp_f32 v126, v126
    v_mfma_f32_16x16x32_bf16 v[186:189], v[110:113], v[154:157], v[186:189]
    ds_read_b128 v[182:185], v0 offset:20480
    ds_read_b128 v[198:201], v1 offset:20480
    v_mfma_f32_16x16x32_bf16 v[206:209], v[118:121], v[28:31], 0
    ds_read_b128 v[210:213], v0 offset:20608
    ds_read_b128 v[222:225], v1 offset:20608
    v_mfma_f32_16x16x32_bf16 v[206:209], v[162:165], v[28:31], v[206:209]
    v_exp_f32 v127, v127
    v_mfma_f32_16x16x32_bf16 v[154:157], v[118:121], v[170:173], 0
    ds_read_b128 v[226:229], v0 offset:20736
    v_cvt_pk_bf16_f32 v36, v126, v127
    v_mfma_f32_16x16x32_bf16 v[154:157], v[162:165], v[194:197], v[154:157]
    ds_read_b128 v[242:245], v1 offset:20736
    v_sub_f32 v128, v128, v254
    v_exp_f32 v128, v128
    v_sub_f32 v129, v129, v254
    v_exp_f32 v129, v129
    v_sub_f32 v238, v238, v254
    v_cvt_pk_bf16_f32 v37, v128, v129
    v_mfma_f32_16x16x32_bf16 v[134:137], v[118:121], v[130:133], 0
    v_exp_f32 v238, v238
    v_mfma_f32_16x16x32_bf16 v[134:137], v[162:165], v[214:217], v[134:137]
    s_waitcnt lgkmcnt(4)
    v_cvt_pk_bf16_f32 v39, v238, 0
    v_cvt_pk_bf16_f32 v125, v220, v221
    v_mfma_f32_16x16x32_bf16 v[218:221], v[118:121], v[114:117], 0
    s_waitcnt lgkmcnt(2)
    ds_write_b128 v3, v[122:125] offset:6144
    v_mfma_f32_16x16x32_bf16 v[126:129], v[28:31], v[36:39], 0
    s_waitcnt lgkmcnt(2)
    v_mul_f32 v166, v174, v166
    v_mul_f32 v167, v174, v167
    v_mfma_f32_16x16x32_bf16 v[126:129], v[28:31], v[234:237], v[126:129]
    s_waitcnt lgkmcnt(1)
    v_cvt_pk_bf16_f32 v166, v166, v167
    v_mul_f32 v168, v174, v168
    v_mfma_f32_16x16x32_bf16 v[122:125], v[194:197], v[36:39], 0
    v_mul_f32 v169, v174, v169
    v_cvt_pk_bf16_f32 v167, v168, v169
    v_mfma_f32_16x16x32_bf16 v[122:125], v[170:173], v[234:237], v[122:125]
    ds_write_b64 v4, v[166:167] offset:10240
    v_mfma_f32_16x16x32_bf16 v[170:173], v[214:217], v[36:39], 0
    v_rcp_f32 v126, v126
    v_mfma_f32_16x16x32_bf16 v[170:173], v[130:133], v[234:237], v[170:173]
    v_fma_f32 v254, v146, v146, s33
    v_fmac_f32 v254, v147, v147
    v_mfma_f32_16x16x32_bf16 v[174:177], v[230:233], v[36:39], 0
    v_fmac_f32 v254, v148, v148
    v_mul_f32 v122, v126, v122
    v_mfma_f32_16x16x32_bf16 v[174:177], v[114:117], v[234:237], v[174:177]
    v_mul_f32 v123, v126, v123
    v_cvt_pk_bf16_f32 v122, v122, v123
    v_mfma_f32_16x16x32_bf16 v[218:221], v[162:165], v[230:233], v[218:221]
    v_mul_f32 v124, v126, v124
    v_mul_f32 v125, v126, v125
    v_mfma_f32_16x16x32_bf16 v[114:117], a[72:75], v[182:185], 0
    v_cvt_pk_bf16_f32 v123, v124, v125
    v_mul_f32 v170, v126, v170
    v_mfma_f32_16x16x32_bf16 v[114:117], a[76:79], v[198:201], v[114:117]
    v_mul_f32 v171, v126, v171
    v_cvt_pk_bf16_f32 v124, v170, v171
    v_mfma_f32_16x16x32_bf16 v[114:117], a[80:83], v[210:213], v[114:117]
    v_mul_f32 v172, v126, v172
    v_mul_f32 v173, v126, v173
    v_mfma_f32_16x16x32_bf16 v[114:117], a[84:87], v[222:225], v[114:117]
    v_cvt_pk_bf16_f32 v125, v172, v173
    v_mul_f32 v174, v126, v174
    v_mfma_f32_16x16x32_bf16 v[114:117], a[88:91], v[226:229], v[114:117]
    ds_write_b128 v3, v[122:125] offset:12288
    v_mfma_f32_16x16x32_bf16 v[114:117], a[92:95], v[242:245], v[114:117]
    v_mul_f32 v175, v126, v175
    v_cvt_pk_bf16_f32 v174, v174, v175
    v_mfma_f32_16x16x32_bf16 v[122:125], a[96:99], v[182:185], 0
    v_mul_f32 v176, v126, v176
    v_mul_f32 v177, v126, v177
    v_mfma_f32_16x16x32_bf16 v[122:125], a[100:103], v[198:201], v[122:125]
    v_cvt_pk_bf16_f32 v175, v176, v177
    v_fmac_f32 v254, v149, v149
    v_mfma_f32_16x16x32_bf16 v[122:125], a[104:107], v[210:213], v[122:125]
    ds_write_b64 v4, v[174:175] offset:16384
    v_mfma_f32_16x16x32_bf16 v[122:125], a[108:111], v[222:225], v[122:125]
    v_fmac_f32 v254, v138, v138
    v_fmac_f32 v254, v139, v139
    v_mfma_f32_16x16x32_bf16 v[122:125], a[112:115], v[226:229], v[122:125]
    v_fmac_f32 v254, v140, v140
    v_fmac_f32 v254, v141, v141
    v_mfma_f32_16x16x32_bf16 v[122:125], a[116:119], v[242:245], v[122:125]
    v_fmac_f32 v254, v186, v186
    v_fmac_f32 v254, v187, v187
    v_mfma_f32_16x16x32_bf16 v[126:129], a[120:123], v[182:185], 0
    v_fmac_f32 v254, v188, v188
    v_fmac_f32 v254, v189, v189
    v_mfma_f32_16x16x32_bf16 v[126:129], a[124:127], v[198:201], v[126:129]
    v_cvt_pk_bf16_f32 v155, v254, v254
    v_fmac_f32 v255, v153, v153
    v_mfma_f32_16x16x32_bf16 v[126:129], a[128:131], v[210:213], v[126:129]
    v_rcp_f32 v206, v206
    v_mfma_f32_16x16x32_bf16 v[126:129], a[132:135], v[222:225], v[126:129]
    v_mul_f32 v154, v154, v206
    v_mul_f32_dpp v154, v134, v206 quad_perm:[0,1,2,3] row_mask:0x2 bank_mask:0xf
    v_mfma_f32_16x16x32_bf16 v[126:129], a[136:139], v[226:229], v[126:129]
    v_mul_f32_dpp v154, v218, v206 quad_perm:[0,1,2,3] row_mask:0x4 bank_mask:0xf
    v_cvt_pk_bf16_f32 v154, v154, v154
    v_mfma_f32_16x16x32_bf16 v[126:129], a[140:143], v[242:245], v[126:129]
    ds_write_b16 v7, v154
    v_mfma_f32_16x16x32_bf16 v[206:209], a[0:3], v[182:185], 0
    v_fmac_f32 v255, v190, v190
    v_fmac_f32 v255, v191, v191
    v_mfma_f32_16x16x32_bf16 v[206:209], a[4:7], v[198:201], v[206:209]
    v_fmac_f32 v255, v192, v192
    v_fmac_f32 v255, v193, v193
    v_mfma_f32_16x16x32_bf16 v[206:209], a[8:11], v[210:213], v[206:209]
    v_fmac_f32 v255, v202, v202
    v_fmac_f32 v255, v203, v203
    v_mfma_f32_16x16x32_bf16 v[206:209], a[12:15], v[222:225], v[206:209]
    v_fmac_f32 v255, v204, v204
    v_fmac_f32 v255, v205, v205
    v_mfma_f32_16x16x32_bf16 v[206:209], a[16:19], v[226:229], v[206:209]
    v_fma_f32 v254, v142, v142, s33
    v_fmac_f32 v254, v143, v143
    v_mfma_f32_16x16x32_bf16 v[206:209], a[20:23], v[242:245], v[206:209]
    v_fmac_f32 v254, v144, v144
    v_fmac_f32 v254, v145, v145
    v_mfma_f32_16x16x32_bf16 v[174:177], a[24:27], v[182:185], 0
    v_fmac_f32 v254, v158, v158
    v_fmac_f32 v254, v159, v159
    v_mfma_f32_16x16x32_bf16 v[174:177], a[28:31], v[198:201], v[174:177]
    v_fmac_f32 v254, v160, v160
    v_fmac_f32 v254, v161, v161
    v_mfma_f32_16x16x32_bf16 v[174:177], a[32:35], v[210:213], v[174:177]
    v_fmac_f32 v254, v178, v178
    v_fmac_f32 v254, v179, v179
    v_mfma_f32_16x16x32_bf16 v[174:177], a[36:39], v[222:225], v[174:177]
    v_fmac_f32 v254, v180, v180
    v_fmac_f32 v254, v181, v181
    v_mfma_f32_16x16x32_bf16 v[174:177], a[40:43], v[226:229], v[174:177]
    v_cvt_pk_bf16_f32 v154, v255, v254
    v_add_u32 v5, 336, v5
    v_mfma_f32_16x16x32_bf16 v[174:177], a[44:47], v[242:245], v[174:177]
    ds_write_b64 v4, v[154:155] offset:18432
    v_mfma_f32_16x16x32_bf16 v[218:221], a[48:51], v[182:185], 0
    v_add_u32 v6, 272, v6
    v_add_u32 v7, 16, v7
    v_mfma_f32_16x16x32_bf16 v[218:221], a[52:55], v[198:201], v[218:221]
    v_fma_f32 v130, v114, v114, s32
    v_fmac_f32 v130, v115, v115
    v_mfma_f32_16x16x32_bf16 v[218:221], a[56:59], v[210:213], v[218:221]
    v_fmac_f32 v130, v116, v116
    v_fmac_f32 v130, v117, v117
    v_mfma_f32_16x16x32_bf16 v[218:221], a[60:63], v[222:225], v[218:221]
    v_fmac_f32 v130, v122, v122
    v_fmac_f32 v130, v123, v123
    v_mfma_f32_16x16x32_bf16 v[218:221], a[64:67], v[226:229], v[218:221]
    v_fmac_f32 v130, v124, v124
    v_fmac_f32 v130, v125, v125
    v_mfma_f32_16x16x32_bf16 v[218:221], a[68:71], v[242:245], v[218:221]
    v_fmac_f32 v130, v126, v126
    v_fmac_f32 v130, v127, v127
    v_mfma_f32_16x16x32_bf16 v[170:173], v[182:185], a[144:147], 0
    s_waitcnt lgkmcnt(0)
    v_fmac_f32 v130, v128, v128
    v_fmac_f32 v130, v129, v129
    v_mfma_f32_16x16x32_bf16 v[170:173], v[198:201], a[148:151], v[170:173]
    s_nop 0
    v_fma_f32 v131, v206, v206, s32
    v_fmac_f32 v131, v207, v207
    v_mfma_f32_16x16x32_bf16 v[170:173], v[210:213], a[152:155], v[170:173]
    s_nop 0
    v_fmac_f32 v131, v208, v208
    v_fmac_f32 v131, v209, v209
    v_mfma_f32_16x16x32_bf16 v[170:173], v[222:225], a[156:159], v[170:173]
    s_barrier
    v_fmac_f32 v131, v174, v174
    v_xor_b32 v2, 65536, v2
    v_mfma_f32_16x16x32_bf16 v[170:173], v[226:229], a[160:163], v[170:173]
    s_nop 0
    v_xor_b32 v3, 65536, v3
    v_xor_b32 v4, 65536, v4
    v_mfma_f32_16x16x32_bf16 v[170:173], v[242:245], a[164:167], v[170:173]
    s_cbranch_scc1 L_loop_safe2
    s_branch L_drain
.p2align 6
L_loop_safe3:
    v_mfma_f32_16x16x32_bf16 v[162:165], v[182:185], a[168:171], 0
    s_add_u32 s12, s42, s27
    ds_read_b128 v[194:197], v2 offset:18432
    ds_read_b128 v[230:233], v2 offset:19456
    v_mfma_f32_16x16x32_bf16 v[162:165], v[198:201], a[172:175], v[162:165]
    s_addc_u32 s13, s43, 0
    v_fmac_f32 v131, v175, v175
    v_fmac_f32 v131, v176, v176
    v_mfma_f32_16x16x32_bf16 v[162:165], v[210:213], a[176:179], v[162:165]
    s_sub_u32 s14, s36, s27
    v_fmac_f32 v131, v177, v177
    v_fmac_f32 v131, v218, v218
    v_mfma_f32_16x16x32_bf16 v[162:165], v[222:225], a[180:183], v[162:165]
    s_cmp_ge_u32 s18, 2
    v_fmac_f32 v131, v219, v219
    v_fmac_f32 v131, v220, v220
    v_mfma_f32_16x16x32_bf16 v[162:165], v[226:229], a[184:187], v[162:165]
    s_cselect_b32 s14, s14, 0
    ds_read_b128 v[118:121], v0 offset:26624
    v_fmac_f32 v131, v221, v221
    v_mfma_f32_16x16x32_bf16 v[162:165], v[242:245], a[188:191], v[162:165]
    s_add_u32 s34, s18, 2
    ds_read_b128 v[134:137], v1 offset:26624
    v_cvt_pk_bf16_f32 v36, v131, v130
    v_mfma_f32_16x16x32_bf16 v[214:217], v[182:185], a[192:195], 0
    s_add_u32 s8, s40, s23
    ds_read_b128 v[154:157], v0 offset:26752
    v_cvt_pk_bf16_f32 v170, v170, v171
    v_mfma_f32_16x16x32_bf16 v[214:217], v[198:201], a[196:199], v[214:217]
    s_addc_u32 s9, s41, 0
    ds_read_b128 v[198:201], v1 offset:26752
    v_cvt_pk_bf16_f32 v171, v172, v173
    v_mfma_f32_16x16x32_bf16 v[166:169], v[32:35], v[36:39], 0
    s_sub_u32 s10, s36, s23
    v_cvt_pk_bf16_f32 v130, v162, v163
    v_cvt_pk_bf16_f32 v131, v164, v165
    v_mfma_f32_16x16x32_bf16 v[214:217], v[210:213], a[200:203], v[214:217]
    s_waitcnt lgkmcnt(4)
    ds_read_b128 v[210:213], v0 offset:26880
    s_cmp_lt_u32 s34, s17
    v_mfma_f32_16x16x32_bf16 v[234:237], v[32:35], v[194:197], 0
    s_cselect_b32 s10, s10, 0
    v_rsq_f32 v167, v167
    v_mfma_f32_16x16x32_bf16 v[234:237], v[32:35], v[230:233], v[234:237]
    s_add_u32 m0, s28, 0
    v_rsq_f32 v166, v166
    v_mfma_f32_16x16x32_bf16 v[214:217], v[222:225], a[204:207], v[214:217]
    s_waitcnt lgkmcnt(4)
    ds_read_b128 v[162:165], v1 offset:26880
    v_mul_f32 v166, s31, v166
    v_mfma_f32_16x16x32_bf16 v[214:217], v[226:229], a[208:211], v[214:217]
    s_mov_b32 s27, s26
    v_mul_f32 v114, v167, v114
    v_mul_f32 v115, v167, v115
    v_mfma_f32_16x16x32_bf16 v[214:217], v[242:245], a[212:215], v[214:217]
    s_mov_b32 s26, s25
    v_cvt_pk_f16_f32 v242, v114, v115
    v_mul_f32 v116, v167, v116
    v_mfma_f32_16x16x32_bf16 v[226:229], a[72:75], v[118:121], 0
    s_waitcnt lgkmcnt(2)
    v_mul_f32 v117, v167, v117
    v_cvt_pk_f16_f32 v243, v116, v117
    v_mfma_f32_16x16x32_bf16 v[226:229], a[76:79], v[134:137], v[226:229]
    s_mov_b32 s25, s24
    v_cvt_pk_bf16_f32 v114, v214, v215
    v_cvt_pk_bf16_f32 v115, v216, v217
    v_mfma_f32_16x16x32_bf16 v[226:229], a[80:83], v[154:157], v[226:229]
    s_mov_b32 s24, s23
    v_mul_f32 v122, v167, v122
    v_mul_f32 v123, v167, v123
    v_mfma_f32_16x16x32_bf16 v[226:229], a[84:87], v[198:201], v[226:229]
    s_waitcnt lgkmcnt(1)
    v_cvt_pk_f16_f32 v244, v122, v123
    v_mul_f32 v124, v167, v124
    v_mfma_f32_16x16x32_bf16 v[226:229], a[88:91], v[210:213], v[226:229]
    v_mul_f32 v125, v167, v125
    v_cvt_pk_f16_f32 v245, v124, v125
    v_mfma_f32_16x16x32_bf16 v[122:125], a[96:99], v[118:121], 0
    s_waitcnt lgkmcnt(0)
    v_mul_f32 v126, v167, v126
    v_mul_f32 v127, v167, v127
    v_mfma_f32_16x16x32_bf16 v[226:229], a[92:95], v[162:165], v[226:229]
    v_cvt_pk_f16_f32 v184, v126, v127
    v_mul_f32 v128, v167, v128
    v_mfma_f32_16x16x32_bf16 v[122:125], a[100:103], v[134:137], v[122:125]
    v_mul_f32 v129, v167, v129
    v_cvt_pk_f16_f32 v185, v128, v129
    v_mfma_f32_16x16x32_bf16 v[122:125], a[104:107], v[154:157], v[122:125]
    v_mul_f32 v206, v166, v206
    v_mul_f32 v207, v166, v207
    v_mfma_f32_16x16x32_bf16 v[122:125], a[108:111], v[198:201], v[122:125]
    v_cvt_pk_f16_f32 v222, v206, v207
    v_mul_f32 v208, v166, v208
    v_mfma_f32_16x16x32_bf16 v[122:125], a[112:115], v[210:213], v[122:125]
    v_mul_f32 v209, v166, v209
    v_cvt_pk_f16_f32 v223, v208, v209
    v_mfma_f32_16x16x32_bf16 v[122:125], a[116:119], v[162:165], v[122:125]
    v_mul_f32 v174, v166, v174
    v_mul_f32 v175, v166, v175
    v_mfma_f32_16x16x32_bf16 v[126:129], a[120:123], v[118:121], 0
    v_cvt_pk_f16_f32 v224, v174, v175
    v_mul_f32 v176, v166, v176
    v_mfma_f32_16x16x32_bf16 v[126:129], a[124:127], v[134:137], v[126:129]
    v_mul_f32 v177, v166, v177
    v_cvt_pk_f16_f32 v225, v176, v177
    v_mfma_f32_16x16x32_bf16 v[126:129], a[128:131], v[154:157], v[126:129]
    v_mul_f32 v218, v166, v218
    v_mul_f32 v219, v166, v219
    v_mfma_f32_16x16x32_bf16 v[126:129], a[132:135], v[198:201], v[126:129]
    v_cvt_pk_f16_f32 v182, v218, v219
    v_mul_f32 v220, v166, v220
    v_mfma_f32_16x16x32_bf16 v[126:129], a[136:139], v[210:213], v[126:129]
    v_mul_f32 v221, v166, v221
    v_cvt_pk_f16_f32 v183, v220, v221
    v_mfma_f32_16x16x32_bf16 v[126:129], a[140:143], v[162:165], v[126:129]
    v_fma_f32 v116, v226, v226, s32
    v_fmac_f32 v116, v227, v227
    v_mfma_f32_16x16x32_bf16 v[206:209], a[0:3], v[118:121], 0
    v_fmac_f32 v116, v228, v228
    v_fmac_f32 v116, v229, v229
    v_mfma_f32_16x16x32_bf16 v[206:209], a[4:7], v[134:137], v[206:209]
    v_fmac_f32 v116, v122, v122
    v_fmac_f32 v116, v123, v123
    v_mfma_f32_16x16x32_bf16 v[206:209], a[8:11], v[154:157], v[206:209]
    v_fmac_f32 v116, v124, v124
    v_fmac_f32 v116, v125, v125
    v_mfma_f32_16x16x32_bf16 v[206:209], a[12:15], v[198:201], v[206:209]
    v_fmac_f32 v116, v126, v126
    v_fmac_f32 v116, v127, v127
    v_mfma_f32_16x16x32_bf16 v[206:209], a[16:19], v[210:213], v[206:209]
    v_fmac_f32 v116, v128, v128
    v_fmac_f32 v116, v129, v129
    v_mfma_f32_16x16x32_bf16 v[206:209], a[20:23], v[162:165], v[206:209]
    v_mul_f32 v117, 0x3baaaaab, v234
    v_mul_f32 v254, 0x3baaaaab, v235
    v_mfma_f32_16x16x32_bf16 v[174:177], a[24:27], v[118:121], 0
    v_rsq_f32 v117, v117
    v_mfma_f32_16x16x32_bf16 v[174:177], a[28:31], v[134:137], v[174:177]
    v_rsq_f32 v254, v254
    v_mfma_f32_16x16x32_bf16 v[174:177], a[32:35], v[154:157], v[174:177]
    v_mul_f32 v255, 0x3baaaaab, v236
    v_fma_f32 v132, v206, v206, s32
    v_mfma_f32_16x16x32_bf16 v[174:177], a[36:39], v[198:201], v[174:177]
    v_fmac_f32 v132, v207, v207
    v_fmac_f32 v132, v208, v208
    v_mfma_f32_16x16x32_bf16 v[174:177], a[40:43], v[210:213], v[174:177]
    v_fmac_f32 v132, v209, v209
    v_mul_f32 v150, v117, v150
    v_mfma_f32_16x16x32_bf16 v[174:177], a[44:47], v[162:165], v[174:177]
    v_rsq_f32 v255, v255
    v_mfma_f32_16x16x32_bf16 v[218:221], a[48:51], v[118:121], 0
    v_mul_f32 v151, v117, v151
    v_cvt_pk_bf16_f32 v194, v150, v151
    v_mfma_f32_16x16x32_bf16 v[218:221], a[52:55], v[134:137], v[218:221]
    v_mul_f32 v152, v117, v152
    v_mul_f32 v153, v117, v153
    v_mfma_f32_16x16x32_bf16 v[218:221], a[56:59], v[154:157], v[218:221]
    v_fmac_f32 v132, v174, v174
    v_fmac_f32 v132, v175, v175
    v_mfma_f32_16x16x32_bf16 v[218:221], a[60:63], v[198:201], v[218:221]
    v_fmac_f32 v132, v176, v176
    v_fmac_f32 v132, v177, v177
    v_mfma_f32_16x16x32_bf16 v[218:221], a[64:67], v[210:213], v[218:221]
    v_cvt_pk_bf16_f32 v195, v152, v153
    v_mul_f32 v190, v117, v190
    v_mfma_f32_16x16x32_bf16 v[218:221], a[68:71], v[162:165], v[218:221]
    v_mul_f32 v191, v117, v191
    v_cvt_pk_bf16_f32 v196, v190, v191
    v_mfma_f32_16x16x32_bf16 v[150:153], v[118:121], a[144:147], 0
    v_mul_f32 v192, v117, v192
    v_mul_f32 v193, v117, v193
    v_mfma_f32_16x16x32_bf16 v[150:153], v[134:137], a[148:151], v[150:153]
    v_cvt_pk_bf16_f32 v197, v192, v193
    v_mul_f32 v202, v117, v202
    v_mfma_f32_16x16x32_bf16 v[150:153], v[154:157], a[152:155], v[150:153]
    buffer_store_dwordx4 v[194:197], v15, s[12:15], 0 offen nt
    v_fmac_f32 v132, v218, v218
    v_fmac_f32 v132, v219, v219
    v_fmac_f32 v132, v220, v220
    v_fmac_f32 v132, v221, v221
    v_mfma_f32_16x16x32_bf16 v[150:153], v[198:201], a[156:159], v[150:153]
    v_cvt_pk_bf16_f32 v36, v132, v116
    v_mul_f32 v203, v117, v203
    v_mfma_f32_16x16x32_bf16 v[150:153], v[210:213], a[160:163], v[150:153]
    v_cvt_pk_bf16_f32 v116, v202, v203
    v_mul_f32 v204, v117, v204
    v_mfma_f32_16x16x32_bf16 v[190:193], v[32:35], v[36:39], 0
    v_mul_f32 v205, v117, v205
    v_cvt_pk_bf16_f32 v117, v204, v205
    v_mfma_f32_16x16x32_bf16 v[150:153], v[162:165], a[164:167], v[150:153]
    v_mul_f32 v146, v255, v146
    v_mul_f32 v147, v255, v147
    v_mfma_f32_16x16x32_bf16 v[202:205], v[118:121], a[168:171], 0
    v_cvt_pk_bf16_f32 v146, v146, v147
    v_mul_f32 v148, v255, v148
    v_mfma_f32_16x16x32_bf16 v[202:205], v[134:137], a[172:175], v[202:205]
    v_rsq_f32 v191, v191
    v_mfma_f32_16x16x32_bf16 v[202:205], v[154:157], a[176:179], v[202:205]
    v_cvt_pk_bf16_f32 v172, v150, v151
    v_cvt_pk_bf16_f32 v173, v152, v153
    v_mfma_f32_16x16x32_bf16 v[202:205], v[198:201], a[180:183], v[202:205]
    v_rsq_f32 v190, v190
    v_mfma_f32_16x16x32_bf16 v[202:205], v[210:213], a[184:187], v[202:205]
    ds_read_b128 v[150:153], v0 offset:32768
    v_mul_f32 v190, s31, v190
    v_mfma_f32_16x16x32_bf16 v[202:205], v[162:165], a[188:191], v[202:205]
    ds_read_b128 v[166:169], v1 offset:32768
    v_mul_f32 v226, v191, v226
    v_mfma_f32_16x16x32_bf16 v[194:197], v[118:121], a[192:195], 0
    ds_read_b128 v[118:121], v0 offset:32896
    v_mul_f32 v227, v191, v227
    v_mfma_f32_16x16x32_bf16 v[194:197], v[134:137], a[196:199], v[194:197]
    ds_read_b128 v[134:137], v1 offset:32896
    v_cvt_pk_f16_f32 v226, v226, v227
    v_mfma_f32_16x16x32_bf16 v[194:197], v[154:157], a[200:203], v[194:197]
    ds_read_b128 v[154:157], v0 offset:33024
    v_cvt_pk_bf16_f32 v132, v202, v203
    v_mfma_f32_16x16x32_bf16 v[194:197], v[198:201], a[204:207], v[194:197]
    ds_read_b128 v[198:201], v1 offset:33024
    v_cvt_pk_bf16_f32 v133, v204, v205
    v_mfma_f32_16x16x32_bf16 v[194:197], v[210:213], a[208:211], v[194:197]
    v_mul_f32 v228, v191, v228
    v_mul_f32 v229, v191, v229
    v_mfma_f32_16x16x32_bf16 v[194:197], v[162:165], a[212:215], v[194:197]
    v_cvt_pk_f16_f32 v227, v228, v229
    v_mul_f32 v122, v191, v122
    v_mfma_f32_16x16x32_f16 v[210:213], v[242:245], v[222:225], v[46:49]
    s_waitcnt lgkmcnt(5)
    buffer_store_dwordx2 v[116:117], v18, s[12:15], 0 offen nt
    v_mul_f32 v123, v191, v123
    v_cvt_pk_f16_f32 v228, v122, v123
    v_mfma_f32_16x16x32_bf16 v[202:205], a[72:75], v[150:153], 0
    s_waitcnt lgkmcnt(3)
    v_cvt_pk_bf16_f32 v116, v194, v195
    v_cvt_pk_bf16_f32 v117, v196, v197
    v_mfma_f32_16x16x32_bf16 v[202:205], a[76:79], v[166:169], v[202:205]
    s_waitcnt lgkmcnt(2)
    v_mul_f32 v124, v191, v124
    v_mul_f32 v125, v191, v125
    v_mfma_f32_16x16x32_bf16 v[202:205], a[80:83], v[118:121], v[202:205]
    s_waitcnt lgkmcnt(1)
    v_cvt_pk_f16_f32 v229, v124, v125
    v_mul_f32 v126, v191, v126
    v_mfma_f32_16x16x32_bf16 v[202:205], a[84:87], v[134:137], v[202:205]
    s_waitcnt lgkmcnt(0)
    v_mul_f32 v127, v191, v127
    v_cvt_pk_f16_f32 v124, v126, v127
    v_mfma_f32_16x16x32_bf16 v[202:205], a[88:91], v[154:157], v[202:205]
    v_mul_f32 v128, v191, v128
    v_mul_f32 v129, v191, v129
    v_mfma_f32_16x16x32_bf16 v[202:205], a[92:95], v[198:201], v[202:205]
    v_cvt_pk_f16_f32 v125, v128, v129
    v_mul_f32 v206, v190, v206
    v_mfma_f32_16x16x32_bf16 v[126:129], a[96:99], v[150:153], 0
    v_mul_f32 v207, v190, v207
    v_cvt_pk_f16_f32 v206, v206, v207
    v_mfma_f32_16x16x32_bf16 v[126:129], a[100:103], v[166:169], v[126:129]
    v_mul_f32 v208, v190, v208
    v_mul_f32 v209, v190, v209
    v_mfma_f32_16x16x32_bf16 v[126:129], a[104:107], v[118:121], v[126:129]
    v_cvt_pk_f16_f32 v207, v208, v209
    v_mul_f32 v174, v190, v174
    v_mfma_f32_16x16x32_bf16 v[126:129], a[108:111], v[134:137], v[126:129]
    v_mul_f32 v175, v190, v175
    v_cvt_pk_f16_f32 v208, v174, v175
    v_mfma_f32_16x16x32_bf16 v[126:129], a[112:115], v[154:157], v[126:129]
    v_mul_f32 v176, v190, v176
    v_mul_f32 v177, v190, v177
    v_mfma_f32_16x16x32_bf16 v[126:129], a[116:119], v[198:201], v[126:129]
    v_cvt_pk_f16_f32 v209, v176, v177
    v_mul_f32 v218, v190, v218
    v_mfma_f32_16x16x32_bf16 v[174:177], a[120:123], v[150:153], 0
    v_mul_f32 v219, v190, v219
    v_cvt_pk_f16_f32 v122, v218, v219
    v_mfma_f32_16x16x32_bf16 v[174:177], a[124:127], v[166:169], v[174:177]
    v_mul_f32 v220, v190, v220
    v_mul_f32 v221, v190, v221
    v_mfma_f32_16x16x32_bf16 v[174:177], a[128:131], v[118:121], v[174:177]
    v_cvt_pk_f16_f32 v123, v220, v221
    v_fma_f32 v162, v202, v202, s32
    v_mfma_f32_16x16x32_bf16 v[174:177], a[132:135], v[134:137], v[174:177]
    v_fmac_f32 v162, v203, v203
    v_fmac_f32 v162, v204, v204
    v_mfma_f32_16x16x32_bf16 v[174:177], a[136:139], v[154:157], v[174:177]
    v_fmac_f32 v162, v205, v205
    v_fmac_f32 v162, v126, v126
    v_mfma_f32_16x16x32_bf16 v[174:177], a[140:143], v[198:201], v[174:177]
    v_fmac_f32 v162, v127, v127
    v_fmac_f32 v162, v128, v128
    v_mfma_f32_16x16x32_bf16 v[190:193], a[0:3], v[150:153], 0
    v_fmac_f32 v162, v129, v129
    v_mul_f32 v149, v255, v149
    v_mfma_f32_16x16x32_bf16 v[190:193], a[4:7], v[166:169], v[190:193]
    v_cvt_pk_bf16_f32 v147, v148, v149
    v_mul_f32 v138, v255, v138
    v_mfma_f32_16x16x32_bf16 v[190:193], a[8:11], v[118:121], v[190:193]
    v_fmac_f32 v162, v174, v174
    v_fmac_f32 v162, v175, v175
    v_mfma_f32_16x16x32_bf16 v[190:193], a[12:15], v[134:137], v[190:193]
    v_fmac_f32 v162, v176, v176
    v_fmac_f32 v162, v177, v177
    v_mfma_f32_16x16x32_bf16 v[190:193], a[16:19], v[154:157], v[190:193]
    v_mul_f32 v139, v255, v139
    v_cvt_pk_bf16_f32 v148, v138, v139
    v_mfma_f32_16x16x32_bf16 v[190:193], a[20:23], v[198:201], v[190:193]
    v_mul_f32 v140, v255, v140
    v_mul_f32 v141, v255, v141
    v_mfma_f32_16x16x32_bf16 v[218:221], a[24:27], v[150:153], 0
    v_cvt_pk_bf16_f32 v149, v140, v141
    v_mul_f32 v186, v255, v186
    v_mfma_f32_16x16x32_bf16 v[218:221], a[28:31], v[166:169], v[218:221]
    buffer_store_dwordx4 v[146:149], v17, s[12:15], 0 offen nt
    v_mul_f32 v187, v255, v187
    v_fma_f32 v163, v190, v190, s32
    v_fmac_f32 v163, v191, v191
    v_fmac_f32 v163, v192, v192
    v_mfma_f32_16x16x32_bf16 v[218:221], a[32:35], v[118:121], v[218:221]
    v_fmac_f32 v163, v193, v193
    v_cvt_pk_bf16_f32 v164, v186, v187
    v_mfma_f32_16x16x32_bf16 v[218:221], a[36:39], v[134:137], v[218:221]
    v_mul_f32 v188, v255, v188
    v_mul_f32 v189, v255, v189
    v_mfma_f32_16x16x32_bf16 v[218:221], a[40:43], v[154:157], v[218:221]
    v_cvt_pk_bf16_f32 v165, v188, v189
    v_mul_f32 v142, v254, v142
    v_mfma_f32_16x16x32_bf16 v[218:221], a[44:47], v[198:201], v[218:221]
    v_mul_f32 v143, v254, v143
    v_cvt_pk_bf16_f32 v142, v142, v143
    v_mfma_f32_16x16x32_bf16 v[138:141], a[48:51], v[150:153], 0
    v_mul_f32 v144, v254, v144
    v_mul_f32 v145, v254, v145
    v_mfma_f32_16x16x32_bf16 v[138:141], a[52:55], v[166:169], v[138:141]
    v_cvt_pk_bf16_f32 v143, v144, v145
    v_mul_f32 v158, v254, v158
    v_mfma_f32_16x16x32_bf16 v[138:141], a[56:59], v[118:121], v[138:141]
    v_fmac_f32 v163, v218, v218
    v_fmac_f32 v163, v219, v219
    v_mfma_f32_16x16x32_bf16 v[138:141], a[60:63], v[134:137], v[138:141]
    ds_read2_b32 v[196:197], v6 offset0:0 offset1:0
    ds_read2_b32 v[216:217], v6 offset0:16 offset1:16
    v_mfma_f32_16x16x32_bf16 v[138:141], a[64:67], v[154:157], v[138:141]
    ds_read2_b32 v[232:233], v6 offset0:32 offset1:32
    v_fmac_f32 v163, v220, v220
    v_mfma_f32_16x16x32_bf16 v[138:141], a[68:71], v[198:201], v[138:141]
    v_fmac_f32 v163, v221, v221
    v_mul_f32 v159, v254, v159
    v_mfma_f32_16x16x32_bf16 v[146:149], v[150:153], a[144:147], 0
    v_cvt_pk_bf16_f32 v144, v158, v159
    v_mul_f32 v160, v254, v160
    v_mfma_f32_16x16x32_bf16 v[146:149], v[166:169], a[148:151], v[146:149]
    v_mul_f32 v161, v254, v161
    v_cvt_pk_bf16_f32 v145, v160, v161
    v_mfma_f32_16x16x32_bf16 v[146:149], v[118:121], a[152:155], v[146:149]
    v_fmac_f32 v163, v138, v138
    v_fmac_f32 v163, v139, v139
    v_mfma_f32_16x16x32_bf16 v[146:149], v[134:137], a[156:159], v[146:149]
    v_fmac_f32 v163, v140, v140
    v_fmac_f32 v163, v141, v141
    v_mfma_f32_16x16x32_bf16 v[146:149], v[154:157], a[160:163], v[146:149]
    v_cvt_pk_bf16_f32 v36, v163, v162
    v_mul_f32 v178, v254, v178
    v_mfma_f32_16x16x32_bf16 v[146:149], v[198:201], a[164:167], v[146:149]
    s_waitcnt lgkmcnt(1)
    v_mul_f32 v179, v254, v179
    v_cvt_pk_bf16_f32 v178, v178, v179
    v_mfma_f32_16x16x32_bf16 v[158:161], v[32:35], v[36:39], 0
    s_waitcnt lgkmcnt(0)
    buffer_store_dwordx2 v[164:165], v20, s[12:15], 0 offen nt
    v_mul_f32 v180, v254, v180
    v_mul_f32 v181, v254, v181
    v_mfma_f32_16x16x32_bf16 v[186:189], v[150:153], a[168:171], 0
    v_cvt_pk_bf16_f32 v194, v146, v147
    v_cvt_pk_bf16_f32 v195, v148, v149
    v_mfma_f32_16x16x32_bf16 v[186:189], v[166:169], a[172:175], v[186:189]
    v_rsq_f32 v159, v159
    v_mfma_f32_16x16x32_bf16 v[186:189], v[118:121], a[176:179], v[186:189]
    v_rsq_f32 v158, v158
    v_mfma_f32_16x16x32_bf16 v[186:189], v[134:137], a[180:183], v[186:189]
    v_mul_f32 v158, s31, v158
    v_mul_f32 v202, v159, v202
    v_mfma_f32_16x16x32_bf16 v[186:189], v[154:157], a[184:187], v[186:189]
    v_mul_f32 v203, v159, v203
    v_cvt_pk_f16_f32 v146, v202, v203
    v_mfma_f32_16x16x32_bf16 v[186:189], v[198:201], a[188:191], v[186:189]
    v_mul_f32 v204, v159, v204
    v_mul_f32 v205, v159, v205
    v_mfma_f32_16x16x32_bf16 v[162:165], v[150:153], a[192:195], 0
    v_cvt_pk_f16_f32 v147, v204, v205
    v_mul_f32 v126, v159, v126
    v_mfma_f32_16x16x32_bf16 v[162:165], v[166:169], a[196:199], v[162:165]
    ds_read_b128 v[150:153], v5 offset:0
    ds_read_b128 v[202:205], v5 offset:16
    v_mfma_f32_16x16x32_bf16 v[162:165], v[118:121], a[200:203], v[162:165]
    ds_read_b128 v[118:121], v5 offset:48
    ds_read_b32 v254, v6 offset:192
    v_mfma_f32_16x16x32_bf16 v[162:165], v[134:137], a[204:207], v[162:165]
    v_cvt_pk_bf16_f32 v214, v186, v187
    v_cvt_pk_bf16_f32 v215, v188, v189
    v_mfma_f32_16x16x32_bf16 v[162:165], v[154:157], a[208:211], v[162:165]
    v_mul_f32 v127, v159, v127
    v_cvt_pk_f16_f32 v148, v126, v127
    v_mfma_f32_16x16x32_bf16 v[162:165], v[198:201], a[212:215], v[162:165]
    ds_read_b128 v[198:201], v2 offset:0
    ds_read_b128 v[186:189], v2 offset:1024
    v_mfma_f32_16x16x32_f16 v[134:137], v[226:229], v[222:225], v[50:53]
    ds_read_b128 v[154:157], v2 offset:2048
    v_mul_f32 v128, v159, v128
    v_mul_f32 v129, v159, v129
    v_mfma_f32_16x16x16_f16 v[210:213], v[184:185], v[182:183], v[210:213]
    v_cvt_pk_f16_f32 v149, v128, v129
    v_cvt_pk_bf16_f32 v230, v162, v163
    v_cvt_pk_bf16_f32 v231, v164, v165
    v_mul_f32 v174, v159, v174
    v_mfma_f32_16x16x32_f16 v[126:129], v[146:149], v[222:225], v[54:57]
    s_waitcnt lgkmcnt(5)
    v_mul_f32 v175, v159, v175
    v_cvt_pk_f16_f32 v164, v174, v175
    v_mul_f32 v176, v159, v176
    v_mfma_f32_16x16x16_f16 v[134:137], v[124:125], v[182:183], v[134:137]
    v_mul_f32 v177, v159, v177
    v_cvt_pk_f16_f32 v165, v176, v177
    v_mul_f32 v190, v158, v190
    v_mul_f32 v191, v158, v191
    v_mfma_f32_16x16x16_f16 v[126:129], v[164:165], v[182:183], v[126:129]
    v_cvt_pk_f16_f32 v174, v190, v191
    v_mul_f32 v192, v158, v192
    v_mul_f32 v193, v158, v193
    v_cvt_pk_f16_f32 v175, v192, v193
    v_mfma_f32_16x16x32_f16 v[166:169], v[150:153], v[222:225], v[22:25]
    s_waitcnt lgkmcnt(2)
    ds_read_b128 v[222:225], v2 offset:3072
    buffer_store_dwordx4 v[142:145], v16, s[12:15], 0 offen nt
    ds_read_b128 v[234:237], v2 offset:4096
    v_mul_f32 v218, v158, v218
    v_mul_f32 v219, v158, v219
    v_cvt_pk_f16_f32 v176, v218, v219
    v_mfma_f32_16x16x32_f16 v[166:169], v[202:205], v[242:245], v[166:169]
    s_waitcnt lgkmcnt(2)
    v_mul_f32 v220, v158, v220
    v_mul_f32 v221, v158, v221
    v_mfma_f32_16x16x32_f16 v[166:169], v[118:121], v[182:185], v[166:169]
    ds_read_b128 v[142:145], v2 offset:5120
    v_cvt_pk_f16_f32 v177, v220, v221
    v_mul_f32 v138, v158, v138
    v_mul_f32 v139, v158, v139
    v_cvt_pk_f16_f32 v162, v138, v139
    v_mfma_f32_16x16x32_f16 v[218:221], v[150:153], v[206:209], v[24:27]
    v_mul_f32 v140, v158, v140
    v_mul_f32 v141, v158, v141
    v_mfma_f32_16x16x32_f16 v[218:221], v[202:205], v[226:229], v[218:221]
    v_mov_b32_dpp v254, v167 quad_perm:[0,1,2,3] row_mask:0x1 bank_mask:0xf
    v_cvt_pk_f16_f32 v163, v140, v141
    v_mfma_f32_16x16x32_f16 v[218:221], v[118:121], v[122:125], v[218:221]
    v_max3_f32 v255, v166, v210, v211
    v_max3_f32 v255, v255, v212, v213
    v_mfma_f32_16x16x32_f16 v[238:241], v[150:153], v[174:177], v[26:29]
    s_waitcnt lgkmcnt(1)
    v_max3_f32 v255, v255, v134, v135
    v_max3_f32 v255, v255, v136, v137
    v_mfma_f32_16x16x32_f16 v[238:241], v[202:205], v[146:149], v[238:241]
    v_max3_f32 v255, v255, v126, v127
    v_mov_b32_dpp v254, v219 quad_perm:[0,1,2,3] row_mask:0x2 bank_mask:0xf
    v_mfma_f32_16x16x32_f16 v[238:241], v[118:121], v[162:165], v[238:241]
    v_max3_f32 v255, v255, v128, v129
    v_mov_b32 v182, v255
    v_mfma_f32_16x16x32_bf16 v[150:153], a[216:219], v[198:201], 0
    s_waitcnt lgkmcnt(0)
    v_permlane32_swap_b32 v255, v182
    v_mfma_f32_16x16x32_bf16 v[150:153], a[220:223], v[186:189], v[150:153]
    v_max_f32 v255, v255, v182
    v_mov_b32 v182, v255
    v_mfma_f32_16x16x32_bf16 v[150:153], a[224:227], v[154:157], v[150:153]
    v_cvt_pk_bf16_f32 v179, v180, v181
    v_xor_b32 v0, 65536, v0
    v_mfma_f32_16x16x32_bf16 v[150:153], a[228:231], v[222:225], v[150:153]
    s_waitcnt vmcnt(5)
    v_permlane16_swap_b32 v255, v182
    v_mfma_f32_16x16x32_bf16 v[150:153], a[232:235], v[234:237], v[150:153]
    s_nop 0
    v_max_f32 v255, v255, v182
    v_sub_f32 v210, v210, v255
    v_mfma_f32_16x16x32_bf16 v[150:153], a[236:239], v[142:145], v[150:153]
    s_nop 0
    v_exp_f32 v210, v210
    v_mfma_f32_16x16x32_bf16 v[190:193], a[240:243], v[198:201], 0
    s_nop 0
    v_sub_f32 v211, v211, v255
    v_sub_f32 v212, v212, v255
    v_mfma_f32_16x16x32_bf16 v[190:193], a[244:247], v[186:189], v[190:193]
    s_barrier
    buffer_load_dwordx4 v10, s[8:11], 0 offen nt lds
    v_sub_f32 v213, v213, v255
    v_mfma_f32_16x16x32_bf16 v[190:193], a[248:251], v[154:157], v[190:193]
    s_add_u32 m0, s28, 4096
    v_exp_f32 v211, v211
    v_mfma_f32_16x16x32_bf16 v[190:193], a[252:255], v[222:225], v[190:193]
    v_cvt_pk_bf16_f32 v158, v210, v211
    v_sub_f32 v134, v134, v255
    v_mfma_f32_16x16x32_bf16 v[190:193], v[82:85], v[234:237], v[190:193]
    v_exp_f32 v212, v212
    v_mfma_f32_16x16x32_bf16 v[190:193], v[86:89], v[142:145], v[190:193]
    v_exp_f32 v213, v213
    v_mfma_f32_16x16x32_bf16 v[202:205], v[90:93], v[198:201], 0
    ds_read_b128 v[198:201], v2 offset:6144
    buffer_load_dwordx4 v11, s[8:11], 0 offen nt lds
    v_mfma_f32_16x16x32_bf16 v[202:205], v[94:97], v[186:189], v[202:205]
    s_add_u32 m0, s28, 8192
    ds_read_b128 v[138:141], v2 offset:7168
    v_cvt_pk_bf16_f32 v159, v212, v213
    v_mfma_f32_16x16x32_bf16 v[202:205], v[98:101], v[154:157], v[202:205]
    ds_read_b128 v[210:213], v2 offset:8192
    v_sub_f32 v135, v135, v255
    v_mfma_f32_16x16x32_bf16 v[202:205], v[102:105], v[222:225], v[202:205]
    ds_read_b128 v[186:189], v2 offset:9216
    v_sub_f32 v136, v136, v255
    v_mfma_f32_16x16x32_bf16 v[202:205], v[106:109], v[234:237], v[202:205]
    ds_read_b128 v[222:225], v2 offset:10240
    v_sub_f32 v137, v137, v255
    v_mfma_f32_16x16x32_bf16 v[202:205], v[110:113], v[142:145], v[202:205]
    ds_read_b128 v[154:157], v2 offset:11264
    buffer_load_dwordx4 v12, s[8:11], 0 offen nt lds
    v_exp_f32 v134, v134
    v_mfma_f32_16x16x32_f16 v[118:121], v[242:245], v[206:209], v[58:61]
    s_add_u32 m0, s28, 12288
    v_exp_f32 v135, v135
    v_exp_f32 v136, v136
    v_cvt_pk_bf16_f32 v160, v134, v135
    v_exp_f32 v137, v137
    v_sub_f32 v126, v126, v255
    v_mfma_f32_16x16x16_f16 v[118:121], v[184:185], v[122:123], v[118:121]
    v_cvt_pk_bf16_f32 v161, v136, v137
    v_exp_f32 v126, v126
    v_sub_f32 v127, v127, v255
    v_mfma_f32_16x16x32_f16 v[134:137], v[226:229], v[206:209], v[62:65]
    s_xor_b32 s28, s28, 65536
    buffer_load_dwordx4 v13, s[8:11], 0 offen nt lds
    v_exp_f32 v127, v127
    v_sub_f32 v128, v128, v255
    v_cvt_pk_bf16_f32 v36, v126, v127
    v_exp_f32 v128, v128
    v_mfma_f32_16x16x16_f16 v[134:137], v[124:125], v[122:123], v[134:137]
    v_sub_f32 v129, v129, v255
    v_exp_f32 v129, v129
    v_sub_f32 v166, v166, v255
    v_cvt_pk_bf16_f32 v37, v128, v129
    v_mfma_f32_16x16x32_f16 v[126:129], v[146:149], v[206:209], v[66:69]
    s_waitcnt lgkmcnt(0)
    v_exp_f32 v166, v166
    v_mfma_f32_16x16x32_bf16 v[142:145], a[216:219], v[198:201], 0
    s_mov_b32 m0, s29
    v_cvt_pk_bf16_f32 v39, v166, 0
    v_max3_f32 v255, v218, v118, v119
    v_max3_f32 v255, v255, v120, v121
    v_mfma_f32_16x16x16_f16 v[126:129], v[164:165], v[122:123], v[126:129]
    v_max3_f32 v255, v255, v134, v135
    v_max3_f32 v255, v255, v136, v137
    v_xor_b32 v1, 65536, v1
    v_mov_b32_dpp v254, v239 quad_perm:[0,1,2,3] row_mask:0x4 bank_mask:0xf
    v_mfma_f32_16x16x32_bf16 v[206:209], v[28:31], v[36:39], 0
    s_xor_b32 s29, s29, s30
    buffer_store_dwordx2 v[178:179], v19, s[12:15], 0 offen nt
    v_mov_b32 v122, v254
    v_max3_f32 v255, v255, v126, v127
    v_mfma_f32_16x16x32_bf16 v[206:209], v[28:31], v[158:161], v[206:209]
    s_add_u32 s19, s19, s20
    v_max3_f32 v255, v255, v128, v129
    v_mov_b32 v123, v255
    v_mfma_f32_16x16x32_bf16 v[142:145], a[220:223], v[138:141], v[142:145]
    s_add_u32 s23, s23, s21
    v_permlane32_swap_b32 v255, v123
    v_mfma_f32_16x16x32_bf16 v[142:145], a[224:227], v[210:213], v[142:145]
    s_cmp_ge_u32 s19, 72
    v_rcp_f32 v206, v206
    v_mfma_f32_16x16x32_bf16 v[142:145], a[228:231], v[186:189], v[142:145]
    s_cselect_b32 s34, 72, 0
    v_max_f32 v255, v255, v123
    v_mov_b32 v123, v255
    v_mfma_f32_16x16x32_bf16 v[142:145], a[232:235], v[222:225], v[142:145]
    s_cselect_b32 s35, s22, 0
    v_permlane16_swap_b32 v255, v123
    v_mfma_f32_16x16x32_bf16 v[142:145], a[236:239], v[154:157], v[142:145]
    s_sub_u32 s19, s19, s34
    v_max_f32 v255, v255, v123
    v_sub_f32 v118, v118, v255
    v_mfma_f32_16x16x32_bf16 v[178:181], v[194:197], v[36:39], 0
    s_add_u32 s23, s23, s35
    v_exp_f32 v118, v118
    v_mfma_f32_16x16x32_bf16 v[178:181], v[170:173], v[158:161], v[178:181]
    s_add_u32 s18, s18, 1
    v_sub_f32 v119, v119, v255
    v_exp_f32 v119, v119
    v_sub_f32 v120, v120, v255
    v_cvt_pk_bf16_f32 v118, v118, v119
    v_exp_f32 v120, v120
    v_sub_f32 v121, v121, v255
    v_exp_f32 v121, v121
    v_mul_f32 v178, v206, v178
    v_mul_f32 v179, v206, v179
    v_cvt_pk_bf16_f32 v178, v178, v179
    v_mul_f32 v180, v206, v180
    v_mul_f32 v181, v206, v181
    v_cvt_pk_bf16_f32 v179, v180, v181
    v_cvt_pk_bf16_f32 v119, v120, v121
    v_mfma_f32_16x16x32_bf16 v[166:169], v[214:217], v[36:39], 0
    s_cmp_lt_u32 s18, s17
    v_sub_f32 v134, v134, v255
    v_sub_f32 v135, v135, v255
    v_mfma_f32_16x16x32_bf16 v[166:169], v[130:133], v[158:161], v[166:169]
    v_exp_f32 v134, v134
    v_exp_f32 v135, v135
    v_sub_f32 v136, v136, v255
    v_cvt_pk_bf16_f32 v120, v134, v135
    v_exp_f32 v136, v136
    v_sub_f32 v137, v137, v255
    v_exp_f32 v137, v137
    v_sub_f32 v126, v126, v255
    v_mul_f32 v166, v206, v166
    v_mul_f32 v167, v206, v167
    v_cvt_pk_bf16_f32 v180, v166, v167
    v_mul_f32 v168, v206, v168
    v_mul_f32 v169, v206, v169
    v_cvt_pk_bf16_f32 v181, v168, v169
    v_cvt_pk_bf16_f32 v121, v136, v137
    v_mfma_f32_16x16x32_bf16 v[134:137], v[230:233], v[36:39], 0
    buffer_load_dwordx4 v14, s[8:11], 0 offen nt lds
    v_sub_f32 v127, v127, v255
    v_mfma_f32_16x16x32_bf16 v[134:137], v[114:117], v[158:161], v[134:137]
    ds_write_b128 v3, v[178:181] offset:0
    v_mfma_f32_16x16x32_bf16 v[158:161], a[240:243], v[198:201], 0
    v_exp_f32 v126, v126
    v_mfma_f32_16x16x32_bf16 v[158:161], a[244:247], v[138:141], v[158:161]
    v_exp_f32 v127, v127
    v_mfma_f32_16x16x32_bf16 v[158:161], a[248:251], v[210:213], v[158:161]
    v_cvt_pk_bf16_f32 v36, v126, v127
    v_sub_f32 v128, v128, v255
    v_mfma_f32_16x16x32_bf16 v[158:161], a[252:255], v[186:189], v[158:161]
    v_mul_f32 v134, v206, v134
    v_mul_f32 v135, v206, v135
    v_mfma_f32_16x16x32_bf16 v[158:161], v[82:85], v[222:225], v[158:161]
    v_cvt_pk_bf16_f32 v126, v134, v135
    v_mul_f32 v136, v206, v136
    v_mfma_f32_16x16x32_bf16 v[158:161], v[86:89], v[154:157], v[158:161]
    v_mul_f32 v137, v206, v137
    v_cvt_pk_bf16_f32 v127, v136, v137
    v_mfma_f32_16x16x32_bf16 v[178:181], v[90:93], v[198:201], 0
    ds_read_b128 v[198:201], v2 offset:12288
    v_sub_f32 v129, v129, v255
    v_mfma_f32_16x16x32_bf16 v[178:181], v[94:97], v[138:141], v[178:181]
    ds_read_b128 v[206:209], v2 offset:13312
    v_sub_f32 v218, v218, v255
    v_mfma_f32_16x16x32_bf16 v[178:181], v[98:101], v[210:213], v[178:181]
    ds_read_b128 v[210:213], v2 offset:14336
    v_max_f32_dpp v122, v122, v122 quad_perm:[1,0,3,2] row_mask:0xf bank_mask:0xf
    v_mfma_f32_16x16x32_bf16 v[178:181], v[102:105], v[186:189], v[178:181]
    ds_read_b128 v[134:137], v2 offset:15360
    v_max_f32_dpp v122, v122, v122 quad_perm:[2,3,0,1] row_mask:0xf bank_mask:0xf
    v_mfma_f32_16x16x32_bf16 v[178:181], v[106:109], v[222:225], v[178:181]
    ds_read_b128 v[222:225], v2 offset:16384
    v_max_f32_dpp v122, v122, v122 row_half_mirror row_mask:0xf bank_mask:0xf
    v_mfma_f32_16x16x32_bf16 v[178:181], v[110:113], v[154:157], v[178:181]
    ds_read_b128 v[154:157], v2 offset:17408
    ds_write_b64 v4, v[126:127] offset:4096
    v_exp_f32 v128, v128
    v_exp_f32 v129, v129
    v_mfma_f32_16x16x32_f16 v[186:189], v[242:245], v[174:177], v[70:73]
    s_waitcnt lgkmcnt(6)
    v_cvt_pk_bf16_f32 v37, v128, v129
    v_max_f32_dpp v122, v122, v122 row_mirror row_mask:0xf bank_mask:0xf
    v_mfma_f32_16x16x32_f16 v[242:245], v[226:229], v[174:177], v[74:77]
    s_waitcnt lgkmcnt(5)
    v_exp_f32 v218, v218
    v_mfma_f32_16x16x32_f16 v[126:129], v[146:149], v[174:177], v[78:81]
    s_waitcnt lgkmcnt(4)
    v_cvt_pk_bf16_f32 v39, v218, 0
    v_mov_b32 v123, v122
    v_fma_f32 v255, v150, v150, s33
    v_mfma_f32_16x16x32_bf16 v[174:177], v[28:31], v[36:39], 0
    s_waitcnt lgkmcnt(3)
    v_permlane32_swap_b32 v122, v123
    v_mfma_f32_16x16x32_bf16 v[174:177], v[28:31], v[118:121], v[174:177]
    s_waitcnt lgkmcnt(2)
    v_max_f32 v122, v122, v123
    v_mov_b32 v123, v122
    v_mfma_f32_16x16x32_bf16 v[226:229], v[194:197], v[36:39], 0
    s_waitcnt lgkmcnt(0)
    v_permlane16_swap_b32 v122, v123
    v_mfma_f32_16x16x32_bf16 v[226:229], v[170:173], v[118:121], v[226:229]
    v_max_f32 v122, v122, v123
    v_sub_f32 v254, v254, v122
    v_mfma_f32_16x16x32_bf16 v[218:221], v[214:217], v[36:39], 0
    v_exp_f32 v254, v254
    v_mfma_f32_16x16x32_bf16 v[218:221], v[130:133], v[118:121], v[218:221]
    v_cvt_pk_bf16_f32 v254, v254, v254
    v_fmac_f32 v255, v151, v151
    v_mfma_f32_16x16x32_bf16 v[166:169], v[230:233], v[36:39], 0
    ds_write_b16 v8, v254
    v_mfma_f32_16x16x32_bf16 v[166:169], v[114:117], v[118:121], v[166:169]
    v_rcp_f32 v174, v174
    v_fmac_f32 v255, v152, v152
    v_mfma_f32_16x16x16_f16 v[186:189], v[184:185], v[162:163], v[186:189]
    v_mul_f32 v226, v174, v226
    v_mul_f32 v227, v174, v227
    v_cvt_pk_bf16_f32 v122, v226, v227
    v_mfma_f32_16x16x16_f16 v[242:245], v[124:125], v[162:163], v[242:245]
    v_mul_f32 v228, v174, v228
    v_mul_f32 v229, v174, v229
    v_cvt_pk_bf16_f32 v123, v228, v229
    v_mfma_f32_16x16x16_f16 v[126:129], v[164:165], v[162:163], v[126:129]
    v_max3_f32 v254, v238, v186, v187
    v_max3_f32 v254, v254, v188, v189
    v_mul_f32 v218, v174, v218
    v_mul_f32 v219, v174, v219
    v_mfma_f32_16x16x32_bf16 v[146:149], a[216:219], v[198:201], 0
    ds_read_b128 v[118:121], v9
    ds_read_b128 v[162:165], v9 offset:64
    v_mfma_f32_16x16x32_bf16 v[146:149], a[220:223], v[206:209], v[146:149]
    v_max3_f32 v254, v254, v242, v243
    v_max3_f32 v254, v254, v244, v245
    v_mfma_f32_16x16x32_bf16 v[146:149], a[224:227], v[210:213], v[146:149]
    v_max3_f32 v254, v254, v126, v127
    v_max3_f32 v254, v254, v128, v129
    v_mfma_f32_16x16x32_bf16 v[146:149], a[228:231], v[134:137], v[146:149]
    v_mov_b32 v125, v254
    v_cvt_pk_bf16_f32 v124, v218, v219
    v_mfma_f32_16x16x32_bf16 v[146:149], a[232:235], v[222:225], v[146:149]
    v_permlane32_swap_b32 v254, v125
    v_mfma_f32_16x16x32_bf16 v[146:149], a[236:239], v[154:157], v[146:149]
    v_max_f32 v254, v254, v125
    v_mov_b32 v125, v254
    v_mfma_f32_16x16x32_bf16 v[138:141], a[240:243], v[198:201], 0
    v_mul_f32 v220, v174, v220
    v_mul_f32 v221, v174, v221
    v_mfma_f32_16x16x32_bf16 v[138:141], a[244:247], v[206:209], v[138:141]
    v_permlane16_swap_b32 v254, v125
    v_mfma_f32_16x16x32_bf16 v[138:141], a[248:251], v[210:213], v[138:141]
    s_waitcnt lgkmcnt(0)
    v_max_f32 v254, v254, v125
    v_sub_f32 v186, v186, v254
    v_mfma_f32_16x16x32_bf16 v[138:141], a[252:255], v[134:137], v[138:141]
    v_exp_f32 v186, v186
    v_mfma_f32_16x16x32_bf16 v[138:141], v[82:85], v[222:225], v[138:141]
    v_sub_f32 v187, v187, v254
    v_sub_f32 v188, v188, v254
    v_mfma_f32_16x16x32_bf16 v[138:141], v[86:89], v[154:157], v[138:141]
    v_exp_f32 v187, v187
    v_exp_f32 v188, v188
    v_cvt_pk_bf16_f32 v234, v186, v187
    v_sub_f32 v189, v189, v254
    v_exp_f32 v189, v189
    v_sub_f32 v242, v242, v254
    v_cvt_pk_bf16_f32 v235, v188, v189
    v_exp_f32 v242, v242
    v_sub_f32 v243, v243, v254
    v_exp_f32 v243, v243
    v_sub_f32 v244, v244, v254
    v_cvt_pk_bf16_f32 v236, v242, v243
    v_mfma_f32_16x16x32_bf16 v[186:189], v[90:93], v[198:201], 0
    v_exp_f32 v244, v244
    v_mfma_f32_16x16x32_bf16 v[186:189], v[94:97], v[206:209], v[186:189]
    v_sub_f32 v245, v245, v254
    v_sub_f32 v126, v126, v254
    v_mfma_f32_16x16x32_bf16 v[186:189], v[98:101], v[210:213], v[186:189]
    v_exp_f32 v245, v245
    v_mfma_f32_16x16x32_bf16 v[186:189], v[102:105], v[134:137], v[186:189]
    v_cvt_pk_bf16_f32 v237, v244, v245
    v_sub_f32 v127, v127, v254
    v_mfma_f32_16x16x32_bf16 v[186:189], v[106:109], v[222:225], v[186:189]
    v_exp_f32 v126, v126
    v_mfma_f32_16x16x32_bf16 v[186:189], v[110:113], v[154:157], v[186:189]
    ds_read_b128 v[182:185], v0 offset:20480
    ds_read_b128 v[198:201], v1 offset:20480
    v_mfma_f32_16x16x32_bf16 v[206:209], v[118:121], v[28:31], 0
    ds_read_b128 v[210:213], v0 offset:20608
    ds_read_b128 v[222:225], v1 offset:20608
    v_mfma_f32_16x16x32_bf16 v[206:209], v[162:165], v[28:31], v[206:209]
    v_exp_f32 v127, v127
    v_mfma_f32_16x16x32_bf16 v[154:157], v[118:121], v[170:173], 0
    ds_read_b128 v[226:229], v0 offset:20736
    v_cvt_pk_bf16_f32 v36, v126, v127
    v_mfma_f32_16x16x32_bf16 v[154:157], v[162:165], v[194:197], v[154:157]
    ds_read_b128 v[242:245], v1 offset:20736
    v_sub_f32 v128, v128, v254
    v_exp_f32 v128, v128
    v_sub_f32 v129, v129, v254
    v_exp_f32 v129, v129
    v_sub_f32 v238, v238, v254
    v_cvt_pk_bf16_f32 v37, v128, v129
    v_mfma_f32_16x16x32_bf16 v[134:137], v[118:121], v[130:133], 0
    v_exp_f32 v238, v238
    v_mfma_f32_16x16x32_bf16 v[134:137], v[162:165], v[214:217], v[134:137]
    s_waitcnt lgkmcnt(4)
    v_cvt_pk_bf16_f32 v39, v238, 0
    v_cvt_pk_bf16_f32 v125, v220, v221
    v_mfma_f32_16x16x32_bf16 v[218:221], v[118:121], v[114:117], 0
    s_waitcnt lgkmcnt(2)
    ds_write_b128 v3, v[122:125] offset:6144
    v_mfma_f32_16x16x32_bf16 v[126:129], v[28:31], v[36:39], 0
    s_waitcnt lgkmcnt(2)
    v_mul_f32 v166, v174, v166
    v_mul_f32 v167, v174, v167
    v_mfma_f32_16x16x32_bf16 v[126:129], v[28:31], v[234:237], v[126:129]
    s_waitcnt lgkmcnt(1)
    v_cvt_pk_bf16_f32 v166, v166, v167
    v_mul_f32 v168, v174, v168
    v_mfma_f32_16x16x32_bf16 v[122:125], v[194:197], v[36:39], 0
    v_mul_f32 v169, v174, v169
    v_cvt_pk_bf16_f32 v167, v168, v169
    v_mfma_f32_16x16x32_bf16 v[122:125], v[170:173], v[234:237], v[122:125]
    ds_write_b64 v4, v[166:167] offset:10240
    v_mfma_f32_16x16x32_bf16 v[170:173], v[214:217], v[36:39], 0
    v_rcp_f32 v126, v126
    v_mfma_f32_16x16x32_bf16 v[170:173], v[130:133], v[234:237], v[170:173]
    v_fma_f32 v254, v146, v146, s33
    v_fmac_f32 v254, v147, v147
    v_mfma_f32_16x16x32_bf16 v[174:177], v[230:233], v[36:39], 0
    v_fmac_f32 v254, v148, v148
    v_mul_f32 v122, v126, v122
    v_mfma_f32_16x16x32_bf16 v[174:177], v[114:117], v[234:237], v[174:177]
    v_mul_f32 v123, v126, v123
    v_cvt_pk_bf16_f32 v122, v122, v123
    v_mfma_f32_16x16x32_bf16 v[218:221], v[162:165], v[230:233], v[218:221]
    v_mul_f32 v124, v126, v124
    v_mul_f32 v125, v126, v125
    v_mfma_f32_16x16x32_bf16 v[114:117], a[72:75], v[182:185], 0
    v_cvt_pk_bf16_f32 v123, v124, v125
    v_mul_f32 v170, v126, v170
    v_mfma_f32_16x16x32_bf16 v[114:117], a[76:79], v[198:201], v[114:117]
    v_mul_f32 v171, v126, v171
    v_cvt_pk_bf16_f32 v124, v170, v171
    v_mfma_f32_16x16x32_bf16 v[114:117], a[80:83], v[210:213], v[114:117]
    v_mul_f32 v172, v126, v172
    v_mul_f32 v173, v126, v173
    v_mfma_f32_16x16x32_bf16 v[114:117], a[84:87], v[222:225], v[114:117]
    v_cvt_pk_bf16_f32 v125, v172, v173
    v_mul_f32 v174, v126, v174
    v_mfma_f32_16x16x32_bf16 v[114:117], a[88:91], v[226:229], v[114:117]
    ds_write_b128 v3, v[122:125] offset:12288
    v_mfma_f32_16x16x32_bf16 v[114:117], a[92:95], v[242:245], v[114:117]
    v_mul_f32 v175, v126, v175
    v_cvt_pk_bf16_f32 v174, v174, v175
    v_mfma_f32_16x16x32_bf16 v[122:125], a[96:99], v[182:185], 0
    v_mul_f32 v176, v126, v176
    v_mul_f32 v177, v126, v177
    v_mfma_f32_16x16x32_bf16 v[122:125], a[100:103], v[198:201], v[122:125]
    v_cvt_pk_bf16_f32 v175, v176, v177
    v_fmac_f32 v254, v149, v149
    v_mfma_f32_16x16x32_bf16 v[122:125], a[104:107], v[210:213], v[122:125]
    ds_write_b64 v4, v[174:175] offset:16384
    v_mfma_f32_16x16x32_bf16 v[122:125], a[108:111], v[222:225], v[122:125]
    v_fmac_f32 v254, v138, v138
    v_fmac_f32 v254, v139, v139
    v_mfma_f32_16x16x32_bf16 v[122:125], a[112:115], v[226:229], v[122:125]
    v_fmac_f32 v254, v140, v140
    v_fmac_f32 v254, v141, v141
    v_mfma_f32_16x16x32_bf16 v[122:125], a[116:119], v[242:245], v[122:125]
    v_fmac_f32 v254, v186, v186
    v_fmac_f32 v254, v187, v187
    v_mfma_f32_16x16x32_bf16 v[126:129], a[120:123], v[182:185], 0
    v_fmac_f32 v254, v188, v188
    v_fmac_f32 v254, v189, v189
    v_mfma_f32_16x16x32_bf16 v[126:129], a[124:127], v[198:201], v[126:129]
    v_cvt_pk_bf16_f32 v155, v254, v254
    v_fmac_f32 v255, v153, v153
    v_mfma_f32_16x16x32_bf16 v[126:129], a[128:131], v[210:213], v[126:129]
    v_rcp_f32 v206, v206
    v_mfma_f32_16x16x32_bf16 v[126:129], a[132:135], v[222:225], v[126:129]
    v_mul_f32 v154, v154, v206
    v_mul_f32_dpp v154, v134, v206 quad_perm:[0,1,2,3] row_mask:0x2 bank_mask:0xf
    v_mfma_f32_16x16x32_bf16 v[126:129], a[136:139], v[226:229], v[126:129]
    v_mul_f32_dpp v154, v218, v206 quad_perm:[0,1,2,3] row_mask:0x4 bank_mask:0xf
    v_cvt_pk_bf16_f32 v154, v154, v154
    v_mfma_f32_16x16x32_bf16 v[126:129], a[140:143], v[242:245], v[126:129]
    ds_write_b16 v7, v154
    v_mfma_f32_16x16x32_bf16 v[206:209], a[0:3], v[182:185], 0
    v_fmac_f32 v255, v190, v190
    v_fmac_f32 v255, v191, v191
    v_mfma_f32_16x16x32_bf16 v[206:209], a[4:7], v[198:201], v[206:209]
    v_fmac_f32 v255, v192, v192
    v_fmac_f32 v255, v193, v193
    v_mfma_f32_16x16x32_bf16 v[206:209], a[8:11], v[210:213], v[206:209]
    v_fmac_f32 v255, v202, v202
    v_fmac_f32 v255, v203, v203
    v_mfma_f32_16x16x32_bf16 v[206:209], a[12:15], v[222:225], v[206:209]
    v_fmac_f32 v255, v204, v204
    v_fmac_f32 v255, v205, v205
    v_mfma_f32_16x16x32_bf16 v[206:209], a[16:19], v[226:229], v[206:209]
    v_fma_f32 v254, v142, v142, s33
    v_fmac_f32 v254, v143, v143
    v_mfma_f32_16x16x32_bf16 v[206:209], a[20:23], v[242:245], v[206:209]
    v_fmac_f32 v254, v144, v144
    v_fmac_f32 v254, v145, v145
    v_mfma_f32_16x16x32_bf16 v[174:177], a[24:27], v[182:185], 0
    v_fmac_f32 v254, v158, v158
    v_fmac_f32 v254, v159, v159
    v_mfma_f32_16x16x32_bf16 v[174:177], a[28:31], v[198:201], v[174:177]
    v_fmac_f32 v254, v160, v160
    v_fmac_f32 v254, v161, v161
    v_mfma_f32_16x16x32_bf16 v[174:177], a[32:35], v[210:213], v[174:177]
    v_fmac_f32 v254, v178, v178
    v_fmac_f32 v254, v179, v179
    v_mfma_f32_16x16x32_bf16 v[174:177], a[36:39], v[222:225], v[174:177]
    v_fmac_f32 v254, v180, v180
    v_fmac_f32 v254, v181, v181
    v_mfma_f32_16x16x32_bf16 v[174:177], a[40:43], v[226:229], v[174:177]
    v_cvt_pk_bf16_f32 v154, v255, v254
    v_add_u32 v5, 336, v5
    v_mfma_f32_16x16x32_bf16 v[174:177], a[44:47], v[242:245], v[174:177]
    ds_write_b64 v4, v[154:155] offset:18432
    v_mfma_f32_16x16x32_bf16 v[218:221], a[48:51], v[182:185], 0
    v_add_u32 v6, 272, v6
    v_add_u32 v7, 16, v7
    v_mfma_f32_16x16x32_bf16 v[218:221], a[52:55], v[198:201], v[218:221]
    v_fma_f32 v130, v114, v114, s32
    v_fmac_f32 v130, v115, v115
    v_mfma_f32_16x16x32_bf16 v[218:221], a[56:59], v[210:213], v[218:221]
    v_fmac_f32 v130, v116, v116
    v_fmac_f32 v130, v117, v117
    v_mfma_f32_16x16x32_bf16 v[218:221], a[60:63], v[222:225], v[218:221]
    v_fmac_f32 v130, v122, v122
    v_fmac_f32 v130, v123, v123
    v_mfma_f32_16x16x32_bf16 v[218:221], a[64:67], v[226:229], v[218:221]
    v_fmac_f32 v130, v124, v124
    v_fmac_f32 v130, v125, v125
    v_mfma_f32_16x16x32_bf16 v[218:221], a[68:71], v[242:245], v[218:221]
    v_fmac_f32 v130, v126, v126
    v_fmac_f32 v130, v127, v127
    v_mfma_f32_16x16x32_bf16 v[170:173], v[182:185], a[144:147], 0
    s_waitcnt lgkmcnt(0)
    v_fmac_f32 v130, v128, v128
    v_fmac_f32 v130, v129, v129
    v_mfma_f32_16x16x32_bf16 v[170:173], v[198:201], a[148:151], v[170:173]
    s_nop 0
    v_fma_f32 v131, v206, v206, s32
    v_fmac_f32 v131, v207, v207
    v_mfma_f32_16x16x32_bf16 v[170:173], v[210:213], a[152:155], v[170:173]
    s_nop 0
    v_fmac_f32 v131, v208, v208
    v_fmac_f32 v131, v209, v209
    v_mfma_f32_16x16x32_bf16 v[170:173], v[222:225], a[156:159], v[170:173]
    s_nop 0
    v_fmac_f32 v131, v174, v174
    v_xor_b32 v2, 65536, v2
    v_mfma_f32_16x16x32_bf16 v[170:173], v[226:229], a[160:163], v[170:173]
    s_barrier
    v_xor_b32 v3, 65536, v3
    v_xor_b32 v4, 65536, v4
    v_mfma_f32_16x16x32_bf16 v[170:173], v[242:245], a[164:167], v[170:173]
    s_cbranch_scc1 L_loop_safe3
    s_branch L_drain
.section .rodata,"a"
.p2align 6
.amdhsa_kernel standalone__window_attn_swin_v2__vision_kernel
  .amdhsa_next_free_vgpr 512
  .amdhsa_next_free_sgpr 102
  .amdhsa_accum_offset 256
  .amdhsa_group_segment_fixed_size 0
  .amdhsa_kernarg_size 96
  .amdhsa_user_sgpr_count 2
  .amdhsa_user_sgpr_kernarg_segment_ptr 1
  .amdhsa_system_sgpr_workgroup_id_x 1
  .amdhsa_float_denorm_mode_32 3
.end_amdhsa_kernel
```

```asm
; @launch grid=(256,1,1) block=(256,1,1) lds=163840
.amdgcn_target "amdgcn-amd-amdhsa--gfx950"
.text
.globl standalone__window_attn_swin_v2__vision_kernel
.p2align 12
.p2align 8
.type standalone__window_attn_swin_v2__vision_kernel,@function
standalone__window_attn_swin_v2__vision_kernel:
    s_mov_b32 s44, 0
L_again:
    s_load_dwordx16 s[76:91], s[0:1], 0
    v_readfirstlane_b32 s16, v0
    s_cmp_ge_u32 s2, 256
    s_cbranch_scc1 L_done
    s_lshr_b32 s16, s16, 6
    s_cbranch_scc1 L_nopf
    s_getpc_b64 s[96:97]
    s_bfe_u32 s3, s2, 0x30003
    s_mul_i32 s3, s3, 42
    v_cmp_gt_u32 vcc, 22, v0
    v_add_u32 v190, s3, v0
    v_mov_b32 v191, 0
    v_cndmask_b32 v190, v190, v0, vcc
    v_lshlrev_b32 v190, 7, v190
    v_lshl_add_u64 v[190:191], s[96:97], 0, v[190:191]
    global_load_dword a255, v[190:191], off offset:992
L_nopf:
    s_max_u32 s3, s2, s44
    s_cmp_ge_u32 s3, 247
    s_cbranch_scc1 L_edge
    v_mov_b32 v190, v0
    v_mov_b32 v191, 0x40000000
    v_and_b32 v254, 63, v0
    s_bfe_u32 s3, s2, 0x50003
    s_lshl_b32 s4, s16, 3
    s_lshr_b32 s98, 0x00123600, s4
    s_and_b32 s98, s98, 0xff
    s_mul_i32 s3, s3, s98
    s_lshr_b32 s4, 0x05113500, s4
    s_and_b32 s4, s4, 0xff
    v_min_u32 v114, s4, v254
    v_add_lshl_u32 v114, v114, s3, 7
    v_mov_b32 v115, 0
    v_lshrrev_b32 v255, 4, v254
    v_and_b32 v116, 15, v254
    s_mov_b32 s10, 100270464
    s_mov_b32 s11, 0x00020000
    s_mov_b32 s50, 221184
    s_mov_b32 s51, 0x00020000
    v_mul_u32_u24 v117, 171, v254
    v_lshrrev_b32 v117, 10, v117
    v_lshrrev_b32 v122, 1, v117
    v_xor_b32 v122, v122, v117
    v_and_b32 v122, 4, v122
    v_mul_u32_u24 v122, 3, v122
    v_xor_b32 v122, v122, v117
    v_mul_u32_u24 v122, 1152, v122
    v_mul_u32_u24 v123, 96, v117
    v_sub_u32 v122, v122, v123
    v_lshl_add_u32 v123, v254, 4, v122
    v_add_u32 v122, 64, v254
    v_mul_u32_u24 v122, 171, v122
    v_lshrrev_b32 v122, 10, v122
    v_lshrrev_b32 v124, 1, v122
    v_xor_b32 v124, v124, v122
    v_and_b32 v124, 4, v124
    v_mul_u32_u24 v124, 3, v124
    v_xor_b32 v124, v124, v122
    v_mul_u32_u24 v124, 1152, v124
    v_mul_u32_u24 v125, 96, v122
    v_sub_u32 v124, v124, v125
    v_lshl_add_u32 v125, v254, 4, v124
    v_add_u32 v124, 128, v254
    v_mul_u32_u24 v124, 171, v124
    v_lshrrev_b32 v124, 10, v124
    v_lshrrev_b32 v126, 1, v124
    v_xor_b32 v126, v126, v124
    v_and_b32 v126, 4, v126
    v_mul_u32_u24 v126, 3, v126
    v_xor_b32 v126, v126, v124
    v_mul_u32_u24 v126, 1152, v126
    v_mul_u32_u24 v127, 96, v124
    v_sub_u32 v126, v126, v127
    v_lshl_add_u32 v127, v254, 4, v126
    s_mul_i32 s68, s16, 6144
    s_add_u32 s69, s68, 65536
    s_cmp_eq_u32 s16, 3
    s_cselect_b32 s68, 136704, s68
    s_cselect_b32 s69, 142848, s69
    s_mul_i32 s45, s16, 96
    s_mov_b32 s70, 193536
    s_mov_b32 s36, 100270464
    s_mov_b32 s22, 1180032
    s_mul_i32 s3, s2, 911
    s_lshr_b32 s3, s3, 16
    s_mul_i32 s99, s3, 72
    s_sub_u32 s38, s2, s99
    s_mul_i32 s3, s3, 1373568
    s_mul_i32 s99, s38, 2688
    s_add_u32 s3, s3, s99
    s_add_u32 s25, s3, 589824
    s_add_u32 s7, s3, 1769472
    s_mov_b32 s20, 31
    s_mov_b32 s21, 4204032
    s_cmp_lt_u32 s2, 244
    s_cselect_b32 s17, 21, 20
    v_mul_u32_u24 v126, 2731, v190
    v_bfe_u32 v128, v126, 17, 3
    v_lshrrev_b32 v126, 16, v126
    v_xor_b32 v129, v128, v190
    v_mul_u32_u24 v128, 37, v126
    v_lshrrev_b32 v128, 8, v128
    v_lshlrev_b32 v129, 4, v129
    v_mad_u32_u24 v10, v128, s70, v129
    v_mul_u32_u24 v128, s20, v126
    v_add_u32 v128, s38, v128
    v_mul_u32_u24 v128, 911, v128
    v_lshrrev_b32 v128, 16, v128
    v_mul_u32_u24 v128, s22, v128
    v_mad_u32_u24 v128, v126, s21, v128
    v_cmp_gt_u32 vcc, s17, v126
    v_add_u32 v128, s7, v128
    s_nop 0
    v_cndmask_b32 v128, v191, v128, vcc
    v_mul_u32_u24 v126, 384, v126
    v_sub_u32 v126, v129, v126
    v_add_u32 v128, v128, v126
    v_add_u32 v126, 256, v190
    v_mul_u32_u24 v129, 2731, v126
    v_bfe_u32 v130, v129, 17, 3
    v_lshrrev_b32 v129, 16, v129
    v_xor_b32 v126, v130, v126
    v_mul_u32_u24 v130, 37, v129
    v_lshrrev_b32 v130, 8, v130
    v_lshlrev_b32 v126, 4, v126
    v_mad_u32_u24 v11, v130, s70, v126
    v_mul_u32_u24 v130, s20, v129
    v_add_u32 v130, s38, v130
    v_mul_u32_u24 v130, 911, v130
    v_lshrrev_b32 v130, 16, v130
    v_mul_u32_u24 v130, s22, v130
    v_mad_u32_u24 v130, v129, s21, v130
    v_cmp_gt_u32 vcc, s17, v129
    v_add_u32 v130, s7, v130
    s_nop 0
    v_cndmask_b32 v130, v191, v130, vcc
    v_mul_u32_u24 v129, 384, v129
    v_sub_u32 v129, v126, v129
    v_add_u32 v130, v130, v129
    s_lshl_b32 s28, s16, 10
    s_add_u32 s28, s28, 20480
    s_waitcnt lgkmcnt(0)
    s_cmp_eq_u32 s16, 2
    s_cselect_b64 s[98:99], s[80:81], s[78:79]
    s_cmp_eq_u32 s16, 3
    s_cselect_b64 s[98:99], s[88:89], s[98:99]
    s_mov_b64 s[8:9], s[76:77]
    v_lshl_add_u64 v[114:115], s[98:99], 0, v[114:115]
    s_cmp_eq_u32 s16, 2
    s_cselect_b64 s[98:99], s[84:85], s[82:83]
    s_cmp_eq_u32 s16, 3
    s_cselect_b64 s[98:99], s[86:87], s[98:99]
    v_writelane_b32 v114, s98, 63
    v_writelane_b32 v115, s99, 63
    s_cmp_eq_u32 s16, 0
    s_cbranch_scc1 L_nowu
    global_load_dword a254, v[114:115], off
L_nowu:
    s_add_u32 m0, s28, 128512
    s_nop 0
    buffer_load_dwordx4 v128, s[8:11], 0 offen nt lds
    s_add_u32 m0, s28, 132608
    s_nop 0
    buffer_load_dwordx4 v130, s[8:11], 0 offen nt lds
    s_add_u32 m0, s28, 0
    s_nop 0
    buffer_load_dwordx4 v10, s[8:11], s25 offen nt lds
    s_add_u32 m0, s28, 4096
    s_nop 0
    buffer_load_dwordx4 v11, s[8:11], s25 offen nt lds
    s_mov_b64 s[48:49], s[78:79]
    s_mov_b64 s[52:53], s[80:81]
    s_mov_b64 s[60:61], s[84:85]
    s_mov_b64 s[64:65], s[86:87]
    s_mov_b64 s[56:57], s[88:89]
    s_mov_b64 s[46:47], s[82:83]
    s_load_dwordx2 s[42:43], s[0:1], 72
    s_add_u32 m0, s68, 0
    s_add_u32 s4, s45, 384
    v_add_u32 v114, s16, v254
    v_and_b32 v114, 3, v114
    v_lshlrev_b32 v114, 1, v114
    s_mov_b32 s54, 73728
    s_mov_b32 s55, 0x00020000
    s_mov_b32 s62, 64
    s_mov_b32 s63, 0x00020000
    s_mov_b32 s66, 128
    s_mov_b32 s67, 0x00020000
    s_mov_b32 s58, 676
    s_mov_b32 s59, 0x00020000
    s_mov_b32 s14, 0
    s_mov_b32 s15, 0x00020000
    v_mov_b32 v193, 0
    v_cmp_lt_u32 s[92:93], 7, v116
    v_mov_b32 v119, 0
    v_mov_b32 v129, 0
    v_mov_b32 v121, 0
    v_lshlrev_b32 v115, 1, v254
    v_mul_u32_u24 v126, 12, v116
    s_mul_i32 s71, s16, 192
    v_add_u32 v126, s71, v126
    v_lshlrev_b32 v128, 5, v255
    s_mul_i32 s72, s16, 8064
    s_add_u32 s72, s72, 104448
    s_mul_i32 s73, s16, 6528
    s_add_u32 s73, s73, 38912
    v_lshrrev_b32 v120, 2, v116
    v_and_b32 v118, 1, v120
    v_mul_u32_u24 v118, 0x020202, v118
    v_lshl_or_b32 v118, v118, 8, v118
    v_add_u32 v118, 0x05040100, v118
    v_and_b32 v131, 3, v116
    v_lshrrev_b32 v192, 1, v116
    v_xor_b32 v192, v192, v255
    v_mul_u32_u24 v130, 384, v116
    v_lshl_add_u32 v0, v192, 4, v130
    v_xor_b32 v1, 64, v0
    v_and_b32 v192, 2, v255
    v_add_u32 v192, v192, v255
    v_lshl_add_u32 v192, v192, 2, v120
    v_mul_u32_u24 v192, 96, v192
    v_lshl_add_u32 v192, v131, 3, v192
    v_add_u32 v133, s68, v192
    v_add_u32 v130, s69, v192
    v_add_u32 v132, s72, v192
    v_add_u32 v134, s73, v192
    v_mov_b32 v28, 0x3f803f80
    v_mov_b32 v29, 0x3f803f80
    v_mov_b32 v30, 0x3f803f80
    v_mov_b32 v31, 0x3f803f80
    v_mul_u32_u24 v135, 768, v255
    v_add_u32 v135, v126, v135
    v_add_u32 v135, 157184, v135
    s_mov_b32 s76, 0x3f80
    v_and_b32 v137, 1, v116
    v_lshlrev_b32 v137, 4, v137
    v_lshlrev_b32 v136, v137, s76
    v_mov_b32 v139, 0x3c003c00
    v_mov_b32 v44, 1.0
    v_mov_b32 v45, 1.0
    v_lshlrev_b32 v138, 4, v255
    s_mov_b32 s19, s38
    s_mov_b32 s23, s25
    s_mov_b32 s26, 0
    s_mov_b32 s27, 0
    s_mov_b32 s18, 0
    s_add_u32 s19, s19, s20
    s_add_u32 s23, s23, s21
    s_cmp_ge_u32 s19, 72
    s_cselect_b32 s34, 72, 0
    s_cselect_b32 s35, s22, 0
    s_sub_u32 s19, s19, s34
    s_add_u32 s23, s23, s35
    s_mov_b32 s24, s23
    s_add_u32 s19, s19, s20
    s_add_u32 s23, s23, s21
    s_cmp_ge_u32 s19, 72
    s_cselect_b32 s34, 72, 0
    s_cselect_b32 s35, s22, 0
    s_sub_u32 s19, s19, s34
    s_add_u32 s23, s23, s35
    s_mul_i32 s79, s16, 64
    v_lshl_add_u32 v141, v255, 4, s79
    s_mul_i32 s80, s16, 32
    s_add_u32 s80, s80, 256
    v_lshl_add_u32 v140, v255, 3, s80
    v_add_u32 v192, 0, v116
    v_mul_u32_u24 v142, 37, v192
    v_mul_u32_u24 v143, 384, v192
    v_lshrrev_b32 v142, 8, v142
    v_mad_u32_u24 v143, v142, s70, v143
    v_add_u32 v15, v143, v141
    v_add_u32 v18, v143, v140
    v_add_u32 v144, 16, v116
    v_mul_u32_u24 v143, 37, v144
    v_mul_u32_u24 v145, 384, v144
    v_lshrrev_b32 v143, 8, v143
    v_mad_u32_u24 v145, v143, s70, v145
    v_add_u32 v16, v145, v141
    v_add_u32 v19, v145, v140
    v_add_u32 v146, 32, v116
    v_mul_u32_u24 v145, 37, v146
    v_mul_u32_u24 v147, 384, v146
    v_lshrrev_b32 v145, 8, v145
    v_mad_u32_u24 v147, v145, s70, v147
    v_add_u32 v17, v147, v141
    v_add_u32 v20, v147, v140
    s_mul_i32 s81, s16, 768
    s_add_u32 s81, s81, 157184
    v_mul_u32_u24 v142, 24, v142
    v_lshl_add_u32 v142, v192, 2, v142
    v_add_u32 v22, s81, v142
    v_sub_u32 v23, s81, v142
    v_sub_u32 v192, v22, v138
    v_mul_u32_u24 v140, 24, v143
    v_lshl_add_u32 v140, v144, 2, v140
    v_add_u32 v24, s81, v140
    v_sub_u32 v25, s81, v140
    v_sub_u32 v141, v24, v138
    v_mul_u32_u24 v140, 24, v145
    v_lshl_add_u32 v140, v146, 2, v140
    v_add_u32 v26, s81, v140
    v_sub_u32 v27, s81, v140
    v_sub_u32 v140, v26, v138
    v_mul_u32_u24 v142, 148, v255
    s_mov_b32 s82, -24
    v_add_u32 v143, 0, v142
    v_lshrrev_b32 v143, 8, v143
    v_mad_i32_i24 v46, v143, s82, v192
    v_mad_i32_i24 v58, v143, s82, v141
    v_mad_i32_i24 v70, v143, s82, v140
    v_add_u32 v143, 37, v142
    v_lshrrev_b32 v143, 8, v143
    v_mad_i32_i24 v47, v143, s82, v192
    v_mad_i32_i24 v59, v143, s82, v141
    v_mad_i32_i24 v71, v143, s82, v140
    v_add_u32 v143, 74, v142
    v_lshrrev_b32 v143, 8, v143
    v_mad_i32_i24 v48, v143, s82, v192
    v_mad_i32_i24 v60, v143, s82, v141
    v_mad_i32_i24 v72, v143, s82, v140
    v_add_u32 v143, 111, v142
    v_lshrrev_b32 v143, 8, v143
    v_mad_i32_i24 v49, v143, s82, v192
    v_mad_i32_i24 v61, v143, s82, v141
    v_mad_i32_i24 v73, v143, s82, v140
    v_add_u32 v143, 592, v142
    v_lshrrev_b32 v143, 8, v143
    v_mad_i32_i24 v50, v143, s82, v192
    v_mad_i32_i24 v62, v143, s82, v141
    v_mad_i32_i24 v74, v143, s82, v140
    v_add_u32 v143, 629, v142
    v_lshrrev_b32 v143, 8, v143
    v_mad_i32_i24 v51, v143, s82, v192
    v_mad_i32_i24 v63, v143, s82, v141
    v_mad_i32_i24 v75, v143, s82, v140
    v_add_u32 v143, 666, v142
    v_lshrrev_b32 v143, 8, v143
    v_mad_i32_i24 v52, v143, s82, v192
    v_mad_i32_i24 v64, v143, s82, v141
    v_mad_i32_i24 v76, v143, s82, v140
    v_add_u32 v143, 703, v142
    v_lshrrev_b32 v143, 8, v143
    v_mad_i32_i24 v53, v143, s82, v192
    v_mad_i32_i24 v65, v143, s82, v141
    v_mad_i32_i24 v77, v143, s82, v140
    v_add_u32 v143, 1184, v142
    v_lshrrev_b32 v143, 8, v143
    v_mad_i32_i24 v54, v143, s82, v192
    v_mad_i32_i24 v66, v143, s82, v141
    s_lshr_b32 s83, s16, 1
    s_and_b32 s84, s16, 1
    buffer_load_dwordx4 v123, s[48:51], s4 offen lds
    v_mad_i32_i24 v78, v143, s82, v140
    v_add_u32 v143, 1221, v142
    v_lshrrev_b32 v143, 8, v143
    v_mad_i32_i24 v55, v143, s82, v192
    v_mad_i32_i24 v67, v143, s82, v141
    v_mad_i32_i24 v79, v143, s82, v140
    v_add_u32 v143, 1258, v142
    v_lshrrev_b32 v143, 8, v143
    v_mad_i32_i24 v56, v143, s82, v192
    v_mad_i32_i24 v68, v143, s82, v141
    v_mad_i32_i24 v80, v143, s82, v140
    s_lshl_b32 s84, s84, 3
    s_lshl_b32 s85, s83, 10
    buffer_load_dwordx4 v125, s[48:51], s4 offen offset:1024 lds
    v_add_u32 v142, 1295, v142
    v_lshrrev_b32 v142, 8, v142
    v_mad_i32_i24 v57, v142, s82, v192
    v_mad_i32_i24 v69, v142, s82, v141
    v_mad_i32_i24 v81, v142, s82, v140
    v_mov_b32 v140, s81
    v_lshlrev_b32 v141, 4, v254
    v_xor_b32 v2, 65536, v141
    v_lshl_add_u32 v3, s16, 10, v141
    s_add_u32 s85, s85, s84
    v_add_u32 v4, s85, v141
    s_lshl_b32 s83, s83, 11
    s_add_u32 s83, s83, s84
    buffer_load_dwordx4 v127, s[48:51], s4 offen offset:2048 lds
    s_add_u32 m0, s68, 3072
    s_add_u32 s4, s45, 37248
    s_add_u32 s83, s83, 144896
    s_mul_i32 s86, s16, 2048
    s_add_u32 s86, s86, 136704
    v_lshl_add_u32 v142, v255, 3, s86
    v_mov_b32 v141, s83
    v_mov_b32 v143, 161536
    v_mul_u32_u24 v144, 80, v255
    v_add3_u32 v5, v144, v137, s72
    v_lshl_add_u32 v6, v116, 2, s73
    s_mul_i32 s87, s16, 128
    s_add_u32 s87, s87, 65024
    buffer_load_ushort v192, v115, s[60:63], 0 offen
    v_add_u32 v9, s87, v138
    s_mov_b32 s40, s8
    s_mov_b32 s41, s9
    buffer_load_dwordx3 v[206:208], v126, s[56:59], 0 offen
    v_lshrrev_b32 v115, 1, v255
    s_mov_b32 s32, 0x2a8cbccc
    s_mov_b32 s33, 0x38fba882
    buffer_load_dwordx4 v[182:185], v128, s[64:67], 0 offen
    v_mul_u32_u24 v115, 48, v115
    s_add_u32 s75, s28, 16384
    s_cmp_lt_u32 s16, 2
    buffer_load_dwordx4 v[194:197], v128, s[64:67], 0 offen offset:16
    v_lshl_add_u32 v115, v255, 3, v115
    s_cselect_b32 s29, s75, 160256
    s_cselect_b32 s30, 65536, 0
    global_load_ushort v114, v114, s[46:47]
    v_lshl_add_u32 v115, v120, 4, v115
    s_xor_b32 s74, s29, s30
    s_mul_i32 s77, s16, 64
    buffer_load_dwordx4 v123, s[48:51], s4 offen lds
    v_lshl_add_u32 v115, v131, 1, v115
    v_add_u32 v8, s87, v115
    v_mov_b32 v37, 0
    v_mov_b32 v38, 0
    v_mov_b32 v39, 0
    v_add_u32 v126, 148992, v0
    v_add_u32 v145, 148992, v1
    v_lshlrev_b32 v128, 4, v116
    v_add_u32 v128, 160256, v128
    v_mul_u32_u24 v115, 336, v116
    v_add3_u32 v115, v115, v144, s72
    s_mul_i32 s78, s16, 32
    s_add_u32 s78, s78, 192
    buffer_load_dwordx4 v125, s[48:51], s4 offen offset:1024 lds
    v_mul_u32_u24 v144, 272, v116
    v_add3_u32 v144, v144, v138, s73
    v_mul_u32_u24 v147, 1088, v255
    v_add_u32 v147, v147, v6
    v_add_u32 v146, 5376, v115
    v_add_u32 v162, 4352, v144
    v_add_u32 v148, 4352, v147
    v_cmp_gt_u32 s[88:89], 16, v254
    v_mov_b32 v149, 0xf149f2ca
    v_add_u32 v209, 512, v190
    v_mul_u32_u24 v163, 2731, v209
    s_add_u32 s34, s18, 2
    s_mov_b32 s18, 1
    buffer_load_dwordx4 v127, s[48:51], s4 offen offset:2048 lds
    s_add_u32 m0, s69, 0
    s_add_u32 s4, s45, 74112
    v_bfe_u32 v164, v163, 17, 3
    v_lshrrev_b32 v163, 16, v163
    v_xor_b32 v209, v164, v209
    v_mul_u32_u24 v164, 37, v163
    v_lshrrev_b32 v164, 8, v164
    v_lshlrev_b32 v209, 4, v209
    v_mad_u32_u24 v12, v164, s70, v209
    v_add_u32 v209, 768, v190
    v_mul_u32_u24 v163, 2731, v209
    s_mov_b32 s27, s26
    s_mov_b32 s26, s25
    buffer_load_dwordx4 v123, s[48:51], s4 offen lds
    v_bfe_u32 v164, v163, 17, 3
    v_lshrrev_b32 v163, 16, v163
    v_xor_b32 v209, v164, v209
    v_mul_u32_u24 v164, 37, v163
    v_lshrrev_b32 v164, 8, v164
    v_lshlrev_b32 v209, 4, v209
    v_mad_u32_u24 v13, v164, s70, v209
    v_add_u32 v190, 1024, v190
    v_mul_u32_u24 v163, 2731, v190
    v_bfe_u32 v209, v163, 17, 3
    v_lshrrev_b32 v163, 16, v163
    v_xor_b32 v190, v209, v190
    v_mul_u32_u24 v209, 37, v163
    v_lshrrev_b32 v209, 8, v209
    v_lshlrev_b32 v190, 4, v190
    v_mad_u32_u24 v14, v209, s70, v190
    v_cmp_gt_u32 vcc, 48, v163
    v_mul_u32_u24 v190, 6, v117
    v_sub_u32 v209, v254, v190
    v_cndmask_b32 v14, v191, v14, vcc
    v_cmp_gt_u32 vcc, 2, v131
    v_mul_u32_u24 v190, 384, v117
    v_lshl_add_u32 v190, v209, 4, v190
    v_cndmask_b32 v32, 0, v136, vcc
    v_cndmask_b32 v33, v136, 0, vcc
    v_cndmask_b32 v34, 0, v136, vcc
    v_cndmask_b32 v35, v136, 0, vcc
    v_cmp_eq_u32 vcc, 0, v137
    v_add_u32 v117, s78, v190
    v_add_u32 v190, s77, v190
    v_cndmask_b32 v40, 0, v139, vcc
    v_cndmask_b32 v41, v139, 0, vcc
    v_cndmask_b32 v42, 0, v139, vcc
    v_cndmask_b32 v43, v139, 0, vcc
    v_cmp_eq_u32 vcc, v255, v120
    v_mul_u32_u24 v139, 6, v122
    v_sub_u32 v136, v254, v139
    v_cndmask_b32 v150, 0, v32, vcc
    v_cndmask_b32 v151, 0, v33, vcc
    v_cmp_gt_i32 vcc, 4, v209
    v_mul_u32_u24 v139, 384, v122
    v_lshl_add_u32 v139, v136, 4, v139
    v_cndmask_b32 v152, v117, v190, vcc
    v_add_u32 v122, s78, v139
    v_add_u32 v139, s77, v139
    v_cmp_gt_i32 vcc, -60, v136
    v_mul_u32_u24 v117, 6, v124
    v_sub_u32 v136, v254, v117
    v_cndmask_b32 v153, v122, v139, vcc
    v_mul_u32_u24 v117, 384, v124
    v_lshl_add_u32 v117, v136, 4, v117
    v_add_u32 v139, s78, v117
    v_add_u32 v117, s77, v117
    v_cmp_gt_i32 vcc, -124, v136
    v_mul_u32_u24 v136, 96, v116
    v_add3_u32 v254, v136, v138, s68
    v_cndmask_b32 v122, v139, v117, vcc
    v_cmp_gt_u32 vcc, 2, v255
    v_lshl_add_u32 v124, v255, 3, v136
    v_add3_u32 v124, v124, 64, s68
    v_cndmask_b32 v142, v141, v142, vcc
    v_lshl_add_u32 v142, v120, 9, v142
    v_lshl_add_u32 v142, v131, 1, v142
    v_cmp_gt_u32 vcc, 3, v255
    v_add3_u32 v139, v136, v138, s69
    v_lshl_add_u32 v117, v255, 3, v136
    v_cndmask_b32 v7, v143, v142, vcc
    v_cmp_gt_u32 vcc, 8, v116
    v_add3_u32 v117, v117, 64, s69
    v_add_u32 v116, 16, v116
    v_cndmask_b32 v146, v128, v146, vcc
    v_cndmask_b32 v162, v128, v162, vcc
    v_cmp_gt_u32 vcc, 2, v255
    v_cmp_gt_u32 s[94:95], s17, v116
    v_cmp_ne_u32 s[96:97], 0, v137
    v_cndmask_b32 v148, v128, v148, vcc
    v_cmp_lt_u32 s[98:99], 1, v131
    v_cmp_eq_u32 vcc, v255, v120
    v_sub_u32 v255, v144, v138
    v_sub_u32 v131, v162, v138
    v_cndmask_b32 v255, v128, v255, vcc
    v_cndmask_b32 v131, v128, v131, vcc
    s_add_u32 s19, s19, s20
    buffer_load_dwordx4 v125, s[48:51], s4 offen offset:1024 lds
    s_waitcnt vmcnt(12)
    s_barrier
    ds_read_b128 v[198:201], v0 offset:20480
    ds_read_b128 v[226:229], v1 offset:20480
    ds_read_b128 v[222:225], v0 offset:20608
    ds_read_b128 v[170:173], v1 offset:20608
    ds_read_b128 v[242:245], v0 offset:20736
    buffer_load_dwordx4 v127, s[48:51], s4 offen offset:2048 lds
    ds_read_b128 v[210:213], v1 offset:20736
    s_add_u32 m0, s69, 3072
    s_add_u32 s4, s45, 110976
    buffer_load_dwordx4 v123, s[48:51], s4 offen lds
    s_waitcnt vmcnt(12)
    ds_read_b64_tr_b16 a[72:73], v133 offset:0
    s_waitcnt vmcnt(10)
    ds_read_b64_tr_b16 a[74:75], v133 offset:768
    s_waitcnt vmcnt(9)
    ds_read_b64_tr_b16 a[96:97], v133 offset:32
    s_waitcnt vmcnt(8)
    ds_read_b64_tr_b16 a[98:99], v133 offset:800
    s_waitcnt vmcnt(7)
    ds_read_b64_tr_b16 a[120:121], v133 offset:64
    ds_read_b64_tr_b16 a[122:123], v133 offset:832
    buffer_load_dwordx4 v125, s[48:51], s4 offen offset:1024 lds
    v_cndmask_b32 v182, v182, v183, s[92:93]
    v_cndmask_b32 v184, v184, v185, s[92:93]
    v_perm_b32 v136, v184, v182, v118
    v_cndmask_b32 v194, v194, v195, s[92:93]
    v_cndmask_b32 v196, v196, v197, s[92:93]
    v_perm_b32 v137, v196, v194, v118
    v_bfe_u32 v118, v206, v138, 16
    v_bfe_u32 v128, v207, v138, 16
    v_bfe_u32 v120, v208, v138, 16
    v_mfma_f32_16x16x16_bf16 v[206:209], v[192:193], v[118:119], 0
    v_lshlrev_b32 v114, 16, v114
    v_max_f32 v114, 0xc2c80000, v114
    v_min_f32 v114, 0x40930000, v114
    v_mfma_f32_16x16x16_bf16 v[194:197], v[192:193], v[128:129], 0
    v_mul_f32 v114, 0x3fb8aa3b, v114
    v_exp_f32 v114, v114
    v_mfma_f32_16x16x16_bf16 v[182:185], v[192:193], v[120:121], 0
    s_waitcnt lgkmcnt(3)
    buffer_load_dwordx4 v127, s[48:51], s4 offen offset:2048 lds
    v_max_f32 v206, 0, v206
    v_mfma_f32_16x16x32_bf16 v[118:121], a[72:75], v[198:201], 0
    s_waitcnt lgkmcnt(0)
    v_max_f32 v207, 0, v207
    v_max_f32 v208, 0, v208
    v_mfma_f32_16x16x32_bf16 v[190:193], a[96:99], v[198:201], 0
    s_add_u32 m0, s72, 0
    v_max_f32 v209, 0, v209
    v_cvt_pk_bf16_f32 v128, v206, v207
    v_mfma_f32_16x16x32_bf16 v[158:161], a[120:123], v[198:201], 0
    s_add_u32 s4, s45, 147840
    ds_read_b128 v[154:157], v126 offset:6272
    buffer_load_dwordx4 v123, s[48:51], s4 offen lds
    v_cvt_pk_bf16_f32 v129, v208, v209
    v_max_f32 v194, 0, v194
    s_waitcnt vmcnt(7)
    v_mfma_f32_16x16x16_bf16 v[206:209], v[136:137], v[128:129], 0
    ds_read_b64_tr_b16 a[76:77], v133 offset:3072
    ds_read_b64_tr_b16 a[78:79], v133 offset:3840
    ds_read_b64_tr_b16 a[100:101], v133 offset:3104
    ds_read_b64_tr_b16 a[102:103], v133 offset:3872
    ds_read_b64_tr_b16 a[124:125], v133 offset:3136
    ds_read_b64_tr_b16 a[126:127], v133 offset:3904
    v_max_f32 v195, 0, v195
    buffer_load_dwordx4 v125, s[48:51], s4 offen offset:1024 lds
    v_cvt_pk_bf16_f32 v206, v206, v206
    v_and_b32 v206, 0xffff0000, v206
    v_mul_f32 v206, 0xbfb8aa3b, v206
    v_exp_f32 v206, v206
    v_max_f32 v196, 0, v196
    v_add_f32 v206, 1.0, v206
    v_rcp_f32 v206, v206
    v_max_f32 v197, 0, v197
    v_cvt_pk_bf16_f32 v206, v206, v206
    buffer_load_dwordx4 v127, s[48:51], s4 offen offset:2048 lds
    s_add_u32 m0, s72, 3072
    s_add_u32 s4, s45, 184704
    v_and_b32 v206, 0xffff0000, v206
    s_waitcnt lgkmcnt(4)
    v_mfma_f32_16x16x32_bf16 v[118:121], a[76:79], v[226:229], v[118:121]
    s_waitcnt lgkmcnt(2)
    v_add_f32 v206, -0.5, v206
    v_mul_f32 v206, 0x41b8aa3b, v206
    v_mfma_f32_16x16x32_bf16 v[190:193], a[100:103], v[226:229], v[190:193]
    s_waitcnt lgkmcnt(0)
    ds_write_b32 v135, v206 offset:0
    v_mfma_f32_16x16x32_bf16 v[158:161], a[124:127], v[226:229], v[158:161]
    buffer_load_dwordx4 v123, s[48:51], s4 offen lds
    v_cvt_pk_bf16_f32 v128, v194, v195
    v_cvt_pk_bf16_f32 v129, v196, v197
    v_max_f32 v182, 0, v182
    v_max_f32 v183, 0, v183
    v_mfma_f32_16x16x16_bf16 v[206:209], v[136:137], v[128:129], 0
    v_max_f32 v184, 0, v184
    v_max_f32 v185, 0, v185
    v_cvt_pk_bf16_f32 v128, v182, v183
    v_cvt_pk_bf16_f32 v129, v184, v185
    v_cvt_pk_bf16_f32 v114, v114, v114
    v_and_b32 v114, 0xffff0000, v114
    s_waitcnt vmcnt(7)
    v_mfma_f32_16x16x16_bf16 v[194:197], v[136:137], v[128:129], 0
    buffer_load_dwordx4 v125, s[48:51], s4 offen offset:1024 lds
    ds_read_b64_tr_b16 a[80:81], v130 offset:0
    ds_read_b64_tr_b16 a[82:83], v130 offset:768
    ds_read_b64_tr_b16 a[104:105], v130 offset:32
    ds_read_b64_tr_b16 a[106:107], v130 offset:800
    ds_read_b64_tr_b16 a[128:129], v130 offset:64
    ds_read_b64_tr_b16 a[130:131], v130 offset:832
    ds_read_b128 v[182:185], v145 offset:6272
    v_cvt_pk_bf16_f32 v206, v206, v206
    v_and_b32 v206, 0xffff0000, v206
    v_mul_f32 v206, 0xbfb8aa3b, v206
    v_exp_f32 v206, v206
    buffer_load_dwordx4 v127, s[48:51], s4 offen offset:2048 lds
    s_add_u32 m0, s73, 0
    s_add_u32 s4, s45, 36864
    v_add_f32 v206, 1.0, v206
    v_rcp_f32 v206, v206
    v_cvt_pk_bf16_f32 v194, v194, v194
    v_cvt_pk_bf16_f32 v206, v206, v206
    v_and_b32 v206, 0xffff0000, v206
    v_add_f32 v206, -0.5, v206
    v_mul_f32 v206, 0x41b8aa3b, v206
    ds_write_b32 v135, v206 offset:4
    s_waitcnt lgkmcnt(5)
    v_mfma_f32_16x16x32_bf16 v[118:121], a[80:83], v[222:225], v[118:121]
    s_waitcnt lgkmcnt(3)
    buffer_load_dwordx4 v123, s[48:51], s45 offen lds
    v_mfma_f32_16x16x32_bf16 v[190:193], a[104:107], v[222:225], v[190:193]
    s_waitcnt lgkmcnt(1)
    v_and_b32 v194, 0xffff0000, v194
    v_mul_f32 v194, 0xbfb8aa3b, v194
    v_mfma_f32_16x16x32_bf16 v[158:161], a[128:131], v[222:225], v[158:161]
    ds_read_b128 v[166:169], v126 offset:6400
    v_exp_f32 v194, v194
    v_mul_f32 v116, 0x3fb8aa3b, v114
    v_add_f32 v194, 1.0, v194
    buffer_load_dwordx4 v125, s[48:51], s45 offen offset:1024 lds
    s_waitcnt vmcnt(8)
    ds_read_b64_tr_b16 a[84:85], v130 offset:3072
    ds_read_b64_tr_b16 a[86:87], v130 offset:3840
    ds_read_b64_tr_b16 a[108:109], v130 offset:3104
    ds_read_b64_tr_b16 a[110:111], v130 offset:3872
    ds_read_b64_tr_b16 a[132:133], v130 offset:3136
    ds_read_b64_tr_b16 a[134:135], v130 offset:3904
    v_rcp_f32 v194, v194
    v_readfirstlane_b32 s37, v114
    v_cvt_pk_bf16_f32 v194, v194, v194
    buffer_load_dwordx4 v127, s[48:51], s45 offen offset:2048 lds
    s_add_u32 m0, s73, 3072
    v_and_b32 v194, 0xffff0000, v194
    v_add_f32 v194, -0.5, v194
    v_mul_f32 v194, 0x41b8aa3b, v194
    ds_write_b32 v135, v194 offset:8
    v_readfirstlane_b32 s31, v116
    v_mul_f32 v114, 0x3e000000, v114
    v_cmp_lt_f32 s[90:91], 4.0, v114
    buffer_load_dwordx4 v123, s[48:51], s4 offen lds
    s_waitcnt lgkmcnt(5)
    v_mfma_f32_16x16x32_bf16 v[118:121], a[84:87], v[170:173], v[118:121]
    s_waitcnt lgkmcnt(3)
    s_cmp_lg_u64 s[90:91], 0
    s_cbranch_scc1 L_slow
    v_mfma_f32_16x16x32_bf16 v[190:193], a[108:111], v[170:173], v[190:193]
    s_waitcnt lgkmcnt(1)
    v_mfma_f32_16x16x32_bf16 v[158:161], a[132:135], v[170:173], v[158:161]
    ds_read_b128 v[194:197], v145 offset:6400
    s_waitcnt vmcnt(7)
    buffer_load_dwordx4 v125, s[48:51], s4 offen offset:1024 lds
    ds_read_b64_tr_b16 a[88:89], v132 offset:0
    ds_read_b64_tr_b16 a[90:91], v132 offset:768
    ds_read_b64_tr_b16 a[112:113], v132 offset:32
    ds_read_b64_tr_b16 a[114:115], v132 offset:800
    s_waitcnt lgkmcnt(5)
    s_barrier
    ds_read_b64_tr_b16 a[136:137], v132 offset:64
    ds_read_b64_tr_b16 a[138:139], v132 offset:832
    ds_read_b32 v22, v22 offset:0
    ds_read_b32 v23, v23 offset:672
    ds_read_b32 v24, v24 offset:0
    ds_read_b32 v25, v25 offset:672
    buffer_load_dwordx4 v127, s[48:51], s4 offen offset:2048 lds
    ds_read_b32 v26, v26 offset:0
    ds_read_b32 v27, v27 offset:672
    ds_read_b32 v46, v46 offset:336
    s_add_u32 m0, s68, 0
    ds_read_b32 v58, v58 offset:336
    s_add_u32 s4, s45, 73728
    ds_read_b32 v70, v70 offset:336
    ds_read_b32 v47, v47 offset:332
    ds_read_b32 v59, v59 offset:332
    buffer_load_dwordx4 v123, s[48:51], s4 offen lds
    s_waitcnt lgkmcnt(14)
    v_mfma_f32_16x16x32_bf16 v[118:121], a[88:91], v[242:245], v[118:121]
    s_waitcnt lgkmcnt(13)
    ds_read_b32 v71, v71 offset:332
    ds_read_b32 v48, v48 offset:328
    v_mfma_f32_16x16x32_bf16 v[190:193], a[112:115], v[242:245], v[190:193]
    s_waitcnt lgkmcnt(12)
    ds_read_b128 v[206:209], v126 offset:6144
    ds_read_b32 v60, v60 offset:328
    v_mfma_f32_16x16x32_bf16 v[158:161], a[136:139], v[242:245], v[158:161]
    s_waitcnt lgkmcnt(11)
    ds_read_b32 v72, v72 offset:328
    ds_read_b32 v49, v49 offset:324
    s_waitcnt lgkmcnt(12)
    s_waitcnt vmcnt(7)
    buffer_load_dwordx4 v125, s[48:51], s4 offen offset:1024 lds
    ds_read_b64_tr_b16 a[92:93], v132 offset:3072
    ds_read_b64_tr_b16 a[94:95], v132 offset:3840
    ds_read_b64_tr_b16 a[116:117], v132 offset:3104
    ds_read_b64_tr_b16 a[118:119], v132 offset:3872
    ds_read_b64_tr_b16 a[140:141], v132 offset:3136
    ds_read_b64_tr_b16 a[142:143], v132 offset:3904
    ds_read_b32 v61, v61 offset:324
    ds_read_b32 v73, v73 offset:324
    ds_read_b32 v50, v50 offset:272
    buffer_load_dwordx4 v127, s[48:51], s4 offen offset:2048 lds
    ds_read_b32 v62, v62 offset:272
    ds_read_b32 v74, v74 offset:272
    ds_read_b32 v51, v51 offset:268
    s_waitcnt lgkmcnt(15)
    v_mfma_f32_16x16x32_bf16 v[186:189], a[72:75], v[206:209], 0
    s_add_u32 m0, s68, 3072
    ds_read_b32 v63, v63 offset:268
    ds_read_b32 v75, v75 offset:268
    v_mfma_f32_16x16x32_bf16 v[178:181], a[96:99], v[206:209], 0
    s_add_u32 s4, s45, 110592
    ds_read_b32 v52, v52 offset:264
    ds_read_b32 v64, v64 offset:264
    v_mfma_f32_16x16x32_bf16 v[202:205], a[120:123], v[206:209], 0
    s_waitcnt lgkmcnt(15)
    s_waitcnt lgkmcnt(14)
    ds_read_b32 v76, v76 offset:264
    v_mfma_f32_16x16x32_bf16 v[118:121], a[92:95], v[210:213], v[118:121]
    s_waitcnt lgkmcnt(12)
    buffer_load_dwordx4 v123, s[48:51], s4 offen lds
    v_mfma_f32_16x16x32_bf16 v[190:193], a[116:119], v[210:213], v[190:193]
    s_waitcnt lgkmcnt(9)
    ds_read_b128 v[214:217], v145 offset:6144
    ds_read_b32 v53, v53 offset:260
    v_mfma_f32_16x16x32_bf16 v[158:161], a[140:143], v[210:213], v[158:161]
    s_waitcnt lgkmcnt(10)
    ds_read_b32 v65, v65 offset:260
    ds_read_b32 v77, v77 offset:260
    ds_read_b32 v54, v54 offset:208
    ds_read_b32 v66, v66 offset:208
    ds_read_b32 v78, v78 offset:208
    s_waitcnt vmcnt(7)
    ds_read_b64_tr_b16 a[0:1], v134 offset:0
    buffer_load_dwordx4 v125, s[48:51], s4 offen offset:1024 lds
    ds_read_b64_tr_b16 a[2:3], v134 offset:768
    ds_read_b64_tr_b16 a[24:25], v134 offset:32
    ds_read_b64_tr_b16 a[26:27], v134 offset:800
    ds_read_b64_tr_b16 a[48:49], v134 offset:64
    ds_read_b64_tr_b16 a[50:51], v134 offset:832
    ds_read_b32 v55, v55 offset:204
    ds_read_b32 v67, v67 offset:204
    buffer_load_dwordx4 v127, s[48:51], s4 offen offset:2048 lds
    s_waitcnt lgkmcnt(14)
    v_mfma_f32_16x16x32_bf16 v[186:189], a[76:79], v[214:217], v[186:189]
    s_add_u32 m0, s69, 0
    ds_read_b32 v79, v79 offset:204
    ds_read_b32 v56, v56 offset:200
    v_mfma_f32_16x16x32_bf16 v[186:189], a[80:83], v[154:157], v[186:189]
    s_add_u32 s4, s45, 147456
    ds_read_b32 v68, v68 offset:200
    ds_read_b32 v80, v80 offset:200
    v_mfma_f32_16x16x32_bf16 v[186:189], a[84:87], v[182:185], v[186:189]
    s_waitcnt lgkmcnt(11)
    ds_read_b32 v57, v57 offset:196
    ds_read_b32 v69, v69 offset:196
    v_mfma_f32_16x16x32_bf16 v[186:189], a[88:91], v[166:169], v[186:189]
    s_waitcnt lgkmcnt(11)
    buffer_load_dwordx4 v123, s[48:51], s4 offen lds
    v_mfma_f32_16x16x32_bf16 v[206:209], a[0:3], v[198:201], 0
    s_waitcnt lgkmcnt(9)
    ds_read_b32 v81, v81 offset:196
    ds_read_b32 v140, v140 offset:336
    v_mfma_f32_16x16x32_bf16 v[174:177], a[24:27], v[198:201], 0
    s_waitcnt lgkmcnt(9)
    v_cndmask_b32 v22, v149, v22, s[88:89]
    v_cndmask_b32 v24, v149, v24, s[88:89]
    v_mfma_f32_16x16x32_bf16 v[218:221], a[48:51], v[198:201], 0
    s_waitcnt vmcnt(7)
    ds_read_b64_tr_b16 a[4:5], v134 offset:3072
    ds_read_b64_tr_b16 a[6:7], v134 offset:3840
    v_mfma_f32_16x16x32_bf16 v[186:189], a[92:95], v[194:197], v[186:189]
    s_waitcnt lgkmcnt(10)
    buffer_load_dwordx4 v125, s[48:51], s4 offen offset:1024 lds
    v_mfma_f32_16x16x32_bf16 v[178:181], a[100:103], v[214:217], v[178:181]
    s_waitcnt lgkmcnt(8)
    ds_read_b64_tr_b16 a[28:29], v134 offset:3104
    ds_read_b64_tr_b16 a[30:31], v134 offset:3872
    v_mfma_f32_16x16x32_bf16 v[178:181], a[104:107], v[154:157], v[178:181]
    s_waitcnt lgkmcnt(8)
    ds_read_b64_tr_b16 a[52:53], v134 offset:3136
    ds_read_b64_tr_b16 a[54:55], v134 offset:3904
    v_mfma_f32_16x16x32_bf16 v[178:181], a[108:111], v[182:185], v[178:181]
    s_waitcnt lgkmcnt(8)
    ds_read_b128 v[198:201], v126 offset:128
    v_cndmask_b32 v26, v149, v26, s[88:89]
    v_mfma_f32_16x16x32_bf16 v[178:181], a[112:115], v[166:169], v[178:181]
    buffer_load_dwordx4 v127, s[48:51], s4 offen offset:2048 lds
    v_mfma_f32_16x16x32_bf16 v[178:181], a[116:119], v[194:197], v[178:181]
    s_waitcnt lgkmcnt(7)
    v_readfirstlane_b32 s39, v140
    v_mov_b32 v134, 0
    v_mfma_f32_16x16x32_bf16 v[202:205], a[124:127], v[214:217], v[202:205]
    s_add_u32 m0, s69, 3072
    v_mov_b32 v135, 0
    v_mov_b32 v136, 0
    v_mfma_f32_16x16x32_bf16 v[202:205], a[128:131], v[154:157], v[202:205]
    s_waitcnt lgkmcnt(5)
    ds_write_b64 v115, v[134:135] offset:56
    v_mfma_f32_16x16x32_bf16 v[206:209], a[4:7], v[226:229], v[206:209]
    s_add_u32 s4, s45, 184320
    buffer_load_dwordx4 v123, s[48:51], s4 offen lds
    v_mfma_f32_16x16x32_bf16 v[202:205], a[132:135], v[182:185], v[202:205]
    s_waitcnt lgkmcnt(3)
    ds_write_b64 v115, v[134:135] offset:64
    v_mfma_f32_16x16x32_bf16 v[174:177], a[28:31], v[226:229], v[174:177]
    s_waitcnt lgkmcnt(2)
    s_waitcnt vmcnt(7)
    v_mov_b32 v137, 0
    v_mfma_f32_16x16x32_bf16 v[218:221], a[52:55], v[226:229], v[218:221]
    ds_read_b64_tr_b16 a[8:9], v133 offset:0
    ds_read_b64_tr_b16 a[10:11], v133 offset:768
    v_mfma_f32_16x16x32_bf16 v[202:205], a[136:139], v[166:169], v[202:205]
    buffer_load_dwordx4 v125, s[48:51], s4 offen offset:1024 lds
    v_mfma_f32_16x16x32_bf16 v[202:205], a[140:143], v[194:197], v[202:205]
    ds_read_b64_tr_b16 a[32:33], v133 offset:32
    ds_read_b64_tr_b16 a[34:35], v133 offset:800
    ds_read_b64_tr_b16 a[56:57], v133 offset:64
    ds_read_b64_tr_b16 a[58:59], v133 offset:832
    ds_read_b128 v[182:185], v145 offset:128
    ds_write_b128 v115, v[134:137] offset:16
    buffer_load_dwordx4 v127, s[48:51], s4 offen offset:2048 lds
    s_add_u32 m0, s28, 8192
    s_add_u32 s4, s45, 768
    v_mov_b32 v194, v149
    v_mov_b32 v195, v149
    ds_write_b128 v146, v[134:137] offset:16
    s_waitcnt lgkmcnt(7)
    v_mfma_f32_16x16x32_bf16 v[206:209], a[8:11], v[222:225], v[206:209]
    buffer_load_dwordx4 v12, s[8:11], s25 offen nt lds
    s_waitcnt lgkmcnt(5)
    v_mfma_f32_16x16x32_bf16 v[174:177], a[32:35], v[222:225], v[174:177]
    s_waitcnt lgkmcnt(3)
    v_mov_b32 v196, v149
    v_mov_b32 v197, v149
    v_mfma_f32_16x16x32_bf16 v[218:221], a[56:59], v[222:225], v[218:221]
    s_add_u32 m0, s28, 12288
    ds_read_b128 v[222:225], v126 offset:256
    ds_write_b64 v146, v[134:135] offset:56
    s_waitcnt vmcnt(7)
    buffer_load_dwordx4 v13, s[8:11], s25 offen nt lds
    s_add_u32 m0, s29, 0
    ds_read_b64_tr_b16 a[12:13], v133 offset:3072
    ds_read_b64_tr_b16 a[14:15], v133 offset:3840
    ds_read_b64_tr_b16 a[36:37], v133 offset:3104
    ds_read_b64_tr_b16 a[38:39], v133 offset:3872
    ds_read_b64_tr_b16 a[60:61], v133 offset:3136
    ds_read_b64_tr_b16 a[62:63], v133 offset:3904
    ds_write_b64 v146, v[134:135] offset:64
    v_cvt_pk_f16_f32 v118, v118, v119
    buffer_load_dwordx4 v14, s[8:11], s25 offen nt lds
    ds_write_b128 v144, v[194:197] offset:192
    s_add_u32 m0, s68, 0
    s_cmp_lt_u32 1, s17
    s_cselect_b32 s10, s36, 0
    v_pk_mul_f16 v163, v118, v118
    v_cvt_pk_f16_f32 v119, v120, v121
    v_pk_mul_f16 v165, v119, v119
    s_mov_b32 s25, s24
    buffer_load_dwordx4 v123, s[48:51], s4 offen lds
    s_waitcnt lgkmcnt(6)
    v_mfma_f32_16x16x32_bf16 v[206:209], a[12:15], v[170:173], v[206:209]
    s_waitcnt lgkmcnt(4)
    ds_write_b128 v162, v[194:197] offset:192
    v_mfma_f32_16x16x32_bf16 v[174:177], a[36:39], v[170:173], v[174:177]
    s_waitcnt lgkmcnt(2)
    v_cvt_pk_f16_f32 v120, v190, v191
    v_pk_fma_f16 v163, v120, v120, v163
    v_mfma_f32_16x16x32_bf16 v[218:221], a[60:63], v[170:173], v[218:221]
    s_waitcnt vmcnt(7)
    buffer_load_dwordx4 v125, s[48:51], s4 offen offset:1024 lds
    ds_read_b64_tr_b16 a[16:17], v130 offset:0
    ds_read_b64_tr_b16 a[18:19], v130 offset:768
    ds_read_b64_tr_b16 a[40:41], v130 offset:32
    ds_read_b64_tr_b16 a[42:43], v130 offset:800
    ds_read_b64_tr_b16 a[64:65], v130 offset:64
    ds_read_b64_tr_b16 a[66:67], v130 offset:832
    ds_read_b128 v[226:229], v145 offset:256
    v_cvt_pk_f16_f32 v121, v192, v193
    v_pk_fma_f16 v165, v121, v121, v165
    v_cvt_pk_f16_f32 v196, v158, v159
    buffer_load_dwordx4 v127, s[48:51], s4 offen offset:2048 lds
    s_add_u32 m0, s68, 3072
    s_add_u32 s4, s45, 37632
    v_pk_fma_f16 v163, v196, v196, v163
    v_cvt_pk_f16_f32 v197, v160, v161
    v_pk_fma_f16 v165, v197, v197, v165
    v_cvt_pk_f16_f32 v190, v186, v187
    v_pk_mul_f16 v171, v190, v190
    v_cvt_pk_f16_f32 v191, v188, v189
    v_pk_mul_f16 v173, v191, v191
    v_cvt_pk_f16_f32 v192, v178, v179
    v_pk_fma_f16 v171, v192, v192, v171
    buffer_load_dwordx4 v123, s[48:51], s4 offen lds
    s_waitcnt lgkmcnt(5)
    v_mfma_f32_16x16x32_bf16 v[206:209], a[16:19], v[242:245], v[206:209]
    s_waitcnt lgkmcnt(3)
    v_cvt_pk_f16_f32 v193, v180, v181
    v_pk_fma_f16 v173, v193, v193, v173
    v_mfma_f32_16x16x32_bf16 v[174:177], a[40:43], v[242:245], v[174:177]
    s_waitcnt lgkmcnt(0)
    ds_read_b128 v[134:137], v126 offset:0
    v_cvt_pk_f16_f32 v156, v202, v203
    v_mfma_f32_16x16x32_bf16 v[218:221], a[64:67], v[242:245], v[218:221]
    buffer_load_dwordx4 v125, s[48:51], s4 offen offset:1024 lds
    v_pk_fma_f16 v171, v156, v156, v171
    s_waitcnt vmcnt(8)
    ds_read_b64_tr_b16 a[20:21], v130 offset:3072
    ds_read_b64_tr_b16 a[22:23], v130 offset:3840
    ds_read_b64_tr_b16 a[44:45], v130 offset:3104
    ds_read_b64_tr_b16 a[46:47], v130 offset:3872
    ds_read_b64_tr_b16 a[68:69], v130 offset:3136
    ds_read_b64_tr_b16 a[70:71], v130 offset:3904
    v_cvt_pk_f16_f32 v157, v204, v205
    v_pk_fma_f16 v173, v157, v157, v173
    buffer_load_dwordx4 v127, s[48:51], s4 offen offset:2048 lds
    s_add_u32 m0, s69, 0
    s_add_u32 s4, s45, 74496
    s_waitcnt lgkmcnt(6)
    v_mfma_f32_16x16x32_bf16 v[242:245], a[72:75], v[134:137], 0
    v_mfma_f32_16x16x32_bf16 v[178:181], a[96:99], v[134:137], 0
    ds_read_b128 v[158:161], v126 offset:6144
    v_mfma_f32_16x16x32_bf16 v[202:205], a[120:123], v[134:137], 0
    buffer_load_dwordx4 v123, s[48:51], s4 offen lds
    v_mfma_f32_16x16x32_bf16 v[166:169], a[0:3], v[134:137], 0
    s_waitcnt lgkmcnt(4)
    v_mfma_f32_16x16x32_bf16 v[206:209], a[20:23], v[210:213], v[206:209]
    s_waitcnt lgkmcnt(1)
    v_mfma_f32_16x16x32_bf16 v[174:177], a[44:47], v[210:213], v[174:177]
    ds_read_b128 v[186:189], v145 offset:0
    v_mfma_f32_16x16x32_bf16 v[218:221], a[68:71], v[210:213], v[218:221]
    buffer_load_dwordx4 v125, s[48:51], s4 offen offset:1024 lds
    v_mfma_f32_16x16x32_bf16 v[210:213], a[24:27], v[134:137], 0
    v_mfma_f32_16x16x32_bf16 v[214:217], a[48:51], v[134:137], 0
    s_nop 0
    s_waitcnt lgkmcnt(1)
    v_cvt_pk_f16_f32 v206, v206, v207
    v_mfma_f32_16x16x32_bf16 v[230:233], a[0:3], v[158:161], 0
    v_pk_mul_f16 v162, v206, v206
    v_cvt_pk_f16_f32 v207, v208, v209
    v_mfma_f32_16x16x32_bf16 v[234:237], a[24:27], v[158:161], 0
    buffer_load_dwordx4 v127, s[48:51], s4 offen offset:2048 lds
    v_mfma_f32_16x16x32_bf16 v[134:137], a[48:51], v[158:161], 0
    s_add_u32 m0, s69, 3072
    s_add_u32 s4, s45, 111360
    v_pk_mul_f16 v164, v207, v207
    v_cvt_pk_f16_f32 v208, v174, v175
    v_pk_fma_f16 v162, v208, v208, v162
    s_waitcnt lgkmcnt(0)
    v_mfma_f32_16x16x32_bf16 v[242:245], a[76:79], v[186:189], v[242:245]
    v_cvt_pk_f16_f32 v209, v176, v177
    v_pk_fma_f16 v164, v209, v209, v164
    v_mfma_f32_16x16x32_bf16 v[242:245], a[80:83], v[198:201], v[242:245]
    v_cvt_pk_f16_f32 v194, v218, v219
    v_pk_fma_f16 v162, v194, v194, v162
    v_mfma_f32_16x16x32_bf16 v[242:245], a[84:87], v[182:185], v[242:245]
    v_cvt_pk_f16_f32 v195, v220, v221
    v_pk_fma_f16 v164, v195, v195, v164
    v_mfma_f32_16x16x32_bf16 v[242:245], a[88:91], v[222:225], v[242:245]
    v_mfma_f32_16x16x32_bf16 v[242:245], a[92:95], v[226:229], v[242:245]
    v_mfma_f32_16x16x32_f16 v[158:161], v[40:43], v[162:165], 0
    v_mfma_f32_16x16x32_bf16 v[178:181], a[100:103], v[186:189], v[178:181]
    ds_read_b128 v[174:177], v145 offset:6144
    v_mfma_f32_16x16x32_bf16 v[178:181], a[104:107], v[198:201], v[178:181]
    ds_read_b128 v[218:221], v126 offset:6272
    v_mfma_f32_16x16x32_bf16 v[178:181], a[108:111], v[182:185], v[178:181]
    ds_read_b128 v[162:165], v145 offset:6272
    v_mfma_f32_16x16x32_bf16 v[178:181], a[112:115], v[222:225], v[178:181]
    ds_read_b128 v[238:241], v126 offset:6400
    v_min3_u32 v44, v44, v158, v159
    v_mfma_f32_16x16x32_bf16 v[178:181], a[116:119], v[226:229], v[178:181]
    ds_read_b128 v[246:249], v145 offset:6400
    v_max3_u32 v45, v45, v158, v159
    v_mfma_f32_16x16x32_bf16 v[202:205], a[124:127], v[186:189], v[202:205]
    v_rsq_f32 v160, v158
    v_mfma_f32_16x16x32_bf16 v[202:205], a[128:131], v[198:201], v[202:205]
    v_rsq_f32 v161, v159
    v_mfma_f32_16x16x32_bf16 v[202:205], a[132:135], v[182:185], v[202:205]
    v_mul_f32 v160, s31, v160
    v_cvt_pk_f16_f32 v160, v160, v161
    v_mfma_f32_16x16x32_bf16 v[202:205], a[136:139], v[222:225], v[202:205]
    s_waitcnt lgkmcnt(4)
    v_pk_mul_f16 v118, v118, v160 op_sel:[0,1] op_sel_hi:[1,1]
    v_pk_mul_f16 v119, v119, v160 op_sel:[0,1] op_sel_hi:[1,1]
    v_mfma_f32_16x16x32_bf16 v[202:205], a[140:143], v[226:229], v[202:205]
    s_waitcnt lgkmcnt(3)
    v_pk_mul_f16 v120, v120, v160 op_sel:[0,1] op_sel_hi:[1,1]
    v_pk_mul_f16 v121, v121, v160 op_sel:[0,1] op_sel_hi:[1,1]
    v_mfma_f32_16x16x32_bf16 v[166:169], a[4:7], v[186:189], v[166:169]
    s_waitcnt lgkmcnt(2)
    v_pk_mul_f16 v196, v196, v160 op_sel:[0,1] op_sel_hi:[1,1]
    v_pk_mul_f16 v197, v197, v160 op_sel:[0,1] op_sel_hi:[1,1]
    v_mfma_f32_16x16x32_bf16 v[166:169], a[8:11], v[198:201], v[166:169]
    s_waitcnt lgkmcnt(1)
    v_pk_mul_f16 v206, v206, v160 op_sel:[0,0] op_sel_hi:[1,0]
    v_pk_mul_f16 v207, v207, v160 op_sel:[0,0] op_sel_hi:[1,0]
    v_mfma_f32_16x16x32_bf16 v[166:169], a[12:15], v[182:185], v[166:169]
    s_waitcnt lgkmcnt(0)
    v_pk_mul_f16 v208, v208, v160 op_sel:[0,0] op_sel_hi:[1,0]
    v_pk_mul_f16 v209, v209, v160 op_sel:[0,0] op_sel_hi:[1,0]
    v_mfma_f32_16x16x32_bf16 v[166:169], a[16:19], v[222:225], v[166:169]
    v_pk_mul_f16 v194, v194, v160 op_sel:[0,0] op_sel_hi:[1,0]
    v_pk_mul_f16 v195, v195, v160 op_sel:[0,0] op_sel_hi:[1,0]
    v_mfma_f32_16x16x32_bf16 v[166:169], a[20:23], v[226:229], v[166:169]
    v_cvt_pk_f16_f32 v158, v242, v243
    v_pk_mul_f16 v243, v158, v158
    v_mfma_f32_16x16x32_bf16 v[210:213], a[28:31], v[186:189], v[210:213]
    v_cvt_pk_f16_f32 v159, v244, v245
    v_pk_mul_f16 v245, v159, v159
    v_mfma_f32_16x16x32_bf16 v[210:213], a[32:35], v[198:201], v[210:213]
    v_cvt_pk_f16_f32 v160, v178, v179
    v_pk_fma_f16 v243, v160, v160, v243
    v_mfma_f32_16x16x32_bf16 v[210:213], a[36:39], v[182:185], v[210:213]
    v_cvt_pk_f16_f32 v161, v180, v181
    v_pk_fma_f16 v245, v161, v161, v245
    v_mfma_f32_16x16x32_bf16 v[210:213], a[40:43], v[222:225], v[210:213]
    v_cvt_pk_f16_f32 v180, v202, v203
    v_pk_fma_f16 v243, v180, v180, v243
    v_mfma_f32_16x16x32_bf16 v[210:213], a[44:47], v[226:229], v[210:213]
    v_cvt_pk_f16_f32 v181, v204, v205
    v_pk_fma_f16 v245, v181, v181, v245
    v_mfma_f32_16x16x32_bf16 v[214:217], a[52:55], v[186:189], v[214:217]
    v_cvt_pk_f16_f32 v166, v166, v167
    v_pk_mul_f16 v242, v166, v166
    v_mfma_f32_16x16x32_bf16 v[214:217], a[56:59], v[198:201], v[214:217]
    v_cvt_pk_f16_f32 v167, v168, v169
    v_pk_mul_f16 v244, v167, v167
    v_mfma_f32_16x16x32_bf16 v[214:217], a[60:63], v[182:185], v[214:217]
    v_cvt_pk_f16_f32 v168, v210, v211
    v_pk_fma_f16 v242, v168, v168, v242
    v_mfma_f32_16x16x32_bf16 v[214:217], a[64:67], v[222:225], v[214:217]
    v_cvt_pk_f16_f32 v169, v212, v213
    v_pk_fma_f16 v244, v169, v169, v244
    v_mfma_f32_16x16x32_bf16 v[214:217], a[68:71], v[226:229], v[214:217]
    v_mfma_f32_16x16x32_bf16 v[230:233], a[4:7], v[174:177], v[230:233]
    v_mfma_f32_16x16x32_bf16 v[230:233], a[8:11], v[218:221], v[230:233]
    v_mfma_f32_16x16x32_bf16 v[230:233], a[12:15], v[162:165], v[230:233]
    v_mfma_f32_16x16x32_bf16 v[230:233], a[16:19], v[238:241], v[230:233]
    v_mfma_f32_16x16x32_bf16 v[230:233], a[20:23], v[246:249], v[230:233]
    v_mfma_f32_16x16x32_bf16 v[234:237], a[28:31], v[174:177], v[234:237]
    v_mfma_f32_16x16x32_bf16 v[234:237], a[32:35], v[218:221], v[234:237]
    v_mfma_f32_16x16x32_bf16 v[234:237], a[36:39], v[162:165], v[234:237]
    v_cvt_pk_f16_f32 v178, v214, v215
    v_pk_fma_f16 v242, v178, v178, v242
    v_mfma_f32_16x16x32_bf16 v[234:237], a[40:43], v[238:241], v[234:237]
    v_cvt_pk_f16_f32 v179, v216, v217
    v_pk_fma_f16 v244, v179, v179, v244
    v_mfma_f32_16x16x32_bf16 v[234:237], a[44:47], v[246:249], v[234:237]
    v_cvt_pk_f16_f32 v222, v230, v231
    v_pk_mul_f16 v170, v222, v222
    v_mfma_f32_16x16x32_f16 v[182:185], v[40:43], v[242:245], 0
    v_cvt_pk_f16_f32 v223, v232, v233
    v_pk_mul_f16 v172, v223, v223
    v_mfma_f32_16x16x32_bf16 v[134:137], a[52:55], v[174:177], v[134:137]
    v_mfma_f32_16x16x32_bf16 v[134:137], a[56:59], v[218:221], v[134:137]
    v_mfma_f32_16x16x32_bf16 v[134:137], a[60:63], v[162:165], v[134:137]
    v_cvt_pk_f16_f32 v224, v234, v235
    v_pk_fma_f16 v170, v224, v224, v170
    v_mfma_f32_16x16x32_bf16 v[134:137], a[64:67], v[238:241], v[134:137]
    v_rsq_f32 v184, v182
    v_mfma_f32_16x16x32_bf16 v[134:137], a[68:71], v[246:249], v[134:137]
    v_rsq_f32 v185, v183
    v_mfma_f32_16x16x32_f16 v[210:213], v[118:121], v[206:209], v[46:49]
    v_mul_f32 v184, s31, v184
    v_cvt_pk_f16_f32 v184, v184, v185
    v_pk_mul_f16 v158, v158, v184 op_sel:[0,1] op_sel_hi:[1,1]
    v_pk_mul_f16 v159, v159, v184 op_sel:[0,1] op_sel_hi:[1,1]
    v_pk_mul_f16 v160, v160, v184 op_sel:[0,1] op_sel_hi:[1,1]
    v_pk_mul_f16 v161, v161, v184 op_sel:[0,1] op_sel_hi:[1,1]
    v_mfma_f32_16x16x16_f16 v[210:213], v[196:197], v[194:195], v[210:213]
    v_pk_mul_f16 v180, v180, v184 op_sel:[0,1] op_sel_hi:[1,1]
    v_pk_mul_f16 v181, v181, v184 op_sel:[0,1] op_sel_hi:[1,1]
    v_pk_mul_f16 v166, v166, v184 op_sel:[0,0] op_sel_hi:[1,0]
    v_pk_mul_f16 v167, v167, v184 op_sel:[0,0] op_sel_hi:[1,0]
    v_pk_mul_f16 v168, v168, v184 op_sel:[0,0] op_sel_hi:[1,0]
    v_pk_mul_f16 v169, v169, v184 op_sel:[0,0] op_sel_hi:[1,0]
    v_pk_mul_f16 v178, v178, v184 op_sel:[0,0] op_sel_hi:[1,0]
    v_pk_mul_f16 v179, v179, v184 op_sel:[0,0] op_sel_hi:[1,0]
    v_mfma_f32_16x16x32_f16 v[242:245], v[158:161], v[166:169], 0
    ds_write_b128 v115, v[158:161]
    v_min3_u32 v44, v44, v182, v183
    v_max3_u32 v45, v45, v182, v183
    v_cvt_pk_f16_f32 v225, v236, v237
    v_pk_fma_f16 v172, v225, v225, v172
    v_cvt_pk_f16_f32 v154, v134, v135
    v_mfma_f32_16x16x16_f16 v[242:245], v[180:181], v[178:179], v[242:245]
    v_pk_fma_f16 v170, v154, v154, v170
    ds_write_b64 v115, v[180:181] offset:48
    v_cvt_pk_f16_f32 v155, v136, v137
    v_pk_fma_f16 v172, v155, v155, v172
    v_exp_f32 v210, v210
    ds_write_b128 v115, v[166:169] offset:32
    v_mfma_f32_16x16x32_f16 v[182:185], v[40:43], v[170:173], 0
    v_exp_f32 v211, v211
    v_cndmask_b32 v242, v242, v243, s[96:97]
    v_cndmask_b32 v244, v244, v245, s[96:97]
    v_cndmask_b32 v242, v242, v244, s[98:99]
    v_add_f32 v242, s39, v242
    ds_write_b32 v255, v242 offset:192
    v_cvt_pk_bf16_f32 v210, v210, v211
    v_exp_f32 v212, v212
    v_rsq_f32 v184, v182
    ds_write_b64 v115, v[178:179] offset:72
    v_rsq_f32 v185, v183
    v_mul_f32 v184, s31, v184
    v_cvt_pk_f16_f32 v184, v184, v185
    v_pk_mul_f16 v190, v190, v184 op_sel:[0,1] op_sel_hi:[1,1]
    v_pk_mul_f16 v191, v191, v184 op_sel:[0,1] op_sel_hi:[1,1]
    v_pk_mul_f16 v192, v192, v184 op_sel:[0,1] op_sel_hi:[1,1]
    v_pk_mul_f16 v193, v193, v184 op_sel:[0,1] op_sel_hi:[1,1]
    v_pk_mul_f16 v156, v156, v184 op_sel:[0,1] op_sel_hi:[1,1]
    v_pk_mul_f16 v157, v157, v184 op_sel:[0,1] op_sel_hi:[1,1]
    v_pk_mul_f16 v222, v222, v184 op_sel:[0,0] op_sel_hi:[1,0]
    v_pk_mul_f16 v223, v223, v184 op_sel:[0,0] op_sel_hi:[1,0]
    v_pk_mul_f16 v224, v224, v184 op_sel:[0,0] op_sel_hi:[1,0]
    v_pk_mul_f16 v225, v225, v184 op_sel:[0,0] op_sel_hi:[1,0]
    v_pk_mul_f16 v154, v154, v184 op_sel:[0,0] op_sel_hi:[1,0]
    v_pk_mul_f16 v155, v155, v184 op_sel:[0,0] op_sel_hi:[1,0]
    v_mfma_f32_16x16x32_f16 v[242:245], v[190:193], v[222:225], 0
    ds_write_b128 v146, v[190:193]
    v_cndmask_b32 v182, 1.0, v182, s[94:95]
    v_cndmask_b32 v183, 1.0, v183, s[94:95]
    v_min3_u32 v44, v44, v182, v183
    v_max3_u32 v45, v45, v182, v183
    v_exp_f32 v213, v213
    v_mfma_f32_16x16x16_f16 v[242:245], v[156:157], v[154:155], v[242:245]
    ds_write_b64 v146, v[156:157] offset:48
    v_cvt_pk_bf16_f32 v211, v212, v213
    s_nop 0
    buffer_load_dwordx4 v123, s[48:51], s4 offen lds
    ds_write_b128 v146, v[222:225] offset:32
    s_nop 0
    s_nop 0
    s_nop 0
    v_cndmask_b32 v242, v242, v243, s[96:97]
    v_cndmask_b32 v244, v244, v245, s[96:97]
    v_cndmask_b32 v242, v242, v244, s[98:99]
    buffer_load_dwordx4 v125, s[48:51], s4 offen offset:1024 lds
    ds_write_b64 v146, v[154:155] offset:72
    v_add_f32 v242, s39, v242
    buffer_load_dwordx4 v127, s[48:51], s4 offen offset:2048 lds
    s_waitcnt vmcnt(12)
    s_barrier
    ds_read_b128 v[182:185], v0 offset:26624
    ds_read_b128 v[190:193], v1 offset:26624
    ds_read_b128 v[134:137], v0 offset:26752
    s_add_u32 m0, s68, 0
    s_add_u32 s4, s45, 148224
    ds_read_b128 v[222:225], v1 offset:26752
    ds_read_b128 v[198:201], v0 offset:26880
    ds_read_b128 v[226:229], v1 offset:26880
    ds_write_b32 v131, v242 offset:192
    s_waitcnt lgkmcnt(6)
    v_mfma_f32_16x16x32_bf16 v[242:245], a[72:75], v[182:185], 0
    s_waitcnt lgkmcnt(5)
    v_mfma_f32_16x16x32_bf16 v[242:245], a[76:79], v[190:193], v[242:245]
    s_waitcnt lgkmcnt(3)
    v_mfma_f32_16x16x32_bf16 v[242:245], a[80:83], v[134:137], v[242:245]
    s_waitcnt lgkmcnt(2)
    v_mfma_f32_16x16x32_bf16 v[242:245], a[84:87], v[222:225], v[242:245]
    s_waitcnt vmcnt(9)
    ds_read_b64_tr_b16 a[144:145], v133 offset:0
    ds_read_b64_tr_b16 a[146:147], v133 offset:768
    v_mfma_f32_16x16x32_bf16 v[242:245], a[88:91], v[198:201], v[242:245]
    s_waitcnt lgkmcnt(2)
    ds_read_b64_tr_b16 a[168:169], v133 offset:32
    ds_read_b64_tr_b16 a[170:171], v133 offset:800
    v_mfma_f32_16x16x32_bf16 v[242:245], a[92:95], v[226:229], v[242:245]
    ds_read_b64_tr_b16 a[192:193], v133 offset:64
    ds_read_b64_tr_b16 a[194:195], v133 offset:832
    v_mfma_f32_16x16x32_bf16 v[158:161], a[96:99], v[182:185], 0
    ds_read_b128 v[170:173], v0 offset:32768
    v_mfma_f32_16x16x32_bf16 v[158:161], a[100:103], v[190:193], v[158:161]
    ds_read_b128 v[154:157], v1 offset:32768
    v_mfma_f32_16x16x32_bf16 v[158:161], a[104:107], v[134:137], v[158:161]
    ds_read_b128 v[174:177], v0 offset:32896
    v_cvt_pk_f16_f32 v242, v242, v243
    v_mfma_f32_16x16x32_bf16 v[158:161], a[108:111], v[222:225], v[158:161]
    ds_read_b128 v[166:169], v1 offset:32896
    v_pk_mul_f16 v179, v242, v242
    v_mfma_f32_16x16x32_bf16 v[158:161], a[112:115], v[198:201], v[158:161]
    ds_read_b128 v[162:165], v0 offset:33024
    v_cvt_pk_f16_f32 v243, v244, v245
    v_mfma_f32_16x16x32_bf16 v[158:161], a[116:119], v[226:229], v[158:161]
    s_waitcnt lgkmcnt(9)
    ds_read_b128 v[202:205], v1 offset:33024
    v_pk_mul_f16 v181, v243, v243
    v_mfma_f32_16x16x32_bf16 v[218:221], a[120:123], v[182:185], 0
    s_waitcnt lgkmcnt(8)
    v_mfma_f32_16x16x32_bf16 v[218:221], a[124:127], v[190:193], v[218:221]
    s_waitcnt lgkmcnt(6)
    buffer_load_dwordx4 v123, s[48:51], s4 offen lds
    v_mfma_f32_16x16x32_bf16 v[218:221], a[128:131], v[134:137], v[218:221]
    s_waitcnt lgkmcnt(5)
    s_waitcnt vmcnt(7)
    ds_read_b64_tr_b16 a[148:149], v133 offset:3072
    v_mfma_f32_16x16x32_bf16 v[218:221], a[132:135], v[222:225], v[218:221]
    s_waitcnt lgkmcnt(5)
    ds_read_b64_tr_b16 a[150:151], v133 offset:3840
    ds_read_b64_tr_b16 a[172:173], v133 offset:3104
    v_mfma_f32_16x16x32_bf16 v[218:221], a[136:139], v[198:201], v[218:221]
    s_waitcnt lgkmcnt(6)
    ds_read_b64_tr_b16 a[174:175], v133 offset:3872
    ds_read_b64_tr_b16 a[196:197], v133 offset:3136
    v_mfma_f32_16x16x32_bf16 v[218:221], a[140:143], v[226:229], v[218:221]
    s_waitcnt lgkmcnt(7)
    buffer_load_dwordx4 v125, s[48:51], s4 offen offset:1024 lds
    v_mfma_f32_16x16x32_bf16 v[186:189], a[0:3], v[182:185], 0
    s_waitcnt lgkmcnt(6)
    ds_read_b64_tr_b16 a[198:199], v133 offset:3904
    v_cvt_pk_f16_f32 v244, v158, v159
    v_mfma_f32_16x16x32_bf16 v[186:189], a[4:7], v[190:193], v[186:189]
    s_waitcnt lgkmcnt(6)
    v_pk_fma_f16 v179, v244, v244, v179
    v_cvt_pk_f16_f32 v245, v160, v161
    v_mfma_f32_16x16x32_bf16 v[186:189], a[8:11], v[134:137], v[186:189]
    v_pk_fma_f16 v181, v245, v245, v181
    v_cvt_pk_f16_f32 v160, v218, v219
    v_mfma_f32_16x16x32_bf16 v[186:189], a[12:15], v[222:225], v[186:189]
    buffer_load_dwordx4 v127, s[48:51], s4 offen offset:2048 lds
    v_mfma_f32_16x16x32_bf16 v[186:189], a[16:19], v[198:201], v[186:189]
    s_add_u32 m0, s68, 3072
    v_pk_fma_f16 v179, v160, v160, v179
    v_cvt_pk_f16_f32 v161, v220, v221
    v_mfma_f32_16x16x32_bf16 v[186:189], a[20:23], v[226:229], v[186:189]
    s_add_u32 s4, s45, 185088
    v_pk_fma_f16 v181, v161, v161, v181
    s_sub_u32 s45, s17, 1
    v_mfma_f32_16x16x32_bf16 v[218:221], a[24:27], v[182:185], 0
    s_waitcnt lgkmcnt(1)
    v_mfma_f32_16x16x32_bf16 v[218:221], a[28:31], v[190:193], v[218:221]
    v_mfma_f32_16x16x32_bf16 v[218:221], a[32:35], v[134:137], v[218:221]
    s_waitcnt vmcnt(6)
    ds_read_b64_tr_b16 a[152:153], v130 offset:0
    ds_read_b64_tr_b16 a[154:155], v130 offset:768
    v_mfma_f32_16x16x32_bf16 v[218:221], a[36:39], v[222:225], v[218:221]
    s_waitcnt lgkmcnt(2)
    buffer_load_dwordx4 v123, s[48:51], s4 offen lds
    v_mfma_f32_16x16x32_bf16 v[218:221], a[40:43], v[198:201], v[218:221]
    ds_read_b64_tr_b16 a[176:177], v130 offset:32
    ds_read_b64_tr_b16 a[178:179], v130 offset:800
    v_mfma_f32_16x16x32_bf16 v[218:221], a[44:47], v[226:229], v[218:221]
    ds_read_b64_tr_b16 a[200:201], v130 offset:64
    ds_read_b64_tr_b16 a[202:203], v130 offset:832
    v_mfma_f32_16x16x32_bf16 v[214:217], a[48:51], v[182:185], 0
    v_cvt_pk_f16_f32 v182, v186, v187
    v_pk_mul_f16 v178, v182, v182
    v_mfma_f32_16x16x32_bf16 v[214:217], a[52:55], v[190:193], v[214:217]
    buffer_load_dwordx4 v125, s[48:51], s4 offen offset:1024 lds
    v_mfma_f32_16x16x32_bf16 v[214:217], a[56:59], v[134:137], v[214:217]
    v_cvt_pk_f16_f32 v183, v188, v189
    v_pk_mul_f16 v180, v183, v183
    v_mfma_f32_16x16x32_bf16 v[214:217], a[60:63], v[222:225], v[214:217]
    v_cvt_pk_f16_f32 v184, v218, v219
    v_pk_fma_f16 v178, v184, v184, v178
    v_mfma_f32_16x16x32_bf16 v[214:217], a[64:67], v[198:201], v[214:217]
    s_waitcnt lgkmcnt(4)
    v_cvt_pk_f16_f32 v185, v220, v221
    v_pk_fma_f16 v180, v185, v185, v180
    v_mfma_f32_16x16x32_bf16 v[214:217], a[68:71], v[226:229], v[214:217]
    buffer_load_dwordx4 v127, s[48:51], s4 offen offset:2048 lds
    v_mfma_f32_16x16x32_bf16 v[190:193], a[72:75], v[170:173], 0
    s_add_u32 m0, s69, 0
    s_add_u32 s4, 0, 12288
    v_mfma_f32_16x16x32_bf16 v[190:193], a[76:79], v[154:157], v[190:193]
    s_waitcnt vmcnt(6)
    ds_read_b64_tr_b16 a[156:157], v130 offset:3072
    ds_read_b64_tr_b16 a[158:159], v130 offset:3840
    v_mfma_f32_16x16x32_bf16 v[190:193], a[80:83], v[174:177], v[190:193]
    s_waitcnt lgkmcnt(2)
    ds_read_b64_tr_b16 a[180:181], v130 offset:3104
    ds_read_b64_tr_b16 a[182:183], v130 offset:3872
    v_mfma_f32_16x16x32_bf16 v[190:193], a[84:87], v[166:169], v[190:193]
    buffer_load_dwordx4 v152, s[52:55], 0 offen lds
    ds_read_b64_tr_b16 a[204:205], v130 offset:3136
    v_mfma_f32_16x16x32_bf16 v[190:193], a[88:91], v[162:165], v[190:193]
    ds_read_b64_tr_b16 a[206:207], v130 offset:3904
    v_cvt_pk_f16_f32 v158, v214, v215
    v_mfma_f32_16x16x32_bf16 v[190:193], a[92:95], v[202:205], v[190:193]
    v_pk_fma_f16 v178, v158, v158, v178
    v_cvt_pk_f16_f32 v159, v216, v217
    v_mfma_f32_16x16x32_bf16 v[222:225], a[96:99], v[170:173], 0
    v_pk_fma_f16 v180, v159, v159, v180
    v_mfma_f32_16x16x32_bf16 v[222:225], a[100:103], v[154:157], v[222:225]
    buffer_load_dwordx4 v153, s[52:55], 0 offen offset:1024 lds
    v_mfma_f32_16x16x32_f16 v[198:201], v[40:43], v[178:181], 0
    v_mfma_f32_16x16x32_bf16 v[222:225], a[104:107], v[174:177], v[222:225]
    s_waitcnt lgkmcnt(4)
    v_cvt_pk_f16_f32 v190, v190, v191
    v_pk_mul_f16 v227, v190, v190
    v_mfma_f32_16x16x32_bf16 v[222:225], a[108:111], v[166:169], v[222:225]
    s_waitcnt lgkmcnt(2)
    v_cvt_pk_f16_f32 v191, v192, v193
    v_pk_mul_f16 v229, v191, v191
    v_mfma_f32_16x16x32_bf16 v[222:225], a[112:115], v[162:165], v[222:225]
    s_waitcnt lgkmcnt(1)
    buffer_load_dwordx4 v122, s[52:55], 0 offen offset:2048 lds
    v_min3_u32 v44, v44, v198, v199
    v_mfma_f32_16x16x32_bf16 v[222:225], a[116:119], v[202:205], v[222:225]
    s_add_u32 m0, s69, 3072
    v_rsq_f32 v200, v198
    v_mfma_f32_16x16x32_bf16 v[134:137], a[120:123], v[170:173], 0
    s_waitcnt lgkmcnt(0)
    v_rsq_f32 v201, v199
    v_mfma_f32_16x16x32_bf16 v[134:137], a[124:127], v[154:157], v[134:137]
    v_mul_f32 v200, s31, v200
    v_cvt_pk_f16_f32 v200, v200, v201
    v_mfma_f32_16x16x32_bf16 v[134:137], a[128:131], v[174:177], v[134:137]
    buffer_load_dwordx4 v152, s[52:55], s4 offen lds
    v_mfma_f32_16x16x32_bf16 v[134:137], a[132:135], v[166:169], v[134:137]
    v_pk_mul_f16 v242, v242, v200 op_sel:[0,1] op_sel_hi:[1,1]
    s_waitcnt vmcnt(7)
    v_mfma_f32_16x16x32_bf16 v[134:137], a[136:139], v[162:165], v[134:137]
    ds_read_b64_tr_b16 a[160:161], v133 offset:0
    ds_read_b64_tr_b16 a[162:163], v133 offset:768
    v_mfma_f32_16x16x32_bf16 v[134:137], a[140:143], v[202:205], v[134:137]
    ds_read_b64_tr_b16 a[184:185], v133 offset:32
    ds_read_b64_tr_b16 a[186:187], v133 offset:800
    v_mfma_f32_16x16x32_bf16 v[178:181], a[0:3], v[170:173], 0
    buffer_load_dwordx4 v153, s[52:55], s4 offen offset:1024 lds
    v_mfma_f32_16x16x32_bf16 v[178:181], a[4:7], v[154:157], v[178:181]
    ds_read_b64_tr_b16 a[208:209], v133 offset:64
    ds_read_b64_tr_b16 a[210:211], v133 offset:832
    v_mfma_f32_16x16x32_bf16 v[178:181], a[8:11], v[174:177], v[178:181]
    v_pk_mul_f16 v243, v243, v200 op_sel:[0,1] op_sel_hi:[1,1]
    v_pk_mul_f16 v244, v244, v200 op_sel:[0,1] op_sel_hi:[1,1]
    v_mfma_f32_16x16x32_bf16 v[178:181], a[12:15], v[166:169], v[178:181]
    v_pk_mul_f16 v245, v245, v200 op_sel:[0,1] op_sel_hi:[1,1]
    v_pk_mul_f16 v160, v160, v200 op_sel:[0,1] op_sel_hi:[1,1]
    v_mfma_f32_16x16x32_bf16 v[178:181], a[16:19], v[162:165], v[178:181]
    buffer_load_dwordx4 v122, s[52:55], s4 offen offset:2048 lds
    v_mfma_f32_16x16x32_bf16 v[178:181], a[20:23], v[202:205], v[178:181]
    s_add_u32 m0, s68, 0
    v_pk_mul_f16 v161, v161, v200 op_sel:[0,1] op_sel_hi:[1,1]
    v_pk_mul_f16 v182, v182, v200 op_sel:[0,0] op_sel_hi:[1,0]
    v_mfma_f32_16x16x32_bf16 v[218:221], a[24:27], v[170:173], 0
    s_add_u32 s4, 0, 24576
    ds_read_b128 v[186:189], v126 offset:0
    v_pk_mul_f16 v183, v183, v200 op_sel:[0,0] op_sel_hi:[1,0]
    v_mfma_f32_16x16x32_bf16 v[218:221], a[28:31], v[154:157], v[218:221]
    s_waitcnt lgkmcnt(3)
    ds_read_b128 v[214:217], v145 offset:0
    v_pk_mul_f16 v184, v184, v200 op_sel:[0,0] op_sel_hi:[1,0]
    v_mfma_f32_16x16x32_bf16 v[218:221], a[32:35], v[174:177], v[218:221]
    ds_read_b128 v[234:237], v126 offset:128
    v_pk_mul_f16 v185, v185, v200 op_sel:[0,0] op_sel_hi:[1,0]
    v_mfma_f32_16x16x32_bf16 v[218:221], a[36:39], v[166:169], v[218:221]
    s_waitcnt lgkmcnt(3)
    buffer_load_dwordx4 v152, s[52:55], s4 offen lds
    v_mfma_f32_16x16x32_bf16 v[218:221], a[40:43], v[162:165], v[218:221]
    ds_read_b128 v[238:241], v145 offset:128
    ds_read_b128 v[250:253], v126 offset:256
    v_mfma_f32_16x16x32_bf16 v[218:221], a[44:47], v[202:205], v[218:221]
    ds_read_b128 v[230:233], v145 offset:256
    s_waitcnt vmcnt(7)
    v_mfma_f32_16x16x32_bf16 v[246:249], a[48:51], v[170:173], 0
    ds_read_b64_tr_b16 a[164:165], v133 offset:3072
    ds_read_b64_tr_b16 a[166:167], v133 offset:3840
    v_mfma_f32_16x16x32_bf16 v[246:249], a[52:55], v[154:157], v[246:249]
    buffer_load_dwordx4 v153, s[52:55], s4 offen offset:1024 lds
    v_mfma_f32_16x16x32_bf16 v[246:249], a[56:59], v[174:177], v[246:249]
    s_waitcnt lgkmcnt(7)
    ds_read_b64_tr_b16 a[188:189], v133 offset:3104
    ds_read_b64_tr_b16 a[190:191], v133 offset:3872
    v_mfma_f32_16x16x32_bf16 v[246:249], a[60:63], v[166:169], v[246:249]
    s_waitcnt lgkmcnt(8)
    ds_read_b64_tr_b16 a[212:213], v133 offset:3136
    ds_read_b64_tr_b16 a[214:215], v133 offset:3904
    v_mfma_f32_16x16x32_bf16 v[246:249], a[64:67], v[162:165], v[246:249]
    s_waitcnt lgkmcnt(9)
    v_pk_mul_f16 v158, v158, v200 op_sel:[0,0] op_sel_hi:[1,0]
    v_pk_mul_f16 v159, v159, v200 op_sel:[0,0] op_sel_hi:[1,0]
    v_mfma_f32_16x16x32_bf16 v[246:249], a[68:71], v[202:205], v[246:249]
    buffer_load_dwordx4 v122, s[52:55], s4 offen offset:2048 lds
    v_mfma_f32_16x16x32_bf16 v[130:133], v[170:173], a[144:147], 0
    s_add_u32 m0, s68, 3072
    v_max3_u32 v45, v45, v198, v199
    v_cvt_pk_f16_f32 v192, v222, v223
    v_mfma_f32_16x16x32_bf16 v[130:133], v[154:157], a[148:151], v[130:133]
    s_add_u32 s4, 0, 36864
    v_pk_fma_f16 v227, v192, v192, v227
    v_cvt_pk_f16_f32 v193, v224, v225
    v_mfma_f32_16x16x32_bf16 v[130:133], v[174:177], a[152:155], v[130:133]
    s_waitcnt lgkmcnt(4)
    v_pk_fma_f16 v229, v193, v193, v229
    v_cvt_pk_f16_f32 v200, v134, v135
    v_mfma_f32_16x16x32_bf16 v[130:133], v[166:169], a[156:159], v[130:133]
    v_pk_fma_f16 v227, v200, v200, v227
    v_cvt_pk_f16_f32 v201, v136, v137
    v_mfma_f32_16x16x32_bf16 v[130:133], v[162:165], a[160:163], v[130:133]
    s_waitcnt lgkmcnt(2)
    v_pk_fma_f16 v229, v201, v201, v229
    v_cvt_pk_f16_f32 v222, v178, v179
    v_mfma_f32_16x16x32_bf16 v[130:133], v[202:205], a[164:167], v[130:133]
    s_waitcnt lgkmcnt(0)
    buffer_load_dwordx4 v152, s[52:55], s4 offen lds
    s_waitcnt vmcnt(7)
    v_mfma_f32_16x16x32_bf16 v[134:137], v[170:173], a[168:171], 0
    ds_read_b64 a[216:217], v139 offset:0
    ds_read_b64 a[218:219], v139 offset:1536
    v_mfma_f32_16x16x32_bf16 v[134:137], v[154:157], a[172:175], v[134:137]
    ds_read_b64 a[240:241], v139 offset:8
    ds_read_b64 a[242:243], v139 offset:1544
    v_mfma_f32_16x16x32_bf16 v[134:137], v[174:177], a[176:179], v[134:137]
    ds_read_b64 v[90:91], v117 offset:0
    ds_read_b64 v[92:93], v117 offset:1536
    v_mfma_f32_16x16x32_bf16 v[134:137], v[166:169], a[180:183], v[134:137]
    buffer_load_dwordx4 v153, s[52:55], s4 offen offset:1024 lds
    v_mfma_f32_16x16x32_bf16 v[134:137], v[162:165], a[184:187], v[134:137]
    ds_read_b128 v[140:143], v0 offset:20480
    v_pk_mul_f16 v226, v222, v222
    v_mfma_f32_16x16x32_bf16 v[134:137], v[202:205], a[188:191], v[134:137]
    v_cvt_pk_f16_f32 v223, v180, v181
    v_pk_mul_f16 v228, v223, v223
    v_cvt_pk_f16_f32 v224, v218, v219
    v_pk_fma_f16 v226, v224, v224, v226
    v_cvt_pk_f16_f32 v225, v220, v221
    buffer_load_dwordx4 v122, s[52:55], s4 offen offset:2048 lds
    s_add_u32 m0, s69, 0
    s_add_u32 s4, 0, 49152
    v_pk_fma_f16 v228, v225, v225, v228
    v_cvt_pk_f16_f32 v198, v246, v247
    v_mfma_f32_16x16x32_bf16 v[178:181], v[170:173], a[192:195], 0
    s_waitcnt lgkmcnt(3)
    ds_read_b128 v[218:221], v1 offset:20480
    v_pk_fma_f16 v226, v198, v198, v226
    v_mfma_f32_16x16x32_bf16 v[178:181], v[154:157], a[196:199], v[178:181]
    s_waitcnt lgkmcnt(2)
    ds_read_b128 v[154:157], v0 offset:20608
    v_cvt_pk_f16_f32 v199, v248, v249
    v_mfma_f32_16x16x32_bf16 v[178:181], v[174:177], a[200:203], v[178:181]
    buffer_load_dwordx4 v152, s[52:55], s4 offen lds
    s_waitcnt vmcnt(7)
    v_mfma_f32_16x16x32_bf16 v[178:181], v[166:169], a[204:207], v[178:181]
    s_waitcnt lgkmcnt(2)
    ds_read_b64 a[232:233], v139 offset:3072
    ds_read_b64 a[220:221], v139 offset:4608
    v_mfma_f32_16x16x32_bf16 v[178:181], v[162:165], a[208:211], v[178:181]
    ds_read_b64 v[82:83], v139 offset:3080
    ds_read_b64 a[244:245], v139 offset:4616
    v_mfma_f32_16x16x32_bf16 v[178:181], v[202:205], a[212:215], v[178:181]
    ds_read_b64 v[106:107], v117 offset:3072
    ds_read_b64 v[94:95], v117 offset:4608
    v_mfma_f32_16x16x32_bf16 v[166:169], v[186:189], a[144:147], 0
    buffer_load_dwordx4 v153, s[52:55], s4 offen offset:1024 lds
    v_mfma_f32_16x16x32_bf16 v[166:169], v[214:217], a[148:151], v[166:169]
    s_waitcnt lgkmcnt(7)
    ds_read_b128 v[162:165], v1 offset:20608
    ds_read_b128 v[202:205], v0 offset:20736
    v_mfma_f32_16x16x32_bf16 v[166:169], v[234:237], a[152:155], v[166:169]
    s_waitcnt lgkmcnt(8)
    ds_read_b128 v[174:177], v1 offset:20736
    v_pk_fma_f16 v228, v199, v199, v228
    v_mfma_f32_16x16x32_bf16 v[166:169], v[238:241], a[156:159], v[166:169]
    v_cvt_pk_bf16_f32 v130, v130, v131
    v_cvt_pk_bf16_f32 v131, v132, v133
    v_mfma_f32_16x16x32_bf16 v[166:169], v[250:253], a[160:163], v[166:169]
    buffer_load_dwordx4 v122, s[52:55], s4 offen offset:2048 lds
    v_mfma_f32_16x16x32_bf16 v[166:169], v[230:233], a[164:167], v[166:169]
    s_add_u32 m0, s69, 3072
    s_add_u32 s4, 0, 61440
    v_cvt_pk_bf16_f32 v134, v134, v135
    v_mfma_f32_16x16x32_f16 v[170:173], v[40:43], v[226:229], 0
    s_waitcnt lgkmcnt(5)
    v_cvt_pk_bf16_f32 v135, v136, v137
    v_cvt_pk_bf16_f32 v114, v178, v179
    v_mfma_f32_16x16x32_bf16 v[226:229], v[186:189], a[168:171], 0
    s_waitcnt lgkmcnt(3)
    ds_read_b128 v[246:249], v0 offset:26624
    v_cvt_pk_bf16_f32 v115, v180, v181
    v_mfma_f32_16x16x32_bf16 v[226:229], v[214:217], a[172:175], v[226:229]
    buffer_load_dwordx4 v152, s[52:55], s4 offen lds
    v_mfma_f32_16x16x32_bf16 v[226:229], v[234:237], a[176:179], v[226:229]
    s_waitcnt lgkmcnt(2)
    s_waitcnt vmcnt(7)
    ds_read_b64 a[222:223], v254 offset:0
    v_mfma_f32_16x16x32_bf16 v[226:229], v[238:241], a[180:183], v[226:229]
    s_waitcnt lgkmcnt(2)
    ds_read_b64 a[234:235], v254 offset:1536
    ds_read_b64 a[246:247], v254 offset:8
    v_mfma_f32_16x16x32_bf16 v[226:229], v[250:253], a[184:187], v[226:229]
    ds_read_b64 v[84:85], v254 offset:1544
    ds_read_b64 v[96:97], v124 offset:0
    v_mfma_f32_16x16x32_bf16 v[226:229], v[230:233], a[188:191], v[226:229]
    buffer_load_dwordx4 v153, s[52:55], s4 offen offset:1024 lds
    ds_read_b64 v[108:109], v124 offset:1536
    v_rsq_f32 v172, v170
    v_rsq_f32 v173, v171
    v_mul_f32 v172, s31, v172
    v_cvt_pk_f16_f32 v172, v172, v173
    v_pk_mul_f16 v190, v190, v172 op_sel:[0,1] op_sel_hi:[1,1]
    v_pk_mul_f16 v191, v191, v172 op_sel:[0,1] op_sel_hi:[1,1]
    v_pk_mul_f16 v192, v192, v172 op_sel:[0,1] op_sel_hi:[1,1]
    v_pk_mul_f16 v193, v193, v172 op_sel:[0,1] op_sel_hi:[1,1]
    buffer_load_dwordx4 v122, s[52:55], s4 offen offset:2048 lds
    s_add_u32 m0, s28, 65536
    v_pk_mul_f16 v200, v200, v172 op_sel:[0,1] op_sel_hi:[1,1]
    v_pk_mul_f16 v201, v201, v172 op_sel:[0,1] op_sel_hi:[1,1]
    v_pk_mul_f16 v222, v222, v172 op_sel:[0,0] op_sel_hi:[1,0]
    v_pk_mul_f16 v223, v223, v172 op_sel:[0,0] op_sel_hi:[1,0]
    v_pk_mul_f16 v224, v224, v172 op_sel:[0,0] op_sel_hi:[1,0]
    v_pk_mul_f16 v225, v225, v172 op_sel:[0,0] op_sel_hi:[1,0]
    v_pk_mul_f16 v198, v198, v172 op_sel:[0,0] op_sel_hi:[1,0]
    v_pk_mul_f16 v199, v199, v172 op_sel:[0,0] op_sel_hi:[1,0]
    v_mfma_f32_16x16x32_bf16 v[178:181], v[186:189], a[192:195], 0
    s_waitcnt lgkmcnt(1)
    ds_read_b128 v[186:189], v1 offset:26624
    v_min3_u32 v44, v44, v170, v171
    v_mfma_f32_16x16x32_bf16 v[178:181], v[214:217], a[196:199], v[178:181]
    s_waitcnt lgkmcnt(1)
    buffer_load_dwordx4 v10, s[8:11], s24 offen nt lds
    v_mfma_f32_16x16x32_bf16 v[178:181], v[234:237], a[200:203], v[178:181]
    s_add_u32 m0, s28, 69632
    ds_read_b128 v[214:217], v0 offset:26752
    ds_read_b128 v[234:237], v1 offset:26752
    v_mfma_f32_16x16x32_bf16 v[178:181], v[238:241], a[204:207], v[178:181]
    ds_read_b128 v[238:241], v0 offset:26880
    v_max3_u32 v45, v45, v170, v171
    v_mfma_f32_16x16x32_bf16 v[178:181], v[250:253], a[208:211], v[178:181]
    ds_read_b128 v[250:253], v1 offset:26880
    s_waitcnt vmcnt(7)
    v_mfma_f32_16x16x32_bf16 v[178:181], v[230:233], a[212:215], v[178:181]
    buffer_load_dwordx4 v11, s[8:11], s24 offen nt lds
    v_mfma_f32_16x16x32_bf16 v[170:173], v[140:143], a[144:147], 0
    s_add_u32 m0, s28, 73728
    ds_read_b64 a[224:225], v254 offset:3072
    ds_read_b64 a[226:227], v254 offset:4608
    v_mfma_f32_16x16x32_bf16 v[170:173], v[218:221], a[148:151], v[170:173]
    ds_read_b64 a[248:249], v254 offset:3080
    ds_read_b64 a[250:251], v254 offset:4616
    v_mfma_f32_16x16x32_bf16 v[170:173], v[154:157], a[152:155], v[170:173]
    s_waitcnt lgkmcnt(8)
    ds_read_b64 v[98:99], v124 offset:3072
    ds_read_b64 v[100:101], v124 offset:4608
    v_mfma_f32_16x16x32_bf16 v[170:173], v[162:165], a[156:159], v[170:173]
    buffer_load_dwordx4 v12, s[8:11], s24 offen nt lds
    v_mfma_f32_16x16x32_bf16 v[170:173], v[202:205], a[160:163], v[170:173]
    s_add_u32 m0, s28, 77824
    v_cvt_pk_bf16_f32 v166, v166, v166
    v_cvt_pk_bf16_f32 v167, v167, v167
    v_mfma_f32_16x16x32_bf16 v[170:173], v[174:177], a[164:167], v[170:173]
    s_waitcnt lgkmcnt(7)
    ds_write2_b32 v147, v166, v167 offset0:0 offset1:68
    v_mfma_f32_16x16x32_bf16 v[122:125], v[140:143], a[168:171], 0
    s_waitcnt lgkmcnt(7)
    v_cvt_pk_bf16_f32 v168, v168, v168
    v_cvt_pk_bf16_f32 v169, v169, v169
    v_mfma_f32_16x16x32_bf16 v[122:125], v[218:221], a[172:175], v[122:125]
    s_waitcnt lgkmcnt(6)
    buffer_load_dwordx4 v13, s[8:11], s24 offen nt lds
    v_mfma_f32_16x16x32_bf16 v[122:125], v[154:157], a[176:179], v[122:125]
    s_add_u32 m0, s74, 0
    ds_write2_b32 v147, v168, v169 offset0:136 offset1:204
    v_mfma_f32_16x16x32_bf16 v[122:125], v[162:165], a[180:183], v[122:125]
    s_waitcnt lgkmcnt(2)
    v_cvt_pk_bf16_f32 v226, v226, v226
    v_cvt_pk_bf16_f32 v227, v227, v227
    v_mfma_f32_16x16x32_bf16 v[122:125], v[202:205], a[184:187], v[122:125]
    s_waitcnt vmcnt(7)
    ds_read_b64 a[236:237], v139 offset:0
    ds_read_b64 a[228:229], v139 offset:1536
    v_mfma_f32_16x16x32_bf16 v[122:125], v[174:177], a[188:191], v[122:125]
    buffer_load_dwordx4 v14, s[8:11], s24 offen nt lds
    v_mfma_f32_16x16x32_bf16 v[166:169], v[140:143], a[192:195], 0
    s_add_u32 s8, s40, s23
    ds_read_b64 v[86:87], v139 offset:8
    ds_read_b64 a[252:253], v139 offset:1544
    v_mfma_f32_16x16x32_bf16 v[166:169], v[218:221], a[196:199], v[166:169]
    s_addc_u32 s9, s41, 0
    ds_read_b64 v[110:111], v117 offset:0
    ds_read_b64 v[102:103], v117 offset:1536
    v_mfma_f32_16x16x32_bf16 v[166:169], v[154:157], a[200:203], v[166:169]
    s_sub_u32 s10, s36, s23
    ds_read_b128 v[218:221], v126 offset:6144
    ds_read_b128 v[154:157], v145 offset:6144
    v_mfma_f32_16x16x32_bf16 v[166:169], v[162:165], a[204:207], v[166:169]
    s_cmp_lt_u32 s34, s17
    ds_read_b128 v[162:165], v126 offset:6272
    ds_read_b128 v[230:233], v145 offset:6272
    v_mfma_f32_16x16x32_bf16 v[166:169], v[202:205], a[208:211], v[166:169]
    s_cselect_b32 s10, s10, 0
    v_cvt_pk_bf16_f32 v228, v228, v228
    v_cvt_pk_bf16_f32 v229, v229, v229
    v_mfma_f32_16x16x32_bf16 v[166:169], v[174:177], a[212:215], v[166:169]
    s_add_u32 m0, s28, 0
    ds_read_b128 v[174:177], v126 offset:6400
    ds_read_b128 v[126:129], v145 offset:6400
    s_mov_b32 s24, s23
    s_add_u32 s23, s23, s21
    s_cmp_ge_u32 s19, 72
    ds_write2_b32 v147, v226, v227 offset0:16 offset1:84
    v_mfma_f32_16x16x32_bf16 v[202:205], v[246:249], a[144:147], 0
    s_cselect_b32 s34, 72, 0
    v_cvt_pk_bf16_f32 v178, v178, v178
    v_cvt_pk_bf16_f32 v179, v179, v179
    v_mfma_f32_16x16x32_bf16 v[202:205], v[186:189], a[148:151], v[202:205]
    s_cselect_b32 s35, s22, 0
    ds_write2_b32 v147, v228, v229 offset0:152 offset1:220
    v_mfma_f32_16x16x32_bf16 v[202:205], v[214:217], a[152:155], v[202:205]
    s_waitcnt vmcnt(5)
    v_cvt_pk_bf16_f32 v180, v180, v180
    v_cvt_pk_bf16_f32 v181, v181, v181
    v_mfma_f32_16x16x32_bf16 v[202:205], v[234:237], a[156:159], v[202:205]
    s_sub_u32 s19, s19, s34
    ds_read_b64 a[230:231], v139 offset:3072
    ds_read_b64 a[238:239], v139 offset:4608
    v_mfma_f32_16x16x32_bf16 v[202:205], v[238:241], a[160:163], v[202:205]
    s_add_u32 s23, s23, s35
    ds_read_b64 a[254:255], v139 offset:3080
    ds_read_b64 v[88:89], v139 offset:4616
    v_mfma_f32_16x16x32_bf16 v[202:205], v[250:253], a[164:167], v[202:205]
    s_waitcnt lgkmcnt(6)
    ds_read_b64 v[104:105], v117 offset:3072
    ds_read_b64 v[112:113], v117 offset:4608
    v_mfma_f32_16x16x32_bf16 v[226:229], v[246:249], a[168:171], 0
    ds_write2_b32 v147, v178, v179 offset0:32 offset1:100
    v_mfma_f32_16x16x32_bf16 v[226:229], v[186:189], a[172:175], v[226:229]
    v_cvt_pk_bf16_f32 v138, v170, v171
    v_cvt_pk_bf16_f32 v139, v172, v173
    v_mfma_f32_16x16x32_bf16 v[226:229], v[214:217], a[176:179], v[226:229]
    ds_write2_b32 v147, v180, v181 offset0:168 offset1:236
    v_mfma_f32_16x16x32_bf16 v[226:229], v[234:237], a[180:183], v[226:229]
    v_cvt_pk_bf16_f32 v122, v122, v123
    v_cvt_pk_bf16_f32 v123, v124, v125
    v_mfma_f32_16x16x32_bf16 v[226:229], v[238:241], a[184:187], v[226:229]
    s_waitcnt lgkmcnt(6)
    v_cvt_pk_bf16_f32 v166, v166, v167
    v_cvt_pk_bf16_f32 v167, v168, v169
    v_mfma_f32_16x16x32_bf16 v[226:229], v[250:253], a[188:191], v[226:229]
    s_waitcnt lgkmcnt(4)
    v_cvt_pk_bf16_f32 v140, v202, v203
    v_cvt_pk_bf16_f32 v141, v204, v205
    v_mfma_f32_16x16x32_bf16 v[170:173], v[246:249], a[192:195], 0
    s_waitcnt lgkmcnt(2)
    v_xor_b32 v0, 65536, v0
    v_xor_b32 v1, 65536, v1
    v_mfma_f32_16x16x32_bf16 v[170:173], v[186:189], a[196:199], v[170:173]
    v_cvt_pk_bf16_f32 v124, v226, v227
    v_cvt_pk_bf16_f32 v125, v228, v229
    v_mfma_f32_16x16x32_bf16 v[170:173], v[214:217], a[200:203], v[170:173]
    v_xor_b32 v152, 65536, v2
    v_lshrrev_b32 v153, 2, v152
    v_mfma_f32_16x16x32_bf16 v[170:173], v[234:237], a[204:207], v[170:173]
    v_lshrrev_b32 v254, 8, v152
    v_add_u32 v152, 157184, v152
    v_mfma_f32_16x16x32_bf16 v[170:173], v[238:241], a[208:211], v[170:173]
    v_lshl_add_u32 v255, s16, 2, v152
    v_add_u32 v153, 162048, v153
    v_mfma_f32_16x16x32_bf16 v[170:173], v[250:253], a[212:215], v[170:173]
    v_lshlrev_b32 v254, 4, v254
    v_add_u32 v254, 162048, v254
    v_mfma_f32_16x16x32_bf16 v[226:229], v[218:221], a[144:147], 0
    v_or_b32 v202, v32, v33
    v_and_b32 v202, 0xffff, v202
    v_mfma_f32_16x16x32_bf16 v[226:229], v[154:157], a[148:151], v[226:229]
    v_lshl_or_b32 v202, v202, 16, v202
    v_or_b32 v203, v32, v33
    v_mfma_f32_16x16x32_bf16 v[226:229], v[162:165], a[152:155], v[226:229]
    v_cvt_pk_bf16_f32 v168, v170, v171
    v_cvt_pk_bf16_f32 v169, v172, v173
    v_mfma_f32_16x16x32_bf16 v[226:229], v[230:233], a[156:159], v[226:229]
    v_and_b32 v203, 0xffff, v203
    v_lshl_or_b32 v203, v203, 16, v203
    v_mfma_f32_16x16x32_bf16 v[226:229], v[174:177], a[160:163], v[226:229]
    v_or_b32 v204, v32, v33
    v_lshrrev_b32 v204, 16, v204
    v_mfma_f32_16x16x32_bf16 v[226:229], v[126:129], a[164:167], v[226:229]
    v_lshl_or_b32 v204, v204, 16, v204
    v_or_b32 v205, v32, v33
    v_mfma_f32_16x16x32_f16 v[170:173], v[242:245], v[206:209], v[50:53]
    v_lshrrev_b32 v205, 16, v205
    v_lshl_or_b32 v205, v205, 16, v205
    v_mfma_f32_16x16x32_f16 v[142:145], v[190:193], v[206:209], v[54:57]
    v_xor_b32 v2, 65536, v2
    v_mfma_f32_16x16x32_bf16 v[178:181], v[218:221], a[168:171], 0
    v_cvt_pk_bf16_f32 v226, v226, v226
    v_cvt_pk_bf16_f32 v227, v227, v227
    v_cvt_pk_bf16_f32 v228, v228, v228
    v_mfma_f32_16x16x16_f16 v[170:173], v[160:161], v[194:195], v[170:173]
    v_cvt_pk_bf16_f32 v229, v229, v229
    v_mfma_f32_16x16x16_f16 v[142:145], v[200:201], v[194:195], v[142:145]
    ds_write2_b32 v148, v226, v227 offset0:0 offset1:68
    v_mfma_f32_16x16x32_bf16 v[178:181], v[154:157], a[172:175], v[178:181]
    v_mfma_f32_16x16x32_bf16 v[178:181], v[162:165], a[176:179], v[178:181]
    ds_write2_b32 v148, v228, v229 offset0:136 offset1:204
    v_mfma_f32_16x16x32_bf16 v[178:181], v[230:233], a[180:183], v[178:181]
    v_mfma_f32_16x16x32_bf16 v[178:181], v[174:177], a[184:187], v[178:181]
    v_exp_f32 v170, v170
    v_mfma_f32_16x16x32_bf16 v[178:181], v[126:129], a[188:191], v[178:181]
    v_exp_f32 v171, v171
    v_mfma_f32_16x16x32_bf16 v[226:229], v[218:221], a[192:195], 0
    v_exp_f32 v172, v172
    v_mfma_f32_16x16x32_bf16 v[226:229], v[154:157], a[196:199], v[226:229]
    v_exp_f32 v173, v173
    v_mfma_f32_16x16x32_bf16 v[226:229], v[162:165], a[200:203], v[226:229]
    v_cvt_pk_bf16_f32 v212, v170, v171
    v_cvt_pk_bf16_f32 v213, v172, v173
    v_mfma_f32_16x16x32_bf16 v[226:229], v[230:233], a[204:207], v[226:229]
    v_cvt_pk_bf16_f32 v178, v178, v178
    v_cvt_pk_bf16_f32 v179, v179, v179
    v_mfma_f32_16x16x32_bf16 v[226:229], v[174:177], a[208:211], v[226:229]
    ds_write2_b32 v148, v178, v179 offset0:16 offset1:84
    v_mfma_f32_16x16x32_bf16 v[226:229], v[126:129], a[212:215], v[226:229]
    v_cvt_pk_bf16_f32 v180, v180, v180
    v_cvt_pk_bf16_f32 v181, v181, v181
    v_mfma_f32_16x16x32_bf16 v[170:173], v[202:205], a[216:219], 0
    ds_write2_b32 v148, v180, v181 offset0:152 offset1:220
    v_mfma_f32_16x16x32_bf16 v[170:173], v[202:205], a[240:243], v[170:173]
    v_exp_f32 v142, v142
    v_mfma_f32_16x16x32_bf16 v[170:173], v[202:205], v[90:93], v[170:173]
    v_exp_f32 v143, v143
    v_mfma_f32_16x16x32_f16 v[126:129], v[118:121], v[182:185], v[58:61]
    v_cvt_pk_bf16_f32 v226, v226, v226
    v_cvt_pk_bf16_f32 v227, v227, v227
    v_mfma_f32_16x16x32_bf16 v[154:157], v[202:205], a[220:223], 0
    ds_write2_b32 v148, v226, v227 offset0:32 offset1:100
    v_mfma_f32_16x16x32_bf16 v[154:157], v[202:205], a[244:247], v[154:157]
    v_cvt_pk_bf16_f32 v228, v228, v228
    v_mov_b32 v226, v170
    v_mov_b32_dpp v226, v171 quad_perm:[0,1,2,3] row_mask:0x2 bank_mask:0xf
    v_mfma_f32_16x16x16_f16 v[126:129], v[196:197], v[158:159], v[126:129]
    v_cvt_pk_bf16_f32 v229, v229, v229
    v_cvt_pk_bf16_f32 v36, v142, v143
    v_exp_f32 v144, v144
    v_mfma_f32_16x16x32_bf16 v[154:157], v[202:205], v[94:97], v[154:157]
    ds_write2_b32 v148, v228, v229 offset0:168 offset1:236
    v_mfma_f32_16x16x32_bf16 v[170:173], v[202:205], a[232:235], 0
    v_exp_f32 v145, v145
    v_mfma_f32_16x16x32_f16 v[218:221], v[242:245], v[182:185], v[62:65]
    ds_read_b128 v[146:149], v5 offset:0
    ds_read_b128 v[162:165], v5 offset:16
    v_mfma_f32_16x16x32_f16 v[174:177], v[190:193], v[182:185], v[66:69]
    ds_read_b128 v[178:181], v5 offset:48
    ds_read_b32 v142, v6 offset:192
    v_mfma_f32_16x16x32_bf16 v[170:173], v[202:205], v[82:85], v[170:173]
    ds_read2_b32 v[132:133], v6 offset0:0 offset1:0
    v_mov_b32 v143, v155
    v_cvt_pk_bf16_f32 v37, v144, v145
    v_mfma_f32_16x16x16_f16 v[218:221], v[160:161], v[158:159], v[218:221]
    v_exp_f32 v126, v126
    v_add_u32 v5, 336, v5
    v_mfma_f32_16x16x16_f16 v[174:177], v[200:201], v[158:159], v[174:177]
    v_exp_f32 v127, v127
    v_exp_f32 v128, v128
    v_mfma_f32_16x16x32_f16 v[186:189], v[118:121], v[222:225], v[70:73]
    ds_read2_b32 v[136:137], v6 offset0:16 offset1:16
    ds_read2_b32 v[116:117], v6 offset0:32 offset1:32
    v_mfma_f32_16x16x32_bf16 v[170:173], v[202:205], v[106:109], v[170:173]
    v_cvt_pk_bf16_f32 v126, v126, v127
    v_add_u32 v6, 272, v6
    v_mfma_f32_16x16x32_bf16 v[234:237], v[202:205], a[224:227], 0
    s_waitcnt lgkmcnt(5)
    v_exp_f32 v129, v129
    v_mfma_f32_16x16x32_f16 v[214:217], v[146:149], v[182:185], v[24:27]
    s_waitcnt lgkmcnt(3)
    v_exp_f32 v218, v218
    v_mfma_f32_16x16x32_f16 v[214:217], v[162:165], v[242:245], v[214:217]
    s_waitcnt lgkmcnt(2)
    v_mov_b32_dpp v226, v170 quad_perm:[0,1,2,3] row_mask:0x4 bank_mask:0xf
    v_mov_b32_dpp v226, v154 quad_perm:[0,1,2,3] row_mask:0x8 bank_mask:0xf
    v_mfma_f32_16x16x32_f16 v[214:217], v[178:181], v[158:161], v[214:217]
    ds_write_b32 v255, v226 offset:0
    v_mfma_f32_16x16x32_f16 v[182:185], v[146:149], v[206:209], v[22:25]
    v_mov_b32_dpp v143, v171 quad_perm:[0,1,2,3] row_mask:0x2 bank_mask:0xf
    v_cvt_pk_bf16_f32 v127, v128, v129
    v_mfma_f32_16x16x32_f16 v[182:185], v[162:165], v[118:121], v[182:185]
    v_exp_f32 v219, v219
    v_mfma_f32_16x16x32_f16 v[182:185], v[178:181], v[194:197], v[182:185]
    s_waitcnt lgkmcnt(1)
    v_exp_f32 v220, v220
    v_mfma_f32_16x16x32_f16 v[118:121], v[146:149], v[222:225], v[26:29]
    v_exp_f32 v221, v221
    v_mfma_f32_16x16x32_f16 v[118:121], v[162:165], v[190:193], v[118:121]
    v_cvt_pk_bf16_f32 v128, v218, v219
    v_cvt_pk_bf16_f32 v129, v220, v221
    v_mfma_f32_16x16x32_f16 v[118:121], v[178:181], v[198:201], v[118:121]
    v_exp_f32 v174, v174
    v_mfma_f32_16x16x32_f16 v[206:209], v[242:245], v[222:225], v[74:77]
    v_exp_f32 v175, v175
    v_mfma_f32_16x16x32_f16 v[242:245], v[190:193], v[222:225], v[78:81]
    v_mov_b32_dpp v142, v183 quad_perm:[0,1,2,3] row_mask:0x1 bank_mask:0xf
    v_exp_f32 v176, v176
    v_mfma_f32_16x16x16_f16 v[186:189], v[196:197], v[198:199], v[186:189]
    v_mov_b32_dpp v142, v215 quad_perm:[0,1,2,3] row_mask:0x2 bank_mask:0xf
    v_exp_f32 v118, v118
    v_mfma_f32_16x16x16_f16 v[206:209], v[160:161], v[198:199], v[206:209]
    v_exp_f32 v177, v177
    v_mov_b32_dpp v142, v119 quad_perm:[0,1,2,3] row_mask:0x4 bank_mask:0xf
    v_mfma_f32_16x16x16_f16 v[242:245], v[200:201], v[198:199], v[242:245]
    v_exp_f32 v214, v214
    v_exp_f32 v182, v182
    v_mfma_f32_16x16x32_bf16 v[234:237], v[202:205], a[248:251], v[234:237]
    v_exp_f32 v186, v186
    v_mfma_f32_16x16x32_bf16 v[234:237], v[202:205], v[98:101], v[234:237]
    v_exp_f32 v187, v187
    v_mfma_f32_16x16x32_bf16 v[222:225], v[202:205], a[228:231], 0
    v_cvt_pk_bf16_f32 v190, v186, v187
    v_cvt_pk_bf16_f32 v39, v182, 0
    v_mfma_f32_16x16x32_bf16 v[222:225], v[202:205], a[252:255], v[222:225]
    v_exp_f32 v188, v188
    v_mfma_f32_16x16x32_bf16 v[194:197], v[28:31], v[36:39], 0
    v_exp_f32 v189, v189
    v_mfma_f32_16x16x32_bf16 v[194:197], v[28:31], v[210:213], v[194:197]
    v_mov_b32_dpp v143, v234 quad_perm:[0,1,2,3] row_mask:0x4 bank_mask:0xf
    v_mov_b32_dpp v143, v235 quad_perm:[0,1,2,3] row_mask:0x8 bank_mask:0xf
    v_mfma_f32_16x16x32_bf16 v[198:201], v[130:133], v[36:39], 0
    ds_write_b32 v255, v143 offset:1024
    v_mfma_f32_16x16x32_bf16 v[198:201], v[138:141], v[210:213], v[198:201]
    v_exp_f32 v206, v206
    v_mfma_f32_16x16x32_bf16 v[182:185], v[134:137], v[36:39], 0
    v_exp_f32 v207, v207
    v_mfma_f32_16x16x32_bf16 v[182:185], v[122:125], v[210:213], v[182:185]
    v_cvt_pk_bf16_f32 v191, v188, v189
    v_cvt_pk_bf16_f32 v192, v206, v207
    v_mfma_f32_16x16x32_bf16 v[158:161], v[114:117], v[36:39], 0
    v_exp_f32 v208, v208
    v_mfma_f32_16x16x32_bf16 v[158:161], v[166:169], v[210:213], v[158:161]
    v_exp_f32 v209, v209
    v_mfma_f32_16x16x32_bf16 v[222:225], v[202:205], v[102:105], v[222:225]
    v_cvt_pk_bf16_f32 v193, v208, v209
    v_cvt_pk_bf16_f32 v36, v174, v175
    v_mfma_f32_16x16x32_bf16 v[206:209], v[202:205], a[236:239], 0
    v_exp_f32 v242, v242
    v_mfma_f32_16x16x32_bf16 v[206:209], v[202:205], v[86:89], v[206:209]
    v_exp_f32 v243, v243
    v_mfma_f32_16x16x32_bf16 v[206:209], v[202:205], v[110:113], v[206:209]
    v_exp_f32 v244, v244
    v_exp_f32 v245, v245
    v_cvt_pk_bf16_f32 v37, v176, v177
    v_cvt_pk_bf16_f32 v39, v214, 0
    v_rcp_f32 v194, v194
    v_exp_f32 v142, v142
    v_mfma_f32_16x16x32_bf16 v[170:173], v[28:31], v[36:39], 0
    v_mul_f32 v198, v194, v198
    v_mov_b32 v119, v206
    v_mfma_f32_16x16x32_bf16 v[170:173], v[28:31], v[126:129], v[170:173]
    v_mov_b32_dpp v119, v222 quad_perm:[0,1,2,3] row_mask:0x2 bank_mask:0xf
    v_mov_b32_dpp v119, v223 quad_perm:[0,1,2,3] row_mask:0x4 bank_mask:0xf
    v_mfma_f32_16x16x32_bf16 v[146:149], v[130:133], v[36:39], 0
    v_mov_b32_dpp v119, v207 quad_perm:[0,1,2,3] row_mask:0x8 bank_mask:0xf
    v_mul_f32 v199, v194, v199
    v_mfma_f32_16x16x32_bf16 v[146:149], v[138:141], v[126:129], v[146:149]
    ds_write_b32 v255, v119 offset:2048
    v_mfma_f32_16x16x32_bf16 v[206:209], v[134:137], v[36:39], 0
    v_cvt_pk_bf16_f32 v222, v198, v199
    v_mul_f32 v200, v194, v200
    v_mfma_f32_16x16x32_bf16 v[206:209], v[122:125], v[126:129], v[206:209]
    v_mul_f32 v201, v194, v201
    v_cvt_pk_bf16_f32 v223, v200, v201
    v_mfma_f32_16x16x32_bf16 v[154:157], v[114:117], v[36:39], 0
    v_cvt_pk_bf16_f32 v36, v242, v243
    v_cvt_pk_bf16_f32 v37, v244, v245
    v_mfma_f32_16x16x32_bf16 v[154:157], v[166:169], v[126:129], v[154:157]
    v_cvt_pk_bf16_f32 v39, v118, 0
    v_mul_f32 v182, v194, v182
    v_mul_f32 v183, v194, v183
    v_mfma_f32_16x16x32_bf16 v[126:129], v[28:31], v[36:39], 0
    v_cvt_pk_bf16_f32 v224, v182, v183
    v_mul_f32 v184, v194, v184
    v_mfma_f32_16x16x32_bf16 v[126:129], v[28:31], v[190:193], v[126:129]
    v_mul_f32 v185, v194, v185
    v_cvt_pk_bf16_f32 v225, v184, v185
    v_mfma_f32_16x16x32_bf16 v[118:121], v[130:133], v[36:39], 0
    s_waitcnt lgkmcnt(0)
    v_mul_f32 v158, v194, v158
    v_mul_f32 v159, v194, v159
    v_mfma_f32_16x16x32_bf16 v[118:121], v[138:141], v[190:193], v[118:121]
    s_barrier
    ds_read_b128 v[182:185], v152 offset:0
    ds_read_b128 v[242:245], v152 offset:1024
    v_mfma_f32_16x16x32_bf16 v[174:177], v[134:137], v[36:39], 0
    ds_read_b128 v[162:165], v152 offset:2048
    v_cvt_pk_bf16_f32 v152, v158, v159
    v_mfma_f32_16x16x32_bf16 v[174:177], v[122:125], v[190:193], v[174:177]
    ds_write_b128 v3, v[222:225] offset:0
    v_mfma_f32_16x16x32_bf16 v[202:205], v[114:117], v[36:39], 0
    v_rcp_f32 v126, v126
    v_mfma_f32_16x16x32_bf16 v[202:205], v[166:169], v[190:193], v[202:205]
    v_mul_f32 v118, v126, v118
    v_mul_f32 v119, v126, v119
    v_cvt_pk_bf16_f32 v190, v118, v119
    v_mul_f32 v120, v126, v120
    v_mul_f32 v121, v126, v121
    v_cvt_pk_bf16_f32 v191, v120, v121
    v_mul_f32 v174, v126, v174
    v_mul_f32 v175, v126, v175
    v_cvt_pk_bf16_f32 v192, v174, v175
    s_waitcnt lgkmcnt(3)
    s_waitcnt lgkmcnt(2)
    v_add_f32 v182, v182, v183
    v_add_f32 v184, v184, v185
    s_waitcnt lgkmcnt(1)
    v_add_f32 v182, v182, v184
    v_mul_f32 v182, 0xbbaaaaab, v182
    ds_write_b32 v153, v182 offset:0
    v_add_f32 v242, v242, v243
    v_add_f32 v244, v244, v245
    v_add_f32 v242, v242, v244
    v_mul_f32 v242, 0xbbaaaaab, v242
    ds_write_b32 v153, v242 offset:256
    v_add_f32 v162, v162, v163
    v_add_f32 v164, v164, v165
    s_waitcnt vmcnt(0)
    s_barrier
    buffer_load_dwordx4 v10, s[8:11], 0 offen nt lds
    s_add_u32 m0, s28, 4096
    ds_read_b128 v[182:185], v0 offset:20480
    ds_read_b128 v[198:201], v1 offset:20480
    ds_read_b128 v[210:213], v0 offset:20608
    ds_read_b128 v[222:225], v1 offset:20608
    ds_read_b128 v[226:229], v0 offset:20736
    ds_read_b128 v[242:245], v1 offset:20736
    buffer_load_dwordx4 v11, s[8:11], 0 offen nt lds
    v_add_f32 v162, v162, v164
    v_mul_f32 v162, 0xbbaaaaab, v162
    s_add_u32 m0, s28, 8192
    ds_write_b32 v153, v162 offset:512
    v_mul_f32 v176, v126, v176
    v_mul_f32 v177, v126, v177
    v_cvt_pk_bf16_f32 v193, v176, v177
    v_mul_f32 v202, v126, v202
    ds_read_b128 v[174:177], v254 offset:0
    s_waitcnt lgkmcnt(7)
    v_mfma_f32_16x16x32_bf16 v[118:121], a[72:75], v[182:185], 0
    s_waitcnt lgkmcnt(5)
    buffer_load_dwordx4 v12, s[8:11], 0 offen nt lds
    ds_read_b128 v[218:221], v254 offset:64
    v_mfma_f32_16x16x32_bf16 v[118:121], a[76:79], v[198:201], v[118:121]
    s_add_u32 m0, s28, 12288
    ds_read_b128 v[178:181], v254 offset:128
    ds_read_b128 v[162:165], v254 offset:192
    v_mfma_f32_16x16x32_bf16 v[118:121], a[80:83], v[210:213], v[118:121]
    s_waitcnt lgkmcnt(6)
    ds_read_b128 v[186:189], v254 offset:256
    v_mul_f32 v203, v126, v203
    v_mfma_f32_16x16x32_bf16 v[118:121], a[84:87], v[222:225], v[118:121]
    s_xor_b32 s28, s28, 65536
    ds_write_b128 v3, v[190:193] offset:12288
    v_mfma_f32_16x16x32_bf16 v[118:121], a[88:91], v[226:229], v[118:121]
    s_waitcnt lgkmcnt(6)
    buffer_load_dwordx4 v13, s[8:11], 0 offen nt lds
    v_cvt_pk_bf16_f32 v144, v202, v203
    v_mfma_f32_16x16x32_bf16 v[118:121], a[92:95], v[242:245], v[118:121]
    s_mov_b32 m0, s29
    v_mul_f32 v204, v126, v204
    v_mul_f32 v205, v126, v205
    v_mfma_f32_16x16x32_bf16 v[190:193], a[96:99], v[182:185], 0
    s_waitcnt lgkmcnt(5)
    v_cvt_pk_bf16_f32 v145, v204, v205
    v_mul_f32 v160, v194, v160
    v_mul_f32 v161, v194, v161
    v_mfma_f32_16x16x16_bf16 v[194:197], a[216:217], v[150:151], v[174:177]
    v_cvt_pk_bf16_f32 v153, v160, v161
    v_rcp_f32 v170, v170
    v_mfma_f32_16x16x16_bf16 v[158:161], a[240:241], v[150:151], v[174:177]
    v_mul_f32 v146, v170, v146
    v_mul_f32 v147, v170, v147
    v_cvt_pk_bf16_f32 v146, v146, v147
    v_mfma_f32_16x16x16_bf16 v[126:129], v[90:91], v[150:151], v[174:177]
    v_mul_f32 v148, v170, v148
    v_cvt_pk_bf16_f32 v194, v194, v195
    v_accvgpr_write_b32 a216, v194
    v_cvt_pk_bf16_f32 v196, v196, v197
    v_mfma_f32_16x16x32_bf16 v[190:193], a[100:103], v[198:201], v[190:193]
    s_waitcnt lgkmcnt(0)
    buffer_load_dwordx4 v14, s[8:11], 0 offen nt lds
    ds_write_b64 v4, v[152:153] offset:4096
    v_mfma_f32_16x16x16_bf16 v[174:177], a[218:219], v[150:151], v[218:221]
    v_accvgpr_write_b32 a217, v196
    v_cvt_pk_bf16_f32 v158, v158, v159
    v_accvgpr_write_b32 a240, v158
    v_mfma_f32_16x16x16_bf16 v[194:197], a[242:243], v[150:151], v[218:221]
    v_cvt_pk_bf16_f32 v160, v160, v161
    v_accvgpr_write_b32 a241, v160
    v_cvt_pk_bf16_f32 v90, v126, v127
    v_mfma_f32_16x16x16_bf16 v[158:161], v[92:93], v[150:151], v[218:221]
    v_cvt_pk_bf16_f32 v91, v128, v129
    v_cvt_pk_bf16_f32 v174, v174, v175
    v_accvgpr_write_b32 a218, v174
    v_mfma_f32_16x16x16_bf16 v[126:129], a[232:233], v[150:151], v[178:181]
    v_cvt_pk_bf16_f32 v176, v176, v177
    v_accvgpr_write_b32 a219, v176
    v_cvt_pk_bf16_f32 v194, v194, v195
    v_mfma_f32_16x16x16_bf16 v[174:177], v[82:83], v[150:151], v[178:181]
    v_accvgpr_write_b32 a242, v194
    v_cvt_pk_bf16_f32 v196, v196, v197
    v_accvgpr_write_b32 a243, v196
    v_mfma_f32_16x16x16_bf16 v[194:197], v[106:107], v[150:151], v[178:181]
    v_cvt_pk_bf16_f32 v92, v158, v159
    v_cvt_pk_bf16_f32 v93, v160, v161
    v_cvt_pk_bf16_f32 v126, v126, v127
    v_mfma_f32_16x16x16_bf16 v[158:161], a[220:221], v[150:151], v[162:165]
    v_accvgpr_write_b32 a232, v126
    v_cvt_pk_bf16_f32 v128, v128, v129
    v_accvgpr_write_b32 a233, v128
    v_mfma_f32_16x16x16_bf16 v[202:205], a[244:245], v[150:151], v[162:165]
    v_cvt_pk_bf16_f32 v82, v174, v175
    v_cvt_pk_bf16_f32 v83, v176, v177
    v_cvt_pk_bf16_f32 v106, v194, v195
    v_mfma_f32_16x16x16_bf16 v[126:129], v[94:95], v[150:151], v[162:165]
    v_cvt_pk_bf16_f32 v107, v196, v197
    v_cvt_pk_bf16_f32 v158, v158, v159
    v_accvgpr_write_b32 a220, v158
    v_mfma_f32_16x16x16_bf16 v[174:177], a[222:223], v[150:151], v[186:189]
    v_cvt_pk_bf16_f32 v160, v160, v161
    v_accvgpr_write_b32 a221, v160
    v_cvt_pk_bf16_f32 v202, v202, v203
    v_mfma_f32_16x16x16_bf16 v[194:197], a[246:247], v[150:151], v[186:189]
    v_accvgpr_write_b32 a244, v202
    v_cvt_pk_bf16_f32 v204, v204, v205
    v_accvgpr_write_b32 a245, v204
    v_mfma_f32_16x16x16_bf16 v[162:165], v[96:97], v[150:151], v[186:189]
    v_cvt_pk_bf16_f32 v94, v126, v127
    v_cvt_pk_bf16_f32 v95, v128, v129
    v_cvt_pk_bf16_f32 v174, v174, v175
    v_accvgpr_write_b32 a222, v174
    v_mfma_f32_16x16x32_bf16 v[190:193], a[104:107], v[210:213], v[190:193]
    s_xor_b32 s29, s29, s30
    ds_read_b128 v[126:129], v254 offset:320
    ds_read_b128 v[202:205], v254 offset:384
    v_mfma_f32_16x16x32_bf16 v[190:193], a[108:111], v[222:225], v[190:193]
    ds_read_b128 v[218:221], v254 offset:448
    ds_read_b128 v[178:181], v254 offset:512
    v_mfma_f32_16x16x32_bf16 v[190:193], a[112:115], v[226:229], v[190:193]
    v_cvt_pk_bf16_f32 v176, v176, v177
    v_accvgpr_write_b32 a223, v176
    v_mfma_f32_16x16x32_bf16 v[190:193], a[116:119], v[242:245], v[190:193]
    ds_write_b64 v4, v[144:145] offset:16384
    v_mfma_f32_16x16x32_bf16 v[158:161], a[120:123], v[182:185], 0
    v_cvt_pk_bf16_f32 v194, v194, v195
    v_accvgpr_write_b32 a246, v194
    v_mfma_f32_16x16x32_bf16 v[158:161], a[124:127], v[198:201], v[158:161]
    v_cvt_pk_bf16_f32 v196, v196, v197
    v_accvgpr_write_b32 a247, v196
    v_mfma_f32_16x16x32_bf16 v[158:161], a[128:131], v[210:213], v[158:161]
    v_cvt_pk_bf16_f32 v96, v162, v163
    v_cvt_pk_bf16_f32 v97, v164, v165
    v_mfma_f32_16x16x32_bf16 v[158:161], a[132:135], v[222:225], v[158:161]
    s_waitcnt lgkmcnt(4)
    ds_read_b128 v[194:197], v254 offset:576
    v_mul_f32 v149, v170, v149
    v_cvt_pk_bf16_f32 v147, v148, v149
    v_mfma_f32_16x16x16_bf16 v[174:177], a[234:235], v[150:151], v[126:129]
    v_mul_f32 v206, v170, v206
    v_mul_f32 v207, v170, v207
    v_cvt_pk_bf16_f32 v148, v206, v207
    v_mfma_f32_16x16x16_bf16 v[162:165], v[84:85], v[150:151], v[126:129]
    v_mul_f32 v208, v170, v208
    v_mul_f32 v209, v170, v209
    v_cvt_pk_bf16_f32 v149, v208, v209
    v_mfma_f32_16x16x16_bf16 v[206:209], v[108:109], v[150:151], v[126:129]
    v_cvt_pk_bf16_f32 v174, v174, v175
    v_accvgpr_write_b32 a234, v174
    v_cvt_pk_bf16_f32 v176, v176, v177
    v_accvgpr_write_b32 a235, v176
    v_mfma_f32_16x16x32_bf16 v[158:161], a[136:139], v[226:229], v[158:161]
    s_waitcnt lgkmcnt(1)
    ds_write_b128 v3, v[146:149] offset:6144
    v_mfma_f32_16x16x16_bf16 v[146:149], a[224:225], v[150:151], v[202:205]
    v_cvt_pk_bf16_f32 v84, v162, v163
    v_cvt_pk_bf16_f32 v85, v164, v165
    v_cvt_pk_bf16_f32 v108, v206, v207
    v_mfma_f32_16x16x16_bf16 v[126:129], a[248:249], v[150:151], v[202:205]
    v_cvt_pk_bf16_f32 v109, v208, v209
    v_mul_f32 v154, v170, v154
    v_mul_f32 v155, v170, v155
    v_mfma_f32_16x16x16_bf16 v[206:209], v[98:99], v[150:151], v[202:205]
    v_cvt_pk_bf16_f32 v146, v146, v147
    v_accvgpr_write_b32 a224, v146
    v_cvt_pk_bf16_f32 v148, v148, v149
    v_mfma_f32_16x16x16_bf16 v[174:177], a[226:227], v[150:151], v[218:221]
    v_accvgpr_write_b32 a225, v148
    v_cvt_pk_bf16_f32 v126, v126, v127
    v_accvgpr_write_b32 a248, v126
    v_mfma_f32_16x16x16_bf16 v[146:149], a[250:251], v[150:151], v[218:221]
    v_cvt_pk_bf16_f32 v128, v128, v129
    v_accvgpr_write_b32 a249, v128
    v_cvt_pk_bf16_f32 v98, v206, v207
    v_mfma_f32_16x16x16_bf16 v[126:129], v[100:101], v[150:151], v[218:221]
    v_cvt_pk_bf16_f32 v99, v208, v209
    v_cvt_pk_bf16_f32 v174, v174, v175
    v_accvgpr_write_b32 a226, v174
    v_mfma_f32_16x16x16_bf16 v[206:209], a[236:237], v[150:151], v[178:181]
    v_cvt_pk_bf16_f32 v176, v176, v177
    v_accvgpr_write_b32 a227, v176
    v_cvt_pk_bf16_f32 v146, v146, v147
    v_mfma_f32_16x16x16_bf16 v[174:177], v[86:87], v[150:151], v[178:181]
    v_accvgpr_write_b32 a250, v146
    v_cvt_pk_bf16_f32 v148, v148, v149
    v_accvgpr_write_b32 a251, v148
    v_mfma_f32_16x16x16_bf16 v[146:149], v[110:111], v[150:151], v[178:181]
    v_cvt_pk_bf16_f32 v100, v126, v127
    v_cvt_pk_bf16_f32 v101, v128, v129
    v_cvt_pk_bf16_f32 v206, v206, v207
    v_accvgpr_write_b32 a236, v206
    v_mfma_f32_16x16x32_bf16 v[158:161], a[140:143], v[242:245], v[158:161]
    s_waitcnt lgkmcnt(0)
    ds_read_b128 v[126:129], v254 offset:640
    ds_read_b128 v[218:221], v254 offset:704
    v_cvt_pk_bf16_f32 v208, v208, v209
    v_mfma_f32_16x16x16_bf16 v[202:205], a[228:229], v[150:151], v[194:197]
    v_accvgpr_write_b32 a237, v208
    v_cvt_pk_bf16_f32 v86, v174, v175
    v_cvt_pk_bf16_f32 v87, v176, v177
    v_mfma_f32_16x16x16_bf16 v[174:177], a[252:253], v[150:151], v[194:197]
    v_cvt_pk_bf16_f32 v110, v146, v147
    v_cvt_pk_bf16_f32 v111, v148, v149
    v_cvt_pk_bf16_f32 v254, v154, v155
    v_mfma_f32_16x16x16_bf16 v[146:149], v[102:103], v[150:151], v[194:197]
    v_cvt_pk_bf16_f32 v202, v202, v203
    v_accvgpr_write_b32 a228, v202
    v_cvt_pk_bf16_f32 v204, v204, v205
    v_accvgpr_write_b32 a229, v204
    v_mfma_f32_16x16x32_bf16 v[206:209], a[0:3], v[182:185], 0
    v_cvt_pk_bf16_f32 v174, v174, v175
    v_accvgpr_write_b32 a252, v174
    v_mfma_f32_16x16x32_bf16 v[206:209], a[4:7], v[198:201], v[206:209]
    v_cvt_pk_bf16_f32 v176, v176, v177
    v_accvgpr_write_b32 a253, v176
    v_mfma_f32_16x16x32_bf16 v[206:209], a[8:11], v[210:213], v[206:209]
    v_cvt_pk_bf16_f32 v102, v146, v147
    v_cvt_pk_bf16_f32 v103, v148, v149
    v_mfma_f32_16x16x32_bf16 v[206:209], a[12:15], v[222:225], v[206:209]
    s_waitcnt lgkmcnt(0)
    v_mul_f32 v156, v170, v156
    v_mul_f32 v157, v170, v157
    v_cvt_pk_bf16_f32 v255, v156, v157
    v_mfma_f32_16x16x16_bf16 v[194:197], a[230:231], v[150:151], v[126:129]
    v_cvt_pk_f16_f32 v118, v118, v119
    v_pk_mul_f16 v163, v118, v118
    v_cvt_pk_f16_f32 v119, v120, v121
    v_mfma_f32_16x16x16_bf16 v[146:149], a[254:255], v[150:151], v[126:129]
    v_pk_mul_f16 v165, v119, v119
    v_cvt_pk_f16_f32 v120, v190, v191
    v_pk_fma_f16 v163, v120, v120, v163
    v_mfma_f32_16x16x16_bf16 v[154:157], v[104:105], v[150:151], v[126:129]
    v_cvt_pk_bf16_f32 v194, v194, v195
    v_accvgpr_write_b32 a230, v194
    v_cvt_pk_bf16_f32 v196, v196, v197
    v_mfma_f32_16x16x16_bf16 v[174:177], a[238:239], v[150:151], v[218:221]
    v_accvgpr_write_b32 a231, v196
    v_cvt_pk_bf16_f32 v146, v146, v147
    v_accvgpr_write_b32 a254, v146
    v_mfma_f32_16x16x16_bf16 v[194:197], v[88:89], v[150:151], v[218:221]
    v_cvt_pk_bf16_f32 v148, v148, v149
    v_accvgpr_write_b32 a255, v148
    v_cvt_pk_bf16_f32 v104, v154, v155
    v_mfma_f32_16x16x16_bf16 v[146:149], v[112:113], v[150:151], v[218:221]
    v_cvt_pk_bf16_f32 v105, v156, v157
    v_cvt_pk_bf16_f32 v174, v174, v175
    v_accvgpr_write_b32 a238, v174
    v_cvt_pk_bf16_f32 v176, v176, v177
    v_mfma_f32_16x16x32_bf16 v[206:209], a[16:19], v[226:229], v[206:209]
    ds_write_b64 v4, v[254:255] offset:10240
    v_mfma_f32_16x16x32_bf16 v[206:209], a[20:23], v[242:245], v[206:209]
    v_accvgpr_write_b32 a239, v176
    v_cvt_pk_bf16_f32 v88, v194, v195
    v_mfma_f32_16x16x32_bf16 v[174:177], a[24:27], v[182:185], 0
    v_cvt_pk_bf16_f32 v89, v196, v197
    v_cvt_pk_bf16_f32 v112, v146, v147
    v_mfma_f32_16x16x32_bf16 v[174:177], a[28:31], v[198:201], v[174:177]
    v_cvt_pk_bf16_f32 v113, v148, v149
    v_cvt_pk_f16_f32 v121, v192, v193
    v_mfma_f32_16x16x32_bf16 v[174:177], a[32:35], v[210:213], v[174:177]
    v_pk_fma_f16 v165, v121, v121, v165
    v_cvt_pk_f16_f32 v196, v158, v159
    v_mfma_f32_16x16x32_bf16 v[174:177], a[36:39], v[222:225], v[174:177]
    v_pk_fma_f16 v163, v196, v196, v163
    v_cvt_pk_f16_f32 v197, v160, v161
    v_mfma_f32_16x16x32_bf16 v[174:177], a[40:43], v[226:229], v[174:177]
    v_pk_fma_f16 v165, v197, v197, v165
    v_cvt_pk_f16_f32 v206, v206, v207
    v_mfma_f32_16x16x32_bf16 v[174:177], a[44:47], v[242:245], v[174:177]
    v_cvt_pk_bf16_f32 v142, v142, v142
    v_xor_b32 v3, 65536, v3
    v_mfma_f32_16x16x32_bf16 v[218:221], a[48:51], v[182:185], 0
    ds_write_b16 v8, v142
    v_mfma_f32_16x16x32_bf16 v[218:221], a[52:55], v[198:201], v[218:221]
    v_xor_b32 v4, 65536, v4
    v_mfma_f32_16x16x32_bf16 v[218:221], a[56:59], v[210:213], v[218:221]
    ds_read_b128 v[190:193], v9
    ds_read_b128 v[150:153], v9 offset:64
    v_mfma_f32_16x16x32_bf16 v[218:221], a[60:63], v[222:225], v[218:221]
    v_mfma_f32_16x16x32_bf16 v[218:221], a[64:67], v[226:229], v[218:221]
    v_mfma_f32_16x16x32_bf16 v[218:221], a[68:71], v[242:245], v[218:221]
    v_mfma_f32_16x16x32_bf16 v[170:173], v[182:185], a[144:147], 0
    v_mfma_f32_16x16x32_bf16 v[170:173], v[198:201], a[148:151], v[170:173]
    v_mfma_f32_16x16x32_bf16 v[170:173], v[210:213], a[152:155], v[170:173]
    v_mfma_f32_16x16x32_bf16 v[170:173], v[222:225], a[156:159], v[170:173]
    v_mfma_f32_16x16x32_bf16 v[170:173], v[226:229], a[160:163], v[170:173]
    s_waitcnt lgkmcnt(0)
    v_mfma_f32_16x16x32_bf16 v[158:161], v[190:193], v[28:31], 0
    v_mfma_f32_16x16x32_bf16 v[158:161], v[150:153], v[28:31], v[158:161]
    v_mfma_f32_16x16x32_bf16 v[146:149], v[190:193], v[138:141], 0
    v_mfma_f32_16x16x32_bf16 v[146:149], v[150:153], v[130:133], v[146:149]
    v_mfma_f32_16x16x32_bf16 v[130:133], v[190:193], v[122:125], 0
    v_mfma_f32_16x16x32_bf16 v[130:133], v[150:153], v[134:137], v[130:133]
    v_mfma_f32_16x16x32_bf16 v[122:125], v[190:193], v[166:169], 0
    v_mfma_f32_16x16x32_bf16 v[122:125], v[150:153], v[114:117], v[122:125]
    v_mfma_f32_16x16x32_bf16 v[170:173], v[242:245], a[164:167], v[170:173]
    s_nop 0
    v_rcp_f32 v158, v158
    s_nop 0
    v_mul_f32 v146, v146, v158
    s_nop 0
    v_mul_f32_dpp v146, v130, v158 quad_perm:[0,1,2,3] row_mask:0x2 bank_mask:0xf
    s_nop 0
    v_mul_f32_dpp v146, v122, v158 quad_perm:[0,1,2,3] row_mask:0x4 bank_mask:0xf
    v_cvt_pk_bf16_f32 v146, v146, v146
    ds_write_b16 v7, v146
    v_add_u32 v7, 16, v7
    s_waitcnt lgkmcnt(0)
    s_barrier
L_go:
    s_waitcnt lgkmcnt(0)
    s_cmp_eq_u32 s16, 1
    s_cbranch_scc1 L_loop_fast1
    s_cmp_eq_u32 s16, 2
    s_cbranch_scc1 L_loop_fast2
    s_cmp_eq_u32 s16, 3
    s_cbranch_scc1 L_loop_fast3
    s_branch L_loop_fast0
.p2align 6
L_loop_fast0:
    v_mfma_f32_16x16x32_bf16 v[234:237], v[182:185], a[168:171], 0
    s_add_u32 s12, s42, s27
    ds_read_b128 v[230:233], v2 offset:18432
    ds_read_b128 v[238:241], v2 offset:19456
    v_mfma_f32_16x16x32_bf16 v[234:237], v[198:201], a[172:175], v[234:237]
    s_addc_u32 s13, s43, 0
    v_pk_mul_f16 v162, v206, v206
    v_cvt_pk_f16_f32 v207, v208, v209
    v_mfma_f32_16x16x32_bf16 v[234:237], v[210:213], a[176:179], v[234:237]
    s_sub_u32 s14, s36, s27
    ds_read_b128 v[134:137], v0 offset:26624
    v_pk_mul_f16 v164, v207, v207
    v_mfma_f32_16x16x32_bf16 v[234:237], v[222:225], a[180:183], v[234:237]
    s_cmp_ge_u32 s18, 2
    ds_read_b128 v[154:157], v1 offset:26624
    v_cvt_pk_f16_f32 v208, v174, v175
    v_mfma_f32_16x16x32_bf16 v[234:237], v[226:229], a[184:187], v[234:237]
    s_cselect_b32 s14, s14, 0
    ds_read_b128 v[130:133], v0 offset:26752
    v_pk_fma_f16 v162, v208, v208, v162
    v_mfma_f32_16x16x32_bf16 v[234:237], v[242:245], a[188:191], v[234:237]
    s_add_u32 s34, s18, 2
    ds_read_b128 v[122:125], v1 offset:26752
    v_cvt_pk_f16_f32 v209, v176, v177
    v_mfma_f32_16x16x32_bf16 v[114:117], v[182:185], a[192:195], 0
    s_add_u32 s8, s40, s23
    ds_read_b128 v[126:129], v0 offset:26880
    v_pk_fma_f16 v164, v209, v209, v164
    v_mfma_f32_16x16x32_bf16 v[114:117], v[198:201], a[196:199], v[114:117]
    s_addc_u32 s9, s41, 0
    ds_read_b128 v[166:169], v1 offset:26880
    v_cvt_pk_f16_f32 v194, v218, v219
    v_mfma_f32_16x16x32_bf16 v[114:117], v[210:213], a[200:203], v[114:117]
    s_waitcnt lgkmcnt(6)
    v_pk_fma_f16 v162, v194, v194, v162
    v_cvt_pk_f16_f32 v195, v220, v221
    v_mfma_f32_16x16x32_bf16 v[198:201], v[32:35], v[230:233], 0
    s_sub_u32 s10, s36, s23
    v_pk_fma_f16 v164, v195, v195, v164
    v_cvt_pk_bf16_f32 v174, v170, v171
    v_mfma_f32_16x16x32_bf16 v[198:201], v[32:35], v[238:241], v[198:201]
    s_waitcnt lgkmcnt(5)
    v_cvt_pk_bf16_f32 v175, v172, v173
    v_cvt_pk_bf16_f32 v182, v234, v235
    v_mfma_f32_16x16x32_f16 v[170:173], v[40:43], v[162:165], 0
    s_cmp_lt_u32 s34, s17
    v_cvt_pk_bf16_f32 v183, v236, v237
    s_cselect_b32 s10, s10, 0
    v_mfma_f32_16x16x32_bf16 v[114:117], v[222:225], a[204:207], v[114:117]
    s_add_u32 m0, s28, 0
    v_mul_f32 v255, 0x3baaaaab, v198
    v_mul_f32 v254, 0x3baaaaab, v199
    v_mfma_f32_16x16x32_bf16 v[114:117], v[226:229], a[208:211], v[114:117]
    s_mov_b32 s27, s26
    v_rsq_f32 v172, v170
    v_mfma_f32_16x16x32_bf16 v[114:117], v[242:245], a[212:215], v[114:117]
    s_mov_b32 s26, s25
    v_rsq_f32 v173, v171
    v_mfma_f32_16x16x32_bf16 v[162:165], a[72:75], v[134:137], 0
    s_waitcnt lgkmcnt(0)
    v_mul_f32 v172, s31, v172
    v_cvt_pk_f16_f32 v172, v172, v173
    v_mfma_f32_16x16x32_bf16 v[162:165], a[76:79], v[154:157], v[162:165]
    s_mov_b32 s25, s24
    v_cvt_pk_bf16_f32 v114, v114, v115
    v_cvt_pk_bf16_f32 v115, v116, v117
    v_mfma_f32_16x16x32_bf16 v[162:165], a[80:83], v[130:133], v[162:165]
    s_mov_b32 s24, s23
    v_pk_mul_f16 v118, v118, v172 op_sel:[0,1] op_sel_hi:[1,1]
    v_pk_mul_f16 v119, v119, v172 op_sel:[0,1] op_sel_hi:[1,1]
    v_mfma_f32_16x16x32_bf16 v[162:165], a[84:87], v[122:125], v[162:165]
    v_pk_mul_f16 v120, v120, v172 op_sel:[0,1] op_sel_hi:[1,1]
    v_pk_mul_f16 v121, v121, v172 op_sel:[0,1] op_sel_hi:[1,1]
    v_mfma_f32_16x16x32_bf16 v[162:165], a[88:91], v[126:129], v[162:165]
    v_pk_mul_f16 v196, v196, v172 op_sel:[0,1] op_sel_hi:[1,1]
    v_pk_mul_f16 v197, v197, v172 op_sel:[0,1] op_sel_hi:[1,1]
    v_mfma_f32_16x16x32_bf16 v[162:165], a[92:95], v[166:169], v[162:165]
    v_pk_mul_f16 v206, v206, v172 op_sel:[0,0] op_sel_hi:[1,0]
    v_pk_mul_f16 v207, v207, v172 op_sel:[0,0] op_sel_hi:[1,0]
    v_mfma_f32_16x16x32_bf16 v[210:213], a[96:99], v[134:137], 0
    v_pk_mul_f16 v208, v208, v172 op_sel:[0,0] op_sel_hi:[1,0]
    v_pk_mul_f16 v209, v209, v172 op_sel:[0,0] op_sel_hi:[1,0]
    v_mfma_f32_16x16x32_bf16 v[210:213], a[100:103], v[154:157], v[210:213]
    v_pk_mul_f16 v194, v194, v172 op_sel:[0,0] op_sel_hi:[1,0]
    v_pk_mul_f16 v195, v195, v172 op_sel:[0,0] op_sel_hi:[1,0]
    v_mfma_f32_16x16x32_bf16 v[210:213], a[104:107], v[130:133], v[210:213]
    v_min3_u32 v44, v44, v170, v171
    v_max3_u32 v45, v45, v170, v171
    v_mfma_f32_16x16x32_bf16 v[210:213], a[108:111], v[122:125], v[210:213]
    v_cvt_pk_f16_f32 v170, v162, v163
    v_pk_mul_f16 v163, v170, v170
    v_mfma_f32_16x16x32_bf16 v[210:213], a[112:115], v[126:129], v[210:213]
    v_cvt_pk_f16_f32 v171, v164, v165
    v_pk_mul_f16 v165, v171, v171
    v_mfma_f32_16x16x32_bf16 v[210:213], a[116:119], v[166:169], v[210:213]
    v_rsq_f32 v255, v255
    v_mfma_f32_16x16x32_bf16 v[214:217], a[120:123], v[134:137], 0
    v_rsq_f32 v254, v254
    v_mfma_f32_16x16x32_bf16 v[214:217], a[124:127], v[154:157], v[214:217]
    v_mul_f32 v142, v254, v142
    v_mul_f32 v143, v254, v143
    v_mfma_f32_16x16x32_bf16 v[214:217], a[128:131], v[130:133], v[214:217]
    v_cvt_pk_bf16_f32 v142, v142, v143
    v_cvt_pk_f16_f32 v172, v210, v211
    v_mfma_f32_16x16x32_bf16 v[214:217], a[132:135], v[122:125], v[214:217]
    v_pk_fma_f16 v163, v172, v172, v163
    v_cvt_pk_f16_f32 v173, v212, v213
    v_mfma_f32_16x16x32_bf16 v[214:217], a[136:139], v[126:129], v[214:217]
    v_pk_fma_f16 v165, v173, v173, v165
    v_mul_f32 v144, v254, v144
    v_mfma_f32_16x16x32_bf16 v[214:217], a[140:143], v[166:169], v[214:217]
    v_mul_f32 v145, v254, v145
    v_cvt_pk_bf16_f32 v143, v144, v145
    v_mfma_f32_16x16x32_bf16 v[210:213], a[0:3], v[134:137], 0
    v_mul_f32 v158, v254, v158
    v_mul_f32 v159, v254, v159
    v_mfma_f32_16x16x32_bf16 v[210:213], a[4:7], v[154:157], v[210:213]
    v_cvt_pk_bf16_f32 v144, v158, v159
    v_mul_f32 v160, v254, v160
    v_mfma_f32_16x16x32_bf16 v[210:213], a[8:11], v[130:133], v[210:213]
    v_cvt_pk_f16_f32 v220, v214, v215
    v_pk_fma_f16 v163, v220, v220, v163
    v_mfma_f32_16x16x32_bf16 v[210:213], a[12:15], v[122:125], v[210:213]
    v_cvt_pk_f16_f32 v221, v216, v217
    v_pk_fma_f16 v165, v221, v221, v165
    v_mfma_f32_16x16x32_bf16 v[210:213], a[16:19], v[126:129], v[210:213]
    v_mul_f32 v161, v254, v161
    v_cvt_pk_bf16_f32 v145, v160, v161
    v_mfma_f32_16x16x32_bf16 v[210:213], a[20:23], v[166:169], v[210:213]
    buffer_store_dwordx4 v[142:145], v16, s[12:15], 0 offen nt
    v_mul_f32 v178, v254, v178
    v_mul_f32 v179, v254, v179
    v_cvt_pk_bf16_f32 v198, v178, v179
    v_mul_f32 v180, v254, v180
    v_mfma_f32_16x16x32_bf16 v[142:145], a[24:27], v[134:137], 0
    v_mul_f32 v181, v254, v181
    v_cvt_pk_bf16_f32 v199, v180, v181
    v_mfma_f32_16x16x32_bf16 v[142:145], a[28:31], v[154:157], v[142:145]
    v_cvt_pk_f16_f32 v158, v210, v211
    v_pk_mul_f16 v162, v158, v158
    v_mfma_f32_16x16x32_bf16 v[142:145], a[32:35], v[130:133], v[142:145]
    v_cvt_pk_f16_f32 v159, v212, v213
    v_pk_mul_f16 v164, v159, v159
    v_mfma_f32_16x16x32_bf16 v[142:145], a[36:39], v[122:125], v[142:145]
    v_mul_f32 v254, 0x3baaaaab, v200
    v_mul_f32 v150, v255, v150
    v_mfma_f32_16x16x32_bf16 v[142:145], a[40:43], v[126:129], v[142:145]
    v_rsq_f32 v254, v254
    v_mfma_f32_16x16x32_bf16 v[142:145], a[44:47], v[166:169], v[142:145]
    v_mul_f32 v146, v254, v146
    v_mul_f32 v147, v254, v147
    v_mfma_f32_16x16x32_bf16 v[178:181], a[48:51], v[134:137], 0
    v_cvt_pk_bf16_f32 v146, v146, v147
    v_mul_f32 v148, v254, v148
    v_mfma_f32_16x16x32_bf16 v[178:181], a[52:55], v[154:157], v[178:181]
    v_mul_f32 v149, v254, v149
    v_cvt_pk_bf16_f32 v147, v148, v149
    v_mfma_f32_16x16x32_bf16 v[178:181], a[56:59], v[130:133], v[178:181]
    v_mul_f32 v138, v254, v138
    v_mul_f32 v139, v254, v139
    v_mfma_f32_16x16x32_bf16 v[178:181], a[60:63], v[122:125], v[178:181]
    v_cvt_pk_bf16_f32 v148, v138, v139
    v_mul_f32 v140, v254, v140
    v_mfma_f32_16x16x32_bf16 v[178:181], a[64:67], v[126:129], v[178:181]
    v_mul_f32 v141, v254, v141
    v_cvt_pk_bf16_f32 v149, v140, v141
    v_mfma_f32_16x16x32_bf16 v[178:181], a[68:71], v[166:169], v[178:181]
    v_mul_f32 v186, v254, v186
    v_mul_f32 v187, v254, v187
    v_mfma_f32_16x16x32_bf16 v[138:141], v[134:137], a[144:147], 0
    v_cvt_pk_bf16_f32 v200, v186, v187
    v_mul_f32 v188, v254, v188
    v_mfma_f32_16x16x32_bf16 v[138:141], v[154:157], a[148:151], v[138:141]
    v_mul_f32 v189, v254, v189
    v_cvt_pk_bf16_f32 v201, v188, v189
    v_mfma_f32_16x16x32_bf16 v[138:141], v[130:133], a[152:155], v[138:141]
    v_cvt_pk_f16_f32 v160, v142, v143
    v_pk_fma_f16 v162, v160, v160, v162
    v_mfma_f32_16x16x32_bf16 v[138:141], v[122:125], a[156:159], v[138:141]
    v_cvt_pk_f16_f32 v161, v144, v145
    v_pk_fma_f16 v164, v161, v161, v164
    v_mfma_f32_16x16x32_bf16 v[138:141], v[126:129], a[160:163], v[138:141]
    buffer_store_dwordx4 v[146:149], v17, s[12:15], 0 offen nt
    v_cvt_pk_f16_f32 v218, v178, v179
    v_pk_fma_f16 v162, v218, v218, v162
    v_cvt_pk_f16_f32 v219, v180, v181
    v_pk_fma_f16 v164, v219, v219, v164
    v_mfma_f32_16x16x32_bf16 v[138:141], v[166:169], a[164:167], v[138:141]
    v_mul_f32 v151, v255, v151
    v_cvt_pk_bf16_f32 v150, v150, v151
    v_mfma_f32_16x16x32_f16 v[142:145], v[40:43], v[162:165], 0
    v_mul_f32 v152, v255, v152
    v_mul_f32 v153, v255, v153
    v_mfma_f32_16x16x32_bf16 v[178:181], v[134:137], a[168:171], 0
    v_cvt_pk_bf16_f32 v151, v152, v153
    v_mul_f32 v190, v255, v190
    v_mfma_f32_16x16x32_bf16 v[178:181], v[154:157], a[172:175], v[178:181]
    v_cvt_pk_bf16_f32 v176, v138, v139
    v_cvt_pk_bf16_f32 v177, v140, v141
    v_mfma_f32_16x16x32_bf16 v[178:181], v[130:133], a[176:179], v[178:181]
    ds_read_b128 v[146:149], v0 offset:32768
    v_min3_u32 v44, v44, v142, v143
    v_mfma_f32_16x16x32_bf16 v[178:181], v[122:125], a[180:183], v[178:181]
    ds_read_b128 v[138:141], v1 offset:32768
    v_max3_u32 v45, v45, v142, v143
    v_mfma_f32_16x16x32_bf16 v[178:181], v[126:129], a[184:187], v[178:181]
    ds_read_b128 v[186:189], v0 offset:32896
    v_mul_f32 v191, v255, v191
    v_mfma_f32_16x16x32_bf16 v[178:181], v[166:169], a[188:191], v[178:181]
    ds_read_b128 v[162:165], v1 offset:32896
    v_cvt_pk_bf16_f32 v152, v190, v191
    v_mfma_f32_16x16x32_bf16 v[210:213], v[134:137], a[192:195], 0
    ds_read_b128 v[134:137], v0 offset:33024
    v_mul_f32 v192, v255, v192
    v_mfma_f32_16x16x32_bf16 v[210:213], v[154:157], a[196:199], v[210:213]
    ds_read_b128 v[154:157], v1 offset:33024
    v_mul_f32 v193, v255, v193
    v_mfma_f32_16x16x32_bf16 v[210:213], v[130:133], a[200:203], v[210:213]
    v_rsq_f32 v144, v142
    v_mfma_f32_16x16x32_bf16 v[210:213], v[122:125], a[204:207], v[210:213]
    v_rsq_f32 v145, v143
    v_mfma_f32_16x16x32_bf16 v[210:213], v[126:129], a[208:211], v[210:213]
    s_waitcnt lgkmcnt(5)
    v_mul_f32 v144, s31, v144
    v_cvt_pk_f16_f32 v144, v144, v145
    v_mfma_f32_16x16x32_bf16 v[210:213], v[166:169], a[212:215], v[210:213]
    s_waitcnt lgkmcnt(4)
    v_cvt_pk_bf16_f32 v184, v178, v179
    v_cvt_pk_bf16_f32 v185, v180, v181
    v_mfma_f32_16x16x32_bf16 v[178:181], a[72:75], v[146:149], 0
    s_waitcnt lgkmcnt(3)
    v_pk_mul_f16 v170, v170, v144 op_sel:[0,1] op_sel_hi:[1,1]
    v_pk_mul_f16 v171, v171, v144 op_sel:[0,1] op_sel_hi:[1,1]
    v_mfma_f32_16x16x32_bf16 v[178:181], a[76:79], v[138:141], v[178:181]
    s_waitcnt lgkmcnt(2)
    v_cvt_pk_bf16_f32 v116, v210, v211
    v_cvt_pk_bf16_f32 v117, v212, v213
    v_mfma_f32_16x16x32_bf16 v[178:181], a[80:83], v[186:189], v[178:181]
    s_waitcnt lgkmcnt(1)
    buffer_store_dwordx2 v[200:201], v20, s[12:15], 0 offen nt
    v_pk_mul_f16 v172, v172, v144 op_sel:[0,1] op_sel_hi:[1,1]
    v_pk_mul_f16 v173, v173, v144 op_sel:[0,1] op_sel_hi:[1,1]
    v_mfma_f32_16x16x32_bf16 v[178:181], a[84:87], v[162:165], v[178:181]
    s_waitcnt lgkmcnt(0)
    v_pk_mul_f16 v220, v220, v144 op_sel:[0,1] op_sel_hi:[1,1]
    v_pk_mul_f16 v221, v221, v144 op_sel:[0,1] op_sel_hi:[1,1]
    v_mfma_f32_16x16x32_bf16 v[178:181], a[88:91], v[134:137], v[178:181]
    v_pk_mul_f16 v158, v158, v144 op_sel:[0,0] op_sel_hi:[1,0]
    v_pk_mul_f16 v159, v159, v144 op_sel:[0,0] op_sel_hi:[1,0]
    v_mfma_f32_16x16x32_bf16 v[178:181], a[92:95], v[154:157], v[178:181]
    v_pk_mul_f16 v160, v160, v144 op_sel:[0,0] op_sel_hi:[1,0]
    v_pk_mul_f16 v161, v161, v144 op_sel:[0,0] op_sel_hi:[1,0]
    v_mfma_f32_16x16x32_bf16 v[130:133], a[96:99], v[146:149], 0
    v_pk_mul_f16 v218, v218, v144 op_sel:[0,0] op_sel_hi:[1,0]
    v_pk_mul_f16 v219, v219, v144 op_sel:[0,0] op_sel_hi:[1,0]
    v_mfma_f32_16x16x32_bf16 v[130:133], a[100:103], v[138:141], v[130:133]
    s_waitcnt vmcnt(3)
    v_cvt_pk_bf16_f32 v153, v192, v193
    v_cvt_pk_f16_f32 v142, v178, v179
    v_mfma_f32_16x16x32_bf16 v[130:133], a[104:107], v[186:189], v[130:133]
    s_barrier
    v_pk_mul_f16 v191, v142, v142
    v_cvt_pk_f16_f32 v143, v180, v181
    v_mfma_f32_16x16x32_bf16 v[130:133], a[108:111], v[162:165], v[130:133]
    s_nop 0
    v_pk_mul_f16 v193, v143, v143
    v_mul_f32 v202, v255, v202
    v_mfma_f32_16x16x32_bf16 v[130:133], a[112:115], v[134:137], v[130:133]
    s_nop 0
    v_mul_f32 v203, v255, v203
    v_cvt_pk_bf16_f32 v254, v202, v203
    v_mfma_f32_16x16x32_bf16 v[130:133], a[116:119], v[154:157], v[130:133]
    s_nop 0
    v_mul_f32 v204, v255, v204
    v_mul_f32 v205, v255, v205
    v_mfma_f32_16x16x32_bf16 v[178:181], a[120:123], v[146:149], 0
    v_cvt_pk_bf16_f32 v255, v204, v205
    v_xor_b32 v0, 65536, v0
    v_mfma_f32_16x16x32_bf16 v[178:181], a[124:127], v[138:141], v[178:181]
    v_xor_b32 v1, 65536, v1
    v_cvt_pk_f16_f32 v144, v130, v131
    v_mfma_f32_16x16x32_bf16 v[178:181], a[128:131], v[186:189], v[178:181]
    v_pk_fma_f16 v191, v144, v144, v191
    v_cvt_pk_f16_f32 v145, v132, v133
    v_mfma_f32_16x16x32_bf16 v[178:181], a[132:135], v[162:165], v[178:181]
    v_pk_fma_f16 v193, v145, v145, v193
    v_mfma_f32_16x16x32_bf16 v[178:181], a[136:139], v[134:137], v[178:181]
    v_mfma_f32_16x16x32_bf16 v[178:181], a[140:143], v[154:157], v[178:181]
    v_mfma_f32_16x16x32_bf16 v[202:205], a[0:3], v[146:149], 0
    v_mfma_f32_16x16x32_bf16 v[202:205], a[4:7], v[138:141], v[202:205]
    buffer_load_dwordx4 v10, s[8:11], 0 offen nt lds
    s_add_u32 m0, s28, 4096
    v_mfma_f32_16x16x32_bf16 v[202:205], a[8:11], v[186:189], v[202:205]
    v_mfma_f32_16x16x32_bf16 v[202:205], a[12:15], v[162:165], v[202:205]
    v_mfma_f32_16x16x32_bf16 v[202:205], a[16:19], v[134:137], v[202:205]
    v_mfma_f32_16x16x32_bf16 v[202:205], a[20:23], v[154:157], v[202:205]
    v_cvt_pk_f16_f32 v124, v178, v179
    v_pk_fma_f16 v191, v124, v124, v191
    v_mfma_f32_16x16x32_bf16 v[130:133], a[24:27], v[146:149], 0
    buffer_load_dwordx4 v11, s[8:11], 0 offen nt lds
    v_cvt_pk_f16_f32 v125, v180, v181
    v_mfma_f32_16x16x32_bf16 v[130:133], a[28:31], v[138:141], v[130:133]
    s_add_u32 m0, s28, 8192
    v_pk_fma_f16 v193, v125, v125, v193
    v_cvt_pk_f16_f32 v178, v202, v203
    v_mfma_f32_16x16x32_bf16 v[130:133], a[32:35], v[186:189], v[130:133]
    v_pk_mul_f16 v190, v178, v178
    v_cvt_pk_f16_f32 v179, v204, v205
    v_mfma_f32_16x16x32_bf16 v[130:133], a[36:39], v[162:165], v[130:133]
    v_pk_mul_f16 v192, v179, v179
    v_mfma_f32_16x16x32_bf16 v[130:133], a[40:43], v[134:137], v[130:133]
    v_mfma_f32_16x16x32_bf16 v[130:133], a[44:47], v[154:157], v[130:133]
    buffer_load_dwordx4 v12, s[8:11], 0 offen nt lds
    s_add_u32 m0, s28, 12288
    v_mfma_f32_16x16x32_bf16 v[202:205], a[48:51], v[146:149], 0
    s_xor_b32 s28, s28, 65536
    v_mfma_f32_16x16x32_bf16 v[202:205], a[52:55], v[138:141], v[202:205]
    ds_read_b128 v[166:169], v5 offset:0
    ds_read_b128 v[126:129], v5 offset:16
    v_mfma_f32_16x16x32_bf16 v[202:205], a[56:59], v[186:189], v[202:205]
    ds_read_b128 v[210:213], v5 offset:48
    ds_read_b32 v200, v6 offset:192
    v_mfma_f32_16x16x32_bf16 v[202:205], a[60:63], v[162:165], v[202:205]
    v_cvt_pk_f16_f32 v180, v130, v131
    v_pk_fma_f16 v190, v180, v180, v190
    v_mfma_f32_16x16x32_bf16 v[202:205], a[64:67], v[134:137], v[202:205]
    buffer_load_dwordx4 v13, s[8:11], 0 offen nt lds
    v_cvt_pk_f16_f32 v181, v132, v133
    v_mfma_f32_16x16x32_bf16 v[202:205], a[68:71], v[154:157], v[202:205]
    s_mov_b32 m0, s29
    v_pk_fma_f16 v192, v181, v181, v192
    v_add_u32 v5, 336, v5
    v_mfma_f32_16x16x32_bf16 v[130:133], v[146:149], a[144:147], 0
    s_xor_b32 s29, s29, s30
    s_add_u32 s19, s19, s20
    s_add_u32 s23, s23, s21
    v_mfma_f32_16x16x32_bf16 v[130:133], v[138:141], a[148:151], v[130:133]
    s_cmp_ge_u32 s19, 72
    v_cvt_pk_f16_f32 v122, v202, v203
    v_pk_fma_f16 v190, v122, v122, v190
    v_mfma_f32_16x16x32_bf16 v[130:133], v[186:189], a[152:155], v[130:133]
    s_cselect_b32 s34, 72, 0
    v_cvt_pk_f16_f32 v123, v204, v205
    v_pk_fma_f16 v192, v123, v123, v192
    v_mfma_f32_16x16x32_bf16 v[130:133], v[162:165], a[156:159], v[130:133]
    s_waitcnt lgkmcnt(2)
    buffer_store_dwordx2 v[198:199], v19, s[12:15], 0 offen nt
    s_cselect_b32 s35, s22, 0
    s_sub_u32 s19, s19, s34
    v_mfma_f32_16x16x32_f16 v[202:205], v[40:43], v[190:193], 0
    s_add_u32 s23, s23, s35
    s_add_u32 s18, s18, 1
    s_cmp_lt_u32 s18, s45
    v_mfma_f32_16x16x32_f16 v[214:217], v[166:169], v[158:161], v[24:27]
    s_waitcnt lgkmcnt(0)
    v_mfma_f32_16x16x32_f16 v[214:217], v[126:129], v[170:173], v[214:217]
    v_mfma_f32_16x16x32_f16 v[214:217], v[210:213], v[218:221], v[214:217]
    v_mfma_f32_16x16x32_f16 v[190:193], v[166:169], v[206:209], v[22:25]
    v_rsq_f32 v204, v202
    v_mfma_f32_16x16x32_f16 v[190:193], v[126:129], v[118:121], v[190:193]
    v_rsq_f32 v205, v203
    v_mfma_f32_16x16x32_f16 v[190:193], v[210:213], v[194:197], v[190:193]
    v_mul_f32 v204, s31, v204
    v_cvt_pk_f16_f32 v204, v204, v205
    v_mfma_f32_16x16x32_bf16 v[130:133], v[134:137], a[160:163], v[130:133]
    v_pk_mul_f16 v142, v142, v204 op_sel:[0,1] op_sel_hi:[1,1]
    v_pk_mul_f16 v143, v143, v204 op_sel:[0,1] op_sel_hi:[1,1]
    v_mfma_f32_16x16x32_bf16 v[130:133], v[154:157], a[164:167], v[130:133]
    v_pk_mul_f16 v144, v144, v204 op_sel:[0,1] op_sel_hi:[1,1]
    v_pk_mul_f16 v145, v145, v204 op_sel:[0,1] op_sel_hi:[1,1]
    v_mfma_f32_16x16x32_bf16 v[222:225], v[146:149], a[168:171], 0
    v_mov_b32_dpp v200, v191 quad_perm:[0,1,2,3] row_mask:0x1 bank_mask:0xf
    v_mov_b32_dpp v200, v215 quad_perm:[0,1,2,3] row_mask:0x2 bank_mask:0xf
    v_mfma_f32_16x16x32_bf16 v[222:225], v[138:141], a[172:175], v[222:225]
    v_pk_mul_f16 v124, v124, v204 op_sel:[0,1] op_sel_hi:[1,1]
    v_pk_mul_f16 v125, v125, v204 op_sel:[0,1] op_sel_hi:[1,1]
    v_mfma_f32_16x16x32_bf16 v[222:225], v[186:189], a[176:179], v[222:225]
    v_cvt_pk_bf16_f32 v130, v130, v131
    v_cvt_pk_bf16_f32 v131, v132, v133
    v_mfma_f32_16x16x32_bf16 v[222:225], v[162:165], a[180:183], v[222:225]
    v_pk_mul_f16 v178, v178, v204 op_sel:[0,0] op_sel_hi:[1,0]
    v_pk_mul_f16 v179, v179, v204 op_sel:[0,0] op_sel_hi:[1,0]
    v_mfma_f32_16x16x32_f16 v[226:229], v[118:121], v[206:209], v[46:49]
    v_pk_mul_f16 v180, v180, v204 op_sel:[0,0] op_sel_hi:[1,0]
    v_pk_mul_f16 v181, v181, v204 op_sel:[0,0] op_sel_hi:[1,0]
    v_mfma_f32_16x16x32_f16 v[230:233], v[170:173], v[206:209], v[50:53]
    v_pk_mul_f16 v122, v122, v204 op_sel:[0,0] op_sel_hi:[1,0]
    v_pk_mul_f16 v123, v123, v204 op_sel:[0,0] op_sel_hi:[1,0]
    v_mfma_f32_16x16x32_f16 v[234:237], v[142:145], v[206:209], v[54:57]
    v_min3_u32 v44, v44, v202, v203
    v_exp_f32 v214, v214
    v_mfma_f32_16x16x16_f16 v[226:229], v[196:197], v[194:195], v[226:229]
    v_max3_u32 v45, v45, v202, v203
    v_exp_f32 v190, v190
    v_mfma_f32_16x16x16_f16 v[230:233], v[220:221], v[194:195], v[230:233]
    v_cvt_pk_bf16_f32 v39, v190, 0
    v_mfma_f32_16x16x16_f16 v[234:237], v[124:125], v[194:195], v[234:237]
    buffer_store_dwordx4 v[150:153], v15, s[12:15], 0 offen nt
    v_mfma_f32_16x16x32_bf16 v[222:225], v[134:137], a[184:187], v[222:225]
    v_mfma_f32_16x16x32_bf16 v[222:225], v[154:157], a[188:191], v[222:225]
    ds_read_b128 v[206:209], v2 offset:0
    v_mfma_f32_16x16x32_bf16 v[150:153], v[146:149], a[192:195], 0
    ds_read_b128 v[146:149], v2 offset:1024
    v_mfma_f32_16x16x32_bf16 v[150:153], v[138:141], a[196:199], v[150:153]
    ds_read_b128 v[138:141], v2 offset:2048
    v_mfma_f32_16x16x32_bf16 v[150:153], v[186:189], a[200:203], v[150:153]
    ds_read_b128 v[186:189], v2 offset:3072
    v_mfma_f32_16x16x32_bf16 v[150:153], v[162:165], a[204:207], v[150:153]
    ds_read_b128 v[162:165], v2 offset:4096
    v_cvt_pk_bf16_f32 v222, v222, v223
    v_mfma_f32_16x16x32_bf16 v[150:153], v[134:137], a[208:211], v[150:153]
    ds_read_b128 v[134:137], v2 offset:5120
    v_cvt_pk_bf16_f32 v223, v224, v225
    v_mfma_f32_16x16x32_bf16 v[150:153], v[154:157], a[212:215], v[150:153]
    ds_read2_b32 v[132:133], v6 offset0:0 offset1:0
    ds_read2_b32 v[224:225], v6 offset0:16 offset1:16
    v_mfma_f32_16x16x32_f16 v[154:157], v[166:169], v[178:181], v[26:29]
    ds_read2_b32 v[168:169], v6 offset0:32 offset1:32
    v_add_u32 v6, 272, v6
    v_mfma_f32_16x16x32_f16 v[154:157], v[126:129], v[142:145], v[154:157]
    s_waitcnt lgkmcnt(8)
    v_exp_f32 v226, v226
    v_mfma_f32_16x16x32_f16 v[154:157], v[210:213], v[122:125], v[154:157]
    s_waitcnt lgkmcnt(7)
    v_cvt_pk_bf16_f32 v166, v150, v151
    v_cvt_pk_bf16_f32 v167, v152, v153
    v_mfma_f32_16x16x32_bf16 v[150:153], a[216:219], v[206:209], 0
    s_waitcnt lgkmcnt(6)
    v_exp_f32 v227, v227
    v_mfma_f32_16x16x32_bf16 v[150:153], a[220:223], v[146:149], v[150:153]
    s_waitcnt lgkmcnt(5)
    v_exp_f32 v154, v154
    v_mfma_f32_16x16x32_bf16 v[150:153], a[224:227], v[138:141], v[150:153]
    s_waitcnt lgkmcnt(4)
    v_mov_b32_dpp v200, v155 quad_perm:[0,1,2,3] row_mask:0x4 bank_mask:0xf
    v_cvt_pk_bf16_f32 v126, v226, v227
    v_mfma_f32_16x16x32_bf16 v[150:153], a[228:231], v[186:189], v[150:153]
    s_waitcnt lgkmcnt(3)
    v_exp_f32 v200, v200
    v_mfma_f32_16x16x32_bf16 v[150:153], a[232:235], v[162:165], v[150:153]
    s_waitcnt lgkmcnt(1)
    v_exp_f32 v228, v228
    v_mfma_f32_16x16x32_bf16 v[150:153], a[236:239], v[134:137], v[150:153]
    s_waitcnt lgkmcnt(0)
    buffer_store_dwordx2 v[254:255], v18, s[12:15], 0 offen nt
    v_exp_f32 v229, v229
    v_mfma_f32_16x16x32_bf16 v[190:193], a[240:243], v[206:209], 0
    v_cvt_pk_bf16_f32 v200, v200, v200
    v_cvt_pk_bf16_f32 v127, v228, v229
    v_mfma_f32_16x16x32_bf16 v[190:193], a[244:247], v[146:149], v[190:193]
    ds_write_b16 v8, v200
    v_mfma_f32_16x16x32_bf16 v[190:193], a[248:251], v[138:141], v[190:193]
    v_exp_f32 v230, v230
    v_mfma_f32_16x16x32_bf16 v[190:193], a[252:255], v[186:189], v[190:193]
    ds_read_b128 v[198:201], v2 offset:6144
    ds_read_b128 v[210:213], v9
    v_mfma_f32_16x16x32_bf16 v[190:193], v[82:85], v[162:165], v[190:193]
    ds_read_b128 v[226:229], v2 offset:7168
    ds_read_b128 v[238:241], v9 offset:64
    v_mfma_f32_16x16x32_bf16 v[190:193], v[86:89], v[134:137], v[190:193]
    v_exp_f32 v231, v231
    v_mfma_f32_16x16x32_bf16 v[202:205], v[90:93], v[206:209], 0
    ds_read_b128 v[206:209], v2 offset:8192
    ds_read_b128 v[242:245], v2 offset:9216
    v_mfma_f32_16x16x32_bf16 v[202:205], v[94:97], v[146:149], v[202:205]
    v_cvt_pk_bf16_f32 v128, v230, v231
    v_fma_f32 v254, v150, v150, s33
    v_mfma_f32_16x16x32_bf16 v[202:205], v[98:101], v[138:141], v[202:205]
    ds_read_b128 v[146:149], v2 offset:10240
    ds_read_b128 v[138:141], v2 offset:11264
    v_mfma_f32_16x16x32_bf16 v[202:205], v[102:105], v[186:189], v[202:205]
    v_exp_f32 v232, v232
    v_mfma_f32_16x16x32_bf16 v[202:205], v[106:109], v[162:165], v[202:205]
    v_exp_f32 v233, v233
    v_mfma_f32_16x16x32_bf16 v[202:205], v[110:113], v[134:137], v[202:205]
    s_waitcnt lgkmcnt(6)
    v_cvt_pk_bf16_f32 v129, v232, v233
    v_fmac_f32 v254, v151, v151
    v_mfma_f32_16x16x32_bf16 v[186:189], v[210:213], v[28:31], 0
    s_waitcnt lgkmcnt(4)
    v_exp_f32 v234, v234
    v_mfma_f32_16x16x32_bf16 v[186:189], v[238:241], v[28:31], v[186:189]
    v_exp_f32 v235, v235
    v_mfma_f32_16x16x32_f16 v[134:137], v[118:121], v[158:161], v[58:61]
    s_waitcnt lgkmcnt(2)
    v_cvt_pk_bf16_f32 v36, v234, v235
    v_fmac_f32 v254, v152, v152
    v_mfma_f32_16x16x32_f16 v[162:165], v[170:173], v[158:161], v[62:65]
    v_exp_f32 v236, v236
    v_mfma_f32_16x16x32_f16 v[230:233], v[142:145], v[158:161], v[66:69]
    s_waitcnt lgkmcnt(0)
    buffer_load_dwordx4 v14, s[8:11], 0 offen nt lds
    v_rcp_f32 v186, v186
    v_mfma_f32_16x16x16_f16 v[134:137], v[196:197], v[218:219], v[134:137]
    v_exp_f32 v237, v237
    v_fmac_f32 v254, v153, v153
    v_mfma_f32_16x16x16_f16 v[162:165], v[220:221], v[218:219], v[162:165]
    v_cvt_pk_bf16_f32 v37, v236, v237
    v_fmac_f32 v254, v190, v190
    v_fmac_f32 v254, v191, v191
    v_mfma_f32_16x16x16_f16 v[230:233], v[124:125], v[218:219], v[230:233]
    v_fmac_f32 v254, v192, v192
    v_exp_f32 v134, v134
    v_fmac_f32 v254, v193, v193
    v_mfma_f32_16x16x32_bf16 v[158:161], v[210:213], v[174:177], 0
    v_exp_f32 v135, v135
    v_mfma_f32_16x16x32_bf16 v[158:161], v[238:241], v[130:133], v[158:161]
    v_cvt_pk_bf16_f32 v134, v134, v135
    v_fmac_f32 v254, v202, v202
    v_mfma_f32_16x16x32_bf16 v[234:237], v[210:213], v[182:185], 0
    v_exp_f32 v136, v136
    v_mfma_f32_16x16x32_bf16 v[234:237], v[238:241], v[222:225], v[234:237]
    v_exp_f32 v137, v137
    v_mfma_f32_16x16x32_bf16 v[246:249], v[210:213], v[114:117], 0
    v_cvt_pk_bf16_f32 v135, v136, v137
    v_mul_f32 v158, v158, v186
    v_mfma_f32_16x16x32_bf16 v[246:249], v[238:241], v[166:169], v[246:249]
    v_exp_f32 v162, v162
    v_mfma_f32_16x16x32_bf16 v[210:213], v[28:31], v[36:39], 0
    v_exp_f32 v163, v163
    v_mfma_f32_16x16x32_bf16 v[210:213], v[28:31], v[126:129], v[210:213]
    v_cvt_pk_bf16_f32 v136, v162, v163
    v_mul_f32_dpp v158, v234, v186 quad_perm:[0,1,2,3] row_mask:0x2 bank_mask:0xf
    v_mfma_f32_16x16x32_bf16 v[234:237], v[130:133], v[36:39], 0
    v_exp_f32 v164, v164
    v_mfma_f32_16x16x32_bf16 v[234:237], v[174:177], v[126:129], v[234:237]
    v_exp_f32 v165, v165
    v_mfma_f32_16x16x32_bf16 v[238:241], v[222:225], v[36:39], 0
    v_cvt_pk_bf16_f32 v137, v164, v165
    v_mul_f32_dpp v158, v246, v186 quad_perm:[0,1,2,3] row_mask:0x4 bank_mask:0xf
    v_mfma_f32_16x16x32_bf16 v[238:241], v[182:185], v[126:129], v[238:241]
    v_exp_f32 v230, v230
    v_mfma_f32_16x16x32_bf16 v[186:189], v[166:169], v[36:39], 0
    v_exp_f32 v231, v231
    v_mfma_f32_16x16x32_bf16 v[186:189], v[114:117], v[126:129], v[186:189]
    v_cvt_pk_bf16_f32 v36, v230, v231
    v_cvt_pk_bf16_f32 v39, v214, 0
    v_mfma_f32_16x16x32_f16 v[162:165], v[118:121], v[178:181], v[70:73]
    v_exp_f32 v232, v232
    v_mfma_f32_16x16x32_f16 v[118:121], v[170:173], v[178:181], v[74:77]
    v_exp_f32 v233, v233
    v_mfma_f32_16x16x32_f16 v[170:173], v[142:145], v[178:181], v[78:81]
    v_cvt_pk_bf16_f32 v37, v232, v233
    v_cvt_pk_bf16_f32 v158, v158, v158
    v_fmac_f32 v254, v203, v203
    v_mfma_f32_16x16x16_f16 v[162:165], v[196:197], v[122:123], v[162:165]
    v_rcp_f32 v210, v210
    v_fmac_f32 v254, v204, v204
    v_mfma_f32_16x16x16_f16 v[118:121], v[220:221], v[122:123], v[118:121]
    v_mul_f32 v234, v210, v234
    v_mul_f32 v235, v210, v235
    v_cvt_pk_bf16_f32 v178, v234, v235
    v_mfma_f32_16x16x16_f16 v[170:173], v[124:125], v[122:123], v[170:173]
    v_mul_f32 v236, v210, v236
    v_exp_f32 v162, v162
    v_mul_f32 v237, v210, v237
    v_mfma_f32_16x16x32_bf16 v[194:197], v[28:31], v[36:39], 0
    ds_write_b16 v7, v158
    v_mfma_f32_16x16x32_bf16 v[194:197], v[28:31], v[134:137], v[194:197]
    v_exp_f32 v163, v163
    v_mfma_f32_16x16x32_bf16 v[122:125], v[130:133], v[36:39], 0
    v_cvt_pk_bf16_f32 v162, v162, v163
    v_cvt_pk_bf16_f32 v179, v236, v237
    v_mfma_f32_16x16x32_bf16 v[122:125], v[174:177], v[134:137], v[122:125]
    v_exp_f32 v164, v164
    v_mfma_f32_16x16x32_bf16 v[126:129], v[222:225], v[36:39], 0
    v_exp_f32 v165, v165
    v_mfma_f32_16x16x32_bf16 v[126:129], v[182:185], v[134:137], v[126:129]
    v_cvt_pk_bf16_f32 v163, v164, v165
    v_mul_f32 v238, v210, v238
    v_mfma_f32_16x16x32_bf16 v[218:221], v[166:169], v[36:39], 0
    v_exp_f32 v118, v118
    v_mfma_f32_16x16x32_bf16 v[218:221], v[114:117], v[134:137], v[218:221]
    v_exp_f32 v119, v119
    v_mfma_f32_16x16x32_bf16 v[142:145], a[216:219], v[198:201], 0
    v_cvt_pk_bf16_f32 v164, v118, v119
    v_cvt_pk_bf16_f32 v39, v154, 0
    v_mfma_f32_16x16x32_bf16 v[142:145], a[220:223], v[226:229], v[142:145]
    v_exp_f32 v120, v120
    v_mfma_f32_16x16x32_bf16 v[142:145], a[224:227], v[206:209], v[142:145]
    v_exp_f32 v121, v121
    v_mfma_f32_16x16x32_bf16 v[142:145], a[228:231], v[242:245], v[142:145]
    v_cvt_pk_bf16_f32 v165, v120, v121
    v_mul_f32 v239, v210, v239
    v_mfma_f32_16x16x32_bf16 v[142:145], a[232:235], v[146:149], v[142:145]
    v_exp_f32 v170, v170
    v_mfma_f32_16x16x32_bf16 v[142:145], a[236:239], v[138:141], v[142:145]
    v_exp_f32 v171, v171
    v_mfma_f32_16x16x32_bf16 v[158:161], a[240:243], v[198:201], 0
    v_cvt_pk_bf16_f32 v36, v170, v171
    v_cvt_pk_bf16_f32 v180, v238, v239
    v_mfma_f32_16x16x32_bf16 v[158:161], a[244:247], v[226:229], v[158:161]
    v_exp_f32 v172, v172
    v_mfma_f32_16x16x32_bf16 v[158:161], a[248:251], v[206:209], v[158:161]
    v_exp_f32 v173, v173
    v_mfma_f32_16x16x32_bf16 v[158:161], a[252:255], v[242:245], v[158:161]
    ds_read_b128 v[118:121], v2 offset:12288
    v_cvt_pk_bf16_f32 v37, v172, v173
    v_mfma_f32_16x16x32_bf16 v[158:161], v[82:85], v[146:149], v[158:161]
    ds_read_b128 v[134:137], v2 offset:13312
    v_mul_f32 v240, v210, v240
    v_mfma_f32_16x16x32_bf16 v[170:173], v[28:31], v[36:39], 0
    v_mul_f32 v241, v210, v241
    v_cvt_pk_bf16_f32 v181, v240, v241
    v_mfma_f32_16x16x32_bf16 v[170:173], v[28:31], v[162:165], v[170:173]
    ds_write_b128 v3, v[178:181] offset:0
    v_mfma_f32_16x16x32_bf16 v[154:157], v[130:133], v[36:39], 0
    v_mul_f32 v186, v210, v186
    v_mul_f32 v187, v210, v187
    v_mfma_f32_16x16x32_bf16 v[154:157], v[174:177], v[162:165], v[154:157]
    v_cvt_pk_bf16_f32 v186, v186, v187
    v_mul_f32 v188, v210, v188
    v_mfma_f32_16x16x32_bf16 v[130:133], v[222:225], v[36:39], 0
    v_mul_f32 v189, v210, v189
    v_cvt_pk_bf16_f32 v187, v188, v189
    v_mfma_f32_16x16x32_bf16 v[130:133], v[182:185], v[162:165], v[130:133]
    s_waitcnt lgkmcnt(2)
    ds_write_b64 v4, v[186:187] offset:4096
    v_mfma_f32_16x16x32_bf16 v[174:177], v[166:169], v[36:39], 0
    s_waitcnt lgkmcnt(2)
    v_fma_f32 v255, v142, v142, s33
    v_fmac_f32 v255, v143, v143
    v_mfma_f32_16x16x32_bf16 v[174:177], v[114:117], v[162:165], v[174:177]
    v_fmac_f32 v255, v144, v144
    v_fmac_f32 v255, v145, v145
    v_mfma_f32_16x16x32_bf16 v[158:161], v[86:89], v[138:141], v[158:161]
    ds_read_b128 v[114:117], v2 offset:14336
    v_fmac_f32 v254, v205, v205
    v_mfma_f32_16x16x32_bf16 v[178:181], v[90:93], v[198:201], 0
    ds_read_b128 v[166:169], v2 offset:15360
    v_add_u32 v7, 16, v7
    v_mfma_f32_16x16x32_bf16 v[178:181], v[94:97], v[226:229], v[178:181]
    ds_read_b128 v[162:165], v2 offset:16384
    v_mfma_f32_16x16x32_bf16 v[178:181], v[98:101], v[206:209], v[178:181]
    ds_read_b128 v[206:209], v2 offset:17408
    v_fmac_f32 v255, v158, v158
    v_mfma_f32_16x16x32_bf16 v[178:181], v[102:105], v[242:245], v[178:181]
    v_fmac_f32 v255, v159, v159
    v_fmac_f32 v255, v160, v160
    v_mfma_f32_16x16x32_bf16 v[178:181], v[106:109], v[146:149], v[178:181]
    v_fmac_f32 v255, v161, v161
    v_xor_b32 v2, 65536, v2
    v_mfma_f32_16x16x32_bf16 v[178:181], v[110:113], v[138:141], v[178:181]
    v_rcp_f32 v170, v170
    v_mfma_f32_16x16x32_bf16 v[146:149], a[216:219], v[118:121], 0
    v_mul_f32 v154, v170, v154
    v_mul_f32 v155, v170, v155
    v_mfma_f32_16x16x32_bf16 v[146:149], a[220:223], v[134:137], v[146:149]
    s_waitcnt lgkmcnt(3)
    ds_read_b128 v[182:185], v0 offset:20480
    v_cvt_pk_bf16_f32 v154, v154, v155
    v_mfma_f32_16x16x32_bf16 v[146:149], a[224:227], v[114:117], v[146:149]
    s_waitcnt lgkmcnt(3)
    ds_read_b128 v[198:201], v1 offset:20480
    v_fmac_f32 v255, v178, v178
    v_mfma_f32_16x16x32_bf16 v[146:149], a[228:231], v[166:169], v[146:149]
    s_waitcnt lgkmcnt(3)
    ds_read_b128 v[210:213], v0 offset:20608
    v_fmac_f32 v255, v179, v179
    v_mfma_f32_16x16x32_bf16 v[146:149], a[232:235], v[162:165], v[146:149]
    s_waitcnt lgkmcnt(3)
    ds_read_b128 v[222:225], v1 offset:20608
    v_fmac_f32 v255, v180, v180
    v_mfma_f32_16x16x32_bf16 v[146:149], a[236:239], v[206:209], v[146:149]
    ds_read_b128 v[226:229], v0 offset:20736
    v_fmac_f32 v255, v181, v181
    v_mfma_f32_16x16x32_bf16 v[138:141], a[240:243], v[118:121], 0
    ds_read_b128 v[242:245], v1 offset:20736
    v_cvt_pk_bf16_f32 v254, v254, v255
    v_mfma_f32_16x16x32_bf16 v[138:141], a[244:247], v[134:137], v[138:141]
    v_mul_f32 v156, v170, v156
    v_mul_f32 v157, v170, v157
    v_mfma_f32_16x16x32_bf16 v[138:141], a[248:251], v[114:117], v[138:141]
    v_fma_f32 v255, v146, v146, s33
    v_fmac_f32 v255, v147, v147
    v_mfma_f32_16x16x32_bf16 v[138:141], a[252:255], v[166:169], v[138:141]
    s_waitcnt lgkmcnt(5)
    v_fmac_f32 v255, v148, v148
    v_fmac_f32 v255, v149, v149
    v_mfma_f32_16x16x32_bf16 v[138:141], v[82:85], v[162:165], v[138:141]
    s_waitcnt lgkmcnt(4)
    v_cvt_pk_bf16_f32 v155, v156, v157
    v_mul_f32 v130, v170, v130
    v_mfma_f32_16x16x32_bf16 v[138:141], v[86:89], v[206:209], v[138:141]
    s_waitcnt lgkmcnt(3)
    v_mul_f32 v131, v170, v131
    v_cvt_pk_bf16_f32 v156, v130, v131
    v_mfma_f32_16x16x32_bf16 v[186:189], v[90:93], v[118:121], 0
    s_waitcnt lgkmcnt(2)
    v_mul_f32 v132, v170, v132
    v_mul_f32 v133, v170, v133
    v_mfma_f32_16x16x32_bf16 v[186:189], v[94:97], v[134:137], v[186:189]
    s_waitcnt lgkmcnt(1)
    v_fmac_f32 v255, v138, v138
    v_fmac_f32 v255, v139, v139
    v_mfma_f32_16x16x32_bf16 v[186:189], v[98:101], v[114:117], v[186:189]
    s_waitcnt lgkmcnt(0)
    v_fmac_f32 v255, v140, v140
    v_fmac_f32 v255, v141, v141
    v_mfma_f32_16x16x32_bf16 v[186:189], v[102:105], v[166:169], v[186:189]
    v_cvt_pk_bf16_f32 v157, v132, v133
    v_mul_f32 v174, v170, v174
    v_mfma_f32_16x16x32_bf16 v[186:189], v[106:109], v[162:165], v[186:189]
    ds_write_b128 v3, v[154:157] offset:12288
    v_mfma_f32_16x16x32_bf16 v[186:189], v[110:113], v[206:209], v[186:189]
    v_mul_f32 v175, v170, v175
    v_cvt_pk_bf16_f32 v174, v174, v175
    v_mfma_f32_16x16x32_bf16 v[118:121], a[72:75], v[182:185], 0
    v_mul_f32 v176, v170, v176
    v_mul_f32 v177, v170, v177
    v_mfma_f32_16x16x32_bf16 v[118:121], a[76:79], v[198:201], v[118:121]
    v_rcp_f32 v194, v194
    v_mfma_f32_16x16x32_bf16 v[118:121], a[80:83], v[210:213], v[118:121]
    v_fmac_f32 v255, v186, v186
    v_fmac_f32 v255, v187, v187
    v_mfma_f32_16x16x32_bf16 v[118:121], a[84:87], v[222:225], v[118:121]
    v_fmac_f32 v255, v188, v188
    v_fmac_f32 v255, v189, v189
    v_mfma_f32_16x16x32_bf16 v[118:121], a[88:91], v[226:229], v[118:121]
    v_cvt_pk_bf16_f32 v255, v255, v255
    v_cvt_pk_bf16_f32 v175, v176, v177
    v_mfma_f32_16x16x32_bf16 v[118:121], a[92:95], v[242:245], v[118:121]
    ds_write_b64 v4, v[174:175] offset:16384
    v_mfma_f32_16x16x32_bf16 v[206:209], a[96:99], v[182:185], 0
    v_mul_f32 v122, v194, v122
    v_mul_f32 v123, v194, v123
    v_mfma_f32_16x16x32_bf16 v[206:209], a[100:103], v[198:201], v[206:209]
    ds_write_b64 v4, v[254:255] offset:18432
    v_mfma_f32_16x16x32_bf16 v[206:209], a[104:107], v[210:213], v[206:209]
    v_cvt_pk_bf16_f32 v134, v122, v123
    v_cvt_pk_f16_f32 v118, v118, v119
    v_mfma_f32_16x16x32_bf16 v[206:209], a[108:111], v[222:225], v[206:209]
    v_pk_mul_f16 v163, v118, v118
    v_cvt_pk_f16_f32 v119, v120, v121
    v_mfma_f32_16x16x32_bf16 v[206:209], a[112:115], v[226:229], v[206:209]
    v_pk_mul_f16 v165, v119, v119
    v_mul_f32 v124, v194, v124
    v_mfma_f32_16x16x32_bf16 v[206:209], a[116:119], v[242:245], v[206:209]
    v_mul_f32 v125, v194, v125
    v_cvt_pk_bf16_f32 v135, v124, v125
    v_mfma_f32_16x16x32_bf16 v[122:125], a[120:123], v[182:185], 0
    v_mul_f32 v126, v194, v126
    v_mul_f32 v127, v194, v127
    v_mfma_f32_16x16x32_bf16 v[122:125], a[124:127], v[198:201], v[122:125]
    v_cvt_pk_bf16_f32 v136, v126, v127
    v_mul_f32 v128, v194, v128
    v_mfma_f32_16x16x32_bf16 v[122:125], a[128:131], v[210:213], v[122:125]
    v_cvt_pk_f16_f32 v120, v206, v207
    v_pk_fma_f16 v163, v120, v120, v163
    v_mfma_f32_16x16x32_bf16 v[122:125], a[132:135], v[222:225], v[122:125]
    v_cvt_pk_f16_f32 v121, v208, v209
    v_pk_fma_f16 v165, v121, v121, v165
    v_mfma_f32_16x16x32_bf16 v[122:125], a[136:139], v[226:229], v[122:125]
    v_mul_f32 v129, v194, v129
    v_cvt_pk_bf16_f32 v137, v128, v129
    v_mfma_f32_16x16x32_bf16 v[122:125], a[140:143], v[242:245], v[122:125]
    ds_write_b128 v3, v[134:137] offset:6144
    v_mfma_f32_16x16x32_bf16 v[206:209], a[0:3], v[182:185], 0
    v_mul_f32 v218, v194, v218
    v_mul_f32 v219, v194, v219
    v_mfma_f32_16x16x32_bf16 v[206:209], a[4:7], v[198:201], v[206:209]
    v_cvt_pk_bf16_f32 v254, v218, v219
    v_mul_f32 v220, v194, v220
    v_mfma_f32_16x16x32_bf16 v[206:209], a[8:11], v[210:213], v[206:209]
    v_cvt_pk_f16_f32 v196, v122, v123
    v_pk_fma_f16 v163, v196, v196, v163
    v_mfma_f32_16x16x32_bf16 v[206:209], a[12:15], v[222:225], v[206:209]
    v_cvt_pk_f16_f32 v197, v124, v125
    v_pk_fma_f16 v165, v197, v197, v165
    v_mfma_f32_16x16x32_bf16 v[206:209], a[16:19], v[226:229], v[206:209]
    v_mul_f32 v221, v194, v221
    v_cvt_pk_bf16_f32 v255, v220, v221
    v_mfma_f32_16x16x32_bf16 v[206:209], a[20:23], v[242:245], v[206:209]
    ds_write_b64 v4, v[254:255] offset:10240
    v_mfma_f32_16x16x32_bf16 v[174:177], a[24:27], v[182:185], 0
    v_xor_b32 v3, 65536, v3
    v_xor_b32 v4, 65536, v4
    v_mfma_f32_16x16x32_bf16 v[174:177], a[28:31], v[198:201], v[174:177]
    v_mfma_f32_16x16x32_bf16 v[174:177], a[32:35], v[210:213], v[174:177]
    v_mfma_f32_16x16x32_bf16 v[174:177], a[36:39], v[222:225], v[174:177]
    v_mfma_f32_16x16x32_bf16 v[174:177], a[40:43], v[226:229], v[174:177]
    v_cvt_pk_f16_f32 v206, v206, v207
    v_mfma_f32_16x16x32_bf16 v[174:177], a[44:47], v[242:245], v[174:177]
    v_mfma_f32_16x16x32_bf16 v[218:221], a[48:51], v[182:185], 0
    s_waitcnt lgkmcnt(0)
    v_mfma_f32_16x16x32_bf16 v[218:221], a[52:55], v[198:201], v[218:221]
    s_barrier
    v_mfma_f32_16x16x32_bf16 v[218:221], a[56:59], v[210:213], v[218:221]
    s_nop 0
    v_mfma_f32_16x16x32_bf16 v[218:221], a[60:63], v[222:225], v[218:221]
    s_nop 0
    v_mfma_f32_16x16x32_bf16 v[218:221], a[64:67], v[226:229], v[218:221]
    s_nop 0
    v_mfma_f32_16x16x32_bf16 v[218:221], a[68:71], v[242:245], v[218:221]
    v_mfma_f32_16x16x32_bf16 v[170:173], v[182:185], a[144:147], 0
    v_mfma_f32_16x16x32_bf16 v[170:173], v[198:201], a[148:151], v[170:173]
    v_mfma_f32_16x16x32_bf16 v[170:173], v[210:213], a[152:155], v[170:173]
    v_mfma_f32_16x16x32_bf16 v[170:173], v[222:225], a[156:159], v[170:173]
    v_mfma_f32_16x16x32_bf16 v[170:173], v[226:229], a[160:163], v[170:173]
    v_mfma_f32_16x16x32_bf16 v[170:173], v[242:245], a[164:167], v[170:173]
    s_cbranch_scc1 L_loop_fast0
    s_branch L_final_fast
.p2align 6
L_loop_fast1:
    v_mfma_f32_16x16x32_bf16 v[234:237], v[182:185], a[168:171], 0
    s_add_u32 s12, s42, s27
    ds_read_b128 v[230:233], v2 offset:18432
    ds_read_b128 v[238:241], v2 offset:19456
    v_mfma_f32_16x16x32_bf16 v[234:237], v[198:201], a[172:175], v[234:237]
    s_addc_u32 s13, s43, 0
    v_pk_mul_f16 v162, v206, v206
    v_cvt_pk_f16_f32 v207, v208, v209
    v_mfma_f32_16x16x32_bf16 v[234:237], v[210:213], a[176:179], v[234:237]
    s_sub_u32 s14, s36, s27
    ds_read_b128 v[134:137], v0 offset:26624
    v_pk_mul_f16 v164, v207, v207
    v_mfma_f32_16x16x32_bf16 v[234:237], v[222:225], a[180:183], v[234:237]
    s_cmp_ge_u32 s18, 2
    ds_read_b128 v[154:157], v1 offset:26624
    v_cvt_pk_f16_f32 v208, v174, v175
    v_mfma_f32_16x16x32_bf16 v[234:237], v[226:229], a[184:187], v[234:237]
    s_cselect_b32 s14, s14, 0
    ds_read_b128 v[130:133], v0 offset:26752
    v_pk_fma_f16 v162, v208, v208, v162
    v_mfma_f32_16x16x32_bf16 v[234:237], v[242:245], a[188:191], v[234:237]
    s_add_u32 s34, s18, 2
    ds_read_b128 v[122:125], v1 offset:26752
    v_cvt_pk_f16_f32 v209, v176, v177
    v_mfma_f32_16x16x32_bf16 v[114:117], v[182:185], a[192:195], 0
    s_add_u32 s8, s40, s23
    ds_read_b128 v[126:129], v0 offset:26880
    v_pk_fma_f16 v164, v209, v209, v164
    v_mfma_f32_16x16x32_bf16 v[114:117], v[198:201], a[196:199], v[114:117]
    s_addc_u32 s9, s41, 0
    ds_read_b128 v[166:169], v1 offset:26880
    v_cvt_pk_f16_f32 v194, v218, v219
    v_mfma_f32_16x16x32_bf16 v[114:117], v[210:213], a[200:203], v[114:117]
    s_waitcnt lgkmcnt(6)
    v_pk_fma_f16 v162, v194, v194, v162
    v_cvt_pk_f16_f32 v195, v220, v221
    v_mfma_f32_16x16x32_bf16 v[198:201], v[32:35], v[230:233], 0
    s_sub_u32 s10, s36, s23
    v_pk_fma_f16 v164, v195, v195, v164
    v_cvt_pk_bf16_f32 v174, v170, v171
    v_mfma_f32_16x16x32_bf16 v[198:201], v[32:35], v[238:241], v[198:201]
    s_waitcnt lgkmcnt(5)
    v_cvt_pk_bf16_f32 v175, v172, v173
    v_cvt_pk_bf16_f32 v182, v234, v235
    v_mfma_f32_16x16x32_f16 v[170:173], v[40:43], v[162:165], 0
    s_cmp_lt_u32 s34, s17
    v_cvt_pk_bf16_f32 v183, v236, v237
    s_cselect_b32 s10, s10, 0
    v_mfma_f32_16x16x32_bf16 v[114:117], v[222:225], a[204:207], v[114:117]
    s_add_u32 m0, s28, 0
    v_mul_f32 v255, 0x3baaaaab, v198
    v_mul_f32 v254, 0x3baaaaab, v199
    v_mfma_f32_16x16x32_bf16 v[114:117], v[226:229], a[208:211], v[114:117]
    s_mov_b32 s27, s26
    v_rsq_f32 v172, v170
    v_mfma_f32_16x16x32_bf16 v[114:117], v[242:245], a[212:215], v[114:117]
    s_mov_b32 s26, s25
    v_rsq_f32 v173, v171
    v_mfma_f32_16x16x32_bf16 v[162:165], a[72:75], v[134:137], 0
    s_waitcnt lgkmcnt(0)
    v_mul_f32 v172, s31, v172
    v_cvt_pk_f16_f32 v172, v172, v173
    v_mfma_f32_16x16x32_bf16 v[162:165], a[76:79], v[154:157], v[162:165]
    s_mov_b32 s25, s24
    v_cvt_pk_bf16_f32 v114, v114, v115
    v_cvt_pk_bf16_f32 v115, v116, v117
    v_mfma_f32_16x16x32_bf16 v[162:165], a[80:83], v[130:133], v[162:165]
    s_mov_b32 s24, s23
    v_pk_mul_f16 v118, v118, v172 op_sel:[0,1] op_sel_hi:[1,1]
    v_pk_mul_f16 v119, v119, v172 op_sel:[0,1] op_sel_hi:[1,1]
    v_mfma_f32_16x16x32_bf16 v[162:165], a[84:87], v[122:125], v[162:165]
    v_pk_mul_f16 v120, v120, v172 op_sel:[0,1] op_sel_hi:[1,1]
    v_pk_mul_f16 v121, v121, v172 op_sel:[0,1] op_sel_hi:[1,1]
    v_mfma_f32_16x16x32_bf16 v[162:165], a[88:91], v[126:129], v[162:165]
    v_pk_mul_f16 v196, v196, v172 op_sel:[0,1] op_sel_hi:[1,1]
    v_pk_mul_f16 v197, v197, v172 op_sel:[0,1] op_sel_hi:[1,1]
    v_mfma_f32_16x16x32_bf16 v[162:165], a[92:95], v[166:169], v[162:165]
    v_pk_mul_f16 v206, v206, v172 op_sel:[0,0] op_sel_hi:[1,0]
    v_pk_mul_f16 v207, v207, v172 op_sel:[0,0] op_sel_hi:[1,0]
    v_mfma_f32_16x16x32_bf16 v[210:213], a[96:99], v[134:137], 0
    v_pk_mul_f16 v208, v208, v172 op_sel:[0,0] op_sel_hi:[1,0]
    v_pk_mul_f16 v209, v209, v172 op_sel:[0,0] op_sel_hi:[1,0]
    v_mfma_f32_16x16x32_bf16 v[210:213], a[100:103], v[154:157], v[210:213]
    v_pk_mul_f16 v194, v194, v172 op_sel:[0,0] op_sel_hi:[1,0]
    v_pk_mul_f16 v195, v195, v172 op_sel:[0,0] op_sel_hi:[1,0]
    v_mfma_f32_16x16x32_bf16 v[210:213], a[104:107], v[130:133], v[210:213]
    v_min3_u32 v44, v44, v170, v171
    v_max3_u32 v45, v45, v170, v171
    v_mfma_f32_16x16x32_bf16 v[210:213], a[108:111], v[122:125], v[210:213]
    v_cvt_pk_f16_f32 v170, v162, v163
    v_pk_mul_f16 v163, v170, v170
    v_mfma_f32_16x16x32_bf16 v[210:213], a[112:115], v[126:129], v[210:213]
    v_cvt_pk_f16_f32 v171, v164, v165
    v_pk_mul_f16 v165, v171, v171
    v_mfma_f32_16x16x32_bf16 v[210:213], a[116:119], v[166:169], v[210:213]
    v_rsq_f32 v255, v255
    v_mfma_f32_16x16x32_bf16 v[214:217], a[120:123], v[134:137], 0
    v_rsq_f32 v254, v254
    v_mfma_f32_16x16x32_bf16 v[214:217], a[124:127], v[154:157], v[214:217]
    v_mul_f32 v142, v254, v142
    v_mul_f32 v143, v254, v143
    v_mfma_f32_16x16x32_bf16 v[214:217], a[128:131], v[130:133], v[214:217]
    v_cvt_pk_bf16_f32 v142, v142, v143
    v_cvt_pk_f16_f32 v172, v210, v211
    v_mfma_f32_16x16x32_bf16 v[214:217], a[132:135], v[122:125], v[214:217]
    v_pk_fma_f16 v163, v172, v172, v163
    v_cvt_pk_f16_f32 v173, v212, v213
    v_mfma_f32_16x16x32_bf16 v[214:217], a[136:139], v[126:129], v[214:217]
    v_pk_fma_f16 v165, v173, v173, v165
    v_mul_f32 v144, v254, v144
    v_mfma_f32_16x16x32_bf16 v[214:217], a[140:143], v[166:169], v[214:217]
    v_mul_f32 v145, v254, v145
    v_cvt_pk_bf16_f32 v143, v144, v145
    v_mfma_f32_16x16x32_bf16 v[210:213], a[0:3], v[134:137], 0
    v_mul_f32 v158, v254, v158
    v_mul_f32 v159, v254, v159
    v_mfma_f32_16x16x32_bf16 v[210:213], a[4:7], v[154:157], v[210:213]
    v_cvt_pk_bf16_f32 v144, v158, v159
    v_mul_f32 v160, v254, v160
    v_mfma_f32_16x16x32_bf16 v[210:213], a[8:11], v[130:133], v[210:213]
    v_cvt_pk_f16_f32 v220, v214, v215
    v_pk_fma_f16 v163, v220, v220, v163
    v_mfma_f32_16x16x32_bf16 v[210:213], a[12:15], v[122:125], v[210:213]
    v_cvt_pk_f16_f32 v221, v216, v217
    v_pk_fma_f16 v165, v221, v221, v165
    v_mfma_f32_16x16x32_bf16 v[210:213], a[16:19], v[126:129], v[210:213]
    v_mul_f32 v161, v254, v161
    v_cvt_pk_bf16_f32 v145, v160, v161
    v_mfma_f32_16x16x32_bf16 v[210:213], a[20:23], v[166:169], v[210:213]
    buffer_store_dwordx4 v[142:145], v16, s[12:15], 0 offen nt
    v_mul_f32 v178, v254, v178
    v_mul_f32 v179, v254, v179
    v_cvt_pk_bf16_f32 v198, v178, v179
    v_mul_f32 v180, v254, v180
    v_mfma_f32_16x16x32_bf16 v[142:145], a[24:27], v[134:137], 0
    v_mul_f32 v181, v254, v181
    v_cvt_pk_bf16_f32 v199, v180, v181
    v_mfma_f32_16x16x32_bf16 v[142:145], a[28:31], v[154:157], v[142:145]
    v_cvt_pk_f16_f32 v158, v210, v211
    v_pk_mul_f16 v162, v158, v158
    v_mfma_f32_16x16x32_bf16 v[142:145], a[32:35], v[130:133], v[142:145]
    v_cvt_pk_f16_f32 v159, v212, v213
    v_pk_mul_f16 v164, v159, v159
    v_mfma_f32_16x16x32_bf16 v[142:145], a[36:39], v[122:125], v[142:145]
    v_mul_f32 v254, 0x3baaaaab, v200
    v_mul_f32 v150, v255, v150
    v_mfma_f32_16x16x32_bf16 v[142:145], a[40:43], v[126:129], v[142:145]
    v_rsq_f32 v254, v254
    v_mfma_f32_16x16x32_bf16 v[142:145], a[44:47], v[166:169], v[142:145]
    v_mul_f32 v146, v254, v146
    v_mul_f32 v147, v254, v147
    v_mfma_f32_16x16x32_bf16 v[178:181], a[48:51], v[134:137], 0
    v_cvt_pk_bf16_f32 v146, v146, v147
    v_mul_f32 v148, v254, v148
    v_mfma_f32_16x16x32_bf16 v[178:181], a[52:55], v[154:157], v[178:181]
    v_mul_f32 v149, v254, v149
    v_cvt_pk_bf16_f32 v147, v148, v149
    v_mfma_f32_16x16x32_bf16 v[178:181], a[56:59], v[130:133], v[178:181]
    v_mul_f32 v138, v254, v138
    v_mul_f32 v139, v254, v139
    v_mfma_f32_16x16x32_bf16 v[178:181], a[60:63], v[122:125], v[178:181]
    v_cvt_pk_bf16_f32 v148, v138, v139
    v_mul_f32 v140, v254, v140
    v_mfma_f32_16x16x32_bf16 v[178:181], a[64:67], v[126:129], v[178:181]
    v_mul_f32 v141, v254, v141
    v_cvt_pk_bf16_f32 v149, v140, v141
    v_mfma_f32_16x16x32_bf16 v[178:181], a[68:71], v[166:169], v[178:181]
    v_mul_f32 v186, v254, v186
    v_mul_f32 v187, v254, v187
    v_mfma_f32_16x16x32_bf16 v[138:141], v[134:137], a[144:147], 0
    v_cvt_pk_bf16_f32 v200, v186, v187
    v_mul_f32 v188, v254, v188
    v_mfma_f32_16x16x32_bf16 v[138:141], v[154:157], a[148:151], v[138:141]
    v_mul_f32 v189, v254, v189
    v_cvt_pk_bf16_f32 v201, v188, v189
    v_mfma_f32_16x16x32_bf16 v[138:141], v[130:133], a[152:155], v[138:141]
    v_cvt_pk_f16_f32 v160, v142, v143
    v_pk_fma_f16 v162, v160, v160, v162
    v_mfma_f32_16x16x32_bf16 v[138:141], v[122:125], a[156:159], v[138:141]
    v_cvt_pk_f16_f32 v161, v144, v145
    v_pk_fma_f16 v164, v161, v161, v164
    v_mfma_f32_16x16x32_bf16 v[138:141], v[126:129], a[160:163], v[138:141]
    buffer_store_dwordx4 v[146:149], v17, s[12:15], 0 offen nt
    v_cvt_pk_f16_f32 v218, v178, v179
    v_pk_fma_f16 v162, v218, v218, v162
    v_cvt_pk_f16_f32 v219, v180, v181
    v_pk_fma_f16 v164, v219, v219, v164
    v_mfma_f32_16x16x32_bf16 v[138:141], v[166:169], a[164:167], v[138:141]
    v_mul_f32 v151, v255, v151
    v_cvt_pk_bf16_f32 v150, v150, v151
    v_mfma_f32_16x16x32_f16 v[142:145], v[40:43], v[162:165], 0
    v_mul_f32 v152, v255, v152
    v_mul_f32 v153, v255, v153
    v_mfma_f32_16x16x32_bf16 v[178:181], v[134:137], a[168:171], 0
    v_cvt_pk_bf16_f32 v151, v152, v153
    v_mul_f32 v190, v255, v190
    v_mfma_f32_16x16x32_bf16 v[178:181], v[154:157], a[172:175], v[178:181]
    v_cvt_pk_bf16_f32 v176, v138, v139
    v_cvt_pk_bf16_f32 v177, v140, v141
    v_mfma_f32_16x16x32_bf16 v[178:181], v[130:133], a[176:179], v[178:181]
    ds_read_b128 v[146:149], v0 offset:32768
    v_min3_u32 v44, v44, v142, v143
    v_mfma_f32_16x16x32_bf16 v[178:181], v[122:125], a[180:183], v[178:181]
    ds_read_b128 v[138:141], v1 offset:32768
    v_max3_u32 v45, v45, v142, v143
    v_mfma_f32_16x16x32_bf16 v[178:181], v[126:129], a[184:187], v[178:181]
    ds_read_b128 v[186:189], v0 offset:32896
    v_mul_f32 v191, v255, v191
    v_mfma_f32_16x16x32_bf16 v[178:181], v[166:169], a[188:191], v[178:181]
    ds_read_b128 v[162:165], v1 offset:32896
    v_cvt_pk_bf16_f32 v152, v190, v191
    v_mfma_f32_16x16x32_bf16 v[210:213], v[134:137], a[192:195], 0
    ds_read_b128 v[134:137], v0 offset:33024
    v_mul_f32 v192, v255, v192
    v_mfma_f32_16x16x32_bf16 v[210:213], v[154:157], a[196:199], v[210:213]
    ds_read_b128 v[154:157], v1 offset:33024
    v_mul_f32 v193, v255, v193
    v_mfma_f32_16x16x32_bf16 v[210:213], v[130:133], a[200:203], v[210:213]
    v_rsq_f32 v144, v142
    v_mfma_f32_16x16x32_bf16 v[210:213], v[122:125], a[204:207], v[210:213]
    v_rsq_f32 v145, v143
    v_mfma_f32_16x16x32_bf16 v[210:213], v[126:129], a[208:211], v[210:213]
    s_waitcnt lgkmcnt(5)
    v_mul_f32 v144, s31, v144
    v_cvt_pk_f16_f32 v144, v144, v145
    v_mfma_f32_16x16x32_bf16 v[210:213], v[166:169], a[212:215], v[210:213]
    s_waitcnt lgkmcnt(4)
    v_cvt_pk_bf16_f32 v184, v178, v179
    v_cvt_pk_bf16_f32 v185, v180, v181
    v_mfma_f32_16x16x32_bf16 v[178:181], a[72:75], v[146:149], 0
    s_waitcnt lgkmcnt(3)
    v_pk_mul_f16 v170, v170, v144 op_sel:[0,1] op_sel_hi:[1,1]
    v_pk_mul_f16 v171, v171, v144 op_sel:[0,1] op_sel_hi:[1,1]
    v_mfma_f32_16x16x32_bf16 v[178:181], a[76:79], v[138:141], v[178:181]
    s_waitcnt lgkmcnt(2)
    v_cvt_pk_bf16_f32 v116, v210, v211
    v_cvt_pk_bf16_f32 v117, v212, v213
    v_mfma_f32_16x16x32_bf16 v[178:181], a[80:83], v[186:189], v[178:181]
    s_waitcnt lgkmcnt(1)
    buffer_store_dwordx2 v[200:201], v20, s[12:15], 0 offen nt
    v_pk_mul_f16 v172, v172, v144 op_sel:[0,1] op_sel_hi:[1,1]
    v_pk_mul_f16 v173, v173, v144 op_sel:[0,1] op_sel_hi:[1,1]
    v_mfma_f32_16x16x32_bf16 v[178:181], a[84:87], v[162:165], v[178:181]
    s_waitcnt lgkmcnt(0)
    v_pk_mul_f16 v220, v220, v144 op_sel:[0,1] op_sel_hi:[1,1]
    v_pk_mul_f16 v221, v221, v144 op_sel:[0,1] op_sel_hi:[1,1]
    v_mfma_f32_16x16x32_bf16 v[178:181], a[88:91], v[134:137], v[178:181]
    v_pk_mul_f16 v158, v158, v144 op_sel:[0,0] op_sel_hi:[1,0]
    v_pk_mul_f16 v159, v159, v144 op_sel:[0,0] op_sel_hi:[1,0]
    v_mfma_f32_16x16x32_bf16 v[178:181], a[92:95], v[154:157], v[178:181]
    v_pk_mul_f16 v160, v160, v144 op_sel:[0,0] op_sel_hi:[1,0]
    v_pk_mul_f16 v161, v161, v144 op_sel:[0,0] op_sel_hi:[1,0]
    v_mfma_f32_16x16x32_bf16 v[130:133], a[96:99], v[146:149], 0
    v_pk_mul_f16 v218, v218, v144 op_sel:[0,0] op_sel_hi:[1,0]
    v_pk_mul_f16 v219, v219, v144 op_sel:[0,0] op_sel_hi:[1,0]
    v_mfma_f32_16x16x32_bf16 v[130:133], a[100:103], v[138:141], v[130:133]
    s_waitcnt vmcnt(3)
    v_cvt_pk_bf16_f32 v153, v192, v193
    v_cvt_pk_f16_f32 v142, v178, v179
    v_mfma_f32_16x16x32_bf16 v[130:133], a[104:107], v[186:189], v[130:133]
    s_nop 0
    v_pk_mul_f16 v191, v142, v142
    v_cvt_pk_f16_f32 v143, v180, v181
    v_mfma_f32_16x16x32_bf16 v[130:133], a[108:111], v[162:165], v[130:133]
    s_barrier
    v_pk_mul_f16 v193, v143, v143
    v_mul_f32 v202, v255, v202
    v_mfma_f32_16x16x32_bf16 v[130:133], a[112:115], v[134:137], v[130:133]
    s_nop 0
    v_mul_f32 v203, v255, v203
    v_cvt_pk_bf16_f32 v254, v202, v203
    v_mfma_f32_16x16x32_bf16 v[130:133], a[116:119], v[154:157], v[130:133]
    s_nop 0
    v_mul_f32 v204, v255, v204
    v_mul_f32 v205, v255, v205
    v_mfma_f32_16x16x32_bf16 v[178:181], a[120:123], v[146:149], 0
    v_cvt_pk_bf16_f32 v255, v204, v205
    v_xor_b32 v0, 65536, v0
    v_mfma_f32_16x16x32_bf16 v[178:181], a[124:127], v[138:141], v[178:181]
    v_xor_b32 v1, 65536, v1
    v_cvt_pk_f16_f32 v144, v130, v131
    v_mfma_f32_16x16x32_bf16 v[178:181], a[128:131], v[186:189], v[178:181]
    v_pk_fma_f16 v191, v144, v144, v191
    v_cvt_pk_f16_f32 v145, v132, v133
    v_mfma_f32_16x16x32_bf16 v[178:181], a[132:135], v[162:165], v[178:181]
    v_pk_fma_f16 v193, v145, v145, v193
    v_mfma_f32_16x16x32_bf16 v[178:181], a[136:139], v[134:137], v[178:181]
    v_mfma_f32_16x16x32_bf16 v[178:181], a[140:143], v[154:157], v[178:181]
    v_mfma_f32_16x16x32_bf16 v[202:205], a[0:3], v[146:149], 0
    v_mfma_f32_16x16x32_bf16 v[202:205], a[4:7], v[138:141], v[202:205]
    buffer_load_dwordx4 v10, s[8:11], 0 offen nt lds
    s_add_u32 m0, s28, 4096
    v_mfma_f32_16x16x32_bf16 v[202:205], a[8:11], v[186:189], v[202:205]
    v_mfma_f32_16x16x32_bf16 v[202:205], a[12:15], v[162:165], v[202:205]
    v_mfma_f32_16x16x32_bf16 v[202:205], a[16:19], v[134:137], v[202:205]
    v_mfma_f32_16x16x32_bf16 v[202:205], a[20:23], v[154:157], v[202:205]
    v_cvt_pk_f16_f32 v124, v178, v179
    v_pk_fma_f16 v191, v124, v124, v191
    v_mfma_f32_16x16x32_bf16 v[130:133], a[24:27], v[146:149], 0
    buffer_load_dwordx4 v11, s[8:11], 0 offen nt lds
    v_cvt_pk_f16_f32 v125, v180, v181
    v_mfma_f32_16x16x32_bf16 v[130:133], a[28:31], v[138:141], v[130:133]
    s_add_u32 m0, s28, 8192
    v_pk_fma_f16 v193, v125, v125, v193
    v_cvt_pk_f16_f32 v178, v202, v203
    v_mfma_f32_16x16x32_bf16 v[130:133], a[32:35], v[186:189], v[130:133]
    v_pk_mul_f16 v190, v178, v178
    v_cvt_pk_f16_f32 v179, v204, v205
    v_mfma_f32_16x16x32_bf16 v[130:133], a[36:39], v[162:165], v[130:133]
    v_pk_mul_f16 v192, v179, v179
    v_mfma_f32_16x16x32_bf16 v[130:133], a[40:43], v[134:137], v[130:133]
    v_mfma_f32_16x16x32_bf16 v[130:133], a[44:47], v[154:157], v[130:133]
    buffer_load_dwordx4 v12, s[8:11], 0 offen nt lds
    s_add_u32 m0, s28, 12288
    v_mfma_f32_16x16x32_bf16 v[202:205], a[48:51], v[146:149], 0
    s_xor_b32 s28, s28, 65536
    v_mfma_f32_16x16x32_bf16 v[202:205], a[52:55], v[138:141], v[202:205]
    ds_read_b128 v[166:169], v5 offset:0
    ds_read_b128 v[126:129], v5 offset:16
    v_mfma_f32_16x16x32_bf16 v[202:205], a[56:59], v[186:189], v[202:205]
    ds_read_b128 v[210:213], v5 offset:48
    ds_read_b32 v200, v6 offset:192
    v_mfma_f32_16x16x32_bf16 v[202:205], a[60:63], v[162:165], v[202:205]
    v_cvt_pk_f16_f32 v180, v130, v131
    v_pk_fma_f16 v190, v180, v180, v190
    v_mfma_f32_16x16x32_bf16 v[202:205], a[64:67], v[134:137], v[202:205]
    buffer_load_dwordx4 v13, s[8:11], 0 offen nt lds
    v_cvt_pk_f16_f32 v181, v132, v133
    v_mfma_f32_16x16x32_bf16 v[202:205], a[68:71], v[154:157], v[202:205]
    s_mov_b32 m0, s29
    v_pk_fma_f16 v192, v181, v181, v192
    v_add_u32 v5, 336, v5
    v_mfma_f32_16x16x32_bf16 v[130:133], v[146:149], a[144:147], 0
    s_xor_b32 s29, s29, s30
    s_add_u32 s19, s19, s20
    s_add_u32 s23, s23, s21
    v_mfma_f32_16x16x32_bf16 v[130:133], v[138:141], a[148:151], v[130:133]
    s_cmp_ge_u32 s19, 72
    v_cvt_pk_f16_f32 v122, v202, v203
    v_pk_fma_f16 v190, v122, v122, v190
    v_mfma_f32_16x16x32_bf16 v[130:133], v[186:189], a[152:155], v[130:133]
    s_cselect_b32 s34, 72, 0
    v_cvt_pk_f16_f32 v123, v204, v205
    v_pk_fma_f16 v192, v123, v123, v192
    v_mfma_f32_16x16x32_bf16 v[130:133], v[162:165], a[156:159], v[130:133]
    s_waitcnt lgkmcnt(2)
    buffer_store_dwordx2 v[198:199], v19, s[12:15], 0 offen nt
    s_cselect_b32 s35, s22, 0
    s_sub_u32 s19, s19, s34
    v_mfma_f32_16x16x32_f16 v[202:205], v[40:43], v[190:193], 0
    s_add_u32 s23, s23, s35
    s_add_u32 s18, s18, 1
    s_cmp_lt_u32 s18, s45
    v_mfma_f32_16x16x32_f16 v[214:217], v[166:169], v[158:161], v[24:27]
    s_waitcnt lgkmcnt(0)
    v_mfma_f32_16x16x32_f16 v[214:217], v[126:129], v[170:173], v[214:217]
    v_mfma_f32_16x16x32_f16 v[214:217], v[210:213], v[218:221], v[214:217]
    v_mfma_f32_16x16x32_f16 v[190:193], v[166:169], v[206:209], v[22:25]
    v_rsq_f32 v204, v202
    v_mfma_f32_16x16x32_f16 v[190:193], v[126:129], v[118:121], v[190:193]
    v_rsq_f32 v205, v203
    v_mfma_f32_16x16x32_f16 v[190:193], v[210:213], v[194:197], v[190:193]
    v_mul_f32 v204, s31, v204
    v_cvt_pk_f16_f32 v204, v204, v205
    v_mfma_f32_16x16x32_bf16 v[130:133], v[134:137], a[160:163], v[130:133]
    v_pk_mul_f16 v142, v142, v204 op_sel:[0,1] op_sel_hi:[1,1]
    v_pk_mul_f16 v143, v143, v204 op_sel:[0,1] op_sel_hi:[1,1]
    v_mfma_f32_16x16x32_bf16 v[130:133], v[154:157], a[164:167], v[130:133]
    v_pk_mul_f16 v144, v144, v204 op_sel:[0,1] op_sel_hi:[1,1]
    v_pk_mul_f16 v145, v145, v204 op_sel:[0,1] op_sel_hi:[1,1]
    v_mfma_f32_16x16x32_bf16 v[222:225], v[146:149], a[168:171], 0
    v_mov_b32_dpp v200, v191 quad_perm:[0,1,2,3] row_mask:0x1 bank_mask:0xf
    v_mov_b32_dpp v200, v215 quad_perm:[0,1,2,3] row_mask:0x2 bank_mask:0xf
    v_mfma_f32_16x16x32_bf16 v[222:225], v[138:141], a[172:175], v[222:225]
    v_pk_mul_f16 v124, v124, v204 op_sel:[0,1] op_sel_hi:[1,1]
    v_pk_mul_f16 v125, v125, v204 op_sel:[0,1] op_sel_hi:[1,1]
    v_mfma_f32_16x16x32_bf16 v[222:225], v[186:189], a[176:179], v[222:225]
    v_cvt_pk_bf16_f32 v130, v130, v131
    v_cvt_pk_bf16_f32 v131, v132, v133
    v_mfma_f32_16x16x32_bf16 v[222:225], v[162:165], a[180:183], v[222:225]
    v_pk_mul_f16 v178, v178, v204 op_sel:[0,0] op_sel_hi:[1,0]
    v_pk_mul_f16 v179, v179, v204 op_sel:[0,0] op_sel_hi:[1,0]
    v_mfma_f32_16x16x32_f16 v[226:229], v[118:121], v[206:209], v[46:49]
    v_pk_mul_f16 v180, v180, v204 op_sel:[0,0] op_sel_hi:[1,0]
    v_pk_mul_f16 v181, v181, v204 op_sel:[0,0] op_sel_hi:[1,0]
    v_mfma_f32_16x16x32_f16 v[230:233], v[170:173], v[206:209], v[50:53]
    v_pk_mul_f16 v122, v122, v204 op_sel:[0,0] op_sel_hi:[1,0]
    v_pk_mul_f16 v123, v123, v204 op_sel:[0,0] op_sel_hi:[1,0]
    v_mfma_f32_16x16x32_f16 v[234:237], v[142:145], v[206:209], v[54:57]
    v_min3_u32 v44, v44, v202, v203
    v_exp_f32 v214, v214
    v_mfma_f32_16x16x16_f16 v[226:229], v[196:197], v[194:195], v[226:229]
    v_max3_u32 v45, v45, v202, v203
    v_exp_f32 v190, v190
    v_mfma_f32_16x16x16_f16 v[230:233], v[220:221], v[194:195], v[230:233]
    v_cvt_pk_bf16_f32 v39, v190, 0
    v_mfma_f32_16x16x16_f16 v[234:237], v[124:125], v[194:195], v[234:237]
    buffer_store_dwordx4 v[150:153], v15, s[12:15], 0 offen nt
    v_mfma_f32_16x16x32_bf16 v[222:225], v[134:137], a[184:187], v[222:225]
    v_mfma_f32_16x16x32_bf16 v[222:225], v[154:157], a[188:191], v[222:225]
    ds_read_b128 v[206:209], v2 offset:0
    v_mfma_f32_16x16x32_bf16 v[150:153], v[146:149], a[192:195], 0
    ds_read_b128 v[146:149], v2 offset:1024
    v_mfma_f32_16x16x32_bf16 v[150:153], v[138:141], a[196:199], v[150:153]
    ds_read_b128 v[138:141], v2 offset:2048
    v_mfma_f32_16x16x32_bf16 v[150:153], v[186:189], a[200:203], v[150:153]
    ds_read_b128 v[186:189], v2 offset:3072
    v_mfma_f32_16x16x32_bf16 v[150:153], v[162:165], a[204:207], v[150:153]
    ds_read_b128 v[162:165], v2 offset:4096
    v_cvt_pk_bf16_f32 v222, v222, v223
    v_mfma_f32_16x16x32_bf16 v[150:153], v[134:137], a[208:211], v[150:153]
    ds_read_b128 v[134:137], v2 offset:5120
    v_cvt_pk_bf16_f32 v223, v224, v225
    v_mfma_f32_16x16x32_bf16 v[150:153], v[154:157], a[212:215], v[150:153]
    ds_read2_b32 v[132:133], v6 offset0:0 offset1:0
    ds_read2_b32 v[224:225], v6 offset0:16 offset1:16
    v_mfma_f32_16x16x32_f16 v[154:157], v[166:169], v[178:181], v[26:29]
    ds_read2_b32 v[168:169], v6 offset0:32 offset1:32
    v_add_u32 v6, 272, v6
    v_mfma_f32_16x16x32_f16 v[154:157], v[126:129], v[142:145], v[154:157]
    s_waitcnt lgkmcnt(8)
    v_exp_f32 v226, v226
    v_mfma_f32_16x16x32_f16 v[154:157], v[210:213], v[122:125], v[154:157]
    s_waitcnt lgkmcnt(7)
    v_cvt_pk_bf16_f32 v166, v150, v151
    v_cvt_pk_bf16_f32 v167, v152, v153
    v_mfma_f32_16x16x32_bf16 v[150:153], a[216:219], v[206:209], 0
    s_waitcnt lgkmcnt(6)
    v_exp_f32 v227, v227
    v_mfma_f32_16x16x32_bf16 v[150:153], a[220:223], v[146:149], v[150:153]
    s_waitcnt lgkmcnt(5)
    v_exp_f32 v154, v154
    v_mfma_f32_16x16x32_bf16 v[150:153], a[224:227], v[138:141], v[150:153]
    s_waitcnt lgkmcnt(4)
    v_mov_b32_dpp v200, v155 quad_perm:[0,1,2,3] row_mask:0x4 bank_mask:0xf
    v_cvt_pk_bf16_f32 v126, v226, v227
    v_mfma_f32_16x16x32_bf16 v[150:153], a[228:231], v[186:189], v[150:153]
    s_waitcnt lgkmcnt(3)
    v_exp_f32 v200, v200
    v_mfma_f32_16x16x32_bf16 v[150:153], a[232:235], v[162:165], v[150:153]
    s_waitcnt lgkmcnt(1)
    v_exp_f32 v228, v228
    v_mfma_f32_16x16x32_bf16 v[150:153], a[236:239], v[134:137], v[150:153]
    s_waitcnt lgkmcnt(0)
    buffer_store_dwordx2 v[254:255], v18, s[12:15], 0 offen nt
    v_exp_f32 v229, v229
    v_mfma_f32_16x16x32_bf16 v[190:193], a[240:243], v[206:209], 0
    v_cvt_pk_bf16_f32 v200, v200, v200
    v_cvt_pk_bf16_f32 v127, v228, v229
    v_mfma_f32_16x16x32_bf16 v[190:193], a[244:247], v[146:149], v[190:193]
    ds_write_b16 v8, v200
    v_mfma_f32_16x16x32_bf16 v[190:193], a[248:251], v[138:141], v[190:193]
    v_exp_f32 v230, v230
    v_mfma_f32_16x16x32_bf16 v[190:193], a[252:255], v[186:189], v[190:193]
    ds_read_b128 v[198:201], v2 offset:6144
    ds_read_b128 v[210:213], v9
    v_mfma_f32_16x16x32_bf16 v[190:193], v[82:85], v[162:165], v[190:193]
    ds_read_b128 v[226:229], v2 offset:7168
    ds_read_b128 v[238:241], v9 offset:64
    v_mfma_f32_16x16x32_bf16 v[190:193], v[86:89], v[134:137], v[190:193]
    v_exp_f32 v231, v231
    v_mfma_f32_16x16x32_bf16 v[202:205], v[90:93], v[206:209], 0
    ds_read_b128 v[206:209], v2 offset:8192
    ds_read_b128 v[242:245], v2 offset:9216
    v_mfma_f32_16x16x32_bf16 v[202:205], v[94:97], v[146:149], v[202:205]
    v_cvt_pk_bf16_f32 v128, v230, v231
    v_fma_f32 v254, v150, v150, s33
    v_mfma_f32_16x16x32_bf16 v[202:205], v[98:101], v[138:141], v[202:205]
    ds_read_b128 v[146:149], v2 offset:10240
    ds_read_b128 v[138:141], v2 offset:11264
    v_mfma_f32_16x16x32_bf16 v[202:205], v[102:105], v[186:189], v[202:205]
    v_exp_f32 v232, v232
    v_mfma_f32_16x16x32_bf16 v[202:205], v[106:109], v[162:165], v[202:205]
    v_exp_f32 v233, v233
    v_mfma_f32_16x16x32_bf16 v[202:205], v[110:113], v[134:137], v[202:205]
    s_waitcnt lgkmcnt(6)
    v_cvt_pk_bf16_f32 v129, v232, v233
    v_fmac_f32 v254, v151, v151
    v_mfma_f32_16x16x32_bf16 v[186:189], v[210:213], v[28:31], 0
    s_waitcnt lgkmcnt(4)
    v_exp_f32 v234, v234
    v_mfma_f32_16x16x32_bf16 v[186:189], v[238:241], v[28:31], v[186:189]
    v_exp_f32 v235, v235
    v_mfma_f32_16x16x32_f16 v[134:137], v[118:121], v[158:161], v[58:61]
    s_waitcnt lgkmcnt(2)
    v_cvt_pk_bf16_f32 v36, v234, v235
    v_fmac_f32 v254, v152, v152
    v_mfma_f32_16x16x32_f16 v[162:165], v[170:173], v[158:161], v[62:65]
    v_exp_f32 v236, v236
    v_mfma_f32_16x16x32_f16 v[230:233], v[142:145], v[158:161], v[66:69]
    s_waitcnt lgkmcnt(0)
    buffer_load_dwordx4 v14, s[8:11], 0 offen nt lds
    v_rcp_f32 v186, v186
    v_mfma_f32_16x16x16_f16 v[134:137], v[196:197], v[218:219], v[134:137]
    v_exp_f32 v237, v237
    v_fmac_f32 v254, v153, v153
    v_mfma_f32_16x16x16_f16 v[162:165], v[220:221], v[218:219], v[162:165]
    v_cvt_pk_bf16_f32 v37, v236, v237
    v_fmac_f32 v254, v190, v190
    v_fmac_f32 v254, v191, v191
    v_mfma_f32_16x16x16_f16 v[230:233], v[124:125], v[218:219], v[230:233]
    v_fmac_f32 v254, v192, v192
    v_exp_f32 v134, v134
    v_fmac_f32 v254, v193, v193
    v_mfma_f32_16x16x32_bf16 v[158:161], v[210:213], v[174:177], 0
    v_exp_f32 v135, v135
    v_mfma_f32_16x16x32_bf16 v[158:161], v[238:241], v[130:133], v[158:161]
    v_cvt_pk_bf16_f32 v134, v134, v135
    v_fmac_f32 v254, v202, v202
    v_mfma_f32_16x16x32_bf16 v[234:237], v[210:213], v[182:185], 0
    v_exp_f32 v136, v136
    v_mfma_f32_16x16x32_bf16 v[234:237], v[238:241], v[222:225], v[234:237]
    v_exp_f32 v137, v137
    v_mfma_f32_16x16x32_bf16 v[246:249], v[210:213], v[114:117], 0
    v_cvt_pk_bf16_f32 v135, v136, v137
    v_mul_f32 v158, v158, v186
    v_mfma_f32_16x16x32_bf16 v[246:249], v[238:241], v[166:169], v[246:249]
    v_exp_f32 v162, v162
    v_mfma_f32_16x16x32_bf16 v[210:213], v[28:31], v[36:39], 0
    v_exp_f32 v163, v163
    v_mfma_f32_16x16x32_bf16 v[210:213], v[28:31], v[126:129], v[210:213]
    v_cvt_pk_bf16_f32 v136, v162, v163
    v_mul_f32_dpp v158, v234, v186 quad_perm:[0,1,2,3] row_mask:0x2 bank_mask:0xf
    v_mfma_f32_16x16x32_bf16 v[234:237], v[130:133], v[36:39], 0
    v_exp_f32 v164, v164
    v_mfma_f32_16x16x32_bf16 v[234:237], v[174:177], v[126:129], v[234:237]
    v_exp_f32 v165, v165
    v_mfma_f32_16x16x32_bf16 v[238:241], v[222:225], v[36:39], 0
    v_cvt_pk_bf16_f32 v137, v164, v165
    v_mul_f32_dpp v158, v246, v186 quad_perm:[0,1,2,3] row_mask:0x4 bank_mask:0xf
    v_mfma_f32_16x16x32_bf16 v[238:241], v[182:185], v[126:129], v[238:241]
    v_exp_f32 v230, v230
    v_mfma_f32_16x16x32_bf16 v[186:189], v[166:169], v[36:39], 0
    v_exp_f32 v231, v231
    v_mfma_f32_16x16x32_bf16 v[186:189], v[114:117], v[126:129], v[186:189]
    v_cvt_pk_bf16_f32 v36, v230, v231
    v_cvt_pk_bf16_f32 v39, v214, 0
    v_mfma_f32_16x16x32_f16 v[162:165], v[118:121], v[178:181], v[70:73]
    v_exp_f32 v232, v232
    v_mfma_f32_16x16x32_f16 v[118:121], v[170:173], v[178:181], v[74:77]
    v_exp_f32 v233, v233
    v_mfma_f32_16x16x32_f16 v[170:173], v[142:145], v[178:181], v[78:81]
    v_cvt_pk_bf16_f32 v37, v232, v233
    v_cvt_pk_bf16_f32 v158, v158, v158
    v_fmac_f32 v254, v203, v203
    v_mfma_f32_16x16x16_f16 v[162:165], v[196:197], v[122:123], v[162:165]
    v_rcp_f32 v210, v210
    v_fmac_f32 v254, v204, v204
    v_mfma_f32_16x16x16_f16 v[118:121], v[220:221], v[122:123], v[118:121]
    v_mul_f32 v234, v210, v234
    v_mul_f32 v235, v210, v235
    v_cvt_pk_bf16_f32 v178, v234, v235
    v_mfma_f32_16x16x16_f16 v[170:173], v[124:125], v[122:123], v[170:173]
    v_mul_f32 v236, v210, v236
    v_exp_f32 v162, v162
    v_mul_f32 v237, v210, v237
    v_mfma_f32_16x16x32_bf16 v[194:197], v[28:31], v[36:39], 0
    ds_write_b16 v7, v158
    v_mfma_f32_16x16x32_bf16 v[194:197], v[28:31], v[134:137], v[194:197]
    v_exp_f32 v163, v163
    v_mfma_f32_16x16x32_bf16 v[122:125], v[130:133], v[36:39], 0
    v_cvt_pk_bf16_f32 v162, v162, v163
    v_cvt_pk_bf16_f32 v179, v236, v237
    v_mfma_f32_16x16x32_bf16 v[122:125], v[174:177], v[134:137], v[122:125]
    v_exp_f32 v164, v164
    v_mfma_f32_16x16x32_bf16 v[126:129], v[222:225], v[36:39], 0
    v_exp_f32 v165, v165
    v_mfma_f32_16x16x32_bf16 v[126:129], v[182:185], v[134:137], v[126:129]
    v_cvt_pk_bf16_f32 v163, v164, v165
    v_mul_f32 v238, v210, v238
    v_mfma_f32_16x16x32_bf16 v[218:221], v[166:169], v[36:39], 0
    v_exp_f32 v118, v118
    v_mfma_f32_16x16x32_bf16 v[218:221], v[114:117], v[134:137], v[218:221]
    v_exp_f32 v119, v119
    v_mfma_f32_16x16x32_bf16 v[142:145], a[216:219], v[198:201], 0
    v_cvt_pk_bf16_f32 v164, v118, v119
    v_cvt_pk_bf16_f32 v39, v154, 0
    v_mfma_f32_16x16x32_bf16 v[142:145], a[220:223], v[226:229], v[142:145]
    v_exp_f32 v120, v120
    v_mfma_f32_16x16x32_bf16 v[142:145], a[224:227], v[206:209], v[142:145]
    v_exp_f32 v121, v121
    v_mfma_f32_16x16x32_bf16 v[142:145], a[228:231], v[242:245], v[142:145]
    v_cvt_pk_bf16_f32 v165, v120, v121
    v_mul_f32 v239, v210, v239
    v_mfma_f32_16x16x32_bf16 v[142:145], a[232:235], v[146:149], v[142:145]
    v_exp_f32 v170, v170
    v_mfma_f32_16x16x32_bf16 v[142:145], a[236:239], v[138:141], v[142:145]
    v_exp_f32 v171, v171
    v_mfma_f32_16x16x32_bf16 v[158:161], a[240:243], v[198:201], 0
    v_cvt_pk_bf16_f32 v36, v170, v171
    v_cvt_pk_bf16_f32 v180, v238, v239
    v_mfma_f32_16x16x32_bf16 v[158:161], a[244:247], v[226:229], v[158:161]
    v_exp_f32 v172, v172
    v_mfma_f32_16x16x32_bf16 v[158:161], a[248:251], v[206:209], v[158:161]
    v_exp_f32 v173, v173
    v_mfma_f32_16x16x32_bf16 v[158:161], a[252:255], v[242:245], v[158:161]
    ds_read_b128 v[118:121], v2 offset:12288
    v_cvt_pk_bf16_f32 v37, v172, v173
    v_mfma_f32_16x16x32_bf16 v[158:161], v[82:85], v[146:149], v[158:161]
    ds_read_b128 v[134:137], v2 offset:13312
    v_mul_f32 v240, v210, v240
    v_mfma_f32_16x16x32_bf16 v[170:173], v[28:31], v[36:39], 0
    v_mul_f32 v241, v210, v241
    v_cvt_pk_bf16_f32 v181, v240, v241
    v_mfma_f32_16x16x32_bf16 v[170:173], v[28:31], v[162:165], v[170:173]
    ds_write_b128 v3, v[178:181] offset:0
    v_mfma_f32_16x16x32_bf16 v[154:157], v[130:133], v[36:39], 0
    v_mul_f32 v186, v210, v186
    v_mul_f32 v187, v210, v187
    v_mfma_f32_16x16x32_bf16 v[154:157], v[174:177], v[162:165], v[154:157]
    v_cvt_pk_bf16_f32 v186, v186, v187
    v_mul_f32 v188, v210, v188
    v_mfma_f32_16x16x32_bf16 v[130:133], v[222:225], v[36:39], 0
    v_mul_f32 v189, v210, v189
    v_cvt_pk_bf16_f32 v187, v188, v189
    v_mfma_f32_16x16x32_bf16 v[130:133], v[182:185], v[162:165], v[130:133]
    s_waitcnt lgkmcnt(2)
    ds_write_b64 v4, v[186:187] offset:4096
    v_mfma_f32_16x16x32_bf16 v[174:177], v[166:169], v[36:39], 0
    s_waitcnt lgkmcnt(2)
    v_fma_f32 v255, v142, v142, s33
    v_fmac_f32 v255, v143, v143
    v_mfma_f32_16x16x32_bf16 v[174:177], v[114:117], v[162:165], v[174:177]
    v_fmac_f32 v255, v144, v144
    v_fmac_f32 v255, v145, v145
    v_mfma_f32_16x16x32_bf16 v[158:161], v[86:89], v[138:141], v[158:161]
    ds_read_b128 v[114:117], v2 offset:14336
    v_fmac_f32 v254, v205, v205
    v_mfma_f32_16x16x32_bf16 v[178:181], v[90:93], v[198:201], 0
    ds_read_b128 v[166:169], v2 offset:15360
    v_add_u32 v7, 16, v7
    v_mfma_f32_16x16x32_bf16 v[178:181], v[94:97], v[226:229], v[178:181]
    ds_read_b128 v[162:165], v2 offset:16384
    v_mfma_f32_16x16x32_bf16 v[178:181], v[98:101], v[206:209], v[178:181]
    ds_read_b128 v[206:209], v2 offset:17408
    v_fmac_f32 v255, v158, v158
    v_mfma_f32_16x16x32_bf16 v[178:181], v[102:105], v[242:245], v[178:181]
    v_fmac_f32 v255, v159, v159
    v_fmac_f32 v255, v160, v160
    v_mfma_f32_16x16x32_bf16 v[178:181], v[106:109], v[146:149], v[178:181]
    v_fmac_f32 v255, v161, v161
    v_xor_b32 v2, 65536, v2
    v_mfma_f32_16x16x32_bf16 v[178:181], v[110:113], v[138:141], v[178:181]
    v_rcp_f32 v170, v170
    v_mfma_f32_16x16x32_bf16 v[146:149], a[216:219], v[118:121], 0
    v_mul_f32 v154, v170, v154
    v_mul_f32 v155, v170, v155
    v_mfma_f32_16x16x32_bf16 v[146:149], a[220:223], v[134:137], v[146:149]
    s_waitcnt lgkmcnt(3)
    ds_read_b128 v[182:185], v0 offset:20480
    v_cvt_pk_bf16_f32 v154, v154, v155
    v_mfma_f32_16x16x32_bf16 v[146:149], a[224:227], v[114:117], v[146:149]
    s_waitcnt lgkmcnt(3)
    ds_read_b128 v[198:201], v1 offset:20480
    v_fmac_f32 v255, v178, v178
    v_mfma_f32_16x16x32_bf16 v[146:149], a[228:231], v[166:169], v[146:149]
    s_waitcnt lgkmcnt(3)
    ds_read_b128 v[210:213], v0 offset:20608
    v_fmac_f32 v255, v179, v179
    v_mfma_f32_16x16x32_bf16 v[146:149], a[232:235], v[162:165], v[146:149]
    s_waitcnt lgkmcnt(3)
    ds_read_b128 v[222:225], v1 offset:20608
    v_fmac_f32 v255, v180, v180
    v_mfma_f32_16x16x32_bf16 v[146:149], a[236:239], v[206:209], v[146:149]
    ds_read_b128 v[226:229], v0 offset:20736
    v_fmac_f32 v255, v181, v181
    v_mfma_f32_16x16x32_bf16 v[138:141], a[240:243], v[118:121], 0
    ds_read_b128 v[242:245], v1 offset:20736
    v_cvt_pk_bf16_f32 v254, v254, v255
    v_mfma_f32_16x16x32_bf16 v[138:141], a[244:247], v[134:137], v[138:141]
    v_mul_f32 v156, v170, v156
    v_mul_f32 v157, v170, v157
    v_mfma_f32_16x16x32_bf16 v[138:141], a[248:251], v[114:117], v[138:141]
    v_fma_f32 v255, v146, v146, s33
    v_fmac_f32 v255, v147, v147
    v_mfma_f32_16x16x32_bf16 v[138:141], a[252:255], v[166:169], v[138:141]
    s_waitcnt lgkmcnt(5)
    v_fmac_f32 v255, v148, v148
    v_fmac_f32 v255, v149, v149
    v_mfma_f32_16x16x32_bf16 v[138:141], v[82:85], v[162:165], v[138:141]
    s_waitcnt lgkmcnt(4)
    v_cvt_pk_bf16_f32 v155, v156, v157
    v_mul_f32 v130, v170, v130
    v_mfma_f32_16x16x32_bf16 v[138:141], v[86:89], v[206:209], v[138:141]
    s_waitcnt lgkmcnt(3)
    v_mul_f32 v131, v170, v131
    v_cvt_pk_bf16_f32 v156, v130, v131
    v_mfma_f32_16x16x32_bf16 v[186:189], v[90:93], v[118:121], 0
    s_waitcnt lgkmcnt(2)
    v_mul_f32 v132, v170, v132
    v_mul_f32 v133, v170, v133
    v_mfma_f32_16x16x32_bf16 v[186:189], v[94:97], v[134:137], v[186:189]
    s_waitcnt lgkmcnt(1)
    v_fmac_f32 v255, v138, v138
    v_fmac_f32 v255, v139, v139
    v_mfma_f32_16x16x32_bf16 v[186:189], v[98:101], v[114:117], v[186:189]
    s_waitcnt lgkmcnt(0)
    v_fmac_f32 v255, v140, v140
    v_fmac_f32 v255, v141, v141
    v_mfma_f32_16x16x32_bf16 v[186:189], v[102:105], v[166:169], v[186:189]
    v_cvt_pk_bf16_f32 v157, v132, v133
    v_mul_f32 v174, v170, v174
    v_mfma_f32_16x16x32_bf16 v[186:189], v[106:109], v[162:165], v[186:189]
    ds_write_b128 v3, v[154:157] offset:12288
    v_mfma_f32_16x16x32_bf16 v[186:189], v[110:113], v[206:209], v[186:189]
    v_mul_f32 v175, v170, v175
    v_cvt_pk_bf16_f32 v174, v174, v175
    v_mfma_f32_16x16x32_bf16 v[118:121], a[72:75], v[182:185], 0
    v_mul_f32 v176, v170, v176
    v_mul_f32 v177, v170, v177
    v_mfma_f32_16x16x32_bf16 v[118:121], a[76:79], v[198:201], v[118:121]
    v_rcp_f32 v194, v194
    v_mfma_f32_16x16x32_bf16 v[118:121], a[80:83], v[210:213], v[118:121]
    v_fmac_f32 v255, v186, v186
    v_fmac_f32 v255, v187, v187
    v_mfma_f32_16x16x32_bf16 v[118:121], a[84:87], v[222:225], v[118:121]
    v_fmac_f32 v255, v188, v188
    v_fmac_f32 v255, v189, v189
    v_mfma_f32_16x16x32_bf16 v[118:121], a[88:91], v[226:229], v[118:121]
    v_cvt_pk_bf16_f32 v255, v255, v255
    v_cvt_pk_bf16_f32 v175, v176, v177
    v_mfma_f32_16x16x32_bf16 v[118:121], a[92:95], v[242:245], v[118:121]
    ds_write_b64 v4, v[174:175] offset:16384
    v_mfma_f32_16x16x32_bf16 v[206:209], a[96:99], v[182:185], 0
    v_mul_f32 v122, v194, v122
    v_mul_f32 v123, v194, v123
    v_mfma_f32_16x16x32_bf16 v[206:209], a[100:103], v[198:201], v[206:209]
    ds_write_b64 v4, v[254:255] offset:18432
    v_mfma_f32_16x16x32_bf16 v[206:209], a[104:107], v[210:213], v[206:209]
    v_cvt_pk_bf16_f32 v134, v122, v123
    v_cvt_pk_f16_f32 v118, v118, v119
    v_mfma_f32_16x16x32_bf16 v[206:209], a[108:111], v[222:225], v[206:209]
    v_pk_mul_f16 v163, v118, v118
    v_cvt_pk_f16_f32 v119, v120, v121
    v_mfma_f32_16x16x32_bf16 v[206:209], a[112:115], v[226:229], v[206:209]
    v_pk_mul_f16 v165, v119, v119
    v_mul_f32 v124, v194, v124
    v_mfma_f32_16x16x32_bf16 v[206:209], a[116:119], v[242:245], v[206:209]
    v_mul_f32 v125, v194, v125
    v_cvt_pk_bf16_f32 v135, v124, v125
    v_mfma_f32_16x16x32_bf16 v[122:125], a[120:123], v[182:185], 0
    v_mul_f32 v126, v194, v126
    v_mul_f32 v127, v194, v127
    v_mfma_f32_16x16x32_bf16 v[122:125], a[124:127], v[198:201], v[122:125]
    v_cvt_pk_bf16_f32 v136, v126, v127
    v_mul_f32 v128, v194, v128
    v_mfma_f32_16x16x32_bf16 v[122:125], a[128:131], v[210:213], v[122:125]
    v_cvt_pk_f16_f32 v120, v206, v207
    v_pk_fma_f16 v163, v120, v120, v163
    v_mfma_f32_16x16x32_bf16 v[122:125], a[132:135], v[222:225], v[122:125]
    v_cvt_pk_f16_f32 v121, v208, v209
    v_pk_fma_f16 v165, v121, v121, v165
    v_mfma_f32_16x16x32_bf16 v[122:125], a[136:139], v[226:229], v[122:125]
    v_mul_f32 v129, v194, v129
    v_cvt_pk_bf16_f32 v137, v128, v129
    v_mfma_f32_16x16x32_bf16 v[122:125], a[140:143], v[242:245], v[122:125]
    ds_write_b128 v3, v[134:137] offset:6144
    v_mfma_f32_16x16x32_bf16 v[206:209], a[0:3], v[182:185], 0
    v_mul_f32 v218, v194, v218
    v_mul_f32 v219, v194, v219
    v_mfma_f32_16x16x32_bf16 v[206:209], a[4:7], v[198:201], v[206:209]
    v_cvt_pk_bf16_f32 v254, v218, v219
    v_mul_f32 v220, v194, v220
    v_mfma_f32_16x16x32_bf16 v[206:209], a[8:11], v[210:213], v[206:209]
    v_cvt_pk_f16_f32 v196, v122, v123
    v_pk_fma_f16 v163, v196, v196, v163
    v_mfma_f32_16x16x32_bf16 v[206:209], a[12:15], v[222:225], v[206:209]
    v_cvt_pk_f16_f32 v197, v124, v125
    v_pk_fma_f16 v165, v197, v197, v165
    v_mfma_f32_16x16x32_bf16 v[206:209], a[16:19], v[226:229], v[206:209]
    v_mul_f32 v221, v194, v221
    v_cvt_pk_bf16_f32 v255, v220, v221
    v_mfma_f32_16x16x32_bf16 v[206:209], a[20:23], v[242:245], v[206:209]
    ds_write_b64 v4, v[254:255] offset:10240
    v_mfma_f32_16x16x32_bf16 v[174:177], a[24:27], v[182:185], 0
    v_xor_b32 v3, 65536, v3
    v_xor_b32 v4, 65536, v4
    v_mfma_f32_16x16x32_bf16 v[174:177], a[28:31], v[198:201], v[174:177]
    v_mfma_f32_16x16x32_bf16 v[174:177], a[32:35], v[210:213], v[174:177]
    v_mfma_f32_16x16x32_bf16 v[174:177], a[36:39], v[222:225], v[174:177]
    v_mfma_f32_16x16x32_bf16 v[174:177], a[40:43], v[226:229], v[174:177]
    v_cvt_pk_f16_f32 v206, v206, v207
    v_mfma_f32_16x16x32_bf16 v[174:177], a[44:47], v[242:245], v[174:177]
    v_mfma_f32_16x16x32_bf16 v[218:221], a[48:51], v[182:185], 0
    s_waitcnt lgkmcnt(0)
    v_mfma_f32_16x16x32_bf16 v[218:221], a[52:55], v[198:201], v[218:221]
    s_nop 0
    v_mfma_f32_16x16x32_bf16 v[218:221], a[56:59], v[210:213], v[218:221]
    s_barrier
    v_mfma_f32_16x16x32_bf16 v[218:221], a[60:63], v[222:225], v[218:221]
    s_nop 0
    v_mfma_f32_16x16x32_bf16 v[218:221], a[64:67], v[226:229], v[218:221]
    s_nop 0
    v_mfma_f32_16x16x32_bf16 v[218:221], a[68:71], v[242:245], v[218:221]
    v_mfma_f32_16x16x32_bf16 v[170:173], v[182:185], a[144:147], 0
    v_mfma_f32_16x16x32_bf16 v[170:173], v[198:201], a[148:151], v[170:173]
    v_mfma_f32_16x16x32_bf16 v[170:173], v[210:213], a[152:155], v[170:173]
    v_mfma_f32_16x16x32_bf16 v[170:173], v[222:225], a[156:159], v[170:173]
    v_mfma_f32_16x16x32_bf16 v[170:173], v[226:229], a[160:163], v[170:173]
    v_mfma_f32_16x16x32_bf16 v[170:173], v[242:245], a[164:167], v[170:173]
    s_cbranch_scc1 L_loop_fast1
    s_branch L_final_fast
.p2align 6
L_loop_fast2:
    v_mfma_f32_16x16x32_bf16 v[234:237], v[182:185], a[168:171], 0
    s_add_u32 s12, s42, s27
    ds_read_b128 v[230:233], v2 offset:18432
    ds_read_b128 v[238:241], v2 offset:19456
    v_mfma_f32_16x16x32_bf16 v[234:237], v[198:201], a[172:175], v[234:237]
    s_addc_u32 s13, s43, 0
    v_pk_mul_f16 v162, v206, v206
    v_cvt_pk_f16_f32 v207, v208, v209
    v_mfma_f32_16x16x32_bf16 v[234:237], v[210:213], a[176:179], v[234:237]
    s_sub_u32 s14, s36, s27
    ds_read_b128 v[134:137], v0 offset:26624
    v_pk_mul_f16 v164, v207, v207
    v_mfma_f32_16x16x32_bf16 v[234:237], v[222:225], a[180:183], v[234:237]
    s_cmp_ge_u32 s18, 2
    ds_read_b128 v[154:157], v1 offset:26624
    v_cvt_pk_f16_f32 v208, v174, v175
    v_mfma_f32_16x16x32_bf16 v[234:237], v[226:229], a[184:187], v[234:237]
    s_cselect_b32 s14, s14, 0
    ds_read_b128 v[130:133], v0 offset:26752
    v_pk_fma_f16 v162, v208, v208, v162
    v_mfma_f32_16x16x32_bf16 v[234:237], v[242:245], a[188:191], v[234:237]
    s_add_u32 s34, s18, 2
    ds_read_b128 v[122:125], v1 offset:26752
    v_cvt_pk_f16_f32 v209, v176, v177
    v_mfma_f32_16x16x32_bf16 v[114:117], v[182:185], a[192:195], 0
    s_add_u32 s8, s40, s23
    ds_read_b128 v[126:129], v0 offset:26880
    v_pk_fma_f16 v164, v209, v209, v164
    v_mfma_f32_16x16x32_bf16 v[114:117], v[198:201], a[196:199], v[114:117]
    s_addc_u32 s9, s41, 0
    ds_read_b128 v[166:169], v1 offset:26880
    v_cvt_pk_f16_f32 v194, v218, v219
    v_mfma_f32_16x16x32_bf16 v[114:117], v[210:213], a[200:203], v[114:117]
    s_waitcnt lgkmcnt(6)
    v_pk_fma_f16 v162, v194, v194, v162
    v_cvt_pk_f16_f32 v195, v220, v221
    v_mfma_f32_16x16x32_bf16 v[198:201], v[32:35], v[230:233], 0
    s_sub_u32 s10, s36, s23
    v_pk_fma_f16 v164, v195, v195, v164
    v_cvt_pk_bf16_f32 v174, v170, v171
    v_mfma_f32_16x16x32_bf16 v[198:201], v[32:35], v[238:241], v[198:201]
    s_waitcnt lgkmcnt(5)
    v_cvt_pk_bf16_f32 v175, v172, v173
    v_cvt_pk_bf16_f32 v182, v234, v235
    v_mfma_f32_16x16x32_f16 v[170:173], v[40:43], v[162:165], 0
    s_cmp_lt_u32 s34, s17
    v_cvt_pk_bf16_f32 v183, v236, v237
    s_cselect_b32 s10, s10, 0
    v_mfma_f32_16x16x32_bf16 v[114:117], v[222:225], a[204:207], v[114:117]
    s_add_u32 m0, s28, 0
    v_mul_f32 v255, 0x3baaaaab, v198
    v_mul_f32 v254, 0x3baaaaab, v199
    v_mfma_f32_16x16x32_bf16 v[114:117], v[226:229], a[208:211], v[114:117]
    s_mov_b32 s27, s26
    v_rsq_f32 v172, v170
    v_mfma_f32_16x16x32_bf16 v[114:117], v[242:245], a[212:215], v[114:117]
    s_mov_b32 s26, s25
    v_rsq_f32 v173, v171
    v_mfma_f32_16x16x32_bf16 v[162:165], a[72:75], v[134:137], 0
    s_waitcnt lgkmcnt(0)
    v_mul_f32 v172, s31, v172
    v_cvt_pk_f16_f32 v172, v172, v173
    v_mfma_f32_16x16x32_bf16 v[162:165], a[76:79], v[154:157], v[162:165]
    s_mov_b32 s25, s24
    v_cvt_pk_bf16_f32 v114, v114, v115
    v_cvt_pk_bf16_f32 v115, v116, v117
    v_mfma_f32_16x16x32_bf16 v[162:165], a[80:83], v[130:133], v[162:165]
    s_mov_b32 s24, s23
    v_pk_mul_f16 v118, v118, v172 op_sel:[0,1] op_sel_hi:[1,1]
    v_pk_mul_f16 v119, v119, v172 op_sel:[0,1] op_sel_hi:[1,1]
    v_mfma_f32_16x16x32_bf16 v[162:165], a[84:87], v[122:125], v[162:165]
    v_pk_mul_f16 v120, v120, v172 op_sel:[0,1] op_sel_hi:[1,1]
    v_pk_mul_f16 v121, v121, v172 op_sel:[0,1] op_sel_hi:[1,1]
    v_mfma_f32_16x16x32_bf16 v[162:165], a[88:91], v[126:129], v[162:165]
    v_pk_mul_f16 v196, v196, v172 op_sel:[0,1] op_sel_hi:[1,1]
    v_pk_mul_f16 v197, v197, v172 op_sel:[0,1] op_sel_hi:[1,1]
    v_mfma_f32_16x16x32_bf16 v[162:165], a[92:95], v[166:169], v[162:165]
    v_pk_mul_f16 v206, v206, v172 op_sel:[0,0] op_sel_hi:[1,0]
    v_pk_mul_f16 v207, v207, v172 op_sel:[0,0] op_sel_hi:[1,0]
    v_mfma_f32_16x16x32_bf16 v[210:213], a[96:99], v[134:137], 0
    v_pk_mul_f16 v208, v208, v172 op_sel:[0,0] op_sel_hi:[1,0]
    v_pk_mul_f16 v209, v209, v172 op_sel:[0,0] op_sel_hi:[1,0]
    v_mfma_f32_16x16x32_bf16 v[210:213], a[100:103], v[154:157], v[210:213]
    v_pk_mul_f16 v194, v194, v172 op_sel:[0,0] op_sel_hi:[1,0]
    v_pk_mul_f16 v195, v195, v172 op_sel:[0,0] op_sel_hi:[1,0]
    v_mfma_f32_16x16x32_bf16 v[210:213], a[104:107], v[130:133], v[210:213]
    v_min3_u32 v44, v44, v170, v171
    v_max3_u32 v45, v45, v170, v171
    v_mfma_f32_16x16x32_bf16 v[210:213], a[108:111], v[122:125], v[210:213]
    v_cvt_pk_f16_f32 v170, v162, v163
    v_pk_mul_f16 v163, v170, v170
    v_mfma_f32_16x16x32_bf16 v[210:213], a[112:115], v[126:129], v[210:213]
    v_cvt_pk_f16_f32 v171, v164, v165
    v_pk_mul_f16 v165, v171, v171
    v_mfma_f32_16x16x32_bf16 v[210:213], a[116:119], v[166:169], v[210:213]
    v_rsq_f32 v255, v255
    v_mfma_f32_16x16x32_bf16 v[214:217], a[120:123], v[134:137], 0
    v_rsq_f32 v254, v254
    v_mfma_f32_16x16x32_bf16 v[214:217], a[124:127], v[154:157], v[214:217]
    v_mul_f32 v142, v254, v142
    v_mul_f32 v143, v254, v143
    v_mfma_f32_16x16x32_bf16 v[214:217], a[128:131], v[130:133], v[214:217]
    v_cvt_pk_bf16_f32 v142, v142, v143
    v_cvt_pk_f16_f32 v172, v210, v211
    v_mfma_f32_16x16x32_bf16 v[214:217], a[132:135], v[122:125], v[214:217]
    v_pk_fma_f16 v163, v172, v172, v163
    v_cvt_pk_f16_f32 v173, v212, v213
    v_mfma_f32_16x16x32_bf16 v[214:217], a[136:139], v[126:129], v[214:217]
    v_pk_fma_f16 v165, v173, v173, v165
    v_mul_f32 v144, v254, v144
    v_mfma_f32_16x16x32_bf16 v[214:217], a[140:143], v[166:169], v[214:217]
    v_mul_f32 v145, v254, v145
    v_cvt_pk_bf16_f32 v143, v144, v145
    v_mfma_f32_16x16x32_bf16 v[210:213], a[0:3], v[134:137], 0
    v_mul_f32 v158, v254, v158
    v_mul_f32 v159, v254, v159
    v_mfma_f32_16x16x32_bf16 v[210:213], a[4:7], v[154:157], v[210:213]
    v_cvt_pk_bf16_f32 v144, v158, v159
    v_mul_f32 v160, v254, v160
    v_mfma_f32_16x16x32_bf16 v[210:213], a[8:11], v[130:133], v[210:213]
    v_cvt_pk_f16_f32 v220, v214, v215
    v_pk_fma_f16 v163, v220, v220, v163
    v_mfma_f32_16x16x32_bf16 v[210:213], a[12:15], v[122:125], v[210:213]
    v_cvt_pk_f16_f32 v221, v216, v217
    v_pk_fma_f16 v165, v221, v221, v165
    v_mfma_f32_16x16x32_bf16 v[210:213], a[16:19], v[126:129], v[210:213]
    v_mul_f32 v161, v254, v161
    v_cvt_pk_bf16_f32 v145, v160, v161
    v_mfma_f32_16x16x32_bf16 v[210:213], a[20:23], v[166:169], v[210:213]
    buffer_store_dwordx4 v[142:145], v16, s[12:15], 0 offen nt
    v_mul_f32 v178, v254, v178
    v_mul_f32 v179, v254, v179
    v_cvt_pk_bf16_f32 v198, v178, v179
    v_mul_f32 v180, v254, v180
    v_mfma_f32_16x16x32_bf16 v[142:145], a[24:27], v[134:137], 0
    v_mul_f32 v181, v254, v181
    v_cvt_pk_bf16_f32 v199, v180, v181
    v_mfma_f32_16x16x32_bf16 v[142:145], a[28:31], v[154:157], v[142:145]
    v_cvt_pk_f16_f32 v158, v210, v211
    v_pk_mul_f16 v162, v158, v158
    v_mfma_f32_16x16x32_bf16 v[142:145], a[32:35], v[130:133], v[142:145]
    v_cvt_pk_f16_f32 v159, v212, v213
    v_pk_mul_f16 v164, v159, v159
    v_mfma_f32_16x16x32_bf16 v[142:145], a[36:39], v[122:125], v[142:145]
    v_mul_f32 v254, 0x3baaaaab, v200
    v_mul_f32 v150, v255, v150
    v_mfma_f32_16x16x32_bf16 v[142:145], a[40:43], v[126:129], v[142:145]
    v_rsq_f32 v254, v254
    v_mfma_f32_16x16x32_bf16 v[142:145], a[44:47], v[166:169], v[142:145]
    v_mul_f32 v146, v254, v146
    v_mul_f32 v147, v254, v147
    v_mfma_f32_16x16x32_bf16 v[178:181], a[48:51], v[134:137], 0
    v_cvt_pk_bf16_f32 v146, v146, v147
    v_mul_f32 v148, v254, v148
    v_mfma_f32_16x16x32_bf16 v[178:181], a[52:55], v[154:157], v[178:181]
    v_mul_f32 v149, v254, v149
    v_cvt_pk_bf16_f32 v147, v148, v149
    v_mfma_f32_16x16x32_bf16 v[178:181], a[56:59], v[130:133], v[178:181]
    v_mul_f32 v138, v254, v138
    v_mul_f32 v139, v254, v139
    v_mfma_f32_16x16x32_bf16 v[178:181], a[60:63], v[122:125], v[178:181]
    v_cvt_pk_bf16_f32 v148, v138, v139
    v_mul_f32 v140, v254, v140
    v_mfma_f32_16x16x32_bf16 v[178:181], a[64:67], v[126:129], v[178:181]
    v_mul_f32 v141, v254, v141
    v_cvt_pk_bf16_f32 v149, v140, v141
    v_mfma_f32_16x16x32_bf16 v[178:181], a[68:71], v[166:169], v[178:181]
    v_mul_f32 v186, v254, v186
    v_mul_f32 v187, v254, v187
    v_mfma_f32_16x16x32_bf16 v[138:141], v[134:137], a[144:147], 0
    v_cvt_pk_bf16_f32 v200, v186, v187
    v_mul_f32 v188, v254, v188
    v_mfma_f32_16x16x32_bf16 v[138:141], v[154:157], a[148:151], v[138:141]
    v_mul_f32 v189, v254, v189
    v_cvt_pk_bf16_f32 v201, v188, v189
    v_mfma_f32_16x16x32_bf16 v[138:141], v[130:133], a[152:155], v[138:141]
    v_cvt_pk_f16_f32 v160, v142, v143
    v_pk_fma_f16 v162, v160, v160, v162
    v_mfma_f32_16x16x32_bf16 v[138:141], v[122:125], a[156:159], v[138:141]
    v_cvt_pk_f16_f32 v161, v144, v145
    v_pk_fma_f16 v164, v161, v161, v164
    v_mfma_f32_16x16x32_bf16 v[138:141], v[126:129], a[160:163], v[138:141]
    buffer_store_dwordx4 v[146:149], v17, s[12:15], 0 offen nt
    v_cvt_pk_f16_f32 v218, v178, v179
    v_pk_fma_f16 v162, v218, v218, v162
    v_cvt_pk_f16_f32 v219, v180, v181
    v_pk_fma_f16 v164, v219, v219, v164
    v_mfma_f32_16x16x32_bf16 v[138:141], v[166:169], a[164:167], v[138:141]
    v_mul_f32 v151, v255, v151
    v_cvt_pk_bf16_f32 v150, v150, v151
    v_mfma_f32_16x16x32_f16 v[142:145], v[40:43], v[162:165], 0
    v_mul_f32 v152, v255, v152
    v_mul_f32 v153, v255, v153
    v_mfma_f32_16x16x32_bf16 v[178:181], v[134:137], a[168:171], 0
    v_cvt_pk_bf16_f32 v151, v152, v153
    v_mul_f32 v190, v255, v190
    v_mfma_f32_16x16x32_bf16 v[178:181], v[154:157], a[172:175], v[178:181]
    v_cvt_pk_bf16_f32 v176, v138, v139
    v_cvt_pk_bf16_f32 v177, v140, v141
    v_mfma_f32_16x16x32_bf16 v[178:181], v[130:133], a[176:179], v[178:181]
    ds_read_b128 v[146:149], v0 offset:32768
    v_min3_u32 v44, v44, v142, v143
    v_mfma_f32_16x16x32_bf16 v[178:181], v[122:125], a[180:183], v[178:181]
    ds_read_b128 v[138:141], v1 offset:32768
    v_max3_u32 v45, v45, v142, v143
    v_mfma_f32_16x16x32_bf16 v[178:181], v[126:129], a[184:187], v[178:181]
    ds_read_b128 v[186:189], v0 offset:32896
    v_mul_f32 v191, v255, v191
    v_mfma_f32_16x16x32_bf16 v[178:181], v[166:169], a[188:191], v[178:181]
    ds_read_b128 v[162:165], v1 offset:32896
    v_cvt_pk_bf16_f32 v152, v190, v191
    v_mfma_f32_16x16x32_bf16 v[210:213], v[134:137], a[192:195], 0
    ds_read_b128 v[134:137], v0 offset:33024
    v_mul_f32 v192, v255, v192
    v_mfma_f32_16x16x32_bf16 v[210:213], v[154:157], a[196:199], v[210:213]
    ds_read_b128 v[154:157], v1 offset:33024
    v_mul_f32 v193, v255, v193
    v_mfma_f32_16x16x32_bf16 v[210:213], v[130:133], a[200:203], v[210:213]
    v_rsq_f32 v144, v142
    v_mfma_f32_16x16x32_bf16 v[210:213], v[122:125], a[204:207], v[210:213]
    v_rsq_f32 v145, v143
    v_mfma_f32_16x16x32_bf16 v[210:213], v[126:129], a[208:211], v[210:213]
    s_waitcnt lgkmcnt(5)
    v_mul_f32 v144, s31, v144
    v_cvt_pk_f16_f32 v144, v144, v145
    v_mfma_f32_16x16x32_bf16 v[210:213], v[166:169], a[212:215], v[210:213]
    s_waitcnt lgkmcnt(4)
    v_cvt_pk_bf16_f32 v184, v178, v179
    v_cvt_pk_bf16_f32 v185, v180, v181
    v_mfma_f32_16x16x32_bf16 v[178:181], a[72:75], v[146:149], 0
    s_waitcnt lgkmcnt(3)
    v_pk_mul_f16 v170, v170, v144 op_sel:[0,1] op_sel_hi:[1,1]
    v_pk_mul_f16 v171, v171, v144 op_sel:[0,1] op_sel_hi:[1,1]
    v_mfma_f32_16x16x32_bf16 v[178:181], a[76:79], v[138:141], v[178:181]
    s_waitcnt lgkmcnt(2)
    v_cvt_pk_bf16_f32 v116, v210, v211
    v_cvt_pk_bf16_f32 v117, v212, v213
    v_mfma_f32_16x16x32_bf16 v[178:181], a[80:83], v[186:189], v[178:181]
    s_waitcnt lgkmcnt(1)
    buffer_store_dwordx2 v[200:201], v20, s[12:15], 0 offen nt
    v_pk_mul_f16 v172, v172, v144 op_sel:[0,1] op_sel_hi:[1,1]
    v_pk_mul_f16 v173, v173, v144 op_sel:[0,1] op_sel_hi:[1,1]
    v_mfma_f32_16x16x32_bf16 v[178:181], a[84:87], v[162:165], v[178:181]
    s_waitcnt lgkmcnt(0)
    v_pk_mul_f16 v220, v220, v144 op_sel:[0,1] op_sel_hi:[1,1]
    v_pk_mul_f16 v221, v221, v144 op_sel:[0,1] op_sel_hi:[1,1]
    v_mfma_f32_16x16x32_bf16 v[178:181], a[88:91], v[134:137], v[178:181]
    v_pk_mul_f16 v158, v158, v144 op_sel:[0,0] op_sel_hi:[1,0]
    v_pk_mul_f16 v159, v159, v144 op_sel:[0,0] op_sel_hi:[1,0]
    v_mfma_f32_16x16x32_bf16 v[178:181], a[92:95], v[154:157], v[178:181]
    v_pk_mul_f16 v160, v160, v144 op_sel:[0,0] op_sel_hi:[1,0]
    v_pk_mul_f16 v161, v161, v144 op_sel:[0,0] op_sel_hi:[1,0]
    v_mfma_f32_16x16x32_bf16 v[130:133], a[96:99], v[146:149], 0
    v_pk_mul_f16 v218, v218, v144 op_sel:[0,0] op_sel_hi:[1,0]
    v_pk_mul_f16 v219, v219, v144 op_sel:[0,0] op_sel_hi:[1,0]
    v_mfma_f32_16x16x32_bf16 v[130:133], a[100:103], v[138:141], v[130:133]
    s_waitcnt vmcnt(3)
    v_cvt_pk_bf16_f32 v153, v192, v193
    v_cvt_pk_f16_f32 v142, v178, v179
    v_mfma_f32_16x16x32_bf16 v[130:133], a[104:107], v[186:189], v[130:133]
    s_nop 0
    v_pk_mul_f16 v191, v142, v142
    v_cvt_pk_f16_f32 v143, v180, v181
    v_mfma_f32_16x16x32_bf16 v[130:133], a[108:111], v[162:165], v[130:133]
    s_nop 0
    v_pk_mul_f16 v193, v143, v143
    v_mul_f32 v202, v255, v202
    v_mfma_f32_16x16x32_bf16 v[130:133], a[112:115], v[134:137], v[130:133]
    s_barrier
    v_mul_f32 v203, v255, v203
    v_cvt_pk_bf16_f32 v254, v202, v203
    v_mfma_f32_16x16x32_bf16 v[130:133], a[116:119], v[154:157], v[130:133]
    s_nop 0
    v_mul_f32 v204, v255, v204
    v_mul_f32 v205, v255, v205
    v_mfma_f32_16x16x32_bf16 v[178:181], a[120:123], v[146:149], 0
    v_cvt_pk_bf16_f32 v255, v204, v205
    v_xor_b32 v0, 65536, v0
    v_mfma_f32_16x16x32_bf16 v[178:181], a[124:127], v[138:141], v[178:181]
    v_xor_b32 v1, 65536, v1
    v_cvt_pk_f16_f32 v144, v130, v131
    v_mfma_f32_16x16x32_bf16 v[178:181], a[128:131], v[186:189], v[178:181]
    v_pk_fma_f16 v191, v144, v144, v191
    v_cvt_pk_f16_f32 v145, v132, v133
    v_mfma_f32_16x16x32_bf16 v[178:181], a[132:135], v[162:165], v[178:181]
    v_pk_fma_f16 v193, v145, v145, v193
    v_mfma_f32_16x16x32_bf16 v[178:181], a[136:139], v[134:137], v[178:181]
    v_mfma_f32_16x16x32_bf16 v[178:181], a[140:143], v[154:157], v[178:181]
    v_mfma_f32_16x16x32_bf16 v[202:205], a[0:3], v[146:149], 0
    v_mfma_f32_16x16x32_bf16 v[202:205], a[4:7], v[138:141], v[202:205]
    buffer_load_dwordx4 v10, s[8:11], 0 offen nt lds
    s_add_u32 m0, s28, 4096
    v_mfma_f32_16x16x32_bf16 v[202:205], a[8:11], v[186:189], v[202:205]
    v_mfma_f32_16x16x32_bf16 v[202:205], a[12:15], v[162:165], v[202:205]
    v_mfma_f32_16x16x32_bf16 v[202:205], a[16:19], v[134:137], v[202:205]
    v_mfma_f32_16x16x32_bf16 v[202:205], a[20:23], v[154:157], v[202:205]
    v_cvt_pk_f16_f32 v124, v178, v179
    v_pk_fma_f16 v191, v124, v124, v191
    v_mfma_f32_16x16x32_bf16 v[130:133], a[24:27], v[146:149], 0
    buffer_load_dwordx4 v11, s[8:11], 0 offen nt lds
    v_cvt_pk_f16_f32 v125, v180, v181
    v_mfma_f32_16x16x32_bf16 v[130:133], a[28:31], v[138:141], v[130:133]
    s_add_u32 m0, s28, 8192
    v_pk_fma_f16 v193, v125, v125, v193
    v_cvt_pk_f16_f32 v178, v202, v203
    v_mfma_f32_16x16x32_bf16 v[130:133], a[32:35], v[186:189], v[130:133]
    v_pk_mul_f16 v190, v178, v178
    v_cvt_pk_f16_f32 v179, v204, v205
    v_mfma_f32_16x16x32_bf16 v[130:133], a[36:39], v[162:165], v[130:133]
    v_pk_mul_f16 v192, v179, v179
    v_mfma_f32_16x16x32_bf16 v[130:133], a[40:43], v[134:137], v[130:133]
    v_mfma_f32_16x16x32_bf16 v[130:133], a[44:47], v[154:157], v[130:133]
    buffer_load_dwordx4 v12, s[8:11], 0 offen nt lds
    s_add_u32 m0, s28, 12288
    v_mfma_f32_16x16x32_bf16 v[202:205], a[48:51], v[146:149], 0
    s_xor_b32 s28, s28, 65536
    v_mfma_f32_16x16x32_bf16 v[202:205], a[52:55], v[138:141], v[202:205]
    ds_read_b128 v[166:169], v5 offset:0
    ds_read_b128 v[126:129], v5 offset:16
    v_mfma_f32_16x16x32_bf16 v[202:205], a[56:59], v[186:189], v[202:205]
    ds_read_b128 v[210:213], v5 offset:48
    ds_read_b32 v200, v6 offset:192
    v_mfma_f32_16x16x32_bf16 v[202:205], a[60:63], v[162:165], v[202:205]
    v_cvt_pk_f16_f32 v180, v130, v131
    v_pk_fma_f16 v190, v180, v180, v190
    v_mfma_f32_16x16x32_bf16 v[202:205], a[64:67], v[134:137], v[202:205]
    buffer_load_dwordx4 v13, s[8:11], 0 offen nt lds
    v_cvt_pk_f16_f32 v181, v132, v133
    v_mfma_f32_16x16x32_bf16 v[202:205], a[68:71], v[154:157], v[202:205]
    s_mov_b32 m0, s29
    v_pk_fma_f16 v192, v181, v181, v192
    v_add_u32 v5, 336, v5
    v_mfma_f32_16x16x32_bf16 v[130:133], v[146:149], a[144:147], 0
    s_xor_b32 s29, s29, s30
    s_add_u32 s19, s19, s20
    s_add_u32 s23, s23, s21
    v_mfma_f32_16x16x32_bf16 v[130:133], v[138:141], a[148:151], v[130:133]
    s_cmp_ge_u32 s19, 72
    v_cvt_pk_f16_f32 v122, v202, v203
    v_pk_fma_f16 v190, v122, v122, v190
    v_mfma_f32_16x16x32_bf16 v[130:133], v[186:189], a[152:155], v[130:133]
    s_cselect_b32 s34, 72, 0
    v_cvt_pk_f16_f32 v123, v204, v205
    v_pk_fma_f16 v192, v123, v123, v192
    v_mfma_f32_16x16x32_bf16 v[130:133], v[162:165], a[156:159], v[130:133]
    s_waitcnt lgkmcnt(2)
    buffer_store_dwordx2 v[198:199], v19, s[12:15], 0 offen nt
    s_cselect_b32 s35, s22, 0
    s_sub_u32 s19, s19, s34
    v_mfma_f32_16x16x32_f16 v[202:205], v[40:43], v[190:193], 0
    s_add_u32 s23, s23, s35
    s_add_u32 s18, s18, 1
    s_cmp_lt_u32 s18, s45
    v_mfma_f32_16x16x32_f16 v[214:217], v[166:169], v[158:161], v[24:27]
    s_waitcnt lgkmcnt(0)
    v_mfma_f32_16x16x32_f16 v[214:217], v[126:129], v[170:173], v[214:217]
    v_mfma_f32_16x16x32_f16 v[214:217], v[210:213], v[218:221], v[214:217]
    v_mfma_f32_16x16x32_f16 v[190:193], v[166:169], v[206:209], v[22:25]
    v_rsq_f32 v204, v202
    v_mfma_f32_16x16x32_f16 v[190:193], v[126:129], v[118:121], v[190:193]
    v_rsq_f32 v205, v203
    v_mfma_f32_16x16x32_f16 v[190:193], v[210:213], v[194:197], v[190:193]
    v_mul_f32 v204, s31, v204
    v_cvt_pk_f16_f32 v204, v204, v205
    v_mfma_f32_16x16x32_bf16 v[130:133], v[134:137], a[160:163], v[130:133]
    v_pk_mul_f16 v142, v142, v204 op_sel:[0,1] op_sel_hi:[1,1]
    v_pk_mul_f16 v143, v143, v204 op_sel:[0,1] op_sel_hi:[1,1]
    v_mfma_f32_16x16x32_bf16 v[130:133], v[154:157], a[164:167], v[130:133]
    v_pk_mul_f16 v144, v144, v204 op_sel:[0,1] op_sel_hi:[1,1]
    v_pk_mul_f16 v145, v145, v204 op_sel:[0,1] op_sel_hi:[1,1]
    v_mfma_f32_16x16x32_bf16 v[222:225], v[146:149], a[168:171], 0
    v_mov_b32_dpp v200, v191 quad_perm:[0,1,2,3] row_mask:0x1 bank_mask:0xf
    v_mov_b32_dpp v200, v215 quad_perm:[0,1,2,3] row_mask:0x2 bank_mask:0xf
    v_mfma_f32_16x16x32_bf16 v[222:225], v[138:141], a[172:175], v[222:225]
    v_pk_mul_f16 v124, v124, v204 op_sel:[0,1] op_sel_hi:[1,1]
    v_pk_mul_f16 v125, v125, v204 op_sel:[0,1] op_sel_hi:[1,1]
    v_mfma_f32_16x16x32_bf16 v[222:225], v[186:189], a[176:179], v[222:225]
    v_cvt_pk_bf16_f32 v130, v130, v131
    v_cvt_pk_bf16_f32 v131, v132, v133
    v_mfma_f32_16x16x32_bf16 v[222:225], v[162:165], a[180:183], v[222:225]
    v_pk_mul_f16 v178, v178, v204 op_sel:[0,0] op_sel_hi:[1,0]
    v_pk_mul_f16 v179, v179, v204 op_sel:[0,0] op_sel_hi:[1,0]
    v_mfma_f32_16x16x32_f16 v[226:229], v[118:121], v[206:209], v[46:49]
    v_pk_mul_f16 v180, v180, v204 op_sel:[0,0] op_sel_hi:[1,0]
    v_pk_mul_f16 v181, v181, v204 op_sel:[0,0] op_sel_hi:[1,0]
    v_mfma_f32_16x16x32_f16 v[230:233], v[170:173], v[206:209], v[50:53]
    v_pk_mul_f16 v122, v122, v204 op_sel:[0,0] op_sel_hi:[1,0]
    v_pk_mul_f16 v123, v123, v204 op_sel:[0,0] op_sel_hi:[1,0]
    v_mfma_f32_16x16x32_f16 v[234:237], v[142:145], v[206:209], v[54:57]
    v_min3_u32 v44, v44, v202, v203
    v_exp_f32 v214, v214
    v_mfma_f32_16x16x16_f16 v[226:229], v[196:197], v[194:195], v[226:229]
    v_max3_u32 v45, v45, v202, v203
    v_exp_f32 v190, v190
    v_mfma_f32_16x16x16_f16 v[230:233], v[220:221], v[194:195], v[230:233]
    v_cvt_pk_bf16_f32 v39, v190, 0
    v_mfma_f32_16x16x16_f16 v[234:237], v[124:125], v[194:195], v[234:237]
    buffer_store_dwordx4 v[150:153], v15, s[12:15], 0 offen nt
    v_mfma_f32_16x16x32_bf16 v[222:225], v[134:137], a[184:187], v[222:225]
    v_mfma_f32_16x16x32_bf16 v[222:225], v[154:157], a[188:191], v[222:225]
    ds_read_b128 v[206:209], v2 offset:0
    v_mfma_f32_16x16x32_bf16 v[150:153], v[146:149], a[192:195], 0
    ds_read_b128 v[146:149], v2 offset:1024
    v_mfma_f32_16x16x32_bf16 v[150:153], v[138:141], a[196:199], v[150:153]
    ds_read_b128 v[138:141], v2 offset:2048
    v_mfma_f32_16x16x32_bf16 v[150:153], v[186:189], a[200:203], v[150:153]
    ds_read_b128 v[186:189], v2 offset:3072
    v_mfma_f32_16x16x32_bf16 v[150:153], v[162:165], a[204:207], v[150:153]
    ds_read_b128 v[162:165], v2 offset:4096
    v_cvt_pk_bf16_f32 v222, v222, v223
    v_mfma_f32_16x16x32_bf16 v[150:153], v[134:137], a[208:211], v[150:153]
    ds_read_b128 v[134:137], v2 offset:5120
    v_cvt_pk_bf16_f32 v223, v224, v225
    v_mfma_f32_16x16x32_bf16 v[150:153], v[154:157], a[212:215], v[150:153]
    ds_read2_b32 v[132:133], v6 offset0:0 offset1:0
    ds_read2_b32 v[224:225], v6 offset0:16 offset1:16
    v_mfma_f32_16x16x32_f16 v[154:157], v[166:169], v[178:181], v[26:29]
    ds_read2_b32 v[168:169], v6 offset0:32 offset1:32
    v_add_u32 v6, 272, v6
    v_mfma_f32_16x16x32_f16 v[154:157], v[126:129], v[142:145], v[154:157]
    s_waitcnt lgkmcnt(8)
    v_exp_f32 v226, v226
    v_mfma_f32_16x16x32_f16 v[154:157], v[210:213], v[122:125], v[154:157]
    s_waitcnt lgkmcnt(7)
    v_cvt_pk_bf16_f32 v166, v150, v151
    v_cvt_pk_bf16_f32 v167, v152, v153
    v_mfma_f32_16x16x32_bf16 v[150:153], a[216:219], v[206:209], 0
    s_waitcnt lgkmcnt(6)
    v_exp_f32 v227, v227
    v_mfma_f32_16x16x32_bf16 v[150:153], a[220:223], v[146:149], v[150:153]
    s_waitcnt lgkmcnt(5)
    v_exp_f32 v154, v154
    v_mfma_f32_16x16x32_bf16 v[150:153], a[224:227], v[138:141], v[150:153]
    s_waitcnt lgkmcnt(4)
    v_mov_b32_dpp v200, v155 quad_perm:[0,1,2,3] row_mask:0x4 bank_mask:0xf
    v_cvt_pk_bf16_f32 v126, v226, v227
    v_mfma_f32_16x16x32_bf16 v[150:153], a[228:231], v[186:189], v[150:153]
    s_waitcnt lgkmcnt(3)
    v_exp_f32 v200, v200
    v_mfma_f32_16x16x32_bf16 v[150:153], a[232:235], v[162:165], v[150:153]
    s_waitcnt lgkmcnt(1)
    v_exp_f32 v228, v228
    v_mfma_f32_16x16x32_bf16 v[150:153], a[236:239], v[134:137], v[150:153]
    s_waitcnt lgkmcnt(0)
    buffer_store_dwordx2 v[254:255], v18, s[12:15], 0 offen nt
    v_exp_f32 v229, v229
    v_mfma_f32_16x16x32_bf16 v[190:193], a[240:243], v[206:209], 0
    v_cvt_pk_bf16_f32 v200, v200, v200
    v_cvt_pk_bf16_f32 v127, v228, v229
    v_mfma_f32_16x16x32_bf16 v[190:193], a[244:247], v[146:149], v[190:193]
    ds_write_b16 v8, v200
    v_mfma_f32_16x16x32_bf16 v[190:193], a[248:251], v[138:141], v[190:193]
    v_exp_f32 v230, v230
    v_mfma_f32_16x16x32_bf16 v[190:193], a[252:255], v[186:189], v[190:193]
    ds_read_b128 v[198:201], v2 offset:6144
    ds_read_b128 v[210:213], v9
    v_mfma_f32_16x16x32_bf16 v[190:193], v[82:85], v[162:165], v[190:193]
    ds_read_b128 v[226:229], v2 offset:7168
    ds_read_b128 v[238:241], v9 offset:64
    v_mfma_f32_16x16x32_bf16 v[190:193], v[86:89], v[134:137], v[190:193]
    v_exp_f32 v231, v231
    v_mfma_f32_16x16x32_bf16 v[202:205], v[90:93], v[206:209], 0
    ds_read_b128 v[206:209], v2 offset:8192
    ds_read_b128 v[242:245], v2 offset:9216
    v_mfma_f32_16x16x32_bf16 v[202:205], v[94:97], v[146:149], v[202:205]
    v_cvt_pk_bf16_f32 v128, v230, v231
    v_fma_f32 v254, v150, v150, s33
    v_mfma_f32_16x16x32_bf16 v[202:205], v[98:101], v[138:141], v[202:205]
    ds_read_b128 v[146:149], v2 offset:10240
    ds_read_b128 v[138:141], v2 offset:11264
    v_mfma_f32_16x16x32_bf16 v[202:205], v[102:105], v[186:189], v[202:205]
    v_exp_f32 v232, v232
    v_mfma_f32_16x16x32_bf16 v[202:205], v[106:109], v[162:165], v[202:205]
    v_exp_f32 v233, v233
    v_mfma_f32_16x16x32_bf16 v[202:205], v[110:113], v[134:137], v[202:205]
    s_waitcnt lgkmcnt(6)
    v_cvt_pk_bf16_f32 v129, v232, v233
    v_fmac_f32 v254, v151, v151
    v_mfma_f32_16x16x32_bf16 v[186:189], v[210:213], v[28:31], 0
    s_waitcnt lgkmcnt(4)
    v_exp_f32 v234, v234
    v_mfma_f32_16x16x32_bf16 v[186:189], v[238:241], v[28:31], v[186:189]
    v_exp_f32 v235, v235
    v_mfma_f32_16x16x32_f16 v[134:137], v[118:121], v[158:161], v[58:61]
    s_waitcnt lgkmcnt(2)
    v_cvt_pk_bf16_f32 v36, v234, v235
    v_fmac_f32 v254, v152, v152
    v_mfma_f32_16x16x32_f16 v[162:165], v[170:173], v[158:161], v[62:65]
    v_exp_f32 v236, v236
    v_mfma_f32_16x16x32_f16 v[230:233], v[142:145], v[158:161], v[66:69]
    s_waitcnt lgkmcnt(0)
    buffer_load_dwordx4 v14, s[8:11], 0 offen nt lds
    v_rcp_f32 v186, v186
    v_mfma_f32_16x16x16_f16 v[134:137], v[196:197], v[218:219], v[134:137]
    v_exp_f32 v237, v237
    v_fmac_f32 v254, v153, v153
    v_mfma_f32_16x16x16_f16 v[162:165], v[220:221], v[218:219], v[162:165]
    v_cvt_pk_bf16_f32 v37, v236, v237
    v_fmac_f32 v254, v190, v190
    v_fmac_f32 v254, v191, v191
    v_mfma_f32_16x16x16_f16 v[230:233], v[124:125], v[218:219], v[230:233]
    v_fmac_f32 v254, v192, v192
    v_exp_f32 v134, v134
    v_fmac_f32 v254, v193, v193
    v_mfma_f32_16x16x32_bf16 v[158:161], v[210:213], v[174:177], 0
    v_exp_f32 v135, v135
    v_mfma_f32_16x16x32_bf16 v[158:161], v[238:241], v[130:133], v[158:161]
    v_cvt_pk_bf16_f32 v134, v134, v135
    v_fmac_f32 v254, v202, v202
    v_mfma_f32_16x16x32_bf16 v[234:237], v[210:213], v[182:185], 0
    v_exp_f32 v136, v136
    v_mfma_f32_16x16x32_bf16 v[234:237], v[238:241], v[222:225], v[234:237]
    v_exp_f32 v137, v137
    v_mfma_f32_16x16x32_bf16 v[246:249], v[210:213], v[114:117], 0
    v_cvt_pk_bf16_f32 v135, v136, v137
    v_mul_f32 v158, v158, v186
    v_mfma_f32_16x16x32_bf16 v[246:249], v[238:241], v[166:169], v[246:249]
    v_exp_f32 v162, v162
    v_mfma_f32_16x16x32_bf16 v[210:213], v[28:31], v[36:39], 0
    v_exp_f32 v163, v163
    v_mfma_f32_16x16x32_bf16 v[210:213], v[28:31], v[126:129], v[210:213]
    v_cvt_pk_bf16_f32 v136, v162, v163
    v_mul_f32_dpp v158, v234, v186 quad_perm:[0,1,2,3] row_mask:0x2 bank_mask:0xf
    v_mfma_f32_16x16x32_bf16 v[234:237], v[130:133], v[36:39], 0
    v_exp_f32 v164, v164
    v_mfma_f32_16x16x32_bf16 v[234:237], v[174:177], v[126:129], v[234:237]
    v_exp_f32 v165, v165
    v_mfma_f32_16x16x32_bf16 v[238:241], v[222:225], v[36:39], 0
    v_cvt_pk_bf16_f32 v137, v164, v165
    v_mul_f32_dpp v158, v246, v186 quad_perm:[0,1,2,3] row_mask:0x4 bank_mask:0xf
    v_mfma_f32_16x16x32_bf16 v[238:241], v[182:185], v[126:129], v[238:241]
    v_exp_f32 v230, v230
    v_mfma_f32_16x16x32_bf16 v[186:189], v[166:169], v[36:39], 0
    v_exp_f32 v231, v231
    v_mfma_f32_16x16x32_bf16 v[186:189], v[114:117], v[126:129], v[186:189]
    v_cvt_pk_bf16_f32 v36, v230, v231
    v_cvt_pk_bf16_f32 v39, v214, 0
    v_mfma_f32_16x16x32_f16 v[162:165], v[118:121], v[178:181], v[70:73]
    v_exp_f32 v232, v232
    v_mfma_f32_16x16x32_f16 v[118:121], v[170:173], v[178:181], v[74:77]
    v_exp_f32 v233, v233
    v_mfma_f32_16x16x32_f16 v[170:173], v[142:145], v[178:181], v[78:81]
    v_cvt_pk_bf16_f32 v37, v232, v233
    v_cvt_pk_bf16_f32 v158, v158, v158
    v_fmac_f32 v254, v203, v203
    v_mfma_f32_16x16x16_f16 v[162:165], v[196:197], v[122:123], v[162:165]
    v_rcp_f32 v210, v210
    v_fmac_f32 v254, v204, v204
    v_mfma_f32_16x16x16_f16 v[118:121], v[220:221], v[122:123], v[118:121]
    v_mul_f32 v234, v210, v234
    v_mul_f32 v235, v210, v235
    v_cvt_pk_bf16_f32 v178, v234, v235
    v_mfma_f32_16x16x16_f16 v[170:173], v[124:125], v[122:123], v[170:173]
    v_mul_f32 v236, v210, v236
    v_exp_f32 v162, v162
    v_mul_f32 v237, v210, v237
    v_mfma_f32_16x16x32_bf16 v[194:197], v[28:31], v[36:39], 0
    ds_write_b16 v7, v158
    v_mfma_f32_16x16x32_bf16 v[194:197], v[28:31], v[134:137], v[194:197]
    v_exp_f32 v163, v163
    v_mfma_f32_16x16x32_bf16 v[122:125], v[130:133], v[36:39], 0
    v_cvt_pk_bf16_f32 v162, v162, v163
    v_cvt_pk_bf16_f32 v179, v236, v237
    v_mfma_f32_16x16x32_bf16 v[122:125], v[174:177], v[134:137], v[122:125]
    v_exp_f32 v164, v164
    v_mfma_f32_16x16x32_bf16 v[126:129], v[222:225], v[36:39], 0
    v_exp_f32 v165, v165
    v_mfma_f32_16x16x32_bf16 v[126:129], v[182:185], v[134:137], v[126:129]
    v_cvt_pk_bf16_f32 v163, v164, v165
    v_mul_f32 v238, v210, v238
    v_mfma_f32_16x16x32_bf16 v[218:221], v[166:169], v[36:39], 0
    v_exp_f32 v118, v118
    v_mfma_f32_16x16x32_bf16 v[218:221], v[114:117], v[134:137], v[218:221]
    v_exp_f32 v119, v119
    v_mfma_f32_16x16x32_bf16 v[142:145], a[216:219], v[198:201], 0
    v_cvt_pk_bf16_f32 v164, v118, v119
    v_cvt_pk_bf16_f32 v39, v154, 0
    v_mfma_f32_16x16x32_bf16 v[142:145], a[220:223], v[226:229], v[142:145]
    v_exp_f32 v120, v120
    v_mfma_f32_16x16x32_bf16 v[142:145], a[224:227], v[206:209], v[142:145]
    v_exp_f32 v121, v121
    v_mfma_f32_16x16x32_bf16 v[142:145], a[228:231], v[242:245], v[142:145]
    v_cvt_pk_bf16_f32 v165, v120, v121
    v_mul_f32 v239, v210, v239
    v_mfma_f32_16x16x32_bf16 v[142:145], a[232:235], v[146:149], v[142:145]
    v_exp_f32 v170, v170
    v_mfma_f32_16x16x32_bf16 v[142:145], a[236:239], v[138:141], v[142:145]
    v_exp_f32 v171, v171
    v_mfma_f32_16x16x32_bf16 v[158:161], a[240:243], v[198:201], 0
    v_cvt_pk_bf16_f32 v36, v170, v171
    v_cvt_pk_bf16_f32 v180, v238, v239
    v_mfma_f32_16x16x32_bf16 v[158:161], a[244:247], v[226:229], v[158:161]
    v_exp_f32 v172, v172
    v_mfma_f32_16x16x32_bf16 v[158:161], a[248:251], v[206:209], v[158:161]
    v_exp_f32 v173, v173
    v_mfma_f32_16x16x32_bf16 v[158:161], a[252:255], v[242:245], v[158:161]
    ds_read_b128 v[118:121], v2 offset:12288
    v_cvt_pk_bf16_f32 v37, v172, v173
    v_mfma_f32_16x16x32_bf16 v[158:161], v[82:85], v[146:149], v[158:161]
    ds_read_b128 v[134:137], v2 offset:13312
    v_mul_f32 v240, v210, v240
    v_mfma_f32_16x16x32_bf16 v[170:173], v[28:31], v[36:39], 0
    v_mul_f32 v241, v210, v241
    v_cvt_pk_bf16_f32 v181, v240, v241
    v_mfma_f32_16x16x32_bf16 v[170:173], v[28:31], v[162:165], v[170:173]
    ds_write_b128 v3, v[178:181] offset:0
    v_mfma_f32_16x16x32_bf16 v[154:157], v[130:133], v[36:39], 0
    v_mul_f32 v186, v210, v186
    v_mul_f32 v187, v210, v187
    v_mfma_f32_16x16x32_bf16 v[154:157], v[174:177], v[162:165], v[154:157]
    v_cvt_pk_bf16_f32 v186, v186, v187
    v_mul_f32 v188, v210, v188
    v_mfma_f32_16x16x32_bf16 v[130:133], v[222:225], v[36:39], 0
    v_mul_f32 v189, v210, v189
    v_cvt_pk_bf16_f32 v187, v188, v189
    v_mfma_f32_16x16x32_bf16 v[130:133], v[182:185], v[162:165], v[130:133]
    s_waitcnt lgkmcnt(2)
    ds_write_b64 v4, v[186:187] offset:4096
    v_mfma_f32_16x16x32_bf16 v[174:177], v[166:169], v[36:39], 0
    s_waitcnt lgkmcnt(2)
    v_fma_f32 v255, v142, v142, s33
    v_fmac_f32 v255, v143, v143
    v_mfma_f32_16x16x32_bf16 v[174:177], v[114:117], v[162:165], v[174:177]
    v_fmac_f32 v255, v144, v144
    v_fmac_f32 v255, v145, v145
    v_mfma_f32_16x16x32_bf16 v[158:161], v[86:89], v[138:141], v[158:161]
    ds_read_b128 v[114:117], v2 offset:14336
    v_fmac_f32 v254, v205, v205
    v_mfma_f32_16x16x32_bf16 v[178:181], v[90:93], v[198:201], 0
    ds_read_b128 v[166:169], v2 offset:15360
    v_add_u32 v7, 16, v7
    v_mfma_f32_16x16x32_bf16 v[178:181], v[94:97], v[226:229], v[178:181]
    ds_read_b128 v[162:165], v2 offset:16384
    v_mfma_f32_16x16x32_bf16 v[178:181], v[98:101], v[206:209], v[178:181]
    ds_read_b128 v[206:209], v2 offset:17408
    v_fmac_f32 v255, v158, v158
    v_mfma_f32_16x16x32_bf16 v[178:181], v[102:105], v[242:245], v[178:181]
    v_fmac_f32 v255, v159, v159
    v_fmac_f32 v255, v160, v160
    v_mfma_f32_16x16x32_bf16 v[178:181], v[106:109], v[146:149], v[178:181]
    v_fmac_f32 v255, v161, v161
    v_xor_b32 v2, 65536, v2
    v_mfma_f32_16x16x32_bf16 v[178:181], v[110:113], v[138:141], v[178:181]
    v_rcp_f32 v170, v170
    v_mfma_f32_16x16x32_bf16 v[146:149], a[216:219], v[118:121], 0
    v_mul_f32 v154, v170, v154
    v_mul_f32 v155, v170, v155
    v_mfma_f32_16x16x32_bf16 v[146:149], a[220:223], v[134:137], v[146:149]
    s_waitcnt lgkmcnt(3)
    ds_read_b128 v[182:185], v0 offset:20480
    v_cvt_pk_bf16_f32 v154, v154, v155
    v_mfma_f32_16x16x32_bf16 v[146:149], a[224:227], v[114:117], v[146:149]
    s_waitcnt lgkmcnt(3)
    ds_read_b128 v[198:201], v1 offset:20480
    v_fmac_f32 v255, v178, v178
    v_mfma_f32_16x16x32_bf16 v[146:149], a[228:231], v[166:169], v[146:149]
    s_waitcnt lgkmcnt(3)
    ds_read_b128 v[210:213], v0 offset:20608
    v_fmac_f32 v255, v179, v179
    v_mfma_f32_16x16x32_bf16 v[146:149], a[232:235], v[162:165], v[146:149]
    s_waitcnt lgkmcnt(3)
    ds_read_b128 v[222:225], v1 offset:20608
    v_fmac_f32 v255, v180, v180
    v_mfma_f32_16x16x32_bf16 v[146:149], a[236:239], v[206:209], v[146:149]
    ds_read_b128 v[226:229], v0 offset:20736
    v_fmac_f32 v255, v181, v181
    v_mfma_f32_16x16x32_bf16 v[138:141], a[240:243], v[118:121], 0
    ds_read_b128 v[242:245], v1 offset:20736
    v_cvt_pk_bf16_f32 v254, v254, v255
    v_mfma_f32_16x16x32_bf16 v[138:141], a[244:247], v[134:137], v[138:141]
    v_mul_f32 v156, v170, v156
    v_mul_f32 v157, v170, v157
    v_mfma_f32_16x16x32_bf16 v[138:141], a[248:251], v[114:117], v[138:141]
    v_fma_f32 v255, v146, v146, s33
    v_fmac_f32 v255, v147, v147
    v_mfma_f32_16x16x32_bf16 v[138:141], a[252:255], v[166:169], v[138:141]
    s_waitcnt lgkmcnt(5)
    v_fmac_f32 v255, v148, v148
    v_fmac_f32 v255, v149, v149
    v_mfma_f32_16x16x32_bf16 v[138:141], v[82:85], v[162:165], v[138:141]
    s_waitcnt lgkmcnt(4)
    v_cvt_pk_bf16_f32 v155, v156, v157
    v_mul_f32 v130, v170, v130
    v_mfma_f32_16x16x32_bf16 v[138:141], v[86:89], v[206:209], v[138:141]
    s_waitcnt lgkmcnt(3)
    v_mul_f32 v131, v170, v131
    v_cvt_pk_bf16_f32 v156, v130, v131
    v_mfma_f32_16x16x32_bf16 v[186:189], v[90:93], v[118:121], 0
    s_waitcnt lgkmcnt(2)
    v_mul_f32 v132, v170, v132
    v_mul_f32 v133, v170, v133
    v_mfma_f32_16x16x32_bf16 v[186:189], v[94:97], v[134:137], v[186:189]
    s_waitcnt lgkmcnt(1)
    v_fmac_f32 v255, v138, v138
    v_fmac_f32 v255, v139, v139
    v_mfma_f32_16x16x32_bf16 v[186:189], v[98:101], v[114:117], v[186:189]
    s_waitcnt lgkmcnt(0)
    v_fmac_f32 v255, v140, v140
    v_fmac_f32 v255, v141, v141
    v_mfma_f32_16x16x32_bf16 v[186:189], v[102:105], v[166:169], v[186:189]
    v_cvt_pk_bf16_f32 v157, v132, v133
    v_mul_f32 v174, v170, v174
    v_mfma_f32_16x16x32_bf16 v[186:189], v[106:109], v[162:165], v[186:189]
    ds_write_b128 v3, v[154:157] offset:12288
    v_mfma_f32_16x16x32_bf16 v[186:189], v[110:113], v[206:209], v[186:189]
    v_mul_f32 v175, v170, v175
    v_cvt_pk_bf16_f32 v174, v174, v175
    v_mfma_f32_16x16x32_bf16 v[118:121], a[72:75], v[182:185], 0
    v_mul_f32 v176, v170, v176
    v_mul_f32 v177, v170, v177
    v_mfma_f32_16x16x32_bf16 v[118:121], a[76:79], v[198:201], v[118:121]
    v_rcp_f32 v194, v194
    v_mfma_f32_16x16x32_bf16 v[118:121], a[80:83], v[210:213], v[118:121]
    v_fmac_f32 v255, v186, v186
    v_fmac_f32 v255, v187, v187
    v_mfma_f32_16x16x32_bf16 v[118:121], a[84:87], v[222:225], v[118:121]
    v_fmac_f32 v255, v188, v188
    v_fmac_f32 v255, v189, v189
    v_mfma_f32_16x16x32_bf16 v[118:121], a[88:91], v[226:229], v[118:121]
    v_cvt_pk_bf16_f32 v255, v255, v255
    v_cvt_pk_bf16_f32 v175, v176, v177
    v_mfma_f32_16x16x32_bf16 v[118:121], a[92:95], v[242:245], v[118:121]
    ds_write_b64 v4, v[174:175] offset:16384
    v_mfma_f32_16x16x32_bf16 v[206:209], a[96:99], v[182:185], 0
    v_mul_f32 v122, v194, v122
    v_mul_f32 v123, v194, v123
    v_mfma_f32_16x16x32_bf16 v[206:209], a[100:103], v[198:201], v[206:209]
    ds_write_b64 v4, v[254:255] offset:18432
    v_mfma_f32_16x16x32_bf16 v[206:209], a[104:107], v[210:213], v[206:209]
    v_cvt_pk_bf16_f32 v134, v122, v123
    v_cvt_pk_f16_f32 v118, v118, v119
    v_mfma_f32_16x16x32_bf16 v[206:209], a[108:111], v[222:225], v[206:209]
    v_pk_mul_f16 v163, v118, v118
    v_cvt_pk_f16_f32 v119, v120, v121
    v_mfma_f32_16x16x32_bf16 v[206:209], a[112:115], v[226:229], v[206:209]
    v_pk_mul_f16 v165, v119, v119
    v_mul_f32 v124, v194, v124
    v_mfma_f32_16x16x32_bf16 v[206:209], a[116:119], v[242:245], v[206:209]
    v_mul_f32 v125, v194, v125
    v_cvt_pk_bf16_f32 v135, v124, v125
    v_mfma_f32_16x16x32_bf16 v[122:125], a[120:123], v[182:185], 0
    v_mul_f32 v126, v194, v126
    v_mul_f32 v127, v194, v127
    v_mfma_f32_16x16x32_bf16 v[122:125], a[124:127], v[198:201], v[122:125]
    v_cvt_pk_bf16_f32 v136, v126, v127
    v_mul_f32 v128, v194, v128
    v_mfma_f32_16x16x32_bf16 v[122:125], a[128:131], v[210:213], v[122:125]
    v_cvt_pk_f16_f32 v120, v206, v207
    v_pk_fma_f16 v163, v120, v120, v163
    v_mfma_f32_16x16x32_bf16 v[122:125], a[132:135], v[222:225], v[122:125]
    v_cvt_pk_f16_f32 v121, v208, v209
    v_pk_fma_f16 v165, v121, v121, v165
    v_mfma_f32_16x16x32_bf16 v[122:125], a[136:139], v[226:229], v[122:125]
    v_mul_f32 v129, v194, v129
    v_cvt_pk_bf16_f32 v137, v128, v129
    v_mfma_f32_16x16x32_bf16 v[122:125], a[140:143], v[242:245], v[122:125]
    ds_write_b128 v3, v[134:137] offset:6144
    v_mfma_f32_16x16x32_bf16 v[206:209], a[0:3], v[182:185], 0
    v_mul_f32 v218, v194, v218
    v_mul_f32 v219, v194, v219
    v_mfma_f32_16x16x32_bf16 v[206:209], a[4:7], v[198:201], v[206:209]
    v_cvt_pk_bf16_f32 v254, v218, v219
    v_mul_f32 v220, v194, v220
    v_mfma_f32_16x16x32_bf16 v[206:209], a[8:11], v[210:213], v[206:209]
    v_cvt_pk_f16_f32 v196, v122, v123
    v_pk_fma_f16 v163, v196, v196, v163
    v_mfma_f32_16x16x32_bf16 v[206:209], a[12:15], v[222:225], v[206:209]
    v_cvt_pk_f16_f32 v197, v124, v125
    v_pk_fma_f16 v165, v197, v197, v165
    v_mfma_f32_16x16x32_bf16 v[206:209], a[16:19], v[226:229], v[206:209]
    v_mul_f32 v221, v194, v221
    v_cvt_pk_bf16_f32 v255, v220, v221
    v_mfma_f32_16x16x32_bf16 v[206:209], a[20:23], v[242:245], v[206:209]
    ds_write_b64 v4, v[254:255] offset:10240
    v_mfma_f32_16x16x32_bf16 v[174:177], a[24:27], v[182:185], 0
    v_xor_b32 v3, 65536, v3
    v_xor_b32 v4, 65536, v4
    v_mfma_f32_16x16x32_bf16 v[174:177], a[28:31], v[198:201], v[174:177]
    v_mfma_f32_16x16x32_bf16 v[174:177], a[32:35], v[210:213], v[174:177]
    v_mfma_f32_16x16x32_bf16 v[174:177], a[36:39], v[222:225], v[174:177]
    v_mfma_f32_16x16x32_bf16 v[174:177], a[40:43], v[226:229], v[174:177]
    v_cvt_pk_f16_f32 v206, v206, v207
    v_mfma_f32_16x16x32_bf16 v[174:177], a[44:47], v[242:245], v[174:177]
    v_mfma_f32_16x16x32_bf16 v[218:221], a[48:51], v[182:185], 0
    s_waitcnt lgkmcnt(0)
    v_mfma_f32_16x16x32_bf16 v[218:221], a[52:55], v[198:201], v[218:221]
    s_nop 0
    v_mfma_f32_16x16x32_bf16 v[218:221], a[56:59], v[210:213], v[218:221]
    s_nop 0
    v_mfma_f32_16x16x32_bf16 v[218:221], a[60:63], v[222:225], v[218:221]
    s_barrier
    v_mfma_f32_16x16x32_bf16 v[218:221], a[64:67], v[226:229], v[218:221]
    s_nop 0
    v_mfma_f32_16x16x32_bf16 v[218:221], a[68:71], v[242:245], v[218:221]
    v_mfma_f32_16x16x32_bf16 v[170:173], v[182:185], a[144:147], 0
    v_mfma_f32_16x16x32_bf16 v[170:173], v[198:201], a[148:151], v[170:173]
    v_mfma_f32_16x16x32_bf16 v[170:173], v[210:213], a[152:155], v[170:173]
    v_mfma_f32_16x16x32_bf16 v[170:173], v[222:225], a[156:159], v[170:173]
    v_mfma_f32_16x16x32_bf16 v[170:173], v[226:229], a[160:163], v[170:173]
    v_mfma_f32_16x16x32_bf16 v[170:173], v[242:245], a[164:167], v[170:173]
    s_cbranch_scc1 L_loop_fast2
    s_branch L_final_fast
.p2align 6
L_loop_fast3:
    v_mfma_f32_16x16x32_bf16 v[234:237], v[182:185], a[168:171], 0
    s_add_u32 s12, s42, s27
    ds_read_b128 v[230:233], v2 offset:18432
    ds_read_b128 v[238:241], v2 offset:19456
    v_mfma_f32_16x16x32_bf16 v[234:237], v[198:201], a[172:175], v[234:237]
    s_addc_u32 s13, s43, 0
    v_pk_mul_f16 v162, v206, v206
    v_cvt_pk_f16_f32 v207, v208, v209
    v_mfma_f32_16x16x32_bf16 v[234:237], v[210:213], a[176:179], v[234:237]
    s_sub_u32 s14, s36, s27
    ds_read_b128 v[134:137], v0 offset:26624
    v_pk_mul_f16 v164, v207, v207
    v_mfma_f32_16x16x32_bf16 v[234:237], v[222:225], a[180:183], v[234:237]
    s_cmp_ge_u32 s18, 2
    ds_read_b128 v[154:157], v1 offset:26624
    v_cvt_pk_f16_f32 v208, v174, v175
    v_mfma_f32_16x16x32_bf16 v[234:237], v[226:229], a[184:187], v[234:237]
    s_cselect_b32 s14, s14, 0
    ds_read_b128 v[130:133], v0 offset:26752
    v_pk_fma_f16 v162, v208, v208, v162
    v_mfma_f32_16x16x32_bf16 v[234:237], v[242:245], a[188:191], v[234:237]
    s_add_u32 s34, s18, 2
    ds_read_b128 v[122:125], v1 offset:26752
    v_cvt_pk_f16_f32 v209, v176, v177
    v_mfma_f32_16x16x32_bf16 v[114:117], v[182:185], a[192:195], 0
    s_add_u32 s8, s40, s23
    ds_read_b128 v[126:129], v0 offset:26880
    v_pk_fma_f16 v164, v209, v209, v164
    v_mfma_f32_16x16x32_bf16 v[114:117], v[198:201], a[196:199], v[114:117]
    s_addc_u32 s9, s41, 0
    ds_read_b128 v[166:169], v1 offset:26880
    v_cvt_pk_f16_f32 v194, v218, v219
    v_mfma_f32_16x16x32_bf16 v[114:117], v[210:213], a[200:203], v[114:117]
    s_waitcnt lgkmcnt(6)
    v_pk_fma_f16 v162, v194, v194, v162
    v_cvt_pk_f16_f32 v195, v220, v221
    v_mfma_f32_16x16x32_bf16 v[198:201], v[32:35], v[230:233], 0
    s_sub_u32 s10, s36, s23
    v_pk_fma_f16 v164, v195, v195, v164
    v_cvt_pk_bf16_f32 v174, v170, v171
    v_mfma_f32_16x16x32_bf16 v[198:201], v[32:35], v[238:241], v[198:201]
    s_waitcnt lgkmcnt(5)
    v_cvt_pk_bf16_f32 v175, v172, v173
    v_cvt_pk_bf16_f32 v182, v234, v235
    v_mfma_f32_16x16x32_f16 v[170:173], v[40:43], v[162:165], 0
    s_cmp_lt_u32 s34, s17
    v_cvt_pk_bf16_f32 v183, v236, v237
    s_cselect_b32 s10, s10, 0
    v_mfma_f32_16x16x32_bf16 v[114:117], v[222:225], a[204:207], v[114:117]
    s_add_u32 m0, s28, 0
    v_mul_f32 v255, 0x3baaaaab, v198
    v_mul_f32 v254, 0x3baaaaab, v199
    v_mfma_f32_16x16x32_bf16 v[114:117], v[226:229], a[208:211], v[114:117]
    s_mov_b32 s27, s26
    v_rsq_f32 v172, v170
    v_mfma_f32_16x16x32_bf16 v[114:117], v[242:245], a[212:215], v[114:117]
    s_mov_b32 s26, s25
    v_rsq_f32 v173, v171
    v_mfma_f32_16x16x32_bf16 v[162:165], a[72:75], v[134:137], 0
    s_waitcnt lgkmcnt(0)
    v_mul_f32 v172, s31, v172
    v_cvt_pk_f16_f32 v172, v172, v173
    v_mfma_f32_16x16x32_bf16 v[162:165], a[76:79], v[154:157], v[162:165]
    s_mov_b32 s25, s24
    v_cvt_pk_bf16_f32 v114, v114, v115
    v_cvt_pk_bf16_f32 v115, v116, v117
    v_mfma_f32_16x16x32_bf16 v[162:165], a[80:83], v[130:133], v[162:165]
    s_mov_b32 s24, s23
    v_pk_mul_f16 v118, v118, v172 op_sel:[0,1] op_sel_hi:[1,1]
    v_pk_mul_f16 v119, v119, v172 op_sel:[0,1] op_sel_hi:[1,1]
    v_mfma_f32_16x16x32_bf16 v[162:165], a[84:87], v[122:125], v[162:165]
    v_pk_mul_f16 v120, v120, v172 op_sel:[0,1] op_sel_hi:[1,1]
    v_pk_mul_f16 v121, v121, v172 op_sel:[0,1] op_sel_hi:[1,1]
    v_mfma_f32_16x16x32_bf16 v[162:165], a[88:91], v[126:129], v[162:165]
    v_pk_mul_f16 v196, v196, v172 op_sel:[0,1] op_sel_hi:[1,1]
    v_pk_mul_f16 v197, v197, v172 op_sel:[0,1] op_sel_hi:[1,1]
    v_mfma_f32_16x16x32_bf16 v[162:165], a[92:95], v[166:169], v[162:165]
    v_pk_mul_f16 v206, v206, v172 op_sel:[0,0] op_sel_hi:[1,0]
    v_pk_mul_f16 v207, v207, v172 op_sel:[0,0] op_sel_hi:[1,0]
    v_mfma_f32_16x16x32_bf16 v[210:213], a[96:99], v[134:137], 0
    v_pk_mul_f16 v208, v208, v172 op_sel:[0,0] op_sel_hi:[1,0]
    v_pk_mul_f16 v209, v209, v172 op_sel:[0,0] op_sel_hi:[1,0]
    v_mfma_f32_16x16x32_bf16 v[210:213], a[100:103], v[154:157], v[210:213]
    v_pk_mul_f16 v194, v194, v172 op_sel:[0,0] op_sel_hi:[1,0]
    v_pk_mul_f16 v195, v195, v172 op_sel:[0,0] op_sel_hi:[1,0]
    v_mfma_f32_16x16x32_bf16 v[210:213], a[104:107], v[130:133], v[210:213]
    v_min3_u32 v44, v44, v170, v171
    v_max3_u32 v45, v45, v170, v171
    v_mfma_f32_16x16x32_bf16 v[210:213], a[108:111], v[122:125], v[210:213]
    v_cvt_pk_f16_f32 v170, v162, v163
    v_pk_mul_f16 v163, v170, v170
    v_mfma_f32_16x16x32_bf16 v[210:213], a[112:115], v[126:129], v[210:213]
    v_cvt_pk_f16_f32 v171, v164, v165
    v_pk_mul_f16 v165, v171, v171
    v_mfma_f32_16x16x32_bf16 v[210:213], a[116:119], v[166:169], v[210:213]
    v_rsq_f32 v255, v255
    v_mfma_f32_16x16x32_bf16 v[214:217], a[120:123], v[134:137], 0
    v_rsq_f32 v254, v254
    v_mfma_f32_16x16x32_bf16 v[214:217], a[124:127], v[154:157], v[214:217]
    v_mul_f32 v142, v254, v142
    v_mul_f32 v143, v254, v143
    v_mfma_f32_16x16x32_bf16 v[214:217], a[128:131], v[130:133], v[214:217]
    v_cvt_pk_bf16_f32 v142, v142, v143
    v_cvt_pk_f16_f32 v172, v210, v211
    v_mfma_f32_16x16x32_bf16 v[214:217], a[132:135], v[122:125], v[214:217]
    v_pk_fma_f16 v163, v172, v172, v163
    v_cvt_pk_f16_f32 v173, v212, v213
    v_mfma_f32_16x16x32_bf16 v[214:217], a[136:139], v[126:129], v[214:217]
    v_pk_fma_f16 v165, v173, v173, v165
    v_mul_f32 v144, v254, v144
    v_mfma_f32_16x16x32_bf16 v[214:217], a[140:143], v[166:169], v[214:217]
    v_mul_f32 v145, v254, v145
    v_cvt_pk_bf16_f32 v143, v144, v145
    v_mfma_f32_16x16x32_bf16 v[210:213], a[0:3], v[134:137], 0
    v_mul_f32 v158, v254, v158
    v_mul_f32 v159, v254, v159
    v_mfma_f32_16x16x32_bf16 v[210:213], a[4:7], v[154:157], v[210:213]
    v_cvt_pk_bf16_f32 v144, v158, v159
    v_mul_f32 v160, v254, v160
    v_mfma_f32_16x16x32_bf16 v[210:213], a[8:11], v[130:133], v[210:213]
    v_cvt_pk_f16_f32 v220, v214, v215
    v_pk_fma_f16 v163, v220, v220, v163
    v_mfma_f32_16x16x32_bf16 v[210:213], a[12:15], v[122:125], v[210:213]
    v_cvt_pk_f16_f32 v221, v216, v217
    v_pk_fma_f16 v165, v221, v221, v165
    v_mfma_f32_16x16x32_bf16 v[210:213], a[16:19], v[126:129], v[210:213]
    v_mul_f32 v161, v254, v161
    v_cvt_pk_bf16_f32 v145, v160, v161
    v_mfma_f32_16x16x32_bf16 v[210:213], a[20:23], v[166:169], v[210:213]
    buffer_store_dwordx4 v[142:145], v16, s[12:15], 0 offen nt
    v_mul_f32 v178, v254, v178
    v_mul_f32 v179, v254, v179
    v_cvt_pk_bf16_f32 v198, v178, v179
    v_mul_f32 v180, v254, v180
    v_mfma_f32_16x16x32_bf16 v[142:145], a[24:27], v[134:137], 0
    v_mul_f32 v181, v254, v181
    v_cvt_pk_bf16_f32 v199, v180, v181
    v_mfma_f32_16x16x32_bf16 v[142:145], a[28:31], v[154:157], v[142:145]
    v_cvt_pk_f16_f32 v158, v210, v211
    v_pk_mul_f16 v162, v158, v158
    v_mfma_f32_16x16x32_bf16 v[142:145], a[32:35], v[130:133], v[142:145]
    v_cvt_pk_f16_f32 v159, v212, v213
    v_pk_mul_f16 v164, v159, v159
    v_mfma_f32_16x16x32_bf16 v[142:145], a[36:39], v[122:125], v[142:145]
    v_mul_f32 v254, 0x3baaaaab, v200
    v_mul_f32 v150, v255, v150
    v_mfma_f32_16x16x32_bf16 v[142:145], a[40:43], v[126:129], v[142:145]
    v_rsq_f32 v254, v254
    v_mfma_f32_16x16x32_bf16 v[142:145], a[44:47], v[166:169], v[142:145]
    v_mul_f32 v146, v254, v146
    v_mul_f32 v147, v254, v147
    v_mfma_f32_16x16x32_bf16 v[178:181], a[48:51], v[134:137], 0
    v_cvt_pk_bf16_f32 v146, v146, v147
    v_mul_f32 v148, v254, v148
    v_mfma_f32_16x16x32_bf16 v[178:181], a[52:55], v[154:157], v[178:181]
    v_mul_f32 v149, v254, v149
    v_cvt_pk_bf16_f32 v147, v148, v149
    v_mfma_f32_16x16x32_bf16 v[178:181], a[56:59], v[130:133], v[178:181]
    v_mul_f32 v138, v254, v138
    v_mul_f32 v139, v254, v139
    v_mfma_f32_16x16x32_bf16 v[178:181], a[60:63], v[122:125], v[178:181]
    v_cvt_pk_bf16_f32 v148, v138, v139
    v_mul_f32 v140, v254, v140
    v_mfma_f32_16x16x32_bf16 v[178:181], a[64:67], v[126:129], v[178:181]
    v_mul_f32 v141, v254, v141
    v_cvt_pk_bf16_f32 v149, v140, v141
    v_mfma_f32_16x16x32_bf16 v[178:181], a[68:71], v[166:169], v[178:181]
    v_mul_f32 v186, v254, v186
    v_mul_f32 v187, v254, v187
    v_mfma_f32_16x16x32_bf16 v[138:141], v[134:137], a[144:147], 0
    v_cvt_pk_bf16_f32 v200, v186, v187
    v_mul_f32 v188, v254, v188
    v_mfma_f32_16x16x32_bf16 v[138:141], v[154:157], a[148:151], v[138:141]
    v_mul_f32 v189, v254, v189
    v_cvt_pk_bf16_f32 v201, v188, v189
    v_mfma_f32_16x16x32_bf16 v[138:141], v[130:133], a[152:155], v[138:141]
    v_cvt_pk_f16_f32 v160, v142, v143
    v_pk_fma_f16 v162, v160, v160, v162
    v_mfma_f32_16x16x32_bf16 v[138:141], v[122:125], a[156:159], v[138:141]
    v_cvt_pk_f16_f32 v161, v144, v145
    v_pk_fma_f16 v164, v161, v161, v164
    v_mfma_f32_16x16x32_bf16 v[138:141], v[126:129], a[160:163], v[138:141]
    buffer_store_dwordx4 v[146:149], v17, s[12:15], 0 offen nt
    v_cvt_pk_f16_f32 v218, v178, v179
    v_pk_fma_f16 v162, v218, v218, v162
    v_cvt_pk_f16_f32 v219, v180, v181
    v_pk_fma_f16 v164, v219, v219, v164
    v_mfma_f32_16x16x32_bf16 v[138:141], v[166:169], a[164:167], v[138:141]
    v_mul_f32 v151, v255, v151
    v_cvt_pk_bf16_f32 v150, v150, v151
    v_mfma_f32_16x16x32_f16 v[142:145], v[40:43], v[162:165], 0
    v_mul_f32 v152, v255, v152
    v_mul_f32 v153, v255, v153
    v_mfma_f32_16x16x32_bf16 v[178:181], v[134:137], a[168:171], 0
    v_cvt_pk_bf16_f32 v151, v152, v153
    v_mul_f32 v190, v255, v190
    v_mfma_f32_16x16x32_bf16 v[178:181], v[154:157], a[172:175], v[178:181]
    v_cvt_pk_bf16_f32 v176, v138, v139
    v_cvt_pk_bf16_f32 v177, v140, v141
    v_mfma_f32_16x16x32_bf16 v[178:181], v[130:133], a[176:179], v[178:181]
    ds_read_b128 v[146:149], v0 offset:32768
    v_min3_u32 v44, v44, v142, v143
    v_mfma_f32_16x16x32_bf16 v[178:181], v[122:125], a[180:183], v[178:181]
    ds_read_b128 v[138:141], v1 offset:32768
    v_max3_u32 v45, v45, v142, v143
    v_mfma_f32_16x16x32_bf16 v[178:181], v[126:129], a[184:187], v[178:181]
    ds_read_b128 v[186:189], v0 offset:32896
    v_mul_f32 v191, v255, v191
    v_mfma_f32_16x16x32_bf16 v[178:181], v[166:169], a[188:191], v[178:181]
    ds_read_b128 v[162:165], v1 offset:32896
    v_cvt_pk_bf16_f32 v152, v190, v191
    v_mfma_f32_16x16x32_bf16 v[210:213], v[134:137], a[192:195], 0
    ds_read_b128 v[134:137], v0 offset:33024
    v_mul_f32 v192, v255, v192
    v_mfma_f32_16x16x32_bf16 v[210:213], v[154:157], a[196:199], v[210:213]
    ds_read_b128 v[154:157], v1 offset:33024
    v_mul_f32 v193, v255, v193
    v_mfma_f32_16x16x32_bf16 v[210:213], v[130:133], a[200:203], v[210:213]
    v_rsq_f32 v144, v142
    v_mfma_f32_16x16x32_bf16 v[210:213], v[122:125], a[204:207], v[210:213]
    v_rsq_f32 v145, v143
    v_mfma_f32_16x16x32_bf16 v[210:213], v[126:129], a[208:211], v[210:213]
    s_waitcnt lgkmcnt(5)
    v_mul_f32 v144, s31, v144
    v_cvt_pk_f16_f32 v144, v144, v145
    v_mfma_f32_16x16x32_bf16 v[210:213], v[166:169], a[212:215], v[210:213]
    s_waitcnt lgkmcnt(4)
    v_cvt_pk_bf16_f32 v184, v178, v179
    v_cvt_pk_bf16_f32 v185, v180, v181
    v_mfma_f32_16x16x32_bf16 v[178:181], a[72:75], v[146:149], 0
    s_waitcnt lgkmcnt(3)
    v_pk_mul_f16 v170, v170, v144 op_sel:[0,1] op_sel_hi:[1,1]
    v_pk_mul_f16 v171, v171, v144 op_sel:[0,1] op_sel_hi:[1,1]
    v_mfma_f32_16x16x32_bf16 v[178:181], a[76:79], v[138:141], v[178:181]
    s_waitcnt lgkmcnt(2)
    v_cvt_pk_bf16_f32 v116, v210, v211
    v_cvt_pk_bf16_f32 v117, v212, v213
    v_mfma_f32_16x16x32_bf16 v[178:181], a[80:83], v[186:189], v[178:181]
    s_waitcnt lgkmcnt(1)
    buffer_store_dwordx2 v[200:201], v20, s[12:15], 0 offen nt
    v_pk_mul_f16 v172, v172, v144 op_sel:[0,1] op_sel_hi:[1,1]
    v_pk_mul_f16 v173, v173, v144 op_sel:[0,1] op_sel_hi:[1,1]
    v_mfma_f32_16x16x32_bf16 v[178:181], a[84:87], v[162:165], v[178:181]
    s_waitcnt lgkmcnt(0)
    v_pk_mul_f16 v220, v220, v144 op_sel:[0,1] op_sel_hi:[1,1]
    v_pk_mul_f16 v221, v221, v144 op_sel:[0,1] op_sel_hi:[1,1]
    v_mfma_f32_16x16x32_bf16 v[178:181], a[88:91], v[134:137], v[178:181]
    v_pk_mul_f16 v158, v158, v144 op_sel:[0,0] op_sel_hi:[1,0]
    v_pk_mul_f16 v159, v159, v144 op_sel:[0,0] op_sel_hi:[1,0]
    v_mfma_f32_16x16x32_bf16 v[178:181], a[92:95], v[154:157], v[178:181]
    v_pk_mul_f16 v160, v160, v144 op_sel:[0,0] op_sel_hi:[1,0]
    v_pk_mul_f16 v161, v161, v144 op_sel:[0,0] op_sel_hi:[1,0]
    v_mfma_f32_16x16x32_bf16 v[130:133], a[96:99], v[146:149], 0
    v_pk_mul_f16 v218, v218, v144 op_sel:[0,0] op_sel_hi:[1,0]
    v_pk_mul_f16 v219, v219, v144 op_sel:[0,0] op_sel_hi:[1,0]
    v_mfma_f32_16x16x32_bf16 v[130:133], a[100:103], v[138:141], v[130:133]
    s_waitcnt vmcnt(3)
    v_cvt_pk_bf16_f32 v153, v192, v193
    v_cvt_pk_f16_f32 v142, v178, v179
    v_mfma_f32_16x16x32_bf16 v[130:133], a[104:107], v[186:189], v[130:133]
    s_nop 0
    v_pk_mul_f16 v191, v142, v142
    v_cvt_pk_f16_f32 v143, v180, v181
    v_mfma_f32_16x16x32_bf16 v[130:133], a[108:111], v[162:165], v[130:133]
    s_nop 0
    v_pk_mul_f16 v193, v143, v143
    v_mul_f32 v202, v255, v202
    v_mfma_f32_16x16x32_bf16 v[130:133], a[112:115], v[134:137], v[130:133]
    s_nop 0
    v_mul_f32 v203, v255, v203
    v_cvt_pk_bf16_f32 v254, v202, v203
    v_mfma_f32_16x16x32_bf16 v[130:133], a[116:119], v[154:157], v[130:133]
    s_barrier
    v_mul_f32 v204, v255, v204
    v_mul_f32 v205, v255, v205
    v_mfma_f32_16x16x32_bf16 v[178:181], a[120:123], v[146:149], 0
    v_cvt_pk_bf16_f32 v255, v204, v205
    v_xor_b32 v0, 65536, v0
    v_mfma_f32_16x16x32_bf16 v[178:181], a[124:127], v[138:141], v[178:181]
    v_xor_b32 v1, 65536, v1
    v_cvt_pk_f16_f32 v144, v130, v131
    v_mfma_f32_16x16x32_bf16 v[178:181], a[128:131], v[186:189], v[178:181]
    v_pk_fma_f16 v191, v144, v144, v191
    v_cvt_pk_f16_f32 v145, v132, v133
    v_mfma_f32_16x16x32_bf16 v[178:181], a[132:135], v[162:165], v[178:181]
    v_pk_fma_f16 v193, v145, v145, v193
    v_mfma_f32_16x16x32_bf16 v[178:181], a[136:139], v[134:137], v[178:181]
    v_mfma_f32_16x16x32_bf16 v[178:181], a[140:143], v[154:157], v[178:181]
    v_mfma_f32_16x16x32_bf16 v[202:205], a[0:3], v[146:149], 0
    v_mfma_f32_16x16x32_bf16 v[202:205], a[4:7], v[138:141], v[202:205]
    buffer_load_dwordx4 v10, s[8:11], 0 offen nt lds
    s_add_u32 m0, s28, 4096
    v_mfma_f32_16x16x32_bf16 v[202:205], a[8:11], v[186:189], v[202:205]
    v_mfma_f32_16x16x32_bf16 v[202:205], a[12:15], v[162:165], v[202:205]
    v_mfma_f32_16x16x32_bf16 v[202:205], a[16:19], v[134:137], v[202:205]
    v_mfma_f32_16x16x32_bf16 v[202:205], a[20:23], v[154:157], v[202:205]
    v_cvt_pk_f16_f32 v124, v178, v179
    v_pk_fma_f16 v191, v124, v124, v191
    v_mfma_f32_16x16x32_bf16 v[130:133], a[24:27], v[146:149], 0
    buffer_load_dwordx4 v11, s[8:11], 0 offen nt lds
    v_cvt_pk_f16_f32 v125, v180, v181
    v_mfma_f32_16x16x32_bf16 v[130:133], a[28:31], v[138:141], v[130:133]
    s_add_u32 m0, s28, 8192
    v_pk_fma_f16 v193, v125, v125, v193
    v_cvt_pk_f16_f32 v178, v202, v203
    v_mfma_f32_16x16x32_bf16 v[130:133], a[32:35], v[186:189], v[130:133]
    v_pk_mul_f16 v190, v178, v178
    v_cvt_pk_f16_f32 v179, v204, v205
    v_mfma_f32_16x16x32_bf16 v[130:133], a[36:39], v[162:165], v[130:133]
    v_pk_mul_f16 v192, v179, v179
    v_mfma_f32_16x16x32_bf16 v[130:133], a[40:43], v[134:137], v[130:133]
    v_mfma_f32_16x16x32_bf16 v[130:133], a[44:47], v[154:157], v[130:133]
    buffer_load_dwordx4 v12, s[8:11], 0 offen nt lds
    s_add_u32 m0, s28, 12288
    v_mfma_f32_16x16x32_bf16 v[202:205], a[48:51], v[146:149], 0
    s_xor_b32 s28, s28, 65536
    v_mfma_f32_16x16x32_bf16 v[202:205], a[52:55], v[138:141], v[202:205]
    ds_read_b128 v[166:169], v5 offset:0
    ds_read_b128 v[126:129], v5 offset:16
    v_mfma_f32_16x16x32_bf16 v[202:205], a[56:59], v[186:189], v[202:205]
    ds_read_b128 v[210:213], v5 offset:48
    ds_read_b32 v200, v6 offset:192
    v_mfma_f32_16x16x32_bf16 v[202:205], a[60:63], v[162:165], v[202:205]
    v_cvt_pk_f16_f32 v180, v130, v131
    v_pk_fma_f16 v190, v180, v180, v190
    v_mfma_f32_16x16x32_bf16 v[202:205], a[64:67], v[134:137], v[202:205]
    buffer_load_dwordx4 v13, s[8:11], 0 offen nt lds
    v_cvt_pk_f16_f32 v181, v132, v133
    v_mfma_f32_16x16x32_bf16 v[202:205], a[68:71], v[154:157], v[202:205]
    s_mov_b32 m0, s29
    v_pk_fma_f16 v192, v181, v181, v192
    v_add_u32 v5, 336, v5
    v_mfma_f32_16x16x32_bf16 v[130:133], v[146:149], a[144:147], 0
    s_xor_b32 s29, s29, s30
    s_add_u32 s19, s19, s20
    s_add_u32 s23, s23, s21
    v_mfma_f32_16x16x32_bf16 v[130:133], v[138:141], a[148:151], v[130:133]
    s_cmp_ge_u32 s19, 72
    v_cvt_pk_f16_f32 v122, v202, v203
    v_pk_fma_f16 v190, v122, v122, v190
    v_mfma_f32_16x16x32_bf16 v[130:133], v[186:189], a[152:155], v[130:133]
    s_cselect_b32 s34, 72, 0
    v_cvt_pk_f16_f32 v123, v204, v205
    v_pk_fma_f16 v192, v123, v123, v192
    v_mfma_f32_16x16x32_bf16 v[130:133], v[162:165], a[156:159], v[130:133]
    s_waitcnt lgkmcnt(2)
    buffer_store_dwordx2 v[198:199], v19, s[12:15], 0 offen nt
    s_cselect_b32 s35, s22, 0
    s_sub_u32 s19, s19, s34
    v_mfma_f32_16x16x32_f16 v[202:205], v[40:43], v[190:193], 0
    s_add_u32 s23, s23, s35
    s_add_u32 s18, s18, 1
    s_cmp_lt_u32 s18, s45
    v_mfma_f32_16x16x32_f16 v[214:217], v[166:169], v[158:161], v[24:27]
    s_waitcnt lgkmcnt(0)
    v_mfma_f32_16x16x32_f16 v[214:217], v[126:129], v[170:173], v[214:217]
    v_mfma_f32_16x16x32_f16 v[214:217], v[210:213], v[218:221], v[214:217]
    v_mfma_f32_16x16x32_f16 v[190:193], v[166:169], v[206:209], v[22:25]
    v_rsq_f32 v204, v202
    v_mfma_f32_16x16x32_f16 v[190:193], v[126:129], v[118:121], v[190:193]
    v_rsq_f32 v205, v203
    v_mfma_f32_16x16x32_f16 v[190:193], v[210:213], v[194:197], v[190:193]
    v_mul_f32 v204, s31, v204
    v_cvt_pk_f16_f32 v204, v204, v205
    v_mfma_f32_16x16x32_bf16 v[130:133], v[134:137], a[160:163], v[130:133]
    v_pk_mul_f16 v142, v142, v204 op_sel:[0,1] op_sel_hi:[1,1]
    v_pk_mul_f16 v143, v143, v204 op_sel:[0,1] op_sel_hi:[1,1]
    v_mfma_f32_16x16x32_bf16 v[130:133], v[154:157], a[164:167], v[130:133]
    v_pk_mul_f16 v144, v144, v204 op_sel:[0,1] op_sel_hi:[1,1]
    v_pk_mul_f16 v145, v145, v204 op_sel:[0,1] op_sel_hi:[1,1]
    v_mfma_f32_16x16x32_bf16 v[222:225], v[146:149], a[168:171], 0
    v_mov_b32_dpp v200, v191 quad_perm:[0,1,2,3] row_mask:0x1 bank_mask:0xf
    v_mov_b32_dpp v200, v215 quad_perm:[0,1,2,3] row_mask:0x2 bank_mask:0xf
    v_mfma_f32_16x16x32_bf16 v[222:225], v[138:141], a[172:175], v[222:225]
    v_pk_mul_f16 v124, v124, v204 op_sel:[0,1] op_sel_hi:[1,1]
    v_pk_mul_f16 v125, v125, v204 op_sel:[0,1] op_sel_hi:[1,1]
    v_mfma_f32_16x16x32_bf16 v[222:225], v[186:189], a[176:179], v[222:225]
    v_cvt_pk_bf16_f32 v130, v130, v131
    v_cvt_pk_bf16_f32 v131, v132, v133
    v_mfma_f32_16x16x32_bf16 v[222:225], v[162:165], a[180:183], v[222:225]
    v_pk_mul_f16 v178, v178, v204 op_sel:[0,0] op_sel_hi:[1,0]
    v_pk_mul_f16 v179, v179, v204 op_sel:[0,0] op_sel_hi:[1,0]
    v_mfma_f32_16x16x32_f16 v[226:229], v[118:121], v[206:209], v[46:49]
    v_pk_mul_f16 v180, v180, v204 op_sel:[0,0] op_sel_hi:[1,0]
    v_pk_mul_f16 v181, v181, v204 op_sel:[0,0] op_sel_hi:[1,0]
    v_mfma_f32_16x16x32_f16 v[230:233], v[170:173], v[206:209], v[50:53]
    v_pk_mul_f16 v122, v122, v204 op_sel:[0,0] op_sel_hi:[1,0]
    v_pk_mul_f16 v123, v123, v204 op_sel:[0,0] op_sel_hi:[1,0]
    v_mfma_f32_16x16x32_f16 v[234:237], v[142:145], v[206:209], v[54:57]
    v_min3_u32 v44, v44, v202, v203
    v_exp_f32 v214, v214
    v_mfma_f32_16x16x16_f16 v[226:229], v[196:197], v[194:195], v[226:229]
    v_max3_u32 v45, v45, v202, v203
    v_exp_f32 v190, v190
    v_mfma_f32_16x16x16_f16 v[230:233], v[220:221], v[194:195], v[230:233]
    v_cvt_pk_bf16_f32 v39, v190, 0
    v_mfma_f32_16x16x16_f16 v[234:237], v[124:125], v[194:195], v[234:237]
    buffer_store_dwordx4 v[150:153], v15, s[12:15], 0 offen nt
    v_mfma_f32_16x16x32_bf16 v[222:225], v[134:137], a[184:187], v[222:225]
    v_mfma_f32_16x16x32_bf16 v[222:225], v[154:157], a[188:191], v[222:225]
    ds_read_b128 v[206:209], v2 offset:0
    v_mfma_f32_16x16x32_bf16 v[150:153], v[146:149], a[192:195], 0
    ds_read_b128 v[146:149], v2 offset:1024
    v_mfma_f32_16x16x32_bf16 v[150:153], v[138:141], a[196:199], v[150:153]
    ds_read_b128 v[138:141], v2 offset:2048
    v_mfma_f32_16x16x32_bf16 v[150:153], v[186:189], a[200:203], v[150:153]
    ds_read_b128 v[186:189], v2 offset:3072
    v_mfma_f32_16x16x32_bf16 v[150:153], v[162:165], a[204:207], v[150:153]
    ds_read_b128 v[162:165], v2 offset:4096
    v_cvt_pk_bf16_f32 v222, v222, v223
    v_mfma_f32_16x16x32_bf16 v[150:153], v[134:137], a[208:211], v[150:153]
    ds_read_b128 v[134:137], v2 offset:5120
    v_cvt_pk_bf16_f32 v223, v224, v225
    v_mfma_f32_16x16x32_bf16 v[150:153], v[154:157], a[212:215], v[150:153]
    ds_read2_b32 v[132:133], v6 offset0:0 offset1:0
    ds_read2_b32 v[224:225], v6 offset0:16 offset1:16
    v_mfma_f32_16x16x32_f16 v[154:157], v[166:169], v[178:181], v[26:29]
    ds_read2_b32 v[168:169], v6 offset0:32 offset1:32
    v_add_u32 v6, 272, v6
    v_mfma_f32_16x16x32_f16 v[154:157], v[126:129], v[142:145], v[154:157]
    s_waitcnt lgkmcnt(8)
    v_exp_f32 v226, v226
    v_mfma_f32_16x16x32_f16 v[154:157], v[210:213], v[122:125], v[154:157]
    s_waitcnt lgkmcnt(7)
    v_cvt_pk_bf16_f32 v166, v150, v151
    v_cvt_pk_bf16_f32 v167, v152, v153
    v_mfma_f32_16x16x32_bf16 v[150:153], a[216:219], v[206:209], 0
    s_waitcnt lgkmcnt(6)
    v_exp_f32 v227, v227
    v_mfma_f32_16x16x32_bf16 v[150:153], a[220:223], v[146:149], v[150:153]
    s_waitcnt lgkmcnt(5)
    v_exp_f32 v154, v154
    v_mfma_f32_16x16x32_bf16 v[150:153], a[224:227], v[138:141], v[150:153]
    s_waitcnt lgkmcnt(4)
    v_mov_b32_dpp v200, v155 quad_perm:[0,1,2,3] row_mask:0x4 bank_mask:0xf
    v_cvt_pk_bf16_f32 v126, v226, v227
    v_mfma_f32_16x16x32_bf16 v[150:153], a[228:231], v[186:189], v[150:153]
    s_waitcnt lgkmcnt(3)
    v_exp_f32 v200, v200
    v_mfma_f32_16x16x32_bf16 v[150:153], a[232:235], v[162:165], v[150:153]
    s_waitcnt lgkmcnt(1)
    v_exp_f32 v228, v228
    v_mfma_f32_16x16x32_bf16 v[150:153], a[236:239], v[134:137], v[150:153]
    s_waitcnt lgkmcnt(0)
    buffer_store_dwordx2 v[254:255], v18, s[12:15], 0 offen nt
    v_exp_f32 v229, v229
    v_mfma_f32_16x16x32_bf16 v[190:193], a[240:243], v[206:209], 0
    v_cvt_pk_bf16_f32 v200, v200, v200
    v_cvt_pk_bf16_f32 v127, v228, v229
    v_mfma_f32_16x16x32_bf16 v[190:193], a[244:247], v[146:149], v[190:193]
    ds_write_b16 v8, v200
    v_mfma_f32_16x16x32_bf16 v[190:193], a[248:251], v[138:141], v[190:193]
    v_exp_f32 v230, v230
    v_mfma_f32_16x16x32_bf16 v[190:193], a[252:255], v[186:189], v[190:193]
    ds_read_b128 v[198:201], v2 offset:6144
    ds_read_b128 v[210:213], v9
    v_mfma_f32_16x16x32_bf16 v[190:193], v[82:85], v[162:165], v[190:193]
    ds_read_b128 v[226:229], v2 offset:7168
    ds_read_b128 v[238:241], v9 offset:64
    v_mfma_f32_16x16x32_bf16 v[190:193], v[86:89], v[134:137], v[190:193]
    v_exp_f32 v231, v231
    v_mfma_f32_16x16x32_bf16 v[202:205], v[90:93], v[206:209], 0
    ds_read_b128 v[206:209], v2 offset:8192
    ds_read_b128 v[242:245], v2 offset:9216
    v_mfma_f32_16x16x32_bf16 v[202:205], v[94:97], v[146:149], v[202:205]
    v_cvt_pk_bf16_f32 v128, v230, v231
    v_fma_f32 v254, v150, v150, s33
    v_mfma_f32_16x16x32_bf16 v[202:205], v[98:101], v[138:141], v[202:205]
    ds_read_b128 v[146:149], v2 offset:10240
    ds_read_b128 v[138:141], v2 offset:11264
    v_mfma_f32_16x16x32_bf16 v[202:205], v[102:105], v[186:189], v[202:205]
    v_exp_f32 v232, v232
    v_mfma_f32_16x16x32_bf16 v[202:205], v[106:109], v[162:165], v[202:205]
    v_exp_f32 v233, v233
    v_mfma_f32_16x16x32_bf16 v[202:205], v[110:113], v[134:137], v[202:205]
    s_waitcnt lgkmcnt(6)
    v_cvt_pk_bf16_f32 v129, v232, v233
    v_fmac_f32 v254, v151, v151
    v_mfma_f32_16x16x32_bf16 v[186:189], v[210:213], v[28:31], 0
    s_waitcnt lgkmcnt(4)
    v_exp_f32 v234, v234
    v_mfma_f32_16x16x32_bf16 v[186:189], v[238:241], v[28:31], v[186:189]
    v_exp_f32 v235, v235
    v_mfma_f32_16x16x32_f16 v[134:137], v[118:121], v[158:161], v[58:61]
    s_waitcnt lgkmcnt(2)
    v_cvt_pk_bf16_f32 v36, v234, v235
    v_fmac_f32 v254, v152, v152
    v_mfma_f32_16x16x32_f16 v[162:165], v[170:173], v[158:161], v[62:65]
    v_exp_f32 v236, v236
    v_mfma_f32_16x16x32_f16 v[230:233], v[142:145], v[158:161], v[66:69]
    s_waitcnt lgkmcnt(0)
    buffer_load_dwordx4 v14, s[8:11], 0 offen nt lds
    v_rcp_f32 v186, v186
    v_mfma_f32_16x16x16_f16 v[134:137], v[196:197], v[218:219], v[134:137]
    v_exp_f32 v237, v237
    v_fmac_f32 v254, v153, v153
    v_mfma_f32_16x16x16_f16 v[162:165], v[220:221], v[218:219], v[162:165]
    v_cvt_pk_bf16_f32 v37, v236, v237
    v_fmac_f32 v254, v190, v190
    v_fmac_f32 v254, v191, v191
    v_mfma_f32_16x16x16_f16 v[230:233], v[124:125], v[218:219], v[230:233]
    v_fmac_f32 v254, v192, v192
    v_exp_f32 v134, v134
    v_fmac_f32 v254, v193, v193
    v_mfma_f32_16x16x32_bf16 v[158:161], v[210:213], v[174:177], 0
    v_exp_f32 v135, v135
    v_mfma_f32_16x16x32_bf16 v[158:161], v[238:241], v[130:133], v[158:161]
    v_cvt_pk_bf16_f32 v134, v134, v135
    v_fmac_f32 v254, v202, v202
    v_mfma_f32_16x16x32_bf16 v[234:237], v[210:213], v[182:185], 0
    v_exp_f32 v136, v136
    v_mfma_f32_16x16x32_bf16 v[234:237], v[238:241], v[222:225], v[234:237]
    v_exp_f32 v137, v137
    v_mfma_f32_16x16x32_bf16 v[246:249], v[210:213], v[114:117], 0
    v_cvt_pk_bf16_f32 v135, v136, v137
    v_mul_f32 v158, v158, v186
    v_mfma_f32_16x16x32_bf16 v[246:249], v[238:241], v[166:169], v[246:249]
    v_exp_f32 v162, v162
    v_mfma_f32_16x16x32_bf16 v[210:213], v[28:31], v[36:39], 0
    v_exp_f32 v163, v163
    v_mfma_f32_16x16x32_bf16 v[210:213], v[28:31], v[126:129], v[210:213]
    v_cvt_pk_bf16_f32 v136, v162, v163
    v_mul_f32_dpp v158, v234, v186 quad_perm:[0,1,2,3] row_mask:0x2 bank_mask:0xf
    v_mfma_f32_16x16x32_bf16 v[234:237], v[130:133], v[36:39], 0
    v_exp_f32 v164, v164
    v_mfma_f32_16x16x32_bf16 v[234:237], v[174:177], v[126:129], v[234:237]
    v_exp_f32 v165, v165
    v_mfma_f32_16x16x32_bf16 v[238:241], v[222:225], v[36:39], 0
    v_cvt_pk_bf16_f32 v137, v164, v165
    v_mul_f32_dpp v158, v246, v186 quad_perm:[0,1,2,3] row_mask:0x4 bank_mask:0xf
    v_mfma_f32_16x16x32_bf16 v[238:241], v[182:185], v[126:129], v[238:241]
    v_exp_f32 v230, v230
    v_mfma_f32_16x16x32_bf16 v[186:189], v[166:169], v[36:39], 0
    v_exp_f32 v231, v231
    v_mfma_f32_16x16x32_bf16 v[186:189], v[114:117], v[126:129], v[186:189]
    v_cvt_pk_bf16_f32 v36, v230, v231
    v_cvt_pk_bf16_f32 v39, v214, 0
    v_mfma_f32_16x16x32_f16 v[162:165], v[118:121], v[178:181], v[70:73]
    v_exp_f32 v232, v232
    v_mfma_f32_16x16x32_f16 v[118:121], v[170:173], v[178:181], v[74:77]
    v_exp_f32 v233, v233
    v_mfma_f32_16x16x32_f16 v[170:173], v[142:145], v[178:181], v[78:81]
    v_cvt_pk_bf16_f32 v37, v232, v233
    v_cvt_pk_bf16_f32 v158, v158, v158
    v_fmac_f32 v254, v203, v203
    v_mfma_f32_16x16x16_f16 v[162:165], v[196:197], v[122:123], v[162:165]
    v_rcp_f32 v210, v210
    v_fmac_f32 v254, v204, v204
    v_mfma_f32_16x16x16_f16 v[118:121], v[220:221], v[122:123], v[118:121]
    v_mul_f32 v234, v210, v234
    v_mul_f32 v235, v210, v235
    v_cvt_pk_bf16_f32 v178, v234, v235
    v_mfma_f32_16x16x16_f16 v[170:173], v[124:125], v[122:123], v[170:173]
    v_mul_f32 v236, v210, v236
    v_exp_f32 v162, v162
    v_mul_f32 v237, v210, v237
    v_mfma_f32_16x16x32_bf16 v[194:197], v[28:31], v[36:39], 0
    ds_write_b16 v7, v158
    v_mfma_f32_16x16x32_bf16 v[194:197], v[28:31], v[134:137], v[194:197]
    v_exp_f32 v163, v163
    v_mfma_f32_16x16x32_bf16 v[122:125], v[130:133], v[36:39], 0
    v_cvt_pk_bf16_f32 v162, v162, v163
    v_cvt_pk_bf16_f32 v179, v236, v237
    v_mfma_f32_16x16x32_bf16 v[122:125], v[174:177], v[134:137], v[122:125]
    v_exp_f32 v164, v164
    v_mfma_f32_16x16x32_bf16 v[126:129], v[222:225], v[36:39], 0
    v_exp_f32 v165, v165
    v_mfma_f32_16x16x32_bf16 v[126:129], v[182:185], v[134:137], v[126:129]
    v_cvt_pk_bf16_f32 v163, v164, v165
    v_mul_f32 v238, v210, v238
    v_mfma_f32_16x16x32_bf16 v[218:221], v[166:169], v[36:39], 0
    v_exp_f32 v118, v118
    v_mfma_f32_16x16x32_bf16 v[218:221], v[114:117], v[134:137], v[218:221]
    v_exp_f32 v119, v119
    v_mfma_f32_16x16x32_bf16 v[142:145], a[216:219], v[198:201], 0
    v_cvt_pk_bf16_f32 v164, v118, v119
    v_cvt_pk_bf16_f32 v39, v154, 0
    v_mfma_f32_16x16x32_bf16 v[142:145], a[220:223], v[226:229], v[142:145]
    v_exp_f32 v120, v120
    v_mfma_f32_16x16x32_bf16 v[142:145], a[224:227], v[206:209], v[142:145]
    v_exp_f32 v121, v121
    v_mfma_f32_16x16x32_bf16 v[142:145], a[228:231], v[242:245], v[142:145]
    v_cvt_pk_bf16_f32 v165, v120, v121
    v_mul_f32 v239, v210, v239
    v_mfma_f32_16x16x32_bf16 v[142:145], a[232:235], v[146:149], v[142:145]
    v_exp_f32 v170, v170
    v_mfma_f32_16x16x32_bf16 v[142:145], a[236:239], v[138:141], v[142:145]
    v_exp_f32 v171, v171
    v_mfma_f32_16x16x32_bf16 v[158:161], a[240:243], v[198:201], 0
    v_cvt_pk_bf16_f32 v36, v170, v171
    v_cvt_pk_bf16_f32 v180, v238, v239
    v_mfma_f32_16x16x32_bf16 v[158:161], a[244:247], v[226:229], v[158:161]
    v_exp_f32 v172, v172
    v_mfma_f32_16x16x32_bf16 v[158:161], a[248:251], v[206:209], v[158:161]
    v_exp_f32 v173, v173
    v_mfma_f32_16x16x32_bf16 v[158:161], a[252:255], v[242:245], v[158:161]
    ds_read_b128 v[118:121], v2 offset:12288
    v_cvt_pk_bf16_f32 v37, v172, v173
    v_mfma_f32_16x16x32_bf16 v[158:161], v[82:85], v[146:149], v[158:161]
    ds_read_b128 v[134:137], v2 offset:13312
    v_mul_f32 v240, v210, v240
    v_mfma_f32_16x16x32_bf16 v[170:173], v[28:31], v[36:39], 0
    v_mul_f32 v241, v210, v241
    v_cvt_pk_bf16_f32 v181, v240, v241
    v_mfma_f32_16x16x32_bf16 v[170:173], v[28:31], v[162:165], v[170:173]
    ds_write_b128 v3, v[178:181] offset:0
    v_mfma_f32_16x16x32_bf16 v[154:157], v[130:133], v[36:39], 0
    v_mul_f32 v186, v210, v186
    v_mul_f32 v187, v210, v187
    v_mfma_f32_16x16x32_bf16 v[154:157], v[174:177], v[162:165], v[154:157]
    v_cvt_pk_bf16_f32 v186, v186, v187
    v_mul_f32 v188, v210, v188
    v_mfma_f32_16x16x32_bf16 v[130:133], v[222:225], v[36:39], 0
    v_mul_f32 v189, v210, v189
    v_cvt_pk_bf16_f32 v187, v188, v189
    v_mfma_f32_16x16x32_bf16 v[130:133], v[182:185], v[162:165], v[130:133]
    s_waitcnt lgkmcnt(2)
    ds_write_b64 v4, v[186:187] offset:4096
    v_mfma_f32_16x16x32_bf16 v[174:177], v[166:169], v[36:39], 0
    s_waitcnt lgkmcnt(2)
    v_fma_f32 v255, v142, v142, s33
    v_fmac_f32 v255, v143, v143
    v_mfma_f32_16x16x32_bf16 v[174:177], v[114:117], v[162:165], v[174:177]
    v_fmac_f32 v255, v144, v144
    v_fmac_f32 v255, v145, v145
    v_mfma_f32_16x16x32_bf16 v[158:161], v[86:89], v[138:141], v[158:161]
    ds_read_b128 v[114:117], v2 offset:14336
    v_fmac_f32 v254, v205, v205
    v_mfma_f32_16x16x32_bf16 v[178:181], v[90:93], v[198:201], 0
    ds_read_b128 v[166:169], v2 offset:15360
    v_add_u32 v7, 16, v7
    v_mfma_f32_16x16x32_bf16 v[178:181], v[94:97], v[226:229], v[178:181]
    ds_read_b128 v[162:165], v2 offset:16384
    v_mfma_f32_16x16x32_bf16 v[178:181], v[98:101], v[206:209], v[178:181]
    ds_read_b128 v[206:209], v2 offset:17408
    v_fmac_f32 v255, v158, v158
    v_mfma_f32_16x16x32_bf16 v[178:181], v[102:105], v[242:245], v[178:181]
    v_fmac_f32 v255, v159, v159
    v_fmac_f32 v255, v160, v160
    v_mfma_f32_16x16x32_bf16 v[178:181], v[106:109], v[146:149], v[178:181]
    v_fmac_f32 v255, v161, v161
    v_xor_b32 v2, 65536, v2
    v_mfma_f32_16x16x32_bf16 v[178:181], v[110:113], v[138:141], v[178:181]
    v_rcp_f32 v170, v170
    v_mfma_f32_16x16x32_bf16 v[146:149], a[216:219], v[118:121], 0
    v_mul_f32 v154, v170, v154
    v_mul_f32 v155, v170, v155
    v_mfma_f32_16x16x32_bf16 v[146:149], a[220:223], v[134:137], v[146:149]
    s_waitcnt lgkmcnt(3)
    ds_read_b128 v[182:185], v0 offset:20480
    v_cvt_pk_bf16_f32 v154, v154, v155
    v_mfma_f32_16x16x32_bf16 v[146:149], a[224:227], v[114:117], v[146:149]
    s_waitcnt lgkmcnt(3)
    ds_read_b128 v[198:201], v1 offset:20480
    v_fmac_f32 v255, v178, v178
    v_mfma_f32_16x16x32_bf16 v[146:149], a[228:231], v[166:169], v[146:149]
    s_waitcnt lgkmcnt(3)
    ds_read_b128 v[210:213], v0 offset:20608
    v_fmac_f32 v255, v179, v179
    v_mfma_f32_16x16x32_bf16 v[146:149], a[232:235], v[162:165], v[146:149]
    s_waitcnt lgkmcnt(3)
    ds_read_b128 v[222:225], v1 offset:20608
    v_fmac_f32 v255, v180, v180
    v_mfma_f32_16x16x32_bf16 v[146:149], a[236:239], v[206:209], v[146:149]
    ds_read_b128 v[226:229], v0 offset:20736
    v_fmac_f32 v255, v181, v181
    v_mfma_f32_16x16x32_bf16 v[138:141], a[240:243], v[118:121], 0
    ds_read_b128 v[242:245], v1 offset:20736
    v_cvt_pk_bf16_f32 v254, v254, v255
    v_mfma_f32_16x16x32_bf16 v[138:141], a[244:247], v[134:137], v[138:141]
    v_mul_f32 v156, v170, v156
    v_mul_f32 v157, v170, v157
    v_mfma_f32_16x16x32_bf16 v[138:141], a[248:251], v[114:117], v[138:141]
    v_fma_f32 v255, v146, v146, s33
    v_fmac_f32 v255, v147, v147
    v_mfma_f32_16x16x32_bf16 v[138:141], a[252:255], v[166:169], v[138:141]
    s_waitcnt lgkmcnt(5)
    v_fmac_f32 v255, v148, v148
    v_fmac_f32 v255, v149, v149
    v_mfma_f32_16x16x32_bf16 v[138:141], v[82:85], v[162:165], v[138:141]
    s_waitcnt lgkmcnt(4)
    v_cvt_pk_bf16_f32 v155, v156, v157
    v_mul_f32 v130, v170, v130
    v_mfma_f32_16x16x32_bf16 v[138:141], v[86:89], v[206:209], v[138:141]
    s_waitcnt lgkmcnt(3)
    v_mul_f32 v131, v170, v131
    v_cvt_pk_bf16_f32 v156, v130, v131
    v_mfma_f32_16x16x32_bf16 v[186:189], v[90:93], v[118:121], 0
    s_waitcnt lgkmcnt(2)
    v_mul_f32 v132, v170, v132
    v_mul_f32 v133, v170, v133
    v_mfma_f32_16x16x32_bf16 v[186:189], v[94:97], v[134:137], v[186:189]
    s_waitcnt lgkmcnt(1)
    v_fmac_f32 v255, v138, v138
    v_fmac_f32 v255, v139, v139
    v_mfma_f32_16x16x32_bf16 v[186:189], v[98:101], v[114:117], v[186:189]
    s_waitcnt lgkmcnt(0)
    v_fmac_f32 v255, v140, v140
    v_fmac_f32 v255, v141, v141
    v_mfma_f32_16x16x32_bf16 v[186:189], v[102:105], v[166:169], v[186:189]
    v_cvt_pk_bf16_f32 v157, v132, v133
    v_mul_f32 v174, v170, v174
    v_mfma_f32_16x16x32_bf16 v[186:189], v[106:109], v[162:165], v[186:189]
    ds_write_b128 v3, v[154:157] offset:12288
    v_mfma_f32_16x16x32_bf16 v[186:189], v[110:113], v[206:209], v[186:189]
    v_mul_f32 v175, v170, v175
    v_cvt_pk_bf16_f32 v174, v174, v175
    v_mfma_f32_16x16x32_bf16 v[118:121], a[72:75], v[182:185], 0
    v_mul_f32 v176, v170, v176
    v_mul_f32 v177, v170, v177
    v_mfma_f32_16x16x32_bf16 v[118:121], a[76:79], v[198:201], v[118:121]
    v_rcp_f32 v194, v194
    v_mfma_f32_16x16x32_bf16 v[118:121], a[80:83], v[210:213], v[118:121]
    v_fmac_f32 v255, v186, v186
    v_fmac_f32 v255, v187, v187
    v_mfma_f32_16x16x32_bf16 v[118:121], a[84:87], v[222:225], v[118:121]
    v_fmac_f32 v255, v188, v188
    v_fmac_f32 v255, v189, v189
    v_mfma_f32_16x16x32_bf16 v[118:121], a[88:91], v[226:229], v[118:121]
    v_cvt_pk_bf16_f32 v255, v255, v255
    v_cvt_pk_bf16_f32 v175, v176, v177
    v_mfma_f32_16x16x32_bf16 v[118:121], a[92:95], v[242:245], v[118:121]
    ds_write_b64 v4, v[174:175] offset:16384
    v_mfma_f32_16x16x32_bf16 v[206:209], a[96:99], v[182:185], 0
    v_mul_f32 v122, v194, v122
    v_mul_f32 v123, v194, v123
    v_mfma_f32_16x16x32_bf16 v[206:209], a[100:103], v[198:201], v[206:209]
    ds_write_b64 v4, v[254:255] offset:18432
    v_mfma_f32_16x16x32_bf16 v[206:209], a[104:107], v[210:213], v[206:209]
    v_cvt_pk_bf16_f32 v134, v122, v123
    v_cvt_pk_f16_f32 v118, v118, v119
    v_mfma_f32_16x16x32_bf16 v[206:209], a[108:111], v[222:225], v[206:209]
    v_pk_mul_f16 v163, v118, v118
    v_cvt_pk_f16_f32 v119, v120, v121
    v_mfma_f32_16x16x32_bf16 v[206:209], a[112:115], v[226:229], v[206:209]
    v_pk_mul_f16 v165, v119, v119
    v_mul_f32 v124, v194, v124
    v_mfma_f32_16x16x32_bf16 v[206:209], a[116:119], v[242:245], v[206:209]
    v_mul_f32 v125, v194, v125
    v_cvt_pk_bf16_f32 v135, v124, v125
    v_mfma_f32_16x16x32_bf16 v[122:125], a[120:123], v[182:185], 0
    v_mul_f32 v126, v194, v126
    v_mul_f32 v127, v194, v127
    v_mfma_f32_16x16x32_bf16 v[122:125], a[124:127], v[198:201], v[122:125]
    v_cvt_pk_bf16_f32 v136, v126, v127
    v_mul_f32 v128, v194, v128
    v_mfma_f32_16x16x32_bf16 v[122:125], a[128:131], v[210:213], v[122:125]
    v_cvt_pk_f16_f32 v120, v206, v207
    v_pk_fma_f16 v163, v120, v120, v163
    v_mfma_f32_16x16x32_bf16 v[122:125], a[132:135], v[222:225], v[122:125]
    v_cvt_pk_f16_f32 v121, v208, v209
    v_pk_fma_f16 v165, v121, v121, v165
    v_mfma_f32_16x16x32_bf16 v[122:125], a[136:139], v[226:229], v[122:125]
    v_mul_f32 v129, v194, v129
    v_cvt_pk_bf16_f32 v137, v128, v129
    v_mfma_f32_16x16x32_bf16 v[122:125], a[140:143], v[242:245], v[122:125]
    ds_write_b128 v3, v[134:137] offset:6144
    v_mfma_f32_16x16x32_bf16 v[206:209], a[0:3], v[182:185], 0
    v_mul_f32 v218, v194, v218
    v_mul_f32 v219, v194, v219
    v_mfma_f32_16x16x32_bf16 v[206:209], a[4:7], v[198:201], v[206:209]
    v_cvt_pk_bf16_f32 v254, v218, v219
    v_mul_f32 v220, v194, v220
    v_mfma_f32_16x16x32_bf16 v[206:209], a[8:11], v[210:213], v[206:209]
    v_cvt_pk_f16_f32 v196, v122, v123
    v_pk_fma_f16 v163, v196, v196, v163
    v_mfma_f32_16x16x32_bf16 v[206:209], a[12:15], v[222:225], v[206:209]
    v_cvt_pk_f16_f32 v197, v124, v125
    v_pk_fma_f16 v165, v197, v197, v165
    v_mfma_f32_16x16x32_bf16 v[206:209], a[16:19], v[226:229], v[206:209]
    v_mul_f32 v221, v194, v221
    v_cvt_pk_bf16_f32 v255, v220, v221
    v_mfma_f32_16x16x32_bf16 v[206:209], a[20:23], v[242:245], v[206:209]
    ds_write_b64 v4, v[254:255] offset:10240
    v_mfma_f32_16x16x32_bf16 v[174:177], a[24:27], v[182:185], 0
    v_xor_b32 v3, 65536, v3
    v_xor_b32 v4, 65536, v4
    v_mfma_f32_16x16x32_bf16 v[174:177], a[28:31], v[198:201], v[174:177]
    v_mfma_f32_16x16x32_bf16 v[174:177], a[32:35], v[210:213], v[174:177]
    v_mfma_f32_16x16x32_bf16 v[174:177], a[36:39], v[222:225], v[174:177]
    v_mfma_f32_16x16x32_bf16 v[174:177], a[40:43], v[226:229], v[174:177]
    v_cvt_pk_f16_f32 v206, v206, v207
    v_mfma_f32_16x16x32_bf16 v[174:177], a[44:47], v[242:245], v[174:177]
    v_mfma_f32_16x16x32_bf16 v[218:221], a[48:51], v[182:185], 0
    s_waitcnt lgkmcnt(0)
    v_mfma_f32_16x16x32_bf16 v[218:221], a[52:55], v[198:201], v[218:221]
    s_nop 0
    v_mfma_f32_16x16x32_bf16 v[218:221], a[56:59], v[210:213], v[218:221]
    s_nop 0
    v_mfma_f32_16x16x32_bf16 v[218:221], a[60:63], v[222:225], v[218:221]
    s_nop 0
    v_mfma_f32_16x16x32_bf16 v[218:221], a[64:67], v[226:229], v[218:221]
    s_barrier
    v_mfma_f32_16x16x32_bf16 v[218:221], a[68:71], v[242:245], v[218:221]
    v_mfma_f32_16x16x32_bf16 v[170:173], v[182:185], a[144:147], 0
    v_mfma_f32_16x16x32_bf16 v[170:173], v[198:201], a[148:151], v[170:173]
    v_mfma_f32_16x16x32_bf16 v[170:173], v[210:213], a[152:155], v[170:173]
    v_mfma_f32_16x16x32_bf16 v[170:173], v[222:225], a[156:159], v[170:173]
    v_mfma_f32_16x16x32_bf16 v[170:173], v[226:229], a[160:163], v[170:173]
    v_mfma_f32_16x16x32_bf16 v[170:173], v[242:245], a[164:167], v[170:173]
    s_cbranch_scc1 L_loop_fast3
L_final_fast:
    v_mfma_f32_16x16x32_bf16 v[114:117], v[182:185], a[168:171], 0
    s_mov_b32 s12, s42
    ds_read_b128 v[122:125], v2 offset:18432
    ds_read_b128 v[126:129], v2 offset:19456
    v_mfma_f32_16x16x32_bf16 v[114:117], v[198:201], a[172:175], v[114:117]
    s_mov_b32 s13, s43
    ds_read_b128 v[130:133], v0 offset:26624
    ds_read_b128 v[134:137], v1 offset:26624
    v_mfma_f32_16x16x32_bf16 v[114:117], v[210:213], a[176:179], v[114:117]
    s_mov_b32 s14, s36
    v_bfe_u32 v254, v2, 4, 6
    v_lshrrev_b32 v255, 4, v254
    v_mfma_f32_16x16x32_bf16 v[114:117], v[222:225], a[180:183], v[114:117]
    s_add_u32 s48, s42, s27
    ds_read_b128 v[154:157], v0 offset:26752
    ds_read_b128 v[166:169], v1 offset:26752
    v_mfma_f32_16x16x32_bf16 v[114:117], v[226:229], a[184:187], v[114:117]
    s_addc_u32 s49, s43, 0
    v_and_b32 v214, 15, v254
    v_lshlrev_b32 v215, 9, v255
    v_mfma_f32_16x16x32_bf16 v[114:117], v[242:245], a[188:191], v[114:117]
    s_sub_u32 s50, s36, s27
    ds_read_b128 v[230:233], v0 offset:26880
    ds_read_b128 v[234:237], v1 offset:26880
    v_mfma_f32_16x16x32_bf16 v[238:241], v[182:185], a[192:195], 0
    s_mov_b32 s51, 0x00020000
    v_lshl_add_u32 v215, v214, 4, v215
    v_add_u32 v215, 136704, v215
    v_mfma_f32_16x16x32_bf16 v[238:241], v[198:201], a[196:199], v[238:241]
    s_add_u32 s52, s42, s26
    ds_read_b128 v[182:185], v2 offset:0
    ds_read_b128 v[198:201], v2 offset:1024
    v_mfma_f32_16x16x32_bf16 v[238:241], v[210:213], a[200:203], v[238:241]
    s_waitcnt lgkmcnt(8)
    v_and_b32 v216, 0xffff, v2
    v_add_u32 v216, 148992, v216
    v_mfma_f32_16x16x32_bf16 v[210:213], v[32:35], v[122:125], 0
    s_waitcnt lgkmcnt(6)
    ds_read_b128 v[122:125], v2 offset:2048
    v_and_b32 v217, 0xffff, v4
    v_mfma_f32_16x16x32_bf16 v[210:213], v[32:35], v[126:129], v[210:213]
    s_addc_u32 s53, s43, 0
    ds_read_b128 v[126:129], v2 offset:3072
    v_add_u32 v217, 148992, v217
    v_mfma_f32_16x16x32_bf16 v[238:241], v[222:225], a[204:207], v[238:241]
    s_sub_u32 s54, s36, s26
    ds_read_b128 v[222:225], v2 offset:4096
    v_pk_mul_f16 v162, v206, v206
    v_mfma_f32_16x16x32_bf16 v[238:241], v[226:229], a[208:211], v[238:241]
    s_mov_b32 s55, 0x00020000
    v_mul_f32 v164, 0x3baaaaab, v211
    v_mul_f32 v207, 0x3baaaaab, v212
    v_mfma_f32_16x16x32_bf16 v[238:241], v[242:245], a[212:215], v[238:241]
    s_add_u32 s56, s42, s25
    ds_read_b128 v[226:229], v2 offset:5120
    s_addc_u32 s57, s43, 0
    s_sub_u32 s58, s36, s25
    s_mov_b32 s59, 0x00020000
    v_rsq_f32 v164, v164
    v_rsq_f32 v207, v207
    v_mul_f32 v142, v164, v142
    v_mul_f32 v143, v164, v143
    v_cvt_pk_bf16_f32 v142, v142, v143
    v_mfma_f32_16x16x32_bf16 v[242:245], a[72:75], v[130:133], 0
    s_lshl_b32 s3, s16, 6
    v_mul_f32 v144, v164, v144
    v_mul_f32 v145, v164, v145
    v_mfma_f32_16x16x32_bf16 v[242:245], a[76:79], v[134:137], v[242:245]
    s_waitcnt lgkmcnt(2)
    v_cvt_pk_bf16_f32 v143, v144, v145
    v_mul_f32 v158, v164, v158
    v_mfma_f32_16x16x32_bf16 v[242:245], a[80:83], v[154:157], v[242:245]
    s_lshl_b32 s4, s16, 5
    v_mul_f32 v159, v164, v159
    v_cvt_pk_bf16_f32 v144, v158, v159
    v_mfma_f32_16x16x32_bf16 v[242:245], a[84:87], v[166:169], v[242:245]
    s_add_u32 s4, s4, 256
    v_mul_f32 v160, v164, v160
    v_mul_f32 v161, v164, v161
    v_mfma_f32_16x16x32_bf16 v[242:245], a[88:91], v[230:233], v[242:245]
    s_mul_i32 s5, s16, 8064
    v_cvt_pk_bf16_f32 v145, v160, v161
    v_mul_f32 v178, v164, v178
    v_mfma_f32_16x16x32_bf16 v[242:245], a[92:95], v[234:237], v[242:245]
    s_add_u32 s5, s5, 104448
    buffer_store_dwordx4 v[142:145], v16, s[48:51], 0 offen nt
    v_mul_f32 v179, v164, v179
    v_cvt_pk_bf16_f32 v194, v178, v179
    v_mul_f32 v180, v164, v180
    v_mul_f32 v181, v164, v181
    v_mfma_f32_16x16x32_bf16 v[142:145], a[216:219], v[182:185], 0
    s_waitcnt lgkmcnt(0)
    v_cvt_pk_bf16_f32 v195, v180, v181
    v_mul_f32 v146, v207, v146
    v_mfma_f32_16x16x32_bf16 v[142:145], a[220:223], v[198:201], v[142:145]
    v_mul_f32 v147, v207, v147
    v_cvt_pk_bf16_f32 v146, v146, v147
    v_mfma_f32_16x16x32_bf16 v[142:145], a[224:227], v[122:125], v[142:145]
    v_mul_f32 v148, v207, v148
    v_mul_f32 v149, v207, v149
    v_mfma_f32_16x16x32_bf16 v[142:145], a[228:231], v[126:129], v[142:145]
    v_cvt_pk_bf16_f32 v147, v148, v149
    v_mul_f32 v138, v207, v138
    v_mfma_f32_16x16x32_bf16 v[142:145], a[232:235], v[222:225], v[142:145]
    v_mul_f32 v139, v207, v139
    v_cvt_pk_bf16_f32 v148, v138, v139
    v_mfma_f32_16x16x32_bf16 v[142:145], a[236:239], v[226:229], v[142:145]
    v_mul_f32 v140, v207, v140
    v_mul_f32 v141, v207, v141
    v_mfma_f32_16x16x32_bf16 v[158:161], a[240:243], v[182:185], 0
    v_cvt_pk_bf16_f32 v149, v140, v141
    v_mul_f32 v186, v207, v186
    v_mfma_f32_16x16x32_bf16 v[158:161], a[244:247], v[198:201], v[158:161]
    v_mul_f32 v187, v207, v187
    v_cvt_pk_bf16_f32 v186, v186, v187
    v_mfma_f32_16x16x32_bf16 v[158:161], a[248:251], v[122:125], v[158:161]
    v_mul_f32 v188, v207, v188
    v_mul_f32 v189, v207, v189
    v_mfma_f32_16x16x32_bf16 v[158:161], a[252:255], v[126:129], v[158:161]
    v_cvt_pk_bf16_f32 v187, v188, v189
    v_mul_f32 v164, 0x3baaaaab, v210
    v_mfma_f32_16x16x32_bf16 v[158:161], v[82:85], v[222:225], v[158:161]
    v_rsq_f32 v164, v164
    v_mfma_f32_16x16x32_bf16 v[158:161], v[86:89], v[226:229], v[158:161]
    v_mul_f32 v150, v164, v150
    v_mul_f32 v151, v164, v151
    v_mfma_f32_16x16x32_bf16 v[138:141], v[90:93], v[182:185], 0
    ds_read_b128 v[178:181], v2 offset:6144
    v_cvt_pk_bf16_f32 v150, v150, v151
    v_mfma_f32_16x16x32_bf16 v[138:141], v[94:97], v[198:201], v[138:141]
    ds_read_b128 v[182:185], v2 offset:7168
    v_mul_f32 v152, v164, v152
    v_mfma_f32_16x16x32_bf16 v[138:141], v[98:101], v[122:125], v[138:141]
    ds_read_b128 v[122:125], v2 offset:8192
    buffer_store_dwordx2 v[194:195], v19, s[48:51], 0 offen nt
    v_mul_f32 v153, v164, v153
    v_cvt_pk_bf16_f32 v151, v152, v153
    v_mfma_f32_16x16x32_bf16 v[138:141], v[102:105], v[126:129], v[138:141]
    ds_read_b128 v[126:129], v2 offset:9216
    v_mul_f32 v190, v164, v190
    v_mfma_f32_16x16x32_bf16 v[138:141], v[106:109], v[222:225], v[138:141]
    ds_read_b128 v[198:201], v2 offset:10240
    v_mul_f32 v191, v164, v191
    v_mfma_f32_16x16x32_bf16 v[138:141], v[110:113], v[226:229], v[138:141]
    ds_read_b128 v[210:213], v2 offset:11264
    v_cvt_pk_bf16_f32 v152, v190, v191
    v_mfma_f32_16x16x32_bf16 v[222:225], a[96:99], v[130:133], 0
    v_mul_f32 v192, v164, v192
    v_mul_f32 v193, v164, v193
    v_mfma_f32_16x16x32_bf16 v[222:225], a[100:103], v[134:137], v[222:225]
    s_waitcnt lgkmcnt(5)
    v_cvt_pk_bf16_f32 v153, v192, v193
    v_mul_f32 v202, v164, v202
    v_mfma_f32_16x16x32_bf16 v[190:193], a[216:219], v[178:181], 0
    s_waitcnt lgkmcnt(4)
    v_mul_f32 v203, v164, v203
    v_cvt_pk_bf16_f32 v188, v202, v203
    v_mfma_f32_16x16x32_bf16 v[190:193], a[220:223], v[182:185], v[190:193]
    s_waitcnt lgkmcnt(3)
    v_mul_f32 v204, v164, v204
    v_mul_f32 v205, v164, v205
    v_mfma_f32_16x16x32_bf16 v[190:193], a[224:227], v[122:125], v[190:193]
    v_cvt_pk_bf16_f32 v189, v204, v205
    v_fma_f32 v202, v142, v142, s33
    v_mfma_f32_16x16x32_bf16 v[226:229], a[240:243], v[178:181], 0
    s_waitcnt lgkmcnt(2)
    v_fmac_f32 v202, v143, v143
    v_fmac_f32 v202, v144, v144
    v_mfma_f32_16x16x32_bf16 v[190:193], a[228:231], v[126:129], v[190:193]
    s_waitcnt lgkmcnt(1)
    v_fmac_f32 v202, v145, v145
    v_fmac_f32 v202, v158, v158
    v_mfma_f32_16x16x32_bf16 v[190:193], a[232:235], v[198:201], v[190:193]
    s_waitcnt lgkmcnt(0)
    v_fmac_f32 v202, v159, v159
    v_fmac_f32 v202, v160, v160
    v_mfma_f32_16x16x32_bf16 v[190:193], a[236:239], v[210:213], v[190:193]
    v_fmac_f32 v202, v161, v161
    v_fmac_f32 v202, v138, v138
    v_mfma_f32_16x16x32_bf16 v[226:229], a[244:247], v[182:185], v[226:229]
    v_fmac_f32 v202, v139, v139
    v_fmac_f32 v202, v140, v140
    v_mfma_f32_16x16x32_bf16 v[226:229], a[248:251], v[122:125], v[226:229]
    v_fmac_f32 v202, v141, v141
    v_cvt_pk_f16_f32 v207, v208, v209
    v_mfma_f32_16x16x32_bf16 v[226:229], a[252:255], v[126:129], v[226:229]
    v_fma_f32 v203, v190, v190, s33
    v_fmac_f32 v203, v191, v191
    v_mfma_f32_16x16x32_bf16 v[226:229], v[82:85], v[198:201], v[226:229]
    buffer_store_dwordx4 v[146:149], v17, s[48:51], 0 offen nt
    v_fmac_f32 v203, v192, v192
    v_fmac_f32 v203, v193, v193
    v_pk_mul_f16 v164, v207, v207
    v_cvt_pk_f16_f32 v208, v174, v175
    v_mfma_f32_16x16x32_bf16 v[226:229], v[86:89], v[210:213], v[226:229]
    v_pk_fma_f16 v162, v208, v208, v162
    v_cvt_pk_f16_f32 v209, v176, v177
    v_mfma_f32_16x16x32_bf16 v[146:149], v[90:93], v[178:181], 0
    ds_read_b128 v[174:177], v2 offset:12288
    v_pk_fma_f16 v164, v209, v209, v164
    v_mfma_f32_16x16x32_bf16 v[146:149], v[94:97], v[182:185], v[146:149]
    ds_read_b128 v[178:181], v2 offset:13312
    v_cvt_pk_f16_f32 v194, v218, v219
    v_mfma_f32_16x16x32_bf16 v[146:149], v[98:101], v[122:125], v[146:149]
    ds_read_b128 v[122:125], v2 offset:14336
    v_fmac_f32 v203, v226, v226
    v_mfma_f32_16x16x32_bf16 v[146:149], v[102:105], v[126:129], v[146:149]
    ds_read_b128 v[126:129], v2 offset:15360
    v_fmac_f32 v203, v227, v227
    v_mfma_f32_16x16x32_bf16 v[146:149], v[106:109], v[198:201], v[146:149]
    ds_read_b128 v[182:185], v2 offset:16384
    v_fmac_f32 v203, v228, v228
    v_mfma_f32_16x16x32_bf16 v[146:149], v[110:113], v[210:213], v[146:149]
    ds_read_b128 v[198:201], v2 offset:17408
    v_fmac_f32 v203, v229, v229
    v_mfma_f32_16x16x32_bf16 v[222:225], a[104:107], v[154:157], v[222:225]
    v_pk_fma_f16 v162, v194, v194, v162
    v_cvt_pk_f16_f32 v195, v220, v221
    v_mfma_f32_16x16x32_bf16 v[222:225], a[108:111], v[166:169], v[222:225]
    v_pk_fma_f16 v164, v195, v195, v164
    v_cvt_pk_bf16_f32 v170, v170, v171
    v_mfma_f32_16x16x32_bf16 v[222:225], a[112:115], v[230:233], v[222:225]
    s_waitcnt lgkmcnt(5)
    v_fmac_f32 v203, v146, v146
    v_fmac_f32 v203, v147, v147
    v_mfma_f32_16x16x32_f16 v[210:213], v[40:43], v[162:165], 0
    s_waitcnt lgkmcnt(4)
    v_fmac_f32 v203, v148, v148
    v_fmac_f32 v203, v149, v149
    v_mfma_f32_16x16x32_bf16 v[162:165], a[216:219], v[174:177], 0
    s_waitcnt lgkmcnt(3)
    v_cvt_pk_bf16_f32 v202, v202, v203
    v_cvt_pk_bf16_f32 v203, v203, v203
    v_mfma_f32_16x16x32_bf16 v[162:165], a[220:223], v[178:181], v[162:165]
    s_waitcnt lgkmcnt(2)
    ds_write_b64 v217, v[202:203] offset:0
    v_mfma_f32_16x16x32_bf16 v[162:165], a[224:227], v[122:125], v[162:165]
    s_waitcnt lgkmcnt(1)
    v_rsq_f32 v212, v210
    v_mfma_f32_16x16x32_bf16 v[162:165], a[228:231], v[126:129], v[162:165]
    buffer_store_dwordx2 v[186:187], v20, s[48:51], 0 offen nt
    v_rsq_f32 v213, v211
    v_mfma_f32_16x16x32_bf16 v[162:165], a[232:235], v[182:185], v[162:165]
    v_mul_f32 v212, s31, v212
    v_cvt_pk_f16_f32 v212, v212, v213
    v_mfma_f32_16x16x32_bf16 v[162:165], a[236:239], v[198:201], v[162:165]
    v_cvt_pk_bf16_f32 v171, v172, v173
    v_cvt_pk_bf16_f32 v114, v114, v115
    v_mfma_f32_16x16x32_bf16 v[202:205], a[240:243], v[174:177], 0
    v_cvt_pk_bf16_f32 v115, v116, v117
    v_cvt_pk_bf16_f32 v186, v238, v239
    v_mfma_f32_16x16x32_bf16 v[202:205], a[244:247], v[178:181], v[202:205]
    v_cvt_pk_bf16_f32 v187, v240, v241
    v_pk_mul_f16 v118, v118, v212 op_sel:[0,1] op_sel_hi:[1,1]
    v_mfma_f32_16x16x32_bf16 v[202:205], a[248:251], v[122:125], v[202:205]
    s_waitcnt lgkmcnt(0)
    v_pk_mul_f16 v119, v119, v212 op_sel:[0,1] op_sel_hi:[1,1]
    v_pk_mul_f16 v120, v120, v212 op_sel:[0,1] op_sel_hi:[1,1]
    v_mfma_f32_16x16x32_bf16 v[202:205], a[252:255], v[126:129], v[202:205]
    s_barrier
    ds_read_b128 v[218:221], v216 offset:0
    v_pk_mul_f16 v121, v121, v212 op_sel:[0,1] op_sel_hi:[1,1]
    v_mfma_f32_16x16x32_bf16 v[202:205], v[82:85], v[182:185], v[202:205]
    v_pk_mul_f16 v196, v196, v212 op_sel:[0,1] op_sel_hi:[1,1]
    v_pk_mul_f16 v197, v197, v212 op_sel:[0,1] op_sel_hi:[1,1]
    v_mfma_f32_16x16x32_bf16 v[202:205], v[86:89], v[198:201], v[202:205]
    v_pk_mul_f16 v206, v206, v212 op_sel:[0,0] op_sel_hi:[1,0]
    v_pk_mul_f16 v207, v207, v212 op_sel:[0,0] op_sel_hi:[1,0]
    v_mfma_f32_16x16x32_bf16 v[222:225], a[116:119], v[234:237], v[222:225]
    v_pk_mul_f16 v208, v208, v212 op_sel:[0,0] op_sel_hi:[1,0]
    v_pk_mul_f16 v209, v209, v212 op_sel:[0,0] op_sel_hi:[1,0]
    v_pk_mul_f16 v194, v194, v212 op_sel:[0,0] op_sel_hi:[1,0]
    v_pk_mul_f16 v195, v195, v212 op_sel:[0,0] op_sel_hi:[1,0]
    v_mfma_f32_16x16x32_bf16 v[238:241], v[90:93], v[174:177], 0
    ds_read_b128 v[174:177], v216 offset:1024
    v_min3_u32 v44, v44, v210, v211
    v_mfma_f32_16x16x32_bf16 v[238:241], v[94:97], v[178:181], v[238:241]
    ds_read_b128 v[178:181], v215 offset:0
    v_max3_u32 v45, v45, v210, v211
    v_mfma_f32_16x16x32_bf16 v[238:241], v[98:101], v[122:125], v[238:241]
    ds_read_b128 v[122:125], v215 offset:2048
    v_mov_b32 v210, 0x40000000
    v_mfma_f32_16x16x32_bf16 v[238:241], v[102:105], v[126:129], v[238:241]
    s_waitcnt lgkmcnt(3)
    ds_read_b128 v[126:129], v215 offset:4096
    v_add_u32 v116, 0, v214
    v_mfma_f32_16x16x32_bf16 v[238:241], v[106:109], v[182:185], v[238:241]
    ds_read_b128 v[182:185], v215 offset:6144
    v_mul_u32_u24 v117, s20, v116
    v_mfma_f32_16x16x32_bf16 v[238:241], v[110:113], v[198:201], v[238:241]
    buffer_store_dwordx4 v[150:153], v15, s[48:51], 0 offen nt
    ds_read_b128 v[198:201], v215 offset:8192
    v_add_u32 v117, s38, v117
    v_mul_u32_u24 v117, 911, v117
    v_lshrrev_b32 v117, 16, v117
    v_mul_u32_u24 v117, s22, v117
    v_mad_u32_u24 v117, v116, s21, v117
    v_cmp_gt_u32 vcc, s17, v116
    v_mfma_f32_16x16x32_bf16 v[150:153], v[32:35], v[218:221], 0
    s_waitcnt lgkmcnt(5)
    ds_read_b128 v[218:221], v215 offset:10240
    v_add_u32 v116, s7, v117
    v_mfma_f32_16x16x32_bf16 v[150:153], v[32:35], v[174:177], v[150:153]
    s_waitcnt lgkmcnt(5)
    v_cndmask_b32 v116, v210, v116, vcc
    v_lshl_add_u32 v211, v255, 4, v116
    v_mfma_f32_16x16x32_bf16 v[174:177], a[120:123], v[130:133], 0
    s_waitcnt lgkmcnt(4)
    v_add_u32 v211, s3, v211
    v_lshl_add_u32 v212, v255, 3, v116
    v_mfma_f32_16x16x32_bf16 v[174:177], a[124:127], v[134:137], v[174:177]
    s_waitcnt lgkmcnt(3)
    v_mul_f32 v213, 0x3baaaaab, v151
    v_mul_f32 v116, 0x3baaaaab, v150
    v_mfma_f32_16x16x32_bf16 v[174:177], a[128:131], v[154:157], v[174:177]
    s_waitcnt lgkmcnt(2)
    v_rsq_f32 v213, v213
    v_mfma_f32_16x16x32_bf16 v[174:177], a[132:135], v[166:169], v[174:177]
    s_waitcnt lgkmcnt(1)
    v_mul_f32 v190, v213, v190
    v_mul_f32 v191, v213, v191
    v_mfma_f32_16x16x32_bf16 v[174:177], a[136:139], v[230:233], v[174:177]
    v_cvt_pk_bf16_f32 v150, v190, v191
    v_mul_f32 v192, v213, v192
    v_mfma_f32_16x16x32_bf16 v[174:177], a[140:143], v[234:237], v[174:177]
    v_mul_f32 v193, v213, v193
    v_cvt_pk_bf16_f32 v151, v192, v193
    v_mul_f32 v226, v213, v226
    v_mul_f32 v227, v213, v227
    v_cvt_pk_bf16_f32 v152, v226, v227
    v_mfma_f32_16x16x32_bf16 v[190:193], a[216:219], v[178:181], 0
    s_waitcnt lgkmcnt(0)
    v_mul_f32 v228, v213, v228
    v_mul_f32 v229, v213, v229
    v_mfma_f32_16x16x32_bf16 v[190:193], a[220:223], v[122:125], v[190:193]
    v_cvt_pk_bf16_f32 v153, v228, v229
    v_mul_f32 v146, v213, v146
    v_mfma_f32_16x16x32_bf16 v[190:193], a[224:227], v[126:129], v[190:193]
    v_mul_f32 v147, v213, v147
    v_cvt_pk_bf16_f32 v172, v146, v147
    v_mfma_f32_16x16x32_bf16 v[190:193], a[228:231], v[182:185], v[190:193]
    v_mul_f32 v148, v213, v148
    v_mul_f32 v149, v213, v149
    v_mfma_f32_16x16x32_bf16 v[190:193], a[232:235], v[198:201], v[190:193]
    v_cvt_pk_bf16_f32 v173, v148, v149
    v_add_u32 v212, s4, v212
    v_mfma_f32_16x16x32_bf16 v[190:193], a[236:239], v[218:221], v[190:193]
    buffer_store_dwordx4 v[150:153], v16, s[52:55], 0 offen nt
    v_rsq_f32 v116, v116
    v_fma_f32 v213, v162, v162, s33
    v_mul_f32 v142, v116, v142
    v_mfma_f32_16x16x32_bf16 v[146:149], a[240:243], v[178:181], 0
    v_mul_f32 v143, v116, v143
    v_cvt_pk_bf16_f32 v142, v142, v143
    v_mfma_f32_16x16x32_bf16 v[146:149], a[244:247], v[122:125], v[146:149]
    v_mul_f32 v144, v116, v144
    v_mul_f32 v145, v116, v145
    v_mfma_f32_16x16x32_bf16 v[146:149], a[248:251], v[126:129], v[146:149]
    v_cvt_pk_bf16_f32 v143, v144, v145
    v_mul_f32 v158, v116, v158
    v_mfma_f32_16x16x32_bf16 v[146:149], a[252:255], v[182:185], v[146:149]
    v_mul_f32 v159, v116, v159
    v_cvt_pk_bf16_f32 v144, v158, v159
    v_mfma_f32_16x16x32_bf16 v[146:149], v[82:85], v[198:201], v[146:149]
    v_mul_f32 v160, v116, v160
    v_mul_f32 v161, v116, v161
    v_mfma_f32_16x16x32_bf16 v[146:149], v[86:89], v[218:221], v[146:149]
    v_cvt_pk_bf16_f32 v145, v160, v161
    v_mul_f32 v138, v116, v138
    v_mfma_f32_16x16x32_bf16 v[150:153], v[90:93], v[178:181], 0
    v_mul_f32 v139, v116, v139
    v_cvt_pk_bf16_f32 v138, v138, v139
    v_mfma_f32_16x16x32_bf16 v[150:153], v[94:97], v[122:125], v[150:153]
    v_mul_f32 v140, v116, v140
    v_mul_f32 v141, v116, v141
    v_mfma_f32_16x16x32_bf16 v[150:153], v[98:101], v[126:129], v[150:153]
    v_cvt_pk_bf16_f32 v139, v140, v141
    v_fma_f32 v116, v190, v190, s33
    v_mfma_f32_16x16x32_bf16 v[150:153], v[102:105], v[182:185], v[150:153]
    v_fmac_f32 v116, v191, v191
    v_fmac_f32 v116, v192, v192
    v_mfma_f32_16x16x32_bf16 v[150:153], v[106:109], v[198:201], v[150:153]
    v_fmac_f32 v116, v193, v193
    v_fmac_f32 v116, v146, v146
    v_mfma_f32_16x16x32_bf16 v[150:153], v[110:113], v[218:221], v[150:153]
    v_fmac_f32 v116, v147, v147
    v_fmac_f32 v116, v148, v148
    v_mfma_f32_16x16x32_bf16 v[122:125], a[0:3], v[130:133], 0
    v_fmac_f32 v116, v149, v149
    v_fmac_f32 v213, v163, v163
    v_mfma_f32_16x16x32_bf16 v[122:125], a[4:7], v[134:137], v[122:125]
    v_fmac_f32 v213, v164, v164
    v_fmac_f32 v213, v165, v165
    v_mfma_f32_16x16x32_bf16 v[122:125], a[8:11], v[154:157], v[122:125]
    v_fmac_f32 v116, v150, v150
    v_fmac_f32 v116, v151, v151
    v_mfma_f32_16x16x32_bf16 v[122:125], a[12:15], v[166:169], v[122:125]
    buffer_store_dwordx2 v[172:173], v19, s[52:55], 0 offen nt
    v_fmac_f32 v116, v152, v152
    v_fmac_f32 v116, v153, v153
    v_mfma_f32_16x16x32_bf16 v[122:125], a[16:19], v[230:233], v[122:125]
    v_cvt_pk_bf16_f32 v117, v116, v116
    v_fmac_f32 v213, v202, v202
    v_mfma_f32_16x16x32_bf16 v[122:125], a[20:23], v[234:237], v[122:125]
    v_fmac_f32 v213, v203, v203
    v_fmac_f32 v213, v204, v204
    v_mfma_f32_16x16x32_bf16 v[126:129], a[24:27], v[130:133], 0
    v_fmac_f32 v213, v205, v205
    v_fmac_f32 v213, v238, v238
    v_mfma_f32_16x16x32_bf16 v[126:129], a[28:31], v[134:137], v[126:129]
    v_fmac_f32 v213, v239, v239
    v_fmac_f32 v213, v240, v240
    v_mfma_f32_16x16x32_bf16 v[126:129], a[32:35], v[154:157], v[126:129]
    v_fmac_f32 v213, v241, v241
    v_cvt_pk_bf16_f32 v116, v213, v116
    v_mfma_f32_16x16x32_bf16 v[126:129], a[36:39], v[166:169], v[126:129]
    ds_write_b64 v217, v[116:117] offset:2048
    v_mfma_f32_16x16x32_bf16 v[126:129], a[40:43], v[230:233], v[126:129]
    v_cvt_pk_f16_f32 v122, v122, v123
    v_pk_mul_f16 v158, v122, v122
    v_mfma_f32_16x16x32_bf16 v[126:129], a[44:47], v[234:237], v[126:129]
    v_cvt_pk_f16_f32 v123, v124, v125
    v_pk_mul_f16 v160, v123, v123
    v_mfma_f32_16x16x32_bf16 v[178:181], a[48:51], v[130:133], 0
    v_cvt_pk_f16_f32 v182, v242, v243
    v_pk_mul_f16 v159, v182, v182
    v_mfma_f32_16x16x32_bf16 v[178:181], a[52:55], v[134:137], v[178:181]
    v_cvt_pk_f16_f32 v183, v244, v245
    v_pk_mul_f16 v161, v183, v183
    v_mfma_f32_16x16x32_bf16 v[178:181], a[56:59], v[154:157], v[178:181]
    v_cvt_pk_f16_f32 v124, v126, v127
    v_pk_fma_f16 v158, v124, v124, v158
    v_mfma_f32_16x16x32_bf16 v[178:181], a[60:63], v[166:169], v[178:181]
    v_cvt_pk_f16_f32 v125, v128, v129
    v_pk_fma_f16 v160, v125, v125, v160
    v_mfma_f32_16x16x32_bf16 v[178:181], a[64:67], v[230:233], v[178:181]
    s_waitcnt lgkmcnt(0)
    v_cvt_pk_f16_f32 v184, v222, v223
    v_pk_fma_f16 v159, v184, v184, v159
    v_mfma_f32_16x16x32_bf16 v[178:181], a[68:71], v[234:237], v[178:181]
    s_barrier
    ds_read_b128 v[126:129], v216 offset:2048
    ds_read_b128 v[198:201], v216 offset:3072
    v_mfma_f32_16x16x32_bf16 v[218:221], v[130:133], a[144:147], 0
    v_cvt_pk_f16_f32 v185, v224, v225
    v_pk_fma_f16 v161, v185, v185, v161
    v_mfma_f32_16x16x32_bf16 v[218:221], v[134:137], a[148:151], v[218:221]
    buffer_store_dwordx2 v[188:189], v18, s[48:51], 0 offen nt
    v_cvt_pk_f16_f32 v178, v178, v179
    v_pk_fma_f16 v158, v178, v178, v158
    v_mfma_f32_16x16x32_bf16 v[218:221], v[154:157], a[152:155], v[218:221]
    v_cvt_pk_f16_f32 v179, v180, v181
    v_pk_fma_f16 v160, v179, v179, v160
    v_mfma_f32_16x16x32_bf16 v[218:221], v[166:169], a[156:159], v[218:221]
    v_cvt_pk_f16_f32 v180, v174, v175
    v_pk_fma_f16 v159, v180, v180, v159
    v_mfma_f32_16x16x32_bf16 v[218:221], v[230:233], a[160:163], v[218:221]
    v_cvt_pk_f16_f32 v181, v176, v177
    v_pk_fma_f16 v161, v181, v181, v161
    v_mfma_f32_16x16x32_bf16 v[218:221], v[234:237], a[164:167], v[218:221]
    ds_read_b128 v[174:177], v0 offset:32768
    v_xor_b32 v213, 65536, v2
    v_mfma_f32_16x16x32_f16 v[222:225], v[40:43], v[158:161], 0
    s_waitcnt lgkmcnt(2)
    v_bfe_u32 v140, v214, 1, 2
    v_xor_b32 v140, v140, v255
    v_mfma_f32_16x16x32_bf16 v[158:161], v[32:35], v[126:129], 0
    s_waitcnt lgkmcnt(1)
    v_cvt_pk_bf16_f32 v172, v218, v219
    v_cvt_pk_bf16_f32 v173, v220, v221
    v_mfma_f32_16x16x32_bf16 v[158:161], v[32:35], v[198:201], v[158:161]
    v_rsq_f32 v224, v222
    v_mfma_f32_16x16x32_bf16 v[126:129], v[130:133], a[168:171], 0
    ds_read_b128 v[198:201], v1 offset:32768
    v_mul_f32 v224, s31, v224
    v_mfma_f32_16x16x32_bf16 v[126:129], v[134:137], a[172:175], v[126:129]
    ds_read_b128 v[218:221], v0 offset:32896
    v_min3_u32 v44, v44, v222, v223
    v_mfma_f32_16x16x32_bf16 v[126:129], v[154:157], a[176:179], v[126:129]
    ds_read_b128 v[226:229], v1 offset:32896
    v_mul_f32 v141, 0x3baaaaab, v159
    v_mfma_f32_16x16x32_bf16 v[126:129], v[166:169], a[180:183], v[126:129]
    ds_read_b128 v[242:245], v0 offset:33024
    v_max3_u32 v45, v45, v222, v223
    v_mfma_f32_16x16x32_bf16 v[126:129], v[230:233], a[184:187], v[126:129]
    s_waitcnt lgkmcnt(4)
    v_rsq_f32 v225, v223
    v_mfma_f32_16x16x32_bf16 v[126:129], v[234:237], a[188:191], v[126:129]
    v_cvt_pk_f16_f32 v224, v224, v225
    v_pk_mul_f16 v182, v182, v224 op_sel:[0,1] op_sel_hi:[1,1]
    v_mfma_f32_16x16x32_bf16 v[246:249], v[130:133], a[192:195], 0
    ds_read_b128 v[130:133], v1 offset:33024
    v_pk_mul_f16 v183, v183, v224 op_sel:[0,1] op_sel_hi:[1,1]
    v_mfma_f32_16x16x32_bf16 v[246:249], v[134:137], a[196:199], v[246:249]
    v_rsq_f32 v141, v141
    v_mfma_f32_16x16x32_bf16 v[246:249], v[154:157], a[200:203], v[246:249]
    s_waitcnt lgkmcnt(4)
    buffer_store_dwordx4 v[142:145], v15, s[52:55], 0 offen nt
    v_cvt_pk_bf16_f32 v116, v126, v127
    v_cvt_pk_bf16_f32 v117, v128, v129
    v_mul_f32 v190, v141, v190
    v_mul_f32 v191, v141, v191
    v_mfma_f32_16x16x32_bf16 v[246:249], v[166:169], a[204:207], v[246:249]
    s_waitcnt lgkmcnt(2)
    v_cvt_pk_bf16_f32 v126, v190, v191
    v_mul_f32 v192, v141, v192
    v_mfma_f32_16x16x32_bf16 v[246:249], v[230:233], a[208:211], v[246:249]
    s_waitcnt lgkmcnt(1)
    v_mul_f32 v193, v141, v193
    v_cvt_pk_bf16_f32 v127, v192, v193
    v_mfma_f32_16x16x32_bf16 v[246:249], v[234:237], a[212:215], v[246:249]
    v_mul_f32 v146, v141, v146
    v_mul_f32 v147, v141, v147
    v_mfma_f32_16x16x32_bf16 v[134:137], a[72:75], v[174:177], 0
    v_cvt_pk_bf16_f32 v128, v146, v147
    v_mul_f32 v148, v141, v148
    v_mfma_f32_16x16x32_bf16 v[134:137], a[76:79], v[198:201], v[134:137]
    s_waitcnt lgkmcnt(0)
    v_mul_f32 v149, v141, v149
    v_cvt_pk_bf16_f32 v129, v148, v149
    v_mfma_f32_16x16x32_bf16 v[134:137], a[80:83], v[218:221], v[134:137]
    v_mul_f32 v150, v141, v150
    v_mul_f32 v151, v141, v151
    v_mfma_f32_16x16x32_bf16 v[134:137], a[84:87], v[226:229], v[134:137]
    v_cvt_pk_bf16_f32 v160, v150, v151
    v_mul_f32 v152, v141, v152
    v_mfma_f32_16x16x32_bf16 v[134:137], a[88:91], v[242:245], v[134:137]
    v_mul_f32 v153, v141, v153
    v_cvt_pk_bf16_f32 v161, v152, v153
    v_mfma_f32_16x16x32_bf16 v[134:137], a[92:95], v[130:133], v[134:137]
    v_cvt_pk_bf16_f32 v188, v246, v247
    v_cvt_pk_bf16_f32 v189, v248, v249
    v_mfma_f32_16x16x32_bf16 v[142:145], a[96:99], v[174:177], 0
    v_pk_mul_f16 v184, v184, v224 op_sel:[0,1] op_sel_hi:[1,1]
    v_pk_mul_f16 v185, v185, v224 op_sel:[0,1] op_sel_hi:[1,1]
    v_mfma_f32_16x16x32_bf16 v[142:145], a[100:103], v[198:201], v[142:145]
    v_pk_mul_f16 v180, v180, v224 op_sel:[0,1] op_sel_hi:[1,1]
    v_pk_mul_f16 v181, v181, v224 op_sel:[0,1] op_sel_hi:[1,1]
    v_mfma_f32_16x16x32_bf16 v[142:145], a[104:107], v[218:221], v[142:145]
    v_pk_mul_f16 v122, v122, v224 op_sel:[0,0] op_sel_hi:[1,0]
    v_pk_mul_f16 v123, v123, v224 op_sel:[0,0] op_sel_hi:[1,0]
    v_mfma_f32_16x16x32_bf16 v[142:145], a[108:111], v[226:229], v[142:145]
    v_pk_mul_f16 v124, v124, v224 op_sel:[0,0] op_sel_hi:[1,0]
    v_pk_mul_f16 v125, v125, v224 op_sel:[0,0] op_sel_hi:[1,0]
    v_mfma_f32_16x16x32_bf16 v[142:145], a[112:115], v[242:245], v[142:145]
    v_pk_mul_f16 v178, v178, v224 op_sel:[0,0] op_sel_hi:[1,0]
    v_pk_mul_f16 v179, v179, v224 op_sel:[0,0] op_sel_hi:[1,0]
    v_mfma_f32_16x16x32_bf16 v[142:145], a[116:119], v[130:133], v[142:145]
    v_mul_f32 v158, 0x3baaaaab, v158
    v_lshl_add_u32 v140, v214, 2, v140
    v_mfma_f32_16x16x32_bf16 v[146:149], a[120:123], v[174:177], 0
    buffer_store_dwordx2 v[138:139], v18, s[52:55], 0 offen nt
    v_rsq_f32 v158, v158
    v_mfma_f32_16x16x32_bf16 v[146:149], a[124:127], v[198:201], v[146:149]
    v_mul_f32 v162, v158, v162
    v_mul_f32 v163, v158, v163
    v_mfma_f32_16x16x32_bf16 v[146:149], a[128:131], v[218:221], v[146:149]
    v_cvt_pk_bf16_f32 v150, v162, v163
    v_mul_f32 v164, v158, v164
    v_mfma_f32_16x16x32_bf16 v[146:149], a[132:135], v[226:229], v[146:149]
    v_mul_f32 v165, v158, v165
    v_cvt_pk_bf16_f32 v151, v164, v165
    v_mfma_f32_16x16x32_bf16 v[146:149], a[136:139], v[242:245], v[146:149]
    v_mul_f32 v202, v158, v202
    v_mul_f32 v203, v158, v203
    v_mfma_f32_16x16x32_bf16 v[146:149], a[140:143], v[130:133], v[146:149]
    v_cvt_pk_bf16_f32 v152, v202, v203
    v_mul_f32 v204, v158, v204
    v_mfma_f32_16x16x32_bf16 v[154:157], a[0:3], v[174:177], 0
    v_mul_f32 v205, v158, v205
    v_cvt_pk_bf16_f32 v153, v204, v205
    v_mfma_f32_16x16x32_bf16 v[154:157], a[4:7], v[198:201], v[154:157]
    v_mul_f32 v238, v158, v238
    v_mul_f32 v239, v158, v239
    v_mfma_f32_16x16x32_bf16 v[154:157], a[8:11], v[218:221], v[154:157]
    v_cvt_pk_bf16_f32 v138, v238, v239
    v_mul_f32 v240, v158, v240
    v_mfma_f32_16x16x32_bf16 v[154:157], a[12:15], v[226:229], v[154:157]
    v_mul_f32 v241, v158, v241
    v_cvt_pk_bf16_f32 v139, v240, v241
    v_mfma_f32_16x16x32_bf16 v[154:157], a[16:19], v[242:245], v[154:157]
    v_lshl_add_u32 v141, v140, 4, s5
    v_lshl_add_u32 v158, v140, 3, s5
    v_mfma_f32_16x16x32_bf16 v[154:157], a[20:23], v[130:133], v[154:157]
    v_lshl_add_u32 v159, v254, 4, s5
    v_lshl_add_u32 v254, v254, 3, s5
    v_mfma_f32_16x16x32_bf16 v[162:165], a[24:27], v[174:177], 0
    v_lshlrev_b32 v140, 2, v140
    v_cvt_pk_f16_f32 v134, v134, v135
    v_mfma_f32_16x16x32_bf16 v[162:165], a[28:31], v[198:201], v[162:165]
    ds_permute_b32 v166, v140, v16
    ds_permute_b32 v167, v140, v19
    v_mfma_f32_16x16x32_bf16 v[162:165], a[32:35], v[218:221], v[162:165]
    ds_permute_b32 v168, v140, v17
    ds_permute_b32 v169, v140, v20
    v_mfma_f32_16x16x32_bf16 v[162:165], a[36:39], v[226:229], v[162:165]
    v_cvt_pk_f16_f32 v154, v154, v155
    v_pk_mul_f16 v190, v154, v154
    v_mfma_f32_16x16x32_bf16 v[162:165], a[40:43], v[242:245], v[162:165]
    buffer_store_dwordx4 v[126:129], v211, s[12:15], 0 offen nt
    v_cvt_pk_f16_f32 v155, v156, v157
    v_pk_mul_f16 v192, v155, v155
    v_pk_mul_f16 v191, v134, v134
    v_cvt_pk_f16_f32 v135, v136, v137
    v_mfma_f32_16x16x32_bf16 v[162:165], a[44:47], v[130:133], v[162:165]
    v_pk_mul_f16 v193, v135, v135
    v_cvt_pk_f16_f32 v136, v142, v143
    v_mfma_f32_16x16x32_bf16 v[126:129], a[48:51], v[174:177], 0
    v_pk_fma_f16 v191, v136, v136, v191
    v_cvt_pk_f16_f32 v137, v144, v145
    v_mfma_f32_16x16x32_bf16 v[126:129], a[52:55], v[198:201], v[126:129]
    v_pk_fma_f16 v193, v137, v137, v193
    v_cvt_pk_f16_f32 v144, v146, v147
    v_mfma_f32_16x16x32_bf16 v[126:129], a[56:59], v[218:221], v[126:129]
    s_waitcnt lgkmcnt(2)
    v_cvt_pk_f16_f32 v156, v162, v163
    v_pk_fma_f16 v190, v156, v156, v190
    v_mfma_f32_16x16x32_bf16 v[126:129], a[60:63], v[226:229], v[126:129]
    s_waitcnt lgkmcnt(0)
    v_cvt_pk_f16_f32 v157, v164, v165
    v_pk_fma_f16 v192, v157, v157, v192
    v_mfma_f32_16x16x32_bf16 v[126:129], a[64:67], v[242:245], v[126:129]
    v_pk_fma_f16 v191, v144, v144, v191
    v_cvt_pk_f16_f32 v145, v148, v149
    v_mfma_f32_16x16x32_bf16 v[126:129], a[68:71], v[130:133], v[126:129]
    v_pk_fma_f16 v193, v145, v145, v193
    v_add_u32 v140, 16, v214
    v_mfma_f32_16x16x32_bf16 v[146:149], v[174:177], a[144:147], 0
    v_mul_u32_u24 v211, s20, v140
    v_add_u32 v211, s38, v211
    v_mfma_f32_16x16x32_bf16 v[146:149], v[198:201], a[148:151], v[146:149]
    v_mul_u32_u24 v211, 911, v211
    v_lshrrev_b32 v211, 16, v211
    v_mfma_f32_16x16x32_bf16 v[146:149], v[218:221], a[152:155], v[146:149]
    v_cvt_pk_f16_f32 v142, v126, v127
    v_pk_fma_f16 v190, v142, v142, v190
    v_mfma_f32_16x16x32_bf16 v[146:149], v[226:229], a[156:159], v[146:149]
    v_cvt_pk_f16_f32 v143, v128, v129
    v_pk_fma_f16 v192, v143, v143, v192
    v_mfma_f32_16x16x32_bf16 v[146:149], v[242:245], a[160:163], v[146:149]
    ds_read2_b32 v[128:129], v6 offset0:0 offset1:0
    ds_read2_b32 v[164:165], v6 offset0:16 offset1:16
    v_mfma_f32_16x16x32_f16 v[202:205], v[40:43], v[190:193], 0
    ds_read2_b32 v[192:193], v6 offset0:32 offset1:32
    v_mul_u32_u24 v211, s22, v211
    v_mfma_f32_16x16x32_bf16 v[146:149], v[130:133], a[164:167], v[146:149]
    v_mad_u32_u24 v211, v140, s21, v211
    v_cmp_gt_u32 vcc, s17, v140
    v_mfma_f32_16x16x32_bf16 v[222:225], v[174:177], a[168:171], 0
    v_add_u32 v140, s7, v211
    v_cndmask_b32 v140, v210, v140, vcc
    v_mfma_f32_16x16x32_bf16 v[222:225], v[198:201], a[172:175], v[222:225]
    buffer_store_dwordx2 v[160:161], v212, s[12:15], 0 offen nt
    v_rsq_f32 v204, v202
    v_mfma_f32_16x16x32_bf16 v[222:225], v[218:221], a[176:179], v[222:225]
    v_cvt_pk_bf16_f32 v126, v146, v147
    v_cvt_pk_bf16_f32 v127, v148, v149
    v_mfma_f32_16x16x32_bf16 v[222:225], v[226:229], a[180:183], v[222:225]
    v_rsq_f32 v205, v203
    v_mfma_f32_16x16x32_bf16 v[222:225], v[242:245], a[184:187], v[222:225]
    s_waitcnt lgkmcnt(2)
    v_mul_f32 v204, s31, v204
    v_cvt_pk_f16_f32 v204, v204, v205
    v_mfma_f32_16x16x32_bf16 v[222:225], v[130:133], a[188:191], v[222:225]
    s_waitcnt lgkmcnt(0)
    v_pk_mul_f16 v134, v134, v204 op_sel:[0,1] op_sel_hi:[1,1]
    v_pk_mul_f16 v135, v135, v204 op_sel:[0,1] op_sel_hi:[1,1]
    v_mfma_f32_16x16x32_bf16 v[146:149], v[174:177], a[192:195], 0
    v_pk_mul_f16 v136, v136, v204 op_sel:[0,1] op_sel_hi:[1,1]
    v_pk_mul_f16 v137, v137, v204 op_sel:[0,1] op_sel_hi:[1,1]
    v_mfma_f32_16x16x32_bf16 v[146:149], v[198:201], a[196:199], v[146:149]
    v_pk_mul_f16 v144, v144, v204 op_sel:[0,1] op_sel_hi:[1,1]
    v_cvt_pk_bf16_f32 v162, v222, v223
    v_mfma_f32_16x16x32_bf16 v[146:149], v[218:221], a[200:203], v[146:149]
    ds_read_b128 v[174:177], v5 offset:0
    ds_read_b128 v[198:201], v5 offset:16
    v_mfma_f32_16x16x32_bf16 v[146:149], v[226:229], a[204:207], v[146:149]
    ds_read_b128 v[218:221], v5 offset:48
    ds_read_b32 v214, v6 offset:192
    v_mfma_f32_16x16x32_bf16 v[146:149], v[242:245], a[208:211], v[146:149]
    v_cvt_pk_bf16_f32 v163, v224, v225
    v_pk_mul_f16 v145, v145, v204 op_sel:[0,1] op_sel_hi:[1,1]
    v_mfma_f32_16x16x32_f16 v[222:225], v[118:121], v[206:209], v[46:49]
    v_pk_mul_f16 v154, v154, v204 op_sel:[0,0] op_sel_hi:[1,0]
    v_pk_mul_f16 v155, v155, v204 op_sel:[0,0] op_sel_hi:[1,0]
    v_mfma_f32_16x16x32_f16 v[226:229], v[182:185], v[206:209], v[50:53]
    v_pk_mul_f16 v156, v156, v204 op_sel:[0,0] op_sel_hi:[1,0]
    v_pk_mul_f16 v157, v157, v204 op_sel:[0,0] op_sel_hi:[1,0]
    v_mfma_f32_16x16x32_f16 v[230:233], v[134:137], v[206:209], v[54:57]
    v_pk_mul_f16 v142, v142, v204 op_sel:[0,0] op_sel_hi:[1,0]
    v_pk_mul_f16 v143, v143, v204 op_sel:[0,0] op_sel_hi:[1,0]
    v_min3_u32 v44, v44, v202, v203
    v_mfma_f32_16x16x16_f16 v[222:225], v[196:197], v[194:195], v[222:225]
    v_max3_u32 v45, v45, v202, v203
    v_subrev_u32 v160, 0x3d800000, v44
    v_sub_u32 v161, 0x4a000000, v45
    v_mfma_f32_16x16x16_f16 v[226:229], v[180:181], v[194:195], v[226:229]
    v_or3_b32 v160, v160, v161, v45
    v_lshl_add_u32 v161, s16, 2, v213
    v_lshl_add_u32 v210, v255, 4, v140
    v_mfma_f32_16x16x16_f16 v[230:233], v[144:145], v[194:195], v[230:233]
    v_add_u32 v210, s3, v210
    v_lshl_add_u32 v255, v255, 3, v140
    v_exp_f32 v222, v222
    v_mfma_f32_16x16x32_bf16 v[146:149], v[130:133], a[212:215], v[146:149]
    s_waitcnt lgkmcnt(0)
    buffer_store_dwordx4 v[150:153], v17, s[52:55], 0 offen nt
    ds_write_b32 v161, v160 offset:18432
    v_exp_f32 v223, v223
    v_mfma_f32_16x16x32_f16 v[130:133], v[174:177], v[206:209], v[22:25]
    v_add_u32 v255, s4, v255
    v_cvt_pk_bf16_f32 v150, v222, v223
    v_mfma_f32_16x16x32_f16 v[130:133], v[198:201], v[118:121], v[130:133]
    v_cvt_pk_bf16_f32 v190, v146, v147
    v_cvt_pk_bf16_f32 v191, v148, v149
    v_mfma_f32_16x16x32_f16 v[130:133], v[218:221], v[194:197], v[130:133]
    v_exp_f32 v224, v224
    v_mfma_f32_16x16x32_f16 v[146:149], v[174:177], v[122:125], v[24:27]
    v_exp_f32 v225, v225
    v_mfma_f32_16x16x32_f16 v[146:149], v[198:201], v[182:185], v[146:149]
    v_exp_f32 v226, v226
    v_mfma_f32_16x16x32_f16 v[146:149], v[218:221], v[178:181], v[146:149]
    v_exp_f32 v227, v227
    v_mfma_f32_16x16x32_f16 v[202:205], v[174:177], v[154:157], v[26:29]
    v_mov_b32_dpp v214, v131 quad_perm:[0,1,2,3] row_mask:0x1 bank_mask:0xf
    v_cvt_pk_bf16_f32 v151, v224, v225
    v_mfma_f32_16x16x32_f16 v[202:205], v[198:201], v[134:137], v[202:205]
    v_exp_f32 v228, v228
    v_mfma_f32_16x16x32_f16 v[202:205], v[218:221], v[142:145], v[202:205]
    v_cvt_pk_bf16_f32 v152, v226, v227
    v_mov_b32_dpp v214, v147 quad_perm:[0,1,2,3] row_mask:0x2 bank_mask:0xf
    v_exp_f32 v146, v146
    v_exp_f32 v229, v229
    v_exp_f32 v230, v230
    v_cvt_pk_bf16_f32 v153, v228, v229
    v_exp_f32 v231, v231
    v_mfma_f32_16x16x32_f16 v[174:177], v[118:121], v[122:125], v[58:61]
    v_mov_b32_dpp v214, v203 quad_perm:[0,1,2,3] row_mask:0x4 bank_mask:0xf
    v_cvt_pk_bf16_f32 v36, v230, v231
    v_mfma_f32_16x16x32_f16 v[198:201], v[182:185], v[122:125], v[62:65]
    v_exp_f32 v214, v214
    v_mfma_f32_16x16x32_f16 v[206:209], v[134:137], v[122:125], v[66:69]
    v_cvt_pk_bf16_f32 v214, v214, v214
    v_exp_f32 v202, v202
    v_mfma_f32_16x16x16_f16 v[174:177], v[196:197], v[178:179], v[174:177]
    ds_write_b16 v8, v214
    v_mfma_f32_16x16x16_f16 v[198:201], v[180:181], v[178:179], v[198:201]
    buffer_store_dwordx2 v[138:139], v20, s[52:55], 0 offen nt
    v_exp_f32 v232, v232
    v_mfma_f32_16x16x16_f16 v[206:209], v[144:145], v[178:179], v[206:209]
    v_exp_f32 v233, v233
    v_exp_f32 v130, v130
    v_cvt_pk_bf16_f32 v37, v232, v233
    v_exp_f32 v174, v174
    v_exp_f32 v175, v175
    v_mfma_f32_16x16x32_f16 v[122:125], v[118:121], v[154:157], v[70:73]
    v_cvt_pk_bf16_f32 v118, v174, v175
    v_cvt_pk_bf16_f32 v39, v130, 0
    v_mfma_f32_16x16x32_f16 v[130:133], v[182:185], v[154:157], v[74:77]
    v_exp_f32 v176, v176
    v_mfma_f32_16x16x32_bf16 v[182:185], v[28:31], v[36:39], 0
    v_exp_f32 v177, v177
    v_mfma_f32_16x16x32_bf16 v[182:185], v[28:31], v[150:153], v[182:185]
    v_exp_f32 v198, v198
    v_mfma_f32_16x16x32_bf16 v[218:221], v[126:129], v[36:39], 0
    v_exp_f32 v199, v199
    v_mfma_f32_16x16x32_bf16 v[218:221], v[170:173], v[150:153], v[218:221]
    v_cvt_pk_bf16_f32 v119, v176, v177
    v_cvt_pk_bf16_f32 v120, v198, v199
    v_mfma_f32_16x16x32_bf16 v[174:177], v[162:165], v[36:39], 0
    v_exp_f32 v200, v200
    v_mfma_f32_16x16x32_bf16 v[174:177], v[114:117], v[150:153], v[174:177]
    v_rcp_f32 v182, v182
    v_mfma_f32_16x16x32_bf16 v[222:225], v[190:193], v[36:39], 0
    v_exp_f32 v201, v201
    v_mfma_f32_16x16x32_bf16 v[222:225], v[186:189], v[150:153], v[222:225]
    v_mul_f32 v218, v182, v218
    v_mul_f32 v219, v182, v219
    v_mfma_f32_16x16x32_f16 v[150:153], v[134:137], v[154:157], v[78:81]
    v_cvt_pk_bf16_f32 v134, v218, v219
    v_mul_f32 v220, v182, v220
    v_mul_f32 v221, v182, v221
    v_mfma_f32_16x16x16_f16 v[122:125], v[196:197], v[142:143], v[122:125]
    v_cvt_pk_bf16_f32 v135, v220, v221
    v_mul_f32 v174, v182, v174
    v_mul_f32 v175, v182, v175
    v_mfma_f32_16x16x16_f16 v[130:133], v[180:181], v[142:143], v[130:133]
    v_cvt_pk_bf16_f32 v136, v174, v175
    v_mul_f32 v176, v182, v176
    v_mul_f32 v177, v182, v177
    v_mfma_f32_16x16x16_f16 v[150:153], v[144:145], v[142:143], v[150:153]
    v_cvt_pk_bf16_f32 v137, v176, v177
    ds_write_b128 v3, v[134:137] offset:0
    v_mul_f32 v222, v182, v222
    v_mul_f32 v223, v182, v223
    v_cvt_pk_bf16_f32 v160, v222, v223
    v_mul_f32 v224, v182, v224
    v_mul_f32 v225, v182, v225
    v_cvt_pk_bf16_f32 v161, v224, v225
    v_cvt_pk_bf16_f32 v121, v200, v201
    ds_write_b64 v4, v[160:161] offset:4096
    v_exp_f32 v206, v206
    v_exp_f32 v207, v207
    v_exp_f32 v208, v208
    v_cvt_pk_bf16_f32 v36, v206, v207
    v_exp_f32 v209, v209
    v_cvt_pk_bf16_f32 v39, v146, 0
    v_cvt_pk_bf16_f32 v37, v208, v209
    v_exp_f32 v122, v122
    v_exp_f32 v123, v123
    v_mfma_f32_16x16x32_bf16 v[134:137], v[28:31], v[36:39], 0
    v_exp_f32 v124, v124
    v_mfma_f32_16x16x32_bf16 v[134:137], v[28:31], v[118:121], v[134:137]
    v_exp_f32 v125, v125
    v_mfma_f32_16x16x32_bf16 v[142:145], v[126:129], v[36:39], 0
    ds_read_b128 v[146:149], v9
    ds_read_b128 v[154:157], v9 offset:64
    v_mfma_f32_16x16x32_bf16 v[142:145], v[170:173], v[118:121], v[142:145]
    s_waitcnt lgkmcnt(2)
    v_cvt_pk_bf16_f32 v122, v122, v123
    v_cvt_pk_bf16_f32 v123, v124, v125
    v_mfma_f32_16x16x32_bf16 v[174:177], v[162:165], v[36:39], 0
    s_barrier
    ds_read_b128 v[178:181], v213 offset:0
    ds_read_b128 v[182:185], v213 offset:1024
    v_mfma_f32_16x16x32_bf16 v[174:177], v[114:117], v[118:121], v[174:177]
    ds_read_b128 v[194:197], v213 offset:2048
    ds_read_b128 v[198:201], v213 offset:3072
    v_mfma_f32_16x16x32_bf16 v[206:209], v[190:193], v[36:39], 0
    v_exp_f32 v130, v130
    v_mfma_f32_16x16x32_bf16 v[206:209], v[186:189], v[118:121], v[206:209]
    ds_read_b128 v[118:121], v213 offset:4096
    ds_read_b128 v[218:221], v213 offset:5120
    v_exp_f32 v131, v131
    v_exp_f32 v132, v132
    v_cvt_pk_bf16_f32 v124, v130, v131
    v_exp_f32 v133, v133
    s_waitcnt lgkmcnt(6)
    v_mfma_f32_16x16x32_bf16 v[222:225], v[146:149], v[28:31], 0
    v_cvt_pk_bf16_f32 v125, v132, v133
    v_cvt_pk_bf16_f32 v39, v202, 0
    v_mfma_f32_16x16x32_bf16 v[222:225], v[154:157], v[28:31], v[222:225]
    v_exp_f32 v150, v150
    v_mfma_f32_16x16x32_bf16 v[130:133], v[146:149], v[170:173], 0
    s_waitcnt lgkmcnt(4)
    v_exp_f32 v151, v151
    v_mfma_f32_16x16x32_bf16 v[202:205], a[216:219], v[178:181], 0
    s_waitcnt lgkmcnt(2)
    v_exp_f32 v152, v152
    v_mfma_f32_16x16x32_bf16 v[202:205], a[220:223], v[182:185], v[202:205]
    v_exp_f32 v153, v153
    v_mfma_f32_16x16x32_bf16 v[202:205], a[224:227], v[194:197], v[202:205]
    s_waitcnt lgkmcnt(0)
    v_cvt_pk_bf16_f32 v36, v150, v151
    v_cvt_pk_bf16_f32 v37, v152, v153
    v_mfma_f32_16x16x32_bf16 v[202:205], a[228:231], v[198:201], v[202:205]
    v_rcp_f32 v222, v222
    v_mfma_f32_16x16x32_bf16 v[202:205], a[232:235], v[118:121], v[202:205]
    v_rcp_f32 v134, v134
    v_mfma_f32_16x16x32_bf16 v[202:205], a[236:239], v[218:221], v[202:205]
    v_mul_f32 v142, v134, v142
    v_mul_f32 v143, v134, v143
    v_mfma_f32_16x16x32_bf16 v[150:153], a[240:243], v[178:181], 0
    v_cvt_pk_bf16_f32 v142, v142, v143
    v_mul_f32 v144, v134, v144
    v_mfma_f32_16x16x32_bf16 v[150:153], a[244:247], v[182:185], v[150:153]
    v_mul_f32 v145, v134, v145
    v_cvt_pk_bf16_f32 v143, v144, v145
    v_mfma_f32_16x16x32_bf16 v[150:153], a[248:251], v[194:197], v[150:153]
    v_fma_f32 v214, v202, v202, s33
    v_fmac_f32 v214, v203, v203
    v_mfma_f32_16x16x32_bf16 v[150:153], a[252:255], v[198:201], v[150:153]
    v_fmac_f32 v214, v204, v204
    v_fmac_f32 v214, v205, v205
    v_mfma_f32_16x16x32_bf16 v[150:153], v[82:85], v[118:121], v[150:153]
    v_mul_f32 v174, v134, v174
    v_mul_f32 v175, v134, v175
    v_mfma_f32_16x16x32_bf16 v[150:153], v[86:89], v[218:221], v[150:153]
    v_cvt_pk_bf16_f32 v144, v174, v175
    v_mul_f32 v176, v134, v176
    v_mfma_f32_16x16x32_bf16 v[226:229], v[90:93], v[178:181], 0
    v_mul_f32 v177, v134, v177
    v_cvt_pk_bf16_f32 v145, v176, v177
    v_mfma_f32_16x16x32_bf16 v[226:229], v[94:97], v[182:185], v[226:229]
    ds_write_b128 v3, v[142:145] offset:6144
    v_mfma_f32_16x16x32_bf16 v[226:229], v[98:101], v[194:197], v[226:229]
    v_fmac_f32 v214, v150, v150
    v_fmac_f32 v214, v151, v151
    v_mfma_f32_16x16x32_bf16 v[226:229], v[102:105], v[198:201], v[226:229]
    v_fmac_f32 v214, v152, v152
    v_fmac_f32 v214, v153, v153
    v_mfma_f32_16x16x32_bf16 v[226:229], v[106:109], v[118:121], v[226:229]
    v_mul_f32 v206, v134, v206
    v_mul_f32 v207, v134, v207
    v_mfma_f32_16x16x32_bf16 v[226:229], v[110:113], v[218:221], v[226:229]
    v_cvt_pk_bf16_f32 v160, v206, v207
    v_mul_f32 v208, v134, v208
    v_mfma_f32_16x16x32_bf16 v[130:133], v[154:157], v[126:129], v[130:133]
    v_mul_f32 v209, v134, v209
    v_cvt_pk_bf16_f32 v161, v208, v209
    v_mfma_f32_16x16x32_bf16 v[118:121], v[146:149], v[114:117], 0
    ds_write_b64 v4, v[160:161] offset:10240
    v_mfma_f32_16x16x32_bf16 v[118:121], v[154:157], v[162:165], v[118:121]
    v_fmac_f32 v214, v226, v226
    v_fmac_f32 v214, v227, v227
    v_mfma_f32_16x16x32_bf16 v[134:137], v[146:149], v[186:189], 0
    v_mul_f32 v130, v130, v222
    v_fmac_f32 v214, v228, v228
    v_mfma_f32_16x16x32_bf16 v[134:137], v[154:157], v[190:193], v[134:137]
    v_fmac_f32 v214, v229, v229
    v_cvt_pk_bf16_f32 v160, v214, v214
    v_mfma_f32_16x16x32_bf16 v[142:145], v[28:31], v[36:39], 0
    v_mul_f32_dpp v130, v118, v222 quad_perm:[0,1,2,3] row_mask:0x2 bank_mask:0xf
    v_cvt_pk_bf16_f32 v161, v214, v214
    v_mfma_f32_16x16x32_bf16 v[142:145], v[28:31], v[122:125], v[142:145]
    ds_write_b64 v217, v[160:161] offset:4096
    v_mfma_f32_16x16x32_bf16 v[118:121], v[126:129], v[36:39], 0
    v_mul_f32_dpp v130, v134, v222 quad_perm:[0,1,2,3] row_mask:0x4 bank_mask:0xf
    v_cvt_pk_bf16_f32 v130, v130, v130
    v_mfma_f32_16x16x32_bf16 v[118:121], v[170:173], v[122:125], v[118:121]
    ds_write_b16 v7, v130
    v_mfma_f32_16x16x32_bf16 v[126:129], v[162:165], v[36:39], 0
    v_mfma_f32_16x16x32_bf16 v[126:129], v[114:117], v[122:125], v[126:129]
    v_rcp_f32 v142, v142
    v_mfma_f32_16x16x32_bf16 v[114:117], v[190:193], v[36:39], 0
    v_mfma_f32_16x16x32_bf16 v[114:117], v[186:189], v[122:125], v[114:117]
    s_nop 0
    s_nop 0
    v_mul_f32 v118, v142, v118
    v_mul_f32 v119, v142, v119
    v_cvt_pk_bf16_f32 v118, v118, v119
    v_mul_f32 v120, v142, v120
    v_mul_f32 v121, v142, v121
    v_cvt_pk_bf16_f32 v119, v120, v121
    v_mul_f32 v126, v142, v126
    v_mul_f32 v127, v142, v127
    v_cvt_pk_bf16_f32 v120, v126, v127
    v_mul_f32 v128, v142, v128
    v_mul_f32 v129, v142, v129
    s_waitcnt lgkmcnt(0)
    s_barrier
    ds_read_b128 v[122:125], v216 offset:4096
    ds_read_b128 v[130:133], v216 offset:5120
    ds_read_b128 v[134:137], v213 offset:6144
    ds_read_b128 v[146:149], v213 offset:7168
    ds_read_b128 v[154:157], v213 offset:8192
    ds_read_b128 v[162:165], v213 offset:9216
    ds_read_b128 v[170:173], v213 offset:10240
    ds_read_b128 v[174:177], v213 offset:11264
    v_cvt_pk_bf16_f32 v121, v128, v129
    ds_write_b128 v3, v[118:121] offset:12288
    s_waitcnt lgkmcnt(6)
    v_mfma_f32_16x16x32_bf16 v[118:121], v[32:35], v[122:125], 0
    v_mul_f32 v114, v142, v114
    v_mul_f32 v115, v142, v115
    v_mfma_f32_16x16x32_bf16 v[118:121], v[32:35], v[130:133], v[118:121]
    s_waitcnt lgkmcnt(5)
    v_cvt_pk_bf16_f32 v160, v114, v115
    v_mul_f32 v116, v142, v116
    v_mfma_f32_16x16x32_bf16 v[122:125], a[216:219], v[134:137], 0
    s_waitcnt lgkmcnt(4)
    v_mul_f32 v117, v142, v117
    v_cvt_pk_bf16_f32 v161, v116, v117
    v_mfma_f32_16x16x32_bf16 v[122:125], a[220:223], v[146:149], v[122:125]
    s_waitcnt lgkmcnt(3)
    ds_write_b64 v4, v[160:161] offset:16384
    v_mfma_f32_16x16x32_bf16 v[122:125], a[224:227], v[154:157], v[122:125]
    s_waitcnt lgkmcnt(2)
    v_mul_f32 v214, 0x3baaaaab, v118
    v_mfma_f32_16x16x32_bf16 v[122:125], a[228:231], v[162:165], v[122:125]
    v_rsq_f32 v214, v214
    v_mfma_f32_16x16x32_bf16 v[122:125], a[232:235], v[170:173], v[122:125]
    v_mul_f32 v202, v214, v202
    v_mul_f32 v203, v214, v203
    v_mfma_f32_16x16x32_bf16 v[122:125], a[236:239], v[174:177], v[122:125]
    v_cvt_pk_bf16_f32 v114, v202, v203
    v_mul_f32 v204, v214, v204
    v_mfma_f32_16x16x32_bf16 v[118:121], a[240:243], v[134:137], 0
    v_mul_f32 v205, v214, v205
    v_cvt_pk_bf16_f32 v115, v204, v205
    v_mfma_f32_16x16x32_bf16 v[118:121], a[244:247], v[146:149], v[118:121]
    v_mul_f32 v150, v214, v150
    v_mul_f32 v151, v214, v151
    v_mfma_f32_16x16x32_bf16 v[118:121], a[248:251], v[154:157], v[118:121]
    v_cvt_pk_bf16_f32 v116, v150, v151
    v_mul_f32 v152, v214, v152
    v_mfma_f32_16x16x32_bf16 v[118:121], a[252:255], v[162:165], v[118:121]
    v_mul_f32 v153, v214, v153
    v_cvt_pk_bf16_f32 v117, v152, v153
    v_mfma_f32_16x16x32_bf16 v[118:121], v[82:85], v[170:173], v[118:121]
    buffer_store_dwordx4 v[114:117], v15, s[56:59], 0 offen nt
    v_mul_f32 v226, v214, v226
    v_mul_f32 v227, v214, v227
    v_cvt_pk_bf16_f32 v160, v226, v227
    v_mul_f32 v228, v214, v228
    v_mfma_f32_16x16x32_bf16 v[118:121], v[86:89], v[174:177], v[118:121]
    v_mul_f32 v229, v214, v229
    v_cvt_pk_bf16_f32 v161, v228, v229
    v_mfma_f32_16x16x32_bf16 v[114:117], v[90:93], v[134:137], 0
    ds_read_b128 v[126:129], v215 offset:256
    v_fma_f32 v214, v122, v122, s33
    v_mfma_f32_16x16x32_bf16 v[114:117], v[94:97], v[146:149], v[114:117]
    ds_read_b128 v[130:133], v215 offset:2304
    v_fmac_f32 v214, v123, v123
    v_mfma_f32_16x16x32_bf16 v[114:117], v[98:101], v[154:157], v[114:117]
    ds_read_b128 v[134:137], v215 offset:4352
    v_fmac_f32 v214, v124, v124
    v_mfma_f32_16x16x32_bf16 v[114:117], v[102:105], v[162:165], v[114:117]
    ds_read_b128 v[142:145], v215 offset:6400
    v_fmac_f32 v214, v125, v125
    v_mfma_f32_16x16x32_bf16 v[114:117], v[106:109], v[170:173], v[114:117]
    ds_read_b128 v[146:149], v215 offset:8448
    v_fmac_f32 v214, v118, v118
    v_mfma_f32_16x16x32_bf16 v[114:117], v[110:113], v[174:177], v[114:117]
    ds_read_b128 v[150:153], v215 offset:10496
    v_fmac_f32 v214, v119, v119
    v_fmac_f32 v214, v120, v120
    v_fmac_f32 v214, v121, v121
    s_nop 0
    s_nop 0
    s_nop 0
    s_nop 0
    s_waitcnt lgkmcnt(5)
    v_mfma_f32_16x16x32_bf16 v[154:157], a[216:219], v[126:129], 0
    v_fmac_f32 v214, v114, v114
    v_fmac_f32 v214, v115, v115
    v_mfma_f32_16x16x32_bf16 v[162:165], a[240:243], v[126:129], 0
    s_waitcnt lgkmcnt(4)
    v_fmac_f32 v214, v116, v116
    v_fmac_f32 v214, v117, v117
    v_mfma_f32_16x16x32_bf16 v[154:157], a[220:223], v[130:133], v[154:157]
    s_waitcnt lgkmcnt(3)
    v_cvt_pk_bf16_f32 v138, v214, v214
    v_cvt_pk_bf16_f32 v139, v214, v214
    v_mfma_f32_16x16x32_bf16 v[154:157], a[224:227], v[134:137], v[154:157]
    s_waitcnt lgkmcnt(2)
    ds_write_b64 v217, v[138:139] offset:6144
    v_mfma_f32_16x16x32_bf16 v[154:157], a[228:231], v[142:145], v[154:157]
    s_waitcnt lgkmcnt(2)
    v_mfma_f32_16x16x32_bf16 v[154:157], a[232:235], v[146:149], v[154:157]
    s_waitcnt lgkmcnt(1)
    v_mfma_f32_16x16x32_bf16 v[154:157], a[236:239], v[150:153], v[154:157]
    buffer_store_dwordx2 v[160:161], v18, s[56:59], 0 offen nt
    v_mfma_f32_16x16x32_bf16 v[162:165], a[244:247], v[130:133], v[162:165]
    v_mfma_f32_16x16x32_bf16 v[162:165], a[248:251], v[134:137], v[162:165]
    v_mfma_f32_16x16x32_bf16 v[162:165], a[252:255], v[142:145], v[162:165]
    v_mfma_f32_16x16x32_bf16 v[162:165], v[82:85], v[146:149], v[162:165]
    s_waitcnt lgkmcnt(0)
    v_mfma_f32_16x16x32_bf16 v[162:165], v[86:89], v[150:153], v[162:165]
    s_barrier
    ds_read_b128 v[170:173], v216 offset:6144
    ds_read_b128 v[174:177], v216 offset:7168
    v_mfma_f32_16x16x32_bf16 v[178:181], v[90:93], v[126:129], 0
    ds_read_b128 v[126:129], v213 offset:12288
    v_fma_f32 v160, v154, v154, s33
    v_mfma_f32_16x16x32_bf16 v[178:181], v[94:97], v[130:133], v[178:181]
    ds_read_b128 v[130:133], v213 offset:13312
    v_fmac_f32 v160, v155, v155
    v_mfma_f32_16x16x32_bf16 v[178:181], v[98:101], v[134:137], v[178:181]
    ds_read_b128 v[134:137], v213 offset:14336
    v_fmac_f32 v160, v156, v156
    v_mfma_f32_16x16x32_bf16 v[178:181], v[102:105], v[142:145], v[178:181]
    ds_read_b128 v[142:145], v213 offset:15360
    v_fmac_f32 v160, v157, v157
    v_mfma_f32_16x16x32_bf16 v[178:181], v[106:109], v[146:149], v[178:181]
    ds_read_b128 v[146:149], v213 offset:16384
    v_fmac_f32 v160, v162, v162
    v_mfma_f32_16x16x32_bf16 v[178:181], v[110:113], v[150:153], v[178:181]
    ds_read_b128 v[150:153], v213 offset:17408
    v_fmac_f32 v160, v163, v163
    v_fmac_f32 v160, v164, v164
    v_fmac_f32 v160, v165, v165
    s_waitcnt lgkmcnt(7)
    v_mfma_f32_16x16x32_bf16 v[182:185], v[32:35], v[170:173], 0
    s_waitcnt lgkmcnt(6)
    v_mfma_f32_16x16x32_bf16 v[182:185], v[32:35], v[174:177], v[182:185]
    s_waitcnt lgkmcnt(5)
    v_fmac_f32 v160, v178, v178
    v_fmac_f32 v160, v179, v179
    v_mfma_f32_16x16x32_bf16 v[170:173], a[216:219], v[126:129], 0
    s_waitcnt lgkmcnt(4)
    v_fmac_f32 v160, v180, v180
    v_fmac_f32 v160, v181, v181
    v_mfma_f32_16x16x32_bf16 v[170:173], a[220:223], v[130:133], v[170:173]
    s_waitcnt lgkmcnt(3)
    v_cvt_pk_bf16_f32 v214, v160, v160
    v_cvt_pk_bf16_f32 v215, v160, v160
    v_mfma_f32_16x16x32_bf16 v[170:173], a[224:227], v[134:137], v[170:173]
    s_waitcnt lgkmcnt(2)
    ds_write_b64 v217, v[214:215] offset:8192
    v_mfma_f32_16x16x32_bf16 v[170:173], a[228:231], v[142:145], v[170:173]
    s_waitcnt lgkmcnt(2)
    v_mul_f32 v160, 0x3baaaaab, v182
    v_mfma_f32_16x16x32_bf16 v[170:173], a[232:235], v[146:149], v[170:173]
    s_waitcnt lgkmcnt(1)
    v_rsq_f32 v160, v160
    v_mfma_f32_16x16x32_bf16 v[170:173], a[236:239], v[150:153], v[170:173]
    v_mul_f32 v122, v160, v122
    v_mul_f32 v123, v160, v123
    v_mfma_f32_16x16x32_bf16 v[174:177], a[240:243], v[126:129], 0
    v_cvt_pk_bf16_f32 v122, v122, v123
    v_mul_f32 v124, v160, v124
    v_mfma_f32_16x16x32_bf16 v[174:177], a[244:247], v[130:133], v[174:177]
    v_mul_f32 v125, v160, v125
    v_cvt_pk_bf16_f32 v123, v124, v125
    v_mfma_f32_16x16x32_bf16 v[174:177], a[248:251], v[134:137], v[174:177]
    v_fma_f32 v161, v170, v170, s33
    v_fmac_f32 v161, v171, v171
    v_mfma_f32_16x16x32_bf16 v[174:177], a[252:255], v[142:145], v[174:177]
    s_waitcnt lgkmcnt(0)
    v_fmac_f32 v161, v172, v172
    v_fmac_f32 v161, v173, v173
    v_mfma_f32_16x16x32_bf16 v[174:177], v[82:85], v[146:149], v[174:177]
    s_barrier
    ds_read_b128 v[182:185], v216 offset:8192
    ds_read_b128 v[186:189], v216 offset:9216
    v_mfma_f32_16x16x32_bf16 v[174:177], v[86:89], v[150:153], v[174:177]
    v_mul_f32 v118, v160, v118
    v_mul_f32 v119, v160, v119
    v_mfma_f32_16x16x32_bf16 v[190:193], v[90:93], v[126:129], 0
    v_cvt_pk_bf16_f32 v124, v118, v119
    v_mul_f32 v120, v160, v120
    v_mfma_f32_16x16x32_bf16 v[190:193], v[94:97], v[130:133], v[190:193]
    v_mul_f32 v121, v160, v121
    v_cvt_pk_bf16_f32 v125, v120, v121
    v_mfma_f32_16x16x32_bf16 v[190:193], v[98:101], v[134:137], v[190:193]
    ds_write_b128 v141, v[122:125] offset:1536
    v_mfma_f32_16x16x32_bf16 v[190:193], v[102:105], v[142:145], v[190:193]
    v_fmac_f32 v161, v174, v174
    v_fmac_f32 v161, v175, v175
    v_mfma_f32_16x16x32_bf16 v[190:193], v[106:109], v[146:149], v[190:193]
    v_fmac_f32 v161, v176, v176
    v_fmac_f32 v161, v177, v177
    v_mfma_f32_16x16x32_bf16 v[190:193], v[110:113], v[150:153], v[190:193]
    s_waitcnt lgkmcnt(1)
    ds_read_b128 v[118:121], v159 offset:1536
    v_mul_f32 v114, v160, v114
    v_mfma_f32_16x16x32_bf16 v[122:125], v[32:35], v[182:185], 0
    v_mul_f32 v115, v160, v115
    v_cvt_pk_bf16_f32 v114, v114, v115
    v_mfma_f32_16x16x32_bf16 v[122:125], v[32:35], v[186:189], v[122:125]
    v_mul_f32 v116, v160, v116
    v_fmac_f32 v161, v190, v190
    v_fmac_f32 v161, v191, v191
    v_fmac_f32 v161, v192, v192
    v_fmac_f32 v161, v193, v193
    v_cvt_pk_bf16_f32 v214, v161, v161
    v_cvt_pk_bf16_f32 v215, v161, v161
    ds_write_b64 v217, v[214:215] offset:0
    v_mul_f32 v117, v160, v117
    v_cvt_pk_bf16_f32 v115, v116, v117
    v_mul_f32 v160, 0x3baaaaab, v122
    ds_write_b64 v158, v[114:115] offset:2560
    s_waitcnt lgkmcnt(2)
    buffer_store_dwordx4 v[118:121], v166, s[56:59], 0 offen nt
    v_rsq_f32 v160, v160
    ds_read_b64 v[138:139], v254 offset:2560
    v_mul_f32 v154, v160, v154
    v_mul_f32 v155, v160, v155
    v_cvt_pk_bf16_f32 v114, v154, v155
    v_mul_f32 v156, v160, v156
    v_mul_f32 v157, v160, v157
    v_cvt_pk_bf16_f32 v115, v156, v157
    v_mul_f32 v162, v160, v162
    v_mul_f32 v163, v160, v163
    v_cvt_pk_bf16_f32 v116, v162, v163
    v_mul_f32 v164, v160, v164
    s_waitcnt lgkmcnt(2)
    s_barrier
    ds_read_b128 v[118:121], v216 offset:0
    ds_read_b128 v[122:125], v216 offset:1024
    ds_read_b128 v[126:129], v213 offset:18432
    v_mul_f32 v165, v160, v165
    v_cvt_pk_bf16_f32 v117, v164, v165
    buffer_store_dwordx4 v[114:117], v210, s[12:15], 0 offen nt
    v_mul_f32 v178, v160, v178
    v_mul_f32 v179, v160, v179
    v_cvt_pk_bf16_f32 v178, v178, v179
    v_mul_f32 v180, v160, v180
    v_mul_f32 v181, v160, v181
    v_cvt_pk_bf16_f32 v179, v180, v181
    s_waitcnt lgkmcnt(3)
    s_waitcnt lgkmcnt(2)
    v_mfma_f32_16x16x32_bf16 v[114:117], v[32:35], v[118:121], 0
    s_waitcnt lgkmcnt(1)
    v_mfma_f32_16x16x32_bf16 v[114:117], v[32:35], v[122:125], v[114:117]
    s_waitcnt lgkmcnt(0)
    v_or3_b32 v126, v126, v127, v128
    v_or_b32 v126, v126, v129
    v_cmp_gt_i32 s[46:47], 0, v126
    buffer_store_dwordx2 v[138:139], v167, s[56:59], 0 offen nt
    s_nop 0
    s_nop 0
    s_nop 0
    v_mul_f32 v160, 0x3baaaaab, v114
    v_rsq_f32 v160, v160
    s_nop 0
    v_mul_f32 v170, v160, v170
    v_mul_f32 v171, v160, v171
    v_cvt_pk_bf16_f32 v114, v170, v171
    v_mul_f32 v172, v160, v172
    v_mul_f32 v173, v160, v173
    v_cvt_pk_bf16_f32 v115, v172, v173
    v_mul_f32 v174, v160, v174
    v_mul_f32 v175, v160, v175
    v_cvt_pk_bf16_f32 v116, v174, v175
    v_mul_f32 v176, v160, v176
    v_mul_f32 v177, v160, v177
    v_cvt_pk_bf16_f32 v117, v176, v177
    ds_write_b128 v141, v[114:117] offset:3072
    buffer_store_dwordx2 v[178:179], v255, s[12:15], 0 offen nt
    v_mul_f32 v190, v160, v190
    v_mul_f32 v191, v160, v191
    v_cvt_pk_bf16_f32 v166, v190, v191
    v_mul_f32 v192, v160, v192
    v_mul_f32 v193, v160, v193
    v_cvt_pk_bf16_f32 v167, v192, v193
    ds_read_b128 v[114:117], v159 offset:3072
    ds_write_b64 v158, v[166:167] offset:4096
    ds_read_b64 v[166:167], v254 offset:4096
    s_waitcnt lgkmcnt(2)
    buffer_store_dwordx4 v[114:117], v168, s[56:59], 0 offen nt
    s_waitcnt lgkmcnt(0)
    buffer_store_dwordx2 v[166:167], v169, s[56:59], 0 offen nt
L_end:
    s_nop 1
    s_cmp_lg_u64 s[46:47], 0
    s_cbranch_scc1 L_rerun
L_done:
    s_endpgm
L_slow:
    s_mov_b32 s44, 0xff
    s_branch L_redo
L_rerun:
    s_mov_b32 s44, 0x7f000000
L_redo:
    s_waitcnt vmcnt(0) lgkmcnt(0)
    s_barrier
    v_mbcnt_lo_u32_b32 v0, -1, 0
    v_mbcnt_hi_u32_b32 v0, -1, v0
    v_lshl_add_u32 v0, s16, 6, v0
    s_nop 7
    s_branch L_again
L_edge:
    v_mov_b32 v254, v0
    v_mov_b32 v255, 0x40000000
    v_and_b32 v118, 63, v0
    s_bfe_u32 s3, s2, 0x50003
    s_lshl_b32 s4, s16, 3
    s_lshr_b32 s98, 0x00123600, s4
    s_and_b32 s98, s98, 0xff
    s_mul_i32 s3, s3, s98
    s_lshr_b32 s4, 0x05113500, s4
    s_and_b32 s4, s4, 0xff
    v_min_u32 v120, s4, v118
    v_add_lshl_u32 v120, v120, s3, 7
    v_mov_b32 v121, 0
    v_lshrrev_b32 v119, 4, v118
    v_and_b32 v130, 15, v118
    s_mov_b32 s10, 100270464
    s_mov_b32 s11, 0x00020000
    s_mov_b32 s50, 221184
    s_mov_b32 s51, 0x00020000
    v_mul_u32_u24 v131, 171, v118
    v_lshrrev_b32 v131, 10, v131
    v_lshrrev_b32 v132, 1, v131
    v_xor_b32 v132, v132, v131
    v_and_b32 v132, 4, v132
    v_mul_u32_u24 v132, 3, v132
    v_xor_b32 v132, v132, v131
    v_mul_u32_u24 v132, 1152, v132
    v_mul_u32_u24 v133, 96, v131
    v_sub_u32 v132, v132, v133
    v_lshl_add_u32 v133, v118, 4, v132
    v_add_u32 v132, 64, v118
    v_mul_u32_u24 v132, 171, v132
    v_lshrrev_b32 v132, 10, v132
    v_lshrrev_b32 v134, 1, v132
    v_xor_b32 v134, v134, v132
    v_and_b32 v134, 4, v134
    v_mul_u32_u24 v134, 3, v134
    v_xor_b32 v134, v134, v132
    v_mul_u32_u24 v134, 1152, v134
    v_mul_u32_u24 v135, 96, v132
    v_sub_u32 v134, v134, v135
    v_lshl_add_u32 v135, v118, 4, v134
    v_add_u32 v134, 128, v118
    v_mul_u32_u24 v134, 171, v134
    v_lshrrev_b32 v134, 10, v134
    v_lshrrev_b32 v136, 1, v134
    v_xor_b32 v136, v136, v134
    v_and_b32 v136, 4, v136
    v_mul_u32_u24 v136, 3, v136
    v_xor_b32 v136, v136, v134
    v_mul_u32_u24 v136, 1152, v136
    v_mul_u32_u24 v137, 96, v134
    v_sub_u32 v136, v136, v137
    v_lshl_add_u32 v137, v118, 4, v136
    s_mul_i32 s68, s16, 6144
    s_add_u32 s69, s68, 65536
    s_cmp_eq_u32 s16, 3
    s_cselect_b32 s68, 136704, s68
    s_cselect_b32 s69, 142848, s69
    s_mul_i32 s45, s16, 96
    s_mov_b32 s70, 193536
    s_mov_b32 s36, 100270464
    s_mov_b32 s22, 1180032
    s_mul_i32 s3, s2, 911
    s_lshr_b32 s3, s3, 16
    s_mul_i32 s99, s3, 72
    s_sub_u32 s38, s2, s99
    s_mul_i32 s3, s3, 1373568
    s_mul_i32 s99, s38, 2688
    s_add_u32 s3, s3, s99
    s_add_u32 s25, s3, 589824
    s_add_u32 s7, s3, 1769472
    s_mov_b32 s20, 31
    s_mov_b32 s21, 4204032
    s_cmp_lt_u32 s2, 244
    s_cselect_b32 s17, 21, 20
    s_mov_b32 s5, 0
    s_mov_b32 s6, 0
    s_cmp_lt_u32 s2, 247
    s_cbranch_scc1 L_inner
    s_mov_b32 s20, 0
    s_mov_b32 s38, 0
    s_sub_u32 s3, s2, 247
    s_and_b32 s3, s3, 3
    s_mul_i32 s3, s3, 7
    s_add_u32 s3, s3, 3
    s_mov_b32 s99, 196224
    s_cmp_lt_u32 s2, 251
    s_cselect_b32 s99, s99, 384
    s_cselect_b32 s6, 1, 0
    s_cselect_b32 s5, 0, 1
    s_mul_i32 s25, s3, s99
    s_mul_i32 s21, s99, 28
    s_cmp_lt_u32 s2, 255
    s_cselect_b32 s17, 18, 1
    s_cselect_b32 s25, s25, 0
    s_cselect_b32 s6, s6, 1
    s_add_u32 s7, s25, 1179648
L_inner:
    s_mul_i32 s3, s5, 99485568
    s_mul_i32 s99, s5, -784896
    v_mov_b32 v136, s3
    v_mov_b32 v138, s99
    s_add_u32 s7, s7, s99
    s_mul_i32 s3, s6, 194688
    s_mul_i32 s99, s6, -1536
    v_mov_b32 v139, s3
    v_mov_b32 v140, s99
    s_add_u32 s7, s7, s99
    v_mul_u32_u24 v141, 2731, v254
    v_bfe_u32 v142, v141, 17, 3
    v_lshrrev_b32 v141, 16, v141
    v_xor_b32 v143, v142, v254
    v_mul_u32_u24 v142, 37, v141
    v_lshrrev_b32 v142, 8, v142
    v_lshlrev_b32 v143, 4, v143
    v_mad_u32_u24 v10, v142, s70, v143
    v_mul_u32_u24 v142, 37, v141
    v_lshrrev_b32 v142, 8, v142
    v_mul_u32_u24 v144, 7, v142
    v_sub_u32 v144, v141, v144
    v_cmp_gt_u32 vcc, 4, v142
    s_nop 1
    v_cndmask_b32 v142, v138, v136, vcc
    v_cmp_gt_u32 vcc, 4, v144
    s_nop 1
    v_cndmask_b32 v144, v140, v139, vcc
    v_add3_u32 v10, v10, v142, v144
    v_mul_u32_u24 v142, s20, v141
    v_add_u32 v142, s38, v142
    v_mul_u32_u24 v142, 911, v142
    v_lshrrev_b32 v142, 16, v142
    v_mul_u32_u24 v142, s22, v142
    v_mad_u32_u24 v142, v141, s21, v142
    v_cmp_gt_u32 vcc, s17, v141
    v_add_u32 v142, s7, v142
    s_nop 0
    v_cndmask_b32 v142, v255, v142, vcc
    v_mul_u32_u24 v141, 384, v141
    v_sub_u32 v141, v143, v141
    v_add_u32 v142, v142, v141
    v_add_u32 v141, 256, v254
    v_mul_u32_u24 v143, 2731, v141
    v_bfe_u32 v144, v143, 17, 3
    v_lshrrev_b32 v143, 16, v143
    v_xor_b32 v141, v144, v141
    v_mul_u32_u24 v144, 37, v143
    v_lshrrev_b32 v144, 8, v144
    v_lshlrev_b32 v141, 4, v141
    v_mad_u32_u24 v11, v144, s70, v141
    v_mul_u32_u24 v144, 37, v143
    v_lshrrev_b32 v144, 8, v144
    v_mul_u32_u24 v145, 7, v144
    v_sub_u32 v145, v143, v145
    v_cmp_gt_u32 vcc, 4, v144
    s_nop 1
    v_cndmask_b32 v144, v138, v136, vcc
    v_cmp_gt_u32 vcc, 4, v145
    s_nop 1
    v_cndmask_b32 v145, v140, v139, vcc
    v_add3_u32 v11, v11, v144, v145
    v_mul_u32_u24 v144, s20, v143
    v_add_u32 v144, s38, v144
    v_mul_u32_u24 v144, 911, v144
    v_lshrrev_b32 v144, 16, v144
    v_mul_u32_u24 v144, s22, v144
    v_mad_u32_u24 v144, v143, s21, v144
    v_cmp_gt_u32 vcc, s17, v143
    v_add_u32 v144, s7, v144
    s_nop 0
    v_cndmask_b32 v144, v255, v144, vcc
    v_mul_u32_u24 v143, 384, v143
    v_sub_u32 v143, v141, v143
    v_add_u32 v144, v144, v143
    s_lshl_b32 s28, s16, 10
    s_add_u32 s28, s28, 20480
    s_waitcnt lgkmcnt(0)
    s_cmp_eq_u32 s16, 2
    s_cselect_b64 s[98:99], s[80:81], s[78:79]
    s_cmp_eq_u32 s16, 3
    s_cselect_b64 s[98:99], s[88:89], s[98:99]
    s_mov_b64 s[8:9], s[76:77]
    v_lshl_add_u64 v[120:121], s[98:99], 0, v[120:121]
    s_cmp_eq_u32 s16, 2
    s_cselect_b64 s[98:99], s[84:85], s[82:83]
    s_cmp_eq_u32 s16, 3
    s_cselect_b64 s[98:99], s[86:87], s[98:99]
    v_writelane_b32 v120, s98, 63
    v_writelane_b32 v121, s99, 63
    s_cmp_eq_u32 s16, 0
    s_cbranch_scc1 L_nowue
    global_load_dword a254, v[120:121], off
L_nowue:
    s_add_u32 m0, s28, 128512
    s_nop 0
    buffer_load_dwordx4 v142, s[8:11], 0 offen nt lds
    s_add_u32 m0, s28, 132608
    s_nop 0
    buffer_load_dwordx4 v144, s[8:11], 0 offen nt lds
    s_add_u32 m0, s28, 0
    s_nop 0
    buffer_load_dwordx4 v10, s[8:11], s25 offen nt lds
    s_add_u32 m0, s28, 4096
    s_nop 0
    buffer_load_dwordx4 v11, s[8:11], s25 offen nt lds
    s_mov_b64 s[48:49], s[78:79]
    s_mov_b64 s[52:53], s[80:81]
    s_mov_b64 s[60:61], s[84:85]
    s_mov_b64 s[64:65], s[86:87]
    s_mov_b64 s[56:57], s[88:89]
    s_mov_b64 s[46:47], s[82:83]
    s_load_dwordx2 s[42:43], s[0:1], 72
    s_add_u32 m0, s68, 0
    s_add_u32 s4, s45, 384
    v_add_u32 v141, s16, v118
    v_and_b32 v141, 3, v141
    v_lshlrev_b32 v141, 1, v141
    s_mov_b32 s54, 73728
    s_mov_b32 s55, 0x00020000
    s_mov_b32 s62, 64
    s_mov_b32 s63, 0x00020000
    s_mov_b32 s66, 128
    s_mov_b32 s67, 0x00020000
    s_mov_b32 s58, 676
    s_mov_b32 s59, 0x00020000
    s_mov_b32 s14, 0
    s_mov_b32 s15, 0x00020000
    v_mov_b32 v117, 0
    v_cmp_lt_u32 s[90:91], 7, v130
    v_mov_b32 v115, 0
    v_mov_b32 v125, 0
    v_mov_b32 v121, 0
    v_lshlrev_b32 v120, 1, v118
    v_mul_u32_u24 v114, 12, v130
    s_mul_i32 s71, s16, 192
    v_add_u32 v114, s71, v114
    v_lshlrev_b32 v124, 5, v119
    s_mul_i32 s72, s16, 8064
    s_add_u32 s72, s72, 104448
    s_mul_i32 s73, s16, 6528
    s_add_u32 s73, s73, 38912
    v_lshrrev_b32 v127, 2, v130
    v_and_b32 v123, 1, v127
    v_mul_u32_u24 v123, 0x020202, v123
    v_lshl_or_b32 v123, v123, 8, v123
    v_add_u32 v123, 0x05040100, v123
    v_and_b32 v122, 3, v130
    v_lshrrev_b32 v116, 1, v130
    v_xor_b32 v116, v116, v119
    v_mul_u32_u24 v126, 384, v130
    v_lshl_add_u32 v0, v116, 4, v126
    v_xor_b32 v1, 64, v0
    v_and_b32 v116, 2, v119
    v_add_u32 v116, v116, v119
    v_lshl_add_u32 v116, v116, 2, v127
    v_mul_u32_u24 v116, 96, v116
    v_lshl_add_u32 v116, v122, 3, v116
    v_add_u32 v128, s68, v116
    v_add_u32 v126, s69, v116
    v_add_u32 v129, s72, v116
    v_add_u32 v142, s73, v116
    v_mov_b32 v28, 0x3f803f80
    v_mov_b32 v29, 0x3f803f80
    v_mov_b32 v30, 0x3f803f80
    v_mov_b32 v31, 0x3f803f80
    v_mul_u32_u24 v146, 768, v119
    v_add_u32 v146, v114, v146
    v_add_u32 v146, 157184, v146
    s_mov_b32 s76, 0x3f80
    v_and_b32 v143, 1, v130
    v_lshlrev_b32 v143, 4, v143
    v_lshlrev_b32 v144, v143, s76
    v_mov_b32 v145, 0x3c003c00
    v_mov_b32 v44, 1.0
    v_mov_b32 v45, 1.0
    v_lshlrev_b32 v147, 4, v119
    s_mov_b32 s19, s38
    s_mov_b32 s23, s25
    s_mov_b32 s26, 0
    s_mov_b32 s27, 0
    s_mov_b32 s18, 0
    s_add_u32 s19, s19, s20
    s_add_u32 s23, s23, s21
    s_cmp_ge_u32 s19, 72
    s_cselect_b32 s34, 72, 0
    s_cselect_b32 s35, s22, 0
    s_sub_u32 s19, s19, s34
    s_add_u32 s23, s23, s35
    s_mov_b32 s24, s23
    s_add_u32 s19, s19, s20
    s_add_u32 s23, s23, s21
    s_cmp_ge_u32 s19, 72
    s_cselect_b32 s34, 72, 0
    s_cselect_b32 s35, s22, 0
    s_sub_u32 s19, s19, s34
    s_add_u32 s23, s23, s35
    s_mul_i32 s79, s16, 64
    v_lshl_add_u32 v154, v119, 4, s79
    s_mul_i32 s80, s16, 32
    s_add_u32 s80, s80, 256
    v_lshl_add_u32 v150, v119, 3, s80
    v_add_u32 v148, 0, v130
    v_mul_u32_u24 v155, 37, v148
    v_mul_u32_u24 v116, 384, v148
    v_lshrrev_b32 v155, 8, v155
    v_mad_u32_u24 v116, v155, s70, v116
    v_add_u32 v15, v116, v154
    v_add_u32 v18, v116, v150
    v_mul_u32_u24 v149, 37, v148
    v_lshrrev_b32 v149, 8, v149
    v_mul_u32_u24 v156, 7, v149
    v_sub_u32 v156, v148, v156
    v_add_u32 v153, 16, v130
    v_mul_u32_u24 v152, 37, v153
    v_mul_u32_u24 v116, 384, v153
    v_lshrrev_b32 v152, 8, v152
    v_mad_u32_u24 v116, v152, s70, v116
    v_add_u32 v16, v116, v154
    v_add_u32 v19, v116, v150
    v_mul_u32_u24 v158, 37, v153
    v_lshrrev_b32 v158, 8, v158
    v_mul_u32_u24 v157, 7, v158
    v_sub_u32 v157, v153, v157
    v_add_u32 v151, 32, v130
    v_mul_u32_u24 v116, 37, v151
    v_mul_u32_u24 v159, 384, v151
    v_lshrrev_b32 v116, 8, v116
    v_mad_u32_u24 v159, v116, s70, v159
    v_add_u32 v17, v159, v154
    v_add_u32 v20, v159, v150
    v_mul_u32_u24 v154, 37, v151
    v_lshrrev_b32 v154, 8, v154
    v_mul_u32_u24 v150, 7, v154
    v_sub_u32 v150, v151, v150
    s_mul_i32 s81, s16, 768
    s_add_u32 s81, s81, 157184
    v_mul_u32_u24 v155, 24, v155
    v_lshl_add_u32 v155, v148, 2, v155
    v_add_u32 v22, s81, v155
    v_sub_u32 v23, s81, v155
    v_sub_u32 v155, v22, v147
    v_mul_u32_u24 v152, 24, v152
    v_lshl_add_u32 v152, v153, 2, v152
    v_add_u32 v24, s81, v152
    v_sub_u32 v25, s81, v152
    v_sub_u32 v152, v24, v147
    v_mul_u32_u24 v116, 24, v116
    v_lshl_add_u32 v116, v151, 2, v116
    v_add_u32 v26, s81, v116
    v_sub_u32 v27, s81, v116
    v_sub_u32 v116, v26, v147
    v_mul_u32_u24 v160, 148, v119
    s_mov_b32 s82, -24
    v_add_u32 v159, 0, v160
    v_lshrrev_b32 v159, 8, v159
    v_mad_i32_i24 v46, v159, s82, v155
    v_mad_i32_i24 v58, v159, s82, v152
    v_mad_i32_i24 v70, v159, s82, v116
    v_add_u32 v159, 37, v160
    v_lshrrev_b32 v159, 8, v159
    v_mad_i32_i24 v47, v159, s82, v155
    v_mad_i32_i24 v59, v159, s82, v152
    v_mad_i32_i24 v71, v159, s82, v116
    v_add_u32 v159, 74, v160
    v_lshrrev_b32 v159, 8, v159
    v_mad_i32_i24 v48, v159, s82, v155
    v_mad_i32_i24 v60, v159, s82, v152
    v_mad_i32_i24 v72, v159, s82, v116
    v_add_u32 v159, 111, v160
    v_lshrrev_b32 v159, 8, v159
    v_mad_i32_i24 v49, v159, s82, v155
    v_mad_i32_i24 v61, v159, s82, v152
    v_mad_i32_i24 v73, v159, s82, v116
    v_add_u32 v159, 592, v160
    v_lshrrev_b32 v159, 8, v159
    v_mad_i32_i24 v50, v159, s82, v155
    v_mad_i32_i24 v62, v159, s82, v152
    v_mad_i32_i24 v74, v159, s82, v116
    v_add_u32 v159, 629, v160
    v_lshrrev_b32 v159, 8, v159
    v_mad_i32_i24 v51, v159, s82, v155
    v_mad_i32_i24 v63, v159, s82, v152
    v_mad_i32_i24 v75, v159, s82, v116
    v_add_u32 v159, 666, v160
    v_lshrrev_b32 v159, 8, v159
    v_mad_i32_i24 v52, v159, s82, v155
    v_mad_i32_i24 v64, v159, s82, v152
    v_mad_i32_i24 v76, v159, s82, v116
    v_add_u32 v159, 703, v160
    v_lshrrev_b32 v159, 8, v159
    v_mad_i32_i24 v53, v159, s82, v155
    v_mad_i32_i24 v65, v159, s82, v152
    v_mad_i32_i24 v77, v159, s82, v116
    v_add_u32 v159, 1184, v160
    v_lshrrev_b32 v159, 8, v159
    v_mad_i32_i24 v54, v159, s82, v155
    v_mad_i32_i24 v66, v159, s82, v152
    v_mad_i32_i24 v78, v159, s82, v116
    v_add_u32 v159, 1221, v160
    v_lshrrev_b32 v159, 8, v159
    v_mad_i32_i24 v55, v159, s82, v155
    v_mad_i32_i24 v67, v159, s82, v152
    v_mad_i32_i24 v79, v159, s82, v116
    v_add_u32 v159, 1258, v160
    v_lshrrev_b32 v159, 8, v159
    v_mad_i32_i24 v56, v159, s82, v155
    v_mad_i32_i24 v68, v159, s82, v152
    v_mad_i32_i24 v80, v159, s82, v116
    v_add_u32 v159, 1295, v160
    v_lshrrev_b32 v159, 8, v159
    v_mad_i32_i24 v57, v159, s82, v155
    v_mad_i32_i24 v69, v159, s82, v152
    v_mad_i32_i24 v81, v159, s82, v116
    v_mov_b32 v155, s81
    v_lshlrev_b32 v116, 4, v118
    v_xor_b32 v2, 65536, v116
    v_lshl_add_u32 v3, s16, 10, v116
    s_lshr_b32 s83, s16, 1
    s_and_b32 s84, s16, 1
    s_lshl_b32 s84, s84, 3
    s_lshl_b32 s85, s83, 10
    s_add_u32 s85, s85, s84
    v_add_u32 v4, s85, v116
    s_lshl_b32 s83, s83, 11
    s_add_u32 s83, s83, s84
    s_add_u32 s83, s83, 144896
    s_mul_i32 s86, s16, 2048
    s_add_u32 s86, s86, 136704
    v_lshl_add_u32 v152, v119, 3, s86
    v_mov_b32 v160, s83
    v_mov_b32 v161, 161536
    v_mul_u32_u24 v159, 80, v119
    v_add3_u32 v5, v159, v143, s72
    v_lshl_add_u32 v6, v130, 2, s73
    s_mul_i32 s87, s16, 128
    s_add_u32 s87, s87, 65024
    s_mov_b32 s40, s8
    buffer_load_dwordx4 v133, s[48:51], s4 offen lds
    v_add_u32 v9, s87, v147
    v_lshrrev_b32 v116, 1, v119
    s_mov_b32 s41, s9
    s_mov_b32 s32, 0x2a8cbccc
    buffer_load_dwordx4 v135, s[48:51], s4 offen offset:1024 lds
    v_mul_u32_u24 v116, 48, v116
    v_lshl_add_u32 v116, v119, 3, v116
    s_mov_b32 s33, 0x38fba882
    s_add_u32 s75, s28, 16384
    buffer_load_dwordx4 v137, s[48:51], s4 offen offset:2048 lds
    s_add_u32 m0, s68, 3072
    s_add_u32 s4, s45, 37248
    s_cmp_lt_u32 s16, 2
    s_cselect_b32 s29, s75, 160256
    buffer_load_dwordx4 v133, s[48:51], s4 offen lds
    v_lshl_add_u32 v116, v127, 4, v116
    v_lshl_add_u32 v116, v122, 1, v116
    s_cselect_b32 s30, 65536, 0
    s_xor_b32 s74, s29, s30
    buffer_load_dwordx4 v135, s[48:51], s4 offen offset:1024 lds
    v_add_u32 v8, s87, v116
    v_mov_b32 v37, 0
    s_lshl_b32 s92, s5, 1
    s_or_b32 s92, s92, s6
    buffer_load_dwordx4 v137, s[48:51], s4 offen offset:2048 lds
    s_add_u32 m0, s69, 0
    s_add_u32 s4, s45, 74112
    s_mul_i32 s77, s16, 64
    s_mul_i32 s78, s16, 32
    buffer_load_ushort v116, v120, s[60:63], 0 offen
    v_mov_b32 v38, 0
    s_add_u32 s78, s78, 192
    s_add_u32 s34, s18, 2
    buffer_load_dwordx3 v[182:184], v114, s[56:59], 0 offen
    v_mov_b32 v39, 0
    s_mov_b32 s27, s26
    s_mov_b32 s26, s25
    buffer_load_dwordx4 v[174:177], v124, s[64:67], 0 offen
    v_add_u32 v164, 148992, v0
    v_add_u32 v163, 148992, v1
    v_lshlrev_b32 v185, 4, v130
    v_add_u32 v185, 160256, v185
    v_mul_u32_u24 v167, 336, v130
    v_add3_u32 v167, v167, v159, s72
    v_mul_u32_u24 v166, 272, v130
    v_add3_u32 v166, v166, v147, s73
    v_mul_u32_u24 v165, 1088, v119
    v_add_u32 v165, v165, v6
    v_add_u32 v159, 5376, v167
    v_add_u32 v169, 4352, v166
    v_add_u32 v168, 4352, v165
    v_cmp_gt_u32 s[88:89], 16, v118
    v_mov_b32 v162, 0xf149f2ca
    v_add_u32 v170, 512, v254
    v_mul_u32_u24 v114, 2731, v170
    v_bfe_u32 v120, v114, 17, 3
    v_lshrrev_b32 v114, 16, v114
    v_xor_b32 v170, v120, v170
    v_mul_u32_u24 v120, 37, v114
    v_lshrrev_b32 v120, 8, v120
    v_lshlrev_b32 v170, 4, v170
    v_mad_u32_u24 v12, v120, s70, v170
    v_mul_u32_u24 v170, 37, v114
    v_lshrrev_b32 v170, 8, v170
    v_mul_u32_u24 v171, 7, v170
    v_sub_u32 v171, v114, v171
    s_add_u32 s19, s19, s20
    s_mov_b32 s18, 1
    buffer_load_dwordx4 v[198:201], v124, s[64:67], 0 offen offset:16
    v_cmp_gt_u32 vcc, 4, v170
    v_add_u32 v124, 768, v254
    v_mul_u32_u24 v114, 2731, v124
    v_cndmask_b32 v170, v138, v136, vcc
    v_cmp_gt_u32 vcc, 4, v171
    v_bfe_u32 v120, v114, 17, 3
    v_lshrrev_b32 v114, 16, v114
    v_cndmask_b32 v171, v140, v139, vcc
    v_add3_u32 v12, v12, v170, v171
    v_xor_b32 v124, v120, v124
    v_mul_u32_u24 v120, 37, v114
    v_lshrrev_b32 v120, 8, v120
    v_lshlrev_b32 v124, 4, v124
    v_mad_u32_u24 v13, v120, s70, v124
    v_mul_u32_u24 v120, 37, v114
    v_lshrrev_b32 v120, 8, v120
    v_mul_u32_u24 v170, 7, v120
    v_sub_u32 v170, v114, v170
    v_cmp_gt_u32 vcc, 4, v120
    v_add_u32 v114, 1024, v254
    v_mul_u32_u24 v124, 2731, v114
    v_cndmask_b32 v120, v138, v136, vcc
    v_cmp_gt_u32 vcc, 4, v170
    v_bfe_u32 v254, v124, 17, 3
    v_lshrrev_b32 v124, 16, v124
    v_cndmask_b32 v170, v140, v139, vcc
    v_add3_u32 v13, v13, v120, v170
    v_xor_b32 v114, v254, v114
    v_mul_u32_u24 v254, 37, v124
    v_lshrrev_b32 v254, 8, v254
    v_lshlrev_b32 v114, 4, v114
    v_mad_u32_u24 v14, v254, s70, v114
    v_mul_u32_u24 v120, 37, v124
    v_lshrrev_b32 v120, 8, v120
    v_mul_u32_u24 v114, 7, v120
    v_sub_u32 v114, v124, v114
    v_cmp_gt_u32 vcc, 4, v120
    v_mov_b32 v254, 0xc31044fe
    v_mul_u32_u24 v170, 37, v148
    v_cndmask_b32 v120, v138, v136, vcc
    v_cmp_gt_u32 vcc, 4, v114
    v_lshrrev_b32 v170, 8, v170
    v_mul_u32_u24 v171, 7, v170
    v_cndmask_b32 v114, v140, v139, vcc
    v_add3_u32 v14, v14, v120, v114
    v_cmp_gt_u32 vcc, 48, v124
    v_sub_u32 v171, v148, v171
    global_load_ushort v141, v141, s[46:47]
    s_waitcnt vmcnt(10)
    s_barrier
    v_cndmask_b32 v14, v255, v14, vcc
    v_cmp_gt_u32 vcc, 2, v122
    v_lshrrev_b32 v170, 2, v170
    v_lshrrev_b32 v171, 2, v171
    v_cndmask_b32 v32, 0, v144, vcc
    v_cndmask_b32 v33, v144, 0, vcc
    v_cndmask_b32 v34, 0, v144, vcc
    v_cndmask_b32 v35, v144, 0, vcc
    v_cmp_eq_u32 vcc, 0, v143
    v_and_b32 v170, s5, v170
    v_and_b32 v171, s6, v171
    v_cndmask_b32 v40, 0, v145, vcc
    buffer_load_dwordx4 v133, s[48:51], s4 offen lds
    v_cndmask_b32 v41, v145, 0, vcc
    v_cndmask_b32 v42, 0, v145, vcc
    v_cndmask_b32 v43, v145, 0, vcc
    v_cmp_eq_u32 vcc, v119, v127
    v_lshl_or_b32 v170, v170, 1, v171
    v_mul_u32_u24 v255, 37, v153
    v_cndmask_b32 v144, 0, v32, vcc
    v_cndmask_b32 v145, 0, v33, vcc
    v_lshrrev_b32 v255, 8, v255
    v_mul_u32_u24 v114, 7, v255
    v_sub_u32 v114, v153, v114
    v_lshrrev_b32 v255, 2, v255
    v_lshrrev_b32 v114, 2, v114
    v_and_b32 v255, s5, v255
    buffer_load_dwordx4 v135, s[48:51], s4 offen offset:1024 lds
    s_waitcnt vmcnt(10)
    ds_read_b64_tr_b16 a[72:73], v128 offset:0
    ds_read_b64_tr_b16 a[74:75], v128 offset:768
    ds_read_b64_tr_b16 a[96:97], v128 offset:32
    ds_read_b64_tr_b16 a[98:99], v128 offset:800
    ds_read_b64_tr_b16 a[120:121], v128 offset:64
    ds_read_b64_tr_b16 a[122:123], v128 offset:832
    v_and_b32 v114, s6, v114
    v_lshl_or_b32 v255, v255, 1, v114
    v_mul_u32_u24 v171, 37, v151
    v_lshrrev_b32 v171, 8, v171
    v_mul_u32_u24 v114, 7, v171
    v_sub_u32 v114, v151, v114
    v_lshrrev_b32 v171, 2, v171
    buffer_load_dwordx4 v137, s[48:51], s4 offen offset:2048 lds
    s_add_u32 m0, s69, 3072
    s_add_u32 s4, s45, 110976
    v_lshrrev_b32 v114, 2, v114
    v_and_b32 v171, s5, v171
    v_and_b32 v114, s6, v114
    v_lshl_or_b32 v171, v171, 1, v114
    v_mul_u32_u24 v120, 6, v131
    v_sub_u32 v124, v118, v120
    v_mul_u32_u24 v120, 384, v131
    v_lshl_add_u32 v120, v124, 4, v120
    v_add_u32 v114, s78, v120
    v_add_u32 v120, s77, v120
    v_cmp_gt_i32 vcc, 4, v124
    v_mul_u32_u24 v124, 6, v132
    buffer_load_dwordx4 v133, s[48:51], s4 offen lds
    v_cndmask_b32 v143, v114, v120, vcc
    v_sub_u32 v120, v118, v124
    v_mul_u32_u24 v124, 384, v132
    v_lshl_add_u32 v124, v120, 4, v124
    v_add_u32 v114, s78, v124
    v_add_u32 v124, s77, v124
    v_cmp_gt_i32 vcc, -60, v120
    v_mul_u32_u24 v131, 6, v134
    v_sub_u32 v148, v118, v131
    v_cndmask_b32 v132, v114, v124, vcc
    v_mul_u32_u24 v131, 384, v134
    v_lshl_add_u32 v131, v148, 4, v131
    s_waitcnt vmcnt(9)
    ds_read_b64_tr_b16 a[76:77], v128 offset:3072
    ds_read_b64_tr_b16 a[78:79], v128 offset:3840
    s_waitcnt vmcnt(7)
    buffer_load_dwordx4 v135, s[48:51], s4 offen offset:1024 lds
    s_waitcnt vmcnt(7)
    s_waitcnt vmcnt(6)
    ds_read_b64_tr_b16 a[100:101], v128 offset:3104
    ds_read_b64_tr_b16 a[102:103], v128 offset:3872
    ds_read_b64_tr_b16 a[124:125], v128 offset:3136
    ds_read_b64_tr_b16 a[126:127], v128 offset:3904
    v_cndmask_b32 v174, v174, v175, s[90:91]
    v_cndmask_b32 v176, v176, v177, s[90:91]
    v_perm_b32 v172, v176, v174, v123
    v_cndmask_b32 v198, v198, v199, s[90:91]
    v_cndmask_b32 v200, v200, v201, s[90:91]
    v_perm_b32 v173, v200, v198, v123
    v_bfe_u32 v114, v182, v147, 16
    v_bfe_u32 v124, v183, v147, 16
    buffer_load_dwordx4 v137, s[48:51], s4 offen offset:2048 lds
    v_mfma_f32_16x16x16_bf16 v[174:177], v[116:117], v[114:115], 0
    v_bfe_u32 v120, v184, v147, 16
    v_add_u32 v151, s78, v131
    v_add_u32 v131, s77, v131
    v_mfma_f32_16x16x16_bf16 v[198:201], v[116:117], v[124:125], 0
    v_cmp_gt_i32 vcc, -124, v148
    v_mul_u32_u24 v148, 96, v130
    v_add3_u32 v134, v148, v147, s68
    v_mfma_f32_16x16x16_bf16 v[210:213], v[116:117], v[120:121], 0
    s_add_u32 m0, s72, 0
    s_add_u32 s4, s45, 147840
    v_max_f32 v174, 0, v174
    v_max_f32 v175, 0, v175
    v_max_f32 v176, 0, v176
    buffer_load_dwordx4 v133, s[48:51], s4 offen lds
    s_waitcnt vmcnt(7)
    v_max_f32 v177, 0, v177
    v_cvt_pk_bf16_f32 v120, v174, v175
    v_cvt_pk_bf16_f32 v121, v176, v177
    v_max_f32 v198, 0, v198
    v_max_f32 v199, 0, v199
    v_mfma_f32_16x16x16_bf16 v[114:117], v[172:173], v[120:121], 0
    v_max_f32 v200, 0, v200
    v_max_f32 v201, 0, v201
    v_cvt_pk_bf16_f32 v120, v198, v199
    v_cvt_pk_bf16_f32 v121, v200, v201
    v_max_f32 v210, 0, v210
    v_max_f32 v211, 0, v211
    v_mfma_f32_16x16x16_bf16 v[174:177], v[172:173], v[120:121], 0
    buffer_load_dwordx4 v135, s[48:51], s4 offen offset:1024 lds
    v_cvt_pk_bf16_f32 v114, v114, v114
    v_and_b32 v114, 0xffff0000, v114
    v_mul_f32 v114, 0xbfb8aa3b, v114
    v_exp_f32 v114, v114
    v_max_f32 v212, 0, v212
    v_add_f32 v114, 1.0, v114
    v_rcp_f32 v114, v114
    v_cvt_pk_bf16_f32 v174, v174, v174
    v_cvt_pk_bf16_f32 v114, v114, v114
    v_and_b32 v114, 0xffff0000, v114
    v_add_f32 v114, -0.5, v114
    v_mul_f32 v114, 0x41b8aa3b, v114
    buffer_load_dwordx4 v137, s[48:51], s4 offen offset:2048 lds
    ds_write_b32 v146, v114 offset:0
    s_add_u32 m0, s72, 3072
    s_add_u32 s4, s45, 184704
    v_and_b32 v174, 0xffff0000, v174
    v_mul_f32 v174, 0xbfb8aa3b, v174
    v_exp_f32 v174, v174
    v_max_f32 v213, 0, v213
    v_add_f32 v174, 1.0, v174
    v_rcp_f32 v174, v174
    v_cvt_pk_bf16_f32 v210, v210, v211
    v_cvt_pk_bf16_f32 v174, v174, v174
    s_waitcnt vmcnt(6)
    buffer_load_dwordx4 v133, s[48:51], s4 offen lds
    ds_read_b64_tr_b16 a[80:81], v126 offset:0
    ds_read_b64_tr_b16 a[82:83], v126 offset:768
    ds_read_b64_tr_b16 a[104:105], v126 offset:32
    ds_read_b64_tr_b16 a[106:107], v126 offset:800
    ds_read_b64_tr_b16 a[128:129], v126 offset:64
    ds_read_b64_tr_b16 a[130:131], v126 offset:832
    v_and_b32 v174, 0xffff0000, v174
    v_add_f32 v174, -0.5, v174
    v_mul_f32 v174, 0x41b8aa3b, v174
    ds_write_b32 v146, v174 offset:4
    v_cvt_pk_bf16_f32 v211, v212, v213
    buffer_load_dwordx4 v135, s[48:51], s4 offen offset:1024 lds
    v_lshlrev_b32 v141, 16, v141
    v_mfma_f32_16x16x16_bf16 v[114:117], v[172:173], v[210:211], 0
    v_max_f32 v141, 0xc2c80000, v141
    v_min_f32 v141, 0x40930000, v141
    v_mul_f32 v141, 0x3fb8aa3b, v141
    v_exp_f32 v141, v141
    v_cndmask_b32 v118, v151, v131, vcc
    v_cvt_pk_bf16_f32 v141, v141, v141
    v_and_b32 v141, 0xffff0000, v141
    v_mul_f32 v131, 0x3fb8aa3b, v141
    v_cvt_pk_bf16_f32 v114, v114, v114
    v_and_b32 v114, 0xffff0000, v114
    v_mul_f32 v114, 0xbfb8aa3b, v114
    buffer_load_dwordx4 v137, s[48:51], s4 offen offset:2048 lds
    s_add_u32 m0, s73, 0
    s_add_u32 s4, s45, 36864
    v_exp_f32 v114, v114
    v_readfirstlane_b32 s37, v141
    v_add_f32 v114, 1.0, v114
    v_rcp_f32 v114, v114
    v_readfirstlane_b32 s31, v131
    v_cvt_pk_bf16_f32 v114, v114, v114
    v_and_b32 v114, 0xffff0000, v114
    v_add_f32 v114, -0.5, v114
    v_mul_f32 v114, 0x41b8aa3b, v114
    ds_write_b32 v146, v114 offset:8
    s_waitcnt vmcnt(6)
    buffer_load_dwordx4 v133, s[48:51], s45 offen lds
    v_cmp_gt_u32 vcc, 4, v149
    ds_read_b64_tr_b16 a[84:85], v126 offset:3072
    ds_read_b64_tr_b16 a[86:87], v126 offset:3840
    ds_read_b64_tr_b16 a[108:109], v126 offset:3104
    ds_read_b64_tr_b16 a[110:111], v126 offset:3872
    ds_read_b64_tr_b16 a[132:133], v126 offset:3136
    ds_read_b64_tr_b16 a[134:135], v126 offset:3904
    v_cndmask_b32 v149, v138, v136, vcc
    v_cmp_gt_u32 vcc, 4, v156
    v_lshl_add_u32 v120, v119, 3, v148
    v_add3_u32 v120, v120, 64, s68
    v_cndmask_b32 v156, v140, v139, vcc
    buffer_load_dwordx4 v135, s[48:51], s45 offen offset:1024 lds
    v_add3_u32 v15, v15, v149, v156
    v_add3_u32 v18, v18, v149, v156
    v_cmp_gt_u32 vcc, 4, v158
    v_add3_u32 v131, v148, v147, s69
    v_lshl_add_u32 v121, v119, 3, v148
    s_waitcnt lgkmcnt(6)
    s_barrier
    ds_read_b32 v22, v22 offset:0
    ds_read_b32 v23, v23 offset:672
    ds_read_b32 v24, v24 offset:0
    ds_read_b32 v25, v25 offset:672
    ds_read_b32 v26, v26 offset:0
    ds_read_b32 v27, v27 offset:672
    ds_read_b32 v46, v46 offset:336
    ds_read_b32 v58, v58 offset:336
    buffer_load_dwordx4 v137, s[48:51], s45 offen offset:2048 lds
    ds_read_b32 v70, v70 offset:336
    ds_read_b32 v47, v47 offset:332
    ds_read_b32 v59, v59 offset:332
    s_add_u32 m0, s73, 3072
    ds_read_b32 v71, v71 offset:332
    v_cndmask_b32 v158, v138, v136, vcc
    v_cmp_gt_u32 vcc, 4, v157
    ds_read_b32 v48, v48 offset:328
    ds_read_b32 v60, v60 offset:328
    ds_read_b32 v72, v72 offset:328
    ds_read_b32 v49, v49 offset:324
    s_waitcnt vmcnt(6)
    ds_read_b64_tr_b16 a[88:89], v129 offset:0
    buffer_load_dwordx4 v133, s[48:51], s4 offen lds
    ds_read_b64_tr_b16 a[90:91], v129 offset:768
    ds_read_b64_tr_b16 a[112:113], v129 offset:32
    ds_read_b64_tr_b16 a[114:115], v129 offset:800
    ds_read_b64_tr_b16 a[136:137], v129 offset:64
    ds_read_b64_tr_b16 a[138:139], v129 offset:832
    v_cndmask_b32 v157, v140, v139, vcc
    v_add3_u32 v16, v16, v158, v157
    v_add3_u32 v19, v19, v158, v157
    v_cmp_gt_u32 vcc, 4, v154
    ds_read_b32 v61, v61 offset:324
    ds_read_b32 v73, v73 offset:324
    ds_read_b32 v50, v50 offset:272
    buffer_load_dwordx4 v135, s[48:51], s4 offen offset:1024 lds
    ds_read_b32 v62, v62 offset:272
    ds_read_b32 v74, v74 offset:272
    ds_read_b32 v51, v51 offset:268
    ds_read_b32 v63, v63 offset:268
    ds_read_b32 v75, v75 offset:268
    v_cndmask_b32 v154, v138, v136, vcc
    v_cmp_gt_u32 vcc, 4, v150
    ds_read_b32 v52, v52 offset:264
    ds_read_b32 v64, v64 offset:264
    ds_read_b32 v76, v76 offset:264
    ds_read_b32 v53, v53 offset:260
    v_cndmask_b32 v150, v140, v139, vcc
    buffer_load_dwordx4 v137, s[48:51], s4 offen offset:2048 lds
    ds_read_b32 v65, v65 offset:260
    ds_read_b32 v77, v77 offset:260
    ds_read_b32 v54, v54 offset:208
    ds_read_b32 v66, v66 offset:208
    ds_read_b32 v78, v78 offset:208
    s_add_u32 m0, s68, 0
    ds_read_b32 v55, v55 offset:204
    s_add_u32 s4, s45, 73728
    ds_read_b32 v67, v67 offset:204
    v_add3_u32 v17, v17, v154, v150
    v_add3_u32 v20, v20, v154, v150
    v_cmp_gt_u32 vcc, 2, v119
    ds_read_b32 v79, v79 offset:204
    s_waitcnt vmcnt(6)
    buffer_load_dwordx4 v133, s[48:51], s4 offen lds
    ds_read_b64_tr_b16 a[92:93], v129 offset:3072
    ds_read_b64_tr_b16 a[94:95], v129 offset:3840
    ds_read_b64_tr_b16 a[116:117], v129 offset:3104
    ds_read_b64_tr_b16 a[118:119], v129 offset:3872
    ds_read_b64_tr_b16 a[140:141], v129 offset:3136
    ds_read_b64_tr_b16 a[142:143], v129 offset:3904
    ds_read_b32 v56, v56 offset:200
    v_cndmask_b32 v152, v160, v152, vcc
    v_lshl_add_u32 v152, v127, 9, v152
    v_lshl_add_u32 v152, v122, 1, v152
    v_cmp_gt_u32 vcc, 3, v119
    ds_read_b32 v68, v68 offset:200
    ds_read_b32 v80, v80 offset:200
    ds_read_b32 v57, v57 offset:196
    buffer_load_dwordx4 v135, s[48:51], s4 offen offset:1024 lds
    ds_read_b32 v69, v69 offset:196
    ds_read_b32 v81, v81 offset:196
    ds_read_b32 v155, v155 offset:336
    v_cndmask_b32 v7, v161, v152, vcc
    v_cmp_gt_u32 vcc, 8, v130
    v_lshl_add_u32 v130, v119, 2, 0
    v_mul_u32_u24 v129, 37, v130
    v_cndmask_b32 v159, v185, v159, vcc
    v_cndmask_b32 v169, v185, v169, vcc
    v_cmp_gt_u32 vcc, 2, v119
    v_lshrrev_b32 v129, 8, v129
    v_mul_u32_u24 v127, 7, v129
    v_cndmask_b32 v168, v185, v168, vcc
    v_cmp_ne_u32 vcc, s92, v170
    buffer_load_dwordx4 v137, s[48:51], s4 offen offset:2048 lds
    s_add_u32 m0, s68, 3072
    s_add_u32 s4, s45, 110592
    v_cndmask_b32 v136, 0, v254, vcc
    s_waitcnt lgkmcnt(6)
    v_add_f32 v22, v22, v136
    v_cmp_ne_u32 vcc, s92, v170
    v_sub_u32 v127, v130, v127
    v_lshrrev_b32 v129, 2, v129
    v_cndmask_b32 v130, 0, v254, vcc
    v_add_f32 v23, v23, v130
    v_cmp_ne_u32 vcc, s92, v255
    v_lshrrev_b32 v127, 2, v127
    s_waitcnt lgkmcnt(0)
    v_readfirstlane_b32 s39, v155
    buffer_load_dwordx4 v133, s[48:51], s4 offen lds
    s_waitcnt vmcnt(7)
    ds_read_b64_tr_b16 a[0:1], v142 offset:0
    ds_read_b64_tr_b16 a[2:3], v142 offset:768
    ds_read_b64_tr_b16 a[24:25], v142 offset:32
    ds_read_b64_tr_b16 a[26:27], v142 offset:800
    ds_read_b64_tr_b16 a[48:49], v142 offset:64
    ds_read_b64_tr_b16 a[50:51], v142 offset:832
    v_cndmask_b32 v130, 0, v254, vcc
    v_add_f32 v24, v24, v130
    v_cmp_ne_u32 vcc, s92, v255
    v_and_b32 v129, s5, v129
    v_and_b32 v127, s6, v127
    v_cndmask_b32 v130, 0, v254, vcc
    v_add_f32 v25, v25, v130
    buffer_load_dwordx4 v135, s[48:51], s4 offen offset:1024 lds
    v_cmp_ne_u32 vcc, s92, v171
    v_lshl_or_b32 v129, v129, 1, v127
    v_lshl_add_u32 v127, v119, 2, 1
    v_cndmask_b32 v130, 0, v254, vcc
    v_add_f32 v26, v26, v130
    v_cmp_ne_u32 vcc, s92, v171
    v_mul_u32_u24 v130, 37, v127
    v_lshrrev_b32 v130, 8, v130
    v_cndmask_b32 v136, 0, v254, vcc
    v_add_f32 v27, v27, v136
    v_cmp_ne_u32 vcc, v129, v170
    v_mul_u32_u24 v136, 7, v130
    v_sub_u32 v136, v127, v136
    v_cndmask_b32 v127, 0, v254, vcc
    buffer_load_dwordx4 v137, s[48:51], s4 offen offset:2048 lds
    s_add_u32 m0, s69, 0
    s_add_u32 s4, s45, 147456
    v_add_f32 v46, v46, v127
    v_cmp_ne_u32 vcc, v129, v255
    v_lshrrev_b32 v130, 2, v130
    v_lshrrev_b32 v136, 2, v136
    v_cndmask_b32 v127, 0, v254, vcc
    v_add_f32 v58, v58, v127
    v_cmp_ne_u32 vcc, v129, v171
    v_and_b32 v130, s5, v130
    v_and_b32 v136, s6, v136
    v_cndmask_b32 v127, 0, v254, vcc
    v_add_f32 v70, v70, v127
    v_lshl_or_b32 v130, v130, 1, v136
    buffer_load_dwordx4 v133, s[48:51], s4 offen lds
    s_waitcnt vmcnt(7)
    ds_read_b64_tr_b16 a[4:5], v142 offset:3072
    ds_read_b64_tr_b16 a[6:7], v142 offset:3840
    ds_read_b64_tr_b16 a[28:29], v142 offset:3104
    ds_read_b64_tr_b16 a[30:31], v142 offset:3872
    ds_read_b64_tr_b16 a[52:53], v142 offset:3136
    ds_read_b64_tr_b16 a[54:55], v142 offset:3904
    v_cmp_ne_u32 vcc, v130, v170
    v_lshl_add_u32 v136, v119, 2, 2
    v_mul_u32_u24 v142, 37, v136
    v_cndmask_b32 v127, 0, v254, vcc
    v_add_f32 v47, v47, v127
    v_cmp_ne_u32 vcc, v130, v255
    v_lshrrev_b32 v142, 8, v142
    buffer_load_dwordx4 v135, s[48:51], s4 offen offset:1024 lds
    v_cndmask_b32 v127, 0, v254, vcc
    v_add_f32 v59, v59, v127
    v_cmp_ne_u32 vcc, v130, v171
    v_mul_u32_u24 v127, 7, v142
    v_sub_u32 v127, v136, v127
    v_cndmask_b32 v130, 0, v254, vcc
    v_add_f32 v71, v71, v130
    v_lshrrev_b32 v142, 2, v142
    v_lshrrev_b32 v127, 2, v127
    v_and_b32 v142, s5, v142
    v_and_b32 v127, s6, v127
    v_lshl_or_b32 v142, v142, 1, v127
    v_cmp_ne_u32 vcc, v142, v170
    v_lshl_add_u32 v130, v119, 2, 3
    buffer_load_dwordx4 v137, s[48:51], s4 offen offset:2048 lds
    s_add_u32 m0, s69, 3072
    s_add_u32 s4, s45, 184320
    v_cndmask_b32 v136, 0, v254, vcc
    v_add_f32 v48, v48, v136
    v_cmp_ne_u32 vcc, v142, v255
    v_mul_u32_u24 v127, 37, v130
    v_lshrrev_b32 v127, 8, v127
    v_cndmask_b32 v136, 0, v254, vcc
    v_add_f32 v60, v60, v136
    v_cmp_ne_u32 vcc, v142, v171
    v_mul_u32_u24 v129, 7, v127
    v_sub_u32 v129, v130, v129
    v_cndmask_b32 v130, 0, v254, vcc
    v_add_f32 v72, v72, v130
    buffer_load_dwordx4 v133, s[48:51], s4 offen lds
    s_waitcnt vmcnt(7)
    ds_read_b64_tr_b16 a[8:9], v128 offset:0
    ds_read_b64_tr_b16 a[10:11], v128 offset:768
    ds_read_b64_tr_b16 a[32:33], v128 offset:32
    ds_read_b64_tr_b16 a[34:35], v128 offset:800
    ds_read_b64_tr_b16 a[56:57], v128 offset:64
    ds_read_b64_tr_b16 a[58:59], v128 offset:832
    v_lshrrev_b32 v127, 2, v127
    v_lshrrev_b32 v129, 2, v129
    v_and_b32 v127, s5, v127
    v_and_b32 v129, s6, v129
    v_lshl_or_b32 v127, v127, 1, v129
    v_cmp_ne_u32 vcc, v127, v170
    v_lshl_add_u32 v130, v119, 2, 16
    buffer_load_dwordx4 v135, s[48:51], s4 offen offset:1024 lds
    v_cndmask_b32 v129, 0, v254, vcc
    v_add_f32 v49, v49, v129
    v_cmp_ne_u32 vcc, v127, v255
    v_mul_u32_u24 v142, 37, v130
    v_lshrrev_b32 v142, 8, v142
    v_cndmask_b32 v129, 0, v254, vcc
    v_add_f32 v61, v61, v129
    v_cmp_ne_u32 vcc, v127, v171
    v_mul_u32_u24 v136, 7, v142
    v_sub_u32 v136, v130, v136
    v_cndmask_b32 v130, 0, v254, vcc
    v_add_f32 v73, v73, v130
    v_lshrrev_b32 v142, 2, v142
    v_lshrrev_b32 v136, 2, v136
    buffer_load_dwordx4 v137, s[48:51], s4 offen offset:2048 lds
    s_add_u32 m0, s68, 0
    s_add_u32 s4, s45, 768
    s_waitcnt lgkmcnt(0)
    v_and_b32 v142, s5, v142
    v_and_b32 v136, s6, v136
    v_lshl_or_b32 v142, v142, 1, v136
    v_cmp_ne_u32 vcc, v142, v170
    v_lshl_add_u32 v127, v119, 2, 17
    v_mul_u32_u24 v130, 37, v127
    v_cndmask_b32 v136, 0, v254, vcc
    v_add_f32 v50, v50, v136
    v_cmp_ne_u32 vcc, v142, v255
    v_lshrrev_b32 v130, 8, v130
    v_mul_u32_u24 v136, 7, v130
    buffer_load_dwordx4 v133, s[48:51], s4 offen lds
    s_waitcnt vmcnt(7)
    ds_read_b64_tr_b16 a[12:13], v128 offset:3072
    ds_read_b64_tr_b16 a[14:15], v128 offset:3840
    ds_read_b64_tr_b16 a[36:37], v128 offset:3104
    ds_read_b64_tr_b16 a[38:39], v128 offset:3872
    ds_read_b64_tr_b16 a[60:61], v128 offset:3136
    ds_read_b64_tr_b16 a[62:63], v128 offset:3904
    v_cndmask_b32 v129, 0, v254, vcc
    v_add_f32 v62, v62, v129
    v_cmp_ne_u32 vcc, v142, v171
    v_sub_u32 v136, v127, v136
    v_lshrrev_b32 v130, 2, v130
    v_cndmask_b32 v142, 0, v254, vcc
    v_add_f32 v74, v74, v142
    buffer_load_dwordx4 v135, s[48:51], s4 offen offset:1024 lds
    v_lshrrev_b32 v136, 2, v136
    v_and_b32 v130, s5, v130
    v_and_b32 v136, s6, v136
    v_lshl_or_b32 v130, v130, 1, v136
    v_cmp_ne_u32 vcc, v130, v170
    v_lshl_add_u32 v127, v119, 2, 18
    v_mul_u32_u24 v142, 37, v127
    v_cndmask_b32 v136, 0, v254, vcc
    v_add_f32 v51, v51, v136
    v_cmp_ne_u32 vcc, v130, v255
    v_lshrrev_b32 v142, 8, v142
    v_mul_u32_u24 v129, 7, v142
    v_cndmask_b32 v136, 0, v254, vcc
    v_add_f32 v63, v63, v136
    buffer_load_dwordx4 v137, s[48:51], s4 offen offset:2048 lds
    s_add_u32 m0, s68, 3072
    s_add_u32 s4, s45, 37632
    s_waitcnt lgkmcnt(0)
    v_cmp_ne_u32 vcc, v130, v171
    v_sub_u32 v129, v127, v129
    v_lshrrev_b32 v142, 2, v142
    v_cndmask_b32 v130, 0, v254, vcc
    v_add_f32 v75, v75, v130
    v_lshrrev_b32 v129, 2, v129
    v_and_b32 v142, s5, v142
    v_and_b32 v129, s6, v129
    v_lshl_or_b32 v142, v142, 1, v129
    v_cmp_ne_u32 vcc, v142, v170
    v_lshl_add_u32 v136, v119, 2, 19
    buffer_load_dwordx4 v133, s[48:51], s4 offen lds
    s_waitcnt vmcnt(7)
    ds_read_b64_tr_b16 a[16:17], v126 offset:0
    ds_read_b64_tr_b16 a[18:19], v126 offset:768
    ds_read_b64_tr_b16 a[40:41], v126 offset:32
    ds_read_b64_tr_b16 a[42:43], v126 offset:800
    ds_read_b64_tr_b16 a[64:65], v126 offset:64
    ds_read_b64_tr_b16 a[66:67], v126 offset:832
    v_cndmask_b32 v130, 0, v254, vcc
    v_add_f32 v52, v52, v130
    v_cmp_ne_u32 vcc, v142, v255
    v_mul_u32_u24 v127, 37, v136
    v_lshrrev_b32 v127, 8, v127
    v_cndmask_b32 v130, 0, v254, vcc
    v_add_f32 v64, v64, v130
    buffer_load_dwordx4 v135, s[48:51], s4 offen offset:1024 lds
    v_cmp_ne_u32 vcc, v142, v171
    v_mul_u32_u24 v130, 7, v127
    v_sub_u32 v130, v136, v130
    v_cndmask_b32 v136, 0, v254, vcc
    v_add_f32 v76, v76, v136
    v_lshrrev_b32 v127, 2, v127
    v_lshrrev_b32 v130, 2, v130
    v_and_b32 v127, s5, v127
    v_and_b32 v130, s6, v130
    v_lshl_or_b32 v127, v127, 1, v130
    v_cmp_ne_u32 vcc, v127, v170
    v_lshl_add_u32 v130, v119, 2, 32
    v_mul_u32_u24 v142, 37, v130
    v_cndmask_b32 v136, 0, v254, vcc
    buffer_load_dwordx4 v137, s[48:51], s4 offen offset:2048 lds
    s_add_u32 m0, s69, 0
    s_add_u32 s4, s45, 74496
    s_waitcnt lgkmcnt(0)
    v_add_f32 v53, v53, v136
    v_cmp_ne_u32 vcc, v127, v255
    v_lshrrev_b32 v142, 8, v142
    v_mul_u32_u24 v136, 7, v142
    v_cndmask_b32 v129, 0, v254, vcc
    v_add_f32 v65, v65, v129
    v_cmp_ne_u32 vcc, v127, v171
    v_sub_u32 v136, v130, v136
    v_lshrrev_b32 v142, 2, v142
    v_cndmask_b32 v130, 0, v254, vcc
    v_add_f32 v77, v77, v130
    buffer_load_dwordx4 v133, s[48:51], s4 offen lds
    s_waitcnt vmcnt(7)
    ds_read_b64_tr_b16 a[20:21], v126 offset:3072
    ds_read_b64_tr_b16 a[22:23], v126 offset:3840
    ds_read_b64_tr_b16 a[44:45], v126 offset:3104
    ds_read_b64_tr_b16 a[46:47], v126 offset:3872
    ds_read_b64_tr_b16 a[68:69], v126 offset:3136
    ds_read_b64_tr_b16 a[70:71], v126 offset:3904
    v_lshrrev_b32 v136, 2, v136
    v_and_b32 v142, s5, v142
    v_and_b32 v136, s6, v136
    v_lshl_or_b32 v142, v142, 1, v136
    v_cmp_ne_u32 vcc, v142, v170
    v_lshl_add_u32 v130, v119, 2, 33
    v_mul_u32_u24 v136, 37, v130
    buffer_load_dwordx4 v135, s[48:51], s4 offen offset:1024 lds
    v_cndmask_b32 v127, 0, v254, vcc
    v_add_f32 v54, v54, v127
    v_cmp_ne_u32 vcc, v142, v255
    v_lshrrev_b32 v136, 8, v136
    v_mul_u32_u24 v127, 7, v136
    v_cndmask_b32 v129, 0, v254, vcc
    v_add_f32 v66, v66, v129
    v_cmp_ne_u32 vcc, v142, v171
    v_sub_u32 v127, v130, v127
    v_lshrrev_b32 v136, 2, v136
    v_cndmask_b32 v129, 0, v254, vcc
    v_add_f32 v78, v78, v129
    v_lshrrev_b32 v127, 2, v127
    v_and_b32 v136, s5, v136
    buffer_load_dwordx4 v137, s[48:51], s4 offen offset:2048 lds
    s_add_u32 m0, s69, 3072
    s_add_u32 s4, s45, 111360
    s_waitcnt lgkmcnt(0)
    v_and_b32 v127, s6, v127
    v_lshl_or_b32 v136, v136, 1, v127
    v_cmp_ne_u32 vcc, v136, v170
    v_lshl_add_u32 v130, v119, 2, 34
    v_mul_u32_u24 v129, 37, v130
    v_cndmask_b32 v127, 0, v254, vcc
    v_add_f32 v55, v55, v127
    v_cmp_ne_u32 vcc, v136, v255
    v_lshrrev_b32 v129, 8, v129
    v_mul_u32_u24 v142, 7, v129
    v_cndmask_b32 v127, 0, v254, vcc
    buffer_load_dwordx4 v133, s[48:51], s4 offen lds
    s_waitcnt vmcnt(7)
    ds_read_b64_tr_b16 a[144:145], v128 offset:0
    ds_read_b64_tr_b16 a[146:147], v128 offset:768
    ds_read_b64_tr_b16 a[168:169], v128 offset:32
    ds_read_b64_tr_b16 a[170:171], v128 offset:800
    ds_read_b64_tr_b16 a[192:193], v128 offset:64
    ds_read_b64_tr_b16 a[194:195], v128 offset:832
    v_add_f32 v67, v67, v127
    v_cmp_ne_u32 vcc, v136, v171
    v_sub_u32 v142, v130, v142
    v_lshrrev_b32 v129, 2, v129
    v_cndmask_b32 v127, 0, v254, vcc
    v_add_f32 v79, v79, v127
    v_lshrrev_b32 v142, 2, v142
    buffer_load_dwordx4 v135, s[48:51], s4 offen offset:1024 lds
    v_and_b32 v129, s5, v129
    v_and_b32 v142, s6, v142
    v_lshl_or_b32 v129, v129, 1, v142
    v_cmp_ne_u32 vcc, v129, v170
    v_lshl_add_u32 v130, v119, 2, 35
    v_mul_u32_u24 v119, 37, v130
    v_cndmask_b32 v127, 0, v254, vcc
    v_add_f32 v56, v56, v127
    v_cmp_ne_u32 vcc, v129, v255
    v_lshrrev_b32 v119, 8, v119
    v_mul_u32_u24 v136, 7, v119
    v_cndmask_b32 v127, 0, v254, vcc
    v_add_f32 v68, v68, v127
    v_cmp_ne_u32 vcc, v129, v171
    buffer_load_dwordx4 v137, s[48:51], s4 offen offset:2048 lds
    s_add_u32 m0, s68, 0
    s_add_u32 s4, s45, 148224
    s_waitcnt lgkmcnt(0)
    v_cndmask_b32 v142, 0, v254, vcc
    v_add_f32 v80, v80, v142
    v_sub_u32 v136, v130, v136
    v_lshrrev_b32 v119, 2, v119
    v_lshrrev_b32 v136, 2, v136
    v_and_b32 v119, s5, v119
    v_and_b32 v136, s6, v136
    v_lshl_or_b32 v119, v119, 1, v136
    v_cmp_ne_u32 vcc, v119, v170
    v_cndmask_b32 v22, v162, v22, s[88:89]
    v_cndmask_b32 v24, v162, v24, s[88:89]
    buffer_load_dwordx4 v133, s[48:51], s4 offen lds
    s_waitcnt vmcnt(7)
    ds_read_b64_tr_b16 a[148:149], v128 offset:3072
    ds_read_b64_tr_b16 a[150:151], v128 offset:3840
    ds_read_b64_tr_b16 a[172:173], v128 offset:3104
    ds_read_b64_tr_b16 a[174:175], v128 offset:3872
    ds_read_b64_tr_b16 a[196:197], v128 offset:3136
    ds_read_b64_tr_b16 a[198:199], v128 offset:3904
    v_cndmask_b32 v130, 0, v254, vcc
    v_add_f32 v57, v57, v130
    v_cmp_ne_u32 vcc, v119, v255
    v_cndmask_b32 v26, v162, v26, s[88:89]
    v_add3_u32 v121, v121, 64, s69
    v_cndmask_b32 v130, 0, v254, vcc
    v_add_f32 v69, v69, v130
    buffer_load_dwordx4 v135, s[48:51], s4 offen offset:1024 lds
    v_cmp_ne_u32 vcc, v119, v171
    v_mov_b32 v122, 0
    v_mov_b32 v123, 0
    v_cndmask_b32 v119, 0, v254, vcc
    v_add_f32 v81, v81, v119
    ds_read_b128 v[198:201], v164 offset:0
    ds_read_b128 v[114:117], v163 offset:0
    ds_read_b128 v[182:185], v164 offset:128
    ds_read_b128 v[138:141], v163 offset:128
    ds_read_b128 v[170:173], v164 offset:256
    buffer_load_dwordx4 v137, s[48:51], s4 offen offset:2048 lds
    s_add_u32 m0, s68, 3072
    ds_read_b128 v[174:177], v163 offset:256
    s_add_u32 s4, s45, 185088
    s_waitcnt lgkmcnt(6)
    v_mov_b32 v124, 0
    v_mov_b32 v125, 0
    s_sub_u32 s45, s17, 1
    ds_write_b128 v167, v[122:125] offset:16
    s_waitcnt vmcnt(6)
    buffer_load_dwordx4 v133, s[48:51], s4 offen lds
    s_waitcnt lgkmcnt(4)
    v_mfma_f32_16x16x32_bf16 v[146:149], a[72:75], v[198:201], 0
    v_mfma_f32_16x16x32_bf16 v[146:149], a[76:79], v[114:117], v[146:149]
    s_waitcnt lgkmcnt(3)
    ds_read_b64_tr_b16 a[152:153], v126 offset:0
    ds_read_b64_tr_b16 a[154:155], v126 offset:768
    v_mfma_f32_16x16x32_bf16 v[146:149], a[80:83], v[182:185], v[146:149]
    s_waitcnt lgkmcnt(4)
    ds_read_b64_tr_b16 a[176:177], v126 offset:32
    ds_read_b64_tr_b16 a[178:179], v126 offset:800
    v_mfma_f32_16x16x32_bf16 v[146:149], a[84:87], v[138:141], v[146:149]
    s_waitcnt lgkmcnt(5)
    ds_read_b64_tr_b16 a[200:201], v126 offset:64
    ds_read_b64_tr_b16 a[202:203], v126 offset:832
    v_mfma_f32_16x16x32_bf16 v[146:149], a[88:91], v[170:173], v[146:149]
    buffer_load_dwordx4 v135, s[48:51], s4 offen offset:1024 lds
    v_mfma_f32_16x16x32_bf16 v[146:149], a[92:95], v[174:177], v[146:149]
    ds_write_b64 v167, v[122:123] offset:56
    v_mfma_f32_16x16x32_bf16 v[154:157], a[96:99], v[198:201], 0
    v_mfma_f32_16x16x32_bf16 v[154:157], a[100:103], v[114:117], v[154:157]
    ds_write_b64 v167, v[122:123] offset:64
    v_mfma_f32_16x16x32_bf16 v[154:157], a[104:107], v[182:185], v[154:157]
    s_waitcnt lgkmcnt(6)
    buffer_load_dwordx4 v137, s[48:51], s4 offen offset:2048 lds
    v_mfma_f32_16x16x32_bf16 v[154:157], a[108:111], v[138:141], v[154:157]
    s_add_u32 m0, s28, 8192
    ds_read_b128 v[222:225], v164 offset:6144
    v_fma_f32 v119, v146, v146, s32
    v_mfma_f32_16x16x32_bf16 v[154:157], a[112:115], v[170:173], v[154:157]
    s_add_u32 s4, 0, 12288
    ds_read_b128 v[226:229], v163 offset:6144
    v_fmac_f32 v119, v147, v147
    v_mfma_f32_16x16x32_bf16 v[154:157], a[116:119], v[174:177], v[154:157]
    s_waitcnt lgkmcnt(4)
    ds_read_b128 v[242:245], v164 offset:6272
    s_waitcnt vmcnt(6)
    v_mfma_f32_16x16x32_bf16 v[178:181], a[120:123], v[198:201], 0
    ds_read_b64_tr_b16 a[156:157], v126 offset:3072
    ds_read_b64_tr_b16 a[158:159], v126 offset:3840
    v_mfma_f32_16x16x32_bf16 v[178:181], a[124:127], v[114:117], v[178:181]
    buffer_load_dwordx4 v12, s[8:11], s25 offen nt lds
    v_mfma_f32_16x16x32_bf16 v[178:181], a[128:131], v[182:185], v[178:181]
    s_add_u32 m0, s28, 12288
    ds_read_b64_tr_b16 a[180:181], v126 offset:3104
    ds_read_b64_tr_b16 a[182:183], v126 offset:3872
    v_mfma_f32_16x16x32_bf16 v[178:181], a[132:135], v[138:141], v[178:181]
    ds_read_b64_tr_b16 a[204:205], v126 offset:3136
    ds_read_b64_tr_b16 a[206:207], v126 offset:3904
    v_mfma_f32_16x16x32_bf16 v[178:181], a[136:139], v[170:173], v[178:181]
    ds_read_b128 v[190:193], v163 offset:6272
    ds_read_b128 v[218:221], v164 offset:6400
    v_mfma_f32_16x16x32_bf16 v[178:181], a[140:143], v[174:177], v[178:181]
    s_waitcnt lgkmcnt(10)
    ds_read_b128 v[206:209], v163 offset:6400
    v_fmac_f32 v119, v148, v148
    v_mfma_f32_16x16x32_bf16 v[150:153], a[72:75], v[222:225], 0
    s_waitcnt lgkmcnt(10)
    buffer_load_dwordx4 v13, s[8:11], s25 offen nt lds
    v_mfma_f32_16x16x32_bf16 v[150:153], a[76:79], v[226:229], v[150:153]
    s_waitcnt lgkmcnt(9)
    ds_write_b128 v159, v[122:125] offset:16
    v_mfma_f32_16x16x32_bf16 v[150:153], a[80:83], v[242:245], v[150:153]
    s_add_u32 m0, s29, 0
    v_fmac_f32 v119, v149, v149
    v_fmac_f32 v119, v154, v154
    v_mfma_f32_16x16x32_bf16 v[186:189], a[96:99], v[222:225], 0
    s_waitcnt lgkmcnt(6)
    v_fmac_f32 v119, v155, v155
    v_fmac_f32 v119, v156, v156
    v_mfma_f32_16x16x32_bf16 v[186:189], a[100:103], v[226:229], v[186:189]
    s_waitcnt lgkmcnt(4)
    buffer_load_dwordx4 v14, s[8:11], s25 offen nt lds
    v_mfma_f32_16x16x32_bf16 v[186:189], a[104:107], v[242:245], v[186:189]
    s_waitcnt lgkmcnt(2)
    ds_write_b64 v159, v[122:123] offset:56
    v_mfma_f32_16x16x32_bf16 v[150:153], a[84:87], v[190:193], v[150:153]
    s_add_u32 m0, s69, 0
    s_waitcnt vmcnt(6)
    v_fmac_f32 v119, v157, v157
    v_mfma_f32_16x16x32_bf16 v[150:153], a[88:91], v[218:221], v[150:153]
    s_waitcnt lgkmcnt(2)
    ds_read_b64_tr_b16 a[160:161], v128 offset:0
    ds_read_b64_tr_b16 a[162:163], v128 offset:768
    v_mfma_f32_16x16x32_bf16 v[150:153], a[92:95], v[206:209], v[150:153]
    s_cmp_lt_u32 1, s17
    ds_read_b64_tr_b16 a[184:185], v128 offset:32
    buffer_load_dwordx4 v143, s[52:55], 0 offen lds
    v_mfma_f32_16x16x32_bf16 v[186:189], a[108:111], v[190:193], v[186:189]
    s_cselect_b32 s10, s36, 0
    ds_read_b64_tr_b16 a[186:187], v128 offset:800
    ds_read_b64_tr_b16 a[208:209], v128 offset:64
    v_mfma_f32_16x16x32_bf16 v[186:189], a[112:115], v[218:221], v[186:189]
    s_mov_b32 s25, s24
    ds_read_b64_tr_b16 a[210:211], v128 offset:832
    v_fmac_f32 v119, v178, v178
    v_mfma_f32_16x16x32_bf16 v[186:189], a[116:119], v[206:209], v[186:189]
    ds_write_b64 v159, v[122:123] offset:64
    v_mfma_f32_16x16x32_bf16 v[194:197], a[120:123], v[222:225], 0
    v_fmac_f32 v119, v179, v179
    v_fmac_f32 v119, v180, v180
    v_mfma_f32_16x16x32_bf16 v[194:197], a[124:127], v[226:229], v[194:197]
    buffer_load_dwordx4 v132, s[52:55], 0 offen offset:1024 lds
    v_fmac_f32 v119, v181, v181
    v_mfma_f32_16x16x32_bf16 v[194:197], a[128:131], v[242:245], v[194:197]
    s_waitcnt lgkmcnt(6)
    v_fma_f32 v142, v150, v150, s32
    v_fmac_f32 v142, v151, v151
    v_mfma_f32_16x16x32_bf16 v[194:197], a[132:135], v[190:193], v[194:197]
    s_waitcnt lgkmcnt(4)
    v_fmac_f32 v142, v152, v152
    v_fmac_f32 v142, v153, v153
    v_mfma_f32_16x16x32_bf16 v[194:197], a[136:139], v[218:221], v[194:197]
    s_waitcnt lgkmcnt(3)
    v_fmac_f32 v142, v186, v186
    v_fmac_f32 v142, v187, v187
    v_mfma_f32_16x16x32_bf16 v[194:197], a[140:143], v[206:209], v[194:197]
    s_waitcnt lgkmcnt(1)
    v_fmac_f32 v142, v188, v188
    v_fmac_f32 v142, v189, v189
    v_mfma_f32_16x16x32_bf16 v[202:205], a[0:3], v[198:201], 0
    buffer_load_dwordx4 v118, s[52:55], 0 offen offset:2048 lds
    v_xor_b32 v254, 65536, v2
    v_mfma_f32_16x16x32_bf16 v[202:205], a[4:7], v[114:117], v[202:205]
    s_add_u32 m0, s69, 3072
    v_fmac_f32 v142, v194, v194
    v_fmac_f32 v142, v195, v195
    v_mfma_f32_16x16x32_bf16 v[202:205], a[8:11], v[182:185], v[202:205]
    v_fmac_f32 v142, v196, v196
    s_waitcnt vmcnt(6)
    v_mfma_f32_16x16x32_bf16 v[202:205], a[12:15], v[138:141], v[202:205]
    ds_read_b64_tr_b16 a[164:165], v128 offset:3072
    ds_read_b64_tr_b16 a[166:167], v128 offset:3840
    v_mfma_f32_16x16x32_bf16 v[202:205], a[16:19], v[170:173], v[202:205]
    ds_read_b64_tr_b16 a[188:189], v128 offset:3104
    ds_read_b64_tr_b16 a[190:191], v128 offset:3872
    v_mfma_f32_16x16x32_bf16 v[202:205], a[20:23], v[174:177], v[202:205]
    buffer_load_dwordx4 v143, s[52:55], s4 offen lds
    v_mfma_f32_16x16x32_bf16 v[230:233], a[24:27], v[198:201], 0
    ds_read_b64_tr_b16 a[212:213], v128 offset:3136
    ds_read_b64_tr_b16 a[214:215], v128 offset:3904
    v_mfma_f32_16x16x32_bf16 v[230:233], a[28:31], v[114:117], v[230:233]
    v_fmac_f32 v142, v197, v197
    v_lshrrev_b32 v130, 2, v254
    v_mfma_f32_16x16x32_bf16 v[230:233], a[32:35], v[182:185], v[230:233]
    v_fma_f32 v255, v202, v202, s32
    v_fmac_f32 v255, v203, v203
    v_mfma_f32_16x16x32_bf16 v[230:233], a[36:39], v[138:141], v[230:233]
    v_fmac_f32 v255, v204, v204
    v_fmac_f32 v255, v205, v205
    v_mfma_f32_16x16x32_bf16 v[230:233], a[40:43], v[170:173], v[230:233]
    buffer_load_dwordx4 v132, s[52:55], s4 offen offset:1024 lds
    v_mfma_f32_16x16x32_bf16 v[230:233], a[44:47], v[174:177], v[230:233]
    s_waitcnt lgkmcnt(4)
    v_lshrrev_b32 v133, 8, v254
    v_add_u32 v254, 157184, v254
    v_mfma_f32_16x16x32_bf16 v[214:217], a[48:51], v[198:201], 0
    s_waitcnt lgkmcnt(2)
    v_lshl_add_u32 v135, s16, 2, v254
    v_add_u32 v130, 162048, v130
    v_mfma_f32_16x16x32_bf16 v[214:217], a[52:55], v[114:117], v[214:217]
    v_fmac_f32 v255, v230, v230
    v_fmac_f32 v255, v231, v231
    v_mfma_f32_16x16x32_bf16 v[214:217], a[56:59], v[182:185], v[214:217]
    s_waitcnt lgkmcnt(0)
    v_fmac_f32 v255, v232, v232
    v_fmac_f32 v255, v233, v233
    v_mfma_f32_16x16x32_bf16 v[214:217], a[60:63], v[138:141], v[214:217]
    buffer_load_dwordx4 v118, s[52:55], s4 offen offset:2048 lds
    v_mfma_f32_16x16x32_bf16 v[214:217], a[64:67], v[170:173], v[214:217]
    s_add_u32 m0, s68, 0
    v_lshlrev_b32 v133, 4, v133
    v_add_u32 v133, 162048, v133
    v_mfma_f32_16x16x32_bf16 v[214:217], a[68:71], v[174:177], v[214:217]
    s_add_u32 s4, 0, 24576
    v_or_b32 v234, v32, v33
    v_and_b32 v234, 0xffff, v234
    v_mfma_f32_16x16x32_bf16 v[138:141], a[0:3], v[222:225], 0
    v_lshl_or_b32 v234, v234, 16, v234
    v_or_b32 v235, v32, v33
    v_mfma_f32_16x16x32_bf16 v[138:141], a[4:7], v[226:229], v[138:141]
    v_and_b32 v235, 0xffff, v235
    v_fmac_f32 v255, v214, v214
    v_mfma_f32_16x16x32_bf16 v[138:141], a[8:11], v[242:245], v[138:141]
    buffer_load_dwordx4 v143, s[52:55], s4 offen lds
    v_mfma_f32_16x16x32_bf16 v[138:141], a[12:15], v[190:193], v[138:141]
    v_fmac_f32 v255, v215, v215
    v_fmac_f32 v255, v216, v216
    v_mfma_f32_16x16x32_bf16 v[138:141], a[16:19], v[218:221], v[138:141]
    v_fmac_f32 v255, v217, v217
    v_cvt_pk_bf16_f32 v36, v255, v119
    v_mfma_f32_16x16x32_bf16 v[138:141], a[20:23], v[206:209], v[138:141]
    v_lshl_or_b32 v235, v235, 16, v235
    v_or_b32 v236, v32, v33
    v_mfma_f32_16x16x32_bf16 v[114:117], v[32:35], v[36:39], 0
    v_lshrrev_b32 v236, 16, v236
    v_lshl_or_b32 v236, v236, 16, v236
    v_mfma_f32_16x16x32_bf16 v[238:241], a[24:27], v[222:225], 0
    v_or_b32 v237, v32, v33
    v_lshrrev_b32 v237, 16, v237
    v_mfma_f32_16x16x32_bf16 v[238:241], a[28:31], v[226:229], v[238:241]
    v_lshl_or_b32 v237, v237, 16, v237
    v_fma_f32 v119, v138, v138, s32
    v_mfma_f32_16x16x32_bf16 v[238:241], a[32:35], v[242:245], v[238:241]
    v_rsq_f32 v115, v115
    v_mfma_f32_16x16x32_bf16 v[238:241], a[36:39], v[190:193], v[238:241]
    ds_read_b128 v[182:185], v0 offset:20480
    v_mul_f32 v146, v115, v146
    v_mfma_f32_16x16x32_bf16 v[238:241], a[40:43], v[218:221], v[238:241]
    ds_read_b128 v[198:201], v1 offset:20480
    v_mul_f32 v147, v115, v147
    v_mfma_f32_16x16x32_bf16 v[238:241], a[44:47], v[206:209], v[238:241]
    ds_read_b128 v[210:213], v0 offset:20608
    v_cvt_pk_f16_f32 v126, v146, v147
    v_mfma_f32_16x16x32_bf16 v[246:249], a[48:51], v[222:225], 0
    ds_read_b128 v[222:225], v1 offset:20608
    v_mul_f32 v148, v115, v148
    v_mfma_f32_16x16x32_bf16 v[246:249], a[52:55], v[226:229], v[246:249]
    ds_read_b128 v[226:229], v0 offset:20736
    v_mul_f32 v149, v115, v149
    v_mfma_f32_16x16x32_bf16 v[246:249], a[56:59], v[242:245], v[246:249]
    ds_read_b128 v[242:245], v1 offset:20736
    v_cvt_pk_f16_f32 v127, v148, v149
    v_mfma_f32_16x16x32_bf16 v[246:249], a[60:63], v[190:193], v[246:249]
    v_rsq_f32 v114, v114
    v_mfma_f32_16x16x32_bf16 v[246:249], a[64:67], v[218:221], v[246:249]
    v_mul_f32 v114, s31, v114
    v_mul_f32 v154, v115, v154
    v_mfma_f32_16x16x32_bf16 v[246:249], a[68:71], v[206:209], v[246:249]
    s_waitcnt lgkmcnt(5)
    v_mul_f32 v155, v115, v155
    v_cvt_pk_f16_f32 v128, v154, v155
    v_mfma_f32_16x16x32_bf16 v[122:125], a[96:99], v[182:185], 0
    s_waitcnt lgkmcnt(4)
    v_mul_f32 v156, v115, v156
    v_mul_f32 v157, v115, v157
    v_mfma_f32_16x16x32_bf16 v[122:125], a[100:103], v[198:201], v[122:125]
    s_waitcnt lgkmcnt(3)
    v_cvt_pk_f16_f32 v129, v156, v157
    v_mul_f32 v178, v115, v178
    v_mfma_f32_16x16x32_bf16 v[122:125], a[104:107], v[210:213], v[122:125]
    s_waitcnt lgkmcnt(2)
    ds_write_b128 v167, v[126:129]
    v_mfma_f32_16x16x32_bf16 v[122:125], a[108:111], v[222:225], v[122:125]
    s_waitcnt lgkmcnt(1)
    v_mul_f32 v179, v115, v179
    v_cvt_pk_f16_f32 v172, v178, v179
    v_mfma_f32_16x16x32_bf16 v[122:125], a[112:115], v[226:229], v[122:125]
    v_mul_f32 v180, v115, v180
    v_mul_f32 v181, v115, v181
    v_mfma_f32_16x16x32_bf16 v[122:125], a[116:119], v[242:245], v[122:125]
    v_cvt_pk_f16_f32 v173, v180, v181
    v_mul_f32 v202, v114, v202
    v_mfma_f32_16x16x32_bf16 v[126:129], a[120:123], v[182:185], 0
    ds_write_b64 v167, v[172:173] offset:48
    v_mfma_f32_16x16x32_bf16 v[126:129], a[124:127], v[198:201], v[126:129]
    v_mul_f32 v203, v114, v203
    v_cvt_pk_f16_f32 v170, v202, v203
    v_mfma_f32_16x16x32_bf16 v[126:129], a[128:131], v[210:213], v[126:129]
    v_mul_f32 v204, v114, v204
    v_mul_f32 v205, v114, v205
    v_mfma_f32_16x16x32_bf16 v[126:129], a[132:135], v[222:225], v[126:129]
    v_cvt_pk_f16_f32 v171, v204, v205
    v_mul_f32 v230, v114, v230
    v_mfma_f32_16x16x32_bf16 v[126:129], a[136:139], v[226:229], v[126:129]
    v_mul_f32 v231, v114, v231
    v_cvt_pk_f16_f32 v172, v230, v231
    v_mfma_f32_16x16x32_bf16 v[126:129], a[140:143], v[242:245], v[126:129]
    v_mul_f32 v232, v114, v232
    v_mul_f32 v233, v114, v233
    v_mfma_f32_16x16x32_bf16 v[174:177], a[24:27], v[182:185], 0
    v_cvt_pk_f16_f32 v173, v232, v233
    v_mul_f32 v214, v114, v214
    v_mfma_f32_16x16x32_bf16 v[174:177], a[28:31], v[198:201], v[174:177]
    ds_write_b128 v167, v[170:173] offset:32
    v_mfma_f32_16x16x32_bf16 v[174:177], a[32:35], v[210:213], v[174:177]
    v_mul_f32 v215, v114, v215
    v_cvt_pk_f16_f32 v170, v214, v215
    v_mfma_f32_16x16x32_bf16 v[174:177], a[36:39], v[222:225], v[174:177]
    v_mul_f32 v216, v114, v216
    v_mul_f32 v217, v114, v217
    v_mfma_f32_16x16x32_bf16 v[174:177], a[40:43], v[226:229], v[174:177]
    v_cvt_pk_f16_f32 v171, v216, v217
    v_mul_f32 v146, v202, v146
    v_mfma_f32_16x16x32_bf16 v[174:177], a[44:47], v[242:245], v[174:177]
    ds_write_b64 v167, v[170:171] offset:72
    v_mfma_f32_16x16x32_bf16 v[114:117], a[72:75], v[182:185], 0
    v_fmac_f32 v146, v203, v147
    v_fmac_f32 v146, v204, v148
    v_mfma_f32_16x16x32_bf16 v[114:117], a[76:79], v[198:201], v[114:117]
    v_fmac_f32 v146, v205, v149
    v_fmac_f32 v146, v230, v154
    v_mfma_f32_16x16x32_bf16 v[114:117], a[80:83], v[210:213], v[114:117]
    v_fmac_f32 v146, v231, v155
    v_fmac_f32 v146, v232, v156
    v_mfma_f32_16x16x32_bf16 v[114:117], a[84:87], v[222:225], v[114:117]
    v_fmac_f32 v146, v233, v157
    v_fmac_f32 v146, v214, v178
    v_mfma_f32_16x16x32_bf16 v[114:117], a[88:91], v[226:229], v[114:117]
    v_fmac_f32 v146, v215, v179
    v_fmac_f32 v146, v216, v180
    v_mfma_f32_16x16x32_bf16 v[114:117], a[92:95], v[242:245], v[114:117]
    v_fmac_f32 v146, v217, v181
    v_mov_b32 v167, v146
    v_mfma_f32_16x16x32_bf16 v[218:221], a[48:51], v[182:185], 0
    v_fmac_f32 v119, v139, v139
    v_fmac_f32 v119, v140, v140
    v_mfma_f32_16x16x32_bf16 v[218:221], a[52:55], v[198:201], v[218:221]
    v_permlane32_swap_b32 v146, v167
    v_mfma_f32_16x16x32_bf16 v[218:221], a[56:59], v[210:213], v[218:221]
    v_add_f32 v146, v146, v167
    v_mov_b32 v167, v146
    v_mfma_f32_16x16x32_bf16 v[218:221], a[60:63], v[222:225], v[218:221]
    v_fmac_f32 v119, v141, v141
    v_fmac_f32 v119, v238, v238
    v_mfma_f32_16x16x32_bf16 v[218:221], a[64:67], v[226:229], v[218:221]
    v_permlane16_swap_b32 v146, v167
    v_mfma_f32_16x16x32_bf16 v[218:221], a[68:71], v[242:245], v[218:221]
    v_add_f32 v146, v146, v167
    v_add_f32 v146, s39, v146
    v_mfma_f32_16x16x32_bf16 v[170:173], v[182:185], a[144:147], 0
    v_mov_b32 v147, v162
    v_mov_b32 v148, v162
    v_mfma_f32_16x16x32_bf16 v[170:173], v[198:201], a[148:151], v[170:173]
    v_mov_b32 v149, v162
    v_cndmask_b32 v146, v162, v146, s[88:89]
    v_mfma_f32_16x16x32_bf16 v[170:173], v[210:213], a[152:155], v[170:173]
    ds_write_b128 v166, v[146:149] offset:192
    v_mfma_f32_16x16x32_bf16 v[170:173], v[222:225], a[156:159], v[170:173]
    v_fmac_f32 v119, v239, v239
    v_fmac_f32 v119, v240, v240
    v_mfma_f32_16x16x32_bf16 v[170:173], v[226:229], a[160:163], v[170:173]
    v_fmac_f32 v119, v241, v241
    v_fmac_f32 v119, v246, v246
    v_mfma_f32_16x16x32_bf16 v[170:173], v[242:245], a[164:167], v[170:173]
    v_fmac_f32 v119, v247, v247
    v_fmac_f32 v119, v248, v248
    v_mfma_f32_16x16x32_bf16 v[154:157], v[182:185], a[168:171], 0
    v_fmac_f32 v119, v249, v249
    v_cvt_pk_bf16_f32 v36, v119, v142
    v_mfma_f32_16x16x32_bf16 v[154:157], v[198:201], a[172:175], v[154:157]
    v_fma_f32 v119, v114, v114, s32
    v_fmac_f32 v119, v115, v115
    v_mfma_f32_16x16x32_bf16 v[146:149], v[32:35], v[36:39], 0
    v_fmac_f32 v119, v116, v116
    v_fmac_f32 v119, v117, v117
    v_mfma_f32_16x16x32_bf16 v[154:157], v[210:213], a[176:179], v[154:157]
    v_fmac_f32 v119, v122, v122
    v_fmac_f32 v119, v123, v123
    v_mfma_f32_16x16x32_bf16 v[154:157], v[222:225], a[180:183], v[154:157]
    ds_read_b128 v[202:205], v164 offset:0
    v_fmac_f32 v119, v124, v124
    v_mfma_f32_16x16x32_bf16 v[154:157], v[226:229], a[184:187], v[154:157]
    ds_read_b128 v[190:193], v163 offset:0
    v_fmac_f32 v119, v125, v125
    v_mfma_f32_16x16x32_bf16 v[154:157], v[242:245], a[188:191], v[154:157]
    ds_read_b128 v[178:181], v164 offset:128
    v_rsq_f32 v147, v147
    v_rsq_f32 v146, v146
    v_mul_f32 v150, v147, v150
    v_mul_f32 v146, s31, v146
    v_mul_f32 v151, v147, v151
    v_cvt_pk_f16_f32 v206, v150, v151
    v_mul_f32 v152, v147, v152
    v_mul_f32 v153, v147, v153
    v_cvt_pk_f16_f32 v207, v152, v153
    v_mul_f32 v186, v147, v186
    v_mul_f32 v187, v147, v187
    v_cvt_pk_f16_f32 v208, v186, v187
    v_mul_f32 v188, v147, v188
    v_mul_f32 v189, v147, v189
    v_cvt_pk_f16_f32 v209, v188, v189
    v_mul_f32 v194, v147, v194
    v_mul_f32 v195, v147, v195
    v_cvt_pk_f16_f32 v232, v194, v195
    v_mul_f32 v196, v147, v196
    v_mul_f32 v197, v147, v197
    v_cvt_pk_f16_f32 v233, v196, v197
    buffer_load_dwordx4 v132, s[52:55], s4 offen offset:1024 lds
    ds_write_b128 v159, v[206:209]
    v_mul_f32 v138, v146, v138
    v_mul_f32 v139, v146, v139
    v_cvt_pk_f16_f32 v206, v138, v139
    v_mul_f32 v140, v146, v140
    v_mul_f32 v141, v146, v141
    v_cvt_pk_f16_f32 v207, v140, v141
    v_mul_f32 v238, v146, v238
    v_mul_f32 v239, v146, v239
    v_cvt_pk_f16_f32 v208, v238, v239
    v_mul_f32 v240, v146, v240
    v_mul_f32 v241, v146, v241
    buffer_load_dwordx4 v118, s[52:55], s4 offen offset:2048 lds
    ds_write_b64 v159, v[232:233] offset:48
    s_add_u32 m0, s68, 3072
    s_add_u32 s4, 0, 36864
    v_cvt_pk_f16_f32 v209, v240, v241
    v_mul_f32 v246, v146, v246
    v_mul_f32 v247, v146, v247
    v_cvt_pk_f16_f32 v230, v246, v247
    v_mul_f32 v248, v146, v248
    v_mul_f32 v249, v146, v249
    v_cvt_pk_f16_f32 v231, v248, v249
    v_mul_f32 v138, v138, v150
    v_fmac_f32 v138, v139, v151
    v_fmac_f32 v138, v140, v152
    buffer_load_dwordx4 v143, s[52:55], s4 offen lds
    ds_write_b128 v159, v[206:209] offset:32
    v_mfma_f32_16x16x32_bf16 v[206:209], a[0:3], v[182:185], 0
    s_waitcnt lgkmcnt(2)
    v_fmac_f32 v138, v141, v153
    v_fmac_f32 v138, v238, v186
    v_mfma_f32_16x16x32_bf16 v[206:209], a[4:7], v[198:201], v[206:209]
    v_fmac_f32 v138, v239, v187
    v_fmac_f32 v138, v240, v188
    v_mfma_f32_16x16x32_bf16 v[206:209], a[8:11], v[210:213], v[206:209]
    ds_write_b64 v159, v[230:231] offset:72
    v_mfma_f32_16x16x32_bf16 v[206:209], a[12:15], v[222:225], v[206:209]
    buffer_load_dwordx4 v132, s[52:55], s4 offen offset:1024 lds
    v_mfma_f32_16x16x32_bf16 v[206:209], a[16:19], v[226:229], v[206:209]
    v_fmac_f32 v138, v241, v189
    v_fmac_f32 v138, v246, v194
    v_mfma_f32_16x16x32_bf16 v[206:209], a[20:23], v[242:245], v[206:209]
    v_fmac_f32 v138, v247, v195
    v_fmac_f32 v138, v248, v196
    v_mfma_f32_16x16x32_bf16 v[146:149], v[182:185], a[192:195], 0
    ds_read_b128 v[150:153], v163 offset:128
    v_fmac_f32 v138, v249, v197
    v_mfma_f32_16x16x32_bf16 v[146:149], v[198:201], a[196:199], v[146:149]
    ds_read_b128 v[182:185], v164 offset:256
    v_mov_b32 v142, v138
    v_mfma_f32_16x16x32_bf16 v[146:149], v[210:213], a[200:203], v[146:149]
    buffer_load_dwordx4 v118, s[52:55], s4 offen offset:2048 lds
    v_mfma_f32_16x16x32_bf16 v[146:149], v[222:225], a[204:207], v[146:149]
    s_add_u32 m0, s69, 0
    ds_read_b128 v[222:225], v163 offset:256
    v_fmac_f32 v119, v126, v126
    v_mfma_f32_16x16x32_bf16 v[146:149], v[226:229], a[208:211], v[146:149]
    s_add_u32 s4, 0, 49152
    v_permlane32_swap_b32 v138, v142
    s_waitcnt vmcnt(9)
    v_mfma_f32_16x16x32_bf16 v[146:149], v[242:245], a[212:215], v[146:149]
    ds_read_b64 a[216:217], v131 offset:0
    ds_read_b64 a[218:219], v131 offset:1536
    v_mfma_f32_16x16x32_bf16 v[198:201], v[202:205], a[144:147], 0
    ds_read_b64 a[240:241], v131 offset:8
    ds_read_b64 a[242:243], v131 offset:1544
    v_mfma_f32_16x16x32_bf16 v[198:201], v[190:193], a[148:151], v[198:201]
    s_waitcnt lgkmcnt(6)
    ds_read_b64 v[90:91], v121 offset:0
    ds_read_b64 v[92:93], v121 offset:1536
    v_mfma_f32_16x16x32_bf16 v[198:201], v[178:181], a[152:155], v[198:201]
    s_waitcnt lgkmcnt(7)
    v_add_f32 v138, v138, v142
    v_mov_b32 v142, v138
    v_mfma_f32_16x16x32_bf16 v[198:201], v[150:153], a[156:159], v[198:201]
    v_fmac_f32 v119, v127, v127
    v_fmac_f32 v119, v128, v128
    v_mfma_f32_16x16x32_bf16 v[198:201], v[182:185], a[160:163], v[198:201]
    s_waitcnt lgkmcnt(6)
    v_permlane16_swap_b32 v138, v142
    v_mfma_f32_16x16x32_bf16 v[198:201], v[222:225], a[164:167], v[198:201]
    v_add_f32 v138, v138, v142
    v_add_f32 v138, s39, v138
    v_mfma_f32_16x16x32_bf16 v[242:245], v[202:205], a[168:171], 0
    v_mov_b32 v139, v162
    v_mov_b32 v140, v162
    v_mfma_f32_16x16x32_bf16 v[242:245], v[190:193], a[172:175], v[242:245]
    s_waitcnt lgkmcnt(4)
    v_mov_b32 v141, v162
    v_cndmask_b32 v138, v162, v138, s[88:89]
    v_mfma_f32_16x16x32_bf16 v[226:229], v[234:237], a[216:219], 0
    s_waitcnt lgkmcnt(2)
    ds_write_b128 v169, v[138:141] offset:192
    v_mfma_f32_16x16x32_bf16 v[226:229], v[234:237], a[240:243], v[226:229]
    s_waitcnt lgkmcnt(1)
    buffer_load_dwordx4 v143, s[52:55], s4 offen lds
    v_mfma_f32_16x16x32_bf16 v[226:229], v[234:237], v[90:93], v[226:229]
    v_fmac_f32 v119, v129, v129
    s_waitcnt vmcnt(7)
    v_mfma_f32_16x16x32_bf16 v[242:245], v[178:181], a[176:179], v[242:245]
    ds_read_b64 a[232:233], v131 offset:3072
    ds_read_b64 a[220:221], v131 offset:4608
    v_mfma_f32_16x16x32_bf16 v[242:245], v[150:153], a[180:183], v[242:245]
    ds_read_b64 v[82:83], v131 offset:3080
    ds_read_b64 a[244:245], v131 offset:4616
    v_mfma_f32_16x16x32_bf16 v[242:245], v[182:185], a[184:187], v[242:245]
    ds_read_b64 v[106:107], v121 offset:3072
    ds_read_b64 v[94:95], v121 offset:4608
    v_mfma_f32_16x16x32_bf16 v[242:245], v[222:225], a[188:191], v[242:245]
    buffer_load_dwordx4 v132, s[52:55], s4 offen offset:1024 lds
    v_mfma_f32_16x16x32_bf16 v[186:189], v[202:205], a[192:195], 0
    ds_read_b128 v[158:161], v164 offset:6144
    ds_read_b128 v[138:141], v163 offset:6144
    v_mfma_f32_16x16x32_bf16 v[186:189], v[190:193], a[196:199], v[186:189]
    ds_read_b128 v[194:197], v164 offset:6272
    ds_read_b128 v[210:213], v163 offset:6272
    v_mfma_f32_16x16x32_bf16 v[186:189], v[178:181], a[200:203], v[186:189]
    v_mov_b32 v255, v226
    v_mov_b32_dpp v255, v227 quad_perm:[0,1,2,3] row_mask:0x2 bank_mask:0xf
    v_mfma_f32_16x16x32_bf16 v[186:189], v[150:153], a[204:207], v[186:189]
    ds_read_b128 v[226:229], v164 offset:6400
    ds_read_b128 v[150:153], v163 offset:6400
    v_mfma_f32_16x16x32_bf16 v[186:189], v[182:185], a[208:211], v[186:189]
    s_waitcnt lgkmcnt(10)
    buffer_load_dwordx4 v118, s[52:55], s4 offen offset:2048 lds
    v_mfma_f32_16x16x32_bf16 v[186:189], v[222:225], a[212:215], v[186:189]
    s_add_u32 m0, s69, 3072
    s_add_u32 s4, 0, 61440
    s_waitcnt lgkmcnt(6)
    v_fma_f32 v142, v206, v206, s32
    v_fmac_f32 v142, v207, v207
    v_fmac_f32 v142, v208, v208
    v_fmac_f32 v142, v209, v209
    v_fmac_f32 v142, v174, v174
    v_fmac_f32 v142, v175, v175
    s_waitcnt lgkmcnt(5)
    v_mfma_f32_16x16x32_bf16 v[182:185], v[158:161], a[144:147], 0
    s_waitcnt lgkmcnt(4)
    s_waitcnt vmcnt(6)
    ds_read_b64 a[222:223], v134 offset:0
    v_mfma_f32_16x16x32_bf16 v[182:185], v[138:141], a[148:151], v[182:185]
    s_waitcnt lgkmcnt(3)
    buffer_load_dwordx4 v143, s[52:55], s4 offen lds
    v_mfma_f32_16x16x32_bf16 v[182:185], v[194:197], a[152:155], v[182:185]
    ds_read_b64 a[234:235], v134 offset:1536
    ds_read_b64 a[246:247], v134 offset:8
    v_mfma_f32_16x16x32_bf16 v[182:185], v[210:213], a[156:159], v[182:185]
    s_waitcnt lgkmcnt(3)
    ds_read_b64 v[84:85], v134 offset:1544
    ds_read_b64 v[96:97], v120 offset:0
    v_mfma_f32_16x16x32_bf16 v[182:185], v[226:229], a[160:163], v[182:185]
    ds_read_b64 v[108:109], v120 offset:1536
    v_fmac_f32 v142, v176, v176
    v_mfma_f32_16x16x32_bf16 v[182:185], v[150:153], a[164:167], v[182:185]
    v_fmac_f32 v142, v177, v177
    v_fmac_f32 v142, v218, v218
    v_mfma_f32_16x16x32_bf16 v[222:225], v[158:161], a[168:171], 0
    buffer_load_dwordx4 v132, s[52:55], s4 offen offset:1024 lds
    v_mfma_f32_16x16x32_bf16 v[222:225], v[138:141], a[172:175], v[222:225]
    v_fmac_f32 v142, v219, v219
    v_fmac_f32 v142, v220, v220
    v_mfma_f32_16x16x32_bf16 v[222:225], v[194:197], a[176:179], v[222:225]
    s_waitcnt lgkmcnt(5)
    v_fmac_f32 v142, v221, v221
    v_cvt_pk_bf16_f32 v36, v142, v119
    v_mfma_f32_16x16x32_bf16 v[178:181], v[234:237], a[220:223], 0
    v_cvt_pk_bf16_f32 v190, v170, v171
    v_cvt_pk_bf16_f32 v191, v172, v173
    v_mfma_f32_16x16x32_bf16 v[170:173], v[32:35], v[36:39], 0
    s_waitcnt lgkmcnt(3)
    v_cvt_pk_bf16_f32 v162, v154, v155
    v_cvt_pk_bf16_f32 v163, v156, v157
    v_mfma_f32_16x16x32_bf16 v[178:181], v[234:237], a[244:247], v[178:181]
    s_waitcnt lgkmcnt(1)
    buffer_load_dwordx4 v118, s[52:55], s4 offen offset:2048 lds
    v_mfma_f32_16x16x32_bf16 v[178:181], v[234:237], v[94:97], v[178:181]
    s_add_u32 m0, s28, 65536
    v_rsq_f32 v171, v171
    v_mfma_f32_16x16x32_bf16 v[154:157], v[234:237], a[232:235], 0
    s_waitcnt vmcnt(6)
    ds_read_b64 a[224:225], v134 offset:3072
    ds_read_b64 a[226:227], v134 offset:4608
    v_mfma_f32_16x16x32_bf16 v[154:157], v[234:237], v[82:85], v[154:157]
    s_waitcnt lgkmcnt(2)
    ds_read_b64 a[248:249], v134 offset:3080
    ds_read_b64 a[250:251], v134 offset:4616
    v_mfma_f32_16x16x32_bf16 v[154:157], v[234:237], v[106:109], v[154:157]
    ds_read_b64 v[98:99], v120 offset:3072
    ds_read_b64 v[100:101], v120 offset:4608
    v_mfma_f32_16x16x32_bf16 v[222:225], v[210:213], a[180:183], v[222:225]
    buffer_load_dwordx4 v10, s[8:11], s24 offen nt lds
    v_mfma_f32_16x16x32_bf16 v[222:225], v[226:229], a[184:187], v[222:225]
    s_add_u32 m0, s28, 69632
    v_mov_b32 v132, v179
    v_mul_f32 v114, v171, v114
    v_mfma_f32_16x16x32_bf16 v[222:225], v[150:153], a[188:191], v[222:225]
    v_mov_b32_dpp v255, v154 quad_perm:[0,1,2,3] row_mask:0x4 bank_mask:0xf
    v_mov_b32_dpp v255, v178 quad_perm:[0,1,2,3] row_mask:0x8 bank_mask:0xf
    v_mfma_f32_16x16x32_bf16 v[178:181], v[158:161], a[192:195], 0
    v_mov_b32_dpp v132, v155 quad_perm:[0,1,2,3] row_mask:0x2 bank_mask:0xf
    v_mul_f32 v115, v171, v115
    v_mfma_f32_16x16x32_bf16 v[178:181], v[138:141], a[196:199], v[178:181]
    v_rsq_f32 v170, v170
    v_mfma_f32_16x16x32_bf16 v[178:181], v[194:197], a[200:203], v[178:181]
    s_waitcnt lgkmcnt(4)
    buffer_load_dwordx4 v11, s[8:11], s24 offen nt lds
    v_mfma_f32_16x16x32_bf16 v[138:141], v[234:237], a[224:227], 0
    s_waitcnt lgkmcnt(2)
    v_mul_f32 v170, s31, v170
    v_cvt_pk_f16_f32 v114, v114, v115
    v_mfma_f32_16x16x32_bf16 v[138:141], v[234:237], a[248:251], v[138:141]
    s_waitcnt lgkmcnt(0)
    v_mul_f32 v116, v171, v116
    v_mul_f32 v117, v171, v117
    v_mfma_f32_16x16x32_bf16 v[138:141], v[234:237], v[98:101], v[138:141]
    s_add_u32 m0, s28, 73728
    v_cvt_pk_f16_f32 v115, v116, v117
    v_mul_f32 v122, v171, v122
    v_mfma_f32_16x16x32_bf16 v[178:181], v[210:213], a[204:207], v[178:181]
    v_mul_f32 v123, v171, v123
    v_cvt_pk_f16_f32 v116, v122, v123
    v_mfma_f32_16x16x32_bf16 v[178:181], v[226:229], a[208:211], v[178:181]
    buffer_load_dwordx4 v12, s[8:11], s24 offen nt lds
    v_mfma_f32_16x16x32_bf16 v[178:181], v[150:153], a[212:215], v[178:181]
    s_barrier
    ds_read_b128 v[154:157], v0 offset:26624
    ds_read_b128 v[158:161], v1 offset:26624
    s_waitcnt vmcnt(6)
    ds_read_b64 a[236:237], v131 offset:0
    ds_read_b64 a[228:229], v131 offset:1536
    ds_read_b64 v[86:87], v131 offset:8
    s_add_u32 m0, s28, 77824
    ds_read_b64 a[252:253], v131 offset:1544
    ds_read_b64 v[110:111], v121 offset:0
    ds_read_b64 v[102:103], v121 offset:1536
    buffer_load_dwordx4 v13, s[8:11], s24 offen nt lds
    ds_read_b128 v[226:229], v0 offset:26752
    ds_read_b128 v[150:153], v1 offset:26752
    s_add_u32 m0, s74, 0
    ds_read_b128 v[202:205], v0 offset:26880
    ds_read_b128 v[194:197], v1 offset:26880
    v_mov_b32_dpp v132, v138 quad_perm:[0,1,2,3] row_mask:0x4 bank_mask:0xf
    v_mov_b32_dpp v132, v139 quad_perm:[0,1,2,3] row_mask:0x8 bank_mask:0xf
    s_waitcnt lgkmcnt(11)
    v_mfma_f32_16x16x32_bf16 v[210:213], a[72:75], v[154:157], 0
    s_waitcnt lgkmcnt(10)
    ds_write_b32 v135, v255 offset:0
    v_mfma_f32_16x16x32_bf16 v[210:213], a[76:79], v[158:161], v[210:213]
    s_waitcnt lgkmcnt(8)
    buffer_load_dwordx4 v14, s[8:11], s24 offen nt lds
    v_mfma_f32_16x16x32_bf16 v[138:141], a[96:99], v[154:157], 0
    s_add_u32 s8, s40, s23
    ds_write_b32 v135, v132 offset:1024
    v_mfma_f32_16x16x32_bf16 v[138:141], a[100:103], v[158:161], v[138:141]
    s_addc_u32 s9, s41, 0
    v_mul_f32 v124, v171, v124
    v_mul_f32 v125, v171, v125
    v_mfma_f32_16x16x32_bf16 v[238:241], a[120:123], v[154:157], 0
    s_waitcnt lgkmcnt(4)
    v_cvt_pk_f16_f32 v117, v124, v125
    v_mul_f32 v126, v171, v126
    v_mfma_f32_16x16x32_bf16 v[210:213], a[80:83], v[226:229], v[210:213]
    s_sub_u32 s10, s36, s23
    v_mul_f32 v127, v171, v127
    v_cvt_pk_f16_f32 v124, v126, v127
    v_mfma_f32_16x16x32_bf16 v[210:213], a[84:87], v[150:153], v[210:213]
    s_waitcnt lgkmcnt(2)
    v_mul_f32 v128, v171, v128
    v_mul_f32 v129, v171, v129
    v_mfma_f32_16x16x32_bf16 v[210:213], a[88:91], v[202:205], v[210:213]
    s_cmp_lt_u32 s34, s17
    v_cvt_pk_f16_f32 v125, v128, v129
    v_mul_f32 v206, v170, v206
    s_waitcnt vmcnt(5)
    v_mfma_f32_16x16x32_bf16 v[210:213], a[92:95], v[194:197], v[210:213]
    s_cselect_b32 s10, s10, 0
    ds_read_b64 a[230:231], v131 offset:3072
    ds_read_b64 a[238:239], v131 offset:4608
    v_mfma_f32_16x16x32_bf16 v[138:141], a[104:107], v[226:229], v[138:141]
    s_add_u32 m0, s28, 0
    ds_read_b64 a[254:255], v131 offset:3080
    ds_read_b64 v[88:89], v131 offset:4616
    v_mfma_f32_16x16x32_bf16 v[138:141], a[108:111], v[150:153], v[138:141]
    s_mov_b32 s24, s23
    ds_read_b64 v[104:105], v121 offset:3072
    ds_read_b64 v[112:113], v121 offset:4608
    v_mfma_f32_16x16x32_bf16 v[138:141], a[112:115], v[202:205], v[138:141]
    s_add_u32 s23, s23, s21
    v_mul_f32 v207, v170, v207
    v_cvt_pk_f16_f32 v126, v206, v207
    v_mfma_f32_16x16x32_bf16 v[138:141], a[116:119], v[194:197], v[138:141]
    s_cmp_ge_u32 s19, 72
    v_mul_f32 v208, v170, v208
    v_mul_f32 v209, v170, v209
    v_mfma_f32_16x16x32_bf16 v[238:241], a[124:127], v[158:161], v[238:241]
    s_cselect_b32 s34, 72, 0
    v_cvt_pk_f16_f32 v127, v208, v209
    v_mul_f32 v174, v170, v174
    v_mfma_f32_16x16x32_bf16 v[238:241], a[128:131], v[226:229], v[238:241]
    s_cselect_b32 s35, s22, 0
    v_mul_f32 v175, v170, v175
    v_cvt_pk_f16_f32 v128, v174, v175
    v_mfma_f32_16x16x32_bf16 v[238:241], a[132:135], v[150:153], v[238:241]
    s_sub_u32 s19, s19, s34
    v_mul_f32 v176, v170, v176
    v_mul_f32 v177, v170, v177
    v_mfma_f32_16x16x32_bf16 v[238:241], a[136:139], v[202:205], v[238:241]
    s_waitcnt lgkmcnt(4)
    v_cvt_pk_f16_f32 v129, v176, v177
    v_mul_f32 v218, v170, v218
    v_mfma_f32_16x16x32_bf16 v[174:177], v[234:237], a[228:231], 0
    s_waitcnt lgkmcnt(2)
    v_mul_f32 v219, v170, v219
    v_cvt_pk_f16_f32 v122, v218, v219
    v_mfma_f32_16x16x32_bf16 v[174:177], v[234:237], a[252:255], v[174:177]
    s_waitcnt lgkmcnt(0)
    v_mul_f32 v220, v170, v220
    v_mul_f32 v221, v170, v221
    v_mfma_f32_16x16x32_bf16 v[174:177], v[234:237], v[102:105], v[174:177]
    s_add_u32 s23, s23, s35
    v_cvt_pk_f16_f32 v123, v220, v221
    v_cvt_pk_bf16_f32 v166, v146, v147
    v_mfma_f32_16x16x32_bf16 v[118:121], v[234:237], a[236:239], 0
    v_cvt_pk_bf16_f32 v167, v148, v149
    v_cvt_pk_bf16_f32 v198, v198, v198
    v_mfma_f32_16x16x32_bf16 v[118:121], v[234:237], v[86:89], v[118:121]
    v_cvt_pk_bf16_f32 v199, v199, v199
    v_cvt_pk_bf16_f32 v200, v200, v200
    v_mfma_f32_16x16x32_bf16 v[118:121], v[234:237], v[110:113], v[118:121]
    ds_write2_b32 v165, v198, v199 offset0:0 offset1:68
    v_mfma_f32_16x16x32_bf16 v[238:241], a[140:143], v[194:197], v[238:241]
    v_cvt_pk_bf16_f32 v201, v201, v201
    v_cvt_pk_bf16_f32 v242, v242, v242
    v_mfma_f32_16x16x32_bf16 v[146:149], a[0:3], v[154:157], 0
    ds_write2_b32 v165, v200, v201 offset0:136 offset1:204
    v_mfma_f32_16x16x32_bf16 v[146:149], a[4:7], v[158:161], v[146:149]
    v_cvt_pk_bf16_f32 v243, v243, v243
    v_mov_b32 v164, v118
    v_mfma_f32_16x16x32_bf16 v[146:149], a[8:11], v[226:229], v[146:149]
    ds_write2_b32 v165, v242, v243 offset0:16 offset1:84
    v_mfma_f32_16x16x32_bf16 v[146:149], a[12:15], v[150:153], v[146:149]
    v_mov_b32_dpp v164, v174 quad_perm:[0,1,2,3] row_mask:0x2 bank_mask:0xf
    v_mov_b32_dpp v164, v175 quad_perm:[0,1,2,3] row_mask:0x4 bank_mask:0xf
    v_mfma_f32_16x16x32_bf16 v[146:149], a[16:19], v[202:205], v[146:149]
    v_mov_b32_dpp v164, v119 quad_perm:[0,1,2,3] row_mask:0x8 bank_mask:0xf
    v_cvt_pk_bf16_f32 v244, v244, v244
    v_mfma_f32_16x16x32_bf16 v[146:149], a[20:23], v[194:197], v[146:149]
    ds_write_b32 v135, v164 offset:2048
    v_mfma_f32_16x16x32_bf16 v[118:121], a[24:27], v[154:157], 0
    v_cvt_pk_bf16_f32 v245, v245, v245
    v_cvt_pk_bf16_f32 v186, v186, v186
    v_mfma_f32_16x16x32_bf16 v[118:121], a[28:31], v[158:161], v[118:121]
    ds_write2_b32 v165, v244, v245 offset0:152 offset1:220
    v_mfma_f32_16x16x32_bf16 v[118:121], a[32:35], v[226:229], v[118:121]
    v_cvt_pk_bf16_f32 v187, v187, v187
    v_cvt_pk_bf16_f32 v188, v188, v188
    v_mfma_f32_16x16x32_bf16 v[118:121], a[36:39], v[150:153], v[118:121]
    ds_write2_b32 v165, v186, v187 offset0:32 offset1:100
    v_mfma_f32_16x16x32_bf16 v[118:121], a[40:43], v[202:205], v[118:121]
    v_cvt_pk_bf16_f32 v189, v189, v189
    v_cvt_pk_bf16_f32 v182, v182, v182
    v_mfma_f32_16x16x32_bf16 v[118:121], a[44:47], v[194:197], v[118:121]
    ds_write2_b32 v165, v188, v189 offset0:168 offset1:236
    v_mfma_f32_16x16x32_bf16 v[134:137], a[48:51], v[154:157], 0
    s_waitcnt lgkmcnt(3)
    v_cvt_pk_bf16_f32 v183, v183, v183
    v_cvt_pk_bf16_f32 v184, v184, v184
    v_mfma_f32_16x16x32_bf16 v[134:137], a[52:55], v[158:161], v[134:137]
    s_barrier
    ds_read_b128 v[174:177], v254 offset:0
    ds_read_b128 v[242:245], v254 offset:1024
    v_mfma_f32_16x16x32_bf16 v[134:137], a[56:59], v[226:229], v[134:137]
    ds_read_b128 v[198:201], v254 offset:2048
    v_cvt_pk_bf16_f32 v185, v185, v185
    v_mfma_f32_16x16x32_bf16 v[134:137], a[60:63], v[150:153], v[134:137]
    ds_write2_b32 v168, v182, v183 offset0:0 offset1:68
    v_mfma_f32_16x16x32_bf16 v[134:137], a[64:67], v[202:205], v[134:137]
    v_cvt_pk_bf16_f32 v222, v222, v222
    v_cvt_pk_bf16_f32 v223, v223, v223
    v_mfma_f32_16x16x32_bf16 v[134:137], a[68:71], v[194:197], v[134:137]
    ds_write2_b32 v168, v184, v185 offset0:136 offset1:204
    v_mfma_f32_16x16x32_bf16 v[182:185], v[154:157], a[144:147], 0
    v_cvt_pk_bf16_f32 v224, v224, v224
    v_cvt_pk_bf16_f32 v225, v225, v225
    v_mfma_f32_16x16x32_bf16 v[182:185], v[158:161], a[148:151], v[182:185]
    ds_write2_b32 v168, v222, v223 offset0:16 offset1:84
    v_mfma_f32_16x16x32_bf16 v[182:185], v[226:229], a[152:155], v[182:185]
    s_waitcnt lgkmcnt(4)
    v_add_f32 v174, v174, v175
    v_add_f32 v176, v176, v177
    v_mfma_f32_16x16x32_bf16 v[182:185], v[150:153], a[156:159], v[182:185]
    s_waitcnt lgkmcnt(3)
    ds_write2_b32 v168, v224, v225 offset0:152 offset1:220
    v_mfma_f32_16x16x32_bf16 v[182:185], v[202:205], a[160:163], v[182:185]
    v_add_f32 v174, v174, v176
    v_mul_f32 v174, 0xbbaaaaab, v174
    v_mfma_f32_16x16x32_bf16 v[182:185], v[194:197], a[164:167], v[182:185]
    ds_write_b32 v130, v174 offset:0
    v_mfma_f32_16x16x32_bf16 v[174:177], v[154:157], a[168:171], 0
    v_add_f32 v242, v242, v243
    v_add_f32 v244, v244, v245
    v_mfma_f32_16x16x32_bf16 v[174:177], v[158:161], a[172:175], v[174:177]
    ds_read_b128 v[222:225], v133 offset:0
    ds_read_b128 v[218:221], v133 offset:64
    v_mfma_f32_16x16x32_bf16 v[174:177], v[226:229], a[176:179], v[174:177]
    v_add_f32 v242, v242, v244
    v_mul_f32 v242, 0xbbaaaaab, v242
    v_mfma_f32_16x16x32_bf16 v[174:177], v[150:153], a[180:183], v[174:177]
    ds_read_b128 v[186:189], v0 offset:32768
    v_add_f32 v198, v198, v199
    v_mfma_f32_16x16x32_bf16 v[174:177], v[202:205], a[184:187], v[174:177]
    ds_read_b128 v[170:173], v1 offset:32768
    v_add_f32 v200, v200, v201
    v_mfma_f32_16x16x32_bf16 v[174:177], v[194:197], a[188:191], v[174:177]
    ds_read_b128 v[234:237], v0 offset:32896
    v_add_f32 v198, v198, v200
    v_mfma_f32_16x16x32_bf16 v[206:209], v[154:157], a[192:195], 0
    ds_read_b128 v[154:157], v1 offset:32896
    v_mul_f32 v198, 0xbbaaaaab, v198
    v_mfma_f32_16x16x32_bf16 v[206:209], v[158:161], a[196:199], v[206:209]
    ds_read_b128 v[158:161], v0 offset:33024
    v_cvt_pk_bf16_f32 v178, v178, v178
    v_mfma_f32_16x16x32_bf16 v[206:209], v[226:229], a[200:203], v[206:209]
    ds_read_b128 v[226:229], v1 offset:33024
    v_cvt_pk_bf16_f32 v179, v179, v179
    v_mfma_f32_16x16x32_bf16 v[206:209], v[150:153], a[204:207], v[206:209]
    s_waitcnt lgkmcnt(6)
    ds_write_b32 v130, v242 offset:256
    v_mfma_f32_16x16x32_bf16 v[206:209], v[202:205], a[208:211], v[206:209]
    v_cvt_pk_bf16_f32 v180, v180, v180
    v_cvt_pk_bf16_f32 v181, v181, v181
    v_mfma_f32_16x16x32_bf16 v[206:209], v[194:197], a[212:215], v[206:209]
    s_waitcnt lgkmcnt(6)
    ds_write_b32 v130, v198 offset:512
    v_mfma_f32_16x16x32_bf16 v[150:153], a[72:75], v[186:189], 0
    s_waitcnt lgkmcnt(6)
    v_cvt_pk_bf16_f32 v192, v182, v183
    v_cvt_pk_bf16_f32 v193, v184, v185
    v_mfma_f32_16x16x32_bf16 v[150:153], a[76:79], v[170:173], v[150:153]
    s_waitcnt lgkmcnt(5)
    ds_write2_b32 v168, v178, v179 offset0:32 offset1:100
    v_mfma_f32_16x16x32_bf16 v[150:153], a[80:83], v[234:237], v[150:153]
    s_waitcnt lgkmcnt(4)
    v_fma_f32 v169, v146, v146, s32
    v_fmac_f32 v169, v147, v147
    v_mfma_f32_16x16x32_bf16 v[150:153], a[84:87], v[154:157], v[150:153]
    s_waitcnt lgkmcnt(3)
    ds_write2_b32 v168, v180, v181 offset0:168 offset1:236
    v_mfma_f32_16x16x32_bf16 v[150:153], a[88:91], v[158:161], v[150:153]
    v_fmac_f32 v169, v148, v148
    v_fmac_f32 v169, v149, v149
    v_mfma_f32_16x16x32_bf16 v[150:153], a[92:95], v[226:229], v[150:153]
    v_fmac_f32 v169, v118, v118
    v_fmac_f32 v169, v119, v119
    v_mfma_f32_16x16x32_bf16 v[182:185], a[96:99], v[186:189], 0
    v_fmac_f32 v169, v120, v120
    v_fmac_f32 v169, v121, v121
    v_mfma_f32_16x16x32_bf16 v[182:185], a[100:103], v[170:173], v[182:185]
    v_fmac_f32 v169, v134, v134
    v_fmac_f32 v169, v135, v135
    v_mfma_f32_16x16x32_bf16 v[182:185], a[104:107], v[234:237], v[182:185]
    v_fmac_f32 v169, v136, v136
    v_fmac_f32 v169, v137, v137
    v_mfma_f32_16x16x32_bf16 v[182:185], a[108:111], v[154:157], v[182:185]
    v_fma_f32 v168, v210, v210, s32
    v_fmac_f32 v168, v211, v211
    v_mfma_f32_16x16x32_bf16 v[182:185], a[112:115], v[158:161], v[182:185]
    v_fmac_f32 v168, v212, v212
    v_fmac_f32 v168, v213, v213
    v_mfma_f32_16x16x32_bf16 v[182:185], a[116:119], v[226:229], v[182:185]
    v_fmac_f32 v168, v138, v138
    v_fmac_f32 v168, v139, v139
    v_mfma_f32_16x16x32_bf16 v[198:201], a[120:123], v[186:189], 0
    v_fmac_f32 v168, v140, v140
    v_fmac_f32 v168, v141, v141
    v_mfma_f32_16x16x32_bf16 v[198:201], a[124:127], v[170:173], v[198:201]
    v_fmac_f32 v168, v238, v238
    v_fmac_f32 v168, v239, v239
    v_mfma_f32_16x16x32_bf16 v[198:201], a[128:131], v[234:237], v[198:201]
    v_fmac_f32 v168, v240, v240
    v_fmac_f32 v168, v241, v241
    v_mfma_f32_16x16x32_bf16 v[198:201], a[132:135], v[154:157], v[198:201]
    v_cvt_pk_bf16_f32 v36, v169, v168
    v_cvt_pk_bf16_f32 v164, v174, v175
    v_mfma_f32_16x16x32_bf16 v[198:201], a[136:139], v[158:161], v[198:201]
    v_cvt_pk_bf16_f32 v165, v176, v177
    v_cvt_pk_bf16_f32 v168, v206, v207
    v_mfma_f32_16x16x32_bf16 v[242:245], v[32:35], v[36:39], 0
    v_cvt_pk_bf16_f32 v169, v208, v209
    v_fma_f32 v142, v150, v150, s32
    v_mfma_f32_16x16x32_bf16 v[198:201], a[140:143], v[226:229], v[198:201]
    v_fmac_f32 v142, v151, v151
    v_fmac_f32 v142, v152, v152
    v_mfma_f32_16x16x32_bf16 v[178:181], a[0:3], v[186:189], 0
    v_fmac_f32 v142, v153, v153
    v_fmac_f32 v142, v182, v182
    v_mfma_f32_16x16x32_bf16 v[178:181], a[4:7], v[170:173], v[178:181]
    v_rsq_f32 v243, v243
    v_mfma_f32_16x16x32_bf16 v[178:181], a[8:11], v[234:237], v[178:181]
    v_rsq_f32 v242, v242
    v_mfma_f32_16x16x32_bf16 v[178:181], a[12:15], v[154:157], v[178:181]
    v_mul_f32 v242, s31, v242
    v_mul_f32 v210, v243, v210
    v_mfma_f32_16x16x32_bf16 v[178:181], a[16:19], v[158:161], v[178:181]
    v_mul_f32 v211, v243, v211
    v_cvt_pk_f16_f32 v210, v210, v211
    v_mfma_f32_16x16x32_bf16 v[178:181], a[20:23], v[226:229], v[178:181]
    v_mul_f32 v212, v243, v212
    v_mul_f32 v213, v243, v213
    v_mfma_f32_16x16x32_bf16 v[174:177], a[24:27], v[186:189], 0
    v_cvt_pk_f16_f32 v211, v212, v213
    v_mul_f32 v138, v243, v138
    v_mfma_f32_16x16x32_bf16 v[174:177], a[28:31], v[170:173], v[174:177]
    v_mul_f32 v139, v243, v139
    v_cvt_pk_f16_f32 v212, v138, v139
    v_mfma_f32_16x16x32_bf16 v[174:177], a[32:35], v[234:237], v[174:177]
    v_mul_f32 v140, v243, v140
    v_mul_f32 v141, v243, v141
    v_mfma_f32_16x16x32_bf16 v[174:177], a[36:39], v[154:157], v[174:177]
    v_cvt_pk_f16_f32 v213, v140, v141
    v_mul_f32 v238, v243, v238
    v_mfma_f32_16x16x32_bf16 v[174:177], a[40:43], v[158:161], v[174:177]
    v_mul_f32 v239, v243, v239
    v_cvt_pk_f16_f32 v204, v238, v239
    v_mfma_f32_16x16x32_bf16 v[174:177], a[44:47], v[226:229], v[174:177]
    v_mul_f32 v240, v243, v240
    v_mul_f32 v241, v243, v241
    v_mfma_f32_16x16x32_bf16 v[138:141], a[48:51], v[186:189], 0
    v_cvt_pk_f16_f32 v205, v240, v241
    v_mul_f32 v146, v242, v146
    v_mfma_f32_16x16x32_bf16 v[138:141], a[52:55], v[170:173], v[138:141]
    ds_read_b128 v[206:209], v5 offset:0
    ds_read_b128 v[194:197], v5 offset:16
    v_mfma_f32_16x16x32_bf16 v[138:141], a[56:59], v[234:237], v[138:141]
    ds_read_b128 v[238:241], v5 offset:48
    ds_read_b32 v143, v6 offset:192
    v_mfma_f32_16x16x32_bf16 v[138:141], a[60:63], v[154:157], v[138:141]
    v_mul_f32 v147, v242, v147
    v_cvt_pk_f16_f32 v146, v146, v147
    v_mfma_f32_16x16x32_bf16 v[138:141], a[64:67], v[158:161], v[138:141]
    v_mul_f32 v148, v242, v148
    v_mul_f32 v149, v242, v149
    v_mfma_f32_16x16x32_bf16 v[138:141], a[68:71], v[226:229], v[138:141]
    v_cvt_pk_f16_f32 v147, v148, v149
    v_mul_f32 v118, v242, v118
    v_mul_f32 v119, v242, v119
    v_cvt_pk_f16_f32 v148, v118, v119
    v_mul_f32 v120, v242, v120
    v_mul_f32 v121, v242, v121
    v_cvt_pk_f16_f32 v149, v120, v121
    v_mfma_f32_16x16x32_bf16 v[118:121], v[186:189], a[144:147], 0
    v_mul_f32 v134, v242, v134
    v_mul_f32 v135, v242, v135
    v_mfma_f32_16x16x32_bf16 v[118:121], v[170:173], a[148:151], v[118:121]
    s_waitcnt lgkmcnt(3)
    v_cvt_pk_f16_f32 v202, v134, v135
    v_mul_f32 v136, v242, v136
    v_mfma_f32_16x16x32_bf16 v[118:121], v[234:237], a[152:155], v[118:121]
    s_waitcnt lgkmcnt(1)
    v_mul_f32 v137, v242, v137
    v_cvt_pk_f16_f32 v203, v136, v137
    v_mfma_f32_16x16x32_bf16 v[118:121], v[154:157], a[156:159], v[118:121]
    s_waitcnt lgkmcnt(0)
    v_fma_f32 v254, v178, v178, s32
    v_fmac_f32 v254, v179, v179
    v_mfma_f32_16x16x32_bf16 v[118:121], v[158:161], a[160:163], v[118:121]
    v_fmac_f32 v254, v180, v180
    v_fmac_f32 v254, v181, v181
    v_mfma_f32_16x16x32_bf16 v[118:121], v[226:229], a[164:167], v[118:121]
    v_fmac_f32 v254, v174, v174
    v_fmac_f32 v254, v175, v175
    v_fmac_f32 v254, v176, v176
    v_fmac_f32 v254, v177, v177
    v_fmac_f32 v254, v138, v138
    v_fmac_f32 v254, v139, v139
    v_fmac_f32 v254, v140, v140
    v_fmac_f32 v254, v141, v141
    v_cvt_pk_bf16_f32 v134, v118, v119
    v_cvt_pk_bf16_f32 v135, v120, v121
    v_mfma_f32_16x16x32_f16 v[118:121], v[206:209], v[126:129], v[22:25]
    v_fmac_f32 v142, v183, v183
    v_fmac_f32 v142, v184, v184
    v_mfma_f32_16x16x32_f16 v[118:121], v[194:197], v[114:117], v[118:121]
    v_fmac_f32 v142, v185, v185
    v_fmac_f32 v142, v198, v198
    v_mfma_f32_16x16x32_f16 v[118:121], v[238:241], v[122:125], v[118:121]
    v_fmac_f32 v142, v199, v199
    v_fmac_f32 v142, v200, v200
    v_fmac_f32 v142, v201, v201
    v_cvt_pk_bf16_f32 v36, v254, v142
    v_mfma_f32_16x16x32_bf16 v[242:245], v[186:189], a[168:171], 0
    v_xor_b32 v0, 65536, v0
    v_xor_b32 v1, 65536, v1
    v_mfma_f32_16x16x32_bf16 v[242:245], v[170:173], a[172:175], v[242:245]
    v_mov_b32_dpp v143, v119 quad_perm:[0,1,2,3] row_mask:0x1 bank_mask:0xf
    v_add_u32 v5, 336, v5
    v_mfma_f32_16x16x32_bf16 v[242:245], v[234:237], a[176:179], v[242:245]
    v_xor_b32 v2, 65536, v2
    v_mfma_f32_16x16x32_bf16 v[242:245], v[154:157], a[180:183], v[242:245]
    v_mfma_f32_16x16x32_bf16 v[242:245], v[158:161], a[184:187], v[242:245]
    v_mfma_f32_16x16x32_bf16 v[242:245], v[226:229], a[188:191], v[242:245]
    s_nop 0
    s_nop 0
    s_nop 0
    s_nop 0
    s_nop 0
    s_nop 0
    s_nop 0
    s_nop 0
    v_cvt_pk_bf16_f32 v246, v242, v243
    v_cvt_pk_bf16_f32 v247, v244, v245
    v_mfma_f32_16x16x32_bf16 v[242:245], v[32:35], v[36:39], 0
    s_nop 0
    s_nop 0
    s_nop 0
    s_nop 0
    s_nop 0
    s_nop 0
    s_nop 0
    s_nop 0
    v_rsq_f32 v243, v243
    v_rsq_f32 v242, v242
    v_mul_f32 v150, v243, v150
    v_mul_f32 v242, s31, v242
    v_mul_f32 v151, v243, v151
    v_cvt_pk_f16_f32 v150, v150, v151
    v_mul_f32 v152, v243, v152
    v_mul_f32 v153, v243, v153
    v_cvt_pk_f16_f32 v151, v152, v153
    v_mul_f32 v182, v243, v182
    v_mul_f32 v183, v243, v183
    v_cvt_pk_f16_f32 v152, v182, v183
    v_mfma_f32_16x16x32_f16 v[230:233], v[206:209], v[146:149], v[24:27]
    v_mul_f32 v184, v243, v184
    v_mul_f32 v185, v243, v185
    v_mfma_f32_16x16x32_f16 v[230:233], v[194:197], v[210:213], v[230:233]
    v_cvt_pk_f16_f32 v153, v184, v185
    v_mul_f32 v198, v243, v198
    v_mfma_f32_16x16x32_f16 v[230:233], v[238:241], v[202:205], v[230:233]
    v_mul_f32 v199, v243, v199
    v_cvt_pk_f16_f32 v216, v198, v199
    v_mfma_f32_16x16x32_bf16 v[182:185], v[186:189], a[192:195], 0
    v_mul_f32 v200, v243, v200
    v_mul_f32 v201, v243, v201
    v_mfma_f32_16x16x32_bf16 v[182:185], v[170:173], a[196:199], v[182:185]
    v_cvt_pk_f16_f32 v217, v200, v201
    v_mul_f32 v178, v242, v178
    v_mfma_f32_16x16x32_bf16 v[182:185], v[234:237], a[200:203], v[182:185]
    v_mul_f32 v179, v242, v179
    v_cvt_pk_f16_f32 v198, v178, v179
    v_mfma_f32_16x16x32_bf16 v[182:185], v[154:157], a[204:207], v[182:185]
    v_mul_f32 v180, v242, v180
    v_mul_f32 v181, v242, v181
    v_mfma_f32_16x16x32_bf16 v[182:185], v[158:161], a[208:211], v[182:185]
    v_cvt_pk_f16_f32 v199, v180, v181
    v_mul_f32 v174, v242, v174
    v_mfma_f32_16x16x32_bf16 v[182:185], v[226:229], a[212:215], v[182:185]
    s_waitcnt vmcnt(0)
    ds_read2_b32 v[136:137], v6 offset0:0 offset1:0
    ds_read2_b32 v[248:249], v6 offset0:16 offset1:16
    v_mfma_f32_16x16x32_f16 v[226:229], v[114:117], v[126:129], v[46:49]
    s_barrier
    buffer_load_dwordx4 v10, s[8:11], 0 offen nt lds
    ds_read2_b32 v[160:161], v6 offset0:32 offset1:32
    v_mfma_f32_16x16x32_f16 v[154:157], v[210:213], v[126:129], v[50:53]
    s_add_u32 m0, s28, 4096
    v_cvt_pk_bf16_f32 v158, v182, v183
    v_cvt_pk_bf16_f32 v159, v184, v185
    v_mfma_f32_16x16x32_f16 v[182:185], v[150:153], v[126:129], v[54:57]
    v_mul_f32 v175, v242, v175
    v_cvt_pk_f16_f32 v200, v174, v175
    v_mul_f32 v176, v242, v176
    v_mfma_f32_16x16x16_f16 v[226:229], v[124:125], v[122:123], v[226:229]
    v_mul_f32 v177, v242, v177
    v_cvt_pk_f16_f32 v201, v176, v177
    v_mul_f32 v138, v242, v138
    v_mfma_f32_16x16x16_f16 v[154:157], v[204:205], v[122:123], v[154:157]
    v_mul_f32 v139, v242, v139
    v_cvt_pk_f16_f32 v214, v138, v139
    v_mul_f32 v140, v242, v140
    v_mfma_f32_16x16x16_f16 v[182:185], v[216:217], v[122:123], v[182:185]
    v_mul_f32 v141, v242, v141
    v_cvt_pk_f16_f32 v215, v140, v141
    v_mov_b32_dpp v143, v231 quad_perm:[0,1,2,3] row_mask:0x2 bank_mask:0xf
    v_max3_f32 v142, v118, v226, v227
    v_mfma_f32_16x16x32_f16 v[138:141], v[206:209], v[198:201], v[26:29]
    s_waitcnt lgkmcnt(1)
    buffer_load_dwordx4 v11, s[8:11], 0 offen nt lds
    v_max3_f32 v142, v142, v228, v229
    v_mfma_f32_16x16x32_f16 v[138:141], v[194:197], v[150:153], v[138:141]
    s_add_u32 m0, s28, 8192
    v_max3_f32 v142, v142, v154, v155
    v_max3_f32 v142, v142, v156, v157
    v_mfma_f32_16x16x32_f16 v[138:141], v[238:241], v[214:217], v[138:141]
    s_waitcnt lgkmcnt(0)
    v_max3_f32 v142, v142, v182, v183
    v_max3_f32 v142, v142, v184, v185
    v_mov_b32 v122, v142
    v_mfma_f32_16x16x16_bf16 v[126:129], a[216:217], v[144:145], v[222:225]
    v_add_u32 v6, 272, v6
    v_permlane32_swap_b32 v142, v122
    v_mfma_f32_16x16x16_bf16 v[174:177], a[240:241], v[144:145], v[222:225]
    v_max_f32 v142, v142, v122
    v_mov_b32 v122, v142
    v_mov_b32_dpp v143, v139 quad_perm:[0,1,2,3] row_mask:0x4 bank_mask:0xf
    v_mfma_f32_16x16x16_bf16 v[242:245], v[90:91], v[144:145], v[222:225]
    v_permlane16_swap_b32 v142, v122
    v_max_f32 v142, v142, v122
    v_mfma_f32_16x16x16_bf16 v[178:181], a[218:219], v[144:145], v[218:221]
    v_sub_f32 v226, v226, v142
    v_exp_f32 v226, v226
    v_mfma_f32_16x16x16_bf16 v[170:173], a[242:243], v[144:145], v[218:221]
    v_sub_f32 v227, v227, v142
    v_exp_f32 v227, v227
    v_mfma_f32_16x16x16_bf16 v[222:225], v[92:93], v[144:145], v[218:221]
    buffer_load_dwordx4 v12, s[8:11], 0 offen nt lds
    s_add_u32 m0, s28, 12288
    s_xor_b32 s28, s28, 65536
    v_cvt_pk_bf16_f32 v226, v226, v227
    v_sub_f32 v228, v228, v142
    v_exp_f32 v228, v228
    v_sub_f32 v229, v229, v142
    v_exp_f32 v229, v229
    v_sub_f32 v154, v154, v142
    v_cvt_pk_bf16_f32 v227, v228, v229
    v_exp_f32 v154, v154
    v_mfma_f32_16x16x32_f16 v[218:221], v[114:117], v[146:149], v[58:61]
    buffer_load_dwordx4 v13, s[8:11], 0 offen nt lds
    s_mov_b32 m0, s29
    s_xor_b32 s29, s29, s30
    v_sub_f32 v155, v155, v142
    v_exp_f32 v155, v155
    v_sub_f32 v156, v156, v142
    v_mfma_f32_16x16x16_f16 v[218:221], v[124:125], v[202:203], v[218:221]
    v_cvt_pk_bf16_f32 v228, v154, v155
    v_exp_f32 v156, v156
    v_sub_f32 v157, v157, v142
    v_exp_f32 v157, v157
    v_sub_f32 v182, v182, v142
    v_cvt_pk_bf16_f32 v229, v156, v157
    buffer_load_dwordx4 v14, s[8:11], 0 offen nt lds
    v_exp_f32 v182, v182
    v_mfma_f32_16x16x32_f16 v[154:157], v[210:213], v[146:149], v[62:65]
    v_sub_f32 v183, v183, v142
    v_exp_f32 v183, v183
    v_sub_f32 v184, v184, v142
    v_cvt_pk_bf16_f32 v36, v182, v183
    v_exp_f32 v184, v184
    v_sub_f32 v185, v185, v142
    v_mfma_f32_16x16x16_f16 v[154:157], v[204:205], v[202:203], v[154:157]
    v_exp_f32 v185, v185
    v_sub_f32 v118, v118, v142
    v_cvt_pk_bf16_f32 v37, v184, v185
    v_mfma_f32_16x16x32_f16 v[182:185], v[150:153], v[146:149], v[66:69]
    v_exp_f32 v118, v118
    v_max3_f32 v142, v230, v218, v219
    v_cvt_pk_bf16_f32 v39, v118, 0
    v_max3_f32 v142, v142, v220, v221
    v_max3_f32 v142, v142, v154, v155
    v_mfma_f32_16x16x32_bf16 v[118:121], v[28:31], v[36:39], 0
    v_max3_f32 v142, v142, v156, v157
    v_cvt_pk_bf16_f32 v126, v126, v127
    v_mfma_f32_16x16x32_bf16 v[118:121], v[28:31], v[226:229], v[118:121]
    v_accvgpr_write_b32 a216, v126
    v_cvt_pk_bf16_f32 v128, v128, v129
    v_mfma_f32_16x16x32_bf16 v[146:149], v[134:137], v[36:39], 0
    v_accvgpr_write_b32 a217, v128
    v_cvt_pk_bf16_f32 v174, v174, v175
    v_mfma_f32_16x16x32_bf16 v[146:149], v[190:193], v[226:229], v[146:149]
    v_accvgpr_write_b32 a240, v174
    v_cvt_pk_bf16_f32 v176, v176, v177
    v_mfma_f32_16x16x32_bf16 v[126:129], v[246:249], v[36:39], 0
    v_rcp_f32 v118, v118
    v_mfma_f32_16x16x32_bf16 v[126:129], v[162:165], v[226:229], v[126:129]
    v_accvgpr_write_b32 a241, v176
    v_cvt_pk_bf16_f32 v90, v242, v243
    v_mfma_f32_16x16x32_bf16 v[174:177], v[158:161], v[36:39], 0
    v_mul_f32 v146, v118, v146
    v_mul_f32 v147, v118, v147
    v_mfma_f32_16x16x32_bf16 v[174:177], v[166:169], v[226:229], v[174:177]
    v_cvt_pk_bf16_f32 v146, v146, v147
    v_mul_f32 v148, v118, v148
    v_mul_f32 v149, v118, v149
    v_mfma_f32_16x16x16_f16 v[182:185], v[216:217], v[202:203], v[182:185]
    v_cvt_pk_bf16_f32 v147, v148, v149
    v_mul_f32 v126, v118, v126
    v_mul_f32 v127, v118, v127
    v_cvt_pk_bf16_f32 v148, v126, v127
    v_mul_f32 v128, v118, v128
    v_mul_f32 v129, v118, v129
    v_cvt_pk_bf16_f32 v149, v128, v129
    ds_write_b128 v3, v[146:149] offset:0
    v_mul_f32 v174, v118, v174
    v_mul_f32 v175, v118, v175
    v_cvt_pk_bf16_f32 v122, v174, v175
    v_mul_f32 v176, v118, v176
    v_mul_f32 v177, v118, v177
    v_cvt_pk_bf16_f32 v123, v176, v177
    v_max3_f32 v142, v142, v182, v183
    ds_write_b64 v4, v[122:123] offset:4096
    v_max3_f32 v142, v142, v184, v185
    v_mov_b32 v122, v142
    v_cvt_pk_bf16_f32 v91, v244, v245
    ds_read_b128 v[118:121], v133 offset:128
    v_permlane32_swap_b32 v142, v122
    v_max_f32 v142, v142, v122
    v_mov_b32 v122, v142
    v_cvt_pk_bf16_f32 v178, v178, v179
    v_accvgpr_write_b32 a218, v178
    v_permlane16_swap_b32 v142, v122
    v_max_f32 v142, v142, v122
    v_sub_f32 v218, v218, v142
    v_exp_f32 v218, v218
    v_sub_f32 v219, v219, v142
    v_exp_f32 v219, v219
    v_sub_f32 v220, v220, v142
    v_cvt_pk_bf16_f32 v126, v218, v219
    v_exp_f32 v220, v220
    v_sub_f32 v221, v221, v142
    v_exp_f32 v221, v221
    v_sub_f32 v154, v154, v142
    v_cvt_pk_bf16_f32 v127, v220, v221
    v_exp_f32 v154, v154
    v_sub_f32 v155, v155, v142
    s_waitcnt lgkmcnt(0)
    v_mfma_f32_16x16x16_bf16 v[174:177], a[232:233], v[144:145], v[118:121]
    v_exp_f32 v155, v155
    v_sub_f32 v156, v156, v142
    v_mfma_f32_16x16x16_bf16 v[226:229], v[82:83], v[144:145], v[118:121]
    v_cvt_pk_bf16_f32 v128, v154, v155
    v_exp_f32 v156, v156
    v_mfma_f32_16x16x16_bf16 v[146:149], v[106:107], v[144:145], v[118:121]
    v_sub_f32 v157, v157, v142
    v_exp_f32 v157, v157
    v_sub_f32 v182, v182, v142
    v_cvt_pk_bf16_f32 v129, v156, v157
    v_exp_f32 v182, v182
    v_sub_f32 v183, v183, v142
    v_exp_f32 v183, v183
    v_sub_f32 v184, v184, v142
    v_cvt_pk_bf16_f32 v36, v182, v183
    v_exp_f32 v184, v184
    v_sub_f32 v185, v185, v142
    v_exp_f32 v185, v185
    v_mfma_f32_16x16x32_f16 v[218:221], v[114:117], v[198:201], v[70:73]
    v_cvt_pk_bf16_f32 v37, v184, v185
    v_sub_f32 v230, v230, v142
    v_mfma_f32_16x16x32_f16 v[154:157], v[210:213], v[198:201], v[74:77]
    v_exp_f32 v230, v230
    v_mfma_f32_16x16x32_f16 v[118:121], v[150:153], v[198:201], v[78:81]
    v_cvt_pk_bf16_f32 v39, v230, 0
    v_cvt_pk_bf16_f32 v180, v180, v181
    v_accvgpr_write_b32 a219, v180
    v_mfma_f32_16x16x32_bf16 v[150:153], v[28:31], v[36:39], 0
    v_cvt_pk_bf16_f32 v170, v170, v171
    v_accvgpr_write_b32 a242, v170
    v_mfma_f32_16x16x32_bf16 v[150:153], v[28:31], v[126:129], v[150:153]
    v_cvt_pk_bf16_f32 v172, v172, v173
    v_accvgpr_write_b32 a243, v172
    v_mfma_f32_16x16x32_bf16 v[170:173], v[134:137], v[36:39], 0
    v_cvt_pk_bf16_f32 v92, v222, v223
    v_cvt_pk_bf16_f32 v93, v224, v225
    v_mfma_f32_16x16x32_bf16 v[170:173], v[190:193], v[126:129], v[170:173]
    ds_read_b128 v[114:117], v133 offset:192
    v_cvt_pk_bf16_f32 v174, v174, v175
    v_mfma_f32_16x16x32_bf16 v[186:189], v[246:249], v[36:39], 0
    v_accvgpr_write_b32 a232, v174
    v_cvt_pk_bf16_f32 v176, v176, v177
    v_mfma_f32_16x16x32_bf16 v[186:189], v[162:165], v[126:129], v[186:189]
    v_accvgpr_write_b32 a233, v176
    v_cvt_pk_bf16_f32 v82, v226, v227
    v_mfma_f32_16x16x32_bf16 v[178:181], v[158:161], v[36:39], 0
    v_cvt_pk_bf16_f32 v83, v228, v229
    v_cvt_pk_bf16_f32 v106, v146, v147
    v_mfma_f32_16x16x32_bf16 v[178:181], v[166:169], v[126:129], v[178:181]
    v_cvt_pk_bf16_f32 v107, v148, v149
    v_rcp_f32 v150, v150
    v_mfma_f32_16x16x16_f16 v[218:221], v[124:125], v[214:215], v[218:221]
    v_mov_b32 v142, v143
    v_mul_f32 v170, v150, v170
    v_mul_f32 v171, v150, v171
    v_mfma_f32_16x16x16_f16 v[154:157], v[204:205], v[214:215], v[154:157]
    v_max_f32_dpp v142, v142, v142 quad_perm:[1,0,3,2] row_mask:0xf bank_mask:0xf
    v_cvt_pk_bf16_f32 v130, v170, v171
    v_mul_f32 v172, v150, v172
    v_mfma_f32_16x16x16_f16 v[118:121], v[216:217], v[214:215], v[118:121]
    s_waitcnt lgkmcnt(0)
    ds_read_b128 v[126:129], v133 offset:256
    v_max3_f32 v132, v138, v218, v219
    v_mfma_f32_16x16x16_bf16 v[122:125], a[220:221], v[144:145], v[114:117]
    v_max3_f32 v132, v132, v220, v221
    v_max3_f32 v132, v132, v154, v155
    v_max3_f32 v132, v132, v156, v157
    v_mfma_f32_16x16x16_bf16 v[146:149], a[244:245], v[144:145], v[114:117]
    v_max3_f32 v132, v132, v118, v119
    v_max3_f32 v132, v132, v120, v121
    v_mov_b32 v131, v132
    v_mfma_f32_16x16x16_bf16 v[182:185], v[94:95], v[144:145], v[114:117]
    v_cvt_pk_bf16_f32 v122, v122, v123
    v_accvgpr_write_b32 a220, v122
    v_cvt_pk_bf16_f32 v124, v124, v125
    v_accvgpr_write_b32 a221, v124
    v_cvt_pk_bf16_f32 v146, v146, v147
    v_accvgpr_write_b32 a244, v146
    v_cvt_pk_bf16_f32 v148, v148, v149
    v_accvgpr_write_b32 a245, v148
    v_cvt_pk_bf16_f32 v94, v182, v183
    v_cvt_pk_bf16_f32 v95, v184, v185
    ds_read_b128 v[122:125], v133 offset:320
    v_permlane32_swap_b32 v132, v131
    v_max_f32 v132, v132, v131
    v_mov_b32 v131, v132
    s_waitcnt lgkmcnt(1)
    v_mfma_f32_16x16x16_bf16 v[114:117], a[222:223], v[144:145], v[126:129]
    v_permlane16_swap_b32 v132, v131
    v_max_f32 v132, v132, v131
    v_mfma_f32_16x16x16_bf16 v[182:185], a[246:247], v[144:145], v[126:129]
    v_sub_f32 v218, v218, v132
    v_exp_f32 v218, v218
    v_mfma_f32_16x16x16_bf16 v[146:149], v[96:97], v[144:145], v[126:129]
    v_sub_f32 v219, v219, v132
    v_exp_f32 v219, v219
    v_cvt_pk_bf16_f32 v114, v114, v115
    v_accvgpr_write_b32 a222, v114
    v_cvt_pk_bf16_f32 v116, v116, v117
    v_accvgpr_write_b32 a223, v116
    v_cvt_pk_bf16_f32 v182, v182, v183
    v_accvgpr_write_b32 a246, v182
    v_cvt_pk_bf16_f32 v184, v184, v185
    v_accvgpr_write_b32 a247, v184
    v_cvt_pk_bf16_f32 v96, v146, v147
    v_cvt_pk_bf16_f32 v97, v148, v149
    s_waitcnt lgkmcnt(0)
    v_mfma_f32_16x16x16_bf16 v[114:117], a[234:235], v[144:145], v[122:125]
    ds_read_b128 v[206:209], v133 offset:384
    v_cvt_pk_bf16_f32 v146, v218, v219
    v_sub_f32 v220, v220, v132
    v_mfma_f32_16x16x16_bf16 v[174:177], v[84:85], v[144:145], v[122:125]
    v_exp_f32 v220, v220
    v_sub_f32 v221, v221, v132
    v_mfma_f32_16x16x16_bf16 v[126:129], v[108:109], v[144:145], v[122:125]
    ds_read_b128 v[182:185], v0 offset:20480
    ds_read_b128 v[198:201], v1 offset:20480
    ds_read_b128 v[210:213], v0 offset:20608
    ds_read_b128 v[222:225], v1 offset:20608
    ds_read_b128 v[226:229], v0 offset:20736
    ds_read_b128 v[242:245], v1 offset:20736
    v_cvt_pk_bf16_f32 v114, v114, v115
    v_accvgpr_write_b32 a234, v114
    v_cvt_pk_bf16_f32 v116, v116, v117
    v_accvgpr_write_b32 a235, v116
    v_cvt_pk_bf16_f32 v84, v174, v175
    s_waitcnt lgkmcnt(6)
    v_mfma_f32_16x16x16_bf16 v[122:125], a[224:225], v[144:145], v[206:209]
    v_cvt_pk_bf16_f32 v85, v176, v177
    v_cvt_pk_bf16_f32 v108, v126, v127
    v_cvt_pk_bf16_f32 v109, v128, v129
    v_mfma_f32_16x16x16_bf16 v[174:177], a[248:249], v[144:145], v[206:209]
    v_exp_f32 v221, v221
    v_sub_f32 v154, v154, v132
    v_mfma_f32_16x16x16_bf16 v[126:129], v[98:99], v[144:145], v[206:209]
    s_waitcnt lgkmcnt(4)
    ds_read_b128 v[202:205], v133 offset:448
    v_cvt_pk_bf16_f32 v122, v122, v123
    v_accvgpr_write_b32 a224, v122
    v_mfma_f32_16x16x32_bf16 v[114:117], a[72:75], v[182:185], 0
    s_waitcnt lgkmcnt(3)
    v_cvt_pk_bf16_f32 v124, v124, v125
    v_accvgpr_write_b32 a225, v124
    v_mfma_f32_16x16x32_bf16 v[114:117], a[76:79], v[198:201], v[114:117]
    s_waitcnt lgkmcnt(2)
    v_cvt_pk_bf16_f32 v174, v174, v175
    v_accvgpr_write_b32 a248, v174
    v_mfma_f32_16x16x32_bf16 v[114:117], a[80:83], v[210:213], v[114:117]
    s_waitcnt lgkmcnt(1)
    v_cvt_pk_bf16_f32 v176, v176, v177
    v_accvgpr_write_b32 a249, v176
    v_mfma_f32_16x16x32_bf16 v[114:117], a[84:87], v[222:225], v[114:117]
    v_cvt_pk_bf16_f32 v98, v126, v127
    v_cvt_pk_bf16_f32 v99, v128, v129
    v_mfma_f32_16x16x32_bf16 v[114:117], a[88:91], v[226:229], v[114:117]
    ds_read_b128 v[126:129], v133 offset:512
    v_cvt_pk_bf16_f32 v147, v220, v221
    v_mfma_f32_16x16x32_bf16 v[114:117], a[92:95], v[242:245], v[114:117]
    v_exp_f32 v154, v154
    v_mfma_f32_16x16x32_bf16 v[122:125], a[96:99], v[182:185], 0
    s_waitcnt lgkmcnt(1)
    v_sub_f32 v155, v155, v132
    v_exp_f32 v155, v155
    v_mfma_f32_16x16x16_bf16 v[174:177], a[226:227], v[144:145], v[202:205]
    v_cvt_pk_bf16_f32 v148, v154, v155
    v_sub_f32 v156, v156, v132
    v_sub_f32 v157, v157, v132
    v_mfma_f32_16x16x16_bf16 v[218:221], a[250:251], v[144:145], v[202:205]
    v_exp_f32 v156, v156
    v_sub_f32 v118, v118, v132
    v_mfma_f32_16x16x16_bf16 v[206:209], v[100:101], v[144:145], v[202:205]
    v_exp_f32 v157, v157
    v_cvt_pk_bf16_f32 v174, v174, v175
    v_accvgpr_write_b32 a226, v174
    v_mfma_f32_16x16x32_bf16 v[122:125], a[100:103], v[198:201], v[122:125]
    v_cvt_pk_bf16_f32 v176, v176, v177
    v_accvgpr_write_b32 a227, v176
    v_mfma_f32_16x16x32_bf16 v[122:125], a[104:107], v[210:213], v[122:125]
    s_waitcnt lgkmcnt(0)
    v_cvt_pk_bf16_f32 v218, v218, v219
    v_accvgpr_write_b32 a250, v218
    v_cvt_pk_bf16_f32 v220, v220, v221
    v_mfma_f32_16x16x16_bf16 v[174:177], a[236:237], v[144:145], v[126:129]
    v_accvgpr_write_b32 a251, v220
    v_cvt_pk_bf16_f32 v100, v206, v207
    v_cvt_pk_bf16_f32 v101, v208, v209
    v_mfma_f32_16x16x16_bf16 v[218:221], v[86:87], v[144:145], v[126:129]
    v_cvt_pk_bf16_f32 v149, v156, v157
    v_exp_f32 v118, v118
    v_mfma_f32_16x16x16_bf16 v[206:209], v[110:111], v[144:145], v[126:129]
    v_sub_f32 v119, v119, v132
    v_cvt_pk_bf16_f32 v174, v174, v175
    v_accvgpr_write_b32 a236, v174
    v_cvt_pk_bf16_f32 v176, v176, v177
    v_mfma_f32_16x16x32_bf16 v[122:125], a[108:111], v[222:225], v[122:125]
    ds_read_b128 v[154:157], v133 offset:576
    v_accvgpr_write_b32 a237, v176
    v_mfma_f32_16x16x32_bf16 v[122:125], a[112:115], v[226:229], v[122:125]
    v_cvt_pk_bf16_f32 v86, v218, v219
    v_cvt_pk_bf16_f32 v87, v220, v221
    v_mfma_f32_16x16x32_bf16 v[122:125], a[116:119], v[242:245], v[122:125]
    v_cvt_pk_bf16_f32 v110, v206, v207
    v_cvt_pk_bf16_f32 v111, v208, v209
    v_mfma_f32_16x16x32_bf16 v[126:129], a[120:123], v[182:185], 0
    ds_read_b128 v[174:177], v133 offset:640
    v_sub_f32 v120, v120, v132
    v_mfma_f32_16x16x32_bf16 v[126:129], a[124:127], v[198:201], v[126:129]
    v_exp_f32 v119, v119
    v_mfma_f32_16x16x32_bf16 v[126:129], a[128:131], v[210:213], v[126:129]
    v_cvt_pk_bf16_f32 v36, v118, v119
    v_sub_f32 v121, v121, v132
    v_mfma_f32_16x16x32_bf16 v[126:129], a[132:135], v[222:225], v[126:129]
    v_exp_f32 v120, v120
    v_mfma_f32_16x16x32_bf16 v[126:129], a[136:139], v[226:229], v[126:129]
    v_exp_f32 v121, v121
    v_mfma_f32_16x16x32_bf16 v[126:129], a[140:143], v[242:245], v[126:129]
    s_waitcnt lgkmcnt(1)
    v_cvt_pk_bf16_f32 v37, v120, v121
    v_sub_f32 v138, v138, v132
    v_max_f32_dpp v142, v142, v142 quad_perm:[2,3,0,1] row_mask:0xf bank_mask:0xf
    v_mfma_f32_16x16x16_bf16 v[118:121], a[228:229], v[144:145], v[154:157]
    v_exp_f32 v138, v138
    v_max_f32_dpp v142, v142, v142 row_half_mirror row_mask:0xf bank_mask:0xf
    v_mfma_f32_16x16x16_bf16 v[218:221], a[252:253], v[144:145], v[154:157]
    v_cvt_pk_bf16_f32 v39, v138, 0
    v_max_f32_dpp v142, v142, v142 row_mirror row_mask:0xf bank_mask:0xf
    v_mov_b32 v254, v142
    v_mul_f32 v173, v150, v173
    v_mfma_f32_16x16x32_bf16 v[206:209], v[28:31], v[36:39], 0
    s_waitcnt lgkmcnt(0)
    v_cvt_pk_bf16_f32 v118, v118, v119
    v_accvgpr_write_b32 a228, v118
    v_mfma_f32_16x16x32_bf16 v[206:209], v[28:31], v[146:149], v[206:209]
    v_cvt_pk_bf16_f32 v120, v120, v121
    v_accvgpr_write_b32 a229, v120
    v_mfma_f32_16x16x32_bf16 v[138:141], v[134:137], v[36:39], 0
    v_cvt_pk_bf16_f32 v218, v218, v219
    v_accvgpr_write_b32 a252, v218
    v_mfma_f32_16x16x32_bf16 v[138:141], v[190:193], v[146:149], v[138:141]
    v_cvt_pk_bf16_f32 v220, v220, v221
    v_accvgpr_write_b32 a253, v220
    v_mfma_f32_16x16x32_bf16 v[118:121], v[246:249], v[36:39], 0
    v_rcp_f32 v206, v206
    v_mfma_f32_16x16x32_bf16 v[118:121], v[162:165], v[146:149], v[118:121]
    v_permlane32_swap_b32 v142, v254
    v_mfma_f32_16x16x32_bf16 v[218:221], v[158:161], v[36:39], 0
    v_max_f32 v142, v142, v254
    v_mul_f32 v138, v206, v138
    v_mfma_f32_16x16x32_bf16 v[218:221], v[166:169], v[146:149], v[218:221]
    v_mul_f32 v139, v206, v139
    v_cvt_pk_bf16_f32 v146, v138, v139
    v_mul_f32 v140, v206, v140
    v_mfma_f32_16x16x16_bf16 v[202:205], v[102:103], v[144:145], v[154:157]
    v_mul_f32 v141, v206, v141
    v_cvt_pk_bf16_f32 v147, v140, v141
    v_mul_f32 v118, v206, v118
    v_mfma_f32_16x16x16_bf16 v[138:141], a[230:231], v[144:145], v[174:177]
    v_mul_f32 v119, v206, v119
    v_cvt_pk_bf16_f32 v148, v118, v119
    v_mul_f32 v120, v206, v120
    v_mfma_f32_16x16x16_bf16 v[154:157], a[254:255], v[144:145], v[174:177]
    v_mul_f32 v121, v206, v121
    v_cvt_pk_bf16_f32 v149, v120, v121
    v_mul_f32 v218, v206, v218
    v_mfma_f32_16x16x16_bf16 v[118:121], v[104:105], v[144:145], v[174:177]
    v_mul_f32 v219, v206, v219
    v_cvt_pk_bf16_f32 v170, v218, v219
    v_mul_f32 v220, v206, v220
    v_mul_f32 v221, v206, v221
    v_mfma_f32_16x16x32_bf16 v[206:209], a[0:3], v[182:185], 0
    ds_write_b128 v3, v[146:149] offset:12288
    v_mfma_f32_16x16x32_bf16 v[206:209], a[4:7], v[198:201], v[206:209]
    v_cvt_pk_bf16_f32 v171, v220, v221
    v_cvt_pk_bf16_f32 v102, v202, v203
    v_mfma_f32_16x16x32_bf16 v[206:209], a[8:11], v[210:213], v[206:209]
    v_cvt_pk_bf16_f32 v103, v204, v205
    v_cvt_pk_bf16_f32 v138, v138, v139
    v_mfma_f32_16x16x32_bf16 v[206:209], a[12:15], v[222:225], v[206:209]
    ds_read_b128 v[146:149], v133 offset:704
    v_accvgpr_write_b32 a230, v138
    v_mfma_f32_16x16x32_bf16 v[206:209], a[16:19], v[226:229], v[206:209]
    ds_write_b64 v4, v[170:171] offset:16384
    v_mfma_f32_16x16x32_bf16 v[206:209], a[20:23], v[242:245], v[206:209]
    v_cvt_pk_bf16_f32 v140, v140, v141
    v_accvgpr_write_b32 a231, v140
    v_mfma_f32_16x16x32_bf16 v[174:177], a[24:27], v[182:185], 0
    v_cvt_pk_bf16_f32 v154, v154, v155
    v_accvgpr_write_b32 a254, v154
    v_mfma_f32_16x16x32_bf16 v[174:177], a[28:31], v[198:201], v[174:177]
    v_cvt_pk_bf16_f32 v156, v156, v157
    v_accvgpr_write_b32 a255, v156
    v_mfma_f32_16x16x32_bf16 v[174:177], a[32:35], v[210:213], v[174:177]
    v_cvt_pk_bf16_f32 v104, v118, v119
    v_cvt_pk_bf16_f32 v105, v120, v121
    v_mfma_f32_16x16x32_bf16 v[174:177], a[36:39], v[222:225], v[174:177]
    v_mov_b32 v254, v142
    v_cvt_pk_bf16_f32 v131, v172, v173
    v_mfma_f32_16x16x32_bf16 v[174:177], a[40:43], v[226:229], v[174:177]
    s_waitcnt lgkmcnt(1)
    v_permlane16_swap_b32 v142, v254
    v_max_f32 v142, v142, v254
    v_mfma_f32_16x16x16_bf16 v[118:121], a[238:239], v[144:145], v[146:149]
    v_sub_f32 v143, v143, v142
    v_exp_f32 v143, v143
    v_mfma_f32_16x16x16_bf16 v[154:157], v[88:89], v[144:145], v[146:149]
    v_cvt_pk_bf16_f32 v143, v143, v143
    v_mul_f32 v186, v150, v186
    v_mul_f32 v187, v150, v187
    v_mfma_f32_16x16x16_bf16 v[138:141], v[112:113], v[144:145], v[146:149]
    v_cvt_pk_bf16_f32 v132, v186, v187
    v_cvt_pk_bf16_f32 v118, v118, v119
    v_accvgpr_write_b32 a238, v118
    v_cvt_pk_bf16_f32 v120, v120, v121
    v_mfma_f32_16x16x32_bf16 v[174:177], a[44:47], v[242:245], v[174:177]
    ds_write_b16 v8, v143
    v_mfma_f32_16x16x32_bf16 v[218:221], a[48:51], v[182:185], 0
    v_accvgpr_write_b32 a239, v120
    v_cvt_pk_bf16_f32 v88, v154, v155
    v_mfma_f32_16x16x32_bf16 v[218:221], a[52:55], v[198:201], v[218:221]
    ds_read_b128 v[142:145], v9
    ds_read_b128 v[118:121], v9 offset:64
    v_mfma_f32_16x16x32_bf16 v[218:221], a[56:59], v[210:213], v[218:221]
    v_cvt_pk_bf16_f32 v89, v156, v157
    v_cvt_pk_bf16_f32 v112, v138, v139
    v_mfma_f32_16x16x32_bf16 v[218:221], a[60:63], v[222:225], v[218:221]
    v_cvt_pk_bf16_f32 v113, v140, v141
    v_mul_f32 v188, v150, v188
    v_mfma_f32_16x16x32_bf16 v[218:221], a[64:67], v[226:229], v[218:221]
    v_mul_f32 v189, v150, v189
    v_cvt_pk_bf16_f32 v133, v188, v189
    v_mfma_f32_16x16x32_bf16 v[218:221], a[68:71], v[242:245], v[218:221]
    ds_write_b128 v3, v[130:133] offset:6144
    v_mfma_f32_16x16x32_bf16 v[170:173], v[182:185], a[144:147], 0
    v_mul_f32 v178, v150, v178
    v_mul_f32 v179, v150, v179
    v_mfma_f32_16x16x32_bf16 v[170:173], v[198:201], a[148:151], v[170:173]
    v_cvt_pk_bf16_f32 v254, v178, v179
    v_mul_f32 v180, v150, v180
    v_mfma_f32_16x16x32_bf16 v[170:173], v[210:213], a[152:155], v[170:173]
    s_waitcnt lgkmcnt(1)
    v_mul_f32 v181, v150, v181
    v_cvt_pk_bf16_f32 v255, v180, v181
    v_mfma_f32_16x16x32_bf16 v[130:133], v[142:145], v[28:31], 0
    ds_write_b64 v4, v[254:255] offset:10240
    v_mfma_f32_16x16x32_bf16 v[130:133], v[118:121], v[28:31], v[130:133]
    v_xor_b32 v3, 65536, v3
    v_xor_b32 v4, 65536, v4
    v_mfma_f32_16x16x32_bf16 v[154:157], v[142:145], v[190:193], 0
    v_mfma_f32_16x16x32_bf16 v[154:157], v[118:121], v[134:137], v[154:157]
    v_mfma_f32_16x16x32_bf16 v[134:137], v[142:145], v[162:165], 0
    v_mfma_f32_16x16x32_bf16 v[134:137], v[118:121], v[246:249], v[134:137]
    v_mfma_f32_16x16x32_bf16 v[162:165], v[142:145], v[166:169], 0
    v_mfma_f32_16x16x32_bf16 v[162:165], v[118:121], v[158:161], v[162:165]
    v_rcp_f32 v130, v130
    v_mfma_f32_16x16x32_bf16 v[170:173], v[222:225], a[156:159], v[170:173]
    v_mfma_f32_16x16x32_bf16 v[170:173], v[226:229], a[160:163], v[170:173]
    v_mfma_f32_16x16x32_bf16 v[170:173], v[242:245], a[164:167], v[170:173]
    v_mul_f32 v154, v154, v130
    s_nop 0
    v_mul_f32_dpp v154, v134, v130 quad_perm:[0,1,2,3] row_mask:0x2 bank_mask:0xf
    s_nop 0
    v_mul_f32_dpp v154, v162, v130 quad_perm:[0,1,2,3] row_mask:0x4 bank_mask:0xf
    v_cvt_pk_bf16_f32 v154, v154, v154
    ds_write_b16 v7, v154
    v_add_u32 v7, 16, v7
    s_waitcnt lgkmcnt(0)
    s_barrier
    s_waitcnt lgkmcnt(0)
    s_cmp_eq_u32 s17, 1
    s_cbranch_scc1 L_drain
    s_max_u32 s3, s37, s44
    s_cmp_gt_u32 s3, 0x42000000
    s_cbranch_scc1 L_safe
    v_cvt_pk_f16_f32 v118, v114, v115
    v_pk_mul_f16 v163, v118, v118
    v_cvt_pk_f16_f32 v119, v116, v117
    v_pk_mul_f16 v165, v119, v119
    v_cvt_pk_f16_f32 v120, v122, v123
    v_pk_fma_f16 v163, v120, v120, v163
    v_cvt_pk_f16_f32 v121, v124, v125
    v_pk_fma_f16 v165, v121, v121, v165
    v_cvt_pk_f16_f32 v196, v126, v127
    v_pk_fma_f16 v163, v196, v196, v163
    v_cvt_pk_f16_f32 v197, v128, v129
    v_pk_fma_f16 v165, v197, v197, v165
    v_cvt_pk_f16_f32 v206, v206, v207
    s_branch L_go
L_safe:
    v_fma_f32 v130, v114, v114, s32
    v_fmac_f32 v130, v115, v115
    v_fmac_f32 v130, v116, v116
    v_fmac_f32 v130, v117, v117
    v_fmac_f32 v130, v122, v122
    v_fmac_f32 v130, v123, v123
    v_fmac_f32 v130, v124, v124
    v_fmac_f32 v130, v125, v125
    v_fmac_f32 v130, v126, v126
    v_fmac_f32 v130, v127, v127
    v_fmac_f32 v130, v128, v128
    v_fmac_f32 v130, v129, v129
    v_fma_f32 v131, v206, v206, s32
    v_fmac_f32 v131, v207, v207
    v_fmac_f32 v131, v208, v208
    v_fmac_f32 v131, v209, v209
    v_fmac_f32 v131, v174, v174
    s_cmp_eq_u32 s16, 1
    s_cbranch_scc1 L_loop_safe1
    s_cmp_eq_u32 s16, 2
    s_cbranch_scc1 L_loop_safe2
    s_cmp_eq_u32 s16, 3
    s_cbranch_scc1 L_loop_safe3
    s_branch L_loop_safe0
.p2align 6
L_loop_safe0:
    v_mfma_f32_16x16x32_bf16 v[162:165], v[182:185], a[168:171], 0
    s_add_u32 s12, s42, s27
    ds_read_b128 v[194:197], v2 offset:18432
    ds_read_b128 v[230:233], v2 offset:19456
    v_mfma_f32_16x16x32_bf16 v[162:165], v[198:201], a[172:175], v[162:165]
    s_addc_u32 s13, s43, 0
    v_fmac_f32 v131, v175, v175
    v_fmac_f32 v131, v176, v176
    v_mfma_f32_16x16x32_bf16 v[162:165], v[210:213], a[176:179], v[162:165]
    s_sub_u32 s14, s36, s27
    v_fmac_f32 v131, v177, v177
    v_fmac_f32 v131, v218, v218
    v_mfma_f32_16x16x32_bf16 v[162:165], v[222:225], a[180:183], v[162:165]
    s_cmp_ge_u32 s18, 2
    v_fmac_f32 v131, v219, v219
    v_fmac_f32 v131, v220, v220
    v_mfma_f32_16x16x32_bf16 v[162:165], v[226:229], a[184:187], v[162:165]
    s_cselect_b32 s14, s14, 0
    ds_read_b128 v[118:121], v0 offset:26624
    v_fmac_f32 v131, v221, v221
    v_mfma_f32_16x16x32_bf16 v[162:165], v[242:245], a[188:191], v[162:165]
    s_add_u32 s34, s18, 2
    ds_read_b128 v[134:137], v1 offset:26624
    v_cvt_pk_bf16_f32 v36, v131, v130
    v_mfma_f32_16x16x32_bf16 v[214:217], v[182:185], a[192:195], 0
    s_add_u32 s8, s40, s23
    ds_read_b128 v[154:157], v0 offset:26752
    v_cvt_pk_bf16_f32 v170, v170, v171
    v_mfma_f32_16x16x32_bf16 v[214:217], v[198:201], a[196:199], v[214:217]
    s_addc_u32 s9, s41, 0
    ds_read_b128 v[198:201], v1 offset:26752
    v_cvt_pk_bf16_f32 v171, v172, v173
    v_mfma_f32_16x16x32_bf16 v[166:169], v[32:35], v[36:39], 0
    s_sub_u32 s10, s36, s23
    v_cvt_pk_bf16_f32 v130, v162, v163
    v_cvt_pk_bf16_f32 v131, v164, v165
    v_mfma_f32_16x16x32_bf16 v[214:217], v[210:213], a[200:203], v[214:217]
    s_waitcnt lgkmcnt(4)
    ds_read_b128 v[210:213], v0 offset:26880
    s_cmp_lt_u32 s34, s17
    v_mfma_f32_16x16x32_bf16 v[234:237], v[32:35], v[194:197], 0
    s_cselect_b32 s10, s10, 0
    v_rsq_f32 v167, v167
    v_mfma_f32_16x16x32_bf16 v[234:237], v[32:35], v[230:233], v[234:237]
    s_add_u32 m0, s28, 0
    v_rsq_f32 v166, v166
    v_mfma_f32_16x16x32_bf16 v[214:217], v[222:225], a[204:207], v[214:217]
    s_waitcnt lgkmcnt(4)
    ds_read_b128 v[162:165], v1 offset:26880
    v_mul_f32 v166, s31, v166
    v_mfma_f32_16x16x32_bf16 v[214:217], v[226:229], a[208:211], v[214:217]
    s_mov_b32 s27, s26
    v_mul_f32 v114, v167, v114
    v_mul_f32 v115, v167, v115
    v_mfma_f32_16x16x32_bf16 v[214:217], v[242:245], a[212:215], v[214:217]
    s_mov_b32 s26, s25
    v_cvt_pk_f16_f32 v242, v114, v115
    v_mul_f32 v116, v167, v116
    v_mfma_f32_16x16x32_bf16 v[226:229], a[72:75], v[118:121], 0
    s_waitcnt lgkmcnt(2)
    v_mul_f32 v117, v167, v117
    v_cvt_pk_f16_f32 v243, v116, v117
    v_mfma_f32_16x16x32_bf16 v[226:229], a[76:79], v[134:137], v[226:229]
    s_mov_b32 s25, s24
    v_cvt_pk_bf16_f32 v114, v214, v215
    v_cvt_pk_bf16_f32 v115, v216, v217
    v_mfma_f32_16x16x32_bf16 v[226:229], a[80:83], v[154:157], v[226:229]
    s_mov_b32 s24, s23
    v_mul_f32 v122, v167, v122
    v_mul_f32 v123, v167, v123
    v_mfma_f32_16x16x32_bf16 v[226:229], a[84:87], v[198:201], v[226:229]
    s_waitcnt lgkmcnt(1)
    v_cvt_pk_f16_f32 v244, v122, v123
    v_mul_f32 v124, v167, v124
    v_mfma_f32_16x16x32_bf16 v[226:229], a[88:91], v[210:213], v[226:229]
    v_mul_f32 v125, v167, v125
    v_cvt_pk_f16_f32 v245, v124, v125
    v_mfma_f32_16x16x32_bf16 v[122:125], a[96:99], v[118:121], 0
    s_waitcnt lgkmcnt(0)
    v_mul_f32 v126, v167, v126
    v_mul_f32 v127, v167, v127
    v_mfma_f32_16x16x32_bf16 v[226:229], a[92:95], v[162:165], v[226:229]
    v_cvt_pk_f16_f32 v184, v126, v127
    v_mul_f32 v128, v167, v128
    v_mfma_f32_16x16x32_bf16 v[122:125], a[100:103], v[134:137], v[122:125]
    v_mul_f32 v129, v167, v129
    v_cvt_pk_f16_f32 v185, v128, v129
    v_mfma_f32_16x16x32_bf16 v[122:125], a[104:107], v[154:157], v[122:125]
    v_mul_f32 v206, v166, v206
    v_mul_f32 v207, v166, v207
    v_mfma_f32_16x16x32_bf16 v[122:125], a[108:111], v[198:201], v[122:125]
    v_cvt_pk_f16_f32 v222, v206, v207
    v_mul_f32 v208, v166, v208
    v_mfma_f32_16x16x32_bf16 v[122:125], a[112:115], v[210:213], v[122:125]
    v_mul_f32 v209, v166, v209
    v_cvt_pk_f16_f32 v223, v208, v209
    v_mfma_f32_16x16x32_bf16 v[122:125], a[116:119], v[162:165], v[122:125]
    v_mul_f32 v174, v166, v174
    v_mul_f32 v175, v166, v175
    v_mfma_f32_16x16x32_bf16 v[126:129], a[120:123], v[118:121], 0
    v_cvt_pk_f16_f32 v224, v174, v175
    v_mul_f32 v176, v166, v176
    v_mfma_f32_16x16x32_bf16 v[126:129], a[124:127], v[134:137], v[126:129]
    v_mul_f32 v177, v166, v177
    v_cvt_pk_f16_f32 v225, v176, v177
    v_mfma_f32_16x16x32_bf16 v[126:129], a[128:131], v[154:157], v[126:129]
    v_mul_f32 v218, v166, v218
    v_mul_f32 v219, v166, v219
    v_mfma_f32_16x16x32_bf16 v[126:129], a[132:135], v[198:201], v[126:129]
    v_cvt_pk_f16_f32 v182, v218, v219
    v_mul_f32 v220, v166, v220
    v_mfma_f32_16x16x32_bf16 v[126:129], a[136:139], v[210:213], v[126:129]
    v_mul_f32 v221, v166, v221
    v_cvt_pk_f16_f32 v183, v220, v221
    v_mfma_f32_16x16x32_bf16 v[126:129], a[140:143], v[162:165], v[126:129]
    v_fma_f32 v116, v226, v226, s32
    v_fmac_f32 v116, v227, v227
    v_mfma_f32_16x16x32_bf16 v[206:209], a[0:3], v[118:121], 0
    v_fmac_f32 v116, v228, v228
    v_fmac_f32 v116, v229, v229
    v_mfma_f32_16x16x32_bf16 v[206:209], a[4:7], v[134:137], v[206:209]
    v_fmac_f32 v116, v122, v122
    v_fmac_f32 v116, v123, v123
    v_mfma_f32_16x16x32_bf16 v[206:209], a[8:11], v[154:157], v[206:209]
    v_fmac_f32 v116, v124, v124
    v_fmac_f32 v116, v125, v125
    v_mfma_f32_16x16x32_bf16 v[206:209], a[12:15], v[198:201], v[206:209]
    v_fmac_f32 v116, v126, v126
    v_fmac_f32 v116, v127, v127
    v_mfma_f32_16x16x32_bf16 v[206:209], a[16:19], v[210:213], v[206:209]
    v_fmac_f32 v116, v128, v128
    v_fmac_f32 v116, v129, v129
    v_mfma_f32_16x16x32_bf16 v[206:209], a[20:23], v[162:165], v[206:209]
    v_mul_f32 v117, 0x3baaaaab, v234
    v_mul_f32 v254, 0x3baaaaab, v235
    v_mfma_f32_16x16x32_bf16 v[174:177], a[24:27], v[118:121], 0
    v_rsq_f32 v117, v117
    v_mfma_f32_16x16x32_bf16 v[174:177], a[28:31], v[134:137], v[174:177]
    v_rsq_f32 v254, v254
    v_mfma_f32_16x16x32_bf16 v[174:177], a[32:35], v[154:157], v[174:177]
    v_mul_f32 v255, 0x3baaaaab, v236
    v_fma_f32 v132, v206, v206, s32
    v_mfma_f32_16x16x32_bf16 v[174:177], a[36:39], v[198:201], v[174:177]
    v_fmac_f32 v132, v207, v207
    v_fmac_f32 v132, v208, v208
    v_mfma_f32_16x16x32_bf16 v[174:177], a[40:43], v[210:213], v[174:177]
    v_fmac_f32 v132, v209, v209
    v_mul_f32 v150, v117, v150
    v_mfma_f32_16x16x32_bf16 v[174:177], a[44:47], v[162:165], v[174:177]
    v_rsq_f32 v255, v255
    v_mfma_f32_16x16x32_bf16 v[218:221], a[48:51], v[118:121], 0
    v_mul_f32 v151, v117, v151
    v_cvt_pk_bf16_f32 v194, v150, v151
    v_mfma_f32_16x16x32_bf16 v[218:221], a[52:55], v[134:137], v[218:221]
    v_mul_f32 v152, v117, v152
    v_mul_f32 v153, v117, v153
    v_mfma_f32_16x16x32_bf16 v[218:221], a[56:59], v[154:157], v[218:221]
    v_fmac_f32 v132, v174, v174
    v_fmac_f32 v132, v175, v175
    v_mfma_f32_16x16x32_bf16 v[218:221], a[60:63], v[198:201], v[218:221]
    v_fmac_f32 v132, v176, v176
    v_fmac_f32 v132, v177, v177
    v_mfma_f32_16x16x32_bf16 v[218:221], a[64:67], v[210:213], v[218:221]
    v_cvt_pk_bf16_f32 v195, v152, v153
    v_mul_f32 v190, v117, v190
    v_mfma_f32_16x16x32_bf16 v[218:221], a[68:71], v[162:165], v[218:221]
    v_mul_f32 v191, v117, v191
    v_cvt_pk_bf16_f32 v196, v190, v191
    v_mfma_f32_16x16x32_bf16 v[150:153], v[118:121], a[144:147], 0
    v_mul_f32 v192, v117, v192
    v_mul_f32 v193, v117, v193
    v_mfma_f32_16x16x32_bf16 v[150:153], v[134:137], a[148:151], v[150:153]
    v_cvt_pk_bf16_f32 v197, v192, v193
    v_mul_f32 v202, v117, v202
    v_mfma_f32_16x16x32_bf16 v[150:153], v[154:157], a[152:155], v[150:153]
    buffer_store_dwordx4 v[194:197], v15, s[12:15], 0 offen nt
    v_fmac_f32 v132, v218, v218
    v_fmac_f32 v132, v219, v219
    v_fmac_f32 v132, v220, v220
    v_fmac_f32 v132, v221, v221
    v_mfma_f32_16x16x32_bf16 v[150:153], v[198:201], a[156:159], v[150:153]
    v_cvt_pk_bf16_f32 v36, v132, v116
    v_mul_f32 v203, v117, v203
    v_mfma_f32_16x16x32_bf16 v[150:153], v[210:213], a[160:163], v[150:153]
    v_cvt_pk_bf16_f32 v116, v202, v203
    v_mul_f32 v204, v117, v204
    v_mfma_f32_16x16x32_bf16 v[190:193], v[32:35], v[36:39], 0
    v_mul_f32 v205, v117, v205
    v_cvt_pk_bf16_f32 v117, v204, v205
    v_mfma_f32_16x16x32_bf16 v[150:153], v[162:165], a[164:167], v[150:153]
    v_mul_f32 v146, v255, v146
    v_mul_f32 v147, v255, v147
    v_mfma_f32_16x16x32_bf16 v[202:205], v[118:121], a[168:171], 0
    v_cvt_pk_bf16_f32 v146, v146, v147
    v_mul_f32 v148, v255, v148
    v_mfma_f32_16x16x32_bf16 v[202:205], v[134:137], a[172:175], v[202:205]
    v_rsq_f32 v191, v191
    v_mfma_f32_16x16x32_bf16 v[202:205], v[154:157], a[176:179], v[202:205]
    v_cvt_pk_bf16_f32 v172, v150, v151
    v_cvt_pk_bf16_f32 v173, v152, v153
    v_mfma_f32_16x16x32_bf16 v[202:205], v[198:201], a[180:183], v[202:205]
    v_rsq_f32 v190, v190
    v_mfma_f32_16x16x32_bf16 v[202:205], v[210:213], a[184:187], v[202:205]
    ds_read_b128 v[150:153], v0 offset:32768
    v_mul_f32 v190, s31, v190
    v_mfma_f32_16x16x32_bf16 v[202:205], v[162:165], a[188:191], v[202:205]
    ds_read_b128 v[166:169], v1 offset:32768
    v_mul_f32 v226, v191, v226
    v_mfma_f32_16x16x32_bf16 v[194:197], v[118:121], a[192:195], 0
    ds_read_b128 v[118:121], v0 offset:32896
    v_mul_f32 v227, v191, v227
    v_mfma_f32_16x16x32_bf16 v[194:197], v[134:137], a[196:199], v[194:197]
    ds_read_b128 v[134:137], v1 offset:32896
    v_cvt_pk_f16_f32 v226, v226, v227
    v_mfma_f32_16x16x32_bf16 v[194:197], v[154:157], a[200:203], v[194:197]
    ds_read_b128 v[154:157], v0 offset:33024
    v_cvt_pk_bf16_f32 v132, v202, v203
    v_mfma_f32_16x16x32_bf16 v[194:197], v[198:201], a[204:207], v[194:197]
    ds_read_b128 v[198:201], v1 offset:33024
    v_cvt_pk_bf16_f32 v133, v204, v205
    v_mfma_f32_16x16x32_bf16 v[194:197], v[210:213], a[208:211], v[194:197]
    v_mul_f32 v228, v191, v228
    v_mul_f32 v229, v191, v229
    v_mfma_f32_16x16x32_bf16 v[194:197], v[162:165], a[212:215], v[194:197]
    v_cvt_pk_f16_f32 v227, v228, v229
    v_mul_f32 v122, v191, v122
    v_mfma_f32_16x16x32_f16 v[210:213], v[242:245], v[222:225], v[46:49]
    s_waitcnt lgkmcnt(5)
    buffer_store_dwordx2 v[116:117], v18, s[12:15], 0 offen nt
    v_mul_f32 v123, v191, v123
    v_cvt_pk_f16_f32 v228, v122, v123
    v_mfma_f32_16x16x32_bf16 v[202:205], a[72:75], v[150:153], 0
    s_waitcnt lgkmcnt(3)
    v_cvt_pk_bf16_f32 v116, v194, v195
    v_cvt_pk_bf16_f32 v117, v196, v197
    v_mfma_f32_16x16x32_bf16 v[202:205], a[76:79], v[166:169], v[202:205]
    s_waitcnt lgkmcnt(2)
    v_mul_f32 v124, v191, v124
    v_mul_f32 v125, v191, v125
    v_mfma_f32_16x16x32_bf16 v[202:205], a[80:83], v[118:121], v[202:205]
    s_waitcnt lgkmcnt(1)
    v_cvt_pk_f16_f32 v229, v124, v125
    v_mul_f32 v126, v191, v126
    v_mfma_f32_16x16x32_bf16 v[202:205], a[84:87], v[134:137], v[202:205]
    s_waitcnt lgkmcnt(0)
    v_mul_f32 v127, v191, v127
    v_cvt_pk_f16_f32 v124, v126, v127
    v_mfma_f32_16x16x32_bf16 v[202:205], a[88:91], v[154:157], v[202:205]
    v_mul_f32 v128, v191, v128
    v_mul_f32 v129, v191, v129
    v_mfma_f32_16x16x32_bf16 v[202:205], a[92:95], v[198:201], v[202:205]
    v_cvt_pk_f16_f32 v125, v128, v129
    v_mul_f32 v206, v190, v206
    v_mfma_f32_16x16x32_bf16 v[126:129], a[96:99], v[150:153], 0
    v_mul_f32 v207, v190, v207
    v_cvt_pk_f16_f32 v206, v206, v207
    v_mfma_f32_16x16x32_bf16 v[126:129], a[100:103], v[166:169], v[126:129]
    v_mul_f32 v208, v190, v208
    v_mul_f32 v209, v190, v209
    v_mfma_f32_16x16x32_bf16 v[126:129], a[104:107], v[118:121], v[126:129]
    v_cvt_pk_f16_f32 v207, v208, v209
    v_mul_f32 v174, v190, v174
    v_mfma_f32_16x16x32_bf16 v[126:129], a[108:111], v[134:137], v[126:129]
    v_mul_f32 v175, v190, v175
    v_cvt_pk_f16_f32 v208, v174, v175
    v_mfma_f32_16x16x32_bf16 v[126:129], a[112:115], v[154:157], v[126:129]
    v_mul_f32 v176, v190, v176
    v_mul_f32 v177, v190, v177
    v_mfma_f32_16x16x32_bf16 v[126:129], a[116:119], v[198:201], v[126:129]
    v_cvt_pk_f16_f32 v209, v176, v177
    v_mul_f32 v218, v190, v218
    v_mfma_f32_16x16x32_bf16 v[174:177], a[120:123], v[150:153], 0
    v_mul_f32 v219, v190, v219
    v_cvt_pk_f16_f32 v122, v218, v219
    v_mfma_f32_16x16x32_bf16 v[174:177], a[124:127], v[166:169], v[174:177]
    v_mul_f32 v220, v190, v220
    v_mul_f32 v221, v190, v221
    v_mfma_f32_16x16x32_bf16 v[174:177], a[128:131], v[118:121], v[174:177]
    v_cvt_pk_f16_f32 v123, v220, v221
    v_fma_f32 v162, v202, v202, s32
    v_mfma_f32_16x16x32_bf16 v[174:177], a[132:135], v[134:137], v[174:177]
    v_fmac_f32 v162, v203, v203
    v_fmac_f32 v162, v204, v204
    v_mfma_f32_16x16x32_bf16 v[174:177], a[136:139], v[154:157], v[174:177]
    v_fmac_f32 v162, v205, v205
    v_fmac_f32 v162, v126, v126
    v_mfma_f32_16x16x32_bf16 v[174:177], a[140:143], v[198:201], v[174:177]
    v_fmac_f32 v162, v127, v127
    v_fmac_f32 v162, v128, v128
    v_mfma_f32_16x16x32_bf16 v[190:193], a[0:3], v[150:153], 0
    v_fmac_f32 v162, v129, v129
    v_mul_f32 v149, v255, v149
    v_mfma_f32_16x16x32_bf16 v[190:193], a[4:7], v[166:169], v[190:193]
    v_cvt_pk_bf16_f32 v147, v148, v149
    v_mul_f32 v138, v255, v138
    v_mfma_f32_16x16x32_bf16 v[190:193], a[8:11], v[118:121], v[190:193]
    v_fmac_f32 v162, v174, v174
    v_fmac_f32 v162, v175, v175
    v_mfma_f32_16x16x32_bf16 v[190:193], a[12:15], v[134:137], v[190:193]
    v_fmac_f32 v162, v176, v176
    v_fmac_f32 v162, v177, v177
    v_mfma_f32_16x16x32_bf16 v[190:193], a[16:19], v[154:157], v[190:193]
    v_mul_f32 v139, v255, v139
    v_cvt_pk_bf16_f32 v148, v138, v139
    v_mfma_f32_16x16x32_bf16 v[190:193], a[20:23], v[198:201], v[190:193]
    v_mul_f32 v140, v255, v140
    v_mul_f32 v141, v255, v141
    v_mfma_f32_16x16x32_bf16 v[218:221], a[24:27], v[150:153], 0
    v_cvt_pk_bf16_f32 v149, v140, v141
    v_mul_f32 v186, v255, v186
    v_mfma_f32_16x16x32_bf16 v[218:221], a[28:31], v[166:169], v[218:221]
    buffer_store_dwordx4 v[146:149], v17, s[12:15], 0 offen nt
    v_mul_f32 v187, v255, v187
    v_fma_f32 v163, v190, v190, s32
    v_fmac_f32 v163, v191, v191
    v_fmac_f32 v163, v192, v192
    v_mfma_f32_16x16x32_bf16 v[218:221], a[32:35], v[118:121], v[218:221]
    v_fmac_f32 v163, v193, v193
    v_cvt_pk_bf16_f32 v164, v186, v187
    v_mfma_f32_16x16x32_bf16 v[218:221], a[36:39], v[134:137], v[218:221]
    v_mul_f32 v188, v255, v188
    v_mul_f32 v189, v255, v189
    v_mfma_f32_16x16x32_bf16 v[218:221], a[40:43], v[154:157], v[218:221]
    v_cvt_pk_bf16_f32 v165, v188, v189
    v_mul_f32 v142, v254, v142
    v_mfma_f32_16x16x32_bf16 v[218:221], a[44:47], v[198:201], v[218:221]
    v_mul_f32 v143, v254, v143
    v_cvt_pk_bf16_f32 v142, v142, v143
    v_mfma_f32_16x16x32_bf16 v[138:141], a[48:51], v[150:153], 0
    v_mul_f32 v144, v254, v144
    v_mul_f32 v145, v254, v145
    v_mfma_f32_16x16x32_bf16 v[138:141], a[52:55], v[166:169], v[138:141]
    v_cvt_pk_bf16_f32 v143, v144, v145
    v_mul_f32 v158, v254, v158
    v_mfma_f32_16x16x32_bf16 v[138:141], a[56:59], v[118:121], v[138:141]
    v_fmac_f32 v163, v218, v218
    v_fmac_f32 v163, v219, v219
    v_mfma_f32_16x16x32_bf16 v[138:141], a[60:63], v[134:137], v[138:141]
    ds_read2_b32 v[196:197], v6 offset0:0 offset1:0
    ds_read2_b32 v[216:217], v6 offset0:16 offset1:16
    v_mfma_f32_16x16x32_bf16 v[138:141], a[64:67], v[154:157], v[138:141]
    ds_read2_b32 v[232:233], v6 offset0:32 offset1:32
    v_fmac_f32 v163, v220, v220
    v_mfma_f32_16x16x32_bf16 v[138:141], a[68:71], v[198:201], v[138:141]
    v_fmac_f32 v163, v221, v221
    v_mul_f32 v159, v254, v159
    v_mfma_f32_16x16x32_bf16 v[146:149], v[150:153], a[144:147], 0
    v_cvt_pk_bf16_f32 v144, v158, v159
    v_mul_f32 v160, v254, v160
    v_mfma_f32_16x16x32_bf16 v[146:149], v[166:169], a[148:151], v[146:149]
    v_mul_f32 v161, v254, v161
    v_cvt_pk_bf16_f32 v145, v160, v161
    v_mfma_f32_16x16x32_bf16 v[146:149], v[118:121], a[152:155], v[146:149]
    v_fmac_f32 v163, v138, v138
    v_fmac_f32 v163, v139, v139
    v_mfma_f32_16x16x32_bf16 v[146:149], v[134:137], a[156:159], v[146:149]
    v_fmac_f32 v163, v140, v140
    v_fmac_f32 v163, v141, v141
    v_mfma_f32_16x16x32_bf16 v[146:149], v[154:157], a[160:163], v[146:149]
    v_cvt_pk_bf16_f32 v36, v163, v162
    v_mul_f32 v178, v254, v178
    v_mfma_f32_16x16x32_bf16 v[146:149], v[198:201], a[164:167], v[146:149]
    s_waitcnt lgkmcnt(1)
    v_mul_f32 v179, v254, v179
    v_cvt_pk_bf16_f32 v178, v178, v179
    v_mfma_f32_16x16x32_bf16 v[158:161], v[32:35], v[36:39], 0
    s_waitcnt lgkmcnt(0)
    buffer_store_dwordx2 v[164:165], v20, s[12:15], 0 offen nt
    v_mul_f32 v180, v254, v180
    v_mul_f32 v181, v254, v181
    v_mfma_f32_16x16x32_bf16 v[186:189], v[150:153], a[168:171], 0
    v_cvt_pk_bf16_f32 v194, v146, v147
    v_cvt_pk_bf16_f32 v195, v148, v149
    v_mfma_f32_16x16x32_bf16 v[186:189], v[166:169], a[172:175], v[186:189]
    v_rsq_f32 v159, v159
    v_mfma_f32_16x16x32_bf16 v[186:189], v[118:121], a[176:179], v[186:189]
    v_rsq_f32 v158, v158
    v_mfma_f32_16x16x32_bf16 v[186:189], v[134:137], a[180:183], v[186:189]
    v_mul_f32 v158, s31, v158
    v_mul_f32 v202, v159, v202
    v_mfma_f32_16x16x32_bf16 v[186:189], v[154:157], a[184:187], v[186:189]
    v_mul_f32 v203, v159, v203
    v_cvt_pk_f16_f32 v146, v202, v203
    v_mfma_f32_16x16x32_bf16 v[186:189], v[198:201], a[188:191], v[186:189]
    v_mul_f32 v204, v159, v204
    v_mul_f32 v205, v159, v205
    v_mfma_f32_16x16x32_bf16 v[162:165], v[150:153], a[192:195], 0
    v_cvt_pk_f16_f32 v147, v204, v205
    v_mul_f32 v126, v159, v126
    v_mfma_f32_16x16x32_bf16 v[162:165], v[166:169], a[196:199], v[162:165]
    ds_read_b128 v[150:153], v5 offset:0
    ds_read_b128 v[202:205], v5 offset:16
    v_mfma_f32_16x16x32_bf16 v[162:165], v[118:121], a[200:203], v[162:165]
    ds_read_b128 v[118:121], v5 offset:48
    ds_read_b32 v254, v6 offset:192
    v_mfma_f32_16x16x32_bf16 v[162:165], v[134:137], a[204:207], v[162:165]
    v_cvt_pk_bf16_f32 v214, v186, v187
    v_cvt_pk_bf16_f32 v215, v188, v189
    v_mfma_f32_16x16x32_bf16 v[162:165], v[154:157], a[208:211], v[162:165]
    v_mul_f32 v127, v159, v127
    v_cvt_pk_f16_f32 v148, v126, v127
    v_mfma_f32_16x16x32_bf16 v[162:165], v[198:201], a[212:215], v[162:165]
    ds_read_b128 v[198:201], v2 offset:0
    ds_read_b128 v[186:189], v2 offset:1024
    v_mfma_f32_16x16x32_f16 v[134:137], v[226:229], v[222:225], v[50:53]
    ds_read_b128 v[154:157], v2 offset:2048
    v_mul_f32 v128, v159, v128
    v_mul_f32 v129, v159, v129
    v_mfma_f32_16x16x16_f16 v[210:213], v[184:185], v[182:183], v[210:213]
    v_cvt_pk_f16_f32 v149, v128, v129
    v_cvt_pk_bf16_f32 v230, v162, v163
    v_cvt_pk_bf16_f32 v231, v164, v165
    v_mul_f32 v174, v159, v174
    v_mfma_f32_16x16x32_f16 v[126:129], v[146:149], v[222:225], v[54:57]
    s_waitcnt lgkmcnt(5)
    v_mul_f32 v175, v159, v175
    v_cvt_pk_f16_f32 v164, v174, v175
    v_mul_f32 v176, v159, v176
    v_mfma_f32_16x16x16_f16 v[134:137], v[124:125], v[182:183], v[134:137]
    v_mul_f32 v177, v159, v177
    v_cvt_pk_f16_f32 v165, v176, v177
    v_mul_f32 v190, v158, v190
    v_mul_f32 v191, v158, v191
    v_mfma_f32_16x16x16_f16 v[126:129], v[164:165], v[182:183], v[126:129]
    v_cvt_pk_f16_f32 v174, v190, v191
    v_mul_f32 v192, v158, v192
    v_mul_f32 v193, v158, v193
    v_cvt_pk_f16_f32 v175, v192, v193
    v_mfma_f32_16x16x32_f16 v[166:169], v[150:153], v[222:225], v[22:25]
    s_waitcnt lgkmcnt(2)
    ds_read_b128 v[222:225], v2 offset:3072
    buffer_store_dwordx4 v[142:145], v16, s[12:15], 0 offen nt
    ds_read_b128 v[234:237], v2 offset:4096
    v_mul_f32 v218, v158, v218
    v_mul_f32 v219, v158, v219
    v_cvt_pk_f16_f32 v176, v218, v219
    v_mfma_f32_16x16x32_f16 v[166:169], v[202:205], v[242:245], v[166:169]
    s_waitcnt lgkmcnt(2)
    v_mul_f32 v220, v158, v220
    v_mul_f32 v221, v158, v221
    v_mfma_f32_16x16x32_f16 v[166:169], v[118:121], v[182:185], v[166:169]
    ds_read_b128 v[142:145], v2 offset:5120
    v_cvt_pk_f16_f32 v177, v220, v221
    v_mul_f32 v138, v158, v138
    v_mul_f32 v139, v158, v139
    v_cvt_pk_f16_f32 v162, v138, v139
    v_mfma_f32_16x16x32_f16 v[218:221], v[150:153], v[206:209], v[24:27]
    v_mul_f32 v140, v158, v140
    v_mul_f32 v141, v158, v141
    v_mfma_f32_16x16x32_f16 v[218:221], v[202:205], v[226:229], v[218:221]
    v_mov_b32_dpp v254, v167 quad_perm:[0,1,2,3] row_mask:0x1 bank_mask:0xf
    v_cvt_pk_f16_f32 v163, v140, v141
    v_mfma_f32_16x16x32_f16 v[218:221], v[118:121], v[122:125], v[218:221]
    v_max3_f32 v255, v166, v210, v211
    v_max3_f32 v255, v255, v212, v213
    v_mfma_f32_16x16x32_f16 v[238:241], v[150:153], v[174:177], v[26:29]
    s_waitcnt lgkmcnt(1)
    v_max3_f32 v255, v255, v134, v135
    v_max3_f32 v255, v255, v136, v137
    v_mfma_f32_16x16x32_f16 v[238:241], v[202:205], v[146:149], v[238:241]
    v_max3_f32 v255, v255, v126, v127
    v_mov_b32_dpp v254, v219 quad_perm:[0,1,2,3] row_mask:0x2 bank_mask:0xf
    v_mfma_f32_16x16x32_f16 v[238:241], v[118:121], v[162:165], v[238:241]
    v_max3_f32 v255, v255, v128, v129
    v_mov_b32 v182, v255
    v_mfma_f32_16x16x32_bf16 v[150:153], a[216:219], v[198:201], 0
    s_waitcnt lgkmcnt(0)
    v_permlane32_swap_b32 v255, v182
    v_mfma_f32_16x16x32_bf16 v[150:153], a[220:223], v[186:189], v[150:153]
    v_max_f32 v255, v255, v182
    v_mov_b32 v182, v255
    v_mfma_f32_16x16x32_bf16 v[150:153], a[224:227], v[154:157], v[150:153]
    v_cvt_pk_bf16_f32 v179, v180, v181
    v_xor_b32 v0, 65536, v0
    v_mfma_f32_16x16x32_bf16 v[150:153], a[228:231], v[222:225], v[150:153]
    s_waitcnt vmcnt(5)
    v_permlane16_swap_b32 v255, v182
    v_mfma_f32_16x16x32_bf16 v[150:153], a[232:235], v[234:237], v[150:153]
    s_barrier
    v_max_f32 v255, v255, v182
    v_sub_f32 v210, v210, v255
    v_mfma_f32_16x16x32_bf16 v[150:153], a[236:239], v[142:145], v[150:153]
    s_nop 0
    v_exp_f32 v210, v210
    v_mfma_f32_16x16x32_bf16 v[190:193], a[240:243], v[198:201], 0
    s_nop 0
    v_sub_f32 v211, v211, v255
    v_sub_f32 v212, v212, v255
    v_mfma_f32_16x16x32_bf16 v[190:193], a[244:247], v[186:189], v[190:193]
    s_nop 0
    buffer_load_dwordx4 v10, s[8:11], 0 offen nt lds
    v_sub_f32 v213, v213, v255
    v_mfma_f32_16x16x32_bf16 v[190:193], a[248:251], v[154:157], v[190:193]
    s_add_u32 m0, s28, 4096
    v_exp_f32 v211, v211
    v_mfma_f32_16x16x32_bf16 v[190:193], a[252:255], v[222:225], v[190:193]
    v_cvt_pk_bf16_f32 v158, v210, v211
    v_sub_f32 v134, v134, v255
    v_mfma_f32_16x16x32_bf16 v[190:193], v[82:85], v[234:237], v[190:193]
    v_exp_f32 v212, v212
    v_mfma_f32_16x16x32_bf16 v[190:193], v[86:89], v[142:145], v[190:193]
    v_exp_f32 v213, v213
    v_mfma_f32_16x16x32_bf16 v[202:205], v[90:93], v[198:201], 0
    ds_read_b128 v[198:201], v2 offset:6144
    buffer_load_dwordx4 v11, s[8:11], 0 offen nt lds
    v_mfma_f32_16x16x32_bf16 v[202:205], v[94:97], v[186:189], v[202:205]
    s_add_u32 m0, s28, 8192
    ds_read_b128 v[138:141], v2 offset:7168
    v_cvt_pk_bf16_f32 v159, v212, v213
    v_mfma_f32_16x16x32_bf16 v[202:205], v[98:101], v[154:157], v[202:205]
    ds_read_b128 v[210:213], v2 offset:8192
    v_sub_f32 v135, v135, v255
    v_mfma_f32_16x16x32_bf16 v[202:205], v[102:105], v[222:225], v[202:205]
    ds_read_b128 v[186:189], v2 offset:9216
    v_sub_f32 v136, v136, v255
    v_mfma_f32_16x16x32_bf16 v[202:205], v[106:109], v[234:237], v[202:205]
    ds_read_b128 v[222:225], v2 offset:10240
    v_sub_f32 v137, v137, v255
    v_mfma_f32_16x16x32_bf16 v[202:205], v[110:113], v[142:145], v[202:205]
    ds_read_b128 v[154:157], v2 offset:11264
    buffer_load_dwordx4 v12, s[8:11], 0 offen nt lds
    v_exp_f32 v134, v134
    v_mfma_f32_16x16x32_f16 v[118:121], v[242:245], v[206:209], v[58:61]
    s_add_u32 m0, s28, 12288
    v_exp_f32 v135, v135
    v_exp_f32 v136, v136
    v_cvt_pk_bf16_f32 v160, v134, v135
    v_exp_f32 v137, v137
    v_sub_f32 v126, v126, v255
    v_mfma_f32_16x16x16_f16 v[118:121], v[184:185], v[122:123], v[118:121]
    v_cvt_pk_bf16_f32 v161, v136, v137
    v_exp_f32 v126, v126
    v_sub_f32 v127, v127, v255
    v_mfma_f32_16x16x32_f16 v[134:137], v[226:229], v[206:209], v[62:65]
    s_xor_b32 s28, s28, 65536
    buffer_load_dwordx4 v13, s[8:11], 0 offen nt lds
    v_exp_f32 v127, v127
    v_sub_f32 v128, v128, v255
    v_cvt_pk_bf16_f32 v36, v126, v127
    v_exp_f32 v128, v128
    v_mfma_f32_16x16x16_f16 v[134:137], v[124:125], v[122:123], v[134:137]
    v_sub_f32 v129, v129, v255
    v_exp_f32 v129, v129
    v_sub_f32 v166, v166, v255
    v_cvt_pk_bf16_f32 v37, v128, v129
    v_mfma_f32_16x16x32_f16 v[126:129], v[146:149], v[206:209], v[66:69]
    s_waitcnt lgkmcnt(0)
    v_exp_f32 v166, v166
    v_mfma_f32_16x16x32_bf16 v[142:145], a[216:219], v[198:201], 0
    s_mov_b32 m0, s29
    v_cvt_pk_bf16_f32 v39, v166, 0
    v_max3_f32 v255, v218, v118, v119
    v_max3_f32 v255, v255, v120, v121
    v_mfma_f32_16x16x16_f16 v[126:129], v[164:165], v[122:123], v[126:129]
    v_max3_f32 v255, v255, v134, v135
    v_max3_f32 v255, v255, v136, v137
    v_xor_b32 v1, 65536, v1
    v_mov_b32_dpp v254, v239 quad_perm:[0,1,2,3] row_mask:0x4 bank_mask:0xf
    v_mfma_f32_16x16x32_bf16 v[206:209], v[28:31], v[36:39], 0
    s_xor_b32 s29, s29, s30
    buffer_store_dwordx2 v[178:179], v19, s[12:15], 0 offen nt
    v_mov_b32 v122, v254
    v_max3_f32 v255, v255, v126, v127
    v_mfma_f32_16x16x32_bf16 v[206:209], v[28:31], v[158:161], v[206:209]
    s_add_u32 s19, s19, s20
    v_max3_f32 v255, v255, v128, v129
    v_mov_b32 v123, v255
    v_mfma_f32_16x16x32_bf16 v[142:145], a[220:223], v[138:141], v[142:145]
    s_add_u32 s23, s23, s21
    v_permlane32_swap_b32 v255, v123
    v_mfma_f32_16x16x32_bf16 v[142:145], a[224:227], v[210:213], v[142:145]
    s_cmp_ge_u32 s19, 72
    v_rcp_f32 v206, v206
    v_mfma_f32_16x16x32_bf16 v[142:145], a[228:231], v[186:189], v[142:145]
    s_cselect_b32 s34, 72, 0
    v_max_f32 v255, v255, v123
    v_mov_b32 v123, v255
    v_mfma_f32_16x16x32_bf16 v[142:145], a[232:235], v[222:225], v[142:145]
    s_cselect_b32 s35, s22, 0
    v_permlane16_swap_b32 v255, v123
    v_mfma_f32_16x16x32_bf16 v[142:145], a[236:239], v[154:157], v[142:145]
    s_sub_u32 s19, s19, s34
    v_max_f32 v255, v255, v123
    v_sub_f32 v118, v118, v255
    v_mfma_f32_16x16x32_bf16 v[178:181], v[194:197], v[36:39], 0
    s_add_u32 s23, s23, s35
    v_exp_f32 v118, v118
    v_mfma_f32_16x16x32_bf16 v[178:181], v[170:173], v[158:161], v[178:181]
    s_add_u32 s18, s18, 1
    v_sub_f32 v119, v119, v255
    v_exp_f32 v119, v119
    v_sub_f32 v120, v120, v255
    v_cvt_pk_bf16_f32 v118, v118, v119
    v_exp_f32 v120, v120
    v_sub_f32 v121, v121, v255
    v_exp_f32 v121, v121
    v_mul_f32 v178, v206, v178
    v_mul_f32 v179, v206, v179
    v_cvt_pk_bf16_f32 v178, v178, v179
    v_mul_f32 v180, v206, v180
    v_mul_f32 v181, v206, v181
    v_cvt_pk_bf16_f32 v179, v180, v181
    v_cvt_pk_bf16_f32 v119, v120, v121
    v_mfma_f32_16x16x32_bf16 v[166:169], v[214:217], v[36:39], 0
    s_cmp_lt_u32 s18, s45
    v_sub_f32 v134, v134, v255
    v_sub_f32 v135, v135, v255
    v_mfma_f32_16x16x32_bf16 v[166:169], v[130:133], v[158:161], v[166:169]
    v_exp_f32 v134, v134
    v_exp_f32 v135, v135
    v_sub_f32 v136, v136, v255
    v_cvt_pk_bf16_f32 v120, v134, v135
    v_exp_f32 v136, v136
    v_sub_f32 v137, v137, v255
    v_exp_f32 v137, v137
    v_sub_f32 v126, v126, v255
    v_mul_f32 v166, v206, v166
    v_mul_f32 v167, v206, v167
    v_cvt_pk_bf16_f32 v180, v166, v167
    v_mul_f32 v168, v206, v168
    v_mul_f32 v169, v206, v169
    v_cvt_pk_bf16_f32 v181, v168, v169
    v_cvt_pk_bf16_f32 v121, v136, v137
    v_mfma_f32_16x16x32_bf16 v[134:137], v[230:233], v[36:39], 0
    buffer_load_dwordx4 v14, s[8:11], 0 offen nt lds
    v_sub_f32 v127, v127, v255
    v_mfma_f32_16x16x32_bf16 v[134:137], v[114:117], v[158:161], v[134:137]
    ds_write_b128 v3, v[178:181] offset:0
    v_mfma_f32_16x16x32_bf16 v[158:161], a[240:243], v[198:201], 0
    v_exp_f32 v126, v126
    v_mfma_f32_16x16x32_bf16 v[158:161], a[244:247], v[138:141], v[158:161]
    v_exp_f32 v127, v127
    v_mfma_f32_16x16x32_bf16 v[158:161], a[248:251], v[210:213], v[158:161]
    v_cvt_pk_bf16_f32 v36, v126, v127
    v_sub_f32 v128, v128, v255
    v_mfma_f32_16x16x32_bf16 v[158:161], a[252:255], v[186:189], v[158:161]
    v_mul_f32 v134, v206, v134
    v_mul_f32 v135, v206, v135
    v_mfma_f32_16x16x32_bf16 v[158:161], v[82:85], v[222:225], v[158:161]
    v_cvt_pk_bf16_f32 v126, v134, v135
    v_mul_f32 v136, v206, v136
    v_mfma_f32_16x16x32_bf16 v[158:161], v[86:89], v[154:157], v[158:161]
    v_mul_f32 v137, v206, v137
    v_cvt_pk_bf16_f32 v127, v136, v137
    v_mfma_f32_16x16x32_bf16 v[178:181], v[90:93], v[198:201], 0
    ds_read_b128 v[198:201], v2 offset:12288
    v_sub_f32 v129, v129, v255
    v_mfma_f32_16x16x32_bf16 v[178:181], v[94:97], v[138:141], v[178:181]
    ds_read_b128 v[206:209], v2 offset:13312
    v_sub_f32 v218, v218, v255
    v_mfma_f32_16x16x32_bf16 v[178:181], v[98:101], v[210:213], v[178:181]
    ds_read_b128 v[210:213], v2 offset:14336
    v_max_f32_dpp v122, v122, v122 quad_perm:[1,0,3,2] row_mask:0xf bank_mask:0xf
    v_mfma_f32_16x16x32_bf16 v[178:181], v[102:105], v[186:189], v[178:181]
    ds_read_b128 v[134:137], v2 offset:15360
    v_max_f32_dpp v122, v122, v122 quad_perm:[2,3,0,1] row_mask:0xf bank_mask:0xf
    v_mfma_f32_16x16x32_bf16 v[178:181], v[106:109], v[222:225], v[178:181]
    ds_read_b128 v[222:225], v2 offset:16384
    v_max_f32_dpp v122, v122, v122 row_half_mirror row_mask:0xf bank_mask:0xf
    v_mfma_f32_16x16x32_bf16 v[178:181], v[110:113], v[154:157], v[178:181]
    ds_read_b128 v[154:157], v2 offset:17408
    ds_write_b64 v4, v[126:127] offset:4096
    v_exp_f32 v128, v128
    v_exp_f32 v129, v129
    v_mfma_f32_16x16x32_f16 v[186:189], v[242:245], v[174:177], v[70:73]
    s_waitcnt lgkmcnt(6)
    v_cvt_pk_bf16_f32 v37, v128, v129
    v_max_f32_dpp v122, v122, v122 row_mirror row_mask:0xf bank_mask:0xf
    v_mfma_f32_16x16x32_f16 v[242:245], v[226:229], v[174:177], v[74:77]
    s_waitcnt lgkmcnt(5)
    v_exp_f32 v218, v218
    v_mfma_f32_16x16x32_f16 v[126:129], v[146:149], v[174:177], v[78:81]
    s_waitcnt lgkmcnt(4)
    v_cvt_pk_bf16_f32 v39, v218, 0
    v_mov_b32 v123, v122
    v_fma_f32 v255, v150, v150, s33
    v_mfma_f32_16x16x32_bf16 v[174:177], v[28:31], v[36:39], 0
    s_waitcnt lgkmcnt(3)
    v_permlane32_swap_b32 v122, v123
    v_mfma_f32_16x16x32_bf16 v[174:177], v[28:31], v[118:121], v[174:177]
    s_waitcnt lgkmcnt(2)
    v_max_f32 v122, v122, v123
    v_mov_b32 v123, v122
    v_mfma_f32_16x16x32_bf16 v[226:229], v[194:197], v[36:39], 0
    s_waitcnt lgkmcnt(0)
    v_permlane16_swap_b32 v122, v123
    v_mfma_f32_16x16x32_bf16 v[226:229], v[170:173], v[118:121], v[226:229]
    v_max_f32 v122, v122, v123
    v_sub_f32 v254, v254, v122
    v_mfma_f32_16x16x32_bf16 v[218:221], v[214:217], v[36:39], 0
    v_exp_f32 v254, v254
    v_mfma_f32_16x16x32_bf16 v[218:221], v[130:133], v[118:121], v[218:221]
    v_cvt_pk_bf16_f32 v254, v254, v254
    v_fmac_f32 v255, v151, v151
    v_mfma_f32_16x16x32_bf16 v[166:169], v[230:233], v[36:39], 0
    ds_write_b16 v8, v254
    v_mfma_f32_16x16x32_bf16 v[166:169], v[114:117], v[118:121], v[166:169]
    v_rcp_f32 v174, v174
    v_fmac_f32 v255, v152, v152
    v_mfma_f32_16x16x16_f16 v[186:189], v[184:185], v[162:163], v[186:189]
    v_mul_f32 v226, v174, v226
    v_mul_f32 v227, v174, v227
    v_cvt_pk_bf16_f32 v122, v226, v227
    v_mfma_f32_16x16x16_f16 v[242:245], v[124:125], v[162:163], v[242:245]
    v_mul_f32 v228, v174, v228
    v_mul_f32 v229, v174, v229
    v_cvt_pk_bf16_f32 v123, v228, v229
    v_mfma_f32_16x16x16_f16 v[126:129], v[164:165], v[162:163], v[126:129]
    v_max3_f32 v254, v238, v186, v187
    v_max3_f32 v254, v254, v188, v189
    v_mul_f32 v218, v174, v218
    v_mul_f32 v219, v174, v219
    v_mfma_f32_16x16x32_bf16 v[146:149], a[216:219], v[198:201], 0
    ds_read_b128 v[118:121], v9
    ds_read_b128 v[162:165], v9 offset:64
    v_mfma_f32_16x16x32_bf16 v[146:149], a[220:223], v[206:209], v[146:149]
    v_max3_f32 v254, v254, v242, v243
    v_max3_f32 v254, v254, v244, v245
    v_mfma_f32_16x16x32_bf16 v[146:149], a[224:227], v[210:213], v[146:149]
    v_max3_f32 v254, v254, v126, v127
    v_max3_f32 v254, v254, v128, v129
    v_mfma_f32_16x16x32_bf16 v[146:149], a[228:231], v[134:137], v[146:149]
    v_mov_b32 v125, v254
    v_cvt_pk_bf16_f32 v124, v218, v219
    v_mfma_f32_16x16x32_bf16 v[146:149], a[232:235], v[222:225], v[146:149]
    v_permlane32_swap_b32 v254, v125
    v_mfma_f32_16x16x32_bf16 v[146:149], a[236:239], v[154:157], v[146:149]
    v_max_f32 v254, v254, v125
    v_mov_b32 v125, v254
    v_mfma_f32_16x16x32_bf16 v[138:141], a[240:243], v[198:201], 0
    v_mul_f32 v220, v174, v220
    v_mul_f32 v221, v174, v221
    v_mfma_f32_16x16x32_bf16 v[138:141], a[244:247], v[206:209], v[138:141]
    v_permlane16_swap_b32 v254, v125
    v_mfma_f32_16x16x32_bf16 v[138:141], a[248:251], v[210:213], v[138:141]
    s_waitcnt lgkmcnt(0)
    v_max_f32 v254, v254, v125
    v_sub_f32 v186, v186, v254
    v_mfma_f32_16x16x32_bf16 v[138:141], a[252:255], v[134:137], v[138:141]
    v_exp_f32 v186, v186
    v_mfma_f32_16x16x32_bf16 v[138:141], v[82:85], v[222:225], v[138:141]
    v_sub_f32 v187, v187, v254
    v_sub_f32 v188, v188, v254
    v_mfma_f32_16x16x32_bf16 v[138:141], v[86:89], v[154:157], v[138:141]
    v_exp_f32 v187, v187
    v_exp_f32 v188, v188
    v_cvt_pk_bf16_f32 v234, v186, v187
    v_sub_f32 v189, v189, v254
    v_exp_f32 v189, v189
    v_sub_f32 v242, v242, v254
    v_cvt_pk_bf16_f32 v235, v188, v189
    v_exp_f32 v242, v242
    v_sub_f32 v243, v243, v254
    v_exp_f32 v243, v243
    v_sub_f32 v244, v244, v254
    v_cvt_pk_bf16_f32 v236, v242, v243
    v_mfma_f32_16x16x32_bf16 v[186:189], v[90:93], v[198:201], 0
    v_exp_f32 v244, v244
    v_mfma_f32_16x16x32_bf16 v[186:189], v[94:97], v[206:209], v[186:189]
    v_sub_f32 v245, v245, v254
    v_sub_f32 v126, v126, v254
    v_mfma_f32_16x16x32_bf16 v[186:189], v[98:101], v[210:213], v[186:189]
    v_exp_f32 v245, v245
    v_mfma_f32_16x16x32_bf16 v[186:189], v[102:105], v[134:137], v[186:189]
    v_cvt_pk_bf16_f32 v237, v244, v245
    v_sub_f32 v127, v127, v254
    v_mfma_f32_16x16x32_bf16 v[186:189], v[106:109], v[222:225], v[186:189]
    v_exp_f32 v126, v126
    v_mfma_f32_16x16x32_bf16 v[186:189], v[110:113], v[154:157], v[186:189]
    ds_read_b128 v[182:185], v0 offset:20480
    ds_read_b128 v[198:201], v1 offset:20480
    v_mfma_f32_16x16x32_bf16 v[206:209], v[118:121], v[28:31], 0
    ds_read_b128 v[210:213], v0 offset:20608
    ds_read_b128 v[222:225], v1 offset:20608
    v_mfma_f32_16x16x32_bf16 v[206:209], v[162:165], v[28:31], v[206:209]
    v_exp_f32 v127, v127
    v_mfma_f32_16x16x32_bf16 v[154:157], v[118:121], v[170:173], 0
    ds_read_b128 v[226:229], v0 offset:20736
    v_cvt_pk_bf16_f32 v36, v126, v127
    v_mfma_f32_16x16x32_bf16 v[154:157], v[162:165], v[194:197], v[154:157]
    ds_read_b128 v[242:245], v1 offset:20736
    v_sub_f32 v128, v128, v254
    v_exp_f32 v128, v128
    v_sub_f32 v129, v129, v254
    v_exp_f32 v129, v129
    v_sub_f32 v238, v238, v254
    v_cvt_pk_bf16_f32 v37, v128, v129
    v_mfma_f32_16x16x32_bf16 v[134:137], v[118:121], v[130:133], 0
    v_exp_f32 v238, v238
    v_mfma_f32_16x16x32_bf16 v[134:137], v[162:165], v[214:217], v[134:137]
    s_waitcnt lgkmcnt(4)
    v_cvt_pk_bf16_f32 v39, v238, 0
    v_cvt_pk_bf16_f32 v125, v220, v221
    v_mfma_f32_16x16x32_bf16 v[218:221], v[118:121], v[114:117], 0
    s_waitcnt lgkmcnt(2)
    ds_write_b128 v3, v[122:125] offset:6144
    v_mfma_f32_16x16x32_bf16 v[126:129], v[28:31], v[36:39], 0
    s_waitcnt lgkmcnt(2)
    v_mul_f32 v166, v174, v166
    v_mul_f32 v167, v174, v167
    v_mfma_f32_16x16x32_bf16 v[126:129], v[28:31], v[234:237], v[126:129]
    s_waitcnt lgkmcnt(1)
    v_cvt_pk_bf16_f32 v166, v166, v167
    v_mul_f32 v168, v174, v168
    v_mfma_f32_16x16x32_bf16 v[122:125], v[194:197], v[36:39], 0
    v_mul_f32 v169, v174, v169
    v_cvt_pk_bf16_f32 v167, v168, v169
    v_mfma_f32_16x16x32_bf16 v[122:125], v[170:173], v[234:237], v[122:125]
    ds_write_b64 v4, v[166:167] offset:10240
    v_mfma_f32_16x16x32_bf16 v[170:173], v[214:217], v[36:39], 0
    v_rcp_f32 v126, v126
    v_mfma_f32_16x16x32_bf16 v[170:173], v[130:133], v[234:237], v[170:173]
    v_fma_f32 v254, v146, v146, s33
    v_fmac_f32 v254, v147, v147
    v_mfma_f32_16x16x32_bf16 v[174:177], v[230:233], v[36:39], 0
    v_fmac_f32 v254, v148, v148
    v_mul_f32 v122, v126, v122
    v_mfma_f32_16x16x32_bf16 v[174:177], v[114:117], v[234:237], v[174:177]
    v_mul_f32 v123, v126, v123
    v_cvt_pk_bf16_f32 v122, v122, v123
    v_mfma_f32_16x16x32_bf16 v[218:221], v[162:165], v[230:233], v[218:221]
    v_mul_f32 v124, v126, v124
    v_mul_f32 v125, v126, v125
    v_mfma_f32_16x16x32_bf16 v[114:117], a[72:75], v[182:185], 0
    v_cvt_pk_bf16_f32 v123, v124, v125
    v_mul_f32 v170, v126, v170
    v_mfma_f32_16x16x32_bf16 v[114:117], a[76:79], v[198:201], v[114:117]
    v_mul_f32 v171, v126, v171
    v_cvt_pk_bf16_f32 v124, v170, v171
    v_mfma_f32_16x16x32_bf16 v[114:117], a[80:83], v[210:213], v[114:117]
    v_mul_f32 v172, v126, v172
    v_mul_f32 v173, v126, v173
    v_mfma_f32_16x16x32_bf16 v[114:117], a[84:87], v[222:225], v[114:117]
    v_cvt_pk_bf16_f32 v125, v172, v173
    v_mul_f32 v174, v126, v174
    v_mfma_f32_16x16x32_bf16 v[114:117], a[88:91], v[226:229], v[114:117]
    ds_write_b128 v3, v[122:125] offset:12288
    v_mfma_f32_16x16x32_bf16 v[114:117], a[92:95], v[242:245], v[114:117]
    v_mul_f32 v175, v126, v175
    v_cvt_pk_bf16_f32 v174, v174, v175
    v_mfma_f32_16x16x32_bf16 v[122:125], a[96:99], v[182:185], 0
    v_mul_f32 v176, v126, v176
    v_mul_f32 v177, v126, v177
    v_mfma_f32_16x16x32_bf16 v[122:125], a[100:103], v[198:201], v[122:125]
    v_cvt_pk_bf16_f32 v175, v176, v177
    v_fmac_f32 v254, v149, v149
    v_mfma_f32_16x16x32_bf16 v[122:125], a[104:107], v[210:213], v[122:125]
    ds_write_b64 v4, v[174:175] offset:16384
    v_mfma_f32_16x16x32_bf16 v[122:125], a[108:111], v[222:225], v[122:125]
    v_fmac_f32 v254, v138, v138
    v_fmac_f32 v254, v139, v139
    v_mfma_f32_16x16x32_bf16 v[122:125], a[112:115], v[226:229], v[122:125]
    v_fmac_f32 v254, v140, v140
    v_fmac_f32 v254, v141, v141
    v_mfma_f32_16x16x32_bf16 v[122:125], a[116:119], v[242:245], v[122:125]
    v_fmac_f32 v254, v186, v186
    v_fmac_f32 v254, v187, v187
    v_mfma_f32_16x16x32_bf16 v[126:129], a[120:123], v[182:185], 0
    v_fmac_f32 v254, v188, v188
    v_fmac_f32 v254, v189, v189
    v_mfma_f32_16x16x32_bf16 v[126:129], a[124:127], v[198:201], v[126:129]
    v_cvt_pk_bf16_f32 v155, v254, v254
    v_fmac_f32 v255, v153, v153
    v_mfma_f32_16x16x32_bf16 v[126:129], a[128:131], v[210:213], v[126:129]
    v_rcp_f32 v206, v206
    v_mfma_f32_16x16x32_bf16 v[126:129], a[132:135], v[222:225], v[126:129]
    v_mul_f32 v154, v154, v206
    v_mul_f32_dpp v154, v134, v206 quad_perm:[0,1,2,3] row_mask:0x2 bank_mask:0xf
    v_mfma_f32_16x16x32_bf16 v[126:129], a[136:139], v[226:229], v[126:129]
    v_mul_f32_dpp v154, v218, v206 quad_perm:[0,1,2,3] row_mask:0x4 bank_mask:0xf
    v_cvt_pk_bf16_f32 v154, v154, v154
    v_mfma_f32_16x16x32_bf16 v[126:129], a[140:143], v[242:245], v[126:129]
    ds_write_b16 v7, v154
    v_mfma_f32_16x16x32_bf16 v[206:209], a[0:3], v[182:185], 0
    v_fmac_f32 v255, v190, v190
    v_fmac_f32 v255, v191, v191
    v_mfma_f32_16x16x32_bf16 v[206:209], a[4:7], v[198:201], v[206:209]
    v_fmac_f32 v255, v192, v192
    v_fmac_f32 v255, v193, v193
    v_mfma_f32_16x16x32_bf16 v[206:209], a[8:11], v[210:213], v[206:209]
    v_fmac_f32 v255, v202, v202
    v_fmac_f32 v255, v203, v203
    v_mfma_f32_16x16x32_bf16 v[206:209], a[12:15], v[222:225], v[206:209]
    v_fmac_f32 v255, v204, v204
    v_fmac_f32 v255, v205, v205
    v_mfma_f32_16x16x32_bf16 v[206:209], a[16:19], v[226:229], v[206:209]
    v_fma_f32 v254, v142, v142, s33
    v_fmac_f32 v254, v143, v143
    v_mfma_f32_16x16x32_bf16 v[206:209], a[20:23], v[242:245], v[206:209]
    v_fmac_f32 v254, v144, v144
    v_fmac_f32 v254, v145, v145
    v_mfma_f32_16x16x32_bf16 v[174:177], a[24:27], v[182:185], 0
    v_fmac_f32 v254, v158, v158
    v_fmac_f32 v254, v159, v159
    v_mfma_f32_16x16x32_bf16 v[174:177], a[28:31], v[198:201], v[174:177]
    v_fmac_f32 v254, v160, v160
    v_fmac_f32 v254, v161, v161
    v_mfma_f32_16x16x32_bf16 v[174:177], a[32:35], v[210:213], v[174:177]
    v_fmac_f32 v254, v178, v178
    v_fmac_f32 v254, v179, v179
    v_mfma_f32_16x16x32_bf16 v[174:177], a[36:39], v[222:225], v[174:177]
    v_fmac_f32 v254, v180, v180
    v_fmac_f32 v254, v181, v181
    v_mfma_f32_16x16x32_bf16 v[174:177], a[40:43], v[226:229], v[174:177]
    v_cvt_pk_bf16_f32 v154, v255, v254
    v_add_u32 v5, 336, v5
    v_mfma_f32_16x16x32_bf16 v[174:177], a[44:47], v[242:245], v[174:177]
    ds_write_b64 v4, v[154:155] offset:18432
    v_mfma_f32_16x16x32_bf16 v[218:221], a[48:51], v[182:185], 0
    v_add_u32 v6, 272, v6
    v_add_u32 v7, 16, v7
    v_mfma_f32_16x16x32_bf16 v[218:221], a[52:55], v[198:201], v[218:221]
    v_fma_f32 v130, v114, v114, s32
    v_fmac_f32 v130, v115, v115
    v_mfma_f32_16x16x32_bf16 v[218:221], a[56:59], v[210:213], v[218:221]
    v_fmac_f32 v130, v116, v116
    v_fmac_f32 v130, v117, v117
    v_mfma_f32_16x16x32_bf16 v[218:221], a[60:63], v[222:225], v[218:221]
    v_fmac_f32 v130, v122, v122
    v_fmac_f32 v130, v123, v123
    v_mfma_f32_16x16x32_bf16 v[218:221], a[64:67], v[226:229], v[218:221]
    v_fmac_f32 v130, v124, v124
    v_fmac_f32 v130, v125, v125
    v_mfma_f32_16x16x32_bf16 v[218:221], a[68:71], v[242:245], v[218:221]
    v_fmac_f32 v130, v126, v126
    v_fmac_f32 v130, v127, v127
    v_mfma_f32_16x16x32_bf16 v[170:173], v[182:185], a[144:147], 0
    s_waitcnt lgkmcnt(0)
    v_fmac_f32 v130, v128, v128
    v_fmac_f32 v130, v129, v129
    v_mfma_f32_16x16x32_bf16 v[170:173], v[198:201], a[148:151], v[170:173]
    s_barrier
    v_fma_f32 v131, v206, v206, s32
    v_fmac_f32 v131, v207, v207
    v_mfma_f32_16x16x32_bf16 v[170:173], v[210:213], a[152:155], v[170:173]
    s_nop 0
    v_fmac_f32 v131, v208, v208
    v_fmac_f32 v131, v209, v209
    v_mfma_f32_16x16x32_bf16 v[170:173], v[222:225], a[156:159], v[170:173]
    s_nop 0
    v_fmac_f32 v131, v174, v174
    v_xor_b32 v2, 65536, v2
    v_mfma_f32_16x16x32_bf16 v[170:173], v[226:229], a[160:163], v[170:173]
    s_nop 0
    v_xor_b32 v3, 65536, v3
    v_xor_b32 v4, 65536, v4
    v_mfma_f32_16x16x32_bf16 v[170:173], v[242:245], a[164:167], v[170:173]
    s_cbranch_scc1 L_loop_safe0
    s_branch L_final_safe
.p2align 6
L_loop_safe1:
    v_mfma_f32_16x16x32_bf16 v[162:165], v[182:185], a[168:171], 0
    s_add_u32 s12, s42, s27
    ds_read_b128 v[194:197], v2 offset:18432
    ds_read_b128 v[230:233], v2 offset:19456
    v_mfma_f32_16x16x32_bf16 v[162:165], v[198:201], a[172:175], v[162:165]
    s_addc_u32 s13, s43, 0
    v_fmac_f32 v131, v175, v175
    v_fmac_f32 v131, v176, v176
    v_mfma_f32_16x16x32_bf16 v[162:165], v[210:213], a[176:179], v[162:165]
    s_sub_u32 s14, s36, s27
    v_fmac_f32 v131, v177, v177
    v_fmac_f32 v131, v218, v218
    v_mfma_f32_16x16x32_bf16 v[162:165], v[222:225], a[180:183], v[162:165]
    s_cmp_ge_u32 s18, 2
    v_fmac_f32 v131, v219, v219
    v_fmac_f32 v131, v220, v220
    v_mfma_f32_16x16x32_bf16 v[162:165], v[226:229], a[184:187], v[162:165]
    s_cselect_b32 s14, s14, 0
    ds_read_b128 v[118:121], v0 offset:26624
    v_fmac_f32 v131, v221, v221
    v_mfma_f32_16x16x32_bf16 v[162:165], v[242:245], a[188:191], v[162:165]
    s_add_u32 s34, s18, 2
    ds_read_b128 v[134:137], v1 offset:26624
    v_cvt_pk_bf16_f32 v36, v131, v130
    v_mfma_f32_16x16x32_bf16 v[214:217], v[182:185], a[192:195], 0
    s_add_u32 s8, s40, s23
    ds_read_b128 v[154:157], v0 offset:26752
    v_cvt_pk_bf16_f32 v170, v170, v171
    v_mfma_f32_16x16x32_bf16 v[214:217], v[198:201], a[196:199], v[214:217]
    s_addc_u32 s9, s41, 0
    ds_read_b128 v[198:201], v1 offset:26752
    v_cvt_pk_bf16_f32 v171, v172, v173
    v_mfma_f32_16x16x32_bf16 v[166:169], v[32:35], v[36:39], 0
    s_sub_u32 s10, s36, s23
    v_cvt_pk_bf16_f32 v130, v162, v163
    v_cvt_pk_bf16_f32 v131, v164, v165
    v_mfma_f32_16x16x32_bf16 v[214:217], v[210:213], a[200:203], v[214:217]
    s_waitcnt lgkmcnt(4)
    ds_read_b128 v[210:213], v0 offset:26880
    s_cmp_lt_u32 s34, s17
    v_mfma_f32_16x16x32_bf16 v[234:237], v[32:35], v[194:197], 0
    s_cselect_b32 s10, s10, 0
    v_rsq_f32 v167, v167
    v_mfma_f32_16x16x32_bf16 v[234:237], v[32:35], v[230:233], v[234:237]
    s_add_u32 m0, s28, 0
    v_rsq_f32 v166, v166
    v_mfma_f32_16x16x32_bf16 v[214:217], v[222:225], a[204:207], v[214:217]
    s_waitcnt lgkmcnt(4)
    ds_read_b128 v[162:165], v1 offset:26880
    v_mul_f32 v166, s31, v166
    v_mfma_f32_16x16x32_bf16 v[214:217], v[226:229], a[208:211], v[214:217]
    s_mov_b32 s27, s26
    v_mul_f32 v114, v167, v114
    v_mul_f32 v115, v167, v115
    v_mfma_f32_16x16x32_bf16 v[214:217], v[242:245], a[212:215], v[214:217]
    s_mov_b32 s26, s25
    v_cvt_pk_f16_f32 v242, v114, v115
    v_mul_f32 v116, v167, v116
    v_mfma_f32_16x16x32_bf16 v[226:229], a[72:75], v[118:121], 0
    s_waitcnt lgkmcnt(2)
    v_mul_f32 v117, v167, v117
    v_cvt_pk_f16_f32 v243, v116, v117
    v_mfma_f32_16x16x32_bf16 v[226:229], a[76:79], v[134:137], v[226:229]
    s_mov_b32 s25, s24
    v_cvt_pk_bf16_f32 v114, v214, v215
    v_cvt_pk_bf16_f32 v115, v216, v217
    v_mfma_f32_16x16x32_bf16 v[226:229], a[80:83], v[154:157], v[226:229]
    s_mov_b32 s24, s23
    v_mul_f32 v122, v167, v122
    v_mul_f32 v123, v167, v123
    v_mfma_f32_16x16x32_bf16 v[226:229], a[84:87], v[198:201], v[226:229]
    s_waitcnt lgkmcnt(1)
    v_cvt_pk_f16_f32 v244, v122, v123
    v_mul_f32 v124, v167, v124
    v_mfma_f32_16x16x32_bf16 v[226:229], a[88:91], v[210:213], v[226:229]
    v_mul_f32 v125, v167, v125
    v_cvt_pk_f16_f32 v245, v124, v125
    v_mfma_f32_16x16x32_bf16 v[122:125], a[96:99], v[118:121], 0
    s_waitcnt lgkmcnt(0)
    v_mul_f32 v126, v167, v126
    v_mul_f32 v127, v167, v127
    v_mfma_f32_16x16x32_bf16 v[226:229], a[92:95], v[162:165], v[226:229]
    v_cvt_pk_f16_f32 v184, v126, v127
    v_mul_f32 v128, v167, v128
    v_mfma_f32_16x16x32_bf16 v[122:125], a[100:103], v[134:137], v[122:125]
    v_mul_f32 v129, v167, v129
    v_cvt_pk_f16_f32 v185, v128, v129
    v_mfma_f32_16x16x32_bf16 v[122:125], a[104:107], v[154:157], v[122:125]
    v_mul_f32 v206, v166, v206
    v_mul_f32 v207, v166, v207
    v_mfma_f32_16x16x32_bf16 v[122:125], a[108:111], v[198:201], v[122:125]
    v_cvt_pk_f16_f32 v222, v206, v207
    v_mul_f32 v208, v166, v208
    v_mfma_f32_16x16x32_bf16 v[122:125], a[112:115], v[210:213], v[122:125]
    v_mul_f32 v209, v166, v209
    v_cvt_pk_f16_f32 v223, v208, v209
    v_mfma_f32_16x16x32_bf16 v[122:125], a[116:119], v[162:165], v[122:125]
    v_mul_f32 v174, v166, v174
    v_mul_f32 v175, v166, v175
    v_mfma_f32_16x16x32_bf16 v[126:129], a[120:123], v[118:121], 0
    v_cvt_pk_f16_f32 v224, v174, v175
    v_mul_f32 v176, v166, v176
    v_mfma_f32_16x16x32_bf16 v[126:129], a[124:127], v[134:137], v[126:129]
    v_mul_f32 v177, v166, v177
    v_cvt_pk_f16_f32 v225, v176, v177
    v_mfma_f32_16x16x32_bf16 v[126:129], a[128:131], v[154:157], v[126:129]
    v_mul_f32 v218, v166, v218
    v_mul_f32 v219, v166, v219
    v_mfma_f32_16x16x32_bf16 v[126:129], a[132:135], v[198:201], v[126:129]
    v_cvt_pk_f16_f32 v182, v218, v219
    v_mul_f32 v220, v166, v220
    v_mfma_f32_16x16x32_bf16 v[126:129], a[136:139], v[210:213], v[126:129]
    v_mul_f32 v221, v166, v221
    v_cvt_pk_f16_f32 v183, v220, v221
    v_mfma_f32_16x16x32_bf16 v[126:129], a[140:143], v[162:165], v[126:129]
    v_fma_f32 v116, v226, v226, s32
    v_fmac_f32 v116, v227, v227
    v_mfma_f32_16x16x32_bf16 v[206:209], a[0:3], v[118:121], 0
    v_fmac_f32 v116, v228, v228
    v_fmac_f32 v116, v229, v229
    v_mfma_f32_16x16x32_bf16 v[206:209], a[4:7], v[134:137], v[206:209]
    v_fmac_f32 v116, v122, v122
    v_fmac_f32 v116, v123, v123
    v_mfma_f32_16x16x32_bf16 v[206:209], a[8:11], v[154:157], v[206:209]
    v_fmac_f32 v116, v124, v124
    v_fmac_f32 v116, v125, v125
    v_mfma_f32_16x16x32_bf16 v[206:209], a[12:15], v[198:201], v[206:209]
    v_fmac_f32 v116, v126, v126
    v_fmac_f32 v116, v127, v127
    v_mfma_f32_16x16x32_bf16 v[206:209], a[16:19], v[210:213], v[206:209]
    v_fmac_f32 v116, v128, v128
    v_fmac_f32 v116, v129, v129
    v_mfma_f32_16x16x32_bf16 v[206:209], a[20:23], v[162:165], v[206:209]
    v_mul_f32 v117, 0x3baaaaab, v234
    v_mul_f32 v254, 0x3baaaaab, v235
    v_mfma_f32_16x16x32_bf16 v[174:177], a[24:27], v[118:121], 0
    v_rsq_f32 v117, v117
    v_mfma_f32_16x16x32_bf16 v[174:177], a[28:31], v[134:137], v[174:177]
    v_rsq_f32 v254, v254
    v_mfma_f32_16x16x32_bf16 v[174:177], a[32:35], v[154:157], v[174:177]
    v_mul_f32 v255, 0x3baaaaab, v236
    v_fma_f32 v132, v206, v206, s32
    v_mfma_f32_16x16x32_bf16 v[174:177], a[36:39], v[198:201], v[174:177]
    v_fmac_f32 v132, v207, v207
    v_fmac_f32 v132, v208, v208
    v_mfma_f32_16x16x32_bf16 v[174:177], a[40:43], v[210:213], v[174:177]
    v_fmac_f32 v132, v209, v209
    v_mul_f32 v150, v117, v150
    v_mfma_f32_16x16x32_bf16 v[174:177], a[44:47], v[162:165], v[174:177]
    v_rsq_f32 v255, v255
    v_mfma_f32_16x16x32_bf16 v[218:221], a[48:51], v[118:121], 0
    v_mul_f32 v151, v117, v151
    v_cvt_pk_bf16_f32 v194, v150, v151
    v_mfma_f32_16x16x32_bf16 v[218:221], a[52:55], v[134:137], v[218:221]
    v_mul_f32 v152, v117, v152
    v_mul_f32 v153, v117, v153
    v_mfma_f32_16x16x32_bf16 v[218:221], a[56:59], v[154:157], v[218:221]
    v_fmac_f32 v132, v174, v174
    v_fmac_f32 v132, v175, v175
    v_mfma_f32_16x16x32_bf16 v[218:221], a[60:63], v[198:201], v[218:221]
    v_fmac_f32 v132, v176, v176
    v_fmac_f32 v132, v177, v177
    v_mfma_f32_16x16x32_bf16 v[218:221], a[64:67], v[210:213], v[218:221]
    v_cvt_pk_bf16_f32 v195, v152, v153
    v_mul_f32 v190, v117, v190
    v_mfma_f32_16x16x32_bf16 v[218:221], a[68:71], v[162:165], v[218:221]
    v_mul_f32 v191, v117, v191
    v_cvt_pk_bf16_f32 v196, v190, v191
    v_mfma_f32_16x16x32_bf16 v[150:153], v[118:121], a[144:147], 0
    v_mul_f32 v192, v117, v192
    v_mul_f32 v193, v117, v193
    v_mfma_f32_16x16x32_bf16 v[150:153], v[134:137], a[148:151], v[150:153]
    v_cvt_pk_bf16_f32 v197, v192, v193
    v_mul_f32 v202, v117, v202
    v_mfma_f32_16x16x32_bf16 v[150:153], v[154:157], a[152:155], v[150:153]
    buffer_store_dwordx4 v[194:197], v15, s[12:15], 0 offen nt
    v_fmac_f32 v132, v218, v218
    v_fmac_f32 v132, v219, v219
    v_fmac_f32 v132, v220, v220
    v_fmac_f32 v132, v221, v221
    v_mfma_f32_16x16x32_bf16 v[150:153], v[198:201], a[156:159], v[150:153]
    v_cvt_pk_bf16_f32 v36, v132, v116
    v_mul_f32 v203, v117, v203
    v_mfma_f32_16x16x32_bf16 v[150:153], v[210:213], a[160:163], v[150:153]
    v_cvt_pk_bf16_f32 v116, v202, v203
    v_mul_f32 v204, v117, v204
    v_mfma_f32_16x16x32_bf16 v[190:193], v[32:35], v[36:39], 0
    v_mul_f32 v205, v117, v205
    v_cvt_pk_bf16_f32 v117, v204, v205
    v_mfma_f32_16x16x32_bf16 v[150:153], v[162:165], a[164:167], v[150:153]
    v_mul_f32 v146, v255, v146
    v_mul_f32 v147, v255, v147
    v_mfma_f32_16x16x32_bf16 v[202:205], v[118:121], a[168:171], 0
    v_cvt_pk_bf16_f32 v146, v146, v147
    v_mul_f32 v148, v255, v148
    v_mfma_f32_16x16x32_bf16 v[202:205], v[134:137], a[172:175], v[202:205]
    v_rsq_f32 v191, v191
    v_mfma_f32_16x16x32_bf16 v[202:205], v[154:157], a[176:179], v[202:205]
    v_cvt_pk_bf16_f32 v172, v150, v151
    v_cvt_pk_bf16_f32 v173, v152, v153
    v_mfma_f32_16x16x32_bf16 v[202:205], v[198:201], a[180:183], v[202:205]
    v_rsq_f32 v190, v190
    v_mfma_f32_16x16x32_bf16 v[202:205], v[210:213], a[184:187], v[202:205]
    ds_read_b128 v[150:153], v0 offset:32768
    v_mul_f32 v190, s31, v190
    v_mfma_f32_16x16x32_bf16 v[202:205], v[162:165], a[188:191], v[202:205]
    ds_read_b128 v[166:169], v1 offset:32768
    v_mul_f32 v226, v191, v226
    v_mfma_f32_16x16x32_bf16 v[194:197], v[118:121], a[192:195], 0
    ds_read_b128 v[118:121], v0 offset:32896
    v_mul_f32 v227, v191, v227
    v_mfma_f32_16x16x32_bf16 v[194:197], v[134:137], a[196:199], v[194:197]
    ds_read_b128 v[134:137], v1 offset:32896
    v_cvt_pk_f16_f32 v226, v226, v227
    v_mfma_f32_16x16x32_bf16 v[194:197], v[154:157], a[200:203], v[194:197]
    ds_read_b128 v[154:157], v0 offset:33024
    v_cvt_pk_bf16_f32 v132, v202, v203
    v_mfma_f32_16x16x32_bf16 v[194:197], v[198:201], a[204:207], v[194:197]
    ds_read_b128 v[198:201], v1 offset:33024
    v_cvt_pk_bf16_f32 v133, v204, v205
    v_mfma_f32_16x16x32_bf16 v[194:197], v[210:213], a[208:211], v[194:197]
    v_mul_f32 v228, v191, v228
    v_mul_f32 v229, v191, v229
    v_mfma_f32_16x16x32_bf16 v[194:197], v[162:165], a[212:215], v[194:197]
    v_cvt_pk_f16_f32 v227, v228, v229
    v_mul_f32 v122, v191, v122
    v_mfma_f32_16x16x32_f16 v[210:213], v[242:245], v[222:225], v[46:49]
    s_waitcnt lgkmcnt(5)
    buffer_store_dwordx2 v[116:117], v18, s[12:15], 0 offen nt
    v_mul_f32 v123, v191, v123
    v_cvt_pk_f16_f32 v228, v122, v123
    v_mfma_f32_16x16x32_bf16 v[202:205], a[72:75], v[150:153], 0
    s_waitcnt lgkmcnt(3)
    v_cvt_pk_bf16_f32 v116, v194, v195
    v_cvt_pk_bf16_f32 v117, v196, v197
    v_mfma_f32_16x16x32_bf16 v[202:205], a[76:79], v[166:169], v[202:205]
    s_waitcnt lgkmcnt(2)
    v_mul_f32 v124, v191, v124
    v_mul_f32 v125, v191, v125
    v_mfma_f32_16x16x32_bf16 v[202:205], a[80:83], v[118:121], v[202:205]
    s_waitcnt lgkmcnt(1)
    v_cvt_pk_f16_f32 v229, v124, v125
    v_mul_f32 v126, v191, v126
    v_mfma_f32_16x16x32_bf16 v[202:205], a[84:87], v[134:137], v[202:205]
    s_waitcnt lgkmcnt(0)
    v_mul_f32 v127, v191, v127
    v_cvt_pk_f16_f32 v124, v126, v127
    v_mfma_f32_16x16x32_bf16 v[202:205], a[88:91], v[154:157], v[202:205]
    v_mul_f32 v128, v191, v128
    v_mul_f32 v129, v191, v129
    v_mfma_f32_16x16x32_bf16 v[202:205], a[92:95], v[198:201], v[202:205]
    v_cvt_pk_f16_f32 v125, v128, v129
    v_mul_f32 v206, v190, v206
    v_mfma_f32_16x16x32_bf16 v[126:129], a[96:99], v[150:153], 0
    v_mul_f32 v207, v190, v207
    v_cvt_pk_f16_f32 v206, v206, v207
    v_mfma_f32_16x16x32_bf16 v[126:129], a[100:103], v[166:169], v[126:129]
    v_mul_f32 v208, v190, v208
    v_mul_f32 v209, v190, v209
    v_mfma_f32_16x16x32_bf16 v[126:129], a[104:107], v[118:121], v[126:129]
    v_cvt_pk_f16_f32 v207, v208, v209
    v_mul_f32 v174, v190, v174
    v_mfma_f32_16x16x32_bf16 v[126:129], a[108:111], v[134:137], v[126:129]
    v_mul_f32 v175, v190, v175
    v_cvt_pk_f16_f32 v208, v174, v175
    v_mfma_f32_16x16x32_bf16 v[126:129], a[112:115], v[154:157], v[126:129]
    v_mul_f32 v176, v190, v176
    v_mul_f32 v177, v190, v177
    v_mfma_f32_16x16x32_bf16 v[126:129], a[116:119], v[198:201], v[126:129]
    v_cvt_pk_f16_f32 v209, v176, v177
    v_mul_f32 v218, v190, v218
    v_mfma_f32_16x16x32_bf16 v[174:177], a[120:123], v[150:153], 0
    v_mul_f32 v219, v190, v219
    v_cvt_pk_f16_f32 v122, v218, v219
    v_mfma_f32_16x16x32_bf16 v[174:177], a[124:127], v[166:169], v[174:177]
    v_mul_f32 v220, v190, v220
    v_mul_f32 v221, v190, v221
    v_mfma_f32_16x16x32_bf16 v[174:177], a[128:131], v[118:121], v[174:177]
    v_cvt_pk_f16_f32 v123, v220, v221
    v_fma_f32 v162, v202, v202, s32
    v_mfma_f32_16x16x32_bf16 v[174:177], a[132:135], v[134:137], v[174:177]
    v_fmac_f32 v162, v203, v203
    v_fmac_f32 v162, v204, v204
    v_mfma_f32_16x16x32_bf16 v[174:177], a[136:139], v[154:157], v[174:177]
    v_fmac_f32 v162, v205, v205
    v_fmac_f32 v162, v126, v126
    v_mfma_f32_16x16x32_bf16 v[174:177], a[140:143], v[198:201], v[174:177]
    v_fmac_f32 v162, v127, v127
    v_fmac_f32 v162, v128, v128
    v_mfma_f32_16x16x32_bf16 v[190:193], a[0:3], v[150:153], 0
    v_fmac_f32 v162, v129, v129
    v_mul_f32 v149, v255, v149
    v_mfma_f32_16x16x32_bf16 v[190:193], a[4:7], v[166:169], v[190:193]
    v_cvt_pk_bf16_f32 v147, v148, v149
    v_mul_f32 v138, v255, v138
    v_mfma_f32_16x16x32_bf16 v[190:193], a[8:11], v[118:121], v[190:193]
    v_fmac_f32 v162, v174, v174
    v_fmac_f32 v162, v175, v175
    v_mfma_f32_16x16x32_bf16 v[190:193], a[12:15], v[134:137], v[190:193]
    v_fmac_f32 v162, v176, v176
    v_fmac_f32 v162, v177, v177
    v_mfma_f32_16x16x32_bf16 v[190:193], a[16:19], v[154:157], v[190:193]
    v_mul_f32 v139, v255, v139
    v_cvt_pk_bf16_f32 v148, v138, v139
    v_mfma_f32_16x16x32_bf16 v[190:193], a[20:23], v[198:201], v[190:193]
    v_mul_f32 v140, v255, v140
    v_mul_f32 v141, v255, v141
    v_mfma_f32_16x16x32_bf16 v[218:221], a[24:27], v[150:153], 0
    v_cvt_pk_bf16_f32 v149, v140, v141
    v_mul_f32 v186, v255, v186
    v_mfma_f32_16x16x32_bf16 v[218:221], a[28:31], v[166:169], v[218:221]
    buffer_store_dwordx4 v[146:149], v17, s[12:15], 0 offen nt
    v_mul_f32 v187, v255, v187
    v_fma_f32 v163, v190, v190, s32
    v_fmac_f32 v163, v191, v191
    v_fmac_f32 v163, v192, v192
    v_mfma_f32_16x16x32_bf16 v[218:221], a[32:35], v[118:121], v[218:221]
    v_fmac_f32 v163, v193, v193
    v_cvt_pk_bf16_f32 v164, v186, v187
    v_mfma_f32_16x16x32_bf16 v[218:221], a[36:39], v[134:137], v[218:221]
    v_mul_f32 v188, v255, v188
    v_mul_f32 v189, v255, v189
    v_mfma_f32_16x16x32_bf16 v[218:221], a[40:43], v[154:157], v[218:221]
    v_cvt_pk_bf16_f32 v165, v188, v189
    v_mul_f32 v142, v254, v142
    v_mfma_f32_16x16x32_bf16 v[218:221], a[44:47], v[198:201], v[218:221]
    v_mul_f32 v143, v254, v143
    v_cvt_pk_bf16_f32 v142, v142, v143
    v_mfma_f32_16x16x32_bf16 v[138:141], a[48:51], v[150:153], 0
    v_mul_f32 v144, v254, v144
    v_mul_f32 v145, v254, v145
    v_mfma_f32_16x16x32_bf16 v[138:141], a[52:55], v[166:169], v[138:141]
    v_cvt_pk_bf16_f32 v143, v144, v145
    v_mul_f32 v158, v254, v158
    v_mfma_f32_16x16x32_bf16 v[138:141], a[56:59], v[118:121], v[138:141]
    v_fmac_f32 v163, v218, v218
    v_fmac_f32 v163, v219, v219
    v_mfma_f32_16x16x32_bf16 v[138:141], a[60:63], v[134:137], v[138:141]
    ds_read2_b32 v[196:197], v6 offset0:0 offset1:0
    ds_read2_b32 v[216:217], v6 offset0:16 offset1:16
    v_mfma_f32_16x16x32_bf16 v[138:141], a[64:67], v[154:157], v[138:141]
    ds_read2_b32 v[232:233], v6 offset0:32 offset1:32
    v_fmac_f32 v163, v220, v220
    v_mfma_f32_16x16x32_bf16 v[138:141], a[68:71], v[198:201], v[138:141]
    v_fmac_f32 v163, v221, v221
    v_mul_f32 v159, v254, v159
    v_mfma_f32_16x16x32_bf16 v[146:149], v[150:153], a[144:147], 0
    v_cvt_pk_bf16_f32 v144, v158, v159
    v_mul_f32 v160, v254, v160
    v_mfma_f32_16x16x32_bf16 v[146:149], v[166:169], a[148:151], v[146:149]
    v_mul_f32 v161, v254, v161
    v_cvt_pk_bf16_f32 v145, v160, v161
    v_mfma_f32_16x16x32_bf16 v[146:149], v[118:121], a[152:155], v[146:149]
    v_fmac_f32 v163, v138, v138
    v_fmac_f32 v163, v139, v139
    v_mfma_f32_16x16x32_bf16 v[146:149], v[134:137], a[156:159], v[146:149]
    v_fmac_f32 v163, v140, v140
    v_fmac_f32 v163, v141, v141
    v_mfma_f32_16x16x32_bf16 v[146:149], v[154:157], a[160:163], v[146:149]
    v_cvt_pk_bf16_f32 v36, v163, v162
    v_mul_f32 v178, v254, v178
    v_mfma_f32_16x16x32_bf16 v[146:149], v[198:201], a[164:167], v[146:149]
    s_waitcnt lgkmcnt(1)
    v_mul_f32 v179, v254, v179
    v_cvt_pk_bf16_f32 v178, v178, v179
    v_mfma_f32_16x16x32_bf16 v[158:161], v[32:35], v[36:39], 0
    s_waitcnt lgkmcnt(0)
    buffer_store_dwordx2 v[164:165], v20, s[12:15], 0 offen nt
    v_mul_f32 v180, v254, v180
    v_mul_f32 v181, v254, v181
    v_mfma_f32_16x16x32_bf16 v[186:189], v[150:153], a[168:171], 0
    v_cvt_pk_bf16_f32 v194, v146, v147
    v_cvt_pk_bf16_f32 v195, v148, v149
    v_mfma_f32_16x16x32_bf16 v[186:189], v[166:169], a[172:175], v[186:189]
    v_rsq_f32 v159, v159
    v_mfma_f32_16x16x32_bf16 v[186:189], v[118:121], a[176:179], v[186:189]
    v_rsq_f32 v158, v158
    v_mfma_f32_16x16x32_bf16 v[186:189], v[134:137], a[180:183], v[186:189]
    v_mul_f32 v158, s31, v158
    v_mul_f32 v202, v159, v202
    v_mfma_f32_16x16x32_bf16 v[186:189], v[154:157], a[184:187], v[186:189]
    v_mul_f32 v203, v159, v203
    v_cvt_pk_f16_f32 v146, v202, v203
    v_mfma_f32_16x16x32_bf16 v[186:189], v[198:201], a[188:191], v[186:189]
    v_mul_f32 v204, v159, v204
    v_mul_f32 v205, v159, v205
    v_mfma_f32_16x16x32_bf16 v[162:165], v[150:153], a[192:195], 0
    v_cvt_pk_f16_f32 v147, v204, v205
    v_mul_f32 v126, v159, v126
    v_mfma_f32_16x16x32_bf16 v[162:165], v[166:169], a[196:199], v[162:165]
    ds_read_b128 v[150:153], v5 offset:0
    ds_read_b128 v[202:205], v5 offset:16
    v_mfma_f32_16x16x32_bf16 v[162:165], v[118:121], a[200:203], v[162:165]
    ds_read_b128 v[118:121], v5 offset:48
    ds_read_b32 v254, v6 offset:192
    v_mfma_f32_16x16x32_bf16 v[162:165], v[134:137], a[204:207], v[162:165]
    v_cvt_pk_bf16_f32 v214, v186, v187
    v_cvt_pk_bf16_f32 v215, v188, v189
    v_mfma_f32_16x16x32_bf16 v[162:165], v[154:157], a[208:211], v[162:165]
    v_mul_f32 v127, v159, v127
    v_cvt_pk_f16_f32 v148, v126, v127
    v_mfma_f32_16x16x32_bf16 v[162:165], v[198:201], a[212:215], v[162:165]
    ds_read_b128 v[198:201], v2 offset:0
    ds_read_b128 v[186:189], v2 offset:1024
    v_mfma_f32_16x16x32_f16 v[134:137], v[226:229], v[222:225], v[50:53]
    ds_read_b128 v[154:157], v2 offset:2048
    v_mul_f32 v128, v159, v128
    v_mul_f32 v129, v159, v129
    v_mfma_f32_16x16x16_f16 v[210:213], v[184:185], v[182:183], v[210:213]
    v_cvt_pk_f16_f32 v149, v128, v129
    v_cvt_pk_bf16_f32 v230, v162, v163
    v_cvt_pk_bf16_f32 v231, v164, v165
    v_mul_f32 v174, v159, v174
    v_mfma_f32_16x16x32_f16 v[126:129], v[146:149], v[222:225], v[54:57]
    s_waitcnt lgkmcnt(5)
    v_mul_f32 v175, v159, v175
    v_cvt_pk_f16_f32 v164, v174, v175
    v_mul_f32 v176, v159, v176
    v_mfma_f32_16x16x16_f16 v[134:137], v[124:125], v[182:183], v[134:137]
    v_mul_f32 v177, v159, v177
    v_cvt_pk_f16_f32 v165, v176, v177
    v_mul_f32 v190, v158, v190
    v_mul_f32 v191, v158, v191
    v_mfma_f32_16x16x16_f16 v[126:129], v[164:165], v[182:183], v[126:129]
    v_cvt_pk_f16_f32 v174, v190, v191
    v_mul_f32 v192, v158, v192
    v_mul_f32 v193, v158, v193
    v_cvt_pk_f16_f32 v175, v192, v193
    v_mfma_f32_16x16x32_f16 v[166:169], v[150:153], v[222:225], v[22:25]
    s_waitcnt lgkmcnt(2)
    ds_read_b128 v[222:225], v2 offset:3072
    buffer_store_dwordx4 v[142:145], v16, s[12:15], 0 offen nt
    ds_read_b128 v[234:237], v2 offset:4096
    v_mul_f32 v218, v158, v218
    v_mul_f32 v219, v158, v219
    v_cvt_pk_f16_f32 v176, v218, v219
    v_mfma_f32_16x16x32_f16 v[166:169], v[202:205], v[242:245], v[166:169]
    s_waitcnt lgkmcnt(2)
    v_mul_f32 v220, v158, v220
    v_mul_f32 v221, v158, v221
    v_mfma_f32_16x16x32_f16 v[166:169], v[118:121], v[182:185], v[166:169]
    ds_read_b128 v[142:145], v2 offset:5120
    v_cvt_pk_f16_f32 v177, v220, v221
    v_mul_f32 v138, v158, v138
    v_mul_f32 v139, v158, v139
    v_cvt_pk_f16_f32 v162, v138, v139
    v_mfma_f32_16x16x32_f16 v[218:221], v[150:153], v[206:209], v[24:27]
    v_mul_f32 v140, v158, v140
    v_mul_f32 v141, v158, v141
    v_mfma_f32_16x16x32_f16 v[218:221], v[202:205], v[226:229], v[218:221]
    v_mov_b32_dpp v254, v167 quad_perm:[0,1,2,3] row_mask:0x1 bank_mask:0xf
    v_cvt_pk_f16_f32 v163, v140, v141
    v_mfma_f32_16x16x32_f16 v[218:221], v[118:121], v[122:125], v[218:221]
    v_max3_f32 v255, v166, v210, v211
    v_max3_f32 v255, v255, v212, v213
    v_mfma_f32_16x16x32_f16 v[238:241], v[150:153], v[174:177], v[26:29]
    s_waitcnt lgkmcnt(1)
    v_max3_f32 v255, v255, v134, v135
    v_max3_f32 v255, v255, v136, v137
    v_mfma_f32_16x16x32_f16 v[238:241], v[202:205], v[146:149], v[238:241]
    v_max3_f32 v255, v255, v126, v127
    v_mov_b32_dpp v254, v219 quad_perm:[0,1,2,3] row_mask:0x2 bank_mask:0xf
    v_mfma_f32_16x16x32_f16 v[238:241], v[118:121], v[162:165], v[238:241]
    v_max3_f32 v255, v255, v128, v129
    v_mov_b32 v182, v255
    v_mfma_f32_16x16x32_bf16 v[150:153], a[216:219], v[198:201], 0
    s_waitcnt lgkmcnt(0)
    v_permlane32_swap_b32 v255, v182
    v_mfma_f32_16x16x32_bf16 v[150:153], a[220:223], v[186:189], v[150:153]
    v_max_f32 v255, v255, v182
    v_mov_b32 v182, v255
    v_mfma_f32_16x16x32_bf16 v[150:153], a[224:227], v[154:157], v[150:153]
    v_cvt_pk_bf16_f32 v179, v180, v181
    v_xor_b32 v0, 65536, v0
    v_mfma_f32_16x16x32_bf16 v[150:153], a[228:231], v[222:225], v[150:153]
    s_waitcnt vmcnt(5)
    v_permlane16_swap_b32 v255, v182
    v_mfma_f32_16x16x32_bf16 v[150:153], a[232:235], v[234:237], v[150:153]
    s_nop 0
    v_max_f32 v255, v255, v182
    v_sub_f32 v210, v210, v255
    v_mfma_f32_16x16x32_bf16 v[150:153], a[236:239], v[142:145], v[150:153]
    s_barrier
    v_exp_f32 v210, v210
    v_mfma_f32_16x16x32_bf16 v[190:193], a[240:243], v[198:201], 0
    s_nop 0
    v_sub_f32 v211, v211, v255
    v_sub_f32 v212, v212, v255
    v_mfma_f32_16x16x32_bf16 v[190:193], a[244:247], v[186:189], v[190:193]
    s_nop 0
    buffer_load_dwordx4 v10, s[8:11], 0 offen nt lds
    v_sub_f32 v213, v213, v255
    v_mfma_f32_16x16x32_bf16 v[190:193], a[248:251], v[154:157], v[190:193]
    s_add_u32 m0, s28, 4096
    v_exp_f32 v211, v211
    v_mfma_f32_16x16x32_bf16 v[190:193], a[252:255], v[222:225], v[190:193]
    v_cvt_pk_bf16_f32 v158, v210, v211
    v_sub_f32 v134, v134, v255
    v_mfma_f32_16x16x32_bf16 v[190:193], v[82:85], v[234:237], v[190:193]
    v_exp_f32 v212, v212
    v_mfma_f32_16x16x32_bf16 v[190:193], v[86:89], v[142:145], v[190:193]
    v_exp_f32 v213, v213
    v_mfma_f32_16x16x32_bf16 v[202:205], v[90:93], v[198:201], 0
    ds_read_b128 v[198:201], v2 offset:6144
    buffer_load_dwordx4 v11, s[8:11], 0 offen nt lds
    v_mfma_f32_16x16x32_bf16 v[202:205], v[94:97], v[186:189], v[202:205]
    s_add_u32 m0, s28, 8192
    ds_read_b128 v[138:141], v2 offset:7168
    v_cvt_pk_bf16_f32 v159, v212, v213
    v_mfma_f32_16x16x32_bf16 v[202:205], v[98:101], v[154:157], v[202:205]
    ds_read_b128 v[210:213], v2 offset:8192
    v_sub_f32 v135, v135, v255
    v_mfma_f32_16x16x32_bf16 v[202:205], v[102:105], v[222:225], v[202:205]
    ds_read_b128 v[186:189], v2 offset:9216
    v_sub_f32 v136, v136, v255
    v_mfma_f32_16x16x32_bf16 v[202:205], v[106:109], v[234:237], v[202:205]
    ds_read_b128 v[222:225], v2 offset:10240
    v_sub_f32 v137, v137, v255
    v_mfma_f32_16x16x32_bf16 v[202:205], v[110:113], v[142:145], v[202:205]
    ds_read_b128 v[154:157], v2 offset:11264
    buffer_load_dwordx4 v12, s[8:11], 0 offen nt lds
    v_exp_f32 v134, v134
    v_mfma_f32_16x16x32_f16 v[118:121], v[242:245], v[206:209], v[58:61]
    s_add_u32 m0, s28, 12288
    v_exp_f32 v135, v135
    v_exp_f32 v136, v136
    v_cvt_pk_bf16_f32 v160, v134, v135
    v_exp_f32 v137, v137
    v_sub_f32 v126, v126, v255
    v_mfma_f32_16x16x16_f16 v[118:121], v[184:185], v[122:123], v[118:121]
    v_cvt_pk_bf16_f32 v161, v136, v137
    v_exp_f32 v126, v126
    v_sub_f32 v127, v127, v255
    v_mfma_f32_16x16x32_f16 v[134:137], v[226:229], v[206:209], v[62:65]
    s_xor_b32 s28, s28, 65536
    buffer_load_dwordx4 v13, s[8:11], 0 offen nt lds
    v_exp_f32 v127, v127
    v_sub_f32 v128, v128, v255
    v_cvt_pk_bf16_f32 v36, v126, v127
    v_exp_f32 v128, v128
    v_mfma_f32_16x16x16_f16 v[134:137], v[124:125], v[122:123], v[134:137]
    v_sub_f32 v129, v129, v255
    v_exp_f32 v129, v129
    v_sub_f32 v166, v166, v255
    v_cvt_pk_bf16_f32 v37, v128, v129
    v_mfma_f32_16x16x32_f16 v[126:129], v[146:149], v[206:209], v[66:69]
    s_waitcnt lgkmcnt(0)
    v_exp_f32 v166, v166
    v_mfma_f32_16x16x32_bf16 v[142:145], a[216:219], v[198:201], 0
    s_mov_b32 m0, s29
    v_cvt_pk_bf16_f32 v39, v166, 0
    v_max3_f32 v255, v218, v118, v119
    v_max3_f32 v255, v255, v120, v121
    v_mfma_f32_16x16x16_f16 v[126:129], v[164:165], v[122:123], v[126:129]
    v_max3_f32 v255, v255, v134, v135
    v_max3_f32 v255, v255, v136, v137
    v_xor_b32 v1, 65536, v1
    v_mov_b32_dpp v254, v239 quad_perm:[0,1,2,3] row_mask:0x4 bank_mask:0xf
    v_mfma_f32_16x16x32_bf16 v[206:209], v[28:31], v[36:39], 0
    s_xor_b32 s29, s29, s30
    buffer_store_dwordx2 v[178:179], v19, s[12:15], 0 offen nt
    v_mov_b32 v122, v254
    v_max3_f32 v255, v255, v126, v127
    v_mfma_f32_16x16x32_bf16 v[206:209], v[28:31], v[158:161], v[206:209]
    s_add_u32 s19, s19, s20
    v_max3_f32 v255, v255, v128, v129
    v_mov_b32 v123, v255
    v_mfma_f32_16x16x32_bf16 v[142:145], a[220:223], v[138:141], v[142:145]
    s_add_u32 s23, s23, s21
    v_permlane32_swap_b32 v255, v123
    v_mfma_f32_16x16x32_bf16 v[142:145], a[224:227], v[210:213], v[142:145]
    s_cmp_ge_u32 s19, 72
    v_rcp_f32 v206, v206
    v_mfma_f32_16x16x32_bf16 v[142:145], a[228:231], v[186:189], v[142:145]
    s_cselect_b32 s34, 72, 0
    v_max_f32 v255, v255, v123
    v_mov_b32 v123, v255
    v_mfma_f32_16x16x32_bf16 v[142:145], a[232:235], v[222:225], v[142:145]
    s_cselect_b32 s35, s22, 0
    v_permlane16_swap_b32 v255, v123
    v_mfma_f32_16x16x32_bf16 v[142:145], a[236:239], v[154:157], v[142:145]
    s_sub_u32 s19, s19, s34
    v_max_f32 v255, v255, v123
    v_sub_f32 v118, v118, v255
    v_mfma_f32_16x16x32_bf16 v[178:181], v[194:197], v[36:39], 0
    s_add_u32 s23, s23, s35
    v_exp_f32 v118, v118
    v_mfma_f32_16x16x32_bf16 v[178:181], v[170:173], v[158:161], v[178:181]
    s_add_u32 s18, s18, 1
    v_sub_f32 v119, v119, v255
    v_exp_f32 v119, v119
    v_sub_f32 v120, v120, v255
    v_cvt_pk_bf16_f32 v118, v118, v119
    v_exp_f32 v120, v120
    v_sub_f32 v121, v121, v255
    v_exp_f32 v121, v121
    v_mul_f32 v178, v206, v178
    v_mul_f32 v179, v206, v179
    v_cvt_pk_bf16_f32 v178, v178, v179
    v_mul_f32 v180, v206, v180
    v_mul_f32 v181, v206, v181
    v_cvt_pk_bf16_f32 v179, v180, v181
    v_cvt_pk_bf16_f32 v119, v120, v121
    v_mfma_f32_16x16x32_bf16 v[166:169], v[214:217], v[36:39], 0
    s_cmp_lt_u32 s18, s45
    v_sub_f32 v134, v134, v255
    v_sub_f32 v135, v135, v255
    v_mfma_f32_16x16x32_bf16 v[166:169], v[130:133], v[158:161], v[166:169]
    v_exp_f32 v134, v134
    v_exp_f32 v135, v135
    v_sub_f32 v136, v136, v255
    v_cvt_pk_bf16_f32 v120, v134, v135
    v_exp_f32 v136, v136
    v_sub_f32 v137, v137, v255
    v_exp_f32 v137, v137
    v_sub_f32 v126, v126, v255
    v_mul_f32 v166, v206, v166
    v_mul_f32 v167, v206, v167
    v_cvt_pk_bf16_f32 v180, v166, v167
    v_mul_f32 v168, v206, v168
    v_mul_f32 v169, v206, v169
    v_cvt_pk_bf16_f32 v181, v168, v169
    v_cvt_pk_bf16_f32 v121, v136, v137
    v_mfma_f32_16x16x32_bf16 v[134:137], v[230:233], v[36:39], 0
    buffer_load_dwordx4 v14, s[8:11], 0 offen nt lds
    v_sub_f32 v127, v127, v255
    v_mfma_f32_16x16x32_bf16 v[134:137], v[114:117], v[158:161], v[134:137]
    ds_write_b128 v3, v[178:181] offset:0
    v_mfma_f32_16x16x32_bf16 v[158:161], a[240:243], v[198:201], 0
    v_exp_f32 v126, v126
    v_mfma_f32_16x16x32_bf16 v[158:161], a[244:247], v[138:141], v[158:161]
    v_exp_f32 v127, v127
    v_mfma_f32_16x16x32_bf16 v[158:161], a[248:251], v[210:213], v[158:161]
    v_cvt_pk_bf16_f32 v36, v126, v127
    v_sub_f32 v128, v128, v255
    v_mfma_f32_16x16x32_bf16 v[158:161], a[252:255], v[186:189], v[158:161]
    v_mul_f32 v134, v206, v134
    v_mul_f32 v135, v206, v135
    v_mfma_f32_16x16x32_bf16 v[158:161], v[82:85], v[222:225], v[158:161]
    v_cvt_pk_bf16_f32 v126, v134, v135
    v_mul_f32 v136, v206, v136
    v_mfma_f32_16x16x32_bf16 v[158:161], v[86:89], v[154:157], v[158:161]
    v_mul_f32 v137, v206, v137
    v_cvt_pk_bf16_f32 v127, v136, v137
    v_mfma_f32_16x16x32_bf16 v[178:181], v[90:93], v[198:201], 0
    ds_read_b128 v[198:201], v2 offset:12288
    v_sub_f32 v129, v129, v255
    v_mfma_f32_16x16x32_bf16 v[178:181], v[94:97], v[138:141], v[178:181]
    ds_read_b128 v[206:209], v2 offset:13312
    v_sub_f32 v218, v218, v255
    v_mfma_f32_16x16x32_bf16 v[178:181], v[98:101], v[210:213], v[178:181]
    ds_read_b128 v[210:213], v2 offset:14336
    v_max_f32_dpp v122, v122, v122 quad_perm:[1,0,3,2] row_mask:0xf bank_mask:0xf
    v_mfma_f32_16x16x32_bf16 v[178:181], v[102:105], v[186:189], v[178:181]
    ds_read_b128 v[134:137], v2 offset:15360
    v_max_f32_dpp v122, v122, v122 quad_perm:[2,3,0,1] row_mask:0xf bank_mask:0xf
    v_mfma_f32_16x16x32_bf16 v[178:181], v[106:109], v[222:225], v[178:181]
    ds_read_b128 v[222:225], v2 offset:16384
    v_max_f32_dpp v122, v122, v122 row_half_mirror row_mask:0xf bank_mask:0xf
    v_mfma_f32_16x16x32_bf16 v[178:181], v[110:113], v[154:157], v[178:181]
    ds_read_b128 v[154:157], v2 offset:17408
    ds_write_b64 v4, v[126:127] offset:4096
    v_exp_f32 v128, v128
    v_exp_f32 v129, v129
    v_mfma_f32_16x16x32_f16 v[186:189], v[242:245], v[174:177], v[70:73]
    s_waitcnt lgkmcnt(6)
    v_cvt_pk_bf16_f32 v37, v128, v129
    v_max_f32_dpp v122, v122, v122 row_mirror row_mask:0xf bank_mask:0xf
    v_mfma_f32_16x16x32_f16 v[242:245], v[226:229], v[174:177], v[74:77]
    s_waitcnt lgkmcnt(5)
    v_exp_f32 v218, v218
    v_mfma_f32_16x16x32_f16 v[126:129], v[146:149], v[174:177], v[78:81]
    s_waitcnt lgkmcnt(4)
    v_cvt_pk_bf16_f32 v39, v218, 0
    v_mov_b32 v123, v122
    v_fma_f32 v255, v150, v150, s33
    v_mfma_f32_16x16x32_bf16 v[174:177], v[28:31], v[36:39], 0
    s_waitcnt lgkmcnt(3)
    v_permlane32_swap_b32 v122, v123
    v_mfma_f32_16x16x32_bf16 v[174:177], v[28:31], v[118:121], v[174:177]
    s_waitcnt lgkmcnt(2)
    v_max_f32 v122, v122, v123
    v_mov_b32 v123, v122
    v_mfma_f32_16x16x32_bf16 v[226:229], v[194:197], v[36:39], 0
    s_waitcnt lgkmcnt(0)
    v_permlane16_swap_b32 v122, v123
    v_mfma_f32_16x16x32_bf16 v[226:229], v[170:173], v[118:121], v[226:229]
    v_max_f32 v122, v122, v123
    v_sub_f32 v254, v254, v122
    v_mfma_f32_16x16x32_bf16 v[218:221], v[214:217], v[36:39], 0
    v_exp_f32 v254, v254
    v_mfma_f32_16x16x32_bf16 v[218:221], v[130:133], v[118:121], v[218:221]
    v_cvt_pk_bf16_f32 v254, v254, v254
    v_fmac_f32 v255, v151, v151
    v_mfma_f32_16x16x32_bf16 v[166:169], v[230:233], v[36:39], 0
    ds_write_b16 v8, v254
    v_mfma_f32_16x16x32_bf16 v[166:169], v[114:117], v[118:121], v[166:169]
    v_rcp_f32 v174, v174
    v_fmac_f32 v255, v152, v152
    v_mfma_f32_16x16x16_f16 v[186:189], v[184:185], v[162:163], v[186:189]
    v_mul_f32 v226, v174, v226
    v_mul_f32 v227, v174, v227
    v_cvt_pk_bf16_f32 v122, v226, v227
    v_mfma_f32_16x16x16_f16 v[242:245], v[124:125], v[162:163], v[242:245]
    v_mul_f32 v228, v174, v228
    v_mul_f32 v229, v174, v229
    v_cvt_pk_bf16_f32 v123, v228, v229
    v_mfma_f32_16x16x16_f16 v[126:129], v[164:165], v[162:163], v[126:129]
    v_max3_f32 v254, v238, v186, v187
    v_max3_f32 v254, v254, v188, v189
    v_mul_f32 v218, v174, v218
    v_mul_f32 v219, v174, v219
    v_mfma_f32_16x16x32_bf16 v[146:149], a[216:219], v[198:201], 0
    ds_read_b128 v[118:121], v9
    ds_read_b128 v[162:165], v9 offset:64
    v_mfma_f32_16x16x32_bf16 v[146:149], a[220:223], v[206:209], v[146:149]
    v_max3_f32 v254, v254, v242, v243
    v_max3_f32 v254, v254, v244, v245
    v_mfma_f32_16x16x32_bf16 v[146:149], a[224:227], v[210:213], v[146:149]
    v_max3_f32 v254, v254, v126, v127
    v_max3_f32 v254, v254, v128, v129
    v_mfma_f32_16x16x32_bf16 v[146:149], a[228:231], v[134:137], v[146:149]
    v_mov_b32 v125, v254
    v_cvt_pk_bf16_f32 v124, v218, v219
    v_mfma_f32_16x16x32_bf16 v[146:149], a[232:235], v[222:225], v[146:149]
    v_permlane32_swap_b32 v254, v125
    v_mfma_f32_16x16x32_bf16 v[146:149], a[236:239], v[154:157], v[146:149]
    v_max_f32 v254, v254, v125
    v_mov_b32 v125, v254
    v_mfma_f32_16x16x32_bf16 v[138:141], a[240:243], v[198:201], 0
    v_mul_f32 v220, v174, v220
    v_mul_f32 v221, v174, v221
    v_mfma_f32_16x16x32_bf16 v[138:141], a[244:247], v[206:209], v[138:141]
    v_permlane16_swap_b32 v254, v125
    v_mfma_f32_16x16x32_bf16 v[138:141], a[248:251], v[210:213], v[138:141]
    s_waitcnt lgkmcnt(0)
    v_max_f32 v254, v254, v125
    v_sub_f32 v186, v186, v254
    v_mfma_f32_16x16x32_bf16 v[138:141], a[252:255], v[134:137], v[138:141]
    v_exp_f32 v186, v186
    v_mfma_f32_16x16x32_bf16 v[138:141], v[82:85], v[222:225], v[138:141]
    v_sub_f32 v187, v187, v254
    v_sub_f32 v188, v188, v254
    v_mfma_f32_16x16x32_bf16 v[138:141], v[86:89], v[154:157], v[138:141]
    v_exp_f32 v187, v187
    v_exp_f32 v188, v188
    v_cvt_pk_bf16_f32 v234, v186, v187
    v_sub_f32 v189, v189, v254
    v_exp_f32 v189, v189
    v_sub_f32 v242, v242, v254
    v_cvt_pk_bf16_f32 v235, v188, v189
    v_exp_f32 v242, v242
    v_sub_f32 v243, v243, v254
    v_exp_f32 v243, v243
    v_sub_f32 v244, v244, v254
    v_cvt_pk_bf16_f32 v236, v242, v243
    v_mfma_f32_16x16x32_bf16 v[186:189], v[90:93], v[198:201], 0
    v_exp_f32 v244, v244
    v_mfma_f32_16x16x32_bf16 v[186:189], v[94:97], v[206:209], v[186:189]
    v_sub_f32 v245, v245, v254
    v_sub_f32 v126, v126, v254
    v_mfma_f32_16x16x32_bf16 v[186:189], v[98:101], v[210:213], v[186:189]
    v_exp_f32 v245, v245
    v_mfma_f32_16x16x32_bf16 v[186:189], v[102:105], v[134:137], v[186:189]
    v_cvt_pk_bf16_f32 v237, v244, v245
    v_sub_f32 v127, v127, v254
    v_mfma_f32_16x16x32_bf16 v[186:189], v[106:109], v[222:225], v[186:189]
    v_exp_f32 v126, v126
    v_mfma_f32_16x16x32_bf16 v[186:189], v[110:113], v[154:157], v[186:189]
    ds_read_b128 v[182:185], v0 offset:20480
    ds_read_b128 v[198:201], v1 offset:20480
    v_mfma_f32_16x16x32_bf16 v[206:209], v[118:121], v[28:31], 0
    ds_read_b128 v[210:213], v0 offset:20608
    ds_read_b128 v[222:225], v1 offset:20608
    v_mfma_f32_16x16x32_bf16 v[206:209], v[162:165], v[28:31], v[206:209]
    v_exp_f32 v127, v127
    v_mfma_f32_16x16x32_bf16 v[154:157], v[118:121], v[170:173], 0
    ds_read_b128 v[226:229], v0 offset:20736
    v_cvt_pk_bf16_f32 v36, v126, v127
    v_mfma_f32_16x16x32_bf16 v[154:157], v[162:165], v[194:197], v[154:157]
    ds_read_b128 v[242:245], v1 offset:20736
    v_sub_f32 v128, v128, v254
    v_exp_f32 v128, v128
    v_sub_f32 v129, v129, v254
    v_exp_f32 v129, v129
    v_sub_f32 v238, v238, v254
    v_cvt_pk_bf16_f32 v37, v128, v129
    v_mfma_f32_16x16x32_bf16 v[134:137], v[118:121], v[130:133], 0
    v_exp_f32 v238, v238
    v_mfma_f32_16x16x32_bf16 v[134:137], v[162:165], v[214:217], v[134:137]
    s_waitcnt lgkmcnt(4)
    v_cvt_pk_bf16_f32 v39, v238, 0
    v_cvt_pk_bf16_f32 v125, v220, v221
    v_mfma_f32_16x16x32_bf16 v[218:221], v[118:121], v[114:117], 0
    s_waitcnt lgkmcnt(2)
    ds_write_b128 v3, v[122:125] offset:6144
    v_mfma_f32_16x16x32_bf16 v[126:129], v[28:31], v[36:39], 0
    s_waitcnt lgkmcnt(2)
    v_mul_f32 v166, v174, v166
    v_mul_f32 v167, v174, v167
    v_mfma_f32_16x16x32_bf16 v[126:129], v[28:31], v[234:237], v[126:129]
    s_waitcnt lgkmcnt(1)
    v_cvt_pk_bf16_f32 v166, v166, v167
    v_mul_f32 v168, v174, v168
    v_mfma_f32_16x16x32_bf16 v[122:125], v[194:197], v[36:39], 0
    v_mul_f32 v169, v174, v169
    v_cvt_pk_bf16_f32 v167, v168, v169
    v_mfma_f32_16x16x32_bf16 v[122:125], v[170:173], v[234:237], v[122:125]
    ds_write_b64 v4, v[166:167] offset:10240
    v_mfma_f32_16x16x32_bf16 v[170:173], v[214:217], v[36:39], 0
    v_rcp_f32 v126, v126
    v_mfma_f32_16x16x32_bf16 v[170:173], v[130:133], v[234:237], v[170:173]
    v_fma_f32 v254, v146, v146, s33
    v_fmac_f32 v254, v147, v147
    v_mfma_f32_16x16x32_bf16 v[174:177], v[230:233], v[36:39], 0
    v_fmac_f32 v254, v148, v148
    v_mul_f32 v122, v126, v122
    v_mfma_f32_16x16x32_bf16 v[174:177], v[114:117], v[234:237], v[174:177]
    v_mul_f32 v123, v126, v123
    v_cvt_pk_bf16_f32 v122, v122, v123
    v_mfma_f32_16x16x32_bf16 v[218:221], v[162:165], v[230:233], v[218:221]
    v_mul_f32 v124, v126, v124
    v_mul_f32 v125, v126, v125
    v_mfma_f32_16x16x32_bf16 v[114:117], a[72:75], v[182:185], 0
    v_cvt_pk_bf16_f32 v123, v124, v125
    v_mul_f32 v170, v126, v170
    v_mfma_f32_16x16x32_bf16 v[114:117], a[76:79], v[198:201], v[114:117]
    v_mul_f32 v171, v126, v171
    v_cvt_pk_bf16_f32 v124, v170, v171
    v_mfma_f32_16x16x32_bf16 v[114:117], a[80:83], v[210:213], v[114:117]
    v_mul_f32 v172, v126, v172
    v_mul_f32 v173, v126, v173
    v_mfma_f32_16x16x32_bf16 v[114:117], a[84:87], v[222:225], v[114:117]
    v_cvt_pk_bf16_f32 v125, v172, v173
    v_mul_f32 v174, v126, v174
    v_mfma_f32_16x16x32_bf16 v[114:117], a[88:91], v[226:229], v[114:117]
    ds_write_b128 v3, v[122:125] offset:12288
    v_mfma_f32_16x16x32_bf16 v[114:117], a[92:95], v[242:245], v[114:117]
    v_mul_f32 v175, v126, v175
    v_cvt_pk_bf16_f32 v174, v174, v175
    v_mfma_f32_16x16x32_bf16 v[122:125], a[96:99], v[182:185], 0
    v_mul_f32 v176, v126, v176
    v_mul_f32 v177, v126, v177
    v_mfma_f32_16x16x32_bf16 v[122:125], a[100:103], v[198:201], v[122:125]
    v_cvt_pk_bf16_f32 v175, v176, v177
    v_fmac_f32 v254, v149, v149
    v_mfma_f32_16x16x32_bf16 v[122:125], a[104:107], v[210:213], v[122:125]
    ds_write_b64 v4, v[174:175] offset:16384
    v_mfma_f32_16x16x32_bf16 v[122:125], a[108:111], v[222:225], v[122:125]
    v_fmac_f32 v254, v138, v138
    v_fmac_f32 v254, v139, v139
    v_mfma_f32_16x16x32_bf16 v[122:125], a[112:115], v[226:229], v[122:125]
    v_fmac_f32 v254, v140, v140
    v_fmac_f32 v254, v141, v141
    v_mfma_f32_16x16x32_bf16 v[122:125], a[116:119], v[242:245], v[122:125]
    v_fmac_f32 v254, v186, v186
    v_fmac_f32 v254, v187, v187
    v_mfma_f32_16x16x32_bf16 v[126:129], a[120:123], v[182:185], 0
    v_fmac_f32 v254, v188, v188
    v_fmac_f32 v254, v189, v189
    v_mfma_f32_16x16x32_bf16 v[126:129], a[124:127], v[198:201], v[126:129]
    v_cvt_pk_bf16_f32 v155, v254, v254
    v_fmac_f32 v255, v153, v153
    v_mfma_f32_16x16x32_bf16 v[126:129], a[128:131], v[210:213], v[126:129]
    v_rcp_f32 v206, v206
    v_mfma_f32_16x16x32_bf16 v[126:129], a[132:135], v[222:225], v[126:129]
    v_mul_f32 v154, v154, v206
    v_mul_f32_dpp v154, v134, v206 quad_perm:[0,1,2,3] row_mask:0x2 bank_mask:0xf
    v_mfma_f32_16x16x32_bf16 v[126:129], a[136:139], v[226:229], v[126:129]
    v_mul_f32_dpp v154, v218, v206 quad_perm:[0,1,2,3] row_mask:0x4 bank_mask:0xf
    v_cvt_pk_bf16_f32 v154, v154, v154
    v_mfma_f32_16x16x32_bf16 v[126:129], a[140:143], v[242:245], v[126:129]
    ds_write_b16 v7, v154
    v_mfma_f32_16x16x32_bf16 v[206:209], a[0:3], v[182:185], 0
    v_fmac_f32 v255, v190, v190
    v_fmac_f32 v255, v191, v191
    v_mfma_f32_16x16x32_bf16 v[206:209], a[4:7], v[198:201], v[206:209]
    v_fmac_f32 v255, v192, v192
    v_fmac_f32 v255, v193, v193
    v_mfma_f32_16x16x32_bf16 v[206:209], a[8:11], v[210:213], v[206:209]
    v_fmac_f32 v255, v202, v202
    v_fmac_f32 v255, v203, v203
    v_mfma_f32_16x16x32_bf16 v[206:209], a[12:15], v[222:225], v[206:209]
    v_fmac_f32 v255, v204, v204
    v_fmac_f32 v255, v205, v205
    v_mfma_f32_16x16x32_bf16 v[206:209], a[16:19], v[226:229], v[206:209]
    v_fma_f32 v254, v142, v142, s33
    v_fmac_f32 v254, v143, v143
    v_mfma_f32_16x16x32_bf16 v[206:209], a[20:23], v[242:245], v[206:209]
    v_fmac_f32 v254, v144, v144
    v_fmac_f32 v254, v145, v145
    v_mfma_f32_16x16x32_bf16 v[174:177], a[24:27], v[182:185], 0
    v_fmac_f32 v254, v158, v158
    v_fmac_f32 v254, v159, v159
    v_mfma_f32_16x16x32_bf16 v[174:177], a[28:31], v[198:201], v[174:177]
    v_fmac_f32 v254, v160, v160
    v_fmac_f32 v254, v161, v161
    v_mfma_f32_16x16x32_bf16 v[174:177], a[32:35], v[210:213], v[174:177]
    v_fmac_f32 v254, v178, v178
    v_fmac_f32 v254, v179, v179
    v_mfma_f32_16x16x32_bf16 v[174:177], a[36:39], v[222:225], v[174:177]
    v_fmac_f32 v254, v180, v180
    v_fmac_f32 v254, v181, v181
    v_mfma_f32_16x16x32_bf16 v[174:177], a[40:43], v[226:229], v[174:177]
    v_cvt_pk_bf16_f32 v154, v255, v254
    v_add_u32 v5, 336, v5
    v_mfma_f32_16x16x32_bf16 v[174:177], a[44:47], v[242:245], v[174:177]
    ds_write_b64 v4, v[154:155] offset:18432
    v_mfma_f32_16x16x32_bf16 v[218:221], a[48:51], v[182:185], 0
    v_add_u32 v6, 272, v6
    v_add_u32 v7, 16, v7
    v_mfma_f32_16x16x32_bf16 v[218:221], a[52:55], v[198:201], v[218:221]
    v_fma_f32 v130, v114, v114, s32
    v_fmac_f32 v130, v115, v115
    v_mfma_f32_16x16x32_bf16 v[218:221], a[56:59], v[210:213], v[218:221]
    v_fmac_f32 v130, v116, v116
    v_fmac_f32 v130, v117, v117
    v_mfma_f32_16x16x32_bf16 v[218:221], a[60:63], v[222:225], v[218:221]
    v_fmac_f32 v130, v122, v122
    v_fmac_f32 v130, v123, v123
    v_mfma_f32_16x16x32_bf16 v[218:221], a[64:67], v[226:229], v[218:221]
    v_fmac_f32 v130, v124, v124
    v_fmac_f32 v130, v125, v125
    v_mfma_f32_16x16x32_bf16 v[218:221], a[68:71], v[242:245], v[218:221]
    v_fmac_f32 v130, v126, v126
    v_fmac_f32 v130, v127, v127
    v_mfma_f32_16x16x32_bf16 v[170:173], v[182:185], a[144:147], 0
    s_waitcnt lgkmcnt(0)
    v_fmac_f32 v130, v128, v128
    v_fmac_f32 v130, v129, v129
    v_mfma_f32_16x16x32_bf16 v[170:173], v[198:201], a[148:151], v[170:173]
    s_nop 0
    v_fma_f32 v131, v206, v206, s32
    v_fmac_f32 v131, v207, v207
    v_mfma_f32_16x16x32_bf16 v[170:173], v[210:213], a[152:155], v[170:173]
    s_barrier
    v_fmac_f32 v131, v208, v208
    v_fmac_f32 v131, v209, v209
    v_mfma_f32_16x16x32_bf16 v[170:173], v[222:225], a[156:159], v[170:173]
    s_nop 0
    v_fmac_f32 v131, v174, v174
    v_xor_b32 v2, 65536, v2
    v_mfma_f32_16x16x32_bf16 v[170:173], v[226:229], a[160:163], v[170:173]
    s_nop 0
    v_xor_b32 v3, 65536, v3
    v_xor_b32 v4, 65536, v4
    v_mfma_f32_16x16x32_bf16 v[170:173], v[242:245], a[164:167], v[170:173]
    s_cbranch_scc1 L_loop_safe1
    s_branch L_final_safe
.p2align 6
L_loop_safe2:
    v_mfma_f32_16x16x32_bf16 v[162:165], v[182:185], a[168:171], 0
    s_add_u32 s12, s42, s27
    ds_read_b128 v[194:197], v2 offset:18432
    ds_read_b128 v[230:233], v2 offset:19456
    v_mfma_f32_16x16x32_bf16 v[162:165], v[198:201], a[172:175], v[162:165]
    s_addc_u32 s13, s43, 0
    v_fmac_f32 v131, v175, v175
    v_fmac_f32 v131, v176, v176
    v_mfma_f32_16x16x32_bf16 v[162:165], v[210:213], a[176:179], v[162:165]
    s_sub_u32 s14, s36, s27
    v_fmac_f32 v131, v177, v177
    v_fmac_f32 v131, v218, v218
    v_mfma_f32_16x16x32_bf16 v[162:165], v[222:225], a[180:183], v[162:165]
    s_cmp_ge_u32 s18, 2
    v_fmac_f32 v131, v219, v219
    v_fmac_f32 v131, v220, v220
    v_mfma_f32_16x16x32_bf16 v[162:165], v[226:229], a[184:187], v[162:165]
    s_cselect_b32 s14, s14, 0
    ds_read_b128 v[118:121], v0 offset:26624
    v_fmac_f32 v131, v221, v221
    v_mfma_f32_16x16x32_bf16 v[162:165], v[242:245], a[188:191], v[162:165]
    s_add_u32 s34, s18, 2
    ds_read_b128 v[134:137], v1 offset:26624
    v_cvt_pk_bf16_f32 v36, v131, v130
    v_mfma_f32_16x16x32_bf16 v[214:217], v[182:185], a[192:195], 0
    s_add_u32 s8, s40, s23
    ds_read_b128 v[154:157], v0 offset:26752
    v_cvt_pk_bf16_f32 v170, v170, v171
    v_mfma_f32_16x16x32_bf16 v[214:217], v[198:201], a[196:199], v[214:217]
    s_addc_u32 s9, s41, 0
    ds_read_b128 v[198:201], v1 offset:26752
    v_cvt_pk_bf16_f32 v171, v172, v173
    v_mfma_f32_16x16x32_bf16 v[166:169], v[32:35], v[36:39], 0
    s_sub_u32 s10, s36, s23
    v_cvt_pk_bf16_f32 v130, v162, v163
    v_cvt_pk_bf16_f32 v131, v164, v165
    v_mfma_f32_16x16x32_bf16 v[214:217], v[210:213], a[200:203], v[214:217]
    s_waitcnt lgkmcnt(4)
    ds_read_b128 v[210:213], v0 offset:26880
    s_cmp_lt_u32 s34, s17
    v_mfma_f32_16x16x32_bf16 v[234:237], v[32:35], v[194:197], 0
    s_cselect_b32 s10, s10, 0
    v_rsq_f32 v167, v167
    v_mfma_f32_16x16x32_bf16 v[234:237], v[32:35], v[230:233], v[234:237]
    s_add_u32 m0, s28, 0
    v_rsq_f32 v166, v166
    v_mfma_f32_16x16x32_bf16 v[214:217], v[222:225], a[204:207], v[214:217]
    s_waitcnt lgkmcnt(4)
    ds_read_b128 v[162:165], v1 offset:26880
    v_mul_f32 v166, s31, v166
    v_mfma_f32_16x16x32_bf16 v[214:217], v[226:229], a[208:211], v[214:217]
    s_mov_b32 s27, s26
    v_mul_f32 v114, v167, v114
    v_mul_f32 v115, v167, v115
    v_mfma_f32_16x16x32_bf16 v[214:217], v[242:245], a[212:215], v[214:217]
    s_mov_b32 s26, s25
    v_cvt_pk_f16_f32 v242, v114, v115
    v_mul_f32 v116, v167, v116
    v_mfma_f32_16x16x32_bf16 v[226:229], a[72:75], v[118:121], 0
    s_waitcnt lgkmcnt(2)
    v_mul_f32 v117, v167, v117
    v_cvt_pk_f16_f32 v243, v116, v117
    v_mfma_f32_16x16x32_bf16 v[226:229], a[76:79], v[134:137], v[226:229]
    s_mov_b32 s25, s24
    v_cvt_pk_bf16_f32 v114, v214, v215
    v_cvt_pk_bf16_f32 v115, v216, v217
    v_mfma_f32_16x16x32_bf16 v[226:229], a[80:83], v[154:157], v[226:229]
    s_mov_b32 s24, s23
    v_mul_f32 v122, v167, v122
    v_mul_f32 v123, v167, v123
    v_mfma_f32_16x16x32_bf16 v[226:229], a[84:87], v[198:201], v[226:229]
    s_waitcnt lgkmcnt(1)
    v_cvt_pk_f16_f32 v244, v122, v123
    v_mul_f32 v124, v167, v124
    v_mfma_f32_16x16x32_bf16 v[226:229], a[88:91], v[210:213], v[226:229]
    v_mul_f32 v125, v167, v125
    v_cvt_pk_f16_f32 v245, v124, v125
    v_mfma_f32_16x16x32_bf16 v[122:125], a[96:99], v[118:121], 0
    s_waitcnt lgkmcnt(0)
    v_mul_f32 v126, v167, v126
    v_mul_f32 v127, v167, v127
    v_mfma_f32_16x16x32_bf16 v[226:229], a[92:95], v[162:165], v[226:229]
    v_cvt_pk_f16_f32 v184, v126, v127
    v_mul_f32 v128, v167, v128
    v_mfma_f32_16x16x32_bf16 v[122:125], a[100:103], v[134:137], v[122:125]
    v_mul_f32 v129, v167, v129
    v_cvt_pk_f16_f32 v185, v128, v129
    v_mfma_f32_16x16x32_bf16 v[122:125], a[104:107], v[154:157], v[122:125]
    v_mul_f32 v206, v166, v206
    v_mul_f32 v207, v166, v207
    v_mfma_f32_16x16x32_bf16 v[122:125], a[108:111], v[198:201], v[122:125]
    v_cvt_pk_f16_f32 v222, v206, v207
    v_mul_f32 v208, v166, v208
    v_mfma_f32_16x16x32_bf16 v[122:125], a[112:115], v[210:213], v[122:125]
    v_mul_f32 v209, v166, v209
    v_cvt_pk_f16_f32 v223, v208, v209
    v_mfma_f32_16x16x32_bf16 v[122:125], a[116:119], v[162:165], v[122:125]
    v_mul_f32 v174, v166, v174
    v_mul_f32 v175, v166, v175
    v_mfma_f32_16x16x32_bf16 v[126:129], a[120:123], v[118:121], 0
    v_cvt_pk_f16_f32 v224, v174, v175
    v_mul_f32 v176, v166, v176
    v_mfma_f32_16x16x32_bf16 v[126:129], a[124:127], v[134:137], v[126:129]
    v_mul_f32 v177, v166, v177
    v_cvt_pk_f16_f32 v225, v176, v177
    v_mfma_f32_16x16x32_bf16 v[126:129], a[128:131], v[154:157], v[126:129]
    v_mul_f32 v218, v166, v218
    v_mul_f32 v219, v166, v219
    v_mfma_f32_16x16x32_bf16 v[126:129], a[132:135], v[198:201], v[126:129]
    v_cvt_pk_f16_f32 v182, v218, v219
    v_mul_f32 v220, v166, v220
    v_mfma_f32_16x16x32_bf16 v[126:129], a[136:139], v[210:213], v[126:129]
    v_mul_f32 v221, v166, v221
    v_cvt_pk_f16_f32 v183, v220, v221
    v_mfma_f32_16x16x32_bf16 v[126:129], a[140:143], v[162:165], v[126:129]
    v_fma_f32 v116, v226, v226, s32
    v_fmac_f32 v116, v227, v227
    v_mfma_f32_16x16x32_bf16 v[206:209], a[0:3], v[118:121], 0
    v_fmac_f32 v116, v228, v228
    v_fmac_f32 v116, v229, v229
    v_mfma_f32_16x16x32_bf16 v[206:209], a[4:7], v[134:137], v[206:209]
    v_fmac_f32 v116, v122, v122
    v_fmac_f32 v116, v123, v123
    v_mfma_f32_16x16x32_bf16 v[206:209], a[8:11], v[154:157], v[206:209]
    v_fmac_f32 v116, v124, v124
    v_fmac_f32 v116, v125, v125
    v_mfma_f32_16x16x32_bf16 v[206:209], a[12:15], v[198:201], v[206:209]
    v_fmac_f32 v116, v126, v126
    v_fmac_f32 v116, v127, v127
    v_mfma_f32_16x16x32_bf16 v[206:209], a[16:19], v[210:213], v[206:209]
    v_fmac_f32 v116, v128, v128
    v_fmac_f32 v116, v129, v129
    v_mfma_f32_16x16x32_bf16 v[206:209], a[20:23], v[162:165], v[206:209]
    v_mul_f32 v117, 0x3baaaaab, v234
    v_mul_f32 v254, 0x3baaaaab, v235
    v_mfma_f32_16x16x32_bf16 v[174:177], a[24:27], v[118:121], 0
    v_rsq_f32 v117, v117
    v_mfma_f32_16x16x32_bf16 v[174:177], a[28:31], v[134:137], v[174:177]
    v_rsq_f32 v254, v254
    v_mfma_f32_16x16x32_bf16 v[174:177], a[32:35], v[154:157], v[174:177]
    v_mul_f32 v255, 0x3baaaaab, v236
    v_fma_f32 v132, v206, v206, s32
    v_mfma_f32_16x16x32_bf16 v[174:177], a[36:39], v[198:201], v[174:177]
    v_fmac_f32 v132, v207, v207
    v_fmac_f32 v132, v208, v208
    v_mfma_f32_16x16x32_bf16 v[174:177], a[40:43], v[210:213], v[174:177]
    v_fmac_f32 v132, v209, v209
    v_mul_f32 v150, v117, v150
    v_mfma_f32_16x16x32_bf16 v[174:177], a[44:47], v[162:165], v[174:177]
    v_rsq_f32 v255, v255
    v_mfma_f32_16x16x32_bf16 v[218:221], a[48:51], v[118:121], 0
    v_mul_f32 v151, v117, v151
    v_cvt_pk_bf16_f32 v194, v150, v151
    v_mfma_f32_16x16x32_bf16 v[218:221], a[52:55], v[134:137], v[218:221]
    v_mul_f32 v152, v117, v152
    v_mul_f32 v153, v117, v153
    v_mfma_f32_16x16x32_bf16 v[218:221], a[56:59], v[154:157], v[218:221]
    v_fmac_f32 v132, v174, v174
    v_fmac_f32 v132, v175, v175
    v_mfma_f32_16x16x32_bf16 v[218:221], a[60:63], v[198:201], v[218:221]
    v_fmac_f32 v132, v176, v176
    v_fmac_f32 v132, v177, v177
    v_mfma_f32_16x16x32_bf16 v[218:221], a[64:67], v[210:213], v[218:221]
    v_cvt_pk_bf16_f32 v195, v152, v153
    v_mul_f32 v190, v117, v190
    v_mfma_f32_16x16x32_bf16 v[218:221], a[68:71], v[162:165], v[218:221]
    v_mul_f32 v191, v117, v191
    v_cvt_pk_bf16_f32 v196, v190, v191
    v_mfma_f32_16x16x32_bf16 v[150:153], v[118:121], a[144:147], 0
    v_mul_f32 v192, v117, v192
    v_mul_f32 v193, v117, v193
    v_mfma_f32_16x16x32_bf16 v[150:153], v[134:137], a[148:151], v[150:153]
    v_cvt_pk_bf16_f32 v197, v192, v193
    v_mul_f32 v202, v117, v202
    v_mfma_f32_16x16x32_bf16 v[150:153], v[154:157], a[152:155], v[150:153]
    buffer_store_dwordx4 v[194:197], v15, s[12:15], 0 offen nt
    v_fmac_f32 v132, v218, v218
    v_fmac_f32 v132, v219, v219
    v_fmac_f32 v132, v220, v220
    v_fmac_f32 v132, v221, v221
    v_mfma_f32_16x16x32_bf16 v[150:153], v[198:201], a[156:159], v[150:153]
    v_cvt_pk_bf16_f32 v36, v132, v116
    v_mul_f32 v203, v117, v203
    v_mfma_f32_16x16x32_bf16 v[150:153], v[210:213], a[160:163], v[150:153]
    v_cvt_pk_bf16_f32 v116, v202, v203
    v_mul_f32 v204, v117, v204
    v_mfma_f32_16x16x32_bf16 v[190:193], v[32:35], v[36:39], 0
    v_mul_f32 v205, v117, v205
    v_cvt_pk_bf16_f32 v117, v204, v205
    v_mfma_f32_16x16x32_bf16 v[150:153], v[162:165], a[164:167], v[150:153]
    v_mul_f32 v146, v255, v146
    v_mul_f32 v147, v255, v147
    v_mfma_f32_16x16x32_bf16 v[202:205], v[118:121], a[168:171], 0
    v_cvt_pk_bf16_f32 v146, v146, v147
    v_mul_f32 v148, v255, v148
    v_mfma_f32_16x16x32_bf16 v[202:205], v[134:137], a[172:175], v[202:205]
    v_rsq_f32 v191, v191
    v_mfma_f32_16x16x32_bf16 v[202:205], v[154:157], a[176:179], v[202:205]
    v_cvt_pk_bf16_f32 v172, v150, v151
    v_cvt_pk_bf16_f32 v173, v152, v153
    v_mfma_f32_16x16x32_bf16 v[202:205], v[198:201], a[180:183], v[202:205]
    v_rsq_f32 v190, v190
    v_mfma_f32_16x16x32_bf16 v[202:205], v[210:213], a[184:187], v[202:205]
    ds_read_b128 v[150:153], v0 offset:32768
    v_mul_f32 v190, s31, v190
    v_mfma_f32_16x16x32_bf16 v[202:205], v[162:165], a[188:191], v[202:205]
    ds_read_b128 v[166:169], v1 offset:32768
    v_mul_f32 v226, v191, v226
    v_mfma_f32_16x16x32_bf16 v[194:197], v[118:121], a[192:195], 0
    ds_read_b128 v[118:121], v0 offset:32896
    v_mul_f32 v227, v191, v227
    v_mfma_f32_16x16x32_bf16 v[194:197], v[134:137], a[196:199], v[194:197]
    ds_read_b128 v[134:137], v1 offset:32896
    v_cvt_pk_f16_f32 v226, v226, v227
    v_mfma_f32_16x16x32_bf16 v[194:197], v[154:157], a[200:203], v[194:197]
    ds_read_b128 v[154:157], v0 offset:33024
    v_cvt_pk_bf16_f32 v132, v202, v203
    v_mfma_f32_16x16x32_bf16 v[194:197], v[198:201], a[204:207], v[194:197]
    ds_read_b128 v[198:201], v1 offset:33024
    v_cvt_pk_bf16_f32 v133, v204, v205
    v_mfma_f32_16x16x32_bf16 v[194:197], v[210:213], a[208:211], v[194:197]
    v_mul_f32 v228, v191, v228
    v_mul_f32 v229, v191, v229
    v_mfma_f32_16x16x32_bf16 v[194:197], v[162:165], a[212:215], v[194:197]
    v_cvt_pk_f16_f32 v227, v228, v229
    v_mul_f32 v122, v191, v122
    v_mfma_f32_16x16x32_f16 v[210:213], v[242:245], v[222:225], v[46:49]
    s_waitcnt lgkmcnt(5)
    buffer_store_dwordx2 v[116:117], v18, s[12:15], 0 offen nt
    v_mul_f32 v123, v191, v123
    v_cvt_pk_f16_f32 v228, v122, v123
    v_mfma_f32_16x16x32_bf16 v[202:205], a[72:75], v[150:153], 0
    s_waitcnt lgkmcnt(3)
    v_cvt_pk_bf16_f32 v116, v194, v195
    v_cvt_pk_bf16_f32 v117, v196, v197
    v_mfma_f32_16x16x32_bf16 v[202:205], a[76:79], v[166:169], v[202:205]
    s_waitcnt lgkmcnt(2)
    v_mul_f32 v124, v191, v124
    v_mul_f32 v125, v191, v125
    v_mfma_f32_16x16x32_bf16 v[202:205], a[80:83], v[118:121], v[202:205]
    s_waitcnt lgkmcnt(1)
    v_cvt_pk_f16_f32 v229, v124, v125
    v_mul_f32 v126, v191, v126
    v_mfma_f32_16x16x32_bf16 v[202:205], a[84:87], v[134:137], v[202:205]
    s_waitcnt lgkmcnt(0)
    v_mul_f32 v127, v191, v127
    v_cvt_pk_f16_f32 v124, v126, v127
    v_mfma_f32_16x16x32_bf16 v[202:205], a[88:91], v[154:157], v[202:205]
    v_mul_f32 v128, v191, v128
    v_mul_f32 v129, v191, v129
    v_mfma_f32_16x16x32_bf16 v[202:205], a[92:95], v[198:201], v[202:205]
    v_cvt_pk_f16_f32 v125, v128, v129
    v_mul_f32 v206, v190, v206
    v_mfma_f32_16x16x32_bf16 v[126:129], a[96:99], v[150:153], 0
    v_mul_f32 v207, v190, v207
    v_cvt_pk_f16_f32 v206, v206, v207
    v_mfma_f32_16x16x32_bf16 v[126:129], a[100:103], v[166:169], v[126:129]
    v_mul_f32 v208, v190, v208
    v_mul_f32 v209, v190, v209
    v_mfma_f32_16x16x32_bf16 v[126:129], a[104:107], v[118:121], v[126:129]
    v_cvt_pk_f16_f32 v207, v208, v209
    v_mul_f32 v174, v190, v174
    v_mfma_f32_16x16x32_bf16 v[126:129], a[108:111], v[134:137], v[126:129]
    v_mul_f32 v175, v190, v175
    v_cvt_pk_f16_f32 v208, v174, v175
    v_mfma_f32_16x16x32_bf16 v[126:129], a[112:115], v[154:157], v[126:129]
    v_mul_f32 v176, v190, v176
    v_mul_f32 v177, v190, v177
    v_mfma_f32_16x16x32_bf16 v[126:129], a[116:119], v[198:201], v[126:129]
    v_cvt_pk_f16_f32 v209, v176, v177
    v_mul_f32 v218, v190, v218
    v_mfma_f32_16x16x32_bf16 v[174:177], a[120:123], v[150:153], 0
    v_mul_f32 v219, v190, v219
    v_cvt_pk_f16_f32 v122, v218, v219
    v_mfma_f32_16x16x32_bf16 v[174:177], a[124:127], v[166:169], v[174:177]
    v_mul_f32 v220, v190, v220
    v_mul_f32 v221, v190, v221
    v_mfma_f32_16x16x32_bf16 v[174:177], a[128:131], v[118:121], v[174:177]
    v_cvt_pk_f16_f32 v123, v220, v221
    v_fma_f32 v162, v202, v202, s32
    v_mfma_f32_16x16x32_bf16 v[174:177], a[132:135], v[134:137], v[174:177]
    v_fmac_f32 v162, v203, v203
    v_fmac_f32 v162, v204, v204
    v_mfma_f32_16x16x32_bf16 v[174:177], a[136:139], v[154:157], v[174:177]
    v_fmac_f32 v162, v205, v205
    v_fmac_f32 v162, v126, v126
    v_mfma_f32_16x16x32_bf16 v[174:177], a[140:143], v[198:201], v[174:177]
    v_fmac_f32 v162, v127, v127
    v_fmac_f32 v162, v128, v128
    v_mfma_f32_16x16x32_bf16 v[190:193], a[0:3], v[150:153], 0
    v_fmac_f32 v162, v129, v129
    v_mul_f32 v149, v255, v149
    v_mfma_f32_16x16x32_bf16 v[190:193], a[4:7], v[166:169], v[190:193]
    v_cvt_pk_bf16_f32 v147, v148, v149
    v_mul_f32 v138, v255, v138
    v_mfma_f32_16x16x32_bf16 v[190:193], a[8:11], v[118:121], v[190:193]
    v_fmac_f32 v162, v174, v174
    v_fmac_f32 v162, v175, v175
    v_mfma_f32_16x16x32_bf16 v[190:193], a[12:15], v[134:137], v[190:193]
    v_fmac_f32 v162, v176, v176
    v_fmac_f32 v162, v177, v177
    v_mfma_f32_16x16x32_bf16 v[190:193], a[16:19], v[154:157], v[190:193]
    v_mul_f32 v139, v255, v139
    v_cvt_pk_bf16_f32 v148, v138, v139
    v_mfma_f32_16x16x32_bf16 v[190:193], a[20:23], v[198:201], v[190:193]
    v_mul_f32 v140, v255, v140
    v_mul_f32 v141, v255, v141
    v_mfma_f32_16x16x32_bf16 v[218:221], a[24:27], v[150:153], 0
    v_cvt_pk_bf16_f32 v149, v140, v141
    v_mul_f32 v186, v255, v186
    v_mfma_f32_16x16x32_bf16 v[218:221], a[28:31], v[166:169], v[218:221]
    buffer_store_dwordx4 v[146:149], v17, s[12:15], 0 offen nt
    v_mul_f32 v187, v255, v187
    v_fma_f32 v163, v190, v190, s32
    v_fmac_f32 v163, v191, v191
    v_fmac_f32 v163, v192, v192
    v_mfma_f32_16x16x32_bf16 v[218:221], a[32:35], v[118:121], v[218:221]
    v_fmac_f32 v163, v193, v193
    v_cvt_pk_bf16_f32 v164, v186, v187
    v_mfma_f32_16x16x32_bf16 v[218:221], a[36:39], v[134:137], v[218:221]
    v_mul_f32 v188, v255, v188
    v_mul_f32 v189, v255, v189
    v_mfma_f32_16x16x32_bf16 v[218:221], a[40:43], v[154:157], v[218:221]
    v_cvt_pk_bf16_f32 v165, v188, v189
    v_mul_f32 v142, v254, v142
    v_mfma_f32_16x16x32_bf16 v[218:221], a[44:47], v[198:201], v[218:221]
    v_mul_f32 v143, v254, v143
    v_cvt_pk_bf16_f32 v142, v142, v143
    v_mfma_f32_16x16x32_bf16 v[138:141], a[48:51], v[150:153], 0
    v_mul_f32 v144, v254, v144
    v_mul_f32 v145, v254, v145
    v_mfma_f32_16x16x32_bf16 v[138:141], a[52:55], v[166:169], v[138:141]
    v_cvt_pk_bf16_f32 v143, v144, v145
    v_mul_f32 v158, v254, v158
    v_mfma_f32_16x16x32_bf16 v[138:141], a[56:59], v[118:121], v[138:141]
    v_fmac_f32 v163, v218, v218
    v_fmac_f32 v163, v219, v219
    v_mfma_f32_16x16x32_bf16 v[138:141], a[60:63], v[134:137], v[138:141]
    ds_read2_b32 v[196:197], v6 offset0:0 offset1:0
    ds_read2_b32 v[216:217], v6 offset0:16 offset1:16
    v_mfma_f32_16x16x32_bf16 v[138:141], a[64:67], v[154:157], v[138:141]
    ds_read2_b32 v[232:233], v6 offset0:32 offset1:32
    v_fmac_f32 v163, v220, v220
    v_mfma_f32_16x16x32_bf16 v[138:141], a[68:71], v[198:201], v[138:141]
    v_fmac_f32 v163, v221, v221
    v_mul_f32 v159, v254, v159
    v_mfma_f32_16x16x32_bf16 v[146:149], v[150:153], a[144:147], 0
    v_cvt_pk_bf16_f32 v144, v158, v159
    v_mul_f32 v160, v254, v160
    v_mfma_f32_16x16x32_bf16 v[146:149], v[166:169], a[148:151], v[146:149]
    v_mul_f32 v161, v254, v161
    v_cvt_pk_bf16_f32 v145, v160, v161
    v_mfma_f32_16x16x32_bf16 v[146:149], v[118:121], a[152:155], v[146:149]
    v_fmac_f32 v163, v138, v138
    v_fmac_f32 v163, v139, v139
    v_mfma_f32_16x16x32_bf16 v[146:149], v[134:137], a[156:159], v[146:149]
    v_fmac_f32 v163, v140, v140
    v_fmac_f32 v163, v141, v141
    v_mfma_f32_16x16x32_bf16 v[146:149], v[154:157], a[160:163], v[146:149]
    v_cvt_pk_bf16_f32 v36, v163, v162
    v_mul_f32 v178, v254, v178
    v_mfma_f32_16x16x32_bf16 v[146:149], v[198:201], a[164:167], v[146:149]
    s_waitcnt lgkmcnt(1)
    v_mul_f32 v179, v254, v179
    v_cvt_pk_bf16_f32 v178, v178, v179
    v_mfma_f32_16x16x32_bf16 v[158:161], v[32:35], v[36:39], 0
    s_waitcnt lgkmcnt(0)
    buffer_store_dwordx2 v[164:165], v20, s[12:15], 0 offen nt
    v_mul_f32 v180, v254, v180
    v_mul_f32 v181, v254, v181
    v_mfma_f32_16x16x32_bf16 v[186:189], v[150:153], a[168:171], 0
    v_cvt_pk_bf16_f32 v194, v146, v147
    v_cvt_pk_bf16_f32 v195, v148, v149
    v_mfma_f32_16x16x32_bf16 v[186:189], v[166:169], a[172:175], v[186:189]
    v_rsq_f32 v159, v159
    v_mfma_f32_16x16x32_bf16 v[186:189], v[118:121], a[176:179], v[186:189]
    v_rsq_f32 v158, v158
    v_mfma_f32_16x16x32_bf16 v[186:189], v[134:137], a[180:183], v[186:189]
    v_mul_f32 v158, s31, v158
    v_mul_f32 v202, v159, v202
    v_mfma_f32_16x16x32_bf16 v[186:189], v[154:157], a[184:187], v[186:189]
    v_mul_f32 v203, v159, v203
    v_cvt_pk_f16_f32 v146, v202, v203
    v_mfma_f32_16x16x32_bf16 v[186:189], v[198:201], a[188:191], v[186:189]
    v_mul_f32 v204, v159, v204
    v_mul_f32 v205, v159, v205
    v_mfma_f32_16x16x32_bf16 v[162:165], v[150:153], a[192:195], 0
    v_cvt_pk_f16_f32 v147, v204, v205
    v_mul_f32 v126, v159, v126
    v_mfma_f32_16x16x32_bf16 v[162:165], v[166:169], a[196:199], v[162:165]
    ds_read_b128 v[150:153], v5 offset:0
    ds_read_b128 v[202:205], v5 offset:16
    v_mfma_f32_16x16x32_bf16 v[162:165], v[118:121], a[200:203], v[162:165]
    ds_read_b128 v[118:121], v5 offset:48
    ds_read_b32 v254, v6 offset:192
    v_mfma_f32_16x16x32_bf16 v[162:165], v[134:137], a[204:207], v[162:165]
    v_cvt_pk_bf16_f32 v214, v186, v187
    v_cvt_pk_bf16_f32 v215, v188, v189
    v_mfma_f32_16x16x32_bf16 v[162:165], v[154:157], a[208:211], v[162:165]
    v_mul_f32 v127, v159, v127
    v_cvt_pk_f16_f32 v148, v126, v127
    v_mfma_f32_16x16x32_bf16 v[162:165], v[198:201], a[212:215], v[162:165]
    ds_read_b128 v[198:201], v2 offset:0
    ds_read_b128 v[186:189], v2 offset:1024
    v_mfma_f32_16x16x32_f16 v[134:137], v[226:229], v[222:225], v[50:53]
    ds_read_b128 v[154:157], v2 offset:2048
    v_mul_f32 v128, v159, v128
    v_mul_f32 v129, v159, v129
    v_mfma_f32_16x16x16_f16 v[210:213], v[184:185], v[182:183], v[210:213]
    v_cvt_pk_f16_f32 v149, v128, v129
    v_cvt_pk_bf16_f32 v230, v162, v163
    v_cvt_pk_bf16_f32 v231, v164, v165
    v_mul_f32 v174, v159, v174
    v_mfma_f32_16x16x32_f16 v[126:129], v[146:149], v[222:225], v[54:57]
    s_waitcnt lgkmcnt(5)
    v_mul_f32 v175, v159, v175
    v_cvt_pk_f16_f32 v164, v174, v175
    v_mul_f32 v176, v159, v176
    v_mfma_f32_16x16x16_f16 v[134:137], v[124:125], v[182:183], v[134:137]
    v_mul_f32 v177, v159, v177
    v_cvt_pk_f16_f32 v165, v176, v177
    v_mul_f32 v190, v158, v190
    v_mul_f32 v191, v158, v191
    v_mfma_f32_16x16x16_f16 v[126:129], v[164:165], v[182:183], v[126:129]
    v_cvt_pk_f16_f32 v174, v190, v191
    v_mul_f32 v192, v158, v192
    v_mul_f32 v193, v158, v193
    v_cvt_pk_f16_f32 v175, v192, v193
    v_mfma_f32_16x16x32_f16 v[166:169], v[150:153], v[222:225], v[22:25]
    s_waitcnt lgkmcnt(2)
    ds_read_b128 v[222:225], v2 offset:3072
    buffer_store_dwordx4 v[142:145], v16, s[12:15], 0 offen nt
    ds_read_b128 v[234:237], v2 offset:4096
    v_mul_f32 v218, v158, v218
    v_mul_f32 v219, v158, v219
    v_cvt_pk_f16_f32 v176, v218, v219
    v_mfma_f32_16x16x32_f16 v[166:169], v[202:205], v[242:245], v[166:169]
    s_waitcnt lgkmcnt(2)
    v_mul_f32 v220, v158, v220
    v_mul_f32 v221, v158, v221
    v_mfma_f32_16x16x32_f16 v[166:169], v[118:121], v[182:185], v[166:169]
    ds_read_b128 v[142:145], v2 offset:5120
    v_cvt_pk_f16_f32 v177, v220, v221
    v_mul_f32 v138, v158, v138
    v_mul_f32 v139, v158, v139
    v_cvt_pk_f16_f32 v162, v138, v139
    v_mfma_f32_16x16x32_f16 v[218:221], v[150:153], v[206:209], v[24:27]
    v_mul_f32 v140, v158, v140
    v_mul_f32 v141, v158, v141
    v_mfma_f32_16x16x32_f16 v[218:221], v[202:205], v[226:229], v[218:221]
    v_mov_b32_dpp v254, v167 quad_perm:[0,1,2,3] row_mask:0x1 bank_mask:0xf
    v_cvt_pk_f16_f32 v163, v140, v141
    v_mfma_f32_16x16x32_f16 v[218:221], v[118:121], v[122:125], v[218:221]
    v_max3_f32 v255, v166, v210, v211
    v_max3_f32 v255, v255, v212, v213
    v_mfma_f32_16x16x32_f16 v[238:241], v[150:153], v[174:177], v[26:29]
    s_waitcnt lgkmcnt(1)
    v_max3_f32 v255, v255, v134, v135
    v_max3_f32 v255, v255, v136, v137
    v_mfma_f32_16x16x32_f16 v[238:241], v[202:205], v[146:149], v[238:241]
    v_max3_f32 v255, v255, v126, v127
    v_mov_b32_dpp v254, v219 quad_perm:[0,1,2,3] row_mask:0x2 bank_mask:0xf
    v_mfma_f32_16x16x32_f16 v[238:241], v[118:121], v[162:165], v[238:241]
    v_max3_f32 v255, v255, v128, v129
    v_mov_b32 v182, v255
    v_mfma_f32_16x16x32_bf16 v[150:153], a[216:219], v[198:201], 0
    s_waitcnt lgkmcnt(0)
    v_permlane32_swap_b32 v255, v182
    v_mfma_f32_16x16x32_bf16 v[150:153], a[220:223], v[186:189], v[150:153]
    v_max_f32 v255, v255, v182
    v_mov_b32 v182, v255
    v_mfma_f32_16x16x32_bf16 v[150:153], a[224:227], v[154:157], v[150:153]
    v_cvt_pk_bf16_f32 v179, v180, v181
    v_xor_b32 v0, 65536, v0
    v_mfma_f32_16x16x32_bf16 v[150:153], a[228:231], v[222:225], v[150:153]
    s_waitcnt vmcnt(5)
    v_permlane16_swap_b32 v255, v182
    v_mfma_f32_16x16x32_bf16 v[150:153], a[232:235], v[234:237], v[150:153]
    s_nop 0
    v_max_f32 v255, v255, v182
    v_sub_f32 v210, v210, v255
    v_mfma_f32_16x16x32_bf16 v[150:153], a[236:239], v[142:145], v[150:153]
    s_nop 0
    v_exp_f32 v210, v210
    v_mfma_f32_16x16x32_bf16 v[190:193], a[240:243], v[198:201], 0
    s_barrier
    v_sub_f32 v211, v211, v255
    v_sub_f32 v212, v212, v255
    v_mfma_f32_16x16x32_bf16 v[190:193], a[244:247], v[186:189], v[190:193]
    s_nop 0
    buffer_load_dwordx4 v10, s[8:11], 0 offen nt lds
    v_sub_f32 v213, v213, v255
    v_mfma_f32_16x16x32_bf16 v[190:193], a[248:251], v[154:157], v[190:193]
    s_add_u32 m0, s28, 4096
    v_exp_f32 v211, v211
    v_mfma_f32_16x16x32_bf16 v[190:193], a[252:255], v[222:225], v[190:193]
    v_cvt_pk_bf16_f32 v158, v210, v211
    v_sub_f32 v134, v134, v255
    v_mfma_f32_16x16x32_bf16 v[190:193], v[82:85], v[234:237], v[190:193]
    v_exp_f32 v212, v212
    v_mfma_f32_16x16x32_bf16 v[190:193], v[86:89], v[142:145], v[190:193]
    v_exp_f32 v213, v213
    v_mfma_f32_16x16x32_bf16 v[202:205], v[90:93], v[198:201], 0
    ds_read_b128 v[198:201], v2 offset:6144
    buffer_load_dwordx4 v11, s[8:11], 0 offen nt lds
    v_mfma_f32_16x16x32_bf16 v[202:205], v[94:97], v[186:189], v[202:205]
    s_add_u32 m0, s28, 8192
    ds_read_b128 v[138:141], v2 offset:7168
    v_cvt_pk_bf16_f32 v159, v212, v213
    v_mfma_f32_16x16x32_bf16 v[202:205], v[98:101], v[154:157], v[202:205]
    ds_read_b128 v[210:213], v2 offset:8192
    v_sub_f32 v135, v135, v255
    v_mfma_f32_16x16x32_bf16 v[202:205], v[102:105], v[222:225], v[202:205]
    ds_read_b128 v[186:189], v2 offset:9216
    v_sub_f32 v136, v136, v255
    v_mfma_f32_16x16x32_bf16 v[202:205], v[106:109], v[234:237], v[202:205]
    ds_read_b128 v[222:225], v2 offset:10240
    v_sub_f32 v137, v137, v255
    v_mfma_f32_16x16x32_bf16 v[202:205], v[110:113], v[142:145], v[202:205]
    ds_read_b128 v[154:157], v2 offset:11264
    buffer_load_dwordx4 v12, s[8:11], 0 offen nt lds
    v_exp_f32 v134, v134
    v_mfma_f32_16x16x32_f16 v[118:121], v[242:245], v[206:209], v[58:61]
    s_add_u32 m0, s28, 12288
    v_exp_f32 v135, v135
    v_exp_f32 v136, v136
    v_cvt_pk_bf16_f32 v160, v134, v135
    v_exp_f32 v137, v137
    v_sub_f32 v126, v126, v255
    v_mfma_f32_16x16x16_f16 v[118:121], v[184:185], v[122:123], v[118:121]
    v_cvt_pk_bf16_f32 v161, v136, v137
    v_exp_f32 v126, v126
    v_sub_f32 v127, v127, v255
    v_mfma_f32_16x16x32_f16 v[134:137], v[226:229], v[206:209], v[62:65]
    s_xor_b32 s28, s28, 65536
    buffer_load_dwordx4 v13, s[8:11], 0 offen nt lds
    v_exp_f32 v127, v127
    v_sub_f32 v128, v128, v255
    v_cvt_pk_bf16_f32 v36, v126, v127
    v_exp_f32 v128, v128
    v_mfma_f32_16x16x16_f16 v[134:137], v[124:125], v[122:123], v[134:137]
    v_sub_f32 v129, v129, v255
    v_exp_f32 v129, v129
    v_sub_f32 v166, v166, v255
    v_cvt_pk_bf16_f32 v37, v128, v129
    v_mfma_f32_16x16x32_f16 v[126:129], v[146:149], v[206:209], v[66:69]
    s_waitcnt lgkmcnt(0)
    v_exp_f32 v166, v166
    v_mfma_f32_16x16x32_bf16 v[142:145], a[216:219], v[198:201], 0
    s_mov_b32 m0, s29
    v_cvt_pk_bf16_f32 v39, v166, 0
    v_max3_f32 v255, v218, v118, v119
    v_max3_f32 v255, v255, v120, v121
    v_mfma_f32_16x16x16_f16 v[126:129], v[164:165], v[122:123], v[126:129]
    v_max3_f32 v255, v255, v134, v135
    v_max3_f32 v255, v255, v136, v137
    v_xor_b32 v1, 65536, v1
    v_mov_b32_dpp v254, v239 quad_perm:[0,1,2,3] row_mask:0x4 bank_mask:0xf
    v_mfma_f32_16x16x32_bf16 v[206:209], v[28:31], v[36:39], 0
    s_xor_b32 s29, s29, s30
    buffer_store_dwordx2 v[178:179], v19, s[12:15], 0 offen nt
    v_mov_b32 v122, v254
    v_max3_f32 v255, v255, v126, v127
    v_mfma_f32_16x16x32_bf16 v[206:209], v[28:31], v[158:161], v[206:209]
    s_add_u32 s19, s19, s20
    v_max3_f32 v255, v255, v128, v129
    v_mov_b32 v123, v255
    v_mfma_f32_16x16x32_bf16 v[142:145], a[220:223], v[138:141], v[142:145]
    s_add_u32 s23, s23, s21
    v_permlane32_swap_b32 v255, v123
    v_mfma_f32_16x16x32_bf16 v[142:145], a[224:227], v[210:213], v[142:145]
    s_cmp_ge_u32 s19, 72
    v_rcp_f32 v206, v206
    v_mfma_f32_16x16x32_bf16 v[142:145], a[228:231], v[186:189], v[142:145]
    s_cselect_b32 s34, 72, 0
    v_max_f32 v255, v255, v123
    v_mov_b32 v123, v255
    v_mfma_f32_16x16x32_bf16 v[142:145], a[232:235], v[222:225], v[142:145]
    s_cselect_b32 s35, s22, 0
    v_permlane16_swap_b32 v255, v123
    v_mfma_f32_16x16x32_bf16 v[142:145], a[236:239], v[154:157], v[142:145]
    s_sub_u32 s19, s19, s34
    v_max_f32 v255, v255, v123
    v_sub_f32 v118, v118, v255
    v_mfma_f32_16x16x32_bf16 v[178:181], v[194:197], v[36:39], 0
    s_add_u32 s23, s23, s35
    v_exp_f32 v118, v118
    v_mfma_f32_16x16x32_bf16 v[178:181], v[170:173], v[158:161], v[178:181]
    s_add_u32 s18, s18, 1
    v_sub_f32 v119, v119, v255
    v_exp_f32 v119, v119
    v_sub_f32 v120, v120, v255
    v_cvt_pk_bf16_f32 v118, v118, v119
    v_exp_f32 v120, v120
    v_sub_f32 v121, v121, v255
    v_exp_f32 v121, v121
    v_mul_f32 v178, v206, v178
    v_mul_f32 v179, v206, v179
    v_cvt_pk_bf16_f32 v178, v178, v179
    v_mul_f32 v180, v206, v180
    v_mul_f32 v181, v206, v181
    v_cvt_pk_bf16_f32 v179, v180, v181
    v_cvt_pk_bf16_f32 v119, v120, v121
    v_mfma_f32_16x16x32_bf16 v[166:169], v[214:217], v[36:39], 0
    s_cmp_lt_u32 s18, s45
    v_sub_f32 v134, v134, v255
    v_sub_f32 v135, v135, v255
    v_mfma_f32_16x16x32_bf16 v[166:169], v[130:133], v[158:161], v[166:169]
    v_exp_f32 v134, v134
    v_exp_f32 v135, v135
    v_sub_f32 v136, v136, v255
    v_cvt_pk_bf16_f32 v120, v134, v135
    v_exp_f32 v136, v136
    v_sub_f32 v137, v137, v255
    v_exp_f32 v137, v137
    v_sub_f32 v126, v126, v255
    v_mul_f32 v166, v206, v166
    v_mul_f32 v167, v206, v167
    v_cvt_pk_bf16_f32 v180, v166, v167
    v_mul_f32 v168, v206, v168
    v_mul_f32 v169, v206, v169
    v_cvt_pk_bf16_f32 v181, v168, v169
    v_cvt_pk_bf16_f32 v121, v136, v137
    v_mfma_f32_16x16x32_bf16 v[134:137], v[230:233], v[36:39], 0
    buffer_load_dwordx4 v14, s[8:11], 0 offen nt lds
    v_sub_f32 v127, v127, v255
    v_mfma_f32_16x16x32_bf16 v[134:137], v[114:117], v[158:161], v[134:137]
    ds_write_b128 v3, v[178:181] offset:0
    v_mfma_f32_16x16x32_bf16 v[158:161], a[240:243], v[198:201], 0
    v_exp_f32 v126, v126
    v_mfma_f32_16x16x32_bf16 v[158:161], a[244:247], v[138:141], v[158:161]
    v_exp_f32 v127, v127
    v_mfma_f32_16x16x32_bf16 v[158:161], a[248:251], v[210:213], v[158:161]
    v_cvt_pk_bf16_f32 v36, v126, v127
    v_sub_f32 v128, v128, v255
    v_mfma_f32_16x16x32_bf16 v[158:161], a[252:255], v[186:189], v[158:161]
    v_mul_f32 v134, v206, v134
    v_mul_f32 v135, v206, v135
    v_mfma_f32_16x16x32_bf16 v[158:161], v[82:85], v[222:225], v[158:161]
    v_cvt_pk_bf16_f32 v126, v134, v135
    v_mul_f32 v136, v206, v136
    v_mfma_f32_16x16x32_bf16 v[158:161], v[86:89], v[154:157], v[158:161]
    v_mul_f32 v137, v206, v137
    v_cvt_pk_bf16_f32 v127, v136, v137
    v_mfma_f32_16x16x32_bf16 v[178:181], v[90:93], v[198:201], 0
    ds_read_b128 v[198:201], v2 offset:12288
    v_sub_f32 v129, v129, v255
    v_mfma_f32_16x16x32_bf16 v[178:181], v[94:97], v[138:141], v[178:181]
    ds_read_b128 v[206:209], v2 offset:13312
    v_sub_f32 v218, v218, v255
    v_mfma_f32_16x16x32_bf16 v[178:181], v[98:101], v[210:213], v[178:181]
    ds_read_b128 v[210:213], v2 offset:14336
    v_max_f32_dpp v122, v122, v122 quad_perm:[1,0,3,2] row_mask:0xf bank_mask:0xf
    v_mfma_f32_16x16x32_bf16 v[178:181], v[102:105], v[186:189], v[178:181]
    ds_read_b128 v[134:137], v2 offset:15360
    v_max_f32_dpp v122, v122, v122 quad_perm:[2,3,0,1] row_mask:0xf bank_mask:0xf
    v_mfma_f32_16x16x32_bf16 v[178:181], v[106:109], v[222:225], v[178:181]
    ds_read_b128 v[222:225], v2 offset:16384
    v_max_f32_dpp v122, v122, v122 row_half_mirror row_mask:0xf bank_mask:0xf
    v_mfma_f32_16x16x32_bf16 v[178:181], v[110:113], v[154:157], v[178:181]
    ds_read_b128 v[154:157], v2 offset:17408
    ds_write_b64 v4, v[126:127] offset:4096
    v_exp_f32 v128, v128
    v_exp_f32 v129, v129
    v_mfma_f32_16x16x32_f16 v[186:189], v[242:245], v[174:177], v[70:73]
    s_waitcnt lgkmcnt(6)
    v_cvt_pk_bf16_f32 v37, v128, v129
    v_max_f32_dpp v122, v122, v122 row_mirror row_mask:0xf bank_mask:0xf
    v_mfma_f32_16x16x32_f16 v[242:245], v[226:229], v[174:177], v[74:77]
    s_waitcnt lgkmcnt(5)
    v_exp_f32 v218, v218
    v_mfma_f32_16x16x32_f16 v[126:129], v[146:149], v[174:177], v[78:81]
    s_waitcnt lgkmcnt(4)
    v_cvt_pk_bf16_f32 v39, v218, 0
    v_mov_b32 v123, v122
    v_fma_f32 v255, v150, v150, s33
    v_mfma_f32_16x16x32_bf16 v[174:177], v[28:31], v[36:39], 0
    s_waitcnt lgkmcnt(3)
    v_permlane32_swap_b32 v122, v123
    v_mfma_f32_16x16x32_bf16 v[174:177], v[28:31], v[118:121], v[174:177]
    s_waitcnt lgkmcnt(2)
    v_max_f32 v122, v122, v123
    v_mov_b32 v123, v122
    v_mfma_f32_16x16x32_bf16 v[226:229], v[194:197], v[36:39], 0
    s_waitcnt lgkmcnt(0)
    v_permlane16_swap_b32 v122, v123
    v_mfma_f32_16x16x32_bf16 v[226:229], v[170:173], v[118:121], v[226:229]
    v_max_f32 v122, v122, v123
    v_sub_f32 v254, v254, v122
    v_mfma_f32_16x16x32_bf16 v[218:221], v[214:217], v[36:39], 0
    v_exp_f32 v254, v254
    v_mfma_f32_16x16x32_bf16 v[218:221], v[130:133], v[118:121], v[218:221]
    v_cvt_pk_bf16_f32 v254, v254, v254
    v_fmac_f32 v255, v151, v151
    v_mfma_f32_16x16x32_bf16 v[166:169], v[230:233], v[36:39], 0
    ds_write_b16 v8, v254
    v_mfma_f32_16x16x32_bf16 v[166:169], v[114:117], v[118:121], v[166:169]
    v_rcp_f32 v174, v174
    v_fmac_f32 v255, v152, v152
    v_mfma_f32_16x16x16_f16 v[186:189], v[184:185], v[162:163], v[186:189]
    v_mul_f32 v226, v174, v226
    v_mul_f32 v227, v174, v227
    v_cvt_pk_bf16_f32 v122, v226, v227
    v_mfma_f32_16x16x16_f16 v[242:245], v[124:125], v[162:163], v[242:245]
    v_mul_f32 v228, v174, v228
    v_mul_f32 v229, v174, v229
    v_cvt_pk_bf16_f32 v123, v228, v229
    v_mfma_f32_16x16x16_f16 v[126:129], v[164:165], v[162:163], v[126:129]
    v_max3_f32 v254, v238, v186, v187
    v_max3_f32 v254, v254, v188, v189
    v_mul_f32 v218, v174, v218
    v_mul_f32 v219, v174, v219
    v_mfma_f32_16x16x32_bf16 v[146:149], a[216:219], v[198:201], 0
    ds_read_b128 v[118:121], v9
    ds_read_b128 v[162:165], v9 offset:64
    v_mfma_f32_16x16x32_bf16 v[146:149], a[220:223], v[206:209], v[146:149]
    v_max3_f32 v254, v254, v242, v243
    v_max3_f32 v254, v254, v244, v245
    v_mfma_f32_16x16x32_bf16 v[146:149], a[224:227], v[210:213], v[146:149]
    v_max3_f32 v254, v254, v126, v127
    v_max3_f32 v254, v254, v128, v129
    v_mfma_f32_16x16x32_bf16 v[146:149], a[228:231], v[134:137], v[146:149]
    v_mov_b32 v125, v254
    v_cvt_pk_bf16_f32 v124, v218, v219
    v_mfma_f32_16x16x32_bf16 v[146:149], a[232:235], v[222:225], v[146:149]
    v_permlane32_swap_b32 v254, v125
    v_mfma_f32_16x16x32_bf16 v[146:149], a[236:239], v[154:157], v[146:149]
    v_max_f32 v254, v254, v125
    v_mov_b32 v125, v254
    v_mfma_f32_16x16x32_bf16 v[138:141], a[240:243], v[198:201], 0
    v_mul_f32 v220, v174, v220
    v_mul_f32 v221, v174, v221
    v_mfma_f32_16x16x32_bf16 v[138:141], a[244:247], v[206:209], v[138:141]
    v_permlane16_swap_b32 v254, v125
    v_mfma_f32_16x16x32_bf16 v[138:141], a[248:251], v[210:213], v[138:141]
    s_waitcnt lgkmcnt(0)
    v_max_f32 v254, v254, v125
    v_sub_f32 v186, v186, v254
    v_mfma_f32_16x16x32_bf16 v[138:141], a[252:255], v[134:137], v[138:141]
    v_exp_f32 v186, v186
    v_mfma_f32_16x16x32_bf16 v[138:141], v[82:85], v[222:225], v[138:141]
    v_sub_f32 v187, v187, v254
    v_sub_f32 v188, v188, v254
    v_mfma_f32_16x16x32_bf16 v[138:141], v[86:89], v[154:157], v[138:141]
    v_exp_f32 v187, v187
    v_exp_f32 v188, v188
    v_cvt_pk_bf16_f32 v234, v186, v187
    v_sub_f32 v189, v189, v254
    v_exp_f32 v189, v189
    v_sub_f32 v242, v242, v254
    v_cvt_pk_bf16_f32 v235, v188, v189
    v_exp_f32 v242, v242
    v_sub_f32 v243, v243, v254
    v_exp_f32 v243, v243
    v_sub_f32 v244, v244, v254
    v_cvt_pk_bf16_f32 v236, v242, v243
    v_mfma_f32_16x16x32_bf16 v[186:189], v[90:93], v[198:201], 0
    v_exp_f32 v244, v244
    v_mfma_f32_16x16x32_bf16 v[186:189], v[94:97], v[206:209], v[186:189]
    v_sub_f32 v245, v245, v254
    v_sub_f32 v126, v126, v254
    v_mfma_f32_16x16x32_bf16 v[186:189], v[98:101], v[210:213], v[186:189]
    v_exp_f32 v245, v245
    v_mfma_f32_16x16x32_bf16 v[186:189], v[102:105], v[134:137], v[186:189]
    v_cvt_pk_bf16_f32 v237, v244, v245
    v_sub_f32 v127, v127, v254
    v_mfma_f32_16x16x32_bf16 v[186:189], v[106:109], v[222:225], v[186:189]
    v_exp_f32 v126, v126
    v_mfma_f32_16x16x32_bf16 v[186:189], v[110:113], v[154:157], v[186:189]
    ds_read_b128 v[182:185], v0 offset:20480
    ds_read_b128 v[198:201], v1 offset:20480
    v_mfma_f32_16x16x32_bf16 v[206:209], v[118:121], v[28:31], 0
    ds_read_b128 v[210:213], v0 offset:20608
    ds_read_b128 v[222:225], v1 offset:20608
    v_mfma_f32_16x16x32_bf16 v[206:209], v[162:165], v[28:31], v[206:209]
    v_exp_f32 v127, v127
    v_mfma_f32_16x16x32_bf16 v[154:157], v[118:121], v[170:173], 0
    ds_read_b128 v[226:229], v0 offset:20736
    v_cvt_pk_bf16_f32 v36, v126, v127
    v_mfma_f32_16x16x32_bf16 v[154:157], v[162:165], v[194:197], v[154:157]
    ds_read_b128 v[242:245], v1 offset:20736
    v_sub_f32 v128, v128, v254
    v_exp_f32 v128, v128
    v_sub_f32 v129, v129, v254
    v_exp_f32 v129, v129
    v_sub_f32 v238, v238, v254
    v_cvt_pk_bf16_f32 v37, v128, v129
    v_mfma_f32_16x16x32_bf16 v[134:137], v[118:121], v[130:133], 0
    v_exp_f32 v238, v238
    v_mfma_f32_16x16x32_bf16 v[134:137], v[162:165], v[214:217], v[134:137]
    s_waitcnt lgkmcnt(4)
    v_cvt_pk_bf16_f32 v39, v238, 0
    v_cvt_pk_bf16_f32 v125, v220, v221
    v_mfma_f32_16x16x32_bf16 v[218:221], v[118:121], v[114:117], 0
    s_waitcnt lgkmcnt(2)
    ds_write_b128 v3, v[122:125] offset:6144
    v_mfma_f32_16x16x32_bf16 v[126:129], v[28:31], v[36:39], 0
    s_waitcnt lgkmcnt(2)
    v_mul_f32 v166, v174, v166
    v_mul_f32 v167, v174, v167
    v_mfma_f32_16x16x32_bf16 v[126:129], v[28:31], v[234:237], v[126:129]
    s_waitcnt lgkmcnt(1)
    v_cvt_pk_bf16_f32 v166, v166, v167
    v_mul_f32 v168, v174, v168
    v_mfma_f32_16x16x32_bf16 v[122:125], v[194:197], v[36:39], 0
    v_mul_f32 v169, v174, v169
    v_cvt_pk_bf16_f32 v167, v168, v169
    v_mfma_f32_16x16x32_bf16 v[122:125], v[170:173], v[234:237], v[122:125]
    ds_write_b64 v4, v[166:167] offset:10240
    v_mfma_f32_16x16x32_bf16 v[170:173], v[214:217], v[36:39], 0
    v_rcp_f32 v126, v126
    v_mfma_f32_16x16x32_bf16 v[170:173], v[130:133], v[234:237], v[170:173]
    v_fma_f32 v254, v146, v146, s33
    v_fmac_f32 v254, v147, v147
    v_mfma_f32_16x16x32_bf16 v[174:177], v[230:233], v[36:39], 0
    v_fmac_f32 v254, v148, v148
    v_mul_f32 v122, v126, v122
    v_mfma_f32_16x16x32_bf16 v[174:177], v[114:117], v[234:237], v[174:177]
    v_mul_f32 v123, v126, v123
    v_cvt_pk_bf16_f32 v122, v122, v123
    v_mfma_f32_16x16x32_bf16 v[218:221], v[162:165], v[230:233], v[218:221]
    v_mul_f32 v124, v126, v124
    v_mul_f32 v125, v126, v125
    v_mfma_f32_16x16x32_bf16 v[114:117], a[72:75], v[182:185], 0
    v_cvt_pk_bf16_f32 v123, v124, v125
    v_mul_f32 v170, v126, v170
    v_mfma_f32_16x16x32_bf16 v[114:117], a[76:79], v[198:201], v[114:117]
    v_mul_f32 v171, v126, v171
    v_cvt_pk_bf16_f32 v124, v170, v171
    v_mfma_f32_16x16x32_bf16 v[114:117], a[80:83], v[210:213], v[114:117]
    v_mul_f32 v172, v126, v172
    v_mul_f32 v173, v126, v173
    v_mfma_f32_16x16x32_bf16 v[114:117], a[84:87], v[222:225], v[114:117]
    v_cvt_pk_bf16_f32 v125, v172, v173
    v_mul_f32 v174, v126, v174
    v_mfma_f32_16x16x32_bf16 v[114:117], a[88:91], v[226:229], v[114:117]
    ds_write_b128 v3, v[122:125] offset:12288
    v_mfma_f32_16x16x32_bf16 v[114:117], a[92:95], v[242:245], v[114:117]
    v_mul_f32 v175, v126, v175
    v_cvt_pk_bf16_f32 v174, v174, v175
    v_mfma_f32_16x16x32_bf16 v[122:125], a[96:99], v[182:185], 0
    v_mul_f32 v176, v126, v176
    v_mul_f32 v177, v126, v177
    v_mfma_f32_16x16x32_bf16 v[122:125], a[100:103], v[198:201], v[122:125]
    v_cvt_pk_bf16_f32 v175, v176, v177
    v_fmac_f32 v254, v149, v149
    v_mfma_f32_16x16x32_bf16 v[122:125], a[104:107], v[210:213], v[122:125]
    ds_write_b64 v4, v[174:175] offset:16384
    v_mfma_f32_16x16x32_bf16 v[122:125], a[108:111], v[222:225], v[122:125]
    v_fmac_f32 v254, v138, v138
    v_fmac_f32 v254, v139, v139
    v_mfma_f32_16x16x32_bf16 v[122:125], a[112:115], v[226:229], v[122:125]
    v_fmac_f32 v254, v140, v140
    v_fmac_f32 v254, v141, v141
    v_mfma_f32_16x16x32_bf16 v[122:125], a[116:119], v[242:245], v[122:125]
    v_fmac_f32 v254, v186, v186
    v_fmac_f32 v254, v187, v187
    v_mfma_f32_16x16x32_bf16 v[126:129], a[120:123], v[182:185], 0
    v_fmac_f32 v254, v188, v188
    v_fmac_f32 v254, v189, v189
    v_mfma_f32_16x16x32_bf16 v[126:129], a[124:127], v[198:201], v[126:129]
    v_cvt_pk_bf16_f32 v155, v254, v254
    v_fmac_f32 v255, v153, v153
    v_mfma_f32_16x16x32_bf16 v[126:129], a[128:131], v[210:213], v[126:129]
    v_rcp_f32 v206, v206
    v_mfma_f32_16x16x32_bf16 v[126:129], a[132:135], v[222:225], v[126:129]
    v_mul_f32 v154, v154, v206
    v_mul_f32_dpp v154, v134, v206 quad_perm:[0,1,2,3] row_mask:0x2 bank_mask:0xf
    v_mfma_f32_16x16x32_bf16 v[126:129], a[136:139], v[226:229], v[126:129]
    v_mul_f32_dpp v154, v218, v206 quad_perm:[0,1,2,3] row_mask:0x4 bank_mask:0xf
    v_cvt_pk_bf16_f32 v154, v154, v154
    v_mfma_f32_16x16x32_bf16 v[126:129], a[140:143], v[242:245], v[126:129]
    ds_write_b16 v7, v154
    v_mfma_f32_16x16x32_bf16 v[206:209], a[0:3], v[182:185], 0
    v_fmac_f32 v255, v190, v190
    v_fmac_f32 v255, v191, v191
    v_mfma_f32_16x16x32_bf16 v[206:209], a[4:7], v[198:201], v[206:209]
    v_fmac_f32 v255, v192, v192
    v_fmac_f32 v255, v193, v193
    v_mfma_f32_16x16x32_bf16 v[206:209], a[8:11], v[210:213], v[206:209]
    v_fmac_f32 v255, v202, v202
    v_fmac_f32 v255, v203, v203
    v_mfma_f32_16x16x32_bf16 v[206:209], a[12:15], v[222:225], v[206:209]
    v_fmac_f32 v255, v204, v204
    v_fmac_f32 v255, v205, v205
    v_mfma_f32_16x16x32_bf16 v[206:209], a[16:19], v[226:229], v[206:209]
    v_fma_f32 v254, v142, v142, s33
    v_fmac_f32 v254, v143, v143
    v_mfma_f32_16x16x32_bf16 v[206:209], a[20:23], v[242:245], v[206:209]
    v_fmac_f32 v254, v144, v144
    v_fmac_f32 v254, v145, v145
    v_mfma_f32_16x16x32_bf16 v[174:177], a[24:27], v[182:185], 0
    v_fmac_f32 v254, v158, v158
    v_fmac_f32 v254, v159, v159
    v_mfma_f32_16x16x32_bf16 v[174:177], a[28:31], v[198:201], v[174:177]
    v_fmac_f32 v254, v160, v160
    v_fmac_f32 v254, v161, v161
    v_mfma_f32_16x16x32_bf16 v[174:177], a[32:35], v[210:213], v[174:177]
    v_fmac_f32 v254, v178, v178
    v_fmac_f32 v254, v179, v179
    v_mfma_f32_16x16x32_bf16 v[174:177], a[36:39], v[222:225], v[174:177]
    v_fmac_f32 v254, v180, v180
    v_fmac_f32 v254, v181, v181
    v_mfma_f32_16x16x32_bf16 v[174:177], a[40:43], v[226:229], v[174:177]
    v_cvt_pk_bf16_f32 v154, v255, v254
    v_add_u32 v5, 336, v5
    v_mfma_f32_16x16x32_bf16 v[174:177], a[44:47], v[242:245], v[174:177]
    ds_write_b64 v4, v[154:155] offset:18432
    v_mfma_f32_16x16x32_bf16 v[218:221], a[48:51], v[182:185], 0
    v_add_u32 v6, 272, v6
    v_add_u32 v7, 16, v7
    v_mfma_f32_16x16x32_bf16 v[218:221], a[52:55], v[198:201], v[218:221]
    v_fma_f32 v130, v114, v114, s32
    v_fmac_f32 v130, v115, v115
    v_mfma_f32_16x16x32_bf16 v[218:221], a[56:59], v[210:213], v[218:221]
    v_fmac_f32 v130, v116, v116
    v_fmac_f32 v130, v117, v117
    v_mfma_f32_16x16x32_bf16 v[218:221], a[60:63], v[222:225], v[218:221]
    v_fmac_f32 v130, v122, v122
    v_fmac_f32 v130, v123, v123
    v_mfma_f32_16x16x32_bf16 v[218:221], a[64:67], v[226:229], v[218:221]
    v_fmac_f32 v130, v124, v124
    v_fmac_f32 v130, v125, v125
    v_mfma_f32_16x16x32_bf16 v[218:221], a[68:71], v[242:245], v[218:221]
    v_fmac_f32 v130, v126, v126
    v_fmac_f32 v130, v127, v127
    v_mfma_f32_16x16x32_bf16 v[170:173], v[182:185], a[144:147], 0
    s_waitcnt lgkmcnt(0)
    v_fmac_f32 v130, v128, v128
    v_fmac_f32 v130, v129, v129
    v_mfma_f32_16x16x32_bf16 v[170:173], v[198:201], a[148:151], v[170:173]
    s_nop 0
    v_fma_f32 v131, v206, v206, s32
    v_fmac_f32 v131, v207, v207
    v_mfma_f32_16x16x32_bf16 v[170:173], v[210:213], a[152:155], v[170:173]
    s_nop 0
    v_fmac_f32 v131, v208, v208
    v_fmac_f32 v131, v209, v209
    v_mfma_f32_16x16x32_bf16 v[170:173], v[222:225], a[156:159], v[170:173]
    s_barrier
    v_fmac_f32 v131, v174, v174
    v_xor_b32 v2, 65536, v2
    v_mfma_f32_16x16x32_bf16 v[170:173], v[226:229], a[160:163], v[170:173]
    s_nop 0
    v_xor_b32 v3, 65536, v3
    v_xor_b32 v4, 65536, v4
    v_mfma_f32_16x16x32_bf16 v[170:173], v[242:245], a[164:167], v[170:173]
    s_cbranch_scc1 L_loop_safe2
    s_branch L_final_safe
.p2align 6
L_loop_safe3:
    v_mfma_f32_16x16x32_bf16 v[162:165], v[182:185], a[168:171], 0
    s_add_u32 s12, s42, s27
    ds_read_b128 v[194:197], v2 offset:18432
    ds_read_b128 v[230:233], v2 offset:19456
    v_mfma_f32_16x16x32_bf16 v[162:165], v[198:201], a[172:175], v[162:165]
    s_addc_u32 s13, s43, 0
    v_fmac_f32 v131, v175, v175
    v_fmac_f32 v131, v176, v176
    v_mfma_f32_16x16x32_bf16 v[162:165], v[210:213], a[176:179], v[162:165]
    s_sub_u32 s14, s36, s27
    v_fmac_f32 v131, v177, v177
    v_fmac_f32 v131, v218, v218
    v_mfma_f32_16x16x32_bf16 v[162:165], v[222:225], a[180:183], v[162:165]
    s_cmp_ge_u32 s18, 2
    v_fmac_f32 v131, v219, v219
    v_fmac_f32 v131, v220, v220
    v_mfma_f32_16x16x32_bf16 v[162:165], v[226:229], a[184:187], v[162:165]
    s_cselect_b32 s14, s14, 0
    ds_read_b128 v[118:121], v0 offset:26624
    v_fmac_f32 v131, v221, v221
    v_mfma_f32_16x16x32_bf16 v[162:165], v[242:245], a[188:191], v[162:165]
    s_add_u32 s34, s18, 2
    ds_read_b128 v[134:137], v1 offset:26624
    v_cvt_pk_bf16_f32 v36, v131, v130
    v_mfma_f32_16x16x32_bf16 v[214:217], v[182:185], a[192:195], 0
    s_add_u32 s8, s40, s23
    ds_read_b128 v[154:157], v0 offset:26752
    v_cvt_pk_bf16_f32 v170, v170, v171
    v_mfma_f32_16x16x32_bf16 v[214:217], v[198:201], a[196:199], v[214:217]
    s_addc_u32 s9, s41, 0
    ds_read_b128 v[198:201], v1 offset:26752
    v_cvt_pk_bf16_f32 v171, v172, v173
    v_mfma_f32_16x16x32_bf16 v[166:169], v[32:35], v[36:39], 0
    s_sub_u32 s10, s36, s23
    v_cvt_pk_bf16_f32 v130, v162, v163
    v_cvt_pk_bf16_f32 v131, v164, v165
    v_mfma_f32_16x16x32_bf16 v[214:217], v[210:213], a[200:203], v[214:217]
    s_waitcnt lgkmcnt(4)
    ds_read_b128 v[210:213], v0 offset:26880
    s_cmp_lt_u32 s34, s17
    v_mfma_f32_16x16x32_bf16 v[234:237], v[32:35], v[194:197], 0
    s_cselect_b32 s10, s10, 0
    v_rsq_f32 v167, v167
    v_mfma_f32_16x16x32_bf16 v[234:237], v[32:35], v[230:233], v[234:237]
    s_add_u32 m0, s28, 0
    v_rsq_f32 v166, v166
    v_mfma_f32_16x16x32_bf16 v[214:217], v[222:225], a[204:207], v[214:217]
    s_waitcnt lgkmcnt(4)
    ds_read_b128 v[162:165], v1 offset:26880
    v_mul_f32 v166, s31, v166
    v_mfma_f32_16x16x32_bf16 v[214:217], v[226:229], a[208:211], v[214:217]
    s_mov_b32 s27, s26
    v_mul_f32 v114, v167, v114
    v_mul_f32 v115, v167, v115
    v_mfma_f32_16x16x32_bf16 v[214:217], v[242:245], a[212:215], v[214:217]
    s_mov_b32 s26, s25
    v_cvt_pk_f16_f32 v242, v114, v115
    v_mul_f32 v116, v167, v116
    v_mfma_f32_16x16x32_bf16 v[226:229], a[72:75], v[118:121], 0
    s_waitcnt lgkmcnt(2)
    v_mul_f32 v117, v167, v117
    v_cvt_pk_f16_f32 v243, v116, v117
    v_mfma_f32_16x16x32_bf16 v[226:229], a[76:79], v[134:137], v[226:229]
    s_mov_b32 s25, s24
    v_cvt_pk_bf16_f32 v114, v214, v215
    v_cvt_pk_bf16_f32 v115, v216, v217
    v_mfma_f32_16x16x32_bf16 v[226:229], a[80:83], v[154:157], v[226:229]
    s_mov_b32 s24, s23
    v_mul_f32 v122, v167, v122
    v_mul_f32 v123, v167, v123
    v_mfma_f32_16x16x32_bf16 v[226:229], a[84:87], v[198:201], v[226:229]
    s_waitcnt lgkmcnt(1)
    v_cvt_pk_f16_f32 v244, v122, v123
    v_mul_f32 v124, v167, v124
    v_mfma_f32_16x16x32_bf16 v[226:229], a[88:91], v[210:213], v[226:229]
    v_mul_f32 v125, v167, v125
    v_cvt_pk_f16_f32 v245, v124, v125
    v_mfma_f32_16x16x32_bf16 v[122:125], a[96:99], v[118:121], 0
    s_waitcnt lgkmcnt(0)
    v_mul_f32 v126, v167, v126
    v_mul_f32 v127, v167, v127
    v_mfma_f32_16x16x32_bf16 v[226:229], a[92:95], v[162:165], v[226:229]
    v_cvt_pk_f16_f32 v184, v126, v127
    v_mul_f32 v128, v167, v128
    v_mfma_f32_16x16x32_bf16 v[122:125], a[100:103], v[134:137], v[122:125]
    v_mul_f32 v129, v167, v129
    v_cvt_pk_f16_f32 v185, v128, v129
    v_mfma_f32_16x16x32_bf16 v[122:125], a[104:107], v[154:157], v[122:125]
    v_mul_f32 v206, v166, v206
    v_mul_f32 v207, v166, v207
    v_mfma_f32_16x16x32_bf16 v[122:125], a[108:111], v[198:201], v[122:125]
    v_cvt_pk_f16_f32 v222, v206, v207
    v_mul_f32 v208, v166, v208
    v_mfma_f32_16x16x32_bf16 v[122:125], a[112:115], v[210:213], v[122:125]
    v_mul_f32 v209, v166, v209
    v_cvt_pk_f16_f32 v223, v208, v209
    v_mfma_f32_16x16x32_bf16 v[122:125], a[116:119], v[162:165], v[122:125]
    v_mul_f32 v174, v166, v174
    v_mul_f32 v175, v166, v175
    v_mfma_f32_16x16x32_bf16 v[126:129], a[120:123], v[118:121], 0
    v_cvt_pk_f16_f32 v224, v174, v175
    v_mul_f32 v176, v166, v176
    v_mfma_f32_16x16x32_bf16 v[126:129], a[124:127], v[134:137], v[126:129]
    v_mul_f32 v177, v166, v177
    v_cvt_pk_f16_f32 v225, v176, v177
    v_mfma_f32_16x16x32_bf16 v[126:129], a[128:131], v[154:157], v[126:129]
    v_mul_f32 v218, v166, v218
    v_mul_f32 v219, v166, v219
    v_mfma_f32_16x16x32_bf16 v[126:129], a[132:135], v[198:201], v[126:129]
    v_cvt_pk_f16_f32 v182, v218, v219
    v_mul_f32 v220, v166, v220
    v_mfma_f32_16x16x32_bf16 v[126:129], a[136:139], v[210:213], v[126:129]
    v_mul_f32 v221, v166, v221
    v_cvt_pk_f16_f32 v183, v220, v221
    v_mfma_f32_16x16x32_bf16 v[126:129], a[140:143], v[162:165], v[126:129]
    v_fma_f32 v116, v226, v226, s32
    v_fmac_f32 v116, v227, v227
    v_mfma_f32_16x16x32_bf16 v[206:209], a[0:3], v[118:121], 0
    v_fmac_f32 v116, v228, v228
    v_fmac_f32 v116, v229, v229
    v_mfma_f32_16x16x32_bf16 v[206:209], a[4:7], v[134:137], v[206:209]
    v_fmac_f32 v116, v122, v122
    v_fmac_f32 v116, v123, v123
    v_mfma_f32_16x16x32_bf16 v[206:209], a[8:11], v[154:157], v[206:209]
    v_fmac_f32 v116, v124, v124
    v_fmac_f32 v116, v125, v125
    v_mfma_f32_16x16x32_bf16 v[206:209], a[12:15], v[198:201], v[206:209]
    v_fmac_f32 v116, v126, v126
    v_fmac_f32 v116, v127, v127
    v_mfma_f32_16x16x32_bf16 v[206:209], a[16:19], v[210:213], v[206:209]
    v_fmac_f32 v116, v128, v128
    v_fmac_f32 v116, v129, v129
    v_mfma_f32_16x16x32_bf16 v[206:209], a[20:23], v[162:165], v[206:209]
    v_mul_f32 v117, 0x3baaaaab, v234
    v_mul_f32 v254, 0x3baaaaab, v235
    v_mfma_f32_16x16x32_bf16 v[174:177], a[24:27], v[118:121], 0
    v_rsq_f32 v117, v117
    v_mfma_f32_16x16x32_bf16 v[174:177], a[28:31], v[134:137], v[174:177]
    v_rsq_f32 v254, v254
    v_mfma_f32_16x16x32_bf16 v[174:177], a[32:35], v[154:157], v[174:177]
    v_mul_f32 v255, 0x3baaaaab, v236
    v_fma_f32 v132, v206, v206, s32
    v_mfma_f32_16x16x32_bf16 v[174:177], a[36:39], v[198:201], v[174:177]
    v_fmac_f32 v132, v207, v207
    v_fmac_f32 v132, v208, v208
    v_mfma_f32_16x16x32_bf16 v[174:177], a[40:43], v[210:213], v[174:177]
    v_fmac_f32 v132, v209, v209
    v_mul_f32 v150, v117, v150
    v_mfma_f32_16x16x32_bf16 v[174:177], a[44:47], v[162:165], v[174:177]
    v_rsq_f32 v255, v255
    v_mfma_f32_16x16x32_bf16 v[218:221], a[48:51], v[118:121], 0
    v_mul_f32 v151, v117, v151
    v_cvt_pk_bf16_f32 v194, v150, v151
    v_mfma_f32_16x16x32_bf16 v[218:221], a[52:55], v[134:137], v[218:221]
    v_mul_f32 v152, v117, v152
    v_mul_f32 v153, v117, v153
    v_mfma_f32_16x16x32_bf16 v[218:221], a[56:59], v[154:157], v[218:221]
    v_fmac_f32 v132, v174, v174
    v_fmac_f32 v132, v175, v175
    v_mfma_f32_16x16x32_bf16 v[218:221], a[60:63], v[198:201], v[218:221]
    v_fmac_f32 v132, v176, v176
    v_fmac_f32 v132, v177, v177
    v_mfma_f32_16x16x32_bf16 v[218:221], a[64:67], v[210:213], v[218:221]
    v_cvt_pk_bf16_f32 v195, v152, v153
    v_mul_f32 v190, v117, v190
    v_mfma_f32_16x16x32_bf16 v[218:221], a[68:71], v[162:165], v[218:221]
    v_mul_f32 v191, v117, v191
    v_cvt_pk_bf16_f32 v196, v190, v191
    v_mfma_f32_16x16x32_bf16 v[150:153], v[118:121], a[144:147], 0
    v_mul_f32 v192, v117, v192
    v_mul_f32 v193, v117, v193
    v_mfma_f32_16x16x32_bf16 v[150:153], v[134:137], a[148:151], v[150:153]
    v_cvt_pk_bf16_f32 v197, v192, v193
    v_mul_f32 v202, v117, v202
    v_mfma_f32_16x16x32_bf16 v[150:153], v[154:157], a[152:155], v[150:153]
    buffer_store_dwordx4 v[194:197], v15, s[12:15], 0 offen nt
    v_fmac_f32 v132, v218, v218
    v_fmac_f32 v132, v219, v219
    v_fmac_f32 v132, v220, v220
    v_fmac_f32 v132, v221, v221
    v_mfma_f32_16x16x32_bf16 v[150:153], v[198:201], a[156:159], v[150:153]
    v_cvt_pk_bf16_f32 v36, v132, v116
    v_mul_f32 v203, v117, v203
    v_mfma_f32_16x16x32_bf16 v[150:153], v[210:213], a[160:163], v[150:153]
    v_cvt_pk_bf16_f32 v116, v202, v203
    v_mul_f32 v204, v117, v204
    v_mfma_f32_16x16x32_bf16 v[190:193], v[32:35], v[36:39], 0
    v_mul_f32 v205, v117, v205
    v_cvt_pk_bf16_f32 v117, v204, v205
    v_mfma_f32_16x16x32_bf16 v[150:153], v[162:165], a[164:167], v[150:153]
    v_mul_f32 v146, v255, v146
    v_mul_f32 v147, v255, v147
    v_mfma_f32_16x16x32_bf16 v[202:205], v[118:121], a[168:171], 0
    v_cvt_pk_bf16_f32 v146, v146, v147
    v_mul_f32 v148, v255, v148
    v_mfma_f32_16x16x32_bf16 v[202:205], v[134:137], a[172:175], v[202:205]
    v_rsq_f32 v191, v191
    v_mfma_f32_16x16x32_bf16 v[202:205], v[154:157], a[176:179], v[202:205]
    v_cvt_pk_bf16_f32 v172, v150, v151
    v_cvt_pk_bf16_f32 v173, v152, v153
    v_mfma_f32_16x16x32_bf16 v[202:205], v[198:201], a[180:183], v[202:205]
    v_rsq_f32 v190, v190
    v_mfma_f32_16x16x32_bf16 v[202:205], v[210:213], a[184:187], v[202:205]
    ds_read_b128 v[150:153], v0 offset:32768
    v_mul_f32 v190, s31, v190
    v_mfma_f32_16x16x32_bf16 v[202:205], v[162:165], a[188:191], v[202:205]
    ds_read_b128 v[166:169], v1 offset:32768
    v_mul_f32 v226, v191, v226
    v_mfma_f32_16x16x32_bf16 v[194:197], v[118:121], a[192:195], 0
    ds_read_b128 v[118:121], v0 offset:32896
    v_mul_f32 v227, v191, v227
    v_mfma_f32_16x16x32_bf16 v[194:197], v[134:137], a[196:199], v[194:197]
    ds_read_b128 v[134:137], v1 offset:32896
    v_cvt_pk_f16_f32 v226, v226, v227
    v_mfma_f32_16x16x32_bf16 v[194:197], v[154:157], a[200:203], v[194:197]
    ds_read_b128 v[154:157], v0 offset:33024
    v_cvt_pk_bf16_f32 v132, v202, v203
    v_mfma_f32_16x16x32_bf16 v[194:197], v[198:201], a[204:207], v[194:197]
    ds_read_b128 v[198:201], v1 offset:33024
    v_cvt_pk_bf16_f32 v133, v204, v205
    v_mfma_f32_16x16x32_bf16 v[194:197], v[210:213], a[208:211], v[194:197]
    v_mul_f32 v228, v191, v228
    v_mul_f32 v229, v191, v229
    v_mfma_f32_16x16x32_bf16 v[194:197], v[162:165], a[212:215], v[194:197]
    v_cvt_pk_f16_f32 v227, v228, v229
    v_mul_f32 v122, v191, v122
    v_mfma_f32_16x16x32_f16 v[210:213], v[242:245], v[222:225], v[46:49]
    s_waitcnt lgkmcnt(5)
    buffer_store_dwordx2 v[116:117], v18, s[12:15], 0 offen nt
    v_mul_f32 v123, v191, v123
    v_cvt_pk_f16_f32 v228, v122, v123
    v_mfma_f32_16x16x32_bf16 v[202:205], a[72:75], v[150:153], 0
    s_waitcnt lgkmcnt(3)
    v_cvt_pk_bf16_f32 v116, v194, v195
    v_cvt_pk_bf16_f32 v117, v196, v197
    v_mfma_f32_16x16x32_bf16 v[202:205], a[76:79], v[166:169], v[202:205]
    s_waitcnt lgkmcnt(2)
    v_mul_f32 v124, v191, v124
    v_mul_f32 v125, v191, v125
    v_mfma_f32_16x16x32_bf16 v[202:205], a[80:83], v[118:121], v[202:205]
    s_waitcnt lgkmcnt(1)
    v_cvt_pk_f16_f32 v229, v124, v125
    v_mul_f32 v126, v191, v126
    v_mfma_f32_16x16x32_bf16 v[202:205], a[84:87], v[134:137], v[202:205]
    s_waitcnt lgkmcnt(0)
    v_mul_f32 v127, v191, v127
    v_cvt_pk_f16_f32 v124, v126, v127
    v_mfma_f32_16x16x32_bf16 v[202:205], a[88:91], v[154:157], v[202:205]
    v_mul_f32 v128, v191, v128
    v_mul_f32 v129, v191, v129
    v_mfma_f32_16x16x32_bf16 v[202:205], a[92:95], v[198:201], v[202:205]
    v_cvt_pk_f16_f32 v125, v128, v129
    v_mul_f32 v206, v190, v206
    v_mfma_f32_16x16x32_bf16 v[126:129], a[96:99], v[150:153], 0
    v_mul_f32 v207, v190, v207
    v_cvt_pk_f16_f32 v206, v206, v207
    v_mfma_f32_16x16x32_bf16 v[126:129], a[100:103], v[166:169], v[126:129]
    v_mul_f32 v208, v190, v208
    v_mul_f32 v209, v190, v209
    v_mfma_f32_16x16x32_bf16 v[126:129], a[104:107], v[118:121], v[126:129]
    v_cvt_pk_f16_f32 v207, v208, v209
    v_mul_f32 v174, v190, v174
    v_mfma_f32_16x16x32_bf16 v[126:129], a[108:111], v[134:137], v[126:129]
    v_mul_f32 v175, v190, v175
    v_cvt_pk_f16_f32 v208, v174, v175
    v_mfma_f32_16x16x32_bf16 v[126:129], a[112:115], v[154:157], v[126:129]
    v_mul_f32 v176, v190, v176
    v_mul_f32 v177, v190, v177
    v_mfma_f32_16x16x32_bf16 v[126:129], a[116:119], v[198:201], v[126:129]
    v_cvt_pk_f16_f32 v209, v176, v177
    v_mul_f32 v218, v190, v218
    v_mfma_f32_16x16x32_bf16 v[174:177], a[120:123], v[150:153], 0
    v_mul_f32 v219, v190, v219
    v_cvt_pk_f16_f32 v122, v218, v219
    v_mfma_f32_16x16x32_bf16 v[174:177], a[124:127], v[166:169], v[174:177]
    v_mul_f32 v220, v190, v220
    v_mul_f32 v221, v190, v221
    v_mfma_f32_16x16x32_bf16 v[174:177], a[128:131], v[118:121], v[174:177]
    v_cvt_pk_f16_f32 v123, v220, v221
    v_fma_f32 v162, v202, v202, s32
    v_mfma_f32_16x16x32_bf16 v[174:177], a[132:135], v[134:137], v[174:177]
    v_fmac_f32 v162, v203, v203
    v_fmac_f32 v162, v204, v204
    v_mfma_f32_16x16x32_bf16 v[174:177], a[136:139], v[154:157], v[174:177]
    v_fmac_f32 v162, v205, v205
    v_fmac_f32 v162, v126, v126
    v_mfma_f32_16x16x32_bf16 v[174:177], a[140:143], v[198:201], v[174:177]
    v_fmac_f32 v162, v127, v127
    v_fmac_f32 v162, v128, v128
    v_mfma_f32_16x16x32_bf16 v[190:193], a[0:3], v[150:153], 0
    v_fmac_f32 v162, v129, v129
    v_mul_f32 v149, v255, v149
    v_mfma_f32_16x16x32_bf16 v[190:193], a[4:7], v[166:169], v[190:193]
    v_cvt_pk_bf16_f32 v147, v148, v149
    v_mul_f32 v138, v255, v138
    v_mfma_f32_16x16x32_bf16 v[190:193], a[8:11], v[118:121], v[190:193]
    v_fmac_f32 v162, v174, v174
    v_fmac_f32 v162, v175, v175
    v_mfma_f32_16x16x32_bf16 v[190:193], a[12:15], v[134:137], v[190:193]
    v_fmac_f32 v162, v176, v176
    v_fmac_f32 v162, v177, v177
    v_mfma_f32_16x16x32_bf16 v[190:193], a[16:19], v[154:157], v[190:193]
    v_mul_f32 v139, v255, v139
    v_cvt_pk_bf16_f32 v148, v138, v139
    v_mfma_f32_16x16x32_bf16 v[190:193], a[20:23], v[198:201], v[190:193]
    v_mul_f32 v140, v255, v140
    v_mul_f32 v141, v255, v141
    v_mfma_f32_16x16x32_bf16 v[218:221], a[24:27], v[150:153], 0
    v_cvt_pk_bf16_f32 v149, v140, v141
    v_mul_f32 v186, v255, v186
    v_mfma_f32_16x16x32_bf16 v[218:221], a[28:31], v[166:169], v[218:221]
    buffer_store_dwordx4 v[146:149], v17, s[12:15], 0 offen nt
    v_mul_f32 v187, v255, v187
    v_fma_f32 v163, v190, v190, s32
    v_fmac_f32 v163, v191, v191
    v_fmac_f32 v163, v192, v192
    v_mfma_f32_16x16x32_bf16 v[218:221], a[32:35], v[118:121], v[218:221]
    v_fmac_f32 v163, v193, v193
    v_cvt_pk_bf16_f32 v164, v186, v187
    v_mfma_f32_16x16x32_bf16 v[218:221], a[36:39], v[134:137], v[218:221]
    v_mul_f32 v188, v255, v188
    v_mul_f32 v189, v255, v189
    v_mfma_f32_16x16x32_bf16 v[218:221], a[40:43], v[154:157], v[218:221]
    v_cvt_pk_bf16_f32 v165, v188, v189
    v_mul_f32 v142, v254, v142
    v_mfma_f32_16x16x32_bf16 v[218:221], a[44:47], v[198:201], v[218:221]
    v_mul_f32 v143, v254, v143
    v_cvt_pk_bf16_f32 v142, v142, v143
    v_mfma_f32_16x16x32_bf16 v[138:141], a[48:51], v[150:153], 0
    v_mul_f32 v144, v254, v144
    v_mul_f32 v145, v254, v145
    v_mfma_f32_16x16x32_bf16 v[138:141], a[52:55], v[166:169], v[138:141]
    v_cvt_pk_bf16_f32 v143, v144, v145
    v_mul_f32 v158, v254, v158
    v_mfma_f32_16x16x32_bf16 v[138:141], a[56:59], v[118:121], v[138:141]
    v_fmac_f32 v163, v218, v218
    v_fmac_f32 v163, v219, v219
    v_mfma_f32_16x16x32_bf16 v[138:141], a[60:63], v[134:137], v[138:141]
    ds_read2_b32 v[196:197], v6 offset0:0 offset1:0
    ds_read2_b32 v[216:217], v6 offset0:16 offset1:16
    v_mfma_f32_16x16x32_bf16 v[138:141], a[64:67], v[154:157], v[138:141]
    ds_read2_b32 v[232:233], v6 offset0:32 offset1:32
    v_fmac_f32 v163, v220, v220
    v_mfma_f32_16x16x32_bf16 v[138:141], a[68:71], v[198:201], v[138:141]
    v_fmac_f32 v163, v221, v221
    v_mul_f32 v159, v254, v159
    v_mfma_f32_16x16x32_bf16 v[146:149], v[150:153], a[144:147], 0
    v_cvt_pk_bf16_f32 v144, v158, v159
    v_mul_f32 v160, v254, v160
    v_mfma_f32_16x16x32_bf16 v[146:149], v[166:169], a[148:151], v[146:149]
    v_mul_f32 v161, v254, v161
    v_cvt_pk_bf16_f32 v145, v160, v161
    v_mfma_f32_16x16x32_bf16 v[146:149], v[118:121], a[152:155], v[146:149]
    v_fmac_f32 v163, v138, v138
    v_fmac_f32 v163, v139, v139
    v_mfma_f32_16x16x32_bf16 v[146:149], v[134:137], a[156:159], v[146:149]
    v_fmac_f32 v163, v140, v140
    v_fmac_f32 v163, v141, v141
    v_mfma_f32_16x16x32_bf16 v[146:149], v[154:157], a[160:163], v[146:149]
    v_cvt_pk_bf16_f32 v36, v163, v162
    v_mul_f32 v178, v254, v178
    v_mfma_f32_16x16x32_bf16 v[146:149], v[198:201], a[164:167], v[146:149]
    s_waitcnt lgkmcnt(1)
    v_mul_f32 v179, v254, v179
    v_cvt_pk_bf16_f32 v178, v178, v179
    v_mfma_f32_16x16x32_bf16 v[158:161], v[32:35], v[36:39], 0
    s_waitcnt lgkmcnt(0)
    buffer_store_dwordx2 v[164:165], v20, s[12:15], 0 offen nt
    v_mul_f32 v180, v254, v180
    v_mul_f32 v181, v254, v181
    v_mfma_f32_16x16x32_bf16 v[186:189], v[150:153], a[168:171], 0
    v_cvt_pk_bf16_f32 v194, v146, v147
    v_cvt_pk_bf16_f32 v195, v148, v149
    v_mfma_f32_16x16x32_bf16 v[186:189], v[166:169], a[172:175], v[186:189]
    v_rsq_f32 v159, v159
    v_mfma_f32_16x16x32_bf16 v[186:189], v[118:121], a[176:179], v[186:189]
    v_rsq_f32 v158, v158
    v_mfma_f32_16x16x32_bf16 v[186:189], v[134:137], a[180:183], v[186:189]
    v_mul_f32 v158, s31, v158
    v_mul_f32 v202, v159, v202
    v_mfma_f32_16x16x32_bf16 v[186:189], v[154:157], a[184:187], v[186:189]
    v_mul_f32 v203, v159, v203
    v_cvt_pk_f16_f32 v146, v202, v203
    v_mfma_f32_16x16x32_bf16 v[186:189], v[198:201], a[188:191], v[186:189]
    v_mul_f32 v204, v159, v204
    v_mul_f32 v205, v159, v205
    v_mfma_f32_16x16x32_bf16 v[162:165], v[150:153], a[192:195], 0
    v_cvt_pk_f16_f32 v147, v204, v205
    v_mul_f32 v126, v159, v126
    v_mfma_f32_16x16x32_bf16 v[162:165], v[166:169], a[196:199], v[162:165]
    ds_read_b128 v[150:153], v5 offset:0
    ds_read_b128 v[202:205], v5 offset:16
    v_mfma_f32_16x16x32_bf16 v[162:165], v[118:121], a[200:203], v[162:165]
    ds_read_b128 v[118:121], v5 offset:48
    ds_read_b32 v254, v6 offset:192
    v_mfma_f32_16x16x32_bf16 v[162:165], v[134:137], a[204:207], v[162:165]
    v_cvt_pk_bf16_f32 v214, v186, v187
    v_cvt_pk_bf16_f32 v215, v188, v189
    v_mfma_f32_16x16x32_bf16 v[162:165], v[154:157], a[208:211], v[162:165]
    v_mul_f32 v127, v159, v127
    v_cvt_pk_f16_f32 v148, v126, v127
    v_mfma_f32_16x16x32_bf16 v[162:165], v[198:201], a[212:215], v[162:165]
    ds_read_b128 v[198:201], v2 offset:0
    ds_read_b128 v[186:189], v2 offset:1024
    v_mfma_f32_16x16x32_f16 v[134:137], v[226:229], v[222:225], v[50:53]
    ds_read_b128 v[154:157], v2 offset:2048
    v_mul_f32 v128, v159, v128
    v_mul_f32 v129, v159, v129
    v_mfma_f32_16x16x16_f16 v[210:213], v[184:185], v[182:183], v[210:213]
    v_cvt_pk_f16_f32 v149, v128, v129
    v_cvt_pk_bf16_f32 v230, v162, v163
    v_cvt_pk_bf16_f32 v231, v164, v165
    v_mul_f32 v174, v159, v174
    v_mfma_f32_16x16x32_f16 v[126:129], v[146:149], v[222:225], v[54:57]
    s_waitcnt lgkmcnt(5)
    v_mul_f32 v175, v159, v175
    v_cvt_pk_f16_f32 v164, v174, v175
    v_mul_f32 v176, v159, v176
    v_mfma_f32_16x16x16_f16 v[134:137], v[124:125], v[182:183], v[134:137]
    v_mul_f32 v177, v159, v177
    v_cvt_pk_f16_f32 v165, v176, v177
    v_mul_f32 v190, v158, v190
    v_mul_f32 v191, v158, v191
    v_mfma_f32_16x16x16_f16 v[126:129], v[164:165], v[182:183], v[126:129]
    v_cvt_pk_f16_f32 v174, v190, v191
    v_mul_f32 v192, v158, v192
    v_mul_f32 v193, v158, v193
    v_cvt_pk_f16_f32 v175, v192, v193
    v_mfma_f32_16x16x32_f16 v[166:169], v[150:153], v[222:225], v[22:25]
    s_waitcnt lgkmcnt(2)
    ds_read_b128 v[222:225], v2 offset:3072
    buffer_store_dwordx4 v[142:145], v16, s[12:15], 0 offen nt
    ds_read_b128 v[234:237], v2 offset:4096
    v_mul_f32 v218, v158, v218
    v_mul_f32 v219, v158, v219
    v_cvt_pk_f16_f32 v176, v218, v219
    v_mfma_f32_16x16x32_f16 v[166:169], v[202:205], v[242:245], v[166:169]
    s_waitcnt lgkmcnt(2)
    v_mul_f32 v220, v158, v220
    v_mul_f32 v221, v158, v221
    v_mfma_f32_16x16x32_f16 v[166:169], v[118:121], v[182:185], v[166:169]
    ds_read_b128 v[142:145], v2 offset:5120
    v_cvt_pk_f16_f32 v177, v220, v221
    v_mul_f32 v138, v158, v138
    v_mul_f32 v139, v158, v139
    v_cvt_pk_f16_f32 v162, v138, v139
    v_mfma_f32_16x16x32_f16 v[218:221], v[150:153], v[206:209], v[24:27]
    v_mul_f32 v140, v158, v140
    v_mul_f32 v141, v158, v141
    v_mfma_f32_16x16x32_f16 v[218:221], v[202:205], v[226:229], v[218:221]
    v_mov_b32_dpp v254, v167 quad_perm:[0,1,2,3] row_mask:0x1 bank_mask:0xf
    v_cvt_pk_f16_f32 v163, v140, v141
    v_mfma_f32_16x16x32_f16 v[218:221], v[118:121], v[122:125], v[218:221]
    v_max3_f32 v255, v166, v210, v211
    v_max3_f32 v255, v255, v212, v213
    v_mfma_f32_16x16x32_f16 v[238:241], v[150:153], v[174:177], v[26:29]
    s_waitcnt lgkmcnt(1)
    v_max3_f32 v255, v255, v134, v135
    v_max3_f32 v255, v255, v136, v137
    v_mfma_f32_16x16x32_f16 v[238:241], v[202:205], v[146:149], v[238:241]
    v_max3_f32 v255, v255, v126, v127
    v_mov_b32_dpp v254, v219 quad_perm:[0,1,2,3] row_mask:0x2 bank_mask:0xf
    v_mfma_f32_16x16x32_f16 v[238:241], v[118:121], v[162:165], v[238:241]
    v_max3_f32 v255, v255, v128, v129
    v_mov_b32 v182, v255
    v_mfma_f32_16x16x32_bf16 v[150:153], a[216:219], v[198:201], 0
    s_waitcnt lgkmcnt(0)
    v_permlane32_swap_b32 v255, v182
    v_mfma_f32_16x16x32_bf16 v[150:153], a[220:223], v[186:189], v[150:153]
    v_max_f32 v255, v255, v182
    v_mov_b32 v182, v255
    v_mfma_f32_16x16x32_bf16 v[150:153], a[224:227], v[154:157], v[150:153]
    v_cvt_pk_bf16_f32 v179, v180, v181
    v_xor_b32 v0, 65536, v0
    v_mfma_f32_16x16x32_bf16 v[150:153], a[228:231], v[222:225], v[150:153]
    s_waitcnt vmcnt(5)
    v_permlane16_swap_b32 v255, v182
    v_mfma_f32_16x16x32_bf16 v[150:153], a[232:235], v[234:237], v[150:153]
    s_nop 0
    v_max_f32 v255, v255, v182
    v_sub_f32 v210, v210, v255
    v_mfma_f32_16x16x32_bf16 v[150:153], a[236:239], v[142:145], v[150:153]
    s_nop 0
    v_exp_f32 v210, v210
    v_mfma_f32_16x16x32_bf16 v[190:193], a[240:243], v[198:201], 0
    s_nop 0
    v_sub_f32 v211, v211, v255
    v_sub_f32 v212, v212, v255
    v_mfma_f32_16x16x32_bf16 v[190:193], a[244:247], v[186:189], v[190:193]
    s_barrier
    buffer_load_dwordx4 v10, s[8:11], 0 offen nt lds
    v_sub_f32 v213, v213, v255
    v_mfma_f32_16x16x32_bf16 v[190:193], a[248:251], v[154:157], v[190:193]
    s_add_u32 m0, s28, 4096
    v_exp_f32 v211, v211
    v_mfma_f32_16x16x32_bf16 v[190:193], a[252:255], v[222:225], v[190:193]
    v_cvt_pk_bf16_f32 v158, v210, v211
    v_sub_f32 v134, v134, v255
    v_mfma_f32_16x16x32_bf16 v[190:193], v[82:85], v[234:237], v[190:193]
    v_exp_f32 v212, v212
    v_mfma_f32_16x16x32_bf16 v[190:193], v[86:89], v[142:145], v[190:193]
    v_exp_f32 v213, v213
    v_mfma_f32_16x16x32_bf16 v[202:205], v[90:93], v[198:201], 0
    ds_read_b128 v[198:201], v2 offset:6144
    buffer_load_dwordx4 v11, s[8:11], 0 offen nt lds
    v_mfma_f32_16x16x32_bf16 v[202:205], v[94:97], v[186:189], v[202:205]
    s_add_u32 m0, s28, 8192
    ds_read_b128 v[138:141], v2 offset:7168
    v_cvt_pk_bf16_f32 v159, v212, v213
    v_mfma_f32_16x16x32_bf16 v[202:205], v[98:101], v[154:157], v[202:205]
    ds_read_b128 v[210:213], v2 offset:8192
    v_sub_f32 v135, v135, v255
    v_mfma_f32_16x16x32_bf16 v[202:205], v[102:105], v[222:225], v[202:205]
    ds_read_b128 v[186:189], v2 offset:9216
    v_sub_f32 v136, v136, v255
    v_mfma_f32_16x16x32_bf16 v[202:205], v[106:109], v[234:237], v[202:205]
    ds_read_b128 v[222:225], v2 offset:10240
    v_sub_f32 v137, v137, v255
    v_mfma_f32_16x16x32_bf16 v[202:205], v[110:113], v[142:145], v[202:205]
    ds_read_b128 v[154:157], v2 offset:11264
    buffer_load_dwordx4 v12, s[8:11], 0 offen nt lds
    v_exp_f32 v134, v134
    v_mfma_f32_16x16x32_f16 v[118:121], v[242:245], v[206:209], v[58:61]
    s_add_u32 m0, s28, 12288
    v_exp_f32 v135, v135
    v_exp_f32 v136, v136
    v_cvt_pk_bf16_f32 v160, v134, v135
    v_exp_f32 v137, v137
    v_sub_f32 v126, v126, v255
    v_mfma_f32_16x16x16_f16 v[118:121], v[184:185], v[122:123], v[118:121]
    v_cvt_pk_bf16_f32 v161, v136, v137
    v_exp_f32 v126, v126
    v_sub_f32 v127, v127, v255
    v_mfma_f32_16x16x32_f16 v[134:137], v[226:229], v[206:209], v[62:65]
    s_xor_b32 s28, s28, 65536
    buffer_load_dwordx4 v13, s[8:11], 0 offen nt lds
    v_exp_f32 v127, v127
    v_sub_f32 v128, v128, v255
    v_cvt_pk_bf16_f32 v36, v126, v127
    v_exp_f32 v128, v128
    v_mfma_f32_16x16x16_f16 v[134:137], v[124:125], v[122:123], v[134:137]
    v_sub_f32 v129, v129, v255
    v_exp_f32 v129, v129
    v_sub_f32 v166, v166, v255
    v_cvt_pk_bf16_f32 v37, v128, v129
    v_mfma_f32_16x16x32_f16 v[126:129], v[146:149], v[206:209], v[66:69]
    s_waitcnt lgkmcnt(0)
    v_exp_f32 v166, v166
    v_mfma_f32_16x16x32_bf16 v[142:145], a[216:219], v[198:201], 0
    s_mov_b32 m0, s29
    v_cvt_pk_bf16_f32 v39, v166, 0
    v_max3_f32 v255, v218, v118, v119
    v_max3_f32 v255, v255, v120, v121
    v_mfma_f32_16x16x16_f16 v[126:129], v[164:165], v[122:123], v[126:129]
    v_max3_f32 v255, v255, v134, v135
    v_max3_f32 v255, v255, v136, v137
    v_xor_b32 v1, 65536, v1
    v_mov_b32_dpp v254, v239 quad_perm:[0,1,2,3] row_mask:0x4 bank_mask:0xf
    v_mfma_f32_16x16x32_bf16 v[206:209], v[28:31], v[36:39], 0
    s_xor_b32 s29, s29, s30
    buffer_store_dwordx2 v[178:179], v19, s[12:15], 0 offen nt
    v_mov_b32 v122, v254
    v_max3_f32 v255, v255, v126, v127
    v_mfma_f32_16x16x32_bf16 v[206:209], v[28:31], v[158:161], v[206:209]
    s_add_u32 s19, s19, s20
    v_max3_f32 v255, v255, v128, v129
    v_mov_b32 v123, v255
    v_mfma_f32_16x16x32_bf16 v[142:145], a[220:223], v[138:141], v[142:145]
    s_add_u32 s23, s23, s21
    v_permlane32_swap_b32 v255, v123
    v_mfma_f32_16x16x32_bf16 v[142:145], a[224:227], v[210:213], v[142:145]
    s_cmp_ge_u32 s19, 72
    v_rcp_f32 v206, v206
    v_mfma_f32_16x16x32_bf16 v[142:145], a[228:231], v[186:189], v[142:145]
    s_cselect_b32 s34, 72, 0
    v_max_f32 v255, v255, v123
    v_mov_b32 v123, v255
    v_mfma_f32_16x16x32_bf16 v[142:145], a[232:235], v[222:225], v[142:145]
    s_cselect_b32 s35, s22, 0
    v_permlane16_swap_b32 v255, v123
    v_mfma_f32_16x16x32_bf16 v[142:145], a[236:239], v[154:157], v[142:145]
    s_sub_u32 s19, s19, s34
    v_max_f32 v255, v255, v123
    v_sub_f32 v118, v118, v255
    v_mfma_f32_16x16x32_bf16 v[178:181], v[194:197], v[36:39], 0
    s_add_u32 s23, s23, s35
    v_exp_f32 v118, v118
    v_mfma_f32_16x16x32_bf16 v[178:181], v[170:173], v[158:161], v[178:181]
    s_add_u32 s18, s18, 1
    v_sub_f32 v119, v119, v255
    v_exp_f32 v119, v119
    v_sub_f32 v120, v120, v255
    v_cvt_pk_bf16_f32 v118, v118, v119
    v_exp_f32 v120, v120
    v_sub_f32 v121, v121, v255
    v_exp_f32 v121, v121
    v_mul_f32 v178, v206, v178
    v_mul_f32 v179, v206, v179
    v_cvt_pk_bf16_f32 v178, v178, v179
    v_mul_f32 v180, v206, v180
    v_mul_f32 v181, v206, v181
    v_cvt_pk_bf16_f32 v179, v180, v181
    v_cvt_pk_bf16_f32 v119, v120, v121
    v_mfma_f32_16x16x32_bf16 v[166:169], v[214:217], v[36:39], 0
    s_cmp_lt_u32 s18, s45
    v_sub_f32 v134, v134, v255
    v_sub_f32 v135, v135, v255
    v_mfma_f32_16x16x32_bf16 v[166:169], v[130:133], v[158:161], v[166:169]
    v_exp_f32 v134, v134
    v_exp_f32 v135, v135
    v_sub_f32 v136, v136, v255
    v_cvt_pk_bf16_f32 v120, v134, v135
    v_exp_f32 v136, v136
    v_sub_f32 v137, v137, v255
    v_exp_f32 v137, v137
    v_sub_f32 v126, v126, v255
    v_mul_f32 v166, v206, v166
    v_mul_f32 v167, v206, v167
    v_cvt_pk_bf16_f32 v180, v166, v167
    v_mul_f32 v168, v206, v168
    v_mul_f32 v169, v206, v169
    v_cvt_pk_bf16_f32 v181, v168, v169
    v_cvt_pk_bf16_f32 v121, v136, v137
    v_mfma_f32_16x16x32_bf16 v[134:137], v[230:233], v[36:39], 0
    buffer_load_dwordx4 v14, s[8:11], 0 offen nt lds
    v_sub_f32 v127, v127, v255
    v_mfma_f32_16x16x32_bf16 v[134:137], v[114:117], v[158:161], v[134:137]
    ds_write_b128 v3, v[178:181] offset:0
    v_mfma_f32_16x16x32_bf16 v[158:161], a[240:243], v[198:201], 0
    v_exp_f32 v126, v126
    v_mfma_f32_16x16x32_bf16 v[158:161], a[244:247], v[138:141], v[158:161]
    v_exp_f32 v127, v127
    v_mfma_f32_16x16x32_bf16 v[158:161], a[248:251], v[210:213], v[158:161]
    v_cvt_pk_bf16_f32 v36, v126, v127
    v_sub_f32 v128, v128, v255
    v_mfma_f32_16x16x32_bf16 v[158:161], a[252:255], v[186:189], v[158:161]
    v_mul_f32 v134, v206, v134
    v_mul_f32 v135, v206, v135
    v_mfma_f32_16x16x32_bf16 v[158:161], v[82:85], v[222:225], v[158:161]
    v_cvt_pk_bf16_f32 v126, v134, v135
    v_mul_f32 v136, v206, v136
    v_mfma_f32_16x16x32_bf16 v[158:161], v[86:89], v[154:157], v[158:161]
    v_mul_f32 v137, v206, v137
    v_cvt_pk_bf16_f32 v127, v136, v137
    v_mfma_f32_16x16x32_bf16 v[178:181], v[90:93], v[198:201], 0
    ds_read_b128 v[198:201], v2 offset:12288
    v_sub_f32 v129, v129, v255
    v_mfma_f32_16x16x32_bf16 v[178:181], v[94:97], v[138:141], v[178:181]
    ds_read_b128 v[206:209], v2 offset:13312
    v_sub_f32 v218, v218, v255
    v_mfma_f32_16x16x32_bf16 v[178:181], v[98:101], v[210:213], v[178:181]
    ds_read_b128 v[210:213], v2 offset:14336
    v_max_f32_dpp v122, v122, v122 quad_perm:[1,0,3,2] row_mask:0xf bank_mask:0xf
    v_mfma_f32_16x16x32_bf16 v[178:181], v[102:105], v[186:189], v[178:181]
    ds_read_b128 v[134:137], v2 offset:15360
    v_max_f32_dpp v122, v122, v122 quad_perm:[2,3,0,1] row_mask:0xf bank_mask:0xf
    v_mfma_f32_16x16x32_bf16 v[178:181], v[106:109], v[222:225], v[178:181]
    ds_read_b128 v[222:225], v2 offset:16384
    v_max_f32_dpp v122, v122, v122 row_half_mirror row_mask:0xf bank_mask:0xf
    v_mfma_f32_16x16x32_bf16 v[178:181], v[110:113], v[154:157], v[178:181]
    ds_read_b128 v[154:157], v2 offset:17408
    ds_write_b64 v4, v[126:127] offset:4096
    v_exp_f32 v128, v128
    v_exp_f32 v129, v129
    v_mfma_f32_16x16x32_f16 v[186:189], v[242:245], v[174:177], v[70:73]
    s_waitcnt lgkmcnt(6)
    v_cvt_pk_bf16_f32 v37, v128, v129
    v_max_f32_dpp v122, v122, v122 row_mirror row_mask:0xf bank_mask:0xf
    v_mfma_f32_16x16x32_f16 v[242:245], v[226:229], v[174:177], v[74:77]
    s_waitcnt lgkmcnt(5)
    v_exp_f32 v218, v218
    v_mfma_f32_16x16x32_f16 v[126:129], v[146:149], v[174:177], v[78:81]
    s_waitcnt lgkmcnt(4)
    v_cvt_pk_bf16_f32 v39, v218, 0
    v_mov_b32 v123, v122
    v_fma_f32 v255, v150, v150, s33
    v_mfma_f32_16x16x32_bf16 v[174:177], v[28:31], v[36:39], 0
    s_waitcnt lgkmcnt(3)
    v_permlane32_swap_b32 v122, v123
    v_mfma_f32_16x16x32_bf16 v[174:177], v[28:31], v[118:121], v[174:177]
    s_waitcnt lgkmcnt(2)
    v_max_f32 v122, v122, v123
    v_mov_b32 v123, v122
    v_mfma_f32_16x16x32_bf16 v[226:229], v[194:197], v[36:39], 0
    s_waitcnt lgkmcnt(0)
    v_permlane16_swap_b32 v122, v123
    v_mfma_f32_16x16x32_bf16 v[226:229], v[170:173], v[118:121], v[226:229]
    v_max_f32 v122, v122, v123
    v_sub_f32 v254, v254, v122
    v_mfma_f32_16x16x32_bf16 v[218:221], v[214:217], v[36:39], 0
    v_exp_f32 v254, v254
    v_mfma_f32_16x16x32_bf16 v[218:221], v[130:133], v[118:121], v[218:221]
    v_cvt_pk_bf16_f32 v254, v254, v254
    v_fmac_f32 v255, v151, v151
    v_mfma_f32_16x16x32_bf16 v[166:169], v[230:233], v[36:39], 0
    ds_write_b16 v8, v254
    v_mfma_f32_16x16x32_bf16 v[166:169], v[114:117], v[118:121], v[166:169]
    v_rcp_f32 v174, v174
    v_fmac_f32 v255, v152, v152
    v_mfma_f32_16x16x16_f16 v[186:189], v[184:185], v[162:163], v[186:189]
    v_mul_f32 v226, v174, v226
    v_mul_f32 v227, v174, v227
    v_cvt_pk_bf16_f32 v122, v226, v227
    v_mfma_f32_16x16x16_f16 v[242:245], v[124:125], v[162:163], v[242:245]
    v_mul_f32 v228, v174, v228
    v_mul_f32 v229, v174, v229
    v_cvt_pk_bf16_f32 v123, v228, v229
    v_mfma_f32_16x16x16_f16 v[126:129], v[164:165], v[162:163], v[126:129]
    v_max3_f32 v254, v238, v186, v187
    v_max3_f32 v254, v254, v188, v189
    v_mul_f32 v218, v174, v218
    v_mul_f32 v219, v174, v219
    v_mfma_f32_16x16x32_bf16 v[146:149], a[216:219], v[198:201], 0
    ds_read_b128 v[118:121], v9
    ds_read_b128 v[162:165], v9 offset:64
    v_mfma_f32_16x16x32_bf16 v[146:149], a[220:223], v[206:209], v[146:149]
    v_max3_f32 v254, v254, v242, v243
    v_max3_f32 v254, v254, v244, v245
    v_mfma_f32_16x16x32_bf16 v[146:149], a[224:227], v[210:213], v[146:149]
    v_max3_f32 v254, v254, v126, v127
    v_max3_f32 v254, v254, v128, v129
    v_mfma_f32_16x16x32_bf16 v[146:149], a[228:231], v[134:137], v[146:149]
    v_mov_b32 v125, v254
    v_cvt_pk_bf16_f32 v124, v218, v219
    v_mfma_f32_16x16x32_bf16 v[146:149], a[232:235], v[222:225], v[146:149]
    v_permlane32_swap_b32 v254, v125
    v_mfma_f32_16x16x32_bf16 v[146:149], a[236:239], v[154:157], v[146:149]
    v_max_f32 v254, v254, v125
    v_mov_b32 v125, v254
    v_mfma_f32_16x16x32_bf16 v[138:141], a[240:243], v[198:201], 0
    v_mul_f32 v220, v174, v220
    v_mul_f32 v221, v174, v221
    v_mfma_f32_16x16x32_bf16 v[138:141], a[244:247], v[206:209], v[138:141]
    v_permlane16_swap_b32 v254, v125
    v_mfma_f32_16x16x32_bf16 v[138:141], a[248:251], v[210:213], v[138:141]
    s_waitcnt lgkmcnt(0)
    v_max_f32 v254, v254, v125
    v_sub_f32 v186, v186, v254
    v_mfma_f32_16x16x32_bf16 v[138:141], a[252:255], v[134:137], v[138:141]
    v_exp_f32 v186, v186
    v_mfma_f32_16x16x32_bf16 v[138:141], v[82:85], v[222:225], v[138:141]
    v_sub_f32 v187, v187, v254
    v_sub_f32 v188, v188, v254
    v_mfma_f32_16x16x32_bf16 v[138:141], v[86:89], v[154:157], v[138:141]
    v_exp_f32 v187, v187
    v_exp_f32 v188, v188
    v_cvt_pk_bf16_f32 v234, v186, v187
    v_sub_f32 v189, v189, v254
    v_exp_f32 v189, v189
    v_sub_f32 v242, v242, v254
    v_cvt_pk_bf16_f32 v235, v188, v189
    v_exp_f32 v242, v242
    v_sub_f32 v243, v243, v254
    v_exp_f32 v243, v243
    v_sub_f32 v244, v244, v254
    v_cvt_pk_bf16_f32 v236, v242, v243
    v_mfma_f32_16x16x32_bf16 v[186:189], v[90:93], v[198:201], 0
    v_exp_f32 v244, v244
    v_mfma_f32_16x16x32_bf16 v[186:189], v[94:97], v[206:209], v[186:189]
    v_sub_f32 v245, v245, v254
    v_sub_f32 v126, v126, v254
    v_mfma_f32_16x16x32_bf16 v[186:189], v[98:101], v[210:213], v[186:189]
    v_exp_f32 v245, v245
    v_mfma_f32_16x16x32_bf16 v[186:189], v[102:105], v[134:137], v[186:189]
    v_cvt_pk_bf16_f32 v237, v244, v245
    v_sub_f32 v127, v127, v254
    v_mfma_f32_16x16x32_bf16 v[186:189], v[106:109], v[222:225], v[186:189]
    v_exp_f32 v126, v126
    v_mfma_f32_16x16x32_bf16 v[186:189], v[110:113], v[154:157], v[186:189]
    ds_read_b128 v[182:185], v0 offset:20480
    ds_read_b128 v[198:201], v1 offset:20480
    v_mfma_f32_16x16x32_bf16 v[206:209], v[118:121], v[28:31], 0
    ds_read_b128 v[210:213], v0 offset:20608
    ds_read_b128 v[222:225], v1 offset:20608
    v_mfma_f32_16x16x32_bf16 v[206:209], v[162:165], v[28:31], v[206:209]
    v_exp_f32 v127, v127
    v_mfma_f32_16x16x32_bf16 v[154:157], v[118:121], v[170:173], 0
    ds_read_b128 v[226:229], v0 offset:20736
    v_cvt_pk_bf16_f32 v36, v126, v127
    v_mfma_f32_16x16x32_bf16 v[154:157], v[162:165], v[194:197], v[154:157]
    ds_read_b128 v[242:245], v1 offset:20736
    v_sub_f32 v128, v128, v254
    v_exp_f32 v128, v128
    v_sub_f32 v129, v129, v254
    v_exp_f32 v129, v129
    v_sub_f32 v238, v238, v254
    v_cvt_pk_bf16_f32 v37, v128, v129
    v_mfma_f32_16x16x32_bf16 v[134:137], v[118:121], v[130:133], 0
    v_exp_f32 v238, v238
    v_mfma_f32_16x16x32_bf16 v[134:137], v[162:165], v[214:217], v[134:137]
    s_waitcnt lgkmcnt(4)
    v_cvt_pk_bf16_f32 v39, v238, 0
    v_cvt_pk_bf16_f32 v125, v220, v221
    v_mfma_f32_16x16x32_bf16 v[218:221], v[118:121], v[114:117], 0
    s_waitcnt lgkmcnt(2)
    ds_write_b128 v3, v[122:125] offset:6144
    v_mfma_f32_16x16x32_bf16 v[126:129], v[28:31], v[36:39], 0
    s_waitcnt lgkmcnt(2)
    v_mul_f32 v166, v174, v166
    v_mul_f32 v167, v174, v167
    v_mfma_f32_16x16x32_bf16 v[126:129], v[28:31], v[234:237], v[126:129]
    s_waitcnt lgkmcnt(1)
    v_cvt_pk_bf16_f32 v166, v166, v167
    v_mul_f32 v168, v174, v168
    v_mfma_f32_16x16x32_bf16 v[122:125], v[194:197], v[36:39], 0
    v_mul_f32 v169, v174, v169
    v_cvt_pk_bf16_f32 v167, v168, v169
    v_mfma_f32_16x16x32_bf16 v[122:125], v[170:173], v[234:237], v[122:125]
    ds_write_b64 v4, v[166:167] offset:10240
    v_mfma_f32_16x16x32_bf16 v[170:173], v[214:217], v[36:39], 0
    v_rcp_f32 v126, v126
    v_mfma_f32_16x16x32_bf16 v[170:173], v[130:133], v[234:237], v[170:173]
    v_fma_f32 v254, v146, v146, s33
    v_fmac_f32 v254, v147, v147
    v_mfma_f32_16x16x32_bf16 v[174:177], v[230:233], v[36:39], 0
    v_fmac_f32 v254, v148, v148
    v_mul_f32 v122, v126, v122
    v_mfma_f32_16x16x32_bf16 v[174:177], v[114:117], v[234:237], v[174:177]
    v_mul_f32 v123, v126, v123
    v_cvt_pk_bf16_f32 v122, v122, v123
    v_mfma_f32_16x16x32_bf16 v[218:221], v[162:165], v[230:233], v[218:221]
    v_mul_f32 v124, v126, v124
    v_mul_f32 v125, v126, v125
    v_mfma_f32_16x16x32_bf16 v[114:117], a[72:75], v[182:185], 0
    v_cvt_pk_bf16_f32 v123, v124, v125
    v_mul_f32 v170, v126, v170
    v_mfma_f32_16x16x32_bf16 v[114:117], a[76:79], v[198:201], v[114:117]
    v_mul_f32 v171, v126, v171
    v_cvt_pk_bf16_f32 v124, v170, v171
    v_mfma_f32_16x16x32_bf16 v[114:117], a[80:83], v[210:213], v[114:117]
    v_mul_f32 v172, v126, v172
    v_mul_f32 v173, v126, v173
    v_mfma_f32_16x16x32_bf16 v[114:117], a[84:87], v[222:225], v[114:117]
    v_cvt_pk_bf16_f32 v125, v172, v173
    v_mul_f32 v174, v126, v174
    v_mfma_f32_16x16x32_bf16 v[114:117], a[88:91], v[226:229], v[114:117]
    ds_write_b128 v3, v[122:125] offset:12288
    v_mfma_f32_16x16x32_bf16 v[114:117], a[92:95], v[242:245], v[114:117]
    v_mul_f32 v175, v126, v175
    v_cvt_pk_bf16_f32 v174, v174, v175
    v_mfma_f32_16x16x32_bf16 v[122:125], a[96:99], v[182:185], 0
    v_mul_f32 v176, v126, v176
    v_mul_f32 v177, v126, v177
    v_mfma_f32_16x16x32_bf16 v[122:125], a[100:103], v[198:201], v[122:125]
    v_cvt_pk_bf16_f32 v175, v176, v177
    v_fmac_f32 v254, v149, v149
    v_mfma_f32_16x16x32_bf16 v[122:125], a[104:107], v[210:213], v[122:125]
    ds_write_b64 v4, v[174:175] offset:16384
    v_mfma_f32_16x16x32_bf16 v[122:125], a[108:111], v[222:225], v[122:125]
    v_fmac_f32 v254, v138, v138
    v_fmac_f32 v254, v139, v139
    v_mfma_f32_16x16x32_bf16 v[122:125], a[112:115], v[226:229], v[122:125]
    v_fmac_f32 v254, v140, v140
    v_fmac_f32 v254, v141, v141
    v_mfma_f32_16x16x32_bf16 v[122:125], a[116:119], v[242:245], v[122:125]
    v_fmac_f32 v254, v186, v186
    v_fmac_f32 v254, v187, v187
    v_mfma_f32_16x16x32_bf16 v[126:129], a[120:123], v[182:185], 0
    v_fmac_f32 v254, v188, v188
    v_fmac_f32 v254, v189, v189
    v_mfma_f32_16x16x32_bf16 v[126:129], a[124:127], v[198:201], v[126:129]
    v_cvt_pk_bf16_f32 v155, v254, v254
    v_fmac_f32 v255, v153, v153
    v_mfma_f32_16x16x32_bf16 v[126:129], a[128:131], v[210:213], v[126:129]
    v_rcp_f32 v206, v206
    v_mfma_f32_16x16x32_bf16 v[126:129], a[132:135], v[222:225], v[126:129]
    v_mul_f32 v154, v154, v206
    v_mul_f32_dpp v154, v134, v206 quad_perm:[0,1,2,3] row_mask:0x2 bank_mask:0xf
    v_mfma_f32_16x16x32_bf16 v[126:129], a[136:139], v[226:229], v[126:129]
    v_mul_f32_dpp v154, v218, v206 quad_perm:[0,1,2,3] row_mask:0x4 bank_mask:0xf
    v_cvt_pk_bf16_f32 v154, v154, v154
    v_mfma_f32_16x16x32_bf16 v[126:129], a[140:143], v[242:245], v[126:129]
    ds_write_b16 v7, v154
    v_mfma_f32_16x16x32_bf16 v[206:209], a[0:3], v[182:185], 0
    v_fmac_f32 v255, v190, v190
    v_fmac_f32 v255, v191, v191
    v_mfma_f32_16x16x32_bf16 v[206:209], a[4:7], v[198:201], v[206:209]
    v_fmac_f32 v255, v192, v192
    v_fmac_f32 v255, v193, v193
    v_mfma_f32_16x16x32_bf16 v[206:209], a[8:11], v[210:213], v[206:209]
    v_fmac_f32 v255, v202, v202
    v_fmac_f32 v255, v203, v203
    v_mfma_f32_16x16x32_bf16 v[206:209], a[12:15], v[222:225], v[206:209]
    v_fmac_f32 v255, v204, v204
    v_fmac_f32 v255, v205, v205
    v_mfma_f32_16x16x32_bf16 v[206:209], a[16:19], v[226:229], v[206:209]
    v_fma_f32 v254, v142, v142, s33
    v_fmac_f32 v254, v143, v143
    v_mfma_f32_16x16x32_bf16 v[206:209], a[20:23], v[242:245], v[206:209]
    v_fmac_f32 v254, v144, v144
    v_fmac_f32 v254, v145, v145
    v_mfma_f32_16x16x32_bf16 v[174:177], a[24:27], v[182:185], 0
    v_fmac_f32 v254, v158, v158
    v_fmac_f32 v254, v159, v159
    v_mfma_f32_16x16x32_bf16 v[174:177], a[28:31], v[198:201], v[174:177]
    v_fmac_f32 v254, v160, v160
    v_fmac_f32 v254, v161, v161
    v_mfma_f32_16x16x32_bf16 v[174:177], a[32:35], v[210:213], v[174:177]
    v_fmac_f32 v254, v178, v178
    v_fmac_f32 v254, v179, v179
    v_mfma_f32_16x16x32_bf16 v[174:177], a[36:39], v[222:225], v[174:177]
    v_fmac_f32 v254, v180, v180
    v_fmac_f32 v254, v181, v181
    v_mfma_f32_16x16x32_bf16 v[174:177], a[40:43], v[226:229], v[174:177]
    v_cvt_pk_bf16_f32 v154, v255, v254
    v_add_u32 v5, 336, v5
    v_mfma_f32_16x16x32_bf16 v[174:177], a[44:47], v[242:245], v[174:177]
    ds_write_b64 v4, v[154:155] offset:18432
    v_mfma_f32_16x16x32_bf16 v[218:221], a[48:51], v[182:185], 0
    v_add_u32 v6, 272, v6
    v_add_u32 v7, 16, v7
    v_mfma_f32_16x16x32_bf16 v[218:221], a[52:55], v[198:201], v[218:221]
    v_fma_f32 v130, v114, v114, s32
    v_fmac_f32 v130, v115, v115
    v_mfma_f32_16x16x32_bf16 v[218:221], a[56:59], v[210:213], v[218:221]
    v_fmac_f32 v130, v116, v116
    v_fmac_f32 v130, v117, v117
    v_mfma_f32_16x16x32_bf16 v[218:221], a[60:63], v[222:225], v[218:221]
    v_fmac_f32 v130, v122, v122
    v_fmac_f32 v130, v123, v123
    v_mfma_f32_16x16x32_bf16 v[218:221], a[64:67], v[226:229], v[218:221]
    v_fmac_f32 v130, v124, v124
    v_fmac_f32 v130, v125, v125
    v_mfma_f32_16x16x32_bf16 v[218:221], a[68:71], v[242:245], v[218:221]
    v_fmac_f32 v130, v126, v126
    v_fmac_f32 v130, v127, v127
    v_mfma_f32_16x16x32_bf16 v[170:173], v[182:185], a[144:147], 0
    s_waitcnt lgkmcnt(0)
    v_fmac_f32 v130, v128, v128
    v_fmac_f32 v130, v129, v129
    v_mfma_f32_16x16x32_bf16 v[170:173], v[198:201], a[148:151], v[170:173]
    s_nop 0
    v_fma_f32 v131, v206, v206, s32
    v_fmac_f32 v131, v207, v207
    v_mfma_f32_16x16x32_bf16 v[170:173], v[210:213], a[152:155], v[170:173]
    s_nop 0
    v_fmac_f32 v131, v208, v208
    v_fmac_f32 v131, v209, v209
    v_mfma_f32_16x16x32_bf16 v[170:173], v[222:225], a[156:159], v[170:173]
    s_nop 0
    v_fmac_f32 v131, v174, v174
    v_xor_b32 v2, 65536, v2
    v_mfma_f32_16x16x32_bf16 v[170:173], v[226:229], a[160:163], v[170:173]
    s_barrier
    v_xor_b32 v3, 65536, v3
    v_xor_b32 v4, 65536, v4
    v_mfma_f32_16x16x32_bf16 v[170:173], v[242:245], a[164:167], v[170:173]
    s_cbranch_scc1 L_loop_safe3
L_final_safe:
    v_mfma_f32_16x16x32_bf16 v[118:121], v[182:185], a[168:171], 0
    s_mov_b32 s12, s42
    ds_read_b128 v[134:137], v2 offset:18432
    ds_read_b128 v[154:157], v2 offset:19456
    v_mfma_f32_16x16x32_bf16 v[118:121], v[198:201], a[172:175], v[118:121]
    s_mov_b32 s13, s43
    ds_read_b128 v[162:165], v0 offset:26624
    ds_read_b128 v[166:169], v1 offset:26624
    v_mfma_f32_16x16x32_bf16 v[118:121], v[210:213], a[176:179], v[118:121]
    s_mov_b32 s14, s36
    v_bfe_u32 v254, v2, 4, 6
    v_lshrrev_b32 v255, 4, v254
    v_mfma_f32_16x16x32_bf16 v[118:121], v[222:225], a[180:183], v[118:121]
    s_add_u32 s48, s42, s27
    ds_read_b128 v[194:197], v0 offset:26752
    ds_read_b128 v[214:217], v1 offset:26752
    v_mfma_f32_16x16x32_bf16 v[118:121], v[226:229], a[184:187], v[118:121]
    s_addc_u32 s49, s43, 0
    v_and_b32 v132, 15, v254
    v_lshlrev_b32 v133, 9, v255
    v_mfma_f32_16x16x32_bf16 v[118:121], v[242:245], a[188:191], v[118:121]
    s_sub_u32 s50, s36, s27
    ds_read_b128 v[230:233], v0 offset:26880
    s_mov_b32 s51, 0x00020000
    s_add_u32 s52, s42, s26
    s_addc_u32 s53, s43, 0
    s_sub_u32 s54, s36, s26
    s_mov_b32 s55, 0x00020000
    s_add_u32 s56, s42, s25
    s_addc_u32 s57, s43, 0
    s_sub_u32 s58, s36, s25
    s_mov_b32 s59, 0x00020000
    v_lshl_add_u32 v133, v132, 4, v133
    v_add_u32 v133, 136704, v133
    v_and_b32 v234, 0xffff, v2
    v_add_u32 v234, 148992, v234
    v_and_b32 v235, 0xffff, v4
    v_add_u32 v235, 148992, v235
    v_fmac_f32 v131, v175, v175
    v_fmac_f32 v131, v176, v176
    v_fmac_f32 v131, v177, v177
    v_fmac_f32 v131, v218, v218
    v_fmac_f32 v131, v219, v219
    v_fmac_f32 v131, v220, v220
    v_fmac_f32 v131, v221, v221
    v_cvt_pk_bf16_f32 v36, v131, v130
    v_cvt_pk_bf16_f32 v170, v170, v171
    v_cvt_pk_bf16_f32 v171, v172, v173
    v_mfma_f32_16x16x32_bf16 v[238:241], v[32:35], v[36:39], 0
    v_cvt_pk_bf16_f32 v118, v118, v119
    v_cvt_pk_bf16_f32 v119, v120, v121
    v_mfma_f32_16x16x32_bf16 v[246:249], v[182:185], a[192:195], 0
    s_waitcnt lgkmcnt(0)
    ds_read_b128 v[182:185], v1 offset:26880
    v_mov_b32 v236, 0x40000000
    v_mfma_f32_16x16x32_bf16 v[246:249], v[198:201], a[196:199], v[246:249]
    s_lshl_b32 s3, s16, 6
    v_rsq_f32 v239, v239
    v_mfma_f32_16x16x32_bf16 v[246:249], v[210:213], a[200:203], v[246:249]
    s_lshl_b32 s4, s16, 5
    ds_read_b128 v[198:201], v2 offset:0
    v_mul_f32 v114, v239, v114
    v_mfma_f32_16x16x32_bf16 v[246:249], v[222:225], a[204:207], v[246:249]
    s_add_u32 s4, s4, 256
    ds_read_b128 v[210:213], v2 offset:1024
    v_mul_f32 v115, v239, v115
    v_mfma_f32_16x16x32_bf16 v[246:249], v[226:229], a[208:211], v[246:249]
    s_mul_i32 s5, s16, 8064
    ds_read_b128 v[222:225], v2 offset:2048
    v_cvt_pk_f16_f32 v114, v114, v115
    v_mfma_f32_16x16x32_bf16 v[226:229], v[32:35], v[134:137], 0
    s_add_u32 s5, s5, 104448
    ds_read_b128 v[134:137], v2 offset:3072
    v_mul_f32 v116, v239, v116
    v_mfma_f32_16x16x32_bf16 v[226:229], v[32:35], v[154:157], v[226:229]
    ds_read_b128 v[154:157], v2 offset:4096
    v_mul_f32 v117, v239, v117
    v_mfma_f32_16x16x32_bf16 v[246:249], v[242:245], a[212:215], v[246:249]
    ds_read_b128 v[242:245], v2 offset:5120
    v_rsq_f32 v238, v238
    v_cvt_pk_f16_f32 v115, v116, v117
    v_mul_f32 v238, s31, v238
    v_mul_f32 v122, v239, v122
    v_mul_f32 v237, 0x3baaaaab, v227
    v_rsq_f32 v237, v237
    v_mul_f32 v116, 0x3baaaaab, v228
    v_mul_f32 v142, v237, v142
    v_mul_f32 v143, v237, v143
    v_cvt_pk_bf16_f32 v142, v142, v143
    v_mul_f32 v144, v237, v144
    v_mul_f32 v145, v237, v145
    v_cvt_pk_bf16_f32 v143, v144, v145
    v_mfma_f32_16x16x32_bf16 v[250:253], a[72:75], v[162:165], 0
    s_waitcnt lgkmcnt(3)
    v_mul_f32 v158, v237, v158
    v_mul_f32 v159, v237, v159
    v_mfma_f32_16x16x32_bf16 v[250:253], a[76:79], v[166:169], v[250:253]
    s_waitcnt lgkmcnt(2)
    v_cvt_pk_bf16_f32 v144, v158, v159
    v_mul_f32 v160, v237, v160
    v_mfma_f32_16x16x32_bf16 v[250:253], a[80:83], v[194:197], v[250:253]
    s_waitcnt lgkmcnt(1)
    v_mul_f32 v161, v237, v161
    v_cvt_pk_bf16_f32 v145, v160, v161
    v_mfma_f32_16x16x32_bf16 v[250:253], a[84:87], v[214:217], v[250:253]
    s_waitcnt lgkmcnt(0)
    buffer_store_dwordx4 v[142:145], v16, s[48:51], 0 offen nt
    v_mul_f32 v178, v237, v178
    v_mul_f32 v179, v237, v179
    v_cvt_pk_bf16_f32 v120, v178, v179
    v_mul_f32 v180, v237, v180
    v_mfma_f32_16x16x32_bf16 v[142:145], a[216:219], v[198:201], 0
    v_mul_f32 v181, v237, v181
    v_cvt_pk_bf16_f32 v121, v180, v181
    v_mfma_f32_16x16x32_bf16 v[142:145], a[220:223], v[210:213], v[142:145]
    v_rsq_f32 v116, v116
    v_mfma_f32_16x16x32_bf16 v[142:145], a[224:227], v[222:225], v[142:145]
    v_mul_f32 v146, v116, v146
    v_mul_f32 v147, v116, v147
    v_mfma_f32_16x16x32_bf16 v[142:145], a[228:231], v[134:137], v[142:145]
    v_cvt_pk_bf16_f32 v146, v146, v147
    v_mul_f32 v148, v116, v148
    v_mfma_f32_16x16x32_bf16 v[142:145], a[232:235], v[154:157], v[142:145]
    v_mul_f32 v149, v116, v149
    v_cvt_pk_bf16_f32 v147, v148, v149
    v_mfma_f32_16x16x32_bf16 v[142:145], a[236:239], v[242:245], v[142:145]
    v_mul_f32 v138, v116, v138
    v_mul_f32 v139, v116, v139
    v_mfma_f32_16x16x32_bf16 v[158:161], a[240:243], v[198:201], 0
    v_cvt_pk_bf16_f32 v148, v138, v139
    v_mul_f32 v140, v116, v140
    v_mfma_f32_16x16x32_bf16 v[158:161], a[244:247], v[210:213], v[158:161]
    v_mul_f32 v141, v116, v141
    v_cvt_pk_bf16_f32 v149, v140, v141
    v_mfma_f32_16x16x32_bf16 v[158:161], a[248:251], v[222:225], v[158:161]
    v_mul_f32 v186, v116, v186
    v_mul_f32 v187, v116, v187
    v_mfma_f32_16x16x32_bf16 v[158:161], a[252:255], v[134:137], v[158:161]
    v_cvt_pk_bf16_f32 v130, v186, v187
    v_mul_f32 v188, v116, v188
    v_mfma_f32_16x16x32_bf16 v[158:161], v[82:85], v[154:157], v[158:161]
    v_mul_f32 v189, v116, v189
    v_cvt_pk_bf16_f32 v131, v188, v189
    v_mfma_f32_16x16x32_bf16 v[158:161], v[86:89], v[242:245], v[158:161]
    v_mul_f32 v237, 0x3baaaaab, v226
    v_fma_f32 v172, v142, v142, s33
    v_mfma_f32_16x16x32_bf16 v[138:141], v[90:93], v[198:201], 0
    ds_read_b128 v[178:181], v2 offset:6144
    v_fmac_f32 v172, v143, v143
    v_mfma_f32_16x16x32_bf16 v[138:141], v[94:97], v[210:213], v[138:141]
    ds_read_b128 v[186:189], v2 offset:7168
    v_fmac_f32 v172, v144, v144
    v_mfma_f32_16x16x32_bf16 v[138:141], v[98:101], v[222:225], v[138:141]
    ds_read_b128 v[198:201], v2 offset:8192
    buffer_store_dwordx2 v[120:121], v19, s[48:51], 0 offen nt
    v_rsq_f32 v237, v237
    v_mfma_f32_16x16x32_bf16 v[138:141], v[102:105], v[134:137], v[138:141]
    ds_read_b128 v[134:137], v2 offset:9216
    v_mul_f32 v150, v237, v150
    v_mfma_f32_16x16x32_bf16 v[138:141], v[106:109], v[154:157], v[138:141]
    ds_read_b128 v[154:157], v2 offset:10240
    v_mul_f32 v151, v237, v151
    v_mfma_f32_16x16x32_bf16 v[138:141], v[110:113], v[242:245], v[138:141]
    ds_read_b128 v[210:213], v2 offset:11264
    v_cvt_pk_bf16_f32 v150, v150, v151
    v_mfma_f32_16x16x32_bf16 v[250:253], a[88:91], v[230:233], v[250:253]
    v_mul_f32 v152, v237, v152
    v_mul_f32 v153, v237, v153
    v_mfma_f32_16x16x32_bf16 v[250:253], a[92:95], v[182:185], v[250:253]
    s_waitcnt lgkmcnt(5)
    v_cvt_pk_bf16_f32 v151, v152, v153
    v_mul_f32 v190, v237, v190
    v_mfma_f32_16x16x32_bf16 v[222:225], a[216:219], v[178:181], 0
    s_waitcnt lgkmcnt(4)
    v_mul_f32 v191, v237, v191
    v_cvt_pk_bf16_f32 v152, v190, v191
    v_mfma_f32_16x16x32_bf16 v[222:225], a[220:223], v[186:189], v[222:225]
    s_waitcnt lgkmcnt(3)
    v_mul_f32 v192, v237, v192
    v_mul_f32 v193, v237, v193
    v_mfma_f32_16x16x32_bf16 v[222:225], a[224:227], v[198:201], v[222:225]
    v_cvt_pk_bf16_f32 v153, v192, v193
    v_mul_f32 v202, v237, v202
    v_mfma_f32_16x16x32_bf16 v[190:193], a[240:243], v[178:181], 0
    s_waitcnt lgkmcnt(2)
    v_mul_f32 v203, v237, v203
    v_cvt_pk_bf16_f32 v120, v202, v203
    v_mfma_f32_16x16x32_bf16 v[222:225], a[228:231], v[134:137], v[222:225]
    s_waitcnt lgkmcnt(1)
    v_mul_f32 v204, v237, v204
    v_mul_f32 v205, v237, v205
    v_mfma_f32_16x16x32_bf16 v[222:225], a[232:235], v[154:157], v[222:225]
    s_waitcnt lgkmcnt(0)
    v_cvt_pk_bf16_f32 v121, v204, v205
    v_fmac_f32 v172, v145, v145
    v_mfma_f32_16x16x32_bf16 v[222:225], a[236:239], v[210:213], v[222:225]
    v_fmac_f32 v172, v158, v158
    v_fmac_f32 v172, v159, v159
    v_mfma_f32_16x16x32_bf16 v[190:193], a[244:247], v[186:189], v[190:193]
    v_fmac_f32 v172, v160, v160
    v_fmac_f32 v172, v161, v161
    v_mfma_f32_16x16x32_bf16 v[190:193], a[248:251], v[198:201], v[190:193]
    v_fmac_f32 v172, v138, v138
    v_fmac_f32 v172, v139, v139
    v_mfma_f32_16x16x32_bf16 v[190:193], a[252:255], v[134:137], v[190:193]
    v_fma_f32 v237, v222, v222, s33
    v_fmac_f32 v237, v223, v223
    v_mfma_f32_16x16x32_bf16 v[190:193], v[82:85], v[154:157], v[190:193]
    buffer_store_dwordx4 v[146:149], v17, s[48:51], 0 offen nt
    v_fmac_f32 v237, v224, v224
    v_fmac_f32 v237, v225, v225
    v_fmac_f32 v172, v140, v140
    v_fmac_f32 v172, v141, v141
    v_mfma_f32_16x16x32_bf16 v[190:193], v[86:89], v[210:213], v[190:193]
    v_cvt_pk_bf16_f32 v146, v246, v247
    v_cvt_pk_bf16_f32 v147, v248, v249
    v_mfma_f32_16x16x32_bf16 v[202:205], v[90:93], v[178:181], 0
    ds_read_b128 v[178:181], v2 offset:12288
    v_mul_f32 v123, v239, v123
    v_mfma_f32_16x16x32_bf16 v[202:205], v[94:97], v[186:189], v[202:205]
    ds_read_b128 v[186:189], v2 offset:13312
    v_cvt_pk_f16_f32 v116, v122, v123
    v_mfma_f32_16x16x32_bf16 v[202:205], v[98:101], v[198:201], v[202:205]
    ds_read_b128 v[198:201], v2 offset:14336
    v_fmac_f32 v237, v190, v190
    v_mfma_f32_16x16x32_bf16 v[202:205], v[102:105], v[134:137], v[202:205]
    ds_read_b128 v[134:137], v2 offset:15360
    v_fmac_f32 v237, v191, v191
    v_mfma_f32_16x16x32_bf16 v[202:205], v[106:109], v[154:157], v[202:205]
    ds_read_b128 v[154:157], v2 offset:16384
    v_fmac_f32 v237, v192, v192
    v_mfma_f32_16x16x32_bf16 v[202:205], v[110:113], v[210:213], v[202:205]
    ds_read_b128 v[210:213], v2 offset:17408
    v_fmac_f32 v237, v193, v193
    v_mfma_f32_16x16x32_bf16 v[226:229], a[96:99], v[162:165], 0
    v_mul_f32 v124, v239, v124
    v_mul_f32 v125, v239, v125
    v_mfma_f32_16x16x32_bf16 v[226:229], a[100:103], v[166:169], v[226:229]
    v_cvt_pk_f16_f32 v117, v124, v125
    v_mul_f32 v126, v239, v126
    v_mfma_f32_16x16x32_bf16 v[226:229], a[104:107], v[194:197], v[226:229]
    s_waitcnt lgkmcnt(5)
    v_fmac_f32 v237, v202, v202
    v_fmac_f32 v237, v203, v203
    v_mfma_f32_16x16x32_bf16 v[226:229], a[108:111], v[214:217], v[226:229]
    s_waitcnt lgkmcnt(4)
    v_fmac_f32 v237, v204, v204
    v_fmac_f32 v237, v205, v205
    v_mfma_f32_16x16x32_bf16 v[226:229], a[112:115], v[230:233], v[226:229]
    s_waitcnt lgkmcnt(3)
    v_cvt_pk_bf16_f32 v148, v172, v237
    v_cvt_pk_bf16_f32 v149, v237, v237
    v_mfma_f32_16x16x32_bf16 v[226:229], a[116:119], v[182:185], v[226:229]
    s_waitcnt lgkmcnt(2)
    ds_write_b64 v235, v[148:149] offset:0
    v_mfma_f32_16x16x32_bf16 v[122:125], a[216:219], v[178:181], 0
    s_waitcnt lgkmcnt(1)
    v_mul_f32 v127, v239, v127
    v_cvt_pk_f16_f32 v244, v126, v127
    v_mfma_f32_16x16x32_bf16 v[122:125], a[220:223], v[186:189], v[122:125]
    buffer_store_dwordx2 v[130:131], v20, s[48:51], 0 offen nt
    v_mul_f32 v128, v239, v128
    v_mul_f32 v129, v239, v129
    v_mfma_f32_16x16x32_bf16 v[122:125], a[224:227], v[198:201], v[122:125]
    v_cvt_pk_f16_f32 v245, v128, v129
    v_mul_f32 v206, v238, v206
    v_mfma_f32_16x16x32_bf16 v[122:125], a[228:231], v[134:137], v[122:125]
    v_mul_f32 v207, v238, v207
    v_cvt_pk_f16_f32 v126, v206, v207
    v_mfma_f32_16x16x32_bf16 v[122:125], a[232:235], v[154:157], v[122:125]
    v_mul_f32 v208, v238, v208
    v_mul_f32 v209, v238, v209
    v_mfma_f32_16x16x32_bf16 v[122:125], a[236:239], v[210:213], v[122:125]
    v_cvt_pk_f16_f32 v127, v208, v209
    v_mul_f32 v174, v238, v174
    v_mfma_f32_16x16x32_bf16 v[206:209], a[240:243], v[178:181], 0
    s_waitcnt lgkmcnt(0)
    v_mul_f32 v175, v238, v175
    v_cvt_pk_f16_f32 v128, v174, v175
    v_mfma_f32_16x16x32_bf16 v[206:209], a[244:247], v[186:189], v[206:209]
    s_barrier
    ds_read_b128 v[246:249], v234 offset:0
    v_mul_f32 v176, v238, v176
    v_mfma_f32_16x16x32_bf16 v[206:209], a[248:251], v[198:201], v[206:209]
    v_mul_f32 v177, v238, v177
    v_cvt_pk_f16_f32 v129, v176, v177
    v_mfma_f32_16x16x32_bf16 v[206:209], a[252:255], v[134:137], v[206:209]
    v_mul_f32 v218, v238, v218
    v_mul_f32 v219, v238, v219
    v_mfma_f32_16x16x32_bf16 v[206:209], v[82:85], v[154:157], v[206:209]
    v_cvt_pk_f16_f32 v242, v218, v219
    v_mul_f32 v220, v238, v220
    v_mfma_f32_16x16x32_bf16 v[206:209], v[86:89], v[210:213], v[206:209]
    v_mul_f32 v221, v238, v221
    v_cvt_pk_f16_f32 v243, v220, v221
    v_mfma_f32_16x16x32_bf16 v[174:177], v[90:93], v[178:181], 0
    ds_read_b128 v[178:181], v234 offset:1024
    v_add_u32 v237, 0, v132
    v_mfma_f32_16x16x32_bf16 v[174:177], v[94:97], v[186:189], v[174:177]
    ds_read_b128 v[186:189], v133 offset:0
    v_mul_u32_u24 v130, s20, v237
    v_mfma_f32_16x16x32_bf16 v[174:177], v[98:101], v[198:201], v[174:177]
    v_add_u32 v130, s38, v130
    v_mul_u32_u24 v130, 911, v130
    v_mfma_f32_16x16x32_bf16 v[174:177], v[102:105], v[134:137], v[174:177]
    s_waitcnt lgkmcnt(2)
    ds_read_b128 v[134:137], v133 offset:2048
    v_lshrrev_b32 v130, 16, v130
    v_mfma_f32_16x16x32_bf16 v[174:177], v[106:109], v[154:157], v[174:177]
    ds_read_b128 v[154:157], v133 offset:4096
    v_mul_u32_u24 v130, s22, v130
    v_mfma_f32_16x16x32_bf16 v[174:177], v[110:113], v[210:213], v[174:177]
    ds_read_b128 v[198:201], v133 offset:6144
    buffer_store_dwordx4 v[150:153], v15, s[48:51], 0 offen nt
    ds_read_b128 v[210:213], v133 offset:8192
    v_mad_u32_u24 v130, v237, s21, v130
    v_cmp_gt_u32 vcc, s17, v237
    v_add_u32 v237, s7, v130
    v_mfma_f32_16x16x32_bf16 v[150:153], v[32:35], v[246:249], 0
    ds_read_b128 v[218:221], v133 offset:10240
    s_waitcnt lgkmcnt(6)
    v_mfma_f32_16x16x32_bf16 v[150:153], v[32:35], v[178:181], v[150:153]
    v_cndmask_b32 v237, v236, v237, vcc
    v_lshl_add_u32 v130, v255, 4, v237
    v_mfma_f32_16x16x32_bf16 v[178:181], a[120:123], v[162:165], 0
    s_waitcnt lgkmcnt(5)
    v_add_u32 v130, s3, v130
    v_lshl_add_u32 v237, v255, 3, v237
    v_mfma_f32_16x16x32_bf16 v[178:181], a[124:127], v[166:169], v[178:181]
    v_add_u32 v237, s4, v237
    v_mul_f32 v131, 0x3baaaaab, v151
    v_mfma_f32_16x16x32_bf16 v[178:181], a[128:131], v[194:197], v[178:181]
    s_waitcnt lgkmcnt(4)
    v_rsq_f32 v131, v131
    v_mfma_f32_16x16x32_bf16 v[178:181], a[132:135], v[214:217], v[178:181]
    s_waitcnt lgkmcnt(3)
    v_mul_f32 v222, v131, v222
    v_mul_f32 v223, v131, v223
    v_mfma_f32_16x16x32_bf16 v[178:181], a[136:139], v[230:233], v[178:181]
    s_waitcnt lgkmcnt(1)
    v_cvt_pk_bf16_f32 v222, v222, v223
    v_mul_f32 v224, v131, v224
    v_mfma_f32_16x16x32_bf16 v[178:181], a[140:143], v[182:185], v[178:181]
    v_mul_f32 v225, v131, v225
    v_cvt_pk_bf16_f32 v223, v224, v225
    v_mul_f32 v190, v131, v190
    v_mul_f32 v191, v131, v191
    v_cvt_pk_bf16_f32 v224, v190, v191
    v_mfma_f32_16x16x32_bf16 v[238:241], a[216:219], v[186:189], 0
    s_waitcnt lgkmcnt(0)
    v_mul_f32 v192, v131, v192
    v_mul_f32 v193, v131, v193
    v_mfma_f32_16x16x32_bf16 v[238:241], a[220:223], v[134:137], v[238:241]
    v_cvt_pk_bf16_f32 v225, v192, v193
    v_mul_f32 v202, v131, v202
    v_mfma_f32_16x16x32_bf16 v[238:241], a[224:227], v[154:157], v[238:241]
    v_mul_f32 v203, v131, v203
    v_cvt_pk_bf16_f32 v148, v202, v203
    v_mfma_f32_16x16x32_bf16 v[238:241], a[228:231], v[198:201], v[238:241]
    v_mul_f32 v204, v131, v204
    v_mul_f32 v205, v131, v205
    v_mfma_f32_16x16x32_bf16 v[238:241], a[232:235], v[210:213], v[238:241]
    v_cvt_pk_bf16_f32 v149, v204, v205
    v_mul_f32 v131, 0x3baaaaab, v150
    v_mfma_f32_16x16x32_bf16 v[238:241], a[236:239], v[218:221], v[238:241]
    v_rsq_f32 v131, v131
    v_mfma_f32_16x16x32_bf16 v[150:153], a[240:243], v[186:189], 0
    buffer_store_dwordx4 v[222:225], v16, s[52:55], 0 offen nt
    v_mul_f32 v142, v131, v142
    v_mul_f32 v143, v131, v143
    v_cvt_pk_bf16_f32 v142, v142, v143
    v_mul_f32 v144, v131, v144
    v_mfma_f32_16x16x32_bf16 v[150:153], a[244:247], v[134:137], v[150:153]
    v_mul_f32 v145, v131, v145
    v_cvt_pk_bf16_f32 v143, v144, v145
    v_mfma_f32_16x16x32_bf16 v[150:153], a[248:251], v[154:157], v[150:153]
    v_mul_f32 v158, v131, v158
    v_mul_f32 v159, v131, v159
    v_mfma_f32_16x16x32_bf16 v[150:153], a[252:255], v[198:201], v[150:153]
    v_cvt_pk_bf16_f32 v144, v158, v159
    v_mul_f32 v160, v131, v160
    v_mfma_f32_16x16x32_bf16 v[150:153], v[82:85], v[210:213], v[150:153]
    v_mul_f32 v161, v131, v161
    v_cvt_pk_bf16_f32 v145, v160, v161
    v_mfma_f32_16x16x32_bf16 v[150:153], v[86:89], v[218:221], v[150:153]
    v_mul_f32 v138, v131, v138
    v_mul_f32 v139, v131, v139
    v_mfma_f32_16x16x32_bf16 v[158:161], v[90:93], v[186:189], 0
    v_cvt_pk_bf16_f32 v138, v138, v139
    v_mul_f32 v140, v131, v140
    v_mfma_f32_16x16x32_bf16 v[158:161], v[94:97], v[134:137], v[158:161]
    v_mul_f32 v141, v131, v141
    v_cvt_pk_bf16_f32 v139, v140, v141
    v_mfma_f32_16x16x32_bf16 v[158:161], v[98:101], v[154:157], v[158:161]
    v_fma_f32 v131, v238, v238, s33
    v_fmac_f32 v131, v239, v239
    v_mfma_f32_16x16x32_bf16 v[158:161], v[102:105], v[198:201], v[158:161]
    v_fmac_f32 v131, v240, v240
    v_fmac_f32 v131, v241, v241
    v_mfma_f32_16x16x32_bf16 v[158:161], v[106:109], v[210:213], v[158:161]
    v_fmac_f32 v131, v150, v150
    v_fmac_f32 v131, v151, v151
    v_mfma_f32_16x16x32_bf16 v[158:161], v[110:113], v[218:221], v[158:161]
    v_fmac_f32 v131, v152, v152
    v_fmac_f32 v131, v153, v153
    v_mfma_f32_16x16x32_bf16 v[134:137], a[0:3], v[162:165], 0
    v_fma_f32 v140, v122, v122, s33
    v_fmac_f32 v140, v123, v123
    v_mfma_f32_16x16x32_bf16 v[134:137], a[4:7], v[166:169], v[134:137]
    v_fmac_f32 v140, v124, v124
    v_fmac_f32 v140, v125, v125
    v_mfma_f32_16x16x32_bf16 v[134:137], a[8:11], v[194:197], v[134:137]
    v_fmac_f32 v131, v158, v158
    v_fmac_f32 v131, v159, v159
    v_mfma_f32_16x16x32_bf16 v[134:137], a[12:15], v[214:217], v[134:137]
    v_fmac_f32 v131, v160, v160
    v_fmac_f32 v131, v161, v161
    v_mfma_f32_16x16x32_bf16 v[134:137], a[16:19], v[230:233], v[134:137]
    buffer_store_dwordx2 v[148:149], v19, s[52:55], 0 offen nt
    v_cvt_pk_bf16_f32 v141, v131, v131
    v_fmac_f32 v140, v206, v206
    v_mfma_f32_16x16x32_bf16 v[134:137], a[20:23], v[182:185], v[134:137]
    v_fmac_f32 v140, v207, v207
    v_fmac_f32 v140, v208, v208
    v_mfma_f32_16x16x32_bf16 v[154:157], a[24:27], v[162:165], 0
    v_fmac_f32 v140, v209, v209
    v_fmac_f32 v140, v174, v174
    v_mfma_f32_16x16x32_bf16 v[154:157], a[28:31], v[166:169], v[154:157]
    v_fmac_f32 v140, v175, v175
    v_fmac_f32 v140, v176, v176
    v_mfma_f32_16x16x32_bf16 v[154:157], a[32:35], v[194:197], v[154:157]
    v_fmac_f32 v140, v177, v177
    v_cvt_pk_bf16_f32 v140, v140, v131
    v_mfma_f32_16x16x32_bf16 v[154:157], a[36:39], v[214:217], v[154:157]
    ds_write_b64 v235, v[140:141] offset:2048
    v_mfma_f32_16x16x32_bf16 v[154:157], a[40:43], v[230:233], v[154:157]
    v_fma_f32 v131, v134, v134, s32
    v_fmac_f32 v131, v135, v135
    v_mfma_f32_16x16x32_bf16 v[154:157], a[44:47], v[182:185], v[154:157]
    v_fmac_f32 v131, v136, v136
    v_fmac_f32 v131, v137, v137
    v_mfma_f32_16x16x32_bf16 v[186:189], a[48:51], v[162:165], 0
    v_fma_f32 v140, v250, v250, s32
    v_fmac_f32 v140, v251, v251
    v_mfma_f32_16x16x32_bf16 v[186:189], a[52:55], v[166:169], v[186:189]
    v_fmac_f32 v140, v252, v252
    v_fmac_f32 v140, v253, v253
    v_mfma_f32_16x16x32_bf16 v[186:189], a[56:59], v[194:197], v[186:189]
    v_fmac_f32 v131, v154, v154
    v_fmac_f32 v131, v155, v155
    v_mfma_f32_16x16x32_bf16 v[186:189], a[60:63], v[214:217], v[186:189]
    v_fmac_f32 v131, v156, v156
    v_fmac_f32 v131, v157, v157
    v_mfma_f32_16x16x32_bf16 v[186:189], a[64:67], v[230:233], v[186:189]
    s_waitcnt lgkmcnt(0)
    v_fmac_f32 v140, v226, v226
    v_fmac_f32 v140, v227, v227
    v_mfma_f32_16x16x32_bf16 v[186:189], a[68:71], v[182:185], v[186:189]
    s_barrier
    ds_read_b128 v[190:193], v234 offset:2048
    ds_read_b128 v[198:201], v234 offset:3072
    v_mfma_f32_16x16x32_bf16 v[202:205], v[162:165], a[144:147], 0
    v_fmac_f32 v140, v228, v228
    v_fmac_f32 v140, v229, v229
    v_mfma_f32_16x16x32_bf16 v[202:205], v[166:169], a[148:151], v[202:205]
    v_fmac_f32 v140, v178, v178
    v_fmac_f32 v131, v186, v186
    v_mfma_f32_16x16x32_bf16 v[202:205], v[194:197], a[152:155], v[202:205]
    buffer_store_dwordx2 v[120:121], v18, s[48:51], 0 offen nt
    v_fmac_f32 v131, v187, v187
    v_fmac_f32 v131, v188, v188
    v_mfma_f32_16x16x32_bf16 v[202:205], v[214:217], a[156:159], v[202:205]
    v_fmac_f32 v131, v189, v189
    v_fmac_f32 v140, v179, v179
    v_mfma_f32_16x16x32_bf16 v[202:205], v[230:233], a[160:163], v[202:205]
    v_fmac_f32 v140, v180, v180
    v_fmac_f32 v140, v181, v181
    v_mfma_f32_16x16x32_bf16 v[202:205], v[182:185], a[164:167], v[202:205]
    ds_read_b128 v[210:213], v0 offset:32768
    v_cvt_pk_bf16_f32 v36, v131, v140
    v_mfma_f32_16x16x32_bf16 v[218:221], v[162:165], a[168:171], 0
    s_waitcnt lgkmcnt(2)
    v_xor_b32 v131, 65536, v2
    v_bfe_u32 v120, v132, 1, 2
    v_mfma_f32_16x16x32_bf16 v[218:221], v[166:169], a[172:175], v[218:221]
    s_waitcnt lgkmcnt(1)
    v_cvt_pk_bf16_f32 v172, v202, v203
    v_cvt_pk_bf16_f32 v173, v204, v205
    v_mfma_f32_16x16x32_bf16 v[218:221], v[194:197], a[176:179], v[218:221]
    v_xor_b32 v120, v120, v255
    v_lshl_add_u32 v120, v132, 2, v120
    v_mfma_f32_16x16x32_bf16 v[218:221], v[214:217], a[180:183], v[218:221]
    v_lshl_add_u32 v140, v120, 4, s5
    v_lshl_add_u32 v141, v120, 3, s5
    v_mfma_f32_16x16x32_bf16 v[218:221], v[230:233], a[184:187], v[218:221]
    v_lshl_add_u32 v202, v254, 4, s5
    v_lshl_add_u32 v254, v254, 3, s5
    v_mfma_f32_16x16x32_bf16 v[218:221], v[182:185], a[188:191], v[218:221]
    v_lshlrev_b32 v120, 2, v120
    ds_permute_b32 v203, v120, v16
    ds_permute_b32 v204, v120, v19
    ds_permute_b32 v205, v120, v17
    ds_permute_b32 v222, v120, v20
    v_subrev_u32 v148, 0x3d800000, v44
    v_sub_u32 v149, 0x4a000000, v45
    v_or3_b32 v148, v148, v149, v45
    v_cvt_pk_bf16_f32 v120, v218, v219
    v_cvt_pk_bf16_f32 v121, v220, v221
    v_lshl_add_u32 v149, s16, 2, v131
    ds_write_b32 v149, v148 offset:18432
    v_add_u32 v132, 16, v132
    v_mul_u32_u24 v148, s20, v132
    v_add_u32 v148, s38, v148
    v_mul_u32_u24 v148, 911, v148
    v_lshrrev_b32 v148, 16, v148
    v_mul_u32_u24 v148, s22, v148
    v_mad_u32_u24 v148, v132, s21, v148
    v_cmp_gt_u32 vcc, s17, v132
    buffer_store_dwordx4 v[142:145], v15, s[52:55], 0 offen nt
    v_add_u32 v132, s7, v148
    v_cndmask_b32 v132, v236, v132, vcc
    v_lshl_add_u32 v236, v255, 4, v132
    v_add_u32 v236, s3, v236
    v_lshl_add_u32 v255, v255, 3, v132
    v_mfma_f32_16x16x32_bf16 v[142:145], v[32:35], v[36:39], 0
    v_add_u32 v255, s4, v255
    s_nop 0
    s_nop 0
    s_nop 0
    s_nop 0
    s_nop 0
    s_nop 0
    s_nop 0
    v_rsq_f32 v143, v143
    v_rsq_f32 v142, v142
    v_mul_f32 v250, v143, v250
    v_mul_f32 v142, s31, v142
    v_mul_f32 v251, v143, v251
    v_cvt_pk_f16_f32 v218, v250, v251
    v_mul_f32 v252, v143, v252
    v_mul_f32 v253, v143, v253
    v_cvt_pk_f16_f32 v219, v252, v253
    v_mfma_f32_16x16x32_bf16 v[246:249], v[32:35], v[190:193], 0
    s_waitcnt lgkmcnt(0)
    ds_read_b128 v[190:193], v1 offset:32768
    v_mul_f32 v226, v143, v226
    v_mfma_f32_16x16x32_bf16 v[246:249], v[32:35], v[198:201], v[246:249]
    ds_read_b128 v[198:201], v0 offset:32896
    v_mul_f32 v227, v143, v227
    v_cvt_pk_f16_f32 v220, v226, v227
    v_mul_f32 v228, v143, v228
    v_mul_f32 v229, v143, v229
    v_cvt_pk_f16_f32 v221, v228, v229
    v_mfma_f32_16x16x32_bf16 v[226:229], v[162:165], a[192:195], 0
    ds_read_b128 v[162:165], v1 offset:32896
    v_mul_f32 v132, 0x3baaaaab, v247
    v_mfma_f32_16x16x32_bf16 v[226:229], v[166:169], a[196:199], v[226:229]
    ds_read_b128 v[166:169], v0 offset:33024
    v_mul_f32 v178, v143, v178
    v_mfma_f32_16x16x32_bf16 v[226:229], v[194:197], a[200:203], v[226:229]
    ds_read_b128 v[194:197], v1 offset:33024
    v_mul_f32 v179, v143, v179
    v_mfma_f32_16x16x32_bf16 v[226:229], v[214:217], a[204:207], v[226:229]
    v_rsq_f32 v132, v132
    v_mfma_f32_16x16x32_bf16 v[226:229], v[230:233], a[208:211], v[226:229]
    v_mul_f32 v238, v132, v238
    v_mul_f32 v239, v132, v239
    v_mfma_f32_16x16x32_bf16 v[226:229], v[182:185], a[212:215], v[226:229]
    s_waitcnt lgkmcnt(4)
    v_cvt_pk_bf16_f32 v182, v238, v239
    v_mul_f32 v240, v132, v240
    v_mfma_f32_16x16x32_bf16 v[214:217], a[72:75], v[210:213], 0
    s_waitcnt lgkmcnt(3)
    buffer_store_dwordx2 v[138:139], v18, s[52:55], 0 offen nt
    v_mul_f32 v241, v132, v241
    v_cvt_pk_bf16_f32 v183, v240, v241
    v_mfma_f32_16x16x32_bf16 v[214:217], a[76:79], v[190:193], v[214:217]
    s_waitcnt lgkmcnt(2)
    v_mul_f32 v150, v132, v150
    v_mul_f32 v151, v132, v151
    v_mfma_f32_16x16x32_bf16 v[214:217], a[80:83], v[198:201], v[214:217]
    s_waitcnt lgkmcnt(1)
    v_cvt_pk_bf16_f32 v184, v150, v151
    v_mul_f32 v152, v132, v152
    v_mfma_f32_16x16x32_bf16 v[214:217], a[84:87], v[162:165], v[214:217]
    s_waitcnt lgkmcnt(0)
    v_mul_f32 v153, v132, v153
    v_cvt_pk_bf16_f32 v185, v152, v153
    v_mfma_f32_16x16x32_bf16 v[214:217], a[88:91], v[166:169], v[214:217]
    v_mul_f32 v158, v132, v158
    v_mul_f32 v159, v132, v159
    v_mfma_f32_16x16x32_bf16 v[214:217], a[92:95], v[194:197], v[214:217]
    v_cvt_pk_bf16_f32 v138, v158, v159
    v_mul_f32 v160, v132, v160
    v_mfma_f32_16x16x32_bf16 v[150:153], a[96:99], v[210:213], 0
    v_mul_f32 v161, v132, v161
    v_cvt_pk_bf16_f32 v139, v160, v161
    v_mfma_f32_16x16x32_bf16 v[150:153], a[100:103], v[190:193], v[150:153]
    v_cvt_pk_bf16_f32 v148, v226, v227
    v_cvt_pk_bf16_f32 v149, v228, v229
    v_mfma_f32_16x16x32_bf16 v[150:153], a[104:107], v[198:201], v[150:153]
    v_cvt_pk_f16_f32 v160, v178, v179
    v_mul_f32 v180, v143, v180
    v_mfma_f32_16x16x32_bf16 v[150:153], a[108:111], v[162:165], v[150:153]
    v_mul_f32 v181, v143, v181
    v_cvt_pk_f16_f32 v161, v180, v181
    v_mfma_f32_16x16x32_bf16 v[150:153], a[112:115], v[166:169], v[150:153]
    v_mul_f32 v134, v142, v134
    v_mul_f32 v135, v142, v135
    v_mfma_f32_16x16x32_bf16 v[150:153], a[116:119], v[194:197], v[150:153]
    v_cvt_pk_f16_f32 v134, v134, v135
    v_mul_f32 v136, v142, v136
    v_mfma_f32_16x16x32_bf16 v[178:181], a[120:123], v[210:213], 0
    v_mul_f32 v137, v142, v137
    v_cvt_pk_f16_f32 v135, v136, v137
    v_mfma_f32_16x16x32_bf16 v[178:181], a[124:127], v[190:193], v[178:181]
    v_mul_f32 v154, v142, v154
    v_mul_f32 v155, v142, v155
    v_mfma_f32_16x16x32_bf16 v[178:181], a[128:131], v[198:201], v[178:181]
    v_cvt_pk_f16_f32 v136, v154, v155
    v_mul_f32 v156, v142, v156
    v_mfma_f32_16x16x32_bf16 v[178:181], a[132:135], v[162:165], v[178:181]
    v_mul_f32 v157, v142, v157
    v_cvt_pk_f16_f32 v137, v156, v157
    v_mfma_f32_16x16x32_bf16 v[178:181], a[136:139], v[166:169], v[178:181]
    buffer_store_dwordx4 v[182:185], v130, s[12:15], 0 offen nt
    v_mul_f32 v186, v142, v186
    v_mul_f32 v187, v142, v187
    v_cvt_pk_f16_f32 v158, v186, v187
    v_mul_f32 v188, v142, v188
    v_mfma_f32_16x16x32_bf16 v[178:181], a[140:143], v[194:197], v[178:181]
    v_mul_f32 v189, v142, v189
    v_cvt_pk_f16_f32 v159, v188, v189
    v_mfma_f32_16x16x32_bf16 v[142:145], a[0:3], v[210:213], 0
    v_mul_f32 v130, 0x3baaaaab, v246
    v_fma_f32 v132, v214, v214, s32
    v_mfma_f32_16x16x32_bf16 v[142:145], a[4:7], v[190:193], v[142:145]
    v_rsq_f32 v130, v130
    v_mfma_f32_16x16x32_bf16 v[142:145], a[8:11], v[198:201], v[142:145]
    v_mul_f32 v122, v130, v122
    v_mul_f32 v123, v130, v123
    v_mfma_f32_16x16x32_bf16 v[142:145], a[12:15], v[162:165], v[142:145]
    v_cvt_pk_bf16_f32 v122, v122, v123
    v_mul_f32 v124, v130, v124
    v_mfma_f32_16x16x32_bf16 v[142:145], a[16:19], v[166:169], v[142:145]
    v_mul_f32 v125, v130, v125
    v_cvt_pk_bf16_f32 v123, v124, v125
    v_mfma_f32_16x16x32_bf16 v[142:145], a[20:23], v[194:197], v[142:145]
    v_mul_f32 v206, v130, v206
    v_mul_f32 v207, v130, v207
    v_mfma_f32_16x16x32_bf16 v[154:157], a[24:27], v[210:213], 0
    v_cvt_pk_bf16_f32 v124, v206, v207
    v_mul_f32 v208, v130, v208
    v_mfma_f32_16x16x32_bf16 v[154:157], a[28:31], v[190:193], v[154:157]
    v_mul_f32 v209, v130, v209
    v_cvt_pk_bf16_f32 v125, v208, v209
    v_mfma_f32_16x16x32_bf16 v[154:157], a[32:35], v[198:201], v[154:157]
    v_mul_f32 v174, v130, v174
    v_mul_f32 v175, v130, v175
    v_mfma_f32_16x16x32_bf16 v[154:157], a[36:39], v[162:165], v[154:157]
    v_cvt_pk_bf16_f32 v224, v174, v175
    v_mul_f32 v176, v130, v176
    v_mfma_f32_16x16x32_bf16 v[154:157], a[40:43], v[166:169], v[154:157]
    v_mul_f32 v177, v130, v177
    v_cvt_pk_bf16_f32 v225, v176, v177
    v_mfma_f32_16x16x32_bf16 v[154:157], a[44:47], v[194:197], v[154:157]
    v_fma_f32 v130, v142, v142, s32
    v_fmac_f32 v130, v143, v143
    v_mfma_f32_16x16x32_bf16 v[174:177], a[48:51], v[210:213], 0
    v_fmac_f32 v130, v144, v144
    v_fmac_f32 v130, v145, v145
    v_mfma_f32_16x16x32_bf16 v[174:177], a[52:55], v[190:193], v[174:177]
    v_fmac_f32 v132, v215, v215
    v_fmac_f32 v132, v216, v216
    v_mfma_f32_16x16x32_bf16 v[174:177], a[56:59], v[198:201], v[174:177]
    buffer_store_dwordx2 v[138:139], v237, s[12:15], 0 offen nt
    v_fmac_f32 v130, v154, v154
    v_fmac_f32 v130, v155, v155
    v_mfma_f32_16x16x32_bf16 v[174:177], a[60:63], v[162:165], v[174:177]
    v_fmac_f32 v130, v156, v156
    v_fmac_f32 v130, v157, v157
    v_mfma_f32_16x16x32_bf16 v[174:177], a[64:67], v[166:169], v[174:177]
    v_fmac_f32 v132, v217, v217
    v_fmac_f32 v132, v150, v150
    v_mfma_f32_16x16x32_bf16 v[174:177], a[68:71], v[194:197], v[174:177]
    v_fmac_f32 v132, v151, v151
    v_fmac_f32 v132, v152, v152
    v_mfma_f32_16x16x32_bf16 v[182:185], v[210:213], a[144:147], 0
    v_fmac_f32 v132, v153, v153
    v_fmac_f32 v132, v178, v178
    v_mfma_f32_16x16x32_bf16 v[182:185], v[190:193], a[148:151], v[182:185]
    v_fmac_f32 v132, v179, v179
    v_fmac_f32 v132, v180, v180
    v_mfma_f32_16x16x32_bf16 v[182:185], v[198:201], a[152:155], v[182:185]
    v_fmac_f32 v130, v174, v174
    v_fmac_f32 v130, v175, v175
    v_mfma_f32_16x16x32_bf16 v[182:185], v[162:165], a[156:159], v[182:185]
    v_fmac_f32 v130, v176, v176
    v_fmac_f32 v130, v177, v177
    v_mfma_f32_16x16x32_bf16 v[182:185], v[166:169], a[160:163], v[182:185]
    ds_read2_b32 v[188:189], v6 offset0:0 offset1:0
    ds_read2_b32 v[208:209], v6 offset0:16 offset1:16
    v_mfma_f32_16x16x32_bf16 v[182:185], v[194:197], a[164:167], v[182:185]
    ds_read2_b32 v[228:229], v6 offset0:32 offset1:32
    v_fmac_f32 v132, v181, v181
    v_mfma_f32_16x16x32_bf16 v[230:233], v[210:213], a[168:171], 0
    v_cvt_pk_bf16_f32 v36, v130, v132
    v_mfma_f32_16x16x32_bf16 v[230:233], v[190:193], a[172:175], v[230:233]
    v_mfma_f32_16x16x32_bf16 v[230:233], v[198:201], a[176:179], v[230:233]
    v_mfma_f32_16x16x32_bf16 v[238:241], v[32:35], v[36:39], 0
    v_mfma_f32_16x16x32_bf16 v[230:233], v[162:165], a[180:183], v[230:233]
    v_cvt_pk_bf16_f32 v186, v182, v183
    v_cvt_pk_bf16_f32 v187, v184, v185
    v_mfma_f32_16x16x32_bf16 v[230:233], v[166:169], a[184:187], v[230:233]
    v_mfma_f32_16x16x32_bf16 v[230:233], v[194:197], a[188:191], v[230:233]
    s_waitcnt lgkmcnt(1)
    buffer_store_dwordx4 v[122:125], v17, s[52:55], 0 offen nt
    v_mfma_f32_16x16x32_bf16 v[182:185], v[210:213], a[192:195], 0
    s_waitcnt lgkmcnt(0)
    v_rsq_f32 v239, v239
    v_mfma_f32_16x16x32_bf16 v[182:185], v[190:193], a[196:199], v[182:185]
    v_rsq_f32 v238, v238
    v_mfma_f32_16x16x32_bf16 v[182:185], v[198:201], a[200:203], v[182:185]
    ds_read_b128 v[122:125], v5 offset:0
    ds_read_b128 v[190:193], v5 offset:16
    v_mfma_f32_16x16x32_bf16 v[182:185], v[162:165], a[204:207], v[182:185]
    ds_read_b128 v[162:165], v5 offset:48
    ds_read_b32 v237, v6 offset:192
    v_mfma_f32_16x16x32_bf16 v[182:185], v[166:169], a[208:211], v[182:185]
    v_mul_f32 v238, s31, v238
    v_cvt_pk_bf16_f32 v206, v230, v231
    v_mfma_f32_16x16x32_f16 v[166:169], v[114:117], v[126:129], v[46:49]
    v_cvt_pk_bf16_f32 v207, v232, v233
    v_mul_f32 v214, v239, v214
    v_mfma_f32_16x16x32_f16 v[198:201], v[218:221], v[126:129], v[50:53]
    v_mul_f32 v215, v239, v215
    v_cvt_pk_f16_f32 v210, v214, v215
    v_mfma_f32_16x16x32_bf16 v[182:185], v[194:197], a[212:215], v[182:185]
    v_mul_f32 v216, v239, v216
    v_mul_f32 v217, v239, v217
    v_cvt_pk_f16_f32 v211, v216, v217
    v_mfma_f32_16x16x16_f16 v[166:169], v[244:245], v[242:243], v[166:169]
    v_mul_f32 v150, v239, v150
    v_mul_f32 v151, v239, v151
    v_cvt_pk_f16_f32 v212, v150, v151
    v_mfma_f32_16x16x16_f16 v[198:201], v[160:161], v[242:243], v[198:201]
    s_waitcnt lgkmcnt(3)
    v_cvt_pk_bf16_f32 v226, v182, v183
    v_cvt_pk_bf16_f32 v227, v184, v185
    v_mul_f32 v152, v239, v152
    v_mfma_f32_16x16x32_f16 v[182:185], v[122:125], v[126:129], v[22:25]
    s_waitcnt lgkmcnt(0)
    v_mul_f32 v153, v239, v153
    v_cvt_pk_f16_f32 v213, v152, v153
    v_mfma_f32_16x16x32_f16 v[182:185], v[190:193], v[114:117], v[182:185]
    v_mul_f32 v178, v239, v178
    v_mul_f32 v179, v239, v179
    v_mfma_f32_16x16x32_f16 v[182:185], v[162:165], v[242:245], v[182:185]
    v_cvt_pk_f16_f32 v152, v178, v179
    v_mul_f32 v180, v239, v180
    v_mfma_f32_16x16x32_f16 v[194:197], v[122:125], v[134:137], v[24:27]
    v_mul_f32 v181, v239, v181
    v_cvt_pk_f16_f32 v153, v180, v181
    v_mfma_f32_16x16x32_f16 v[194:197], v[190:193], v[218:221], v[194:197]
    buffer_store_dwordx2 v[224:225], v20, s[52:55], 0 offen nt
    v_mul_f32 v142, v238, v142
    v_mov_b32_dpp v237, v183 quad_perm:[0,1,2,3] row_mask:0x1 bank_mask:0xf
    v_mfma_f32_16x16x32_f16 v[194:197], v[162:165], v[158:161], v[194:197]
    v_mul_f32 v143, v238, v143
    v_cvt_pk_f16_f32 v142, v142, v143
    v_mfma_f32_16x16x32_f16 v[178:181], v[210:213], v[126:129], v[54:57]
    v_mul_f32 v144, v238, v144
    v_mul_f32 v145, v238, v145
    v_cvt_pk_f16_f32 v143, v144, v145
    v_mul_f32 v154, v238, v154
    v_mul_f32 v155, v238, v155
    v_mov_b32_dpp v237, v195 quad_perm:[0,1,2,3] row_mask:0x2 bank_mask:0xf
    v_mfma_f32_16x16x16_f16 v[178:181], v[152:153], v[242:243], v[178:181]
    v_cvt_pk_f16_f32 v144, v154, v155
    v_mul_f32 v156, v238, v156
    v_mul_f32 v157, v238, v157
    v_cvt_pk_f16_f32 v145, v156, v157
    v_mul_f32 v174, v238, v174
    v_mul_f32 v175, v238, v175
    v_mfma_f32_16x16x32_f16 v[126:129], v[122:125], v[142:145], v[26:29]
    v_cvt_pk_f16_f32 v150, v174, v175
    v_mul_f32 v176, v238, v176
    v_mfma_f32_16x16x32_f16 v[126:129], v[190:193], v[210:213], v[126:129]
    v_mul_f32 v177, v238, v177
    v_cvt_pk_f16_f32 v151, v176, v177
    v_max3_f32 v130, v182, v166, v167
    v_max3_f32 v130, v130, v168, v169
    v_mfma_f32_16x16x32_f16 v[126:129], v[162:165], v[150:153], v[126:129]
    v_max3_f32 v130, v130, v198, v199
    v_max3_f32 v130, v130, v200, v201
    v_max3_f32 v130, v130, v178, v179
    v_max3_f32 v130, v130, v180, v181
    v_mov_b32 v132, v130
    s_nop 0
    s_nop 0
    v_permlane32_swap_b32 v130, v132
    v_mov_b32_dpp v237, v127 quad_perm:[0,1,2,3] row_mask:0x4 bank_mask:0xf
    v_mov_b32 v138, v237
    v_max_f32 v130, v130, v132
    v_mov_b32 v132, v130
    v_max_f32_dpp v138, v138, v138 quad_perm:[1,0,3,2] row_mask:0xf bank_mask:0xf
    s_nop 0
    v_permlane16_swap_b32 v130, v132
    v_max_f32_dpp v138, v138, v138 quad_perm:[2,3,0,1] row_mask:0xf bank_mask:0xf
    v_max_f32 v130, v130, v132
    v_sub_f32 v166, v166, v130
    v_max_f32_dpp v138, v138, v138 row_half_mirror row_mask:0xf bank_mask:0xf
    v_exp_f32 v166, v166
    v_sub_f32 v167, v167, v130
    v_max_f32_dpp v138, v138, v138 row_mirror row_mask:0xf bank_mask:0xf
    v_mov_b32 v132, v138
    v_exp_f32 v167, v167
    v_sub_f32 v168, v168, v130
    v_permlane32_swap_b32 v138, v132
    v_max_f32 v138, v138, v132
    v_mov_b32 v132, v138
    v_cvt_pk_bf16_f32 v122, v166, v167
    v_exp_f32 v168, v168
    v_permlane16_swap_b32 v138, v132
    v_max_f32 v138, v138, v132
    v_sub_f32 v237, v237, v138
    v_exp_f32 v237, v237
    v_sub_f32 v169, v169, v130
    v_cvt_pk_bf16_f32 v237, v237, v237
    ds_write_b16 v8, v237
    v_exp_f32 v169, v169
    v_sub_f32 v198, v198, v130
    v_cvt_pk_bf16_f32 v123, v168, v169
    v_exp_f32 v198, v198
    v_sub_f32 v199, v199, v130
    v_exp_f32 v199, v199
    v_sub_f32 v200, v200, v130
    v_cvt_pk_bf16_f32 v124, v198, v199
    v_exp_f32 v200, v200
    v_sub_f32 v201, v201, v130
    v_exp_f32 v201, v201
    v_sub_f32 v178, v178, v130
    v_cvt_pk_bf16_f32 v125, v200, v201
    v_exp_f32 v178, v178
    v_sub_f32 v179, v179, v130
    v_exp_f32 v179, v179
    v_mfma_f32_16x16x32_f16 v[154:157], v[114:117], v[134:137], v[58:61]
    v_cvt_pk_bf16_f32 v36, v178, v179
    v_sub_f32 v180, v180, v130
    v_mfma_f32_16x16x32_f16 v[162:165], v[218:221], v[134:137], v[62:65]
    v_exp_f32 v180, v180
    v_mfma_f32_16x16x32_f16 v[166:169], v[210:213], v[134:137], v[66:69]
    v_sub_f32 v181, v181, v130
    v_exp_f32 v181, v181
    v_mfma_f32_16x16x16_f16 v[154:157], v[244:245], v[158:159], v[154:157]
    v_cvt_pk_bf16_f32 v37, v180, v181
    v_sub_f32 v182, v182, v130
    v_mfma_f32_16x16x16_f16 v[162:165], v[160:161], v[158:159], v[162:165]
    v_exp_f32 v182, v182
    v_mfma_f32_16x16x16_f16 v[166:169], v[152:153], v[158:159], v[166:169]
    v_cvt_pk_bf16_f32 v39, v182, 0
    s_nop 0
    s_nop 0
    v_max3_f32 v237, v194, v154, v155
    v_mfma_f32_16x16x32_bf16 v[134:137], v[28:31], v[36:39], 0
    v_max3_f32 v237, v237, v156, v157
    v_max3_f32 v237, v237, v162, v163
    v_mfma_f32_16x16x32_bf16 v[134:137], v[28:31], v[122:125], v[134:137]
    v_max3_f32 v237, v237, v164, v165
    v_max3_f32 v237, v237, v166, v167
    v_mfma_f32_16x16x32_bf16 v[174:177], v[186:189], v[36:39], 0
    v_max3_f32 v237, v237, v168, v169
    v_mov_b32 v130, v237
    v_mfma_f32_16x16x32_bf16 v[174:177], v[170:173], v[122:125], v[174:177]
    v_mfma_f32_16x16x32_bf16 v[178:181], v[206:209], v[36:39], 0
    v_permlane32_swap_b32 v237, v130
    v_mfma_f32_16x16x32_bf16 v[178:181], v[118:121], v[122:125], v[178:181]
    v_rcp_f32 v134, v134
    v_mfma_f32_16x16x32_bf16 v[182:185], v[226:229], v[36:39], 0
    v_max_f32 v237, v237, v130
    v_mov_b32 v130, v237
    v_mfma_f32_16x16x32_bf16 v[182:185], v[146:149], v[122:125], v[182:185]
    v_mul_f32 v174, v134, v174
    v_mul_f32 v175, v134, v175
    v_cvt_pk_bf16_f32 v122, v174, v175
    v_mul_f32 v176, v134, v176
    v_mul_f32 v177, v134, v177
    v_cvt_pk_bf16_f32 v123, v176, v177
    v_mul_f32 v178, v134, v178
    v_mul_f32 v179, v134, v179
    v_cvt_pk_bf16_f32 v124, v178, v179
    v_mul_f32 v180, v134, v180
    v_mul_f32 v181, v134, v181
    v_cvt_pk_bf16_f32 v125, v180, v181
    ds_write_b128 v3, v[122:125] offset:0
    v_mul_f32 v182, v134, v182
    v_mul_f32 v183, v134, v183
    v_cvt_pk_bf16_f32 v138, v182, v183
    v_mul_f32 v184, v134, v184
    v_mul_f32 v185, v134, v185
    v_cvt_pk_bf16_f32 v139, v184, v185
    v_permlane16_swap_b32 v237, v130
    ds_write_b64 v4, v[138:139] offset:4096
    v_max_f32 v237, v237, v130
    v_sub_f32 v154, v154, v237
    v_exp_f32 v154, v154
    v_sub_f32 v155, v155, v237
    v_exp_f32 v155, v155
    v_mfma_f32_16x16x32_f16 v[122:125], v[114:117], v[142:145], v[70:73]
    v_cvt_pk_bf16_f32 v114, v154, v155
    v_sub_f32 v156, v156, v237
    v_mfma_f32_16x16x32_f16 v[134:137], v[218:221], v[142:145], v[74:77]
    v_exp_f32 v156, v156
    v_mfma_f32_16x16x32_f16 v[174:177], v[210:213], v[142:145], v[78:81]
    v_sub_f32 v157, v157, v237
    v_exp_f32 v157, v157
    v_mfma_f32_16x16x16_f16 v[122:125], v[244:245], v[150:151], v[122:125]
    v_cvt_pk_bf16_f32 v115, v156, v157
    v_sub_f32 v162, v162, v237
    v_sub_f32 v163, v163, v237
    v_mfma_f32_16x16x16_f16 v[134:137], v[160:161], v[150:151], v[134:137]
    v_exp_f32 v162, v162
    v_sub_f32 v164, v164, v237
    v_mfma_f32_16x16x16_f16 v[174:177], v[152:153], v[150:151], v[174:177]
    s_waitcnt lgkmcnt(0)
    s_barrier
    ds_read_b128 v[142:145], v131 offset:0
    ds_read_b128 v[150:153], v131 offset:1024
    ds_read_b128 v[154:157], v131 offset:2048
    ds_read_b128 v[158:161], v131 offset:3072
    ds_read_b128 v[178:181], v131 offset:4096
    ds_read_b128 v[182:185], v131 offset:5120
    v_exp_f32 v163, v163
    v_exp_f32 v164, v164
    v_cvt_pk_bf16_f32 v116, v162, v163
    v_sub_f32 v165, v165, v237
    v_exp_f32 v165, v165
    v_sub_f32 v166, v166, v237
    v_cvt_pk_bf16_f32 v117, v164, v165
    v_exp_f32 v166, v166
    v_sub_f32 v167, v167, v237
    v_exp_f32 v167, v167
    s_waitcnt lgkmcnt(4)
    v_mfma_f32_16x16x32_bf16 v[162:165], a[216:219], v[142:145], 0
    s_waitcnt lgkmcnt(3)
    v_cvt_pk_bf16_f32 v36, v166, v167
    v_sub_f32 v168, v168, v237
    v_mfma_f32_16x16x32_bf16 v[162:165], a[220:223], v[150:153], v[162:165]
    s_waitcnt lgkmcnt(2)
    v_exp_f32 v168, v168
    v_mfma_f32_16x16x32_bf16 v[162:165], a[224:227], v[154:157], v[162:165]
    s_waitcnt lgkmcnt(1)
    v_sub_f32 v169, v169, v237
    v_sub_f32 v194, v194, v237
    v_mfma_f32_16x16x32_bf16 v[162:165], a[228:231], v[158:161], v[162:165]
    s_waitcnt lgkmcnt(0)
    v_exp_f32 v169, v169
    v_mfma_f32_16x16x32_bf16 v[162:165], a[232:235], v[178:181], v[162:165]
    v_cvt_pk_bf16_f32 v37, v168, v169
    v_max3_f32 v237, v126, v122, v123
    v_mfma_f32_16x16x32_bf16 v[162:165], a[236:239], v[182:185], v[162:165]
    v_exp_f32 v194, v194
    v_mfma_f32_16x16x32_bf16 v[166:169], a[240:243], v[142:145], 0
    v_cvt_pk_bf16_f32 v39, v194, 0
    v_max3_f32 v237, v237, v124, v125
    v_mfma_f32_16x16x32_bf16 v[166:169], a[244:247], v[150:153], v[166:169]
    v_max3_f32 v237, v237, v134, v135
    v_max3_f32 v237, v237, v136, v137
    v_mfma_f32_16x16x32_bf16 v[166:169], a[248:251], v[154:157], v[166:169]
    v_max3_f32 v237, v237, v174, v175
    v_max3_f32 v237, v237, v176, v177
    v_mfma_f32_16x16x32_bf16 v[166:169], a[252:255], v[158:161], v[166:169]
    v_mov_b32 v130, v237
    v_fma_f32 v132, v162, v162, s33
    v_mfma_f32_16x16x32_bf16 v[166:169], v[82:85], v[178:181], v[166:169]
    v_permlane32_swap_b32 v237, v130
    v_mfma_f32_16x16x32_bf16 v[166:169], v[86:89], v[182:185], v[166:169]
    v_max_f32 v237, v237, v130
    v_mov_b32 v130, v237
    v_mfma_f32_16x16x32_bf16 v[190:193], v[90:93], v[142:145], 0
    v_fmac_f32 v132, v163, v163
    v_fmac_f32 v132, v164, v164
    v_mfma_f32_16x16x32_bf16 v[190:193], v[94:97], v[150:153], v[190:193]
    v_permlane16_swap_b32 v237, v130
    v_mfma_f32_16x16x32_bf16 v[190:193], v[98:101], v[154:157], v[190:193]
    v_max_f32 v237, v237, v130
    v_sub_f32 v122, v122, v237
    v_mfma_f32_16x16x32_bf16 v[190:193], v[102:105], v[158:161], v[190:193]
    v_exp_f32 v122, v122
    v_mfma_f32_16x16x32_bf16 v[190:193], v[106:109], v[178:181], v[190:193]
    v_sub_f32 v123, v123, v237
    v_sub_f32 v124, v124, v237
    v_mfma_f32_16x16x32_bf16 v[190:193], v[110:113], v[182:185], v[190:193]
    v_exp_f32 v123, v123
    v_mfma_f32_16x16x32_bf16 v[142:145], v[28:31], v[36:39], 0
    v_cvt_pk_bf16_f32 v122, v122, v123
    v_sub_f32 v125, v125, v237
    v_mfma_f32_16x16x32_bf16 v[142:145], v[28:31], v[114:117], v[142:145]
    v_exp_f32 v124, v124
    v_mfma_f32_16x16x32_bf16 v[150:153], v[186:189], v[36:39], 0
    v_exp_f32 v125, v125
    v_mfma_f32_16x16x32_bf16 v[150:153], v[170:173], v[114:117], v[150:153]
    ds_read_b128 v[154:157], v9
    ds_read_b128 v[158:161], v9 offset:64
    v_mfma_f32_16x16x32_bf16 v[178:181], v[206:209], v[36:39], 0
    v_cvt_pk_bf16_f32 v123, v124, v125
    v_sub_f32 v134, v134, v237
    v_mfma_f32_16x16x32_bf16 v[178:181], v[118:121], v[114:117], v[178:181]
    v_exp_f32 v134, v134
    v_mfma_f32_16x16x32_bf16 v[182:185], v[226:229], v[36:39], 0
    v_sub_f32 v135, v135, v237
    v_sub_f32 v136, v136, v237
    v_mfma_f32_16x16x32_bf16 v[182:185], v[146:149], v[114:117], v[182:185]
    v_exp_f32 v135, v135
    v_exp_f32 v136, v136
    v_cvt_pk_bf16_f32 v124, v134, v135
    v_sub_f32 v137, v137, v237
    v_exp_f32 v137, v137
    v_sub_f32 v174, v174, v237
    v_cvt_pk_bf16_f32 v125, v136, v137
    v_exp_f32 v174, v174
    s_waitcnt lgkmcnt(1)
    v_mfma_f32_16x16x32_bf16 v[114:117], v[154:157], v[28:31], 0
    s_waitcnt lgkmcnt(0)
    v_sub_f32 v175, v175, v237
    v_sub_f32 v176, v176, v237
    v_mfma_f32_16x16x32_bf16 v[114:117], v[158:161], v[28:31], v[114:117]
    v_exp_f32 v175, v175
    v_mfma_f32_16x16x32_bf16 v[134:137], v[154:157], v[170:173], 0
    v_cvt_pk_bf16_f32 v36, v174, v175
    v_sub_f32 v177, v177, v237
    v_mfma_f32_16x16x32_bf16 v[134:137], v[158:161], v[186:189], v[134:137]
    v_exp_f32 v176, v176
    v_mfma_f32_16x16x32_bf16 v[194:197], v[154:157], v[118:121], 0
    v_exp_f32 v177, v177
    v_mfma_f32_16x16x32_bf16 v[194:197], v[158:161], v[206:209], v[194:197]
    v_cvt_pk_bf16_f32 v37, v176, v177
    v_sub_f32 v126, v126, v237
    v_mfma_f32_16x16x32_bf16 v[174:177], v[154:157], v[146:149], 0
    v_exp_f32 v126, v126
    v_mfma_f32_16x16x32_bf16 v[174:177], v[158:161], v[226:229], v[174:177]
    v_cvt_pk_bf16_f32 v39, v126, 0
    v_rcp_f32 v114, v114
    v_fmac_f32 v132, v165, v165
    v_mfma_f32_16x16x32_bf16 v[126:129], v[28:31], v[36:39], 0
    v_mul_f32 v134, v134, v114
    v_mul_f32_dpp v134, v194, v114 quad_perm:[0,1,2,3] row_mask:0x2 bank_mask:0xf
    v_mfma_f32_16x16x32_bf16 v[126:129], v[28:31], v[122:125], v[126:129]
    v_rcp_f32 v142, v142
    v_mfma_f32_16x16x32_bf16 v[154:157], v[186:189], v[36:39], 0
    v_mul_f32_dpp v134, v174, v114 quad_perm:[0,1,2,3] row_mask:0x4 bank_mask:0xf
    v_cvt_pk_bf16_f32 v134, v134, v134
    v_mfma_f32_16x16x32_bf16 v[154:157], v[170:173], v[122:125], v[154:157]
    ds_write_b16 v7, v134
    v_mfma_f32_16x16x32_bf16 v[114:117], v[206:209], v[36:39], 0
    v_fmac_f32 v132, v166, v166
    v_fmac_f32 v132, v167, v167
    v_mfma_f32_16x16x32_bf16 v[114:117], v[118:121], v[122:125], v[114:117]
    v_rcp_f32 v126, v126
    v_mfma_f32_16x16x32_bf16 v[118:121], v[226:229], v[36:39], 0
    v_fmac_f32 v132, v168, v168
    v_mul_f32 v154, v126, v154
    v_mfma_f32_16x16x32_bf16 v[118:121], v[146:149], v[122:125], v[118:121]
    v_mul_f32 v155, v126, v155
    v_cvt_pk_bf16_f32 v122, v154, v155
    v_mul_f32 v156, v126, v156
    v_mul_f32 v157, v126, v157
    v_cvt_pk_bf16_f32 v123, v156, v157
    v_mul_f32 v114, v126, v114
    v_mul_f32 v115, v126, v115
    v_cvt_pk_bf16_f32 v124, v114, v115
    v_mul_f32 v116, v126, v116
    v_mul_f32 v117, v126, v117
    v_cvt_pk_bf16_f32 v125, v116, v117
    ds_write_b128 v3, v[122:125] offset:12288
    v_mul_f32 v118, v126, v118
    v_mul_f32 v119, v126, v119
    v_cvt_pk_bf16_f32 v138, v118, v119
    v_mul_f32 v120, v126, v120
    v_mul_f32 v121, v126, v121
    v_cvt_pk_bf16_f32 v139, v120, v121
    v_fmac_f32 v132, v169, v169
    ds_write_b64 v4, v[138:139] offset:16384
    v_fmac_f32 v132, v190, v190
    v_fmac_f32 v132, v191, v191
    v_fmac_f32 v132, v192, v192
    v_fmac_f32 v132, v193, v193
    v_cvt_pk_bf16_f32 v138, v132, v132
    v_cvt_pk_bf16_f32 v139, v132, v132
    ds_write_b64 v235, v[138:139] offset:4096
    v_mul_f32 v150, v142, v150
    v_mul_f32 v151, v142, v151
    v_cvt_pk_bf16_f32 v114, v150, v151
    v_mul_f32 v152, v142, v152
    v_mul_f32 v153, v142, v153
    v_cvt_pk_bf16_f32 v115, v152, v153
    v_mul_f32 v178, v142, v178
    v_mul_f32 v179, v142, v179
    v_cvt_pk_bf16_f32 v116, v178, v179
    v_mul_f32 v180, v142, v180
    v_mul_f32 v181, v142, v181
    v_cvt_pk_bf16_f32 v117, v180, v181
    ds_write_b128 v3, v[114:117] offset:6144
    v_mul_f32 v182, v142, v182
    v_mul_f32 v183, v142, v183
    v_cvt_pk_bf16_f32 v138, v182, v183
    v_mul_f32 v184, v142, v184
    v_mul_f32 v185, v142, v185
    v_cvt_pk_bf16_f32 v139, v184, v185
    ds_write_b64 v4, v[138:139] offset:10240
    s_waitcnt lgkmcnt(0)
    s_barrier
    ds_read_b128 v[114:117], v234 offset:4096
    ds_read_b128 v[118:121], v234 offset:5120
    ds_read_b128 v[122:125], v131 offset:6144
    ds_read_b128 v[126:129], v131 offset:7168
    ds_read_b128 v[134:137], v131 offset:8192
    ds_read_b128 v[142:145], v131 offset:9216
    ds_read_b128 v[146:149], v131 offset:10240
    ds_read_b128 v[150:153], v131 offset:11264
    s_waitcnt lgkmcnt(7)
    v_mfma_f32_16x16x32_bf16 v[154:157], v[32:35], v[114:117], 0
    s_waitcnt lgkmcnt(6)
    v_mfma_f32_16x16x32_bf16 v[154:157], v[32:35], v[118:121], v[154:157]
    s_waitcnt lgkmcnt(4)
    v_mfma_f32_16x16x32_bf16 v[114:117], a[216:219], v[122:125], 0
    s_waitcnt lgkmcnt(3)
    v_mfma_f32_16x16x32_bf16 v[114:117], a[220:223], v[126:129], v[114:117]
    s_waitcnt lgkmcnt(2)
    v_mfma_f32_16x16x32_bf16 v[114:117], a[224:227], v[134:137], v[114:117]
    s_waitcnt lgkmcnt(1)
    v_mfma_f32_16x16x32_bf16 v[114:117], a[228:231], v[142:145], v[114:117]
    s_waitcnt lgkmcnt(0)
    v_mul_f32 v237, 0x3baaaaab, v154
    v_mfma_f32_16x16x32_bf16 v[114:117], a[232:235], v[146:149], v[114:117]
    v_rsq_f32 v237, v237
    v_mfma_f32_16x16x32_bf16 v[114:117], a[236:239], v[150:153], v[114:117]
    v_mul_f32 v162, v237, v162
    v_mul_f32 v163, v237, v163
    v_mfma_f32_16x16x32_bf16 v[118:121], a[240:243], v[122:125], 0
    v_cvt_pk_bf16_f32 v154, v162, v163
    v_mul_f32 v164, v237, v164
    v_mfma_f32_16x16x32_bf16 v[118:121], a[244:247], v[126:129], v[118:121]
    v_mul_f32 v165, v237, v165
    v_cvt_pk_bf16_f32 v155, v164, v165
    v_mfma_f32_16x16x32_bf16 v[118:121], a[248:251], v[134:137], v[118:121]
    v_mul_f32 v166, v237, v166
    v_mul_f32 v167, v237, v167
    v_mfma_f32_16x16x32_bf16 v[118:121], a[252:255], v[142:145], v[118:121]
    v_cvt_pk_bf16_f32 v156, v166, v167
    v_mul_f32 v168, v237, v168
    v_mfma_f32_16x16x32_bf16 v[118:121], v[82:85], v[146:149], v[118:121]
    v_mul_f32 v169, v237, v169
    v_cvt_pk_bf16_f32 v157, v168, v169
    v_mfma_f32_16x16x32_bf16 v[118:121], v[86:89], v[150:153], v[118:121]
    buffer_store_dwordx4 v[154:157], v15, s[56:59], 0 offen nt
    v_mul_f32 v190, v237, v190
    v_mul_f32 v191, v237, v191
    v_cvt_pk_bf16_f32 v138, v190, v191
    v_mul_f32 v192, v237, v192
    v_mfma_f32_16x16x32_bf16 v[154:157], v[90:93], v[122:125], 0
    ds_read_b128 v[122:125], v133 offset:256
    v_mul_f32 v193, v237, v193
    v_mfma_f32_16x16x32_bf16 v[154:157], v[94:97], v[126:129], v[154:157]
    ds_read_b128 v[126:129], v133 offset:2304
    v_cvt_pk_bf16_f32 v139, v192, v193
    v_mfma_f32_16x16x32_bf16 v[154:157], v[98:101], v[134:137], v[154:157]
    ds_read_b128 v[134:137], v133 offset:4352
    v_fma_f32 v237, v114, v114, s33
    v_mfma_f32_16x16x32_bf16 v[154:157], v[102:105], v[142:145], v[154:157]
    ds_read_b128 v[142:145], v133 offset:6400
    v_fmac_f32 v237, v115, v115
    v_mfma_f32_16x16x32_bf16 v[154:157], v[106:109], v[146:149], v[154:157]
    ds_read_b128 v[146:149], v133 offset:8448
    v_fmac_f32 v237, v116, v116
    v_mfma_f32_16x16x32_bf16 v[154:157], v[110:113], v[150:153], v[154:157]
    ds_read_b128 v[150:153], v133 offset:10496
    v_fmac_f32 v237, v117, v117
    v_fmac_f32 v237, v118, v118
    v_fmac_f32 v237, v119, v119
    v_fmac_f32 v237, v120, v120
    v_fmac_f32 v237, v121, v121
    s_nop 0
    s_nop 0
    s_waitcnt lgkmcnt(5)
    v_mfma_f32_16x16x32_bf16 v[158:161], a[216:219], v[122:125], 0
    v_fmac_f32 v237, v154, v154
    v_fmac_f32 v237, v155, v155
    v_mfma_f32_16x16x32_bf16 v[162:165], a[240:243], v[122:125], 0
    s_waitcnt lgkmcnt(4)
    v_fmac_f32 v237, v156, v156
    v_fmac_f32 v237, v157, v157
    v_mfma_f32_16x16x32_bf16 v[158:161], a[220:223], v[126:129], v[158:161]
    s_waitcnt lgkmcnt(3)
    v_cvt_pk_bf16_f32 v132, v237, v237
    v_cvt_pk_bf16_f32 v133, v237, v237
    v_mfma_f32_16x16x32_bf16 v[158:161], a[224:227], v[134:137], v[158:161]
    s_waitcnt lgkmcnt(2)
    ds_write_b64 v235, v[132:133] offset:6144
    v_mfma_f32_16x16x32_bf16 v[158:161], a[228:231], v[142:145], v[158:161]
    s_waitcnt lgkmcnt(2)
    v_mfma_f32_16x16x32_bf16 v[158:161], a[232:235], v[146:149], v[158:161]
    s_waitcnt lgkmcnt(1)
    v_mfma_f32_16x16x32_bf16 v[158:161], a[236:239], v[150:153], v[158:161]
    v_mfma_f32_16x16x32_bf16 v[162:165], a[244:247], v[126:129], v[162:165]
    buffer_store_dwordx2 v[138:139], v18, s[56:59], 0 offen nt
    v_mfma_f32_16x16x32_bf16 v[162:165], a[248:251], v[134:137], v[162:165]
    v_mfma_f32_16x16x32_bf16 v[162:165], a[252:255], v[142:145], v[162:165]
    v_mfma_f32_16x16x32_bf16 v[162:165], v[82:85], v[146:149], v[162:165]
    s_waitcnt lgkmcnt(0)
    v_mfma_f32_16x16x32_bf16 v[162:165], v[86:89], v[150:153], v[162:165]
    s_barrier
    ds_read_b128 v[166:169], v234 offset:6144
    ds_read_b128 v[170:173], v234 offset:7168
    v_mfma_f32_16x16x32_bf16 v[174:177], v[90:93], v[122:125], 0
    ds_read_b128 v[122:125], v131 offset:12288
    v_fma_f32 v237, v158, v158, s33
    v_mfma_f32_16x16x32_bf16 v[174:177], v[94:97], v[126:129], v[174:177]
    ds_read_b128 v[126:129], v131 offset:13312
    v_fmac_f32 v237, v159, v159
    v_mfma_f32_16x16x32_bf16 v[174:177], v[98:101], v[134:137], v[174:177]
    ds_read_b128 v[134:137], v131 offset:14336
    v_fmac_f32 v237, v160, v160
    v_mfma_f32_16x16x32_bf16 v[174:177], v[102:105], v[142:145], v[174:177]
    ds_read_b128 v[142:145], v131 offset:15360
    v_fmac_f32 v237, v161, v161
    v_mfma_f32_16x16x32_bf16 v[174:177], v[106:109], v[146:149], v[174:177]
    ds_read_b128 v[146:149], v131 offset:16384
    v_fmac_f32 v237, v162, v162
    v_mfma_f32_16x16x32_bf16 v[174:177], v[110:113], v[150:153], v[174:177]
    ds_read_b128 v[150:153], v131 offset:17408
    v_fmac_f32 v237, v163, v163
    v_fmac_f32 v237, v164, v164
    v_fmac_f32 v237, v165, v165
    s_waitcnt lgkmcnt(7)
    v_mfma_f32_16x16x32_bf16 v[178:181], v[32:35], v[166:169], 0
    s_waitcnt lgkmcnt(6)
    v_mfma_f32_16x16x32_bf16 v[178:181], v[32:35], v[170:173], v[178:181]
    s_waitcnt lgkmcnt(5)
    v_fmac_f32 v237, v174, v174
    v_fmac_f32 v237, v175, v175
    v_mfma_f32_16x16x32_bf16 v[166:169], a[216:219], v[122:125], 0
    s_waitcnt lgkmcnt(4)
    v_fmac_f32 v237, v176, v176
    v_fmac_f32 v237, v177, v177
    v_mfma_f32_16x16x32_bf16 v[166:169], a[220:223], v[126:129], v[166:169]
    s_waitcnt lgkmcnt(3)
    v_cvt_pk_bf16_f32 v138, v237, v237
    v_cvt_pk_bf16_f32 v139, v237, v237
    v_mfma_f32_16x16x32_bf16 v[166:169], a[224:227], v[134:137], v[166:169]
    s_waitcnt lgkmcnt(2)
    ds_write_b64 v235, v[138:139] offset:8192
    v_mfma_f32_16x16x32_bf16 v[166:169], a[228:231], v[142:145], v[166:169]
    s_waitcnt lgkmcnt(2)
    v_mul_f32 v237, 0x3baaaaab, v178
    v_mfma_f32_16x16x32_bf16 v[166:169], a[232:235], v[146:149], v[166:169]
    s_waitcnt lgkmcnt(1)
    v_rsq_f32 v237, v237
    v_mfma_f32_16x16x32_bf16 v[166:169], a[236:239], v[150:153], v[166:169]
    v_mul_f32 v114, v237, v114
    v_mul_f32 v115, v237, v115
    v_mfma_f32_16x16x32_bf16 v[170:173], a[240:243], v[122:125], 0
    v_cvt_pk_bf16_f32 v114, v114, v115
    v_mul_f32 v116, v237, v116
    v_mfma_f32_16x16x32_bf16 v[170:173], a[244:247], v[126:129], v[170:173]
    v_mul_f32 v117, v237, v117
    v_cvt_pk_bf16_f32 v115, v116, v117
    v_mfma_f32_16x16x32_bf16 v[170:173], a[248:251], v[134:137], v[170:173]
    v_fma_f32 v138, v166, v166, s33
    v_fmac_f32 v138, v167, v167
    v_mfma_f32_16x16x32_bf16 v[170:173], a[252:255], v[142:145], v[170:173]
    s_waitcnt lgkmcnt(0)
    v_fmac_f32 v138, v168, v168
    v_fmac_f32 v138, v169, v169
    v_mfma_f32_16x16x32_bf16 v[170:173], v[82:85], v[146:149], v[170:173]
    s_barrier
    ds_read_b128 v[178:181], v234 offset:8192
    ds_read_b128 v[182:185], v234 offset:9216
    v_mfma_f32_16x16x32_bf16 v[170:173], v[86:89], v[150:153], v[170:173]
    v_mul_f32 v118, v237, v118
    v_mul_f32 v119, v237, v119
    v_mfma_f32_16x16x32_bf16 v[186:189], v[90:93], v[122:125], 0
    v_cvt_pk_bf16_f32 v116, v118, v119
    v_mul_f32 v120, v237, v120
    v_mfma_f32_16x16x32_bf16 v[186:189], v[94:97], v[126:129], v[186:189]
    v_mul_f32 v121, v237, v121
    v_cvt_pk_bf16_f32 v117, v120, v121
    v_mfma_f32_16x16x32_bf16 v[186:189], v[98:101], v[134:137], v[186:189]
    ds_write_b128 v140, v[114:117] offset:1536
    v_mfma_f32_16x16x32_bf16 v[186:189], v[102:105], v[142:145], v[186:189]
    v_fmac_f32 v138, v170, v170
    v_fmac_f32 v138, v171, v171
    v_mfma_f32_16x16x32_bf16 v[186:189], v[106:109], v[146:149], v[186:189]
    v_fmac_f32 v138, v172, v172
    v_fmac_f32 v138, v173, v173
    v_mfma_f32_16x16x32_bf16 v[186:189], v[110:113], v[150:153], v[186:189]
    s_waitcnt lgkmcnt(1)
    ds_read_b128 v[114:117], v202 offset:1536
    v_mul_f32 v154, v237, v154
    v_mfma_f32_16x16x32_bf16 v[118:121], v[32:35], v[178:181], 0
    v_mul_f32 v155, v237, v155
    v_cvt_pk_bf16_f32 v154, v154, v155
    v_mfma_f32_16x16x32_bf16 v[118:121], v[32:35], v[182:185], v[118:121]
    v_mul_f32 v156, v237, v156
    v_fmac_f32 v138, v186, v186
    v_fmac_f32 v138, v187, v187
    v_fmac_f32 v138, v188, v188
    v_fmac_f32 v138, v189, v189
    v_cvt_pk_bf16_f32 v132, v138, v138
    v_cvt_pk_bf16_f32 v133, v138, v138
    ds_write_b64 v235, v[132:133] offset:0
    v_mul_f32 v157, v237, v157
    v_cvt_pk_bf16_f32 v155, v156, v157
    v_mul_f32 v138, 0x3baaaaab, v118
    ds_write_b64 v141, v[154:155] offset:2560
    s_waitcnt lgkmcnt(2)
    buffer_store_dwordx4 v[114:117], v203, s[56:59], 0 offen nt
    v_rsq_f32 v138, v138
    ds_read_b64 v[224:225], v254 offset:2560
    v_mul_f32 v158, v138, v158
    v_mul_f32 v159, v138, v159
    v_cvt_pk_bf16_f32 v114, v158, v159
    v_mul_f32 v160, v138, v160
    v_mul_f32 v161, v138, v161
    v_cvt_pk_bf16_f32 v115, v160, v161
    v_mul_f32 v162, v138, v162
    v_mul_f32 v163, v138, v163
    v_cvt_pk_bf16_f32 v116, v162, v163
    v_mul_f32 v164, v138, v164
    s_waitcnt lgkmcnt(2)
    s_barrier
    ds_read_b128 v[118:121], v234 offset:0
    ds_read_b128 v[122:125], v234 offset:1024
    ds_read_b128 v[126:129], v131 offset:18432
    v_mul_f32 v165, v138, v165
    v_cvt_pk_bf16_f32 v117, v164, v165
    buffer_store_dwordx4 v[114:117], v236, s[12:15], 0 offen nt
    v_mul_f32 v174, v138, v174
    v_mul_f32 v175, v138, v175
    v_cvt_pk_bf16_f32 v174, v174, v175
    v_mul_f32 v176, v138, v176
    v_mul_f32 v177, v138, v177
    v_cvt_pk_bf16_f32 v175, v176, v177
    s_waitcnt lgkmcnt(3)
    s_waitcnt lgkmcnt(2)
    v_mfma_f32_16x16x32_bf16 v[114:117], v[32:35], v[118:121], 0
    s_waitcnt lgkmcnt(1)
    v_mfma_f32_16x16x32_bf16 v[114:117], v[32:35], v[122:125], v[114:117]
    s_waitcnt lgkmcnt(0)
    v_or3_b32 v126, v126, v127, v128
    v_or_b32 v126, v126, v129
    v_cmp_gt_i32 s[46:47], 0, v126
    buffer_store_dwordx2 v[224:225], v204, s[56:59], 0 offen nt
    s_nop 0
    s_nop 0
    s_nop 0
    v_mul_f32 v203, 0x3baaaaab, v114
    v_rsq_f32 v203, v203
    s_nop 0
    v_mul_f32 v166, v203, v166
    v_mul_f32 v167, v203, v167
    v_cvt_pk_bf16_f32 v114, v166, v167
    v_mul_f32 v168, v203, v168
    v_mul_f32 v169, v203, v169
    v_cvt_pk_bf16_f32 v115, v168, v169
    v_mul_f32 v170, v203, v170
    v_mul_f32 v171, v203, v171
    v_cvt_pk_bf16_f32 v116, v170, v171
    v_mul_f32 v172, v203, v172
    v_mul_f32 v173, v203, v173
    v_cvt_pk_bf16_f32 v117, v172, v173
    ds_write_b128 v140, v[114:117] offset:3072
    buffer_store_dwordx2 v[174:175], v255, s[12:15], 0 offen nt
    v_mul_f32 v186, v203, v186
    v_mul_f32 v187, v203, v187
    v_cvt_pk_bf16_f32 v186, v186, v187
    v_mul_f32 v188, v203, v188
    v_mul_f32 v189, v203, v189
    v_cvt_pk_bf16_f32 v187, v188, v189
    ds_read_b128 v[114:117], v202 offset:3072
    ds_write_b64 v141, v[186:187] offset:4096
    ds_read_b64 v[224:225], v254 offset:4096
    s_waitcnt lgkmcnt(2)
    buffer_store_dwordx4 v[114:117], v205, s[56:59], 0 offen nt
    s_waitcnt lgkmcnt(0)
    buffer_store_dwordx2 v[224:225], v222, s[56:59], 0 offen nt
    s_branch L_end
L_drain:
    ds_read_b128 v[114:117], v2 offset:18432
    ds_read_b128 v[118:121], v2 offset:19456
    ds_read_b128 v[122:125], v2 offset:0
    s_mul_i32 s5, s16, 8064
    s_mov_b32 s12, s42
    ds_read_b128 v[126:129], v2 offset:1024
    s_mov_b32 s13, s43
    s_cmp_ge_u32 s18, 2
    s_cselect_b32 s14, s36, 0
    ds_read_b128 v[130:133], v2 offset:2048
    s_add_u32 s5, s5, 104448
    s_lshl_b32 s3, s16, 6
    s_lshl_b32 s4, s16, 5
    ds_read_b128 v[134:137], v2 offset:3072
    s_add_u32 s4, s4, 256
    ds_read_b128 v[154:157], v2 offset:4096
    ds_read_b128 v[162:165], v2 offset:5120
    v_bfe_u32 v254, v2, 4, 6
    v_lshrrev_b32 v255, 4, v254
    v_and_b32 v166, 15, v254
    v_lshlrev_b32 v167, 9, v255
    v_lshl_add_u32 v167, v166, 4, v167
    v_add_u32 v167, 136704, v167
    s_waitcnt lgkmcnt(7)
    v_mfma_f32_16x16x32_bf16 v[170:173], v[32:35], v[114:117], 0
    s_waitcnt lgkmcnt(5)
    v_xor_b32 v168, 65536, v2
    v_bfe_u32 v169, v166, 1, 2
    v_mfma_f32_16x16x32_bf16 v[170:173], v[32:35], v[118:121], v[170:173]
    s_waitcnt lgkmcnt(4)
    v_xor_b32 v169, v169, v255
    v_lshl_add_u32 v169, v166, 2, v169
    v_lshl_add_u32 v114, v169, 4, s5
    v_mfma_f32_16x16x32_bf16 v[118:121], a[216:219], v[122:125], 0
    s_waitcnt lgkmcnt(3)
    v_lshl_add_u32 v115, v169, 3, s5
    v_lshl_add_u32 v116, v254, 4, s5
    v_lshl_add_u32 v117, v254, 3, s5
    v_mfma_f32_16x16x32_bf16 v[118:121], a[220:223], v[126:129], v[118:121]
    s_waitcnt lgkmcnt(2)
    v_lshlrev_b32 v169, 2, v169
    v_mul_f32 v170, 0x3baaaaab, v170
    v_rsq_f32 v170, v170
    v_mfma_f32_16x16x32_bf16 v[118:121], a[224:227], v[130:133], v[118:121]
    s_waitcnt lgkmcnt(0)
    ds_permute_b32 v173, v169, v15
    ds_permute_b32 v174, v169, v18
    v_mul_f32 v150, v170, v150
    v_mfma_f32_16x16x32_bf16 v[118:121], a[228:231], v[134:137], v[118:121]
    ds_permute_b32 v175, v169, v16
    ds_permute_b32 v176, v169, v19
    v_mul_f32 v151, v170, v151
    v_mfma_f32_16x16x32_bf16 v[118:121], a[232:235], v[154:157], v[118:121]
    ds_permute_b32 v177, v169, v17
    ds_permute_b32 v182, v169, v20
    v_cvt_pk_bf16_f32 v150, v150, v151
    v_mfma_f32_16x16x32_bf16 v[118:121], a[236:239], v[162:165], v[118:121]
    v_mul_f32 v152, v170, v152
    v_mul_f32 v153, v170, v153
    v_cvt_pk_bf16_f32 v151, v152, v153
    v_mfma_f32_16x16x32_bf16 v[194:197], a[240:243], v[122:125], 0
    v_mul_f32 v190, v170, v190
    v_mul_f32 v191, v170, v191
    v_cvt_pk_bf16_f32 v152, v190, v191
    v_mfma_f32_16x16x32_bf16 v[194:197], a[244:247], v[126:129], v[194:197]
    v_mul_f32 v192, v170, v192
    v_mul_f32 v193, v170, v193
    v_cvt_pk_bf16_f32 v153, v192, v193
    v_mfma_f32_16x16x32_bf16 v[194:197], a[248:251], v[130:133], v[194:197]
    s_waitcnt lgkmcnt(4)
    ds_read_b128 v[190:193], v2 offset:6144
    v_mul_f32 v202, v170, v202
    v_mul_f32 v203, v170, v203
    v_mfma_f32_16x16x32_bf16 v[194:197], a[252:255], v[134:137], v[194:197]
    s_waitcnt lgkmcnt(3)
    ds_read_b128 v[198:201], v2 offset:7168
    v_cvt_pk_bf16_f32 v184, v202, v203
    v_mul_f32 v204, v170, v204
    v_mfma_f32_16x16x32_bf16 v[194:197], v[82:85], v[154:157], v[194:197]
    s_waitcnt lgkmcnt(2)
    ds_read_b128 v[206:209], v2 offset:8192
    v_mul_f32 v205, v170, v205
    v_cvt_pk_bf16_f32 v185, v204, v205
    v_mfma_f32_16x16x32_bf16 v[194:197], v[86:89], v[162:165], v[194:197]
    ds_read_b128 v[202:205], v2 offset:9216
    v_fma_f32 v169, v118, v118, s33
    v_fmac_f32 v169, v119, v119
    v_mfma_f32_16x16x32_bf16 v[210:213], v[90:93], v[122:125], 0
    ds_read_b128 v[122:125], v2 offset:10240
    v_fmac_f32 v169, v120, v120
    v_fmac_f32 v169, v121, v121
    v_mfma_f32_16x16x32_bf16 v[210:213], v[94:97], v[126:129], v[210:213]
    ds_read_b128 v[126:129], v2 offset:11264
    v_fmac_f32 v169, v194, v194
    v_fmac_f32 v169, v195, v195
    v_mfma_f32_16x16x32_bf16 v[210:213], v[98:101], v[130:133], v[210:213]
    s_waitcnt lgkmcnt(5)
    buffer_store_dwordx4 v[150:153], v15, s[12:15], s27 offen nt
    v_fmac_f32 v169, v196, v196
    v_fmac_f32 v169, v197, v197
    v_mul_f32 v183, 0x3baaaaab, v171
    v_mfma_f32_16x16x32_bf16 v[210:213], v[102:105], v[134:137], v[210:213]
    s_waitcnt lgkmcnt(4)
    v_rsq_f32 v183, v183
    v_subrev_u32 v170, 0x3d800000, v44
    v_mfma_f32_16x16x32_bf16 v[210:213], v[106:109], v[154:157], v[210:213]
    s_waitcnt lgkmcnt(3)
    v_mul_f32 v142, v183, v142
    v_mul_f32 v143, v183, v143
    v_cvt_pk_bf16_f32 v130, v142, v143
    v_mfma_f32_16x16x32_bf16 v[210:213], v[110:113], v[162:165], v[210:213]
    s_waitcnt lgkmcnt(2)
    v_mul_f32 v144, v183, v144
    v_mul_f32 v145, v183, v145
    v_cvt_pk_bf16_f32 v131, v144, v145
    v_mfma_f32_16x16x32_bf16 v[134:137], a[216:219], v[190:193], 0
    s_waitcnt lgkmcnt(1)
    v_mul_f32 v158, v183, v158
    v_mul_f32 v159, v183, v159
    v_fmac_f32 v169, v210, v210
    v_mfma_f32_16x16x32_bf16 v[134:137], a[220:223], v[198:201], v[134:137]
    s_waitcnt lgkmcnt(0)
    v_fmac_f32 v169, v211, v211
    v_fmac_f32 v169, v212, v212
    v_fmac_f32 v169, v213, v213
    v_mfma_f32_16x16x32_bf16 v[134:137], a[224:227], v[206:209], v[134:137]
    v_cvt_pk_bf16_f32 v132, v158, v159
    v_mul_f32 v160, v183, v160
    v_mul_f32 v161, v183, v161
    v_mfma_f32_16x16x32_bf16 v[134:137], a[228:231], v[202:205], v[134:137]
    v_cvt_pk_bf16_f32 v133, v160, v161
    v_mul_f32 v178, v183, v178
    v_mul_f32 v179, v183, v179
    v_mfma_f32_16x16x32_bf16 v[134:137], a[232:235], v[122:125], v[134:137]
    v_cvt_pk_bf16_f32 v178, v178, v179
    v_mul_f32 v180, v183, v180
    v_mul_f32 v181, v183, v181
    v_mfma_f32_16x16x32_bf16 v[134:137], a[236:239], v[126:129], v[134:137]
    v_cvt_pk_bf16_f32 v179, v180, v181
    v_sub_u32 v183, 0x4a000000, v45
    v_or3_b32 v170, v170, v183, v45
    v_mfma_f32_16x16x32_bf16 v[142:145], a[240:243], v[190:193], 0
    v_lshl_add_u32 v183, s16, 2, v168
    v_mul_f32 v180, 0x3baaaaab, v172
    v_rsq_f32 v180, v180
    v_mfma_f32_16x16x32_bf16 v[142:145], a[244:247], v[198:201], v[142:145]
    ds_write_b32 v183, v170 offset:18432
    v_fma_f32 v181, v134, v134, s33
    v_mfma_f32_16x16x32_bf16 v[142:145], a[248:251], v[206:209], v[142:145]
    v_fmac_f32 v181, v135, v135
    v_fmac_f32 v181, v136, v136
    v_fmac_f32 v181, v137, v137
    v_mfma_f32_16x16x32_bf16 v[142:145], a[252:255], v[202:205], v[142:145]
    ds_read_b128 v[150:153], v2 offset:12288
    ds_read_b128 v[154:157], v2 offset:13312
    v_mul_f32 v146, v180, v146
    v_mfma_f32_16x16x32_bf16 v[142:145], v[82:85], v[122:125], v[142:145]
    ds_read_b128 v[158:161], v2 offset:14336
    v_mul_f32 v147, v180, v147
    v_cvt_pk_bf16_f32 v146, v146, v147
    v_mfma_f32_16x16x32_bf16 v[142:145], v[86:89], v[126:129], v[142:145]
    ds_read_b128 v[162:165], v2 offset:15360
    v_mul_f32 v148, v180, v148
    v_mul_f32 v149, v180, v149
    v_mfma_f32_16x16x32_bf16 v[214:217], v[90:93], v[190:193], 0
    ds_read_b128 v[190:193], v2 offset:16384
    v_cvt_pk_bf16_f32 v147, v148, v149
    v_mul_f32 v138, v180, v138
    v_mfma_f32_16x16x32_bf16 v[214:217], v[94:97], v[198:201], v[214:217]
    ds_read_b128 v[198:201], v2 offset:17408
    v_fmac_f32 v181, v142, v142
    v_fmac_f32 v181, v143, v143
    v_mfma_f32_16x16x32_bf16 v[214:217], v[98:101], v[206:209], v[214:217]
    buffer_store_dwordx2 v[184:185], v18, s[12:15], s27 offen nt
    v_fmac_f32 v181, v144, v144
    v_mfma_f32_16x16x32_bf16 v[214:217], v[102:105], v[202:205], v[214:217]
    s_waitcnt lgkmcnt(4)
    v_fmac_f32 v181, v145, v145
    v_mul_f32 v139, v180, v139
    v_cvt_pk_bf16_f32 v148, v138, v139
    v_mfma_f32_16x16x32_bf16 v[214:217], v[106:109], v[122:125], v[214:217]
    s_waitcnt lgkmcnt(3)
    v_mul_f32 v140, v180, v140
    v_mul_f32 v141, v180, v141
    v_cvt_pk_bf16_f32 v149, v140, v141
    v_mfma_f32_16x16x32_bf16 v[214:217], v[110:113], v[126:129], v[214:217]
    s_waitcnt lgkmcnt(2)
    ds_write_b128 v114, v[146:149] offset:3072
    v_mfma_f32_16x16x32_bf16 v[122:125], a[216:219], v[150:153], 0
    s_waitcnt lgkmcnt(2)
    v_mul_f32 v186, v180, v186
    v_mul_f32 v187, v180, v187
    v_cvt_pk_bf16_f32 v186, v186, v187
    v_mfma_f32_16x16x32_bf16 v[122:125], a[220:223], v[154:157], v[122:125]
    s_waitcnt lgkmcnt(1)
    v_fmac_f32 v181, v214, v214
    v_fmac_f32 v181, v215, v215
    v_fmac_f32 v181, v216, v216
    v_mfma_f32_16x16x32_bf16 v[122:125], a[224:227], v[158:161], v[122:125]
    ds_read_b128 v[126:129], v116 offset:3072
    v_fmac_f32 v181, v217, v217
    v_cvt_pk_bf16_f32 v170, v169, v181
    v_mfma_f32_16x16x32_bf16 v[122:125], a[228:231], v[162:165], v[122:125]
    v_cvt_pk_bf16_f32 v171, v181, v181
    v_mul_f32 v188, v180, v188
    v_mul_f32 v189, v180, v189
    v_mfma_f32_16x16x32_bf16 v[122:125], a[232:235], v[190:193], v[122:125]
    ds_write_b64 v4, v[170:171] offset:0
    v_mfma_f32_16x16x32_bf16 v[122:125], a[236:239], v[198:201], v[122:125]
    v_cvt_pk_bf16_f32 v187, v188, v189
    v_mov_b32 v169, 0x40000000
    v_lshrrev_b32 v180, 2, v254
    v_mfma_f32_16x16x32_bf16 v[138:141], a[240:243], v[150:153], 0
    ds_write_b64 v115, v[186:187] offset:4096
    v_mfma_f32_16x16x32_bf16 v[138:141], a[244:247], v[154:157], v[138:141]
    v_lshrrev_b32 v181, 3, v254
    v_xor_b32 v181, v181, v254
    v_fma_f32 v254, v122, v122, s33
    v_mfma_f32_16x16x32_bf16 v[138:141], a[248:251], v[158:161], v[138:141]
    s_waitcnt lgkmcnt(2)
    ds_read_b128 v[146:149], v167 offset:0
    ds_read_b64 v[170:171], v117 offset:4096
    v_fmac_f32 v254, v123, v123
    v_mfma_f32_16x16x32_bf16 v[138:141], a[252:255], v[162:165], v[138:141]
    ds_read_b128 v[186:189], v167 offset:2048
    v_fmac_f32 v254, v124, v124
    v_fmac_f32 v254, v125, v125
    v_mfma_f32_16x16x32_bf16 v[138:141], v[82:85], v[190:193], v[138:141]
    s_waitcnt lgkmcnt(4)
    ds_read_b128 v[202:205], v167 offset:4096
    v_and_b32 v181, 3, v181
    v_add_u32 v172, 0, v180
    v_mfma_f32_16x16x32_bf16 v[138:141], v[86:89], v[198:201], v[138:141]
    s_barrier
    ds_read_b128 v[206:209], v168 offset:0
    ds_read_b128 v[218:221], v168 offset:1024
    v_mul_u32_u24 v180, s20, v172
    v_mfma_f32_16x16x32_bf16 v[222:225], v[90:93], v[150:153], 0
    ds_read_b128 v[150:153], v167 offset:6144
    ds_read_b128 v[226:229], v167 offset:8192
    v_add_u32 v180, s38, v180
    v_mfma_f32_16x16x32_bf16 v[222:225], v[94:97], v[154:157], v[222:225]
    ds_read_b128 v[154:157], v167 offset:10240
    v_fmac_f32 v254, v138, v138
    v_fmac_f32 v254, v139, v139
    v_mfma_f32_16x16x32_bf16 v[222:225], v[98:101], v[158:161], v[222:225]
    s_waitcnt lgkmcnt(7)
    buffer_store_dwordx4 v[130:133], v16, s[12:15], s27 offen nt
    ds_read_b128 v[158:161], v168 offset:18432
    v_fmac_f32 v254, v140, v140
    v_fmac_f32 v254, v141, v141
    v_mfma_f32_16x16x32_bf16 v[222:225], v[102:105], v[162:165], v[222:225]
    s_waitcnt lgkmcnt(7)
    v_mul_u32_u24 v180, 911, v180
    v_lshrrev_b32 v180, 16, v180
    v_mul_u32_u24 v180, s22, v180
    v_mfma_f32_16x16x32_bf16 v[222:225], v[106:109], v[190:193], v[222:225]
    s_waitcnt lgkmcnt(6)
    v_mad_u32_u24 v180, v172, s21, v180
    v_cmp_gt_u32 vcc, s17, v172
    v_add_u32 v172, s7, v180
    v_mfma_f32_16x16x32_bf16 v[222:225], v[110:113], v[198:201], v[222:225]
    s_waitcnt lgkmcnt(4)
    v_cndmask_b32 v172, v169, v172, vcc
    v_lshl_add_u32 v183, v181, 4, v172
    v_mfma_f32_16x16x32_bf16 v[130:133], v[32:35], v[206:209], 0
    s_waitcnt lgkmcnt(2)
    v_add_u32 v183, s3, v183
    v_lshl_add_u32 v184, v181, 3, v172
    v_mfma_f32_16x16x32_bf16 v[130:133], v[32:35], v[218:221], v[130:133]
    s_waitcnt lgkmcnt(1)
    v_fmac_f32 v254, v222, v222
    v_fmac_f32 v254, v223, v223
    v_fmac_f32 v254, v224, v224
    v_mfma_f32_16x16x32_bf16 v[162:165], a[216:219], v[146:149], 0
    v_fmac_f32 v254, v225, v225
    v_cvt_pk_bf16_f32 v180, v254, v254
    v_cvt_pk_bf16_f32 v181, v254, v254
    v_mfma_f32_16x16x32_bf16 v[162:165], a[220:223], v[186:189], v[162:165]
    s_waitcnt lgkmcnt(0)
    ds_write_b64 v4, v[180:181] offset:2048
    v_mfma_f32_16x16x32_bf16 v[162:165], a[224:227], v[202:205], v[162:165]
    v_add_u32 v184, s4, v184
    v_add_u32 v166, 16, v166
    v_mul_u32_u24 v172, s20, v166
    v_mfma_f32_16x16x32_bf16 v[162:165], a[228:231], v[150:153], v[162:165]
    v_add_u32 v172, s38, v172
    v_mul_u32_u24 v172, 911, v172
    v_lshrrev_b32 v172, 16, v172
    v_mfma_f32_16x16x32_bf16 v[162:165], a[232:235], v[226:229], v[162:165]
    v_mul_u32_u24 v172, s22, v172
    v_mad_u32_u24 v172, v166, s21, v172
    v_cmp_gt_u32 vcc, s17, v166
    v_mfma_f32_16x16x32_bf16 v[162:165], a[236:239], v[154:157], v[162:165]
    v_add_u32 v172, s7, v172
    v_cndmask_b32 v172, v169, v172, vcc
    v_lshl_add_u32 v185, v255, 4, v172
    v_mfma_f32_16x16x32_bf16 v[190:193], a[240:243], v[146:149], 0
    v_add_u32 v185, s3, v185
    v_lshl_add_u32 v254, v255, 3, v172
    v_add_u32 v254, s4, v254
    v_mfma_f32_16x16x32_bf16 v[190:193], a[244:247], v[186:189], v[190:193]
    buffer_store_dwordx2 v[178:179], v19, s[12:15], s27 offen nt
    v_fma_f32 v172, v162, v162, s33
    v_mfma_f32_16x16x32_bf16 v[190:193], a[248:251], v[202:205], v[190:193]
    ds_read_b128 v[198:201], v167 offset:256
    v_fmac_f32 v172, v163, v163
    v_fmac_f32 v172, v164, v164
    v_mfma_f32_16x16x32_bf16 v[190:193], a[252:255], v[150:153], v[190:193]
    ds_read_b128 v[178:181], v167 offset:2304
    v_fmac_f32 v172, v165, v165
    v_mul_f32 v255, 0x3baaaaab, v130
    v_mfma_f32_16x16x32_bf16 v[190:193], v[82:85], v[226:229], v[190:193]
    ds_read_b128 v[206:209], v167 offset:4352
    v_mul_f32 v166, 0x3baaaaab, v131
    v_rsq_f32 v255, v255
    v_mfma_f32_16x16x32_bf16 v[190:193], v[86:89], v[154:157], v[190:193]
    ds_read_b128 v[130:133], v167 offset:6400
    v_mul_f32 v118, v255, v118
    v_mul_f32 v119, v255, v119
    v_mfma_f32_16x16x32_bf16 v[218:221], v[90:93], v[146:149], 0
    ds_read_b128 v[146:149], v167 offset:8448
    v_cvt_pk_bf16_f32 v118, v118, v119
    v_mul_f32 v120, v255, v120
    v_mfma_f32_16x16x32_bf16 v[218:221], v[94:97], v[186:189], v[218:221]
    ds_read_b128 v[186:189], v167 offset:10496
    v_fmac_f32 v172, v190, v190
    v_fmac_f32 v172, v191, v191
    v_mfma_f32_16x16x32_bf16 v[218:221], v[98:101], v[202:205], v[218:221]
    s_waitcnt lgkmcnt(5)
    v_fmac_f32 v172, v192, v192
    v_fmac_f32 v172, v193, v193
    v_mul_f32 v121, v255, v121
    v_mfma_f32_16x16x32_bf16 v[218:221], v[102:105], v[150:153], v[218:221]
    s_waitcnt lgkmcnt(4)
    v_cvt_pk_bf16_f32 v119, v120, v121
    v_mul_f32 v194, v255, v194
    v_mul_f32 v195, v255, v195
    v_mfma_f32_16x16x32_bf16 v[218:221], v[106:109], v[226:229], v[218:221]
    s_waitcnt lgkmcnt(3)
    v_cvt_pk_bf16_f32 v120, v194, v195
    v_mul_f32 v196, v255, v196
    v_mul_f32 v197, v255, v197
    v_mfma_f32_16x16x32_bf16 v[218:221], v[110:113], v[154:157], v[218:221]
    s_waitcnt lgkmcnt(2)
    v_cvt_pk_bf16_f32 v121, v196, v197
    v_mul_f32 v210, v255, v210
    v_mul_f32 v211, v255, v211
    v_mfma_f32_16x16x32_bf16 v[150:153], a[216:219], v[198:201], 0
    s_waitcnt lgkmcnt(1)
    ds_write_b128 v114, v[118:121] offset:4608
    v_mfma_f32_16x16x32_bf16 v[150:153], a[220:223], v[178:181], v[150:153]
    s_waitcnt lgkmcnt(1)
    v_fmac_f32 v172, v218, v218
    v_fmac_f32 v172, v219, v219
    v_fmac_f32 v172, v220, v220
    v_mfma_f32_16x16x32_bf16 v[150:153], a[224:227], v[206:209], v[150:153]
    buffer_store_dwordx4 v[126:129], v177, s[12:15], s27 offen nt
    ds_read_b128 v[118:121], v116 offset:4608
    v_fmac_f32 v172, v221, v221
    v_cvt_pk_bf16_f32 v126, v172, v172
    v_mfma_f32_16x16x32_bf16 v[150:153], a[228:231], v[130:133], v[150:153]
    v_cvt_pk_bf16_f32 v127, v172, v172
    v_cvt_pk_bf16_f32 v210, v210, v211
    v_mul_f32 v212, v255, v212
    v_mfma_f32_16x16x32_bf16 v[150:153], a[232:235], v[146:149], v[150:153]
    ds_write_b64 v4, v[126:127] offset:4096
    v_mfma_f32_16x16x32_bf16 v[150:153], a[236:239], v[186:189], v[150:153]
    v_mul_f32 v213, v255, v213
    v_cvt_pk_bf16_f32 v211, v212, v213
    v_rsq_f32 v166, v166
    v_mfma_f32_16x16x32_bf16 v[126:129], a[240:243], v[198:201], 0
    buffer_store_dwordx2 v[170:171], v182, s[12:15], s27 offen nt
    v_mul_f32 v134, v166, v134
    v_mfma_f32_16x16x32_bf16 v[126:129], a[244:247], v[178:181], v[126:129]
    s_mov_b32 s14, s36
    ds_write_b64 v115, v[210:211] offset:5632
    v_mfma_f32_16x16x32_bf16 v[126:129], a[248:251], v[206:209], v[126:129]
    s_waitcnt lgkmcnt(2)
    v_fma_f32 v255, v150, v150, s33
    v_fmac_f32 v255, v151, v151
    v_fmac_f32 v255, v152, v152
    v_mfma_f32_16x16x32_bf16 v[126:129], a[252:255], v[130:133], v[126:129]
    ds_read_b64 v[170:171], v117 offset:5632
    v_fmac_f32 v255, v153, v153
    v_mul_f32 v135, v166, v135
    v_mfma_f32_16x16x32_bf16 v[126:129], v[82:85], v[146:149], v[126:129]
    s_waitcnt lgkmcnt(2)
    buffer_store_dwordx4 v[118:121], v173, s[12:15], s26 offen nt
    v_cvt_pk_bf16_f32 v134, v134, v135
    v_mul_f32 v136, v166, v136
    v_mul_f32 v137, v166, v137
    v_mfma_f32_16x16x32_bf16 v[126:129], v[86:89], v[186:189], v[126:129]
    s_barrier
    ds_read_b128 v[118:121], v168 offset:2048
    ds_read_b128 v[154:157], v168 offset:3072
    v_cvt_pk_bf16_f32 v135, v136, v137
    v_mfma_f32_16x16x32_bf16 v[194:197], v[90:93], v[198:201], 0
    ds_read_b128 v[198:201], v168 offset:4096
    ds_read_b128 v[202:205], v168 offset:5120
    v_mul_f32 v142, v166, v142
    v_mfma_f32_16x16x32_bf16 v[194:197], v[94:97], v[178:181], v[194:197]
    v_fmac_f32 v255, v126, v126
    v_fmac_f32 v255, v127, v127
    v_fmac_f32 v255, v128, v128
    v_mfma_f32_16x16x32_bf16 v[194:197], v[98:101], v[206:209], v[194:197]
    v_fmac_f32 v255, v129, v129
    v_mul_f32 v143, v166, v143
    v_cvt_pk_bf16_f32 v136, v142, v143
    v_mfma_f32_16x16x32_bf16 v[194:197], v[102:105], v[130:133], v[194:197]
    s_waitcnt lgkmcnt(4)
    buffer_store_dwordx2 v[170:171], v174, s[12:15], s26 offen nt
    v_mul_f32 v144, v166, v144
    v_mfma_f32_16x16x32_bf16 v[194:197], v[106:109], v[146:149], v[194:197]
    v_mul_f32 v145, v166, v145
    v_cvt_pk_bf16_f32 v137, v144, v145
    v_mul_f32 v214, v166, v214
    v_mfma_f32_16x16x32_bf16 v[194:197], v[110:113], v[186:189], v[194:197]
    s_waitcnt lgkmcnt(2)
    ds_write_b128 v114, v[134:137] offset:6144
    v_mfma_f32_16x16x32_bf16 v[130:133], v[32:35], v[118:121], 0
    s_waitcnt lgkmcnt(1)
    v_mul_f32 v215, v166, v215
    v_cvt_pk_bf16_f32 v214, v214, v215
    v_mfma_f32_16x16x32_bf16 v[130:133], v[32:35], v[154:157], v[130:133]
    v_mul_f32 v216, v166, v216
    v_fmac_f32 v255, v194, v194
    v_mfma_f32_16x16x32_bf16 v[118:121], v[32:35], v[198:201], 0
    ds_read_b128 v[134:137], v116 offset:6144
    v_fmac_f32 v255, v195, v195
    v_mfma_f32_16x16x32_bf16 v[118:121], v[32:35], v[202:205], v[118:121]
    v_fmac_f32 v255, v196, v196
    v_fmac_f32 v255, v197, v197
    v_cvt_pk_bf16_f32 v132, v255, v255
    v_cvt_pk_bf16_f32 v133, v255, v255
    ds_write_b64 v4, v[132:133] offset:6144
    v_mul_f32 v217, v166, v217
    v_cvt_pk_bf16_f32 v215, v216, v217
    v_mul_f32 v255, 0x3baaaaab, v130
    ds_write_b64 v115, v[214:215] offset:7168
    v_rsq_f32 v255, v255
    v_mul_f32 v174, 0x3baaaaab, v118
    ds_read_b64 v[166:167], v117 offset:7168
    v_mul_f32 v122, v255, v122
    s_waitcnt lgkmcnt(3)
    buffer_store_dwordx4 v[134:137], v175, s[12:15], s26 offen nt
    v_mul_f32 v123, v255, v123
    v_cvt_pk_bf16_f32 v118, v122, v123
    v_mul_f32 v124, v255, v124
    v_mul_f32 v125, v255, v125
    v_cvt_pk_bf16_f32 v119, v124, v125
    v_mul_f32 v138, v255, v138
    s_waitcnt lgkmcnt(2)
    s_barrier
    ds_read_b128 v[122:125], v168 offset:6144
    ds_read_b128 v[130:133], v168 offset:7168
    v_mul_f32 v139, v255, v139
    v_cvt_pk_bf16_f32 v120, v138, v139
    v_mul_f32 v140, v255, v140
    v_mul_f32 v141, v255, v141
    v_cvt_pk_bf16_f32 v121, v140, v141
    ds_write_b128 v114, v[118:121] offset:0
    s_waitcnt lgkmcnt(3)
    buffer_store_dwordx2 v[166:167], v176, s[12:15], s26 offen nt
    v_mul_f32 v222, v255, v222
    v_mul_f32 v223, v255, v223
    v_cvt_pk_bf16_f32 v222, v222, v223
    v_mul_f32 v224, v255, v224
    ds_read_b128 v[118:121], v116 offset:0
    v_mul_f32 v225, v255, v225
    v_cvt_pk_bf16_f32 v223, v224, v225
    ds_write_b64 v115, v[222:223] offset:1024
    s_waitcnt lgkmcnt(3)
    v_mfma_f32_16x16x32_bf16 v[134:137], v[32:35], v[122:125], 0
    v_rsq_f32 v174, v174
    v_mfma_f32_16x16x32_bf16 v[134:137], v[32:35], v[130:133], v[134:137]
    ds_read_b64 v[122:123], v117 offset:1024
    v_mul_f32 v162, v174, v162
    v_mul_f32 v163, v174, v163
    v_cvt_pk_bf16_f32 v130, v162, v163
    v_mul_f32 v164, v174, v164
    v_mul_f32 v165, v174, v165
    v_cvt_pk_bf16_f32 v131, v164, v165
    v_mul_f32 v190, v174, v190
    v_mul_f32 v191, v174, v191
    v_cvt_pk_bf16_f32 v132, v190, v191
    v_mul_f32 v192, v174, v192
    v_mul_f32 v193, v174, v193
    v_cvt_pk_bf16_f32 v133, v192, v193
    s_waitcnt lgkmcnt(2)
    buffer_store_dwordx4 v[118:121], v177, s[12:15], s26 offen nt
    ds_write_b128 v114, v[130:133] offset:1536
    v_mul_f32 v218, v174, v218
    v_mul_f32 v219, v174, v219
    v_cvt_pk_bf16_f32 v124, v218, v219
    v_mul_f32 v220, v174, v220
    v_mul_f32 v221, v174, v221
    v_cvt_pk_bf16_f32 v125, v220, v221
    s_waitcnt lgkmcnt(1)
    ds_read_b128 v[118:121], v116 offset:1536
    ds_write_b64 v115, v[124:125] offset:2560
    buffer_store_dwordx2 v[122:123], v182, s[12:15], s26 offen nt
    v_mul_f32 v255, 0x3baaaaab, v134
    ds_read_b64 v[124:125], v117 offset:2560
    v_rsq_f32 v255, v255
    v_or3_b32 v158, v158, v159, v160
    v_mul_f32 v150, v255, v150
    v_mul_f32 v151, v255, v151
    v_cvt_pk_bf16_f32 v114, v150, v151
    v_mul_f32 v152, v255, v152
    v_mul_f32 v153, v255, v153
    v_cvt_pk_bf16_f32 v115, v152, v153
    v_mul_f32 v126, v255, v126
    v_mul_f32 v127, v255, v127
    v_cvt_pk_bf16_f32 v116, v126, v127
    v_mul_f32 v128, v255, v128
    v_mul_f32 v129, v255, v129
    v_cvt_pk_bf16_f32 v117, v128, v129
    buffer_store_dwordx4 v[114:117], v185, s[12:15], 0 offen nt
    s_waitcnt lgkmcnt(2)
    v_mul_f32 v194, v255, v194
    v_mul_f32 v195, v255, v195
    v_cvt_pk_bf16_f32 v122, v194, v195
    v_mul_f32 v196, v255, v196
    v_mul_f32 v197, v255, v197
    v_cvt_pk_bf16_f32 v123, v196, v197
    v_or_b32 v158, v158, v161
    v_cmp_gt_i32 s[46:47], 0, v158
    s_waitcnt lgkmcnt(0)
    buffer_store_dwordx4 v[118:121], v183, s[12:15], 0 offen nt
    buffer_store_dwordx2 v[124:125], v184, s[12:15], 0 offen nt
    buffer_store_dwordx2 v[122:123], v254, s[12:15], 0 offen nt
    s_branch L_end
.section .rodata,"a"
.p2align 6
.amdhsa_kernel standalone__window_attn_swin_v2__vision_kernel
  .amdhsa_next_free_vgpr 512
  .amdhsa_next_free_sgpr 102
  .amdhsa_accum_offset 256
  .amdhsa_group_segment_fixed_size 0
  .amdhsa_kernarg_size 96
  .amdhsa_user_sgpr_count 2
  .amdhsa_user_sgpr_kernarg_segment_ptr 1
  .amdhsa_system_sgpr_workgroup_id_x 1
  .amdhsa_float_denorm_mode_32 3
.end_amdhsa_kernel
```

```asm
; @launch grid=(256,1,1) block=(256,1,1) lds=163840
.amdgcn_target "amdgcn-amd-amdhsa--gfx950"
.text
.globl standalone__window_attn_swin_v2__vision_kernel
.p2align 12
.p2align 8
.type standalone__window_attn_swin_v2__vision_kernel,@function
standalone__window_attn_swin_v2__vision_kernel:
    s_mov_b32 s44, 0
L_again:
    s_load_dwordx16 s[76:91], s[0:1], 0
    v_readfirstlane_b32 s16, v0
    s_cmp_ge_u32 s2, 256
    s_cbranch_scc1 L_done
    s_lshr_b32 s16, s16, 6
    s_cbranch_scc1 L_nopf
    s_getpc_b64 s[96:97]
    s_bfe_u32 s3, s2, 0x30003
    s_mul_i32 s3, s3, 42
    v_cmp_gt_u32 vcc, 22, v0
    v_add_u32 v190, s3, v0
    v_mov_b32 v191, 0
    v_cndmask_b32 v190, v190, v0, vcc
    v_lshlrev_b32 v190, 7, v190
    v_lshl_add_u64 v[190:191], s[96:97], 0, v[190:191]
    global_load_dword a255, v[190:191], off offset:992
L_nopf:
    s_max_u32 s3, s2, s44
    s_cmp_ge_u32 s3, 247
    s_cbranch_scc1 L_edge
    v_mov_b32 v190, v0
    v_mov_b32 v191, 0x40000000
    v_and_b32 v254, 63, v0
    s_bfe_u32 s3, s2, 0x50003
    s_lshl_b32 s4, s16, 3
    s_lshr_b32 s98, 0x06143a01, s4
    s_and_b32 s98, s98, 0xff
    s_mul_i32 s3, s3, s98
    s_sub_u32 s98, s98, 1
    s_lshr_b32 s4, 0x0048d800, s4
    s_and_b32 s4, s4, 0xff
    s_lshl_b32 s4, s4, 3
    s_max_u32 s4, s4, 6
    s_sub_u32 s4, s4, s98
    s_sub_u32 s4, s4, 1
    s_min_u32 s3, s3, s4
    v_min_u32 v114, s98, v254
    v_add_lshl_u32 v114, v114, s3, 7
    v_mov_b32 v115, 0
    v_lshrrev_b32 v255, 4, v254
    v_and_b32 v116, 15, v254
    s_mov_b32 s10, 100270464
    s_mov_b32 s11, 0x00020000
    s_mov_b32 s50, 221184
    s_mov_b32 s51, 0x00020000
    v_mul_u32_u24 v117, 171, v254
    v_lshrrev_b32 v117, 10, v117
    v_lshrrev_b32 v122, 1, v117
    v_xor_b32 v122, v122, v117
    v_and_b32 v122, 4, v122
    v_mul_u32_u24 v122, 3, v122
    v_xor_b32 v122, v122, v117
    v_mul_u32_u24 v122, 1152, v122
    v_mul_u32_u24 v123, 96, v117
    v_sub_u32 v122, v122, v123
    v_lshl_add_u32 v123, v254, 4, v122
    v_add_u32 v122, 64, v254
    v_mul_u32_u24 v122, 171, v122
    v_lshrrev_b32 v122, 10, v122
    v_lshrrev_b32 v124, 1, v122
    v_xor_b32 v124, v124, v122
    v_and_b32 v124, 4, v124
    v_mul_u32_u24 v124, 3, v124
    v_xor_b32 v124, v124, v122
    v_mul_u32_u24 v124, 1152, v124
    v_mul_u32_u24 v125, 96, v122
    v_sub_u32 v124, v124, v125
    v_lshl_add_u32 v125, v254, 4, v124
    v_add_u32 v124, 128, v254
    v_mul_u32_u24 v124, 171, v124
    v_lshrrev_b32 v124, 10, v124
    v_lshrrev_b32 v126, 1, v124
    v_xor_b32 v126, v126, v124
    v_and_b32 v126, 4, v126
    v_mul_u32_u24 v126, 3, v126
    v_xor_b32 v126, v126, v124
    v_mul_u32_u24 v126, 1152, v126
    v_mul_u32_u24 v127, 96, v124
    v_sub_u32 v126, v126, v127
    v_lshl_add_u32 v127, v254, 4, v126
    s_mul_i32 s68, s16, 6144
    s_add_u32 s69, s68, 65536
    s_cmp_eq_u32 s16, 3
    s_cselect_b32 s68, 136704, s68
    s_cselect_b32 s69, 142848, s69
    s_mul_i32 s45, s16, 96
    s_waitcnt lgkmcnt(0)
    s_cmp_eq_u32 s16, 2
    s_cselect_b64 s[98:99], s[80:81], s[78:79]
    s_cmp_eq_u32 s16, 3
    s_cselect_b64 s[98:99], s[88:89], s[98:99]
    s_mov_b64 s[8:9], s[76:77]
    v_lshl_add_u64 v[114:115], s[98:99], 0, v[114:115]
    s_cmp_eq_u32 s16, 2
    s_cselect_b64 s[98:99], s[84:85], s[82:83]
    s_cmp_eq_u32 s16, 3
    s_cselect_b64 s[98:99], s[86:87], s[98:99]
    v_writelane_b32 v114, s98, 63
    v_writelane_b32 v115, s99, 63
    s_cmp_eq_u32 s16, 0
    s_cbranch_scc1 L_nowu
    global_load_dword a254, v[114:115], off
L_nowu:
    s_mov_b64 s[48:49], s[78:79]
    s_mov_b64 s[52:53], s[80:81]
    s_mov_b64 s[60:61], s[84:85]
    s_mov_b64 s[64:65], s[86:87]
    s_mov_b64 s[56:57], s[88:89]
    s_mov_b64 s[46:47], s[82:83]
    s_load_dwordx2 s[42:43], s[0:1], 72
    s_add_u32 m0, s68, 0
    s_add_u32 s4, s45, 384
    buffer_load_dwordx4 v123, s[48:51], s4 offen lds
    v_add_u32 v114, s16, v254
    v_and_b32 v114, 3, v114
    s_mov_b32 s54, 73728
    s_mov_b32 s55, 0x00020000
    buffer_load_dwordx4 v125, s[48:51], s4 offen offset:1024 lds
    v_lshlrev_b32 v114, 1, v114
    s_mov_b32 s62, 64
    s_mov_b32 s63, 0x00020000
    s_mov_b32 s66, 128
    buffer_load_dwordx4 v127, s[48:51], s4 offen offset:2048 lds
    s_add_u32 m0, s68, 3072
    s_add_u32 s4, s45, 37248
    s_mov_b32 s67, 0x00020000
    s_mov_b32 s58, 676
    global_load_ushort v114, v114, s[46:47]
    s_mov_b32 s59, 0x00020000
    s_mov_b32 s14, 0
    s_mov_b32 s15, 0x00020000
    buffer_load_dwordx4 v123, s[48:51], s4 offen lds
    v_mov_b32 v193, 0
    v_cmp_lt_u32 s[92:93], 7, v116
    s_mul_i32 s71, s16, 192
    s_mul_i32 s72, s16, 8064
    buffer_load_dwordx4 v125, s[48:51], s4 offen offset:1024 lds
    v_mov_b32 v115, 0
    v_mov_b32 v129, 0
    s_add_u32 s72, s72, 104448
    s_mul_i32 s73, s16, 6528
    buffer_load_dwordx4 v127, s[48:51], s4 offen offset:2048 lds
    s_add_u32 m0, s69, 0
    s_add_u32 s4, s45, 74112
    s_add_u32 s73, s73, 38912
    s_mov_b32 s70, 193536
    buffer_load_dwordx4 v123, s[48:51], s4 offen lds
    v_mov_b32 v119, 0
    v_lshlrev_b32 v126, 1, v254
    v_mul_u32_u24 v128, 12, v116
    v_add_u32 v128, s71, v128
    v_lshlrev_b32 v118, 5, v255
    s_mov_b32 s36, 100270464
    s_mov_b32 s22, 1180032
    s_mul_i32 s3, s2, 911
    s_lshr_b32 s3, s3, 16
    s_mul_i32 s35, s3, 72
    s_sub_u32 s38, s2, s35
    s_mul_i32 s3, s3, 1373568
    s_mul_i32 s35, s38, 2688
    s_add_u32 s3, s3, s35
    s_add_u32 s25, s3, 589824
    s_add_u32 s7, s3, 1769472
    s_mov_b32 s20, 31
    s_mov_b32 s21, 4204032
    s_cmp_lt_u32 s2, 244
    s_cselect_b32 s17, 21, 20
    v_mul_u32_u24 v192, 2731, v190
    v_bfe_u32 v120, v192, 17, 3
    v_lshrrev_b32 v192, 16, v192
    v_xor_b32 v121, v120, v190
    v_mul_u32_u24 v120, 37, v192
    v_lshrrev_b32 v120, 8, v120
    v_lshlrev_b32 v121, 4, v121
    v_mad_u32_u24 v10, v120, s70, v121
    v_mul_u32_u24 v120, s20, v192
    v_add_u32 v120, s38, v120
    v_mul_u32_u24 v120, 911, v120
    v_lshrrev_b32 v120, 16, v120
    v_mul_u32_u24 v120, s22, v120
    v_mad_u32_u24 v120, v192, s21, v120
    v_cmp_gt_u32 vcc, s17, v192
    v_add_u32 v120, s7, v120
    v_mul_u32_u24 v192, 384, v192
    v_cndmask_b32 v120, v191, v120, vcc
    v_sub_u32 v192, v121, v192
    v_add_u32 v120, v120, v192
    v_add_u32 v121, 256, v190
    v_mul_u32_u24 v192, 2731, v121
    v_bfe_u32 v130, v192, 17, 3
    v_lshrrev_b32 v192, 16, v192
    v_xor_b32 v121, v130, v121
    v_mul_u32_u24 v130, 37, v192
    v_lshrrev_b32 v130, 8, v130
    v_lshlrev_b32 v121, 4, v121
    v_mad_u32_u24 v11, v130, s70, v121
    v_mul_u32_u24 v130, s20, v192
    v_add_u32 v130, s38, v130
    v_mul_u32_u24 v130, 911, v130
    v_lshrrev_b32 v130, 16, v130
    v_mul_u32_u24 v130, s22, v130
    v_mad_u32_u24 v130, v192, s21, v130
    v_cmp_gt_u32 vcc, s17, v192
    v_add_u32 v130, s7, v130
    v_mul_u32_u24 v192, 384, v192
    v_cndmask_b32 v130, v191, v130, vcc
    v_sub_u32 v192, v121, v192
    v_add_u32 v130, v130, v192
    s_lshl_b32 s28, s16, 10
    s_add_u32 s28, s28, 20480
    v_lshrrev_b32 v121, 2, v116
    v_and_b32 v131, 1, v121
    v_mul_u32_u24 v131, 0x020202, v131
    v_lshl_or_b32 v131, v131, 8, v131
    v_add_u32 v131, 0x05040100, v131
    v_and_b32 v132, 3, v116
    v_lshrrev_b32 v133, 1, v116
    v_xor_b32 v133, v133, v255
    v_mul_u32_u24 v192, 384, v116
    v_lshl_add_u32 v0, v133, 4, v192
    v_xor_b32 v1, 64, v0
    v_and_b32 v133, 2, v255
    v_add_u32 v133, v133, v255
    v_lshl_add_u32 v133, v133, 2, v121
    v_mul_u32_u24 v133, 96, v133
    v_lshl_add_u32 v133, v132, 3, v133
    v_add_u32 v162, s68, v133
    v_add_u32 v164, s69, v133
    v_add_u32 v163, s72, v133
    v_add_u32 v165, s73, v133
    v_mov_b32 v28, 0x3f803f80
    v_mov_b32 v29, 0x3f803f80
    v_mov_b32 v30, 0x3f803f80
    v_mov_b32 v31, 0x3f803f80
    v_mul_u32_u24 v133, 768, v255
    v_add_u32 v133, v128, v133
    v_add_u32 v133, 157184, v133
    s_mov_b32 s76, 0x3f80
    v_and_b32 v134, 1, v116
    v_lshlrev_b32 v134, 4, v134
    v_lshlrev_b32 v135, v134, s76
    v_mov_b32 v136, 0x3c003c00
    v_mov_b32 v44, 1.0
    v_mov_b32 v45, 1.0
    v_lshlrev_b32 v137, 4, v255
    s_mov_b32 s19, s38
    s_mov_b32 s23, s25
    s_mov_b32 s26, 0
    s_mov_b32 s27, 0
    s_mov_b32 s18, 0
    s_add_u32 s19, s19, s20
    s_add_u32 s23, s23, s21
    s_cmp_ge_u32 s19, 72
    s_cselect_b32 s34, 72, 0
    s_cselect_b32 s35, s22, 0
    s_sub_u32 s19, s19, s34
    s_add_u32 s23, s23, s35
    s_mov_b32 s24, s23
    s_add_u32 s19, s19, s20
    s_add_u32 s23, s23, s21
    s_cmp_ge_u32 s19, 72
    s_cselect_b32 s34, 72, 0
    s_cselect_b32 s35, s22, 0
    s_sub_u32 s19, s19, s34
    s_add_u32 s23, s23, s35
    s_mul_i32 s79, s16, 64
    v_lshl_add_u32 v192, v255, 4, s79
    s_mul_i32 s80, s16, 32
    s_add_u32 s80, s80, 256
    v_lshl_add_u32 v138, v255, 3, s80
    v_add_u32 v139, 0, v116
    v_mul_u32_u24 v140, 37, v139
    v_mul_u32_u24 v141, 384, v139
    v_lshrrev_b32 v140, 8, v140
    v_mad_u32_u24 v141, v140, s70, v141
    v_add_u32 v15, v141, v192
    v_add_u32 v18, v141, v138
    v_add_u32 v141, 16, v116
    v_mul_u32_u24 v142, 37, v141
    v_mul_u32_u24 v143, 384, v141
    v_lshrrev_b32 v142, 8, v142
    v_mad_u32_u24 v143, v142, s70, v143
    v_add_u32 v16, v143, v192
    v_add_u32 v19, v143, v138
    v_add_u32 v143, 32, v116
    v_mul_u32_u24 v144, 37, v143
    v_mul_u32_u24 v145, 384, v143
    v_lshrrev_b32 v144, 8, v144
    v_mad_u32_u24 v145, v144, s70, v145
    v_add_u32 v17, v145, v192
    v_add_u32 v20, v145, v138
    s_mul_i32 s81, s16, 768
    s_add_u32 s81, s81, 157184
    v_mul_u32_u24 v145, 24, v140
    v_lshl_add_u32 v145, v139, 2, v145
    v_add_u32 v22, s81, v145
    v_sub_u32 v23, s81, v145
    v_sub_u32 v192, v22, v137
    v_mul_u32_u24 v142, 24, v142
    v_lshl_add_u32 v142, v141, 2, v142
    v_add_u32 v24, s81, v142
    v_sub_u32 v25, s81, v142
    v_sub_u32 v142, v24, v137
    v_mul_u32_u24 v144, 24, v144
    v_lshl_add_u32 v144, v143, 2, v144
    v_add_u32 v26, s81, v144
    v_sub_u32 v27, s81, v144
    v_sub_u32 v143, v26, v137
    v_mul_u32_u24 v144, 148, v255
    s_mov_b32 s82, -24
    v_add_u32 v145, 0, v144
    v_lshrrev_b32 v145, 8, v145
    v_mad_i32_i24 v46, v145, s82, v192
    v_mad_i32_i24 v58, v145, s82, v142
    v_mad_i32_i24 v70, v145, s82, v143
    v_add_u32 v145, 37, v144
    v_lshrrev_b32 v145, 8, v145
    v_mad_i32_i24 v47, v145, s82, v192
    v_mad_i32_i24 v59, v145, s82, v142
    v_mad_i32_i24 v71, v145, s82, v143
    v_add_u32 v145, 74, v144
    v_lshrrev_b32 v145, 8, v145
    v_mad_i32_i24 v48, v145, s82, v192
    v_mad_i32_i24 v60, v145, s82, v142
    v_mad_i32_i24 v72, v145, s82, v143
    v_add_u32 v145, 111, v144
    v_lshrrev_b32 v145, 8, v145
    v_mad_i32_i24 v49, v145, s82, v192
    v_mad_i32_i24 v61, v145, s82, v142
    v_mad_i32_i24 v73, v145, s82, v143
    v_add_u32 v145, 592, v144
    v_lshrrev_b32 v145, 8, v145
    v_mad_i32_i24 v50, v145, s82, v192
    v_mad_i32_i24 v62, v145, s82, v142
    v_mad_i32_i24 v74, v145, s82, v143
    v_add_u32 v145, 629, v144
    v_lshrrev_b32 v145, 8, v145
    v_mad_i32_i24 v51, v145, s82, v192
    v_mad_i32_i24 v63, v145, s82, v142
    v_mad_i32_i24 v75, v145, s82, v143
    v_add_u32 v145, 666, v144
    v_lshrrev_b32 v145, 8, v145
    v_mad_i32_i24 v52, v145, s82, v192
    v_mad_i32_i24 v64, v145, s82, v142
    v_mad_i32_i24 v76, v145, s82, v143
    v_add_u32 v145, 703, v144
    v_lshrrev_b32 v145, 8, v145
    v_mad_i32_i24 v53, v145, s82, v192
    v_mad_i32_i24 v65, v145, s82, v142
    v_mad_i32_i24 v77, v145, s82, v143
    v_add_u32 v145, 1184, v144
    v_lshrrev_b32 v145, 8, v145
    v_mad_i32_i24 v54, v145, s82, v192
    v_mad_i32_i24 v66, v145, s82, v142
    v_mad_i32_i24 v78, v145, s82, v143
    v_add_u32 v145, 1221, v144
    v_lshrrev_b32 v145, 8, v145
    v_mad_i32_i24 v55, v145, s82, v192
    v_mad_i32_i24 v67, v145, s82, v142
    v_mad_i32_i24 v79, v145, s82, v143
    v_add_u32 v145, 1258, v144
    v_lshrrev_b32 v145, 8, v145
    v_mad_i32_i24 v56, v145, s82, v192
    v_mad_i32_i24 v68, v145, s82, v142
    v_mad_i32_i24 v80, v145, s82, v143
    v_add_u32 v144, 1295, v144
    v_lshrrev_b32 v144, 8, v144
    v_mad_i32_i24 v57, v144, s82, v192
    v_mad_i32_i24 v69, v144, s82, v142
    v_mad_i32_i24 v81, v144, s82, v143
    v_mov_b32 v138, s81
    v_lshlrev_b32 v192, 4, v254
    v_xor_b32 v2, 65536, v192
    v_lshl_add_u32 v3, s16, 10, v192
    s_lshr_b32 s83, s16, 1
    s_and_b32 s84, s16, 1
    s_lshl_b32 s84, s84, 3
    s_lshl_b32 s85, s83, 10
    s_add_u32 s85, s85, s84
    v_add_u32 v4, s85, v192
    s_lshl_b32 s83, s83, 11
    s_add_u32 s83, s83, s84
    s_add_u32 s83, s83, 144896
    s_mul_i32 s86, s16, 2048
    s_add_u32 s86, s86, 136704
    v_lshl_add_u32 v139, v255, 3, s86
    v_mov_b32 v140, s83
    v_mov_b32 v141, 161536
    v_mul_u32_u24 v192, 80, v255
    v_add3_u32 v5, v192, v134, s72
    v_lshl_add_u32 v6, v116, 2, s73
    s_mul_i32 s87, s16, 128
    s_add_u32 s87, s87, 65024
    v_add_u32 v9, s87, v137
    v_lshrrev_b32 v142, 1, v255
    v_mul_u32_u24 v142, 48, v142
    v_lshl_add_u32 v142, v255, 3, v142
    v_lshl_add_u32 v142, v121, 4, v142
    v_lshl_add_u32 v142, v132, 1, v142
    v_add_u32 v8, s87, v142
    v_mov_b32 v37, 0
    v_mov_b32 v38, 0
    v_mov_b32 v39, 0
    s_mov_b32 s40, s8
    s_mov_b32 s41, s9
    s_mov_b32 s32, 0x2a8cbccc
    s_mov_b32 s33, 0x38fba882
    v_add_u32 v194, 148992, v0
    v_add_u32 v142, 148992, v1
    v_lshlrev_b32 v143, 4, v116
    v_add_u32 v143, 160256, v143
    v_mul_u32_u24 v144, 336, v116
    v_add3_u32 v144, v144, v192, s72
    v_mul_u32_u24 v145, 272, v116
    v_add3_u32 v145, v145, v137, s73
    v_mul_u32_u24 v146, 1088, v255
    v_add_u32 v146, v146, v6
    v_add_u32 v147, 5376, v144
    v_add_u32 v148, 4352, v145
    v_add_u32 v149, 4352, v146
    v_cmp_gt_u32 s[88:89], 16, v254
    v_mov_b32 v195, 0xf149f2ca
    v_add_u32 v196, 512, v190
    v_mul_u32_u24 v197, 2731, v196
    v_bfe_u32 v150, v197, 17, 3
    v_lshrrev_b32 v197, 16, v197
    s_add_u32 s75, s28, 16384
    s_cmp_lt_u32 s16, 2
    buffer_load_ushort v192, v126, s[60:63], 0 offen
    v_xor_b32 v196, v150, v196
    s_cselect_b32 s29, s75, 160256
    s_cselect_b32 s30, 65536, 0
    buffer_load_dwordx3 v[154:156], v128, s[56:59], 0 offen
    v_mul_u32_u24 v150, 37, v197
    s_xor_b32 s74, s29, s30
    s_mul_i32 s77, s16, 64
    buffer_load_dwordx4 v[158:161], v118, s[64:67], 0 offen
    v_lshrrev_b32 v150, 8, v150
    v_lshlrev_b32 v196, 4, v196
    v_mad_u32_u24 v12, v150, s70, v196
    v_add_u32 v157, 768, v190
    v_mul_u32_u24 v126, 2731, v157
    v_bfe_u32 v128, v126, 17, 3
    s_mul_i32 s78, s16, 32
    s_add_u32 s78, s78, 192
    buffer_load_dwordx4 v[150:153], v118, s[64:67], 0 offen offset:16
    v_lshrrev_b32 v126, 16, v126
    v_xor_b32 v157, v128, v157
    v_mul_u32_u24 v128, 37, v126
    v_lshrrev_b32 v128, 8, v128
    v_lshlrev_b32 v157, 4, v157
    v_mad_u32_u24 v13, v128, s70, v157
    v_add_u32 v118, 1024, v190
    v_mul_u32_u24 v157, 2731, v118
    v_bfe_u32 v190, v157, 17, 3
    v_lshrrev_b32 v157, 16, v157
    v_xor_b32 v118, v190, v118
    v_mul_u32_u24 v190, 37, v157
    v_lshrrev_b32 v190, 8, v190
    v_lshlrev_b32 v118, 4, v118
    s_add_u32 s34, s18, 2
    s_mov_b32 s18, 1
    s_waitcnt vmcnt(9)
    buffer_load_dwordx4 v125, s[48:51], s4 offen offset:1024 lds
    s_waitcnt vmcnt(9)
    ds_read_b64_tr_b16 a[72:73], v162 offset:0
    ds_read_b64_tr_b16 a[74:75], v162 offset:768
    ds_read_b64_tr_b16 a[96:97], v162 offset:32
    ds_read_b64_tr_b16 a[98:99], v162 offset:800
    ds_read_b64_tr_b16 a[120:121], v162 offset:64
    ds_read_b64_tr_b16 a[122:123], v162 offset:832
    v_lshlrev_b32 v114, 16, v114
    v_max_f32 v114, 0xc2c80000, v114
    v_min_f32 v114, 0x40930000, v114
    v_mul_f32 v114, 0x3fb8aa3b, v114
    v_exp_f32 v114, v114
    s_mov_b32 s27, s26
    s_mov_b32 s26, s25
    buffer_load_dwordx4 v127, s[48:51], s4 offen offset:2048 lds
    s_add_u32 m0, s69, 3072
    s_add_u32 s4, s45, 110976
    v_cvt_pk_bf16_f32 v114, v114, v114
    v_and_b32 v114, 0xffff0000, v114
    v_mul_f32 v126, 0x3fb8aa3b, v114
    v_readfirstlane_b32 s37, v114
    v_readfirstlane_b32 s31, v126
    v_mul_f32 v114, 0x3e000000, v114
    v_cmp_lt_f32 s[90:91], 4.0, v114
    v_mad_u32_u24 v14, v190, s70, v118
    v_cmp_gt_u32 vcc, 48, v157
    s_cmp_lg_u64 s[90:91], 0
    s_cbranch_scc1 L_slow
    s_add_u32 s19, s19, s20
    buffer_load_dwordx4 v123, s[48:51], s4 offen lds
    v_cndmask_b32 v14, v191, v14, vcc
    v_cmp_gt_u32 vcc, 2, v132
    v_mul_u32_u24 v118, 6, v117
    v_sub_u32 v157, v254, v118
    v_cndmask_b32 v32, 0, v135, vcc
    v_cndmask_b32 v33, v135, 0, vcc
    v_cndmask_b32 v34, 0, v135, vcc
    v_cndmask_b32 v35, v135, 0, vcc
    v_cmp_eq_u32 vcc, 0, v134
    v_mul_u32_u24 v118, 384, v117
    v_lshl_add_u32 v118, v157, 4, v118
    v_cndmask_b32 v40, 0, v136, vcc
    buffer_load_dwordx4 v125, s[48:51], s4 offen offset:1024 lds
    s_waitcnt vmcnt(9)
    ds_read_b64_tr_b16 a[76:77], v162 offset:3072
    ds_read_b64_tr_b16 a[78:79], v162 offset:3840
    ds_read_b64_tr_b16 a[100:101], v162 offset:3104
    ds_read_b64_tr_b16 a[102:103], v162 offset:3872
    ds_read_b64_tr_b16 a[124:125], v162 offset:3136
    ds_read_b64_tr_b16 a[126:127], v162 offset:3904
    v_cndmask_b32 v41, v136, 0, vcc
    v_cndmask_b32 v42, 0, v136, vcc
    v_cndmask_b32 v43, v136, 0, vcc
    v_cmp_eq_u32 vcc, v255, v121
    v_add_u32 v114, s78, v118
    buffer_load_dwordx4 v127, s[48:51], s4 offen offset:2048 lds
    s_add_u32 m0, s72, 0
    s_add_u32 s4, s45, 147840
    v_cndmask_b32 v190, 0, v32, vcc
    v_cndmask_b32 v191, 0, v33, vcc
    v_add_u32 v118, s77, v118
    v_cmp_gt_i32 vcc, 4, v157
    v_mul_u32_u24 v157, 6, v122
    v_sub_u32 v117, v254, v157
    v_cndmask_b32 v126, v114, v118, vcc
    v_mul_u32_u24 v157, 384, v122
    v_lshl_add_u32 v157, v117, 4, v157
    v_add_u32 v118, s78, v157
    buffer_load_dwordx4 v123, s[48:51], s4 offen lds
    v_add_u32 v157, s77, v157
    v_cmp_gt_i32 vcc, -60, v117
    v_mul_u32_u24 v122, 6, v124
    v_sub_u32 v128, v254, v122
    v_cndmask_b32 v254, v118, v157, vcc
    v_mul_u32_u24 v122, 384, v124
    v_lshl_add_u32 v122, v128, 4, v122
    v_add_u32 v124, s78, v122
    v_add_u32 v122, s77, v122
    v_cmp_gt_i32 vcc, -124, v128
    v_mul_u32_u24 v135, 96, v116
    s_waitcnt vmcnt(8)
    buffer_load_dwordx4 v125, s[48:51], s4 offen offset:1024 lds
    s_waitcnt vmcnt(8)
    v_cndmask_b32 v158, v158, v159, s[92:93]
    v_cndmask_b32 v160, v160, v161, s[92:93]
    v_perm_b32 v196, v160, v158, v131
    v_bfe_u32 v114, v154, v137, 16
    v_bfe_u32 v128, v155, v137, 16
    v_bfe_u32 v118, v156, v137, 16
    v_mfma_f32_16x16x16_bf16 v[154:157], v[192:193], v[114:115], 0
    s_waitcnt vmcnt(7)
    v_cndmask_b32 v150, v150, v151, s[92:93]
    v_cndmask_b32 v152, v152, v153, s[92:93]
    v_mfma_f32_16x16x16_bf16 v[158:161], v[192:193], v[128:129], 0
    v_perm_b32 v197, v152, v150, v131
    v_cndmask_b32 v128, v124, v122, vcc
    v_cmp_gt_u32 vcc, 2, v255
    v_mfma_f32_16x16x16_bf16 v[150:153], v[192:193], v[118:119], 0
    buffer_load_dwordx4 v127, s[48:51], s4 offen offset:2048 lds
    s_add_u32 m0, s72, 3072
    s_add_u32 s4, s45, 184704
    v_max_f32 v154, 0, v154
    v_max_f32 v155, 0, v155
    v_max_f32 v156, 0, v156
    v_max_f32 v157, 0, v157
    v_cvt_pk_bf16_f32 v118, v154, v155
    v_cvt_pk_bf16_f32 v119, v156, v157
    v_max_f32 v158, 0, v158
    v_max_f32 v159, 0, v159
    v_mfma_f32_16x16x16_bf16 v[154:157], v[196:197], v[118:119], 0
    v_max_f32 v160, 0, v160
    buffer_load_dwordx4 v123, s[48:51], s4 offen lds
    v_max_f32 v161, 0, v161
    v_cvt_pk_bf16_f32 v118, v158, v159
    v_cvt_pk_bf16_f32 v119, v160, v161
    v_max_f32 v150, 0, v150
    v_max_f32 v151, 0, v151
    v_mfma_f32_16x16x16_bf16 v[158:161], v[196:197], v[118:119], 0
    v_cvt_pk_bf16_f32 v154, v154, v154
    v_and_b32 v154, 0xffff0000, v154
    s_waitcnt vmcnt(7)
    ds_read_b64_tr_b16 a[80:81], v164 offset:0
    ds_read_b64_tr_b16 a[82:83], v164 offset:768
    ds_read_b64_tr_b16 a[104:105], v164 offset:32
    ds_read_b64_tr_b16 a[106:107], v164 offset:800
    buffer_load_dwordx4 v125, s[48:51], s4 offen offset:1024 lds
    ds_read_b64_tr_b16 a[128:129], v164 offset:64
    ds_read_b64_tr_b16 a[130:131], v164 offset:832
    v_mul_f32 v154, 0xbfb8aa3b, v154
    v_exp_f32 v154, v154
    v_cvt_pk_bf16_f32 v158, v158, v158
    v_add_f32 v154, 1.0, v154
    v_rcp_f32 v154, v154
    v_and_b32 v158, 0xffff0000, v158
    v_cvt_pk_bf16_f32 v154, v154, v154
    v_and_b32 v154, 0xffff0000, v154
    buffer_load_dwordx4 v127, s[48:51], s4 offen offset:2048 lds
    s_add_u32 m0, s73, 0
    s_add_u32 s4, s45, 36864
    v_add_f32 v154, -0.5, v154
    v_mul_f32 v154, 0x41b8aa3b, v154
    ds_write_b32 v133, v154 offset:0
    v_mul_f32 v158, 0xbfb8aa3b, v158
    v_exp_f32 v158, v158
    v_max_f32 v152, 0, v152
    buffer_load_dwordx4 v123, s[48:51], s45 offen lds
    v_add_f32 v158, 1.0, v158
    v_rcp_f32 v158, v158
    v_max_f32 v153, 0, v153
    v_cvt_pk_bf16_f32 v158, v158, v158
    v_and_b32 v158, 0xffff0000, v158
    v_add_f32 v158, -0.5, v158
    v_mul_f32 v158, 0x41b8aa3b, v158
    ds_write_b32 v133, v158 offset:4
    s_waitcnt vmcnt(7)
    buffer_load_dwordx4 v125, s[48:51], s45 offen offset:1024 lds
    ds_read_b64_tr_b16 a[84:85], v164 offset:3072
    ds_read_b64_tr_b16 a[86:87], v164 offset:3840
    ds_read_b64_tr_b16 a[108:109], v164 offset:3104
    ds_read_b64_tr_b16 a[110:111], v164 offset:3872
    ds_read_b64_tr_b16 a[132:133], v164 offset:3136
    ds_read_b64_tr_b16 a[134:135], v164 offset:3904
    v_cvt_pk_bf16_f32 v118, v150, v151
    v_cvt_pk_bf16_f32 v119, v152, v153
    v_cndmask_b32 v139, v140, v139, vcc
    v_lshl_add_u32 v139, v121, 9, v139
    v_mfma_f32_16x16x16_bf16 v[150:153], v[196:197], v[118:119], 0
    buffer_load_dwordx4 v127, s[48:51], s45 offen offset:2048 lds
    s_add_u32 m0, s73, 3072
    v_lshl_add_u32 v139, v132, 1, v139
    v_cmp_gt_u32 vcc, 3, v255
    v_add3_u32 v129, v135, v137, s68
    v_lshl_add_u32 v192, v255, 3, v135
    v_cndmask_b32 v7, v141, v139, vcc
    v_cmp_gt_u32 vcc, 8, v116
    v_cvt_pk_bf16_f32 v150, v150, v150
    v_and_b32 v150, 0xffff0000, v150
    v_mul_f32 v150, 0xbfb8aa3b, v150
    v_exp_f32 v150, v150
    buffer_load_dwordx4 v123, s[48:51], s4 offen lds
    v_add_f32 v150, 1.0, v150
    v_rcp_f32 v150, v150
    v_cndmask_b32 v147, v143, v147, vcc
    v_cvt_pk_bf16_f32 v150, v150, v150
    v_and_b32 v150, 0xffff0000, v150
    v_add_f32 v150, -0.5, v150
    v_mul_f32 v150, 0x41b8aa3b, v150
    ds_write_b32 v133, v150 offset:8
    buffer_load_dwordx4 v125, s[48:51], s4 offen offset:1024 lds
    s_waitcnt vmcnt(8)
    ds_read_b64_tr_b16 a[88:89], v163 offset:0
    ds_read_b64_tr_b16 a[90:91], v163 offset:768
    ds_read_b64_tr_b16 a[112:113], v163 offset:32
    ds_read_b64_tr_b16 a[114:115], v163 offset:800
    ds_read_b64_tr_b16 a[136:137], v163 offset:64
    ds_read_b64_tr_b16 a[138:139], v163 offset:832
    v_cndmask_b32 v148, v143, v148, vcc
    v_cmp_gt_u32 vcc, 2, v255
    v_add3_u32 v192, v192, 64, s68
    v_add3_u32 v193, v135, v137, s69
    buffer_load_dwordx4 v127, s[48:51], s4 offen offset:2048 lds
    s_add_u32 m0, s68, 0
    s_add_u32 s4, s45, 73728
    s_waitcnt lgkmcnt(7)
    v_cndmask_b32 v149, v143, v149, vcc
    v_lshl_add_u32 v122, v255, 3, v135
    v_add3_u32 v122, v122, 64, s69
    s_waitcnt lgkmcnt(6)
    s_barrier
    ds_read_b32 v22, v22 offset:0
    ds_read_b32 v23, v23 offset:672
    ds_read_b32 v24, v24 offset:0
    ds_read_b32 v25, v25 offset:672
    ds_read_b32 v26, v26 offset:0
    ds_read_b32 v27, v27 offset:672
    buffer_load_dwordx4 v123, s[48:51], s4 offen lds
    ds_read_b32 v46, v46 offset:336
    ds_read_b32 v58, v58 offset:336
    ds_read_b32 v70, v70 offset:336
    ds_read_b32 v47, v47 offset:332
    ds_read_b32 v59, v59 offset:332
    ds_read_b32 v71, v71 offset:332
    ds_read_b32 v48, v48 offset:328
    ds_read_b32 v60, v60 offset:328
    buffer_load_dwordx4 v125, s[48:51], s4 offen offset:1024 lds
    s_waitcnt vmcnt(8)
    ds_read_b64_tr_b16 a[92:93], v163 offset:3072
    ds_read_b64_tr_b16 a[94:95], v163 offset:3840
    ds_read_b64_tr_b16 a[116:117], v163 offset:3104
    s_waitcnt lgkmcnt(15)
    ds_read_b64_tr_b16 a[118:119], v163 offset:3872
    s_waitcnt lgkmcnt(15)
    ds_read_b64_tr_b16 a[140:141], v163 offset:3136
    s_waitcnt lgkmcnt(14)
    ds_read_b64_tr_b16 a[142:143], v163 offset:3904
    ds_read_b32 v72, v72 offset:328
    ds_read_b32 v49, v49 offset:324
    buffer_load_dwordx4 v127, s[48:51], s4 offen offset:2048 lds
    ds_read_b32 v61, v61 offset:324
    ds_read_b32 v73, v73 offset:324
    ds_read_b32 v50, v50 offset:272
    ds_read_b32 v62, v62 offset:272
    s_add_u32 m0, s28, 128512
    ds_read_b32 v74, v74 offset:272
    s_add_u32 s4, s45, 110592
    ds_read_b32 v51, v51 offset:268
    ds_read_b32 v63, v63 offset:268
    ds_read_b32 v75, v75 offset:268
    buffer_load_dwordx4 v120, s[8:11], 0 offen nt lds
    ds_read_b32 v52, v52 offset:264
    ds_read_b32 v64, v64 offset:264
    ds_read_b32 v76, v76 offset:264
    s_add_u32 m0, s28, 132608
    ds_read_b32 v53, v53 offset:260
    ds_read_b32 v65, v65 offset:260
    ds_read_b32 v77, v77 offset:260
    ds_read_b32 v54, v54 offset:208
    ds_read_b32 v66, v66 offset:208
    buffer_load_dwordx4 v130, s[8:11], 0 offen nt lds
    ds_read_b32 v78, v78 offset:208
    ds_read_b32 v55, v55 offset:204
    s_waitcnt vmcnt(8)
    ds_read_b64_tr_b16 a[0:1], v165 offset:0
    ds_read_b64_tr_b16 a[2:3], v165 offset:768
    s_add_u32 m0, s28, 0
    ds_read_b64_tr_b16 a[24:25], v165 offset:32
    ds_read_b64_tr_b16 a[26:27], v165 offset:800
    ds_read_b64_tr_b16 a[48:49], v165 offset:64
    ds_read_b64_tr_b16 a[50:51], v165 offset:832
    buffer_load_dwordx4 v10, s[8:11], s25 offen nt lds
    ds_read_b32 v67, v67 offset:204
    ds_read_b32 v79, v79 offset:204
    ds_read_b32 v56, v56 offset:200
    ds_read_b32 v68, v68 offset:200
    s_add_u32 m0, s28, 4096
    ds_read_b32 v80, v80 offset:200
    ds_read_b32 v57, v57 offset:196
    ds_read_b32 v69, v69 offset:196
    ds_read_b32 v81, v81 offset:196
    buffer_load_dwordx4 v11, s[8:11], s25 offen nt lds
    ds_read_b32 v138, v138 offset:336
    s_add_u32 m0, s68, 3072
    v_cndmask_b32 v22, v195, v22, s[88:89]
    v_cndmask_b32 v24, v195, v24, s[88:89]
    v_cndmask_b32 v26, v195, v26, s[88:89]
    v_add_u32 v124, 16, v116
    v_cmp_gt_u32 s[94:95], s17, v124
    v_cmp_ne_u32 s[96:97], 0, v134
    v_cmp_lt_u32 s[98:99], 1, v132
    v_cmp_eq_u32 vcc, v255, v121
    v_sub_u32 v255, v145, v137
    v_sub_u32 v124, v148, v137
    buffer_load_dwordx4 v123, s[48:51], s4 offen lds
    v_cndmask_b32 v255, v143, v255, vcc
    v_cndmask_b32 v124, v143, v124, vcc
    v_mov_b32 v114, 0
    v_mov_b32 v115, 0
    s_waitcnt vmcnt(8)
    ds_read_b64_tr_b16 a[4:5], v165 offset:3072
    ds_read_b64_tr_b16 a[6:7], v165 offset:3840
    ds_read_b64_tr_b16 a[28:29], v165 offset:3104
    ds_read_b64_tr_b16 a[30:31], v165 offset:3872
    ds_read_b64_tr_b16 a[52:53], v165 offset:3136
    ds_read_b64_tr_b16 a[54:55], v165 offset:3904
    s_waitcnt lgkmcnt(6)
    ds_write_b64 v144, v[114:115] offset:56
    buffer_load_dwordx4 v125, s[48:51], s4 offen offset:1024 lds
    v_readfirstlane_b32 s39, v138
    v_mov_b32 v116, 0
    v_mov_b32 v117, 0
    ds_write_b128 v144, v[114:117] offset:16
    v_mov_b32 v118, v195
    v_mov_b32 v119, v195
    buffer_load_dwordx4 v127, s[48:51], s4 offen offset:2048 lds
    s_add_u32 m0, s69, 0
    s_add_u32 s4, s45, 147456
    ds_write_b64 v144, v[114:115] offset:64
    v_mov_b32 v120, v195
    v_mov_b32 v121, v195
    buffer_load_dwordx4 v123, s[48:51], s4 offen lds
    ds_write_b128 v147, v[114:117] offset:16
    s_waitcnt vmcnt(8)
    buffer_load_dwordx4 v125, s[48:51], s4 offen offset:1024 lds
    ds_read_b64_tr_b16 a[8:9], v162 offset:0
    ds_read_b64_tr_b16 a[10:11], v162 offset:768
    ds_read_b64_tr_b16 a[32:33], v162 offset:32
    ds_read_b64_tr_b16 a[34:35], v162 offset:800
    ds_read_b64_tr_b16 a[56:57], v162 offset:64
    ds_read_b64_tr_b16 a[58:59], v162 offset:832
    ds_write_b64 v147, v[114:115] offset:56
    buffer_load_dwordx4 v127, s[48:51], s4 offen offset:2048 lds
    ds_write_b64 v147, v[114:115] offset:64
    s_add_u32 m0, s69, 3072
    s_add_u32 s4, s45, 184320
    buffer_load_dwordx4 v123, s[48:51], s4 offen lds
    ds_write_b128 v145, v[118:121] offset:192
    buffer_load_dwordx4 v125, s[48:51], s4 offen offset:1024 lds
    ds_write_b128 v148, v[118:121] offset:192
    buffer_load_dwordx4 v127, s[48:51], s4 offen offset:2048 lds
    s_add_u32 m0, s68, 0
    s_add_u32 s4, s45, 768
    s_waitcnt lgkmcnt(1)
    buffer_load_dwordx4 v123, s[48:51], s4 offen lds
    s_waitcnt vmcnt(10)
    s_barrier
    ds_read_b128 v[114:117], v194 offset:6144
    ds_read_b128 v[118:121], v142 offset:6144
    ds_read_b128 v[130:133], v194 offset:6272
    ds_read_b128 v[134:137], v142 offset:6272
    ds_read_b128 v[138:141], v194 offset:6400
    ds_read_b128 v[150:153], v142 offset:6400
    buffer_load_dwordx4 v125, s[48:51], s4 offen offset:1024 lds
    ds_read_b128 v[154:157], v194 offset:0
    ds_read_b128 v[158:161], v142 offset:0
    ds_read_b128 v[166:169], v194 offset:128
    ds_read_b128 v[170:173], v142 offset:128
    s_waitcnt lgkmcnt(7)
    v_mfma_f32_16x16x32_bf16 v[174:177], a[72:75], v[114:117], 0
    buffer_load_dwordx4 v127, s[48:51], s4 offen offset:2048 lds
    v_mfma_f32_16x16x32_bf16 v[174:177], a[76:79], v[118:121], v[174:177]
    s_add_u32 m0, s68, 3072
    ds_read_b128 v[178:181], v194 offset:256
    ds_read_b128 v[182:185], v142 offset:256
    v_mfma_f32_16x16x32_bf16 v[174:177], a[80:83], v[130:133], v[174:177]
    s_waitcnt lgkmcnt(7)
    s_add_u32 s4, s45, 37632
    v_mfma_f32_16x16x32_bf16 v[174:177], a[84:87], v[134:137], v[174:177]
    s_waitcnt lgkmcnt(6)
    v_mfma_f32_16x16x32_bf16 v[174:177], a[88:91], v[138:141], v[174:177]
    s_waitcnt vmcnt(9)
    ds_read_b64_tr_b16 a[12:13], v162 offset:3072
    ds_read_b64_tr_b16 a[14:15], v162 offset:3840
    v_mfma_f32_16x16x32_bf16 v[174:177], a[92:95], v[150:153], v[174:177]
    s_waitcnt lgkmcnt(6)
    ds_read_b64_tr_b16 a[36:37], v162 offset:3104
    ds_read_b64_tr_b16 a[38:39], v162 offset:3872
    v_mfma_f32_16x16x32_bf16 v[186:189], a[96:99], v[114:117], 0
    s_waitcnt lgkmcnt(7)
    ds_read_b64_tr_b16 a[60:61], v162 offset:3136
    ds_read_b64_tr_b16 a[62:63], v162 offset:3904
    v_mfma_f32_16x16x32_bf16 v[186:189], a[100:103], v[118:121], v[186:189]
    s_waitcnt lgkmcnt(8)
    v_cvt_pk_f16_f32 v198, v174, v175
    v_pk_mul_f16 v143, v198, v198
    v_mfma_f32_16x16x32_bf16 v[186:189], a[104:107], v[130:133], v[186:189]
    v_cvt_pk_f16_f32 v199, v176, v177
    v_pk_mul_f16 v145, v199, v199
    v_mfma_f32_16x16x32_bf16 v[186:189], a[108:111], v[134:137], v[186:189]
    s_waitcnt lgkmcnt(6)
    v_mfma_f32_16x16x32_bf16 v[186:189], a[112:115], v[138:141], v[186:189]
    v_mfma_f32_16x16x32_bf16 v[186:189], a[116:119], v[150:153], v[186:189]
    v_mfma_f32_16x16x32_bf16 v[174:177], a[120:123], v[114:117], 0
    s_waitcnt lgkmcnt(4)
    v_mfma_f32_16x16x32_bf16 v[174:177], a[124:127], v[118:121], v[174:177]
    s_waitcnt lgkmcnt(2)
    v_mfma_f32_16x16x32_bf16 v[174:177], a[128:131], v[130:133], v[174:177]
    s_waitcnt lgkmcnt(0)
    buffer_load_dwordx4 v123, s[48:51], s4 offen lds
    v_mfma_f32_16x16x32_bf16 v[174:177], a[132:135], v[134:137], v[174:177]
    v_cvt_pk_f16_f32 v200, v186, v187
    v_pk_fma_f16 v143, v200, v200, v143
    v_mfma_f32_16x16x32_bf16 v[174:177], a[136:139], v[138:141], v[174:177]
    v_cvt_pk_f16_f32 v201, v188, v189
    s_waitcnt vmcnt(7)
    v_mfma_f32_16x16x32_bf16 v[174:177], a[140:143], v[150:153], v[174:177]
    ds_read_b64_tr_b16 a[16:17], v164 offset:0
    ds_read_b64_tr_b16 a[18:19], v164 offset:768
    v_mfma_f32_16x16x32_bf16 v[114:117], a[72:75], v[154:157], 0
    buffer_load_dwordx4 v125, s[48:51], s4 offen offset:1024 lds
    v_mfma_f32_16x16x32_bf16 v[114:117], a[76:79], v[158:161], v[114:117]
    ds_read_b64_tr_b16 a[40:41], v164 offset:32
    ds_read_b64_tr_b16 a[42:43], v164 offset:800
    v_mfma_f32_16x16x32_bf16 v[114:117], a[80:83], v[166:169], v[114:117]
    ds_read_b64_tr_b16 a[64:65], v164 offset:64
    ds_read_b64_tr_b16 a[66:67], v164 offset:832
    v_mfma_f32_16x16x32_bf16 v[114:117], a[84:87], v[170:173], v[114:117]
    ds_read_b128 v[130:133], v0 offset:20480
    ds_read_b128 v[134:137], v1 offset:20480
    v_mfma_f32_16x16x32_bf16 v[114:117], a[88:91], v[178:181], v[114:117]
    buffer_load_dwordx4 v127, s[48:51], s4 offen offset:2048 lds
    v_mfma_f32_16x16x32_bf16 v[114:117], a[92:95], v[182:185], v[114:117]
    s_add_u32 m0, s69, 0
    ds_read_b128 v[138:141], v0 offset:20608
    ds_read_b128 v[150:153], v1 offset:20608
    v_mfma_f32_16x16x32_bf16 v[118:121], a[96:99], v[154:157], 0
    s_add_u32 s4, s45, 74496
    ds_read_b128 v[186:189], v0 offset:20736
    ds_read_b128 v[202:205], v1 offset:20736
    v_mfma_f32_16x16x32_bf16 v[118:121], a[100:103], v[158:161], v[118:121]
    s_waitcnt lgkmcnt(10)
    v_pk_fma_f16 v145, v201, v201, v145
    v_cvt_pk_f16_f32 v212, v174, v175
    v_mfma_f32_16x16x32_bf16 v[118:121], a[104:107], v[166:169], v[118:121]
    v_pk_fma_f16 v143, v212, v212, v143
    v_cvt_pk_f16_f32 v213, v176, v177
    v_mfma_f32_16x16x32_bf16 v[118:121], a[108:111], v[170:173], v[118:121]
    s_waitcnt lgkmcnt(8)
    v_pk_fma_f16 v145, v213, v213, v145
    v_cvt_pk_f16_f32 v114, v114, v115
    v_mfma_f32_16x16x32_bf16 v[118:121], a[112:115], v[178:181], v[118:121]
    s_waitcnt lgkmcnt(6)
    buffer_load_dwordx4 v123, s[48:51], s4 offen lds
    s_waitcnt vmcnt(7)
    v_mfma_f32_16x16x32_bf16 v[118:121], a[116:119], v[182:185], v[118:121]
    s_waitcnt lgkmcnt(4)
    ds_read_b64_tr_b16 a[20:21], v164 offset:3072
    ds_read_b64_tr_b16 a[22:23], v164 offset:3840
    v_mfma_f32_16x16x32_bf16 v[174:177], a[120:123], v[154:157], 0
    s_waitcnt lgkmcnt(5)
    ds_read_b64_tr_b16 a[44:45], v164 offset:3104
    ds_read_b64_tr_b16 a[46:47], v164 offset:3872
    v_mfma_f32_16x16x32_bf16 v[174:177], a[124:127], v[158:161], v[174:177]
    s_waitcnt lgkmcnt(5)
    ds_read_b64_tr_b16 a[68:69], v164 offset:3136
    ds_read_b64_tr_b16 a[70:71], v164 offset:3904
    v_mfma_f32_16x16x32_bf16 v[174:177], a[128:131], v[166:169], v[174:177]
    s_waitcnt lgkmcnt(6)
    buffer_load_dwordx4 v125, s[48:51], s4 offen offset:1024 lds
    v_mfma_f32_16x16x32_bf16 v[174:177], a[132:135], v[170:173], v[174:177]
    v_pk_mul_f16 v207, v114, v114
    v_cvt_pk_f16_f32 v115, v116, v117
    v_mfma_f32_16x16x32_bf16 v[174:177], a[136:139], v[178:181], v[174:177]
    v_pk_mul_f16 v209, v115, v115
    v_cvt_pk_f16_f32 v116, v118, v119
    v_mfma_f32_16x16x32_bf16 v[174:177], a[140:143], v[182:185], v[174:177]
    v_pk_fma_f16 v207, v116, v116, v207
    v_cvt_pk_f16_f32 v117, v120, v121
    v_mfma_f32_16x16x32_bf16 v[118:121], a[0:3], v[154:157], 0
    buffer_load_dwordx4 v127, s[48:51], s4 offen offset:2048 lds
    v_mfma_f32_16x16x32_bf16 v[118:121], a[4:7], v[158:161], v[118:121]
    s_add_u32 m0, s69, 3072
    v_pk_fma_f16 v209, v117, v117, v209
    s_add_u32 s4, s45, 111360
    v_mfma_f32_16x16x32_bf16 v[118:121], a[8:11], v[166:169], v[118:121]
    s_waitcnt lgkmcnt(2)
    v_cvt_pk_f16_f32 v216, v174, v175
    v_pk_fma_f16 v207, v216, v216, v207
    v_mfma_f32_16x16x32_bf16 v[118:121], a[12:15], v[170:173], v[118:121]
    s_waitcnt lgkmcnt(0)
    v_cvt_pk_f16_f32 v217, v176, v177
    v_pk_fma_f16 v209, v217, v217, v209
    v_mfma_f32_16x16x32_bf16 v[118:121], a[16:19], v[178:181], v[118:121]
    buffer_load_dwordx4 v123, s[48:51], s4 offen lds
    v_mfma_f32_16x16x32_bf16 v[118:121], a[20:23], v[182:185], v[118:121]
    s_waitcnt vmcnt(7)
    ds_read_b64_tr_b16 a[144:145], v162 offset:0
    ds_read_b64_tr_b16 a[146:147], v162 offset:768
    v_mfma_f32_16x16x32_bf16 v[174:177], a[24:27], v[154:157], 0
    ds_read_b64_tr_b16 a[168:169], v162 offset:32
    ds_read_b64_tr_b16 a[170:171], v162 offset:800
    v_mfma_f32_16x16x32_bf16 v[174:177], a[28:31], v[158:161], v[174:177]
    ds_read_b64_tr_b16 a[192:193], v162 offset:64
    ds_read_b64_tr_b16 a[194:195], v162 offset:832
    v_mfma_f32_16x16x32_bf16 v[174:177], a[32:35], v[166:169], v[174:177]
    buffer_load_dwordx4 v125, s[48:51], s4 offen offset:1024 lds
    v_mfma_f32_16x16x32_bf16 v[174:177], a[36:39], v[170:173], v[174:177]
    v_cvt_pk_f16_f32 v218, v118, v119
    v_pk_mul_f16 v206, v218, v218
    v_mfma_f32_16x16x32_bf16 v[174:177], a[40:43], v[178:181], v[174:177]
    v_cvt_pk_f16_f32 v219, v120, v121
    v_pk_mul_f16 v208, v219, v219
    v_mfma_f32_16x16x32_bf16 v[174:177], a[44:47], v[182:185], v[174:177]
    v_mfma_f32_16x16x32_bf16 v[118:121], a[48:51], v[154:157], 0
    buffer_load_dwordx4 v127, s[48:51], s4 offen offset:2048 lds
    v_mfma_f32_16x16x32_bf16 v[118:121], a[52:55], v[158:161], v[118:121]
    s_add_u32 m0, s68, 0
    s_add_u32 s4, s45, 148224
    v_mfma_f32_16x16x32_bf16 v[118:121], a[56:59], v[166:169], v[118:121]
    s_waitcnt lgkmcnt(2)
    v_mfma_f32_16x16x32_bf16 v[118:121], a[60:63], v[170:173], v[118:121]
    s_waitcnt lgkmcnt(0)
    v_cvt_pk_f16_f32 v220, v174, v175
    v_pk_fma_f16 v206, v220, v220, v206
    v_mfma_f32_16x16x32_bf16 v[118:121], a[64:67], v[178:181], v[118:121]
    buffer_load_dwordx4 v123, s[48:51], s4 offen lds
    v_mfma_f32_16x16x32_bf16 v[118:121], a[68:71], v[182:185], v[118:121]
    v_cvt_pk_f16_f32 v221, v176, v177
    v_pk_fma_f16 v208, v221, v221, v208
    s_waitcnt vmcnt(7)
    v_mfma_f32_16x16x32_bf16 v[154:157], a[72:75], v[130:133], 0
    ds_read_b64_tr_b16 a[148:149], v162 offset:3072
    ds_read_b64_tr_b16 a[150:151], v162 offset:3840
    v_mfma_f32_16x16x32_bf16 v[154:157], a[76:79], v[134:137], v[154:157]
    ds_read_b64_tr_b16 a[172:173], v162 offset:3104
    ds_read_b64_tr_b16 a[174:175], v162 offset:3872
    v_mfma_f32_16x16x32_bf16 v[154:157], a[80:83], v[138:141], v[154:157]
    buffer_load_dwordx4 v125, s[48:51], s4 offen offset:1024 lds
    v_mfma_f32_16x16x32_bf16 v[154:157], a[84:87], v[150:153], v[154:157]
    ds_read_b64_tr_b16 a[196:197], v162 offset:3136
    ds_read_b64_tr_b16 a[198:199], v162 offset:3904
    v_mfma_f32_16x16x32_bf16 v[154:157], a[88:91], v[186:189], v[154:157]
    ds_read_b128 v[158:161], v194 offset:6144
    ds_read_b128 v[166:169], v142 offset:6144
    v_mfma_f32_16x16x32_bf16 v[154:157], a[92:95], v[202:205], v[154:157]
    ds_read_b128 v[170:173], v194 offset:6272
    ds_read_b128 v[178:181], v142 offset:6272
    v_mfma_f32_16x16x32_bf16 v[230:233], a[96:99], v[130:133], 0
    buffer_load_dwordx4 v127, s[48:51], s4 offen offset:2048 lds
    v_mfma_f32_16x16x32_bf16 v[230:233], a[100:103], v[134:137], v[230:233]
    s_add_u32 m0, s68, 3072
    ds_read_b128 v[182:185], v194 offset:6400
    ds_read_b128 v[222:225], v142 offset:6400
    v_mfma_f32_16x16x32_bf16 v[230:233], a[104:107], v[138:141], v[230:233]
    s_add_u32 s4, s45, 185088
    v_cvt_pk_f16_f32 v214, v118, v119
    v_pk_fma_f16 v206, v214, v214, v206
    v_mfma_f32_16x16x32_bf16 v[230:233], a[108:111], v[150:153], v[230:233]
    s_sub_u32 s45, s17, 1
    v_cvt_pk_f16_f32 v215, v120, v121
    v_pk_fma_f16 v208, v215, v215, v208
    v_mfma_f32_16x16x32_bf16 v[230:233], a[112:115], v[186:189], v[230:233]
    s_waitcnt lgkmcnt(8)
    v_cvt_pk_f16_f32 v118, v154, v155
    v_pk_mul_f16 v163, v118, v118
    v_mfma_f32_16x16x32_f16 v[174:177], v[40:43], v[206:209], 0
    s_waitcnt lgkmcnt(6)
    buffer_load_dwordx4 v123, s[48:51], s4 offen lds
    v_mfma_f32_16x16x32_bf16 v[230:233], a[116:119], v[202:205], v[230:233]
    s_waitcnt lgkmcnt(4)
    v_cvt_pk_f16_f32 v119, v156, v157
    v_pk_mul_f16 v165, v119, v119
    v_mfma_f32_16x16x32_bf16 v[234:237], a[120:123], v[130:133], 0
    s_waitcnt lgkmcnt(2)
    v_rsq_f32 v176, v174
    s_waitcnt vmcnt(7)
    v_mfma_f32_16x16x32_bf16 v[234:237], a[124:127], v[134:137], v[234:237]
    s_waitcnt lgkmcnt(1)
    ds_read_b64_tr_b16 a[152:153], v164 offset:0
    ds_read_b64_tr_b16 a[154:155], v164 offset:768
    v_mfma_f32_16x16x32_bf16 v[234:237], a[128:131], v[138:141], v[234:237]
    s_waitcnt lgkmcnt(2)
    buffer_load_dwordx4 v125, s[48:51], s4 offen offset:1024 lds
    v_mfma_f32_16x16x32_bf16 v[234:237], a[132:135], v[150:153], v[234:237]
    ds_read_b64_tr_b16 a[176:177], v164 offset:32
    ds_read_b64_tr_b16 a[178:179], v164 offset:800
    v_mfma_f32_16x16x32_bf16 v[234:237], a[136:139], v[186:189], v[234:237]
    ds_read_b64_tr_b16 a[200:201], v164 offset:64
    ds_read_b64_tr_b16 a[202:203], v164 offset:832
    v_mfma_f32_16x16x32_bf16 v[234:237], a[140:143], v[202:205], v[234:237]
    v_rsq_f32 v177, v175
    v_mfma_f32_16x16x32_bf16 v[206:209], a[0:3], v[130:133], 0
    buffer_load_dwordx4 v127, s[48:51], s4 offen offset:2048 lds
    v_mfma_f32_16x16x32_bf16 v[206:209], a[4:7], v[134:137], v[206:209]
    s_add_u32 m0, s28, 8192
    ds_read_b128 v[154:157], v194 offset:0
    ds_read_b128 v[226:229], v142 offset:0
    v_mfma_f32_16x16x32_bf16 v[206:209], a[8:11], v[138:141], v[206:209]
    s_add_u32 s4, 0, 12288
    v_mul_f32 v176, s31, v176
    v_cvt_pk_f16_f32 v176, v176, v177
    v_mfma_f32_16x16x32_bf16 v[206:209], a[12:15], v[150:153], v[206:209]
    s_waitcnt lgkmcnt(6)
    ds_read_b128 v[238:241], v194 offset:128
    v_pk_mul_f16 v114, v114, v176 op_sel:[0,1] op_sel_hi:[1,1]
    v_mfma_f32_16x16x32_bf16 v[206:209], a[16:19], v[186:189], v[206:209]
    buffer_load_dwordx4 v12, s[8:11], s25 offen nt lds
    v_mfma_f32_16x16x32_bf16 v[206:209], a[20:23], v[202:205], v[206:209]
    s_add_u32 m0, s28, 12288
    v_pk_mul_f16 v115, v115, v176 op_sel:[0,1] op_sel_hi:[1,1]
    v_pk_mul_f16 v116, v116, v176 op_sel:[0,1] op_sel_hi:[1,1]
    v_pk_mul_f16 v117, v117, v176 op_sel:[0,1] op_sel_hi:[1,1]
    v_pk_mul_f16 v216, v216, v176 op_sel:[0,1] op_sel_hi:[1,1]
    v_pk_mul_f16 v217, v217, v176 op_sel:[0,1] op_sel_hi:[1,1]
    v_pk_mul_f16 v218, v218, v176 op_sel:[0,0] op_sel_hi:[1,0]
    s_waitcnt vmcnt(7)
    ds_read_b64_tr_b16 a[156:157], v164 offset:3072
    ds_read_b64_tr_b16 a[158:159], v164 offset:3840
    ds_read_b64_tr_b16 a[180:181], v164 offset:3104
    ds_read_b64_tr_b16 a[182:183], v164 offset:3872
    buffer_load_dwordx4 v13, s[8:11], s25 offen nt lds
    ds_read_b64_tr_b16 a[204:205], v164 offset:3136
    ds_read_b64_tr_b16 a[206:207], v164 offset:3904
    ds_write_b128 v144, v[114:117]
    s_add_u32 m0, s29, 0
    v_pk_mul_f16 v219, v219, v176 op_sel:[0,0] op_sel_hi:[1,0]
    v_pk_mul_f16 v220, v220, v176 op_sel:[0,0] op_sel_hi:[1,0]
    v_pk_mul_f16 v221, v221, v176 op_sel:[0,0] op_sel_hi:[1,0]
    v_pk_mul_f16 v214, v214, v176 op_sel:[0,0] op_sel_hi:[1,0]
    buffer_load_dwordx4 v14, s[8:11], s25 offen nt lds
    ds_write_b64 v144, v[216:217] offset:48
    s_add_u32 m0, s69, 0
    s_waitcnt lgkmcnt(8)
    s_cmp_lt_u32 1, s17
    s_cselect_b32 s10, s36, 0
    v_pk_mul_f16 v215, v215, v176 op_sel:[0,0] op_sel_hi:[1,0]
    v_min3_u32 v44, v44, v174, v175
    v_max3_u32 v45, v45, v174, v175
    v_mfma_f32_16x16x32_f16 v[242:245], v[114:117], v[218:221], 0
    s_mov_b32 s25, s24
    ds_read_b128 v[114:117], v142 offset:128
    ds_write_b128 v144, v[218:221] offset:32
    v_mfma_f32_16x16x32_bf16 v[174:177], a[24:27], v[130:133], 0
    s_waitcnt lgkmcnt(3)
    buffer_load_dwordx4 v126, s[52:55], 0 offen lds
    v_cvt_pk_f16_f32 v120, v230, v231
    v_pk_fma_f16 v163, v120, v120, v163
    v_mfma_f32_16x16x16_f16 v[242:245], v[216:217], v[214:215], v[242:245]
    v_cvt_pk_f16_f32 v121, v232, v233
    v_pk_fma_f16 v165, v121, v121, v165
    v_cvt_pk_f16_f32 v196, v234, v235
    s_waitcnt vmcnt(7)
    v_mfma_f32_16x16x32_bf16 v[174:177], a[28:31], v[134:137], v[174:177]
    ds_read_b64_tr_b16 a[160:161], v162 offset:0
    ds_read_b64_tr_b16 a[162:163], v162 offset:768
    v_mfma_f32_16x16x32_bf16 v[174:177], a[32:35], v[138:141], v[174:177]
    ds_read_b64_tr_b16 a[184:185], v162 offset:32
    ds_read_b64_tr_b16 a[186:187], v162 offset:800
    v_mfma_f32_16x16x32_bf16 v[174:177], a[36:39], v[150:153], v[174:177]
    buffer_load_dwordx4 v254, s[52:55], 0 offen offset:1024 lds
    ds_read_b64_tr_b16 a[208:209], v162 offset:64
    v_mfma_f32_16x16x32_bf16 v[174:177], a[40:43], v[186:189], v[174:177]
    s_waitcnt lgkmcnt(5)
    ds_read_b64_tr_b16 a[210:211], v162 offset:832
    ds_read_b128 v[230:233], v194 offset:256
    v_mfma_f32_16x16x32_bf16 v[174:177], a[44:47], v[202:205], v[174:177]
    ds_write_b64 v144, v[214:215] offset:72
    v_mfma_f32_16x16x32_bf16 v[218:221], a[48:51], v[130:133], 0
    v_cndmask_b32 v242, v242, v243, s[96:97]
    v_cndmask_b32 v244, v244, v245, s[96:97]
    v_mfma_f32_16x16x32_bf16 v[218:221], a[52:55], v[134:137], v[218:221]
    buffer_load_dwordx4 v128, s[52:55], 0 offen offset:2048 lds
    ds_read_b128 v[130:133], v142 offset:256
    v_mfma_f32_16x16x32_bf16 v[218:221], a[56:59], v[138:141], v[218:221]
    s_add_u32 m0, s69, 3072
    v_cndmask_b32 v242, v242, v244, s[98:99]
    v_add_f32 v242, s39, v242
    v_mfma_f32_16x16x32_bf16 v[218:221], a[60:63], v[150:153], v[218:221]
    s_waitcnt lgkmcnt(6)
    ds_write_b32 v255, v242 offset:192
    v_mfma_f32_16x16x32_bf16 v[218:221], a[64:67], v[186:189], v[218:221]
    s_waitcnt lgkmcnt(6)
    v_pk_fma_f16 v163, v196, v196, v163
    v_cvt_pk_f16_f32 v197, v236, v237
    v_mfma_f32_16x16x32_bf16 v[218:221], a[68:71], v[202:205], v[218:221]
    s_waitcnt lgkmcnt(4)
    buffer_load_dwordx4 v126, s[52:55], s4 offen lds
    v_mfma_f32_16x16x32_bf16 v[134:137], a[0:3], v[158:161], 0
    s_waitcnt lgkmcnt(2)
    ds_read_b128 v[138:141], v194 offset:6144
    v_pk_fma_f16 v165, v197, v197, v165
    s_waitcnt vmcnt(7)
    v_mfma_f32_16x16x32_bf16 v[134:137], a[4:7], v[166:169], v[134:137]
    ds_read_b64_tr_b16 a[164:165], v162 offset:3072
    ds_read_b64_tr_b16 a[166:167], v162 offset:3840
    v_mfma_f32_16x16x32_bf16 v[134:137], a[8:11], v[170:173], v[134:137]
    ds_read_b64_tr_b16 a[188:189], v162 offset:3104
    ds_read_b64_tr_b16 a[190:191], v162 offset:3872
    v_mfma_f32_16x16x32_bf16 v[134:137], a[12:15], v[178:181], v[134:137]
    s_waitcnt lgkmcnt(6)
    buffer_load_dwordx4 v254, s[52:55], s4 offen offset:1024 lds
    v_mfma_f32_16x16x32_bf16 v[134:137], a[16:19], v[182:185], v[134:137]
    ds_read_b64_tr_b16 a[212:213], v162 offset:3136
    ds_read_b64_tr_b16 a[214:215], v162 offset:3904
    v_mfma_f32_16x16x32_bf16 v[134:137], a[20:23], v[222:225], v[134:137]
    ds_read_b128 v[150:153], v142 offset:6144
    ds_read_b128 v[186:189], v194 offset:6272
    v_mfma_f32_16x16x32_bf16 v[202:205], a[24:27], v[158:161], 0
    ds_read_b128 v[214:217], v142 offset:6272
    v_cvt_pk_f16_f32 v206, v206, v207
    v_mfma_f32_16x16x32_bf16 v[202:205], a[28:31], v[166:169], v[202:205]
    s_waitcnt lgkmcnt(9)
    buffer_load_dwordx4 v128, s[52:55], s4 offen offset:2048 lds
    v_mfma_f32_16x16x32_bf16 v[202:205], a[32:35], v[170:173], v[202:205]
    s_add_u32 m0, s68, 0
    ds_read_b128 v[234:237], v194 offset:6400
    v_pk_mul_f16 v162, v206, v206
    v_mfma_f32_16x16x32_bf16 v[202:205], a[36:39], v[178:181], v[202:205]
    s_add_u32 s4, 0, 24576
    v_cvt_pk_f16_f32 v207, v208, v209
    v_pk_mul_f16 v164, v207, v207
    v_mfma_f32_16x16x32_bf16 v[202:205], a[40:43], v[182:185], v[202:205]
    s_waitcnt lgkmcnt(6)
    v_cvt_pk_f16_f32 v208, v174, v175
    v_pk_fma_f16 v162, v208, v208, v162
    v_mfma_f32_16x16x32_bf16 v[202:205], a[44:47], v[222:225], v[202:205]
    buffer_load_dwordx4 v126, s[52:55], s4 offen lds
    v_cvt_pk_f16_f32 v209, v176, v177
    v_pk_fma_f16 v164, v209, v209, v164
    v_cvt_pk_f16_f32 v194, v218, v219
    v_pk_fma_f16 v162, v194, v194, v162
    v_cvt_pk_f16_f32 v195, v220, v221
    v_mfma_f32_16x16x32_bf16 v[174:177], a[48:51], v[158:161], 0
    s_waitcnt lgkmcnt(1)
    ds_read_b128 v[158:161], v142 offset:6400
    v_pk_fma_f16 v164, v195, v195, v164
    v_mfma_f32_16x16x32_bf16 v[174:177], a[52:55], v[166:169], v[174:177]
    v_cvt_pk_f16_f32 v134, v134, v135
    v_pk_mul_f16 v142, v134, v134
    v_mfma_f32_16x16x32_f16 v[166:169], v[40:43], v[162:165], 0
    s_waitcnt lgkmcnt(1)
    v_cvt_pk_f16_f32 v135, v136, v137
    v_pk_mul_f16 v144, v135, v135
    v_mfma_f32_16x16x32_bf16 v[174:177], a[56:59], v[170:173], v[174:177]
    v_cvt_pk_f16_f32 v136, v202, v203
    v_pk_fma_f16 v142, v136, v136, v142
    v_mfma_f32_16x16x32_bf16 v[174:177], a[60:63], v[178:181], v[174:177]
    v_cvt_pk_f16_f32 v137, v204, v205
    v_min3_u32 v44, v44, v166, v167
    v_mfma_f32_16x16x32_bf16 v[174:177], a[64:67], v[182:185], v[174:177]
    v_rsq_f32 v168, v166
    v_mfma_f32_16x16x32_bf16 v[174:177], a[68:71], v[222:225], v[174:177]
    v_rsq_f32 v169, v167
    v_mfma_f32_16x16x32_bf16 v[162:165], v[154:157], a[144:147], 0
    ds_read_b128 v[178:181], v0 offset:20480
    v_mul_f32 v168, s31, v168
    v_mfma_f32_16x16x32_bf16 v[162:165], v[226:229], a[148:151], v[162:165]
    s_waitcnt lgkmcnt(1)
    ds_read_b128 v[182:185], v1 offset:20480
    v_cvt_pk_f16_f32 v168, v168, v169
    v_mfma_f32_16x16x32_bf16 v[162:165], v[238:241], a[152:155], v[162:165]
    ds_read_b128 v[202:205], v0 offset:20608
    v_pk_mul_f16 v118, v118, v168 op_sel:[0,1] op_sel_hi:[1,1]
    v_mfma_f32_16x16x32_bf16 v[162:165], v[114:117], a[156:159], v[162:165]
    ds_read_b128 v[218:221], v1 offset:20608
    v_pk_mul_f16 v119, v119, v168 op_sel:[0,1] op_sel_hi:[1,1]
    v_mfma_f32_16x16x32_bf16 v[162:165], v[230:233], a[160:163], v[162:165]
    ds_read_b128 v[222:225], v0 offset:20736
    v_pk_mul_f16 v120, v120, v168 op_sel:[0,1] op_sel_hi:[1,1]
    v_mfma_f32_16x16x32_bf16 v[162:165], v[130:133], a[164:167], v[162:165]
    v_pk_mul_f16 v121, v121, v168 op_sel:[0,1] op_sel_hi:[1,1]
    v_pk_mul_f16 v196, v196, v168 op_sel:[0,1] op_sel_hi:[1,1]
    v_pk_mul_f16 v197, v197, v168 op_sel:[0,1] op_sel_hi:[1,1]
    v_pk_mul_f16 v206, v206, v168 op_sel:[0,0] op_sel_hi:[1,0]
    v_pk_mul_f16 v207, v207, v168 op_sel:[0,0] op_sel_hi:[1,0]
    v_pk_mul_f16 v208, v208, v168 op_sel:[0,0] op_sel_hi:[1,0]
    v_pk_mul_f16 v209, v209, v168 op_sel:[0,0] op_sel_hi:[1,0]
    v_pk_mul_f16 v194, v194, v168 op_sel:[0,0] op_sel_hi:[1,0]
    v_pk_mul_f16 v195, v195, v168 op_sel:[0,0] op_sel_hi:[1,0]
    v_max3_u32 v45, v45, v166, v167
    v_pk_fma_f16 v144, v137, v137, v144
    v_cvt_pk_f16_f32 v210, v174, v175
    v_mfma_f32_16x16x32_bf16 v[166:169], v[154:157], a[168:171], 0
    s_waitcnt lgkmcnt(3)
    v_pk_fma_f16 v142, v210, v210, v142
    v_cvt_pk_f16_f32 v211, v176, v177
    v_mfma_f32_16x16x32_bf16 v[166:169], v[226:229], a[172:175], v[166:169]
    s_waitcnt lgkmcnt(2)
    v_pk_fma_f16 v144, v211, v211, v144
    v_cvt_pk_bf16_f32 v162, v162, v162
    v_mfma_f32_16x16x32_bf16 v[166:169], v[238:241], a[176:179], v[166:169]
    s_waitcnt lgkmcnt(1)
    v_cvt_pk_bf16_f32 v163, v163, v163
    v_cvt_pk_bf16_f32 v164, v164, v164
    v_mfma_f32_16x16x32_bf16 v[166:169], v[114:117], a[180:183], v[166:169]
    s_waitcnt lgkmcnt(0)
    ds_write2_b32 v146, v162, v163 offset0:0 offset1:68
    v_mfma_f32_16x16x32_bf16 v[166:169], v[230:233], a[184:187], v[166:169]
    v_cvt_pk_bf16_f32 v165, v165, v165
    v_xor_b32 v255, 65536, v2
    v_mfma_f32_16x16x32_bf16 v[166:169], v[130:133], a[188:191], v[166:169]
    ds_write2_b32 v146, v164, v165 offset0:136 offset1:204
    v_mfma_f32_16x16x32_f16 v[162:165], v[40:43], v[142:145], 0
    v_lshrrev_b32 v127, 2, v255
    v_lshrrev_b32 v123, 8, v255
    v_mfma_f32_16x16x32_bf16 v[142:145], v[154:157], a[192:195], 0
    ds_read_b128 v[154:157], v1 offset:20736
    v_add_u32 v255, 157184, v255
    v_mfma_f32_16x16x32_bf16 v[142:145], v[226:229], a[196:199], v[142:145]
    v_cvt_pk_bf16_f32 v166, v166, v166
    v_cvt_pk_bf16_f32 v167, v167, v167
    v_mfma_f32_16x16x32_bf16 v[142:145], v[238:241], a[200:203], v[142:145]
    ds_write2_b32 v146, v166, v167 offset0:16 offset1:84
    v_mfma_f32_16x16x32_bf16 v[142:145], v[114:117], a[204:207], v[142:145]
    v_rsq_f32 v164, v162
    v_mfma_f32_16x16x32_bf16 v[142:145], v[230:233], a[208:211], v[142:145]
    v_rsq_f32 v165, v163
    v_mfma_f32_16x16x32_bf16 v[142:145], v[130:133], a[212:215], v[142:145]
    v_mul_f32 v164, s31, v164
    v_cvt_pk_f16_f32 v164, v164, v165
    v_mfma_f32_16x16x32_bf16 v[114:117], v[138:141], a[144:147], 0
    v_pk_mul_f16 v198, v198, v164 op_sel:[0,1] op_sel_hi:[1,1]
    v_pk_mul_f16 v199, v199, v164 op_sel:[0,1] op_sel_hi:[1,1]
    v_mfma_f32_16x16x32_bf16 v[114:117], v[150:153], a[148:151], v[114:117]
    s_waitcnt lgkmcnt(1)
    v_pk_mul_f16 v200, v200, v164 op_sel:[0,1] op_sel_hi:[1,1]
    v_pk_mul_f16 v201, v201, v164 op_sel:[0,1] op_sel_hi:[1,1]
    v_mfma_f32_16x16x32_bf16 v[114:117], v[186:189], a[152:155], v[114:117]
    ds_write_b128 v147, v[198:201]
    v_mfma_f32_16x16x32_bf16 v[114:117], v[214:217], a[156:159], v[114:117]
    v_pk_mul_f16 v212, v212, v164 op_sel:[0,1] op_sel_hi:[1,1]
    v_pk_mul_f16 v213, v213, v164 op_sel:[0,1] op_sel_hi:[1,1]
    v_mfma_f32_16x16x32_bf16 v[114:117], v[234:237], a[160:163], v[114:117]
    v_pk_mul_f16 v134, v134, v164 op_sel:[0,0] op_sel_hi:[1,0]
    v_pk_mul_f16 v135, v135, v164 op_sel:[0,0] op_sel_hi:[1,0]
    v_mfma_f32_16x16x32_bf16 v[114:117], v[158:161], a[164:167], v[114:117]
    ds_write_b64 v147, v[212:213] offset:48
    v_mfma_f32_16x16x32_bf16 v[130:133], v[138:141], a[168:171], 0
    v_pk_mul_f16 v136, v136, v164 op_sel:[0,0] op_sel_hi:[1,0]
    v_pk_mul_f16 v137, v137, v164 op_sel:[0,0] op_sel_hi:[1,0]
    v_mfma_f32_16x16x32_bf16 v[130:133], v[150:153], a[172:175], v[130:133]
    ds_write_b128 v147, v[134:137] offset:32
    v_mfma_f32_16x16x32_f16 v[170:173], v[198:201], v[134:137], 0
    v_pk_mul_f16 v210, v210, v164 op_sel:[0,0] op_sel_hi:[1,0]
    v_pk_mul_f16 v211, v211, v164 op_sel:[0,0] op_sel_hi:[1,0]
    v_mfma_f32_16x16x32_bf16 v[130:133], v[186:189], a[176:179], v[130:133]
    v_cndmask_b32 v162, 1.0, v162, s[94:95]
    v_cndmask_b32 v163, 1.0, v163, s[94:95]
    v_mfma_f32_16x16x32_bf16 v[130:133], v[214:217], a[180:183], v[130:133]
    ds_write_b64 v147, v[210:211] offset:72
    v_mfma_f32_16x16x16_f16 v[170:173], v[212:213], v[210:211], v[170:173]
    v_min3_u32 v44, v44, v162, v163
    v_max3_u32 v45, v45, v162, v163
    v_cvt_pk_bf16_f32 v168, v168, v168
    v_cvt_pk_bf16_f32 v169, v169, v169
    v_mfma_f32_16x16x32_bf16 v[130:133], v[234:237], a[184:187], v[130:133]
    ds_write2_b32 v146, v168, v169 offset0:152 offset1:220
    v_mfma_f32_16x16x32_bf16 v[130:133], v[158:161], a[188:191], v[130:133]
    v_cvt_pk_bf16_f32 v142, v142, v142
    v_cndmask_b32 v170, v170, v171, s[96:97]
    v_mfma_f32_16x16x32_bf16 v[134:137], v[138:141], a[192:195], 0
    v_cndmask_b32 v172, v172, v173, s[96:97]
    v_cndmask_b32 v170, v170, v172, s[98:99]
    v_mfma_f32_16x16x32_bf16 v[134:137], v[150:153], a[196:199], v[134:137]
    v_add_f32 v170, s39, v170
    v_cvt_pk_bf16_f32 v143, v143, v143
    v_mfma_f32_16x16x32_bf16 v[134:137], v[186:189], a[200:203], v[134:137]
    ds_write_b32 v124, v170 offset:192
    v_mfma_f32_16x16x32_bf16 v[134:137], v[214:217], a[204:207], v[134:137]
    v_cvt_pk_bf16_f32 v144, v144, v144
    v_cvt_pk_bf16_f32 v145, v145, v145
    v_mfma_f32_16x16x32_bf16 v[134:137], v[234:237], a[208:211], v[134:137]
    ds_write2_b32 v146, v142, v143 offset0:32 offset1:100
    v_mfma_f32_16x16x32_bf16 v[134:137], v[158:161], a[212:215], v[134:137]
    v_cvt_pk_bf16_f32 v114, v114, v114
    v_cvt_pk_bf16_f32 v115, v115, v115
    v_mfma_f32_16x16x32_bf16 v[170:173], v[178:181], a[144:147], 0
    ds_write2_b32 v146, v144, v145 offset0:168 offset1:236
    v_mfma_f32_16x16x32_bf16 v[170:173], v[182:185], a[148:151], v[170:173]
    v_cvt_pk_bf16_f32 v116, v116, v116
    v_cvt_pk_bf16_f32 v117, v117, v117
    v_mfma_f32_16x16x32_bf16 v[170:173], v[202:205], a[152:155], v[170:173]
    ds_write2_b32 v149, v114, v115 offset0:0 offset1:68
    v_mfma_f32_16x16x32_bf16 v[170:173], v[218:221], a[156:159], v[170:173]
    v_cvt_pk_bf16_f32 v130, v130, v130
    v_cvt_pk_bf16_f32 v131, v131, v131
    v_mfma_f32_16x16x32_bf16 v[170:173], v[222:225], a[160:163], v[170:173]
    ds_write2_b32 v149, v116, v117 offset0:136 offset1:204
    v_mfma_f32_16x16x32_bf16 v[170:173], v[154:157], a[164:167], v[170:173]
    v_cvt_pk_bf16_f32 v132, v132, v132
    v_cvt_pk_bf16_f32 v133, v133, v133
    v_mfma_f32_16x16x32_bf16 v[114:117], v[178:181], a[168:171], 0
    ds_write2_b32 v149, v130, v131 offset0:16 offset1:84
    v_mfma_f32_16x16x32_bf16 v[114:117], v[182:185], a[172:175], v[114:117]
    v_cvt_pk_bf16_f32 v134, v134, v134
    v_cvt_pk_bf16_f32 v135, v135, v135
    v_mfma_f32_16x16x32_bf16 v[114:117], v[202:205], a[176:179], v[114:117]
    ds_write2_b32 v149, v132, v133 offset0:152 offset1:220
    v_mfma_f32_16x16x32_bf16 v[114:117], v[218:221], a[180:183], v[114:117]
    v_cvt_pk_bf16_f32 v136, v136, v136
    v_cvt_pk_bf16_f32 v137, v137, v137
    v_mfma_f32_16x16x32_bf16 v[114:117], v[222:225], a[184:187], v[114:117]
    ds_write2_b32 v149, v134, v135 offset0:32 offset1:100
    v_mfma_f32_16x16x32_bf16 v[114:117], v[154:157], a[188:191], v[114:117]
    v_cvt_pk_bf16_f32 v130, v170, v171
    v_cvt_pk_bf16_f32 v131, v172, v173
    v_mfma_f32_16x16x32_bf16 v[138:141], v[178:181], a[192:195], 0
    ds_write2_b32 v149, v136, v137 offset0:168 offset1:236
    v_mfma_f32_16x16x32_bf16 v[138:141], v[182:185], a[196:199], v[138:141]
    v_lshl_add_u32 v124, s16, 2, v255
    v_add_u32 v127, 162048, v127
    v_mfma_f32_16x16x32_bf16 v[138:141], v[202:205], a[200:203], v[138:141]
    v_cvt_pk_bf16_f32 v114, v114, v115
    v_cvt_pk_bf16_f32 v115, v116, v117
    v_mfma_f32_16x16x32_bf16 v[138:141], v[218:221], a[204:207], v[138:141]
    v_lshlrev_b32 v123, 4, v123
    v_add_u32 v123, 162048, v123
    v_mfma_f32_16x16x32_bf16 v[138:141], v[222:225], a[208:211], v[138:141]
    v_or_b32 v134, v32, v33
    v_and_b32 v134, 0xffff, v134
    v_mfma_f32_16x16x32_bf16 v[138:141], v[154:157], a[212:215], v[138:141]
    v_lshl_or_b32 v134, v134, 16, v134
    v_or_b32 v135, v32, v33
    v_mfma_f32_16x16x32_f16 v[142:145], v[118:121], v[206:209], v[46:49]
    buffer_load_dwordx4 v254, s[52:55], s4 offen offset:1024 lds
    v_and_b32 v135, 0xffff, v135
    v_lshl_or_b32 v135, v135, 16, v135
    v_or_b32 v136, v32, v33
    v_lshrrev_b32 v136, 16, v136
    v_cvt_pk_bf16_f32 v138, v138, v139
    v_mfma_f32_16x16x16_f16 v[142:145], v[196:197], v[194:195], v[142:145]
    v_cvt_pk_bf16_f32 v139, v140, v141
    v_lshl_or_b32 v136, v136, 16, v136
    v_or_b32 v137, v32, v33
    v_lshrrev_b32 v137, 16, v137
    v_lshl_or_b32 v137, v137, 16, v137
    v_xor_b32 v2, 65536, v2
    s_nop 0
    buffer_load_dwordx4 v128, s[52:55], s4 offen offset:2048 lds
    s_add_u32 m0, s68, 3072
    s_add_u32 s4, 0, 36864
    v_exp_f32 v142, v142
    v_exp_f32 v143, v143
    v_exp_f32 v144, v144
    v_cvt_pk_bf16_f32 v142, v142, v143
    v_exp_f32 v145, v145
    s_nop 0
    v_cvt_pk_bf16_f32 v143, v144, v145
    buffer_load_dwordx4 v126, s[52:55], s4 offen lds
    s_waitcnt vmcnt(10)
    s_barrier
    ds_read_b128 v[146:149], v0 offset:26624
    ds_read_b128 v[150:153], v1 offset:26624
    ds_read_b128 v[154:157], v0 offset:26752
    ds_read_b128 v[158:161], v1 offset:26752
    ds_read_b128 v[162:165], v0 offset:26880
    ds_read_b128 v[166:169], v1 offset:26880
    buffer_load_dwordx4 v254, s[52:55], s4 offen offset:1024 lds
    s_waitcnt lgkmcnt(5)
    v_mfma_f32_16x16x32_bf16 v[170:173], a[72:75], v[146:149], 0
    s_waitcnt lgkmcnt(4)
    buffer_load_dwordx4 v128, s[52:55], s4 offen offset:2048 lds
    v_mfma_f32_16x16x32_bf16 v[170:173], a[76:79], v[150:153], v[170:173]
    s_waitcnt lgkmcnt(2)
    s_add_u32 m0, s69, 0
    s_add_u32 s4, 0, 49152
    v_mfma_f32_16x16x32_bf16 v[170:173], a[80:83], v[154:157], v[170:173]
    s_waitcnt lgkmcnt(1)
    v_mfma_f32_16x16x32_bf16 v[170:173], a[84:87], v[158:161], v[170:173]
    s_waitcnt lgkmcnt(0)
    v_mfma_f32_16x16x32_bf16 v[170:173], a[88:91], v[162:165], v[170:173]
    v_mfma_f32_16x16x32_bf16 v[170:173], a[92:95], v[166:169], v[170:173]
    s_waitcnt vmcnt(9)
    ds_read_b64 a[216:217], v193 offset:0
    ds_read_b64 a[218:219], v193 offset:1536
    v_mfma_f32_16x16x32_bf16 v[174:177], a[96:99], v[146:149], 0
    ds_read_b64 a[240:241], v193 offset:8
    ds_read_b64 a[242:243], v193 offset:1544
    v_mfma_f32_16x16x32_bf16 v[174:177], a[100:103], v[150:153], v[174:177]
    ds_read_b64 v[90:91], v122 offset:0
    ds_read_b64 v[92:93], v122 offset:1536
    v_mfma_f32_16x16x32_bf16 v[174:177], a[104:107], v[154:157], v[174:177]
    v_cvt_pk_f16_f32 v170, v170, v171
    v_pk_mul_f16 v179, v170, v170
    v_mfma_f32_16x16x32_bf16 v[174:177], a[108:111], v[158:161], v[174:177]
    v_cvt_pk_f16_f32 v171, v172, v173
    v_pk_mul_f16 v181, v171, v171
    v_mfma_f32_16x16x32_bf16 v[174:177], a[112:115], v[162:165], v[174:177]
    v_mfma_f32_16x16x32_bf16 v[174:177], a[116:119], v[166:169], v[174:177]
    v_mfma_f32_16x16x32_bf16 v[182:185], a[120:123], v[146:149], 0
    v_mfma_f32_16x16x32_bf16 v[182:185], a[124:127], v[150:153], v[182:185]
    s_waitcnt lgkmcnt(4)
    v_mfma_f32_16x16x32_bf16 v[182:185], a[128:131], v[154:157], v[182:185]
    s_waitcnt lgkmcnt(2)
    v_mfma_f32_16x16x32_bf16 v[182:185], a[132:135], v[158:161], v[182:185]
    s_waitcnt lgkmcnt(0)
    buffer_load_dwordx4 v126, s[52:55], s4 offen lds
    v_mfma_f32_16x16x32_bf16 v[182:185], a[136:139], v[162:165], v[182:185]
    v_cvt_pk_f16_f32 v172, v174, v175
    v_pk_fma_f16 v179, v172, v172, v179
    v_mfma_f32_16x16x32_bf16 v[182:185], a[140:143], v[166:169], v[182:185]
    s_waitcnt vmcnt(7)
    ds_read_b64 a[232:233], v193 offset:3072
    ds_read_b64 a[220:221], v193 offset:4608
    v_mfma_f32_16x16x32_bf16 v[186:189], a[0:3], v[146:149], 0
    ds_read_b64 v[82:83], v193 offset:3080
    ds_read_b64 a[244:245], v193 offset:4616
    v_mfma_f32_16x16x32_bf16 v[186:189], a[4:7], v[150:153], v[186:189]
    buffer_load_dwordx4 v254, s[52:55], s4 offen offset:1024 lds
    v_mfma_f32_16x16x32_bf16 v[186:189], a[8:11], v[154:157], v[186:189]
    ds_read_b64 v[106:107], v122 offset:3072
    ds_read_b64 v[94:95], v122 offset:4608
    v_mfma_f32_16x16x32_bf16 v[186:189], a[12:15], v[158:161], v[186:189]
    v_cvt_pk_f16_f32 v173, v176, v177
    v_pk_fma_f16 v181, v173, v173, v181
    v_mfma_f32_16x16x32_bf16 v[186:189], a[16:19], v[162:165], v[186:189]
    v_cvt_pk_f16_f32 v176, v182, v183
    v_pk_fma_f16 v179, v176, v176, v179
    v_mfma_f32_16x16x32_bf16 v[186:189], a[20:23], v[166:169], v[186:189]
    buffer_load_dwordx4 v128, s[52:55], s4 offen offset:2048 lds
    v_mfma_f32_16x16x32_bf16 v[198:201], a[24:27], v[146:149], 0
    s_add_u32 m0, s69, 3072
    v_cvt_pk_f16_f32 v177, v184, v185
    v_pk_fma_f16 v181, v177, v177, v181
    v_mfma_f32_16x16x32_bf16 v[198:201], a[28:31], v[150:153], v[198:201]
    s_add_u32 s4, 0, 61440
    v_mfma_f32_16x16x32_bf16 v[198:201], a[32:35], v[154:157], v[198:201]
    s_waitcnt lgkmcnt(2)
    v_cvt_pk_f16_f32 v182, v186, v187
    v_pk_mul_f16 v178, v182, v182
    v_mfma_f32_16x16x32_bf16 v[198:201], a[36:39], v[158:161], v[198:201]
    v_cvt_pk_f16_f32 v183, v188, v189
    v_pk_mul_f16 v180, v183, v183
    v_mfma_f32_16x16x32_bf16 v[198:201], a[40:43], v[162:165], v[198:201]
    s_waitcnt lgkmcnt(0)
    buffer_load_dwordx4 v126, s[52:55], s4 offen lds
    v_mfma_f32_16x16x32_bf16 v[198:201], a[44:47], v[166:169], v[198:201]
    v_mfma_f32_16x16x32_bf16 v[186:189], a[48:51], v[146:149], 0
    s_waitcnt vmcnt(7)
    ds_read_b64 a[222:223], v129 offset:0
    ds_read_b64 a[234:235], v129 offset:1536
    v_mfma_f32_16x16x32_bf16 v[186:189], a[52:55], v[150:153], v[186:189]
    ds_read_b64 a[246:247], v129 offset:8
    ds_read_b64 v[84:85], v129 offset:1544
    v_mfma_f32_16x16x32_bf16 v[186:189], a[56:59], v[154:157], v[186:189]
    buffer_load_dwordx4 v254, s[52:55], s4 offen offset:1024 lds
    v_mfma_f32_16x16x32_bf16 v[186:189], a[60:63], v[158:161], v[186:189]
    ds_read_b64 v[96:97], v192 offset:0
    ds_read_b64 v[108:109], v192 offset:1536
    v_mfma_f32_16x16x32_bf16 v[186:189], a[64:67], v[162:165], v[186:189]
    ds_read_b128 v[202:205], v0 offset:32768
    v_cvt_pk_f16_f32 v184, v198, v199
    v_mfma_f32_16x16x32_bf16 v[186:189], a[68:71], v[166:169], v[186:189]
    ds_read_b128 v[210:213], v1 offset:32768
    v_pk_fma_f16 v178, v184, v184, v178
    v_mfma_f32_16x16x32_bf16 v[214:217], v[146:149], a[144:147], 0
    buffer_load_dwordx4 v128, s[52:55], s4 offen offset:2048 lds
    v_mfma_f32_16x16x32_bf16 v[214:217], v[150:153], a[148:151], v[214:217]
    s_add_u32 m0, s28, 65536
    ds_read_b128 v[218:221], v0 offset:32896
    ds_read_b128 v[222:225], v1 offset:32896
    v_mfma_f32_16x16x32_bf16 v[214:217], v[154:157], a[152:155], v[214:217]
    s_waitcnt lgkmcnt(8)
    ds_read_b128 v[226:229], v0 offset:33024
    v_cvt_pk_f16_f32 v185, v200, v201
    v_mfma_f32_16x16x32_bf16 v[214:217], v[158:161], a[156:159], v[214:217]
    s_waitcnt lgkmcnt(7)
    ds_read_b128 v[198:201], v1 offset:33024
    v_pk_fma_f16 v180, v185, v185, v180
    v_mfma_f32_16x16x32_bf16 v[214:217], v[162:165], a[160:163], v[214:217]
    buffer_load_dwordx4 v10, s[8:11], s24 offen nt lds
    v_mfma_f32_16x16x32_bf16 v[214:217], v[166:169], a[164:167], v[214:217]
    s_add_u32 m0, s28, 69632
    v_cvt_pk_f16_f32 v174, v186, v187
    v_pk_fma_f16 v178, v174, v174, v178
    v_mfma_f32_16x16x32_bf16 v[230:233], v[146:149], a[168:171], 0
    s_waitcnt vmcnt(7)
    ds_read_b64 a[224:225], v129 offset:3072
    ds_read_b64 a[226:227], v129 offset:4608
    v_mfma_f32_16x16x32_bf16 v[230:233], v[150:153], a[172:175], v[230:233]
    s_waitcnt lgkmcnt(6)
    ds_read_b64 a[248:249], v129 offset:3080
    ds_read_b64 a[250:251], v129 offset:4616
    v_mfma_f32_16x16x32_bf16 v[230:233], v[154:157], a[176:179], v[230:233]
    buffer_load_dwordx4 v11, s[8:11], s24 offen nt lds
    v_mfma_f32_16x16x32_bf16 v[230:233], v[158:161], a[180:183], v[230:233]
    s_add_u32 m0, s28, 73728
    ds_read_b64 v[98:99], v192 offset:3072
    ds_read_b64 v[100:101], v192 offset:4608
    v_mfma_f32_16x16x32_bf16 v[230:233], v[162:165], a[184:187], v[230:233]
    s_waitcnt lgkmcnt(7)
    v_cvt_pk_f16_f32 v175, v188, v189
    v_pk_fma_f16 v180, v175, v175, v180
    v_mfma_f32_16x16x32_bf16 v[230:233], v[166:169], a[188:191], v[230:233]
    s_waitcnt lgkmcnt(6)
    v_cvt_pk_bf16_f32 v132, v214, v215
    v_cvt_pk_bf16_f32 v133, v216, v217
    v_mfma_f32_16x16x32_f16 v[186:189], v[40:43], v[178:181], 0
    buffer_load_dwordx4 v12, s[8:11], s24 offen nt lds
    v_mfma_f32_16x16x32_bf16 v[178:181], v[146:149], a[192:195], 0
    s_add_u32 m0, s28, 77824
    v_xor_b32 v0, 65536, v0
    v_cvt_pk_bf16_f32 v116, v230, v231
    v_mfma_f32_16x16x32_bf16 v[178:181], v[150:153], a[196:199], v[178:181]
    s_waitcnt lgkmcnt(4)
    v_cvt_pk_bf16_f32 v117, v232, v233
    v_min3_u32 v44, v44, v186, v187
    v_mfma_f32_16x16x32_bf16 v[178:181], v[154:157], a[200:203], v[178:181]
    s_waitcnt lgkmcnt(2)
    v_rsq_f32 v188, v186
    v_mfma_f32_16x16x32_bf16 v[178:181], v[158:161], a[204:207], v[178:181]
    buffer_load_dwordx4 v13, s[8:11], s24 offen nt lds
    v_mfma_f32_16x16x32_bf16 v[178:181], v[162:165], a[208:211], v[178:181]
    s_add_u32 m0, s74, 0
    v_rsq_f32 v189, v187
    v_mfma_f32_16x16x32_bf16 v[178:181], v[166:169], a[212:215], v[178:181]
    s_waitcnt lgkmcnt(0)
    v_mul_f32 v188, s31, v188
    v_cvt_pk_f16_f32 v188, v188, v189
    v_mfma_f32_16x16x32_bf16 v[146:149], a[72:75], v[202:205], 0
    s_waitcnt vmcnt(7)
    ds_read_b64 a[236:237], v193 offset:0
    ds_read_b64 a[228:229], v193 offset:1536
    v_mfma_f32_16x16x32_bf16 v[146:149], a[76:79], v[210:213], v[146:149]
    buffer_load_dwordx4 v14, s[8:11], s24 offen nt lds
    v_mfma_f32_16x16x32_bf16 v[146:149], a[80:83], v[218:221], v[146:149]
    s_add_u32 s8, s40, s23
    ds_read_b64 v[86:87], v193 offset:8
    ds_read_b64 a[252:253], v193 offset:1544
    v_mfma_f32_16x16x32_bf16 v[146:149], a[84:87], v[222:225], v[146:149]
    s_addc_u32 s9, s41, 0
    ds_read_b64 v[110:111], v122 offset:0
    ds_read_b64 v[102:103], v122 offset:1536
    v_mfma_f32_16x16x32_bf16 v[146:149], a[88:91], v[226:229], v[146:149]
    s_sub_u32 s10, s36, s23
    v_pk_mul_f16 v170, v170, v188 op_sel:[0,1] op_sel_hi:[1,1]
    v_pk_mul_f16 v171, v171, v188 op_sel:[0,1] op_sel_hi:[1,1]
    v_mfma_f32_16x16x32_bf16 v[146:149], a[92:95], v[198:201], v[146:149]
    s_cmp_lt_u32 s34, s17
    v_pk_mul_f16 v172, v172, v188 op_sel:[0,1] op_sel_hi:[1,1]
    v_pk_mul_f16 v173, v173, v188 op_sel:[0,1] op_sel_hi:[1,1]
    v_mfma_f32_16x16x32_bf16 v[150:153], a[96:99], v[202:205], 0
    s_cselect_b32 s10, s10, 0
    v_pk_mul_f16 v176, v176, v188 op_sel:[0,1] op_sel_hi:[1,1]
    v_pk_mul_f16 v177, v177, v188 op_sel:[0,1] op_sel_hi:[1,1]
    v_mfma_f32_16x16x32_bf16 v[150:153], a[100:103], v[210:213], v[150:153]
    s_add_u32 m0, s28, 0
    v_pk_mul_f16 v182, v182, v188 op_sel:[0,0] op_sel_hi:[1,0]
    v_pk_mul_f16 v183, v183, v188 op_sel:[0,0] op_sel_hi:[1,0]
    v_mfma_f32_16x16x32_bf16 v[150:153], a[104:107], v[218:221], v[150:153]
    s_mov_b32 s24, s23
    v_pk_mul_f16 v184, v184, v188 op_sel:[0,0] op_sel_hi:[1,0]
    v_pk_mul_f16 v185, v185, v188 op_sel:[0,0] op_sel_hi:[1,0]
    v_mfma_f32_16x16x32_bf16 v[150:153], a[108:111], v[222:225], v[150:153]
    s_add_u32 s23, s23, s21
    v_pk_mul_f16 v174, v174, v188 op_sel:[0,0] op_sel_hi:[1,0]
    v_pk_mul_f16 v175, v175, v188 op_sel:[0,0] op_sel_hi:[1,0]
    v_mfma_f32_16x16x32_bf16 v[150:153], a[112:115], v[226:229], v[150:153]
    s_cmp_ge_u32 s19, 72
    v_max3_u32 v45, v45, v186, v187
    v_cvt_pk_bf16_f32 v140, v178, v179
    v_mfma_f32_16x16x32_bf16 v[150:153], a[116:119], v[198:201], v[150:153]
    s_cselect_b32 s34, 72, 0
    v_cvt_pk_bf16_f32 v141, v180, v181
    v_cvt_pk_f16_f32 v146, v146, v147
    v_mfma_f32_16x16x32_bf16 v[154:157], a[120:123], v[202:205], 0
    s_cselect_b32 s35, s22, 0
    v_pk_mul_f16 v159, v146, v146
    v_cvt_pk_f16_f32 v147, v148, v149
    v_mfma_f32_16x16x32_bf16 v[154:157], a[124:127], v[210:213], v[154:157]
    s_waitcnt vmcnt(5)
    ds_read_b64 a[230:231], v193 offset:3072
    ds_read_b64 a[238:239], v193 offset:4608
    v_mfma_f32_16x16x32_bf16 v[154:157], a[128:131], v[218:221], v[154:157]
    s_sub_u32 s19, s19, s34
    ds_read_b64 a[254:255], v193 offset:3080
    ds_read_b64 v[88:89], v193 offset:4616
    v_mfma_f32_16x16x32_bf16 v[154:157], a[132:135], v[222:225], v[154:157]
    s_add_u32 s23, s23, s35
    ds_read_b64 v[104:105], v122 offset:3072
    ds_read_b64 v[112:113], v122 offset:4608
    v_mfma_f32_16x16x32_bf16 v[154:157], a[136:139], v[226:229], v[154:157]
    s_waitcnt lgkmcnt(6)
    v_pk_mul_f16 v161, v147, v147
    v_cvt_pk_f16_f32 v148, v150, v151
    v_mfma_f32_16x16x32_bf16 v[154:157], a[140:143], v[198:201], v[154:157]
    v_pk_fma_f16 v159, v148, v148, v159
    v_cvt_pk_f16_f32 v149, v152, v153
    v_mfma_f32_16x16x32_bf16 v[150:153], a[0:3], v[202:205], 0
    v_pk_fma_f16 v161, v149, v149, v161
    v_xor_b32 v1, 65536, v1
    v_mfma_f32_16x16x32_bf16 v[150:153], a[4:7], v[210:213], v[150:153]
    v_mfma_f32_16x16x32_bf16 v[150:153], a[8:11], v[218:221], v[150:153]
    v_mfma_f32_16x16x32_bf16 v[150:153], a[12:15], v[222:225], v[150:153]
    s_waitcnt lgkmcnt(4)
    v_cvt_pk_f16_f32 v164, v154, v155
    v_pk_fma_f16 v159, v164, v164, v159
    v_mfma_f32_16x16x32_bf16 v[150:153], a[16:19], v[226:229], v[150:153]
    s_waitcnt lgkmcnt(2)
    v_cvt_pk_f16_f32 v165, v156, v157
    v_pk_fma_f16 v161, v165, v165, v161
    v_mfma_f32_16x16x32_bf16 v[150:153], a[20:23], v[198:201], v[150:153]
    s_waitcnt lgkmcnt(0)
    v_mfma_f32_16x16x32_bf16 v[154:157], a[24:27], v[202:205], 0
    v_mfma_f32_16x16x32_bf16 v[154:157], a[28:31], v[210:213], v[154:157]
    v_mfma_f32_16x16x32_bf16 v[154:157], a[32:35], v[218:221], v[154:157]
    v_mfma_f32_16x16x32_bf16 v[154:157], a[36:39], v[222:225], v[154:157]
    v_mfma_f32_16x16x32_bf16 v[154:157], a[40:43], v[226:229], v[154:157]
    v_mfma_f32_16x16x32_bf16 v[154:157], a[44:47], v[198:201], v[154:157]
    v_mfma_f32_16x16x32_bf16 v[166:169], a[48:51], v[202:205], 0
    v_cvt_pk_f16_f32 v150, v150, v151
    v_pk_mul_f16 v158, v150, v150
    v_mfma_f32_16x16x32_bf16 v[166:169], a[52:55], v[210:213], v[166:169]
    v_cvt_pk_f16_f32 v151, v152, v153
    v_pk_mul_f16 v160, v151, v151
    v_mfma_f32_16x16x32_bf16 v[166:169], a[56:59], v[218:221], v[166:169]
    v_mfma_f32_16x16x32_bf16 v[166:169], a[60:63], v[222:225], v[166:169]
    v_cvt_pk_f16_f32 v152, v154, v155
    v_pk_fma_f16 v158, v152, v152, v158
    v_mfma_f32_16x16x32_bf16 v[166:169], a[64:67], v[226:229], v[166:169]
    v_cvt_pk_f16_f32 v153, v156, v157
    v_pk_fma_f16 v160, v153, v153, v160
    v_mfma_f32_16x16x32_bf16 v[166:169], a[68:71], v[198:201], v[166:169]
    v_mfma_f32_16x16x32_bf16 v[154:157], v[202:205], a[144:147], 0
    v_mfma_f32_16x16x32_bf16 v[154:157], v[210:213], a[148:151], v[154:157]
    v_mfma_f32_16x16x32_bf16 v[154:157], v[218:221], a[152:155], v[154:157]
    ds_read_b128 v[178:181], v5 offset:0
    ds_read_b128 v[186:189], v5 offset:16
    v_mfma_f32_16x16x32_bf16 v[154:157], v[222:225], a[156:159], v[154:157]
    ds_read_b128 v[214:217], v5 offset:48
    ds_read_b32 v254, v6 offset:192
    v_mfma_f32_16x16x32_bf16 v[154:157], v[226:229], a[160:163], v[154:157]
    v_cvt_pk_f16_f32 v162, v166, v167
    v_pk_fma_f16 v158, v162, v162, v158
    v_mfma_f32_16x16x32_bf16 v[154:157], v[198:201], a[164:167], v[154:157]
    v_cvt_pk_f16_f32 v163, v168, v169
    v_pk_fma_f16 v160, v163, v163, v160
    v_mfma_f32_16x16x32_bf16 v[166:169], v[202:205], a[168:171], 0
    v_add_u32 v5, 336, v5
    v_mfma_f32_16x16x32_f16 v[230:233], v[40:43], v[158:161], 0
    v_mfma_f32_16x16x32_bf16 v[166:169], v[210:213], a[172:175], v[166:169]
    v_mfma_f32_16x16x32_bf16 v[166:169], v[218:221], a[176:179], v[166:169]
    v_mfma_f32_16x16x32_f16 v[158:161], v[170:173], v[206:209], v[50:53]
    s_waitcnt lgkmcnt(2)
    v_cvt_pk_bf16_f32 v154, v154, v155
    v_cvt_pk_bf16_f32 v155, v156, v157
    v_mfma_f32_16x16x32_f16 v[234:237], v[178:181], v[182:185], v[24:27]
    s_waitcnt lgkmcnt(0)
    v_rsq_f32 v232, v230
    v_mfma_f32_16x16x32_f16 v[234:237], v[186:189], v[170:173], v[234:237]
    v_rsq_f32 v233, v231
    v_mfma_f32_16x16x32_f16 v[234:237], v[214:217], v[174:177], v[234:237]
    v_mul_f32 v232, s31, v232
    v_cvt_pk_f16_f32 v232, v232, v233
    v_mfma_f32_16x16x32_f16 v[238:241], v[178:181], v[206:209], v[22:25]
    v_pk_mul_f16 v146, v146, v232 op_sel:[0,1] op_sel_hi:[1,1]
    v_pk_mul_f16 v147, v147, v232 op_sel:[0,1] op_sel_hi:[1,1]
    v_mfma_f32_16x16x32_f16 v[238:241], v[186:189], v[118:121], v[238:241]
    v_pk_mul_f16 v148, v148, v232 op_sel:[0,1] op_sel_hi:[1,1]
    v_pk_mul_f16 v149, v149, v232 op_sel:[0,1] op_sel_hi:[1,1]
    v_mfma_f32_16x16x32_f16 v[238:241], v[214:217], v[194:197], v[238:241]
    v_pk_mul_f16 v164, v164, v232 op_sel:[0,1] op_sel_hi:[1,1]
    v_pk_mul_f16 v165, v165, v232 op_sel:[0,1] op_sel_hi:[1,1]
    v_mfma_f32_16x16x32_f16 v[242:245], v[146:149], v[206:209], v[54:57]
    v_pk_mul_f16 v150, v150, v232 op_sel:[0,0] op_sel_hi:[1,0]
    v_pk_mul_f16 v151, v151, v232 op_sel:[0,0] op_sel_hi:[1,0]
    v_pk_mul_f16 v152, v152, v232 op_sel:[0,0] op_sel_hi:[1,0]
    v_mfma_f32_16x16x16_f16 v[158:161], v[176:177], v[194:195], v[158:161]
    v_pk_mul_f16 v153, v153, v232 op_sel:[0,0] op_sel_hi:[1,0]
    v_pk_mul_f16 v162, v162, v232 op_sel:[0,0] op_sel_hi:[1,0]
    v_pk_mul_f16 v163, v163, v232 op_sel:[0,0] op_sel_hi:[1,0]
    v_mfma_f32_16x16x16_f16 v[242:245], v[164:165], v[194:195], v[242:245]
    v_min3_u32 v44, v44, v230, v231
    v_max3_u32 v45, v45, v230, v231
    v_exp_f32 v238, v238
    v_mfma_f32_16x16x32_bf16 v[166:169], v[222:225], a[180:183], v[166:169]
    v_mov_b32_dpp v254, v239 quad_perm:[0,1,2,3] row_mask:0x1 bank_mask:0xf
    v_mov_b32_dpp v254, v235 quad_perm:[0,1,2,3] row_mask:0x2 bank_mask:0xf
    v_mfma_f32_16x16x32_bf16 v[166:169], v[226:229], a[184:187], v[166:169]
    v_exp_f32 v158, v158
    v_mfma_f32_16x16x32_bf16 v[166:169], v[198:201], a[188:191], v[166:169]
    v_exp_f32 v159, v159
    v_mfma_f32_16x16x32_bf16 v[206:209], v[202:205], a[192:195], 0
    v_cvt_pk_bf16_f32 v144, v158, v159
    v_cvt_pk_bf16_f32 v39, v238, 0
    v_mfma_f32_16x16x32_bf16 v[206:209], v[210:213], a[196:199], v[206:209]
    v_exp_f32 v160, v160
    v_mfma_f32_16x16x32_bf16 v[206:209], v[218:221], a[200:203], v[206:209]
    v_exp_f32 v161, v161
    v_mfma_f32_16x16x32_bf16 v[206:209], v[222:225], a[204:207], v[206:209]
    v_cvt_pk_bf16_f32 v166, v166, v167
    v_cvt_pk_bf16_f32 v167, v168, v169
    v_mfma_f32_16x16x32_bf16 v[206:209], v[226:229], a[208:211], v[206:209]
    v_exp_f32 v242, v242
    v_mfma_f32_16x16x32_bf16 v[206:209], v[198:201], a[212:215], v[206:209]
    ds_read2_b32 v[156:157], v6 offset0:0 offset1:0
    ds_read2_b32 v[168:169], v6 offset0:16 offset1:16
    v_mfma_f32_16x16x32_f16 v[198:201], v[178:181], v[150:153], v[26:29]
    ds_read2_b32 v[180:181], v6 offset0:32 offset1:32
    v_cvt_pk_bf16_f32 v145, v160, v161
    v_mfma_f32_16x16x32_f16 v[198:201], v[186:189], v[146:149], v[198:201]
    v_exp_f32 v243, v243
    v_mfma_f32_16x16x32_f16 v[198:201], v[214:217], v[162:165], v[198:201]
    v_cvt_pk_bf16_f32 v178, v206, v207
    v_cvt_pk_bf16_f32 v179, v208, v209
    v_mfma_f32_16x16x32_bf16 v[158:161], v[134:137], a[216:219], 0
    v_cvt_pk_bf16_f32 v36, v242, v243
    v_add_u32 v6, 272, v6
    v_mfma_f32_16x16x32_bf16 v[158:161], v[134:137], a[240:243], v[158:161]
    v_exp_f32 v244, v244
    v_mfma_f32_16x16x32_bf16 v[158:161], v[134:137], v[90:93], v[158:161]
    v_exp_f32 v245, v245
    v_mfma_f32_16x16x32_f16 v[186:189], v[118:121], v[182:185], v[58:61]
    v_cvt_pk_bf16_f32 v37, v244, v245
    v_mov_b32_dpp v254, v199 quad_perm:[0,1,2,3] row_mask:0x4 bank_mask:0xf
    v_mfma_f32_16x16x32_f16 v[202:205], v[170:173], v[182:185], v[62:65]
    s_waitcnt lgkmcnt(1)
    v_exp_f32 v198, v198
    v_mfma_f32_16x16x32_f16 v[206:209], v[146:149], v[182:185], v[66:69]
    s_waitcnt lgkmcnt(0)
    v_mov_b32 v122, v158
    v_exp_f32 v234, v234
    v_mfma_f32_16x16x16_f16 v[186:189], v[196:197], v[174:175], v[186:189]
    v_mov_b32_dpp v122, v159 quad_perm:[0,1,2,3] row_mask:0x2 bank_mask:0xf
    v_exp_f32 v254, v254
    v_mfma_f32_16x16x16_f16 v[202:205], v[176:177], v[174:175], v[202:205]
    v_cvt_pk_bf16_f32 v254, v254, v254
    v_mfma_f32_16x16x16_f16 v[206:209], v[164:165], v[174:175], v[206:209]
    ds_write_b16 v8, v254
    v_mfma_f32_16x16x32_bf16 v[158:161], v[28:31], v[36:39], 0
    v_mfma_f32_16x16x32_bf16 v[158:161], v[28:31], v[142:145], v[158:161]
    v_exp_f32 v186, v186
    v_mfma_f32_16x16x32_f16 v[182:185], v[118:121], v[150:153], v[70:73]
    v_exp_f32 v187, v187
    v_mfma_f32_16x16x32_bf16 v[118:121], v[154:157], v[36:39], 0
    v_exp_f32 v188, v188
    v_mfma_f32_16x16x32_f16 v[210:213], v[170:173], v[150:153], v[74:77]
    v_exp_f32 v189, v189
    v_mfma_f32_16x16x32_bf16 v[118:121], v[130:133], v[142:145], v[118:121]
    v_cvt_pk_bf16_f32 v170, v186, v187
    v_exp_f32 v202, v202
    v_mfma_f32_16x16x32_f16 v[214:217], v[146:149], v[150:153], v[78:81]
    v_cvt_pk_bf16_f32 v171, v188, v189
    v_exp_f32 v203, v203
    v_mfma_f32_16x16x16_f16 v[182:185], v[196:197], v[162:163], v[182:185]
    v_cvt_pk_bf16_f32 v172, v202, v203
    v_exp_f32 v204, v204
    v_mfma_f32_16x16x16_f16 v[210:213], v[176:177], v[162:163], v[210:213]
    v_exp_f32 v205, v205
    v_mfma_f32_16x16x16_f16 v[214:217], v[164:165], v[162:163], v[214:217]
    v_cvt_pk_bf16_f32 v173, v204, v205
    v_exp_f32 v206, v206
    v_mfma_f32_16x16x32_bf16 v[146:149], v[166:169], v[36:39], 0
    v_exp_f32 v182, v182
    v_mfma_f32_16x16x32_bf16 v[146:149], v[114:117], v[142:145], v[146:149]
    v_exp_f32 v183, v183
    v_mfma_f32_16x16x32_bf16 v[150:153], v[178:181], v[36:39], 0
    v_cvt_pk_bf16_f32 v162, v182, v183
    v_cvt_pk_bf16_f32 v39, v234, 0
    v_mfma_f32_16x16x32_bf16 v[150:153], v[138:141], v[142:145], v[150:153]
    v_exp_f32 v184, v184
    v_mfma_f32_16x16x32_bf16 v[142:145], v[134:137], a[220:223], 0
    v_exp_f32 v185, v185
    v_mfma_f32_16x16x32_bf16 v[142:145], v[134:137], a[244:247], v[142:145]
    v_exp_f32 v210, v210
    v_mfma_f32_16x16x32_bf16 v[142:145], v[134:137], v[94:97], v[142:145]
    v_exp_f32 v211, v211
    v_mfma_f32_16x16x32_bf16 v[174:177], v[134:137], a[232:235], 0
    v_cvt_pk_bf16_f32 v163, v184, v185
    v_cvt_pk_bf16_f32 v164, v210, v211
    v_mfma_f32_16x16x32_bf16 v[174:177], v[134:137], v[82:85], v[174:177]
    v_exp_f32 v212, v212
    v_mfma_f32_16x16x32_bf16 v[174:177], v[134:137], v[106:109], v[174:177]
    v_exp_f32 v213, v213
    v_mfma_f32_16x16x32_bf16 v[182:185], v[134:137], a[224:227], 0
    v_mov_b32 v254, v143
    v_cvt_pk_bf16_f32 v165, v212, v213
    v_mfma_f32_16x16x32_bf16 v[182:185], v[134:137], a[248:251], v[182:185]
    v_exp_f32 v214, v214
    v_mfma_f32_16x16x32_bf16 v[182:185], v[134:137], v[98:101], v[182:185]
    v_exp_f32 v215, v215
    v_mfma_f32_16x16x32_bf16 v[186:189], v[134:137], a[228:231], 0
    v_mov_b32_dpp v122, v174 quad_perm:[0,1,2,3] row_mask:0x4 bank_mask:0xf
    v_mov_b32_dpp v122, v142 quad_perm:[0,1,2,3] row_mask:0x8 bank_mask:0xf
    v_mfma_f32_16x16x32_bf16 v[186:189], v[134:137], a[252:255], v[186:189]
    ds_write_b32 v124, v122 offset:0
    v_mfma_f32_16x16x32_bf16 v[186:189], v[134:137], v[102:105], v[186:189]
    v_exp_f32 v216, v216
    v_mfma_f32_16x16x32_bf16 v[142:145], v[134:137], a[236:239], 0
    v_exp_f32 v217, v217
    v_mfma_f32_16x16x32_bf16 v[142:145], v[134:137], v[86:89], v[142:145]
    ds_read_b128 v[194:197], v9
    ds_read_b128 v[202:205], v9 offset:64
    v_mfma_f32_16x16x32_bf16 v[142:145], v[134:137], v[110:113], v[142:145]
    v_mov_b32_dpp v254, v175 quad_perm:[0,1,2,3] row_mask:0x2 bank_mask:0xf
    v_mov_b32_dpp v254, v182 quad_perm:[0,1,2,3] row_mask:0x4 bank_mask:0xf
    v_mov_b32_dpp v254, v183 quad_perm:[0,1,2,3] row_mask:0x8 bank_mask:0xf
    v_exp_f32 v207, v207
    v_exp_f32 v208, v208
    v_cvt_pk_bf16_f32 v36, v206, v207
    v_exp_f32 v209, v209
    v_rcp_f32 v158, v158
    v_mov_b32 v122, v142
    v_mov_b32_dpp v122, v186 quad_perm:[0,1,2,3] row_mask:0x2 bank_mask:0xf
    v_mov_b32_dpp v122, v187 quad_perm:[0,1,2,3] row_mask:0x4 bank_mask:0xf
    v_mov_b32_dpp v122, v143 quad_perm:[0,1,2,3] row_mask:0x8 bank_mask:0xf
    v_cvt_pk_bf16_f32 v37, v208, v209
    v_mul_f32 v118, v158, v118
    v_mul_f32 v119, v158, v119
    v_mfma_f32_16x16x32_bf16 v[134:137], v[28:31], v[36:39], 0
    ds_write_b32 v124, v254 offset:1024
    v_mfma_f32_16x16x32_bf16 v[134:137], v[28:31], v[170:173], v[134:137]
    s_waitcnt lgkmcnt(2)
    v_cvt_pk_bf16_f32 v118, v118, v119
    v_mul_f32 v120, v158, v120
    v_mfma_f32_16x16x32_bf16 v[142:145], v[154:157], v[36:39], 0
    s_waitcnt lgkmcnt(1)
    ds_write_b32 v124, v122 offset:2048
    v_mfma_f32_16x16x32_bf16 v[142:145], v[130:133], v[170:173], v[142:145]
    v_mul_f32 v121, v158, v121
    v_cvt_pk_bf16_f32 v119, v120, v121
    v_mfma_f32_16x16x32_bf16 v[186:189], v[166:169], v[36:39], 0
    v_mul_f32 v146, v158, v146
    v_mul_f32 v147, v158, v147
    v_mfma_f32_16x16x32_bf16 v[186:189], v[114:117], v[170:173], v[186:189]
    v_cvt_pk_bf16_f32 v120, v146, v147
    v_mul_f32 v148, v158, v148
    v_mfma_f32_16x16x32_bf16 v[238:241], v[178:181], v[36:39], 0
    v_cvt_pk_bf16_f32 v36, v214, v215
    v_cvt_pk_bf16_f32 v37, v216, v217
    v_mfma_f32_16x16x32_bf16 v[238:241], v[138:141], v[170:173], v[238:241]
    v_cvt_pk_bf16_f32 v39, v198, 0
    v_mul_f32 v149, v158, v149
    v_mfma_f32_16x16x32_bf16 v[170:173], v[194:197], v[28:31], 0
    v_cvt_pk_bf16_f32 v121, v148, v149
    v_mul_f32 v150, v158, v150
    v_mfma_f32_16x16x32_bf16 v[146:149], v[28:31], v[36:39], 0
    v_mul_f32 v151, v158, v151
    v_cvt_pk_bf16_f32 v254, v150, v151
    v_mfma_f32_16x16x32_bf16 v[146:149], v[28:31], v[162:165], v[146:149]
    s_waitcnt lgkmcnt(0)
    v_mul_f32 v152, v158, v152
    v_mul_f32 v153, v158, v153
    v_mfma_f32_16x16x32_bf16 v[158:161], v[154:157], v[36:39], 0
    s_barrier
    ds_read_b128 v[174:177], v255 offset:0
    ds_read_b128 v[206:209], v255 offset:1024
    v_mfma_f32_16x16x32_bf16 v[158:161], v[130:133], v[162:165], v[158:161]
    ds_read_b128 v[214:217], v255 offset:2048
    v_cvt_pk_bf16_f32 v255, v152, v153
    v_mfma_f32_16x16x32_bf16 v[150:153], v[166:169], v[36:39], 0
    ds_write_b128 v3, v[118:121] offset:0
    v_mfma_f32_16x16x32_bf16 v[150:153], v[114:117], v[162:165], v[150:153]
    v_rcp_f32 v146, v146
    s_waitcnt vmcnt(0)
    v_mfma_f32_16x16x32_bf16 v[118:121], v[178:181], v[36:39], 0
    s_barrier
    buffer_load_dwordx4 v10, s[8:11], 0 offen nt lds
    v_mul_f32 v158, v146, v158
    v_mfma_f32_16x16x32_bf16 v[118:121], v[138:141], v[162:165], v[118:121]
    s_add_u32 m0, s28, 4096
    ds_read_b128 v[182:185], v0 offset:20480
    ds_read_b128 v[198:201], v1 offset:20480
    v_mfma_f32_16x16x32_bf16 v[170:173], v[202:205], v[28:31], v[170:173]
    ds_read_b128 v[210:213], v0 offset:20608
    ds_read_b128 v[222:225], v1 offset:20608
    v_mfma_f32_16x16x32_bf16 v[162:165], v[194:197], v[130:133], 0
    s_waitcnt lgkmcnt(6)
    v_add_f32 v174, v174, v175
    v_add_f32 v176, v176, v177
    v_mfma_f32_16x16x32_bf16 v[162:165], v[202:205], v[154:157], v[162:165]
    s_waitcnt lgkmcnt(5)
    ds_read_b128 v[226:229], v0 offset:20736
    ds_read_b128 v[242:245], v1 offset:20736
    v_mfma_f32_16x16x32_bf16 v[130:133], v[194:197], v[114:117], 0
    buffer_load_dwordx4 v11, s[8:11], 0 offen nt lds
    v_add_f32 v174, v174, v176
    v_mfma_f32_16x16x32_bf16 v[130:133], v[202:205], v[166:169], v[130:133]
    s_add_u32 m0, s28, 8192
    ds_write_b64 v4, v[254:255] offset:4096
    v_mfma_f32_16x16x32_bf16 v[114:117], v[194:197], v[138:141], 0
    v_mul_f32 v174, 0xbbaaaaab, v174
    v_add_f32 v206, v206, v207
    v_mfma_f32_16x16x32_bf16 v[114:117], v[202:205], v[178:181], v[114:117]
    s_waitcnt lgkmcnt(6)
    ds_write_b32 v127, v174 offset:0
    v_mfma_f32_16x16x32_bf16 v[154:157], a[72:75], v[182:185], 0
    s_waitcnt lgkmcnt(5)
    buffer_load_dwordx4 v12, s[8:11], 0 offen nt lds
    v_add_f32 v208, v208, v209
    v_mfma_f32_16x16x32_bf16 v[154:157], a[76:79], v[198:201], v[154:157]
    s_add_u32 m0, s28, 12288
    ds_read_b128 v[138:141], v123 offset:0
    ds_read_b128 v[166:169], v123 offset:64
    v_mfma_f32_16x16x32_bf16 v[154:157], a[80:83], v[210:213], v[154:157]
    s_waitcnt lgkmcnt(5)
    ds_read_b128 v[174:177], v123 offset:128
    v_add_f32 v206, v206, v208
    v_mfma_f32_16x16x32_bf16 v[154:157], a[84:87], v[222:225], v[154:157]
    s_xor_b32 s28, s28, 65536
    v_mul_f32 v206, 0xbbaaaaab, v206
    v_add_f32 v214, v214, v215
    v_mfma_f32_16x16x32_bf16 v[154:157], a[88:91], v[226:229], v[154:157]
    s_waitcnt lgkmcnt(4)
    buffer_load_dwordx4 v13, s[8:11], 0 offen nt lds
    v_add_f32 v216, v216, v217
    v_mfma_f32_16x16x32_bf16 v[154:157], a[92:95], v[242:245], v[154:157]
    s_mov_b32 m0, s29
    ds_write_b32 v127, v206 offset:256
    v_mfma_f32_16x16x32_bf16 v[230:233], a[96:99], v[182:185], 0
    s_xor_b32 s29, s29, s30
    v_add_f32 v214, v214, v216
    v_mul_f32 v214, 0xbbaaaaab, v214
    v_mfma_f32_16x16x32_bf16 v[230:233], a[100:103], v[198:201], v[230:233]
    ds_write_b32 v127, v214 offset:512
    v_mfma_f32_16x16x32_bf16 v[230:233], a[104:107], v[210:213], v[230:233]
    buffer_load_dwordx4 v14, s[8:11], 0 offen nt lds
    v_mul_f32 v159, v146, v159
    v_mfma_f32_16x16x32_bf16 v[230:233], a[108:111], v[222:225], v[230:233]
    s_waitcnt lgkmcnt(3)
    v_rcp_f32 v170, v170
    v_cvt_pk_bf16_f32 v126, v158, v159
    v_mfma_f32_16x16x16_bf16 v[178:181], a[216:217], v[190:191], v[138:141]
    v_mul_f32 v162, v162, v170
    v_mul_f32_dpp v162, v130, v170 quad_perm:[0,1,2,3] row_mask:0x2 bank_mask:0xf
    v_mul_f32_dpp v162, v114, v170 quad_perm:[0,1,2,3] row_mask:0x4 bank_mask:0xf
    v_mfma_f32_16x16x16_bf16 v[114:117], a[240:241], v[190:191], v[138:141]
    v_cvt_pk_bf16_f32 v162, v162, v162
    v_mul_f32 v160, v146, v160
    v_mul_f32 v161, v146, v161
    v_mfma_f32_16x16x16_bf16 v[130:133], v[90:91], v[190:191], v[138:141]
    v_cvt_pk_bf16_f32 v178, v178, v179
    v_accvgpr_write_b32 a216, v178
    v_cvt_pk_bf16_f32 v180, v180, v181
    v_mfma_f32_16x16x16_bf16 v[170:173], a[218:219], v[190:191], v[166:169]
    v_accvgpr_write_b32 a217, v180
    v_cvt_pk_bf16_f32 v114, v114, v115
    v_accvgpr_write_b32 a240, v114
    v_mfma_f32_16x16x16_bf16 v[138:141], a[242:243], v[190:191], v[166:169]
    v_cvt_pk_bf16_f32 v116, v116, v117
    v_accvgpr_write_b32 a241, v116
    v_cvt_pk_bf16_f32 v90, v130, v131
    v_mfma_f32_16x16x16_bf16 v[114:117], v[92:93], v[190:191], v[166:169]
    v_cvt_pk_bf16_f32 v91, v132, v133
    v_cvt_pk_bf16_f32 v170, v170, v171
    v_accvgpr_write_b32 a218, v170
    v_cvt_pk_bf16_f32 v172, v172, v173
    v_mfma_f32_16x16x32_bf16 v[230:233], a[112:115], v[226:229], v[230:233]
    s_waitcnt lgkmcnt(0)
    ds_read_b128 v[130:133], v123 offset:192
    ds_write_b16 v7, v162
    v_mfma_f32_16x16x16_bf16 v[162:165], a[232:233], v[190:191], v[174:177]
    v_accvgpr_write_b32 a219, v172
    v_cvt_pk_bf16_f32 v138, v138, v139
    v_accvgpr_write_b32 a242, v138
    v_mfma_f32_16x16x16_bf16 v[166:169], v[82:83], v[190:191], v[174:177]
    v_cvt_pk_bf16_f32 v140, v140, v141
    v_accvgpr_write_b32 a243, v140
    v_cvt_pk_bf16_f32 v92, v114, v115
    v_mfma_f32_16x16x16_bf16 v[138:141], v[106:107], v[190:191], v[174:177]
    v_cvt_pk_bf16_f32 v93, v116, v117
    v_cvt_pk_bf16_f32 v162, v162, v163
    v_accvgpr_write_b32 a232, v162
    v_cvt_pk_bf16_f32 v164, v164, v165
    v_mfma_f32_16x16x32_bf16 v[230:233], a[116:119], v[242:245], v[230:233]
    ds_read_b128 v[114:117], v123 offset:256
    v_accvgpr_write_b32 a233, v164
    v_mfma_f32_16x16x32_bf16 v[234:237], a[120:123], v[182:185], 0
    v_cvt_pk_bf16_f32 v82, v166, v167
    v_cvt_pk_bf16_f32 v83, v168, v169
    v_mfma_f32_16x16x32_bf16 v[234:237], a[124:127], v[198:201], v[234:237]
    v_cvt_pk_bf16_f32 v106, v138, v139
    v_cvt_pk_bf16_f32 v107, v140, v141
    v_mfma_f32_16x16x32_bf16 v[234:237], a[128:131], v[210:213], v[234:237]
    s_waitcnt lgkmcnt(1)
    ds_read_b128 v[138:141], v123 offset:320
    v_cvt_pk_bf16_f32 v127, v160, v161
    v_mul_f32 v150, v146, v150
    v_mfma_f32_16x16x16_bf16 v[158:161], a[220:221], v[190:191], v[130:133]
    v_mul_f32 v151, v146, v151
    v_cvt_pk_bf16_f32 v128, v150, v151
    v_mul_f32 v152, v146, v152
    v_mfma_f32_16x16x16_bf16 v[162:165], a[244:245], v[190:191], v[130:133]
    v_mul_f32 v153, v146, v153
    v_cvt_pk_bf16_f32 v129, v152, v153
    v_mul_f32 v118, v146, v118
    v_mfma_f32_16x16x16_bf16 v[150:153], v[94:95], v[190:191], v[130:133]
    v_cvt_pk_bf16_f32 v158, v158, v159
    v_accvgpr_write_b32 a220, v158
    v_cvt_pk_bf16_f32 v160, v160, v161
    v_accvgpr_write_b32 a221, v160
    v_mfma_f32_16x16x32_bf16 v[234:237], a[132:135], v[222:225], v[234:237]
    s_waitcnt lgkmcnt(1)
    ds_write_b128 v3, v[126:129] offset:12288
    v_mfma_f32_16x16x16_bf16 v[126:129], a[222:223], v[190:191], v[114:117]
    v_cvt_pk_bf16_f32 v162, v162, v163
    v_accvgpr_write_b32 a244, v162
    v_cvt_pk_bf16_f32 v164, v164, v165
    v_mfma_f32_16x16x16_bf16 v[130:133], a[246:247], v[190:191], v[114:117]
    v_accvgpr_write_b32 a245, v164
    v_cvt_pk_bf16_f32 v94, v150, v151
    v_cvt_pk_bf16_f32 v95, v152, v153
    v_mfma_f32_16x16x16_bf16 v[150:153], v[96:97], v[190:191], v[114:117]
    v_cvt_pk_bf16_f32 v126, v126, v127
    v_accvgpr_write_b32 a222, v126
    v_cvt_pk_bf16_f32 v128, v128, v129
    v_accvgpr_write_b32 a223, v128
    v_mfma_f32_16x16x32_bf16 v[234:237], a[136:139], v[226:229], v[234:237]
    s_waitcnt lgkmcnt(1)
    ds_read_b128 v[114:117], v123 offset:384
    v_cvt_pk_bf16_f32 v130, v130, v131
    v_accvgpr_write_b32 a246, v130
    v_mfma_f32_16x16x16_bf16 v[126:129], a[234:235], v[190:191], v[138:141]
    v_cvt_pk_bf16_f32 v132, v132, v133
    v_accvgpr_write_b32 a247, v132
    v_cvt_pk_bf16_f32 v96, v150, v151
    v_mfma_f32_16x16x16_bf16 v[130:133], v[84:85], v[190:191], v[138:141]
    v_cvt_pk_bf16_f32 v97, v152, v153
    v_mul_f32 v119, v146, v119
    v_cvt_pk_bf16_f32 v192, v118, v119
    v_mfma_f32_16x16x16_bf16 v[150:153], v[108:109], v[190:191], v[138:141]
    v_cvt_pk_bf16_f32 v126, v126, v127
    v_accvgpr_write_b32 a234, v126
    v_cvt_pk_bf16_f32 v128, v128, v129
    v_accvgpr_write_b32 a235, v128
    v_mfma_f32_16x16x32_bf16 v[234:237], a[140:143], v[242:245], v[234:237]
    ds_read_b128 v[126:129], v123 offset:448
    v_cvt_pk_bf16_f32 v84, v130, v131
    v_mfma_f32_16x16x32_bf16 v[206:209], a[0:3], v[182:185], 0
    v_cvt_pk_bf16_f32 v85, v132, v133
    v_cvt_pk_bf16_f32 v108, v150, v151
    v_mfma_f32_16x16x32_bf16 v[206:209], a[4:7], v[198:201], v[206:209]
    v_cvt_pk_bf16_f32 v109, v152, v153
    v_mul_f32 v120, v146, v120
    v_mfma_f32_16x16x32_bf16 v[206:209], a[8:11], v[210:213], v[206:209]
    s_waitcnt lgkmcnt(1)
    ds_read_b128 v[130:133], v123 offset:512
    v_mul_f32 v121, v146, v121
    v_cvt_pk_bf16_f32 v193, v120, v121
    v_mfma_f32_16x16x16_bf16 v[138:141], a[224:225], v[190:191], v[114:117]
    v_rcp_f32 v134, v134
    v_cvt_pk_f16_f32 v118, v154, v155
    v_mfma_f32_16x16x16_bf16 v[146:149], a[248:249], v[190:191], v[114:117]
    v_mul_f32 v142, v134, v142
    v_mul_f32 v143, v134, v143
    v_cvt_pk_bf16_f32 v142, v142, v143
    v_mfma_f32_16x16x16_bf16 v[150:153], v[98:99], v[190:191], v[114:117]
    v_mul_f32 v144, v134, v144
    v_cvt_pk_bf16_f32 v138, v138, v139
    v_accvgpr_write_b32 a224, v138
    v_cvt_pk_bf16_f32 v140, v140, v141
    v_mfma_f32_16x16x32_bf16 v[206:209], a[12:15], v[222:225], v[206:209]
    s_waitcnt lgkmcnt(1)
    ds_write_b64 v4, v[192:193] offset:16384
    v_mfma_f32_16x16x16_bf16 v[114:117], a[226:227], v[190:191], v[126:129]
    v_accvgpr_write_b32 a225, v140
    v_cvt_pk_bf16_f32 v146, v146, v147
    v_accvgpr_write_b32 a248, v146
    v_mfma_f32_16x16x16_bf16 v[138:141], a[250:251], v[190:191], v[126:129]
    v_cvt_pk_bf16_f32 v148, v148, v149
    v_accvgpr_write_b32 a249, v148
    v_cvt_pk_bf16_f32 v98, v150, v151
    v_mfma_f32_16x16x16_bf16 v[146:149], v[100:101], v[190:191], v[126:129]
    v_cvt_pk_bf16_f32 v99, v152, v153
    v_cvt_pk_bf16_f32 v114, v114, v115
    v_accvgpr_write_b32 a226, v114
    v_cvt_pk_bf16_f32 v116, v116, v117
    v_mfma_f32_16x16x32_bf16 v[206:209], a[16:19], v[226:229], v[206:209]
    s_waitcnt lgkmcnt(1)
    ds_read_b128 v[126:129], v123 offset:576
    v_accvgpr_write_b32 a227, v116
    v_cvt_pk_bf16_f32 v138, v138, v139
    v_mfma_f32_16x16x16_bf16 v[114:117], a[236:237], v[190:191], v[130:133]
    v_accvgpr_write_b32 a250, v138
    v_cvt_pk_bf16_f32 v140, v140, v141
    v_accvgpr_write_b32 a251, v140
    v_mfma_f32_16x16x16_bf16 v[138:141], v[86:87], v[190:191], v[130:133]
    v_cvt_pk_bf16_f32 v100, v146, v147
    v_cvt_pk_bf16_f32 v101, v148, v149
    v_mul_f32 v145, v134, v145
    v_mfma_f32_16x16x16_bf16 v[146:149], v[110:111], v[190:191], v[130:133]
    v_cvt_pk_bf16_f32 v114, v114, v115
    v_accvgpr_write_b32 a236, v114
    v_cvt_pk_bf16_f32 v116, v116, v117
    v_accvgpr_write_b32 a237, v116
    v_mfma_f32_16x16x32_bf16 v[206:209], a[20:23], v[242:245], v[206:209]
    ds_read_b128 v[114:117], v123 offset:640
    v_cvt_pk_bf16_f32 v86, v138, v139
    v_mfma_f32_16x16x32_bf16 v[174:177], a[24:27], v[182:185], 0
    v_cvt_pk_bf16_f32 v87, v140, v141
    v_cvt_pk_bf16_f32 v110, v146, v147
    v_mfma_f32_16x16x32_bf16 v[174:177], a[28:31], v[198:201], v[174:177]
    v_cvt_pk_bf16_f32 v111, v148, v149
    v_cvt_pk_bf16_f32 v143, v144, v145
    v_mfma_f32_16x16x32_bf16 v[174:177], a[32:35], v[210:213], v[174:177]
    s_waitcnt lgkmcnt(1)
    ds_read_b128 v[130:133], v123 offset:704
    v_mul_f32 v186, v134, v186
    v_mul_f32 v187, v134, v187
    v_mfma_f32_16x16x16_bf16 v[122:125], a[228:229], v[190:191], v[126:129]
    v_cvt_pk_bf16_f32 v144, v186, v187
    v_mul_f32 v188, v134, v188
    v_mul_f32 v189, v134, v189
    v_mfma_f32_16x16x16_bf16 v[138:141], a[252:253], v[190:191], v[126:129]
    v_cvt_pk_bf16_f32 v145, v188, v189
    v_mul_f32 v238, v134, v238
    v_mul_f32 v239, v134, v239
    v_mfma_f32_16x16x16_bf16 v[146:149], v[102:103], v[190:191], v[126:129]
    v_cvt_pk_bf16_f32 v122, v122, v123
    v_accvgpr_write_b32 a228, v122
    v_cvt_pk_bf16_f32 v124, v124, v125
    v_accvgpr_write_b32 a229, v124
    v_mfma_f32_16x16x32_bf16 v[174:177], a[36:39], v[222:225], v[174:177]
    s_waitcnt lgkmcnt(1)
    ds_write_b128 v3, v[142:145] offset:6144
    v_mfma_f32_16x16x16_bf16 v[122:125], a[230:231], v[190:191], v[114:117]
    v_cvt_pk_bf16_f32 v138, v138, v139
    v_accvgpr_write_b32 a252, v138
    v_cvt_pk_bf16_f32 v140, v140, v141
    v_mfma_f32_16x16x16_bf16 v[126:129], a[254:255], v[190:191], v[114:117]
    v_accvgpr_write_b32 a253, v140
    v_cvt_pk_bf16_f32 v102, v146, v147
    v_cvt_pk_bf16_f32 v103, v148, v149
    v_mfma_f32_16x16x16_bf16 v[138:141], v[104:105], v[190:191], v[114:117]
    v_cvt_pk_bf16_f32 v122, v122, v123
    v_accvgpr_write_b32 a230, v122
    v_cvt_pk_bf16_f32 v124, v124, v125
    v_accvgpr_write_b32 a231, v124
    v_mfma_f32_16x16x32_bf16 v[174:177], a[40:43], v[226:229], v[174:177]
    s_waitcnt lgkmcnt(1)
    v_cvt_pk_bf16_f32 v126, v126, v127
    v_accvgpr_write_b32 a254, v126
    v_cvt_pk_bf16_f32 v128, v128, v129
    v_mfma_f32_16x16x16_bf16 v[114:117], a[238:239], v[190:191], v[130:133]
    v_accvgpr_write_b32 a255, v128
    v_cvt_pk_bf16_f32 v104, v138, v139
    v_cvt_pk_bf16_f32 v105, v140, v141
    v_mfma_f32_16x16x16_bf16 v[122:125], v[88:89], v[190:191], v[130:133]
    v_cvt_pk_bf16_f32 v154, v238, v239
    v_mul_f32 v240, v134, v240
    v_mul_f32 v241, v134, v241
    v_mfma_f32_16x16x16_bf16 v[126:129], v[112:113], v[190:191], v[130:133]
    v_cvt_pk_bf16_f32 v114, v114, v115
    v_accvgpr_write_b32 a238, v114
    v_cvt_pk_bf16_f32 v116, v116, v117
    v_accvgpr_write_b32 a239, v116
    v_mfma_f32_16x16x32_bf16 v[174:177], a[44:47], v[242:245], v[174:177]
    v_cvt_pk_bf16_f32 v88, v122, v123
    v_cvt_pk_bf16_f32 v89, v124, v125
    v_mfma_f32_16x16x32_bf16 v[218:221], a[48:51], v[182:185], 0
    v_cvt_pk_bf16_f32 v112, v126, v127
    v_cvt_pk_bf16_f32 v113, v128, v129
    v_mfma_f32_16x16x32_bf16 v[218:221], a[52:55], v[198:201], v[218:221]
    v_cvt_pk_bf16_f32 v155, v240, v241
    v_pk_mul_f16 v163, v118, v118
    v_mfma_f32_16x16x32_bf16 v[218:221], a[56:59], v[210:213], v[218:221]
    ds_write_b64 v4, v[154:155] offset:10240
    v_mfma_f32_16x16x32_bf16 v[218:221], a[60:63], v[222:225], v[218:221]
    v_cvt_pk_f16_f32 v119, v156, v157
    v_pk_mul_f16 v165, v119, v119
    v_mfma_f32_16x16x32_bf16 v[218:221], a[64:67], v[226:229], v[218:221]
    v_cvt_pk_f16_f32 v120, v230, v231
    v_pk_fma_f16 v163, v120, v120, v163
    v_mfma_f32_16x16x32_bf16 v[218:221], a[68:71], v[242:245], v[218:221]
    v_cvt_pk_f16_f32 v121, v232, v233
    v_pk_fma_f16 v165, v121, v121, v165
    v_mfma_f32_16x16x32_bf16 v[170:173], v[182:185], a[144:147], 0
    v_cvt_pk_f16_f32 v196, v234, v235
    v_pk_fma_f16 v163, v196, v196, v163
    v_mfma_f32_16x16x32_bf16 v[170:173], v[198:201], a[148:151], v[170:173]
    v_cvt_pk_f16_f32 v197, v236, v237
    v_pk_fma_f16 v165, v197, v197, v165
    v_mfma_f32_16x16x32_bf16 v[170:173], v[210:213], a[152:155], v[170:173]
    v_cvt_pk_f16_f32 v206, v206, v207
    v_add_u32 v7, 16, v7
    v_mfma_f32_16x16x32_bf16 v[170:173], v[222:225], a[156:159], v[170:173]
    s_waitcnt lgkmcnt(0)
    v_xor_b32 v3, 65536, v3
    v_xor_b32 v4, 65536, v4
    v_mfma_f32_16x16x32_bf16 v[170:173], v[226:229], a[160:163], v[170:173]
    s_barrier
    v_mfma_f32_16x16x32_bf16 v[170:173], v[242:245], a[164:167], v[170:173]
L_go:
    s_waitcnt lgkmcnt(0)
    s_cmp_eq_u32 s16, 1
    s_cbranch_scc1 L_loop_fast1
    s_cmp_eq_u32 s16, 2
    s_cbranch_scc1 L_loop_fast2
    s_cmp_eq_u32 s16, 3
    s_cbranch_scc1 L_loop_fast3
    s_branch L_loop_fast0
.p2align 6
L_loop_fast0:
    v_mfma_f32_16x16x32_bf16 v[234:237], v[182:185], a[168:171], 0
    s_add_u32 s12, s42, s27
    ds_read_b128 v[230:233], v2 offset:18432
    ds_read_b128 v[238:241], v2 offset:19456
    v_mfma_f32_16x16x32_bf16 v[234:237], v[198:201], a[172:175], v[234:237]
    s_addc_u32 s13, s43, 0
    v_pk_mul_f16 v162, v206, v206
    v_cvt_pk_f16_f32 v207, v208, v209
    v_mfma_f32_16x16x32_bf16 v[234:237], v[210:213], a[176:179], v[234:237]
    s_sub_u32 s14, s36, s27
    ds_read_b128 v[134:137], v0 offset:26624
    v_pk_mul_f16 v164, v207, v207
    v_mfma_f32_16x16x32_bf16 v[234:237], v[222:225], a[180:183], v[234:237]
    s_cmp_ge_u32 s18, 2
    ds_read_b128 v[154:157], v1 offset:26624
    v_cvt_pk_f16_f32 v208, v174, v175
    v_mfma_f32_16x16x32_bf16 v[234:237], v[226:229], a[184:187], v[234:237]
    s_cselect_b32 s14, s14, 0
    ds_read_b128 v[130:133], v0 offset:26752
    v_pk_fma_f16 v162, v208, v208, v162
    v_mfma_f32_16x16x32_bf16 v[234:237], v[242:245], a[188:191], v[234:237]
    s_add_u32 s34, s18, 2
    ds_read_b128 v[122:125], v1 offset:26752
    v_cvt_pk_f16_f32 v209, v176, v177
    v_mfma_f32_16x16x32_bf16 v[114:117], v[182:185], a[192:195], 0
    s_add_u32 s8, s40, s23
    ds_read_b128 v[126:129], v0 offset:26880
    v_pk_fma_f16 v164, v209, v209, v164
    v_mfma_f32_16x16x32_bf16 v[114:117], v[198:201], a[196:199], v[114:117]
    s_addc_u32 s9, s41, 0
    ds_read_b128 v[166:169], v1 offset:26880
    v_cvt_pk_f16_f32 v194, v218, v219
    v_mfma_f32_16x16x32_bf16 v[114:117], v[210:213], a[200:203], v[114:117]
    s_waitcnt lgkmcnt(6)
    v_pk_fma_f16 v162, v194, v194, v162
    v_cvt_pk_f16_f32 v195, v220, v221
    v_mfma_f32_16x16x32_bf16 v[198:201], v[32:35], v[230:233], 0
    s_sub_u32 s10, s36, s23
    v_pk_fma_f16 v164, v195, v195, v164
    v_cvt_pk_bf16_f32 v174, v170, v171
    v_mfma_f32_16x16x32_bf16 v[198:201], v[32:35], v[238:241], v[198:201]
    s_waitcnt lgkmcnt(5)
    v_cvt_pk_bf16_f32 v175, v172, v173
    v_cvt_pk_bf16_f32 v182, v234, v235
    v_mfma_f32_16x16x32_f16 v[170:173], v[40:43], v[162:165], 0
    s_cmp_lt_u32 s34, s17
    v_cvt_pk_bf16_f32 v183, v236, v237
    s_cselect_b32 s10, s10, 0
    v_mfma_f32_16x16x32_bf16 v[114:117], v[222:225], a[204:207], v[114:117]
    s_add_u32 m0, s28, 0
    v_mul_f32 v255, 0x3baaaaab, v198
    v_mul_f32 v254, 0x3baaaaab, v199
    v_mfma_f32_16x16x32_bf16 v[114:117], v[226:229], a[208:211], v[114:117]
    s_mov_b32 s27, s26
    v_rsq_f32 v172, v170
    v_mfma_f32_16x16x32_bf16 v[114:117], v[242:245], a[212:215], v[114:117]
    s_mov_b32 s26, s25
    v_rsq_f32 v173, v171
    v_mfma_f32_16x16x32_bf16 v[162:165], a[72:75], v[134:137], 0
    s_waitcnt lgkmcnt(0)
    v_mul_f32 v172, s31, v172
    v_cvt_pk_f16_f32 v172, v172, v173
    v_mfma_f32_16x16x32_bf16 v[162:165], a[76:79], v[154:157], v[162:165]
    s_mov_b32 s25, s24
    v_cvt_pk_bf16_f32 v114, v114, v115
    v_cvt_pk_bf16_f32 v115, v116, v117
    v_mfma_f32_16x16x32_bf16 v[162:165], a[80:83], v[130:133], v[162:165]
    s_mov_b32 s24, s23
    v_pk_mul_f16 v118, v118, v172 op_sel:[0,1] op_sel_hi:[1,1]
    v_pk_mul_f16 v119, v119, v172 op_sel:[0,1] op_sel_hi:[1,1]
    v_mfma_f32_16x16x32_bf16 v[162:165], a[84:87], v[122:125], v[162:165]
    v_pk_mul_f16 v120, v120, v172 op_sel:[0,1] op_sel_hi:[1,1]
    v_pk_mul_f16 v121, v121, v172 op_sel:[0,1] op_sel_hi:[1,1]
    v_mfma_f32_16x16x32_bf16 v[162:165], a[88:91], v[126:129], v[162:165]
    v_pk_mul_f16 v196, v196, v172 op_sel:[0,1] op_sel_hi:[1,1]
    v_pk_mul_f16 v197, v197, v172 op_sel:[0,1] op_sel_hi:[1,1]
    v_mfma_f32_16x16x32_bf16 v[162:165], a[92:95], v[166:169], v[162:165]
    v_pk_mul_f16 v206, v206, v172 op_sel:[0,0] op_sel_hi:[1,0]
    v_pk_mul_f16 v207, v207, v172 op_sel:[0,0] op_sel_hi:[1,0]
    v_mfma_f32_16x16x32_bf16 v[210:213], a[96:99], v[134:137], 0
    v_pk_mul_f16 v208, v208, v172 op_sel:[0,0] op_sel_hi:[1,0]
    v_pk_mul_f16 v209, v209, v172 op_sel:[0,0] op_sel_hi:[1,0]
    v_mfma_f32_16x16x32_bf16 v[210:213], a[100:103], v[154:157], v[210:213]
    v_pk_mul_f16 v194, v194, v172 op_sel:[0,0] op_sel_hi:[1,0]
    v_pk_mul_f16 v195, v195, v172 op_sel:[0,0] op_sel_hi:[1,0]
    v_mfma_f32_16x16x32_bf16 v[210:213], a[104:107], v[130:133], v[210:213]
    v_min3_u32 v44, v44, v170, v171
    v_max3_u32 v45, v45, v170, v171
    v_mfma_f32_16x16x32_bf16 v[210:213], a[108:111], v[122:125], v[210:213]
    v_cvt_pk_f16_f32 v170, v162, v163
    v_pk_mul_f16 v163, v170, v170
    v_mfma_f32_16x16x32_bf16 v[210:213], a[112:115], v[126:129], v[210:213]
    v_cvt_pk_f16_f32 v171, v164, v165
    v_pk_mul_f16 v165, v171, v171
    v_mfma_f32_16x16x32_bf16 v[210:213], a[116:119], v[166:169], v[210:213]
    v_rsq_f32 v255, v255
    v_mfma_f32_16x16x32_bf16 v[214:217], a[120:123], v[134:137], 0
    v_rsq_f32 v254, v254
    v_mfma_f32_16x16x32_bf16 v[214:217], a[124:127], v[154:157], v[214:217]
    v_mul_f32 v142, v254, v142
    v_mul_f32 v143, v254, v143
    v_mfma_f32_16x16x32_bf16 v[214:217], a[128:131], v[130:133], v[214:217]
    v_cvt_pk_bf16_f32 v142, v142, v143
    v_cvt_pk_f16_f32 v172, v210, v211
    v_mfma_f32_16x16x32_bf16 v[214:217], a[132:135], v[122:125], v[214:217]
    v_pk_fma_f16 v163, v172, v172, v163
    v_cvt_pk_f16_f32 v173, v212, v213
    v_mfma_f32_16x16x32_bf16 v[214:217], a[136:139], v[126:129], v[214:217]
    v_pk_fma_f16 v165, v173, v173, v165
    v_mul_f32 v144, v254, v144
    v_mfma_f32_16x16x32_bf16 v[214:217], a[140:143], v[166:169], v[214:217]
    v_mul_f32 v145, v254, v145
    v_cvt_pk_bf16_f32 v143, v144, v145
    v_mfma_f32_16x16x32_bf16 v[210:213], a[0:3], v[134:137], 0
    v_mul_f32 v158, v254, v158
    v_mul_f32 v159, v254, v159
    v_mfma_f32_16x16x32_bf16 v[210:213], a[4:7], v[154:157], v[210:213]
    v_cvt_pk_bf16_f32 v144, v158, v159
    v_mul_f32 v160, v254, v160
    v_mfma_f32_16x16x32_bf16 v[210:213], a[8:11], v[130:133], v[210:213]
    v_cvt_pk_f16_f32 v220, v214, v215
    v_pk_fma_f16 v163, v220, v220, v163
    v_mfma_f32_16x16x32_bf16 v[210:213], a[12:15], v[122:125], v[210:213]
    v_cvt_pk_f16_f32 v221, v216, v217
    v_pk_fma_f16 v165, v221, v221, v165
    v_mfma_f32_16x16x32_bf16 v[210:213], a[16:19], v[126:129], v[210:213]
    v_mul_f32 v161, v254, v161
    v_cvt_pk_bf16_f32 v145, v160, v161
    v_mfma_f32_16x16x32_bf16 v[210:213], a[20:23], v[166:169], v[210:213]
    buffer_store_dwordx4 v[142:145], v16, s[12:15], 0 offen nt
    v_mul_f32 v178, v254, v178
    v_mul_f32 v179, v254, v179
    v_cvt_pk_bf16_f32 v198, v178, v179
    v_mul_f32 v180, v254, v180
    v_mfma_f32_16x16x32_bf16 v[142:145], a[24:27], v[134:137], 0
    v_mul_f32 v181, v254, v181
    v_cvt_pk_bf16_f32 v199, v180, v181
    v_mfma_f32_16x16x32_bf16 v[142:145], a[28:31], v[154:157], v[142:145]
    v_cvt_pk_f16_f32 v158, v210, v211
    v_pk_mul_f16 v162, v158, v158
    v_mfma_f32_16x16x32_bf16 v[142:145], a[32:35], v[130:133], v[142:145]
    v_cvt_pk_f16_f32 v159, v212, v213
    v_pk_mul_f16 v164, v159, v159
    v_mfma_f32_16x16x32_bf16 v[142:145], a[36:39], v[122:125], v[142:145]
    v_mul_f32 v254, 0x3baaaaab, v200
    v_mul_f32 v150, v255, v150
    v_mfma_f32_16x16x32_bf16 v[142:145], a[40:43], v[126:129], v[142:145]
    v_rsq_f32 v254, v254
    v_mfma_f32_16x16x32_bf16 v[142:145], a[44:47], v[166:169], v[142:145]
    v_mul_f32 v146, v254, v146
    v_mul_f32 v147, v254, v147
    v_mfma_f32_16x16x32_bf16 v[178:181], a[48:51], v[134:137], 0
    v_cvt_pk_bf16_f32 v146, v146, v147
    v_mul_f32 v148, v254, v148
    v_mfma_f32_16x16x32_bf16 v[178:181], a[52:55], v[154:157], v[178:181]
    v_mul_f32 v149, v254, v149
    v_cvt_pk_bf16_f32 v147, v148, v149
    v_mfma_f32_16x16x32_bf16 v[178:181], a[56:59], v[130:133], v[178:181]
    v_mul_f32 v138, v254, v138
    v_mul_f32 v139, v254, v139
    v_mfma_f32_16x16x32_bf16 v[178:181], a[60:63], v[122:125], v[178:181]
    v_cvt_pk_bf16_f32 v148, v138, v139
    v_mul_f32 v140, v254, v140
    v_mfma_f32_16x16x32_bf16 v[178:181], a[64:67], v[126:129], v[178:181]
    v_mul_f32 v141, v254, v141
    v_cvt_pk_bf16_f32 v149, v140, v141
    v_mfma_f32_16x16x32_bf16 v[178:181], a[68:71], v[166:169], v[178:181]
    v_mul_f32 v186, v254, v186
    v_mul_f32 v187, v254, v187
    v_mfma_f32_16x16x32_bf16 v[138:141], v[134:137], a[144:147], 0
    v_cvt_pk_bf16_f32 v200, v186, v187
    v_mul_f32 v188, v254, v188
    v_mfma_f32_16x16x32_bf16 v[138:141], v[154:157], a[148:151], v[138:141]
    v_mul_f32 v189, v254, v189
    v_cvt_pk_bf16_f32 v201, v188, v189
    v_mfma_f32_16x16x32_bf16 v[138:141], v[130:133], a[152:155], v[138:141]
    v_cvt_pk_f16_f32 v160, v142, v143
    v_pk_fma_f16 v162, v160, v160, v162
    v_mfma_f32_16x16x32_bf16 v[138:141], v[122:125], a[156:159], v[138:141]
    v_cvt_pk_f16_f32 v161, v144, v145
    v_pk_fma_f16 v164, v161, v161, v164
    v_mfma_f32_16x16x32_bf16 v[138:141], v[126:129], a[160:163], v[138:141]
    buffer_store_dwordx4 v[146:149], v17, s[12:15], 0 offen nt
    v_cvt_pk_f16_f32 v218, v178, v179
    v_pk_fma_f16 v162, v218, v218, v162
    v_cvt_pk_f16_f32 v219, v180, v181
    v_pk_fma_f16 v164, v219, v219, v164
    v_mfma_f32_16x16x32_bf16 v[138:141], v[166:169], a[164:167], v[138:141]
    v_mul_f32 v151, v255, v151
    v_cvt_pk_bf16_f32 v150, v150, v151
    v_mfma_f32_16x16x32_f16 v[142:145], v[40:43], v[162:165], 0
    v_mul_f32 v152, v255, v152
    v_mul_f32 v153, v255, v153
    v_mfma_f32_16x16x32_bf16 v[178:181], v[134:137], a[168:171], 0
    v_cvt_pk_bf16_f32 v151, v152, v153
    v_mul_f32 v190, v255, v190
    v_mfma_f32_16x16x32_bf16 v[178:181], v[154:157], a[172:175], v[178:181]
    v_cvt_pk_bf16_f32 v176, v138, v139
    v_cvt_pk_bf16_f32 v177, v140, v141
    v_mfma_f32_16x16x32_bf16 v[178:181], v[130:133], a[176:179], v[178:181]
    ds_read_b128 v[146:149], v0 offset:32768
    v_min3_u32 v44, v44, v142, v143
    v_mfma_f32_16x16x32_bf16 v[178:181], v[122:125], a[180:183], v[178:181]
    ds_read_b128 v[138:141], v1 offset:32768
    v_max3_u32 v45, v45, v142, v143
    v_mfma_f32_16x16x32_bf16 v[178:181], v[126:129], a[184:187], v[178:181]
    ds_read_b128 v[186:189], v0 offset:32896
    v_mul_f32 v191, v255, v191
    v_mfma_f32_16x16x32_bf16 v[178:181], v[166:169], a[188:191], v[178:181]
    ds_read_b128 v[162:165], v1 offset:32896
    v_cvt_pk_bf16_f32 v152, v190, v191
    v_mfma_f32_16x16x32_bf16 v[210:213], v[134:137], a[192:195], 0
    ds_read_b128 v[134:137], v0 offset:33024
    v_mul_f32 v192, v255, v192
    v_mfma_f32_16x16x32_bf16 v[210:213], v[154:157], a[196:199], v[210:213]
    ds_read_b128 v[154:157], v1 offset:33024
    v_mul_f32 v193, v255, v193
    v_mfma_f32_16x16x32_bf16 v[210:213], v[130:133], a[200:203], v[210:213]
    v_rsq_f32 v144, v142
    v_mfma_f32_16x16x32_bf16 v[210:213], v[122:125], a[204:207], v[210:213]
    v_rsq_f32 v145, v143
    v_mfma_f32_16x16x32_bf16 v[210:213], v[126:129], a[208:211], v[210:213]
    s_waitcnt lgkmcnt(5)
    v_mul_f32 v144, s31, v144
    v_cvt_pk_f16_f32 v144, v144, v145
    v_mfma_f32_16x16x32_bf16 v[210:213], v[166:169], a[212:215], v[210:213]
    s_waitcnt lgkmcnt(4)
    v_cvt_pk_bf16_f32 v184, v178, v179
    v_cvt_pk_bf16_f32 v185, v180, v181
    v_mfma_f32_16x16x32_bf16 v[178:181], a[72:75], v[146:149], 0
    s_waitcnt lgkmcnt(3)
    v_pk_mul_f16 v170, v170, v144 op_sel:[0,1] op_sel_hi:[1,1]
    v_pk_mul_f16 v171, v171, v144 op_sel:[0,1] op_sel_hi:[1,1]
    v_mfma_f32_16x16x32_bf16 v[178:181], a[76:79], v[138:141], v[178:181]
    s_waitcnt lgkmcnt(2)
    v_cvt_pk_bf16_f32 v116, v210, v211
    v_cvt_pk_bf16_f32 v117, v212, v213
    v_mfma_f32_16x16x32_bf16 v[178:181], a[80:83], v[186:189], v[178:181]
    s_waitcnt lgkmcnt(1)
    buffer_store_dwordx2 v[200:201], v20, s[12:15], 0 offen nt
    v_pk_mul_f16 v172, v172, v144 op_sel:[0,1] op_sel_hi:[1,1]
    v_pk_mul_f16 v173, v173, v144 op_sel:[0,1] op_sel_hi:[1,1]
    v_mfma_f32_16x16x32_bf16 v[178:181], a[84:87], v[162:165], v[178:181]
    s_waitcnt lgkmcnt(0)
    v_pk_mul_f16 v220, v220, v144 op_sel:[0,1] op_sel_hi:[1,1]
    v_pk_mul_f16 v221, v221, v144 op_sel:[0,1] op_sel_hi:[1,1]
    v_mfma_f32_16x16x32_bf16 v[178:181], a[88:91], v[134:137], v[178:181]
    v_pk_mul_f16 v158, v158, v144 op_sel:[0,0] op_sel_hi:[1,0]
    v_pk_mul_f16 v159, v159, v144 op_sel:[0,0] op_sel_hi:[1,0]
    v_mfma_f32_16x16x32_bf16 v[178:181], a[92:95], v[154:157], v[178:181]
    v_pk_mul_f16 v160, v160, v144 op_sel:[0,0] op_sel_hi:[1,0]
    v_pk_mul_f16 v161, v161, v144 op_sel:[0,0] op_sel_hi:[1,0]
    v_mfma_f32_16x16x32_bf16 v[130:133], a[96:99], v[146:149], 0
    v_pk_mul_f16 v218, v218, v144 op_sel:[0,0] op_sel_hi:[1,0]
    v_pk_mul_f16 v219, v219, v144 op_sel:[0,0] op_sel_hi:[1,0]
    v_mfma_f32_16x16x32_bf16 v[130:133], a[100:103], v[138:141], v[130:133]
    s_waitcnt vmcnt(3)
    v_cvt_pk_bf16_f32 v153, v192, v193
    v_cvt_pk_f16_f32 v142, v178, v179
    v_mfma_f32_16x16x32_bf16 v[130:133], a[104:107], v[186:189], v[130:133]
    s_barrier
    v_pk_mul_f16 v191, v142, v142
    v_cvt_pk_f16_f32 v143, v180, v181
    v_mfma_f32_16x16x32_bf16 v[130:133], a[108:111], v[162:165], v[130:133]
    s_nop 0
    v_pk_mul_f16 v193, v143, v143
    v_mul_f32 v202, v255, v202
    v_mfma_f32_16x16x32_bf16 v[130:133], a[112:115], v[134:137], v[130:133]
    s_nop 0
    v_mul_f32 v203, v255, v203
    v_cvt_pk_bf16_f32 v254, v202, v203
    v_mfma_f32_16x16x32_bf16 v[130:133], a[116:119], v[154:157], v[130:133]
    s_nop 0
    v_mul_f32 v204, v255, v204
    v_mul_f32 v205, v255, v205
    v_mfma_f32_16x16x32_bf16 v[178:181], a[120:123], v[146:149], 0
    v_cvt_pk_bf16_f32 v255, v204, v205
    v_xor_b32 v0, 65536, v0
    v_mfma_f32_16x16x32_bf16 v[178:181], a[124:127], v[138:141], v[178:181]
    v_xor_b32 v1, 65536, v1
    v_cvt_pk_f16_f32 v144, v130, v131
    v_mfma_f32_16x16x32_bf16 v[178:181], a[128:131], v[186:189], v[178:181]
    v_pk_fma_f16 v191, v144, v144, v191
    v_cvt_pk_f16_f32 v145, v132, v133
    v_mfma_f32_16x16x32_bf16 v[178:181], a[132:135], v[162:165], v[178:181]
    v_pk_fma_f16 v193, v145, v145, v193
    v_mfma_f32_16x16x32_bf16 v[178:181], a[136:139], v[134:137], v[178:181]
    v_mfma_f32_16x16x32_bf16 v[178:181], a[140:143], v[154:157], v[178:181]
    v_mfma_f32_16x16x32_bf16 v[202:205], a[0:3], v[146:149], 0
    v_mfma_f32_16x16x32_bf16 v[202:205], a[4:7], v[138:141], v[202:205]
    buffer_load_dwordx4 v10, s[8:11], 0 offen nt lds
    s_add_u32 m0, s28, 4096
    v_mfma_f32_16x16x32_bf16 v[202:205], a[8:11], v[186:189], v[202:205]
    v_mfma_f32_16x16x32_bf16 v[202:205], a[12:15], v[162:165], v[202:205]
    v_mfma_f32_16x16x32_bf16 v[202:205], a[16:19], v[134:137], v[202:205]
    v_mfma_f32_16x16x32_bf16 v[202:205], a[20:23], v[154:157], v[202:205]
    v_cvt_pk_f16_f32 v124, v178, v179
    v_pk_fma_f16 v191, v124, v124, v191
    v_mfma_f32_16x16x32_bf16 v[130:133], a[24:27], v[146:149], 0
    buffer_load_dwordx4 v11, s[8:11], 0 offen nt lds
    v_cvt_pk_f16_f32 v125, v180, v181
    v_mfma_f32_16x16x32_bf16 v[130:133], a[28:31], v[138:141], v[130:133]
    s_add_u32 m0, s28, 8192
    v_pk_fma_f16 v193, v125, v125, v193
    v_cvt_pk_f16_f32 v178, v202, v203
    v_mfma_f32_16x16x32_bf16 v[130:133], a[32:35], v[186:189], v[130:133]
    v_pk_mul_f16 v190, v178, v178
    v_cvt_pk_f16_f32 v179, v204, v205
    v_mfma_f32_16x16x32_bf16 v[130:133], a[36:39], v[162:165], v[130:133]
    v_pk_mul_f16 v192, v179, v179
    v_mfma_f32_16x16x32_bf16 v[130:133], a[40:43], v[134:137], v[130:133]
    v_mfma_f32_16x16x32_bf16 v[130:133], a[44:47], v[154:157], v[130:133]
    buffer_load_dwordx4 v12, s[8:11], 0 offen nt lds
    s_add_u32 m0, s28, 12288
    v_mfma_f32_16x16x32_bf16 v[202:205], a[48:51], v[146:149], 0
    s_xor_b32 s28, s28, 65536
    v_mfma_f32_16x16x32_bf16 v[202:205], a[52:55], v[138:141], v[202:205]
    ds_read_b128 v[166:169], v5 offset:0
    ds_read_b128 v[126:129], v5 offset:16
    v_mfma_f32_16x16x32_bf16 v[202:205], a[56:59], v[186:189], v[202:205]
    ds_read_b128 v[210:213], v5 offset:48
    ds_read_b32 v200, v6 offset:192
    v_mfma_f32_16x16x32_bf16 v[202:205], a[60:63], v[162:165], v[202:205]
    v_cvt_pk_f16_f32 v180, v130, v131
    v_pk_fma_f16 v190, v180, v180, v190
    v_mfma_f32_16x16x32_bf16 v[202:205], a[64:67], v[134:137], v[202:205]
    buffer_load_dwordx4 v13, s[8:11], 0 offen nt lds
    v_cvt_pk_f16_f32 v181, v132, v133
    v_mfma_f32_16x16x32_bf16 v[202:205], a[68:71], v[154:157], v[202:205]
    s_mov_b32 m0, s29
    v_pk_fma_f16 v192, v181, v181, v192
    v_add_u32 v5, 336, v5
    v_mfma_f32_16x16x32_bf16 v[130:133], v[146:149], a[144:147], 0
    s_xor_b32 s29, s29, s30
    s_add_u32 s19, s19, s20
    s_add_u32 s23, s23, s21
    v_mfma_f32_16x16x32_bf16 v[130:133], v[138:141], a[148:151], v[130:133]
    s_cmp_ge_u32 s19, 72
    v_cvt_pk_f16_f32 v122, v202, v203
    v_pk_fma_f16 v190, v122, v122, v190
    v_mfma_f32_16x16x32_bf16 v[130:133], v[186:189], a[152:155], v[130:133]
    s_cselect_b32 s34, 72, 0
    v_cvt_pk_f16_f32 v123, v204, v205
    v_pk_fma_f16 v192, v123, v123, v192
    v_mfma_f32_16x16x32_bf16 v[130:133], v[162:165], a[156:159], v[130:133]
    s_waitcnt lgkmcnt(2)
    buffer_store_dwordx2 v[198:199], v19, s[12:15], 0 offen nt
    s_cselect_b32 s35, s22, 0
    s_sub_u32 s19, s19, s34
    v_mfma_f32_16x16x32_f16 v[202:205], v[40:43], v[190:193], 0
    s_add_u32 s23, s23, s35
    s_add_u32 s18, s18, 1
    s_cmp_lt_u32 s18, s45
    v_mfma_f32_16x16x32_f16 v[214:217], v[166:169], v[158:161], v[24:27]
    s_waitcnt lgkmcnt(0)
    v_mfma_f32_16x16x32_f16 v[214:217], v[126:129], v[170:173], v[214:217]
    v_mfma_f32_16x16x32_f16 v[214:217], v[210:213], v[218:221], v[214:217]
    v_mfma_f32_16x16x32_f16 v[190:193], v[166:169], v[206:209], v[22:25]
    v_rsq_f32 v204, v202
    v_mfma_f32_16x16x32_f16 v[190:193], v[126:129], v[118:121], v[190:193]
    v_rsq_f32 v205, v203
    v_mfma_f32_16x16x32_f16 v[190:193], v[210:213], v[194:197], v[190:193]
    v_mul_f32 v204, s31, v204
    v_cvt_pk_f16_f32 v204, v204, v205
    v_mfma_f32_16x16x32_bf16 v[130:133], v[134:137], a[160:163], v[130:133]
    v_pk_mul_f16 v142, v142, v204 op_sel:[0,1] op_sel_hi:[1,1]
    v_pk_mul_f16 v143, v143, v204 op_sel:[0,1] op_sel_hi:[1,1]
    v_mfma_f32_16x16x32_bf16 v[130:133], v[154:157], a[164:167], v[130:133]
    v_pk_mul_f16 v144, v144, v204 op_sel:[0,1] op_sel_hi:[1,1]
    v_pk_mul_f16 v145, v145, v204 op_sel:[0,1] op_sel_hi:[1,1]
    v_mfma_f32_16x16x32_bf16 v[222:225], v[146:149], a[168:171], 0
    v_mov_b32_dpp v200, v191 quad_perm:[0,1,2,3] row_mask:0x1 bank_mask:0xf
    v_mov_b32_dpp v200, v215 quad_perm:[0,1,2,3] row_mask:0x2 bank_mask:0xf
    v_mfma_f32_16x16x32_bf16 v[222:225], v[138:141], a[172:175], v[222:225]
    v_pk_mul_f16 v124, v124, v204 op_sel:[0,1] op_sel_hi:[1,1]
    v_pk_mul_f16 v125, v125, v204 op_sel:[0,1] op_sel_hi:[1,1]
    v_mfma_f32_16x16x32_bf16 v[222:225], v[186:189], a[176:179], v[222:225]
    v_cvt_pk_bf16_f32 v130, v130, v131
    v_cvt_pk_bf16_f32 v131, v132, v133
    v_mfma_f32_16x16x32_bf16 v[222:225], v[162:165], a[180:183], v[222:225]
    v_pk_mul_f16 v178, v178, v204 op_sel:[0,0] op_sel_hi:[1,0]
    v_pk_mul_f16 v179, v179, v204 op_sel:[0,0] op_sel_hi:[1,0]
    v_mfma_f32_16x16x32_f16 v[226:229], v[118:121], v[206:209], v[46:49]
    v_pk_mul_f16 v180, v180, v204 op_sel:[0,0] op_sel_hi:[1,0]
    v_pk_mul_f16 v181, v181, v204 op_sel:[0,0] op_sel_hi:[1,0]
    v_mfma_f32_16x16x32_f16 v[230:233], v[170:173], v[206:209], v[50:53]
    v_pk_mul_f16 v122, v122, v204 op_sel:[0,0] op_sel_hi:[1,0]
    v_pk_mul_f16 v123, v123, v204 op_sel:[0,0] op_sel_hi:[1,0]
    v_mfma_f32_16x16x32_f16 v[234:237], v[142:145], v[206:209], v[54:57]
    v_min3_u32 v44, v44, v202, v203
    v_exp_f32 v214, v214
    v_mfma_f32_16x16x16_f16 v[226:229], v[196:197], v[194:195], v[226:229]
    v_max3_u32 v45, v45, v202, v203
    v_exp_f32 v190, v190
    v_mfma_f32_16x16x16_f16 v[230:233], v[220:221], v[194:195], v[230:233]
    v_cvt_pk_bf16_f32 v39, v190, 0
    v_mfma_f32_16x16x16_f16 v[234:237], v[124:125], v[194:195], v[234:237]
    buffer_store_dwordx4 v[150:153], v15, s[12:15], 0 offen nt
    v_mfma_f32_16x16x32_bf16 v[222:225], v[134:137], a[184:187], v[222:225]
    v_mfma_f32_16x16x32_bf16 v[222:225], v[154:157], a[188:191], v[222:225]
    ds_read_b128 v[206:209], v2 offset:0
    v_mfma_f32_16x16x32_bf16 v[150:153], v[146:149], a[192:195], 0
    ds_read_b128 v[146:149], v2 offset:1024
    v_mfma_f32_16x16x32_bf16 v[150:153], v[138:141], a[196:199], v[150:153]
    ds_read_b128 v[138:141], v2 offset:2048
    v_mfma_f32_16x16x32_bf16 v[150:153], v[186:189], a[200:203], v[150:153]
    ds_read_b128 v[186:189], v2 offset:3072
    v_mfma_f32_16x16x32_bf16 v[150:153], v[162:165], a[204:207], v[150:153]
    ds_read_b128 v[162:165], v2 offset:4096
    v_cvt_pk_bf16_f32 v222, v222, v223
    v_mfma_f32_16x16x32_bf16 v[150:153], v[134:137], a[208:211], v[150:153]
    ds_read_b128 v[134:137], v2 offset:5120
    v_cvt_pk_bf16_f32 v223, v224, v225
    v_mfma_f32_16x16x32_bf16 v[150:153], v[154:157], a[212:215], v[150:153]
    ds_read2_b32 v[132:133], v6 offset0:0 offset1:0
    ds_read2_b32 v[224:225], v6 offset0:16 offset1:16
    v_mfma_f32_16x16x32_f16 v[154:157], v[166:169], v[178:181], v[26:29]
    ds_read2_b32 v[168:169], v6 offset0:32 offset1:32
    v_add_u32 v6, 272, v6
    v_mfma_f32_16x16x32_f16 v[154:157], v[126:129], v[142:145], v[154:157]
    s_waitcnt lgkmcnt(8)
    v_exp_f32 v226, v226
    v_mfma_f32_16x16x32_f16 v[154:157], v[210:213], v[122:125], v[154:157]
    s_waitcnt lgkmcnt(7)
    v_cvt_pk_bf16_f32 v166, v150, v151
    v_cvt_pk_bf16_f32 v167, v152, v153
    v_mfma_f32_16x16x32_bf16 v[150:153], a[216:219], v[206:209], 0
    s_waitcnt lgkmcnt(6)
    v_exp_f32 v227, v227
    v_mfma_f32_16x16x32_bf16 v[150:153], a[220:223], v[146:149], v[150:153]
    s_waitcnt lgkmcnt(5)
    v_exp_f32 v154, v154
    v_mfma_f32_16x16x32_bf16 v[150:153], a[224:227], v[138:141], v[150:153]
    s_waitcnt lgkmcnt(4)
    v_mov_b32_dpp v200, v155 quad_perm:[0,1,2,3] row_mask:0x4 bank_mask:0xf
    v_cvt_pk_bf16_f32 v126, v226, v227
    v_mfma_f32_16x16x32_bf16 v[150:153], a[228:231], v[186:189], v[150:153]
    s_waitcnt lgkmcnt(3)
    v_exp_f32 v200, v200
    v_mfma_f32_16x16x32_bf16 v[150:153], a[232:235], v[162:165], v[150:153]
    s_waitcnt lgkmcnt(1)
    v_exp_f32 v228, v228
    v_mfma_f32_16x16x32_bf16 v[150:153], a[236:239], v[134:137], v[150:153]
    s_waitcnt lgkmcnt(0)
    buffer_store_dwordx2 v[254:255], v18, s[12:15], 0 offen nt
    v_exp_f32 v229, v229
    v_mfma_f32_16x16x32_bf16 v[190:193], a[240:243], v[206:209], 0
    v_cvt_pk_bf16_f32 v200, v200, v200
    v_cvt_pk_bf16_f32 v127, v228, v229
    v_mfma_f32_16x16x32_bf16 v[190:193], a[244:247], v[146:149], v[190:193]
    ds_write_b16 v8, v200
    v_mfma_f32_16x16x32_bf16 v[190:193], a[248:251], v[138:141], v[190:193]
    v_exp_f32 v230, v230
    v_mfma_f32_16x16x32_bf16 v[190:193], a[252:255], v[186:189], v[190:193]
    ds_read_b128 v[198:201], v2 offset:6144
    ds_read_b128 v[210:213], v9
    v_mfma_f32_16x16x32_bf16 v[190:193], v[82:85], v[162:165], v[190:193]
    ds_read_b128 v[226:229], v2 offset:7168
    ds_read_b128 v[238:241], v9 offset:64
    v_mfma_f32_16x16x32_bf16 v[190:193], v[86:89], v[134:137], v[190:193]
    v_exp_f32 v231, v231
    v_mfma_f32_16x16x32_bf16 v[202:205], v[90:93], v[206:209], 0
    ds_read_b128 v[206:209], v2 offset:8192
    ds_read_b128 v[242:245], v2 offset:9216
    v_mfma_f32_16x16x32_bf16 v[202:205], v[94:97], v[146:149], v[202:205]
    v_cvt_pk_bf16_f32 v128, v230, v231
    v_fma_f32 v254, v150, v150, s33
    v_mfma_f32_16x16x32_bf16 v[202:205], v[98:101], v[138:141], v[202:205]
    ds_read_b128 v[146:149], v2 offset:10240
    ds_read_b128 v[138:141], v2 offset:11264
    v_mfma_f32_16x16x32_bf16 v[202:205], v[102:105], v[186:189], v[202:205]
    v_exp_f32 v232, v232
    v_mfma_f32_16x16x32_bf16 v[202:205], v[106:109], v[162:165], v[202:205]
    v_exp_f32 v233, v233
    v_mfma_f32_16x16x32_bf16 v[202:205], v[110:113], v[134:137], v[202:205]
    s_waitcnt lgkmcnt(6)
    v_cvt_pk_bf16_f32 v129, v232, v233
    v_fmac_f32 v254, v151, v151
    v_mfma_f32_16x16x32_bf16 v[186:189], v[210:213], v[28:31], 0
    s_waitcnt lgkmcnt(4)
    v_exp_f32 v234, v234
    v_mfma_f32_16x16x32_bf16 v[186:189], v[238:241], v[28:31], v[186:189]
    v_exp_f32 v235, v235
    v_mfma_f32_16x16x32_f16 v[134:137], v[118:121], v[158:161], v[58:61]
    s_waitcnt lgkmcnt(2)
    v_cvt_pk_bf16_f32 v36, v234, v235
    v_fmac_f32 v254, v152, v152
    v_mfma_f32_16x16x32_f16 v[162:165], v[170:173], v[158:161], v[62:65]
    v_exp_f32 v236, v236
    v_mfma_f32_16x16x32_f16 v[230:233], v[142:145], v[158:161], v[66:69]
    s_waitcnt lgkmcnt(0)
    buffer_load_dwordx4 v14, s[8:11], 0 offen nt lds
    v_rcp_f32 v186, v186
    v_mfma_f32_16x16x16_f16 v[134:137], v[196:197], v[218:219], v[134:137]
    v_exp_f32 v237, v237
    v_fmac_f32 v254, v153, v153
    v_mfma_f32_16x16x16_f16 v[162:165], v[220:221], v[218:219], v[162:165]
    v_cvt_pk_bf16_f32 v37, v236, v237
    v_fmac_f32 v254, v190, v190
    v_fmac_f32 v254, v191, v191
    v_mfma_f32_16x16x16_f16 v[230:233], v[124:125], v[218:219], v[230:233]
    v_fmac_f32 v254, v192, v192
    v_exp_f32 v134, v134
    v_fmac_f32 v254, v193, v193
    v_mfma_f32_16x16x32_bf16 v[158:161], v[210:213], v[174:177], 0
    v_exp_f32 v135, v135
    v_mfma_f32_16x16x32_bf16 v[158:161], v[238:241], v[130:133], v[158:161]
    v_cvt_pk_bf16_f32 v134, v134, v135
    v_fmac_f32 v254, v202, v202
    v_mfma_f32_16x16x32_bf16 v[234:237], v[210:213], v[182:185], 0
    v_exp_f32 v136, v136
    v_mfma_f32_16x16x32_bf16 v[234:237], v[238:241], v[222:225], v[234:237]
    v_exp_f32 v137, v137
    v_mfma_f32_16x16x32_bf16 v[246:249], v[210:213], v[114:117], 0
    v_cvt_pk_bf16_f32 v135, v136, v137
    v_mul_f32 v158, v158, v186
    v_mfma_f32_16x16x32_bf16 v[246:249], v[238:241], v[166:169], v[246:249]
    v_exp_f32 v162, v162
    v_mfma_f32_16x16x32_bf16 v[210:213], v[28:31], v[36:39], 0
    v_exp_f32 v163, v163
    v_mfma_f32_16x16x32_bf16 v[210:213], v[28:31], v[126:129], v[210:213]
    v_cvt_pk_bf16_f32 v136, v162, v163
    v_mul_f32_dpp v158, v234, v186 quad_perm:[0,1,2,3] row_mask:0x2 bank_mask:0xf
    v_mfma_f32_16x16x32_bf16 v[234:237], v[130:133], v[36:39], 0
    v_exp_f32 v164, v164
    v_mfma_f32_16x16x32_bf16 v[234:237], v[174:177], v[126:129], v[234:237]
    v_exp_f32 v165, v165
    v_mfma_f32_16x16x32_bf16 v[238:241], v[222:225], v[36:39], 0
    v_cvt_pk_bf16_f32 v137, v164, v165
    v_mul_f32_dpp v158, v246, v186 quad_perm:[0,1,2,3] row_mask:0x4 bank_mask:0xf
    v_mfma_f32_16x16x32_bf16 v[238:241], v[182:185], v[126:129], v[238:241]
    v_exp_f32 v230, v230
    v_mfma_f32_16x16x32_bf16 v[186:189], v[166:169], v[36:39], 0
    v_exp_f32 v231, v231
    v_mfma_f32_16x16x32_bf16 v[186:189], v[114:117], v[126:129], v[186:189]
    v_cvt_pk_bf16_f32 v36, v230, v231
    v_cvt_pk_bf16_f32 v39, v214, 0
    v_mfma_f32_16x16x32_f16 v[162:165], v[118:121], v[178:181], v[70:73]
    v_exp_f32 v232, v232
    v_mfma_f32_16x16x32_f16 v[118:121], v[170:173], v[178:181], v[74:77]
    v_exp_f32 v233, v233
    v_mfma_f32_16x16x32_f16 v[170:173], v[142:145], v[178:181], v[78:81]
    v_cvt_pk_bf16_f32 v37, v232, v233
    v_cvt_pk_bf16_f32 v158, v158, v158
    v_fmac_f32 v254, v203, v203
    v_mfma_f32_16x16x16_f16 v[162:165], v[196:197], v[122:123], v[162:165]
    v_rcp_f32 v210, v210
    v_fmac_f32 v254, v204, v204
    v_mfma_f32_16x16x16_f16 v[118:121], v[220:221], v[122:123], v[118:121]
    v_mul_f32 v234, v210, v234
    v_mul_f32 v235, v210, v235
    v_cvt_pk_bf16_f32 v178, v234, v235
    v_mfma_f32_16x16x16_f16 v[170:173], v[124:125], v[122:123], v[170:173]
    v_mul_f32 v236, v210, v236
    v_exp_f32 v162, v162
    v_mul_f32 v237, v210, v237
    v_mfma_f32_16x16x32_bf16 v[194:197], v[28:31], v[36:39], 0
    ds_write_b16 v7, v158
    v_mfma_f32_16x16x32_bf16 v[194:197], v[28:31], v[134:137], v[194:197]
    v_exp_f32 v163, v163
    v_mfma_f32_16x16x32_bf16 v[122:125], v[130:133], v[36:39], 0
    v_cvt_pk_bf16_f32 v162, v162, v163
    v_cvt_pk_bf16_f32 v179, v236, v237
    v_mfma_f32_16x16x32_bf16 v[122:125], v[174:177], v[134:137], v[122:125]
    v_exp_f32 v164, v164
    v_mfma_f32_16x16x32_bf16 v[126:129], v[222:225], v[36:39], 0
    v_exp_f32 v165, v165
    v_mfma_f32_16x16x32_bf16 v[126:129], v[182:185], v[134:137], v[126:129]
    v_cvt_pk_bf16_f32 v163, v164, v165
    v_mul_f32 v238, v210, v238
    v_mfma_f32_16x16x32_bf16 v[218:221], v[166:169], v[36:39], 0
    v_exp_f32 v118, v118
    v_mfma_f32_16x16x32_bf16 v[218:221], v[114:117], v[134:137], v[218:221]
    v_exp_f32 v119, v119
    v_mfma_f32_16x16x32_bf16 v[142:145], a[216:219], v[198:201], 0
    v_cvt_pk_bf16_f32 v164, v118, v119
    v_cvt_pk_bf16_f32 v39, v154, 0
    v_mfma_f32_16x16x32_bf16 v[142:145], a[220:223], v[226:229], v[142:145]
    v_exp_f32 v120, v120
    v_mfma_f32_16x16x32_bf16 v[142:145], a[224:227], v[206:209], v[142:145]
    v_exp_f32 v121, v121
    v_mfma_f32_16x16x32_bf16 v[142:145], a[228:231], v[242:245], v[142:145]
    v_cvt_pk_bf16_f32 v165, v120, v121
    v_mul_f32 v239, v210, v239
    v_mfma_f32_16x16x32_bf16 v[142:145], a[232:235], v[146:149], v[142:145]
    v_exp_f32 v170, v170
    v_mfma_f32_16x16x32_bf16 v[142:145], a[236:239], v[138:141], v[142:145]
    v_exp_f32 v171, v171
    v_mfma_f32_16x16x32_bf16 v[158:161], a[240:243], v[198:201], 0
    v_cvt_pk_bf16_f32 v36, v170, v171
    v_cvt_pk_bf16_f32 v180, v238, v239
    v_mfma_f32_16x16x32_bf16 v[158:161], a[244:247], v[226:229], v[158:161]
    v_exp_f32 v172, v172
    v_mfma_f32_16x16x32_bf16 v[158:161], a[248:251], v[206:209], v[158:161]
    v_exp_f32 v173, v173
    v_mfma_f32_16x16x32_bf16 v[158:161], a[252:255], v[242:245], v[158:161]
    ds_read_b128 v[118:121], v2 offset:12288
    v_cvt_pk_bf16_f32 v37, v172, v173
    v_mfma_f32_16x16x32_bf16 v[158:161], v[82:85], v[146:149], v[158:161]
    ds_read_b128 v[134:137], v2 offset:13312
    v_mul_f32 v240, v210, v240
    v_mfma_f32_16x16x32_bf16 v[170:173], v[28:31], v[36:39], 0
    v_mul_f32 v241, v210, v241
    v_cvt_pk_bf16_f32 v181, v240, v241
    v_mfma_f32_16x16x32_bf16 v[170:173], v[28:31], v[162:165], v[170:173]
    ds_write_b128 v3, v[178:181] offset:0
    v_mfma_f32_16x16x32_bf16 v[154:157], v[130:133], v[36:39], 0
    v_mul_f32 v186, v210, v186
    v_mul_f32 v187, v210, v187
    v_mfma_f32_16x16x32_bf16 v[154:157], v[174:177], v[162:165], v[154:157]
    v_cvt_pk_bf16_f32 v186, v186, v187
    v_mul_f32 v188, v210, v188
    v_mfma_f32_16x16x32_bf16 v[130:133], v[222:225], v[36:39], 0
    v_mul_f32 v189, v210, v189
    v_cvt_pk_bf16_f32 v187, v188, v189
    v_mfma_f32_16x16x32_bf16 v[130:133], v[182:185], v[162:165], v[130:133]
    s_waitcnt lgkmcnt(2)
    ds_write_b64 v4, v[186:187] offset:4096
    v_mfma_f32_16x16x32_bf16 v[174:177], v[166:169], v[36:39], 0
    s_waitcnt lgkmcnt(2)
    v_fma_f32 v255, v142, v142, s33
    v_fmac_f32 v255, v143, v143
    v_mfma_f32_16x16x32_bf16 v[174:177], v[114:117], v[162:165], v[174:177]
    v_fmac_f32 v255, v144, v144
    v_fmac_f32 v255, v145, v145
    v_mfma_f32_16x16x32_bf16 v[158:161], v[86:89], v[138:141], v[158:161]
    ds_read_b128 v[114:117], v2 offset:14336
    v_fmac_f32 v254, v205, v205
    v_mfma_f32_16x16x32_bf16 v[178:181], v[90:93], v[198:201], 0
    ds_read_b128 v[166:169], v2 offset:15360
    v_add_u32 v7, 16, v7
    v_mfma_f32_16x16x32_bf16 v[178:181], v[94:97], v[226:229], v[178:181]
    ds_read_b128 v[162:165], v2 offset:16384
    v_mfma_f32_16x16x32_bf16 v[178:181], v[98:101], v[206:209], v[178:181]
    ds_read_b128 v[206:209], v2 offset:17408
    v_fmac_f32 v255, v158, v158
    v_mfma_f32_16x16x32_bf16 v[178:181], v[102:105], v[242:245], v[178:181]
    v_fmac_f32 v255, v159, v159
    v_fmac_f32 v255, v160, v160
    v_mfma_f32_16x16x32_bf16 v[178:181], v[106:109], v[146:149], v[178:181]
    v_fmac_f32 v255, v161, v161
    v_xor_b32 v2, 65536, v2
    v_mfma_f32_16x16x32_bf16 v[178:181], v[110:113], v[138:141], v[178:181]
    v_rcp_f32 v170, v170
    v_mfma_f32_16x16x32_bf16 v[146:149], a[216:219], v[118:121], 0
    v_mul_f32 v154, v170, v154
    v_mul_f32 v155, v170, v155
    v_mfma_f32_16x16x32_bf16 v[146:149], a[220:223], v[134:137], v[146:149]
    s_waitcnt lgkmcnt(3)
    ds_read_b128 v[182:185], v0 offset:20480
    v_cvt_pk_bf16_f32 v154, v154, v155
    v_mfma_f32_16x16x32_bf16 v[146:149], a[224:227], v[114:117], v[146:149]
    s_waitcnt lgkmcnt(3)
    ds_read_b128 v[198:201], v1 offset:20480
    v_fmac_f32 v255, v178, v178
    v_mfma_f32_16x16x32_bf16 v[146:149], a[228:231], v[166:169], v[146:149]
    s_waitcnt lgkmcnt(3)
    ds_read_b128 v[210:213], v0 offset:20608
    v_fmac_f32 v255, v179, v179
    v_mfma_f32_16x16x32_bf16 v[146:149], a[232:235], v[162:165], v[146:149]
    s_waitcnt lgkmcnt(3)
    ds_read_b128 v[222:225], v1 offset:20608
    v_fmac_f32 v255, v180, v180
    v_mfma_f32_16x16x32_bf16 v[146:149], a[236:239], v[206:209], v[146:149]
    ds_read_b128 v[226:229], v0 offset:20736
    v_fmac_f32 v255, v181, v181
    v_mfma_f32_16x16x32_bf16 v[138:141], a[240:243], v[118:121], 0
    ds_read_b128 v[242:245], v1 offset:20736
    v_cvt_pk_bf16_f32 v254, v254, v255
    v_mfma_f32_16x16x32_bf16 v[138:141], a[244:247], v[134:137], v[138:141]
    v_mul_f32 v156, v170, v156
    v_mul_f32 v157, v170, v157
    v_mfma_f32_16x16x32_bf16 v[138:141], a[248:251], v[114:117], v[138:141]
    v_fma_f32 v255, v146, v146, s33
    v_fmac_f32 v255, v147, v147
    v_mfma_f32_16x16x32_bf16 v[138:141], a[252:255], v[166:169], v[138:141]
    s_waitcnt lgkmcnt(5)
    v_fmac_f32 v255, v148, v148
    v_fmac_f32 v255, v149, v149
    v_mfma_f32_16x16x32_bf16 v[138:141], v[82:85], v[162:165], v[138:141]
    s_waitcnt lgkmcnt(4)
    v_cvt_pk_bf16_f32 v155, v156, v157
    v_mul_f32 v130, v170, v130
    v_mfma_f32_16x16x32_bf16 v[138:141], v[86:89], v[206:209], v[138:141]
    s_waitcnt lgkmcnt(3)
    v_mul_f32 v131, v170, v131
    v_cvt_pk_bf16_f32 v156, v130, v131
    v_mfma_f32_16x16x32_bf16 v[186:189], v[90:93], v[118:121], 0
    s_waitcnt lgkmcnt(2)
    v_mul_f32 v132, v170, v132
    v_mul_f32 v133, v170, v133
    v_mfma_f32_16x16x32_bf16 v[186:189], v[94:97], v[134:137], v[186:189]
    s_waitcnt lgkmcnt(1)
    v_fmac_f32 v255, v138, v138
    v_fmac_f32 v255, v139, v139
    v_mfma_f32_16x16x32_bf16 v[186:189], v[98:101], v[114:117], v[186:189]
    s_waitcnt lgkmcnt(0)
    v_fmac_f32 v255, v140, v140
    v_fmac_f32 v255, v141, v141
    v_mfma_f32_16x16x32_bf16 v[186:189], v[102:105], v[166:169], v[186:189]
    v_cvt_pk_bf16_f32 v157, v132, v133
    v_mul_f32 v174, v170, v174
    v_mfma_f32_16x16x32_bf16 v[186:189], v[106:109], v[162:165], v[186:189]
    ds_write_b128 v3, v[154:157] offset:12288
    v_mfma_f32_16x16x32_bf16 v[186:189], v[110:113], v[206:209], v[186:189]
    v_mul_f32 v175, v170, v175
    v_cvt_pk_bf16_f32 v174, v174, v175
    v_mfma_f32_16x16x32_bf16 v[118:121], a[72:75], v[182:185], 0
    v_mul_f32 v176, v170, v176
    v_mul_f32 v177, v170, v177
    v_mfma_f32_16x16x32_bf16 v[118:121], a[76:79], v[198:201], v[118:121]
    v_rcp_f32 v194, v194
    v_mfma_f32_16x16x32_bf16 v[118:121], a[80:83], v[210:213], v[118:121]
    v_fmac_f32 v255, v186, v186
    v_fmac_f32 v255, v187, v187
    v_mfma_f32_16x16x32_bf16 v[118:121], a[84:87], v[222:225], v[118:121]
    v_fmac_f32 v255, v188, v188
    v_fmac_f32 v255, v189, v189
    v_mfma_f32_16x16x32_bf16 v[118:121], a[88:91], v[226:229], v[118:121]
    v_cvt_pk_bf16_f32 v255, v255, v255
    v_cvt_pk_bf16_f32 v175, v176, v177
    v_mfma_f32_16x16x32_bf16 v[118:121], a[92:95], v[242:245], v[118:121]
    ds_write_b64 v4, v[174:175] offset:16384
    v_mfma_f32_16x16x32_bf16 v[206:209], a[96:99], v[182:185], 0
    v_mul_f32 v122, v194, v122
    v_mul_f32 v123, v194, v123
    v_mfma_f32_16x16x32_bf16 v[206:209], a[100:103], v[198:201], v[206:209]
    ds_write_b64 v4, v[254:255] offset:18432
    v_mfma_f32_16x16x32_bf16 v[206:209], a[104:107], v[210:213], v[206:209]
    v_cvt_pk_bf16_f32 v134, v122, v123
    v_cvt_pk_f16_f32 v118, v118, v119
    v_mfma_f32_16x16x32_bf16 v[206:209], a[108:111], v[222:225], v[206:209]
    v_pk_mul_f16 v163, v118, v118
    v_cvt_pk_f16_f32 v119, v120, v121
    v_mfma_f32_16x16x32_bf16 v[206:209], a[112:115], v[226:229], v[206:209]
    v_pk_mul_f16 v165, v119, v119
    v_mul_f32 v124, v194, v124
    v_mfma_f32_16x16x32_bf16 v[206:209], a[116:119], v[242:245], v[206:209]
    v_mul_f32 v125, v194, v125
    v_cvt_pk_bf16_f32 v135, v124, v125
    v_mfma_f32_16x16x32_bf16 v[122:125], a[120:123], v[182:185], 0
    v_mul_f32 v126, v194, v126
    v_mul_f32 v127, v194, v127
    v_mfma_f32_16x16x32_bf16 v[122:125], a[124:127], v[198:201], v[122:125]
    v_cvt_pk_bf16_f32 v136, v126, v127
    v_mul_f32 v128, v194, v128
    v_mfma_f32_16x16x32_bf16 v[122:125], a[128:131], v[210:213], v[122:125]
    v_cvt_pk_f16_f32 v120, v206, v207
    v_pk_fma_f16 v163, v120, v120, v163
    v_mfma_f32_16x16x32_bf16 v[122:125], a[132:135], v[222:225], v[122:125]
    v_cvt_pk_f16_f32 v121, v208, v209
    v_pk_fma_f16 v165, v121, v121, v165
    v_mfma_f32_16x16x32_bf16 v[122:125], a[136:139], v[226:229], v[122:125]
    v_mul_f32 v129, v194, v129
    v_cvt_pk_bf16_f32 v137, v128, v129
    v_mfma_f32_16x16x32_bf16 v[122:125], a[140:143], v[242:245], v[122:125]
    ds_write_b128 v3, v[134:137] offset:6144
    v_mfma_f32_16x16x32_bf16 v[206:209], a[0:3], v[182:185], 0
    v_mul_f32 v218, v194, v218
    v_mul_f32 v219, v194, v219
    v_mfma_f32_16x16x32_bf16 v[206:209], a[4:7], v[198:201], v[206:209]
    v_cvt_pk_bf16_f32 v254, v218, v219
    v_mul_f32 v220, v194, v220
    v_mfma_f32_16x16x32_bf16 v[206:209], a[8:11], v[210:213], v[206:209]
    v_cvt_pk_f16_f32 v196, v122, v123
    v_pk_fma_f16 v163, v196, v196, v163
    v_mfma_f32_16x16x32_bf16 v[206:209], a[12:15], v[222:225], v[206:209]
    v_cvt_pk_f16_f32 v197, v124, v125
    v_pk_fma_f16 v165, v197, v197, v165
    v_mfma_f32_16x16x32_bf16 v[206:209], a[16:19], v[226:229], v[206:209]
    v_mul_f32 v221, v194, v221
    v_cvt_pk_bf16_f32 v255, v220, v221
    v_mfma_f32_16x16x32_bf16 v[206:209], a[20:23], v[242:245], v[206:209]
    ds_write_b64 v4, v[254:255] offset:10240
    v_mfma_f32_16x16x32_bf16 v[174:177], a[24:27], v[182:185], 0
    v_xor_b32 v3, 65536, v3
    v_xor_b32 v4, 65536, v4
    v_mfma_f32_16x16x32_bf16 v[174:177], a[28:31], v[198:201], v[174:177]
    v_mfma_f32_16x16x32_bf16 v[174:177], a[32:35], v[210:213], v[174:177]
    v_mfma_f32_16x16x32_bf16 v[174:177], a[36:39], v[222:225], v[174:177]
    v_mfma_f32_16x16x32_bf16 v[174:177], a[40:43], v[226:229], v[174:177]
    v_cvt_pk_f16_f32 v206, v206, v207
    v_mfma_f32_16x16x32_bf16 v[174:177], a[44:47], v[242:245], v[174:177]
    v_mfma_f32_16x16x32_bf16 v[218:221], a[48:51], v[182:185], 0
    s_waitcnt lgkmcnt(0)
    v_mfma_f32_16x16x32_bf16 v[218:221], a[52:55], v[198:201], v[218:221]
    s_barrier
    v_mfma_f32_16x16x32_bf16 v[218:221], a[56:59], v[210:213], v[218:221]
    s_nop 0
    v_mfma_f32_16x16x32_bf16 v[218:221], a[60:63], v[222:225], v[218:221]
    s_nop 0
    v_mfma_f32_16x16x32_bf16 v[218:221], a[64:67], v[226:229], v[218:221]
    s_nop 0
    v_mfma_f32_16x16x32_bf16 v[218:221], a[68:71], v[242:245], v[218:221]
    v_mfma_f32_16x16x32_bf16 v[170:173], v[182:185], a[144:147], 0
    v_mfma_f32_16x16x32_bf16 v[170:173], v[198:201], a[148:151], v[170:173]
    v_mfma_f32_16x16x32_bf16 v[170:173], v[210:213], a[152:155], v[170:173]
    v_mfma_f32_16x16x32_bf16 v[170:173], v[222:225], a[156:159], v[170:173]
    v_mfma_f32_16x16x32_bf16 v[170:173], v[226:229], a[160:163], v[170:173]
    v_mfma_f32_16x16x32_bf16 v[170:173], v[242:245], a[164:167], v[170:173]
    s_cbranch_scc1 L_loop_fast0
    s_branch L_final_fast
.p2align 6
L_loop_fast1:
    v_mfma_f32_16x16x32_bf16 v[234:237], v[182:185], a[168:171], 0
    s_add_u32 s12, s42, s27
    ds_read_b128 v[230:233], v2 offset:18432
    ds_read_b128 v[238:241], v2 offset:19456
    v_mfma_f32_16x16x32_bf16 v[234:237], v[198:201], a[172:175], v[234:237]
    s_addc_u32 s13, s43, 0
    v_pk_mul_f16 v162, v206, v206
    v_cvt_pk_f16_f32 v207, v208, v209
    v_mfma_f32_16x16x32_bf16 v[234:237], v[210:213], a[176:179], v[234:237]
    s_sub_u32 s14, s36, s27
    ds_read_b128 v[134:137], v0 offset:26624
    v_pk_mul_f16 v164, v207, v207
    v_mfma_f32_16x16x32_bf16 v[234:237], v[222:225], a[180:183], v[234:237]
    s_cmp_ge_u32 s18, 2
    ds_read_b128 v[154:157], v1 offset:26624
    v_cvt_pk_f16_f32 v208, v174, v175
    v_mfma_f32_16x16x32_bf16 v[234:237], v[226:229], a[184:187], v[234:237]
    s_cselect_b32 s14, s14, 0
    ds_read_b128 v[130:133], v0 offset:26752
    v_pk_fma_f16 v162, v208, v208, v162
    v_mfma_f32_16x16x32_bf16 v[234:237], v[242:245], a[188:191], v[234:237]
    s_add_u32 s34, s18, 2
    ds_read_b128 v[122:125], v1 offset:26752
    v_cvt_pk_f16_f32 v209, v176, v177
    v_mfma_f32_16x16x32_bf16 v[114:117], v[182:185], a[192:195], 0
    s_add_u32 s8, s40, s23
    ds_read_b128 v[126:129], v0 offset:26880
    v_pk_fma_f16 v164, v209, v209, v164
    v_mfma_f32_16x16x32_bf16 v[114:117], v[198:201], a[196:199], v[114:117]
    s_addc_u32 s9, s41, 0
    ds_read_b128 v[166:169], v1 offset:26880
    v_cvt_pk_f16_f32 v194, v218, v219
    v_mfma_f32_16x16x32_bf16 v[114:117], v[210:213], a[200:203], v[114:117]
    s_waitcnt lgkmcnt(6)
    v_pk_fma_f16 v162, v194, v194, v162
    v_cvt_pk_f16_f32 v195, v220, v221
    v_mfma_f32_16x16x32_bf16 v[198:201], v[32:35], v[230:233], 0
    s_sub_u32 s10, s36, s23
    v_pk_fma_f16 v164, v195, v195, v164
    v_cvt_pk_bf16_f32 v174, v170, v171
    v_mfma_f32_16x16x32_bf16 v[198:201], v[32:35], v[238:241], v[198:201]
    s_waitcnt lgkmcnt(5)
    v_cvt_pk_bf16_f32 v175, v172, v173
    v_cvt_pk_bf16_f32 v182, v234, v235
    v_mfma_f32_16x16x32_f16 v[170:173], v[40:43], v[162:165], 0
    s_cmp_lt_u32 s34, s17
    v_cvt_pk_bf16_f32 v183, v236, v237
    s_cselect_b32 s10, s10, 0
    v_mfma_f32_16x16x32_bf16 v[114:117], v[222:225], a[204:207], v[114:117]
    s_add_u32 m0, s28, 0
    v_mul_f32 v255, 0x3baaaaab, v198
    v_mul_f32 v254, 0x3baaaaab, v199
    v_mfma_f32_16x16x32_bf16 v[114:117], v[226:229], a[208:211], v[114:117]
    s_mov_b32 s27, s26
    v_rsq_f32 v172, v170
    v_mfma_f32_16x16x32_bf16 v[114:117], v[242:245], a[212:215], v[114:117]
    s_mov_b32 s26, s25
    v_rsq_f32 v173, v171
    v_mfma_f32_16x16x32_bf16 v[162:165], a[72:75], v[134:137], 0
    s_waitcnt lgkmcnt(0)
    v_mul_f32 v172, s31, v172
    v_cvt_pk_f16_f32 v172, v172, v173
    v_mfma_f32_16x16x32_bf16 v[162:165], a[76:79], v[154:157], v[162:165]
    s_mov_b32 s25, s24
    v_cvt_pk_bf16_f32 v114, v114, v115
    v_cvt_pk_bf16_f32 v115, v116, v117
    v_mfma_f32_16x16x32_bf16 v[162:165], a[80:83], v[130:133], v[162:165]
    s_mov_b32 s24, s23
    v_pk_mul_f16 v118, v118, v172 op_sel:[0,1] op_sel_hi:[1,1]
    v_pk_mul_f16 v119, v119, v172 op_sel:[0,1] op_sel_hi:[1,1]
    v_mfma_f32_16x16x32_bf16 v[162:165], a[84:87], v[122:125], v[162:165]
    v_pk_mul_f16 v120, v120, v172 op_sel:[0,1] op_sel_hi:[1,1]
    v_pk_mul_f16 v121, v121, v172 op_sel:[0,1] op_sel_hi:[1,1]
    v_mfma_f32_16x16x32_bf16 v[162:165], a[88:91], v[126:129], v[162:165]
    v_pk_mul_f16 v196, v196, v172 op_sel:[0,1] op_sel_hi:[1,1]
    v_pk_mul_f16 v197, v197, v172 op_sel:[0,1] op_sel_hi:[1,1]
    v_mfma_f32_16x16x32_bf16 v[162:165], a[92:95], v[166:169], v[162:165]
    v_pk_mul_f16 v206, v206, v172 op_sel:[0,0] op_sel_hi:[1,0]
    v_pk_mul_f16 v207, v207, v172 op_sel:[0,0] op_sel_hi:[1,0]
    v_mfma_f32_16x16x32_bf16 v[210:213], a[96:99], v[134:137], 0
    v_pk_mul_f16 v208, v208, v172 op_sel:[0,0] op_sel_hi:[1,0]
    v_pk_mul_f16 v209, v209, v172 op_sel:[0,0] op_sel_hi:[1,0]
    v_mfma_f32_16x16x32_bf16 v[210:213], a[100:103], v[154:157], v[210:213]
    v_pk_mul_f16 v194, v194, v172 op_sel:[0,0] op_sel_hi:[1,0]
    v_pk_mul_f16 v195, v195, v172 op_sel:[0,0] op_sel_hi:[1,0]
    v_mfma_f32_16x16x32_bf16 v[210:213], a[104:107], v[130:133], v[210:213]
    v_min3_u32 v44, v44, v170, v171
    v_max3_u32 v45, v45, v170, v171
    v_mfma_f32_16x16x32_bf16 v[210:213], a[108:111], v[122:125], v[210:213]
    v_cvt_pk_f16_f32 v170, v162, v163
    v_pk_mul_f16 v163, v170, v170
    v_mfma_f32_16x16x32_bf16 v[210:213], a[112:115], v[126:129], v[210:213]
    v_cvt_pk_f16_f32 v171, v164, v165
    v_pk_mul_f16 v165, v171, v171
    v_mfma_f32_16x16x32_bf16 v[210:213], a[116:119], v[166:169], v[210:213]
    v_rsq_f32 v255, v255
    v_mfma_f32_16x16x32_bf16 v[214:217], a[120:123], v[134:137], 0
    v_rsq_f32 v254, v254
    v_mfma_f32_16x16x32_bf16 v[214:217], a[124:127], v[154:157], v[214:217]
    v_mul_f32 v142, v254, v142
    v_mul_f32 v143, v254, v143
    v_mfma_f32_16x16x32_bf16 v[214:217], a[128:131], v[130:133], v[214:217]
    v_cvt_pk_bf16_f32 v142, v142, v143
    v_cvt_pk_f16_f32 v172, v210, v211
    v_mfma_f32_16x16x32_bf16 v[214:217], a[132:135], v[122:125], v[214:217]
    v_pk_fma_f16 v163, v172, v172, v163
    v_cvt_pk_f16_f32 v173, v212, v213
    v_mfma_f32_16x16x32_bf16 v[214:217], a[136:139], v[126:129], v[214:217]
    v_pk_fma_f16 v165, v173, v173, v165
    v_mul_f32 v144, v254, v144
    v_mfma_f32_16x16x32_bf16 v[214:217], a[140:143], v[166:169], v[214:217]
    v_mul_f32 v145, v254, v145
    v_cvt_pk_bf16_f32 v143, v144, v145
    v_mfma_f32_16x16x32_bf16 v[210:213], a[0:3], v[134:137], 0
    v_mul_f32 v158, v254, v158
    v_mul_f32 v159, v254, v159
    v_mfma_f32_16x16x32_bf16 v[210:213], a[4:7], v[154:157], v[210:213]
    v_cvt_pk_bf16_f32 v144, v158, v159
    v_mul_f32 v160, v254, v160
    v_mfma_f32_16x16x32_bf16 v[210:213], a[8:11], v[130:133], v[210:213]
    v_cvt_pk_f16_f32 v220, v214, v215
    v_pk_fma_f16 v163, v220, v220, v163
    v_mfma_f32_16x16x32_bf16 v[210:213], a[12:15], v[122:125], v[210:213]
    v_cvt_pk_f16_f32 v221, v216, v217
    v_pk_fma_f16 v165, v221, v221, v165
    v_mfma_f32_16x16x32_bf16 v[210:213], a[16:19], v[126:129], v[210:213]
    v_mul_f32 v161, v254, v161
    v_cvt_pk_bf16_f32 v145, v160, v161
    v_mfma_f32_16x16x32_bf16 v[210:213], a[20:23], v[166:169], v[210:213]
    buffer_store_dwordx4 v[142:145], v16, s[12:15], 0 offen nt
    v_mul_f32 v178, v254, v178
    v_mul_f32 v179, v254, v179
    v_cvt_pk_bf16_f32 v198, v178, v179
    v_mul_f32 v180, v254, v180
    v_mfma_f32_16x16x32_bf16 v[142:145], a[24:27], v[134:137], 0
    v_mul_f32 v181, v254, v181
    v_cvt_pk_bf16_f32 v199, v180, v181
    v_mfma_f32_16x16x32_bf16 v[142:145], a[28:31], v[154:157], v[142:145]
    v_cvt_pk_f16_f32 v158, v210, v211
    v_pk_mul_f16 v162, v158, v158
    v_mfma_f32_16x16x32_bf16 v[142:145], a[32:35], v[130:133], v[142:145]
    v_cvt_pk_f16_f32 v159, v212, v213
    v_pk_mul_f16 v164, v159, v159
    v_mfma_f32_16x16x32_bf16 v[142:145], a[36:39], v[122:125], v[142:145]
    v_mul_f32 v254, 0x3baaaaab, v200
    v_mul_f32 v150, v255, v150
    v_mfma_f32_16x16x32_bf16 v[142:145], a[40:43], v[126:129], v[142:145]
    v_rsq_f32 v254, v254
    v_mfma_f32_16x16x32_bf16 v[142:145], a[44:47], v[166:169], v[142:145]
    v_mul_f32 v146, v254, v146
    v_mul_f32 v147, v254, v147
    v_mfma_f32_16x16x32_bf16 v[178:181], a[48:51], v[134:137], 0
    v_cvt_pk_bf16_f32 v146, v146, v147
    v_mul_f32 v148, v254, v148
    v_mfma_f32_16x16x32_bf16 v[178:181], a[52:55], v[154:157], v[178:181]
    v_mul_f32 v149, v254, v149
    v_cvt_pk_bf16_f32 v147, v148, v149
    v_mfma_f32_16x16x32_bf16 v[178:181], a[56:59], v[130:133], v[178:181]
    v_mul_f32 v138, v254, v138
    v_mul_f32 v139, v254, v139
    v_mfma_f32_16x16x32_bf16 v[178:181], a[60:63], v[122:125], v[178:181]
    v_cvt_pk_bf16_f32 v148, v138, v139
    v_mul_f32 v140, v254, v140
    v_mfma_f32_16x16x32_bf16 v[178:181], a[64:67], v[126:129], v[178:181]
    v_mul_f32 v141, v254, v141
    v_cvt_pk_bf16_f32 v149, v140, v141
    v_mfma_f32_16x16x32_bf16 v[178:181], a[68:71], v[166:169], v[178:181]
    v_mul_f32 v186, v254, v186
    v_mul_f32 v187, v254, v187
    v_mfma_f32_16x16x32_bf16 v[138:141], v[134:137], a[144:147], 0
    v_cvt_pk_bf16_f32 v200, v186, v187
    v_mul_f32 v188, v254, v188
    v_mfma_f32_16x16x32_bf16 v[138:141], v[154:157], a[148:151], v[138:141]
    v_mul_f32 v189, v254, v189
    v_cvt_pk_bf16_f32 v201, v188, v189
    v_mfma_f32_16x16x32_bf16 v[138:141], v[130:133], a[152:155], v[138:141]
    v_cvt_pk_f16_f32 v160, v142, v143
    v_pk_fma_f16 v162, v160, v160, v162
    v_mfma_f32_16x16x32_bf16 v[138:141], v[122:125], a[156:159], v[138:141]
    v_cvt_pk_f16_f32 v161, v144, v145
    v_pk_fma_f16 v164, v161, v161, v164
    v_mfma_f32_16x16x32_bf16 v[138:141], v[126:129], a[160:163], v[138:141]
    buffer_store_dwordx4 v[146:149], v17, s[12:15], 0 offen nt
    v_cvt_pk_f16_f32 v218, v178, v179
    v_pk_fma_f16 v162, v218, v218, v162
    v_cvt_pk_f16_f32 v219, v180, v181
    v_pk_fma_f16 v164, v219, v219, v164
    v_mfma_f32_16x16x32_bf16 v[138:141], v[166:169], a[164:167], v[138:141]
    v_mul_f32 v151, v255, v151
    v_cvt_pk_bf16_f32 v150, v150, v151
    v_mfma_f32_16x16x32_f16 v[142:145], v[40:43], v[162:165], 0
    v_mul_f32 v152, v255, v152
    v_mul_f32 v153, v255, v153
    v_mfma_f32_16x16x32_bf16 v[178:181], v[134:137], a[168:171], 0
    v_cvt_pk_bf16_f32 v151, v152, v153
    v_mul_f32 v190, v255, v190
    v_mfma_f32_16x16x32_bf16 v[178:181], v[154:157], a[172:175], v[178:181]
    v_cvt_pk_bf16_f32 v176, v138, v139
    v_cvt_pk_bf16_f32 v177, v140, v141
    v_mfma_f32_16x16x32_bf16 v[178:181], v[130:133], a[176:179], v[178:181]
    ds_read_b128 v[146:149], v0 offset:32768
    v_min3_u32 v44, v44, v142, v143
    v_mfma_f32_16x16x32_bf16 v[178:181], v[122:125], a[180:183], v[178:181]
    ds_read_b128 v[138:141], v1 offset:32768
    v_max3_u32 v45, v45, v142, v143
    v_mfma_f32_16x16x32_bf16 v[178:181], v[126:129], a[184:187], v[178:181]
    ds_read_b128 v[186:189], v0 offset:32896
    v_mul_f32 v191, v255, v191
    v_mfma_f32_16x16x32_bf16 v[178:181], v[166:169], a[188:191], v[178:181]
    ds_read_b128 v[162:165], v1 offset:32896
    v_cvt_pk_bf16_f32 v152, v190, v191
    v_mfma_f32_16x16x32_bf16 v[210:213], v[134:137], a[192:195], 0
    ds_read_b128 v[134:137], v0 offset:33024
    v_mul_f32 v192, v255, v192
    v_mfma_f32_16x16x32_bf16 v[210:213], v[154:157], a[196:199], v[210:213]
    ds_read_b128 v[154:157], v1 offset:33024
    v_mul_f32 v193, v255, v193
    v_mfma_f32_16x16x32_bf16 v[210:213], v[130:133], a[200:203], v[210:213]
    v_rsq_f32 v144, v142
    v_mfma_f32_16x16x32_bf16 v[210:213], v[122:125], a[204:207], v[210:213]
    v_rsq_f32 v145, v143
    v_mfma_f32_16x16x32_bf16 v[210:213], v[126:129], a[208:211], v[210:213]
    s_waitcnt lgkmcnt(5)
    v_mul_f32 v144, s31, v144
    v_cvt_pk_f16_f32 v144, v144, v145
    v_mfma_f32_16x16x32_bf16 v[210:213], v[166:169], a[212:215], v[210:213]
    s_waitcnt lgkmcnt(4)
    v_cvt_pk_bf16_f32 v184, v178, v179
    v_cvt_pk_bf16_f32 v185, v180, v181
    v_mfma_f32_16x16x32_bf16 v[178:181], a[72:75], v[146:149], 0
    s_waitcnt lgkmcnt(3)
    v_pk_mul_f16 v170, v170, v144 op_sel:[0,1] op_sel_hi:[1,1]
    v_pk_mul_f16 v171, v171, v144 op_sel:[0,1] op_sel_hi:[1,1]
    v_mfma_f32_16x16x32_bf16 v[178:181], a[76:79], v[138:141], v[178:181]
    s_waitcnt lgkmcnt(2)
    v_cvt_pk_bf16_f32 v116, v210, v211
    v_cvt_pk_bf16_f32 v117, v212, v213
    v_mfma_f32_16x16x32_bf16 v[178:181], a[80:83], v[186:189], v[178:181]
    s_waitcnt lgkmcnt(1)
    buffer_store_dwordx2 v[200:201], v20, s[12:15], 0 offen nt
    v_pk_mul_f16 v172, v172, v144 op_sel:[0,1] op_sel_hi:[1,1]
    v_pk_mul_f16 v173, v173, v144 op_sel:[0,1] op_sel_hi:[1,1]
    v_mfma_f32_16x16x32_bf16 v[178:181], a[84:87], v[162:165], v[178:181]
    s_waitcnt lgkmcnt(0)
    v_pk_mul_f16 v220, v220, v144 op_sel:[0,1] op_sel_hi:[1,1]
    v_pk_mul_f16 v221, v221, v144 op_sel:[0,1] op_sel_hi:[1,1]
    v_mfma_f32_16x16x32_bf16 v[178:181], a[88:91], v[134:137], v[178:181]
    v_pk_mul_f16 v158, v158, v144 op_sel:[0,0] op_sel_hi:[1,0]
    v_pk_mul_f16 v159, v159, v144 op_sel:[0,0] op_sel_hi:[1,0]
    v_mfma_f32_16x16x32_bf16 v[178:181], a[92:95], v[154:157], v[178:181]
    v_pk_mul_f16 v160, v160, v144 op_sel:[0,0] op_sel_hi:[1,0]
    v_pk_mul_f16 v161, v161, v144 op_sel:[0,0] op_sel_hi:[1,0]
    v_mfma_f32_16x16x32_bf16 v[130:133], a[96:99], v[146:149], 0
    v_pk_mul_f16 v218, v218, v144 op_sel:[0,0] op_sel_hi:[1,0]
    v_pk_mul_f16 v219, v219, v144 op_sel:[0,0] op_sel_hi:[1,0]
    v_mfma_f32_16x16x32_bf16 v[130:133], a[100:103], v[138:141], v[130:133]
    s_waitcnt vmcnt(3)
    v_cvt_pk_bf16_f32 v153, v192, v193
    v_cvt_pk_f16_f32 v142, v178, v179
    v_mfma_f32_16x16x32_bf16 v[130:133], a[104:107], v[186:189], v[130:133]
    s_nop 0
    v_pk_mul_f16 v191, v142, v142
    v_cvt_pk_f16_f32 v143, v180, v181
    v_mfma_f32_16x16x32_bf16 v[130:133], a[108:111], v[162:165], v[130:133]
    s_barrier
    v_pk_mul_f16 v193, v143, v143
    v_mul_f32 v202, v255, v202
    v_mfma_f32_16x16x32_bf16 v[130:133], a[112:115], v[134:137], v[130:133]
    s_nop 0
    v_mul_f32 v203, v255, v203
    v_cvt_pk_bf16_f32 v254, v202, v203
    v_mfma_f32_16x16x32_bf16 v[130:133], a[116:119], v[154:157], v[130:133]
    s_nop 0
    v_mul_f32 v204, v255, v204
    v_mul_f32 v205, v255, v205
    v_mfma_f32_16x16x32_bf16 v[178:181], a[120:123], v[146:149], 0
    v_cvt_pk_bf16_f32 v255, v204, v205
    v_xor_b32 v0, 65536, v0
    v_mfma_f32_16x16x32_bf16 v[178:181], a[124:127], v[138:141], v[178:181]
    v_xor_b32 v1, 65536, v1
    v_cvt_pk_f16_f32 v144, v130, v131
    v_mfma_f32_16x16x32_bf16 v[178:181], a[128:131], v[186:189], v[178:181]
    v_pk_fma_f16 v191, v144, v144, v191
    v_cvt_pk_f16_f32 v145, v132, v133
    v_mfma_f32_16x16x32_bf16 v[178:181], a[132:135], v[162:165], v[178:181]
    v_pk_fma_f16 v193, v145, v145, v193
    v_mfma_f32_16x16x32_bf16 v[178:181], a[136:139], v[134:137], v[178:181]
    v_mfma_f32_16x16x32_bf16 v[178:181], a[140:143], v[154:157], v[178:181]
    v_mfma_f32_16x16x32_bf16 v[202:205], a[0:3], v[146:149], 0
    v_mfma_f32_16x16x32_bf16 v[202:205], a[4:7], v[138:141], v[202:205]
    buffer_load_dwordx4 v10, s[8:11], 0 offen nt lds
    s_add_u32 m0, s28, 4096
    v_mfma_f32_16x16x32_bf16 v[202:205], a[8:11], v[186:189], v[202:205]
    v_mfma_f32_16x16x32_bf16 v[202:205], a[12:15], v[162:165], v[202:205]
    v_mfma_f32_16x16x32_bf16 v[202:205], a[16:19], v[134:137], v[202:205]
    v_mfma_f32_16x16x32_bf16 v[202:205], a[20:23], v[154:157], v[202:205]
    v_cvt_pk_f16_f32 v124, v178, v179
    v_pk_fma_f16 v191, v124, v124, v191
    v_mfma_f32_16x16x32_bf16 v[130:133], a[24:27], v[146:149], 0
    buffer_load_dwordx4 v11, s[8:11], 0 offen nt lds
    v_cvt_pk_f16_f32 v125, v180, v181
    v_mfma_f32_16x16x32_bf16 v[130:133], a[28:31], v[138:141], v[130:133]
    s_add_u32 m0, s28, 8192
    v_pk_fma_f16 v193, v125, v125, v193
    v_cvt_pk_f16_f32 v178, v202, v203
    v_mfma_f32_16x16x32_bf16 v[130:133], a[32:35], v[186:189], v[130:133]
    v_pk_mul_f16 v190, v178, v178
    v_cvt_pk_f16_f32 v179, v204, v205
    v_mfma_f32_16x16x32_bf16 v[130:133], a[36:39], v[162:165], v[130:133]
    v_pk_mul_f16 v192, v179, v179
    v_mfma_f32_16x16x32_bf16 v[130:133], a[40:43], v[134:137], v[130:133]
    v_mfma_f32_16x16x32_bf16 v[130:133], a[44:47], v[154:157], v[130:133]
    buffer_load_dwordx4 v12, s[8:11], 0 offen nt lds
    s_add_u32 m0, s28, 12288
    v_mfma_f32_16x16x32_bf16 v[202:205], a[48:51], v[146:149], 0
    s_xor_b32 s28, s28, 65536
    v_mfma_f32_16x16x32_bf16 v[202:205], a[52:55], v[138:141], v[202:205]
    ds_read_b128 v[166:169], v5 offset:0
    ds_read_b128 v[126:129], v5 offset:16
    v_mfma_f32_16x16x32_bf16 v[202:205], a[56:59], v[186:189], v[202:205]
    ds_read_b128 v[210:213], v5 offset:48
    ds_read_b32 v200, v6 offset:192
    v_mfma_f32_16x16x32_bf16 v[202:205], a[60:63], v[162:165], v[202:205]
    v_cvt_pk_f16_f32 v180, v130, v131
    v_pk_fma_f16 v190, v180, v180, v190
    v_mfma_f32_16x16x32_bf16 v[202:205], a[64:67], v[134:137], v[202:205]
    buffer_load_dwordx4 v13, s[8:11], 0 offen nt lds
    v_cvt_pk_f16_f32 v181, v132, v133
    v_mfma_f32_16x16x32_bf16 v[202:205], a[68:71], v[154:157], v[202:205]
    s_mov_b32 m0, s29
    v_pk_fma_f16 v192, v181, v181, v192
    v_add_u32 v5, 336, v5
    v_mfma_f32_16x16x32_bf16 v[130:133], v[146:149], a[144:147], 0
    s_xor_b32 s29, s29, s30
    s_add_u32 s19, s19, s20
    s_add_u32 s23, s23, s21
    v_mfma_f32_16x16x32_bf16 v[130:133], v[138:141], a[148:151], v[130:133]
    s_cmp_ge_u32 s19, 72
    v_cvt_pk_f16_f32 v122, v202, v203
    v_pk_fma_f16 v190, v122, v122, v190
    v_mfma_f32_16x16x32_bf16 v[130:133], v[186:189], a[152:155], v[130:133]
    s_cselect_b32 s34, 72, 0
    v_cvt_pk_f16_f32 v123, v204, v205
    v_pk_fma_f16 v192, v123, v123, v192
    v_mfma_f32_16x16x32_bf16 v[130:133], v[162:165], a[156:159], v[130:133]
    s_waitcnt lgkmcnt(2)
    buffer_store_dwordx2 v[198:199], v19, s[12:15], 0 offen nt
    s_cselect_b32 s35, s22, 0
    s_sub_u32 s19, s19, s34
    v_mfma_f32_16x16x32_f16 v[202:205], v[40:43], v[190:193], 0
    s_add_u32 s23, s23, s35
    s_add_u32 s18, s18, 1
    s_cmp_lt_u32 s18, s45
    v_mfma_f32_16x16x32_f16 v[214:217], v[166:169], v[158:161], v[24:27]
    s_waitcnt lgkmcnt(0)
    v_mfma_f32_16x16x32_f16 v[214:217], v[126:129], v[170:173], v[214:217]
    v_mfma_f32_16x16x32_f16 v[214:217], v[210:213], v[218:221], v[214:217]
    v_mfma_f32_16x16x32_f16 v[190:193], v[166:169], v[206:209], v[22:25]
    v_rsq_f32 v204, v202
    v_mfma_f32_16x16x32_f16 v[190:193], v[126:129], v[118:121], v[190:193]
    v_rsq_f32 v205, v203
    v_mfma_f32_16x16x32_f16 v[190:193], v[210:213], v[194:197], v[190:193]
    v_mul_f32 v204, s31, v204
    v_cvt_pk_f16_f32 v204, v204, v205
    v_mfma_f32_16x16x32_bf16 v[130:133], v[134:137], a[160:163], v[130:133]
    v_pk_mul_f16 v142, v142, v204 op_sel:[0,1] op_sel_hi:[1,1]
    v_pk_mul_f16 v143, v143, v204 op_sel:[0,1] op_sel_hi:[1,1]
    v_mfma_f32_16x16x32_bf16 v[130:133], v[154:157], a[164:167], v[130:133]
    v_pk_mul_f16 v144, v144, v204 op_sel:[0,1] op_sel_hi:[1,1]
    v_pk_mul_f16 v145, v145, v204 op_sel:[0,1] op_sel_hi:[1,1]
    v_mfma_f32_16x16x32_bf16 v[222:225], v[146:149], a[168:171], 0
    v_mov_b32_dpp v200, v191 quad_perm:[0,1,2,3] row_mask:0x1 bank_mask:0xf
    v_mov_b32_dpp v200, v215 quad_perm:[0,1,2,3] row_mask:0x2 bank_mask:0xf
    v_mfma_f32_16x16x32_bf16 v[222:225], v[138:141], a[172:175], v[222:225]
    v_pk_mul_f16 v124, v124, v204 op_sel:[0,1] op_sel_hi:[1,1]
    v_pk_mul_f16 v125, v125, v204 op_sel:[0,1] op_sel_hi:[1,1]
    v_mfma_f32_16x16x32_bf16 v[222:225], v[186:189], a[176:179], v[222:225]
    v_cvt_pk_bf16_f32 v130, v130, v131
    v_cvt_pk_bf16_f32 v131, v132, v133
    v_mfma_f32_16x16x32_bf16 v[222:225], v[162:165], a[180:183], v[222:225]
    v_pk_mul_f16 v178, v178, v204 op_sel:[0,0] op_sel_hi:[1,0]
    v_pk_mul_f16 v179, v179, v204 op_sel:[0,0] op_sel_hi:[1,0]
    v_mfma_f32_16x16x32_f16 v[226:229], v[118:121], v[206:209], v[46:49]
    v_pk_mul_f16 v180, v180, v204 op_sel:[0,0] op_sel_hi:[1,0]
    v_pk_mul_f16 v181, v181, v204 op_sel:[0,0] op_sel_hi:[1,0]
    v_mfma_f32_16x16x32_f16 v[230:233], v[170:173], v[206:209], v[50:53]
    v_pk_mul_f16 v122, v122, v204 op_sel:[0,0] op_sel_hi:[1,0]
    v_pk_mul_f16 v123, v123, v204 op_sel:[0,0] op_sel_hi:[1,0]
    v_mfma_f32_16x16x32_f16 v[234:237], v[142:145], v[206:209], v[54:57]
    v_min3_u32 v44, v44, v202, v203
    v_exp_f32 v214, v214
    v_mfma_f32_16x16x16_f16 v[226:229], v[196:197], v[194:195], v[226:229]
    v_max3_u32 v45, v45, v202, v203
    v_exp_f32 v190, v190
    v_mfma_f32_16x16x16_f16 v[230:233], v[220:221], v[194:195], v[230:233]
    v_cvt_pk_bf16_f32 v39, v190, 0
    v_mfma_f32_16x16x16_f16 v[234:237], v[124:125], v[194:195], v[234:237]
    buffer_store_dwordx4 v[150:153], v15, s[12:15], 0 offen nt
    v_mfma_f32_16x16x32_bf16 v[222:225], v[134:137], a[184:187], v[222:225]
    v_mfma_f32_16x16x32_bf16 v[222:225], v[154:157], a[188:191], v[222:225]
    ds_read_b128 v[206:209], v2 offset:0
    v_mfma_f32_16x16x32_bf16 v[150:153], v[146:149], a[192:195], 0
    ds_read_b128 v[146:149], v2 offset:1024
    v_mfma_f32_16x16x32_bf16 v[150:153], v[138:141], a[196:199], v[150:153]
    ds_read_b128 v[138:141], v2 offset:2048
    v_mfma_f32_16x16x32_bf16 v[150:153], v[186:189], a[200:203], v[150:153]
    ds_read_b128 v[186:189], v2 offset:3072
    v_mfma_f32_16x16x32_bf16 v[150:153], v[162:165], a[204:207], v[150:153]
    ds_read_b128 v[162:165], v2 offset:4096
    v_cvt_pk_bf16_f32 v222, v222, v223
    v_mfma_f32_16x16x32_bf16 v[150:153], v[134:137], a[208:211], v[150:153]
    ds_read_b128 v[134:137], v2 offset:5120
    v_cvt_pk_bf16_f32 v223, v224, v225
    v_mfma_f32_16x16x32_bf16 v[150:153], v[154:157], a[212:215], v[150:153]
    ds_read2_b32 v[132:133], v6 offset0:0 offset1:0
    ds_read2_b32 v[224:225], v6 offset0:16 offset1:16
    v_mfma_f32_16x16x32_f16 v[154:157], v[166:169], v[178:181], v[26:29]
    ds_read2_b32 v[168:169], v6 offset0:32 offset1:32
    v_add_u32 v6, 272, v6
    v_mfma_f32_16x16x32_f16 v[154:157], v[126:129], v[142:145], v[154:157]
    s_waitcnt lgkmcnt(8)
    v_exp_f32 v226, v226
    v_mfma_f32_16x16x32_f16 v[154:157], v[210:213], v[122:125], v[154:157]
    s_waitcnt lgkmcnt(7)
    v_cvt_pk_bf16_f32 v166, v150, v151
    v_cvt_pk_bf16_f32 v167, v152, v153
    v_mfma_f32_16x16x32_bf16 v[150:153], a[216:219], v[206:209], 0
    s_waitcnt lgkmcnt(6)
    v_exp_f32 v227, v227
    v_mfma_f32_16x16x32_bf16 v[150:153], a[220:223], v[146:149], v[150:153]
    s_waitcnt lgkmcnt(5)
    v_exp_f32 v154, v154
    v_mfma_f32_16x16x32_bf16 v[150:153], a[224:227], v[138:141], v[150:153]
    s_waitcnt lgkmcnt(4)
    v_mov_b32_dpp v200, v155 quad_perm:[0,1,2,3] row_mask:0x4 bank_mask:0xf
    v_cvt_pk_bf16_f32 v126, v226, v227
    v_mfma_f32_16x16x32_bf16 v[150:153], a[228:231], v[186:189], v[150:153]
    s_waitcnt lgkmcnt(3)
    v_exp_f32 v200, v200
    v_mfma_f32_16x16x32_bf16 v[150:153], a[232:235], v[162:165], v[150:153]
    s_waitcnt lgkmcnt(1)
    v_exp_f32 v228, v228
    v_mfma_f32_16x16x32_bf16 v[150:153], a[236:239], v[134:137], v[150:153]
    s_waitcnt lgkmcnt(0)
    buffer_store_dwordx2 v[254:255], v18, s[12:15], 0 offen nt
    v_exp_f32 v229, v229
    v_mfma_f32_16x16x32_bf16 v[190:193], a[240:243], v[206:209], 0
    v_cvt_pk_bf16_f32 v200, v200, v200
    v_cvt_pk_bf16_f32 v127, v228, v229
    v_mfma_f32_16x16x32_bf16 v[190:193], a[244:247], v[146:149], v[190:193]
    ds_write_b16 v8, v200
    v_mfma_f32_16x16x32_bf16 v[190:193], a[248:251], v[138:141], v[190:193]
    v_exp_f32 v230, v230
    v_mfma_f32_16x16x32_bf16 v[190:193], a[252:255], v[186:189], v[190:193]
    ds_read_b128 v[198:201], v2 offset:6144
    ds_read_b128 v[210:213], v9
    v_mfma_f32_16x16x32_bf16 v[190:193], v[82:85], v[162:165], v[190:193]
    ds_read_b128 v[226:229], v2 offset:7168
    ds_read_b128 v[238:241], v9 offset:64
    v_mfma_f32_16x16x32_bf16 v[190:193], v[86:89], v[134:137], v[190:193]
    v_exp_f32 v231, v231
    v_mfma_f32_16x16x32_bf16 v[202:205], v[90:93], v[206:209], 0
    ds_read_b128 v[206:209], v2 offset:8192
    ds_read_b128 v[242:245], v2 offset:9216
    v_mfma_f32_16x16x32_bf16 v[202:205], v[94:97], v[146:149], v[202:205]
    v_cvt_pk_bf16_f32 v128, v230, v231
    v_fma_f32 v254, v150, v150, s33
    v_mfma_f32_16x16x32_bf16 v[202:205], v[98:101], v[138:141], v[202:205]
    ds_read_b128 v[146:149], v2 offset:10240
    ds_read_b128 v[138:141], v2 offset:11264
    v_mfma_f32_16x16x32_bf16 v[202:205], v[102:105], v[186:189], v[202:205]
    v_exp_f32 v232, v232
    v_mfma_f32_16x16x32_bf16 v[202:205], v[106:109], v[162:165], v[202:205]
    v_exp_f32 v233, v233
    v_mfma_f32_16x16x32_bf16 v[202:205], v[110:113], v[134:137], v[202:205]
    s_waitcnt lgkmcnt(6)
    v_cvt_pk_bf16_f32 v129, v232, v233
    v_fmac_f32 v254, v151, v151
    v_mfma_f32_16x16x32_bf16 v[186:189], v[210:213], v[28:31], 0
    s_waitcnt lgkmcnt(4)
    v_exp_f32 v234, v234
    v_mfma_f32_16x16x32_bf16 v[186:189], v[238:241], v[28:31], v[186:189]
    v_exp_f32 v235, v235
    v_mfma_f32_16x16x32_f16 v[134:137], v[118:121], v[158:161], v[58:61]
    s_waitcnt lgkmcnt(2)
    v_cvt_pk_bf16_f32 v36, v234, v235
    v_fmac_f32 v254, v152, v152
    v_mfma_f32_16x16x32_f16 v[162:165], v[170:173], v[158:161], v[62:65]
    v_exp_f32 v236, v236
    v_mfma_f32_16x16x32_f16 v[230:233], v[142:145], v[158:161], v[66:69]
    s_waitcnt lgkmcnt(0)
    buffer_load_dwordx4 v14, s[8:11], 0 offen nt lds
    v_rcp_f32 v186, v186
    v_mfma_f32_16x16x16_f16 v[134:137], v[196:197], v[218:219], v[134:137]
    v_exp_f32 v237, v237
    v_fmac_f32 v254, v153, v153
    v_mfma_f32_16x16x16_f16 v[162:165], v[220:221], v[218:219], v[162:165]
    v_cvt_pk_bf16_f32 v37, v236, v237
    v_fmac_f32 v254, v190, v190
    v_fmac_f32 v254, v191, v191
    v_mfma_f32_16x16x16_f16 v[230:233], v[124:125], v[218:219], v[230:233]
    v_fmac_f32 v254, v192, v192
    v_exp_f32 v134, v134
    v_fmac_f32 v254, v193, v193
    v_mfma_f32_16x16x32_bf16 v[158:161], v[210:213], v[174:177], 0
    v_exp_f32 v135, v135
    v_mfma_f32_16x16x32_bf16 v[158:161], v[238:241], v[130:133], v[158:161]
    v_cvt_pk_bf16_f32 v134, v134, v135
    v_fmac_f32 v254, v202, v202
    v_mfma_f32_16x16x32_bf16 v[234:237], v[210:213], v[182:185], 0
    v_exp_f32 v136, v136
    v_mfma_f32_16x16x32_bf16 v[234:237], v[238:241], v[222:225], v[234:237]
    v_exp_f32 v137, v137
    v_mfma_f32_16x16x32_bf16 v[246:249], v[210:213], v[114:117], 0
    v_cvt_pk_bf16_f32 v135, v136, v137
    v_mul_f32 v158, v158, v186
    v_mfma_f32_16x16x32_bf16 v[246:249], v[238:241], v[166:169], v[246:249]
    v_exp_f32 v162, v162
    v_mfma_f32_16x16x32_bf16 v[210:213], v[28:31], v[36:39], 0
    v_exp_f32 v163, v163
    v_mfma_f32_16x16x32_bf16 v[210:213], v[28:31], v[126:129], v[210:213]
    v_cvt_pk_bf16_f32 v136, v162, v163
    v_mul_f32_dpp v158, v234, v186 quad_perm:[0,1,2,3] row_mask:0x2 bank_mask:0xf
    v_mfma_f32_16x16x32_bf16 v[234:237], v[130:133], v[36:39], 0
    v_exp_f32 v164, v164
    v_mfma_f32_16x16x32_bf16 v[234:237], v[174:177], v[126:129], v[234:237]
    v_exp_f32 v165, v165
    v_mfma_f32_16x16x32_bf16 v[238:241], v[222:225], v[36:39], 0
    v_cvt_pk_bf16_f32 v137, v164, v165
    v_mul_f32_dpp v158, v246, v186 quad_perm:[0,1,2,3] row_mask:0x4 bank_mask:0xf
    v_mfma_f32_16x16x32_bf16 v[238:241], v[182:185], v[126:129], v[238:241]
    v_exp_f32 v230, v230
    v_mfma_f32_16x16x32_bf16 v[186:189], v[166:169], v[36:39], 0
    v_exp_f32 v231, v231
    v_mfma_f32_16x16x32_bf16 v[186:189], v[114:117], v[126:129], v[186:189]
    v_cvt_pk_bf16_f32 v36, v230, v231
    v_cvt_pk_bf16_f32 v39, v214, 0
    v_mfma_f32_16x16x32_f16 v[162:165], v[118:121], v[178:181], v[70:73]
    v_exp_f32 v232, v232
    v_mfma_f32_16x16x32_f16 v[118:121], v[170:173], v[178:181], v[74:77]
    v_exp_f32 v233, v233
    v_mfma_f32_16x16x32_f16 v[170:173], v[142:145], v[178:181], v[78:81]
    v_cvt_pk_bf16_f32 v37, v232, v233
    v_cvt_pk_bf16_f32 v158, v158, v158
    v_fmac_f32 v254, v203, v203
    v_mfma_f32_16x16x16_f16 v[162:165], v[196:197], v[122:123], v[162:165]
    v_rcp_f32 v210, v210
    v_fmac_f32 v254, v204, v204
    v_mfma_f32_16x16x16_f16 v[118:121], v[220:221], v[122:123], v[118:121]
    v_mul_f32 v234, v210, v234
    v_mul_f32 v235, v210, v235
    v_cvt_pk_bf16_f32 v178, v234, v235
    v_mfma_f32_16x16x16_f16 v[170:173], v[124:125], v[122:123], v[170:173]
    v_mul_f32 v236, v210, v236
    v_exp_f32 v162, v162
    v_mul_f32 v237, v210, v237
    v_mfma_f32_16x16x32_bf16 v[194:197], v[28:31], v[36:39], 0
    ds_write_b16 v7, v158
    v_mfma_f32_16x16x32_bf16 v[194:197], v[28:31], v[134:137], v[194:197]
    v_exp_f32 v163, v163
    v_mfma_f32_16x16x32_bf16 v[122:125], v[130:133], v[36:39], 0
    v_cvt_pk_bf16_f32 v162, v162, v163
    v_cvt_pk_bf16_f32 v179, v236, v237
    v_mfma_f32_16x16x32_bf16 v[122:125], v[174:177], v[134:137], v[122:125]
    v_exp_f32 v164, v164
    v_mfma_f32_16x16x32_bf16 v[126:129], v[222:225], v[36:39], 0
    v_exp_f32 v165, v165
    v_mfma_f32_16x16x32_bf16 v[126:129], v[182:185], v[134:137], v[126:129]
    v_cvt_pk_bf16_f32 v163, v164, v165
    v_mul_f32 v238, v210, v238
    v_mfma_f32_16x16x32_bf16 v[218:221], v[166:169], v[36:39], 0
    v_exp_f32 v118, v118
    v_mfma_f32_16x16x32_bf16 v[218:221], v[114:117], v[134:137], v[218:221]
    v_exp_f32 v119, v119
    v_mfma_f32_16x16x32_bf16 v[142:145], a[216:219], v[198:201], 0
    v_cvt_pk_bf16_f32 v164, v118, v119
    v_cvt_pk_bf16_f32 v39, v154, 0
    v_mfma_f32_16x16x32_bf16 v[142:145], a[220:223], v[226:229], v[142:145]
    v_exp_f32 v120, v120
    v_mfma_f32_16x16x32_bf16 v[142:145], a[224:227], v[206:209], v[142:145]
    v_exp_f32 v121, v121
    v_mfma_f32_16x16x32_bf16 v[142:145], a[228:231], v[242:245], v[142:145]
    v_cvt_pk_bf16_f32 v165, v120, v121
    v_mul_f32 v239, v210, v239
    v_mfma_f32_16x16x32_bf16 v[142:145], a[232:235], v[146:149], v[142:145]
    v_exp_f32 v170, v170
    v_mfma_f32_16x16x32_bf16 v[142:145], a[236:239], v[138:141], v[142:145]
    v_exp_f32 v171, v171
    v_mfma_f32_16x16x32_bf16 v[158:161], a[240:243], v[198:201], 0
    v_cvt_pk_bf16_f32 v36, v170, v171
    v_cvt_pk_bf16_f32 v180, v238, v239
    v_mfma_f32_16x16x32_bf16 v[158:161], a[244:247], v[226:229], v[158:161]
    v_exp_f32 v172, v172
    v_mfma_f32_16x16x32_bf16 v[158:161], a[248:251], v[206:209], v[158:161]
    v_exp_f32 v173, v173
    v_mfma_f32_16x16x32_bf16 v[158:161], a[252:255], v[242:245], v[158:161]
    ds_read_b128 v[118:121], v2 offset:12288
    v_cvt_pk_bf16_f32 v37, v172, v173
    v_mfma_f32_16x16x32_bf16 v[158:161], v[82:85], v[146:149], v[158:161]
    ds_read_b128 v[134:137], v2 offset:13312
    v_mul_f32 v240, v210, v240
    v_mfma_f32_16x16x32_bf16 v[170:173], v[28:31], v[36:39], 0
    v_mul_f32 v241, v210, v241
    v_cvt_pk_bf16_f32 v181, v240, v241
    v_mfma_f32_16x16x32_bf16 v[170:173], v[28:31], v[162:165], v[170:173]
    ds_write_b128 v3, v[178:181] offset:0
    v_mfma_f32_16x16x32_bf16 v[154:157], v[130:133], v[36:39], 0
    v_mul_f32 v186, v210, v186
    v_mul_f32 v187, v210, v187
    v_mfma_f32_16x16x32_bf16 v[154:157], v[174:177], v[162:165], v[154:157]
    v_cvt_pk_bf16_f32 v186, v186, v187
    v_mul_f32 v188, v210, v188
    v_mfma_f32_16x16x32_bf16 v[130:133], v[222:225], v[36:39], 0
    v_mul_f32 v189, v210, v189
    v_cvt_pk_bf16_f32 v187, v188, v189
    v_mfma_f32_16x16x32_bf16 v[130:133], v[182:185], v[162:165], v[130:133]
    s_waitcnt lgkmcnt(2)
    ds_write_b64 v4, v[186:187] offset:4096
    v_mfma_f32_16x16x32_bf16 v[174:177], v[166:169], v[36:39], 0
    s_waitcnt lgkmcnt(2)
    v_fma_f32 v255, v142, v142, s33
    v_fmac_f32 v255, v143, v143
    v_mfma_f32_16x16x32_bf16 v[174:177], v[114:117], v[162:165], v[174:177]
    v_fmac_f32 v255, v144, v144
    v_fmac_f32 v255, v145, v145
    v_mfma_f32_16x16x32_bf16 v[158:161], v[86:89], v[138:141], v[158:161]
    ds_read_b128 v[114:117], v2 offset:14336
    v_fmac_f32 v254, v205, v205
    v_mfma_f32_16x16x32_bf16 v[178:181], v[90:93], v[198:201], 0
    ds_read_b128 v[166:169], v2 offset:15360
    v_add_u32 v7, 16, v7
    v_mfma_f32_16x16x32_bf16 v[178:181], v[94:97], v[226:229], v[178:181]
    ds_read_b128 v[162:165], v2 offset:16384
    v_mfma_f32_16x16x32_bf16 v[178:181], v[98:101], v[206:209], v[178:181]
    ds_read_b128 v[206:209], v2 offset:17408
    v_fmac_f32 v255, v158, v158
    v_mfma_f32_16x16x32_bf16 v[178:181], v[102:105], v[242:245], v[178:181]
    v_fmac_f32 v255, v159, v159
    v_fmac_f32 v255, v160, v160
    v_mfma_f32_16x16x32_bf16 v[178:181], v[106:109], v[146:149], v[178:181]
    v_fmac_f32 v255, v161, v161
    v_xor_b32 v2, 65536, v2
    v_mfma_f32_16x16x32_bf16 v[178:181], v[110:113], v[138:141], v[178:181]
    v_rcp_f32 v170, v170
    v_mfma_f32_16x16x32_bf16 v[146:149], a[216:219], v[118:121], 0
    v_mul_f32 v154, v170, v154
    v_mul_f32 v155, v170, v155
    v_mfma_f32_16x16x32_bf16 v[146:149], a[220:223], v[134:137], v[146:149]
    s_waitcnt lgkmcnt(3)
    ds_read_b128 v[182:185], v0 offset:20480
    v_cvt_pk_bf16_f32 v154, v154, v155
    v_mfma_f32_16x16x32_bf16 v[146:149], a[224:227], v[114:117], v[146:149]
    s_waitcnt lgkmcnt(3)
    ds_read_b128 v[198:201], v1 offset:20480
    v_fmac_f32 v255, v178, v178
    v_mfma_f32_16x16x32_bf16 v[146:149], a[228:231], v[166:169], v[146:149]
    s_waitcnt lgkmcnt(3)
    ds_read_b128 v[210:213], v0 offset:20608
    v_fmac_f32 v255, v179, v179
    v_mfma_f32_16x16x32_bf16 v[146:149], a[232:235], v[162:165], v[146:149]
    s_waitcnt lgkmcnt(3)
    ds_read_b128 v[222:225], v1 offset:20608
    v_fmac_f32 v255, v180, v180
    v_mfma_f32_16x16x32_bf16 v[146:149], a[236:239], v[206:209], v[146:149]
    ds_read_b128 v[226:229], v0 offset:20736
    v_fmac_f32 v255, v181, v181
    v_mfma_f32_16x16x32_bf16 v[138:141], a[240:243], v[118:121], 0
    ds_read_b128 v[242:245], v1 offset:20736
    v_cvt_pk_bf16_f32 v254, v254, v255
    v_mfma_f32_16x16x32_bf16 v[138:141], a[244:247], v[134:137], v[138:141]
    v_mul_f32 v156, v170, v156
    v_mul_f32 v157, v170, v157
    v_mfma_f32_16x16x32_bf16 v[138:141], a[248:251], v[114:117], v[138:141]
    v_fma_f32 v255, v146, v146, s33
    v_fmac_f32 v255, v147, v147
    v_mfma_f32_16x16x32_bf16 v[138:141], a[252:255], v[166:169], v[138:141]
    s_waitcnt lgkmcnt(5)
    v_fmac_f32 v255, v148, v148
    v_fmac_f32 v255, v149, v149
    v_mfma_f32_16x16x32_bf16 v[138:141], v[82:85], v[162:165], v[138:141]
    s_waitcnt lgkmcnt(4)
    v_cvt_pk_bf16_f32 v155, v156, v157
    v_mul_f32 v130, v170, v130
    v_mfma_f32_16x16x32_bf16 v[138:141], v[86:89], v[206:209], v[138:141]
    s_waitcnt lgkmcnt(3)
    v_mul_f32 v131, v170, v131
    v_cvt_pk_bf16_f32 v156, v130, v131
    v_mfma_f32_16x16x32_bf16 v[186:189], v[90:93], v[118:121], 0
    s_waitcnt lgkmcnt(2)
    v_mul_f32 v132, v170, v132
    v_mul_f32 v133, v170, v133
    v_mfma_f32_16x16x32_bf16 v[186:189], v[94:97], v[134:137], v[186:189]
    s_waitcnt lgkmcnt(1)
    v_fmac_f32 v255, v138, v138
    v_fmac_f32 v255, v139, v139
    v_mfma_f32_16x16x32_bf16 v[186:189], v[98:101], v[114:117], v[186:189]
    s_waitcnt lgkmcnt(0)
    v_fmac_f32 v255, v140, v140
    v_fmac_f32 v255, v141, v141
    v_mfma_f32_16x16x32_bf16 v[186:189], v[102:105], v[166:169], v[186:189]
    v_cvt_pk_bf16_f32 v157, v132, v133
    v_mul_f32 v174, v170, v174
    v_mfma_f32_16x16x32_bf16 v[186:189], v[106:109], v[162:165], v[186:189]
    ds_write_b128 v3, v[154:157] offset:12288
    v_mfma_f32_16x16x32_bf16 v[186:189], v[110:113], v[206:209], v[186:189]
    v_mul_f32 v175, v170, v175
    v_cvt_pk_bf16_f32 v174, v174, v175
    v_mfma_f32_16x16x32_bf16 v[118:121], a[72:75], v[182:185], 0
    v_mul_f32 v176, v170, v176
    v_mul_f32 v177, v170, v177
    v_mfma_f32_16x16x32_bf16 v[118:121], a[76:79], v[198:201], v[118:121]
    v_rcp_f32 v194, v194
    v_mfma_f32_16x16x32_bf16 v[118:121], a[80:83], v[210:213], v[118:121]
    v_fmac_f32 v255, v186, v186
    v_fmac_f32 v255, v187, v187
    v_mfma_f32_16x16x32_bf16 v[118:121], a[84:87], v[222:225], v[118:121]
    v_fmac_f32 v255, v188, v188
    v_fmac_f32 v255, v189, v189
    v_mfma_f32_16x16x32_bf16 v[118:121], a[88:91], v[226:229], v[118:121]
    v_cvt_pk_bf16_f32 v255, v255, v255
    v_cvt_pk_bf16_f32 v175, v176, v177
    v_mfma_f32_16x16x32_bf16 v[118:121], a[92:95], v[242:245], v[118:121]
    ds_write_b64 v4, v[174:175] offset:16384
    v_mfma_f32_16x16x32_bf16 v[206:209], a[96:99], v[182:185], 0
    v_mul_f32 v122, v194, v122
    v_mul_f32 v123, v194, v123
    v_mfma_f32_16x16x32_bf16 v[206:209], a[100:103], v[198:201], v[206:209]
    ds_write_b64 v4, v[254:255] offset:18432
    v_mfma_f32_16x16x32_bf16 v[206:209], a[104:107], v[210:213], v[206:209]
    v_cvt_pk_bf16_f32 v134, v122, v123
    v_cvt_pk_f16_f32 v118, v118, v119
    v_mfma_f32_16x16x32_bf16 v[206:209], a[108:111], v[222:225], v[206:209]
    v_pk_mul_f16 v163, v118, v118
    v_cvt_pk_f16_f32 v119, v120, v121
    v_mfma_f32_16x16x32_bf16 v[206:209], a[112:115], v[226:229], v[206:209]
    v_pk_mul_f16 v165, v119, v119
    v_mul_f32 v124, v194, v124
    v_mfma_f32_16x16x32_bf16 v[206:209], a[116:119], v[242:245], v[206:209]
    v_mul_f32 v125, v194, v125
    v_cvt_pk_bf16_f32 v135, v124, v125
    v_mfma_f32_16x16x32_bf16 v[122:125], a[120:123], v[182:185], 0
    v_mul_f32 v126, v194, v126
    v_mul_f32 v127, v194, v127
    v_mfma_f32_16x16x32_bf16 v[122:125], a[124:127], v[198:201], v[122:125]
    v_cvt_pk_bf16_f32 v136, v126, v127
    v_mul_f32 v128, v194, v128
    v_mfma_f32_16x16x32_bf16 v[122:125], a[128:131], v[210:213], v[122:125]
    v_cvt_pk_f16_f32 v120, v206, v207
    v_pk_fma_f16 v163, v120, v120, v163
    v_mfma_f32_16x16x32_bf16 v[122:125], a[132:135], v[222:225], v[122:125]
    v_cvt_pk_f16_f32 v121, v208, v209
    v_pk_fma_f16 v165, v121, v121, v165
    v_mfma_f32_16x16x32_bf16 v[122:125], a[136:139], v[226:229], v[122:125]
    v_mul_f32 v129, v194, v129
    v_cvt_pk_bf16_f32 v137, v128, v129
    v_mfma_f32_16x16x32_bf16 v[122:125], a[140:143], v[242:245], v[122:125]
    ds_write_b128 v3, v[134:137] offset:6144
    v_mfma_f32_16x16x32_bf16 v[206:209], a[0:3], v[182:185], 0
    v_mul_f32 v218, v194, v218
    v_mul_f32 v219, v194, v219
    v_mfma_f32_16x16x32_bf16 v[206:209], a[4:7], v[198:201], v[206:209]
    v_cvt_pk_bf16_f32 v254, v218, v219
    v_mul_f32 v220, v194, v220
    v_mfma_f32_16x16x32_bf16 v[206:209], a[8:11], v[210:213], v[206:209]
    v_cvt_pk_f16_f32 v196, v122, v123
    v_pk_fma_f16 v163, v196, v196, v163
    v_mfma_f32_16x16x32_bf16 v[206:209], a[12:15], v[222:225], v[206:209]
    v_cvt_pk_f16_f32 v197, v124, v125
    v_pk_fma_f16 v165, v197, v197, v165
    v_mfma_f32_16x16x32_bf16 v[206:209], a[16:19], v[226:229], v[206:209]
    v_mul_f32 v221, v194, v221
    v_cvt_pk_bf16_f32 v255, v220, v221
    v_mfma_f32_16x16x32_bf16 v[206:209], a[20:23], v[242:245], v[206:209]
    ds_write_b64 v4, v[254:255] offset:10240
    v_mfma_f32_16x16x32_bf16 v[174:177], a[24:27], v[182:185], 0
    v_xor_b32 v3, 65536, v3
    v_xor_b32 v4, 65536, v4
    v_mfma_f32_16x16x32_bf16 v[174:177], a[28:31], v[198:201], v[174:177]
    v_mfma_f32_16x16x32_bf16 v[174:177], a[32:35], v[210:213], v[174:177]
    v_mfma_f32_16x16x32_bf16 v[174:177], a[36:39], v[222:225], v[174:177]
    v_mfma_f32_16x16x32_bf16 v[174:177], a[40:43], v[226:229], v[174:177]
    v_cvt_pk_f16_f32 v206, v206, v207
    v_mfma_f32_16x16x32_bf16 v[174:177], a[44:47], v[242:245], v[174:177]
    v_mfma_f32_16x16x32_bf16 v[218:221], a[48:51], v[182:185], 0
    s_waitcnt lgkmcnt(0)
    v_mfma_f32_16x16x32_bf16 v[218:221], a[52:55], v[198:201], v[218:221]
    s_nop 0
    v_mfma_f32_16x16x32_bf16 v[218:221], a[56:59], v[210:213], v[218:221]
    s_barrier
    v_mfma_f32_16x16x32_bf16 v[218:221], a[60:63], v[222:225], v[218:221]
    s_nop 0
    v_mfma_f32_16x16x32_bf16 v[218:221], a[64:67], v[226:229], v[218:221]
    s_nop 0
    v_mfma_f32_16x16x32_bf16 v[218:221], a[68:71], v[242:245], v[218:221]
    v_mfma_f32_16x16x32_bf16 v[170:173], v[182:185], a[144:147], 0
    v_mfma_f32_16x16x32_bf16 v[170:173], v[198:201], a[148:151], v[170:173]
    v_mfma_f32_16x16x32_bf16 v[170:173], v[210:213], a[152:155], v[170:173]
    v_mfma_f32_16x16x32_bf16 v[170:173], v[222:225], a[156:159], v[170:173]
    v_mfma_f32_16x16x32_bf16 v[170:173], v[226:229], a[160:163], v[170:173]
    v_mfma_f32_16x16x32_bf16 v[170:173], v[242:245], a[164:167], v[170:173]
    s_cbranch_scc1 L_loop_fast1
    s_branch L_final_fast
.p2align 6
L_loop_fast2:
    v_mfma_f32_16x16x32_bf16 v[234:237], v[182:185], a[168:171], 0
    s_add_u32 s12, s42, s27
    ds_read_b128 v[230:233], v2 offset:18432
    ds_read_b128 v[238:241], v2 offset:19456
    v_mfma_f32_16x16x32_bf16 v[234:237], v[198:201], a[172:175], v[234:237]
    s_addc_u32 s13, s43, 0
    v_pk_mul_f16 v162, v206, v206
    v_cvt_pk_f16_f32 v207, v208, v209
    v_mfma_f32_16x16x32_bf16 v[234:237], v[210:213], a[176:179], v[234:237]
    s_sub_u32 s14, s36, s27
    ds_read_b128 v[134:137], v0 offset:26624
    v_pk_mul_f16 v164, v207, v207
    v_mfma_f32_16x16x32_bf16 v[234:237], v[222:225], a[180:183], v[234:237]
    s_cmp_ge_u32 s18, 2
    ds_read_b128 v[154:157], v1 offset:26624
    v_cvt_pk_f16_f32 v208, v174, v175
    v_mfma_f32_16x16x32_bf16 v[234:237], v[226:229], a[184:187], v[234:237]
    s_cselect_b32 s14, s14, 0
    ds_read_b128 v[130:133], v0 offset:26752
    v_pk_fma_f16 v162, v208, v208, v162
    v_mfma_f32_16x16x32_bf16 v[234:237], v[242:245], a[188:191], v[234:237]
    s_add_u32 s34, s18, 2
    ds_read_b128 v[122:125], v1 offset:26752
    v_cvt_pk_f16_f32 v209, v176, v177
    v_mfma_f32_16x16x32_bf16 v[114:117], v[182:185], a[192:195], 0
    s_add_u32 s8, s40, s23
    ds_read_b128 v[126:129], v0 offset:26880
    v_pk_fma_f16 v164, v209, v209, v164
    v_mfma_f32_16x16x32_bf16 v[114:117], v[198:201], a[196:199], v[114:117]
    s_addc_u32 s9, s41, 0
    ds_read_b128 v[166:169], v1 offset:26880
    v_cvt_pk_f16_f32 v194, v218, v219
    v_mfma_f32_16x16x32_bf16 v[114:117], v[210:213], a[200:203], v[114:117]
    s_waitcnt lgkmcnt(6)
    v_pk_fma_f16 v162, v194, v194, v162
    v_cvt_pk_f16_f32 v195, v220, v221
    v_mfma_f32_16x16x32_bf16 v[198:201], v[32:35], v[230:233], 0
    s_sub_u32 s10, s36, s23
    v_pk_fma_f16 v164, v195, v195, v164
    v_cvt_pk_bf16_f32 v174, v170, v171
    v_mfma_f32_16x16x32_bf16 v[198:201], v[32:35], v[238:241], v[198:201]
    s_waitcnt lgkmcnt(5)
    v_cvt_pk_bf16_f32 v175, v172, v173
    v_cvt_pk_bf16_f32 v182, v234, v235
    v_mfma_f32_16x16x32_f16 v[170:173], v[40:43], v[162:165], 0
    s_cmp_lt_u32 s34, s17
    v_cvt_pk_bf16_f32 v183, v236, v237
    s_cselect_b32 s10, s10, 0
    v_mfma_f32_16x16x32_bf16 v[114:117], v[222:225], a[204:207], v[114:117]
    s_add_u32 m0, s28, 0
    v_mul_f32 v255, 0x3baaaaab, v198
    v_mul_f32 v254, 0x3baaaaab, v199
    v_mfma_f32_16x16x32_bf16 v[114:117], v[226:229], a[208:211], v[114:117]
    s_mov_b32 s27, s26
    v_rsq_f32 v172, v170
    v_mfma_f32_16x16x32_bf16 v[114:117], v[242:245], a[212:215], v[114:117]
    s_mov_b32 s26, s25
    v_rsq_f32 v173, v171
    v_mfma_f32_16x16x32_bf16 v[162:165], a[72:75], v[134:137], 0
    s_waitcnt lgkmcnt(0)
    v_mul_f32 v172, s31, v172
    v_cvt_pk_f16_f32 v172, v172, v173
    v_mfma_f32_16x16x32_bf16 v[162:165], a[76:79], v[154:157], v[162:165]
    s_mov_b32 s25, s24
    v_cvt_pk_bf16_f32 v114, v114, v115
    v_cvt_pk_bf16_f32 v115, v116, v117
    v_mfma_f32_16x16x32_bf16 v[162:165], a[80:83], v[130:133], v[162:165]
    s_mov_b32 s24, s23
    v_pk_mul_f16 v118, v118, v172 op_sel:[0,1] op_sel_hi:[1,1]
    v_pk_mul_f16 v119, v119, v172 op_sel:[0,1] op_sel_hi:[1,1]
    v_mfma_f32_16x16x32_bf16 v[162:165], a[84:87], v[122:125], v[162:165]
    v_pk_mul_f16 v120, v120, v172 op_sel:[0,1] op_sel_hi:[1,1]
    v_pk_mul_f16 v121, v121, v172 op_sel:[0,1] op_sel_hi:[1,1]
    v_mfma_f32_16x16x32_bf16 v[162:165], a[88:91], v[126:129], v[162:165]
    v_pk_mul_f16 v196, v196, v172 op_sel:[0,1] op_sel_hi:[1,1]
    v_pk_mul_f16 v197, v197, v172 op_sel:[0,1] op_sel_hi:[1,1]
    v_mfma_f32_16x16x32_bf16 v[162:165], a[92:95], v[166:169], v[162:165]
    v_pk_mul_f16 v206, v206, v172 op_sel:[0,0] op_sel_hi:[1,0]
    v_pk_mul_f16 v207, v207, v172 op_sel:[0,0] op_sel_hi:[1,0]
    v_mfma_f32_16x16x32_bf16 v[210:213], a[96:99], v[134:137], 0
    v_pk_mul_f16 v208, v208, v172 op_sel:[0,0] op_sel_hi:[1,0]
    v_pk_mul_f16 v209, v209, v172 op_sel:[0,0] op_sel_hi:[1,0]
    v_mfma_f32_16x16x32_bf16 v[210:213], a[100:103], v[154:157], v[210:213]
    v_pk_mul_f16 v194, v194, v172 op_sel:[0,0] op_sel_hi:[1,0]
    v_pk_mul_f16 v195, v195, v172 op_sel:[0,0] op_sel_hi:[1,0]
    v_mfma_f32_16x16x32_bf16 v[210:213], a[104:107], v[130:133], v[210:213]
    v_min3_u32 v44, v44, v170, v171
    v_max3_u32 v45, v45, v170, v171
    v_mfma_f32_16x16x32_bf16 v[210:213], a[108:111], v[122:125], v[210:213]
    v_cvt_pk_f16_f32 v170, v162, v163
    v_pk_mul_f16 v163, v170, v170
    v_mfma_f32_16x16x32_bf16 v[210:213], a[112:115], v[126:129], v[210:213]
    v_cvt_pk_f16_f32 v171, v164, v165
    v_pk_mul_f16 v165, v171, v171
    v_mfma_f32_16x16x32_bf16 v[210:213], a[116:119], v[166:169], v[210:213]
    v_rsq_f32 v255, v255
    v_mfma_f32_16x16x32_bf16 v[214:217], a[120:123], v[134:137], 0
    v_rsq_f32 v254, v254
    v_mfma_f32_16x16x32_bf16 v[214:217], a[124:127], v[154:157], v[214:217]
    v_mul_f32 v142, v254, v142
    v_mul_f32 v143, v254, v143
    v_mfma_f32_16x16x32_bf16 v[214:217], a[128:131], v[130:133], v[214:217]
    v_cvt_pk_bf16_f32 v142, v142, v143
    v_cvt_pk_f16_f32 v172, v210, v211
    v_mfma_f32_16x16x32_bf16 v[214:217], a[132:135], v[122:125], v[214:217]
    v_pk_fma_f16 v163, v172, v172, v163
    v_cvt_pk_f16_f32 v173, v212, v213
    v_mfma_f32_16x16x32_bf16 v[214:217], a[136:139], v[126:129], v[214:217]
    v_pk_fma_f16 v165, v173, v173, v165
    v_mul_f32 v144, v254, v144
    v_mfma_f32_16x16x32_bf16 v[214:217], a[140:143], v[166:169], v[214:217]
    v_mul_f32 v145, v254, v145
    v_cvt_pk_bf16_f32 v143, v144, v145
    v_mfma_f32_16x16x32_bf16 v[210:213], a[0:3], v[134:137], 0
    v_mul_f32 v158, v254, v158
    v_mul_f32 v159, v254, v159
    v_mfma_f32_16x16x32_bf16 v[210:213], a[4:7], v[154:157], v[210:213]
    v_cvt_pk_bf16_f32 v144, v158, v159
    v_mul_f32 v160, v254, v160
    v_mfma_f32_16x16x32_bf16 v[210:213], a[8:11], v[130:133], v[210:213]
    v_cvt_pk_f16_f32 v220, v214, v215
    v_pk_fma_f16 v163, v220, v220, v163
    v_mfma_f32_16x16x32_bf16 v[210:213], a[12:15], v[122:125], v[210:213]
    v_cvt_pk_f16_f32 v221, v216, v217
    v_pk_fma_f16 v165, v221, v221, v165
    v_mfma_f32_16x16x32_bf16 v[210:213], a[16:19], v[126:129], v[210:213]
    v_mul_f32 v161, v254, v161
    v_cvt_pk_bf16_f32 v145, v160, v161
    v_mfma_f32_16x16x32_bf16 v[210:213], a[20:23], v[166:169], v[210:213]
    buffer_store_dwordx4 v[142:145], v16, s[12:15], 0 offen nt
    v_mul_f32 v178, v254, v178
    v_mul_f32 v179, v254, v179
    v_cvt_pk_bf16_f32 v198, v178, v179
    v_mul_f32 v180, v254, v180
    v_mfma_f32_16x16x32_bf16 v[142:145], a[24:27], v[134:137], 0
    v_mul_f32 v181, v254, v181
    v_cvt_pk_bf16_f32 v199, v180, v181
    v_mfma_f32_16x16x32_bf16 v[142:145], a[28:31], v[154:157], v[142:145]
    v_cvt_pk_f16_f32 v158, v210, v211
    v_pk_mul_f16 v162, v158, v158
    v_mfma_f32_16x16x32_bf16 v[142:145], a[32:35], v[130:133], v[142:145]
    v_cvt_pk_f16_f32 v159, v212, v213
    v_pk_mul_f16 v164, v159, v159
    v_mfma_f32_16x16x32_bf16 v[142:145], a[36:39], v[122:125], v[142:145]
    v_mul_f32 v254, 0x3baaaaab, v200
    v_mul_f32 v150, v255, v150
    v_mfma_f32_16x16x32_bf16 v[142:145], a[40:43], v[126:129], v[142:145]
    v_rsq_f32 v254, v254
    v_mfma_f32_16x16x32_bf16 v[142:145], a[44:47], v[166:169], v[142:145]
    v_mul_f32 v146, v254, v146
    v_mul_f32 v147, v254, v147
    v_mfma_f32_16x16x32_bf16 v[178:181], a[48:51], v[134:137], 0
    v_cvt_pk_bf16_f32 v146, v146, v147
    v_mul_f32 v148, v254, v148
    v_mfma_f32_16x16x32_bf16 v[178:181], a[52:55], v[154:157], v[178:181]
    v_mul_f32 v149, v254, v149
    v_cvt_pk_bf16_f32 v147, v148, v149
    v_mfma_f32_16x16x32_bf16 v[178:181], a[56:59], v[130:133], v[178:181]
    v_mul_f32 v138, v254, v138
    v_mul_f32 v139, v254, v139
    v_mfma_f32_16x16x32_bf16 v[178:181], a[60:63], v[122:125], v[178:181]
    v_cvt_pk_bf16_f32 v148, v138, v139
    v_mul_f32 v140, v254, v140
    v_mfma_f32_16x16x32_bf16 v[178:181], a[64:67], v[126:129], v[178:181]
    v_mul_f32 v141, v254, v141
    v_cvt_pk_bf16_f32 v149, v140, v141
    v_mfma_f32_16x16x32_bf16 v[178:181], a[68:71], v[166:169], v[178:181]
    v_mul_f32 v186, v254, v186
    v_mul_f32 v187, v254, v187
    v_mfma_f32_16x16x32_bf16 v[138:141], v[134:137], a[144:147], 0
    v_cvt_pk_bf16_f32 v200, v186, v187
    v_mul_f32 v188, v254, v188
    v_mfma_f32_16x16x32_bf16 v[138:141], v[154:157], a[148:151], v[138:141]
    v_mul_f32 v189, v254, v189
    v_cvt_pk_bf16_f32 v201, v188, v189
    v_mfma_f32_16x16x32_bf16 v[138:141], v[130:133], a[152:155], v[138:141]
    v_cvt_pk_f16_f32 v160, v142, v143
    v_pk_fma_f16 v162, v160, v160, v162
    v_mfma_f32_16x16x32_bf16 v[138:141], v[122:125], a[156:159], v[138:141]
    v_cvt_pk_f16_f32 v161, v144, v145
    v_pk_fma_f16 v164, v161, v161, v164
    v_mfma_f32_16x16x32_bf16 v[138:141], v[126:129], a[160:163], v[138:141]
    buffer_store_dwordx4 v[146:149], v17, s[12:15], 0 offen nt
    v_cvt_pk_f16_f32 v218, v178, v179
    v_pk_fma_f16 v162, v218, v218, v162
    v_cvt_pk_f16_f32 v219, v180, v181
    v_pk_fma_f16 v164, v219, v219, v164
    v_mfma_f32_16x16x32_bf16 v[138:141], v[166:169], a[164:167], v[138:141]
    v_mul_f32 v151, v255, v151
    v_cvt_pk_bf16_f32 v150, v150, v151
    v_mfma_f32_16x16x32_f16 v[142:145], v[40:43], v[162:165], 0
    v_mul_f32 v152, v255, v152
    v_mul_f32 v153, v255, v153
    v_mfma_f32_16x16x32_bf16 v[178:181], v[134:137], a[168:171], 0
    v_cvt_pk_bf16_f32 v151, v152, v153
    v_mul_f32 v190, v255, v190
    v_mfma_f32_16x16x32_bf16 v[178:181], v[154:157], a[172:175], v[178:181]
    v_cvt_pk_bf16_f32 v176, v138, v139
    v_cvt_pk_bf16_f32 v177, v140, v141
    v_mfma_f32_16x16x32_bf16 v[178:181], v[130:133], a[176:179], v[178:181]
    ds_read_b128 v[146:149], v0 offset:32768
    v_min3_u32 v44, v44, v142, v143
    v_mfma_f32_16x16x32_bf16 v[178:181], v[122:125], a[180:183], v[178:181]
    ds_read_b128 v[138:141], v1 offset:32768
    v_max3_u32 v45, v45, v142, v143
    v_mfma_f32_16x16x32_bf16 v[178:181], v[126:129], a[184:187], v[178:181]
    ds_read_b128 v[186:189], v0 offset:32896
    v_mul_f32 v191, v255, v191
    v_mfma_f32_16x16x32_bf16 v[178:181], v[166:169], a[188:191], v[178:181]
    ds_read_b128 v[162:165], v1 offset:32896
    v_cvt_pk_bf16_f32 v152, v190, v191
    v_mfma_f32_16x16x32_bf16 v[210:213], v[134:137], a[192:195], 0
    ds_read_b128 v[134:137], v0 offset:33024
    v_mul_f32 v192, v255, v192
    v_mfma_f32_16x16x32_bf16 v[210:213], v[154:157], a[196:199], v[210:213]
    ds_read_b128 v[154:157], v1 offset:33024
    v_mul_f32 v193, v255, v193
    v_mfma_f32_16x16x32_bf16 v[210:213], v[130:133], a[200:203], v[210:213]
    v_rsq_f32 v144, v142
    v_mfma_f32_16x16x32_bf16 v[210:213], v[122:125], a[204:207], v[210:213]
    v_rsq_f32 v145, v143
    v_mfma_f32_16x16x32_bf16 v[210:213], v[126:129], a[208:211], v[210:213]
    s_waitcnt lgkmcnt(5)
    v_mul_f32 v144, s31, v144
    v_cvt_pk_f16_f32 v144, v144, v145
    v_mfma_f32_16x16x32_bf16 v[210:213], v[166:169], a[212:215], v[210:213]
    s_waitcnt lgkmcnt(4)
    v_cvt_pk_bf16_f32 v184, v178, v179
    v_cvt_pk_bf16_f32 v185, v180, v181
    v_mfma_f32_16x16x32_bf16 v[178:181], a[72:75], v[146:149], 0
    s_waitcnt lgkmcnt(3)
    v_pk_mul_f16 v170, v170, v144 op_sel:[0,1] op_sel_hi:[1,1]
    v_pk_mul_f16 v171, v171, v144 op_sel:[0,1] op_sel_hi:[1,1]
    v_mfma_f32_16x16x32_bf16 v[178:181], a[76:79], v[138:141], v[178:181]
    s_waitcnt lgkmcnt(2)
    v_cvt_pk_bf16_f32 v116, v210, v211
    v_cvt_pk_bf16_f32 v117, v212, v213
    v_mfma_f32_16x16x32_bf16 v[178:181], a[80:83], v[186:189], v[178:181]
    s_waitcnt lgkmcnt(1)
    buffer_store_dwordx2 v[200:201], v20, s[12:15], 0 offen nt
    v_pk_mul_f16 v172, v172, v144 op_sel:[0,1] op_sel_hi:[1,1]
    v_pk_mul_f16 v173, v173, v144 op_sel:[0,1] op_sel_hi:[1,1]
    v_mfma_f32_16x16x32_bf16 v[178:181], a[84:87], v[162:165], v[178:181]
    s_waitcnt lgkmcnt(0)
    v_pk_mul_f16 v220, v220, v144 op_sel:[0,1] op_sel_hi:[1,1]
    v_pk_mul_f16 v221, v221, v144 op_sel:[0,1] op_sel_hi:[1,1]
    v_mfma_f32_16x16x32_bf16 v[178:181], a[88:91], v[134:137], v[178:181]
    v_pk_mul_f16 v158, v158, v144 op_sel:[0,0] op_sel_hi:[1,0]
    v_pk_mul_f16 v159, v159, v144 op_sel:[0,0] op_sel_hi:[1,0]
    v_mfma_f32_16x16x32_bf16 v[178:181], a[92:95], v[154:157], v[178:181]
    v_pk_mul_f16 v160, v160, v144 op_sel:[0,0] op_sel_hi:[1,0]
    v_pk_mul_f16 v161, v161, v144 op_sel:[0,0] op_sel_hi:[1,0]
    v_mfma_f32_16x16x32_bf16 v[130:133], a[96:99], v[146:149], 0
    v_pk_mul_f16 v218, v218, v144 op_sel:[0,0] op_sel_hi:[1,0]
    v_pk_mul_f16 v219, v219, v144 op_sel:[0,0] op_sel_hi:[1,0]
    v_mfma_f32_16x16x32_bf16 v[130:133], a[100:103], v[138:141], v[130:133]
    s_waitcnt vmcnt(3)
    v_cvt_pk_bf16_f32 v153, v192, v193
    v_cvt_pk_f16_f32 v142, v178, v179
    v_mfma_f32_16x16x32_bf16 v[130:133], a[104:107], v[186:189], v[130:133]
    s_nop 0
    v_pk_mul_f16 v191, v142, v142
    v_cvt_pk_f16_f32 v143, v180, v181
    v_mfma_f32_16x16x32_bf16 v[130:133], a[108:111], v[162:165], v[130:133]
    s_nop 0
    v_pk_mul_f16 v193, v143, v143
    v_mul_f32 v202, v255, v202
    v_mfma_f32_16x16x32_bf16 v[130:133], a[112:115], v[134:137], v[130:133]
    s_barrier
    v_mul_f32 v203, v255, v203
    v_cvt_pk_bf16_f32 v254, v202, v203
    v_mfma_f32_16x16x32_bf16 v[130:133], a[116:119], v[154:157], v[130:133]
    s_nop 0
    v_mul_f32 v204, v255, v204
    v_mul_f32 v205, v255, v205
    v_mfma_f32_16x16x32_bf16 v[178:181], a[120:123], v[146:149], 0
    v_cvt_pk_bf16_f32 v255, v204, v205
    v_xor_b32 v0, 65536, v0
    v_mfma_f32_16x16x32_bf16 v[178:181], a[124:127], v[138:141], v[178:181]
    v_xor_b32 v1, 65536, v1
    v_cvt_pk_f16_f32 v144, v130, v131
    v_mfma_f32_16x16x32_bf16 v[178:181], a[128:131], v[186:189], v[178:181]
    v_pk_fma_f16 v191, v144, v144, v191
    v_cvt_pk_f16_f32 v145, v132, v133
    v_mfma_f32_16x16x32_bf16 v[178:181], a[132:135], v[162:165], v[178:181]
    v_pk_fma_f16 v193, v145, v145, v193
    v_mfma_f32_16x16x32_bf16 v[178:181], a[136:139], v[134:137], v[178:181]
    v_mfma_f32_16x16x32_bf16 v[178:181], a[140:143], v[154:157], v[178:181]
    v_mfma_f32_16x16x32_bf16 v[202:205], a[0:3], v[146:149], 0
    v_mfma_f32_16x16x32_bf16 v[202:205], a[4:7], v[138:141], v[202:205]
    buffer_load_dwordx4 v10, s[8:11], 0 offen nt lds
    s_add_u32 m0, s28, 4096
    v_mfma_f32_16x16x32_bf16 v[202:205], a[8:11], v[186:189], v[202:205]
    v_mfma_f32_16x16x32_bf16 v[202:205], a[12:15], v[162:165], v[202:205]
    v_mfma_f32_16x16x32_bf16 v[202:205], a[16:19], v[134:137], v[202:205]
    v_mfma_f32_16x16x32_bf16 v[202:205], a[20:23], v[154:157], v[202:205]
    v_cvt_pk_f16_f32 v124, v178, v179
    v_pk_fma_f16 v191, v124, v124, v191
    v_mfma_f32_16x16x32_bf16 v[130:133], a[24:27], v[146:149], 0
    buffer_load_dwordx4 v11, s[8:11], 0 offen nt lds
    v_cvt_pk_f16_f32 v125, v180, v181
    v_mfma_f32_16x16x32_bf16 v[130:133], a[28:31], v[138:141], v[130:133]
    s_add_u32 m0, s28, 8192
    v_pk_fma_f16 v193, v125, v125, v193
    v_cvt_pk_f16_f32 v178, v202, v203
    v_mfma_f32_16x16x32_bf16 v[130:133], a[32:35], v[186:189], v[130:133]
    v_pk_mul_f16 v190, v178, v178
    v_cvt_pk_f16_f32 v179, v204, v205
    v_mfma_f32_16x16x32_bf16 v[130:133], a[36:39], v[162:165], v[130:133]
    v_pk_mul_f16 v192, v179, v179
    v_mfma_f32_16x16x32_bf16 v[130:133], a[40:43], v[134:137], v[130:133]
    v_mfma_f32_16x16x32_bf16 v[130:133], a[44:47], v[154:157], v[130:133]
    buffer_load_dwordx4 v12, s[8:11], 0 offen nt lds
    s_add_u32 m0, s28, 12288
    v_mfma_f32_16x16x32_bf16 v[202:205], a[48:51], v[146:149], 0
    s_xor_b32 s28, s28, 65536
    v_mfma_f32_16x16x32_bf16 v[202:205], a[52:55], v[138:141], v[202:205]
    ds_read_b128 v[166:169], v5 offset:0
    ds_read_b128 v[126:129], v5 offset:16
    v_mfma_f32_16x16x32_bf16 v[202:205], a[56:59], v[186:189], v[202:205]
    ds_read_b128 v[210:213], v5 offset:48
    ds_read_b32 v200, v6 offset:192
    v_mfma_f32_16x16x32_bf16 v[202:205], a[60:63], v[162:165], v[202:205]
    v_cvt_pk_f16_f32 v180, v130, v131
    v_pk_fma_f16 v190, v180, v180, v190
    v_mfma_f32_16x16x32_bf16 v[202:205], a[64:67], v[134:137], v[202:205]
    buffer_load_dwordx4 v13, s[8:11], 0 offen nt lds
    v_cvt_pk_f16_f32 v181, v132, v133
    v_mfma_f32_16x16x32_bf16 v[202:205], a[68:71], v[154:157], v[202:205]
    s_mov_b32 m0, s29
    v_pk_fma_f16 v192, v181, v181, v192
    v_add_u32 v5, 336, v5
    v_mfma_f32_16x16x32_bf16 v[130:133], v[146:149], a[144:147], 0
    s_xor_b32 s29, s29, s30
    s_add_u32 s19, s19, s20
    s_add_u32 s23, s23, s21
    v_mfma_f32_16x16x32_bf16 v[130:133], v[138:141], a[148:151], v[130:133]
    s_cmp_ge_u32 s19, 72
    v_cvt_pk_f16_f32 v122, v202, v203
    v_pk_fma_f16 v190, v122, v122, v190
    v_mfma_f32_16x16x32_bf16 v[130:133], v[186:189], a[152:155], v[130:133]
    s_cselect_b32 s34, 72, 0
    v_cvt_pk_f16_f32 v123, v204, v205
    v_pk_fma_f16 v192, v123, v123, v192
    v_mfma_f32_16x16x32_bf16 v[130:133], v[162:165], a[156:159], v[130:133]
    s_waitcnt lgkmcnt(2)
    buffer_store_dwordx2 v[198:199], v19, s[12:15], 0 offen nt
    s_cselect_b32 s35, s22, 0
    s_sub_u32 s19, s19, s34
    v_mfma_f32_16x16x32_f16 v[202:205], v[40:43], v[190:193], 0
    s_add_u32 s23, s23, s35
    s_add_u32 s18, s18, 1
    s_cmp_lt_u32 s18, s45
    v_mfma_f32_16x16x32_f16 v[214:217], v[166:169], v[158:161], v[24:27]
    s_waitcnt lgkmcnt(0)
    v_mfma_f32_16x16x32_f16 v[214:217], v[126:129], v[170:173], v[214:217]
    v_mfma_f32_16x16x32_f16 v[214:217], v[210:213], v[218:221], v[214:217]
    v_mfma_f32_16x16x32_f16 v[190:193], v[166:169], v[206:209], v[22:25]
    v_rsq_f32 v204, v202
    v_mfma_f32_16x16x32_f16 v[190:193], v[126:129], v[118:121], v[190:193]
    v_rsq_f32 v205, v203
    v_mfma_f32_16x16x32_f16 v[190:193], v[210:213], v[194:197], v[190:193]
    v_mul_f32 v204, s31, v204
    v_cvt_pk_f16_f32 v204, v204, v205
    v_mfma_f32_16x16x32_bf16 v[130:133], v[134:137], a[160:163], v[130:133]
    v_pk_mul_f16 v142, v142, v204 op_sel:[0,1] op_sel_hi:[1,1]
    v_pk_mul_f16 v143, v143, v204 op_sel:[0,1] op_sel_hi:[1,1]
    v_mfma_f32_16x16x32_bf16 v[130:133], v[154:157], a[164:167], v[130:133]
    v_pk_mul_f16 v144, v144, v204 op_sel:[0,1] op_sel_hi:[1,1]
    v_pk_mul_f16 v145, v145, v204 op_sel:[0,1] op_sel_hi:[1,1]
    v_mfma_f32_16x16x32_bf16 v[222:225], v[146:149], a[168:171], 0
    v_mov_b32_dpp v200, v191 quad_perm:[0,1,2,3] row_mask:0x1 bank_mask:0xf
    v_mov_b32_dpp v200, v215 quad_perm:[0,1,2,3] row_mask:0x2 bank_mask:0xf
    v_mfma_f32_16x16x32_bf16 v[222:225], v[138:141], a[172:175], v[222:225]
    v_pk_mul_f16 v124, v124, v204 op_sel:[0,1] op_sel_hi:[1,1]
    v_pk_mul_f16 v125, v125, v204 op_sel:[0,1] op_sel_hi:[1,1]
    v_mfma_f32_16x16x32_bf16 v[222:225], v[186:189], a[176:179], v[222:225]
    v_cvt_pk_bf16_f32 v130, v130, v131
    v_cvt_pk_bf16_f32 v131, v132, v133
    v_mfma_f32_16x16x32_bf16 v[222:225], v[162:165], a[180:183], v[222:225]
    v_pk_mul_f16 v178, v178, v204 op_sel:[0,0] op_sel_hi:[1,0]
    v_pk_mul_f16 v179, v179, v204 op_sel:[0,0] op_sel_hi:[1,0]
    v_mfma_f32_16x16x32_f16 v[226:229], v[118:121], v[206:209], v[46:49]
    v_pk_mul_f16 v180, v180, v204 op_sel:[0,0] op_sel_hi:[1,0]
    v_pk_mul_f16 v181, v181, v204 op_sel:[0,0] op_sel_hi:[1,0]
    v_mfma_f32_16x16x32_f16 v[230:233], v[170:173], v[206:209], v[50:53]
    v_pk_mul_f16 v122, v122, v204 op_sel:[0,0] op_sel_hi:[1,0]
    v_pk_mul_f16 v123, v123, v204 op_sel:[0,0] op_sel_hi:[1,0]
    v_mfma_f32_16x16x32_f16 v[234:237], v[142:145], v[206:209], v[54:57]
    v_min3_u32 v44, v44, v202, v203
    v_exp_f32 v214, v214
    v_mfma_f32_16x16x16_f16 v[226:229], v[196:197], v[194:195], v[226:229]
    v_max3_u32 v45, v45, v202, v203
    v_exp_f32 v190, v190
    v_mfma_f32_16x16x16_f16 v[230:233], v[220:221], v[194:195], v[230:233]
    v_cvt_pk_bf16_f32 v39, v190, 0
    v_mfma_f32_16x16x16_f16 v[234:237], v[124:125], v[194:195], v[234:237]
    buffer_store_dwordx4 v[150:153], v15, s[12:15], 0 offen nt
    v_mfma_f32_16x16x32_bf16 v[222:225], v[134:137], a[184:187], v[222:225]
    v_mfma_f32_16x16x32_bf16 v[222:225], v[154:157], a[188:191], v[222:225]
    ds_read_b128 v[206:209], v2 offset:0
    v_mfma_f32_16x16x32_bf16 v[150:153], v[146:149], a[192:195], 0
    ds_read_b128 v[146:149], v2 offset:1024
    v_mfma_f32_16x16x32_bf16 v[150:153], v[138:141], a[196:199], v[150:153]
    ds_read_b128 v[138:141], v2 offset:2048
    v_mfma_f32_16x16x32_bf16 v[150:153], v[186:189], a[200:203], v[150:153]
    ds_read_b128 v[186:189], v2 offset:3072
    v_mfma_f32_16x16x32_bf16 v[150:153], v[162:165], a[204:207], v[150:153]
    ds_read_b128 v[162:165], v2 offset:4096
    v_cvt_pk_bf16_f32 v222, v222, v223
    v_mfma_f32_16x16x32_bf16 v[150:153], v[134:137], a[208:211], v[150:153]
    ds_read_b128 v[134:137], v2 offset:5120
    v_cvt_pk_bf16_f32 v223, v224, v225
    v_mfma_f32_16x16x32_bf16 v[150:153], v[154:157], a[212:215], v[150:153]
    ds_read2_b32 v[132:133], v6 offset0:0 offset1:0
    ds_read2_b32 v[224:225], v6 offset0:16 offset1:16
    v_mfma_f32_16x16x32_f16 v[154:157], v[166:169], v[178:181], v[26:29]
    ds_read2_b32 v[168:169], v6 offset0:32 offset1:32
    v_add_u32 v6, 272, v6
    v_mfma_f32_16x16x32_f16 v[154:157], v[126:129], v[142:145], v[154:157]
    s_waitcnt lgkmcnt(8)
    v_exp_f32 v226, v226
    v_mfma_f32_16x16x32_f16 v[154:157], v[210:213], v[122:125], v[154:157]
    s_waitcnt lgkmcnt(7)
    v_cvt_pk_bf16_f32 v166, v150, v151
    v_cvt_pk_bf16_f32 v167, v152, v153
    v_mfma_f32_16x16x32_bf16 v[150:153], a[216:219], v[206:209], 0
    s_waitcnt lgkmcnt(6)
    v_exp_f32 v227, v227
    v_mfma_f32_16x16x32_bf16 v[150:153], a[220:223], v[146:149], v[150:153]
    s_waitcnt lgkmcnt(5)
    v_exp_f32 v154, v154
    v_mfma_f32_16x16x32_bf16 v[150:153], a[224:227], v[138:141], v[150:153]
    s_waitcnt lgkmcnt(4)
    v_mov_b32_dpp v200, v155 quad_perm:[0,1,2,3] row_mask:0x4 bank_mask:0xf
    v_cvt_pk_bf16_f32 v126, v226, v227
    v_mfma_f32_16x16x32_bf16 v[150:153], a[228:231], v[186:189], v[150:153]
    s_waitcnt lgkmcnt(3)
    v_exp_f32 v200, v200
    v_mfma_f32_16x16x32_bf16 v[150:153], a[232:235], v[162:165], v[150:153]
    s_waitcnt lgkmcnt(1)
    v_exp_f32 v228, v228
    v_mfma_f32_16x16x32_bf16 v[150:153], a[236:239], v[134:137], v[150:153]
    s_waitcnt lgkmcnt(0)
    buffer_store_dwordx2 v[254:255], v18, s[12:15], 0 offen nt
    v_exp_f32 v229, v229
    v_mfma_f32_16x16x32_bf16 v[190:193], a[240:243], v[206:209], 0
    v_cvt_pk_bf16_f32 v200, v200, v200
    v_cvt_pk_bf16_f32 v127, v228, v229
    v_mfma_f32_16x16x32_bf16 v[190:193], a[244:247], v[146:149], v[190:193]
    ds_write_b16 v8, v200
    v_mfma_f32_16x16x32_bf16 v[190:193], a[248:251], v[138:141], v[190:193]
    v_exp_f32 v230, v230
    v_mfma_f32_16x16x32_bf16 v[190:193], a[252:255], v[186:189], v[190:193]
    ds_read_b128 v[198:201], v2 offset:6144
    ds_read_b128 v[210:213], v9
    v_mfma_f32_16x16x32_bf16 v[190:193], v[82:85], v[162:165], v[190:193]
    ds_read_b128 v[226:229], v2 offset:7168
    ds_read_b128 v[238:241], v9 offset:64
    v_mfma_f32_16x16x32_bf16 v[190:193], v[86:89], v[134:137], v[190:193]
    v_exp_f32 v231, v231
    v_mfma_f32_16x16x32_bf16 v[202:205], v[90:93], v[206:209], 0
    ds_read_b128 v[206:209], v2 offset:8192
    ds_read_b128 v[242:245], v2 offset:9216
    v_mfma_f32_16x16x32_bf16 v[202:205], v[94:97], v[146:149], v[202:205]
    v_cvt_pk_bf16_f32 v128, v230, v231
    v_fma_f32 v254, v150, v150, s33
    v_mfma_f32_16x16x32_bf16 v[202:205], v[98:101], v[138:141], v[202:205]
    ds_read_b128 v[146:149], v2 offset:10240
    ds_read_b128 v[138:141], v2 offset:11264
    v_mfma_f32_16x16x32_bf16 v[202:205], v[102:105], v[186:189], v[202:205]
    v_exp_f32 v232, v232
    v_mfma_f32_16x16x32_bf16 v[202:205], v[106:109], v[162:165], v[202:205]
    v_exp_f32 v233, v233
    v_mfma_f32_16x16x32_bf16 v[202:205], v[110:113], v[134:137], v[202:205]
    s_waitcnt lgkmcnt(6)
    v_cvt_pk_bf16_f32 v129, v232, v233
    v_fmac_f32 v254, v151, v151
    v_mfma_f32_16x16x32_bf16 v[186:189], v[210:213], v[28:31], 0
    s_waitcnt lgkmcnt(4)
    v_exp_f32 v234, v234
    v_mfma_f32_16x16x32_bf16 v[186:189], v[238:241], v[28:31], v[186:189]
    v_exp_f32 v235, v235
    v_mfma_f32_16x16x32_f16 v[134:137], v[118:121], v[158:161], v[58:61]
    s_waitcnt lgkmcnt(2)
    v_cvt_pk_bf16_f32 v36, v234, v235
    v_fmac_f32 v254, v152, v152
    v_mfma_f32_16x16x32_f16 v[162:165], v[170:173], v[158:161], v[62:65]
    v_exp_f32 v236, v236
    v_mfma_f32_16x16x32_f16 v[230:233], v[142:145], v[158:161], v[66:69]
    s_waitcnt lgkmcnt(0)
    buffer_load_dwordx4 v14, s[8:11], 0 offen nt lds
    v_rcp_f32 v186, v186
    v_mfma_f32_16x16x16_f16 v[134:137], v[196:197], v[218:219], v[134:137]
    v_exp_f32 v237, v237
    v_fmac_f32 v254, v153, v153
    v_mfma_f32_16x16x16_f16 v[162:165], v[220:221], v[218:219], v[162:165]
    v_cvt_pk_bf16_f32 v37, v236, v237
    v_fmac_f32 v254, v190, v190
    v_fmac_f32 v254, v191, v191
    v_mfma_f32_16x16x16_f16 v[230:233], v[124:125], v[218:219], v[230:233]
    v_fmac_f32 v254, v192, v192
    v_exp_f32 v134, v134
    v_fmac_f32 v254, v193, v193
    v_mfma_f32_16x16x32_bf16 v[158:161], v[210:213], v[174:177], 0
    v_exp_f32 v135, v135
    v_mfma_f32_16x16x32_bf16 v[158:161], v[238:241], v[130:133], v[158:161]
    v_cvt_pk_bf16_f32 v134, v134, v135
    v_fmac_f32 v254, v202, v202
    v_mfma_f32_16x16x32_bf16 v[234:237], v[210:213], v[182:185], 0
    v_exp_f32 v136, v136
    v_mfma_f32_16x16x32_bf16 v[234:237], v[238:241], v[222:225], v[234:237]
    v_exp_f32 v137, v137
    v_mfma_f32_16x16x32_bf16 v[246:249], v[210:213], v[114:117], 0
    v_cvt_pk_bf16_f32 v135, v136, v137
    v_mul_f32 v158, v158, v186
    v_mfma_f32_16x16x32_bf16 v[246:249], v[238:241], v[166:169], v[246:249]
    v_exp_f32 v162, v162
    v_mfma_f32_16x16x32_bf16 v[210:213], v[28:31], v[36:39], 0
    v_exp_f32 v163, v163
    v_mfma_f32_16x16x32_bf16 v[210:213], v[28:31], v[126:129], v[210:213]
    v_cvt_pk_bf16_f32 v136, v162, v163
    v_mul_f32_dpp v158, v234, v186 quad_perm:[0,1,2,3] row_mask:0x2 bank_mask:0xf
    v_mfma_f32_16x16x32_bf16 v[234:237], v[130:133], v[36:39], 0
    v_exp_f32 v164, v164
    v_mfma_f32_16x16x32_bf16 v[234:237], v[174:177], v[126:129], v[234:237]
    v_exp_f32 v165, v165
    v_mfma_f32_16x16x32_bf16 v[238:241], v[222:225], v[36:39], 0
    v_cvt_pk_bf16_f32 v137, v164, v165
    v_mul_f32_dpp v158, v246, v186 quad_perm:[0,1,2,3] row_mask:0x4 bank_mask:0xf
    v_mfma_f32_16x16x32_bf16 v[238:241], v[182:185], v[126:129], v[238:241]
    v_exp_f32 v230, v230
    v_mfma_f32_16x16x32_bf16 v[186:189], v[166:169], v[36:39], 0
    v_exp_f32 v231, v231
    v_mfma_f32_16x16x32_bf16 v[186:189], v[114:117], v[126:129], v[186:189]
    v_cvt_pk_bf16_f32 v36, v230, v231
    v_cvt_pk_bf16_f32 v39, v214, 0
    v_mfma_f32_16x16x32_f16 v[162:165], v[118:121], v[178:181], v[70:73]
    v_exp_f32 v232, v232
    v_mfma_f32_16x16x32_f16 v[118:121], v[170:173], v[178:181], v[74:77]
    v_exp_f32 v233, v233
    v_mfma_f32_16x16x32_f16 v[170:173], v[142:145], v[178:181], v[78:81]
    v_cvt_pk_bf16_f32 v37, v232, v233
    v_cvt_pk_bf16_f32 v158, v158, v158
    v_fmac_f32 v254, v203, v203
    v_mfma_f32_16x16x16_f16 v[162:165], v[196:197], v[122:123], v[162:165]
    v_rcp_f32 v210, v210
    v_fmac_f32 v254, v204, v204
    v_mfma_f32_16x16x16_f16 v[118:121], v[220:221], v[122:123], v[118:121]
    v_mul_f32 v234, v210, v234
    v_mul_f32 v235, v210, v235
    v_cvt_pk_bf16_f32 v178, v234, v235
    v_mfma_f32_16x16x16_f16 v[170:173], v[124:125], v[122:123], v[170:173]
    v_mul_f32 v236, v210, v236
    v_exp_f32 v162, v162
    v_mul_f32 v237, v210, v237
    v_mfma_f32_16x16x32_bf16 v[194:197], v[28:31], v[36:39], 0
    ds_write_b16 v7, v158
    v_mfma_f32_16x16x32_bf16 v[194:197], v[28:31], v[134:137], v[194:197]
    v_exp_f32 v163, v163
    v_mfma_f32_16x16x32_bf16 v[122:125], v[130:133], v[36:39], 0
    v_cvt_pk_bf16_f32 v162, v162, v163
    v_cvt_pk_bf16_f32 v179, v236, v237
    v_mfma_f32_16x16x32_bf16 v[122:125], v[174:177], v[134:137], v[122:125]
    v_exp_f32 v164, v164
    v_mfma_f32_16x16x32_bf16 v[126:129], v[222:225], v[36:39], 0
    v_exp_f32 v165, v165
    v_mfma_f32_16x16x32_bf16 v[126:129], v[182:185], v[134:137], v[126:129]
    v_cvt_pk_bf16_f32 v163, v164, v165
    v_mul_f32 v238, v210, v238
    v_mfma_f32_16x16x32_bf16 v[218:221], v[166:169], v[36:39], 0
    v_exp_f32 v118, v118
    v_mfma_f32_16x16x32_bf16 v[218:221], v[114:117], v[134:137], v[218:221]
    v_exp_f32 v119, v119
    v_mfma_f32_16x16x32_bf16 v[142:145], a[216:219], v[198:201], 0
    v_cvt_pk_bf16_f32 v164, v118, v119
    v_cvt_pk_bf16_f32 v39, v154, 0
    v_mfma_f32_16x16x32_bf16 v[142:145], a[220:223], v[226:229], v[142:145]
    v_exp_f32 v120, v120
    v_mfma_f32_16x16x32_bf16 v[142:145], a[224:227], v[206:209], v[142:145]
    v_exp_f32 v121, v121
    v_mfma_f32_16x16x32_bf16 v[142:145], a[228:231], v[242:245], v[142:145]
    v_cvt_pk_bf16_f32 v165, v120, v121
    v_mul_f32 v239, v210, v239
    v_mfma_f32_16x16x32_bf16 v[142:145], a[232:235], v[146:149], v[142:145]
    v_exp_f32 v170, v170
    v_mfma_f32_16x16x32_bf16 v[142:145], a[236:239], v[138:141], v[142:145]
    v_exp_f32 v171, v171
    v_mfma_f32_16x16x32_bf16 v[158:161], a[240:243], v[198:201], 0
    v_cvt_pk_bf16_f32 v36, v170, v171
    v_cvt_pk_bf16_f32 v180, v238, v239
    v_mfma_f32_16x16x32_bf16 v[158:161], a[244:247], v[226:229], v[158:161]
    v_exp_f32 v172, v172
    v_mfma_f32_16x16x32_bf16 v[158:161], a[248:251], v[206:209], v[158:161]
    v_exp_f32 v173, v173
    v_mfma_f32_16x16x32_bf16 v[158:161], a[252:255], v[242:245], v[158:161]
    ds_read_b128 v[118:121], v2 offset:12288
    v_cvt_pk_bf16_f32 v37, v172, v173
    v_mfma_f32_16x16x32_bf16 v[158:161], v[82:85], v[146:149], v[158:161]
    ds_read_b128 v[134:137], v2 offset:13312
    v_mul_f32 v240, v210, v240
    v_mfma_f32_16x16x32_bf16 v[170:173], v[28:31], v[36:39], 0
    v_mul_f32 v241, v210, v241
    v_cvt_pk_bf16_f32 v181, v240, v241
    v_mfma_f32_16x16x32_bf16 v[170:173], v[28:31], v[162:165], v[170:173]
    ds_write_b128 v3, v[178:181] offset:0
    v_mfma_f32_16x16x32_bf16 v[154:157], v[130:133], v[36:39], 0
    v_mul_f32 v186, v210, v186
    v_mul_f32 v187, v210, v187
    v_mfma_f32_16x16x32_bf16 v[154:157], v[174:177], v[162:165], v[154:157]
    v_cvt_pk_bf16_f32 v186, v186, v187
    v_mul_f32 v188, v210, v188
    v_mfma_f32_16x16x32_bf16 v[130:133], v[222:225], v[36:39], 0
    v_mul_f32 v189, v210, v189
    v_cvt_pk_bf16_f32 v187, v188, v189
    v_mfma_f32_16x16x32_bf16 v[130:133], v[182:185], v[162:165], v[130:133]
    s_waitcnt lgkmcnt(2)
    ds_write_b64 v4, v[186:187] offset:4096
    v_mfma_f32_16x16x32_bf16 v[174:177], v[166:169], v[36:39], 0
    s_waitcnt lgkmcnt(2)
    v_fma_f32 v255, v142, v142, s33
    v_fmac_f32 v255, v143, v143
    v_mfma_f32_16x16x32_bf16 v[174:177], v[114:117], v[162:165], v[174:177]
    v_fmac_f32 v255, v144, v144
    v_fmac_f32 v255, v145, v145
    v_mfma_f32_16x16x32_bf16 v[158:161], v[86:89], v[138:141], v[158:161]
    ds_read_b128 v[114:117], v2 offset:14336
    v_fmac_f32 v254, v205, v205
    v_mfma_f32_16x16x32_bf16 v[178:181], v[90:93], v[198:201], 0
    ds_read_b128 v[166:169], v2 offset:15360
    v_add_u32 v7, 16, v7
    v_mfma_f32_16x16x32_bf16 v[178:181], v[94:97], v[226:229], v[178:181]
    ds_read_b128 v[162:165], v2 offset:16384
    v_mfma_f32_16x16x32_bf16 v[178:181], v[98:101], v[206:209], v[178:181]
    ds_read_b128 v[206:209], v2 offset:17408
    v_fmac_f32 v255, v158, v158
    v_mfma_f32_16x16x32_bf16 v[178:181], v[102:105], v[242:245], v[178:181]
    v_fmac_f32 v255, v159, v159
    v_fmac_f32 v255, v160, v160
    v_mfma_f32_16x16x32_bf16 v[178:181], v[106:109], v[146:149], v[178:181]
    v_fmac_f32 v255, v161, v161
    v_xor_b32 v2, 65536, v2
    v_mfma_f32_16x16x32_bf16 v[178:181], v[110:113], v[138:141], v[178:181]
    v_rcp_f32 v170, v170
    v_mfma_f32_16x16x32_bf16 v[146:149], a[216:219], v[118:121], 0
    v_mul_f32 v154, v170, v154
    v_mul_f32 v155, v170, v155
    v_mfma_f32_16x16x32_bf16 v[146:149], a[220:223], v[134:137], v[146:149]
    s_waitcnt lgkmcnt(3)
    ds_read_b128 v[182:185], v0 offset:20480
    v_cvt_pk_bf16_f32 v154, v154, v155
    v_mfma_f32_16x16x32_bf16 v[146:149], a[224:227], v[114:117], v[146:149]
    s_waitcnt lgkmcnt(3)
    ds_read_b128 v[198:201], v1 offset:20480
    v_fmac_f32 v255, v178, v178
    v_mfma_f32_16x16x32_bf16 v[146:149], a[228:231], v[166:169], v[146:149]
    s_waitcnt lgkmcnt(3)
    ds_read_b128 v[210:213], v0 offset:20608
    v_fmac_f32 v255, v179, v179
    v_mfma_f32_16x16x32_bf16 v[146:149], a[232:235], v[162:165], v[146:149]
    s_waitcnt lgkmcnt(3)
    ds_read_b128 v[222:225], v1 offset:20608
    v_fmac_f32 v255, v180, v180
    v_mfma_f32_16x16x32_bf16 v[146:149], a[236:239], v[206:209], v[146:149]
    ds_read_b128 v[226:229], v0 offset:20736
    v_fmac_f32 v255, v181, v181
    v_mfma_f32_16x16x32_bf16 v[138:141], a[240:243], v[118:121], 0
    ds_read_b128 v[242:245], v1 offset:20736
    v_cvt_pk_bf16_f32 v254, v254, v255
    v_mfma_f32_16x16x32_bf16 v[138:141], a[244:247], v[134:137], v[138:141]
    v_mul_f32 v156, v170, v156
    v_mul_f32 v157, v170, v157
    v_mfma_f32_16x16x32_bf16 v[138:141], a[248:251], v[114:117], v[138:141]
    v_fma_f32 v255, v146, v146, s33
    v_fmac_f32 v255, v147, v147
    v_mfma_f32_16x16x32_bf16 v[138:141], a[252:255], v[166:169], v[138:141]
    s_waitcnt lgkmcnt(5)
    v_fmac_f32 v255, v148, v148
    v_fmac_f32 v255, v149, v149
    v_mfma_f32_16x16x32_bf16 v[138:141], v[82:85], v[162:165], v[138:141]
    s_waitcnt lgkmcnt(4)
    v_cvt_pk_bf16_f32 v155, v156, v157
    v_mul_f32 v130, v170, v130
    v_mfma_f32_16x16x32_bf16 v[138:141], v[86:89], v[206:209], v[138:141]
    s_waitcnt lgkmcnt(3)
    v_mul_f32 v131, v170, v131
    v_cvt_pk_bf16_f32 v156, v130, v131
    v_mfma_f32_16x16x32_bf16 v[186:189], v[90:93], v[118:121], 0
    s_waitcnt lgkmcnt(2)
    v_mul_f32 v132, v170, v132
    v_mul_f32 v133, v170, v133
    v_mfma_f32_16x16x32_bf16 v[186:189], v[94:97], v[134:137], v[186:189]
    s_waitcnt lgkmcnt(1)
    v_fmac_f32 v255, v138, v138
    v_fmac_f32 v255, v139, v139
    v_mfma_f32_16x16x32_bf16 v[186:189], v[98:101], v[114:117], v[186:189]
    s_waitcnt lgkmcnt(0)
    v_fmac_f32 v255, v140, v140
    v_fmac_f32 v255, v141, v141
    v_mfma_f32_16x16x32_bf16 v[186:189], v[102:105], v[166:169], v[186:189]
    v_cvt_pk_bf16_f32 v157, v132, v133
    v_mul_f32 v174, v170, v174
    v_mfma_f32_16x16x32_bf16 v[186:189], v[106:109], v[162:165], v[186:189]
    ds_write_b128 v3, v[154:157] offset:12288
    v_mfma_f32_16x16x32_bf16 v[186:189], v[110:113], v[206:209], v[186:189]
    v_mul_f32 v175, v170, v175
    v_cvt_pk_bf16_f32 v174, v174, v175
    v_mfma_f32_16x16x32_bf16 v[118:121], a[72:75], v[182:185], 0
    v_mul_f32 v176, v170, v176
    v_mul_f32 v177, v170, v177
    v_mfma_f32_16x16x32_bf16 v[118:121], a[76:79], v[198:201], v[118:121]
    v_rcp_f32 v194, v194
    v_mfma_f32_16x16x32_bf16 v[118:121], a[80:83], v[210:213], v[118:121]
    v_fmac_f32 v255, v186, v186
    v_fmac_f32 v255, v187, v187
    v_mfma_f32_16x16x32_bf16 v[118:121], a[84:87], v[222:225], v[118:121]
    v_fmac_f32 v255, v188, v188
    v_fmac_f32 v255, v189, v189
    v_mfma_f32_16x16x32_bf16 v[118:121], a[88:91], v[226:229], v[118:121]
    v_cvt_pk_bf16_f32 v255, v255, v255
    v_cvt_pk_bf16_f32 v175, v176, v177
    v_mfma_f32_16x16x32_bf16 v[118:121], a[92:95], v[242:245], v[118:121]
    ds_write_b64 v4, v[174:175] offset:16384
    v_mfma_f32_16x16x32_bf16 v[206:209], a[96:99], v[182:185], 0
    v_mul_f32 v122, v194, v122
    v_mul_f32 v123, v194, v123
    v_mfma_f32_16x16x32_bf16 v[206:209], a[100:103], v[198:201], v[206:209]
    ds_write_b64 v4, v[254:255] offset:18432
    v_mfma_f32_16x16x32_bf16 v[206:209], a[104:107], v[210:213], v[206:209]
    v_cvt_pk_bf16_f32 v134, v122, v123
    v_cvt_pk_f16_f32 v118, v118, v119
    v_mfma_f32_16x16x32_bf16 v[206:209], a[108:111], v[222:225], v[206:209]
    v_pk_mul_f16 v163, v118, v118
    v_cvt_pk_f16_f32 v119, v120, v121
    v_mfma_f32_16x16x32_bf16 v[206:209], a[112:115], v[226:229], v[206:209]
    v_pk_mul_f16 v165, v119, v119
    v_mul_f32 v124, v194, v124
    v_mfma_f32_16x16x32_bf16 v[206:209], a[116:119], v[242:245], v[206:209]
    v_mul_f32 v125, v194, v125
    v_cvt_pk_bf16_f32 v135, v124, v125
    v_mfma_f32_16x16x32_bf16 v[122:125], a[120:123], v[182:185], 0
    v_mul_f32 v126, v194, v126
    v_mul_f32 v127, v194, v127
    v_mfma_f32_16x16x32_bf16 v[122:125], a[124:127], v[198:201], v[122:125]
    v_cvt_pk_bf16_f32 v136, v126, v127
    v_mul_f32 v128, v194, v128
    v_mfma_f32_16x16x32_bf16 v[122:125], a[128:131], v[210:213], v[122:125]
    v_cvt_pk_f16_f32 v120, v206, v207
    v_pk_fma_f16 v163, v120, v120, v163
    v_mfma_f32_16x16x32_bf16 v[122:125], a[132:135], v[222:225], v[122:125]
    v_cvt_pk_f16_f32 v121, v208, v209
    v_pk_fma_f16 v165, v121, v121, v165
    v_mfma_f32_16x16x32_bf16 v[122:125], a[136:139], v[226:229], v[122:125]
    v_mul_f32 v129, v194, v129
    v_cvt_pk_bf16_f32 v137, v128, v129
    v_mfma_f32_16x16x32_bf16 v[122:125], a[140:143], v[242:245], v[122:125]
    ds_write_b128 v3, v[134:137] offset:6144
    v_mfma_f32_16x16x32_bf16 v[206:209], a[0:3], v[182:185], 0
    v_mul_f32 v218, v194, v218
    v_mul_f32 v219, v194, v219
    v_mfma_f32_16x16x32_bf16 v[206:209], a[4:7], v[198:201], v[206:209]
    v_cvt_pk_bf16_f32 v254, v218, v219
    v_mul_f32 v220, v194, v220
    v_mfma_f32_16x16x32_bf16 v[206:209], a[8:11], v[210:213], v[206:209]
    v_cvt_pk_f16_f32 v196, v122, v123
    v_pk_fma_f16 v163, v196, v196, v163
    v_mfma_f32_16x16x32_bf16 v[206:209], a[12:15], v[222:225], v[206:209]
    v_cvt_pk_f16_f32 v197, v124, v125
    v_pk_fma_f16 v165, v197, v197, v165
    v_mfma_f32_16x16x32_bf16 v[206:209], a[16:19], v[226:229], v[206:209]
    v_mul_f32 v221, v194, v221
    v_cvt_pk_bf16_f32 v255, v220, v221
    v_mfma_f32_16x16x32_bf16 v[206:209], a[20:23], v[242:245], v[206:209]
    ds_write_b64 v4, v[254:255] offset:10240
    v_mfma_f32_16x16x32_bf16 v[174:177], a[24:27], v[182:185], 0
    v_xor_b32 v3, 65536, v3
    v_xor_b32 v4, 65536, v4
    v_mfma_f32_16x16x32_bf16 v[174:177], a[28:31], v[198:201], v[174:177]
    v_mfma_f32_16x16x32_bf16 v[174:177], a[32:35], v[210:213], v[174:177]
    v_mfma_f32_16x16x32_bf16 v[174:177], a[36:39], v[222:225], v[174:177]
    v_mfma_f32_16x16x32_bf16 v[174:177], a[40:43], v[226:229], v[174:177]
    v_cvt_pk_f16_f32 v206, v206, v207
    v_mfma_f32_16x16x32_bf16 v[174:177], a[44:47], v[242:245], v[174:177]
    v_mfma_f32_16x16x32_bf16 v[218:221], a[48:51], v[182:185], 0
    s_waitcnt lgkmcnt(0)
    v_mfma_f32_16x16x32_bf16 v[218:221], a[52:55], v[198:201], v[218:221]
    s_nop 0
    v_mfma_f32_16x16x32_bf16 v[218:221], a[56:59], v[210:213], v[218:221]
    s_nop 0
    v_mfma_f32_16x16x32_bf16 v[218:221], a[60:63], v[222:225], v[218:221]
    s_barrier
    v_mfma_f32_16x16x32_bf16 v[218:221], a[64:67], v[226:229], v[218:221]
    s_nop 0
    v_mfma_f32_16x16x32_bf16 v[218:221], a[68:71], v[242:245], v[218:221]
    v_mfma_f32_16x16x32_bf16 v[170:173], v[182:185], a[144:147], 0
    v_mfma_f32_16x16x32_bf16 v[170:173], v[198:201], a[148:151], v[170:173]
    v_mfma_f32_16x16x32_bf16 v[170:173], v[210:213], a[152:155], v[170:173]
    v_mfma_f32_16x16x32_bf16 v[170:173], v[222:225], a[156:159], v[170:173]
    v_mfma_f32_16x16x32_bf16 v[170:173], v[226:229], a[160:163], v[170:173]
    v_mfma_f32_16x16x32_bf16 v[170:173], v[242:245], a[164:167], v[170:173]
    s_cbranch_scc1 L_loop_fast2
    s_branch L_final_fast
.p2align 6
L_loop_fast3:
    v_mfma_f32_16x16x32_bf16 v[234:237], v[182:185], a[168:171], 0
    s_add_u32 s12, s42, s27
    ds_read_b128 v[230:233], v2 offset:18432
    ds_read_b128 v[238:241], v2 offset:19456
    v_mfma_f32_16x16x32_bf16 v[234:237], v[198:201], a[172:175], v[234:237]
    s_addc_u32 s13, s43, 0
    v_pk_mul_f16 v162, v206, v206
    v_cvt_pk_f16_f32 v207, v208, v209
    v_mfma_f32_16x16x32_bf16 v[234:237], v[210:213], a[176:179], v[234:237]
    s_sub_u32 s14, s36, s27
    ds_read_b128 v[134:137], v0 offset:26624
    v_pk_mul_f16 v164, v207, v207
    v_mfma_f32_16x16x32_bf16 v[234:237], v[222:225], a[180:183], v[234:237]
    s_cmp_ge_u32 s18, 2
    ds_read_b128 v[154:157], v1 offset:26624
    v_cvt_pk_f16_f32 v208, v174, v175
    v_mfma_f32_16x16x32_bf16 v[234:237], v[226:229], a[184:187], v[234:237]
    s_cselect_b32 s14, s14, 0
    ds_read_b128 v[130:133], v0 offset:26752
    v_pk_fma_f16 v162, v208, v208, v162
    v_mfma_f32_16x16x32_bf16 v[234:237], v[242:245], a[188:191], v[234:237]
    s_add_u32 s34, s18, 2
    ds_read_b128 v[122:125], v1 offset:26752
    v_cvt_pk_f16_f32 v209, v176, v177
    v_mfma_f32_16x16x32_bf16 v[114:117], v[182:185], a[192:195], 0
    s_add_u32 s8, s40, s23
    ds_read_b128 v[126:129], v0 offset:26880
    v_pk_fma_f16 v164, v209, v209, v164
    v_mfma_f32_16x16x32_bf16 v[114:117], v[198:201], a[196:199], v[114:117]
    s_addc_u32 s9, s41, 0
    ds_read_b128 v[166:169], v1 offset:26880
    v_cvt_pk_f16_f32 v194, v218, v219
    v_mfma_f32_16x16x32_bf16 v[114:117], v[210:213], a[200:203], v[114:117]
    s_waitcnt lgkmcnt(6)
    v_pk_fma_f16 v162, v194, v194, v162
    v_cvt_pk_f16_f32 v195, v220, v221
    v_mfma_f32_16x16x32_bf16 v[198:201], v[32:35], v[230:233], 0
    s_sub_u32 s10, s36, s23
    v_pk_fma_f16 v164, v195, v195, v164
    v_cvt_pk_bf16_f32 v174, v170, v171
    v_mfma_f32_16x16x32_bf16 v[198:201], v[32:35], v[238:241], v[198:201]
    s_waitcnt lgkmcnt(5)
    v_cvt_pk_bf16_f32 v175, v172, v173
    v_cvt_pk_bf16_f32 v182, v234, v235
    v_mfma_f32_16x16x32_f16 v[170:173], v[40:43], v[162:165], 0
    s_cmp_lt_u32 s34, s17
    v_cvt_pk_bf16_f32 v183, v236, v237
    s_cselect_b32 s10, s10, 0
    v_mfma_f32_16x16x32_bf16 v[114:117], v[222:225], a[204:207], v[114:117]
    s_add_u32 m0, s28, 0
    v_mul_f32 v255, 0x3baaaaab, v198
    v_mul_f32 v254, 0x3baaaaab, v199
    v_mfma_f32_16x16x32_bf16 v[114:117], v[226:229], a[208:211], v[114:117]
    s_mov_b32 s27, s26
    v_rsq_f32 v172, v170
    v_mfma_f32_16x16x32_bf16 v[114:117], v[242:245], a[212:215], v[114:117]
    s_mov_b32 s26, s25
    v_rsq_f32 v173, v171
    v_mfma_f32_16x16x32_bf16 v[162:165], a[72:75], v[134:137], 0
    s_waitcnt lgkmcnt(0)
    v_mul_f32 v172, s31, v172
    v_cvt_pk_f16_f32 v172, v172, v173
    v_mfma_f32_16x16x32_bf16 v[162:165], a[76:79], v[154:157], v[162:165]
    s_mov_b32 s25, s24
    v_cvt_pk_bf16_f32 v114, v114, v115
    v_cvt_pk_bf16_f32 v115, v116, v117
    v_mfma_f32_16x16x32_bf16 v[162:165], a[80:83], v[130:133], v[162:165]
    s_mov_b32 s24, s23
    v_pk_mul_f16 v118, v118, v172 op_sel:[0,1] op_sel_hi:[1,1]
    v_pk_mul_f16 v119, v119, v172 op_sel:[0,1] op_sel_hi:[1,1]
    v_mfma_f32_16x16x32_bf16 v[162:165], a[84:87], v[122:125], v[162:165]
    v_pk_mul_f16 v120, v120, v172 op_sel:[0,1] op_sel_hi:[1,1]
    v_pk_mul_f16 v121, v121, v172 op_sel:[0,1] op_sel_hi:[1,1]
    v_mfma_f32_16x16x32_bf16 v[162:165], a[88:91], v[126:129], v[162:165]
    v_pk_mul_f16 v196, v196, v172 op_sel:[0,1] op_sel_hi:[1,1]
    v_pk_mul_f16 v197, v197, v172 op_sel:[0,1] op_sel_hi:[1,1]
    v_mfma_f32_16x16x32_bf16 v[162:165], a[92:95], v[166:169], v[162:165]
    v_pk_mul_f16 v206, v206, v172 op_sel:[0,0] op_sel_hi:[1,0]
    v_pk_mul_f16 v207, v207, v172 op_sel:[0,0] op_sel_hi:[1,0]
    v_mfma_f32_16x16x32_bf16 v[210:213], a[96:99], v[134:137], 0
    v_pk_mul_f16 v208, v208, v172 op_sel:[0,0] op_sel_hi:[1,0]
    v_pk_mul_f16 v209, v209, v172 op_sel:[0,0] op_sel_hi:[1,0]
    v_mfma_f32_16x16x32_bf16 v[210:213], a[100:103], v[154:157], v[210:213]
    v_pk_mul_f16 v194, v194, v172 op_sel:[0,0] op_sel_hi:[1,0]
    v_pk_mul_f16 v195, v195, v172 op_sel:[0,0] op_sel_hi:[1,0]
    v_mfma_f32_16x16x32_bf16 v[210:213], a[104:107], v[130:133], v[210:213]
    v_min3_u32 v44, v44, v170, v171
    v_max3_u32 v45, v45, v170, v171
    v_mfma_f32_16x16x32_bf16 v[210:213], a[108:111], v[122:125], v[210:213]
    v_cvt_pk_f16_f32 v170, v162, v163
    v_pk_mul_f16 v163, v170, v170
    v_mfma_f32_16x16x32_bf16 v[210:213], a[112:115], v[126:129], v[210:213]
    v_cvt_pk_f16_f32 v171, v164, v165
    v_pk_mul_f16 v165, v171, v171
    v_mfma_f32_16x16x32_bf16 v[210:213], a[116:119], v[166:169], v[210:213]
    v_rsq_f32 v255, v255
    v_mfma_f32_16x16x32_bf16 v[214:217], a[120:123], v[134:137], 0
    v_rsq_f32 v254, v254
    v_mfma_f32_16x16x32_bf16 v[214:217], a[124:127], v[154:157], v[214:217]
    v_mul_f32 v142, v254, v142
    v_mul_f32 v143, v254, v143
    v_mfma_f32_16x16x32_bf16 v[214:217], a[128:131], v[130:133], v[214:217]
    v_cvt_pk_bf16_f32 v142, v142, v143
    v_cvt_pk_f16_f32 v172, v210, v211
    v_mfma_f32_16x16x32_bf16 v[214:217], a[132:135], v[122:125], v[214:217]
    v_pk_fma_f16 v163, v172, v172, v163
    v_cvt_pk_f16_f32 v173, v212, v213
    v_mfma_f32_16x16x32_bf16 v[214:217], a[136:139], v[126:129], v[214:217]
    v_pk_fma_f16 v165, v173, v173, v165
    v_mul_f32 v144, v254, v144
    v_mfma_f32_16x16x32_bf16 v[214:217], a[140:143], v[166:169], v[214:217]
    v_mul_f32 v145, v254, v145
    v_cvt_pk_bf16_f32 v143, v144, v145
    v_mfma_f32_16x16x32_bf16 v[210:213], a[0:3], v[134:137], 0
    v_mul_f32 v158, v254, v158
    v_mul_f32 v159, v254, v159
    v_mfma_f32_16x16x32_bf16 v[210:213], a[4:7], v[154:157], v[210:213]
    v_cvt_pk_bf16_f32 v144, v158, v159
    v_mul_f32 v160, v254, v160
    v_mfma_f32_16x16x32_bf16 v[210:213], a[8:11], v[130:133], v[210:213]
    v_cvt_pk_f16_f32 v220, v214, v215
    v_pk_fma_f16 v163, v220, v220, v163
    v_mfma_f32_16x16x32_bf16 v[210:213], a[12:15], v[122:125], v[210:213]
    v_cvt_pk_f16_f32 v221, v216, v217
    v_pk_fma_f16 v165, v221, v221, v165
    v_mfma_f32_16x16x32_bf16 v[210:213], a[16:19], v[126:129], v[210:213]
    v_mul_f32 v161, v254, v161
    v_cvt_pk_bf16_f32 v145, v160, v161
    v_mfma_f32_16x16x32_bf16 v[210:213], a[20:23], v[166:169], v[210:213]
    buffer_store_dwordx4 v[142:145], v16, s[12:15], 0 offen nt
    v_mul_f32 v178, v254, v178
    v_mul_f32 v179, v254, v179
    v_cvt_pk_bf16_f32 v198, v178, v179
    v_mul_f32 v180, v254, v180
    v_mfma_f32_16x16x32_bf16 v[142:145], a[24:27], v[134:137], 0
    v_mul_f32 v181, v254, v181
    v_cvt_pk_bf16_f32 v199, v180, v181
    v_mfma_f32_16x16x32_bf16 v[142:145], a[28:31], v[154:157], v[142:145]
    v_cvt_pk_f16_f32 v158, v210, v211
    v_pk_mul_f16 v162, v158, v158
    v_mfma_f32_16x16x32_bf16 v[142:145], a[32:35], v[130:133], v[142:145]
    v_cvt_pk_f16_f32 v159, v212, v213
    v_pk_mul_f16 v164, v159, v159
    v_mfma_f32_16x16x32_bf16 v[142:145], a[36:39], v[122:125], v[142:145]
    v_mul_f32 v254, 0x3baaaaab, v200
    v_mul_f32 v150, v255, v150
    v_mfma_f32_16x16x32_bf16 v[142:145], a[40:43], v[126:129], v[142:145]
    v_rsq_f32 v254, v254
    v_mfma_f32_16x16x32_bf16 v[142:145], a[44:47], v[166:169], v[142:145]
    v_mul_f32 v146, v254, v146
    v_mul_f32 v147, v254, v147
    v_mfma_f32_16x16x32_bf16 v[178:181], a[48:51], v[134:137], 0
    v_cvt_pk_bf16_f32 v146, v146, v147
    v_mul_f32 v148, v254, v148
    v_mfma_f32_16x16x32_bf16 v[178:181], a[52:55], v[154:157], v[178:181]
    v_mul_f32 v149, v254, v149
    v_cvt_pk_bf16_f32 v147, v148, v149
    v_mfma_f32_16x16x32_bf16 v[178:181], a[56:59], v[130:133], v[178:181]
    v_mul_f32 v138, v254, v138
    v_mul_f32 v139, v254, v139
    v_mfma_f32_16x16x32_bf16 v[178:181], a[60:63], v[122:125], v[178:181]
    v_cvt_pk_bf16_f32 v148, v138, v139
    v_mul_f32 v140, v254, v140
    v_mfma_f32_16x16x32_bf16 v[178:181], a[64:67], v[126:129], v[178:181]
    v_mul_f32 v141, v254, v141
    v_cvt_pk_bf16_f32 v149, v140, v141
    v_mfma_f32_16x16x32_bf16 v[178:181], a[68:71], v[166:169], v[178:181]
    v_mul_f32 v186, v254, v186
    v_mul_f32 v187, v254, v187
    v_mfma_f32_16x16x32_bf16 v[138:141], v[134:137], a[144:147], 0
    v_cvt_pk_bf16_f32 v200, v186, v187
    v_mul_f32 v188, v254, v188
    v_mfma_f32_16x16x32_bf16 v[138:141], v[154:157], a[148:151], v[138:141]
    v_mul_f32 v189, v254, v189
    v_cvt_pk_bf16_f32 v201, v188, v189
    v_mfma_f32_16x16x32_bf16 v[138:141], v[130:133], a[152:155], v[138:141]
    v_cvt_pk_f16_f32 v160, v142, v143
    v_pk_fma_f16 v162, v160, v160, v162
    v_mfma_f32_16x16x32_bf16 v[138:141], v[122:125], a[156:159], v[138:141]
    v_cvt_pk_f16_f32 v161, v144, v145
    v_pk_fma_f16 v164, v161, v161, v164
    v_mfma_f32_16x16x32_bf16 v[138:141], v[126:129], a[160:163], v[138:141]
    buffer_store_dwordx4 v[146:149], v17, s[12:15], 0 offen nt
    v_cvt_pk_f16_f32 v218, v178, v179
    v_pk_fma_f16 v162, v218, v218, v162
    v_cvt_pk_f16_f32 v219, v180, v181
    v_pk_fma_f16 v164, v219, v219, v164
    v_mfma_f32_16x16x32_bf16 v[138:141], v[166:169], a[164:167], v[138:141]
    v_mul_f32 v151, v255, v151
    v_cvt_pk_bf16_f32 v150, v150, v151
    v_mfma_f32_16x16x32_f16 v[142:145], v[40:43], v[162:165], 0
    v_mul_f32 v152, v255, v152
    v_mul_f32 v153, v255, v153
    v_mfma_f32_16x16x32_bf16 v[178:181], v[134:137], a[168:171], 0
    v_cvt_pk_bf16_f32 v151, v152, v153
    v_mul_f32 v190, v255, v190
    v_mfma_f32_16x16x32_bf16 v[178:181], v[154:157], a[172:175], v[178:181]
    v_cvt_pk_bf16_f32 v176, v138, v139
    v_cvt_pk_bf16_f32 v177, v140, v141
    v_mfma_f32_16x16x32_bf16 v[178:181], v[130:133], a[176:179], v[178:181]
    ds_read_b128 v[146:149], v0 offset:32768
    v_min3_u32 v44, v44, v142, v143
    v_mfma_f32_16x16x32_bf16 v[178:181], v[122:125], a[180:183], v[178:181]
    ds_read_b128 v[138:141], v1 offset:32768
    v_max3_u32 v45, v45, v142, v143
    v_mfma_f32_16x16x32_bf16 v[178:181], v[126:129], a[184:187], v[178:181]
    ds_read_b128 v[186:189], v0 offset:32896
    v_mul_f32 v191, v255, v191
    v_mfma_f32_16x16x32_bf16 v[178:181], v[166:169], a[188:191], v[178:181]
    ds_read_b128 v[162:165], v1 offset:32896
    v_cvt_pk_bf16_f32 v152, v190, v191
    v_mfma_f32_16x16x32_bf16 v[210:213], v[134:137], a[192:195], 0
    ds_read_b128 v[134:137], v0 offset:33024
    v_mul_f32 v192, v255, v192
    v_mfma_f32_16x16x32_bf16 v[210:213], v[154:157], a[196:199], v[210:213]
    ds_read_b128 v[154:157], v1 offset:33024
    v_mul_f32 v193, v255, v193
    v_mfma_f32_16x16x32_bf16 v[210:213], v[130:133], a[200:203], v[210:213]
    v_rsq_f32 v144, v142
    v_mfma_f32_16x16x32_bf16 v[210:213], v[122:125], a[204:207], v[210:213]
    v_rsq_f32 v145, v143
    v_mfma_f32_16x16x32_bf16 v[210:213], v[126:129], a[208:211], v[210:213]
    s_waitcnt lgkmcnt(5)
    v_mul_f32 v144, s31, v144
    v_cvt_pk_f16_f32 v144, v144, v145
    v_mfma_f32_16x16x32_bf16 v[210:213], v[166:169], a[212:215], v[210:213]
    s_waitcnt lgkmcnt(4)
    v_cvt_pk_bf16_f32 v184, v178, v179
    v_cvt_pk_bf16_f32 v185, v180, v181
    v_mfma_f32_16x16x32_bf16 v[178:181], a[72:75], v[146:149], 0
    s_waitcnt lgkmcnt(3)
    v_pk_mul_f16 v170, v170, v144 op_sel:[0,1] op_sel_hi:[1,1]
    v_pk_mul_f16 v171, v171, v144 op_sel:[0,1] op_sel_hi:[1,1]
    v_mfma_f32_16x16x32_bf16 v[178:181], a[76:79], v[138:141], v[178:181]
    s_waitcnt lgkmcnt(2)
    v_cvt_pk_bf16_f32 v116, v210, v211
    v_cvt_pk_bf16_f32 v117, v212, v213
    v_mfma_f32_16x16x32_bf16 v[178:181], a[80:83], v[186:189], v[178:181]
    s_waitcnt lgkmcnt(1)
    buffer_store_dwordx2 v[200:201], v20, s[12:15], 0 offen nt
    v_pk_mul_f16 v172, v172, v144 op_sel:[0,1] op_sel_hi:[1,1]
    v_pk_mul_f16 v173, v173, v144 op_sel:[0,1] op_sel_hi:[1,1]
    v_mfma_f32_16x16x32_bf16 v[178:181], a[84:87], v[162:165], v[178:181]
    s_waitcnt lgkmcnt(0)
    v_pk_mul_f16 v220, v220, v144 op_sel:[0,1] op_sel_hi:[1,1]
    v_pk_mul_f16 v221, v221, v144 op_sel:[0,1] op_sel_hi:[1,1]
    v_mfma_f32_16x16x32_bf16 v[178:181], a[88:91], v[134:137], v[178:181]
    v_pk_mul_f16 v158, v158, v144 op_sel:[0,0] op_sel_hi:[1,0]
    v_pk_mul_f16 v159, v159, v144 op_sel:[0,0] op_sel_hi:[1,0]
    v_mfma_f32_16x16x32_bf16 v[178:181], a[92:95], v[154:157], v[178:181]
    v_pk_mul_f16 v160, v160, v144 op_sel:[0,0] op_sel_hi:[1,0]
    v_pk_mul_f16 v161, v161, v144 op_sel:[0,0] op_sel_hi:[1,0]
    v_mfma_f32_16x16x32_bf16 v[130:133], a[96:99], v[146:149], 0
    v_pk_mul_f16 v218, v218, v144 op_sel:[0,0] op_sel_hi:[1,0]
    v_pk_mul_f16 v219, v219, v144 op_sel:[0,0] op_sel_hi:[1,0]
    v_mfma_f32_16x16x32_bf16 v[130:133], a[100:103], v[138:141], v[130:133]
    s_waitcnt vmcnt(3)
    v_cvt_pk_bf16_f32 v153, v192, v193
    v_cvt_pk_f16_f32 v142, v178, v179
    v_mfma_f32_16x16x32_bf16 v[130:133], a[104:107], v[186:189], v[130:133]
    s_nop 0
    v_pk_mul_f16 v191, v142, v142
    v_cvt_pk_f16_f32 v143, v180, v181
    v_mfma_f32_16x16x32_bf16 v[130:133], a[108:111], v[162:165], v[130:133]
    s_nop 0
    v_pk_mul_f16 v193, v143, v143
    v_mul_f32 v202, v255, v202
    v_mfma_f32_16x16x32_bf16 v[130:133], a[112:115], v[134:137], v[130:133]
    s_nop 0
    v_mul_f32 v203, v255, v203
    v_cvt_pk_bf16_f32 v254, v202, v203
    v_mfma_f32_16x16x32_bf16 v[130:133], a[116:119], v[154:157], v[130:133]
    s_barrier
    v_mul_f32 v204, v255, v204
    v_mul_f32 v205, v255, v205
    v_mfma_f32_16x16x32_bf16 v[178:181], a[120:123], v[146:149], 0
    v_cvt_pk_bf16_f32 v255, v204, v205
    v_xor_b32 v0, 65536, v0
    v_mfma_f32_16x16x32_bf16 v[178:181], a[124:127], v[138:141], v[178:181]
    v_xor_b32 v1, 65536, v1
    v_cvt_pk_f16_f32 v144, v130, v131
    v_mfma_f32_16x16x32_bf16 v[178:181], a[128:131], v[186:189], v[178:181]
    v_pk_fma_f16 v191, v144, v144, v191
    v_cvt_pk_f16_f32 v145, v132, v133
    v_mfma_f32_16x16x32_bf16 v[178:181], a[132:135], v[162:165], v[178:181]
    v_pk_fma_f16 v193, v145, v145, v193
    v_mfma_f32_16x16x32_bf16 v[178:181], a[136:139], v[134:137], v[178:181]
    v_mfma_f32_16x16x32_bf16 v[178:181], a[140:143], v[154:157], v[178:181]
    v_mfma_f32_16x16x32_bf16 v[202:205], a[0:3], v[146:149], 0
    v_mfma_f32_16x16x32_bf16 v[202:205], a[4:7], v[138:141], v[202:205]
    buffer_load_dwordx4 v10, s[8:11], 0 offen nt lds
    s_add_u32 m0, s28, 4096
    v_mfma_f32_16x16x32_bf16 v[202:205], a[8:11], v[186:189], v[202:205]
    v_mfma_f32_16x16x32_bf16 v[202:205], a[12:15], v[162:165], v[202:205]
    v_mfma_f32_16x16x32_bf16 v[202:205], a[16:19], v[134:137], v[202:205]
    v_mfma_f32_16x16x32_bf16 v[202:205], a[20:23], v[154:157], v[202:205]
    v_cvt_pk_f16_f32 v124, v178, v179
    v_pk_fma_f16 v191, v124, v124, v191
    v_mfma_f32_16x16x32_bf16 v[130:133], a[24:27], v[146:149], 0
    buffer_load_dwordx4 v11, s[8:11], 0 offen nt lds
    v_cvt_pk_f16_f32 v125, v180, v181
    v_mfma_f32_16x16x32_bf16 v[130:133], a[28:31], v[138:141], v[130:133]
    s_add_u32 m0, s28, 8192
    v_pk_fma_f16 v193, v125, v125, v193
    v_cvt_pk_f16_f32 v178, v202, v203
    v_mfma_f32_16x16x32_bf16 v[130:133], a[32:35], v[186:189], v[130:133]
    v_pk_mul_f16 v190, v178, v178
    v_cvt_pk_f16_f32 v179, v204, v205
    v_mfma_f32_16x16x32_bf16 v[130:133], a[36:39], v[162:165], v[130:133]
    v_pk_mul_f16 v192, v179, v179
    v_mfma_f32_16x16x32_bf16 v[130:133], a[40:43], v[134:137], v[130:133]
    v_mfma_f32_16x16x32_bf16 v[130:133], a[44:47], v[154:157], v[130:133]
    buffer_load_dwordx4 v12, s[8:11], 0 offen nt lds
    s_add_u32 m0, s28, 12288
    v_mfma_f32_16x16x32_bf16 v[202:205], a[48:51], v[146:149], 0
    s_xor_b32 s28, s28, 65536
    v_mfma_f32_16x16x32_bf16 v[202:205], a[52:55], v[138:141], v[202:205]
    ds_read_b128 v[166:169], v5 offset:0
    ds_read_b128 v[126:129], v5 offset:16
    v_mfma_f32_16x16x32_bf16 v[202:205], a[56:59], v[186:189], v[202:205]
    ds_read_b128 v[210:213], v5 offset:48
    ds_read_b32 v200, v6 offset:192
    v_mfma_f32_16x16x32_bf16 v[202:205], a[60:63], v[162:165], v[202:205]
    v_cvt_pk_f16_f32 v180, v130, v131
    v_pk_fma_f16 v190, v180, v180, v190
    v_mfma_f32_16x16x32_bf16 v[202:205], a[64:67], v[134:137], v[202:205]
    buffer_load_dwordx4 v13, s[8:11], 0 offen nt lds
    v_cvt_pk_f16_f32 v181, v132, v133
    v_mfma_f32_16x16x32_bf16 v[202:205], a[68:71], v[154:157], v[202:205]
    s_mov_b32 m0, s29
    v_pk_fma_f16 v192, v181, v181, v192
    v_add_u32 v5, 336, v5
    v_mfma_f32_16x16x32_bf16 v[130:133], v[146:149], a[144:147], 0
    s_xor_b32 s29, s29, s30
    s_add_u32 s19, s19, s20
    s_add_u32 s23, s23, s21
    v_mfma_f32_16x16x32_bf16 v[130:133], v[138:141], a[148:151], v[130:133]
    s_cmp_ge_u32 s19, 72
    v_cvt_pk_f16_f32 v122, v202, v203
    v_pk_fma_f16 v190, v122, v122, v190
    v_mfma_f32_16x16x32_bf16 v[130:133], v[186:189], a[152:155], v[130:133]
    s_cselect_b32 s34, 72, 0
    v_cvt_pk_f16_f32 v123, v204, v205
    v_pk_fma_f16 v192, v123, v123, v192
    v_mfma_f32_16x16x32_bf16 v[130:133], v[162:165], a[156:159], v[130:133]
    s_waitcnt lgkmcnt(2)
    buffer_store_dwordx2 v[198:199], v19, s[12:15], 0 offen nt
    s_cselect_b32 s35, s22, 0
    s_sub_u32 s19, s19, s34
    v_mfma_f32_16x16x32_f16 v[202:205], v[40:43], v[190:193], 0
    s_add_u32 s23, s23, s35
    s_add_u32 s18, s18, 1
    s_cmp_lt_u32 s18, s45
    v_mfma_f32_16x16x32_f16 v[214:217], v[166:169], v[158:161], v[24:27]
    s_waitcnt lgkmcnt(0)
    v_mfma_f32_16x16x32_f16 v[214:217], v[126:129], v[170:173], v[214:217]
    v_mfma_f32_16x16x32_f16 v[214:217], v[210:213], v[218:221], v[214:217]
    v_mfma_f32_16x16x32_f16 v[190:193], v[166:169], v[206:209], v[22:25]
    v_rsq_f32 v204, v202
    v_mfma_f32_16x16x32_f16 v[190:193], v[126:129], v[118:121], v[190:193]
    v_rsq_f32 v205, v203
    v_mfma_f32_16x16x32_f16 v[190:193], v[210:213], v[194:197], v[190:193]
    v_mul_f32 v204, s31, v204
    v_cvt_pk_f16_f32 v204, v204, v205
    v_mfma_f32_16x16x32_bf16 v[130:133], v[134:137], a[160:163], v[130:133]
    v_pk_mul_f16 v142, v142, v204 op_sel:[0,1] op_sel_hi:[1,1]
    v_pk_mul_f16 v143, v143, v204 op_sel:[0,1] op_sel_hi:[1,1]
    v_mfma_f32_16x16x32_bf16 v[130:133], v[154:157], a[164:167], v[130:133]
    v_pk_mul_f16 v144, v144, v204 op_sel:[0,1] op_sel_hi:[1,1]
    v_pk_mul_f16 v145, v145, v204 op_sel:[0,1] op_sel_hi:[1,1]
    v_mfma_f32_16x16x32_bf16 v[222:225], v[146:149], a[168:171], 0
    v_mov_b32_dpp v200, v191 quad_perm:[0,1,2,3] row_mask:0x1 bank_mask:0xf
    v_mov_b32_dpp v200, v215 quad_perm:[0,1,2,3] row_mask:0x2 bank_mask:0xf
    v_mfma_f32_16x16x32_bf16 v[222:225], v[138:141], a[172:175], v[222:225]
    v_pk_mul_f16 v124, v124, v204 op_sel:[0,1] op_sel_hi:[1,1]
    v_pk_mul_f16 v125, v125, v204 op_sel:[0,1] op_sel_hi:[1,1]
    v_mfma_f32_16x16x32_bf16 v[222:225], v[186:189], a[176:179], v[222:225]
    v_cvt_pk_bf16_f32 v130, v130, v131
    v_cvt_pk_bf16_f32 v131, v132, v133
    v_mfma_f32_16x16x32_bf16 v[222:225], v[162:165], a[180:183], v[222:225]
    v_pk_mul_f16 v178, v178, v204 op_sel:[0,0] op_sel_hi:[1,0]
    v_pk_mul_f16 v179, v179, v204 op_sel:[0,0] op_sel_hi:[1,0]
    v_mfma_f32_16x16x32_f16 v[226:229], v[118:121], v[206:209], v[46:49]
    v_pk_mul_f16 v180, v180, v204 op_sel:[0,0] op_sel_hi:[1,0]
    v_pk_mul_f16 v181, v181, v204 op_sel:[0,0] op_sel_hi:[1,0]
    v_mfma_f32_16x16x32_f16 v[230:233], v[170:173], v[206:209], v[50:53]
    v_pk_mul_f16 v122, v122, v204 op_sel:[0,0] op_sel_hi:[1,0]
    v_pk_mul_f16 v123, v123, v204 op_sel:[0,0] op_sel_hi:[1,0]
    v_mfma_f32_16x16x32_f16 v[234:237], v[142:145], v[206:209], v[54:57]
    v_min3_u32 v44, v44, v202, v203
    v_exp_f32 v214, v214
    v_mfma_f32_16x16x16_f16 v[226:229], v[196:197], v[194:195], v[226:229]
    v_max3_u32 v45, v45, v202, v203
    v_exp_f32 v190, v190
    v_mfma_f32_16x16x16_f16 v[230:233], v[220:221], v[194:195], v[230:233]
    v_cvt_pk_bf16_f32 v39, v190, 0
    v_mfma_f32_16x16x16_f16 v[234:237], v[124:125], v[194:195], v[234:237]
    buffer_store_dwordx4 v[150:153], v15, s[12:15], 0 offen nt
    v_mfma_f32_16x16x32_bf16 v[222:225], v[134:137], a[184:187], v[222:225]
    v_mfma_f32_16x16x32_bf16 v[222:225], v[154:157], a[188:191], v[222:225]
    ds_read_b128 v[206:209], v2 offset:0
    v_mfma_f32_16x16x32_bf16 v[150:153], v[146:149], a[192:195], 0
    ds_read_b128 v[146:149], v2 offset:1024
    v_mfma_f32_16x16x32_bf16 v[150:153], v[138:141], a[196:199], v[150:153]
    ds_read_b128 v[138:141], v2 offset:2048
    v_mfma_f32_16x16x32_bf16 v[150:153], v[186:189], a[200:203], v[150:153]
    ds_read_b128 v[186:189], v2 offset:3072
    v_mfma_f32_16x16x32_bf16 v[150:153], v[162:165], a[204:207], v[150:153]
    ds_read_b128 v[162:165], v2 offset:4096
    v_cvt_pk_bf16_f32 v222, v222, v223
    v_mfma_f32_16x16x32_bf16 v[150:153], v[134:137], a[208:211], v[150:153]
    ds_read_b128 v[134:137], v2 offset:5120
    v_cvt_pk_bf16_f32 v223, v224, v225
    v_mfma_f32_16x16x32_bf16 v[150:153], v[154:157], a[212:215], v[150:153]
    ds_read2_b32 v[132:133], v6 offset0:0 offset1:0
    ds_read2_b32 v[224:225], v6 offset0:16 offset1:16
    v_mfma_f32_16x16x32_f16 v[154:157], v[166:169], v[178:181], v[26:29]
    ds_read2_b32 v[168:169], v6 offset0:32 offset1:32
    v_add_u32 v6, 272, v6
    v_mfma_f32_16x16x32_f16 v[154:157], v[126:129], v[142:145], v[154:157]
    s_waitcnt lgkmcnt(8)
    v_exp_f32 v226, v226
    v_mfma_f32_16x16x32_f16 v[154:157], v[210:213], v[122:125], v[154:157]
    s_waitcnt lgkmcnt(7)
    v_cvt_pk_bf16_f32 v166, v150, v151
    v_cvt_pk_bf16_f32 v167, v152, v153
    v_mfma_f32_16x16x32_bf16 v[150:153], a[216:219], v[206:209], 0
    s_waitcnt lgkmcnt(6)
    v_exp_f32 v227, v227
    v_mfma_f32_16x16x32_bf16 v[150:153], a[220:223], v[146:149], v[150:153]
    s_waitcnt lgkmcnt(5)
    v_exp_f32 v154, v154
    v_mfma_f32_16x16x32_bf16 v[150:153], a[224:227], v[138:141], v[150:153]
    s_waitcnt lgkmcnt(4)
    v_mov_b32_dpp v200, v155 quad_perm:[0,1,2,3] row_mask:0x4 bank_mask:0xf
    v_cvt_pk_bf16_f32 v126, v226, v227
    v_mfma_f32_16x16x32_bf16 v[150:153], a[228:231], v[186:189], v[150:153]
    s_waitcnt lgkmcnt(3)
    v_exp_f32 v200, v200
    v_mfma_f32_16x16x32_bf16 v[150:153], a[232:235], v[162:165], v[150:153]
    s_waitcnt lgkmcnt(1)
    v_exp_f32 v228, v228
    v_mfma_f32_16x16x32_bf16 v[150:153], a[236:239], v[134:137], v[150:153]
    s_waitcnt lgkmcnt(0)
    buffer_store_dwordx2 v[254:255], v18, s[12:15], 0 offen nt
    v_exp_f32 v229, v229
    v_mfma_f32_16x16x32_bf16 v[190:193], a[240:243], v[206:209], 0
    v_cvt_pk_bf16_f32 v200, v200, v200
    v_cvt_pk_bf16_f32 v127, v228, v229
    v_mfma_f32_16x16x32_bf16 v[190:193], a[244:247], v[146:149], v[190:193]
    ds_write_b16 v8, v200
    v_mfma_f32_16x16x32_bf16 v[190:193], a[248:251], v[138:141], v[190:193]
    v_exp_f32 v230, v230
    v_mfma_f32_16x16x32_bf16 v[190:193], a[252:255], v[186:189], v[190:193]
    ds_read_b128 v[198:201], v2 offset:6144
    ds_read_b128 v[210:213], v9
    v_mfma_f32_16x16x32_bf16 v[190:193], v[82:85], v[162:165], v[190:193]
    ds_read_b128 v[226:229], v2 offset:7168
    ds_read_b128 v[238:241], v9 offset:64
    v_mfma_f32_16x16x32_bf16 v[190:193], v[86:89], v[134:137], v[190:193]
    v_exp_f32 v231, v231
    v_mfma_f32_16x16x32_bf16 v[202:205], v[90:93], v[206:209], 0
    ds_read_b128 v[206:209], v2 offset:8192
    ds_read_b128 v[242:245], v2 offset:9216
    v_mfma_f32_16x16x32_bf16 v[202:205], v[94:97], v[146:149], v[202:205]
    v_cvt_pk_bf16_f32 v128, v230, v231
    v_fma_f32 v254, v150, v150, s33
    v_mfma_f32_16x16x32_bf16 v[202:205], v[98:101], v[138:141], v[202:205]
    ds_read_b128 v[146:149], v2 offset:10240
    ds_read_b128 v[138:141], v2 offset:11264
    v_mfma_f32_16x16x32_bf16 v[202:205], v[102:105], v[186:189], v[202:205]
    v_exp_f32 v232, v232
    v_mfma_f32_16x16x32_bf16 v[202:205], v[106:109], v[162:165], v[202:205]
    v_exp_f32 v233, v233
    v_mfma_f32_16x16x32_bf16 v[202:205], v[110:113], v[134:137], v[202:205]
    s_waitcnt lgkmcnt(6)
    v_cvt_pk_bf16_f32 v129, v232, v233
    v_fmac_f32 v254, v151, v151
    v_mfma_f32_16x16x32_bf16 v[186:189], v[210:213], v[28:31], 0
    s_waitcnt lgkmcnt(4)
    v_exp_f32 v234, v234
    v_mfma_f32_16x16x32_bf16 v[186:189], v[238:241], v[28:31], v[186:189]
    v_exp_f32 v235, v235
    v_mfma_f32_16x16x32_f16 v[134:137], v[118:121], v[158:161], v[58:61]
    s_waitcnt lgkmcnt(2)
    v_cvt_pk_bf16_f32 v36, v234, v235
    v_fmac_f32 v254, v152, v152
    v_mfma_f32_16x16x32_f16 v[162:165], v[170:173], v[158:161], v[62:65]
    v_exp_f32 v236, v236
    v_mfma_f32_16x16x32_f16 v[230:233], v[142:145], v[158:161], v[66:69]
    s_waitcnt lgkmcnt(0)
    buffer_load_dwordx4 v14, s[8:11], 0 offen nt lds
    v_rcp_f32 v186, v186
    v_mfma_f32_16x16x16_f16 v[134:137], v[196:197], v[218:219], v[134:137]
    v_exp_f32 v237, v237
    v_fmac_f32 v254, v153, v153
    v_mfma_f32_16x16x16_f16 v[162:165], v[220:221], v[218:219], v[162:165]
    v_cvt_pk_bf16_f32 v37, v236, v237
    v_fmac_f32 v254, v190, v190
    v_fmac_f32 v254, v191, v191
    v_mfma_f32_16x16x16_f16 v[230:233], v[124:125], v[218:219], v[230:233]
    v_fmac_f32 v254, v192, v192
    v_exp_f32 v134, v134
    v_fmac_f32 v254, v193, v193
    v_mfma_f32_16x16x32_bf16 v[158:161], v[210:213], v[174:177], 0
    v_exp_f32 v135, v135
    v_mfma_f32_16x16x32_bf16 v[158:161], v[238:241], v[130:133], v[158:161]
    v_cvt_pk_bf16_f32 v134, v134, v135
    v_fmac_f32 v254, v202, v202
    v_mfma_f32_16x16x32_bf16 v[234:237], v[210:213], v[182:185], 0
    v_exp_f32 v136, v136
    v_mfma_f32_16x16x32_bf16 v[234:237], v[238:241], v[222:225], v[234:237]
    v_exp_f32 v137, v137
    v_mfma_f32_16x16x32_bf16 v[246:249], v[210:213], v[114:117], 0
    v_cvt_pk_bf16_f32 v135, v136, v137
    v_mul_f32 v158, v158, v186
    v_mfma_f32_16x16x32_bf16 v[246:249], v[238:241], v[166:169], v[246:249]
    v_exp_f32 v162, v162
    v_mfma_f32_16x16x32_bf16 v[210:213], v[28:31], v[36:39], 0
    v_exp_f32 v163, v163
    v_mfma_f32_16x16x32_bf16 v[210:213], v[28:31], v[126:129], v[210:213]
    v_cvt_pk_bf16_f32 v136, v162, v163
    v_mul_f32_dpp v158, v234, v186 quad_perm:[0,1,2,3] row_mask:0x2 bank_mask:0xf
    v_mfma_f32_16x16x32_bf16 v[234:237], v[130:133], v[36:39], 0
    v_exp_f32 v164, v164
    v_mfma_f32_16x16x32_bf16 v[234:237], v[174:177], v[126:129], v[234:237]
    v_exp_f32 v165, v165
    v_mfma_f32_16x16x32_bf16 v[238:241], v[222:225], v[36:39], 0
    v_cvt_pk_bf16_f32 v137, v164, v165
    v_mul_f32_dpp v158, v246, v186 quad_perm:[0,1,2,3] row_mask:0x4 bank_mask:0xf
    v_mfma_f32_16x16x32_bf16 v[238:241], v[182:185], v[126:129], v[238:241]
    v_exp_f32 v230, v230
    v_mfma_f32_16x16x32_bf16 v[186:189], v[166:169], v[36:39], 0
    v_exp_f32 v231, v231
    v_mfma_f32_16x16x32_bf16 v[186:189], v[114:117], v[126:129], v[186:189]
    v_cvt_pk_bf16_f32 v36, v230, v231
    v_cvt_pk_bf16_f32 v39, v214, 0
    v_mfma_f32_16x16x32_f16 v[162:165], v[118:121], v[178:181], v[70:73]
    v_exp_f32 v232, v232
    v_mfma_f32_16x16x32_f16 v[118:121], v[170:173], v[178:181], v[74:77]
    v_exp_f32 v233, v233
    v_mfma_f32_16x16x32_f16 v[170:173], v[142:145], v[178:181], v[78:81]
    v_cvt_pk_bf16_f32 v37, v232, v233
    v_cvt_pk_bf16_f32 v158, v158, v158
    v_fmac_f32 v254, v203, v203
    v_mfma_f32_16x16x16_f16 v[162:165], v[196:197], v[122:123], v[162:165]
    v_rcp_f32 v210, v210
    v_fmac_f32 v254, v204, v204
    v_mfma_f32_16x16x16_f16 v[118:121], v[220:221], v[122:123], v[118:121]
    v_mul_f32 v234, v210, v234
    v_mul_f32 v235, v210, v235
    v_cvt_pk_bf16_f32 v178, v234, v235
    v_mfma_f32_16x16x16_f16 v[170:173], v[124:125], v[122:123], v[170:173]
    v_mul_f32 v236, v210, v236
    v_exp_f32 v162, v162
    v_mul_f32 v237, v210, v237
    v_mfma_f32_16x16x32_bf16 v[194:197], v[28:31], v[36:39], 0
    ds_write_b16 v7, v158
    v_mfma_f32_16x16x32_bf16 v[194:197], v[28:31], v[134:137], v[194:197]
    v_exp_f32 v163, v163
    v_mfma_f32_16x16x32_bf16 v[122:125], v[130:133], v[36:39], 0
    v_cvt_pk_bf16_f32 v162, v162, v163
    v_cvt_pk_bf16_f32 v179, v236, v237
    v_mfma_f32_16x16x32_bf16 v[122:125], v[174:177], v[134:137], v[122:125]
    v_exp_f32 v164, v164
    v_mfma_f32_16x16x32_bf16 v[126:129], v[222:225], v[36:39], 0
    v_exp_f32 v165, v165
    v_mfma_f32_16x16x32_bf16 v[126:129], v[182:185], v[134:137], v[126:129]
    v_cvt_pk_bf16_f32 v163, v164, v165
    v_mul_f32 v238, v210, v238
    v_mfma_f32_16x16x32_bf16 v[218:221], v[166:169], v[36:39], 0
    v_exp_f32 v118, v118
    v_mfma_f32_16x16x32_bf16 v[218:221], v[114:117], v[134:137], v[218:221]
    v_exp_f32 v119, v119
    v_mfma_f32_16x16x32_bf16 v[142:145], a[216:219], v[198:201], 0
    v_cvt_pk_bf16_f32 v164, v118, v119
    v_cvt_pk_bf16_f32 v39, v154, 0
    v_mfma_f32_16x16x32_bf16 v[142:145], a[220:223], v[226:229], v[142:145]
    v_exp_f32 v120, v120
    v_mfma_f32_16x16x32_bf16 v[142:145], a[224:227], v[206:209], v[142:145]
    v_exp_f32 v121, v121
    v_mfma_f32_16x16x32_bf16 v[142:145], a[228:231], v[242:245], v[142:145]
    v_cvt_pk_bf16_f32 v165, v120, v121
    v_mul_f32 v239, v210, v239
    v_mfma_f32_16x16x32_bf16 v[142:145], a[232:235], v[146:149], v[142:145]
    v_exp_f32 v170, v170
    v_mfma_f32_16x16x32_bf16 v[142:145], a[236:239], v[138:141], v[142:145]
    v_exp_f32 v171, v171
    v_mfma_f32_16x16x32_bf16 v[158:161], a[240:243], v[198:201], 0
    v_cvt_pk_bf16_f32 v36, v170, v171
    v_cvt_pk_bf16_f32 v180, v238, v239
    v_mfma_f32_16x16x32_bf16 v[158:161], a[244:247], v[226:229], v[158:161]
    v_exp_f32 v172, v172
    v_mfma_f32_16x16x32_bf16 v[158:161], a[248:251], v[206:209], v[158:161]
    v_exp_f32 v173, v173
    v_mfma_f32_16x16x32_bf16 v[158:161], a[252:255], v[242:245], v[158:161]
    ds_read_b128 v[118:121], v2 offset:12288
    v_cvt_pk_bf16_f32 v37, v172, v173
    v_mfma_f32_16x16x32_bf16 v[158:161], v[82:85], v[146:149], v[158:161]
    ds_read_b128 v[134:137], v2 offset:13312
    v_mul_f32 v240, v210, v240
    v_mfma_f32_16x16x32_bf16 v[170:173], v[28:31], v[36:39], 0
    v_mul_f32 v241, v210, v241
    v_cvt_pk_bf16_f32 v181, v240, v241
    v_mfma_f32_16x16x32_bf16 v[170:173], v[28:31], v[162:165], v[170:173]
    ds_write_b128 v3, v[178:181] offset:0
    v_mfma_f32_16x16x32_bf16 v[154:157], v[130:133], v[36:39], 0
    v_mul_f32 v186, v210, v186
    v_mul_f32 v187, v210, v187
    v_mfma_f32_16x16x32_bf16 v[154:157], v[174:177], v[162:165], v[154:157]
    v_cvt_pk_bf16_f32 v186, v186, v187
    v_mul_f32 v188, v210, v188
    v_mfma_f32_16x16x32_bf16 v[130:133], v[222:225], v[36:39], 0
    v_mul_f32 v189, v210, v189
    v_cvt_pk_bf16_f32 v187, v188, v189
    v_mfma_f32_16x16x32_bf16 v[130:133], v[182:185], v[162:165], v[130:133]
    s_waitcnt lgkmcnt(2)
    ds_write_b64 v4, v[186:187] offset:4096
    v_mfma_f32_16x16x32_bf16 v[174:177], v[166:169], v[36:39], 0
    s_waitcnt lgkmcnt(2)
    v_fma_f32 v255, v142, v142, s33
    v_fmac_f32 v255, v143, v143
    v_mfma_f32_16x16x32_bf16 v[174:177], v[114:117], v[162:165], v[174:177]
    v_fmac_f32 v255, v144, v144
    v_fmac_f32 v255, v145, v145
    v_mfma_f32_16x16x32_bf16 v[158:161], v[86:89], v[138:141], v[158:161]
    ds_read_b128 v[114:117], v2 offset:14336
    v_fmac_f32 v254, v205, v205
    v_mfma_f32_16x16x32_bf16 v[178:181], v[90:93], v[198:201], 0
    ds_read_b128 v[166:169], v2 offset:15360
    v_add_u32 v7, 16, v7
    v_mfma_f32_16x16x32_bf16 v[178:181], v[94:97], v[226:229], v[178:181]
    ds_read_b128 v[162:165], v2 offset:16384
    v_mfma_f32_16x16x32_bf16 v[178:181], v[98:101], v[206:209], v[178:181]
    ds_read_b128 v[206:209], v2 offset:17408
    v_fmac_f32 v255, v158, v158
    v_mfma_f32_16x16x32_bf16 v[178:181], v[102:105], v[242:245], v[178:181]
    v_fmac_f32 v255, v159, v159
    v_fmac_f32 v255, v160, v160
    v_mfma_f32_16x16x32_bf16 v[178:181], v[106:109], v[146:149], v[178:181]
    v_fmac_f32 v255, v161, v161
    v_xor_b32 v2, 65536, v2
    v_mfma_f32_16x16x32_bf16 v[178:181], v[110:113], v[138:141], v[178:181]
    v_rcp_f32 v170, v170
    v_mfma_f32_16x16x32_bf16 v[146:149], a[216:219], v[118:121], 0
    v_mul_f32 v154, v170, v154
    v_mul_f32 v155, v170, v155
    v_mfma_f32_16x16x32_bf16 v[146:149], a[220:223], v[134:137], v[146:149]
    s_waitcnt lgkmcnt(3)
    ds_read_b128 v[182:185], v0 offset:20480
    v_cvt_pk_bf16_f32 v154, v154, v155
    v_mfma_f32_16x16x32_bf16 v[146:149], a[224:227], v[114:117], v[146:149]
    s_waitcnt lgkmcnt(3)
    ds_read_b128 v[198:201], v1 offset:20480
    v_fmac_f32 v255, v178, v178
    v_mfma_f32_16x16x32_bf16 v[146:149], a[228:231], v[166:169], v[146:149]
    s_waitcnt lgkmcnt(3)
    ds_read_b128 v[210:213], v0 offset:20608
    v_fmac_f32 v255, v179, v179
    v_mfma_f32_16x16x32_bf16 v[146:149], a[232:235], v[162:165], v[146:149]
    s_waitcnt lgkmcnt(3)
    ds_read_b128 v[222:225], v1 offset:20608
    v_fmac_f32 v255, v180, v180
    v_mfma_f32_16x16x32_bf16 v[146:149], a[236:239], v[206:209], v[146:149]
    ds_read_b128 v[226:229], v0 offset:20736
    v_fmac_f32 v255, v181, v181
    v_mfma_f32_16x16x32_bf16 v[138:141], a[240:243], v[118:121], 0
    ds_read_b128 v[242:245], v1 offset:20736
    v_cvt_pk_bf16_f32 v254, v254, v255
    v_mfma_f32_16x16x32_bf16 v[138:141], a[244:247], v[134:137], v[138:141]
    v_mul_f32 v156, v170, v156
    v_mul_f32 v157, v170, v157
    v_mfma_f32_16x16x32_bf16 v[138:141], a[248:251], v[114:117], v[138:141]
    v_fma_f32 v255, v146, v146, s33
    v_fmac_f32 v255, v147, v147
    v_mfma_f32_16x16x32_bf16 v[138:141], a[252:255], v[166:169], v[138:141]
    s_waitcnt lgkmcnt(5)
    v_fmac_f32 v255, v148, v148
    v_fmac_f32 v255, v149, v149
    v_mfma_f32_16x16x32_bf16 v[138:141], v[82:85], v[162:165], v[138:141]
    s_waitcnt lgkmcnt(4)
    v_cvt_pk_bf16_f32 v155, v156, v157
    v_mul_f32 v130, v170, v130
    v_mfma_f32_16x16x32_bf16 v[138:141], v[86:89], v[206:209], v[138:141]
    s_waitcnt lgkmcnt(3)
    v_mul_f32 v131, v170, v131
    v_cvt_pk_bf16_f32 v156, v130, v131
    v_mfma_f32_16x16x32_bf16 v[186:189], v[90:93], v[118:121], 0
    s_waitcnt lgkmcnt(2)
    v_mul_f32 v132, v170, v132
    v_mul_f32 v133, v170, v133
    v_mfma_f32_16x16x32_bf16 v[186:189], v[94:97], v[134:137], v[186:189]
    s_waitcnt lgkmcnt(1)
    v_fmac_f32 v255, v138, v138
    v_fmac_f32 v255, v139, v139
    v_mfma_f32_16x16x32_bf16 v[186:189], v[98:101], v[114:117], v[186:189]
    s_waitcnt lgkmcnt(0)
    v_fmac_f32 v255, v140, v140
    v_fmac_f32 v255, v141, v141
    v_mfma_f32_16x16x32_bf16 v[186:189], v[102:105], v[166:169], v[186:189]
    v_cvt_pk_bf16_f32 v157, v132, v133
    v_mul_f32 v174, v170, v174
    v_mfma_f32_16x16x32_bf16 v[186:189], v[106:109], v[162:165], v[186:189]
    ds_write_b128 v3, v[154:157] offset:12288
    v_mfma_f32_16x16x32_bf16 v[186:189], v[110:113], v[206:209], v[186:189]
    v_mul_f32 v175, v170, v175
    v_cvt_pk_bf16_f32 v174, v174, v175
    v_mfma_f32_16x16x32_bf16 v[118:121], a[72:75], v[182:185], 0
    v_mul_f32 v176, v170, v176
    v_mul_f32 v177, v170, v177
    v_mfma_f32_16x16x32_bf16 v[118:121], a[76:79], v[198:201], v[118:121]
    v_rcp_f32 v194, v194
    v_mfma_f32_16x16x32_bf16 v[118:121], a[80:83], v[210:213], v[118:121]
    v_fmac_f32 v255, v186, v186
    v_fmac_f32 v255, v187, v187
    v_mfma_f32_16x16x32_bf16 v[118:121], a[84:87], v[222:225], v[118:121]
    v_fmac_f32 v255, v188, v188
    v_fmac_f32 v255, v189, v189
    v_mfma_f32_16x16x32_bf16 v[118:121], a[88:91], v[226:229], v[118:121]
    v_cvt_pk_bf16_f32 v255, v255, v255
    v_cvt_pk_bf16_f32 v175, v176, v177
    v_mfma_f32_16x16x32_bf16 v[118:121], a[92:95], v[242:245], v[118:121]
    ds_write_b64 v4, v[174:175] offset:16384
    v_mfma_f32_16x16x32_bf16 v[206:209], a[96:99], v[182:185], 0
    v_mul_f32 v122, v194, v122
    v_mul_f32 v123, v194, v123
    v_mfma_f32_16x16x32_bf16 v[206:209], a[100:103], v[198:201], v[206:209]
    ds_write_b64 v4, v[254:255] offset:18432
    v_mfma_f32_16x16x32_bf16 v[206:209], a[104:107], v[210:213], v[206:209]
    v_cvt_pk_bf16_f32 v134, v122, v123
    v_cvt_pk_f16_f32 v118, v118, v119
    v_mfma_f32_16x16x32_bf16 v[206:209], a[108:111], v[222:225], v[206:209]
    v_pk_mul_f16 v163, v118, v118
    v_cvt_pk_f16_f32 v119, v120, v121
    v_mfma_f32_16x16x32_bf16 v[206:209], a[112:115], v[226:229], v[206:209]
    v_pk_mul_f16 v165, v119, v119
    v_mul_f32 v124, v194, v124
    v_mfma_f32_16x16x32_bf16 v[206:209], a[116:119], v[242:245], v[206:209]
    v_mul_f32 v125, v194, v125
    v_cvt_pk_bf16_f32 v135, v124, v125
    v_mfma_f32_16x16x32_bf16 v[122:125], a[120:123], v[182:185], 0
    v_mul_f32 v126, v194, v126
    v_mul_f32 v127, v194, v127
    v_mfma_f32_16x16x32_bf16 v[122:125], a[124:127], v[198:201], v[122:125]
    v_cvt_pk_bf16_f32 v136, v126, v127
    v_mul_f32 v128, v194, v128
    v_mfma_f32_16x16x32_bf16 v[122:125], a[128:131], v[210:213], v[122:125]
    v_cvt_pk_f16_f32 v120, v206, v207
    v_pk_fma_f16 v163, v120, v120, v163
    v_mfma_f32_16x16x32_bf16 v[122:125], a[132:135], v[222:225], v[122:125]
    v_cvt_pk_f16_f32 v121, v208, v209
    v_pk_fma_f16 v165, v121, v121, v165
    v_mfma_f32_16x16x32_bf16 v[122:125], a[136:139], v[226:229], v[122:125]
    v_mul_f32 v129, v194, v129
    v_cvt_pk_bf16_f32 v137, v128, v129
    v_mfma_f32_16x16x32_bf16 v[122:125], a[140:143], v[242:245], v[122:125]
    ds_write_b128 v3, v[134:137] offset:6144
    v_mfma_f32_16x16x32_bf16 v[206:209], a[0:3], v[182:185], 0
    v_mul_f32 v218, v194, v218
    v_mul_f32 v219, v194, v219
    v_mfma_f32_16x16x32_bf16 v[206:209], a[4:7], v[198:201], v[206:209]
    v_cvt_pk_bf16_f32 v254, v218, v219
    v_mul_f32 v220, v194, v220
    v_mfma_f32_16x16x32_bf16 v[206:209], a[8:11], v[210:213], v[206:209]
    v_cvt_pk_f16_f32 v196, v122, v123
    v_pk_fma_f16 v163, v196, v196, v163
    v_mfma_f32_16x16x32_bf16 v[206:209], a[12:15], v[222:225], v[206:209]
    v_cvt_pk_f16_f32 v197, v124, v125
    v_pk_fma_f16 v165, v197, v197, v165
    v_mfma_f32_16x16x32_bf16 v[206:209], a[16:19], v[226:229], v[206:209]
    v_mul_f32 v221, v194, v221
    v_cvt_pk_bf16_f32 v255, v220, v221
    v_mfma_f32_16x16x32_bf16 v[206:209], a[20:23], v[242:245], v[206:209]
    ds_write_b64 v4, v[254:255] offset:10240
    v_mfma_f32_16x16x32_bf16 v[174:177], a[24:27], v[182:185], 0
    v_xor_b32 v3, 65536, v3
    v_xor_b32 v4, 65536, v4
    v_mfma_f32_16x16x32_bf16 v[174:177], a[28:31], v[198:201], v[174:177]
    v_mfma_f32_16x16x32_bf16 v[174:177], a[32:35], v[210:213], v[174:177]
    v_mfma_f32_16x16x32_bf16 v[174:177], a[36:39], v[222:225], v[174:177]
    v_mfma_f32_16x16x32_bf16 v[174:177], a[40:43], v[226:229], v[174:177]
    v_cvt_pk_f16_f32 v206, v206, v207
    v_mfma_f32_16x16x32_bf16 v[174:177], a[44:47], v[242:245], v[174:177]
    v_mfma_f32_16x16x32_bf16 v[218:221], a[48:51], v[182:185], 0
    s_waitcnt lgkmcnt(0)
    v_mfma_f32_16x16x32_bf16 v[218:221], a[52:55], v[198:201], v[218:221]
    s_nop 0
    v_mfma_f32_16x16x32_bf16 v[218:221], a[56:59], v[210:213], v[218:221]
    s_nop 0
    v_mfma_f32_16x16x32_bf16 v[218:221], a[60:63], v[222:225], v[218:221]
    s_nop 0
    v_mfma_f32_16x16x32_bf16 v[218:221], a[64:67], v[226:229], v[218:221]
    s_barrier
    v_mfma_f32_16x16x32_bf16 v[218:221], a[68:71], v[242:245], v[218:221]
    v_mfma_f32_16x16x32_bf16 v[170:173], v[182:185], a[144:147], 0
    v_mfma_f32_16x16x32_bf16 v[170:173], v[198:201], a[148:151], v[170:173]
    v_mfma_f32_16x16x32_bf16 v[170:173], v[210:213], a[152:155], v[170:173]
    v_mfma_f32_16x16x32_bf16 v[170:173], v[222:225], a[156:159], v[170:173]
    v_mfma_f32_16x16x32_bf16 v[170:173], v[226:229], a[160:163], v[170:173]
    v_mfma_f32_16x16x32_bf16 v[170:173], v[242:245], a[164:167], v[170:173]
    s_cbranch_scc1 L_loop_fast3
L_final_fast:
    v_mfma_f32_16x16x32_bf16 v[114:117], v[182:185], a[168:171], 0
    s_mov_b32 s12, s42
    ds_read_b128 v[122:125], v2 offset:18432
    ds_read_b128 v[126:129], v2 offset:19456
    v_mfma_f32_16x16x32_bf16 v[114:117], v[198:201], a[172:175], v[114:117]
    s_mov_b32 s13, s43
    ds_read_b128 v[130:133], v0 offset:26624
    ds_read_b128 v[134:137], v1 offset:26624
    v_mfma_f32_16x16x32_bf16 v[114:117], v[210:213], a[176:179], v[114:117]
    s_mov_b32 s14, s36
    v_bfe_u32 v254, v2, 4, 6
    v_lshrrev_b32 v255, 4, v254
    v_mfma_f32_16x16x32_bf16 v[114:117], v[222:225], a[180:183], v[114:117]
    s_add_u32 s48, s42, s27
    ds_read_b128 v[154:157], v0 offset:26752
    ds_read_b128 v[166:169], v1 offset:26752
    v_mfma_f32_16x16x32_bf16 v[114:117], v[226:229], a[184:187], v[114:117]
    s_addc_u32 s49, s43, 0
    v_and_b32 v214, 15, v254
    v_lshlrev_b32 v215, 9, v255
    v_mfma_f32_16x16x32_bf16 v[114:117], v[242:245], a[188:191], v[114:117]
    s_sub_u32 s50, s36, s27
    ds_read_b128 v[230:233], v0 offset:26880
    ds_read_b128 v[234:237], v1 offset:26880
    v_mfma_f32_16x16x32_bf16 v[238:241], v[182:185], a[192:195], 0
    s_mov_b32 s51, 0x00020000
    v_lshl_add_u32 v215, v214, 4, v215
    v_add_u32 v215, 136704, v215
    v_mfma_f32_16x16x32_bf16 v[238:241], v[198:201], a[196:199], v[238:241]
    s_add_u32 s52, s42, s26
    ds_read_b128 v[182:185], v2 offset:0
    ds_read_b128 v[198:201], v2 offset:1024
    v_mfma_f32_16x16x32_bf16 v[238:241], v[210:213], a[200:203], v[238:241]
    s_waitcnt lgkmcnt(8)
    v_and_b32 v216, 0xffff, v2
    v_add_u32 v216, 148992, v216
    v_mfma_f32_16x16x32_bf16 v[210:213], v[32:35], v[122:125], 0
    s_waitcnt lgkmcnt(6)
    ds_read_b128 v[122:125], v2 offset:2048
    v_and_b32 v217, 0xffff, v4
    v_mfma_f32_16x16x32_bf16 v[210:213], v[32:35], v[126:129], v[210:213]
    s_addc_u32 s53, s43, 0
    ds_read_b128 v[126:129], v2 offset:3072
    v_add_u32 v217, 148992, v217
    v_mfma_f32_16x16x32_bf16 v[238:241], v[222:225], a[204:207], v[238:241]
    s_sub_u32 s54, s36, s26
    ds_read_b128 v[222:225], v2 offset:4096
    v_pk_mul_f16 v162, v206, v206
    v_mfma_f32_16x16x32_bf16 v[238:241], v[226:229], a[208:211], v[238:241]
    s_mov_b32 s55, 0x00020000
    v_mul_f32 v164, 0x3baaaaab, v211
    v_mul_f32 v207, 0x3baaaaab, v212
    v_mfma_f32_16x16x32_bf16 v[238:241], v[242:245], a[212:215], v[238:241]
    s_add_u32 s56, s42, s25
    ds_read_b128 v[226:229], v2 offset:5120
    s_addc_u32 s57, s43, 0
    s_sub_u32 s58, s36, s25
    s_mov_b32 s59, 0x00020000
    v_rsq_f32 v164, v164
    v_rsq_f32 v207, v207
    v_mul_f32 v142, v164, v142
    v_mul_f32 v143, v164, v143
    v_cvt_pk_bf16_f32 v142, v142, v143
    v_mfma_f32_16x16x32_bf16 v[242:245], a[72:75], v[130:133], 0
    s_lshl_b32 s3, s16, 6
    v_mul_f32 v144, v164, v144
    v_mul_f32 v145, v164, v145
    v_mfma_f32_16x16x32_bf16 v[242:245], a[76:79], v[134:137], v[242:245]
    s_waitcnt lgkmcnt(2)
    v_cvt_pk_bf16_f32 v143, v144, v145
    v_mul_f32 v158, v164, v158
    v_mfma_f32_16x16x32_bf16 v[242:245], a[80:83], v[154:157], v[242:245]
    s_lshl_b32 s4, s16, 5
    v_mul_f32 v159, v164, v159
    v_cvt_pk_bf16_f32 v144, v158, v159
    v_mfma_f32_16x16x32_bf16 v[242:245], a[84:87], v[166:169], v[242:245]
    s_add_u32 s4, s4, 256
    v_mul_f32 v160, v164, v160
    v_mul_f32 v161, v164, v161
    v_mfma_f32_16x16x32_bf16 v[242:245], a[88:91], v[230:233], v[242:245]
    s_mul_i32 s5, s16, 8064
    v_cvt_pk_bf16_f32 v145, v160, v161
    v_mul_f32 v178, v164, v178
    v_mfma_f32_16x16x32_bf16 v[242:245], a[92:95], v[234:237], v[242:245]
    s_add_u32 s5, s5, 104448
    buffer_store_dwordx4 v[142:145], v16, s[48:51], 0 offen nt
    v_mul_f32 v179, v164, v179
    v_cvt_pk_bf16_f32 v194, v178, v179
    v_mul_f32 v180, v164, v180
    v_mul_f32 v181, v164, v181
    v_mfma_f32_16x16x32_bf16 v[142:145], a[216:219], v[182:185], 0
    s_waitcnt lgkmcnt(0)
    v_cvt_pk_bf16_f32 v195, v180, v181
    v_mul_f32 v146, v207, v146
    v_mfma_f32_16x16x32_bf16 v[142:145], a[220:223], v[198:201], v[142:145]
    v_mul_f32 v147, v207, v147
    v_cvt_pk_bf16_f32 v146, v146, v147
    v_mfma_f32_16x16x32_bf16 v[142:145], a[224:227], v[122:125], v[142:145]
    v_mul_f32 v148, v207, v148
    v_mul_f32 v149, v207, v149
    v_mfma_f32_16x16x32_bf16 v[142:145], a[228:231], v[126:129], v[142:145]
    v_cvt_pk_bf16_f32 v147, v148, v149
    v_mul_f32 v138, v207, v138
    v_mfma_f32_16x16x32_bf16 v[142:145], a[232:235], v[222:225], v[142:145]
    v_mul_f32 v139, v207, v139
    v_cvt_pk_bf16_f32 v148, v138, v139
    v_mfma_f32_16x16x32_bf16 v[142:145], a[236:239], v[226:229], v[142:145]
    v_mul_f32 v140, v207, v140
    v_mul_f32 v141, v207, v141
    v_mfma_f32_16x16x32_bf16 v[158:161], a[240:243], v[182:185], 0
    v_cvt_pk_bf16_f32 v149, v140, v141
    v_mul_f32 v186, v207, v186
    v_mfma_f32_16x16x32_bf16 v[158:161], a[244:247], v[198:201], v[158:161]
    v_mul_f32 v187, v207, v187
    v_cvt_pk_bf16_f32 v186, v186, v187
    v_mfma_f32_16x16x32_bf16 v[158:161], a[248:251], v[122:125], v[158:161]
    v_mul_f32 v188, v207, v188
    v_mul_f32 v189, v207, v189
    v_mfma_f32_16x16x32_bf16 v[158:161], a[252:255], v[126:129], v[158:161]
    v_cvt_pk_bf16_f32 v187, v188, v189
    v_mul_f32 v164, 0x3baaaaab, v210
    v_mfma_f32_16x16x32_bf16 v[158:161], v[82:85], v[222:225], v[158:161]
    v_rsq_f32 v164, v164
    v_mfma_f32_16x16x32_bf16 v[158:161], v[86:89], v[226:229], v[158:161]
    v_mul_f32 v150, v164, v150
    v_mul_f32 v151, v164, v151
    v_mfma_f32_16x16x32_bf16 v[138:141], v[90:93], v[182:185], 0
    ds_read_b128 v[178:181], v2 offset:6144
    v_cvt_pk_bf16_f32 v150, v150, v151
    v_mfma_f32_16x16x32_bf16 v[138:141], v[94:97], v[198:201], v[138:141]
    ds_read_b128 v[182:185], v2 offset:7168
    v_mul_f32 v152, v164, v152
    v_mfma_f32_16x16x32_bf16 v[138:141], v[98:101], v[122:125], v[138:141]
    ds_read_b128 v[122:125], v2 offset:8192
    buffer_store_dwordx2 v[194:195], v19, s[48:51], 0 offen nt
    v_mul_f32 v153, v164, v153
    v_cvt_pk_bf16_f32 v151, v152, v153
    v_mfma_f32_16x16x32_bf16 v[138:141], v[102:105], v[126:129], v[138:141]
    ds_read_b128 v[126:129], v2 offset:9216
    v_mul_f32 v190, v164, v190
    v_mfma_f32_16x16x32_bf16 v[138:141], v[106:109], v[222:225], v[138:141]
    ds_read_b128 v[198:201], v2 offset:10240
    v_mul_f32 v191, v164, v191
    v_mfma_f32_16x16x32_bf16 v[138:141], v[110:113], v[226:229], v[138:141]
    ds_read_b128 v[210:213], v2 offset:11264
    v_cvt_pk_bf16_f32 v152, v190, v191
    v_mfma_f32_16x16x32_bf16 v[222:225], a[96:99], v[130:133], 0
    v_mul_f32 v192, v164, v192
    v_mul_f32 v193, v164, v193
    v_mfma_f32_16x16x32_bf16 v[222:225], a[100:103], v[134:137], v[222:225]
    s_waitcnt lgkmcnt(5)
    v_cvt_pk_bf16_f32 v153, v192, v193
    v_mul_f32 v202, v164, v202
    v_mfma_f32_16x16x32_bf16 v[190:193], a[216:219], v[178:181], 0
    s_waitcnt lgkmcnt(4)
    v_mul_f32 v203, v164, v203
    v_cvt_pk_bf16_f32 v188, v202, v203
    v_mfma_f32_16x16x32_bf16 v[190:193], a[220:223], v[182:185], v[190:193]
    s_waitcnt lgkmcnt(3)
    v_mul_f32 v204, v164, v204
    v_mul_f32 v205, v164, v205
    v_mfma_f32_16x16x32_bf16 v[190:193], a[224:227], v[122:125], v[190:193]
    v_cvt_pk_bf16_f32 v189, v204, v205
    v_fma_f32 v202, v142, v142, s33
    v_mfma_f32_16x16x32_bf16 v[226:229], a[240:243], v[178:181], 0
    s_waitcnt lgkmcnt(2)
    v_fmac_f32 v202, v143, v143
    v_fmac_f32 v202, v144, v144
    v_mfma_f32_16x16x32_bf16 v[190:193], a[228:231], v[126:129], v[190:193]
    s_waitcnt lgkmcnt(1)
    v_fmac_f32 v202, v145, v145
    v_fmac_f32 v202, v158, v158
    v_mfma_f32_16x16x32_bf16 v[190:193], a[232:235], v[198:201], v[190:193]
    s_waitcnt lgkmcnt(0)
    v_fmac_f32 v202, v159, v159
    v_fmac_f32 v202, v160, v160
    v_mfma_f32_16x16x32_bf16 v[190:193], a[236:239], v[210:213], v[190:193]
    v_fmac_f32 v202, v161, v161
    v_fmac_f32 v202, v138, v138
    v_mfma_f32_16x16x32_bf16 v[226:229], a[244:247], v[182:185], v[226:229]
    v_fmac_f32 v202, v139, v139
    v_fmac_f32 v202, v140, v140
    v_mfma_f32_16x16x32_bf16 v[226:229], a[248:251], v[122:125], v[226:229]
    v_fmac_f32 v202, v141, v141
    v_cvt_pk_f16_f32 v207, v208, v209
    v_mfma_f32_16x16x32_bf16 v[226:229], a[252:255], v[126:129], v[226:229]
    v_fma_f32 v203, v190, v190, s33
    v_fmac_f32 v203, v191, v191
    v_mfma_f32_16x16x32_bf16 v[226:229], v[82:85], v[198:201], v[226:229]
    buffer_store_dwordx4 v[146:149], v17, s[48:51], 0 offen nt
    v_fmac_f32 v203, v192, v192
    v_fmac_f32 v203, v193, v193
    v_pk_mul_f16 v164, v207, v207
    v_cvt_pk_f16_f32 v208, v174, v175
    v_mfma_f32_16x16x32_bf16 v[226:229], v[86:89], v[210:213], v[226:229]
    v_pk_fma_f16 v162, v208, v208, v162
    v_cvt_pk_f16_f32 v209, v176, v177
    v_mfma_f32_16x16x32_bf16 v[146:149], v[90:93], v[178:181], 0
    ds_read_b128 v[174:177], v2 offset:12288
    v_pk_fma_f16 v164, v209, v209, v164
    v_mfma_f32_16x16x32_bf16 v[146:149], v[94:97], v[182:185], v[146:149]
    ds_read_b128 v[178:181], v2 offset:13312
    v_cvt_pk_f16_f32 v194, v218, v219
    v_mfma_f32_16x16x32_bf16 v[146:149], v[98:101], v[122:125], v[146:149]
    ds_read_b128 v[122:125], v2 offset:14336
    v_fmac_f32 v203, v226, v226
    v_mfma_f32_16x16x32_bf16 v[146:149], v[102:105], v[126:129], v[146:149]
    ds_read_b128 v[126:129], v2 offset:15360
    v_fmac_f32 v203, v227, v227
    v_mfma_f32_16x16x32_bf16 v[146:149], v[106:109], v[198:201], v[146:149]
    ds_read_b128 v[182:185], v2 offset:16384
    v_fmac_f32 v203, v228, v228
    v_mfma_f32_16x16x32_bf16 v[146:149], v[110:113], v[210:213], v[146:149]
    ds_read_b128 v[198:201], v2 offset:17408
    v_fmac_f32 v203, v229, v229
    v_mfma_f32_16x16x32_bf16 v[222:225], a[104:107], v[154:157], v[222:225]
    v_pk_fma_f16 v162, v194, v194, v162
    v_cvt_pk_f16_f32 v195, v220, v221
    v_mfma_f32_16x16x32_bf16 v[222:225], a[108:111], v[166:169], v[222:225]
    v_pk_fma_f16 v164, v195, v195, v164
    v_cvt_pk_bf16_f32 v170, v170, v171
    v_mfma_f32_16x16x32_bf16 v[222:225], a[112:115], v[230:233], v[222:225]
    s_waitcnt lgkmcnt(5)
    v_fmac_f32 v203, v146, v146
    v_fmac_f32 v203, v147, v147
    v_mfma_f32_16x16x32_f16 v[210:213], v[40:43], v[162:165], 0
    s_waitcnt lgkmcnt(4)
    v_fmac_f32 v203, v148, v148
    v_fmac_f32 v203, v149, v149
    v_mfma_f32_16x16x32_bf16 v[162:165], a[216:219], v[174:177], 0
    s_waitcnt lgkmcnt(3)
    v_cvt_pk_bf16_f32 v202, v202, v203
    v_cvt_pk_bf16_f32 v203, v203, v203
    v_mfma_f32_16x16x32_bf16 v[162:165], a[220:223], v[178:181], v[162:165]
    s_waitcnt lgkmcnt(2)
    ds_write_b64 v217, v[202:203] offset:0
    v_mfma_f32_16x16x32_bf16 v[162:165], a[224:227], v[122:125], v[162:165]
    s_waitcnt lgkmcnt(1)
    v_rsq_f32 v212, v210
    v_mfma_f32_16x16x32_bf16 v[162:165], a[228:231], v[126:129], v[162:165]
    buffer_store_dwordx2 v[186:187], v20, s[48:51], 0 offen nt
    v_rsq_f32 v213, v211
    v_mfma_f32_16x16x32_bf16 v[162:165], a[232:235], v[182:185], v[162:165]
    v_mul_f32 v212, s31, v212
    v_cvt_pk_f16_f32 v212, v212, v213
    v_mfma_f32_16x16x32_bf16 v[162:165], a[236:239], v[198:201], v[162:165]
    v_cvt_pk_bf16_f32 v171, v172, v173
    v_cvt_pk_bf16_f32 v114, v114, v115
    v_mfma_f32_16x16x32_bf16 v[202:205], a[240:243], v[174:177], 0
    v_cvt_pk_bf16_f32 v115, v116, v117
    v_cvt_pk_bf16_f32 v186, v238, v239
    v_mfma_f32_16x16x32_bf16 v[202:205], a[244:247], v[178:181], v[202:205]
    v_cvt_pk_bf16_f32 v187, v240, v241
    v_pk_mul_f16 v118, v118, v212 op_sel:[0,1] op_sel_hi:[1,1]
    v_mfma_f32_16x16x32_bf16 v[202:205], a[248:251], v[122:125], v[202:205]
    s_waitcnt lgkmcnt(0)
    v_pk_mul_f16 v119, v119, v212 op_sel:[0,1] op_sel_hi:[1,1]
    v_pk_mul_f16 v120, v120, v212 op_sel:[0,1] op_sel_hi:[1,1]
    v_mfma_f32_16x16x32_bf16 v[202:205], a[252:255], v[126:129], v[202:205]
    s_barrier
    ds_read_b128 v[218:221], v216 offset:0
    v_pk_mul_f16 v121, v121, v212 op_sel:[0,1] op_sel_hi:[1,1]
    v_mfma_f32_16x16x32_bf16 v[202:205], v[82:85], v[182:185], v[202:205]
    v_pk_mul_f16 v196, v196, v212 op_sel:[0,1] op_sel_hi:[1,1]
    v_pk_mul_f16 v197, v197, v212 op_sel:[0,1] op_sel_hi:[1,1]
    v_mfma_f32_16x16x32_bf16 v[202:205], v[86:89], v[198:201], v[202:205]
    v_pk_mul_f16 v206, v206, v212 op_sel:[0,0] op_sel_hi:[1,0]
    v_pk_mul_f16 v207, v207, v212 op_sel:[0,0] op_sel_hi:[1,0]
    v_mfma_f32_16x16x32_bf16 v[222:225], a[116:119], v[234:237], v[222:225]
    v_pk_mul_f16 v208, v208, v212 op_sel:[0,0] op_sel_hi:[1,0]
    v_pk_mul_f16 v209, v209, v212 op_sel:[0,0] op_sel_hi:[1,0]
    v_pk_mul_f16 v194, v194, v212 op_sel:[0,0] op_sel_hi:[1,0]
    v_pk_mul_f16 v195, v195, v212 op_sel:[0,0] op_sel_hi:[1,0]
    v_mfma_f32_16x16x32_bf16 v[238:241], v[90:93], v[174:177], 0
    ds_read_b128 v[174:177], v216 offset:1024
    v_min3_u32 v44, v44, v210, v211
    v_mfma_f32_16x16x32_bf16 v[238:241], v[94:97], v[178:181], v[238:241]
    ds_read_b128 v[178:181], v215 offset:0
    v_max3_u32 v45, v45, v210, v211
    v_mfma_f32_16x16x32_bf16 v[238:241], v[98:101], v[122:125], v[238:241]
    ds_read_b128 v[122:125], v215 offset:2048
    v_mov_b32 v210, 0x40000000
    v_mfma_f32_16x16x32_bf16 v[238:241], v[102:105], v[126:129], v[238:241]
    s_waitcnt lgkmcnt(3)
    ds_read_b128 v[126:129], v215 offset:4096
    v_add_u32 v116, 0, v214
    v_mfma_f32_16x16x32_bf16 v[238:241], v[106:109], v[182:185], v[238:241]
    ds_read_b128 v[182:185], v215 offset:6144
    v_mul_u32_u24 v117, s20, v116
    v_mfma_f32_16x16x32_bf16 v[238:241], v[110:113], v[198:201], v[238:241]
    buffer_store_dwordx4 v[150:153], v15, s[48:51], 0 offen nt
    ds_read_b128 v[198:201], v215 offset:8192
    v_add_u32 v117, s38, v117
    v_mul_u32_u24 v117, 911, v117
    v_lshrrev_b32 v117, 16, v117
    v_mul_u32_u24 v117, s22, v117
    v_mad_u32_u24 v117, v116, s21, v117
    v_cmp_gt_u32 vcc, s17, v116
    v_mfma_f32_16x16x32_bf16 v[150:153], v[32:35], v[218:221], 0
    s_waitcnt lgkmcnt(5)
    ds_read_b128 v[218:221], v215 offset:10240
    v_add_u32 v116, s7, v117
    v_mfma_f32_16x16x32_bf16 v[150:153], v[32:35], v[174:177], v[150:153]
    s_waitcnt lgkmcnt(5)
    v_cndmask_b32 v116, v210, v116, vcc
    v_lshl_add_u32 v211, v255, 4, v116
    v_mfma_f32_16x16x32_bf16 v[174:177], a[120:123], v[130:133], 0
    s_waitcnt lgkmcnt(4)
    v_add_u32 v211, s3, v211
    v_lshl_add_u32 v212, v255, 3, v116
    v_mfma_f32_16x16x32_bf16 v[174:177], a[124:127], v[134:137], v[174:177]
    s_waitcnt lgkmcnt(3)
    v_mul_f32 v213, 0x3baaaaab, v151
    v_mul_f32 v116, 0x3baaaaab, v150
    v_mfma_f32_16x16x32_bf16 v[174:177], a[128:131], v[154:157], v[174:177]
    s_waitcnt lgkmcnt(2)
    v_rsq_f32 v213, v213
    v_mfma_f32_16x16x32_bf16 v[174:177], a[132:135], v[166:169], v[174:177]
    s_waitcnt lgkmcnt(1)
    v_mul_f32 v190, v213, v190
    v_mul_f32 v191, v213, v191
    v_mfma_f32_16x16x32_bf16 v[174:177], a[136:139], v[230:233], v[174:177]
    v_cvt_pk_bf16_f32 v150, v190, v191
    v_mul_f32 v192, v213, v192
    v_mfma_f32_16x16x32_bf16 v[174:177], a[140:143], v[234:237], v[174:177]
    v_mul_f32 v193, v213, v193
    v_cvt_pk_bf16_f32 v151, v192, v193
    v_mul_f32 v226, v213, v226
    v_mul_f32 v227, v213, v227
    v_cvt_pk_bf16_f32 v152, v226, v227
    v_mfma_f32_16x16x32_bf16 v[190:193], a[216:219], v[178:181], 0
    s_waitcnt lgkmcnt(0)
    v_mul_f32 v228, v213, v228
    v_mul_f32 v229, v213, v229
    v_mfma_f32_16x16x32_bf16 v[190:193], a[220:223], v[122:125], v[190:193]
    v_cvt_pk_bf16_f32 v153, v228, v229
    v_mul_f32 v146, v213, v146
    v_mfma_f32_16x16x32_bf16 v[190:193], a[224:227], v[126:129], v[190:193]
    v_mul_f32 v147, v213, v147
    v_cvt_pk_bf16_f32 v172, v146, v147
    v_mfma_f32_16x16x32_bf16 v[190:193], a[228:231], v[182:185], v[190:193]
    v_mul_f32 v148, v213, v148
    v_mul_f32 v149, v213, v149
    v_mfma_f32_16x16x32_bf16 v[190:193], a[232:235], v[198:201], v[190:193]
    v_cvt_pk_bf16_f32 v173, v148, v149
    v_add_u32 v212, s4, v212
    v_mfma_f32_16x16x32_bf16 v[190:193], a[236:239], v[218:221], v[190:193]
    buffer_store_dwordx4 v[150:153], v16, s[52:55], 0 offen nt
    v_rsq_f32 v116, v116
    v_fma_f32 v213, v162, v162, s33
    v_mul_f32 v142, v116, v142
    v_mfma_f32_16x16x32_bf16 v[146:149], a[240:243], v[178:181], 0
    v_mul_f32 v143, v116, v143
    v_cvt_pk_bf16_f32 v142, v142, v143
    v_mfma_f32_16x16x32_bf16 v[146:149], a[244:247], v[122:125], v[146:149]
    v_mul_f32 v144, v116, v144
    v_mul_f32 v145, v116, v145
    v_mfma_f32_16x16x32_bf16 v[146:149], a[248:251], v[126:129], v[146:149]
    v_cvt_pk_bf16_f32 v143, v144, v145
    v_mul_f32 v158, v116, v158
    v_mfma_f32_16x16x32_bf16 v[146:149], a[252:255], v[182:185], v[146:149]
    v_mul_f32 v159, v116, v159
    v_cvt_pk_bf16_f32 v144, v158, v159
    v_mfma_f32_16x16x32_bf16 v[146:149], v[82:85], v[198:201], v[146:149]
    v_mul_f32 v160, v116, v160
    v_mul_f32 v161, v116, v161
    v_mfma_f32_16x16x32_bf16 v[146:149], v[86:89], v[218:221], v[146:149]
    v_cvt_pk_bf16_f32 v145, v160, v161
    v_mul_f32 v138, v116, v138
    v_mfma_f32_16x16x32_bf16 v[150:153], v[90:93], v[178:181], 0
    v_mul_f32 v139, v116, v139
    v_cvt_pk_bf16_f32 v138, v138, v139
    v_mfma_f32_16x16x32_bf16 v[150:153], v[94:97], v[122:125], v[150:153]
    v_mul_f32 v140, v116, v140
    v_mul_f32 v141, v116, v141
    v_mfma_f32_16x16x32_bf16 v[150:153], v[98:101], v[126:129], v[150:153]
    v_cvt_pk_bf16_f32 v139, v140, v141
    v_fma_f32 v116, v190, v190, s33
    v_mfma_f32_16x16x32_bf16 v[150:153], v[102:105], v[182:185], v[150:153]
    v_fmac_f32 v116, v191, v191
    v_fmac_f32 v116, v192, v192
    v_mfma_f32_16x16x32_bf16 v[150:153], v[106:109], v[198:201], v[150:153]
    v_fmac_f32 v116, v193, v193
    v_fmac_f32 v116, v146, v146
    v_mfma_f32_16x16x32_bf16 v[150:153], v[110:113], v[218:221], v[150:153]
    v_fmac_f32 v116, v147, v147
    v_fmac_f32 v116, v148, v148
    v_mfma_f32_16x16x32_bf16 v[122:125], a[0:3], v[130:133], 0
    v_fmac_f32 v116, v149, v149
    v_fmac_f32 v213, v163, v163
    v_mfma_f32_16x16x32_bf16 v[122:125], a[4:7], v[134:137], v[122:125]
    v_fmac_f32 v213, v164, v164
    v_fmac_f32 v213, v165, v165
    v_mfma_f32_16x16x32_bf16 v[122:125], a[8:11], v[154:157], v[122:125]
    v_fmac_f32 v116, v150, v150
    v_fmac_f32 v116, v151, v151
    v_mfma_f32_16x16x32_bf16 v[122:125], a[12:15], v[166:169], v[122:125]
    buffer_store_dwordx2 v[172:173], v19, s[52:55], 0 offen nt
    v_fmac_f32 v116, v152, v152
    v_fmac_f32 v116, v153, v153
    v_mfma_f32_16x16x32_bf16 v[122:125], a[16:19], v[230:233], v[122:125]
    v_cvt_pk_bf16_f32 v117, v116, v116
    v_fmac_f32 v213, v202, v202
    v_mfma_f32_16x16x32_bf16 v[122:125], a[20:23], v[234:237], v[122:125]
    v_fmac_f32 v213, v203, v203
    v_fmac_f32 v213, v204, v204
    v_mfma_f32_16x16x32_bf16 v[126:129], a[24:27], v[130:133], 0
    v_fmac_f32 v213, v205, v205
    v_fmac_f32 v213, v238, v238
    v_mfma_f32_16x16x32_bf16 v[126:129], a[28:31], v[134:137], v[126:129]
    v_fmac_f32 v213, v239, v239
    v_fmac_f32 v213, v240, v240
    v_mfma_f32_16x16x32_bf16 v[126:129], a[32:35], v[154:157], v[126:129]
    v_fmac_f32 v213, v241, v241
    v_cvt_pk_bf16_f32 v116, v213, v116
    v_mfma_f32_16x16x32_bf16 v[126:129], a[36:39], v[166:169], v[126:129]
    ds_write_b64 v217, v[116:117] offset:2048
    v_mfma_f32_16x16x32_bf16 v[126:129], a[40:43], v[230:233], v[126:129]
    v_cvt_pk_f16_f32 v122, v122, v123
    v_pk_mul_f16 v158, v122, v122
    v_mfma_f32_16x16x32_bf16 v[126:129], a[44:47], v[234:237], v[126:129]
    v_cvt_pk_f16_f32 v123, v124, v125
    v_pk_mul_f16 v160, v123, v123
    v_mfma_f32_16x16x32_bf16 v[178:181], a[48:51], v[130:133], 0
    v_cvt_pk_f16_f32 v182, v242, v243
    v_pk_mul_f16 v159, v182, v182
    v_mfma_f32_16x16x32_bf16 v[178:181], a[52:55], v[134:137], v[178:181]
    v_cvt_pk_f16_f32 v183, v244, v245
    v_pk_mul_f16 v161, v183, v183
    v_mfma_f32_16x16x32_bf16 v[178:181], a[56:59], v[154:157], v[178:181]
    v_cvt_pk_f16_f32 v124, v126, v127
    v_pk_fma_f16 v158, v124, v124, v158
    v_mfma_f32_16x16x32_bf16 v[178:181], a[60:63], v[166:169], v[178:181]
    v_cvt_pk_f16_f32 v125, v128, v129
    v_pk_fma_f16 v160, v125, v125, v160
    v_mfma_f32_16x16x32_bf16 v[178:181], a[64:67], v[230:233], v[178:181]
    s_waitcnt lgkmcnt(0)
    v_cvt_pk_f16_f32 v184, v222, v223
    v_pk_fma_f16 v159, v184, v184, v159
    v_mfma_f32_16x16x32_bf16 v[178:181], a[68:71], v[234:237], v[178:181]
    s_barrier
    ds_read_b128 v[126:129], v216 offset:2048
    ds_read_b128 v[198:201], v216 offset:3072
    v_mfma_f32_16x16x32_bf16 v[218:221], v[130:133], a[144:147], 0
    v_cvt_pk_f16_f32 v185, v224, v225
    v_pk_fma_f16 v161, v185, v185, v161
    v_mfma_f32_16x16x32_bf16 v[218:221], v[134:137], a[148:151], v[218:221]
    buffer_store_dwordx2 v[188:189], v18, s[48:51], 0 offen nt
    v_cvt_pk_f16_f32 v178, v178, v179
    v_pk_fma_f16 v158, v178, v178, v158
    v_mfma_f32_16x16x32_bf16 v[218:221], v[154:157], a[152:155], v[218:221]
    v_cvt_pk_f16_f32 v179, v180, v181
    v_pk_fma_f16 v160, v179, v179, v160
    v_mfma_f32_16x16x32_bf16 v[218:221], v[166:169], a[156:159], v[218:221]
    v_cvt_pk_f16_f32 v180, v174, v175
    v_pk_fma_f16 v159, v180, v180, v159
    v_mfma_f32_16x16x32_bf16 v[218:221], v[230:233], a[160:163], v[218:221]
    v_cvt_pk_f16_f32 v181, v176, v177
    v_pk_fma_f16 v161, v181, v181, v161
    v_mfma_f32_16x16x32_bf16 v[218:221], v[234:237], a[164:167], v[218:221]
    ds_read_b128 v[174:177], v0 offset:32768
    v_xor_b32 v213, 65536, v2
    v_mfma_f32_16x16x32_f16 v[222:225], v[40:43], v[158:161], 0
    s_waitcnt lgkmcnt(2)
    v_bfe_u32 v140, v214, 1, 2
    v_xor_b32 v140, v140, v255
    v_mfma_f32_16x16x32_bf16 v[158:161], v[32:35], v[126:129], 0
    s_waitcnt lgkmcnt(1)
    v_cvt_pk_bf16_f32 v172, v218, v219
    v_cvt_pk_bf16_f32 v173, v220, v221
    v_mfma_f32_16x16x32_bf16 v[158:161], v[32:35], v[198:201], v[158:161]
    v_rsq_f32 v224, v222
    v_mfma_f32_16x16x32_bf16 v[126:129], v[130:133], a[168:171], 0
    ds_read_b128 v[198:201], v1 offset:32768
    v_mul_f32 v224, s31, v224
    v_mfma_f32_16x16x32_bf16 v[126:129], v[134:137], a[172:175], v[126:129]
    ds_read_b128 v[218:221], v0 offset:32896
    v_min3_u32 v44, v44, v222, v223
    v_mfma_f32_16x16x32_bf16 v[126:129], v[154:157], a[176:179], v[126:129]
    ds_read_b128 v[226:229], v1 offset:32896
    v_mul_f32 v141, 0x3baaaaab, v159
    v_mfma_f32_16x16x32_bf16 v[126:129], v[166:169], a[180:183], v[126:129]
    ds_read_b128 v[242:245], v0 offset:33024
    v_max3_u32 v45, v45, v222, v223
    v_mfma_f32_16x16x32_bf16 v[126:129], v[230:233], a[184:187], v[126:129]
    s_waitcnt lgkmcnt(4)
    v_rsq_f32 v225, v223
    v_mfma_f32_16x16x32_bf16 v[126:129], v[234:237], a[188:191], v[126:129]
    v_cvt_pk_f16_f32 v224, v224, v225
    v_pk_mul_f16 v182, v182, v224 op_sel:[0,1] op_sel_hi:[1,1]
    v_mfma_f32_16x16x32_bf16 v[246:249], v[130:133], a[192:195], 0
    ds_read_b128 v[130:133], v1 offset:33024
    v_pk_mul_f16 v183, v183, v224 op_sel:[0,1] op_sel_hi:[1,1]
    v_mfma_f32_16x16x32_bf16 v[246:249], v[134:137], a[196:199], v[246:249]
    v_rsq_f32 v141, v141
    v_mfma_f32_16x16x32_bf16 v[246:249], v[154:157], a[200:203], v[246:249]
    s_waitcnt lgkmcnt(4)
    buffer_store_dwordx4 v[142:145], v15, s[52:55], 0 offen nt
    v_cvt_pk_bf16_f32 v116, v126, v127
    v_cvt_pk_bf16_f32 v117, v128, v129
    v_mul_f32 v190, v141, v190
    v_mul_f32 v191, v141, v191
    v_mfma_f32_16x16x32_bf16 v[246:249], v[166:169], a[204:207], v[246:249]
    s_waitcnt lgkmcnt(2)
    v_cvt_pk_bf16_f32 v126, v190, v191
    v_mul_f32 v192, v141, v192
    v_mfma_f32_16x16x32_bf16 v[246:249], v[230:233], a[208:211], v[246:249]
    s_waitcnt lgkmcnt(1)
    v_mul_f32 v193, v141, v193
    v_cvt_pk_bf16_f32 v127, v192, v193
    v_mfma_f32_16x16x32_bf16 v[246:249], v[234:237], a[212:215], v[246:249]
    v_mul_f32 v146, v141, v146
    v_mul_f32 v147, v141, v147
    v_mfma_f32_16x16x32_bf16 v[134:137], a[72:75], v[174:177], 0
    v_cvt_pk_bf16_f32 v128, v146, v147
    v_mul_f32 v148, v141, v148
    v_mfma_f32_16x16x32_bf16 v[134:137], a[76:79], v[198:201], v[134:137]
    s_waitcnt lgkmcnt(0)
    v_mul_f32 v149, v141, v149
    v_cvt_pk_bf16_f32 v129, v148, v149
    v_mfma_f32_16x16x32_bf16 v[134:137], a[80:83], v[218:221], v[134:137]
    v_mul_f32 v150, v141, v150
    v_mul_f32 v151, v141, v151
    v_mfma_f32_16x16x32_bf16 v[134:137], a[84:87], v[226:229], v[134:137]
    v_cvt_pk_bf16_f32 v160, v150, v151
    v_mul_f32 v152, v141, v152
    v_mfma_f32_16x16x32_bf16 v[134:137], a[88:91], v[242:245], v[134:137]
    v_mul_f32 v153, v141, v153
    v_cvt_pk_bf16_f32 v161, v152, v153
    v_mfma_f32_16x16x32_bf16 v[134:137], a[92:95], v[130:133], v[134:137]
    v_cvt_pk_bf16_f32 v188, v246, v247
    v_cvt_pk_bf16_f32 v189, v248, v249
    v_mfma_f32_16x16x32_bf16 v[142:145], a[96:99], v[174:177], 0
    v_pk_mul_f16 v184, v184, v224 op_sel:[0,1] op_sel_hi:[1,1]
    v_pk_mul_f16 v185, v185, v224 op_sel:[0,1] op_sel_hi:[1,1]
    v_mfma_f32_16x16x32_bf16 v[142:145], a[100:103], v[198:201], v[142:145]
    v_pk_mul_f16 v180, v180, v224 op_sel:[0,1] op_sel_hi:[1,1]
    v_pk_mul_f16 v181, v181, v224 op_sel:[0,1] op_sel_hi:[1,1]
    v_mfma_f32_16x16x32_bf16 v[142:145], a[104:107], v[218:221], v[142:145]
    v_pk_mul_f16 v122, v122, v224 op_sel:[0,0] op_sel_hi:[1,0]
    v_pk_mul_f16 v123, v123, v224 op_sel:[0,0] op_sel_hi:[1,0]
    v_mfma_f32_16x16x32_bf16 v[142:145], a[108:111], v[226:229], v[142:145]
    v_pk_mul_f16 v124, v124, v224 op_sel:[0,0] op_sel_hi:[1,0]
    v_pk_mul_f16 v125, v125, v224 op_sel:[0,0] op_sel_hi:[1,0]
    v_mfma_f32_16x16x32_bf16 v[142:145], a[112:115], v[242:245], v[142:145]
    v_pk_mul_f16 v178, v178, v224 op_sel:[0,0] op_sel_hi:[1,0]
    v_pk_mul_f16 v179, v179, v224 op_sel:[0,0] op_sel_hi:[1,0]
    v_mfma_f32_16x16x32_bf16 v[142:145], a[116:119], v[130:133], v[142:145]
    v_mul_f32 v158, 0x3baaaaab, v158
    v_lshl_add_u32 v140, v214, 2, v140
    v_mfma_f32_16x16x32_bf16 v[146:149], a[120:123], v[174:177], 0
    buffer_store_dwordx2 v[138:139], v18, s[52:55], 0 offen nt
    v_rsq_f32 v158, v158
    v_mfma_f32_16x16x32_bf16 v[146:149], a[124:127], v[198:201], v[146:149]
    v_mul_f32 v162, v158, v162
    v_mul_f32 v163, v158, v163
    v_mfma_f32_16x16x32_bf16 v[146:149], a[128:131], v[218:221], v[146:149]
    v_cvt_pk_bf16_f32 v150, v162, v163
    v_mul_f32 v164, v158, v164
    v_mfma_f32_16x16x32_bf16 v[146:149], a[132:135], v[226:229], v[146:149]
    v_mul_f32 v165, v158, v165
    v_cvt_pk_bf16_f32 v151, v164, v165
    v_mfma_f32_16x16x32_bf16 v[146:149], a[136:139], v[242:245], v[146:149]
    v_mul_f32 v202, v158, v202
    v_mul_f32 v203, v158, v203
    v_mfma_f32_16x16x32_bf16 v[146:149], a[140:143], v[130:133], v[146:149]
    v_cvt_pk_bf16_f32 v152, v202, v203
    v_mul_f32 v204, v158, v204
    v_mfma_f32_16x16x32_bf16 v[154:157], a[0:3], v[174:177], 0
    v_mul_f32 v205, v158, v205
    v_cvt_pk_bf16_f32 v153, v204, v205
    v_mfma_f32_16x16x32_bf16 v[154:157], a[4:7], v[198:201], v[154:157]
    v_mul_f32 v238, v158, v238
    v_mul_f32 v239, v158, v239
    v_mfma_f32_16x16x32_bf16 v[154:157], a[8:11], v[218:221], v[154:157]
    v_cvt_pk_bf16_f32 v138, v238, v239
    v_mul_f32 v240, v158, v240
    v_mfma_f32_16x16x32_bf16 v[154:157], a[12:15], v[226:229], v[154:157]
    v_mul_f32 v241, v158, v241
    v_cvt_pk_bf16_f32 v139, v240, v241
    v_mfma_f32_16x16x32_bf16 v[154:157], a[16:19], v[242:245], v[154:157]
    v_lshl_add_u32 v141, v140, 4, s5
    v_lshl_add_u32 v158, v140, 3, s5
    v_mfma_f32_16x16x32_bf16 v[154:157], a[20:23], v[130:133], v[154:157]
    v_lshl_add_u32 v159, v254, 4, s5
    v_lshl_add_u32 v254, v254, 3, s5
    v_mfma_f32_16x16x32_bf16 v[162:165], a[24:27], v[174:177], 0
    v_lshlrev_b32 v140, 2, v140
    v_cvt_pk_f16_f32 v134, v134, v135
    v_mfma_f32_16x16x32_bf16 v[162:165], a[28:31], v[198:201], v[162:165]
    ds_permute_b32 v166, v140, v16
    ds_permute_b32 v167, v140, v19
    v_mfma_f32_16x16x32_bf16 v[162:165], a[32:35], v[218:221], v[162:165]
    ds_permute_b32 v168, v140, v17
    ds_permute_b32 v169, v140, v20
    v_mfma_f32_16x16x32_bf16 v[162:165], a[36:39], v[226:229], v[162:165]
    v_cvt_pk_f16_f32 v154, v154, v155
    v_pk_mul_f16 v190, v154, v154
    v_mfma_f32_16x16x32_bf16 v[162:165], a[40:43], v[242:245], v[162:165]
    buffer_store_dwordx4 v[126:129], v211, s[12:15], 0 offen nt
    v_cvt_pk_f16_f32 v155, v156, v157
    v_pk_mul_f16 v192, v155, v155
    v_pk_mul_f16 v191, v134, v134
    v_cvt_pk_f16_f32 v135, v136, v137
    v_mfma_f32_16x16x32_bf16 v[162:165], a[44:47], v[130:133], v[162:165]
    v_pk_mul_f16 v193, v135, v135
    v_cvt_pk_f16_f32 v136, v142, v143
    v_mfma_f32_16x16x32_bf16 v[126:129], a[48:51], v[174:177], 0
    v_pk_fma_f16 v191, v136, v136, v191
    v_cvt_pk_f16_f32 v137, v144, v145
    v_mfma_f32_16x16x32_bf16 v[126:129], a[52:55], v[198:201], v[126:129]
    v_pk_fma_f16 v193, v137, v137, v193
    v_cvt_pk_f16_f32 v144, v146, v147
    v_mfma_f32_16x16x32_bf16 v[126:129], a[56:59], v[218:221], v[126:129]
    s_waitcnt lgkmcnt(2)
    ds_read2_b32 v[204:205], v6 offset0:0 offset1:0
    ds_read2_b32 v[224:225], v6 offset0:16 offset1:16
    v_mfma_f32_16x16x32_bf16 v[126:129], a[60:63], v[226:229], v[126:129]
    s_waitcnt lgkmcnt(2)
    ds_read2_b32 v[232:233], v6 offset0:32 offset1:32
    v_cvt_pk_f16_f32 v156, v162, v163
    v_mfma_f32_16x16x32_bf16 v[126:129], a[64:67], v[242:245], v[126:129]
    v_pk_fma_f16 v190, v156, v156, v190
    v_cvt_pk_f16_f32 v157, v164, v165
    v_mfma_f32_16x16x32_bf16 v[126:129], a[68:71], v[130:133], v[126:129]
    v_pk_fma_f16 v192, v157, v157, v192
    v_pk_fma_f16 v191, v144, v144, v191
    v_mfma_f32_16x16x32_bf16 v[162:165], v[174:177], a[144:147], 0
    v_cvt_pk_f16_f32 v145, v148, v149
    v_pk_fma_f16 v193, v145, v145, v193
    v_mfma_f32_16x16x32_bf16 v[162:165], v[198:201], a[148:151], v[162:165]
    v_add_u32 v140, 16, v214
    v_mul_u32_u24 v211, s20, v140
    v_mfma_f32_16x16x32_bf16 v[162:165], v[218:221], a[152:155], v[162:165]
    v_cvt_pk_f16_f32 v142, v126, v127
    v_pk_fma_f16 v190, v142, v142, v190
    v_mfma_f32_16x16x32_bf16 v[162:165], v[226:229], a[156:159], v[162:165]
    v_cvt_pk_f16_f32 v143, v128, v129
    v_pk_fma_f16 v192, v143, v143, v192
    v_mfma_f32_16x16x32_bf16 v[162:165], v[242:245], a[160:163], v[162:165]
    s_waitcnt lgkmcnt(1)
    v_add_u32 v211, s38, v211
    v_mul_u32_u24 v211, 911, v211
    v_mfma_f32_16x16x32_f16 v[126:129], v[40:43], v[190:193], 0
    s_waitcnt lgkmcnt(0)
    v_lshrrev_b32 v211, 16, v211
    v_mul_u32_u24 v211, s22, v211
    v_mfma_f32_16x16x32_bf16 v[162:165], v[130:133], a[164:167], v[162:165]
    v_mad_u32_u24 v211, v140, s21, v211
    v_cmp_gt_u32 vcc, s17, v140
    v_mfma_f32_16x16x32_bf16 v[146:149], v[174:177], a[168:171], 0
    v_add_u32 v140, s7, v211
    v_min3_u32 v44, v44, v126, v127
    v_mfma_f32_16x16x32_bf16 v[146:149], v[198:201], a[172:175], v[146:149]
    buffer_store_dwordx2 v[160:161], v212, s[12:15], 0 offen nt
    v_rsq_f32 v128, v126
    v_mfma_f32_16x16x32_bf16 v[146:149], v[218:221], a[176:179], v[146:149]
    v_cvt_pk_bf16_f32 v202, v162, v163
    v_cvt_pk_bf16_f32 v203, v164, v165
    v_mfma_f32_16x16x32_bf16 v[146:149], v[226:229], a[180:183], v[146:149]
    v_rsq_f32 v129, v127
    v_mfma_f32_16x16x32_bf16 v[146:149], v[242:245], a[184:187], v[146:149]
    v_mul_f32 v128, s31, v128
    v_cvt_pk_f16_f32 v128, v128, v129
    v_mfma_f32_16x16x32_bf16 v[146:149], v[130:133], a[188:191], v[146:149]
    v_pk_mul_f16 v134, v134, v128 op_sel:[0,1] op_sel_hi:[1,1]
    v_pk_mul_f16 v135, v135, v128 op_sel:[0,1] op_sel_hi:[1,1]
    v_mfma_f32_16x16x32_bf16 v[162:165], v[174:177], a[192:195], 0
    v_pk_mul_f16 v136, v136, v128 op_sel:[0,1] op_sel_hi:[1,1]
    v_pk_mul_f16 v137, v137, v128 op_sel:[0,1] op_sel_hi:[1,1]
    v_mfma_f32_16x16x32_bf16 v[162:165], v[198:201], a[196:199], v[162:165]
    v_pk_mul_f16 v144, v144, v128 op_sel:[0,1] op_sel_hi:[1,1]
    v_pk_mul_f16 v145, v145, v128 op_sel:[0,1] op_sel_hi:[1,1]
    v_mfma_f32_16x16x32_bf16 v[162:165], v[218:221], a[200:203], v[162:165]
    v_cvt_pk_bf16_f32 v222, v146, v147
    v_cvt_pk_bf16_f32 v223, v148, v149
    v_mfma_f32_16x16x32_bf16 v[162:165], v[226:229], a[204:207], v[162:165]
    v_pk_mul_f16 v154, v154, v128 op_sel:[0,0] op_sel_hi:[1,0]
    v_pk_mul_f16 v155, v155, v128 op_sel:[0,0] op_sel_hi:[1,0]
    v_mfma_f32_16x16x32_bf16 v[162:165], v[242:245], a[208:211], v[162:165]
    ds_read_b128 v[146:149], v5 offset:0
    ds_read_b128 v[174:177], v5 offset:16
    v_mfma_f32_16x16x32_f16 v[190:193], v[118:121], v[206:209], v[46:49]
    ds_read_b128 v[198:201], v5 offset:48
    ds_read_b32 v214, v6 offset:192
    v_mfma_f32_16x16x32_f16 v[218:221], v[182:185], v[206:209], v[50:53]
    v_pk_mul_f16 v156, v156, v128 op_sel:[0,0] op_sel_hi:[1,0]
    v_pk_mul_f16 v157, v157, v128 op_sel:[0,0] op_sel_hi:[1,0]
    v_mfma_f32_16x16x32_f16 v[226:229], v[134:137], v[206:209], v[54:57]
    v_pk_mul_f16 v142, v142, v128 op_sel:[0,0] op_sel_hi:[1,0]
    v_pk_mul_f16 v143, v143, v128 op_sel:[0,0] op_sel_hi:[1,0]
    v_max3_u32 v45, v45, v126, v127
    v_mfma_f32_16x16x16_f16 v[190:193], v[196:197], v[194:195], v[190:193]
    v_subrev_u32 v160, 0x3d800000, v44
    v_sub_u32 v161, 0x4a000000, v45
    v_or3_b32 v160, v160, v161, v45
    v_mfma_f32_16x16x16_f16 v[218:221], v[180:181], v[194:195], v[218:221]
    v_lshl_add_u32 v161, s16, 2, v213
    v_cndmask_b32 v140, v210, v140, vcc
    v_lshl_add_u32 v210, v255, 4, v140
    v_mfma_f32_16x16x16_f16 v[226:229], v[144:145], v[194:195], v[226:229]
    v_add_u32 v210, s3, v210
    v_lshl_add_u32 v255, v255, 3, v140
    v_exp_f32 v190, v190
    v_mfma_f32_16x16x32_bf16 v[162:165], v[130:133], a[212:215], v[162:165]
    s_waitcnt lgkmcnt(2)
    buffer_store_dwordx4 v[150:153], v17, s[52:55], 0 offen nt
    ds_write_b32 v161, v160 offset:18432
    v_exp_f32 v191, v191
    v_mfma_f32_16x16x32_f16 v[126:129], v[146:149], v[206:209], v[22:25]
    s_waitcnt lgkmcnt(1)
    v_add_u32 v255, s4, v255
    v_cvt_pk_bf16_f32 v130, v190, v191
    v_mfma_f32_16x16x32_f16 v[126:129], v[174:177], v[118:121], v[126:129]
    v_cvt_pk_bf16_f32 v230, v162, v163
    v_cvt_pk_bf16_f32 v231, v164, v165
    v_mfma_f32_16x16x32_f16 v[126:129], v[198:201], v[194:197], v[126:129]
    v_exp_f32 v192, v192
    v_mfma_f32_16x16x32_f16 v[150:153], v[146:149], v[122:125], v[24:27]
    v_exp_f32 v193, v193
    v_mfma_f32_16x16x32_f16 v[150:153], v[174:177], v[182:185], v[150:153]
    v_exp_f32 v218, v218
    v_mfma_f32_16x16x32_f16 v[150:153], v[198:201], v[178:181], v[150:153]
    v_exp_f32 v219, v219
    v_mfma_f32_16x16x32_f16 v[162:165], v[146:149], v[154:157], v[26:29]
    v_mov_b32_dpp v214, v127 quad_perm:[0,1,2,3] row_mask:0x1 bank_mask:0xf
    v_cvt_pk_bf16_f32 v131, v192, v193
    v_mfma_f32_16x16x32_f16 v[162:165], v[174:177], v[134:137], v[162:165]
    v_exp_f32 v220, v220
    v_mfma_f32_16x16x32_f16 v[162:165], v[198:201], v[142:145], v[162:165]
    v_cvt_pk_bf16_f32 v132, v218, v219
    v_mov_b32_dpp v214, v151 quad_perm:[0,1,2,3] row_mask:0x2 bank_mask:0xf
    v_exp_f32 v221, v221
    v_exp_f32 v226, v226
    v_cvt_pk_bf16_f32 v133, v220, v221
    v_exp_f32 v227, v227
    v_mfma_f32_16x16x32_f16 v[146:149], v[118:121], v[122:125], v[58:61]
    v_exp_f32 v228, v228
    v_mfma_f32_16x16x32_f16 v[174:177], v[182:185], v[122:125], v[62:65]
    v_mov_b32_dpp v214, v163 quad_perm:[0,1,2,3] row_mask:0x4 bank_mask:0xf
    v_cvt_pk_bf16_f32 v36, v226, v227
    v_mfma_f32_16x16x32_f16 v[190:193], v[134:137], v[122:125], v[66:69]
    v_exp_f32 v214, v214
    v_mfma_f32_16x16x16_f16 v[146:149], v[196:197], v[178:179], v[146:149]
    buffer_store_dwordx2 v[138:139], v20, s[52:55], 0 offen nt
    v_exp_f32 v229, v229
    v_mfma_f32_16x16x16_f16 v[174:177], v[180:181], v[178:179], v[174:177]
    v_cvt_pk_bf16_f32 v214, v214, v214
    v_exp_f32 v126, v126
    v_mfma_f32_16x16x16_f16 v[190:193], v[144:145], v[178:179], v[190:193]
    ds_write_b16 v8, v214
    v_cvt_pk_bf16_f32 v37, v228, v229
    v_cvt_pk_bf16_f32 v39, v126, 0
    v_exp_f32 v146, v146
    v_mfma_f32_16x16x32_f16 v[122:125], v[118:121], v[154:157], v[70:73]
    v_exp_f32 v147, v147
    v_mfma_f32_16x16x32_bf16 v[118:121], v[28:31], v[36:39], 0
    v_exp_f32 v148, v148
    v_mfma_f32_16x16x32_bf16 v[118:121], v[28:31], v[130:133], v[118:121]
    v_exp_f32 v149, v149
    v_mfma_f32_16x16x32_bf16 v[126:129], v[202:205], v[36:39], 0
    v_cvt_pk_bf16_f32 v146, v146, v147
    v_cvt_pk_bf16_f32 v147, v148, v149
    v_mfma_f32_16x16x32_bf16 v[126:129], v[170:173], v[130:133], v[126:129]
    v_exp_f32 v174, v174
    v_mfma_f32_16x16x32_bf16 v[198:201], v[222:225], v[36:39], 0
    v_exp_f32 v175, v175
    v_mfma_f32_16x16x32_bf16 v[198:201], v[114:117], v[130:133], v[198:201]
    v_rcp_f32 v118, v118
    v_mfma_f32_16x16x32_bf16 v[206:209], v[230:233], v[36:39], 0
    v_exp_f32 v176, v176
    v_mfma_f32_16x16x32_bf16 v[206:209], v[186:189], v[130:133], v[206:209]
    v_mul_f32 v126, v118, v126
    v_mul_f32 v127, v118, v127
    v_mfma_f32_16x16x32_f16 v[130:133], v[182:185], v[154:157], v[74:77]
    v_cvt_pk_bf16_f32 v126, v126, v127
    v_mul_f32 v128, v118, v128
    v_mfma_f32_16x16x32_f16 v[182:185], v[134:137], v[154:157], v[78:81]
    v_mul_f32 v129, v118, v129
    v_cvt_pk_bf16_f32 v127, v128, v129
    v_mul_f32 v198, v118, v198
    v_mfma_f32_16x16x16_f16 v[122:125], v[196:197], v[142:143], v[122:125]
    v_mul_f32 v199, v118, v199
    v_cvt_pk_bf16_f32 v128, v198, v199
    v_mul_f32 v200, v118, v200
    v_mfma_f32_16x16x16_f16 v[130:133], v[180:181], v[142:143], v[130:133]
    v_mul_f32 v201, v118, v201
    v_cvt_pk_bf16_f32 v129, v200, v201
    v_mul_f32 v206, v118, v206
    v_mfma_f32_16x16x16_f16 v[182:185], v[144:145], v[142:143], v[182:185]
    ds_write_b128 v3, v[126:129] offset:0
    v_mul_f32 v207, v118, v207
    v_cvt_pk_bf16_f32 v160, v206, v207
    v_mul_f32 v208, v118, v208
    v_mul_f32 v209, v118, v209
    v_cvt_pk_bf16_f32 v161, v208, v209
    v_cvt_pk_bf16_f32 v148, v174, v175
    v_exp_f32 v177, v177
    ds_write_b64 v4, v[160:161] offset:4096
    v_cvt_pk_bf16_f32 v149, v176, v177
    v_exp_f32 v190, v190
    v_exp_f32 v191, v191
    v_exp_f32 v192, v192
    v_cvt_pk_bf16_f32 v36, v190, v191
    v_exp_f32 v193, v193
    v_exp_f32 v150, v150
    v_cvt_pk_bf16_f32 v37, v192, v193
    v_cvt_pk_bf16_f32 v39, v150, 0
    v_exp_f32 v122, v122
    v_exp_f32 v123, v123
    v_mfma_f32_16x16x32_bf16 v[118:121], v[28:31], v[36:39], 0
    v_exp_f32 v124, v124
    v_mfma_f32_16x16x32_bf16 v[118:121], v[28:31], v[146:149], v[118:121]
    v_exp_f32 v125, v125
    v_mfma_f32_16x16x32_bf16 v[126:129], v[202:205], v[36:39], 0
    s_waitcnt lgkmcnt(0)
    ds_read_b128 v[134:137], v9
    ds_read_b128 v[142:145], v9 offset:64
    v_mfma_f32_16x16x32_bf16 v[126:129], v[170:173], v[146:149], v[126:129]
    s_barrier
    ds_read_b128 v[150:153], v213 offset:0
    ds_read_b128 v[154:157], v213 offset:1024
    v_mfma_f32_16x16x32_bf16 v[174:177], v[222:225], v[36:39], 0
    v_cvt_pk_bf16_f32 v122, v122, v123
    v_cvt_pk_bf16_f32 v123, v124, v125
    v_mfma_f32_16x16x32_bf16 v[174:177], v[114:117], v[146:149], v[174:177]
    ds_read_b128 v[178:181], v213 offset:2048
    ds_read_b128 v[190:193], v213 offset:3072
    v_mfma_f32_16x16x32_bf16 v[194:197], v[230:233], v[36:39], 0
    v_exp_f32 v130, v130
    v_mfma_f32_16x16x32_bf16 v[194:197], v[186:189], v[146:149], v[194:197]
    ds_read_b128 v[146:149], v213 offset:4096
    ds_read_b128 v[198:201], v213 offset:5120
    v_exp_f32 v131, v131
    v_exp_f32 v132, v132
    v_cvt_pk_bf16_f32 v124, v130, v131
    v_exp_f32 v133, v133
    s_waitcnt lgkmcnt(6)
    v_mfma_f32_16x16x32_bf16 v[206:209], v[134:137], v[28:31], 0
    v_exp_f32 v182, v182
    v_mfma_f32_16x16x32_bf16 v[206:209], v[142:145], v[28:31], v[206:209]
    s_waitcnt lgkmcnt(4)
    v_exp_f32 v183, v183
    v_mfma_f32_16x16x32_bf16 v[218:221], a[216:219], v[150:153], 0
    v_cvt_pk_bf16_f32 v125, v132, v133
    v_cvt_pk_bf16_f32 v36, v182, v183
    v_mfma_f32_16x16x32_bf16 v[218:221], a[220:223], v[154:157], v[218:221]
    s_waitcnt lgkmcnt(2)
    v_exp_f32 v184, v184
    v_mfma_f32_16x16x32_bf16 v[218:221], a[224:227], v[178:181], v[218:221]
    v_exp_f32 v185, v185
    v_mfma_f32_16x16x32_bf16 v[218:221], a[228:231], v[190:193], v[218:221]
    s_waitcnt lgkmcnt(0)
    v_exp_f32 v162, v162
    v_mfma_f32_16x16x32_bf16 v[218:221], a[232:235], v[146:149], v[218:221]
    v_cvt_pk_bf16_f32 v37, v184, v185
    v_cvt_pk_bf16_f32 v39, v162, 0
    v_mfma_f32_16x16x32_bf16 v[218:221], a[236:239], v[198:201], v[218:221]
    v_rcp_f32 v118, v118
    v_mfma_f32_16x16x32_bf16 v[130:133], a[240:243], v[150:153], 0
    v_mul_f32 v126, v118, v126
    v_mul_f32 v127, v118, v127
    v_mfma_f32_16x16x32_bf16 v[130:133], a[244:247], v[154:157], v[130:133]
    v_cvt_pk_bf16_f32 v126, v126, v127
    v_mul_f32 v128, v118, v128
    v_mfma_f32_16x16x32_bf16 v[130:133], a[248:251], v[178:181], v[130:133]
    v_fma_f32 v214, v218, v218, s33
    v_fmac_f32 v214, v219, v219
    v_mfma_f32_16x16x32_bf16 v[130:133], a[252:255], v[190:193], v[130:133]
    v_fmac_f32 v214, v220, v220
    v_fmac_f32 v214, v221, v221
    v_mfma_f32_16x16x32_bf16 v[130:133], v[82:85], v[146:149], v[130:133]
    v_mul_f32 v129, v118, v129
    v_cvt_pk_bf16_f32 v127, v128, v129
    v_mfma_f32_16x16x32_bf16 v[130:133], v[86:89], v[198:201], v[130:133]
    v_mul_f32 v174, v118, v174
    v_mul_f32 v175, v118, v175
    v_mfma_f32_16x16x32_bf16 v[162:165], v[90:93], v[150:153], 0
    v_cvt_pk_bf16_f32 v128, v174, v175
    v_mul_f32 v176, v118, v176
    v_mfma_f32_16x16x32_bf16 v[162:165], v[94:97], v[154:157], v[162:165]
    v_mul_f32 v177, v118, v177
    v_cvt_pk_bf16_f32 v129, v176, v177
    v_mfma_f32_16x16x32_bf16 v[162:165], v[98:101], v[178:181], v[162:165]
    ds_write_b128 v3, v[126:129] offset:6144
    v_mfma_f32_16x16x32_bf16 v[162:165], v[102:105], v[190:193], v[162:165]
    v_fmac_f32 v214, v130, v130
    v_fmac_f32 v214, v131, v131
    v_mfma_f32_16x16x32_bf16 v[162:165], v[106:109], v[146:149], v[162:165]
    v_fmac_f32 v214, v132, v132
    v_fmac_f32 v214, v133, v133
    v_mfma_f32_16x16x32_bf16 v[162:165], v[110:113], v[198:201], v[162:165]
    v_mul_f32 v194, v118, v194
    v_mul_f32 v195, v118, v195
    v_mfma_f32_16x16x32_bf16 v[126:129], v[134:137], v[170:173], 0
    v_cvt_pk_bf16_f32 v160, v194, v195
    v_mul_f32 v196, v118, v196
    v_mfma_f32_16x16x32_bf16 v[126:129], v[142:145], v[202:205], v[126:129]
    v_mul_f32 v197, v118, v197
    v_cvt_pk_bf16_f32 v161, v196, v197
    v_mfma_f32_16x16x32_bf16 v[118:121], v[134:137], v[114:117], 0
    ds_write_b64 v4, v[160:161] offset:10240
    v_mfma_f32_16x16x32_bf16 v[118:121], v[142:145], v[222:225], v[118:121]
    v_rcp_f32 v206, v206
    v_mfma_f32_16x16x32_bf16 v[146:149], v[134:137], v[186:189], 0
    v_fmac_f32 v214, v162, v162
    v_fmac_f32 v214, v163, v163
    v_mfma_f32_16x16x32_bf16 v[146:149], v[142:145], v[230:233], v[146:149]
    v_fmac_f32 v214, v164, v164
    v_fmac_f32 v214, v165, v165
    v_mfma_f32_16x16x32_bf16 v[134:137], v[28:31], v[36:39], 0
    v_cvt_pk_bf16_f32 v160, v214, v214
    v_cvt_pk_bf16_f32 v161, v214, v214
    v_mfma_f32_16x16x32_bf16 v[134:137], v[28:31], v[122:125], v[134:137]
    ds_write_b64 v217, v[160:161] offset:4096
    v_mfma_f32_16x16x32_bf16 v[142:145], v[202:205], v[36:39], 0
    v_mul_f32 v126, v126, v206
    v_mul_f32_dpp v126, v118, v206 quad_perm:[0,1,2,3] row_mask:0x2 bank_mask:0xf
    v_mfma_f32_16x16x32_bf16 v[142:145], v[170:173], v[122:125], v[142:145]
    v_mul_f32_dpp v126, v146, v206 quad_perm:[0,1,2,3] row_mask:0x4 bank_mask:0xf
    v_cvt_pk_bf16_f32 v126, v126, v126
    v_mfma_f32_16x16x32_bf16 v[118:121], v[222:225], v[36:39], 0
    ds_write_b16 v7, v126
    v_mfma_f32_16x16x32_bf16 v[118:121], v[114:117], v[122:125], v[118:121]
    v_rcp_f32 v134, v134
    v_mfma_f32_16x16x32_bf16 v[114:117], v[230:233], v[36:39], 0
    v_mfma_f32_16x16x32_bf16 v[114:117], v[186:189], v[122:125], v[114:117]
    v_mul_f32 v142, v134, v142
    v_mul_f32 v143, v134, v143
    v_cvt_pk_bf16_f32 v122, v142, v143
    v_mul_f32 v144, v134, v144
    v_mul_f32 v145, v134, v145
    v_cvt_pk_bf16_f32 v123, v144, v145
    v_mul_f32 v118, v134, v118
    v_mul_f32 v119, v134, v119
    v_cvt_pk_bf16_f32 v124, v118, v119
    v_mul_f32 v120, v134, v120
    v_mul_f32 v121, v134, v121
    v_cvt_pk_bf16_f32 v125, v120, v121
    ds_write_b128 v3, v[122:125] offset:12288
    s_waitcnt lgkmcnt(1)
    s_barrier
    v_mul_f32 v114, v134, v114
    v_mul_f32 v115, v134, v115
    v_cvt_pk_bf16_f32 v160, v114, v115
    v_mul_f32 v116, v134, v116
    v_mul_f32 v117, v134, v117
    ds_read_b128 v[118:121], v216 offset:4096
    ds_read_b128 v[122:125], v216 offset:5120
    ds_read_b128 v[126:129], v213 offset:6144
    ds_read_b128 v[134:137], v213 offset:7168
    ds_read_b128 v[142:145], v213 offset:8192
    ds_read_b128 v[146:149], v213 offset:9216
    ds_read_b128 v[150:153], v213 offset:10240
    ds_read_b128 v[154:157], v213 offset:11264
    v_cvt_pk_bf16_f32 v161, v116, v117
    ds_write_b64 v4, v[160:161] offset:16384
    s_waitcnt lgkmcnt(8)
    v_mfma_f32_16x16x32_bf16 v[114:117], v[32:35], v[118:121], 0
    s_waitcnt lgkmcnt(6)
    v_mfma_f32_16x16x32_bf16 v[114:117], v[32:35], v[122:125], v[114:117]
    s_waitcnt lgkmcnt(5)
    v_mfma_f32_16x16x32_bf16 v[118:121], a[216:219], v[126:129], 0
    s_waitcnt lgkmcnt(4)
    v_mfma_f32_16x16x32_bf16 v[118:121], a[220:223], v[134:137], v[118:121]
    s_waitcnt lgkmcnt(3)
    v_mfma_f32_16x16x32_bf16 v[118:121], a[224:227], v[142:145], v[118:121]
    s_waitcnt lgkmcnt(2)
    v_mfma_f32_16x16x32_bf16 v[118:121], a[228:231], v[146:149], v[118:121]
    s_waitcnt lgkmcnt(1)
    v_mul_f32 v214, 0x3baaaaab, v114
    v_mfma_f32_16x16x32_bf16 v[118:121], a[232:235], v[150:153], v[118:121]
    v_rsq_f32 v214, v214
    v_mfma_f32_16x16x32_bf16 v[118:121], a[236:239], v[154:157], v[118:121]
    v_mul_f32 v218, v214, v218
    v_mul_f32 v219, v214, v219
    v_mfma_f32_16x16x32_bf16 v[114:117], a[240:243], v[126:129], 0
    v_cvt_pk_bf16_f32 v122, v218, v219
    v_mul_f32 v220, v214, v220
    v_mfma_f32_16x16x32_bf16 v[114:117], a[244:247], v[134:137], v[114:117]
    v_mul_f32 v221, v214, v221
    v_cvt_pk_bf16_f32 v123, v220, v221
    v_mfma_f32_16x16x32_bf16 v[114:117], a[248:251], v[142:145], v[114:117]
    v_mul_f32 v130, v214, v130
    v_mul_f32 v131, v214, v131
    v_mfma_f32_16x16x32_bf16 v[114:117], a[252:255], v[146:149], v[114:117]
    v_cvt_pk_bf16_f32 v124, v130, v131
    v_mul_f32 v132, v214, v132
    v_mfma_f32_16x16x32_bf16 v[114:117], v[82:85], v[150:153], v[114:117]
    v_mul_f32 v133, v214, v133
    v_cvt_pk_bf16_f32 v125, v132, v133
    v_mfma_f32_16x16x32_bf16 v[114:117], v[86:89], v[154:157], v[114:117]
    buffer_store_dwordx4 v[122:125], v15, s[56:59], 0 offen nt
    v_mul_f32 v162, v214, v162
    v_mul_f32 v163, v214, v163
    v_cvt_pk_bf16_f32 v160, v162, v163
    v_mul_f32 v164, v214, v164
    v_mfma_f32_16x16x32_bf16 v[122:125], v[90:93], v[126:129], 0
    ds_read_b128 v[126:129], v215 offset:256
    v_mul_f32 v165, v214, v165
    v_mfma_f32_16x16x32_bf16 v[122:125], v[94:97], v[134:137], v[122:125]
    ds_read_b128 v[130:133], v215 offset:2304
    v_cvt_pk_bf16_f32 v161, v164, v165
    v_mfma_f32_16x16x32_bf16 v[122:125], v[98:101], v[142:145], v[122:125]
    ds_read_b128 v[134:137], v215 offset:4352
    v_fma_f32 v214, v118, v118, s33
    v_mfma_f32_16x16x32_bf16 v[122:125], v[102:105], v[146:149], v[122:125]
    ds_read_b128 v[142:145], v215 offset:6400
    v_fmac_f32 v214, v119, v119
    v_mfma_f32_16x16x32_bf16 v[122:125], v[106:109], v[150:153], v[122:125]
    ds_read_b128 v[146:149], v215 offset:8448
    v_fmac_f32 v214, v120, v120
    v_mfma_f32_16x16x32_bf16 v[122:125], v[110:113], v[154:157], v[122:125]
    ds_read_b128 v[150:153], v215 offset:10496
    v_fmac_f32 v214, v121, v121
    v_fmac_f32 v214, v114, v114
    v_fmac_f32 v214, v115, v115
    v_fmac_f32 v214, v116, v116
    v_fmac_f32 v214, v117, v117
    s_nop 0
    s_nop 0
    s_waitcnt lgkmcnt(5)
    v_mfma_f32_16x16x32_bf16 v[154:157], a[216:219], v[126:129], 0
    v_fmac_f32 v214, v122, v122
    v_fmac_f32 v214, v123, v123
    v_mfma_f32_16x16x32_bf16 v[162:165], a[240:243], v[126:129], 0
    s_waitcnt lgkmcnt(4)
    v_fmac_f32 v214, v124, v124
    v_fmac_f32 v214, v125, v125
    v_mfma_f32_16x16x32_bf16 v[154:157], a[220:223], v[130:133], v[154:157]
    s_waitcnt lgkmcnt(3)
    v_cvt_pk_bf16_f32 v138, v214, v214
    v_cvt_pk_bf16_f32 v139, v214, v214
    v_mfma_f32_16x16x32_bf16 v[154:157], a[224:227], v[134:137], v[154:157]
    s_waitcnt lgkmcnt(2)
    ds_write_b64 v217, v[138:139] offset:6144
    v_mfma_f32_16x16x32_bf16 v[154:157], a[228:231], v[142:145], v[154:157]
    s_waitcnt lgkmcnt(2)
    v_mfma_f32_16x16x32_bf16 v[154:157], a[232:235], v[146:149], v[154:157]
    s_waitcnt lgkmcnt(1)
    v_mfma_f32_16x16x32_bf16 v[154:157], a[236:239], v[150:153], v[154:157]
    v_mfma_f32_16x16x32_bf16 v[162:165], a[244:247], v[130:133], v[162:165]
    buffer_store_dwordx2 v[160:161], v18, s[56:59], 0 offen nt
    v_mfma_f32_16x16x32_bf16 v[162:165], a[248:251], v[134:137], v[162:165]
    v_mfma_f32_16x16x32_bf16 v[162:165], a[252:255], v[142:145], v[162:165]
    v_mfma_f32_16x16x32_bf16 v[162:165], v[82:85], v[146:149], v[162:165]
    s_waitcnt lgkmcnt(0)
    v_mfma_f32_16x16x32_bf16 v[162:165], v[86:89], v[150:153], v[162:165]
    s_barrier
    ds_read_b128 v[170:173], v216 offset:6144
    ds_read_b128 v[174:177], v216 offset:7168
    v_mfma_f32_16x16x32_bf16 v[178:181], v[90:93], v[126:129], 0
    ds_read_b128 v[126:129], v213 offset:12288
    v_fma_f32 v160, v154, v154, s33
    v_mfma_f32_16x16x32_bf16 v[178:181], v[94:97], v[130:133], v[178:181]
    ds_read_b128 v[130:133], v213 offset:13312
    v_fmac_f32 v160, v155, v155
    v_mfma_f32_16x16x32_bf16 v[178:181], v[98:101], v[134:137], v[178:181]
    ds_read_b128 v[134:137], v213 offset:14336
    v_fmac_f32 v160, v156, v156
    v_mfma_f32_16x16x32_bf16 v[178:181], v[102:105], v[142:145], v[178:181]
    ds_read_b128 v[142:145], v213 offset:15360
    v_fmac_f32 v160, v157, v157
    v_mfma_f32_16x16x32_bf16 v[178:181], v[106:109], v[146:149], v[178:181]
    ds_read_b128 v[146:149], v213 offset:16384
    v_fmac_f32 v160, v162, v162
    v_mfma_f32_16x16x32_bf16 v[178:181], v[110:113], v[150:153], v[178:181]
    ds_read_b128 v[150:153], v213 offset:17408
    v_fmac_f32 v160, v163, v163
    v_fmac_f32 v160, v164, v164
    v_fmac_f32 v160, v165, v165
    s_waitcnt lgkmcnt(7)
    v_mfma_f32_16x16x32_bf16 v[182:185], v[32:35], v[170:173], 0
    s_waitcnt lgkmcnt(6)
    v_mfma_f32_16x16x32_bf16 v[182:185], v[32:35], v[174:177], v[182:185]
    s_waitcnt lgkmcnt(5)
    v_fmac_f32 v160, v178, v178
    v_fmac_f32 v160, v179, v179
    v_mfma_f32_16x16x32_bf16 v[170:173], a[216:219], v[126:129], 0
    s_waitcnt lgkmcnt(4)
    v_fmac_f32 v160, v180, v180
    v_fmac_f32 v160, v181, v181
    v_mfma_f32_16x16x32_bf16 v[170:173], a[220:223], v[130:133], v[170:173]
    s_waitcnt lgkmcnt(3)
    v_cvt_pk_bf16_f32 v214, v160, v160
    v_cvt_pk_bf16_f32 v215, v160, v160
    v_mfma_f32_16x16x32_bf16 v[170:173], a[224:227], v[134:137], v[170:173]
    s_waitcnt lgkmcnt(2)
    ds_write_b64 v217, v[214:215] offset:8192
    v_mfma_f32_16x16x32_bf16 v[170:173], a[228:231], v[142:145], v[170:173]
    s_waitcnt lgkmcnt(2)
    v_mul_f32 v160, 0x3baaaaab, v182
    v_mfma_f32_16x16x32_bf16 v[170:173], a[232:235], v[146:149], v[170:173]
    s_waitcnt lgkmcnt(1)
    v_rsq_f32 v160, v160
    v_mfma_f32_16x16x32_bf16 v[170:173], a[236:239], v[150:153], v[170:173]
    v_mul_f32 v118, v160, v118
    v_mul_f32 v119, v160, v119
    v_mfma_f32_16x16x32_bf16 v[174:177], a[240:243], v[126:129], 0
    v_cvt_pk_bf16_f32 v118, v118, v119
    v_mul_f32 v120, v160, v120
    v_mfma_f32_16x16x32_bf16 v[174:177], a[244:247], v[130:133], v[174:177]
    v_mul_f32 v121, v160, v121
    v_cvt_pk_bf16_f32 v119, v120, v121
    v_mfma_f32_16x16x32_bf16 v[174:177], a[248:251], v[134:137], v[174:177]
    v_fma_f32 v161, v170, v170, s33
    v_fmac_f32 v161, v171, v171
    v_mfma_f32_16x16x32_bf16 v[174:177], a[252:255], v[142:145], v[174:177]
    s_waitcnt lgkmcnt(0)
    v_fmac_f32 v161, v172, v172
    v_fmac_f32 v161, v173, v173
    v_mfma_f32_16x16x32_bf16 v[174:177], v[82:85], v[146:149], v[174:177]
    s_barrier
    ds_read_b128 v[182:185], v216 offset:8192
    ds_read_b128 v[186:189], v216 offset:9216
    v_mfma_f32_16x16x32_bf16 v[174:177], v[86:89], v[150:153], v[174:177]
    v_mul_f32 v114, v160, v114
    v_mul_f32 v115, v160, v115
    v_mfma_f32_16x16x32_bf16 v[190:193], v[90:93], v[126:129], 0
    v_cvt_pk_bf16_f32 v120, v114, v115
    v_mul_f32 v116, v160, v116
    v_mfma_f32_16x16x32_bf16 v[190:193], v[94:97], v[130:133], v[190:193]
    v_mul_f32 v117, v160, v117
    v_cvt_pk_bf16_f32 v121, v116, v117
    v_mfma_f32_16x16x32_bf16 v[190:193], v[98:101], v[134:137], v[190:193]
    ds_write_b128 v141, v[118:121] offset:1536
    v_mfma_f32_16x16x32_bf16 v[190:193], v[102:105], v[142:145], v[190:193]
    v_fmac_f32 v161, v174, v174
    v_fmac_f32 v161, v175, v175
    v_mfma_f32_16x16x32_bf16 v[190:193], v[106:109], v[146:149], v[190:193]
    v_fmac_f32 v161, v176, v176
    v_fmac_f32 v161, v177, v177
    v_mfma_f32_16x16x32_bf16 v[190:193], v[110:113], v[150:153], v[190:193]
    s_waitcnt lgkmcnt(1)
    ds_read_b128 v[114:117], v159 offset:1536
    v_mul_f32 v122, v160, v122
    v_mfma_f32_16x16x32_bf16 v[118:121], v[32:35], v[182:185], 0
    v_mul_f32 v123, v160, v123
    v_cvt_pk_bf16_f32 v122, v122, v123
    v_mfma_f32_16x16x32_bf16 v[118:121], v[32:35], v[186:189], v[118:121]
    v_mul_f32 v124, v160, v124
    v_fmac_f32 v161, v190, v190
    v_fmac_f32 v161, v191, v191
    v_fmac_f32 v161, v192, v192
    v_fmac_f32 v161, v193, v193
    v_cvt_pk_bf16_f32 v214, v161, v161
    v_cvt_pk_bf16_f32 v215, v161, v161
    ds_write_b64 v217, v[214:215] offset:0
    v_mul_f32 v123, 0x3baaaaab, v118
    v_rsq_f32 v123, v123
    v_mul_f32 v125, v160, v125
    v_mul_f32 v154, v123, v154
    v_mul_f32 v155, v123, v155
    v_cvt_pk_bf16_f32 v118, v154, v155
    v_mul_f32 v156, v123, v156
    s_waitcnt lgkmcnt(1)
    v_mul_f32 v157, v123, v157
    v_cvt_pk_bf16_f32 v119, v156, v157
    v_mul_f32 v162, v123, v162
    v_mul_f32 v163, v123, v163
    v_cvt_pk_bf16_f32 v120, v162, v163
    v_mul_f32 v164, v123, v164
    v_mul_f32 v165, v123, v165
    v_cvt_pk_bf16_f32 v121, v164, v165
    buffer_store_dwordx4 v[118:121], v210, s[12:15], 0 offen nt
    v_mul_f32 v178, v123, v178
    v_mul_f32 v179, v123, v179
    v_cvt_pk_bf16_f32 v160, v178, v179
    v_mul_f32 v180, v123, v180
    v_mul_f32 v181, v123, v181
    s_waitcnt lgkmcnt(0)
    s_barrier
    ds_read_b128 v[118:121], v216 offset:0
    ds_read_b128 v[126:129], v216 offset:1024
    ds_read_b128 v[130:133], v213 offset:18432
    v_cvt_pk_bf16_f32 v161, v180, v181
    v_cvt_pk_bf16_f32 v123, v124, v125
    ds_write_b64 v158, v[122:123] offset:2560
    buffer_store_dwordx2 v[160:161], v255, s[12:15], 0 offen nt
    ds_read_b64 v[138:139], v254 offset:2560
    s_waitcnt lgkmcnt(4)
    v_mfma_f32_16x16x32_bf16 v[122:125], v[32:35], v[118:121], 0
    s_waitcnt lgkmcnt(3)
    v_mfma_f32_16x16x32_bf16 v[122:125], v[32:35], v[126:129], v[122:125]
    s_waitcnt lgkmcnt(2)
    v_or3_b32 v130, v130, v131, v132
    v_or_b32 v130, v130, v133
    v_cmp_gt_i32 s[46:47], 0, v130
    s_nop 0
    s_nop 0
    s_nop 0
    s_nop 0
    v_mul_f32 v255, 0x3baaaaab, v122
    v_rsq_f32 v255, v255
    s_nop 0
    v_mul_f32 v170, v255, v170
    buffer_store_dwordx4 v[114:117], v166, s[56:59], 0 offen nt
    s_waitcnt lgkmcnt(0)
    v_mul_f32 v171, v255, v171
    v_cvt_pk_bf16_f32 v114, v170, v171
    v_mul_f32 v172, v255, v172
    v_mul_f32 v173, v255, v173
    v_cvt_pk_bf16_f32 v115, v172, v173
    v_mul_f32 v174, v255, v174
    v_mul_f32 v175, v255, v175
    v_cvt_pk_bf16_f32 v116, v174, v175
    v_mul_f32 v176, v255, v176
    v_mul_f32 v177, v255, v177
    v_cvt_pk_bf16_f32 v117, v176, v177
    ds_write_b128 v141, v[114:117] offset:3072
    buffer_store_dwordx2 v[138:139], v167, s[56:59], 0 offen nt
    v_mul_f32 v190, v255, v190
    v_mul_f32 v191, v255, v191
    v_cvt_pk_bf16_f32 v166, v190, v191
    v_mul_f32 v192, v255, v192
    v_mul_f32 v193, v255, v193
    v_cvt_pk_bf16_f32 v167, v192, v193
    ds_read_b128 v[114:117], v159 offset:3072
    ds_write_b64 v158, v[166:167] offset:4096
    ds_read_b64 v[166:167], v254 offset:4096
    s_waitcnt lgkmcnt(2)
    buffer_store_dwordx4 v[114:117], v168, s[56:59], 0 offen nt
    s_waitcnt lgkmcnt(0)
    buffer_store_dwordx2 v[166:167], v169, s[56:59], 0 offen nt
L_end:
    s_nop 1
    s_cmp_lg_u64 s[46:47], 0
    s_cbranch_scc1 L_rerun
L_done:
    s_endpgm
L_slow:
    s_mov_b32 s44, 0xff
    s_branch L_redo
L_rerun:
    s_mov_b32 s44, 0x7f000000
L_redo:
    s_waitcnt vmcnt(0) lgkmcnt(0)
    s_barrier
    v_mbcnt_lo_u32_b32 v0, -1, 0
    v_mbcnt_hi_u32_b32 v0, -1, v0
    v_lshl_add_u32 v0, s16, 6, v0
    s_nop 7
    s_branch L_again
L_edge:
    v_mov_b32 v254, v0
    v_mov_b32 v255, 0x40000000
    s_lshl_b32 s3, s16, 4
    s_load_dwordx4 s[92:95], s[0:1], s3
    v_and_b32 v118, 63, v0
    s_bfe_u32 s3, s2, 0x50003
    s_lshl_b32 s4, s16, 3
    s_lshr_b32 s98, 0x06143a01, s4
    s_and_b32 s98, s98, 0xff
    s_mul_i32 s3, s3, s98
    s_sub_u32 s98, s98, 1
    s_lshr_b32 s4, 0x0048d800, s4
    s_and_b32 s4, s4, 0xff
    s_lshl_b32 s4, s4, 3
    s_max_u32 s4, s4, 6
    s_sub_u32 s4, s4, s98
    s_sub_u32 s4, s4, 1
    s_min_u32 s3, s3, s4
    v_min_u32 v120, s98, v118
    v_add_lshl_u32 v120, v120, s3, 7
    v_mov_b32 v121, 0
    v_lshrrev_b32 v119, 4, v118
    v_and_b32 v130, 15, v118
    s_mov_b32 s10, 100270464
    s_mov_b32 s11, 0x00020000
    s_mov_b32 s50, 221184
    s_mov_b32 s51, 0x00020000
    v_mul_u32_u24 v131, 171, v118
    v_lshrrev_b32 v131, 10, v131
    v_lshrrev_b32 v132, 1, v131
    v_xor_b32 v132, v132, v131
    v_and_b32 v132, 4, v132
    v_mul_u32_u24 v132, 3, v132
    v_xor_b32 v132, v132, v131
    v_mul_u32_u24 v132, 1152, v132
    v_mul_u32_u24 v133, 96, v131
    v_sub_u32 v132, v132, v133
    v_lshl_add_u32 v133, v118, 4, v132
    v_add_u32 v132, 64, v118
    v_mul_u32_u24 v132, 171, v132
    v_lshrrev_b32 v132, 10, v132
    v_lshrrev_b32 v134, 1, v132
    v_xor_b32 v134, v134, v132
    v_and_b32 v134, 4, v134
    v_mul_u32_u24 v134, 3, v134
    v_xor_b32 v134, v134, v132
    v_mul_u32_u24 v134, 1152, v134
    v_mul_u32_u24 v135, 96, v132
    v_sub_u32 v134, v134, v135
    v_lshl_add_u32 v135, v118, 4, v134
    v_add_u32 v134, 128, v118
    v_mul_u32_u24 v134, 171, v134
    v_lshrrev_b32 v134, 10, v134
    v_lshrrev_b32 v136, 1, v134
    v_xor_b32 v136, v136, v134
    v_and_b32 v136, 4, v136
    v_mul_u32_u24 v136, 3, v136
    v_xor_b32 v136, v136, v134
    v_mul_u32_u24 v136, 1152, v136
    v_mul_u32_u24 v137, 96, v134
    v_sub_u32 v136, v136, v137
    v_lshl_add_u32 v137, v118, 4, v136
    s_mul_i32 s68, s16, 6144
    s_add_u32 s69, s68, 65536
    s_cmp_eq_u32 s16, 3
    s_cselect_b32 s68, 136704, s68
    s_cselect_b32 s69, 142848, s69
    s_mul_i32 s45, s16, 96
    s_mov_b32 s70, 193536
    s_mov_b32 s36, 100270464
    s_mov_b32 s22, 1180032
    s_mul_i32 s3, s2, 911
    s_lshr_b32 s3, s3, 16
    s_mul_i32 s35, s3, 72
    s_sub_u32 s38, s2, s35
    s_mul_i32 s3, s3, 1373568
    s_mul_i32 s35, s38, 2688
    s_add_u32 s3, s3, s35
    s_add_u32 s25, s3, 589824
    s_add_u32 s7, s3, 1769472
    s_mov_b32 s20, 31
    s_mov_b32 s21, 4204032
    s_cmp_lt_u32 s2, 244
    s_cselect_b32 s17, 21, 20
    s_mov_b32 s5, 0
    s_mov_b32 s6, 0
    s_cmp_lt_u32 s2, 247
    s_cbranch_scc1 L_inner
    s_mov_b32 s20, 0
    s_mov_b32 s38, 0
    s_sub_u32 s3, s2, 247
    s_and_b32 s3, s3, 3
    s_mul_i32 s3, s3, 7
    s_add_u32 s3, s3, 3
    s_mov_b32 s35, 196224
    s_cmp_lt_u32 s2, 251
    s_cselect_b32 s35, s35, 384
    s_cselect_b32 s6, 1, 0
    s_cselect_b32 s5, 0, 1
    s_mul_i32 s25, s3, s35
    s_mul_i32 s21, s35, 28
    s_cmp_lt_u32 s2, 255
    s_cselect_b32 s17, 18, 1
    s_cselect_b32 s25, s25, 0
    s_cselect_b32 s6, s6, 1
    s_add_u32 s7, s25, 1179648
L_inner:
    s_mul_i32 s3, s5, 99485568
    s_mul_i32 s35, s5, -784896
    v_mov_b32 v136, s3
    v_mov_b32 v138, s35
    s_add_u32 s7, s7, s35
    s_mul_i32 s3, s6, 194688
    s_mul_i32 s35, s6, -1536
    v_mov_b32 v139, s3
    v_mov_b32 v140, s35
    s_add_u32 s7, s7, s35
    v_mul_u32_u24 v141, 2731, v254
    v_bfe_u32 v142, v141, 17, 3
    v_lshrrev_b32 v141, 16, v141
    v_xor_b32 v143, v142, v254
    v_mul_u32_u24 v142, 37, v141
    v_lshrrev_b32 v142, 8, v142
    v_lshlrev_b32 v143, 4, v143
    v_mad_u32_u24 v10, v142, s70, v143
    v_mul_u32_u24 v142, 37, v141
    v_lshrrev_b32 v142, 8, v142
    v_mul_u32_u24 v144, 7, v142
    v_sub_u32 v144, v141, v144
    v_cmp_gt_u32 vcc, 4, v142
    s_nop 1
    v_cndmask_b32 v142, v138, v136, vcc
    v_cmp_gt_u32 vcc, 4, v144
    s_nop 1
    v_cndmask_b32 v144, v140, v139, vcc
    v_add3_u32 v10, v10, v142, v144
    v_mul_u32_u24 v142, s20, v141
    v_add_u32 v142, s38, v142
    v_mul_u32_u24 v142, 911, v142
    v_lshrrev_b32 v142, 16, v142
    v_mul_u32_u24 v142, s22, v142
    v_mad_u32_u24 v142, v141, s21, v142
    v_cmp_gt_u32 vcc, s17, v141
    v_add_u32 v142, s7, v142
    s_nop 0
    v_cndmask_b32 v142, v255, v142, vcc
    v_mul_u32_u24 v141, 384, v141
    v_sub_u32 v141, v143, v141
    v_add_u32 v142, v142, v141
    v_add_u32 v141, 256, v254
    v_mul_u32_u24 v143, 2731, v141
    v_bfe_u32 v144, v143, 17, 3
    v_lshrrev_b32 v143, 16, v143
    v_xor_b32 v141, v144, v141
    v_mul_u32_u24 v144, 37, v143
    v_lshrrev_b32 v144, 8, v144
    v_lshlrev_b32 v141, 4, v141
    v_mad_u32_u24 v11, v144, s70, v141
    v_mul_u32_u24 v144, 37, v143
    v_lshrrev_b32 v144, 8, v144
    v_mul_u32_u24 v145, 7, v144
    v_sub_u32 v145, v143, v145
    v_cmp_gt_u32 vcc, 4, v144
    s_nop 1
    v_cndmask_b32 v144, v138, v136, vcc
    v_cmp_gt_u32 vcc, 4, v145
    s_nop 1
    v_cndmask_b32 v145, v140, v139, vcc
    v_add3_u32 v11, v11, v144, v145
    v_mul_u32_u24 v144, s20, v143
    v_add_u32 v144, s38, v144
    v_mul_u32_u24 v144, 911, v144
    v_lshrrev_b32 v144, 16, v144
    v_mul_u32_u24 v144, s22, v144
    v_mad_u32_u24 v144, v143, s21, v144
    v_cmp_gt_u32 vcc, s17, v143
    v_add_u32 v144, s7, v144
    s_nop 0
    v_cndmask_b32 v144, v255, v144, vcc
    v_mul_u32_u24 v143, 384, v143
    v_sub_u32 v143, v141, v143
    v_add_u32 v144, v144, v143
    s_lshl_b32 s28, s16, 10
    s_add_u32 s28, s28, 20480
    s_waitcnt lgkmcnt(0)
    s_load_dword s101, s[92:93], 0
    s_load_dword s101, s[94:95], 0
    s_cmp_eq_u32 s16, 2
    s_cselect_b64 s[98:99], s[80:81], s[78:79]
    s_cmp_eq_u32 s16, 3
    s_cselect_b64 s[98:99], s[88:89], s[98:99]
    s_mov_b64 s[8:9], s[76:77]
    v_lshl_add_u64 v[120:121], s[98:99], 0, v[120:121]
    s_cmp_eq_u32 s16, 2
    s_cselect_b64 s[98:99], s[84:85], s[82:83]
    s_cmp_eq_u32 s16, 3
    s_cselect_b64 s[98:99], s[86:87], s[98:99]
    v_writelane_b32 v120, s98, 63
    v_writelane_b32 v121, s99, 63
    s_cmp_eq_u32 s16, 0
    s_cbranch_scc1 L_nowue
    global_load_dword a254, v[120:121], off
L_nowue:
    s_add_u32 m0, s28, 128512
    s_nop 0
    buffer_load_dwordx4 v142, s[8:11], 0 offen nt lds
    s_add_u32 m0, s28, 132608
    s_nop 0
    buffer_load_dwordx4 v144, s[8:11], 0 offen nt lds
    s_add_u32 m0, s28, 0
    s_nop 0
    buffer_load_dwordx4 v10, s[8:11], s25 offen nt lds
    s_add_u32 m0, s28, 4096
    s_nop 0
    buffer_load_dwordx4 v11, s[8:11], s25 offen nt lds
    s_mov_b64 s[48:49], s[78:79]
    s_mov_b64 s[52:53], s[80:81]
    s_mov_b64 s[60:61], s[84:85]
    s_mov_b64 s[64:65], s[86:87]
    s_mov_b64 s[56:57], s[88:89]
    s_mov_b64 s[46:47], s[82:83]
    s_load_dwordx2 s[42:43], s[0:1], 72
    s_add_u32 m0, s68, 0
    s_add_u32 s4, s45, 384
    v_add_u32 v141, s16, v118
    v_and_b32 v141, 3, v141
    v_lshlrev_b32 v141, 1, v141
    s_mov_b32 s54, 73728
    s_mov_b32 s55, 0x00020000
    s_mov_b32 s62, 64
    s_mov_b32 s63, 0x00020000
    s_mov_b32 s66, 128
    s_mov_b32 s67, 0x00020000
    s_mov_b32 s58, 676
    s_mov_b32 s59, 0x00020000
    s_mov_b32 s14, 0
    s_mov_b32 s15, 0x00020000
    v_mov_b32 v117, 0
    v_cmp_lt_u32 s[90:91], 7, v130
    v_mov_b32 v115, 0
    v_mov_b32 v125, 0
    v_mov_b32 v121, 0
    v_lshlrev_b32 v120, 1, v118
    v_mul_u32_u24 v114, 12, v130
    s_mul_i32 s71, s16, 192
    v_add_u32 v114, s71, v114
    v_lshlrev_b32 v124, 5, v119
    s_mul_i32 s72, s16, 8064
    s_add_u32 s72, s72, 104448
    s_mul_i32 s73, s16, 6528
    s_add_u32 s73, s73, 38912
    v_lshrrev_b32 v127, 2, v130
    v_and_b32 v123, 1, v127
    v_mul_u32_u24 v123, 0x020202, v123
    v_lshl_or_b32 v123, v123, 8, v123
    v_add_u32 v123, 0x05040100, v123
    v_and_b32 v122, 3, v130
    v_lshrrev_b32 v116, 1, v130
    v_xor_b32 v116, v116, v119
    v_mul_u32_u24 v126, 384, v130
    v_lshl_add_u32 v0, v116, 4, v126
    v_xor_b32 v1, 64, v0
    v_and_b32 v116, 2, v119
    v_add_u32 v116, v116, v119
    v_lshl_add_u32 v116, v116, 2, v127
    v_mul_u32_u24 v116, 96, v116
    v_lshl_add_u32 v116, v122, 3, v116
    v_add_u32 v128, s68, v116
    v_add_u32 v126, s69, v116
    v_add_u32 v129, s72, v116
    v_add_u32 v142, s73, v116
    v_mov_b32 v28, 0x3f803f80
    v_mov_b32 v29, 0x3f803f80
    v_mov_b32 v30, 0x3f803f80
    v_mov_b32 v31, 0x3f803f80
    v_mul_u32_u24 v146, 768, v119
    v_add_u32 v146, v114, v146
    v_add_u32 v146, 157184, v146
    s_mov_b32 s76, 0x3f80
    v_and_b32 v143, 1, v130
    v_lshlrev_b32 v143, 4, v143
    v_lshlrev_b32 v144, v143, s76
    v_mov_b32 v145, 0x3c003c00
    v_mov_b32 v44, 1.0
    v_mov_b32 v45, 1.0
    v_lshlrev_b32 v147, 4, v119
    s_mov_b32 s19, s38
    s_mov_b32 s23, s25
    s_mov_b32 s26, 0
    s_mov_b32 s27, 0
    s_mov_b32 s18, 0
    s_add_u32 s19, s19, s20
    s_add_u32 s23, s23, s21
    s_cmp_ge_u32 s19, 72
    s_cselect_b32 s34, 72, 0
    s_cselect_b32 s35, s22, 0
    s_sub_u32 s19, s19, s34
    s_add_u32 s23, s23, s35
    s_mov_b32 s24, s23
    s_add_u32 s19, s19, s20
    s_add_u32 s23, s23, s21
    s_cmp_ge_u32 s19, 72
    s_cselect_b32 s34, 72, 0
    s_cselect_b32 s35, s22, 0
    s_sub_u32 s19, s19, s34
    s_add_u32 s23, s23, s35
    s_mul_i32 s79, s16, 64
    v_lshl_add_u32 v154, v119, 4, s79
    s_mul_i32 s80, s16, 32
    s_add_u32 s80, s80, 256
    v_lshl_add_u32 v150, v119, 3, s80
    v_add_u32 v148, 0, v130
    v_mul_u32_u24 v155, 37, v148
    v_mul_u32_u24 v116, 384, v148
    v_lshrrev_b32 v155, 8, v155
    v_mad_u32_u24 v116, v155, s70, v116
    v_add_u32 v15, v116, v154
    v_add_u32 v18, v116, v150
    v_mul_u32_u24 v149, 37, v148
    v_lshrrev_b32 v149, 8, v149
    v_mul_u32_u24 v156, 7, v149
    v_sub_u32 v156, v148, v156
    v_add_u32 v153, 16, v130
    v_mul_u32_u24 v152, 37, v153
    v_mul_u32_u24 v116, 384, v153
    v_lshrrev_b32 v152, 8, v152
    v_mad_u32_u24 v116, v152, s70, v116
    v_add_u32 v16, v116, v154
    v_add_u32 v19, v116, v150
    v_mul_u32_u24 v158, 37, v153
    v_lshrrev_b32 v158, 8, v158
    v_mul_u32_u24 v157, 7, v158
    v_sub_u32 v157, v153, v157
    v_add_u32 v151, 32, v130
    v_mul_u32_u24 v116, 37, v151
    v_mul_u32_u24 v159, 384, v151
    v_lshrrev_b32 v116, 8, v116
    v_mad_u32_u24 v159, v116, s70, v159
    v_add_u32 v17, v159, v154
    v_add_u32 v20, v159, v150
    v_mul_u32_u24 v154, 37, v151
    v_lshrrev_b32 v154, 8, v154
    v_mul_u32_u24 v150, 7, v154
    v_sub_u32 v150, v151, v150
    s_mul_i32 s81, s16, 768
    s_add_u32 s81, s81, 157184
    v_mul_u32_u24 v155, 24, v155
    v_lshl_add_u32 v155, v148, 2, v155
    v_add_u32 v22, s81, v155
    v_sub_u32 v23, s81, v155
    v_sub_u32 v155, v22, v147
    v_mul_u32_u24 v152, 24, v152
    v_lshl_add_u32 v152, v153, 2, v152
    v_add_u32 v24, s81, v152
    v_sub_u32 v25, s81, v152
    v_sub_u32 v152, v24, v147
    v_mul_u32_u24 v116, 24, v116
    v_lshl_add_u32 v116, v151, 2, v116
    v_add_u32 v26, s81, v116
    v_sub_u32 v27, s81, v116
    v_sub_u32 v116, v26, v147
    v_mul_u32_u24 v160, 148, v119
    s_mov_b32 s82, -24
    v_add_u32 v159, 0, v160
    v_lshrrev_b32 v159, 8, v159
    v_mad_i32_i24 v46, v159, s82, v155
    v_mad_i32_i24 v58, v159, s82, v152
    v_mad_i32_i24 v70, v159, s82, v116
    v_add_u32 v159, 37, v160
    v_lshrrev_b32 v159, 8, v159
    v_mad_i32_i24 v47, v159, s82, v155
    v_mad_i32_i24 v59, v159, s82, v152
    v_mad_i32_i24 v71, v159, s82, v116
    v_add_u32 v159, 74, v160
    v_lshrrev_b32 v159, 8, v159
    v_mad_i32_i24 v48, v159, s82, v155
    v_mad_i32_i24 v60, v159, s82, v152
    v_mad_i32_i24 v72, v159, s82, v116
    v_add_u32 v159, 111, v160
    v_lshrrev_b32 v159, 8, v159
    v_mad_i32_i24 v49, v159, s82, v155
    v_mad_i32_i24 v61, v159, s82, v152
    v_mad_i32_i24 v73, v159, s82, v116
    v_add_u32 v159, 592, v160
    v_lshrrev_b32 v159, 8, v159
    v_mad_i32_i24 v50, v159, s82, v155
    v_mad_i32_i24 v62, v159, s82, v152
    v_mad_i32_i24 v74, v159, s82, v116
    v_add_u32 v159, 629, v160
    v_lshrrev_b32 v159, 8, v159
    v_mad_i32_i24 v51, v159, s82, v155
    v_mad_i32_i24 v63, v159, s82, v152
    v_mad_i32_i24 v75, v159, s82, v116
    v_add_u32 v159, 666, v160
    v_lshrrev_b32 v159, 8, v159
    v_mad_i32_i24 v52, v159, s82, v155
    v_mad_i32_i24 v64, v159, s82, v152
    v_mad_i32_i24 v76, v159, s82, v116
    v_add_u32 v159, 703, v160
    v_lshrrev_b32 v159, 8, v159
    v_mad_i32_i24 v53, v159, s82, v155
    v_mad_i32_i24 v65, v159, s82, v152
    v_mad_i32_i24 v77, v159, s82, v116
    v_add_u32 v159, 1184, v160
    v_lshrrev_b32 v159, 8, v159
    v_mad_i32_i24 v54, v159, s82, v155
    v_mad_i32_i24 v66, v159, s82, v152
    v_mad_i32_i24 v78, v159, s82, v116
    v_add_u32 v159, 1221, v160
    v_lshrrev_b32 v159, 8, v159
    v_mad_i32_i24 v55, v159, s82, v155
    v_mad_i32_i24 v67, v159, s82, v152
    v_mad_i32_i24 v79, v159, s82, v116
    v_add_u32 v159, 1258, v160
    v_lshrrev_b32 v159, 8, v159
    v_mad_i32_i24 v56, v159, s82, v155
    v_mad_i32_i24 v68, v159, s82, v152
    v_mad_i32_i24 v80, v159, s82, v116
    v_add_u32 v159, 1295, v160
    v_lshrrev_b32 v159, 8, v159
    v_mad_i32_i24 v57, v159, s82, v155
    v_mad_i32_i24 v69, v159, s82, v152
    v_mad_i32_i24 v81, v159, s82, v116
    v_mov_b32 v155, s81
    v_lshlrev_b32 v116, 4, v118
    v_xor_b32 v2, 65536, v116
    v_lshl_add_u32 v3, s16, 10, v116
    s_lshr_b32 s83, s16, 1
    s_and_b32 s84, s16, 1
    s_lshl_b32 s84, s84, 3
    s_lshl_b32 s85, s83, 10
    s_add_u32 s85, s85, s84
    v_add_u32 v4, s85, v116
    s_lshl_b32 s83, s83, 11
    s_add_u32 s83, s83, s84
    s_add_u32 s83, s83, 144896
    s_mul_i32 s86, s16, 2048
    s_add_u32 s86, s86, 136704
    v_lshl_add_u32 v152, v119, 3, s86
    v_mov_b32 v160, s83
    v_mov_b32 v161, 161536
    v_mul_u32_u24 v159, 80, v119
    v_add3_u32 v5, v159, v143, s72
    v_lshl_add_u32 v6, v130, 2, s73
    s_mul_i32 s87, s16, 128
    s_add_u32 s87, s87, 65024
    s_mov_b32 s40, s8
    buffer_load_dwordx4 v133, s[48:51], s4 offen lds
    v_add_u32 v9, s87, v147
    v_lshrrev_b32 v116, 1, v119
    s_mov_b32 s41, s9
    s_mov_b32 s32, 0x2a8cbccc
    buffer_load_dwordx4 v135, s[48:51], s4 offen offset:1024 lds
    v_mul_u32_u24 v116, 48, v116
    v_lshl_add_u32 v116, v119, 3, v116
    s_mov_b32 s33, 0x38fba882
    s_add_u32 s75, s28, 16384
    buffer_load_dwordx4 v137, s[48:51], s4 offen offset:2048 lds
    s_add_u32 m0, s68, 3072
    s_add_u32 s4, s45, 37248
    s_cmp_lt_u32 s16, 2
    s_cselect_b32 s29, s75, 160256
    buffer_load_dwordx4 v133, s[48:51], s4 offen lds
    v_lshl_add_u32 v116, v127, 4, v116
    v_lshl_add_u32 v116, v122, 1, v116
    s_cselect_b32 s30, 65536, 0
    s_xor_b32 s74, s29, s30
    buffer_load_dwordx4 v135, s[48:51], s4 offen offset:1024 lds
    v_add_u32 v8, s87, v116
    v_mov_b32 v37, 0
    s_lshl_b32 s92, s5, 1
    s_or_b32 s92, s92, s6
    buffer_load_dwordx4 v137, s[48:51], s4 offen offset:2048 lds
    s_add_u32 m0, s69, 0
    s_add_u32 s4, s45, 74112
    s_mul_i32 s77, s16, 64
    s_mul_i32 s78, s16, 32
    buffer_load_ushort v116, v120, s[60:63], 0 offen
    v_mov_b32 v38, 0
    s_add_u32 s78, s78, 192
    s_add_u32 s34, s18, 2
    buffer_load_dwordx3 v[182:184], v114, s[56:59], 0 offen
    v_mov_b32 v39, 0
    s_mov_b32 s27, s26
    s_mov_b32 s26, s25
    buffer_load_dwordx4 v[174:177], v124, s[64:67], 0 offen
    v_add_u32 v164, 148992, v0
    v_add_u32 v163, 148992, v1
    v_lshlrev_b32 v185, 4, v130
    v_add_u32 v185, 160256, v185
    v_mul_u32_u24 v167, 336, v130
    v_add3_u32 v167, v167, v159, s72
    v_mul_u32_u24 v166, 272, v130
    v_add3_u32 v166, v166, v147, s73
    v_mul_u32_u24 v165, 1088, v119
    v_add_u32 v165, v165, v6
    v_add_u32 v159, 5376, v167
    v_add_u32 v169, 4352, v166
    v_add_u32 v168, 4352, v165
    v_cmp_gt_u32 s[88:89], 16, v118
    v_mov_b32 v162, 0xf149f2ca
    v_add_u32 v170, 512, v254
    v_mul_u32_u24 v114, 2731, v170
    v_bfe_u32 v120, v114, 17, 3
    v_lshrrev_b32 v114, 16, v114
    v_xor_b32 v170, v120, v170
    v_mul_u32_u24 v120, 37, v114
    v_lshrrev_b32 v120, 8, v120
    v_lshlrev_b32 v170, 4, v170
    v_mad_u32_u24 v12, v120, s70, v170
    v_mul_u32_u24 v170, 37, v114
    v_lshrrev_b32 v170, 8, v170
    v_mul_u32_u24 v171, 7, v170
    v_sub_u32 v171, v114, v171
    s_add_u32 s19, s19, s20
    s_mov_b32 s18, 1
    buffer_load_dwordx4 v[198:201], v124, s[64:67], 0 offen offset:16
    v_cmp_gt_u32 vcc, 4, v170
    v_add_u32 v124, 768, v254
    v_mul_u32_u24 v114, 2731, v124
    v_cndmask_b32 v170, v138, v136, vcc
    v_cmp_gt_u32 vcc, 4, v171
    v_bfe_u32 v120, v114, 17, 3
    v_lshrrev_b32 v114, 16, v114
    v_cndmask_b32 v171, v140, v139, vcc
    v_add3_u32 v12, v12, v170, v171
    v_xor_b32 v124, v120, v124
    v_mul_u32_u24 v120, 37, v114
    v_lshrrev_b32 v120, 8, v120
    v_lshlrev_b32 v124, 4, v124
    v_mad_u32_u24 v13, v120, s70, v124
    v_mul_u32_u24 v120, 37, v114
    v_lshrrev_b32 v120, 8, v120
    v_mul_u32_u24 v170, 7, v120
    v_sub_u32 v170, v114, v170
    v_cmp_gt_u32 vcc, 4, v120
    v_add_u32 v114, 1024, v254
    v_mul_u32_u24 v124, 2731, v114
    v_cndmask_b32 v120, v138, v136, vcc
    v_cmp_gt_u32 vcc, 4, v170
    v_bfe_u32 v254, v124, 17, 3
    v_lshrrev_b32 v124, 16, v124
    v_cndmask_b32 v170, v140, v139, vcc
    v_add3_u32 v13, v13, v120, v170
    v_xor_b32 v114, v254, v114
    v_mul_u32_u24 v254, 37, v124
    v_lshrrev_b32 v254, 8, v254
    v_lshlrev_b32 v114, 4, v114
    v_mad_u32_u24 v14, v254, s70, v114
    v_mul_u32_u24 v120, 37, v124
    v_lshrrev_b32 v120, 8, v120
    v_mul_u32_u24 v114, 7, v120
    v_sub_u32 v114, v124, v114
    v_cmp_gt_u32 vcc, 4, v120
    v_mov_b32 v254, 0xc31044fe
    v_mul_u32_u24 v170, 37, v148
    v_cndmask_b32 v120, v138, v136, vcc
    v_cmp_gt_u32 vcc, 4, v114
    v_lshrrev_b32 v170, 8, v170
    v_mul_u32_u24 v171, 7, v170
    v_cndmask_b32 v114, v140, v139, vcc
    v_add3_u32 v14, v14, v120, v114
    v_cmp_gt_u32 vcc, 48, v124
    v_sub_u32 v171, v148, v171
    global_load_ushort v141, v141, s[46:47]
    s_waitcnt vmcnt(10)
    s_barrier
    v_cndmask_b32 v14, v255, v14, vcc
    v_cmp_gt_u32 vcc, 2, v122
    v_lshrrev_b32 v170, 2, v170
    v_lshrrev_b32 v171, 2, v171
    v_cndmask_b32 v32, 0, v144, vcc
    v_cndmask_b32 v33, v144, 0, vcc
    v_cndmask_b32 v34, 0, v144, vcc
    v_cndmask_b32 v35, v144, 0, vcc
    v_cmp_eq_u32 vcc, 0, v143
    v_and_b32 v170, s5, v170
    v_and_b32 v171, s6, v171
    v_cndmask_b32 v40, 0, v145, vcc
    buffer_load_dwordx4 v133, s[48:51], s4 offen lds
    v_cndmask_b32 v41, v145, 0, vcc
    v_cndmask_b32 v42, 0, v145, vcc
    v_cndmask_b32 v43, v145, 0, vcc
    v_cmp_eq_u32 vcc, v119, v127
    v_lshl_or_b32 v170, v170, 1, v171
    v_mul_u32_u24 v255, 37, v153
    v_cndmask_b32 v144, 0, v32, vcc
    v_cndmask_b32 v145, 0, v33, vcc
    v_lshrrev_b32 v255, 8, v255
    v_mul_u32_u24 v114, 7, v255
    v_sub_u32 v114, v153, v114
    v_lshrrev_b32 v255, 2, v255
    v_lshrrev_b32 v114, 2, v114
    v_and_b32 v255, s5, v255
    buffer_load_dwordx4 v135, s[48:51], s4 offen offset:1024 lds
    s_waitcnt vmcnt(10)
    ds_read_b64_tr_b16 a[72:73], v128 offset:0
    ds_read_b64_tr_b16 a[74:75], v128 offset:768
    ds_read_b64_tr_b16 a[96:97], v128 offset:32
    ds_read_b64_tr_b16 a[98:99], v128 offset:800
    ds_read_b64_tr_b16 a[120:121], v128 offset:64
    ds_read_b64_tr_b16 a[122:123], v128 offset:832
    v_and_b32 v114, s6, v114
    v_lshl_or_b32 v255, v255, 1, v114
    v_mul_u32_u24 v171, 37, v151
    v_lshrrev_b32 v171, 8, v171
    v_mul_u32_u24 v114, 7, v171
    v_sub_u32 v114, v151, v114
    v_lshrrev_b32 v171, 2, v171
    buffer_load_dwordx4 v137, s[48:51], s4 offen offset:2048 lds
    s_add_u32 m0, s69, 3072
    s_add_u32 s4, s45, 110976
    v_lshrrev_b32 v114, 2, v114
    v_and_b32 v171, s5, v171
    v_and_b32 v114, s6, v114
    v_lshl_or_b32 v171, v171, 1, v114
    v_mul_u32_u24 v120, 6, v131
    v_sub_u32 v124, v118, v120
    v_mul_u32_u24 v120, 384, v131
    v_lshl_add_u32 v120, v124, 4, v120
    v_add_u32 v114, s78, v120
    v_add_u32 v120, s77, v120
    v_cmp_gt_i32 vcc, 4, v124
    v_mul_u32_u24 v124, 6, v132
    buffer_load_dwordx4 v133, s[48:51], s4 offen lds
    v_cndmask_b32 v143, v114, v120, vcc
    v_sub_u32 v120, v118, v124
    v_mul_u32_u24 v124, 384, v132
    v_lshl_add_u32 v124, v120, 4, v124
    v_add_u32 v114, s78, v124
    v_add_u32 v124, s77, v124
    v_cmp_gt_i32 vcc, -60, v120
    v_mul_u32_u24 v131, 6, v134
    v_sub_u32 v148, v118, v131
    v_cndmask_b32 v132, v114, v124, vcc
    v_mul_u32_u24 v131, 384, v134
    v_lshl_add_u32 v131, v148, 4, v131
    s_waitcnt vmcnt(9)
    ds_read_b64_tr_b16 a[76:77], v128 offset:3072
    ds_read_b64_tr_b16 a[78:79], v128 offset:3840
    s_waitcnt vmcnt(7)
    buffer_load_dwordx4 v135, s[48:51], s4 offen offset:1024 lds
    s_waitcnt vmcnt(7)
    s_waitcnt vmcnt(6)
    ds_read_b64_tr_b16 a[100:101], v128 offset:3104
    ds_read_b64_tr_b16 a[102:103], v128 offset:3872
    ds_read_b64_tr_b16 a[124:125], v128 offset:3136
    ds_read_b64_tr_b16 a[126:127], v128 offset:3904
    v_cndmask_b32 v174, v174, v175, s[90:91]
    v_cndmask_b32 v176, v176, v177, s[90:91]
    v_perm_b32 v172, v176, v174, v123
    v_cndmask_b32 v198, v198, v199, s[90:91]
    v_cndmask_b32 v200, v200, v201, s[90:91]
    v_perm_b32 v173, v200, v198, v123
    v_bfe_u32 v114, v182, v147, 16
    v_bfe_u32 v124, v183, v147, 16
    buffer_load_dwordx4 v137, s[48:51], s4 offen offset:2048 lds
    v_mfma_f32_16x16x16_bf16 v[174:177], v[116:117], v[114:115], 0
    v_bfe_u32 v120, v184, v147, 16
    v_add_u32 v151, s78, v131
    v_add_u32 v131, s77, v131
    v_mfma_f32_16x16x16_bf16 v[198:201], v[116:117], v[124:125], 0
    v_cmp_gt_i32 vcc, -124, v148
    v_mul_u32_u24 v148, 96, v130
    v_add3_u32 v134, v148, v147, s68
    v_mfma_f32_16x16x16_bf16 v[210:213], v[116:117], v[120:121], 0
    s_add_u32 m0, s72, 0
    s_add_u32 s4, s45, 147840
    v_max_f32 v174, 0, v174
    v_max_f32 v175, 0, v175
    v_max_f32 v176, 0, v176
    buffer_load_dwordx4 v133, s[48:51], s4 offen lds
    s_waitcnt vmcnt(7)
    v_max_f32 v177, 0, v177
    v_cvt_pk_bf16_f32 v120, v174, v175
    v_cvt_pk_bf16_f32 v121, v176, v177
    v_max_f32 v198, 0, v198
    v_max_f32 v199, 0, v199
    v_mfma_f32_16x16x16_bf16 v[114:117], v[172:173], v[120:121], 0
    v_max_f32 v200, 0, v200
    v_max_f32 v201, 0, v201
    v_cvt_pk_bf16_f32 v120, v198, v199
    v_cvt_pk_bf16_f32 v121, v200, v201
    v_max_f32 v210, 0, v210
    v_max_f32 v211, 0, v211
    v_mfma_f32_16x16x16_bf16 v[174:177], v[172:173], v[120:121], 0
    buffer_load_dwordx4 v135, s[48:51], s4 offen offset:1024 lds
    v_cvt_pk_bf16_f32 v114, v114, v114
    v_and_b32 v114, 0xffff0000, v114
    v_mul_f32 v114, 0xbfb8aa3b, v114
    v_exp_f32 v114, v114
    v_max_f32 v212, 0, v212
    v_add_f32 v114, 1.0, v114
    v_rcp_f32 v114, v114
    v_cvt_pk_bf16_f32 v174, v174, v174
    v_cvt_pk_bf16_f32 v114, v114, v114
    v_and_b32 v114, 0xffff0000, v114
    v_add_f32 v114, -0.5, v114
    v_mul_f32 v114, 0x41b8aa3b, v114
    buffer_load_dwordx4 v137, s[48:51], s4 offen offset:2048 lds
    ds_write_b32 v146, v114 offset:0
    s_add_u32 m0, s72, 3072
    s_add_u32 s4, s45, 184704
    v_and_b32 v174, 0xffff0000, v174
    v_mul_f32 v174, 0xbfb8aa3b, v174
    v_exp_f32 v174, v174
    v_max_f32 v213, 0, v213
    v_add_f32 v174, 1.0, v174
    v_rcp_f32 v174, v174
    v_cvt_pk_bf16_f32 v210, v210, v211
    v_cvt_pk_bf16_f32 v174, v174, v174
    s_waitcnt vmcnt(6)
    buffer_load_dwordx4 v133, s[48:51], s4 offen lds
    ds_read_b64_tr_b16 a[80:81], v126 offset:0
    ds_read_b64_tr_b16 a[82:83], v126 offset:768
    ds_read_b64_tr_b16 a[104:105], v126 offset:32
    ds_read_b64_tr_b16 a[106:107], v126 offset:800
    ds_read_b64_tr_b16 a[128:129], v126 offset:64
    ds_read_b64_tr_b16 a[130:131], v126 offset:832
    v_and_b32 v174, 0xffff0000, v174
    v_add_f32 v174, -0.5, v174
    v_mul_f32 v174, 0x41b8aa3b, v174
    ds_write_b32 v146, v174 offset:4
    v_cvt_pk_bf16_f32 v211, v212, v213
    buffer_load_dwordx4 v135, s[48:51], s4 offen offset:1024 lds
    v_lshlrev_b32 v141, 16, v141
    v_mfma_f32_16x16x16_bf16 v[114:117], v[172:173], v[210:211], 0
    v_max_f32 v141, 0xc2c80000, v141
    v_min_f32 v141, 0x40930000, v141
    v_mul_f32 v141, 0x3fb8aa3b, v141
    v_exp_f32 v141, v141
    v_cndmask_b32 v118, v151, v131, vcc
    v_cvt_pk_bf16_f32 v141, v141, v141
    v_and_b32 v141, 0xffff0000, v141
    v_mul_f32 v131, 0x3fb8aa3b, v141
    v_cvt_pk_bf16_f32 v114, v114, v114
    v_and_b32 v114, 0xffff0000, v114
    v_mul_f32 v114, 0xbfb8aa3b, v114
    buffer_load_dwordx4 v137, s[48:51], s4 offen offset:2048 lds
    s_add_u32 m0, s73, 0
    s_add_u32 s4, s45, 36864
    v_exp_f32 v114, v114
    v_readfirstlane_b32 s37, v141
    v_add_f32 v114, 1.0, v114
    v_rcp_f32 v114, v114
    v_readfirstlane_b32 s31, v131
    v_cvt_pk_bf16_f32 v114, v114, v114
    v_and_b32 v114, 0xffff0000, v114
    v_add_f32 v114, -0.5, v114
    v_mul_f32 v114, 0x41b8aa3b, v114
    ds_write_b32 v146, v114 offset:8
    s_waitcnt vmcnt(6)
    buffer_load_dwordx4 v133, s[48:51], s45 offen lds
    v_cmp_gt_u32 vcc, 4, v149
    ds_read_b64_tr_b16 a[84:85], v126 offset:3072
    ds_read_b64_tr_b16 a[86:87], v126 offset:3840
    ds_read_b64_tr_b16 a[108:109], v126 offset:3104
    ds_read_b64_tr_b16 a[110:111], v126 offset:3872
    ds_read_b64_tr_b16 a[132:133], v126 offset:3136
    ds_read_b64_tr_b16 a[134:135], v126 offset:3904
    v_cndmask_b32 v149, v138, v136, vcc
    v_cmp_gt_u32 vcc, 4, v156
    v_lshl_add_u32 v120, v119, 3, v148
    v_add3_u32 v120, v120, 64, s68
    v_cndmask_b32 v156, v140, v139, vcc
    buffer_load_dwordx4 v135, s[48:51], s45 offen offset:1024 lds
    v_add3_u32 v15, v15, v149, v156
    v_add3_u32 v18, v18, v149, v156
    v_cmp_gt_u32 vcc, 4, v158
    v_add3_u32 v131, v148, v147, s69
    v_lshl_add_u32 v121, v119, 3, v148
    s_waitcnt lgkmcnt(6)
    s_barrier
    ds_read_b32 v22, v22 offset:0
    ds_read_b32 v23, v23 offset:672
    ds_read_b32 v24, v24 offset:0
    ds_read_b32 v25, v25 offset:672
    ds_read_b32 v26, v26 offset:0
    ds_read_b32 v27, v27 offset:672
    ds_read_b32 v46, v46 offset:336
    ds_read_b32 v58, v58 offset:336
    buffer_load_dwordx4 v137, s[48:51], s45 offen offset:2048 lds
    ds_read_b32 v70, v70 offset:336
    ds_read_b32 v47, v47 offset:332
    ds_read_b32 v59, v59 offset:332
    s_add_u32 m0, s73, 3072
    ds_read_b32 v71, v71 offset:332
    v_cndmask_b32 v158, v138, v136, vcc
    v_cmp_gt_u32 vcc, 4, v157
    ds_read_b32 v48, v48 offset:328
    ds_read_b32 v60, v60 offset:328
    ds_read_b32 v72, v72 offset:328
    ds_read_b32 v49, v49 offset:324
    s_waitcnt vmcnt(6)
    ds_read_b64_tr_b16 a[88:89], v129 offset:0
    buffer_load_dwordx4 v133, s[48:51], s4 offen lds
    ds_read_b64_tr_b16 a[90:91], v129 offset:768
    ds_read_b64_tr_b16 a[112:113], v129 offset:32
    ds_read_b64_tr_b16 a[114:115], v129 offset:800
    ds_read_b64_tr_b16 a[136:137], v129 offset:64
    ds_read_b64_tr_b16 a[138:139], v129 offset:832
    v_cndmask_b32 v157, v140, v139, vcc
    v_add3_u32 v16, v16, v158, v157
    v_add3_u32 v19, v19, v158, v157
    v_cmp_gt_u32 vcc, 4, v154
    ds_read_b32 v61, v61 offset:324
    ds_read_b32 v73, v73 offset:324
    ds_read_b32 v50, v50 offset:272
    buffer_load_dwordx4 v135, s[48:51], s4 offen offset:1024 lds
    ds_read_b32 v62, v62 offset:272
    ds_read_b32 v74, v74 offset:272
    ds_read_b32 v51, v51 offset:268
    ds_read_b32 v63, v63 offset:268
    ds_read_b32 v75, v75 offset:268
    v_cndmask_b32 v154, v138, v136, vcc
    v_cmp_gt_u32 vcc, 4, v150
    ds_read_b32 v52, v52 offset:264
    ds_read_b32 v64, v64 offset:264
    ds_read_b32 v76, v76 offset:264
    ds_read_b32 v53, v53 offset:260
    v_cndmask_b32 v150, v140, v139, vcc
    buffer_load_dwordx4 v137, s[48:51], s4 offen offset:2048 lds
    ds_read_b32 v65, v65 offset:260
    ds_read_b32 v77, v77 offset:260
    ds_read_b32 v54, v54 offset:208
    ds_read_b32 v66, v66 offset:208
    ds_read_b32 v78, v78 offset:208
    s_add_u32 m0, s68, 0
    ds_read_b32 v55, v55 offset:204
    s_add_u32 s4, s45, 73728
    ds_read_b32 v67, v67 offset:204
    v_add3_u32 v17, v17, v154, v150
    v_add3_u32 v20, v20, v154, v150
    v_cmp_gt_u32 vcc, 2, v119
    ds_read_b32 v79, v79 offset:204
    s_waitcnt vmcnt(6)
    buffer_load_dwordx4 v133, s[48:51], s4 offen lds
    ds_read_b64_tr_b16 a[92:93], v129 offset:3072
    ds_read_b64_tr_b16 a[94:95], v129 offset:3840
    ds_read_b64_tr_b16 a[116:117], v129 offset:3104
    ds_read_b64_tr_b16 a[118:119], v129 offset:3872
    ds_read_b64_tr_b16 a[140:141], v129 offset:3136
    ds_read_b64_tr_b16 a[142:143], v129 offset:3904
    ds_read_b32 v56, v56 offset:200
    v_cndmask_b32 v152, v160, v152, vcc
    v_lshl_add_u32 v152, v127, 9, v152
    v_lshl_add_u32 v152, v122, 1, v152
    v_cmp_gt_u32 vcc, 3, v119
    ds_read_b32 v68, v68 offset:200
    ds_read_b32 v80, v80 offset:200
    ds_read_b32 v57, v57 offset:196
    buffer_load_dwordx4 v135, s[48:51], s4 offen offset:1024 lds
    ds_read_b32 v69, v69 offset:196
    ds_read_b32 v81, v81 offset:196
    ds_read_b32 v155, v155 offset:336
    v_cndmask_b32 v7, v161, v152, vcc
    v_cmp_gt_u32 vcc, 8, v130
    v_lshl_add_u32 v130, v119, 2, 0
    v_mul_u32_u24 v129, 37, v130
    v_cndmask_b32 v159, v185, v159, vcc
    v_cndmask_b32 v169, v185, v169, vcc
    v_cmp_gt_u32 vcc, 2, v119
    v_lshrrev_b32 v129, 8, v129
    v_mul_u32_u24 v127, 7, v129
    v_cndmask_b32 v168, v185, v168, vcc
    v_cmp_ne_u32 vcc, s92, v170
    buffer_load_dwordx4 v137, s[48:51], s4 offen offset:2048 lds
    s_add_u32 m0, s68, 3072
    s_add_u32 s4, s45, 110592
    v_cndmask_b32 v136, 0, v254, vcc
    s_waitcnt lgkmcnt(6)
    v_add_f32 v22, v22, v136
    v_cmp_ne_u32 vcc, s92, v170
    v_sub_u32 v127, v130, v127
    v_lshrrev_b32 v129, 2, v129
    v_cndmask_b32 v130, 0, v254, vcc
    v_add_f32 v23, v23, v130
    v_cmp_ne_u32 vcc, s92, v255
    v_lshrrev_b32 v127, 2, v127
    s_waitcnt lgkmcnt(0)
    v_readfirstlane_b32 s39, v155
    buffer_load_dwordx4 v133, s[48:51], s4 offen lds
    s_waitcnt vmcnt(7)
    ds_read_b64_tr_b16 a[0:1], v142 offset:0
    ds_read_b64_tr_b16 a[2:3], v142 offset:768
    ds_read_b64_tr_b16 a[24:25], v142 offset:32
    ds_read_b64_tr_b16 a[26:27], v142 offset:800
    ds_read_b64_tr_b16 a[48:49], v142 offset:64
    ds_read_b64_tr_b16 a[50:51], v142 offset:832
    v_cndmask_b32 v130, 0, v254, vcc
    v_add_f32 v24, v24, v130
    v_cmp_ne_u32 vcc, s92, v255
    v_and_b32 v129, s5, v129
    v_and_b32 v127, s6, v127
    v_cndmask_b32 v130, 0, v254, vcc
    v_add_f32 v25, v25, v130
    buffer_load_dwordx4 v135, s[48:51], s4 offen offset:1024 lds
    v_cmp_ne_u32 vcc, s92, v171
    v_lshl_or_b32 v129, v129, 1, v127
    v_lshl_add_u32 v127, v119, 2, 1
    v_cndmask_b32 v130, 0, v254, vcc
    v_add_f32 v26, v26, v130
    v_cmp_ne_u32 vcc, s92, v171
    v_mul_u32_u24 v130, 37, v127
    v_lshrrev_b32 v130, 8, v130
    v_cndmask_b32 v136, 0, v254, vcc
    v_add_f32 v27, v27, v136
    v_cmp_ne_u32 vcc, v129, v170
    v_mul_u32_u24 v136, 7, v130
    v_sub_u32 v136, v127, v136
    v_cndmask_b32 v127, 0, v254, vcc
    buffer_load_dwordx4 v137, s[48:51], s4 offen offset:2048 lds
    s_add_u32 m0, s69, 0
    s_add_u32 s4, s45, 147456
    v_add_f32 v46, v46, v127
    v_cmp_ne_u32 vcc, v129, v255
    v_lshrrev_b32 v130, 2, v130
    v_lshrrev_b32 v136, 2, v136
    v_cndmask_b32 v127, 0, v254, vcc
    v_add_f32 v58, v58, v127
    v_cmp_ne_u32 vcc, v129, v171
    v_and_b32 v130, s5, v130
    v_and_b32 v136, s6, v136
    v_cndmask_b32 v127, 0, v254, vcc
    v_add_f32 v70, v70, v127
    v_lshl_or_b32 v130, v130, 1, v136
    buffer_load_dwordx4 v133, s[48:51], s4 offen lds
    s_waitcnt vmcnt(7)
    ds_read_b64_tr_b16 a[4:5], v142 offset:3072
    ds_read_b64_tr_b16 a[6:7], v142 offset:3840
    ds_read_b64_tr_b16 a[28:29], v142 offset:3104
    ds_read_b64_tr_b16 a[30:31], v142 offset:3872
    ds_read_b64_tr_b16 a[52:53], v142 offset:3136
    ds_read_b64_tr_b16 a[54:55], v142 offset:3904
    v_cmp_ne_u32 vcc, v130, v170
    v_lshl_add_u32 v136, v119, 2, 2
    v_mul_u32_u24 v142, 37, v136
    v_cndmask_b32 v127, 0, v254, vcc
    v_add_f32 v47, v47, v127
    v_cmp_ne_u32 vcc, v130, v255
    v_lshrrev_b32 v142, 8, v142
    buffer_load_dwordx4 v135, s[48:51], s4 offen offset:1024 lds
    v_cndmask_b32 v127, 0, v254, vcc
    v_add_f32 v59, v59, v127
    v_cmp_ne_u32 vcc, v130, v171
    v_mul_u32_u24 v127, 7, v142
    v_sub_u32 v127, v136, v127
    v_cndmask_b32 v130, 0, v254, vcc
    v_add_f32 v71, v71, v130
    v_lshrrev_b32 v142, 2, v142
    v_lshrrev_b32 v127, 2, v127
    v_and_b32 v142, s5, v142
    v_and_b32 v127, s6, v127
    v_lshl_or_b32 v142, v142, 1, v127
    v_cmp_ne_u32 vcc, v142, v170
    v_lshl_add_u32 v130, v119, 2, 3
    buffer_load_dwordx4 v137, s[48:51], s4 offen offset:2048 lds
    s_add_u32 m0, s69, 3072
    s_add_u32 s4, s45, 184320
    v_cndmask_b32 v136, 0, v254, vcc
    v_add_f32 v48, v48, v136
    v_cmp_ne_u32 vcc, v142, v255
    v_mul_u32_u24 v127, 37, v130
    v_lshrrev_b32 v127, 8, v127
    v_cndmask_b32 v136, 0, v254, vcc
    v_add_f32 v60, v60, v136
    v_cmp_ne_u32 vcc, v142, v171
    v_mul_u32_u24 v129, 7, v127
    v_sub_u32 v129, v130, v129
    v_cndmask_b32 v130, 0, v254, vcc
    v_add_f32 v72, v72, v130
    buffer_load_dwordx4 v133, s[48:51], s4 offen lds
    s_waitcnt vmcnt(7)
    ds_read_b64_tr_b16 a[8:9], v128 offset:0
    ds_read_b64_tr_b16 a[10:11], v128 offset:768
    ds_read_b64_tr_b16 a[32:33], v128 offset:32
    ds_read_b64_tr_b16 a[34:35], v128 offset:800
    ds_read_b64_tr_b16 a[56:57], v128 offset:64
    ds_read_b64_tr_b16 a[58:59], v128 offset:832
    v_lshrrev_b32 v127, 2, v127
    v_lshrrev_b32 v129, 2, v129
    v_and_b32 v127, s5, v127
    v_and_b32 v129, s6, v129
    v_lshl_or_b32 v127, v127, 1, v129
    v_cmp_ne_u32 vcc, v127, v170
    v_lshl_add_u32 v130, v119, 2, 16
    buffer_load_dwordx4 v135, s[48:51], s4 offen offset:1024 lds
    v_cndmask_b32 v129, 0, v254, vcc
    v_add_f32 v49, v49, v129
    v_cmp_ne_u32 vcc, v127, v255
    v_mul_u32_u24 v142, 37, v130
    v_lshrrev_b32 v142, 8, v142
    v_cndmask_b32 v129, 0, v254, vcc
    v_add_f32 v61, v61, v129
    v_cmp_ne_u32 vcc, v127, v171
    v_mul_u32_u24 v136, 7, v142
    v_sub_u32 v136, v130, v136
    v_cndmask_b32 v130, 0, v254, vcc
    v_add_f32 v73, v73, v130
    v_lshrrev_b32 v142, 2, v142
    v_lshrrev_b32 v136, 2, v136
    buffer_load_dwordx4 v137, s[48:51], s4 offen offset:2048 lds
    s_add_u32 m0, s68, 0
    s_add_u32 s4, s45, 768
    s_waitcnt lgkmcnt(0)
    v_and_b32 v142, s5, v142
    v_and_b32 v136, s6, v136
    v_lshl_or_b32 v142, v142, 1, v136
    v_cmp_ne_u32 vcc, v142, v170
    v_lshl_add_u32 v127, v119, 2, 17
    v_mul_u32_u24 v130, 37, v127
    v_cndmask_b32 v136, 0, v254, vcc
    v_add_f32 v50, v50, v136
    v_cmp_ne_u32 vcc, v142, v255
    v_lshrrev_b32 v130, 8, v130
    v_mul_u32_u24 v136, 7, v130
    buffer_load_dwordx4 v133, s[48:51], s4 offen lds
    s_waitcnt vmcnt(7)
    ds_read_b64_tr_b16 a[12:13], v128 offset:3072
    ds_read_b64_tr_b16 a[14:15], v128 offset:3840
    ds_read_b64_tr_b16 a[36:37], v128 offset:3104
    ds_read_b64_tr_b16 a[38:39], v128 offset:3872
    ds_read_b64_tr_b16 a[60:61], v128 offset:3136
    ds_read_b64_tr_b16 a[62:63], v128 offset:3904
    v_cndmask_b32 v129, 0, v254, vcc
    v_add_f32 v62, v62, v129
    v_cmp_ne_u32 vcc, v142, v171
    v_sub_u32 v136, v127, v136
    v_lshrrev_b32 v130, 2, v130
    v_cndmask_b32 v142, 0, v254, vcc
    v_add_f32 v74, v74, v142
    buffer_load_dwordx4 v135, s[48:51], s4 offen offset:1024 lds
    v_lshrrev_b32 v136, 2, v136
    v_and_b32 v130, s5, v130
    v_and_b32 v136, s6, v136
    v_lshl_or_b32 v130, v130, 1, v136
    v_cmp_ne_u32 vcc, v130, v170
    v_lshl_add_u32 v127, v119, 2, 18
    v_mul_u32_u24 v142, 37, v127
    v_cndmask_b32 v136, 0, v254, vcc
    v_add_f32 v51, v51, v136
    v_cmp_ne_u32 vcc, v130, v255
    v_lshrrev_b32 v142, 8, v142
    v_mul_u32_u24 v129, 7, v142
    v_cndmask_b32 v136, 0, v254, vcc
    v_add_f32 v63, v63, v136
    buffer_load_dwordx4 v137, s[48:51], s4 offen offset:2048 lds
    s_add_u32 m0, s68, 3072
    s_add_u32 s4, s45, 37632
    s_waitcnt lgkmcnt(0)
    v_cmp_ne_u32 vcc, v130, v171
    v_sub_u32 v129, v127, v129
    v_lshrrev_b32 v142, 2, v142
    v_cndmask_b32 v130, 0, v254, vcc
    v_add_f32 v75, v75, v130
    v_lshrrev_b32 v129, 2, v129
    v_and_b32 v142, s5, v142
    v_and_b32 v129, s6, v129
    v_lshl_or_b32 v142, v142, 1, v129
    v_cmp_ne_u32 vcc, v142, v170
    v_lshl_add_u32 v136, v119, 2, 19
    buffer_load_dwordx4 v133, s[48:51], s4 offen lds
    s_waitcnt vmcnt(7)
    ds_read_b64_tr_b16 a[16:17], v126 offset:0
    ds_read_b64_tr_b16 a[18:19], v126 offset:768
    ds_read_b64_tr_b16 a[40:41], v126 offset:32
    ds_read_b64_tr_b16 a[42:43], v126 offset:800
    ds_read_b64_tr_b16 a[64:65], v126 offset:64
    ds_read_b64_tr_b16 a[66:67], v126 offset:832
    v_cndmask_b32 v130, 0, v254, vcc
    v_add_f32 v52, v52, v130
    v_cmp_ne_u32 vcc, v142, v255
    v_mul_u32_u24 v127, 37, v136
    v_lshrrev_b32 v127, 8, v127
    v_cndmask_b32 v130, 0, v254, vcc
    v_add_f32 v64, v64, v130
    buffer_load_dwordx4 v135, s[48:51], s4 offen offset:1024 lds
    v_cmp_ne_u32 vcc, v142, v171
    v_mul_u32_u24 v130, 7, v127
    v_sub_u32 v130, v136, v130
    v_cndmask_b32 v136, 0, v254, vcc
    v_add_f32 v76, v76, v136
    v_lshrrev_b32 v127, 2, v127
    v_lshrrev_b32 v130, 2, v130
    v_and_b32 v127, s5, v127
    v_and_b32 v130, s6, v130
    v_lshl_or_b32 v127, v127, 1, v130
    v_cmp_ne_u32 vcc, v127, v170
    v_lshl_add_u32 v130, v119, 2, 32
    v_mul_u32_u24 v142, 37, v130
    v_cndmask_b32 v136, 0, v254, vcc
    buffer_load_dwordx4 v137, s[48:51], s4 offen offset:2048 lds
    s_add_u32 m0, s69, 0
    s_add_u32 s4, s45, 74496
    s_waitcnt lgkmcnt(0)
    v_add_f32 v53, v53, v136
    v_cmp_ne_u32 vcc, v127, v255
    v_lshrrev_b32 v142, 8, v142
    v_mul_u32_u24 v136, 7, v142
    v_cndmask_b32 v129, 0, v254, vcc
    v_add_f32 v65, v65, v129
    v_cmp_ne_u32 vcc, v127, v171
    v_sub_u32 v136, v130, v136
    v_lshrrev_b32 v142, 2, v142
    v_cndmask_b32 v130, 0, v254, vcc
    v_add_f32 v77, v77, v130
    buffer_load_dwordx4 v133, s[48:51], s4 offen lds
    s_waitcnt vmcnt(7)
    ds_read_b64_tr_b16 a[20:21], v126 offset:3072
    ds_read_b64_tr_b16 a[22:23], v126 offset:3840
    ds_read_b64_tr_b16 a[44:45], v126 offset:3104
    ds_read_b64_tr_b16 a[46:47], v126 offset:3872
    ds_read_b64_tr_b16 a[68:69], v126 offset:3136
    ds_read_b64_tr_b16 a[70:71], v126 offset:3904
    v_lshrrev_b32 v136, 2, v136
    v_and_b32 v142, s5, v142
    v_and_b32 v136, s6, v136
    v_lshl_or_b32 v142, v142, 1, v136
    v_cmp_ne_u32 vcc, v142, v170
    v_lshl_add_u32 v130, v119, 2, 33
    v_mul_u32_u24 v136, 37, v130
    buffer_load_dwordx4 v135, s[48:51], s4 offen offset:1024 lds
    v_cndmask_b32 v127, 0, v254, vcc
    v_add_f32 v54, v54, v127
    v_cmp_ne_u32 vcc, v142, v255
    v_lshrrev_b32 v136, 8, v136
    v_mul_u32_u24 v127, 7, v136
    v_cndmask_b32 v129, 0, v254, vcc
    v_add_f32 v66, v66, v129
    v_cmp_ne_u32 vcc, v142, v171
    v_sub_u32 v127, v130, v127
    v_lshrrev_b32 v136, 2, v136
    v_cndmask_b32 v129, 0, v254, vcc
    v_add_f32 v78, v78, v129
    v_lshrrev_b32 v127, 2, v127
    v_and_b32 v136, s5, v136
    buffer_load_dwordx4 v137, s[48:51], s4 offen offset:2048 lds
    s_add_u32 m0, s69, 3072
    s_add_u32 s4, s45, 111360
    s_waitcnt lgkmcnt(0)
    v_and_b32 v127, s6, v127
    v_lshl_or_b32 v136, v136, 1, v127
    v_cmp_ne_u32 vcc, v136, v170
    v_lshl_add_u32 v130, v119, 2, 34
    v_mul_u32_u24 v129, 37, v130
    v_cndmask_b32 v127, 0, v254, vcc
    v_add_f32 v55, v55, v127
    v_cmp_ne_u32 vcc, v136, v255
    v_lshrrev_b32 v129, 8, v129
    v_mul_u32_u24 v142, 7, v129
    v_cndmask_b32 v127, 0, v254, vcc
    buffer_load_dwordx4 v133, s[48:51], s4 offen lds
    s_waitcnt vmcnt(7)
    ds_read_b64_tr_b16 a[144:145], v128 offset:0
    ds_read_b64_tr_b16 a[146:147], v128 offset:768
    ds_read_b64_tr_b16 a[168:169], v128 offset:32
    ds_read_b64_tr_b16 a[170:171], v128 offset:800
    ds_read_b64_tr_b16 a[192:193], v128 offset:64
    ds_read_b64_tr_b16 a[194:195], v128 offset:832
    v_add_f32 v67, v67, v127
    v_cmp_ne_u32 vcc, v136, v171
    v_sub_u32 v142, v130, v142
    v_lshrrev_b32 v129, 2, v129
    v_cndmask_b32 v127, 0, v254, vcc
    v_add_f32 v79, v79, v127
    v_lshrrev_b32 v142, 2, v142
    buffer_load_dwordx4 v135, s[48:51], s4 offen offset:1024 lds
    v_and_b32 v129, s5, v129
    v_and_b32 v142, s6, v142
    v_lshl_or_b32 v129, v129, 1, v142
    v_cmp_ne_u32 vcc, v129, v170
    v_lshl_add_u32 v130, v119, 2, 35
    v_mul_u32_u24 v119, 37, v130
    v_cndmask_b32 v127, 0, v254, vcc
    v_add_f32 v56, v56, v127
    v_cmp_ne_u32 vcc, v129, v255
    v_lshrrev_b32 v119, 8, v119
    v_mul_u32_u24 v136, 7, v119
    v_cndmask_b32 v127, 0, v254, vcc
    v_add_f32 v68, v68, v127
    v_cmp_ne_u32 vcc, v129, v171
    buffer_load_dwordx4 v137, s[48:51], s4 offen offset:2048 lds
    s_add_u32 m0, s68, 0
    s_add_u32 s4, s45, 148224
    s_waitcnt lgkmcnt(0)
    v_cndmask_b32 v142, 0, v254, vcc
    v_add_f32 v80, v80, v142
    v_sub_u32 v136, v130, v136
    v_lshrrev_b32 v119, 2, v119
    v_lshrrev_b32 v136, 2, v136
    v_and_b32 v119, s5, v119
    v_and_b32 v136, s6, v136
    v_lshl_or_b32 v119, v119, 1, v136
    v_cmp_ne_u32 vcc, v119, v170
    v_cndmask_b32 v22, v162, v22, s[88:89]
    v_cndmask_b32 v24, v162, v24, s[88:89]
    buffer_load_dwordx4 v133, s[48:51], s4 offen lds
    s_waitcnt vmcnt(7)
    ds_read_b64_tr_b16 a[148:149], v128 offset:3072
    ds_read_b64_tr_b16 a[150:151], v128 offset:3840
    ds_read_b64_tr_b16 a[172:173], v128 offset:3104
    ds_read_b64_tr_b16 a[174:175], v128 offset:3872
    ds_read_b64_tr_b16 a[196:197], v128 offset:3136
    ds_read_b64_tr_b16 a[198:199], v128 offset:3904
    v_cndmask_b32 v130, 0, v254, vcc
    v_add_f32 v57, v57, v130
    v_cmp_ne_u32 vcc, v119, v255
    v_cndmask_b32 v26, v162, v26, s[88:89]
    v_add3_u32 v121, v121, 64, s69
    v_cndmask_b32 v130, 0, v254, vcc
    v_add_f32 v69, v69, v130
    buffer_load_dwordx4 v135, s[48:51], s4 offen offset:1024 lds
    v_cmp_ne_u32 vcc, v119, v171
    v_mov_b32 v122, 0
    v_mov_b32 v123, 0
    v_cndmask_b32 v119, 0, v254, vcc
    v_add_f32 v81, v81, v119
    ds_read_b128 v[198:201], v164 offset:0
    ds_read_b128 v[114:117], v163 offset:0
    ds_read_b128 v[182:185], v164 offset:128
    ds_read_b128 v[138:141], v163 offset:128
    ds_read_b128 v[170:173], v164 offset:256
    buffer_load_dwordx4 v137, s[48:51], s4 offen offset:2048 lds
    s_add_u32 m0, s68, 3072
    ds_read_b128 v[174:177], v163 offset:256
    s_add_u32 s4, s45, 185088
    s_waitcnt lgkmcnt(6)
    v_mov_b32 v124, 0
    v_mov_b32 v125, 0
    s_sub_u32 s45, s17, 1
    ds_write_b128 v167, v[122:125] offset:16
    s_waitcnt vmcnt(6)
    buffer_load_dwordx4 v133, s[48:51], s4 offen lds
    s_waitcnt lgkmcnt(4)
    v_mfma_f32_16x16x32_bf16 v[146:149], a[72:75], v[198:201], 0
    v_mfma_f32_16x16x32_bf16 v[146:149], a[76:79], v[114:117], v[146:149]
    s_waitcnt lgkmcnt(3)
    ds_read_b64_tr_b16 a[152:153], v126 offset:0
    ds_read_b64_tr_b16 a[154:155], v126 offset:768
    v_mfma_f32_16x16x32_bf16 v[146:149], a[80:83], v[182:185], v[146:149]
    s_waitcnt lgkmcnt(4)
    ds_read_b64_tr_b16 a[176:177], v126 offset:32
    ds_read_b64_tr_b16 a[178:179], v126 offset:800
    v_mfma_f32_16x16x32_bf16 v[146:149], a[84:87], v[138:141], v[146:149]
    s_waitcnt lgkmcnt(5)
    ds_read_b64_tr_b16 a[200:201], v126 offset:64
    ds_read_b64_tr_b16 a[202:203], v126 offset:832
    v_mfma_f32_16x16x32_bf16 v[146:149], a[88:91], v[170:173], v[146:149]
    buffer_load_dwordx4 v135, s[48:51], s4 offen offset:1024 lds
    v_mfma_f32_16x16x32_bf16 v[146:149], a[92:95], v[174:177], v[146:149]
    ds_write_b64 v167, v[122:123] offset:56
    v_mfma_f32_16x16x32_bf16 v[154:157], a[96:99], v[198:201], 0
    v_mfma_f32_16x16x32_bf16 v[154:157], a[100:103], v[114:117], v[154:157]
    ds_write_b64 v167, v[122:123] offset:64
    v_mfma_f32_16x16x32_bf16 v[154:157], a[104:107], v[182:185], v[154:157]
    s_waitcnt lgkmcnt(6)
    buffer_load_dwordx4 v137, s[48:51], s4 offen offset:2048 lds
    v_mfma_f32_16x16x32_bf16 v[154:157], a[108:111], v[138:141], v[154:157]
    s_add_u32 m0, s28, 8192
    ds_read_b128 v[222:225], v164 offset:6144
    v_fma_f32 v119, v146, v146, s32
    v_mfma_f32_16x16x32_bf16 v[154:157], a[112:115], v[170:173], v[154:157]
    s_add_u32 s4, 0, 12288
    ds_read_b128 v[226:229], v163 offset:6144
    v_fmac_f32 v119, v147, v147
    v_mfma_f32_16x16x32_bf16 v[154:157], a[116:119], v[174:177], v[154:157]
    s_waitcnt lgkmcnt(4)
    ds_read_b128 v[242:245], v164 offset:6272
    s_waitcnt vmcnt(6)
    v_mfma_f32_16x16x32_bf16 v[178:181], a[120:123], v[198:201], 0
    ds_read_b64_tr_b16 a[156:157], v126 offset:3072
    ds_read_b64_tr_b16 a[158:159], v126 offset:3840
    v_mfma_f32_16x16x32_bf16 v[178:181], a[124:127], v[114:117], v[178:181]
    buffer_load_dwordx4 v12, s[8:11], s25 offen nt lds
    v_mfma_f32_16x16x32_bf16 v[178:181], a[128:131], v[182:185], v[178:181]
    s_add_u32 m0, s28, 12288
    ds_read_b64_tr_b16 a[180:181], v126 offset:3104
    ds_read_b64_tr_b16 a[182:183], v126 offset:3872
    v_mfma_f32_16x16x32_bf16 v[178:181], a[132:135], v[138:141], v[178:181]
    ds_read_b64_tr_b16 a[204:205], v126 offset:3136
    ds_read_b64_tr_b16 a[206:207], v126 offset:3904
    v_mfma_f32_16x16x32_bf16 v[178:181], a[136:139], v[170:173], v[178:181]
    ds_read_b128 v[190:193], v163 offset:6272
    ds_read_b128 v[218:221], v164 offset:6400
    v_mfma_f32_16x16x32_bf16 v[178:181], a[140:143], v[174:177], v[178:181]
    s_waitcnt lgkmcnt(10)
    ds_read_b128 v[206:209], v163 offset:6400
    v_fmac_f32 v119, v148, v148
    v_mfma_f32_16x16x32_bf16 v[150:153], a[72:75], v[222:225], 0
    s_waitcnt lgkmcnt(10)
    buffer_load_dwordx4 v13, s[8:11], s25 offen nt lds
    v_mfma_f32_16x16x32_bf16 v[150:153], a[76:79], v[226:229], v[150:153]
    s_waitcnt lgkmcnt(9)
    ds_write_b128 v159, v[122:125] offset:16
    v_mfma_f32_16x16x32_bf16 v[150:153], a[80:83], v[242:245], v[150:153]
    s_add_u32 m0, s29, 0
    v_fmac_f32 v119, v149, v149
    v_fmac_f32 v119, v154, v154
    v_mfma_f32_16x16x32_bf16 v[186:189], a[96:99], v[222:225], 0
    s_waitcnt lgkmcnt(6)
    v_fmac_f32 v119, v155, v155
    v_fmac_f32 v119, v156, v156
    v_mfma_f32_16x16x32_bf16 v[186:189], a[100:103], v[226:229], v[186:189]
    s_waitcnt lgkmcnt(4)
    buffer_load_dwordx4 v14, s[8:11], s25 offen nt lds
    v_mfma_f32_16x16x32_bf16 v[186:189], a[104:107], v[242:245], v[186:189]
    s_waitcnt lgkmcnt(2)
    ds_write_b64 v159, v[122:123] offset:56
    v_mfma_f32_16x16x32_bf16 v[150:153], a[84:87], v[190:193], v[150:153]
    s_add_u32 m0, s69, 0
    s_waitcnt vmcnt(6)
    v_fmac_f32 v119, v157, v157
    v_mfma_f32_16x16x32_bf16 v[150:153], a[88:91], v[218:221], v[150:153]
    s_waitcnt lgkmcnt(2)
    ds_read_b64_tr_b16 a[160:161], v128 offset:0
    ds_read_b64_tr_b16 a[162:163], v128 offset:768
    v_mfma_f32_16x16x32_bf16 v[150:153], a[92:95], v[206:209], v[150:153]
    s_cmp_lt_u32 1, s17
    ds_read_b64_tr_b16 a[184:185], v128 offset:32
    buffer_load_dwordx4 v143, s[52:55], 0 offen lds
    v_mfma_f32_16x16x32_bf16 v[186:189], a[108:111], v[190:193], v[186:189]
    s_cselect_b32 s10, s36, 0
    ds_read_b64_tr_b16 a[186:187], v128 offset:800
    ds_read_b64_tr_b16 a[208:209], v128 offset:64
    v_mfma_f32_16x16x32_bf16 v[186:189], a[112:115], v[218:221], v[186:189]
    s_mov_b32 s25, s24
    ds_read_b64_tr_b16 a[210:211], v128 offset:832
    v_fmac_f32 v119, v178, v178
    v_mfma_f32_16x16x32_bf16 v[186:189], a[116:119], v[206:209], v[186:189]
    ds_write_b64 v159, v[122:123] offset:64
    v_mfma_f32_16x16x32_bf16 v[194:197], a[120:123], v[222:225], 0
    v_fmac_f32 v119, v179, v179
    v_fmac_f32 v119, v180, v180
    v_mfma_f32_16x16x32_bf16 v[194:197], a[124:127], v[226:229], v[194:197]
    buffer_load_dwordx4 v132, s[52:55], 0 offen offset:1024 lds
    v_fmac_f32 v119, v181, v181
    v_mfma_f32_16x16x32_bf16 v[194:197], a[128:131], v[242:245], v[194:197]
    s_waitcnt lgkmcnt(6)
    v_fma_f32 v142, v150, v150, s32
    v_fmac_f32 v142, v151, v151
    v_mfma_f32_16x16x32_bf16 v[194:197], a[132:135], v[190:193], v[194:197]
    s_waitcnt lgkmcnt(4)
    v_fmac_f32 v142, v152, v152
    v_fmac_f32 v142, v153, v153
    v_mfma_f32_16x16x32_bf16 v[194:197], a[136:139], v[218:221], v[194:197]
    s_waitcnt lgkmcnt(3)
    v_fmac_f32 v142, v186, v186
    v_fmac_f32 v142, v187, v187
    v_mfma_f32_16x16x32_bf16 v[194:197], a[140:143], v[206:209], v[194:197]
    s_waitcnt lgkmcnt(1)
    v_fmac_f32 v142, v188, v188
    v_fmac_f32 v142, v189, v189
    v_mfma_f32_16x16x32_bf16 v[202:205], a[0:3], v[198:201], 0
    buffer_load_dwordx4 v118, s[52:55], 0 offen offset:2048 lds
    v_xor_b32 v254, 65536, v2
    v_mfma_f32_16x16x32_bf16 v[202:205], a[4:7], v[114:117], v[202:205]
    s_add_u32 m0, s69, 3072
    v_fmac_f32 v142, v194, v194
    v_fmac_f32 v142, v195, v195
    v_mfma_f32_16x16x32_bf16 v[202:205], a[8:11], v[182:185], v[202:205]
    v_fmac_f32 v142, v196, v196
    s_waitcnt vmcnt(6)
    v_mfma_f32_16x16x32_bf16 v[202:205], a[12:15], v[138:141], v[202:205]
    ds_read_b64_tr_b16 a[164:165], v128 offset:3072
    ds_read_b64_tr_b16 a[166:167], v128 offset:3840
    v_mfma_f32_16x16x32_bf16 v[202:205], a[16:19], v[170:173], v[202:205]
    ds_read_b64_tr_b16 a[188:189], v128 offset:3104
    ds_read_b64_tr_b16 a[190:191], v128 offset:3872
    v_mfma_f32_16x16x32_bf16 v[202:205], a[20:23], v[174:177], v[202:205]
    buffer_load_dwordx4 v143, s[52:55], s4 offen lds
    v_mfma_f32_16x16x32_bf16 v[230:233], a[24:27], v[198:201], 0
    ds_read_b64_tr_b16 a[212:213], v128 offset:3136
    ds_read_b64_tr_b16 a[214:215], v128 offset:3904
    v_mfma_f32_16x16x32_bf16 v[230:233], a[28:31], v[114:117], v[230:233]
    v_fmac_f32 v142, v197, v197
    v_lshrrev_b32 v130, 2, v254
    v_mfma_f32_16x16x32_bf16 v[230:233], a[32:35], v[182:185], v[230:233]
    v_fma_f32 v255, v202, v202, s32
    v_fmac_f32 v255, v203, v203
    v_mfma_f32_16x16x32_bf16 v[230:233], a[36:39], v[138:141], v[230:233]
    v_fmac_f32 v255, v204, v204
    v_fmac_f32 v255, v205, v205
    v_mfma_f32_16x16x32_bf16 v[230:233], a[40:43], v[170:173], v[230:233]
    buffer_load_dwordx4 v132, s[52:55], s4 offen offset:1024 lds
    v_mfma_f32_16x16x32_bf16 v[230:233], a[44:47], v[174:177], v[230:233]
    s_waitcnt lgkmcnt(4)
    v_lshrrev_b32 v133, 8, v254
    v_add_u32 v254, 157184, v254
    v_mfma_f32_16x16x32_bf16 v[214:217], a[48:51], v[198:201], 0
    s_waitcnt lgkmcnt(2)
    v_lshl_add_u32 v135, s16, 2, v254
    v_add_u32 v130, 162048, v130
    v_mfma_f32_16x16x32_bf16 v[214:217], a[52:55], v[114:117], v[214:217]
    v_fmac_f32 v255, v230, v230
    v_fmac_f32 v255, v231, v231
    v_mfma_f32_16x16x32_bf16 v[214:217], a[56:59], v[182:185], v[214:217]
    s_waitcnt lgkmcnt(0)
    v_fmac_f32 v255, v232, v232
    v_fmac_f32 v255, v233, v233
    v_mfma_f32_16x16x32_bf16 v[214:217], a[60:63], v[138:141], v[214:217]
    buffer_load_dwordx4 v118, s[52:55], s4 offen offset:2048 lds
    v_mfma_f32_16x16x32_bf16 v[214:217], a[64:67], v[170:173], v[214:217]
    s_add_u32 m0, s68, 0
    v_lshlrev_b32 v133, 4, v133
    v_add_u32 v133, 162048, v133
    v_mfma_f32_16x16x32_bf16 v[214:217], a[68:71], v[174:177], v[214:217]
    s_add_u32 s4, 0, 24576
    v_or_b32 v234, v32, v33
    v_and_b32 v234, 0xffff, v234
    v_mfma_f32_16x16x32_bf16 v[138:141], a[0:3], v[222:225], 0
    v_lshl_or_b32 v234, v234, 16, v234
    v_or_b32 v235, v32, v33
    v_mfma_f32_16x16x32_bf16 v[138:141], a[4:7], v[226:229], v[138:141]
    v_and_b32 v235, 0xffff, v235
    v_fmac_f32 v255, v214, v214
    v_mfma_f32_16x16x32_bf16 v[138:141], a[8:11], v[242:245], v[138:141]
    buffer_load_dwordx4 v143, s[52:55], s4 offen lds
    v_mfma_f32_16x16x32_bf16 v[138:141], a[12:15], v[190:193], v[138:141]
    v_fmac_f32 v255, v215, v215
    v_fmac_f32 v255, v216, v216
    v_mfma_f32_16x16x32_bf16 v[138:141], a[16:19], v[218:221], v[138:141]
    v_fmac_f32 v255, v217, v217
    v_cvt_pk_bf16_f32 v36, v255, v119
    v_mfma_f32_16x16x32_bf16 v[138:141], a[20:23], v[206:209], v[138:141]
    v_lshl_or_b32 v235, v235, 16, v235
    v_or_b32 v236, v32, v33
    v_mfma_f32_16x16x32_bf16 v[114:117], v[32:35], v[36:39], 0
    v_lshrrev_b32 v236, 16, v236
    v_lshl_or_b32 v236, v236, 16, v236
    v_mfma_f32_16x16x32_bf16 v[238:241], a[24:27], v[222:225], 0
    v_or_b32 v237, v32, v33
    v_lshrrev_b32 v237, 16, v237
    v_mfma_f32_16x16x32_bf16 v[238:241], a[28:31], v[226:229], v[238:241]
    v_lshl_or_b32 v237, v237, 16, v237
    v_fma_f32 v119, v138, v138, s32
    v_mfma_f32_16x16x32_bf16 v[238:241], a[32:35], v[242:245], v[238:241]
    v_rsq_f32 v115, v115
    v_mfma_f32_16x16x32_bf16 v[238:241], a[36:39], v[190:193], v[238:241]
    ds_read_b128 v[182:185], v0 offset:20480
    v_mul_f32 v146, v115, v146
    v_mfma_f32_16x16x32_bf16 v[238:241], a[40:43], v[218:221], v[238:241]
    ds_read_b128 v[198:201], v1 offset:20480
    v_mul_f32 v147, v115, v147
    v_mfma_f32_16x16x32_bf16 v[238:241], a[44:47], v[206:209], v[238:241]
    ds_read_b128 v[210:213], v0 offset:20608
    v_cvt_pk_f16_f32 v126, v146, v147
    v_mfma_f32_16x16x32_bf16 v[246:249], a[48:51], v[222:225], 0
    ds_read_b128 v[222:225], v1 offset:20608
    v_mul_f32 v148, v115, v148
    v_mfma_f32_16x16x32_bf16 v[246:249], a[52:55], v[226:229], v[246:249]
    ds_read_b128 v[226:229], v0 offset:20736
    v_mul_f32 v149, v115, v149
    v_mfma_f32_16x16x32_bf16 v[246:249], a[56:59], v[242:245], v[246:249]
    ds_read_b128 v[242:245], v1 offset:20736
    v_cvt_pk_f16_f32 v127, v148, v149
    v_mfma_f32_16x16x32_bf16 v[246:249], a[60:63], v[190:193], v[246:249]
    v_rsq_f32 v114, v114
    v_mfma_f32_16x16x32_bf16 v[246:249], a[64:67], v[218:221], v[246:249]
    v_mul_f32 v114, s31, v114
    v_mul_f32 v154, v115, v154
    v_mfma_f32_16x16x32_bf16 v[246:249], a[68:71], v[206:209], v[246:249]
    s_waitcnt lgkmcnt(5)
    v_mul_f32 v155, v115, v155
    v_cvt_pk_f16_f32 v128, v154, v155
    v_mfma_f32_16x16x32_bf16 v[122:125], a[96:99], v[182:185], 0
    s_waitcnt lgkmcnt(4)
    v_mul_f32 v156, v115, v156
    v_mul_f32 v157, v115, v157
    v_mfma_f32_16x16x32_bf16 v[122:125], a[100:103], v[198:201], v[122:125]
    s_waitcnt lgkmcnt(3)
    v_cvt_pk_f16_f32 v129, v156, v157
    v_mul_f32 v178, v115, v178
    v_mfma_f32_16x16x32_bf16 v[122:125], a[104:107], v[210:213], v[122:125]
    s_waitcnt lgkmcnt(2)
    ds_write_b128 v167, v[126:129]
    v_mfma_f32_16x16x32_bf16 v[122:125], a[108:111], v[222:225], v[122:125]
    s_waitcnt lgkmcnt(1)
    v_mul_f32 v179, v115, v179
    v_cvt_pk_f16_f32 v172, v178, v179
    v_mfma_f32_16x16x32_bf16 v[122:125], a[112:115], v[226:229], v[122:125]
    v_mul_f32 v180, v115, v180
    v_mul_f32 v181, v115, v181
    v_mfma_f32_16x16x32_bf16 v[122:125], a[116:119], v[242:245], v[122:125]
    v_cvt_pk_f16_f32 v173, v180, v181
    v_mul_f32 v202, v114, v202
    v_mfma_f32_16x16x32_bf16 v[126:129], a[120:123], v[182:185], 0
    ds_write_b64 v167, v[172:173] offset:48
    v_mfma_f32_16x16x32_bf16 v[126:129], a[124:127], v[198:201], v[126:129]
    v_mul_f32 v203, v114, v203
    v_cvt_pk_f16_f32 v170, v202, v203
    v_mfma_f32_16x16x32_bf16 v[126:129], a[128:131], v[210:213], v[126:129]
    v_mul_f32 v204, v114, v204
    v_mul_f32 v205, v114, v205
    v_mfma_f32_16x16x32_bf16 v[126:129], a[132:135], v[222:225], v[126:129]
    v_cvt_pk_f16_f32 v171, v204, v205
    v_mul_f32 v230, v114, v230
    v_mfma_f32_16x16x32_bf16 v[126:129], a[136:139], v[226:229], v[126:129]
    v_mul_f32 v231, v114, v231
    v_cvt_pk_f16_f32 v172, v230, v231
    v_mfma_f32_16x16x32_bf16 v[126:129], a[140:143], v[242:245], v[126:129]
    v_mul_f32 v232, v114, v232
    v_mul_f32 v233, v114, v233
    v_mfma_f32_16x16x32_bf16 v[174:177], a[24:27], v[182:185], 0
    v_cvt_pk_f16_f32 v173, v232, v233
    v_mul_f32 v214, v114, v214
    v_mfma_f32_16x16x32_bf16 v[174:177], a[28:31], v[198:201], v[174:177]
    ds_write_b128 v167, v[170:173] offset:32
    v_mfma_f32_16x16x32_bf16 v[174:177], a[32:35], v[210:213], v[174:177]
    v_mul_f32 v215, v114, v215
    v_cvt_pk_f16_f32 v170, v214, v215
    v_mfma_f32_16x16x32_bf16 v[174:177], a[36:39], v[222:225], v[174:177]
    v_mul_f32 v216, v114, v216
    v_mul_f32 v217, v114, v217
    v_mfma_f32_16x16x32_bf16 v[174:177], a[40:43], v[226:229], v[174:177]
    v_cvt_pk_f16_f32 v171, v216, v217
    v_mul_f32 v146, v202, v146
    v_mfma_f32_16x16x32_bf16 v[174:177], a[44:47], v[242:245], v[174:177]
    ds_write_b64 v167, v[170:171] offset:72
    v_mfma_f32_16x16x32_bf16 v[114:117], a[72:75], v[182:185], 0
    v_fmac_f32 v146, v203, v147
    v_fmac_f32 v146, v204, v148
    v_mfma_f32_16x16x32_bf16 v[114:117], a[76:79], v[198:201], v[114:117]
    v_fmac_f32 v146, v205, v149
    v_fmac_f32 v146, v230, v154
    v_mfma_f32_16x16x32_bf16 v[114:117], a[80:83], v[210:213], v[114:117]
    v_fmac_f32 v146, v231, v155
    v_fmac_f32 v146, v232, v156
    v_mfma_f32_16x16x32_bf16 v[114:117], a[84:87], v[222:225], v[114:117]
    v_fmac_f32 v146, v233, v157
    v_fmac_f32 v146, v214, v178
    v_mfma_f32_16x16x32_bf16 v[114:117], a[88:91], v[226:229], v[114:117]
    v_fmac_f32 v146, v215, v179
    v_fmac_f32 v146, v216, v180
    v_mfma_f32_16x16x32_bf16 v[114:117], a[92:95], v[242:245], v[114:117]
    v_fmac_f32 v146, v217, v181
    v_mov_b32 v167, v146
    v_mfma_f32_16x16x32_bf16 v[218:221], a[48:51], v[182:185], 0
    v_fmac_f32 v119, v139, v139
    v_fmac_f32 v119, v140, v140
    v_mfma_f32_16x16x32_bf16 v[218:221], a[52:55], v[198:201], v[218:221]
    v_permlane32_swap_b32 v146, v167
    v_mfma_f32_16x16x32_bf16 v[218:221], a[56:59], v[210:213], v[218:221]
    v_add_f32 v146, v146, v167
    v_mov_b32 v167, v146
    v_mfma_f32_16x16x32_bf16 v[218:221], a[60:63], v[222:225], v[218:221]
    v_fmac_f32 v119, v141, v141
    v_fmac_f32 v119, v238, v238
    v_mfma_f32_16x16x32_bf16 v[218:221], a[64:67], v[226:229], v[218:221]
    v_permlane16_swap_b32 v146, v167
    v_mfma_f32_16x16x32_bf16 v[218:221], a[68:71], v[242:245], v[218:221]
    v_add_f32 v146, v146, v167
    v_add_f32 v146, s39, v146
    v_mfma_f32_16x16x32_bf16 v[170:173], v[182:185], a[144:147], 0
    v_mov_b32 v147, v162
    v_mov_b32 v148, v162
    v_mfma_f32_16x16x32_bf16 v[170:173], v[198:201], a[148:151], v[170:173]
    v_mov_b32 v149, v162
    v_cndmask_b32 v146, v162, v146, s[88:89]
    v_mfma_f32_16x16x32_bf16 v[170:173], v[210:213], a[152:155], v[170:173]
    ds_write_b128 v166, v[146:149] offset:192
    v_mfma_f32_16x16x32_bf16 v[170:173], v[222:225], a[156:159], v[170:173]
    v_fmac_f32 v119, v239, v239
    v_fmac_f32 v119, v240, v240
    v_mfma_f32_16x16x32_bf16 v[170:173], v[226:229], a[160:163], v[170:173]
    v_fmac_f32 v119, v241, v241
    v_fmac_f32 v119, v246, v246
    v_mfma_f32_16x16x32_bf16 v[170:173], v[242:245], a[164:167], v[170:173]
    v_fmac_f32 v119, v247, v247
    v_fmac_f32 v119, v248, v248
    v_mfma_f32_16x16x32_bf16 v[154:157], v[182:185], a[168:171], 0
    v_fmac_f32 v119, v249, v249
    v_cvt_pk_bf16_f32 v36, v119, v142
    v_mfma_f32_16x16x32_bf16 v[154:157], v[198:201], a[172:175], v[154:157]
    v_fma_f32 v119, v114, v114, s32
    v_fmac_f32 v119, v115, v115
    v_mfma_f32_16x16x32_bf16 v[146:149], v[32:35], v[36:39], 0
    v_fmac_f32 v119, v116, v116
    v_fmac_f32 v119, v117, v117
    v_mfma_f32_16x16x32_bf16 v[154:157], v[210:213], a[176:179], v[154:157]
    v_fmac_f32 v119, v122, v122
    v_fmac_f32 v119, v123, v123
    v_mfma_f32_16x16x32_bf16 v[154:157], v[222:225], a[180:183], v[154:157]
    ds_read_b128 v[202:205], v164 offset:0
    v_fmac_f32 v119, v124, v124
    v_mfma_f32_16x16x32_bf16 v[154:157], v[226:229], a[184:187], v[154:157]
    ds_read_b128 v[190:193], v163 offset:0
    v_fmac_f32 v119, v125, v125
    v_mfma_f32_16x16x32_bf16 v[154:157], v[242:245], a[188:191], v[154:157]
    ds_read_b128 v[178:181], v164 offset:128
    v_rsq_f32 v147, v147
    v_rsq_f32 v146, v146
    v_mul_f32 v150, v147, v150
    v_mul_f32 v146, s31, v146
    v_mul_f32 v151, v147, v151
    v_cvt_pk_f16_f32 v206, v150, v151
    v_mul_f32 v152, v147, v152
    v_mul_f32 v153, v147, v153
    v_cvt_pk_f16_f32 v207, v152, v153
    v_mul_f32 v186, v147, v186
    v_mul_f32 v187, v147, v187
    v_cvt_pk_f16_f32 v208, v186, v187
    v_mul_f32 v188, v147, v188
    v_mul_f32 v189, v147, v189
    v_cvt_pk_f16_f32 v209, v188, v189
    v_mul_f32 v194, v147, v194
    v_mul_f32 v195, v147, v195
    v_cvt_pk_f16_f32 v232, v194, v195
    v_mul_f32 v196, v147, v196
    v_mul_f32 v197, v147, v197
    v_cvt_pk_f16_f32 v233, v196, v197
    buffer_load_dwordx4 v132, s[52:55], s4 offen offset:1024 lds
    ds_write_b128 v159, v[206:209]
    v_mul_f32 v138, v146, v138
    v_mul_f32 v139, v146, v139
    v_cvt_pk_f16_f32 v206, v138, v139
    v_mul_f32 v140, v146, v140
    v_mul_f32 v141, v146, v141
    v_cvt_pk_f16_f32 v207, v140, v141
    v_mul_f32 v238, v146, v238
    v_mul_f32 v239, v146, v239
    v_cvt_pk_f16_f32 v208, v238, v239
    v_mul_f32 v240, v146, v240
    v_mul_f32 v241, v146, v241
    buffer_load_dwordx4 v118, s[52:55], s4 offen offset:2048 lds
    ds_write_b64 v159, v[232:233] offset:48
    s_add_u32 m0, s68, 3072
    s_add_u32 s4, 0, 36864
    v_cvt_pk_f16_f32 v209, v240, v241
    v_mul_f32 v246, v146, v246
    v_mul_f32 v247, v146, v247
    v_cvt_pk_f16_f32 v230, v246, v247
    v_mul_f32 v248, v146, v248
    v_mul_f32 v249, v146, v249
    v_cvt_pk_f16_f32 v231, v248, v249
    v_mul_f32 v138, v138, v150
    v_fmac_f32 v138, v139, v151
    v_fmac_f32 v138, v140, v152
    buffer_load_dwordx4 v143, s[52:55], s4 offen lds
    ds_write_b128 v159, v[206:209] offset:32
    v_mfma_f32_16x16x32_bf16 v[206:209], a[0:3], v[182:185], 0
    s_waitcnt lgkmcnt(2)
    v_fmac_f32 v138, v141, v153
    v_fmac_f32 v138, v238, v186
    v_mfma_f32_16x16x32_bf16 v[206:209], a[4:7], v[198:201], v[206:209]
    v_fmac_f32 v138, v239, v187
    v_fmac_f32 v138, v240, v188
    v_mfma_f32_16x16x32_bf16 v[206:209], a[8:11], v[210:213], v[206:209]
    ds_write_b64 v159, v[230:231] offset:72
    v_mfma_f32_16x16x32_bf16 v[206:209], a[12:15], v[222:225], v[206:209]
    buffer_load_dwordx4 v132, s[52:55], s4 offen offset:1024 lds
    v_mfma_f32_16x16x32_bf16 v[206:209], a[16:19], v[226:229], v[206:209]
    v_fmac_f32 v138, v241, v189
    v_fmac_f32 v138, v246, v194
    v_mfma_f32_16x16x32_bf16 v[206:209], a[20:23], v[242:245], v[206:209]
    v_fmac_f32 v138, v247, v195
    v_fmac_f32 v138, v248, v196
    v_mfma_f32_16x16x32_bf16 v[146:149], v[182:185], a[192:195], 0
    ds_read_b128 v[150:153], v163 offset:128
    v_fmac_f32 v138, v249, v197
    v_mfma_f32_16x16x32_bf16 v[146:149], v[198:201], a[196:199], v[146:149]
    ds_read_b128 v[182:185], v164 offset:256
    v_mov_b32 v142, v138
    v_mfma_f32_16x16x32_bf16 v[146:149], v[210:213], a[200:203], v[146:149]
    buffer_load_dwordx4 v118, s[52:55], s4 offen offset:2048 lds
    v_mfma_f32_16x16x32_bf16 v[146:149], v[222:225], a[204:207], v[146:149]
    s_add_u32 m0, s69, 0
    ds_read_b128 v[222:225], v163 offset:256
    v_fmac_f32 v119, v126, v126
    v_mfma_f32_16x16x32_bf16 v[146:149], v[226:229], a[208:211], v[146:149]
    s_add_u32 s4, 0, 49152
    v_permlane32_swap_b32 v138, v142
    s_waitcnt vmcnt(9)
    v_mfma_f32_16x16x32_bf16 v[146:149], v[242:245], a[212:215], v[146:149]
    ds_read_b64 a[216:217], v131 offset:0
    ds_read_b64 a[218:219], v131 offset:1536
    v_mfma_f32_16x16x32_bf16 v[198:201], v[202:205], a[144:147], 0
    ds_read_b64 a[240:241], v131 offset:8
    ds_read_b64 a[242:243], v131 offset:1544
    v_mfma_f32_16x16x32_bf16 v[198:201], v[190:193], a[148:151], v[198:201]
    s_waitcnt lgkmcnt(6)
    ds_read_b64 v[90:91], v121 offset:0
    ds_read_b64 v[92:93], v121 offset:1536
    v_mfma_f32_16x16x32_bf16 v[198:201], v[178:181], a[152:155], v[198:201]
    s_waitcnt lgkmcnt(7)
    v_add_f32 v138, v138, v142
    v_mov_b32 v142, v138
    v_mfma_f32_16x16x32_bf16 v[198:201], v[150:153], a[156:159], v[198:201]
    v_fmac_f32 v119, v127, v127
    v_fmac_f32 v119, v128, v128
    v_mfma_f32_16x16x32_bf16 v[198:201], v[182:185], a[160:163], v[198:201]
    s_waitcnt lgkmcnt(6)
    v_permlane16_swap_b32 v138, v142
    v_mfma_f32_16x16x32_bf16 v[198:201], v[222:225], a[164:167], v[198:201]
    v_add_f32 v138, v138, v142
    v_add_f32 v138, s39, v138
    v_mfma_f32_16x16x32_bf16 v[242:245], v[202:205], a[168:171], 0
    v_mov_b32 v139, v162
    v_mov_b32 v140, v162
    v_mfma_f32_16x16x32_bf16 v[242:245], v[190:193], a[172:175], v[242:245]
    s_waitcnt lgkmcnt(4)
    v_mov_b32 v141, v162
    v_cndmask_b32 v138, v162, v138, s[88:89]
    v_mfma_f32_16x16x32_bf16 v[226:229], v[234:237], a[216:219], 0
    s_waitcnt lgkmcnt(2)
    ds_write_b128 v169, v[138:141] offset:192
    v_mfma_f32_16x16x32_bf16 v[226:229], v[234:237], a[240:243], v[226:229]
    s_waitcnt lgkmcnt(1)
    buffer_load_dwordx4 v143, s[52:55], s4 offen lds
    v_mfma_f32_16x16x32_bf16 v[226:229], v[234:237], v[90:93], v[226:229]
    v_fmac_f32 v119, v129, v129
    s_waitcnt vmcnt(7)
    v_mfma_f32_16x16x32_bf16 v[242:245], v[178:181], a[176:179], v[242:245]
    ds_read_b64 a[232:233], v131 offset:3072
    ds_read_b64 a[220:221], v131 offset:4608
    v_mfma_f32_16x16x32_bf16 v[242:245], v[150:153], a[180:183], v[242:245]
    ds_read_b64 v[82:83], v131 offset:3080
    ds_read_b64 a[244:245], v131 offset:4616
    v_mfma_f32_16x16x32_bf16 v[242:245], v[182:185], a[184:187], v[242:245]
    ds_read_b64 v[106:107], v121 offset:3072
    ds_read_b64 v[94:95], v121 offset:4608
    v_mfma_f32_16x16x32_bf16 v[242:245], v[222:225], a[188:191], v[242:245]
    buffer_load_dwordx4 v132, s[52:55], s4 offen offset:1024 lds
    v_mfma_f32_16x16x32_bf16 v[186:189], v[202:205], a[192:195], 0
    ds_read_b128 v[158:161], v164 offset:6144
    ds_read_b128 v[138:141], v163 offset:6144
    v_mfma_f32_16x16x32_bf16 v[186:189], v[190:193], a[196:199], v[186:189]
    ds_read_b128 v[194:197], v164 offset:6272
    ds_read_b128 v[210:213], v163 offset:6272
    v_mfma_f32_16x16x32_bf16 v[186:189], v[178:181], a[200:203], v[186:189]
    v_mov_b32 v255, v226
    v_mov_b32_dpp v255, v227 quad_perm:[0,1,2,3] row_mask:0x2 bank_mask:0xf
    v_mfma_f32_16x16x32_bf16 v[186:189], v[150:153], a[204:207], v[186:189]
    ds_read_b128 v[226:229], v164 offset:6400
    ds_read_b128 v[150:153], v163 offset:6400
    v_mfma_f32_16x16x32_bf16 v[186:189], v[182:185], a[208:211], v[186:189]
    s_waitcnt lgkmcnt(10)
    buffer_load_dwordx4 v118, s[52:55], s4 offen offset:2048 lds
    v_mfma_f32_16x16x32_bf16 v[186:189], v[222:225], a[212:215], v[186:189]
    s_add_u32 m0, s69, 3072
    s_add_u32 s4, 0, 61440
    s_waitcnt lgkmcnt(6)
    v_fma_f32 v142, v206, v206, s32
    v_fmac_f32 v142, v207, v207
    v_fmac_f32 v142, v208, v208
    v_fmac_f32 v142, v209, v209
    v_fmac_f32 v142, v174, v174
    v_fmac_f32 v142, v175, v175
    s_waitcnt lgkmcnt(5)
    v_mfma_f32_16x16x32_bf16 v[182:185], v[158:161], a[144:147], 0
    s_waitcnt lgkmcnt(4)
    s_waitcnt vmcnt(6)
    ds_read_b64 a[222:223], v134 offset:0
    v_mfma_f32_16x16x32_bf16 v[182:185], v[138:141], a[148:151], v[182:185]
    s_waitcnt lgkmcnt(3)
    buffer_load_dwordx4 v143, s[52:55], s4 offen lds
    v_mfma_f32_16x16x32_bf16 v[182:185], v[194:197], a[152:155], v[182:185]
    ds_read_b64 a[234:235], v134 offset:1536
    ds_read_b64 a[246:247], v134 offset:8
    v_mfma_f32_16x16x32_bf16 v[182:185], v[210:213], a[156:159], v[182:185]
    s_waitcnt lgkmcnt(3)
    ds_read_b64 v[84:85], v134 offset:1544
    ds_read_b64 v[96:97], v120 offset:0
    v_mfma_f32_16x16x32_bf16 v[182:185], v[226:229], a[160:163], v[182:185]
    ds_read_b64 v[108:109], v120 offset:1536
    v_fmac_f32 v142, v176, v176
    v_mfma_f32_16x16x32_bf16 v[182:185], v[150:153], a[164:167], v[182:185]
    v_fmac_f32 v142, v177, v177
    v_fmac_f32 v142, v218, v218
    v_mfma_f32_16x16x32_bf16 v[222:225], v[158:161], a[168:171], 0
    buffer_load_dwordx4 v132, s[52:55], s4 offen offset:1024 lds
    v_mfma_f32_16x16x32_bf16 v[222:225], v[138:141], a[172:175], v[222:225]
    v_fmac_f32 v142, v219, v219
    v_fmac_f32 v142, v220, v220
    v_mfma_f32_16x16x32_bf16 v[222:225], v[194:197], a[176:179], v[222:225]
    s_waitcnt lgkmcnt(5)
    v_fmac_f32 v142, v221, v221
    v_cvt_pk_bf16_f32 v36, v142, v119
    v_mfma_f32_16x16x32_bf16 v[178:181], v[234:237], a[220:223], 0
    v_cvt_pk_bf16_f32 v190, v170, v171
    v_cvt_pk_bf16_f32 v191, v172, v173
    v_mfma_f32_16x16x32_bf16 v[170:173], v[32:35], v[36:39], 0
    s_waitcnt lgkmcnt(3)
    v_cvt_pk_bf16_f32 v162, v154, v155
    v_cvt_pk_bf16_f32 v163, v156, v157
    v_mfma_f32_16x16x32_bf16 v[178:181], v[234:237], a[244:247], v[178:181]
    s_waitcnt lgkmcnt(1)
    buffer_load_dwordx4 v118, s[52:55], s4 offen offset:2048 lds
    v_mfma_f32_16x16x32_bf16 v[178:181], v[234:237], v[94:97], v[178:181]
    s_add_u32 m0, s28, 65536
    v_rsq_f32 v171, v171
    v_mfma_f32_16x16x32_bf16 v[154:157], v[234:237], a[232:235], 0
    s_waitcnt vmcnt(6)
    ds_read_b64 a[224:225], v134 offset:3072
    ds_read_b64 a[226:227], v134 offset:4608
    v_mfma_f32_16x16x32_bf16 v[154:157], v[234:237], v[82:85], v[154:157]
    s_waitcnt lgkmcnt(2)
    ds_read_b64 a[248:249], v134 offset:3080
    ds_read_b64 a[250:251], v134 offset:4616
    v_mfma_f32_16x16x32_bf16 v[154:157], v[234:237], v[106:109], v[154:157]
    ds_read_b64 v[98:99], v120 offset:3072
    ds_read_b64 v[100:101], v120 offset:4608
    v_mfma_f32_16x16x32_bf16 v[222:225], v[210:213], a[180:183], v[222:225]
    buffer_load_dwordx4 v10, s[8:11], s24 offen nt lds
    v_mfma_f32_16x16x32_bf16 v[222:225], v[226:229], a[184:187], v[222:225]
    s_add_u32 m0, s28, 69632
    v_mov_b32 v132, v179
    v_mul_f32 v114, v171, v114
    v_mfma_f32_16x16x32_bf16 v[222:225], v[150:153], a[188:191], v[222:225]
    v_mov_b32_dpp v255, v154 quad_perm:[0,1,2,3] row_mask:0x4 bank_mask:0xf
    v_mov_b32_dpp v255, v178 quad_perm:[0,1,2,3] row_mask:0x8 bank_mask:0xf
    v_mfma_f32_16x16x32_bf16 v[178:181], v[158:161], a[192:195], 0
    v_mov_b32_dpp v132, v155 quad_perm:[0,1,2,3] row_mask:0x2 bank_mask:0xf
    v_mul_f32 v115, v171, v115
    v_mfma_f32_16x16x32_bf16 v[178:181], v[138:141], a[196:199], v[178:181]
    v_rsq_f32 v170, v170
    v_mfma_f32_16x16x32_bf16 v[178:181], v[194:197], a[200:203], v[178:181]
    s_waitcnt lgkmcnt(4)
    buffer_load_dwordx4 v11, s[8:11], s24 offen nt lds
    v_mfma_f32_16x16x32_bf16 v[138:141], v[234:237], a[224:227], 0
    s_waitcnt lgkmcnt(2)
    v_mul_f32 v170, s31, v170
    v_cvt_pk_f16_f32 v114, v114, v115
    v_mfma_f32_16x16x32_bf16 v[138:141], v[234:237], a[248:251], v[138:141]
    s_waitcnt lgkmcnt(0)
    v_mul_f32 v116, v171, v116
    v_mul_f32 v117, v171, v117
    v_mfma_f32_16x16x32_bf16 v[138:141], v[234:237], v[98:101], v[138:141]
    s_add_u32 m0, s28, 73728
    v_cvt_pk_f16_f32 v115, v116, v117
    v_mul_f32 v122, v171, v122
    v_mfma_f32_16x16x32_bf16 v[178:181], v[210:213], a[204:207], v[178:181]
    v_mul_f32 v123, v171, v123
    v_cvt_pk_f16_f32 v116, v122, v123
    v_mfma_f32_16x16x32_bf16 v[178:181], v[226:229], a[208:211], v[178:181]
    buffer_load_dwordx4 v12, s[8:11], s24 offen nt lds
    v_mfma_f32_16x16x32_bf16 v[178:181], v[150:153], a[212:215], v[178:181]
    s_barrier
    ds_read_b128 v[154:157], v0 offset:26624
    ds_read_b128 v[158:161], v1 offset:26624
    s_waitcnt vmcnt(6)
    ds_read_b64 a[236:237], v131 offset:0
    ds_read_b64 a[228:229], v131 offset:1536
    ds_read_b64 v[86:87], v131 offset:8
    s_add_u32 m0, s28, 77824
    ds_read_b64 a[252:253], v131 offset:1544
    ds_read_b64 v[110:111], v121 offset:0
    ds_read_b64 v[102:103], v121 offset:1536
    buffer_load_dwordx4 v13, s[8:11], s24 offen nt lds
    ds_read_b128 v[226:229], v0 offset:26752
    ds_read_b128 v[150:153], v1 offset:26752
    s_add_u32 m0, s74, 0
    ds_read_b128 v[202:205], v0 offset:26880
    ds_read_b128 v[194:197], v1 offset:26880
    v_mov_b32_dpp v132, v138 quad_perm:[0,1,2,3] row_mask:0x4 bank_mask:0xf
    v_mov_b32_dpp v132, v139 quad_perm:[0,1,2,3] row_mask:0x8 bank_mask:0xf
    s_waitcnt lgkmcnt(11)
    v_mfma_f32_16x16x32_bf16 v[210:213], a[72:75], v[154:157], 0
    s_waitcnt lgkmcnt(10)
    ds_write_b32 v135, v255 offset:0
    v_mfma_f32_16x16x32_bf16 v[210:213], a[76:79], v[158:161], v[210:213]
    s_waitcnt lgkmcnt(8)
    buffer_load_dwordx4 v14, s[8:11], s24 offen nt lds
    v_mfma_f32_16x16x32_bf16 v[138:141], a[96:99], v[154:157], 0
    s_add_u32 s8, s40, s23
    ds_write_b32 v135, v132 offset:1024
    v_mfma_f32_16x16x32_bf16 v[138:141], a[100:103], v[158:161], v[138:141]
    s_addc_u32 s9, s41, 0
    v_mul_f32 v124, v171, v124
    v_mul_f32 v125, v171, v125
    v_mfma_f32_16x16x32_bf16 v[238:241], a[120:123], v[154:157], 0
    s_waitcnt lgkmcnt(4)
    v_cvt_pk_f16_f32 v117, v124, v125
    v_mul_f32 v126, v171, v126
    v_mfma_f32_16x16x32_bf16 v[210:213], a[80:83], v[226:229], v[210:213]
    s_sub_u32 s10, s36, s23
    v_mul_f32 v127, v171, v127
    v_cvt_pk_f16_f32 v124, v126, v127
    v_mfma_f32_16x16x32_bf16 v[210:213], a[84:87], v[150:153], v[210:213]
    s_waitcnt lgkmcnt(2)
    v_mul_f32 v128, v171, v128
    v_mul_f32 v129, v171, v129
    v_mfma_f32_16x16x32_bf16 v[210:213], a[88:91], v[202:205], v[210:213]
    s_cmp_lt_u32 s34, s17
    v_cvt_pk_f16_f32 v125, v128, v129
    v_mul_f32 v206, v170, v206
    s_waitcnt vmcnt(5)
    v_mfma_f32_16x16x32_bf16 v[210:213], a[92:95], v[194:197], v[210:213]
    s_cselect_b32 s10, s10, 0
    ds_read_b64 a[230:231], v131 offset:3072
    ds_read_b64 a[238:239], v131 offset:4608
    v_mfma_f32_16x16x32_bf16 v[138:141], a[104:107], v[226:229], v[138:141]
    s_add_u32 m0, s28, 0
    ds_read_b64 a[254:255], v131 offset:3080
    ds_read_b64 v[88:89], v131 offset:4616
    v_mfma_f32_16x16x32_bf16 v[138:141], a[108:111], v[150:153], v[138:141]
    s_mov_b32 s24, s23
    ds_read_b64 v[104:105], v121 offset:3072
    ds_read_b64 v[112:113], v121 offset:4608
    v_mfma_f32_16x16x32_bf16 v[138:141], a[112:115], v[202:205], v[138:141]
    s_add_u32 s23, s23, s21
    v_mul_f32 v207, v170, v207
    v_cvt_pk_f16_f32 v126, v206, v207
    v_mfma_f32_16x16x32_bf16 v[138:141], a[116:119], v[194:197], v[138:141]
    s_cmp_ge_u32 s19, 72
    v_mul_f32 v208, v170, v208
    v_mul_f32 v209, v170, v209
    v_mfma_f32_16x16x32_bf16 v[238:241], a[124:127], v[158:161], v[238:241]
    s_cselect_b32 s34, 72, 0
    v_cvt_pk_f16_f32 v127, v208, v209
    v_mul_f32 v174, v170, v174
    v_mfma_f32_16x16x32_bf16 v[238:241], a[128:131], v[226:229], v[238:241]
    s_cselect_b32 s35, s22, 0
    v_mul_f32 v175, v170, v175
    v_cvt_pk_f16_f32 v128, v174, v175
    v_mfma_f32_16x16x32_bf16 v[238:241], a[132:135], v[150:153], v[238:241]
    s_sub_u32 s19, s19, s34
    v_mul_f32 v176, v170, v176
    v_mul_f32 v177, v170, v177
    v_mfma_f32_16x16x32_bf16 v[238:241], a[136:139], v[202:205], v[238:241]
    s_waitcnt lgkmcnt(4)
    v_cvt_pk_f16_f32 v129, v176, v177
    v_mul_f32 v218, v170, v218
    v_mfma_f32_16x16x32_bf16 v[174:177], v[234:237], a[228:231], 0
    s_waitcnt lgkmcnt(2)
    v_mul_f32 v219, v170, v219
    v_cvt_pk_f16_f32 v122, v218, v219
    v_mfma_f32_16x16x32_bf16 v[174:177], v[234:237], a[252:255], v[174:177]
    s_waitcnt lgkmcnt(0)
    v_mul_f32 v220, v170, v220
    v_mul_f32 v221, v170, v221
    v_mfma_f32_16x16x32_bf16 v[174:177], v[234:237], v[102:105], v[174:177]
    s_add_u32 s23, s23, s35
    v_cvt_pk_f16_f32 v123, v220, v221
    v_cvt_pk_bf16_f32 v166, v146, v147
    v_mfma_f32_16x16x32_bf16 v[118:121], v[234:237], a[236:239], 0
    v_cvt_pk_bf16_f32 v167, v148, v149
    v_cvt_pk_bf16_f32 v198, v198, v198
    v_mfma_f32_16x16x32_bf16 v[118:121], v[234:237], v[86:89], v[118:121]
    v_cvt_pk_bf16_f32 v199, v199, v199
    v_cvt_pk_bf16_f32 v200, v200, v200
    v_mfma_f32_16x16x32_bf16 v[118:121], v[234:237], v[110:113], v[118:121]
    ds_write2_b32 v165, v198, v199 offset0:0 offset1:68
    v_mfma_f32_16x16x32_bf16 v[238:241], a[140:143], v[194:197], v[238:241]
    v_cvt_pk_bf16_f32 v201, v201, v201
    v_cvt_pk_bf16_f32 v242, v242, v242
    v_mfma_f32_16x16x32_bf16 v[146:149], a[0:3], v[154:157], 0
    ds_write2_b32 v165, v200, v201 offset0:136 offset1:204
    v_mfma_f32_16x16x32_bf16 v[146:149], a[4:7], v[158:161], v[146:149]
    v_cvt_pk_bf16_f32 v243, v243, v243
    v_mov_b32 v164, v118
    v_mfma_f32_16x16x32_bf16 v[146:149], a[8:11], v[226:229], v[146:149]
    ds_write2_b32 v165, v242, v243 offset0:16 offset1:84
    v_mfma_f32_16x16x32_bf16 v[146:149], a[12:15], v[150:153], v[146:149]
    v_mov_b32_dpp v164, v174 quad_perm:[0,1,2,3] row_mask:0x2 bank_mask:0xf
    v_mov_b32_dpp v164, v175 quad_perm:[0,1,2,3] row_mask:0x4 bank_mask:0xf
    v_mfma_f32_16x16x32_bf16 v[146:149], a[16:19], v[202:205], v[146:149]
    v_mov_b32_dpp v164, v119 quad_perm:[0,1,2,3] row_mask:0x8 bank_mask:0xf
    v_cvt_pk_bf16_f32 v244, v244, v244
    v_mfma_f32_16x16x32_bf16 v[146:149], a[20:23], v[194:197], v[146:149]
    ds_write_b32 v135, v164 offset:2048
    v_mfma_f32_16x16x32_bf16 v[118:121], a[24:27], v[154:157], 0
    v_cvt_pk_bf16_f32 v245, v245, v245
    v_cvt_pk_bf16_f32 v186, v186, v186
    v_mfma_f32_16x16x32_bf16 v[118:121], a[28:31], v[158:161], v[118:121]
    ds_write2_b32 v165, v244, v245 offset0:152 offset1:220
    v_mfma_f32_16x16x32_bf16 v[118:121], a[32:35], v[226:229], v[118:121]
    v_cvt_pk_bf16_f32 v187, v187, v187
    v_cvt_pk_bf16_f32 v188, v188, v188
    v_mfma_f32_16x16x32_bf16 v[118:121], a[36:39], v[150:153], v[118:121]
    ds_write2_b32 v165, v186, v187 offset0:32 offset1:100
    v_mfma_f32_16x16x32_bf16 v[118:121], a[40:43], v[202:205], v[118:121]
    v_cvt_pk_bf16_f32 v189, v189, v189
    v_cvt_pk_bf16_f32 v182, v182, v182
    v_mfma_f32_16x16x32_bf16 v[118:121], a[44:47], v[194:197], v[118:121]
    ds_write2_b32 v165, v188, v189 offset0:168 offset1:236
    v_mfma_f32_16x16x32_bf16 v[134:137], a[48:51], v[154:157], 0
    s_waitcnt lgkmcnt(3)
    v_cvt_pk_bf16_f32 v183, v183, v183
    v_cvt_pk_bf16_f32 v184, v184, v184
    v_mfma_f32_16x16x32_bf16 v[134:137], a[52:55], v[158:161], v[134:137]
    s_barrier
    ds_read_b128 v[174:177], v254 offset:0
    ds_read_b128 v[242:245], v254 offset:1024
    v_mfma_f32_16x16x32_bf16 v[134:137], a[56:59], v[226:229], v[134:137]
    ds_read_b128 v[198:201], v254 offset:2048
    v_cvt_pk_bf16_f32 v185, v185, v185
    v_mfma_f32_16x16x32_bf16 v[134:137], a[60:63], v[150:153], v[134:137]
    ds_write2_b32 v168, v182, v183 offset0:0 offset1:68
    v_mfma_f32_16x16x32_bf16 v[134:137], a[64:67], v[202:205], v[134:137]
    v_cvt_pk_bf16_f32 v222, v222, v222
    v_cvt_pk_bf16_f32 v223, v223, v223
    v_mfma_f32_16x16x32_bf16 v[134:137], a[68:71], v[194:197], v[134:137]
    ds_write2_b32 v168, v184, v185 offset0:136 offset1:204
    v_mfma_f32_16x16x32_bf16 v[182:185], v[154:157], a[144:147], 0
    v_cvt_pk_bf16_f32 v224, v224, v224
    v_cvt_pk_bf16_f32 v225, v225, v225
    v_mfma_f32_16x16x32_bf16 v[182:185], v[158:161], a[148:151], v[182:185]
    ds_write2_b32 v168, v222, v223 offset0:16 offset1:84
    v_mfma_f32_16x16x32_bf16 v[182:185], v[226:229], a[152:155], v[182:185]
    s_waitcnt lgkmcnt(4)
    v_add_f32 v174, v174, v175
    v_add_f32 v176, v176, v177
    v_mfma_f32_16x16x32_bf16 v[182:185], v[150:153], a[156:159], v[182:185]
    s_waitcnt lgkmcnt(3)
    ds_write2_b32 v168, v224, v225 offset0:152 offset1:220
    v_mfma_f32_16x16x32_bf16 v[182:185], v[202:205], a[160:163], v[182:185]
    v_add_f32 v174, v174, v176
    v_mul_f32 v174, 0xbbaaaaab, v174
    v_mfma_f32_16x16x32_bf16 v[182:185], v[194:197], a[164:167], v[182:185]
    ds_write_b32 v130, v174 offset:0
    v_mfma_f32_16x16x32_bf16 v[174:177], v[154:157], a[168:171], 0
    v_add_f32 v242, v242, v243
    v_add_f32 v244, v244, v245
    v_mfma_f32_16x16x32_bf16 v[174:177], v[158:161], a[172:175], v[174:177]
    ds_read_b128 v[222:225], v133 offset:0
    ds_read_b128 v[218:221], v133 offset:64
    v_mfma_f32_16x16x32_bf16 v[174:177], v[226:229], a[176:179], v[174:177]
    v_add_f32 v242, v242, v244
    v_mul_f32 v242, 0xbbaaaaab, v242
    v_mfma_f32_16x16x32_bf16 v[174:177], v[150:153], a[180:183], v[174:177]
    ds_read_b128 v[186:189], v0 offset:32768
    v_add_f32 v198, v198, v199
    v_mfma_f32_16x16x32_bf16 v[174:177], v[202:205], a[184:187], v[174:177]
    ds_read_b128 v[170:173], v1 offset:32768
    v_add_f32 v200, v200, v201
    v_mfma_f32_16x16x32_bf16 v[174:177], v[194:197], a[188:191], v[174:177]
    ds_read_b128 v[234:237], v0 offset:32896
    v_add_f32 v198, v198, v200
    v_mfma_f32_16x16x32_bf16 v[206:209], v[154:157], a[192:195], 0
    ds_read_b128 v[154:157], v1 offset:32896
    v_mul_f32 v198, 0xbbaaaaab, v198
    v_mfma_f32_16x16x32_bf16 v[206:209], v[158:161], a[196:199], v[206:209]
    ds_read_b128 v[158:161], v0 offset:33024
    v_cvt_pk_bf16_f32 v178, v178, v178
    v_mfma_f32_16x16x32_bf16 v[206:209], v[226:229], a[200:203], v[206:209]
    ds_read_b128 v[226:229], v1 offset:33024
    v_cvt_pk_bf16_f32 v179, v179, v179
    v_mfma_f32_16x16x32_bf16 v[206:209], v[150:153], a[204:207], v[206:209]
    s_waitcnt lgkmcnt(6)
    ds_write_b32 v130, v242 offset:256
    v_mfma_f32_16x16x32_bf16 v[206:209], v[202:205], a[208:211], v[206:209]
    v_cvt_pk_bf16_f32 v180, v180, v180
    v_cvt_pk_bf16_f32 v181, v181, v181
    v_mfma_f32_16x16x32_bf16 v[206:209], v[194:197], a[212:215], v[206:209]
    s_waitcnt lgkmcnt(6)
    ds_write_b32 v130, v198 offset:512
    v_mfma_f32_16x16x32_bf16 v[150:153], a[72:75], v[186:189], 0
    s_waitcnt lgkmcnt(6)
    v_cvt_pk_bf16_f32 v192, v182, v183
    v_cvt_pk_bf16_f32 v193, v184, v185
    v_mfma_f32_16x16x32_bf16 v[150:153], a[76:79], v[170:173], v[150:153]
    s_waitcnt lgkmcnt(5)
    ds_write2_b32 v168, v178, v179 offset0:32 offset1:100
    v_mfma_f32_16x16x32_bf16 v[150:153], a[80:83], v[234:237], v[150:153]
    s_waitcnt lgkmcnt(4)
    v_fma_f32 v169, v146, v146, s32
    v_fmac_f32 v169, v147, v147
    v_mfma_f32_16x16x32_bf16 v[150:153], a[84:87], v[154:157], v[150:153]
    s_waitcnt lgkmcnt(3)
    ds_write2_b32 v168, v180, v181 offset0:168 offset1:236
    v_mfma_f32_16x16x32_bf16 v[150:153], a[88:91], v[158:161], v[150:153]
    v_fmac_f32 v169, v148, v148
    v_fmac_f32 v169, v149, v149
    v_mfma_f32_16x16x32_bf16 v[150:153], a[92:95], v[226:229], v[150:153]
    v_fmac_f32 v169, v118, v118
    v_fmac_f32 v169, v119, v119
    v_mfma_f32_16x16x32_bf16 v[182:185], a[96:99], v[186:189], 0
    v_fmac_f32 v169, v120, v120
    v_fmac_f32 v169, v121, v121
    v_mfma_f32_16x16x32_bf16 v[182:185], a[100:103], v[170:173], v[182:185]
    v_fmac_f32 v169, v134, v134
    v_fmac_f32 v169, v135, v135
    v_mfma_f32_16x16x32_bf16 v[182:185], a[104:107], v[234:237], v[182:185]
    v_fmac_f32 v169, v136, v136
    v_fmac_f32 v169, v137, v137
    v_mfma_f32_16x16x32_bf16 v[182:185], a[108:111], v[154:157], v[182:185]
    v_fma_f32 v168, v210, v210, s32
    v_fmac_f32 v168, v211, v211
    v_mfma_f32_16x16x32_bf16 v[182:185], a[112:115], v[158:161], v[182:185]
    v_fmac_f32 v168, v212, v212
    v_fmac_f32 v168, v213, v213
    v_mfma_f32_16x16x32_bf16 v[182:185], a[116:119], v[226:229], v[182:185]
    v_fmac_f32 v168, v138, v138
    v_fmac_f32 v168, v139, v139
    v_mfma_f32_16x16x32_bf16 v[198:201], a[120:123], v[186:189], 0
    v_fmac_f32 v168, v140, v140
    v_fmac_f32 v168, v141, v141
    v_mfma_f32_16x16x32_bf16 v[198:201], a[124:127], v[170:173], v[198:201]
    v_fmac_f32 v168, v238, v238
    v_fmac_f32 v168, v239, v239
    v_mfma_f32_16x16x32_bf16 v[198:201], a[128:131], v[234:237], v[198:201]
    v_fmac_f32 v168, v240, v240
    v_fmac_f32 v168, v241, v241
    v_mfma_f32_16x16x32_bf16 v[198:201], a[132:135], v[154:157], v[198:201]
    v_cvt_pk_bf16_f32 v36, v169, v168
    v_cvt_pk_bf16_f32 v164, v174, v175
    v_mfma_f32_16x16x32_bf16 v[198:201], a[136:139], v[158:161], v[198:201]
    v_cvt_pk_bf16_f32 v165, v176, v177
    v_cvt_pk_bf16_f32 v168, v206, v207
    v_mfma_f32_16x16x32_bf16 v[242:245], v[32:35], v[36:39], 0
    v_cvt_pk_bf16_f32 v169, v208, v209
    v_fma_f32 v142, v150, v150, s32
    v_mfma_f32_16x16x32_bf16 v[198:201], a[140:143], v[226:229], v[198:201]
    v_fmac_f32 v142, v151, v151
    v_fmac_f32 v142, v152, v152
    v_mfma_f32_16x16x32_bf16 v[178:181], a[0:3], v[186:189], 0
    v_fmac_f32 v142, v153, v153
    v_fmac_f32 v142, v182, v182
    v_mfma_f32_16x16x32_bf16 v[178:181], a[4:7], v[170:173], v[178:181]
    v_rsq_f32 v243, v243
    v_mfma_f32_16x16x32_bf16 v[178:181], a[8:11], v[234:237], v[178:181]
    v_rsq_f32 v242, v242
    v_mfma_f32_16x16x32_bf16 v[178:181], a[12:15], v[154:157], v[178:181]
    v_mul_f32 v242, s31, v242
    v_mul_f32 v210, v243, v210
    v_mfma_f32_16x16x32_bf16 v[178:181], a[16:19], v[158:161], v[178:181]
    v_mul_f32 v211, v243, v211
    v_cvt_pk_f16_f32 v210, v210, v211
    v_mfma_f32_16x16x32_bf16 v[178:181], a[20:23], v[226:229], v[178:181]
    v_mul_f32 v212, v243, v212
    v_mul_f32 v213, v243, v213
    v_mfma_f32_16x16x32_bf16 v[174:177], a[24:27], v[186:189], 0
    v_cvt_pk_f16_f32 v211, v212, v213
    v_mul_f32 v138, v243, v138
    v_mfma_f32_16x16x32_bf16 v[174:177], a[28:31], v[170:173], v[174:177]
    v_mul_f32 v139, v243, v139
    v_cvt_pk_f16_f32 v212, v138, v139
    v_mfma_f32_16x16x32_bf16 v[174:177], a[32:35], v[234:237], v[174:177]
    v_mul_f32 v140, v243, v140
    v_mul_f32 v141, v243, v141
    v_mfma_f32_16x16x32_bf16 v[174:177], a[36:39], v[154:157], v[174:177]
    v_cvt_pk_f16_f32 v213, v140, v141
    v_mul_f32 v238, v243, v238
    v_mfma_f32_16x16x32_bf16 v[174:177], a[40:43], v[158:161], v[174:177]
    v_mul_f32 v239, v243, v239
    v_cvt_pk_f16_f32 v204, v238, v239
    v_mfma_f32_16x16x32_bf16 v[174:177], a[44:47], v[226:229], v[174:177]
    v_mul_f32 v240, v243, v240
    v_mul_f32 v241, v243, v241
    v_mfma_f32_16x16x32_bf16 v[138:141], a[48:51], v[186:189], 0
    v_cvt_pk_f16_f32 v205, v240, v241
    v_mul_f32 v146, v242, v146
    v_mfma_f32_16x16x32_bf16 v[138:141], a[52:55], v[170:173], v[138:141]
    ds_read_b128 v[206:209], v5 offset:0
    ds_read_b128 v[194:197], v5 offset:16
    v_mfma_f32_16x16x32_bf16 v[138:141], a[56:59], v[234:237], v[138:141]
    ds_read_b128 v[238:241], v5 offset:48
    ds_read_b32 v143, v6 offset:192
    v_mfma_f32_16x16x32_bf16 v[138:141], a[60:63], v[154:157], v[138:141]
    v_mul_f32 v147, v242, v147
    v_cvt_pk_f16_f32 v146, v146, v147
    v_mfma_f32_16x16x32_bf16 v[138:141], a[64:67], v[158:161], v[138:141]
    v_mul_f32 v148, v242, v148
    v_mul_f32 v149, v242, v149
    v_mfma_f32_16x16x32_bf16 v[138:141], a[68:71], v[226:229], v[138:141]
    v_cvt_pk_f16_f32 v147, v148, v149
    v_mul_f32 v118, v242, v118
    v_mul_f32 v119, v242, v119
    v_cvt_pk_f16_f32 v148, v118, v119
    v_mul_f32 v120, v242, v120
    v_mul_f32 v121, v242, v121
    v_cvt_pk_f16_f32 v149, v120, v121
    v_mfma_f32_16x16x32_bf16 v[118:121], v[186:189], a[144:147], 0
    v_mul_f32 v134, v242, v134
    v_mul_f32 v135, v242, v135
    v_mfma_f32_16x16x32_bf16 v[118:121], v[170:173], a[148:151], v[118:121]
    s_waitcnt lgkmcnt(3)
    v_cvt_pk_f16_f32 v202, v134, v135
    v_mul_f32 v136, v242, v136
    v_mfma_f32_16x16x32_bf16 v[118:121], v[234:237], a[152:155], v[118:121]
    s_waitcnt lgkmcnt(1)
    v_mul_f32 v137, v242, v137
    v_cvt_pk_f16_f32 v203, v136, v137
    v_mfma_f32_16x16x32_bf16 v[118:121], v[154:157], a[156:159], v[118:121]
    s_waitcnt lgkmcnt(0)
    v_fma_f32 v254, v178, v178, s32
    v_fmac_f32 v254, v179, v179
    v_mfma_f32_16x16x32_bf16 v[118:121], v[158:161], a[160:163], v[118:121]
    v_fmac_f32 v254, v180, v180
    v_fmac_f32 v254, v181, v181
    v_mfma_f32_16x16x32_bf16 v[118:121], v[226:229], a[164:167], v[118:121]
    v_fmac_f32 v254, v174, v174
    v_fmac_f32 v254, v175, v175
    v_fmac_f32 v254, v176, v176
    v_fmac_f32 v254, v177, v177
    v_fmac_f32 v254, v138, v138
    v_fmac_f32 v254, v139, v139
    v_fmac_f32 v254, v140, v140
    v_fmac_f32 v254, v141, v141
    v_cvt_pk_bf16_f32 v134, v118, v119
    v_cvt_pk_bf16_f32 v135, v120, v121
    v_mfma_f32_16x16x32_f16 v[118:121], v[206:209], v[126:129], v[22:25]
    v_fmac_f32 v142, v183, v183
    v_fmac_f32 v142, v184, v184
    v_mfma_f32_16x16x32_f16 v[118:121], v[194:197], v[114:117], v[118:121]
    v_fmac_f32 v142, v185, v185
    v_fmac_f32 v142, v198, v198
    v_mfma_f32_16x16x32_f16 v[118:121], v[238:241], v[122:125], v[118:121]
    v_fmac_f32 v142, v199, v199
    v_fmac_f32 v142, v200, v200
    v_fmac_f32 v142, v201, v201
    v_cvt_pk_bf16_f32 v36, v254, v142
    v_mfma_f32_16x16x32_bf16 v[242:245], v[186:189], a[168:171], 0
    v_xor_b32 v0, 65536, v0
    v_xor_b32 v1, 65536, v1
    v_mfma_f32_16x16x32_bf16 v[242:245], v[170:173], a[172:175], v[242:245]
    v_mov_b32_dpp v143, v119 quad_perm:[0,1,2,3] row_mask:0x1 bank_mask:0xf
    v_add_u32 v5, 336, v5
    v_mfma_f32_16x16x32_bf16 v[242:245], v[234:237], a[176:179], v[242:245]
    v_xor_b32 v2, 65536, v2
    v_mfma_f32_16x16x32_bf16 v[242:245], v[154:157], a[180:183], v[242:245]
    v_mfma_f32_16x16x32_bf16 v[242:245], v[158:161], a[184:187], v[242:245]
    v_mfma_f32_16x16x32_bf16 v[242:245], v[226:229], a[188:191], v[242:245]
    s_nop 0
    s_nop 0
    s_nop 0
    s_nop 0
    s_nop 0
    s_nop 0
    s_nop 0
    s_nop 0
    v_cvt_pk_bf16_f32 v246, v242, v243
    v_cvt_pk_bf16_f32 v247, v244, v245
    v_mfma_f32_16x16x32_bf16 v[242:245], v[32:35], v[36:39], 0
    s_nop 0
    s_nop 0
    s_nop 0
    s_nop 0
    s_nop 0
    s_nop 0
    s_nop 0
    s_nop 0
    v_rsq_f32 v243, v243
    v_rsq_f32 v242, v242
    v_mul_f32 v150, v243, v150
    v_mul_f32 v242, s31, v242
    v_mul_f32 v151, v243, v151
    v_cvt_pk_f16_f32 v150, v150, v151
    v_mul_f32 v152, v243, v152
    v_mul_f32 v153, v243, v153
    v_cvt_pk_f16_f32 v151, v152, v153
    v_mul_f32 v182, v243, v182
    v_mul_f32 v183, v243, v183
    v_cvt_pk_f16_f32 v152, v182, v183
    v_mfma_f32_16x16x32_f16 v[230:233], v[206:209], v[146:149], v[24:27]
    v_mul_f32 v184, v243, v184
    v_mul_f32 v185, v243, v185
    v_mfma_f32_16x16x32_f16 v[230:233], v[194:197], v[210:213], v[230:233]
    v_cvt_pk_f16_f32 v153, v184, v185
    v_mul_f32 v198, v243, v198
    v_mfma_f32_16x16x32_f16 v[230:233], v[238:241], v[202:205], v[230:233]
    v_mul_f32 v199, v243, v199
    v_cvt_pk_f16_f32 v216, v198, v199
    v_mfma_f32_16x16x32_bf16 v[182:185], v[186:189], a[192:195], 0
    v_mul_f32 v200, v243, v200
    v_mul_f32 v201, v243, v201
    v_mfma_f32_16x16x32_bf16 v[182:185], v[170:173], a[196:199], v[182:185]
    v_cvt_pk_f16_f32 v217, v200, v201
    v_mul_f32 v178, v242, v178
    v_mfma_f32_16x16x32_bf16 v[182:185], v[234:237], a[200:203], v[182:185]
    v_mul_f32 v179, v242, v179
    v_cvt_pk_f16_f32 v198, v178, v179
    v_mfma_f32_16x16x32_bf16 v[182:185], v[154:157], a[204:207], v[182:185]
    v_mul_f32 v180, v242, v180
    v_mul_f32 v181, v242, v181
    v_mfma_f32_16x16x32_bf16 v[182:185], v[158:161], a[208:211], v[182:185]
    v_cvt_pk_f16_f32 v199, v180, v181
    v_mul_f32 v174, v242, v174
    v_mfma_f32_16x16x32_bf16 v[182:185], v[226:229], a[212:215], v[182:185]
    s_waitcnt vmcnt(0)
    ds_read2_b32 v[136:137], v6 offset0:0 offset1:0
    ds_read2_b32 v[248:249], v6 offset0:16 offset1:16
    v_mfma_f32_16x16x32_f16 v[226:229], v[114:117], v[126:129], v[46:49]
    s_barrier
    buffer_load_dwordx4 v10, s[8:11], 0 offen nt lds
    ds_read2_b32 v[160:161], v6 offset0:32 offset1:32
    v_mfma_f32_16x16x32_f16 v[154:157], v[210:213], v[126:129], v[50:53]
    s_add_u32 m0, s28, 4096
    v_cvt_pk_bf16_f32 v158, v182, v183
    v_cvt_pk_bf16_f32 v159, v184, v185
    v_mfma_f32_16x16x32_f16 v[182:185], v[150:153], v[126:129], v[54:57]
    v_mul_f32 v175, v242, v175
    v_cvt_pk_f16_f32 v200, v174, v175
    v_mul_f32 v176, v242, v176
    v_mfma_f32_16x16x16_f16 v[226:229], v[124:125], v[122:123], v[226:229]
    v_mul_f32 v177, v242, v177
    v_cvt_pk_f16_f32 v201, v176, v177
    v_mul_f32 v138, v242, v138
    v_mfma_f32_16x16x16_f16 v[154:157], v[204:205], v[122:123], v[154:157]
    v_mul_f32 v139, v242, v139
    v_cvt_pk_f16_f32 v214, v138, v139
    v_mul_f32 v140, v242, v140
    v_mfma_f32_16x16x16_f16 v[182:185], v[216:217], v[122:123], v[182:185]
    v_mul_f32 v141, v242, v141
    v_cvt_pk_f16_f32 v215, v140, v141
    v_mov_b32_dpp v143, v231 quad_perm:[0,1,2,3] row_mask:0x2 bank_mask:0xf
    v_max3_f32 v142, v118, v226, v227
    v_mfma_f32_16x16x32_f16 v[138:141], v[206:209], v[198:201], v[26:29]
    s_waitcnt lgkmcnt(1)
    buffer_load_dwordx4 v11, s[8:11], 0 offen nt lds
    v_max3_f32 v142, v142, v228, v229
    v_mfma_f32_16x16x32_f16 v[138:141], v[194:197], v[150:153], v[138:141]
    s_add_u32 m0, s28, 8192
    v_max3_f32 v142, v142, v154, v155
    v_max3_f32 v142, v142, v156, v157
    v_mfma_f32_16x16x32_f16 v[138:141], v[238:241], v[214:217], v[138:141]
    s_waitcnt lgkmcnt(0)
    v_max3_f32 v142, v142, v182, v183
    v_max3_f32 v142, v142, v184, v185
    v_mov_b32 v122, v142
    v_mfma_f32_16x16x16_bf16 v[126:129], a[216:217], v[144:145], v[222:225]
    v_add_u32 v6, 272, v6
    v_permlane32_swap_b32 v142, v122
    v_mfma_f32_16x16x16_bf16 v[174:177], a[240:241], v[144:145], v[222:225]
    v_max_f32 v142, v142, v122
    v_mov_b32 v122, v142
    v_mov_b32_dpp v143, v139 quad_perm:[0,1,2,3] row_mask:0x4 bank_mask:0xf
    v_mfma_f32_16x16x16_bf16 v[242:245], v[90:91], v[144:145], v[222:225]
    v_permlane16_swap_b32 v142, v122
    v_max_f32 v142, v142, v122
    v_mfma_f32_16x16x16_bf16 v[178:181], a[218:219], v[144:145], v[218:221]
    v_sub_f32 v226, v226, v142
    v_exp_f32 v226, v226
    v_mfma_f32_16x16x16_bf16 v[170:173], a[242:243], v[144:145], v[218:221]
    v_sub_f32 v227, v227, v142
    v_exp_f32 v227, v227
    v_mfma_f32_16x16x16_bf16 v[222:225], v[92:93], v[144:145], v[218:221]
    buffer_load_dwordx4 v12, s[8:11], 0 offen nt lds
    s_add_u32 m0, s28, 12288
    s_xor_b32 s28, s28, 65536
    v_cvt_pk_bf16_f32 v226, v226, v227
    v_sub_f32 v228, v228, v142
    v_exp_f32 v228, v228
    v_sub_f32 v229, v229, v142
    v_exp_f32 v229, v229
    v_sub_f32 v154, v154, v142
    v_cvt_pk_bf16_f32 v227, v228, v229
    v_exp_f32 v154, v154
    v_mfma_f32_16x16x32_f16 v[218:221], v[114:117], v[146:149], v[58:61]
    buffer_load_dwordx4 v13, s[8:11], 0 offen nt lds
    s_mov_b32 m0, s29
    s_xor_b32 s29, s29, s30
    v_sub_f32 v155, v155, v142
    v_exp_f32 v155, v155
    v_sub_f32 v156, v156, v142
    v_mfma_f32_16x16x16_f16 v[218:221], v[124:125], v[202:203], v[218:221]
    v_cvt_pk_bf16_f32 v228, v154, v155
    v_exp_f32 v156, v156
    v_sub_f32 v157, v157, v142
    v_exp_f32 v157, v157
    v_sub_f32 v182, v182, v142
    v_cvt_pk_bf16_f32 v229, v156, v157
    buffer_load_dwordx4 v14, s[8:11], 0 offen nt lds
    v_exp_f32 v182, v182
    v_mfma_f32_16x16x32_f16 v[154:157], v[210:213], v[146:149], v[62:65]
    v_sub_f32 v183, v183, v142
    v_exp_f32 v183, v183
    v_sub_f32 v184, v184, v142
    v_cvt_pk_bf16_f32 v36, v182, v183
    v_exp_f32 v184, v184
    v_sub_f32 v185, v185, v142
    v_mfma_f32_16x16x16_f16 v[154:157], v[204:205], v[202:203], v[154:157]
    v_exp_f32 v185, v185
    v_sub_f32 v118, v118, v142
    v_cvt_pk_bf16_f32 v37, v184, v185
    v_mfma_f32_16x16x32_f16 v[182:185], v[150:153], v[146:149], v[66:69]
    v_exp_f32 v118, v118
    v_max3_f32 v142, v230, v218, v219
    v_cvt_pk_bf16_f32 v39, v118, 0
    v_max3_f32 v142, v142, v220, v221
    v_max3_f32 v142, v142, v154, v155
    v_mfma_f32_16x16x32_bf16 v[118:121], v[28:31], v[36:39], 0
    v_max3_f32 v142, v142, v156, v157
    v_cvt_pk_bf16_f32 v126, v126, v127
    v_mfma_f32_16x16x32_bf16 v[118:121], v[28:31], v[226:229], v[118:121]
    v_accvgpr_write_b32 a216, v126
    v_cvt_pk_bf16_f32 v128, v128, v129
    v_mfma_f32_16x16x32_bf16 v[146:149], v[134:137], v[36:39], 0
    v_accvgpr_write_b32 a217, v128
    v_cvt_pk_bf16_f32 v174, v174, v175
    v_mfma_f32_16x16x32_bf16 v[146:149], v[190:193], v[226:229], v[146:149]
    v_accvgpr_write_b32 a240, v174
    v_cvt_pk_bf16_f32 v176, v176, v177
    v_mfma_f32_16x16x32_bf16 v[126:129], v[246:249], v[36:39], 0
    v_rcp_f32 v118, v118
    v_mfma_f32_16x16x32_bf16 v[126:129], v[162:165], v[226:229], v[126:129]
    v_accvgpr_write_b32 a241, v176
    v_cvt_pk_bf16_f32 v90, v242, v243
    v_mfma_f32_16x16x32_bf16 v[174:177], v[158:161], v[36:39], 0
    v_mul_f32 v146, v118, v146
    v_mul_f32 v147, v118, v147
    v_mfma_f32_16x16x32_bf16 v[174:177], v[166:169], v[226:229], v[174:177]
    v_cvt_pk_bf16_f32 v146, v146, v147
    v_mul_f32 v148, v118, v148
    v_mul_f32 v149, v118, v149
    v_mfma_f32_16x16x16_f16 v[182:185], v[216:217], v[202:203], v[182:185]
    v_cvt_pk_bf16_f32 v147, v148, v149
    v_mul_f32 v126, v118, v126
    v_mul_f32 v127, v118, v127
    v_cvt_pk_bf16_f32 v148, v126, v127
    v_mul_f32 v128, v118, v128
    v_mul_f32 v129, v118, v129
    v_cvt_pk_bf16_f32 v149, v128, v129
    ds_write_b128 v3, v[146:149] offset:0
    v_mul_f32 v174, v118, v174
    v_mul_f32 v175, v118, v175
    v_cvt_pk_bf16_f32 v122, v174, v175
    v_mul_f32 v176, v118, v176
    v_mul_f32 v177, v118, v177
    v_cvt_pk_bf16_f32 v123, v176, v177
    v_max3_f32 v142, v142, v182, v183
    ds_write_b64 v4, v[122:123] offset:4096
    v_max3_f32 v142, v142, v184, v185
    v_mov_b32 v122, v142
    v_cvt_pk_bf16_f32 v91, v244, v245
    ds_read_b128 v[118:121], v133 offset:128
    v_permlane32_swap_b32 v142, v122
    v_max_f32 v142, v142, v122
    v_mov_b32 v122, v142
    v_cvt_pk_bf16_f32 v178, v178, v179
    v_accvgpr_write_b32 a218, v178
    v_permlane16_swap_b32 v142, v122
    v_max_f32 v142, v142, v122
    v_sub_f32 v218, v218, v142
    v_exp_f32 v218, v218
    v_sub_f32 v219, v219, v142
    v_exp_f32 v219, v219
    v_sub_f32 v220, v220, v142
    v_cvt_pk_bf16_f32 v126, v218, v219
    v_exp_f32 v220, v220
    v_sub_f32 v221, v221, v142
    v_exp_f32 v221, v221
    v_sub_f32 v154, v154, v142
    v_cvt_pk_bf16_f32 v127, v220, v221
    v_exp_f32 v154, v154
    v_sub_f32 v155, v155, v142
    s_waitcnt lgkmcnt(0)
    v_mfma_f32_16x16x16_bf16 v[174:177], a[232:233], v[144:145], v[118:121]
    v_exp_f32 v155, v155
    v_sub_f32 v156, v156, v142
    v_mfma_f32_16x16x16_bf16 v[226:229], v[82:83], v[144:145], v[118:121]
    v_cvt_pk_bf16_f32 v128, v154, v155
    v_exp_f32 v156, v156
    v_mfma_f32_16x16x16_bf16 v[146:149], v[106:107], v[144:145], v[118:121]
    v_sub_f32 v157, v157, v142
    v_exp_f32 v157, v157
    v_sub_f32 v182, v182, v142
    v_cvt_pk_bf16_f32 v129, v156, v157
    v_exp_f32 v182, v182
    v_sub_f32 v183, v183, v142
    v_exp_f32 v183, v183
    v_sub_f32 v184, v184, v142
    v_cvt_pk_bf16_f32 v36, v182, v183
    v_exp_f32 v184, v184
    v_sub_f32 v185, v185, v142
    v_exp_f32 v185, v185
    v_mfma_f32_16x16x32_f16 v[218:221], v[114:117], v[198:201], v[70:73]
    v_cvt_pk_bf16_f32 v37, v184, v185
    v_sub_f32 v230, v230, v142
    v_mfma_f32_16x16x32_f16 v[154:157], v[210:213], v[198:201], v[74:77]
    v_exp_f32 v230, v230
    v_mfma_f32_16x16x32_f16 v[118:121], v[150:153], v[198:201], v[78:81]
    v_cvt_pk_bf16_f32 v39, v230, 0
    v_cvt_pk_bf16_f32 v180, v180, v181
    v_accvgpr_write_b32 a219, v180
    v_mfma_f32_16x16x32_bf16 v[150:153], v[28:31], v[36:39], 0
    v_cvt_pk_bf16_f32 v170, v170, v171
    v_accvgpr_write_b32 a242, v170
    v_mfma_f32_16x16x32_bf16 v[150:153], v[28:31], v[126:129], v[150:153]
    v_cvt_pk_bf16_f32 v172, v172, v173
    v_accvgpr_write_b32 a243, v172
    v_mfma_f32_16x16x32_bf16 v[170:173], v[134:137], v[36:39], 0
    v_cvt_pk_bf16_f32 v92, v222, v223
    v_cvt_pk_bf16_f32 v93, v224, v225
    v_mfma_f32_16x16x32_bf16 v[170:173], v[190:193], v[126:129], v[170:173]
    ds_read_b128 v[114:117], v133 offset:192
    v_cvt_pk_bf16_f32 v174, v174, v175
    v_mfma_f32_16x16x32_bf16 v[186:189], v[246:249], v[36:39], 0
    v_accvgpr_write_b32 a232, v174
    v_cvt_pk_bf16_f32 v176, v176, v177
    v_mfma_f32_16x16x32_bf16 v[186:189], v[162:165], v[126:129], v[186:189]
    v_accvgpr_write_b32 a233, v176
    v_cvt_pk_bf16_f32 v82, v226, v227
    v_mfma_f32_16x16x32_bf16 v[178:181], v[158:161], v[36:39], 0
    v_cvt_pk_bf16_f32 v83, v228, v229
    v_cvt_pk_bf16_f32 v106, v146, v147
    v_mfma_f32_16x16x32_bf16 v[178:181], v[166:169], v[126:129], v[178:181]
    v_cvt_pk_bf16_f32 v107, v148, v149
    v_rcp_f32 v150, v150
    v_mfma_f32_16x16x16_f16 v[218:221], v[124:125], v[214:215], v[218:221]
    v_mov_b32 v142, v143
    v_mul_f32 v170, v150, v170
    v_mul_f32 v171, v150, v171
    v_mfma_f32_16x16x16_f16 v[154:157], v[204:205], v[214:215], v[154:157]
    v_max_f32_dpp v142, v142, v142 quad_perm:[1,0,3,2] row_mask:0xf bank_mask:0xf
    v_cvt_pk_bf16_f32 v130, v170, v171
    v_mul_f32 v172, v150, v172
    v_mfma_f32_16x16x16_f16 v[118:121], v[216:217], v[214:215], v[118:121]
    s_waitcnt lgkmcnt(0)
    ds_read_b128 v[126:129], v133 offset:256
    v_max3_f32 v132, v138, v218, v219
    v_mfma_f32_16x16x16_bf16 v[122:125], a[220:221], v[144:145], v[114:117]
    v_max3_f32 v132, v132, v220, v221
    v_max3_f32 v132, v132, v154, v155
    v_max3_f32 v132, v132, v156, v157
    v_mfma_f32_16x16x16_bf16 v[146:149], a[244:245], v[144:145], v[114:117]
    v_max3_f32 v132, v132, v118, v119
    v_max3_f32 v132, v132, v120, v121
    v_mov_b32 v131, v132
    v_mfma_f32_16x16x16_bf16 v[182:185], v[94:95], v[144:145], v[114:117]
    v_cvt_pk_bf16_f32 v122, v122, v123
    v_accvgpr_write_b32 a220, v122
    v_cvt_pk_bf16_f32 v124, v124, v125
    v_accvgpr_write_b32 a221, v124
    v_cvt_pk_bf16_f32 v146, v146, v147
    v_accvgpr_write_b32 a244, v146
    v_cvt_pk_bf16_f32 v148, v148, v149
    v_accvgpr_write_b32 a245, v148
    v_cvt_pk_bf16_f32 v94, v182, v183
    v_cvt_pk_bf16_f32 v95, v184, v185
    ds_read_b128 v[122:125], v133 offset:320
    v_permlane32_swap_b32 v132, v131
    v_max_f32 v132, v132, v131
    v_mov_b32 v131, v132
    s_waitcnt lgkmcnt(1)
    v_mfma_f32_16x16x16_bf16 v[114:117], a[222:223], v[144:145], v[126:129]
    v_permlane16_swap_b32 v132, v131
    v_max_f32 v132, v132, v131
    v_mfma_f32_16x16x16_bf16 v[182:185], a[246:247], v[144:145], v[126:129]
    v_sub_f32 v218, v218, v132
    v_exp_f32 v218, v218
    v_mfma_f32_16x16x16_bf16 v[146:149], v[96:97], v[144:145], v[126:129]
    v_sub_f32 v219, v219, v132
    v_exp_f32 v219, v219
    v_cvt_pk_bf16_f32 v114, v114, v115
    v_accvgpr_write_b32 a222, v114
    v_cvt_pk_bf16_f32 v116, v116, v117
    v_accvgpr_write_b32 a223, v116
    v_cvt_pk_bf16_f32 v182, v182, v183
    v_accvgpr_write_b32 a246, v182
    v_cvt_pk_bf16_f32 v184, v184, v185
    v_accvgpr_write_b32 a247, v184
    v_cvt_pk_bf16_f32 v96, v146, v147
    v_cvt_pk_bf16_f32 v97, v148, v149
    s_waitcnt lgkmcnt(0)
    v_mfma_f32_16x16x16_bf16 v[114:117], a[234:235], v[144:145], v[122:125]
    ds_read_b128 v[206:209], v133 offset:384
    v_cvt_pk_bf16_f32 v146, v218, v219
    v_sub_f32 v220, v220, v132
    v_mfma_f32_16x16x16_bf16 v[174:177], v[84:85], v[144:145], v[122:125]
    v_exp_f32 v220, v220
    v_sub_f32 v221, v221, v132
    v_mfma_f32_16x16x16_bf16 v[126:129], v[108:109], v[144:145], v[122:125]
    ds_read_b128 v[182:185], v0 offset:20480
    ds_read_b128 v[198:201], v1 offset:20480
    ds_read_b128 v[210:213], v0 offset:20608
    ds_read_b128 v[222:225], v1 offset:20608
    ds_read_b128 v[226:229], v0 offset:20736
    ds_read_b128 v[242:245], v1 offset:20736
    v_cvt_pk_bf16_f32 v114, v114, v115
    v_accvgpr_write_b32 a234, v114
    v_cvt_pk_bf16_f32 v116, v116, v117
    v_accvgpr_write_b32 a235, v116
    v_cvt_pk_bf16_f32 v84, v174, v175
    s_waitcnt lgkmcnt(6)
    v_mfma_f32_16x16x16_bf16 v[122:125], a[224:225], v[144:145], v[206:209]
    v_cvt_pk_bf16_f32 v85, v176, v177
    v_cvt_pk_bf16_f32 v108, v126, v127
    v_cvt_pk_bf16_f32 v109, v128, v129
    v_mfma_f32_16x16x16_bf16 v[174:177], a[248:249], v[144:145], v[206:209]
    v_exp_f32 v221, v221
    v_sub_f32 v154, v154, v132
    v_mfma_f32_16x16x16_bf16 v[126:129], v[98:99], v[144:145], v[206:209]
    s_waitcnt lgkmcnt(4)
    ds_read_b128 v[202:205], v133 offset:448
    v_cvt_pk_bf16_f32 v122, v122, v123
    v_accvgpr_write_b32 a224, v122
    v_mfma_f32_16x16x32_bf16 v[114:117], a[72:75], v[182:185], 0
    s_waitcnt lgkmcnt(3)
    v_cvt_pk_bf16_f32 v124, v124, v125
    v_accvgpr_write_b32 a225, v124
    v_mfma_f32_16x16x32_bf16 v[114:117], a[76:79], v[198:201], v[114:117]
    s_waitcnt lgkmcnt(2)
    v_cvt_pk_bf16_f32 v174, v174, v175
    v_accvgpr_write_b32 a248, v174
    v_mfma_f32_16x16x32_bf16 v[114:117], a[80:83], v[210:213], v[114:117]
    s_waitcnt lgkmcnt(1)
    v_cvt_pk_bf16_f32 v176, v176, v177
    v_accvgpr_write_b32 a249, v176
    v_mfma_f32_16x16x32_bf16 v[114:117], a[84:87], v[222:225], v[114:117]
    v_cvt_pk_bf16_f32 v98, v126, v127
    v_cvt_pk_bf16_f32 v99, v128, v129
    v_mfma_f32_16x16x32_bf16 v[114:117], a[88:91], v[226:229], v[114:117]
    ds_read_b128 v[126:129], v133 offset:512
    v_cvt_pk_bf16_f32 v147, v220, v221
    v_mfma_f32_16x16x32_bf16 v[114:117], a[92:95], v[242:245], v[114:117]
    v_exp_f32 v154, v154
    v_mfma_f32_16x16x32_bf16 v[122:125], a[96:99], v[182:185], 0
    s_waitcnt lgkmcnt(1)
    v_sub_f32 v155, v155, v132
    v_exp_f32 v155, v155
    v_mfma_f32_16x16x16_bf16 v[174:177], a[226:227], v[144:145], v[202:205]
    v_cvt_pk_bf16_f32 v148, v154, v155
    v_sub_f32 v156, v156, v132
    v_sub_f32 v157, v157, v132
    v_mfma_f32_16x16x16_bf16 v[218:221], a[250:251], v[144:145], v[202:205]
    v_exp_f32 v156, v156
    v_sub_f32 v118, v118, v132
    v_mfma_f32_16x16x16_bf16 v[206:209], v[100:101], v[144:145], v[202:205]
    v_exp_f32 v157, v157
    v_cvt_pk_bf16_f32 v174, v174, v175
    v_accvgpr_write_b32 a226, v174
    v_mfma_f32_16x16x32_bf16 v[122:125], a[100:103], v[198:201], v[122:125]
    v_cvt_pk_bf16_f32 v176, v176, v177
    v_accvgpr_write_b32 a227, v176
    v_mfma_f32_16x16x32_bf16 v[122:125], a[104:107], v[210:213], v[122:125]
    s_waitcnt lgkmcnt(0)
    v_cvt_pk_bf16_f32 v218, v218, v219
    v_accvgpr_write_b32 a250, v218
    v_cvt_pk_bf16_f32 v220, v220, v221
    v_mfma_f32_16x16x16_bf16 v[174:177], a[236:237], v[144:145], v[126:129]
    v_accvgpr_write_b32 a251, v220
    v_cvt_pk_bf16_f32 v100, v206, v207
    v_cvt_pk_bf16_f32 v101, v208, v209
    v_mfma_f32_16x16x16_bf16 v[218:221], v[86:87], v[144:145], v[126:129]
    v_cvt_pk_bf16_f32 v149, v156, v157
    v_exp_f32 v118, v118
    v_mfma_f32_16x16x16_bf16 v[206:209], v[110:111], v[144:145], v[126:129]
    v_sub_f32 v119, v119, v132
    v_cvt_pk_bf16_f32 v174, v174, v175
    v_accvgpr_write_b32 a236, v174
    v_cvt_pk_bf16_f32 v176, v176, v177
    v_mfma_f32_16x16x32_bf16 v[122:125], a[108:111], v[222:225], v[122:125]
    ds_read_b128 v[154:157], v133 offset:576
    v_accvgpr_write_b32 a237, v176
    v_mfma_f32_16x16x32_bf16 v[122:125], a[112:115], v[226:229], v[122:125]
    v_cvt_pk_bf16_f32 v86, v218, v219
    v_cvt_pk_bf16_f32 v87, v220, v221
    v_mfma_f32_16x16x32_bf16 v[122:125], a[116:119], v[242:245], v[122:125]
    v_cvt_pk_bf16_f32 v110, v206, v207
    v_cvt_pk_bf16_f32 v111, v208, v209
    v_mfma_f32_16x16x32_bf16 v[126:129], a[120:123], v[182:185], 0
    ds_read_b128 v[174:177], v133 offset:640
    v_sub_f32 v120, v120, v132
    v_mfma_f32_16x16x32_bf16 v[126:129], a[124:127], v[198:201], v[126:129]
    v_exp_f32 v119, v119
    v_mfma_f32_16x16x32_bf16 v[126:129], a[128:131], v[210:213], v[126:129]
    v_cvt_pk_bf16_f32 v36, v118, v119
    v_sub_f32 v121, v121, v132
    v_mfma_f32_16x16x32_bf16 v[126:129], a[132:135], v[222:225], v[126:129]
    v_exp_f32 v120, v120
    v_mfma_f32_16x16x32_bf16 v[126:129], a[136:139], v[226:229], v[126:129]
    v_exp_f32 v121, v121
    v_mfma_f32_16x16x32_bf16 v[126:129], a[140:143], v[242:245], v[126:129]
    s_waitcnt lgkmcnt(1)
    v_cvt_pk_bf16_f32 v37, v120, v121
    v_sub_f32 v138, v138, v132
    v_max_f32_dpp v142, v142, v142 quad_perm:[2,3,0,1] row_mask:0xf bank_mask:0xf
    v_mfma_f32_16x16x16_bf16 v[118:121], a[228:229], v[144:145], v[154:157]
    v_exp_f32 v138, v138
    v_max_f32_dpp v142, v142, v142 row_half_mirror row_mask:0xf bank_mask:0xf
    v_mfma_f32_16x16x16_bf16 v[218:221], a[252:253], v[144:145], v[154:157]
    v_cvt_pk_bf16_f32 v39, v138, 0
    v_max_f32_dpp v142, v142, v142 row_mirror row_mask:0xf bank_mask:0xf
    v_mov_b32 v254, v142
    v_mul_f32 v173, v150, v173
    v_mfma_f32_16x16x32_bf16 v[206:209], v[28:31], v[36:39], 0
    s_waitcnt lgkmcnt(0)
    v_cvt_pk_bf16_f32 v118, v118, v119
    v_accvgpr_write_b32 a228, v118
    v_mfma_f32_16x16x32_bf16 v[206:209], v[28:31], v[146:149], v[206:209]
    v_cvt_pk_bf16_f32 v120, v120, v121
    v_accvgpr_write_b32 a229, v120
    v_mfma_f32_16x16x32_bf16 v[138:141], v[134:137], v[36:39], 0
    v_cvt_pk_bf16_f32 v218, v218, v219
    v_accvgpr_write_b32 a252, v218
    v_mfma_f32_16x16x32_bf16 v[138:141], v[190:193], v[146:149], v[138:141]
    v_cvt_pk_bf16_f32 v220, v220, v221
    v_accvgpr_write_b32 a253, v220
    v_mfma_f32_16x16x32_bf16 v[118:121], v[246:249], v[36:39], 0
    v_rcp_f32 v206, v206
    v_mfma_f32_16x16x32_bf16 v[118:121], v[162:165], v[146:149], v[118:121]
    v_permlane32_swap_b32 v142, v254
    v_mfma_f32_16x16x32_bf16 v[218:221], v[158:161], v[36:39], 0
    v_max_f32 v142, v142, v254
    v_mul_f32 v138, v206, v138
    v_mfma_f32_16x16x32_bf16 v[218:221], v[166:169], v[146:149], v[218:221]
    v_mul_f32 v139, v206, v139
    v_cvt_pk_bf16_f32 v146, v138, v139
    v_mul_f32 v140, v206, v140
    v_mfma_f32_16x16x16_bf16 v[202:205], v[102:103], v[144:145], v[154:157]
    v_mul_f32 v141, v206, v141
    v_cvt_pk_bf16_f32 v147, v140, v141
    v_mul_f32 v118, v206, v118
    v_mfma_f32_16x16x16_bf16 v[138:141], a[230:231], v[144:145], v[174:177]
    v_mul_f32 v119, v206, v119
    v_cvt_pk_bf16_f32 v148, v118, v119
    v_mul_f32 v120, v206, v120
    v_mfma_f32_16x16x16_bf16 v[154:157], a[254:255], v[144:145], v[174:177]
    v_mul_f32 v121, v206, v121
    v_cvt_pk_bf16_f32 v149, v120, v121
    v_mul_f32 v218, v206, v218
    v_mfma_f32_16x16x16_bf16 v[118:121], v[104:105], v[144:145], v[174:177]
    v_mul_f32 v219, v206, v219
    v_cvt_pk_bf16_f32 v170, v218, v219
    v_mul_f32 v220, v206, v220
    v_mul_f32 v221, v206, v221
    v_mfma_f32_16x16x32_bf16 v[206:209], a[0:3], v[182:185], 0
    ds_write_b128 v3, v[146:149] offset:12288
    v_mfma_f32_16x16x32_bf16 v[206:209], a[4:7], v[198:201], v[206:209]
    v_cvt_pk_bf16_f32 v171, v220, v221
    v_cvt_pk_bf16_f32 v102, v202, v203
    v_mfma_f32_16x16x32_bf16 v[206:209], a[8:11], v[210:213], v[206:209]
    v_cvt_pk_bf16_f32 v103, v204, v205
    v_cvt_pk_bf16_f32 v138, v138, v139
    v_mfma_f32_16x16x32_bf16 v[206:209], a[12:15], v[222:225], v[206:209]
    ds_read_b128 v[146:149], v133 offset:704
    v_accvgpr_write_b32 a230, v138
    v_mfma_f32_16x16x32_bf16 v[206:209], a[16:19], v[226:229], v[206:209]
    ds_write_b64 v4, v[170:171] offset:16384
    v_mfma_f32_16x16x32_bf16 v[206:209], a[20:23], v[242:245], v[206:209]
    v_cvt_pk_bf16_f32 v140, v140, v141
    v_accvgpr_write_b32 a231, v140
    v_mfma_f32_16x16x32_bf16 v[174:177], a[24:27], v[182:185], 0
    v_cvt_pk_bf16_f32 v154, v154, v155
    v_accvgpr_write_b32 a254, v154
    v_mfma_f32_16x16x32_bf16 v[174:177], a[28:31], v[198:201], v[174:177]
    v_cvt_pk_bf16_f32 v156, v156, v157
    v_accvgpr_write_b32 a255, v156
    v_mfma_f32_16x16x32_bf16 v[174:177], a[32:35], v[210:213], v[174:177]
    v_cvt_pk_bf16_f32 v104, v118, v119
    v_cvt_pk_bf16_f32 v105, v120, v121
    v_mfma_f32_16x16x32_bf16 v[174:177], a[36:39], v[222:225], v[174:177]
    v_mov_b32 v254, v142
    v_cvt_pk_bf16_f32 v131, v172, v173
    v_mfma_f32_16x16x32_bf16 v[174:177], a[40:43], v[226:229], v[174:177]
    s_waitcnt lgkmcnt(1)
    v_permlane16_swap_b32 v142, v254
    v_max_f32 v142, v142, v254
    v_mfma_f32_16x16x16_bf16 v[118:121], a[238:239], v[144:145], v[146:149]
    v_sub_f32 v143, v143, v142
    v_exp_f32 v143, v143
    v_mfma_f32_16x16x16_bf16 v[154:157], v[88:89], v[144:145], v[146:149]
    v_cvt_pk_bf16_f32 v143, v143, v143
    v_mul_f32 v186, v150, v186
    v_mul_f32 v187, v150, v187
    v_mfma_f32_16x16x16_bf16 v[138:141], v[112:113], v[144:145], v[146:149]
    v_cvt_pk_bf16_f32 v132, v186, v187
    v_cvt_pk_bf16_f32 v118, v118, v119
    v_accvgpr_write_b32 a238, v118
    v_cvt_pk_bf16_f32 v120, v120, v121
    v_mfma_f32_16x16x32_bf16 v[174:177], a[44:47], v[242:245], v[174:177]
    ds_write_b16 v8, v143
    v_mfma_f32_16x16x32_bf16 v[218:221], a[48:51], v[182:185], 0
    v_accvgpr_write_b32 a239, v120
    v_cvt_pk_bf16_f32 v88, v154, v155
    v_mfma_f32_16x16x32_bf16 v[218:221], a[52:55], v[198:201], v[218:221]
    ds_read_b128 v[142:145], v9
    ds_read_b128 v[118:121], v9 offset:64
    v_mfma_f32_16x16x32_bf16 v[218:221], a[56:59], v[210:213], v[218:221]
    v_cvt_pk_bf16_f32 v89, v156, v157
    v_cvt_pk_bf16_f32 v112, v138, v139
    v_mfma_f32_16x16x32_bf16 v[218:221], a[60:63], v[222:225], v[218:221]
    v_cvt_pk_bf16_f32 v113, v140, v141
    v_mul_f32 v188, v150, v188
    v_mfma_f32_16x16x32_bf16 v[218:221], a[64:67], v[226:229], v[218:221]
    v_mul_f32 v189, v150, v189
    v_cvt_pk_bf16_f32 v133, v188, v189
    v_mfma_f32_16x16x32_bf16 v[218:221], a[68:71], v[242:245], v[218:221]
    ds_write_b128 v3, v[130:133] offset:6144
    v_mfma_f32_16x16x32_bf16 v[170:173], v[182:185], a[144:147], 0
    v_mul_f32 v178, v150, v178
    v_mul_f32 v179, v150, v179
    v_mfma_f32_16x16x32_bf16 v[170:173], v[198:201], a[148:151], v[170:173]
    v_cvt_pk_bf16_f32 v254, v178, v179
    v_mul_f32 v180, v150, v180
    v_mfma_f32_16x16x32_bf16 v[170:173], v[210:213], a[152:155], v[170:173]
    s_waitcnt lgkmcnt(1)
    v_mul_f32 v181, v150, v181
    v_cvt_pk_bf16_f32 v255, v180, v181
    v_mfma_f32_16x16x32_bf16 v[130:133], v[142:145], v[28:31], 0
    ds_write_b64 v4, v[254:255] offset:10240
    v_mfma_f32_16x16x32_bf16 v[130:133], v[118:121], v[28:31], v[130:133]
    v_xor_b32 v3, 65536, v3
    v_xor_b32 v4, 65536, v4
    v_mfma_f32_16x16x32_bf16 v[154:157], v[142:145], v[190:193], 0
    v_mfma_f32_16x16x32_bf16 v[154:157], v[118:121], v[134:137], v[154:157]
    v_mfma_f32_16x16x32_bf16 v[134:137], v[142:145], v[162:165], 0
    v_mfma_f32_16x16x32_bf16 v[134:137], v[118:121], v[246:249], v[134:137]
    v_mfma_f32_16x16x32_bf16 v[162:165], v[142:145], v[166:169], 0
    v_mfma_f32_16x16x32_bf16 v[162:165], v[118:121], v[158:161], v[162:165]
    v_rcp_f32 v130, v130
    v_mfma_f32_16x16x32_bf16 v[170:173], v[222:225], a[156:159], v[170:173]
    v_mfma_f32_16x16x32_bf16 v[170:173], v[226:229], a[160:163], v[170:173]
    v_mfma_f32_16x16x32_bf16 v[170:173], v[242:245], a[164:167], v[170:173]
    v_mul_f32 v154, v154, v130
    s_nop 0
    v_mul_f32_dpp v154, v134, v130 quad_perm:[0,1,2,3] row_mask:0x2 bank_mask:0xf
    s_nop 0
    v_mul_f32_dpp v154, v162, v130 quad_perm:[0,1,2,3] row_mask:0x4 bank_mask:0xf
    v_cvt_pk_bf16_f32 v154, v154, v154
    ds_write_b16 v7, v154
    v_add_u32 v7, 16, v7
    s_waitcnt lgkmcnt(0)
    s_barrier
    s_waitcnt lgkmcnt(0)
    s_cmp_eq_u32 s17, 1
    s_cbranch_scc1 L_drain
    s_max_u32 s3, s37, s44
    s_cmp_gt_u32 s3, 0x42000000
    s_cbranch_scc1 L_safe
    v_cvt_pk_f16_f32 v118, v114, v115
    v_pk_mul_f16 v163, v118, v118
    v_cvt_pk_f16_f32 v119, v116, v117
    v_pk_mul_f16 v165, v119, v119
    v_cvt_pk_f16_f32 v120, v122, v123
    v_pk_fma_f16 v163, v120, v120, v163
    v_cvt_pk_f16_f32 v121, v124, v125
    v_pk_fma_f16 v165, v121, v121, v165
    v_cvt_pk_f16_f32 v196, v126, v127
    v_pk_fma_f16 v163, v196, v196, v163
    v_cvt_pk_f16_f32 v197, v128, v129
    v_pk_fma_f16 v165, v197, v197, v165
    v_cvt_pk_f16_f32 v206, v206, v207
    s_nop 7
    s_branch L_go
L_safe:
    v_fma_f32 v130, v114, v114, s32
    v_fmac_f32 v130, v115, v115
    v_fmac_f32 v130, v116, v116
    v_fmac_f32 v130, v117, v117
    v_fmac_f32 v130, v122, v122
    v_fmac_f32 v130, v123, v123
    v_fmac_f32 v130, v124, v124
    v_fmac_f32 v130, v125, v125
    v_fmac_f32 v130, v126, v126
    v_fmac_f32 v130, v127, v127
    v_fmac_f32 v130, v128, v128
    v_fmac_f32 v130, v129, v129
    v_fma_f32 v131, v206, v206, s32
    v_fmac_f32 v131, v207, v207
    v_fmac_f32 v131, v208, v208
    v_fmac_f32 v131, v209, v209
    v_fmac_f32 v131, v174, v174
    s_nop 7
    s_cmp_eq_u32 s16, 1
    s_cbranch_scc1 L_loop_safe1
    s_cmp_eq_u32 s16, 2
    s_cbranch_scc1 L_loop_safe2
    s_cmp_eq_u32 s16, 3
    s_cbranch_scc1 L_loop_safe3
    s_branch L_loop_safe0
.p2align 6
L_loop_safe0:
    v_mfma_f32_16x16x32_bf16 v[162:165], v[182:185], a[168:171], 0
    s_add_u32 s12, s42, s27
    ds_read_b128 v[194:197], v2 offset:18432
    ds_read_b128 v[230:233], v2 offset:19456
    v_mfma_f32_16x16x32_bf16 v[162:165], v[198:201], a[172:175], v[162:165]
    s_addc_u32 s13, s43, 0
    v_fmac_f32 v131, v175, v175
    v_fmac_f32 v131, v176, v176
    v_mfma_f32_16x16x32_bf16 v[162:165], v[210:213], a[176:179], v[162:165]
    s_sub_u32 s14, s36, s27
    v_fmac_f32 v131, v177, v177
    v_fmac_f32 v131, v218, v218
    v_mfma_f32_16x16x32_bf16 v[162:165], v[222:225], a[180:183], v[162:165]
    s_cmp_ge_u32 s18, 2
    v_fmac_f32 v131, v219, v219
    v_fmac_f32 v131, v220, v220
    v_mfma_f32_16x16x32_bf16 v[162:165], v[226:229], a[184:187], v[162:165]
    s_cselect_b32 s14, s14, 0
    ds_read_b128 v[118:121], v0 offset:26624
    v_fmac_f32 v131, v221, v221
    v_mfma_f32_16x16x32_bf16 v[162:165], v[242:245], a[188:191], v[162:165]
    s_add_u32 s34, s18, 2
    ds_read_b128 v[134:137], v1 offset:26624
    v_cvt_pk_bf16_f32 v36, v131, v130
    v_mfma_f32_16x16x32_bf16 v[214:217], v[182:185], a[192:195], 0
    s_add_u32 s8, s40, s23
    ds_read_b128 v[154:157], v0 offset:26752
    v_cvt_pk_bf16_f32 v170, v170, v171
    v_mfma_f32_16x16x32_bf16 v[214:217], v[198:201], a[196:199], v[214:217]
    s_addc_u32 s9, s41, 0
    ds_read_b128 v[198:201], v1 offset:26752
    v_cvt_pk_bf16_f32 v171, v172, v173
    v_mfma_f32_16x16x32_bf16 v[166:169], v[32:35], v[36:39], 0
    s_sub_u32 s10, s36, s23
    v_cvt_pk_bf16_f32 v130, v162, v163
    v_cvt_pk_bf16_f32 v131, v164, v165
    v_mfma_f32_16x16x32_bf16 v[214:217], v[210:213], a[200:203], v[214:217]
    s_waitcnt lgkmcnt(4)
    ds_read_b128 v[210:213], v0 offset:26880
    s_cmp_lt_u32 s34, s17
    v_mfma_f32_16x16x32_bf16 v[234:237], v[32:35], v[194:197], 0
    s_cselect_b32 s10, s10, 0
    v_rsq_f32 v167, v167
    v_mfma_f32_16x16x32_bf16 v[234:237], v[32:35], v[230:233], v[234:237]
    s_add_u32 m0, s28, 0
    v_rsq_f32 v166, v166
    v_mfma_f32_16x16x32_bf16 v[214:217], v[222:225], a[204:207], v[214:217]
    s_waitcnt lgkmcnt(4)
    ds_read_b128 v[162:165], v1 offset:26880
    v_mul_f32 v166, s31, v166
    v_mfma_f32_16x16x32_bf16 v[214:217], v[226:229], a[208:211], v[214:217]
    s_mov_b32 s27, s26
    v_mul_f32 v114, v167, v114
    v_mul_f32 v115, v167, v115
    v_mfma_f32_16x16x32_bf16 v[214:217], v[242:245], a[212:215], v[214:217]
    s_mov_b32 s26, s25
    v_cvt_pk_f16_f32 v242, v114, v115
    v_mul_f32 v116, v167, v116
    v_mfma_f32_16x16x32_bf16 v[226:229], a[72:75], v[118:121], 0
    s_waitcnt lgkmcnt(2)
    v_mul_f32 v117, v167, v117
    v_cvt_pk_f16_f32 v243, v116, v117
    v_mfma_f32_16x16x32_bf16 v[226:229], a[76:79], v[134:137], v[226:229]
    s_mov_b32 s25, s24
    v_cvt_pk_bf16_f32 v114, v214, v215
    v_cvt_pk_bf16_f32 v115, v216, v217
    v_mfma_f32_16x16x32_bf16 v[226:229], a[80:83], v[154:157], v[226:229]
    s_mov_b32 s24, s23
    v_mul_f32 v122, v167, v122
    v_mul_f32 v123, v167, v123
    v_mfma_f32_16x16x32_bf16 v[226:229], a[84:87], v[198:201], v[226:229]
    s_waitcnt lgkmcnt(1)
    v_cvt_pk_f16_f32 v244, v122, v123
    v_mul_f32 v124, v167, v124
    v_mfma_f32_16x16x32_bf16 v[226:229], a[88:91], v[210:213], v[226:229]
    v_mul_f32 v125, v167, v125
    v_cvt_pk_f16_f32 v245, v124, v125
    v_mfma_f32_16x16x32_bf16 v[122:125], a[96:99], v[118:121], 0
    s_waitcnt lgkmcnt(0)
    v_mul_f32 v126, v167, v126
    v_mul_f32 v127, v167, v127
    v_mfma_f32_16x16x32_bf16 v[226:229], a[92:95], v[162:165], v[226:229]
    v_cvt_pk_f16_f32 v184, v126, v127
    v_mul_f32 v128, v167, v128
    v_mfma_f32_16x16x32_bf16 v[122:125], a[100:103], v[134:137], v[122:125]
    v_mul_f32 v129, v167, v129
    v_cvt_pk_f16_f32 v185, v128, v129
    v_mfma_f32_16x16x32_bf16 v[122:125], a[104:107], v[154:157], v[122:125]
    v_mul_f32 v206, v166, v206
    v_mul_f32 v207, v166, v207
    v_mfma_f32_16x16x32_bf16 v[122:125], a[108:111], v[198:201], v[122:125]
    v_cvt_pk_f16_f32 v222, v206, v207
    v_mul_f32 v208, v166, v208
    v_mfma_f32_16x16x32_bf16 v[122:125], a[112:115], v[210:213], v[122:125]
    v_mul_f32 v209, v166, v209
    v_cvt_pk_f16_f32 v223, v208, v209
    v_mfma_f32_16x16x32_bf16 v[122:125], a[116:119], v[162:165], v[122:125]
    v_mul_f32 v174, v166, v174
    v_mul_f32 v175, v166, v175
    v_mfma_f32_16x16x32_bf16 v[126:129], a[120:123], v[118:121], 0
    v_cvt_pk_f16_f32 v224, v174, v175
    v_mul_f32 v176, v166, v176
    v_mfma_f32_16x16x32_bf16 v[126:129], a[124:127], v[134:137], v[126:129]
    v_mul_f32 v177, v166, v177
    v_cvt_pk_f16_f32 v225, v176, v177
    v_mfma_f32_16x16x32_bf16 v[126:129], a[128:131], v[154:157], v[126:129]
    v_mul_f32 v218, v166, v218
    v_mul_f32 v219, v166, v219
    v_mfma_f32_16x16x32_bf16 v[126:129], a[132:135], v[198:201], v[126:129]
    v_cvt_pk_f16_f32 v182, v218, v219
    v_mul_f32 v220, v166, v220
    v_mfma_f32_16x16x32_bf16 v[126:129], a[136:139], v[210:213], v[126:129]
    v_mul_f32 v221, v166, v221
    v_cvt_pk_f16_f32 v183, v220, v221
    v_mfma_f32_16x16x32_bf16 v[126:129], a[140:143], v[162:165], v[126:129]
    v_fma_f32 v116, v226, v226, s32
    v_fmac_f32 v116, v227, v227
    v_mfma_f32_16x16x32_bf16 v[206:209], a[0:3], v[118:121], 0
    v_fmac_f32 v116, v228, v228
    v_fmac_f32 v116, v229, v229
    v_mfma_f32_16x16x32_bf16 v[206:209], a[4:7], v[134:137], v[206:209]
    v_fmac_f32 v116, v122, v122
    v_fmac_f32 v116, v123, v123
    v_mfma_f32_16x16x32_bf16 v[206:209], a[8:11], v[154:157], v[206:209]
    v_fmac_f32 v116, v124, v124
    v_fmac_f32 v116, v125, v125
    v_mfma_f32_16x16x32_bf16 v[206:209], a[12:15], v[198:201], v[206:209]
    v_fmac_f32 v116, v126, v126
    v_fmac_f32 v116, v127, v127
    v_mfma_f32_16x16x32_bf16 v[206:209], a[16:19], v[210:213], v[206:209]
    v_fmac_f32 v116, v128, v128
    v_fmac_f32 v116, v129, v129
    v_mfma_f32_16x16x32_bf16 v[206:209], a[20:23], v[162:165], v[206:209]
    v_mul_f32 v117, 0x3baaaaab, v234
    v_mul_f32 v254, 0x3baaaaab, v235
    v_mfma_f32_16x16x32_bf16 v[174:177], a[24:27], v[118:121], 0
    v_rsq_f32 v117, v117
    v_mfma_f32_16x16x32_bf16 v[174:177], a[28:31], v[134:137], v[174:177]
    v_rsq_f32 v254, v254
    v_mfma_f32_16x16x32_bf16 v[174:177], a[32:35], v[154:157], v[174:177]
    v_mul_f32 v255, 0x3baaaaab, v236
    v_fma_f32 v132, v206, v206, s32
    v_mfma_f32_16x16x32_bf16 v[174:177], a[36:39], v[198:201], v[174:177]
    v_fmac_f32 v132, v207, v207
    v_fmac_f32 v132, v208, v208
    v_mfma_f32_16x16x32_bf16 v[174:177], a[40:43], v[210:213], v[174:177]
    v_fmac_f32 v132, v209, v209
    v_mul_f32 v150, v117, v150
    v_mfma_f32_16x16x32_bf16 v[174:177], a[44:47], v[162:165], v[174:177]
    v_rsq_f32 v255, v255
    v_mfma_f32_16x16x32_bf16 v[218:221], a[48:51], v[118:121], 0
    v_mul_f32 v151, v117, v151
    v_cvt_pk_bf16_f32 v194, v150, v151
    v_mfma_f32_16x16x32_bf16 v[218:221], a[52:55], v[134:137], v[218:221]
    v_mul_f32 v152, v117, v152
    v_mul_f32 v153, v117, v153
    v_mfma_f32_16x16x32_bf16 v[218:221], a[56:59], v[154:157], v[218:221]
    v_fmac_f32 v132, v174, v174
    v_fmac_f32 v132, v175, v175
    v_mfma_f32_16x16x32_bf16 v[218:221], a[60:63], v[198:201], v[218:221]
    v_fmac_f32 v132, v176, v176
    v_fmac_f32 v132, v177, v177
    v_mfma_f32_16x16x32_bf16 v[218:221], a[64:67], v[210:213], v[218:221]
    v_cvt_pk_bf16_f32 v195, v152, v153
    v_mul_f32 v190, v117, v190
    v_mfma_f32_16x16x32_bf16 v[218:221], a[68:71], v[162:165], v[218:221]
    v_mul_f32 v191, v117, v191
    v_cvt_pk_bf16_f32 v196, v190, v191
    v_mfma_f32_16x16x32_bf16 v[150:153], v[118:121], a[144:147], 0
    v_mul_f32 v192, v117, v192
    v_mul_f32 v193, v117, v193
    v_mfma_f32_16x16x32_bf16 v[150:153], v[134:137], a[148:151], v[150:153]
    v_cvt_pk_bf16_f32 v197, v192, v193
    v_mul_f32 v202, v117, v202
    v_mfma_f32_16x16x32_bf16 v[150:153], v[154:157], a[152:155], v[150:153]
    buffer_store_dwordx4 v[194:197], v15, s[12:15], 0 offen nt
    v_fmac_f32 v132, v218, v218
    v_fmac_f32 v132, v219, v219
    v_fmac_f32 v132, v220, v220
    v_fmac_f32 v132, v221, v221
    v_mfma_f32_16x16x32_bf16 v[150:153], v[198:201], a[156:159], v[150:153]
    v_cvt_pk_bf16_f32 v36, v132, v116
    v_mul_f32 v203, v117, v203
    v_mfma_f32_16x16x32_bf16 v[150:153], v[210:213], a[160:163], v[150:153]
    v_cvt_pk_bf16_f32 v116, v202, v203
    v_mul_f32 v204, v117, v204
    v_mfma_f32_16x16x32_bf16 v[190:193], v[32:35], v[36:39], 0
    v_mul_f32 v205, v117, v205
    v_cvt_pk_bf16_f32 v117, v204, v205
    v_mfma_f32_16x16x32_bf16 v[150:153], v[162:165], a[164:167], v[150:153]
    v_mul_f32 v146, v255, v146
    v_mul_f32 v147, v255, v147
    v_mfma_f32_16x16x32_bf16 v[202:205], v[118:121], a[168:171], 0
    v_cvt_pk_bf16_f32 v146, v146, v147
    v_mul_f32 v148, v255, v148
    v_mfma_f32_16x16x32_bf16 v[202:205], v[134:137], a[172:175], v[202:205]
    v_rsq_f32 v191, v191
    v_mfma_f32_16x16x32_bf16 v[202:205], v[154:157], a[176:179], v[202:205]
    v_cvt_pk_bf16_f32 v172, v150, v151
    v_cvt_pk_bf16_f32 v173, v152, v153
    v_mfma_f32_16x16x32_bf16 v[202:205], v[198:201], a[180:183], v[202:205]
    v_rsq_f32 v190, v190
    v_mfma_f32_16x16x32_bf16 v[202:205], v[210:213], a[184:187], v[202:205]
    ds_read_b128 v[150:153], v0 offset:32768
    v_mul_f32 v190, s31, v190
    v_mfma_f32_16x16x32_bf16 v[202:205], v[162:165], a[188:191], v[202:205]
    ds_read_b128 v[166:169], v1 offset:32768
    v_mul_f32 v226, v191, v226
    v_mfma_f32_16x16x32_bf16 v[194:197], v[118:121], a[192:195], 0
    ds_read_b128 v[118:121], v0 offset:32896
    v_mul_f32 v227, v191, v227
    v_mfma_f32_16x16x32_bf16 v[194:197], v[134:137], a[196:199], v[194:197]
    ds_read_b128 v[134:137], v1 offset:32896
    v_cvt_pk_f16_f32 v226, v226, v227
    v_mfma_f32_16x16x32_bf16 v[194:197], v[154:157], a[200:203], v[194:197]
    ds_read_b128 v[154:157], v0 offset:33024
    v_cvt_pk_bf16_f32 v132, v202, v203
    v_mfma_f32_16x16x32_bf16 v[194:197], v[198:201], a[204:207], v[194:197]
    ds_read_b128 v[198:201], v1 offset:33024
    v_cvt_pk_bf16_f32 v133, v204, v205
    v_mfma_f32_16x16x32_bf16 v[194:197], v[210:213], a[208:211], v[194:197]
    v_mul_f32 v228, v191, v228
    v_mul_f32 v229, v191, v229
    v_mfma_f32_16x16x32_bf16 v[194:197], v[162:165], a[212:215], v[194:197]
    v_cvt_pk_f16_f32 v227, v228, v229
    v_mul_f32 v122, v191, v122
    v_mfma_f32_16x16x32_f16 v[210:213], v[242:245], v[222:225], v[46:49]
    s_waitcnt lgkmcnt(5)
    buffer_store_dwordx2 v[116:117], v18, s[12:15], 0 offen nt
    v_mul_f32 v123, v191, v123
    v_cvt_pk_f16_f32 v228, v122, v123
    v_mfma_f32_16x16x32_bf16 v[202:205], a[72:75], v[150:153], 0
    s_waitcnt lgkmcnt(3)
    v_cvt_pk_bf16_f32 v116, v194, v195
    v_cvt_pk_bf16_f32 v117, v196, v197
    v_mfma_f32_16x16x32_bf16 v[202:205], a[76:79], v[166:169], v[202:205]
    s_waitcnt lgkmcnt(2)
    v_mul_f32 v124, v191, v124
    v_mul_f32 v125, v191, v125
    v_mfma_f32_16x16x32_bf16 v[202:205], a[80:83], v[118:121], v[202:205]
    s_waitcnt lgkmcnt(1)
    v_cvt_pk_f16_f32 v229, v124, v125
    v_mul_f32 v126, v191, v126
    v_mfma_f32_16x16x32_bf16 v[202:205], a[84:87], v[134:137], v[202:205]
    s_waitcnt lgkmcnt(0)
    v_mul_f32 v127, v191, v127
    v_cvt_pk_f16_f32 v124, v126, v127
    v_mfma_f32_16x16x32_bf16 v[202:205], a[88:91], v[154:157], v[202:205]
    v_mul_f32 v128, v191, v128
    v_mul_f32 v129, v191, v129
    v_mfma_f32_16x16x32_bf16 v[202:205], a[92:95], v[198:201], v[202:205]
    v_cvt_pk_f16_f32 v125, v128, v129
    v_mul_f32 v206, v190, v206
    v_mfma_f32_16x16x32_bf16 v[126:129], a[96:99], v[150:153], 0
    v_mul_f32 v207, v190, v207
    v_cvt_pk_f16_f32 v206, v206, v207
    v_mfma_f32_16x16x32_bf16 v[126:129], a[100:103], v[166:169], v[126:129]
    v_mul_f32 v208, v190, v208
    v_mul_f32 v209, v190, v209
    v_mfma_f32_16x16x32_bf16 v[126:129], a[104:107], v[118:121], v[126:129]
    v_cvt_pk_f16_f32 v207, v208, v209
    v_mul_f32 v174, v190, v174
    v_mfma_f32_16x16x32_bf16 v[126:129], a[108:111], v[134:137], v[126:129]
    v_mul_f32 v175, v190, v175
    v_cvt_pk_f16_f32 v208, v174, v175
    v_mfma_f32_16x16x32_bf16 v[126:129], a[112:115], v[154:157], v[126:129]
    v_mul_f32 v176, v190, v176
    v_mul_f32 v177, v190, v177
    v_mfma_f32_16x16x32_bf16 v[126:129], a[116:119], v[198:201], v[126:129]
    v_cvt_pk_f16_f32 v209, v176, v177
    v_mul_f32 v218, v190, v218
    v_mfma_f32_16x16x32_bf16 v[174:177], a[120:123], v[150:153], 0
    v_mul_f32 v219, v190, v219
    v_cvt_pk_f16_f32 v122, v218, v219
    v_mfma_f32_16x16x32_bf16 v[174:177], a[124:127], v[166:169], v[174:177]
    v_mul_f32 v220, v190, v220
    v_mul_f32 v221, v190, v221
    v_mfma_f32_16x16x32_bf16 v[174:177], a[128:131], v[118:121], v[174:177]
    v_cvt_pk_f16_f32 v123, v220, v221
    v_fma_f32 v162, v202, v202, s32
    v_mfma_f32_16x16x32_bf16 v[174:177], a[132:135], v[134:137], v[174:177]
    v_fmac_f32 v162, v203, v203
    v_fmac_f32 v162, v204, v204
    v_mfma_f32_16x16x32_bf16 v[174:177], a[136:139], v[154:157], v[174:177]
    v_fmac_f32 v162, v205, v205
    v_fmac_f32 v162, v126, v126
    v_mfma_f32_16x16x32_bf16 v[174:177], a[140:143], v[198:201], v[174:177]
    v_fmac_f32 v162, v127, v127
    v_fmac_f32 v162, v128, v128
    v_mfma_f32_16x16x32_bf16 v[190:193], a[0:3], v[150:153], 0
    v_fmac_f32 v162, v129, v129
    v_mul_f32 v149, v255, v149
    v_mfma_f32_16x16x32_bf16 v[190:193], a[4:7], v[166:169], v[190:193]
    v_cvt_pk_bf16_f32 v147, v148, v149
    v_mul_f32 v138, v255, v138
    v_mfma_f32_16x16x32_bf16 v[190:193], a[8:11], v[118:121], v[190:193]
    v_fmac_f32 v162, v174, v174
    v_fmac_f32 v162, v175, v175
    v_mfma_f32_16x16x32_bf16 v[190:193], a[12:15], v[134:137], v[190:193]
    v_fmac_f32 v162, v176, v176
    v_fmac_f32 v162, v177, v177
    v_mfma_f32_16x16x32_bf16 v[190:193], a[16:19], v[154:157], v[190:193]
    v_mul_f32 v139, v255, v139
    v_cvt_pk_bf16_f32 v148, v138, v139
    v_mfma_f32_16x16x32_bf16 v[190:193], a[20:23], v[198:201], v[190:193]
    v_mul_f32 v140, v255, v140
    v_mul_f32 v141, v255, v141
    v_mfma_f32_16x16x32_bf16 v[218:221], a[24:27], v[150:153], 0
    v_cvt_pk_bf16_f32 v149, v140, v141
    v_mul_f32 v186, v255, v186
    v_mfma_f32_16x16x32_bf16 v[218:221], a[28:31], v[166:169], v[218:221]
    buffer_store_dwordx4 v[146:149], v17, s[12:15], 0 offen nt
    v_mul_f32 v187, v255, v187
    v_fma_f32 v163, v190, v190, s32
    v_fmac_f32 v163, v191, v191
    v_fmac_f32 v163, v192, v192
    v_mfma_f32_16x16x32_bf16 v[218:221], a[32:35], v[118:121], v[218:221]
    v_fmac_f32 v163, v193, v193
    v_cvt_pk_bf16_f32 v164, v186, v187
    v_mfma_f32_16x16x32_bf16 v[218:221], a[36:39], v[134:137], v[218:221]
    v_mul_f32 v188, v255, v188
    v_mul_f32 v189, v255, v189
    v_mfma_f32_16x16x32_bf16 v[218:221], a[40:43], v[154:157], v[218:221]
    v_cvt_pk_bf16_f32 v165, v188, v189
    v_mul_f32 v142, v254, v142
    v_mfma_f32_16x16x32_bf16 v[218:221], a[44:47], v[198:201], v[218:221]
    v_mul_f32 v143, v254, v143
    v_cvt_pk_bf16_f32 v142, v142, v143
    v_mfma_f32_16x16x32_bf16 v[138:141], a[48:51], v[150:153], 0
    v_mul_f32 v144, v254, v144
    v_mul_f32 v145, v254, v145
    v_mfma_f32_16x16x32_bf16 v[138:141], a[52:55], v[166:169], v[138:141]
    v_cvt_pk_bf16_f32 v143, v144, v145
    v_mul_f32 v158, v254, v158
    v_mfma_f32_16x16x32_bf16 v[138:141], a[56:59], v[118:121], v[138:141]
    v_fmac_f32 v163, v218, v218
    v_fmac_f32 v163, v219, v219
    v_mfma_f32_16x16x32_bf16 v[138:141], a[60:63], v[134:137], v[138:141]
    ds_read2_b32 v[196:197], v6 offset0:0 offset1:0
    ds_read2_b32 v[216:217], v6 offset0:16 offset1:16
    v_mfma_f32_16x16x32_bf16 v[138:141], a[64:67], v[154:157], v[138:141]
    ds_read2_b32 v[232:233], v6 offset0:32 offset1:32
    v_fmac_f32 v163, v220, v220
    v_mfma_f32_16x16x32_bf16 v[138:141], a[68:71], v[198:201], v[138:141]
    v_fmac_f32 v163, v221, v221
    v_mul_f32 v159, v254, v159
    v_mfma_f32_16x16x32_bf16 v[146:149], v[150:153], a[144:147], 0
    v_cvt_pk_bf16_f32 v144, v158, v159
    v_mul_f32 v160, v254, v160
    v_mfma_f32_16x16x32_bf16 v[146:149], v[166:169], a[148:151], v[146:149]
    v_mul_f32 v161, v254, v161
    v_cvt_pk_bf16_f32 v145, v160, v161
    v_mfma_f32_16x16x32_bf16 v[146:149], v[118:121], a[152:155], v[146:149]
    v_fmac_f32 v163, v138, v138
    v_fmac_f32 v163, v139, v139
    v_mfma_f32_16x16x32_bf16 v[146:149], v[134:137], a[156:159], v[146:149]
    v_fmac_f32 v163, v140, v140
    v_fmac_f32 v163, v141, v141
    v_mfma_f32_16x16x32_bf16 v[146:149], v[154:157], a[160:163], v[146:149]
    v_cvt_pk_bf16_f32 v36, v163, v162
    v_mul_f32 v178, v254, v178
    v_mfma_f32_16x16x32_bf16 v[146:149], v[198:201], a[164:167], v[146:149]
    s_waitcnt lgkmcnt(1)
    v_mul_f32 v179, v254, v179
    v_cvt_pk_bf16_f32 v178, v178, v179
    v_mfma_f32_16x16x32_bf16 v[158:161], v[32:35], v[36:39], 0
    s_waitcnt lgkmcnt(0)
    buffer_store_dwordx2 v[164:165], v20, s[12:15], 0 offen nt
    v_mul_f32 v180, v254, v180
    v_mul_f32 v181, v254, v181
    v_mfma_f32_16x16x32_bf16 v[186:189], v[150:153], a[168:171], 0
    v_cvt_pk_bf16_f32 v194, v146, v147
    v_cvt_pk_bf16_f32 v195, v148, v149
    v_mfma_f32_16x16x32_bf16 v[186:189], v[166:169], a[172:175], v[186:189]
    v_rsq_f32 v159, v159
    v_mfma_f32_16x16x32_bf16 v[186:189], v[118:121], a[176:179], v[186:189]
    v_rsq_f32 v158, v158
    v_mfma_f32_16x16x32_bf16 v[186:189], v[134:137], a[180:183], v[186:189]
    v_mul_f32 v158, s31, v158
    v_mul_f32 v202, v159, v202
    v_mfma_f32_16x16x32_bf16 v[186:189], v[154:157], a[184:187], v[186:189]
    v_mul_f32 v203, v159, v203
    v_cvt_pk_f16_f32 v146, v202, v203
    v_mfma_f32_16x16x32_bf16 v[186:189], v[198:201], a[188:191], v[186:189]
    v_mul_f32 v204, v159, v204
    v_mul_f32 v205, v159, v205
    v_mfma_f32_16x16x32_bf16 v[162:165], v[150:153], a[192:195], 0
    v_cvt_pk_f16_f32 v147, v204, v205
    v_mul_f32 v126, v159, v126
    v_mfma_f32_16x16x32_bf16 v[162:165], v[166:169], a[196:199], v[162:165]
    ds_read_b128 v[150:153], v5 offset:0
    ds_read_b128 v[202:205], v5 offset:16
    v_mfma_f32_16x16x32_bf16 v[162:165], v[118:121], a[200:203], v[162:165]
    ds_read_b128 v[118:121], v5 offset:48
    ds_read_b32 v254, v6 offset:192
    v_mfma_f32_16x16x32_bf16 v[162:165], v[134:137], a[204:207], v[162:165]
    v_cvt_pk_bf16_f32 v214, v186, v187
    v_cvt_pk_bf16_f32 v215, v188, v189
    v_mfma_f32_16x16x32_bf16 v[162:165], v[154:157], a[208:211], v[162:165]
    v_mul_f32 v127, v159, v127
    v_cvt_pk_f16_f32 v148, v126, v127
    v_mfma_f32_16x16x32_bf16 v[162:165], v[198:201], a[212:215], v[162:165]
    ds_read_b128 v[198:201], v2 offset:0
    ds_read_b128 v[186:189], v2 offset:1024
    v_mfma_f32_16x16x32_f16 v[134:137], v[226:229], v[222:225], v[50:53]
    ds_read_b128 v[154:157], v2 offset:2048
    v_mul_f32 v128, v159, v128
    v_mul_f32 v129, v159, v129
    v_mfma_f32_16x16x16_f16 v[210:213], v[184:185], v[182:183], v[210:213]
    v_cvt_pk_f16_f32 v149, v128, v129
    v_cvt_pk_bf16_f32 v230, v162, v163
    v_cvt_pk_bf16_f32 v231, v164, v165
    v_mul_f32 v174, v159, v174
    v_mfma_f32_16x16x32_f16 v[126:129], v[146:149], v[222:225], v[54:57]
    s_waitcnt lgkmcnt(5)
    v_mul_f32 v175, v159, v175
    v_cvt_pk_f16_f32 v164, v174, v175
    v_mul_f32 v176, v159, v176
    v_mfma_f32_16x16x16_f16 v[134:137], v[124:125], v[182:183], v[134:137]
    v_mul_f32 v177, v159, v177
    v_cvt_pk_f16_f32 v165, v176, v177
    v_mul_f32 v190, v158, v190
    v_mul_f32 v191, v158, v191
    v_mfma_f32_16x16x16_f16 v[126:129], v[164:165], v[182:183], v[126:129]
    v_cvt_pk_f16_f32 v174, v190, v191
    v_mul_f32 v192, v158, v192
    v_mul_f32 v193, v158, v193
    v_cvt_pk_f16_f32 v175, v192, v193
    v_mfma_f32_16x16x32_f16 v[166:169], v[150:153], v[222:225], v[22:25]
    s_waitcnt lgkmcnt(2)
    ds_read_b128 v[222:225], v2 offset:3072
    buffer_store_dwordx4 v[142:145], v16, s[12:15], 0 offen nt
    ds_read_b128 v[234:237], v2 offset:4096
    v_mul_f32 v218, v158, v218
    v_mul_f32 v219, v158, v219
    v_cvt_pk_f16_f32 v176, v218, v219
    v_mfma_f32_16x16x32_f16 v[166:169], v[202:205], v[242:245], v[166:169]
    s_waitcnt lgkmcnt(2)
    v_mul_f32 v220, v158, v220
    v_mul_f32 v221, v158, v221
    v_mfma_f32_16x16x32_f16 v[166:169], v[118:121], v[182:185], v[166:169]
    ds_read_b128 v[142:145], v2 offset:5120
    v_cvt_pk_f16_f32 v177, v220, v221
    v_mul_f32 v138, v158, v138
    v_mul_f32 v139, v158, v139
    v_cvt_pk_f16_f32 v162, v138, v139
    v_mfma_f32_16x16x32_f16 v[218:221], v[150:153], v[206:209], v[24:27]
    v_mul_f32 v140, v158, v140
    v_mul_f32 v141, v158, v141
    v_mfma_f32_16x16x32_f16 v[218:221], v[202:205], v[226:229], v[218:221]
    v_mov_b32_dpp v254, v167 quad_perm:[0,1,2,3] row_mask:0x1 bank_mask:0xf
    v_cvt_pk_f16_f32 v163, v140, v141
    v_mfma_f32_16x16x32_f16 v[218:221], v[118:121], v[122:125], v[218:221]
    v_max3_f32 v255, v166, v210, v211
    v_max3_f32 v255, v255, v212, v213
    v_mfma_f32_16x16x32_f16 v[238:241], v[150:153], v[174:177], v[26:29]
    s_waitcnt lgkmcnt(1)
    v_max3_f32 v255, v255, v134, v135
    v_max3_f32 v255, v255, v136, v137
    v_mfma_f32_16x16x32_f16 v[238:241], v[202:205], v[146:149], v[238:241]
    v_max3_f32 v255, v255, v126, v127
    v_mov_b32_dpp v254, v219 quad_perm:[0,1,2,3] row_mask:0x2 bank_mask:0xf
    v_mfma_f32_16x16x32_f16 v[238:241], v[118:121], v[162:165], v[238:241]
    v_max3_f32 v255, v255, v128, v129
    v_mov_b32 v182, v255
    v_mfma_f32_16x16x32_bf16 v[150:153], a[216:219], v[198:201], 0
    s_waitcnt lgkmcnt(0)
    v_permlane32_swap_b32 v255, v182
    v_mfma_f32_16x16x32_bf16 v[150:153], a[220:223], v[186:189], v[150:153]
    v_max_f32 v255, v255, v182
    v_mov_b32 v182, v255
    v_mfma_f32_16x16x32_bf16 v[150:153], a[224:227], v[154:157], v[150:153]
    v_cvt_pk_bf16_f32 v179, v180, v181
    v_xor_b32 v0, 65536, v0
    v_mfma_f32_16x16x32_bf16 v[150:153], a[228:231], v[222:225], v[150:153]
    s_waitcnt vmcnt(5)
    v_permlane16_swap_b32 v255, v182
    v_mfma_f32_16x16x32_bf16 v[150:153], a[232:235], v[234:237], v[150:153]
    s_barrier
    v_max_f32 v255, v255, v182
    v_sub_f32 v210, v210, v255
    v_mfma_f32_16x16x32_bf16 v[150:153], a[236:239], v[142:145], v[150:153]
    s_nop 0
    v_exp_f32 v210, v210
    v_mfma_f32_16x16x32_bf16 v[190:193], a[240:243], v[198:201], 0
    s_nop 0
    v_sub_f32 v211, v211, v255
    v_sub_f32 v212, v212, v255
    v_mfma_f32_16x16x32_bf16 v[190:193], a[244:247], v[186:189], v[190:193]
    s_nop 0
    buffer_load_dwordx4 v10, s[8:11], 0 offen nt lds
    v_sub_f32 v213, v213, v255
    v_mfma_f32_16x16x32_bf16 v[190:193], a[248:251], v[154:157], v[190:193]
    s_add_u32 m0, s28, 4096
    v_exp_f32 v211, v211
    v_mfma_f32_16x16x32_bf16 v[190:193], a[252:255], v[222:225], v[190:193]
    v_cvt_pk_bf16_f32 v158, v210, v211
    v_sub_f32 v134, v134, v255
    v_mfma_f32_16x16x32_bf16 v[190:193], v[82:85], v[234:237], v[190:193]
    v_exp_f32 v212, v212
    v_mfma_f32_16x16x32_bf16 v[190:193], v[86:89], v[142:145], v[190:193]
    v_exp_f32 v213, v213
    v_mfma_f32_16x16x32_bf16 v[202:205], v[90:93], v[198:201], 0
    ds_read_b128 v[198:201], v2 offset:6144
    buffer_load_dwordx4 v11, s[8:11], 0 offen nt lds
    v_mfma_f32_16x16x32_bf16 v[202:205], v[94:97], v[186:189], v[202:205]
    s_add_u32 m0, s28, 8192
    ds_read_b128 v[138:141], v2 offset:7168
    v_cvt_pk_bf16_f32 v159, v212, v213
    v_mfma_f32_16x16x32_bf16 v[202:205], v[98:101], v[154:157], v[202:205]
    ds_read_b128 v[210:213], v2 offset:8192
    v_sub_f32 v135, v135, v255
    v_mfma_f32_16x16x32_bf16 v[202:205], v[102:105], v[222:225], v[202:205]
    ds_read_b128 v[186:189], v2 offset:9216
    v_sub_f32 v136, v136, v255
    v_mfma_f32_16x16x32_bf16 v[202:205], v[106:109], v[234:237], v[202:205]
    ds_read_b128 v[222:225], v2 offset:10240
    v_sub_f32 v137, v137, v255
    v_mfma_f32_16x16x32_bf16 v[202:205], v[110:113], v[142:145], v[202:205]
    ds_read_b128 v[154:157], v2 offset:11264
    buffer_load_dwordx4 v12, s[8:11], 0 offen nt lds
    v_exp_f32 v134, v134
    v_mfma_f32_16x16x32_f16 v[118:121], v[242:245], v[206:209], v[58:61]
    s_add_u32 m0, s28, 12288
    v_exp_f32 v135, v135
    v_exp_f32 v136, v136
    v_cvt_pk_bf16_f32 v160, v134, v135
    v_exp_f32 v137, v137
    v_sub_f32 v126, v126, v255
    v_mfma_f32_16x16x16_f16 v[118:121], v[184:185], v[122:123], v[118:121]
    v_cvt_pk_bf16_f32 v161, v136, v137
    v_exp_f32 v126, v126
    v_sub_f32 v127, v127, v255
    v_mfma_f32_16x16x32_f16 v[134:137], v[226:229], v[206:209], v[62:65]
    s_xor_b32 s28, s28, 65536
    buffer_load_dwordx4 v13, s[8:11], 0 offen nt lds
    v_exp_f32 v127, v127
    v_sub_f32 v128, v128, v255
    v_cvt_pk_bf16_f32 v36, v126, v127
    v_exp_f32 v128, v128
    v_mfma_f32_16x16x16_f16 v[134:137], v[124:125], v[122:123], v[134:137]
    v_sub_f32 v129, v129, v255
    v_exp_f32 v129, v129
    v_sub_f32 v166, v166, v255
    v_cvt_pk_bf16_f32 v37, v128, v129
    v_mfma_f32_16x16x32_f16 v[126:129], v[146:149], v[206:209], v[66:69]
    s_waitcnt lgkmcnt(0)
    v_exp_f32 v166, v166
    v_mfma_f32_16x16x32_bf16 v[142:145], a[216:219], v[198:201], 0
    s_mov_b32 m0, s29
    v_cvt_pk_bf16_f32 v39, v166, 0
    v_max3_f32 v255, v218, v118, v119
    v_max3_f32 v255, v255, v120, v121
    v_mfma_f32_16x16x16_f16 v[126:129], v[164:165], v[122:123], v[126:129]
    v_max3_f32 v255, v255, v134, v135
    v_max3_f32 v255, v255, v136, v137
    v_xor_b32 v1, 65536, v1
    v_mov_b32_dpp v254, v239 quad_perm:[0,1,2,3] row_mask:0x4 bank_mask:0xf
    v_mfma_f32_16x16x32_bf16 v[206:209], v[28:31], v[36:39], 0
    s_xor_b32 s29, s29, s30
    buffer_store_dwordx2 v[178:179], v19, s[12:15], 0 offen nt
    v_mov_b32 v122, v254
    v_max3_f32 v255, v255, v126, v127
    v_mfma_f32_16x16x32_bf16 v[206:209], v[28:31], v[158:161], v[206:209]
    s_add_u32 s19, s19, s20
    v_max3_f32 v255, v255, v128, v129
    v_mov_b32 v123, v255
    v_mfma_f32_16x16x32_bf16 v[142:145], a[220:223], v[138:141], v[142:145]
    s_add_u32 s23, s23, s21
    v_permlane32_swap_b32 v255, v123
    v_mfma_f32_16x16x32_bf16 v[142:145], a[224:227], v[210:213], v[142:145]
    s_cmp_ge_u32 s19, 72
    v_rcp_f32 v206, v206
    v_mfma_f32_16x16x32_bf16 v[142:145], a[228:231], v[186:189], v[142:145]
    s_cselect_b32 s34, 72, 0
    v_max_f32 v255, v255, v123
    v_mov_b32 v123, v255
    v_mfma_f32_16x16x32_bf16 v[142:145], a[232:235], v[222:225], v[142:145]
    s_cselect_b32 s35, s22, 0
    v_permlane16_swap_b32 v255, v123
    v_mfma_f32_16x16x32_bf16 v[142:145], a[236:239], v[154:157], v[142:145]
    s_sub_u32 s19, s19, s34
    v_max_f32 v255, v255, v123
    v_sub_f32 v118, v118, v255
    v_mfma_f32_16x16x32_bf16 v[178:181], v[194:197], v[36:39], 0
    s_add_u32 s23, s23, s35
    v_exp_f32 v118, v118
    v_mfma_f32_16x16x32_bf16 v[178:181], v[170:173], v[158:161], v[178:181]
    s_add_u32 s18, s18, 1
    v_sub_f32 v119, v119, v255
    v_exp_f32 v119, v119
    v_sub_f32 v120, v120, v255
    v_cvt_pk_bf16_f32 v118, v118, v119
    v_exp_f32 v120, v120
    v_sub_f32 v121, v121, v255
    v_exp_f32 v121, v121
    v_mul_f32 v178, v206, v178
    v_mul_f32 v179, v206, v179
    v_cvt_pk_bf16_f32 v178, v178, v179
    v_mul_f32 v180, v206, v180
    v_mul_f32 v181, v206, v181
    v_cvt_pk_bf16_f32 v179, v180, v181
    v_cvt_pk_bf16_f32 v119, v120, v121
    v_mfma_f32_16x16x32_bf16 v[166:169], v[214:217], v[36:39], 0
    s_cmp_lt_u32 s18, s45
    v_sub_f32 v134, v134, v255
    v_sub_f32 v135, v135, v255
    v_mfma_f32_16x16x32_bf16 v[166:169], v[130:133], v[158:161], v[166:169]
    v_exp_f32 v134, v134
    v_exp_f32 v135, v135
    v_sub_f32 v136, v136, v255
    v_cvt_pk_bf16_f32 v120, v134, v135
    v_exp_f32 v136, v136
    v_sub_f32 v137, v137, v255
    v_exp_f32 v137, v137
    v_sub_f32 v126, v126, v255
    v_mul_f32 v166, v206, v166
    v_mul_f32 v167, v206, v167
    v_cvt_pk_bf16_f32 v180, v166, v167
    v_mul_f32 v168, v206, v168
    v_mul_f32 v169, v206, v169
    v_cvt_pk_bf16_f32 v181, v168, v169
    v_cvt_pk_bf16_f32 v121, v136, v137
    v_mfma_f32_16x16x32_bf16 v[134:137], v[230:233], v[36:39], 0
    buffer_load_dwordx4 v14, s[8:11], 0 offen nt lds
    v_sub_f32 v127, v127, v255
    v_mfma_f32_16x16x32_bf16 v[134:137], v[114:117], v[158:161], v[134:137]
    ds_write_b128 v3, v[178:181] offset:0
    v_mfma_f32_16x16x32_bf16 v[158:161], a[240:243], v[198:201], 0
    v_exp_f32 v126, v126
    v_mfma_f32_16x16x32_bf16 v[158:161], a[244:247], v[138:141], v[158:161]
    v_exp_f32 v127, v127
    v_mfma_f32_16x16x32_bf16 v[158:161], a[248:251], v[210:213], v[158:161]
    v_cvt_pk_bf16_f32 v36, v126, v127
    v_sub_f32 v128, v128, v255
    v_mfma_f32_16x16x32_bf16 v[158:161], a[252:255], v[186:189], v[158:161]
    v_mul_f32 v134, v206, v134
    v_mul_f32 v135, v206, v135
    v_mfma_f32_16x16x32_bf16 v[158:161], v[82:85], v[222:225], v[158:161]
    v_cvt_pk_bf16_f32 v126, v134, v135
    v_mul_f32 v136, v206, v136
    v_mfma_f32_16x16x32_bf16 v[158:161], v[86:89], v[154:157], v[158:161]
    v_mul_f32 v137, v206, v137
    v_cvt_pk_bf16_f32 v127, v136, v137
    v_mfma_f32_16x16x32_bf16 v[178:181], v[90:93], v[198:201], 0
    ds_read_b128 v[198:201], v2 offset:12288
    v_sub_f32 v129, v129, v255
    v_mfma_f32_16x16x32_bf16 v[178:181], v[94:97], v[138:141], v[178:181]
    ds_read_b128 v[206:209], v2 offset:13312
    v_sub_f32 v218, v218, v255
    v_mfma_f32_16x16x32_bf16 v[178:181], v[98:101], v[210:213], v[178:181]
    ds_read_b128 v[210:213], v2 offset:14336
    v_max_f32_dpp v122, v122, v122 quad_perm:[1,0,3,2] row_mask:0xf bank_mask:0xf
    v_mfma_f32_16x16x32_bf16 v[178:181], v[102:105], v[186:189], v[178:181]
    ds_read_b128 v[134:137], v2 offset:15360
    v_max_f32_dpp v122, v122, v122 quad_perm:[2,3,0,1] row_mask:0xf bank_mask:0xf
    v_mfma_f32_16x16x32_bf16 v[178:181], v[106:109], v[222:225], v[178:181]
    ds_read_b128 v[222:225], v2 offset:16384
    v_max_f32_dpp v122, v122, v122 row_half_mirror row_mask:0xf bank_mask:0xf
    v_mfma_f32_16x16x32_bf16 v[178:181], v[110:113], v[154:157], v[178:181]
    ds_read_b128 v[154:157], v2 offset:17408
    ds_write_b64 v4, v[126:127] offset:4096
    v_exp_f32 v128, v128
    v_exp_f32 v129, v129
    v_mfma_f32_16x16x32_f16 v[186:189], v[242:245], v[174:177], v[70:73]
    s_waitcnt lgkmcnt(6)
    v_cvt_pk_bf16_f32 v37, v128, v129
    v_max_f32_dpp v122, v122, v122 row_mirror row_mask:0xf bank_mask:0xf
    v_mfma_f32_16x16x32_f16 v[242:245], v[226:229], v[174:177], v[74:77]
    s_waitcnt lgkmcnt(5)
    v_exp_f32 v218, v218
    v_mfma_f32_16x16x32_f16 v[126:129], v[146:149], v[174:177], v[78:81]
    s_waitcnt lgkmcnt(4)
    v_cvt_pk_bf16_f32 v39, v218, 0
    v_mov_b32 v123, v122
    v_fma_f32 v255, v150, v150, s33
    v_mfma_f32_16x16x32_bf16 v[174:177], v[28:31], v[36:39], 0
    s_waitcnt lgkmcnt(3)
    v_permlane32_swap_b32 v122, v123
    v_mfma_f32_16x16x32_bf16 v[174:177], v[28:31], v[118:121], v[174:177]
    s_waitcnt lgkmcnt(2)
    v_max_f32 v122, v122, v123
    v_mov_b32 v123, v122
    v_mfma_f32_16x16x32_bf16 v[226:229], v[194:197], v[36:39], 0
    s_waitcnt lgkmcnt(0)
    v_permlane16_swap_b32 v122, v123
    v_mfma_f32_16x16x32_bf16 v[226:229], v[170:173], v[118:121], v[226:229]
    v_max_f32 v122, v122, v123
    v_sub_f32 v254, v254, v122
    v_mfma_f32_16x16x32_bf16 v[218:221], v[214:217], v[36:39], 0
    v_exp_f32 v254, v254
    v_mfma_f32_16x16x32_bf16 v[218:221], v[130:133], v[118:121], v[218:221]
    v_cvt_pk_bf16_f32 v254, v254, v254
    v_fmac_f32 v255, v151, v151
    v_mfma_f32_16x16x32_bf16 v[166:169], v[230:233], v[36:39], 0
    ds_write_b16 v8, v254
    v_mfma_f32_16x16x32_bf16 v[166:169], v[114:117], v[118:121], v[166:169]
    v_rcp_f32 v174, v174
    v_fmac_f32 v255, v152, v152
    v_mfma_f32_16x16x16_f16 v[186:189], v[184:185], v[162:163], v[186:189]
    v_mul_f32 v226, v174, v226
    v_mul_f32 v227, v174, v227
    v_cvt_pk_bf16_f32 v122, v226, v227
    v_mfma_f32_16x16x16_f16 v[242:245], v[124:125], v[162:163], v[242:245]
    v_mul_f32 v228, v174, v228
    v_mul_f32 v229, v174, v229
    v_cvt_pk_bf16_f32 v123, v228, v229
    v_mfma_f32_16x16x16_f16 v[126:129], v[164:165], v[162:163], v[126:129]
    v_max3_f32 v254, v238, v186, v187
    v_max3_f32 v254, v254, v188, v189
    v_mul_f32 v218, v174, v218
    v_mul_f32 v219, v174, v219
    v_mfma_f32_16x16x32_bf16 v[146:149], a[216:219], v[198:201], 0
    ds_read_b128 v[118:121], v9
    ds_read_b128 v[162:165], v9 offset:64
    v_mfma_f32_16x16x32_bf16 v[146:149], a[220:223], v[206:209], v[146:149]
    v_max3_f32 v254, v254, v242, v243
    v_max3_f32 v254, v254, v244, v245
    v_mfma_f32_16x16x32_bf16 v[146:149], a[224:227], v[210:213], v[146:149]
    v_max3_f32 v254, v254, v126, v127
    v_max3_f32 v254, v254, v128, v129
    v_mfma_f32_16x16x32_bf16 v[146:149], a[228:231], v[134:137], v[146:149]
    v_mov_b32 v125, v254
    v_cvt_pk_bf16_f32 v124, v218, v219
    v_mfma_f32_16x16x32_bf16 v[146:149], a[232:235], v[222:225], v[146:149]
    v_permlane32_swap_b32 v254, v125
    v_mfma_f32_16x16x32_bf16 v[146:149], a[236:239], v[154:157], v[146:149]
    v_max_f32 v254, v254, v125
    v_mov_b32 v125, v254
    v_mfma_f32_16x16x32_bf16 v[138:141], a[240:243], v[198:201], 0
    v_mul_f32 v220, v174, v220
    v_mul_f32 v221, v174, v221
    v_mfma_f32_16x16x32_bf16 v[138:141], a[244:247], v[206:209], v[138:141]
    v_permlane16_swap_b32 v254, v125
    v_mfma_f32_16x16x32_bf16 v[138:141], a[248:251], v[210:213], v[138:141]
    s_waitcnt lgkmcnt(0)
    v_max_f32 v254, v254, v125
    v_sub_f32 v186, v186, v254
    v_mfma_f32_16x16x32_bf16 v[138:141], a[252:255], v[134:137], v[138:141]
    v_exp_f32 v186, v186
    v_mfma_f32_16x16x32_bf16 v[138:141], v[82:85], v[222:225], v[138:141]
    v_sub_f32 v187, v187, v254
    v_sub_f32 v188, v188, v254
    v_mfma_f32_16x16x32_bf16 v[138:141], v[86:89], v[154:157], v[138:141]
    v_exp_f32 v187, v187
    v_exp_f32 v188, v188
    v_cvt_pk_bf16_f32 v234, v186, v187
    v_sub_f32 v189, v189, v254
    v_exp_f32 v189, v189
    v_sub_f32 v242, v242, v254
    v_cvt_pk_bf16_f32 v235, v188, v189
    v_exp_f32 v242, v242
    v_sub_f32 v243, v243, v254
    v_exp_f32 v243, v243
    v_sub_f32 v244, v244, v254
    v_cvt_pk_bf16_f32 v236, v242, v243
    v_mfma_f32_16x16x32_bf16 v[186:189], v[90:93], v[198:201], 0
    v_exp_f32 v244, v244
    v_mfma_f32_16x16x32_bf16 v[186:189], v[94:97], v[206:209], v[186:189]
    v_sub_f32 v245, v245, v254
    v_sub_f32 v126, v126, v254
    v_mfma_f32_16x16x32_bf16 v[186:189], v[98:101], v[210:213], v[186:189]
    v_exp_f32 v245, v245
    v_mfma_f32_16x16x32_bf16 v[186:189], v[102:105], v[134:137], v[186:189]
    v_cvt_pk_bf16_f32 v237, v244, v245
    v_sub_f32 v127, v127, v254
    v_mfma_f32_16x16x32_bf16 v[186:189], v[106:109], v[222:225], v[186:189]
    v_exp_f32 v126, v126
    v_mfma_f32_16x16x32_bf16 v[186:189], v[110:113], v[154:157], v[186:189]
    ds_read_b128 v[182:185], v0 offset:20480
    ds_read_b128 v[198:201], v1 offset:20480
    v_mfma_f32_16x16x32_bf16 v[206:209], v[118:121], v[28:31], 0
    ds_read_b128 v[210:213], v0 offset:20608
    ds_read_b128 v[222:225], v1 offset:20608
    v_mfma_f32_16x16x32_bf16 v[206:209], v[162:165], v[28:31], v[206:209]
    v_exp_f32 v127, v127
    v_mfma_f32_16x16x32_bf16 v[154:157], v[118:121], v[170:173], 0
    ds_read_b128 v[226:229], v0 offset:20736
    v_cvt_pk_bf16_f32 v36, v126, v127
    v_mfma_f32_16x16x32_bf16 v[154:157], v[162:165], v[194:197], v[154:157]
    ds_read_b128 v[242:245], v1 offset:20736
    v_sub_f32 v128, v128, v254
    v_exp_f32 v128, v128
    v_sub_f32 v129, v129, v254
    v_exp_f32 v129, v129
    v_sub_f32 v238, v238, v254
    v_cvt_pk_bf16_f32 v37, v128, v129
    v_mfma_f32_16x16x32_bf16 v[134:137], v[118:121], v[130:133], 0
    v_exp_f32 v238, v238
    v_mfma_f32_16x16x32_bf16 v[134:137], v[162:165], v[214:217], v[134:137]
    s_waitcnt lgkmcnt(4)
    v_cvt_pk_bf16_f32 v39, v238, 0
    v_cvt_pk_bf16_f32 v125, v220, v221
    v_mfma_f32_16x16x32_bf16 v[218:221], v[118:121], v[114:117], 0
    s_waitcnt lgkmcnt(2)
    ds_write_b128 v3, v[122:125] offset:6144
    v_mfma_f32_16x16x32_bf16 v[126:129], v[28:31], v[36:39], 0
    s_waitcnt lgkmcnt(2)
    v_mul_f32 v166, v174, v166
    v_mul_f32 v167, v174, v167
    v_mfma_f32_16x16x32_bf16 v[126:129], v[28:31], v[234:237], v[126:129]
    s_waitcnt lgkmcnt(1)
    v_cvt_pk_bf16_f32 v166, v166, v167
    v_mul_f32 v168, v174, v168
    v_mfma_f32_16x16x32_bf16 v[122:125], v[194:197], v[36:39], 0
    v_mul_f32 v169, v174, v169
    v_cvt_pk_bf16_f32 v167, v168, v169
    v_mfma_f32_16x16x32_bf16 v[122:125], v[170:173], v[234:237], v[122:125]
    ds_write_b64 v4, v[166:167] offset:10240
    v_mfma_f32_16x16x32_bf16 v[170:173], v[214:217], v[36:39], 0
    v_rcp_f32 v126, v126
    v_mfma_f32_16x16x32_bf16 v[170:173], v[130:133], v[234:237], v[170:173]
    v_fma_f32 v254, v146, v146, s33
    v_fmac_f32 v254, v147, v147
    v_mfma_f32_16x16x32_bf16 v[174:177], v[230:233], v[36:39], 0
    v_fmac_f32 v254, v148, v148
    v_mul_f32 v122, v126, v122
    v_mfma_f32_16x16x32_bf16 v[174:177], v[114:117], v[234:237], v[174:177]
    v_mul_f32 v123, v126, v123
    v_cvt_pk_bf16_f32 v122, v122, v123
    v_mfma_f32_16x16x32_bf16 v[218:221], v[162:165], v[230:233], v[218:221]
    v_mul_f32 v124, v126, v124
    v_mul_f32 v125, v126, v125
    v_mfma_f32_16x16x32_bf16 v[114:117], a[72:75], v[182:185], 0
    v_cvt_pk_bf16_f32 v123, v124, v125
    v_mul_f32 v170, v126, v170
    v_mfma_f32_16x16x32_bf16 v[114:117], a[76:79], v[198:201], v[114:117]
    v_mul_f32 v171, v126, v171
    v_cvt_pk_bf16_f32 v124, v170, v171
    v_mfma_f32_16x16x32_bf16 v[114:117], a[80:83], v[210:213], v[114:117]
    v_mul_f32 v172, v126, v172
    v_mul_f32 v173, v126, v173
    v_mfma_f32_16x16x32_bf16 v[114:117], a[84:87], v[222:225], v[114:117]
    v_cvt_pk_bf16_f32 v125, v172, v173
    v_mul_f32 v174, v126, v174
    v_mfma_f32_16x16x32_bf16 v[114:117], a[88:91], v[226:229], v[114:117]
    ds_write_b128 v3, v[122:125] offset:12288
    v_mfma_f32_16x16x32_bf16 v[114:117], a[92:95], v[242:245], v[114:117]
    v_mul_f32 v175, v126, v175
    v_cvt_pk_bf16_f32 v174, v174, v175
    v_mfma_f32_16x16x32_bf16 v[122:125], a[96:99], v[182:185], 0
    v_mul_f32 v176, v126, v176
    v_mul_f32 v177, v126, v177
    v_mfma_f32_16x16x32_bf16 v[122:125], a[100:103], v[198:201], v[122:125]
    v_cvt_pk_bf16_f32 v175, v176, v177
    v_fmac_f32 v254, v149, v149
    v_mfma_f32_16x16x32_bf16 v[122:125], a[104:107], v[210:213], v[122:125]
    ds_write_b64 v4, v[174:175] offset:16384
    v_mfma_f32_16x16x32_bf16 v[122:125], a[108:111], v[222:225], v[122:125]
    v_fmac_f32 v254, v138, v138
    v_fmac_f32 v254, v139, v139
    v_mfma_f32_16x16x32_bf16 v[122:125], a[112:115], v[226:229], v[122:125]
    v_fmac_f32 v254, v140, v140
    v_fmac_f32 v254, v141, v141
    v_mfma_f32_16x16x32_bf16 v[122:125], a[116:119], v[242:245], v[122:125]
    v_fmac_f32 v254, v186, v186
    v_fmac_f32 v254, v187, v187
    v_mfma_f32_16x16x32_bf16 v[126:129], a[120:123], v[182:185], 0
    v_fmac_f32 v254, v188, v188
    v_fmac_f32 v254, v189, v189
    v_mfma_f32_16x16x32_bf16 v[126:129], a[124:127], v[198:201], v[126:129]
    v_cvt_pk_bf16_f32 v155, v254, v254
    v_fmac_f32 v255, v153, v153
    v_mfma_f32_16x16x32_bf16 v[126:129], a[128:131], v[210:213], v[126:129]
    v_rcp_f32 v206, v206
    v_mfma_f32_16x16x32_bf16 v[126:129], a[132:135], v[222:225], v[126:129]
    v_mul_f32 v154, v154, v206
    v_mul_f32_dpp v154, v134, v206 quad_perm:[0,1,2,3] row_mask:0x2 bank_mask:0xf
    v_mfma_f32_16x16x32_bf16 v[126:129], a[136:139], v[226:229], v[126:129]
    v_mul_f32_dpp v154, v218, v206 quad_perm:[0,1,2,3] row_mask:0x4 bank_mask:0xf
    v_cvt_pk_bf16_f32 v154, v154, v154
    v_mfma_f32_16x16x32_bf16 v[126:129], a[140:143], v[242:245], v[126:129]
    ds_write_b16 v7, v154
    v_mfma_f32_16x16x32_bf16 v[206:209], a[0:3], v[182:185], 0
    v_fmac_f32 v255, v190, v190
    v_fmac_f32 v255, v191, v191
    v_mfma_f32_16x16x32_bf16 v[206:209], a[4:7], v[198:201], v[206:209]
    v_fmac_f32 v255, v192, v192
    v_fmac_f32 v255, v193, v193
    v_mfma_f32_16x16x32_bf16 v[206:209], a[8:11], v[210:213], v[206:209]
    v_fmac_f32 v255, v202, v202
    v_fmac_f32 v255, v203, v203
    v_mfma_f32_16x16x32_bf16 v[206:209], a[12:15], v[222:225], v[206:209]
    v_fmac_f32 v255, v204, v204
    v_fmac_f32 v255, v205, v205
    v_mfma_f32_16x16x32_bf16 v[206:209], a[16:19], v[226:229], v[206:209]
    v_fma_f32 v254, v142, v142, s33
    v_fmac_f32 v254, v143, v143
    v_mfma_f32_16x16x32_bf16 v[206:209], a[20:23], v[242:245], v[206:209]
    v_fmac_f32 v254, v144, v144
    v_fmac_f32 v254, v145, v145
    v_mfma_f32_16x16x32_bf16 v[174:177], a[24:27], v[182:185], 0
    v_fmac_f32 v254, v158, v158
    v_fmac_f32 v254, v159, v159
    v_mfma_f32_16x16x32_bf16 v[174:177], a[28:31], v[198:201], v[174:177]
    v_fmac_f32 v254, v160, v160
    v_fmac_f32 v254, v161, v161
    v_mfma_f32_16x16x32_bf16 v[174:177], a[32:35], v[210:213], v[174:177]
    v_fmac_f32 v254, v178, v178
    v_fmac_f32 v254, v179, v179
    v_mfma_f32_16x16x32_bf16 v[174:177], a[36:39], v[222:225], v[174:177]
    v_fmac_f32 v254, v180, v180
    v_fmac_f32 v254, v181, v181
    v_mfma_f32_16x16x32_bf16 v[174:177], a[40:43], v[226:229], v[174:177]
    v_cvt_pk_bf16_f32 v154, v255, v254
    v_add_u32 v5, 336, v5
    v_mfma_f32_16x16x32_bf16 v[174:177], a[44:47], v[242:245], v[174:177]
    ds_write_b64 v4, v[154:155] offset:18432
    v_mfma_f32_16x16x32_bf16 v[218:221], a[48:51], v[182:185], 0
    v_add_u32 v6, 272, v6
    v_add_u32 v7, 16, v7
    v_mfma_f32_16x16x32_bf16 v[218:221], a[52:55], v[198:201], v[218:221]
    v_fma_f32 v130, v114, v114, s32
    v_fmac_f32 v130, v115, v115
    v_mfma_f32_16x16x32_bf16 v[218:221], a[56:59], v[210:213], v[218:221]
    v_fmac_f32 v130, v116, v116
    v_fmac_f32 v130, v117, v117
    v_mfma_f32_16x16x32_bf16 v[218:221], a[60:63], v[222:225], v[218:221]
    v_fmac_f32 v130, v122, v122
    v_fmac_f32 v130, v123, v123
    v_mfma_f32_16x16x32_bf16 v[218:221], a[64:67], v[226:229], v[218:221]
    v_fmac_f32 v130, v124, v124
    v_fmac_f32 v130, v125, v125
    v_mfma_f32_16x16x32_bf16 v[218:221], a[68:71], v[242:245], v[218:221]
    v_fmac_f32 v130, v126, v126
    v_fmac_f32 v130, v127, v127
    v_mfma_f32_16x16x32_bf16 v[170:173], v[182:185], a[144:147], 0
    s_waitcnt lgkmcnt(0)
    v_fmac_f32 v130, v128, v128
    v_fmac_f32 v130, v129, v129
    v_mfma_f32_16x16x32_bf16 v[170:173], v[198:201], a[148:151], v[170:173]
    s_barrier
    v_fma_f32 v131, v206, v206, s32
    v_fmac_f32 v131, v207, v207
    v_mfma_f32_16x16x32_bf16 v[170:173], v[210:213], a[152:155], v[170:173]
    s_nop 0
    v_fmac_f32 v131, v208, v208
    v_fmac_f32 v131, v209, v209
    v_mfma_f32_16x16x32_bf16 v[170:173], v[222:225], a[156:159], v[170:173]
    s_nop 0
    v_fmac_f32 v131, v174, v174
    v_xor_b32 v2, 65536, v2
    v_mfma_f32_16x16x32_bf16 v[170:173], v[226:229], a[160:163], v[170:173]
    s_nop 0
    v_xor_b32 v3, 65536, v3
    v_xor_b32 v4, 65536, v4
    v_mfma_f32_16x16x32_bf16 v[170:173], v[242:245], a[164:167], v[170:173]
    s_cbranch_scc1 L_loop_safe0
    s_branch L_final_safe
.p2align 6
L_loop_safe1:
    v_mfma_f32_16x16x32_bf16 v[162:165], v[182:185], a[168:171], 0
    s_add_u32 s12, s42, s27
    ds_read_b128 v[194:197], v2 offset:18432
    ds_read_b128 v[230:233], v2 offset:19456
    v_mfma_f32_16x16x32_bf16 v[162:165], v[198:201], a[172:175], v[162:165]
    s_addc_u32 s13, s43, 0
    v_fmac_f32 v131, v175, v175
    v_fmac_f32 v131, v176, v176
    v_mfma_f32_16x16x32_bf16 v[162:165], v[210:213], a[176:179], v[162:165]
    s_sub_u32 s14, s36, s27
    v_fmac_f32 v131, v177, v177
    v_fmac_f32 v131, v218, v218
    v_mfma_f32_16x16x32_bf16 v[162:165], v[222:225], a[180:183], v[162:165]
    s_cmp_ge_u32 s18, 2
    v_fmac_f32 v131, v219, v219
    v_fmac_f32 v131, v220, v220
    v_mfma_f32_16x16x32_bf16 v[162:165], v[226:229], a[184:187], v[162:165]
    s_cselect_b32 s14, s14, 0
    ds_read_b128 v[118:121], v0 offset:26624
    v_fmac_f32 v131, v221, v221
    v_mfma_f32_16x16x32_bf16 v[162:165], v[242:245], a[188:191], v[162:165]
    s_add_u32 s34, s18, 2
    ds_read_b128 v[134:137], v1 offset:26624
    v_cvt_pk_bf16_f32 v36, v131, v130
    v_mfma_f32_16x16x32_bf16 v[214:217], v[182:185], a[192:195], 0
    s_add_u32 s8, s40, s23
    ds_read_b128 v[154:157], v0 offset:26752
    v_cvt_pk_bf16_f32 v170, v170, v171
    v_mfma_f32_16x16x32_bf16 v[214:217], v[198:201], a[196:199], v[214:217]
    s_addc_u32 s9, s41, 0
    ds_read_b128 v[198:201], v1 offset:26752
    v_cvt_pk_bf16_f32 v171, v172, v173
    v_mfma_f32_16x16x32_bf16 v[166:169], v[32:35], v[36:39], 0
    s_sub_u32 s10, s36, s23
    v_cvt_pk_bf16_f32 v130, v162, v163
    v_cvt_pk_bf16_f32 v131, v164, v165
    v_mfma_f32_16x16x32_bf16 v[214:217], v[210:213], a[200:203], v[214:217]
    s_waitcnt lgkmcnt(4)
    ds_read_b128 v[210:213], v0 offset:26880
    s_cmp_lt_u32 s34, s17
    v_mfma_f32_16x16x32_bf16 v[234:237], v[32:35], v[194:197], 0
    s_cselect_b32 s10, s10, 0
    v_rsq_f32 v167, v167
    v_mfma_f32_16x16x32_bf16 v[234:237], v[32:35], v[230:233], v[234:237]
    s_add_u32 m0, s28, 0
    v_rsq_f32 v166, v166
    v_mfma_f32_16x16x32_bf16 v[214:217], v[222:225], a[204:207], v[214:217]
    s_waitcnt lgkmcnt(4)
    ds_read_b128 v[162:165], v1 offset:26880
    v_mul_f32 v166, s31, v166
    v_mfma_f32_16x16x32_bf16 v[214:217], v[226:229], a[208:211], v[214:217]
    s_mov_b32 s27, s26
    v_mul_f32 v114, v167, v114
    v_mul_f32 v115, v167, v115
    v_mfma_f32_16x16x32_bf16 v[214:217], v[242:245], a[212:215], v[214:217]
    s_mov_b32 s26, s25
    v_cvt_pk_f16_f32 v242, v114, v115
    v_mul_f32 v116, v167, v116
    v_mfma_f32_16x16x32_bf16 v[226:229], a[72:75], v[118:121], 0
    s_waitcnt lgkmcnt(2)
    v_mul_f32 v117, v167, v117
    v_cvt_pk_f16_f32 v243, v116, v117
    v_mfma_f32_16x16x32_bf16 v[226:229], a[76:79], v[134:137], v[226:229]
    s_mov_b32 s25, s24
    v_cvt_pk_bf16_f32 v114, v214, v215
    v_cvt_pk_bf16_f32 v115, v216, v217
    v_mfma_f32_16x16x32_bf16 v[226:229], a[80:83], v[154:157], v[226:229]
    s_mov_b32 s24, s23
    v_mul_f32 v122, v167, v122
    v_mul_f32 v123, v167, v123
    v_mfma_f32_16x16x32_bf16 v[226:229], a[84:87], v[198:201], v[226:229]
    s_waitcnt lgkmcnt(1)
    v_cvt_pk_f16_f32 v244, v122, v123
    v_mul_f32 v124, v167, v124
    v_mfma_f32_16x16x32_bf16 v[226:229], a[88:91], v[210:213], v[226:229]
    v_mul_f32 v125, v167, v125
    v_cvt_pk_f16_f32 v245, v124, v125
    v_mfma_f32_16x16x32_bf16 v[122:125], a[96:99], v[118:121], 0
    s_waitcnt lgkmcnt(0)
    v_mul_f32 v126, v167, v126
    v_mul_f32 v127, v167, v127
    v_mfma_f32_16x16x32_bf16 v[226:229], a[92:95], v[162:165], v[226:229]
    v_cvt_pk_f16_f32 v184, v126, v127
    v_mul_f32 v128, v167, v128
    v_mfma_f32_16x16x32_bf16 v[122:125], a[100:103], v[134:137], v[122:125]
    v_mul_f32 v129, v167, v129
    v_cvt_pk_f16_f32 v185, v128, v129
    v_mfma_f32_16x16x32_bf16 v[122:125], a[104:107], v[154:157], v[122:125]
    v_mul_f32 v206, v166, v206
    v_mul_f32 v207, v166, v207
    v_mfma_f32_16x16x32_bf16 v[122:125], a[108:111], v[198:201], v[122:125]
    v_cvt_pk_f16_f32 v222, v206, v207
    v_mul_f32 v208, v166, v208
    v_mfma_f32_16x16x32_bf16 v[122:125], a[112:115], v[210:213], v[122:125]
    v_mul_f32 v209, v166, v209
    v_cvt_pk_f16_f32 v223, v208, v209
    v_mfma_f32_16x16x32_bf16 v[122:125], a[116:119], v[162:165], v[122:125]
    v_mul_f32 v174, v166, v174
    v_mul_f32 v175, v166, v175
    v_mfma_f32_16x16x32_bf16 v[126:129], a[120:123], v[118:121], 0
    v_cvt_pk_f16_f32 v224, v174, v175
    v_mul_f32 v176, v166, v176
    v_mfma_f32_16x16x32_bf16 v[126:129], a[124:127], v[134:137], v[126:129]
    v_mul_f32 v177, v166, v177
    v_cvt_pk_f16_f32 v225, v176, v177
    v_mfma_f32_16x16x32_bf16 v[126:129], a[128:131], v[154:157], v[126:129]
    v_mul_f32 v218, v166, v218
    v_mul_f32 v219, v166, v219
    v_mfma_f32_16x16x32_bf16 v[126:129], a[132:135], v[198:201], v[126:129]
    v_cvt_pk_f16_f32 v182, v218, v219
    v_mul_f32 v220, v166, v220
    v_mfma_f32_16x16x32_bf16 v[126:129], a[136:139], v[210:213], v[126:129]
    v_mul_f32 v221, v166, v221
    v_cvt_pk_f16_f32 v183, v220, v221
    v_mfma_f32_16x16x32_bf16 v[126:129], a[140:143], v[162:165], v[126:129]
    v_fma_f32 v116, v226, v226, s32
    v_fmac_f32 v116, v227, v227
    v_mfma_f32_16x16x32_bf16 v[206:209], a[0:3], v[118:121], 0
    v_fmac_f32 v116, v228, v228
    v_fmac_f32 v116, v229, v229
    v_mfma_f32_16x16x32_bf16 v[206:209], a[4:7], v[134:137], v[206:209]
    v_fmac_f32 v116, v122, v122
    v_fmac_f32 v116, v123, v123
    v_mfma_f32_16x16x32_bf16 v[206:209], a[8:11], v[154:157], v[206:209]
    v_fmac_f32 v116, v124, v124
    v_fmac_f32 v116, v125, v125
    v_mfma_f32_16x16x32_bf16 v[206:209], a[12:15], v[198:201], v[206:209]
    v_fmac_f32 v116, v126, v126
    v_fmac_f32 v116, v127, v127
    v_mfma_f32_16x16x32_bf16 v[206:209], a[16:19], v[210:213], v[206:209]
    v_fmac_f32 v116, v128, v128
    v_fmac_f32 v116, v129, v129
    v_mfma_f32_16x16x32_bf16 v[206:209], a[20:23], v[162:165], v[206:209]
    v_mul_f32 v117, 0x3baaaaab, v234
    v_mul_f32 v254, 0x3baaaaab, v235
    v_mfma_f32_16x16x32_bf16 v[174:177], a[24:27], v[118:121], 0
    v_rsq_f32 v117, v117
    v_mfma_f32_16x16x32_bf16 v[174:177], a[28:31], v[134:137], v[174:177]
    v_rsq_f32 v254, v254
    v_mfma_f32_16x16x32_bf16 v[174:177], a[32:35], v[154:157], v[174:177]
    v_mul_f32 v255, 0x3baaaaab, v236
    v_fma_f32 v132, v206, v206, s32
    v_mfma_f32_16x16x32_bf16 v[174:177], a[36:39], v[198:201], v[174:177]
    v_fmac_f32 v132, v207, v207
    v_fmac_f32 v132, v208, v208
    v_mfma_f32_16x16x32_bf16 v[174:177], a[40:43], v[210:213], v[174:177]
    v_fmac_f32 v132, v209, v209
    v_mul_f32 v150, v117, v150
    v_mfma_f32_16x16x32_bf16 v[174:177], a[44:47], v[162:165], v[174:177]
    v_rsq_f32 v255, v255
    v_mfma_f32_16x16x32_bf16 v[218:221], a[48:51], v[118:121], 0
    v_mul_f32 v151, v117, v151
    v_cvt_pk_bf16_f32 v194, v150, v151
    v_mfma_f32_16x16x32_bf16 v[218:221], a[52:55], v[134:137], v[218:221]
    v_mul_f32 v152, v117, v152
    v_mul_f32 v153, v117, v153
    v_mfma_f32_16x16x32_bf16 v[218:221], a[56:59], v[154:157], v[218:221]
    v_fmac_f32 v132, v174, v174
    v_fmac_f32 v132, v175, v175
    v_mfma_f32_16x16x32_bf16 v[218:221], a[60:63], v[198:201], v[218:221]
    v_fmac_f32 v132, v176, v176
    v_fmac_f32 v132, v177, v177
    v_mfma_f32_16x16x32_bf16 v[218:221], a[64:67], v[210:213], v[218:221]
    v_cvt_pk_bf16_f32 v195, v152, v153
    v_mul_f32 v190, v117, v190
    v_mfma_f32_16x16x32_bf16 v[218:221], a[68:71], v[162:165], v[218:221]
    v_mul_f32 v191, v117, v191
    v_cvt_pk_bf16_f32 v196, v190, v191
    v_mfma_f32_16x16x32_bf16 v[150:153], v[118:121], a[144:147], 0
    v_mul_f32 v192, v117, v192
    v_mul_f32 v193, v117, v193
    v_mfma_f32_16x16x32_bf16 v[150:153], v[134:137], a[148:151], v[150:153]
    v_cvt_pk_bf16_f32 v197, v192, v193
    v_mul_f32 v202, v117, v202
    v_mfma_f32_16x16x32_bf16 v[150:153], v[154:157], a[152:155], v[150:153]
    buffer_store_dwordx4 v[194:197], v15, s[12:15], 0 offen nt
    v_fmac_f32 v132, v218, v218
    v_fmac_f32 v132, v219, v219
    v_fmac_f32 v132, v220, v220
    v_fmac_f32 v132, v221, v221
    v_mfma_f32_16x16x32_bf16 v[150:153], v[198:201], a[156:159], v[150:153]
    v_cvt_pk_bf16_f32 v36, v132, v116
    v_mul_f32 v203, v117, v203
    v_mfma_f32_16x16x32_bf16 v[150:153], v[210:213], a[160:163], v[150:153]
    v_cvt_pk_bf16_f32 v116, v202, v203
    v_mul_f32 v204, v117, v204
    v_mfma_f32_16x16x32_bf16 v[190:193], v[32:35], v[36:39], 0
    v_mul_f32 v205, v117, v205
    v_cvt_pk_bf16_f32 v117, v204, v205
    v_mfma_f32_16x16x32_bf16 v[150:153], v[162:165], a[164:167], v[150:153]
    v_mul_f32 v146, v255, v146
    v_mul_f32 v147, v255, v147
    v_mfma_f32_16x16x32_bf16 v[202:205], v[118:121], a[168:171], 0
    v_cvt_pk_bf16_f32 v146, v146, v147
    v_mul_f32 v148, v255, v148
    v_mfma_f32_16x16x32_bf16 v[202:205], v[134:137], a[172:175], v[202:205]
    v_rsq_f32 v191, v191
    v_mfma_f32_16x16x32_bf16 v[202:205], v[154:157], a[176:179], v[202:205]
    v_cvt_pk_bf16_f32 v172, v150, v151
    v_cvt_pk_bf16_f32 v173, v152, v153
    v_mfma_f32_16x16x32_bf16 v[202:205], v[198:201], a[180:183], v[202:205]
    v_rsq_f32 v190, v190
    v_mfma_f32_16x16x32_bf16 v[202:205], v[210:213], a[184:187], v[202:205]
    ds_read_b128 v[150:153], v0 offset:32768
    v_mul_f32 v190, s31, v190
    v_mfma_f32_16x16x32_bf16 v[202:205], v[162:165], a[188:191], v[202:205]
    ds_read_b128 v[166:169], v1 offset:32768
    v_mul_f32 v226, v191, v226
    v_mfma_f32_16x16x32_bf16 v[194:197], v[118:121], a[192:195], 0
    ds_read_b128 v[118:121], v0 offset:32896
    v_mul_f32 v227, v191, v227
    v_mfma_f32_16x16x32_bf16 v[194:197], v[134:137], a[196:199], v[194:197]
    ds_read_b128 v[134:137], v1 offset:32896
    v_cvt_pk_f16_f32 v226, v226, v227
    v_mfma_f32_16x16x32_bf16 v[194:197], v[154:157], a[200:203], v[194:197]
    ds_read_b128 v[154:157], v0 offset:33024
    v_cvt_pk_bf16_f32 v132, v202, v203
    v_mfma_f32_16x16x32_bf16 v[194:197], v[198:201], a[204:207], v[194:197]
    ds_read_b128 v[198:201], v1 offset:33024
    v_cvt_pk_bf16_f32 v133, v204, v205
    v_mfma_f32_16x16x32_bf16 v[194:197], v[210:213], a[208:211], v[194:197]
    v_mul_f32 v228, v191, v228
    v_mul_f32 v229, v191, v229
    v_mfma_f32_16x16x32_bf16 v[194:197], v[162:165], a[212:215], v[194:197]
    v_cvt_pk_f16_f32 v227, v228, v229
    v_mul_f32 v122, v191, v122
    v_mfma_f32_16x16x32_f16 v[210:213], v[242:245], v[222:225], v[46:49]
    s_waitcnt lgkmcnt(5)
    buffer_store_dwordx2 v[116:117], v18, s[12:15], 0 offen nt
    v_mul_f32 v123, v191, v123
    v_cvt_pk_f16_f32 v228, v122, v123
    v_mfma_f32_16x16x32_bf16 v[202:205], a[72:75], v[150:153], 0
    s_waitcnt lgkmcnt(3)
    v_cvt_pk_bf16_f32 v116, v194, v195
    v_cvt_pk_bf16_f32 v117, v196, v197
    v_mfma_f32_16x16x32_bf16 v[202:205], a[76:79], v[166:169], v[202:205]
    s_waitcnt lgkmcnt(2)
    v_mul_f32 v124, v191, v124
    v_mul_f32 v125, v191, v125
    v_mfma_f32_16x16x32_bf16 v[202:205], a[80:83], v[118:121], v[202:205]
    s_waitcnt lgkmcnt(1)
    v_cvt_pk_f16_f32 v229, v124, v125
    v_mul_f32 v126, v191, v126
    v_mfma_f32_16x16x32_bf16 v[202:205], a[84:87], v[134:137], v[202:205]
    s_waitcnt lgkmcnt(0)
    v_mul_f32 v127, v191, v127
    v_cvt_pk_f16_f32 v124, v126, v127
    v_mfma_f32_16x16x32_bf16 v[202:205], a[88:91], v[154:157], v[202:205]
    v_mul_f32 v128, v191, v128
    v_mul_f32 v129, v191, v129
    v_mfma_f32_16x16x32_bf16 v[202:205], a[92:95], v[198:201], v[202:205]
    v_cvt_pk_f16_f32 v125, v128, v129
    v_mul_f32 v206, v190, v206
    v_mfma_f32_16x16x32_bf16 v[126:129], a[96:99], v[150:153], 0
    v_mul_f32 v207, v190, v207
    v_cvt_pk_f16_f32 v206, v206, v207
    v_mfma_f32_16x16x32_bf16 v[126:129], a[100:103], v[166:169], v[126:129]
    v_mul_f32 v208, v190, v208
    v_mul_f32 v209, v190, v209
    v_mfma_f32_16x16x32_bf16 v[126:129], a[104:107], v[118:121], v[126:129]
    v_cvt_pk_f16_f32 v207, v208, v209
    v_mul_f32 v174, v190, v174
    v_mfma_f32_16x16x32_bf16 v[126:129], a[108:111], v[134:137], v[126:129]
    v_mul_f32 v175, v190, v175
    v_cvt_pk_f16_f32 v208, v174, v175
    v_mfma_f32_16x16x32_bf16 v[126:129], a[112:115], v[154:157], v[126:129]
    v_mul_f32 v176, v190, v176
    v_mul_f32 v177, v190, v177
    v_mfma_f32_16x16x32_bf16 v[126:129], a[116:119], v[198:201], v[126:129]
    v_cvt_pk_f16_f32 v209, v176, v177
    v_mul_f32 v218, v190, v218
    v_mfma_f32_16x16x32_bf16 v[174:177], a[120:123], v[150:153], 0
    v_mul_f32 v219, v190, v219
    v_cvt_pk_f16_f32 v122, v218, v219
    v_mfma_f32_16x16x32_bf16 v[174:177], a[124:127], v[166:169], v[174:177]
    v_mul_f32 v220, v190, v220
    v_mul_f32 v221, v190, v221
    v_mfma_f32_16x16x32_bf16 v[174:177], a[128:131], v[118:121], v[174:177]
    v_cvt_pk_f16_f32 v123, v220, v221
    v_fma_f32 v162, v202, v202, s32
    v_mfma_f32_16x16x32_bf16 v[174:177], a[132:135], v[134:137], v[174:177]
    v_fmac_f32 v162, v203, v203
    v_fmac_f32 v162, v204, v204
    v_mfma_f32_16x16x32_bf16 v[174:177], a[136:139], v[154:157], v[174:177]
    v_fmac_f32 v162, v205, v205
    v_fmac_f32 v162, v126, v126
    v_mfma_f32_16x16x32_bf16 v[174:177], a[140:143], v[198:201], v[174:177]
    v_fmac_f32 v162, v127, v127
    v_fmac_f32 v162, v128, v128
    v_mfma_f32_16x16x32_bf16 v[190:193], a[0:3], v[150:153], 0
    v_fmac_f32 v162, v129, v129
    v_mul_f32 v149, v255, v149
    v_mfma_f32_16x16x32_bf16 v[190:193], a[4:7], v[166:169], v[190:193]
    v_cvt_pk_bf16_f32 v147, v148, v149
    v_mul_f32 v138, v255, v138
    v_mfma_f32_16x16x32_bf16 v[190:193], a[8:11], v[118:121], v[190:193]
    v_fmac_f32 v162, v174, v174
    v_fmac_f32 v162, v175, v175
    v_mfma_f32_16x16x32_bf16 v[190:193], a[12:15], v[134:137], v[190:193]
    v_fmac_f32 v162, v176, v176
    v_fmac_f32 v162, v177, v177
    v_mfma_f32_16x16x32_bf16 v[190:193], a[16:19], v[154:157], v[190:193]
    v_mul_f32 v139, v255, v139
    v_cvt_pk_bf16_f32 v148, v138, v139
    v_mfma_f32_16x16x32_bf16 v[190:193], a[20:23], v[198:201], v[190:193]
    v_mul_f32 v140, v255, v140
    v_mul_f32 v141, v255, v141
    v_mfma_f32_16x16x32_bf16 v[218:221], a[24:27], v[150:153], 0
    v_cvt_pk_bf16_f32 v149, v140, v141
    v_mul_f32 v186, v255, v186
    v_mfma_f32_16x16x32_bf16 v[218:221], a[28:31], v[166:169], v[218:221]
    buffer_store_dwordx4 v[146:149], v17, s[12:15], 0 offen nt
    v_mul_f32 v187, v255, v187
    v_fma_f32 v163, v190, v190, s32
    v_fmac_f32 v163, v191, v191
    v_fmac_f32 v163, v192, v192
    v_mfma_f32_16x16x32_bf16 v[218:221], a[32:35], v[118:121], v[218:221]
    v_fmac_f32 v163, v193, v193
    v_cvt_pk_bf16_f32 v164, v186, v187
    v_mfma_f32_16x16x32_bf16 v[218:221], a[36:39], v[134:137], v[218:221]
    v_mul_f32 v188, v255, v188
    v_mul_f32 v189, v255, v189
    v_mfma_f32_16x16x32_bf16 v[218:221], a[40:43], v[154:157], v[218:221]
    v_cvt_pk_bf16_f32 v165, v188, v189
    v_mul_f32 v142, v254, v142
    v_mfma_f32_16x16x32_bf16 v[218:221], a[44:47], v[198:201], v[218:221]
    v_mul_f32 v143, v254, v143
    v_cvt_pk_bf16_f32 v142, v142, v143
    v_mfma_f32_16x16x32_bf16 v[138:141], a[48:51], v[150:153], 0
    v_mul_f32 v144, v254, v144
    v_mul_f32 v145, v254, v145
    v_mfma_f32_16x16x32_bf16 v[138:141], a[52:55], v[166:169], v[138:141]
    v_cvt_pk_bf16_f32 v143, v144, v145
    v_mul_f32 v158, v254, v158
    v_mfma_f32_16x16x32_bf16 v[138:141], a[56:59], v[118:121], v[138:141]
    v_fmac_f32 v163, v218, v218
    v_fmac_f32 v163, v219, v219
    v_mfma_f32_16x16x32_bf16 v[138:141], a[60:63], v[134:137], v[138:141]
    ds_read2_b32 v[196:197], v6 offset0:0 offset1:0
    ds_read2_b32 v[216:217], v6 offset0:16 offset1:16
    v_mfma_f32_16x16x32_bf16 v[138:141], a[64:67], v[154:157], v[138:141]
    ds_read2_b32 v[232:233], v6 offset0:32 offset1:32
    v_fmac_f32 v163, v220, v220
    v_mfma_f32_16x16x32_bf16 v[138:141], a[68:71], v[198:201], v[138:141]
    v_fmac_f32 v163, v221, v221
    v_mul_f32 v159, v254, v159
    v_mfma_f32_16x16x32_bf16 v[146:149], v[150:153], a[144:147], 0
    v_cvt_pk_bf16_f32 v144, v158, v159
    v_mul_f32 v160, v254, v160
    v_mfma_f32_16x16x32_bf16 v[146:149], v[166:169], a[148:151], v[146:149]
    v_mul_f32 v161, v254, v161
    v_cvt_pk_bf16_f32 v145, v160, v161
    v_mfma_f32_16x16x32_bf16 v[146:149], v[118:121], a[152:155], v[146:149]
    v_fmac_f32 v163, v138, v138
    v_fmac_f32 v163, v139, v139
    v_mfma_f32_16x16x32_bf16 v[146:149], v[134:137], a[156:159], v[146:149]
    v_fmac_f32 v163, v140, v140
    v_fmac_f32 v163, v141, v141
    v_mfma_f32_16x16x32_bf16 v[146:149], v[154:157], a[160:163], v[146:149]
    v_cvt_pk_bf16_f32 v36, v163, v162
    v_mul_f32 v178, v254, v178
    v_mfma_f32_16x16x32_bf16 v[146:149], v[198:201], a[164:167], v[146:149]
    s_waitcnt lgkmcnt(1)
    v_mul_f32 v179, v254, v179
    v_cvt_pk_bf16_f32 v178, v178, v179
    v_mfma_f32_16x16x32_bf16 v[158:161], v[32:35], v[36:39], 0
    s_waitcnt lgkmcnt(0)
    buffer_store_dwordx2 v[164:165], v20, s[12:15], 0 offen nt
    v_mul_f32 v180, v254, v180
    v_mul_f32 v181, v254, v181
    v_mfma_f32_16x16x32_bf16 v[186:189], v[150:153], a[168:171], 0
    v_cvt_pk_bf16_f32 v194, v146, v147
    v_cvt_pk_bf16_f32 v195, v148, v149
    v_mfma_f32_16x16x32_bf16 v[186:189], v[166:169], a[172:175], v[186:189]
    v_rsq_f32 v159, v159
    v_mfma_f32_16x16x32_bf16 v[186:189], v[118:121], a[176:179], v[186:189]
    v_rsq_f32 v158, v158
    v_mfma_f32_16x16x32_bf16 v[186:189], v[134:137], a[180:183], v[186:189]
    v_mul_f32 v158, s31, v158
    v_mul_f32 v202, v159, v202
    v_mfma_f32_16x16x32_bf16 v[186:189], v[154:157], a[184:187], v[186:189]
    v_mul_f32 v203, v159, v203
    v_cvt_pk_f16_f32 v146, v202, v203
    v_mfma_f32_16x16x32_bf16 v[186:189], v[198:201], a[188:191], v[186:189]
    v_mul_f32 v204, v159, v204
    v_mul_f32 v205, v159, v205
    v_mfma_f32_16x16x32_bf16 v[162:165], v[150:153], a[192:195], 0
    v_cvt_pk_f16_f32 v147, v204, v205
    v_mul_f32 v126, v159, v126
    v_mfma_f32_16x16x32_bf16 v[162:165], v[166:169], a[196:199], v[162:165]
    ds_read_b128 v[150:153], v5 offset:0
    ds_read_b128 v[202:205], v5 offset:16
    v_mfma_f32_16x16x32_bf16 v[162:165], v[118:121], a[200:203], v[162:165]
    ds_read_b128 v[118:121], v5 offset:48
    ds_read_b32 v254, v6 offset:192
    v_mfma_f32_16x16x32_bf16 v[162:165], v[134:137], a[204:207], v[162:165]
    v_cvt_pk_bf16_f32 v214, v186, v187
    v_cvt_pk_bf16_f32 v215, v188, v189
    v_mfma_f32_16x16x32_bf16 v[162:165], v[154:157], a[208:211], v[162:165]
    v_mul_f32 v127, v159, v127
    v_cvt_pk_f16_f32 v148, v126, v127
    v_mfma_f32_16x16x32_bf16 v[162:165], v[198:201], a[212:215], v[162:165]
    ds_read_b128 v[198:201], v2 offset:0
    ds_read_b128 v[186:189], v2 offset:1024
    v_mfma_f32_16x16x32_f16 v[134:137], v[226:229], v[222:225], v[50:53]
    ds_read_b128 v[154:157], v2 offset:2048
    v_mul_f32 v128, v159, v128
    v_mul_f32 v129, v159, v129
    v_mfma_f32_16x16x16_f16 v[210:213], v[184:185], v[182:183], v[210:213]
    v_cvt_pk_f16_f32 v149, v128, v129
    v_cvt_pk_bf16_f32 v230, v162, v163
    v_cvt_pk_bf16_f32 v231, v164, v165
    v_mul_f32 v174, v159, v174
    v_mfma_f32_16x16x32_f16 v[126:129], v[146:149], v[222:225], v[54:57]
    s_waitcnt lgkmcnt(5)
    v_mul_f32 v175, v159, v175
    v_cvt_pk_f16_f32 v164, v174, v175
    v_mul_f32 v176, v159, v176
    v_mfma_f32_16x16x16_f16 v[134:137], v[124:125], v[182:183], v[134:137]
    v_mul_f32 v177, v159, v177
    v_cvt_pk_f16_f32 v165, v176, v177
    v_mul_f32 v190, v158, v190
    v_mul_f32 v191, v158, v191
    v_mfma_f32_16x16x16_f16 v[126:129], v[164:165], v[182:183], v[126:129]
    v_cvt_pk_f16_f32 v174, v190, v191
    v_mul_f32 v192, v158, v192
    v_mul_f32 v193, v158, v193
    v_cvt_pk_f16_f32 v175, v192, v193
    v_mfma_f32_16x16x32_f16 v[166:169], v[150:153], v[222:225], v[22:25]
    s_waitcnt lgkmcnt(2)
    ds_read_b128 v[222:225], v2 offset:3072
    buffer_store_dwordx4 v[142:145], v16, s[12:15], 0 offen nt
    ds_read_b128 v[234:237], v2 offset:4096
    v_mul_f32 v218, v158, v218
    v_mul_f32 v219, v158, v219
    v_cvt_pk_f16_f32 v176, v218, v219
    v_mfma_f32_16x16x32_f16 v[166:169], v[202:205], v[242:245], v[166:169]
    s_waitcnt lgkmcnt(2)
    v_mul_f32 v220, v158, v220
    v_mul_f32 v221, v158, v221
    v_mfma_f32_16x16x32_f16 v[166:169], v[118:121], v[182:185], v[166:169]
    ds_read_b128 v[142:145], v2 offset:5120
    v_cvt_pk_f16_f32 v177, v220, v221
    v_mul_f32 v138, v158, v138
    v_mul_f32 v139, v158, v139
    v_cvt_pk_f16_f32 v162, v138, v139
    v_mfma_f32_16x16x32_f16 v[218:221], v[150:153], v[206:209], v[24:27]
    v_mul_f32 v140, v158, v140
    v_mul_f32 v141, v158, v141
    v_mfma_f32_16x16x32_f16 v[218:221], v[202:205], v[226:229], v[218:221]
    v_mov_b32_dpp v254, v167 quad_perm:[0,1,2,3] row_mask:0x1 bank_mask:0xf
    v_cvt_pk_f16_f32 v163, v140, v141
    v_mfma_f32_16x16x32_f16 v[218:221], v[118:121], v[122:125], v[218:221]
    v_max3_f32 v255, v166, v210, v211
    v_max3_f32 v255, v255, v212, v213
    v_mfma_f32_16x16x32_f16 v[238:241], v[150:153], v[174:177], v[26:29]
    s_waitcnt lgkmcnt(1)
    v_max3_f32 v255, v255, v134, v135
    v_max3_f32 v255, v255, v136, v137
    v_mfma_f32_16x16x32_f16 v[238:241], v[202:205], v[146:149], v[238:241]
    v_max3_f32 v255, v255, v126, v127
    v_mov_b32_dpp v254, v219 quad_perm:[0,1,2,3] row_mask:0x2 bank_mask:0xf
    v_mfma_f32_16x16x32_f16 v[238:241], v[118:121], v[162:165], v[238:241]
    v_max3_f32 v255, v255, v128, v129
    v_mov_b32 v182, v255
    v_mfma_f32_16x16x32_bf16 v[150:153], a[216:219], v[198:201], 0
    s_waitcnt lgkmcnt(0)
    v_permlane32_swap_b32 v255, v182
    v_mfma_f32_16x16x32_bf16 v[150:153], a[220:223], v[186:189], v[150:153]
    v_max_f32 v255, v255, v182
    v_mov_b32 v182, v255
    v_mfma_f32_16x16x32_bf16 v[150:153], a[224:227], v[154:157], v[150:153]
    v_cvt_pk_bf16_f32 v179, v180, v181
    v_xor_b32 v0, 65536, v0
    v_mfma_f32_16x16x32_bf16 v[150:153], a[228:231], v[222:225], v[150:153]
    s_waitcnt vmcnt(5)
    v_permlane16_swap_b32 v255, v182
    v_mfma_f32_16x16x32_bf16 v[150:153], a[232:235], v[234:237], v[150:153]
    s_nop 0
    v_max_f32 v255, v255, v182
    v_sub_f32 v210, v210, v255
    v_mfma_f32_16x16x32_bf16 v[150:153], a[236:239], v[142:145], v[150:153]
    s_barrier
    v_exp_f32 v210, v210
    v_mfma_f32_16x16x32_bf16 v[190:193], a[240:243], v[198:201], 0
    s_nop 0
    v_sub_f32 v211, v211, v255
    v_sub_f32 v212, v212, v255
    v_mfma_f32_16x16x32_bf16 v[190:193], a[244:247], v[186:189], v[190:193]
    s_nop 0
    buffer_load_dwordx4 v10, s[8:11], 0 offen nt lds
    v_sub_f32 v213, v213, v255
    v_mfma_f32_16x16x32_bf16 v[190:193], a[248:251], v[154:157], v[190:193]
    s_add_u32 m0, s28, 4096
    v_exp_f32 v211, v211
    v_mfma_f32_16x16x32_bf16 v[190:193], a[252:255], v[222:225], v[190:193]
    v_cvt_pk_bf16_f32 v158, v210, v211
    v_sub_f32 v134, v134, v255
    v_mfma_f32_16x16x32_bf16 v[190:193], v[82:85], v[234:237], v[190:193]
    v_exp_f32 v212, v212
    v_mfma_f32_16x16x32_bf16 v[190:193], v[86:89], v[142:145], v[190:193]
    v_exp_f32 v213, v213
    v_mfma_f32_16x16x32_bf16 v[202:205], v[90:93], v[198:201], 0
    ds_read_b128 v[198:201], v2 offset:6144
    buffer_load_dwordx4 v11, s[8:11], 0 offen nt lds
    v_mfma_f32_16x16x32_bf16 v[202:205], v[94:97], v[186:189], v[202:205]
    s_add_u32 m0, s28, 8192
    ds_read_b128 v[138:141], v2 offset:7168
    v_cvt_pk_bf16_f32 v159, v212, v213
    v_mfma_f32_16x16x32_bf16 v[202:205], v[98:101], v[154:157], v[202:205]
    ds_read_b128 v[210:213], v2 offset:8192
    v_sub_f32 v135, v135, v255
    v_mfma_f32_16x16x32_bf16 v[202:205], v[102:105], v[222:225], v[202:205]
    ds_read_b128 v[186:189], v2 offset:9216
    v_sub_f32 v136, v136, v255
    v_mfma_f32_16x16x32_bf16 v[202:205], v[106:109], v[234:237], v[202:205]
    ds_read_b128 v[222:225], v2 offset:10240
    v_sub_f32 v137, v137, v255
    v_mfma_f32_16x16x32_bf16 v[202:205], v[110:113], v[142:145], v[202:205]
    ds_read_b128 v[154:157], v2 offset:11264
    buffer_load_dwordx4 v12, s[8:11], 0 offen nt lds
    v_exp_f32 v134, v134
    v_mfma_f32_16x16x32_f16 v[118:121], v[242:245], v[206:209], v[58:61]
    s_add_u32 m0, s28, 12288
    v_exp_f32 v135, v135
    v_exp_f32 v136, v136
    v_cvt_pk_bf16_f32 v160, v134, v135
    v_exp_f32 v137, v137
    v_sub_f32 v126, v126, v255
    v_mfma_f32_16x16x16_f16 v[118:121], v[184:185], v[122:123], v[118:121]
    v_cvt_pk_bf16_f32 v161, v136, v137
    v_exp_f32 v126, v126
    v_sub_f32 v127, v127, v255
    v_mfma_f32_16x16x32_f16 v[134:137], v[226:229], v[206:209], v[62:65]
    s_xor_b32 s28, s28, 65536
    buffer_load_dwordx4 v13, s[8:11], 0 offen nt lds
    v_exp_f32 v127, v127
    v_sub_f32 v128, v128, v255
    v_cvt_pk_bf16_f32 v36, v126, v127
    v_exp_f32 v128, v128
    v_mfma_f32_16x16x16_f16 v[134:137], v[124:125], v[122:123], v[134:137]
    v_sub_f32 v129, v129, v255
    v_exp_f32 v129, v129
    v_sub_f32 v166, v166, v255
    v_cvt_pk_bf16_f32 v37, v128, v129
    v_mfma_f32_16x16x32_f16 v[126:129], v[146:149], v[206:209], v[66:69]
    s_waitcnt lgkmcnt(0)
    v_exp_f32 v166, v166
    v_mfma_f32_16x16x32_bf16 v[142:145], a[216:219], v[198:201], 0
    s_mov_b32 m0, s29
    v_cvt_pk_bf16_f32 v39, v166, 0
    v_max3_f32 v255, v218, v118, v119
    v_max3_f32 v255, v255, v120, v121
    v_mfma_f32_16x16x16_f16 v[126:129], v[164:165], v[122:123], v[126:129]
    v_max3_f32 v255, v255, v134, v135
    v_max3_f32 v255, v255, v136, v137
    v_xor_b32 v1, 65536, v1
    v_mov_b32_dpp v254, v239 quad_perm:[0,1,2,3] row_mask:0x4 bank_mask:0xf
    v_mfma_f32_16x16x32_bf16 v[206:209], v[28:31], v[36:39], 0
    s_xor_b32 s29, s29, s30
    buffer_store_dwordx2 v[178:179], v19, s[12:15], 0 offen nt
    v_mov_b32 v122, v254
    v_max3_f32 v255, v255, v126, v127
    v_mfma_f32_16x16x32_bf16 v[206:209], v[28:31], v[158:161], v[206:209]
    s_add_u32 s19, s19, s20
    v_max3_f32 v255, v255, v128, v129
    v_mov_b32 v123, v255
    v_mfma_f32_16x16x32_bf16 v[142:145], a[220:223], v[138:141], v[142:145]
    s_add_u32 s23, s23, s21
    v_permlane32_swap_b32 v255, v123
    v_mfma_f32_16x16x32_bf16 v[142:145], a[224:227], v[210:213], v[142:145]
    s_cmp_ge_u32 s19, 72
    v_rcp_f32 v206, v206
    v_mfma_f32_16x16x32_bf16 v[142:145], a[228:231], v[186:189], v[142:145]
    s_cselect_b32 s34, 72, 0
    v_max_f32 v255, v255, v123
    v_mov_b32 v123, v255
    v_mfma_f32_16x16x32_bf16 v[142:145], a[232:235], v[222:225], v[142:145]
    s_cselect_b32 s35, s22, 0
    v_permlane16_swap_b32 v255, v123
    v_mfma_f32_16x16x32_bf16 v[142:145], a[236:239], v[154:157], v[142:145]
    s_sub_u32 s19, s19, s34
    v_max_f32 v255, v255, v123
    v_sub_f32 v118, v118, v255
    v_mfma_f32_16x16x32_bf16 v[178:181], v[194:197], v[36:39], 0
    s_add_u32 s23, s23, s35
    v_exp_f32 v118, v118
    v_mfma_f32_16x16x32_bf16 v[178:181], v[170:173], v[158:161], v[178:181]
    s_add_u32 s18, s18, 1
    v_sub_f32 v119, v119, v255
    v_exp_f32 v119, v119
    v_sub_f32 v120, v120, v255
    v_cvt_pk_bf16_f32 v118, v118, v119
    v_exp_f32 v120, v120
    v_sub_f32 v121, v121, v255
    v_exp_f32 v121, v121
    v_mul_f32 v178, v206, v178
    v_mul_f32 v179, v206, v179
    v_cvt_pk_bf16_f32 v178, v178, v179
    v_mul_f32 v180, v206, v180
    v_mul_f32 v181, v206, v181
    v_cvt_pk_bf16_f32 v179, v180, v181
    v_cvt_pk_bf16_f32 v119, v120, v121
    v_mfma_f32_16x16x32_bf16 v[166:169], v[214:217], v[36:39], 0
    s_cmp_lt_u32 s18, s45
    v_sub_f32 v134, v134, v255
    v_sub_f32 v135, v135, v255
    v_mfma_f32_16x16x32_bf16 v[166:169], v[130:133], v[158:161], v[166:169]
    v_exp_f32 v134, v134
    v_exp_f32 v135, v135
    v_sub_f32 v136, v136, v255
    v_cvt_pk_bf16_f32 v120, v134, v135
    v_exp_f32 v136, v136
    v_sub_f32 v137, v137, v255
    v_exp_f32 v137, v137
    v_sub_f32 v126, v126, v255
    v_mul_f32 v166, v206, v166
    v_mul_f32 v167, v206, v167
    v_cvt_pk_bf16_f32 v180, v166, v167
    v_mul_f32 v168, v206, v168
    v_mul_f32 v169, v206, v169
    v_cvt_pk_bf16_f32 v181, v168, v169
    v_cvt_pk_bf16_f32 v121, v136, v137
    v_mfma_f32_16x16x32_bf16 v[134:137], v[230:233], v[36:39], 0
    buffer_load_dwordx4 v14, s[8:11], 0 offen nt lds
    v_sub_f32 v127, v127, v255
    v_mfma_f32_16x16x32_bf16 v[134:137], v[114:117], v[158:161], v[134:137]
    ds_write_b128 v3, v[178:181] offset:0
    v_mfma_f32_16x16x32_bf16 v[158:161], a[240:243], v[198:201], 0
    v_exp_f32 v126, v126
    v_mfma_f32_16x16x32_bf16 v[158:161], a[244:247], v[138:141], v[158:161]
    v_exp_f32 v127, v127
    v_mfma_f32_16x16x32_bf16 v[158:161], a[248:251], v[210:213], v[158:161]
    v_cvt_pk_bf16_f32 v36, v126, v127
    v_sub_f32 v128, v128, v255
    v_mfma_f32_16x16x32_bf16 v[158:161], a[252:255], v[186:189], v[158:161]
    v_mul_f32 v134, v206, v134
    v_mul_f32 v135, v206, v135
    v_mfma_f32_16x16x32_bf16 v[158:161], v[82:85], v[222:225], v[158:161]
    v_cvt_pk_bf16_f32 v126, v134, v135
    v_mul_f32 v136, v206, v136
    v_mfma_f32_16x16x32_bf16 v[158:161], v[86:89], v[154:157], v[158:161]
    v_mul_f32 v137, v206, v137
    v_cvt_pk_bf16_f32 v127, v136, v137
    v_mfma_f32_16x16x32_bf16 v[178:181], v[90:93], v[198:201], 0
    ds_read_b128 v[198:201], v2 offset:12288
    v_sub_f32 v129, v129, v255
    v_mfma_f32_16x16x32_bf16 v[178:181], v[94:97], v[138:141], v[178:181]
    ds_read_b128 v[206:209], v2 offset:13312
    v_sub_f32 v218, v218, v255
    v_mfma_f32_16x16x32_bf16 v[178:181], v[98:101], v[210:213], v[178:181]
    ds_read_b128 v[210:213], v2 offset:14336
    v_max_f32_dpp v122, v122, v122 quad_perm:[1,0,3,2] row_mask:0xf bank_mask:0xf
    v_mfma_f32_16x16x32_bf16 v[178:181], v[102:105], v[186:189], v[178:181]
    ds_read_b128 v[134:137], v2 offset:15360
    v_max_f32_dpp v122, v122, v122 quad_perm:[2,3,0,1] row_mask:0xf bank_mask:0xf
    v_mfma_f32_16x16x32_bf16 v[178:181], v[106:109], v[222:225], v[178:181]
    ds_read_b128 v[222:225], v2 offset:16384
    v_max_f32_dpp v122, v122, v122 row_half_mirror row_mask:0xf bank_mask:0xf
    v_mfma_f32_16x16x32_bf16 v[178:181], v[110:113], v[154:157], v[178:181]
    ds_read_b128 v[154:157], v2 offset:17408
    ds_write_b64 v4, v[126:127] offset:4096
    v_exp_f32 v128, v128
    v_exp_f32 v129, v129
    v_mfma_f32_16x16x32_f16 v[186:189], v[242:245], v[174:177], v[70:73]
    s_waitcnt lgkmcnt(6)
    v_cvt_pk_bf16_f32 v37, v128, v129
    v_max_f32_dpp v122, v122, v122 row_mirror row_mask:0xf bank_mask:0xf
    v_mfma_f32_16x16x32_f16 v[242:245], v[226:229], v[174:177], v[74:77]
    s_waitcnt lgkmcnt(5)
    v_exp_f32 v218, v218
    v_mfma_f32_16x16x32_f16 v[126:129], v[146:149], v[174:177], v[78:81]
    s_waitcnt lgkmcnt(4)
    v_cvt_pk_bf16_f32 v39, v218, 0
    v_mov_b32 v123, v122
    v_fma_f32 v255, v150, v150, s33
    v_mfma_f32_16x16x32_bf16 v[174:177], v[28:31], v[36:39], 0
    s_waitcnt lgkmcnt(3)
    v_permlane32_swap_b32 v122, v123
    v_mfma_f32_16x16x32_bf16 v[174:177], v[28:31], v[118:121], v[174:177]
    s_waitcnt lgkmcnt(2)
    v_max_f32 v122, v122, v123
    v_mov_b32 v123, v122
    v_mfma_f32_16x16x32_bf16 v[226:229], v[194:197], v[36:39], 0
    s_waitcnt lgkmcnt(0)
    v_permlane16_swap_b32 v122, v123
    v_mfma_f32_16x16x32_bf16 v[226:229], v[170:173], v[118:121], v[226:229]
    v_max_f32 v122, v122, v123
    v_sub_f32 v254, v254, v122
    v_mfma_f32_16x16x32_bf16 v[218:221], v[214:217], v[36:39], 0
    v_exp_f32 v254, v254
    v_mfma_f32_16x16x32_bf16 v[218:221], v[130:133], v[118:121], v[218:221]
    v_cvt_pk_bf16_f32 v254, v254, v254
    v_fmac_f32 v255, v151, v151
    v_mfma_f32_16x16x32_bf16 v[166:169], v[230:233], v[36:39], 0
    ds_write_b16 v8, v254
    v_mfma_f32_16x16x32_bf16 v[166:169], v[114:117], v[118:121], v[166:169]
    v_rcp_f32 v174, v174
    v_fmac_f32 v255, v152, v152
    v_mfma_f32_16x16x16_f16 v[186:189], v[184:185], v[162:163], v[186:189]
    v_mul_f32 v226, v174, v226
    v_mul_f32 v227, v174, v227
    v_cvt_pk_bf16_f32 v122, v226, v227
    v_mfma_f32_16x16x16_f16 v[242:245], v[124:125], v[162:163], v[242:245]
    v_mul_f32 v228, v174, v228
    v_mul_f32 v229, v174, v229
    v_cvt_pk_bf16_f32 v123, v228, v229
    v_mfma_f32_16x16x16_f16 v[126:129], v[164:165], v[162:163], v[126:129]
    v_max3_f32 v254, v238, v186, v187
    v_max3_f32 v254, v254, v188, v189
    v_mul_f32 v218, v174, v218
    v_mul_f32 v219, v174, v219
    v_mfma_f32_16x16x32_bf16 v[146:149], a[216:219], v[198:201], 0
    ds_read_b128 v[118:121], v9
    ds_read_b128 v[162:165], v9 offset:64
    v_mfma_f32_16x16x32_bf16 v[146:149], a[220:223], v[206:209], v[146:149]
    v_max3_f32 v254, v254, v242, v243
    v_max3_f32 v254, v254, v244, v245
    v_mfma_f32_16x16x32_bf16 v[146:149], a[224:227], v[210:213], v[146:149]
    v_max3_f32 v254, v254, v126, v127
    v_max3_f32 v254, v254, v128, v129
    v_mfma_f32_16x16x32_bf16 v[146:149], a[228:231], v[134:137], v[146:149]
    v_mov_b32 v125, v254
    v_cvt_pk_bf16_f32 v124, v218, v219
    v_mfma_f32_16x16x32_bf16 v[146:149], a[232:235], v[222:225], v[146:149]
    v_permlane32_swap_b32 v254, v125
    v_mfma_f32_16x16x32_bf16 v[146:149], a[236:239], v[154:157], v[146:149]
    v_max_f32 v254, v254, v125
    v_mov_b32 v125, v254
    v_mfma_f32_16x16x32_bf16 v[138:141], a[240:243], v[198:201], 0
    v_mul_f32 v220, v174, v220
    v_mul_f32 v221, v174, v221
    v_mfma_f32_16x16x32_bf16 v[138:141], a[244:247], v[206:209], v[138:141]
    v_permlane16_swap_b32 v254, v125
    v_mfma_f32_16x16x32_bf16 v[138:141], a[248:251], v[210:213], v[138:141]
    s_waitcnt lgkmcnt(0)
    v_max_f32 v254, v254, v125
    v_sub_f32 v186, v186, v254
    v_mfma_f32_16x16x32_bf16 v[138:141], a[252:255], v[134:137], v[138:141]
    v_exp_f32 v186, v186
    v_mfma_f32_16x16x32_bf16 v[138:141], v[82:85], v[222:225], v[138:141]
    v_sub_f32 v187, v187, v254
    v_sub_f32 v188, v188, v254
    v_mfma_f32_16x16x32_bf16 v[138:141], v[86:89], v[154:157], v[138:141]
    v_exp_f32 v187, v187
    v_exp_f32 v188, v188
    v_cvt_pk_bf16_f32 v234, v186, v187
    v_sub_f32 v189, v189, v254
    v_exp_f32 v189, v189
    v_sub_f32 v242, v242, v254
    v_cvt_pk_bf16_f32 v235, v188, v189
    v_exp_f32 v242, v242
    v_sub_f32 v243, v243, v254
    v_exp_f32 v243, v243
    v_sub_f32 v244, v244, v254
    v_cvt_pk_bf16_f32 v236, v242, v243
    v_mfma_f32_16x16x32_bf16 v[186:189], v[90:93], v[198:201], 0
    v_exp_f32 v244, v244
    v_mfma_f32_16x16x32_bf16 v[186:189], v[94:97], v[206:209], v[186:189]
    v_sub_f32 v245, v245, v254
    v_sub_f32 v126, v126, v254
    v_mfma_f32_16x16x32_bf16 v[186:189], v[98:101], v[210:213], v[186:189]
    v_exp_f32 v245, v245
    v_mfma_f32_16x16x32_bf16 v[186:189], v[102:105], v[134:137], v[186:189]
    v_cvt_pk_bf16_f32 v237, v244, v245
    v_sub_f32 v127, v127, v254
    v_mfma_f32_16x16x32_bf16 v[186:189], v[106:109], v[222:225], v[186:189]
    v_exp_f32 v126, v126
    v_mfma_f32_16x16x32_bf16 v[186:189], v[110:113], v[154:157], v[186:189]
    ds_read_b128 v[182:185], v0 offset:20480
    ds_read_b128 v[198:201], v1 offset:20480
    v_mfma_f32_16x16x32_bf16 v[206:209], v[118:121], v[28:31], 0
    ds_read_b128 v[210:213], v0 offset:20608
    ds_read_b128 v[222:225], v1 offset:20608
    v_mfma_f32_16x16x32_bf16 v[206:209], v[162:165], v[28:31], v[206:209]
    v_exp_f32 v127, v127
    v_mfma_f32_16x16x32_bf16 v[154:157], v[118:121], v[170:173], 0
    ds_read_b128 v[226:229], v0 offset:20736
    v_cvt_pk_bf16_f32 v36, v126, v127
    v_mfma_f32_16x16x32_bf16 v[154:157], v[162:165], v[194:197], v[154:157]
    ds_read_b128 v[242:245], v1 offset:20736
    v_sub_f32 v128, v128, v254
    v_exp_f32 v128, v128
    v_sub_f32 v129, v129, v254
    v_exp_f32 v129, v129
    v_sub_f32 v238, v238, v254
    v_cvt_pk_bf16_f32 v37, v128, v129
    v_mfma_f32_16x16x32_bf16 v[134:137], v[118:121], v[130:133], 0
    v_exp_f32 v238, v238
    v_mfma_f32_16x16x32_bf16 v[134:137], v[162:165], v[214:217], v[134:137]
    s_waitcnt lgkmcnt(4)
    v_cvt_pk_bf16_f32 v39, v238, 0
    v_cvt_pk_bf16_f32 v125, v220, v221
    v_mfma_f32_16x16x32_bf16 v[218:221], v[118:121], v[114:117], 0
    s_waitcnt lgkmcnt(2)
    ds_write_b128 v3, v[122:125] offset:6144
    v_mfma_f32_16x16x32_bf16 v[126:129], v[28:31], v[36:39], 0
    s_waitcnt lgkmcnt(2)
    v_mul_f32 v166, v174, v166
    v_mul_f32 v167, v174, v167
    v_mfma_f32_16x16x32_bf16 v[126:129], v[28:31], v[234:237], v[126:129]
    s_waitcnt lgkmcnt(1)
    v_cvt_pk_bf16_f32 v166, v166, v167
    v_mul_f32 v168, v174, v168
    v_mfma_f32_16x16x32_bf16 v[122:125], v[194:197], v[36:39], 0
    v_mul_f32 v169, v174, v169
    v_cvt_pk_bf16_f32 v167, v168, v169
    v_mfma_f32_16x16x32_bf16 v[122:125], v[170:173], v[234:237], v[122:125]
    ds_write_b64 v4, v[166:167] offset:10240
    v_mfma_f32_16x16x32_bf16 v[170:173], v[214:217], v[36:39], 0
    v_rcp_f32 v126, v126
    v_mfma_f32_16x16x32_bf16 v[170:173], v[130:133], v[234:237], v[170:173]
    v_fma_f32 v254, v146, v146, s33
    v_fmac_f32 v254, v147, v147
    v_mfma_f32_16x16x32_bf16 v[174:177], v[230:233], v[36:39], 0
    v_fmac_f32 v254, v148, v148
    v_mul_f32 v122, v126, v122
    v_mfma_f32_16x16x32_bf16 v[174:177], v[114:117], v[234:237], v[174:177]
    v_mul_f32 v123, v126, v123
    v_cvt_pk_bf16_f32 v122, v122, v123
    v_mfma_f32_16x16x32_bf16 v[218:221], v[162:165], v[230:233], v[218:221]
    v_mul_f32 v124, v126, v124
    v_mul_f32 v125, v126, v125
    v_mfma_f32_16x16x32_bf16 v[114:117], a[72:75], v[182:185], 0
    v_cvt_pk_bf16_f32 v123, v124, v125
    v_mul_f32 v170, v126, v170
    v_mfma_f32_16x16x32_bf16 v[114:117], a[76:79], v[198:201], v[114:117]
    v_mul_f32 v171, v126, v171
    v_cvt_pk_bf16_f32 v124, v170, v171
    v_mfma_f32_16x16x32_bf16 v[114:117], a[80:83], v[210:213], v[114:117]
    v_mul_f32 v172, v126, v172
    v_mul_f32 v173, v126, v173
    v_mfma_f32_16x16x32_bf16 v[114:117], a[84:87], v[222:225], v[114:117]
    v_cvt_pk_bf16_f32 v125, v172, v173
    v_mul_f32 v174, v126, v174
    v_mfma_f32_16x16x32_bf16 v[114:117], a[88:91], v[226:229], v[114:117]
    ds_write_b128 v3, v[122:125] offset:12288
    v_mfma_f32_16x16x32_bf16 v[114:117], a[92:95], v[242:245], v[114:117]
    v_mul_f32 v175, v126, v175
    v_cvt_pk_bf16_f32 v174, v174, v175
    v_mfma_f32_16x16x32_bf16 v[122:125], a[96:99], v[182:185], 0
    v_mul_f32 v176, v126, v176
    v_mul_f32 v177, v126, v177
    v_mfma_f32_16x16x32_bf16 v[122:125], a[100:103], v[198:201], v[122:125]
    v_cvt_pk_bf16_f32 v175, v176, v177
    v_fmac_f32 v254, v149, v149
    v_mfma_f32_16x16x32_bf16 v[122:125], a[104:107], v[210:213], v[122:125]
    ds_write_b64 v4, v[174:175] offset:16384
    v_mfma_f32_16x16x32_bf16 v[122:125], a[108:111], v[222:225], v[122:125]
    v_fmac_f32 v254, v138, v138
    v_fmac_f32 v254, v139, v139
    v_mfma_f32_16x16x32_bf16 v[122:125], a[112:115], v[226:229], v[122:125]
    v_fmac_f32 v254, v140, v140
    v_fmac_f32 v254, v141, v141
    v_mfma_f32_16x16x32_bf16 v[122:125], a[116:119], v[242:245], v[122:125]
    v_fmac_f32 v254, v186, v186
    v_fmac_f32 v254, v187, v187
    v_mfma_f32_16x16x32_bf16 v[126:129], a[120:123], v[182:185], 0
    v_fmac_f32 v254, v188, v188
    v_fmac_f32 v254, v189, v189
    v_mfma_f32_16x16x32_bf16 v[126:129], a[124:127], v[198:201], v[126:129]
    v_cvt_pk_bf16_f32 v155, v254, v254
    v_fmac_f32 v255, v153, v153
    v_mfma_f32_16x16x32_bf16 v[126:129], a[128:131], v[210:213], v[126:129]
    v_rcp_f32 v206, v206
    v_mfma_f32_16x16x32_bf16 v[126:129], a[132:135], v[222:225], v[126:129]
    v_mul_f32 v154, v154, v206
    v_mul_f32_dpp v154, v134, v206 quad_perm:[0,1,2,3] row_mask:0x2 bank_mask:0xf
    v_mfma_f32_16x16x32_bf16 v[126:129], a[136:139], v[226:229], v[126:129]
    v_mul_f32_dpp v154, v218, v206 quad_perm:[0,1,2,3] row_mask:0x4 bank_mask:0xf
    v_cvt_pk_bf16_f32 v154, v154, v154
    v_mfma_f32_16x16x32_bf16 v[126:129], a[140:143], v[242:245], v[126:129]
    ds_write_b16 v7, v154
    v_mfma_f32_16x16x32_bf16 v[206:209], a[0:3], v[182:185], 0
    v_fmac_f32 v255, v190, v190
    v_fmac_f32 v255, v191, v191
    v_mfma_f32_16x16x32_bf16 v[206:209], a[4:7], v[198:201], v[206:209]
    v_fmac_f32 v255, v192, v192
    v_fmac_f32 v255, v193, v193
    v_mfma_f32_16x16x32_bf16 v[206:209], a[8:11], v[210:213], v[206:209]
    v_fmac_f32 v255, v202, v202
    v_fmac_f32 v255, v203, v203
    v_mfma_f32_16x16x32_bf16 v[206:209], a[12:15], v[222:225], v[206:209]
    v_fmac_f32 v255, v204, v204
    v_fmac_f32 v255, v205, v205
    v_mfma_f32_16x16x32_bf16 v[206:209], a[16:19], v[226:229], v[206:209]
    v_fma_f32 v254, v142, v142, s33
    v_fmac_f32 v254, v143, v143
    v_mfma_f32_16x16x32_bf16 v[206:209], a[20:23], v[242:245], v[206:209]
    v_fmac_f32 v254, v144, v144
    v_fmac_f32 v254, v145, v145
    v_mfma_f32_16x16x32_bf16 v[174:177], a[24:27], v[182:185], 0
    v_fmac_f32 v254, v158, v158
    v_fmac_f32 v254, v159, v159
    v_mfma_f32_16x16x32_bf16 v[174:177], a[28:31], v[198:201], v[174:177]
    v_fmac_f32 v254, v160, v160
    v_fmac_f32 v254, v161, v161
    v_mfma_f32_16x16x32_bf16 v[174:177], a[32:35], v[210:213], v[174:177]
    v_fmac_f32 v254, v178, v178
    v_fmac_f32 v254, v179, v179
    v_mfma_f32_16x16x32_bf16 v[174:177], a[36:39], v[222:225], v[174:177]
    v_fmac_f32 v254, v180, v180
    v_fmac_f32 v254, v181, v181
    v_mfma_f32_16x16x32_bf16 v[174:177], a[40:43], v[226:229], v[174:177]
    v_cvt_pk_bf16_f32 v154, v255, v254
    v_add_u32 v5, 336, v5
    v_mfma_f32_16x16x32_bf16 v[174:177], a[44:47], v[242:245], v[174:177]
    ds_write_b64 v4, v[154:155] offset:18432
    v_mfma_f32_16x16x32_bf16 v[218:221], a[48:51], v[182:185], 0
    v_add_u32 v6, 272, v6
    v_add_u32 v7, 16, v7
    v_mfma_f32_16x16x32_bf16 v[218:221], a[52:55], v[198:201], v[218:221]
    v_fma_f32 v130, v114, v114, s32
    v_fmac_f32 v130, v115, v115
    v_mfma_f32_16x16x32_bf16 v[218:221], a[56:59], v[210:213], v[218:221]
    v_fmac_f32 v130, v116, v116
    v_fmac_f32 v130, v117, v117
    v_mfma_f32_16x16x32_bf16 v[218:221], a[60:63], v[222:225], v[218:221]
    v_fmac_f32 v130, v122, v122
    v_fmac_f32 v130, v123, v123
    v_mfma_f32_16x16x32_bf16 v[218:221], a[64:67], v[226:229], v[218:221]
    v_fmac_f32 v130, v124, v124
    v_fmac_f32 v130, v125, v125
    v_mfma_f32_16x16x32_bf16 v[218:221], a[68:71], v[242:245], v[218:221]
    v_fmac_f32 v130, v126, v126
    v_fmac_f32 v130, v127, v127
    v_mfma_f32_16x16x32_bf16 v[170:173], v[182:185], a[144:147], 0
    s_waitcnt lgkmcnt(0)
    v_fmac_f32 v130, v128, v128
    v_fmac_f32 v130, v129, v129
    v_mfma_f32_16x16x32_bf16 v[170:173], v[198:201], a[148:151], v[170:173]
    s_nop 0
    v_fma_f32 v131, v206, v206, s32
    v_fmac_f32 v131, v207, v207
    v_mfma_f32_16x16x32_bf16 v[170:173], v[210:213], a[152:155], v[170:173]
    s_barrier
    v_fmac_f32 v131, v208, v208
    v_fmac_f32 v131, v209, v209
    v_mfma_f32_16x16x32_bf16 v[170:173], v[222:225], a[156:159], v[170:173]
    s_nop 0
    v_fmac_f32 v131, v174, v174
    v_xor_b32 v2, 65536, v2
    v_mfma_f32_16x16x32_bf16 v[170:173], v[226:229], a[160:163], v[170:173]
    s_nop 0
    v_xor_b32 v3, 65536, v3
    v_xor_b32 v4, 65536, v4
    v_mfma_f32_16x16x32_bf16 v[170:173], v[242:245], a[164:167], v[170:173]
    s_cbranch_scc1 L_loop_safe1
    s_branch L_final_safe
.p2align 6
L_loop_safe2:
    v_mfma_f32_16x16x32_bf16 v[162:165], v[182:185], a[168:171], 0
    s_add_u32 s12, s42, s27
    ds_read_b128 v[194:197], v2 offset:18432
    ds_read_b128 v[230:233], v2 offset:19456
    v_mfma_f32_16x16x32_bf16 v[162:165], v[198:201], a[172:175], v[162:165]
    s_addc_u32 s13, s43, 0
    v_fmac_f32 v131, v175, v175
    v_fmac_f32 v131, v176, v176
    v_mfma_f32_16x16x32_bf16 v[162:165], v[210:213], a[176:179], v[162:165]
    s_sub_u32 s14, s36, s27
    v_fmac_f32 v131, v177, v177
    v_fmac_f32 v131, v218, v218
    v_mfma_f32_16x16x32_bf16 v[162:165], v[222:225], a[180:183], v[162:165]
    s_cmp_ge_u32 s18, 2
    v_fmac_f32 v131, v219, v219
    v_fmac_f32 v131, v220, v220
    v_mfma_f32_16x16x32_bf16 v[162:165], v[226:229], a[184:187], v[162:165]
    s_cselect_b32 s14, s14, 0
    ds_read_b128 v[118:121], v0 offset:26624
    v_fmac_f32 v131, v221, v221
    v_mfma_f32_16x16x32_bf16 v[162:165], v[242:245], a[188:191], v[162:165]
    s_add_u32 s34, s18, 2
    ds_read_b128 v[134:137], v1 offset:26624
    v_cvt_pk_bf16_f32 v36, v131, v130
    v_mfma_f32_16x16x32_bf16 v[214:217], v[182:185], a[192:195], 0
    s_add_u32 s8, s40, s23
    ds_read_b128 v[154:157], v0 offset:26752
    v_cvt_pk_bf16_f32 v170, v170, v171
    v_mfma_f32_16x16x32_bf16 v[214:217], v[198:201], a[196:199], v[214:217]
    s_addc_u32 s9, s41, 0
    ds_read_b128 v[198:201], v1 offset:26752
    v_cvt_pk_bf16_f32 v171, v172, v173
    v_mfma_f32_16x16x32_bf16 v[166:169], v[32:35], v[36:39], 0
    s_sub_u32 s10, s36, s23
    v_cvt_pk_bf16_f32 v130, v162, v163
    v_cvt_pk_bf16_f32 v131, v164, v165
    v_mfma_f32_16x16x32_bf16 v[214:217], v[210:213], a[200:203], v[214:217]
    s_waitcnt lgkmcnt(4)
    ds_read_b128 v[210:213], v0 offset:26880
    s_cmp_lt_u32 s34, s17
    v_mfma_f32_16x16x32_bf16 v[234:237], v[32:35], v[194:197], 0
    s_cselect_b32 s10, s10, 0
    v_rsq_f32 v167, v167
    v_mfma_f32_16x16x32_bf16 v[234:237], v[32:35], v[230:233], v[234:237]
    s_add_u32 m0, s28, 0
    v_rsq_f32 v166, v166
    v_mfma_f32_16x16x32_bf16 v[214:217], v[222:225], a[204:207], v[214:217]
    s_waitcnt lgkmcnt(4)
    ds_read_b128 v[162:165], v1 offset:26880
    v_mul_f32 v166, s31, v166
    v_mfma_f32_16x16x32_bf16 v[214:217], v[226:229], a[208:211], v[214:217]
    s_mov_b32 s27, s26
    v_mul_f32 v114, v167, v114
    v_mul_f32 v115, v167, v115
    v_mfma_f32_16x16x32_bf16 v[214:217], v[242:245], a[212:215], v[214:217]
    s_mov_b32 s26, s25
    v_cvt_pk_f16_f32 v242, v114, v115
    v_mul_f32 v116, v167, v116
    v_mfma_f32_16x16x32_bf16 v[226:229], a[72:75], v[118:121], 0
    s_waitcnt lgkmcnt(2)
    v_mul_f32 v117, v167, v117
    v_cvt_pk_f16_f32 v243, v116, v117
    v_mfma_f32_16x16x32_bf16 v[226:229], a[76:79], v[134:137], v[226:229]
    s_mov_b32 s25, s24
    v_cvt_pk_bf16_f32 v114, v214, v215
    v_cvt_pk_bf16_f32 v115, v216, v217
    v_mfma_f32_16x16x32_bf16 v[226:229], a[80:83], v[154:157], v[226:229]
    s_mov_b32 s24, s23
    v_mul_f32 v122, v167, v122
    v_mul_f32 v123, v167, v123
    v_mfma_f32_16x16x32_bf16 v[226:229], a[84:87], v[198:201], v[226:229]
    s_waitcnt lgkmcnt(1)
    v_cvt_pk_f16_f32 v244, v122, v123
    v_mul_f32 v124, v167, v124
    v_mfma_f32_16x16x32_bf16 v[226:229], a[88:91], v[210:213], v[226:229]
    v_mul_f32 v125, v167, v125
    v_cvt_pk_f16_f32 v245, v124, v125
    v_mfma_f32_16x16x32_bf16 v[122:125], a[96:99], v[118:121], 0
    s_waitcnt lgkmcnt(0)
    v_mul_f32 v126, v167, v126
    v_mul_f32 v127, v167, v127
    v_mfma_f32_16x16x32_bf16 v[226:229], a[92:95], v[162:165], v[226:229]
    v_cvt_pk_f16_f32 v184, v126, v127
    v_mul_f32 v128, v167, v128
    v_mfma_f32_16x16x32_bf16 v[122:125], a[100:103], v[134:137], v[122:125]
    v_mul_f32 v129, v167, v129
    v_cvt_pk_f16_f32 v185, v128, v129
    v_mfma_f32_16x16x32_bf16 v[122:125], a[104:107], v[154:157], v[122:125]
    v_mul_f32 v206, v166, v206
    v_mul_f32 v207, v166, v207
    v_mfma_f32_16x16x32_bf16 v[122:125], a[108:111], v[198:201], v[122:125]
    v_cvt_pk_f16_f32 v222, v206, v207
    v_mul_f32 v208, v166, v208
    v_mfma_f32_16x16x32_bf16 v[122:125], a[112:115], v[210:213], v[122:125]
    v_mul_f32 v209, v166, v209
    v_cvt_pk_f16_f32 v223, v208, v209
    v_mfma_f32_16x16x32_bf16 v[122:125], a[116:119], v[162:165], v[122:125]
    v_mul_f32 v174, v166, v174
    v_mul_f32 v175, v166, v175
    v_mfma_f32_16x16x32_bf16 v[126:129], a[120:123], v[118:121], 0
    v_cvt_pk_f16_f32 v224, v174, v175
    v_mul_f32 v176, v166, v176
    v_mfma_f32_16x16x32_bf16 v[126:129], a[124:127], v[134:137], v[126:129]
    v_mul_f32 v177, v166, v177
    v_cvt_pk_f16_f32 v225, v176, v177
    v_mfma_f32_16x16x32_bf16 v[126:129], a[128:131], v[154:157], v[126:129]
    v_mul_f32 v218, v166, v218
    v_mul_f32 v219, v166, v219
    v_mfma_f32_16x16x32_bf16 v[126:129], a[132:135], v[198:201], v[126:129]
    v_cvt_pk_f16_f32 v182, v218, v219
    v_mul_f32 v220, v166, v220
    v_mfma_f32_16x16x32_bf16 v[126:129], a[136:139], v[210:213], v[126:129]
    v_mul_f32 v221, v166, v221
    v_cvt_pk_f16_f32 v183, v220, v221
    v_mfma_f32_16x16x32_bf16 v[126:129], a[140:143], v[162:165], v[126:129]
    v_fma_f32 v116, v226, v226, s32
    v_fmac_f32 v116, v227, v227
    v_mfma_f32_16x16x32_bf16 v[206:209], a[0:3], v[118:121], 0
    v_fmac_f32 v116, v228, v228
    v_fmac_f32 v116, v229, v229
    v_mfma_f32_16x16x32_bf16 v[206:209], a[4:7], v[134:137], v[206:209]
    v_fmac_f32 v116, v122, v122
    v_fmac_f32 v116, v123, v123
    v_mfma_f32_16x16x32_bf16 v[206:209], a[8:11], v[154:157], v[206:209]
    v_fmac_f32 v116, v124, v124
    v_fmac_f32 v116, v125, v125
    v_mfma_f32_16x16x32_bf16 v[206:209], a[12:15], v[198:201], v[206:209]
    v_fmac_f32 v116, v126, v126
    v_fmac_f32 v116, v127, v127
    v_mfma_f32_16x16x32_bf16 v[206:209], a[16:19], v[210:213], v[206:209]
    v_fmac_f32 v116, v128, v128
    v_fmac_f32 v116, v129, v129
    v_mfma_f32_16x16x32_bf16 v[206:209], a[20:23], v[162:165], v[206:209]
    v_mul_f32 v117, 0x3baaaaab, v234
    v_mul_f32 v254, 0x3baaaaab, v235
    v_mfma_f32_16x16x32_bf16 v[174:177], a[24:27], v[118:121], 0
    v_rsq_f32 v117, v117
    v_mfma_f32_16x16x32_bf16 v[174:177], a[28:31], v[134:137], v[174:177]
    v_rsq_f32 v254, v254
    v_mfma_f32_16x16x32_bf16 v[174:177], a[32:35], v[154:157], v[174:177]
    v_mul_f32 v255, 0x3baaaaab, v236
    v_fma_f32 v132, v206, v206, s32
    v_mfma_f32_16x16x32_bf16 v[174:177], a[36:39], v[198:201], v[174:177]
    v_fmac_f32 v132, v207, v207
    v_fmac_f32 v132, v208, v208
    v_mfma_f32_16x16x32_bf16 v[174:177], a[40:43], v[210:213], v[174:177]
    v_fmac_f32 v132, v209, v209
    v_mul_f32 v150, v117, v150
    v_mfma_f32_16x16x32_bf16 v[174:177], a[44:47], v[162:165], v[174:177]
    v_rsq_f32 v255, v255
    v_mfma_f32_16x16x32_bf16 v[218:221], a[48:51], v[118:121], 0
    v_mul_f32 v151, v117, v151
    v_cvt_pk_bf16_f32 v194, v150, v151
    v_mfma_f32_16x16x32_bf16 v[218:221], a[52:55], v[134:137], v[218:221]
    v_mul_f32 v152, v117, v152
    v_mul_f32 v153, v117, v153
    v_mfma_f32_16x16x32_bf16 v[218:221], a[56:59], v[154:157], v[218:221]
    v_fmac_f32 v132, v174, v174
    v_fmac_f32 v132, v175, v175
    v_mfma_f32_16x16x32_bf16 v[218:221], a[60:63], v[198:201], v[218:221]
    v_fmac_f32 v132, v176, v176
    v_fmac_f32 v132, v177, v177
    v_mfma_f32_16x16x32_bf16 v[218:221], a[64:67], v[210:213], v[218:221]
    v_cvt_pk_bf16_f32 v195, v152, v153
    v_mul_f32 v190, v117, v190
    v_mfma_f32_16x16x32_bf16 v[218:221], a[68:71], v[162:165], v[218:221]
    v_mul_f32 v191, v117, v191
    v_cvt_pk_bf16_f32 v196, v190, v191
    v_mfma_f32_16x16x32_bf16 v[150:153], v[118:121], a[144:147], 0
    v_mul_f32 v192, v117, v192
    v_mul_f32 v193, v117, v193
    v_mfma_f32_16x16x32_bf16 v[150:153], v[134:137], a[148:151], v[150:153]
    v_cvt_pk_bf16_f32 v197, v192, v193
    v_mul_f32 v202, v117, v202
    v_mfma_f32_16x16x32_bf16 v[150:153], v[154:157], a[152:155], v[150:153]
    buffer_store_dwordx4 v[194:197], v15, s[12:15], 0 offen nt
    v_fmac_f32 v132, v218, v218
    v_fmac_f32 v132, v219, v219
    v_fmac_f32 v132, v220, v220
    v_fmac_f32 v132, v221, v221
    v_mfma_f32_16x16x32_bf16 v[150:153], v[198:201], a[156:159], v[150:153]
    v_cvt_pk_bf16_f32 v36, v132, v116
    v_mul_f32 v203, v117, v203
    v_mfma_f32_16x16x32_bf16 v[150:153], v[210:213], a[160:163], v[150:153]
    v_cvt_pk_bf16_f32 v116, v202, v203
    v_mul_f32 v204, v117, v204
    v_mfma_f32_16x16x32_bf16 v[190:193], v[32:35], v[36:39], 0
    v_mul_f32 v205, v117, v205
    v_cvt_pk_bf16_f32 v117, v204, v205
    v_mfma_f32_16x16x32_bf16 v[150:153], v[162:165], a[164:167], v[150:153]
    v_mul_f32 v146, v255, v146
    v_mul_f32 v147, v255, v147
    v_mfma_f32_16x16x32_bf16 v[202:205], v[118:121], a[168:171], 0
    v_cvt_pk_bf16_f32 v146, v146, v147
    v_mul_f32 v148, v255, v148
    v_mfma_f32_16x16x32_bf16 v[202:205], v[134:137], a[172:175], v[202:205]
    v_rsq_f32 v191, v191
    v_mfma_f32_16x16x32_bf16 v[202:205], v[154:157], a[176:179], v[202:205]
    v_cvt_pk_bf16_f32 v172, v150, v151
    v_cvt_pk_bf16_f32 v173, v152, v153
    v_mfma_f32_16x16x32_bf16 v[202:205], v[198:201], a[180:183], v[202:205]
    v_rsq_f32 v190, v190
    v_mfma_f32_16x16x32_bf16 v[202:205], v[210:213], a[184:187], v[202:205]
    ds_read_b128 v[150:153], v0 offset:32768
    v_mul_f32 v190, s31, v190
    v_mfma_f32_16x16x32_bf16 v[202:205], v[162:165], a[188:191], v[202:205]
    ds_read_b128 v[166:169], v1 offset:32768
    v_mul_f32 v226, v191, v226
    v_mfma_f32_16x16x32_bf16 v[194:197], v[118:121], a[192:195], 0
    ds_read_b128 v[118:121], v0 offset:32896
    v_mul_f32 v227, v191, v227
    v_mfma_f32_16x16x32_bf16 v[194:197], v[134:137], a[196:199], v[194:197]
    ds_read_b128 v[134:137], v1 offset:32896
    v_cvt_pk_f16_f32 v226, v226, v227
    v_mfma_f32_16x16x32_bf16 v[194:197], v[154:157], a[200:203], v[194:197]
    ds_read_b128 v[154:157], v0 offset:33024
    v_cvt_pk_bf16_f32 v132, v202, v203
    v_mfma_f32_16x16x32_bf16 v[194:197], v[198:201], a[204:207], v[194:197]
    ds_read_b128 v[198:201], v1 offset:33024
    v_cvt_pk_bf16_f32 v133, v204, v205
    v_mfma_f32_16x16x32_bf16 v[194:197], v[210:213], a[208:211], v[194:197]
    v_mul_f32 v228, v191, v228
    v_mul_f32 v229, v191, v229
    v_mfma_f32_16x16x32_bf16 v[194:197], v[162:165], a[212:215], v[194:197]
    v_cvt_pk_f16_f32 v227, v228, v229
    v_mul_f32 v122, v191, v122
    v_mfma_f32_16x16x32_f16 v[210:213], v[242:245], v[222:225], v[46:49]
    s_waitcnt lgkmcnt(5)
    buffer_store_dwordx2 v[116:117], v18, s[12:15], 0 offen nt
    v_mul_f32 v123, v191, v123
    v_cvt_pk_f16_f32 v228, v122, v123
    v_mfma_f32_16x16x32_bf16 v[202:205], a[72:75], v[150:153], 0
    s_waitcnt lgkmcnt(3)
    v_cvt_pk_bf16_f32 v116, v194, v195
    v_cvt_pk_bf16_f32 v117, v196, v197
    v_mfma_f32_16x16x32_bf16 v[202:205], a[76:79], v[166:169], v[202:205]
    s_waitcnt lgkmcnt(2)
    v_mul_f32 v124, v191, v124
    v_mul_f32 v125, v191, v125
    v_mfma_f32_16x16x32_bf16 v[202:205], a[80:83], v[118:121], v[202:205]
    s_waitcnt lgkmcnt(1)
    v_cvt_pk_f16_f32 v229, v124, v125
    v_mul_f32 v126, v191, v126
    v_mfma_f32_16x16x32_bf16 v[202:205], a[84:87], v[134:137], v[202:205]
    s_waitcnt lgkmcnt(0)
    v_mul_f32 v127, v191, v127
    v_cvt_pk_f16_f32 v124, v126, v127
    v_mfma_f32_16x16x32_bf16 v[202:205], a[88:91], v[154:157], v[202:205]
    v_mul_f32 v128, v191, v128
    v_mul_f32 v129, v191, v129
    v_mfma_f32_16x16x32_bf16 v[202:205], a[92:95], v[198:201], v[202:205]
    v_cvt_pk_f16_f32 v125, v128, v129
    v_mul_f32 v206, v190, v206
    v_mfma_f32_16x16x32_bf16 v[126:129], a[96:99], v[150:153], 0
    v_mul_f32 v207, v190, v207
    v_cvt_pk_f16_f32 v206, v206, v207
    v_mfma_f32_16x16x32_bf16 v[126:129], a[100:103], v[166:169], v[126:129]
    v_mul_f32 v208, v190, v208
    v_mul_f32 v209, v190, v209
    v_mfma_f32_16x16x32_bf16 v[126:129], a[104:107], v[118:121], v[126:129]
    v_cvt_pk_f16_f32 v207, v208, v209
    v_mul_f32 v174, v190, v174
    v_mfma_f32_16x16x32_bf16 v[126:129], a[108:111], v[134:137], v[126:129]
    v_mul_f32 v175, v190, v175
    v_cvt_pk_f16_f32 v208, v174, v175
    v_mfma_f32_16x16x32_bf16 v[126:129], a[112:115], v[154:157], v[126:129]
    v_mul_f32 v176, v190, v176
    v_mul_f32 v177, v190, v177
    v_mfma_f32_16x16x32_bf16 v[126:129], a[116:119], v[198:201], v[126:129]
    v_cvt_pk_f16_f32 v209, v176, v177
    v_mul_f32 v218, v190, v218
    v_mfma_f32_16x16x32_bf16 v[174:177], a[120:123], v[150:153], 0
    v_mul_f32 v219, v190, v219
    v_cvt_pk_f16_f32 v122, v218, v219
    v_mfma_f32_16x16x32_bf16 v[174:177], a[124:127], v[166:169], v[174:177]
    v_mul_f32 v220, v190, v220
    v_mul_f32 v221, v190, v221
    v_mfma_f32_16x16x32_bf16 v[174:177], a[128:131], v[118:121], v[174:177]
    v_cvt_pk_f16_f32 v123, v220, v221
    v_fma_f32 v162, v202, v202, s32
    v_mfma_f32_16x16x32_bf16 v[174:177], a[132:135], v[134:137], v[174:177]
    v_fmac_f32 v162, v203, v203
    v_fmac_f32 v162, v204, v204
    v_mfma_f32_16x16x32_bf16 v[174:177], a[136:139], v[154:157], v[174:177]
    v_fmac_f32 v162, v205, v205
    v_fmac_f32 v162, v126, v126
    v_mfma_f32_16x16x32_bf16 v[174:177], a[140:143], v[198:201], v[174:177]
    v_fmac_f32 v162, v127, v127
    v_fmac_f32 v162, v128, v128
    v_mfma_f32_16x16x32_bf16 v[190:193], a[0:3], v[150:153], 0
    v_fmac_f32 v162, v129, v129
    v_mul_f32 v149, v255, v149
    v_mfma_f32_16x16x32_bf16 v[190:193], a[4:7], v[166:169], v[190:193]
    v_cvt_pk_bf16_f32 v147, v148, v149
    v_mul_f32 v138, v255, v138
    v_mfma_f32_16x16x32_bf16 v[190:193], a[8:11], v[118:121], v[190:193]
    v_fmac_f32 v162, v174, v174
    v_fmac_f32 v162, v175, v175
    v_mfma_f32_16x16x32_bf16 v[190:193], a[12:15], v[134:137], v[190:193]
    v_fmac_f32 v162, v176, v176
    v_fmac_f32 v162, v177, v177
    v_mfma_f32_16x16x32_bf16 v[190:193], a[16:19], v[154:157], v[190:193]
    v_mul_f32 v139, v255, v139
    v_cvt_pk_bf16_f32 v148, v138, v139
    v_mfma_f32_16x16x32_bf16 v[190:193], a[20:23], v[198:201], v[190:193]
    v_mul_f32 v140, v255, v140
    v_mul_f32 v141, v255, v141
    v_mfma_f32_16x16x32_bf16 v[218:221], a[24:27], v[150:153], 0
    v_cvt_pk_bf16_f32 v149, v140, v141
    v_mul_f32 v186, v255, v186
    v_mfma_f32_16x16x32_bf16 v[218:221], a[28:31], v[166:169], v[218:221]
    buffer_store_dwordx4 v[146:149], v17, s[12:15], 0 offen nt
    v_mul_f32 v187, v255, v187
    v_fma_f32 v163, v190, v190, s32
    v_fmac_f32 v163, v191, v191
    v_fmac_f32 v163, v192, v192
    v_mfma_f32_16x16x32_bf16 v[218:221], a[32:35], v[118:121], v[218:221]
    v_fmac_f32 v163, v193, v193
    v_cvt_pk_bf16_f32 v164, v186, v187
    v_mfma_f32_16x16x32_bf16 v[218:221], a[36:39], v[134:137], v[218:221]
    v_mul_f32 v188, v255, v188
    v_mul_f32 v189, v255, v189
    v_mfma_f32_16x16x32_bf16 v[218:221], a[40:43], v[154:157], v[218:221]
    v_cvt_pk_bf16_f32 v165, v188, v189
    v_mul_f32 v142, v254, v142
    v_mfma_f32_16x16x32_bf16 v[218:221], a[44:47], v[198:201], v[218:221]
    v_mul_f32 v143, v254, v143
    v_cvt_pk_bf16_f32 v142, v142, v143
    v_mfma_f32_16x16x32_bf16 v[138:141], a[48:51], v[150:153], 0
    v_mul_f32 v144, v254, v144
    v_mul_f32 v145, v254, v145
    v_mfma_f32_16x16x32_bf16 v[138:141], a[52:55], v[166:169], v[138:141]
    v_cvt_pk_bf16_f32 v143, v144, v145
    v_mul_f32 v158, v254, v158
    v_mfma_f32_16x16x32_bf16 v[138:141], a[56:59], v[118:121], v[138:141]
    v_fmac_f32 v163, v218, v218
    v_fmac_f32 v163, v219, v219
    v_mfma_f32_16x16x32_bf16 v[138:141], a[60:63], v[134:137], v[138:141]
    ds_read2_b32 v[196:197], v6 offset0:0 offset1:0
    ds_read2_b32 v[216:217], v6 offset0:16 offset1:16
    v_mfma_f32_16x16x32_bf16 v[138:141], a[64:67], v[154:157], v[138:141]
    ds_read2_b32 v[232:233], v6 offset0:32 offset1:32
    v_fmac_f32 v163, v220, v220
    v_mfma_f32_16x16x32_bf16 v[138:141], a[68:71], v[198:201], v[138:141]
    v_fmac_f32 v163, v221, v221
    v_mul_f32 v159, v254, v159
    v_mfma_f32_16x16x32_bf16 v[146:149], v[150:153], a[144:147], 0
    v_cvt_pk_bf16_f32 v144, v158, v159
    v_mul_f32 v160, v254, v160
    v_mfma_f32_16x16x32_bf16 v[146:149], v[166:169], a[148:151], v[146:149]
    v_mul_f32 v161, v254, v161
    v_cvt_pk_bf16_f32 v145, v160, v161
    v_mfma_f32_16x16x32_bf16 v[146:149], v[118:121], a[152:155], v[146:149]
    v_fmac_f32 v163, v138, v138
    v_fmac_f32 v163, v139, v139
    v_mfma_f32_16x16x32_bf16 v[146:149], v[134:137], a[156:159], v[146:149]
    v_fmac_f32 v163, v140, v140
    v_fmac_f32 v163, v141, v141
    v_mfma_f32_16x16x32_bf16 v[146:149], v[154:157], a[160:163], v[146:149]
    v_cvt_pk_bf16_f32 v36, v163, v162
    v_mul_f32 v178, v254, v178
    v_mfma_f32_16x16x32_bf16 v[146:149], v[198:201], a[164:167], v[146:149]
    s_waitcnt lgkmcnt(1)
    v_mul_f32 v179, v254, v179
    v_cvt_pk_bf16_f32 v178, v178, v179
    v_mfma_f32_16x16x32_bf16 v[158:161], v[32:35], v[36:39], 0
    s_waitcnt lgkmcnt(0)
    buffer_store_dwordx2 v[164:165], v20, s[12:15], 0 offen nt
    v_mul_f32 v180, v254, v180
    v_mul_f32 v181, v254, v181
    v_mfma_f32_16x16x32_bf16 v[186:189], v[150:153], a[168:171], 0
    v_cvt_pk_bf16_f32 v194, v146, v147
    v_cvt_pk_bf16_f32 v195, v148, v149
    v_mfma_f32_16x16x32_bf16 v[186:189], v[166:169], a[172:175], v[186:189]
    v_rsq_f32 v159, v159
    v_mfma_f32_16x16x32_bf16 v[186:189], v[118:121], a[176:179], v[186:189]
    v_rsq_f32 v158, v158
    v_mfma_f32_16x16x32_bf16 v[186:189], v[134:137], a[180:183], v[186:189]
    v_mul_f32 v158, s31, v158
    v_mul_f32 v202, v159, v202
    v_mfma_f32_16x16x32_bf16 v[186:189], v[154:157], a[184:187], v[186:189]
    v_mul_f32 v203, v159, v203
    v_cvt_pk_f16_f32 v146, v202, v203
    v_mfma_f32_16x16x32_bf16 v[186:189], v[198:201], a[188:191], v[186:189]
    v_mul_f32 v204, v159, v204
    v_mul_f32 v205, v159, v205
    v_mfma_f32_16x16x32_bf16 v[162:165], v[150:153], a[192:195], 0
    v_cvt_pk_f16_f32 v147, v204, v205
    v_mul_f32 v126, v159, v126
    v_mfma_f32_16x16x32_bf16 v[162:165], v[166:169], a[196:199], v[162:165]
    ds_read_b128 v[150:153], v5 offset:0
    ds_read_b128 v[202:205], v5 offset:16
    v_mfma_f32_16x16x32_bf16 v[162:165], v[118:121], a[200:203], v[162:165]
    ds_read_b128 v[118:121], v5 offset:48
    ds_read_b32 v254, v6 offset:192
    v_mfma_f32_16x16x32_bf16 v[162:165], v[134:137], a[204:207], v[162:165]
    v_cvt_pk_bf16_f32 v214, v186, v187
    v_cvt_pk_bf16_f32 v215, v188, v189
    v_mfma_f32_16x16x32_bf16 v[162:165], v[154:157], a[208:211], v[162:165]
    v_mul_f32 v127, v159, v127
    v_cvt_pk_f16_f32 v148, v126, v127
    v_mfma_f32_16x16x32_bf16 v[162:165], v[198:201], a[212:215], v[162:165]
    ds_read_b128 v[198:201], v2 offset:0
    ds_read_b128 v[186:189], v2 offset:1024
    v_mfma_f32_16x16x32_f16 v[134:137], v[226:229], v[222:225], v[50:53]
    ds_read_b128 v[154:157], v2 offset:2048
    v_mul_f32 v128, v159, v128
    v_mul_f32 v129, v159, v129
    v_mfma_f32_16x16x16_f16 v[210:213], v[184:185], v[182:183], v[210:213]
    v_cvt_pk_f16_f32 v149, v128, v129
    v_cvt_pk_bf16_f32 v230, v162, v163
    v_cvt_pk_bf16_f32 v231, v164, v165
    v_mul_f32 v174, v159, v174
    v_mfma_f32_16x16x32_f16 v[126:129], v[146:149], v[222:225], v[54:57]
    s_waitcnt lgkmcnt(5)
    v_mul_f32 v175, v159, v175
    v_cvt_pk_f16_f32 v164, v174, v175
    v_mul_f32 v176, v159, v176
    v_mfma_f32_16x16x16_f16 v[134:137], v[124:125], v[182:183], v[134:137]
    v_mul_f32 v177, v159, v177
    v_cvt_pk_f16_f32 v165, v176, v177
    v_mul_f32 v190, v158, v190
    v_mul_f32 v191, v158, v191
    v_mfma_f32_16x16x16_f16 v[126:129], v[164:165], v[182:183], v[126:129]
    v_cvt_pk_f16_f32 v174, v190, v191
    v_mul_f32 v192, v158, v192
    v_mul_f32 v193, v158, v193
    v_cvt_pk_f16_f32 v175, v192, v193
    v_mfma_f32_16x16x32_f16 v[166:169], v[150:153], v[222:225], v[22:25]
    s_waitcnt lgkmcnt(2)
    ds_read_b128 v[222:225], v2 offset:3072
    buffer_store_dwordx4 v[142:145], v16, s[12:15], 0 offen nt
    ds_read_b128 v[234:237], v2 offset:4096
    v_mul_f32 v218, v158, v218
    v_mul_f32 v219, v158, v219
    v_cvt_pk_f16_f32 v176, v218, v219
    v_mfma_f32_16x16x32_f16 v[166:169], v[202:205], v[242:245], v[166:169]
    s_waitcnt lgkmcnt(2)
    v_mul_f32 v220, v158, v220
    v_mul_f32 v221, v158, v221
    v_mfma_f32_16x16x32_f16 v[166:169], v[118:121], v[182:185], v[166:169]
    ds_read_b128 v[142:145], v2 offset:5120
    v_cvt_pk_f16_f32 v177, v220, v221
    v_mul_f32 v138, v158, v138
    v_mul_f32 v139, v158, v139
    v_cvt_pk_f16_f32 v162, v138, v139
    v_mfma_f32_16x16x32_f16 v[218:221], v[150:153], v[206:209], v[24:27]
    v_mul_f32 v140, v158, v140
    v_mul_f32 v141, v158, v141
    v_mfma_f32_16x16x32_f16 v[218:221], v[202:205], v[226:229], v[218:221]
    v_mov_b32_dpp v254, v167 quad_perm:[0,1,2,3] row_mask:0x1 bank_mask:0xf
    v_cvt_pk_f16_f32 v163, v140, v141
    v_mfma_f32_16x16x32_f16 v[218:221], v[118:121], v[122:125], v[218:221]
    v_max3_f32 v255, v166, v210, v211
    v_max3_f32 v255, v255, v212, v213
    v_mfma_f32_16x16x32_f16 v[238:241], v[150:153], v[174:177], v[26:29]
    s_waitcnt lgkmcnt(1)
    v_max3_f32 v255, v255, v134, v135
    v_max3_f32 v255, v255, v136, v137
    v_mfma_f32_16x16x32_f16 v[238:241], v[202:205], v[146:149], v[238:241]
    v_max3_f32 v255, v255, v126, v127
    v_mov_b32_dpp v254, v219 quad_perm:[0,1,2,3] row_mask:0x2 bank_mask:0xf
    v_mfma_f32_16x16x32_f16 v[238:241], v[118:121], v[162:165], v[238:241]
    v_max3_f32 v255, v255, v128, v129
    v_mov_b32 v182, v255
    v_mfma_f32_16x16x32_bf16 v[150:153], a[216:219], v[198:201], 0
    s_waitcnt lgkmcnt(0)
    v_permlane32_swap_b32 v255, v182
    v_mfma_f32_16x16x32_bf16 v[150:153], a[220:223], v[186:189], v[150:153]
    v_max_f32 v255, v255, v182
    v_mov_b32 v182, v255
    v_mfma_f32_16x16x32_bf16 v[150:153], a[224:227], v[154:157], v[150:153]
    v_cvt_pk_bf16_f32 v179, v180, v181
    v_xor_b32 v0, 65536, v0
    v_mfma_f32_16x16x32_bf16 v[150:153], a[228:231], v[222:225], v[150:153]
    s_waitcnt vmcnt(5)
    v_permlane16_swap_b32 v255, v182
    v_mfma_f32_16x16x32_bf16 v[150:153], a[232:235], v[234:237], v[150:153]
    s_nop 0
    v_max_f32 v255, v255, v182
    v_sub_f32 v210, v210, v255
    v_mfma_f32_16x16x32_bf16 v[150:153], a[236:239], v[142:145], v[150:153]
    s_nop 0
    v_exp_f32 v210, v210
    v_mfma_f32_16x16x32_bf16 v[190:193], a[240:243], v[198:201], 0
    s_barrier
    v_sub_f32 v211, v211, v255
    v_sub_f32 v212, v212, v255
    v_mfma_f32_16x16x32_bf16 v[190:193], a[244:247], v[186:189], v[190:193]
    s_nop 0
    buffer_load_dwordx4 v10, s[8:11], 0 offen nt lds
    v_sub_f32 v213, v213, v255
    v_mfma_f32_16x16x32_bf16 v[190:193], a[248:251], v[154:157], v[190:193]
    s_add_u32 m0, s28, 4096
    v_exp_f32 v211, v211
    v_mfma_f32_16x16x32_bf16 v[190:193], a[252:255], v[222:225], v[190:193]
    v_cvt_pk_bf16_f32 v158, v210, v211
    v_sub_f32 v134, v134, v255
    v_mfma_f32_16x16x32_bf16 v[190:193], v[82:85], v[234:237], v[190:193]
    v_exp_f32 v212, v212
    v_mfma_f32_16x16x32_bf16 v[190:193], v[86:89], v[142:145], v[190:193]
    v_exp_f32 v213, v213
    v_mfma_f32_16x16x32_bf16 v[202:205], v[90:93], v[198:201], 0
    ds_read_b128 v[198:201], v2 offset:6144
    buffer_load_dwordx4 v11, s[8:11], 0 offen nt lds
    v_mfma_f32_16x16x32_bf16 v[202:205], v[94:97], v[186:189], v[202:205]
    s_add_u32 m0, s28, 8192
    ds_read_b128 v[138:141], v2 offset:7168
    v_cvt_pk_bf16_f32 v159, v212, v213
    v_mfma_f32_16x16x32_bf16 v[202:205], v[98:101], v[154:157], v[202:205]
    ds_read_b128 v[210:213], v2 offset:8192
    v_sub_f32 v135, v135, v255
    v_mfma_f32_16x16x32_bf16 v[202:205], v[102:105], v[222:225], v[202:205]
    ds_read_b128 v[186:189], v2 offset:9216
    v_sub_f32 v136, v136, v255
    v_mfma_f32_16x16x32_bf16 v[202:205], v[106:109], v[234:237], v[202:205]
    ds_read_b128 v[222:225], v2 offset:10240
    v_sub_f32 v137, v137, v255
    v_mfma_f32_16x16x32_bf16 v[202:205], v[110:113], v[142:145], v[202:205]
    ds_read_b128 v[154:157], v2 offset:11264
    buffer_load_dwordx4 v12, s[8:11], 0 offen nt lds
    v_exp_f32 v134, v134
    v_mfma_f32_16x16x32_f16 v[118:121], v[242:245], v[206:209], v[58:61]
    s_add_u32 m0, s28, 12288
    v_exp_f32 v135, v135
    v_exp_f32 v136, v136
    v_cvt_pk_bf16_f32 v160, v134, v135
    v_exp_f32 v137, v137
    v_sub_f32 v126, v126, v255
    v_mfma_f32_16x16x16_f16 v[118:121], v[184:185], v[122:123], v[118:121]
    v_cvt_pk_bf16_f32 v161, v136, v137
    v_exp_f32 v126, v126
    v_sub_f32 v127, v127, v255
    v_mfma_f32_16x16x32_f16 v[134:137], v[226:229], v[206:209], v[62:65]
    s_xor_b32 s28, s28, 65536
    buffer_load_dwordx4 v13, s[8:11], 0 offen nt lds
    v_exp_f32 v127, v127
    v_sub_f32 v128, v128, v255
    v_cvt_pk_bf16_f32 v36, v126, v127
    v_exp_f32 v128, v128
    v_mfma_f32_16x16x16_f16 v[134:137], v[124:125], v[122:123], v[134:137]
    v_sub_f32 v129, v129, v255
    v_exp_f32 v129, v129
    v_sub_f32 v166, v166, v255
    v_cvt_pk_bf16_f32 v37, v128, v129
    v_mfma_f32_16x16x32_f16 v[126:129], v[146:149], v[206:209], v[66:69]
    s_waitcnt lgkmcnt(0)
    v_exp_f32 v166, v166
    v_mfma_f32_16x16x32_bf16 v[142:145], a[216:219], v[198:201], 0
    s_mov_b32 m0, s29
    v_cvt_pk_bf16_f32 v39, v166, 0
    v_max3_f32 v255, v218, v118, v119
    v_max3_f32 v255, v255, v120, v121
    v_mfma_f32_16x16x16_f16 v[126:129], v[164:165], v[122:123], v[126:129]
    v_max3_f32 v255, v255, v134, v135
    v_max3_f32 v255, v255, v136, v137
    v_xor_b32 v1, 65536, v1
    v_mov_b32_dpp v254, v239 quad_perm:[0,1,2,3] row_mask:0x4 bank_mask:0xf
    v_mfma_f32_16x16x32_bf16 v[206:209], v[28:31], v[36:39], 0
    s_xor_b32 s29, s29, s30
    buffer_store_dwordx2 v[178:179], v19, s[12:15], 0 offen nt
    v_mov_b32 v122, v254
    v_max3_f32 v255, v255, v126, v127
    v_mfma_f32_16x16x32_bf16 v[206:209], v[28:31], v[158:161], v[206:209]
    s_add_u32 s19, s19, s20
    v_max3_f32 v255, v255, v128, v129
    v_mov_b32 v123, v255
    v_mfma_f32_16x16x32_bf16 v[142:145], a[220:223], v[138:141], v[142:145]
    s_add_u32 s23, s23, s21
    v_permlane32_swap_b32 v255, v123
    v_mfma_f32_16x16x32_bf16 v[142:145], a[224:227], v[210:213], v[142:145]
    s_cmp_ge_u32 s19, 72
    v_rcp_f32 v206, v206
    v_mfma_f32_16x16x32_bf16 v[142:145], a[228:231], v[186:189], v[142:145]
    s_cselect_b32 s34, 72, 0
    v_max_f32 v255, v255, v123
    v_mov_b32 v123, v255
    v_mfma_f32_16x16x32_bf16 v[142:145], a[232:235], v[222:225], v[142:145]
    s_cselect_b32 s35, s22, 0
    v_permlane16_swap_b32 v255, v123
    v_mfma_f32_16x16x32_bf16 v[142:145], a[236:239], v[154:157], v[142:145]
    s_sub_u32 s19, s19, s34
    v_max_f32 v255, v255, v123
    v_sub_f32 v118, v118, v255
    v_mfma_f32_16x16x32_bf16 v[178:181], v[194:197], v[36:39], 0
    s_add_u32 s23, s23, s35
    v_exp_f32 v118, v118
    v_mfma_f32_16x16x32_bf16 v[178:181], v[170:173], v[158:161], v[178:181]
    s_add_u32 s18, s18, 1
    v_sub_f32 v119, v119, v255
    v_exp_f32 v119, v119
    v_sub_f32 v120, v120, v255
    v_cvt_pk_bf16_f32 v118, v118, v119
    v_exp_f32 v120, v120
    v_sub_f32 v121, v121, v255
    v_exp_f32 v121, v121
    v_mul_f32 v178, v206, v178
    v_mul_f32 v179, v206, v179
    v_cvt_pk_bf16_f32 v178, v178, v179
    v_mul_f32 v180, v206, v180
    v_mul_f32 v181, v206, v181
    v_cvt_pk_bf16_f32 v179, v180, v181
    v_cvt_pk_bf16_f32 v119, v120, v121
    v_mfma_f32_16x16x32_bf16 v[166:169], v[214:217], v[36:39], 0
    s_cmp_lt_u32 s18, s45
    v_sub_f32 v134, v134, v255
    v_sub_f32 v135, v135, v255
    v_mfma_f32_16x16x32_bf16 v[166:169], v[130:133], v[158:161], v[166:169]
    v_exp_f32 v134, v134
    v_exp_f32 v135, v135
    v_sub_f32 v136, v136, v255
    v_cvt_pk_bf16_f32 v120, v134, v135
    v_exp_f32 v136, v136
    v_sub_f32 v137, v137, v255
    v_exp_f32 v137, v137
    v_sub_f32 v126, v126, v255
    v_mul_f32 v166, v206, v166
    v_mul_f32 v167, v206, v167
    v_cvt_pk_bf16_f32 v180, v166, v167
    v_mul_f32 v168, v206, v168
    v_mul_f32 v169, v206, v169
    v_cvt_pk_bf16_f32 v181, v168, v169
    v_cvt_pk_bf16_f32 v121, v136, v137
    v_mfma_f32_16x16x32_bf16 v[134:137], v[230:233], v[36:39], 0
    buffer_load_dwordx4 v14, s[8:11], 0 offen nt lds
    v_sub_f32 v127, v127, v255
    v_mfma_f32_16x16x32_bf16 v[134:137], v[114:117], v[158:161], v[134:137]
    ds_write_b128 v3, v[178:181] offset:0
    v_mfma_f32_16x16x32_bf16 v[158:161], a[240:243], v[198:201], 0
    v_exp_f32 v126, v126
    v_mfma_f32_16x16x32_bf16 v[158:161], a[244:247], v[138:141], v[158:161]
    v_exp_f32 v127, v127
    v_mfma_f32_16x16x32_bf16 v[158:161], a[248:251], v[210:213], v[158:161]
    v_cvt_pk_bf16_f32 v36, v126, v127
    v_sub_f32 v128, v128, v255
    v_mfma_f32_16x16x32_bf16 v[158:161], a[252:255], v[186:189], v[158:161]
    v_mul_f32 v134, v206, v134
    v_mul_f32 v135, v206, v135
    v_mfma_f32_16x16x32_bf16 v[158:161], v[82:85], v[222:225], v[158:161]
    v_cvt_pk_bf16_f32 v126, v134, v135
    v_mul_f32 v136, v206, v136
    v_mfma_f32_16x16x32_bf16 v[158:161], v[86:89], v[154:157], v[158:161]
    v_mul_f32 v137, v206, v137
    v_cvt_pk_bf16_f32 v127, v136, v137
    v_mfma_f32_16x16x32_bf16 v[178:181], v[90:93], v[198:201], 0
    ds_read_b128 v[198:201], v2 offset:12288
    v_sub_f32 v129, v129, v255
    v_mfma_f32_16x16x32_bf16 v[178:181], v[94:97], v[138:141], v[178:181]
    ds_read_b128 v[206:209], v2 offset:13312
    v_sub_f32 v218, v218, v255
    v_mfma_f32_16x16x32_bf16 v[178:181], v[98:101], v[210:213], v[178:181]
    ds_read_b128 v[210:213], v2 offset:14336
    v_max_f32_dpp v122, v122, v122 quad_perm:[1,0,3,2] row_mask:0xf bank_mask:0xf
    v_mfma_f32_16x16x32_bf16 v[178:181], v[102:105], v[186:189], v[178:181]
    ds_read_b128 v[134:137], v2 offset:15360
    v_max_f32_dpp v122, v122, v122 quad_perm:[2,3,0,1] row_mask:0xf bank_mask:0xf
    v_mfma_f32_16x16x32_bf16 v[178:181], v[106:109], v[222:225], v[178:181]
    ds_read_b128 v[222:225], v2 offset:16384
    v_max_f32_dpp v122, v122, v122 row_half_mirror row_mask:0xf bank_mask:0xf
    v_mfma_f32_16x16x32_bf16 v[178:181], v[110:113], v[154:157], v[178:181]
    ds_read_b128 v[154:157], v2 offset:17408
    ds_write_b64 v4, v[126:127] offset:4096
    v_exp_f32 v128, v128
    v_exp_f32 v129, v129
    v_mfma_f32_16x16x32_f16 v[186:189], v[242:245], v[174:177], v[70:73]
    s_waitcnt lgkmcnt(6)
    v_cvt_pk_bf16_f32 v37, v128, v129
    v_max_f32_dpp v122, v122, v122 row_mirror row_mask:0xf bank_mask:0xf
    v_mfma_f32_16x16x32_f16 v[242:245], v[226:229], v[174:177], v[74:77]
    s_waitcnt lgkmcnt(5)
    v_exp_f32 v218, v218
    v_mfma_f32_16x16x32_f16 v[126:129], v[146:149], v[174:177], v[78:81]
    s_waitcnt lgkmcnt(4)
    v_cvt_pk_bf16_f32 v39, v218, 0
    v_mov_b32 v123, v122
    v_fma_f32 v255, v150, v150, s33
    v_mfma_f32_16x16x32_bf16 v[174:177], v[28:31], v[36:39], 0
    s_waitcnt lgkmcnt(3)
    v_permlane32_swap_b32 v122, v123
    v_mfma_f32_16x16x32_bf16 v[174:177], v[28:31], v[118:121], v[174:177]
    s_waitcnt lgkmcnt(2)
    v_max_f32 v122, v122, v123
    v_mov_b32 v123, v122
    v_mfma_f32_16x16x32_bf16 v[226:229], v[194:197], v[36:39], 0
    s_waitcnt lgkmcnt(0)
    v_permlane16_swap_b32 v122, v123
    v_mfma_f32_16x16x32_bf16 v[226:229], v[170:173], v[118:121], v[226:229]
    v_max_f32 v122, v122, v123
    v_sub_f32 v254, v254, v122
    v_mfma_f32_16x16x32_bf16 v[218:221], v[214:217], v[36:39], 0
    v_exp_f32 v254, v254
    v_mfma_f32_16x16x32_bf16 v[218:221], v[130:133], v[118:121], v[218:221]
    v_cvt_pk_bf16_f32 v254, v254, v254
    v_fmac_f32 v255, v151, v151
    v_mfma_f32_16x16x32_bf16 v[166:169], v[230:233], v[36:39], 0
    ds_write_b16 v8, v254
    v_mfma_f32_16x16x32_bf16 v[166:169], v[114:117], v[118:121], v[166:169]
    v_rcp_f32 v174, v174
    v_fmac_f32 v255, v152, v152
    v_mfma_f32_16x16x16_f16 v[186:189], v[184:185], v[162:163], v[186:189]
    v_mul_f32 v226, v174, v226
    v_mul_f32 v227, v174, v227
    v_cvt_pk_bf16_f32 v122, v226, v227
    v_mfma_f32_16x16x16_f16 v[242:245], v[124:125], v[162:163], v[242:245]
    v_mul_f32 v228, v174, v228
    v_mul_f32 v229, v174, v229
    v_cvt_pk_bf16_f32 v123, v228, v229
    v_mfma_f32_16x16x16_f16 v[126:129], v[164:165], v[162:163], v[126:129]
    v_max3_f32 v254, v238, v186, v187
    v_max3_f32 v254, v254, v188, v189
    v_mul_f32 v218, v174, v218
    v_mul_f32 v219, v174, v219
    v_mfma_f32_16x16x32_bf16 v[146:149], a[216:219], v[198:201], 0
    ds_read_b128 v[118:121], v9
    ds_read_b128 v[162:165], v9 offset:64
    v_mfma_f32_16x16x32_bf16 v[146:149], a[220:223], v[206:209], v[146:149]
    v_max3_f32 v254, v254, v242, v243
    v_max3_f32 v254, v254, v244, v245
    v_mfma_f32_16x16x32_bf16 v[146:149], a[224:227], v[210:213], v[146:149]
    v_max3_f32 v254, v254, v126, v127
    v_max3_f32 v254, v254, v128, v129
    v_mfma_f32_16x16x32_bf16 v[146:149], a[228:231], v[134:137], v[146:149]
    v_mov_b32 v125, v254
    v_cvt_pk_bf16_f32 v124, v218, v219
    v_mfma_f32_16x16x32_bf16 v[146:149], a[232:235], v[222:225], v[146:149]
    v_permlane32_swap_b32 v254, v125
    v_mfma_f32_16x16x32_bf16 v[146:149], a[236:239], v[154:157], v[146:149]
    v_max_f32 v254, v254, v125
    v_mov_b32 v125, v254
    v_mfma_f32_16x16x32_bf16 v[138:141], a[240:243], v[198:201], 0
    v_mul_f32 v220, v174, v220
    v_mul_f32 v221, v174, v221
    v_mfma_f32_16x16x32_bf16 v[138:141], a[244:247], v[206:209], v[138:141]
    v_permlane16_swap_b32 v254, v125
    v_mfma_f32_16x16x32_bf16 v[138:141], a[248:251], v[210:213], v[138:141]
    s_waitcnt lgkmcnt(0)
    v_max_f32 v254, v254, v125
    v_sub_f32 v186, v186, v254
    v_mfma_f32_16x16x32_bf16 v[138:141], a[252:255], v[134:137], v[138:141]
    v_exp_f32 v186, v186
    v_mfma_f32_16x16x32_bf16 v[138:141], v[82:85], v[222:225], v[138:141]
    v_sub_f32 v187, v187, v254
    v_sub_f32 v188, v188, v254
    v_mfma_f32_16x16x32_bf16 v[138:141], v[86:89], v[154:157], v[138:141]
    v_exp_f32 v187, v187
    v_exp_f32 v188, v188
    v_cvt_pk_bf16_f32 v234, v186, v187
    v_sub_f32 v189, v189, v254
    v_exp_f32 v189, v189
    v_sub_f32 v242, v242, v254
    v_cvt_pk_bf16_f32 v235, v188, v189
    v_exp_f32 v242, v242
    v_sub_f32 v243, v243, v254
    v_exp_f32 v243, v243
    v_sub_f32 v244, v244, v254
    v_cvt_pk_bf16_f32 v236, v242, v243
    v_mfma_f32_16x16x32_bf16 v[186:189], v[90:93], v[198:201], 0
    v_exp_f32 v244, v244
    v_mfma_f32_16x16x32_bf16 v[186:189], v[94:97], v[206:209], v[186:189]
    v_sub_f32 v245, v245, v254
    v_sub_f32 v126, v126, v254
    v_mfma_f32_16x16x32_bf16 v[186:189], v[98:101], v[210:213], v[186:189]
    v_exp_f32 v245, v245
    v_mfma_f32_16x16x32_bf16 v[186:189], v[102:105], v[134:137], v[186:189]
    v_cvt_pk_bf16_f32 v237, v244, v245
    v_sub_f32 v127, v127, v254
    v_mfma_f32_16x16x32_bf16 v[186:189], v[106:109], v[222:225], v[186:189]
    v_exp_f32 v126, v126
    v_mfma_f32_16x16x32_bf16 v[186:189], v[110:113], v[154:157], v[186:189]
    ds_read_b128 v[182:185], v0 offset:20480
    ds_read_b128 v[198:201], v1 offset:20480
    v_mfma_f32_16x16x32_bf16 v[206:209], v[118:121], v[28:31], 0
    ds_read_b128 v[210:213], v0 offset:20608
    ds_read_b128 v[222:225], v1 offset:20608
    v_mfma_f32_16x16x32_bf16 v[206:209], v[162:165], v[28:31], v[206:209]
    v_exp_f32 v127, v127
    v_mfma_f32_16x16x32_bf16 v[154:157], v[118:121], v[170:173], 0
    ds_read_b128 v[226:229], v0 offset:20736
    v_cvt_pk_bf16_f32 v36, v126, v127
    v_mfma_f32_16x16x32_bf16 v[154:157], v[162:165], v[194:197], v[154:157]
    ds_read_b128 v[242:245], v1 offset:20736
    v_sub_f32 v128, v128, v254
    v_exp_f32 v128, v128
    v_sub_f32 v129, v129, v254
    v_exp_f32 v129, v129
    v_sub_f32 v238, v238, v254
    v_cvt_pk_bf16_f32 v37, v128, v129
    v_mfma_f32_16x16x32_bf16 v[134:137], v[118:121], v[130:133], 0
    v_exp_f32 v238, v238
    v_mfma_f32_16x16x32_bf16 v[134:137], v[162:165], v[214:217], v[134:137]
    s_waitcnt lgkmcnt(4)
    v_cvt_pk_bf16_f32 v39, v238, 0
    v_cvt_pk_bf16_f32 v125, v220, v221
    v_mfma_f32_16x16x32_bf16 v[218:221], v[118:121], v[114:117], 0
    s_waitcnt lgkmcnt(2)
    ds_write_b128 v3, v[122:125] offset:6144
    v_mfma_f32_16x16x32_bf16 v[126:129], v[28:31], v[36:39], 0
    s_waitcnt lgkmcnt(2)
    v_mul_f32 v166, v174, v166
    v_mul_f32 v167, v174, v167
    v_mfma_f32_16x16x32_bf16 v[126:129], v[28:31], v[234:237], v[126:129]
    s_waitcnt lgkmcnt(1)
    v_cvt_pk_bf16_f32 v166, v166, v167
    v_mul_f32 v168, v174, v168
    v_mfma_f32_16x16x32_bf16 v[122:125], v[194:197], v[36:39], 0
    v_mul_f32 v169, v174, v169
    v_cvt_pk_bf16_f32 v167, v168, v169
    v_mfma_f32_16x16x32_bf16 v[122:125], v[170:173], v[234:237], v[122:125]
    ds_write_b64 v4, v[166:167] offset:10240
    v_mfma_f32_16x16x32_bf16 v[170:173], v[214:217], v[36:39], 0
    v_rcp_f32 v126, v126
    v_mfma_f32_16x16x32_bf16 v[170:173], v[130:133], v[234:237], v[170:173]
    v_fma_f32 v254, v146, v146, s33
    v_fmac_f32 v254, v147, v147
    v_mfma_f32_16x16x32_bf16 v[174:177], v[230:233], v[36:39], 0
    v_fmac_f32 v254, v148, v148
    v_mul_f32 v122, v126, v122
    v_mfma_f32_16x16x32_bf16 v[174:177], v[114:117], v[234:237], v[174:177]
    v_mul_f32 v123, v126, v123
    v_cvt_pk_bf16_f32 v122, v122, v123
    v_mfma_f32_16x16x32_bf16 v[218:221], v[162:165], v[230:233], v[218:221]
    v_mul_f32 v124, v126, v124
    v_mul_f32 v125, v126, v125
    v_mfma_f32_16x16x32_bf16 v[114:117], a[72:75], v[182:185], 0
    v_cvt_pk_bf16_f32 v123, v124, v125
    v_mul_f32 v170, v126, v170
    v_mfma_f32_16x16x32_bf16 v[114:117], a[76:79], v[198:201], v[114:117]
    v_mul_f32 v171, v126, v171
    v_cvt_pk_bf16_f32 v124, v170, v171
    v_mfma_f32_16x16x32_bf16 v[114:117], a[80:83], v[210:213], v[114:117]
    v_mul_f32 v172, v126, v172
    v_mul_f32 v173, v126, v173
    v_mfma_f32_16x16x32_bf16 v[114:117], a[84:87], v[222:225], v[114:117]
    v_cvt_pk_bf16_f32 v125, v172, v173
    v_mul_f32 v174, v126, v174
    v_mfma_f32_16x16x32_bf16 v[114:117], a[88:91], v[226:229], v[114:117]
    ds_write_b128 v3, v[122:125] offset:12288
    v_mfma_f32_16x16x32_bf16 v[114:117], a[92:95], v[242:245], v[114:117]
    v_mul_f32 v175, v126, v175
    v_cvt_pk_bf16_f32 v174, v174, v175
    v_mfma_f32_16x16x32_bf16 v[122:125], a[96:99], v[182:185], 0
    v_mul_f32 v176, v126, v176
    v_mul_f32 v177, v126, v177
    v_mfma_f32_16x16x32_bf16 v[122:125], a[100:103], v[198:201], v[122:125]
    v_cvt_pk_bf16_f32 v175, v176, v177
    v_fmac_f32 v254, v149, v149
    v_mfma_f32_16x16x32_bf16 v[122:125], a[104:107], v[210:213], v[122:125]
    ds_write_b64 v4, v[174:175] offset:16384
    v_mfma_f32_16x16x32_bf16 v[122:125], a[108:111], v[222:225], v[122:125]
    v_fmac_f32 v254, v138, v138
    v_fmac_f32 v254, v139, v139
    v_mfma_f32_16x16x32_bf16 v[122:125], a[112:115], v[226:229], v[122:125]
    v_fmac_f32 v254, v140, v140
    v_fmac_f32 v254, v141, v141
    v_mfma_f32_16x16x32_bf16 v[122:125], a[116:119], v[242:245], v[122:125]
    v_fmac_f32 v254, v186, v186
    v_fmac_f32 v254, v187, v187
    v_mfma_f32_16x16x32_bf16 v[126:129], a[120:123], v[182:185], 0
    v_fmac_f32 v254, v188, v188
    v_fmac_f32 v254, v189, v189
    v_mfma_f32_16x16x32_bf16 v[126:129], a[124:127], v[198:201], v[126:129]
    v_cvt_pk_bf16_f32 v155, v254, v254
    v_fmac_f32 v255, v153, v153
    v_mfma_f32_16x16x32_bf16 v[126:129], a[128:131], v[210:213], v[126:129]
    v_rcp_f32 v206, v206
    v_mfma_f32_16x16x32_bf16 v[126:129], a[132:135], v[222:225], v[126:129]
    v_mul_f32 v154, v154, v206
    v_mul_f32_dpp v154, v134, v206 quad_perm:[0,1,2,3] row_mask:0x2 bank_mask:0xf
    v_mfma_f32_16x16x32_bf16 v[126:129], a[136:139], v[226:229], v[126:129]
    v_mul_f32_dpp v154, v218, v206 quad_perm:[0,1,2,3] row_mask:0x4 bank_mask:0xf
    v_cvt_pk_bf16_f32 v154, v154, v154
    v_mfma_f32_16x16x32_bf16 v[126:129], a[140:143], v[242:245], v[126:129]
    ds_write_b16 v7, v154
    v_mfma_f32_16x16x32_bf16 v[206:209], a[0:3], v[182:185], 0
    v_fmac_f32 v255, v190, v190
    v_fmac_f32 v255, v191, v191
    v_mfma_f32_16x16x32_bf16 v[206:209], a[4:7], v[198:201], v[206:209]
    v_fmac_f32 v255, v192, v192
    v_fmac_f32 v255, v193, v193
    v_mfma_f32_16x16x32_bf16 v[206:209], a[8:11], v[210:213], v[206:209]
    v_fmac_f32 v255, v202, v202
    v_fmac_f32 v255, v203, v203
    v_mfma_f32_16x16x32_bf16 v[206:209], a[12:15], v[222:225], v[206:209]
    v_fmac_f32 v255, v204, v204
    v_fmac_f32 v255, v205, v205
    v_mfma_f32_16x16x32_bf16 v[206:209], a[16:19], v[226:229], v[206:209]
    v_fma_f32 v254, v142, v142, s33
    v_fmac_f32 v254, v143, v143
    v_mfma_f32_16x16x32_bf16 v[206:209], a[20:23], v[242:245], v[206:209]
    v_fmac_f32 v254, v144, v144
    v_fmac_f32 v254, v145, v145
    v_mfma_f32_16x16x32_bf16 v[174:177], a[24:27], v[182:185], 0
    v_fmac_f32 v254, v158, v158
    v_fmac_f32 v254, v159, v159
    v_mfma_f32_16x16x32_bf16 v[174:177], a[28:31], v[198:201], v[174:177]
    v_fmac_f32 v254, v160, v160
    v_fmac_f32 v254, v161, v161
    v_mfma_f32_16x16x32_bf16 v[174:177], a[32:35], v[210:213], v[174:177]
    v_fmac_f32 v254, v178, v178
    v_fmac_f32 v254, v179, v179
    v_mfma_f32_16x16x32_bf16 v[174:177], a[36:39], v[222:225], v[174:177]
    v_fmac_f32 v254, v180, v180
    v_fmac_f32 v254, v181, v181
    v_mfma_f32_16x16x32_bf16 v[174:177], a[40:43], v[226:229], v[174:177]
    v_cvt_pk_bf16_f32 v154, v255, v254
    v_add_u32 v5, 336, v5
    v_mfma_f32_16x16x32_bf16 v[174:177], a[44:47], v[242:245], v[174:177]
    ds_write_b64 v4, v[154:155] offset:18432
    v_mfma_f32_16x16x32_bf16 v[218:221], a[48:51], v[182:185], 0
    v_add_u32 v6, 272, v6
    v_add_u32 v7, 16, v7
    v_mfma_f32_16x16x32_bf16 v[218:221], a[52:55], v[198:201], v[218:221]
    v_fma_f32 v130, v114, v114, s32
    v_fmac_f32 v130, v115, v115
    v_mfma_f32_16x16x32_bf16 v[218:221], a[56:59], v[210:213], v[218:221]
    v_fmac_f32 v130, v116, v116
    v_fmac_f32 v130, v117, v117
    v_mfma_f32_16x16x32_bf16 v[218:221], a[60:63], v[222:225], v[218:221]
    v_fmac_f32 v130, v122, v122
    v_fmac_f32 v130, v123, v123
    v_mfma_f32_16x16x32_bf16 v[218:221], a[64:67], v[226:229], v[218:221]
    v_fmac_f32 v130, v124, v124
    v_fmac_f32 v130, v125, v125
    v_mfma_f32_16x16x32_bf16 v[218:221], a[68:71], v[242:245], v[218:221]
    v_fmac_f32 v130, v126, v126
    v_fmac_f32 v130, v127, v127
    v_mfma_f32_16x16x32_bf16 v[170:173], v[182:185], a[144:147], 0
    s_waitcnt lgkmcnt(0)
    v_fmac_f32 v130, v128, v128
    v_fmac_f32 v130, v129, v129
    v_mfma_f32_16x16x32_bf16 v[170:173], v[198:201], a[148:151], v[170:173]
    s_nop 0
    v_fma_f32 v131, v206, v206, s32
    v_fmac_f32 v131, v207, v207
    v_mfma_f32_16x16x32_bf16 v[170:173], v[210:213], a[152:155], v[170:173]
    s_nop 0
    v_fmac_f32 v131, v208, v208
    v_fmac_f32 v131, v209, v209
    v_mfma_f32_16x16x32_bf16 v[170:173], v[222:225], a[156:159], v[170:173]
    s_barrier
    v_fmac_f32 v131, v174, v174
    v_xor_b32 v2, 65536, v2
    v_mfma_f32_16x16x32_bf16 v[170:173], v[226:229], a[160:163], v[170:173]
    s_nop 0
    v_xor_b32 v3, 65536, v3
    v_xor_b32 v4, 65536, v4
    v_mfma_f32_16x16x32_bf16 v[170:173], v[242:245], a[164:167], v[170:173]
    s_cbranch_scc1 L_loop_safe2
    s_branch L_final_safe
.p2align 6
L_loop_safe3:
    v_mfma_f32_16x16x32_bf16 v[162:165], v[182:185], a[168:171], 0
    s_add_u32 s12, s42, s27
    ds_read_b128 v[194:197], v2 offset:18432
    ds_read_b128 v[230:233], v2 offset:19456
    v_mfma_f32_16x16x32_bf16 v[162:165], v[198:201], a[172:175], v[162:165]
    s_addc_u32 s13, s43, 0
    v_fmac_f32 v131, v175, v175
    v_fmac_f32 v131, v176, v176
    v_mfma_f32_16x16x32_bf16 v[162:165], v[210:213], a[176:179], v[162:165]
    s_sub_u32 s14, s36, s27
    v_fmac_f32 v131, v177, v177
    v_fmac_f32 v131, v218, v218
    v_mfma_f32_16x16x32_bf16 v[162:165], v[222:225], a[180:183], v[162:165]
    s_cmp_ge_u32 s18, 2
    v_fmac_f32 v131, v219, v219
    v_fmac_f32 v131, v220, v220
    v_mfma_f32_16x16x32_bf16 v[162:165], v[226:229], a[184:187], v[162:165]
    s_cselect_b32 s14, s14, 0
    ds_read_b128 v[118:121], v0 offset:26624
    v_fmac_f32 v131, v221, v221
    v_mfma_f32_16x16x32_bf16 v[162:165], v[242:245], a[188:191], v[162:165]
    s_add_u32 s34, s18, 2
    ds_read_b128 v[134:137], v1 offset:26624
    v_cvt_pk_bf16_f32 v36, v131, v130
    v_mfma_f32_16x16x32_bf16 v[214:217], v[182:185], a[192:195], 0
    s_add_u32 s8, s40, s23
    ds_read_b128 v[154:157], v0 offset:26752
    v_cvt_pk_bf16_f32 v170, v170, v171
    v_mfma_f32_16x16x32_bf16 v[214:217], v[198:201], a[196:199], v[214:217]
    s_addc_u32 s9, s41, 0
    ds_read_b128 v[198:201], v1 offset:26752
    v_cvt_pk_bf16_f32 v171, v172, v173
    v_mfma_f32_16x16x32_bf16 v[166:169], v[32:35], v[36:39], 0
    s_sub_u32 s10, s36, s23
    v_cvt_pk_bf16_f32 v130, v162, v163
    v_cvt_pk_bf16_f32 v131, v164, v165
    v_mfma_f32_16x16x32_bf16 v[214:217], v[210:213], a[200:203], v[214:217]
    s_waitcnt lgkmcnt(4)
    ds_read_b128 v[210:213], v0 offset:26880
    s_cmp_lt_u32 s34, s17
    v_mfma_f32_16x16x32_bf16 v[234:237], v[32:35], v[194:197], 0
    s_cselect_b32 s10, s10, 0
    v_rsq_f32 v167, v167
    v_mfma_f32_16x16x32_bf16 v[234:237], v[32:35], v[230:233], v[234:237]
    s_add_u32 m0, s28, 0
    v_rsq_f32 v166, v166
    v_mfma_f32_16x16x32_bf16 v[214:217], v[222:225], a[204:207], v[214:217]
    s_waitcnt lgkmcnt(4)
    ds_read_b128 v[162:165], v1 offset:26880
    v_mul_f32 v166, s31, v166
    v_mfma_f32_16x16x32_bf16 v[214:217], v[226:229], a[208:211], v[214:217]
    s_mov_b32 s27, s26
    v_mul_f32 v114, v167, v114
    v_mul_f32 v115, v167, v115
    v_mfma_f32_16x16x32_bf16 v[214:217], v[242:245], a[212:215], v[214:217]
    s_mov_b32 s26, s25
    v_cvt_pk_f16_f32 v242, v114, v115
    v_mul_f32 v116, v167, v116
    v_mfma_f32_16x16x32_bf16 v[226:229], a[72:75], v[118:121], 0
    s_waitcnt lgkmcnt(2)
    v_mul_f32 v117, v167, v117
    v_cvt_pk_f16_f32 v243, v116, v117
    v_mfma_f32_16x16x32_bf16 v[226:229], a[76:79], v[134:137], v[226:229]
    s_mov_b32 s25, s24
    v_cvt_pk_bf16_f32 v114, v214, v215
    v_cvt_pk_bf16_f32 v115, v216, v217
    v_mfma_f32_16x16x32_bf16 v[226:229], a[80:83], v[154:157], v[226:229]
    s_mov_b32 s24, s23
    v_mul_f32 v122, v167, v122
    v_mul_f32 v123, v167, v123
    v_mfma_f32_16x16x32_bf16 v[226:229], a[84:87], v[198:201], v[226:229]
    s_waitcnt lgkmcnt(1)
    v_cvt_pk_f16_f32 v244, v122, v123
    v_mul_f32 v124, v167, v124
    v_mfma_f32_16x16x32_bf16 v[226:229], a[88:91], v[210:213], v[226:229]
    v_mul_f32 v125, v167, v125
    v_cvt_pk_f16_f32 v245, v124, v125
    v_mfma_f32_16x16x32_bf16 v[122:125], a[96:99], v[118:121], 0
    s_waitcnt lgkmcnt(0)
    v_mul_f32 v126, v167, v126
    v_mul_f32 v127, v167, v127
    v_mfma_f32_16x16x32_bf16 v[226:229], a[92:95], v[162:165], v[226:229]
    v_cvt_pk_f16_f32 v184, v126, v127
    v_mul_f32 v128, v167, v128
    v_mfma_f32_16x16x32_bf16 v[122:125], a[100:103], v[134:137], v[122:125]
    v_mul_f32 v129, v167, v129
    v_cvt_pk_f16_f32 v185, v128, v129
    v_mfma_f32_16x16x32_bf16 v[122:125], a[104:107], v[154:157], v[122:125]
    v_mul_f32 v206, v166, v206
    v_mul_f32 v207, v166, v207
    v_mfma_f32_16x16x32_bf16 v[122:125], a[108:111], v[198:201], v[122:125]
    v_cvt_pk_f16_f32 v222, v206, v207
    v_mul_f32 v208, v166, v208
    v_mfma_f32_16x16x32_bf16 v[122:125], a[112:115], v[210:213], v[122:125]
    v_mul_f32 v209, v166, v209
    v_cvt_pk_f16_f32 v223, v208, v209
    v_mfma_f32_16x16x32_bf16 v[122:125], a[116:119], v[162:165], v[122:125]
    v_mul_f32 v174, v166, v174
    v_mul_f32 v175, v166, v175
    v_mfma_f32_16x16x32_bf16 v[126:129], a[120:123], v[118:121], 0
    v_cvt_pk_f16_f32 v224, v174, v175
    v_mul_f32 v176, v166, v176
    v_mfma_f32_16x16x32_bf16 v[126:129], a[124:127], v[134:137], v[126:129]
    v_mul_f32 v177, v166, v177
    v_cvt_pk_f16_f32 v225, v176, v177
    v_mfma_f32_16x16x32_bf16 v[126:129], a[128:131], v[154:157], v[126:129]
    v_mul_f32 v218, v166, v218
    v_mul_f32 v219, v166, v219
    v_mfma_f32_16x16x32_bf16 v[126:129], a[132:135], v[198:201], v[126:129]
    v_cvt_pk_f16_f32 v182, v218, v219
    v_mul_f32 v220, v166, v220
    v_mfma_f32_16x16x32_bf16 v[126:129], a[136:139], v[210:213], v[126:129]
    v_mul_f32 v221, v166, v221
    v_cvt_pk_f16_f32 v183, v220, v221
    v_mfma_f32_16x16x32_bf16 v[126:129], a[140:143], v[162:165], v[126:129]
    v_fma_f32 v116, v226, v226, s32
    v_fmac_f32 v116, v227, v227
    v_mfma_f32_16x16x32_bf16 v[206:209], a[0:3], v[118:121], 0
    v_fmac_f32 v116, v228, v228
    v_fmac_f32 v116, v229, v229
    v_mfma_f32_16x16x32_bf16 v[206:209], a[4:7], v[134:137], v[206:209]
    v_fmac_f32 v116, v122, v122
    v_fmac_f32 v116, v123, v123
    v_mfma_f32_16x16x32_bf16 v[206:209], a[8:11], v[154:157], v[206:209]
    v_fmac_f32 v116, v124, v124
    v_fmac_f32 v116, v125, v125
    v_mfma_f32_16x16x32_bf16 v[206:209], a[12:15], v[198:201], v[206:209]
    v_fmac_f32 v116, v126, v126
    v_fmac_f32 v116, v127, v127
    v_mfma_f32_16x16x32_bf16 v[206:209], a[16:19], v[210:213], v[206:209]
    v_fmac_f32 v116, v128, v128
    v_fmac_f32 v116, v129, v129
    v_mfma_f32_16x16x32_bf16 v[206:209], a[20:23], v[162:165], v[206:209]
    v_mul_f32 v117, 0x3baaaaab, v234
    v_mul_f32 v254, 0x3baaaaab, v235
    v_mfma_f32_16x16x32_bf16 v[174:177], a[24:27], v[118:121], 0
    v_rsq_f32 v117, v117
    v_mfma_f32_16x16x32_bf16 v[174:177], a[28:31], v[134:137], v[174:177]
    v_rsq_f32 v254, v254
    v_mfma_f32_16x16x32_bf16 v[174:177], a[32:35], v[154:157], v[174:177]
    v_mul_f32 v255, 0x3baaaaab, v236
    v_fma_f32 v132, v206, v206, s32
    v_mfma_f32_16x16x32_bf16 v[174:177], a[36:39], v[198:201], v[174:177]
    v_fmac_f32 v132, v207, v207
    v_fmac_f32 v132, v208, v208
    v_mfma_f32_16x16x32_bf16 v[174:177], a[40:43], v[210:213], v[174:177]
    v_fmac_f32 v132, v209, v209
    v_mul_f32 v150, v117, v150
    v_mfma_f32_16x16x32_bf16 v[174:177], a[44:47], v[162:165], v[174:177]
    v_rsq_f32 v255, v255
    v_mfma_f32_16x16x32_bf16 v[218:221], a[48:51], v[118:121], 0
    v_mul_f32 v151, v117, v151
    v_cvt_pk_bf16_f32 v194, v150, v151
    v_mfma_f32_16x16x32_bf16 v[218:221], a[52:55], v[134:137], v[218:221]
    v_mul_f32 v152, v117, v152
    v_mul_f32 v153, v117, v153
    v_mfma_f32_16x16x32_bf16 v[218:221], a[56:59], v[154:157], v[218:221]
    v_fmac_f32 v132, v174, v174
    v_fmac_f32 v132, v175, v175
    v_mfma_f32_16x16x32_bf16 v[218:221], a[60:63], v[198:201], v[218:221]
    v_fmac_f32 v132, v176, v176
    v_fmac_f32 v132, v177, v177
    v_mfma_f32_16x16x32_bf16 v[218:221], a[64:67], v[210:213], v[218:221]
    v_cvt_pk_bf16_f32 v195, v152, v153
    v_mul_f32 v190, v117, v190
    v_mfma_f32_16x16x32_bf16 v[218:221], a[68:71], v[162:165], v[218:221]
    v_mul_f32 v191, v117, v191
    v_cvt_pk_bf16_f32 v196, v190, v191
    v_mfma_f32_16x16x32_bf16 v[150:153], v[118:121], a[144:147], 0
    v_mul_f32 v192, v117, v192
    v_mul_f32 v193, v117, v193
    v_mfma_f32_16x16x32_bf16 v[150:153], v[134:137], a[148:151], v[150:153]
    v_cvt_pk_bf16_f32 v197, v192, v193
    v_mul_f32 v202, v117, v202
    v_mfma_f32_16x16x32_bf16 v[150:153], v[154:157], a[152:155], v[150:153]
    buffer_store_dwordx4 v[194:197], v15, s[12:15], 0 offen nt
    v_fmac_f32 v132, v218, v218
    v_fmac_f32 v132, v219, v219
    v_fmac_f32 v132, v220, v220
    v_fmac_f32 v132, v221, v221
    v_mfma_f32_16x16x32_bf16 v[150:153], v[198:201], a[156:159], v[150:153]
    v_cvt_pk_bf16_f32 v36, v132, v116
    v_mul_f32 v203, v117, v203
    v_mfma_f32_16x16x32_bf16 v[150:153], v[210:213], a[160:163], v[150:153]
    v_cvt_pk_bf16_f32 v116, v202, v203
    v_mul_f32 v204, v117, v204
    v_mfma_f32_16x16x32_bf16 v[190:193], v[32:35], v[36:39], 0
    v_mul_f32 v205, v117, v205
    v_cvt_pk_bf16_f32 v117, v204, v205
    v_mfma_f32_16x16x32_bf16 v[150:153], v[162:165], a[164:167], v[150:153]
    v_mul_f32 v146, v255, v146
    v_mul_f32 v147, v255, v147
    v_mfma_f32_16x16x32_bf16 v[202:205], v[118:121], a[168:171], 0
    v_cvt_pk_bf16_f32 v146, v146, v147
    v_mul_f32 v148, v255, v148
    v_mfma_f32_16x16x32_bf16 v[202:205], v[134:137], a[172:175], v[202:205]
    v_rsq_f32 v191, v191
    v_mfma_f32_16x16x32_bf16 v[202:205], v[154:157], a[176:179], v[202:205]
    v_cvt_pk_bf16_f32 v172, v150, v151
    v_cvt_pk_bf16_f32 v173, v152, v153
    v_mfma_f32_16x16x32_bf16 v[202:205], v[198:201], a[180:183], v[202:205]
    v_rsq_f32 v190, v190
    v_mfma_f32_16x16x32_bf16 v[202:205], v[210:213], a[184:187], v[202:205]
    ds_read_b128 v[150:153], v0 offset:32768
    v_mul_f32 v190, s31, v190
    v_mfma_f32_16x16x32_bf16 v[202:205], v[162:165], a[188:191], v[202:205]
    ds_read_b128 v[166:169], v1 offset:32768
    v_mul_f32 v226, v191, v226
    v_mfma_f32_16x16x32_bf16 v[194:197], v[118:121], a[192:195], 0
    ds_read_b128 v[118:121], v0 offset:32896
    v_mul_f32 v227, v191, v227
    v_mfma_f32_16x16x32_bf16 v[194:197], v[134:137], a[196:199], v[194:197]
    ds_read_b128 v[134:137], v1 offset:32896
    v_cvt_pk_f16_f32 v226, v226, v227
    v_mfma_f32_16x16x32_bf16 v[194:197], v[154:157], a[200:203], v[194:197]
    ds_read_b128 v[154:157], v0 offset:33024
    v_cvt_pk_bf16_f32 v132, v202, v203
    v_mfma_f32_16x16x32_bf16 v[194:197], v[198:201], a[204:207], v[194:197]
    ds_read_b128 v[198:201], v1 offset:33024
    v_cvt_pk_bf16_f32 v133, v204, v205
    v_mfma_f32_16x16x32_bf16 v[194:197], v[210:213], a[208:211], v[194:197]
    v_mul_f32 v228, v191, v228
    v_mul_f32 v229, v191, v229
    v_mfma_f32_16x16x32_bf16 v[194:197], v[162:165], a[212:215], v[194:197]
    v_cvt_pk_f16_f32 v227, v228, v229
    v_mul_f32 v122, v191, v122
    v_mfma_f32_16x16x32_f16 v[210:213], v[242:245], v[222:225], v[46:49]
    s_waitcnt lgkmcnt(5)
    buffer_store_dwordx2 v[116:117], v18, s[12:15], 0 offen nt
    v_mul_f32 v123, v191, v123
    v_cvt_pk_f16_f32 v228, v122, v123
    v_mfma_f32_16x16x32_bf16 v[202:205], a[72:75], v[150:153], 0
    s_waitcnt lgkmcnt(3)
    v_cvt_pk_bf16_f32 v116, v194, v195
    v_cvt_pk_bf16_f32 v117, v196, v197
    v_mfma_f32_16x16x32_bf16 v[202:205], a[76:79], v[166:169], v[202:205]
    s_waitcnt lgkmcnt(2)
    v_mul_f32 v124, v191, v124
    v_mul_f32 v125, v191, v125
    v_mfma_f32_16x16x32_bf16 v[202:205], a[80:83], v[118:121], v[202:205]
    s_waitcnt lgkmcnt(1)
    v_cvt_pk_f16_f32 v229, v124, v125
    v_mul_f32 v126, v191, v126
    v_mfma_f32_16x16x32_bf16 v[202:205], a[84:87], v[134:137], v[202:205]
    s_waitcnt lgkmcnt(0)
    v_mul_f32 v127, v191, v127
    v_cvt_pk_f16_f32 v124, v126, v127
    v_mfma_f32_16x16x32_bf16 v[202:205], a[88:91], v[154:157], v[202:205]
    v_mul_f32 v128, v191, v128
    v_mul_f32 v129, v191, v129
    v_mfma_f32_16x16x32_bf16 v[202:205], a[92:95], v[198:201], v[202:205]
    v_cvt_pk_f16_f32 v125, v128, v129
    v_mul_f32 v206, v190, v206
    v_mfma_f32_16x16x32_bf16 v[126:129], a[96:99], v[150:153], 0
    v_mul_f32 v207, v190, v207
    v_cvt_pk_f16_f32 v206, v206, v207
    v_mfma_f32_16x16x32_bf16 v[126:129], a[100:103], v[166:169], v[126:129]
    v_mul_f32 v208, v190, v208
    v_mul_f32 v209, v190, v209
    v_mfma_f32_16x16x32_bf16 v[126:129], a[104:107], v[118:121], v[126:129]
    v_cvt_pk_f16_f32 v207, v208, v209
    v_mul_f32 v174, v190, v174
    v_mfma_f32_16x16x32_bf16 v[126:129], a[108:111], v[134:137], v[126:129]
    v_mul_f32 v175, v190, v175
    v_cvt_pk_f16_f32 v208, v174, v175
    v_mfma_f32_16x16x32_bf16 v[126:129], a[112:115], v[154:157], v[126:129]
    v_mul_f32 v176, v190, v176
    v_mul_f32 v177, v190, v177
    v_mfma_f32_16x16x32_bf16 v[126:129], a[116:119], v[198:201], v[126:129]
    v_cvt_pk_f16_f32 v209, v176, v177
    v_mul_f32 v218, v190, v218
    v_mfma_f32_16x16x32_bf16 v[174:177], a[120:123], v[150:153], 0
    v_mul_f32 v219, v190, v219
    v_cvt_pk_f16_f32 v122, v218, v219
    v_mfma_f32_16x16x32_bf16 v[174:177], a[124:127], v[166:169], v[174:177]
    v_mul_f32 v220, v190, v220
    v_mul_f32 v221, v190, v221
    v_mfma_f32_16x16x32_bf16 v[174:177], a[128:131], v[118:121], v[174:177]
    v_cvt_pk_f16_f32 v123, v220, v221
    v_fma_f32 v162, v202, v202, s32
    v_mfma_f32_16x16x32_bf16 v[174:177], a[132:135], v[134:137], v[174:177]
    v_fmac_f32 v162, v203, v203
    v_fmac_f32 v162, v204, v204
    v_mfma_f32_16x16x32_bf16 v[174:177], a[136:139], v[154:157], v[174:177]
    v_fmac_f32 v162, v205, v205
    v_fmac_f32 v162, v126, v126
    v_mfma_f32_16x16x32_bf16 v[174:177], a[140:143], v[198:201], v[174:177]
    v_fmac_f32 v162, v127, v127
    v_fmac_f32 v162, v128, v128
    v_mfma_f32_16x16x32_bf16 v[190:193], a[0:3], v[150:153], 0
    v_fmac_f32 v162, v129, v129
    v_mul_f32 v149, v255, v149
    v_mfma_f32_16x16x32_bf16 v[190:193], a[4:7], v[166:169], v[190:193]
    v_cvt_pk_bf16_f32 v147, v148, v149
    v_mul_f32 v138, v255, v138
    v_mfma_f32_16x16x32_bf16 v[190:193], a[8:11], v[118:121], v[190:193]
    v_fmac_f32 v162, v174, v174
    v_fmac_f32 v162, v175, v175
    v_mfma_f32_16x16x32_bf16 v[190:193], a[12:15], v[134:137], v[190:193]
    v_fmac_f32 v162, v176, v176
    v_fmac_f32 v162, v177, v177
    v_mfma_f32_16x16x32_bf16 v[190:193], a[16:19], v[154:157], v[190:193]
    v_mul_f32 v139, v255, v139
    v_cvt_pk_bf16_f32 v148, v138, v139
    v_mfma_f32_16x16x32_bf16 v[190:193], a[20:23], v[198:201], v[190:193]
    v_mul_f32 v140, v255, v140
    v_mul_f32 v141, v255, v141
    v_mfma_f32_16x16x32_bf16 v[218:221], a[24:27], v[150:153], 0
    v_cvt_pk_bf16_f32 v149, v140, v141
    v_mul_f32 v186, v255, v186
    v_mfma_f32_16x16x32_bf16 v[218:221], a[28:31], v[166:169], v[218:221]
    buffer_store_dwordx4 v[146:149], v17, s[12:15], 0 offen nt
    v_mul_f32 v187, v255, v187
    v_fma_f32 v163, v190, v190, s32
    v_fmac_f32 v163, v191, v191
    v_fmac_f32 v163, v192, v192
    v_mfma_f32_16x16x32_bf16 v[218:221], a[32:35], v[118:121], v[218:221]
    v_fmac_f32 v163, v193, v193
    v_cvt_pk_bf16_f32 v164, v186, v187
    v_mfma_f32_16x16x32_bf16 v[218:221], a[36:39], v[134:137], v[218:221]
    v_mul_f32 v188, v255, v188
    v_mul_f32 v189, v255, v189
    v_mfma_f32_16x16x32_bf16 v[218:221], a[40:43], v[154:157], v[218:221]
    v_cvt_pk_bf16_f32 v165, v188, v189
    v_mul_f32 v142, v254, v142
    v_mfma_f32_16x16x32_bf16 v[218:221], a[44:47], v[198:201], v[218:221]
    v_mul_f32 v143, v254, v143
    v_cvt_pk_bf16_f32 v142, v142, v143
    v_mfma_f32_16x16x32_bf16 v[138:141], a[48:51], v[150:153], 0
    v_mul_f32 v144, v254, v144
    v_mul_f32 v145, v254, v145
    v_mfma_f32_16x16x32_bf16 v[138:141], a[52:55], v[166:169], v[138:141]
    v_cvt_pk_bf16_f32 v143, v144, v145
    v_mul_f32 v158, v254, v158
    v_mfma_f32_16x16x32_bf16 v[138:141], a[56:59], v[118:121], v[138:141]
    v_fmac_f32 v163, v218, v218
    v_fmac_f32 v163, v219, v219
    v_mfma_f32_16x16x32_bf16 v[138:141], a[60:63], v[134:137], v[138:141]
    ds_read2_b32 v[196:197], v6 offset0:0 offset1:0
    ds_read2_b32 v[216:217], v6 offset0:16 offset1:16
    v_mfma_f32_16x16x32_bf16 v[138:141], a[64:67], v[154:157], v[138:141]
    ds_read2_b32 v[232:233], v6 offset0:32 offset1:32
    v_fmac_f32 v163, v220, v220
    v_mfma_f32_16x16x32_bf16 v[138:141], a[68:71], v[198:201], v[138:141]
    v_fmac_f32 v163, v221, v221
    v_mul_f32 v159, v254, v159
    v_mfma_f32_16x16x32_bf16 v[146:149], v[150:153], a[144:147], 0
    v_cvt_pk_bf16_f32 v144, v158, v159
    v_mul_f32 v160, v254, v160
    v_mfma_f32_16x16x32_bf16 v[146:149], v[166:169], a[148:151], v[146:149]
    v_mul_f32 v161, v254, v161
    v_cvt_pk_bf16_f32 v145, v160, v161
    v_mfma_f32_16x16x32_bf16 v[146:149], v[118:121], a[152:155], v[146:149]
    v_fmac_f32 v163, v138, v138
    v_fmac_f32 v163, v139, v139
    v_mfma_f32_16x16x32_bf16 v[146:149], v[134:137], a[156:159], v[146:149]
    v_fmac_f32 v163, v140, v140
    v_fmac_f32 v163, v141, v141
    v_mfma_f32_16x16x32_bf16 v[146:149], v[154:157], a[160:163], v[146:149]
    v_cvt_pk_bf16_f32 v36, v163, v162
    v_mul_f32 v178, v254, v178
    v_mfma_f32_16x16x32_bf16 v[146:149], v[198:201], a[164:167], v[146:149]
    s_waitcnt lgkmcnt(1)
    v_mul_f32 v179, v254, v179
    v_cvt_pk_bf16_f32 v178, v178, v179
    v_mfma_f32_16x16x32_bf16 v[158:161], v[32:35], v[36:39], 0
    s_waitcnt lgkmcnt(0)
    buffer_store_dwordx2 v[164:165], v20, s[12:15], 0 offen nt
    v_mul_f32 v180, v254, v180
    v_mul_f32 v181, v254, v181
    v_mfma_f32_16x16x32_bf16 v[186:189], v[150:153], a[168:171], 0
    v_cvt_pk_bf16_f32 v194, v146, v147
    v_cvt_pk_bf16_f32 v195, v148, v149
    v_mfma_f32_16x16x32_bf16 v[186:189], v[166:169], a[172:175], v[186:189]
    v_rsq_f32 v159, v159
    v_mfma_f32_16x16x32_bf16 v[186:189], v[118:121], a[176:179], v[186:189]
    v_rsq_f32 v158, v158
    v_mfma_f32_16x16x32_bf16 v[186:189], v[134:137], a[180:183], v[186:189]
    v_mul_f32 v158, s31, v158
    v_mul_f32 v202, v159, v202
    v_mfma_f32_16x16x32_bf16 v[186:189], v[154:157], a[184:187], v[186:189]
    v_mul_f32 v203, v159, v203
    v_cvt_pk_f16_f32 v146, v202, v203
    v_mfma_f32_16x16x32_bf16 v[186:189], v[198:201], a[188:191], v[186:189]
    v_mul_f32 v204, v159, v204
    v_mul_f32 v205, v159, v205
    v_mfma_f32_16x16x32_bf16 v[162:165], v[150:153], a[192:195], 0
    v_cvt_pk_f16_f32 v147, v204, v205
    v_mul_f32 v126, v159, v126
    v_mfma_f32_16x16x32_bf16 v[162:165], v[166:169], a[196:199], v[162:165]
    ds_read_b128 v[150:153], v5 offset:0
    ds_read_b128 v[202:205], v5 offset:16
    v_mfma_f32_16x16x32_bf16 v[162:165], v[118:121], a[200:203], v[162:165]
    ds_read_b128 v[118:121], v5 offset:48
    ds_read_b32 v254, v6 offset:192
    v_mfma_f32_16x16x32_bf16 v[162:165], v[134:137], a[204:207], v[162:165]
    v_cvt_pk_bf16_f32 v214, v186, v187
    v_cvt_pk_bf16_f32 v215, v188, v189
    v_mfma_f32_16x16x32_bf16 v[162:165], v[154:157], a[208:211], v[162:165]
    v_mul_f32 v127, v159, v127
    v_cvt_pk_f16_f32 v148, v126, v127
    v_mfma_f32_16x16x32_bf16 v[162:165], v[198:201], a[212:215], v[162:165]
    ds_read_b128 v[198:201], v2 offset:0
    ds_read_b128 v[186:189], v2 offset:1024
    v_mfma_f32_16x16x32_f16 v[134:137], v[226:229], v[222:225], v[50:53]
    ds_read_b128 v[154:157], v2 offset:2048
    v_mul_f32 v128, v159, v128
    v_mul_f32 v129, v159, v129
    v_mfma_f32_16x16x16_f16 v[210:213], v[184:185], v[182:183], v[210:213]
    v_cvt_pk_f16_f32 v149, v128, v129
    v_cvt_pk_bf16_f32 v230, v162, v163
    v_cvt_pk_bf16_f32 v231, v164, v165
    v_mul_f32 v174, v159, v174
    v_mfma_f32_16x16x32_f16 v[126:129], v[146:149], v[222:225], v[54:57]
    s_waitcnt lgkmcnt(5)
    v_mul_f32 v175, v159, v175
    v_cvt_pk_f16_f32 v164, v174, v175
    v_mul_f32 v176, v159, v176
    v_mfma_f32_16x16x16_f16 v[134:137], v[124:125], v[182:183], v[134:137]
    v_mul_f32 v177, v159, v177
    v_cvt_pk_f16_f32 v165, v176, v177
    v_mul_f32 v190, v158, v190
    v_mul_f32 v191, v158, v191
    v_mfma_f32_16x16x16_f16 v[126:129], v[164:165], v[182:183], v[126:129]
    v_cvt_pk_f16_f32 v174, v190, v191
    v_mul_f32 v192, v158, v192
    v_mul_f32 v193, v158, v193
    v_cvt_pk_f16_f32 v175, v192, v193
    v_mfma_f32_16x16x32_f16 v[166:169], v[150:153], v[222:225], v[22:25]
    s_waitcnt lgkmcnt(2)
    ds_read_b128 v[222:225], v2 offset:3072
    buffer_store_dwordx4 v[142:145], v16, s[12:15], 0 offen nt
    ds_read_b128 v[234:237], v2 offset:4096
    v_mul_f32 v218, v158, v218
    v_mul_f32 v219, v158, v219
    v_cvt_pk_f16_f32 v176, v218, v219
    v_mfma_f32_16x16x32_f16 v[166:169], v[202:205], v[242:245], v[166:169]
    s_waitcnt lgkmcnt(2)
    v_mul_f32 v220, v158, v220
    v_mul_f32 v221, v158, v221
    v_mfma_f32_16x16x32_f16 v[166:169], v[118:121], v[182:185], v[166:169]
    ds_read_b128 v[142:145], v2 offset:5120
    v_cvt_pk_f16_f32 v177, v220, v221
    v_mul_f32 v138, v158, v138
    v_mul_f32 v139, v158, v139
    v_cvt_pk_f16_f32 v162, v138, v139
    v_mfma_f32_16x16x32_f16 v[218:221], v[150:153], v[206:209], v[24:27]
    v_mul_f32 v140, v158, v140
    v_mul_f32 v141, v158, v141
    v_mfma_f32_16x16x32_f16 v[218:221], v[202:205], v[226:229], v[218:221]
    v_mov_b32_dpp v254, v167 quad_perm:[0,1,2,3] row_mask:0x1 bank_mask:0xf
    v_cvt_pk_f16_f32 v163, v140, v141
    v_mfma_f32_16x16x32_f16 v[218:221], v[118:121], v[122:125], v[218:221]
    v_max3_f32 v255, v166, v210, v211
    v_max3_f32 v255, v255, v212, v213
    v_mfma_f32_16x16x32_f16 v[238:241], v[150:153], v[174:177], v[26:29]
    s_waitcnt lgkmcnt(1)
    v_max3_f32 v255, v255, v134, v135
    v_max3_f32 v255, v255, v136, v137
    v_mfma_f32_16x16x32_f16 v[238:241], v[202:205], v[146:149], v[238:241]
    v_max3_f32 v255, v255, v126, v127
    v_mov_b32_dpp v254, v219 quad_perm:[0,1,2,3] row_mask:0x2 bank_mask:0xf
    v_mfma_f32_16x16x32_f16 v[238:241], v[118:121], v[162:165], v[238:241]
    v_max3_f32 v255, v255, v128, v129
    v_mov_b32 v182, v255
    v_mfma_f32_16x16x32_bf16 v[150:153], a[216:219], v[198:201], 0
    s_waitcnt lgkmcnt(0)
    v_permlane32_swap_b32 v255, v182
    v_mfma_f32_16x16x32_bf16 v[150:153], a[220:223], v[186:189], v[150:153]
    v_max_f32 v255, v255, v182
    v_mov_b32 v182, v255
    v_mfma_f32_16x16x32_bf16 v[150:153], a[224:227], v[154:157], v[150:153]
    v_cvt_pk_bf16_f32 v179, v180, v181
    v_xor_b32 v0, 65536, v0
    v_mfma_f32_16x16x32_bf16 v[150:153], a[228:231], v[222:225], v[150:153]
    s_waitcnt vmcnt(5)
    v_permlane16_swap_b32 v255, v182
    v_mfma_f32_16x16x32_bf16 v[150:153], a[232:235], v[234:237], v[150:153]
    s_nop 0
    v_max_f32 v255, v255, v182
    v_sub_f32 v210, v210, v255
    v_mfma_f32_16x16x32_bf16 v[150:153], a[236:239], v[142:145], v[150:153]
    s_nop 0
    v_exp_f32 v210, v210
    v_mfma_f32_16x16x32_bf16 v[190:193], a[240:243], v[198:201], 0
    s_nop 0
    v_sub_f32 v211, v211, v255
    v_sub_f32 v212, v212, v255
    v_mfma_f32_16x16x32_bf16 v[190:193], a[244:247], v[186:189], v[190:193]
    s_barrier
    buffer_load_dwordx4 v10, s[8:11], 0 offen nt lds
    v_sub_f32 v213, v213, v255
    v_mfma_f32_16x16x32_bf16 v[190:193], a[248:251], v[154:157], v[190:193]
    s_add_u32 m0, s28, 4096
    v_exp_f32 v211, v211
    v_mfma_f32_16x16x32_bf16 v[190:193], a[252:255], v[222:225], v[190:193]
    v_cvt_pk_bf16_f32 v158, v210, v211
    v_sub_f32 v134, v134, v255
    v_mfma_f32_16x16x32_bf16 v[190:193], v[82:85], v[234:237], v[190:193]
    v_exp_f32 v212, v212
    v_mfma_f32_16x16x32_bf16 v[190:193], v[86:89], v[142:145], v[190:193]
    v_exp_f32 v213, v213
    v_mfma_f32_16x16x32_bf16 v[202:205], v[90:93], v[198:201], 0
    ds_read_b128 v[198:201], v2 offset:6144
    buffer_load_dwordx4 v11, s[8:11], 0 offen nt lds
    v_mfma_f32_16x16x32_bf16 v[202:205], v[94:97], v[186:189], v[202:205]
    s_add_u32 m0, s28, 8192
    ds_read_b128 v[138:141], v2 offset:7168
    v_cvt_pk_bf16_f32 v159, v212, v213
    v_mfma_f32_16x16x32_bf16 v[202:205], v[98:101], v[154:157], v[202:205]
    ds_read_b128 v[210:213], v2 offset:8192
    v_sub_f32 v135, v135, v255
    v_mfma_f32_16x16x32_bf16 v[202:205], v[102:105], v[222:225], v[202:205]
    ds_read_b128 v[186:189], v2 offset:9216
    v_sub_f32 v136, v136, v255
    v_mfma_f32_16x16x32_bf16 v[202:205], v[106:109], v[234:237], v[202:205]
    ds_read_b128 v[222:225], v2 offset:10240
    v_sub_f32 v137, v137, v255
    v_mfma_f32_16x16x32_bf16 v[202:205], v[110:113], v[142:145], v[202:205]
    ds_read_b128 v[154:157], v2 offset:11264
    buffer_load_dwordx4 v12, s[8:11], 0 offen nt lds
    v_exp_f32 v134, v134
    v_mfma_f32_16x16x32_f16 v[118:121], v[242:245], v[206:209], v[58:61]
    s_add_u32 m0, s28, 12288
    v_exp_f32 v135, v135
    v_exp_f32 v136, v136
    v_cvt_pk_bf16_f32 v160, v134, v135
    v_exp_f32 v137, v137
    v_sub_f32 v126, v126, v255
    v_mfma_f32_16x16x16_f16 v[118:121], v[184:185], v[122:123], v[118:121]
    v_cvt_pk_bf16_f32 v161, v136, v137
    v_exp_f32 v126, v126
    v_sub_f32 v127, v127, v255
    v_mfma_f32_16x16x32_f16 v[134:137], v[226:229], v[206:209], v[62:65]
    s_xor_b32 s28, s28, 65536
    buffer_load_dwordx4 v13, s[8:11], 0 offen nt lds
    v_exp_f32 v127, v127
    v_sub_f32 v128, v128, v255
    v_cvt_pk_bf16_f32 v36, v126, v127
    v_exp_f32 v128, v128
    v_mfma_f32_16x16x16_f16 v[134:137], v[124:125], v[122:123], v[134:137]
    v_sub_f32 v129, v129, v255
    v_exp_f32 v129, v129
    v_sub_f32 v166, v166, v255
    v_cvt_pk_bf16_f32 v37, v128, v129
    v_mfma_f32_16x16x32_f16 v[126:129], v[146:149], v[206:209], v[66:69]
    s_waitcnt lgkmcnt(0)
    v_exp_f32 v166, v166
    v_mfma_f32_16x16x32_bf16 v[142:145], a[216:219], v[198:201], 0
    s_mov_b32 m0, s29
    v_cvt_pk_bf16_f32 v39, v166, 0
    v_max3_f32 v255, v218, v118, v119
    v_max3_f32 v255, v255, v120, v121
    v_mfma_f32_16x16x16_f16 v[126:129], v[164:165], v[122:123], v[126:129]
    v_max3_f32 v255, v255, v134, v135
    v_max3_f32 v255, v255, v136, v137
    v_xor_b32 v1, 65536, v1
    v_mov_b32_dpp v254, v239 quad_perm:[0,1,2,3] row_mask:0x4 bank_mask:0xf
    v_mfma_f32_16x16x32_bf16 v[206:209], v[28:31], v[36:39], 0
    s_xor_b32 s29, s29, s30
    buffer_store_dwordx2 v[178:179], v19, s[12:15], 0 offen nt
    v_mov_b32 v122, v254
    v_max3_f32 v255, v255, v126, v127
    v_mfma_f32_16x16x32_bf16 v[206:209], v[28:31], v[158:161], v[206:209]
    s_add_u32 s19, s19, s20
    v_max3_f32 v255, v255, v128, v129
    v_mov_b32 v123, v255
    v_mfma_f32_16x16x32_bf16 v[142:145], a[220:223], v[138:141], v[142:145]
    s_add_u32 s23, s23, s21
    v_permlane32_swap_b32 v255, v123
    v_mfma_f32_16x16x32_bf16 v[142:145], a[224:227], v[210:213], v[142:145]
    s_cmp_ge_u32 s19, 72
    v_rcp_f32 v206, v206
    v_mfma_f32_16x16x32_bf16 v[142:145], a[228:231], v[186:189], v[142:145]
    s_cselect_b32 s34, 72, 0
    v_max_f32 v255, v255, v123
    v_mov_b32 v123, v255
    v_mfma_f32_16x16x32_bf16 v[142:145], a[232:235], v[222:225], v[142:145]
    s_cselect_b32 s35, s22, 0
    v_permlane16_swap_b32 v255, v123
    v_mfma_f32_16x16x32_bf16 v[142:145], a[236:239], v[154:157], v[142:145]
    s_sub_u32 s19, s19, s34
    v_max_f32 v255, v255, v123
    v_sub_f32 v118, v118, v255
    v_mfma_f32_16x16x32_bf16 v[178:181], v[194:197], v[36:39], 0
    s_add_u32 s23, s23, s35
    v_exp_f32 v118, v118
    v_mfma_f32_16x16x32_bf16 v[178:181], v[170:173], v[158:161], v[178:181]
    s_add_u32 s18, s18, 1
    v_sub_f32 v119, v119, v255
    v_exp_f32 v119, v119
    v_sub_f32 v120, v120, v255
    v_cvt_pk_bf16_f32 v118, v118, v119
    v_exp_f32 v120, v120
    v_sub_f32 v121, v121, v255
    v_exp_f32 v121, v121
    v_mul_f32 v178, v206, v178
    v_mul_f32 v179, v206, v179
    v_cvt_pk_bf16_f32 v178, v178, v179
    v_mul_f32 v180, v206, v180
    v_mul_f32 v181, v206, v181
    v_cvt_pk_bf16_f32 v179, v180, v181
    v_cvt_pk_bf16_f32 v119, v120, v121
    v_mfma_f32_16x16x32_bf16 v[166:169], v[214:217], v[36:39], 0
    s_cmp_lt_u32 s18, s45
    v_sub_f32 v134, v134, v255
    v_sub_f32 v135, v135, v255
    v_mfma_f32_16x16x32_bf16 v[166:169], v[130:133], v[158:161], v[166:169]
    v_exp_f32 v134, v134
    v_exp_f32 v135, v135
    v_sub_f32 v136, v136, v255
    v_cvt_pk_bf16_f32 v120, v134, v135
    v_exp_f32 v136, v136
    v_sub_f32 v137, v137, v255
    v_exp_f32 v137, v137
    v_sub_f32 v126, v126, v255
    v_mul_f32 v166, v206, v166
    v_mul_f32 v167, v206, v167
    v_cvt_pk_bf16_f32 v180, v166, v167
    v_mul_f32 v168, v206, v168
    v_mul_f32 v169, v206, v169
    v_cvt_pk_bf16_f32 v181, v168, v169
    v_cvt_pk_bf16_f32 v121, v136, v137
    v_mfma_f32_16x16x32_bf16 v[134:137], v[230:233], v[36:39], 0
    buffer_load_dwordx4 v14, s[8:11], 0 offen nt lds
    v_sub_f32 v127, v127, v255
    v_mfma_f32_16x16x32_bf16 v[134:137], v[114:117], v[158:161], v[134:137]
    ds_write_b128 v3, v[178:181] offset:0
    v_mfma_f32_16x16x32_bf16 v[158:161], a[240:243], v[198:201], 0
    v_exp_f32 v126, v126
    v_mfma_f32_16x16x32_bf16 v[158:161], a[244:247], v[138:141], v[158:161]
    v_exp_f32 v127, v127
    v_mfma_f32_16x16x32_bf16 v[158:161], a[248:251], v[210:213], v[158:161]
    v_cvt_pk_bf16_f32 v36, v126, v127
    v_sub_f32 v128, v128, v255
    v_mfma_f32_16x16x32_bf16 v[158:161], a[252:255], v[186:189], v[158:161]
    v_mul_f32 v134, v206, v134
    v_mul_f32 v135, v206, v135
    v_mfma_f32_16x16x32_bf16 v[158:161], v[82:85], v[222:225], v[158:161]
    v_cvt_pk_bf16_f32 v126, v134, v135
    v_mul_f32 v136, v206, v136
    v_mfma_f32_16x16x32_bf16 v[158:161], v[86:89], v[154:157], v[158:161]
    v_mul_f32 v137, v206, v137
    v_cvt_pk_bf16_f32 v127, v136, v137
    v_mfma_f32_16x16x32_bf16 v[178:181], v[90:93], v[198:201], 0
    ds_read_b128 v[198:201], v2 offset:12288
    v_sub_f32 v129, v129, v255
    v_mfma_f32_16x16x32_bf16 v[178:181], v[94:97], v[138:141], v[178:181]
    ds_read_b128 v[206:209], v2 offset:13312
    v_sub_f32 v218, v218, v255
    v_mfma_f32_16x16x32_bf16 v[178:181], v[98:101], v[210:213], v[178:181]
    ds_read_b128 v[210:213], v2 offset:14336
    v_max_f32_dpp v122, v122, v122 quad_perm:[1,0,3,2] row_mask:0xf bank_mask:0xf
    v_mfma_f32_16x16x32_bf16 v[178:181], v[102:105], v[186:189], v[178:181]
    ds_read_b128 v[134:137], v2 offset:15360
    v_max_f32_dpp v122, v122, v122 quad_perm:[2,3,0,1] row_mask:0xf bank_mask:0xf
    v_mfma_f32_16x16x32_bf16 v[178:181], v[106:109], v[222:225], v[178:181]
    ds_read_b128 v[222:225], v2 offset:16384
    v_max_f32_dpp v122, v122, v122 row_half_mirror row_mask:0xf bank_mask:0xf
    v_mfma_f32_16x16x32_bf16 v[178:181], v[110:113], v[154:157], v[178:181]
    ds_read_b128 v[154:157], v2 offset:17408
    ds_write_b64 v4, v[126:127] offset:4096
    v_exp_f32 v128, v128
    v_exp_f32 v129, v129
    v_mfma_f32_16x16x32_f16 v[186:189], v[242:245], v[174:177], v[70:73]
    s_waitcnt lgkmcnt(6)
    v_cvt_pk_bf16_f32 v37, v128, v129
    v_max_f32_dpp v122, v122, v122 row_mirror row_mask:0xf bank_mask:0xf
    v_mfma_f32_16x16x32_f16 v[242:245], v[226:229], v[174:177], v[74:77]
    s_waitcnt lgkmcnt(5)
    v_exp_f32 v218, v218
    v_mfma_f32_16x16x32_f16 v[126:129], v[146:149], v[174:177], v[78:81]
    s_waitcnt lgkmcnt(4)
    v_cvt_pk_bf16_f32 v39, v218, 0
    v_mov_b32 v123, v122
    v_fma_f32 v255, v150, v150, s33
    v_mfma_f32_16x16x32_bf16 v[174:177], v[28:31], v[36:39], 0
    s_waitcnt lgkmcnt(3)
    v_permlane32_swap_b32 v122, v123
    v_mfma_f32_16x16x32_bf16 v[174:177], v[28:31], v[118:121], v[174:177]
    s_waitcnt lgkmcnt(2)
    v_max_f32 v122, v122, v123
    v_mov_b32 v123, v122
    v_mfma_f32_16x16x32_bf16 v[226:229], v[194:197], v[36:39], 0
    s_waitcnt lgkmcnt(0)
    v_permlane16_swap_b32 v122, v123
    v_mfma_f32_16x16x32_bf16 v[226:229], v[170:173], v[118:121], v[226:229]
    v_max_f32 v122, v122, v123
    v_sub_f32 v254, v254, v122
    v_mfma_f32_16x16x32_bf16 v[218:221], v[214:217], v[36:39], 0
    v_exp_f32 v254, v254
    v_mfma_f32_16x16x32_bf16 v[218:221], v[130:133], v[118:121], v[218:221]
    v_cvt_pk_bf16_f32 v254, v254, v254
    v_fmac_f32 v255, v151, v151
    v_mfma_f32_16x16x32_bf16 v[166:169], v[230:233], v[36:39], 0
    ds_write_b16 v8, v254
    v_mfma_f32_16x16x32_bf16 v[166:169], v[114:117], v[118:121], v[166:169]
    v_rcp_f32 v174, v174
    v_fmac_f32 v255, v152, v152
    v_mfma_f32_16x16x16_f16 v[186:189], v[184:185], v[162:163], v[186:189]
    v_mul_f32 v226, v174, v226
    v_mul_f32 v227, v174, v227
    v_cvt_pk_bf16_f32 v122, v226, v227
    v_mfma_f32_16x16x16_f16 v[242:245], v[124:125], v[162:163], v[242:245]
    v_mul_f32 v228, v174, v228
    v_mul_f32 v229, v174, v229
    v_cvt_pk_bf16_f32 v123, v228, v229
    v_mfma_f32_16x16x16_f16 v[126:129], v[164:165], v[162:163], v[126:129]
    v_max3_f32 v254, v238, v186, v187
    v_max3_f32 v254, v254, v188, v189
    v_mul_f32 v218, v174, v218
    v_mul_f32 v219, v174, v219
    v_mfma_f32_16x16x32_bf16 v[146:149], a[216:219], v[198:201], 0
    ds_read_b128 v[118:121], v9
    ds_read_b128 v[162:165], v9 offset:64
    v_mfma_f32_16x16x32_bf16 v[146:149], a[220:223], v[206:209], v[146:149]
    v_max3_f32 v254, v254, v242, v243
    v_max3_f32 v254, v254, v244, v245
    v_mfma_f32_16x16x32_bf16 v[146:149], a[224:227], v[210:213], v[146:149]
    v_max3_f32 v254, v254, v126, v127
    v_max3_f32 v254, v254, v128, v129
    v_mfma_f32_16x16x32_bf16 v[146:149], a[228:231], v[134:137], v[146:149]
    v_mov_b32 v125, v254
    v_cvt_pk_bf16_f32 v124, v218, v219
    v_mfma_f32_16x16x32_bf16 v[146:149], a[232:235], v[222:225], v[146:149]
    v_permlane32_swap_b32 v254, v125
    v_mfma_f32_16x16x32_bf16 v[146:149], a[236:239], v[154:157], v[146:149]
    v_max_f32 v254, v254, v125
    v_mov_b32 v125, v254
    v_mfma_f32_16x16x32_bf16 v[138:141], a[240:243], v[198:201], 0
    v_mul_f32 v220, v174, v220
    v_mul_f32 v221, v174, v221
    v_mfma_f32_16x16x32_bf16 v[138:141], a[244:247], v[206:209], v[138:141]
    v_permlane16_swap_b32 v254, v125
    v_mfma_f32_16x16x32_bf16 v[138:141], a[248:251], v[210:213], v[138:141]
    s_waitcnt lgkmcnt(0)
    v_max_f32 v254, v254, v125
    v_sub_f32 v186, v186, v254
    v_mfma_f32_16x16x32_bf16 v[138:141], a[252:255], v[134:137], v[138:141]
    v_exp_f32 v186, v186
    v_mfma_f32_16x16x32_bf16 v[138:141], v[82:85], v[222:225], v[138:141]
    v_sub_f32 v187, v187, v254
    v_sub_f32 v188, v188, v254
    v_mfma_f32_16x16x32_bf16 v[138:141], v[86:89], v[154:157], v[138:141]
    v_exp_f32 v187, v187
    v_exp_f32 v188, v188
    v_cvt_pk_bf16_f32 v234, v186, v187
    v_sub_f32 v189, v189, v254
    v_exp_f32 v189, v189
    v_sub_f32 v242, v242, v254
    v_cvt_pk_bf16_f32 v235, v188, v189
    v_exp_f32 v242, v242
    v_sub_f32 v243, v243, v254
    v_exp_f32 v243, v243
    v_sub_f32 v244, v244, v254
    v_cvt_pk_bf16_f32 v236, v242, v243
    v_mfma_f32_16x16x32_bf16 v[186:189], v[90:93], v[198:201], 0
    v_exp_f32 v244, v244
    v_mfma_f32_16x16x32_bf16 v[186:189], v[94:97], v[206:209], v[186:189]
    v_sub_f32 v245, v245, v254
    v_sub_f32 v126, v126, v254
    v_mfma_f32_16x16x32_bf16 v[186:189], v[98:101], v[210:213], v[186:189]
    v_exp_f32 v245, v245
    v_mfma_f32_16x16x32_bf16 v[186:189], v[102:105], v[134:137], v[186:189]
    v_cvt_pk_bf16_f32 v237, v244, v245
    v_sub_f32 v127, v127, v254
    v_mfma_f32_16x16x32_bf16 v[186:189], v[106:109], v[222:225], v[186:189]
    v_exp_f32 v126, v126
    v_mfma_f32_16x16x32_bf16 v[186:189], v[110:113], v[154:157], v[186:189]
    ds_read_b128 v[182:185], v0 offset:20480
    ds_read_b128 v[198:201], v1 offset:20480
    v_mfma_f32_16x16x32_bf16 v[206:209], v[118:121], v[28:31], 0
    ds_read_b128 v[210:213], v0 offset:20608
    ds_read_b128 v[222:225], v1 offset:20608
    v_mfma_f32_16x16x32_bf16 v[206:209], v[162:165], v[28:31], v[206:209]
    v_exp_f32 v127, v127
    v_mfma_f32_16x16x32_bf16 v[154:157], v[118:121], v[170:173], 0
    ds_read_b128 v[226:229], v0 offset:20736
    v_cvt_pk_bf16_f32 v36, v126, v127
    v_mfma_f32_16x16x32_bf16 v[154:157], v[162:165], v[194:197], v[154:157]
    ds_read_b128 v[242:245], v1 offset:20736
    v_sub_f32 v128, v128, v254
    v_exp_f32 v128, v128
    v_sub_f32 v129, v129, v254
    v_exp_f32 v129, v129
    v_sub_f32 v238, v238, v254
    v_cvt_pk_bf16_f32 v37, v128, v129
    v_mfma_f32_16x16x32_bf16 v[134:137], v[118:121], v[130:133], 0
    v_exp_f32 v238, v238
    v_mfma_f32_16x16x32_bf16 v[134:137], v[162:165], v[214:217], v[134:137]
    s_waitcnt lgkmcnt(4)
    v_cvt_pk_bf16_f32 v39, v238, 0
    v_cvt_pk_bf16_f32 v125, v220, v221
    v_mfma_f32_16x16x32_bf16 v[218:221], v[118:121], v[114:117], 0
    s_waitcnt lgkmcnt(2)
    ds_write_b128 v3, v[122:125] offset:6144
    v_mfma_f32_16x16x32_bf16 v[126:129], v[28:31], v[36:39], 0
    s_waitcnt lgkmcnt(2)
    v_mul_f32 v166, v174, v166
    v_mul_f32 v167, v174, v167
    v_mfma_f32_16x16x32_bf16 v[126:129], v[28:31], v[234:237], v[126:129]
    s_waitcnt lgkmcnt(1)
    v_cvt_pk_bf16_f32 v166, v166, v167
    v_mul_f32 v168, v174, v168
    v_mfma_f32_16x16x32_bf16 v[122:125], v[194:197], v[36:39], 0
    v_mul_f32 v169, v174, v169
    v_cvt_pk_bf16_f32 v167, v168, v169
    v_mfma_f32_16x16x32_bf16 v[122:125], v[170:173], v[234:237], v[122:125]
    ds_write_b64 v4, v[166:167] offset:10240
    v_mfma_f32_16x16x32_bf16 v[170:173], v[214:217], v[36:39], 0
    v_rcp_f32 v126, v126
    v_mfma_f32_16x16x32_bf16 v[170:173], v[130:133], v[234:237], v[170:173]
    v_fma_f32 v254, v146, v146, s33
    v_fmac_f32 v254, v147, v147
    v_mfma_f32_16x16x32_bf16 v[174:177], v[230:233], v[36:39], 0
    v_fmac_f32 v254, v148, v148
    v_mul_f32 v122, v126, v122
    v_mfma_f32_16x16x32_bf16 v[174:177], v[114:117], v[234:237], v[174:177]
    v_mul_f32 v123, v126, v123
    v_cvt_pk_bf16_f32 v122, v122, v123
    v_mfma_f32_16x16x32_bf16 v[218:221], v[162:165], v[230:233], v[218:221]
    v_mul_f32 v124, v126, v124
    v_mul_f32 v125, v126, v125
    v_mfma_f32_16x16x32_bf16 v[114:117], a[72:75], v[182:185], 0
    v_cvt_pk_bf16_f32 v123, v124, v125
    v_mul_f32 v170, v126, v170
    v_mfma_f32_16x16x32_bf16 v[114:117], a[76:79], v[198:201], v[114:117]
    v_mul_f32 v171, v126, v171
    v_cvt_pk_bf16_f32 v124, v170, v171
    v_mfma_f32_16x16x32_bf16 v[114:117], a[80:83], v[210:213], v[114:117]
    v_mul_f32 v172, v126, v172
    v_mul_f32 v173, v126, v173
    v_mfma_f32_16x16x32_bf16 v[114:117], a[84:87], v[222:225], v[114:117]
    v_cvt_pk_bf16_f32 v125, v172, v173
    v_mul_f32 v174, v126, v174
    v_mfma_f32_16x16x32_bf16 v[114:117], a[88:91], v[226:229], v[114:117]
    ds_write_b128 v3, v[122:125] offset:12288
    v_mfma_f32_16x16x32_bf16 v[114:117], a[92:95], v[242:245], v[114:117]
    v_mul_f32 v175, v126, v175
    v_cvt_pk_bf16_f32 v174, v174, v175
    v_mfma_f32_16x16x32_bf16 v[122:125], a[96:99], v[182:185], 0
    v_mul_f32 v176, v126, v176
    v_mul_f32 v177, v126, v177
    v_mfma_f32_16x16x32_bf16 v[122:125], a[100:103], v[198:201], v[122:125]
    v_cvt_pk_bf16_f32 v175, v176, v177
    v_fmac_f32 v254, v149, v149
    v_mfma_f32_16x16x32_bf16 v[122:125], a[104:107], v[210:213], v[122:125]
    ds_write_b64 v4, v[174:175] offset:16384
    v_mfma_f32_16x16x32_bf16 v[122:125], a[108:111], v[222:225], v[122:125]
    v_fmac_f32 v254, v138, v138
    v_fmac_f32 v254, v139, v139
    v_mfma_f32_16x16x32_bf16 v[122:125], a[112:115], v[226:229], v[122:125]
    v_fmac_f32 v254, v140, v140
    v_fmac_f32 v254, v141, v141
    v_mfma_f32_16x16x32_bf16 v[122:125], a[116:119], v[242:245], v[122:125]
    v_fmac_f32 v254, v186, v186
    v_fmac_f32 v254, v187, v187
    v_mfma_f32_16x16x32_bf16 v[126:129], a[120:123], v[182:185], 0
    v_fmac_f32 v254, v188, v188
    v_fmac_f32 v254, v189, v189
    v_mfma_f32_16x16x32_bf16 v[126:129], a[124:127], v[198:201], v[126:129]
    v_cvt_pk_bf16_f32 v155, v254, v254
    v_fmac_f32 v255, v153, v153
    v_mfma_f32_16x16x32_bf16 v[126:129], a[128:131], v[210:213], v[126:129]
    v_rcp_f32 v206, v206
    v_mfma_f32_16x16x32_bf16 v[126:129], a[132:135], v[222:225], v[126:129]
    v_mul_f32 v154, v154, v206
    v_mul_f32_dpp v154, v134, v206 quad_perm:[0,1,2,3] row_mask:0x2 bank_mask:0xf
    v_mfma_f32_16x16x32_bf16 v[126:129], a[136:139], v[226:229], v[126:129]
    v_mul_f32_dpp v154, v218, v206 quad_perm:[0,1,2,3] row_mask:0x4 bank_mask:0xf
    v_cvt_pk_bf16_f32 v154, v154, v154
    v_mfma_f32_16x16x32_bf16 v[126:129], a[140:143], v[242:245], v[126:129]
    ds_write_b16 v7, v154
    v_mfma_f32_16x16x32_bf16 v[206:209], a[0:3], v[182:185], 0
    v_fmac_f32 v255, v190, v190
    v_fmac_f32 v255, v191, v191
    v_mfma_f32_16x16x32_bf16 v[206:209], a[4:7], v[198:201], v[206:209]
    v_fmac_f32 v255, v192, v192
    v_fmac_f32 v255, v193, v193
    v_mfma_f32_16x16x32_bf16 v[206:209], a[8:11], v[210:213], v[206:209]
    v_fmac_f32 v255, v202, v202
    v_fmac_f32 v255, v203, v203
    v_mfma_f32_16x16x32_bf16 v[206:209], a[12:15], v[222:225], v[206:209]
    v_fmac_f32 v255, v204, v204
    v_fmac_f32 v255, v205, v205
    v_mfma_f32_16x16x32_bf16 v[206:209], a[16:19], v[226:229], v[206:209]
    v_fma_f32 v254, v142, v142, s33
    v_fmac_f32 v254, v143, v143
    v_mfma_f32_16x16x32_bf16 v[206:209], a[20:23], v[242:245], v[206:209]
    v_fmac_f32 v254, v144, v144
    v_fmac_f32 v254, v145, v145
    v_mfma_f32_16x16x32_bf16 v[174:177], a[24:27], v[182:185], 0
    v_fmac_f32 v254, v158, v158
    v_fmac_f32 v254, v159, v159
    v_mfma_f32_16x16x32_bf16 v[174:177], a[28:31], v[198:201], v[174:177]
    v_fmac_f32 v254, v160, v160
    v_fmac_f32 v254, v161, v161
    v_mfma_f32_16x16x32_bf16 v[174:177], a[32:35], v[210:213], v[174:177]
    v_fmac_f32 v254, v178, v178
    v_fmac_f32 v254, v179, v179
    v_mfma_f32_16x16x32_bf16 v[174:177], a[36:39], v[222:225], v[174:177]
    v_fmac_f32 v254, v180, v180
    v_fmac_f32 v254, v181, v181
    v_mfma_f32_16x16x32_bf16 v[174:177], a[40:43], v[226:229], v[174:177]
    v_cvt_pk_bf16_f32 v154, v255, v254
    v_add_u32 v5, 336, v5
    v_mfma_f32_16x16x32_bf16 v[174:177], a[44:47], v[242:245], v[174:177]
    ds_write_b64 v4, v[154:155] offset:18432
    v_mfma_f32_16x16x32_bf16 v[218:221], a[48:51], v[182:185], 0
    v_add_u32 v6, 272, v6
    v_add_u32 v7, 16, v7
    v_mfma_f32_16x16x32_bf16 v[218:221], a[52:55], v[198:201], v[218:221]
    v_fma_f32 v130, v114, v114, s32
    v_fmac_f32 v130, v115, v115
    v_mfma_f32_16x16x32_bf16 v[218:221], a[56:59], v[210:213], v[218:221]
    v_fmac_f32 v130, v116, v116
    v_fmac_f32 v130, v117, v117
    v_mfma_f32_16x16x32_bf16 v[218:221], a[60:63], v[222:225], v[218:221]
    v_fmac_f32 v130, v122, v122
    v_fmac_f32 v130, v123, v123
    v_mfma_f32_16x16x32_bf16 v[218:221], a[64:67], v[226:229], v[218:221]
    v_fmac_f32 v130, v124, v124
    v_fmac_f32 v130, v125, v125
    v_mfma_f32_16x16x32_bf16 v[218:221], a[68:71], v[242:245], v[218:221]
    v_fmac_f32 v130, v126, v126
    v_fmac_f32 v130, v127, v127
    v_mfma_f32_16x16x32_bf16 v[170:173], v[182:185], a[144:147], 0
    s_waitcnt lgkmcnt(0)
    v_fmac_f32 v130, v128, v128
    v_fmac_f32 v130, v129, v129
    v_mfma_f32_16x16x32_bf16 v[170:173], v[198:201], a[148:151], v[170:173]
    s_nop 0
    v_fma_f32 v131, v206, v206, s32
    v_fmac_f32 v131, v207, v207
    v_mfma_f32_16x16x32_bf16 v[170:173], v[210:213], a[152:155], v[170:173]
    s_nop 0
    v_fmac_f32 v131, v208, v208
    v_fmac_f32 v131, v209, v209
    v_mfma_f32_16x16x32_bf16 v[170:173], v[222:225], a[156:159], v[170:173]
    s_nop 0
    v_fmac_f32 v131, v174, v174
    v_xor_b32 v2, 65536, v2
    v_mfma_f32_16x16x32_bf16 v[170:173], v[226:229], a[160:163], v[170:173]
    s_barrier
    v_xor_b32 v3, 65536, v3
    v_xor_b32 v4, 65536, v4
    v_mfma_f32_16x16x32_bf16 v[170:173], v[242:245], a[164:167], v[170:173]
    s_cbranch_scc1 L_loop_safe3
L_final_safe:
    v_mfma_f32_16x16x32_bf16 v[118:121], v[182:185], a[168:171], 0
    s_mov_b32 s12, s42
    ds_read_b128 v[134:137], v2 offset:18432
    ds_read_b128 v[154:157], v2 offset:19456
    v_mfma_f32_16x16x32_bf16 v[118:121], v[198:201], a[172:175], v[118:121]
    s_mov_b32 s13, s43
    ds_read_b128 v[162:165], v0 offset:26624
    ds_read_b128 v[166:169], v1 offset:26624
    v_mfma_f32_16x16x32_bf16 v[118:121], v[210:213], a[176:179], v[118:121]
    s_mov_b32 s14, s36
    v_bfe_u32 v254, v2, 4, 6
    v_lshrrev_b32 v255, 4, v254
    v_mfma_f32_16x16x32_bf16 v[118:121], v[222:225], a[180:183], v[118:121]
    s_add_u32 s48, s42, s27
    ds_read_b128 v[194:197], v0 offset:26752
    ds_read_b128 v[214:217], v1 offset:26752
    v_mfma_f32_16x16x32_bf16 v[118:121], v[226:229], a[184:187], v[118:121]
    s_addc_u32 s49, s43, 0
    v_and_b32 v132, 15, v254
    v_lshlrev_b32 v133, 9, v255
    v_mfma_f32_16x16x32_bf16 v[118:121], v[242:245], a[188:191], v[118:121]
    s_sub_u32 s50, s36, s27
    ds_read_b128 v[230:233], v0 offset:26880
    s_mov_b32 s51, 0x00020000
    s_add_u32 s52, s42, s26
    s_addc_u32 s53, s43, 0
    s_sub_u32 s54, s36, s26
    s_mov_b32 s55, 0x00020000
    s_add_u32 s56, s42, s25
    s_addc_u32 s57, s43, 0
    s_sub_u32 s58, s36, s25
    s_mov_b32 s59, 0x00020000
    v_lshl_add_u32 v133, v132, 4, v133
    v_add_u32 v133, 136704, v133
    v_and_b32 v234, 0xffff, v2
    v_add_u32 v234, 148992, v234
    v_and_b32 v235, 0xffff, v4
    v_add_u32 v235, 148992, v235
    v_fmac_f32 v131, v175, v175
    v_fmac_f32 v131, v176, v176
    v_fmac_f32 v131, v177, v177
    v_fmac_f32 v131, v218, v218
    v_fmac_f32 v131, v219, v219
    v_fmac_f32 v131, v220, v220
    v_fmac_f32 v131, v221, v221
    v_cvt_pk_bf16_f32 v36, v131, v130
    v_cvt_pk_bf16_f32 v170, v170, v171
    v_cvt_pk_bf16_f32 v171, v172, v173
    v_mfma_f32_16x16x32_bf16 v[238:241], v[32:35], v[36:39], 0
    v_cvt_pk_bf16_f32 v118, v118, v119
    v_cvt_pk_bf16_f32 v119, v120, v121
    v_mfma_f32_16x16x32_bf16 v[246:249], v[182:185], a[192:195], 0
    s_waitcnt lgkmcnt(0)
    ds_read_b128 v[182:185], v1 offset:26880
    v_mov_b32 v236, 0x40000000
    v_mfma_f32_16x16x32_bf16 v[246:249], v[198:201], a[196:199], v[246:249]
    s_lshl_b32 s3, s16, 6
    v_rsq_f32 v239, v239
    v_mfma_f32_16x16x32_bf16 v[246:249], v[210:213], a[200:203], v[246:249]
    s_lshl_b32 s4, s16, 5
    ds_read_b128 v[198:201], v2 offset:0
    v_mul_f32 v114, v239, v114
    v_mfma_f32_16x16x32_bf16 v[246:249], v[222:225], a[204:207], v[246:249]
    s_add_u32 s4, s4, 256
    ds_read_b128 v[210:213], v2 offset:1024
    v_mul_f32 v115, v239, v115
    v_mfma_f32_16x16x32_bf16 v[246:249], v[226:229], a[208:211], v[246:249]
    s_mul_i32 s5, s16, 8064
    ds_read_b128 v[222:225], v2 offset:2048
    v_cvt_pk_f16_f32 v114, v114, v115
    v_mfma_f32_16x16x32_bf16 v[226:229], v[32:35], v[134:137], 0
    s_add_u32 s5, s5, 104448
    ds_read_b128 v[134:137], v2 offset:3072
    v_mul_f32 v116, v239, v116
    v_mfma_f32_16x16x32_bf16 v[226:229], v[32:35], v[154:157], v[226:229]
    ds_read_b128 v[154:157], v2 offset:4096
    v_mul_f32 v117, v239, v117
    v_mfma_f32_16x16x32_bf16 v[246:249], v[242:245], a[212:215], v[246:249]
    ds_read_b128 v[242:245], v2 offset:5120
    v_rsq_f32 v238, v238
    v_cvt_pk_f16_f32 v115, v116, v117
    v_mul_f32 v238, s31, v238
    v_mul_f32 v122, v239, v122
    v_mul_f32 v237, 0x3baaaaab, v227
    v_rsq_f32 v237, v237
    v_mul_f32 v116, 0x3baaaaab, v228
    v_mul_f32 v142, v237, v142
    v_mul_f32 v143, v237, v143
    v_cvt_pk_bf16_f32 v142, v142, v143
    v_mul_f32 v144, v237, v144
    v_mul_f32 v145, v237, v145
    v_cvt_pk_bf16_f32 v143, v144, v145
    v_mfma_f32_16x16x32_bf16 v[250:253], a[72:75], v[162:165], 0
    s_waitcnt lgkmcnt(3)
    v_mul_f32 v158, v237, v158
    v_mul_f32 v159, v237, v159
    v_mfma_f32_16x16x32_bf16 v[250:253], a[76:79], v[166:169], v[250:253]
    s_waitcnt lgkmcnt(2)
    v_cvt_pk_bf16_f32 v144, v158, v159
    v_mul_f32 v160, v237, v160
    v_mfma_f32_16x16x32_bf16 v[250:253], a[80:83], v[194:197], v[250:253]
    s_waitcnt lgkmcnt(1)
    v_mul_f32 v161, v237, v161
    v_cvt_pk_bf16_f32 v145, v160, v161
    v_mfma_f32_16x16x32_bf16 v[250:253], a[84:87], v[214:217], v[250:253]
    s_waitcnt lgkmcnt(0)
    buffer_store_dwordx4 v[142:145], v16, s[48:51], 0 offen nt
    v_mul_f32 v178, v237, v178
    v_mul_f32 v179, v237, v179
    v_cvt_pk_bf16_f32 v120, v178, v179
    v_mul_f32 v180, v237, v180
    v_mfma_f32_16x16x32_bf16 v[142:145], a[216:219], v[198:201], 0
    v_mul_f32 v181, v237, v181
    v_cvt_pk_bf16_f32 v121, v180, v181
    v_mfma_f32_16x16x32_bf16 v[142:145], a[220:223], v[210:213], v[142:145]
    v_rsq_f32 v116, v116
    v_mfma_f32_16x16x32_bf16 v[142:145], a[224:227], v[222:225], v[142:145]
    v_mul_f32 v146, v116, v146
    v_mul_f32 v147, v116, v147
    v_mfma_f32_16x16x32_bf16 v[142:145], a[228:231], v[134:137], v[142:145]
    v_cvt_pk_bf16_f32 v146, v146, v147
    v_mul_f32 v148, v116, v148
    v_mfma_f32_16x16x32_bf16 v[142:145], a[232:235], v[154:157], v[142:145]
    v_mul_f32 v149, v116, v149
    v_cvt_pk_bf16_f32 v147, v148, v149
    v_mfma_f32_16x16x32_bf16 v[142:145], a[236:239], v[242:245], v[142:145]
    v_mul_f32 v138, v116, v138
    v_mul_f32 v139, v116, v139
    v_mfma_f32_16x16x32_bf16 v[158:161], a[240:243], v[198:201], 0
    v_cvt_pk_bf16_f32 v148, v138, v139
    v_mul_f32 v140, v116, v140
    v_mfma_f32_16x16x32_bf16 v[158:161], a[244:247], v[210:213], v[158:161]
    v_mul_f32 v141, v116, v141
    v_cvt_pk_bf16_f32 v149, v140, v141
    v_mfma_f32_16x16x32_bf16 v[158:161], a[248:251], v[222:225], v[158:161]
    v_mul_f32 v186, v116, v186
    v_mul_f32 v187, v116, v187
    v_mfma_f32_16x16x32_bf16 v[158:161], a[252:255], v[134:137], v[158:161]
    v_cvt_pk_bf16_f32 v130, v186, v187
    v_mul_f32 v188, v116, v188
    v_mfma_f32_16x16x32_bf16 v[158:161], v[82:85], v[154:157], v[158:161]
    v_mul_f32 v189, v116, v189
    v_cvt_pk_bf16_f32 v131, v188, v189
    v_mfma_f32_16x16x32_bf16 v[158:161], v[86:89], v[242:245], v[158:161]
    v_mul_f32 v237, 0x3baaaaab, v226
    v_fma_f32 v172, v142, v142, s33
    v_mfma_f32_16x16x32_bf16 v[138:141], v[90:93], v[198:201], 0
    ds_read_b128 v[178:181], v2 offset:6144
    v_fmac_f32 v172, v143, v143
    v_mfma_f32_16x16x32_bf16 v[138:141], v[94:97], v[210:213], v[138:141]
    ds_read_b128 v[186:189], v2 offset:7168
    v_fmac_f32 v172, v144, v144
    v_mfma_f32_16x16x32_bf16 v[138:141], v[98:101], v[222:225], v[138:141]
    ds_read_b128 v[198:201], v2 offset:8192
    buffer_store_dwordx2 v[120:121], v19, s[48:51], 0 offen nt
    v_rsq_f32 v237, v237
    v_mfma_f32_16x16x32_bf16 v[138:141], v[102:105], v[134:137], v[138:141]
    ds_read_b128 v[134:137], v2 offset:9216
    v_mul_f32 v150, v237, v150
    v_mfma_f32_16x16x32_bf16 v[138:141], v[106:109], v[154:157], v[138:141]
    ds_read_b128 v[154:157], v2 offset:10240
    v_mul_f32 v151, v237, v151
    v_mfma_f32_16x16x32_bf16 v[138:141], v[110:113], v[242:245], v[138:141]
    ds_read_b128 v[210:213], v2 offset:11264
    v_cvt_pk_bf16_f32 v150, v150, v151
    v_mfma_f32_16x16x32_bf16 v[250:253], a[88:91], v[230:233], v[250:253]
    v_mul_f32 v152, v237, v152
    v_mul_f32 v153, v237, v153
    v_mfma_f32_16x16x32_bf16 v[250:253], a[92:95], v[182:185], v[250:253]
    s_waitcnt lgkmcnt(5)
    v_cvt_pk_bf16_f32 v151, v152, v153
    v_mul_f32 v190, v237, v190
    v_mfma_f32_16x16x32_bf16 v[222:225], a[216:219], v[178:181], 0
    s_waitcnt lgkmcnt(4)
    v_mul_f32 v191, v237, v191
    v_cvt_pk_bf16_f32 v152, v190, v191
    v_mfma_f32_16x16x32_bf16 v[222:225], a[220:223], v[186:189], v[222:225]
    s_waitcnt lgkmcnt(3)
    v_mul_f32 v192, v237, v192
    v_mul_f32 v193, v237, v193
    v_mfma_f32_16x16x32_bf16 v[222:225], a[224:227], v[198:201], v[222:225]
    v_cvt_pk_bf16_f32 v153, v192, v193
    v_mul_f32 v202, v237, v202
    v_mfma_f32_16x16x32_bf16 v[190:193], a[240:243], v[178:181], 0
    s_waitcnt lgkmcnt(2)
    v_mul_f32 v203, v237, v203
    v_cvt_pk_bf16_f32 v120, v202, v203
    v_mfma_f32_16x16x32_bf16 v[222:225], a[228:231], v[134:137], v[222:225]
    s_waitcnt lgkmcnt(1)
    v_mul_f32 v204, v237, v204
    v_mul_f32 v205, v237, v205
    v_mfma_f32_16x16x32_bf16 v[222:225], a[232:235], v[154:157], v[222:225]
    s_waitcnt lgkmcnt(0)
    v_cvt_pk_bf16_f32 v121, v204, v205
    v_fmac_f32 v172, v145, v145
    v_mfma_f32_16x16x32_bf16 v[222:225], a[236:239], v[210:213], v[222:225]
    v_fmac_f32 v172, v158, v158
    v_fmac_f32 v172, v159, v159
    v_mfma_f32_16x16x32_bf16 v[190:193], a[244:247], v[186:189], v[190:193]
    v_fmac_f32 v172, v160, v160
    v_fmac_f32 v172, v161, v161
    v_mfma_f32_16x16x32_bf16 v[190:193], a[248:251], v[198:201], v[190:193]
    v_fmac_f32 v172, v138, v138
    v_fmac_f32 v172, v139, v139
    v_mfma_f32_16x16x32_bf16 v[190:193], a[252:255], v[134:137], v[190:193]
    v_fma_f32 v237, v222, v222, s33
    v_fmac_f32 v237, v223, v223
    v_mfma_f32_16x16x32_bf16 v[190:193], v[82:85], v[154:157], v[190:193]
    buffer_store_dwordx4 v[146:149], v17, s[48:51], 0 offen nt
    v_fmac_f32 v237, v224, v224
    v_fmac_f32 v237, v225, v225
    v_fmac_f32 v172, v140, v140
    v_fmac_f32 v172, v141, v141
    v_mfma_f32_16x16x32_bf16 v[190:193], v[86:89], v[210:213], v[190:193]
    v_cvt_pk_bf16_f32 v146, v246, v247
    v_cvt_pk_bf16_f32 v147, v248, v249
    v_mfma_f32_16x16x32_bf16 v[202:205], v[90:93], v[178:181], 0
    ds_read_b128 v[178:181], v2 offset:12288
    v_mul_f32 v123, v239, v123
    v_mfma_f32_16x16x32_bf16 v[202:205], v[94:97], v[186:189], v[202:205]
    ds_read_b128 v[186:189], v2 offset:13312
    v_cvt_pk_f16_f32 v116, v122, v123
    v_mfma_f32_16x16x32_bf16 v[202:205], v[98:101], v[198:201], v[202:205]
    ds_read_b128 v[198:201], v2 offset:14336
    v_fmac_f32 v237, v190, v190
    v_mfma_f32_16x16x32_bf16 v[202:205], v[102:105], v[134:137], v[202:205]
    ds_read_b128 v[134:137], v2 offset:15360
    v_fmac_f32 v237, v191, v191
    v_mfma_f32_16x16x32_bf16 v[202:205], v[106:109], v[154:157], v[202:205]
    ds_read_b128 v[154:157], v2 offset:16384
    v_fmac_f32 v237, v192, v192
    v_mfma_f32_16x16x32_bf16 v[202:205], v[110:113], v[210:213], v[202:205]
    ds_read_b128 v[210:213], v2 offset:17408
    v_fmac_f32 v237, v193, v193
    v_mfma_f32_16x16x32_bf16 v[226:229], a[96:99], v[162:165], 0
    v_mul_f32 v124, v239, v124
    v_mul_f32 v125, v239, v125
    v_mfma_f32_16x16x32_bf16 v[226:229], a[100:103], v[166:169], v[226:229]
    v_cvt_pk_f16_f32 v117, v124, v125
    v_mul_f32 v126, v239, v126
    v_mfma_f32_16x16x32_bf16 v[226:229], a[104:107], v[194:197], v[226:229]
    s_waitcnt lgkmcnt(5)
    v_fmac_f32 v237, v202, v202
    v_fmac_f32 v237, v203, v203
    v_mfma_f32_16x16x32_bf16 v[226:229], a[108:111], v[214:217], v[226:229]
    s_waitcnt lgkmcnt(4)
    v_fmac_f32 v237, v204, v204
    v_fmac_f32 v237, v205, v205
    v_mfma_f32_16x16x32_bf16 v[226:229], a[112:115], v[230:233], v[226:229]
    s_waitcnt lgkmcnt(3)
    v_cvt_pk_bf16_f32 v148, v172, v237
    v_cvt_pk_bf16_f32 v149, v237, v237
    v_mfma_f32_16x16x32_bf16 v[226:229], a[116:119], v[182:185], v[226:229]
    s_waitcnt lgkmcnt(2)
    ds_write_b64 v235, v[148:149] offset:0
    v_mfma_f32_16x16x32_bf16 v[122:125], a[216:219], v[178:181], 0
    s_waitcnt lgkmcnt(1)
    v_mul_f32 v127, v239, v127
    v_cvt_pk_f16_f32 v244, v126, v127
    v_mfma_f32_16x16x32_bf16 v[122:125], a[220:223], v[186:189], v[122:125]
    buffer_store_dwordx2 v[130:131], v20, s[48:51], 0 offen nt
    v_mul_f32 v128, v239, v128
    v_mul_f32 v129, v239, v129
    v_mfma_f32_16x16x32_bf16 v[122:125], a[224:227], v[198:201], v[122:125]
    v_cvt_pk_f16_f32 v245, v128, v129
    v_mul_f32 v206, v238, v206
    v_mfma_f32_16x16x32_bf16 v[122:125], a[228:231], v[134:137], v[122:125]
    v_mul_f32 v207, v238, v207
    v_cvt_pk_f16_f32 v126, v206, v207
    v_mfma_f32_16x16x32_bf16 v[122:125], a[232:235], v[154:157], v[122:125]
    v_mul_f32 v208, v238, v208
    v_mul_f32 v209, v238, v209
    v_mfma_f32_16x16x32_bf16 v[122:125], a[236:239], v[210:213], v[122:125]
    v_cvt_pk_f16_f32 v127, v208, v209
    v_mul_f32 v174, v238, v174
    v_mfma_f32_16x16x32_bf16 v[206:209], a[240:243], v[178:181], 0
    s_waitcnt lgkmcnt(0)
    v_mul_f32 v175, v238, v175
    v_cvt_pk_f16_f32 v128, v174, v175
    v_mfma_f32_16x16x32_bf16 v[206:209], a[244:247], v[186:189], v[206:209]
    s_barrier
    ds_read_b128 v[246:249], v234 offset:0
    v_mul_f32 v176, v238, v176
    v_mfma_f32_16x16x32_bf16 v[206:209], a[248:251], v[198:201], v[206:209]
    v_mul_f32 v177, v238, v177
    v_cvt_pk_f16_f32 v129, v176, v177
    v_mfma_f32_16x16x32_bf16 v[206:209], a[252:255], v[134:137], v[206:209]
    v_mul_f32 v218, v238, v218
    v_mul_f32 v219, v238, v219
    v_mfma_f32_16x16x32_bf16 v[206:209], v[82:85], v[154:157], v[206:209]
    v_cvt_pk_f16_f32 v242, v218, v219
    v_mul_f32 v220, v238, v220
    v_mfma_f32_16x16x32_bf16 v[206:209], v[86:89], v[210:213], v[206:209]
    v_mul_f32 v221, v238, v221
    v_cvt_pk_f16_f32 v243, v220, v221
    v_mfma_f32_16x16x32_bf16 v[174:177], v[90:93], v[178:181], 0
    ds_read_b128 v[178:181], v234 offset:1024
    v_add_u32 v237, 0, v132
    v_mfma_f32_16x16x32_bf16 v[174:177], v[94:97], v[186:189], v[174:177]
    ds_read_b128 v[186:189], v133 offset:0
    v_mul_u32_u24 v130, s20, v237
    v_mfma_f32_16x16x32_bf16 v[174:177], v[98:101], v[198:201], v[174:177]
    v_add_u32 v130, s38, v130
    v_mul_u32_u24 v130, 911, v130
    v_mfma_f32_16x16x32_bf16 v[174:177], v[102:105], v[134:137], v[174:177]
    s_waitcnt lgkmcnt(2)
    ds_read_b128 v[134:137], v133 offset:2048
    v_lshrrev_b32 v130, 16, v130
    v_mfma_f32_16x16x32_bf16 v[174:177], v[106:109], v[154:157], v[174:177]
    ds_read_b128 v[154:157], v133 offset:4096
    v_mul_u32_u24 v130, s22, v130
    v_mfma_f32_16x16x32_bf16 v[174:177], v[110:113], v[210:213], v[174:177]
    ds_read_b128 v[198:201], v133 offset:6144
    buffer_store_dwordx4 v[150:153], v15, s[48:51], 0 offen nt
    ds_read_b128 v[210:213], v133 offset:8192
    v_mad_u32_u24 v130, v237, s21, v130
    v_cmp_gt_u32 vcc, s17, v237
    v_add_u32 v237, s7, v130
    v_mfma_f32_16x16x32_bf16 v[150:153], v[32:35], v[246:249], 0
    ds_read_b128 v[218:221], v133 offset:10240
    s_waitcnt lgkmcnt(6)
    v_mfma_f32_16x16x32_bf16 v[150:153], v[32:35], v[178:181], v[150:153]
    v_cndmask_b32 v237, v236, v237, vcc
    v_lshl_add_u32 v130, v255, 4, v237
    v_mfma_f32_16x16x32_bf16 v[178:181], a[120:123], v[162:165], 0
    s_waitcnt lgkmcnt(5)
    v_add_u32 v130, s3, v130
    v_lshl_add_u32 v237, v255, 3, v237
    v_mfma_f32_16x16x32_bf16 v[178:181], a[124:127], v[166:169], v[178:181]
    v_add_u32 v237, s4, v237
    v_mul_f32 v131, 0x3baaaaab, v151
    v_mfma_f32_16x16x32_bf16 v[178:181], a[128:131], v[194:197], v[178:181]
    s_waitcnt lgkmcnt(4)
    v_rsq_f32 v131, v131
    v_mfma_f32_16x16x32_bf16 v[178:181], a[132:135], v[214:217], v[178:181]
    s_waitcnt lgkmcnt(3)
    v_mul_f32 v222, v131, v222
    v_mul_f32 v223, v131, v223
    v_mfma_f32_16x16x32_bf16 v[178:181], a[136:139], v[230:233], v[178:181]
    s_waitcnt lgkmcnt(1)
    v_cvt_pk_bf16_f32 v222, v222, v223
    v_mul_f32 v224, v131, v224
    v_mfma_f32_16x16x32_bf16 v[178:181], a[140:143], v[182:185], v[178:181]
    v_mul_f32 v225, v131, v225
    v_cvt_pk_bf16_f32 v223, v224, v225
    v_mul_f32 v190, v131, v190
    v_mul_f32 v191, v131, v191
    v_cvt_pk_bf16_f32 v224, v190, v191
    v_mfma_f32_16x16x32_bf16 v[238:241], a[216:219], v[186:189], 0
    s_waitcnt lgkmcnt(0)
    v_mul_f32 v192, v131, v192
    v_mul_f32 v193, v131, v193
    v_mfma_f32_16x16x32_bf16 v[238:241], a[220:223], v[134:137], v[238:241]
    v_cvt_pk_bf16_f32 v225, v192, v193
    v_mul_f32 v202, v131, v202
    v_mfma_f32_16x16x32_bf16 v[238:241], a[224:227], v[154:157], v[238:241]
    v_mul_f32 v203, v131, v203
    v_cvt_pk_bf16_f32 v148, v202, v203
    v_mfma_f32_16x16x32_bf16 v[238:241], a[228:231], v[198:201], v[238:241]
    v_mul_f32 v204, v131, v204
    v_mul_f32 v205, v131, v205
    v_mfma_f32_16x16x32_bf16 v[238:241], a[232:235], v[210:213], v[238:241]
    v_cvt_pk_bf16_f32 v149, v204, v205
    v_mul_f32 v131, 0x3baaaaab, v150
    v_mfma_f32_16x16x32_bf16 v[238:241], a[236:239], v[218:221], v[238:241]
    v_rsq_f32 v131, v131
    v_mfma_f32_16x16x32_bf16 v[150:153], a[240:243], v[186:189], 0
    buffer_store_dwordx4 v[222:225], v16, s[52:55], 0 offen nt
    v_mul_f32 v142, v131, v142
    v_mul_f32 v143, v131, v143
    v_cvt_pk_bf16_f32 v142, v142, v143
    v_mul_f32 v144, v131, v144
    v_mfma_f32_16x16x32_bf16 v[150:153], a[244:247], v[134:137], v[150:153]
    v_mul_f32 v145, v131, v145
    v_cvt_pk_bf16_f32 v143, v144, v145
    v_mfma_f32_16x16x32_bf16 v[150:153], a[248:251], v[154:157], v[150:153]
    v_mul_f32 v158, v131, v158
    v_mul_f32 v159, v131, v159
    v_mfma_f32_16x16x32_bf16 v[150:153], a[252:255], v[198:201], v[150:153]
    v_cvt_pk_bf16_f32 v144, v158, v159
    v_mul_f32 v160, v131, v160
    v_mfma_f32_16x16x32_bf16 v[150:153], v[82:85], v[210:213], v[150:153]
    v_mul_f32 v161, v131, v161
    v_cvt_pk_bf16_f32 v145, v160, v161
    v_mfma_f32_16x16x32_bf16 v[150:153], v[86:89], v[218:221], v[150:153]
    v_mul_f32 v138, v131, v138
    v_mul_f32 v139, v131, v139
    v_mfma_f32_16x16x32_bf16 v[158:161], v[90:93], v[186:189], 0
    v_cvt_pk_bf16_f32 v138, v138, v139
    v_mul_f32 v140, v131, v140
    v_mfma_f32_16x16x32_bf16 v[158:161], v[94:97], v[134:137], v[158:161]
    v_mul_f32 v141, v131, v141
    v_cvt_pk_bf16_f32 v139, v140, v141
    v_mfma_f32_16x16x32_bf16 v[158:161], v[98:101], v[154:157], v[158:161]
    v_fma_f32 v131, v238, v238, s33
    v_fmac_f32 v131, v239, v239
    v_mfma_f32_16x16x32_bf16 v[158:161], v[102:105], v[198:201], v[158:161]
    v_fmac_f32 v131, v240, v240
    v_fmac_f32 v131, v241, v241
    v_mfma_f32_16x16x32_bf16 v[158:161], v[106:109], v[210:213], v[158:161]
    v_fmac_f32 v131, v150, v150
    v_fmac_f32 v131, v151, v151
    v_mfma_f32_16x16x32_bf16 v[158:161], v[110:113], v[218:221], v[158:161]
    v_fmac_f32 v131, v152, v152
    v_fmac_f32 v131, v153, v153
    v_mfma_f32_16x16x32_bf16 v[134:137], a[0:3], v[162:165], 0
    v_fma_f32 v140, v122, v122, s33
    v_fmac_f32 v140, v123, v123
    v_mfma_f32_16x16x32_bf16 v[134:137], a[4:7], v[166:169], v[134:137]
    v_fmac_f32 v140, v124, v124
    v_fmac_f32 v140, v125, v125
    v_mfma_f32_16x16x32_bf16 v[134:137], a[8:11], v[194:197], v[134:137]
    v_fmac_f32 v131, v158, v158
    v_fmac_f32 v131, v159, v159
    v_mfma_f32_16x16x32_bf16 v[134:137], a[12:15], v[214:217], v[134:137]
    v_fmac_f32 v131, v160, v160
    v_fmac_f32 v131, v161, v161
    v_mfma_f32_16x16x32_bf16 v[134:137], a[16:19], v[230:233], v[134:137]
    buffer_store_dwordx2 v[148:149], v19, s[52:55], 0 offen nt
    v_cvt_pk_bf16_f32 v141, v131, v131
    v_fmac_f32 v140, v206, v206
    v_mfma_f32_16x16x32_bf16 v[134:137], a[20:23], v[182:185], v[134:137]
    v_fmac_f32 v140, v207, v207
    v_fmac_f32 v140, v208, v208
    v_mfma_f32_16x16x32_bf16 v[154:157], a[24:27], v[162:165], 0
    v_fmac_f32 v140, v209, v209
    v_fmac_f32 v140, v174, v174
    v_mfma_f32_16x16x32_bf16 v[154:157], a[28:31], v[166:169], v[154:157]
    v_fmac_f32 v140, v175, v175
    v_fmac_f32 v140, v176, v176
    v_mfma_f32_16x16x32_bf16 v[154:157], a[32:35], v[194:197], v[154:157]
    v_fmac_f32 v140, v177, v177
    v_cvt_pk_bf16_f32 v140, v140, v131
    v_mfma_f32_16x16x32_bf16 v[154:157], a[36:39], v[214:217], v[154:157]
    ds_write_b64 v235, v[140:141] offset:2048
    v_mfma_f32_16x16x32_bf16 v[154:157], a[40:43], v[230:233], v[154:157]
    v_fma_f32 v131, v134, v134, s32
    v_fmac_f32 v131, v135, v135
    v_mfma_f32_16x16x32_bf16 v[154:157], a[44:47], v[182:185], v[154:157]
    v_fmac_f32 v131, v136, v136
    v_fmac_f32 v131, v137, v137
    v_mfma_f32_16x16x32_bf16 v[186:189], a[48:51], v[162:165], 0
    v_fma_f32 v140, v250, v250, s32
    v_fmac_f32 v140, v251, v251
    v_mfma_f32_16x16x32_bf16 v[186:189], a[52:55], v[166:169], v[186:189]
    v_fmac_f32 v140, v252, v252
    v_fmac_f32 v140, v253, v253
    v_mfma_f32_16x16x32_bf16 v[186:189], a[56:59], v[194:197], v[186:189]
    v_fmac_f32 v131, v154, v154
    v_fmac_f32 v131, v155, v155
    v_mfma_f32_16x16x32_bf16 v[186:189], a[60:63], v[214:217], v[186:189]
    v_fmac_f32 v131, v156, v156
    v_fmac_f32 v131, v157, v157
    v_mfma_f32_16x16x32_bf16 v[186:189], a[64:67], v[230:233], v[186:189]
    s_waitcnt lgkmcnt(0)
    v_fmac_f32 v140, v226, v226
    v_fmac_f32 v140, v227, v227
    v_mfma_f32_16x16x32_bf16 v[186:189], a[68:71], v[182:185], v[186:189]
    s_barrier
    ds_read_b128 v[190:193], v234 offset:2048
    ds_read_b128 v[198:201], v234 offset:3072
    v_mfma_f32_16x16x32_bf16 v[202:205], v[162:165], a[144:147], 0
    v_fmac_f32 v140, v228, v228
    v_fmac_f32 v140, v229, v229
    v_mfma_f32_16x16x32_bf16 v[202:205], v[166:169], a[148:151], v[202:205]
    v_fmac_f32 v140, v178, v178
    v_fmac_f32 v131, v186, v186
    v_mfma_f32_16x16x32_bf16 v[202:205], v[194:197], a[152:155], v[202:205]
    buffer_store_dwordx2 v[120:121], v18, s[48:51], 0 offen nt
    v_fmac_f32 v131, v187, v187
    v_fmac_f32 v131, v188, v188
    v_mfma_f32_16x16x32_bf16 v[202:205], v[214:217], a[156:159], v[202:205]
    v_fmac_f32 v131, v189, v189
    v_fmac_f32 v140, v179, v179
    v_mfma_f32_16x16x32_bf16 v[202:205], v[230:233], a[160:163], v[202:205]
    v_fmac_f32 v140, v180, v180
    v_fmac_f32 v140, v181, v181
    v_mfma_f32_16x16x32_bf16 v[202:205], v[182:185], a[164:167], v[202:205]
    ds_read_b128 v[210:213], v0 offset:32768
    v_cvt_pk_bf16_f32 v36, v131, v140
    v_mfma_f32_16x16x32_bf16 v[218:221], v[162:165], a[168:171], 0
    s_waitcnt lgkmcnt(2)
    v_xor_b32 v131, 65536, v2
    v_bfe_u32 v120, v132, 1, 2
    v_mfma_f32_16x16x32_bf16 v[218:221], v[166:169], a[172:175], v[218:221]
    s_waitcnt lgkmcnt(1)
    v_cvt_pk_bf16_f32 v172, v202, v203
    v_cvt_pk_bf16_f32 v173, v204, v205
    v_mfma_f32_16x16x32_bf16 v[218:221], v[194:197], a[176:179], v[218:221]
    v_xor_b32 v120, v120, v255
    v_lshl_add_u32 v120, v132, 2, v120
    v_mfma_f32_16x16x32_bf16 v[218:221], v[214:217], a[180:183], v[218:221]
    v_lshl_add_u32 v140, v120, 4, s5
    v_lshl_add_u32 v141, v120, 3, s5
    v_mfma_f32_16x16x32_bf16 v[218:221], v[230:233], a[184:187], v[218:221]
    v_lshl_add_u32 v202, v254, 4, s5
    v_lshl_add_u32 v254, v254, 3, s5
    v_mfma_f32_16x16x32_bf16 v[218:221], v[182:185], a[188:191], v[218:221]
    v_lshlrev_b32 v120, 2, v120
    ds_permute_b32 v203, v120, v16
    ds_permute_b32 v204, v120, v19
    ds_permute_b32 v205, v120, v17
    ds_permute_b32 v222, v120, v20
    v_subrev_u32 v148, 0x3d800000, v44
    v_sub_u32 v149, 0x4a000000, v45
    v_or3_b32 v148, v148, v149, v45
    v_cvt_pk_bf16_f32 v120, v218, v219
    v_cvt_pk_bf16_f32 v121, v220, v221
    v_lshl_add_u32 v149, s16, 2, v131
    ds_write_b32 v149, v148 offset:18432
    v_add_u32 v132, 16, v132
    v_mul_u32_u24 v148, s20, v132
    v_add_u32 v148, s38, v148
    v_mul_u32_u24 v148, 911, v148
    v_lshrrev_b32 v148, 16, v148
    v_mul_u32_u24 v148, s22, v148
    v_mad_u32_u24 v148, v132, s21, v148
    v_cmp_gt_u32 vcc, s17, v132
    buffer_store_dwordx4 v[142:145], v15, s[52:55], 0 offen nt
    v_add_u32 v132, s7, v148
    v_cndmask_b32 v132, v236, v132, vcc
    v_lshl_add_u32 v236, v255, 4, v132
    v_add_u32 v236, s3, v236
    v_lshl_add_u32 v255, v255, 3, v132
    v_mfma_f32_16x16x32_bf16 v[142:145], v[32:35], v[36:39], 0
    v_add_u32 v255, s4, v255
    s_nop 0
    s_nop 0
    s_nop 0
    s_nop 0
    s_nop 0
    s_nop 0
    s_nop 0
    v_rsq_f32 v143, v143
    v_rsq_f32 v142, v142
    v_mul_f32 v250, v143, v250
    v_mul_f32 v142, s31, v142
    v_mul_f32 v251, v143, v251
    v_cvt_pk_f16_f32 v218, v250, v251
    v_mul_f32 v252, v143, v252
    v_mul_f32 v253, v143, v253
    v_cvt_pk_f16_f32 v219, v252, v253
    v_mfma_f32_16x16x32_bf16 v[246:249], v[32:35], v[190:193], 0
    s_waitcnt lgkmcnt(0)
    ds_read_b128 v[190:193], v1 offset:32768
    v_mul_f32 v226, v143, v226
    v_mfma_f32_16x16x32_bf16 v[246:249], v[32:35], v[198:201], v[246:249]
    ds_read_b128 v[198:201], v0 offset:32896
    v_mul_f32 v227, v143, v227
    v_cvt_pk_f16_f32 v220, v226, v227
    v_mul_f32 v228, v143, v228
    v_mul_f32 v229, v143, v229
    v_cvt_pk_f16_f32 v221, v228, v229
    v_mfma_f32_16x16x32_bf16 v[226:229], v[162:165], a[192:195], 0
    ds_read_b128 v[162:165], v1 offset:32896
    v_mul_f32 v132, 0x3baaaaab, v247
    v_mfma_f32_16x16x32_bf16 v[226:229], v[166:169], a[196:199], v[226:229]
    ds_read_b128 v[166:169], v0 offset:33024
    v_mul_f32 v178, v143, v178
    v_mfma_f32_16x16x32_bf16 v[226:229], v[194:197], a[200:203], v[226:229]
    ds_read_b128 v[194:197], v1 offset:33024
    v_mul_f32 v179, v143, v179
    v_mfma_f32_16x16x32_bf16 v[226:229], v[214:217], a[204:207], v[226:229]
    v_rsq_f32 v132, v132
    v_mfma_f32_16x16x32_bf16 v[226:229], v[230:233], a[208:211], v[226:229]
    v_mul_f32 v238, v132, v238
    v_mul_f32 v239, v132, v239
    v_mfma_f32_16x16x32_bf16 v[226:229], v[182:185], a[212:215], v[226:229]
    s_waitcnt lgkmcnt(4)
    v_cvt_pk_bf16_f32 v182, v238, v239
    v_mul_f32 v240, v132, v240
    v_mfma_f32_16x16x32_bf16 v[214:217], a[72:75], v[210:213], 0
    s_waitcnt lgkmcnt(3)
    buffer_store_dwordx2 v[138:139], v18, s[52:55], 0 offen nt
    v_mul_f32 v241, v132, v241
    v_cvt_pk_bf16_f32 v183, v240, v241
    v_mfma_f32_16x16x32_bf16 v[214:217], a[76:79], v[190:193], v[214:217]
    s_waitcnt lgkmcnt(2)
    v_mul_f32 v150, v132, v150
    v_mul_f32 v151, v132, v151
    v_mfma_f32_16x16x32_bf16 v[214:217], a[80:83], v[198:201], v[214:217]
    s_waitcnt lgkmcnt(1)
    v_cvt_pk_bf16_f32 v184, v150, v151
    v_mul_f32 v152, v132, v152
    v_mfma_f32_16x16x32_bf16 v[214:217], a[84:87], v[162:165], v[214:217]
    s_waitcnt lgkmcnt(0)
    v_mul_f32 v153, v132, v153
    v_cvt_pk_bf16_f32 v185, v152, v153
    v_mfma_f32_16x16x32_bf16 v[214:217], a[88:91], v[166:169], v[214:217]
    v_mul_f32 v158, v132, v158
    v_mul_f32 v159, v132, v159
    v_mfma_f32_16x16x32_bf16 v[214:217], a[92:95], v[194:197], v[214:217]
    v_cvt_pk_bf16_f32 v138, v158, v159
    v_mul_f32 v160, v132, v160
    v_mfma_f32_16x16x32_bf16 v[150:153], a[96:99], v[210:213], 0
    v_mul_f32 v161, v132, v161
    v_cvt_pk_bf16_f32 v139, v160, v161
    v_mfma_f32_16x16x32_bf16 v[150:153], a[100:103], v[190:193], v[150:153]
    v_cvt_pk_bf16_f32 v148, v226, v227
    v_cvt_pk_bf16_f32 v149, v228, v229
    v_mfma_f32_16x16x32_bf16 v[150:153], a[104:107], v[198:201], v[150:153]
    v_cvt_pk_f16_f32 v160, v178, v179
    v_mul_f32 v180, v143, v180
    v_mfma_f32_16x16x32_bf16 v[150:153], a[108:111], v[162:165], v[150:153]
    v_mul_f32 v181, v143, v181
    v_cvt_pk_f16_f32 v161, v180, v181
    v_mfma_f32_16x16x32_bf16 v[150:153], a[112:115], v[166:169], v[150:153]
    v_mul_f32 v134, v142, v134
    v_mul_f32 v135, v142, v135
    v_mfma_f32_16x16x32_bf16 v[150:153], a[116:119], v[194:197], v[150:153]
    v_cvt_pk_f16_f32 v134, v134, v135
    v_mul_f32 v136, v142, v136
    v_mfma_f32_16x16x32_bf16 v[178:181], a[120:123], v[210:213], 0
    v_mul_f32 v137, v142, v137
    v_cvt_pk_f16_f32 v135, v136, v137
    v_mfma_f32_16x16x32_bf16 v[178:181], a[124:127], v[190:193], v[178:181]
    v_mul_f32 v154, v142, v154
    v_mul_f32 v155, v142, v155
    v_mfma_f32_16x16x32_bf16 v[178:181], a[128:131], v[198:201], v[178:181]
    v_cvt_pk_f16_f32 v136, v154, v155
    v_mul_f32 v156, v142, v156
    v_mfma_f32_16x16x32_bf16 v[178:181], a[132:135], v[162:165], v[178:181]
    v_mul_f32 v157, v142, v157
    v_cvt_pk_f16_f32 v137, v156, v157
    v_mfma_f32_16x16x32_bf16 v[178:181], a[136:139], v[166:169], v[178:181]
    buffer_store_dwordx4 v[182:185], v130, s[12:15], 0 offen nt
    v_mul_f32 v186, v142, v186
    v_mul_f32 v187, v142, v187
    v_cvt_pk_f16_f32 v158, v186, v187
    v_mul_f32 v188, v142, v188
    v_mfma_f32_16x16x32_bf16 v[178:181], a[140:143], v[194:197], v[178:181]
    v_mul_f32 v189, v142, v189
    v_cvt_pk_f16_f32 v159, v188, v189
    v_mfma_f32_16x16x32_bf16 v[142:145], a[0:3], v[210:213], 0
    v_mul_f32 v130, 0x3baaaaab, v246
    v_fma_f32 v132, v214, v214, s32
    v_mfma_f32_16x16x32_bf16 v[142:145], a[4:7], v[190:193], v[142:145]
    v_rsq_f32 v130, v130
    v_mfma_f32_16x16x32_bf16 v[142:145], a[8:11], v[198:201], v[142:145]
    v_mul_f32 v122, v130, v122
    v_mul_f32 v123, v130, v123
    v_mfma_f32_16x16x32_bf16 v[142:145], a[12:15], v[162:165], v[142:145]
    v_cvt_pk_bf16_f32 v122, v122, v123
    v_mul_f32 v124, v130, v124
    v_mfma_f32_16x16x32_bf16 v[142:145], a[16:19], v[166:169], v[142:145]
    v_mul_f32 v125, v130, v125
    v_cvt_pk_bf16_f32 v123, v124, v125
    v_mfma_f32_16x16x32_bf16 v[142:145], a[20:23], v[194:197], v[142:145]
    v_mul_f32 v206, v130, v206
    v_mul_f32 v207, v130, v207
    v_mfma_f32_16x16x32_bf16 v[154:157], a[24:27], v[210:213], 0
    v_cvt_pk_bf16_f32 v124, v206, v207
    v_mul_f32 v208, v130, v208
    v_mfma_f32_16x16x32_bf16 v[154:157], a[28:31], v[190:193], v[154:157]
    v_mul_f32 v209, v130, v209
    v_cvt_pk_bf16_f32 v125, v208, v209
    v_mfma_f32_16x16x32_bf16 v[154:157], a[32:35], v[198:201], v[154:157]
    v_mul_f32 v174, v130, v174
    v_mul_f32 v175, v130, v175
    v_mfma_f32_16x16x32_bf16 v[154:157], a[36:39], v[162:165], v[154:157]
    v_cvt_pk_bf16_f32 v224, v174, v175
    v_mul_f32 v176, v130, v176
    v_mfma_f32_16x16x32_bf16 v[154:157], a[40:43], v[166:169], v[154:157]
    v_mul_f32 v177, v130, v177
    v_cvt_pk_bf16_f32 v225, v176, v177
    v_mfma_f32_16x16x32_bf16 v[154:157], a[44:47], v[194:197], v[154:157]
    v_fma_f32 v130, v142, v142, s32
    v_fmac_f32 v130, v143, v143
    v_mfma_f32_16x16x32_bf16 v[174:177], a[48:51], v[210:213], 0
    v_fmac_f32 v130, v144, v144
    v_fmac_f32 v130, v145, v145
    v_mfma_f32_16x16x32_bf16 v[174:177], a[52:55], v[190:193], v[174:177]
    v_fmac_f32 v132, v215, v215
    v_fmac_f32 v132, v216, v216
    v_mfma_f32_16x16x32_bf16 v[174:177], a[56:59], v[198:201], v[174:177]
    ds_read2_b32 v[184:185], v6 offset0:0 offset1:0
    ds_read2_b32 v[188:189], v6 offset0:16 offset1:16
    v_mfma_f32_16x16x32_bf16 v[174:177], a[60:63], v[162:165], v[174:177]
    ds_read2_b32 v[208:209], v6 offset0:32 offset1:32
    buffer_store_dwordx2 v[138:139], v237, s[12:15], 0 offen nt
    v_fmac_f32 v130, v154, v154
    v_fmac_f32 v130, v155, v155
    v_mfma_f32_16x16x32_bf16 v[174:177], a[64:67], v[166:169], v[174:177]
    v_fmac_f32 v130, v156, v156
    v_fmac_f32 v130, v157, v157
    v_mfma_f32_16x16x32_bf16 v[174:177], a[68:71], v[194:197], v[174:177]
    v_fmac_f32 v132, v217, v217
    v_fmac_f32 v132, v150, v150
    v_mfma_f32_16x16x32_bf16 v[226:229], v[210:213], a[144:147], 0
    v_fmac_f32 v132, v151, v151
    v_fmac_f32 v132, v152, v152
    v_mfma_f32_16x16x32_bf16 v[226:229], v[190:193], a[148:151], v[226:229]
    v_fmac_f32 v132, v153, v153
    v_fmac_f32 v132, v178, v178
    v_mfma_f32_16x16x32_bf16 v[226:229], v[198:201], a[152:155], v[226:229]
    v_fmac_f32 v130, v174, v174
    v_fmac_f32 v130, v175, v175
    v_mfma_f32_16x16x32_bf16 v[226:229], v[162:165], a[156:159], v[226:229]
    s_waitcnt lgkmcnt(1)
    v_fmac_f32 v130, v176, v176
    v_fmac_f32 v130, v177, v177
    v_mfma_f32_16x16x32_bf16 v[226:229], v[166:169], a[160:163], v[226:229]
    s_waitcnt lgkmcnt(0)
    v_fmac_f32 v132, v179, v179
    v_fmac_f32 v132, v180, v180
    v_mfma_f32_16x16x32_bf16 v[226:229], v[194:197], a[164:167], v[226:229]
    v_fmac_f32 v132, v181, v181
    v_cvt_pk_bf16_f32 v36, v130, v132
    v_mfma_f32_16x16x32_bf16 v[230:233], v[210:213], a[168:171], 0
    v_mfma_f32_16x16x32_bf16 v[230:233], v[190:193], a[172:175], v[230:233]
    v_mfma_f32_16x16x32_bf16 v[238:241], v[32:35], v[36:39], 0
    v_mfma_f32_16x16x32_bf16 v[230:233], v[198:201], a[176:179], v[230:233]
    v_mfma_f32_16x16x32_bf16 v[230:233], v[162:165], a[180:183], v[230:233]
    v_mfma_f32_16x16x32_bf16 v[230:233], v[166:169], a[184:187], v[230:233]
    v_cvt_pk_bf16_f32 v182, v226, v227
    v_cvt_pk_bf16_f32 v183, v228, v229
    v_mfma_f32_16x16x32_bf16 v[230:233], v[194:197], a[188:191], v[230:233]
    v_mfma_f32_16x16x32_bf16 v[226:229], v[210:213], a[192:195], 0
    buffer_store_dwordx4 v[122:125], v17, s[52:55], 0 offen nt
    v_rsq_f32 v239, v239
    v_rsq_f32 v238, v238
    v_mfma_f32_16x16x32_bf16 v[226:229], v[190:193], a[196:199], v[226:229]
    v_mul_f32 v238, s31, v238
    v_mul_f32 v214, v239, v214
    v_mfma_f32_16x16x32_bf16 v[226:229], v[198:201], a[200:203], v[226:229]
    v_cvt_pk_bf16_f32 v186, v230, v231
    v_cvt_pk_bf16_f32 v187, v232, v233
    v_mfma_f32_16x16x32_bf16 v[226:229], v[162:165], a[204:207], v[226:229]
    v_mul_f32 v215, v239, v215
    v_cvt_pk_f16_f32 v122, v214, v215
    v_mfma_f32_16x16x32_bf16 v[226:229], v[166:169], a[208:211], v[226:229]
    ds_read_b128 v[162:165], v5 offset:0
    ds_read_b128 v[166:169], v5 offset:16
    v_mfma_f32_16x16x32_f16 v[190:193], v[114:117], v[126:129], v[46:49]
    ds_read_b128 v[198:201], v5 offset:48
    ds_read_b32 v237, v6 offset:192
    v_mfma_f32_16x16x32_f16 v[210:213], v[218:221], v[126:129], v[50:53]
    v_mul_f32 v216, v239, v216
    v_mul_f32 v217, v239, v217
    v_mfma_f32_16x16x32_bf16 v[226:229], v[194:197], a[212:215], v[226:229]
    v_cvt_pk_f16_f32 v123, v216, v217
    v_mul_f32 v150, v239, v150
    v_mul_f32 v151, v239, v151
    v_mfma_f32_16x16x16_f16 v[190:193], v[244:245], v[242:243], v[190:193]
    v_cvt_pk_f16_f32 v124, v150, v151
    v_mul_f32 v152, v239, v152
    v_mul_f32 v153, v239, v153
    v_mfma_f32_16x16x16_f16 v[210:213], v[160:161], v[242:243], v[210:213]
    v_cvt_pk_bf16_f32 v206, v226, v227
    v_cvt_pk_bf16_f32 v207, v228, v229
    v_cvt_pk_f16_f32 v125, v152, v153
    v_mul_f32 v178, v239, v178
    v_mul_f32 v179, v239, v179
    v_mfma_f32_16x16x32_f16 v[150:153], v[122:125], v[126:129], v[54:57]
    v_cvt_pk_f16_f32 v196, v178, v179
    s_waitcnt lgkmcnt(3)
    v_mfma_f32_16x16x32_f16 v[214:217], v[162:165], v[126:129], v[22:25]
    s_waitcnt lgkmcnt(2)
    v_mul_f32 v180, v239, v180
    v_mul_f32 v181, v239, v181
    v_mfma_f32_16x16x32_f16 v[214:217], v[166:169], v[114:117], v[214:217]
    s_waitcnt lgkmcnt(0)
    v_cvt_pk_f16_f32 v197, v180, v181
    v_mul_f32 v142, v238, v142
    v_mfma_f32_16x16x32_f16 v[214:217], v[198:201], v[242:245], v[214:217]
    v_mul_f32 v143, v238, v143
    v_cvt_pk_f16_f32 v126, v142, v143
    v_mfma_f32_16x16x32_f16 v[178:181], v[162:165], v[134:137], v[24:27]
    v_mul_f32 v144, v238, v144
    v_mul_f32 v145, v238, v145
    v_mfma_f32_16x16x32_f16 v[178:181], v[166:169], v[218:221], v[178:181]
    buffer_store_dwordx2 v[224:225], v20, s[52:55], 0 offen nt
    v_cvt_pk_f16_f32 v127, v144, v145
    v_mov_b32_dpp v237, v215 quad_perm:[0,1,2,3] row_mask:0x1 bank_mask:0xf
    v_mfma_f32_16x16x32_f16 v[178:181], v[198:201], v[158:161], v[178:181]
    v_mul_f32 v154, v238, v154
    v_mul_f32 v155, v238, v155
    v_cvt_pk_f16_f32 v128, v154, v155
    v_mfma_f32_16x16x16_f16 v[150:153], v[196:197], v[242:243], v[150:153]
    v_mul_f32 v156, v238, v156
    v_mul_f32 v157, v238, v157
    v_cvt_pk_f16_f32 v129, v156, v157
    v_mul_f32 v174, v238, v174
    v_mov_b32_dpp v237, v179 quad_perm:[0,1,2,3] row_mask:0x2 bank_mask:0xf
    v_mfma_f32_16x16x32_f16 v[142:145], v[162:165], v[126:129], v[26:29]
    v_mul_f32 v175, v238, v175
    v_cvt_pk_f16_f32 v194, v174, v175
    v_mfma_f32_16x16x32_f16 v[142:145], v[166:169], v[122:125], v[142:145]
    v_mul_f32 v176, v238, v176
    v_mul_f32 v177, v238, v177
    v_cvt_pk_f16_f32 v195, v176, v177
    v_max3_f32 v130, v214, v190, v191
    v_max3_f32 v130, v130, v192, v193
    v_mfma_f32_16x16x32_f16 v[142:145], v[198:201], v[194:197], v[142:145]
    v_max3_f32 v130, v130, v210, v211
    v_max3_f32 v130, v130, v212, v213
    v_max3_f32 v130, v130, v150, v151
    v_max3_f32 v130, v130, v152, v153
    v_mov_b32 v132, v130
    s_nop 0
    s_nop 0
    v_permlane32_swap_b32 v130, v132
    v_mov_b32_dpp v237, v143 quad_perm:[0,1,2,3] row_mask:0x4 bank_mask:0xf
    v_mov_b32 v138, v237
    v_max_f32 v130, v130, v132
    v_mov_b32 v132, v130
    v_max_f32_dpp v138, v138, v138 quad_perm:[1,0,3,2] row_mask:0xf bank_mask:0xf
    s_nop 0
    v_permlane16_swap_b32 v130, v132
    v_max_f32_dpp v138, v138, v138 quad_perm:[2,3,0,1] row_mask:0xf bank_mask:0xf
    v_max_f32 v130, v130, v132
    v_sub_f32 v190, v190, v130
    v_max_f32_dpp v138, v138, v138 row_half_mirror row_mask:0xf bank_mask:0xf
    v_exp_f32 v190, v190
    v_sub_f32 v191, v191, v130
    v_max_f32_dpp v138, v138, v138 row_mirror row_mask:0xf bank_mask:0xf
    v_mov_b32 v132, v138
    v_exp_f32 v191, v191
    v_sub_f32 v192, v192, v130
    v_permlane32_swap_b32 v138, v132
    v_max_f32 v138, v138, v132
    v_mov_b32 v132, v138
    v_cvt_pk_bf16_f32 v154, v190, v191
    v_exp_f32 v192, v192
    v_permlane16_swap_b32 v138, v132
    v_max_f32 v138, v138, v132
    v_sub_f32 v237, v237, v138
    v_exp_f32 v237, v237
    v_sub_f32 v193, v193, v130
    v_cvt_pk_bf16_f32 v237, v237, v237
    ds_write_b16 v8, v237
    v_exp_f32 v193, v193
    v_sub_f32 v210, v210, v130
    v_cvt_pk_bf16_f32 v155, v192, v193
    v_exp_f32 v210, v210
    v_sub_f32 v211, v211, v130
    v_exp_f32 v211, v211
    v_sub_f32 v212, v212, v130
    v_cvt_pk_bf16_f32 v156, v210, v211
    v_exp_f32 v212, v212
    v_sub_f32 v213, v213, v130
    v_exp_f32 v213, v213
    v_sub_f32 v150, v150, v130
    v_cvt_pk_bf16_f32 v157, v212, v213
    v_exp_f32 v150, v150
    v_sub_f32 v151, v151, v130
    v_exp_f32 v151, v151
    v_mfma_f32_16x16x32_f16 v[162:165], v[114:117], v[134:137], v[58:61]
    v_cvt_pk_bf16_f32 v36, v150, v151
    v_sub_f32 v152, v152, v130
    v_mfma_f32_16x16x32_f16 v[166:169], v[218:221], v[134:137], v[62:65]
    v_exp_f32 v152, v152
    v_mfma_f32_16x16x32_f16 v[174:177], v[122:125], v[134:137], v[66:69]
    v_sub_f32 v153, v153, v130
    v_exp_f32 v153, v153
    v_mfma_f32_16x16x16_f16 v[162:165], v[244:245], v[158:159], v[162:165]
    v_cvt_pk_bf16_f32 v37, v152, v153
    v_sub_f32 v214, v214, v130
    v_mfma_f32_16x16x16_f16 v[166:169], v[160:161], v[158:159], v[166:169]
    v_exp_f32 v214, v214
    v_mfma_f32_16x16x16_f16 v[174:177], v[196:197], v[158:159], v[174:177]
    v_cvt_pk_bf16_f32 v39, v214, 0
    s_nop 0
    s_nop 0
    v_max3_f32 v237, v178, v162, v163
    v_mfma_f32_16x16x32_bf16 v[134:137], v[28:31], v[36:39], 0
    v_max3_f32 v237, v237, v164, v165
    v_max3_f32 v237, v237, v166, v167
    v_mfma_f32_16x16x32_bf16 v[134:137], v[28:31], v[154:157], v[134:137]
    v_max3_f32 v237, v237, v168, v169
    v_max3_f32 v237, v237, v174, v175
    v_mfma_f32_16x16x32_bf16 v[150:153], v[182:185], v[36:39], 0
    v_max3_f32 v237, v237, v176, v177
    v_mov_b32 v130, v237
    v_mfma_f32_16x16x32_bf16 v[150:153], v[170:173], v[154:157], v[150:153]
    v_mfma_f32_16x16x32_bf16 v[190:193], v[186:189], v[36:39], 0
    v_permlane32_swap_b32 v237, v130
    v_mfma_f32_16x16x32_bf16 v[190:193], v[118:121], v[154:157], v[190:193]
    v_rcp_f32 v134, v134
    v_mfma_f32_16x16x32_bf16 v[198:201], v[206:209], v[36:39], 0
    v_max_f32 v237, v237, v130
    v_mov_b32 v130, v237
    v_mfma_f32_16x16x32_bf16 v[198:201], v[146:149], v[154:157], v[198:201]
    v_mul_f32 v150, v134, v150
    v_mul_f32 v151, v134, v151
    v_cvt_pk_bf16_f32 v150, v150, v151
    v_mul_f32 v152, v134, v152
    v_mul_f32 v153, v134, v153
    v_cvt_pk_bf16_f32 v151, v152, v153
    v_mul_f32 v190, v134, v190
    v_mul_f32 v191, v134, v191
    v_cvt_pk_bf16_f32 v152, v190, v191
    v_mul_f32 v192, v134, v192
    v_mul_f32 v193, v134, v193
    v_cvt_pk_bf16_f32 v153, v192, v193
    ds_write_b128 v3, v[150:153] offset:0
    v_mul_f32 v198, v134, v198
    v_mul_f32 v199, v134, v199
    v_cvt_pk_bf16_f32 v138, v198, v199
    v_mul_f32 v200, v134, v200
    v_mul_f32 v201, v134, v201
    v_cvt_pk_bf16_f32 v139, v200, v201
    v_permlane16_swap_b32 v237, v130
    ds_write_b64 v4, v[138:139] offset:4096
    v_max_f32 v237, v237, v130
    v_sub_f32 v162, v162, v237
    v_exp_f32 v162, v162
    v_mfma_f32_16x16x32_f16 v[134:137], v[114:117], v[126:129], v[70:73]
    v_sub_f32 v163, v163, v237
    v_sub_f32 v164, v164, v237
    v_mfma_f32_16x16x32_f16 v[114:117], v[218:221], v[126:129], v[74:77]
    v_exp_f32 v163, v163
    v_mfma_f32_16x16x32_f16 v[150:153], v[122:125], v[126:129], v[78:81]
    v_cvt_pk_bf16_f32 v122, v162, v163
    v_exp_f32 v164, v164
    v_mfma_f32_16x16x16_f16 v[134:137], v[244:245], v[194:195], v[134:137]
    v_sub_f32 v165, v165, v237
    v_exp_f32 v165, v165
    v_mfma_f32_16x16x16_f16 v[114:117], v[160:161], v[194:195], v[114:117]
    v_cvt_pk_bf16_f32 v123, v164, v165
    v_sub_f32 v166, v166, v237
    v_sub_f32 v167, v167, v237
    v_mfma_f32_16x16x16_f16 v[150:153], v[196:197], v[194:195], v[150:153]
    s_waitcnt lgkmcnt(0)
    s_barrier
    ds_read_b128 v[126:129], v131 offset:0
    ds_read_b128 v[154:157], v131 offset:1024
    ds_read_b128 v[158:161], v131 offset:2048
    ds_read_b128 v[162:165], v131 offset:3072
    ds_read_b128 v[190:193], v131 offset:4096
    ds_read_b128 v[194:197], v131 offset:5120
    v_exp_f32 v166, v166
    v_exp_f32 v167, v167
    v_sub_f32 v168, v168, v237
    v_cvt_pk_bf16_f32 v124, v166, v167
    v_exp_f32 v168, v168
    v_sub_f32 v169, v169, v237
    v_exp_f32 v169, v169
    v_sub_f32 v174, v174, v237
    v_cvt_pk_bf16_f32 v125, v168, v169
    v_exp_f32 v174, v174
    s_waitcnt lgkmcnt(4)
    v_mfma_f32_16x16x32_bf16 v[166:169], a[216:219], v[126:129], 0
    s_waitcnt lgkmcnt(3)
    v_sub_f32 v175, v175, v237
    v_sub_f32 v176, v176, v237
    v_mfma_f32_16x16x32_bf16 v[166:169], a[220:223], v[154:157], v[166:169]
    s_waitcnt lgkmcnt(2)
    v_exp_f32 v175, v175
    v_mfma_f32_16x16x32_bf16 v[166:169], a[224:227], v[158:161], v[166:169]
    s_waitcnt lgkmcnt(1)
    v_cvt_pk_bf16_f32 v36, v174, v175
    v_sub_f32 v177, v177, v237
    v_mfma_f32_16x16x32_bf16 v[166:169], a[228:231], v[162:165], v[166:169]
    s_waitcnt lgkmcnt(0)
    v_exp_f32 v176, v176
    v_mfma_f32_16x16x32_bf16 v[166:169], a[232:235], v[190:193], v[166:169]
    v_exp_f32 v177, v177
    v_mfma_f32_16x16x32_bf16 v[166:169], a[236:239], v[194:197], v[166:169]
    v_cvt_pk_bf16_f32 v37, v176, v177
    v_sub_f32 v178, v178, v237
    v_mfma_f32_16x16x32_bf16 v[174:177], a[240:243], v[126:129], 0
    v_exp_f32 v178, v178
    v_mfma_f32_16x16x32_bf16 v[174:177], a[244:247], v[154:157], v[174:177]
    v_cvt_pk_bf16_f32 v39, v178, 0
    v_max3_f32 v237, v142, v134, v135
    v_mfma_f32_16x16x32_bf16 v[174:177], a[248:251], v[158:161], v[174:177]
    v_max3_f32 v237, v237, v136, v137
    v_max3_f32 v237, v237, v114, v115
    v_mfma_f32_16x16x32_bf16 v[174:177], a[252:255], v[162:165], v[174:177]
    v_max3_f32 v237, v237, v116, v117
    v_max3_f32 v237, v237, v150, v151
    v_mfma_f32_16x16x32_bf16 v[174:177], v[82:85], v[190:193], v[174:177]
    v_max3_f32 v237, v237, v152, v153
    v_mov_b32 v130, v237
    v_mfma_f32_16x16x32_bf16 v[174:177], v[86:89], v[194:197], v[174:177]
    v_fma_f32 v132, v166, v166, s33
    v_fmac_f32 v132, v167, v167
    v_mfma_f32_16x16x32_bf16 v[178:181], v[90:93], v[126:129], 0
    v_permlane32_swap_b32 v237, v130
    v_mfma_f32_16x16x32_bf16 v[178:181], v[94:97], v[154:157], v[178:181]
    v_max_f32 v237, v237, v130
    v_mov_b32 v130, v237
    v_mfma_f32_16x16x32_bf16 v[178:181], v[98:101], v[158:161], v[178:181]
    v_fmac_f32 v132, v168, v168
    v_fmac_f32 v132, v169, v169
    v_mfma_f32_16x16x32_bf16 v[178:181], v[102:105], v[162:165], v[178:181]
    v_permlane16_swap_b32 v237, v130
    v_mfma_f32_16x16x32_bf16 v[178:181], v[106:109], v[190:193], v[178:181]
    v_max_f32 v237, v237, v130
    v_sub_f32 v134, v134, v237
    v_mfma_f32_16x16x32_bf16 v[178:181], v[110:113], v[194:197], v[178:181]
    v_exp_f32 v134, v134
    v_mfma_f32_16x16x32_bf16 v[126:129], v[28:31], v[36:39], 0
    v_sub_f32 v135, v135, v237
    v_sub_f32 v136, v136, v237
    v_mfma_f32_16x16x32_bf16 v[126:129], v[28:31], v[122:125], v[126:129]
    v_exp_f32 v135, v135
    v_mfma_f32_16x16x32_bf16 v[154:157], v[182:185], v[36:39], 0
    v_cvt_pk_bf16_f32 v134, v134, v135
    v_sub_f32 v137, v137, v237
    v_mfma_f32_16x16x32_bf16 v[154:157], v[170:173], v[122:125], v[154:157]
    v_exp_f32 v136, v136
    v_mfma_f32_16x16x32_bf16 v[158:161], v[186:189], v[36:39], 0
    v_exp_f32 v137, v137
    v_mfma_f32_16x16x32_bf16 v[158:161], v[118:121], v[122:125], v[158:161]
    ds_read_b128 v[162:165], v9
    ds_read_b128 v[190:193], v9 offset:64
    v_mfma_f32_16x16x32_bf16 v[194:197], v[206:209], v[36:39], 0
    v_cvt_pk_bf16_f32 v135, v136, v137
    v_sub_f32 v114, v114, v237
    v_mfma_f32_16x16x32_bf16 v[194:197], v[146:149], v[122:125], v[194:197]
    v_exp_f32 v114, v114
    v_sub_f32 v115, v115, v237
    v_exp_f32 v115, v115
    v_sub_f32 v116, v116, v237
    v_cvt_pk_bf16_f32 v136, v114, v115
    v_exp_f32 v116, v116
    v_sub_f32 v117, v117, v237
    v_exp_f32 v117, v117
    v_sub_f32 v150, v150, v237
    v_cvt_pk_bf16_f32 v137, v116, v117
    v_exp_f32 v150, v150
    v_sub_f32 v151, v151, v237
    v_exp_f32 v151, v151
    v_sub_f32 v152, v152, v237
    s_waitcnt lgkmcnt(1)
    v_mfma_f32_16x16x32_bf16 v[114:117], v[162:165], v[28:31], 0
    s_waitcnt lgkmcnt(0)
    v_cvt_pk_bf16_f32 v36, v150, v151
    v_sub_f32 v153, v153, v237
    v_mfma_f32_16x16x32_bf16 v[114:117], v[190:193], v[28:31], v[114:117]
    v_exp_f32 v152, v152
    v_mfma_f32_16x16x32_bf16 v[122:125], v[162:165], v[170:173], 0
    v_exp_f32 v153, v153
    v_mfma_f32_16x16x32_bf16 v[122:125], v[190:193], v[182:185], v[122:125]
    v_cvt_pk_bf16_f32 v37, v152, v153
    v_sub_f32 v142, v142, v237
    v_mfma_f32_16x16x32_bf16 v[150:153], v[162:165], v[118:121], 0
    v_exp_f32 v142, v142
    v_mfma_f32_16x16x32_bf16 v[150:153], v[190:193], v[186:189], v[150:153]
    v_cvt_pk_bf16_f32 v39, v142, 0
    v_fmac_f32 v132, v174, v174
    v_mfma_f32_16x16x32_bf16 v[142:145], v[162:165], v[146:149], 0
    v_rcp_f32 v126, v126
    v_mfma_f32_16x16x32_bf16 v[142:145], v[190:193], v[206:209], v[142:145]
    v_fmac_f32 v132, v175, v175
    v_fmac_f32 v132, v176, v176
    v_mfma_f32_16x16x32_bf16 v[162:165], v[28:31], v[36:39], 0
    v_fmac_f32 v132, v177, v177
    v_fmac_f32 v132, v178, v178
    v_mfma_f32_16x16x32_bf16 v[162:165], v[28:31], v[134:137], v[162:165]
    v_fmac_f32 v132, v179, v179
    v_fmac_f32 v132, v180, v180
    v_mfma_f32_16x16x32_bf16 v[190:193], v[182:185], v[36:39], 0
    v_fmac_f32 v132, v181, v181
    v_cvt_pk_bf16_f32 v138, v132, v132
    v_mfma_f32_16x16x32_bf16 v[190:193], v[170:173], v[134:137], v[190:193]
    v_cvt_pk_bf16_f32 v139, v132, v132
    v_mul_f32 v154, v126, v154
    v_mfma_f32_16x16x32_bf16 v[170:173], v[186:189], v[36:39], 0
    ds_write_b64 v235, v[138:139] offset:4096
    v_mfma_f32_16x16x32_bf16 v[170:173], v[118:121], v[134:137], v[170:173]
    v_rcp_f32 v162, v162
    v_mfma_f32_16x16x32_bf16 v[118:121], v[206:209], v[36:39], 0
    v_mul_f32 v155, v126, v155
    v_mul_f32 v190, v162, v190
    v_mfma_f32_16x16x32_bf16 v[118:121], v[146:149], v[134:137], v[118:121]
    v_mul_f32 v191, v162, v191
    v_cvt_pk_bf16_f32 v134, v190, v191
    v_mul_f32 v192, v162, v192
    v_mul_f32 v193, v162, v193
    v_cvt_pk_bf16_f32 v135, v192, v193
    v_mul_f32 v170, v162, v170
    v_mul_f32 v171, v162, v171
    v_cvt_pk_bf16_f32 v136, v170, v171
    v_mul_f32 v172, v162, v172
    v_mul_f32 v173, v162, v173
    v_cvt_pk_bf16_f32 v137, v172, v173
    ds_write_b128 v3, v[134:137] offset:12288
    v_mul_f32 v118, v162, v118
    v_mul_f32 v119, v162, v119
    v_cvt_pk_bf16_f32 v138, v118, v119
    v_mul_f32 v120, v162, v120
    v_mul_f32 v121, v162, v121
    v_cvt_pk_bf16_f32 v139, v120, v121
    v_cvt_pk_bf16_f32 v118, v154, v155
    ds_write_b64 v4, v[138:139] offset:16384
    v_mul_f32 v156, v126, v156
    v_mul_f32 v157, v126, v157
    v_cvt_pk_bf16_f32 v119, v156, v157
    v_mul_f32 v158, v126, v158
    v_mul_f32 v159, v126, v159
    v_cvt_pk_bf16_f32 v120, v158, v159
    v_mul_f32 v160, v126, v160
    v_mul_f32 v161, v126, v161
    v_cvt_pk_bf16_f32 v121, v160, v161
    ds_write_b128 v3, v[118:121] offset:6144
    v_mul_f32 v194, v126, v194
    v_mul_f32 v195, v126, v195
    v_cvt_pk_bf16_f32 v138, v194, v195
    v_mul_f32 v196, v126, v196
    v_mul_f32 v197, v126, v197
    v_cvt_pk_bf16_f32 v139, v196, v197
    v_rcp_f32 v114, v114
    ds_write_b64 v4, v[138:139] offset:10240
    v_mul_f32 v122, v122, v114
    v_mul_f32_dpp v122, v150, v114 quad_perm:[0,1,2,3] row_mask:0x2 bank_mask:0xf
    v_mul_f32_dpp v122, v142, v114 quad_perm:[0,1,2,3] row_mask:0x4 bank_mask:0xf
    v_cvt_pk_bf16_f32 v122, v122, v122
    ds_write_b16 v7, v122
    s_waitcnt lgkmcnt(0)
    s_barrier
    ds_read_b128 v[114:117], v234 offset:4096
    ds_read_b128 v[118:121], v234 offset:5120
    ds_read_b128 v[122:125], v131 offset:6144
    ds_read_b128 v[126:129], v131 offset:7168
    ds_read_b128 v[134:137], v131 offset:8192
    ds_read_b128 v[142:145], v131 offset:9216
    ds_read_b128 v[146:149], v131 offset:10240
    ds_read_b128 v[150:153], v131 offset:11264
    s_waitcnt lgkmcnt(7)
    v_mfma_f32_16x16x32_bf16 v[154:157], v[32:35], v[114:117], 0
    s_waitcnt lgkmcnt(6)
    v_mfma_f32_16x16x32_bf16 v[154:157], v[32:35], v[118:121], v[154:157]
    s_waitcnt lgkmcnt(4)
    v_mfma_f32_16x16x32_bf16 v[114:117], a[216:219], v[122:125], 0
    s_waitcnt lgkmcnt(3)
    v_mfma_f32_16x16x32_bf16 v[114:117], a[220:223], v[126:129], v[114:117]
    s_waitcnt lgkmcnt(2)
    v_mfma_f32_16x16x32_bf16 v[114:117], a[224:227], v[134:137], v[114:117]
    s_waitcnt lgkmcnt(1)
    v_mfma_f32_16x16x32_bf16 v[114:117], a[228:231], v[142:145], v[114:117]
    s_waitcnt lgkmcnt(0)
    v_mul_f32 v237, 0x3baaaaab, v154
    v_mfma_f32_16x16x32_bf16 v[114:117], a[232:235], v[146:149], v[114:117]
    v_rsq_f32 v237, v237
    v_mfma_f32_16x16x32_bf16 v[114:117], a[236:239], v[150:153], v[114:117]
    v_mul_f32 v166, v237, v166
    v_mul_f32 v167, v237, v167
    v_mfma_f32_16x16x32_bf16 v[118:121], a[240:243], v[122:125], 0
    v_cvt_pk_bf16_f32 v154, v166, v167
    v_mul_f32 v168, v237, v168
    v_mfma_f32_16x16x32_bf16 v[118:121], a[244:247], v[126:129], v[118:121]
    v_mul_f32 v169, v237, v169
    v_cvt_pk_bf16_f32 v155, v168, v169
    v_mfma_f32_16x16x32_bf16 v[118:121], a[248:251], v[134:137], v[118:121]
    v_mul_f32 v174, v237, v174
    v_mul_f32 v175, v237, v175
    v_mfma_f32_16x16x32_bf16 v[118:121], a[252:255], v[142:145], v[118:121]
    v_cvt_pk_bf16_f32 v156, v174, v175
    v_mul_f32 v176, v237, v176
    v_mfma_f32_16x16x32_bf16 v[118:121], v[82:85], v[146:149], v[118:121]
    v_mul_f32 v177, v237, v177
    v_cvt_pk_bf16_f32 v157, v176, v177
    v_mfma_f32_16x16x32_bf16 v[118:121], v[86:89], v[150:153], v[118:121]
    buffer_store_dwordx4 v[154:157], v15, s[56:59], 0 offen nt
    v_mul_f32 v178, v237, v178
    v_mul_f32 v179, v237, v179
    v_cvt_pk_bf16_f32 v138, v178, v179
    v_mul_f32 v180, v237, v180
    v_mfma_f32_16x16x32_bf16 v[154:157], v[90:93], v[122:125], 0
    ds_read_b128 v[122:125], v133 offset:256
    v_mul_f32 v181, v237, v181
    v_mfma_f32_16x16x32_bf16 v[154:157], v[94:97], v[126:129], v[154:157]
    ds_read_b128 v[126:129], v133 offset:2304
    v_cvt_pk_bf16_f32 v139, v180, v181
    v_mfma_f32_16x16x32_bf16 v[154:157], v[98:101], v[134:137], v[154:157]
    ds_read_b128 v[134:137], v133 offset:4352
    v_fma_f32 v237, v114, v114, s33
    v_mfma_f32_16x16x32_bf16 v[154:157], v[102:105], v[142:145], v[154:157]
    ds_read_b128 v[142:145], v133 offset:6400
    v_fmac_f32 v237, v115, v115
    v_mfma_f32_16x16x32_bf16 v[154:157], v[106:109], v[146:149], v[154:157]
    ds_read_b128 v[146:149], v133 offset:8448
    v_fmac_f32 v237, v116, v116
    v_mfma_f32_16x16x32_bf16 v[154:157], v[110:113], v[150:153], v[154:157]
    ds_read_b128 v[150:153], v133 offset:10496
    v_fmac_f32 v237, v117, v117
    v_fmac_f32 v237, v118, v118
    v_fmac_f32 v237, v119, v119
    v_fmac_f32 v237, v120, v120
    v_fmac_f32 v237, v121, v121
    s_nop 0
    s_nop 0
    s_waitcnt lgkmcnt(5)
    v_mfma_f32_16x16x32_bf16 v[158:161], a[216:219], v[122:125], 0
    v_fmac_f32 v237, v154, v154
    v_fmac_f32 v237, v155, v155
    v_mfma_f32_16x16x32_bf16 v[162:165], a[240:243], v[122:125], 0
    s_waitcnt lgkmcnt(4)
    v_fmac_f32 v237, v156, v156
    v_fmac_f32 v237, v157, v157
    v_mfma_f32_16x16x32_bf16 v[158:161], a[220:223], v[126:129], v[158:161]
    s_waitcnt lgkmcnt(3)
    v_cvt_pk_bf16_f32 v132, v237, v237
    v_cvt_pk_bf16_f32 v133, v237, v237
    v_mfma_f32_16x16x32_bf16 v[158:161], a[224:227], v[134:137], v[158:161]
    s_waitcnt lgkmcnt(2)
    ds_write_b64 v235, v[132:133] offset:6144
    v_mfma_f32_16x16x32_bf16 v[158:161], a[228:231], v[142:145], v[158:161]
    s_waitcnt lgkmcnt(2)
    v_mfma_f32_16x16x32_bf16 v[158:161], a[232:235], v[146:149], v[158:161]
    s_waitcnt lgkmcnt(1)
    v_mfma_f32_16x16x32_bf16 v[158:161], a[236:239], v[150:153], v[158:161]
    v_mfma_f32_16x16x32_bf16 v[162:165], a[244:247], v[126:129], v[162:165]
    buffer_store_dwordx2 v[138:139], v18, s[56:59], 0 offen nt
    v_mfma_f32_16x16x32_bf16 v[162:165], a[248:251], v[134:137], v[162:165]
    v_mfma_f32_16x16x32_bf16 v[162:165], a[252:255], v[142:145], v[162:165]
    v_mfma_f32_16x16x32_bf16 v[162:165], v[82:85], v[146:149], v[162:165]
    s_waitcnt lgkmcnt(0)
    v_mfma_f32_16x16x32_bf16 v[162:165], v[86:89], v[150:153], v[162:165]
    s_barrier
    ds_read_b128 v[166:169], v234 offset:6144
    ds_read_b128 v[170:173], v234 offset:7168
    v_mfma_f32_16x16x32_bf16 v[174:177], v[90:93], v[122:125], 0
    ds_read_b128 v[122:125], v131 offset:12288
    v_fma_f32 v237, v158, v158, s33
    v_mfma_f32_16x16x32_bf16 v[174:177], v[94:97], v[126:129], v[174:177]
    ds_read_b128 v[126:129], v131 offset:13312
    v_fmac_f32 v237, v159, v159
    v_mfma_f32_16x16x32_bf16 v[174:177], v[98:101], v[134:137], v[174:177]
    ds_read_b128 v[134:137], v131 offset:14336
    v_fmac_f32 v237, v160, v160
    v_mfma_f32_16x16x32_bf16 v[174:177], v[102:105], v[142:145], v[174:177]
    ds_read_b128 v[142:145], v131 offset:15360
    v_fmac_f32 v237, v161, v161
    v_mfma_f32_16x16x32_bf16 v[174:177], v[106:109], v[146:149], v[174:177]
    ds_read_b128 v[146:149], v131 offset:16384
    v_fmac_f32 v237, v162, v162
    v_mfma_f32_16x16x32_bf16 v[174:177], v[110:113], v[150:153], v[174:177]
    ds_read_b128 v[150:153], v131 offset:17408
    v_fmac_f32 v237, v163, v163
    v_fmac_f32 v237, v164, v164
    v_fmac_f32 v237, v165, v165
    s_waitcnt lgkmcnt(7)
    v_mfma_f32_16x16x32_bf16 v[178:181], v[32:35], v[166:169], 0
    s_waitcnt lgkmcnt(6)
    v_mfma_f32_16x16x32_bf16 v[178:181], v[32:35], v[170:173], v[178:181]
    s_waitcnt lgkmcnt(5)
    v_fmac_f32 v237, v174, v174
    v_fmac_f32 v237, v175, v175
    v_mfma_f32_16x16x32_bf16 v[166:169], a[216:219], v[122:125], 0
    s_waitcnt lgkmcnt(4)
    v_fmac_f32 v237, v176, v176
    v_fmac_f32 v237, v177, v177
    v_mfma_f32_16x16x32_bf16 v[166:169], a[220:223], v[126:129], v[166:169]
    s_waitcnt lgkmcnt(3)
    v_cvt_pk_bf16_f32 v138, v237, v237
    v_cvt_pk_bf16_f32 v139, v237, v237
    v_mfma_f32_16x16x32_bf16 v[166:169], a[224:227], v[134:137], v[166:169]
    s_waitcnt lgkmcnt(2)
    ds_write_b64 v235, v[138:139] offset:8192
    v_mfma_f32_16x16x32_bf16 v[166:169], a[228:231], v[142:145], v[166:169]
    s_waitcnt lgkmcnt(2)
    v_mul_f32 v237, 0x3baaaaab, v178
    v_mfma_f32_16x16x32_bf16 v[166:169], a[232:235], v[146:149], v[166:169]
    s_waitcnt lgkmcnt(1)
    v_rsq_f32 v237, v237
    v_mfma_f32_16x16x32_bf16 v[166:169], a[236:239], v[150:153], v[166:169]
    v_mul_f32 v114, v237, v114
    v_mul_f32 v115, v237, v115
    v_mfma_f32_16x16x32_bf16 v[170:173], a[240:243], v[122:125], 0
    v_cvt_pk_bf16_f32 v114, v114, v115
    v_mul_f32 v116, v237, v116
    v_mfma_f32_16x16x32_bf16 v[170:173], a[244:247], v[126:129], v[170:173]
    v_mul_f32 v117, v237, v117
    v_cvt_pk_bf16_f32 v115, v116, v117
    v_mfma_f32_16x16x32_bf16 v[170:173], a[248:251], v[134:137], v[170:173]
    v_fma_f32 v138, v166, v166, s33
    v_fmac_f32 v138, v167, v167
    v_mfma_f32_16x16x32_bf16 v[170:173], a[252:255], v[142:145], v[170:173]
    s_waitcnt lgkmcnt(0)
    v_fmac_f32 v138, v168, v168
    v_fmac_f32 v138, v169, v169
    v_mfma_f32_16x16x32_bf16 v[170:173], v[82:85], v[146:149], v[170:173]
    s_barrier
    ds_read_b128 v[178:181], v234 offset:8192
    ds_read_b128 v[182:185], v234 offset:9216
    v_mfma_f32_16x16x32_bf16 v[170:173], v[86:89], v[150:153], v[170:173]
    v_mul_f32 v118, v237, v118
    v_mul_f32 v119, v237, v119
    v_mfma_f32_16x16x32_bf16 v[186:189], v[90:93], v[122:125], 0
    v_cvt_pk_bf16_f32 v116, v118, v119
    v_mul_f32 v120, v237, v120
    v_mfma_f32_16x16x32_bf16 v[186:189], v[94:97], v[126:129], v[186:189]
    v_mul_f32 v121, v237, v121
    v_cvt_pk_bf16_f32 v117, v120, v121
    v_mfma_f32_16x16x32_bf16 v[186:189], v[98:101], v[134:137], v[186:189]
    ds_write_b128 v140, v[114:117] offset:1536
    v_mfma_f32_16x16x32_bf16 v[186:189], v[102:105], v[142:145], v[186:189]
    v_fmac_f32 v138, v170, v170
    v_fmac_f32 v138, v171, v171
    v_mfma_f32_16x16x32_bf16 v[186:189], v[106:109], v[146:149], v[186:189]
    v_fmac_f32 v138, v172, v172
    v_fmac_f32 v138, v173, v173
    v_mfma_f32_16x16x32_bf16 v[186:189], v[110:113], v[150:153], v[186:189]
    s_waitcnt lgkmcnt(1)
    ds_read_b128 v[114:117], v202 offset:1536
    v_mul_f32 v154, v237, v154
    v_mfma_f32_16x16x32_bf16 v[118:121], v[32:35], v[178:181], 0
    v_mul_f32 v155, v237, v155
    v_cvt_pk_bf16_f32 v154, v154, v155
    v_mfma_f32_16x16x32_bf16 v[118:121], v[32:35], v[182:185], v[118:121]
    v_mul_f32 v156, v237, v156
    v_fmac_f32 v138, v186, v186
    v_fmac_f32 v138, v187, v187
    v_fmac_f32 v138, v188, v188
    v_fmac_f32 v138, v189, v189
    v_cvt_pk_bf16_f32 v132, v138, v138
    v_cvt_pk_bf16_f32 v133, v138, v138
    ds_write_b64 v235, v[132:133] offset:0
    v_mul_f32 v155, 0x3baaaaab, v118
    v_rsq_f32 v155, v155
    v_mul_f32 v157, v237, v157
    v_mul_f32 v158, v155, v158
    v_mul_f32 v159, v155, v159
    v_cvt_pk_bf16_f32 v118, v158, v159
    v_mul_f32 v160, v155, v160
    s_waitcnt lgkmcnt(1)
    v_mul_f32 v161, v155, v161
    v_cvt_pk_bf16_f32 v119, v160, v161
    v_mul_f32 v162, v155, v162
    v_mul_f32 v163, v155, v163
    v_cvt_pk_bf16_f32 v120, v162, v163
    v_mul_f32 v164, v155, v164
    v_mul_f32 v165, v155, v165
    v_cvt_pk_bf16_f32 v121, v164, v165
    buffer_store_dwordx4 v[118:121], v236, s[12:15], 0 offen nt
    v_mul_f32 v174, v155, v174
    v_mul_f32 v175, v155, v175
    v_cvt_pk_bf16_f32 v138, v174, v175
    v_mul_f32 v176, v155, v176
    v_mul_f32 v177, v155, v177
    s_waitcnt lgkmcnt(0)
    s_barrier
    ds_read_b128 v[118:121], v234 offset:0
    ds_read_b128 v[122:125], v234 offset:1024
    ds_read_b128 v[126:129], v131 offset:18432
    v_cvt_pk_bf16_f32 v139, v176, v177
    v_cvt_pk_bf16_f32 v155, v156, v157
    ds_write_b64 v141, v[154:155] offset:2560
    buffer_store_dwordx2 v[138:139], v255, s[12:15], 0 offen nt
    ds_read_b64 v[224:225], v254 offset:2560
    s_waitcnt lgkmcnt(4)
    v_mfma_f32_16x16x32_bf16 v[130:133], v[32:35], v[118:121], 0
    s_waitcnt lgkmcnt(3)
    v_mfma_f32_16x16x32_bf16 v[130:133], v[32:35], v[122:125], v[130:133]
    s_waitcnt lgkmcnt(2)
    v_or3_b32 v126, v126, v127, v128
    v_or_b32 v126, v126, v129
    v_cmp_gt_i32 s[46:47], 0, v126
    s_nop 0
    s_nop 0
    s_nop 0
    s_nop 0
    v_mul_f32 v255, 0x3baaaaab, v130
    v_rsq_f32 v255, v255
    s_nop 0
    v_mul_f32 v166, v255, v166
    buffer_store_dwordx4 v[114:117], v203, s[56:59], 0 offen nt
    s_waitcnt lgkmcnt(0)
    v_mul_f32 v167, v255, v167
    v_cvt_pk_bf16_f32 v114, v166, v167
    v_mul_f32 v168, v255, v168
    v_mul_f32 v169, v255, v169
    v_cvt_pk_bf16_f32 v115, v168, v169
    v_mul_f32 v170, v255, v170
    v_mul_f32 v171, v255, v171
    v_cvt_pk_bf16_f32 v116, v170, v171
    v_mul_f32 v172, v255, v172
    v_mul_f32 v173, v255, v173
    v_cvt_pk_bf16_f32 v117, v172, v173
    ds_write_b128 v140, v[114:117] offset:3072
    buffer_store_dwordx2 v[224:225], v204, s[56:59], 0 offen nt
    v_mul_f32 v186, v255, v186
    v_mul_f32 v187, v255, v187
    v_cvt_pk_bf16_f32 v186, v186, v187
    v_mul_f32 v188, v255, v188
    v_mul_f32 v189, v255, v189
    v_cvt_pk_bf16_f32 v187, v188, v189
    ds_read_b128 v[114:117], v202 offset:3072
    ds_write_b64 v141, v[186:187] offset:4096
    ds_read_b64 v[224:225], v254 offset:4096
    s_waitcnt lgkmcnt(2)
    buffer_store_dwordx4 v[114:117], v205, s[56:59], 0 offen nt
    s_waitcnt lgkmcnt(0)
    buffer_store_dwordx2 v[224:225], v222, s[56:59], 0 offen nt
    s_branch L_end
L_drain:
    ds_read_b128 v[114:117], v2 offset:18432
    ds_read_b128 v[118:121], v2 offset:19456
    ds_read_b128 v[122:125], v2 offset:0
    s_mul_i32 s5, s16, 8064
    s_mov_b32 s12, s42
    ds_read_b128 v[126:129], v2 offset:1024
    s_mov_b32 s13, s43
    s_cmp_ge_u32 s18, 2
    s_cselect_b32 s14, s36, 0
    ds_read_b128 v[130:133], v2 offset:2048
    s_add_u32 s5, s5, 104448
    s_lshl_b32 s3, s16, 6
    s_lshl_b32 s4, s16, 5
    ds_read_b128 v[134:137], v2 offset:3072
    s_add_u32 s4, s4, 256
    ds_read_b128 v[154:157], v2 offset:4096
    ds_read_b128 v[162:165], v2 offset:5120
    v_bfe_u32 v254, v2, 4, 6
    v_lshrrev_b32 v255, 4, v254
    v_and_b32 v166, 15, v254
    v_lshlrev_b32 v167, 9, v255
    v_lshl_add_u32 v167, v166, 4, v167
    v_add_u32 v167, 136704, v167
    s_waitcnt lgkmcnt(7)
    v_mfma_f32_16x16x32_bf16 v[170:173], v[32:35], v[114:117], 0
    s_waitcnt lgkmcnt(5)
    v_xor_b32 v168, 65536, v2
    v_bfe_u32 v169, v166, 1, 2
    v_mfma_f32_16x16x32_bf16 v[170:173], v[32:35], v[118:121], v[170:173]
    s_waitcnt lgkmcnt(4)
    v_xor_b32 v169, v169, v255
    v_lshl_add_u32 v169, v166, 2, v169
    v_lshl_add_u32 v114, v169, 4, s5
    v_mfma_f32_16x16x32_bf16 v[118:121], a[216:219], v[122:125], 0
    s_waitcnt lgkmcnt(3)
    v_lshl_add_u32 v115, v169, 3, s5
    v_lshl_add_u32 v116, v254, 4, s5
    v_lshl_add_u32 v117, v254, 3, s5
    v_mfma_f32_16x16x32_bf16 v[118:121], a[220:223], v[126:129], v[118:121]
    s_waitcnt lgkmcnt(2)
    v_lshlrev_b32 v169, 2, v169
    v_mul_f32 v170, 0x3baaaaab, v170
    v_rsq_f32 v170, v170
    v_mfma_f32_16x16x32_bf16 v[118:121], a[224:227], v[130:133], v[118:121]
    s_waitcnt lgkmcnt(0)
    ds_permute_b32 v173, v169, v15
    ds_permute_b32 v174, v169, v18
    v_mul_f32 v150, v170, v150
    v_mfma_f32_16x16x32_bf16 v[118:121], a[228:231], v[134:137], v[118:121]
    ds_permute_b32 v175, v169, v16
    ds_permute_b32 v176, v169, v19
    v_mul_f32 v151, v170, v151
    v_mfma_f32_16x16x32_bf16 v[118:121], a[232:235], v[154:157], v[118:121]
    ds_permute_b32 v177, v169, v17
    ds_permute_b32 v182, v169, v20
    v_cvt_pk_bf16_f32 v150, v150, v151
    v_mfma_f32_16x16x32_bf16 v[118:121], a[236:239], v[162:165], v[118:121]
    v_mul_f32 v152, v170, v152
    v_mul_f32 v153, v170, v153
    v_cvt_pk_bf16_f32 v151, v152, v153
    v_mfma_f32_16x16x32_bf16 v[194:197], a[240:243], v[122:125], 0
    v_mul_f32 v190, v170, v190
    v_mul_f32 v191, v170, v191
    v_cvt_pk_bf16_f32 v152, v190, v191
    v_mfma_f32_16x16x32_bf16 v[194:197], a[244:247], v[126:129], v[194:197]
    v_mul_f32 v192, v170, v192
    v_mul_f32 v193, v170, v193
    v_cvt_pk_bf16_f32 v153, v192, v193
    v_mfma_f32_16x16x32_bf16 v[194:197], a[248:251], v[130:133], v[194:197]
    s_waitcnt lgkmcnt(4)
    ds_read_b128 v[190:193], v2 offset:6144
    v_mul_f32 v202, v170, v202
    v_mul_f32 v203, v170, v203
    v_mfma_f32_16x16x32_bf16 v[194:197], a[252:255], v[134:137], v[194:197]
    s_waitcnt lgkmcnt(3)
    ds_read_b128 v[198:201], v2 offset:7168
    v_cvt_pk_bf16_f32 v184, v202, v203
    v_mul_f32 v204, v170, v204
    v_mfma_f32_16x16x32_bf16 v[194:197], v[82:85], v[154:157], v[194:197]
    s_waitcnt lgkmcnt(2)
    ds_read_b128 v[206:209], v2 offset:8192
    v_mul_f32 v205, v170, v205
    v_cvt_pk_bf16_f32 v185, v204, v205
    v_mfma_f32_16x16x32_bf16 v[194:197], v[86:89], v[162:165], v[194:197]
    ds_read_b128 v[202:205], v2 offset:9216
    v_fma_f32 v169, v118, v118, s33
    v_fmac_f32 v169, v119, v119
    v_mfma_f32_16x16x32_bf16 v[210:213], v[90:93], v[122:125], 0
    ds_read_b128 v[122:125], v2 offset:10240
    v_fmac_f32 v169, v120, v120
    v_fmac_f32 v169, v121, v121
    v_mfma_f32_16x16x32_bf16 v[210:213], v[94:97], v[126:129], v[210:213]
    ds_read_b128 v[126:129], v2 offset:11264
    v_fmac_f32 v169, v194, v194
    v_fmac_f32 v169, v195, v195
    v_mfma_f32_16x16x32_bf16 v[210:213], v[98:101], v[130:133], v[210:213]
    s_waitcnt lgkmcnt(5)
    buffer_store_dwordx4 v[150:153], v15, s[12:15], s27 offen nt
    v_fmac_f32 v169, v196, v196
    v_fmac_f32 v169, v197, v197
    v_mul_f32 v183, 0x3baaaaab, v171
    v_mfma_f32_16x16x32_bf16 v[210:213], v[102:105], v[134:137], v[210:213]
    s_waitcnt lgkmcnt(4)
    v_rsq_f32 v183, v183
    v_subrev_u32 v170, 0x3d800000, v44
    v_mfma_f32_16x16x32_bf16 v[210:213], v[106:109], v[154:157], v[210:213]
    s_waitcnt lgkmcnt(3)
    v_mul_f32 v142, v183, v142
    v_mul_f32 v143, v183, v143
    v_cvt_pk_bf16_f32 v130, v142, v143
    v_mfma_f32_16x16x32_bf16 v[210:213], v[110:113], v[162:165], v[210:213]
    s_waitcnt lgkmcnt(2)
    v_mul_f32 v144, v183, v144
    v_mul_f32 v145, v183, v145
    v_cvt_pk_bf16_f32 v131, v144, v145
    v_mfma_f32_16x16x32_bf16 v[134:137], a[216:219], v[190:193], 0
    s_waitcnt lgkmcnt(1)
    v_mul_f32 v158, v183, v158
    v_mul_f32 v159, v183, v159
    v_fmac_f32 v169, v210, v210
    v_mfma_f32_16x16x32_bf16 v[134:137], a[220:223], v[198:201], v[134:137]
    s_waitcnt lgkmcnt(0)
    v_fmac_f32 v169, v211, v211
    v_fmac_f32 v169, v212, v212
    v_fmac_f32 v169, v213, v213
    v_mfma_f32_16x16x32_bf16 v[134:137], a[224:227], v[206:209], v[134:137]
    v_cvt_pk_bf16_f32 v132, v158, v159
    v_mul_f32 v160, v183, v160
    v_mul_f32 v161, v183, v161
    v_mfma_f32_16x16x32_bf16 v[134:137], a[228:231], v[202:205], v[134:137]
    v_cvt_pk_bf16_f32 v133, v160, v161
    v_mul_f32 v178, v183, v178
    v_mul_f32 v179, v183, v179
    v_mfma_f32_16x16x32_bf16 v[134:137], a[232:235], v[122:125], v[134:137]
    v_cvt_pk_bf16_f32 v178, v178, v179
    v_mul_f32 v180, v183, v180
    v_mul_f32 v181, v183, v181
    v_mfma_f32_16x16x32_bf16 v[134:137], a[236:239], v[126:129], v[134:137]
    v_cvt_pk_bf16_f32 v179, v180, v181
    v_sub_u32 v183, 0x4a000000, v45
    v_or3_b32 v170, v170, v183, v45
    v_mfma_f32_16x16x32_bf16 v[142:145], a[240:243], v[190:193], 0
    v_lshl_add_u32 v183, s16, 2, v168
    v_mul_f32 v180, 0x3baaaaab, v172
    v_rsq_f32 v180, v180
    v_mfma_f32_16x16x32_bf16 v[142:145], a[244:247], v[198:201], v[142:145]
    ds_write_b32 v183, v170 offset:18432
    v_fma_f32 v181, v134, v134, s33
    v_mfma_f32_16x16x32_bf16 v[142:145], a[248:251], v[206:209], v[142:145]
    v_fmac_f32 v181, v135, v135
    v_fmac_f32 v181, v136, v136
    v_fmac_f32 v181, v137, v137
    v_mfma_f32_16x16x32_bf16 v[142:145], a[252:255], v[202:205], v[142:145]
    ds_read_b128 v[150:153], v2 offset:12288
    ds_read_b128 v[154:157], v2 offset:13312
    v_mul_f32 v146, v180, v146
    v_mfma_f32_16x16x32_bf16 v[142:145], v[82:85], v[122:125], v[142:145]
    ds_read_b128 v[158:161], v2 offset:14336
    v_mul_f32 v147, v180, v147
    v_cvt_pk_bf16_f32 v146, v146, v147
    v_mfma_f32_16x16x32_bf16 v[142:145], v[86:89], v[126:129], v[142:145]
    ds_read_b128 v[162:165], v2 offset:15360
    v_mul_f32 v148, v180, v148
    v_mul_f32 v149, v180, v149
    v_mfma_f32_16x16x32_bf16 v[214:217], v[90:93], v[190:193], 0
    ds_read_b128 v[190:193], v2 offset:16384
    v_cvt_pk_bf16_f32 v147, v148, v149
    v_mul_f32 v138, v180, v138
    v_mfma_f32_16x16x32_bf16 v[214:217], v[94:97], v[198:201], v[214:217]
    ds_read_b128 v[198:201], v2 offset:17408
    v_fmac_f32 v181, v142, v142
    v_fmac_f32 v181, v143, v143
    v_mfma_f32_16x16x32_bf16 v[214:217], v[98:101], v[206:209], v[214:217]
    buffer_store_dwordx2 v[184:185], v18, s[12:15], s27 offen nt
    v_fmac_f32 v181, v144, v144
    v_mfma_f32_16x16x32_bf16 v[214:217], v[102:105], v[202:205], v[214:217]
    s_waitcnt lgkmcnt(4)
    v_fmac_f32 v181, v145, v145
    v_mul_f32 v139, v180, v139
    v_cvt_pk_bf16_f32 v148, v138, v139
    v_mfma_f32_16x16x32_bf16 v[214:217], v[106:109], v[122:125], v[214:217]
    s_waitcnt lgkmcnt(3)
    v_mul_f32 v140, v180, v140
    v_mul_f32 v141, v180, v141
    v_cvt_pk_bf16_f32 v149, v140, v141
    v_mfma_f32_16x16x32_bf16 v[214:217], v[110:113], v[126:129], v[214:217]
    s_waitcnt lgkmcnt(2)
    ds_write_b128 v114, v[146:149] offset:3072
    v_mfma_f32_16x16x32_bf16 v[122:125], a[216:219], v[150:153], 0
    s_waitcnt lgkmcnt(2)
    v_mul_f32 v186, v180, v186
    v_mul_f32 v187, v180, v187
    v_cvt_pk_bf16_f32 v186, v186, v187
    v_mfma_f32_16x16x32_bf16 v[122:125], a[220:223], v[154:157], v[122:125]
    s_waitcnt lgkmcnt(1)
    v_fmac_f32 v181, v214, v214
    v_fmac_f32 v181, v215, v215
    v_fmac_f32 v181, v216, v216
    v_mfma_f32_16x16x32_bf16 v[122:125], a[224:227], v[158:161], v[122:125]
    ds_read_b128 v[126:129], v116 offset:3072
    v_fmac_f32 v181, v217, v217
    v_cvt_pk_bf16_f32 v170, v169, v181
    v_mfma_f32_16x16x32_bf16 v[122:125], a[228:231], v[162:165], v[122:125]
    v_cvt_pk_bf16_f32 v171, v181, v181
    v_mul_f32 v188, v180, v188
    v_mul_f32 v189, v180, v189
    v_mfma_f32_16x16x32_bf16 v[122:125], a[232:235], v[190:193], v[122:125]
    ds_write_b64 v4, v[170:171] offset:0
    v_mfma_f32_16x16x32_bf16 v[122:125], a[236:239], v[198:201], v[122:125]
    v_cvt_pk_bf16_f32 v187, v188, v189
    v_mov_b32 v169, 0x40000000
    v_lshrrev_b32 v180, 2, v254
    v_mfma_f32_16x16x32_bf16 v[138:141], a[240:243], v[150:153], 0
    ds_write_b64 v115, v[186:187] offset:4096
    v_mfma_f32_16x16x32_bf16 v[138:141], a[244:247], v[154:157], v[138:141]
    v_lshrrev_b32 v181, 3, v254
    v_xor_b32 v181, v181, v254
    v_fma_f32 v254, v122, v122, s33
    v_mfma_f32_16x16x32_bf16 v[138:141], a[248:251], v[158:161], v[138:141]
    s_waitcnt lgkmcnt(2)
    ds_read_b128 v[146:149], v167 offset:0
    ds_read_b64 v[170:171], v117 offset:4096
    v_fmac_f32 v254, v123, v123
    v_mfma_f32_16x16x32_bf16 v[138:141], a[252:255], v[162:165], v[138:141]
    ds_read_b128 v[186:189], v167 offset:2048
    v_fmac_f32 v254, v124, v124
    v_fmac_f32 v254, v125, v125
    v_mfma_f32_16x16x32_bf16 v[138:141], v[82:85], v[190:193], v[138:141]
    s_waitcnt lgkmcnt(4)
    ds_read_b128 v[202:205], v167 offset:4096
    v_and_b32 v181, 3, v181
    v_add_u32 v172, 0, v180
    v_mfma_f32_16x16x32_bf16 v[138:141], v[86:89], v[198:201], v[138:141]
    s_barrier
    ds_read_b128 v[206:209], v168 offset:0
    ds_read_b128 v[218:221], v168 offset:1024
    v_mul_u32_u24 v180, s20, v172
    v_mfma_f32_16x16x32_bf16 v[222:225], v[90:93], v[150:153], 0
    ds_read_b128 v[150:153], v167 offset:6144
    ds_read_b128 v[226:229], v167 offset:8192
    v_add_u32 v180, s38, v180
    v_mfma_f32_16x16x32_bf16 v[222:225], v[94:97], v[154:157], v[222:225]
    ds_read_b128 v[154:157], v167 offset:10240
    v_fmac_f32 v254, v138, v138
    v_fmac_f32 v254, v139, v139
    v_mfma_f32_16x16x32_bf16 v[222:225], v[98:101], v[158:161], v[222:225]
    s_waitcnt lgkmcnt(7)
    buffer_store_dwordx4 v[130:133], v16, s[12:15], s27 offen nt
    ds_read_b128 v[158:161], v168 offset:18432
    v_fmac_f32 v254, v140, v140
    v_fmac_f32 v254, v141, v141
    v_mfma_f32_16x16x32_bf16 v[222:225], v[102:105], v[162:165], v[222:225]
    s_waitcnt lgkmcnt(7)
    v_mul_u32_u24 v180, 911, v180
    v_lshrrev_b32 v180, 16, v180
    v_mul_u32_u24 v180, s22, v180
    v_mfma_f32_16x16x32_bf16 v[222:225], v[106:109], v[190:193], v[222:225]
    s_waitcnt lgkmcnt(6)
    v_mad_u32_u24 v180, v172, s21, v180
    v_cmp_gt_u32 vcc, s17, v172
    v_add_u32 v172, s7, v180
    v_mfma_f32_16x16x32_bf16 v[222:225], v[110:113], v[198:201], v[222:225]
    s_waitcnt lgkmcnt(4)
    v_cndmask_b32 v172, v169, v172, vcc
    v_lshl_add_u32 v183, v181, 4, v172
    v_mfma_f32_16x16x32_bf16 v[130:133], v[32:35], v[206:209], 0
    s_waitcnt lgkmcnt(2)
    v_add_u32 v183, s3, v183
    v_lshl_add_u32 v184, v181, 3, v172
    v_mfma_f32_16x16x32_bf16 v[130:133], v[32:35], v[218:221], v[130:133]
    s_waitcnt lgkmcnt(1)
    v_fmac_f32 v254, v222, v222
    v_fmac_f32 v254, v223, v223
    v_fmac_f32 v254, v224, v224
    v_mfma_f32_16x16x32_bf16 v[162:165], a[216:219], v[146:149], 0
    v_fmac_f32 v254, v225, v225
    v_cvt_pk_bf16_f32 v180, v254, v254
    v_cvt_pk_bf16_f32 v181, v254, v254
    v_mfma_f32_16x16x32_bf16 v[162:165], a[220:223], v[186:189], v[162:165]
    s_waitcnt lgkmcnt(0)
    ds_write_b64 v4, v[180:181] offset:2048
    v_mfma_f32_16x16x32_bf16 v[162:165], a[224:227], v[202:205], v[162:165]
    v_add_u32 v184, s4, v184
    v_add_u32 v166, 16, v166
    v_mul_u32_u24 v172, s20, v166
    v_mfma_f32_16x16x32_bf16 v[162:165], a[228:231], v[150:153], v[162:165]
    v_add_u32 v172, s38, v172
    v_mul_u32_u24 v172, 911, v172
    v_lshrrev_b32 v172, 16, v172
    v_mfma_f32_16x16x32_bf16 v[162:165], a[232:235], v[226:229], v[162:165]
    v_mul_u32_u24 v172, s22, v172
    v_mad_u32_u24 v172, v166, s21, v172
    v_cmp_gt_u32 vcc, s17, v166
    v_mfma_f32_16x16x32_bf16 v[162:165], a[236:239], v[154:157], v[162:165]
    v_add_u32 v172, s7, v172
    v_cndmask_b32 v172, v169, v172, vcc
    v_lshl_add_u32 v185, v255, 4, v172
    v_mfma_f32_16x16x32_bf16 v[190:193], a[240:243], v[146:149], 0
    v_add_u32 v185, s3, v185
    v_lshl_add_u32 v254, v255, 3, v172
    v_add_u32 v254, s4, v254
    v_mfma_f32_16x16x32_bf16 v[190:193], a[244:247], v[186:189], v[190:193]
    buffer_store_dwordx2 v[178:179], v19, s[12:15], s27 offen nt
    v_fma_f32 v172, v162, v162, s33
    v_mfma_f32_16x16x32_bf16 v[190:193], a[248:251], v[202:205], v[190:193]
    ds_read_b128 v[198:201], v167 offset:256
    v_fmac_f32 v172, v163, v163
    v_fmac_f32 v172, v164, v164
    v_mfma_f32_16x16x32_bf16 v[190:193], a[252:255], v[150:153], v[190:193]
    ds_read_b128 v[178:181], v167 offset:2304
    v_fmac_f32 v172, v165, v165
    v_mul_f32 v255, 0x3baaaaab, v130
    v_mfma_f32_16x16x32_bf16 v[190:193], v[82:85], v[226:229], v[190:193]
    ds_read_b128 v[206:209], v167 offset:4352
    v_mul_f32 v166, 0x3baaaaab, v131
    v_rsq_f32 v255, v255
    v_mfma_f32_16x16x32_bf16 v[190:193], v[86:89], v[154:157], v[190:193]
    ds_read_b128 v[130:133], v167 offset:6400
    v_mul_f32 v118, v255, v118
    v_mul_f32 v119, v255, v119
    v_mfma_f32_16x16x32_bf16 v[218:221], v[90:93], v[146:149], 0
    ds_read_b128 v[146:149], v167 offset:8448
    v_cvt_pk_bf16_f32 v118, v118, v119
    v_mul_f32 v120, v255, v120
    v_mfma_f32_16x16x32_bf16 v[218:221], v[94:97], v[186:189], v[218:221]
    ds_read_b128 v[186:189], v167 offset:10496
    v_fmac_f32 v172, v190, v190
    v_fmac_f32 v172, v191, v191
    v_mfma_f32_16x16x32_bf16 v[218:221], v[98:101], v[202:205], v[218:221]
    s_waitcnt lgkmcnt(5)
    v_fmac_f32 v172, v192, v192
    v_fmac_f32 v172, v193, v193
    v_mul_f32 v121, v255, v121
    v_mfma_f32_16x16x32_bf16 v[218:221], v[102:105], v[150:153], v[218:221]
    s_waitcnt lgkmcnt(4)
    v_cvt_pk_bf16_f32 v119, v120, v121
    v_mul_f32 v194, v255, v194
    v_mul_f32 v195, v255, v195
    v_mfma_f32_16x16x32_bf16 v[218:221], v[106:109], v[226:229], v[218:221]
    s_waitcnt lgkmcnt(3)
    v_cvt_pk_bf16_f32 v120, v194, v195
    v_mul_f32 v196, v255, v196
    v_mul_f32 v197, v255, v197
    v_mfma_f32_16x16x32_bf16 v[218:221], v[110:113], v[154:157], v[218:221]
    s_waitcnt lgkmcnt(2)
    v_cvt_pk_bf16_f32 v121, v196, v197
    v_mul_f32 v210, v255, v210
    v_mul_f32 v211, v255, v211
    v_mfma_f32_16x16x32_bf16 v[150:153], a[216:219], v[198:201], 0
    s_waitcnt lgkmcnt(1)
    ds_write_b128 v114, v[118:121] offset:4608
    v_mfma_f32_16x16x32_bf16 v[150:153], a[220:223], v[178:181], v[150:153]
    s_waitcnt lgkmcnt(1)
    v_fmac_f32 v172, v218, v218
    v_fmac_f32 v172, v219, v219
    v_fmac_f32 v172, v220, v220
    v_mfma_f32_16x16x32_bf16 v[150:153], a[224:227], v[206:209], v[150:153]
    buffer_store_dwordx4 v[126:129], v177, s[12:15], s27 offen nt
    ds_read_b128 v[118:121], v116 offset:4608
    v_fmac_f32 v172, v221, v221
    v_cvt_pk_bf16_f32 v126, v172, v172
    v_mfma_f32_16x16x32_bf16 v[150:153], a[228:231], v[130:133], v[150:153]
    v_cvt_pk_bf16_f32 v127, v172, v172
    v_cvt_pk_bf16_f32 v210, v210, v211
    v_mul_f32 v212, v255, v212
    v_mfma_f32_16x16x32_bf16 v[150:153], a[232:235], v[146:149], v[150:153]
    ds_write_b64 v4, v[126:127] offset:4096
    v_mfma_f32_16x16x32_bf16 v[150:153], a[236:239], v[186:189], v[150:153]
    v_mul_f32 v213, v255, v213
    v_cvt_pk_bf16_f32 v211, v212, v213
    v_rsq_f32 v166, v166
    v_mfma_f32_16x16x32_bf16 v[126:129], a[240:243], v[198:201], 0
    buffer_store_dwordx2 v[170:171], v182, s[12:15], s27 offen nt
    v_mul_f32 v134, v166, v134
    v_mfma_f32_16x16x32_bf16 v[126:129], a[244:247], v[178:181], v[126:129]
    s_mov_b32 s14, s36
    ds_write_b64 v115, v[210:211] offset:5632
    v_mfma_f32_16x16x32_bf16 v[126:129], a[248:251], v[206:209], v[126:129]
    s_waitcnt lgkmcnt(2)
    v_fma_f32 v255, v150, v150, s33
    v_fmac_f32 v255, v151, v151
    v_fmac_f32 v255, v152, v152
    v_mfma_f32_16x16x32_bf16 v[126:129], a[252:255], v[130:133], v[126:129]
    ds_read_b64 v[170:171], v117 offset:5632
    v_fmac_f32 v255, v153, v153
    v_mul_f32 v135, v166, v135
    v_mfma_f32_16x16x32_bf16 v[126:129], v[82:85], v[146:149], v[126:129]
    s_waitcnt lgkmcnt(2)
    buffer_store_dwordx4 v[118:121], v173, s[12:15], s26 offen nt
    v_cvt_pk_bf16_f32 v134, v134, v135
    v_mul_f32 v136, v166, v136
    v_mul_f32 v137, v166, v137
    v_mfma_f32_16x16x32_bf16 v[126:129], v[86:89], v[186:189], v[126:129]
    s_barrier
    ds_read_b128 v[118:121], v168 offset:2048
    ds_read_b128 v[154:157], v168 offset:3072
    v_cvt_pk_bf16_f32 v135, v136, v137
    v_mfma_f32_16x16x32_bf16 v[194:197], v[90:93], v[198:201], 0
    ds_read_b128 v[198:201], v168 offset:4096
    ds_read_b128 v[202:205], v168 offset:5120
    v_mul_f32 v142, v166, v142
    v_mfma_f32_16x16x32_bf16 v[194:197], v[94:97], v[178:181], v[194:197]
    v_fmac_f32 v255, v126, v126
    v_fmac_f32 v255, v127, v127
    v_fmac_f32 v255, v128, v128
    v_mfma_f32_16x16x32_bf16 v[194:197], v[98:101], v[206:209], v[194:197]
    v_fmac_f32 v255, v129, v129
    v_mul_f32 v143, v166, v143
    v_cvt_pk_bf16_f32 v136, v142, v143
    v_mfma_f32_16x16x32_bf16 v[194:197], v[102:105], v[130:133], v[194:197]
    s_waitcnt lgkmcnt(4)
    buffer_store_dwordx2 v[170:171], v174, s[12:15], s26 offen nt
    v_mul_f32 v144, v166, v144
    v_mfma_f32_16x16x32_bf16 v[194:197], v[106:109], v[146:149], v[194:197]
    v_mul_f32 v145, v166, v145
    v_cvt_pk_bf16_f32 v137, v144, v145
    v_mul_f32 v214, v166, v214
    v_mfma_f32_16x16x32_bf16 v[194:197], v[110:113], v[186:189], v[194:197]
    s_waitcnt lgkmcnt(2)
    ds_write_b128 v114, v[134:137] offset:6144
    v_mfma_f32_16x16x32_bf16 v[130:133], v[32:35], v[118:121], 0
    s_waitcnt lgkmcnt(1)
    v_mul_f32 v215, v166, v215
    v_cvt_pk_bf16_f32 v214, v214, v215
    v_mfma_f32_16x16x32_bf16 v[130:133], v[32:35], v[154:157], v[130:133]
    v_mul_f32 v216, v166, v216
    v_fmac_f32 v255, v194, v194
    v_mfma_f32_16x16x32_bf16 v[118:121], v[32:35], v[198:201], 0
    ds_read_b128 v[134:137], v116 offset:6144
    v_fmac_f32 v255, v195, v195
    v_mfma_f32_16x16x32_bf16 v[118:121], v[32:35], v[202:205], v[118:121]
    v_fmac_f32 v255, v196, v196
    v_fmac_f32 v255, v197, v197
    v_cvt_pk_bf16_f32 v132, v255, v255
    v_cvt_pk_bf16_f32 v133, v255, v255
    ds_write_b64 v4, v[132:133] offset:6144
    v_mul_f32 v217, v166, v217
    v_cvt_pk_bf16_f32 v215, v216, v217
    v_mul_f32 v255, 0x3baaaaab, v130
    ds_write_b64 v115, v[214:215] offset:7168
    v_rsq_f32 v255, v255
    v_mul_f32 v174, 0x3baaaaab, v118
    ds_read_b64 v[166:167], v117 offset:7168
    v_mul_f32 v122, v255, v122
    s_waitcnt lgkmcnt(3)
    buffer_store_dwordx4 v[134:137], v175, s[12:15], s26 offen nt
    v_mul_f32 v123, v255, v123
    v_cvt_pk_bf16_f32 v118, v122, v123
    v_mul_f32 v124, v255, v124
    v_mul_f32 v125, v255, v125
    v_cvt_pk_bf16_f32 v119, v124, v125
    v_mul_f32 v138, v255, v138
    s_waitcnt lgkmcnt(2)
    s_barrier
    ds_read_b128 v[122:125], v168 offset:6144
    ds_read_b128 v[130:133], v168 offset:7168
    v_mul_f32 v139, v255, v139
    v_cvt_pk_bf16_f32 v120, v138, v139
    v_mul_f32 v140, v255, v140
    v_mul_f32 v141, v255, v141
    v_cvt_pk_bf16_f32 v121, v140, v141
    ds_write_b128 v114, v[118:121] offset:0
    s_waitcnt lgkmcnt(3)
    buffer_store_dwordx2 v[166:167], v176, s[12:15], s26 offen nt
    v_mul_f32 v222, v255, v222
    v_mul_f32 v223, v255, v223
    v_cvt_pk_bf16_f32 v222, v222, v223
    v_mul_f32 v224, v255, v224
    ds_read_b128 v[118:121], v116 offset:0
    v_mul_f32 v225, v255, v225
    v_cvt_pk_bf16_f32 v223, v224, v225
    ds_write_b64 v115, v[222:223] offset:1024
    s_waitcnt lgkmcnt(3)
    v_mfma_f32_16x16x32_bf16 v[134:137], v[32:35], v[122:125], 0
    v_rsq_f32 v174, v174
    v_mfma_f32_16x16x32_bf16 v[134:137], v[32:35], v[130:133], v[134:137]
    ds_read_b64 v[122:123], v117 offset:1024
    v_mul_f32 v162, v174, v162
    v_mul_f32 v163, v174, v163
    v_cvt_pk_bf16_f32 v130, v162, v163
    v_mul_f32 v164, v174, v164
    v_mul_f32 v165, v174, v165
    v_cvt_pk_bf16_f32 v131, v164, v165
    v_mul_f32 v190, v174, v190
    v_mul_f32 v191, v174, v191
    v_cvt_pk_bf16_f32 v132, v190, v191
    v_mul_f32 v192, v174, v192
    v_mul_f32 v193, v174, v193
    v_cvt_pk_bf16_f32 v133, v192, v193
    s_waitcnt lgkmcnt(2)
    buffer_store_dwordx4 v[118:121], v177, s[12:15], s26 offen nt
    ds_write_b128 v114, v[130:133] offset:1536
    v_mul_f32 v218, v174, v218
    v_mul_f32 v219, v174, v219
    v_cvt_pk_bf16_f32 v124, v218, v219
    v_mul_f32 v220, v174, v220
    v_mul_f32 v221, v174, v221
    v_cvt_pk_bf16_f32 v125, v220, v221
    s_waitcnt lgkmcnt(1)
    ds_read_b128 v[118:121], v116 offset:1536
    ds_write_b64 v115, v[124:125] offset:2560
    buffer_store_dwordx2 v[122:123], v182, s[12:15], s26 offen nt
    v_mul_f32 v255, 0x3baaaaab, v134
    ds_read_b64 v[124:125], v117 offset:2560
    v_rsq_f32 v255, v255
    v_or3_b32 v158, v158, v159, v160
    v_mul_f32 v150, v255, v150
    v_mul_f32 v151, v255, v151
    v_cvt_pk_bf16_f32 v114, v150, v151
    v_mul_f32 v152, v255, v152
    v_mul_f32 v153, v255, v153
    v_cvt_pk_bf16_f32 v115, v152, v153
    v_mul_f32 v126, v255, v126
    v_mul_f32 v127, v255, v127
    v_cvt_pk_bf16_f32 v116, v126, v127
    v_mul_f32 v128, v255, v128
    v_mul_f32 v129, v255, v129
    v_cvt_pk_bf16_f32 v117, v128, v129
    buffer_store_dwordx4 v[114:117], v185, s[12:15], 0 offen nt
    s_waitcnt lgkmcnt(2)
    v_mul_f32 v194, v255, v194
    v_mul_f32 v195, v255, v195
    v_cvt_pk_bf16_f32 v122, v194, v195
    v_mul_f32 v196, v255, v196
    v_mul_f32 v197, v255, v197
    v_cvt_pk_bf16_f32 v123, v196, v197
    v_or_b32 v158, v158, v161
    v_cmp_gt_i32 s[46:47], 0, v158
    s_waitcnt lgkmcnt(0)
    buffer_store_dwordx4 v[118:121], v183, s[12:15], 0 offen nt
    buffer_store_dwordx2 v[124:125], v184, s[12:15], 0 offen nt
    buffer_store_dwordx2 v[122:123], v254, s[12:15], 0 offen nt
    s_branch L_end
.section .rodata,"a"
.p2align 6
.amdhsa_kernel standalone__window_attn_swin_v2__vision_kernel
  .amdhsa_next_free_vgpr 512
  .amdhsa_next_free_sgpr 102
  .amdhsa_accum_offset 256
  .amdhsa_group_segment_fixed_size 0
  .amdhsa_kernarg_size 96
  .amdhsa_user_sgpr_count 2
  .amdhsa_user_sgpr_kernarg_segment_ptr 1
  .amdhsa_system_sgpr_workgroup_id_x 1
  .amdhsa_float_denorm_mode_32 3
.end_amdhsa_kernel
```

```asm
; @launch grid=(256,1,1) block=(256,1,1) lds=163840
.amdgcn_target "amdgcn-amd-amdhsa--gfx950"
.text
.globl standalone__window_attn_swin_v2__vision_kernel
.p2align 12
.p2align 8
.type standalone__window_attn_swin_v2__vision_kernel,@function
standalone__window_attn_swin_v2__vision_kernel:
    s_mov_b32 s44, 0
L_again:
    s_load_dwordx16 s[76:91], s[0:1], 0
    v_readfirstlane_b32 s16, v0
    s_cmp_ge_u32 s2, 256
    s_cbranch_scc1 L_done
    s_lshr_b32 s16, s16, 6
    s_cbranch_scc1 L_nopf
    s_getpc_b64 s[96:97]
    s_bfe_u32 s3, s2, 0x30003
    s_mul_i32 s3, s3, 42
    v_cmp_gt_u32 vcc, 22, v0
    v_add_u32 v190, s3, v0
    v_mov_b32 v191, 0
    v_cndmask_b32 v190, v190, v0, vcc
    v_lshlrev_b32 v190, 7, v190
    v_lshl_add_u64 v[190:191], s[96:97], 0, v[190:191]
    global_load_dword a255, v[190:191], off offset:992
L_nopf:
    s_max_u32 s3, s2, s44
    s_cmp_ge_u32 s3, 247
    s_cbranch_scc1 L_edge
    v_mov_b32 v190, v0
    v_mov_b32 v191, 0x40000000
    v_and_b32 v254, 63, v0
    s_bfe_u32 s3, s2, 0x50003
    s_lshl_b32 s4, s16, 3
    s_lshr_b32 s98, 0x06143a01, s4
    s_and_b32 s98, s98, 0xff
    s_mul_i32 s3, s3, s98
    s_sub_u32 s98, s98, 1
    s_lshr_b32 s4, 0x0048d800, s4
    s_and_b32 s4, s4, 0xff
    s_lshl_b32 s4, s4, 3
    s_max_u32 s4, s4, 6
    s_sub_u32 s4, s4, s98
    s_sub_u32 s4, s4, 1
    s_min_u32 s3, s3, s4
    v_min_u32 v114, s98, v254
    v_add_lshl_u32 v114, v114, s3, 7
    v_mov_b32 v115, 0
    v_lshrrev_b32 v255, 4, v254
    v_and_b32 v116, 15, v254
    s_mov_b32 s10, 100270464
    s_mov_b32 s11, 0x00020000
    s_mov_b32 s50, 221184
    s_mov_b32 s51, 0x00020000
    v_mul_u32_u24 v117, 171, v254
    v_lshrrev_b32 v117, 10, v117
    v_lshrrev_b32 v122, 1, v117
    v_xor_b32 v122, v122, v117
    v_and_b32 v122, 4, v122
    v_mul_u32_u24 v122, 3, v122
    v_xor_b32 v122, v122, v117
    v_mul_u32_u24 v122, 1152, v122
    v_mul_u32_u24 v123, 96, v117
    v_sub_u32 v122, v122, v123
    v_lshl_add_u32 v123, v254, 4, v122
    v_add_u32 v122, 64, v254
    v_mul_u32_u24 v122, 171, v122
    v_lshrrev_b32 v122, 10, v122
    v_lshrrev_b32 v124, 1, v122
    v_xor_b32 v124, v124, v122
    v_and_b32 v124, 4, v124
    v_mul_u32_u24 v124, 3, v124
    v_xor_b32 v124, v124, v122
    v_mul_u32_u24 v124, 1152, v124
    v_mul_u32_u24 v125, 96, v122
    v_sub_u32 v124, v124, v125
    v_lshl_add_u32 v125, v254, 4, v124
    v_add_u32 v124, 128, v254
    v_mul_u32_u24 v124, 171, v124
    v_lshrrev_b32 v124, 10, v124
    v_lshrrev_b32 v126, 1, v124
    v_xor_b32 v126, v126, v124
    v_and_b32 v126, 4, v126
    v_mul_u32_u24 v126, 3, v126
    v_xor_b32 v126, v126, v124
    v_mul_u32_u24 v126, 1152, v126
    v_mul_u32_u24 v127, 96, v124
    v_sub_u32 v126, v126, v127
    v_lshl_add_u32 v127, v254, 4, v126
    s_mul_i32 s68, s16, 6144
    s_add_u32 s69, s68, 65536
    s_cmp_eq_u32 s16, 3
    s_cselect_b32 s68, 136704, s68
    s_cselect_b32 s69, 142848, s69
    s_mul_i32 s45, s16, 96
    s_waitcnt lgkmcnt(0)
    s_cmp_eq_u32 s16, 2
    s_cselect_b64 s[98:99], s[80:81], s[78:79]
    s_cmp_eq_u32 s16, 3
    s_cselect_b64 s[98:99], s[88:89], s[98:99]
    s_mov_b64 s[8:9], s[76:77]
    v_lshl_add_u64 v[114:115], s[98:99], 0, v[114:115]
    s_cmp_eq_u32 s16, 2
    s_cselect_b64 s[98:99], s[84:85], s[82:83]
    s_cmp_eq_u32 s16, 3
    s_cselect_b64 s[98:99], s[86:87], s[98:99]
    v_writelane_b32 v114, s98, 63
    v_writelane_b32 v115, s99, 63
    s_cmp_eq_u32 s16, 0
    s_cbranch_scc1 L_nowu
    global_load_dword a254, v[114:115], off
L_nowu:
    s_mov_b64 s[48:49], s[78:79]
    s_mov_b64 s[52:53], s[80:81]
    s_mov_b64 s[60:61], s[84:85]
    s_mov_b64 s[64:65], s[86:87]
    s_mov_b64 s[56:57], s[88:89]
    s_mov_b64 s[46:47], s[82:83]
    s_load_dwordx2 s[42:43], s[0:1], 72
    s_add_u32 m0, s68, 0
    s_add_u32 s4, s45, 384
    buffer_load_dwordx4 v123, s[48:51], s4 offen lds
    v_add_u32 v114, s16, v254
    v_and_b32 v114, 3, v114
    s_mov_b32 s54, 73728
    s_mov_b32 s55, 0x00020000
    buffer_load_dwordx4 v125, s[48:51], s4 offen offset:1024 lds
    v_lshlrev_b32 v114, 1, v114
    s_mov_b32 s62, 64
    s_mov_b32 s63, 0x00020000
    s_mov_b32 s66, 128
    buffer_load_dwordx4 v127, s[48:51], s4 offen offset:2048 lds
    s_add_u32 m0, s68, 3072
    s_add_u32 s4, s45, 37248
    s_mov_b32 s67, 0x00020000
    s_mov_b32 s58, 676
    global_load_ushort v114, v114, s[46:47]
    s_mov_b32 s59, 0x00020000
    s_mov_b32 s14, 0
    s_mov_b32 s15, 0x00020000
    buffer_load_dwordx4 v123, s[48:51], s4 offen lds
    v_mov_b32 v193, 0
    v_cmp_lt_u32 s[92:93], 7, v116
    s_mul_i32 s71, s16, 192
    s_mul_i32 s72, s16, 8064
    buffer_load_dwordx4 v125, s[48:51], s4 offen offset:1024 lds
    v_mov_b32 v115, 0
    v_mov_b32 v129, 0
    s_add_u32 s72, s72, 104448
    s_mul_i32 s73, s16, 6528
    buffer_load_dwordx4 v127, s[48:51], s4 offen offset:2048 lds
    s_add_u32 m0, s69, 0
    s_add_u32 s4, s45, 74112
    s_add_u32 s73, s73, 38912
    s_mov_b32 s70, 193536
    buffer_load_dwordx4 v123, s[48:51], s4 offen lds
    v_mov_b32 v119, 0
    v_lshlrev_b32 v126, 1, v254
    v_mul_u32_u24 v128, 12, v116
    v_add_u32 v128, s71, v128
    v_lshlrev_b32 v118, 5, v255
    s_mov_b32 s36, 100270464
    s_mov_b32 s22, 1180032
    s_mul_i32 s3, s2, 911
    s_lshr_b32 s3, s3, 16
    s_mul_i32 s35, s3, 72
    s_sub_u32 s38, s2, s35
    s_mul_i32 s3, s3, 1373568
    s_mul_i32 s35, s38, 2688
    s_add_u32 s3, s3, s35
    s_add_u32 s25, s3, 589824
    s_add_u32 s7, s3, 1769472
    s_mov_b32 s20, 31
    s_mov_b32 s21, 4204032
    s_cmp_lt_u32 s2, 244
    s_cselect_b32 s17, 21, 20
    v_mul_u32_u24 v192, 2731, v190
    v_bfe_u32 v120, v192, 17, 3
    v_lshrrev_b32 v192, 16, v192
    v_xor_b32 v121, v120, v190
    v_mul_u32_u24 v120, 37, v192
    v_lshrrev_b32 v120, 8, v120
    v_lshlrev_b32 v121, 4, v121
    v_mad_u32_u24 v10, v120, s70, v121
    v_mul_u32_u24 v120, s20, v192
    v_add_u32 v120, s38, v120
    v_mul_u32_u24 v120, 911, v120
    v_lshrrev_b32 v120, 16, v120
    v_mul_u32_u24 v120, s22, v120
    v_mad_u32_u24 v120, v192, s21, v120
    v_cmp_gt_u32 vcc, s17, v192
    v_add_u32 v120, s7, v120
    v_mul_u32_u24 v192, 384, v192
    v_cndmask_b32 v120, v191, v120, vcc
    v_sub_u32 v192, v121, v192
    v_add_u32 v120, v120, v192
    v_add_u32 v121, 256, v190
    v_mul_u32_u24 v192, 2731, v121
    v_bfe_u32 v130, v192, 17, 3
    v_lshrrev_b32 v192, 16, v192
    v_xor_b32 v121, v130, v121
    v_mul_u32_u24 v130, 37, v192
    v_lshrrev_b32 v130, 8, v130
    v_lshlrev_b32 v121, 4, v121
    v_mad_u32_u24 v11, v130, s70, v121
    v_mul_u32_u24 v130, s20, v192
    v_add_u32 v130, s38, v130
    v_mul_u32_u24 v130, 911, v130
    v_lshrrev_b32 v130, 16, v130
    v_mul_u32_u24 v130, s22, v130
    v_mad_u32_u24 v130, v192, s21, v130
    v_cmp_gt_u32 vcc, s17, v192
    v_add_u32 v130, s7, v130
    v_mul_u32_u24 v192, 384, v192
    v_cndmask_b32 v130, v191, v130, vcc
    v_sub_u32 v192, v121, v192
    v_add_u32 v130, v130, v192
    s_lshl_b32 s28, s16, 10
    s_add_u32 s28, s28, 20480
    v_lshrrev_b32 v121, 2, v116
    v_and_b32 v131, 1, v121
    v_mul_u32_u24 v131, 0x020202, v131
    v_lshl_or_b32 v131, v131, 8, v131
    v_add_u32 v131, 0x05040100, v131
    v_and_b32 v132, 3, v116
    v_lshrrev_b32 v133, 1, v116
    v_xor_b32 v133, v133, v255
    v_mul_u32_u24 v192, 384, v116
    v_lshl_add_u32 v0, v133, 4, v192
    v_xor_b32 v1, 64, v0
    v_and_b32 v133, 2, v255
    v_add_u32 v133, v133, v255
    v_lshl_add_u32 v133, v133, 2, v121
    v_mul_u32_u24 v133, 96, v133
    v_lshl_add_u32 v133, v132, 3, v133
    v_add_u32 v222, s68, v133
    v_add_u32 v224, s69, v133
    v_add_u32 v223, s72, v133
    v_add_u32 v225, s73, v133
    v_mov_b32 v28, 0x3f803f80
    v_mov_b32 v29, 0x3f803f80
    v_mov_b32 v30, 0x3f803f80
    v_mov_b32 v31, 0x3f803f80
    v_mul_u32_u24 v133, 768, v255
    v_add_u32 v133, v128, v133
    v_add_u32 v133, 157184, v133
    s_mov_b32 s76, 0x3f80
    v_and_b32 v134, 1, v116
    v_lshlrev_b32 v134, 4, v134
    v_lshlrev_b32 v135, v134, s76
    v_mov_b32 v136, 0x3c003c00
    v_mov_b32 v44, 1.0
    v_mov_b32 v45, 1.0
    v_lshlrev_b32 v137, 4, v255
    s_mov_b32 s19, s38
    s_mov_b32 s23, s25
    s_mov_b32 s26, 0
    s_mov_b32 s27, 0
    s_mov_b32 s18, 0
    s_add_u32 s19, s19, s20
    s_add_u32 s23, s23, s21
    s_cmp_ge_u32 s19, 72
    s_cselect_b32 s34, 72, 0
    s_cselect_b32 s35, s22, 0
    s_sub_u32 s19, s19, s34
    s_add_u32 s23, s23, s35
    s_mov_b32 s24, s23
    s_add_u32 s19, s19, s20
    s_add_u32 s23, s23, s21
    s_cmp_ge_u32 s19, 72
    s_cselect_b32 s34, 72, 0
    s_cselect_b32 s35, s22, 0
    s_sub_u32 s19, s19, s34
    s_add_u32 s23, s23, s35
    s_mul_i32 s79, s16, 64
    v_lshl_add_u32 v192, v255, 4, s79
    s_mul_i32 s80, s16, 32
    s_add_u32 s80, s80, 256
    v_lshl_add_u32 v138, v255, 3, s80
    v_add_u32 v139, 0, v116
    v_mul_u32_u24 v140, 37, v139
    v_mul_u32_u24 v141, 384, v139
    v_lshrrev_b32 v140, 8, v140
    v_mad_u32_u24 v141, v140, s70, v141
    v_add_u32 v15, v141, v192
    v_add_u32 v18, v141, v138
    v_add_u32 v141, 16, v116
    v_mul_u32_u24 v142, 37, v141
    v_mul_u32_u24 v143, 384, v141
    v_lshrrev_b32 v142, 8, v142
    v_mad_u32_u24 v143, v142, s70, v143
    v_add_u32 v16, v143, v192
    v_add_u32 v19, v143, v138
    v_add_u32 v143, 32, v116
    v_mul_u32_u24 v144, 37, v143
    v_mul_u32_u24 v145, 384, v143
    v_lshrrev_b32 v144, 8, v144
    v_mad_u32_u24 v145, v144, s70, v145
    v_add_u32 v17, v145, v192
    v_add_u32 v20, v145, v138
    s_mul_i32 s81, s16, 768
    s_add_u32 s81, s81, 157184
    v_mul_u32_u24 v145, 24, v140
    v_lshl_add_u32 v145, v139, 2, v145
    v_add_u32 v22, s81, v145
    v_sub_u32 v23, s81, v145
    v_sub_u32 v192, v22, v137
    v_mul_u32_u24 v142, 24, v142
    v_lshl_add_u32 v142, v141, 2, v142
    v_add_u32 v24, s81, v142
    v_sub_u32 v25, s81, v142
    v_sub_u32 v142, v24, v137
    v_mul_u32_u24 v144, 24, v144
    v_lshl_add_u32 v144, v143, 2, v144
    v_add_u32 v26, s81, v144
    v_sub_u32 v27, s81, v144
    v_sub_u32 v143, v26, v137
    v_mul_u32_u24 v144, 148, v255
    s_mov_b32 s82, -24
    v_add_u32 v145, 0, v144
    v_lshrrev_b32 v145, 8, v145
    v_mad_i32_i24 v46, v145, s82, v192
    v_mad_i32_i24 v58, v145, s82, v142
    v_mad_i32_i24 v70, v145, s82, v143
    v_add_u32 v145, 37, v144
    v_lshrrev_b32 v145, 8, v145
    v_mad_i32_i24 v47, v145, s82, v192
    v_mad_i32_i24 v59, v145, s82, v142
    v_mad_i32_i24 v71, v145, s82, v143
    v_add_u32 v145, 74, v144
    v_lshrrev_b32 v145, 8, v145
    v_mad_i32_i24 v48, v145, s82, v192
    v_mad_i32_i24 v60, v145, s82, v142
    v_mad_i32_i24 v72, v145, s82, v143
    v_add_u32 v145, 111, v144
    v_lshrrev_b32 v145, 8, v145
    v_mad_i32_i24 v49, v145, s82, v192
    v_mad_i32_i24 v61, v145, s82, v142
    v_mad_i32_i24 v73, v145, s82, v143
    v_add_u32 v145, 592, v144
    v_lshrrev_b32 v145, 8, v145
    v_mad_i32_i24 v50, v145, s82, v192
    v_mad_i32_i24 v62, v145, s82, v142
    v_mad_i32_i24 v74, v145, s82, v143
    v_add_u32 v145, 629, v144
    v_lshrrev_b32 v145, 8, v145
    v_mad_i32_i24 v51, v145, s82, v192
    v_mad_i32_i24 v63, v145, s82, v142
    v_mad_i32_i24 v75, v145, s82, v143
    v_add_u32 v145, 666, v144
    v_lshrrev_b32 v145, 8, v145
    v_mad_i32_i24 v52, v145, s82, v192
    v_mad_i32_i24 v64, v145, s82, v142
    v_mad_i32_i24 v76, v145, s82, v143
    v_add_u32 v145, 703, v144
    v_lshrrev_b32 v145, 8, v145
    v_mad_i32_i24 v53, v145, s82, v192
    v_mad_i32_i24 v65, v145, s82, v142
    v_mad_i32_i24 v77, v145, s82, v143
    v_add_u32 v145, 1184, v144
    v_lshrrev_b32 v145, 8, v145
    v_mad_i32_i24 v54, v145, s82, v192
    v_mad_i32_i24 v66, v145, s82, v142
    v_mad_i32_i24 v78, v145, s82, v143
    v_add_u32 v145, 1221, v144
    v_lshrrev_b32 v145, 8, v145
    v_mad_i32_i24 v55, v145, s82, v192
    v_mad_i32_i24 v67, v145, s82, v142
    v_mad_i32_i24 v79, v145, s82, v143
    v_add_u32 v145, 1258, v144
    v_lshrrev_b32 v145, 8, v145
    v_mad_i32_i24 v56, v145, s82, v192
    v_mad_i32_i24 v68, v145, s82, v142
    v_mad_i32_i24 v80, v145, s82, v143
    v_add_u32 v144, 1295, v144
    v_lshrrev_b32 v144, 8, v144
    v_mad_i32_i24 v57, v144, s82, v192
    v_mad_i32_i24 v69, v144, s82, v142
    v_mad_i32_i24 v81, v144, s82, v143
    v_mov_b32 v138, s81
    v_lshlrev_b32 v192, 4, v254
    v_xor_b32 v2, 65536, v192
    v_lshl_add_u32 v3, s16, 10, v192
    s_lshr_b32 s83, s16, 1
    s_and_b32 s84, s16, 1
    s_lshl_b32 s84, s84, 3
    s_lshl_b32 s85, s83, 10
    s_add_u32 s85, s85, s84
    v_add_u32 v4, s85, v192
    s_lshl_b32 s83, s83, 11
    s_add_u32 s83, s83, s84
    s_add_u32 s83, s83, 144896
    s_mul_i32 s86, s16, 2048
    s_add_u32 s86, s86, 136704
    v_lshl_add_u32 v139, v255, 3, s86
    v_mov_b32 v140, s83
    v_mov_b32 v141, 161536
    v_mul_u32_u24 v192, 80, v255
    v_add3_u32 v5, v192, v134, s72
    v_lshl_add_u32 v6, v116, 2, s73
    s_mul_i32 s87, s16, 128
    s_add_u32 s87, s87, 65024
    v_add_u32 v9, s87, v137
    v_lshrrev_b32 v142, 1, v255
    v_mul_u32_u24 v142, 48, v142
    v_lshl_add_u32 v142, v255, 3, v142
    v_lshl_add_u32 v142, v121, 4, v142
    v_lshl_add_u32 v142, v132, 1, v142
    v_add_u32 v8, s87, v142
    v_mov_b32 v37, 0
    v_mov_b32 v38, 0
    v_mov_b32 v39, 0
    s_mov_b32 s40, s8
    s_mov_b32 s41, s9
    s_mov_b32 s32, 0x2a8cbccc
    s_mov_b32 s33, 0x38fba882
    v_add_u32 v194, 148992, v0
    v_add_u32 v142, 148992, v1
    v_lshlrev_b32 v143, 4, v116
    v_add_u32 v143, 160256, v143
    v_mul_u32_u24 v144, 336, v116
    v_add3_u32 v144, v144, v192, s72
    v_mul_u32_u24 v145, 272, v116
    v_add3_u32 v145, v145, v137, s73
    v_mul_u32_u24 v146, 1088, v255
    v_add_u32 v146, v146, v6
    v_add_u32 v147, 5376, v144
    v_add_u32 v148, 4352, v145
    v_add_u32 v149, 4352, v146
    v_cmp_gt_u32 s[88:89], 16, v254
    v_mov_b32 v195, 0xf149f2ca
    v_add_u32 v196, 512, v190
    v_mul_u32_u24 v197, 2731, v196
    v_bfe_u32 v150, v197, 17, 3
    v_lshrrev_b32 v197, 16, v197
    s_add_u32 s75, s28, 16384
    s_cmp_lt_u32 s16, 2
    buffer_load_ushort v192, v126, s[60:63], 0 offen
    v_xor_b32 v196, v150, v196
    s_cselect_b32 s29, s75, 160256
    s_cselect_b32 s30, 65536, 0
    buffer_load_dwordx3 v[154:156], v128, s[56:59], 0 offen
    v_mul_u32_u24 v150, 37, v197
    s_xor_b32 s74, s29, s30
    s_mul_i32 s77, s16, 64
    buffer_load_dwordx4 v[158:161], v118, s[64:67], 0 offen
    v_lshrrev_b32 v150, 8, v150
    v_lshlrev_b32 v196, 4, v196
    v_mad_u32_u24 v12, v150, s70, v196
    v_add_u32 v157, 768, v190
    v_mul_u32_u24 v126, 2731, v157
    v_bfe_u32 v128, v126, 17, 3
    s_mul_i32 s78, s16, 32
    s_add_u32 s78, s78, 192
    buffer_load_dwordx4 v[150:153], v118, s[64:67], 0 offen offset:16
    v_lshrrev_b32 v126, 16, v126
    v_xor_b32 v157, v128, v157
    v_mul_u32_u24 v128, 37, v126
    v_lshrrev_b32 v128, 8, v128
    v_lshlrev_b32 v157, 4, v157
    v_mad_u32_u24 v13, v128, s70, v157
    v_add_u32 v118, 1024, v190
    v_mul_u32_u24 v157, 2731, v118
    v_bfe_u32 v190, v157, 17, 3
    v_lshrrev_b32 v157, 16, v157
    v_xor_b32 v118, v190, v118
    v_mul_u32_u24 v190, 37, v157
    v_lshrrev_b32 v190, 8, v190
    v_lshlrev_b32 v118, 4, v118
    s_add_u32 s34, s18, 2
    s_mov_b32 s18, 1
    s_waitcnt vmcnt(9)
    buffer_load_dwordx4 v125, s[48:51], s4 offen offset:1024 lds
    s_waitcnt vmcnt(9)
    ds_read_b64_tr_b16 a[72:73], v222 offset:0
    ds_read_b64_tr_b16 a[74:75], v222 offset:768
    ds_read_b64_tr_b16 a[96:97], v222 offset:32
    ds_read_b64_tr_b16 a[98:99], v222 offset:800
    ds_read_b64_tr_b16 a[120:121], v222 offset:64
    ds_read_b64_tr_b16 a[122:123], v222 offset:832
    v_lshlrev_b32 v114, 16, v114
    v_max_f32 v114, 0xc2c80000, v114
    v_min_f32 v114, 0x40930000, v114
    v_mul_f32 v114, 0x3fb8aa3b, v114
    v_exp_f32 v114, v114
    s_mov_b32 s27, s26
    s_mov_b32 s26, s25
    buffer_load_dwordx4 v127, s[48:51], s4 offen offset:2048 lds
    s_add_u32 m0, s69, 3072
    s_add_u32 s4, s45, 110976
    v_cvt_pk_bf16_f32 v114, v114, v114
    v_and_b32 v114, 0xffff0000, v114
    v_mul_f32 v126, 0x3fb8aa3b, v114
    v_readfirstlane_b32 s37, v114
    v_readfirstlane_b32 s31, v126
    v_mul_f32 v114, 0x3e000000, v114
    v_cmp_lt_f32 s[90:91], 4.0, v114
    v_mad_u32_u24 v14, v190, s70, v118
    v_cmp_gt_u32 vcc, 48, v157
    s_cmp_lg_u64 s[90:91], 0
    s_cbranch_scc1 L_slow
    s_add_u32 s19, s19, s20
    buffer_load_dwordx4 v123, s[48:51], s4 offen lds
    v_cndmask_b32 v14, v191, v14, vcc
    v_cmp_gt_u32 vcc, 2, v132
    v_mul_u32_u24 v118, 6, v117
    v_sub_u32 v157, v254, v118
    v_cndmask_b32 v32, 0, v135, vcc
    v_cndmask_b32 v33, v135, 0, vcc
    v_cndmask_b32 v34, 0, v135, vcc
    v_cndmask_b32 v35, v135, 0, vcc
    v_cmp_eq_u32 vcc, 0, v134
    v_mul_u32_u24 v118, 384, v117
    v_lshl_add_u32 v118, v157, 4, v118
    v_cndmask_b32 v40, 0, v136, vcc
    buffer_load_dwordx4 v125, s[48:51], s4 offen offset:1024 lds
    s_waitcnt vmcnt(9)
    ds_read_b64_tr_b16 a[76:77], v222 offset:3072
    ds_read_b64_tr_b16 a[78:79], v222 offset:3840
    ds_read_b64_tr_b16 a[100:101], v222 offset:3104
    ds_read_b64_tr_b16 a[102:103], v222 offset:3872
    ds_read_b64_tr_b16 a[124:125], v222 offset:3136
    ds_read_b64_tr_b16 a[126:127], v222 offset:3904
    v_cndmask_b32 v41, v136, 0, vcc
    v_cndmask_b32 v42, 0, v136, vcc
    v_cndmask_b32 v43, v136, 0, vcc
    v_cmp_eq_u32 vcc, v255, v121
    v_add_u32 v114, s78, v118
    buffer_load_dwordx4 v127, s[48:51], s4 offen offset:2048 lds
    s_add_u32 m0, s72, 0
    s_add_u32 s4, s45, 147840
    v_cndmask_b32 v190, 0, v32, vcc
    v_cndmask_b32 v191, 0, v33, vcc
    v_add_u32 v118, s77, v118
    v_cmp_gt_i32 vcc, 4, v157
    v_mul_u32_u24 v157, 6, v122
    v_sub_u32 v117, v254, v157
    v_cndmask_b32 v126, v114, v118, vcc
    v_mul_u32_u24 v157, 384, v122
    v_lshl_add_u32 v157, v117, 4, v157
    v_add_u32 v118, s78, v157
    buffer_load_dwordx4 v123, s[48:51], s4 offen lds
    v_add_u32 v157, s77, v157
    v_cmp_gt_i32 vcc, -60, v117
    v_mul_u32_u24 v122, 6, v124
    v_sub_u32 v128, v254, v122
    v_cndmask_b32 v254, v118, v157, vcc
    v_mul_u32_u24 v122, 384, v124
    v_lshl_add_u32 v122, v128, 4, v122
    v_add_u32 v124, s78, v122
    v_add_u32 v122, s77, v122
    v_cmp_gt_i32 vcc, -124, v128
    v_mul_u32_u24 v135, 96, v116
    s_waitcnt vmcnt(8)
    buffer_load_dwordx4 v125, s[48:51], s4 offen offset:1024 lds
    s_waitcnt vmcnt(8)
    v_cndmask_b32 v158, v158, v159, s[92:93]
    v_cndmask_b32 v160, v160, v161, s[92:93]
    v_perm_b32 v196, v160, v158, v131
    v_bfe_u32 v114, v154, v137, 16
    v_bfe_u32 v128, v155, v137, 16
    v_bfe_u32 v118, v156, v137, 16
    v_mfma_f32_16x16x16_bf16 v[154:157], v[192:193], v[114:115], 0
    s_waitcnt vmcnt(7)
    v_cndmask_b32 v150, v150, v151, s[92:93]
    v_cndmask_b32 v152, v152, v153, s[92:93]
    v_mfma_f32_16x16x16_bf16 v[158:161], v[192:193], v[128:129], 0
    v_perm_b32 v197, v152, v150, v131
    v_cndmask_b32 v128, v124, v122, vcc
    v_cmp_gt_u32 vcc, 2, v255
    v_mfma_f32_16x16x16_bf16 v[150:153], v[192:193], v[118:119], 0
    buffer_load_dwordx4 v127, s[48:51], s4 offen offset:2048 lds
    s_add_u32 m0, s72, 3072
    s_add_u32 s4, s45, 184704
    v_max_f32 v154, 0, v154
    v_max_f32 v155, 0, v155
    v_max_f32 v156, 0, v156
    v_max_f32 v157, 0, v157
    v_cvt_pk_bf16_f32 v118, v154, v155
    v_cvt_pk_bf16_f32 v119, v156, v157
    v_max_f32 v158, 0, v158
    v_max_f32 v159, 0, v159
    v_mfma_f32_16x16x16_bf16 v[154:157], v[196:197], v[118:119], 0
    v_max_f32 v160, 0, v160
    buffer_load_dwordx4 v123, s[48:51], s4 offen lds
    v_max_f32 v161, 0, v161
    v_cvt_pk_bf16_f32 v118, v158, v159
    v_cvt_pk_bf16_f32 v119, v160, v161
    v_max_f32 v150, 0, v150
    v_max_f32 v151, 0, v151
    v_mfma_f32_16x16x16_bf16 v[158:161], v[196:197], v[118:119], 0
    v_cvt_pk_bf16_f32 v154, v154, v154
    v_and_b32 v154, 0xffff0000, v154
    s_waitcnt vmcnt(7)
    ds_read_b64_tr_b16 a[80:81], v224 offset:0
    ds_read_b64_tr_b16 a[82:83], v224 offset:768
    ds_read_b64_tr_b16 a[104:105], v224 offset:32
    ds_read_b64_tr_b16 a[106:107], v224 offset:800
    buffer_load_dwordx4 v125, s[48:51], s4 offen offset:1024 lds
    ds_read_b64_tr_b16 a[128:129], v224 offset:64
    ds_read_b64_tr_b16 a[130:131], v224 offset:832
    v_mul_f32 v154, 0xbfb8aa3b, v154
    v_exp_f32 v154, v154
    v_cvt_pk_bf16_f32 v158, v158, v158
    v_add_f32 v154, 1.0, v154
    v_rcp_f32 v154, v154
    v_and_b32 v158, 0xffff0000, v158
    v_cvt_pk_bf16_f32 v154, v154, v154
    v_and_b32 v154, 0xffff0000, v154
    buffer_load_dwordx4 v127, s[48:51], s4 offen offset:2048 lds
    s_add_u32 m0, s73, 0
    s_add_u32 s4, s45, 36864
    v_add_f32 v154, -0.5, v154
    v_mul_f32 v154, 0x41b8aa3b, v154
    ds_write_b32 v133, v154 offset:0
    v_mul_f32 v158, 0xbfb8aa3b, v158
    v_exp_f32 v158, v158
    v_max_f32 v152, 0, v152
    buffer_load_dwordx4 v123, s[48:51], s45 offen lds
    v_add_f32 v158, 1.0, v158
    v_rcp_f32 v158, v158
    v_max_f32 v153, 0, v153
    v_cvt_pk_bf16_f32 v158, v158, v158
    v_and_b32 v158, 0xffff0000, v158
    v_add_f32 v158, -0.5, v158
    v_mul_f32 v158, 0x41b8aa3b, v158
    ds_write_b32 v133, v158 offset:4
    s_waitcnt vmcnt(7)
    buffer_load_dwordx4 v125, s[48:51], s45 offen offset:1024 lds
    ds_read_b64_tr_b16 a[84:85], v224 offset:3072
    ds_read_b64_tr_b16 a[86:87], v224 offset:3840
    ds_read_b64_tr_b16 a[108:109], v224 offset:3104
    ds_read_b64_tr_b16 a[110:111], v224 offset:3872
    ds_read_b64_tr_b16 a[132:133], v224 offset:3136
    ds_read_b64_tr_b16 a[134:135], v224 offset:3904
    v_cvt_pk_bf16_f32 v118, v150, v151
    v_cvt_pk_bf16_f32 v119, v152, v153
    v_cndmask_b32 v139, v140, v139, vcc
    v_lshl_add_u32 v139, v121, 9, v139
    v_mfma_f32_16x16x16_bf16 v[150:153], v[196:197], v[118:119], 0
    buffer_load_dwordx4 v127, s[48:51], s45 offen offset:2048 lds
    s_add_u32 m0, s73, 3072
    v_lshl_add_u32 v139, v132, 1, v139
    v_cmp_gt_u32 vcc, 3, v255
    v_add3_u32 v129, v135, v137, s68
    v_lshl_add_u32 v192, v255, 3, v135
    v_cndmask_b32 v7, v141, v139, vcc
    v_cmp_gt_u32 vcc, 8, v116
    v_cvt_pk_bf16_f32 v150, v150, v150
    v_and_b32 v150, 0xffff0000, v150
    v_mul_f32 v150, 0xbfb8aa3b, v150
    v_exp_f32 v150, v150
    buffer_load_dwordx4 v123, s[48:51], s4 offen lds
    v_add_f32 v150, 1.0, v150
    v_rcp_f32 v150, v150
    v_cndmask_b32 v147, v143, v147, vcc
    v_cvt_pk_bf16_f32 v150, v150, v150
    v_and_b32 v150, 0xffff0000, v150
    v_add_f32 v150, -0.5, v150
    v_mul_f32 v150, 0x41b8aa3b, v150
    ds_write_b32 v133, v150 offset:8
    buffer_load_dwordx4 v125, s[48:51], s4 offen offset:1024 lds
    s_waitcnt vmcnt(8)
    ds_read_b64_tr_b16 a[88:89], v223 offset:0
    ds_read_b64_tr_b16 a[90:91], v223 offset:768
    ds_read_b64_tr_b16 a[112:113], v223 offset:32
    ds_read_b64_tr_b16 a[114:115], v223 offset:800
    ds_read_b64_tr_b16 a[136:137], v223 offset:64
    ds_read_b64_tr_b16 a[138:139], v223 offset:832
    v_cndmask_b32 v148, v143, v148, vcc
    v_cmp_gt_u32 vcc, 2, v255
    v_add3_u32 v192, v192, 64, s68
    v_add3_u32 v193, v135, v137, s69
    buffer_load_dwordx4 v127, s[48:51], s4 offen offset:2048 lds
    s_add_u32 m0, s68, 0
    s_add_u32 s4, s45, 73728
    s_waitcnt lgkmcnt(7)
    v_cndmask_b32 v149, v143, v149, vcc
    v_lshl_add_u32 v122, v255, 3, v135
    v_add3_u32 v122, v122, 64, s69
    s_waitcnt lgkmcnt(6)
    s_barrier
    ds_read_b32 v22, v22 offset:0
    ds_read_b32 v23, v23 offset:672
    ds_read_b32 v24, v24 offset:0
    ds_read_b32 v25, v25 offset:672
    ds_read_b32 v26, v26 offset:0
    ds_read_b32 v27, v27 offset:672
    buffer_load_dwordx4 v123, s[48:51], s4 offen lds
    ds_read_b32 v46, v46 offset:336
    ds_read_b32 v58, v58 offset:336
    ds_read_b32 v70, v70 offset:336
    ds_read_b32 v47, v47 offset:332
    ds_read_b32 v59, v59 offset:332
    ds_read_b32 v71, v71 offset:332
    ds_read_b32 v48, v48 offset:328
    ds_read_b32 v60, v60 offset:328
    buffer_load_dwordx4 v125, s[48:51], s4 offen offset:1024 lds
    s_waitcnt vmcnt(8)
    ds_read_b64_tr_b16 a[92:93], v223 offset:3072
    ds_read_b64_tr_b16 a[94:95], v223 offset:3840
    ds_read_b64_tr_b16 a[116:117], v223 offset:3104
    s_waitcnt lgkmcnt(15)
    ds_read_b64_tr_b16 a[118:119], v223 offset:3872
    s_waitcnt lgkmcnt(15)
    ds_read_b64_tr_b16 a[140:141], v223 offset:3136
    s_waitcnt lgkmcnt(14)
    ds_read_b64_tr_b16 a[142:143], v223 offset:3904
    ds_read_b32 v72, v72 offset:328
    ds_read_b32 v49, v49 offset:324
    buffer_load_dwordx4 v127, s[48:51], s4 offen offset:2048 lds
    ds_read_b32 v61, v61 offset:324
    ds_read_b32 v73, v73 offset:324
    ds_read_b32 v50, v50 offset:272
    ds_read_b32 v62, v62 offset:272
    s_add_u32 m0, s28, 128512
    ds_read_b32 v74, v74 offset:272
    s_add_u32 s4, s45, 110592
    ds_read_b32 v51, v51 offset:268
    ds_read_b32 v63, v63 offset:268
    ds_read_b32 v75, v75 offset:268
    buffer_load_dwordx4 v120, s[8:11], 0 offen nt lds
    ds_read_b32 v52, v52 offset:264
    ds_read_b32 v64, v64 offset:264
    ds_read_b32 v76, v76 offset:264
    s_add_u32 m0, s28, 132608
    ds_read_b32 v53, v53 offset:260
    ds_read_b32 v65, v65 offset:260
    ds_read_b32 v77, v77 offset:260
    ds_read_b32 v54, v54 offset:208
    ds_read_b32 v66, v66 offset:208
    buffer_load_dwordx4 v130, s[8:11], 0 offen nt lds
    ds_read_b32 v78, v78 offset:208
    ds_read_b32 v55, v55 offset:204
    s_waitcnt vmcnt(8)
    ds_read_b64_tr_b16 a[0:1], v225 offset:0
    ds_read_b64_tr_b16 a[2:3], v225 offset:768
    s_add_u32 m0, s28, 0
    ds_read_b64_tr_b16 a[24:25], v225 offset:32
    ds_read_b64_tr_b16 a[26:27], v225 offset:800
    ds_read_b64_tr_b16 a[48:49], v225 offset:64
    ds_read_b64_tr_b16 a[50:51], v225 offset:832
    buffer_load_dwordx4 v10, s[8:11], s25 offen nt lds
    ds_read_b32 v67, v67 offset:204
    ds_read_b32 v79, v79 offset:204
    ds_read_b32 v56, v56 offset:200
    ds_read_b32 v68, v68 offset:200
    s_add_u32 m0, s28, 4096
    ds_read_b32 v80, v80 offset:200
    ds_read_b32 v57, v57 offset:196
    ds_read_b32 v69, v69 offset:196
    ds_read_b32 v81, v81 offset:196
    buffer_load_dwordx4 v11, s[8:11], s25 offen nt lds
    ds_read_b32 v138, v138 offset:336
    s_add_u32 m0, s68, 3072
    v_cndmask_b32 v22, v195, v22, s[88:89]
    v_cndmask_b32 v24, v195, v24, s[88:89]
    v_cndmask_b32 v26, v195, v26, s[88:89]
    v_add_u32 v124, 16, v116
    v_cmp_gt_u32 s[94:95], s17, v124
    v_cmp_ne_u32 s[96:97], 0, v134
    v_cmp_lt_u32 s[98:99], 1, v132
    v_cmp_eq_u32 vcc, v255, v121
    v_sub_u32 v255, v145, v137
    v_sub_u32 v124, v148, v137
    buffer_load_dwordx4 v123, s[48:51], s4 offen lds
    v_cndmask_b32 v255, v143, v255, vcc
    v_cndmask_b32 v124, v143, v124, vcc
    v_mov_b32 v114, 0
    v_mov_b32 v115, 0
    s_waitcnt vmcnt(8)
    ds_read_b64_tr_b16 a[4:5], v225 offset:3072
    ds_read_b64_tr_b16 a[6:7], v225 offset:3840
    ds_read_b64_tr_b16 a[28:29], v225 offset:3104
    ds_read_b64_tr_b16 a[30:31], v225 offset:3872
    ds_read_b64_tr_b16 a[52:53], v225 offset:3136
    ds_read_b64_tr_b16 a[54:55], v225 offset:3904
    s_waitcnt lgkmcnt(6)
    ds_write_b64 v144, v[114:115] offset:56
    buffer_load_dwordx4 v125, s[48:51], s4 offen offset:1024 lds
    v_readfirstlane_b32 s39, v138
    v_mov_b32 v116, 0
    v_mov_b32 v117, 0
    ds_write_b128 v144, v[114:117] offset:16
    v_mov_b32 v118, v195
    v_mov_b32 v119, v195
    buffer_load_dwordx4 v127, s[48:51], s4 offen offset:2048 lds
    s_add_u32 m0, s69, 0
    s_add_u32 s4, s45, 147456
    ds_write_b64 v144, v[114:115] offset:64
    v_mov_b32 v120, v195
    v_mov_b32 v121, v195
    buffer_load_dwordx4 v123, s[48:51], s4 offen lds
    ds_write_b128 v147, v[114:117] offset:16
    s_waitcnt vmcnt(8)
    buffer_load_dwordx4 v125, s[48:51], s4 offen offset:1024 lds
    ds_read_b64_tr_b16 a[8:9], v222 offset:0
    ds_read_b64_tr_b16 a[10:11], v222 offset:768
    ds_read_b64_tr_b16 a[32:33], v222 offset:32
    ds_read_b64_tr_b16 a[34:35], v222 offset:800
    ds_read_b64_tr_b16 a[56:57], v222 offset:64
    ds_read_b64_tr_b16 a[58:59], v222 offset:832
    ds_write_b64 v147, v[114:115] offset:56
    buffer_load_dwordx4 v127, s[48:51], s4 offen offset:2048 lds
    ds_write_b64 v147, v[114:115] offset:64
    s_add_u32 m0, s69, 3072
    s_add_u32 s4, s45, 184320
    buffer_load_dwordx4 v123, s[48:51], s4 offen lds
    ds_write_b128 v145, v[118:121] offset:192
    buffer_load_dwordx4 v125, s[48:51], s4 offen offset:1024 lds
    ds_write_b128 v148, v[118:121] offset:192
    buffer_load_dwordx4 v127, s[48:51], s4 offen offset:2048 lds
    s_add_u32 m0, s68, 0
    s_add_u32 s4, s45, 768
    s_waitcnt lgkmcnt(1)
    buffer_load_dwordx4 v123, s[48:51], s4 offen lds
    s_waitcnt vmcnt(10)
    s_barrier
    ds_read_b128 v[114:117], v194 offset:6144
    ds_read_b128 v[118:121], v142 offset:6144
    ds_read_b128 v[130:133], v194 offset:6272
    ds_read_b128 v[134:137], v142 offset:6272
    ds_read_b128 v[138:141], v194 offset:6400
    ds_read_b128 v[150:153], v142 offset:6400
    buffer_load_dwordx4 v125, s[48:51], s4 offen offset:1024 lds
    ds_read_b128 v[154:157], v194 offset:0
    ds_read_b128 v[158:161], v142 offset:0
    ds_read_b128 v[162:165], v194 offset:128
    ds_read_b128 v[166:169], v142 offset:128
    s_waitcnt lgkmcnt(7)
    v_mfma_f32_16x16x32_bf16 v[170:173], a[72:75], v[114:117], 0
    buffer_load_dwordx4 v127, s[48:51], s4 offen offset:2048 lds
    v_mfma_f32_16x16x32_bf16 v[170:173], a[76:79], v[118:121], v[170:173]
    s_add_u32 m0, s68, 3072
    ds_read_b128 v[174:177], v194 offset:256
    ds_read_b128 v[178:181], v142 offset:256
    v_mfma_f32_16x16x32_bf16 v[170:173], a[80:83], v[130:133], v[170:173]
    s_waitcnt lgkmcnt(7)
    s_add_u32 s4, s45, 37632
    v_mfma_f32_16x16x32_bf16 v[170:173], a[84:87], v[134:137], v[170:173]
    s_waitcnt lgkmcnt(6)
    v_mfma_f32_16x16x32_bf16 v[170:173], a[88:91], v[138:141], v[170:173]
    s_waitcnt vmcnt(9)
    ds_read_b64_tr_b16 a[12:13], v222 offset:3072
    ds_read_b64_tr_b16 a[14:15], v222 offset:3840
    v_mfma_f32_16x16x32_bf16 v[170:173], a[92:95], v[150:153], v[170:173]
    s_waitcnt lgkmcnt(6)
    ds_read_b64_tr_b16 a[36:37], v222 offset:3104
    ds_read_b64_tr_b16 a[38:39], v222 offset:3872
    v_mfma_f32_16x16x32_bf16 v[182:185], a[96:99], v[114:117], 0
    s_waitcnt lgkmcnt(7)
    ds_read_b64_tr_b16 a[60:61], v222 offset:3136
    ds_read_b64_tr_b16 a[62:63], v222 offset:3904
    v_mfma_f32_16x16x32_bf16 v[182:185], a[100:103], v[118:121], v[182:185]
    s_waitcnt lgkmcnt(8)
    v_cvt_pk_f16_f32 v170, v170, v171
    v_pk_mul_f16 v143, v170, v170
    v_mfma_f32_16x16x32_bf16 v[182:185], a[104:107], v[130:133], v[182:185]
    v_cvt_pk_f16_f32 v171, v172, v173
    v_pk_mul_f16 v145, v171, v171
    v_mfma_f32_16x16x32_bf16 v[182:185], a[108:111], v[134:137], v[182:185]
    s_waitcnt lgkmcnt(6)
    v_mfma_f32_16x16x32_bf16 v[182:185], a[112:115], v[138:141], v[182:185]
    v_mfma_f32_16x16x32_bf16 v[182:185], a[116:119], v[150:153], v[182:185]
    v_mfma_f32_16x16x32_bf16 v[186:189], a[120:123], v[114:117], 0
    s_waitcnt lgkmcnt(4)
    v_mfma_f32_16x16x32_bf16 v[186:189], a[124:127], v[118:121], v[186:189]
    s_waitcnt lgkmcnt(2)
    v_mfma_f32_16x16x32_bf16 v[186:189], a[128:131], v[130:133], v[186:189]
    s_waitcnt lgkmcnt(0)
    buffer_load_dwordx4 v123, s[48:51], s4 offen lds
    v_mfma_f32_16x16x32_bf16 v[186:189], a[132:135], v[134:137], v[186:189]
    v_cvt_pk_f16_f32 v172, v182, v183
    v_pk_fma_f16 v143, v172, v172, v143
    v_mfma_f32_16x16x32_bf16 v[186:189], a[136:139], v[138:141], v[186:189]
    v_cvt_pk_f16_f32 v173, v184, v185
    s_waitcnt vmcnt(7)
    v_mfma_f32_16x16x32_bf16 v[186:189], a[140:143], v[150:153], v[186:189]
    ds_read_b64_tr_b16 a[16:17], v224 offset:0
    ds_read_b64_tr_b16 a[18:19], v224 offset:768
    v_mfma_f32_16x16x32_bf16 v[114:117], a[72:75], v[154:157], 0
    buffer_load_dwordx4 v125, s[48:51], s4 offen offset:1024 lds
    v_mfma_f32_16x16x32_bf16 v[114:117], a[76:79], v[158:161], v[114:117]
    ds_read_b64_tr_b16 a[40:41], v224 offset:32
    ds_read_b64_tr_b16 a[42:43], v224 offset:800
    v_mfma_f32_16x16x32_bf16 v[114:117], a[80:83], v[162:165], v[114:117]
    ds_read_b64_tr_b16 a[64:65], v224 offset:64
    ds_read_b64_tr_b16 a[66:67], v224 offset:832
    v_mfma_f32_16x16x32_bf16 v[114:117], a[84:87], v[166:169], v[114:117]
    ds_read_b128 v[130:133], v0 offset:20480
    ds_read_b128 v[134:137], v1 offset:20480
    v_mfma_f32_16x16x32_bf16 v[114:117], a[88:91], v[174:177], v[114:117]
    buffer_load_dwordx4 v127, s[48:51], s4 offen offset:2048 lds
    v_mfma_f32_16x16x32_bf16 v[114:117], a[92:95], v[178:181], v[114:117]
    s_add_u32 m0, s69, 0
    ds_read_b128 v[138:141], v0 offset:20608
    ds_read_b128 v[150:153], v1 offset:20608
    v_mfma_f32_16x16x32_bf16 v[118:121], a[96:99], v[154:157], 0
    s_add_u32 s4, s45, 74496
    ds_read_b128 v[198:201], v0 offset:20736
    ds_read_b128 v[202:205], v1 offset:20736
    v_mfma_f32_16x16x32_bf16 v[118:121], a[100:103], v[158:161], v[118:121]
    s_waitcnt lgkmcnt(10)
    v_pk_fma_f16 v145, v173, v173, v145
    v_cvt_pk_f16_f32 v212, v186, v187
    v_mfma_f32_16x16x32_bf16 v[118:121], a[104:107], v[162:165], v[118:121]
    v_pk_fma_f16 v143, v212, v212, v143
    v_cvt_pk_f16_f32 v213, v188, v189
    v_mfma_f32_16x16x32_bf16 v[118:121], a[108:111], v[166:169], v[118:121]
    s_waitcnt lgkmcnt(8)
    v_pk_fma_f16 v145, v213, v213, v145
    v_cvt_pk_f16_f32 v114, v114, v115
    v_mfma_f32_16x16x32_bf16 v[118:121], a[112:115], v[174:177], v[118:121]
    s_waitcnt lgkmcnt(6)
    buffer_load_dwordx4 v123, s[48:51], s4 offen lds
    s_waitcnt vmcnt(7)
    v_mfma_f32_16x16x32_bf16 v[118:121], a[116:119], v[178:181], v[118:121]
    s_waitcnt lgkmcnt(4)
    ds_read_b64_tr_b16 a[20:21], v224 offset:3072
    ds_read_b64_tr_b16 a[22:23], v224 offset:3840
    v_mfma_f32_16x16x32_bf16 v[182:185], a[120:123], v[154:157], 0
    s_waitcnt lgkmcnt(5)
    ds_read_b64_tr_b16 a[44:45], v224 offset:3104
    ds_read_b64_tr_b16 a[46:47], v224 offset:3872
    v_mfma_f32_16x16x32_bf16 v[182:185], a[124:127], v[158:161], v[182:185]
    s_waitcnt lgkmcnt(5)
    ds_read_b64_tr_b16 a[68:69], v224 offset:3136
    ds_read_b64_tr_b16 a[70:71], v224 offset:3904
    v_mfma_f32_16x16x32_bf16 v[182:185], a[128:131], v[162:165], v[182:185]
    s_waitcnt lgkmcnt(6)
    buffer_load_dwordx4 v125, s[48:51], s4 offen offset:1024 lds
    v_mfma_f32_16x16x32_bf16 v[182:185], a[132:135], v[166:169], v[182:185]
    v_pk_mul_f16 v187, v114, v114
    v_cvt_pk_f16_f32 v115, v116, v117
    v_mfma_f32_16x16x32_bf16 v[182:185], a[136:139], v[174:177], v[182:185]
    v_pk_mul_f16 v189, v115, v115
    v_cvt_pk_f16_f32 v116, v118, v119
    v_mfma_f32_16x16x32_bf16 v[182:185], a[140:143], v[178:181], v[182:185]
    v_pk_fma_f16 v187, v116, v116, v187
    v_cvt_pk_f16_f32 v117, v120, v121
    v_mfma_f32_16x16x32_bf16 v[118:121], a[0:3], v[154:157], 0
    buffer_load_dwordx4 v127, s[48:51], s4 offen offset:2048 lds
    v_mfma_f32_16x16x32_bf16 v[118:121], a[4:7], v[158:161], v[118:121]
    s_add_u32 m0, s69, 3072
    v_pk_fma_f16 v189, v117, v117, v189
    s_add_u32 s4, s45, 111360
    v_mfma_f32_16x16x32_bf16 v[118:121], a[8:11], v[162:165], v[118:121]
    s_waitcnt lgkmcnt(2)
    v_cvt_pk_f16_f32 v208, v182, v183
    v_pk_fma_f16 v187, v208, v208, v187
    v_mfma_f32_16x16x32_bf16 v[118:121], a[12:15], v[166:169], v[118:121]
    s_waitcnt lgkmcnt(0)
    v_cvt_pk_f16_f32 v209, v184, v185
    v_pk_fma_f16 v189, v209, v209, v189
    v_mfma_f32_16x16x32_bf16 v[118:121], a[16:19], v[174:177], v[118:121]
    buffer_load_dwordx4 v123, s[48:51], s4 offen lds
    v_mfma_f32_16x16x32_bf16 v[118:121], a[20:23], v[178:181], v[118:121]
    s_waitcnt vmcnt(7)
    ds_read_b64_tr_b16 a[144:145], v222 offset:0
    ds_read_b64_tr_b16 a[146:147], v222 offset:768
    v_mfma_f32_16x16x32_bf16 v[182:185], a[24:27], v[154:157], 0
    ds_read_b64_tr_b16 a[168:169], v222 offset:32
    ds_read_b64_tr_b16 a[170:171], v222 offset:800
    v_mfma_f32_16x16x32_bf16 v[182:185], a[28:31], v[158:161], v[182:185]
    ds_read_b64_tr_b16 a[192:193], v222 offset:64
    ds_read_b64_tr_b16 a[194:195], v222 offset:832
    v_mfma_f32_16x16x32_bf16 v[182:185], a[32:35], v[162:165], v[182:185]
    buffer_load_dwordx4 v125, s[48:51], s4 offen offset:1024 lds
    v_mfma_f32_16x16x32_bf16 v[182:185], a[36:39], v[166:169], v[182:185]
    v_cvt_pk_f16_f32 v214, v118, v119
    v_pk_mul_f16 v186, v214, v214
    v_mfma_f32_16x16x32_bf16 v[182:185], a[40:43], v[174:177], v[182:185]
    v_cvt_pk_f16_f32 v215, v120, v121
    v_pk_mul_f16 v188, v215, v215
    v_mfma_f32_16x16x32_bf16 v[182:185], a[44:47], v[178:181], v[182:185]
    v_mfma_f32_16x16x32_bf16 v[118:121], a[48:51], v[154:157], 0
    buffer_load_dwordx4 v127, s[48:51], s4 offen offset:2048 lds
    v_mfma_f32_16x16x32_bf16 v[118:121], a[52:55], v[158:161], v[118:121]
    s_add_u32 m0, s68, 0
    s_add_u32 s4, s45, 148224
    v_mfma_f32_16x16x32_bf16 v[118:121], a[56:59], v[162:165], v[118:121]
    s_waitcnt lgkmcnt(2)
    v_mfma_f32_16x16x32_bf16 v[118:121], a[60:63], v[166:169], v[118:121]
    s_waitcnt lgkmcnt(0)
    v_cvt_pk_f16_f32 v216, v182, v183
    v_pk_fma_f16 v186, v216, v216, v186
    v_mfma_f32_16x16x32_bf16 v[118:121], a[64:67], v[174:177], v[118:121]
    buffer_load_dwordx4 v123, s[48:51], s4 offen lds
    v_mfma_f32_16x16x32_bf16 v[118:121], a[68:71], v[178:181], v[118:121]
    v_cvt_pk_f16_f32 v217, v184, v185
    v_pk_fma_f16 v188, v217, v217, v188
    s_waitcnt vmcnt(7)
    v_mfma_f32_16x16x32_bf16 v[158:161], a[72:75], v[130:133], 0
    ds_read_b64_tr_b16 a[148:149], v222 offset:3072
    ds_read_b64_tr_b16 a[150:151], v222 offset:3840
    v_mfma_f32_16x16x32_bf16 v[158:161], a[76:79], v[134:137], v[158:161]
    ds_read_b64_tr_b16 a[172:173], v222 offset:3104
    ds_read_b64_tr_b16 a[174:175], v222 offset:3872
    v_mfma_f32_16x16x32_bf16 v[158:161], a[80:83], v[138:141], v[158:161]
    buffer_load_dwordx4 v125, s[48:51], s4 offen offset:1024 lds
    v_mfma_f32_16x16x32_bf16 v[158:161], a[84:87], v[150:153], v[158:161]
    ds_read_b64_tr_b16 a[196:197], v222 offset:3136
    ds_read_b64_tr_b16 a[198:199], v222 offset:3904
    v_mfma_f32_16x16x32_bf16 v[158:161], a[88:91], v[198:201], v[158:161]
    ds_read_b128 v[162:165], v194 offset:6144
    ds_read_b128 v[166:169], v142 offset:6144
    v_mfma_f32_16x16x32_bf16 v[158:161], a[92:95], v[202:205], v[158:161]
    ds_read_b128 v[178:181], v194 offset:6272
    ds_read_b128 v[218:221], v142 offset:6272
    v_mfma_f32_16x16x32_bf16 v[230:233], a[96:99], v[130:133], 0
    buffer_load_dwordx4 v127, s[48:51], s4 offen offset:2048 lds
    v_mfma_f32_16x16x32_bf16 v[230:233], a[100:103], v[134:137], v[230:233]
    s_add_u32 m0, s68, 3072
    ds_read_b128 v[226:229], v194 offset:6400
    ds_read_b128 v[234:237], v142 offset:6400
    v_mfma_f32_16x16x32_bf16 v[230:233], a[104:107], v[138:141], v[230:233]
    s_add_u32 s4, s45, 185088
    v_cvt_pk_f16_f32 v206, v118, v119
    v_pk_fma_f16 v186, v206, v206, v186
    v_mfma_f32_16x16x32_bf16 v[230:233], a[108:111], v[150:153], v[230:233]
    s_sub_u32 s45, s17, 1
    v_cvt_pk_f16_f32 v207, v120, v121
    v_pk_fma_f16 v188, v207, v207, v188
    v_mfma_f32_16x16x32_bf16 v[230:233], a[112:115], v[198:201], v[230:233]
    s_waitcnt lgkmcnt(8)
    v_cvt_pk_f16_f32 v118, v158, v159
    v_pk_mul_f16 v223, v118, v118
    v_mfma_f32_16x16x32_f16 v[174:177], v[40:43], v[186:189], 0
    s_waitcnt lgkmcnt(6)
    buffer_load_dwordx4 v123, s[48:51], s4 offen lds
    v_mfma_f32_16x16x32_bf16 v[230:233], a[116:119], v[202:205], v[230:233]
    s_waitcnt lgkmcnt(4)
    v_cvt_pk_f16_f32 v119, v160, v161
    v_pk_mul_f16 v225, v119, v119
    v_mfma_f32_16x16x32_bf16 v[186:189], a[120:123], v[130:133], 0
    s_waitcnt lgkmcnt(2)
    v_rsq_f32 v176, v174
    s_waitcnt vmcnt(7)
    v_mfma_f32_16x16x32_bf16 v[186:189], a[124:127], v[134:137], v[186:189]
    s_waitcnt lgkmcnt(1)
    ds_read_b64_tr_b16 a[152:153], v224 offset:0
    ds_read_b64_tr_b16 a[154:155], v224 offset:768
    v_mfma_f32_16x16x32_bf16 v[186:189], a[128:131], v[138:141], v[186:189]
    s_waitcnt lgkmcnt(2)
    buffer_load_dwordx4 v125, s[48:51], s4 offen offset:1024 lds
    v_mfma_f32_16x16x32_bf16 v[186:189], a[132:135], v[150:153], v[186:189]
    ds_read_b64_tr_b16 a[176:177], v224 offset:32
    ds_read_b64_tr_b16 a[178:179], v224 offset:800
    v_mfma_f32_16x16x32_bf16 v[186:189], a[136:139], v[198:201], v[186:189]
    ds_read_b64_tr_b16 a[200:201], v224 offset:64
    ds_read_b64_tr_b16 a[202:203], v224 offset:832
    v_mfma_f32_16x16x32_bf16 v[186:189], a[140:143], v[202:205], v[186:189]
    v_rsq_f32 v177, v175
    v_mfma_f32_16x16x32_bf16 v[154:157], a[0:3], v[130:133], 0
    buffer_load_dwordx4 v127, s[48:51], s4 offen offset:2048 lds
    v_mfma_f32_16x16x32_bf16 v[154:157], a[4:7], v[134:137], v[154:157]
    s_add_u32 m0, s28, 8192
    ds_read_b128 v[158:161], v194 offset:0
    ds_read_b128 v[238:241], v142 offset:0
    v_mfma_f32_16x16x32_bf16 v[154:157], a[8:11], v[138:141], v[154:157]
    s_add_u32 s4, 0, 12288
    v_mul_f32 v176, s31, v176
    v_cvt_pk_f16_f32 v176, v176, v177
    v_mfma_f32_16x16x32_bf16 v[154:157], a[12:15], v[150:153], v[154:157]
    s_waitcnt lgkmcnt(6)
    ds_read_b128 v[242:245], v194 offset:128
    v_pk_mul_f16 v114, v114, v176 op_sel:[0,1] op_sel_hi:[1,1]
    v_mfma_f32_16x16x32_bf16 v[154:157], a[16:19], v[198:201], v[154:157]
    buffer_load_dwordx4 v12, s[8:11], s25 offen nt lds
    v_mfma_f32_16x16x32_bf16 v[154:157], a[20:23], v[202:205], v[154:157]
    s_add_u32 m0, s28, 12288
    v_pk_mul_f16 v115, v115, v176 op_sel:[0,1] op_sel_hi:[1,1]
    v_pk_mul_f16 v116, v116, v176 op_sel:[0,1] op_sel_hi:[1,1]
    v_pk_mul_f16 v117, v117, v176 op_sel:[0,1] op_sel_hi:[1,1]
    v_pk_mul_f16 v208, v208, v176 op_sel:[0,1] op_sel_hi:[1,1]
    v_pk_mul_f16 v209, v209, v176 op_sel:[0,1] op_sel_hi:[1,1]
    v_pk_mul_f16 v214, v214, v176 op_sel:[0,0] op_sel_hi:[1,0]
    s_waitcnt vmcnt(7)
    ds_read_b64_tr_b16 a[156:157], v224 offset:3072
    ds_read_b64_tr_b16 a[158:159], v224 offset:3840
    ds_read_b64_tr_b16 a[180:181], v224 offset:3104
    ds_read_b64_tr_b16 a[182:183], v224 offset:3872
    buffer_load_dwordx4 v13, s[8:11], s25 offen nt lds
    ds_read_b64_tr_b16 a[204:205], v224 offset:3136
    ds_read_b64_tr_b16 a[206:207], v224 offset:3904
    ds_write_b128 v144, v[114:117]
    s_add_u32 m0, s29, 0
    v_pk_mul_f16 v215, v215, v176 op_sel:[0,0] op_sel_hi:[1,0]
    v_pk_mul_f16 v216, v216, v176 op_sel:[0,0] op_sel_hi:[1,0]
    v_pk_mul_f16 v217, v217, v176 op_sel:[0,0] op_sel_hi:[1,0]
    v_pk_mul_f16 v206, v206, v176 op_sel:[0,0] op_sel_hi:[1,0]
    buffer_load_dwordx4 v14, s[8:11], s25 offen nt lds
    ds_write_b64 v144, v[208:209] offset:48
    s_add_u32 m0, s69, 0
    s_waitcnt lgkmcnt(8)
    s_cmp_lt_u32 1, s17
    s_cselect_b32 s10, s36, 0
    v_pk_mul_f16 v207, v207, v176 op_sel:[0,0] op_sel_hi:[1,0]
    v_min3_u32 v44, v44, v174, v175
    v_max3_u32 v45, v45, v174, v175
    v_mfma_f32_16x16x32_f16 v[246:249], v[114:117], v[214:217], 0
    s_mov_b32 s25, s24
    ds_read_b128 v[114:117], v142 offset:128
    ds_write_b128 v144, v[214:217] offset:32
    v_mfma_f32_16x16x32_bf16 v[174:177], a[24:27], v[130:133], 0
    s_waitcnt lgkmcnt(3)
    buffer_load_dwordx4 v126, s[52:55], 0 offen lds
    v_cvt_pk_f16_f32 v120, v230, v231
    v_pk_fma_f16 v223, v120, v120, v223
    v_mfma_f32_16x16x16_f16 v[246:249], v[208:209], v[206:207], v[246:249]
    v_cvt_pk_f16_f32 v121, v232, v233
    v_pk_fma_f16 v225, v121, v121, v225
    v_cvt_pk_f16_f32 v196, v186, v187
    s_waitcnt vmcnt(7)
    v_mfma_f32_16x16x32_bf16 v[174:177], a[28:31], v[134:137], v[174:177]
    ds_read_b64_tr_b16 a[160:161], v222 offset:0
    ds_read_b64_tr_b16 a[162:163], v222 offset:768
    v_mfma_f32_16x16x32_bf16 v[174:177], a[32:35], v[138:141], v[174:177]
    ds_read_b64_tr_b16 a[184:185], v222 offset:32
    ds_read_b64_tr_b16 a[186:187], v222 offset:800
    v_mfma_f32_16x16x32_bf16 v[174:177], a[36:39], v[150:153], v[174:177]
    buffer_load_dwordx4 v254, s[52:55], 0 offen offset:1024 lds
    ds_read_b64_tr_b16 a[208:209], v222 offset:64
    v_mfma_f32_16x16x32_bf16 v[174:177], a[40:43], v[198:201], v[174:177]
    s_waitcnt lgkmcnt(5)
    ds_read_b64_tr_b16 a[210:211], v222 offset:832
    ds_read_b128 v[214:217], v194 offset:256
    v_mfma_f32_16x16x32_bf16 v[174:177], a[44:47], v[202:205], v[174:177]
    ds_write_b64 v144, v[206:207] offset:72
    v_mfma_f32_16x16x32_bf16 v[182:185], a[48:51], v[130:133], 0
    v_cndmask_b32 v246, v246, v247, s[96:97]
    v_cndmask_b32 v248, v248, v249, s[96:97]
    v_mfma_f32_16x16x32_bf16 v[182:185], a[52:55], v[134:137], v[182:185]
    buffer_load_dwordx4 v128, s[52:55], 0 offen offset:2048 lds
    ds_read_b128 v[130:133], v142 offset:256
    v_mfma_f32_16x16x32_bf16 v[182:185], a[56:59], v[138:141], v[182:185]
    s_add_u32 m0, s69, 3072
    v_cndmask_b32 v246, v246, v248, s[98:99]
    v_add_f32 v246, s39, v246
    v_mfma_f32_16x16x32_bf16 v[182:185], a[60:63], v[150:153], v[182:185]
    s_waitcnt lgkmcnt(6)
    ds_write_b32 v255, v246 offset:192
    v_mfma_f32_16x16x32_bf16 v[182:185], a[64:67], v[198:201], v[182:185]
    s_waitcnt lgkmcnt(6)
    v_pk_fma_f16 v223, v196, v196, v223
    v_cvt_pk_f16_f32 v197, v188, v189
    v_mfma_f32_16x16x32_bf16 v[182:185], a[68:71], v[202:205], v[182:185]
    s_waitcnt lgkmcnt(4)
    buffer_load_dwordx4 v126, s[52:55], s4 offen lds
    v_mfma_f32_16x16x32_bf16 v[134:137], a[0:3], v[162:165], 0
    s_waitcnt lgkmcnt(2)
    ds_read_b128 v[138:141], v194 offset:6144
    v_pk_fma_f16 v225, v197, v197, v225
    s_waitcnt vmcnt(7)
    v_mfma_f32_16x16x32_bf16 v[134:137], a[4:7], v[166:169], v[134:137]
    ds_read_b64_tr_b16 a[164:165], v222 offset:3072
    ds_read_b64_tr_b16 a[166:167], v222 offset:3840
    v_mfma_f32_16x16x32_bf16 v[134:137], a[8:11], v[178:181], v[134:137]
    ds_read_b64_tr_b16 a[188:189], v222 offset:3104
    ds_read_b64_tr_b16 a[190:191], v222 offset:3872
    v_mfma_f32_16x16x32_bf16 v[134:137], a[12:15], v[218:221], v[134:137]
    s_waitcnt lgkmcnt(6)
    buffer_load_dwordx4 v254, s[52:55], s4 offen offset:1024 lds
    v_mfma_f32_16x16x32_bf16 v[134:137], a[16:19], v[226:229], v[134:137]
    ds_read_b64_tr_b16 a[212:213], v222 offset:3136
    ds_read_b64_tr_b16 a[214:215], v222 offset:3904
    v_mfma_f32_16x16x32_bf16 v[134:137], a[20:23], v[234:237], v[134:137]
    ds_read_b128 v[150:153], v142 offset:6144
    ds_read_b128 v[186:189], v194 offset:6272
    v_mfma_f32_16x16x32_bf16 v[198:201], a[24:27], v[162:165], 0
    ds_read_b128 v[202:205], v142 offset:6272
    v_cvt_pk_f16_f32 v206, v154, v155
    v_mfma_f32_16x16x32_bf16 v[198:201], a[28:31], v[166:169], v[198:201]
    s_waitcnt lgkmcnt(9)
    buffer_load_dwordx4 v128, s[52:55], s4 offen offset:2048 lds
    v_mfma_f32_16x16x32_bf16 v[198:201], a[32:35], v[178:181], v[198:201]
    s_add_u32 m0, s68, 0
    ds_read_b128 v[230:233], v194 offset:6400
    v_pk_mul_f16 v222, v206, v206
    v_mfma_f32_16x16x32_bf16 v[198:201], a[36:39], v[218:221], v[198:201]
    s_add_u32 s4, 0, 24576
    v_cvt_pk_f16_f32 v207, v156, v157
    v_pk_mul_f16 v224, v207, v207
    v_mfma_f32_16x16x32_bf16 v[198:201], a[40:43], v[226:229], v[198:201]
    s_waitcnt lgkmcnt(6)
    v_cvt_pk_f16_f32 v208, v174, v175
    v_pk_fma_f16 v222, v208, v208, v222
    v_mfma_f32_16x16x32_bf16 v[198:201], a[44:47], v[234:237], v[198:201]
    buffer_load_dwordx4 v126, s[52:55], s4 offen lds
    v_cvt_pk_f16_f32 v209, v176, v177
    v_pk_fma_f16 v224, v209, v209, v224
    v_cvt_pk_f16_f32 v194, v182, v183
    v_pk_fma_f16 v222, v194, v194, v222
    v_cvt_pk_f16_f32 v195, v184, v185
    v_mfma_f32_16x16x32_bf16 v[154:157], a[48:51], v[162:165], 0
    s_waitcnt lgkmcnt(1)
    ds_read_b128 v[162:165], v142 offset:6400
    v_pk_fma_f16 v224, v195, v195, v224
    v_mfma_f32_16x16x32_bf16 v[154:157], a[52:55], v[166:169], v[154:157]
    v_cvt_pk_f16_f32 v134, v134, v135
    v_pk_mul_f16 v142, v134, v134
    v_mfma_f32_16x16x32_f16 v[166:169], v[40:43], v[222:225], 0
    s_waitcnt lgkmcnt(1)
    v_cvt_pk_f16_f32 v135, v136, v137
    v_pk_mul_f16 v144, v135, v135
    v_mfma_f32_16x16x32_bf16 v[154:157], a[56:59], v[178:181], v[154:157]
    v_cvt_pk_f16_f32 v136, v198, v199
    v_pk_fma_f16 v142, v136, v136, v142
    v_mfma_f32_16x16x32_bf16 v[154:157], a[60:63], v[218:221], v[154:157]
    v_cvt_pk_f16_f32 v137, v200, v201
    v_min3_u32 v44, v44, v166, v167
    v_mfma_f32_16x16x32_bf16 v[154:157], a[64:67], v[226:229], v[154:157]
    v_rsq_f32 v168, v166
    v_mfma_f32_16x16x32_bf16 v[154:157], a[68:71], v[234:237], v[154:157]
    v_rsq_f32 v169, v167
    v_mfma_f32_16x16x32_bf16 v[174:177], v[158:161], a[144:147], 0
    ds_read_b128 v[178:181], v0 offset:20480
    v_mul_f32 v168, s31, v168
    v_mfma_f32_16x16x32_bf16 v[174:177], v[238:241], a[148:151], v[174:177]
    s_waitcnt lgkmcnt(1)
    ds_read_b128 v[182:185], v1 offset:20480
    v_cvt_pk_f16_f32 v168, v168, v169
    v_mfma_f32_16x16x32_bf16 v[174:177], v[242:245], a[152:155], v[174:177]
    ds_read_b128 v[198:201], v0 offset:20608
    v_pk_mul_f16 v118, v118, v168 op_sel:[0,1] op_sel_hi:[1,1]
    v_mfma_f32_16x16x32_bf16 v[174:177], v[114:117], a[156:159], v[174:177]
    ds_read_b128 v[218:221], v1 offset:20608
    v_pk_mul_f16 v119, v119, v168 op_sel:[0,1] op_sel_hi:[1,1]
    v_mfma_f32_16x16x32_bf16 v[174:177], v[214:217], a[160:163], v[174:177]
    ds_read_b128 v[222:225], v0 offset:20736
    v_pk_mul_f16 v120, v120, v168 op_sel:[0,1] op_sel_hi:[1,1]
    v_mfma_f32_16x16x32_bf16 v[174:177], v[130:133], a[164:167], v[174:177]
    v_pk_mul_f16 v121, v121, v168 op_sel:[0,1] op_sel_hi:[1,1]
    v_pk_mul_f16 v196, v196, v168 op_sel:[0,1] op_sel_hi:[1,1]
    v_pk_mul_f16 v197, v197, v168 op_sel:[0,1] op_sel_hi:[1,1]
    v_pk_mul_f16 v206, v206, v168 op_sel:[0,0] op_sel_hi:[1,0]
    v_pk_mul_f16 v207, v207, v168 op_sel:[0,0] op_sel_hi:[1,0]
    v_pk_mul_f16 v208, v208, v168 op_sel:[0,0] op_sel_hi:[1,0]
    v_pk_mul_f16 v209, v209, v168 op_sel:[0,0] op_sel_hi:[1,0]
    v_pk_mul_f16 v194, v194, v168 op_sel:[0,0] op_sel_hi:[1,0]
    v_pk_mul_f16 v195, v195, v168 op_sel:[0,0] op_sel_hi:[1,0]
    v_max3_u32 v45, v45, v166, v167
    v_pk_fma_f16 v144, v137, v137, v144
    v_cvt_pk_f16_f32 v210, v154, v155
    v_mfma_f32_16x16x32_bf16 v[166:169], v[158:161], a[168:171], 0
    s_waitcnt lgkmcnt(3)
    v_pk_fma_f16 v142, v210, v210, v142
    v_cvt_pk_f16_f32 v211, v156, v157
    v_mfma_f32_16x16x32_bf16 v[166:169], v[238:241], a[172:175], v[166:169]
    s_waitcnt lgkmcnt(2)
    v_pk_fma_f16 v144, v211, v211, v144
    v_cvt_pk_bf16_f32 v174, v174, v174
    v_mfma_f32_16x16x32_bf16 v[166:169], v[242:245], a[176:179], v[166:169]
    s_waitcnt lgkmcnt(1)
    v_cvt_pk_bf16_f32 v175, v175, v175
    v_cvt_pk_bf16_f32 v176, v176, v176
    v_mfma_f32_16x16x32_bf16 v[166:169], v[114:117], a[180:183], v[166:169]
    s_waitcnt lgkmcnt(0)
    ds_write2_b32 v146, v174, v175 offset0:0 offset1:68
    v_mfma_f32_16x16x32_bf16 v[166:169], v[214:217], a[184:187], v[166:169]
    v_cvt_pk_bf16_f32 v177, v177, v177
    v_xor_b32 v255, 65536, v2
    v_mfma_f32_16x16x32_bf16 v[166:169], v[130:133], a[188:191], v[166:169]
    ds_write2_b32 v146, v176, v177 offset0:136 offset1:204
    v_mfma_f32_16x16x32_f16 v[154:157], v[40:43], v[142:145], 0
    v_lshrrev_b32 v127, 2, v255
    v_lshrrev_b32 v123, 8, v255
    v_mfma_f32_16x16x32_bf16 v[142:145], v[158:161], a[192:195], 0
    ds_read_b128 v[158:161], v1 offset:20736
    v_add_u32 v255, 157184, v255
    v_mfma_f32_16x16x32_bf16 v[142:145], v[238:241], a[196:199], v[142:145]
    v_cvt_pk_bf16_f32 v166, v166, v166
    v_cvt_pk_bf16_f32 v167, v167, v167
    v_mfma_f32_16x16x32_bf16 v[142:145], v[242:245], a[200:203], v[142:145]
    ds_write2_b32 v146, v166, v167 offset0:16 offset1:84
    v_mfma_f32_16x16x32_bf16 v[142:145], v[114:117], a[204:207], v[142:145]
    v_rsq_f32 v156, v154
    v_mfma_f32_16x16x32_bf16 v[142:145], v[214:217], a[208:211], v[142:145]
    v_rsq_f32 v157, v155
    v_mfma_f32_16x16x32_bf16 v[142:145], v[130:133], a[212:215], v[142:145]
    v_mul_f32 v156, s31, v156
    v_cvt_pk_f16_f32 v156, v156, v157
    v_mfma_f32_16x16x32_bf16 v[114:117], v[138:141], a[144:147], 0
    v_pk_mul_f16 v170, v170, v156 op_sel:[0,1] op_sel_hi:[1,1]
    v_pk_mul_f16 v171, v171, v156 op_sel:[0,1] op_sel_hi:[1,1]
    v_mfma_f32_16x16x32_bf16 v[114:117], v[150:153], a[148:151], v[114:117]
    s_waitcnt lgkmcnt(1)
    v_pk_mul_f16 v172, v172, v156 op_sel:[0,1] op_sel_hi:[1,1]
    v_pk_mul_f16 v173, v173, v156 op_sel:[0,1] op_sel_hi:[1,1]
    v_mfma_f32_16x16x32_bf16 v[114:117], v[186:189], a[152:155], v[114:117]
    ds_write_b128 v147, v[170:173]
    v_mfma_f32_16x16x32_bf16 v[114:117], v[202:205], a[156:159], v[114:117]
    v_pk_mul_f16 v212, v212, v156 op_sel:[0,1] op_sel_hi:[1,1]
    v_pk_mul_f16 v213, v213, v156 op_sel:[0,1] op_sel_hi:[1,1]
    v_mfma_f32_16x16x32_bf16 v[114:117], v[230:233], a[160:163], v[114:117]
    v_pk_mul_f16 v134, v134, v156 op_sel:[0,0] op_sel_hi:[1,0]
    v_pk_mul_f16 v135, v135, v156 op_sel:[0,0] op_sel_hi:[1,0]
    v_mfma_f32_16x16x32_bf16 v[114:117], v[162:165], a[164:167], v[114:117]
    ds_write_b64 v147, v[212:213] offset:48
    v_mfma_f32_16x16x32_bf16 v[130:133], v[138:141], a[168:171], 0
    v_pk_mul_f16 v136, v136, v156 op_sel:[0,0] op_sel_hi:[1,0]
    v_pk_mul_f16 v137, v137, v156 op_sel:[0,0] op_sel_hi:[1,0]
    v_mfma_f32_16x16x32_bf16 v[130:133], v[150:153], a[172:175], v[130:133]
    ds_write_b128 v147, v[134:137] offset:32
    v_mfma_f32_16x16x32_f16 v[174:177], v[170:173], v[134:137], 0
    v_pk_mul_f16 v210, v210, v156 op_sel:[0,0] op_sel_hi:[1,0]
    v_pk_mul_f16 v211, v211, v156 op_sel:[0,0] op_sel_hi:[1,0]
    v_mfma_f32_16x16x32_bf16 v[130:133], v[186:189], a[176:179], v[130:133]
    v_cndmask_b32 v154, 1.0, v154, s[94:95]
    v_cndmask_b32 v155, 1.0, v155, s[94:95]
    v_mfma_f32_16x16x32_bf16 v[130:133], v[202:205], a[180:183], v[130:133]
    ds_write_b64 v147, v[210:211] offset:72
    v_mfma_f32_16x16x16_f16 v[174:177], v[212:213], v[210:211], v[174:177]
    v_min3_u32 v44, v44, v154, v155
    v_max3_u32 v45, v45, v154, v155
    v_cvt_pk_bf16_f32 v168, v168, v168
    v_cvt_pk_bf16_f32 v169, v169, v169
    v_mfma_f32_16x16x32_bf16 v[130:133], v[230:233], a[184:187], v[130:133]
    ds_write2_b32 v146, v168, v169 offset0:152 offset1:220
    v_mfma_f32_16x16x32_bf16 v[130:133], v[162:165], a[188:191], v[130:133]
    v_cvt_pk_bf16_f32 v142, v142, v142
    v_cndmask_b32 v174, v174, v175, s[96:97]
    v_mfma_f32_16x16x32_bf16 v[134:137], v[138:141], a[192:195], 0
    v_cndmask_b32 v176, v176, v177, s[96:97]
    v_cndmask_b32 v174, v174, v176, s[98:99]
    v_mfma_f32_16x16x32_bf16 v[134:137], v[150:153], a[196:199], v[134:137]
    v_add_f32 v174, s39, v174
    v_cvt_pk_bf16_f32 v143, v143, v143
    v_mfma_f32_16x16x32_bf16 v[134:137], v[186:189], a[200:203], v[134:137]
    ds_write_b32 v124, v174 offset:192
    v_mfma_f32_16x16x32_bf16 v[134:137], v[202:205], a[204:207], v[134:137]
    v_cvt_pk_bf16_f32 v144, v144, v144
    v_cvt_pk_bf16_f32 v145, v145, v145
    v_mfma_f32_16x16x32_bf16 v[134:137], v[230:233], a[208:211], v[134:137]
    ds_write2_b32 v146, v142, v143 offset0:32 offset1:100
    v_mfma_f32_16x16x32_bf16 v[134:137], v[162:165], a[212:215], v[134:137]
    v_cvt_pk_bf16_f32 v114, v114, v114
    v_cvt_pk_bf16_f32 v115, v115, v115
    v_mfma_f32_16x16x32_bf16 v[230:233], v[178:181], a[144:147], 0
    ds_write2_b32 v146, v144, v145 offset0:168 offset1:236
    v_mfma_f32_16x16x32_bf16 v[230:233], v[182:185], a[148:151], v[230:233]
    v_cvt_pk_bf16_f32 v116, v116, v116
    v_cvt_pk_bf16_f32 v117, v117, v117
    v_mfma_f32_16x16x32_bf16 v[230:233], v[198:201], a[152:155], v[230:233]
    ds_write2_b32 v149, v114, v115 offset0:0 offset1:68
    v_mfma_f32_16x16x32_bf16 v[230:233], v[218:221], a[156:159], v[230:233]
    v_cvt_pk_bf16_f32 v130, v130, v130
    v_cvt_pk_bf16_f32 v131, v131, v131
    v_mfma_f32_16x16x32_bf16 v[230:233], v[222:225], a[160:163], v[230:233]
    ds_write2_b32 v149, v116, v117 offset0:136 offset1:204
    v_mfma_f32_16x16x32_bf16 v[230:233], v[158:161], a[164:167], v[230:233]
    v_cvt_pk_bf16_f32 v132, v132, v132
    v_cvt_pk_bf16_f32 v133, v133, v133
    v_mfma_f32_16x16x32_bf16 v[114:117], v[178:181], a[168:171], 0
    ds_write2_b32 v149, v130, v131 offset0:16 offset1:84
    v_mfma_f32_16x16x32_bf16 v[114:117], v[182:185], a[172:175], v[114:117]
    v_cvt_pk_bf16_f32 v134, v134, v134
    v_cvt_pk_bf16_f32 v135, v135, v135
    v_mfma_f32_16x16x32_bf16 v[114:117], v[198:201], a[176:179], v[114:117]
    ds_write2_b32 v149, v132, v133 offset0:152 offset1:220
    v_mfma_f32_16x16x32_bf16 v[114:117], v[218:221], a[180:183], v[114:117]
    v_cvt_pk_bf16_f32 v136, v136, v136
    v_cvt_pk_bf16_f32 v137, v137, v137
    v_mfma_f32_16x16x32_bf16 v[114:117], v[222:225], a[184:187], v[114:117]
    ds_write2_b32 v149, v134, v135 offset0:32 offset1:100
    v_mfma_f32_16x16x32_bf16 v[114:117], v[158:161], a[188:191], v[114:117]
    v_cvt_pk_bf16_f32 v130, v230, v231
    v_cvt_pk_bf16_f32 v131, v232, v233
    v_mfma_f32_16x16x32_bf16 v[138:141], v[178:181], a[192:195], 0
    ds_write2_b32 v149, v136, v137 offset0:168 offset1:236
    v_mfma_f32_16x16x32_bf16 v[138:141], v[182:185], a[196:199], v[138:141]
    v_lshl_add_u32 v124, s16, 2, v255
    v_add_u32 v127, 162048, v127
    v_mfma_f32_16x16x32_bf16 v[138:141], v[198:201], a[200:203], v[138:141]
    v_cvt_pk_bf16_f32 v114, v114, v115
    v_cvt_pk_bf16_f32 v115, v116, v117
    v_mfma_f32_16x16x32_bf16 v[138:141], v[218:221], a[204:207], v[138:141]
    v_lshlrev_b32 v123, 4, v123
    v_add_u32 v123, 162048, v123
    v_mfma_f32_16x16x32_bf16 v[138:141], v[222:225], a[208:211], v[138:141]
    v_or_b32 v134, v32, v33
    v_and_b32 v134, 0xffff, v134
    v_mfma_f32_16x16x32_bf16 v[138:141], v[158:161], a[212:215], v[138:141]
    v_lshl_or_b32 v134, v134, 16, v134
    v_or_b32 v135, v32, v33
    v_mfma_f32_16x16x32_f16 v[142:145], v[118:121], v[206:209], v[46:49]
    buffer_load_dwordx4 v254, s[52:55], s4 offen offset:1024 lds
    v_and_b32 v135, 0xffff, v135
    v_lshl_or_b32 v135, v135, 16, v135
    v_or_b32 v136, v32, v33
    v_lshrrev_b32 v136, 16, v136
    v_cvt_pk_bf16_f32 v138, v138, v139
    v_mfma_f32_16x16x16_f16 v[142:145], v[196:197], v[194:195], v[142:145]
    v_cvt_pk_bf16_f32 v139, v140, v141
    v_lshl_or_b32 v136, v136, 16, v136
    v_or_b32 v137, v32, v33
    v_lshrrev_b32 v137, 16, v137
    v_lshl_or_b32 v137, v137, 16, v137
    v_xor_b32 v2, 65536, v2
    s_nop 0
    buffer_load_dwordx4 v128, s[52:55], s4 offen offset:2048 lds
    s_add_u32 m0, s68, 3072
    s_add_u32 s4, 0, 36864
    v_exp_f32 v142, v142
    v_exp_f32 v143, v143
    v_exp_f32 v144, v144
    v_cvt_pk_bf16_f32 v142, v142, v143
    v_exp_f32 v145, v145
    s_nop 0
    v_cvt_pk_bf16_f32 v143, v144, v145
    buffer_load_dwordx4 v126, s[52:55], s4 offen lds
    s_waitcnt vmcnt(10)
    s_barrier
    ds_read_b128 v[146:149], v0 offset:26624
    ds_read_b128 v[150:153], v1 offset:26624
    ds_read_b128 v[154:157], v0 offset:26752
    ds_read_b128 v[158:161], v1 offset:26752
    ds_read_b128 v[162:165], v0 offset:26880
    ds_read_b128 v[166:169], v1 offset:26880
    buffer_load_dwordx4 v254, s[52:55], s4 offen offset:1024 lds
    s_waitcnt lgkmcnt(5)
    v_mfma_f32_16x16x32_bf16 v[170:173], a[72:75], v[146:149], 0
    s_waitcnt lgkmcnt(4)
    buffer_load_dwordx4 v128, s[52:55], s4 offen offset:2048 lds
    v_mfma_f32_16x16x32_bf16 v[170:173], a[76:79], v[150:153], v[170:173]
    s_waitcnt lgkmcnt(2)
    s_add_u32 m0, s69, 0
    s_add_u32 s4, 0, 49152
    v_mfma_f32_16x16x32_bf16 v[170:173], a[80:83], v[154:157], v[170:173]
    s_waitcnt lgkmcnt(1)
    v_mfma_f32_16x16x32_bf16 v[170:173], a[84:87], v[158:161], v[170:173]
    s_waitcnt lgkmcnt(0)
    v_mfma_f32_16x16x32_bf16 v[170:173], a[88:91], v[162:165], v[170:173]
    v_mfma_f32_16x16x32_bf16 v[170:173], a[92:95], v[166:169], v[170:173]
    s_waitcnt vmcnt(9)
    ds_read_b64 a[216:217], v193 offset:0
    ds_read_b64 a[218:219], v193 offset:1536
    v_mfma_f32_16x16x32_bf16 v[174:177], a[96:99], v[146:149], 0
    ds_read_b64 a[240:241], v193 offset:8
    ds_read_b64 a[242:243], v193 offset:1544
    v_mfma_f32_16x16x32_bf16 v[174:177], a[100:103], v[150:153], v[174:177]
    ds_read_b64 v[90:91], v122 offset:0
    ds_read_b64 v[92:93], v122 offset:1536
    v_mfma_f32_16x16x32_bf16 v[174:177], a[104:107], v[154:157], v[174:177]
    v_cvt_pk_f16_f32 v170, v170, v171
    v_pk_mul_f16 v179, v170, v170
    v_mfma_f32_16x16x32_bf16 v[174:177], a[108:111], v[158:161], v[174:177]
    v_cvt_pk_f16_f32 v171, v172, v173
    v_pk_mul_f16 v181, v171, v171
    v_mfma_f32_16x16x32_bf16 v[174:177], a[112:115], v[162:165], v[174:177]
    v_mfma_f32_16x16x32_bf16 v[174:177], a[116:119], v[166:169], v[174:177]
    v_mfma_f32_16x16x32_bf16 v[182:185], a[120:123], v[146:149], 0
    v_mfma_f32_16x16x32_bf16 v[182:185], a[124:127], v[150:153], v[182:185]
    s_waitcnt lgkmcnt(4)
    v_mfma_f32_16x16x32_bf16 v[182:185], a[128:131], v[154:157], v[182:185]
    s_waitcnt lgkmcnt(2)
    v_mfma_f32_16x16x32_bf16 v[182:185], a[132:135], v[158:161], v[182:185]
    s_waitcnt lgkmcnt(0)
    buffer_load_dwordx4 v126, s[52:55], s4 offen lds
    v_mfma_f32_16x16x32_bf16 v[182:185], a[136:139], v[162:165], v[182:185]
    v_cvt_pk_f16_f32 v172, v174, v175
    v_pk_fma_f16 v179, v172, v172, v179
    v_mfma_f32_16x16x32_bf16 v[182:185], a[140:143], v[166:169], v[182:185]
    s_waitcnt vmcnt(7)
    ds_read_b64 a[232:233], v193 offset:3072
    ds_read_b64 a[220:221], v193 offset:4608
    v_mfma_f32_16x16x32_bf16 v[186:189], a[0:3], v[146:149], 0
    ds_read_b64 v[82:83], v193 offset:3080
    ds_read_b64 a[244:245], v193 offset:4616
    v_mfma_f32_16x16x32_bf16 v[186:189], a[4:7], v[150:153], v[186:189]
    buffer_load_dwordx4 v254, s[52:55], s4 offen offset:1024 lds
    v_mfma_f32_16x16x32_bf16 v[186:189], a[8:11], v[154:157], v[186:189]
    ds_read_b64 v[106:107], v122 offset:3072
    ds_read_b64 v[94:95], v122 offset:4608
    v_mfma_f32_16x16x32_bf16 v[186:189], a[12:15], v[158:161], v[186:189]
    v_cvt_pk_f16_f32 v173, v176, v177
    v_pk_fma_f16 v181, v173, v173, v181
    v_mfma_f32_16x16x32_bf16 v[186:189], a[16:19], v[162:165], v[186:189]
    v_cvt_pk_f16_f32 v176, v182, v183
    v_pk_fma_f16 v179, v176, v176, v179
    v_mfma_f32_16x16x32_bf16 v[186:189], a[20:23], v[166:169], v[186:189]
    buffer_load_dwordx4 v128, s[52:55], s4 offen offset:2048 lds
    v_mfma_f32_16x16x32_bf16 v[198:201], a[24:27], v[146:149], 0
    s_add_u32 m0, s69, 3072
    v_cvt_pk_f16_f32 v177, v184, v185
    v_pk_fma_f16 v181, v177, v177, v181
    v_mfma_f32_16x16x32_bf16 v[198:201], a[28:31], v[150:153], v[198:201]
    s_add_u32 s4, 0, 61440
    v_mfma_f32_16x16x32_bf16 v[198:201], a[32:35], v[154:157], v[198:201]
    s_waitcnt lgkmcnt(2)
    v_cvt_pk_f16_f32 v182, v186, v187
    v_pk_mul_f16 v178, v182, v182
    v_mfma_f32_16x16x32_bf16 v[198:201], a[36:39], v[158:161], v[198:201]
    v_cvt_pk_f16_f32 v183, v188, v189
    v_pk_mul_f16 v180, v183, v183
    v_mfma_f32_16x16x32_bf16 v[198:201], a[40:43], v[162:165], v[198:201]
    s_waitcnt lgkmcnt(0)
    buffer_load_dwordx4 v126, s[52:55], s4 offen lds
    v_mfma_f32_16x16x32_bf16 v[198:201], a[44:47], v[166:169], v[198:201]
    v_mfma_f32_16x16x32_bf16 v[186:189], a[48:51], v[146:149], 0
    s_waitcnt vmcnt(7)
    ds_read_b64 a[222:223], v129 offset:0
    ds_read_b64 a[234:235], v129 offset:1536
    v_mfma_f32_16x16x32_bf16 v[186:189], a[52:55], v[150:153], v[186:189]
    ds_read_b64 a[246:247], v129 offset:8
    ds_read_b64 v[84:85], v129 offset:1544
    v_mfma_f32_16x16x32_bf16 v[186:189], a[56:59], v[154:157], v[186:189]
    buffer_load_dwordx4 v254, s[52:55], s4 offen offset:1024 lds
    v_mfma_f32_16x16x32_bf16 v[186:189], a[60:63], v[158:161], v[186:189]
    ds_read_b64 v[96:97], v192 offset:0
    ds_read_b64 v[108:109], v192 offset:1536
    v_mfma_f32_16x16x32_bf16 v[186:189], a[64:67], v[162:165], v[186:189]
    ds_read_b128 v[202:205], v0 offset:32768
    v_cvt_pk_f16_f32 v184, v198, v199
    v_mfma_f32_16x16x32_bf16 v[186:189], a[68:71], v[166:169], v[186:189]
    ds_read_b128 v[210:213], v1 offset:32768
    v_pk_fma_f16 v178, v184, v184, v178
    v_mfma_f32_16x16x32_bf16 v[214:217], v[146:149], a[144:147], 0
    buffer_load_dwordx4 v128, s[52:55], s4 offen offset:2048 lds
    v_mfma_f32_16x16x32_bf16 v[214:217], v[150:153], a[148:151], v[214:217]
    s_add_u32 m0, s28, 65536
    ds_read_b128 v[218:221], v0 offset:32896
    ds_read_b128 v[222:225], v1 offset:32896
    v_mfma_f32_16x16x32_bf16 v[214:217], v[154:157], a[152:155], v[214:217]
    s_waitcnt lgkmcnt(8)
    ds_read_b128 v[226:229], v0 offset:33024
    v_cvt_pk_f16_f32 v185, v200, v201
    v_mfma_f32_16x16x32_bf16 v[214:217], v[158:161], a[156:159], v[214:217]
    s_waitcnt lgkmcnt(7)
    ds_read_b128 v[198:201], v1 offset:33024
    v_pk_fma_f16 v180, v185, v185, v180
    v_mfma_f32_16x16x32_bf16 v[214:217], v[162:165], a[160:163], v[214:217]
    buffer_load_dwordx4 v10, s[8:11], s24 offen nt lds
    v_mfma_f32_16x16x32_bf16 v[214:217], v[166:169], a[164:167], v[214:217]
    s_add_u32 m0, s28, 69632
    v_cvt_pk_f16_f32 v174, v186, v187
    v_pk_fma_f16 v178, v174, v174, v178
    v_mfma_f32_16x16x32_bf16 v[230:233], v[146:149], a[168:171], 0
    s_waitcnt vmcnt(7)
    ds_read_b64 a[224:225], v129 offset:3072
    ds_read_b64 a[226:227], v129 offset:4608
    v_mfma_f32_16x16x32_bf16 v[230:233], v[150:153], a[172:175], v[230:233]
    s_waitcnt lgkmcnt(6)
    ds_read_b64 a[248:249], v129 offset:3080
    ds_read_b64 a[250:251], v129 offset:4616
    v_mfma_f32_16x16x32_bf16 v[230:233], v[154:157], a[176:179], v[230:233]
    buffer_load_dwordx4 v11, s[8:11], s24 offen nt lds
    v_mfma_f32_16x16x32_bf16 v[230:233], v[158:161], a[180:183], v[230:233]
    s_add_u32 m0, s28, 73728
    ds_read_b64 v[98:99], v192 offset:3072
    ds_read_b64 v[100:101], v192 offset:4608
    v_mfma_f32_16x16x32_bf16 v[230:233], v[162:165], a[184:187], v[230:233]
    s_waitcnt lgkmcnt(7)
    v_cvt_pk_f16_f32 v175, v188, v189
    v_pk_fma_f16 v180, v175, v175, v180
    v_mfma_f32_16x16x32_bf16 v[230:233], v[166:169], a[188:191], v[230:233]
    s_waitcnt lgkmcnt(6)
    v_cvt_pk_bf16_f32 v132, v214, v215
    v_cvt_pk_bf16_f32 v133, v216, v217
    v_mfma_f32_16x16x32_f16 v[186:189], v[40:43], v[178:181], 0
    buffer_load_dwordx4 v12, s[8:11], s24 offen nt lds
    v_mfma_f32_16x16x32_bf16 v[178:181], v[146:149], a[192:195], 0
    s_add_u32 m0, s28, 77824
    v_xor_b32 v0, 65536, v0
    v_cvt_pk_bf16_f32 v116, v230, v231
    v_mfma_f32_16x16x32_bf16 v[178:181], v[150:153], a[196:199], v[178:181]
    s_waitcnt lgkmcnt(4)
    v_cvt_pk_bf16_f32 v117, v232, v233
    v_min3_u32 v44, v44, v186, v187
    v_mfma_f32_16x16x32_bf16 v[178:181], v[154:157], a[200:203], v[178:181]
    s_waitcnt lgkmcnt(2)
    v_rsq_f32 v188, v186
    v_mfma_f32_16x16x32_bf16 v[178:181], v[158:161], a[204:207], v[178:181]
    buffer_load_dwordx4 v13, s[8:11], s24 offen nt lds
    v_mfma_f32_16x16x32_bf16 v[178:181], v[162:165], a[208:211], v[178:181]
    s_add_u32 m0, s74, 0
    v_rsq_f32 v189, v187
    v_mfma_f32_16x16x32_bf16 v[178:181], v[166:169], a[212:215], v[178:181]
    s_waitcnt lgkmcnt(0)
    v_mul_f32 v188, s31, v188
    v_cvt_pk_f16_f32 v188, v188, v189
    v_mfma_f32_16x16x32_bf16 v[146:149], a[72:75], v[202:205], 0
    s_waitcnt vmcnt(7)
    ds_read_b64 a[236:237], v193 offset:0
    ds_read_b64 a[228:229], v193 offset:1536
    v_mfma_f32_16x16x32_bf16 v[146:149], a[76:79], v[210:213], v[146:149]
    buffer_load_dwordx4 v14, s[8:11], s24 offen nt lds
    v_mfma_f32_16x16x32_bf16 v[146:149], a[80:83], v[218:221], v[146:149]
    s_add_u32 s8, s40, s23
    ds_read_b64 v[86:87], v193 offset:8
    ds_read_b64 a[252:253], v193 offset:1544
    v_mfma_f32_16x16x32_bf16 v[146:149], a[84:87], v[222:225], v[146:149]
    s_addc_u32 s9, s41, 0
    ds_read_b64 v[110:111], v122 offset:0
    ds_read_b64 v[102:103], v122 offset:1536
    v_mfma_f32_16x16x32_bf16 v[146:149], a[88:91], v[226:229], v[146:149]
    s_sub_u32 s10, s36, s23
    v_pk_mul_f16 v170, v170, v188 op_sel:[0,1] op_sel_hi:[1,1]
    v_pk_mul_f16 v171, v171, v188 op_sel:[0,1] op_sel_hi:[1,1]
    v_mfma_f32_16x16x32_bf16 v[146:149], a[92:95], v[198:201], v[146:149]
    s_cmp_lt_u32 s34, s17
    v_pk_mul_f16 v172, v172, v188 op_sel:[0,1] op_sel_hi:[1,1]
    v_pk_mul_f16 v173, v173, v188 op_sel:[0,1] op_sel_hi:[1,1]
    v_mfma_f32_16x16x32_bf16 v[150:153], a[96:99], v[202:205], 0
    s_cselect_b32 s10, s10, 0
    v_pk_mul_f16 v176, v176, v188 op_sel:[0,1] op_sel_hi:[1,1]
    v_pk_mul_f16 v177, v177, v188 op_sel:[0,1] op_sel_hi:[1,1]
    v_mfma_f32_16x16x32_bf16 v[150:153], a[100:103], v[210:213], v[150:153]
    s_add_u32 m0, s28, 0
    v_pk_mul_f16 v182, v182, v188 op_sel:[0,0] op_sel_hi:[1,0]
    v_pk_mul_f16 v183, v183, v188 op_sel:[0,0] op_sel_hi:[1,0]
    v_mfma_f32_16x16x32_bf16 v[150:153], a[104:107], v[218:221], v[150:153]
    s_mov_b32 s24, s23
    v_pk_mul_f16 v184, v184, v188 op_sel:[0,0] op_sel_hi:[1,0]
    v_pk_mul_f16 v185, v185, v188 op_sel:[0,0] op_sel_hi:[1,0]
    v_mfma_f32_16x16x32_bf16 v[150:153], a[108:111], v[222:225], v[150:153]
    s_add_u32 s23, s23, s21
    v_pk_mul_f16 v174, v174, v188 op_sel:[0,0] op_sel_hi:[1,0]
    v_pk_mul_f16 v175, v175, v188 op_sel:[0,0] op_sel_hi:[1,0]
    v_mfma_f32_16x16x32_bf16 v[150:153], a[112:115], v[226:229], v[150:153]
    s_cmp_ge_u32 s19, 72
    v_max3_u32 v45, v45, v186, v187
    v_cvt_pk_bf16_f32 v140, v178, v179
    v_mfma_f32_16x16x32_bf16 v[150:153], a[116:119], v[198:201], v[150:153]
    s_cselect_b32 s34, 72, 0
    v_cvt_pk_bf16_f32 v141, v180, v181
    v_cvt_pk_f16_f32 v146, v146, v147
    v_mfma_f32_16x16x32_bf16 v[154:157], a[120:123], v[202:205], 0
    s_cselect_b32 s35, s22, 0
    v_pk_mul_f16 v159, v146, v146
    v_cvt_pk_f16_f32 v147, v148, v149
    v_mfma_f32_16x16x32_bf16 v[154:157], a[124:127], v[210:213], v[154:157]
    s_waitcnt vmcnt(5)
    ds_read_b64 a[230:231], v193 offset:3072
    ds_read_b64 a[238:239], v193 offset:4608
    v_mfma_f32_16x16x32_bf16 v[154:157], a[128:131], v[218:221], v[154:157]
    s_sub_u32 s19, s19, s34
    ds_read_b64 a[254:255], v193 offset:3080
    ds_read_b64 v[88:89], v193 offset:4616
    v_mfma_f32_16x16x32_bf16 v[154:157], a[132:135], v[222:225], v[154:157]
    s_add_u32 s23, s23, s35
    ds_read_b64 v[104:105], v122 offset:3072
    ds_read_b64 v[112:113], v122 offset:4608
    v_mfma_f32_16x16x32_bf16 v[154:157], a[136:139], v[226:229], v[154:157]
    s_waitcnt lgkmcnt(6)
    v_pk_mul_f16 v161, v147, v147
    v_cvt_pk_f16_f32 v148, v150, v151
    v_mfma_f32_16x16x32_bf16 v[154:157], a[140:143], v[198:201], v[154:157]
    v_pk_fma_f16 v159, v148, v148, v159
    v_cvt_pk_f16_f32 v149, v152, v153
    v_mfma_f32_16x16x32_bf16 v[150:153], a[0:3], v[202:205], 0
    v_pk_fma_f16 v161, v149, v149, v161
    v_xor_b32 v1, 65536, v1
    v_mfma_f32_16x16x32_bf16 v[150:153], a[4:7], v[210:213], v[150:153]
    v_mfma_f32_16x16x32_bf16 v[150:153], a[8:11], v[218:221], v[150:153]
    v_mfma_f32_16x16x32_bf16 v[150:153], a[12:15], v[222:225], v[150:153]
    s_waitcnt lgkmcnt(4)
    v_cvt_pk_f16_f32 v164, v154, v155
    v_pk_fma_f16 v159, v164, v164, v159
    v_mfma_f32_16x16x32_bf16 v[150:153], a[16:19], v[226:229], v[150:153]
    s_waitcnt lgkmcnt(2)
    v_cvt_pk_f16_f32 v165, v156, v157
    v_pk_fma_f16 v161, v165, v165, v161
    v_mfma_f32_16x16x32_bf16 v[150:153], a[20:23], v[198:201], v[150:153]
    s_waitcnt lgkmcnt(0)
    v_mfma_f32_16x16x32_bf16 v[154:157], a[24:27], v[202:205], 0
    v_mfma_f32_16x16x32_bf16 v[154:157], a[28:31], v[210:213], v[154:157]
    v_mfma_f32_16x16x32_bf16 v[154:157], a[32:35], v[218:221], v[154:157]
    v_mfma_f32_16x16x32_bf16 v[154:157], a[36:39], v[222:225], v[154:157]
    v_mfma_f32_16x16x32_bf16 v[154:157], a[40:43], v[226:229], v[154:157]
    v_mfma_f32_16x16x32_bf16 v[154:157], a[44:47], v[198:201], v[154:157]
    v_mfma_f32_16x16x32_bf16 v[166:169], a[48:51], v[202:205], 0
    v_cvt_pk_f16_f32 v150, v150, v151
    v_pk_mul_f16 v158, v150, v150
    v_mfma_f32_16x16x32_bf16 v[166:169], a[52:55], v[210:213], v[166:169]
    v_cvt_pk_f16_f32 v151, v152, v153
    v_pk_mul_f16 v160, v151, v151
    v_mfma_f32_16x16x32_bf16 v[166:169], a[56:59], v[218:221], v[166:169]
    v_mfma_f32_16x16x32_bf16 v[166:169], a[60:63], v[222:225], v[166:169]
    v_cvt_pk_f16_f32 v152, v154, v155
    v_pk_fma_f16 v158, v152, v152, v158
    v_mfma_f32_16x16x32_bf16 v[166:169], a[64:67], v[226:229], v[166:169]
    v_cvt_pk_f16_f32 v153, v156, v157
    v_pk_fma_f16 v160, v153, v153, v160
    v_mfma_f32_16x16x32_bf16 v[166:169], a[68:71], v[198:201], v[166:169]
    v_mfma_f32_16x16x32_bf16 v[154:157], v[202:205], a[144:147], 0
    v_mfma_f32_16x16x32_bf16 v[154:157], v[210:213], a[148:151], v[154:157]
    v_mfma_f32_16x16x32_bf16 v[154:157], v[218:221], a[152:155], v[154:157]
    ds_read_b128 v[178:181], v5 offset:0
    ds_read_b128 v[186:189], v5 offset:16
    v_mfma_f32_16x16x32_bf16 v[154:157], v[222:225], a[156:159], v[154:157]
    ds_read_b128 v[214:217], v5 offset:48
    ds_read_b32 v254, v6 offset:192
    v_mfma_f32_16x16x32_bf16 v[154:157], v[226:229], a[160:163], v[154:157]
    v_cvt_pk_f16_f32 v162, v166, v167
    v_pk_fma_f16 v158, v162, v162, v158
    v_mfma_f32_16x16x32_bf16 v[154:157], v[198:201], a[164:167], v[154:157]
    v_cvt_pk_f16_f32 v163, v168, v169
    v_pk_fma_f16 v160, v163, v163, v160
    v_mfma_f32_16x16x32_bf16 v[166:169], v[202:205], a[168:171], 0
    v_add_u32 v5, 336, v5
    v_mfma_f32_16x16x32_f16 v[230:233], v[40:43], v[158:161], 0
    v_mfma_f32_16x16x32_bf16 v[166:169], v[210:213], a[172:175], v[166:169]
    v_mfma_f32_16x16x32_bf16 v[166:169], v[218:221], a[176:179], v[166:169]
    v_mfma_f32_16x16x32_f16 v[158:161], v[170:173], v[206:209], v[50:53]
    s_waitcnt lgkmcnt(2)
    v_cvt_pk_bf16_f32 v154, v154, v155
    v_cvt_pk_bf16_f32 v155, v156, v157
    v_mfma_f32_16x16x32_f16 v[234:237], v[178:181], v[182:185], v[24:27]
    s_waitcnt lgkmcnt(0)
    v_rsq_f32 v232, v230
    v_mfma_f32_16x16x32_f16 v[234:237], v[186:189], v[170:173], v[234:237]
    v_rsq_f32 v233, v231
    v_mfma_f32_16x16x32_f16 v[234:237], v[214:217], v[174:177], v[234:237]
    v_mul_f32 v232, s31, v232
    v_cvt_pk_f16_f32 v232, v232, v233
    v_mfma_f32_16x16x32_f16 v[238:241], v[178:181], v[206:209], v[22:25]
    v_pk_mul_f16 v146, v146, v232 op_sel:[0,1] op_sel_hi:[1,1]
    v_pk_mul_f16 v147, v147, v232 op_sel:[0,1] op_sel_hi:[1,1]
    v_mfma_f32_16x16x32_f16 v[238:241], v[186:189], v[118:121], v[238:241]
    v_pk_mul_f16 v148, v148, v232 op_sel:[0,1] op_sel_hi:[1,1]
    v_pk_mul_f16 v149, v149, v232 op_sel:[0,1] op_sel_hi:[1,1]
    v_mfma_f32_16x16x32_f16 v[238:241], v[214:217], v[194:197], v[238:241]
    v_pk_mul_f16 v164, v164, v232 op_sel:[0,1] op_sel_hi:[1,1]
    v_pk_mul_f16 v165, v165, v232 op_sel:[0,1] op_sel_hi:[1,1]
    v_mfma_f32_16x16x32_f16 v[242:245], v[146:149], v[206:209], v[54:57]
    v_pk_mul_f16 v150, v150, v232 op_sel:[0,0] op_sel_hi:[1,0]
    v_pk_mul_f16 v151, v151, v232 op_sel:[0,0] op_sel_hi:[1,0]
    v_pk_mul_f16 v152, v152, v232 op_sel:[0,0] op_sel_hi:[1,0]
    v_mfma_f32_16x16x16_f16 v[158:161], v[176:177], v[194:195], v[158:161]
    v_pk_mul_f16 v153, v153, v232 op_sel:[0,0] op_sel_hi:[1,0]
    v_pk_mul_f16 v162, v162, v232 op_sel:[0,0] op_sel_hi:[1,0]
    v_pk_mul_f16 v163, v163, v232 op_sel:[0,0] op_sel_hi:[1,0]
    v_mfma_f32_16x16x16_f16 v[242:245], v[164:165], v[194:195], v[242:245]
    v_min3_u32 v44, v44, v230, v231
    v_max3_u32 v45, v45, v230, v231
    v_exp_f32 v238, v238
    v_mfma_f32_16x16x32_bf16 v[166:169], v[222:225], a[180:183], v[166:169]
    v_mov_b32_dpp v254, v239 quad_perm:[0,1,2,3] row_mask:0x1 bank_mask:0xf
    v_mov_b32_dpp v254, v235 quad_perm:[0,1,2,3] row_mask:0x2 bank_mask:0xf
    v_mfma_f32_16x16x32_bf16 v[166:169], v[226:229], a[184:187], v[166:169]
    v_exp_f32 v158, v158
    v_mfma_f32_16x16x32_bf16 v[166:169], v[198:201], a[188:191], v[166:169]
    v_exp_f32 v159, v159
    v_mfma_f32_16x16x32_bf16 v[206:209], v[202:205], a[192:195], 0
    v_cvt_pk_bf16_f32 v144, v158, v159
    v_cvt_pk_bf16_f32 v39, v238, 0
    v_mfma_f32_16x16x32_bf16 v[206:209], v[210:213], a[196:199], v[206:209]
    v_exp_f32 v160, v160
    v_mfma_f32_16x16x32_bf16 v[206:209], v[218:221], a[200:203], v[206:209]
    v_exp_f32 v161, v161
    v_mfma_f32_16x16x32_bf16 v[206:209], v[222:225], a[204:207], v[206:209]
    v_cvt_pk_bf16_f32 v202, v166, v167
    v_cvt_pk_bf16_f32 v203, v168, v169
    v_mfma_f32_16x16x32_bf16 v[206:209], v[226:229], a[208:211], v[206:209]
    v_exp_f32 v242, v242
    v_mfma_f32_16x16x32_bf16 v[206:209], v[198:201], a[212:215], v[206:209]
    ds_read2_b32 v[156:157], v6 offset0:0 offset1:0
    ds_read2_b32 v[204:205], v6 offset0:16 offset1:16
    v_mfma_f32_16x16x32_f16 v[166:169], v[178:181], v[150:153], v[26:29]
    ds_read2_b32 v[180:181], v6 offset0:32 offset1:32
    v_cvt_pk_bf16_f32 v145, v160, v161
    v_mfma_f32_16x16x32_f16 v[166:169], v[186:189], v[146:149], v[166:169]
    v_exp_f32 v243, v243
    v_mfma_f32_16x16x32_f16 v[166:169], v[214:217], v[162:165], v[166:169]
    v_cvt_pk_bf16_f32 v178, v206, v207
    v_cvt_pk_bf16_f32 v179, v208, v209
    v_mfma_f32_16x16x32_bf16 v[158:161], v[134:137], a[216:219], 0
    v_cvt_pk_bf16_f32 v36, v242, v243
    v_add_u32 v6, 272, v6
    v_mfma_f32_16x16x32_bf16 v[158:161], v[134:137], a[240:243], v[158:161]
    v_exp_f32 v244, v244
    v_mfma_f32_16x16x32_bf16 v[158:161], v[134:137], v[90:93], v[158:161]
    v_exp_f32 v245, v245
    v_mfma_f32_16x16x32_f16 v[186:189], v[118:121], v[182:185], v[58:61]
    v_cvt_pk_bf16_f32 v37, v244, v245
    v_mov_b32_dpp v254, v167 quad_perm:[0,1,2,3] row_mask:0x4 bank_mask:0xf
    v_mfma_f32_16x16x32_f16 v[198:201], v[170:173], v[182:185], v[62:65]
    s_waitcnt lgkmcnt(1)
    v_exp_f32 v166, v166
    v_mfma_f32_16x16x32_f16 v[206:209], v[146:149], v[182:185], v[66:69]
    s_waitcnt lgkmcnt(0)
    v_mov_b32 v122, v158
    v_exp_f32 v234, v234
    v_mfma_f32_16x16x16_f16 v[186:189], v[196:197], v[174:175], v[186:189]
    v_mov_b32_dpp v122, v159 quad_perm:[0,1,2,3] row_mask:0x2 bank_mask:0xf
    v_exp_f32 v254, v254
    v_mfma_f32_16x16x16_f16 v[198:201], v[176:177], v[174:175], v[198:201]
    v_cvt_pk_bf16_f32 v254, v254, v254
    v_mfma_f32_16x16x16_f16 v[206:209], v[164:165], v[174:175], v[206:209]
    ds_write_b16 v8, v254
    v_mfma_f32_16x16x32_bf16 v[158:161], v[28:31], v[36:39], 0
    v_mfma_f32_16x16x32_bf16 v[158:161], v[28:31], v[142:145], v[158:161]
    v_exp_f32 v186, v186
    v_mfma_f32_16x16x32_f16 v[182:185], v[118:121], v[150:153], v[70:73]
    v_exp_f32 v187, v187
    v_mfma_f32_16x16x32_bf16 v[118:121], v[154:157], v[36:39], 0
    v_exp_f32 v188, v188
    v_mfma_f32_16x16x32_f16 v[210:213], v[170:173], v[150:153], v[74:77]
    v_exp_f32 v189, v189
    v_mfma_f32_16x16x32_bf16 v[118:121], v[130:133], v[142:145], v[118:121]
    v_cvt_pk_bf16_f32 v170, v186, v187
    v_exp_f32 v198, v198
    v_mfma_f32_16x16x32_f16 v[214:217], v[146:149], v[150:153], v[78:81]
    v_cvt_pk_bf16_f32 v171, v188, v189
    v_exp_f32 v199, v199
    v_mfma_f32_16x16x16_f16 v[182:185], v[196:197], v[162:163], v[182:185]
    v_cvt_pk_bf16_f32 v172, v198, v199
    v_exp_f32 v200, v200
    v_mfma_f32_16x16x16_f16 v[210:213], v[176:177], v[162:163], v[210:213]
    v_exp_f32 v201, v201
    v_mfma_f32_16x16x16_f16 v[214:217], v[164:165], v[162:163], v[214:217]
    v_cvt_pk_bf16_f32 v173, v200, v201
    v_exp_f32 v206, v206
    v_mfma_f32_16x16x32_bf16 v[146:149], v[202:205], v[36:39], 0
    v_exp_f32 v182, v182
    v_mfma_f32_16x16x32_bf16 v[146:149], v[114:117], v[142:145], v[146:149]
    v_exp_f32 v183, v183
    v_mfma_f32_16x16x32_bf16 v[150:153], v[178:181], v[36:39], 0
    v_cvt_pk_bf16_f32 v162, v182, v183
    v_cvt_pk_bf16_f32 v39, v234, 0
    v_mfma_f32_16x16x32_bf16 v[150:153], v[138:141], v[142:145], v[150:153]
    v_exp_f32 v184, v184
    v_mfma_f32_16x16x32_bf16 v[142:145], v[134:137], a[220:223], 0
    v_exp_f32 v185, v185
    v_mfma_f32_16x16x32_bf16 v[142:145], v[134:137], a[244:247], v[142:145]
    v_exp_f32 v210, v210
    v_mfma_f32_16x16x32_bf16 v[142:145], v[134:137], v[94:97], v[142:145]
    v_exp_f32 v211, v211
    v_mfma_f32_16x16x32_bf16 v[174:177], v[134:137], a[232:235], 0
    v_cvt_pk_bf16_f32 v163, v184, v185
    v_cvt_pk_bf16_f32 v164, v210, v211
    v_mfma_f32_16x16x32_bf16 v[174:177], v[134:137], v[82:85], v[174:177]
    v_exp_f32 v212, v212
    v_mfma_f32_16x16x32_bf16 v[174:177], v[134:137], v[106:109], v[174:177]
    v_exp_f32 v213, v213
    v_mfma_f32_16x16x32_bf16 v[182:185], v[134:137], a[224:227], 0
    v_mov_b32 v254, v143
    v_cvt_pk_bf16_f32 v165, v212, v213
    v_mfma_f32_16x16x32_bf16 v[182:185], v[134:137], a[248:251], v[182:185]
    v_exp_f32 v214, v214
    v_mfma_f32_16x16x32_bf16 v[182:185], v[134:137], v[98:101], v[182:185]
    v_exp_f32 v215, v215
    v_mfma_f32_16x16x32_bf16 v[186:189], v[134:137], a[228:231], 0
    v_mov_b32_dpp v122, v174 quad_perm:[0,1,2,3] row_mask:0x4 bank_mask:0xf
    v_mov_b32_dpp v122, v142 quad_perm:[0,1,2,3] row_mask:0x8 bank_mask:0xf
    v_mfma_f32_16x16x32_bf16 v[186:189], v[134:137], a[252:255], v[186:189]
    ds_write_b32 v124, v122 offset:0
    v_mfma_f32_16x16x32_bf16 v[186:189], v[134:137], v[102:105], v[186:189]
    v_exp_f32 v216, v216
    v_mfma_f32_16x16x32_bf16 v[142:145], v[134:137], a[236:239], 0
    v_exp_f32 v217, v217
    v_mfma_f32_16x16x32_bf16 v[142:145], v[134:137], v[86:89], v[142:145]
    ds_read_b128 v[194:197], v9
    ds_read_b128 v[198:201], v9 offset:64
    v_mfma_f32_16x16x32_bf16 v[142:145], v[134:137], v[110:113], v[142:145]
    v_mov_b32_dpp v254, v175 quad_perm:[0,1,2,3] row_mask:0x2 bank_mask:0xf
    v_mov_b32_dpp v254, v182 quad_perm:[0,1,2,3] row_mask:0x4 bank_mask:0xf
    v_mov_b32_dpp v254, v183 quad_perm:[0,1,2,3] row_mask:0x8 bank_mask:0xf
    v_exp_f32 v207, v207
    v_exp_f32 v208, v208
    v_cvt_pk_bf16_f32 v36, v206, v207
    v_exp_f32 v209, v209
    v_rcp_f32 v158, v158
    v_mov_b32 v122, v142
    v_mov_b32_dpp v122, v186 quad_perm:[0,1,2,3] row_mask:0x2 bank_mask:0xf
    v_mov_b32_dpp v122, v187 quad_perm:[0,1,2,3] row_mask:0x4 bank_mask:0xf
    v_mov_b32_dpp v122, v143 quad_perm:[0,1,2,3] row_mask:0x8 bank_mask:0xf
    v_cvt_pk_bf16_f32 v37, v208, v209
    v_mul_f32 v118, v158, v118
    v_mul_f32 v119, v158, v119
    v_mfma_f32_16x16x32_bf16 v[134:137], v[28:31], v[36:39], 0
    ds_write_b32 v124, v254 offset:1024
    v_mfma_f32_16x16x32_bf16 v[134:137], v[28:31], v[170:173], v[134:137]
    s_waitcnt lgkmcnt(2)
    v_cvt_pk_bf16_f32 v118, v118, v119
    v_mul_f32 v120, v158, v120
    v_mfma_f32_16x16x32_bf16 v[142:145], v[154:157], v[36:39], 0
    s_waitcnt lgkmcnt(1)
    ds_write_b32 v124, v122 offset:2048
    v_mfma_f32_16x16x32_bf16 v[142:145], v[130:133], v[170:173], v[142:145]
    v_mul_f32 v121, v158, v121
    v_cvt_pk_bf16_f32 v119, v120, v121
    v_mfma_f32_16x16x32_bf16 v[182:185], v[202:205], v[36:39], 0
    v_mul_f32 v146, v158, v146
    v_mul_f32 v147, v158, v147
    v_mfma_f32_16x16x32_bf16 v[182:185], v[114:117], v[170:173], v[182:185]
    v_cvt_pk_bf16_f32 v120, v146, v147
    v_mul_f32 v148, v158, v148
    v_mfma_f32_16x16x32_bf16 v[206:209], v[178:181], v[36:39], 0
    v_cvt_pk_bf16_f32 v36, v214, v215
    v_cvt_pk_bf16_f32 v37, v216, v217
    v_mfma_f32_16x16x32_bf16 v[206:209], v[138:141], v[170:173], v[206:209]
    v_cvt_pk_bf16_f32 v39, v166, 0
    v_mul_f32 v149, v158, v149
    v_mfma_f32_16x16x32_bf16 v[174:177], v[194:197], v[28:31], 0
    v_cvt_pk_bf16_f32 v121, v148, v149
    v_mul_f32 v150, v158, v150
    v_mfma_f32_16x16x32_bf16 v[146:149], v[28:31], v[36:39], 0
    v_mul_f32 v151, v158, v151
    v_cvt_pk_bf16_f32 v254, v150, v151
    v_mfma_f32_16x16x32_bf16 v[146:149], v[28:31], v[162:165], v[146:149]
    s_waitcnt lgkmcnt(0)
    v_mul_f32 v152, v158, v152
    v_mul_f32 v153, v158, v153
    v_mfma_f32_16x16x32_bf16 v[214:217], v[154:157], v[36:39], 0
    s_barrier
    ds_read_b128 v[158:161], v255 offset:0
    ds_read_b128 v[186:189], v255 offset:1024
    v_mfma_f32_16x16x32_bf16 v[214:217], v[130:133], v[162:165], v[214:217]
    ds_read_b128 v[222:225], v255 offset:2048
    v_cvt_pk_bf16_f32 v255, v152, v153
    v_mfma_f32_16x16x32_bf16 v[150:153], v[202:205], v[36:39], 0
    ds_write_b128 v3, v[118:121] offset:0
    v_mfma_f32_16x16x32_bf16 v[150:153], v[114:117], v[162:165], v[150:153]
    v_rcp_f32 v146, v146
    s_waitcnt vmcnt(0)
    v_mfma_f32_16x16x32_bf16 v[118:121], v[178:181], v[36:39], 0
    s_barrier
    buffer_load_dwordx4 v10, s[8:11], 0 offen nt lds
    v_mul_f32 v214, v146, v214
    v_mfma_f32_16x16x32_bf16 v[118:121], v[138:141], v[162:165], v[118:121]
    s_add_u32 m0, s28, 4096
    ds_read_b128 v[170:173], v0 offset:20480
    ds_read_b128 v[166:169], v1 offset:20480
    v_mfma_f32_16x16x32_bf16 v[174:177], v[198:201], v[28:31], v[174:177]
    ds_read_b128 v[162:165], v0 offset:20608
    ds_read_b128 v[210:213], v1 offset:20608
    v_mfma_f32_16x16x32_bf16 v[234:237], v[194:197], v[130:133], 0
    s_waitcnt lgkmcnt(6)
    v_add_f32 v158, v158, v159
    v_add_f32 v160, v160, v161
    v_mfma_f32_16x16x32_bf16 v[234:237], v[198:201], v[154:157], v[234:237]
    s_waitcnt lgkmcnt(5)
    ds_read_b128 v[226:229], v0 offset:20736
    ds_read_b128 v[218:221], v1 offset:20736
    v_mfma_f32_16x16x32_bf16 v[130:133], v[194:197], v[114:117], 0
    buffer_load_dwordx4 v11, s[8:11], 0 offen nt lds
    v_add_f32 v158, v158, v160
    v_mfma_f32_16x16x32_bf16 v[130:133], v[198:201], v[202:205], v[130:133]
    s_add_u32 m0, s28, 8192
    ds_write_b64 v4, v[254:255] offset:4096
    v_mfma_f32_16x16x32_bf16 v[114:117], v[194:197], v[138:141], 0
    v_mul_f32 v158, 0xbbaaaaab, v158
    v_add_f32 v186, v186, v187
    v_mfma_f32_16x16x32_bf16 v[114:117], v[198:201], v[178:181], v[114:117]
    s_waitcnt lgkmcnt(6)
    ds_write_b32 v127, v158 offset:0
    v_mfma_f32_16x16x32_bf16 v[158:161], a[72:75], v[170:173], 0
    s_waitcnt lgkmcnt(5)
    buffer_load_dwordx4 v12, s[8:11], 0 offen nt lds
    v_add_f32 v188, v188, v189
    v_mfma_f32_16x16x32_bf16 v[158:161], a[76:79], v[166:169], v[158:161]
    s_add_u32 m0, s28, 12288
    ds_read_b128 v[138:141], v123 offset:0
    ds_read_b128 v[154:157], v123 offset:64
    v_mfma_f32_16x16x32_bf16 v[158:161], a[80:83], v[162:165], v[158:161]
    s_waitcnt lgkmcnt(5)
    ds_read_b128 v[178:181], v123 offset:128
    v_add_f32 v186, v186, v188
    v_mfma_f32_16x16x32_bf16 v[158:161], a[84:87], v[210:213], v[158:161]
    s_xor_b32 s28, s28, 65536
    v_mul_f32 v186, 0xbbaaaaab, v186
    v_add_f32 v222, v222, v223
    v_mfma_f32_16x16x32_bf16 v[158:161], a[88:91], v[226:229], v[158:161]
    s_waitcnt lgkmcnt(4)
    buffer_load_dwordx4 v13, s[8:11], 0 offen nt lds
    v_add_f32 v224, v224, v225
    v_mfma_f32_16x16x32_bf16 v[158:161], a[92:95], v[218:221], v[158:161]
    s_mov_b32 m0, s29
    ds_write_b32 v127, v186 offset:256
    v_mfma_f32_16x16x32_bf16 v[230:233], a[96:99], v[170:173], 0
    s_xor_b32 s29, s29, s30
    v_add_f32 v222, v222, v224
    v_mul_f32 v222, 0xbbaaaaab, v222
    v_mfma_f32_16x16x32_bf16 v[230:233], a[100:103], v[166:169], v[230:233]
    ds_write_b32 v127, v222 offset:512
    v_mfma_f32_16x16x32_bf16 v[230:233], a[104:107], v[162:165], v[230:233]
    buffer_load_dwordx4 v14, s[8:11], 0 offen nt lds
    v_mul_f32 v215, v146, v215
    v_mfma_f32_16x16x32_bf16 v[230:233], a[108:111], v[210:213], v[230:233]
    s_waitcnt lgkmcnt(3)
    v_rcp_f32 v174, v174
    v_cvt_pk_bf16_f32 v126, v214, v215
    v_mfma_f32_16x16x16_bf16 v[186:189], a[216:217], v[190:191], v[138:141]
    v_mul_f32 v234, v234, v174
    v_mul_f32_dpp v234, v130, v174 quad_perm:[0,1,2,3] row_mask:0x2 bank_mask:0xf
    v_mul_f32_dpp v234, v114, v174 quad_perm:[0,1,2,3] row_mask:0x4 bank_mask:0xf
    v_mfma_f32_16x16x16_bf16 v[114:117], a[240:241], v[190:191], v[138:141]
    v_cvt_pk_bf16_f32 v234, v234, v234
    v_mul_f32 v216, v146, v216
    v_mul_f32 v217, v146, v217
    v_mfma_f32_16x16x16_bf16 v[130:133], v[90:91], v[190:191], v[138:141]
    v_cvt_pk_bf16_f32 v186, v186, v187
    v_accvgpr_write_b32 a216, v186
    v_cvt_pk_bf16_f32 v188, v188, v189
    v_mfma_f32_16x16x16_bf16 v[174:177], a[218:219], v[190:191], v[154:157]
    v_accvgpr_write_b32 a217, v188
    v_cvt_pk_bf16_f32 v114, v114, v115
    v_accvgpr_write_b32 a240, v114
    v_mfma_f32_16x16x16_bf16 v[138:141], a[242:243], v[190:191], v[154:157]
    v_cvt_pk_bf16_f32 v116, v116, v117
    v_accvgpr_write_b32 a241, v116
    v_cvt_pk_bf16_f32 v90, v130, v131
    v_mfma_f32_16x16x16_bf16 v[114:117], v[92:93], v[190:191], v[154:157]
    v_cvt_pk_bf16_f32 v91, v132, v133
    v_cvt_pk_bf16_f32 v174, v174, v175
    v_accvgpr_write_b32 a218, v174
    v_cvt_pk_bf16_f32 v176, v176, v177
    v_mfma_f32_16x16x32_bf16 v[230:233], a[112:115], v[226:229], v[230:233]
    s_waitcnt lgkmcnt(0)
    ds_read_b128 v[130:133], v123 offset:192
    ds_write_b16 v7, v234
    v_mfma_f32_16x16x16_bf16 v[154:157], a[232:233], v[190:191], v[178:181]
    v_accvgpr_write_b32 a219, v176
    v_cvt_pk_bf16_f32 v138, v138, v139
    v_accvgpr_write_b32 a242, v138
    v_mfma_f32_16x16x16_bf16 v[174:177], v[82:83], v[190:191], v[178:181]
    v_cvt_pk_bf16_f32 v140, v140, v141
    v_accvgpr_write_b32 a243, v140
    v_cvt_pk_bf16_f32 v92, v114, v115
    v_mfma_f32_16x16x16_bf16 v[138:141], v[106:107], v[190:191], v[178:181]
    v_cvt_pk_bf16_f32 v93, v116, v117
    v_cvt_pk_bf16_f32 v154, v154, v155
    v_accvgpr_write_b32 a232, v154
    v_cvt_pk_bf16_f32 v156, v156, v157
    v_mfma_f32_16x16x32_bf16 v[230:233], a[116:119], v[218:221], v[230:233]
    ds_read_b128 v[114:117], v123 offset:256
    v_accvgpr_write_b32 a233, v156
    v_mfma_f32_16x16x32_bf16 v[186:189], a[120:123], v[170:173], 0
    v_cvt_pk_bf16_f32 v82, v174, v175
    v_cvt_pk_bf16_f32 v83, v176, v177
    v_mfma_f32_16x16x32_bf16 v[186:189], a[124:127], v[166:169], v[186:189]
    v_cvt_pk_bf16_f32 v106, v138, v139
    v_cvt_pk_bf16_f32 v107, v140, v141
    v_mfma_f32_16x16x32_bf16 v[186:189], a[128:131], v[162:165], v[186:189]
    s_waitcnt lgkmcnt(1)
    ds_read_b128 v[138:141], v123 offset:320
    v_cvt_pk_bf16_f32 v127, v216, v217
    v_mul_f32 v150, v146, v150
    v_mfma_f32_16x16x16_bf16 v[154:157], a[220:221], v[190:191], v[130:133]
    v_mul_f32 v151, v146, v151
    v_cvt_pk_bf16_f32 v128, v150, v151
    v_mul_f32 v152, v146, v152
    v_mfma_f32_16x16x16_bf16 v[174:177], a[244:245], v[190:191], v[130:133]
    v_mul_f32 v153, v146, v153
    v_cvt_pk_bf16_f32 v129, v152, v153
    v_mul_f32 v118, v146, v118
    v_mfma_f32_16x16x16_bf16 v[150:153], v[94:95], v[190:191], v[130:133]
    v_cvt_pk_bf16_f32 v154, v154, v155
    v_accvgpr_write_b32 a220, v154
    v_cvt_pk_bf16_f32 v156, v156, v157
    v_accvgpr_write_b32 a221, v156
    v_mfma_f32_16x16x32_bf16 v[186:189], a[132:135], v[210:213], v[186:189]
    s_waitcnt lgkmcnt(1)
    ds_write_b128 v3, v[126:129] offset:12288
    v_mfma_f32_16x16x16_bf16 v[126:129], a[222:223], v[190:191], v[114:117]
    v_cvt_pk_bf16_f32 v174, v174, v175
    v_accvgpr_write_b32 a244, v174
    v_cvt_pk_bf16_f32 v176, v176, v177
    v_mfma_f32_16x16x16_bf16 v[130:133], a[246:247], v[190:191], v[114:117]
    v_accvgpr_write_b32 a245, v176
    v_cvt_pk_bf16_f32 v94, v150, v151
    v_cvt_pk_bf16_f32 v95, v152, v153
    v_mfma_f32_16x16x16_bf16 v[150:153], v[96:97], v[190:191], v[114:117]
    v_cvt_pk_bf16_f32 v126, v126, v127
    v_accvgpr_write_b32 a222, v126
    v_cvt_pk_bf16_f32 v128, v128, v129
    v_accvgpr_write_b32 a223, v128
    v_mfma_f32_16x16x32_bf16 v[186:189], a[136:139], v[226:229], v[186:189]
    s_waitcnt lgkmcnt(1)
    ds_read_b128 v[114:117], v123 offset:384
    v_cvt_pk_bf16_f32 v130, v130, v131
    v_accvgpr_write_b32 a246, v130
    v_mfma_f32_16x16x16_bf16 v[126:129], a[234:235], v[190:191], v[138:141]
    v_cvt_pk_bf16_f32 v132, v132, v133
    v_accvgpr_write_b32 a247, v132
    v_cvt_pk_bf16_f32 v96, v150, v151
    v_mfma_f32_16x16x16_bf16 v[130:133], v[84:85], v[190:191], v[138:141]
    v_cvt_pk_bf16_f32 v97, v152, v153
    v_mul_f32 v119, v146, v119
    v_cvt_pk_bf16_f32 v192, v118, v119
    v_mfma_f32_16x16x16_bf16 v[150:153], v[108:109], v[190:191], v[138:141]
    v_cvt_pk_bf16_f32 v126, v126, v127
    v_accvgpr_write_b32 a234, v126
    v_cvt_pk_bf16_f32 v128, v128, v129
    v_accvgpr_write_b32 a235, v128
    v_mfma_f32_16x16x32_bf16 v[186:189], a[140:143], v[218:221], v[186:189]
    ds_read_b128 v[126:129], v123 offset:448
    v_cvt_pk_bf16_f32 v84, v130, v131
    v_mfma_f32_16x16x32_bf16 v[154:157], a[0:3], v[170:173], 0
    v_cvt_pk_bf16_f32 v85, v132, v133
    v_cvt_pk_bf16_f32 v108, v150, v151
    v_mfma_f32_16x16x32_bf16 v[154:157], a[4:7], v[166:169], v[154:157]
    v_cvt_pk_bf16_f32 v109, v152, v153
    v_mul_f32 v120, v146, v120
    v_mfma_f32_16x16x32_bf16 v[154:157], a[8:11], v[162:165], v[154:157]
    s_waitcnt lgkmcnt(1)
    ds_read_b128 v[130:133], v123 offset:512
    v_mul_f32 v121, v146, v121
    v_cvt_pk_bf16_f32 v193, v120, v121
    v_mfma_f32_16x16x16_bf16 v[138:141], a[224:225], v[190:191], v[114:117]
    v_rcp_f32 v134, v134
    v_cvt_pk_f16_f32 v118, v158, v159
    v_mfma_f32_16x16x16_bf16 v[146:149], a[248:249], v[190:191], v[114:117]
    v_mul_f32 v142, v134, v142
    v_mul_f32 v143, v134, v143
    v_cvt_pk_bf16_f32 v142, v142, v143
    v_mfma_f32_16x16x16_bf16 v[150:153], v[98:99], v[190:191], v[114:117]
    v_mul_f32 v144, v134, v144
    v_cvt_pk_bf16_f32 v138, v138, v139
    v_accvgpr_write_b32 a224, v138
    v_cvt_pk_bf16_f32 v140, v140, v141
    v_mfma_f32_16x16x32_bf16 v[154:157], a[12:15], v[210:213], v[154:157]
    s_waitcnt lgkmcnt(1)
    ds_write_b64 v4, v[192:193] offset:16384
    v_mfma_f32_16x16x16_bf16 v[114:117], a[226:227], v[190:191], v[126:129]
    v_accvgpr_write_b32 a225, v140
    v_cvt_pk_bf16_f32 v146, v146, v147
    v_accvgpr_write_b32 a248, v146
    v_mfma_f32_16x16x16_bf16 v[138:141], a[250:251], v[190:191], v[126:129]
    v_cvt_pk_bf16_f32 v148, v148, v149
    v_accvgpr_write_b32 a249, v148
    v_cvt_pk_bf16_f32 v98, v150, v151
    v_mfma_f32_16x16x16_bf16 v[146:149], v[100:101], v[190:191], v[126:129]
    v_cvt_pk_bf16_f32 v99, v152, v153
    v_cvt_pk_bf16_f32 v114, v114, v115
    v_accvgpr_write_b32 a226, v114
    v_cvt_pk_bf16_f32 v116, v116, v117
    v_mfma_f32_16x16x32_bf16 v[154:157], a[16:19], v[226:229], v[154:157]
    s_waitcnt lgkmcnt(1)
    ds_read_b128 v[126:129], v123 offset:576
    v_accvgpr_write_b32 a227, v116
    v_cvt_pk_bf16_f32 v138, v138, v139
    v_mfma_f32_16x16x16_bf16 v[114:117], a[236:237], v[190:191], v[130:133]
    v_accvgpr_write_b32 a250, v138
    v_cvt_pk_bf16_f32 v140, v140, v141
    v_accvgpr_write_b32 a251, v140
    v_mfma_f32_16x16x16_bf16 v[138:141], v[86:87], v[190:191], v[130:133]
    v_cvt_pk_bf16_f32 v100, v146, v147
    v_cvt_pk_bf16_f32 v101, v148, v149
    v_mul_f32 v145, v134, v145
    v_mfma_f32_16x16x16_bf16 v[146:149], v[110:111], v[190:191], v[130:133]
    v_cvt_pk_bf16_f32 v114, v114, v115
    v_accvgpr_write_b32 a236, v114
    v_cvt_pk_bf16_f32 v116, v116, v117
    v_accvgpr_write_b32 a237, v116
    v_mfma_f32_16x16x32_bf16 v[154:157], a[20:23], v[218:221], v[154:157]
    ds_read_b128 v[114:117], v123 offset:640
    v_cvt_pk_bf16_f32 v86, v138, v139
    v_mfma_f32_16x16x32_bf16 v[174:177], a[24:27], v[170:173], 0
    v_cvt_pk_bf16_f32 v87, v140, v141
    v_cvt_pk_bf16_f32 v110, v146, v147
    v_mfma_f32_16x16x32_bf16 v[174:177], a[28:31], v[166:169], v[174:177]
    v_cvt_pk_bf16_f32 v111, v148, v149
    v_cvt_pk_bf16_f32 v143, v144, v145
    v_mfma_f32_16x16x32_bf16 v[174:177], a[32:35], v[162:165], v[174:177]
    s_waitcnt lgkmcnt(1)
    ds_read_b128 v[130:133], v123 offset:704
    v_mul_f32 v182, v134, v182
    v_mul_f32 v183, v134, v183
    v_mfma_f32_16x16x16_bf16 v[122:125], a[228:229], v[190:191], v[126:129]
    v_cvt_pk_bf16_f32 v144, v182, v183
    v_mul_f32 v184, v134, v184
    v_mul_f32 v185, v134, v185
    v_mfma_f32_16x16x16_bf16 v[138:141], a[252:253], v[190:191], v[126:129]
    v_cvt_pk_bf16_f32 v145, v184, v185
    v_mul_f32 v206, v134, v206
    v_mul_f32 v207, v134, v207
    v_mfma_f32_16x16x16_bf16 v[146:149], v[102:103], v[190:191], v[126:129]
    v_cvt_pk_bf16_f32 v122, v122, v123
    v_accvgpr_write_b32 a228, v122
    v_cvt_pk_bf16_f32 v124, v124, v125
    v_accvgpr_write_b32 a229, v124
    v_mfma_f32_16x16x32_bf16 v[174:177], a[36:39], v[210:213], v[174:177]
    s_waitcnt lgkmcnt(1)
    ds_write_b128 v3, v[142:145] offset:6144
    v_mfma_f32_16x16x16_bf16 v[122:125], a[230:231], v[190:191], v[114:117]
    v_cvt_pk_bf16_f32 v138, v138, v139
    v_accvgpr_write_b32 a252, v138
    v_cvt_pk_bf16_f32 v140, v140, v141
    v_mfma_f32_16x16x16_bf16 v[126:129], a[254:255], v[190:191], v[114:117]
    v_accvgpr_write_b32 a253, v140
    v_cvt_pk_bf16_f32 v102, v146, v147
    v_cvt_pk_bf16_f32 v103, v148, v149
    v_mfma_f32_16x16x16_bf16 v[138:141], v[104:105], v[190:191], v[114:117]
    v_cvt_pk_bf16_f32 v122, v122, v123
    v_accvgpr_write_b32 a230, v122
    v_cvt_pk_bf16_f32 v124, v124, v125
    v_accvgpr_write_b32 a231, v124
    v_mfma_f32_16x16x32_bf16 v[174:177], a[40:43], v[226:229], v[174:177]
    s_waitcnt lgkmcnt(1)
    v_cvt_pk_bf16_f32 v126, v126, v127
    v_accvgpr_write_b32 a254, v126
    v_cvt_pk_bf16_f32 v128, v128, v129
    v_mfma_f32_16x16x16_bf16 v[114:117], a[238:239], v[190:191], v[130:133]
    v_accvgpr_write_b32 a255, v128
    v_cvt_pk_bf16_f32 v104, v138, v139
    v_cvt_pk_bf16_f32 v105, v140, v141
    v_mfma_f32_16x16x16_bf16 v[122:125], v[88:89], v[190:191], v[130:133]
    v_cvt_pk_bf16_f32 v158, v206, v207
    v_mul_f32 v208, v134, v208
    v_mul_f32 v209, v134, v209
    v_mfma_f32_16x16x16_bf16 v[126:129], v[112:113], v[190:191], v[130:133]
    v_cvt_pk_bf16_f32 v114, v114, v115
    v_accvgpr_write_b32 a238, v114
    v_cvt_pk_bf16_f32 v116, v116, v117
    v_accvgpr_write_b32 a239, v116
    v_mfma_f32_16x16x32_bf16 v[174:177], a[44:47], v[218:221], v[174:177]
    v_cvt_pk_bf16_f32 v88, v122, v123
    v_cvt_pk_bf16_f32 v89, v124, v125
    v_mfma_f32_16x16x32_bf16 v[182:185], a[48:51], v[170:173], 0
    v_cvt_pk_bf16_f32 v112, v126, v127
    v_cvt_pk_bf16_f32 v113, v128, v129
    v_mfma_f32_16x16x32_bf16 v[182:185], a[52:55], v[166:169], v[182:185]
    v_cvt_pk_bf16_f32 v159, v208, v209
    v_pk_mul_f16 v223, v118, v118
    v_mfma_f32_16x16x32_bf16 v[182:185], a[56:59], v[162:165], v[182:185]
    ds_write_b64 v4, v[158:159] offset:10240
    v_mfma_f32_16x16x32_bf16 v[182:185], a[60:63], v[210:213], v[182:185]
    v_cvt_pk_f16_f32 v119, v160, v161
    v_pk_mul_f16 v225, v119, v119
    v_mfma_f32_16x16x32_bf16 v[182:185], a[64:67], v[226:229], v[182:185]
    v_cvt_pk_f16_f32 v120, v230, v231
    v_pk_fma_f16 v223, v120, v120, v223
    v_mfma_f32_16x16x32_bf16 v[182:185], a[68:71], v[218:221], v[182:185]
    v_cvt_pk_f16_f32 v121, v232, v233
    v_pk_fma_f16 v225, v121, v121, v225
    v_mfma_f32_16x16x32_bf16 v[230:233], v[170:173], a[144:147], 0
    v_cvt_pk_f16_f32 v196, v186, v187
    v_pk_fma_f16 v223, v196, v196, v223
    v_mfma_f32_16x16x32_bf16 v[230:233], v[166:169], a[148:151], v[230:233]
    v_cvt_pk_f16_f32 v197, v188, v189
    v_pk_fma_f16 v225, v197, v197, v225
    v_mfma_f32_16x16x32_bf16 v[230:233], v[162:165], a[152:155], v[230:233]
    v_cvt_pk_f16_f32 v206, v154, v155
    v_add_u32 v7, 16, v7
    v_mfma_f32_16x16x32_bf16 v[230:233], v[210:213], a[156:159], v[230:233]
    s_waitcnt lgkmcnt(0)
    v_xor_b32 v3, 65536, v3
    v_xor_b32 v4, 65536, v4
    v_mfma_f32_16x16x32_bf16 v[230:233], v[226:229], a[160:163], v[230:233]
    s_barrier
    v_mfma_f32_16x16x32_bf16 v[230:233], v[218:221], a[164:167], v[230:233]
L_go:
    s_waitcnt lgkmcnt(0)
    s_cmp_eq_u32 s16, 1
    s_cbranch_scc1 L_loop_fast1
    s_cmp_eq_u32 s16, 2
    s_cbranch_scc1 L_loop_fast2
    s_cmp_eq_u32 s16, 3
    s_cbranch_scc1 L_loop_fast3
    s_branch L_loop_fast0
.p2align 6
L_loop_fast0:
    v_mfma_f32_16x16x32_bf16 v[234:237], v[170:173], a[168:171], 0
    s_add_u32 s12, s42, s27
    ds_read_b128 v[242:245], v2 offset:18432
    ds_read_b128 v[246:249], v2 offset:19456
    v_mfma_f32_16x16x32_bf16 v[234:237], v[166:169], a[172:175], v[234:237]
    s_addc_u32 s13, s43, 0
    v_pk_mul_f16 v222, v206, v206
    v_cvt_pk_f16_f32 v207, v156, v157
    v_mfma_f32_16x16x32_bf16 v[234:237], v[162:165], a[176:179], v[234:237]
    s_sub_u32 s14, s36, s27
    v_pk_mul_f16 v224, v207, v207
    v_cvt_pk_f16_f32 v208, v174, v175
    v_mfma_f32_16x16x32_bf16 v[234:237], v[210:213], a[180:183], v[234:237]
    s_cmp_ge_u32 s18, 2
    ds_read_b128 v[134:137], v0 offset:26624
    v_pk_fma_f16 v222, v208, v208, v222
    v_mfma_f32_16x16x32_bf16 v[234:237], v[226:229], a[184:187], v[234:237]
    s_cselect_b32 s14, s14, 0
    ds_read_b128 v[154:157], v1 offset:26624
    v_cvt_pk_f16_f32 v209, v176, v177
    v_mfma_f32_16x16x32_bf16 v[234:237], v[218:221], a[188:191], v[234:237]
    s_add_u32 s34, s18, 2
    ds_read_b128 v[130:133], v0 offset:26752
    v_pk_fma_f16 v224, v209, v209, v224
    v_mfma_f32_16x16x32_bf16 v[114:117], v[170:173], a[192:195], 0
    s_add_u32 s8, s40, s23
    ds_read_b128 v[122:125], v1 offset:26752
    v_cvt_pk_f16_f32 v194, v182, v183
    v_mfma_f32_16x16x32_bf16 v[114:117], v[166:169], a[196:199], v[114:117]
    s_addc_u32 s9, s41, 0
    ds_read_b128 v[126:129], v0 offset:26880
    v_pk_fma_f16 v222, v194, v194, v222
    v_mfma_f32_16x16x32_bf16 v[114:117], v[162:165], a[200:203], v[114:117]
    s_waitcnt lgkmcnt(5)
    ds_read_b128 v[166:169], v1 offset:26880
    v_cvt_pk_f16_f32 v195, v184, v185
    v_mfma_f32_16x16x32_bf16 v[198:201], v[32:35], v[242:245], 0
    s_sub_u32 s10, s36, s23
    v_pk_fma_f16 v224, v195, v195, v224
    v_cvt_pk_bf16_f32 v174, v230, v231
    v_mfma_f32_16x16x32_bf16 v[198:201], v[32:35], v[246:249], v[198:201]
    s_cmp_lt_u32 s34, s17
    v_cvt_pk_bf16_f32 v175, v232, v233
    v_cvt_pk_bf16_f32 v182, v234, v235
    v_mfma_f32_16x16x32_f16 v[170:173], v[40:43], v[222:225], 0
    s_waitcnt lgkmcnt(5)
    v_cvt_pk_bf16_f32 v183, v236, v237
    s_cselect_b32 s10, s10, 0
    v_mfma_f32_16x16x32_bf16 v[114:117], v[210:213], a[204:207], v[114:117]
    s_add_u32 m0, s28, 0
    v_mul_f32 v255, 0x3baaaaab, v198
    v_mul_f32 v254, 0x3baaaaab, v199
    v_mfma_f32_16x16x32_bf16 v[114:117], v[226:229], a[208:211], v[114:117]
    s_mov_b32 s27, s26
    v_rsq_f32 v172, v170
    v_mfma_f32_16x16x32_bf16 v[114:117], v[218:221], a[212:215], v[114:117]
    s_mov_b32 s26, s25
    v_rsq_f32 v173, v171
    v_mfma_f32_16x16x32_bf16 v[162:165], a[72:75], v[134:137], 0
    s_waitcnt lgkmcnt(1)
    v_mul_f32 v172, s31, v172
    v_cvt_pk_f16_f32 v172, v172, v173
    v_mfma_f32_16x16x32_bf16 v[162:165], a[76:79], v[154:157], v[162:165]
    s_mov_b32 s25, s24
    v_cvt_pk_bf16_f32 v114, v114, v115
    v_cvt_pk_bf16_f32 v115, v116, v117
    v_mfma_f32_16x16x32_bf16 v[162:165], a[80:83], v[130:133], v[162:165]
    s_mov_b32 s24, s23
    v_pk_mul_f16 v118, v118, v172 op_sel:[0,1] op_sel_hi:[1,1]
    v_pk_mul_f16 v119, v119, v172 op_sel:[0,1] op_sel_hi:[1,1]
    v_mfma_f32_16x16x32_bf16 v[162:165], a[84:87], v[122:125], v[162:165]
    s_waitcnt lgkmcnt(0)
    v_pk_mul_f16 v120, v120, v172 op_sel:[0,1] op_sel_hi:[1,1]
    v_pk_mul_f16 v121, v121, v172 op_sel:[0,1] op_sel_hi:[1,1]
    v_mfma_f32_16x16x32_bf16 v[162:165], a[88:91], v[126:129], v[162:165]
    v_pk_mul_f16 v196, v196, v172 op_sel:[0,1] op_sel_hi:[1,1]
    v_pk_mul_f16 v197, v197, v172 op_sel:[0,1] op_sel_hi:[1,1]
    v_mfma_f32_16x16x32_bf16 v[162:165], a[92:95], v[166:169], v[162:165]
    v_pk_mul_f16 v206, v206, v172 op_sel:[0,0] op_sel_hi:[1,0]
    v_pk_mul_f16 v207, v207, v172 op_sel:[0,0] op_sel_hi:[1,0]
    v_mfma_f32_16x16x32_bf16 v[210:213], a[96:99], v[134:137], 0
    v_pk_mul_f16 v208, v208, v172 op_sel:[0,0] op_sel_hi:[1,0]
    v_pk_mul_f16 v209, v209, v172 op_sel:[0,0] op_sel_hi:[1,0]
    v_mfma_f32_16x16x32_bf16 v[210:213], a[100:103], v[154:157], v[210:213]
    v_pk_mul_f16 v194, v194, v172 op_sel:[0,0] op_sel_hi:[1,0]
    v_pk_mul_f16 v195, v195, v172 op_sel:[0,0] op_sel_hi:[1,0]
    v_mfma_f32_16x16x32_bf16 v[210:213], a[104:107], v[130:133], v[210:213]
    v_min3_u32 v44, v44, v170, v171
    v_max3_u32 v45, v45, v170, v171
    v_mfma_f32_16x16x32_bf16 v[210:213], a[108:111], v[122:125], v[210:213]
    v_cvt_pk_f16_f32 v170, v162, v163
    v_pk_mul_f16 v163, v170, v170
    v_mfma_f32_16x16x32_bf16 v[210:213], a[112:115], v[126:129], v[210:213]
    v_cvt_pk_f16_f32 v171, v164, v165
    v_pk_mul_f16 v165, v171, v171
    v_mfma_f32_16x16x32_bf16 v[210:213], a[116:119], v[166:169], v[210:213]
    v_rsq_f32 v255, v255
    v_mfma_f32_16x16x32_bf16 v[214:217], a[120:123], v[134:137], 0
    v_rsq_f32 v254, v254
    v_mfma_f32_16x16x32_bf16 v[214:217], a[124:127], v[154:157], v[214:217]
    v_mul_f32 v142, v254, v142
    v_mul_f32 v143, v254, v143
    v_mfma_f32_16x16x32_bf16 v[214:217], a[128:131], v[130:133], v[214:217]
    v_cvt_pk_bf16_f32 v142, v142, v143
    v_cvt_pk_f16_f32 v172, v210, v211
    v_mfma_f32_16x16x32_bf16 v[214:217], a[132:135], v[122:125], v[214:217]
    v_pk_fma_f16 v163, v172, v172, v163
    v_cvt_pk_f16_f32 v173, v212, v213
    v_mfma_f32_16x16x32_bf16 v[214:217], a[136:139], v[126:129], v[214:217]
    v_pk_fma_f16 v165, v173, v173, v165
    v_mul_f32 v144, v254, v144
    v_mfma_f32_16x16x32_bf16 v[214:217], a[140:143], v[166:169], v[214:217]
    v_mul_f32 v145, v254, v145
    v_cvt_pk_bf16_f32 v143, v144, v145
    v_mfma_f32_16x16x32_bf16 v[210:213], a[0:3], v[134:137], 0
    v_mul_f32 v158, v254, v158
    v_mul_f32 v159, v254, v159
    v_mfma_f32_16x16x32_bf16 v[210:213], a[4:7], v[154:157], v[210:213]
    v_cvt_pk_bf16_f32 v144, v158, v159
    v_mul_f32 v160, v254, v160
    v_mfma_f32_16x16x32_bf16 v[210:213], a[8:11], v[130:133], v[210:213]
    v_cvt_pk_f16_f32 v220, v214, v215
    v_pk_fma_f16 v163, v220, v220, v163
    v_mfma_f32_16x16x32_bf16 v[210:213], a[12:15], v[122:125], v[210:213]
    v_cvt_pk_f16_f32 v221, v216, v217
    v_pk_fma_f16 v165, v221, v221, v165
    v_mfma_f32_16x16x32_bf16 v[210:213], a[16:19], v[126:129], v[210:213]
    v_mul_f32 v161, v254, v161
    v_cvt_pk_bf16_f32 v145, v160, v161
    v_mfma_f32_16x16x32_bf16 v[210:213], a[20:23], v[166:169], v[210:213]
    buffer_store_dwordx4 v[142:145], v16, s[12:15], 0 offen nt
    v_mul_f32 v178, v254, v178
    v_mul_f32 v179, v254, v179
    v_cvt_pk_bf16_f32 v116, v178, v179
    v_mul_f32 v180, v254, v180
    v_mfma_f32_16x16x32_bf16 v[142:145], a[24:27], v[134:137], 0
    v_mul_f32 v181, v254, v181
    v_cvt_pk_bf16_f32 v117, v180, v181
    v_mfma_f32_16x16x32_bf16 v[142:145], a[28:31], v[154:157], v[142:145]
    v_cvt_pk_f16_f32 v158, v210, v211
    v_pk_mul_f16 v162, v158, v158
    v_mfma_f32_16x16x32_bf16 v[142:145], a[32:35], v[130:133], v[142:145]
    v_cvt_pk_f16_f32 v159, v212, v213
    v_pk_mul_f16 v164, v159, v159
    v_mfma_f32_16x16x32_bf16 v[142:145], a[36:39], v[122:125], v[142:145]
    v_mul_f32 v254, 0x3baaaaab, v200
    v_mul_f32 v150, v255, v150
    v_mfma_f32_16x16x32_bf16 v[142:145], a[40:43], v[126:129], v[142:145]
    v_rsq_f32 v254, v254
    v_mfma_f32_16x16x32_bf16 v[142:145], a[44:47], v[166:169], v[142:145]
    v_mul_f32 v151, v255, v151
    v_cvt_pk_bf16_f32 v150, v150, v151
    v_mfma_f32_16x16x32_bf16 v[178:181], a[48:51], v[134:137], 0
    v_mul_f32 v152, v255, v152
    v_mul_f32 v153, v255, v153
    v_mfma_f32_16x16x32_bf16 v[178:181], a[52:55], v[154:157], v[178:181]
    v_cvt_pk_bf16_f32 v151, v152, v153
    v_mul_f32 v190, v255, v190
    v_mfma_f32_16x16x32_bf16 v[178:181], a[56:59], v[130:133], v[178:181]
    v_cvt_pk_f16_f32 v160, v142, v143
    v_pk_fma_f16 v162, v160, v160, v162
    v_mfma_f32_16x16x32_bf16 v[178:181], a[60:63], v[122:125], v[178:181]
    v_cvt_pk_f16_f32 v161, v144, v145
    v_pk_fma_f16 v164, v161, v161, v164
    v_mfma_f32_16x16x32_bf16 v[178:181], a[64:67], v[126:129], v[178:181]
    v_mul_f32 v191, v255, v191
    v_cvt_pk_bf16_f32 v152, v190, v191
    v_mfma_f32_16x16x32_bf16 v[178:181], a[68:71], v[166:169], v[178:181]
    v_mul_f32 v192, v255, v192
    v_mul_f32 v193, v255, v193
    v_mfma_f32_16x16x32_bf16 v[142:145], v[134:137], a[144:147], 0
    v_cvt_pk_bf16_f32 v153, v192, v193
    v_mul_f32 v202, v255, v202
    v_mfma_f32_16x16x32_bf16 v[142:145], v[154:157], a[148:151], v[142:145]
    v_mul_f32 v203, v255, v203
    v_cvt_pk_bf16_f32 v202, v202, v203
    v_mfma_f32_16x16x32_bf16 v[142:145], v[130:133], a[152:155], v[142:145]
    v_cvt_pk_f16_f32 v218, v178, v179
    v_pk_fma_f16 v162, v218, v218, v162
    v_mfma_f32_16x16x32_bf16 v[142:145], v[122:125], a[156:159], v[142:145]
    v_cvt_pk_f16_f32 v219, v180, v181
    v_pk_fma_f16 v164, v219, v219, v164
    v_mfma_f32_16x16x32_bf16 v[142:145], v[126:129], a[160:163], v[142:145]
    buffer_store_dwordx2 v[116:117], v19, s[12:15], 0 offen nt
    v_mul_f32 v204, v255, v204
    v_mul_f32 v205, v255, v205
    v_mfma_f32_16x16x32_f16 v[190:193], v[40:43], v[162:165], 0
    v_cvt_pk_bf16_f32 v203, v204, v205
    v_mul_f32 v146, v254, v146
    v_mfma_f32_16x16x32_bf16 v[142:145], v[166:169], a[164:167], v[142:145]
    v_mul_f32 v147, v254, v147
    v_cvt_pk_bf16_f32 v146, v146, v147
    v_mfma_f32_16x16x32_bf16 v[178:181], v[134:137], a[168:171], 0
    v_mul_f32 v148, v254, v148
    v_mul_f32 v149, v254, v149
    v_mfma_f32_16x16x32_bf16 v[178:181], v[154:157], a[172:175], v[178:181]
    v_rsq_f32 v192, v190
    v_mfma_f32_16x16x32_bf16 v[178:181], v[130:133], a[176:179], v[178:181]
    v_cvt_pk_bf16_f32 v176, v142, v143
    v_cvt_pk_bf16_f32 v177, v144, v145
    v_mfma_f32_16x16x32_bf16 v[178:181], v[122:125], a[180:183], v[178:181]
    ds_read_b128 v[142:145], v0 offset:32768
    v_mul_f32 v192, s31, v192
    v_mfma_f32_16x16x32_bf16 v[178:181], v[126:129], a[184:187], v[178:181]
    ds_read_b128 v[162:165], v1 offset:32768
    v_min3_u32 v44, v44, v190, v191
    v_mfma_f32_16x16x32_bf16 v[178:181], v[166:169], a[188:191], v[178:181]
    ds_read_b128 v[210:213], v0 offset:32896
    v_max3_u32 v45, v45, v190, v191
    v_mfma_f32_16x16x32_bf16 v[198:201], v[134:137], a[192:195], 0
    ds_read_b128 v[134:137], v1 offset:32896
    v_cvt_pk_bf16_f32 v147, v148, v149
    v_mfma_f32_16x16x32_bf16 v[198:201], v[154:157], a[196:199], v[198:201]
    ds_read_b128 v[154:157], v0 offset:33024
    v_mul_f32 v138, v254, v138
    v_mfma_f32_16x16x32_bf16 v[198:201], v[130:133], a[200:203], v[198:201]
    ds_read_b128 v[130:133], v1 offset:33024
    v_cvt_pk_bf16_f32 v184, v178, v179
    v_mfma_f32_16x16x32_bf16 v[198:201], v[122:125], a[204:207], v[198:201]
    v_rsq_f32 v193, v191
    v_mfma_f32_16x16x32_bf16 v[198:201], v[126:129], a[208:211], v[198:201]
    v_cvt_pk_f16_f32 v192, v192, v193
    v_cvt_pk_bf16_f32 v185, v180, v181
    v_mfma_f32_16x16x32_bf16 v[198:201], v[166:169], a[212:215], v[198:201]
    s_waitcnt lgkmcnt(5)
    v_pk_mul_f16 v170, v170, v192 op_sel:[0,1] op_sel_hi:[1,1]
    v_pk_mul_f16 v171, v171, v192 op_sel:[0,1] op_sel_hi:[1,1]
    v_mfma_f32_16x16x32_bf16 v[178:181], a[72:75], v[142:145], 0
    s_waitcnt lgkmcnt(4)
    v_pk_mul_f16 v172, v172, v192 op_sel:[0,1] op_sel_hi:[1,1]
    v_pk_mul_f16 v173, v173, v192 op_sel:[0,1] op_sel_hi:[1,1]
    v_mfma_f32_16x16x32_bf16 v[178:181], a[76:79], v[162:165], v[178:181]
    s_waitcnt lgkmcnt(3)
    v_cvt_pk_bf16_f32 v116, v198, v199
    v_cvt_pk_bf16_f32 v117, v200, v201
    v_mfma_f32_16x16x32_bf16 v[178:181], a[80:83], v[210:213], v[178:181]
    s_waitcnt lgkmcnt(2)
    buffer_store_dwordx4 v[150:153], v15, s[12:15], 0 offen nt
    v_pk_mul_f16 v220, v220, v192 op_sel:[0,1] op_sel_hi:[1,1]
    v_pk_mul_f16 v221, v221, v192 op_sel:[0,1] op_sel_hi:[1,1]
    v_pk_mul_f16 v158, v158, v192 op_sel:[0,0] op_sel_hi:[1,0]
    v_pk_mul_f16 v159, v159, v192 op_sel:[0,0] op_sel_hi:[1,0]
    v_mfma_f32_16x16x32_bf16 v[178:181], a[84:87], v[134:137], v[178:181]
    s_waitcnt lgkmcnt(0)
    v_pk_mul_f16 v160, v160, v192 op_sel:[0,0] op_sel_hi:[1,0]
    v_pk_mul_f16 v161, v161, v192 op_sel:[0,0] op_sel_hi:[1,0]
    v_mfma_f32_16x16x32_bf16 v[178:181], a[88:91], v[154:157], v[178:181]
    v_pk_mul_f16 v218, v218, v192 op_sel:[0,0] op_sel_hi:[1,0]
    v_pk_mul_f16 v219, v219, v192 op_sel:[0,0] op_sel_hi:[1,0]
    v_mfma_f32_16x16x32_bf16 v[178:181], a[92:95], v[130:133], v[178:181]
    v_mul_f32 v139, v254, v139
    v_cvt_pk_bf16_f32 v148, v138, v139
    v_mfma_f32_16x16x32_bf16 v[150:153], a[96:99], v[142:145], 0
    v_mul_f32 v140, v254, v140
    v_mul_f32 v141, v254, v141
    v_mfma_f32_16x16x32_bf16 v[150:153], a[100:103], v[162:165], v[150:153]
    v_cvt_pk_bf16_f32 v149, v140, v141
    v_mul_f32 v186, v254, v186
    v_mfma_f32_16x16x32_bf16 v[150:153], a[104:107], v[210:213], v[150:153]
    v_cvt_pk_f16_f32 v178, v178, v179
    v_pk_mul_f16 v191, v178, v178
    v_mfma_f32_16x16x32_bf16 v[150:153], a[108:111], v[134:137], v[150:153]
    v_cvt_pk_f16_f32 v179, v180, v181
    v_pk_mul_f16 v193, v179, v179
    v_mfma_f32_16x16x32_bf16 v[150:153], a[112:115], v[154:157], v[150:153]
    v_mul_f32 v187, v254, v187
    v_cvt_pk_bf16_f32 v204, v186, v187
    v_mfma_f32_16x16x32_bf16 v[150:153], a[116:119], v[130:133], v[150:153]
    v_mul_f32 v188, v254, v188
    v_mul_f32 v189, v254, v189
    v_mfma_f32_16x16x32_bf16 v[138:141], a[120:123], v[142:145], 0
    s_waitcnt vmcnt(3)
    v_cvt_pk_bf16_f32 v205, v188, v189
    v_xor_b32 v0, 65536, v0
    v_mfma_f32_16x16x32_bf16 v[138:141], a[124:127], v[162:165], v[138:141]
    s_barrier
    v_mfma_f32_16x16x32_bf16 v[138:141], a[128:131], v[210:213], v[138:141]
    v_mfma_f32_16x16x32_bf16 v[138:141], a[132:135], v[134:137], v[138:141]
    v_mfma_f32_16x16x32_bf16 v[138:141], a[136:139], v[154:157], v[138:141]
    v_mfma_f32_16x16x32_bf16 v[138:141], a[140:143], v[130:133], v[138:141]
    v_cvt_pk_f16_f32 v180, v150, v151
    v_pk_fma_f16 v191, v180, v180, v191
    v_mfma_f32_16x16x32_bf16 v[186:189], a[0:3], v[142:145], 0
    v_cvt_pk_f16_f32 v181, v152, v153
    v_pk_fma_f16 v193, v181, v181, v193
    v_mfma_f32_16x16x32_bf16 v[186:189], a[4:7], v[162:165], v[186:189]
    buffer_load_dwordx4 v10, s[8:11], 0 offen nt lds
    v_xor_b32 v1, 65536, v1
    v_mfma_f32_16x16x32_bf16 v[186:189], a[8:11], v[210:213], v[186:189]
    s_add_u32 m0, s28, 4096
    v_cvt_pk_f16_f32 v124, v138, v139
    v_pk_fma_f16 v191, v124, v124, v191
    v_mfma_f32_16x16x32_bf16 v[186:189], a[12:15], v[134:137], v[186:189]
    v_cvt_pk_f16_f32 v125, v140, v141
    v_pk_fma_f16 v193, v125, v125, v193
    v_mfma_f32_16x16x32_bf16 v[186:189], a[16:19], v[154:157], v[186:189]
    v_mfma_f32_16x16x32_bf16 v[186:189], a[20:23], v[130:133], v[186:189]
    v_mfma_f32_16x16x32_bf16 v[150:153], a[24:27], v[142:145], 0
    buffer_load_dwordx4 v11, s[8:11], 0 offen nt lds
    s_add_u32 m0, s28, 8192
    v_mfma_f32_16x16x32_bf16 v[150:153], a[28:31], v[162:165], v[150:153]
    v_mfma_f32_16x16x32_bf16 v[150:153], a[32:35], v[210:213], v[150:153]
    v_mfma_f32_16x16x32_bf16 v[150:153], a[36:39], v[134:137], v[150:153]
    v_mfma_f32_16x16x32_bf16 v[150:153], a[40:43], v[154:157], v[150:153]
    v_mfma_f32_16x16x32_bf16 v[150:153], a[44:47], v[130:133], v[150:153]
    buffer_load_dwordx4 v12, s[8:11], 0 offen nt lds
    v_cvt_pk_f16_f32 v186, v186, v187
    v_mfma_f32_16x16x32_bf16 v[138:141], a[48:51], v[142:145], 0
    s_add_u32 m0, s28, 12288
    v_pk_mul_f16 v190, v186, v186
    v_cvt_pk_f16_f32 v187, v188, v189
    v_mfma_f32_16x16x32_bf16 v[138:141], a[52:55], v[162:165], v[138:141]
    s_xor_b32 s28, s28, 65536
    ds_read_b128 v[166:169], v5 offset:0
    ds_read_b128 v[126:129], v5 offset:16
    v_mfma_f32_16x16x32_bf16 v[138:141], a[56:59], v[210:213], v[138:141]
    ds_read_b128 v[198:201], v5 offset:48
    ds_read_b32 v254, v6 offset:192
    v_mfma_f32_16x16x32_bf16 v[138:141], a[60:63], v[134:137], v[138:141]
    v_pk_mul_f16 v192, v187, v187
    v_cvt_pk_f16_f32 v188, v150, v151
    v_mfma_f32_16x16x32_bf16 v[138:141], a[64:67], v[154:157], v[138:141]
    buffer_load_dwordx4 v13, s[8:11], 0 offen nt lds
    v_pk_fma_f16 v190, v188, v188, v190
    v_mfma_f32_16x16x32_bf16 v[138:141], a[68:71], v[130:133], v[138:141]
    s_mov_b32 m0, s29
    v_cvt_pk_f16_f32 v189, v152, v153
    v_pk_fma_f16 v192, v189, v189, v192
    v_mfma_f32_16x16x32_bf16 v[150:153], v[142:145], a[144:147], 0
    s_xor_b32 s29, s29, s30
    v_add_u32 v5, 336, v5
    s_add_u32 s19, s19, s20
    v_mfma_f32_16x16x32_bf16 v[150:153], v[162:165], a[148:151], v[150:153]
    s_add_u32 s23, s23, s21
    v_cvt_pk_f16_f32 v122, v138, v139
    v_pk_fma_f16 v190, v122, v122, v190
    v_mfma_f32_16x16x32_bf16 v[150:153], v[210:213], a[152:155], v[150:153]
    s_cmp_ge_u32 s19, 72
    v_cvt_pk_f16_f32 v123, v140, v141
    v_pk_fma_f16 v192, v123, v123, v192
    v_mfma_f32_16x16x32_bf16 v[150:153], v[134:137], a[156:159], v[150:153]
    s_waitcnt lgkmcnt(2)
    buffer_store_dwordx2 v[202:203], v18, s[12:15], 0 offen nt
    s_cselect_b32 s34, 72, 0
    s_cselect_b32 s35, s22, 0
    v_mfma_f32_16x16x32_f16 v[138:141], v[40:43], v[190:193], 0
    s_sub_u32 s19, s19, s34
    s_add_u32 s23, s23, s35
    s_add_u32 s18, s18, 1
    v_mfma_f32_16x16x32_f16 v[214:217], v[166:169], v[158:161], v[24:27]
    s_cmp_lt_u32 s18, s45
    v_mfma_f32_16x16x32_f16 v[214:217], v[126:129], v[170:173], v[214:217]
    s_waitcnt lgkmcnt(0)
    v_mfma_f32_16x16x32_f16 v[214:217], v[198:201], v[218:221], v[214:217]
    v_rsq_f32 v140, v138
    v_mfma_f32_16x16x32_f16 v[190:193], v[166:169], v[206:209], v[22:25]
    v_rsq_f32 v141, v139
    v_mfma_f32_16x16x32_f16 v[190:193], v[126:129], v[118:121], v[190:193]
    v_mul_f32 v140, s31, v140
    v_cvt_pk_f16_f32 v140, v140, v141
    v_mfma_f32_16x16x32_f16 v[190:193], v[198:201], v[194:197], v[190:193]
    v_pk_mul_f16 v178, v178, v140 op_sel:[0,1] op_sel_hi:[1,1]
    v_pk_mul_f16 v179, v179, v140 op_sel:[0,1] op_sel_hi:[1,1]
    v_mfma_f32_16x16x32_bf16 v[150:153], v[154:157], a[160:163], v[150:153]
    v_pk_mul_f16 v180, v180, v140 op_sel:[0,1] op_sel_hi:[1,1]
    v_pk_mul_f16 v181, v181, v140 op_sel:[0,1] op_sel_hi:[1,1]
    v_mfma_f32_16x16x32_bf16 v[150:153], v[130:133], a[164:167], v[150:153]
    v_pk_mul_f16 v124, v124, v140 op_sel:[0,1] op_sel_hi:[1,1]
    v_pk_mul_f16 v125, v125, v140 op_sel:[0,1] op_sel_hi:[1,1]
    v_mfma_f32_16x16x32_bf16 v[222:225], v[142:145], a[168:171], 0
    v_mov_b32_dpp v254, v191 quad_perm:[0,1,2,3] row_mask:0x1 bank_mask:0xf
    v_mov_b32_dpp v254, v215 quad_perm:[0,1,2,3] row_mask:0x2 bank_mask:0xf
    v_mfma_f32_16x16x32_bf16 v[222:225], v[162:165], a[172:175], v[222:225]
    v_pk_mul_f16 v186, v186, v140 op_sel:[0,0] op_sel_hi:[1,0]
    v_pk_mul_f16 v187, v187, v140 op_sel:[0,0] op_sel_hi:[1,0]
    v_mfma_f32_16x16x32_bf16 v[222:225], v[210:213], a[176:179], v[222:225]
    v_cvt_pk_bf16_f32 v226, v150, v151
    v_cvt_pk_bf16_f32 v227, v152, v153
    v_mfma_f32_16x16x32_bf16 v[222:225], v[134:137], a[180:183], v[222:225]
    v_pk_mul_f16 v188, v188, v140 op_sel:[0,0] op_sel_hi:[1,0]
    v_pk_mul_f16 v189, v189, v140 op_sel:[0,0] op_sel_hi:[1,0]
    v_mfma_f32_16x16x32_f16 v[230:233], v[118:121], v[206:209], v[46:49]
    v_pk_mul_f16 v122, v122, v140 op_sel:[0,0] op_sel_hi:[1,0]
    v_pk_mul_f16 v123, v123, v140 op_sel:[0,0] op_sel_hi:[1,0]
    v_mfma_f32_16x16x32_f16 v[234:237], v[170:173], v[206:209], v[50:53]
    v_min3_u32 v44, v44, v138, v139
    v_max3_u32 v45, v45, v138, v139
    v_mfma_f32_16x16x32_f16 v[138:141], v[178:181], v[206:209], v[54:57]
    v_exp_f32 v214, v214
    v_mfma_f32_16x16x16_f16 v[230:233], v[196:197], v[194:195], v[230:233]
    buffer_store_dwordx4 v[146:149], v17, s[12:15], 0 offen nt
    v_exp_f32 v190, v190
    v_mfma_f32_16x16x16_f16 v[234:237], v[220:221], v[194:195], v[234:237]
    v_cvt_pk_bf16_f32 v39, v190, 0
    v_mfma_f32_16x16x16_f16 v[138:141], v[124:125], v[194:195], v[138:141]
    v_mfma_f32_16x16x32_bf16 v[222:225], v[154:157], a[184:187], v[222:225]
    v_mfma_f32_16x16x32_bf16 v[222:225], v[130:133], a[188:191], v[222:225]
    ds_read_b128 v[146:149], v2 offset:0
    v_mfma_f32_16x16x32_bf16 v[150:153], v[142:145], a[192:195], 0
    ds_read_b128 v[142:145], v2 offset:1024
    v_mfma_f32_16x16x32_bf16 v[150:153], v[162:165], a[196:199], v[150:153]
    ds_read_b128 v[206:209], v2 offset:2048
    v_mfma_f32_16x16x32_bf16 v[150:153], v[210:213], a[200:203], v[150:153]
    ds_read_b128 v[162:165], v2 offset:3072
    v_mfma_f32_16x16x32_bf16 v[150:153], v[134:137], a[204:207], v[150:153]
    ds_read_b128 v[134:137], v2 offset:4096
    v_cvt_pk_bf16_f32 v210, v222, v223
    v_mfma_f32_16x16x32_bf16 v[150:153], v[154:157], a[208:211], v[150:153]
    ds_read_b128 v[154:157], v2 offset:5120
    v_cvt_pk_bf16_f32 v211, v224, v225
    v_mfma_f32_16x16x32_bf16 v[150:153], v[130:133], a[212:215], v[150:153]
    ds_read2_b32 v[228:229], v6 offset0:0 offset1:0
    ds_read2_b32 v[212:213], v6 offset0:16 offset1:16
    v_mfma_f32_16x16x32_f16 v[130:133], v[166:169], v[186:189], v[26:29]
    ds_read2_b32 v[168:169], v6 offset0:32 offset1:32
    v_add_u32 v6, 272, v6
    v_mfma_f32_16x16x32_f16 v[130:133], v[126:129], v[178:181], v[130:133]
    s_waitcnt lgkmcnt(8)
    v_exp_f32 v230, v230
    v_mfma_f32_16x16x32_f16 v[130:133], v[198:201], v[122:125], v[130:133]
    s_waitcnt lgkmcnt(7)
    v_cvt_pk_bf16_f32 v166, v150, v151
    v_cvt_pk_bf16_f32 v167, v152, v153
    v_mfma_f32_16x16x32_bf16 v[150:153], a[216:219], v[146:149], 0
    s_waitcnt lgkmcnt(6)
    v_exp_f32 v231, v231
    v_mfma_f32_16x16x32_bf16 v[150:153], a[220:223], v[142:145], v[150:153]
    s_waitcnt lgkmcnt(5)
    v_exp_f32 v130, v130
    v_mfma_f32_16x16x32_bf16 v[150:153], a[224:227], v[206:209], v[150:153]
    s_waitcnt lgkmcnt(4)
    buffer_store_dwordx2 v[204:205], v20, s[12:15], 0 offen nt
    v_mov_b32_dpp v254, v131 quad_perm:[0,1,2,3] row_mask:0x4 bank_mask:0xf
    v_cvt_pk_bf16_f32 v126, v230, v231
    v_mfma_f32_16x16x32_bf16 v[150:153], a[228:231], v[162:165], v[150:153]
    s_waitcnt lgkmcnt(3)
    v_exp_f32 v254, v254
    v_mfma_f32_16x16x32_bf16 v[150:153], a[232:235], v[134:137], v[150:153]
    s_waitcnt lgkmcnt(1)
    v_exp_f32 v232, v232
    v_mfma_f32_16x16x32_bf16 v[150:153], a[236:239], v[154:157], v[150:153]
    s_waitcnt lgkmcnt(0)
    v_exp_f32 v233, v233
    v_mfma_f32_16x16x32_bf16 v[190:193], a[240:243], v[146:149], 0
    v_cvt_pk_bf16_f32 v254, v254, v254
    v_cvt_pk_bf16_f32 v127, v232, v233
    v_mfma_f32_16x16x32_bf16 v[190:193], a[244:247], v[142:145], v[190:193]
    ds_write_b16 v8, v254
    v_mfma_f32_16x16x32_bf16 v[190:193], a[248:251], v[206:209], v[190:193]
    v_exp_f32 v234, v234
    v_mfma_f32_16x16x32_bf16 v[190:193], a[252:255], v[162:165], v[190:193]
    ds_read_b128 v[198:201], v2 offset:6144
    ds_read_b128 v[230:233], v9
    v_mfma_f32_16x16x32_bf16 v[190:193], v[82:85], v[134:137], v[190:193]
    ds_read_b128 v[222:225], v2 offset:7168
    ds_read_b128 v[238:241], v9 offset:64
    v_mfma_f32_16x16x32_bf16 v[190:193], v[86:89], v[154:157], v[190:193]
    v_exp_f32 v235, v235
    v_mfma_f32_16x16x32_bf16 v[202:205], v[90:93], v[146:149], 0
    ds_read_b128 v[146:149], v2 offset:8192
    ds_read_b128 v[242:245], v2 offset:9216
    v_mfma_f32_16x16x32_bf16 v[202:205], v[94:97], v[142:145], v[202:205]
    v_cvt_pk_bf16_f32 v128, v234, v235
    v_fma_f32 v254, v150, v150, s33
    v_mfma_f32_16x16x32_bf16 v[202:205], v[98:101], v[206:209], v[202:205]
    ds_read_b128 v[206:209], v2 offset:10240
    ds_read_b128 v[246:249], v2 offset:11264
    v_mfma_f32_16x16x32_bf16 v[202:205], v[102:105], v[162:165], v[202:205]
    v_exp_f32 v236, v236
    v_mfma_f32_16x16x32_bf16 v[202:205], v[106:109], v[134:137], v[202:205]
    v_exp_f32 v237, v237
    v_mfma_f32_16x16x32_bf16 v[202:205], v[110:113], v[154:157], v[202:205]
    s_waitcnt lgkmcnt(6)
    v_cvt_pk_bf16_f32 v129, v236, v237
    v_fmac_f32 v254, v151, v151
    v_mfma_f32_16x16x32_bf16 v[142:145], v[230:233], v[28:31], 0
    s_waitcnt lgkmcnt(4)
    v_exp_f32 v138, v138
    v_mfma_f32_16x16x32_bf16 v[142:145], v[238:241], v[28:31], v[142:145]
    buffer_load_dwordx4 v14, s[8:11], 0 offen nt lds
    v_fmac_f32 v254, v152, v152
    v_mfma_f32_16x16x32_bf16 v[134:137], v[230:233], v[174:177], 0
    s_waitcnt lgkmcnt(2)
    v_exp_f32 v139, v139
    v_mfma_f32_16x16x32_bf16 v[134:137], v[238:241], v[226:229], v[134:137]
    v_cvt_pk_bf16_f32 v36, v138, v139
    v_fmac_f32 v254, v153, v153
    v_mfma_f32_16x16x32_bf16 v[154:157], v[230:233], v[182:185], 0
    s_waitcnt lgkmcnt(0)
    v_rcp_f32 v142, v142
    v_mfma_f32_16x16x32_bf16 v[154:157], v[238:241], v[210:213], v[154:157]
    v_exp_f32 v140, v140
    v_mfma_f32_16x16x32_bf16 v[162:165], v[230:233], v[114:117], 0
    v_mul_f32 v134, v134, v142
    v_fmac_f32 v254, v190, v190
    v_mfma_f32_16x16x32_bf16 v[162:165], v[238:241], v[166:169], v[162:165]
    v_exp_f32 v141, v141
    v_mfma_f32_16x16x32_f16 v[230:233], v[118:121], v[158:161], v[58:61]
    v_cvt_pk_bf16_f32 v37, v140, v141
    v_mul_f32_dpp v134, v154, v142 quad_perm:[0,1,2,3] row_mask:0x2 bank_mask:0xf
    v_mfma_f32_16x16x32_f16 v[138:141], v[170:173], v[158:161], v[62:65]
    v_fmac_f32 v254, v191, v191
    v_fmac_f32 v254, v192, v192
    v_mfma_f32_16x16x32_f16 v[154:157], v[178:181], v[158:161], v[66:69]
    v_mul_f32_dpp v134, v162, v142 quad_perm:[0,1,2,3] row_mask:0x4 bank_mask:0xf
    v_cvt_pk_bf16_f32 v134, v134, v134
    v_fmac_f32 v254, v193, v193
    v_mfma_f32_16x16x16_f16 v[230:233], v[196:197], v[218:219], v[230:233]
    v_fmac_f32 v254, v202, v202
    v_fmac_f32 v254, v203, v203
    v_fmac_f32 v254, v204, v204
    v_mfma_f32_16x16x16_f16 v[138:141], v[220:221], v[218:219], v[138:141]
    v_fmac_f32 v254, v205, v205
    v_mfma_f32_16x16x16_f16 v[154:157], v[124:125], v[218:219], v[154:157]
    ds_write_b16 v7, v134
    v_add_u32 v7, 16, v7
    v_mfma_f32_16x16x32_bf16 v[134:137], v[28:31], v[36:39], 0
    v_exp_f32 v230, v230
    v_mfma_f32_16x16x32_bf16 v[134:137], v[28:31], v[126:129], v[134:137]
    v_exp_f32 v231, v231
    v_mfma_f32_16x16x32_bf16 v[158:161], v[226:229], v[36:39], 0
    v_exp_f32 v232, v232
    v_mfma_f32_16x16x32_bf16 v[158:161], v[174:177], v[126:129], v[158:161]
    v_exp_f32 v233, v233
    v_mfma_f32_16x16x32_bf16 v[162:165], v[210:213], v[36:39], 0
    v_cvt_pk_bf16_f32 v230, v230, v231
    v_cvt_pk_bf16_f32 v231, v232, v233
    v_mfma_f32_16x16x32_bf16 v[162:165], v[182:185], v[126:129], v[162:165]
    v_exp_f32 v138, v138
    v_mfma_f32_16x16x32_bf16 v[234:237], v[166:169], v[36:39], 0
    v_exp_f32 v139, v139
    v_mfma_f32_16x16x32_bf16 v[234:237], v[114:117], v[126:129], v[234:237]
    v_cvt_pk_bf16_f32 v232, v138, v139
    v_cvt_pk_bf16_f32 v39, v214, 0
    v_mfma_f32_16x16x32_f16 v[126:129], v[118:121], v[186:189], v[70:73]
    v_exp_f32 v140, v140
    v_mfma_f32_16x16x32_f16 v[118:121], v[170:173], v[186:189], v[74:77]
    v_exp_f32 v141, v141
    v_mfma_f32_16x16x32_bf16 v[142:145], a[216:219], v[198:201], 0
    v_exp_f32 v154, v154
    v_mfma_f32_16x16x32_bf16 v[142:145], a[220:223], v[222:225], v[142:145]
    v_cvt_pk_bf16_f32 v233, v140, v141
    v_exp_f32 v155, v155
    v_mfma_f32_16x16x32_f16 v[138:141], v[178:181], v[186:189], v[78:81]
    v_cvt_pk_bf16_f32 v36, v154, v155
    v_exp_f32 v156, v156
    v_mfma_f32_16x16x16_f16 v[126:129], v[196:197], v[122:123], v[126:129]
    v_exp_f32 v157, v157
    v_mfma_f32_16x16x16_f16 v[118:121], v[220:221], v[122:123], v[118:121]
    v_cvt_pk_bf16_f32 v37, v156, v157
    v_rcp_f32 v134, v134
    v_mfma_f32_16x16x16_f16 v[138:141], v[124:125], v[122:123], v[138:141]
    v_mul_f32 v158, v134, v158
    v_mul_f32 v159, v134, v159
    v_cvt_pk_bf16_f32 v186, v158, v159
    v_mul_f32 v160, v134, v160
    v_mfma_f32_16x16x32_bf16 v[154:157], v[28:31], v[36:39], 0
    v_exp_f32 v126, v126
    v_mfma_f32_16x16x32_bf16 v[154:157], v[28:31], v[230:233], v[154:157]
    v_exp_f32 v127, v127
    v_mfma_f32_16x16x32_bf16 v[194:197], v[226:229], v[36:39], 0
    v_cvt_pk_bf16_f32 v170, v126, v127
    v_mul_f32 v161, v134, v161
    v_mfma_f32_16x16x32_bf16 v[194:197], v[174:177], v[230:233], v[194:197]
    v_exp_f32 v128, v128
    v_mfma_f32_16x16x32_bf16 v[122:125], v[210:213], v[36:39], 0
    v_exp_f32 v129, v129
    v_mfma_f32_16x16x32_bf16 v[122:125], v[182:185], v[230:233], v[122:125]
    v_cvt_pk_bf16_f32 v171, v128, v129
    v_cvt_pk_bf16_f32 v187, v160, v161
    v_mfma_f32_16x16x32_bf16 v[126:129], v[166:169], v[36:39], 0
    ds_write_b64 v3, v[186:187] offset:0
    v_mfma_f32_16x16x32_bf16 v[126:129], v[114:117], v[230:233], v[126:129]
    v_exp_f32 v118, v118
    v_mfma_f32_16x16x32_bf16 v[142:145], a[224:227], v[146:149], v[142:145]
    v_exp_f32 v119, v119
    v_mfma_f32_16x16x32_bf16 v[142:145], a[228:231], v[242:245], v[142:145]
    v_cvt_pk_bf16_f32 v172, v118, v119
    v_cvt_pk_bf16_f32 v39, v130, 0
    v_mfma_f32_16x16x32_bf16 v[142:145], a[232:235], v[206:209], v[142:145]
    v_exp_f32 v120, v120
    v_mfma_f32_16x16x32_bf16 v[142:145], a[236:239], v[246:249], v[142:145]
    v_exp_f32 v121, v121
    v_mfma_f32_16x16x32_bf16 v[158:161], a[240:243], v[198:201], 0
    v_cvt_pk_bf16_f32 v173, v120, v121
    v_mul_f32 v162, v134, v162
    v_mfma_f32_16x16x32_bf16 v[158:161], a[244:247], v[222:225], v[158:161]
    v_exp_f32 v138, v138
    v_mfma_f32_16x16x32_bf16 v[158:161], a[248:251], v[146:149], v[158:161]
    v_exp_f32 v139, v139
    v_mfma_f32_16x16x32_bf16 v[158:161], a[252:255], v[242:245], v[158:161]
    ds_read_b128 v[118:121], v2 offset:12288
    v_cvt_pk_bf16_f32 v36, v138, v139
    v_mfma_f32_16x16x32_bf16 v[158:161], v[82:85], v[206:209], v[158:161]
    ds_read_b128 v[130:133], v2 offset:13312
    v_fma_f32 v255, v142, v142, s33
    v_mfma_f32_16x16x32_bf16 v[158:161], v[86:89], v[246:249], v[158:161]
    ds_read_b128 v[218:221], v2 offset:14336
    v_fmac_f32 v255, v143, v143
    v_mfma_f32_16x16x32_bf16 v[178:181], v[90:93], v[198:201], 0
    ds_read_b128 v[198:201], v2 offset:15360
    v_fmac_f32 v255, v144, v144
    v_mfma_f32_16x16x32_bf16 v[178:181], v[94:97], v[222:225], v[178:181]
    ds_read_b128 v[222:225], v2 offset:16384
    v_fmac_f32 v255, v145, v145
    v_mfma_f32_16x16x32_bf16 v[178:181], v[98:101], v[146:149], v[178:181]
    ds_read_b128 v[230:233], v2 offset:17408
    v_fmac_f32 v255, v158, v158
    v_mfma_f32_16x16x32_bf16 v[178:181], v[102:105], v[242:245], v[178:181]
    v_exp_f32 v140, v140
    v_mfma_f32_16x16x32_bf16 v[178:181], v[106:109], v[206:209], v[178:181]
    v_exp_f32 v141, v141
    v_mfma_f32_16x16x32_bf16 v[178:181], v[110:113], v[246:249], v[178:181]
    s_waitcnt lgkmcnt(5)
    v_cvt_pk_bf16_f32 v37, v140, v141
    v_fmac_f32 v255, v159, v159
    v_mfma_f32_16x16x32_bf16 v[146:149], a[216:219], v[118:121], 0
    s_waitcnt lgkmcnt(4)
    v_fmac_f32 v255, v160, v160
    v_fmac_f32 v255, v161, v161
    v_mfma_f32_16x16x32_bf16 v[242:245], v[28:31], v[36:39], 0
    s_waitcnt lgkmcnt(3)
    v_fmac_f32 v255, v178, v178
    v_fmac_f32 v255, v179, v179
    v_mfma_f32_16x16x32_bf16 v[242:245], v[28:31], v[170:173], v[242:245]
    s_waitcnt lgkmcnt(2)
    v_fmac_f32 v255, v180, v180
    v_fmac_f32 v255, v181, v181
    v_mfma_f32_16x16x32_bf16 v[206:209], v[226:229], v[36:39], 0
    s_waitcnt lgkmcnt(1)
    v_cvt_pk_bf16_f32 v254, v254, v255
    v_mul_f32 v163, v134, v163
    v_mfma_f32_16x16x32_bf16 v[206:209], v[174:177], v[170:173], v[206:209]
    s_waitcnt lgkmcnt(0)
    v_cvt_pk_bf16_f32 v188, v162, v163
    v_mul_f32 v164, v134, v164
    v_mfma_f32_16x16x32_bf16 v[174:177], v[210:213], v[36:39], 0
    v_mul_f32 v165, v134, v165
    v_cvt_pk_bf16_f32 v189, v164, v165
    v_mfma_f32_16x16x32_bf16 v[174:177], v[182:185], v[170:173], v[174:177]
    ds_write_b64 v3, v[188:189] offset:8
    v_mfma_f32_16x16x32_bf16 v[182:185], v[166:169], v[36:39], 0
    v_mul_f32 v234, v134, v234
    v_mul_f32 v235, v134, v235
    v_mfma_f32_16x16x32_bf16 v[182:185], v[114:117], v[170:173], v[182:185]
    v_cvt_pk_bf16_f32 v234, v234, v235
    v_mul_f32 v236, v134, v236
    v_mfma_f32_16x16x32_bf16 v[146:149], a[220:223], v[130:133], v[146:149]
    v_mul_f32 v237, v134, v237
    v_cvt_pk_bf16_f32 v235, v236, v237
    v_mfma_f32_16x16x32_bf16 v[146:149], a[224:227], v[218:221], v[146:149]
    ds_write_b64 v4, v[234:235] offset:4096
    v_mfma_f32_16x16x32_bf16 v[146:149], a[228:231], v[198:201], v[146:149]
    v_rcp_f32 v154, v154
    v_mfma_f32_16x16x32_bf16 v[146:149], a[232:235], v[222:225], v[146:149]
    v_mul_f32 v194, v154, v194
    v_mul_f32 v195, v154, v195
    v_mfma_f32_16x16x32_bf16 v[146:149], a[236:239], v[230:233], v[146:149]
    v_cvt_pk_bf16_f32 v194, v194, v195
    v_mul_f32 v196, v154, v196
    v_mfma_f32_16x16x32_bf16 v[138:141], a[240:243], v[118:121], 0
    v_mul_f32 v197, v154, v197
    v_cvt_pk_bf16_f32 v195, v196, v197
    v_mfma_f32_16x16x32_bf16 v[138:141], a[244:247], v[130:133], v[138:141]
    ds_write_b64 v3, v[194:195] offset:6144
    v_mfma_f32_16x16x32_bf16 v[138:141], a[248:251], v[218:221], v[138:141]
    v_fma_f32 v255, v146, v146, s33
    v_fmac_f32 v255, v147, v147
    v_mfma_f32_16x16x32_bf16 v[138:141], a[252:255], v[198:201], v[138:141]
    ds_read_b128 v[170:173], v0 offset:20480
    v_fmac_f32 v255, v148, v148
    v_mfma_f32_16x16x32_bf16 v[138:141], v[82:85], v[222:225], v[138:141]
    ds_read_b128 v[166:169], v1 offset:20480
    v_fmac_f32 v255, v149, v149
    v_mfma_f32_16x16x32_bf16 v[138:141], v[86:89], v[230:233], v[138:141]
    ds_read_b128 v[162:165], v0 offset:20608
    v_mul_f32 v122, v154, v122
    v_mfma_f32_16x16x32_bf16 v[186:189], v[90:93], v[118:121], 0
    ds_read_b128 v[210:213], v1 offset:20608
    v_mul_f32 v123, v154, v123
    v_mfma_f32_16x16x32_bf16 v[186:189], v[94:97], v[130:133], v[186:189]
    ds_read_b128 v[226:229], v0 offset:20736
    v_cvt_pk_bf16_f32 v196, v122, v123
    v_mfma_f32_16x16x32_bf16 v[186:189], v[98:101], v[218:221], v[186:189]
    ds_read_b128 v[218:221], v1 offset:20736
    v_fmac_f32 v255, v138, v138
    v_mfma_f32_16x16x32_bf16 v[186:189], v[102:105], v[198:201], v[186:189]
    v_fmac_f32 v255, v139, v139
    v_fmac_f32 v255, v140, v140
    v_mfma_f32_16x16x32_bf16 v[186:189], v[106:109], v[222:225], v[186:189]
    v_fmac_f32 v255, v141, v141
    v_mul_f32 v124, v154, v124
    v_mfma_f32_16x16x32_bf16 v[186:189], v[110:113], v[230:233], v[186:189]
    s_waitcnt lgkmcnt(5)
    v_mul_f32 v125, v154, v125
    v_cvt_pk_bf16_f32 v197, v124, v125
    v_mfma_f32_16x16x32_bf16 v[118:121], a[72:75], v[170:173], 0
    s_waitcnt lgkmcnt(4)
    ds_write_b64 v3, v[196:197] offset:6152
    v_mfma_f32_16x16x32_bf16 v[118:121], a[76:79], v[166:169], v[118:121]
    s_waitcnt lgkmcnt(4)
    v_fmac_f32 v255, v186, v186
    v_fmac_f32 v255, v187, v187
    v_mfma_f32_16x16x32_bf16 v[118:121], a[80:83], v[162:165], v[118:121]
    s_waitcnt lgkmcnt(3)
    v_fmac_f32 v255, v188, v188
    v_fmac_f32 v255, v189, v189
    v_mfma_f32_16x16x32_bf16 v[118:121], a[84:87], v[210:213], v[118:121]
    s_waitcnt lgkmcnt(2)
    v_cvt_pk_bf16_f32 v255, v255, v255
    v_mul_f32 v126, v154, v126
    v_mfma_f32_16x16x32_bf16 v[118:121], a[88:91], v[226:229], v[118:121]
    s_waitcnt lgkmcnt(1)
    ds_write_b64 v4, v[254:255] offset:18432
    v_mfma_f32_16x16x32_bf16 v[118:121], a[92:95], v[218:221], v[118:121]
    v_mul_f32 v127, v154, v127
    v_cvt_pk_bf16_f32 v254, v126, v127
    v_mfma_f32_16x16x32_bf16 v[194:197], a[96:99], v[170:173], 0
    v_mul_f32 v128, v154, v128
    v_mul_f32 v129, v154, v129
    v_mfma_f32_16x16x32_bf16 v[194:197], a[100:103], v[166:169], v[194:197]
    v_cvt_pk_bf16_f32 v255, v128, v129
    v_xor_b32 v2, 65536, v2
    v_mfma_f32_16x16x32_bf16 v[194:197], a[104:107], v[162:165], v[194:197]
    ds_write_b64 v4, v[254:255] offset:10240
    v_mfma_f32_16x16x32_bf16 v[194:197], a[108:111], v[210:213], v[194:197]
    v_cvt_pk_f16_f32 v118, v118, v119
    v_pk_mul_f16 v223, v118, v118
    v_mfma_f32_16x16x32_bf16 v[194:197], a[112:115], v[226:229], v[194:197]
    v_cvt_pk_f16_f32 v119, v120, v121
    v_pk_mul_f16 v225, v119, v119
    v_mfma_f32_16x16x32_bf16 v[194:197], a[116:119], v[218:221], v[194:197]
    v_rcp_f32 v242, v242
    v_mfma_f32_16x16x32_bf16 v[114:117], a[120:123], v[170:173], 0
    v_mul_f32 v206, v242, v206
    v_mul_f32 v207, v242, v207
    v_mfma_f32_16x16x32_bf16 v[114:117], a[124:127], v[166:169], v[114:117]
    v_cvt_pk_bf16_f32 v206, v206, v207
    v_mul_f32 v208, v242, v208
    v_mfma_f32_16x16x32_bf16 v[114:117], a[128:131], v[162:165], v[114:117]
    v_cvt_pk_f16_f32 v120, v194, v195
    v_pk_fma_f16 v223, v120, v120, v223
    v_mfma_f32_16x16x32_bf16 v[114:117], a[132:135], v[210:213], v[114:117]
    v_cvt_pk_f16_f32 v121, v196, v197
    v_pk_fma_f16 v225, v121, v121, v225
    v_mfma_f32_16x16x32_bf16 v[114:117], a[136:139], v[226:229], v[114:117]
    v_mul_f32 v209, v242, v209
    v_cvt_pk_bf16_f32 v207, v208, v209
    v_mfma_f32_16x16x32_bf16 v[114:117], a[140:143], v[218:221], v[114:117]
    ds_write_b64 v3, v[206:207] offset:12288
    v_mfma_f32_16x16x32_bf16 v[154:157], a[0:3], v[170:173], 0
    v_mul_f32 v174, v242, v174
    v_mul_f32 v175, v242, v175
    v_mfma_f32_16x16x32_bf16 v[154:157], a[4:7], v[166:169], v[154:157]
    v_cvt_pk_bf16_f32 v208, v174, v175
    v_mul_f32 v176, v242, v176
    v_mfma_f32_16x16x32_bf16 v[154:157], a[8:11], v[162:165], v[154:157]
    v_cvt_pk_f16_f32 v196, v114, v115
    v_pk_fma_f16 v223, v196, v196, v223
    v_mfma_f32_16x16x32_bf16 v[154:157], a[12:15], v[210:213], v[154:157]
    v_cvt_pk_f16_f32 v197, v116, v117
    v_pk_fma_f16 v225, v197, v197, v225
    v_mfma_f32_16x16x32_bf16 v[154:157], a[16:19], v[226:229], v[154:157]
    v_mul_f32 v177, v242, v177
    v_cvt_pk_bf16_f32 v209, v176, v177
    v_mfma_f32_16x16x32_bf16 v[154:157], a[20:23], v[218:221], v[154:157]
    ds_write_b64 v3, v[208:209] offset:12296
    v_mfma_f32_16x16x32_bf16 v[174:177], a[24:27], v[170:173], 0
    v_mul_f32 v182, v242, v182
    v_mul_f32 v183, v242, v183
    v_mfma_f32_16x16x32_bf16 v[174:177], a[28:31], v[166:169], v[174:177]
    v_cvt_pk_bf16_f32 v194, v182, v183
    v_mul_f32 v184, v242, v184
    v_mfma_f32_16x16x32_bf16 v[174:177], a[32:35], v[162:165], v[174:177]
    v_cvt_pk_f16_f32 v206, v154, v155
    v_mul_f32 v185, v242, v185
    v_mfma_f32_16x16x32_bf16 v[174:177], a[36:39], v[210:213], v[174:177]
    v_cvt_pk_bf16_f32 v195, v184, v185
    v_xor_b32 v3, 65536, v3
    v_mfma_f32_16x16x32_bf16 v[174:177], a[40:43], v[226:229], v[174:177]
    ds_write_b64 v4, v[194:195] offset:16384
    v_mfma_f32_16x16x32_bf16 v[174:177], a[44:47], v[218:221], v[174:177]
    v_xor_b32 v4, 65536, v4
    v_mfma_f32_16x16x32_bf16 v[182:185], a[48:51], v[170:173], 0
    v_mfma_f32_16x16x32_bf16 v[182:185], a[52:55], v[166:169], v[182:185]
    v_mfma_f32_16x16x32_bf16 v[182:185], a[56:59], v[162:165], v[182:185]
    v_mfma_f32_16x16x32_bf16 v[182:185], a[60:63], v[210:213], v[182:185]
    v_mfma_f32_16x16x32_bf16 v[182:185], a[64:67], v[226:229], v[182:185]
    v_mfma_f32_16x16x32_bf16 v[182:185], a[68:71], v[218:221], v[182:185]
    v_mfma_f32_16x16x32_bf16 v[230:233], v[170:173], a[144:147], 0
    s_waitcnt lgkmcnt(0)
    v_mfma_f32_16x16x32_bf16 v[230:233], v[166:169], a[148:151], v[230:233]
    s_barrier
    v_mfma_f32_16x16x32_bf16 v[230:233], v[162:165], a[152:155], v[230:233]
    s_nop 0
    v_mfma_f32_16x16x32_bf16 v[230:233], v[210:213], a[156:159], v[230:233]
    s_nop 0
    v_mfma_f32_16x16x32_bf16 v[230:233], v[226:229], a[160:163], v[230:233]
    s_nop 0
    v_mfma_f32_16x16x32_bf16 v[230:233], v[218:221], a[164:167], v[230:233]
    s_cbranch_scc1 L_loop_fast0
    s_branch L_final_fast
.p2align 6
L_loop_fast1:
    v_mfma_f32_16x16x32_bf16 v[234:237], v[170:173], a[168:171], 0
    s_add_u32 s12, s42, s27
    ds_read_b128 v[242:245], v2 offset:18432
    ds_read_b128 v[246:249], v2 offset:19456
    v_mfma_f32_16x16x32_bf16 v[234:237], v[166:169], a[172:175], v[234:237]
    s_addc_u32 s13, s43, 0
    v_pk_mul_f16 v222, v206, v206
    v_cvt_pk_f16_f32 v207, v156, v157
    v_mfma_f32_16x16x32_bf16 v[234:237], v[162:165], a[176:179], v[234:237]
    s_sub_u32 s14, s36, s27
    v_pk_mul_f16 v224, v207, v207
    v_cvt_pk_f16_f32 v208, v174, v175
    v_mfma_f32_16x16x32_bf16 v[234:237], v[210:213], a[180:183], v[234:237]
    s_cmp_ge_u32 s18, 2
    ds_read_b128 v[134:137], v0 offset:26624
    v_pk_fma_f16 v222, v208, v208, v222
    v_mfma_f32_16x16x32_bf16 v[234:237], v[226:229], a[184:187], v[234:237]
    s_cselect_b32 s14, s14, 0
    ds_read_b128 v[154:157], v1 offset:26624
    v_cvt_pk_f16_f32 v209, v176, v177
    v_mfma_f32_16x16x32_bf16 v[234:237], v[218:221], a[188:191], v[234:237]
    s_add_u32 s34, s18, 2
    ds_read_b128 v[130:133], v0 offset:26752
    v_pk_fma_f16 v224, v209, v209, v224
    v_mfma_f32_16x16x32_bf16 v[114:117], v[170:173], a[192:195], 0
    s_add_u32 s8, s40, s23
    ds_read_b128 v[122:125], v1 offset:26752
    v_cvt_pk_f16_f32 v194, v182, v183
    v_mfma_f32_16x16x32_bf16 v[114:117], v[166:169], a[196:199], v[114:117]
    s_addc_u32 s9, s41, 0
    ds_read_b128 v[126:129], v0 offset:26880
    v_pk_fma_f16 v222, v194, v194, v222
    v_mfma_f32_16x16x32_bf16 v[114:117], v[162:165], a[200:203], v[114:117]
    s_waitcnt lgkmcnt(5)
    ds_read_b128 v[166:169], v1 offset:26880
    v_cvt_pk_f16_f32 v195, v184, v185
    v_mfma_f32_16x16x32_bf16 v[198:201], v[32:35], v[242:245], 0
    s_sub_u32 s10, s36, s23
    v_pk_fma_f16 v224, v195, v195, v224
    v_cvt_pk_bf16_f32 v174, v230, v231
    v_mfma_f32_16x16x32_bf16 v[198:201], v[32:35], v[246:249], v[198:201]
    s_cmp_lt_u32 s34, s17
    v_cvt_pk_bf16_f32 v175, v232, v233
    v_cvt_pk_bf16_f32 v182, v234, v235
    v_mfma_f32_16x16x32_f16 v[170:173], v[40:43], v[222:225], 0
    s_waitcnt lgkmcnt(5)
    v_cvt_pk_bf16_f32 v183, v236, v237
    s_cselect_b32 s10, s10, 0
    v_mfma_f32_16x16x32_bf16 v[114:117], v[210:213], a[204:207], v[114:117]
    s_add_u32 m0, s28, 0
    v_mul_f32 v255, 0x3baaaaab, v198
    v_mul_f32 v254, 0x3baaaaab, v199
    v_mfma_f32_16x16x32_bf16 v[114:117], v[226:229], a[208:211], v[114:117]
    s_mov_b32 s27, s26
    v_rsq_f32 v172, v170
    v_mfma_f32_16x16x32_bf16 v[114:117], v[218:221], a[212:215], v[114:117]
    s_mov_b32 s26, s25
    v_rsq_f32 v173, v171
    v_mfma_f32_16x16x32_bf16 v[162:165], a[72:75], v[134:137], 0
    s_waitcnt lgkmcnt(1)
    v_mul_f32 v172, s31, v172
    v_cvt_pk_f16_f32 v172, v172, v173
    v_mfma_f32_16x16x32_bf16 v[162:165], a[76:79], v[154:157], v[162:165]
    s_mov_b32 s25, s24
    v_cvt_pk_bf16_f32 v114, v114, v115
    v_cvt_pk_bf16_f32 v115, v116, v117
    v_mfma_f32_16x16x32_bf16 v[162:165], a[80:83], v[130:133], v[162:165]
    s_mov_b32 s24, s23
    v_pk_mul_f16 v118, v118, v172 op_sel:[0,1] op_sel_hi:[1,1]
    v_pk_mul_f16 v119, v119, v172 op_sel:[0,1] op_sel_hi:[1,1]
    v_mfma_f32_16x16x32_bf16 v[162:165], a[84:87], v[122:125], v[162:165]
    s_waitcnt lgkmcnt(0)
    v_pk_mul_f16 v120, v120, v172 op_sel:[0,1] op_sel_hi:[1,1]
    v_pk_mul_f16 v121, v121, v172 op_sel:[0,1] op_sel_hi:[1,1]
    v_mfma_f32_16x16x32_bf16 v[162:165], a[88:91], v[126:129], v[162:165]
    v_pk_mul_f16 v196, v196, v172 op_sel:[0,1] op_sel_hi:[1,1]
    v_pk_mul_f16 v197, v197, v172 op_sel:[0,1] op_sel_hi:[1,1]
    v_mfma_f32_16x16x32_bf16 v[162:165], a[92:95], v[166:169], v[162:165]
    v_pk_mul_f16 v206, v206, v172 op_sel:[0,0] op_sel_hi:[1,0]
    v_pk_mul_f16 v207, v207, v172 op_sel:[0,0] op_sel_hi:[1,0]
    v_mfma_f32_16x16x32_bf16 v[210:213], a[96:99], v[134:137], 0
    v_pk_mul_f16 v208, v208, v172 op_sel:[0,0] op_sel_hi:[1,0]
    v_pk_mul_f16 v209, v209, v172 op_sel:[0,0] op_sel_hi:[1,0]
    v_mfma_f32_16x16x32_bf16 v[210:213], a[100:103], v[154:157], v[210:213]
    v_pk_mul_f16 v194, v194, v172 op_sel:[0,0] op_sel_hi:[1,0]
    v_pk_mul_f16 v195, v195, v172 op_sel:[0,0] op_sel_hi:[1,0]
    v_mfma_f32_16x16x32_bf16 v[210:213], a[104:107], v[130:133], v[210:213]
    v_min3_u32 v44, v44, v170, v171
    v_max3_u32 v45, v45, v170, v171
    v_mfma_f32_16x16x32_bf16 v[210:213], a[108:111], v[122:125], v[210:213]
    v_cvt_pk_f16_f32 v170, v162, v163
    v_pk_mul_f16 v163, v170, v170
    v_mfma_f32_16x16x32_bf16 v[210:213], a[112:115], v[126:129], v[210:213]
    v_cvt_pk_f16_f32 v171, v164, v165
    v_pk_mul_f16 v165, v171, v171
    v_mfma_f32_16x16x32_bf16 v[210:213], a[116:119], v[166:169], v[210:213]
    v_rsq_f32 v255, v255
    v_mfma_f32_16x16x32_bf16 v[214:217], a[120:123], v[134:137], 0
    v_rsq_f32 v254, v254
    v_mfma_f32_16x16x32_bf16 v[214:217], a[124:127], v[154:157], v[214:217]
    v_mul_f32 v142, v254, v142
    v_mul_f32 v143, v254, v143
    v_mfma_f32_16x16x32_bf16 v[214:217], a[128:131], v[130:133], v[214:217]
    v_cvt_pk_bf16_f32 v142, v142, v143
    v_cvt_pk_f16_f32 v172, v210, v211
    v_mfma_f32_16x16x32_bf16 v[214:217], a[132:135], v[122:125], v[214:217]
    v_pk_fma_f16 v163, v172, v172, v163
    v_cvt_pk_f16_f32 v173, v212, v213
    v_mfma_f32_16x16x32_bf16 v[214:217], a[136:139], v[126:129], v[214:217]
    v_pk_fma_f16 v165, v173, v173, v165
    v_mul_f32 v144, v254, v144
    v_mfma_f32_16x16x32_bf16 v[214:217], a[140:143], v[166:169], v[214:217]
    v_mul_f32 v145, v254, v145
    v_cvt_pk_bf16_f32 v143, v144, v145
    v_mfma_f32_16x16x32_bf16 v[210:213], a[0:3], v[134:137], 0
    v_mul_f32 v158, v254, v158
    v_mul_f32 v159, v254, v159
    v_mfma_f32_16x16x32_bf16 v[210:213], a[4:7], v[154:157], v[210:213]
    v_cvt_pk_bf16_f32 v144, v158, v159
    v_mul_f32 v160, v254, v160
    v_mfma_f32_16x16x32_bf16 v[210:213], a[8:11], v[130:133], v[210:213]
    v_cvt_pk_f16_f32 v220, v214, v215
    v_pk_fma_f16 v163, v220, v220, v163
    v_mfma_f32_16x16x32_bf16 v[210:213], a[12:15], v[122:125], v[210:213]
    v_cvt_pk_f16_f32 v221, v216, v217
    v_pk_fma_f16 v165, v221, v221, v165
    v_mfma_f32_16x16x32_bf16 v[210:213], a[16:19], v[126:129], v[210:213]
    v_mul_f32 v161, v254, v161
    v_cvt_pk_bf16_f32 v145, v160, v161
    v_mfma_f32_16x16x32_bf16 v[210:213], a[20:23], v[166:169], v[210:213]
    buffer_store_dwordx4 v[142:145], v16, s[12:15], 0 offen nt
    v_mul_f32 v178, v254, v178
    v_mul_f32 v179, v254, v179
    v_cvt_pk_bf16_f32 v116, v178, v179
    v_mul_f32 v180, v254, v180
    v_mfma_f32_16x16x32_bf16 v[142:145], a[24:27], v[134:137], 0
    v_mul_f32 v181, v254, v181
    v_cvt_pk_bf16_f32 v117, v180, v181
    v_mfma_f32_16x16x32_bf16 v[142:145], a[28:31], v[154:157], v[142:145]
    v_cvt_pk_f16_f32 v158, v210, v211
    v_pk_mul_f16 v162, v158, v158
    v_mfma_f32_16x16x32_bf16 v[142:145], a[32:35], v[130:133], v[142:145]
    v_cvt_pk_f16_f32 v159, v212, v213
    v_pk_mul_f16 v164, v159, v159
    v_mfma_f32_16x16x32_bf16 v[142:145], a[36:39], v[122:125], v[142:145]
    v_mul_f32 v254, 0x3baaaaab, v200
    v_mul_f32 v150, v255, v150
    v_mfma_f32_16x16x32_bf16 v[142:145], a[40:43], v[126:129], v[142:145]
    v_rsq_f32 v254, v254
    v_mfma_f32_16x16x32_bf16 v[142:145], a[44:47], v[166:169], v[142:145]
    v_mul_f32 v151, v255, v151
    v_cvt_pk_bf16_f32 v150, v150, v151
    v_mfma_f32_16x16x32_bf16 v[178:181], a[48:51], v[134:137], 0
    v_mul_f32 v152, v255, v152
    v_mul_f32 v153, v255, v153
    v_mfma_f32_16x16x32_bf16 v[178:181], a[52:55], v[154:157], v[178:181]
    v_cvt_pk_bf16_f32 v151, v152, v153
    v_mul_f32 v190, v255, v190
    v_mfma_f32_16x16x32_bf16 v[178:181], a[56:59], v[130:133], v[178:181]
    v_cvt_pk_f16_f32 v160, v142, v143
    v_pk_fma_f16 v162, v160, v160, v162
    v_mfma_f32_16x16x32_bf16 v[178:181], a[60:63], v[122:125], v[178:181]
    v_cvt_pk_f16_f32 v161, v144, v145
    v_pk_fma_f16 v164, v161, v161, v164
    v_mfma_f32_16x16x32_bf16 v[178:181], a[64:67], v[126:129], v[178:181]
    v_mul_f32 v191, v255, v191
    v_cvt_pk_bf16_f32 v152, v190, v191
    v_mfma_f32_16x16x32_bf16 v[178:181], a[68:71], v[166:169], v[178:181]
    v_mul_f32 v192, v255, v192
    v_mul_f32 v193, v255, v193
    v_mfma_f32_16x16x32_bf16 v[142:145], v[134:137], a[144:147], 0
    v_cvt_pk_bf16_f32 v153, v192, v193
    v_mul_f32 v202, v255, v202
    v_mfma_f32_16x16x32_bf16 v[142:145], v[154:157], a[148:151], v[142:145]
    v_mul_f32 v203, v255, v203
    v_cvt_pk_bf16_f32 v202, v202, v203
    v_mfma_f32_16x16x32_bf16 v[142:145], v[130:133], a[152:155], v[142:145]
    v_cvt_pk_f16_f32 v218, v178, v179
    v_pk_fma_f16 v162, v218, v218, v162
    v_mfma_f32_16x16x32_bf16 v[142:145], v[122:125], a[156:159], v[142:145]
    v_cvt_pk_f16_f32 v219, v180, v181
    v_pk_fma_f16 v164, v219, v219, v164
    v_mfma_f32_16x16x32_bf16 v[142:145], v[126:129], a[160:163], v[142:145]
    buffer_store_dwordx2 v[116:117], v19, s[12:15], 0 offen nt
    v_mul_f32 v204, v255, v204
    v_mul_f32 v205, v255, v205
    v_mfma_f32_16x16x32_f16 v[190:193], v[40:43], v[162:165], 0
    v_cvt_pk_bf16_f32 v203, v204, v205
    v_mul_f32 v146, v254, v146
    v_mfma_f32_16x16x32_bf16 v[142:145], v[166:169], a[164:167], v[142:145]
    v_mul_f32 v147, v254, v147
    v_cvt_pk_bf16_f32 v146, v146, v147
    v_mfma_f32_16x16x32_bf16 v[178:181], v[134:137], a[168:171], 0
    v_mul_f32 v148, v254, v148
    v_mul_f32 v149, v254, v149
    v_mfma_f32_16x16x32_bf16 v[178:181], v[154:157], a[172:175], v[178:181]
    v_rsq_f32 v192, v190
    v_mfma_f32_16x16x32_bf16 v[178:181], v[130:133], a[176:179], v[178:181]
    v_cvt_pk_bf16_f32 v176, v142, v143
    v_cvt_pk_bf16_f32 v177, v144, v145
    v_mfma_f32_16x16x32_bf16 v[178:181], v[122:125], a[180:183], v[178:181]
    ds_read_b128 v[142:145], v0 offset:32768
    v_mul_f32 v192, s31, v192
    v_mfma_f32_16x16x32_bf16 v[178:181], v[126:129], a[184:187], v[178:181]
    ds_read_b128 v[162:165], v1 offset:32768
    v_min3_u32 v44, v44, v190, v191
    v_mfma_f32_16x16x32_bf16 v[178:181], v[166:169], a[188:191], v[178:181]
    ds_read_b128 v[210:213], v0 offset:32896
    v_max3_u32 v45, v45, v190, v191
    v_mfma_f32_16x16x32_bf16 v[198:201], v[134:137], a[192:195], 0
    ds_read_b128 v[134:137], v1 offset:32896
    v_cvt_pk_bf16_f32 v147, v148, v149
    v_mfma_f32_16x16x32_bf16 v[198:201], v[154:157], a[196:199], v[198:201]
    ds_read_b128 v[154:157], v0 offset:33024
    v_mul_f32 v138, v254, v138
    v_mfma_f32_16x16x32_bf16 v[198:201], v[130:133], a[200:203], v[198:201]
    ds_read_b128 v[130:133], v1 offset:33024
    v_cvt_pk_bf16_f32 v184, v178, v179
    v_mfma_f32_16x16x32_bf16 v[198:201], v[122:125], a[204:207], v[198:201]
    v_rsq_f32 v193, v191
    v_mfma_f32_16x16x32_bf16 v[198:201], v[126:129], a[208:211], v[198:201]
    v_cvt_pk_f16_f32 v192, v192, v193
    v_cvt_pk_bf16_f32 v185, v180, v181
    v_mfma_f32_16x16x32_bf16 v[198:201], v[166:169], a[212:215], v[198:201]
    s_waitcnt lgkmcnt(5)
    v_pk_mul_f16 v170, v170, v192 op_sel:[0,1] op_sel_hi:[1,1]
    v_pk_mul_f16 v171, v171, v192 op_sel:[0,1] op_sel_hi:[1,1]
    v_mfma_f32_16x16x32_bf16 v[178:181], a[72:75], v[142:145], 0
    s_waitcnt lgkmcnt(4)
    v_pk_mul_f16 v172, v172, v192 op_sel:[0,1] op_sel_hi:[1,1]
    v_pk_mul_f16 v173, v173, v192 op_sel:[0,1] op_sel_hi:[1,1]
    v_mfma_f32_16x16x32_bf16 v[178:181], a[76:79], v[162:165], v[178:181]
    s_waitcnt lgkmcnt(3)
    v_cvt_pk_bf16_f32 v116, v198, v199
    v_cvt_pk_bf16_f32 v117, v200, v201
    v_mfma_f32_16x16x32_bf16 v[178:181], a[80:83], v[210:213], v[178:181]
    s_waitcnt lgkmcnt(2)
    buffer_store_dwordx4 v[150:153], v15, s[12:15], 0 offen nt
    v_pk_mul_f16 v220, v220, v192 op_sel:[0,1] op_sel_hi:[1,1]
    v_pk_mul_f16 v221, v221, v192 op_sel:[0,1] op_sel_hi:[1,1]
    v_pk_mul_f16 v158, v158, v192 op_sel:[0,0] op_sel_hi:[1,0]
    v_pk_mul_f16 v159, v159, v192 op_sel:[0,0] op_sel_hi:[1,0]
    v_mfma_f32_16x16x32_bf16 v[178:181], a[84:87], v[134:137], v[178:181]
    s_waitcnt lgkmcnt(0)
    v_pk_mul_f16 v160, v160, v192 op_sel:[0,0] op_sel_hi:[1,0]
    v_pk_mul_f16 v161, v161, v192 op_sel:[0,0] op_sel_hi:[1,0]
    v_mfma_f32_16x16x32_bf16 v[178:181], a[88:91], v[154:157], v[178:181]
    v_pk_mul_f16 v218, v218, v192 op_sel:[0,0] op_sel_hi:[1,0]
    v_pk_mul_f16 v219, v219, v192 op_sel:[0,0] op_sel_hi:[1,0]
    v_mfma_f32_16x16x32_bf16 v[178:181], a[92:95], v[130:133], v[178:181]
    v_mul_f32 v139, v254, v139
    v_cvt_pk_bf16_f32 v148, v138, v139
    v_mfma_f32_16x16x32_bf16 v[150:153], a[96:99], v[142:145], 0
    v_mul_f32 v140, v254, v140
    v_mul_f32 v141, v254, v141
    v_mfma_f32_16x16x32_bf16 v[150:153], a[100:103], v[162:165], v[150:153]
    v_cvt_pk_bf16_f32 v149, v140, v141
    v_mul_f32 v186, v254, v186
    v_mfma_f32_16x16x32_bf16 v[150:153], a[104:107], v[210:213], v[150:153]
    v_cvt_pk_f16_f32 v178, v178, v179
    v_pk_mul_f16 v191, v178, v178
    v_mfma_f32_16x16x32_bf16 v[150:153], a[108:111], v[134:137], v[150:153]
    v_cvt_pk_f16_f32 v179, v180, v181
    v_pk_mul_f16 v193, v179, v179
    v_mfma_f32_16x16x32_bf16 v[150:153], a[112:115], v[154:157], v[150:153]
    v_mul_f32 v187, v254, v187
    v_cvt_pk_bf16_f32 v204, v186, v187
    v_mfma_f32_16x16x32_bf16 v[150:153], a[116:119], v[130:133], v[150:153]
    v_mul_f32 v188, v254, v188
    v_mul_f32 v189, v254, v189
    v_mfma_f32_16x16x32_bf16 v[138:141], a[120:123], v[142:145], 0
    s_waitcnt vmcnt(3)
    v_cvt_pk_bf16_f32 v205, v188, v189
    v_xor_b32 v0, 65536, v0
    v_mfma_f32_16x16x32_bf16 v[138:141], a[124:127], v[162:165], v[138:141]
    v_mfma_f32_16x16x32_bf16 v[138:141], a[128:131], v[210:213], v[138:141]
    s_barrier
    v_mfma_f32_16x16x32_bf16 v[138:141], a[132:135], v[134:137], v[138:141]
    v_mfma_f32_16x16x32_bf16 v[138:141], a[136:139], v[154:157], v[138:141]
    v_mfma_f32_16x16x32_bf16 v[138:141], a[140:143], v[130:133], v[138:141]
    v_cvt_pk_f16_f32 v180, v150, v151
    v_pk_fma_f16 v191, v180, v180, v191
    v_mfma_f32_16x16x32_bf16 v[186:189], a[0:3], v[142:145], 0
    v_cvt_pk_f16_f32 v181, v152, v153
    v_pk_fma_f16 v193, v181, v181, v193
    v_mfma_f32_16x16x32_bf16 v[186:189], a[4:7], v[162:165], v[186:189]
    buffer_load_dwordx4 v10, s[8:11], 0 offen nt lds
    v_xor_b32 v1, 65536, v1
    v_mfma_f32_16x16x32_bf16 v[186:189], a[8:11], v[210:213], v[186:189]
    s_add_u32 m0, s28, 4096
    v_cvt_pk_f16_f32 v124, v138, v139
    v_pk_fma_f16 v191, v124, v124, v191
    v_mfma_f32_16x16x32_bf16 v[186:189], a[12:15], v[134:137], v[186:189]
    v_cvt_pk_f16_f32 v125, v140, v141
    v_pk_fma_f16 v193, v125, v125, v193
    v_mfma_f32_16x16x32_bf16 v[186:189], a[16:19], v[154:157], v[186:189]
    v_mfma_f32_16x16x32_bf16 v[186:189], a[20:23], v[130:133], v[186:189]
    v_mfma_f32_16x16x32_bf16 v[150:153], a[24:27], v[142:145], 0
    buffer_load_dwordx4 v11, s[8:11], 0 offen nt lds
    s_add_u32 m0, s28, 8192
    v_mfma_f32_16x16x32_bf16 v[150:153], a[28:31], v[162:165], v[150:153]
    v_mfma_f32_16x16x32_bf16 v[150:153], a[32:35], v[210:213], v[150:153]
    v_mfma_f32_16x16x32_bf16 v[150:153], a[36:39], v[134:137], v[150:153]
    v_mfma_f32_16x16x32_bf16 v[150:153], a[40:43], v[154:157], v[150:153]
    v_mfma_f32_16x16x32_bf16 v[150:153], a[44:47], v[130:133], v[150:153]
    buffer_load_dwordx4 v12, s[8:11], 0 offen nt lds
    v_cvt_pk_f16_f32 v186, v186, v187
    v_mfma_f32_16x16x32_bf16 v[138:141], a[48:51], v[142:145], 0
    s_add_u32 m0, s28, 12288
    v_pk_mul_f16 v190, v186, v186
    v_cvt_pk_f16_f32 v187, v188, v189
    v_mfma_f32_16x16x32_bf16 v[138:141], a[52:55], v[162:165], v[138:141]
    s_xor_b32 s28, s28, 65536
    ds_read_b128 v[166:169], v5 offset:0
    ds_read_b128 v[126:129], v5 offset:16
    v_mfma_f32_16x16x32_bf16 v[138:141], a[56:59], v[210:213], v[138:141]
    ds_read_b128 v[198:201], v5 offset:48
    ds_read_b32 v254, v6 offset:192
    v_mfma_f32_16x16x32_bf16 v[138:141], a[60:63], v[134:137], v[138:141]
    v_pk_mul_f16 v192, v187, v187
    v_cvt_pk_f16_f32 v188, v150, v151
    v_mfma_f32_16x16x32_bf16 v[138:141], a[64:67], v[154:157], v[138:141]
    buffer_load_dwordx4 v13, s[8:11], 0 offen nt lds
    v_pk_fma_f16 v190, v188, v188, v190
    v_mfma_f32_16x16x32_bf16 v[138:141], a[68:71], v[130:133], v[138:141]
    s_mov_b32 m0, s29
    v_cvt_pk_f16_f32 v189, v152, v153
    v_pk_fma_f16 v192, v189, v189, v192
    v_mfma_f32_16x16x32_bf16 v[150:153], v[142:145], a[144:147], 0
    s_xor_b32 s29, s29, s30
    v_add_u32 v5, 336, v5
    s_add_u32 s19, s19, s20
    v_mfma_f32_16x16x32_bf16 v[150:153], v[162:165], a[148:151], v[150:153]
    s_add_u32 s23, s23, s21
    v_cvt_pk_f16_f32 v122, v138, v139
    v_pk_fma_f16 v190, v122, v122, v190
    v_mfma_f32_16x16x32_bf16 v[150:153], v[210:213], a[152:155], v[150:153]
    s_cmp_ge_u32 s19, 72
    v_cvt_pk_f16_f32 v123, v140, v141
    v_pk_fma_f16 v192, v123, v123, v192
    v_mfma_f32_16x16x32_bf16 v[150:153], v[134:137], a[156:159], v[150:153]
    s_waitcnt lgkmcnt(2)
    buffer_store_dwordx2 v[202:203], v18, s[12:15], 0 offen nt
    s_cselect_b32 s34, 72, 0
    s_cselect_b32 s35, s22, 0
    v_mfma_f32_16x16x32_f16 v[138:141], v[40:43], v[190:193], 0
    s_sub_u32 s19, s19, s34
    s_add_u32 s23, s23, s35
    s_add_u32 s18, s18, 1
    v_mfma_f32_16x16x32_f16 v[214:217], v[166:169], v[158:161], v[24:27]
    s_cmp_lt_u32 s18, s45
    v_mfma_f32_16x16x32_f16 v[214:217], v[126:129], v[170:173], v[214:217]
    s_waitcnt lgkmcnt(0)
    v_mfma_f32_16x16x32_f16 v[214:217], v[198:201], v[218:221], v[214:217]
    v_rsq_f32 v140, v138
    v_mfma_f32_16x16x32_f16 v[190:193], v[166:169], v[206:209], v[22:25]
    v_rsq_f32 v141, v139
    v_mfma_f32_16x16x32_f16 v[190:193], v[126:129], v[118:121], v[190:193]
    v_mul_f32 v140, s31, v140
    v_cvt_pk_f16_f32 v140, v140, v141
    v_mfma_f32_16x16x32_f16 v[190:193], v[198:201], v[194:197], v[190:193]
    v_pk_mul_f16 v178, v178, v140 op_sel:[0,1] op_sel_hi:[1,1]
    v_pk_mul_f16 v179, v179, v140 op_sel:[0,1] op_sel_hi:[1,1]
    v_mfma_f32_16x16x32_bf16 v[150:153], v[154:157], a[160:163], v[150:153]
    v_pk_mul_f16 v180, v180, v140 op_sel:[0,1] op_sel_hi:[1,1]
    v_pk_mul_f16 v181, v181, v140 op_sel:[0,1] op_sel_hi:[1,1]
    v_mfma_f32_16x16x32_bf16 v[150:153], v[130:133], a[164:167], v[150:153]
    v_pk_mul_f16 v124, v124, v140 op_sel:[0,1] op_sel_hi:[1,1]
    v_pk_mul_f16 v125, v125, v140 op_sel:[0,1] op_sel_hi:[1,1]
    v_mfma_f32_16x16x32_bf16 v[222:225], v[142:145], a[168:171], 0
    v_mov_b32_dpp v254, v191 quad_perm:[0,1,2,3] row_mask:0x1 bank_mask:0xf
    v_mov_b32_dpp v254, v215 quad_perm:[0,1,2,3] row_mask:0x2 bank_mask:0xf
    v_mfma_f32_16x16x32_bf16 v[222:225], v[162:165], a[172:175], v[222:225]
    v_pk_mul_f16 v186, v186, v140 op_sel:[0,0] op_sel_hi:[1,0]
    v_pk_mul_f16 v187, v187, v140 op_sel:[0,0] op_sel_hi:[1,0]
    v_mfma_f32_16x16x32_bf16 v[222:225], v[210:213], a[176:179], v[222:225]
    v_cvt_pk_bf16_f32 v226, v150, v151
    v_cvt_pk_bf16_f32 v227, v152, v153
    v_mfma_f32_16x16x32_bf16 v[222:225], v[134:137], a[180:183], v[222:225]
    v_pk_mul_f16 v188, v188, v140 op_sel:[0,0] op_sel_hi:[1,0]
    v_pk_mul_f16 v189, v189, v140 op_sel:[0,0] op_sel_hi:[1,0]
    v_mfma_f32_16x16x32_f16 v[230:233], v[118:121], v[206:209], v[46:49]
    v_pk_mul_f16 v122, v122, v140 op_sel:[0,0] op_sel_hi:[1,0]
    v_pk_mul_f16 v123, v123, v140 op_sel:[0,0] op_sel_hi:[1,0]
    v_mfma_f32_16x16x32_f16 v[234:237], v[170:173], v[206:209], v[50:53]
    v_min3_u32 v44, v44, v138, v139
    v_max3_u32 v45, v45, v138, v139
    v_mfma_f32_16x16x32_f16 v[138:141], v[178:181], v[206:209], v[54:57]
    v_exp_f32 v214, v214
    v_mfma_f32_16x16x16_f16 v[230:233], v[196:197], v[194:195], v[230:233]
    buffer_store_dwordx4 v[146:149], v17, s[12:15], 0 offen nt
    v_exp_f32 v190, v190
    v_mfma_f32_16x16x16_f16 v[234:237], v[220:221], v[194:195], v[234:237]
    v_cvt_pk_bf16_f32 v39, v190, 0
    v_mfma_f32_16x16x16_f16 v[138:141], v[124:125], v[194:195], v[138:141]
    v_mfma_f32_16x16x32_bf16 v[222:225], v[154:157], a[184:187], v[222:225]
    v_mfma_f32_16x16x32_bf16 v[222:225], v[130:133], a[188:191], v[222:225]
    ds_read_b128 v[146:149], v2 offset:0
    v_mfma_f32_16x16x32_bf16 v[150:153], v[142:145], a[192:195], 0
    ds_read_b128 v[142:145], v2 offset:1024
    v_mfma_f32_16x16x32_bf16 v[150:153], v[162:165], a[196:199], v[150:153]
    ds_read_b128 v[206:209], v2 offset:2048
    v_mfma_f32_16x16x32_bf16 v[150:153], v[210:213], a[200:203], v[150:153]
    ds_read_b128 v[162:165], v2 offset:3072
    v_mfma_f32_16x16x32_bf16 v[150:153], v[134:137], a[204:207], v[150:153]
    ds_read_b128 v[134:137], v2 offset:4096
    v_cvt_pk_bf16_f32 v210, v222, v223
    v_mfma_f32_16x16x32_bf16 v[150:153], v[154:157], a[208:211], v[150:153]
    ds_read_b128 v[154:157], v2 offset:5120
    v_cvt_pk_bf16_f32 v211, v224, v225
    v_mfma_f32_16x16x32_bf16 v[150:153], v[130:133], a[212:215], v[150:153]
    ds_read2_b32 v[228:229], v6 offset0:0 offset1:0
    ds_read2_b32 v[212:213], v6 offset0:16 offset1:16
    v_mfma_f32_16x16x32_f16 v[130:133], v[166:169], v[186:189], v[26:29]
    ds_read2_b32 v[168:169], v6 offset0:32 offset1:32
    v_add_u32 v6, 272, v6
    v_mfma_f32_16x16x32_f16 v[130:133], v[126:129], v[178:181], v[130:133]
    s_waitcnt lgkmcnt(8)
    v_exp_f32 v230, v230
    v_mfma_f32_16x16x32_f16 v[130:133], v[198:201], v[122:125], v[130:133]
    s_waitcnt lgkmcnt(7)
    v_cvt_pk_bf16_f32 v166, v150, v151
    v_cvt_pk_bf16_f32 v167, v152, v153
    v_mfma_f32_16x16x32_bf16 v[150:153], a[216:219], v[146:149], 0
    s_waitcnt lgkmcnt(6)
    v_exp_f32 v231, v231
    v_mfma_f32_16x16x32_bf16 v[150:153], a[220:223], v[142:145], v[150:153]
    s_waitcnt lgkmcnt(5)
    v_exp_f32 v130, v130
    v_mfma_f32_16x16x32_bf16 v[150:153], a[224:227], v[206:209], v[150:153]
    s_waitcnt lgkmcnt(4)
    buffer_store_dwordx2 v[204:205], v20, s[12:15], 0 offen nt
    v_mov_b32_dpp v254, v131 quad_perm:[0,1,2,3] row_mask:0x4 bank_mask:0xf
    v_cvt_pk_bf16_f32 v126, v230, v231
    v_mfma_f32_16x16x32_bf16 v[150:153], a[228:231], v[162:165], v[150:153]
    s_waitcnt lgkmcnt(3)
    v_exp_f32 v254, v254
    v_mfma_f32_16x16x32_bf16 v[150:153], a[232:235], v[134:137], v[150:153]
    s_waitcnt lgkmcnt(1)
    v_exp_f32 v232, v232
    v_mfma_f32_16x16x32_bf16 v[150:153], a[236:239], v[154:157], v[150:153]
    s_waitcnt lgkmcnt(0)
    v_exp_f32 v233, v233
    v_mfma_f32_16x16x32_bf16 v[190:193], a[240:243], v[146:149], 0
    v_cvt_pk_bf16_f32 v254, v254, v254
    v_cvt_pk_bf16_f32 v127, v232, v233
    v_mfma_f32_16x16x32_bf16 v[190:193], a[244:247], v[142:145], v[190:193]
    ds_write_b16 v8, v254
    v_mfma_f32_16x16x32_bf16 v[190:193], a[248:251], v[206:209], v[190:193]
    v_exp_f32 v234, v234
    v_mfma_f32_16x16x32_bf16 v[190:193], a[252:255], v[162:165], v[190:193]
    ds_read_b128 v[198:201], v2 offset:6144
    ds_read_b128 v[230:233], v9
    v_mfma_f32_16x16x32_bf16 v[190:193], v[82:85], v[134:137], v[190:193]
    ds_read_b128 v[222:225], v2 offset:7168
    ds_read_b128 v[238:241], v9 offset:64
    v_mfma_f32_16x16x32_bf16 v[190:193], v[86:89], v[154:157], v[190:193]
    v_exp_f32 v235, v235
    v_mfma_f32_16x16x32_bf16 v[202:205], v[90:93], v[146:149], 0
    ds_read_b128 v[146:149], v2 offset:8192
    ds_read_b128 v[242:245], v2 offset:9216
    v_mfma_f32_16x16x32_bf16 v[202:205], v[94:97], v[142:145], v[202:205]
    v_cvt_pk_bf16_f32 v128, v234, v235
    v_fma_f32 v254, v150, v150, s33
    v_mfma_f32_16x16x32_bf16 v[202:205], v[98:101], v[206:209], v[202:205]
    ds_read_b128 v[206:209], v2 offset:10240
    ds_read_b128 v[246:249], v2 offset:11264
    v_mfma_f32_16x16x32_bf16 v[202:205], v[102:105], v[162:165], v[202:205]
    v_exp_f32 v236, v236
    v_mfma_f32_16x16x32_bf16 v[202:205], v[106:109], v[134:137], v[202:205]
    v_exp_f32 v237, v237
    v_mfma_f32_16x16x32_bf16 v[202:205], v[110:113], v[154:157], v[202:205]
    s_waitcnt lgkmcnt(6)
    v_cvt_pk_bf16_f32 v129, v236, v237
    v_fmac_f32 v254, v151, v151
    v_mfma_f32_16x16x32_bf16 v[142:145], v[230:233], v[28:31], 0
    s_waitcnt lgkmcnt(4)
    v_exp_f32 v138, v138
    v_mfma_f32_16x16x32_bf16 v[142:145], v[238:241], v[28:31], v[142:145]
    buffer_load_dwordx4 v14, s[8:11], 0 offen nt lds
    v_fmac_f32 v254, v152, v152
    v_mfma_f32_16x16x32_bf16 v[134:137], v[230:233], v[174:177], 0
    s_waitcnt lgkmcnt(2)
    v_exp_f32 v139, v139
    v_mfma_f32_16x16x32_bf16 v[134:137], v[238:241], v[226:229], v[134:137]
    v_cvt_pk_bf16_f32 v36, v138, v139
    v_fmac_f32 v254, v153, v153
    v_mfma_f32_16x16x32_bf16 v[154:157], v[230:233], v[182:185], 0
    s_waitcnt lgkmcnt(0)
    v_rcp_f32 v142, v142
    v_mfma_f32_16x16x32_bf16 v[154:157], v[238:241], v[210:213], v[154:157]
    v_exp_f32 v140, v140
    v_mfma_f32_16x16x32_bf16 v[162:165], v[230:233], v[114:117], 0
    v_mul_f32 v134, v134, v142
    v_fmac_f32 v254, v190, v190
    v_mfma_f32_16x16x32_bf16 v[162:165], v[238:241], v[166:169], v[162:165]
    v_exp_f32 v141, v141
    v_mfma_f32_16x16x32_f16 v[230:233], v[118:121], v[158:161], v[58:61]
    v_cvt_pk_bf16_f32 v37, v140, v141
    v_mul_f32_dpp v134, v154, v142 quad_perm:[0,1,2,3] row_mask:0x2 bank_mask:0xf
    v_mfma_f32_16x16x32_f16 v[138:141], v[170:173], v[158:161], v[62:65]
    v_fmac_f32 v254, v191, v191
    v_fmac_f32 v254, v192, v192
    v_mfma_f32_16x16x32_f16 v[154:157], v[178:181], v[158:161], v[66:69]
    v_mul_f32_dpp v134, v162, v142 quad_perm:[0,1,2,3] row_mask:0x4 bank_mask:0xf
    v_cvt_pk_bf16_f32 v134, v134, v134
    v_fmac_f32 v254, v193, v193
    v_mfma_f32_16x16x16_f16 v[230:233], v[196:197], v[218:219], v[230:233]
    v_fmac_f32 v254, v202, v202
    v_fmac_f32 v254, v203, v203
    v_fmac_f32 v254, v204, v204
    v_mfma_f32_16x16x16_f16 v[138:141], v[220:221], v[218:219], v[138:141]
    v_fmac_f32 v254, v205, v205
    v_mfma_f32_16x16x16_f16 v[154:157], v[124:125], v[218:219], v[154:157]
    ds_write_b16 v7, v134
    v_add_u32 v7, 16, v7
    v_mfma_f32_16x16x32_bf16 v[134:137], v[28:31], v[36:39], 0
    v_exp_f32 v230, v230
    v_mfma_f32_16x16x32_bf16 v[134:137], v[28:31], v[126:129], v[134:137]
    v_exp_f32 v231, v231
    v_mfma_f32_16x16x32_bf16 v[158:161], v[226:229], v[36:39], 0
    v_exp_f32 v232, v232
    v_mfma_f32_16x16x32_bf16 v[158:161], v[174:177], v[126:129], v[158:161]
    v_exp_f32 v233, v233
    v_mfma_f32_16x16x32_bf16 v[162:165], v[210:213], v[36:39], 0
    v_cvt_pk_bf16_f32 v230, v230, v231
    v_cvt_pk_bf16_f32 v231, v232, v233
    v_mfma_f32_16x16x32_bf16 v[162:165], v[182:185], v[126:129], v[162:165]
    v_exp_f32 v138, v138
    v_mfma_f32_16x16x32_bf16 v[234:237], v[166:169], v[36:39], 0
    v_exp_f32 v139, v139
    v_mfma_f32_16x16x32_bf16 v[234:237], v[114:117], v[126:129], v[234:237]
    v_cvt_pk_bf16_f32 v232, v138, v139
    v_cvt_pk_bf16_f32 v39, v214, 0
    v_mfma_f32_16x16x32_f16 v[126:129], v[118:121], v[186:189], v[70:73]
    v_exp_f32 v140, v140
    v_mfma_f32_16x16x32_f16 v[118:121], v[170:173], v[186:189], v[74:77]
    v_exp_f32 v141, v141
    v_mfma_f32_16x16x32_bf16 v[142:145], a[216:219], v[198:201], 0
    v_exp_f32 v154, v154
    v_mfma_f32_16x16x32_bf16 v[142:145], a[220:223], v[222:225], v[142:145]
    v_cvt_pk_bf16_f32 v233, v140, v141
    v_exp_f32 v155, v155
    v_mfma_f32_16x16x32_f16 v[138:141], v[178:181], v[186:189], v[78:81]
    v_cvt_pk_bf16_f32 v36, v154, v155
    v_exp_f32 v156, v156
    v_mfma_f32_16x16x16_f16 v[126:129], v[196:197], v[122:123], v[126:129]
    v_exp_f32 v157, v157
    v_mfma_f32_16x16x16_f16 v[118:121], v[220:221], v[122:123], v[118:121]
    v_cvt_pk_bf16_f32 v37, v156, v157
    v_rcp_f32 v134, v134
    v_mfma_f32_16x16x16_f16 v[138:141], v[124:125], v[122:123], v[138:141]
    v_mul_f32 v158, v134, v158
    v_mul_f32 v159, v134, v159
    v_cvt_pk_bf16_f32 v186, v158, v159
    v_mul_f32 v160, v134, v160
    v_mfma_f32_16x16x32_bf16 v[154:157], v[28:31], v[36:39], 0
    v_exp_f32 v126, v126
    v_mfma_f32_16x16x32_bf16 v[154:157], v[28:31], v[230:233], v[154:157]
    v_exp_f32 v127, v127
    v_mfma_f32_16x16x32_bf16 v[194:197], v[226:229], v[36:39], 0
    v_cvt_pk_bf16_f32 v170, v126, v127
    v_mul_f32 v161, v134, v161
    v_mfma_f32_16x16x32_bf16 v[194:197], v[174:177], v[230:233], v[194:197]
    v_exp_f32 v128, v128
    v_mfma_f32_16x16x32_bf16 v[122:125], v[210:213], v[36:39], 0
    v_exp_f32 v129, v129
    v_mfma_f32_16x16x32_bf16 v[122:125], v[182:185], v[230:233], v[122:125]
    v_cvt_pk_bf16_f32 v171, v128, v129
    v_cvt_pk_bf16_f32 v187, v160, v161
    v_mfma_f32_16x16x32_bf16 v[126:129], v[166:169], v[36:39], 0
    ds_write_b64 v3, v[186:187] offset:0
    v_mfma_f32_16x16x32_bf16 v[126:129], v[114:117], v[230:233], v[126:129]
    v_exp_f32 v118, v118
    v_mfma_f32_16x16x32_bf16 v[142:145], a[224:227], v[146:149], v[142:145]
    v_exp_f32 v119, v119
    v_mfma_f32_16x16x32_bf16 v[142:145], a[228:231], v[242:245], v[142:145]
    v_cvt_pk_bf16_f32 v172, v118, v119
    v_cvt_pk_bf16_f32 v39, v130, 0
    v_mfma_f32_16x16x32_bf16 v[142:145], a[232:235], v[206:209], v[142:145]
    v_exp_f32 v120, v120
    v_mfma_f32_16x16x32_bf16 v[142:145], a[236:239], v[246:249], v[142:145]
    v_exp_f32 v121, v121
    v_mfma_f32_16x16x32_bf16 v[158:161], a[240:243], v[198:201], 0
    v_cvt_pk_bf16_f32 v173, v120, v121
    v_mul_f32 v162, v134, v162
    v_mfma_f32_16x16x32_bf16 v[158:161], a[244:247], v[222:225], v[158:161]
    v_exp_f32 v138, v138
    v_mfma_f32_16x16x32_bf16 v[158:161], a[248:251], v[146:149], v[158:161]
    v_exp_f32 v139, v139
    v_mfma_f32_16x16x32_bf16 v[158:161], a[252:255], v[242:245], v[158:161]
    ds_read_b128 v[118:121], v2 offset:12288
    v_cvt_pk_bf16_f32 v36, v138, v139
    v_mfma_f32_16x16x32_bf16 v[158:161], v[82:85], v[206:209], v[158:161]
    ds_read_b128 v[130:133], v2 offset:13312
    v_fma_f32 v255, v142, v142, s33
    v_mfma_f32_16x16x32_bf16 v[158:161], v[86:89], v[246:249], v[158:161]
    ds_read_b128 v[218:221], v2 offset:14336
    v_fmac_f32 v255, v143, v143
    v_mfma_f32_16x16x32_bf16 v[178:181], v[90:93], v[198:201], 0
    ds_read_b128 v[198:201], v2 offset:15360
    v_fmac_f32 v255, v144, v144
    v_mfma_f32_16x16x32_bf16 v[178:181], v[94:97], v[222:225], v[178:181]
    ds_read_b128 v[222:225], v2 offset:16384
    v_fmac_f32 v255, v145, v145
    v_mfma_f32_16x16x32_bf16 v[178:181], v[98:101], v[146:149], v[178:181]
    ds_read_b128 v[230:233], v2 offset:17408
    v_fmac_f32 v255, v158, v158
    v_mfma_f32_16x16x32_bf16 v[178:181], v[102:105], v[242:245], v[178:181]
    v_exp_f32 v140, v140
    v_mfma_f32_16x16x32_bf16 v[178:181], v[106:109], v[206:209], v[178:181]
    v_exp_f32 v141, v141
    v_mfma_f32_16x16x32_bf16 v[178:181], v[110:113], v[246:249], v[178:181]
    s_waitcnt lgkmcnt(5)
    v_cvt_pk_bf16_f32 v37, v140, v141
    v_fmac_f32 v255, v159, v159
    v_mfma_f32_16x16x32_bf16 v[146:149], a[216:219], v[118:121], 0
    s_waitcnt lgkmcnt(4)
    v_fmac_f32 v255, v160, v160
    v_fmac_f32 v255, v161, v161
    v_mfma_f32_16x16x32_bf16 v[242:245], v[28:31], v[36:39], 0
    s_waitcnt lgkmcnt(3)
    v_fmac_f32 v255, v178, v178
    v_fmac_f32 v255, v179, v179
    v_mfma_f32_16x16x32_bf16 v[242:245], v[28:31], v[170:173], v[242:245]
    s_waitcnt lgkmcnt(2)
    v_fmac_f32 v255, v180, v180
    v_fmac_f32 v255, v181, v181
    v_mfma_f32_16x16x32_bf16 v[206:209], v[226:229], v[36:39], 0
    s_waitcnt lgkmcnt(1)
    v_cvt_pk_bf16_f32 v254, v254, v255
    v_mul_f32 v163, v134, v163
    v_mfma_f32_16x16x32_bf16 v[206:209], v[174:177], v[170:173], v[206:209]
    s_waitcnt lgkmcnt(0)
    v_cvt_pk_bf16_f32 v188, v162, v163
    v_mul_f32 v164, v134, v164
    v_mfma_f32_16x16x32_bf16 v[174:177], v[210:213], v[36:39], 0
    v_mul_f32 v165, v134, v165
    v_cvt_pk_bf16_f32 v189, v164, v165
    v_mfma_f32_16x16x32_bf16 v[174:177], v[182:185], v[170:173], v[174:177]
    ds_write_b64 v3, v[188:189] offset:8
    v_mfma_f32_16x16x32_bf16 v[182:185], v[166:169], v[36:39], 0
    v_mul_f32 v234, v134, v234
    v_mul_f32 v235, v134, v235
    v_mfma_f32_16x16x32_bf16 v[182:185], v[114:117], v[170:173], v[182:185]
    v_cvt_pk_bf16_f32 v234, v234, v235
    v_mul_f32 v236, v134, v236
    v_mfma_f32_16x16x32_bf16 v[146:149], a[220:223], v[130:133], v[146:149]
    v_mul_f32 v237, v134, v237
    v_cvt_pk_bf16_f32 v235, v236, v237
    v_mfma_f32_16x16x32_bf16 v[146:149], a[224:227], v[218:221], v[146:149]
    ds_write_b64 v4, v[234:235] offset:4096
    v_mfma_f32_16x16x32_bf16 v[146:149], a[228:231], v[198:201], v[146:149]
    v_rcp_f32 v154, v154
    v_mfma_f32_16x16x32_bf16 v[146:149], a[232:235], v[222:225], v[146:149]
    v_mul_f32 v194, v154, v194
    v_mul_f32 v195, v154, v195
    v_mfma_f32_16x16x32_bf16 v[146:149], a[236:239], v[230:233], v[146:149]
    v_cvt_pk_bf16_f32 v194, v194, v195
    v_mul_f32 v196, v154, v196
    v_mfma_f32_16x16x32_bf16 v[138:141], a[240:243], v[118:121], 0
    v_mul_f32 v197, v154, v197
    v_cvt_pk_bf16_f32 v195, v196, v197
    v_mfma_f32_16x16x32_bf16 v[138:141], a[244:247], v[130:133], v[138:141]
    ds_write_b64 v3, v[194:195] offset:6144
    v_mfma_f32_16x16x32_bf16 v[138:141], a[248:251], v[218:221], v[138:141]
    v_fma_f32 v255, v146, v146, s33
    v_fmac_f32 v255, v147, v147
    v_mfma_f32_16x16x32_bf16 v[138:141], a[252:255], v[198:201], v[138:141]
    ds_read_b128 v[170:173], v0 offset:20480
    v_fmac_f32 v255, v148, v148
    v_mfma_f32_16x16x32_bf16 v[138:141], v[82:85], v[222:225], v[138:141]
    ds_read_b128 v[166:169], v1 offset:20480
    v_fmac_f32 v255, v149, v149
    v_mfma_f32_16x16x32_bf16 v[138:141], v[86:89], v[230:233], v[138:141]
    ds_read_b128 v[162:165], v0 offset:20608
    v_mul_f32 v122, v154, v122
    v_mfma_f32_16x16x32_bf16 v[186:189], v[90:93], v[118:121], 0
    ds_read_b128 v[210:213], v1 offset:20608
    v_mul_f32 v123, v154, v123
    v_mfma_f32_16x16x32_bf16 v[186:189], v[94:97], v[130:133], v[186:189]
    ds_read_b128 v[226:229], v0 offset:20736
    v_cvt_pk_bf16_f32 v196, v122, v123
    v_mfma_f32_16x16x32_bf16 v[186:189], v[98:101], v[218:221], v[186:189]
    ds_read_b128 v[218:221], v1 offset:20736
    v_fmac_f32 v255, v138, v138
    v_mfma_f32_16x16x32_bf16 v[186:189], v[102:105], v[198:201], v[186:189]
    v_fmac_f32 v255, v139, v139
    v_fmac_f32 v255, v140, v140
    v_mfma_f32_16x16x32_bf16 v[186:189], v[106:109], v[222:225], v[186:189]
    v_fmac_f32 v255, v141, v141
    v_mul_f32 v124, v154, v124
    v_mfma_f32_16x16x32_bf16 v[186:189], v[110:113], v[230:233], v[186:189]
    s_waitcnt lgkmcnt(5)
    v_mul_f32 v125, v154, v125
    v_cvt_pk_bf16_f32 v197, v124, v125
    v_mfma_f32_16x16x32_bf16 v[118:121], a[72:75], v[170:173], 0
    s_waitcnt lgkmcnt(4)
    ds_write_b64 v3, v[196:197] offset:6152
    v_mfma_f32_16x16x32_bf16 v[118:121], a[76:79], v[166:169], v[118:121]
    s_waitcnt lgkmcnt(4)
    v_fmac_f32 v255, v186, v186
    v_fmac_f32 v255, v187, v187
    v_mfma_f32_16x16x32_bf16 v[118:121], a[80:83], v[162:165], v[118:121]
    s_waitcnt lgkmcnt(3)
    v_fmac_f32 v255, v188, v188
    v_fmac_f32 v255, v189, v189
    v_mfma_f32_16x16x32_bf16 v[118:121], a[84:87], v[210:213], v[118:121]
    s_waitcnt lgkmcnt(2)
    v_cvt_pk_bf16_f32 v255, v255, v255
    v_mul_f32 v126, v154, v126
    v_mfma_f32_16x16x32_bf16 v[118:121], a[88:91], v[226:229], v[118:121]
    s_waitcnt lgkmcnt(1)
    ds_write_b64 v4, v[254:255] offset:18432
    v_mfma_f32_16x16x32_bf16 v[118:121], a[92:95], v[218:221], v[118:121]
    v_mul_f32 v127, v154, v127
    v_cvt_pk_bf16_f32 v254, v126, v127
    v_mfma_f32_16x16x32_bf16 v[194:197], a[96:99], v[170:173], 0
    v_mul_f32 v128, v154, v128
    v_mul_f32 v129, v154, v129
    v_mfma_f32_16x16x32_bf16 v[194:197], a[100:103], v[166:169], v[194:197]
    v_cvt_pk_bf16_f32 v255, v128, v129
    v_xor_b32 v2, 65536, v2
    v_mfma_f32_16x16x32_bf16 v[194:197], a[104:107], v[162:165], v[194:197]
    ds_write_b64 v4, v[254:255] offset:10240
    v_mfma_f32_16x16x32_bf16 v[194:197], a[108:111], v[210:213], v[194:197]
    v_cvt_pk_f16_f32 v118, v118, v119
    v_pk_mul_f16 v223, v118, v118
    v_mfma_f32_16x16x32_bf16 v[194:197], a[112:115], v[226:229], v[194:197]
    v_cvt_pk_f16_f32 v119, v120, v121
    v_pk_mul_f16 v225, v119, v119
    v_mfma_f32_16x16x32_bf16 v[194:197], a[116:119], v[218:221], v[194:197]
    v_rcp_f32 v242, v242
    v_mfma_f32_16x16x32_bf16 v[114:117], a[120:123], v[170:173], 0
    v_mul_f32 v206, v242, v206
    v_mul_f32 v207, v242, v207
    v_mfma_f32_16x16x32_bf16 v[114:117], a[124:127], v[166:169], v[114:117]
    v_cvt_pk_bf16_f32 v206, v206, v207
    v_mul_f32 v208, v242, v208
    v_mfma_f32_16x16x32_bf16 v[114:117], a[128:131], v[162:165], v[114:117]
    v_cvt_pk_f16_f32 v120, v194, v195
    v_pk_fma_f16 v223, v120, v120, v223
    v_mfma_f32_16x16x32_bf16 v[114:117], a[132:135], v[210:213], v[114:117]
    v_cvt_pk_f16_f32 v121, v196, v197
    v_pk_fma_f16 v225, v121, v121, v225
    v_mfma_f32_16x16x32_bf16 v[114:117], a[136:139], v[226:229], v[114:117]
    v_mul_f32 v209, v242, v209
    v_cvt_pk_bf16_f32 v207, v208, v209
    v_mfma_f32_16x16x32_bf16 v[114:117], a[140:143], v[218:221], v[114:117]
    ds_write_b64 v3, v[206:207] offset:12288
    v_mfma_f32_16x16x32_bf16 v[154:157], a[0:3], v[170:173], 0
    v_mul_f32 v174, v242, v174
    v_mul_f32 v175, v242, v175
    v_mfma_f32_16x16x32_bf16 v[154:157], a[4:7], v[166:169], v[154:157]
    v_cvt_pk_bf16_f32 v208, v174, v175
    v_mul_f32 v176, v242, v176
    v_mfma_f32_16x16x32_bf16 v[154:157], a[8:11], v[162:165], v[154:157]
    v_cvt_pk_f16_f32 v196, v114, v115
    v_pk_fma_f16 v223, v196, v196, v223
    v_mfma_f32_16x16x32_bf16 v[154:157], a[12:15], v[210:213], v[154:157]
    v_cvt_pk_f16_f32 v197, v116, v117
    v_pk_fma_f16 v225, v197, v197, v225
    v_mfma_f32_16x16x32_bf16 v[154:157], a[16:19], v[226:229], v[154:157]
    v_mul_f32 v177, v242, v177
    v_cvt_pk_bf16_f32 v209, v176, v177
    v_mfma_f32_16x16x32_bf16 v[154:157], a[20:23], v[218:221], v[154:157]
    ds_write_b64 v3, v[208:209] offset:12296
    v_mfma_f32_16x16x32_bf16 v[174:177], a[24:27], v[170:173], 0
    v_mul_f32 v182, v242, v182
    v_mul_f32 v183, v242, v183
    v_mfma_f32_16x16x32_bf16 v[174:177], a[28:31], v[166:169], v[174:177]
    v_cvt_pk_bf16_f32 v194, v182, v183
    v_mul_f32 v184, v242, v184
    v_mfma_f32_16x16x32_bf16 v[174:177], a[32:35], v[162:165], v[174:177]
    v_cvt_pk_f16_f32 v206, v154, v155
    v_mul_f32 v185, v242, v185
    v_mfma_f32_16x16x32_bf16 v[174:177], a[36:39], v[210:213], v[174:177]
    v_cvt_pk_bf16_f32 v195, v184, v185
    v_xor_b32 v3, 65536, v3
    v_mfma_f32_16x16x32_bf16 v[174:177], a[40:43], v[226:229], v[174:177]
    ds_write_b64 v4, v[194:195] offset:16384
    v_mfma_f32_16x16x32_bf16 v[174:177], a[44:47], v[218:221], v[174:177]
    v_xor_b32 v4, 65536, v4
    v_mfma_f32_16x16x32_bf16 v[182:185], a[48:51], v[170:173], 0
    v_mfma_f32_16x16x32_bf16 v[182:185], a[52:55], v[166:169], v[182:185]
    v_mfma_f32_16x16x32_bf16 v[182:185], a[56:59], v[162:165], v[182:185]
    v_mfma_f32_16x16x32_bf16 v[182:185], a[60:63], v[210:213], v[182:185]
    v_mfma_f32_16x16x32_bf16 v[182:185], a[64:67], v[226:229], v[182:185]
    v_mfma_f32_16x16x32_bf16 v[182:185], a[68:71], v[218:221], v[182:185]
    v_mfma_f32_16x16x32_bf16 v[230:233], v[170:173], a[144:147], 0
    s_waitcnt lgkmcnt(0)
    v_mfma_f32_16x16x32_bf16 v[230:233], v[166:169], a[148:151], v[230:233]
    s_nop 0
    v_mfma_f32_16x16x32_bf16 v[230:233], v[162:165], a[152:155], v[230:233]
    s_barrier
    v_mfma_f32_16x16x32_bf16 v[230:233], v[210:213], a[156:159], v[230:233]
    s_nop 0
    v_mfma_f32_16x16x32_bf16 v[230:233], v[226:229], a[160:163], v[230:233]
    s_nop 0
    v_mfma_f32_16x16x32_bf16 v[230:233], v[218:221], a[164:167], v[230:233]
    s_cbranch_scc1 L_loop_fast1
    s_branch L_final_fast
.p2align 6
L_loop_fast2:
    v_mfma_f32_16x16x32_bf16 v[234:237], v[170:173], a[168:171], 0
    s_add_u32 s12, s42, s27
    ds_read_b128 v[242:245], v2 offset:18432
    ds_read_b128 v[246:249], v2 offset:19456
    v_mfma_f32_16x16x32_bf16 v[234:237], v[166:169], a[172:175], v[234:237]
    s_addc_u32 s13, s43, 0
    v_pk_mul_f16 v222, v206, v206
    v_cvt_pk_f16_f32 v207, v156, v157
    v_mfma_f32_16x16x32_bf16 v[234:237], v[162:165], a[176:179], v[234:237]
    s_sub_u32 s14, s36, s27
    v_pk_mul_f16 v224, v207, v207
    v_cvt_pk_f16_f32 v208, v174, v175
    v_mfma_f32_16x16x32_bf16 v[234:237], v[210:213], a[180:183], v[234:237]
    s_cmp_ge_u32 s18, 2
    ds_read_b128 v[134:137], v0 offset:26624
    v_pk_fma_f16 v222, v208, v208, v222
    v_mfma_f32_16x16x32_bf16 v[234:237], v[226:229], a[184:187], v[234:237]
    s_cselect_b32 s14, s14, 0
    ds_read_b128 v[154:157], v1 offset:26624
    v_cvt_pk_f16_f32 v209, v176, v177
    v_mfma_f32_16x16x32_bf16 v[234:237], v[218:221], a[188:191], v[234:237]
    s_add_u32 s34, s18, 2
    ds_read_b128 v[130:133], v0 offset:26752
    v_pk_fma_f16 v224, v209, v209, v224
    v_mfma_f32_16x16x32_bf16 v[114:117], v[170:173], a[192:195], 0
    s_add_u32 s8, s40, s23
    ds_read_b128 v[122:125], v1 offset:26752
    v_cvt_pk_f16_f32 v194, v182, v183
    v_mfma_f32_16x16x32_bf16 v[114:117], v[166:169], a[196:199], v[114:117]
    s_addc_u32 s9, s41, 0
    ds_read_b128 v[126:129], v0 offset:26880
    v_pk_fma_f16 v222, v194, v194, v222
    v_mfma_f32_16x16x32_bf16 v[114:117], v[162:165], a[200:203], v[114:117]
    s_waitcnt lgkmcnt(5)
    ds_read_b128 v[166:169], v1 offset:26880
    v_cvt_pk_f16_f32 v195, v184, v185
    v_mfma_f32_16x16x32_bf16 v[198:201], v[32:35], v[242:245], 0
    s_sub_u32 s10, s36, s23
    v_pk_fma_f16 v224, v195, v195, v224
    v_cvt_pk_bf16_f32 v174, v230, v231
    v_mfma_f32_16x16x32_bf16 v[198:201], v[32:35], v[246:249], v[198:201]
    s_cmp_lt_u32 s34, s17
    v_cvt_pk_bf16_f32 v175, v232, v233
    v_cvt_pk_bf16_f32 v182, v234, v235
    v_mfma_f32_16x16x32_f16 v[170:173], v[40:43], v[222:225], 0
    s_waitcnt lgkmcnt(5)
    v_cvt_pk_bf16_f32 v183, v236, v237
    s_cselect_b32 s10, s10, 0
    v_mfma_f32_16x16x32_bf16 v[114:117], v[210:213], a[204:207], v[114:117]
    s_add_u32 m0, s28, 0
    v_mul_f32 v255, 0x3baaaaab, v198
    v_mul_f32 v254, 0x3baaaaab, v199
    v_mfma_f32_16x16x32_bf16 v[114:117], v[226:229], a[208:211], v[114:117]
    s_mov_b32 s27, s26
    v_rsq_f32 v172, v170
    v_mfma_f32_16x16x32_bf16 v[114:117], v[218:221], a[212:215], v[114:117]
    s_mov_b32 s26, s25
    v_rsq_f32 v173, v171
    v_mfma_f32_16x16x32_bf16 v[162:165], a[72:75], v[134:137], 0
    s_waitcnt lgkmcnt(1)
    v_mul_f32 v172, s31, v172
    v_cvt_pk_f16_f32 v172, v172, v173
    v_mfma_f32_16x16x32_bf16 v[162:165], a[76:79], v[154:157], v[162:165]
    s_mov_b32 s25, s24
    v_cvt_pk_bf16_f32 v114, v114, v115
    v_cvt_pk_bf16_f32 v115, v116, v117
    v_mfma_f32_16x16x32_bf16 v[162:165], a[80:83], v[130:133], v[162:165]
    s_mov_b32 s24, s23
    v_pk_mul_f16 v118, v118, v172 op_sel:[0,1] op_sel_hi:[1,1]
    v_pk_mul_f16 v119, v119, v172 op_sel:[0,1] op_sel_hi:[1,1]
    v_mfma_f32_16x16x32_bf16 v[162:165], a[84:87], v[122:125], v[162:165]
    s_waitcnt lgkmcnt(0)
    v_pk_mul_f16 v120, v120, v172 op_sel:[0,1] op_sel_hi:[1,1]
    v_pk_mul_f16 v121, v121, v172 op_sel:[0,1] op_sel_hi:[1,1]
    v_mfma_f32_16x16x32_bf16 v[162:165], a[88:91], v[126:129], v[162:165]
    v_pk_mul_f16 v196, v196, v172 op_sel:[0,1] op_sel_hi:[1,1]
    v_pk_mul_f16 v197, v197, v172 op_sel:[0,1] op_sel_hi:[1,1]
    v_mfma_f32_16x16x32_bf16 v[162:165], a[92:95], v[166:169], v[162:165]
    v_pk_mul_f16 v206, v206, v172 op_sel:[0,0] op_sel_hi:[1,0]
    v_pk_mul_f16 v207, v207, v172 op_sel:[0,0] op_sel_hi:[1,0]
    v_mfma_f32_16x16x32_bf16 v[210:213], a[96:99], v[134:137], 0
    v_pk_mul_f16 v208, v208, v172 op_sel:[0,0] op_sel_hi:[1,0]
    v_pk_mul_f16 v209, v209, v172 op_sel:[0,0] op_sel_hi:[1,0]
    v_mfma_f32_16x16x32_bf16 v[210:213], a[100:103], v[154:157], v[210:213]
    v_pk_mul_f16 v194, v194, v172 op_sel:[0,0] op_sel_hi:[1,0]
    v_pk_mul_f16 v195, v195, v172 op_sel:[0,0] op_sel_hi:[1,0]
    v_mfma_f32_16x16x32_bf16 v[210:213], a[104:107], v[130:133], v[210:213]
    v_min3_u32 v44, v44, v170, v171
    v_max3_u32 v45, v45, v170, v171
    v_mfma_f32_16x16x32_bf16 v[210:213], a[108:111], v[122:125], v[210:213]
    v_cvt_pk_f16_f32 v170, v162, v163
    v_pk_mul_f16 v163, v170, v170
    v_mfma_f32_16x16x32_bf16 v[210:213], a[112:115], v[126:129], v[210:213]
    v_cvt_pk_f16_f32 v171, v164, v165
    v_pk_mul_f16 v165, v171, v171
    v_mfma_f32_16x16x32_bf16 v[210:213], a[116:119], v[166:169], v[210:213]
    v_rsq_f32 v255, v255
    v_mfma_f32_16x16x32_bf16 v[214:217], a[120:123], v[134:137], 0
    v_rsq_f32 v254, v254
    v_mfma_f32_16x16x32_bf16 v[214:217], a[124:127], v[154:157], v[214:217]
    v_mul_f32 v142, v254, v142
    v_mul_f32 v143, v254, v143
    v_mfma_f32_16x16x32_bf16 v[214:217], a[128:131], v[130:133], v[214:217]
    v_cvt_pk_bf16_f32 v142, v142, v143
    v_cvt_pk_f16_f32 v172, v210, v211
    v_mfma_f32_16x16x32_bf16 v[214:217], a[132:135], v[122:125], v[214:217]
    v_pk_fma_f16 v163, v172, v172, v163
    v_cvt_pk_f16_f32 v173, v212, v213
    v_mfma_f32_16x16x32_bf16 v[214:217], a[136:139], v[126:129], v[214:217]
    v_pk_fma_f16 v165, v173, v173, v165
    v_mul_f32 v144, v254, v144
    v_mfma_f32_16x16x32_bf16 v[214:217], a[140:143], v[166:169], v[214:217]
    v_mul_f32 v145, v254, v145
    v_cvt_pk_bf16_f32 v143, v144, v145
    v_mfma_f32_16x16x32_bf16 v[210:213], a[0:3], v[134:137], 0
    v_mul_f32 v158, v254, v158
    v_mul_f32 v159, v254, v159
    v_mfma_f32_16x16x32_bf16 v[210:213], a[4:7], v[154:157], v[210:213]
    v_cvt_pk_bf16_f32 v144, v158, v159
    v_mul_f32 v160, v254, v160
    v_mfma_f32_16x16x32_bf16 v[210:213], a[8:11], v[130:133], v[210:213]
    v_cvt_pk_f16_f32 v220, v214, v215
    v_pk_fma_f16 v163, v220, v220, v163
    v_mfma_f32_16x16x32_bf16 v[210:213], a[12:15], v[122:125], v[210:213]
    v_cvt_pk_f16_f32 v221, v216, v217
    v_pk_fma_f16 v165, v221, v221, v165
    v_mfma_f32_16x16x32_bf16 v[210:213], a[16:19], v[126:129], v[210:213]
    v_mul_f32 v161, v254, v161
    v_cvt_pk_bf16_f32 v145, v160, v161
    v_mfma_f32_16x16x32_bf16 v[210:213], a[20:23], v[166:169], v[210:213]
    buffer_store_dwordx4 v[142:145], v16, s[12:15], 0 offen nt
    v_mul_f32 v178, v254, v178
    v_mul_f32 v179, v254, v179
    v_cvt_pk_bf16_f32 v116, v178, v179
    v_mul_f32 v180, v254, v180
    v_mfma_f32_16x16x32_bf16 v[142:145], a[24:27], v[134:137], 0
    v_mul_f32 v181, v254, v181
    v_cvt_pk_bf16_f32 v117, v180, v181
    v_mfma_f32_16x16x32_bf16 v[142:145], a[28:31], v[154:157], v[142:145]
    v_cvt_pk_f16_f32 v158, v210, v211
    v_pk_mul_f16 v162, v158, v158
    v_mfma_f32_16x16x32_bf16 v[142:145], a[32:35], v[130:133], v[142:145]
    v_cvt_pk_f16_f32 v159, v212, v213
    v_pk_mul_f16 v164, v159, v159
    v_mfma_f32_16x16x32_bf16 v[142:145], a[36:39], v[122:125], v[142:145]
    v_mul_f32 v254, 0x3baaaaab, v200
    v_mul_f32 v150, v255, v150
    v_mfma_f32_16x16x32_bf16 v[142:145], a[40:43], v[126:129], v[142:145]
    v_rsq_f32 v254, v254
    v_mfma_f32_16x16x32_bf16 v[142:145], a[44:47], v[166:169], v[142:145]
    v_mul_f32 v151, v255, v151
    v_cvt_pk_bf16_f32 v150, v150, v151
    v_mfma_f32_16x16x32_bf16 v[178:181], a[48:51], v[134:137], 0
    v_mul_f32 v152, v255, v152
    v_mul_f32 v153, v255, v153
    v_mfma_f32_16x16x32_bf16 v[178:181], a[52:55], v[154:157], v[178:181]
    v_cvt_pk_bf16_f32 v151, v152, v153
    v_mul_f32 v190, v255, v190
    v_mfma_f32_16x16x32_bf16 v[178:181], a[56:59], v[130:133], v[178:181]
    v_cvt_pk_f16_f32 v160, v142, v143
    v_pk_fma_f16 v162, v160, v160, v162
    v_mfma_f32_16x16x32_bf16 v[178:181], a[60:63], v[122:125], v[178:181]
    v_cvt_pk_f16_f32 v161, v144, v145
    v_pk_fma_f16 v164, v161, v161, v164
    v_mfma_f32_16x16x32_bf16 v[178:181], a[64:67], v[126:129], v[178:181]
    v_mul_f32 v191, v255, v191
    v_cvt_pk_bf16_f32 v152, v190, v191
    v_mfma_f32_16x16x32_bf16 v[178:181], a[68:71], v[166:169], v[178:181]
    v_mul_f32 v192, v255, v192
    v_mul_f32 v193, v255, v193
    v_mfma_f32_16x16x32_bf16 v[142:145], v[134:137], a[144:147], 0
    v_cvt_pk_bf16_f32 v153, v192, v193
    v_mul_f32 v202, v255, v202
    v_mfma_f32_16x16x32_bf16 v[142:145], v[154:157], a[148:151], v[142:145]
    v_mul_f32 v203, v255, v203
    v_cvt_pk_bf16_f32 v202, v202, v203
    v_mfma_f32_16x16x32_bf16 v[142:145], v[130:133], a[152:155], v[142:145]
    v_cvt_pk_f16_f32 v218, v178, v179
    v_pk_fma_f16 v162, v218, v218, v162
    v_mfma_f32_16x16x32_bf16 v[142:145], v[122:125], a[156:159], v[142:145]
    v_cvt_pk_f16_f32 v219, v180, v181
    v_pk_fma_f16 v164, v219, v219, v164
    v_mfma_f32_16x16x32_bf16 v[142:145], v[126:129], a[160:163], v[142:145]
    buffer_store_dwordx2 v[116:117], v19, s[12:15], 0 offen nt
    v_mul_f32 v204, v255, v204
    v_mul_f32 v205, v255, v205
    v_mfma_f32_16x16x32_f16 v[190:193], v[40:43], v[162:165], 0
    v_cvt_pk_bf16_f32 v203, v204, v205
    v_mul_f32 v146, v254, v146
    v_mfma_f32_16x16x32_bf16 v[142:145], v[166:169], a[164:167], v[142:145]
    v_mul_f32 v147, v254, v147
    v_cvt_pk_bf16_f32 v146, v146, v147
    v_mfma_f32_16x16x32_bf16 v[178:181], v[134:137], a[168:171], 0
    v_mul_f32 v148, v254, v148
    v_mul_f32 v149, v254, v149
    v_mfma_f32_16x16x32_bf16 v[178:181], v[154:157], a[172:175], v[178:181]
    v_rsq_f32 v192, v190
    v_mfma_f32_16x16x32_bf16 v[178:181], v[130:133], a[176:179], v[178:181]
    v_cvt_pk_bf16_f32 v176, v142, v143
    v_cvt_pk_bf16_f32 v177, v144, v145
    v_mfma_f32_16x16x32_bf16 v[178:181], v[122:125], a[180:183], v[178:181]
    ds_read_b128 v[142:145], v0 offset:32768
    v_mul_f32 v192, s31, v192
    v_mfma_f32_16x16x32_bf16 v[178:181], v[126:129], a[184:187], v[178:181]
    ds_read_b128 v[162:165], v1 offset:32768
    v_min3_u32 v44, v44, v190, v191
    v_mfma_f32_16x16x32_bf16 v[178:181], v[166:169], a[188:191], v[178:181]
    ds_read_b128 v[210:213], v0 offset:32896
    v_max3_u32 v45, v45, v190, v191
    v_mfma_f32_16x16x32_bf16 v[198:201], v[134:137], a[192:195], 0
    ds_read_b128 v[134:137], v1 offset:32896
    v_cvt_pk_bf16_f32 v147, v148, v149
    v_mfma_f32_16x16x32_bf16 v[198:201], v[154:157], a[196:199], v[198:201]
    ds_read_b128 v[154:157], v0 offset:33024
    v_mul_f32 v138, v254, v138
    v_mfma_f32_16x16x32_bf16 v[198:201], v[130:133], a[200:203], v[198:201]
    ds_read_b128 v[130:133], v1 offset:33024
    v_cvt_pk_bf16_f32 v184, v178, v179
    v_mfma_f32_16x16x32_bf16 v[198:201], v[122:125], a[204:207], v[198:201]
    v_rsq_f32 v193, v191
    v_mfma_f32_16x16x32_bf16 v[198:201], v[126:129], a[208:211], v[198:201]
    v_cvt_pk_f16_f32 v192, v192, v193
    v_cvt_pk_bf16_f32 v185, v180, v181
    v_mfma_f32_16x16x32_bf16 v[198:201], v[166:169], a[212:215], v[198:201]
    s_waitcnt lgkmcnt(5)
    v_pk_mul_f16 v170, v170, v192 op_sel:[0,1] op_sel_hi:[1,1]
    v_pk_mul_f16 v171, v171, v192 op_sel:[0,1] op_sel_hi:[1,1]
    v_mfma_f32_16x16x32_bf16 v[178:181], a[72:75], v[142:145], 0
    s_waitcnt lgkmcnt(4)
    v_pk_mul_f16 v172, v172, v192 op_sel:[0,1] op_sel_hi:[1,1]
    v_pk_mul_f16 v173, v173, v192 op_sel:[0,1] op_sel_hi:[1,1]
    v_mfma_f32_16x16x32_bf16 v[178:181], a[76:79], v[162:165], v[178:181]
    s_waitcnt lgkmcnt(3)
    v_cvt_pk_bf16_f32 v116, v198, v199
    v_cvt_pk_bf16_f32 v117, v200, v201
    v_mfma_f32_16x16x32_bf16 v[178:181], a[80:83], v[210:213], v[178:181]
    s_waitcnt lgkmcnt(2)
    buffer_store_dwordx4 v[150:153], v15, s[12:15], 0 offen nt
    v_pk_mul_f16 v220, v220, v192 op_sel:[0,1] op_sel_hi:[1,1]
    v_pk_mul_f16 v221, v221, v192 op_sel:[0,1] op_sel_hi:[1,1]
    v_pk_mul_f16 v158, v158, v192 op_sel:[0,0] op_sel_hi:[1,0]
    v_pk_mul_f16 v159, v159, v192 op_sel:[0,0] op_sel_hi:[1,0]
    v_mfma_f32_16x16x32_bf16 v[178:181], a[84:87], v[134:137], v[178:181]
    s_waitcnt lgkmcnt(0)
    v_pk_mul_f16 v160, v160, v192 op_sel:[0,0] op_sel_hi:[1,0]
    v_pk_mul_f16 v161, v161, v192 op_sel:[0,0] op_sel_hi:[1,0]
    v_mfma_f32_16x16x32_bf16 v[178:181], a[88:91], v[154:157], v[178:181]
    v_pk_mul_f16 v218, v218, v192 op_sel:[0,0] op_sel_hi:[1,0]
    v_pk_mul_f16 v219, v219, v192 op_sel:[0,0] op_sel_hi:[1,0]
    v_mfma_f32_16x16x32_bf16 v[178:181], a[92:95], v[130:133], v[178:181]
    v_mul_f32 v139, v254, v139
    v_cvt_pk_bf16_f32 v148, v138, v139
    v_mfma_f32_16x16x32_bf16 v[150:153], a[96:99], v[142:145], 0
    v_mul_f32 v140, v254, v140
    v_mul_f32 v141, v254, v141
    v_mfma_f32_16x16x32_bf16 v[150:153], a[100:103], v[162:165], v[150:153]
    v_cvt_pk_bf16_f32 v149, v140, v141
    v_mul_f32 v186, v254, v186
    v_mfma_f32_16x16x32_bf16 v[150:153], a[104:107], v[210:213], v[150:153]
    v_cvt_pk_f16_f32 v178, v178, v179
    v_pk_mul_f16 v191, v178, v178
    v_mfma_f32_16x16x32_bf16 v[150:153], a[108:111], v[134:137], v[150:153]
    v_cvt_pk_f16_f32 v179, v180, v181
    v_pk_mul_f16 v193, v179, v179
    v_mfma_f32_16x16x32_bf16 v[150:153], a[112:115], v[154:157], v[150:153]
    v_mul_f32 v187, v254, v187
    v_cvt_pk_bf16_f32 v204, v186, v187
    v_mfma_f32_16x16x32_bf16 v[150:153], a[116:119], v[130:133], v[150:153]
    v_mul_f32 v188, v254, v188
    v_mul_f32 v189, v254, v189
    v_mfma_f32_16x16x32_bf16 v[138:141], a[120:123], v[142:145], 0
    s_waitcnt vmcnt(3)
    v_cvt_pk_bf16_f32 v205, v188, v189
    v_xor_b32 v0, 65536, v0
    v_mfma_f32_16x16x32_bf16 v[138:141], a[124:127], v[162:165], v[138:141]
    v_mfma_f32_16x16x32_bf16 v[138:141], a[128:131], v[210:213], v[138:141]
    v_mfma_f32_16x16x32_bf16 v[138:141], a[132:135], v[134:137], v[138:141]
    s_barrier
    v_mfma_f32_16x16x32_bf16 v[138:141], a[136:139], v[154:157], v[138:141]
    v_mfma_f32_16x16x32_bf16 v[138:141], a[140:143], v[130:133], v[138:141]
    v_cvt_pk_f16_f32 v180, v150, v151
    v_pk_fma_f16 v191, v180, v180, v191
    v_mfma_f32_16x16x32_bf16 v[186:189], a[0:3], v[142:145], 0
    v_cvt_pk_f16_f32 v181, v152, v153
    v_pk_fma_f16 v193, v181, v181, v193
    v_mfma_f32_16x16x32_bf16 v[186:189], a[4:7], v[162:165], v[186:189]
    buffer_load_dwordx4 v10, s[8:11], 0 offen nt lds
    v_xor_b32 v1, 65536, v1
    v_mfma_f32_16x16x32_bf16 v[186:189], a[8:11], v[210:213], v[186:189]
    s_add_u32 m0, s28, 4096
    v_cvt_pk_f16_f32 v124, v138, v139
    v_pk_fma_f16 v191, v124, v124, v191
    v_mfma_f32_16x16x32_bf16 v[186:189], a[12:15], v[134:137], v[186:189]
    v_cvt_pk_f16_f32 v125, v140, v141
    v_pk_fma_f16 v193, v125, v125, v193
    v_mfma_f32_16x16x32_bf16 v[186:189], a[16:19], v[154:157], v[186:189]
    v_mfma_f32_16x16x32_bf16 v[186:189], a[20:23], v[130:133], v[186:189]
    v_mfma_f32_16x16x32_bf16 v[150:153], a[24:27], v[142:145], 0
    buffer_load_dwordx4 v11, s[8:11], 0 offen nt lds
    s_add_u32 m0, s28, 8192
    v_mfma_f32_16x16x32_bf16 v[150:153], a[28:31], v[162:165], v[150:153]
    v_mfma_f32_16x16x32_bf16 v[150:153], a[32:35], v[210:213], v[150:153]
    v_mfma_f32_16x16x32_bf16 v[150:153], a[36:39], v[134:137], v[150:153]
    v_mfma_f32_16x16x32_bf16 v[150:153], a[40:43], v[154:157], v[150:153]
    v_mfma_f32_16x16x32_bf16 v[150:153], a[44:47], v[130:133], v[150:153]
    buffer_load_dwordx4 v12, s[8:11], 0 offen nt lds
    v_cvt_pk_f16_f32 v186, v186, v187
    v_mfma_f32_16x16x32_bf16 v[138:141], a[48:51], v[142:145], 0
    s_add_u32 m0, s28, 12288
    v_pk_mul_f16 v190, v186, v186
    v_cvt_pk_f16_f32 v187, v188, v189
    v_mfma_f32_16x16x32_bf16 v[138:141], a[52:55], v[162:165], v[138:141]
    s_xor_b32 s28, s28, 65536
    ds_read_b128 v[166:169], v5 offset:0
    ds_read_b128 v[126:129], v5 offset:16
    v_mfma_f32_16x16x32_bf16 v[138:141], a[56:59], v[210:213], v[138:141]
    ds_read_b128 v[198:201], v5 offset:48
    ds_read_b32 v254, v6 offset:192
    v_mfma_f32_16x16x32_bf16 v[138:141], a[60:63], v[134:137], v[138:141]
    v_pk_mul_f16 v192, v187, v187
    v_cvt_pk_f16_f32 v188, v150, v151
    v_mfma_f32_16x16x32_bf16 v[138:141], a[64:67], v[154:157], v[138:141]
    buffer_load_dwordx4 v13, s[8:11], 0 offen nt lds
    v_pk_fma_f16 v190, v188, v188, v190
    v_mfma_f32_16x16x32_bf16 v[138:141], a[68:71], v[130:133], v[138:141]
    s_mov_b32 m0, s29
    v_cvt_pk_f16_f32 v189, v152, v153
    v_pk_fma_f16 v192, v189, v189, v192
    v_mfma_f32_16x16x32_bf16 v[150:153], v[142:145], a[144:147], 0
    s_xor_b32 s29, s29, s30
    v_add_u32 v5, 336, v5
    s_add_u32 s19, s19, s20
    v_mfma_f32_16x16x32_bf16 v[150:153], v[162:165], a[148:151], v[150:153]
    s_add_u32 s23, s23, s21
    v_cvt_pk_f16_f32 v122, v138, v139
    v_pk_fma_f16 v190, v122, v122, v190
    v_mfma_f32_16x16x32_bf16 v[150:153], v[210:213], a[152:155], v[150:153]
    s_cmp_ge_u32 s19, 72
    v_cvt_pk_f16_f32 v123, v140, v141
    v_pk_fma_f16 v192, v123, v123, v192
    v_mfma_f32_16x16x32_bf16 v[150:153], v[134:137], a[156:159], v[150:153]
    s_waitcnt lgkmcnt(2)
    buffer_store_dwordx2 v[202:203], v18, s[12:15], 0 offen nt
    s_cselect_b32 s34, 72, 0
    s_cselect_b32 s35, s22, 0
    v_mfma_f32_16x16x32_f16 v[138:141], v[40:43], v[190:193], 0
    s_sub_u32 s19, s19, s34
    s_add_u32 s23, s23, s35
    s_add_u32 s18, s18, 1
    v_mfma_f32_16x16x32_f16 v[214:217], v[166:169], v[158:161], v[24:27]
    s_cmp_lt_u32 s18, s45
    v_mfma_f32_16x16x32_f16 v[214:217], v[126:129], v[170:173], v[214:217]
    s_waitcnt lgkmcnt(0)
    v_mfma_f32_16x16x32_f16 v[214:217], v[198:201], v[218:221], v[214:217]
    v_rsq_f32 v140, v138
    v_mfma_f32_16x16x32_f16 v[190:193], v[166:169], v[206:209], v[22:25]
    v_rsq_f32 v141, v139
    v_mfma_f32_16x16x32_f16 v[190:193], v[126:129], v[118:121], v[190:193]
    v_mul_f32 v140, s31, v140
    v_cvt_pk_f16_f32 v140, v140, v141
    v_mfma_f32_16x16x32_f16 v[190:193], v[198:201], v[194:197], v[190:193]
    v_pk_mul_f16 v178, v178, v140 op_sel:[0,1] op_sel_hi:[1,1]
    v_pk_mul_f16 v179, v179, v140 op_sel:[0,1] op_sel_hi:[1,1]
    v_mfma_f32_16x16x32_bf16 v[150:153], v[154:157], a[160:163], v[150:153]
    v_pk_mul_f16 v180, v180, v140 op_sel:[0,1] op_sel_hi:[1,1]
    v_pk_mul_f16 v181, v181, v140 op_sel:[0,1] op_sel_hi:[1,1]
    v_mfma_f32_16x16x32_bf16 v[150:153], v[130:133], a[164:167], v[150:153]
    v_pk_mul_f16 v124, v124, v140 op_sel:[0,1] op_sel_hi:[1,1]
    v_pk_mul_f16 v125, v125, v140 op_sel:[0,1] op_sel_hi:[1,1]
    v_mfma_f32_16x16x32_bf16 v[222:225], v[142:145], a[168:171], 0
    v_mov_b32_dpp v254, v191 quad_perm:[0,1,2,3] row_mask:0x1 bank_mask:0xf
    v_mov_b32_dpp v254, v215 quad_perm:[0,1,2,3] row_mask:0x2 bank_mask:0xf
    v_mfma_f32_16x16x32_bf16 v[222:225], v[162:165], a[172:175], v[222:225]
    v_pk_mul_f16 v186, v186, v140 op_sel:[0,0] op_sel_hi:[1,0]
    v_pk_mul_f16 v187, v187, v140 op_sel:[0,0] op_sel_hi:[1,0]
    v_mfma_f32_16x16x32_bf16 v[222:225], v[210:213], a[176:179], v[222:225]
    v_cvt_pk_bf16_f32 v226, v150, v151
    v_cvt_pk_bf16_f32 v227, v152, v153
    v_mfma_f32_16x16x32_bf16 v[222:225], v[134:137], a[180:183], v[222:225]
    v_pk_mul_f16 v188, v188, v140 op_sel:[0,0] op_sel_hi:[1,0]
    v_pk_mul_f16 v189, v189, v140 op_sel:[0,0] op_sel_hi:[1,0]
    v_mfma_f32_16x16x32_f16 v[230:233], v[118:121], v[206:209], v[46:49]
    v_pk_mul_f16 v122, v122, v140 op_sel:[0,0] op_sel_hi:[1,0]
    v_pk_mul_f16 v123, v123, v140 op_sel:[0,0] op_sel_hi:[1,0]
    v_mfma_f32_16x16x32_f16 v[234:237], v[170:173], v[206:209], v[50:53]
    v_min3_u32 v44, v44, v138, v139
    v_max3_u32 v45, v45, v138, v139
    v_mfma_f32_16x16x32_f16 v[138:141], v[178:181], v[206:209], v[54:57]
    v_exp_f32 v214, v214
    v_mfma_f32_16x16x16_f16 v[230:233], v[196:197], v[194:195], v[230:233]
    buffer_store_dwordx4 v[146:149], v17, s[12:15], 0 offen nt
    v_exp_f32 v190, v190
    v_mfma_f32_16x16x16_f16 v[234:237], v[220:221], v[194:195], v[234:237]
    v_cvt_pk_bf16_f32 v39, v190, 0
    v_mfma_f32_16x16x16_f16 v[138:141], v[124:125], v[194:195], v[138:141]
    v_mfma_f32_16x16x32_bf16 v[222:225], v[154:157], a[184:187], v[222:225]
    v_mfma_f32_16x16x32_bf16 v[222:225], v[130:133], a[188:191], v[222:225]
    ds_read_b128 v[146:149], v2 offset:0
    v_mfma_f32_16x16x32_bf16 v[150:153], v[142:145], a[192:195], 0
    ds_read_b128 v[142:145], v2 offset:1024
    v_mfma_f32_16x16x32_bf16 v[150:153], v[162:165], a[196:199], v[150:153]
    ds_read_b128 v[206:209], v2 offset:2048
    v_mfma_f32_16x16x32_bf16 v[150:153], v[210:213], a[200:203], v[150:153]
    ds_read_b128 v[162:165], v2 offset:3072
    v_mfma_f32_16x16x32_bf16 v[150:153], v[134:137], a[204:207], v[150:153]
    ds_read_b128 v[134:137], v2 offset:4096
    v_cvt_pk_bf16_f32 v210, v222, v223
    v_mfma_f32_16x16x32_bf16 v[150:153], v[154:157], a[208:211], v[150:153]
    ds_read_b128 v[154:157], v2 offset:5120
    v_cvt_pk_bf16_f32 v211, v224, v225
    v_mfma_f32_16x16x32_bf16 v[150:153], v[130:133], a[212:215], v[150:153]
    ds_read2_b32 v[228:229], v6 offset0:0 offset1:0
    ds_read2_b32 v[212:213], v6 offset0:16 offset1:16
    v_mfma_f32_16x16x32_f16 v[130:133], v[166:169], v[186:189], v[26:29]
    ds_read2_b32 v[168:169], v6 offset0:32 offset1:32
    v_add_u32 v6, 272, v6
    v_mfma_f32_16x16x32_f16 v[130:133], v[126:129], v[178:181], v[130:133]
    s_waitcnt lgkmcnt(8)
    v_exp_f32 v230, v230
    v_mfma_f32_16x16x32_f16 v[130:133], v[198:201], v[122:125], v[130:133]
    s_waitcnt lgkmcnt(7)
    v_cvt_pk_bf16_f32 v166, v150, v151
    v_cvt_pk_bf16_f32 v167, v152, v153
    v_mfma_f32_16x16x32_bf16 v[150:153], a[216:219], v[146:149], 0
    s_waitcnt lgkmcnt(6)
    v_exp_f32 v231, v231
    v_mfma_f32_16x16x32_bf16 v[150:153], a[220:223], v[142:145], v[150:153]
    s_waitcnt lgkmcnt(5)
    v_exp_f32 v130, v130
    v_mfma_f32_16x16x32_bf16 v[150:153], a[224:227], v[206:209], v[150:153]
    s_waitcnt lgkmcnt(4)
    buffer_store_dwordx2 v[204:205], v20, s[12:15], 0 offen nt
    v_mov_b32_dpp v254, v131 quad_perm:[0,1,2,3] row_mask:0x4 bank_mask:0xf
    v_cvt_pk_bf16_f32 v126, v230, v231
    v_mfma_f32_16x16x32_bf16 v[150:153], a[228:231], v[162:165], v[150:153]
    s_waitcnt lgkmcnt(3)
    v_exp_f32 v254, v254
    v_mfma_f32_16x16x32_bf16 v[150:153], a[232:235], v[134:137], v[150:153]
    s_waitcnt lgkmcnt(1)
    v_exp_f32 v232, v232
    v_mfma_f32_16x16x32_bf16 v[150:153], a[236:239], v[154:157], v[150:153]
    s_waitcnt lgkmcnt(0)
    v_exp_f32 v233, v233
    v_mfma_f32_16x16x32_bf16 v[190:193], a[240:243], v[146:149], 0
    v_cvt_pk_bf16_f32 v254, v254, v254
    v_cvt_pk_bf16_f32 v127, v232, v233
    v_mfma_f32_16x16x32_bf16 v[190:193], a[244:247], v[142:145], v[190:193]
    ds_write_b16 v8, v254
    v_mfma_f32_16x16x32_bf16 v[190:193], a[248:251], v[206:209], v[190:193]
    v_exp_f32 v234, v234
    v_mfma_f32_16x16x32_bf16 v[190:193], a[252:255], v[162:165], v[190:193]
    ds_read_b128 v[198:201], v2 offset:6144
    ds_read_b128 v[230:233], v9
    v_mfma_f32_16x16x32_bf16 v[190:193], v[82:85], v[134:137], v[190:193]
    ds_read_b128 v[222:225], v2 offset:7168
    ds_read_b128 v[238:241], v9 offset:64
    v_mfma_f32_16x16x32_bf16 v[190:193], v[86:89], v[154:157], v[190:193]
    v_exp_f32 v235, v235
    v_mfma_f32_16x16x32_bf16 v[202:205], v[90:93], v[146:149], 0
    ds_read_b128 v[146:149], v2 offset:8192
    ds_read_b128 v[242:245], v2 offset:9216
    v_mfma_f32_16x16x32_bf16 v[202:205], v[94:97], v[142:145], v[202:205]
    v_cvt_pk_bf16_f32 v128, v234, v235
    v_fma_f32 v254, v150, v150, s33
    v_mfma_f32_16x16x32_bf16 v[202:205], v[98:101], v[206:209], v[202:205]
    ds_read_b128 v[206:209], v2 offset:10240
    ds_read_b128 v[246:249], v2 offset:11264
    v_mfma_f32_16x16x32_bf16 v[202:205], v[102:105], v[162:165], v[202:205]
    v_exp_f32 v236, v236
    v_mfma_f32_16x16x32_bf16 v[202:205], v[106:109], v[134:137], v[202:205]
    v_exp_f32 v237, v237
    v_mfma_f32_16x16x32_bf16 v[202:205], v[110:113], v[154:157], v[202:205]
    s_waitcnt lgkmcnt(6)
    v_cvt_pk_bf16_f32 v129, v236, v237
    v_fmac_f32 v254, v151, v151
    v_mfma_f32_16x16x32_bf16 v[142:145], v[230:233], v[28:31], 0
    s_waitcnt lgkmcnt(4)
    v_exp_f32 v138, v138
    v_mfma_f32_16x16x32_bf16 v[142:145], v[238:241], v[28:31], v[142:145]
    v_fmac_f32 v254, v152, v152
    v_mfma_f32_16x16x32_bf16 v[134:137], v[230:233], v[174:177], 0
    s_waitcnt lgkmcnt(2)
    v_exp_f32 v139, v139
    v_mfma_f32_16x16x32_bf16 v[134:137], v[238:241], v[226:229], v[134:137]
    v_cvt_pk_bf16_f32 v36, v138, v139
    v_fmac_f32 v254, v153, v153
    v_mfma_f32_16x16x32_bf16 v[154:157], v[230:233], v[182:185], 0
    s_waitcnt lgkmcnt(0)
    v_rcp_f32 v142, v142
    v_mfma_f32_16x16x32_bf16 v[154:157], v[238:241], v[210:213], v[154:157]
    v_exp_f32 v140, v140
    v_mfma_f32_16x16x32_bf16 v[162:165], v[230:233], v[114:117], 0
    v_mul_f32 v134, v134, v142
    v_fmac_f32 v254, v190, v190
    v_mfma_f32_16x16x32_bf16 v[162:165], v[238:241], v[166:169], v[162:165]
    v_exp_f32 v141, v141
    v_mfma_f32_16x16x32_f16 v[230:233], v[118:121], v[158:161], v[58:61]
    v_cvt_pk_bf16_f32 v37, v140, v141
    v_mul_f32_dpp v134, v154, v142 quad_perm:[0,1,2,3] row_mask:0x2 bank_mask:0xf
    v_mfma_f32_16x16x32_f16 v[138:141], v[170:173], v[158:161], v[62:65]
    v_fmac_f32 v254, v191, v191
    v_fmac_f32 v254, v192, v192
    v_mfma_f32_16x16x32_f16 v[154:157], v[178:181], v[158:161], v[66:69]
    v_mul_f32_dpp v134, v162, v142 quad_perm:[0,1,2,3] row_mask:0x4 bank_mask:0xf
    v_cvt_pk_bf16_f32 v134, v134, v134
    v_fmac_f32 v254, v193, v193
    v_mfma_f32_16x16x16_f16 v[230:233], v[196:197], v[218:219], v[230:233]
    v_fmac_f32 v254, v202, v202
    v_fmac_f32 v254, v203, v203
    v_fmac_f32 v254, v204, v204
    v_mfma_f32_16x16x16_f16 v[138:141], v[220:221], v[218:219], v[138:141]
    v_fmac_f32 v254, v205, v205
    v_mfma_f32_16x16x16_f16 v[154:157], v[124:125], v[218:219], v[154:157]
    ds_write_b16 v7, v134
    v_add_u32 v7, 16, v7
    v_mfma_f32_16x16x32_bf16 v[134:137], v[28:31], v[36:39], 0
    v_exp_f32 v230, v230
    v_mfma_f32_16x16x32_bf16 v[134:137], v[28:31], v[126:129], v[134:137]
    v_exp_f32 v231, v231
    v_mfma_f32_16x16x32_bf16 v[158:161], v[226:229], v[36:39], 0
    v_exp_f32 v232, v232
    v_mfma_f32_16x16x32_bf16 v[158:161], v[174:177], v[126:129], v[158:161]
    v_exp_f32 v233, v233
    v_mfma_f32_16x16x32_bf16 v[162:165], v[210:213], v[36:39], 0
    v_cvt_pk_bf16_f32 v230, v230, v231
    v_cvt_pk_bf16_f32 v231, v232, v233
    v_mfma_f32_16x16x32_bf16 v[162:165], v[182:185], v[126:129], v[162:165]
    v_exp_f32 v138, v138
    v_mfma_f32_16x16x32_bf16 v[234:237], v[166:169], v[36:39], 0
    v_exp_f32 v139, v139
    v_mfma_f32_16x16x32_bf16 v[234:237], v[114:117], v[126:129], v[234:237]
    v_cvt_pk_bf16_f32 v232, v138, v139
    v_cvt_pk_bf16_f32 v39, v214, 0
    v_mfma_f32_16x16x32_f16 v[126:129], v[118:121], v[186:189], v[70:73]
    v_exp_f32 v140, v140
    v_mfma_f32_16x16x32_f16 v[118:121], v[170:173], v[186:189], v[74:77]
    v_exp_f32 v141, v141
    v_mfma_f32_16x16x32_bf16 v[142:145], a[216:219], v[198:201], 0
    v_exp_f32 v154, v154
    v_mfma_f32_16x16x32_bf16 v[142:145], a[220:223], v[222:225], v[142:145]
    v_cvt_pk_bf16_f32 v233, v140, v141
    v_exp_f32 v155, v155
    v_mfma_f32_16x16x32_f16 v[138:141], v[178:181], v[186:189], v[78:81]
    v_cvt_pk_bf16_f32 v36, v154, v155
    v_exp_f32 v156, v156
    v_mfma_f32_16x16x16_f16 v[126:129], v[196:197], v[122:123], v[126:129]
    v_exp_f32 v157, v157
    v_mfma_f32_16x16x16_f16 v[118:121], v[220:221], v[122:123], v[118:121]
    v_cvt_pk_bf16_f32 v37, v156, v157
    v_rcp_f32 v134, v134
    v_mfma_f32_16x16x16_f16 v[138:141], v[124:125], v[122:123], v[138:141]
    v_mul_f32 v158, v134, v158
    v_mul_f32 v159, v134, v159
    v_cvt_pk_bf16_f32 v186, v158, v159
    v_mul_f32 v160, v134, v160
    v_mfma_f32_16x16x32_bf16 v[154:157], v[28:31], v[36:39], 0
    v_exp_f32 v126, v126
    v_mfma_f32_16x16x32_bf16 v[154:157], v[28:31], v[230:233], v[154:157]
    v_exp_f32 v127, v127
    v_mfma_f32_16x16x32_bf16 v[194:197], v[226:229], v[36:39], 0
    v_cvt_pk_bf16_f32 v170, v126, v127
    v_mul_f32 v161, v134, v161
    v_mfma_f32_16x16x32_bf16 v[194:197], v[174:177], v[230:233], v[194:197]
    v_exp_f32 v128, v128
    v_mfma_f32_16x16x32_bf16 v[122:125], v[210:213], v[36:39], 0
    v_exp_f32 v129, v129
    v_mfma_f32_16x16x32_bf16 v[122:125], v[182:185], v[230:233], v[122:125]
    v_cvt_pk_bf16_f32 v171, v128, v129
    v_cvt_pk_bf16_f32 v187, v160, v161
    v_mfma_f32_16x16x32_bf16 v[126:129], v[166:169], v[36:39], 0
    ds_write_b64 v3, v[186:187] offset:0
    v_mfma_f32_16x16x32_bf16 v[126:129], v[114:117], v[230:233], v[126:129]
    v_exp_f32 v118, v118
    v_mfma_f32_16x16x32_bf16 v[142:145], a[224:227], v[146:149], v[142:145]
    v_exp_f32 v119, v119
    v_mfma_f32_16x16x32_bf16 v[142:145], a[228:231], v[242:245], v[142:145]
    v_cvt_pk_bf16_f32 v172, v118, v119
    v_cvt_pk_bf16_f32 v39, v130, 0
    v_mfma_f32_16x16x32_bf16 v[142:145], a[232:235], v[206:209], v[142:145]
    v_exp_f32 v120, v120
    v_mfma_f32_16x16x32_bf16 v[142:145], a[236:239], v[246:249], v[142:145]
    v_exp_f32 v121, v121
    v_mfma_f32_16x16x32_bf16 v[158:161], a[240:243], v[198:201], 0
    v_cvt_pk_bf16_f32 v173, v120, v121
    v_mul_f32 v162, v134, v162
    v_mfma_f32_16x16x32_bf16 v[158:161], a[244:247], v[222:225], v[158:161]
    v_exp_f32 v138, v138
    v_mfma_f32_16x16x32_bf16 v[158:161], a[248:251], v[146:149], v[158:161]
    v_exp_f32 v139, v139
    v_mfma_f32_16x16x32_bf16 v[158:161], a[252:255], v[242:245], v[158:161]
    ds_read_b128 v[118:121], v2 offset:12288
    v_cvt_pk_bf16_f32 v36, v138, v139
    v_mfma_f32_16x16x32_bf16 v[158:161], v[82:85], v[206:209], v[158:161]
    ds_read_b128 v[130:133], v2 offset:13312
    v_fma_f32 v255, v142, v142, s33
    v_mfma_f32_16x16x32_bf16 v[158:161], v[86:89], v[246:249], v[158:161]
    ds_read_b128 v[218:221], v2 offset:14336
    v_fmac_f32 v255, v143, v143
    v_mfma_f32_16x16x32_bf16 v[178:181], v[90:93], v[198:201], 0
    ds_read_b128 v[198:201], v2 offset:15360
    v_fmac_f32 v255, v144, v144
    v_mfma_f32_16x16x32_bf16 v[178:181], v[94:97], v[222:225], v[178:181]
    ds_read_b128 v[222:225], v2 offset:16384
    v_fmac_f32 v255, v145, v145
    v_mfma_f32_16x16x32_bf16 v[178:181], v[98:101], v[146:149], v[178:181]
    ds_read_b128 v[230:233], v2 offset:17408
    v_fmac_f32 v255, v158, v158
    v_mfma_f32_16x16x32_bf16 v[178:181], v[102:105], v[242:245], v[178:181]
    v_exp_f32 v140, v140
    v_mfma_f32_16x16x32_bf16 v[178:181], v[106:109], v[206:209], v[178:181]
    v_exp_f32 v141, v141
    v_mfma_f32_16x16x32_bf16 v[178:181], v[110:113], v[246:249], v[178:181]
    s_waitcnt lgkmcnt(5)
    v_cvt_pk_bf16_f32 v37, v140, v141
    v_fmac_f32 v255, v159, v159
    v_mfma_f32_16x16x32_bf16 v[146:149], a[216:219], v[118:121], 0
    s_waitcnt lgkmcnt(4)
    v_fmac_f32 v255, v160, v160
    v_fmac_f32 v255, v161, v161
    v_mfma_f32_16x16x32_bf16 v[242:245], v[28:31], v[36:39], 0
    s_waitcnt lgkmcnt(3)
    v_fmac_f32 v255, v178, v178
    v_fmac_f32 v255, v179, v179
    v_mfma_f32_16x16x32_bf16 v[242:245], v[28:31], v[170:173], v[242:245]
    s_waitcnt lgkmcnt(2)
    v_fmac_f32 v255, v180, v180
    v_fmac_f32 v255, v181, v181
    v_mfma_f32_16x16x32_bf16 v[206:209], v[226:229], v[36:39], 0
    s_waitcnt lgkmcnt(1)
    v_cvt_pk_bf16_f32 v254, v254, v255
    v_mul_f32 v163, v134, v163
    v_mfma_f32_16x16x32_bf16 v[206:209], v[174:177], v[170:173], v[206:209]
    s_waitcnt lgkmcnt(0)
    v_cvt_pk_bf16_f32 v188, v162, v163
    v_mul_f32 v164, v134, v164
    v_mfma_f32_16x16x32_bf16 v[174:177], v[210:213], v[36:39], 0
    v_mul_f32 v165, v134, v165
    v_cvt_pk_bf16_f32 v189, v164, v165
    v_mfma_f32_16x16x32_bf16 v[174:177], v[182:185], v[170:173], v[174:177]
    ds_write_b64 v3, v[188:189] offset:8
    v_mfma_f32_16x16x32_bf16 v[182:185], v[166:169], v[36:39], 0
    v_mul_f32 v234, v134, v234
    v_mul_f32 v235, v134, v235
    v_mfma_f32_16x16x32_bf16 v[182:185], v[114:117], v[170:173], v[182:185]
    v_cvt_pk_bf16_f32 v234, v234, v235
    v_mul_f32 v236, v134, v236
    v_mfma_f32_16x16x32_bf16 v[146:149], a[220:223], v[130:133], v[146:149]
    v_mul_f32 v237, v134, v237
    v_cvt_pk_bf16_f32 v235, v236, v237
    v_mfma_f32_16x16x32_bf16 v[146:149], a[224:227], v[218:221], v[146:149]
    ds_write_b64 v4, v[234:235] offset:4096
    v_mfma_f32_16x16x32_bf16 v[146:149], a[228:231], v[198:201], v[146:149]
    v_rcp_f32 v154, v154
    v_mfma_f32_16x16x32_bf16 v[146:149], a[232:235], v[222:225], v[146:149]
    v_mul_f32 v194, v154, v194
    v_mul_f32 v195, v154, v195
    v_mfma_f32_16x16x32_bf16 v[146:149], a[236:239], v[230:233], v[146:149]
    v_cvt_pk_bf16_f32 v194, v194, v195
    v_mul_f32 v196, v154, v196
    v_mfma_f32_16x16x32_bf16 v[138:141], a[240:243], v[118:121], 0
    v_mul_f32 v197, v154, v197
    v_cvt_pk_bf16_f32 v195, v196, v197
    v_mfma_f32_16x16x32_bf16 v[138:141], a[244:247], v[130:133], v[138:141]
    ds_write_b64 v3, v[194:195] offset:6144
    v_mfma_f32_16x16x32_bf16 v[138:141], a[248:251], v[218:221], v[138:141]
    v_fma_f32 v255, v146, v146, s33
    v_fmac_f32 v255, v147, v147
    v_mfma_f32_16x16x32_bf16 v[138:141], a[252:255], v[198:201], v[138:141]
    ds_read_b128 v[170:173], v0 offset:20480
    v_fmac_f32 v255, v148, v148
    v_mfma_f32_16x16x32_bf16 v[138:141], v[82:85], v[222:225], v[138:141]
    ds_read_b128 v[166:169], v1 offset:20480
    v_fmac_f32 v255, v149, v149
    v_mfma_f32_16x16x32_bf16 v[138:141], v[86:89], v[230:233], v[138:141]
    ds_read_b128 v[162:165], v0 offset:20608
    v_mul_f32 v122, v154, v122
    v_mfma_f32_16x16x32_bf16 v[186:189], v[90:93], v[118:121], 0
    ds_read_b128 v[210:213], v1 offset:20608
    v_mul_f32 v123, v154, v123
    v_mfma_f32_16x16x32_bf16 v[186:189], v[94:97], v[130:133], v[186:189]
    ds_read_b128 v[226:229], v0 offset:20736
    v_cvt_pk_bf16_f32 v196, v122, v123
    v_mfma_f32_16x16x32_bf16 v[186:189], v[98:101], v[218:221], v[186:189]
    ds_read_b128 v[218:221], v1 offset:20736
    v_fmac_f32 v255, v138, v138
    v_mfma_f32_16x16x32_bf16 v[186:189], v[102:105], v[198:201], v[186:189]
    v_fmac_f32 v255, v139, v139
    v_fmac_f32 v255, v140, v140
    v_mfma_f32_16x16x32_bf16 v[186:189], v[106:109], v[222:225], v[186:189]
    v_fmac_f32 v255, v141, v141
    v_mul_f32 v124, v154, v124
    v_mfma_f32_16x16x32_bf16 v[186:189], v[110:113], v[230:233], v[186:189]
    s_waitcnt lgkmcnt(5)
    v_mul_f32 v125, v154, v125
    v_cvt_pk_bf16_f32 v197, v124, v125
    v_mfma_f32_16x16x32_bf16 v[118:121], a[72:75], v[170:173], 0
    s_waitcnt lgkmcnt(4)
    ds_write_b64 v3, v[196:197] offset:6152
    v_mfma_f32_16x16x32_bf16 v[118:121], a[76:79], v[166:169], v[118:121]
    s_waitcnt lgkmcnt(4)
    v_fmac_f32 v255, v186, v186
    v_fmac_f32 v255, v187, v187
    v_mfma_f32_16x16x32_bf16 v[118:121], a[80:83], v[162:165], v[118:121]
    s_waitcnt lgkmcnt(3)
    v_fmac_f32 v255, v188, v188
    v_fmac_f32 v255, v189, v189
    v_mfma_f32_16x16x32_bf16 v[118:121], a[84:87], v[210:213], v[118:121]
    s_waitcnt lgkmcnt(2)
    v_cvt_pk_bf16_f32 v255, v255, v255
    v_mul_f32 v126, v154, v126
    v_mfma_f32_16x16x32_bf16 v[118:121], a[88:91], v[226:229], v[118:121]
    s_waitcnt lgkmcnt(1)
    ds_write_b64 v4, v[254:255] offset:18432
    v_mfma_f32_16x16x32_bf16 v[118:121], a[92:95], v[218:221], v[118:121]
    v_mul_f32 v127, v154, v127
    v_cvt_pk_bf16_f32 v254, v126, v127
    v_mfma_f32_16x16x32_bf16 v[194:197], a[96:99], v[170:173], 0
    v_mul_f32 v128, v154, v128
    v_mul_f32 v129, v154, v129
    v_mfma_f32_16x16x32_bf16 v[194:197], a[100:103], v[166:169], v[194:197]
    v_cvt_pk_bf16_f32 v255, v128, v129
    v_xor_b32 v2, 65536, v2
    v_mfma_f32_16x16x32_bf16 v[194:197], a[104:107], v[162:165], v[194:197]
    ds_write_b64 v4, v[254:255] offset:10240
    v_mfma_f32_16x16x32_bf16 v[194:197], a[108:111], v[210:213], v[194:197]
    v_cvt_pk_f16_f32 v118, v118, v119
    v_pk_mul_f16 v223, v118, v118
    v_mfma_f32_16x16x32_bf16 v[194:197], a[112:115], v[226:229], v[194:197]
    v_cvt_pk_f16_f32 v119, v120, v121
    v_pk_mul_f16 v225, v119, v119
    v_mfma_f32_16x16x32_bf16 v[194:197], a[116:119], v[218:221], v[194:197]
    v_rcp_f32 v242, v242
    v_mfma_f32_16x16x32_bf16 v[114:117], a[120:123], v[170:173], 0
    v_mul_f32 v206, v242, v206
    v_mul_f32 v207, v242, v207
    v_mfma_f32_16x16x32_bf16 v[114:117], a[124:127], v[166:169], v[114:117]
    v_cvt_pk_bf16_f32 v206, v206, v207
    v_mul_f32 v208, v242, v208
    v_mfma_f32_16x16x32_bf16 v[114:117], a[128:131], v[162:165], v[114:117]
    v_cvt_pk_f16_f32 v120, v194, v195
    v_pk_fma_f16 v223, v120, v120, v223
    v_mfma_f32_16x16x32_bf16 v[114:117], a[132:135], v[210:213], v[114:117]
    v_cvt_pk_f16_f32 v121, v196, v197
    v_pk_fma_f16 v225, v121, v121, v225
    v_mfma_f32_16x16x32_bf16 v[114:117], a[136:139], v[226:229], v[114:117]
    v_mul_f32 v209, v242, v209
    v_cvt_pk_bf16_f32 v207, v208, v209
    v_mfma_f32_16x16x32_bf16 v[114:117], a[140:143], v[218:221], v[114:117]
    ds_write_b64 v3, v[206:207] offset:12288
    v_mfma_f32_16x16x32_bf16 v[154:157], a[0:3], v[170:173], 0
    v_mul_f32 v174, v242, v174
    v_mul_f32 v175, v242, v175
    v_mfma_f32_16x16x32_bf16 v[154:157], a[4:7], v[166:169], v[154:157]
    v_cvt_pk_bf16_f32 v208, v174, v175
    v_mul_f32 v176, v242, v176
    v_mfma_f32_16x16x32_bf16 v[154:157], a[8:11], v[162:165], v[154:157]
    v_cvt_pk_f16_f32 v196, v114, v115
    v_pk_fma_f16 v223, v196, v196, v223
    v_mfma_f32_16x16x32_bf16 v[154:157], a[12:15], v[210:213], v[154:157]
    v_cvt_pk_f16_f32 v197, v116, v117
    v_pk_fma_f16 v225, v197, v197, v225
    v_mfma_f32_16x16x32_bf16 v[154:157], a[16:19], v[226:229], v[154:157]
    v_mul_f32 v177, v242, v177
    v_cvt_pk_bf16_f32 v209, v176, v177
    v_mfma_f32_16x16x32_bf16 v[154:157], a[20:23], v[218:221], v[154:157]
    ds_write_b64 v3, v[208:209] offset:12296
    v_mfma_f32_16x16x32_bf16 v[174:177], a[24:27], v[170:173], 0
    v_mul_f32 v182, v242, v182
    v_mul_f32 v183, v242, v183
    v_mfma_f32_16x16x32_bf16 v[174:177], a[28:31], v[166:169], v[174:177]
    v_cvt_pk_bf16_f32 v194, v182, v183
    v_mul_f32 v184, v242, v184
    v_mfma_f32_16x16x32_bf16 v[174:177], a[32:35], v[162:165], v[174:177]
    v_cvt_pk_f16_f32 v206, v154, v155
    v_mul_f32 v185, v242, v185
    v_mfma_f32_16x16x32_bf16 v[174:177], a[36:39], v[210:213], v[174:177]
    v_cvt_pk_bf16_f32 v195, v184, v185
    v_xor_b32 v3, 65536, v3
    v_mfma_f32_16x16x32_bf16 v[174:177], a[40:43], v[226:229], v[174:177]
    ds_write_b64 v4, v[194:195] offset:16384
    v_mfma_f32_16x16x32_bf16 v[174:177], a[44:47], v[218:221], v[174:177]
    v_xor_b32 v4, 65536, v4
    v_mfma_f32_16x16x32_bf16 v[182:185], a[48:51], v[170:173], 0
    v_mfma_f32_16x16x32_bf16 v[182:185], a[52:55], v[166:169], v[182:185]
    v_mfma_f32_16x16x32_bf16 v[182:185], a[56:59], v[162:165], v[182:185]
    v_mfma_f32_16x16x32_bf16 v[182:185], a[60:63], v[210:213], v[182:185]
    v_mfma_f32_16x16x32_bf16 v[182:185], a[64:67], v[226:229], v[182:185]
    v_mfma_f32_16x16x32_bf16 v[182:185], a[68:71], v[218:221], v[182:185]
    v_mfma_f32_16x16x32_bf16 v[230:233], v[170:173], a[144:147], 0
    s_waitcnt lgkmcnt(0)
    v_mfma_f32_16x16x32_bf16 v[230:233], v[166:169], a[148:151], v[230:233]
    s_nop 0
    v_mfma_f32_16x16x32_bf16 v[230:233], v[162:165], a[152:155], v[230:233]
    s_nop 0
    v_mfma_f32_16x16x32_bf16 v[230:233], v[210:213], a[156:159], v[230:233]
    s_barrier
    v_mfma_f32_16x16x32_bf16 v[230:233], v[226:229], a[160:163], v[230:233]
    s_nop 0
    v_mfma_f32_16x16x32_bf16 v[230:233], v[218:221], a[164:167], v[230:233]
    s_cbranch_scc1 L_loop_fast2
    s_branch L_final_fast
.p2align 6
L_loop_fast3:
    v_mfma_f32_16x16x32_bf16 v[234:237], v[170:173], a[168:171], 0
    s_add_u32 s12, s42, s27
    ds_read_b128 v[242:245], v2 offset:18432
    ds_read_b128 v[246:249], v2 offset:19456
    v_mfma_f32_16x16x32_bf16 v[234:237], v[166:169], a[172:175], v[234:237]
    s_addc_u32 s13, s43, 0
    v_pk_mul_f16 v222, v206, v206
    v_cvt_pk_f16_f32 v207, v156, v157
    v_mfma_f32_16x16x32_bf16 v[234:237], v[162:165], a[176:179], v[234:237]
    s_sub_u32 s14, s36, s27
    v_pk_mul_f16 v224, v207, v207
    v_cvt_pk_f16_f32 v208, v174, v175
    v_mfma_f32_16x16x32_bf16 v[234:237], v[210:213], a[180:183], v[234:237]
    s_cmp_ge_u32 s18, 2
    ds_read_b128 v[134:137], v0 offset:26624
    v_pk_fma_f16 v222, v208, v208, v222
    v_mfma_f32_16x16x32_bf16 v[234:237], v[226:229], a[184:187], v[234:237]
    s_cselect_b32 s14, s14, 0
    ds_read_b128 v[154:157], v1 offset:26624
    v_cvt_pk_f16_f32 v209, v176, v177
    v_mfma_f32_16x16x32_bf16 v[234:237], v[218:221], a[188:191], v[234:237]
    s_add_u32 s34, s18, 2
    ds_read_b128 v[130:133], v0 offset:26752
    v_pk_fma_f16 v224, v209, v209, v224
    v_mfma_f32_16x16x32_bf16 v[114:117], v[170:173], a[192:195], 0
    s_add_u32 s8, s40, s23
    ds_read_b128 v[122:125], v1 offset:26752
    v_cvt_pk_f16_f32 v194, v182, v183
    v_mfma_f32_16x16x32_bf16 v[114:117], v[166:169], a[196:199], v[114:117]
    s_addc_u32 s9, s41, 0
    ds_read_b128 v[126:129], v0 offset:26880
    v_pk_fma_f16 v222, v194, v194, v222
    v_mfma_f32_16x16x32_bf16 v[114:117], v[162:165], a[200:203], v[114:117]
    s_waitcnt lgkmcnt(5)
    ds_read_b128 v[166:169], v1 offset:26880
    v_cvt_pk_f16_f32 v195, v184, v185
    v_mfma_f32_16x16x32_bf16 v[198:201], v[32:35], v[242:245], 0
    s_sub_u32 s10, s36, s23
    v_pk_fma_f16 v224, v195, v195, v224
    v_cvt_pk_bf16_f32 v174, v230, v231
    v_mfma_f32_16x16x32_bf16 v[198:201], v[32:35], v[246:249], v[198:201]
    s_cmp_lt_u32 s34, s17
    v_cvt_pk_bf16_f32 v175, v232, v233
    v_cvt_pk_bf16_f32 v182, v234, v235
    v_mfma_f32_16x16x32_f16 v[170:173], v[40:43], v[222:225], 0
    s_waitcnt lgkmcnt(5)
    v_cvt_pk_bf16_f32 v183, v236, v237
    s_cselect_b32 s10, s10, 0
    v_mfma_f32_16x16x32_bf16 v[114:117], v[210:213], a[204:207], v[114:117]
    s_add_u32 m0, s28, 0
    v_mul_f32 v255, 0x3baaaaab, v198
    v_mul_f32 v254, 0x3baaaaab, v199
    v_mfma_f32_16x16x32_bf16 v[114:117], v[226:229], a[208:211], v[114:117]
    s_mov_b32 s27, s26
    v_rsq_f32 v172, v170
    v_mfma_f32_16x16x32_bf16 v[114:117], v[218:221], a[212:215], v[114:117]
    s_mov_b32 s26, s25
    v_rsq_f32 v173, v171
    v_mfma_f32_16x16x32_bf16 v[162:165], a[72:75], v[134:137], 0
    s_waitcnt lgkmcnt(1)
    v_mul_f32 v172, s31, v172
    v_cvt_pk_f16_f32 v172, v172, v173
    v_mfma_f32_16x16x32_bf16 v[162:165], a[76:79], v[154:157], v[162:165]
    s_mov_b32 s25, s24
    v_cvt_pk_bf16_f32 v114, v114, v115
    v_cvt_pk_bf16_f32 v115, v116, v117
    v_mfma_f32_16x16x32_bf16 v[162:165], a[80:83], v[130:133], v[162:165]
    s_mov_b32 s24, s23
    v_pk_mul_f16 v118, v118, v172 op_sel:[0,1] op_sel_hi:[1,1]
    v_pk_mul_f16 v119, v119, v172 op_sel:[0,1] op_sel_hi:[1,1]
    v_mfma_f32_16x16x32_bf16 v[162:165], a[84:87], v[122:125], v[162:165]
    s_waitcnt lgkmcnt(0)
    v_pk_mul_f16 v120, v120, v172 op_sel:[0,1] op_sel_hi:[1,1]
    v_pk_mul_f16 v121, v121, v172 op_sel:[0,1] op_sel_hi:[1,1]
    v_mfma_f32_16x16x32_bf16 v[162:165], a[88:91], v[126:129], v[162:165]
    v_pk_mul_f16 v196, v196, v172 op_sel:[0,1] op_sel_hi:[1,1]
    v_pk_mul_f16 v197, v197, v172 op_sel:[0,1] op_sel_hi:[1,1]
    v_mfma_f32_16x16x32_bf16 v[162:165], a[92:95], v[166:169], v[162:165]
    v_pk_mul_f16 v206, v206, v172 op_sel:[0,0] op_sel_hi:[1,0]
    v_pk_mul_f16 v207, v207, v172 op_sel:[0,0] op_sel_hi:[1,0]
    v_mfma_f32_16x16x32_bf16 v[210:213], a[96:99], v[134:137], 0
    v_pk_mul_f16 v208, v208, v172 op_sel:[0,0] op_sel_hi:[1,0]
    v_pk_mul_f16 v209, v209, v172 op_sel:[0,0] op_sel_hi:[1,0]
    v_mfma_f32_16x16x32_bf16 v[210:213], a[100:103], v[154:157], v[210:213]
    v_pk_mul_f16 v194, v194, v172 op_sel:[0,0] op_sel_hi:[1,0]
    v_pk_mul_f16 v195, v195, v172 op_sel:[0,0] op_sel_hi:[1,0]
    v_mfma_f32_16x16x32_bf16 v[210:213], a[104:107], v[130:133], v[210:213]
    v_min3_u32 v44, v44, v170, v171
    v_max3_u32 v45, v45, v170, v171
    v_mfma_f32_16x16x32_bf16 v[210:213], a[108:111], v[122:125], v[210:213]
    v_cvt_pk_f16_f32 v170, v162, v163
    v_pk_mul_f16 v163, v170, v170
    v_mfma_f32_16x16x32_bf16 v[210:213], a[112:115], v[126:129], v[210:213]
    v_cvt_pk_f16_f32 v171, v164, v165
    v_pk_mul_f16 v165, v171, v171
    v_mfma_f32_16x16x32_bf16 v[210:213], a[116:119], v[166:169], v[210:213]
    v_rsq_f32 v255, v255
    v_mfma_f32_16x16x32_bf16 v[214:217], a[120:123], v[134:137], 0
    v_rsq_f32 v254, v254
    v_mfma_f32_16x16x32_bf16 v[214:217], a[124:127], v[154:157], v[214:217]
    v_mul_f32 v142, v254, v142
    v_mul_f32 v143, v254, v143
    v_mfma_f32_16x16x32_bf16 v[214:217], a[128:131], v[130:133], v[214:217]
    v_cvt_pk_bf16_f32 v142, v142, v143
    v_cvt_pk_f16_f32 v172, v210, v211
    v_mfma_f32_16x16x32_bf16 v[214:217], a[132:135], v[122:125], v[214:217]
    v_pk_fma_f16 v163, v172, v172, v163
    v_cvt_pk_f16_f32 v173, v212, v213
    v_mfma_f32_16x16x32_bf16 v[214:217], a[136:139], v[126:129], v[214:217]
    v_pk_fma_f16 v165, v173, v173, v165
    v_mul_f32 v144, v254, v144
    v_mfma_f32_16x16x32_bf16 v[214:217], a[140:143], v[166:169], v[214:217]
    v_mul_f32 v145, v254, v145
    v_cvt_pk_bf16_f32 v143, v144, v145
    v_mfma_f32_16x16x32_bf16 v[210:213], a[0:3], v[134:137], 0
    v_mul_f32 v158, v254, v158
    v_mul_f32 v159, v254, v159
    v_mfma_f32_16x16x32_bf16 v[210:213], a[4:7], v[154:157], v[210:213]
    v_cvt_pk_bf16_f32 v144, v158, v159
    v_mul_f32 v160, v254, v160
    v_mfma_f32_16x16x32_bf16 v[210:213], a[8:11], v[130:133], v[210:213]
    v_cvt_pk_f16_f32 v220, v214, v215
    v_pk_fma_f16 v163, v220, v220, v163
    v_mfma_f32_16x16x32_bf16 v[210:213], a[12:15], v[122:125], v[210:213]
    v_cvt_pk_f16_f32 v221, v216, v217
    v_pk_fma_f16 v165, v221, v221, v165
    v_mfma_f32_16x16x32_bf16 v[210:213], a[16:19], v[126:129], v[210:213]
    v_mul_f32 v161, v254, v161
    v_cvt_pk_bf16_f32 v145, v160, v161
    v_mfma_f32_16x16x32_bf16 v[210:213], a[20:23], v[166:169], v[210:213]
    buffer_store_dwordx4 v[142:145], v16, s[12:15], 0 offen nt
    v_mul_f32 v178, v254, v178
    v_mul_f32 v179, v254, v179
    v_cvt_pk_bf16_f32 v116, v178, v179
    v_mul_f32 v180, v254, v180
    v_mfma_f32_16x16x32_bf16 v[142:145], a[24:27], v[134:137], 0
    v_mul_f32 v181, v254, v181
    v_cvt_pk_bf16_f32 v117, v180, v181
    v_mfma_f32_16x16x32_bf16 v[142:145], a[28:31], v[154:157], v[142:145]
    v_cvt_pk_f16_f32 v158, v210, v211
    v_pk_mul_f16 v162, v158, v158
    v_mfma_f32_16x16x32_bf16 v[142:145], a[32:35], v[130:133], v[142:145]
    v_cvt_pk_f16_f32 v159, v212, v213
    v_pk_mul_f16 v164, v159, v159
    v_mfma_f32_16x16x32_bf16 v[142:145], a[36:39], v[122:125], v[142:145]
    v_mul_f32 v254, 0x3baaaaab, v200
    v_mul_f32 v150, v255, v150
    v_mfma_f32_16x16x32_bf16 v[142:145], a[40:43], v[126:129], v[142:145]
    v_rsq_f32 v254, v254
    v_mfma_f32_16x16x32_bf16 v[142:145], a[44:47], v[166:169], v[142:145]
    v_mul_f32 v151, v255, v151
    v_cvt_pk_bf16_f32 v150, v150, v151
    v_mfma_f32_16x16x32_bf16 v[178:181], a[48:51], v[134:137], 0
    v_mul_f32 v152, v255, v152
    v_mul_f32 v153, v255, v153
    v_mfma_f32_16x16x32_bf16 v[178:181], a[52:55], v[154:157], v[178:181]
    v_cvt_pk_bf16_f32 v151, v152, v153
    v_mul_f32 v190, v255, v190
    v_mfma_f32_16x16x32_bf16 v[178:181], a[56:59], v[130:133], v[178:181]
    v_cvt_pk_f16_f32 v160, v142, v143
    v_pk_fma_f16 v162, v160, v160, v162
    v_mfma_f32_16x16x32_bf16 v[178:181], a[60:63], v[122:125], v[178:181]
    v_cvt_pk_f16_f32 v161, v144, v145
    v_pk_fma_f16 v164, v161, v161, v164
    v_mfma_f32_16x16x32_bf16 v[178:181], a[64:67], v[126:129], v[178:181]
    v_mul_f32 v191, v255, v191
    v_cvt_pk_bf16_f32 v152, v190, v191
    v_mfma_f32_16x16x32_bf16 v[178:181], a[68:71], v[166:169], v[178:181]
    v_mul_f32 v192, v255, v192
    v_mul_f32 v193, v255, v193
    v_mfma_f32_16x16x32_bf16 v[142:145], v[134:137], a[144:147], 0
    v_cvt_pk_bf16_f32 v153, v192, v193
    v_mul_f32 v202, v255, v202
    v_mfma_f32_16x16x32_bf16 v[142:145], v[154:157], a[148:151], v[142:145]
    v_mul_f32 v203, v255, v203
    v_cvt_pk_bf16_f32 v202, v202, v203
    v_mfma_f32_16x16x32_bf16 v[142:145], v[130:133], a[152:155], v[142:145]
    v_cvt_pk_f16_f32 v218, v178, v179
    v_pk_fma_f16 v162, v218, v218, v162
    v_mfma_f32_16x16x32_bf16 v[142:145], v[122:125], a[156:159], v[142:145]
    v_cvt_pk_f16_f32 v219, v180, v181
    v_pk_fma_f16 v164, v219, v219, v164
    v_mfma_f32_16x16x32_bf16 v[142:145], v[126:129], a[160:163], v[142:145]
    buffer_store_dwordx2 v[116:117], v19, s[12:15], 0 offen nt
    v_mul_f32 v204, v255, v204
    v_mul_f32 v205, v255, v205
    v_mfma_f32_16x16x32_f16 v[190:193], v[40:43], v[162:165], 0
    v_cvt_pk_bf16_f32 v203, v204, v205
    v_mul_f32 v146, v254, v146
    v_mfma_f32_16x16x32_bf16 v[142:145], v[166:169], a[164:167], v[142:145]
    v_mul_f32 v147, v254, v147
    v_cvt_pk_bf16_f32 v146, v146, v147
    v_mfma_f32_16x16x32_bf16 v[178:181], v[134:137], a[168:171], 0
    v_mul_f32 v148, v254, v148
    v_mul_f32 v149, v254, v149
    v_mfma_f32_16x16x32_bf16 v[178:181], v[154:157], a[172:175], v[178:181]
    v_rsq_f32 v192, v190
    v_mfma_f32_16x16x32_bf16 v[178:181], v[130:133], a[176:179], v[178:181]
    v_cvt_pk_bf16_f32 v176, v142, v143
    v_cvt_pk_bf16_f32 v177, v144, v145
    v_mfma_f32_16x16x32_bf16 v[178:181], v[122:125], a[180:183], v[178:181]
    ds_read_b128 v[142:145], v0 offset:32768
    v_mul_f32 v192, s31, v192
    v_mfma_f32_16x16x32_bf16 v[178:181], v[126:129], a[184:187], v[178:181]
    ds_read_b128 v[162:165], v1 offset:32768
    v_min3_u32 v44, v44, v190, v191
    v_mfma_f32_16x16x32_bf16 v[178:181], v[166:169], a[188:191], v[178:181]
    ds_read_b128 v[210:213], v0 offset:32896
    v_max3_u32 v45, v45, v190, v191
    v_mfma_f32_16x16x32_bf16 v[198:201], v[134:137], a[192:195], 0
    ds_read_b128 v[134:137], v1 offset:32896
    v_cvt_pk_bf16_f32 v147, v148, v149
    v_mfma_f32_16x16x32_bf16 v[198:201], v[154:157], a[196:199], v[198:201]
    ds_read_b128 v[154:157], v0 offset:33024
    v_mul_f32 v138, v254, v138
    v_mfma_f32_16x16x32_bf16 v[198:201], v[130:133], a[200:203], v[198:201]
    ds_read_b128 v[130:133], v1 offset:33024
    v_cvt_pk_bf16_f32 v184, v178, v179
    v_mfma_f32_16x16x32_bf16 v[198:201], v[122:125], a[204:207], v[198:201]
    v_rsq_f32 v193, v191
    v_mfma_f32_16x16x32_bf16 v[198:201], v[126:129], a[208:211], v[198:201]
    v_cvt_pk_f16_f32 v192, v192, v193
    v_cvt_pk_bf16_f32 v185, v180, v181
    v_mfma_f32_16x16x32_bf16 v[198:201], v[166:169], a[212:215], v[198:201]
    s_waitcnt lgkmcnt(5)
    v_pk_mul_f16 v170, v170, v192 op_sel:[0,1] op_sel_hi:[1,1]
    v_pk_mul_f16 v171, v171, v192 op_sel:[0,1] op_sel_hi:[1,1]
    v_mfma_f32_16x16x32_bf16 v[178:181], a[72:75], v[142:145], 0
    s_waitcnt lgkmcnt(4)
    v_pk_mul_f16 v172, v172, v192 op_sel:[0,1] op_sel_hi:[1,1]
    v_pk_mul_f16 v173, v173, v192 op_sel:[0,1] op_sel_hi:[1,1]
    v_mfma_f32_16x16x32_bf16 v[178:181], a[76:79], v[162:165], v[178:181]
    s_waitcnt lgkmcnt(3)
    v_cvt_pk_bf16_f32 v116, v198, v199
    v_cvt_pk_bf16_f32 v117, v200, v201
    v_mfma_f32_16x16x32_bf16 v[178:181], a[80:83], v[210:213], v[178:181]
    s_waitcnt lgkmcnt(2)
    buffer_store_dwordx4 v[150:153], v15, s[12:15], 0 offen nt
    v_pk_mul_f16 v220, v220, v192 op_sel:[0,1] op_sel_hi:[1,1]
    v_pk_mul_f16 v221, v221, v192 op_sel:[0,1] op_sel_hi:[1,1]
    v_pk_mul_f16 v158, v158, v192 op_sel:[0,0] op_sel_hi:[1,0]
    v_pk_mul_f16 v159, v159, v192 op_sel:[0,0] op_sel_hi:[1,0]
    v_mfma_f32_16x16x32_bf16 v[178:181], a[84:87], v[134:137], v[178:181]
    s_waitcnt lgkmcnt(0)
    v_pk_mul_f16 v160, v160, v192 op_sel:[0,0] op_sel_hi:[1,0]
    v_pk_mul_f16 v161, v161, v192 op_sel:[0,0] op_sel_hi:[1,0]
    v_mfma_f32_16x16x32_bf16 v[178:181], a[88:91], v[154:157], v[178:181]
    v_pk_mul_f16 v218, v218, v192 op_sel:[0,0] op_sel_hi:[1,0]
    v_pk_mul_f16 v219, v219, v192 op_sel:[0,0] op_sel_hi:[1,0]
    v_mfma_f32_16x16x32_bf16 v[178:181], a[92:95], v[130:133], v[178:181]
    v_mul_f32 v139, v254, v139
    v_cvt_pk_bf16_f32 v148, v138, v139
    v_mfma_f32_16x16x32_bf16 v[150:153], a[96:99], v[142:145], 0
    v_mul_f32 v140, v254, v140
    v_mul_f32 v141, v254, v141
    v_mfma_f32_16x16x32_bf16 v[150:153], a[100:103], v[162:165], v[150:153]
    v_cvt_pk_bf16_f32 v149, v140, v141
    v_mul_f32 v186, v254, v186
    v_mfma_f32_16x16x32_bf16 v[150:153], a[104:107], v[210:213], v[150:153]
    v_cvt_pk_f16_f32 v178, v178, v179
    v_pk_mul_f16 v191, v178, v178
    v_mfma_f32_16x16x32_bf16 v[150:153], a[108:111], v[134:137], v[150:153]
    v_cvt_pk_f16_f32 v179, v180, v181
    v_pk_mul_f16 v193, v179, v179
    v_mfma_f32_16x16x32_bf16 v[150:153], a[112:115], v[154:157], v[150:153]
    v_mul_f32 v187, v254, v187
    v_cvt_pk_bf16_f32 v204, v186, v187
    v_mfma_f32_16x16x32_bf16 v[150:153], a[116:119], v[130:133], v[150:153]
    v_mul_f32 v188, v254, v188
    v_mul_f32 v189, v254, v189
    v_mfma_f32_16x16x32_bf16 v[138:141], a[120:123], v[142:145], 0
    s_waitcnt vmcnt(3)
    v_cvt_pk_bf16_f32 v205, v188, v189
    v_xor_b32 v0, 65536, v0
    v_mfma_f32_16x16x32_bf16 v[138:141], a[124:127], v[162:165], v[138:141]
    v_mfma_f32_16x16x32_bf16 v[138:141], a[128:131], v[210:213], v[138:141]
    v_mfma_f32_16x16x32_bf16 v[138:141], a[132:135], v[134:137], v[138:141]
    v_mfma_f32_16x16x32_bf16 v[138:141], a[136:139], v[154:157], v[138:141]
    s_barrier
    v_mfma_f32_16x16x32_bf16 v[138:141], a[140:143], v[130:133], v[138:141]
    v_cvt_pk_f16_f32 v180, v150, v151
    v_pk_fma_f16 v191, v180, v180, v191
    v_mfma_f32_16x16x32_bf16 v[186:189], a[0:3], v[142:145], 0
    v_cvt_pk_f16_f32 v181, v152, v153
    v_pk_fma_f16 v193, v181, v181, v193
    v_mfma_f32_16x16x32_bf16 v[186:189], a[4:7], v[162:165], v[186:189]
    buffer_load_dwordx4 v10, s[8:11], 0 offen nt lds
    v_xor_b32 v1, 65536, v1
    v_mfma_f32_16x16x32_bf16 v[186:189], a[8:11], v[210:213], v[186:189]
    s_add_u32 m0, s28, 4096
    v_cvt_pk_f16_f32 v124, v138, v139
    v_pk_fma_f16 v191, v124, v124, v191
    v_mfma_f32_16x16x32_bf16 v[186:189], a[12:15], v[134:137], v[186:189]
    v_cvt_pk_f16_f32 v125, v140, v141
    v_pk_fma_f16 v193, v125, v125, v193
    v_mfma_f32_16x16x32_bf16 v[186:189], a[16:19], v[154:157], v[186:189]
    v_mfma_f32_16x16x32_bf16 v[186:189], a[20:23], v[130:133], v[186:189]
    v_mfma_f32_16x16x32_bf16 v[150:153], a[24:27], v[142:145], 0
    buffer_load_dwordx4 v11, s[8:11], 0 offen nt lds
    s_add_u32 m0, s28, 8192
    v_mfma_f32_16x16x32_bf16 v[150:153], a[28:31], v[162:165], v[150:153]
    v_mfma_f32_16x16x32_bf16 v[150:153], a[32:35], v[210:213], v[150:153]
    v_mfma_f32_16x16x32_bf16 v[150:153], a[36:39], v[134:137], v[150:153]
    v_mfma_f32_16x16x32_bf16 v[150:153], a[40:43], v[154:157], v[150:153]
    v_mfma_f32_16x16x32_bf16 v[150:153], a[44:47], v[130:133], v[150:153]
    buffer_load_dwordx4 v12, s[8:11], 0 offen nt lds
    v_cvt_pk_f16_f32 v186, v186, v187
    v_mfma_f32_16x16x32_bf16 v[138:141], a[48:51], v[142:145], 0
    s_add_u32 m0, s28, 12288
    v_pk_mul_f16 v190, v186, v186
    v_cvt_pk_f16_f32 v187, v188, v189
    v_mfma_f32_16x16x32_bf16 v[138:141], a[52:55], v[162:165], v[138:141]
    s_xor_b32 s28, s28, 65536
    ds_read_b128 v[166:169], v5 offset:0
    ds_read_b128 v[126:129], v5 offset:16
    v_mfma_f32_16x16x32_bf16 v[138:141], a[56:59], v[210:213], v[138:141]
    ds_read_b128 v[198:201], v5 offset:48
    ds_read_b32 v254, v6 offset:192
    v_mfma_f32_16x16x32_bf16 v[138:141], a[60:63], v[134:137], v[138:141]
    v_pk_mul_f16 v192, v187, v187
    v_cvt_pk_f16_f32 v188, v150, v151
    v_mfma_f32_16x16x32_bf16 v[138:141], a[64:67], v[154:157], v[138:141]
    buffer_load_dwordx4 v13, s[8:11], 0 offen nt lds
    v_pk_fma_f16 v190, v188, v188, v190
    v_mfma_f32_16x16x32_bf16 v[138:141], a[68:71], v[130:133], v[138:141]
    s_mov_b32 m0, s29
    v_cvt_pk_f16_f32 v189, v152, v153
    v_pk_fma_f16 v192, v189, v189, v192
    v_mfma_f32_16x16x32_bf16 v[150:153], v[142:145], a[144:147], 0
    s_xor_b32 s29, s29, s30
    v_add_u32 v5, 336, v5
    s_add_u32 s19, s19, s20
    v_mfma_f32_16x16x32_bf16 v[150:153], v[162:165], a[148:151], v[150:153]
    s_add_u32 s23, s23, s21
    v_cvt_pk_f16_f32 v122, v138, v139
    v_pk_fma_f16 v190, v122, v122, v190
    v_mfma_f32_16x16x32_bf16 v[150:153], v[210:213], a[152:155], v[150:153]
    s_cmp_ge_u32 s19, 72
    v_cvt_pk_f16_f32 v123, v140, v141
    v_pk_fma_f16 v192, v123, v123, v192
    v_mfma_f32_16x16x32_bf16 v[150:153], v[134:137], a[156:159], v[150:153]
    s_waitcnt lgkmcnt(2)
    buffer_store_dwordx2 v[202:203], v18, s[12:15], 0 offen nt
    s_cselect_b32 s34, 72, 0
    s_cselect_b32 s35, s22, 0
    v_mfma_f32_16x16x32_f16 v[138:141], v[40:43], v[190:193], 0
    s_sub_u32 s19, s19, s34
    s_add_u32 s23, s23, s35
    s_add_u32 s18, s18, 1
    v_mfma_f32_16x16x32_f16 v[214:217], v[166:169], v[158:161], v[24:27]
    s_cmp_lt_u32 s18, s45
    v_mfma_f32_16x16x32_f16 v[214:217], v[126:129], v[170:173], v[214:217]
    s_waitcnt lgkmcnt(0)
    v_mfma_f32_16x16x32_f16 v[214:217], v[198:201], v[218:221], v[214:217]
    v_rsq_f32 v140, v138
    v_mfma_f32_16x16x32_f16 v[190:193], v[166:169], v[206:209], v[22:25]
    v_rsq_f32 v141, v139
    v_mfma_f32_16x16x32_f16 v[190:193], v[126:129], v[118:121], v[190:193]
    v_mul_f32 v140, s31, v140
    v_cvt_pk_f16_f32 v140, v140, v141
    v_mfma_f32_16x16x32_f16 v[190:193], v[198:201], v[194:197], v[190:193]
    v_pk_mul_f16 v178, v178, v140 op_sel:[0,1] op_sel_hi:[1,1]
    v_pk_mul_f16 v179, v179, v140 op_sel:[0,1] op_sel_hi:[1,1]
    v_mfma_f32_16x16x32_bf16 v[150:153], v[154:157], a[160:163], v[150:153]
    v_pk_mul_f16 v180, v180, v140 op_sel:[0,1] op_sel_hi:[1,1]
    v_pk_mul_f16 v181, v181, v140 op_sel:[0,1] op_sel_hi:[1,1]
    v_mfma_f32_16x16x32_bf16 v[150:153], v[130:133], a[164:167], v[150:153]
    v_pk_mul_f16 v124, v124, v140 op_sel:[0,1] op_sel_hi:[1,1]
    v_pk_mul_f16 v125, v125, v140 op_sel:[0,1] op_sel_hi:[1,1]
    v_mfma_f32_16x16x32_bf16 v[222:225], v[142:145], a[168:171], 0
    v_mov_b32_dpp v254, v191 quad_perm:[0,1,2,3] row_mask:0x1 bank_mask:0xf
    v_mov_b32_dpp v254, v215 quad_perm:[0,1,2,3] row_mask:0x2 bank_mask:0xf
    v_mfma_f32_16x16x32_bf16 v[222:225], v[162:165], a[172:175], v[222:225]
    v_pk_mul_f16 v186, v186, v140 op_sel:[0,0] op_sel_hi:[1,0]
    v_pk_mul_f16 v187, v187, v140 op_sel:[0,0] op_sel_hi:[1,0]
    v_mfma_f32_16x16x32_bf16 v[222:225], v[210:213], a[176:179], v[222:225]
    v_cvt_pk_bf16_f32 v226, v150, v151
    v_cvt_pk_bf16_f32 v227, v152, v153
    v_mfma_f32_16x16x32_bf16 v[222:225], v[134:137], a[180:183], v[222:225]
    v_pk_mul_f16 v188, v188, v140 op_sel:[0,0] op_sel_hi:[1,0]
    v_pk_mul_f16 v189, v189, v140 op_sel:[0,0] op_sel_hi:[1,0]
    v_mfma_f32_16x16x32_f16 v[230:233], v[118:121], v[206:209], v[46:49]
    v_pk_mul_f16 v122, v122, v140 op_sel:[0,0] op_sel_hi:[1,0]
    v_pk_mul_f16 v123, v123, v140 op_sel:[0,0] op_sel_hi:[1,0]
    v_mfma_f32_16x16x32_f16 v[234:237], v[170:173], v[206:209], v[50:53]
    v_min3_u32 v44, v44, v138, v139
    v_max3_u32 v45, v45, v138, v139
    v_mfma_f32_16x16x32_f16 v[138:141], v[178:181], v[206:209], v[54:57]
    v_exp_f32 v214, v214
    v_mfma_f32_16x16x16_f16 v[230:233], v[196:197], v[194:195], v[230:233]
    buffer_store_dwordx4 v[146:149], v17, s[12:15], 0 offen nt
    v_exp_f32 v190, v190
    v_mfma_f32_16x16x16_f16 v[234:237], v[220:221], v[194:195], v[234:237]
    v_cvt_pk_bf16_f32 v39, v190, 0
    v_mfma_f32_16x16x16_f16 v[138:141], v[124:125], v[194:195], v[138:141]
    v_mfma_f32_16x16x32_bf16 v[222:225], v[154:157], a[184:187], v[222:225]
    v_mfma_f32_16x16x32_bf16 v[222:225], v[130:133], a[188:191], v[222:225]
    ds_read_b128 v[146:149], v2 offset:0
    v_mfma_f32_16x16x32_bf16 v[150:153], v[142:145], a[192:195], 0
    ds_read_b128 v[142:145], v2 offset:1024
    v_mfma_f32_16x16x32_bf16 v[150:153], v[162:165], a[196:199], v[150:153]
    ds_read_b128 v[206:209], v2 offset:2048
    v_mfma_f32_16x16x32_bf16 v[150:153], v[210:213], a[200:203], v[150:153]
    ds_read_b128 v[162:165], v2 offset:3072
    v_mfma_f32_16x16x32_bf16 v[150:153], v[134:137], a[204:207], v[150:153]
    ds_read_b128 v[134:137], v2 offset:4096
    v_cvt_pk_bf16_f32 v210, v222, v223
    v_mfma_f32_16x16x32_bf16 v[150:153], v[154:157], a[208:211], v[150:153]
    ds_read_b128 v[154:157], v2 offset:5120
    v_cvt_pk_bf16_f32 v211, v224, v225
    v_mfma_f32_16x16x32_bf16 v[150:153], v[130:133], a[212:215], v[150:153]
    ds_read2_b32 v[228:229], v6 offset0:0 offset1:0
    ds_read2_b32 v[212:213], v6 offset0:16 offset1:16
    v_mfma_f32_16x16x32_f16 v[130:133], v[166:169], v[186:189], v[26:29]
    ds_read2_b32 v[168:169], v6 offset0:32 offset1:32
    v_add_u32 v6, 272, v6
    v_mfma_f32_16x16x32_f16 v[130:133], v[126:129], v[178:181], v[130:133]
    s_waitcnt lgkmcnt(8)
    v_exp_f32 v230, v230
    v_mfma_f32_16x16x32_f16 v[130:133], v[198:201], v[122:125], v[130:133]
    s_waitcnt lgkmcnt(7)
    v_cvt_pk_bf16_f32 v166, v150, v151
    v_cvt_pk_bf16_f32 v167, v152, v153
    v_mfma_f32_16x16x32_bf16 v[150:153], a[216:219], v[146:149], 0
    s_waitcnt lgkmcnt(6)
    v_exp_f32 v231, v231
    v_mfma_f32_16x16x32_bf16 v[150:153], a[220:223], v[142:145], v[150:153]
    s_waitcnt lgkmcnt(5)
    v_exp_f32 v130, v130
    v_mfma_f32_16x16x32_bf16 v[150:153], a[224:227], v[206:209], v[150:153]
    s_waitcnt lgkmcnt(4)
    buffer_store_dwordx2 v[204:205], v20, s[12:15], 0 offen nt
    v_mov_b32_dpp v254, v131 quad_perm:[0,1,2,3] row_mask:0x4 bank_mask:0xf
    v_cvt_pk_bf16_f32 v126, v230, v231
    v_mfma_f32_16x16x32_bf16 v[150:153], a[228:231], v[162:165], v[150:153]
    s_waitcnt lgkmcnt(3)
    v_exp_f32 v254, v254
    v_mfma_f32_16x16x32_bf16 v[150:153], a[232:235], v[134:137], v[150:153]
    s_waitcnt lgkmcnt(1)
    v_exp_f32 v232, v232
    v_mfma_f32_16x16x32_bf16 v[150:153], a[236:239], v[154:157], v[150:153]
    s_waitcnt lgkmcnt(0)
    v_exp_f32 v233, v233
    v_mfma_f32_16x16x32_bf16 v[190:193], a[240:243], v[146:149], 0
    v_cvt_pk_bf16_f32 v254, v254, v254
    v_cvt_pk_bf16_f32 v127, v232, v233
    v_mfma_f32_16x16x32_bf16 v[190:193], a[244:247], v[142:145], v[190:193]
    ds_write_b16 v8, v254
    v_mfma_f32_16x16x32_bf16 v[190:193], a[248:251], v[206:209], v[190:193]
    v_exp_f32 v234, v234
    v_mfma_f32_16x16x32_bf16 v[190:193], a[252:255], v[162:165], v[190:193]
    ds_read_b128 v[198:201], v2 offset:6144
    ds_read_b128 v[230:233], v9
    v_mfma_f32_16x16x32_bf16 v[190:193], v[82:85], v[134:137], v[190:193]
    ds_read_b128 v[222:225], v2 offset:7168
    ds_read_b128 v[238:241], v9 offset:64
    v_mfma_f32_16x16x32_bf16 v[190:193], v[86:89], v[154:157], v[190:193]
    v_exp_f32 v235, v235
    v_mfma_f32_16x16x32_bf16 v[202:205], v[90:93], v[146:149], 0
    ds_read_b128 v[146:149], v2 offset:8192
    ds_read_b128 v[242:245], v2 offset:9216
    v_mfma_f32_16x16x32_bf16 v[202:205], v[94:97], v[142:145], v[202:205]
    v_cvt_pk_bf16_f32 v128, v234, v235
    v_fma_f32 v254, v150, v150, s33
    v_mfma_f32_16x16x32_bf16 v[202:205], v[98:101], v[206:209], v[202:205]
    ds_read_b128 v[206:209], v2 offset:10240
    ds_read_b128 v[246:249], v2 offset:11264
    v_mfma_f32_16x16x32_bf16 v[202:205], v[102:105], v[162:165], v[202:205]
    v_exp_f32 v236, v236
    v_mfma_f32_16x16x32_bf16 v[202:205], v[106:109], v[134:137], v[202:205]
    v_exp_f32 v237, v237
    v_mfma_f32_16x16x32_bf16 v[202:205], v[110:113], v[154:157], v[202:205]
    s_waitcnt lgkmcnt(6)
    v_cvt_pk_bf16_f32 v129, v236, v237
    v_fmac_f32 v254, v151, v151
    v_mfma_f32_16x16x32_bf16 v[142:145], v[230:233], v[28:31], 0
    s_waitcnt lgkmcnt(4)
    v_exp_f32 v138, v138
    v_mfma_f32_16x16x32_bf16 v[142:145], v[238:241], v[28:31], v[142:145]
    v_fmac_f32 v254, v152, v152
    v_mfma_f32_16x16x32_bf16 v[134:137], v[230:233], v[174:177], 0
    s_waitcnt lgkmcnt(2)
    v_exp_f32 v139, v139
    v_mfma_f32_16x16x32_bf16 v[134:137], v[238:241], v[226:229], v[134:137]
    v_cvt_pk_bf16_f32 v36, v138, v139
    v_fmac_f32 v254, v153, v153
    v_mfma_f32_16x16x32_bf16 v[154:157], v[230:233], v[182:185], 0
    s_waitcnt lgkmcnt(0)
    v_rcp_f32 v142, v142
    v_mfma_f32_16x16x32_bf16 v[154:157], v[238:241], v[210:213], v[154:157]
    v_exp_f32 v140, v140
    v_mfma_f32_16x16x32_bf16 v[162:165], v[230:233], v[114:117], 0
    v_mul_f32 v134, v134, v142
    v_fmac_f32 v254, v190, v190
    v_mfma_f32_16x16x32_bf16 v[162:165], v[238:241], v[166:169], v[162:165]
    v_exp_f32 v141, v141
    v_mfma_f32_16x16x32_f16 v[230:233], v[118:121], v[158:161], v[58:61]
    v_cvt_pk_bf16_f32 v37, v140, v141
    v_mul_f32_dpp v134, v154, v142 quad_perm:[0,1,2,3] row_mask:0x2 bank_mask:0xf
    v_mfma_f32_16x16x32_f16 v[138:141], v[170:173], v[158:161], v[62:65]
    v_fmac_f32 v254, v191, v191
    v_fmac_f32 v254, v192, v192
    v_mfma_f32_16x16x32_f16 v[154:157], v[178:181], v[158:161], v[66:69]
    v_mul_f32_dpp v134, v162, v142 quad_perm:[0,1,2,3] row_mask:0x4 bank_mask:0xf
    v_cvt_pk_bf16_f32 v134, v134, v134
    v_fmac_f32 v254, v193, v193
    v_mfma_f32_16x16x16_f16 v[230:233], v[196:197], v[218:219], v[230:233]
    v_fmac_f32 v254, v202, v202
    v_fmac_f32 v254, v203, v203
    v_fmac_f32 v254, v204, v204
    v_mfma_f32_16x16x16_f16 v[138:141], v[220:221], v[218:219], v[138:141]
    v_fmac_f32 v254, v205, v205
    v_mfma_f32_16x16x16_f16 v[154:157], v[124:125], v[218:219], v[154:157]
    ds_write_b16 v7, v134
    v_add_u32 v7, 16, v7
    v_mfma_f32_16x16x32_bf16 v[134:137], v[28:31], v[36:39], 0
    v_exp_f32 v230, v230
    v_mfma_f32_16x16x32_bf16 v[134:137], v[28:31], v[126:129], v[134:137]
    v_exp_f32 v231, v231
    v_mfma_f32_16x16x32_bf16 v[158:161], v[226:229], v[36:39], 0
    v_exp_f32 v232, v232
    v_mfma_f32_16x16x32_bf16 v[158:161], v[174:177], v[126:129], v[158:161]
    v_exp_f32 v233, v233
    v_mfma_f32_16x16x32_bf16 v[162:165], v[210:213], v[36:39], 0
    v_cvt_pk_bf16_f32 v230, v230, v231
    v_cvt_pk_bf16_f32 v231, v232, v233
    v_mfma_f32_16x16x32_bf16 v[162:165], v[182:185], v[126:129], v[162:165]
    v_exp_f32 v138, v138
    v_mfma_f32_16x16x32_bf16 v[234:237], v[166:169], v[36:39], 0
    v_exp_f32 v139, v139
    v_mfma_f32_16x16x32_bf16 v[234:237], v[114:117], v[126:129], v[234:237]
    v_cvt_pk_bf16_f32 v232, v138, v139
    v_cvt_pk_bf16_f32 v39, v214, 0
    v_mfma_f32_16x16x32_f16 v[126:129], v[118:121], v[186:189], v[70:73]
    v_exp_f32 v140, v140
    v_mfma_f32_16x16x32_f16 v[118:121], v[170:173], v[186:189], v[74:77]
    v_exp_f32 v141, v141
    v_mfma_f32_16x16x32_bf16 v[142:145], a[216:219], v[198:201], 0
    v_exp_f32 v154, v154
    v_mfma_f32_16x16x32_bf16 v[142:145], a[220:223], v[222:225], v[142:145]
    v_cvt_pk_bf16_f32 v233, v140, v141
    v_exp_f32 v155, v155
    v_mfma_f32_16x16x32_f16 v[138:141], v[178:181], v[186:189], v[78:81]
    v_cvt_pk_bf16_f32 v36, v154, v155
    v_exp_f32 v156, v156
    v_mfma_f32_16x16x16_f16 v[126:129], v[196:197], v[122:123], v[126:129]
    v_exp_f32 v157, v157
    v_mfma_f32_16x16x16_f16 v[118:121], v[220:221], v[122:123], v[118:121]
    v_cvt_pk_bf16_f32 v37, v156, v157
    v_rcp_f32 v134, v134
    v_mfma_f32_16x16x16_f16 v[138:141], v[124:125], v[122:123], v[138:141]
    v_mul_f32 v158, v134, v158
    v_mul_f32 v159, v134, v159
    v_cvt_pk_bf16_f32 v186, v158, v159
    v_mul_f32 v160, v134, v160
    v_mfma_f32_16x16x32_bf16 v[154:157], v[28:31], v[36:39], 0
    v_exp_f32 v126, v126
    v_mfma_f32_16x16x32_bf16 v[154:157], v[28:31], v[230:233], v[154:157]
    v_exp_f32 v127, v127
    v_mfma_f32_16x16x32_bf16 v[194:197], v[226:229], v[36:39], 0
    v_cvt_pk_bf16_f32 v170, v126, v127
    v_mul_f32 v161, v134, v161
    v_mfma_f32_16x16x32_bf16 v[194:197], v[174:177], v[230:233], v[194:197]
    v_exp_f32 v128, v128
    v_mfma_f32_16x16x32_bf16 v[122:125], v[210:213], v[36:39], 0
    v_exp_f32 v129, v129
    v_mfma_f32_16x16x32_bf16 v[122:125], v[182:185], v[230:233], v[122:125]
    v_cvt_pk_bf16_f32 v171, v128, v129
    v_cvt_pk_bf16_f32 v187, v160, v161
    v_mfma_f32_16x16x32_bf16 v[126:129], v[166:169], v[36:39], 0
    ds_write_b64 v3, v[186:187] offset:0
    v_mfma_f32_16x16x32_bf16 v[126:129], v[114:117], v[230:233], v[126:129]
    v_exp_f32 v118, v118
    v_mfma_f32_16x16x32_bf16 v[142:145], a[224:227], v[146:149], v[142:145]
    v_exp_f32 v119, v119
    v_mfma_f32_16x16x32_bf16 v[142:145], a[228:231], v[242:245], v[142:145]
    v_cvt_pk_bf16_f32 v172, v118, v119
    v_cvt_pk_bf16_f32 v39, v130, 0
    v_mfma_f32_16x16x32_bf16 v[142:145], a[232:235], v[206:209], v[142:145]
    v_exp_f32 v120, v120
    v_mfma_f32_16x16x32_bf16 v[142:145], a[236:239], v[246:249], v[142:145]
    v_exp_f32 v121, v121
    v_mfma_f32_16x16x32_bf16 v[158:161], a[240:243], v[198:201], 0
    v_cvt_pk_bf16_f32 v173, v120, v121
    v_mul_f32 v162, v134, v162
    v_mfma_f32_16x16x32_bf16 v[158:161], a[244:247], v[222:225], v[158:161]
    v_exp_f32 v138, v138
    v_mfma_f32_16x16x32_bf16 v[158:161], a[248:251], v[146:149], v[158:161]
    v_exp_f32 v139, v139
    v_mfma_f32_16x16x32_bf16 v[158:161], a[252:255], v[242:245], v[158:161]
    ds_read_b128 v[118:121], v2 offset:12288
    v_cvt_pk_bf16_f32 v36, v138, v139
    v_mfma_f32_16x16x32_bf16 v[158:161], v[82:85], v[206:209], v[158:161]
    ds_read_b128 v[130:133], v2 offset:13312
    v_fma_f32 v255, v142, v142, s33
    v_mfma_f32_16x16x32_bf16 v[158:161], v[86:89], v[246:249], v[158:161]
    ds_read_b128 v[218:221], v2 offset:14336
    v_fmac_f32 v255, v143, v143
    v_mfma_f32_16x16x32_bf16 v[178:181], v[90:93], v[198:201], 0
    ds_read_b128 v[198:201], v2 offset:15360
    v_fmac_f32 v255, v144, v144
    v_mfma_f32_16x16x32_bf16 v[178:181], v[94:97], v[222:225], v[178:181]
    ds_read_b128 v[222:225], v2 offset:16384
    v_fmac_f32 v255, v145, v145
    v_mfma_f32_16x16x32_bf16 v[178:181], v[98:101], v[146:149], v[178:181]
    ds_read_b128 v[230:233], v2 offset:17408
    v_fmac_f32 v255, v158, v158
    v_mfma_f32_16x16x32_bf16 v[178:181], v[102:105], v[242:245], v[178:181]
    v_exp_f32 v140, v140
    v_mfma_f32_16x16x32_bf16 v[178:181], v[106:109], v[206:209], v[178:181]
    v_exp_f32 v141, v141
    v_mfma_f32_16x16x32_bf16 v[178:181], v[110:113], v[246:249], v[178:181]
    s_waitcnt lgkmcnt(5)
    v_cvt_pk_bf16_f32 v37, v140, v141
    v_fmac_f32 v255, v159, v159
    v_mfma_f32_16x16x32_bf16 v[146:149], a[216:219], v[118:121], 0
    s_waitcnt lgkmcnt(4)
    v_fmac_f32 v255, v160, v160
    v_fmac_f32 v255, v161, v161
    v_mfma_f32_16x16x32_bf16 v[242:245], v[28:31], v[36:39], 0
    s_waitcnt lgkmcnt(3)
    v_fmac_f32 v255, v178, v178
    v_fmac_f32 v255, v179, v179
    v_mfma_f32_16x16x32_bf16 v[242:245], v[28:31], v[170:173], v[242:245]
    s_waitcnt lgkmcnt(2)
    v_fmac_f32 v255, v180, v180
    v_fmac_f32 v255, v181, v181
    v_mfma_f32_16x16x32_bf16 v[206:209], v[226:229], v[36:39], 0
    s_waitcnt lgkmcnt(1)
    v_cvt_pk_bf16_f32 v254, v254, v255
    v_mul_f32 v163, v134, v163
    v_mfma_f32_16x16x32_bf16 v[206:209], v[174:177], v[170:173], v[206:209]
    s_waitcnt lgkmcnt(0)
    v_cvt_pk_bf16_f32 v188, v162, v163
    v_mul_f32 v164, v134, v164
    v_mfma_f32_16x16x32_bf16 v[174:177], v[210:213], v[36:39], 0
    v_mul_f32 v165, v134, v165
    v_cvt_pk_bf16_f32 v189, v164, v165
    v_mfma_f32_16x16x32_bf16 v[174:177], v[182:185], v[170:173], v[174:177]
    ds_write_b64 v3, v[188:189] offset:8
    v_mfma_f32_16x16x32_bf16 v[182:185], v[166:169], v[36:39], 0
    v_mul_f32 v234, v134, v234
    v_mul_f32 v235, v134, v235
    v_mfma_f32_16x16x32_bf16 v[182:185], v[114:117], v[170:173], v[182:185]
    v_cvt_pk_bf16_f32 v234, v234, v235
    v_mul_f32 v236, v134, v236
    v_mfma_f32_16x16x32_bf16 v[146:149], a[220:223], v[130:133], v[146:149]
    v_mul_f32 v237, v134, v237
    v_cvt_pk_bf16_f32 v235, v236, v237
    v_mfma_f32_16x16x32_bf16 v[146:149], a[224:227], v[218:221], v[146:149]
    ds_write_b64 v4, v[234:235] offset:4096
    v_mfma_f32_16x16x32_bf16 v[146:149], a[228:231], v[198:201], v[146:149]
    v_rcp_f32 v154, v154
    v_mfma_f32_16x16x32_bf16 v[146:149], a[232:235], v[222:225], v[146:149]
    v_mul_f32 v194, v154, v194
    v_mul_f32 v195, v154, v195
    v_mfma_f32_16x16x32_bf16 v[146:149], a[236:239], v[230:233], v[146:149]
    v_cvt_pk_bf16_f32 v194, v194, v195
    v_mul_f32 v196, v154, v196
    v_mfma_f32_16x16x32_bf16 v[138:141], a[240:243], v[118:121], 0
    v_mul_f32 v197, v154, v197
    v_cvt_pk_bf16_f32 v195, v196, v197
    v_mfma_f32_16x16x32_bf16 v[138:141], a[244:247], v[130:133], v[138:141]
    ds_write_b64 v3, v[194:195] offset:6144
    v_mfma_f32_16x16x32_bf16 v[138:141], a[248:251], v[218:221], v[138:141]
    v_fma_f32 v255, v146, v146, s33
    v_fmac_f32 v255, v147, v147
    v_mfma_f32_16x16x32_bf16 v[138:141], a[252:255], v[198:201], v[138:141]
    ds_read_b128 v[170:173], v0 offset:20480
    v_fmac_f32 v255, v148, v148
    v_mfma_f32_16x16x32_bf16 v[138:141], v[82:85], v[222:225], v[138:141]
    ds_read_b128 v[166:169], v1 offset:20480
    v_fmac_f32 v255, v149, v149
    v_mfma_f32_16x16x32_bf16 v[138:141], v[86:89], v[230:233], v[138:141]
    ds_read_b128 v[162:165], v0 offset:20608
    v_mul_f32 v122, v154, v122
    v_mfma_f32_16x16x32_bf16 v[186:189], v[90:93], v[118:121], 0
    ds_read_b128 v[210:213], v1 offset:20608
    v_mul_f32 v123, v154, v123
    v_mfma_f32_16x16x32_bf16 v[186:189], v[94:97], v[130:133], v[186:189]
    ds_read_b128 v[226:229], v0 offset:20736
    v_cvt_pk_bf16_f32 v196, v122, v123
    v_mfma_f32_16x16x32_bf16 v[186:189], v[98:101], v[218:221], v[186:189]
    ds_read_b128 v[218:221], v1 offset:20736
    v_fmac_f32 v255, v138, v138
    v_mfma_f32_16x16x32_bf16 v[186:189], v[102:105], v[198:201], v[186:189]
    v_fmac_f32 v255, v139, v139
    v_fmac_f32 v255, v140, v140
    v_mfma_f32_16x16x32_bf16 v[186:189], v[106:109], v[222:225], v[186:189]
    v_fmac_f32 v255, v141, v141
    v_mul_f32 v124, v154, v124
    v_mfma_f32_16x16x32_bf16 v[186:189], v[110:113], v[230:233], v[186:189]
    s_waitcnt lgkmcnt(5)
    v_mul_f32 v125, v154, v125
    v_cvt_pk_bf16_f32 v197, v124, v125
    v_mfma_f32_16x16x32_bf16 v[118:121], a[72:75], v[170:173], 0
    s_waitcnt lgkmcnt(4)
    ds_write_b64 v3, v[196:197] offset:6152
    v_mfma_f32_16x16x32_bf16 v[118:121], a[76:79], v[166:169], v[118:121]
    s_waitcnt lgkmcnt(4)
    v_fmac_f32 v255, v186, v186
    v_fmac_f32 v255, v187, v187
    v_mfma_f32_16x16x32_bf16 v[118:121], a[80:83], v[162:165], v[118:121]
    s_waitcnt lgkmcnt(3)
    v_fmac_f32 v255, v188, v188
    v_fmac_f32 v255, v189, v189
    v_mfma_f32_16x16x32_bf16 v[118:121], a[84:87], v[210:213], v[118:121]
    s_waitcnt lgkmcnt(2)
    v_cvt_pk_bf16_f32 v255, v255, v255
    v_mul_f32 v126, v154, v126
    v_mfma_f32_16x16x32_bf16 v[118:121], a[88:91], v[226:229], v[118:121]
    s_waitcnt lgkmcnt(1)
    ds_write_b64 v4, v[254:255] offset:18432
    v_mfma_f32_16x16x32_bf16 v[118:121], a[92:95], v[218:221], v[118:121]
    v_mul_f32 v127, v154, v127
    v_cvt_pk_bf16_f32 v254, v126, v127
    v_mfma_f32_16x16x32_bf16 v[194:197], a[96:99], v[170:173], 0
    v_mul_f32 v128, v154, v128
    v_mul_f32 v129, v154, v129
    v_mfma_f32_16x16x32_bf16 v[194:197], a[100:103], v[166:169], v[194:197]
    v_cvt_pk_bf16_f32 v255, v128, v129
    v_xor_b32 v2, 65536, v2
    v_mfma_f32_16x16x32_bf16 v[194:197], a[104:107], v[162:165], v[194:197]
    ds_write_b64 v4, v[254:255] offset:10240
    v_mfma_f32_16x16x32_bf16 v[194:197], a[108:111], v[210:213], v[194:197]
    v_cvt_pk_f16_f32 v118, v118, v119
    v_pk_mul_f16 v223, v118, v118
    v_mfma_f32_16x16x32_bf16 v[194:197], a[112:115], v[226:229], v[194:197]
    v_cvt_pk_f16_f32 v119, v120, v121
    v_pk_mul_f16 v225, v119, v119
    v_mfma_f32_16x16x32_bf16 v[194:197], a[116:119], v[218:221], v[194:197]
    v_rcp_f32 v242, v242
    v_mfma_f32_16x16x32_bf16 v[114:117], a[120:123], v[170:173], 0
    v_mul_f32 v206, v242, v206
    v_mul_f32 v207, v242, v207
    v_mfma_f32_16x16x32_bf16 v[114:117], a[124:127], v[166:169], v[114:117]
    v_cvt_pk_bf16_f32 v206, v206, v207
    v_mul_f32 v208, v242, v208
    v_mfma_f32_16x16x32_bf16 v[114:117], a[128:131], v[162:165], v[114:117]
    v_cvt_pk_f16_f32 v120, v194, v195
    v_pk_fma_f16 v223, v120, v120, v223
    v_mfma_f32_16x16x32_bf16 v[114:117], a[132:135], v[210:213], v[114:117]
    v_cvt_pk_f16_f32 v121, v196, v197
    v_pk_fma_f16 v225, v121, v121, v225
    v_mfma_f32_16x16x32_bf16 v[114:117], a[136:139], v[226:229], v[114:117]
    v_mul_f32 v209, v242, v209
    v_cvt_pk_bf16_f32 v207, v208, v209
    v_mfma_f32_16x16x32_bf16 v[114:117], a[140:143], v[218:221], v[114:117]
    ds_write_b64 v3, v[206:207] offset:12288
    v_mfma_f32_16x16x32_bf16 v[154:157], a[0:3], v[170:173], 0
    v_mul_f32 v174, v242, v174
    v_mul_f32 v175, v242, v175
    v_mfma_f32_16x16x32_bf16 v[154:157], a[4:7], v[166:169], v[154:157]
    v_cvt_pk_bf16_f32 v208, v174, v175
    v_mul_f32 v176, v242, v176
    v_mfma_f32_16x16x32_bf16 v[154:157], a[8:11], v[162:165], v[154:157]
    v_cvt_pk_f16_f32 v196, v114, v115
    v_pk_fma_f16 v223, v196, v196, v223
    v_mfma_f32_16x16x32_bf16 v[154:157], a[12:15], v[210:213], v[154:157]
    v_cvt_pk_f16_f32 v197, v116, v117
    v_pk_fma_f16 v225, v197, v197, v225
    v_mfma_f32_16x16x32_bf16 v[154:157], a[16:19], v[226:229], v[154:157]
    v_mul_f32 v177, v242, v177
    v_cvt_pk_bf16_f32 v209, v176, v177
    v_mfma_f32_16x16x32_bf16 v[154:157], a[20:23], v[218:221], v[154:157]
    ds_write_b64 v3, v[208:209] offset:12296
    v_mfma_f32_16x16x32_bf16 v[174:177], a[24:27], v[170:173], 0
    v_mul_f32 v182, v242, v182
    v_mul_f32 v183, v242, v183
    v_mfma_f32_16x16x32_bf16 v[174:177], a[28:31], v[166:169], v[174:177]
    v_cvt_pk_bf16_f32 v194, v182, v183
    v_mul_f32 v184, v242, v184
    v_mfma_f32_16x16x32_bf16 v[174:177], a[32:35], v[162:165], v[174:177]
    v_cvt_pk_f16_f32 v206, v154, v155
    v_mul_f32 v185, v242, v185
    v_mfma_f32_16x16x32_bf16 v[174:177], a[36:39], v[210:213], v[174:177]
    v_cvt_pk_bf16_f32 v195, v184, v185
    v_xor_b32 v3, 65536, v3
    v_mfma_f32_16x16x32_bf16 v[174:177], a[40:43], v[226:229], v[174:177]
    ds_write_b64 v4, v[194:195] offset:16384
    v_mfma_f32_16x16x32_bf16 v[174:177], a[44:47], v[218:221], v[174:177]
    v_xor_b32 v4, 65536, v4
    v_mfma_f32_16x16x32_bf16 v[182:185], a[48:51], v[170:173], 0
    v_mfma_f32_16x16x32_bf16 v[182:185], a[52:55], v[166:169], v[182:185]
    v_mfma_f32_16x16x32_bf16 v[182:185], a[56:59], v[162:165], v[182:185]
    v_mfma_f32_16x16x32_bf16 v[182:185], a[60:63], v[210:213], v[182:185]
    v_mfma_f32_16x16x32_bf16 v[182:185], a[64:67], v[226:229], v[182:185]
    v_mfma_f32_16x16x32_bf16 v[182:185], a[68:71], v[218:221], v[182:185]
    v_mfma_f32_16x16x32_bf16 v[230:233], v[170:173], a[144:147], 0
    s_waitcnt lgkmcnt(0)
    v_mfma_f32_16x16x32_bf16 v[230:233], v[166:169], a[148:151], v[230:233]
    s_nop 0
    v_mfma_f32_16x16x32_bf16 v[230:233], v[162:165], a[152:155], v[230:233]
    s_nop 0
    v_mfma_f32_16x16x32_bf16 v[230:233], v[210:213], a[156:159], v[230:233]
    s_nop 0
    v_mfma_f32_16x16x32_bf16 v[230:233], v[226:229], a[160:163], v[230:233]
    s_barrier
    v_mfma_f32_16x16x32_bf16 v[230:233], v[218:221], a[164:167], v[230:233]
    s_cbranch_scc1 L_loop_fast3
L_final_fast:
    v_mfma_f32_16x16x32_bf16 v[114:117], v[170:173], a[168:171], 0
    s_mov_b32 s12, s42
    ds_read_b128 v[122:125], v2 offset:18432
    ds_read_b128 v[126:129], v2 offset:19456
    v_mfma_f32_16x16x32_bf16 v[114:117], v[166:169], a[172:175], v[114:117]
    s_mov_b32 s13, s43
    ds_read_b128 v[130:133], v0 offset:26624
    ds_read_b128 v[134:137], v1 offset:26624
    v_mfma_f32_16x16x32_bf16 v[114:117], v[162:165], a[176:179], v[114:117]
    s_mov_b32 s14, s36
    v_bfe_u32 v254, v2, 4, 6
    v_lshrrev_b32 v255, 4, v254
    v_mfma_f32_16x16x32_bf16 v[114:117], v[210:213], a[180:183], v[114:117]
    s_add_u32 s48, s42, s27
    ds_read_b128 v[198:201], v0 offset:26752
    ds_read_b128 v[214:217], v1 offset:26752
    v_mfma_f32_16x16x32_bf16 v[114:117], v[226:229], a[184:187], v[114:117]
    s_addc_u32 s49, s43, 0
    v_and_b32 v154, 15, v254
    v_lshlrev_b32 v155, 9, v255
    v_mfma_f32_16x16x32_bf16 v[114:117], v[218:221], a[188:191], v[114:117]
    s_sub_u32 s50, s36, s27
    ds_read_b128 v[234:237], v0 offset:26880
    ds_read_b128 v[238:241], v1 offset:26880
    v_mfma_f32_16x16x32_bf16 v[242:245], v[170:173], a[192:195], 0
    s_mov_b32 s51, 0x00020000
    v_lshl_add_u32 v155, v154, 4, v155
    v_add_u32 v155, 136704, v155
    v_mfma_f32_16x16x32_bf16 v[242:245], v[166:169], a[196:199], v[242:245]
    s_add_u32 s52, s42, s26
    ds_read_b128 v[166:169], v2 offset:0
    ds_read_b128 v[170:173], v2 offset:1024
    v_mfma_f32_16x16x32_bf16 v[242:245], v[162:165], a[200:203], v[242:245]
    s_waitcnt lgkmcnt(8)
    v_and_b32 v162, 0xffff, v2
    v_add_u32 v162, 148992, v162
    v_mfma_f32_16x16x32_bf16 v[246:249], v[32:35], v[122:125], 0
    s_waitcnt lgkmcnt(6)
    ds_read_b128 v[122:125], v2 offset:2048
    v_and_b32 v163, 0xffff, v4
    v_mfma_f32_16x16x32_bf16 v[246:249], v[32:35], v[126:129], v[246:249]
    s_addc_u32 s53, s43, 0
    ds_read_b128 v[126:129], v2 offset:3072
    v_add_u32 v163, 148992, v163
    v_mfma_f32_16x16x32_bf16 v[242:245], v[210:213], a[204:207], v[242:245]
    s_sub_u32 s54, s36, s26
    ds_read_b128 v[210:213], v2 offset:4096
    v_pk_mul_f16 v222, v206, v206
    v_mfma_f32_16x16x32_bf16 v[242:245], v[226:229], a[208:211], v[242:245]
    s_mov_b32 s55, 0x00020000
    v_mul_f32 v224, 0x3baaaaab, v247
    v_mul_f32 v164, 0x3baaaaab, v248
    v_mfma_f32_16x16x32_bf16 v[242:245], v[218:221], a[212:215], v[242:245]
    s_add_u32 s56, s42, s25
    ds_read_b128 v[218:221], v2 offset:5120
    s_addc_u32 s57, s43, 0
    s_sub_u32 s58, s36, s25
    s_mov_b32 s59, 0x00020000
    v_rsq_f32 v224, v224
    v_rsq_f32 v164, v164
    v_mul_f32 v142, v224, v142
    v_mul_f32 v143, v224, v143
    v_cvt_pk_bf16_f32 v142, v142, v143
    v_mfma_f32_16x16x32_bf16 v[226:229], a[72:75], v[130:133], 0
    s_lshl_b32 s3, s16, 6
    v_mul_f32 v144, v224, v144
    v_mul_f32 v145, v224, v145
    v_mfma_f32_16x16x32_bf16 v[226:229], a[76:79], v[134:137], v[226:229]
    s_waitcnt lgkmcnt(2)
    v_cvt_pk_bf16_f32 v143, v144, v145
    v_mul_f32 v158, v224, v158
    v_mfma_f32_16x16x32_bf16 v[226:229], a[80:83], v[198:201], v[226:229]
    s_lshl_b32 s4, s16, 5
    v_mul_f32 v159, v224, v159
    v_cvt_pk_bf16_f32 v144, v158, v159
    v_mfma_f32_16x16x32_bf16 v[226:229], a[84:87], v[214:217], v[226:229]
    s_add_u32 s4, s4, 256
    v_mul_f32 v160, v224, v160
    v_mul_f32 v161, v224, v161
    v_mfma_f32_16x16x32_bf16 v[226:229], a[88:91], v[234:237], v[226:229]
    s_mul_i32 s5, s16, 8064
    v_cvt_pk_bf16_f32 v145, v160, v161
    v_mul_f32 v178, v224, v178
    v_mfma_f32_16x16x32_bf16 v[226:229], a[92:95], v[238:241], v[226:229]
    s_add_u32 s5, s5, 104448
    buffer_store_dwordx4 v[142:145], v16, s[48:51], 0 offen nt
    v_mul_f32 v179, v224, v179
    v_cvt_pk_bf16_f32 v194, v178, v179
    v_mul_f32 v180, v224, v180
    v_mul_f32 v181, v224, v181
    v_mfma_f32_16x16x32_bf16 v[142:145], a[216:219], v[166:169], 0
    s_waitcnt lgkmcnt(0)
    v_cvt_pk_bf16_f32 v195, v180, v181
    v_mul_f32 v146, v164, v146
    v_mfma_f32_16x16x32_bf16 v[142:145], a[220:223], v[170:173], v[142:145]
    v_mul_f32 v147, v164, v147
    v_cvt_pk_bf16_f32 v146, v146, v147
    v_mfma_f32_16x16x32_bf16 v[142:145], a[224:227], v[122:125], v[142:145]
    v_mul_f32 v148, v164, v148
    v_mul_f32 v149, v164, v149
    v_mfma_f32_16x16x32_bf16 v[142:145], a[228:231], v[126:129], v[142:145]
    v_cvt_pk_bf16_f32 v147, v148, v149
    v_mul_f32 v138, v164, v138
    v_mfma_f32_16x16x32_bf16 v[142:145], a[232:235], v[210:213], v[142:145]
    v_mul_f32 v139, v164, v139
    v_cvt_pk_bf16_f32 v148, v138, v139
    v_mfma_f32_16x16x32_bf16 v[142:145], a[236:239], v[218:221], v[142:145]
    v_mul_f32 v140, v164, v140
    v_mul_f32 v141, v164, v141
    v_mfma_f32_16x16x32_bf16 v[158:161], a[240:243], v[166:169], 0
    v_cvt_pk_bf16_f32 v149, v140, v141
    v_mul_f32 v186, v164, v186
    v_mfma_f32_16x16x32_bf16 v[158:161], a[244:247], v[170:173], v[158:161]
    v_mul_f32 v187, v164, v187
    v_cvt_pk_bf16_f32 v186, v186, v187
    v_mfma_f32_16x16x32_bf16 v[158:161], a[248:251], v[122:125], v[158:161]
    v_mul_f32 v188, v164, v188
    v_mul_f32 v189, v164, v189
    v_mfma_f32_16x16x32_bf16 v[158:161], a[252:255], v[126:129], v[158:161]
    v_cvt_pk_bf16_f32 v187, v188, v189
    v_mul_f32 v224, 0x3baaaaab, v246
    v_mfma_f32_16x16x32_bf16 v[158:161], v[82:85], v[210:213], v[158:161]
    v_rsq_f32 v224, v224
    v_mfma_f32_16x16x32_bf16 v[158:161], v[86:89], v[218:221], v[158:161]
    v_mul_f32 v150, v224, v150
    v_mul_f32 v151, v224, v151
    v_mfma_f32_16x16x32_bf16 v[138:141], v[90:93], v[166:169], 0
    ds_read_b128 v[166:169], v2 offset:6144
    v_cvt_pk_bf16_f32 v150, v150, v151
    v_mfma_f32_16x16x32_bf16 v[138:141], v[94:97], v[170:173], v[138:141]
    ds_read_b128 v[170:173], v2 offset:7168
    v_mul_f32 v152, v224, v152
    v_mfma_f32_16x16x32_bf16 v[138:141], v[98:101], v[122:125], v[138:141]
    ds_read_b128 v[122:125], v2 offset:8192
    buffer_store_dwordx2 v[194:195], v19, s[48:51], 0 offen nt
    v_mul_f32 v153, v224, v153
    v_cvt_pk_bf16_f32 v151, v152, v153
    v_mfma_f32_16x16x32_bf16 v[138:141], v[102:105], v[126:129], v[138:141]
    ds_read_b128 v[126:129], v2 offset:9216
    v_mul_f32 v190, v224, v190
    v_mfma_f32_16x16x32_bf16 v[138:141], v[106:109], v[210:213], v[138:141]
    ds_read_b128 v[178:181], v2 offset:10240
    v_mul_f32 v191, v224, v191
    v_mfma_f32_16x16x32_bf16 v[138:141], v[110:113], v[218:221], v[138:141]
    ds_read_b128 v[210:213], v2 offset:11264
    v_cvt_pk_bf16_f32 v152, v190, v191
    v_mfma_f32_16x16x32_bf16 v[218:221], a[96:99], v[130:133], 0
    v_mul_f32 v192, v224, v192
    v_mul_f32 v193, v224, v193
    v_mfma_f32_16x16x32_bf16 v[218:221], a[100:103], v[134:137], v[218:221]
    s_waitcnt lgkmcnt(5)
    v_cvt_pk_bf16_f32 v153, v192, v193
    v_mul_f32 v202, v224, v202
    v_mfma_f32_16x16x32_bf16 v[190:193], a[216:219], v[166:169], 0
    s_waitcnt lgkmcnt(4)
    v_mul_f32 v203, v224, v203
    v_cvt_pk_bf16_f32 v164, v202, v203
    v_mfma_f32_16x16x32_bf16 v[190:193], a[220:223], v[170:173], v[190:193]
    s_waitcnt lgkmcnt(3)
    v_mul_f32 v204, v224, v204
    v_mul_f32 v205, v224, v205
    v_mfma_f32_16x16x32_bf16 v[190:193], a[224:227], v[122:125], v[190:193]
    v_cvt_pk_bf16_f32 v165, v204, v205
    v_fma_f32 v188, v142, v142, s33
    v_mfma_f32_16x16x32_bf16 v[202:205], a[240:243], v[166:169], 0
    s_waitcnt lgkmcnt(2)
    v_fmac_f32 v188, v143, v143
    v_fmac_f32 v188, v144, v144
    v_mfma_f32_16x16x32_bf16 v[190:193], a[228:231], v[126:129], v[190:193]
    s_waitcnt lgkmcnt(1)
    v_fmac_f32 v188, v145, v145
    v_fmac_f32 v188, v158, v158
    v_mfma_f32_16x16x32_bf16 v[190:193], a[232:235], v[178:181], v[190:193]
    s_waitcnt lgkmcnt(0)
    v_fmac_f32 v188, v159, v159
    v_fmac_f32 v188, v160, v160
    v_mfma_f32_16x16x32_bf16 v[190:193], a[236:239], v[210:213], v[190:193]
    v_fmac_f32 v188, v161, v161
    v_fmac_f32 v188, v138, v138
    v_mfma_f32_16x16x32_bf16 v[202:205], a[244:247], v[170:173], v[202:205]
    v_fmac_f32 v188, v139, v139
    v_fmac_f32 v188, v140, v140
    v_mfma_f32_16x16x32_bf16 v[202:205], a[248:251], v[122:125], v[202:205]
    v_fmac_f32 v188, v141, v141
    v_cvt_pk_f16_f32 v207, v156, v157
    v_mfma_f32_16x16x32_bf16 v[202:205], a[252:255], v[126:129], v[202:205]
    v_fma_f32 v189, v190, v190, s33
    v_fmac_f32 v189, v191, v191
    v_mfma_f32_16x16x32_bf16 v[202:205], v[82:85], v[178:181], v[202:205]
    buffer_store_dwordx4 v[146:149], v17, s[48:51], 0 offen nt
    v_fmac_f32 v189, v192, v192
    v_fmac_f32 v189, v193, v193
    v_pk_mul_f16 v224, v207, v207
    v_cvt_pk_f16_f32 v208, v174, v175
    v_mfma_f32_16x16x32_bf16 v[202:205], v[86:89], v[210:213], v[202:205]
    v_pk_fma_f16 v222, v208, v208, v222
    v_cvt_pk_f16_f32 v209, v176, v177
    v_mfma_f32_16x16x32_bf16 v[146:149], v[90:93], v[166:169], 0
    ds_read_b128 v[166:169], v2 offset:12288
    v_pk_fma_f16 v224, v209, v209, v224
    v_mfma_f32_16x16x32_bf16 v[146:149], v[94:97], v[170:173], v[146:149]
    ds_read_b128 v[170:173], v2 offset:13312
    v_cvt_pk_f16_f32 v194, v182, v183
    v_mfma_f32_16x16x32_bf16 v[146:149], v[98:101], v[122:125], v[146:149]
    ds_read_b128 v[122:125], v2 offset:14336
    v_fmac_f32 v189, v202, v202
    v_mfma_f32_16x16x32_bf16 v[146:149], v[102:105], v[126:129], v[146:149]
    ds_read_b128 v[126:129], v2 offset:15360
    v_fmac_f32 v189, v203, v203
    v_mfma_f32_16x16x32_bf16 v[146:149], v[106:109], v[178:181], v[146:149]
    ds_read_b128 v[174:177], v2 offset:16384
    v_fmac_f32 v189, v204, v204
    v_mfma_f32_16x16x32_bf16 v[146:149], v[110:113], v[210:213], v[146:149]
    ds_read_b128 v[178:181], v2 offset:17408
    v_fmac_f32 v189, v205, v205
    v_mfma_f32_16x16x32_bf16 v[218:221], a[104:107], v[198:201], v[218:221]
    v_pk_fma_f16 v222, v194, v194, v222
    v_cvt_pk_f16_f32 v195, v184, v185
    v_mfma_f32_16x16x32_bf16 v[218:221], a[108:111], v[214:217], v[218:221]
    v_pk_fma_f16 v224, v195, v195, v224
    v_cvt_pk_bf16_f32 v182, v230, v231
    v_mfma_f32_16x16x32_bf16 v[218:221], a[112:115], v[234:237], v[218:221]
    s_waitcnt lgkmcnt(5)
    v_fmac_f32 v189, v146, v146
    v_fmac_f32 v189, v147, v147
    v_mfma_f32_16x16x32_f16 v[210:213], v[40:43], v[222:225], 0
    s_waitcnt lgkmcnt(4)
    v_fmac_f32 v189, v148, v148
    v_fmac_f32 v189, v149, v149
    v_mfma_f32_16x16x32_bf16 v[222:225], a[216:219], v[166:169], 0
    s_waitcnt lgkmcnt(3)
    v_cvt_pk_bf16_f32 v188, v188, v189
    v_cvt_pk_bf16_f32 v189, v189, v189
    v_mfma_f32_16x16x32_bf16 v[222:225], a[220:223], v[170:173], v[222:225]
    s_waitcnt lgkmcnt(2)
    ds_write_b64 v163, v[188:189] offset:0
    v_mfma_f32_16x16x32_bf16 v[222:225], a[224:227], v[122:125], v[222:225]
    s_waitcnt lgkmcnt(1)
    v_rsq_f32 v212, v210
    v_mfma_f32_16x16x32_bf16 v[222:225], a[228:231], v[126:129], v[222:225]
    buffer_store_dwordx2 v[186:187], v20, s[48:51], 0 offen nt
    v_rsq_f32 v213, v211
    v_mfma_f32_16x16x32_bf16 v[222:225], a[232:235], v[174:177], v[222:225]
    v_mul_f32 v212, s31, v212
    v_cvt_pk_f16_f32 v212, v212, v213
    v_mfma_f32_16x16x32_bf16 v[222:225], a[236:239], v[178:181], v[222:225]
    v_cvt_pk_bf16_f32 v183, v232, v233
    v_cvt_pk_bf16_f32 v114, v114, v115
    v_mfma_f32_16x16x32_bf16 v[186:189], a[240:243], v[166:169], 0
    v_cvt_pk_bf16_f32 v115, v116, v117
    v_cvt_pk_bf16_f32 v230, v242, v243
    v_mfma_f32_16x16x32_bf16 v[186:189], a[244:247], v[170:173], v[186:189]
    v_cvt_pk_bf16_f32 v231, v244, v245
    v_pk_mul_f16 v118, v118, v212 op_sel:[0,1] op_sel_hi:[1,1]
    v_mfma_f32_16x16x32_bf16 v[186:189], a[248:251], v[122:125], v[186:189]
    s_waitcnt lgkmcnt(0)
    v_pk_mul_f16 v119, v119, v212 op_sel:[0,1] op_sel_hi:[1,1]
    v_pk_mul_f16 v120, v120, v212 op_sel:[0,1] op_sel_hi:[1,1]
    v_mfma_f32_16x16x32_bf16 v[186:189], a[252:255], v[126:129], v[186:189]
    s_barrier
    ds_read_b128 v[242:245], v162 offset:0
    v_pk_mul_f16 v121, v121, v212 op_sel:[0,1] op_sel_hi:[1,1]
    v_mfma_f32_16x16x32_bf16 v[186:189], v[82:85], v[174:177], v[186:189]
    v_pk_mul_f16 v196, v196, v212 op_sel:[0,1] op_sel_hi:[1,1]
    v_pk_mul_f16 v197, v197, v212 op_sel:[0,1] op_sel_hi:[1,1]
    v_mfma_f32_16x16x32_bf16 v[186:189], v[86:89], v[178:181], v[186:189]
    v_pk_mul_f16 v206, v206, v212 op_sel:[0,0] op_sel_hi:[1,0]
    v_pk_mul_f16 v207, v207, v212 op_sel:[0,0] op_sel_hi:[1,0]
    v_mfma_f32_16x16x32_bf16 v[218:221], a[116:119], v[238:241], v[218:221]
    v_pk_mul_f16 v208, v208, v212 op_sel:[0,0] op_sel_hi:[1,0]
    v_pk_mul_f16 v209, v209, v212 op_sel:[0,0] op_sel_hi:[1,0]
    v_pk_mul_f16 v194, v194, v212 op_sel:[0,0] op_sel_hi:[1,0]
    v_pk_mul_f16 v195, v195, v212 op_sel:[0,0] op_sel_hi:[1,0]
    v_mfma_f32_16x16x32_bf16 v[246:249], v[90:93], v[166:169], 0
    ds_read_b128 v[166:169], v162 offset:1024
    v_min3_u32 v44, v44, v210, v211
    v_mfma_f32_16x16x32_bf16 v[246:249], v[94:97], v[170:173], v[246:249]
    ds_read_b128 v[170:173], v155 offset:0
    v_max3_u32 v45, v45, v210, v211
    v_mfma_f32_16x16x32_bf16 v[246:249], v[98:101], v[122:125], v[246:249]
    ds_read_b128 v[122:125], v155 offset:2048
    v_mov_b32 v156, 0x40000000
    v_mfma_f32_16x16x32_bf16 v[246:249], v[102:105], v[126:129], v[246:249]
    s_waitcnt lgkmcnt(3)
    ds_read_b128 v[126:129], v155 offset:4096
    v_add_u32 v157, 0, v154
    v_mfma_f32_16x16x32_bf16 v[246:249], v[106:109], v[174:177], v[246:249]
    ds_read_b128 v[174:177], v155 offset:6144
    v_mul_u32_u24 v116, s20, v157
    v_mfma_f32_16x16x32_bf16 v[246:249], v[110:113], v[178:181], v[246:249]
    buffer_store_dwordx4 v[150:153], v15, s[48:51], 0 offen nt
    ds_read_b128 v[178:181], v155 offset:8192
    v_add_u32 v116, s38, v116
    v_mul_u32_u24 v116, 911, v116
    v_lshrrev_b32 v116, 16, v116
    v_mul_u32_u24 v116, s22, v116
    v_mad_u32_u24 v116, v157, s21, v116
    v_cmp_gt_u32 vcc, s17, v157
    v_mfma_f32_16x16x32_bf16 v[150:153], v[32:35], v[242:245], 0
    s_waitcnt lgkmcnt(5)
    ds_read_b128 v[210:213], v155 offset:10240
    v_add_u32 v157, s7, v116
    v_mfma_f32_16x16x32_bf16 v[150:153], v[32:35], v[166:169], v[150:153]
    s_waitcnt lgkmcnt(5)
    v_cndmask_b32 v157, v156, v157, vcc
    v_lshl_add_u32 v166, v255, 4, v157
    v_mfma_f32_16x16x32_bf16 v[242:245], a[120:123], v[130:133], 0
    s_waitcnt lgkmcnt(4)
    v_add_u32 v166, s3, v166
    v_lshl_add_u32 v157, v255, 3, v157
    v_mfma_f32_16x16x32_bf16 v[242:245], a[124:127], v[134:137], v[242:245]
    s_waitcnt lgkmcnt(3)
    v_mul_f32 v116, 0x3baaaaab, v151
    v_mul_f32 v117, 0x3baaaaab, v150
    v_mfma_f32_16x16x32_bf16 v[242:245], a[128:131], v[198:201], v[242:245]
    s_waitcnt lgkmcnt(2)
    v_rsq_f32 v116, v116
    v_mfma_f32_16x16x32_bf16 v[242:245], a[132:135], v[214:217], v[242:245]
    s_waitcnt lgkmcnt(1)
    v_mul_f32 v190, v116, v190
    v_mul_f32 v191, v116, v191
    v_mfma_f32_16x16x32_bf16 v[242:245], a[136:139], v[234:237], v[242:245]
    v_cvt_pk_bf16_f32 v150, v190, v191
    v_mul_f32 v192, v116, v192
    v_mfma_f32_16x16x32_bf16 v[242:245], a[140:143], v[238:241], v[242:245]
    v_mul_f32 v193, v116, v193
    v_cvt_pk_bf16_f32 v151, v192, v193
    v_mul_f32 v202, v116, v202
    v_mul_f32 v203, v116, v203
    v_cvt_pk_bf16_f32 v152, v202, v203
    v_mfma_f32_16x16x32_bf16 v[190:193], a[216:219], v[170:173], 0
    s_waitcnt lgkmcnt(0)
    v_mul_f32 v204, v116, v204
    v_mul_f32 v205, v116, v205
    v_mfma_f32_16x16x32_bf16 v[190:193], a[220:223], v[122:125], v[190:193]
    v_cvt_pk_bf16_f32 v153, v204, v205
    v_mul_f32 v146, v116, v146
    v_mfma_f32_16x16x32_bf16 v[190:193], a[224:227], v[126:129], v[190:193]
    v_mul_f32 v147, v116, v147
    v_cvt_pk_bf16_f32 v184, v146, v147
    v_mfma_f32_16x16x32_bf16 v[190:193], a[228:231], v[174:177], v[190:193]
    v_mul_f32 v148, v116, v148
    v_mul_f32 v149, v116, v149
    v_mfma_f32_16x16x32_bf16 v[190:193], a[232:235], v[178:181], v[190:193]
    v_cvt_pk_bf16_f32 v185, v148, v149
    v_add_u32 v157, s4, v157
    v_mfma_f32_16x16x32_bf16 v[190:193], a[236:239], v[210:213], v[190:193]
    buffer_store_dwordx4 v[150:153], v16, s[52:55], 0 offen nt
    v_rsq_f32 v117, v117
    v_fma_f32 v116, v222, v222, s33
    v_mul_f32 v142, v117, v142
    v_mfma_f32_16x16x32_bf16 v[146:149], a[240:243], v[170:173], 0
    v_mul_f32 v143, v117, v143
    v_cvt_pk_bf16_f32 v142, v142, v143
    v_mfma_f32_16x16x32_bf16 v[146:149], a[244:247], v[122:125], v[146:149]
    v_mul_f32 v144, v117, v144
    v_mul_f32 v145, v117, v145
    v_mfma_f32_16x16x32_bf16 v[146:149], a[248:251], v[126:129], v[146:149]
    v_cvt_pk_bf16_f32 v143, v144, v145
    v_mul_f32 v158, v117, v158
    v_mfma_f32_16x16x32_bf16 v[146:149], a[252:255], v[174:177], v[146:149]
    v_mul_f32 v159, v117, v159
    v_cvt_pk_bf16_f32 v144, v158, v159
    v_mfma_f32_16x16x32_bf16 v[146:149], v[82:85], v[178:181], v[146:149]
    v_mul_f32 v160, v117, v160
    v_mul_f32 v161, v117, v161
    v_mfma_f32_16x16x32_bf16 v[146:149], v[86:89], v[210:213], v[146:149]
    v_cvt_pk_bf16_f32 v145, v160, v161
    v_mul_f32 v138, v117, v138
    v_mfma_f32_16x16x32_bf16 v[150:153], v[90:93], v[170:173], 0
    v_mul_f32 v139, v117, v139
    v_cvt_pk_bf16_f32 v168, v138, v139
    v_mfma_f32_16x16x32_bf16 v[150:153], v[94:97], v[122:125], v[150:153]
    v_mul_f32 v140, v117, v140
    v_mul_f32 v141, v117, v141
    v_mfma_f32_16x16x32_bf16 v[150:153], v[98:101], v[126:129], v[150:153]
    v_cvt_pk_bf16_f32 v169, v140, v141
    v_fma_f32 v117, v190, v190, s33
    v_mfma_f32_16x16x32_bf16 v[150:153], v[102:105], v[174:177], v[150:153]
    v_fmac_f32 v117, v191, v191
    v_fmac_f32 v117, v192, v192
    v_mfma_f32_16x16x32_bf16 v[150:153], v[106:109], v[178:181], v[150:153]
    v_fmac_f32 v117, v193, v193
    v_fmac_f32 v117, v146, v146
    v_mfma_f32_16x16x32_bf16 v[150:153], v[110:113], v[210:213], v[150:153]
    v_fmac_f32 v117, v147, v147
    v_fmac_f32 v117, v148, v148
    v_mfma_f32_16x16x32_bf16 v[122:125], a[0:3], v[130:133], 0
    v_fmac_f32 v117, v149, v149
    v_fmac_f32 v116, v223, v223
    v_mfma_f32_16x16x32_bf16 v[122:125], a[4:7], v[134:137], v[122:125]
    v_fmac_f32 v116, v224, v224
    v_fmac_f32 v116, v225, v225
    v_mfma_f32_16x16x32_bf16 v[122:125], a[8:11], v[198:201], v[122:125]
    v_fmac_f32 v117, v150, v150
    v_fmac_f32 v117, v151, v151
    v_mfma_f32_16x16x32_bf16 v[122:125], a[12:15], v[214:217], v[122:125]
    buffer_store_dwordx2 v[184:185], v19, s[52:55], 0 offen nt
    v_fmac_f32 v117, v152, v152
    v_fmac_f32 v117, v153, v153
    v_mfma_f32_16x16x32_bf16 v[122:125], a[16:19], v[234:237], v[122:125]
    v_cvt_pk_bf16_f32 v185, v117, v117
    v_fmac_f32 v116, v186, v186
    v_mfma_f32_16x16x32_bf16 v[122:125], a[20:23], v[238:241], v[122:125]
    v_fmac_f32 v116, v187, v187
    v_fmac_f32 v116, v188, v188
    v_mfma_f32_16x16x32_bf16 v[126:129], a[24:27], v[130:133], 0
    v_fmac_f32 v116, v189, v189
    v_fmac_f32 v116, v246, v246
    v_mfma_f32_16x16x32_bf16 v[126:129], a[28:31], v[134:137], v[126:129]
    v_fmac_f32 v116, v247, v247
    v_fmac_f32 v116, v248, v248
    v_mfma_f32_16x16x32_bf16 v[126:129], a[32:35], v[198:201], v[126:129]
    v_fmac_f32 v116, v249, v249
    v_cvt_pk_bf16_f32 v184, v116, v117
    v_mfma_f32_16x16x32_bf16 v[126:129], a[36:39], v[214:217], v[126:129]
    ds_write_b64 v163, v[184:185] offset:2048
    v_mfma_f32_16x16x32_bf16 v[126:129], a[40:43], v[234:237], v[126:129]
    v_cvt_pk_f16_f32 v122, v122, v123
    v_pk_mul_f16 v138, v122, v122
    v_mfma_f32_16x16x32_bf16 v[126:129], a[44:47], v[238:241], v[126:129]
    v_cvt_pk_f16_f32 v123, v124, v125
    v_pk_mul_f16 v140, v123, v123
    v_mfma_f32_16x16x32_bf16 v[158:161], a[48:51], v[130:133], 0
    v_cvt_pk_f16_f32 v170, v226, v227
    v_pk_mul_f16 v139, v170, v170
    v_mfma_f32_16x16x32_bf16 v[158:161], a[52:55], v[134:137], v[158:161]
    v_cvt_pk_f16_f32 v171, v228, v229
    v_pk_mul_f16 v141, v171, v171
    v_mfma_f32_16x16x32_bf16 v[158:161], a[56:59], v[198:201], v[158:161]
    v_cvt_pk_f16_f32 v124, v126, v127
    v_pk_fma_f16 v138, v124, v124, v138
    v_mfma_f32_16x16x32_bf16 v[158:161], a[60:63], v[214:217], v[158:161]
    v_cvt_pk_f16_f32 v125, v128, v129
    v_pk_fma_f16 v140, v125, v125, v140
    v_mfma_f32_16x16x32_bf16 v[158:161], a[64:67], v[234:237], v[158:161]
    s_waitcnt lgkmcnt(0)
    v_cvt_pk_f16_f32 v172, v218, v219
    v_pk_fma_f16 v139, v172, v172, v139
    v_mfma_f32_16x16x32_bf16 v[158:161], a[68:71], v[238:241], v[158:161]
    s_barrier
    ds_read_b128 v[126:129], v162 offset:2048
    ds_read_b128 v[174:177], v162 offset:3072
    v_mfma_f32_16x16x32_bf16 v[178:181], v[130:133], a[144:147], 0
    v_cvt_pk_f16_f32 v173, v220, v221
    v_pk_fma_f16 v141, v173, v173, v141
    v_mfma_f32_16x16x32_bf16 v[178:181], v[134:137], a[148:151], v[178:181]
    buffer_store_dwordx2 v[164:165], v18, s[48:51], 0 offen nt
    v_cvt_pk_f16_f32 v158, v158, v159
    v_pk_fma_f16 v138, v158, v158, v138
    v_mfma_f32_16x16x32_bf16 v[178:181], v[198:201], a[152:155], v[178:181]
    v_cvt_pk_f16_f32 v159, v160, v161
    v_pk_fma_f16 v140, v159, v159, v140
    v_mfma_f32_16x16x32_bf16 v[178:181], v[214:217], a[156:159], v[178:181]
    v_cvt_pk_f16_f32 v160, v242, v243
    v_pk_fma_f16 v139, v160, v160, v139
    v_mfma_f32_16x16x32_bf16 v[178:181], v[234:237], a[160:163], v[178:181]
    v_cvt_pk_f16_f32 v161, v244, v245
    v_pk_fma_f16 v141, v161, v161, v141
    v_mfma_f32_16x16x32_bf16 v[178:181], v[238:241], a[164:167], v[178:181]
    ds_read_b128 v[202:205], v0 offset:32768
    v_xor_b32 v164, 65536, v2
    v_mfma_f32_16x16x32_f16 v[210:213], v[40:43], v[138:141], 0
    s_waitcnt lgkmcnt(2)
    v_bfe_u32 v165, v154, 1, 2
    v_xor_b32 v165, v165, v255
    v_mfma_f32_16x16x32_bf16 v[138:141], v[32:35], v[126:129], 0
    s_waitcnt lgkmcnt(1)
    v_cvt_pk_bf16_f32 v184, v178, v179
    v_cvt_pk_bf16_f32 v185, v180, v181
    v_mfma_f32_16x16x32_bf16 v[138:141], v[32:35], v[174:177], v[138:141]
    v_rsq_f32 v212, v210
    v_mfma_f32_16x16x32_bf16 v[126:129], v[130:133], a[168:171], 0
    ds_read_b128 v[174:177], v1 offset:32768
    v_mul_f32 v212, s31, v212
    v_mfma_f32_16x16x32_bf16 v[126:129], v[134:137], a[172:175], v[126:129]
    ds_read_b128 v[178:181], v0 offset:32896
    v_min3_u32 v44, v44, v210, v211
    v_mfma_f32_16x16x32_bf16 v[126:129], v[198:201], a[176:179], v[126:129]
    ds_read_b128 v[218:221], v1 offset:32896
    v_mul_f32 v167, 0x3baaaaab, v139
    v_mfma_f32_16x16x32_bf16 v[126:129], v[214:217], a[180:183], v[126:129]
    ds_read_b128 v[226:229], v0 offset:33024
    v_max3_u32 v45, v45, v210, v211
    v_mfma_f32_16x16x32_bf16 v[126:129], v[234:237], a[184:187], v[126:129]
    s_waitcnt lgkmcnt(4)
    v_rsq_f32 v213, v211
    v_mfma_f32_16x16x32_bf16 v[126:129], v[238:241], a[188:191], v[126:129]
    v_cvt_pk_f16_f32 v212, v212, v213
    v_pk_mul_f16 v170, v170, v212 op_sel:[0,1] op_sel_hi:[1,1]
    v_mfma_f32_16x16x32_bf16 v[242:245], v[130:133], a[192:195], 0
    ds_read_b128 v[130:133], v1 offset:33024
    v_pk_mul_f16 v171, v171, v212 op_sel:[0,1] op_sel_hi:[1,1]
    v_mfma_f32_16x16x32_bf16 v[242:245], v[134:137], a[196:199], v[242:245]
    v_rsq_f32 v167, v167
    v_mfma_f32_16x16x32_bf16 v[242:245], v[198:201], a[200:203], v[242:245]
    s_waitcnt lgkmcnt(4)
    buffer_store_dwordx4 v[142:145], v15, s[52:55], 0 offen nt
    v_cvt_pk_bf16_f32 v116, v126, v127
    v_cvt_pk_bf16_f32 v117, v128, v129
    v_mul_f32 v190, v167, v190
    v_mul_f32 v191, v167, v191
    v_mfma_f32_16x16x32_bf16 v[242:245], v[214:217], a[204:207], v[242:245]
    s_waitcnt lgkmcnt(2)
    v_cvt_pk_bf16_f32 v126, v190, v191
    v_mul_f32 v192, v167, v192
    v_mfma_f32_16x16x32_bf16 v[242:245], v[234:237], a[208:211], v[242:245]
    s_waitcnt lgkmcnt(1)
    v_mul_f32 v193, v167, v193
    v_cvt_pk_bf16_f32 v127, v192, v193
    v_mfma_f32_16x16x32_bf16 v[242:245], v[238:241], a[212:215], v[242:245]
    v_mul_f32 v146, v167, v146
    v_mul_f32 v147, v167, v147
    v_mfma_f32_16x16x32_bf16 v[134:137], a[72:75], v[202:205], 0
    v_cvt_pk_bf16_f32 v128, v146, v147
    v_mul_f32 v148, v167, v148
    v_mfma_f32_16x16x32_bf16 v[134:137], a[76:79], v[174:177], v[134:137]
    s_waitcnt lgkmcnt(0)
    v_mul_f32 v149, v167, v149
    v_cvt_pk_bf16_f32 v129, v148, v149
    v_mfma_f32_16x16x32_bf16 v[134:137], a[80:83], v[178:181], v[134:137]
    v_mul_f32 v150, v167, v150
    v_mul_f32 v151, v167, v151
    v_mfma_f32_16x16x32_bf16 v[134:137], a[84:87], v[218:221], v[134:137]
    v_cvt_pk_bf16_f32 v140, v150, v151
    v_mul_f32 v152, v167, v152
    v_mfma_f32_16x16x32_bf16 v[134:137], a[88:91], v[226:229], v[134:137]
    v_mul_f32 v153, v167, v153
    v_cvt_pk_bf16_f32 v141, v152, v153
    v_mfma_f32_16x16x32_bf16 v[134:137], a[92:95], v[130:133], v[134:137]
    v_cvt_pk_bf16_f32 v232, v242, v243
    v_cvt_pk_bf16_f32 v233, v244, v245
    v_mfma_f32_16x16x32_bf16 v[142:145], a[96:99], v[202:205], 0
    v_pk_mul_f16 v172, v172, v212 op_sel:[0,1] op_sel_hi:[1,1]
    v_pk_mul_f16 v173, v173, v212 op_sel:[0,1] op_sel_hi:[1,1]
    v_mfma_f32_16x16x32_bf16 v[142:145], a[100:103], v[174:177], v[142:145]
    v_pk_mul_f16 v160, v160, v212 op_sel:[0,1] op_sel_hi:[1,1]
    v_pk_mul_f16 v161, v161, v212 op_sel:[0,1] op_sel_hi:[1,1]
    v_mfma_f32_16x16x32_bf16 v[142:145], a[104:107], v[178:181], v[142:145]
    v_pk_mul_f16 v122, v122, v212 op_sel:[0,0] op_sel_hi:[1,0]
    v_pk_mul_f16 v123, v123, v212 op_sel:[0,0] op_sel_hi:[1,0]
    v_mfma_f32_16x16x32_bf16 v[142:145], a[108:111], v[218:221], v[142:145]
    v_pk_mul_f16 v124, v124, v212 op_sel:[0,0] op_sel_hi:[1,0]
    v_pk_mul_f16 v125, v125, v212 op_sel:[0,0] op_sel_hi:[1,0]
    v_mfma_f32_16x16x32_bf16 v[142:145], a[112:115], v[226:229], v[142:145]
    v_pk_mul_f16 v158, v158, v212 op_sel:[0,0] op_sel_hi:[1,0]
    v_pk_mul_f16 v159, v159, v212 op_sel:[0,0] op_sel_hi:[1,0]
    v_mfma_f32_16x16x32_bf16 v[142:145], a[116:119], v[130:133], v[142:145]
    v_mul_f32 v138, 0x3baaaaab, v138
    v_lshl_add_u32 v165, v154, 2, v165
    v_mfma_f32_16x16x32_bf16 v[146:149], a[120:123], v[202:205], 0
    buffer_store_dwordx2 v[168:169], v18, s[52:55], 0 offen nt
    v_rsq_f32 v138, v138
    v_mfma_f32_16x16x32_bf16 v[146:149], a[124:127], v[174:177], v[146:149]
    v_mul_f32 v222, v138, v222
    v_mul_f32 v223, v138, v223
    v_mfma_f32_16x16x32_bf16 v[146:149], a[128:131], v[178:181], v[146:149]
    v_cvt_pk_bf16_f32 v150, v222, v223
    v_mul_f32 v224, v138, v224
    v_mfma_f32_16x16x32_bf16 v[146:149], a[132:135], v[218:221], v[146:149]
    v_mul_f32 v225, v138, v225
    v_cvt_pk_bf16_f32 v151, v224, v225
    v_mfma_f32_16x16x32_bf16 v[146:149], a[136:139], v[226:229], v[146:149]
    v_mul_f32 v186, v138, v186
    v_mul_f32 v187, v138, v187
    v_mfma_f32_16x16x32_bf16 v[146:149], a[140:143], v[130:133], v[146:149]
    v_cvt_pk_bf16_f32 v152, v186, v187
    v_mul_f32 v188, v138, v188
    v_mfma_f32_16x16x32_bf16 v[190:193], a[0:3], v[202:205], 0
    v_mul_f32 v189, v138, v189
    v_cvt_pk_bf16_f32 v153, v188, v189
    v_mfma_f32_16x16x32_bf16 v[190:193], a[4:7], v[174:177], v[190:193]
    v_mul_f32 v246, v138, v246
    v_mul_f32 v247, v138, v247
    v_mfma_f32_16x16x32_bf16 v[190:193], a[8:11], v[178:181], v[190:193]
    v_cvt_pk_bf16_f32 v168, v246, v247
    v_mul_f32 v248, v138, v248
    v_mfma_f32_16x16x32_bf16 v[190:193], a[12:15], v[218:221], v[190:193]
    v_mul_f32 v249, v138, v249
    v_cvt_pk_bf16_f32 v169, v248, v249
    v_mfma_f32_16x16x32_bf16 v[190:193], a[16:19], v[226:229], v[190:193]
    v_lshl_add_u32 v167, v165, 4, s5
    v_lshl_add_u32 v138, v165, 3, s5
    v_mfma_f32_16x16x32_bf16 v[190:193], a[20:23], v[130:133], v[190:193]
    v_lshl_add_u32 v139, v254, 4, s5
    v_lshl_add_u32 v254, v254, 3, s5
    v_mfma_f32_16x16x32_bf16 v[186:189], a[24:27], v[202:205], 0
    v_lshlrev_b32 v165, 2, v165
    v_cvt_pk_f16_f32 v134, v134, v135
    v_mfma_f32_16x16x32_bf16 v[186:189], a[28:31], v[174:177], v[186:189]
    ds_permute_b32 v198, v165, v16
    ds_permute_b32 v199, v165, v19
    v_mfma_f32_16x16x32_bf16 v[186:189], a[32:35], v[178:181], v[186:189]
    ds_permute_b32 v200, v165, v17
    ds_permute_b32 v201, v165, v20
    v_mfma_f32_16x16x32_bf16 v[186:189], a[36:39], v[218:221], v[186:189]
    v_cvt_pk_f16_f32 v190, v190, v191
    v_pk_mul_f16 v210, v190, v190
    v_mfma_f32_16x16x32_bf16 v[186:189], a[40:43], v[226:229], v[186:189]
    buffer_store_dwordx4 v[126:129], v166, s[12:15], 0 offen nt
    v_cvt_pk_f16_f32 v191, v192, v193
    v_pk_mul_f16 v212, v191, v191
    v_pk_mul_f16 v211, v134, v134
    v_cvt_pk_f16_f32 v135, v136, v137
    v_mfma_f32_16x16x32_bf16 v[186:189], a[44:47], v[130:133], v[186:189]
    v_pk_mul_f16 v213, v135, v135
    v_cvt_pk_f16_f32 v136, v142, v143
    v_mfma_f32_16x16x32_bf16 v[126:129], a[48:51], v[202:205], 0
    v_pk_fma_f16 v211, v136, v136, v211
    v_cvt_pk_f16_f32 v137, v144, v145
    v_mfma_f32_16x16x32_bf16 v[126:129], a[52:55], v[174:177], v[126:129]
    v_pk_fma_f16 v213, v137, v137, v213
    v_cvt_pk_f16_f32 v144, v146, v147
    v_mfma_f32_16x16x32_bf16 v[126:129], a[56:59], v[178:181], v[126:129]
    s_waitcnt lgkmcnt(2)
    ds_read2_b32 v[216:217], v6 offset0:0 offset1:0
    ds_read2_b32 v[224:225], v6 offset0:16 offset1:16
    v_mfma_f32_16x16x32_bf16 v[126:129], a[60:63], v[218:221], v[126:129]
    s_waitcnt lgkmcnt(2)
    ds_read2_b32 v[236:237], v6 offset0:32 offset1:32
    v_cvt_pk_f16_f32 v192, v186, v187
    v_mfma_f32_16x16x32_bf16 v[126:129], a[64:67], v[226:229], v[126:129]
    v_pk_fma_f16 v210, v192, v192, v210
    v_cvt_pk_f16_f32 v193, v188, v189
    v_mfma_f32_16x16x32_bf16 v[126:129], a[68:71], v[130:133], v[126:129]
    v_pk_fma_f16 v212, v193, v193, v212
    v_pk_fma_f16 v211, v144, v144, v211
    v_mfma_f32_16x16x32_bf16 v[186:189], v[202:205], a[144:147], 0
    v_cvt_pk_f16_f32 v145, v148, v149
    v_pk_fma_f16 v213, v145, v145, v213
    v_mfma_f32_16x16x32_bf16 v[186:189], v[174:177], a[148:151], v[186:189]
    v_add_u32 v154, 16, v154
    v_mul_u32_u24 v165, s20, v154
    v_mfma_f32_16x16x32_bf16 v[186:189], v[178:181], a[152:155], v[186:189]
    v_cvt_pk_f16_f32 v142, v126, v127
    v_pk_fma_f16 v210, v142, v142, v210
    v_mfma_f32_16x16x32_bf16 v[186:189], v[218:221], a[156:159], v[186:189]
    v_cvt_pk_f16_f32 v143, v128, v129
    v_pk_fma_f16 v212, v143, v143, v212
    v_mfma_f32_16x16x32_bf16 v[186:189], v[226:229], a[160:163], v[186:189]
    s_waitcnt lgkmcnt(1)
    v_add_u32 v165, s38, v165
    v_mul_u32_u24 v165, 911, v165
    v_mfma_f32_16x16x32_f16 v[126:129], v[40:43], v[210:213], 0
    s_waitcnt lgkmcnt(0)
    v_lshrrev_b32 v165, 16, v165
    v_mul_u32_u24 v165, s22, v165
    v_mfma_f32_16x16x32_bf16 v[186:189], v[130:133], a[164:167], v[186:189]
    v_mad_u32_u24 v165, v154, s21, v165
    v_cmp_gt_u32 vcc, s17, v154
    v_mfma_f32_16x16x32_bf16 v[146:149], v[202:205], a[168:171], 0
    v_add_u32 v165, s7, v165
    v_min3_u32 v44, v44, v126, v127
    v_mfma_f32_16x16x32_bf16 v[146:149], v[174:177], a[172:175], v[146:149]
    buffer_store_dwordx2 v[140:141], v157, s[12:15], 0 offen nt
    v_rsq_f32 v128, v126
    v_mfma_f32_16x16x32_bf16 v[146:149], v[178:181], a[176:179], v[146:149]
    v_cvt_pk_bf16_f32 v214, v186, v187
    v_cvt_pk_bf16_f32 v215, v188, v189
    v_mfma_f32_16x16x32_bf16 v[146:149], v[218:221], a[180:183], v[146:149]
    v_rsq_f32 v129, v127
    v_mfma_f32_16x16x32_bf16 v[146:149], v[226:229], a[184:187], v[146:149]
    v_mul_f32 v128, s31, v128
    v_cvt_pk_f16_f32 v128, v128, v129
    v_mfma_f32_16x16x32_bf16 v[146:149], v[130:133], a[188:191], v[146:149]
    v_pk_mul_f16 v134, v134, v128 op_sel:[0,1] op_sel_hi:[1,1]
    v_pk_mul_f16 v135, v135, v128 op_sel:[0,1] op_sel_hi:[1,1]
    v_mfma_f32_16x16x32_bf16 v[186:189], v[202:205], a[192:195], 0
    v_pk_mul_f16 v136, v136, v128 op_sel:[0,1] op_sel_hi:[1,1]
    v_pk_mul_f16 v137, v137, v128 op_sel:[0,1] op_sel_hi:[1,1]
    v_mfma_f32_16x16x32_bf16 v[186:189], v[174:177], a[196:199], v[186:189]
    v_pk_mul_f16 v144, v144, v128 op_sel:[0,1] op_sel_hi:[1,1]
    v_pk_mul_f16 v145, v145, v128 op_sel:[0,1] op_sel_hi:[1,1]
    v_mfma_f32_16x16x32_bf16 v[186:189], v[178:181], a[200:203], v[186:189]
    v_cvt_pk_bf16_f32 v222, v146, v147
    v_cvt_pk_bf16_f32 v223, v148, v149
    v_mfma_f32_16x16x32_bf16 v[186:189], v[218:221], a[204:207], v[186:189]
    v_pk_mul_f16 v190, v190, v128 op_sel:[0,0] op_sel_hi:[1,0]
    v_pk_mul_f16 v191, v191, v128 op_sel:[0,0] op_sel_hi:[1,0]
    v_mfma_f32_16x16x32_bf16 v[186:189], v[226:229], a[208:211], v[186:189]
    ds_read_b128 v[146:149], v5 offset:0
    ds_read_b128 v[174:177], v5 offset:16
    v_mfma_f32_16x16x32_f16 v[178:181], v[118:121], v[206:209], v[46:49]
    ds_read_b128 v[202:205], v5 offset:48
    ds_read_b32 v166, v6 offset:192
    v_mfma_f32_16x16x32_f16 v[210:213], v[170:173], v[206:209], v[50:53]
    v_pk_mul_f16 v192, v192, v128 op_sel:[0,0] op_sel_hi:[1,0]
    v_pk_mul_f16 v193, v193, v128 op_sel:[0,0] op_sel_hi:[1,0]
    v_mfma_f32_16x16x32_f16 v[218:221], v[134:137], v[206:209], v[54:57]
    v_pk_mul_f16 v142, v142, v128 op_sel:[0,0] op_sel_hi:[1,0]
    v_pk_mul_f16 v143, v143, v128 op_sel:[0,0] op_sel_hi:[1,0]
    v_max3_u32 v45, v45, v126, v127
    v_mfma_f32_16x16x16_f16 v[178:181], v[196:197], v[194:195], v[178:181]
    v_subrev_u32 v140, 0x3d800000, v44
    v_sub_u32 v141, 0x4a000000, v45
    v_or3_b32 v140, v140, v141, v45
    v_mfma_f32_16x16x16_f16 v[210:213], v[160:161], v[194:195], v[210:213]
    v_lshl_add_u32 v141, s16, 2, v164
    v_cndmask_b32 v165, v156, v165, vcc
    v_lshl_add_u32 v154, v255, 4, v165
    v_mfma_f32_16x16x16_f16 v[218:221], v[144:145], v[194:195], v[218:221]
    v_add_u32 v154, s3, v154
    v_lshl_add_u32 v255, v255, 3, v165
    v_exp_f32 v178, v178
    v_mfma_f32_16x16x32_bf16 v[186:189], v[130:133], a[212:215], v[186:189]
    s_waitcnt lgkmcnt(2)
    buffer_store_dwordx4 v[150:153], v17, s[52:55], 0 offen nt
    ds_write_b32 v141, v140 offset:18432
    v_exp_f32 v179, v179
    v_mfma_f32_16x16x32_f16 v[126:129], v[146:149], v[206:209], v[22:25]
    s_waitcnt lgkmcnt(1)
    v_add_u32 v255, s4, v255
    v_cvt_pk_bf16_f32 v130, v178, v179
    v_mfma_f32_16x16x32_f16 v[126:129], v[174:177], v[118:121], v[126:129]
    v_cvt_pk_bf16_f32 v234, v186, v187
    v_cvt_pk_bf16_f32 v235, v188, v189
    v_mfma_f32_16x16x32_f16 v[126:129], v[202:205], v[194:197], v[126:129]
    v_exp_f32 v180, v180
    v_mfma_f32_16x16x32_f16 v[150:153], v[146:149], v[122:125], v[24:27]
    v_exp_f32 v181, v181
    v_mfma_f32_16x16x32_f16 v[150:153], v[174:177], v[170:173], v[150:153]
    v_exp_f32 v210, v210
    v_mfma_f32_16x16x32_f16 v[150:153], v[202:205], v[158:161], v[150:153]
    v_exp_f32 v211, v211
    v_mfma_f32_16x16x32_f16 v[186:189], v[146:149], v[190:193], v[26:29]
    v_mov_b32_dpp v166, v127 quad_perm:[0,1,2,3] row_mask:0x1 bank_mask:0xf
    v_cvt_pk_bf16_f32 v131, v180, v181
    v_mfma_f32_16x16x32_f16 v[186:189], v[174:177], v[134:137], v[186:189]
    v_exp_f32 v212, v212
    v_mfma_f32_16x16x32_f16 v[186:189], v[202:205], v[142:145], v[186:189]
    v_cvt_pk_bf16_f32 v132, v210, v211
    v_mov_b32_dpp v166, v151 quad_perm:[0,1,2,3] row_mask:0x2 bank_mask:0xf
    v_exp_f32 v213, v213
    v_exp_f32 v218, v218
    v_cvt_pk_bf16_f32 v133, v212, v213
    v_exp_f32 v219, v219
    v_mfma_f32_16x16x32_f16 v[146:149], v[118:121], v[122:125], v[58:61]
    v_exp_f32 v220, v220
    v_mfma_f32_16x16x32_f16 v[174:177], v[170:173], v[122:125], v[62:65]
    v_mov_b32_dpp v166, v187 quad_perm:[0,1,2,3] row_mask:0x4 bank_mask:0xf
    v_cvt_pk_bf16_f32 v36, v218, v219
    v_mfma_f32_16x16x32_f16 v[178:181], v[134:137], v[122:125], v[66:69]
    v_exp_f32 v166, v166
    v_mfma_f32_16x16x16_f16 v[146:149], v[196:197], v[158:159], v[146:149]
    buffer_store_dwordx2 v[168:169], v20, s[52:55], 0 offen nt
    v_exp_f32 v221, v221
    v_mfma_f32_16x16x16_f16 v[174:177], v[160:161], v[158:159], v[174:177]
    v_cvt_pk_bf16_f32 v166, v166, v166
    v_exp_f32 v126, v126
    v_mfma_f32_16x16x16_f16 v[178:181], v[144:145], v[158:159], v[178:181]
    ds_write_b16 v8, v166
    v_cvt_pk_bf16_f32 v37, v220, v221
    v_cvt_pk_bf16_f32 v39, v126, 0
    v_exp_f32 v146, v146
    v_mfma_f32_16x16x32_f16 v[122:125], v[118:121], v[190:193], v[70:73]
    v_exp_f32 v147, v147
    v_mfma_f32_16x16x32_bf16 v[118:121], v[28:31], v[36:39], 0
    v_exp_f32 v148, v148
    v_mfma_f32_16x16x32_bf16 v[118:121], v[28:31], v[130:133], v[118:121]
    v_exp_f32 v149, v149
    v_mfma_f32_16x16x32_bf16 v[126:129], v[214:217], v[36:39], 0
    v_cvt_pk_bf16_f32 v146, v146, v147
    v_cvt_pk_bf16_f32 v147, v148, v149
    v_mfma_f32_16x16x32_bf16 v[126:129], v[182:185], v[130:133], v[126:129]
    v_exp_f32 v174, v174
    v_mfma_f32_16x16x32_bf16 v[202:205], v[222:225], v[36:39], 0
    v_exp_f32 v175, v175
    v_mfma_f32_16x16x32_bf16 v[202:205], v[114:117], v[130:133], v[202:205]
    v_rcp_f32 v118, v118
    v_mfma_f32_16x16x32_bf16 v[206:209], v[234:237], v[36:39], 0
    v_exp_f32 v176, v176
    v_mfma_f32_16x16x32_bf16 v[206:209], v[230:233], v[130:133], v[206:209]
    v_mul_f32 v126, v118, v126
    v_mul_f32 v127, v118, v127
    v_mfma_f32_16x16x32_f16 v[130:133], v[170:173], v[190:193], v[74:77]
    v_cvt_pk_bf16_f32 v126, v126, v127
    v_mul_f32 v128, v118, v128
    v_mfma_f32_16x16x32_f16 v[170:173], v[134:137], v[190:193], v[78:81]
    v_mul_f32 v129, v118, v129
    v_cvt_pk_bf16_f32 v127, v128, v129
    v_mul_f32 v202, v118, v202
    v_mfma_f32_16x16x16_f16 v[122:125], v[196:197], v[142:143], v[122:125]
    v_mul_f32 v203, v118, v203
    v_cvt_pk_bf16_f32 v128, v202, v203
    v_mul_f32 v204, v118, v204
    v_mfma_f32_16x16x16_f16 v[130:133], v[160:161], v[142:143], v[130:133]
    v_mul_f32 v205, v118, v205
    v_cvt_pk_bf16_f32 v129, v204, v205
    v_mul_f32 v206, v118, v206
    v_mfma_f32_16x16x16_f16 v[170:173], v[144:145], v[142:143], v[170:173]
    ds_write_b128 v3, v[126:129] offset:0
    v_mul_f32 v207, v118, v207
    v_cvt_pk_bf16_f32 v140, v206, v207
    v_mul_f32 v208, v118, v208
    v_mul_f32 v209, v118, v209
    v_cvt_pk_bf16_f32 v141, v208, v209
    v_cvt_pk_bf16_f32 v148, v174, v175
    v_exp_f32 v177, v177
    ds_write_b64 v4, v[140:141] offset:4096
    v_cvt_pk_bf16_f32 v149, v176, v177
    v_exp_f32 v178, v178
    v_exp_f32 v179, v179
    v_exp_f32 v180, v180
    v_cvt_pk_bf16_f32 v36, v178, v179
    v_exp_f32 v181, v181
    v_exp_f32 v150, v150
    v_cvt_pk_bf16_f32 v37, v180, v181
    v_cvt_pk_bf16_f32 v39, v150, 0
    v_exp_f32 v122, v122
    v_exp_f32 v123, v123
    v_mfma_f32_16x16x32_bf16 v[118:121], v[28:31], v[36:39], 0
    v_exp_f32 v124, v124
    v_mfma_f32_16x16x32_bf16 v[118:121], v[28:31], v[146:149], v[118:121]
    v_exp_f32 v125, v125
    v_mfma_f32_16x16x32_bf16 v[126:129], v[214:217], v[36:39], 0
    s_waitcnt lgkmcnt(0)
    ds_read_b128 v[134:137], v9
    ds_read_b128 v[142:145], v9 offset:64
    v_mfma_f32_16x16x32_bf16 v[126:129], v[182:185], v[146:149], v[126:129]
    s_barrier
    ds_read_b128 v[150:153], v164 offset:0
    ds_read_b128 v[158:161], v164 offset:1024
    v_mfma_f32_16x16x32_bf16 v[174:177], v[222:225], v[36:39], 0
    v_cvt_pk_bf16_f32 v122, v122, v123
    v_cvt_pk_bf16_f32 v123, v124, v125
    v_mfma_f32_16x16x32_bf16 v[174:177], v[114:117], v[146:149], v[174:177]
    ds_read_b128 v[178:181], v164 offset:2048
    ds_read_b128 v[190:193], v164 offset:3072
    v_mfma_f32_16x16x32_bf16 v[194:197], v[234:237], v[36:39], 0
    v_exp_f32 v130, v130
    v_mfma_f32_16x16x32_bf16 v[194:197], v[230:233], v[146:149], v[194:197]
    ds_read_b128 v[146:149], v164 offset:4096
    ds_read_b128 v[202:205], v164 offset:5120
    v_exp_f32 v131, v131
    v_exp_f32 v132, v132
    v_cvt_pk_bf16_f32 v124, v130, v131
    v_exp_f32 v133, v133
    s_waitcnt lgkmcnt(6)
    v_mfma_f32_16x16x32_bf16 v[206:209], v[134:137], v[28:31], 0
    v_exp_f32 v170, v170
    v_mfma_f32_16x16x32_bf16 v[206:209], v[142:145], v[28:31], v[206:209]
    s_waitcnt lgkmcnt(4)
    v_exp_f32 v171, v171
    v_mfma_f32_16x16x32_bf16 v[210:213], a[216:219], v[150:153], 0
    v_cvt_pk_bf16_f32 v125, v132, v133
    v_cvt_pk_bf16_f32 v36, v170, v171
    v_mfma_f32_16x16x32_bf16 v[210:213], a[220:223], v[158:161], v[210:213]
    s_waitcnt lgkmcnt(2)
    v_exp_f32 v172, v172
    v_mfma_f32_16x16x32_bf16 v[210:213], a[224:227], v[178:181], v[210:213]
    v_exp_f32 v173, v173
    v_mfma_f32_16x16x32_bf16 v[210:213], a[228:231], v[190:193], v[210:213]
    s_waitcnt lgkmcnt(0)
    v_exp_f32 v186, v186
    v_mfma_f32_16x16x32_bf16 v[210:213], a[232:235], v[146:149], v[210:213]
    v_cvt_pk_bf16_f32 v37, v172, v173
    v_cvt_pk_bf16_f32 v39, v186, 0
    v_mfma_f32_16x16x32_bf16 v[210:213], a[236:239], v[202:205], v[210:213]
    v_rcp_f32 v118, v118
    v_mfma_f32_16x16x32_bf16 v[130:133], a[240:243], v[150:153], 0
    v_mul_f32 v126, v118, v126
    v_mul_f32 v127, v118, v127
    v_mfma_f32_16x16x32_bf16 v[130:133], a[244:247], v[158:161], v[130:133]
    v_cvt_pk_bf16_f32 v126, v126, v127
    v_mul_f32 v128, v118, v128
    v_mfma_f32_16x16x32_bf16 v[130:133], a[248:251], v[178:181], v[130:133]
    v_fma_f32 v165, v210, v210, s33
    v_fmac_f32 v165, v211, v211
    v_mfma_f32_16x16x32_bf16 v[130:133], a[252:255], v[190:193], v[130:133]
    v_fmac_f32 v165, v212, v212
    v_fmac_f32 v165, v213, v213
    v_mfma_f32_16x16x32_bf16 v[130:133], v[82:85], v[146:149], v[130:133]
    v_mul_f32 v129, v118, v129
    v_cvt_pk_bf16_f32 v127, v128, v129
    v_mfma_f32_16x16x32_bf16 v[130:133], v[86:89], v[202:205], v[130:133]
    v_mul_f32 v174, v118, v174
    v_mul_f32 v175, v118, v175
    v_mfma_f32_16x16x32_bf16 v[170:173], v[90:93], v[150:153], 0
    v_cvt_pk_bf16_f32 v128, v174, v175
    v_mul_f32 v176, v118, v176
    v_mfma_f32_16x16x32_bf16 v[170:173], v[94:97], v[158:161], v[170:173]
    v_mul_f32 v177, v118, v177
    v_cvt_pk_bf16_f32 v129, v176, v177
    v_mfma_f32_16x16x32_bf16 v[170:173], v[98:101], v[178:181], v[170:173]
    ds_write_b128 v3, v[126:129] offset:6144
    v_mfma_f32_16x16x32_bf16 v[170:173], v[102:105], v[190:193], v[170:173]
    v_fmac_f32 v165, v130, v130
    v_fmac_f32 v165, v131, v131
    v_mfma_f32_16x16x32_bf16 v[170:173], v[106:109], v[146:149], v[170:173]
    v_fmac_f32 v165, v132, v132
    v_fmac_f32 v165, v133, v133
    v_mfma_f32_16x16x32_bf16 v[170:173], v[110:113], v[202:205], v[170:173]
    v_mul_f32 v194, v118, v194
    v_mul_f32 v195, v118, v195
    v_mfma_f32_16x16x32_bf16 v[126:129], v[134:137], v[182:185], 0
    v_cvt_pk_bf16_f32 v140, v194, v195
    v_mul_f32 v196, v118, v196
    v_mfma_f32_16x16x32_bf16 v[126:129], v[142:145], v[214:217], v[126:129]
    v_mul_f32 v197, v118, v197
    v_cvt_pk_bf16_f32 v141, v196, v197
    v_mfma_f32_16x16x32_bf16 v[118:121], v[134:137], v[114:117], 0
    ds_write_b64 v4, v[140:141] offset:10240
    v_mfma_f32_16x16x32_bf16 v[118:121], v[142:145], v[222:225], v[118:121]
    v_rcp_f32 v206, v206
    v_mfma_f32_16x16x32_bf16 v[146:149], v[134:137], v[230:233], 0
    v_fmac_f32 v165, v170, v170
    v_fmac_f32 v165, v171, v171
    v_mfma_f32_16x16x32_bf16 v[146:149], v[142:145], v[234:237], v[146:149]
    v_fmac_f32 v165, v172, v172
    v_fmac_f32 v165, v173, v173
    v_mfma_f32_16x16x32_bf16 v[134:137], v[28:31], v[36:39], 0
    v_cvt_pk_bf16_f32 v140, v165, v165
    v_cvt_pk_bf16_f32 v141, v165, v165
    v_mfma_f32_16x16x32_bf16 v[134:137], v[28:31], v[122:125], v[134:137]
    ds_write_b64 v163, v[140:141] offset:4096
    v_mfma_f32_16x16x32_bf16 v[142:145], v[214:217], v[36:39], 0
    v_mul_f32 v126, v126, v206
    v_mul_f32_dpp v126, v118, v206 quad_perm:[0,1,2,3] row_mask:0x2 bank_mask:0xf
    v_mfma_f32_16x16x32_bf16 v[142:145], v[182:185], v[122:125], v[142:145]
    v_mul_f32_dpp v126, v146, v206 quad_perm:[0,1,2,3] row_mask:0x4 bank_mask:0xf
    v_cvt_pk_bf16_f32 v126, v126, v126
    v_mfma_f32_16x16x32_bf16 v[118:121], v[222:225], v[36:39], 0
    ds_write_b16 v7, v126
    v_mfma_f32_16x16x32_bf16 v[118:121], v[114:117], v[122:125], v[118:121]
    v_rcp_f32 v134, v134
    v_mfma_f32_16x16x32_bf16 v[114:117], v[234:237], v[36:39], 0
    v_mfma_f32_16x16x32_bf16 v[114:117], v[230:233], v[122:125], v[114:117]
    v_mul_f32 v142, v134, v142
    v_mul_f32 v143, v134, v143
    v_cvt_pk_bf16_f32 v122, v142, v143
    v_mul_f32 v144, v134, v144
    v_mul_f32 v145, v134, v145
    v_cvt_pk_bf16_f32 v123, v144, v145
    v_mul_f32 v118, v134, v118
    v_mul_f32 v119, v134, v119
    v_cvt_pk_bf16_f32 v124, v118, v119
    v_mul_f32 v120, v134, v120
    v_mul_f32 v121, v134, v121
    v_cvt_pk_bf16_f32 v125, v120, v121
    ds_write_b128 v3, v[122:125] offset:12288
    s_waitcnt lgkmcnt(1)
    s_barrier
    v_mul_f32 v114, v134, v114
    v_mul_f32 v115, v134, v115
    v_cvt_pk_bf16_f32 v140, v114, v115
    v_mul_f32 v116, v134, v116
    v_mul_f32 v117, v134, v117
    ds_read_b128 v[118:121], v162 offset:4096
    ds_read_b128 v[122:125], v162 offset:5120
    ds_read_b128 v[126:129], v164 offset:6144
    ds_read_b128 v[134:137], v164 offset:7168
    ds_read_b128 v[142:145], v164 offset:8192
    ds_read_b128 v[146:149], v164 offset:9216
    ds_read_b128 v[150:153], v164 offset:10240
    ds_read_b128 v[158:161], v164 offset:11264
    v_cvt_pk_bf16_f32 v141, v116, v117
    ds_write_b64 v4, v[140:141] offset:16384
    s_waitcnt lgkmcnt(8)
    v_mfma_f32_16x16x32_bf16 v[114:117], v[32:35], v[118:121], 0
    s_waitcnt lgkmcnt(6)
    v_mfma_f32_16x16x32_bf16 v[114:117], v[32:35], v[122:125], v[114:117]
    s_waitcnt lgkmcnt(5)
    v_mfma_f32_16x16x32_bf16 v[118:121], a[216:219], v[126:129], 0
    s_waitcnt lgkmcnt(4)
    v_mfma_f32_16x16x32_bf16 v[118:121], a[220:223], v[134:137], v[118:121]
    s_waitcnt lgkmcnt(3)
    v_mfma_f32_16x16x32_bf16 v[118:121], a[224:227], v[142:145], v[118:121]
    s_waitcnt lgkmcnt(2)
    v_mfma_f32_16x16x32_bf16 v[118:121], a[228:231], v[146:149], v[118:121]
    s_waitcnt lgkmcnt(1)
    v_mul_f32 v165, 0x3baaaaab, v114
    v_mfma_f32_16x16x32_bf16 v[118:121], a[232:235], v[150:153], v[118:121]
    v_rsq_f32 v165, v165
    v_mfma_f32_16x16x32_bf16 v[118:121], a[236:239], v[158:161], v[118:121]
    v_mul_f32 v210, v165, v210
    v_mul_f32 v211, v165, v211
    v_mfma_f32_16x16x32_bf16 v[114:117], a[240:243], v[126:129], 0
    v_cvt_pk_bf16_f32 v122, v210, v211
    v_mul_f32 v212, v165, v212
    v_mfma_f32_16x16x32_bf16 v[114:117], a[244:247], v[134:137], v[114:117]
    v_mul_f32 v213, v165, v213
    v_cvt_pk_bf16_f32 v123, v212, v213
    v_mfma_f32_16x16x32_bf16 v[114:117], a[248:251], v[142:145], v[114:117]
    v_mul_f32 v130, v165, v130
    v_mul_f32 v131, v165, v131
    v_mfma_f32_16x16x32_bf16 v[114:117], a[252:255], v[146:149], v[114:117]
    v_cvt_pk_bf16_f32 v124, v130, v131
    v_mul_f32 v132, v165, v132
    v_mfma_f32_16x16x32_bf16 v[114:117], v[82:85], v[150:153], v[114:117]
    v_mul_f32 v133, v165, v133
    v_cvt_pk_bf16_f32 v125, v132, v133
    v_mfma_f32_16x16x32_bf16 v[114:117], v[86:89], v[158:161], v[114:117]
    buffer_store_dwordx4 v[122:125], v15, s[56:59], 0 offen nt
    v_mul_f32 v170, v165, v170
    v_mul_f32 v171, v165, v171
    v_cvt_pk_bf16_f32 v140, v170, v171
    v_mul_f32 v172, v165, v172
    v_mfma_f32_16x16x32_bf16 v[122:125], v[90:93], v[126:129], 0
    ds_read_b128 v[126:129], v155 offset:256
    v_mul_f32 v173, v165, v173
    v_mfma_f32_16x16x32_bf16 v[122:125], v[94:97], v[134:137], v[122:125]
    ds_read_b128 v[130:133], v155 offset:2304
    v_cvt_pk_bf16_f32 v141, v172, v173
    v_mfma_f32_16x16x32_bf16 v[122:125], v[98:101], v[142:145], v[122:125]
    ds_read_b128 v[134:137], v155 offset:4352
    v_fma_f32 v165, v118, v118, s33
    v_mfma_f32_16x16x32_bf16 v[122:125], v[102:105], v[146:149], v[122:125]
    ds_read_b128 v[142:145], v155 offset:6400
    v_fmac_f32 v165, v119, v119
    v_mfma_f32_16x16x32_bf16 v[122:125], v[106:109], v[150:153], v[122:125]
    ds_read_b128 v[146:149], v155 offset:8448
    v_fmac_f32 v165, v120, v120
    v_mfma_f32_16x16x32_bf16 v[122:125], v[110:113], v[158:161], v[122:125]
    ds_read_b128 v[150:153], v155 offset:10496
    v_fmac_f32 v165, v121, v121
    v_fmac_f32 v165, v114, v114
    v_fmac_f32 v165, v115, v115
    v_fmac_f32 v165, v116, v116
    v_fmac_f32 v165, v117, v117
    s_nop 0
    s_nop 0
    s_waitcnt lgkmcnt(5)
    v_mfma_f32_16x16x32_bf16 v[158:161], a[216:219], v[126:129], 0
    v_fmac_f32 v165, v122, v122
    v_fmac_f32 v165, v123, v123
    v_mfma_f32_16x16x32_bf16 v[170:173], a[240:243], v[126:129], 0
    s_waitcnt lgkmcnt(4)
    v_fmac_f32 v165, v124, v124
    v_fmac_f32 v165, v125, v125
    v_mfma_f32_16x16x32_bf16 v[158:161], a[220:223], v[130:133], v[158:161]
    s_waitcnt lgkmcnt(3)
    v_cvt_pk_bf16_f32 v156, v165, v165
    v_cvt_pk_bf16_f32 v157, v165, v165
    v_mfma_f32_16x16x32_bf16 v[158:161], a[224:227], v[134:137], v[158:161]
    s_waitcnt lgkmcnt(2)
    ds_write_b64 v163, v[156:157] offset:6144
    v_mfma_f32_16x16x32_bf16 v[158:161], a[228:231], v[142:145], v[158:161]
    s_waitcnt lgkmcnt(2)
    v_mfma_f32_16x16x32_bf16 v[158:161], a[232:235], v[146:149], v[158:161]
    s_waitcnt lgkmcnt(1)
    v_mfma_f32_16x16x32_bf16 v[158:161], a[236:239], v[150:153], v[158:161]
    v_mfma_f32_16x16x32_bf16 v[170:173], a[244:247], v[130:133], v[170:173]
    buffer_store_dwordx2 v[140:141], v18, s[56:59], 0 offen nt
    v_mfma_f32_16x16x32_bf16 v[170:173], a[248:251], v[134:137], v[170:173]
    v_mfma_f32_16x16x32_bf16 v[170:173], a[252:255], v[142:145], v[170:173]
    v_mfma_f32_16x16x32_bf16 v[170:173], v[82:85], v[146:149], v[170:173]
    s_waitcnt lgkmcnt(0)
    v_mfma_f32_16x16x32_bf16 v[170:173], v[86:89], v[150:153], v[170:173]
    s_barrier
    ds_read_b128 v[174:177], v162 offset:6144
    ds_read_b128 v[178:181], v162 offset:7168
    v_mfma_f32_16x16x32_bf16 v[182:185], v[90:93], v[126:129], 0
    ds_read_b128 v[126:129], v164 offset:12288
    v_fma_f32 v165, v158, v158, s33
    v_mfma_f32_16x16x32_bf16 v[182:185], v[94:97], v[130:133], v[182:185]
    ds_read_b128 v[130:133], v164 offset:13312
    v_fmac_f32 v165, v159, v159
    v_mfma_f32_16x16x32_bf16 v[182:185], v[98:101], v[134:137], v[182:185]
    ds_read_b128 v[134:137], v164 offset:14336
    v_fmac_f32 v165, v160, v160
    v_mfma_f32_16x16x32_bf16 v[182:185], v[102:105], v[142:145], v[182:185]
    ds_read_b128 v[142:145], v164 offset:15360
    v_fmac_f32 v165, v161, v161
    v_mfma_f32_16x16x32_bf16 v[182:185], v[106:109], v[146:149], v[182:185]
    ds_read_b128 v[146:149], v164 offset:16384
    v_fmac_f32 v165, v170, v170
    v_mfma_f32_16x16x32_bf16 v[182:185], v[110:113], v[150:153], v[182:185]
    ds_read_b128 v[150:153], v164 offset:17408
    v_fmac_f32 v165, v171, v171
    v_fmac_f32 v165, v172, v172
    v_fmac_f32 v165, v173, v173
    s_waitcnt lgkmcnt(7)
    v_mfma_f32_16x16x32_bf16 v[186:189], v[32:35], v[174:177], 0
    s_waitcnt lgkmcnt(6)
    v_mfma_f32_16x16x32_bf16 v[186:189], v[32:35], v[178:181], v[186:189]
    s_waitcnt lgkmcnt(5)
    v_fmac_f32 v165, v182, v182
    v_fmac_f32 v165, v183, v183
    v_mfma_f32_16x16x32_bf16 v[174:177], a[216:219], v[126:129], 0
    s_waitcnt lgkmcnt(4)
    v_fmac_f32 v165, v184, v184
    v_fmac_f32 v165, v185, v185
    v_mfma_f32_16x16x32_bf16 v[174:177], a[220:223], v[130:133], v[174:177]
    s_waitcnt lgkmcnt(3)
    v_cvt_pk_bf16_f32 v140, v165, v165
    v_cvt_pk_bf16_f32 v141, v165, v165
    v_mfma_f32_16x16x32_bf16 v[174:177], a[224:227], v[134:137], v[174:177]
    s_waitcnt lgkmcnt(2)
    ds_write_b64 v163, v[140:141] offset:8192
    v_mfma_f32_16x16x32_bf16 v[174:177], a[228:231], v[142:145], v[174:177]
    s_waitcnt lgkmcnt(2)
    v_mul_f32 v165, 0x3baaaaab, v186
    v_mfma_f32_16x16x32_bf16 v[174:177], a[232:235], v[146:149], v[174:177]
    s_waitcnt lgkmcnt(1)
    v_rsq_f32 v165, v165
    v_mfma_f32_16x16x32_bf16 v[174:177], a[236:239], v[150:153], v[174:177]
    v_mul_f32 v118, v165, v118
    v_mul_f32 v119, v165, v119
    v_mfma_f32_16x16x32_bf16 v[178:181], a[240:243], v[126:129], 0
    v_cvt_pk_bf16_f32 v118, v118, v119
    v_mul_f32 v120, v165, v120
    v_mfma_f32_16x16x32_bf16 v[178:181], a[244:247], v[130:133], v[178:181]
    v_mul_f32 v121, v165, v121
    v_cvt_pk_bf16_f32 v119, v120, v121
    v_mfma_f32_16x16x32_bf16 v[178:181], a[248:251], v[134:137], v[178:181]
    v_fma_f32 v140, v174, v174, s33
    v_fmac_f32 v140, v175, v175
    v_mfma_f32_16x16x32_bf16 v[178:181], a[252:255], v[142:145], v[178:181]
    s_waitcnt lgkmcnt(0)
    v_fmac_f32 v140, v176, v176
    v_fmac_f32 v140, v177, v177
    v_mfma_f32_16x16x32_bf16 v[178:181], v[82:85], v[146:149], v[178:181]
    s_barrier
    ds_read_b128 v[186:189], v162 offset:8192
    ds_read_b128 v[190:193], v162 offset:9216
    v_mfma_f32_16x16x32_bf16 v[178:181], v[86:89], v[150:153], v[178:181]
    v_mul_f32 v114, v165, v114
    v_mul_f32 v115, v165, v115
    v_mfma_f32_16x16x32_bf16 v[194:197], v[90:93], v[126:129], 0
    v_cvt_pk_bf16_f32 v120, v114, v115
    v_mul_f32 v116, v165, v116
    v_mfma_f32_16x16x32_bf16 v[194:197], v[94:97], v[130:133], v[194:197]
    v_mul_f32 v117, v165, v117
    v_cvt_pk_bf16_f32 v121, v116, v117
    v_mfma_f32_16x16x32_bf16 v[194:197], v[98:101], v[134:137], v[194:197]
    ds_write_b128 v167, v[118:121] offset:1536
    v_mfma_f32_16x16x32_bf16 v[194:197], v[102:105], v[142:145], v[194:197]
    v_fmac_f32 v140, v178, v178
    v_fmac_f32 v140, v179, v179
    v_mfma_f32_16x16x32_bf16 v[194:197], v[106:109], v[146:149], v[194:197]
    v_fmac_f32 v140, v180, v180
    v_fmac_f32 v140, v181, v181
    v_mfma_f32_16x16x32_bf16 v[194:197], v[110:113], v[150:153], v[194:197]
    s_waitcnt lgkmcnt(1)
    ds_read_b128 v[114:117], v139 offset:1536
    v_mul_f32 v122, v165, v122
    v_mfma_f32_16x16x32_bf16 v[118:121], v[32:35], v[186:189], 0
    v_mul_f32 v123, v165, v123
    v_cvt_pk_bf16_f32 v122, v122, v123
    v_mfma_f32_16x16x32_bf16 v[118:121], v[32:35], v[190:193], v[118:121]
    v_mul_f32 v124, v165, v124
    v_fmac_f32 v140, v194, v194
    v_fmac_f32 v140, v195, v195
    v_fmac_f32 v140, v196, v196
    v_fmac_f32 v140, v197, v197
    v_cvt_pk_bf16_f32 v156, v140, v140
    v_cvt_pk_bf16_f32 v157, v140, v140
    ds_write_b64 v163, v[156:157] offset:0
    v_mul_f32 v123, 0x3baaaaab, v118
    v_rsq_f32 v123, v123
    v_mul_f32 v125, v165, v125
    v_mul_f32 v158, v123, v158
    v_mul_f32 v159, v123, v159
    v_cvt_pk_bf16_f32 v118, v158, v159
    v_mul_f32 v160, v123, v160
    s_waitcnt lgkmcnt(1)
    v_mul_f32 v161, v123, v161
    v_cvt_pk_bf16_f32 v119, v160, v161
    v_mul_f32 v170, v123, v170
    v_mul_f32 v171, v123, v171
    v_cvt_pk_bf16_f32 v120, v170, v171
    v_mul_f32 v172, v123, v172
    v_mul_f32 v173, v123, v173
    v_cvt_pk_bf16_f32 v121, v172, v173
    buffer_store_dwordx4 v[118:121], v154, s[12:15], 0 offen nt
    v_mul_f32 v182, v123, v182
    v_mul_f32 v183, v123, v183
    v_cvt_pk_bf16_f32 v140, v182, v183
    v_mul_f32 v184, v123, v184
    v_mul_f32 v185, v123, v185
    s_waitcnt lgkmcnt(0)
    s_barrier
    ds_read_b128 v[118:121], v162 offset:0
    ds_read_b128 v[126:129], v162 offset:1024
    ds_read_b128 v[130:133], v164 offset:18432
    v_cvt_pk_bf16_f32 v141, v184, v185
    v_cvt_pk_bf16_f32 v123, v124, v125
    ds_write_b64 v138, v[122:123] offset:2560
    buffer_store_dwordx2 v[140:141], v255, s[12:15], 0 offen nt
    ds_read_b64 v[168:169], v254 offset:2560
    s_waitcnt lgkmcnt(4)
    v_mfma_f32_16x16x32_bf16 v[122:125], v[32:35], v[118:121], 0
    s_waitcnt lgkmcnt(3)
    v_mfma_f32_16x16x32_bf16 v[122:125], v[32:35], v[126:129], v[122:125]
    s_waitcnt lgkmcnt(2)
    v_or3_b32 v130, v130, v131, v132
    v_or_b32 v130, v130, v133
    v_cmp_gt_i32 s[46:47], 0, v130
    s_nop 0
    s_nop 0
    s_nop 0
    s_nop 0
    v_mul_f32 v255, 0x3baaaaab, v122
    v_rsq_f32 v255, v255
    s_nop 0
    v_mul_f32 v174, v255, v174
    buffer_store_dwordx4 v[114:117], v198, s[56:59], 0 offen nt
    s_waitcnt lgkmcnt(0)
    v_mul_f32 v175, v255, v175
    v_cvt_pk_bf16_f32 v114, v174, v175
    v_mul_f32 v176, v255, v176
    v_mul_f32 v177, v255, v177
    v_cvt_pk_bf16_f32 v115, v176, v177
    v_mul_f32 v178, v255, v178
    v_mul_f32 v179, v255, v179
    v_cvt_pk_bf16_f32 v116, v178, v179
    v_mul_f32 v180, v255, v180
    v_mul_f32 v181, v255, v181
    v_cvt_pk_bf16_f32 v117, v180, v181
    ds_write_b128 v167, v[114:117] offset:3072
    buffer_store_dwordx2 v[168:169], v199, s[56:59], 0 offen nt
    v_mul_f32 v194, v255, v194
    v_mul_f32 v195, v255, v195
    v_cvt_pk_bf16_f32 v198, v194, v195
    v_mul_f32 v196, v255, v196
    v_mul_f32 v197, v255, v197
    v_cvt_pk_bf16_f32 v199, v196, v197
    ds_read_b128 v[114:117], v139 offset:3072
    ds_write_b64 v138, v[198:199] offset:4096
    ds_read_b64 v[198:199], v254 offset:4096
    s_waitcnt lgkmcnt(2)
    buffer_store_dwordx4 v[114:117], v200, s[56:59], 0 offen nt
    s_waitcnt lgkmcnt(0)
    buffer_store_dwordx2 v[198:199], v201, s[56:59], 0 offen nt
L_end:
    s_nop 1
    s_cmp_lg_u64 s[46:47], 0
    s_cbranch_scc1 L_rerun
L_done:
    s_endpgm
L_slow:
    s_mov_b32 s44, 0xff
    s_branch L_redo
L_rerun:
    s_mov_b32 s44, 0x7f000000
L_redo:
    s_waitcnt vmcnt(0) lgkmcnt(0)
    s_barrier
    v_mbcnt_lo_u32_b32 v0, -1, 0
    v_mbcnt_hi_u32_b32 v0, -1, v0
    v_lshl_add_u32 v0, s16, 6, v0
    s_nop 7
    s_branch L_again
L_edge:
    v_mov_b32 v254, v0
    v_mov_b32 v255, 0x40000000
    s_lshl_b32 s3, s16, 4
    s_load_dwordx4 s[92:95], s[0:1], s3
    v_and_b32 v118, 63, v0
    s_bfe_u32 s3, s2, 0x50003
    s_lshl_b32 s4, s16, 3
    s_lshr_b32 s98, 0x06143a01, s4
    s_and_b32 s98, s98, 0xff
    s_mul_i32 s3, s3, s98
    s_sub_u32 s98, s98, 1
    s_lshr_b32 s4, 0x0048d800, s4
    s_and_b32 s4, s4, 0xff
    s_lshl_b32 s4, s4, 3
    s_max_u32 s4, s4, 6
    s_sub_u32 s4, s4, s98
    s_sub_u32 s4, s4, 1
    s_min_u32 s3, s3, s4
    v_min_u32 v120, s98, v118
    v_add_lshl_u32 v120, v120, s3, 7
    v_mov_b32 v121, 0
    v_lshrrev_b32 v119, 4, v118
    v_and_b32 v130, 15, v118
    s_mov_b32 s10, 100270464
    s_mov_b32 s11, 0x00020000
    s_mov_b32 s50, 221184
    s_mov_b32 s51, 0x00020000
    v_mul_u32_u24 v131, 171, v118
    v_lshrrev_b32 v131, 10, v131
    v_lshrrev_b32 v132, 1, v131
    v_xor_b32 v132, v132, v131
    v_and_b32 v132, 4, v132
    v_mul_u32_u24 v132, 3, v132
    v_xor_b32 v132, v132, v131
    v_mul_u32_u24 v132, 1152, v132
    v_mul_u32_u24 v133, 96, v131
    v_sub_u32 v132, v132, v133
    v_lshl_add_u32 v133, v118, 4, v132
    v_add_u32 v132, 64, v118
    v_mul_u32_u24 v132, 171, v132
    v_lshrrev_b32 v132, 10, v132
    v_lshrrev_b32 v134, 1, v132
    v_xor_b32 v134, v134, v132
    v_and_b32 v134, 4, v134
    v_mul_u32_u24 v134, 3, v134
    v_xor_b32 v134, v134, v132
    v_mul_u32_u24 v134, 1152, v134
    v_mul_u32_u24 v135, 96, v132
    v_sub_u32 v134, v134, v135
    v_lshl_add_u32 v135, v118, 4, v134
    v_add_u32 v134, 128, v118
    v_mul_u32_u24 v134, 171, v134
    v_lshrrev_b32 v134, 10, v134
    v_lshrrev_b32 v136, 1, v134
    v_xor_b32 v136, v136, v134
    v_and_b32 v136, 4, v136
    v_mul_u32_u24 v136, 3, v136
    v_xor_b32 v136, v136, v134
    v_mul_u32_u24 v136, 1152, v136
    v_mul_u32_u24 v137, 96, v134
    v_sub_u32 v136, v136, v137
    v_lshl_add_u32 v137, v118, 4, v136
    s_mul_i32 s68, s16, 6144
    s_add_u32 s69, s68, 65536
    s_cmp_eq_u32 s16, 3
    s_cselect_b32 s68, 136704, s68
    s_cselect_b32 s69, 142848, s69
    s_mul_i32 s45, s16, 96
    s_mov_b32 s70, 193536
    s_mov_b32 s36, 100270464
    s_mov_b32 s22, 1180032
    s_mul_i32 s3, s2, 911
    s_lshr_b32 s3, s3, 16
    s_mul_i32 s35, s3, 72
    s_sub_u32 s38, s2, s35
    s_mul_i32 s3, s3, 1373568
    s_mul_i32 s35, s38, 2688
    s_add_u32 s3, s3, s35
    s_add_u32 s25, s3, 589824
    s_add_u32 s7, s3, 1769472
    s_mov_b32 s20, 31
    s_mov_b32 s21, 4204032
    s_cmp_lt_u32 s2, 244
    s_cselect_b32 s17, 21, 20
    s_mov_b32 s5, 0
    s_mov_b32 s6, 0
    s_cmp_lt_u32 s2, 247
    s_cbranch_scc1 L_inner
    s_mov_b32 s20, 0
    s_mov_b32 s38, 0
    s_sub_u32 s3, s2, 247
    s_and_b32 s3, s3, 3
    s_mul_i32 s3, s3, 7
    s_add_u32 s3, s3, 3
    s_mov_b32 s35, 196224
    s_cmp_lt_u32 s2, 251
    s_cselect_b32 s35, s35, 384
    s_cselect_b32 s6, 1, 0
    s_cselect_b32 s5, 0, 1
    s_mul_i32 s25, s3, s35
    s_mul_i32 s21, s35, 28
    s_cmp_lt_u32 s2, 255
    s_cselect_b32 s17, 18, 1
    s_cselect_b32 s25, s25, 0
    s_cselect_b32 s6, s6, 1
    s_add_u32 s7, s25, 1179648
L_inner:
    s_mul_i32 s3, s5, 99485568
    s_mul_i32 s35, s5, -784896
    v_mov_b32 v136, s3
    v_mov_b32 v138, s35
    s_add_u32 s7, s7, s35
    s_mul_i32 s3, s6, 194688
    s_mul_i32 s35, s6, -1536
    v_mov_b32 v139, s3
    v_mov_b32 v140, s35
    s_add_u32 s7, s7, s35
    v_mul_u32_u24 v141, 2731, v254
    v_bfe_u32 v142, v141, 17, 3
    v_lshrrev_b32 v141, 16, v141
    v_xor_b32 v143, v142, v254
    v_mul_u32_u24 v142, 37, v141
    v_lshrrev_b32 v142, 8, v142
    v_lshlrev_b32 v143, 4, v143
    v_mad_u32_u24 v10, v142, s70, v143
    v_mul_u32_u24 v142, 37, v141
    v_lshrrev_b32 v142, 8, v142
    v_mul_u32_u24 v144, 7, v142
    v_sub_u32 v144, v141, v144
    v_cmp_gt_u32 vcc, 4, v142
    s_nop 1
    v_cndmask_b32 v142, v138, v136, vcc
    v_cmp_gt_u32 vcc, 4, v144
    s_nop 1
    v_cndmask_b32 v144, v140, v139, vcc
    v_add3_u32 v10, v10, v142, v144
    v_mul_u32_u24 v142, s20, v141
    v_add_u32 v142, s38, v142
    v_mul_u32_u24 v142, 911, v142
    v_lshrrev_b32 v142, 16, v142
    v_mul_u32_u24 v142, s22, v142
    v_mad_u32_u24 v142, v141, s21, v142
    v_cmp_gt_u32 vcc, s17, v141
    v_add_u32 v142, s7, v142
    s_nop 0
    v_cndmask_b32 v142, v255, v142, vcc
    v_mul_u32_u24 v141, 384, v141
    v_sub_u32 v141, v143, v141
    v_add_u32 v142, v142, v141
    v_add_u32 v141, 256, v254
    v_mul_u32_u24 v143, 2731, v141
    v_bfe_u32 v144, v143, 17, 3
    v_lshrrev_b32 v143, 16, v143
    v_xor_b32 v141, v144, v141
    v_mul_u32_u24 v144, 37, v143
    v_lshrrev_b32 v144, 8, v144
    v_lshlrev_b32 v141, 4, v141
    v_mad_u32_u24 v11, v144, s70, v141
    v_mul_u32_u24 v144, 37, v143
    v_lshrrev_b32 v144, 8, v144
    v_mul_u32_u24 v145, 7, v144
    v_sub_u32 v145, v143, v145
    v_cmp_gt_u32 vcc, 4, v144
    s_nop 1
    v_cndmask_b32 v144, v138, v136, vcc
    v_cmp_gt_u32 vcc, 4, v145
    s_nop 1
    v_cndmask_b32 v145, v140, v139, vcc
    v_add3_u32 v11, v11, v144, v145
    v_mul_u32_u24 v144, s20, v143
    v_add_u32 v144, s38, v144
    v_mul_u32_u24 v144, 911, v144
    v_lshrrev_b32 v144, 16, v144
    v_mul_u32_u24 v144, s22, v144
    v_mad_u32_u24 v144, v143, s21, v144
    v_cmp_gt_u32 vcc, s17, v143
    v_add_u32 v144, s7, v144
    s_nop 0
    v_cndmask_b32 v144, v255, v144, vcc
    v_mul_u32_u24 v143, 384, v143
    v_sub_u32 v143, v141, v143
    v_add_u32 v144, v144, v143
    s_lshl_b32 s28, s16, 10
    s_add_u32 s28, s28, 20480
    s_waitcnt lgkmcnt(0)
    s_load_dword s101, s[92:93], 0
    s_load_dword s101, s[94:95], 0
    s_cmp_eq_u32 s16, 2
    s_cselect_b64 s[98:99], s[80:81], s[78:79]
    s_cmp_eq_u32 s16, 3
    s_cselect_b64 s[98:99], s[88:89], s[98:99]
    s_mov_b64 s[8:9], s[76:77]
    v_lshl_add_u64 v[120:121], s[98:99], 0, v[120:121]
    s_cmp_eq_u32 s16, 2
    s_cselect_b64 s[98:99], s[84:85], s[82:83]
    s_cmp_eq_u32 s16, 3
    s_cselect_b64 s[98:99], s[86:87], s[98:99]
    v_writelane_b32 v120, s98, 63
    v_writelane_b32 v121, s99, 63
    s_cmp_eq_u32 s16, 0
    s_cbranch_scc1 L_nowue
    global_load_dword a254, v[120:121], off
L_nowue:
    s_add_u32 m0, s28, 128512
    s_nop 0
    buffer_load_dwordx4 v142, s[8:11], 0 offen nt lds
    s_add_u32 m0, s28, 132608
    s_nop 0
    buffer_load_dwordx4 v144, s[8:11], 0 offen nt lds
    s_add_u32 m0, s28, 0
    s_nop 0
    buffer_load_dwordx4 v10, s[8:11], s25 offen nt lds
    s_add_u32 m0, s28, 4096
    s_nop 0
    buffer_load_dwordx4 v11, s[8:11], s25 offen nt lds
    s_mov_b64 s[48:49], s[78:79]
    s_mov_b64 s[52:53], s[80:81]
    s_mov_b64 s[60:61], s[84:85]
    s_mov_b64 s[64:65], s[86:87]
    s_mov_b64 s[56:57], s[88:89]
    s_mov_b64 s[46:47], s[82:83]
    s_load_dwordx2 s[42:43], s[0:1], 72
    s_add_u32 m0, s68, 0
    s_add_u32 s4, s45, 384
    v_add_u32 v141, s16, v118
    v_and_b32 v141, 3, v141
    v_lshlrev_b32 v141, 1, v141
    s_mov_b32 s54, 73728
    s_mov_b32 s55, 0x00020000
    s_mov_b32 s62, 64
    s_mov_b32 s63, 0x00020000
    s_mov_b32 s66, 128
    s_mov_b32 s67, 0x00020000
    s_mov_b32 s58, 676
    s_mov_b32 s59, 0x00020000
    s_mov_b32 s14, 0
    s_mov_b32 s15, 0x00020000
    v_mov_b32 v117, 0
    v_cmp_lt_u32 s[90:91], 7, v130
    v_mov_b32 v115, 0
    v_mov_b32 v125, 0
    v_mov_b32 v121, 0
    v_lshlrev_b32 v120, 1, v118
    v_mul_u32_u24 v114, 12, v130
    s_mul_i32 s71, s16, 192
    v_add_u32 v114, s71, v114
    v_lshlrev_b32 v124, 5, v119
    s_mul_i32 s72, s16, 8064
    s_add_u32 s72, s72, 104448
    s_mul_i32 s73, s16, 6528
    s_add_u32 s73, s73, 38912
    v_lshrrev_b32 v127, 2, v130
    v_and_b32 v123, 1, v127
    v_mul_u32_u24 v123, 0x020202, v123
    v_lshl_or_b32 v123, v123, 8, v123
    v_add_u32 v123, 0x05040100, v123
    v_and_b32 v122, 3, v130
    v_lshrrev_b32 v116, 1, v130
    v_xor_b32 v116, v116, v119
    v_mul_u32_u24 v126, 384, v130
    v_lshl_add_u32 v0, v116, 4, v126
    v_xor_b32 v1, 64, v0
    v_and_b32 v116, 2, v119
    v_add_u32 v116, v116, v119
    v_lshl_add_u32 v116, v116, 2, v127
    v_mul_u32_u24 v116, 96, v116
    v_lshl_add_u32 v116, v122, 3, v116
    v_add_u32 v128, s68, v116
    v_add_u32 v126, s69, v116
    v_add_u32 v129, s72, v116
    v_add_u32 v142, s73, v116
    v_mov_b32 v28, 0x3f803f80
    v_mov_b32 v29, 0x3f803f80
    v_mov_b32 v30, 0x3f803f80
    v_mov_b32 v31, 0x3f803f80
    v_mul_u32_u24 v146, 768, v119
    v_add_u32 v146, v114, v146
    v_add_u32 v146, 157184, v146
    s_mov_b32 s76, 0x3f80
    v_and_b32 v143, 1, v130
    v_lshlrev_b32 v143, 4, v143
    v_lshlrev_b32 v144, v143, s76
    v_mov_b32 v145, 0x3c003c00
    v_mov_b32 v44, 1.0
    v_mov_b32 v45, 1.0
    v_lshlrev_b32 v147, 4, v119
    s_mov_b32 s19, s38
    s_mov_b32 s23, s25
    s_mov_b32 s26, 0
    s_mov_b32 s27, 0
    s_mov_b32 s18, 0
    s_add_u32 s19, s19, s20
    s_add_u32 s23, s23, s21
    s_cmp_ge_u32 s19, 72
    s_cselect_b32 s34, 72, 0
    s_cselect_b32 s35, s22, 0
    s_sub_u32 s19, s19, s34
    s_add_u32 s23, s23, s35
    s_mov_b32 s24, s23
    s_add_u32 s19, s19, s20
    s_add_u32 s23, s23, s21
    s_cmp_ge_u32 s19, 72
    s_cselect_b32 s34, 72, 0
    s_cselect_b32 s35, s22, 0
    s_sub_u32 s19, s19, s34
    s_add_u32 s23, s23, s35
    s_mul_i32 s79, s16, 64
    v_lshl_add_u32 v154, v119, 4, s79
    s_mul_i32 s80, s16, 32
    s_add_u32 s80, s80, 256
    v_lshl_add_u32 v150, v119, 3, s80
    v_add_u32 v148, 0, v130
    v_mul_u32_u24 v155, 37, v148
    v_mul_u32_u24 v116, 384, v148
    v_lshrrev_b32 v155, 8, v155
    v_mad_u32_u24 v116, v155, s70, v116
    v_add_u32 v15, v116, v154
    v_add_u32 v18, v116, v150
    v_mul_u32_u24 v149, 37, v148
    v_lshrrev_b32 v149, 8, v149
    v_mul_u32_u24 v156, 7, v149
    v_sub_u32 v156, v148, v156
    v_add_u32 v153, 16, v130
    v_mul_u32_u24 v152, 37, v153
    v_mul_u32_u24 v116, 384, v153
    v_lshrrev_b32 v152, 8, v152
    v_mad_u32_u24 v116, v152, s70, v116
    v_add_u32 v16, v116, v154
    v_add_u32 v19, v116, v150
    v_mul_u32_u24 v158, 37, v153
    v_lshrrev_b32 v158, 8, v158
    v_mul_u32_u24 v157, 7, v158
    v_sub_u32 v157, v153, v157
    v_add_u32 v151, 32, v130
    v_mul_u32_u24 v116, 37, v151
    v_mul_u32_u24 v159, 384, v151
    v_lshrrev_b32 v116, 8, v116
    v_mad_u32_u24 v159, v116, s70, v159
    v_add_u32 v17, v159, v154
    v_add_u32 v20, v159, v150
    v_mul_u32_u24 v154, 37, v151
    v_lshrrev_b32 v154, 8, v154
    v_mul_u32_u24 v150, 7, v154
    v_sub_u32 v150, v151, v150
    s_mul_i32 s81, s16, 768
    s_add_u32 s81, s81, 157184
    v_mul_u32_u24 v155, 24, v155
    v_lshl_add_u32 v155, v148, 2, v155
    v_add_u32 v22, s81, v155
    v_sub_u32 v23, s81, v155
    v_sub_u32 v155, v22, v147
    v_mul_u32_u24 v152, 24, v152
    v_lshl_add_u32 v152, v153, 2, v152
    v_add_u32 v24, s81, v152
    v_sub_u32 v25, s81, v152
    v_sub_u32 v152, v24, v147
    v_mul_u32_u24 v116, 24, v116
    v_lshl_add_u32 v116, v151, 2, v116
    v_add_u32 v26, s81, v116
    v_sub_u32 v27, s81, v116
    v_sub_u32 v116, v26, v147
    v_mul_u32_u24 v160, 148, v119
    s_mov_b32 s82, -24
    v_add_u32 v159, 0, v160
    v_lshrrev_b32 v159, 8, v159
    v_mad_i32_i24 v46, v159, s82, v155
    v_mad_i32_i24 v58, v159, s82, v152
    v_mad_i32_i24 v70, v159, s82, v116
    v_add_u32 v159, 37, v160
    v_lshrrev_b32 v159, 8, v159
    v_mad_i32_i24 v47, v159, s82, v155
    v_mad_i32_i24 v59, v159, s82, v152
    v_mad_i32_i24 v71, v159, s82, v116
    v_add_u32 v159, 74, v160
    v_lshrrev_b32 v159, 8, v159
    v_mad_i32_i24 v48, v159, s82, v155
    v_mad_i32_i24 v60, v159, s82, v152
    v_mad_i32_i24 v72, v159, s82, v116
    v_add_u32 v159, 111, v160
    v_lshrrev_b32 v159, 8, v159
    v_mad_i32_i24 v49, v159, s82, v155
    v_mad_i32_i24 v61, v159, s82, v152
    v_mad_i32_i24 v73, v159, s82, v116
    v_add_u32 v159, 592, v160
    v_lshrrev_b32 v159, 8, v159
    v_mad_i32_i24 v50, v159, s82, v155
    v_mad_i32_i24 v62, v159, s82, v152
    v_mad_i32_i24 v74, v159, s82, v116
    v_add_u32 v159, 629, v160
    v_lshrrev_b32 v159, 8, v159
    v_mad_i32_i24 v51, v159, s82, v155
    v_mad_i32_i24 v63, v159, s82, v152
    v_mad_i32_i24 v75, v159, s82, v116
    v_add_u32 v159, 666, v160
    v_lshrrev_b32 v159, 8, v159
    v_mad_i32_i24 v52, v159, s82, v155
    v_mad_i32_i24 v64, v159, s82, v152
    v_mad_i32_i24 v76, v159, s82, v116
    v_add_u32 v159, 703, v160
    v_lshrrev_b32 v159, 8, v159
    v_mad_i32_i24 v53, v159, s82, v155
    v_mad_i32_i24 v65, v159, s82, v152
    v_mad_i32_i24 v77, v159, s82, v116
    v_add_u32 v159, 1184, v160
    v_lshrrev_b32 v159, 8, v159
    v_mad_i32_i24 v54, v159, s82, v155
    v_mad_i32_i24 v66, v159, s82, v152
    v_mad_i32_i24 v78, v159, s82, v116
    v_add_u32 v159, 1221, v160
    v_lshrrev_b32 v159, 8, v159
    v_mad_i32_i24 v55, v159, s82, v155
    v_mad_i32_i24 v67, v159, s82, v152
    v_mad_i32_i24 v79, v159, s82, v116
    v_add_u32 v159, 1258, v160
    v_lshrrev_b32 v159, 8, v159
    v_mad_i32_i24 v56, v159, s82, v155
    v_mad_i32_i24 v68, v159, s82, v152
    v_mad_i32_i24 v80, v159, s82, v116
    v_add_u32 v159, 1295, v160
    v_lshrrev_b32 v159, 8, v159
    v_mad_i32_i24 v57, v159, s82, v155
    v_mad_i32_i24 v69, v159, s82, v152
    v_mad_i32_i24 v81, v159, s82, v116
    v_mov_b32 v155, s81
    v_lshlrev_b32 v116, 4, v118
    v_xor_b32 v2, 65536, v116
    v_lshl_add_u32 v3, s16, 10, v116
    s_lshr_b32 s83, s16, 1
    s_and_b32 s84, s16, 1
    s_lshl_b32 s84, s84, 3
    s_lshl_b32 s85, s83, 10
    s_add_u32 s85, s85, s84
    v_add_u32 v4, s85, v116
    s_lshl_b32 s83, s83, 11
    s_add_u32 s83, s83, s84
    s_add_u32 s83, s83, 144896
    s_mul_i32 s86, s16, 2048
    s_add_u32 s86, s86, 136704
    v_lshl_add_u32 v152, v119, 3, s86
    v_mov_b32 v160, s83
    v_mov_b32 v161, 161536
    v_mul_u32_u24 v159, 80, v119
    v_add3_u32 v5, v159, v143, s72
    v_lshl_add_u32 v6, v130, 2, s73
    s_mul_i32 s87, s16, 128
    s_add_u32 s87, s87, 65024
    s_mov_b32 s40, s8
    buffer_load_dwordx4 v133, s[48:51], s4 offen lds
    v_add_u32 v9, s87, v147
    v_lshrrev_b32 v116, 1, v119
    s_mov_b32 s41, s9
    s_mov_b32 s32, 0x2a8cbccc
    buffer_load_dwordx4 v135, s[48:51], s4 offen offset:1024 lds
    v_mul_u32_u24 v116, 48, v116
    v_lshl_add_u32 v116, v119, 3, v116
    s_mov_b32 s33, 0x38fba882
    s_add_u32 s75, s28, 16384
    buffer_load_dwordx4 v137, s[48:51], s4 offen offset:2048 lds
    s_add_u32 m0, s68, 3072
    s_add_u32 s4, s45, 37248
    s_cmp_lt_u32 s16, 2
    s_cselect_b32 s29, s75, 160256
    buffer_load_dwordx4 v133, s[48:51], s4 offen lds
    v_lshl_add_u32 v116, v127, 4, v116
    v_lshl_add_u32 v116, v122, 1, v116
    s_cselect_b32 s30, 65536, 0
    s_xor_b32 s74, s29, s30
    buffer_load_dwordx4 v135, s[48:51], s4 offen offset:1024 lds
    v_add_u32 v8, s87, v116
    v_mov_b32 v37, 0
    s_lshl_b32 s92, s5, 1
    s_or_b32 s92, s92, s6
    buffer_load_dwordx4 v137, s[48:51], s4 offen offset:2048 lds
    s_add_u32 m0, s69, 0
    s_add_u32 s4, s45, 74112
    s_mul_i32 s77, s16, 64
    s_mul_i32 s78, s16, 32
    buffer_load_ushort v116, v120, s[60:63], 0 offen
    v_mov_b32 v38, 0
    s_add_u32 s78, s78, 192
    s_add_u32 s34, s18, 2
    buffer_load_dwordx3 v[170:172], v114, s[56:59], 0 offen
    v_mov_b32 v39, 0
    s_mov_b32 s27, s26
    s_mov_b32 s26, s25
    buffer_load_dwordx4 v[174:177], v124, s[64:67], 0 offen
    v_add_u32 v180, 148992, v0
    v_add_u32 v179, 148992, v1
    v_lshlrev_b32 v173, 4, v130
    v_add_u32 v173, 160256, v173
    v_mul_u32_u24 v187, 336, v130
    v_add3_u32 v187, v187, v159, s72
    v_mul_u32_u24 v186, 272, v130
    v_add3_u32 v186, v186, v147, s73
    v_mul_u32_u24 v181, 1088, v119
    v_add_u32 v181, v181, v6
    v_add_u32 v159, 5376, v187
    v_add_u32 v189, 4352, v186
    v_add_u32 v188, 4352, v181
    v_cmp_gt_u32 s[88:89], 16, v118
    v_mov_b32 v178, 0xf149f2ca
    v_add_u32 v162, 512, v254
    v_mul_u32_u24 v114, 2731, v162
    v_bfe_u32 v120, v114, 17, 3
    v_lshrrev_b32 v114, 16, v114
    v_xor_b32 v162, v120, v162
    v_mul_u32_u24 v120, 37, v114
    v_lshrrev_b32 v120, 8, v120
    v_lshlrev_b32 v162, 4, v162
    v_mad_u32_u24 v12, v120, s70, v162
    v_mul_u32_u24 v162, 37, v114
    v_lshrrev_b32 v162, 8, v162
    v_mul_u32_u24 v163, 7, v162
    v_sub_u32 v163, v114, v163
    s_add_u32 s19, s19, s20
    s_mov_b32 s18, 1
    buffer_load_dwordx4 v[166:169], v124, s[64:67], 0 offen offset:16
    v_cmp_gt_u32 vcc, 4, v162
    v_add_u32 v124, 768, v254
    v_mul_u32_u24 v114, 2731, v124
    v_cndmask_b32 v162, v138, v136, vcc
    v_cmp_gt_u32 vcc, 4, v163
    v_bfe_u32 v120, v114, 17, 3
    v_lshrrev_b32 v114, 16, v114
    v_cndmask_b32 v163, v140, v139, vcc
    v_add3_u32 v12, v12, v162, v163
    v_xor_b32 v124, v120, v124
    v_mul_u32_u24 v120, 37, v114
    v_lshrrev_b32 v120, 8, v120
    v_lshlrev_b32 v124, 4, v124
    v_mad_u32_u24 v13, v120, s70, v124
    v_mul_u32_u24 v120, 37, v114
    v_lshrrev_b32 v120, 8, v120
    v_mul_u32_u24 v162, 7, v120
    v_sub_u32 v162, v114, v162
    v_cmp_gt_u32 vcc, 4, v120
    v_add_u32 v114, 1024, v254
    v_mul_u32_u24 v124, 2731, v114
    v_cndmask_b32 v120, v138, v136, vcc
    v_cmp_gt_u32 vcc, 4, v162
    v_bfe_u32 v254, v124, 17, 3
    v_lshrrev_b32 v124, 16, v124
    v_cndmask_b32 v162, v140, v139, vcc
    v_add3_u32 v13, v13, v120, v162
    v_xor_b32 v114, v254, v114
    v_mul_u32_u24 v254, 37, v124
    v_lshrrev_b32 v254, 8, v254
    v_lshlrev_b32 v114, 4, v114
    v_mad_u32_u24 v14, v254, s70, v114
    v_mul_u32_u24 v120, 37, v124
    v_lshrrev_b32 v120, 8, v120
    v_mul_u32_u24 v114, 7, v120
    v_sub_u32 v114, v124, v114
    v_cmp_gt_u32 vcc, 4, v120
    v_mov_b32 v254, 0xc31044fe
    v_mul_u32_u24 v162, 37, v148
    v_cndmask_b32 v120, v138, v136, vcc
    v_cmp_gt_u32 vcc, 4, v114
    v_lshrrev_b32 v162, 8, v162
    v_mul_u32_u24 v163, 7, v162
    v_cndmask_b32 v114, v140, v139, vcc
    v_add3_u32 v14, v14, v120, v114
    v_cmp_gt_u32 vcc, 48, v124
    v_sub_u32 v163, v148, v163
    global_load_ushort v141, v141, s[46:47]
    s_waitcnt vmcnt(10)
    s_barrier
    v_cndmask_b32 v14, v255, v14, vcc
    v_cmp_gt_u32 vcc, 2, v122
    v_lshrrev_b32 v162, 2, v162
    v_lshrrev_b32 v163, 2, v163
    v_cndmask_b32 v32, 0, v144, vcc
    v_cndmask_b32 v33, v144, 0, vcc
    v_cndmask_b32 v34, 0, v144, vcc
    v_cndmask_b32 v35, v144, 0, vcc
    v_cmp_eq_u32 vcc, 0, v143
    v_and_b32 v162, s5, v162
    v_and_b32 v163, s6, v163
    v_cndmask_b32 v40, 0, v145, vcc
    buffer_load_dwordx4 v133, s[48:51], s4 offen lds
    v_cndmask_b32 v41, v145, 0, vcc
    v_cndmask_b32 v42, 0, v145, vcc
    v_cndmask_b32 v43, v145, 0, vcc
    v_cmp_eq_u32 vcc, v119, v127
    v_lshl_or_b32 v162, v162, 1, v163
    v_mul_u32_u24 v255, 37, v153
    v_cndmask_b32 v144, 0, v32, vcc
    v_cndmask_b32 v145, 0, v33, vcc
    v_lshrrev_b32 v255, 8, v255
    v_mul_u32_u24 v114, 7, v255
    v_sub_u32 v114, v153, v114
    v_lshrrev_b32 v255, 2, v255
    v_lshrrev_b32 v114, 2, v114
    v_and_b32 v255, s5, v255
    buffer_load_dwordx4 v135, s[48:51], s4 offen offset:1024 lds
    s_waitcnt vmcnt(10)
    ds_read_b64_tr_b16 a[72:73], v128 offset:0
    ds_read_b64_tr_b16 a[74:75], v128 offset:768
    ds_read_b64_tr_b16 a[96:97], v128 offset:32
    ds_read_b64_tr_b16 a[98:99], v128 offset:800
    ds_read_b64_tr_b16 a[120:121], v128 offset:64
    ds_read_b64_tr_b16 a[122:123], v128 offset:832
    v_and_b32 v114, s6, v114
    v_lshl_or_b32 v255, v255, 1, v114
    v_mul_u32_u24 v163, 37, v151
    v_lshrrev_b32 v163, 8, v163
    v_mul_u32_u24 v114, 7, v163
    v_sub_u32 v114, v151, v114
    v_lshrrev_b32 v163, 2, v163
    buffer_load_dwordx4 v137, s[48:51], s4 offen offset:2048 lds
    s_add_u32 m0, s69, 3072
    s_add_u32 s4, s45, 110976
    v_lshrrev_b32 v114, 2, v114
    v_and_b32 v163, s5, v163
    v_and_b32 v114, s6, v114
    v_lshl_or_b32 v163, v163, 1, v114
    v_mul_u32_u24 v120, 6, v131
    v_sub_u32 v124, v118, v120
    v_mul_u32_u24 v120, 384, v131
    v_lshl_add_u32 v120, v124, 4, v120
    v_add_u32 v114, s78, v120
    v_add_u32 v120, s77, v120
    v_cmp_gt_i32 vcc, 4, v124
    v_mul_u32_u24 v124, 6, v132
    buffer_load_dwordx4 v133, s[48:51], s4 offen lds
    v_cndmask_b32 v143, v114, v120, vcc
    v_sub_u32 v120, v118, v124
    v_mul_u32_u24 v124, 384, v132
    v_lshl_add_u32 v124, v120, 4, v124
    v_add_u32 v114, s78, v124
    v_add_u32 v124, s77, v124
    v_cmp_gt_i32 vcc, -60, v120
    v_mul_u32_u24 v131, 6, v134
    v_sub_u32 v148, v118, v131
    v_cndmask_b32 v132, v114, v124, vcc
    v_mul_u32_u24 v131, 384, v134
    v_lshl_add_u32 v131, v148, 4, v131
    s_waitcnt vmcnt(9)
    ds_read_b64_tr_b16 a[76:77], v128 offset:3072
    ds_read_b64_tr_b16 a[78:79], v128 offset:3840
    s_waitcnt vmcnt(7)
    buffer_load_dwordx4 v135, s[48:51], s4 offen offset:1024 lds
    s_waitcnt vmcnt(7)
    s_waitcnt vmcnt(6)
    ds_read_b64_tr_b16 a[100:101], v128 offset:3104
    ds_read_b64_tr_b16 a[102:103], v128 offset:3872
    ds_read_b64_tr_b16 a[124:125], v128 offset:3136
    ds_read_b64_tr_b16 a[126:127], v128 offset:3904
    v_cndmask_b32 v174, v174, v175, s[90:91]
    v_cndmask_b32 v176, v176, v177, s[90:91]
    v_perm_b32 v164, v176, v174, v123
    v_cndmask_b32 v166, v166, v167, s[90:91]
    v_cndmask_b32 v168, v168, v169, s[90:91]
    v_perm_b32 v165, v168, v166, v123
    v_bfe_u32 v114, v170, v147, 16
    v_bfe_u32 v124, v171, v147, 16
    buffer_load_dwordx4 v137, s[48:51], s4 offen offset:2048 lds
    v_mfma_f32_16x16x16_bf16 v[174:177], v[116:117], v[114:115], 0
    v_bfe_u32 v120, v172, v147, 16
    v_add_u32 v151, s78, v131
    v_add_u32 v131, s77, v131
    v_mfma_f32_16x16x16_bf16 v[166:169], v[116:117], v[124:125], 0
    v_cmp_gt_i32 vcc, -124, v148
    v_mul_u32_u24 v148, 96, v130
    v_add3_u32 v134, v148, v147, s68
    v_mfma_f32_16x16x16_bf16 v[210:213], v[116:117], v[120:121], 0
    s_add_u32 m0, s72, 0
    s_add_u32 s4, s45, 147840
    v_max_f32 v174, 0, v174
    v_max_f32 v175, 0, v175
    v_max_f32 v176, 0, v176
    buffer_load_dwordx4 v133, s[48:51], s4 offen lds
    s_waitcnt vmcnt(7)
    v_max_f32 v177, 0, v177
    v_cvt_pk_bf16_f32 v120, v174, v175
    v_cvt_pk_bf16_f32 v121, v176, v177
    v_max_f32 v166, 0, v166
    v_max_f32 v167, 0, v167
    v_mfma_f32_16x16x16_bf16 v[114:117], v[164:165], v[120:121], 0
    v_max_f32 v168, 0, v168
    v_max_f32 v169, 0, v169
    v_cvt_pk_bf16_f32 v120, v166, v167
    v_cvt_pk_bf16_f32 v121, v168, v169
    v_max_f32 v210, 0, v210
    v_max_f32 v211, 0, v211
    v_mfma_f32_16x16x16_bf16 v[174:177], v[164:165], v[120:121], 0
    buffer_load_dwordx4 v135, s[48:51], s4 offen offset:1024 lds
    v_cvt_pk_bf16_f32 v114, v114, v114
    v_and_b32 v114, 0xffff0000, v114
    v_mul_f32 v114, 0xbfb8aa3b, v114
    v_exp_f32 v114, v114
    v_max_f32 v212, 0, v212
    v_add_f32 v114, 1.0, v114
    v_rcp_f32 v114, v114
    v_cvt_pk_bf16_f32 v174, v174, v174
    v_cvt_pk_bf16_f32 v114, v114, v114
    v_and_b32 v114, 0xffff0000, v114
    v_add_f32 v114, -0.5, v114
    v_mul_f32 v114, 0x41b8aa3b, v114
    buffer_load_dwordx4 v137, s[48:51], s4 offen offset:2048 lds
    ds_write_b32 v146, v114 offset:0
    s_add_u32 m0, s72, 3072
    s_add_u32 s4, s45, 184704
    v_and_b32 v174, 0xffff0000, v174
    v_mul_f32 v174, 0xbfb8aa3b, v174
    v_exp_f32 v174, v174
    v_max_f32 v213, 0, v213
    v_add_f32 v174, 1.0, v174
    v_rcp_f32 v174, v174
    v_cvt_pk_bf16_f32 v210, v210, v211
    v_cvt_pk_bf16_f32 v174, v174, v174
    s_waitcnt vmcnt(6)
    buffer_load_dwordx4 v133, s[48:51], s4 offen lds
    ds_read_b64_tr_b16 a[80:81], v126 offset:0
    ds_read_b64_tr_b16 a[82:83], v126 offset:768
    ds_read_b64_tr_b16 a[104:105], v126 offset:32
    ds_read_b64_tr_b16 a[106:107], v126 offset:800
    ds_read_b64_tr_b16 a[128:129], v126 offset:64
    ds_read_b64_tr_b16 a[130:131], v126 offset:832
    v_and_b32 v174, 0xffff0000, v174
    v_add_f32 v174, -0.5, v174
    v_mul_f32 v174, 0x41b8aa3b, v174
    ds_write_b32 v146, v174 offset:4
    v_cvt_pk_bf16_f32 v211, v212, v213
    buffer_load_dwordx4 v135, s[48:51], s4 offen offset:1024 lds
    v_lshlrev_b32 v141, 16, v141
    v_mfma_f32_16x16x16_bf16 v[114:117], v[164:165], v[210:211], 0
    v_max_f32 v141, 0xc2c80000, v141
    v_min_f32 v141, 0x40930000, v141
    v_mul_f32 v141, 0x3fb8aa3b, v141
    v_exp_f32 v141, v141
    v_cndmask_b32 v118, v151, v131, vcc
    v_cvt_pk_bf16_f32 v141, v141, v141
    v_and_b32 v141, 0xffff0000, v141
    v_mul_f32 v131, 0x3fb8aa3b, v141
    v_cvt_pk_bf16_f32 v114, v114, v114
    v_and_b32 v114, 0xffff0000, v114
    v_mul_f32 v114, 0xbfb8aa3b, v114
    buffer_load_dwordx4 v137, s[48:51], s4 offen offset:2048 lds
    s_add_u32 m0, s73, 0
    s_add_u32 s4, s45, 36864
    v_exp_f32 v114, v114
    v_readfirstlane_b32 s37, v141
    v_add_f32 v114, 1.0, v114
    v_rcp_f32 v114, v114
    v_readfirstlane_b32 s31, v131
    v_cvt_pk_bf16_f32 v114, v114, v114
    v_and_b32 v114, 0xffff0000, v114
    v_add_f32 v114, -0.5, v114
    v_mul_f32 v114, 0x41b8aa3b, v114
    ds_write_b32 v146, v114 offset:8
    s_waitcnt vmcnt(6)
    buffer_load_dwordx4 v133, s[48:51], s45 offen lds
    v_cmp_gt_u32 vcc, 4, v149
    ds_read_b64_tr_b16 a[84:85], v126 offset:3072
    ds_read_b64_tr_b16 a[86:87], v126 offset:3840
    ds_read_b64_tr_b16 a[108:109], v126 offset:3104
    ds_read_b64_tr_b16 a[110:111], v126 offset:3872
    ds_read_b64_tr_b16 a[132:133], v126 offset:3136
    ds_read_b64_tr_b16 a[134:135], v126 offset:3904
    v_cndmask_b32 v149, v138, v136, vcc
    v_cmp_gt_u32 vcc, 4, v156
    v_lshl_add_u32 v120, v119, 3, v148
    v_add3_u32 v120, v120, 64, s68
    v_cndmask_b32 v156, v140, v139, vcc
    buffer_load_dwordx4 v135, s[48:51], s45 offen offset:1024 lds
    v_add3_u32 v15, v15, v149, v156
    v_add3_u32 v18, v18, v149, v156
    v_cmp_gt_u32 vcc, 4, v158
    v_add3_u32 v131, v148, v147, s69
    v_lshl_add_u32 v121, v119, 3, v148
    s_waitcnt lgkmcnt(6)
    s_barrier
    ds_read_b32 v22, v22 offset:0
    ds_read_b32 v23, v23 offset:672
    ds_read_b32 v24, v24 offset:0
    ds_read_b32 v25, v25 offset:672
    ds_read_b32 v26, v26 offset:0
    ds_read_b32 v27, v27 offset:672
    ds_read_b32 v46, v46 offset:336
    ds_read_b32 v58, v58 offset:336
    buffer_load_dwordx4 v137, s[48:51], s45 offen offset:2048 lds
    ds_read_b32 v70, v70 offset:336
    ds_read_b32 v47, v47 offset:332
    ds_read_b32 v59, v59 offset:332
    s_add_u32 m0, s73, 3072
    ds_read_b32 v71, v71 offset:332
    v_cndmask_b32 v158, v138, v136, vcc
    v_cmp_gt_u32 vcc, 4, v157
    ds_read_b32 v48, v48 offset:328
    ds_read_b32 v60, v60 offset:328
    ds_read_b32 v72, v72 offset:328
    ds_read_b32 v49, v49 offset:324
    s_waitcnt vmcnt(6)
    ds_read_b64_tr_b16 a[88:89], v129 offset:0
    buffer_load_dwordx4 v133, s[48:51], s4 offen lds
    ds_read_b64_tr_b16 a[90:91], v129 offset:768
    ds_read_b64_tr_b16 a[112:113], v129 offset:32
    ds_read_b64_tr_b16 a[114:115], v129 offset:800
    ds_read_b64_tr_b16 a[136:137], v129 offset:64
    ds_read_b64_tr_b16 a[138:139], v129 offset:832
    v_cndmask_b32 v157, v140, v139, vcc
    v_add3_u32 v16, v16, v158, v157
    v_add3_u32 v19, v19, v158, v157
    v_cmp_gt_u32 vcc, 4, v154
    ds_read_b32 v61, v61 offset:324
    ds_read_b32 v73, v73 offset:324
    ds_read_b32 v50, v50 offset:272
    buffer_load_dwordx4 v135, s[48:51], s4 offen offset:1024 lds
    ds_read_b32 v62, v62 offset:272
    ds_read_b32 v74, v74 offset:272
    ds_read_b32 v51, v51 offset:268
    ds_read_b32 v63, v63 offset:268
    ds_read_b32 v75, v75 offset:268
    v_cndmask_b32 v154, v138, v136, vcc
    v_cmp_gt_u32 vcc, 4, v150
    ds_read_b32 v52, v52 offset:264
    ds_read_b32 v64, v64 offset:264
    ds_read_b32 v76, v76 offset:264
    ds_read_b32 v53, v53 offset:260
    v_cndmask_b32 v150, v140, v139, vcc
    buffer_load_dwordx4 v137, s[48:51], s4 offen offset:2048 lds
    ds_read_b32 v65, v65 offset:260
    ds_read_b32 v77, v77 offset:260
    ds_read_b32 v54, v54 offset:208
    ds_read_b32 v66, v66 offset:208
    ds_read_b32 v78, v78 offset:208
    s_add_u32 m0, s68, 0
    ds_read_b32 v55, v55 offset:204
    s_add_u32 s4, s45, 73728
    ds_read_b32 v67, v67 offset:204
    v_add3_u32 v17, v17, v154, v150
    v_add3_u32 v20, v20, v154, v150
    v_cmp_gt_u32 vcc, 2, v119
    ds_read_b32 v79, v79 offset:204
    s_waitcnt vmcnt(6)
    buffer_load_dwordx4 v133, s[48:51], s4 offen lds
    ds_read_b64_tr_b16 a[92:93], v129 offset:3072
    ds_read_b64_tr_b16 a[94:95], v129 offset:3840
    ds_read_b64_tr_b16 a[116:117], v129 offset:3104
    ds_read_b64_tr_b16 a[118:119], v129 offset:3872
    ds_read_b64_tr_b16 a[140:141], v129 offset:3136
    ds_read_b64_tr_b16 a[142:143], v129 offset:3904
    ds_read_b32 v56, v56 offset:200
    v_cndmask_b32 v152, v160, v152, vcc
    v_lshl_add_u32 v152, v127, 9, v152
    v_lshl_add_u32 v152, v122, 1, v152
    v_cmp_gt_u32 vcc, 3, v119
    ds_read_b32 v68, v68 offset:200
    ds_read_b32 v80, v80 offset:200
    ds_read_b32 v57, v57 offset:196
    buffer_load_dwordx4 v135, s[48:51], s4 offen offset:1024 lds
    ds_read_b32 v69, v69 offset:196
    ds_read_b32 v81, v81 offset:196
    ds_read_b32 v155, v155 offset:336
    v_cndmask_b32 v7, v161, v152, vcc
    v_cmp_gt_u32 vcc, 8, v130
    v_lshl_add_u32 v130, v119, 2, 0
    v_mul_u32_u24 v129, 37, v130
    v_cndmask_b32 v159, v173, v159, vcc
    v_cndmask_b32 v189, v173, v189, vcc
    v_cmp_gt_u32 vcc, 2, v119
    v_lshrrev_b32 v129, 8, v129
    v_mul_u32_u24 v127, 7, v129
    v_cndmask_b32 v188, v173, v188, vcc
    v_cmp_ne_u32 vcc, s92, v162
    buffer_load_dwordx4 v137, s[48:51], s4 offen offset:2048 lds
    s_add_u32 m0, s68, 3072
    s_add_u32 s4, s45, 110592
    v_cndmask_b32 v136, 0, v254, vcc
    s_waitcnt lgkmcnt(6)
    v_add_f32 v22, v22, v136
    v_cmp_ne_u32 vcc, s92, v162
    v_sub_u32 v127, v130, v127
    v_lshrrev_b32 v129, 2, v129
    v_cndmask_b32 v130, 0, v254, vcc
    v_add_f32 v23, v23, v130
    v_cmp_ne_u32 vcc, s92, v255
    v_lshrrev_b32 v127, 2, v127
    s_waitcnt lgkmcnt(0)
    v_readfirstlane_b32 s39, v155
    buffer_load_dwordx4 v133, s[48:51], s4 offen lds
    s_waitcnt vmcnt(7)
    ds_read_b64_tr_b16 a[0:1], v142 offset:0
    ds_read_b64_tr_b16 a[2:3], v142 offset:768
    ds_read_b64_tr_b16 a[24:25], v142 offset:32
    ds_read_b64_tr_b16 a[26:27], v142 offset:800
    ds_read_b64_tr_b16 a[48:49], v142 offset:64
    ds_read_b64_tr_b16 a[50:51], v142 offset:832
    v_cndmask_b32 v130, 0, v254, vcc
    v_add_f32 v24, v24, v130
    v_cmp_ne_u32 vcc, s92, v255
    v_and_b32 v129, s5, v129
    v_and_b32 v127, s6, v127
    v_cndmask_b32 v130, 0, v254, vcc
    v_add_f32 v25, v25, v130
    buffer_load_dwordx4 v135, s[48:51], s4 offen offset:1024 lds
    v_cmp_ne_u32 vcc, s92, v163
    v_lshl_or_b32 v129, v129, 1, v127
    v_lshl_add_u32 v127, v119, 2, 1
    v_cndmask_b32 v130, 0, v254, vcc
    v_add_f32 v26, v26, v130
    v_cmp_ne_u32 vcc, s92, v163
    v_mul_u32_u24 v130, 37, v127
    v_lshrrev_b32 v130, 8, v130
    v_cndmask_b32 v136, 0, v254, vcc
    v_add_f32 v27, v27, v136
    v_cmp_ne_u32 vcc, v129, v162
    v_mul_u32_u24 v136, 7, v130
    v_sub_u32 v136, v127, v136
    v_cndmask_b32 v127, 0, v254, vcc
    buffer_load_dwordx4 v137, s[48:51], s4 offen offset:2048 lds
    s_add_u32 m0, s69, 0
    s_add_u32 s4, s45, 147456
    v_add_f32 v46, v46, v127
    v_cmp_ne_u32 vcc, v129, v255
    v_lshrrev_b32 v130, 2, v130
    v_lshrrev_b32 v136, 2, v136
    v_cndmask_b32 v127, 0, v254, vcc
    v_add_f32 v58, v58, v127
    v_cmp_ne_u32 vcc, v129, v163
    v_and_b32 v130, s5, v130
    v_and_b32 v136, s6, v136
    v_cndmask_b32 v127, 0, v254, vcc
    v_add_f32 v70, v70, v127
    v_lshl_or_b32 v130, v130, 1, v136
    buffer_load_dwordx4 v133, s[48:51], s4 offen lds
    s_waitcnt vmcnt(7)
    ds_read_b64_tr_b16 a[4:5], v142 offset:3072
    ds_read_b64_tr_b16 a[6:7], v142 offset:3840
    ds_read_b64_tr_b16 a[28:29], v142 offset:3104
    ds_read_b64_tr_b16 a[30:31], v142 offset:3872
    ds_read_b64_tr_b16 a[52:53], v142 offset:3136
    ds_read_b64_tr_b16 a[54:55], v142 offset:3904
    v_cmp_ne_u32 vcc, v130, v162
    v_lshl_add_u32 v136, v119, 2, 2
    v_mul_u32_u24 v142, 37, v136
    v_cndmask_b32 v127, 0, v254, vcc
    v_add_f32 v47, v47, v127
    v_cmp_ne_u32 vcc, v130, v255
    v_lshrrev_b32 v142, 8, v142
    buffer_load_dwordx4 v135, s[48:51], s4 offen offset:1024 lds
    v_cndmask_b32 v127, 0, v254, vcc
    v_add_f32 v59, v59, v127
    v_cmp_ne_u32 vcc, v130, v163
    v_mul_u32_u24 v127, 7, v142
    v_sub_u32 v127, v136, v127
    v_cndmask_b32 v130, 0, v254, vcc
    v_add_f32 v71, v71, v130
    v_lshrrev_b32 v142, 2, v142
    v_lshrrev_b32 v127, 2, v127
    v_and_b32 v142, s5, v142
    v_and_b32 v127, s6, v127
    v_lshl_or_b32 v142, v142, 1, v127
    v_cmp_ne_u32 vcc, v142, v162
    v_lshl_add_u32 v130, v119, 2, 3
    buffer_load_dwordx4 v137, s[48:51], s4 offen offset:2048 lds
    s_add_u32 m0, s69, 3072
    s_add_u32 s4, s45, 184320
    v_cndmask_b32 v136, 0, v254, vcc
    v_add_f32 v48, v48, v136
    v_cmp_ne_u32 vcc, v142, v255
    v_mul_u32_u24 v127, 37, v130
    v_lshrrev_b32 v127, 8, v127
    v_cndmask_b32 v136, 0, v254, vcc
    v_add_f32 v60, v60, v136
    v_cmp_ne_u32 vcc, v142, v163
    v_mul_u32_u24 v129, 7, v127
    v_sub_u32 v129, v130, v129
    v_cndmask_b32 v130, 0, v254, vcc
    v_add_f32 v72, v72, v130
    buffer_load_dwordx4 v133, s[48:51], s4 offen lds
    s_waitcnt vmcnt(7)
    ds_read_b64_tr_b16 a[8:9], v128 offset:0
    ds_read_b64_tr_b16 a[10:11], v128 offset:768
    ds_read_b64_tr_b16 a[32:33], v128 offset:32
    ds_read_b64_tr_b16 a[34:35], v128 offset:800
    ds_read_b64_tr_b16 a[56:57], v128 offset:64
    ds_read_b64_tr_b16 a[58:59], v128 offset:832
    v_lshrrev_b32 v127, 2, v127
    v_lshrrev_b32 v129, 2, v129
    v_and_b32 v127, s5, v127
    v_and_b32 v129, s6, v129
    v_lshl_or_b32 v127, v127, 1, v129
    v_cmp_ne_u32 vcc, v127, v162
    v_lshl_add_u32 v130, v119, 2, 16
    buffer_load_dwordx4 v135, s[48:51], s4 offen offset:1024 lds
    v_cndmask_b32 v129, 0, v254, vcc
    v_add_f32 v49, v49, v129
    v_cmp_ne_u32 vcc, v127, v255
    v_mul_u32_u24 v142, 37, v130
    v_lshrrev_b32 v142, 8, v142
    v_cndmask_b32 v129, 0, v254, vcc
    v_add_f32 v61, v61, v129
    v_cmp_ne_u32 vcc, v127, v163
    v_mul_u32_u24 v136, 7, v142
    v_sub_u32 v136, v130, v136
    v_cndmask_b32 v130, 0, v254, vcc
    v_add_f32 v73, v73, v130
    v_lshrrev_b32 v142, 2, v142
    v_lshrrev_b32 v136, 2, v136
    buffer_load_dwordx4 v137, s[48:51], s4 offen offset:2048 lds
    s_add_u32 m0, s68, 0
    s_add_u32 s4, s45, 768
    s_waitcnt lgkmcnt(0)
    v_and_b32 v142, s5, v142
    v_and_b32 v136, s6, v136
    v_lshl_or_b32 v142, v142, 1, v136
    v_cmp_ne_u32 vcc, v142, v162
    v_lshl_add_u32 v127, v119, 2, 17
    v_mul_u32_u24 v130, 37, v127
    v_cndmask_b32 v136, 0, v254, vcc
    v_add_f32 v50, v50, v136
    v_cmp_ne_u32 vcc, v142, v255
    v_lshrrev_b32 v130, 8, v130
    v_mul_u32_u24 v136, 7, v130
    buffer_load_dwordx4 v133, s[48:51], s4 offen lds
    s_waitcnt vmcnt(7)
    ds_read_b64_tr_b16 a[12:13], v128 offset:3072
    ds_read_b64_tr_b16 a[14:15], v128 offset:3840
    ds_read_b64_tr_b16 a[36:37], v128 offset:3104
    ds_read_b64_tr_b16 a[38:39], v128 offset:3872
    ds_read_b64_tr_b16 a[60:61], v128 offset:3136
    ds_read_b64_tr_b16 a[62:63], v128 offset:3904
    v_cndmask_b32 v129, 0, v254, vcc
    v_add_f32 v62, v62, v129
    v_cmp_ne_u32 vcc, v142, v163
    v_sub_u32 v136, v127, v136
    v_lshrrev_b32 v130, 2, v130
    v_cndmask_b32 v142, 0, v254, vcc
    v_add_f32 v74, v74, v142
    buffer_load_dwordx4 v135, s[48:51], s4 offen offset:1024 lds
    v_lshrrev_b32 v136, 2, v136
    v_and_b32 v130, s5, v130
    v_and_b32 v136, s6, v136
    v_lshl_or_b32 v130, v130, 1, v136
    v_cmp_ne_u32 vcc, v130, v162
    v_lshl_add_u32 v127, v119, 2, 18
    v_mul_u32_u24 v142, 37, v127
    v_cndmask_b32 v136, 0, v254, vcc
    v_add_f32 v51, v51, v136
    v_cmp_ne_u32 vcc, v130, v255
    v_lshrrev_b32 v142, 8, v142
    v_mul_u32_u24 v129, 7, v142
    v_cndmask_b32 v136, 0, v254, vcc
    v_add_f32 v63, v63, v136
    buffer_load_dwordx4 v137, s[48:51], s4 offen offset:2048 lds
    s_add_u32 m0, s68, 3072
    s_add_u32 s4, s45, 37632
    s_waitcnt lgkmcnt(0)
    v_cmp_ne_u32 vcc, v130, v163
    v_sub_u32 v129, v127, v129
    v_lshrrev_b32 v142, 2, v142
    v_cndmask_b32 v130, 0, v254, vcc
    v_add_f32 v75, v75, v130
    v_lshrrev_b32 v129, 2, v129
    v_and_b32 v142, s5, v142
    v_and_b32 v129, s6, v129
    v_lshl_or_b32 v142, v142, 1, v129
    v_cmp_ne_u32 vcc, v142, v162
    v_lshl_add_u32 v136, v119, 2, 19
    buffer_load_dwordx4 v133, s[48:51], s4 offen lds
    s_waitcnt vmcnt(7)
    ds_read_b64_tr_b16 a[16:17], v126 offset:0
    ds_read_b64_tr_b16 a[18:19], v126 offset:768
    ds_read_b64_tr_b16 a[40:41], v126 offset:32
    ds_read_b64_tr_b16 a[42:43], v126 offset:800
    ds_read_b64_tr_b16 a[64:65], v126 offset:64
    ds_read_b64_tr_b16 a[66:67], v126 offset:832
    v_cndmask_b32 v130, 0, v254, vcc
    v_add_f32 v52, v52, v130
    v_cmp_ne_u32 vcc, v142, v255
    v_mul_u32_u24 v127, 37, v136
    v_lshrrev_b32 v127, 8, v127
    v_cndmask_b32 v130, 0, v254, vcc
    v_add_f32 v64, v64, v130
    buffer_load_dwordx4 v135, s[48:51], s4 offen offset:1024 lds
    v_cmp_ne_u32 vcc, v142, v163
    v_mul_u32_u24 v130, 7, v127
    v_sub_u32 v130, v136, v130
    v_cndmask_b32 v136, 0, v254, vcc
    v_add_f32 v76, v76, v136
    v_lshrrev_b32 v127, 2, v127
    v_lshrrev_b32 v130, 2, v130
    v_and_b32 v127, s5, v127
    v_and_b32 v130, s6, v130
    v_lshl_or_b32 v127, v127, 1, v130
    v_cmp_ne_u32 vcc, v127, v162
    v_lshl_add_u32 v130, v119, 2, 32
    v_mul_u32_u24 v142, 37, v130
    v_cndmask_b32 v136, 0, v254, vcc
    buffer_load_dwordx4 v137, s[48:51], s4 offen offset:2048 lds
    s_add_u32 m0, s69, 0
    s_add_u32 s4, s45, 74496
    s_waitcnt lgkmcnt(0)
    v_add_f32 v53, v53, v136
    v_cmp_ne_u32 vcc, v127, v255
    v_lshrrev_b32 v142, 8, v142
    v_mul_u32_u24 v136, 7, v142
    v_cndmask_b32 v129, 0, v254, vcc
    v_add_f32 v65, v65, v129
    v_cmp_ne_u32 vcc, v127, v163
    v_sub_u32 v136, v130, v136
    v_lshrrev_b32 v142, 2, v142
    v_cndmask_b32 v130, 0, v254, vcc
    v_add_f32 v77, v77, v130
    buffer_load_dwordx4 v133, s[48:51], s4 offen lds
    s_waitcnt vmcnt(7)
    ds_read_b64_tr_b16 a[20:21], v126 offset:3072
    ds_read_b64_tr_b16 a[22:23], v126 offset:3840
    ds_read_b64_tr_b16 a[44:45], v126 offset:3104
    ds_read_b64_tr_b16 a[46:47], v126 offset:3872
    ds_read_b64_tr_b16 a[68:69], v126 offset:3136
    ds_read_b64_tr_b16 a[70:71], v126 offset:3904
    v_lshrrev_b32 v136, 2, v136
    v_and_b32 v142, s5, v142
    v_and_b32 v136, s6, v136
    v_lshl_or_b32 v142, v142, 1, v136
    v_cmp_ne_u32 vcc, v142, v162
    v_lshl_add_u32 v130, v119, 2, 33
    v_mul_u32_u24 v136, 37, v130
    buffer_load_dwordx4 v135, s[48:51], s4 offen offset:1024 lds
    v_cndmask_b32 v127, 0, v254, vcc
    v_add_f32 v54, v54, v127
    v_cmp_ne_u32 vcc, v142, v255
    v_lshrrev_b32 v136, 8, v136
    v_mul_u32_u24 v127, 7, v136
    v_cndmask_b32 v129, 0, v254, vcc
    v_add_f32 v66, v66, v129
    v_cmp_ne_u32 vcc, v142, v163
    v_sub_u32 v127, v130, v127
    v_lshrrev_b32 v136, 2, v136
    v_cndmask_b32 v129, 0, v254, vcc
    v_add_f32 v78, v78, v129
    v_lshrrev_b32 v127, 2, v127
    v_and_b32 v136, s5, v136
    buffer_load_dwordx4 v137, s[48:51], s4 offen offset:2048 lds
    s_add_u32 m0, s69, 3072
    s_add_u32 s4, s45, 111360
    s_waitcnt lgkmcnt(0)
    v_and_b32 v127, s6, v127
    v_lshl_or_b32 v136, v136, 1, v127
    v_cmp_ne_u32 vcc, v136, v162
    v_lshl_add_u32 v130, v119, 2, 34
    v_mul_u32_u24 v129, 37, v130
    v_cndmask_b32 v127, 0, v254, vcc
    v_add_f32 v55, v55, v127
    v_cmp_ne_u32 vcc, v136, v255
    v_lshrrev_b32 v129, 8, v129
    v_mul_u32_u24 v142, 7, v129
    v_cndmask_b32 v127, 0, v254, vcc
    buffer_load_dwordx4 v133, s[48:51], s4 offen lds
    s_waitcnt vmcnt(7)
    ds_read_b64_tr_b16 a[144:145], v128 offset:0
    ds_read_b64_tr_b16 a[146:147], v128 offset:768
    ds_read_b64_tr_b16 a[168:169], v128 offset:32
    ds_read_b64_tr_b16 a[170:171], v128 offset:800
    ds_read_b64_tr_b16 a[192:193], v128 offset:64
    ds_read_b64_tr_b16 a[194:195], v128 offset:832
    v_add_f32 v67, v67, v127
    v_cmp_ne_u32 vcc, v136, v163
    v_sub_u32 v142, v130, v142
    v_lshrrev_b32 v129, 2, v129
    v_cndmask_b32 v127, 0, v254, vcc
    v_add_f32 v79, v79, v127
    v_lshrrev_b32 v142, 2, v142
    buffer_load_dwordx4 v135, s[48:51], s4 offen offset:1024 lds
    v_and_b32 v129, s5, v129
    v_and_b32 v142, s6, v142
    v_lshl_or_b32 v129, v129, 1, v142
    v_cmp_ne_u32 vcc, v129, v162
    v_lshl_add_u32 v130, v119, 2, 35
    v_mul_u32_u24 v119, 37, v130
    v_cndmask_b32 v127, 0, v254, vcc
    v_add_f32 v56, v56, v127
    v_cmp_ne_u32 vcc, v129, v255
    v_lshrrev_b32 v119, 8, v119
    v_mul_u32_u24 v136, 7, v119
    v_cndmask_b32 v127, 0, v254, vcc
    v_add_f32 v68, v68, v127
    v_cmp_ne_u32 vcc, v129, v163
    buffer_load_dwordx4 v137, s[48:51], s4 offen offset:2048 lds
    s_add_u32 m0, s68, 0
    s_add_u32 s4, s45, 148224
    s_waitcnt lgkmcnt(0)
    v_cndmask_b32 v142, 0, v254, vcc
    v_add_f32 v80, v80, v142
    v_sub_u32 v136, v130, v136
    v_lshrrev_b32 v119, 2, v119
    v_lshrrev_b32 v136, 2, v136
    v_and_b32 v119, s5, v119
    v_and_b32 v136, s6, v136
    v_lshl_or_b32 v119, v119, 1, v136
    v_cmp_ne_u32 vcc, v119, v162
    v_cndmask_b32 v22, v178, v22, s[88:89]
    v_cndmask_b32 v24, v178, v24, s[88:89]
    buffer_load_dwordx4 v133, s[48:51], s4 offen lds
    s_waitcnt vmcnt(7)
    ds_read_b64_tr_b16 a[148:149], v128 offset:3072
    ds_read_b64_tr_b16 a[150:151], v128 offset:3840
    ds_read_b64_tr_b16 a[172:173], v128 offset:3104
    ds_read_b64_tr_b16 a[174:175], v128 offset:3872
    ds_read_b64_tr_b16 a[196:197], v128 offset:3136
    ds_read_b64_tr_b16 a[198:199], v128 offset:3904
    v_cndmask_b32 v130, 0, v254, vcc
    v_add_f32 v57, v57, v130
    v_cmp_ne_u32 vcc, v119, v255
    v_cndmask_b32 v26, v178, v26, s[88:89]
    v_add3_u32 v121, v121, 64, s69
    v_cndmask_b32 v130, 0, v254, vcc
    v_add_f32 v69, v69, v130
    buffer_load_dwordx4 v135, s[48:51], s4 offen offset:1024 lds
    v_cmp_ne_u32 vcc, v119, v163
    v_mov_b32 v122, 0
    v_mov_b32 v123, 0
    v_cndmask_b32 v119, 0, v254, vcc
    v_add_f32 v81, v81, v119
    ds_read_b128 v[174:177], v180 offset:0
    ds_read_b128 v[114:117], v179 offset:0
    ds_read_b128 v[162:165], v180 offset:128
    ds_read_b128 v[166:169], v179 offset:128
    ds_read_b128 v[170:173], v180 offset:256
    buffer_load_dwordx4 v137, s[48:51], s4 offen offset:2048 lds
    s_add_u32 m0, s68, 3072
    ds_read_b128 v[154:157], v179 offset:256
    s_add_u32 s4, s45, 185088
    s_waitcnt lgkmcnt(6)
    v_mov_b32 v124, 0
    v_mov_b32 v125, 0
    s_sub_u32 s45, s17, 1
    ds_write_b128 v187, v[122:125] offset:16
    s_waitcnt vmcnt(6)
    buffer_load_dwordx4 v133, s[48:51], s4 offen lds
    s_waitcnt lgkmcnt(4)
    v_mfma_f32_16x16x32_bf16 v[146:149], a[72:75], v[174:177], 0
    v_mfma_f32_16x16x32_bf16 v[146:149], a[76:79], v[114:117], v[146:149]
    s_waitcnt lgkmcnt(3)
    ds_read_b64_tr_b16 a[152:153], v126 offset:0
    ds_read_b64_tr_b16 a[154:155], v126 offset:768
    v_mfma_f32_16x16x32_bf16 v[146:149], a[80:83], v[162:165], v[146:149]
    s_waitcnt lgkmcnt(4)
    ds_read_b64_tr_b16 a[176:177], v126 offset:32
    ds_read_b64_tr_b16 a[178:179], v126 offset:800
    v_mfma_f32_16x16x32_bf16 v[146:149], a[84:87], v[166:169], v[146:149]
    s_waitcnt lgkmcnt(5)
    ds_read_b64_tr_b16 a[200:201], v126 offset:64
    ds_read_b64_tr_b16 a[202:203], v126 offset:832
    v_mfma_f32_16x16x32_bf16 v[146:149], a[88:91], v[170:173], v[146:149]
    buffer_load_dwordx4 v135, s[48:51], s4 offen offset:1024 lds
    v_mfma_f32_16x16x32_bf16 v[146:149], a[92:95], v[154:157], v[146:149]
    ds_write_b64 v187, v[122:123] offset:56
    v_mfma_f32_16x16x32_bf16 v[138:141], a[96:99], v[174:177], 0
    v_mfma_f32_16x16x32_bf16 v[138:141], a[100:103], v[114:117], v[138:141]
    ds_write_b64 v187, v[122:123] offset:64
    v_mfma_f32_16x16x32_bf16 v[138:141], a[104:107], v[162:165], v[138:141]
    s_waitcnt lgkmcnt(6)
    buffer_load_dwordx4 v137, s[48:51], s4 offen offset:2048 lds
    v_mfma_f32_16x16x32_bf16 v[138:141], a[108:111], v[166:169], v[138:141]
    s_add_u32 m0, s28, 8192
    ds_read_b128 v[210:213], v180 offset:6144
    v_fma_f32 v119, v146, v146, s32
    v_mfma_f32_16x16x32_bf16 v[138:141], a[112:115], v[170:173], v[138:141]
    s_add_u32 s4, 0, 12288
    ds_read_b128 v[218:221], v179 offset:6144
    v_fmac_f32 v119, v147, v147
    v_mfma_f32_16x16x32_bf16 v[138:141], a[116:119], v[154:157], v[138:141]
    s_waitcnt lgkmcnt(4)
    ds_read_b128 v[182:185], v180 offset:6272
    s_waitcnt vmcnt(6)
    v_mfma_f32_16x16x32_bf16 v[194:197], a[120:123], v[174:177], 0
    ds_read_b64_tr_b16 a[156:157], v126 offset:3072
    ds_read_b64_tr_b16 a[158:159], v126 offset:3840
    v_mfma_f32_16x16x32_bf16 v[194:197], a[124:127], v[114:117], v[194:197]
    buffer_load_dwordx4 v12, s[8:11], s25 offen nt lds
    v_mfma_f32_16x16x32_bf16 v[194:197], a[128:131], v[162:165], v[194:197]
    s_add_u32 m0, s28, 12288
    ds_read_b64_tr_b16 a[180:181], v126 offset:3104
    ds_read_b64_tr_b16 a[182:183], v126 offset:3872
    v_mfma_f32_16x16x32_bf16 v[194:197], a[132:135], v[166:169], v[194:197]
    ds_read_b64_tr_b16 a[204:205], v126 offset:3136
    ds_read_b64_tr_b16 a[206:207], v126 offset:3904
    v_mfma_f32_16x16x32_bf16 v[194:197], a[136:139], v[170:173], v[194:197]
    ds_read_b128 v[202:205], v179 offset:6272
    ds_read_b128 v[150:153], v180 offset:6400
    v_mfma_f32_16x16x32_bf16 v[194:197], a[140:143], v[154:157], v[194:197]
    s_waitcnt lgkmcnt(10)
    ds_read_b128 v[230:233], v179 offset:6400
    v_fmac_f32 v119, v148, v148
    v_mfma_f32_16x16x32_bf16 v[190:193], a[72:75], v[210:213], 0
    s_waitcnt lgkmcnt(10)
    buffer_load_dwordx4 v13, s[8:11], s25 offen nt lds
    v_mfma_f32_16x16x32_bf16 v[190:193], a[76:79], v[218:221], v[190:193]
    s_waitcnt lgkmcnt(9)
    ds_write_b128 v159, v[122:125] offset:16
    v_mfma_f32_16x16x32_bf16 v[190:193], a[80:83], v[182:185], v[190:193]
    s_add_u32 m0, s29, 0
    v_fmac_f32 v119, v149, v149
    v_fmac_f32 v119, v138, v138
    v_mfma_f32_16x16x32_bf16 v[198:201], a[96:99], v[210:213], 0
    s_waitcnt lgkmcnt(6)
    v_fmac_f32 v119, v139, v139
    v_fmac_f32 v119, v140, v140
    v_mfma_f32_16x16x32_bf16 v[198:201], a[100:103], v[218:221], v[198:201]
    s_waitcnt lgkmcnt(4)
    buffer_load_dwordx4 v14, s[8:11], s25 offen nt lds
    v_mfma_f32_16x16x32_bf16 v[198:201], a[104:107], v[182:185], v[198:201]
    s_waitcnt lgkmcnt(2)
    ds_write_b64 v159, v[122:123] offset:56
    v_mfma_f32_16x16x32_bf16 v[190:193], a[84:87], v[202:205], v[190:193]
    s_add_u32 m0, s69, 0
    s_waitcnt vmcnt(6)
    v_fmac_f32 v119, v141, v141
    v_mfma_f32_16x16x32_bf16 v[190:193], a[88:91], v[150:153], v[190:193]
    s_waitcnt lgkmcnt(2)
    ds_read_b64_tr_b16 a[160:161], v128 offset:0
    ds_read_b64_tr_b16 a[162:163], v128 offset:768
    v_mfma_f32_16x16x32_bf16 v[190:193], a[92:95], v[230:233], v[190:193]
    s_cmp_lt_u32 1, s17
    ds_read_b64_tr_b16 a[184:185], v128 offset:32
    buffer_load_dwordx4 v143, s[52:55], 0 offen lds
    v_mfma_f32_16x16x32_bf16 v[198:201], a[108:111], v[202:205], v[198:201]
    s_cselect_b32 s10, s36, 0
    ds_read_b64_tr_b16 a[186:187], v128 offset:800
    ds_read_b64_tr_b16 a[208:209], v128 offset:64
    v_mfma_f32_16x16x32_bf16 v[198:201], a[112:115], v[150:153], v[198:201]
    s_mov_b32 s25, s24
    ds_read_b64_tr_b16 a[210:211], v128 offset:832
    v_fmac_f32 v119, v194, v194
    v_mfma_f32_16x16x32_bf16 v[198:201], a[116:119], v[230:233], v[198:201]
    ds_write_b64 v159, v[122:123] offset:64
    v_mfma_f32_16x16x32_bf16 v[206:209], a[120:123], v[210:213], 0
    v_fmac_f32 v119, v195, v195
    v_fmac_f32 v119, v196, v196
    v_mfma_f32_16x16x32_bf16 v[206:209], a[124:127], v[218:221], v[206:209]
    buffer_load_dwordx4 v132, s[52:55], 0 offen offset:1024 lds
    v_fmac_f32 v119, v197, v197
    v_mfma_f32_16x16x32_bf16 v[206:209], a[128:131], v[182:185], v[206:209]
    s_waitcnt lgkmcnt(6)
    v_fma_f32 v142, v190, v190, s32
    v_fmac_f32 v142, v191, v191
    v_mfma_f32_16x16x32_bf16 v[206:209], a[132:135], v[202:205], v[206:209]
    s_waitcnt lgkmcnt(4)
    v_fmac_f32 v142, v192, v192
    v_fmac_f32 v142, v193, v193
    v_mfma_f32_16x16x32_bf16 v[206:209], a[136:139], v[150:153], v[206:209]
    s_waitcnt lgkmcnt(3)
    v_fmac_f32 v142, v198, v198
    v_fmac_f32 v142, v199, v199
    v_mfma_f32_16x16x32_bf16 v[206:209], a[140:143], v[230:233], v[206:209]
    s_waitcnt lgkmcnt(1)
    v_fmac_f32 v142, v200, v200
    v_fmac_f32 v142, v201, v201
    v_mfma_f32_16x16x32_bf16 v[214:217], a[0:3], v[174:177], 0
    buffer_load_dwordx4 v118, s[52:55], 0 offen offset:2048 lds
    v_xor_b32 v254, 65536, v2
    v_mfma_f32_16x16x32_bf16 v[214:217], a[4:7], v[114:117], v[214:217]
    s_add_u32 m0, s69, 3072
    v_fmac_f32 v142, v206, v206
    v_fmac_f32 v142, v207, v207
    v_mfma_f32_16x16x32_bf16 v[214:217], a[8:11], v[162:165], v[214:217]
    v_fmac_f32 v142, v208, v208
    s_waitcnt vmcnt(6)
    v_mfma_f32_16x16x32_bf16 v[214:217], a[12:15], v[166:169], v[214:217]
    ds_read_b64_tr_b16 a[164:165], v128 offset:3072
    ds_read_b64_tr_b16 a[166:167], v128 offset:3840
    v_mfma_f32_16x16x32_bf16 v[214:217], a[16:19], v[170:173], v[214:217]
    ds_read_b64_tr_b16 a[188:189], v128 offset:3104
    ds_read_b64_tr_b16 a[190:191], v128 offset:3872
    v_mfma_f32_16x16x32_bf16 v[214:217], a[20:23], v[154:157], v[214:217]
    buffer_load_dwordx4 v143, s[52:55], s4 offen lds
    v_mfma_f32_16x16x32_bf16 v[234:237], a[24:27], v[174:177], 0
    ds_read_b64_tr_b16 a[212:213], v128 offset:3136
    ds_read_b64_tr_b16 a[214:215], v128 offset:3904
    v_mfma_f32_16x16x32_bf16 v[234:237], a[28:31], v[114:117], v[234:237]
    v_fmac_f32 v142, v209, v209
    v_lshrrev_b32 v130, 2, v254
    v_mfma_f32_16x16x32_bf16 v[234:237], a[32:35], v[162:165], v[234:237]
    v_fma_f32 v255, v214, v214, s32
    v_fmac_f32 v255, v215, v215
    v_mfma_f32_16x16x32_bf16 v[234:237], a[36:39], v[166:169], v[234:237]
    v_fmac_f32 v255, v216, v216
    v_fmac_f32 v255, v217, v217
    v_mfma_f32_16x16x32_bf16 v[234:237], a[40:43], v[170:173], v[234:237]
    buffer_load_dwordx4 v132, s[52:55], s4 offen offset:1024 lds
    v_mfma_f32_16x16x32_bf16 v[234:237], a[44:47], v[154:157], v[234:237]
    s_waitcnt lgkmcnt(4)
    v_lshrrev_b32 v133, 8, v254
    v_add_u32 v254, 157184, v254
    v_mfma_f32_16x16x32_bf16 v[222:225], a[48:51], v[174:177], 0
    s_waitcnt lgkmcnt(2)
    v_lshl_add_u32 v135, s16, 2, v254
    v_add_u32 v130, 162048, v130
    v_mfma_f32_16x16x32_bf16 v[222:225], a[52:55], v[114:117], v[222:225]
    v_fmac_f32 v255, v234, v234
    v_fmac_f32 v255, v235, v235
    v_mfma_f32_16x16x32_bf16 v[222:225], a[56:59], v[162:165], v[222:225]
    s_waitcnt lgkmcnt(0)
    v_fmac_f32 v255, v236, v236
    v_fmac_f32 v255, v237, v237
    v_mfma_f32_16x16x32_bf16 v[222:225], a[60:63], v[166:169], v[222:225]
    buffer_load_dwordx4 v118, s[52:55], s4 offen offset:2048 lds
    v_mfma_f32_16x16x32_bf16 v[222:225], a[64:67], v[170:173], v[222:225]
    s_add_u32 m0, s68, 0
    v_lshlrev_b32 v133, 4, v133
    v_add_u32 v133, 162048, v133
    v_mfma_f32_16x16x32_bf16 v[222:225], a[68:71], v[154:157], v[222:225]
    s_add_u32 s4, 0, 24576
    v_or_b32 v242, v32, v33
    v_and_b32 v242, 0xffff, v242
    v_mfma_f32_16x16x32_bf16 v[238:241], a[0:3], v[210:213], 0
    v_lshl_or_b32 v242, v242, 16, v242
    v_or_b32 v243, v32, v33
    v_mfma_f32_16x16x32_bf16 v[238:241], a[4:7], v[218:221], v[238:241]
    v_and_b32 v243, 0xffff, v243
    v_fmac_f32 v255, v222, v222
    v_mfma_f32_16x16x32_bf16 v[238:241], a[8:11], v[182:185], v[238:241]
    buffer_load_dwordx4 v143, s[52:55], s4 offen lds
    v_mfma_f32_16x16x32_bf16 v[238:241], a[12:15], v[202:205], v[238:241]
    v_fmac_f32 v255, v223, v223
    v_fmac_f32 v255, v224, v224
    v_mfma_f32_16x16x32_bf16 v[238:241], a[16:19], v[150:153], v[238:241]
    v_fmac_f32 v255, v225, v225
    v_cvt_pk_bf16_f32 v36, v255, v119
    v_mfma_f32_16x16x32_bf16 v[238:241], a[20:23], v[230:233], v[238:241]
    v_lshl_or_b32 v243, v243, 16, v243
    v_or_b32 v244, v32, v33
    v_mfma_f32_16x16x32_bf16 v[114:117], v[32:35], v[36:39], 0
    v_lshrrev_b32 v244, 16, v244
    v_lshl_or_b32 v244, v244, 16, v244
    v_mfma_f32_16x16x32_bf16 v[246:249], a[24:27], v[210:213], 0
    v_or_b32 v245, v32, v33
    v_lshrrev_b32 v245, 16, v245
    v_mfma_f32_16x16x32_bf16 v[246:249], a[28:31], v[218:221], v[246:249]
    v_lshl_or_b32 v245, v245, 16, v245
    v_fma_f32 v119, v238, v238, s32
    v_mfma_f32_16x16x32_bf16 v[246:249], a[32:35], v[182:185], v[246:249]
    v_rsq_f32 v115, v115
    v_mfma_f32_16x16x32_bf16 v[246:249], a[36:39], v[202:205], v[246:249]
    ds_read_b128 v[170:173], v0 offset:20480
    v_mul_f32 v146, v115, v146
    v_mfma_f32_16x16x32_bf16 v[246:249], a[40:43], v[150:153], v[246:249]
    ds_read_b128 v[166:169], v1 offset:20480
    v_mul_f32 v147, v115, v147
    v_mfma_f32_16x16x32_bf16 v[246:249], a[44:47], v[230:233], v[246:249]
    ds_read_b128 v[162:165], v0 offset:20608
    v_cvt_pk_f16_f32 v126, v146, v147
    v_mfma_f32_16x16x32_bf16 v[250:253], a[48:51], v[210:213], 0
    ds_read_b128 v[210:213], v1 offset:20608
    v_mul_f32 v148, v115, v148
    v_mfma_f32_16x16x32_bf16 v[250:253], a[52:55], v[218:221], v[250:253]
    ds_read_b128 v[226:229], v0 offset:20736
    v_mul_f32 v149, v115, v149
    v_mfma_f32_16x16x32_bf16 v[250:253], a[56:59], v[182:185], v[250:253]
    ds_read_b128 v[218:221], v1 offset:20736
    v_cvt_pk_f16_f32 v127, v148, v149
    v_mfma_f32_16x16x32_bf16 v[250:253], a[60:63], v[202:205], v[250:253]
    v_rsq_f32 v114, v114
    v_mfma_f32_16x16x32_bf16 v[250:253], a[64:67], v[150:153], v[250:253]
    v_mul_f32 v114, s31, v114
    v_mul_f32 v138, v115, v138
    v_mfma_f32_16x16x32_bf16 v[250:253], a[68:71], v[230:233], v[250:253]
    s_waitcnt lgkmcnt(5)
    v_mul_f32 v139, v115, v139
    v_cvt_pk_f16_f32 v128, v138, v139
    v_mfma_f32_16x16x32_bf16 v[122:125], a[96:99], v[170:173], 0
    s_waitcnt lgkmcnt(4)
    v_mul_f32 v140, v115, v140
    v_mul_f32 v141, v115, v141
    v_mfma_f32_16x16x32_bf16 v[122:125], a[100:103], v[166:169], v[122:125]
    s_waitcnt lgkmcnt(3)
    v_cvt_pk_f16_f32 v129, v140, v141
    v_mul_f32 v194, v115, v194
    v_mfma_f32_16x16x32_bf16 v[122:125], a[104:107], v[162:165], v[122:125]
    s_waitcnt lgkmcnt(2)
    ds_write_b128 v187, v[126:129]
    v_mfma_f32_16x16x32_bf16 v[122:125], a[108:111], v[210:213], v[122:125]
    s_waitcnt lgkmcnt(1)
    v_mul_f32 v195, v115, v195
    v_cvt_pk_f16_f32 v156, v194, v195
    v_mfma_f32_16x16x32_bf16 v[122:125], a[112:115], v[226:229], v[122:125]
    v_mul_f32 v196, v115, v196
    v_mul_f32 v197, v115, v197
    v_mfma_f32_16x16x32_bf16 v[122:125], a[116:119], v[218:221], v[122:125]
    v_cvt_pk_f16_f32 v157, v196, v197
    v_mul_f32 v214, v114, v214
    v_mfma_f32_16x16x32_bf16 v[126:129], a[120:123], v[170:173], 0
    ds_write_b64 v187, v[156:157] offset:48
    v_mfma_f32_16x16x32_bf16 v[126:129], a[124:127], v[166:169], v[126:129]
    v_mul_f32 v215, v114, v215
    v_cvt_pk_f16_f32 v154, v214, v215
    v_mfma_f32_16x16x32_bf16 v[126:129], a[128:131], v[162:165], v[126:129]
    v_mul_f32 v216, v114, v216
    v_mul_f32 v217, v114, v217
    v_mfma_f32_16x16x32_bf16 v[126:129], a[132:135], v[210:213], v[126:129]
    v_cvt_pk_f16_f32 v155, v216, v217
    v_mul_f32 v234, v114, v234
    v_mfma_f32_16x16x32_bf16 v[126:129], a[136:139], v[226:229], v[126:129]
    v_mul_f32 v235, v114, v235
    v_cvt_pk_f16_f32 v156, v234, v235
    v_mfma_f32_16x16x32_bf16 v[126:129], a[140:143], v[218:221], v[126:129]
    v_mul_f32 v236, v114, v236
    v_mul_f32 v237, v114, v237
    v_mfma_f32_16x16x32_bf16 v[174:177], a[24:27], v[170:173], 0
    v_cvt_pk_f16_f32 v157, v236, v237
    v_mul_f32 v222, v114, v222
    v_mfma_f32_16x16x32_bf16 v[174:177], a[28:31], v[166:169], v[174:177]
    ds_write_b128 v187, v[154:157] offset:32
    v_mfma_f32_16x16x32_bf16 v[174:177], a[32:35], v[162:165], v[174:177]
    v_mul_f32 v223, v114, v223
    v_cvt_pk_f16_f32 v154, v222, v223
    v_mfma_f32_16x16x32_bf16 v[174:177], a[36:39], v[210:213], v[174:177]
    v_mul_f32 v224, v114, v224
    v_mul_f32 v225, v114, v225
    v_mfma_f32_16x16x32_bf16 v[174:177], a[40:43], v[226:229], v[174:177]
    v_cvt_pk_f16_f32 v155, v224, v225
    v_mul_f32 v146, v214, v146
    v_mfma_f32_16x16x32_bf16 v[174:177], a[44:47], v[218:221], v[174:177]
    ds_write_b64 v187, v[154:155] offset:72
    v_mfma_f32_16x16x32_bf16 v[114:117], a[72:75], v[170:173], 0
    v_fmac_f32 v146, v215, v147
    v_fmac_f32 v146, v216, v148
    v_mfma_f32_16x16x32_bf16 v[114:117], a[76:79], v[166:169], v[114:117]
    v_fmac_f32 v146, v217, v149
    v_fmac_f32 v146, v234, v138
    v_mfma_f32_16x16x32_bf16 v[114:117], a[80:83], v[162:165], v[114:117]
    v_fmac_f32 v146, v235, v139
    v_fmac_f32 v146, v236, v140
    v_mfma_f32_16x16x32_bf16 v[114:117], a[84:87], v[210:213], v[114:117]
    v_fmac_f32 v146, v237, v141
    v_fmac_f32 v146, v222, v194
    v_mfma_f32_16x16x32_bf16 v[114:117], a[88:91], v[226:229], v[114:117]
    v_fmac_f32 v146, v223, v195
    v_fmac_f32 v146, v224, v196
    v_mfma_f32_16x16x32_bf16 v[114:117], a[92:95], v[218:221], v[114:117]
    v_fmac_f32 v146, v225, v197
    v_mov_b32 v187, v146
    v_mfma_f32_16x16x32_bf16 v[182:185], a[48:51], v[170:173], 0
    v_fmac_f32 v119, v239, v239
    v_fmac_f32 v119, v240, v240
    v_mfma_f32_16x16x32_bf16 v[182:185], a[52:55], v[166:169], v[182:185]
    v_permlane32_swap_b32 v146, v187
    v_mfma_f32_16x16x32_bf16 v[182:185], a[56:59], v[162:165], v[182:185]
    v_add_f32 v146, v146, v187
    v_mov_b32 v187, v146
    v_mfma_f32_16x16x32_bf16 v[182:185], a[60:63], v[210:213], v[182:185]
    v_fmac_f32 v119, v241, v241
    v_fmac_f32 v119, v246, v246
    v_mfma_f32_16x16x32_bf16 v[182:185], a[64:67], v[226:229], v[182:185]
    v_permlane16_swap_b32 v146, v187
    v_mfma_f32_16x16x32_bf16 v[182:185], a[68:71], v[218:221], v[182:185]
    v_add_f32 v146, v146, v187
    v_add_f32 v146, s39, v146
    v_mfma_f32_16x16x32_bf16 v[230:233], v[170:173], a[144:147], 0
    v_mov_b32 v147, v178
    v_mov_b32 v148, v178
    v_mfma_f32_16x16x32_bf16 v[230:233], v[166:169], a[148:151], v[230:233]
    v_mov_b32 v149, v178
    v_cndmask_b32 v146, v178, v146, s[88:89]
    v_mfma_f32_16x16x32_bf16 v[230:233], v[162:165], a[152:155], v[230:233]
    ds_write_b128 v186, v[146:149] offset:192
    v_mfma_f32_16x16x32_bf16 v[230:233], v[210:213], a[156:159], v[230:233]
    v_fmac_f32 v119, v247, v247
    v_fmac_f32 v119, v248, v248
    v_mfma_f32_16x16x32_bf16 v[230:233], v[226:229], a[160:163], v[230:233]
    v_fmac_f32 v119, v249, v249
    v_fmac_f32 v119, v250, v250
    v_mfma_f32_16x16x32_bf16 v[230:233], v[218:221], a[164:167], v[230:233]
    v_fmac_f32 v119, v251, v251
    v_fmac_f32 v119, v252, v252
    v_mfma_f32_16x16x32_bf16 v[138:141], v[170:173], a[168:171], 0
    v_fmac_f32 v119, v253, v253
    v_cvt_pk_bf16_f32 v36, v119, v142
    v_mfma_f32_16x16x32_bf16 v[138:141], v[166:169], a[172:175], v[138:141]
    v_fma_f32 v119, v114, v114, s32
    v_fmac_f32 v119, v115, v115
    v_mfma_f32_16x16x32_bf16 v[154:157], v[32:35], v[36:39], 0
    v_fmac_f32 v119, v116, v116
    v_fmac_f32 v119, v117, v117
    v_mfma_f32_16x16x32_bf16 v[138:141], v[162:165], a[176:179], v[138:141]
    v_fmac_f32 v119, v122, v122
    v_fmac_f32 v119, v123, v123
    v_mfma_f32_16x16x32_bf16 v[138:141], v[210:213], a[180:183], v[138:141]
    ds_read_b128 v[194:197], v180 offset:0
    v_fmac_f32 v119, v124, v124
    v_mfma_f32_16x16x32_bf16 v[138:141], v[226:229], a[184:187], v[138:141]
    ds_read_b128 v[150:153], v179 offset:0
    v_fmac_f32 v119, v125, v125
    v_mfma_f32_16x16x32_bf16 v[138:141], v[218:221], a[188:191], v[138:141]
    ds_read_b128 v[146:149], v180 offset:128
    v_rsq_f32 v155, v155
    v_rsq_f32 v154, v154
    v_mul_f32 v190, v155, v190
    v_mul_f32 v154, s31, v154
    v_mul_f32 v191, v155, v191
    v_cvt_pk_f16_f32 v202, v190, v191
    v_mul_f32 v192, v155, v192
    v_mul_f32 v193, v155, v193
    v_cvt_pk_f16_f32 v203, v192, v193
    v_mul_f32 v198, v155, v198
    v_mul_f32 v199, v155, v199
    v_cvt_pk_f16_f32 v204, v198, v199
    v_mul_f32 v200, v155, v200
    v_mul_f32 v201, v155, v201
    v_cvt_pk_f16_f32 v205, v200, v201
    v_mul_f32 v206, v155, v206
    v_mul_f32 v207, v155, v207
    v_cvt_pk_f16_f32 v216, v206, v207
    v_mul_f32 v208, v155, v208
    v_mul_f32 v209, v155, v209
    v_cvt_pk_f16_f32 v217, v208, v209
    buffer_load_dwordx4 v132, s[52:55], s4 offen offset:1024 lds
    ds_write_b128 v159, v[202:205]
    v_mul_f32 v238, v154, v238
    v_mul_f32 v239, v154, v239
    v_cvt_pk_f16_f32 v202, v238, v239
    v_mul_f32 v240, v154, v240
    v_mul_f32 v241, v154, v241
    v_cvt_pk_f16_f32 v203, v240, v241
    v_mul_f32 v246, v154, v246
    v_mul_f32 v247, v154, v247
    v_cvt_pk_f16_f32 v204, v246, v247
    v_mul_f32 v248, v154, v248
    v_mul_f32 v249, v154, v249
    buffer_load_dwordx4 v118, s[52:55], s4 offen offset:2048 lds
    ds_write_b64 v159, v[216:217] offset:48
    s_add_u32 m0, s68, 3072
    s_add_u32 s4, 0, 36864
    v_cvt_pk_f16_f32 v205, v248, v249
    v_mul_f32 v250, v154, v250
    v_mul_f32 v251, v154, v251
    v_cvt_pk_f16_f32 v214, v250, v251
    v_mul_f32 v252, v154, v252
    v_mul_f32 v253, v154, v253
    v_cvt_pk_f16_f32 v215, v252, v253
    v_mul_f32 v158, v238, v190
    v_fmac_f32 v158, v239, v191
    v_fmac_f32 v158, v240, v192
    buffer_load_dwordx4 v143, s[52:55], s4 offen lds
    ds_write_b128 v159, v[202:205] offset:32
    v_mfma_f32_16x16x32_bf16 v[154:157], a[0:3], v[170:173], 0
    s_waitcnt lgkmcnt(2)
    v_fmac_f32 v158, v241, v193
    v_fmac_f32 v158, v246, v198
    v_mfma_f32_16x16x32_bf16 v[154:157], a[4:7], v[166:169], v[154:157]
    v_fmac_f32 v158, v247, v199
    v_fmac_f32 v158, v248, v200
    v_mfma_f32_16x16x32_bf16 v[154:157], a[8:11], v[162:165], v[154:157]
    ds_write_b64 v159, v[214:215] offset:72
    v_mfma_f32_16x16x32_bf16 v[154:157], a[12:15], v[210:213], v[154:157]
    buffer_load_dwordx4 v132, s[52:55], s4 offen offset:1024 lds
    v_mfma_f32_16x16x32_bf16 v[154:157], a[16:19], v[226:229], v[154:157]
    v_fmac_f32 v158, v249, v201
    v_fmac_f32 v158, v250, v206
    v_mfma_f32_16x16x32_bf16 v[154:157], a[20:23], v[218:221], v[154:157]
    v_fmac_f32 v158, v251, v207
    v_fmac_f32 v158, v252, v208
    v_mfma_f32_16x16x32_bf16 v[190:193], v[170:173], a[192:195], 0
    ds_read_b128 v[198:201], v179 offset:128
    v_fmac_f32 v158, v253, v209
    v_mfma_f32_16x16x32_bf16 v[190:193], v[166:169], a[196:199], v[190:193]
    ds_read_b128 v[170:173], v180 offset:256
    v_mov_b32 v142, v158
    v_mfma_f32_16x16x32_bf16 v[190:193], v[162:165], a[200:203], v[190:193]
    buffer_load_dwordx4 v118, s[52:55], s4 offen offset:2048 lds
    v_mfma_f32_16x16x32_bf16 v[190:193], v[210:213], a[204:207], v[190:193]
    s_add_u32 m0, s69, 0
    ds_read_b128 v[166:169], v179 offset:256
    v_fmac_f32 v119, v126, v126
    v_mfma_f32_16x16x32_bf16 v[190:193], v[226:229], a[208:211], v[190:193]
    s_add_u32 s4, 0, 49152
    v_permlane32_swap_b32 v158, v142
    s_waitcnt vmcnt(9)
    v_mfma_f32_16x16x32_bf16 v[190:193], v[218:221], a[212:215], v[190:193]
    ds_read_b64 a[216:217], v131 offset:0
    ds_read_b64 a[218:219], v131 offset:1536
    v_mfma_f32_16x16x32_bf16 v[162:165], v[194:197], a[144:147], 0
    ds_read_b64 a[240:241], v131 offset:8
    ds_read_b64 a[242:243], v131 offset:1544
    v_mfma_f32_16x16x32_bf16 v[162:165], v[150:153], a[148:151], v[162:165]
    s_waitcnt lgkmcnt(6)
    ds_read_b64 v[90:91], v121 offset:0
    ds_read_b64 v[92:93], v121 offset:1536
    v_mfma_f32_16x16x32_bf16 v[162:165], v[146:149], a[152:155], v[162:165]
    s_waitcnt lgkmcnt(7)
    v_add_f32 v158, v158, v142
    v_mov_b32 v142, v158
    v_mfma_f32_16x16x32_bf16 v[162:165], v[198:201], a[156:159], v[162:165]
    v_fmac_f32 v119, v127, v127
    v_fmac_f32 v119, v128, v128
    v_mfma_f32_16x16x32_bf16 v[162:165], v[170:173], a[160:163], v[162:165]
    s_waitcnt lgkmcnt(6)
    v_permlane16_swap_b32 v158, v142
    v_mfma_f32_16x16x32_bf16 v[162:165], v[166:169], a[164:167], v[162:165]
    v_add_f32 v158, v158, v142
    v_add_f32 v158, s39, v158
    v_mfma_f32_16x16x32_bf16 v[218:221], v[194:197], a[168:171], 0
    v_mov_b32 v159, v178
    v_mov_b32 v160, v178
    v_mfma_f32_16x16x32_bf16 v[218:221], v[150:153], a[172:175], v[218:221]
    s_waitcnt lgkmcnt(4)
    v_mov_b32 v161, v178
    v_cndmask_b32 v158, v178, v158, s[88:89]
    v_mfma_f32_16x16x32_bf16 v[210:213], v[242:245], a[216:219], 0
    s_waitcnt lgkmcnt(2)
    ds_write_b128 v189, v[158:161] offset:192
    v_mfma_f32_16x16x32_bf16 v[210:213], v[242:245], a[240:243], v[210:213]
    s_waitcnt lgkmcnt(1)
    buffer_load_dwordx4 v143, s[52:55], s4 offen lds
    v_mfma_f32_16x16x32_bf16 v[210:213], v[242:245], v[90:93], v[210:213]
    v_fmac_f32 v119, v129, v129
    s_waitcnt vmcnt(7)
    v_mfma_f32_16x16x32_bf16 v[218:221], v[146:149], a[176:179], v[218:221]
    ds_read_b64 a[232:233], v131 offset:3072
    ds_read_b64 a[220:221], v131 offset:4608
    v_mfma_f32_16x16x32_bf16 v[218:221], v[198:201], a[180:183], v[218:221]
    ds_read_b64 v[82:83], v131 offset:3080
    ds_read_b64 a[244:245], v131 offset:4616
    v_mfma_f32_16x16x32_bf16 v[218:221], v[170:173], a[184:187], v[218:221]
    ds_read_b64 v[106:107], v121 offset:3072
    ds_read_b64 v[94:95], v121 offset:4608
    v_mfma_f32_16x16x32_bf16 v[218:221], v[166:169], a[188:191], v[218:221]
    buffer_load_dwordx4 v132, s[52:55], s4 offen offset:1024 lds
    v_mfma_f32_16x16x32_bf16 v[206:209], v[194:197], a[192:195], 0
    ds_read_b128 v[226:229], v180 offset:6144
    ds_read_b128 v[158:161], v179 offset:6144
    v_mfma_f32_16x16x32_bf16 v[206:209], v[150:153], a[196:199], v[206:209]
    ds_read_b128 v[194:197], v180 offset:6272
    ds_read_b128 v[150:153], v179 offset:6272
    v_mfma_f32_16x16x32_bf16 v[206:209], v[146:149], a[200:203], v[206:209]
    v_mov_b32 v255, v210
    v_mov_b32_dpp v255, v211 quad_perm:[0,1,2,3] row_mask:0x2 bank_mask:0xf
    v_mfma_f32_16x16x32_bf16 v[206:209], v[198:201], a[204:207], v[206:209]
    ds_read_b128 v[210:213], v180 offset:6400
    ds_read_b128 v[146:149], v179 offset:6400
    v_mfma_f32_16x16x32_bf16 v[206:209], v[170:173], a[208:211], v[206:209]
    s_waitcnt lgkmcnt(10)
    buffer_load_dwordx4 v118, s[52:55], s4 offen offset:2048 lds
    v_mfma_f32_16x16x32_bf16 v[206:209], v[166:169], a[212:215], v[206:209]
    s_add_u32 m0, s69, 3072
    s_add_u32 s4, 0, 61440
    s_waitcnt lgkmcnt(6)
    v_fma_f32 v142, v154, v154, s32
    v_fmac_f32 v142, v155, v155
    v_fmac_f32 v142, v156, v156
    v_fmac_f32 v142, v157, v157
    v_fmac_f32 v142, v174, v174
    v_fmac_f32 v142, v175, v175
    s_waitcnt lgkmcnt(5)
    v_mfma_f32_16x16x32_bf16 v[170:173], v[226:229], a[144:147], 0
    s_waitcnt lgkmcnt(4)
    s_waitcnt vmcnt(6)
    ds_read_b64 a[222:223], v134 offset:0
    v_mfma_f32_16x16x32_bf16 v[170:173], v[158:161], a[148:151], v[170:173]
    s_waitcnt lgkmcnt(3)
    buffer_load_dwordx4 v143, s[52:55], s4 offen lds
    v_mfma_f32_16x16x32_bf16 v[170:173], v[194:197], a[152:155], v[170:173]
    ds_read_b64 a[234:235], v134 offset:1536
    ds_read_b64 a[246:247], v134 offset:8
    v_mfma_f32_16x16x32_bf16 v[170:173], v[150:153], a[156:159], v[170:173]
    s_waitcnt lgkmcnt(3)
    ds_read_b64 v[84:85], v134 offset:1544
    ds_read_b64 v[96:97], v120 offset:0
    v_mfma_f32_16x16x32_bf16 v[170:173], v[210:213], a[160:163], v[170:173]
    ds_read_b64 v[108:109], v120 offset:1536
    v_fmac_f32 v142, v176, v176
    v_mfma_f32_16x16x32_bf16 v[170:173], v[146:149], a[164:167], v[170:173]
    v_fmac_f32 v142, v177, v177
    v_fmac_f32 v142, v182, v182
    v_mfma_f32_16x16x32_bf16 v[198:201], v[226:229], a[168:171], 0
    buffer_load_dwordx4 v132, s[52:55], s4 offen offset:1024 lds
    v_mfma_f32_16x16x32_bf16 v[198:201], v[158:161], a[172:175], v[198:201]
    v_fmac_f32 v142, v183, v183
    v_fmac_f32 v142, v184, v184
    v_mfma_f32_16x16x32_bf16 v[198:201], v[194:197], a[176:179], v[198:201]
    s_waitcnt lgkmcnt(5)
    v_fmac_f32 v142, v185, v185
    v_cvt_pk_bf16_f32 v36, v142, v119
    v_mfma_f32_16x16x32_bf16 v[238:241], v[242:245], a[220:223], 0
    v_cvt_pk_bf16_f32 v246, v230, v231
    v_cvt_pk_bf16_f32 v247, v232, v233
    v_mfma_f32_16x16x32_bf16 v[166:169], v[32:35], v[36:39], 0
    s_waitcnt lgkmcnt(3)
    v_cvt_pk_bf16_f32 v178, v138, v139
    v_cvt_pk_bf16_f32 v179, v140, v141
    v_mfma_f32_16x16x32_bf16 v[238:241], v[242:245], a[244:247], v[238:241]
    s_waitcnt lgkmcnt(1)
    buffer_load_dwordx4 v118, s[52:55], s4 offen offset:2048 lds
    v_mfma_f32_16x16x32_bf16 v[238:241], v[242:245], v[94:97], v[238:241]
    s_add_u32 m0, s28, 65536
    v_rsq_f32 v167, v167
    v_mfma_f32_16x16x32_bf16 v[138:141], v[242:245], a[232:235], 0
    s_waitcnt vmcnt(6)
    ds_read_b64 a[224:225], v134 offset:3072
    ds_read_b64 a[226:227], v134 offset:4608
    v_mfma_f32_16x16x32_bf16 v[138:141], v[242:245], v[82:85], v[138:141]
    s_waitcnt lgkmcnt(2)
    ds_read_b64 a[248:249], v134 offset:3080
    ds_read_b64 a[250:251], v134 offset:4616
    v_mfma_f32_16x16x32_bf16 v[138:141], v[242:245], v[106:109], v[138:141]
    ds_read_b64 v[98:99], v120 offset:3072
    ds_read_b64 v[100:101], v120 offset:4608
    v_mfma_f32_16x16x32_bf16 v[198:201], v[150:153], a[180:183], v[198:201]
    buffer_load_dwordx4 v10, s[8:11], s24 offen nt lds
    v_mfma_f32_16x16x32_bf16 v[198:201], v[210:213], a[184:187], v[198:201]
    s_add_u32 m0, s28, 69632
    v_mov_b32 v132, v239
    v_mul_f32 v114, v167, v114
    v_mfma_f32_16x16x32_bf16 v[198:201], v[146:149], a[188:191], v[198:201]
    v_mov_b32_dpp v255, v138 quad_perm:[0,1,2,3] row_mask:0x4 bank_mask:0xf
    v_mov_b32_dpp v255, v238 quad_perm:[0,1,2,3] row_mask:0x8 bank_mask:0xf
    v_mfma_f32_16x16x32_bf16 v[230:233], v[226:229], a[192:195], 0
    v_mov_b32_dpp v132, v139 quad_perm:[0,1,2,3] row_mask:0x2 bank_mask:0xf
    v_mul_f32 v115, v167, v115
    v_mfma_f32_16x16x32_bf16 v[230:233], v[158:161], a[196:199], v[230:233]
    v_rsq_f32 v166, v166
    v_mfma_f32_16x16x32_bf16 v[230:233], v[194:197], a[200:203], v[230:233]
    s_waitcnt lgkmcnt(4)
    buffer_load_dwordx4 v11, s[8:11], s24 offen nt lds
    v_mfma_f32_16x16x32_bf16 v[138:141], v[242:245], a[224:227], 0
    s_waitcnt lgkmcnt(2)
    v_mul_f32 v166, s31, v166
    v_cvt_pk_f16_f32 v114, v114, v115
    v_mfma_f32_16x16x32_bf16 v[138:141], v[242:245], a[248:251], v[138:141]
    s_waitcnt lgkmcnt(0)
    v_mul_f32 v116, v167, v116
    v_mul_f32 v117, v167, v117
    v_mfma_f32_16x16x32_bf16 v[138:141], v[242:245], v[98:101], v[138:141]
    s_add_u32 m0, s28, 73728
    v_cvt_pk_f16_f32 v115, v116, v117
    v_mul_f32 v122, v167, v122
    v_mfma_f32_16x16x32_bf16 v[230:233], v[150:153], a[204:207], v[230:233]
    v_mul_f32 v123, v167, v123
    v_cvt_pk_f16_f32 v116, v122, v123
    v_mfma_f32_16x16x32_bf16 v[230:233], v[210:213], a[208:211], v[230:233]
    buffer_load_dwordx4 v12, s[8:11], s24 offen nt lds
    v_mfma_f32_16x16x32_bf16 v[230:233], v[146:149], a[212:215], v[230:233]
    s_barrier
    ds_read_b128 v[146:149], v0 offset:26624
    ds_read_b128 v[158:161], v1 offset:26624
    s_waitcnt vmcnt(6)
    ds_read_b64 a[236:237], v131 offset:0
    ds_read_b64 a[228:229], v131 offset:1536
    ds_read_b64 v[86:87], v131 offset:8
    s_add_u32 m0, s28, 77824
    ds_read_b64 a[252:253], v131 offset:1544
    ds_read_b64 v[110:111], v121 offset:0
    ds_read_b64 v[102:103], v121 offset:1536
    buffer_load_dwordx4 v13, s[8:11], s24 offen nt lds
    ds_read_b128 v[150:153], v0 offset:26752
    ds_read_b128 v[210:213], v1 offset:26752
    s_add_u32 m0, s74, 0
    ds_read_b128 v[238:241], v0 offset:26880
    ds_read_b128 v[194:197], v1 offset:26880
    v_mov_b32_dpp v132, v138 quad_perm:[0,1,2,3] row_mask:0x4 bank_mask:0xf
    v_mov_b32_dpp v132, v139 quad_perm:[0,1,2,3] row_mask:0x8 bank_mask:0xf
    s_waitcnt lgkmcnt(11)
    v_mfma_f32_16x16x32_bf16 v[226:229], a[72:75], v[146:149], 0
    s_waitcnt lgkmcnt(10)
    ds_write_b32 v135, v255 offset:0
    v_mfma_f32_16x16x32_bf16 v[226:229], a[76:79], v[158:161], v[226:229]
    s_waitcnt lgkmcnt(8)
    buffer_load_dwordx4 v14, s[8:11], s24 offen nt lds
    v_mfma_f32_16x16x32_bf16 v[138:141], a[96:99], v[146:149], 0
    s_add_u32 s8, s40, s23
    ds_write_b32 v135, v132 offset:1024
    v_mfma_f32_16x16x32_bf16 v[138:141], a[100:103], v[158:161], v[138:141]
    s_addc_u32 s9, s41, 0
    v_mul_f32 v124, v167, v124
    v_mul_f32 v125, v167, v125
    v_mfma_f32_16x16x32_bf16 v[250:253], a[120:123], v[146:149], 0
    s_waitcnt lgkmcnt(4)
    v_cvt_pk_f16_f32 v117, v124, v125
    v_mul_f32 v126, v167, v126
    v_mfma_f32_16x16x32_bf16 v[226:229], a[80:83], v[150:153], v[226:229]
    s_sub_u32 s10, s36, s23
    v_mul_f32 v127, v167, v127
    v_cvt_pk_f16_f32 v124, v126, v127
    v_mfma_f32_16x16x32_bf16 v[226:229], a[84:87], v[210:213], v[226:229]
    s_waitcnt lgkmcnt(2)
    v_mul_f32 v128, v167, v128
    v_mul_f32 v129, v167, v129
    v_mfma_f32_16x16x32_bf16 v[226:229], a[88:91], v[238:241], v[226:229]
    s_cmp_lt_u32 s34, s17
    v_cvt_pk_f16_f32 v125, v128, v129
    v_mul_f32 v154, v166, v154
    s_waitcnt vmcnt(5)
    v_mfma_f32_16x16x32_bf16 v[226:229], a[92:95], v[194:197], v[226:229]
    s_cselect_b32 s10, s10, 0
    ds_read_b64 a[230:231], v131 offset:3072
    ds_read_b64 a[238:239], v131 offset:4608
    v_mfma_f32_16x16x32_bf16 v[138:141], a[104:107], v[150:153], v[138:141]
    s_add_u32 m0, s28, 0
    ds_read_b64 a[254:255], v131 offset:3080
    ds_read_b64 v[88:89], v131 offset:4616
    v_mfma_f32_16x16x32_bf16 v[138:141], a[108:111], v[210:213], v[138:141]
    s_mov_b32 s24, s23
    ds_read_b64 v[104:105], v121 offset:3072
    ds_read_b64 v[112:113], v121 offset:4608
    v_mfma_f32_16x16x32_bf16 v[138:141], a[112:115], v[238:241], v[138:141]
    s_add_u32 s23, s23, s21
    v_mul_f32 v155, v166, v155
    v_cvt_pk_f16_f32 v126, v154, v155
    v_mfma_f32_16x16x32_bf16 v[138:141], a[116:119], v[194:197], v[138:141]
    s_cmp_ge_u32 s19, 72
    v_mul_f32 v156, v166, v156
    v_mul_f32 v157, v166, v157
    v_mfma_f32_16x16x32_bf16 v[250:253], a[124:127], v[158:161], v[250:253]
    s_cselect_b32 s34, 72, 0
    v_cvt_pk_f16_f32 v127, v156, v157
    v_mul_f32 v174, v166, v174
    v_mfma_f32_16x16x32_bf16 v[250:253], a[128:131], v[150:153], v[250:253]
    s_cselect_b32 s35, s22, 0
    v_mul_f32 v175, v166, v175
    v_cvt_pk_f16_f32 v128, v174, v175
    v_mfma_f32_16x16x32_bf16 v[250:253], a[132:135], v[210:213], v[250:253]
    s_sub_u32 s19, s19, s34
    v_mul_f32 v176, v166, v176
    v_mul_f32 v177, v166, v177
    v_mfma_f32_16x16x32_bf16 v[250:253], a[136:139], v[238:241], v[250:253]
    s_waitcnt lgkmcnt(4)
    v_cvt_pk_f16_f32 v129, v176, v177
    v_mul_f32 v182, v166, v182
    v_mfma_f32_16x16x32_bf16 v[154:157], v[242:245], a[228:231], 0
    s_waitcnt lgkmcnt(2)
    v_mul_f32 v183, v166, v183
    v_cvt_pk_f16_f32 v122, v182, v183
    v_mfma_f32_16x16x32_bf16 v[154:157], v[242:245], a[252:255], v[154:157]
    s_waitcnt lgkmcnt(0)
    v_mul_f32 v184, v166, v184
    v_mul_f32 v185, v166, v185
    v_mfma_f32_16x16x32_bf16 v[154:157], v[242:245], v[102:105], v[154:157]
    s_add_u32 s23, s23, s35
    v_cvt_pk_f16_f32 v123, v184, v185
    v_cvt_pk_bf16_f32 v186, v190, v191
    v_mfma_f32_16x16x32_bf16 v[118:121], v[242:245], a[236:239], 0
    v_cvt_pk_bf16_f32 v187, v192, v193
    v_cvt_pk_bf16_f32 v162, v162, v162
    v_mfma_f32_16x16x32_bf16 v[118:121], v[242:245], v[86:89], v[118:121]
    v_cvt_pk_bf16_f32 v163, v163, v163
    v_cvt_pk_bf16_f32 v164, v164, v164
    v_mfma_f32_16x16x32_bf16 v[118:121], v[242:245], v[110:113], v[118:121]
    ds_write2_b32 v181, v162, v163 offset0:0 offset1:68
    v_mfma_f32_16x16x32_bf16 v[250:253], a[140:143], v[194:197], v[250:253]
    v_cvt_pk_bf16_f32 v165, v165, v165
    v_cvt_pk_bf16_f32 v218, v218, v218
    v_mfma_f32_16x16x32_bf16 v[166:169], a[0:3], v[146:149], 0
    ds_write2_b32 v181, v164, v165 offset0:136 offset1:204
    v_mfma_f32_16x16x32_bf16 v[166:169], a[4:7], v[158:161], v[166:169]
    v_cvt_pk_bf16_f32 v219, v219, v219
    v_mov_b32 v180, v118
    v_mfma_f32_16x16x32_bf16 v[166:169], a[8:11], v[150:153], v[166:169]
    ds_write2_b32 v181, v218, v219 offset0:16 offset1:84
    v_mfma_f32_16x16x32_bf16 v[166:169], a[12:15], v[210:213], v[166:169]
    v_mov_b32_dpp v180, v154 quad_perm:[0,1,2,3] row_mask:0x2 bank_mask:0xf
    v_mov_b32_dpp v180, v155 quad_perm:[0,1,2,3] row_mask:0x4 bank_mask:0xf
    v_mfma_f32_16x16x32_bf16 v[166:169], a[16:19], v[238:241], v[166:169]
    v_mov_b32_dpp v180, v119 quad_perm:[0,1,2,3] row_mask:0x8 bank_mask:0xf
    v_cvt_pk_bf16_f32 v220, v220, v220
    v_mfma_f32_16x16x32_bf16 v[166:169], a[20:23], v[194:197], v[166:169]
    ds_write_b32 v135, v180 offset:2048
    v_mfma_f32_16x16x32_bf16 v[118:121], a[24:27], v[146:149], 0
    v_cvt_pk_bf16_f32 v221, v221, v221
    v_cvt_pk_bf16_f32 v206, v206, v206
    v_mfma_f32_16x16x32_bf16 v[118:121], a[28:31], v[158:161], v[118:121]
    ds_write2_b32 v181, v220, v221 offset0:152 offset1:220
    v_mfma_f32_16x16x32_bf16 v[118:121], a[32:35], v[150:153], v[118:121]
    v_cvt_pk_bf16_f32 v207, v207, v207
    v_cvt_pk_bf16_f32 v208, v208, v208
    v_mfma_f32_16x16x32_bf16 v[118:121], a[36:39], v[210:213], v[118:121]
    ds_write2_b32 v181, v206, v207 offset0:32 offset1:100
    v_mfma_f32_16x16x32_bf16 v[118:121], a[40:43], v[238:241], v[118:121]
    v_cvt_pk_bf16_f32 v209, v209, v209
    v_cvt_pk_bf16_f32 v170, v170, v170
    v_mfma_f32_16x16x32_bf16 v[118:121], a[44:47], v[194:197], v[118:121]
    ds_write2_b32 v181, v208, v209 offset0:168 offset1:236
    v_mfma_f32_16x16x32_bf16 v[162:165], a[48:51], v[146:149], 0
    s_waitcnt lgkmcnt(3)
    v_cvt_pk_bf16_f32 v171, v171, v171
    v_cvt_pk_bf16_f32 v172, v172, v172
    v_mfma_f32_16x16x32_bf16 v[162:165], a[52:55], v[158:161], v[162:165]
    s_barrier
    ds_read_b128 v[218:221], v254 offset:0
    ds_read_b128 v[154:157], v254 offset:1024
    v_mfma_f32_16x16x32_bf16 v[162:165], a[56:59], v[150:153], v[162:165]
    ds_read_b128 v[134:137], v254 offset:2048
    v_cvt_pk_bf16_f32 v173, v173, v173
    v_mfma_f32_16x16x32_bf16 v[162:165], a[60:63], v[210:213], v[162:165]
    ds_write2_b32 v188, v170, v171 offset0:0 offset1:68
    v_mfma_f32_16x16x32_bf16 v[162:165], a[64:67], v[238:241], v[162:165]
    v_cvt_pk_bf16_f32 v198, v198, v198
    v_cvt_pk_bf16_f32 v199, v199, v199
    v_mfma_f32_16x16x32_bf16 v[162:165], a[68:71], v[194:197], v[162:165]
    ds_write2_b32 v188, v172, v173 offset0:136 offset1:204
    v_mfma_f32_16x16x32_bf16 v[170:173], v[146:149], a[144:147], 0
    v_cvt_pk_bf16_f32 v200, v200, v200
    v_cvt_pk_bf16_f32 v201, v201, v201
    v_mfma_f32_16x16x32_bf16 v[170:173], v[158:161], a[148:151], v[170:173]
    ds_write2_b32 v188, v198, v199 offset0:16 offset1:84
    v_mfma_f32_16x16x32_bf16 v[170:173], v[150:153], a[152:155], v[170:173]
    s_waitcnt lgkmcnt(4)
    v_add_f32 v218, v218, v219
    v_add_f32 v220, v220, v221
    v_mfma_f32_16x16x32_bf16 v[170:173], v[210:213], a[156:159], v[170:173]
    s_waitcnt lgkmcnt(3)
    ds_write2_b32 v188, v200, v201 offset0:152 offset1:220
    v_mfma_f32_16x16x32_bf16 v[170:173], v[238:241], a[160:163], v[170:173]
    v_add_f32 v218, v218, v220
    v_mul_f32 v218, 0xbbaaaaab, v218
    v_mfma_f32_16x16x32_bf16 v[170:173], v[194:197], a[164:167], v[170:173]
    ds_write_b32 v130, v218 offset:0
    v_mfma_f32_16x16x32_bf16 v[174:177], v[146:149], a[168:171], 0
    v_add_f32 v154, v154, v155
    v_add_f32 v156, v156, v157
    v_mfma_f32_16x16x32_bf16 v[174:177], v[158:161], a[172:175], v[174:177]
    ds_read_b128 v[218:221], v133 offset:0
    ds_read_b128 v[182:185], v133 offset:64
    v_mfma_f32_16x16x32_bf16 v[174:177], v[150:153], a[176:179], v[174:177]
    v_add_f32 v154, v154, v156
    v_mul_f32 v154, 0xbbaaaaab, v154
    v_mfma_f32_16x16x32_bf16 v[174:177], v[210:213], a[180:183], v[174:177]
    ds_read_b128 v[190:193], v0 offset:32768
    v_add_f32 v134, v134, v135
    v_mfma_f32_16x16x32_bf16 v[174:177], v[238:241], a[184:187], v[174:177]
    ds_read_b128 v[198:201], v1 offset:32768
    v_add_f32 v136, v136, v137
    v_mfma_f32_16x16x32_bf16 v[174:177], v[194:197], a[188:191], v[174:177]
    ds_read_b128 v[242:245], v0 offset:32896
    v_add_f32 v134, v134, v136
    v_mfma_f32_16x16x32_bf16 v[206:209], v[146:149], a[192:195], 0
    ds_read_b128 v[146:149], v1 offset:32896
    v_mul_f32 v134, 0xbbaaaaab, v134
    v_mfma_f32_16x16x32_bf16 v[206:209], v[158:161], a[196:199], v[206:209]
    ds_read_b128 v[158:161], v0 offset:33024
    v_cvt_pk_bf16_f32 v230, v230, v230
    v_mfma_f32_16x16x32_bf16 v[206:209], v[150:153], a[200:203], v[206:209]
    ds_read_b128 v[150:153], v1 offset:33024
    v_cvt_pk_bf16_f32 v231, v231, v231
    v_mfma_f32_16x16x32_bf16 v[206:209], v[210:213], a[204:207], v[206:209]
    s_waitcnt lgkmcnt(6)
    ds_write_b32 v130, v154 offset:256
    v_mfma_f32_16x16x32_bf16 v[206:209], v[238:241], a[208:211], v[206:209]
    v_cvt_pk_bf16_f32 v232, v232, v232
    v_cvt_pk_bf16_f32 v233, v233, v233
    v_mfma_f32_16x16x32_bf16 v[206:209], v[194:197], a[212:215], v[206:209]
    s_waitcnt lgkmcnt(6)
    ds_write_b32 v130, v134 offset:512
    v_mfma_f32_16x16x32_bf16 v[134:137], a[72:75], v[190:193], 0
    s_waitcnt lgkmcnt(6)
    v_cvt_pk_bf16_f32 v248, v170, v171
    v_cvt_pk_bf16_f32 v249, v172, v173
    v_mfma_f32_16x16x32_bf16 v[134:137], a[76:79], v[198:201], v[134:137]
    s_waitcnt lgkmcnt(5)
    ds_write2_b32 v188, v230, v231 offset0:32 offset1:100
    v_mfma_f32_16x16x32_bf16 v[134:137], a[80:83], v[242:245], v[134:137]
    s_waitcnt lgkmcnt(4)
    v_fma_f32 v189, v166, v166, s32
    v_fmac_f32 v189, v167, v167
    v_mfma_f32_16x16x32_bf16 v[134:137], a[84:87], v[146:149], v[134:137]
    s_waitcnt lgkmcnt(3)
    ds_write2_b32 v188, v232, v233 offset0:168 offset1:236
    v_mfma_f32_16x16x32_bf16 v[134:137], a[88:91], v[158:161], v[134:137]
    v_fmac_f32 v189, v168, v168
    v_fmac_f32 v189, v169, v169
    v_mfma_f32_16x16x32_bf16 v[134:137], a[92:95], v[150:153], v[134:137]
    v_fmac_f32 v189, v118, v118
    v_fmac_f32 v189, v119, v119
    v_mfma_f32_16x16x32_bf16 v[170:173], a[96:99], v[190:193], 0
    v_fmac_f32 v189, v120, v120
    v_fmac_f32 v189, v121, v121
    v_mfma_f32_16x16x32_bf16 v[170:173], a[100:103], v[198:201], v[170:173]
    v_fmac_f32 v189, v162, v162
    v_fmac_f32 v189, v163, v163
    v_mfma_f32_16x16x32_bf16 v[170:173], a[104:107], v[242:245], v[170:173]
    v_fmac_f32 v189, v164, v164
    v_fmac_f32 v189, v165, v165
    v_mfma_f32_16x16x32_bf16 v[170:173], a[108:111], v[146:149], v[170:173]
    v_fma_f32 v188, v226, v226, s32
    v_fmac_f32 v188, v227, v227
    v_mfma_f32_16x16x32_bf16 v[170:173], a[112:115], v[158:161], v[170:173]
    v_fmac_f32 v188, v228, v228
    v_fmac_f32 v188, v229, v229
    v_mfma_f32_16x16x32_bf16 v[170:173], a[116:119], v[150:153], v[170:173]
    v_fmac_f32 v188, v138, v138
    v_fmac_f32 v188, v139, v139
    v_mfma_f32_16x16x32_bf16 v[154:157], a[120:123], v[190:193], 0
    v_fmac_f32 v188, v140, v140
    v_fmac_f32 v188, v141, v141
    v_mfma_f32_16x16x32_bf16 v[154:157], a[124:127], v[198:201], v[154:157]
    v_fmac_f32 v188, v250, v250
    v_fmac_f32 v188, v251, v251
    v_mfma_f32_16x16x32_bf16 v[154:157], a[128:131], v[242:245], v[154:157]
    v_fmac_f32 v188, v252, v252
    v_fmac_f32 v188, v253, v253
    v_mfma_f32_16x16x32_bf16 v[154:157], a[132:135], v[146:149], v[154:157]
    v_cvt_pk_bf16_f32 v36, v189, v188
    v_cvt_pk_bf16_f32 v180, v174, v175
    v_mfma_f32_16x16x32_bf16 v[154:157], a[136:139], v[158:161], v[154:157]
    v_cvt_pk_bf16_f32 v181, v176, v177
    v_cvt_pk_bf16_f32 v188, v206, v207
    v_mfma_f32_16x16x32_bf16 v[174:177], v[32:35], v[36:39], 0
    v_cvt_pk_bf16_f32 v189, v208, v209
    v_fma_f32 v142, v134, v134, s32
    v_mfma_f32_16x16x32_bf16 v[154:157], a[140:143], v[150:153], v[154:157]
    v_fmac_f32 v142, v135, v135
    v_fmac_f32 v142, v136, v136
    v_mfma_f32_16x16x32_bf16 v[194:197], a[0:3], v[190:193], 0
    v_fmac_f32 v142, v137, v137
    v_fmac_f32 v142, v170, v170
    v_mfma_f32_16x16x32_bf16 v[194:197], a[4:7], v[198:201], v[194:197]
    v_rsq_f32 v175, v175
    v_mfma_f32_16x16x32_bf16 v[194:197], a[8:11], v[242:245], v[194:197]
    v_rsq_f32 v174, v174
    v_mfma_f32_16x16x32_bf16 v[194:197], a[12:15], v[146:149], v[194:197]
    v_mul_f32 v174, s31, v174
    v_mul_f32 v226, v175, v226
    v_mfma_f32_16x16x32_bf16 v[194:197], a[16:19], v[158:161], v[194:197]
    v_mul_f32 v227, v175, v227
    v_cvt_pk_f16_f32 v226, v226, v227
    v_mfma_f32_16x16x32_bf16 v[194:197], a[20:23], v[150:153], v[194:197]
    v_mul_f32 v228, v175, v228
    v_mul_f32 v229, v175, v229
    v_mfma_f32_16x16x32_bf16 v[210:213], a[24:27], v[190:193], 0
    v_cvt_pk_f16_f32 v227, v228, v229
    v_mul_f32 v138, v175, v138
    v_mfma_f32_16x16x32_bf16 v[210:213], a[28:31], v[198:201], v[210:213]
    v_mul_f32 v139, v175, v139
    v_cvt_pk_f16_f32 v228, v138, v139
    v_mfma_f32_16x16x32_bf16 v[210:213], a[32:35], v[242:245], v[210:213]
    v_mul_f32 v140, v175, v140
    v_mul_f32 v141, v175, v141
    v_mfma_f32_16x16x32_bf16 v[210:213], a[36:39], v[146:149], v[210:213]
    v_cvt_pk_f16_f32 v229, v140, v141
    v_mul_f32 v250, v175, v250
    v_mfma_f32_16x16x32_bf16 v[210:213], a[40:43], v[158:161], v[210:213]
    v_mul_f32 v251, v175, v251
    v_cvt_pk_f16_f32 v216, v250, v251
    v_mfma_f32_16x16x32_bf16 v[210:213], a[44:47], v[150:153], v[210:213]
    v_mul_f32 v252, v175, v252
    v_mul_f32 v253, v175, v253
    v_mfma_f32_16x16x32_bf16 v[138:141], a[48:51], v[190:193], 0
    v_cvt_pk_f16_f32 v217, v252, v253
    v_mul_f32 v166, v174, v166
    v_mfma_f32_16x16x32_bf16 v[138:141], a[52:55], v[198:201], v[138:141]
    ds_read_b128 v[230:233], v5 offset:0
    ds_read_b128 v[206:209], v5 offset:16
    v_mfma_f32_16x16x32_bf16 v[138:141], a[56:59], v[242:245], v[138:141]
    ds_read_b128 v[250:253], v5 offset:48
    ds_read_b32 v143, v6 offset:192
    v_mfma_f32_16x16x32_bf16 v[138:141], a[60:63], v[146:149], v[138:141]
    v_mul_f32 v167, v174, v167
    v_cvt_pk_f16_f32 v166, v166, v167
    v_mfma_f32_16x16x32_bf16 v[138:141], a[64:67], v[158:161], v[138:141]
    v_mul_f32 v168, v174, v168
    v_mul_f32 v169, v174, v169
    v_mfma_f32_16x16x32_bf16 v[138:141], a[68:71], v[150:153], v[138:141]
    v_cvt_pk_f16_f32 v167, v168, v169
    v_mul_f32 v118, v174, v118
    v_mul_f32 v119, v174, v119
    v_cvt_pk_f16_f32 v168, v118, v119
    v_mul_f32 v120, v174, v120
    v_mul_f32 v121, v174, v121
    v_cvt_pk_f16_f32 v169, v120, v121
    v_mfma_f32_16x16x32_bf16 v[118:121], v[190:193], a[144:147], 0
    v_mul_f32 v162, v174, v162
    v_mul_f32 v163, v174, v163
    v_mfma_f32_16x16x32_bf16 v[118:121], v[198:201], a[148:151], v[118:121]
    s_waitcnt lgkmcnt(3)
    v_cvt_pk_f16_f32 v214, v162, v163
    v_mul_f32 v164, v174, v164
    v_mfma_f32_16x16x32_bf16 v[118:121], v[242:245], a[152:155], v[118:121]
    s_waitcnt lgkmcnt(1)
    v_mul_f32 v165, v174, v165
    v_cvt_pk_f16_f32 v215, v164, v165
    v_mfma_f32_16x16x32_bf16 v[118:121], v[146:149], a[156:159], v[118:121]
    s_waitcnt lgkmcnt(0)
    v_fma_f32 v254, v194, v194, s32
    v_fmac_f32 v254, v195, v195
    v_mfma_f32_16x16x32_bf16 v[118:121], v[158:161], a[160:163], v[118:121]
    v_fmac_f32 v254, v196, v196
    v_fmac_f32 v254, v197, v197
    v_mfma_f32_16x16x32_bf16 v[118:121], v[150:153], a[164:167], v[118:121]
    v_fmac_f32 v254, v210, v210
    v_fmac_f32 v254, v211, v211
    v_fmac_f32 v254, v212, v212
    v_fmac_f32 v254, v213, v213
    v_fmac_f32 v254, v138, v138
    v_fmac_f32 v254, v139, v139
    v_fmac_f32 v254, v140, v140
    v_fmac_f32 v254, v141, v141
    v_cvt_pk_bf16_f32 v238, v118, v119
    v_cvt_pk_bf16_f32 v239, v120, v121
    v_mfma_f32_16x16x32_f16 v[118:121], v[230:233], v[126:129], v[22:25]
    v_fmac_f32 v142, v171, v171
    v_fmac_f32 v142, v172, v172
    v_mfma_f32_16x16x32_f16 v[118:121], v[206:209], v[114:117], v[118:121]
    v_fmac_f32 v142, v173, v173
    v_fmac_f32 v142, v154, v154
    v_mfma_f32_16x16x32_f16 v[118:121], v[250:253], v[122:125], v[118:121]
    v_fmac_f32 v142, v155, v155
    v_fmac_f32 v142, v156, v156
    v_fmac_f32 v142, v157, v157
    v_cvt_pk_bf16_f32 v36, v254, v142
    v_mfma_f32_16x16x32_bf16 v[162:165], v[190:193], a[168:171], 0
    v_xor_b32 v0, 65536, v0
    v_xor_b32 v1, 65536, v1
    v_mfma_f32_16x16x32_bf16 v[162:165], v[198:201], a[172:175], v[162:165]
    v_mov_b32_dpp v143, v119 quad_perm:[0,1,2,3] row_mask:0x1 bank_mask:0xf
    v_add_u32 v5, 336, v5
    v_mfma_f32_16x16x32_bf16 v[162:165], v[242:245], a[176:179], v[162:165]
    v_xor_b32 v2, 65536, v2
    v_mfma_f32_16x16x32_bf16 v[162:165], v[146:149], a[180:183], v[162:165]
    v_mfma_f32_16x16x32_bf16 v[162:165], v[158:161], a[184:187], v[162:165]
    v_mfma_f32_16x16x32_bf16 v[162:165], v[150:153], a[188:191], v[162:165]
    s_nop 0
    s_nop 0
    s_nop 0
    s_nop 0
    s_nop 0
    s_nop 0
    s_nop 0
    s_nop 0
    v_cvt_pk_bf16_f32 v202, v162, v163
    v_cvt_pk_bf16_f32 v203, v164, v165
    v_mfma_f32_16x16x32_bf16 v[174:177], v[32:35], v[36:39], 0
    s_nop 0
    s_nop 0
    s_nop 0
    s_nop 0
    s_nop 0
    s_nop 0
    s_nop 0
    s_nop 0
    v_rsq_f32 v175, v175
    v_rsq_f32 v174, v174
    v_mul_f32 v134, v175, v134
    v_mul_f32 v174, s31, v174
    v_mul_f32 v135, v175, v135
    v_cvt_pk_f16_f32 v162, v134, v135
    v_mul_f32 v136, v175, v136
    v_mul_f32 v137, v175, v137
    v_cvt_pk_f16_f32 v163, v136, v137
    v_mul_f32 v170, v175, v170
    v_mul_f32 v171, v175, v171
    v_cvt_pk_f16_f32 v164, v170, v171
    v_mfma_f32_16x16x32_f16 v[234:237], v[230:233], v[166:169], v[24:27]
    v_mul_f32 v172, v175, v172
    v_mul_f32 v173, v175, v173
    v_mfma_f32_16x16x32_f16 v[234:237], v[206:209], v[226:229], v[234:237]
    v_cvt_pk_f16_f32 v165, v172, v173
    v_mul_f32 v154, v175, v154
    v_mfma_f32_16x16x32_f16 v[234:237], v[250:253], v[214:217], v[234:237]
    v_mul_f32 v155, v175, v155
    v_cvt_pk_f16_f32 v172, v154, v155
    v_mfma_f32_16x16x32_bf16 v[134:137], v[190:193], a[192:195], 0
    v_mul_f32 v156, v175, v156
    v_mul_f32 v157, v175, v157
    v_mfma_f32_16x16x32_bf16 v[134:137], v[198:201], a[196:199], v[134:137]
    v_cvt_pk_f16_f32 v173, v156, v157
    v_mul_f32 v194, v174, v194
    v_mfma_f32_16x16x32_bf16 v[134:137], v[242:245], a[200:203], v[134:137]
    v_mul_f32 v195, v174, v195
    v_cvt_pk_f16_f32 v154, v194, v195
    v_mfma_f32_16x16x32_bf16 v[134:137], v[146:149], a[204:207], v[134:137]
    v_mul_f32 v196, v174, v196
    v_mul_f32 v197, v174, v197
    v_mfma_f32_16x16x32_bf16 v[134:137], v[158:161], a[208:211], v[134:137]
    v_cvt_pk_f16_f32 v155, v196, v197
    v_mul_f32 v210, v174, v210
    v_mfma_f32_16x16x32_bf16 v[134:137], v[150:153], a[212:215], v[134:137]
    s_waitcnt vmcnt(0)
    ds_read2_b32 v[240:241], v6 offset0:0 offset1:0
    ds_read2_b32 v[204:205], v6 offset0:16 offset1:16
    v_mfma_f32_16x16x32_f16 v[150:153], v[114:117], v[126:129], v[46:49]
    s_barrier
    buffer_load_dwordx4 v10, s[8:11], 0 offen nt lds
    ds_read2_b32 v[160:161], v6 offset0:32 offset1:32
    v_mfma_f32_16x16x32_f16 v[146:149], v[226:229], v[126:129], v[50:53]
    s_add_u32 m0, s28, 4096
    v_cvt_pk_bf16_f32 v158, v134, v135
    v_cvt_pk_bf16_f32 v159, v136, v137
    v_mfma_f32_16x16x32_f16 v[134:137], v[162:165], v[126:129], v[54:57]
    v_mul_f32 v211, v174, v211
    v_cvt_pk_f16_f32 v156, v210, v211
    v_mul_f32 v212, v174, v212
    v_mfma_f32_16x16x16_f16 v[150:153], v[124:125], v[122:123], v[150:153]
    v_mul_f32 v213, v174, v213
    v_cvt_pk_f16_f32 v157, v212, v213
    v_mul_f32 v138, v174, v138
    v_mfma_f32_16x16x16_f16 v[146:149], v[216:217], v[122:123], v[146:149]
    v_mul_f32 v139, v174, v139
    v_cvt_pk_f16_f32 v170, v138, v139
    v_mul_f32 v140, v174, v140
    v_mfma_f32_16x16x16_f16 v[134:137], v[172:173], v[122:123], v[134:137]
    v_mul_f32 v141, v174, v141
    v_cvt_pk_f16_f32 v171, v140, v141
    v_mov_b32_dpp v143, v235 quad_perm:[0,1,2,3] row_mask:0x2 bank_mask:0xf
    v_max3_f32 v142, v118, v150, v151
    v_mfma_f32_16x16x32_f16 v[138:141], v[230:233], v[154:157], v[26:29]
    s_waitcnt lgkmcnt(1)
    buffer_load_dwordx4 v11, s[8:11], 0 offen nt lds
    v_max3_f32 v142, v142, v152, v153
    v_mfma_f32_16x16x32_f16 v[138:141], v[206:209], v[162:165], v[138:141]
    s_add_u32 m0, s28, 8192
    v_max3_f32 v142, v142, v146, v147
    v_max3_f32 v142, v142, v148, v149
    v_mfma_f32_16x16x32_f16 v[138:141], v[250:253], v[170:173], v[138:141]
    s_waitcnt lgkmcnt(0)
    v_max3_f32 v142, v142, v134, v135
    v_max3_f32 v142, v142, v136, v137
    v_mov_b32 v122, v142
    v_mfma_f32_16x16x16_bf16 v[126:129], a[216:217], v[144:145], v[218:221]
    v_add_u32 v6, 272, v6
    v_permlane32_swap_b32 v142, v122
    v_mfma_f32_16x16x16_bf16 v[210:213], a[240:241], v[144:145], v[218:221]
    v_max_f32 v142, v142, v122
    v_mov_b32 v122, v142
    v_mov_b32_dpp v143, v139 quad_perm:[0,1,2,3] row_mask:0x4 bank_mask:0xf
    v_mfma_f32_16x16x16_bf16 v[198:201], v[90:91], v[144:145], v[218:221]
    v_permlane16_swap_b32 v142, v122
    v_max_f32 v142, v142, v122
    v_mfma_f32_16x16x16_bf16 v[190:193], a[218:219], v[144:145], v[182:185]
    v_sub_f32 v150, v150, v142
    v_exp_f32 v150, v150
    v_mfma_f32_16x16x16_bf16 v[174:177], a[242:243], v[144:145], v[182:185]
    v_sub_f32 v151, v151, v142
    v_exp_f32 v151, v151
    v_mfma_f32_16x16x16_bf16 v[218:221], v[92:93], v[144:145], v[182:185]
    buffer_load_dwordx4 v12, s[8:11], 0 offen nt lds
    s_add_u32 m0, s28, 12288
    s_xor_b32 s28, s28, 65536
    v_cvt_pk_bf16_f32 v150, v150, v151
    v_sub_f32 v152, v152, v142
    v_exp_f32 v152, v152
    v_sub_f32 v153, v153, v142
    v_exp_f32 v153, v153
    v_sub_f32 v146, v146, v142
    v_cvt_pk_bf16_f32 v151, v152, v153
    v_exp_f32 v146, v146
    v_mfma_f32_16x16x32_f16 v[182:185], v[114:117], v[166:169], v[58:61]
    buffer_load_dwordx4 v13, s[8:11], 0 offen nt lds
    s_mov_b32 m0, s29
    s_xor_b32 s29, s29, s30
    v_sub_f32 v147, v147, v142
    v_exp_f32 v147, v147
    v_sub_f32 v148, v148, v142
    v_mfma_f32_16x16x16_f16 v[182:185], v[124:125], v[214:215], v[182:185]
    v_cvt_pk_bf16_f32 v152, v146, v147
    v_exp_f32 v148, v148
    v_sub_f32 v149, v149, v142
    v_exp_f32 v149, v149
    v_sub_f32 v134, v134, v142
    v_cvt_pk_bf16_f32 v153, v148, v149
    buffer_load_dwordx4 v14, s[8:11], 0 offen nt lds
    v_exp_f32 v134, v134
    v_mfma_f32_16x16x32_f16 v[146:149], v[226:229], v[166:169], v[62:65]
    v_sub_f32 v135, v135, v142
    v_exp_f32 v135, v135
    v_sub_f32 v136, v136, v142
    v_cvt_pk_bf16_f32 v36, v134, v135
    v_exp_f32 v136, v136
    v_sub_f32 v137, v137, v142
    v_mfma_f32_16x16x16_f16 v[146:149], v[216:217], v[214:215], v[146:149]
    v_exp_f32 v137, v137
    v_sub_f32 v118, v118, v142
    v_cvt_pk_bf16_f32 v37, v136, v137
    v_mfma_f32_16x16x32_f16 v[134:137], v[162:165], v[166:169], v[66:69]
    v_exp_f32 v118, v118
    v_max3_f32 v142, v234, v182, v183
    v_cvt_pk_bf16_f32 v39, v118, 0
    v_max3_f32 v142, v142, v184, v185
    v_max3_f32 v142, v142, v146, v147
    v_mfma_f32_16x16x32_bf16 v[118:121], v[28:31], v[36:39], 0
    v_max3_f32 v142, v142, v148, v149
    v_cvt_pk_bf16_f32 v126, v126, v127
    v_mfma_f32_16x16x32_bf16 v[118:121], v[28:31], v[150:153], v[118:121]
    v_accvgpr_write_b32 a216, v126
    v_cvt_pk_bf16_f32 v128, v128, v129
    v_mfma_f32_16x16x32_bf16 v[166:169], v[238:241], v[36:39], 0
    v_accvgpr_write_b32 a217, v128
    v_cvt_pk_bf16_f32 v210, v210, v211
    v_mfma_f32_16x16x32_bf16 v[166:169], v[246:249], v[150:153], v[166:169]
    v_accvgpr_write_b32 a240, v210
    v_cvt_pk_bf16_f32 v212, v212, v213
    v_mfma_f32_16x16x32_bf16 v[126:129], v[202:205], v[36:39], 0
    v_rcp_f32 v118, v118
    v_mfma_f32_16x16x32_bf16 v[126:129], v[178:181], v[150:153], v[126:129]
    v_accvgpr_write_b32 a241, v212
    v_cvt_pk_bf16_f32 v90, v198, v199
    v_mfma_f32_16x16x32_bf16 v[210:213], v[158:161], v[36:39], 0
    v_mul_f32 v166, v118, v166
    v_mul_f32 v167, v118, v167
    v_mfma_f32_16x16x32_bf16 v[210:213], v[186:189], v[150:153], v[210:213]
    v_cvt_pk_bf16_f32 v166, v166, v167
    v_mul_f32 v168, v118, v168
    v_mul_f32 v169, v118, v169
    v_mfma_f32_16x16x16_f16 v[134:137], v[172:173], v[214:215], v[134:137]
    v_cvt_pk_bf16_f32 v167, v168, v169
    v_mul_f32 v126, v118, v126
    v_mul_f32 v127, v118, v127
    v_cvt_pk_bf16_f32 v168, v126, v127
    v_mul_f32 v128, v118, v128
    v_mul_f32 v129, v118, v129
    v_cvt_pk_bf16_f32 v169, v128, v129
    ds_write_b128 v3, v[166:169] offset:0
    v_mul_f32 v210, v118, v210
    v_mul_f32 v211, v118, v211
    v_cvt_pk_bf16_f32 v122, v210, v211
    v_mul_f32 v212, v118, v212
    v_mul_f32 v213, v118, v213
    v_cvt_pk_bf16_f32 v123, v212, v213
    v_max3_f32 v142, v142, v134, v135
    ds_write_b64 v4, v[122:123] offset:4096
    v_max3_f32 v142, v142, v136, v137
    v_mov_b32 v122, v142
    v_cvt_pk_bf16_f32 v91, v200, v201
    ds_read_b128 v[118:121], v133 offset:128
    v_permlane32_swap_b32 v142, v122
    v_max_f32 v142, v142, v122
    v_mov_b32 v122, v142
    v_cvt_pk_bf16_f32 v190, v190, v191
    v_accvgpr_write_b32 a218, v190
    v_permlane16_swap_b32 v142, v122
    v_max_f32 v142, v142, v122
    v_sub_f32 v182, v182, v142
    v_exp_f32 v182, v182
    v_sub_f32 v183, v183, v142
    v_exp_f32 v183, v183
    v_sub_f32 v184, v184, v142
    v_cvt_pk_bf16_f32 v126, v182, v183
    v_exp_f32 v184, v184
    v_sub_f32 v185, v185, v142
    v_exp_f32 v185, v185
    v_sub_f32 v146, v146, v142
    v_cvt_pk_bf16_f32 v127, v184, v185
    v_exp_f32 v146, v146
    v_sub_f32 v147, v147, v142
    s_waitcnt lgkmcnt(0)
    v_mfma_f32_16x16x16_bf16 v[210:213], a[232:233], v[144:145], v[118:121]
    v_exp_f32 v147, v147
    v_sub_f32 v148, v148, v142
    v_mfma_f32_16x16x16_bf16 v[150:153], v[82:83], v[144:145], v[118:121]
    v_cvt_pk_bf16_f32 v128, v146, v147
    v_exp_f32 v148, v148
    v_mfma_f32_16x16x16_bf16 v[166:169], v[106:107], v[144:145], v[118:121]
    v_sub_f32 v149, v149, v142
    v_exp_f32 v149, v149
    v_sub_f32 v134, v134, v142
    v_cvt_pk_bf16_f32 v129, v148, v149
    v_exp_f32 v134, v134
    v_sub_f32 v135, v135, v142
    v_exp_f32 v135, v135
    v_sub_f32 v136, v136, v142
    v_cvt_pk_bf16_f32 v36, v134, v135
    v_exp_f32 v136, v136
    v_sub_f32 v137, v137, v142
    v_exp_f32 v137, v137
    v_mfma_f32_16x16x32_f16 v[198:201], v[114:117], v[154:157], v[70:73]
    v_cvt_pk_bf16_f32 v37, v136, v137
    v_sub_f32 v234, v234, v142
    v_mfma_f32_16x16x32_f16 v[134:137], v[226:229], v[154:157], v[74:77]
    v_exp_f32 v234, v234
    v_mfma_f32_16x16x32_f16 v[118:121], v[162:165], v[154:157], v[78:81]
    v_cvt_pk_bf16_f32 v39, v234, 0
    v_cvt_pk_bf16_f32 v192, v192, v193
    v_accvgpr_write_b32 a219, v192
    v_mfma_f32_16x16x32_bf16 v[146:149], v[28:31], v[36:39], 0
    v_cvt_pk_bf16_f32 v174, v174, v175
    v_accvgpr_write_b32 a242, v174
    v_mfma_f32_16x16x32_bf16 v[146:149], v[28:31], v[126:129], v[146:149]
    v_cvt_pk_bf16_f32 v176, v176, v177
    v_accvgpr_write_b32 a243, v176
    v_mfma_f32_16x16x32_bf16 v[182:185], v[238:241], v[36:39], 0
    v_cvt_pk_bf16_f32 v92, v218, v219
    v_cvt_pk_bf16_f32 v93, v220, v221
    v_mfma_f32_16x16x32_bf16 v[182:185], v[246:249], v[126:129], v[182:185]
    ds_read_b128 v[114:117], v133 offset:192
    v_cvt_pk_bf16_f32 v210, v210, v211
    v_mfma_f32_16x16x32_bf16 v[194:197], v[202:205], v[36:39], 0
    v_accvgpr_write_b32 a232, v210
    v_cvt_pk_bf16_f32 v212, v212, v213
    v_mfma_f32_16x16x32_bf16 v[194:197], v[178:181], v[126:129], v[194:197]
    v_accvgpr_write_b32 a233, v212
    v_cvt_pk_bf16_f32 v82, v150, v151
    v_mfma_f32_16x16x32_bf16 v[190:193], v[158:161], v[36:39], 0
    v_cvt_pk_bf16_f32 v83, v152, v153
    v_cvt_pk_bf16_f32 v106, v166, v167
    v_mfma_f32_16x16x32_bf16 v[190:193], v[186:189], v[126:129], v[190:193]
    v_cvt_pk_bf16_f32 v107, v168, v169
    v_rcp_f32 v146, v146
    v_mfma_f32_16x16x16_f16 v[198:201], v[124:125], v[170:171], v[198:201]
    v_mov_b32 v142, v143
    v_mul_f32 v182, v146, v182
    v_mul_f32 v183, v146, v183
    v_mfma_f32_16x16x16_f16 v[134:137], v[216:217], v[170:171], v[134:137]
    v_max_f32_dpp v142, v142, v142 quad_perm:[1,0,3,2] row_mask:0xf bank_mask:0xf
    v_cvt_pk_bf16_f32 v130, v182, v183
    v_mul_f32 v184, v146, v184
    v_mfma_f32_16x16x16_f16 v[118:121], v[172:173], v[170:171], v[118:121]
    s_waitcnt lgkmcnt(0)
    ds_read_b128 v[126:129], v133 offset:256
    v_max3_f32 v132, v138, v198, v199
    v_mfma_f32_16x16x16_bf16 v[170:173], a[220:221], v[144:145], v[114:117]
    v_max3_f32 v132, v132, v200, v201
    v_max3_f32 v132, v132, v134, v135
    v_max3_f32 v132, v132, v136, v137
    v_mfma_f32_16x16x16_bf16 v[122:125], a[244:245], v[144:145], v[114:117]
    v_max3_f32 v132, v132, v118, v119
    v_max3_f32 v132, v132, v120, v121
    v_mov_b32 v131, v132
    v_mfma_f32_16x16x16_bf16 v[162:165], v[94:95], v[144:145], v[114:117]
    v_cvt_pk_bf16_f32 v170, v170, v171
    v_accvgpr_write_b32 a220, v170
    v_cvt_pk_bf16_f32 v172, v172, v173
    v_accvgpr_write_b32 a221, v172
    v_cvt_pk_bf16_f32 v122, v122, v123
    v_accvgpr_write_b32 a244, v122
    v_cvt_pk_bf16_f32 v124, v124, v125
    v_accvgpr_write_b32 a245, v124
    v_cvt_pk_bf16_f32 v94, v162, v163
    v_cvt_pk_bf16_f32 v95, v164, v165
    ds_read_b128 v[122:125], v133 offset:320
    v_permlane32_swap_b32 v132, v131
    v_max_f32 v132, v132, v131
    v_mov_b32 v131, v132
    s_waitcnt lgkmcnt(1)
    v_mfma_f32_16x16x16_bf16 v[114:117], a[222:223], v[144:145], v[126:129]
    v_permlane16_swap_b32 v132, v131
    v_max_f32 v132, v132, v131
    v_mfma_f32_16x16x16_bf16 v[162:165], a[246:247], v[144:145], v[126:129]
    v_sub_f32 v198, v198, v132
    v_exp_f32 v198, v198
    v_mfma_f32_16x16x16_bf16 v[170:173], v[96:97], v[144:145], v[126:129]
    v_sub_f32 v199, v199, v132
    v_exp_f32 v199, v199
    v_cvt_pk_bf16_f32 v114, v114, v115
    v_accvgpr_write_b32 a222, v114
    v_cvt_pk_bf16_f32 v116, v116, v117
    v_accvgpr_write_b32 a223, v116
    v_cvt_pk_bf16_f32 v162, v162, v163
    v_accvgpr_write_b32 a246, v162
    v_cvt_pk_bf16_f32 v164, v164, v165
    v_accvgpr_write_b32 a247, v164
    v_cvt_pk_bf16_f32 v96, v170, v171
    v_cvt_pk_bf16_f32 v97, v172, v173
    s_waitcnt lgkmcnt(0)
    v_mfma_f32_16x16x16_bf16 v[114:117], a[234:235], v[144:145], v[122:125]
    ds_read_b128 v[174:177], v133 offset:384
    v_cvt_pk_bf16_f32 v154, v198, v199
    v_sub_f32 v200, v200, v132
    v_mfma_f32_16x16x16_bf16 v[150:153], v[84:85], v[144:145], v[122:125]
    v_exp_f32 v200, v200
    v_sub_f32 v201, v201, v132
    v_mfma_f32_16x16x16_bf16 v[126:129], v[108:109], v[144:145], v[122:125]
    ds_read_b128 v[170:173], v0 offset:20480
    ds_read_b128 v[166:169], v1 offset:20480
    ds_read_b128 v[162:165], v0 offset:20608
    ds_read_b128 v[210:213], v1 offset:20608
    ds_read_b128 v[226:229], v0 offset:20736
    ds_read_b128 v[218:221], v1 offset:20736
    v_cvt_pk_bf16_f32 v114, v114, v115
    v_accvgpr_write_b32 a234, v114
    v_cvt_pk_bf16_f32 v116, v116, v117
    v_accvgpr_write_b32 a235, v116
    v_cvt_pk_bf16_f32 v84, v150, v151
    s_waitcnt lgkmcnt(6)
    v_mfma_f32_16x16x16_bf16 v[122:125], a[224:225], v[144:145], v[174:177]
    v_cvt_pk_bf16_f32 v85, v152, v153
    v_cvt_pk_bf16_f32 v108, v126, v127
    v_cvt_pk_bf16_f32 v109, v128, v129
    v_mfma_f32_16x16x16_bf16 v[150:153], a[248:249], v[144:145], v[174:177]
    v_exp_f32 v201, v201
    v_sub_f32 v134, v134, v132
    v_mfma_f32_16x16x16_bf16 v[126:129], v[98:99], v[144:145], v[174:177]
    s_waitcnt lgkmcnt(4)
    ds_read_b128 v[230:233], v133 offset:448
    v_cvt_pk_bf16_f32 v122, v122, v123
    v_accvgpr_write_b32 a224, v122
    v_mfma_f32_16x16x32_bf16 v[114:117], a[72:75], v[170:173], 0
    s_waitcnt lgkmcnt(3)
    v_cvt_pk_bf16_f32 v124, v124, v125
    v_accvgpr_write_b32 a225, v124
    v_mfma_f32_16x16x32_bf16 v[114:117], a[76:79], v[166:169], v[114:117]
    s_waitcnt lgkmcnt(2)
    v_cvt_pk_bf16_f32 v150, v150, v151
    v_accvgpr_write_b32 a248, v150
    v_mfma_f32_16x16x32_bf16 v[114:117], a[80:83], v[162:165], v[114:117]
    s_waitcnt lgkmcnt(1)
    v_cvt_pk_bf16_f32 v152, v152, v153
    v_accvgpr_write_b32 a249, v152
    v_mfma_f32_16x16x32_bf16 v[114:117], a[84:87], v[210:213], v[114:117]
    v_cvt_pk_bf16_f32 v98, v126, v127
    v_cvt_pk_bf16_f32 v99, v128, v129
    v_mfma_f32_16x16x32_bf16 v[114:117], a[88:91], v[226:229], v[114:117]
    ds_read_b128 v[126:129], v133 offset:512
    v_cvt_pk_bf16_f32 v155, v200, v201
    v_mfma_f32_16x16x32_bf16 v[114:117], a[92:95], v[218:221], v[114:117]
    v_exp_f32 v134, v134
    v_mfma_f32_16x16x32_bf16 v[122:125], a[96:99], v[170:173], 0
    s_waitcnt lgkmcnt(1)
    v_sub_f32 v135, v135, v132
    v_exp_f32 v135, v135
    v_mfma_f32_16x16x16_bf16 v[150:153], a[226:227], v[144:145], v[230:233]
    v_cvt_pk_bf16_f32 v156, v134, v135
    v_sub_f32 v136, v136, v132
    v_sub_f32 v137, v137, v132
    v_mfma_f32_16x16x16_bf16 v[174:177], a[250:251], v[144:145], v[230:233]
    v_exp_f32 v136, v136
    v_sub_f32 v118, v118, v132
    v_mfma_f32_16x16x16_bf16 v[198:201], v[100:101], v[144:145], v[230:233]
    v_exp_f32 v137, v137
    v_cvt_pk_bf16_f32 v150, v150, v151
    v_accvgpr_write_b32 a226, v150
    v_mfma_f32_16x16x32_bf16 v[122:125], a[100:103], v[166:169], v[122:125]
    v_cvt_pk_bf16_f32 v152, v152, v153
    v_accvgpr_write_b32 a227, v152
    v_mfma_f32_16x16x32_bf16 v[122:125], a[104:107], v[162:165], v[122:125]
    s_waitcnt lgkmcnt(0)
    v_cvt_pk_bf16_f32 v174, v174, v175
    v_accvgpr_write_b32 a250, v174
    v_cvt_pk_bf16_f32 v176, v176, v177
    v_mfma_f32_16x16x16_bf16 v[150:153], a[236:237], v[144:145], v[126:129]
    v_accvgpr_write_b32 a251, v176
    v_cvt_pk_bf16_f32 v100, v198, v199
    v_cvt_pk_bf16_f32 v101, v200, v201
    v_mfma_f32_16x16x16_bf16 v[174:177], v[86:87], v[144:145], v[126:129]
    v_cvt_pk_bf16_f32 v157, v136, v137
    v_exp_f32 v118, v118
    v_mfma_f32_16x16x16_bf16 v[198:201], v[110:111], v[144:145], v[126:129]
    v_sub_f32 v119, v119, v132
    v_cvt_pk_bf16_f32 v150, v150, v151
    v_accvgpr_write_b32 a236, v150
    v_cvt_pk_bf16_f32 v152, v152, v153
    v_mfma_f32_16x16x32_bf16 v[122:125], a[108:111], v[210:213], v[122:125]
    ds_read_b128 v[134:137], v133 offset:576
    v_accvgpr_write_b32 a237, v152
    v_mfma_f32_16x16x32_bf16 v[122:125], a[112:115], v[226:229], v[122:125]
    v_cvt_pk_bf16_f32 v86, v174, v175
    v_cvt_pk_bf16_f32 v87, v176, v177
    v_mfma_f32_16x16x32_bf16 v[122:125], a[116:119], v[218:221], v[122:125]
    v_cvt_pk_bf16_f32 v110, v198, v199
    v_cvt_pk_bf16_f32 v111, v200, v201
    v_mfma_f32_16x16x32_bf16 v[126:129], a[120:123], v[170:173], 0
    ds_read_b128 v[150:153], v133 offset:640
    v_sub_f32 v120, v120, v132
    v_mfma_f32_16x16x32_bf16 v[126:129], a[124:127], v[166:169], v[126:129]
    v_exp_f32 v119, v119
    v_mfma_f32_16x16x32_bf16 v[126:129], a[128:131], v[162:165], v[126:129]
    v_cvt_pk_bf16_f32 v36, v118, v119
    v_sub_f32 v121, v121, v132
    v_mfma_f32_16x16x32_bf16 v[126:129], a[132:135], v[210:213], v[126:129]
    v_exp_f32 v120, v120
    v_mfma_f32_16x16x32_bf16 v[126:129], a[136:139], v[226:229], v[126:129]
    v_exp_f32 v121, v121
    v_mfma_f32_16x16x32_bf16 v[126:129], a[140:143], v[218:221], v[126:129]
    s_waitcnt lgkmcnt(1)
    v_cvt_pk_bf16_f32 v37, v120, v121
    v_sub_f32 v138, v138, v132
    v_max_f32_dpp v142, v142, v142 quad_perm:[2,3,0,1] row_mask:0xf bank_mask:0xf
    v_mfma_f32_16x16x16_bf16 v[118:121], a[228:229], v[144:145], v[134:137]
    v_exp_f32 v138, v138
    v_max_f32_dpp v142, v142, v142 row_half_mirror row_mask:0xf bank_mask:0xf
    v_mfma_f32_16x16x16_bf16 v[174:177], a[252:253], v[144:145], v[134:137]
    v_cvt_pk_bf16_f32 v39, v138, 0
    v_max_f32_dpp v142, v142, v142 row_mirror row_mask:0xf bank_mask:0xf
    v_mov_b32 v254, v142
    v_mul_f32 v185, v146, v185
    v_mfma_f32_16x16x32_bf16 v[198:201], v[28:31], v[36:39], 0
    s_waitcnt lgkmcnt(0)
    v_cvt_pk_bf16_f32 v118, v118, v119
    v_accvgpr_write_b32 a228, v118
    v_mfma_f32_16x16x32_bf16 v[198:201], v[28:31], v[154:157], v[198:201]
    v_cvt_pk_bf16_f32 v120, v120, v121
    v_accvgpr_write_b32 a229, v120
    v_mfma_f32_16x16x32_bf16 v[138:141], v[238:241], v[36:39], 0
    v_cvt_pk_bf16_f32 v174, v174, v175
    v_accvgpr_write_b32 a252, v174
    v_mfma_f32_16x16x32_bf16 v[138:141], v[246:249], v[154:157], v[138:141]
    v_cvt_pk_bf16_f32 v176, v176, v177
    v_accvgpr_write_b32 a253, v176
    v_mfma_f32_16x16x32_bf16 v[118:121], v[202:205], v[36:39], 0
    v_rcp_f32 v198, v198
    v_mfma_f32_16x16x32_bf16 v[118:121], v[178:181], v[154:157], v[118:121]
    v_permlane32_swap_b32 v142, v254
    v_mfma_f32_16x16x32_bf16 v[174:177], v[158:161], v[36:39], 0
    v_max_f32 v142, v142, v254
    v_mul_f32 v138, v198, v138
    v_mfma_f32_16x16x32_bf16 v[174:177], v[186:189], v[154:157], v[174:177]
    v_mul_f32 v139, v198, v139
    v_cvt_pk_bf16_f32 v230, v138, v139
    v_mul_f32 v140, v198, v140
    v_mfma_f32_16x16x16_bf16 v[206:209], v[102:103], v[144:145], v[134:137]
    v_mul_f32 v141, v198, v141
    v_cvt_pk_bf16_f32 v231, v140, v141
    v_mul_f32 v118, v198, v118
    v_mfma_f32_16x16x16_bf16 v[138:141], a[230:231], v[144:145], v[150:153]
    v_mul_f32 v119, v198, v119
    v_cvt_pk_bf16_f32 v232, v118, v119
    v_mul_f32 v120, v198, v120
    v_mfma_f32_16x16x16_bf16 v[134:137], a[254:255], v[144:145], v[150:153]
    v_mul_f32 v121, v198, v121
    v_cvt_pk_bf16_f32 v233, v120, v121
    v_mul_f32 v174, v198, v174
    v_mfma_f32_16x16x16_bf16 v[118:121], v[104:105], v[144:145], v[150:153]
    v_mul_f32 v175, v198, v175
    v_cvt_pk_bf16_f32 v182, v174, v175
    v_mul_f32 v176, v198, v176
    v_mul_f32 v177, v198, v177
    v_mfma_f32_16x16x32_bf16 v[154:157], a[0:3], v[170:173], 0
    ds_write_b128 v3, v[230:233] offset:12288
    v_mfma_f32_16x16x32_bf16 v[154:157], a[4:7], v[166:169], v[154:157]
    v_cvt_pk_bf16_f32 v183, v176, v177
    v_cvt_pk_bf16_f32 v102, v206, v207
    v_mfma_f32_16x16x32_bf16 v[154:157], a[8:11], v[162:165], v[154:157]
    v_cvt_pk_bf16_f32 v103, v208, v209
    v_cvt_pk_bf16_f32 v138, v138, v139
    v_mfma_f32_16x16x32_bf16 v[154:157], a[12:15], v[210:213], v[154:157]
    ds_read_b128 v[150:153], v133 offset:704
    v_accvgpr_write_b32 a230, v138
    v_mfma_f32_16x16x32_bf16 v[154:157], a[16:19], v[226:229], v[154:157]
    ds_write_b64 v4, v[182:183] offset:16384
    v_mfma_f32_16x16x32_bf16 v[154:157], a[20:23], v[218:221], v[154:157]
    v_cvt_pk_bf16_f32 v140, v140, v141
    v_accvgpr_write_b32 a231, v140
    v_mfma_f32_16x16x32_bf16 v[174:177], a[24:27], v[170:173], 0
    v_cvt_pk_bf16_f32 v134, v134, v135
    v_accvgpr_write_b32 a254, v134
    v_mfma_f32_16x16x32_bf16 v[174:177], a[28:31], v[166:169], v[174:177]
    v_cvt_pk_bf16_f32 v136, v136, v137
    v_accvgpr_write_b32 a255, v136
    v_mfma_f32_16x16x32_bf16 v[174:177], a[32:35], v[162:165], v[174:177]
    v_cvt_pk_bf16_f32 v104, v118, v119
    v_cvt_pk_bf16_f32 v105, v120, v121
    v_mfma_f32_16x16x32_bf16 v[174:177], a[36:39], v[210:213], v[174:177]
    v_mov_b32 v254, v142
    v_cvt_pk_bf16_f32 v131, v184, v185
    v_mfma_f32_16x16x32_bf16 v[174:177], a[40:43], v[226:229], v[174:177]
    s_waitcnt lgkmcnt(1)
    v_permlane16_swap_b32 v142, v254
    v_max_f32 v142, v142, v254
    v_mfma_f32_16x16x16_bf16 v[118:121], a[238:239], v[144:145], v[150:153]
    v_sub_f32 v143, v143, v142
    v_exp_f32 v143, v143
    v_mfma_f32_16x16x16_bf16 v[134:137], v[88:89], v[144:145], v[150:153]
    v_cvt_pk_bf16_f32 v143, v143, v143
    v_mul_f32 v194, v146, v194
    v_mul_f32 v195, v146, v195
    v_mfma_f32_16x16x16_bf16 v[138:141], v[112:113], v[144:145], v[150:153]
    v_cvt_pk_bf16_f32 v132, v194, v195
    v_cvt_pk_bf16_f32 v118, v118, v119
    v_accvgpr_write_b32 a238, v118
    v_cvt_pk_bf16_f32 v120, v120, v121
    v_mfma_f32_16x16x32_bf16 v[174:177], a[44:47], v[218:221], v[174:177]
    ds_write_b16 v8, v143
    v_mfma_f32_16x16x32_bf16 v[182:185], a[48:51], v[170:173], 0
    v_accvgpr_write_b32 a239, v120
    v_cvt_pk_bf16_f32 v88, v134, v135
    v_mfma_f32_16x16x32_bf16 v[182:185], a[52:55], v[166:169], v[182:185]
    ds_read_b128 v[142:145], v9
    ds_read_b128 v[118:121], v9 offset:64
    v_mfma_f32_16x16x32_bf16 v[182:185], a[56:59], v[162:165], v[182:185]
    v_cvt_pk_bf16_f32 v89, v136, v137
    v_cvt_pk_bf16_f32 v112, v138, v139
    v_mfma_f32_16x16x32_bf16 v[182:185], a[60:63], v[210:213], v[182:185]
    v_cvt_pk_bf16_f32 v113, v140, v141
    v_mul_f32 v196, v146, v196
    v_mfma_f32_16x16x32_bf16 v[182:185], a[64:67], v[226:229], v[182:185]
    v_mul_f32 v197, v146, v197
    v_cvt_pk_bf16_f32 v133, v196, v197
    v_mfma_f32_16x16x32_bf16 v[182:185], a[68:71], v[218:221], v[182:185]
    ds_write_b128 v3, v[130:133] offset:6144
    v_mfma_f32_16x16x32_bf16 v[230:233], v[170:173], a[144:147], 0
    v_mul_f32 v190, v146, v190
    v_mul_f32 v191, v146, v191
    v_mfma_f32_16x16x32_bf16 v[230:233], v[166:169], a[148:151], v[230:233]
    v_cvt_pk_bf16_f32 v254, v190, v191
    v_mul_f32 v192, v146, v192
    v_mfma_f32_16x16x32_bf16 v[230:233], v[162:165], a[152:155], v[230:233]
    s_waitcnt lgkmcnt(1)
    v_mul_f32 v193, v146, v193
    v_cvt_pk_bf16_f32 v255, v192, v193
    v_mfma_f32_16x16x32_bf16 v[134:137], v[142:145], v[28:31], 0
    ds_write_b64 v4, v[254:255] offset:10240
    v_mfma_f32_16x16x32_bf16 v[134:137], v[118:121], v[28:31], v[134:137]
    v_xor_b32 v3, 65536, v3
    v_xor_b32 v4, 65536, v4
    v_mfma_f32_16x16x32_bf16 v[138:141], v[142:145], v[246:249], 0
    v_mfma_f32_16x16x32_bf16 v[138:141], v[118:121], v[238:241], v[138:141]
    v_mfma_f32_16x16x32_bf16 v[130:133], v[142:145], v[178:181], 0
    v_mfma_f32_16x16x32_bf16 v[130:133], v[118:121], v[202:205], v[130:133]
    v_mfma_f32_16x16x32_bf16 v[178:181], v[142:145], v[186:189], 0
    v_mfma_f32_16x16x32_bf16 v[178:181], v[118:121], v[158:161], v[178:181]
    v_rcp_f32 v134, v134
    v_mfma_f32_16x16x32_bf16 v[230:233], v[210:213], a[156:159], v[230:233]
    v_mfma_f32_16x16x32_bf16 v[230:233], v[226:229], a[160:163], v[230:233]
    v_mfma_f32_16x16x32_bf16 v[230:233], v[218:221], a[164:167], v[230:233]
    v_mul_f32 v138, v138, v134
    s_nop 0
    v_mul_f32_dpp v138, v130, v134 quad_perm:[0,1,2,3] row_mask:0x2 bank_mask:0xf
    s_nop 0
    v_mul_f32_dpp v138, v178, v134 quad_perm:[0,1,2,3] row_mask:0x4 bank_mask:0xf
    v_cvt_pk_bf16_f32 v138, v138, v138
    ds_write_b16 v7, v138
    v_add_u32 v7, 16, v7
    s_waitcnt lgkmcnt(0)
    s_barrier
    s_waitcnt lgkmcnt(0)
    s_cmp_eq_u32 s17, 1
    s_cbranch_scc1 L_drain
    s_max_u32 s3, s37, s44
    s_cmp_gt_u32 s3, 0x42000000
    s_cbranch_scc1 L_safe
    v_cvt_pk_f16_f32 v118, v114, v115
    v_pk_mul_f16 v223, v118, v118
    v_cvt_pk_f16_f32 v119, v116, v117
    v_pk_mul_f16 v225, v119, v119
    v_cvt_pk_f16_f32 v120, v122, v123
    v_pk_fma_f16 v223, v120, v120, v223
    v_cvt_pk_f16_f32 v121, v124, v125
    v_pk_fma_f16 v225, v121, v121, v225
    v_cvt_pk_f16_f32 v196, v126, v127
    v_pk_fma_f16 v223, v196, v196, v223
    v_cvt_pk_f16_f32 v197, v128, v129
    v_pk_fma_f16 v225, v197, v197, v225
    v_cvt_pk_f16_f32 v206, v154, v155
    s_nop 7
    s_branch L_go
L_safe:
    v_fma_f32 v130, v114, v114, s32
    v_fmac_f32 v130, v115, v115
    v_fmac_f32 v130, v116, v116
    v_fmac_f32 v130, v117, v117
    v_fmac_f32 v130, v122, v122
    v_fmac_f32 v130, v123, v123
    v_fmac_f32 v130, v124, v124
    v_fmac_f32 v130, v125, v125
    v_fmac_f32 v130, v126, v126
    v_fmac_f32 v130, v127, v127
    v_fmac_f32 v130, v128, v128
    v_fmac_f32 v130, v129, v129
    v_fma_f32 v131, v154, v154, s32
    v_fmac_f32 v131, v155, v155
    v_fmac_f32 v131, v156, v156
    v_fmac_f32 v131, v157, v157
    v_fmac_f32 v131, v174, v174
    s_nop 7
    s_cmp_eq_u32 s16, 1
    s_cbranch_scc1 L_loop_safe1
    s_cmp_eq_u32 s16, 2
    s_cbranch_scc1 L_loop_safe2
    s_cmp_eq_u32 s16, 3
    s_cbranch_scc1 L_loop_safe3
    s_branch L_loop_safe0
.p2align 6
L_loop_safe0:
    v_mfma_f32_16x16x32_bf16 v[194:197], v[170:173], a[168:171], 0
    s_add_u32 s12, s42, s27
    ds_read_b128 v[198:201], v2 offset:18432
    ds_read_b128 v[214:217], v2 offset:19456
    v_mfma_f32_16x16x32_bf16 v[194:197], v[166:169], a[172:175], v[194:197]
    s_addc_u32 s13, s43, 0
    v_fmac_f32 v131, v175, v175
    v_fmac_f32 v131, v176, v176
    v_mfma_f32_16x16x32_bf16 v[194:197], v[162:165], a[176:179], v[194:197]
    s_sub_u32 s14, s36, s27
    v_fmac_f32 v131, v177, v177
    v_fmac_f32 v131, v182, v182
    v_mfma_f32_16x16x32_bf16 v[194:197], v[210:213], a[180:183], v[194:197]
    s_cmp_ge_u32 s18, 2
    v_fmac_f32 v131, v183, v183
    v_fmac_f32 v131, v184, v184
    v_mfma_f32_16x16x32_bf16 v[194:197], v[226:229], a[184:187], v[194:197]
    s_cselect_b32 s14, s14, 0
    ds_read_b128 v[118:121], v0 offset:26624
    v_fmac_f32 v131, v185, v185
    v_mfma_f32_16x16x32_bf16 v[194:197], v[218:221], a[188:191], v[194:197]
    s_add_u32 s34, s18, 2
    ds_read_b128 v[134:137], v1 offset:26624
    v_cvt_pk_bf16_f32 v36, v131, v130
    v_mfma_f32_16x16x32_bf16 v[234:237], v[170:173], a[192:195], 0
    s_add_u32 s8, s40, s23
    ds_read_b128 v[170:173], v0 offset:26752
    v_cvt_pk_bf16_f32 v230, v230, v231
    v_mfma_f32_16x16x32_bf16 v[234:237], v[166:169], a[196:199], v[234:237]
    s_addc_u32 s9, s41, 0
    ds_read_b128 v[166:169], v1 offset:26752
    v_cvt_pk_bf16_f32 v231, v232, v233
    v_mfma_f32_16x16x32_bf16 v[222:225], v[32:35], v[36:39], 0
    s_sub_u32 s10, s36, s23
    v_cvt_pk_bf16_f32 v130, v194, v195
    v_cvt_pk_bf16_f32 v131, v196, v197
    v_mfma_f32_16x16x32_bf16 v[234:237], v[162:165], a[200:203], v[234:237]
    s_waitcnt lgkmcnt(4)
    ds_read_b128 v[194:197], v0 offset:26880
    s_cmp_lt_u32 s34, s17
    v_mfma_f32_16x16x32_bf16 v[206:209], v[32:35], v[198:201], 0
    s_cselect_b32 s10, s10, 0
    v_rsq_f32 v223, v223
    v_mfma_f32_16x16x32_bf16 v[206:209], v[32:35], v[214:217], v[206:209]
    s_add_u32 m0, s28, 0
    v_rsq_f32 v222, v222
    v_mfma_f32_16x16x32_bf16 v[234:237], v[210:213], a[204:207], v[234:237]
    s_waitcnt lgkmcnt(4)
    ds_read_b128 v[198:201], v1 offset:26880
    v_mul_f32 v222, s31, v222
    v_mfma_f32_16x16x32_bf16 v[234:237], v[226:229], a[208:211], v[234:237]
    s_mov_b32 s27, s26
    v_mul_f32 v114, v223, v114
    v_mul_f32 v115, v223, v115
    v_mfma_f32_16x16x32_bf16 v[234:237], v[218:221], a[212:215], v[234:237]
    s_mov_b32 s26, s25
    v_cvt_pk_f16_f32 v218, v114, v115
    v_mul_f32 v116, v223, v116
    v_mfma_f32_16x16x32_bf16 v[226:229], a[72:75], v[118:121], 0
    s_waitcnt lgkmcnt(2)
    v_mul_f32 v117, v223, v117
    v_cvt_pk_f16_f32 v219, v116, v117
    v_mfma_f32_16x16x32_bf16 v[226:229], a[76:79], v[134:137], v[226:229]
    s_mov_b32 s25, s24
    v_cvt_pk_bf16_f32 v114, v234, v235
    v_cvt_pk_bf16_f32 v115, v236, v237
    v_mfma_f32_16x16x32_bf16 v[226:229], a[80:83], v[170:173], v[226:229]
    s_mov_b32 s24, s23
    v_mul_f32 v122, v223, v122
    v_mul_f32 v123, v223, v123
    v_mfma_f32_16x16x32_bf16 v[226:229], a[84:87], v[166:169], v[226:229]
    s_waitcnt lgkmcnt(1)
    v_cvt_pk_f16_f32 v220, v122, v123
    v_mul_f32 v124, v223, v124
    v_mfma_f32_16x16x32_bf16 v[226:229], a[88:91], v[194:197], v[226:229]
    v_mul_f32 v125, v223, v125
    v_cvt_pk_f16_f32 v221, v124, v125
    v_mfma_f32_16x16x32_bf16 v[122:125], a[96:99], v[118:121], 0
    s_waitcnt lgkmcnt(0)
    v_mul_f32 v126, v223, v126
    v_mul_f32 v127, v223, v127
    v_mfma_f32_16x16x32_bf16 v[226:229], a[92:95], v[198:201], v[226:229]
    v_cvt_pk_f16_f32 v164, v126, v127
    v_mul_f32 v128, v223, v128
    v_mfma_f32_16x16x32_bf16 v[122:125], a[100:103], v[134:137], v[122:125]
    v_mul_f32 v129, v223, v129
    v_cvt_pk_f16_f32 v165, v128, v129
    v_mfma_f32_16x16x32_bf16 v[122:125], a[104:107], v[170:173], v[122:125]
    v_mul_f32 v154, v222, v154
    v_mul_f32 v155, v222, v155
    v_mfma_f32_16x16x32_bf16 v[122:125], a[108:111], v[166:169], v[122:125]
    v_cvt_pk_f16_f32 v210, v154, v155
    v_mul_f32 v156, v222, v156
    v_mfma_f32_16x16x32_bf16 v[122:125], a[112:115], v[194:197], v[122:125]
    v_mul_f32 v157, v222, v157
    v_cvt_pk_f16_f32 v211, v156, v157
    v_mfma_f32_16x16x32_bf16 v[122:125], a[116:119], v[198:201], v[122:125]
    v_mul_f32 v174, v222, v174
    v_mul_f32 v175, v222, v175
    v_mfma_f32_16x16x32_bf16 v[126:129], a[120:123], v[118:121], 0
    v_cvt_pk_f16_f32 v212, v174, v175
    v_mul_f32 v176, v222, v176
    v_mfma_f32_16x16x32_bf16 v[126:129], a[124:127], v[134:137], v[126:129]
    v_mul_f32 v177, v222, v177
    v_cvt_pk_f16_f32 v213, v176, v177
    v_mfma_f32_16x16x32_bf16 v[126:129], a[128:131], v[170:173], v[126:129]
    v_mul_f32 v182, v222, v182
    v_mul_f32 v183, v222, v183
    v_mfma_f32_16x16x32_bf16 v[126:129], a[132:135], v[166:169], v[126:129]
    v_cvt_pk_f16_f32 v162, v182, v183
    v_mul_f32 v184, v222, v184
    v_mfma_f32_16x16x32_bf16 v[126:129], a[136:139], v[194:197], v[126:129]
    v_mul_f32 v185, v222, v185
    v_cvt_pk_f16_f32 v163, v184, v185
    v_mfma_f32_16x16x32_bf16 v[126:129], a[140:143], v[198:201], v[126:129]
    v_fma_f32 v116, v226, v226, s32
    v_fmac_f32 v116, v227, v227
    v_mfma_f32_16x16x32_bf16 v[154:157], a[0:3], v[118:121], 0
    v_fmac_f32 v116, v228, v228
    v_fmac_f32 v116, v229, v229
    v_mfma_f32_16x16x32_bf16 v[154:157], a[4:7], v[134:137], v[154:157]
    v_fmac_f32 v116, v122, v122
    v_fmac_f32 v116, v123, v123
    v_mfma_f32_16x16x32_bf16 v[154:157], a[8:11], v[170:173], v[154:157]
    v_fmac_f32 v116, v124, v124
    v_fmac_f32 v116, v125, v125
    v_mfma_f32_16x16x32_bf16 v[154:157], a[12:15], v[166:169], v[154:157]
    v_fmac_f32 v116, v126, v126
    v_fmac_f32 v116, v127, v127
    v_mfma_f32_16x16x32_bf16 v[154:157], a[16:19], v[194:197], v[154:157]
    v_fmac_f32 v116, v128, v128
    v_fmac_f32 v116, v129, v129
    v_mfma_f32_16x16x32_bf16 v[154:157], a[20:23], v[198:201], v[154:157]
    v_mul_f32 v117, 0x3baaaaab, v206
    v_mul_f32 v254, 0x3baaaaab, v207
    v_mfma_f32_16x16x32_bf16 v[174:177], a[24:27], v[118:121], 0
    v_rsq_f32 v117, v117
    v_mfma_f32_16x16x32_bf16 v[174:177], a[28:31], v[134:137], v[174:177]
    v_rsq_f32 v254, v254
    v_mfma_f32_16x16x32_bf16 v[174:177], a[32:35], v[170:173], v[174:177]
    v_mul_f32 v255, 0x3baaaaab, v208
    v_fma_f32 v132, v154, v154, s32
    v_mfma_f32_16x16x32_bf16 v[174:177], a[36:39], v[166:169], v[174:177]
    v_fmac_f32 v132, v155, v155
    v_fmac_f32 v132, v156, v156
    v_mfma_f32_16x16x32_bf16 v[174:177], a[40:43], v[194:197], v[174:177]
    v_fmac_f32 v132, v157, v157
    v_mul_f32 v150, v117, v150
    v_mfma_f32_16x16x32_bf16 v[174:177], a[44:47], v[198:201], v[174:177]
    v_rsq_f32 v255, v255
    v_mfma_f32_16x16x32_bf16 v[182:185], a[48:51], v[118:121], 0
    v_mul_f32 v151, v117, v151
    v_cvt_pk_bf16_f32 v214, v150, v151
    v_mfma_f32_16x16x32_bf16 v[182:185], a[52:55], v[134:137], v[182:185]
    v_mul_f32 v152, v117, v152
    v_mul_f32 v153, v117, v153
    v_mfma_f32_16x16x32_bf16 v[182:185], a[56:59], v[170:173], v[182:185]
    v_fmac_f32 v132, v174, v174
    v_fmac_f32 v132, v175, v175
    v_mfma_f32_16x16x32_bf16 v[182:185], a[60:63], v[166:169], v[182:185]
    v_fmac_f32 v132, v176, v176
    v_fmac_f32 v132, v177, v177
    v_mfma_f32_16x16x32_bf16 v[182:185], a[64:67], v[194:197], v[182:185]
    v_cvt_pk_bf16_f32 v215, v152, v153
    v_mul_f32 v190, v117, v190
    v_mfma_f32_16x16x32_bf16 v[182:185], a[68:71], v[198:201], v[182:185]
    v_mul_f32 v191, v117, v191
    v_cvt_pk_bf16_f32 v216, v190, v191
    v_mfma_f32_16x16x32_bf16 v[150:153], v[118:121], a[144:147], 0
    v_mul_f32 v192, v117, v192
    v_mul_f32 v193, v117, v193
    v_mfma_f32_16x16x32_bf16 v[150:153], v[134:137], a[148:151], v[150:153]
    v_cvt_pk_bf16_f32 v217, v192, v193
    v_mul_f32 v202, v117, v202
    v_mfma_f32_16x16x32_bf16 v[150:153], v[170:173], a[152:155], v[150:153]
    buffer_store_dwordx4 v[214:217], v15, s[12:15], 0 offen nt
    v_fmac_f32 v132, v182, v182
    v_fmac_f32 v132, v183, v183
    v_fmac_f32 v132, v184, v184
    v_fmac_f32 v132, v185, v185
    v_mfma_f32_16x16x32_bf16 v[150:153], v[166:169], a[156:159], v[150:153]
    v_cvt_pk_bf16_f32 v36, v132, v116
    v_mul_f32 v203, v117, v203
    v_mfma_f32_16x16x32_bf16 v[150:153], v[194:197], a[160:163], v[150:153]
    v_cvt_pk_bf16_f32 v116, v202, v203
    v_mul_f32 v204, v117, v204
    v_mfma_f32_16x16x32_bf16 v[190:193], v[32:35], v[36:39], 0
    v_mul_f32 v205, v117, v205
    v_cvt_pk_bf16_f32 v117, v204, v205
    v_mfma_f32_16x16x32_bf16 v[150:153], v[198:201], a[164:167], v[150:153]
    v_mul_f32 v146, v255, v146
    v_mul_f32 v147, v255, v147
    v_mfma_f32_16x16x32_bf16 v[202:205], v[118:121], a[168:171], 0
    v_cvt_pk_bf16_f32 v146, v146, v147
    v_mul_f32 v148, v255, v148
    v_mfma_f32_16x16x32_bf16 v[202:205], v[134:137], a[172:175], v[202:205]
    v_rsq_f32 v191, v191
    v_mfma_f32_16x16x32_bf16 v[202:205], v[170:173], a[176:179], v[202:205]
    v_cvt_pk_bf16_f32 v232, v150, v151
    v_cvt_pk_bf16_f32 v233, v152, v153
    v_mfma_f32_16x16x32_bf16 v[202:205], v[166:169], a[180:183], v[202:205]
    v_rsq_f32 v190, v190
    v_mfma_f32_16x16x32_bf16 v[202:205], v[194:197], a[184:187], v[202:205]
    ds_read_b128 v[150:153], v0 offset:32768
    v_mul_f32 v190, s31, v190
    v_mfma_f32_16x16x32_bf16 v[202:205], v[198:201], a[188:191], v[202:205]
    ds_read_b128 v[206:209], v1 offset:32768
    v_mul_f32 v226, v191, v226
    v_mfma_f32_16x16x32_bf16 v[214:217], v[118:121], a[192:195], 0
    ds_read_b128 v[118:121], v0 offset:32896
    v_mul_f32 v227, v191, v227
    v_mfma_f32_16x16x32_bf16 v[214:217], v[134:137], a[196:199], v[214:217]
    ds_read_b128 v[134:137], v1 offset:32896
    v_cvt_pk_f16_f32 v226, v226, v227
    v_mfma_f32_16x16x32_bf16 v[214:217], v[170:173], a[200:203], v[214:217]
    ds_read_b128 v[170:173], v0 offset:33024
    v_cvt_pk_bf16_f32 v132, v202, v203
    v_mfma_f32_16x16x32_bf16 v[214:217], v[166:169], a[204:207], v[214:217]
    ds_read_b128 v[166:169], v1 offset:33024
    v_cvt_pk_bf16_f32 v133, v204, v205
    v_mfma_f32_16x16x32_bf16 v[214:217], v[194:197], a[208:211], v[214:217]
    v_mul_f32 v228, v191, v228
    v_mul_f32 v229, v191, v229
    v_mfma_f32_16x16x32_bf16 v[214:217], v[198:201], a[212:215], v[214:217]
    v_cvt_pk_f16_f32 v227, v228, v229
    v_mul_f32 v122, v191, v122
    v_mfma_f32_16x16x32_f16 v[194:197], v[218:221], v[210:213], v[46:49]
    s_waitcnt lgkmcnt(5)
    buffer_store_dwordx2 v[116:117], v18, s[12:15], 0 offen nt
    v_mul_f32 v123, v191, v123
    v_cvt_pk_f16_f32 v228, v122, v123
    v_mfma_f32_16x16x32_bf16 v[202:205], a[72:75], v[150:153], 0
    s_waitcnt lgkmcnt(3)
    v_cvt_pk_bf16_f32 v116, v214, v215
    v_cvt_pk_bf16_f32 v117, v216, v217
    v_mfma_f32_16x16x32_bf16 v[202:205], a[76:79], v[206:209], v[202:205]
    s_waitcnt lgkmcnt(2)
    v_mul_f32 v124, v191, v124
    v_mul_f32 v125, v191, v125
    v_mfma_f32_16x16x32_bf16 v[202:205], a[80:83], v[118:121], v[202:205]
    s_waitcnt lgkmcnt(1)
    v_cvt_pk_f16_f32 v229, v124, v125
    v_mul_f32 v126, v191, v126
    v_mfma_f32_16x16x32_bf16 v[202:205], a[84:87], v[134:137], v[202:205]
    s_waitcnt lgkmcnt(0)
    v_mul_f32 v127, v191, v127
    v_cvt_pk_f16_f32 v124, v126, v127
    v_mfma_f32_16x16x32_bf16 v[202:205], a[88:91], v[170:173], v[202:205]
    v_mul_f32 v128, v191, v128
    v_mul_f32 v129, v191, v129
    v_mfma_f32_16x16x32_bf16 v[202:205], a[92:95], v[166:169], v[202:205]
    v_cvt_pk_f16_f32 v125, v128, v129
    v_mul_f32 v154, v190, v154
    v_mfma_f32_16x16x32_bf16 v[126:129], a[96:99], v[150:153], 0
    v_mul_f32 v155, v190, v155
    v_cvt_pk_f16_f32 v154, v154, v155
    v_mfma_f32_16x16x32_bf16 v[126:129], a[100:103], v[206:209], v[126:129]
    v_mul_f32 v156, v190, v156
    v_mul_f32 v157, v190, v157
    v_mfma_f32_16x16x32_bf16 v[126:129], a[104:107], v[118:121], v[126:129]
    v_cvt_pk_f16_f32 v155, v156, v157
    v_mul_f32 v174, v190, v174
    v_mfma_f32_16x16x32_bf16 v[126:129], a[108:111], v[134:137], v[126:129]
    v_mul_f32 v175, v190, v175
    v_cvt_pk_f16_f32 v156, v174, v175
    v_mfma_f32_16x16x32_bf16 v[126:129], a[112:115], v[170:173], v[126:129]
    v_mul_f32 v176, v190, v176
    v_mul_f32 v177, v190, v177
    v_mfma_f32_16x16x32_bf16 v[126:129], a[116:119], v[166:169], v[126:129]
    v_cvt_pk_f16_f32 v157, v176, v177
    v_mul_f32 v182, v190, v182
    v_mfma_f32_16x16x32_bf16 v[174:177], a[120:123], v[150:153], 0
    v_mul_f32 v183, v190, v183
    v_cvt_pk_f16_f32 v122, v182, v183
    v_mfma_f32_16x16x32_bf16 v[174:177], a[124:127], v[206:209], v[174:177]
    v_mul_f32 v184, v190, v184
    v_mul_f32 v185, v190, v185
    v_mfma_f32_16x16x32_bf16 v[174:177], a[128:131], v[118:121], v[174:177]
    v_cvt_pk_f16_f32 v123, v184, v185
    v_fma_f32 v182, v202, v202, s32
    v_mfma_f32_16x16x32_bf16 v[174:177], a[132:135], v[134:137], v[174:177]
    v_fmac_f32 v182, v203, v203
    v_fmac_f32 v182, v204, v204
    v_mfma_f32_16x16x32_bf16 v[174:177], a[136:139], v[170:173], v[174:177]
    v_fmac_f32 v182, v205, v205
    v_fmac_f32 v182, v126, v126
    v_mfma_f32_16x16x32_bf16 v[174:177], a[140:143], v[166:169], v[174:177]
    v_fmac_f32 v182, v127, v127
    v_fmac_f32 v182, v128, v128
    v_mfma_f32_16x16x32_bf16 v[190:193], a[0:3], v[150:153], 0
    v_fmac_f32 v182, v129, v129
    v_mul_f32 v149, v255, v149
    v_mfma_f32_16x16x32_bf16 v[190:193], a[4:7], v[206:209], v[190:193]
    v_cvt_pk_bf16_f32 v147, v148, v149
    v_mul_f32 v138, v255, v138
    v_mfma_f32_16x16x32_bf16 v[190:193], a[8:11], v[118:121], v[190:193]
    v_fmac_f32 v182, v174, v174
    v_fmac_f32 v182, v175, v175
    v_mfma_f32_16x16x32_bf16 v[190:193], a[12:15], v[134:137], v[190:193]
    v_fmac_f32 v182, v176, v176
    v_fmac_f32 v182, v177, v177
    v_mfma_f32_16x16x32_bf16 v[190:193], a[16:19], v[170:173], v[190:193]
    v_mul_f32 v139, v255, v139
    v_cvt_pk_bf16_f32 v148, v138, v139
    v_mfma_f32_16x16x32_bf16 v[190:193], a[20:23], v[166:169], v[190:193]
    v_mul_f32 v140, v255, v140
    v_mul_f32 v141, v255, v141
    v_mfma_f32_16x16x32_bf16 v[198:201], a[24:27], v[150:153], 0
    v_cvt_pk_bf16_f32 v149, v140, v141
    v_mul_f32 v186, v255, v186
    v_mfma_f32_16x16x32_bf16 v[198:201], a[28:31], v[206:209], v[198:201]
    buffer_store_dwordx4 v[146:149], v17, s[12:15], 0 offen nt
    v_mul_f32 v187, v255, v187
    v_fma_f32 v183, v190, v190, s32
    v_fmac_f32 v183, v191, v191
    v_fmac_f32 v183, v192, v192
    v_mfma_f32_16x16x32_bf16 v[198:201], a[32:35], v[118:121], v[198:201]
    v_fmac_f32 v183, v193, v193
    v_cvt_pk_bf16_f32 v184, v186, v187
    v_mfma_f32_16x16x32_bf16 v[198:201], a[36:39], v[134:137], v[198:201]
    v_mul_f32 v188, v255, v188
    v_mul_f32 v189, v255, v189
    v_mfma_f32_16x16x32_bf16 v[198:201], a[40:43], v[170:173], v[198:201]
    v_cvt_pk_bf16_f32 v185, v188, v189
    v_mul_f32 v142, v254, v142
    v_mfma_f32_16x16x32_bf16 v[198:201], a[44:47], v[166:169], v[198:201]
    v_mul_f32 v143, v254, v143
    v_cvt_pk_bf16_f32 v142, v142, v143
    v_mfma_f32_16x16x32_bf16 v[138:141], a[48:51], v[150:153], 0
    v_mul_f32 v144, v254, v144
    v_mul_f32 v145, v254, v145
    v_mfma_f32_16x16x32_bf16 v[138:141], a[52:55], v[206:209], v[138:141]
    v_cvt_pk_bf16_f32 v143, v144, v145
    v_mul_f32 v158, v254, v158
    v_mfma_f32_16x16x32_bf16 v[138:141], a[56:59], v[118:121], v[138:141]
    v_fmac_f32 v183, v198, v198
    v_fmac_f32 v183, v199, v199
    v_mfma_f32_16x16x32_bf16 v[138:141], a[60:63], v[134:137], v[138:141]
    ds_read2_b32 v[216:217], v6 offset0:0 offset1:0
    ds_read2_b32 v[224:225], v6 offset0:16 offset1:16
    v_mfma_f32_16x16x32_bf16 v[138:141], a[64:67], v[170:173], v[138:141]
    ds_read2_b32 v[236:237], v6 offset0:32 offset1:32
    v_fmac_f32 v183, v200, v200
    v_mfma_f32_16x16x32_bf16 v[138:141], a[68:71], v[166:169], v[138:141]
    v_fmac_f32 v183, v201, v201
    v_mul_f32 v159, v254, v159
    v_mfma_f32_16x16x32_bf16 v[146:149], v[150:153], a[144:147], 0
    v_cvt_pk_bf16_f32 v144, v158, v159
    v_mul_f32 v160, v254, v160
    v_mfma_f32_16x16x32_bf16 v[146:149], v[206:209], a[148:151], v[146:149]
    v_mul_f32 v161, v254, v161
    v_cvt_pk_bf16_f32 v145, v160, v161
    v_mfma_f32_16x16x32_bf16 v[146:149], v[118:121], a[152:155], v[146:149]
    v_fmac_f32 v183, v138, v138
    v_fmac_f32 v183, v139, v139
    v_mfma_f32_16x16x32_bf16 v[146:149], v[134:137], a[156:159], v[146:149]
    v_fmac_f32 v183, v140, v140
    v_fmac_f32 v183, v141, v141
    v_mfma_f32_16x16x32_bf16 v[146:149], v[170:173], a[160:163], v[146:149]
    v_cvt_pk_bf16_f32 v36, v183, v182
    v_mul_f32 v178, v254, v178
    v_mfma_f32_16x16x32_bf16 v[146:149], v[166:169], a[164:167], v[146:149]
    s_waitcnt lgkmcnt(1)
    v_mul_f32 v179, v254, v179
    v_cvt_pk_bf16_f32 v178, v178, v179
    v_mfma_f32_16x16x32_bf16 v[158:161], v[32:35], v[36:39], 0
    s_waitcnt lgkmcnt(0)
    buffer_store_dwordx2 v[184:185], v20, s[12:15], 0 offen nt
    v_mul_f32 v180, v254, v180
    v_mul_f32 v181, v254, v181
    v_mfma_f32_16x16x32_bf16 v[186:189], v[150:153], a[168:171], 0
    v_cvt_pk_bf16_f32 v214, v146, v147
    v_cvt_pk_bf16_f32 v215, v148, v149
    v_mfma_f32_16x16x32_bf16 v[186:189], v[206:209], a[172:175], v[186:189]
    v_rsq_f32 v159, v159
    v_mfma_f32_16x16x32_bf16 v[186:189], v[118:121], a[176:179], v[186:189]
    v_rsq_f32 v158, v158
    v_mfma_f32_16x16x32_bf16 v[186:189], v[134:137], a[180:183], v[186:189]
    v_mul_f32 v158, s31, v158
    v_mul_f32 v202, v159, v202
    v_mfma_f32_16x16x32_bf16 v[186:189], v[170:173], a[184:187], v[186:189]
    v_mul_f32 v203, v159, v203
    v_cvt_pk_f16_f32 v146, v202, v203
    v_mfma_f32_16x16x32_bf16 v[186:189], v[166:169], a[188:191], v[186:189]
    v_mul_f32 v204, v159, v204
    v_mul_f32 v205, v159, v205
    v_mfma_f32_16x16x32_bf16 v[182:185], v[150:153], a[192:195], 0
    v_cvt_pk_f16_f32 v147, v204, v205
    v_mul_f32 v126, v159, v126
    v_mfma_f32_16x16x32_bf16 v[182:185], v[206:209], a[196:199], v[182:185]
    ds_read_b128 v[150:153], v5 offset:0
    ds_read_b128 v[202:205], v5 offset:16
    v_mfma_f32_16x16x32_bf16 v[182:185], v[118:121], a[200:203], v[182:185]
    ds_read_b128 v[118:121], v5 offset:48
    ds_read_b32 v254, v6 offset:192
    v_mfma_f32_16x16x32_bf16 v[182:185], v[134:137], a[204:207], v[182:185]
    v_cvt_pk_bf16_f32 v222, v186, v187
    v_cvt_pk_bf16_f32 v223, v188, v189
    v_mfma_f32_16x16x32_bf16 v[182:185], v[170:173], a[208:211], v[182:185]
    v_mul_f32 v127, v159, v127
    v_cvt_pk_f16_f32 v148, v126, v127
    v_mfma_f32_16x16x32_bf16 v[182:185], v[166:169], a[212:215], v[182:185]
    ds_read_b128 v[166:169], v2 offset:0
    ds_read_b128 v[170:173], v2 offset:1024
    v_mfma_f32_16x16x32_f16 v[186:189], v[226:229], v[210:213], v[50:53]
    ds_read_b128 v[134:137], v2 offset:2048
    v_mul_f32 v128, v159, v128
    v_mul_f32 v129, v159, v129
    v_mfma_f32_16x16x16_f16 v[194:197], v[164:165], v[162:163], v[194:197]
    v_cvt_pk_f16_f32 v149, v128, v129
    v_cvt_pk_bf16_f32 v234, v182, v183
    v_cvt_pk_bf16_f32 v235, v184, v185
    v_mul_f32 v174, v159, v174
    v_mfma_f32_16x16x32_f16 v[126:129], v[146:149], v[210:213], v[54:57]
    s_waitcnt lgkmcnt(5)
    v_mul_f32 v175, v159, v175
    v_cvt_pk_f16_f32 v184, v174, v175
    v_mul_f32 v176, v159, v176
    v_mfma_f32_16x16x16_f16 v[186:189], v[124:125], v[162:163], v[186:189]
    v_mul_f32 v177, v159, v177
    v_cvt_pk_f16_f32 v185, v176, v177
    v_mul_f32 v190, v158, v190
    v_mul_f32 v191, v158, v191
    v_mfma_f32_16x16x16_f16 v[126:129], v[184:185], v[162:163], v[126:129]
    v_cvt_pk_f16_f32 v174, v190, v191
    v_mul_f32 v192, v158, v192
    v_mul_f32 v193, v158, v193
    v_cvt_pk_f16_f32 v175, v192, v193
    v_mfma_f32_16x16x32_f16 v[206:209], v[150:153], v[210:213], v[22:25]
    s_waitcnt lgkmcnt(2)
    ds_read_b128 v[210:213], v2 offset:3072
    buffer_store_dwordx4 v[142:145], v16, s[12:15], 0 offen nt
    ds_read_b128 v[238:241], v2 offset:4096
    v_mul_f32 v198, v158, v198
    v_mul_f32 v199, v158, v199
    v_cvt_pk_f16_f32 v176, v198, v199
    v_mfma_f32_16x16x32_f16 v[206:209], v[202:205], v[218:221], v[206:209]
    s_waitcnt lgkmcnt(2)
    v_mul_f32 v200, v158, v200
    v_mul_f32 v201, v158, v201
    v_mfma_f32_16x16x32_f16 v[206:209], v[118:121], v[162:165], v[206:209]
    ds_read_b128 v[142:145], v2 offset:5120
    v_cvt_pk_f16_f32 v177, v200, v201
    v_mul_f32 v138, v158, v138
    v_mul_f32 v139, v158, v139
    v_cvt_pk_f16_f32 v182, v138, v139
    v_mfma_f32_16x16x32_f16 v[198:201], v[150:153], v[154:157], v[24:27]
    v_mul_f32 v140, v158, v140
    v_mul_f32 v141, v158, v141
    v_mfma_f32_16x16x32_f16 v[198:201], v[202:205], v[226:229], v[198:201]
    v_mov_b32_dpp v254, v207 quad_perm:[0,1,2,3] row_mask:0x1 bank_mask:0xf
    v_cvt_pk_f16_f32 v183, v140, v141
    v_mfma_f32_16x16x32_f16 v[198:201], v[118:121], v[122:125], v[198:201]
    v_max3_f32 v255, v206, v194, v195
    v_max3_f32 v255, v255, v196, v197
    v_mfma_f32_16x16x32_f16 v[242:245], v[150:153], v[174:177], v[26:29]
    s_waitcnt lgkmcnt(1)
    v_max3_f32 v255, v255, v186, v187
    v_max3_f32 v255, v255, v188, v189
    v_mfma_f32_16x16x32_f16 v[242:245], v[202:205], v[146:149], v[242:245]
    v_max3_f32 v255, v255, v126, v127
    v_mov_b32_dpp v254, v199 quad_perm:[0,1,2,3] row_mask:0x2 bank_mask:0xf
    v_mfma_f32_16x16x32_f16 v[242:245], v[118:121], v[182:185], v[242:245]
    v_max3_f32 v255, v255, v128, v129
    v_mov_b32 v162, v255
    v_mfma_f32_16x16x32_bf16 v[150:153], a[216:219], v[166:169], 0
    s_waitcnt lgkmcnt(0)
    v_permlane32_swap_b32 v255, v162
    v_mfma_f32_16x16x32_bf16 v[150:153], a[220:223], v[170:173], v[150:153]
    v_max_f32 v255, v255, v162
    v_mov_b32 v162, v255
    v_mfma_f32_16x16x32_bf16 v[150:153], a[224:227], v[134:137], v[150:153]
    v_cvt_pk_bf16_f32 v179, v180, v181
    v_xor_b32 v0, 65536, v0
    v_mfma_f32_16x16x32_bf16 v[150:153], a[228:231], v[210:213], v[150:153]
    s_waitcnt vmcnt(5)
    v_permlane16_swap_b32 v255, v162
    v_mfma_f32_16x16x32_bf16 v[150:153], a[232:235], v[238:241], v[150:153]
    s_barrier
    v_max_f32 v255, v255, v162
    v_sub_f32 v194, v194, v255
    v_mfma_f32_16x16x32_bf16 v[150:153], a[236:239], v[142:145], v[150:153]
    v_exp_f32 v194, v194
    v_mfma_f32_16x16x32_bf16 v[190:193], a[240:243], v[166:169], 0
    v_sub_f32 v195, v195, v255
    v_sub_f32 v196, v196, v255
    v_mfma_f32_16x16x32_bf16 v[190:193], a[244:247], v[170:173], v[190:193]
    buffer_load_dwordx4 v10, s[8:11], 0 offen nt lds
    v_sub_f32 v197, v197, v255
    v_mfma_f32_16x16x32_bf16 v[190:193], a[248:251], v[134:137], v[190:193]
    s_add_u32 m0, s28, 4096
    v_exp_f32 v195, v195
    v_mfma_f32_16x16x32_bf16 v[190:193], a[252:255], v[210:213], v[190:193]
    v_cvt_pk_bf16_f32 v158, v194, v195
    v_sub_f32 v186, v186, v255
    v_mfma_f32_16x16x32_bf16 v[190:193], v[82:85], v[238:241], v[190:193]
    v_exp_f32 v196, v196
    v_mfma_f32_16x16x32_bf16 v[190:193], v[86:89], v[142:145], v[190:193]
    v_exp_f32 v197, v197
    v_mfma_f32_16x16x32_bf16 v[202:205], v[90:93], v[166:169], 0
    ds_read_b128 v[166:169], v2 offset:6144
    buffer_load_dwordx4 v11, s[8:11], 0 offen nt lds
    v_mfma_f32_16x16x32_bf16 v[202:205], v[94:97], v[170:173], v[202:205]
    s_add_u32 m0, s28, 8192
    ds_read_b128 v[170:173], v2 offset:7168
    v_cvt_pk_bf16_f32 v159, v196, v197
    v_mfma_f32_16x16x32_bf16 v[202:205], v[98:101], v[134:137], v[202:205]
    ds_read_b128 v[138:141], v2 offset:8192
    v_sub_f32 v187, v187, v255
    v_mfma_f32_16x16x32_bf16 v[202:205], v[102:105], v[210:213], v[202:205]
    ds_read_b128 v[210:213], v2 offset:9216
    v_sub_f32 v188, v188, v255
    v_mfma_f32_16x16x32_bf16 v[202:205], v[106:109], v[238:241], v[202:205]
    ds_read_b128 v[134:137], v2 offset:10240
    v_sub_f32 v189, v189, v255
    v_mfma_f32_16x16x32_bf16 v[202:205], v[110:113], v[142:145], v[202:205]
    ds_read_b128 v[194:197], v2 offset:11264
    buffer_load_dwordx4 v12, s[8:11], 0 offen nt lds
    v_exp_f32 v186, v186
    v_mfma_f32_16x16x32_f16 v[118:121], v[218:221], v[154:157], v[58:61]
    s_add_u32 m0, s28, 12288
    v_exp_f32 v187, v187
    v_exp_f32 v188, v188
    v_cvt_pk_bf16_f32 v160, v186, v187
    v_exp_f32 v189, v189
    v_sub_f32 v126, v126, v255
    v_mfma_f32_16x16x16_f16 v[118:121], v[164:165], v[122:123], v[118:121]
    v_cvt_pk_bf16_f32 v161, v188, v189
    v_exp_f32 v126, v126
    v_sub_f32 v127, v127, v255
    v_mfma_f32_16x16x32_f16 v[186:189], v[226:229], v[154:157], v[62:65]
    s_xor_b32 s28, s28, 65536
    buffer_load_dwordx4 v13, s[8:11], 0 offen nt lds
    v_exp_f32 v127, v127
    v_sub_f32 v128, v128, v255
    v_cvt_pk_bf16_f32 v36, v126, v127
    v_exp_f32 v128, v128
    v_mfma_f32_16x16x16_f16 v[186:189], v[124:125], v[122:123], v[186:189]
    v_sub_f32 v129, v129, v255
    v_exp_f32 v129, v129
    v_sub_f32 v206, v206, v255
    v_cvt_pk_bf16_f32 v37, v128, v129
    v_mfma_f32_16x16x32_f16 v[126:129], v[146:149], v[154:157], v[66:69]
    s_waitcnt lgkmcnt(0)
    v_exp_f32 v206, v206
    v_mfma_f32_16x16x32_bf16 v[142:145], a[216:219], v[166:169], 0
    s_mov_b32 m0, s29
    v_cvt_pk_bf16_f32 v39, v206, 0
    v_max3_f32 v255, v198, v118, v119
    v_max3_f32 v255, v255, v120, v121
    v_mfma_f32_16x16x16_f16 v[126:129], v[184:185], v[122:123], v[126:129]
    v_max3_f32 v255, v255, v186, v187
    v_max3_f32 v255, v255, v188, v189
    v_xor_b32 v1, 65536, v1
    v_mov_b32_dpp v254, v243 quad_perm:[0,1,2,3] row_mask:0x4 bank_mask:0xf
    v_mfma_f32_16x16x32_bf16 v[154:157], v[28:31], v[36:39], 0
    s_xor_b32 s29, s29, s30
    buffer_store_dwordx2 v[178:179], v19, s[12:15], 0 offen nt
    v_mov_b32 v122, v254
    v_max3_f32 v255, v255, v126, v127
    v_mfma_f32_16x16x32_bf16 v[154:157], v[28:31], v[158:161], v[154:157]
    s_add_u32 s19, s19, s20
    v_max3_f32 v255, v255, v128, v129
    v_mov_b32 v123, v255
    v_mfma_f32_16x16x32_bf16 v[142:145], a[220:223], v[170:173], v[142:145]
    s_add_u32 s23, s23, s21
    v_permlane32_swap_b32 v255, v123
    v_mfma_f32_16x16x32_bf16 v[142:145], a[224:227], v[138:141], v[142:145]
    s_cmp_ge_u32 s19, 72
    v_rcp_f32 v154, v154
    v_mfma_f32_16x16x32_bf16 v[142:145], a[228:231], v[210:213], v[142:145]
    s_cselect_b32 s34, 72, 0
    v_max_f32 v255, v255, v123
    v_mov_b32 v123, v255
    v_mfma_f32_16x16x32_bf16 v[142:145], a[232:235], v[134:137], v[142:145]
    s_cselect_b32 s35, s22, 0
    v_permlane16_swap_b32 v255, v123
    v_mfma_f32_16x16x32_bf16 v[142:145], a[236:239], v[194:197], v[142:145]
    s_sub_u32 s19, s19, s34
    v_max_f32 v255, v255, v123
    v_sub_f32 v118, v118, v255
    v_mfma_f32_16x16x32_bf16 v[178:181], v[214:217], v[36:39], 0
    s_add_u32 s23, s23, s35
    v_exp_f32 v118, v118
    v_mfma_f32_16x16x32_bf16 v[178:181], v[230:233], v[158:161], v[178:181]
    s_add_u32 s18, s18, 1
    v_sub_f32 v119, v119, v255
    v_exp_f32 v119, v119
    v_sub_f32 v120, v120, v255
    v_cvt_pk_bf16_f32 v118, v118, v119
    v_exp_f32 v120, v120
    v_sub_f32 v121, v121, v255
    v_exp_f32 v121, v121
    v_mul_f32 v178, v154, v178
    v_mul_f32 v179, v154, v179
    v_cvt_pk_bf16_f32 v178, v178, v179
    v_mul_f32 v180, v154, v180
    v_mul_f32 v181, v154, v181
    v_cvt_pk_bf16_f32 v179, v180, v181
    v_cvt_pk_bf16_f32 v119, v120, v121
    v_mfma_f32_16x16x32_bf16 v[206:209], v[222:225], v[36:39], 0
    s_cmp_lt_u32 s18, s45
    v_sub_f32 v186, v186, v255
    v_sub_f32 v187, v187, v255
    v_mfma_f32_16x16x32_bf16 v[206:209], v[130:133], v[158:161], v[206:209]
    v_exp_f32 v186, v186
    v_exp_f32 v187, v187
    v_sub_f32 v188, v188, v255
    v_cvt_pk_bf16_f32 v120, v186, v187
    v_exp_f32 v188, v188
    v_sub_f32 v189, v189, v255
    v_exp_f32 v189, v189
    v_sub_f32 v126, v126, v255
    v_mul_f32 v206, v154, v206
    v_mul_f32 v207, v154, v207
    v_cvt_pk_bf16_f32 v180, v206, v207
    v_mul_f32 v208, v154, v208
    v_mul_f32 v209, v154, v209
    v_cvt_pk_bf16_f32 v181, v208, v209
    v_cvt_pk_bf16_f32 v121, v188, v189
    v_mfma_f32_16x16x32_bf16 v[186:189], v[234:237], v[36:39], 0
    buffer_load_dwordx4 v14, s[8:11], 0 offen nt lds
    v_sub_f32 v127, v127, v255
    v_mfma_f32_16x16x32_bf16 v[186:189], v[114:117], v[158:161], v[186:189]
    ds_write_b128 v3, v[178:181] offset:0
    v_mfma_f32_16x16x32_bf16 v[158:161], a[240:243], v[166:169], 0
    v_exp_f32 v126, v126
    v_mfma_f32_16x16x32_bf16 v[158:161], a[244:247], v[170:173], v[158:161]
    v_exp_f32 v127, v127
    v_mfma_f32_16x16x32_bf16 v[158:161], a[248:251], v[138:141], v[158:161]
    v_cvt_pk_bf16_f32 v36, v126, v127
    v_sub_f32 v128, v128, v255
    v_mfma_f32_16x16x32_bf16 v[158:161], a[252:255], v[210:213], v[158:161]
    v_mul_f32 v186, v154, v186
    v_mul_f32 v187, v154, v187
    v_mfma_f32_16x16x32_bf16 v[158:161], v[82:85], v[134:137], v[158:161]
    v_cvt_pk_bf16_f32 v126, v186, v187
    v_mul_f32 v188, v154, v188
    v_mfma_f32_16x16x32_bf16 v[158:161], v[86:89], v[194:197], v[158:161]
    v_mul_f32 v189, v154, v189
    v_cvt_pk_bf16_f32 v127, v188, v189
    v_mfma_f32_16x16x32_bf16 v[178:181], v[90:93], v[166:169], 0
    ds_read_b128 v[166:169], v2 offset:12288
    v_sub_f32 v129, v129, v255
    v_mfma_f32_16x16x32_bf16 v[178:181], v[94:97], v[170:173], v[178:181]
    ds_read_b128 v[170:173], v2 offset:13312
    v_sub_f32 v198, v198, v255
    v_mfma_f32_16x16x32_bf16 v[178:181], v[98:101], v[138:141], v[178:181]
    ds_read_b128 v[154:157], v2 offset:14336
    v_max_f32_dpp v122, v122, v122 quad_perm:[1,0,3,2] row_mask:0xf bank_mask:0xf
    v_mfma_f32_16x16x32_bf16 v[178:181], v[102:105], v[210:213], v[178:181]
    ds_read_b128 v[210:213], v2 offset:15360
    v_max_f32_dpp v122, v122, v122 quad_perm:[2,3,0,1] row_mask:0xf bank_mask:0xf
    v_mfma_f32_16x16x32_bf16 v[178:181], v[106:109], v[134:137], v[178:181]
    ds_read_b128 v[134:137], v2 offset:16384
    v_max_f32_dpp v122, v122, v122 row_half_mirror row_mask:0xf bank_mask:0xf
    v_mfma_f32_16x16x32_bf16 v[178:181], v[110:113], v[194:197], v[178:181]
    ds_read_b128 v[194:197], v2 offset:17408
    ds_write_b64 v4, v[126:127] offset:4096
    v_exp_f32 v128, v128
    v_exp_f32 v129, v129
    v_mfma_f32_16x16x32_f16 v[186:189], v[218:221], v[174:177], v[70:73]
    s_waitcnt lgkmcnt(6)
    v_cvt_pk_bf16_f32 v37, v128, v129
    v_max_f32_dpp v122, v122, v122 row_mirror row_mask:0xf bank_mask:0xf
    v_mfma_f32_16x16x32_f16 v[218:221], v[226:229], v[174:177], v[74:77]
    s_waitcnt lgkmcnt(5)
    v_exp_f32 v198, v198
    v_mfma_f32_16x16x32_f16 v[126:129], v[146:149], v[174:177], v[78:81]
    s_waitcnt lgkmcnt(4)
    v_cvt_pk_bf16_f32 v39, v198, 0
    v_mov_b32 v123, v122
    v_fma_f32 v255, v150, v150, s33
    v_mfma_f32_16x16x32_bf16 v[174:177], v[28:31], v[36:39], 0
    s_waitcnt lgkmcnt(3)
    v_permlane32_swap_b32 v122, v123
    v_mfma_f32_16x16x32_bf16 v[174:177], v[28:31], v[118:121], v[174:177]
    s_waitcnt lgkmcnt(2)
    v_max_f32 v122, v122, v123
    v_mov_b32 v123, v122
    v_mfma_f32_16x16x32_bf16 v[226:229], v[214:217], v[36:39], 0
    s_waitcnt lgkmcnt(0)
    v_permlane16_swap_b32 v122, v123
    v_mfma_f32_16x16x32_bf16 v[226:229], v[230:233], v[118:121], v[226:229]
    v_max_f32 v122, v122, v123
    v_sub_f32 v254, v254, v122
    v_mfma_f32_16x16x32_bf16 v[198:201], v[222:225], v[36:39], 0
    v_exp_f32 v254, v254
    v_mfma_f32_16x16x32_bf16 v[198:201], v[130:133], v[118:121], v[198:201]
    v_cvt_pk_bf16_f32 v254, v254, v254
    v_fmac_f32 v255, v151, v151
    v_mfma_f32_16x16x32_bf16 v[206:209], v[234:237], v[36:39], 0
    ds_write_b16 v8, v254
    v_mfma_f32_16x16x32_bf16 v[206:209], v[114:117], v[118:121], v[206:209]
    v_rcp_f32 v174, v174
    v_fmac_f32 v255, v152, v152
    v_mfma_f32_16x16x16_f16 v[186:189], v[164:165], v[182:183], v[186:189]
    v_mul_f32 v226, v174, v226
    v_mul_f32 v227, v174, v227
    v_cvt_pk_bf16_f32 v122, v226, v227
    v_mfma_f32_16x16x16_f16 v[218:221], v[124:125], v[182:183], v[218:221]
    v_mul_f32 v228, v174, v228
    v_mul_f32 v229, v174, v229
    v_cvt_pk_bf16_f32 v123, v228, v229
    v_mfma_f32_16x16x16_f16 v[126:129], v[184:185], v[182:183], v[126:129]
    v_max3_f32 v254, v242, v186, v187
    v_max3_f32 v254, v254, v188, v189
    v_mul_f32 v198, v174, v198
    v_mul_f32 v199, v174, v199
    v_mfma_f32_16x16x32_bf16 v[146:149], a[216:219], v[166:169], 0
    ds_read_b128 v[182:185], v9
    ds_read_b128 v[118:121], v9 offset:64
    v_mfma_f32_16x16x32_bf16 v[146:149], a[220:223], v[170:173], v[146:149]
    v_max3_f32 v254, v254, v218, v219
    v_max3_f32 v254, v254, v220, v221
    v_mfma_f32_16x16x32_bf16 v[146:149], a[224:227], v[154:157], v[146:149]
    v_max3_f32 v254, v254, v126, v127
    v_max3_f32 v254, v254, v128, v129
    v_mfma_f32_16x16x32_bf16 v[146:149], a[228:231], v[210:213], v[146:149]
    v_mov_b32 v125, v254
    v_cvt_pk_bf16_f32 v124, v198, v199
    v_mfma_f32_16x16x32_bf16 v[146:149], a[232:235], v[134:137], v[146:149]
    v_permlane32_swap_b32 v254, v125
    v_mfma_f32_16x16x32_bf16 v[146:149], a[236:239], v[194:197], v[146:149]
    v_max_f32 v254, v254, v125
    v_mov_b32 v125, v254
    v_mfma_f32_16x16x32_bf16 v[138:141], a[240:243], v[166:169], 0
    v_mul_f32 v200, v174, v200
    v_mul_f32 v201, v174, v201
    v_mfma_f32_16x16x32_bf16 v[138:141], a[244:247], v[170:173], v[138:141]
    v_permlane16_swap_b32 v254, v125
    v_mfma_f32_16x16x32_bf16 v[138:141], a[248:251], v[154:157], v[138:141]
    s_waitcnt lgkmcnt(0)
    v_max_f32 v254, v254, v125
    v_sub_f32 v186, v186, v254
    v_mfma_f32_16x16x32_bf16 v[138:141], a[252:255], v[210:213], v[138:141]
    v_exp_f32 v186, v186
    v_mfma_f32_16x16x32_bf16 v[138:141], v[82:85], v[134:137], v[138:141]
    v_sub_f32 v187, v187, v254
    v_sub_f32 v188, v188, v254
    v_mfma_f32_16x16x32_bf16 v[138:141], v[86:89], v[194:197], v[138:141]
    v_exp_f32 v187, v187
    v_exp_f32 v188, v188
    v_cvt_pk_bf16_f32 v238, v186, v187
    v_sub_f32 v189, v189, v254
    v_exp_f32 v189, v189
    v_sub_f32 v218, v218, v254
    v_cvt_pk_bf16_f32 v239, v188, v189
    v_exp_f32 v218, v218
    v_sub_f32 v219, v219, v254
    v_exp_f32 v219, v219
    v_sub_f32 v220, v220, v254
    v_cvt_pk_bf16_f32 v240, v218, v219
    v_mfma_f32_16x16x32_bf16 v[186:189], v[90:93], v[166:169], 0
    v_exp_f32 v220, v220
    v_mfma_f32_16x16x32_bf16 v[186:189], v[94:97], v[170:173], v[186:189]
    v_sub_f32 v221, v221, v254
    v_sub_f32 v126, v126, v254
    v_mfma_f32_16x16x32_bf16 v[186:189], v[98:101], v[154:157], v[186:189]
    v_exp_f32 v221, v221
    v_mfma_f32_16x16x32_bf16 v[186:189], v[102:105], v[210:213], v[186:189]
    v_cvt_pk_bf16_f32 v241, v220, v221
    v_sub_f32 v127, v127, v254
    v_mfma_f32_16x16x32_bf16 v[186:189], v[106:109], v[134:137], v[186:189]
    v_exp_f32 v126, v126
    v_mfma_f32_16x16x32_bf16 v[186:189], v[110:113], v[194:197], v[186:189]
    ds_read_b128 v[170:173], v0 offset:20480
    ds_read_b128 v[166:169], v1 offset:20480
    v_mfma_f32_16x16x32_bf16 v[154:157], v[182:185], v[28:31], 0
    ds_read_b128 v[162:165], v0 offset:20608
    ds_read_b128 v[210:213], v1 offset:20608
    v_mfma_f32_16x16x32_bf16 v[154:157], v[118:121], v[28:31], v[154:157]
    v_exp_f32 v127, v127
    v_mfma_f32_16x16x32_bf16 v[134:137], v[182:185], v[230:233], 0
    ds_read_b128 v[226:229], v0 offset:20736
    v_cvt_pk_bf16_f32 v36, v126, v127
    v_mfma_f32_16x16x32_bf16 v[134:137], v[118:121], v[214:217], v[134:137]
    ds_read_b128 v[218:221], v1 offset:20736
    v_sub_f32 v128, v128, v254
    v_exp_f32 v128, v128
    v_sub_f32 v129, v129, v254
    v_exp_f32 v129, v129
    v_sub_f32 v242, v242, v254
    v_cvt_pk_bf16_f32 v37, v128, v129
    v_mfma_f32_16x16x32_bf16 v[194:197], v[182:185], v[130:133], 0
    v_exp_f32 v242, v242
    v_mfma_f32_16x16x32_bf16 v[194:197], v[118:121], v[222:225], v[194:197]
    s_waitcnt lgkmcnt(4)
    v_cvt_pk_bf16_f32 v39, v242, 0
    v_cvt_pk_bf16_f32 v125, v200, v201
    v_mfma_f32_16x16x32_bf16 v[198:201], v[182:185], v[114:117], 0
    s_waitcnt lgkmcnt(2)
    ds_write_b128 v3, v[122:125] offset:6144
    v_mfma_f32_16x16x32_bf16 v[126:129], v[28:31], v[36:39], 0
    s_waitcnt lgkmcnt(2)
    v_mul_f32 v206, v174, v206
    v_mul_f32 v207, v174, v207
    v_mfma_f32_16x16x32_bf16 v[126:129], v[28:31], v[238:241], v[126:129]
    s_waitcnt lgkmcnt(1)
    v_cvt_pk_bf16_f32 v206, v206, v207
    v_mul_f32 v208, v174, v208
    v_mfma_f32_16x16x32_bf16 v[122:125], v[214:217], v[36:39], 0
    v_mul_f32 v209, v174, v209
    v_cvt_pk_bf16_f32 v207, v208, v209
    v_mfma_f32_16x16x32_bf16 v[122:125], v[230:233], v[238:241], v[122:125]
    ds_write_b64 v4, v[206:207] offset:10240
    v_mfma_f32_16x16x32_bf16 v[230:233], v[222:225], v[36:39], 0
    v_rcp_f32 v126, v126
    v_mfma_f32_16x16x32_bf16 v[230:233], v[130:133], v[238:241], v[230:233]
    v_fma_f32 v254, v146, v146, s33
    v_fmac_f32 v254, v147, v147
    v_mfma_f32_16x16x32_bf16 v[174:177], v[234:237], v[36:39], 0
    v_fmac_f32 v254, v148, v148
    v_mul_f32 v122, v126, v122
    v_mfma_f32_16x16x32_bf16 v[174:177], v[114:117], v[238:241], v[174:177]
    v_mul_f32 v123, v126, v123
    v_cvt_pk_bf16_f32 v122, v122, v123
    v_mfma_f32_16x16x32_bf16 v[198:201], v[118:121], v[234:237], v[198:201]
    v_mul_f32 v124, v126, v124
    v_mul_f32 v125, v126, v125
    v_mfma_f32_16x16x32_bf16 v[114:117], a[72:75], v[170:173], 0
    v_cvt_pk_bf16_f32 v123, v124, v125
    v_mul_f32 v230, v126, v230
    v_mfma_f32_16x16x32_bf16 v[114:117], a[76:79], v[166:169], v[114:117]
    v_mul_f32 v231, v126, v231
    v_cvt_pk_bf16_f32 v124, v230, v231
    v_mfma_f32_16x16x32_bf16 v[114:117], a[80:83], v[162:165], v[114:117]
    v_mul_f32 v232, v126, v232
    v_mul_f32 v233, v126, v233
    v_mfma_f32_16x16x32_bf16 v[114:117], a[84:87], v[210:213], v[114:117]
    v_cvt_pk_bf16_f32 v125, v232, v233
    v_mul_f32 v174, v126, v174
    v_mfma_f32_16x16x32_bf16 v[114:117], a[88:91], v[226:229], v[114:117]
    ds_write_b128 v3, v[122:125] offset:12288
    v_mfma_f32_16x16x32_bf16 v[114:117], a[92:95], v[218:221], v[114:117]
    v_mul_f32 v175, v126, v175
    v_cvt_pk_bf16_f32 v174, v174, v175
    v_mfma_f32_16x16x32_bf16 v[122:125], a[96:99], v[170:173], 0
    v_mul_f32 v176, v126, v176
    v_mul_f32 v177, v126, v177
    v_mfma_f32_16x16x32_bf16 v[122:125], a[100:103], v[166:169], v[122:125]
    v_cvt_pk_bf16_f32 v175, v176, v177
    v_fmac_f32 v254, v149, v149
    v_mfma_f32_16x16x32_bf16 v[122:125], a[104:107], v[162:165], v[122:125]
    ds_write_b64 v4, v[174:175] offset:16384
    v_mfma_f32_16x16x32_bf16 v[122:125], a[108:111], v[210:213], v[122:125]
    v_fmac_f32 v254, v138, v138
    v_fmac_f32 v254, v139, v139
    v_mfma_f32_16x16x32_bf16 v[122:125], a[112:115], v[226:229], v[122:125]
    v_fmac_f32 v254, v140, v140
    v_fmac_f32 v254, v141, v141
    v_mfma_f32_16x16x32_bf16 v[122:125], a[116:119], v[218:221], v[122:125]
    v_fmac_f32 v254, v186, v186
    v_fmac_f32 v254, v187, v187
    v_mfma_f32_16x16x32_bf16 v[126:129], a[120:123], v[170:173], 0
    v_fmac_f32 v254, v188, v188
    v_fmac_f32 v254, v189, v189
    v_mfma_f32_16x16x32_bf16 v[126:129], a[124:127], v[166:169], v[126:129]
    v_cvt_pk_bf16_f32 v135, v254, v254
    v_fmac_f32 v255, v153, v153
    v_mfma_f32_16x16x32_bf16 v[126:129], a[128:131], v[162:165], v[126:129]
    v_rcp_f32 v154, v154
    v_mfma_f32_16x16x32_bf16 v[126:129], a[132:135], v[210:213], v[126:129]
    v_mul_f32 v134, v134, v154
    v_mul_f32_dpp v134, v194, v154 quad_perm:[0,1,2,3] row_mask:0x2 bank_mask:0xf
    v_mfma_f32_16x16x32_bf16 v[126:129], a[136:139], v[226:229], v[126:129]
    v_mul_f32_dpp v134, v198, v154 quad_perm:[0,1,2,3] row_mask:0x4 bank_mask:0xf
    v_cvt_pk_bf16_f32 v134, v134, v134
    v_mfma_f32_16x16x32_bf16 v[126:129], a[140:143], v[218:221], v[126:129]
    ds_write_b16 v7, v134
    v_mfma_f32_16x16x32_bf16 v[154:157], a[0:3], v[170:173], 0
    v_fmac_f32 v255, v190, v190
    v_fmac_f32 v255, v191, v191
    v_mfma_f32_16x16x32_bf16 v[154:157], a[4:7], v[166:169], v[154:157]
    v_fmac_f32 v255, v192, v192
    v_fmac_f32 v255, v193, v193
    v_mfma_f32_16x16x32_bf16 v[154:157], a[8:11], v[162:165], v[154:157]
    v_fmac_f32 v255, v202, v202
    v_fmac_f32 v255, v203, v203
    v_mfma_f32_16x16x32_bf16 v[154:157], a[12:15], v[210:213], v[154:157]
    v_fmac_f32 v255, v204, v204
    v_fmac_f32 v255, v205, v205
    v_mfma_f32_16x16x32_bf16 v[154:157], a[16:19], v[226:229], v[154:157]
    v_fma_f32 v254, v142, v142, s33
    v_fmac_f32 v254, v143, v143
    v_mfma_f32_16x16x32_bf16 v[154:157], a[20:23], v[218:221], v[154:157]
    v_fmac_f32 v254, v144, v144
    v_fmac_f32 v254, v145, v145
    v_mfma_f32_16x16x32_bf16 v[174:177], a[24:27], v[170:173], 0
    v_fmac_f32 v254, v158, v158
    v_fmac_f32 v254, v159, v159
    v_mfma_f32_16x16x32_bf16 v[174:177], a[28:31], v[166:169], v[174:177]
    v_fmac_f32 v254, v160, v160
    v_fmac_f32 v254, v161, v161
    v_mfma_f32_16x16x32_bf16 v[174:177], a[32:35], v[162:165], v[174:177]
    v_fmac_f32 v254, v178, v178
    v_fmac_f32 v254, v179, v179
    v_mfma_f32_16x16x32_bf16 v[174:177], a[36:39], v[210:213], v[174:177]
    v_fmac_f32 v254, v180, v180
    v_fmac_f32 v254, v181, v181
    v_mfma_f32_16x16x32_bf16 v[174:177], a[40:43], v[226:229], v[174:177]
    v_cvt_pk_bf16_f32 v134, v255, v254
    v_add_u32 v5, 336, v5
    v_mfma_f32_16x16x32_bf16 v[174:177], a[44:47], v[218:221], v[174:177]
    ds_write_b64 v4, v[134:135] offset:18432
    v_mfma_f32_16x16x32_bf16 v[182:185], a[48:51], v[170:173], 0
    v_add_u32 v6, 272, v6
    v_add_u32 v7, 16, v7
    v_mfma_f32_16x16x32_bf16 v[182:185], a[52:55], v[166:169], v[182:185]
    v_fma_f32 v130, v114, v114, s32
    v_fmac_f32 v130, v115, v115
    v_mfma_f32_16x16x32_bf16 v[182:185], a[56:59], v[162:165], v[182:185]
    v_fmac_f32 v130, v116, v116
    v_fmac_f32 v130, v117, v117
    v_mfma_f32_16x16x32_bf16 v[182:185], a[60:63], v[210:213], v[182:185]
    v_fmac_f32 v130, v122, v122
    v_fmac_f32 v130, v123, v123
    v_mfma_f32_16x16x32_bf16 v[182:185], a[64:67], v[226:229], v[182:185]
    v_fmac_f32 v130, v124, v124
    v_fmac_f32 v130, v125, v125
    v_mfma_f32_16x16x32_bf16 v[182:185], a[68:71], v[218:221], v[182:185]
    v_fmac_f32 v130, v126, v126
    v_fmac_f32 v130, v127, v127
    v_mfma_f32_16x16x32_bf16 v[230:233], v[170:173], a[144:147], 0
    s_waitcnt lgkmcnt(0)
    v_fmac_f32 v130, v128, v128
    v_fmac_f32 v130, v129, v129
    v_mfma_f32_16x16x32_bf16 v[230:233], v[166:169], a[148:151], v[230:233]
    s_barrier
    v_fma_f32 v131, v154, v154, s32
    v_fmac_f32 v131, v155, v155
    v_mfma_f32_16x16x32_bf16 v[230:233], v[162:165], a[152:155], v[230:233]
    v_fmac_f32 v131, v156, v156
    v_fmac_f32 v131, v157, v157
    v_mfma_f32_16x16x32_bf16 v[230:233], v[210:213], a[156:159], v[230:233]
    s_nop 0
    v_fmac_f32 v131, v174, v174
    v_xor_b32 v2, 65536, v2
    v_mfma_f32_16x16x32_bf16 v[230:233], v[226:229], a[160:163], v[230:233]
    s_nop 0
    v_xor_b32 v3, 65536, v3
    v_xor_b32 v4, 65536, v4
    v_mfma_f32_16x16x32_bf16 v[230:233], v[218:221], a[164:167], v[230:233]
    s_cbranch_scc1 L_loop_safe0
    s_branch L_final_safe
.p2align 6
L_loop_safe1:
    v_mfma_f32_16x16x32_bf16 v[194:197], v[170:173], a[168:171], 0
    s_add_u32 s12, s42, s27
    ds_read_b128 v[198:201], v2 offset:18432
    ds_read_b128 v[214:217], v2 offset:19456
    v_mfma_f32_16x16x32_bf16 v[194:197], v[166:169], a[172:175], v[194:197]
    s_addc_u32 s13, s43, 0
    v_fmac_f32 v131, v175, v175
    v_fmac_f32 v131, v176, v176
    v_mfma_f32_16x16x32_bf16 v[194:197], v[162:165], a[176:179], v[194:197]
    s_sub_u32 s14, s36, s27
    v_fmac_f32 v131, v177, v177
    v_fmac_f32 v131, v182, v182
    v_mfma_f32_16x16x32_bf16 v[194:197], v[210:213], a[180:183], v[194:197]
    s_cmp_ge_u32 s18, 2
    v_fmac_f32 v131, v183, v183
    v_fmac_f32 v131, v184, v184
    v_mfma_f32_16x16x32_bf16 v[194:197], v[226:229], a[184:187], v[194:197]
    s_cselect_b32 s14, s14, 0
    ds_read_b128 v[118:121], v0 offset:26624
    v_fmac_f32 v131, v185, v185
    v_mfma_f32_16x16x32_bf16 v[194:197], v[218:221], a[188:191], v[194:197]
    s_add_u32 s34, s18, 2
    ds_read_b128 v[134:137], v1 offset:26624
    v_cvt_pk_bf16_f32 v36, v131, v130
    v_mfma_f32_16x16x32_bf16 v[234:237], v[170:173], a[192:195], 0
    s_add_u32 s8, s40, s23
    ds_read_b128 v[170:173], v0 offset:26752
    v_cvt_pk_bf16_f32 v230, v230, v231
    v_mfma_f32_16x16x32_bf16 v[234:237], v[166:169], a[196:199], v[234:237]
    s_addc_u32 s9, s41, 0
    ds_read_b128 v[166:169], v1 offset:26752
    v_cvt_pk_bf16_f32 v231, v232, v233
    v_mfma_f32_16x16x32_bf16 v[222:225], v[32:35], v[36:39], 0
    s_sub_u32 s10, s36, s23
    v_cvt_pk_bf16_f32 v130, v194, v195
    v_cvt_pk_bf16_f32 v131, v196, v197
    v_mfma_f32_16x16x32_bf16 v[234:237], v[162:165], a[200:203], v[234:237]
    s_waitcnt lgkmcnt(4)
    ds_read_b128 v[194:197], v0 offset:26880
    s_cmp_lt_u32 s34, s17
    v_mfma_f32_16x16x32_bf16 v[206:209], v[32:35], v[198:201], 0
    s_cselect_b32 s10, s10, 0
    v_rsq_f32 v223, v223
    v_mfma_f32_16x16x32_bf16 v[206:209], v[32:35], v[214:217], v[206:209]
    s_add_u32 m0, s28, 0
    v_rsq_f32 v222, v222
    v_mfma_f32_16x16x32_bf16 v[234:237], v[210:213], a[204:207], v[234:237]
    s_waitcnt lgkmcnt(4)
    ds_read_b128 v[198:201], v1 offset:26880
    v_mul_f32 v222, s31, v222
    v_mfma_f32_16x16x32_bf16 v[234:237], v[226:229], a[208:211], v[234:237]
    s_mov_b32 s27, s26
    v_mul_f32 v114, v223, v114
    v_mul_f32 v115, v223, v115
    v_mfma_f32_16x16x32_bf16 v[234:237], v[218:221], a[212:215], v[234:237]
    s_mov_b32 s26, s25
    v_cvt_pk_f16_f32 v218, v114, v115
    v_mul_f32 v116, v223, v116
    v_mfma_f32_16x16x32_bf16 v[226:229], a[72:75], v[118:121], 0
    s_waitcnt lgkmcnt(2)
    v_mul_f32 v117, v223, v117
    v_cvt_pk_f16_f32 v219, v116, v117
    v_mfma_f32_16x16x32_bf16 v[226:229], a[76:79], v[134:137], v[226:229]
    s_mov_b32 s25, s24
    v_cvt_pk_bf16_f32 v114, v234, v235
    v_cvt_pk_bf16_f32 v115, v236, v237
    v_mfma_f32_16x16x32_bf16 v[226:229], a[80:83], v[170:173], v[226:229]
    s_mov_b32 s24, s23
    v_mul_f32 v122, v223, v122
    v_mul_f32 v123, v223, v123
    v_mfma_f32_16x16x32_bf16 v[226:229], a[84:87], v[166:169], v[226:229]
    s_waitcnt lgkmcnt(1)
    v_cvt_pk_f16_f32 v220, v122, v123
    v_mul_f32 v124, v223, v124
    v_mfma_f32_16x16x32_bf16 v[226:229], a[88:91], v[194:197], v[226:229]
    v_mul_f32 v125, v223, v125
    v_cvt_pk_f16_f32 v221, v124, v125
    v_mfma_f32_16x16x32_bf16 v[122:125], a[96:99], v[118:121], 0
    s_waitcnt lgkmcnt(0)
    v_mul_f32 v126, v223, v126
    v_mul_f32 v127, v223, v127
    v_mfma_f32_16x16x32_bf16 v[226:229], a[92:95], v[198:201], v[226:229]
    v_cvt_pk_f16_f32 v164, v126, v127
    v_mul_f32 v128, v223, v128
    v_mfma_f32_16x16x32_bf16 v[122:125], a[100:103], v[134:137], v[122:125]
    v_mul_f32 v129, v223, v129
    v_cvt_pk_f16_f32 v165, v128, v129
    v_mfma_f32_16x16x32_bf16 v[122:125], a[104:107], v[170:173], v[122:125]
    v_mul_f32 v154, v222, v154
    v_mul_f32 v155, v222, v155
    v_mfma_f32_16x16x32_bf16 v[122:125], a[108:111], v[166:169], v[122:125]
    v_cvt_pk_f16_f32 v210, v154, v155
    v_mul_f32 v156, v222, v156
    v_mfma_f32_16x16x32_bf16 v[122:125], a[112:115], v[194:197], v[122:125]
    v_mul_f32 v157, v222, v157
    v_cvt_pk_f16_f32 v211, v156, v157
    v_mfma_f32_16x16x32_bf16 v[122:125], a[116:119], v[198:201], v[122:125]
    v_mul_f32 v174, v222, v174
    v_mul_f32 v175, v222, v175
    v_mfma_f32_16x16x32_bf16 v[126:129], a[120:123], v[118:121], 0
    v_cvt_pk_f16_f32 v212, v174, v175
    v_mul_f32 v176, v222, v176
    v_mfma_f32_16x16x32_bf16 v[126:129], a[124:127], v[134:137], v[126:129]
    v_mul_f32 v177, v222, v177
    v_cvt_pk_f16_f32 v213, v176, v177
    v_mfma_f32_16x16x32_bf16 v[126:129], a[128:131], v[170:173], v[126:129]
    v_mul_f32 v182, v222, v182
    v_mul_f32 v183, v222, v183
    v_mfma_f32_16x16x32_bf16 v[126:129], a[132:135], v[166:169], v[126:129]
    v_cvt_pk_f16_f32 v162, v182, v183
    v_mul_f32 v184, v222, v184
    v_mfma_f32_16x16x32_bf16 v[126:129], a[136:139], v[194:197], v[126:129]
    v_mul_f32 v185, v222, v185
    v_cvt_pk_f16_f32 v163, v184, v185
    v_mfma_f32_16x16x32_bf16 v[126:129], a[140:143], v[198:201], v[126:129]
    v_fma_f32 v116, v226, v226, s32
    v_fmac_f32 v116, v227, v227
    v_mfma_f32_16x16x32_bf16 v[154:157], a[0:3], v[118:121], 0
    v_fmac_f32 v116, v228, v228
    v_fmac_f32 v116, v229, v229
    v_mfma_f32_16x16x32_bf16 v[154:157], a[4:7], v[134:137], v[154:157]
    v_fmac_f32 v116, v122, v122
    v_fmac_f32 v116, v123, v123
    v_mfma_f32_16x16x32_bf16 v[154:157], a[8:11], v[170:173], v[154:157]
    v_fmac_f32 v116, v124, v124
    v_fmac_f32 v116, v125, v125
    v_mfma_f32_16x16x32_bf16 v[154:157], a[12:15], v[166:169], v[154:157]
    v_fmac_f32 v116, v126, v126
    v_fmac_f32 v116, v127, v127
    v_mfma_f32_16x16x32_bf16 v[154:157], a[16:19], v[194:197], v[154:157]
    v_fmac_f32 v116, v128, v128
    v_fmac_f32 v116, v129, v129
    v_mfma_f32_16x16x32_bf16 v[154:157], a[20:23], v[198:201], v[154:157]
    v_mul_f32 v117, 0x3baaaaab, v206
    v_mul_f32 v254, 0x3baaaaab, v207
    v_mfma_f32_16x16x32_bf16 v[174:177], a[24:27], v[118:121], 0
    v_rsq_f32 v117, v117
    v_mfma_f32_16x16x32_bf16 v[174:177], a[28:31], v[134:137], v[174:177]
    v_rsq_f32 v254, v254
    v_mfma_f32_16x16x32_bf16 v[174:177], a[32:35], v[170:173], v[174:177]
    v_mul_f32 v255, 0x3baaaaab, v208
    v_fma_f32 v132, v154, v154, s32
    v_mfma_f32_16x16x32_bf16 v[174:177], a[36:39], v[166:169], v[174:177]
    v_fmac_f32 v132, v155, v155
    v_fmac_f32 v132, v156, v156
    v_mfma_f32_16x16x32_bf16 v[174:177], a[40:43], v[194:197], v[174:177]
    v_fmac_f32 v132, v157, v157
    v_mul_f32 v150, v117, v150
    v_mfma_f32_16x16x32_bf16 v[174:177], a[44:47], v[198:201], v[174:177]
    v_rsq_f32 v255, v255
    v_mfma_f32_16x16x32_bf16 v[182:185], a[48:51], v[118:121], 0
    v_mul_f32 v151, v117, v151
    v_cvt_pk_bf16_f32 v214, v150, v151
    v_mfma_f32_16x16x32_bf16 v[182:185], a[52:55], v[134:137], v[182:185]
    v_mul_f32 v152, v117, v152
    v_mul_f32 v153, v117, v153
    v_mfma_f32_16x16x32_bf16 v[182:185], a[56:59], v[170:173], v[182:185]
    v_fmac_f32 v132, v174, v174
    v_fmac_f32 v132, v175, v175
    v_mfma_f32_16x16x32_bf16 v[182:185], a[60:63], v[166:169], v[182:185]
    v_fmac_f32 v132, v176, v176
    v_fmac_f32 v132, v177, v177
    v_mfma_f32_16x16x32_bf16 v[182:185], a[64:67], v[194:197], v[182:185]
    v_cvt_pk_bf16_f32 v215, v152, v153
    v_mul_f32 v190, v117, v190
    v_mfma_f32_16x16x32_bf16 v[182:185], a[68:71], v[198:201], v[182:185]
    v_mul_f32 v191, v117, v191
    v_cvt_pk_bf16_f32 v216, v190, v191
    v_mfma_f32_16x16x32_bf16 v[150:153], v[118:121], a[144:147], 0
    v_mul_f32 v192, v117, v192
    v_mul_f32 v193, v117, v193
    v_mfma_f32_16x16x32_bf16 v[150:153], v[134:137], a[148:151], v[150:153]
    v_cvt_pk_bf16_f32 v217, v192, v193
    v_mul_f32 v202, v117, v202
    v_mfma_f32_16x16x32_bf16 v[150:153], v[170:173], a[152:155], v[150:153]
    buffer_store_dwordx4 v[214:217], v15, s[12:15], 0 offen nt
    v_fmac_f32 v132, v182, v182
    v_fmac_f32 v132, v183, v183
    v_fmac_f32 v132, v184, v184
    v_fmac_f32 v132, v185, v185
    v_mfma_f32_16x16x32_bf16 v[150:153], v[166:169], a[156:159], v[150:153]
    v_cvt_pk_bf16_f32 v36, v132, v116
    v_mul_f32 v203, v117, v203
    v_mfma_f32_16x16x32_bf16 v[150:153], v[194:197], a[160:163], v[150:153]
    v_cvt_pk_bf16_f32 v116, v202, v203
    v_mul_f32 v204, v117, v204
    v_mfma_f32_16x16x32_bf16 v[190:193], v[32:35], v[36:39], 0
    v_mul_f32 v205, v117, v205
    v_cvt_pk_bf16_f32 v117, v204, v205
    v_mfma_f32_16x16x32_bf16 v[150:153], v[198:201], a[164:167], v[150:153]
    v_mul_f32 v146, v255, v146
    v_mul_f32 v147, v255, v147
    v_mfma_f32_16x16x32_bf16 v[202:205], v[118:121], a[168:171], 0
    v_cvt_pk_bf16_f32 v146, v146, v147
    v_mul_f32 v148, v255, v148
    v_mfma_f32_16x16x32_bf16 v[202:205], v[134:137], a[172:175], v[202:205]
    v_rsq_f32 v191, v191
    v_mfma_f32_16x16x32_bf16 v[202:205], v[170:173], a[176:179], v[202:205]
    v_cvt_pk_bf16_f32 v232, v150, v151
    v_cvt_pk_bf16_f32 v233, v152, v153
    v_mfma_f32_16x16x32_bf16 v[202:205], v[166:169], a[180:183], v[202:205]
    v_rsq_f32 v190, v190
    v_mfma_f32_16x16x32_bf16 v[202:205], v[194:197], a[184:187], v[202:205]
    ds_read_b128 v[150:153], v0 offset:32768
    v_mul_f32 v190, s31, v190
    v_mfma_f32_16x16x32_bf16 v[202:205], v[198:201], a[188:191], v[202:205]
    ds_read_b128 v[206:209], v1 offset:32768
    v_mul_f32 v226, v191, v226
    v_mfma_f32_16x16x32_bf16 v[214:217], v[118:121], a[192:195], 0
    ds_read_b128 v[118:121], v0 offset:32896
    v_mul_f32 v227, v191, v227
    v_mfma_f32_16x16x32_bf16 v[214:217], v[134:137], a[196:199], v[214:217]
    ds_read_b128 v[134:137], v1 offset:32896
    v_cvt_pk_f16_f32 v226, v226, v227
    v_mfma_f32_16x16x32_bf16 v[214:217], v[170:173], a[200:203], v[214:217]
    ds_read_b128 v[170:173], v0 offset:33024
    v_cvt_pk_bf16_f32 v132, v202, v203
    v_mfma_f32_16x16x32_bf16 v[214:217], v[166:169], a[204:207], v[214:217]
    ds_read_b128 v[166:169], v1 offset:33024
    v_cvt_pk_bf16_f32 v133, v204, v205
    v_mfma_f32_16x16x32_bf16 v[214:217], v[194:197], a[208:211], v[214:217]
    v_mul_f32 v228, v191, v228
    v_mul_f32 v229, v191, v229
    v_mfma_f32_16x16x32_bf16 v[214:217], v[198:201], a[212:215], v[214:217]
    v_cvt_pk_f16_f32 v227, v228, v229
    v_mul_f32 v122, v191, v122
    v_mfma_f32_16x16x32_f16 v[194:197], v[218:221], v[210:213], v[46:49]
    s_waitcnt lgkmcnt(5)
    buffer_store_dwordx2 v[116:117], v18, s[12:15], 0 offen nt
    v_mul_f32 v123, v191, v123
    v_cvt_pk_f16_f32 v228, v122, v123
    v_mfma_f32_16x16x32_bf16 v[202:205], a[72:75], v[150:153], 0
    s_waitcnt lgkmcnt(3)
    v_cvt_pk_bf16_f32 v116, v214, v215
    v_cvt_pk_bf16_f32 v117, v216, v217
    v_mfma_f32_16x16x32_bf16 v[202:205], a[76:79], v[206:209], v[202:205]
    s_waitcnt lgkmcnt(2)
    v_mul_f32 v124, v191, v124
    v_mul_f32 v125, v191, v125
    v_mfma_f32_16x16x32_bf16 v[202:205], a[80:83], v[118:121], v[202:205]
    s_waitcnt lgkmcnt(1)
    v_cvt_pk_f16_f32 v229, v124, v125
    v_mul_f32 v126, v191, v126
    v_mfma_f32_16x16x32_bf16 v[202:205], a[84:87], v[134:137], v[202:205]
    s_waitcnt lgkmcnt(0)
    v_mul_f32 v127, v191, v127
    v_cvt_pk_f16_f32 v124, v126, v127
    v_mfma_f32_16x16x32_bf16 v[202:205], a[88:91], v[170:173], v[202:205]
    v_mul_f32 v128, v191, v128
    v_mul_f32 v129, v191, v129
    v_mfma_f32_16x16x32_bf16 v[202:205], a[92:95], v[166:169], v[202:205]
    v_cvt_pk_f16_f32 v125, v128, v129
    v_mul_f32 v154, v190, v154
    v_mfma_f32_16x16x32_bf16 v[126:129], a[96:99], v[150:153], 0
    v_mul_f32 v155, v190, v155
    v_cvt_pk_f16_f32 v154, v154, v155
    v_mfma_f32_16x16x32_bf16 v[126:129], a[100:103], v[206:209], v[126:129]
    v_mul_f32 v156, v190, v156
    v_mul_f32 v157, v190, v157
    v_mfma_f32_16x16x32_bf16 v[126:129], a[104:107], v[118:121], v[126:129]
    v_cvt_pk_f16_f32 v155, v156, v157
    v_mul_f32 v174, v190, v174
    v_mfma_f32_16x16x32_bf16 v[126:129], a[108:111], v[134:137], v[126:129]
    v_mul_f32 v175, v190, v175
    v_cvt_pk_f16_f32 v156, v174, v175
    v_mfma_f32_16x16x32_bf16 v[126:129], a[112:115], v[170:173], v[126:129]
    v_mul_f32 v176, v190, v176
    v_mul_f32 v177, v190, v177
    v_mfma_f32_16x16x32_bf16 v[126:129], a[116:119], v[166:169], v[126:129]
    v_cvt_pk_f16_f32 v157, v176, v177
    v_mul_f32 v182, v190, v182
    v_mfma_f32_16x16x32_bf16 v[174:177], a[120:123], v[150:153], 0
    v_mul_f32 v183, v190, v183
    v_cvt_pk_f16_f32 v122, v182, v183
    v_mfma_f32_16x16x32_bf16 v[174:177], a[124:127], v[206:209], v[174:177]
    v_mul_f32 v184, v190, v184
    v_mul_f32 v185, v190, v185
    v_mfma_f32_16x16x32_bf16 v[174:177], a[128:131], v[118:121], v[174:177]
    v_cvt_pk_f16_f32 v123, v184, v185
    v_fma_f32 v182, v202, v202, s32
    v_mfma_f32_16x16x32_bf16 v[174:177], a[132:135], v[134:137], v[174:177]
    v_fmac_f32 v182, v203, v203
    v_fmac_f32 v182, v204, v204
    v_mfma_f32_16x16x32_bf16 v[174:177], a[136:139], v[170:173], v[174:177]
    v_fmac_f32 v182, v205, v205
    v_fmac_f32 v182, v126, v126
    v_mfma_f32_16x16x32_bf16 v[174:177], a[140:143], v[166:169], v[174:177]
    v_fmac_f32 v182, v127, v127
    v_fmac_f32 v182, v128, v128
    v_mfma_f32_16x16x32_bf16 v[190:193], a[0:3], v[150:153], 0
    v_fmac_f32 v182, v129, v129
    v_mul_f32 v149, v255, v149
    v_mfma_f32_16x16x32_bf16 v[190:193], a[4:7], v[206:209], v[190:193]
    v_cvt_pk_bf16_f32 v147, v148, v149
    v_mul_f32 v138, v255, v138
    v_mfma_f32_16x16x32_bf16 v[190:193], a[8:11], v[118:121], v[190:193]
    v_fmac_f32 v182, v174, v174
    v_fmac_f32 v182, v175, v175
    v_mfma_f32_16x16x32_bf16 v[190:193], a[12:15], v[134:137], v[190:193]
    v_fmac_f32 v182, v176, v176
    v_fmac_f32 v182, v177, v177
    v_mfma_f32_16x16x32_bf16 v[190:193], a[16:19], v[170:173], v[190:193]
    v_mul_f32 v139, v255, v139
    v_cvt_pk_bf16_f32 v148, v138, v139
    v_mfma_f32_16x16x32_bf16 v[190:193], a[20:23], v[166:169], v[190:193]
    v_mul_f32 v140, v255, v140
    v_mul_f32 v141, v255, v141
    v_mfma_f32_16x16x32_bf16 v[198:201], a[24:27], v[150:153], 0
    v_cvt_pk_bf16_f32 v149, v140, v141
    v_mul_f32 v186, v255, v186
    v_mfma_f32_16x16x32_bf16 v[198:201], a[28:31], v[206:209], v[198:201]
    buffer_store_dwordx4 v[146:149], v17, s[12:15], 0 offen nt
    v_mul_f32 v187, v255, v187
    v_fma_f32 v183, v190, v190, s32
    v_fmac_f32 v183, v191, v191
    v_fmac_f32 v183, v192, v192
    v_mfma_f32_16x16x32_bf16 v[198:201], a[32:35], v[118:121], v[198:201]
    v_fmac_f32 v183, v193, v193
    v_cvt_pk_bf16_f32 v184, v186, v187
    v_mfma_f32_16x16x32_bf16 v[198:201], a[36:39], v[134:137], v[198:201]
    v_mul_f32 v188, v255, v188
    v_mul_f32 v189, v255, v189
    v_mfma_f32_16x16x32_bf16 v[198:201], a[40:43], v[170:173], v[198:201]
    v_cvt_pk_bf16_f32 v185, v188, v189
    v_mul_f32 v142, v254, v142
    v_mfma_f32_16x16x32_bf16 v[198:201], a[44:47], v[166:169], v[198:201]
    v_mul_f32 v143, v254, v143
    v_cvt_pk_bf16_f32 v142, v142, v143
    v_mfma_f32_16x16x32_bf16 v[138:141], a[48:51], v[150:153], 0
    v_mul_f32 v144, v254, v144
    v_mul_f32 v145, v254, v145
    v_mfma_f32_16x16x32_bf16 v[138:141], a[52:55], v[206:209], v[138:141]
    v_cvt_pk_bf16_f32 v143, v144, v145
    v_mul_f32 v158, v254, v158
    v_mfma_f32_16x16x32_bf16 v[138:141], a[56:59], v[118:121], v[138:141]
    v_fmac_f32 v183, v198, v198
    v_fmac_f32 v183, v199, v199
    v_mfma_f32_16x16x32_bf16 v[138:141], a[60:63], v[134:137], v[138:141]
    ds_read2_b32 v[216:217], v6 offset0:0 offset1:0
    ds_read2_b32 v[224:225], v6 offset0:16 offset1:16
    v_mfma_f32_16x16x32_bf16 v[138:141], a[64:67], v[170:173], v[138:141]
    ds_read2_b32 v[236:237], v6 offset0:32 offset1:32
    v_fmac_f32 v183, v200, v200
    v_mfma_f32_16x16x32_bf16 v[138:141], a[68:71], v[166:169], v[138:141]
    v_fmac_f32 v183, v201, v201
    v_mul_f32 v159, v254, v159
    v_mfma_f32_16x16x32_bf16 v[146:149], v[150:153], a[144:147], 0
    v_cvt_pk_bf16_f32 v144, v158, v159
    v_mul_f32 v160, v254, v160
    v_mfma_f32_16x16x32_bf16 v[146:149], v[206:209], a[148:151], v[146:149]
    v_mul_f32 v161, v254, v161
    v_cvt_pk_bf16_f32 v145, v160, v161
    v_mfma_f32_16x16x32_bf16 v[146:149], v[118:121], a[152:155], v[146:149]
    v_fmac_f32 v183, v138, v138
    v_fmac_f32 v183, v139, v139
    v_mfma_f32_16x16x32_bf16 v[146:149], v[134:137], a[156:159], v[146:149]
    v_fmac_f32 v183, v140, v140
    v_fmac_f32 v183, v141, v141
    v_mfma_f32_16x16x32_bf16 v[146:149], v[170:173], a[160:163], v[146:149]
    v_cvt_pk_bf16_f32 v36, v183, v182
    v_mul_f32 v178, v254, v178
    v_mfma_f32_16x16x32_bf16 v[146:149], v[166:169], a[164:167], v[146:149]
    s_waitcnt lgkmcnt(1)
    v_mul_f32 v179, v254, v179
    v_cvt_pk_bf16_f32 v178, v178, v179
    v_mfma_f32_16x16x32_bf16 v[158:161], v[32:35], v[36:39], 0
    s_waitcnt lgkmcnt(0)
    buffer_store_dwordx2 v[184:185], v20, s[12:15], 0 offen nt
    v_mul_f32 v180, v254, v180
    v_mul_f32 v181, v254, v181
    v_mfma_f32_16x16x32_bf16 v[186:189], v[150:153], a[168:171], 0
    v_cvt_pk_bf16_f32 v214, v146, v147
    v_cvt_pk_bf16_f32 v215, v148, v149
    v_mfma_f32_16x16x32_bf16 v[186:189], v[206:209], a[172:175], v[186:189]
    v_rsq_f32 v159, v159
    v_mfma_f32_16x16x32_bf16 v[186:189], v[118:121], a[176:179], v[186:189]
    v_rsq_f32 v158, v158
    v_mfma_f32_16x16x32_bf16 v[186:189], v[134:137], a[180:183], v[186:189]
    v_mul_f32 v158, s31, v158
    v_mul_f32 v202, v159, v202
    v_mfma_f32_16x16x32_bf16 v[186:189], v[170:173], a[184:187], v[186:189]
    v_mul_f32 v203, v159, v203
    v_cvt_pk_f16_f32 v146, v202, v203
    v_mfma_f32_16x16x32_bf16 v[186:189], v[166:169], a[188:191], v[186:189]
    v_mul_f32 v204, v159, v204
    v_mul_f32 v205, v159, v205
    v_mfma_f32_16x16x32_bf16 v[182:185], v[150:153], a[192:195], 0
    v_cvt_pk_f16_f32 v147, v204, v205
    v_mul_f32 v126, v159, v126
    v_mfma_f32_16x16x32_bf16 v[182:185], v[206:209], a[196:199], v[182:185]
    ds_read_b128 v[150:153], v5 offset:0
    ds_read_b128 v[202:205], v5 offset:16
    v_mfma_f32_16x16x32_bf16 v[182:185], v[118:121], a[200:203], v[182:185]
    ds_read_b128 v[118:121], v5 offset:48
    ds_read_b32 v254, v6 offset:192
    v_mfma_f32_16x16x32_bf16 v[182:185], v[134:137], a[204:207], v[182:185]
    v_cvt_pk_bf16_f32 v222, v186, v187
    v_cvt_pk_bf16_f32 v223, v188, v189
    v_mfma_f32_16x16x32_bf16 v[182:185], v[170:173], a[208:211], v[182:185]
    v_mul_f32 v127, v159, v127
    v_cvt_pk_f16_f32 v148, v126, v127
    v_mfma_f32_16x16x32_bf16 v[182:185], v[166:169], a[212:215], v[182:185]
    ds_read_b128 v[166:169], v2 offset:0
    ds_read_b128 v[170:173], v2 offset:1024
    v_mfma_f32_16x16x32_f16 v[186:189], v[226:229], v[210:213], v[50:53]
    ds_read_b128 v[134:137], v2 offset:2048
    v_mul_f32 v128, v159, v128
    v_mul_f32 v129, v159, v129
    v_mfma_f32_16x16x16_f16 v[194:197], v[164:165], v[162:163], v[194:197]
    v_cvt_pk_f16_f32 v149, v128, v129
    v_cvt_pk_bf16_f32 v234, v182, v183
    v_cvt_pk_bf16_f32 v235, v184, v185
    v_mul_f32 v174, v159, v174
    v_mfma_f32_16x16x32_f16 v[126:129], v[146:149], v[210:213], v[54:57]
    s_waitcnt lgkmcnt(5)
    v_mul_f32 v175, v159, v175
    v_cvt_pk_f16_f32 v184, v174, v175
    v_mul_f32 v176, v159, v176
    v_mfma_f32_16x16x16_f16 v[186:189], v[124:125], v[162:163], v[186:189]
    v_mul_f32 v177, v159, v177
    v_cvt_pk_f16_f32 v185, v176, v177
    v_mul_f32 v190, v158, v190
    v_mul_f32 v191, v158, v191
    v_mfma_f32_16x16x16_f16 v[126:129], v[184:185], v[162:163], v[126:129]
    v_cvt_pk_f16_f32 v174, v190, v191
    v_mul_f32 v192, v158, v192
    v_mul_f32 v193, v158, v193
    v_cvt_pk_f16_f32 v175, v192, v193
    v_mfma_f32_16x16x32_f16 v[206:209], v[150:153], v[210:213], v[22:25]
    s_waitcnt lgkmcnt(2)
    ds_read_b128 v[210:213], v2 offset:3072
    buffer_store_dwordx4 v[142:145], v16, s[12:15], 0 offen nt
    ds_read_b128 v[238:241], v2 offset:4096
    v_mul_f32 v198, v158, v198
    v_mul_f32 v199, v158, v199
    v_cvt_pk_f16_f32 v176, v198, v199
    v_mfma_f32_16x16x32_f16 v[206:209], v[202:205], v[218:221], v[206:209]
    s_waitcnt lgkmcnt(2)
    v_mul_f32 v200, v158, v200
    v_mul_f32 v201, v158, v201
    v_mfma_f32_16x16x32_f16 v[206:209], v[118:121], v[162:165], v[206:209]
    ds_read_b128 v[142:145], v2 offset:5120
    v_cvt_pk_f16_f32 v177, v200, v201
    v_mul_f32 v138, v158, v138
    v_mul_f32 v139, v158, v139
    v_cvt_pk_f16_f32 v182, v138, v139
    v_mfma_f32_16x16x32_f16 v[198:201], v[150:153], v[154:157], v[24:27]
    v_mul_f32 v140, v158, v140
    v_mul_f32 v141, v158, v141
    v_mfma_f32_16x16x32_f16 v[198:201], v[202:205], v[226:229], v[198:201]
    v_mov_b32_dpp v254, v207 quad_perm:[0,1,2,3] row_mask:0x1 bank_mask:0xf
    v_cvt_pk_f16_f32 v183, v140, v141
    v_mfma_f32_16x16x32_f16 v[198:201], v[118:121], v[122:125], v[198:201]
    v_max3_f32 v255, v206, v194, v195
    v_max3_f32 v255, v255, v196, v197
    v_mfma_f32_16x16x32_f16 v[242:245], v[150:153], v[174:177], v[26:29]
    s_waitcnt lgkmcnt(1)
    v_max3_f32 v255, v255, v186, v187
    v_max3_f32 v255, v255, v188, v189
    v_mfma_f32_16x16x32_f16 v[242:245], v[202:205], v[146:149], v[242:245]
    v_max3_f32 v255, v255, v126, v127
    v_mov_b32_dpp v254, v199 quad_perm:[0,1,2,3] row_mask:0x2 bank_mask:0xf
    v_mfma_f32_16x16x32_f16 v[242:245], v[118:121], v[182:185], v[242:245]
    v_max3_f32 v255, v255, v128, v129
    v_mov_b32 v162, v255
    v_mfma_f32_16x16x32_bf16 v[150:153], a[216:219], v[166:169], 0
    s_waitcnt lgkmcnt(0)
    v_permlane32_swap_b32 v255, v162
    v_mfma_f32_16x16x32_bf16 v[150:153], a[220:223], v[170:173], v[150:153]
    v_max_f32 v255, v255, v162
    v_mov_b32 v162, v255
    v_mfma_f32_16x16x32_bf16 v[150:153], a[224:227], v[134:137], v[150:153]
    v_cvt_pk_bf16_f32 v179, v180, v181
    v_xor_b32 v0, 65536, v0
    v_mfma_f32_16x16x32_bf16 v[150:153], a[228:231], v[210:213], v[150:153]
    s_waitcnt vmcnt(5)
    v_permlane16_swap_b32 v255, v162
    v_mfma_f32_16x16x32_bf16 v[150:153], a[232:235], v[238:241], v[150:153]
    v_max_f32 v255, v255, v162
    v_sub_f32 v194, v194, v255
    v_mfma_f32_16x16x32_bf16 v[150:153], a[236:239], v[142:145], v[150:153]
    s_barrier
    v_exp_f32 v194, v194
    v_mfma_f32_16x16x32_bf16 v[190:193], a[240:243], v[166:169], 0
    v_sub_f32 v195, v195, v255
    v_sub_f32 v196, v196, v255
    v_mfma_f32_16x16x32_bf16 v[190:193], a[244:247], v[170:173], v[190:193]
    buffer_load_dwordx4 v10, s[8:11], 0 offen nt lds
    v_sub_f32 v197, v197, v255
    v_mfma_f32_16x16x32_bf16 v[190:193], a[248:251], v[134:137], v[190:193]
    s_add_u32 m0, s28, 4096
    v_exp_f32 v195, v195
    v_mfma_f32_16x16x32_bf16 v[190:193], a[252:255], v[210:213], v[190:193]
    v_cvt_pk_bf16_f32 v158, v194, v195
    v_sub_f32 v186, v186, v255
    v_mfma_f32_16x16x32_bf16 v[190:193], v[82:85], v[238:241], v[190:193]
    v_exp_f32 v196, v196
    v_mfma_f32_16x16x32_bf16 v[190:193], v[86:89], v[142:145], v[190:193]
    v_exp_f32 v197, v197
    v_mfma_f32_16x16x32_bf16 v[202:205], v[90:93], v[166:169], 0
    ds_read_b128 v[166:169], v2 offset:6144
    buffer_load_dwordx4 v11, s[8:11], 0 offen nt lds
    v_mfma_f32_16x16x32_bf16 v[202:205], v[94:97], v[170:173], v[202:205]
    s_add_u32 m0, s28, 8192
    ds_read_b128 v[170:173], v2 offset:7168
    v_cvt_pk_bf16_f32 v159, v196, v197
    v_mfma_f32_16x16x32_bf16 v[202:205], v[98:101], v[134:137], v[202:205]
    ds_read_b128 v[138:141], v2 offset:8192
    v_sub_f32 v187, v187, v255
    v_mfma_f32_16x16x32_bf16 v[202:205], v[102:105], v[210:213], v[202:205]
    ds_read_b128 v[210:213], v2 offset:9216
    v_sub_f32 v188, v188, v255
    v_mfma_f32_16x16x32_bf16 v[202:205], v[106:109], v[238:241], v[202:205]
    ds_read_b128 v[134:137], v2 offset:10240
    v_sub_f32 v189, v189, v255
    v_mfma_f32_16x16x32_bf16 v[202:205], v[110:113], v[142:145], v[202:205]
    ds_read_b128 v[194:197], v2 offset:11264
    buffer_load_dwordx4 v12, s[8:11], 0 offen nt lds
    v_exp_f32 v186, v186
    v_mfma_f32_16x16x32_f16 v[118:121], v[218:221], v[154:157], v[58:61]
    s_add_u32 m0, s28, 12288
    v_exp_f32 v187, v187
    v_exp_f32 v188, v188
    v_cvt_pk_bf16_f32 v160, v186, v187
    v_exp_f32 v189, v189
    v_sub_f32 v126, v126, v255
    v_mfma_f32_16x16x16_f16 v[118:121], v[164:165], v[122:123], v[118:121]
    v_cvt_pk_bf16_f32 v161, v188, v189
    v_exp_f32 v126, v126
    v_sub_f32 v127, v127, v255
    v_mfma_f32_16x16x32_f16 v[186:189], v[226:229], v[154:157], v[62:65]
    s_xor_b32 s28, s28, 65536
    buffer_load_dwordx4 v13, s[8:11], 0 offen nt lds
    v_exp_f32 v127, v127
    v_sub_f32 v128, v128, v255
    v_cvt_pk_bf16_f32 v36, v126, v127
    v_exp_f32 v128, v128
    v_mfma_f32_16x16x16_f16 v[186:189], v[124:125], v[122:123], v[186:189]
    v_sub_f32 v129, v129, v255
    v_exp_f32 v129, v129
    v_sub_f32 v206, v206, v255
    v_cvt_pk_bf16_f32 v37, v128, v129
    v_mfma_f32_16x16x32_f16 v[126:129], v[146:149], v[154:157], v[66:69]
    s_waitcnt lgkmcnt(0)
    v_exp_f32 v206, v206
    v_mfma_f32_16x16x32_bf16 v[142:145], a[216:219], v[166:169], 0
    s_mov_b32 m0, s29
    v_cvt_pk_bf16_f32 v39, v206, 0
    v_max3_f32 v255, v198, v118, v119
    v_max3_f32 v255, v255, v120, v121
    v_mfma_f32_16x16x16_f16 v[126:129], v[184:185], v[122:123], v[126:129]
    v_max3_f32 v255, v255, v186, v187
    v_max3_f32 v255, v255, v188, v189
    v_xor_b32 v1, 65536, v1
    v_mov_b32_dpp v254, v243 quad_perm:[0,1,2,3] row_mask:0x4 bank_mask:0xf
    v_mfma_f32_16x16x32_bf16 v[154:157], v[28:31], v[36:39], 0
    s_xor_b32 s29, s29, s30
    buffer_store_dwordx2 v[178:179], v19, s[12:15], 0 offen nt
    v_mov_b32 v122, v254
    v_max3_f32 v255, v255, v126, v127
    v_mfma_f32_16x16x32_bf16 v[154:157], v[28:31], v[158:161], v[154:157]
    s_add_u32 s19, s19, s20
    v_max3_f32 v255, v255, v128, v129
    v_mov_b32 v123, v255
    v_mfma_f32_16x16x32_bf16 v[142:145], a[220:223], v[170:173], v[142:145]
    s_add_u32 s23, s23, s21
    v_permlane32_swap_b32 v255, v123
    v_mfma_f32_16x16x32_bf16 v[142:145], a[224:227], v[138:141], v[142:145]
    s_cmp_ge_u32 s19, 72
    v_rcp_f32 v154, v154
    v_mfma_f32_16x16x32_bf16 v[142:145], a[228:231], v[210:213], v[142:145]
    s_cselect_b32 s34, 72, 0
    v_max_f32 v255, v255, v123
    v_mov_b32 v123, v255
    v_mfma_f32_16x16x32_bf16 v[142:145], a[232:235], v[134:137], v[142:145]
    s_cselect_b32 s35, s22, 0
    v_permlane16_swap_b32 v255, v123
    v_mfma_f32_16x16x32_bf16 v[142:145], a[236:239], v[194:197], v[142:145]
    s_sub_u32 s19, s19, s34
    v_max_f32 v255, v255, v123
    v_sub_f32 v118, v118, v255
    v_mfma_f32_16x16x32_bf16 v[178:181], v[214:217], v[36:39], 0
    s_add_u32 s23, s23, s35
    v_exp_f32 v118, v118
    v_mfma_f32_16x16x32_bf16 v[178:181], v[230:233], v[158:161], v[178:181]
    s_add_u32 s18, s18, 1
    v_sub_f32 v119, v119, v255
    v_exp_f32 v119, v119
    v_sub_f32 v120, v120, v255
    v_cvt_pk_bf16_f32 v118, v118, v119
    v_exp_f32 v120, v120
    v_sub_f32 v121, v121, v255
    v_exp_f32 v121, v121
    v_mul_f32 v178, v154, v178
    v_mul_f32 v179, v154, v179
    v_cvt_pk_bf16_f32 v178, v178, v179
    v_mul_f32 v180, v154, v180
    v_mul_f32 v181, v154, v181
    v_cvt_pk_bf16_f32 v179, v180, v181
    v_cvt_pk_bf16_f32 v119, v120, v121
    v_mfma_f32_16x16x32_bf16 v[206:209], v[222:225], v[36:39], 0
    s_cmp_lt_u32 s18, s45
    v_sub_f32 v186, v186, v255
    v_sub_f32 v187, v187, v255
    v_mfma_f32_16x16x32_bf16 v[206:209], v[130:133], v[158:161], v[206:209]
    v_exp_f32 v186, v186
    v_exp_f32 v187, v187
    v_sub_f32 v188, v188, v255
    v_cvt_pk_bf16_f32 v120, v186, v187
    v_exp_f32 v188, v188
    v_sub_f32 v189, v189, v255
    v_exp_f32 v189, v189
    v_sub_f32 v126, v126, v255
    v_mul_f32 v206, v154, v206
    v_mul_f32 v207, v154, v207
    v_cvt_pk_bf16_f32 v180, v206, v207
    v_mul_f32 v208, v154, v208
    v_mul_f32 v209, v154, v209
    v_cvt_pk_bf16_f32 v181, v208, v209
    v_cvt_pk_bf16_f32 v121, v188, v189
    v_mfma_f32_16x16x32_bf16 v[186:189], v[234:237], v[36:39], 0
    buffer_load_dwordx4 v14, s[8:11], 0 offen nt lds
    v_sub_f32 v127, v127, v255
    v_mfma_f32_16x16x32_bf16 v[186:189], v[114:117], v[158:161], v[186:189]
    ds_write_b128 v3, v[178:181] offset:0
    v_mfma_f32_16x16x32_bf16 v[158:161], a[240:243], v[166:169], 0
    v_exp_f32 v126, v126
    v_mfma_f32_16x16x32_bf16 v[158:161], a[244:247], v[170:173], v[158:161]
    v_exp_f32 v127, v127
    v_mfma_f32_16x16x32_bf16 v[158:161], a[248:251], v[138:141], v[158:161]
    v_cvt_pk_bf16_f32 v36, v126, v127
    v_sub_f32 v128, v128, v255
    v_mfma_f32_16x16x32_bf16 v[158:161], a[252:255], v[210:213], v[158:161]
    v_mul_f32 v186, v154, v186
    v_mul_f32 v187, v154, v187
    v_mfma_f32_16x16x32_bf16 v[158:161], v[82:85], v[134:137], v[158:161]
    v_cvt_pk_bf16_f32 v126, v186, v187
    v_mul_f32 v188, v154, v188
    v_mfma_f32_16x16x32_bf16 v[158:161], v[86:89], v[194:197], v[158:161]
    v_mul_f32 v189, v154, v189
    v_cvt_pk_bf16_f32 v127, v188, v189
    v_mfma_f32_16x16x32_bf16 v[178:181], v[90:93], v[166:169], 0
    ds_read_b128 v[166:169], v2 offset:12288
    v_sub_f32 v129, v129, v255
    v_mfma_f32_16x16x32_bf16 v[178:181], v[94:97], v[170:173], v[178:181]
    ds_read_b128 v[170:173], v2 offset:13312
    v_sub_f32 v198, v198, v255
    v_mfma_f32_16x16x32_bf16 v[178:181], v[98:101], v[138:141], v[178:181]
    ds_read_b128 v[154:157], v2 offset:14336
    v_max_f32_dpp v122, v122, v122 quad_perm:[1,0,3,2] row_mask:0xf bank_mask:0xf
    v_mfma_f32_16x16x32_bf16 v[178:181], v[102:105], v[210:213], v[178:181]
    ds_read_b128 v[210:213], v2 offset:15360
    v_max_f32_dpp v122, v122, v122 quad_perm:[2,3,0,1] row_mask:0xf bank_mask:0xf
    v_mfma_f32_16x16x32_bf16 v[178:181], v[106:109], v[134:137], v[178:181]
    ds_read_b128 v[134:137], v2 offset:16384
    v_max_f32_dpp v122, v122, v122 row_half_mirror row_mask:0xf bank_mask:0xf
    v_mfma_f32_16x16x32_bf16 v[178:181], v[110:113], v[194:197], v[178:181]
    ds_read_b128 v[194:197], v2 offset:17408
    ds_write_b64 v4, v[126:127] offset:4096
    v_exp_f32 v128, v128
    v_exp_f32 v129, v129
    v_mfma_f32_16x16x32_f16 v[186:189], v[218:221], v[174:177], v[70:73]
    s_waitcnt lgkmcnt(6)
    v_cvt_pk_bf16_f32 v37, v128, v129
    v_max_f32_dpp v122, v122, v122 row_mirror row_mask:0xf bank_mask:0xf
    v_mfma_f32_16x16x32_f16 v[218:221], v[226:229], v[174:177], v[74:77]
    s_waitcnt lgkmcnt(5)
    v_exp_f32 v198, v198
    v_mfma_f32_16x16x32_f16 v[126:129], v[146:149], v[174:177], v[78:81]
    s_waitcnt lgkmcnt(4)
    v_cvt_pk_bf16_f32 v39, v198, 0
    v_mov_b32 v123, v122
    v_fma_f32 v255, v150, v150, s33
    v_mfma_f32_16x16x32_bf16 v[174:177], v[28:31], v[36:39], 0
    s_waitcnt lgkmcnt(3)
    v_permlane32_swap_b32 v122, v123
    v_mfma_f32_16x16x32_bf16 v[174:177], v[28:31], v[118:121], v[174:177]
    s_waitcnt lgkmcnt(2)
    v_max_f32 v122, v122, v123
    v_mov_b32 v123, v122
    v_mfma_f32_16x16x32_bf16 v[226:229], v[214:217], v[36:39], 0
    s_waitcnt lgkmcnt(0)
    v_permlane16_swap_b32 v122, v123
    v_mfma_f32_16x16x32_bf16 v[226:229], v[230:233], v[118:121], v[226:229]
    v_max_f32 v122, v122, v123
    v_sub_f32 v254, v254, v122
    v_mfma_f32_16x16x32_bf16 v[198:201], v[222:225], v[36:39], 0
    v_exp_f32 v254, v254
    v_mfma_f32_16x16x32_bf16 v[198:201], v[130:133], v[118:121], v[198:201]
    v_cvt_pk_bf16_f32 v254, v254, v254
    v_fmac_f32 v255, v151, v151
    v_mfma_f32_16x16x32_bf16 v[206:209], v[234:237], v[36:39], 0
    ds_write_b16 v8, v254
    v_mfma_f32_16x16x32_bf16 v[206:209], v[114:117], v[118:121], v[206:209]
    v_rcp_f32 v174, v174
    v_fmac_f32 v255, v152, v152
    v_mfma_f32_16x16x16_f16 v[186:189], v[164:165], v[182:183], v[186:189]
    v_mul_f32 v226, v174, v226
    v_mul_f32 v227, v174, v227
    v_cvt_pk_bf16_f32 v122, v226, v227
    v_mfma_f32_16x16x16_f16 v[218:221], v[124:125], v[182:183], v[218:221]
    v_mul_f32 v228, v174, v228
    v_mul_f32 v229, v174, v229
    v_cvt_pk_bf16_f32 v123, v228, v229
    v_mfma_f32_16x16x16_f16 v[126:129], v[184:185], v[182:183], v[126:129]
    v_max3_f32 v254, v242, v186, v187
    v_max3_f32 v254, v254, v188, v189
    v_mul_f32 v198, v174, v198
    v_mul_f32 v199, v174, v199
    v_mfma_f32_16x16x32_bf16 v[146:149], a[216:219], v[166:169], 0
    ds_read_b128 v[182:185], v9
    ds_read_b128 v[118:121], v9 offset:64
    v_mfma_f32_16x16x32_bf16 v[146:149], a[220:223], v[170:173], v[146:149]
    v_max3_f32 v254, v254, v218, v219
    v_max3_f32 v254, v254, v220, v221
    v_mfma_f32_16x16x32_bf16 v[146:149], a[224:227], v[154:157], v[146:149]
    v_max3_f32 v254, v254, v126, v127
    v_max3_f32 v254, v254, v128, v129
    v_mfma_f32_16x16x32_bf16 v[146:149], a[228:231], v[210:213], v[146:149]
    v_mov_b32 v125, v254
    v_cvt_pk_bf16_f32 v124, v198, v199
    v_mfma_f32_16x16x32_bf16 v[146:149], a[232:235], v[134:137], v[146:149]
    v_permlane32_swap_b32 v254, v125
    v_mfma_f32_16x16x32_bf16 v[146:149], a[236:239], v[194:197], v[146:149]
    v_max_f32 v254, v254, v125
    v_mov_b32 v125, v254
    v_mfma_f32_16x16x32_bf16 v[138:141], a[240:243], v[166:169], 0
    v_mul_f32 v200, v174, v200
    v_mul_f32 v201, v174, v201
    v_mfma_f32_16x16x32_bf16 v[138:141], a[244:247], v[170:173], v[138:141]
    v_permlane16_swap_b32 v254, v125
    v_mfma_f32_16x16x32_bf16 v[138:141], a[248:251], v[154:157], v[138:141]
    s_waitcnt lgkmcnt(0)
    v_max_f32 v254, v254, v125
    v_sub_f32 v186, v186, v254
    v_mfma_f32_16x16x32_bf16 v[138:141], a[252:255], v[210:213], v[138:141]
    v_exp_f32 v186, v186
    v_mfma_f32_16x16x32_bf16 v[138:141], v[82:85], v[134:137], v[138:141]
    v_sub_f32 v187, v187, v254
    v_sub_f32 v188, v188, v254
    v_mfma_f32_16x16x32_bf16 v[138:141], v[86:89], v[194:197], v[138:141]
    v_exp_f32 v187, v187
    v_exp_f32 v188, v188
    v_cvt_pk_bf16_f32 v238, v186, v187
    v_sub_f32 v189, v189, v254
    v_exp_f32 v189, v189
    v_sub_f32 v218, v218, v254
    v_cvt_pk_bf16_f32 v239, v188, v189
    v_exp_f32 v218, v218
    v_sub_f32 v219, v219, v254
    v_exp_f32 v219, v219
    v_sub_f32 v220, v220, v254
    v_cvt_pk_bf16_f32 v240, v218, v219
    v_mfma_f32_16x16x32_bf16 v[186:189], v[90:93], v[166:169], 0
    v_exp_f32 v220, v220
    v_mfma_f32_16x16x32_bf16 v[186:189], v[94:97], v[170:173], v[186:189]
    v_sub_f32 v221, v221, v254
    v_sub_f32 v126, v126, v254
    v_mfma_f32_16x16x32_bf16 v[186:189], v[98:101], v[154:157], v[186:189]
    v_exp_f32 v221, v221
    v_mfma_f32_16x16x32_bf16 v[186:189], v[102:105], v[210:213], v[186:189]
    v_cvt_pk_bf16_f32 v241, v220, v221
    v_sub_f32 v127, v127, v254
    v_mfma_f32_16x16x32_bf16 v[186:189], v[106:109], v[134:137], v[186:189]
    v_exp_f32 v126, v126
    v_mfma_f32_16x16x32_bf16 v[186:189], v[110:113], v[194:197], v[186:189]
    ds_read_b128 v[170:173], v0 offset:20480
    ds_read_b128 v[166:169], v1 offset:20480
    v_mfma_f32_16x16x32_bf16 v[154:157], v[182:185], v[28:31], 0
    ds_read_b128 v[162:165], v0 offset:20608
    ds_read_b128 v[210:213], v1 offset:20608
    v_mfma_f32_16x16x32_bf16 v[154:157], v[118:121], v[28:31], v[154:157]
    v_exp_f32 v127, v127
    v_mfma_f32_16x16x32_bf16 v[134:137], v[182:185], v[230:233], 0
    ds_read_b128 v[226:229], v0 offset:20736
    v_cvt_pk_bf16_f32 v36, v126, v127
    v_mfma_f32_16x16x32_bf16 v[134:137], v[118:121], v[214:217], v[134:137]
    ds_read_b128 v[218:221], v1 offset:20736
    v_sub_f32 v128, v128, v254
    v_exp_f32 v128, v128
    v_sub_f32 v129, v129, v254
    v_exp_f32 v129, v129
    v_sub_f32 v242, v242, v254
    v_cvt_pk_bf16_f32 v37, v128, v129
    v_mfma_f32_16x16x32_bf16 v[194:197], v[182:185], v[130:133], 0
    v_exp_f32 v242, v242
    v_mfma_f32_16x16x32_bf16 v[194:197], v[118:121], v[222:225], v[194:197]
    s_waitcnt lgkmcnt(4)
    v_cvt_pk_bf16_f32 v39, v242, 0
    v_cvt_pk_bf16_f32 v125, v200, v201
    v_mfma_f32_16x16x32_bf16 v[198:201], v[182:185], v[114:117], 0
    s_waitcnt lgkmcnt(2)
    ds_write_b128 v3, v[122:125] offset:6144
    v_mfma_f32_16x16x32_bf16 v[126:129], v[28:31], v[36:39], 0
    s_waitcnt lgkmcnt(2)
    v_mul_f32 v206, v174, v206
    v_mul_f32 v207, v174, v207
    v_mfma_f32_16x16x32_bf16 v[126:129], v[28:31], v[238:241], v[126:129]
    s_waitcnt lgkmcnt(1)
    v_cvt_pk_bf16_f32 v206, v206, v207
    v_mul_f32 v208, v174, v208
    v_mfma_f32_16x16x32_bf16 v[122:125], v[214:217], v[36:39], 0
    v_mul_f32 v209, v174, v209
    v_cvt_pk_bf16_f32 v207, v208, v209
    v_mfma_f32_16x16x32_bf16 v[122:125], v[230:233], v[238:241], v[122:125]
    ds_write_b64 v4, v[206:207] offset:10240
    v_mfma_f32_16x16x32_bf16 v[230:233], v[222:225], v[36:39], 0
    v_rcp_f32 v126, v126
    v_mfma_f32_16x16x32_bf16 v[230:233], v[130:133], v[238:241], v[230:233]
    v_fma_f32 v254, v146, v146, s33
    v_fmac_f32 v254, v147, v147
    v_mfma_f32_16x16x32_bf16 v[174:177], v[234:237], v[36:39], 0
    v_fmac_f32 v254, v148, v148
    v_mul_f32 v122, v126, v122
    v_mfma_f32_16x16x32_bf16 v[174:177], v[114:117], v[238:241], v[174:177]
    v_mul_f32 v123, v126, v123
    v_cvt_pk_bf16_f32 v122, v122, v123
    v_mfma_f32_16x16x32_bf16 v[198:201], v[118:121], v[234:237], v[198:201]
    v_mul_f32 v124, v126, v124
    v_mul_f32 v125, v126, v125
    v_mfma_f32_16x16x32_bf16 v[114:117], a[72:75], v[170:173], 0
    v_cvt_pk_bf16_f32 v123, v124, v125
    v_mul_f32 v230, v126, v230
    v_mfma_f32_16x16x32_bf16 v[114:117], a[76:79], v[166:169], v[114:117]
    v_mul_f32 v231, v126, v231
    v_cvt_pk_bf16_f32 v124, v230, v231
    v_mfma_f32_16x16x32_bf16 v[114:117], a[80:83], v[162:165], v[114:117]
    v_mul_f32 v232, v126, v232
    v_mul_f32 v233, v126, v233
    v_mfma_f32_16x16x32_bf16 v[114:117], a[84:87], v[210:213], v[114:117]
    v_cvt_pk_bf16_f32 v125, v232, v233
    v_mul_f32 v174, v126, v174
    v_mfma_f32_16x16x32_bf16 v[114:117], a[88:91], v[226:229], v[114:117]
    ds_write_b128 v3, v[122:125] offset:12288
    v_mfma_f32_16x16x32_bf16 v[114:117], a[92:95], v[218:221], v[114:117]
    v_mul_f32 v175, v126, v175
    v_cvt_pk_bf16_f32 v174, v174, v175
    v_mfma_f32_16x16x32_bf16 v[122:125], a[96:99], v[170:173], 0
    v_mul_f32 v176, v126, v176
    v_mul_f32 v177, v126, v177
    v_mfma_f32_16x16x32_bf16 v[122:125], a[100:103], v[166:169], v[122:125]
    v_cvt_pk_bf16_f32 v175, v176, v177
    v_fmac_f32 v254, v149, v149
    v_mfma_f32_16x16x32_bf16 v[122:125], a[104:107], v[162:165], v[122:125]
    ds_write_b64 v4, v[174:175] offset:16384
    v_mfma_f32_16x16x32_bf16 v[122:125], a[108:111], v[210:213], v[122:125]
    v_fmac_f32 v254, v138, v138
    v_fmac_f32 v254, v139, v139
    v_mfma_f32_16x16x32_bf16 v[122:125], a[112:115], v[226:229], v[122:125]
    v_fmac_f32 v254, v140, v140
    v_fmac_f32 v254, v141, v141
    v_mfma_f32_16x16x32_bf16 v[122:125], a[116:119], v[218:221], v[122:125]
    v_fmac_f32 v254, v186, v186
    v_fmac_f32 v254, v187, v187
    v_mfma_f32_16x16x32_bf16 v[126:129], a[120:123], v[170:173], 0
    v_fmac_f32 v254, v188, v188
    v_fmac_f32 v254, v189, v189
    v_mfma_f32_16x16x32_bf16 v[126:129], a[124:127], v[166:169], v[126:129]
    v_cvt_pk_bf16_f32 v135, v254, v254
    v_fmac_f32 v255, v153, v153
    v_mfma_f32_16x16x32_bf16 v[126:129], a[128:131], v[162:165], v[126:129]
    v_rcp_f32 v154, v154
    v_mfma_f32_16x16x32_bf16 v[126:129], a[132:135], v[210:213], v[126:129]
    v_mul_f32 v134, v134, v154
    v_mul_f32_dpp v134, v194, v154 quad_perm:[0,1,2,3] row_mask:0x2 bank_mask:0xf
    v_mfma_f32_16x16x32_bf16 v[126:129], a[136:139], v[226:229], v[126:129]
    v_mul_f32_dpp v134, v198, v154 quad_perm:[0,1,2,3] row_mask:0x4 bank_mask:0xf
    v_cvt_pk_bf16_f32 v134, v134, v134
    v_mfma_f32_16x16x32_bf16 v[126:129], a[140:143], v[218:221], v[126:129]
    ds_write_b16 v7, v134
    v_mfma_f32_16x16x32_bf16 v[154:157], a[0:3], v[170:173], 0
    v_fmac_f32 v255, v190, v190
    v_fmac_f32 v255, v191, v191
    v_mfma_f32_16x16x32_bf16 v[154:157], a[4:7], v[166:169], v[154:157]
    v_fmac_f32 v255, v192, v192
    v_fmac_f32 v255, v193, v193
    v_mfma_f32_16x16x32_bf16 v[154:157], a[8:11], v[162:165], v[154:157]
    v_fmac_f32 v255, v202, v202
    v_fmac_f32 v255, v203, v203
    v_mfma_f32_16x16x32_bf16 v[154:157], a[12:15], v[210:213], v[154:157]
    v_fmac_f32 v255, v204, v204
    v_fmac_f32 v255, v205, v205
    v_mfma_f32_16x16x32_bf16 v[154:157], a[16:19], v[226:229], v[154:157]
    v_fma_f32 v254, v142, v142, s33
    v_fmac_f32 v254, v143, v143
    v_mfma_f32_16x16x32_bf16 v[154:157], a[20:23], v[218:221], v[154:157]
    v_fmac_f32 v254, v144, v144
    v_fmac_f32 v254, v145, v145
    v_mfma_f32_16x16x32_bf16 v[174:177], a[24:27], v[170:173], 0
    v_fmac_f32 v254, v158, v158
    v_fmac_f32 v254, v159, v159
    v_mfma_f32_16x16x32_bf16 v[174:177], a[28:31], v[166:169], v[174:177]
    v_fmac_f32 v254, v160, v160
    v_fmac_f32 v254, v161, v161
    v_mfma_f32_16x16x32_bf16 v[174:177], a[32:35], v[162:165], v[174:177]
    v_fmac_f32 v254, v178, v178
    v_fmac_f32 v254, v179, v179
    v_mfma_f32_16x16x32_bf16 v[174:177], a[36:39], v[210:213], v[174:177]
    v_fmac_f32 v254, v180, v180
    v_fmac_f32 v254, v181, v181
    v_mfma_f32_16x16x32_bf16 v[174:177], a[40:43], v[226:229], v[174:177]
    v_cvt_pk_bf16_f32 v134, v255, v254
    v_add_u32 v5, 336, v5
    v_mfma_f32_16x16x32_bf16 v[174:177], a[44:47], v[218:221], v[174:177]
    ds_write_b64 v4, v[134:135] offset:18432
    v_mfma_f32_16x16x32_bf16 v[182:185], a[48:51], v[170:173], 0
    v_add_u32 v6, 272, v6
    v_add_u32 v7, 16, v7
    v_mfma_f32_16x16x32_bf16 v[182:185], a[52:55], v[166:169], v[182:185]
    v_fma_f32 v130, v114, v114, s32
    v_fmac_f32 v130, v115, v115
    v_mfma_f32_16x16x32_bf16 v[182:185], a[56:59], v[162:165], v[182:185]
    v_fmac_f32 v130, v116, v116
    v_fmac_f32 v130, v117, v117
    v_mfma_f32_16x16x32_bf16 v[182:185], a[60:63], v[210:213], v[182:185]
    v_fmac_f32 v130, v122, v122
    v_fmac_f32 v130, v123, v123
    v_mfma_f32_16x16x32_bf16 v[182:185], a[64:67], v[226:229], v[182:185]
    v_fmac_f32 v130, v124, v124
    v_fmac_f32 v130, v125, v125
    v_mfma_f32_16x16x32_bf16 v[182:185], a[68:71], v[218:221], v[182:185]
    v_fmac_f32 v130, v126, v126
    v_fmac_f32 v130, v127, v127
    v_mfma_f32_16x16x32_bf16 v[230:233], v[170:173], a[144:147], 0
    s_waitcnt lgkmcnt(0)
    v_fmac_f32 v130, v128, v128
    v_fmac_f32 v130, v129, v129
    v_mfma_f32_16x16x32_bf16 v[230:233], v[166:169], a[148:151], v[230:233]
    v_fma_f32 v131, v154, v154, s32
    v_fmac_f32 v131, v155, v155
    v_mfma_f32_16x16x32_bf16 v[230:233], v[162:165], a[152:155], v[230:233]
    s_barrier
    v_fmac_f32 v131, v156, v156
    v_fmac_f32 v131, v157, v157
    v_mfma_f32_16x16x32_bf16 v[230:233], v[210:213], a[156:159], v[230:233]
    s_nop 0
    v_fmac_f32 v131, v174, v174
    v_xor_b32 v2, 65536, v2
    v_mfma_f32_16x16x32_bf16 v[230:233], v[226:229], a[160:163], v[230:233]
    s_nop 0
    v_xor_b32 v3, 65536, v3
    v_xor_b32 v4, 65536, v4
    v_mfma_f32_16x16x32_bf16 v[230:233], v[218:221], a[164:167], v[230:233]
    s_cbranch_scc1 L_loop_safe1
    s_branch L_final_safe
.p2align 6
L_loop_safe2:
    v_mfma_f32_16x16x32_bf16 v[194:197], v[170:173], a[168:171], 0
    s_add_u32 s12, s42, s27
    ds_read_b128 v[198:201], v2 offset:18432
    ds_read_b128 v[214:217], v2 offset:19456
    v_mfma_f32_16x16x32_bf16 v[194:197], v[166:169], a[172:175], v[194:197]
    s_addc_u32 s13, s43, 0
    v_fmac_f32 v131, v175, v175
    v_fmac_f32 v131, v176, v176
    v_mfma_f32_16x16x32_bf16 v[194:197], v[162:165], a[176:179], v[194:197]
    s_sub_u32 s14, s36, s27
    v_fmac_f32 v131, v177, v177
    v_fmac_f32 v131, v182, v182
    v_mfma_f32_16x16x32_bf16 v[194:197], v[210:213], a[180:183], v[194:197]
    s_cmp_ge_u32 s18, 2
    v_fmac_f32 v131, v183, v183
    v_fmac_f32 v131, v184, v184
    v_mfma_f32_16x16x32_bf16 v[194:197], v[226:229], a[184:187], v[194:197]
    s_cselect_b32 s14, s14, 0
    ds_read_b128 v[118:121], v0 offset:26624
    v_fmac_f32 v131, v185, v185
    v_mfma_f32_16x16x32_bf16 v[194:197], v[218:221], a[188:191], v[194:197]
    s_add_u32 s34, s18, 2
    ds_read_b128 v[134:137], v1 offset:26624
    v_cvt_pk_bf16_f32 v36, v131, v130
    v_mfma_f32_16x16x32_bf16 v[234:237], v[170:173], a[192:195], 0
    s_add_u32 s8, s40, s23
    ds_read_b128 v[170:173], v0 offset:26752
    v_cvt_pk_bf16_f32 v230, v230, v231
    v_mfma_f32_16x16x32_bf16 v[234:237], v[166:169], a[196:199], v[234:237]
    s_addc_u32 s9, s41, 0
    ds_read_b128 v[166:169], v1 offset:26752
    v_cvt_pk_bf16_f32 v231, v232, v233
    v_mfma_f32_16x16x32_bf16 v[222:225], v[32:35], v[36:39], 0
    s_sub_u32 s10, s36, s23
    v_cvt_pk_bf16_f32 v130, v194, v195
    v_cvt_pk_bf16_f32 v131, v196, v197
    v_mfma_f32_16x16x32_bf16 v[234:237], v[162:165], a[200:203], v[234:237]
    s_waitcnt lgkmcnt(4)
    ds_read_b128 v[194:197], v0 offset:26880
    s_cmp_lt_u32 s34, s17
    v_mfma_f32_16x16x32_bf16 v[206:209], v[32:35], v[198:201], 0
    s_cselect_b32 s10, s10, 0
    v_rsq_f32 v223, v223
    v_mfma_f32_16x16x32_bf16 v[206:209], v[32:35], v[214:217], v[206:209]
    s_add_u32 m0, s28, 0
    v_rsq_f32 v222, v222
    v_mfma_f32_16x16x32_bf16 v[234:237], v[210:213], a[204:207], v[234:237]
    s_waitcnt lgkmcnt(4)
    ds_read_b128 v[198:201], v1 offset:26880
    v_mul_f32 v222, s31, v222
    v_mfma_f32_16x16x32_bf16 v[234:237], v[226:229], a[208:211], v[234:237]
    s_mov_b32 s27, s26
    v_mul_f32 v114, v223, v114
    v_mul_f32 v115, v223, v115
    v_mfma_f32_16x16x32_bf16 v[234:237], v[218:221], a[212:215], v[234:237]
    s_mov_b32 s26, s25
    v_cvt_pk_f16_f32 v218, v114, v115
    v_mul_f32 v116, v223, v116
    v_mfma_f32_16x16x32_bf16 v[226:229], a[72:75], v[118:121], 0
    s_waitcnt lgkmcnt(2)
    v_mul_f32 v117, v223, v117
    v_cvt_pk_f16_f32 v219, v116, v117
    v_mfma_f32_16x16x32_bf16 v[226:229], a[76:79], v[134:137], v[226:229]
    s_mov_b32 s25, s24
    v_cvt_pk_bf16_f32 v114, v234, v235
    v_cvt_pk_bf16_f32 v115, v236, v237
    v_mfma_f32_16x16x32_bf16 v[226:229], a[80:83], v[170:173], v[226:229]
    s_mov_b32 s24, s23
    v_mul_f32 v122, v223, v122
    v_mul_f32 v123, v223, v123
    v_mfma_f32_16x16x32_bf16 v[226:229], a[84:87], v[166:169], v[226:229]
    s_waitcnt lgkmcnt(1)
    v_cvt_pk_f16_f32 v220, v122, v123
    v_mul_f32 v124, v223, v124
    v_mfma_f32_16x16x32_bf16 v[226:229], a[88:91], v[194:197], v[226:229]
    v_mul_f32 v125, v223, v125
    v_cvt_pk_f16_f32 v221, v124, v125
    v_mfma_f32_16x16x32_bf16 v[122:125], a[96:99], v[118:121], 0
    s_waitcnt lgkmcnt(0)
    v_mul_f32 v126, v223, v126
    v_mul_f32 v127, v223, v127
    v_mfma_f32_16x16x32_bf16 v[226:229], a[92:95], v[198:201], v[226:229]
    v_cvt_pk_f16_f32 v164, v126, v127
    v_mul_f32 v128, v223, v128
    v_mfma_f32_16x16x32_bf16 v[122:125], a[100:103], v[134:137], v[122:125]
    v_mul_f32 v129, v223, v129
    v_cvt_pk_f16_f32 v165, v128, v129
    v_mfma_f32_16x16x32_bf16 v[122:125], a[104:107], v[170:173], v[122:125]
    v_mul_f32 v154, v222, v154
    v_mul_f32 v155, v222, v155
    v_mfma_f32_16x16x32_bf16 v[122:125], a[108:111], v[166:169], v[122:125]
    v_cvt_pk_f16_f32 v210, v154, v155
    v_mul_f32 v156, v222, v156
    v_mfma_f32_16x16x32_bf16 v[122:125], a[112:115], v[194:197], v[122:125]
    v_mul_f32 v157, v222, v157
    v_cvt_pk_f16_f32 v211, v156, v157
    v_mfma_f32_16x16x32_bf16 v[122:125], a[116:119], v[198:201], v[122:125]
    v_mul_f32 v174, v222, v174
    v_mul_f32 v175, v222, v175
    v_mfma_f32_16x16x32_bf16 v[126:129], a[120:123], v[118:121], 0
    v_cvt_pk_f16_f32 v212, v174, v175
    v_mul_f32 v176, v222, v176
    v_mfma_f32_16x16x32_bf16 v[126:129], a[124:127], v[134:137], v[126:129]
    v_mul_f32 v177, v222, v177
    v_cvt_pk_f16_f32 v213, v176, v177
    v_mfma_f32_16x16x32_bf16 v[126:129], a[128:131], v[170:173], v[126:129]
    v_mul_f32 v182, v222, v182
    v_mul_f32 v183, v222, v183
    v_mfma_f32_16x16x32_bf16 v[126:129], a[132:135], v[166:169], v[126:129]
    v_cvt_pk_f16_f32 v162, v182, v183
    v_mul_f32 v184, v222, v184
    v_mfma_f32_16x16x32_bf16 v[126:129], a[136:139], v[194:197], v[126:129]
    v_mul_f32 v185, v222, v185
    v_cvt_pk_f16_f32 v163, v184, v185
    v_mfma_f32_16x16x32_bf16 v[126:129], a[140:143], v[198:201], v[126:129]
    v_fma_f32 v116, v226, v226, s32
    v_fmac_f32 v116, v227, v227
    v_mfma_f32_16x16x32_bf16 v[154:157], a[0:3], v[118:121], 0
    v_fmac_f32 v116, v228, v228
    v_fmac_f32 v116, v229, v229
    v_mfma_f32_16x16x32_bf16 v[154:157], a[4:7], v[134:137], v[154:157]
    v_fmac_f32 v116, v122, v122
    v_fmac_f32 v116, v123, v123
    v_mfma_f32_16x16x32_bf16 v[154:157], a[8:11], v[170:173], v[154:157]
    v_fmac_f32 v116, v124, v124
    v_fmac_f32 v116, v125, v125
    v_mfma_f32_16x16x32_bf16 v[154:157], a[12:15], v[166:169], v[154:157]
    v_fmac_f32 v116, v126, v126
    v_fmac_f32 v116, v127, v127
    v_mfma_f32_16x16x32_bf16 v[154:157], a[16:19], v[194:197], v[154:157]
    v_fmac_f32 v116, v128, v128
    v_fmac_f32 v116, v129, v129
    v_mfma_f32_16x16x32_bf16 v[154:157], a[20:23], v[198:201], v[154:157]
    v_mul_f32 v117, 0x3baaaaab, v206
    v_mul_f32 v254, 0x3baaaaab, v207
    v_mfma_f32_16x16x32_bf16 v[174:177], a[24:27], v[118:121], 0
    v_rsq_f32 v117, v117
    v_mfma_f32_16x16x32_bf16 v[174:177], a[28:31], v[134:137], v[174:177]
    v_rsq_f32 v254, v254
    v_mfma_f32_16x16x32_bf16 v[174:177], a[32:35], v[170:173], v[174:177]
    v_mul_f32 v255, 0x3baaaaab, v208
    v_fma_f32 v132, v154, v154, s32
    v_mfma_f32_16x16x32_bf16 v[174:177], a[36:39], v[166:169], v[174:177]
    v_fmac_f32 v132, v155, v155
    v_fmac_f32 v132, v156, v156
    v_mfma_f32_16x16x32_bf16 v[174:177], a[40:43], v[194:197], v[174:177]
    v_fmac_f32 v132, v157, v157
    v_mul_f32 v150, v117, v150
    v_mfma_f32_16x16x32_bf16 v[174:177], a[44:47], v[198:201], v[174:177]
    v_rsq_f32 v255, v255
    v_mfma_f32_16x16x32_bf16 v[182:185], a[48:51], v[118:121], 0
    v_mul_f32 v151, v117, v151
    v_cvt_pk_bf16_f32 v214, v150, v151
    v_mfma_f32_16x16x32_bf16 v[182:185], a[52:55], v[134:137], v[182:185]
    v_mul_f32 v152, v117, v152
    v_mul_f32 v153, v117, v153
    v_mfma_f32_16x16x32_bf16 v[182:185], a[56:59], v[170:173], v[182:185]
    v_fmac_f32 v132, v174, v174
    v_fmac_f32 v132, v175, v175
    v_mfma_f32_16x16x32_bf16 v[182:185], a[60:63], v[166:169], v[182:185]
    v_fmac_f32 v132, v176, v176
    v_fmac_f32 v132, v177, v177
    v_mfma_f32_16x16x32_bf16 v[182:185], a[64:67], v[194:197], v[182:185]
    v_cvt_pk_bf16_f32 v215, v152, v153
    v_mul_f32 v190, v117, v190
    v_mfma_f32_16x16x32_bf16 v[182:185], a[68:71], v[198:201], v[182:185]
    v_mul_f32 v191, v117, v191
    v_cvt_pk_bf16_f32 v216, v190, v191
    v_mfma_f32_16x16x32_bf16 v[150:153], v[118:121], a[144:147], 0
    v_mul_f32 v192, v117, v192
    v_mul_f32 v193, v117, v193
    v_mfma_f32_16x16x32_bf16 v[150:153], v[134:137], a[148:151], v[150:153]
    v_cvt_pk_bf16_f32 v217, v192, v193
    v_mul_f32 v202, v117, v202
    v_mfma_f32_16x16x32_bf16 v[150:153], v[170:173], a[152:155], v[150:153]
    buffer_store_dwordx4 v[214:217], v15, s[12:15], 0 offen nt
    v_fmac_f32 v132, v182, v182
    v_fmac_f32 v132, v183, v183
    v_fmac_f32 v132, v184, v184
    v_fmac_f32 v132, v185, v185
    v_mfma_f32_16x16x32_bf16 v[150:153], v[166:169], a[156:159], v[150:153]
    v_cvt_pk_bf16_f32 v36, v132, v116
    v_mul_f32 v203, v117, v203
    v_mfma_f32_16x16x32_bf16 v[150:153], v[194:197], a[160:163], v[150:153]
    v_cvt_pk_bf16_f32 v116, v202, v203
    v_mul_f32 v204, v117, v204
    v_mfma_f32_16x16x32_bf16 v[190:193], v[32:35], v[36:39], 0
    v_mul_f32 v205, v117, v205
    v_cvt_pk_bf16_f32 v117, v204, v205
    v_mfma_f32_16x16x32_bf16 v[150:153], v[198:201], a[164:167], v[150:153]
    v_mul_f32 v146, v255, v146
    v_mul_f32 v147, v255, v147
    v_mfma_f32_16x16x32_bf16 v[202:205], v[118:121], a[168:171], 0
    v_cvt_pk_bf16_f32 v146, v146, v147
    v_mul_f32 v148, v255, v148
    v_mfma_f32_16x16x32_bf16 v[202:205], v[134:137], a[172:175], v[202:205]
    v_rsq_f32 v191, v191
    v_mfma_f32_16x16x32_bf16 v[202:205], v[170:173], a[176:179], v[202:205]
    v_cvt_pk_bf16_f32 v232, v150, v151
    v_cvt_pk_bf16_f32 v233, v152, v153
    v_mfma_f32_16x16x32_bf16 v[202:205], v[166:169], a[180:183], v[202:205]
    v_rsq_f32 v190, v190
    v_mfma_f32_16x16x32_bf16 v[202:205], v[194:197], a[184:187], v[202:205]
    ds_read_b128 v[150:153], v0 offset:32768
    v_mul_f32 v190, s31, v190
    v_mfma_f32_16x16x32_bf16 v[202:205], v[198:201], a[188:191], v[202:205]
    ds_read_b128 v[206:209], v1 offset:32768
    v_mul_f32 v226, v191, v226
    v_mfma_f32_16x16x32_bf16 v[214:217], v[118:121], a[192:195], 0
    ds_read_b128 v[118:121], v0 offset:32896
    v_mul_f32 v227, v191, v227
    v_mfma_f32_16x16x32_bf16 v[214:217], v[134:137], a[196:199], v[214:217]
    ds_read_b128 v[134:137], v1 offset:32896
    v_cvt_pk_f16_f32 v226, v226, v227
    v_mfma_f32_16x16x32_bf16 v[214:217], v[170:173], a[200:203], v[214:217]
    ds_read_b128 v[170:173], v0 offset:33024
    v_cvt_pk_bf16_f32 v132, v202, v203
    v_mfma_f32_16x16x32_bf16 v[214:217], v[166:169], a[204:207], v[214:217]
    ds_read_b128 v[166:169], v1 offset:33024
    v_cvt_pk_bf16_f32 v133, v204, v205
    v_mfma_f32_16x16x32_bf16 v[214:217], v[194:197], a[208:211], v[214:217]
    v_mul_f32 v228, v191, v228
    v_mul_f32 v229, v191, v229
    v_mfma_f32_16x16x32_bf16 v[214:217], v[198:201], a[212:215], v[214:217]
    v_cvt_pk_f16_f32 v227, v228, v229
    v_mul_f32 v122, v191, v122
    v_mfma_f32_16x16x32_f16 v[194:197], v[218:221], v[210:213], v[46:49]
    s_waitcnt lgkmcnt(5)
    buffer_store_dwordx2 v[116:117], v18, s[12:15], 0 offen nt
    v_mul_f32 v123, v191, v123
    v_cvt_pk_f16_f32 v228, v122, v123
    v_mfma_f32_16x16x32_bf16 v[202:205], a[72:75], v[150:153], 0
    s_waitcnt lgkmcnt(3)
    v_cvt_pk_bf16_f32 v116, v214, v215
    v_cvt_pk_bf16_f32 v117, v216, v217
    v_mfma_f32_16x16x32_bf16 v[202:205], a[76:79], v[206:209], v[202:205]
    s_waitcnt lgkmcnt(2)
    v_mul_f32 v124, v191, v124
    v_mul_f32 v125, v191, v125
    v_mfma_f32_16x16x32_bf16 v[202:205], a[80:83], v[118:121], v[202:205]
    s_waitcnt lgkmcnt(1)
    v_cvt_pk_f16_f32 v229, v124, v125
    v_mul_f32 v126, v191, v126
    v_mfma_f32_16x16x32_bf16 v[202:205], a[84:87], v[134:137], v[202:205]
    s_waitcnt lgkmcnt(0)
    v_mul_f32 v127, v191, v127
    v_cvt_pk_f16_f32 v124, v126, v127
    v_mfma_f32_16x16x32_bf16 v[202:205], a[88:91], v[170:173], v[202:205]
    v_mul_f32 v128, v191, v128
    v_mul_f32 v129, v191, v129
    v_mfma_f32_16x16x32_bf16 v[202:205], a[92:95], v[166:169], v[202:205]
    v_cvt_pk_f16_f32 v125, v128, v129
    v_mul_f32 v154, v190, v154
    v_mfma_f32_16x16x32_bf16 v[126:129], a[96:99], v[150:153], 0
    v_mul_f32 v155, v190, v155
    v_cvt_pk_f16_f32 v154, v154, v155
    v_mfma_f32_16x16x32_bf16 v[126:129], a[100:103], v[206:209], v[126:129]
    v_mul_f32 v156, v190, v156
    v_mul_f32 v157, v190, v157
    v_mfma_f32_16x16x32_bf16 v[126:129], a[104:107], v[118:121], v[126:129]
    v_cvt_pk_f16_f32 v155, v156, v157
    v_mul_f32 v174, v190, v174
    v_mfma_f32_16x16x32_bf16 v[126:129], a[108:111], v[134:137], v[126:129]
    v_mul_f32 v175, v190, v175
    v_cvt_pk_f16_f32 v156, v174, v175
    v_mfma_f32_16x16x32_bf16 v[126:129], a[112:115], v[170:173], v[126:129]
    v_mul_f32 v176, v190, v176
    v_mul_f32 v177, v190, v177
    v_mfma_f32_16x16x32_bf16 v[126:129], a[116:119], v[166:169], v[126:129]
    v_cvt_pk_f16_f32 v157, v176, v177
    v_mul_f32 v182, v190, v182
    v_mfma_f32_16x16x32_bf16 v[174:177], a[120:123], v[150:153], 0
    v_mul_f32 v183, v190, v183
    v_cvt_pk_f16_f32 v122, v182, v183
    v_mfma_f32_16x16x32_bf16 v[174:177], a[124:127], v[206:209], v[174:177]
    v_mul_f32 v184, v190, v184
    v_mul_f32 v185, v190, v185
    v_mfma_f32_16x16x32_bf16 v[174:177], a[128:131], v[118:121], v[174:177]
    v_cvt_pk_f16_f32 v123, v184, v185
    v_fma_f32 v182, v202, v202, s32
    v_mfma_f32_16x16x32_bf16 v[174:177], a[132:135], v[134:137], v[174:177]
    v_fmac_f32 v182, v203, v203
    v_fmac_f32 v182, v204, v204
    v_mfma_f32_16x16x32_bf16 v[174:177], a[136:139], v[170:173], v[174:177]
    v_fmac_f32 v182, v205, v205
    v_fmac_f32 v182, v126, v126
    v_mfma_f32_16x16x32_bf16 v[174:177], a[140:143], v[166:169], v[174:177]
    v_fmac_f32 v182, v127, v127
    v_fmac_f32 v182, v128, v128
    v_mfma_f32_16x16x32_bf16 v[190:193], a[0:3], v[150:153], 0
    v_fmac_f32 v182, v129, v129
    v_mul_f32 v149, v255, v149
    v_mfma_f32_16x16x32_bf16 v[190:193], a[4:7], v[206:209], v[190:193]
    v_cvt_pk_bf16_f32 v147, v148, v149
    v_mul_f32 v138, v255, v138
    v_mfma_f32_16x16x32_bf16 v[190:193], a[8:11], v[118:121], v[190:193]
    v_fmac_f32 v182, v174, v174
    v_fmac_f32 v182, v175, v175
    v_mfma_f32_16x16x32_bf16 v[190:193], a[12:15], v[134:137], v[190:193]
    v_fmac_f32 v182, v176, v176
    v_fmac_f32 v182, v177, v177
    v_mfma_f32_16x16x32_bf16 v[190:193], a[16:19], v[170:173], v[190:193]
    v_mul_f32 v139, v255, v139
    v_cvt_pk_bf16_f32 v148, v138, v139
    v_mfma_f32_16x16x32_bf16 v[190:193], a[20:23], v[166:169], v[190:193]
    v_mul_f32 v140, v255, v140
    v_mul_f32 v141, v255, v141
    v_mfma_f32_16x16x32_bf16 v[198:201], a[24:27], v[150:153], 0
    v_cvt_pk_bf16_f32 v149, v140, v141
    v_mul_f32 v186, v255, v186
    v_mfma_f32_16x16x32_bf16 v[198:201], a[28:31], v[206:209], v[198:201]
    buffer_store_dwordx4 v[146:149], v17, s[12:15], 0 offen nt
    v_mul_f32 v187, v255, v187
    v_fma_f32 v183, v190, v190, s32
    v_fmac_f32 v183, v191, v191
    v_fmac_f32 v183, v192, v192
    v_mfma_f32_16x16x32_bf16 v[198:201], a[32:35], v[118:121], v[198:201]
    v_fmac_f32 v183, v193, v193
    v_cvt_pk_bf16_f32 v184, v186, v187
    v_mfma_f32_16x16x32_bf16 v[198:201], a[36:39], v[134:137], v[198:201]
    v_mul_f32 v188, v255, v188
    v_mul_f32 v189, v255, v189
    v_mfma_f32_16x16x32_bf16 v[198:201], a[40:43], v[170:173], v[198:201]
    v_cvt_pk_bf16_f32 v185, v188, v189
    v_mul_f32 v142, v254, v142
    v_mfma_f32_16x16x32_bf16 v[198:201], a[44:47], v[166:169], v[198:201]
    v_mul_f32 v143, v254, v143
    v_cvt_pk_bf16_f32 v142, v142, v143
    v_mfma_f32_16x16x32_bf16 v[138:141], a[48:51], v[150:153], 0
    v_mul_f32 v144, v254, v144
    v_mul_f32 v145, v254, v145
    v_mfma_f32_16x16x32_bf16 v[138:141], a[52:55], v[206:209], v[138:141]
    v_cvt_pk_bf16_f32 v143, v144, v145
    v_mul_f32 v158, v254, v158
    v_mfma_f32_16x16x32_bf16 v[138:141], a[56:59], v[118:121], v[138:141]
    v_fmac_f32 v183, v198, v198
    v_fmac_f32 v183, v199, v199
    v_mfma_f32_16x16x32_bf16 v[138:141], a[60:63], v[134:137], v[138:141]
    ds_read2_b32 v[216:217], v6 offset0:0 offset1:0
    ds_read2_b32 v[224:225], v6 offset0:16 offset1:16
    v_mfma_f32_16x16x32_bf16 v[138:141], a[64:67], v[170:173], v[138:141]
    ds_read2_b32 v[236:237], v6 offset0:32 offset1:32
    v_fmac_f32 v183, v200, v200
    v_mfma_f32_16x16x32_bf16 v[138:141], a[68:71], v[166:169], v[138:141]
    v_fmac_f32 v183, v201, v201
    v_mul_f32 v159, v254, v159
    v_mfma_f32_16x16x32_bf16 v[146:149], v[150:153], a[144:147], 0
    v_cvt_pk_bf16_f32 v144, v158, v159
    v_mul_f32 v160, v254, v160
    v_mfma_f32_16x16x32_bf16 v[146:149], v[206:209], a[148:151], v[146:149]
    v_mul_f32 v161, v254, v161
    v_cvt_pk_bf16_f32 v145, v160, v161
    v_mfma_f32_16x16x32_bf16 v[146:149], v[118:121], a[152:155], v[146:149]
    v_fmac_f32 v183, v138, v138
    v_fmac_f32 v183, v139, v139
    v_mfma_f32_16x16x32_bf16 v[146:149], v[134:137], a[156:159], v[146:149]
    v_fmac_f32 v183, v140, v140
    v_fmac_f32 v183, v141, v141
    v_mfma_f32_16x16x32_bf16 v[146:149], v[170:173], a[160:163], v[146:149]
    v_cvt_pk_bf16_f32 v36, v183, v182
    v_mul_f32 v178, v254, v178
    v_mfma_f32_16x16x32_bf16 v[146:149], v[166:169], a[164:167], v[146:149]
    s_waitcnt lgkmcnt(1)
    v_mul_f32 v179, v254, v179
    v_cvt_pk_bf16_f32 v178, v178, v179
    v_mfma_f32_16x16x32_bf16 v[158:161], v[32:35], v[36:39], 0
    s_waitcnt lgkmcnt(0)
    buffer_store_dwordx2 v[184:185], v20, s[12:15], 0 offen nt
    v_mul_f32 v180, v254, v180
    v_mul_f32 v181, v254, v181
    v_mfma_f32_16x16x32_bf16 v[186:189], v[150:153], a[168:171], 0
    v_cvt_pk_bf16_f32 v214, v146, v147
    v_cvt_pk_bf16_f32 v215, v148, v149
    v_mfma_f32_16x16x32_bf16 v[186:189], v[206:209], a[172:175], v[186:189]
    v_rsq_f32 v159, v159
    v_mfma_f32_16x16x32_bf16 v[186:189], v[118:121], a[176:179], v[186:189]
    v_rsq_f32 v158, v158
    v_mfma_f32_16x16x32_bf16 v[186:189], v[134:137], a[180:183], v[186:189]
    v_mul_f32 v158, s31, v158
    v_mul_f32 v202, v159, v202
    v_mfma_f32_16x16x32_bf16 v[186:189], v[170:173], a[184:187], v[186:189]
    v_mul_f32 v203, v159, v203
    v_cvt_pk_f16_f32 v146, v202, v203
    v_mfma_f32_16x16x32_bf16 v[186:189], v[166:169], a[188:191], v[186:189]
    v_mul_f32 v204, v159, v204
    v_mul_f32 v205, v159, v205
    v_mfma_f32_16x16x32_bf16 v[182:185], v[150:153], a[192:195], 0
    v_cvt_pk_f16_f32 v147, v204, v205
    v_mul_f32 v126, v159, v126
    v_mfma_f32_16x16x32_bf16 v[182:185], v[206:209], a[196:199], v[182:185]
    ds_read_b128 v[150:153], v5 offset:0
    ds_read_b128 v[202:205], v5 offset:16
    v_mfma_f32_16x16x32_bf16 v[182:185], v[118:121], a[200:203], v[182:185]
    ds_read_b128 v[118:121], v5 offset:48
    ds_read_b32 v254, v6 offset:192
    v_mfma_f32_16x16x32_bf16 v[182:185], v[134:137], a[204:207], v[182:185]
    v_cvt_pk_bf16_f32 v222, v186, v187
    v_cvt_pk_bf16_f32 v223, v188, v189
    v_mfma_f32_16x16x32_bf16 v[182:185], v[170:173], a[208:211], v[182:185]
    v_mul_f32 v127, v159, v127
    v_cvt_pk_f16_f32 v148, v126, v127
    v_mfma_f32_16x16x32_bf16 v[182:185], v[166:169], a[212:215], v[182:185]
    ds_read_b128 v[166:169], v2 offset:0
    ds_read_b128 v[170:173], v2 offset:1024
    v_mfma_f32_16x16x32_f16 v[186:189], v[226:229], v[210:213], v[50:53]
    ds_read_b128 v[134:137], v2 offset:2048
    v_mul_f32 v128, v159, v128
    v_mul_f32 v129, v159, v129
    v_mfma_f32_16x16x16_f16 v[194:197], v[164:165], v[162:163], v[194:197]
    v_cvt_pk_f16_f32 v149, v128, v129
    v_cvt_pk_bf16_f32 v234, v182, v183
    v_cvt_pk_bf16_f32 v235, v184, v185
    v_mul_f32 v174, v159, v174
    v_mfma_f32_16x16x32_f16 v[126:129], v[146:149], v[210:213], v[54:57]
    s_waitcnt lgkmcnt(5)
    v_mul_f32 v175, v159, v175
    v_cvt_pk_f16_f32 v184, v174, v175
    v_mul_f32 v176, v159, v176
    v_mfma_f32_16x16x16_f16 v[186:189], v[124:125], v[162:163], v[186:189]
    v_mul_f32 v177, v159, v177
    v_cvt_pk_f16_f32 v185, v176, v177
    v_mul_f32 v190, v158, v190
    v_mul_f32 v191, v158, v191
    v_mfma_f32_16x16x16_f16 v[126:129], v[184:185], v[162:163], v[126:129]
    v_cvt_pk_f16_f32 v174, v190, v191
    v_mul_f32 v192, v158, v192
    v_mul_f32 v193, v158, v193
    v_cvt_pk_f16_f32 v175, v192, v193
    v_mfma_f32_16x16x32_f16 v[206:209], v[150:153], v[210:213], v[22:25]
    s_waitcnt lgkmcnt(2)
    ds_read_b128 v[210:213], v2 offset:3072
    buffer_store_dwordx4 v[142:145], v16, s[12:15], 0 offen nt
    ds_read_b128 v[238:241], v2 offset:4096
    v_mul_f32 v198, v158, v198
    v_mul_f32 v199, v158, v199
    v_cvt_pk_f16_f32 v176, v198, v199
    v_mfma_f32_16x16x32_f16 v[206:209], v[202:205], v[218:221], v[206:209]
    s_waitcnt lgkmcnt(2)
    v_mul_f32 v200, v158, v200
    v_mul_f32 v201, v158, v201
    v_mfma_f32_16x16x32_f16 v[206:209], v[118:121], v[162:165], v[206:209]
    ds_read_b128 v[142:145], v2 offset:5120
    v_cvt_pk_f16_f32 v177, v200, v201
    v_mul_f32 v138, v158, v138
    v_mul_f32 v139, v158, v139
    v_cvt_pk_f16_f32 v182, v138, v139
    v_mfma_f32_16x16x32_f16 v[198:201], v[150:153], v[154:157], v[24:27]
    v_mul_f32 v140, v158, v140
    v_mul_f32 v141, v158, v141
    v_mfma_f32_16x16x32_f16 v[198:201], v[202:205], v[226:229], v[198:201]
    v_mov_b32_dpp v254, v207 quad_perm:[0,1,2,3] row_mask:0x1 bank_mask:0xf
    v_cvt_pk_f16_f32 v183, v140, v141
    v_mfma_f32_16x16x32_f16 v[198:201], v[118:121], v[122:125], v[198:201]
    v_max3_f32 v255, v206, v194, v195
    v_max3_f32 v255, v255, v196, v197
    v_mfma_f32_16x16x32_f16 v[242:245], v[150:153], v[174:177], v[26:29]
    s_waitcnt lgkmcnt(1)
    v_max3_f32 v255, v255, v186, v187
    v_max3_f32 v255, v255, v188, v189
    v_mfma_f32_16x16x32_f16 v[242:245], v[202:205], v[146:149], v[242:245]
    v_max3_f32 v255, v255, v126, v127
    v_mov_b32_dpp v254, v199 quad_perm:[0,1,2,3] row_mask:0x2 bank_mask:0xf
    v_mfma_f32_16x16x32_f16 v[242:245], v[118:121], v[182:185], v[242:245]
    v_max3_f32 v255, v255, v128, v129
    v_mov_b32 v162, v255
    v_mfma_f32_16x16x32_bf16 v[150:153], a[216:219], v[166:169], 0
    s_waitcnt lgkmcnt(0)
    v_permlane32_swap_b32 v255, v162
    v_mfma_f32_16x16x32_bf16 v[150:153], a[220:223], v[170:173], v[150:153]
    v_max_f32 v255, v255, v162
    v_mov_b32 v162, v255
    v_mfma_f32_16x16x32_bf16 v[150:153], a[224:227], v[134:137], v[150:153]
    v_cvt_pk_bf16_f32 v179, v180, v181
    v_xor_b32 v0, 65536, v0
    v_mfma_f32_16x16x32_bf16 v[150:153], a[228:231], v[210:213], v[150:153]
    s_waitcnt vmcnt(5)
    v_permlane16_swap_b32 v255, v162
    v_mfma_f32_16x16x32_bf16 v[150:153], a[232:235], v[238:241], v[150:153]
    v_max_f32 v255, v255, v162
    v_sub_f32 v194, v194, v255
    v_mfma_f32_16x16x32_bf16 v[150:153], a[236:239], v[142:145], v[150:153]
    v_exp_f32 v194, v194
    v_mfma_f32_16x16x32_bf16 v[190:193], a[240:243], v[166:169], 0
    s_barrier
    v_sub_f32 v195, v195, v255
    v_sub_f32 v196, v196, v255
    v_mfma_f32_16x16x32_bf16 v[190:193], a[244:247], v[170:173], v[190:193]
    buffer_load_dwordx4 v10, s[8:11], 0 offen nt lds
    v_sub_f32 v197, v197, v255
    v_mfma_f32_16x16x32_bf16 v[190:193], a[248:251], v[134:137], v[190:193]
    s_add_u32 m0, s28, 4096
    v_exp_f32 v195, v195
    v_mfma_f32_16x16x32_bf16 v[190:193], a[252:255], v[210:213], v[190:193]
    v_cvt_pk_bf16_f32 v158, v194, v195
    v_sub_f32 v186, v186, v255
    v_mfma_f32_16x16x32_bf16 v[190:193], v[82:85], v[238:241], v[190:193]
    v_exp_f32 v196, v196
    v_mfma_f32_16x16x32_bf16 v[190:193], v[86:89], v[142:145], v[190:193]
    v_exp_f32 v197, v197
    v_mfma_f32_16x16x32_bf16 v[202:205], v[90:93], v[166:169], 0
    ds_read_b128 v[166:169], v2 offset:6144
    buffer_load_dwordx4 v11, s[8:11], 0 offen nt lds
    v_mfma_f32_16x16x32_bf16 v[202:205], v[94:97], v[170:173], v[202:205]
    s_add_u32 m0, s28, 8192
    ds_read_b128 v[170:173], v2 offset:7168
    v_cvt_pk_bf16_f32 v159, v196, v197
    v_mfma_f32_16x16x32_bf16 v[202:205], v[98:101], v[134:137], v[202:205]
    ds_read_b128 v[138:141], v2 offset:8192
    v_sub_f32 v187, v187, v255
    v_mfma_f32_16x16x32_bf16 v[202:205], v[102:105], v[210:213], v[202:205]
    ds_read_b128 v[210:213], v2 offset:9216
    v_sub_f32 v188, v188, v255
    v_mfma_f32_16x16x32_bf16 v[202:205], v[106:109], v[238:241], v[202:205]
    ds_read_b128 v[134:137], v2 offset:10240
    v_sub_f32 v189, v189, v255
    v_mfma_f32_16x16x32_bf16 v[202:205], v[110:113], v[142:145], v[202:205]
    ds_read_b128 v[194:197], v2 offset:11264
    buffer_load_dwordx4 v12, s[8:11], 0 offen nt lds
    v_exp_f32 v186, v186
    v_mfma_f32_16x16x32_f16 v[118:121], v[218:221], v[154:157], v[58:61]
    s_add_u32 m0, s28, 12288
    v_exp_f32 v187, v187
    v_exp_f32 v188, v188
    v_cvt_pk_bf16_f32 v160, v186, v187
    v_exp_f32 v189, v189
    v_sub_f32 v126, v126, v255
    v_mfma_f32_16x16x16_f16 v[118:121], v[164:165], v[122:123], v[118:121]
    v_cvt_pk_bf16_f32 v161, v188, v189
    v_exp_f32 v126, v126
    v_sub_f32 v127, v127, v255
    v_mfma_f32_16x16x32_f16 v[186:189], v[226:229], v[154:157], v[62:65]
    s_xor_b32 s28, s28, 65536
    buffer_load_dwordx4 v13, s[8:11], 0 offen nt lds
    v_exp_f32 v127, v127
    v_sub_f32 v128, v128, v255
    v_cvt_pk_bf16_f32 v36, v126, v127
    v_exp_f32 v128, v128
    v_mfma_f32_16x16x16_f16 v[186:189], v[124:125], v[122:123], v[186:189]
    v_sub_f32 v129, v129, v255
    v_exp_f32 v129, v129
    v_sub_f32 v206, v206, v255
    v_cvt_pk_bf16_f32 v37, v128, v129
    v_mfma_f32_16x16x32_f16 v[126:129], v[146:149], v[154:157], v[66:69]
    s_waitcnt lgkmcnt(0)
    v_exp_f32 v206, v206
    v_mfma_f32_16x16x32_bf16 v[142:145], a[216:219], v[166:169], 0
    s_mov_b32 m0, s29
    v_cvt_pk_bf16_f32 v39, v206, 0
    v_max3_f32 v255, v198, v118, v119
    v_max3_f32 v255, v255, v120, v121
    v_mfma_f32_16x16x16_f16 v[126:129], v[184:185], v[122:123], v[126:129]
    v_max3_f32 v255, v255, v186, v187
    v_max3_f32 v255, v255, v188, v189
    v_xor_b32 v1, 65536, v1
    v_mov_b32_dpp v254, v243 quad_perm:[0,1,2,3] row_mask:0x4 bank_mask:0xf
    v_mfma_f32_16x16x32_bf16 v[154:157], v[28:31], v[36:39], 0
    s_xor_b32 s29, s29, s30
    buffer_store_dwordx2 v[178:179], v19, s[12:15], 0 offen nt
    v_mov_b32 v122, v254
    v_max3_f32 v255, v255, v126, v127
    v_mfma_f32_16x16x32_bf16 v[154:157], v[28:31], v[158:161], v[154:157]
    s_add_u32 s19, s19, s20
    v_max3_f32 v255, v255, v128, v129
    v_mov_b32 v123, v255
    v_mfma_f32_16x16x32_bf16 v[142:145], a[220:223], v[170:173], v[142:145]
    s_add_u32 s23, s23, s21
    v_permlane32_swap_b32 v255, v123
    v_mfma_f32_16x16x32_bf16 v[142:145], a[224:227], v[138:141], v[142:145]
    s_cmp_ge_u32 s19, 72
    v_rcp_f32 v154, v154
    v_mfma_f32_16x16x32_bf16 v[142:145], a[228:231], v[210:213], v[142:145]
    s_cselect_b32 s34, 72, 0
    v_max_f32 v255, v255, v123
    v_mov_b32 v123, v255
    v_mfma_f32_16x16x32_bf16 v[142:145], a[232:235], v[134:137], v[142:145]
    s_cselect_b32 s35, s22, 0
    v_permlane16_swap_b32 v255, v123
    v_mfma_f32_16x16x32_bf16 v[142:145], a[236:239], v[194:197], v[142:145]
    s_sub_u32 s19, s19, s34
    v_max_f32 v255, v255, v123
    v_sub_f32 v118, v118, v255
    v_mfma_f32_16x16x32_bf16 v[178:181], v[214:217], v[36:39], 0
    s_add_u32 s23, s23, s35
    v_exp_f32 v118, v118
    v_mfma_f32_16x16x32_bf16 v[178:181], v[230:233], v[158:161], v[178:181]
    s_add_u32 s18, s18, 1
    v_sub_f32 v119, v119, v255
    v_exp_f32 v119, v119
    v_sub_f32 v120, v120, v255
    v_cvt_pk_bf16_f32 v118, v118, v119
    v_exp_f32 v120, v120
    v_sub_f32 v121, v121, v255
    v_exp_f32 v121, v121
    v_mul_f32 v178, v154, v178
    v_mul_f32 v179, v154, v179
    v_cvt_pk_bf16_f32 v178, v178, v179
    v_mul_f32 v180, v154, v180
    v_mul_f32 v181, v154, v181
    v_cvt_pk_bf16_f32 v179, v180, v181
    v_cvt_pk_bf16_f32 v119, v120, v121
    v_mfma_f32_16x16x32_bf16 v[206:209], v[222:225], v[36:39], 0
    s_cmp_lt_u32 s18, s45
    v_sub_f32 v186, v186, v255
    v_sub_f32 v187, v187, v255
    v_mfma_f32_16x16x32_bf16 v[206:209], v[130:133], v[158:161], v[206:209]
    v_exp_f32 v186, v186
    v_exp_f32 v187, v187
    v_sub_f32 v188, v188, v255
    v_cvt_pk_bf16_f32 v120, v186, v187
    v_exp_f32 v188, v188
    v_sub_f32 v189, v189, v255
    v_exp_f32 v189, v189
    v_sub_f32 v126, v126, v255
    v_mul_f32 v206, v154, v206
    v_mul_f32 v207, v154, v207
    v_cvt_pk_bf16_f32 v180, v206, v207
    v_mul_f32 v208, v154, v208
    v_mul_f32 v209, v154, v209
    v_cvt_pk_bf16_f32 v181, v208, v209
    v_cvt_pk_bf16_f32 v121, v188, v189
    v_mfma_f32_16x16x32_bf16 v[186:189], v[234:237], v[36:39], 0
    v_sub_f32 v127, v127, v255
    v_mfma_f32_16x16x32_bf16 v[186:189], v[114:117], v[158:161], v[186:189]
    ds_write_b128 v3, v[178:181] offset:0
    v_mfma_f32_16x16x32_bf16 v[158:161], a[240:243], v[166:169], 0
    v_exp_f32 v126, v126
    v_mfma_f32_16x16x32_bf16 v[158:161], a[244:247], v[170:173], v[158:161]
    v_exp_f32 v127, v127
    v_mfma_f32_16x16x32_bf16 v[158:161], a[248:251], v[138:141], v[158:161]
    v_cvt_pk_bf16_f32 v36, v126, v127
    v_sub_f32 v128, v128, v255
    v_mfma_f32_16x16x32_bf16 v[158:161], a[252:255], v[210:213], v[158:161]
    v_mul_f32 v186, v154, v186
    v_mul_f32 v187, v154, v187
    v_mfma_f32_16x16x32_bf16 v[158:161], v[82:85], v[134:137], v[158:161]
    v_cvt_pk_bf16_f32 v126, v186, v187
    v_mul_f32 v188, v154, v188
    v_mfma_f32_16x16x32_bf16 v[158:161], v[86:89], v[194:197], v[158:161]
    v_mul_f32 v189, v154, v189
    v_cvt_pk_bf16_f32 v127, v188, v189
    v_mfma_f32_16x16x32_bf16 v[178:181], v[90:93], v[166:169], 0
    ds_read_b128 v[166:169], v2 offset:12288
    v_sub_f32 v129, v129, v255
    v_mfma_f32_16x16x32_bf16 v[178:181], v[94:97], v[170:173], v[178:181]
    ds_read_b128 v[170:173], v2 offset:13312
    v_sub_f32 v198, v198, v255
    v_mfma_f32_16x16x32_bf16 v[178:181], v[98:101], v[138:141], v[178:181]
    ds_read_b128 v[154:157], v2 offset:14336
    v_max_f32_dpp v122, v122, v122 quad_perm:[1,0,3,2] row_mask:0xf bank_mask:0xf
    v_mfma_f32_16x16x32_bf16 v[178:181], v[102:105], v[210:213], v[178:181]
    ds_read_b128 v[210:213], v2 offset:15360
    v_max_f32_dpp v122, v122, v122 quad_perm:[2,3,0,1] row_mask:0xf bank_mask:0xf
    v_mfma_f32_16x16x32_bf16 v[178:181], v[106:109], v[134:137], v[178:181]
    ds_read_b128 v[134:137], v2 offset:16384
    v_max_f32_dpp v122, v122, v122 row_half_mirror row_mask:0xf bank_mask:0xf
    v_mfma_f32_16x16x32_bf16 v[178:181], v[110:113], v[194:197], v[178:181]
    ds_read_b128 v[194:197], v2 offset:17408
    ds_write_b64 v4, v[126:127] offset:4096
    v_exp_f32 v128, v128
    v_exp_f32 v129, v129
    v_mfma_f32_16x16x32_f16 v[186:189], v[218:221], v[174:177], v[70:73]
    s_waitcnt lgkmcnt(6)
    v_cvt_pk_bf16_f32 v37, v128, v129
    v_max_f32_dpp v122, v122, v122 row_mirror row_mask:0xf bank_mask:0xf
    v_mfma_f32_16x16x32_f16 v[218:221], v[226:229], v[174:177], v[74:77]
    s_waitcnt lgkmcnt(5)
    v_exp_f32 v198, v198
    v_mfma_f32_16x16x32_f16 v[126:129], v[146:149], v[174:177], v[78:81]
    s_waitcnt lgkmcnt(4)
    v_cvt_pk_bf16_f32 v39, v198, 0
    v_mov_b32 v123, v122
    v_fma_f32 v255, v150, v150, s33
    v_mfma_f32_16x16x32_bf16 v[174:177], v[28:31], v[36:39], 0
    s_waitcnt lgkmcnt(3)
    v_permlane32_swap_b32 v122, v123
    v_mfma_f32_16x16x32_bf16 v[174:177], v[28:31], v[118:121], v[174:177]
    s_waitcnt lgkmcnt(2)
    v_max_f32 v122, v122, v123
    v_mov_b32 v123, v122
    v_mfma_f32_16x16x32_bf16 v[226:229], v[214:217], v[36:39], 0
    s_waitcnt lgkmcnt(0)
    v_permlane16_swap_b32 v122, v123
    v_mfma_f32_16x16x32_bf16 v[226:229], v[230:233], v[118:121], v[226:229]
    v_max_f32 v122, v122, v123
    v_sub_f32 v254, v254, v122
    v_mfma_f32_16x16x32_bf16 v[198:201], v[222:225], v[36:39], 0
    v_exp_f32 v254, v254
    v_mfma_f32_16x16x32_bf16 v[198:201], v[130:133], v[118:121], v[198:201]
    v_cvt_pk_bf16_f32 v254, v254, v254
    v_fmac_f32 v255, v151, v151
    v_mfma_f32_16x16x32_bf16 v[206:209], v[234:237], v[36:39], 0
    ds_write_b16 v8, v254
    v_mfma_f32_16x16x32_bf16 v[206:209], v[114:117], v[118:121], v[206:209]
    v_rcp_f32 v174, v174
    v_fmac_f32 v255, v152, v152
    v_mfma_f32_16x16x16_f16 v[186:189], v[164:165], v[182:183], v[186:189]
    v_mul_f32 v226, v174, v226
    v_mul_f32 v227, v174, v227
    v_cvt_pk_bf16_f32 v122, v226, v227
    v_mfma_f32_16x16x16_f16 v[218:221], v[124:125], v[182:183], v[218:221]
    v_mul_f32 v228, v174, v228
    v_mul_f32 v229, v174, v229
    v_cvt_pk_bf16_f32 v123, v228, v229
    v_mfma_f32_16x16x16_f16 v[126:129], v[184:185], v[182:183], v[126:129]
    v_max3_f32 v254, v242, v186, v187
    v_max3_f32 v254, v254, v188, v189
    v_mul_f32 v198, v174, v198
    v_mul_f32 v199, v174, v199
    v_mfma_f32_16x16x32_bf16 v[146:149], a[216:219], v[166:169], 0
    ds_read_b128 v[182:185], v9
    ds_read_b128 v[118:121], v9 offset:64
    v_mfma_f32_16x16x32_bf16 v[146:149], a[220:223], v[170:173], v[146:149]
    v_max3_f32 v254, v254, v218, v219
    v_max3_f32 v254, v254, v220, v221
    v_mfma_f32_16x16x32_bf16 v[146:149], a[224:227], v[154:157], v[146:149]
    v_max3_f32 v254, v254, v126, v127
    v_max3_f32 v254, v254, v128, v129
    v_mfma_f32_16x16x32_bf16 v[146:149], a[228:231], v[210:213], v[146:149]
    v_mov_b32 v125, v254
    v_cvt_pk_bf16_f32 v124, v198, v199
    v_mfma_f32_16x16x32_bf16 v[146:149], a[232:235], v[134:137], v[146:149]
    v_permlane32_swap_b32 v254, v125
    v_mfma_f32_16x16x32_bf16 v[146:149], a[236:239], v[194:197], v[146:149]
    v_max_f32 v254, v254, v125
    v_mov_b32 v125, v254
    v_mfma_f32_16x16x32_bf16 v[138:141], a[240:243], v[166:169], 0
    v_mul_f32 v200, v174, v200
    v_mul_f32 v201, v174, v201
    v_mfma_f32_16x16x32_bf16 v[138:141], a[244:247], v[170:173], v[138:141]
    v_permlane16_swap_b32 v254, v125
    v_mfma_f32_16x16x32_bf16 v[138:141], a[248:251], v[154:157], v[138:141]
    s_waitcnt lgkmcnt(0)
    v_max_f32 v254, v254, v125
    v_sub_f32 v186, v186, v254
    v_mfma_f32_16x16x32_bf16 v[138:141], a[252:255], v[210:213], v[138:141]
    v_exp_f32 v186, v186
    v_mfma_f32_16x16x32_bf16 v[138:141], v[82:85], v[134:137], v[138:141]
    v_sub_f32 v187, v187, v254
    v_sub_f32 v188, v188, v254
    v_mfma_f32_16x16x32_bf16 v[138:141], v[86:89], v[194:197], v[138:141]
    v_exp_f32 v187, v187
    v_exp_f32 v188, v188
    v_cvt_pk_bf16_f32 v238, v186, v187
    v_sub_f32 v189, v189, v254
    v_exp_f32 v189, v189
    v_sub_f32 v218, v218, v254
    v_cvt_pk_bf16_f32 v239, v188, v189
    v_exp_f32 v218, v218
    v_sub_f32 v219, v219, v254
    v_exp_f32 v219, v219
    v_sub_f32 v220, v220, v254
    v_cvt_pk_bf16_f32 v240, v218, v219
    v_mfma_f32_16x16x32_bf16 v[186:189], v[90:93], v[166:169], 0
    v_exp_f32 v220, v220
    v_mfma_f32_16x16x32_bf16 v[186:189], v[94:97], v[170:173], v[186:189]
    v_sub_f32 v221, v221, v254
    v_sub_f32 v126, v126, v254
    v_mfma_f32_16x16x32_bf16 v[186:189], v[98:101], v[154:157], v[186:189]
    v_exp_f32 v221, v221
    v_mfma_f32_16x16x32_bf16 v[186:189], v[102:105], v[210:213], v[186:189]
    v_cvt_pk_bf16_f32 v241, v220, v221
    v_sub_f32 v127, v127, v254
    v_mfma_f32_16x16x32_bf16 v[186:189], v[106:109], v[134:137], v[186:189]
    v_exp_f32 v126, v126
    v_mfma_f32_16x16x32_bf16 v[186:189], v[110:113], v[194:197], v[186:189]
    ds_read_b128 v[170:173], v0 offset:20480
    ds_read_b128 v[166:169], v1 offset:20480
    v_mfma_f32_16x16x32_bf16 v[154:157], v[182:185], v[28:31], 0
    ds_read_b128 v[162:165], v0 offset:20608
    ds_read_b128 v[210:213], v1 offset:20608
    v_mfma_f32_16x16x32_bf16 v[154:157], v[118:121], v[28:31], v[154:157]
    v_exp_f32 v127, v127
    v_mfma_f32_16x16x32_bf16 v[134:137], v[182:185], v[230:233], 0
    ds_read_b128 v[226:229], v0 offset:20736
    v_cvt_pk_bf16_f32 v36, v126, v127
    v_mfma_f32_16x16x32_bf16 v[134:137], v[118:121], v[214:217], v[134:137]
    ds_read_b128 v[218:221], v1 offset:20736
    v_sub_f32 v128, v128, v254
    v_exp_f32 v128, v128
    v_sub_f32 v129, v129, v254
    v_exp_f32 v129, v129
    v_sub_f32 v242, v242, v254
    v_cvt_pk_bf16_f32 v37, v128, v129
    v_mfma_f32_16x16x32_bf16 v[194:197], v[182:185], v[130:133], 0
    v_exp_f32 v242, v242
    v_mfma_f32_16x16x32_bf16 v[194:197], v[118:121], v[222:225], v[194:197]
    s_waitcnt lgkmcnt(4)
    v_cvt_pk_bf16_f32 v39, v242, 0
    v_cvt_pk_bf16_f32 v125, v200, v201
    v_mfma_f32_16x16x32_bf16 v[198:201], v[182:185], v[114:117], 0
    s_waitcnt lgkmcnt(2)
    ds_write_b128 v3, v[122:125] offset:6144
    v_mfma_f32_16x16x32_bf16 v[126:129], v[28:31], v[36:39], 0
    s_waitcnt lgkmcnt(2)
    v_mul_f32 v206, v174, v206
    v_mul_f32 v207, v174, v207
    v_mfma_f32_16x16x32_bf16 v[126:129], v[28:31], v[238:241], v[126:129]
    s_waitcnt lgkmcnt(1)
    v_cvt_pk_bf16_f32 v206, v206, v207
    v_mul_f32 v208, v174, v208
    v_mfma_f32_16x16x32_bf16 v[122:125], v[214:217], v[36:39], 0
    v_mul_f32 v209, v174, v209
    v_cvt_pk_bf16_f32 v207, v208, v209
    v_mfma_f32_16x16x32_bf16 v[122:125], v[230:233], v[238:241], v[122:125]
    ds_write_b64 v4, v[206:207] offset:10240
    v_mfma_f32_16x16x32_bf16 v[230:233], v[222:225], v[36:39], 0
    v_rcp_f32 v126, v126
    v_mfma_f32_16x16x32_bf16 v[230:233], v[130:133], v[238:241], v[230:233]
    v_fma_f32 v254, v146, v146, s33
    v_fmac_f32 v254, v147, v147
    v_mfma_f32_16x16x32_bf16 v[174:177], v[234:237], v[36:39], 0
    v_fmac_f32 v254, v148, v148
    v_mul_f32 v122, v126, v122
    v_mfma_f32_16x16x32_bf16 v[174:177], v[114:117], v[238:241], v[174:177]
    v_mul_f32 v123, v126, v123
    v_cvt_pk_bf16_f32 v122, v122, v123
    v_mfma_f32_16x16x32_bf16 v[198:201], v[118:121], v[234:237], v[198:201]
    v_mul_f32 v124, v126, v124
    v_mul_f32 v125, v126, v125
    v_mfma_f32_16x16x32_bf16 v[114:117], a[72:75], v[170:173], 0
    v_cvt_pk_bf16_f32 v123, v124, v125
    v_mul_f32 v230, v126, v230
    v_mfma_f32_16x16x32_bf16 v[114:117], a[76:79], v[166:169], v[114:117]
    v_mul_f32 v231, v126, v231
    v_cvt_pk_bf16_f32 v124, v230, v231
    v_mfma_f32_16x16x32_bf16 v[114:117], a[80:83], v[162:165], v[114:117]
    v_mul_f32 v232, v126, v232
    v_mul_f32 v233, v126, v233
    v_mfma_f32_16x16x32_bf16 v[114:117], a[84:87], v[210:213], v[114:117]
    v_cvt_pk_bf16_f32 v125, v232, v233
    v_mul_f32 v174, v126, v174
    v_mfma_f32_16x16x32_bf16 v[114:117], a[88:91], v[226:229], v[114:117]
    ds_write_b128 v3, v[122:125] offset:12288
    v_mfma_f32_16x16x32_bf16 v[114:117], a[92:95], v[218:221], v[114:117]
    v_mul_f32 v175, v126, v175
    v_cvt_pk_bf16_f32 v174, v174, v175
    v_mfma_f32_16x16x32_bf16 v[122:125], a[96:99], v[170:173], 0
    v_mul_f32 v176, v126, v176
    v_mul_f32 v177, v126, v177
    v_mfma_f32_16x16x32_bf16 v[122:125], a[100:103], v[166:169], v[122:125]
    v_cvt_pk_bf16_f32 v175, v176, v177
    v_fmac_f32 v254, v149, v149
    v_mfma_f32_16x16x32_bf16 v[122:125], a[104:107], v[162:165], v[122:125]
    ds_write_b64 v4, v[174:175] offset:16384
    v_mfma_f32_16x16x32_bf16 v[122:125], a[108:111], v[210:213], v[122:125]
    v_fmac_f32 v254, v138, v138
    v_fmac_f32 v254, v139, v139
    v_mfma_f32_16x16x32_bf16 v[122:125], a[112:115], v[226:229], v[122:125]
    v_fmac_f32 v254, v140, v140
    v_fmac_f32 v254, v141, v141
    v_mfma_f32_16x16x32_bf16 v[122:125], a[116:119], v[218:221], v[122:125]
    v_fmac_f32 v254, v186, v186
    v_fmac_f32 v254, v187, v187
    v_mfma_f32_16x16x32_bf16 v[126:129], a[120:123], v[170:173], 0
    v_fmac_f32 v254, v188, v188
    v_fmac_f32 v254, v189, v189
    v_mfma_f32_16x16x32_bf16 v[126:129], a[124:127], v[166:169], v[126:129]
    v_cvt_pk_bf16_f32 v135, v254, v254
    v_fmac_f32 v255, v153, v153
    v_mfma_f32_16x16x32_bf16 v[126:129], a[128:131], v[162:165], v[126:129]
    v_rcp_f32 v154, v154
    v_mfma_f32_16x16x32_bf16 v[126:129], a[132:135], v[210:213], v[126:129]
    v_mul_f32 v134, v134, v154
    v_mul_f32_dpp v134, v194, v154 quad_perm:[0,1,2,3] row_mask:0x2 bank_mask:0xf
    v_mfma_f32_16x16x32_bf16 v[126:129], a[136:139], v[226:229], v[126:129]
    v_mul_f32_dpp v134, v198, v154 quad_perm:[0,1,2,3] row_mask:0x4 bank_mask:0xf
    v_cvt_pk_bf16_f32 v134, v134, v134
    v_mfma_f32_16x16x32_bf16 v[126:129], a[140:143], v[218:221], v[126:129]
    ds_write_b16 v7, v134
    v_mfma_f32_16x16x32_bf16 v[154:157], a[0:3], v[170:173], 0
    v_fmac_f32 v255, v190, v190
    v_fmac_f32 v255, v191, v191
    v_mfma_f32_16x16x32_bf16 v[154:157], a[4:7], v[166:169], v[154:157]
    v_fmac_f32 v255, v192, v192
    v_fmac_f32 v255, v193, v193
    v_mfma_f32_16x16x32_bf16 v[154:157], a[8:11], v[162:165], v[154:157]
    v_fmac_f32 v255, v202, v202
    v_fmac_f32 v255, v203, v203
    v_mfma_f32_16x16x32_bf16 v[154:157], a[12:15], v[210:213], v[154:157]
    v_fmac_f32 v255, v204, v204
    v_fmac_f32 v255, v205, v205
    v_mfma_f32_16x16x32_bf16 v[154:157], a[16:19], v[226:229], v[154:157]
    v_fma_f32 v254, v142, v142, s33
    v_fmac_f32 v254, v143, v143
    v_mfma_f32_16x16x32_bf16 v[154:157], a[20:23], v[218:221], v[154:157]
    v_fmac_f32 v254, v144, v144
    v_fmac_f32 v254, v145, v145
    v_mfma_f32_16x16x32_bf16 v[174:177], a[24:27], v[170:173], 0
    v_fmac_f32 v254, v158, v158
    v_fmac_f32 v254, v159, v159
    v_mfma_f32_16x16x32_bf16 v[174:177], a[28:31], v[166:169], v[174:177]
    v_fmac_f32 v254, v160, v160
    v_fmac_f32 v254, v161, v161
    v_mfma_f32_16x16x32_bf16 v[174:177], a[32:35], v[162:165], v[174:177]
    v_fmac_f32 v254, v178, v178
    v_fmac_f32 v254, v179, v179
    v_mfma_f32_16x16x32_bf16 v[174:177], a[36:39], v[210:213], v[174:177]
    v_fmac_f32 v254, v180, v180
    v_fmac_f32 v254, v181, v181
    v_mfma_f32_16x16x32_bf16 v[174:177], a[40:43], v[226:229], v[174:177]
    v_cvt_pk_bf16_f32 v134, v255, v254
    v_add_u32 v5, 336, v5
    v_mfma_f32_16x16x32_bf16 v[174:177], a[44:47], v[218:221], v[174:177]
    ds_write_b64 v4, v[134:135] offset:18432
    v_mfma_f32_16x16x32_bf16 v[182:185], a[48:51], v[170:173], 0
    v_add_u32 v6, 272, v6
    v_add_u32 v7, 16, v7
    v_mfma_f32_16x16x32_bf16 v[182:185], a[52:55], v[166:169], v[182:185]
    v_fma_f32 v130, v114, v114, s32
    v_fmac_f32 v130, v115, v115
    v_mfma_f32_16x16x32_bf16 v[182:185], a[56:59], v[162:165], v[182:185]
    v_fmac_f32 v130, v116, v116
    v_fmac_f32 v130, v117, v117
    v_mfma_f32_16x16x32_bf16 v[182:185], a[60:63], v[210:213], v[182:185]
    v_fmac_f32 v130, v122, v122
    v_fmac_f32 v130, v123, v123
    v_mfma_f32_16x16x32_bf16 v[182:185], a[64:67], v[226:229], v[182:185]
    v_fmac_f32 v130, v124, v124
    v_fmac_f32 v130, v125, v125
    v_mfma_f32_16x16x32_bf16 v[182:185], a[68:71], v[218:221], v[182:185]
    v_fmac_f32 v130, v126, v126
    v_fmac_f32 v130, v127, v127
    v_mfma_f32_16x16x32_bf16 v[230:233], v[170:173], a[144:147], 0
    s_waitcnt lgkmcnt(0)
    v_fmac_f32 v130, v128, v128
    v_fmac_f32 v130, v129, v129
    v_mfma_f32_16x16x32_bf16 v[230:233], v[166:169], a[148:151], v[230:233]
    v_fma_f32 v131, v154, v154, s32
    v_fmac_f32 v131, v155, v155
    v_mfma_f32_16x16x32_bf16 v[230:233], v[162:165], a[152:155], v[230:233]
    v_fmac_f32 v131, v156, v156
    v_fmac_f32 v131, v157, v157
    v_mfma_f32_16x16x32_bf16 v[230:233], v[210:213], a[156:159], v[230:233]
    s_barrier
    v_fmac_f32 v131, v174, v174
    v_xor_b32 v2, 65536, v2
    v_mfma_f32_16x16x32_bf16 v[230:233], v[226:229], a[160:163], v[230:233]
    s_nop 0
    v_xor_b32 v3, 65536, v3
    v_xor_b32 v4, 65536, v4
    v_mfma_f32_16x16x32_bf16 v[230:233], v[218:221], a[164:167], v[230:233]
    s_cbranch_scc1 L_loop_safe2
    s_branch L_final_safe
.p2align 6
L_loop_safe3:
    v_mfma_f32_16x16x32_bf16 v[194:197], v[170:173], a[168:171], 0
    s_add_u32 s12, s42, s27
    ds_read_b128 v[198:201], v2 offset:18432
    ds_read_b128 v[214:217], v2 offset:19456
    v_mfma_f32_16x16x32_bf16 v[194:197], v[166:169], a[172:175], v[194:197]
    s_addc_u32 s13, s43, 0
    v_fmac_f32 v131, v175, v175
    v_fmac_f32 v131, v176, v176
    v_mfma_f32_16x16x32_bf16 v[194:197], v[162:165], a[176:179], v[194:197]
    s_sub_u32 s14, s36, s27
    v_fmac_f32 v131, v177, v177
    v_fmac_f32 v131, v182, v182
    v_mfma_f32_16x16x32_bf16 v[194:197], v[210:213], a[180:183], v[194:197]
    s_cmp_ge_u32 s18, 2
    v_fmac_f32 v131, v183, v183
    v_fmac_f32 v131, v184, v184
    v_mfma_f32_16x16x32_bf16 v[194:197], v[226:229], a[184:187], v[194:197]
    s_cselect_b32 s14, s14, 0
    ds_read_b128 v[118:121], v0 offset:26624
    v_fmac_f32 v131, v185, v185
    v_mfma_f32_16x16x32_bf16 v[194:197], v[218:221], a[188:191], v[194:197]
    s_add_u32 s34, s18, 2
    ds_read_b128 v[134:137], v1 offset:26624
    v_cvt_pk_bf16_f32 v36, v131, v130
    v_mfma_f32_16x16x32_bf16 v[234:237], v[170:173], a[192:195], 0
    s_add_u32 s8, s40, s23
    ds_read_b128 v[170:173], v0 offset:26752
    v_cvt_pk_bf16_f32 v230, v230, v231
    v_mfma_f32_16x16x32_bf16 v[234:237], v[166:169], a[196:199], v[234:237]
    s_addc_u32 s9, s41, 0
    ds_read_b128 v[166:169], v1 offset:26752
    v_cvt_pk_bf16_f32 v231, v232, v233
    v_mfma_f32_16x16x32_bf16 v[222:225], v[32:35], v[36:39], 0
    s_sub_u32 s10, s36, s23
    v_cvt_pk_bf16_f32 v130, v194, v195
    v_cvt_pk_bf16_f32 v131, v196, v197
    v_mfma_f32_16x16x32_bf16 v[234:237], v[162:165], a[200:203], v[234:237]
    s_waitcnt lgkmcnt(4)
    ds_read_b128 v[194:197], v0 offset:26880
    s_cmp_lt_u32 s34, s17
    v_mfma_f32_16x16x32_bf16 v[206:209], v[32:35], v[198:201], 0
    s_cselect_b32 s10, s10, 0
    v_rsq_f32 v223, v223
    v_mfma_f32_16x16x32_bf16 v[206:209], v[32:35], v[214:217], v[206:209]
    s_add_u32 m0, s28, 0
    v_rsq_f32 v222, v222
    v_mfma_f32_16x16x32_bf16 v[234:237], v[210:213], a[204:207], v[234:237]
    s_waitcnt lgkmcnt(4)
    ds_read_b128 v[198:201], v1 offset:26880
    v_mul_f32 v222, s31, v222
    v_mfma_f32_16x16x32_bf16 v[234:237], v[226:229], a[208:211], v[234:237]
    s_mov_b32 s27, s26
    v_mul_f32 v114, v223, v114
    v_mul_f32 v115, v223, v115
    v_mfma_f32_16x16x32_bf16 v[234:237], v[218:221], a[212:215], v[234:237]
    s_mov_b32 s26, s25
    v_cvt_pk_f16_f32 v218, v114, v115
    v_mul_f32 v116, v223, v116
    v_mfma_f32_16x16x32_bf16 v[226:229], a[72:75], v[118:121], 0
    s_waitcnt lgkmcnt(2)
    v_mul_f32 v117, v223, v117
    v_cvt_pk_f16_f32 v219, v116, v117
    v_mfma_f32_16x16x32_bf16 v[226:229], a[76:79], v[134:137], v[226:229]
    s_mov_b32 s25, s24
    v_cvt_pk_bf16_f32 v114, v234, v235
    v_cvt_pk_bf16_f32 v115, v236, v237
    v_mfma_f32_16x16x32_bf16 v[226:229], a[80:83], v[170:173], v[226:229]
    s_mov_b32 s24, s23
    v_mul_f32 v122, v223, v122
    v_mul_f32 v123, v223, v123
    v_mfma_f32_16x16x32_bf16 v[226:229], a[84:87], v[166:169], v[226:229]
    s_waitcnt lgkmcnt(1)
    v_cvt_pk_f16_f32 v220, v122, v123
    v_mul_f32 v124, v223, v124
    v_mfma_f32_16x16x32_bf16 v[226:229], a[88:91], v[194:197], v[226:229]
    v_mul_f32 v125, v223, v125
    v_cvt_pk_f16_f32 v221, v124, v125
    v_mfma_f32_16x16x32_bf16 v[122:125], a[96:99], v[118:121], 0
    s_waitcnt lgkmcnt(0)
    v_mul_f32 v126, v223, v126
    v_mul_f32 v127, v223, v127
    v_mfma_f32_16x16x32_bf16 v[226:229], a[92:95], v[198:201], v[226:229]
    v_cvt_pk_f16_f32 v164, v126, v127
    v_mul_f32 v128, v223, v128
    v_mfma_f32_16x16x32_bf16 v[122:125], a[100:103], v[134:137], v[122:125]
    v_mul_f32 v129, v223, v129
    v_cvt_pk_f16_f32 v165, v128, v129
    v_mfma_f32_16x16x32_bf16 v[122:125], a[104:107], v[170:173], v[122:125]
    v_mul_f32 v154, v222, v154
    v_mul_f32 v155, v222, v155
    v_mfma_f32_16x16x32_bf16 v[122:125], a[108:111], v[166:169], v[122:125]
    v_cvt_pk_f16_f32 v210, v154, v155
    v_mul_f32 v156, v222, v156
    v_mfma_f32_16x16x32_bf16 v[122:125], a[112:115], v[194:197], v[122:125]
    v_mul_f32 v157, v222, v157
    v_cvt_pk_f16_f32 v211, v156, v157
    v_mfma_f32_16x16x32_bf16 v[122:125], a[116:119], v[198:201], v[122:125]
    v_mul_f32 v174, v222, v174
    v_mul_f32 v175, v222, v175
    v_mfma_f32_16x16x32_bf16 v[126:129], a[120:123], v[118:121], 0
    v_cvt_pk_f16_f32 v212, v174, v175
    v_mul_f32 v176, v222, v176
    v_mfma_f32_16x16x32_bf16 v[126:129], a[124:127], v[134:137], v[126:129]
    v_mul_f32 v177, v222, v177
    v_cvt_pk_f16_f32 v213, v176, v177
    v_mfma_f32_16x16x32_bf16 v[126:129], a[128:131], v[170:173], v[126:129]
    v_mul_f32 v182, v222, v182
    v_mul_f32 v183, v222, v183
    v_mfma_f32_16x16x32_bf16 v[126:129], a[132:135], v[166:169], v[126:129]
    v_cvt_pk_f16_f32 v162, v182, v183
    v_mul_f32 v184, v222, v184
    v_mfma_f32_16x16x32_bf16 v[126:129], a[136:139], v[194:197], v[126:129]
    v_mul_f32 v185, v222, v185
    v_cvt_pk_f16_f32 v163, v184, v185
    v_mfma_f32_16x16x32_bf16 v[126:129], a[140:143], v[198:201], v[126:129]
    v_fma_f32 v116, v226, v226, s32
    v_fmac_f32 v116, v227, v227
    v_mfma_f32_16x16x32_bf16 v[154:157], a[0:3], v[118:121], 0
    v_fmac_f32 v116, v228, v228
    v_fmac_f32 v116, v229, v229
    v_mfma_f32_16x16x32_bf16 v[154:157], a[4:7], v[134:137], v[154:157]
    v_fmac_f32 v116, v122, v122
    v_fmac_f32 v116, v123, v123
    v_mfma_f32_16x16x32_bf16 v[154:157], a[8:11], v[170:173], v[154:157]
    v_fmac_f32 v116, v124, v124
    v_fmac_f32 v116, v125, v125
    v_mfma_f32_16x16x32_bf16 v[154:157], a[12:15], v[166:169], v[154:157]
    v_fmac_f32 v116, v126, v126
    v_fmac_f32 v116, v127, v127
    v_mfma_f32_16x16x32_bf16 v[154:157], a[16:19], v[194:197], v[154:157]
    v_fmac_f32 v116, v128, v128
    v_fmac_f32 v116, v129, v129
    v_mfma_f32_16x16x32_bf16 v[154:157], a[20:23], v[198:201], v[154:157]
    v_mul_f32 v117, 0x3baaaaab, v206
    v_mul_f32 v254, 0x3baaaaab, v207
    v_mfma_f32_16x16x32_bf16 v[174:177], a[24:27], v[118:121], 0
    v_rsq_f32 v117, v117
    v_mfma_f32_16x16x32_bf16 v[174:177], a[28:31], v[134:137], v[174:177]
    v_rsq_f32 v254, v254
    v_mfma_f32_16x16x32_bf16 v[174:177], a[32:35], v[170:173], v[174:177]
    v_mul_f32 v255, 0x3baaaaab, v208
    v_fma_f32 v132, v154, v154, s32
    v_mfma_f32_16x16x32_bf16 v[174:177], a[36:39], v[166:169], v[174:177]
    v_fmac_f32 v132, v155, v155
    v_fmac_f32 v132, v156, v156
    v_mfma_f32_16x16x32_bf16 v[174:177], a[40:43], v[194:197], v[174:177]
    v_fmac_f32 v132, v157, v157
    v_mul_f32 v150, v117, v150
    v_mfma_f32_16x16x32_bf16 v[174:177], a[44:47], v[198:201], v[174:177]
    v_rsq_f32 v255, v255
    v_mfma_f32_16x16x32_bf16 v[182:185], a[48:51], v[118:121], 0
    v_mul_f32 v151, v117, v151
    v_cvt_pk_bf16_f32 v214, v150, v151
    v_mfma_f32_16x16x32_bf16 v[182:185], a[52:55], v[134:137], v[182:185]
    v_mul_f32 v152, v117, v152
    v_mul_f32 v153, v117, v153
    v_mfma_f32_16x16x32_bf16 v[182:185], a[56:59], v[170:173], v[182:185]
    v_fmac_f32 v132, v174, v174
    v_fmac_f32 v132, v175, v175
    v_mfma_f32_16x16x32_bf16 v[182:185], a[60:63], v[166:169], v[182:185]
    v_fmac_f32 v132, v176, v176
    v_fmac_f32 v132, v177, v177
    v_mfma_f32_16x16x32_bf16 v[182:185], a[64:67], v[194:197], v[182:185]
    v_cvt_pk_bf16_f32 v215, v152, v153
    v_mul_f32 v190, v117, v190
    v_mfma_f32_16x16x32_bf16 v[182:185], a[68:71], v[198:201], v[182:185]
    v_mul_f32 v191, v117, v191
    v_cvt_pk_bf16_f32 v216, v190, v191
    v_mfma_f32_16x16x32_bf16 v[150:153], v[118:121], a[144:147], 0
    v_mul_f32 v192, v117, v192
    v_mul_f32 v193, v117, v193
    v_mfma_f32_16x16x32_bf16 v[150:153], v[134:137], a[148:151], v[150:153]
    v_cvt_pk_bf16_f32 v217, v192, v193
    v_mul_f32 v202, v117, v202
    v_mfma_f32_16x16x32_bf16 v[150:153], v[170:173], a[152:155], v[150:153]
    buffer_store_dwordx4 v[214:217], v15, s[12:15], 0 offen nt
    v_fmac_f32 v132, v182, v182
    v_fmac_f32 v132, v183, v183
    v_fmac_f32 v132, v184, v184
    v_fmac_f32 v132, v185, v185
    v_mfma_f32_16x16x32_bf16 v[150:153], v[166:169], a[156:159], v[150:153]
    v_cvt_pk_bf16_f32 v36, v132, v116
    v_mul_f32 v203, v117, v203
    v_mfma_f32_16x16x32_bf16 v[150:153], v[194:197], a[160:163], v[150:153]
    v_cvt_pk_bf16_f32 v116, v202, v203
    v_mul_f32 v204, v117, v204
    v_mfma_f32_16x16x32_bf16 v[190:193], v[32:35], v[36:39], 0
    v_mul_f32 v205, v117, v205
    v_cvt_pk_bf16_f32 v117, v204, v205
    v_mfma_f32_16x16x32_bf16 v[150:153], v[198:201], a[164:167], v[150:153]
    v_mul_f32 v146, v255, v146
    v_mul_f32 v147, v255, v147
    v_mfma_f32_16x16x32_bf16 v[202:205], v[118:121], a[168:171], 0
    v_cvt_pk_bf16_f32 v146, v146, v147
    v_mul_f32 v148, v255, v148
    v_mfma_f32_16x16x32_bf16 v[202:205], v[134:137], a[172:175], v[202:205]
    v_rsq_f32 v191, v191
    v_mfma_f32_16x16x32_bf16 v[202:205], v[170:173], a[176:179], v[202:205]
    v_cvt_pk_bf16_f32 v232, v150, v151
    v_cvt_pk_bf16_f32 v233, v152, v153
    v_mfma_f32_16x16x32_bf16 v[202:205], v[166:169], a[180:183], v[202:205]
    v_rsq_f32 v190, v190
    v_mfma_f32_16x16x32_bf16 v[202:205], v[194:197], a[184:187], v[202:205]
    ds_read_b128 v[150:153], v0 offset:32768
    v_mul_f32 v190, s31, v190
    v_mfma_f32_16x16x32_bf16 v[202:205], v[198:201], a[188:191], v[202:205]
    ds_read_b128 v[206:209], v1 offset:32768
    v_mul_f32 v226, v191, v226
    v_mfma_f32_16x16x32_bf16 v[214:217], v[118:121], a[192:195], 0
    ds_read_b128 v[118:121], v0 offset:32896
    v_mul_f32 v227, v191, v227
    v_mfma_f32_16x16x32_bf16 v[214:217], v[134:137], a[196:199], v[214:217]
    ds_read_b128 v[134:137], v1 offset:32896
    v_cvt_pk_f16_f32 v226, v226, v227
    v_mfma_f32_16x16x32_bf16 v[214:217], v[170:173], a[200:203], v[214:217]
    ds_read_b128 v[170:173], v0 offset:33024
    v_cvt_pk_bf16_f32 v132, v202, v203
    v_mfma_f32_16x16x32_bf16 v[214:217], v[166:169], a[204:207], v[214:217]
    ds_read_b128 v[166:169], v1 offset:33024
    v_cvt_pk_bf16_f32 v133, v204, v205
    v_mfma_f32_16x16x32_bf16 v[214:217], v[194:197], a[208:211], v[214:217]
    v_mul_f32 v228, v191, v228
    v_mul_f32 v229, v191, v229
    v_mfma_f32_16x16x32_bf16 v[214:217], v[198:201], a[212:215], v[214:217]
    v_cvt_pk_f16_f32 v227, v228, v229
    v_mul_f32 v122, v191, v122
    v_mfma_f32_16x16x32_f16 v[194:197], v[218:221], v[210:213], v[46:49]
    s_waitcnt lgkmcnt(5)
    buffer_store_dwordx2 v[116:117], v18, s[12:15], 0 offen nt
    v_mul_f32 v123, v191, v123
    v_cvt_pk_f16_f32 v228, v122, v123
    v_mfma_f32_16x16x32_bf16 v[202:205], a[72:75], v[150:153], 0
    s_waitcnt lgkmcnt(3)
    v_cvt_pk_bf16_f32 v116, v214, v215
    v_cvt_pk_bf16_f32 v117, v216, v217
    v_mfma_f32_16x16x32_bf16 v[202:205], a[76:79], v[206:209], v[202:205]
    s_waitcnt lgkmcnt(2)
    v_mul_f32 v124, v191, v124
    v_mul_f32 v125, v191, v125
    v_mfma_f32_16x16x32_bf16 v[202:205], a[80:83], v[118:121], v[202:205]
    s_waitcnt lgkmcnt(1)
    v_cvt_pk_f16_f32 v229, v124, v125
    v_mul_f32 v126, v191, v126
    v_mfma_f32_16x16x32_bf16 v[202:205], a[84:87], v[134:137], v[202:205]
    s_waitcnt lgkmcnt(0)
    v_mul_f32 v127, v191, v127
    v_cvt_pk_f16_f32 v124, v126, v127
    v_mfma_f32_16x16x32_bf16 v[202:205], a[88:91], v[170:173], v[202:205]
    v_mul_f32 v128, v191, v128
    v_mul_f32 v129, v191, v129
    v_mfma_f32_16x16x32_bf16 v[202:205], a[92:95], v[166:169], v[202:205]
    v_cvt_pk_f16_f32 v125, v128, v129
    v_mul_f32 v154, v190, v154
    v_mfma_f32_16x16x32_bf16 v[126:129], a[96:99], v[150:153], 0
    v_mul_f32 v155, v190, v155
    v_cvt_pk_f16_f32 v154, v154, v155
    v_mfma_f32_16x16x32_bf16 v[126:129], a[100:103], v[206:209], v[126:129]
    v_mul_f32 v156, v190, v156
    v_mul_f32 v157, v190, v157
    v_mfma_f32_16x16x32_bf16 v[126:129], a[104:107], v[118:121], v[126:129]
    v_cvt_pk_f16_f32 v155, v156, v157
    v_mul_f32 v174, v190, v174
    v_mfma_f32_16x16x32_bf16 v[126:129], a[108:111], v[134:137], v[126:129]
    v_mul_f32 v175, v190, v175
    v_cvt_pk_f16_f32 v156, v174, v175
    v_mfma_f32_16x16x32_bf16 v[126:129], a[112:115], v[170:173], v[126:129]
    v_mul_f32 v176, v190, v176
    v_mul_f32 v177, v190, v177
    v_mfma_f32_16x16x32_bf16 v[126:129], a[116:119], v[166:169], v[126:129]
    v_cvt_pk_f16_f32 v157, v176, v177
    v_mul_f32 v182, v190, v182
    v_mfma_f32_16x16x32_bf16 v[174:177], a[120:123], v[150:153], 0
    v_mul_f32 v183, v190, v183
    v_cvt_pk_f16_f32 v122, v182, v183
    v_mfma_f32_16x16x32_bf16 v[174:177], a[124:127], v[206:209], v[174:177]
    v_mul_f32 v184, v190, v184
    v_mul_f32 v185, v190, v185
    v_mfma_f32_16x16x32_bf16 v[174:177], a[128:131], v[118:121], v[174:177]
    v_cvt_pk_f16_f32 v123, v184, v185
    v_fma_f32 v182, v202, v202, s32
    v_mfma_f32_16x16x32_bf16 v[174:177], a[132:135], v[134:137], v[174:177]
    v_fmac_f32 v182, v203, v203
    v_fmac_f32 v182, v204, v204
    v_mfma_f32_16x16x32_bf16 v[174:177], a[136:139], v[170:173], v[174:177]
    v_fmac_f32 v182, v205, v205
    v_fmac_f32 v182, v126, v126
    v_mfma_f32_16x16x32_bf16 v[174:177], a[140:143], v[166:169], v[174:177]
    v_fmac_f32 v182, v127, v127
    v_fmac_f32 v182, v128, v128
    v_mfma_f32_16x16x32_bf16 v[190:193], a[0:3], v[150:153], 0
    v_fmac_f32 v182, v129, v129
    v_mul_f32 v149, v255, v149
    v_mfma_f32_16x16x32_bf16 v[190:193], a[4:7], v[206:209], v[190:193]
    v_cvt_pk_bf16_f32 v147, v148, v149
    v_mul_f32 v138, v255, v138
    v_mfma_f32_16x16x32_bf16 v[190:193], a[8:11], v[118:121], v[190:193]
    v_fmac_f32 v182, v174, v174
    v_fmac_f32 v182, v175, v175
    v_mfma_f32_16x16x32_bf16 v[190:193], a[12:15], v[134:137], v[190:193]
    v_fmac_f32 v182, v176, v176
    v_fmac_f32 v182, v177, v177
    v_mfma_f32_16x16x32_bf16 v[190:193], a[16:19], v[170:173], v[190:193]
    v_mul_f32 v139, v255, v139
    v_cvt_pk_bf16_f32 v148, v138, v139
    v_mfma_f32_16x16x32_bf16 v[190:193], a[20:23], v[166:169], v[190:193]
    v_mul_f32 v140, v255, v140
    v_mul_f32 v141, v255, v141
    v_mfma_f32_16x16x32_bf16 v[198:201], a[24:27], v[150:153], 0
    v_cvt_pk_bf16_f32 v149, v140, v141
    v_mul_f32 v186, v255, v186
    v_mfma_f32_16x16x32_bf16 v[198:201], a[28:31], v[206:209], v[198:201]
    buffer_store_dwordx4 v[146:149], v17, s[12:15], 0 offen nt
    v_mul_f32 v187, v255, v187
    v_fma_f32 v183, v190, v190, s32
    v_fmac_f32 v183, v191, v191
    v_fmac_f32 v183, v192, v192
    v_mfma_f32_16x16x32_bf16 v[198:201], a[32:35], v[118:121], v[198:201]
    v_fmac_f32 v183, v193, v193
    v_cvt_pk_bf16_f32 v184, v186, v187
    v_mfma_f32_16x16x32_bf16 v[198:201], a[36:39], v[134:137], v[198:201]
    v_mul_f32 v188, v255, v188
    v_mul_f32 v189, v255, v189
    v_mfma_f32_16x16x32_bf16 v[198:201], a[40:43], v[170:173], v[198:201]
    v_cvt_pk_bf16_f32 v185, v188, v189
    v_mul_f32 v142, v254, v142
    v_mfma_f32_16x16x32_bf16 v[198:201], a[44:47], v[166:169], v[198:201]
    v_mul_f32 v143, v254, v143
    v_cvt_pk_bf16_f32 v142, v142, v143
    v_mfma_f32_16x16x32_bf16 v[138:141], a[48:51], v[150:153], 0
    v_mul_f32 v144, v254, v144
    v_mul_f32 v145, v254, v145
    v_mfma_f32_16x16x32_bf16 v[138:141], a[52:55], v[206:209], v[138:141]
    v_cvt_pk_bf16_f32 v143, v144, v145
    v_mul_f32 v158, v254, v158
    v_mfma_f32_16x16x32_bf16 v[138:141], a[56:59], v[118:121], v[138:141]
    v_fmac_f32 v183, v198, v198
    v_fmac_f32 v183, v199, v199
    v_mfma_f32_16x16x32_bf16 v[138:141], a[60:63], v[134:137], v[138:141]
    ds_read2_b32 v[216:217], v6 offset0:0 offset1:0
    ds_read2_b32 v[224:225], v6 offset0:16 offset1:16
    v_mfma_f32_16x16x32_bf16 v[138:141], a[64:67], v[170:173], v[138:141]
    ds_read2_b32 v[236:237], v6 offset0:32 offset1:32
    v_fmac_f32 v183, v200, v200
    v_mfma_f32_16x16x32_bf16 v[138:141], a[68:71], v[166:169], v[138:141]
    v_fmac_f32 v183, v201, v201
    v_mul_f32 v159, v254, v159
    v_mfma_f32_16x16x32_bf16 v[146:149], v[150:153], a[144:147], 0
    v_cvt_pk_bf16_f32 v144, v158, v159
    v_mul_f32 v160, v254, v160
    v_mfma_f32_16x16x32_bf16 v[146:149], v[206:209], a[148:151], v[146:149]
    v_mul_f32 v161, v254, v161
    v_cvt_pk_bf16_f32 v145, v160, v161
    v_mfma_f32_16x16x32_bf16 v[146:149], v[118:121], a[152:155], v[146:149]
    v_fmac_f32 v183, v138, v138
    v_fmac_f32 v183, v139, v139
    v_mfma_f32_16x16x32_bf16 v[146:149], v[134:137], a[156:159], v[146:149]
    v_fmac_f32 v183, v140, v140
    v_fmac_f32 v183, v141, v141
    v_mfma_f32_16x16x32_bf16 v[146:149], v[170:173], a[160:163], v[146:149]
    v_cvt_pk_bf16_f32 v36, v183, v182
    v_mul_f32 v178, v254, v178
    v_mfma_f32_16x16x32_bf16 v[146:149], v[166:169], a[164:167], v[146:149]
    s_waitcnt lgkmcnt(1)
    v_mul_f32 v179, v254, v179
    v_cvt_pk_bf16_f32 v178, v178, v179
    v_mfma_f32_16x16x32_bf16 v[158:161], v[32:35], v[36:39], 0
    s_waitcnt lgkmcnt(0)
    buffer_store_dwordx2 v[184:185], v20, s[12:15], 0 offen nt
    v_mul_f32 v180, v254, v180
    v_mul_f32 v181, v254, v181
    v_mfma_f32_16x16x32_bf16 v[186:189], v[150:153], a[168:171], 0
    v_cvt_pk_bf16_f32 v214, v146, v147
    v_cvt_pk_bf16_f32 v215, v148, v149
    v_mfma_f32_16x16x32_bf16 v[186:189], v[206:209], a[172:175], v[186:189]
    v_rsq_f32 v159, v159
    v_mfma_f32_16x16x32_bf16 v[186:189], v[118:121], a[176:179], v[186:189]
    v_rsq_f32 v158, v158
    v_mfma_f32_16x16x32_bf16 v[186:189], v[134:137], a[180:183], v[186:189]
    v_mul_f32 v158, s31, v158
    v_mul_f32 v202, v159, v202
    v_mfma_f32_16x16x32_bf16 v[186:189], v[170:173], a[184:187], v[186:189]
    v_mul_f32 v203, v159, v203
    v_cvt_pk_f16_f32 v146, v202, v203
    v_mfma_f32_16x16x32_bf16 v[186:189], v[166:169], a[188:191], v[186:189]
    v_mul_f32 v204, v159, v204
    v_mul_f32 v205, v159, v205
    v_mfma_f32_16x16x32_bf16 v[182:185], v[150:153], a[192:195], 0
    v_cvt_pk_f16_f32 v147, v204, v205
    v_mul_f32 v126, v159, v126
    v_mfma_f32_16x16x32_bf16 v[182:185], v[206:209], a[196:199], v[182:185]
    ds_read_b128 v[150:153], v5 offset:0
    ds_read_b128 v[202:205], v5 offset:16
    v_mfma_f32_16x16x32_bf16 v[182:185], v[118:121], a[200:203], v[182:185]
    ds_read_b128 v[118:121], v5 offset:48
    ds_read_b32 v254, v6 offset:192
    v_mfma_f32_16x16x32_bf16 v[182:185], v[134:137], a[204:207], v[182:185]
    v_cvt_pk_bf16_f32 v222, v186, v187
    v_cvt_pk_bf16_f32 v223, v188, v189
    v_mfma_f32_16x16x32_bf16 v[182:185], v[170:173], a[208:211], v[182:185]
    v_mul_f32 v127, v159, v127
    v_cvt_pk_f16_f32 v148, v126, v127
    v_mfma_f32_16x16x32_bf16 v[182:185], v[166:169], a[212:215], v[182:185]
    ds_read_b128 v[166:169], v2 offset:0
    ds_read_b128 v[170:173], v2 offset:1024
    v_mfma_f32_16x16x32_f16 v[186:189], v[226:229], v[210:213], v[50:53]
    ds_read_b128 v[134:137], v2 offset:2048
    v_mul_f32 v128, v159, v128
    v_mul_f32 v129, v159, v129
    v_mfma_f32_16x16x16_f16 v[194:197], v[164:165], v[162:163], v[194:197]
    v_cvt_pk_f16_f32 v149, v128, v129
    v_cvt_pk_bf16_f32 v234, v182, v183
    v_cvt_pk_bf16_f32 v235, v184, v185
    v_mul_f32 v174, v159, v174
    v_mfma_f32_16x16x32_f16 v[126:129], v[146:149], v[210:213], v[54:57]
    s_waitcnt lgkmcnt(5)
    v_mul_f32 v175, v159, v175
    v_cvt_pk_f16_f32 v184, v174, v175
    v_mul_f32 v176, v159, v176
    v_mfma_f32_16x16x16_f16 v[186:189], v[124:125], v[162:163], v[186:189]
    v_mul_f32 v177, v159, v177
    v_cvt_pk_f16_f32 v185, v176, v177
    v_mul_f32 v190, v158, v190
    v_mul_f32 v191, v158, v191
    v_mfma_f32_16x16x16_f16 v[126:129], v[184:185], v[162:163], v[126:129]
    v_cvt_pk_f16_f32 v174, v190, v191
    v_mul_f32 v192, v158, v192
    v_mul_f32 v193, v158, v193
    v_cvt_pk_f16_f32 v175, v192, v193
    v_mfma_f32_16x16x32_f16 v[206:209], v[150:153], v[210:213], v[22:25]
    s_waitcnt lgkmcnt(2)
    ds_read_b128 v[210:213], v2 offset:3072
    buffer_store_dwordx4 v[142:145], v16, s[12:15], 0 offen nt
    ds_read_b128 v[238:241], v2 offset:4096
    v_mul_f32 v198, v158, v198
    v_mul_f32 v199, v158, v199
    v_cvt_pk_f16_f32 v176, v198, v199
    v_mfma_f32_16x16x32_f16 v[206:209], v[202:205], v[218:221], v[206:209]
    s_waitcnt lgkmcnt(2)
    v_mul_f32 v200, v158, v200
    v_mul_f32 v201, v158, v201
    v_mfma_f32_16x16x32_f16 v[206:209], v[118:121], v[162:165], v[206:209]
    ds_read_b128 v[142:145], v2 offset:5120
    v_cvt_pk_f16_f32 v177, v200, v201
    v_mul_f32 v138, v158, v138
    v_mul_f32 v139, v158, v139
    v_cvt_pk_f16_f32 v182, v138, v139
    v_mfma_f32_16x16x32_f16 v[198:201], v[150:153], v[154:157], v[24:27]
    v_mul_f32 v140, v158, v140
    v_mul_f32 v141, v158, v141
    v_mfma_f32_16x16x32_f16 v[198:201], v[202:205], v[226:229], v[198:201]
    v_mov_b32_dpp v254, v207 quad_perm:[0,1,2,3] row_mask:0x1 bank_mask:0xf
    v_cvt_pk_f16_f32 v183, v140, v141
    v_mfma_f32_16x16x32_f16 v[198:201], v[118:121], v[122:125], v[198:201]
    v_max3_f32 v255, v206, v194, v195
    v_max3_f32 v255, v255, v196, v197
    v_mfma_f32_16x16x32_f16 v[242:245], v[150:153], v[174:177], v[26:29]
    s_waitcnt lgkmcnt(1)
    v_max3_f32 v255, v255, v186, v187
    v_max3_f32 v255, v255, v188, v189
    v_mfma_f32_16x16x32_f16 v[242:245], v[202:205], v[146:149], v[242:245]
    v_max3_f32 v255, v255, v126, v127
    v_mov_b32_dpp v254, v199 quad_perm:[0,1,2,3] row_mask:0x2 bank_mask:0xf
    v_mfma_f32_16x16x32_f16 v[242:245], v[118:121], v[182:185], v[242:245]
    v_max3_f32 v255, v255, v128, v129
    v_mov_b32 v162, v255
    v_mfma_f32_16x16x32_bf16 v[150:153], a[216:219], v[166:169], 0
    s_waitcnt lgkmcnt(0)
    v_permlane32_swap_b32 v255, v162
    v_mfma_f32_16x16x32_bf16 v[150:153], a[220:223], v[170:173], v[150:153]
    v_max_f32 v255, v255, v162
    v_mov_b32 v162, v255
    v_mfma_f32_16x16x32_bf16 v[150:153], a[224:227], v[134:137], v[150:153]
    v_cvt_pk_bf16_f32 v179, v180, v181
    v_xor_b32 v0, 65536, v0
    v_mfma_f32_16x16x32_bf16 v[150:153], a[228:231], v[210:213], v[150:153]
    s_waitcnt vmcnt(5)
    v_permlane16_swap_b32 v255, v162
    v_mfma_f32_16x16x32_bf16 v[150:153], a[232:235], v[238:241], v[150:153]
    v_max_f32 v255, v255, v162
    v_sub_f32 v194, v194, v255
    v_mfma_f32_16x16x32_bf16 v[150:153], a[236:239], v[142:145], v[150:153]
    v_exp_f32 v194, v194
    v_mfma_f32_16x16x32_bf16 v[190:193], a[240:243], v[166:169], 0
    v_sub_f32 v195, v195, v255
    v_sub_f32 v196, v196, v255
    v_mfma_f32_16x16x32_bf16 v[190:193], a[244:247], v[170:173], v[190:193]
    s_barrier
    buffer_load_dwordx4 v10, s[8:11], 0 offen nt lds
    v_sub_f32 v197, v197, v255
    v_mfma_f32_16x16x32_bf16 v[190:193], a[248:251], v[134:137], v[190:193]
    s_add_u32 m0, s28, 4096
    v_exp_f32 v195, v195
    v_mfma_f32_16x16x32_bf16 v[190:193], a[252:255], v[210:213], v[190:193]
    v_cvt_pk_bf16_f32 v158, v194, v195
    v_sub_f32 v186, v186, v255
    v_mfma_f32_16x16x32_bf16 v[190:193], v[82:85], v[238:241], v[190:193]
    v_exp_f32 v196, v196
    v_mfma_f32_16x16x32_bf16 v[190:193], v[86:89], v[142:145], v[190:193]
    v_exp_f32 v197, v197
    v_mfma_f32_16x16x32_bf16 v[202:205], v[90:93], v[166:169], 0
    ds_read_b128 v[166:169], v2 offset:6144
    buffer_load_dwordx4 v11, s[8:11], 0 offen nt lds
    v_mfma_f32_16x16x32_bf16 v[202:205], v[94:97], v[170:173], v[202:205]
    s_add_u32 m0, s28, 8192
    ds_read_b128 v[170:173], v2 offset:7168
    v_cvt_pk_bf16_f32 v159, v196, v197
    v_mfma_f32_16x16x32_bf16 v[202:205], v[98:101], v[134:137], v[202:205]
    ds_read_b128 v[138:141], v2 offset:8192
    v_sub_f32 v187, v187, v255
    v_mfma_f32_16x16x32_bf16 v[202:205], v[102:105], v[210:213], v[202:205]
    ds_read_b128 v[210:213], v2 offset:9216
    v_sub_f32 v188, v188, v255
    v_mfma_f32_16x16x32_bf16 v[202:205], v[106:109], v[238:241], v[202:205]
    ds_read_b128 v[134:137], v2 offset:10240
    v_sub_f32 v189, v189, v255
    v_mfma_f32_16x16x32_bf16 v[202:205], v[110:113], v[142:145], v[202:205]
    ds_read_b128 v[194:197], v2 offset:11264
    buffer_load_dwordx4 v12, s[8:11], 0 offen nt lds
    v_exp_f32 v186, v186
    v_mfma_f32_16x16x32_f16 v[118:121], v[218:221], v[154:157], v[58:61]
    s_add_u32 m0, s28, 12288
    v_exp_f32 v187, v187
    v_exp_f32 v188, v188
    v_cvt_pk_bf16_f32 v160, v186, v187
    v_exp_f32 v189, v189
    v_sub_f32 v126, v126, v255
    v_mfma_f32_16x16x16_f16 v[118:121], v[164:165], v[122:123], v[118:121]
    v_cvt_pk_bf16_f32 v161, v188, v189
    v_exp_f32 v126, v126
    v_sub_f32 v127, v127, v255
    v_mfma_f32_16x16x32_f16 v[186:189], v[226:229], v[154:157], v[62:65]
    s_xor_b32 s28, s28, 65536
    buffer_load_dwordx4 v13, s[8:11], 0 offen nt lds
    v_exp_f32 v127, v127
    v_sub_f32 v128, v128, v255
    v_cvt_pk_bf16_f32 v36, v126, v127
    v_exp_f32 v128, v128
    v_mfma_f32_16x16x16_f16 v[186:189], v[124:125], v[122:123], v[186:189]
    v_sub_f32 v129, v129, v255
    v_exp_f32 v129, v129
    v_sub_f32 v206, v206, v255
    v_cvt_pk_bf16_f32 v37, v128, v129
    v_mfma_f32_16x16x32_f16 v[126:129], v[146:149], v[154:157], v[66:69]
    s_waitcnt lgkmcnt(0)
    v_exp_f32 v206, v206
    v_mfma_f32_16x16x32_bf16 v[142:145], a[216:219], v[166:169], 0
    s_mov_b32 m0, s29
    v_cvt_pk_bf16_f32 v39, v206, 0
    v_max3_f32 v255, v198, v118, v119
    v_max3_f32 v255, v255, v120, v121
    v_mfma_f32_16x16x16_f16 v[126:129], v[184:185], v[122:123], v[126:129]
    v_max3_f32 v255, v255, v186, v187
    v_max3_f32 v255, v255, v188, v189
    v_xor_b32 v1, 65536, v1
    v_mov_b32_dpp v254, v243 quad_perm:[0,1,2,3] row_mask:0x4 bank_mask:0xf
    v_mfma_f32_16x16x32_bf16 v[154:157], v[28:31], v[36:39], 0
    s_xor_b32 s29, s29, s30
    buffer_store_dwordx2 v[178:179], v19, s[12:15], 0 offen nt
    v_mov_b32 v122, v254
    v_max3_f32 v255, v255, v126, v127
    v_mfma_f32_16x16x32_bf16 v[154:157], v[28:31], v[158:161], v[154:157]
    s_add_u32 s19, s19, s20
    v_max3_f32 v255, v255, v128, v129
    v_mov_b32 v123, v255
    v_mfma_f32_16x16x32_bf16 v[142:145], a[220:223], v[170:173], v[142:145]
    s_add_u32 s23, s23, s21
    v_permlane32_swap_b32 v255, v123
    v_mfma_f32_16x16x32_bf16 v[142:145], a[224:227], v[138:141], v[142:145]
    s_cmp_ge_u32 s19, 72
    v_rcp_f32 v154, v154
    v_mfma_f32_16x16x32_bf16 v[142:145], a[228:231], v[210:213], v[142:145]
    s_cselect_b32 s34, 72, 0
    v_max_f32 v255, v255, v123
    v_mov_b32 v123, v255
    v_mfma_f32_16x16x32_bf16 v[142:145], a[232:235], v[134:137], v[142:145]
    s_cselect_b32 s35, s22, 0
    v_permlane16_swap_b32 v255, v123
    v_mfma_f32_16x16x32_bf16 v[142:145], a[236:239], v[194:197], v[142:145]
    s_sub_u32 s19, s19, s34
    v_max_f32 v255, v255, v123
    v_sub_f32 v118, v118, v255
    v_mfma_f32_16x16x32_bf16 v[178:181], v[214:217], v[36:39], 0
    s_add_u32 s23, s23, s35
    v_exp_f32 v118, v118
    v_mfma_f32_16x16x32_bf16 v[178:181], v[230:233], v[158:161], v[178:181]
    s_add_u32 s18, s18, 1
    v_sub_f32 v119, v119, v255
    v_exp_f32 v119, v119
    v_sub_f32 v120, v120, v255
    v_cvt_pk_bf16_f32 v118, v118, v119
    v_exp_f32 v120, v120
    v_sub_f32 v121, v121, v255
    v_exp_f32 v121, v121
    v_mul_f32 v178, v154, v178
    v_mul_f32 v179, v154, v179
    v_cvt_pk_bf16_f32 v178, v178, v179
    v_mul_f32 v180, v154, v180
    v_mul_f32 v181, v154, v181
    v_cvt_pk_bf16_f32 v179, v180, v181
    v_cvt_pk_bf16_f32 v119, v120, v121
    v_mfma_f32_16x16x32_bf16 v[206:209], v[222:225], v[36:39], 0
    s_cmp_lt_u32 s18, s45
    v_sub_f32 v186, v186, v255
    v_sub_f32 v187, v187, v255
    v_mfma_f32_16x16x32_bf16 v[206:209], v[130:133], v[158:161], v[206:209]
    v_exp_f32 v186, v186
    v_exp_f32 v187, v187
    v_sub_f32 v188, v188, v255
    v_cvt_pk_bf16_f32 v120, v186, v187
    v_exp_f32 v188, v188
    v_sub_f32 v189, v189, v255
    v_exp_f32 v189, v189
    v_sub_f32 v126, v126, v255
    v_mul_f32 v206, v154, v206
    v_mul_f32 v207, v154, v207
    v_cvt_pk_bf16_f32 v180, v206, v207
    v_mul_f32 v208, v154, v208
    v_mul_f32 v209, v154, v209
    v_cvt_pk_bf16_f32 v181, v208, v209
    v_cvt_pk_bf16_f32 v121, v188, v189
    v_mfma_f32_16x16x32_bf16 v[186:189], v[234:237], v[36:39], 0
    v_sub_f32 v127, v127, v255
    v_mfma_f32_16x16x32_bf16 v[186:189], v[114:117], v[158:161], v[186:189]
    ds_write_b128 v3, v[178:181] offset:0
    v_mfma_f32_16x16x32_bf16 v[158:161], a[240:243], v[166:169], 0
    v_exp_f32 v126, v126
    v_mfma_f32_16x16x32_bf16 v[158:161], a[244:247], v[170:173], v[158:161]
    v_exp_f32 v127, v127
    v_mfma_f32_16x16x32_bf16 v[158:161], a[248:251], v[138:141], v[158:161]
    v_cvt_pk_bf16_f32 v36, v126, v127
    v_sub_f32 v128, v128, v255
    v_mfma_f32_16x16x32_bf16 v[158:161], a[252:255], v[210:213], v[158:161]
    v_mul_f32 v186, v154, v186
    v_mul_f32 v187, v154, v187
    v_mfma_f32_16x16x32_bf16 v[158:161], v[82:85], v[134:137], v[158:161]
    v_cvt_pk_bf16_f32 v126, v186, v187
    v_mul_f32 v188, v154, v188
    v_mfma_f32_16x16x32_bf16 v[158:161], v[86:89], v[194:197], v[158:161]
    v_mul_f32 v189, v154, v189
    v_cvt_pk_bf16_f32 v127, v188, v189
    v_mfma_f32_16x16x32_bf16 v[178:181], v[90:93], v[166:169], 0
    ds_read_b128 v[166:169], v2 offset:12288
    v_sub_f32 v129, v129, v255
    v_mfma_f32_16x16x32_bf16 v[178:181], v[94:97], v[170:173], v[178:181]
    ds_read_b128 v[170:173], v2 offset:13312
    v_sub_f32 v198, v198, v255
    v_mfma_f32_16x16x32_bf16 v[178:181], v[98:101], v[138:141], v[178:181]
    ds_read_b128 v[154:157], v2 offset:14336
    v_max_f32_dpp v122, v122, v122 quad_perm:[1,0,3,2] row_mask:0xf bank_mask:0xf
    v_mfma_f32_16x16x32_bf16 v[178:181], v[102:105], v[210:213], v[178:181]
    ds_read_b128 v[210:213], v2 offset:15360
    v_max_f32_dpp v122, v122, v122 quad_perm:[2,3,0,1] row_mask:0xf bank_mask:0xf
    v_mfma_f32_16x16x32_bf16 v[178:181], v[106:109], v[134:137], v[178:181]
    ds_read_b128 v[134:137], v2 offset:16384
    v_max_f32_dpp v122, v122, v122 row_half_mirror row_mask:0xf bank_mask:0xf
    v_mfma_f32_16x16x32_bf16 v[178:181], v[110:113], v[194:197], v[178:181]
    ds_read_b128 v[194:197], v2 offset:17408
    ds_write_b64 v4, v[126:127] offset:4096
    v_exp_f32 v128, v128
    v_exp_f32 v129, v129
    v_mfma_f32_16x16x32_f16 v[186:189], v[218:221], v[174:177], v[70:73]
    s_waitcnt lgkmcnt(6)
    v_cvt_pk_bf16_f32 v37, v128, v129
    v_max_f32_dpp v122, v122, v122 row_mirror row_mask:0xf bank_mask:0xf
    v_mfma_f32_16x16x32_f16 v[218:221], v[226:229], v[174:177], v[74:77]
    s_waitcnt lgkmcnt(5)
    v_exp_f32 v198, v198
    v_mfma_f32_16x16x32_f16 v[126:129], v[146:149], v[174:177], v[78:81]
    s_waitcnt lgkmcnt(4)
    v_cvt_pk_bf16_f32 v39, v198, 0
    v_mov_b32 v123, v122
    v_fma_f32 v255, v150, v150, s33
    v_mfma_f32_16x16x32_bf16 v[174:177], v[28:31], v[36:39], 0
    s_waitcnt lgkmcnt(3)
    v_permlane32_swap_b32 v122, v123
    v_mfma_f32_16x16x32_bf16 v[174:177], v[28:31], v[118:121], v[174:177]
    s_waitcnt lgkmcnt(2)
    v_max_f32 v122, v122, v123
    v_mov_b32 v123, v122
    v_mfma_f32_16x16x32_bf16 v[226:229], v[214:217], v[36:39], 0
    s_waitcnt lgkmcnt(0)
    v_permlane16_swap_b32 v122, v123
    v_mfma_f32_16x16x32_bf16 v[226:229], v[230:233], v[118:121], v[226:229]
    v_max_f32 v122, v122, v123
    v_sub_f32 v254, v254, v122
    v_mfma_f32_16x16x32_bf16 v[198:201], v[222:225], v[36:39], 0
    v_exp_f32 v254, v254
    v_mfma_f32_16x16x32_bf16 v[198:201], v[130:133], v[118:121], v[198:201]
    v_cvt_pk_bf16_f32 v254, v254, v254
    v_fmac_f32 v255, v151, v151
    v_mfma_f32_16x16x32_bf16 v[206:209], v[234:237], v[36:39], 0
    ds_write_b16 v8, v254
    v_mfma_f32_16x16x32_bf16 v[206:209], v[114:117], v[118:121], v[206:209]
    v_rcp_f32 v174, v174
    v_fmac_f32 v255, v152, v152
    v_mfma_f32_16x16x16_f16 v[186:189], v[164:165], v[182:183], v[186:189]
    v_mul_f32 v226, v174, v226
    v_mul_f32 v227, v174, v227
    v_cvt_pk_bf16_f32 v122, v226, v227
    v_mfma_f32_16x16x16_f16 v[218:221], v[124:125], v[182:183], v[218:221]
    v_mul_f32 v228, v174, v228
    v_mul_f32 v229, v174, v229
    v_cvt_pk_bf16_f32 v123, v228, v229
    v_mfma_f32_16x16x16_f16 v[126:129], v[184:185], v[182:183], v[126:129]
    v_max3_f32 v254, v242, v186, v187
    v_max3_f32 v254, v254, v188, v189
    v_mul_f32 v198, v174, v198
    v_mul_f32 v199, v174, v199
    v_mfma_f32_16x16x32_bf16 v[146:149], a[216:219], v[166:169], 0
    ds_read_b128 v[182:185], v9
    ds_read_b128 v[118:121], v9 offset:64
    v_mfma_f32_16x16x32_bf16 v[146:149], a[220:223], v[170:173], v[146:149]
    v_max3_f32 v254, v254, v218, v219
    v_max3_f32 v254, v254, v220, v221
    v_mfma_f32_16x16x32_bf16 v[146:149], a[224:227], v[154:157], v[146:149]
    v_max3_f32 v254, v254, v126, v127
    v_max3_f32 v254, v254, v128, v129
    v_mfma_f32_16x16x32_bf16 v[146:149], a[228:231], v[210:213], v[146:149]
    v_mov_b32 v125, v254
    v_cvt_pk_bf16_f32 v124, v198, v199
    v_mfma_f32_16x16x32_bf16 v[146:149], a[232:235], v[134:137], v[146:149]
    v_permlane32_swap_b32 v254, v125
    v_mfma_f32_16x16x32_bf16 v[146:149], a[236:239], v[194:197], v[146:149]
    v_max_f32 v254, v254, v125
    v_mov_b32 v125, v254
    v_mfma_f32_16x16x32_bf16 v[138:141], a[240:243], v[166:169], 0
    v_mul_f32 v200, v174, v200
    v_mul_f32 v201, v174, v201
    v_mfma_f32_16x16x32_bf16 v[138:141], a[244:247], v[170:173], v[138:141]
    v_permlane16_swap_b32 v254, v125
    v_mfma_f32_16x16x32_bf16 v[138:141], a[248:251], v[154:157], v[138:141]
    s_waitcnt lgkmcnt(0)
    v_max_f32 v254, v254, v125
    v_sub_f32 v186, v186, v254
    v_mfma_f32_16x16x32_bf16 v[138:141], a[252:255], v[210:213], v[138:141]
    v_exp_f32 v186, v186
    v_mfma_f32_16x16x32_bf16 v[138:141], v[82:85], v[134:137], v[138:141]
    v_sub_f32 v187, v187, v254
    v_sub_f32 v188, v188, v254
    v_mfma_f32_16x16x32_bf16 v[138:141], v[86:89], v[194:197], v[138:141]
    v_exp_f32 v187, v187
    v_exp_f32 v188, v188
    v_cvt_pk_bf16_f32 v238, v186, v187
    v_sub_f32 v189, v189, v254
    v_exp_f32 v189, v189
    v_sub_f32 v218, v218, v254
    v_cvt_pk_bf16_f32 v239, v188, v189
    v_exp_f32 v218, v218
    v_sub_f32 v219, v219, v254
    v_exp_f32 v219, v219
    v_sub_f32 v220, v220, v254
    v_cvt_pk_bf16_f32 v240, v218, v219
    v_mfma_f32_16x16x32_bf16 v[186:189], v[90:93], v[166:169], 0
    v_exp_f32 v220, v220
    v_mfma_f32_16x16x32_bf16 v[186:189], v[94:97], v[170:173], v[186:189]
    v_sub_f32 v221, v221, v254
    v_sub_f32 v126, v126, v254
    v_mfma_f32_16x16x32_bf16 v[186:189], v[98:101], v[154:157], v[186:189]
    v_exp_f32 v221, v221
    v_mfma_f32_16x16x32_bf16 v[186:189], v[102:105], v[210:213], v[186:189]
    v_cvt_pk_bf16_f32 v241, v220, v221
    v_sub_f32 v127, v127, v254
    v_mfma_f32_16x16x32_bf16 v[186:189], v[106:109], v[134:137], v[186:189]
    v_exp_f32 v126, v126
    v_mfma_f32_16x16x32_bf16 v[186:189], v[110:113], v[194:197], v[186:189]
    ds_read_b128 v[170:173], v0 offset:20480
    ds_read_b128 v[166:169], v1 offset:20480
    v_mfma_f32_16x16x32_bf16 v[154:157], v[182:185], v[28:31], 0
    ds_read_b128 v[162:165], v0 offset:20608
    ds_read_b128 v[210:213], v1 offset:20608
    v_mfma_f32_16x16x32_bf16 v[154:157], v[118:121], v[28:31], v[154:157]
    v_exp_f32 v127, v127
    v_mfma_f32_16x16x32_bf16 v[134:137], v[182:185], v[230:233], 0
    ds_read_b128 v[226:229], v0 offset:20736
    v_cvt_pk_bf16_f32 v36, v126, v127
    v_mfma_f32_16x16x32_bf16 v[134:137], v[118:121], v[214:217], v[134:137]
    ds_read_b128 v[218:221], v1 offset:20736
    v_sub_f32 v128, v128, v254
    v_exp_f32 v128, v128
    v_sub_f32 v129, v129, v254
    v_exp_f32 v129, v129
    v_sub_f32 v242, v242, v254
    v_cvt_pk_bf16_f32 v37, v128, v129
    v_mfma_f32_16x16x32_bf16 v[194:197], v[182:185], v[130:133], 0
    v_exp_f32 v242, v242
    v_mfma_f32_16x16x32_bf16 v[194:197], v[118:121], v[222:225], v[194:197]
    s_waitcnt lgkmcnt(4)
    v_cvt_pk_bf16_f32 v39, v242, 0
    v_cvt_pk_bf16_f32 v125, v200, v201
    v_mfma_f32_16x16x32_bf16 v[198:201], v[182:185], v[114:117], 0
    s_waitcnt lgkmcnt(2)
    ds_write_b128 v3, v[122:125] offset:6144
    v_mfma_f32_16x16x32_bf16 v[126:129], v[28:31], v[36:39], 0
    s_waitcnt lgkmcnt(2)
    v_mul_f32 v206, v174, v206
    v_mul_f32 v207, v174, v207
    v_mfma_f32_16x16x32_bf16 v[126:129], v[28:31], v[238:241], v[126:129]
    s_waitcnt lgkmcnt(1)
    v_cvt_pk_bf16_f32 v206, v206, v207
    v_mul_f32 v208, v174, v208
    v_mfma_f32_16x16x32_bf16 v[122:125], v[214:217], v[36:39], 0
    v_mul_f32 v209, v174, v209
    v_cvt_pk_bf16_f32 v207, v208, v209
    v_mfma_f32_16x16x32_bf16 v[122:125], v[230:233], v[238:241], v[122:125]
    ds_write_b64 v4, v[206:207] offset:10240
    v_mfma_f32_16x16x32_bf16 v[230:233], v[222:225], v[36:39], 0
    v_rcp_f32 v126, v126
    v_mfma_f32_16x16x32_bf16 v[230:233], v[130:133], v[238:241], v[230:233]
    v_fma_f32 v254, v146, v146, s33
    v_fmac_f32 v254, v147, v147
    v_mfma_f32_16x16x32_bf16 v[174:177], v[234:237], v[36:39], 0
    v_fmac_f32 v254, v148, v148
    v_mul_f32 v122, v126, v122
    v_mfma_f32_16x16x32_bf16 v[174:177], v[114:117], v[238:241], v[174:177]
    v_mul_f32 v123, v126, v123
    v_cvt_pk_bf16_f32 v122, v122, v123
    v_mfma_f32_16x16x32_bf16 v[198:201], v[118:121], v[234:237], v[198:201]
    v_mul_f32 v124, v126, v124
    v_mul_f32 v125, v126, v125
    v_mfma_f32_16x16x32_bf16 v[114:117], a[72:75], v[170:173], 0
    v_cvt_pk_bf16_f32 v123, v124, v125
    v_mul_f32 v230, v126, v230
    v_mfma_f32_16x16x32_bf16 v[114:117], a[76:79], v[166:169], v[114:117]
    v_mul_f32 v231, v126, v231
    v_cvt_pk_bf16_f32 v124, v230, v231
    v_mfma_f32_16x16x32_bf16 v[114:117], a[80:83], v[162:165], v[114:117]
    v_mul_f32 v232, v126, v232
    v_mul_f32 v233, v126, v233
    v_mfma_f32_16x16x32_bf16 v[114:117], a[84:87], v[210:213], v[114:117]
    v_cvt_pk_bf16_f32 v125, v232, v233
    v_mul_f32 v174, v126, v174
    v_mfma_f32_16x16x32_bf16 v[114:117], a[88:91], v[226:229], v[114:117]
    ds_write_b128 v3, v[122:125] offset:12288
    v_mfma_f32_16x16x32_bf16 v[114:117], a[92:95], v[218:221], v[114:117]
    v_mul_f32 v175, v126, v175
    v_cvt_pk_bf16_f32 v174, v174, v175
    v_mfma_f32_16x16x32_bf16 v[122:125], a[96:99], v[170:173], 0
    v_mul_f32 v176, v126, v176
    v_mul_f32 v177, v126, v177
    v_mfma_f32_16x16x32_bf16 v[122:125], a[100:103], v[166:169], v[122:125]
    v_cvt_pk_bf16_f32 v175, v176, v177
    v_fmac_f32 v254, v149, v149
    v_mfma_f32_16x16x32_bf16 v[122:125], a[104:107], v[162:165], v[122:125]
    ds_write_b64 v4, v[174:175] offset:16384
    v_mfma_f32_16x16x32_bf16 v[122:125], a[108:111], v[210:213], v[122:125]
    v_fmac_f32 v254, v138, v138
    v_fmac_f32 v254, v139, v139
    v_mfma_f32_16x16x32_bf16 v[122:125], a[112:115], v[226:229], v[122:125]
    v_fmac_f32 v254, v140, v140
    v_fmac_f32 v254, v141, v141
    v_mfma_f32_16x16x32_bf16 v[122:125], a[116:119], v[218:221], v[122:125]
    v_fmac_f32 v254, v186, v186
    v_fmac_f32 v254, v187, v187
    v_mfma_f32_16x16x32_bf16 v[126:129], a[120:123], v[170:173], 0
    v_fmac_f32 v254, v188, v188
    v_fmac_f32 v254, v189, v189
    v_mfma_f32_16x16x32_bf16 v[126:129], a[124:127], v[166:169], v[126:129]
    v_cvt_pk_bf16_f32 v135, v254, v254
    v_fmac_f32 v255, v153, v153
    v_mfma_f32_16x16x32_bf16 v[126:129], a[128:131], v[162:165], v[126:129]
    v_rcp_f32 v154, v154
    v_mfma_f32_16x16x32_bf16 v[126:129], a[132:135], v[210:213], v[126:129]
    v_mul_f32 v134, v134, v154
    v_mul_f32_dpp v134, v194, v154 quad_perm:[0,1,2,3] row_mask:0x2 bank_mask:0xf
    v_mfma_f32_16x16x32_bf16 v[126:129], a[136:139], v[226:229], v[126:129]
    v_mul_f32_dpp v134, v198, v154 quad_perm:[0,1,2,3] row_mask:0x4 bank_mask:0xf
    v_cvt_pk_bf16_f32 v134, v134, v134
    v_mfma_f32_16x16x32_bf16 v[126:129], a[140:143], v[218:221], v[126:129]
    ds_write_b16 v7, v134
    v_mfma_f32_16x16x32_bf16 v[154:157], a[0:3], v[170:173], 0
    v_fmac_f32 v255, v190, v190
    v_fmac_f32 v255, v191, v191
    v_mfma_f32_16x16x32_bf16 v[154:157], a[4:7], v[166:169], v[154:157]
    v_fmac_f32 v255, v192, v192
    v_fmac_f32 v255, v193, v193
    v_mfma_f32_16x16x32_bf16 v[154:157], a[8:11], v[162:165], v[154:157]
    v_fmac_f32 v255, v202, v202
    v_fmac_f32 v255, v203, v203
    v_mfma_f32_16x16x32_bf16 v[154:157], a[12:15], v[210:213], v[154:157]
    v_fmac_f32 v255, v204, v204
    v_fmac_f32 v255, v205, v205
    v_mfma_f32_16x16x32_bf16 v[154:157], a[16:19], v[226:229], v[154:157]
    v_fma_f32 v254, v142, v142, s33
    v_fmac_f32 v254, v143, v143
    v_mfma_f32_16x16x32_bf16 v[154:157], a[20:23], v[218:221], v[154:157]
    v_fmac_f32 v254, v144, v144
    v_fmac_f32 v254, v145, v145
    v_mfma_f32_16x16x32_bf16 v[174:177], a[24:27], v[170:173], 0
    v_fmac_f32 v254, v158, v158
    v_fmac_f32 v254, v159, v159
    v_mfma_f32_16x16x32_bf16 v[174:177], a[28:31], v[166:169], v[174:177]
    v_fmac_f32 v254, v160, v160
    v_fmac_f32 v254, v161, v161
    v_mfma_f32_16x16x32_bf16 v[174:177], a[32:35], v[162:165], v[174:177]
    v_fmac_f32 v254, v178, v178
    v_fmac_f32 v254, v179, v179
    v_mfma_f32_16x16x32_bf16 v[174:177], a[36:39], v[210:213], v[174:177]
    v_fmac_f32 v254, v180, v180
    v_fmac_f32 v254, v181, v181
    v_mfma_f32_16x16x32_bf16 v[174:177], a[40:43], v[226:229], v[174:177]
    v_cvt_pk_bf16_f32 v134, v255, v254
    v_add_u32 v5, 336, v5
    v_mfma_f32_16x16x32_bf16 v[174:177], a[44:47], v[218:221], v[174:177]
    ds_write_b64 v4, v[134:135] offset:18432
    v_mfma_f32_16x16x32_bf16 v[182:185], a[48:51], v[170:173], 0
    v_add_u32 v6, 272, v6
    v_add_u32 v7, 16, v7
    v_mfma_f32_16x16x32_bf16 v[182:185], a[52:55], v[166:169], v[182:185]
    v_fma_f32 v130, v114, v114, s32
    v_fmac_f32 v130, v115, v115
    v_mfma_f32_16x16x32_bf16 v[182:185], a[56:59], v[162:165], v[182:185]
    v_fmac_f32 v130, v116, v116
    v_fmac_f32 v130, v117, v117
    v_mfma_f32_16x16x32_bf16 v[182:185], a[60:63], v[210:213], v[182:185]
    v_fmac_f32 v130, v122, v122
    v_fmac_f32 v130, v123, v123
    v_mfma_f32_16x16x32_bf16 v[182:185], a[64:67], v[226:229], v[182:185]
    v_fmac_f32 v130, v124, v124
    v_fmac_f32 v130, v125, v125
    v_mfma_f32_16x16x32_bf16 v[182:185], a[68:71], v[218:221], v[182:185]
    v_fmac_f32 v130, v126, v126
    v_fmac_f32 v130, v127, v127
    v_mfma_f32_16x16x32_bf16 v[230:233], v[170:173], a[144:147], 0
    s_waitcnt lgkmcnt(0)
    v_fmac_f32 v130, v128, v128
    v_fmac_f32 v130, v129, v129
    v_mfma_f32_16x16x32_bf16 v[230:233], v[166:169], a[148:151], v[230:233]
    v_fma_f32 v131, v154, v154, s32
    v_fmac_f32 v131, v155, v155
    v_mfma_f32_16x16x32_bf16 v[230:233], v[162:165], a[152:155], v[230:233]
    v_fmac_f32 v131, v156, v156
    v_fmac_f32 v131, v157, v157
    v_mfma_f32_16x16x32_bf16 v[230:233], v[210:213], a[156:159], v[230:233]
    s_nop 0
    v_fmac_f32 v131, v174, v174
    v_xor_b32 v2, 65536, v2
    v_mfma_f32_16x16x32_bf16 v[230:233], v[226:229], a[160:163], v[230:233]
    s_barrier
    v_xor_b32 v3, 65536, v3
    v_xor_b32 v4, 65536, v4
    v_mfma_f32_16x16x32_bf16 v[230:233], v[218:221], a[164:167], v[230:233]
    s_cbranch_scc1 L_loop_safe3
L_final_safe:
    v_mfma_f32_16x16x32_bf16 v[118:121], v[170:173], a[168:171], 0
    s_mov_b32 s12, s42
    ds_read_b128 v[134:137], v2 offset:18432
    ds_read_b128 v[194:197], v2 offset:19456
    v_mfma_f32_16x16x32_bf16 v[118:121], v[166:169], a[172:175], v[118:121]
    s_mov_b32 s13, s43
    ds_read_b128 v[198:201], v0 offset:26624
    ds_read_b128 v[206:209], v1 offset:26624
    v_mfma_f32_16x16x32_bf16 v[118:121], v[162:165], a[176:179], v[118:121]
    s_mov_b32 s14, s36
    v_bfe_u32 v254, v2, 4, 6
    v_lshrrev_b32 v255, 4, v254
    v_mfma_f32_16x16x32_bf16 v[118:121], v[210:213], a[180:183], v[118:121]
    s_add_u32 s48, s42, s27
    ds_read_b128 v[214:217], v0 offset:26752
    ds_read_b128 v[222:225], v1 offset:26752
    v_mfma_f32_16x16x32_bf16 v[118:121], v[226:229], a[184:187], v[118:121]
    s_addc_u32 s49, s43, 0
    v_and_b32 v132, 15, v254
    v_lshlrev_b32 v133, 9, v255
    v_mfma_f32_16x16x32_bf16 v[118:121], v[218:221], a[188:191], v[118:121]
    s_sub_u32 s50, s36, s27
    ds_read_b128 v[234:237], v0 offset:26880
    s_mov_b32 s51, 0x00020000
    s_add_u32 s52, s42, s26
    s_addc_u32 s53, s43, 0
    s_sub_u32 s54, s36, s26
    s_mov_b32 s55, 0x00020000
    s_add_u32 s56, s42, s25
    s_addc_u32 s57, s43, 0
    s_sub_u32 s58, s36, s25
    s_mov_b32 s59, 0x00020000
    v_lshl_add_u32 v133, v132, 4, v133
    v_add_u32 v133, 136704, v133
    v_and_b32 v238, 0xffff, v2
    v_add_u32 v238, 148992, v238
    v_and_b32 v239, 0xffff, v4
    v_add_u32 v239, 148992, v239
    v_fmac_f32 v131, v175, v175
    v_fmac_f32 v131, v176, v176
    v_fmac_f32 v131, v177, v177
    v_fmac_f32 v131, v182, v182
    v_fmac_f32 v131, v183, v183
    v_fmac_f32 v131, v184, v184
    v_fmac_f32 v131, v185, v185
    v_cvt_pk_bf16_f32 v36, v131, v130
    v_cvt_pk_bf16_f32 v230, v230, v231
    v_cvt_pk_bf16_f32 v231, v232, v233
    v_mfma_f32_16x16x32_bf16 v[242:245], v[32:35], v[36:39], 0
    v_cvt_pk_bf16_f32 v118, v118, v119
    v_cvt_pk_bf16_f32 v119, v120, v121
    v_mfma_f32_16x16x32_bf16 v[246:249], v[170:173], a[192:195], 0
    s_waitcnt lgkmcnt(0)
    ds_read_b128 v[170:173], v1 offset:26880
    v_mov_b32 v240, 0x40000000
    v_mfma_f32_16x16x32_bf16 v[246:249], v[166:169], a[196:199], v[246:249]
    s_lshl_b32 s3, s16, 6
    v_rsq_f32 v243, v243
    v_mfma_f32_16x16x32_bf16 v[246:249], v[162:165], a[200:203], v[246:249]
    s_lshl_b32 s4, s16, 5
    ds_read_b128 v[162:165], v2 offset:0
    v_mul_f32 v114, v243, v114
    v_mfma_f32_16x16x32_bf16 v[246:249], v[210:213], a[204:207], v[246:249]
    s_add_u32 s4, s4, 256
    ds_read_b128 v[166:169], v2 offset:1024
    v_mul_f32 v115, v243, v115
    v_mfma_f32_16x16x32_bf16 v[246:249], v[226:229], a[208:211], v[246:249]
    s_mul_i32 s5, s16, 8064
    ds_read_b128 v[210:213], v2 offset:2048
    v_cvt_pk_f16_f32 v114, v114, v115
    v_mfma_f32_16x16x32_bf16 v[226:229], v[32:35], v[134:137], 0
    s_add_u32 s5, s5, 104448
    ds_read_b128 v[134:137], v2 offset:3072
    v_mul_f32 v116, v243, v116
    v_mfma_f32_16x16x32_bf16 v[226:229], v[32:35], v[194:197], v[226:229]
    ds_read_b128 v[194:197], v2 offset:4096
    v_mul_f32 v117, v243, v117
    v_mfma_f32_16x16x32_bf16 v[246:249], v[218:221], a[212:215], v[246:249]
    ds_read_b128 v[218:221], v2 offset:5120
    v_rsq_f32 v242, v242
    v_cvt_pk_f16_f32 v115, v116, v117
    v_mul_f32 v242, s31, v242
    v_mul_f32 v122, v243, v122
    v_mul_f32 v241, 0x3baaaaab, v227
    v_rsq_f32 v241, v241
    v_mul_f32 v116, 0x3baaaaab, v228
    v_mul_f32 v142, v241, v142
    v_mul_f32 v143, v241, v143
    v_cvt_pk_bf16_f32 v142, v142, v143
    v_mul_f32 v144, v241, v144
    v_mul_f32 v145, v241, v145
    v_cvt_pk_bf16_f32 v143, v144, v145
    v_mfma_f32_16x16x32_bf16 v[250:253], a[72:75], v[198:201], 0
    s_waitcnt lgkmcnt(3)
    v_mul_f32 v158, v241, v158
    v_mul_f32 v159, v241, v159
    v_mfma_f32_16x16x32_bf16 v[250:253], a[76:79], v[206:209], v[250:253]
    s_waitcnt lgkmcnt(2)
    v_cvt_pk_bf16_f32 v144, v158, v159
    v_mul_f32 v160, v241, v160
    v_mfma_f32_16x16x32_bf16 v[250:253], a[80:83], v[214:217], v[250:253]
    s_waitcnt lgkmcnt(1)
    v_mul_f32 v161, v241, v161
    v_cvt_pk_bf16_f32 v145, v160, v161
    v_mfma_f32_16x16x32_bf16 v[250:253], a[84:87], v[222:225], v[250:253]
    s_waitcnt lgkmcnt(0)
    buffer_store_dwordx4 v[142:145], v16, s[48:51], 0 offen nt
    v_mul_f32 v178, v241, v178
    v_mul_f32 v179, v241, v179
    v_cvt_pk_bf16_f32 v120, v178, v179
    v_mul_f32 v180, v241, v180
    v_mfma_f32_16x16x32_bf16 v[142:145], a[216:219], v[162:165], 0
    v_mul_f32 v181, v241, v181
    v_cvt_pk_bf16_f32 v121, v180, v181
    v_mfma_f32_16x16x32_bf16 v[142:145], a[220:223], v[166:169], v[142:145]
    v_rsq_f32 v116, v116
    v_mfma_f32_16x16x32_bf16 v[142:145], a[224:227], v[210:213], v[142:145]
    v_mul_f32 v146, v116, v146
    v_mul_f32 v147, v116, v147
    v_mfma_f32_16x16x32_bf16 v[142:145], a[228:231], v[134:137], v[142:145]
    v_cvt_pk_bf16_f32 v146, v146, v147
    v_mul_f32 v148, v116, v148
    v_mfma_f32_16x16x32_bf16 v[142:145], a[232:235], v[194:197], v[142:145]
    v_mul_f32 v149, v116, v149
    v_cvt_pk_bf16_f32 v147, v148, v149
    v_mfma_f32_16x16x32_bf16 v[142:145], a[236:239], v[218:221], v[142:145]
    v_mul_f32 v138, v116, v138
    v_mul_f32 v139, v116, v139
    v_mfma_f32_16x16x32_bf16 v[158:161], a[240:243], v[162:165], 0
    v_cvt_pk_bf16_f32 v148, v138, v139
    v_mul_f32 v140, v116, v140
    v_mfma_f32_16x16x32_bf16 v[158:161], a[244:247], v[166:169], v[158:161]
    v_mul_f32 v141, v116, v141
    v_cvt_pk_bf16_f32 v149, v140, v141
    v_mfma_f32_16x16x32_bf16 v[158:161], a[248:251], v[210:213], v[158:161]
    v_mul_f32 v186, v116, v186
    v_mul_f32 v187, v116, v187
    v_mfma_f32_16x16x32_bf16 v[158:161], a[252:255], v[134:137], v[158:161]
    v_cvt_pk_bf16_f32 v130, v186, v187
    v_mul_f32 v188, v116, v188
    v_mfma_f32_16x16x32_bf16 v[158:161], v[82:85], v[194:197], v[158:161]
    v_mul_f32 v189, v116, v189
    v_cvt_pk_bf16_f32 v131, v188, v189
    v_mfma_f32_16x16x32_bf16 v[158:161], v[86:89], v[218:221], v[158:161]
    v_mul_f32 v241, 0x3baaaaab, v226
    v_fma_f32 v232, v142, v142, s33
    v_mfma_f32_16x16x32_bf16 v[138:141], v[90:93], v[162:165], 0
    ds_read_b128 v[162:165], v2 offset:6144
    v_fmac_f32 v232, v143, v143
    v_mfma_f32_16x16x32_bf16 v[138:141], v[94:97], v[166:169], v[138:141]
    ds_read_b128 v[166:169], v2 offset:7168
    v_fmac_f32 v232, v144, v144
    v_mfma_f32_16x16x32_bf16 v[138:141], v[98:101], v[210:213], v[138:141]
    ds_read_b128 v[178:181], v2 offset:8192
    buffer_store_dwordx2 v[120:121], v19, s[48:51], 0 offen nt
    v_rsq_f32 v241, v241
    v_mfma_f32_16x16x32_bf16 v[138:141], v[102:105], v[134:137], v[138:141]
    ds_read_b128 v[134:137], v2 offset:9216
    v_mul_f32 v150, v241, v150
    v_mfma_f32_16x16x32_bf16 v[138:141], v[106:109], v[194:197], v[138:141]
    ds_read_b128 v[186:189], v2 offset:10240
    v_mul_f32 v151, v241, v151
    v_mfma_f32_16x16x32_bf16 v[138:141], v[110:113], v[218:221], v[138:141]
    ds_read_b128 v[194:197], v2 offset:11264
    v_cvt_pk_bf16_f32 v150, v150, v151
    v_mfma_f32_16x16x32_bf16 v[250:253], a[88:91], v[234:237], v[250:253]
    v_mul_f32 v152, v241, v152
    v_mul_f32 v153, v241, v153
    v_mfma_f32_16x16x32_bf16 v[250:253], a[92:95], v[170:173], v[250:253]
    s_waitcnt lgkmcnt(5)
    v_cvt_pk_bf16_f32 v151, v152, v153
    v_mul_f32 v190, v241, v190
    v_mfma_f32_16x16x32_bf16 v[210:213], a[216:219], v[162:165], 0
    s_waitcnt lgkmcnt(4)
    v_mul_f32 v191, v241, v191
    v_cvt_pk_bf16_f32 v152, v190, v191
    v_mfma_f32_16x16x32_bf16 v[210:213], a[220:223], v[166:169], v[210:213]
    s_waitcnt lgkmcnt(3)
    v_mul_f32 v192, v241, v192
    v_mul_f32 v193, v241, v193
    v_mfma_f32_16x16x32_bf16 v[210:213], a[224:227], v[178:181], v[210:213]
    v_cvt_pk_bf16_f32 v153, v192, v193
    v_mul_f32 v202, v241, v202
    v_mfma_f32_16x16x32_bf16 v[190:193], a[240:243], v[162:165], 0
    s_waitcnt lgkmcnt(2)
    v_mul_f32 v203, v241, v203
    v_cvt_pk_bf16_f32 v120, v202, v203
    v_mfma_f32_16x16x32_bf16 v[210:213], a[228:231], v[134:137], v[210:213]
    s_waitcnt lgkmcnt(1)
    v_mul_f32 v204, v241, v204
    v_mul_f32 v205, v241, v205
    v_mfma_f32_16x16x32_bf16 v[210:213], a[232:235], v[186:189], v[210:213]
    s_waitcnt lgkmcnt(0)
    v_cvt_pk_bf16_f32 v121, v204, v205
    v_fmac_f32 v232, v145, v145
    v_mfma_f32_16x16x32_bf16 v[210:213], a[236:239], v[194:197], v[210:213]
    v_fmac_f32 v232, v158, v158
    v_fmac_f32 v232, v159, v159
    v_mfma_f32_16x16x32_bf16 v[190:193], a[244:247], v[166:169], v[190:193]
    v_fmac_f32 v232, v160, v160
    v_fmac_f32 v232, v161, v161
    v_mfma_f32_16x16x32_bf16 v[190:193], a[248:251], v[178:181], v[190:193]
    v_fmac_f32 v232, v138, v138
    v_fmac_f32 v232, v139, v139
    v_mfma_f32_16x16x32_bf16 v[190:193], a[252:255], v[134:137], v[190:193]
    v_fma_f32 v241, v210, v210, s33
    v_fmac_f32 v241, v211, v211
    v_mfma_f32_16x16x32_bf16 v[190:193], v[82:85], v[186:189], v[190:193]
    buffer_store_dwordx4 v[146:149], v17, s[48:51], 0 offen nt
    v_fmac_f32 v241, v212, v212
    v_fmac_f32 v241, v213, v213
    v_fmac_f32 v232, v140, v140
    v_fmac_f32 v232, v141, v141
    v_mfma_f32_16x16x32_bf16 v[190:193], v[86:89], v[194:197], v[190:193]
    v_cvt_pk_bf16_f32 v146, v246, v247
    v_cvt_pk_bf16_f32 v147, v248, v249
    v_mfma_f32_16x16x32_bf16 v[202:205], v[90:93], v[162:165], 0
    ds_read_b128 v[162:165], v2 offset:12288
    v_mul_f32 v123, v243, v123
    v_mfma_f32_16x16x32_bf16 v[202:205], v[94:97], v[166:169], v[202:205]
    ds_read_b128 v[166:169], v2 offset:13312
    v_cvt_pk_f16_f32 v116, v122, v123
    v_mfma_f32_16x16x32_bf16 v[202:205], v[98:101], v[178:181], v[202:205]
    ds_read_b128 v[178:181], v2 offset:14336
    v_fmac_f32 v241, v190, v190
    v_mfma_f32_16x16x32_bf16 v[202:205], v[102:105], v[134:137], v[202:205]
    ds_read_b128 v[134:137], v2 offset:15360
    v_fmac_f32 v241, v191, v191
    v_mfma_f32_16x16x32_bf16 v[202:205], v[106:109], v[186:189], v[202:205]
    ds_read_b128 v[186:189], v2 offset:16384
    v_fmac_f32 v241, v192, v192
    v_mfma_f32_16x16x32_bf16 v[202:205], v[110:113], v[194:197], v[202:205]
    ds_read_b128 v[194:197], v2 offset:17408
    v_fmac_f32 v241, v193, v193
    v_mfma_f32_16x16x32_bf16 v[218:221], a[96:99], v[198:201], 0
    v_mul_f32 v124, v243, v124
    v_mul_f32 v125, v243, v125
    v_mfma_f32_16x16x32_bf16 v[218:221], a[100:103], v[206:209], v[218:221]
    v_cvt_pk_f16_f32 v117, v124, v125
    v_mul_f32 v126, v243, v126
    v_mfma_f32_16x16x32_bf16 v[218:221], a[104:107], v[214:217], v[218:221]
    s_waitcnt lgkmcnt(5)
    v_fmac_f32 v241, v202, v202
    v_fmac_f32 v241, v203, v203
    v_mfma_f32_16x16x32_bf16 v[218:221], a[108:111], v[222:225], v[218:221]
    s_waitcnt lgkmcnt(4)
    v_fmac_f32 v241, v204, v204
    v_fmac_f32 v241, v205, v205
    v_mfma_f32_16x16x32_bf16 v[218:221], a[112:115], v[234:237], v[218:221]
    s_waitcnt lgkmcnt(3)
    v_cvt_pk_bf16_f32 v148, v232, v241
    v_cvt_pk_bf16_f32 v149, v241, v241
    v_mfma_f32_16x16x32_bf16 v[218:221], a[116:119], v[170:173], v[218:221]
    s_waitcnt lgkmcnt(2)
    ds_write_b64 v239, v[148:149] offset:0
    v_mfma_f32_16x16x32_bf16 v[122:125], a[216:219], v[162:165], 0
    s_waitcnt lgkmcnt(1)
    v_mul_f32 v127, v243, v127
    v_cvt_pk_f16_f32 v228, v126, v127
    v_mfma_f32_16x16x32_bf16 v[122:125], a[220:223], v[166:169], v[122:125]
    buffer_store_dwordx2 v[130:131], v20, s[48:51], 0 offen nt
    v_mul_f32 v128, v243, v128
    v_mul_f32 v129, v243, v129
    v_mfma_f32_16x16x32_bf16 v[122:125], a[224:227], v[178:181], v[122:125]
    v_cvt_pk_f16_f32 v229, v128, v129
    v_mul_f32 v154, v242, v154
    v_mfma_f32_16x16x32_bf16 v[122:125], a[228:231], v[134:137], v[122:125]
    v_mul_f32 v155, v242, v155
    v_cvt_pk_f16_f32 v126, v154, v155
    v_mfma_f32_16x16x32_bf16 v[122:125], a[232:235], v[186:189], v[122:125]
    v_mul_f32 v156, v242, v156
    v_mul_f32 v157, v242, v157
    v_mfma_f32_16x16x32_bf16 v[122:125], a[236:239], v[194:197], v[122:125]
    v_cvt_pk_f16_f32 v127, v156, v157
    v_mul_f32 v174, v242, v174
    v_mfma_f32_16x16x32_bf16 v[154:157], a[240:243], v[162:165], 0
    s_waitcnt lgkmcnt(0)
    v_mul_f32 v175, v242, v175
    v_cvt_pk_f16_f32 v128, v174, v175
    v_mfma_f32_16x16x32_bf16 v[154:157], a[244:247], v[166:169], v[154:157]
    s_barrier
    ds_read_b128 v[246:249], v238 offset:0
    v_mul_f32 v176, v242, v176
    v_mfma_f32_16x16x32_bf16 v[154:157], a[248:251], v[178:181], v[154:157]
    v_mul_f32 v177, v242, v177
    v_cvt_pk_f16_f32 v129, v176, v177
    v_mfma_f32_16x16x32_bf16 v[154:157], a[252:255], v[134:137], v[154:157]
    v_mul_f32 v182, v242, v182
    v_mul_f32 v183, v242, v183
    v_mfma_f32_16x16x32_bf16 v[154:157], v[82:85], v[186:189], v[154:157]
    v_cvt_pk_f16_f32 v226, v182, v183
    v_mul_f32 v184, v242, v184
    v_mfma_f32_16x16x32_bf16 v[154:157], v[86:89], v[194:197], v[154:157]
    v_mul_f32 v185, v242, v185
    v_cvt_pk_f16_f32 v227, v184, v185
    v_mfma_f32_16x16x32_bf16 v[174:177], v[90:93], v[162:165], 0
    ds_read_b128 v[162:165], v238 offset:1024
    v_add_u32 v241, 0, v132
    v_mfma_f32_16x16x32_bf16 v[174:177], v[94:97], v[166:169], v[174:177]
    ds_read_b128 v[166:169], v133 offset:0
    v_mul_u32_u24 v130, s20, v241
    v_mfma_f32_16x16x32_bf16 v[174:177], v[98:101], v[178:181], v[174:177]
    v_add_u32 v130, s38, v130
    v_mul_u32_u24 v130, 911, v130
    v_mfma_f32_16x16x32_bf16 v[174:177], v[102:105], v[134:137], v[174:177]
    s_waitcnt lgkmcnt(2)
    ds_read_b128 v[134:137], v133 offset:2048
    v_lshrrev_b32 v130, 16, v130
    v_mfma_f32_16x16x32_bf16 v[174:177], v[106:109], v[186:189], v[174:177]
    ds_read_b128 v[178:181], v133 offset:4096
    v_mul_u32_u24 v130, s22, v130
    v_mfma_f32_16x16x32_bf16 v[174:177], v[110:113], v[194:197], v[174:177]
    ds_read_b128 v[182:185], v133 offset:6144
    buffer_store_dwordx4 v[150:153], v15, s[48:51], 0 offen nt
    ds_read_b128 v[186:189], v133 offset:8192
    v_mad_u32_u24 v130, v241, s21, v130
    v_cmp_gt_u32 vcc, s17, v241
    v_add_u32 v241, s7, v130
    v_mfma_f32_16x16x32_bf16 v[150:153], v[32:35], v[246:249], 0
    ds_read_b128 v[194:197], v133 offset:10240
    s_waitcnt lgkmcnt(6)
    v_mfma_f32_16x16x32_bf16 v[150:153], v[32:35], v[162:165], v[150:153]
    v_cndmask_b32 v241, v240, v241, vcc
    v_lshl_add_u32 v130, v255, 4, v241
    v_mfma_f32_16x16x32_bf16 v[162:165], a[120:123], v[198:201], 0
    s_waitcnt lgkmcnt(5)
    v_add_u32 v130, s3, v130
    v_lshl_add_u32 v241, v255, 3, v241
    v_mfma_f32_16x16x32_bf16 v[162:165], a[124:127], v[206:209], v[162:165]
    v_add_u32 v241, s4, v241
    v_mul_f32 v131, 0x3baaaaab, v151
    v_mfma_f32_16x16x32_bf16 v[162:165], a[128:131], v[214:217], v[162:165]
    s_waitcnt lgkmcnt(4)
    v_rsq_f32 v131, v131
    v_mfma_f32_16x16x32_bf16 v[162:165], a[132:135], v[222:225], v[162:165]
    s_waitcnt lgkmcnt(3)
    v_mul_f32 v210, v131, v210
    v_mul_f32 v211, v131, v211
    v_mfma_f32_16x16x32_bf16 v[162:165], a[136:139], v[234:237], v[162:165]
    s_waitcnt lgkmcnt(1)
    v_cvt_pk_bf16_f32 v210, v210, v211
    v_mul_f32 v212, v131, v212
    v_mfma_f32_16x16x32_bf16 v[162:165], a[140:143], v[170:173], v[162:165]
    v_mul_f32 v213, v131, v213
    v_cvt_pk_bf16_f32 v211, v212, v213
    v_mul_f32 v190, v131, v190
    v_mul_f32 v191, v131, v191
    v_cvt_pk_bf16_f32 v212, v190, v191
    v_mfma_f32_16x16x32_bf16 v[242:245], a[216:219], v[166:169], 0
    s_waitcnt lgkmcnt(0)
    v_mul_f32 v192, v131, v192
    v_mul_f32 v193, v131, v193
    v_mfma_f32_16x16x32_bf16 v[242:245], a[220:223], v[134:137], v[242:245]
    v_cvt_pk_bf16_f32 v213, v192, v193
    v_mul_f32 v202, v131, v202
    v_mfma_f32_16x16x32_bf16 v[242:245], a[224:227], v[178:181], v[242:245]
    v_mul_f32 v203, v131, v203
    v_cvt_pk_bf16_f32 v148, v202, v203
    v_mfma_f32_16x16x32_bf16 v[242:245], a[228:231], v[182:185], v[242:245]
    v_mul_f32 v204, v131, v204
    v_mul_f32 v205, v131, v205
    v_mfma_f32_16x16x32_bf16 v[242:245], a[232:235], v[186:189], v[242:245]
    v_cvt_pk_bf16_f32 v149, v204, v205
    v_mul_f32 v131, 0x3baaaaab, v150
    v_mfma_f32_16x16x32_bf16 v[242:245], a[236:239], v[194:197], v[242:245]
    v_rsq_f32 v131, v131
    v_mfma_f32_16x16x32_bf16 v[150:153], a[240:243], v[166:169], 0
    buffer_store_dwordx4 v[210:213], v16, s[52:55], 0 offen nt
    v_mul_f32 v142, v131, v142
    v_mul_f32 v143, v131, v143
    v_cvt_pk_bf16_f32 v142, v142, v143
    v_mul_f32 v144, v131, v144
    v_mfma_f32_16x16x32_bf16 v[150:153], a[244:247], v[134:137], v[150:153]
    v_mul_f32 v145, v131, v145
    v_cvt_pk_bf16_f32 v143, v144, v145
    v_mfma_f32_16x16x32_bf16 v[150:153], a[248:251], v[178:181], v[150:153]
    v_mul_f32 v158, v131, v158
    v_mul_f32 v159, v131, v159
    v_mfma_f32_16x16x32_bf16 v[150:153], a[252:255], v[182:185], v[150:153]
    v_cvt_pk_bf16_f32 v144, v158, v159
    v_mul_f32 v160, v131, v160
    v_mfma_f32_16x16x32_bf16 v[150:153], v[82:85], v[186:189], v[150:153]
    v_mul_f32 v161, v131, v161
    v_cvt_pk_bf16_f32 v145, v160, v161
    v_mfma_f32_16x16x32_bf16 v[150:153], v[86:89], v[194:197], v[150:153]
    v_mul_f32 v138, v131, v138
    v_mul_f32 v139, v131, v139
    v_mfma_f32_16x16x32_bf16 v[158:161], v[90:93], v[166:169], 0
    v_cvt_pk_bf16_f32 v138, v138, v139
    v_mul_f32 v140, v131, v140
    v_mfma_f32_16x16x32_bf16 v[158:161], v[94:97], v[134:137], v[158:161]
    v_mul_f32 v141, v131, v141
    v_cvt_pk_bf16_f32 v139, v140, v141
    v_mfma_f32_16x16x32_bf16 v[158:161], v[98:101], v[178:181], v[158:161]
    v_fma_f32 v131, v242, v242, s33
    v_fmac_f32 v131, v243, v243
    v_mfma_f32_16x16x32_bf16 v[158:161], v[102:105], v[182:185], v[158:161]
    v_fmac_f32 v131, v244, v244
    v_fmac_f32 v131, v245, v245
    v_mfma_f32_16x16x32_bf16 v[158:161], v[106:109], v[186:189], v[158:161]
    v_fmac_f32 v131, v150, v150
    v_fmac_f32 v131, v151, v151
    v_mfma_f32_16x16x32_bf16 v[158:161], v[110:113], v[194:197], v[158:161]
    v_fmac_f32 v131, v152, v152
    v_fmac_f32 v131, v153, v153
    v_mfma_f32_16x16x32_bf16 v[134:137], a[0:3], v[198:201], 0
    v_fma_f32 v140, v122, v122, s33
    v_fmac_f32 v140, v123, v123
    v_mfma_f32_16x16x32_bf16 v[134:137], a[4:7], v[206:209], v[134:137]
    v_fmac_f32 v140, v124, v124
    v_fmac_f32 v140, v125, v125
    v_mfma_f32_16x16x32_bf16 v[134:137], a[8:11], v[214:217], v[134:137]
    v_fmac_f32 v131, v158, v158
    v_fmac_f32 v131, v159, v159
    v_mfma_f32_16x16x32_bf16 v[134:137], a[12:15], v[222:225], v[134:137]
    v_fmac_f32 v131, v160, v160
    v_fmac_f32 v131, v161, v161
    v_mfma_f32_16x16x32_bf16 v[134:137], a[16:19], v[234:237], v[134:137]
    buffer_store_dwordx2 v[148:149], v19, s[52:55], 0 offen nt
    v_cvt_pk_bf16_f32 v141, v131, v131
    v_fmac_f32 v140, v154, v154
    v_mfma_f32_16x16x32_bf16 v[134:137], a[20:23], v[170:173], v[134:137]
    v_fmac_f32 v140, v155, v155
    v_fmac_f32 v140, v156, v156
    v_mfma_f32_16x16x32_bf16 v[166:169], a[24:27], v[198:201], 0
    v_fmac_f32 v140, v157, v157
    v_fmac_f32 v140, v174, v174
    v_mfma_f32_16x16x32_bf16 v[166:169], a[28:31], v[206:209], v[166:169]
    v_fmac_f32 v140, v175, v175
    v_fmac_f32 v140, v176, v176
    v_mfma_f32_16x16x32_bf16 v[166:169], a[32:35], v[214:217], v[166:169]
    v_fmac_f32 v140, v177, v177
    v_cvt_pk_bf16_f32 v140, v140, v131
    v_mfma_f32_16x16x32_bf16 v[166:169], a[36:39], v[222:225], v[166:169]
    ds_write_b64 v239, v[140:141] offset:2048
    v_mfma_f32_16x16x32_bf16 v[166:169], a[40:43], v[234:237], v[166:169]
    v_fma_f32 v131, v134, v134, s32
    v_fmac_f32 v131, v135, v135
    v_mfma_f32_16x16x32_bf16 v[166:169], a[44:47], v[170:173], v[166:169]
    v_fmac_f32 v131, v136, v136
    v_fmac_f32 v131, v137, v137
    v_mfma_f32_16x16x32_bf16 v[178:181], a[48:51], v[198:201], 0
    v_fma_f32 v140, v250, v250, s32
    v_fmac_f32 v140, v251, v251
    v_mfma_f32_16x16x32_bf16 v[178:181], a[52:55], v[206:209], v[178:181]
    v_fmac_f32 v140, v252, v252
    v_fmac_f32 v140, v253, v253
    v_mfma_f32_16x16x32_bf16 v[178:181], a[56:59], v[214:217], v[178:181]
    v_fmac_f32 v131, v166, v166
    v_fmac_f32 v131, v167, v167
    v_mfma_f32_16x16x32_bf16 v[178:181], a[60:63], v[222:225], v[178:181]
    v_fmac_f32 v131, v168, v168
    v_fmac_f32 v131, v169, v169
    v_mfma_f32_16x16x32_bf16 v[178:181], a[64:67], v[234:237], v[178:181]
    s_waitcnt lgkmcnt(0)
    v_fmac_f32 v140, v218, v218
    v_fmac_f32 v140, v219, v219
    v_mfma_f32_16x16x32_bf16 v[178:181], a[68:71], v[170:173], v[178:181]
    s_barrier
    ds_read_b128 v[182:185], v238 offset:2048
    ds_read_b128 v[186:189], v238 offset:3072
    v_mfma_f32_16x16x32_bf16 v[190:193], v[198:201], a[144:147], 0
    v_fmac_f32 v140, v220, v220
    v_fmac_f32 v140, v221, v221
    v_mfma_f32_16x16x32_bf16 v[190:193], v[206:209], a[148:151], v[190:193]
    v_fmac_f32 v140, v162, v162
    v_fmac_f32 v131, v178, v178
    v_mfma_f32_16x16x32_bf16 v[190:193], v[214:217], a[152:155], v[190:193]
    buffer_store_dwordx2 v[120:121], v18, s[48:51], 0 offen nt
    v_fmac_f32 v131, v179, v179
    v_fmac_f32 v131, v180, v180
    v_mfma_f32_16x16x32_bf16 v[190:193], v[222:225], a[156:159], v[190:193]
    v_fmac_f32 v131, v181, v181
    v_fmac_f32 v140, v163, v163
    v_mfma_f32_16x16x32_bf16 v[190:193], v[234:237], a[160:163], v[190:193]
    v_fmac_f32 v140, v164, v164
    v_fmac_f32 v140, v165, v165
    v_mfma_f32_16x16x32_bf16 v[190:193], v[170:173], a[164:167], v[190:193]
    ds_read_b128 v[194:197], v0 offset:32768
    v_cvt_pk_bf16_f32 v36, v131, v140
    v_mfma_f32_16x16x32_bf16 v[202:205], v[198:201], a[168:171], 0
    s_waitcnt lgkmcnt(2)
    v_xor_b32 v131, 65536, v2
    v_bfe_u32 v120, v132, 1, 2
    v_mfma_f32_16x16x32_bf16 v[202:205], v[206:209], a[172:175], v[202:205]
    s_waitcnt lgkmcnt(1)
    v_cvt_pk_bf16_f32 v232, v190, v191
    v_cvt_pk_bf16_f32 v233, v192, v193
    v_mfma_f32_16x16x32_bf16 v[202:205], v[214:217], a[176:179], v[202:205]
    v_xor_b32 v120, v120, v255
    v_lshl_add_u32 v120, v132, 2, v120
    v_mfma_f32_16x16x32_bf16 v[202:205], v[222:225], a[180:183], v[202:205]
    v_lshl_add_u32 v140, v120, 4, s5
    v_lshl_add_u32 v141, v120, 3, s5
    v_mfma_f32_16x16x32_bf16 v[202:205], v[234:237], a[184:187], v[202:205]
    v_lshl_add_u32 v190, v254, 4, s5
    v_lshl_add_u32 v254, v254, 3, s5
    v_mfma_f32_16x16x32_bf16 v[202:205], v[170:173], a[188:191], v[202:205]
    v_lshlrev_b32 v120, 2, v120
    ds_permute_b32 v191, v120, v16
    ds_permute_b32 v192, v120, v19
    ds_permute_b32 v193, v120, v17
    ds_permute_b32 v210, v120, v20
    v_subrev_u32 v148, 0x3d800000, v44
    v_sub_u32 v149, 0x4a000000, v45
    v_or3_b32 v148, v148, v149, v45
    v_cvt_pk_bf16_f32 v120, v202, v203
    v_cvt_pk_bf16_f32 v121, v204, v205
    v_lshl_add_u32 v149, s16, 2, v131
    ds_write_b32 v149, v148 offset:18432
    v_add_u32 v132, 16, v132
    v_mul_u32_u24 v148, s20, v132
    v_add_u32 v148, s38, v148
    v_mul_u32_u24 v148, 911, v148
    v_lshrrev_b32 v148, 16, v148
    v_mul_u32_u24 v148, s22, v148
    v_mad_u32_u24 v148, v132, s21, v148
    v_cmp_gt_u32 vcc, s17, v132
    buffer_store_dwordx4 v[142:145], v15, s[52:55], 0 offen nt
    v_add_u32 v132, s7, v148
    v_cndmask_b32 v132, v240, v132, vcc
    v_lshl_add_u32 v240, v255, 4, v132
    v_add_u32 v240, s3, v240
    v_lshl_add_u32 v255, v255, 3, v132
    v_mfma_f32_16x16x32_bf16 v[142:145], v[32:35], v[36:39], 0
    v_add_u32 v255, s4, v255
    s_nop 0
    s_nop 0
    s_nop 0
    s_nop 0
    s_nop 0
    s_nop 0
    s_nop 0
    v_rsq_f32 v143, v143
    v_rsq_f32 v142, v142
    v_mul_f32 v250, v143, v250
    v_mul_f32 v142, s31, v142
    v_mul_f32 v251, v143, v251
    v_cvt_pk_f16_f32 v202, v250, v251
    v_mul_f32 v252, v143, v252
    v_mul_f32 v253, v143, v253
    v_cvt_pk_f16_f32 v203, v252, v253
    v_mfma_f32_16x16x32_bf16 v[246:249], v[32:35], v[182:185], 0
    s_waitcnt lgkmcnt(0)
    ds_read_b128 v[182:185], v1 offset:32768
    v_mul_f32 v218, v143, v218
    v_mfma_f32_16x16x32_bf16 v[246:249], v[32:35], v[186:189], v[246:249]
    ds_read_b128 v[186:189], v0 offset:32896
    v_mul_f32 v219, v143, v219
    v_cvt_pk_f16_f32 v204, v218, v219
    v_mul_f32 v220, v143, v220
    v_mul_f32 v221, v143, v221
    v_cvt_pk_f16_f32 v205, v220, v221
    v_mfma_f32_16x16x32_bf16 v[218:221], v[198:201], a[192:195], 0
    ds_read_b128 v[198:201], v1 offset:32896
    v_mul_f32 v132, 0x3baaaaab, v247
    v_mfma_f32_16x16x32_bf16 v[218:221], v[206:209], a[196:199], v[218:221]
    ds_read_b128 v[206:209], v0 offset:33024
    v_mul_f32 v162, v143, v162
    v_mfma_f32_16x16x32_bf16 v[218:221], v[214:217], a[200:203], v[218:221]
    ds_read_b128 v[214:217], v1 offset:33024
    v_mul_f32 v163, v143, v163
    v_mfma_f32_16x16x32_bf16 v[218:221], v[222:225], a[204:207], v[218:221]
    v_rsq_f32 v132, v132
    v_mfma_f32_16x16x32_bf16 v[218:221], v[234:237], a[208:211], v[218:221]
    v_mul_f32 v242, v132, v242
    v_mul_f32 v243, v132, v243
    v_mfma_f32_16x16x32_bf16 v[218:221], v[170:173], a[212:215], v[218:221]
    s_waitcnt lgkmcnt(4)
    v_cvt_pk_bf16_f32 v170, v242, v243
    v_mul_f32 v244, v132, v244
    v_mfma_f32_16x16x32_bf16 v[222:225], a[72:75], v[194:197], 0
    s_waitcnt lgkmcnt(3)
    buffer_store_dwordx2 v[138:139], v18, s[52:55], 0 offen nt
    v_mul_f32 v245, v132, v245
    v_cvt_pk_bf16_f32 v171, v244, v245
    v_mfma_f32_16x16x32_bf16 v[222:225], a[76:79], v[182:185], v[222:225]
    s_waitcnt lgkmcnt(2)
    v_mul_f32 v150, v132, v150
    v_mul_f32 v151, v132, v151
    v_mfma_f32_16x16x32_bf16 v[222:225], a[80:83], v[186:189], v[222:225]
    s_waitcnt lgkmcnt(1)
    v_cvt_pk_bf16_f32 v172, v150, v151
    v_mul_f32 v152, v132, v152
    v_mfma_f32_16x16x32_bf16 v[222:225], a[84:87], v[198:201], v[222:225]
    s_waitcnt lgkmcnt(0)
    v_mul_f32 v153, v132, v153
    v_cvt_pk_bf16_f32 v173, v152, v153
    v_mfma_f32_16x16x32_bf16 v[222:225], a[88:91], v[206:209], v[222:225]
    v_mul_f32 v158, v132, v158
    v_mul_f32 v159, v132, v159
    v_mfma_f32_16x16x32_bf16 v[222:225], a[92:95], v[214:217], v[222:225]
    v_cvt_pk_bf16_f32 v138, v158, v159
    v_mul_f32 v160, v132, v160
    v_mfma_f32_16x16x32_bf16 v[150:153], a[96:99], v[194:197], 0
    v_mul_f32 v161, v132, v161
    v_cvt_pk_bf16_f32 v139, v160, v161
    v_mfma_f32_16x16x32_bf16 v[150:153], a[100:103], v[182:185], v[150:153]
    v_cvt_pk_bf16_f32 v148, v218, v219
    v_cvt_pk_bf16_f32 v149, v220, v221
    v_mfma_f32_16x16x32_bf16 v[150:153], a[104:107], v[186:189], v[150:153]
    v_cvt_pk_f16_f32 v160, v162, v163
    v_mul_f32 v164, v143, v164
    v_mfma_f32_16x16x32_bf16 v[150:153], a[108:111], v[198:201], v[150:153]
    v_mul_f32 v165, v143, v165
    v_cvt_pk_f16_f32 v161, v164, v165
    v_mfma_f32_16x16x32_bf16 v[150:153], a[112:115], v[206:209], v[150:153]
    v_mul_f32 v134, v142, v134
    v_mul_f32 v135, v142, v135
    v_mfma_f32_16x16x32_bf16 v[150:153], a[116:119], v[214:217], v[150:153]
    v_cvt_pk_f16_f32 v134, v134, v135
    v_mul_f32 v136, v142, v136
    v_mfma_f32_16x16x32_bf16 v[162:165], a[120:123], v[194:197], 0
    v_mul_f32 v137, v142, v137
    v_cvt_pk_f16_f32 v135, v136, v137
    v_mfma_f32_16x16x32_bf16 v[162:165], a[124:127], v[182:185], v[162:165]
    v_mul_f32 v166, v142, v166
    v_mul_f32 v167, v142, v167
    v_mfma_f32_16x16x32_bf16 v[162:165], a[128:131], v[186:189], v[162:165]
    v_cvt_pk_f16_f32 v136, v166, v167
    v_mul_f32 v168, v142, v168
    v_mfma_f32_16x16x32_bf16 v[162:165], a[132:135], v[198:201], v[162:165]
    v_mul_f32 v169, v142, v169
    v_cvt_pk_f16_f32 v137, v168, v169
    v_mfma_f32_16x16x32_bf16 v[162:165], a[136:139], v[206:209], v[162:165]
    buffer_store_dwordx4 v[170:173], v130, s[12:15], 0 offen nt
    v_mul_f32 v178, v142, v178
    v_mul_f32 v179, v142, v179
    v_cvt_pk_f16_f32 v158, v178, v179
    v_mul_f32 v180, v142, v180
    v_mfma_f32_16x16x32_bf16 v[162:165], a[140:143], v[214:217], v[162:165]
    v_mul_f32 v181, v142, v181
    v_cvt_pk_f16_f32 v159, v180, v181
    v_mfma_f32_16x16x32_bf16 v[142:145], a[0:3], v[194:197], 0
    v_mul_f32 v130, 0x3baaaaab, v246
    v_fma_f32 v132, v222, v222, s32
    v_mfma_f32_16x16x32_bf16 v[142:145], a[4:7], v[182:185], v[142:145]
    v_rsq_f32 v130, v130
    v_mfma_f32_16x16x32_bf16 v[142:145], a[8:11], v[186:189], v[142:145]
    v_mul_f32 v122, v130, v122
    v_mul_f32 v123, v130, v123
    v_mfma_f32_16x16x32_bf16 v[142:145], a[12:15], v[198:201], v[142:145]
    v_cvt_pk_bf16_f32 v122, v122, v123
    v_mul_f32 v124, v130, v124
    v_mfma_f32_16x16x32_bf16 v[142:145], a[16:19], v[206:209], v[142:145]
    v_mul_f32 v125, v130, v125
    v_cvt_pk_bf16_f32 v123, v124, v125
    v_mfma_f32_16x16x32_bf16 v[142:145], a[20:23], v[214:217], v[142:145]
    v_mul_f32 v154, v130, v154
    v_mul_f32 v155, v130, v155
    v_mfma_f32_16x16x32_bf16 v[166:169], a[24:27], v[194:197], 0
    v_cvt_pk_bf16_f32 v124, v154, v155
    v_mul_f32 v156, v130, v156
    v_mfma_f32_16x16x32_bf16 v[166:169], a[28:31], v[182:185], v[166:169]
    v_mul_f32 v157, v130, v157
    v_cvt_pk_bf16_f32 v125, v156, v157
    v_mfma_f32_16x16x32_bf16 v[166:169], a[32:35], v[186:189], v[166:169]
    v_mul_f32 v174, v130, v174
    v_mul_f32 v175, v130, v175
    v_mfma_f32_16x16x32_bf16 v[166:169], a[36:39], v[198:201], v[166:169]
    v_cvt_pk_bf16_f32 v212, v174, v175
    v_mul_f32 v176, v130, v176
    v_mfma_f32_16x16x32_bf16 v[166:169], a[40:43], v[206:209], v[166:169]
    v_mul_f32 v177, v130, v177
    v_cvt_pk_bf16_f32 v213, v176, v177
    v_mfma_f32_16x16x32_bf16 v[166:169], a[44:47], v[214:217], v[166:169]
    v_fma_f32 v130, v142, v142, s32
    v_fmac_f32 v130, v143, v143
    v_mfma_f32_16x16x32_bf16 v[154:157], a[48:51], v[194:197], 0
    v_fmac_f32 v130, v144, v144
    v_fmac_f32 v130, v145, v145
    v_mfma_f32_16x16x32_bf16 v[154:157], a[52:55], v[182:185], v[154:157]
    v_fmac_f32 v132, v223, v223
    v_fmac_f32 v132, v224, v224
    v_mfma_f32_16x16x32_bf16 v[154:157], a[56:59], v[186:189], v[154:157]
    ds_read2_b32 v[172:173], v6 offset0:0 offset1:0
    ds_read2_b32 v[176:177], v6 offset0:16 offset1:16
    v_mfma_f32_16x16x32_bf16 v[154:157], a[60:63], v[198:201], v[154:157]
    ds_read2_b32 v[180:181], v6 offset0:32 offset1:32
    buffer_store_dwordx2 v[138:139], v241, s[12:15], 0 offen nt
    v_fmac_f32 v130, v166, v166
    v_fmac_f32 v130, v167, v167
    v_mfma_f32_16x16x32_bf16 v[154:157], a[64:67], v[206:209], v[154:157]
    v_fmac_f32 v130, v168, v168
    v_fmac_f32 v130, v169, v169
    v_mfma_f32_16x16x32_bf16 v[154:157], a[68:71], v[214:217], v[154:157]
    v_fmac_f32 v132, v225, v225
    v_fmac_f32 v132, v150, v150
    v_mfma_f32_16x16x32_bf16 v[218:221], v[194:197], a[144:147], 0
    v_fmac_f32 v132, v151, v151
    v_fmac_f32 v132, v152, v152
    v_mfma_f32_16x16x32_bf16 v[218:221], v[182:185], a[148:151], v[218:221]
    v_fmac_f32 v132, v153, v153
    v_fmac_f32 v132, v162, v162
    v_mfma_f32_16x16x32_bf16 v[218:221], v[186:189], a[152:155], v[218:221]
    v_fmac_f32 v130, v154, v154
    v_fmac_f32 v130, v155, v155
    v_mfma_f32_16x16x32_bf16 v[218:221], v[198:201], a[156:159], v[218:221]
    s_waitcnt lgkmcnt(1)
    v_fmac_f32 v130, v156, v156
    v_fmac_f32 v130, v157, v157
    v_mfma_f32_16x16x32_bf16 v[218:221], v[206:209], a[160:163], v[218:221]
    s_waitcnt lgkmcnt(0)
    v_fmac_f32 v132, v163, v163
    v_fmac_f32 v132, v164, v164
    v_mfma_f32_16x16x32_bf16 v[218:221], v[214:217], a[164:167], v[218:221]
    v_fmac_f32 v132, v165, v165
    v_cvt_pk_bf16_f32 v36, v130, v132
    v_mfma_f32_16x16x32_bf16 v[234:237], v[194:197], a[168:171], 0
    v_mfma_f32_16x16x32_bf16 v[234:237], v[182:185], a[172:175], v[234:237]
    v_mfma_f32_16x16x32_bf16 v[242:245], v[32:35], v[36:39], 0
    v_mfma_f32_16x16x32_bf16 v[234:237], v[186:189], a[176:179], v[234:237]
    v_mfma_f32_16x16x32_bf16 v[234:237], v[198:201], a[180:183], v[234:237]
    v_mfma_f32_16x16x32_bf16 v[234:237], v[206:209], a[184:187], v[234:237]
    v_cvt_pk_bf16_f32 v170, v218, v219
    v_cvt_pk_bf16_f32 v171, v220, v221
    v_mfma_f32_16x16x32_bf16 v[234:237], v[214:217], a[188:191], v[234:237]
    v_mfma_f32_16x16x32_bf16 v[218:221], v[194:197], a[192:195], 0
    buffer_store_dwordx4 v[122:125], v17, s[52:55], 0 offen nt
    v_rsq_f32 v243, v243
    v_rsq_f32 v242, v242
    v_mfma_f32_16x16x32_bf16 v[218:221], v[182:185], a[196:199], v[218:221]
    v_mul_f32 v242, s31, v242
    v_mul_f32 v222, v243, v222
    v_mfma_f32_16x16x32_bf16 v[218:221], v[186:189], a[200:203], v[218:221]
    v_cvt_pk_bf16_f32 v174, v234, v235
    v_cvt_pk_bf16_f32 v175, v236, v237
    v_mfma_f32_16x16x32_bf16 v[218:221], v[198:201], a[204:207], v[218:221]
    v_mul_f32 v223, v243, v223
    v_cvt_pk_f16_f32 v122, v222, v223
    v_mfma_f32_16x16x32_bf16 v[218:221], v[206:209], a[208:211], v[218:221]
    ds_read_b128 v[182:185], v5 offset:0
    ds_read_b128 v[186:189], v5 offset:16
    v_mfma_f32_16x16x32_f16 v[194:197], v[114:117], v[126:129], v[46:49]
    ds_read_b128 v[198:201], v5 offset:48
    ds_read_b32 v241, v6 offset:192
    v_mfma_f32_16x16x32_f16 v[206:209], v[202:205], v[126:129], v[50:53]
    v_mul_f32 v224, v243, v224
    v_mul_f32 v225, v243, v225
    v_mfma_f32_16x16x32_bf16 v[218:221], v[214:217], a[212:215], v[218:221]
    v_cvt_pk_f16_f32 v123, v224, v225
    v_mul_f32 v150, v243, v150
    v_mul_f32 v151, v243, v151
    v_mfma_f32_16x16x16_f16 v[194:197], v[228:229], v[226:227], v[194:197]
    v_cvt_pk_f16_f32 v124, v150, v151
    v_mul_f32 v152, v243, v152
    v_mul_f32 v153, v243, v153
    v_mfma_f32_16x16x16_f16 v[206:209], v[160:161], v[226:227], v[206:209]
    v_cvt_pk_bf16_f32 v178, v218, v219
    v_cvt_pk_bf16_f32 v179, v220, v221
    v_cvt_pk_f16_f32 v125, v152, v153
    v_mul_f32 v162, v243, v162
    v_mul_f32 v163, v243, v163
    v_mfma_f32_16x16x32_f16 v[150:153], v[122:125], v[126:129], v[54:57]
    v_cvt_pk_f16_f32 v216, v162, v163
    s_waitcnt lgkmcnt(3)
    v_mfma_f32_16x16x32_f16 v[218:221], v[182:185], v[126:129], v[22:25]
    s_waitcnt lgkmcnt(2)
    v_mul_f32 v164, v243, v164
    v_mul_f32 v165, v243, v165
    v_mfma_f32_16x16x32_f16 v[218:221], v[186:189], v[114:117], v[218:221]
    s_waitcnt lgkmcnt(0)
    v_cvt_pk_f16_f32 v217, v164, v165
    v_mul_f32 v142, v242, v142
    v_mfma_f32_16x16x32_f16 v[218:221], v[198:201], v[226:229], v[218:221]
    v_mul_f32 v143, v242, v143
    v_cvt_pk_f16_f32 v126, v142, v143
    v_mfma_f32_16x16x32_f16 v[162:165], v[182:185], v[134:137], v[24:27]
    v_mul_f32 v144, v242, v144
    v_mul_f32 v145, v242, v145
    v_mfma_f32_16x16x32_f16 v[162:165], v[186:189], v[202:205], v[162:165]
    buffer_store_dwordx2 v[212:213], v20, s[52:55], 0 offen nt
    v_cvt_pk_f16_f32 v127, v144, v145
    v_mov_b32_dpp v241, v219 quad_perm:[0,1,2,3] row_mask:0x1 bank_mask:0xf
    v_mfma_f32_16x16x32_f16 v[162:165], v[198:201], v[158:161], v[162:165]
    v_mul_f32 v166, v242, v166
    v_mul_f32 v167, v242, v167
    v_cvt_pk_f16_f32 v128, v166, v167
    v_mfma_f32_16x16x16_f16 v[150:153], v[216:217], v[226:227], v[150:153]
    v_mul_f32 v168, v242, v168
    v_mul_f32 v169, v242, v169
    v_cvt_pk_f16_f32 v129, v168, v169
    v_mul_f32 v154, v242, v154
    v_mov_b32_dpp v241, v163 quad_perm:[0,1,2,3] row_mask:0x2 bank_mask:0xf
    v_mfma_f32_16x16x32_f16 v[142:145], v[182:185], v[126:129], v[26:29]
    v_mul_f32 v155, v242, v155
    v_cvt_pk_f16_f32 v214, v154, v155
    v_mfma_f32_16x16x32_f16 v[142:145], v[186:189], v[122:125], v[142:145]
    v_mul_f32 v156, v242, v156
    v_mul_f32 v157, v242, v157
    v_cvt_pk_f16_f32 v215, v156, v157
    v_max3_f32 v130, v218, v194, v195
    v_max3_f32 v130, v130, v196, v197
    v_mfma_f32_16x16x32_f16 v[142:145], v[198:201], v[214:217], v[142:145]
    v_max3_f32 v130, v130, v206, v207
    v_max3_f32 v130, v130, v208, v209
    v_max3_f32 v130, v130, v150, v151
    v_max3_f32 v130, v130, v152, v153
    v_mov_b32 v132, v130
    s_nop 0
    s_nop 0
    v_permlane32_swap_b32 v130, v132
    v_mov_b32_dpp v241, v143 quad_perm:[0,1,2,3] row_mask:0x4 bank_mask:0xf
    v_mov_b32 v138, v241
    v_max_f32 v130, v130, v132
    v_mov_b32 v132, v130
    v_max_f32_dpp v138, v138, v138 quad_perm:[1,0,3,2] row_mask:0xf bank_mask:0xf
    s_nop 0
    v_permlane16_swap_b32 v130, v132
    v_max_f32_dpp v138, v138, v138 quad_perm:[2,3,0,1] row_mask:0xf bank_mask:0xf
    v_max_f32 v130, v130, v132
    v_sub_f32 v194, v194, v130
    v_max_f32_dpp v138, v138, v138 row_half_mirror row_mask:0xf bank_mask:0xf
    v_exp_f32 v194, v194
    v_sub_f32 v195, v195, v130
    v_max_f32_dpp v138, v138, v138 row_mirror row_mask:0xf bank_mask:0xf
    v_mov_b32 v132, v138
    v_exp_f32 v195, v195
    v_sub_f32 v196, v196, v130
    v_permlane32_swap_b32 v138, v132
    v_max_f32 v138, v138, v132
    v_mov_b32 v132, v138
    v_cvt_pk_bf16_f32 v154, v194, v195
    v_exp_f32 v196, v196
    v_permlane16_swap_b32 v138, v132
    v_max_f32 v138, v138, v132
    v_sub_f32 v241, v241, v138
    v_exp_f32 v241, v241
    v_sub_f32 v197, v197, v130
    v_cvt_pk_bf16_f32 v241, v241, v241
    ds_write_b16 v8, v241
    v_exp_f32 v197, v197
    v_sub_f32 v206, v206, v130
    v_cvt_pk_bf16_f32 v155, v196, v197
    v_exp_f32 v206, v206
    v_sub_f32 v207, v207, v130
    v_exp_f32 v207, v207
    v_sub_f32 v208, v208, v130
    v_cvt_pk_bf16_f32 v156, v206, v207
    v_exp_f32 v208, v208
    v_sub_f32 v209, v209, v130
    v_exp_f32 v209, v209
    v_sub_f32 v150, v150, v130
    v_cvt_pk_bf16_f32 v157, v208, v209
    v_exp_f32 v150, v150
    v_sub_f32 v151, v151, v130
    v_exp_f32 v151, v151
    v_mfma_f32_16x16x32_f16 v[166:169], v[114:117], v[134:137], v[58:61]
    v_cvt_pk_bf16_f32 v36, v150, v151
    v_sub_f32 v152, v152, v130
    v_mfma_f32_16x16x32_f16 v[182:185], v[202:205], v[134:137], v[62:65]
    v_exp_f32 v152, v152
    v_mfma_f32_16x16x32_f16 v[186:189], v[122:125], v[134:137], v[66:69]
    v_sub_f32 v153, v153, v130
    v_exp_f32 v153, v153
    v_mfma_f32_16x16x16_f16 v[166:169], v[228:229], v[158:159], v[166:169]
    v_cvt_pk_bf16_f32 v37, v152, v153
    v_sub_f32 v218, v218, v130
    v_mfma_f32_16x16x16_f16 v[182:185], v[160:161], v[158:159], v[182:185]
    v_exp_f32 v218, v218
    v_mfma_f32_16x16x16_f16 v[186:189], v[216:217], v[158:159], v[186:189]
    v_cvt_pk_bf16_f32 v39, v218, 0
    s_nop 0
    s_nop 0
    v_max3_f32 v241, v162, v166, v167
    v_mfma_f32_16x16x32_bf16 v[134:137], v[28:31], v[36:39], 0
    v_max3_f32 v241, v241, v168, v169
    v_max3_f32 v241, v241, v182, v183
    v_mfma_f32_16x16x32_bf16 v[134:137], v[28:31], v[154:157], v[134:137]
    v_max3_f32 v241, v241, v184, v185
    v_max3_f32 v241, v241, v186, v187
    v_mfma_f32_16x16x32_bf16 v[150:153], v[170:173], v[36:39], 0
    v_max3_f32 v241, v241, v188, v189
    v_mov_b32 v130, v241
    v_mfma_f32_16x16x32_bf16 v[150:153], v[230:233], v[154:157], v[150:153]
    v_mfma_f32_16x16x32_bf16 v[194:197], v[174:177], v[36:39], 0
    v_permlane32_swap_b32 v241, v130
    v_mfma_f32_16x16x32_bf16 v[194:197], v[118:121], v[154:157], v[194:197]
    v_rcp_f32 v134, v134
    v_mfma_f32_16x16x32_bf16 v[198:201], v[178:181], v[36:39], 0
    v_max_f32 v241, v241, v130
    v_mov_b32 v130, v241
    v_mfma_f32_16x16x32_bf16 v[198:201], v[146:149], v[154:157], v[198:201]
    v_mul_f32 v150, v134, v150
    v_mul_f32 v151, v134, v151
    v_cvt_pk_bf16_f32 v150, v150, v151
    v_mul_f32 v152, v134, v152
    v_mul_f32 v153, v134, v153
    v_cvt_pk_bf16_f32 v151, v152, v153
    v_mul_f32 v194, v134, v194
    v_mul_f32 v195, v134, v195
    v_cvt_pk_bf16_f32 v152, v194, v195
    v_mul_f32 v196, v134, v196
    v_mul_f32 v197, v134, v197
    v_cvt_pk_bf16_f32 v153, v196, v197
    ds_write_b128 v3, v[150:153] offset:0
    v_mul_f32 v198, v134, v198
    v_mul_f32 v199, v134, v199
    v_cvt_pk_bf16_f32 v138, v198, v199
    v_mul_f32 v200, v134, v200
    v_mul_f32 v201, v134, v201
    v_cvt_pk_bf16_f32 v139, v200, v201
    v_permlane16_swap_b32 v241, v130
    ds_write_b64 v4, v[138:139] offset:4096
    v_max_f32 v241, v241, v130
    v_sub_f32 v166, v166, v241
    v_exp_f32 v166, v166
    v_mfma_f32_16x16x32_f16 v[134:137], v[114:117], v[126:129], v[70:73]
    v_sub_f32 v167, v167, v241
    v_sub_f32 v168, v168, v241
    v_mfma_f32_16x16x32_f16 v[114:117], v[202:205], v[126:129], v[74:77]
    v_exp_f32 v167, v167
    v_mfma_f32_16x16x32_f16 v[150:153], v[122:125], v[126:129], v[78:81]
    v_cvt_pk_bf16_f32 v122, v166, v167
    v_exp_f32 v168, v168
    v_mfma_f32_16x16x16_f16 v[134:137], v[228:229], v[214:215], v[134:137]
    v_sub_f32 v169, v169, v241
    v_exp_f32 v169, v169
    v_mfma_f32_16x16x16_f16 v[114:117], v[160:161], v[214:215], v[114:117]
    v_cvt_pk_bf16_f32 v123, v168, v169
    v_sub_f32 v182, v182, v241
    v_sub_f32 v183, v183, v241
    v_mfma_f32_16x16x16_f16 v[150:153], v[216:217], v[214:215], v[150:153]
    s_waitcnt lgkmcnt(0)
    s_barrier
    ds_read_b128 v[126:129], v131 offset:0
    ds_read_b128 v[154:157], v131 offset:1024
    ds_read_b128 v[158:161], v131 offset:2048
    ds_read_b128 v[166:169], v131 offset:3072
    ds_read_b128 v[194:197], v131 offset:4096
    ds_read_b128 v[198:201], v131 offset:5120
    v_exp_f32 v182, v182
    v_exp_f32 v183, v183
    v_sub_f32 v184, v184, v241
    v_cvt_pk_bf16_f32 v124, v182, v183
    v_exp_f32 v184, v184
    v_sub_f32 v185, v185, v241
    v_exp_f32 v185, v185
    v_sub_f32 v186, v186, v241
    v_cvt_pk_bf16_f32 v125, v184, v185
    v_exp_f32 v186, v186
    s_waitcnt lgkmcnt(4)
    v_mfma_f32_16x16x32_bf16 v[182:185], a[216:219], v[126:129], 0
    s_waitcnt lgkmcnt(3)
    v_sub_f32 v187, v187, v241
    v_sub_f32 v188, v188, v241
    v_mfma_f32_16x16x32_bf16 v[182:185], a[220:223], v[154:157], v[182:185]
    s_waitcnt lgkmcnt(2)
    v_exp_f32 v187, v187
    v_mfma_f32_16x16x32_bf16 v[182:185], a[224:227], v[158:161], v[182:185]
    s_waitcnt lgkmcnt(1)
    v_cvt_pk_bf16_f32 v36, v186, v187
    v_sub_f32 v189, v189, v241
    v_mfma_f32_16x16x32_bf16 v[182:185], a[228:231], v[166:169], v[182:185]
    s_waitcnt lgkmcnt(0)
    v_exp_f32 v188, v188
    v_mfma_f32_16x16x32_bf16 v[182:185], a[232:235], v[194:197], v[182:185]
    v_exp_f32 v189, v189
    v_mfma_f32_16x16x32_bf16 v[182:185], a[236:239], v[198:201], v[182:185]
    v_cvt_pk_bf16_f32 v37, v188, v189
    v_sub_f32 v162, v162, v241
    v_mfma_f32_16x16x32_bf16 v[186:189], a[240:243], v[126:129], 0
    v_exp_f32 v162, v162
    v_mfma_f32_16x16x32_bf16 v[186:189], a[244:247], v[154:157], v[186:189]
    v_cvt_pk_bf16_f32 v39, v162, 0
    v_max3_f32 v241, v142, v134, v135
    v_mfma_f32_16x16x32_bf16 v[186:189], a[248:251], v[158:161], v[186:189]
    v_max3_f32 v241, v241, v136, v137
    v_max3_f32 v241, v241, v114, v115
    v_mfma_f32_16x16x32_bf16 v[186:189], a[252:255], v[166:169], v[186:189]
    v_max3_f32 v241, v241, v116, v117
    v_max3_f32 v241, v241, v150, v151
    v_mfma_f32_16x16x32_bf16 v[186:189], v[82:85], v[194:197], v[186:189]
    v_max3_f32 v241, v241, v152, v153
    v_mov_b32 v130, v241
    v_mfma_f32_16x16x32_bf16 v[186:189], v[86:89], v[198:201], v[186:189]
    v_fma_f32 v132, v182, v182, s33
    v_fmac_f32 v132, v183, v183
    v_mfma_f32_16x16x32_bf16 v[162:165], v[90:93], v[126:129], 0
    v_permlane32_swap_b32 v241, v130
    v_mfma_f32_16x16x32_bf16 v[162:165], v[94:97], v[154:157], v[162:165]
    v_max_f32 v241, v241, v130
    v_mov_b32 v130, v241
    v_mfma_f32_16x16x32_bf16 v[162:165], v[98:101], v[158:161], v[162:165]
    v_fmac_f32 v132, v184, v184
    v_fmac_f32 v132, v185, v185
    v_mfma_f32_16x16x32_bf16 v[162:165], v[102:105], v[166:169], v[162:165]
    v_permlane16_swap_b32 v241, v130
    v_mfma_f32_16x16x32_bf16 v[162:165], v[106:109], v[194:197], v[162:165]
    v_max_f32 v241, v241, v130
    v_sub_f32 v134, v134, v241
    v_mfma_f32_16x16x32_bf16 v[162:165], v[110:113], v[198:201], v[162:165]
    v_exp_f32 v134, v134
    v_mfma_f32_16x16x32_bf16 v[126:129], v[28:31], v[36:39], 0
    v_sub_f32 v135, v135, v241
    v_sub_f32 v136, v136, v241
    v_mfma_f32_16x16x32_bf16 v[126:129], v[28:31], v[122:125], v[126:129]
    v_exp_f32 v135, v135
    v_mfma_f32_16x16x32_bf16 v[154:157], v[170:173], v[36:39], 0
    v_cvt_pk_bf16_f32 v134, v134, v135
    v_sub_f32 v137, v137, v241
    v_mfma_f32_16x16x32_bf16 v[154:157], v[230:233], v[122:125], v[154:157]
    v_exp_f32 v136, v136
    v_mfma_f32_16x16x32_bf16 v[158:161], v[174:177], v[36:39], 0
    v_exp_f32 v137, v137
    v_mfma_f32_16x16x32_bf16 v[158:161], v[118:121], v[122:125], v[158:161]
    ds_read_b128 v[166:169], v9
    ds_read_b128 v[194:197], v9 offset:64
    v_mfma_f32_16x16x32_bf16 v[198:201], v[178:181], v[36:39], 0
    v_cvt_pk_bf16_f32 v135, v136, v137
    v_sub_f32 v114, v114, v241
    v_mfma_f32_16x16x32_bf16 v[198:201], v[146:149], v[122:125], v[198:201]
    v_exp_f32 v114, v114
    v_sub_f32 v115, v115, v241
    v_exp_f32 v115, v115
    v_sub_f32 v116, v116, v241
    v_cvt_pk_bf16_f32 v136, v114, v115
    v_exp_f32 v116, v116
    v_sub_f32 v117, v117, v241
    v_exp_f32 v117, v117
    v_sub_f32 v150, v150, v241
    v_cvt_pk_bf16_f32 v137, v116, v117
    v_exp_f32 v150, v150
    v_sub_f32 v151, v151, v241
    v_exp_f32 v151, v151
    v_sub_f32 v152, v152, v241
    s_waitcnt lgkmcnt(1)
    v_mfma_f32_16x16x32_bf16 v[114:117], v[166:169], v[28:31], 0
    s_waitcnt lgkmcnt(0)
    v_cvt_pk_bf16_f32 v36, v150, v151
    v_sub_f32 v153, v153, v241
    v_mfma_f32_16x16x32_bf16 v[114:117], v[194:197], v[28:31], v[114:117]
    v_exp_f32 v152, v152
    v_mfma_f32_16x16x32_bf16 v[122:125], v[166:169], v[230:233], 0
    v_exp_f32 v153, v153
    v_mfma_f32_16x16x32_bf16 v[122:125], v[194:197], v[170:173], v[122:125]
    v_cvt_pk_bf16_f32 v37, v152, v153
    v_sub_f32 v142, v142, v241
    v_mfma_f32_16x16x32_bf16 v[150:153], v[166:169], v[118:121], 0
    v_exp_f32 v142, v142
    v_mfma_f32_16x16x32_bf16 v[150:153], v[194:197], v[174:177], v[150:153]
    v_cvt_pk_bf16_f32 v39, v142, 0
    v_fmac_f32 v132, v186, v186
    v_mfma_f32_16x16x32_bf16 v[142:145], v[166:169], v[146:149], 0
    v_rcp_f32 v126, v126
    v_mfma_f32_16x16x32_bf16 v[142:145], v[194:197], v[178:181], v[142:145]
    v_fmac_f32 v132, v187, v187
    v_fmac_f32 v132, v188, v188
    v_mfma_f32_16x16x32_bf16 v[166:169], v[28:31], v[36:39], 0
    v_fmac_f32 v132, v189, v189
    v_fmac_f32 v132, v162, v162
    v_mfma_f32_16x16x32_bf16 v[166:169], v[28:31], v[134:137], v[166:169]
    v_fmac_f32 v132, v163, v163
    v_fmac_f32 v132, v164, v164
    v_mfma_f32_16x16x32_bf16 v[194:197], v[170:173], v[36:39], 0
    v_fmac_f32 v132, v165, v165
    v_cvt_pk_bf16_f32 v138, v132, v132
    v_mfma_f32_16x16x32_bf16 v[194:197], v[230:233], v[134:137], v[194:197]
    v_cvt_pk_bf16_f32 v139, v132, v132
    v_mul_f32 v154, v126, v154
    v_mfma_f32_16x16x32_bf16 v[170:173], v[174:177], v[36:39], 0
    ds_write_b64 v239, v[138:139] offset:4096
    v_mfma_f32_16x16x32_bf16 v[170:173], v[118:121], v[134:137], v[170:173]
    v_rcp_f32 v166, v166
    v_mfma_f32_16x16x32_bf16 v[118:121], v[178:181], v[36:39], 0
    v_mul_f32 v155, v126, v155
    v_mul_f32 v194, v166, v194
    v_mfma_f32_16x16x32_bf16 v[118:121], v[146:149], v[134:137], v[118:121]
    v_mul_f32 v195, v166, v195
    v_cvt_pk_bf16_f32 v134, v194, v195
    v_mul_f32 v196, v166, v196
    v_mul_f32 v197, v166, v197
    v_cvt_pk_bf16_f32 v135, v196, v197
    v_mul_f32 v170, v166, v170
    v_mul_f32 v171, v166, v171
    v_cvt_pk_bf16_f32 v136, v170, v171
    v_mul_f32 v172, v166, v172
    v_mul_f32 v173, v166, v173
    v_cvt_pk_bf16_f32 v137, v172, v173
    ds_write_b128 v3, v[134:137] offset:12288
    v_mul_f32 v118, v166, v118
    v_mul_f32 v119, v166, v119
    v_cvt_pk_bf16_f32 v138, v118, v119
    v_mul_f32 v120, v166, v120
    v_mul_f32 v121, v166, v121
    v_cvt_pk_bf16_f32 v139, v120, v121
    v_cvt_pk_bf16_f32 v118, v154, v155
    ds_write_b64 v4, v[138:139] offset:16384
    v_mul_f32 v156, v126, v156
    v_mul_f32 v157, v126, v157
    v_cvt_pk_bf16_f32 v119, v156, v157
    v_mul_f32 v158, v126, v158
    v_mul_f32 v159, v126, v159
    v_cvt_pk_bf16_f32 v120, v158, v159
    v_mul_f32 v160, v126, v160
    v_mul_f32 v161, v126, v161
    v_cvt_pk_bf16_f32 v121, v160, v161
    ds_write_b128 v3, v[118:121] offset:6144
    v_mul_f32 v198, v126, v198
    v_mul_f32 v199, v126, v199
    v_cvt_pk_bf16_f32 v138, v198, v199
    v_mul_f32 v200, v126, v200
    v_mul_f32 v201, v126, v201
    v_cvt_pk_bf16_f32 v139, v200, v201
    v_rcp_f32 v114, v114
    ds_write_b64 v4, v[138:139] offset:10240
    v_mul_f32 v122, v122, v114
    v_mul_f32_dpp v122, v150, v114 quad_perm:[0,1,2,3] row_mask:0x2 bank_mask:0xf
    v_mul_f32_dpp v122, v142, v114 quad_perm:[0,1,2,3] row_mask:0x4 bank_mask:0xf
    v_cvt_pk_bf16_f32 v122, v122, v122
    ds_write_b16 v7, v122
    s_waitcnt lgkmcnt(0)
    s_barrier
    ds_read_b128 v[114:117], v238 offset:4096
    ds_read_b128 v[118:121], v238 offset:5120
    ds_read_b128 v[122:125], v131 offset:6144
    ds_read_b128 v[126:129], v131 offset:7168
    ds_read_b128 v[134:137], v131 offset:8192
    ds_read_b128 v[142:145], v131 offset:9216
    ds_read_b128 v[146:149], v131 offset:10240
    ds_read_b128 v[150:153], v131 offset:11264
    s_waitcnt lgkmcnt(7)
    v_mfma_f32_16x16x32_bf16 v[154:157], v[32:35], v[114:117], 0
    s_waitcnt lgkmcnt(6)
    v_mfma_f32_16x16x32_bf16 v[154:157], v[32:35], v[118:121], v[154:157]
    s_waitcnt lgkmcnt(4)
    v_mfma_f32_16x16x32_bf16 v[114:117], a[216:219], v[122:125], 0
    s_waitcnt lgkmcnt(3)
    v_mfma_f32_16x16x32_bf16 v[114:117], a[220:223], v[126:129], v[114:117]
    s_waitcnt lgkmcnt(2)
    v_mfma_f32_16x16x32_bf16 v[114:117], a[224:227], v[134:137], v[114:117]
    s_waitcnt lgkmcnt(1)
    v_mfma_f32_16x16x32_bf16 v[114:117], a[228:231], v[142:145], v[114:117]
    s_waitcnt lgkmcnt(0)
    v_mul_f32 v241, 0x3baaaaab, v154
    v_mfma_f32_16x16x32_bf16 v[114:117], a[232:235], v[146:149], v[114:117]
    v_rsq_f32 v241, v241
    v_mfma_f32_16x16x32_bf16 v[114:117], a[236:239], v[150:153], v[114:117]
    v_mul_f32 v182, v241, v182
    v_mul_f32 v183, v241, v183
    v_mfma_f32_16x16x32_bf16 v[118:121], a[240:243], v[122:125], 0
    v_cvt_pk_bf16_f32 v154, v182, v183
    v_mul_f32 v184, v241, v184
    v_mfma_f32_16x16x32_bf16 v[118:121], a[244:247], v[126:129], v[118:121]
    v_mul_f32 v185, v241, v185
    v_cvt_pk_bf16_f32 v155, v184, v185
    v_mfma_f32_16x16x32_bf16 v[118:121], a[248:251], v[134:137], v[118:121]
    v_mul_f32 v186, v241, v186
    v_mul_f32 v187, v241, v187
    v_mfma_f32_16x16x32_bf16 v[118:121], a[252:255], v[142:145], v[118:121]
    v_cvt_pk_bf16_f32 v156, v186, v187
    v_mul_f32 v188, v241, v188
    v_mfma_f32_16x16x32_bf16 v[118:121], v[82:85], v[146:149], v[118:121]
    v_mul_f32 v189, v241, v189
    v_cvt_pk_bf16_f32 v157, v188, v189
    v_mfma_f32_16x16x32_bf16 v[118:121], v[86:89], v[150:153], v[118:121]
    buffer_store_dwordx4 v[154:157], v15, s[56:59], 0 offen nt
    v_mul_f32 v162, v241, v162
    v_mul_f32 v163, v241, v163
    v_cvt_pk_bf16_f32 v138, v162, v163
    v_mul_f32 v164, v241, v164
    v_mfma_f32_16x16x32_bf16 v[154:157], v[90:93], v[122:125], 0
    ds_read_b128 v[122:125], v133 offset:256
    v_mul_f32 v165, v241, v165
    v_mfma_f32_16x16x32_bf16 v[154:157], v[94:97], v[126:129], v[154:157]
    ds_read_b128 v[126:129], v133 offset:2304
    v_cvt_pk_bf16_f32 v139, v164, v165
    v_mfma_f32_16x16x32_bf16 v[154:157], v[98:101], v[134:137], v[154:157]
    ds_read_b128 v[134:137], v133 offset:4352
    v_fma_f32 v241, v114, v114, s33
    v_mfma_f32_16x16x32_bf16 v[154:157], v[102:105], v[142:145], v[154:157]
    ds_read_b128 v[142:145], v133 offset:6400
    v_fmac_f32 v241, v115, v115
    v_mfma_f32_16x16x32_bf16 v[154:157], v[106:109], v[146:149], v[154:157]
    ds_read_b128 v[146:149], v133 offset:8448
    v_fmac_f32 v241, v116, v116
    v_mfma_f32_16x16x32_bf16 v[154:157], v[110:113], v[150:153], v[154:157]
    ds_read_b128 v[150:153], v133 offset:10496
    v_fmac_f32 v241, v117, v117
    v_fmac_f32 v241, v118, v118
    v_fmac_f32 v241, v119, v119
    v_fmac_f32 v241, v120, v120
    v_fmac_f32 v241, v121, v121
    s_nop 0
    s_nop 0
    s_waitcnt lgkmcnt(5)
    v_mfma_f32_16x16x32_bf16 v[158:161], a[216:219], v[122:125], 0
    v_fmac_f32 v241, v154, v154
    v_fmac_f32 v241, v155, v155
    v_mfma_f32_16x16x32_bf16 v[162:165], a[240:243], v[122:125], 0
    s_waitcnt lgkmcnt(4)
    v_fmac_f32 v241, v156, v156
    v_fmac_f32 v241, v157, v157
    v_mfma_f32_16x16x32_bf16 v[158:161], a[220:223], v[126:129], v[158:161]
    s_waitcnt lgkmcnt(3)
    v_cvt_pk_bf16_f32 v132, v241, v241
    v_cvt_pk_bf16_f32 v133, v241, v241
    v_mfma_f32_16x16x32_bf16 v[158:161], a[224:227], v[134:137], v[158:161]
    s_waitcnt lgkmcnt(2)
    ds_write_b64 v239, v[132:133] offset:6144
    v_mfma_f32_16x16x32_bf16 v[158:161], a[228:231], v[142:145], v[158:161]
    s_waitcnt lgkmcnt(2)
    v_mfma_f32_16x16x32_bf16 v[158:161], a[232:235], v[146:149], v[158:161]
    s_waitcnt lgkmcnt(1)
    v_mfma_f32_16x16x32_bf16 v[158:161], a[236:239], v[150:153], v[158:161]
    v_mfma_f32_16x16x32_bf16 v[162:165], a[244:247], v[126:129], v[162:165]
    buffer_store_dwordx2 v[138:139], v18, s[56:59], 0 offen nt
    v_mfma_f32_16x16x32_bf16 v[162:165], a[248:251], v[134:137], v[162:165]
    v_mfma_f32_16x16x32_bf16 v[162:165], a[252:255], v[142:145], v[162:165]
    v_mfma_f32_16x16x32_bf16 v[162:165], v[82:85], v[146:149], v[162:165]
    s_waitcnt lgkmcnt(0)
    v_mfma_f32_16x16x32_bf16 v[162:165], v[86:89], v[150:153], v[162:165]
    s_barrier
    ds_read_b128 v[166:169], v238 offset:6144
    ds_read_b128 v[170:173], v238 offset:7168
    v_mfma_f32_16x16x32_bf16 v[174:177], v[90:93], v[122:125], 0
    ds_read_b128 v[122:125], v131 offset:12288
    v_fma_f32 v241, v158, v158, s33
    v_mfma_f32_16x16x32_bf16 v[174:177], v[94:97], v[126:129], v[174:177]
    ds_read_b128 v[126:129], v131 offset:13312
    v_fmac_f32 v241, v159, v159
    v_mfma_f32_16x16x32_bf16 v[174:177], v[98:101], v[134:137], v[174:177]
    ds_read_b128 v[134:137], v131 offset:14336
    v_fmac_f32 v241, v160, v160
    v_mfma_f32_16x16x32_bf16 v[174:177], v[102:105], v[142:145], v[174:177]
    ds_read_b128 v[142:145], v131 offset:15360
    v_fmac_f32 v241, v161, v161
    v_mfma_f32_16x16x32_bf16 v[174:177], v[106:109], v[146:149], v[174:177]
    ds_read_b128 v[146:149], v131 offset:16384
    v_fmac_f32 v241, v162, v162
    v_mfma_f32_16x16x32_bf16 v[174:177], v[110:113], v[150:153], v[174:177]
    ds_read_b128 v[150:153], v131 offset:17408
    v_fmac_f32 v241, v163, v163
    v_fmac_f32 v241, v164, v164
    v_fmac_f32 v241, v165, v165
    s_waitcnt lgkmcnt(7)
    v_mfma_f32_16x16x32_bf16 v[178:181], v[32:35], v[166:169], 0
    s_waitcnt lgkmcnt(6)
    v_mfma_f32_16x16x32_bf16 v[178:181], v[32:35], v[170:173], v[178:181]
    s_waitcnt lgkmcnt(5)
    v_fmac_f32 v241, v174, v174
    v_fmac_f32 v241, v175, v175
    v_mfma_f32_16x16x32_bf16 v[166:169], a[216:219], v[122:125], 0
    s_waitcnt lgkmcnt(4)
    v_fmac_f32 v241, v176, v176
    v_fmac_f32 v241, v177, v177
    v_mfma_f32_16x16x32_bf16 v[166:169], a[220:223], v[126:129], v[166:169]
    s_waitcnt lgkmcnt(3)
    v_cvt_pk_bf16_f32 v138, v241, v241
    v_cvt_pk_bf16_f32 v139, v241, v241
    v_mfma_f32_16x16x32_bf16 v[166:169], a[224:227], v[134:137], v[166:169]
    s_waitcnt lgkmcnt(2)
    ds_write_b64 v239, v[138:139] offset:8192
    v_mfma_f32_16x16x32_bf16 v[166:169], a[228:231], v[142:145], v[166:169]
    s_waitcnt lgkmcnt(2)
    v_mul_f32 v241, 0x3baaaaab, v178
    v_mfma_f32_16x16x32_bf16 v[166:169], a[232:235], v[146:149], v[166:169]
    s_waitcnt lgkmcnt(1)
    v_rsq_f32 v241, v241
    v_mfma_f32_16x16x32_bf16 v[166:169], a[236:239], v[150:153], v[166:169]
    v_mul_f32 v114, v241, v114
    v_mul_f32 v115, v241, v115
    v_mfma_f32_16x16x32_bf16 v[170:173], a[240:243], v[122:125], 0
    v_cvt_pk_bf16_f32 v114, v114, v115
    v_mul_f32 v116, v241, v116
    v_mfma_f32_16x16x32_bf16 v[170:173], a[244:247], v[126:129], v[170:173]
    v_mul_f32 v117, v241, v117
    v_cvt_pk_bf16_f32 v115, v116, v117
    v_mfma_f32_16x16x32_bf16 v[170:173], a[248:251], v[134:137], v[170:173]
    v_fma_f32 v138, v166, v166, s33
    v_fmac_f32 v138, v167, v167
    v_mfma_f32_16x16x32_bf16 v[170:173], a[252:255], v[142:145], v[170:173]
    s_waitcnt lgkmcnt(0)
    v_fmac_f32 v138, v168, v168
    v_fmac_f32 v138, v169, v169
    v_mfma_f32_16x16x32_bf16 v[170:173], v[82:85], v[146:149], v[170:173]
    s_barrier
    ds_read_b128 v[178:181], v238 offset:8192
    ds_read_b128 v[182:185], v238 offset:9216
    v_mfma_f32_16x16x32_bf16 v[170:173], v[86:89], v[150:153], v[170:173]
    v_mul_f32 v118, v241, v118
    v_mul_f32 v119, v241, v119
    v_mfma_f32_16x16x32_bf16 v[186:189], v[90:93], v[122:125], 0
    v_cvt_pk_bf16_f32 v116, v118, v119
    v_mul_f32 v120, v241, v120
    v_mfma_f32_16x16x32_bf16 v[186:189], v[94:97], v[126:129], v[186:189]
    v_mul_f32 v121, v241, v121
    v_cvt_pk_bf16_f32 v117, v120, v121
    v_mfma_f32_16x16x32_bf16 v[186:189], v[98:101], v[134:137], v[186:189]
    ds_write_b128 v140, v[114:117] offset:1536
    v_mfma_f32_16x16x32_bf16 v[186:189], v[102:105], v[142:145], v[186:189]
    v_fmac_f32 v138, v170, v170
    v_fmac_f32 v138, v171, v171
    v_mfma_f32_16x16x32_bf16 v[186:189], v[106:109], v[146:149], v[186:189]
    v_fmac_f32 v138, v172, v172
    v_fmac_f32 v138, v173, v173
    v_mfma_f32_16x16x32_bf16 v[186:189], v[110:113], v[150:153], v[186:189]
    s_waitcnt lgkmcnt(1)
    ds_read_b128 v[114:117], v190 offset:1536
    v_mul_f32 v154, v241, v154
    v_mfma_f32_16x16x32_bf16 v[118:121], v[32:35], v[178:181], 0
    v_mul_f32 v155, v241, v155
    v_cvt_pk_bf16_f32 v154, v154, v155
    v_mfma_f32_16x16x32_bf16 v[118:121], v[32:35], v[182:185], v[118:121]
    v_mul_f32 v156, v241, v156
    v_fmac_f32 v138, v186, v186
    v_fmac_f32 v138, v187, v187
    v_fmac_f32 v138, v188, v188
    v_fmac_f32 v138, v189, v189
    v_cvt_pk_bf16_f32 v132, v138, v138
    v_cvt_pk_bf16_f32 v133, v138, v138
    ds_write_b64 v239, v[132:133] offset:0
    v_mul_f32 v155, 0x3baaaaab, v118
    v_rsq_f32 v155, v155
    v_mul_f32 v157, v241, v157
    v_mul_f32 v158, v155, v158
    v_mul_f32 v159, v155, v159
    v_cvt_pk_bf16_f32 v118, v158, v159
    v_mul_f32 v160, v155, v160
    s_waitcnt lgkmcnt(1)
    v_mul_f32 v161, v155, v161
    v_cvt_pk_bf16_f32 v119, v160, v161
    v_mul_f32 v162, v155, v162
    v_mul_f32 v163, v155, v163
    v_cvt_pk_bf16_f32 v120, v162, v163
    v_mul_f32 v164, v155, v164
    v_mul_f32 v165, v155, v165
    v_cvt_pk_bf16_f32 v121, v164, v165
    buffer_store_dwordx4 v[118:121], v240, s[12:15], 0 offen nt
    v_mul_f32 v174, v155, v174
    v_mul_f32 v175, v155, v175
    v_cvt_pk_bf16_f32 v138, v174, v175
    v_mul_f32 v176, v155, v176
    v_mul_f32 v177, v155, v177
    s_waitcnt lgkmcnt(0)
    s_barrier
    ds_read_b128 v[118:121], v238 offset:0
    ds_read_b128 v[122:125], v238 offset:1024
    ds_read_b128 v[126:129], v131 offset:18432
    v_cvt_pk_bf16_f32 v139, v176, v177
    v_cvt_pk_bf16_f32 v155, v156, v157
    ds_write_b64 v141, v[154:155] offset:2560
    buffer_store_dwordx2 v[138:139], v255, s[12:15], 0 offen nt
    ds_read_b64 v[212:213], v254 offset:2560
    s_waitcnt lgkmcnt(4)
    v_mfma_f32_16x16x32_bf16 v[130:133], v[32:35], v[118:121], 0
    s_waitcnt lgkmcnt(3)
    v_mfma_f32_16x16x32_bf16 v[130:133], v[32:35], v[122:125], v[130:133]
    s_waitcnt lgkmcnt(2)
    v_or3_b32 v126, v126, v127, v128
    v_or_b32 v126, v126, v129
    v_cmp_gt_i32 s[46:47], 0, v126
    s_nop 0
    s_nop 0
    s_nop 0
    s_nop 0
    v_mul_f32 v255, 0x3baaaaab, v130
    v_rsq_f32 v255, v255
    s_nop 0
    v_mul_f32 v166, v255, v166
    buffer_store_dwordx4 v[114:117], v191, s[56:59], 0 offen nt
    s_waitcnt lgkmcnt(0)
    v_mul_f32 v167, v255, v167
    v_cvt_pk_bf16_f32 v114, v166, v167
    v_mul_f32 v168, v255, v168
    v_mul_f32 v169, v255, v169
    v_cvt_pk_bf16_f32 v115, v168, v169
    v_mul_f32 v170, v255, v170
    v_mul_f32 v171, v255, v171
    v_cvt_pk_bf16_f32 v116, v170, v171
    v_mul_f32 v172, v255, v172
    v_mul_f32 v173, v255, v173
    v_cvt_pk_bf16_f32 v117, v172, v173
    ds_write_b128 v140, v[114:117] offset:3072
    buffer_store_dwordx2 v[212:213], v192, s[56:59], 0 offen nt
    v_mul_f32 v186, v255, v186
    v_mul_f32 v187, v255, v187
    v_cvt_pk_bf16_f32 v186, v186, v187
    v_mul_f32 v188, v255, v188
    v_mul_f32 v189, v255, v189
    v_cvt_pk_bf16_f32 v187, v188, v189
    ds_read_b128 v[114:117], v190 offset:3072
    ds_write_b64 v141, v[186:187] offset:4096
    ds_read_b64 v[212:213], v254 offset:4096
    s_waitcnt lgkmcnt(2)
    buffer_store_dwordx4 v[114:117], v193, s[56:59], 0 offen nt
    s_waitcnt lgkmcnt(0)
    buffer_store_dwordx2 v[212:213], v210, s[56:59], 0 offen nt
    s_branch L_end
L_drain:
    ds_read_b128 v[114:117], v2 offset:18432
    ds_read_b128 v[118:121], v2 offset:19456
    ds_read_b128 v[122:125], v2 offset:0
    s_mul_i32 s5, s16, 8064
    s_mov_b32 s12, s42
    ds_read_b128 v[126:129], v2 offset:1024
    s_mov_b32 s13, s43
    s_cmp_ge_u32 s18, 2
    s_cselect_b32 s14, s36, 0
    ds_read_b128 v[130:133], v2 offset:2048
    s_add_u32 s5, s5, 104448
    s_lshl_b32 s3, s16, 6
    s_lshl_b32 s4, s16, 5
    ds_read_b128 v[134:137], v2 offset:3072
    s_add_u32 s4, s4, 256
    ds_read_b128 v[154:157], v2 offset:4096
    ds_read_b128 v[162:165], v2 offset:5120
    v_bfe_u32 v254, v2, 4, 6
    v_lshrrev_b32 v255, 4, v254
    v_and_b32 v166, 15, v254
    v_lshlrev_b32 v167, 9, v255
    v_lshl_add_u32 v167, v166, 4, v167
    v_add_u32 v167, 136704, v167
    v_xor_b32 v168, 65536, v2
    v_bfe_u32 v169, v166, 1, 2
    s_waitcnt lgkmcnt(7)
    v_mfma_f32_16x16x32_bf16 v[170:173], v[32:35], v[114:117], 0
    s_waitcnt lgkmcnt(5)
    v_xor_b32 v169, v169, v255
    v_lshl_add_u32 v169, v166, 2, v169
    v_mfma_f32_16x16x32_bf16 v[170:173], v[32:35], v[118:121], v[170:173]
    s_waitcnt lgkmcnt(4)
    v_lshl_add_u32 v114, v169, 4, s5
    v_lshl_add_u32 v115, v169, 3, s5
    v_lshl_add_u32 v116, v254, 4, s5
    v_mfma_f32_16x16x32_bf16 v[118:121], a[216:219], v[122:125], 0
    s_waitcnt lgkmcnt(3)
    v_lshl_add_u32 v117, v254, 3, s5
    v_lshlrev_b32 v169, 2, v169
    v_mul_f32 v170, 0x3baaaaab, v170
    v_mfma_f32_16x16x32_bf16 v[118:121], a[220:223], v[126:129], v[118:121]
    s_waitcnt lgkmcnt(2)
    ds_permute_b32 v173, v169, v15
    ds_permute_b32 v174, v169, v18
    v_rsq_f32 v170, v170
    v_mfma_f32_16x16x32_bf16 v[118:121], a[224:227], v[130:133], v[118:121]
    s_waitcnt lgkmcnt(2)
    ds_permute_b32 v175, v169, v16
    ds_permute_b32 v176, v169, v19
    v_mul_f32 v150, v170, v150
    v_mfma_f32_16x16x32_bf16 v[118:121], a[228:231], v[134:137], v[118:121]
    ds_permute_b32 v177, v169, v17
    ds_permute_b32 v182, v169, v20
    v_mul_f32 v151, v170, v151
    v_mfma_f32_16x16x32_bf16 v[118:121], a[232:235], v[154:157], v[118:121]
    v_cvt_pk_bf16_f32 v150, v150, v151
    v_mul_f32 v152, v170, v152
    v_mul_f32 v153, v170, v153
    v_mfma_f32_16x16x32_bf16 v[118:121], a[236:239], v[162:165], v[118:121]
    v_cvt_pk_bf16_f32 v151, v152, v153
    v_mul_f32 v190, v170, v190
    v_mul_f32 v191, v170, v191
    v_mfma_f32_16x16x32_bf16 v[194:197], a[240:243], v[122:125], 0
    v_cvt_pk_bf16_f32 v152, v190, v191
    v_mul_f32 v192, v170, v192
    v_mul_f32 v193, v170, v193
    v_mfma_f32_16x16x32_bf16 v[194:197], a[244:247], v[126:129], v[194:197]
    s_waitcnt lgkmcnt(5)
    v_cvt_pk_bf16_f32 v153, v192, v193
    v_mul_f32 v202, v170, v202
    v_mul_f32 v203, v170, v203
    v_mfma_f32_16x16x32_bf16 v[194:197], a[248:251], v[130:133], v[194:197]
    s_waitcnt lgkmcnt(4)
    ds_read_b128 v[190:193], v2 offset:6144
    v_cvt_pk_bf16_f32 v184, v202, v203
    v_mul_f32 v204, v170, v204
    v_mfma_f32_16x16x32_bf16 v[194:197], a[252:255], v[134:137], v[194:197]
    s_waitcnt lgkmcnt(3)
    ds_read_b128 v[198:201], v2 offset:7168
    v_mul_f32 v205, v170, v205
    v_cvt_pk_bf16_f32 v185, v204, v205
    v_mfma_f32_16x16x32_bf16 v[194:197], v[82:85], v[154:157], v[194:197]
    s_waitcnt lgkmcnt(2)
    ds_read_b128 v[202:205], v2 offset:8192
    v_fma_f32 v169, v118, v118, s33
    v_fmac_f32 v169, v119, v119
    v_mfma_f32_16x16x32_bf16 v[194:197], v[86:89], v[162:165], v[194:197]
    ds_read_b128 v[206:209], v2 offset:9216
    v_fmac_f32 v169, v120, v120
    v_fmac_f32 v169, v121, v121
    v_mfma_f32_16x16x32_bf16 v[210:213], v[90:93], v[122:125], 0
    ds_read_b128 v[122:125], v2 offset:10240
    v_mul_f32 v183, 0x3baaaaab, v171
    v_rsq_f32 v183, v183
    v_mfma_f32_16x16x32_bf16 v[210:213], v[94:97], v[126:129], v[210:213]
    ds_read_b128 v[126:129], v2 offset:11264
    v_fmac_f32 v169, v194, v194
    v_fmac_f32 v169, v195, v195
    v_mfma_f32_16x16x32_bf16 v[210:213], v[98:101], v[130:133], v[210:213]
    s_waitcnt lgkmcnt(5)
    buffer_store_dwordx4 v[150:153], v15, s[12:15], s27 offen nt
    v_fmac_f32 v169, v196, v196
    v_fmac_f32 v169, v197, v197
    v_mul_f32 v142, v183, v142
    v_mfma_f32_16x16x32_bf16 v[210:213], v[102:105], v[134:137], v[210:213]
    s_waitcnt lgkmcnt(4)
    v_mul_f32 v143, v183, v143
    v_cvt_pk_bf16_f32 v130, v142, v143
    v_mul_f32 v144, v183, v144
    v_mfma_f32_16x16x32_bf16 v[210:213], v[106:109], v[154:157], v[210:213]
    s_waitcnt lgkmcnt(3)
    v_mul_f32 v145, v183, v145
    v_cvt_pk_bf16_f32 v131, v144, v145
    v_mul_f32 v158, v183, v158
    v_mfma_f32_16x16x32_bf16 v[210:213], v[110:113], v[162:165], v[210:213]
    s_waitcnt lgkmcnt(2)
    v_mul_f32 v159, v183, v159
    v_cvt_pk_bf16_f32 v132, v158, v159
    v_mul_f32 v160, v183, v160
    v_mfma_f32_16x16x32_bf16 v[134:137], a[216:219], v[190:193], 0
    s_waitcnt lgkmcnt(1)
    v_mul_f32 v161, v183, v161
    v_cvt_pk_bf16_f32 v133, v160, v161
    v_fmac_f32 v169, v210, v210
    v_mfma_f32_16x16x32_bf16 v[134:137], a[220:223], v[198:201], v[134:137]
    s_waitcnt lgkmcnt(0)
    v_fmac_f32 v169, v211, v211
    v_fmac_f32 v169, v212, v212
    v_fmac_f32 v169, v213, v213
    v_mfma_f32_16x16x32_bf16 v[134:137], a[224:227], v[202:205], v[134:137]
    v_mul_f32 v178, v183, v178
    v_mul_f32 v179, v183, v179
    v_cvt_pk_bf16_f32 v170, v178, v179
    v_mfma_f32_16x16x32_bf16 v[134:137], a[228:231], v[206:209], v[134:137]
    v_mul_f32 v180, v183, v180
    v_mul_f32 v181, v183, v181
    v_cvt_pk_bf16_f32 v171, v180, v181
    v_mfma_f32_16x16x32_bf16 v[134:137], a[232:235], v[122:125], v[134:137]
    v_subrev_u32 v183, 0x3d800000, v44
    v_sub_u32 v142, 0x4a000000, v45
    v_or3_b32 v183, v183, v142, v45
    v_mfma_f32_16x16x32_bf16 v[134:137], a[236:239], v[126:129], v[134:137]
    v_lshl_add_u32 v142, s16, 2, v168
    v_mul_f32 v172, 0x3baaaaab, v172
    v_rsq_f32 v172, v172
    v_mfma_f32_16x16x32_bf16 v[150:153], a[240:243], v[190:193], 0
    ds_write_b32 v142, v183 offset:18432
    v_mul_f32 v146, v172, v146
    v_mfma_f32_16x16x32_bf16 v[150:153], a[244:247], v[198:201], v[150:153]
    v_mul_f32 v147, v172, v147
    v_fma_f32 v183, v134, v134, s33
    v_fmac_f32 v183, v135, v135
    v_mfma_f32_16x16x32_bf16 v[150:153], a[248:251], v[202:205], v[150:153]
    ds_read_b128 v[142:145], v2 offset:12288
    v_fmac_f32 v183, v136, v136
    v_fmac_f32 v183, v137, v137
    v_mfma_f32_16x16x32_bf16 v[150:153], a[252:255], v[206:209], v[150:153]
    ds_read_b128 v[154:157], v2 offset:13312
    v_cvt_pk_bf16_f32 v146, v146, v147
    v_mul_f32 v148, v172, v148
    v_mfma_f32_16x16x32_bf16 v[150:153], v[82:85], v[122:125], v[150:153]
    ds_read_b128 v[158:161], v2 offset:14336
    v_mul_f32 v149, v172, v149
    v_cvt_pk_bf16_f32 v147, v148, v149
    v_mfma_f32_16x16x32_bf16 v[150:153], v[86:89], v[126:129], v[150:153]
    ds_read_b128 v[162:165], v2 offset:15360
    v_mul_f32 v138, v172, v138
    v_mul_f32 v139, v172, v139
    v_mfma_f32_16x16x32_bf16 v[178:181], v[90:93], v[190:193], 0
    ds_read_b128 v[190:193], v2 offset:16384
    v_cvt_pk_bf16_f32 v148, v138, v139
    v_mul_f32 v140, v172, v140
    v_mfma_f32_16x16x32_bf16 v[178:181], v[94:97], v[198:201], v[178:181]
    ds_read_b128 v[198:201], v2 offset:17408
    v_fmac_f32 v183, v150, v150
    v_fmac_f32 v183, v151, v151
    v_mfma_f32_16x16x32_bf16 v[178:181], v[98:101], v[202:205], v[178:181]
    buffer_store_dwordx2 v[184:185], v18, s[12:15], s27 offen nt
    v_fmac_f32 v183, v152, v152
    v_mfma_f32_16x16x32_bf16 v[178:181], v[102:105], v[206:209], v[178:181]
    s_waitcnt lgkmcnt(5)
    v_fmac_f32 v183, v153, v153
    v_mul_f32 v141, v172, v141
    v_cvt_pk_bf16_f32 v149, v140, v141
    v_mfma_f32_16x16x32_bf16 v[178:181], v[106:109], v[122:125], v[178:181]
    s_waitcnt lgkmcnt(4)
    ds_write_b128 v114, v[146:149] offset:3072
    v_mfma_f32_16x16x32_bf16 v[178:181], v[110:113], v[126:129], v[178:181]
    s_waitcnt lgkmcnt(3)
    v_mul_f32 v186, v172, v186
    v_mul_f32 v187, v172, v187
    v_cvt_pk_bf16_f32 v184, v186, v187
    v_mfma_f32_16x16x32_bf16 v[122:125], a[216:219], v[142:145], 0
    s_waitcnt lgkmcnt(2)
    v_mul_f32 v188, v172, v188
    v_mul_f32 v189, v172, v189
    v_fmac_f32 v183, v178, v178
    v_mfma_f32_16x16x32_bf16 v[122:125], a[220:223], v[154:157], v[122:125]
    s_waitcnt lgkmcnt(1)
    ds_read_b128 v[126:129], v116 offset:3072
    v_fmac_f32 v183, v179, v179
    v_fmac_f32 v183, v180, v180
    v_mfma_f32_16x16x32_bf16 v[122:125], a[224:227], v[158:161], v[122:125]
    v_fmac_f32 v183, v181, v181
    v_cvt_pk_bf16_f32 v186, v169, v183
    v_cvt_pk_bf16_f32 v187, v183, v183
    v_mfma_f32_16x16x32_bf16 v[122:125], a[228:231], v[162:165], v[122:125]
    ds_write_b64 v4, v[186:187] offset:0
    v_mfma_f32_16x16x32_bf16 v[122:125], a[232:235], v[190:193], v[122:125]
    v_cvt_pk_bf16_f32 v185, v188, v189
    v_mov_b32 v172, 0x40000000
    v_lshrrev_b32 v169, 2, v254
    v_mfma_f32_16x16x32_bf16 v[122:125], a[236:239], v[198:201], v[122:125]
    ds_write_b64 v115, v[184:185] offset:4096
    v_mfma_f32_16x16x32_bf16 v[138:141], a[240:243], v[142:145], 0
    v_lshrrev_b32 v183, 3, v254
    v_xor_b32 v183, v183, v254
    v_and_b32 v183, 3, v183
    v_mfma_f32_16x16x32_bf16 v[138:141], a[244:247], v[154:157], v[138:141]
    ds_read_b64 v[184:185], v117 offset:4096
    v_add_u32 v169, 0, v169
    v_fma_f32 v254, v122, v122, s33
    v_mfma_f32_16x16x32_bf16 v[138:141], a[248:251], v[158:161], v[138:141]
    s_waitcnt lgkmcnt(3)
    ds_read_b128 v[146:149], v167 offset:0
    v_fmac_f32 v254, v123, v123
    v_fmac_f32 v254, v124, v124
    v_mfma_f32_16x16x32_bf16 v[138:141], a[252:255], v[162:165], v[138:141]
    ds_read_b128 v[186:189], v167 offset:2048
    v_fmac_f32 v254, v125, v125
    v_mul_u32_u24 v202, s20, v169
    v_mfma_f32_16x16x32_bf16 v[138:141], v[82:85], v[190:193], v[138:141]
    s_waitcnt lgkmcnt(4)
    ds_read_b128 v[206:209], v167 offset:4096
    v_add_u32 v202, s38, v202
    v_mul_u32_u24 v202, 911, v202
    v_mfma_f32_16x16x32_bf16 v[138:141], v[86:89], v[198:201], v[138:141]
    s_barrier
    ds_read_b128 v[214:217], v168 offset:0
    ds_read_b128 v[218:221], v168 offset:1024
    v_lshrrev_b32 v202, 16, v202
    v_mfma_f32_16x16x32_bf16 v[222:225], v[90:93], v[142:145], 0
    ds_read_b128 v[142:145], v167 offset:6144
    ds_read_b128 v[226:229], v167 offset:8192
    v_mul_u32_u24 v202, s22, v202
    v_mfma_f32_16x16x32_bf16 v[222:225], v[94:97], v[154:157], v[222:225]
    ds_read_b128 v[154:157], v167 offset:10240
    v_fmac_f32 v254, v138, v138
    v_fmac_f32 v254, v139, v139
    v_mfma_f32_16x16x32_bf16 v[222:225], v[98:101], v[158:161], v[222:225]
    s_waitcnt lgkmcnt(8)
    buffer_store_dwordx4 v[130:133], v16, s[12:15], s27 offen nt
    ds_read_b128 v[158:161], v168 offset:18432
    v_fmac_f32 v254, v140, v140
    v_fmac_f32 v254, v141, v141
    v_mfma_f32_16x16x32_bf16 v[222:225], v[102:105], v[162:165], v[222:225]
    s_waitcnt lgkmcnt(7)
    v_mad_u32_u24 v202, v169, s21, v202
    v_cmp_gt_u32 vcc, s17, v169
    v_add_u32 v169, s7, v202
    v_mfma_f32_16x16x32_bf16 v[222:225], v[106:109], v[190:193], v[222:225]
    s_waitcnt lgkmcnt(6)
    v_cndmask_b32 v169, v172, v169, vcc
    v_lshl_add_u32 v130, v183, 4, v169
    v_add_u32 v130, s3, v130
    v_mfma_f32_16x16x32_bf16 v[222:225], v[110:113], v[198:201], v[222:225]
    s_waitcnt lgkmcnt(4)
    v_lshl_add_u32 v183, v183, 3, v169
    v_add_u32 v183, s4, v183
    v_mfma_f32_16x16x32_bf16 v[162:165], v[32:35], v[214:217], 0
    s_waitcnt lgkmcnt(3)
    v_add_u32 v166, 16, v166
    v_mul_u32_u24 v169, s20, v166
    v_mfma_f32_16x16x32_bf16 v[162:165], v[32:35], v[218:221], v[162:165]
    s_waitcnt lgkmcnt(2)
    v_fmac_f32 v254, v222, v222
    v_fmac_f32 v254, v223, v223
    v_fmac_f32 v254, v224, v224
    v_mfma_f32_16x16x32_bf16 v[190:193], a[216:219], v[146:149], 0
    s_waitcnt lgkmcnt(1)
    v_fmac_f32 v254, v225, v225
    v_cvt_pk_bf16_f32 v132, v254, v254
    v_cvt_pk_bf16_f32 v133, v254, v254
    v_mfma_f32_16x16x32_bf16 v[190:193], a[220:223], v[186:189], v[190:193]
    s_waitcnt lgkmcnt(0)
    ds_write_b64 v4, v[132:133] offset:2048
    v_mfma_f32_16x16x32_bf16 v[190:193], a[224:227], v[206:209], v[190:193]
    v_add_u32 v169, s38, v169
    v_mul_u32_u24 v254, 911, v169
    v_lshrrev_b32 v254, 16, v254
    v_mfma_f32_16x16x32_bf16 v[190:193], a[228:231], v[142:145], v[190:193]
    v_mul_u32_u24 v254, s22, v254
    v_mad_u32_u24 v254, v166, s21, v254
    v_cmp_gt_u32 vcc, s17, v166
    v_mfma_f32_16x16x32_bf16 v[190:193], a[232:235], v[226:229], v[190:193]
    v_add_u32 v254, s7, v254
    v_cndmask_b32 v254, v172, v254, vcc
    v_lshl_add_u32 v131, v255, 4, v254
    v_mfma_f32_16x16x32_bf16 v[190:193], a[236:239], v[154:157], v[190:193]
    v_add_u32 v131, s3, v131
    v_lshl_add_u32 v254, v255, 3, v254
    v_add_u32 v254, s4, v254
    v_mfma_f32_16x16x32_bf16 v[198:201], a[240:243], v[146:149], 0
    v_mul_f32 v255, 0x3baaaaab, v162
    v_mul_f32 v132, 0x3baaaaab, v163
    v_rsq_f32 v255, v255
    v_mfma_f32_16x16x32_bf16 v[198:201], a[244:247], v[186:189], v[198:201]
    buffer_store_dwordx2 v[170:171], v19, s[12:15], s27 offen nt
    v_fma_f32 v133, v190, v190, s33
    v_mfma_f32_16x16x32_bf16 v[198:201], a[248:251], v[206:209], v[198:201]
    ds_read_b128 v[162:165], v167 offset:256
    v_fmac_f32 v133, v191, v191
    v_fmac_f32 v133, v192, v192
    v_mfma_f32_16x16x32_bf16 v[198:201], a[252:255], v[142:145], v[198:201]
    ds_read_b128 v[202:205], v167 offset:2304
    v_fmac_f32 v133, v193, v193
    v_mul_f32 v118, v255, v118
    v_mfma_f32_16x16x32_bf16 v[198:201], v[82:85], v[226:229], v[198:201]
    ds_read_b128 v[214:217], v167 offset:4352
    v_mul_f32 v119, v255, v119
    v_cvt_pk_bf16_f32 v118, v118, v119
    v_mfma_f32_16x16x32_bf16 v[198:201], v[86:89], v[154:157], v[198:201]
    ds_read_b128 v[218:221], v167 offset:6400
    v_mul_f32 v120, v255, v120
    v_mul_f32 v121, v255, v121
    v_mfma_f32_16x16x32_bf16 v[230:233], v[90:93], v[146:149], 0
    ds_read_b128 v[146:149], v167 offset:8448
    v_cvt_pk_bf16_f32 v119, v120, v121
    v_mul_f32 v194, v255, v194
    v_mfma_f32_16x16x32_bf16 v[230:233], v[94:97], v[186:189], v[230:233]
    ds_read_b128 v[186:189], v167 offset:10496
    v_fmac_f32 v133, v198, v198
    v_fmac_f32 v133, v199, v199
    v_mfma_f32_16x16x32_bf16 v[230:233], v[98:101], v[206:209], v[230:233]
    v_fmac_f32 v133, v200, v200
    v_fmac_f32 v133, v201, v201
    v_mul_f32 v195, v255, v195
    v_mfma_f32_16x16x32_bf16 v[230:233], v[102:105], v[142:145], v[230:233]
    s_waitcnt lgkmcnt(5)
    v_cvt_pk_bf16_f32 v120, v194, v195
    v_mul_f32 v196, v255, v196
    v_mul_f32 v197, v255, v197
    v_mfma_f32_16x16x32_bf16 v[230:233], v[106:109], v[226:229], v[230:233]
    s_waitcnt lgkmcnt(4)
    v_cvt_pk_bf16_f32 v121, v196, v197
    v_mul_f32 v210, v255, v210
    v_mul_f32 v211, v255, v211
    v_mfma_f32_16x16x32_bf16 v[230:233], v[110:113], v[154:157], v[230:233]
    s_waitcnt lgkmcnt(3)
    ds_write_b128 v114, v[118:121] offset:4608
    v_mfma_f32_16x16x32_bf16 v[118:121], a[216:219], v[162:165], 0
    s_waitcnt lgkmcnt(2)
    v_cvt_pk_bf16_f32 v210, v210, v211
    v_mul_f32 v212, v255, v212
    v_mul_f32 v213, v255, v213
    v_mfma_f32_16x16x32_bf16 v[118:121], a[220:223], v[202:205], v[118:121]
    s_waitcnt lgkmcnt(1)
    v_fmac_f32 v133, v230, v230
    v_fmac_f32 v133, v231, v231
    v_fmac_f32 v133, v232, v232
    v_mfma_f32_16x16x32_bf16 v[118:121], a[224:227], v[214:217], v[118:121]
    buffer_store_dwordx4 v[126:129], v177, s[12:15], s27 offen nt
    ds_read_b128 v[142:145], v116 offset:4608
    v_fmac_f32 v133, v233, v233
    v_cvt_pk_bf16_f32 v166, v133, v133
    v_mfma_f32_16x16x32_bf16 v[118:121], a[228:231], v[218:221], v[118:121]
    v_cvt_pk_bf16_f32 v167, v133, v133
    v_cvt_pk_bf16_f32 v211, v212, v213
    v_rsq_f32 v132, v132
    v_mfma_f32_16x16x32_bf16 v[118:121], a[232:235], v[146:149], v[118:121]
    ds_write_b64 v4, v[166:167] offset:4096
    v_mfma_f32_16x16x32_bf16 v[118:121], a[236:239], v[186:189], v[118:121]
    v_mul_f32 v134, v132, v134
    v_mul_f32 v135, v132, v135
    v_cvt_pk_bf16_f32 v126, v134, v135
    v_mfma_f32_16x16x32_bf16 v[154:157], a[240:243], v[162:165], 0
    buffer_store_dwordx2 v[184:185], v182, s[12:15], s27 offen nt
    v_mul_f32 v136, v132, v136
    v_mfma_f32_16x16x32_bf16 v[154:157], a[244:247], v[202:205], v[154:157]
    s_mov_b32 s14, s36
    ds_write_b64 v115, v[210:211] offset:5632
    v_mfma_f32_16x16x32_bf16 v[154:157], a[248:251], v[214:217], v[154:157]
    s_waitcnt lgkmcnt(2)
    v_fma_f32 v255, v118, v118, s33
    v_fmac_f32 v255, v119, v119
    v_fmac_f32 v255, v120, v120
    v_mfma_f32_16x16x32_bf16 v[154:157], a[252:255], v[218:221], v[154:157]
    ds_read_b64 v[184:185], v117 offset:5632
    v_fmac_f32 v255, v121, v121
    v_mul_f32 v137, v132, v137
    v_mfma_f32_16x16x32_bf16 v[154:157], v[82:85], v[146:149], v[154:157]
    buffer_store_dwordx4 v[142:145], v173, s[12:15], s26 offen nt
    v_cvt_pk_bf16_f32 v127, v136, v137
    v_mul_f32 v150, v132, v150
    v_mul_f32 v151, v132, v151
    v_mfma_f32_16x16x32_bf16 v[154:157], v[86:89], v[186:189], v[154:157]
    s_waitcnt lgkmcnt(2)
    v_cvt_pk_bf16_f32 v128, v150, v151
    v_mul_f32 v152, v132, v152
    v_mul_f32 v153, v132, v153
    v_mfma_f32_16x16x32_bf16 v[134:137], v[90:93], v[162:165], 0
    s_barrier
    ds_read_b128 v[142:145], v168 offset:2048
    ds_read_b128 v[162:165], v168 offset:3072
    v_fmac_f32 v255, v154, v154
    v_mfma_f32_16x16x32_bf16 v[134:137], v[94:97], v[202:205], v[134:137]
    ds_read_b128 v[170:173], v168 offset:4096
    ds_read_b128 v[194:197], v168 offset:5120
    v_fmac_f32 v255, v155, v155
    v_mfma_f32_16x16x32_bf16 v[134:137], v[98:101], v[214:217], v[134:137]
    v_fmac_f32 v255, v156, v156
    v_fmac_f32 v255, v157, v157
    v_cvt_pk_bf16_f32 v129, v152, v153
    v_mfma_f32_16x16x32_bf16 v[134:137], v[102:105], v[218:221], v[134:137]
    s_waitcnt lgkmcnt(4)
    buffer_store_dwordx2 v[184:185], v174, s[12:15], s26 offen nt
    v_mul_f32 v178, v132, v178
    v_mfma_f32_16x16x32_bf16 v[134:137], v[106:109], v[146:149], v[134:137]
    ds_write_b128 v114, v[126:129] offset:6144
    v_mfma_f32_16x16x32_bf16 v[134:137], v[110:113], v[186:189], v[134:137]
    v_mul_f32 v179, v132, v179
    v_cvt_pk_bf16_f32 v184, v178, v179
    v_mul_f32 v180, v132, v180
    s_waitcnt lgkmcnt(4)
    v_mfma_f32_16x16x32_bf16 v[126:129], v[32:35], v[142:145], 0
    s_waitcnt lgkmcnt(3)
    v_mul_f32 v181, v132, v181
    v_cvt_pk_bf16_f32 v185, v180, v181
    v_mfma_f32_16x16x32_bf16 v[126:129], v[32:35], v[162:165], v[126:129]
    s_waitcnt lgkmcnt(1)
    ds_read_b128 v[142:145], v116 offset:6144
    v_fmac_f32 v255, v134, v134
    v_mfma_f32_16x16x32_bf16 v[146:149], v[32:35], v[170:173], 0
    ds_write_b64 v115, v[184:185] offset:7168
    v_mfma_f32_16x16x32_bf16 v[146:149], v[32:35], v[194:197], v[146:149]
    v_fmac_f32 v255, v135, v135
    v_fmac_f32 v255, v136, v136
    v_fmac_f32 v255, v137, v137
    v_cvt_pk_bf16_f32 v132, v255, v255
    v_cvt_pk_bf16_f32 v133, v255, v255
    ds_write_b64 v4, v[132:133] offset:6144
    v_mul_f32 v255, 0x3baaaaab, v126
    v_rsq_f32 v255, v255
    ds_read_b64 v[132:133], v117 offset:7168
    v_mul_f32 v122, v255, v122
    v_mul_f32 v123, v255, v123
    v_cvt_pk_bf16_f32 v122, v122, v123
    v_mul_f32 v124, v255, v124
    v_mul_f32 v125, v255, v125
    s_waitcnt lgkmcnt(3)
    buffer_store_dwordx4 v[142:145], v175, s[12:15], s26 offen nt
    v_cvt_pk_bf16_f32 v123, v124, v125
    v_mul_f32 v138, v255, v138
    v_mul_f32 v139, v255, v139
    v_cvt_pk_bf16_f32 v124, v138, v139
    v_mul_f32 v140, v255, v140
    v_mul_f32 v141, v255, v141
    v_cvt_pk_bf16_f32 v125, v140, v141
    ds_write_b128 v114, v[122:125] offset:0
    s_waitcnt lgkmcnt(2)
    s_barrier
    v_mul_f32 v222, v255, v222
    v_mul_f32 v223, v255, v223
    v_cvt_pk_bf16_f32 v184, v222, v223
    v_mul_f32 v224, v255, v224
    s_waitcnt lgkmcnt(1)
    ds_read_b128 v[122:125], v168 offset:6144
    ds_read_b128 v[126:129], v168 offset:7168
    buffer_store_dwordx2 v[132:133], v176, s[12:15], s26 offen nt
    ds_read_b128 v[138:141], v116 offset:0
    v_mul_f32 v225, v255, v225
    v_cvt_pk_bf16_f32 v185, v224, v225
    ds_write_b64 v115, v[184:185] offset:1024
    v_mul_f32 v255, 0x3baaaaab, v146
    v_rsq_f32 v255, v255
    ds_read_b64 v[132:133], v117 offset:1024
    v_mul_f32 v190, v255, v190
    v_mul_f32 v191, v255, v191
    v_cvt_pk_bf16_f32 v142, v190, v191
    v_mul_f32 v192, v255, v192
    v_mul_f32 v193, v255, v193
    v_cvt_pk_bf16_f32 v143, v192, v193
    v_mul_f32 v198, v255, v198
    v_mul_f32 v199, v255, v199
    v_cvt_pk_bf16_f32 v144, v198, v199
    v_mul_f32 v200, v255, v200
    v_mul_f32 v201, v255, v201
    v_cvt_pk_bf16_f32 v145, v200, v201
    s_waitcnt lgkmcnt(4)
    v_mfma_f32_16x16x32_bf16 v[146:149], v[32:35], v[122:125], 0
    s_waitcnt lgkmcnt(3)
    ds_write_b128 v114, v[142:145] offset:1536
    v_mfma_f32_16x16x32_bf16 v[146:149], v[32:35], v[126:129], v[146:149]
    s_waitcnt lgkmcnt(2)
    buffer_store_dwordx4 v[138:141], v177, s[12:15], s26 offen nt
    v_mul_f32 v230, v255, v230
    v_mul_f32 v231, v255, v231
    v_cvt_pk_bf16_f32 v184, v230, v231
    ds_read_b128 v[122:125], v116 offset:1536
    s_waitcnt lgkmcnt(2)
    v_mul_f32 v232, v255, v232
    v_mul_f32 v233, v255, v233
    v_cvt_pk_bf16_f32 v185, v232, v233
    ds_write_b64 v115, v[184:185] offset:2560
    v_mul_f32 v255, 0x3baaaaab, v146
    buffer_store_dwordx2 v[132:133], v182, s[12:15], s26 offen nt
    ds_read_b64 v[184:185], v117 offset:2560
    v_rsq_f32 v255, v255
    v_or3_b32 v158, v158, v159, v160
    v_mul_f32 v118, v255, v118
    v_mul_f32 v119, v255, v119
    v_cvt_pk_bf16_f32 v114, v118, v119
    v_mul_f32 v120, v255, v120
    v_mul_f32 v121, v255, v121
    v_cvt_pk_bf16_f32 v115, v120, v121
    v_mul_f32 v154, v255, v154
    v_mul_f32 v155, v255, v155
    v_cvt_pk_bf16_f32 v116, v154, v155
    v_mul_f32 v156, v255, v156
    v_mul_f32 v157, v255, v157
    s_waitcnt lgkmcnt(2)
    buffer_store_dwordx4 v[122:125], v130, s[12:15], 0 offen nt
    v_cvt_pk_bf16_f32 v117, v156, v157
    v_mul_f32 v134, v255, v134
    v_mul_f32 v135, v255, v135
    v_cvt_pk_bf16_f32 v132, v134, v135
    v_mul_f32 v136, v255, v136
    v_mul_f32 v137, v255, v137
    v_cvt_pk_bf16_f32 v133, v136, v137
    v_or_b32 v158, v158, v161
    v_cmp_gt_i32 s[46:47], 0, v158
    s_waitcnt lgkmcnt(0)
    buffer_store_dwordx2 v[184:185], v183, s[12:15], 0 offen nt
    buffer_store_dwordx4 v[114:117], v131, s[12:15], 0 offen nt
    buffer_store_dwordx2 v[132:133], v254, s[12:15], 0 offen nt
    s_branch L_end
.section .rodata,"a"
.p2align 6
.amdhsa_kernel standalone__window_attn_swin_v2__vision_kernel
  .amdhsa_next_free_vgpr 512
  .amdhsa_next_free_sgpr 102
  .amdhsa_accum_offset 256
  .amdhsa_group_segment_fixed_size 0
  .amdhsa_kernarg_size 96
  .amdhsa_user_sgpr_count 2
  .amdhsa_user_sgpr_kernarg_segment_ptr 1
  .amdhsa_system_sgpr_workgroup_id_x 1
  .amdhsa_float_denorm_mode_32 3
.end_amdhsa_kernel
```

```asm
; @launch grid=(256,1,1) block=(256,1,1) lds=163840
.amdgcn_target "amdgcn-amd-amdhsa--gfx950"
.text
.globl standalone__window_attn_swin_v2__vision_kernel
.p2align 12
.p2align 8
.type standalone__window_attn_swin_v2__vision_kernel,@function
standalone__window_attn_swin_v2__vision_kernel:
    s_mov_b32 s44, 0
L_again:
    s_load_dwordx16 s[76:91], s[0:1], 0
    v_readfirstlane_b32 s16, v0
    s_cmp_ge_u32 s2, 256
    s_cbranch_scc1 L_done
    s_lshr_b32 s16, s16, 6
    s_cbranch_scc1 L_nopf
    s_getpc_b64 s[96:97]
    s_bfe_u32 s3, s2, 0x30003
    s_mul_i32 s3, s3, 42
    v_cmp_gt_u32 vcc, 22, v0
    v_add_u32 v190, s3, v0
    v_mov_b32 v191, 0
    v_cndmask_b32 v190, v190, v0, vcc
    v_lshlrev_b32 v190, 7, v190
    v_lshl_add_u64 v[190:191], s[96:97], 0, v[190:191]
    global_load_dword a255, v[190:191], off offset:992
L_nopf:
    s_max_u32 s3, s2, s44
    s_cmp_ge_u32 s3, 247
    s_cbranch_scc1 L_edge
    v_mov_b32 v190, v0
    v_mov_b32 v191, 0x40000000
    v_and_b32 v254, 63, v0
    s_bfe_u32 s3, s2, 0x50003
    s_lshl_b32 s4, s16, 3
    s_lshr_b32 s98, 0x06143a01, s4
    s_and_b32 s98, s98, 0xff
    s_mul_i32 s3, s3, s98
    s_sub_u32 s98, s98, 1
    s_lshr_b32 s4, 0x0048d800, s4
    s_and_b32 s4, s4, 0xff
    s_lshl_b32 s4, s4, 3
    s_max_u32 s4, s4, 6
    s_sub_u32 s4, s4, s98
    s_sub_u32 s4, s4, 1
    s_min_u32 s3, s3, s4
    v_min_u32 v114, s98, v254
    v_add_lshl_u32 v114, v114, s3, 7
    v_mov_b32 v115, 0
    v_lshrrev_b32 v255, 4, v254
    v_and_b32 v116, 15, v254
    s_mov_b32 s10, 100270464
    s_mov_b32 s11, 0x00020000
    s_mov_b32 s50, 36096
    s_mov_b32 s51, 0x00020000
    s_mul_i32 s3, s16, 96
    v_lshl_add_u32 v117, v254, 4, s3
    v_mul_u32_u24 v122, 171, v254
    v_lshrrev_b32 v122, 10, v122
    v_lshrrev_b32 v123, 1, v122
    v_xor_b32 v123, v123, v122
    v_and_b32 v123, 4, v123
    v_mul_u32_u24 v123, 3, v123
    v_xor_b32 v123, v123, v122
    v_mul_u32_u24 v123, 1152, v123
    v_mul_u32_u24 v124, 96, v122
    v_sub_u32 v123, v123, v124
    v_add_u32 v124, v117, v123
    v_add_u32 v123, 64, v254
    v_mul_u32_u24 v123, 171, v123
    v_lshrrev_b32 v123, 10, v123
    v_lshrrev_b32 v125, 1, v123
    v_xor_b32 v125, v125, v123
    v_and_b32 v125, 4, v125
    v_mul_u32_u24 v125, 3, v125
    v_xor_b32 v125, v125, v123
    v_mul_u32_u24 v125, 1152, v125
    v_mul_u32_u24 v126, 96, v123
    v_sub_u32 v125, v125, v126
    v_add_u32 v126, v117, v125
    v_add_u32 v125, 128, v254
    v_mul_u32_u24 v125, 171, v125
    v_lshrrev_b32 v125, 10, v125
    v_lshrrev_b32 v127, 1, v125
    v_xor_b32 v127, v127, v125
    v_and_b32 v127, 4, v127
    v_mul_u32_u24 v127, 3, v127
    v_xor_b32 v127, v127, v125
    v_mul_u32_u24 v127, 1152, v127
    v_mul_u32_u24 v128, 96, v125
    v_sub_u32 v127, v127, v128
    v_add_u32 v128, v117, v127
    s_mul_i32 s68, s16, 6144
    s_add_u32 s69, s68, 65536
    s_cmp_eq_u32 s16, 3
    s_cselect_b32 s68, 136704, s68
    s_cselect_b32 s69, 142848, s69
    s_waitcnt lgkmcnt(0)
    s_cmp_eq_u32 s16, 2
    s_cselect_b64 s[98:99], s[80:81], s[78:79]
    s_cmp_eq_u32 s16, 3
    s_cselect_b64 s[98:99], s[88:89], s[98:99]
    s_mov_b64 s[8:9], s[76:77]
    v_lshl_add_u64 v[114:115], s[98:99], 0, v[114:115]
    s_cmp_eq_u32 s16, 2
    s_cselect_b64 s[98:99], s[84:85], s[82:83]
    s_cmp_eq_u32 s16, 3
    s_cselect_b64 s[98:99], s[86:87], s[98:99]
    v_writelane_b32 v114, s98, 63
    v_writelane_b32 v115, s99, 63
    s_cmp_eq_u32 s16, 0
    s_cbranch_scc1 L_nowu
    global_load_dword a254, v[114:115], off
L_nowu:
    s_mov_b64 s[48:49], s[78:79]
    s_mov_b64 s[52:53], s[80:81]
    s_mov_b64 s[60:61], s[84:85]
    s_mov_b64 s[64:65], s[86:87]
    s_mov_b64 s[56:57], s[88:89]
    s_mov_b64 s[46:47], s[82:83]
    s_load_dwordx2 s[42:43], s[0:1], 72
    s_add_u32 s48, s48, 384
    s_addc_u32 s49, s49, 0
    s_add_u32 m0, s68, 0
    v_add_u32 v127, s16, v254
    v_and_b32 v127, 3, v127
    v_lshlrev_b32 v127, 1, v127
    s_mov_b32 s54, 12288
    s_mov_b32 s55, 0x00020000
    s_mov_b32 s62, 64
    s_mov_b32 s63, 0x00020000
    s_mov_b32 s66, 128
    s_mov_b32 s67, 0x00020000
    s_mov_b32 s58, 676
    s_mov_b32 s59, 0x00020000
    s_mov_b32 s14, 0
    s_mov_b32 s15, 0x00020000
    v_mov_b32 v193, 0
    v_cmp_lt_u32 s[92:93], 7, v116
    v_mov_b32 v115, 0
    v_mov_b32 v117, 0
    v_mov_b32 v119, 0
    v_lshlrev_b32 v129, 1, v254
    v_mul_u32_u24 v114, 12, v116
    s_mul_i32 s71, s16, 192
    v_add_u32 v114, s71, v114
    v_lshlrev_b32 v118, 5, v255
    s_mul_i32 s72, s16, 8064
    s_add_u32 s72, s72, 104448
    s_mul_i32 s73, s16, 6528
    s_add_u32 s73, s73, 38912
    s_mov_b32 s70, 193536
    s_mov_b32 s36, 100270464
    s_mov_b32 s22, 1180032
    s_mul_i32 s3, s2, 911
    s_lshr_b32 s3, s3, 16
    s_mul_i32 s35, s3, 72
    s_sub_u32 s38, s2, s35
    s_mul_i32 s3, s3, 1373568
    s_mul_i32 s35, s38, 2688
    s_add_u32 s3, s3, s35
    s_add_u32 s25, s3, 589824
    s_add_u32 s7, s3, 1769472
    s_mov_b32 s20, 31
    s_mov_b32 s21, 4204032
    s_cmp_lt_u32 s2, 244
    s_cselect_b32 s17, 21, 20
    v_mul_u32_u24 v192, 2731, v190
    v_bfe_u32 v120, v192, 17, 3
    v_lshrrev_b32 v192, 16, v192
    v_xor_b32 v121, v120, v190
    v_mul_u32_u24 v120, 37, v192
    v_lshrrev_b32 v120, 8, v120
    v_lshlrev_b32 v121, 4, v121
    v_mad_u32_u24 v10, v120, s70, v121
    v_mul_u32_u24 v120, s20, v192
    v_add_u32 v120, s38, v120
    v_mul_u32_u24 v120, 911, v120
    v_lshrrev_b32 v120, 16, v120
    v_mul_u32_u24 v120, s22, v120
    v_mad_u32_u24 v120, v192, s21, v120
    v_cmp_gt_u32 vcc, s17, v192
    v_add_u32 v120, s7, v120
    v_mul_u32_u24 v192, 384, v192
    v_cndmask_b32 v120, v191, v120, vcc
    v_sub_u32 v192, v121, v192
    v_add_u32 v120, v120, v192
    v_add_u32 v121, 256, v190
    v_mul_u32_u24 v192, 2731, v121
    v_bfe_u32 v130, v192, 17, 3
    v_lshrrev_b32 v192, 16, v192
    v_xor_b32 v121, v130, v121
    v_mul_u32_u24 v130, 37, v192
    v_lshrrev_b32 v130, 8, v130
    v_lshlrev_b32 v121, 4, v121
    v_mad_u32_u24 v11, v130, s70, v121
    v_mul_u32_u24 v130, s20, v192
    v_add_u32 v130, s38, v130
    v_mul_u32_u24 v130, 911, v130
    v_lshrrev_b32 v130, 16, v130
    v_mul_u32_u24 v130, s22, v130
    v_mad_u32_u24 v130, v192, s21, v130
    v_cmp_gt_u32 vcc, s17, v192
    v_add_u32 v130, s7, v130
    v_mul_u32_u24 v192, 384, v192
    v_cndmask_b32 v130, v191, v130, vcc
    v_sub_u32 v192, v121, v192
    v_add_u32 v130, v130, v192
    s_lshl_b32 s28, s16, 10
    s_add_u32 s28, s28, 20480
    v_lshrrev_b32 v192, 2, v116
    v_and_b32 v121, 1, v192
    v_mul_u32_u24 v121, 0x020202, v121
    v_lshl_or_b32 v121, v121, 8, v121
    v_add_u32 v121, 0x05040100, v121
    v_and_b32 v131, 3, v116
    v_lshrrev_b32 v132, 1, v116
    v_xor_b32 v133, v132, v255
    v_mul_u32_u24 v132, 384, v116
    v_lshl_add_u32 v0, v133, 4, v132
    v_xor_b32 v1, 64, v0
    v_and_b32 v132, 2, v255
    v_add_u32 v132, v132, v255
    v_lshl_add_u32 v132, v132, 2, v192
    v_mul_u32_u24 v132, 96, v132
    v_lshl_add_u32 v132, v131, 3, v132
    v_add_u32 v133, s68, v132
    v_add_u32 v134, s69, v132
    v_add_u32 v135, s72, v132
    v_add_u32 v132, s73, v132
    v_mov_b32 v28, 0x3f803f80
    v_mov_b32 v29, 0x3f803f80
    v_mov_b32 v30, 0x3f803f80
    v_mov_b32 v31, 0x3f803f80
    v_mul_u32_u24 v136, 768, v255
    v_add_u32 v136, v114, v136
    v_add_u32 v136, 157184, v136
    s_mov_b32 s76, 0x3f80
    v_and_b32 v137, 1, v116
    v_lshlrev_b32 v137, 4, v137
    v_lshlrev_b32 v138, v137, s76
    v_mov_b32 v139, 0x3c003c00
    v_mov_b32 v44, 1.0
    v_mov_b32 v45, 1.0
    s_mov_b32 s19, s38
    s_mov_b32 s23, s25
    buffer_load_dwordx4 v124, s[48:51], 0 offen lds
    v_lshlrev_b32 v140, 4, v255
    s_mov_b32 s26, 0
    s_mov_b32 s27, 0
    s_mov_b32 s18, 0
    s_add_u32 s19, s19, s20
    s_add_u32 s23, s23, s21
    s_cmp_ge_u32 s19, 72
    s_cselect_b32 s34, 72, 0
    s_cselect_b32 s35, s22, 0
    s_sub_u32 s19, s19, s34
    s_add_u32 s23, s23, s35
    s_mov_b32 s24, s23
    s_add_u32 s19, s19, s20
    s_add_u32 s23, s23, s21
    s_cmp_ge_u32 s19, 72
    s_cselect_b32 s34, 72, 0
    buffer_load_dwordx4 v126, s[48:51], 0 offen offset:1024 lds
    s_cselect_b32 s35, s22, 0
    s_sub_u32 s19, s19, s34
    s_add_u32 s23, s23, s35
    s_mul_i32 s79, s16, 64
    v_lshl_add_u32 v141, v255, 4, s79
    s_mul_i32 s80, s16, 32
    s_add_u32 s80, s80, 256
    v_lshl_add_u32 v142, v255, 3, s80
    v_add_u32 v144, 0, v116
    v_mul_u32_u24 v143, 37, v144
    v_mul_u32_u24 v145, 384, v144
    v_lshrrev_b32 v143, 8, v143
    v_mad_u32_u24 v145, v143, s70, v145
    v_add_u32 v15, v145, v141
    s_mul_i32 s81, s16, 768
    s_add_u32 s81, s81, 157184
    buffer_load_dwordx4 v128, s[48:51], 0 offen offset:2048 lds
    s_add_u32 m0, s28, 128512
    s_add_u32 s48, s48, 36864
    s_addc_u32 s49, s49, 0
    v_add_u32 v18, v145, v142
    v_add_u32 v145, 16, v116
    v_mul_u32_u24 v147, 37, v145
    v_mul_u32_u24 v146, 384, v145
    v_lshrrev_b32 v147, 8, v147
    v_mad_u32_u24 v146, v147, s70, v146
    v_add_u32 v16, v146, v141
    v_add_u32 v19, v146, v142
    v_add_u32 v146, 32, v116
    v_mul_u32_u24 v148, 37, v146
    v_mul_u32_u24 v149, 384, v146
    s_mov_b32 s82, -24
    s_lshr_b32 s83, s16, 1
    buffer_load_dwordx4 v120, s[8:11], 0 offen nt lds
    s_add_u32 m0, s28, 132608
    v_lshrrev_b32 v148, 8, v148
    v_mad_u32_u24 v149, v148, s70, v149
    v_add_u32 v17, v149, v141
    v_add_u32 v20, v149, v142
    v_mul_u32_u24 v120, 24, v143
    v_lshl_add_u32 v120, v144, 2, v120
    v_add_u32 v22, s81, v120
    v_sub_u32 v23, s81, v120
    v_sub_u32 v120, v22, v140
    v_mul_u32_u24 v141, 24, v147
    v_lshl_add_u32 v141, v145, 2, v141
    v_add_u32 v24, s81, v141
    v_sub_u32 v25, s81, v141
    s_and_b32 s84, s16, 1
    s_lshl_b32 s84, s84, 3
    buffer_load_dwordx4 v130, s[8:11], 0 offen nt lds
    s_add_u32 m0, s28, 0
    v_sub_u32 v141, v24, v140
    v_mul_u32_u24 v130, 24, v148
    v_lshl_add_u32 v130, v146, 2, v130
    v_add_u32 v26, s81, v130
    v_sub_u32 v27, s81, v130
    v_sub_u32 v130, v26, v140
    v_mul_u32_u24 v142, 148, v255
    v_add_u32 v143, 0, v142
    v_lshrrev_b32 v143, 8, v143
    v_mad_i32_i24 v46, v143, s82, v120
    v_mad_i32_i24 v58, v143, s82, v141
    v_mad_i32_i24 v70, v143, s82, v130
    v_add_u32 v143, 37, v142
    s_lshl_b32 s85, s83, 10
    s_add_u32 s85, s85, s84
    buffer_load_dwordx4 v10, s[8:11], s25 offen nt lds
    s_add_u32 m0, s28, 4096
    v_lshrrev_b32 v143, 8, v143
    v_mad_i32_i24 v47, v143, s82, v120
    v_mad_i32_i24 v59, v143, s82, v141
    v_mad_i32_i24 v71, v143, s82, v130
    v_add_u32 v143, 74, v142
    v_lshrrev_b32 v143, 8, v143
    v_mad_i32_i24 v48, v143, s82, v120
    v_mad_i32_i24 v60, v143, s82, v141
    v_mad_i32_i24 v72, v143, s82, v130
    v_add_u32 v143, 111, v142
    v_lshrrev_b32 v143, 8, v143
    v_mad_i32_i24 v49, v143, s82, v120
    s_lshl_b32 s83, s83, 11
    s_add_u32 s83, s83, s84
    buffer_load_dwordx4 v11, s[8:11], s25 offen nt lds
    s_add_u32 m0, s68, 3072
    v_mad_i32_i24 v61, v143, s82, v141
    v_mad_i32_i24 v73, v143, s82, v130
    v_add_u32 v143, 592, v142
    v_lshrrev_b32 v143, 8, v143
    v_mad_i32_i24 v50, v143, s82, v120
    v_mad_i32_i24 v62, v143, s82, v141
    v_mad_i32_i24 v74, v143, s82, v130
    v_add_u32 v143, 629, v142
    v_lshrrev_b32 v143, 8, v143
    v_mad_i32_i24 v51, v143, s82, v120
    v_mad_i32_i24 v63, v143, s82, v141
    v_mad_i32_i24 v75, v143, s82, v130
    s_add_u32 s83, s83, 144896
    s_mul_i32 s86, s16, 2048
    buffer_load_dwordx4 v124, s[48:51], 0 offen lds
    v_add_u32 v143, 666, v142
    v_lshrrev_b32 v143, 8, v143
    v_mad_i32_i24 v52, v143, s82, v120
    v_mad_i32_i24 v64, v143, s82, v141
    v_mad_i32_i24 v76, v143, s82, v130
    v_add_u32 v143, 703, v142
    v_lshrrev_b32 v143, 8, v143
    v_mad_i32_i24 v53, v143, s82, v120
    v_mad_i32_i24 v65, v143, s82, v141
    v_mad_i32_i24 v77, v143, s82, v130
    v_add_u32 v143, 1184, v142
    v_lshrrev_b32 v143, 8, v143
    v_mad_i32_i24 v54, v143, s82, v120
    v_mad_i32_i24 v66, v143, s82, v141
    s_add_u32 s86, s86, 136704
    s_mul_i32 s87, s16, 128
    buffer_load_dwordx4 v126, s[48:51], 0 offen offset:1024 lds
    v_mad_i32_i24 v78, v143, s82, v130
    v_add_u32 v143, 1221, v142
    v_lshrrev_b32 v143, 8, v143
    v_mad_i32_i24 v55, v143, s82, v120
    v_mad_i32_i24 v67, v143, s82, v141
    v_mad_i32_i24 v79, v143, s82, v130
    v_add_u32 v143, 1258, v142
    v_lshrrev_b32 v143, 8, v143
    v_mad_i32_i24 v56, v143, s82, v120
    v_mad_i32_i24 v68, v143, s82, v141
    v_mad_i32_i24 v80, v143, s82, v130
    v_add_u32 v142, 1295, v142
    v_lshrrev_b32 v142, 8, v142
    v_mad_i32_i24 v57, v142, s82, v120
    v_mad_i32_i24 v69, v142, s82, v141
    v_mad_i32_i24 v81, v142, s82, v130
    v_mov_b32 v130, s81
    v_lshlrev_b32 v120, 4, v254
    v_xor_b32 v2, 65536, v120
    v_lshl_add_u32 v3, s16, 10, v120
    v_add_u32 v4, s85, v120
    v_lshl_add_u32 v120, v255, 3, s86
    v_mov_b32 v141, s83
    v_mov_b32 v142, 161536
    v_mul_u32_u24 v143, 80, v255
    v_add3_u32 v5, v143, v137, s72
    v_lshl_add_u32 v6, v116, 2, s73
    s_add_u32 s87, s87, 65024
    v_add_u32 v9, s87, v140
    v_lshrrev_b32 v144, 1, v255
    v_mul_u32_u24 v144, 48, v144
    v_lshl_add_u32 v144, v255, 3, v144
    v_lshl_add_u32 v144, v192, 4, v144
    v_lshl_add_u32 v144, v131, 1, v144
    v_add_u32 v8, s87, v144
    v_mov_b32 v37, 0
    v_mov_b32 v38, 0
    v_mov_b32 v39, 0
    s_mov_b32 s40, s8
    s_mov_b32 s41, s9
    s_mov_b32 s32, 0x2a8cbccc
    s_mov_b32 s33, 0x38fba882
    v_add_u32 v144, 148992, v0
    v_add_u32 v145, 148992, v1
    v_lshlrev_b32 v146, 4, v116
    v_add_u32 v146, 160256, v146
    v_mul_u32_u24 v147, 336, v116
    v_add3_u32 v147, v147, v143, s72
    v_mul_u32_u24 v143, 272, v116
    v_add3_u32 v143, v143, v140, s73
    v_mul_u32_u24 v148, 1088, v255
    v_add_u32 v148, v148, v6
    v_add_u32 v149, 5376, v147
    v_add_u32 v222, 4352, v143
    v_add_u32 v150, 4352, v148
    v_cmp_gt_u32 s[88:89], 16, v254
    v_mov_b32 v224, 0xf149f2ca
    v_add_u32 v223, 512, v190
    v_mul_u32_u24 v225, 2731, v223
    v_bfe_u32 v151, v225, 17, 3
    v_lshrrev_b32 v225, 16, v225
    v_xor_b32 v223, v151, v223
    v_mul_u32_u24 v151, 37, v225
    v_lshrrev_b32 v151, 8, v151
    v_lshlrev_b32 v223, 4, v223
    v_mad_u32_u24 v12, v151, s70, v223
    v_add_u32 v223, 768, v190
    v_mul_u32_u24 v225, 2731, v223
    v_bfe_u32 v151, v225, 17, 3
    v_lshrrev_b32 v225, 16, v225
    v_xor_b32 v223, v151, v223
    v_mul_u32_u24 v151, 37, v225
    v_lshrrev_b32 v151, 8, v151
    v_lshlrev_b32 v223, 4, v223
    v_mad_u32_u24 v13, v151, s70, v223
    v_add_u32 v190, 1024, v190
    v_mul_u32_u24 v223, 2731, v190
    v_bfe_u32 v225, v223, 17, 3
    v_lshrrev_b32 v223, 16, v223
    v_xor_b32 v190, v225, v190
    v_mul_u32_u24 v225, 37, v223
    v_lshrrev_b32 v225, 8, v225
    v_lshlrev_b32 v190, 4, v190
    v_mad_u32_u24 v14, v225, s70, v190
    v_cmp_gt_u32 vcc, 48, v223
    s_add_u32 s75, s28, 16384
    s_cmp_lt_u32 s16, 2
    v_cndmask_b32 v14, v191, v14, vcc
    v_cmp_gt_u32 vcc, 2, v131
    s_cselect_b32 s29, s75, 160256
    s_cselect_b32 s30, 65536, 0
    v_cndmask_b32 v32, 0, v138, vcc
    v_cndmask_b32 v33, v138, 0, vcc
    v_cndmask_b32 v34, 0, v138, vcc
    v_cndmask_b32 v35, v138, 0, vcc
    v_cmp_eq_u32 vcc, 0, v137
    s_xor_b32 s74, s29, s30
    s_mul_i32 s77, s16, 64
    v_cndmask_b32 v40, 0, v139, vcc
    v_cndmask_b32 v41, v139, 0, vcc
    v_cndmask_b32 v42, 0, v139, vcc
    v_cndmask_b32 v43, v139, 0, vcc
    v_cmp_eq_u32 vcc, v255, v192
    s_mul_i32 s78, s16, 32
    s_add_u32 s78, s78, 192
    v_cndmask_b32 v152, 0, v32, vcc
    v_cndmask_b32 v153, 0, v33, vcc
    v_mul_u32_u24 v151, 6, v122
    v_sub_u32 v138, v254, v151
    v_mul_u32_u24 v151, 384, v122
    v_lshl_add_u32 v151, v138, 4, v151
    v_add_u32 v122, s78, v151
    v_add_u32 v151, s77, v151
    v_cmp_gt_i32 vcc, 4, v138
    v_mul_u32_u24 v138, 6, v123
    v_sub_u32 v139, v254, v138
    v_cndmask_b32 v151, v122, v151, vcc
    v_mul_u32_u24 v138, 384, v123
    v_lshl_add_u32 v138, v139, 4, v138
    v_add_u32 v122, s78, v138
    v_add_u32 v138, s77, v138
    v_cmp_gt_i32 vcc, -60, v139
    v_mul_u32_u24 v139, 6, v125
    v_sub_u32 v254, v254, v139
    v_cndmask_b32 v122, v122, v138, vcc
    v_mul_u32_u24 v139, 384, v125
    v_lshl_add_u32 v139, v254, 4, v139
    v_add_u32 v138, s78, v139
    v_add_u32 v139, s77, v139
    v_cmp_gt_i32 vcc, -124, v254
    v_mul_u32_u24 v123, 96, v116
    v_add3_u32 v254, v123, v140, s68
    v_cndmask_b32 v125, v138, v139, vcc
    v_cmp_gt_u32 vcc, 2, v255
    v_lshl_add_u32 v190, v255, 3, v123
    v_add3_u32 v190, v190, 64, s68
    v_cndmask_b32 v120, v141, v120, vcc
    v_lshl_add_u32 v120, v192, 9, v120
    v_lshl_add_u32 v120, v131, 1, v120
    v_cmp_gt_u32 vcc, 3, v255
    v_add3_u32 v191, v123, v140, s69
    v_lshl_add_u32 v123, v255, 3, v123
    v_cndmask_b32 v7, v142, v120, vcc
    v_cmp_gt_u32 vcc, 8, v116
    v_add3_u32 v123, v123, 64, s69
    v_add_u32 v116, 16, v116
    v_cndmask_b32 v149, v146, v149, vcc
    v_cndmask_b32 v222, v146, v222, vcc
    v_cmp_gt_u32 vcc, 2, v255
    v_cmp_gt_u32 s[94:95], s17, v116
    v_cmp_ne_u32 s[96:97], 0, v137
    v_cndmask_b32 v150, v146, v150, vcc
    v_cmp_lt_u32 s[98:99], 1, v131
    v_cmp_eq_u32 vcc, v255, v192
    v_sub_u32 v255, v143, v140
    v_sub_u32 v142, v222, v140
    v_cndmask_b32 v255, v146, v255, vcc
    v_cndmask_b32 v142, v146, v142, vcc
    s_add_u32 s34, s18, 2
    s_mov_b32 s27, s26
    s_mov_b32 s26, s25
    s_add_u32 s19, s19, s20
    s_mov_b32 s18, 1
    s_sub_u32 s45, s17, 1
    buffer_load_dwordx4 v128, s[48:51], 0 offen offset:2048 lds
    s_add_u32 s48, s48, 36864
    s_addc_u32 s49, s49, 0
    s_add_u32 m0, s69, 0
    s_nop 0
    buffer_load_dwordx4 v124, s[48:51], 0 offen lds
    s_waitcnt vmcnt(8)
    ds_read_b64_tr_b16 a[72:73], v133 offset:0
    buffer_load_dwordx4 v126, s[48:51], 0 offen offset:1024 lds
    ds_read_b64_tr_b16 a[74:75], v133 offset:768
    ds_read_b64_tr_b16 a[96:97], v133 offset:32
    ds_read_b64_tr_b16 a[98:99], v133 offset:800
    ds_read_b64_tr_b16 a[120:121], v133 offset:64
    ds_read_b64_tr_b16 a[122:123], v133 offset:832
    buffer_load_dwordx4 v128, s[48:51], 0 offen offset:2048 lds
    s_add_u32 s48, s48, 36864
    s_addc_u32 s49, s49, 0
    s_add_u32 m0, s69, 3072
    s_nop 0
    buffer_load_ushort v192, v129, s[60:63], 0 offen
    buffer_load_dwordx3 v[194:196], v114, s[56:59], 0 offen
    buffer_load_dwordx4 v[206:209], v118, s[64:67], 0 offen
    buffer_load_dwordx4 v[170:173], v118, s[64:67], 0 offen offset:16
    global_load_ushort v127, v127, s[46:47]
    buffer_load_dwordx4 v124, s[48:51], 0 offen lds
    s_waitcnt vmcnt(12)
    s_barrier
    ds_read_b128 v[166:169], v144 offset:6144
    ds_read_b128 v[162:165], v145 offset:6144
    ds_read_b128 v[210:213], v144 offset:6272
    ds_read_b128 v[226:229], v145 offset:6272
    ds_read_b128 v[218:221], v144 offset:6400
    ds_read_b128 v[154:157], v145 offset:6400
    buffer_load_dwordx4 v126, s[48:51], 0 offen offset:1024 lds
    ds_read_b128 v[230:233], v144 offset:0
    ds_read_b128 v[174:177], v145 offset:0
    ds_read_b128 v[182:185], v144 offset:128
    ds_read_b128 v[158:161], v145 offset:128
    s_waitcnt lgkmcnt(7)
    v_mfma_f32_16x16x32_bf16 v[178:181], a[72:75], v[166:169], 0
    buffer_load_dwordx4 v128, s[48:51], 0 offen offset:2048 lds
    ds_read_b128 v[186:189], v144 offset:256
    v_mfma_f32_16x16x32_bf16 v[198:201], a[96:99], v[166:169], 0
    s_add_u32 s48, s48, 36864
    ds_read_b128 v[202:205], v145 offset:256
    s_addc_u32 s49, s49, 0
    v_mfma_f32_16x16x32_bf16 v[214:217], a[120:123], v[166:169], 0
    s_add_u32 m0, s72, 0
    s_nop 0
    s_waitcnt lgkmcnt(5)
    v_mfma_f32_16x16x32_bf16 v[166:169], a[72:75], v[230:233], 0
    ds_read_b128 v[234:237], v0 offset:20480
    s_waitcnt vmcnt(11)
    v_mfma_f32_16x16x32_bf16 v[238:241], a[96:99], v[230:233], 0
    s_waitcnt lgkmcnt(5)
    buffer_load_dwordx4 v124, s[48:51], 0 offen lds
    ds_read_b64_tr_b16 a[76:77], v133 offset:3072
    v_mfma_f32_16x16x32_bf16 v[242:245], a[120:123], v[230:233], 0
    s_waitcnt lgkmcnt(5)
    ds_read_b64_tr_b16 a[78:79], v133 offset:3840
    ds_read_b64_tr_b16 a[100:101], v133 offset:3104
    ds_read_b64_tr_b16 a[102:103], v133 offset:3872
    ds_read_b64_tr_b16 a[124:125], v133 offset:3136
    ds_read_b64_tr_b16 a[126:127], v133 offset:3904
    buffer_load_dwordx4 v126, s[48:51], 0 offen offset:1024 lds
    s_waitcnt lgkmcnt(4)
    v_mfma_f32_16x16x32_bf16 v[178:181], a[76:79], v[162:165], v[178:181]
    s_waitcnt lgkmcnt(3)
    buffer_load_dwordx4 v128, s[48:51], 0 offen offset:2048 lds
    s_add_u32 s48, s48, 36864
    v_mfma_f32_16x16x32_bf16 v[166:169], a[76:79], v[174:177], v[166:169]
    s_waitcnt lgkmcnt(0)
    s_addc_u32 s49, s49, 0
    s_add_u32 m0, s72, 3072
    v_mfma_f32_16x16x32_bf16 v[198:201], a[100:103], v[162:165], v[198:201]
    v_mfma_f32_16x16x32_bf16 v[214:217], a[124:127], v[162:165], v[214:217]
    ds_read_b128 v[162:165], v1 offset:20480
    s_waitcnt vmcnt(11)
    v_mfma_f32_16x16x32_bf16 v[238:241], a[100:103], v[174:177], v[238:241]
    ds_read_b64_tr_b16 a[80:81], v134 offset:0
    s_waitcnt vmcnt(9)
    v_mfma_f32_16x16x32_bf16 v[242:245], a[124:127], v[174:177], v[242:245]
    s_waitcnt vmcnt(8)
    buffer_load_dwordx4 v124, s[48:51], 0 offen lds
    s_waitcnt vmcnt(8)
    ds_read_b64_tr_b16 a[82:83], v134 offset:768
    s_waitcnt vmcnt(7)
    ds_read_b64_tr_b16 a[104:105], v134 offset:32
    ds_read_b64_tr_b16 a[106:107], v134 offset:800
    ds_read_b64_tr_b16 a[128:129], v134 offset:64
    ds_read_b64_tr_b16 a[130:131], v134 offset:832
    v_cndmask_b32 v206, v206, v207, s[92:93]
    v_cndmask_b32 v208, v208, v209, s[92:93]
    v_perm_b32 v120, v208, v206, v121
    v_mfma_f32_16x16x32_bf16 v[206:209], a[72:75], v[234:237], 0
    v_cndmask_b32 v170, v170, v171, s[92:93]
    v_cndmask_b32 v172, v172, v173, s[92:93]
    buffer_load_dwordx4 v126, s[48:51], 0 offen offset:1024 lds
    v_perm_b32 v121, v172, v170, v121
    v_mfma_f32_16x16x32_bf16 v[246:249], a[96:99], v[234:237], 0
    s_waitcnt lgkmcnt(6)
    v_bfe_u32 v114, v194, v140, 16
    v_bfe_u32 v116, v195, v140, 16
    v_mfma_f32_16x16x32_bf16 v[206:209], a[76:79], v[162:165], v[206:209]
    s_waitcnt lgkmcnt(5)
    v_bfe_u32 v118, v196, v140, 16
    v_lshlrev_b32 v127, 16, v127
    v_mfma_f32_16x16x32_bf16 v[246:249], a[100:103], v[162:165], v[246:249]
    v_max_f32 v127, 0xc2c80000, v127
    s_waitcnt lgkmcnt(4)
    v_mfma_f32_16x16x32_bf16 v[178:181], a[80:83], v[210:213], v[178:181]
    s_waitcnt lgkmcnt(3)
    v_min_f32 v127, 0x40930000, v127
    v_mul_f32 v127, 0x3fb8aa3b, v127
    v_mfma_f32_16x16x32_bf16 v[166:169], a[80:83], v[182:185], v[166:169]
    s_waitcnt lgkmcnt(0)
    buffer_load_dwordx4 v128, s[48:51], 0 offen offset:2048 lds
    s_sub_u32 s48, s48, 184704
    v_mfma_f32_16x16x32_bf16 v[198:201], a[104:107], v[210:213], v[198:201]
    s_subb_u32 s49, s49, 0
    v_exp_f32 v127, v127
    v_mfma_f32_16x16x32_bf16 v[214:217], a[128:131], v[210:213], v[214:217]
    s_add_u32 m0, s73, 0
    ds_read_b128 v[210:213], v0 offset:20608
    v_cvt_pk_bf16_f32 v127, v127, v127
    v_mfma_f32_16x16x32_bf16 v[238:241], a[104:107], v[182:185], v[238:241]
    v_and_b32 v127, 0xffff0000, v127
    v_mul_f32 v129, 0x3fb8aa3b, v127
    v_mfma_f32_16x16x32_bf16 v[242:245], a[128:131], v[182:185], v[242:245]
    buffer_load_dwordx4 v124, s[48:51], 0 offen lds
    s_waitcnt vmcnt(7)
    ds_read_b64_tr_b16 a[84:85], v134 offset:3072
    ds_read_b64_tr_b16 a[86:87], v134 offset:3840
    ds_read_b64_tr_b16 a[108:109], v134 offset:3104
    ds_read_b64_tr_b16 a[110:111], v134 offset:3872
    ds_read_b64_tr_b16 a[132:133], v134 offset:3136
    ds_read_b64_tr_b16 a[134:135], v134 offset:3904
    v_readfirstlane_b32 s37, v127
    v_readfirstlane_b32 s31, v129
    v_mul_f32 v131, 0x3e000000, v127
    v_cmp_lt_f32 s[90:91], 4.0, v131
    s_nop 0
    s_nop 0
    s_cmp_lg_u64 s[90:91], 0
    s_cbranch_scc1 L_slow
    buffer_load_dwordx4 v126, s[48:51], 0 offen offset:1024 lds
    s_waitcnt lgkmcnt(6)
    v_mfma_f32_16x16x32_bf16 v[206:209], a[80:83], v[210:213], v[206:209]
    v_mfma_f32_16x16x32_bf16 v[246:249], a[104:107], v[210:213], v[246:249]
    s_waitcnt lgkmcnt(4)
    v_mfma_f32_16x16x32_bf16 v[178:181], a[84:87], v[226:229], v[178:181]
    s_waitcnt lgkmcnt(3)
    v_mfma_f32_16x16x32_bf16 v[166:169], a[84:87], v[158:161], v[166:169]
    s_waitcnt lgkmcnt(0)
    buffer_load_dwordx4 v128, s[48:51], 0 offen offset:2048 lds
    s_add_u32 s48, s48, 36864
    v_mfma_f32_16x16x32_bf16 v[198:201], a[108:111], v[226:229], v[198:201]
    s_addc_u32 s49, s49, 0
    s_add_u32 m0, s73, 3072
    v_mfma_f32_16x16x32_bf16 v[214:217], a[132:135], v[226:229], v[214:217]
    ds_read_b128 v[226:229], v1 offset:20608
    v_mfma_f32_16x16x32_bf16 v[238:241], a[108:111], v[158:161], v[238:241]
    v_mfma_f32_16x16x32_bf16 v[242:245], a[132:135], v[158:161], v[242:245]
    s_waitcnt vmcnt(6)
    ds_read_b64_tr_b16 a[88:89], v135 offset:0
    buffer_load_dwordx4 v124, s[48:51], 0 offen lds
    ds_read_b64_tr_b16 a[90:91], v135 offset:768
    ds_read_b64_tr_b16 a[112:113], v135 offset:32
    ds_read_b64_tr_b16 a[114:115], v135 offset:800
    ds_read_b64_tr_b16 a[136:137], v135 offset:64
    ds_read_b64_tr_b16 a[138:139], v135 offset:832
    buffer_load_dwordx4 v126, s[48:51], 0 offen offset:1024 lds
    s_waitcnt lgkmcnt(6)
    v_mfma_f32_16x16x32_bf16 v[206:209], a[84:87], v[226:229], v[206:209]
    v_mfma_f32_16x16x32_bf16 v[246:249], a[108:111], v[226:229], v[246:249]
    s_waitcnt lgkmcnt(4)
    v_mfma_f32_16x16x32_bf16 v[178:181], a[88:91], v[218:221], v[178:181]
    s_waitcnt lgkmcnt(3)
    v_mfma_f32_16x16x32_bf16 v[166:169], a[88:91], v[186:189], v[166:169]
    s_waitcnt lgkmcnt(0)
    buffer_load_dwordx4 v128, s[48:51], 0 offen offset:2048 lds
    s_add_u32 s48, s48, 36864
    v_mfma_f32_16x16x32_bf16 v[198:201], a[112:115], v[218:221], v[198:201]
    s_addc_u32 s49, s49, 0
    s_add_u32 m0, s68, 0
    v_mfma_f32_16x16x32_bf16 v[214:217], a[136:139], v[218:221], v[214:217]
    ds_read_b128 v[218:221], v0 offset:20736
    v_mfma_f32_16x16x32_bf16 v[238:241], a[112:115], v[186:189], v[238:241]
    s_waitcnt vmcnt(6)
    ds_read_b64_tr_b16 a[92:93], v135 offset:3072
    ds_read_b64_tr_b16 a[94:95], v135 offset:3840
    v_mfma_f32_16x16x32_bf16 v[242:245], a[136:139], v[186:189], v[242:245]
    ds_read_b64_tr_b16 a[116:117], v135 offset:3104
    buffer_load_dwordx4 v124, s[48:51], 0 offen lds
    ds_read_b64_tr_b16 a[118:119], v135 offset:3872
    ds_read_b64_tr_b16 a[140:141], v135 offset:3136
    ds_read_b64_tr_b16 a[142:143], v135 offset:3904
    v_mov_b32 v194, 0
    v_mov_b32 v195, 0
    v_mov_b32 v196, 0
    v_mov_b32 v197, 0
    v_mov_b32 v170, v224
    v_mov_b32 v171, v224
    v_mov_b32 v172, v224
    v_mov_b32 v173, v224
    buffer_load_dwordx4 v126, s[48:51], 0 offen offset:1024 lds
    s_waitcnt lgkmcnt(6)
    v_mfma_f32_16x16x32_bf16 v[206:209], a[88:91], v[218:221], v[206:209]
    v_mfma_f32_16x16x32_bf16 v[246:249], a[112:115], v[218:221], v[246:249]
    s_waitcnt lgkmcnt(4)
    v_mfma_f32_16x16x32_bf16 v[178:181], a[92:95], v[154:157], v[178:181]
    s_waitcnt lgkmcnt(3)
    v_mfma_f32_16x16x32_bf16 v[166:169], a[92:95], v[202:205], v[166:169]
    s_waitcnt lgkmcnt(0)
    v_mfma_f32_16x16x32_bf16 v[198:201], a[116:119], v[154:157], v[198:201]
    buffer_load_dwordx4 v128, s[48:51], 0 offen offset:2048 lds
    s_add_u32 s48, s48, 36864
    v_mfma_f32_16x16x32_bf16 v[214:217], a[140:143], v[154:157], v[214:217]
    s_addc_u32 s49, s49, 0
    v_cvt_pk_f16_f32 v138, v178, v179
    v_pk_mul_f16 v127, v138, v138
    v_mfma_f32_16x16x32_bf16 v[238:241], a[116:119], v[202:205], v[238:241]
    s_add_u32 m0, s68, 3072
    v_cvt_pk_f16_f32 v139, v180, v181
    s_waitcnt vmcnt(6)
    v_mfma_f32_16x16x32_bf16 v[242:245], a[140:143], v[202:205], v[242:245]
    ds_read_b64_tr_b16 a[0:1], v132 offset:0
    ds_read_b64_tr_b16 a[2:3], v132 offset:768
    ds_read_b64_tr_b16 a[24:25], v132 offset:32
    ds_read_b64_tr_b16 a[26:27], v132 offset:800
    ds_read_b64_tr_b16 a[48:49], v132 offset:64
    buffer_load_dwordx4 v124, s[48:51], 0 offen lds
    ds_read_b64_tr_b16 a[50:51], v132 offset:832
    v_pk_mul_f16 v129, v139, v139
    v_cvt_pk_f16_f32 v140, v198, v199
    v_pk_fma_f16 v127, v140, v140, v127
    v_cvt_pk_f16_f32 v141, v200, v201
    v_pk_fma_f16 v129, v141, v141, v129
    v_cvt_pk_f16_f32 v200, v214, v215
    v_pk_fma_f16 v127, v200, v200, v127
    v_cvt_pk_f16_f32 v201, v216, v217
    v_pk_fma_f16 v129, v201, v201, v129
    v_cvt_pk_f16_f32 v166, v166, v167
    v_mfma_f32_16x16x16_bf16 v[154:157], v[192:193], v[114:115], 0
    v_pk_mul_f16 v215, v166, v166
    v_cvt_pk_f16_f32 v167, v168, v169
    buffer_load_dwordx4 v126, s[48:51], 0 offen offset:1024 lds
    v_pk_mul_f16 v217, v167, v167
    v_cvt_pk_f16_f32 v168, v238, v239
    v_pk_fma_f16 v215, v168, v168, v215
    v_cvt_pk_f16_f32 v169, v240, v241
    v_pk_fma_f16 v217, v169, v169, v217
    v_max_f32 v154, 0, v154
    v_max_f32 v155, 0, v155
    v_max_f32 v156, 0, v156
    v_max_f32 v157, 0, v157
    v_cvt_pk_bf16_f32 v198, v154, v155
    v_mfma_f32_16x16x16_bf16 v[238:241], v[192:193], v[116:117], 0
    v_cvt_pk_bf16_f32 v199, v156, v157
    v_cvt_pk_f16_f32 v180, v242, v243
    v_pk_fma_f16 v215, v180, v180, v215
    v_mfma_f32_16x16x16_bf16 v[114:117], v[120:121], v[198:199], 0
    v_cvt_pk_f16_f32 v181, v244, v245
    v_pk_fma_f16 v217, v181, v181, v217
    v_mfma_f32_16x16x16_bf16 v[154:157], v[192:193], v[118:119], 0
    buffer_load_dwordx4 v128, s[48:51], 0 offen offset:2048 lds
    ds_read_b128 v[242:245], v1 offset:20736
    s_add_u32 s48, s48, 36864
    s_addc_u32 s49, s49, 0
    s_add_u32 m0, s69, 0
    v_cvt_pk_bf16_f32 v114, v114, v114
    v_and_b32 v114, 0xffff0000, v114
    s_waitcnt vmcnt(6)
    ds_read_b64_tr_b16 a[4:5], v132 offset:3072
    ds_read_b64_tr_b16 a[6:7], v132 offset:3840
    ds_read_b64_tr_b16 a[28:29], v132 offset:3104
    ds_read_b64_tr_b16 a[30:31], v132 offset:3872
    ds_read_b64_tr_b16 a[52:53], v132 offset:3136
    ds_read_b64_tr_b16 a[54:55], v132 offset:3904
    ds_write_b128 v147, v[194:197] offset:16
    buffer_load_dwordx4 v124, s[48:51], 0 offen lds
    v_mul_f32 v114, 0xbfb8aa3b, v114
    v_exp_f32 v114, v114
    v_max_f32 v238, 0, v238
    v_add_f32 v114, 1.0, v114
    v_rcp_f32 v114, v114
    v_max_f32 v239, 0, v239
    s_waitcnt lgkmcnt(7)
    v_mfma_f32_16x16x32_bf16 v[206:209], a[92:95], v[242:245], v[206:209]
    ds_write_b64 v147, v[194:195] offset:56
    v_mfma_f32_16x16x32_bf16 v[246:249], a[116:119], v[242:245], v[246:249]
    buffer_load_dwordx4 v126, s[48:51], 0 offen offset:1024 lds
    v_cvt_pk_bf16_f32 v114, v114, v114
    v_and_b32 v114, 0xffff0000, v114
    v_add_f32 v114, -0.5, v114
    v_mul_f32 v114, 0x41b8aa3b, v114
    ds_write_b32 v136, v114 offset:0
    v_mfma_f32_16x16x32_bf16 v[114:117], a[0:3], v[230:233], 0
    s_waitcnt lgkmcnt(2)
    v_max_f32 v240, 0, v240
    v_max_f32 v241, 0, v241
    v_mfma_f32_16x16x32_bf16 v[114:117], a[4:7], v[174:177], v[114:117]
    ds_write_b64 v147, v[194:195] offset:64
    buffer_load_dwordx4 v128, s[48:51], 0 offen offset:2048 lds
    s_add_u32 m0, s28, 8192
    s_add_u32 s48, s48, 36864
    s_addc_u32 s49, s49, 0
    v_cvt_pk_bf16_f32 v118, v238, v239
    v_cvt_pk_bf16_f32 v119, v240, v241
    s_waitcnt vmcnt(6)
    ds_read_b64_tr_b16 a[8:9], v133 offset:0
    ds_read_b64_tr_b16 a[10:11], v133 offset:768
    ds_read_b64_tr_b16 a[32:33], v133 offset:32
    ds_read_b64_tr_b16 a[34:35], v133 offset:800
    ds_read_b64_tr_b16 a[56:57], v133 offset:64
    ds_read_b64_tr_b16 a[58:59], v133 offset:832
    ds_write_b128 v149, v[194:197] offset:16
    v_mfma_f32_16x16x16_bf16 v[238:241], v[120:121], v[118:119], 0
    buffer_load_dwordx4 v12, s[8:11], s25 offen nt lds
    v_max_f32 v154, 0, v154
    v_max_f32 v155, 0, v155
    v_mfma_f32_16x16x32_bf16 v[250:253], a[24:27], v[230:233], 0
    s_add_u32 m0, s28, 12288
    v_max_f32 v156, 0, v156
    v_max_f32 v157, 0, v157
    v_mfma_f32_16x16x32_bf16 v[250:253], a[28:31], v[174:177], v[250:253]
    ds_write_b64 v149, v[194:195] offset:56
    v_cvt_pk_bf16_f32 v238, v238, v238
    v_and_b32 v238, 0xffff0000, v238
    buffer_load_dwordx4 v13, s[8:11], s25 offen nt lds
    s_waitcnt lgkmcnt(4)
    v_mfma_f32_16x16x32_bf16 v[114:117], a[8:11], v[182:185], v[114:117]
    s_add_u32 m0, s29, 0
    ds_write_b64 v149, v[194:195] offset:64
    v_mfma_f32_16x16x32_bf16 v[250:253], a[32:35], v[182:185], v[250:253]
    v_mul_f32 v238, 0xbfb8aa3b, v238
    v_exp_f32 v238, v238
    v_cvt_pk_bf16_f32 v118, v154, v155
    v_mfma_f32_16x16x32_bf16 v[192:195], a[48:51], v[230:233], 0
    s_waitcnt lgkmcnt(2)
    ds_write_b128 v143, v[170:173] offset:192
    v_mfma_f32_16x16x32_bf16 v[192:195], a[52:55], v[174:177], v[192:195]
    buffer_load_dwordx4 v14, s[8:11], s25 offen nt lds
    s_waitcnt vmcnt(6)
    v_mfma_f32_16x16x32_bf16 v[192:195], a[56:59], v[182:185], v[192:195]
    s_add_u32 m0, s69, 3072
    v_add_f32 v238, 1.0, v238
    v_cvt_pk_bf16_f32 v119, v156, v157
    v_mfma_f32_16x16x32_bf16 v[196:199], a[120:123], v[234:237], 0
    s_cmp_lt_u32 1, s17
    ds_read_b64_tr_b16 a[12:13], v133 offset:3072
    ds_read_b64_tr_b16 a[14:15], v133 offset:3840
    ds_read_b64_tr_b16 a[36:37], v133 offset:3104
    v_mfma_f32_16x16x16_bf16 v[230:233], v[120:121], v[118:119], 0
    ds_read_b64_tr_b16 a[38:39], v133 offset:3872
    ds_read_b64_tr_b16 a[60:61], v133 offset:3136
    ds_read_b64_tr_b16 a[62:63], v133 offset:3904
    v_cvt_pk_f16_f32 v118, v206, v207
    v_mfma_f32_16x16x32_bf16 v[196:199], a[124:127], v[162:165], v[196:199]
    s_cselect_b32 s10, s36, 0
    buffer_load_dwordx4 v124, s[48:51], 0 offen lds
    v_pk_mul_f16 v223, v118, v118
    v_mfma_f32_16x16x32_bf16 v[196:199], a[128:131], v[210:213], v[196:199]
    s_mov_b32 s25, s24
    ds_write_b128 v222, v[170:173] offset:192
    v_mfma_f32_16x16x32_bf16 v[196:199], a[132:135], v[226:229], v[196:199]
    v_rcp_f32 v238, v238
    v_mfma_f32_16x16x32_bf16 v[196:199], a[136:139], v[218:221], v[196:199]
    v_cvt_pk_bf16_f32 v238, v238, v238
    v_and_b32 v238, 0xffff0000, v238
    v_mfma_f32_16x16x32_bf16 v[196:199], a[140:143], v[242:245], v[196:199]
    s_waitcnt lgkmcnt(6)
    buffer_load_dwordx4 v126, s[48:51], 0 offen offset:1024 lds
    ds_read_b128 v[170:173], v144 offset:6144
    v_mfma_f32_16x16x32_bf16 v[154:157], a[0:3], v[234:237], 0
    s_waitcnt lgkmcnt(4)
    v_add_f32 v238, -0.5, v238
    v_mul_f32 v238, 0x41b8aa3b, v238
    v_mfma_f32_16x16x32_bf16 v[114:117], a[12:15], v[158:161], v[114:117]
    s_waitcnt lgkmcnt(2)
    ds_write_b32 v136, v238 offset:4
    v_mfma_f32_16x16x32_bf16 v[250:253], a[36:39], v[158:161], v[250:253]
    v_cvt_pk_bf16_f32 v230, v230, v230
    v_and_b32 v230, 0xffff0000, v230
    v_mfma_f32_16x16x32_bf16 v[192:195], a[60:63], v[158:161], v[192:195]
    v_mul_f32 v230, 0xbfb8aa3b, v230
    s_waitcnt vmcnt(5)
    v_mfma_f32_16x16x32_bf16 v[154:157], a[4:7], v[162:165], v[154:157]
    buffer_load_dwordx4 v128, s[48:51], 0 offen offset:2048 lds
    ds_read_b64_tr_b16 a[16:17], v134 offset:0
    v_mfma_f32_16x16x32_bf16 v[154:157], a[8:11], v[210:213], v[154:157]
    s_sub_u32 s48, s48, 183552
    ds_read_b64_tr_b16 a[18:19], v134 offset:768
    ds_read_b64_tr_b16 a[40:41], v134 offset:32
    v_mfma_f32_16x16x32_bf16 v[154:157], a[12:15], v[226:229], v[154:157]
    s_subb_u32 s49, s49, 0
    ds_read_b64_tr_b16 a[42:43], v134 offset:800
    ds_read_b64_tr_b16 a[64:65], v134 offset:64
    v_mfma_f32_16x16x32_bf16 v[174:177], a[24:27], v[234:237], 0
    s_waitcnt lgkmcnt(6)
    ds_read_b64_tr_b16 a[66:67], v134 offset:832
    v_cvt_pk_f16_f32 v119, v208, v209
    v_mfma_f32_16x16x32_bf16 v[174:177], a[28:31], v[162:165], v[174:177]
    s_add_u32 m0, s68, 0
    v_exp_f32 v230, v230
    v_mfma_f32_16x16x32_bf16 v[174:177], a[32:35], v[210:213], v[174:177]
    buffer_load_dwordx4 v124, s[48:51], 0 offen lds
    v_add_f32 v230, 1.0, v230
    v_mfma_f32_16x16x32_bf16 v[174:177], a[36:39], v[226:229], v[174:177]
    v_rcp_f32 v230, v230
    v_mfma_f32_16x16x32_bf16 v[182:185], a[48:51], v[234:237], 0
    v_cvt_pk_bf16_f32 v230, v230, v230
    v_and_b32 v230, 0xffff0000, v230
    v_mfma_f32_16x16x32_bf16 v[182:185], a[52:55], v[162:165], v[182:185]
    s_waitcnt lgkmcnt(5)
    v_add_f32 v230, -0.5, v230
    v_mul_f32 v230, 0x41b8aa3b, v230
    v_mfma_f32_16x16x32_bf16 v[182:185], a[56:59], v[210:213], v[182:185]
    s_waitcnt lgkmcnt(3)
    ds_write_b32 v136, v230 offset:8
    v_mfma_f32_16x16x32_bf16 v[114:117], a[16:19], v[186:189], v[114:117]
    s_waitcnt lgkmcnt(2)
    buffer_load_dwordx4 v126, s[48:51], 0 offen offset:1024 lds
    v_pk_mul_f16 v225, v119, v119
    v_mfma_f32_16x16x32_bf16 v[250:253], a[40:43], v[186:189], v[250:253]
    s_waitcnt lgkmcnt(1)
    v_cvt_pk_f16_f32 v120, v246, v247
    v_pk_fma_f16 v223, v120, v120, v223
    v_mfma_f32_16x16x32_bf16 v[192:195], a[64:67], v[186:189], v[192:195]
    v_cvt_pk_f16_f32 v121, v248, v249
    v_pk_fma_f16 v225, v121, v121, v225
    v_mfma_f32_16x16x32_bf16 v[154:157], a[16:19], v[218:221], v[154:157]
    v_cvt_pk_f16_f32 v196, v196, v197
    v_pk_fma_f16 v223, v196, v196, v223
    v_mfma_f32_16x16x32_bf16 v[174:177], a[40:43], v[218:221], v[174:177]
    v_cvt_pk_f16_f32 v197, v198, v199
    v_pk_fma_f16 v225, v197, v197, v225
    v_mfma_f32_16x16x32_bf16 v[182:185], a[60:63], v[226:229], v[182:185]
    buffer_load_dwordx4 v128, s[48:51], 0 offen offset:2048 lds
    s_add_u32 s48, s48, 36864
    v_mfma_f32_16x16x32_bf16 v[182:185], a[64:67], v[218:221], v[182:185]
    s_addc_u32 s49, s49, 0
    s_add_u32 m0, s68, 3072
    v_mfma_f32_16x16x32_bf16 v[246:249], a[0:3], v[170:173], 0
    s_waitcnt lgkmcnt(0)
    v_mfma_f32_16x16x32_bf16 v[186:189], a[24:27], v[170:173], 0
    s_barrier
    ds_read_b32 v22, v22 offset:0
    ds_read_b32 v23, v23 offset:672
    v_mfma_f32_16x16x32_bf16 v[158:161], a[48:51], v[170:173], 0
    ds_read_b32 v24, v24 offset:0
    buffer_load_dwordx4 v124, s[48:51], 0 offen lds
    ds_read_b32 v25, v25 offset:672
    ds_read_b32 v26, v26 offset:0
    ds_read_b32 v27, v27 offset:672
    ds_read_b32 v46, v46 offset:336
    ds_read_b32 v58, v58 offset:336
    ds_read_b32 v70, v70 offset:336
    ds_read_b32 v47, v47 offset:332
    ds_read_b32 v59, v59 offset:332
    ds_read_b32 v71, v71 offset:332
    ds_read_b32 v48, v48 offset:328
    ds_read_b32 v60, v60 offset:328
    buffer_load_dwordx4 v126, s[48:51], 0 offen offset:1024 lds
    ds_read_b32 v72, v72 offset:328
    ds_read_b32 v49, v49 offset:324
    ds_read_b32 v61, v61 offset:324
    ds_read_b32 v73, v73 offset:324
    s_waitcnt lgkmcnt(15)
    ds_read_b32 v50, v50 offset:272
    ds_read_b32 v62, v62 offset:272
    ds_read_b32 v74, v74 offset:272
    s_waitcnt lgkmcnt(15)
    ds_read_b32 v51, v51 offset:268
    ds_read_b32 v63, v63 offset:268
    buffer_load_dwordx4 v128, s[48:51], 0 offen offset:2048 lds
    ds_read_b32 v75, v75 offset:268
    ds_read_b32 v52, v52 offset:264
    s_add_u32 s48, s48, 36864
    ds_read_b32 v64, v64 offset:264
    s_addc_u32 s49, s49, 0
    ds_read_b32 v76, v76 offset:264
    s_add_u32 m0, s69, 0
    ds_read_b32 v53, v53 offset:260
    ds_read_b32 v65, v65 offset:260
    ds_read_b32 v77, v77 offset:260
    ds_read_b32 v54, v54 offset:208
    ds_read_b32 v66, v66 offset:208
    ds_read_b32 v78, v78 offset:208
    ds_read_b32 v55, v55 offset:204
    ds_read_b32 v67, v67 offset:204
    ds_read_b32 v79, v79 offset:204
    ds_read_b32 v56, v56 offset:200
    ds_read_b32 v68, v68 offset:200
    ds_read_b32 v80, v80 offset:200
    ds_read_b32 v57, v57 offset:196
    ds_read_b32 v69, v69 offset:196
    ds_read_b32 v81, v81 offset:196
    ds_read_b32 v130, v130 offset:336
    v_cndmask_b32 v22, v224, v22, s[88:89]
    v_cndmask_b32 v24, v224, v24, s[88:89]
    v_cndmask_b32 v26, v224, v26, s[88:89]
    s_waitcnt lgkmcnt(0)
    v_readfirstlane_b32 s39, v130
    buffer_load_dwordx4 v124, s[48:51], 0 offen lds
    buffer_load_dwordx4 v126, s[48:51], 0 offen offset:1024 lds
    buffer_load_dwordx4 v128, s[48:51], 0 offen offset:2048 lds
    s_waitcnt vmcnt(12)
    s_barrier
    ds_read_b128 v[238:241], v1 offset:26624
    s_add_u32 s48, s48, 36864
    s_addc_u32 s49, s49, 0
    s_add_u32 m0, s69, 3072
    s_waitcnt vmcnt(9)
    ds_read_b64_tr_b16 a[20:21], v134 offset:3072
    ds_read_b64_tr_b16 a[22:23], v134 offset:3840
    ds_read_b64_tr_b16 a[44:45], v134 offset:3104
    ds_read_b64_tr_b16 a[46:47], v134 offset:3872
    ds_read_b64_tr_b16 a[68:69], v134 offset:3136
    ds_read_b64_tr_b16 a[70:71], v134 offset:3904
    s_waitcnt lgkmcnt(4)
    v_mfma_f32_16x16x32_bf16 v[114:117], a[20:23], v[202:205], v[114:117]
    s_waitcnt lgkmcnt(3)
    v_mfma_f32_16x16x32_bf16 v[154:157], a[20:23], v[242:245], v[154:157]
    s_waitcnt lgkmcnt(0)
    buffer_load_dwordx4 v124, s[48:51], 0 offen lds
    v_mfma_f32_16x16x32_bf16 v[250:253], a[44:47], v[202:205], v[250:253]
    v_mfma_f32_16x16x32_bf16 v[192:195], a[68:71], v[202:205], v[192:195]
    v_mfma_f32_16x16x32_bf16 v[174:177], a[44:47], v[242:245], v[174:177]
    v_mfma_f32_16x16x32_bf16 v[182:185], a[68:71], v[242:245], v[182:185]
    ds_read_b128 v[202:205], v0 offset:26624
    s_waitcnt vmcnt(7)
    buffer_load_dwordx4 v126, s[48:51], 0 offen offset:1024 lds
    ds_read_b64_tr_b16 a[144:145], v133 offset:0
    ds_read_b64_tr_b16 a[146:147], v133 offset:768
    ds_read_b64_tr_b16 a[168:169], v133 offset:32
    ds_read_b64_tr_b16 a[170:171], v133 offset:800
    ds_read_b64_tr_b16 a[192:193], v133 offset:64
    ds_read_b64_tr_b16 a[194:195], v133 offset:832
    v_cvt_pk_f16_f32 v114, v114, v115
    v_pk_mul_f16 v214, v114, v114
    v_cvt_pk_f16_f32 v115, v116, v117
    v_pk_mul_f16 v216, v115, v115
    v_cvt_pk_f16_f32 v116, v250, v251
    v_pk_fma_f16 v214, v116, v116, v214
    v_cvt_pk_f16_f32 v117, v252, v253
    v_pk_fma_f16 v216, v117, v117, v216
    buffer_load_dwordx4 v128, s[48:51], 0 offen offset:2048 lds
    s_add_u32 s48, s48, 36864
    s_addc_u32 s49, s49, 0
    s_add_u32 m0, s68, 0
    v_cvt_pk_f16_f32 v178, v192, v193
    v_pk_fma_f16 v214, v178, v178, v214
    v_cvt_pk_f16_f32 v179, v194, v195
    v_pk_fma_f16 v216, v179, v179, v216
    v_cvt_pk_f16_f32 v206, v154, v155
    s_waitcnt lgkmcnt(6)
    v_mfma_f32_16x16x32_f16 v[250:253], v[40:43], v[214:217], 0
    v_pk_mul_f16 v222, v206, v206
    v_cvt_pk_f16_f32 v207, v156, v157
    v_mfma_f32_16x16x32_bf16 v[154:157], a[72:75], v[202:205], 0
    s_waitcnt lgkmcnt(2)
    v_pk_mul_f16 v224, v207, v207
    v_cvt_pk_f16_f32 v208, v174, v175
    v_mfma_f32_16x16x32_bf16 v[230:233], v[234:237], a[144:147], 0
    s_waitcnt lgkmcnt(0)
    buffer_load_dwordx4 v124, s[48:51], 0 offen lds
    v_min3_u32 v44, v44, v250, v251
    v_mfma_f32_16x16x32_bf16 v[154:157], a[76:79], v[238:241], v[154:157]
    v_rsq_f32 v252, v250
    v_rsq_f32 v253, v251
    v_mul_f32 v252, s31, v252
    v_cvt_pk_f16_f32 v252, v252, v253
    v_pk_mul_f16 v166, v166, v252 op_sel:[0,1] op_sel_hi:[1,1]
    s_waitcnt vmcnt(7)
    ds_read_b64_tr_b16 a[148:149], v133 offset:3072
    ds_read_b64_tr_b16 a[150:151], v133 offset:3840
    ds_read_b64_tr_b16 a[172:173], v133 offset:3104
    ds_read_b64_tr_b16 a[174:175], v133 offset:3872
    buffer_load_dwordx4 v126, s[48:51], 0 offen offset:1024 lds
    ds_read_b64_tr_b16 a[196:197], v133 offset:3136
    ds_read_b64_tr_b16 a[198:199], v133 offset:3904
    v_pk_mul_f16 v167, v167, v252 op_sel:[0,1] op_sel_hi:[1,1]
    v_pk_mul_f16 v168, v168, v252 op_sel:[0,1] op_sel_hi:[1,1]
    v_pk_mul_f16 v169, v169, v252 op_sel:[0,1] op_sel_hi:[1,1]
    v_pk_mul_f16 v180, v180, v252 op_sel:[0,1] op_sel_hi:[1,1]
    v_pk_mul_f16 v181, v181, v252 op_sel:[0,1] op_sel_hi:[1,1]
    v_pk_mul_f16 v114, v114, v252 op_sel:[0,0] op_sel_hi:[1,0]
    v_pk_mul_f16 v115, v115, v252 op_sel:[0,0] op_sel_hi:[1,0]
    v_pk_mul_f16 v116, v116, v252 op_sel:[0,0] op_sel_hi:[1,0]
    v_pk_mul_f16 v117, v117, v252 op_sel:[0,0] op_sel_hi:[1,0]
    v_pk_mul_f16 v178, v178, v252 op_sel:[0,0] op_sel_hi:[1,0]
    v_pk_mul_f16 v179, v179, v252 op_sel:[0,0] op_sel_hi:[1,0]
    v_max3_u32 v45, v45, v250, v251
    v_mfma_f32_16x16x32_f16 v[214:217], v[166:169], v[114:117], 0
    buffer_load_dwordx4 v128, s[48:51], 0 offen offset:2048 lds
    ds_write_b128 v147, v[166:169]
    v_mfma_f32_16x16x32_bf16 v[166:169], v[234:237], a[168:171], 0
    s_add_u32 s48, s48, 36864
    s_waitcnt lgkmcnt(5)
    v_pk_fma_f16 v222, v208, v208, v222
    v_cvt_pk_f16_f32 v209, v176, v177
    v_mfma_f32_16x16x16_f16 v[214:217], v[180:181], v[178:179], v[214:217]
    v_pk_fma_f16 v224, v209, v209, v224
    v_cvt_pk_f16_f32 v194, v182, v183
    v_pk_fma_f16 v222, v194, v194, v222
    v_cvt_pk_f16_f32 v195, v184, v185
    v_mfma_f32_16x16x32_bf16 v[230:233], v[162:165], a[148:151], v[230:233]
    s_waitcnt lgkmcnt(1)
    ds_write_b64 v147, v[180:181] offset:48
    v_mfma_f32_16x16x32_bf16 v[166:169], v[162:165], a[172:175], v[166:169]
    s_addc_u32 s49, s49, 0
    v_cndmask_b32 v214, v214, v215, s[96:97]
    v_cndmask_b32 v216, v216, v217, s[96:97]
    v_mfma_f32_16x16x32_bf16 v[174:177], v[234:237], a[192:195], 0
    s_add_u32 m0, s68, 3072
    s_waitcnt vmcnt(6)
    buffer_load_dwordx4 v124, s[48:51], 0 offen lds
    v_mfma_f32_16x16x32_bf16 v[174:177], v[162:165], a[196:199], v[174:177]
    ds_read_b64_tr_b16 a[152:153], v134 offset:0
    ds_read_b64_tr_b16 a[154:155], v134 offset:768
    v_mfma_f32_16x16x32_bf16 v[162:165], v[170:173], a[144:147], 0
    ds_read_b64_tr_b16 a[176:177], v134 offset:32
    ds_read_b64_tr_b16 a[178:179], v134 offset:800
    v_mfma_f32_16x16x32_bf16 v[234:237], v[170:173], a[168:171], 0
    ds_read_b64_tr_b16 a[200:201], v134 offset:64
    ds_read_b64_tr_b16 a[202:203], v134 offset:832
    v_mfma_f32_16x16x32_bf16 v[182:185], v[170:173], a[192:195], 0
    ds_read_b128 v[170:173], v145 offset:6144
    ds_write_b128 v147, v[114:117] offset:32
    v_mfma_f32_16x16x32_bf16 v[114:117], a[96:99], v[202:205], 0
    buffer_load_dwordx4 v126, s[48:51], 0 offen offset:1024 lds
    v_cndmask_b32 v214, v214, v216, s[98:99]
    v_mfma_f32_16x16x32_bf16 v[114:117], a[100:103], v[238:241], v[114:117]
    v_add_f32 v214, s39, v214
    ds_write_b32 v255, v214 offset:192
    v_mfma_f32_16x16x32_bf16 v[214:217], a[120:123], v[202:205], 0
    s_waitcnt lgkmcnt(7)
    v_pk_fma_f16 v224, v195, v195, v224
    v_mfma_f32_16x16x32_bf16 v[230:233], v[210:213], a[152:155], v[230:233]
    s_waitcnt lgkmcnt(5)
    ds_write_b64 v147, v[178:179] offset:72
    v_mfma_f32_16x16x32_bf16 v[166:169], v[210:213], a[176:179], v[166:169]
    s_waitcnt lgkmcnt(4)
    buffer_load_dwordx4 v128, s[48:51], 0 offen offset:2048 lds
    s_add_u32 m0, s69, 0
    v_mfma_f32_16x16x32_f16 v[178:181], v[40:43], v[222:225], 0
    s_waitcnt lgkmcnt(2)
    ds_read_b128 v[222:225], v144 offset:6272
    v_mfma_f32_16x16x32_bf16 v[174:177], v[210:213], a[200:203], v[174:177]
    s_waitcnt vmcnt(6)
    ds_read_b64_tr_b16 a[156:157], v134 offset:3072
    ds_read_b64_tr_b16 a[158:159], v134 offset:3840
    v_mfma_f32_16x16x32_bf16 v[246:249], a[4:7], v[170:173], v[246:249]
    ds_read_b64_tr_b16 a[180:181], v134 offset:3104
    ds_read_b64_tr_b16 a[182:183], v134 offset:3872
    v_mfma_f32_16x16x32_bf16 v[186:189], a[28:31], v[170:173], v[186:189]
    ds_read_b64_tr_b16 a[204:205], v134 offset:3136
    buffer_load_dwordx4 v151, s[52:55], 0 offen lds
    v_mfma_f32_16x16x32_bf16 v[158:161], a[52:55], v[170:173], v[158:161]
    ds_read_b64_tr_b16 a[206:207], v134 offset:3904
    ds_read_b128 v[210:213], v145 offset:6272
    v_mfma_f32_16x16x32_bf16 v[162:165], v[170:173], a[148:151], v[162:165]
    v_rsq_f32 v180, v178
    v_mfma_f32_16x16x32_bf16 v[234:237], v[170:173], a[172:175], v[234:237]
    v_rsq_f32 v181, v179
    v_mfma_f32_16x16x32_bf16 v[182:185], v[170:173], a[196:199], v[182:185]
    ds_read_b128 v[170:173], v0 offset:26752
    v_mul_f32 v180, s31, v180
    v_mfma_f32_16x16x32_bf16 v[214:217], a[124:127], v[238:241], v[214:217]
    s_waitcnt lgkmcnt(8)
    buffer_load_dwordx4 v122, s[52:55], 0 offen offset:1024 lds
    v_cvt_pk_f16_f32 v180, v180, v181
    v_mfma_f32_16x16x32_bf16 v[246:249], a[8:11], v[222:225], v[246:249]
    s_waitcnt lgkmcnt(6)
    v_pk_mul_f16 v118, v118, v180 op_sel:[0,1] op_sel_hi:[1,1]
    v_pk_mul_f16 v119, v119, v180 op_sel:[0,1] op_sel_hi:[1,1]
    v_mfma_f32_16x16x32_bf16 v[230:233], v[226:229], a[156:159], v[230:233]
    s_waitcnt lgkmcnt(4)
    v_pk_mul_f16 v120, v120, v180 op_sel:[0,1] op_sel_hi:[1,1]
    v_pk_mul_f16 v121, v121, v180 op_sel:[0,1] op_sel_hi:[1,1]
    v_mfma_f32_16x16x32_bf16 v[166:169], v[226:229], a[180:183], v[166:169]
    s_waitcnt lgkmcnt(3)
    v_pk_mul_f16 v196, v196, v180 op_sel:[0,1] op_sel_hi:[1,1]
    v_pk_mul_f16 v197, v197, v180 op_sel:[0,1] op_sel_hi:[1,1]
    v_mfma_f32_16x16x32_bf16 v[186:189], a[32:35], v[222:225], v[186:189]
    s_waitcnt lgkmcnt(1)
    v_pk_mul_f16 v206, v206, v180 op_sel:[0,0] op_sel_hi:[1,0]
    v_pk_mul_f16 v207, v207, v180 op_sel:[0,0] op_sel_hi:[1,0]
    v_mfma_f32_16x16x32_bf16 v[174:177], v[226:229], a[204:207], v[174:177]
    buffer_load_dwordx4 v125, s[52:55], 0 offen offset:2048 lds
    s_waitcnt vmcnt(6)
    v_mfma_f32_16x16x32_bf16 v[246:249], a[12:15], v[210:213], v[246:249]
    s_add_u32 s52, s52, 12288
    ds_read_b64_tr_b16 a[160:161], v133 offset:0
    ds_read_b64_tr_b16 a[162:163], v133 offset:768
    v_mfma_f32_16x16x32_bf16 v[186:189], a[36:39], v[210:213], v[186:189]
    s_waitcnt lgkmcnt(2)
    ds_read_b64_tr_b16 a[184:185], v133 offset:32
    ds_read_b64_tr_b16 a[186:187], v133 offset:800
    v_mfma_f32_16x16x32_bf16 v[158:161], a[56:59], v[222:225], v[158:161]
    s_addc_u32 s53, s53, 0
    ds_read_b64_tr_b16 a[208:209], v133 offset:64
    ds_read_b64_tr_b16 a[210:211], v133 offset:832
    v_mfma_f32_16x16x32_bf16 v[158:161], a[60:63], v[210:213], v[158:161]
    s_add_u32 m0, s69, 3072
    ds_read_b128 v[226:229], v144 offset:6400
    buffer_load_dwordx4 v151, s[52:55], 0 offen lds
    v_mfma_f32_16x16x32_bf16 v[162:165], v[222:225], a[152:155], v[162:165]
    v_pk_mul_f16 v208, v208, v180 op_sel:[0,0] op_sel_hi:[1,0]
    v_pk_mul_f16 v209, v209, v180 op_sel:[0,0] op_sel_hi:[1,0]
    v_mfma_f32_16x16x32_bf16 v[162:165], v[210:213], a[156:159], v[162:165]
    v_pk_mul_f16 v194, v194, v180 op_sel:[0,0] op_sel_hi:[1,0]
    v_pk_mul_f16 v195, v195, v180 op_sel:[0,0] op_sel_hi:[1,0]
    v_mfma_f32_16x16x32_bf16 v[234:237], v[222:225], a[176:179], v[234:237]
    v_min3_u32 v44, v44, v178, v179
    v_max3_u32 v45, v45, v178, v179
    v_mfma_f32_16x16x32_bf16 v[234:237], v[210:213], a[180:183], v[234:237]
    ds_read_b128 v[134:137], v1 offset:26752
    v_xor_b32 v255, 65536, v2
    v_mfma_f32_16x16x32_bf16 v[182:185], v[222:225], a[200:203], v[182:185]
    s_waitcnt lgkmcnt(6)
    buffer_load_dwordx4 v122, s[52:55], 0 offen offset:1024 lds
    ds_read_b128 v[222:225], v0 offset:26880
    v_mfma_f32_16x16x32_bf16 v[230:233], v[218:221], a[160:163], v[230:233]
    s_waitcnt lgkmcnt(5)
    v_lshrrev_b32 v143, 2, v255
    v_lshrrev_b32 v146, 8, v255
    v_mfma_f32_16x16x32_bf16 v[166:169], v[218:221], a[184:187], v[166:169]
    s_waitcnt lgkmcnt(3)
    v_add_u32 v255, 157184, v255
    v_lshl_add_u32 v147, s16, 2, v255
    v_mfma_f32_16x16x32_bf16 v[174:177], v[218:221], a[208:211], v[174:177]
    s_waitcnt lgkmcnt(2)
    v_add_u32 v143, 162048, v143
    v_lshlrev_b32 v146, 4, v146
    v_mfma_f32_16x16x32_bf16 v[246:249], a[16:19], v[226:229], v[246:249]
    v_add_u32 v146, 162048, v146
    v_or_b32 v218, v32, v33
    v_mfma_f32_16x16x32_bf16 v[186:189], a[40:43], v[226:229], v[186:189]
    buffer_load_dwordx4 v125, s[52:55], 0 offen offset:2048 lds
    v_and_b32 v218, 0xffff, v218
    v_mfma_f32_16x16x32_bf16 v[158:161], a[64:67], v[226:229], v[158:161]
    s_waitcnt vmcnt(6)
    ds_read_b64_tr_b16 a[164:165], v133 offset:3072
    ds_read_b64_tr_b16 a[166:167], v133 offset:3840
    v_mfma_f32_16x16x32_bf16 v[162:165], v[226:229], a[160:163], v[162:165]
    s_add_u32 s52, s52, 12288
    ds_read_b64_tr_b16 a[188:189], v133 offset:3104
    ds_read_b64_tr_b16 a[190:191], v133 offset:3872
    v_mfma_f32_16x16x32_bf16 v[234:237], v[226:229], a[184:187], v[234:237]
    s_addc_u32 s53, s53, 0
    ds_read_b64_tr_b16 a[212:213], v133 offset:3136
    ds_read_b64_tr_b16 a[214:215], v133 offset:3904
    v_mfma_f32_16x16x32_bf16 v[182:185], v[210:213], a[204:207], v[182:185]
    s_add_u32 m0, s68, 0
    ds_read_b128 v[210:213], v145 offset:6400
    buffer_load_dwordx4 v151, s[52:55], 0 offen lds
    v_mfma_f32_16x16x32_bf16 v[182:185], v[226:229], a[208:211], v[182:185]
    s_waitcnt lgkmcnt(7)
    ds_read_b128 v[226:229], v1 offset:26880
    v_lshl_or_b32 v218, v218, 16, v218
    v_mfma_f32_16x16x32_bf16 v[154:157], a[80:83], v[170:173], v[154:157]
    v_or_b32 v219, v32, v33
    v_and_b32 v219, 0xffff, v219
    v_mfma_f32_16x16x32_bf16 v[154:157], a[84:87], v[134:137], v[154:157]
    v_lshl_or_b32 v219, v219, 16, v219
    v_or_b32 v220, v32, v33
    v_mfma_f32_16x16x32_bf16 v[154:157], a[88:91], v[222:225], v[154:157]
    v_lshrrev_b32 v220, 16, v220
    v_lshl_or_b32 v220, v220, 16, v220
    v_mfma_f32_16x16x32_bf16 v[114:117], a[104:107], v[170:173], v[114:117]
    s_waitcnt lgkmcnt(6)
    buffer_load_dwordx4 v122, s[52:55], 0 offen offset:1024 lds
    v_or_b32 v221, v32, v33
    v_mfma_f32_16x16x32_bf16 v[230:233], v[242:245], a[164:167], v[230:233]
    s_waitcnt lgkmcnt(4)
    v_lshrrev_b32 v221, 16, v221
    v_lshl_or_b32 v221, v221, 16, v221
    v_mfma_f32_16x16x32_bf16 v[166:169], v[242:245], a[188:191], v[166:169]
    s_waitcnt lgkmcnt(2)
    v_xor_b32 v2, 65536, v2
    v_mfma_f32_16x16x32_bf16 v[174:177], v[242:245], a[212:215], v[174:177]
    s_waitcnt lgkmcnt(1)
    v_cvt_pk_bf16_f32 v242, v230, v231
    v_cvt_pk_bf16_f32 v243, v232, v233
    v_mfma_f32_16x16x32_bf16 v[246:249], a[20:23], v[210:213], v[246:249]
    s_waitcnt lgkmcnt(0)
    v_cvt_pk_bf16_f32 v130, v166, v167
    v_cvt_pk_bf16_f32 v131, v168, v169
    v_mfma_f32_16x16x32_bf16 v[186:189], a[44:47], v[210:213], v[186:189]
    buffer_load_dwordx4 v125, s[52:55], 0 offen offset:2048 lds
    v_cvt_pk_bf16_f32 v174, v174, v175
    v_mfma_f32_16x16x32_bf16 v[158:161], a[68:71], v[210:213], v[158:161]
    s_waitcnt vmcnt(6)
    ds_read_b64 a[216:217], v191 offset:0
    ds_read_b64 a[218:219], v191 offset:1536
    v_mfma_f32_16x16x32_bf16 v[162:165], v[210:213], a[164:167], v[162:165]
    s_add_u32 s52, s52, 12288
    ds_read_b64 a[240:241], v191 offset:8
    ds_read_b64 a[242:243], v191 offset:1544
    v_mfma_f32_16x16x32_bf16 v[234:237], v[210:213], a[188:191], v[234:237]
    s_addc_u32 s53, s53, 0
    ds_read_b64 v[90:91], v123 offset:0
    ds_read_b64 v[92:93], v123 offset:1536
    v_mfma_f32_16x16x32_bf16 v[182:185], v[210:213], a[212:215], v[182:185]
    s_add_u32 m0, s68, 3072
    v_cvt_pk_bf16_f32 v175, v176, v177
    v_cvt_pk_f16_f32 v210, v246, v247
    v_mfma_f32_16x16x32_bf16 v[154:157], a[92:95], v[226:229], v[154:157]
    buffer_load_dwordx4 v151, s[52:55], 0 offen lds
    v_pk_mul_f16 v126, v210, v210
    v_mfma_f32_16x16x32_bf16 v[114:117], a[108:111], v[134:137], v[114:117]
    v_cvt_pk_f16_f32 v211, v248, v249
    v_pk_mul_f16 v128, v211, v211
    v_mfma_f32_16x16x32_bf16 v[114:117], a[112:115], v[222:225], v[114:117]
    v_cvt_pk_f16_f32 v212, v186, v187
    v_pk_fma_f16 v126, v212, v212, v126
    v_mfma_f32_16x16x32_bf16 v[114:117], a[116:119], v[226:229], v[114:117]
    v_cvt_pk_f16_f32 v213, v188, v189
    v_pk_fma_f16 v128, v213, v213, v128
    v_mfma_f32_16x16x32_bf16 v[214:217], a[128:131], v[170:173], v[214:217]
    s_waitcnt lgkmcnt(4)
    v_cvt_pk_f16_f32 v198, v158, v159
    v_pk_fma_f16 v126, v198, v198, v126
    v_mfma_f32_16x16x32_bf16 v[214:217], a[132:135], v[134:137], v[214:217]
    s_waitcnt lgkmcnt(2)
    buffer_load_dwordx4 v122, s[52:55], 0 offen offset:1024 lds
    v_cvt_pk_f16_f32 v199, v160, v161
    v_mfma_f32_16x16x32_bf16 v[214:217], a[136:139], v[222:225], v[214:217]
    s_waitcnt lgkmcnt(0)
    v_pk_fma_f16 v128, v199, v199, v128
    v_cvt_pk_bf16_f32 v162, v162, v162
    v_mfma_f32_16x16x32_bf16 v[214:217], a[140:143], v[226:229], v[214:217]
    v_cvt_pk_bf16_f32 v163, v163, v163
    v_cvt_pk_bf16_f32 v164, v164, v164
    v_mfma_f32_16x16x32_f16 v[166:169], v[40:43], v[126:129], 0
    ds_write2_b32 v150, v162, v163 offset0:0 offset1:68
    v_mfma_f32_16x16x32_bf16 v[126:129], v[202:205], a[144:147], 0
    buffer_load_dwordx4 v125, s[52:55], 0 offen offset:2048 lds
    v_cvt_pk_bf16_f32 v165, v165, v165
    s_waitcnt vmcnt(6)
    v_mfma_f32_16x16x32_bf16 v[126:129], v[238:241], a[148:151], v[126:129]
    s_add_u32 s52, s52, 12288
    ds_read_b64 a[232:233], v191 offset:3072
    ds_read_b64 a[220:221], v191 offset:4608
    v_mfma_f32_16x16x32_bf16 v[126:129], v[170:173], a[152:155], v[126:129]
    s_addc_u32 s53, s53, 0
    ds_read_b64 v[82:83], v191 offset:3080
    ds_read_b64 a[244:245], v191 offset:4616
    v_mfma_f32_16x16x32_bf16 v[126:129], v[134:137], a[156:159], v[126:129]
    s_add_u32 m0, s69, 0
    ds_read_b64 v[106:107], v123 offset:3072
    ds_read_b64 v[94:95], v123 offset:4608
    v_mfma_f32_16x16x32_bf16 v[126:129], v[222:225], a[160:163], v[126:129]
    buffer_load_dwordx4 v151, s[52:55], 0 offen lds
    v_cvt_pk_bf16_f32 v234, v234, v234
    v_mfma_f32_16x16x32_bf16 v[126:129], v[226:229], a[164:167], v[126:129]
    ds_write2_b32 v150, v164, v165 offset0:136 offset1:204
    v_mfma_f32_16x16x32_bf16 v[162:165], v[202:205], a[168:171], 0
    v_rsq_f32 v168, v166
    v_mfma_f32_16x16x32_bf16 v[162:165], v[238:241], a[172:175], v[162:165]
    v_rsq_f32 v169, v167
    v_mfma_f32_16x16x32_bf16 v[162:165], v[170:173], a[176:179], v[162:165]
    s_waitcnt lgkmcnt(6)
    buffer_load_dwordx4 v122, s[52:55], 0 offen offset:1024 lds
    v_mul_f32 v168, s31, v168
    v_mfma_f32_16x16x32_bf16 v[162:165], v[134:137], a[180:183], v[162:165]
    s_waitcnt lgkmcnt(4)
    v_cvt_pk_f16_f32 v168, v168, v169
    v_pk_mul_f16 v138, v138, v168 op_sel:[0,1] op_sel_hi:[1,1]
    v_mfma_f32_16x16x32_bf16 v[162:165], v[222:225], a[184:187], v[162:165]
    s_waitcnt lgkmcnt(2)
    v_pk_mul_f16 v139, v139, v168 op_sel:[0,1] op_sel_hi:[1,1]
    v_pk_mul_f16 v140, v140, v168 op_sel:[0,1] op_sel_hi:[1,1]
    v_mfma_f32_16x16x32_bf16 v[162:165], v[226:229], a[188:191], v[162:165]
    s_waitcnt lgkmcnt(1)
    v_pk_mul_f16 v141, v141, v168 op_sel:[0,1] op_sel_hi:[1,1]
    v_pk_mul_f16 v200, v200, v168 op_sel:[0,1] op_sel_hi:[1,1]
    v_mfma_f32_16x16x32_bf16 v[246:249], v[202:205], a[192:195], 0
    ds_write_b128 v149, v[138:141]
    v_mfma_f32_16x16x32_bf16 v[246:249], v[238:241], a[196:199], v[246:249]
    buffer_load_dwordx4 v125, s[52:55], 0 offen offset:2048 lds
    s_waitcnt vmcnt(6)
    v_mfma_f32_16x16x32_bf16 v[246:249], v[170:173], a[200:203], v[246:249]
    s_add_u32 s52, s52, 12288
    v_pk_mul_f16 v201, v201, v168 op_sel:[0,1] op_sel_hi:[1,1]
    v_pk_mul_f16 v210, v210, v168 op_sel:[0,0] op_sel_hi:[1,0]
    v_mfma_f32_16x16x32_bf16 v[246:249], v[134:137], a[204:207], v[246:249]
    s_addc_u32 s53, s53, 0
    ds_read_b64 a[222:223], v254 offset:0
    ds_read_b64 a[234:235], v254 offset:1536
    v_mfma_f32_16x16x32_bf16 v[246:249], v[222:225], a[208:211], v[246:249]
    s_add_u32 m0, s69, 3072
    ds_read_b64 a[246:247], v254 offset:8
    ds_read_b64 v[84:85], v254 offset:1544
    v_mfma_f32_16x16x32_bf16 v[246:249], v[226:229], a[212:215], v[246:249]
    ds_read_b64 v[96:97], v190 offset:0
    buffer_load_dwordx4 v151, s[52:55], 0 offen lds
    v_mfma_f32_16x16x32_bf16 v[186:189], a[0:3], v[202:205], 0
    ds_read_b64 v[108:109], v190 offset:1536
    ds_read_b128 v[158:161], v0 offset:32768
    v_mfma_f32_16x16x32_bf16 v[186:189], a[4:7], v[238:241], v[186:189]
    ds_write_b64 v149, v[200:201] offset:48
    v_mfma_f32_16x16x32_bf16 v[186:189], a[8:11], v[170:173], v[186:189]
    v_pk_mul_f16 v211, v211, v168 op_sel:[0,0] op_sel_hi:[1,0]
    v_pk_mul_f16 v212, v212, v168 op_sel:[0,0] op_sel_hi:[1,0]
    v_mfma_f32_16x16x32_bf16 v[186:189], a[12:15], v[134:137], v[186:189]
    v_pk_mul_f16 v213, v213, v168 op_sel:[0,0] op_sel_hi:[1,0]
    v_pk_mul_f16 v198, v198, v168 op_sel:[0,0] op_sel_hi:[1,0]
    v_mfma_f32_16x16x32_bf16 v[186:189], a[16:19], v[222:225], v[186:189]
    s_waitcnt lgkmcnt(7)
    buffer_load_dwordx4 v122, s[52:55], 0 offen offset:1024 lds
    v_pk_mul_f16 v199, v199, v168 op_sel:[0,0] op_sel_hi:[1,0]
    v_mfma_f32_16x16x32_f16 v[230:233], v[138:141], v[210:213], 0
    s_waitcnt lgkmcnt(5)
    ds_read_b128 v[138:141], v1 offset:32768
    v_cndmask_b32 v166, 1.0, v166, s[94:95]
    v_mfma_f32_16x16x32_bf16 v[186:189], a[20:23], v[226:229], v[186:189]
    s_waitcnt lgkmcnt(4)
    ds_write_b128 v149, v[210:213] offset:32
    v_mfma_f32_16x16x16_f16 v[230:233], v[200:201], v[198:199], v[230:233]
    v_cndmask_b32 v167, 1.0, v167, s[94:95]
    v_min3_u32 v44, v44, v166, v167
    v_max3_u32 v45, v45, v166, v167
    v_cvt_pk_bf16_f32 v235, v235, v235
    v_mfma_f32_16x16x32_bf16 v[210:213], a[24:27], v[202:205], 0
    s_waitcnt lgkmcnt(2)
    buffer_load_dwordx4 v125, s[52:55], 0 offen offset:2048 lds
    s_waitcnt vmcnt(6)
    v_mfma_f32_16x16x32_bf16 v[210:213], a[28:31], v[238:241], v[210:213]
    s_add_u32 m0, s28, 65536
    ds_read_b64 a[224:225], v254 offset:3072
    ds_read_b64 a[226:227], v254 offset:4608
    v_mfma_f32_16x16x32_bf16 v[210:213], a[32:35], v[170:173], v[210:213]
    ds_read_b64 a[248:249], v254 offset:3080
    ds_read_b64 a[250:251], v254 offset:4616
    v_mfma_f32_16x16x32_bf16 v[210:213], a[36:39], v[134:137], v[210:213]
    ds_read_b64 v[98:99], v190 offset:3072
    ds_read_b64 v[100:101], v190 offset:4608
    v_mfma_f32_16x16x32_bf16 v[210:213], a[40:43], v[222:225], v[210:213]
    s_waitcnt lgkmcnt(7)
    ds_read_b128 v[166:169], v0 offset:32896
    v_cndmask_b32 v230, v230, v231, s[96:97]
    v_mfma_f32_16x16x32_bf16 v[210:213], a[44:47], v[226:229], v[210:213]
    buffer_load_dwordx4 v10, s[8:11], s24 offen nt lds
    v_mfma_f32_16x16x32_bf16 v[178:181], a[48:51], v[202:205], 0
    s_add_u32 m0, s28, 69632
    ds_read_b128 v[202:205], v1 offset:32896
    v_cndmask_b32 v232, v232, v233, s[96:97]
    v_mfma_f32_16x16x32_bf16 v[178:181], a[52:55], v[238:241], v[178:181]
    ds_read_b128 v[238:241], v0 offset:33024
    v_cndmask_b32 v230, v230, v232, s[98:99]
    v_mfma_f32_16x16x32_bf16 v[178:181], a[56:59], v[170:173], v[178:181]
    ds_read_b128 v[170:173], v1 offset:33024
    v_add_f32 v230, s39, v230
    v_mfma_f32_16x16x32_bf16 v[178:181], a[60:63], v[134:137], v[178:181]
    s_waitcnt lgkmcnt(8)
    ds_write_b32 v142, v230 offset:192
    v_mfma_f32_16x16x32_bf16 v[178:181], a[64:67], v[222:225], v[178:181]
    s_waitcnt lgkmcnt(7)
    buffer_load_dwordx4 v11, s[8:11], s24 offen nt lds
    v_mfma_f32_16x16x32_bf16 v[178:181], a[68:71], v[226:229], v[178:181]
    s_add_u32 m0, s28, 73728
    ds_write_b64 v149, v[198:199] offset:72
    v_mfma_f32_16x16x32_bf16 v[226:229], a[72:75], v[158:161], 0
    s_waitcnt lgkmcnt(5)
    v_cvt_pk_bf16_f32 v236, v236, v236
    v_cvt_pk_bf16_f32 v237, v237, v237
    v_mfma_f32_16x16x32_bf16 v[226:229], a[76:79], v[138:141], v[226:229]
    s_waitcnt lgkmcnt(4)
    ds_write2_b32 v150, v234, v235 offset0:16 offset1:84
    v_mfma_f32_16x16x32_bf16 v[226:229], a[80:83], v[166:169], v[226:229]
    s_waitcnt lgkmcnt(4)
    s_waitcnt vmcnt(5)
    v_cvt_pk_bf16_f32 v182, v182, v182
    v_mfma_f32_16x16x32_bf16 v[226:229], a[84:87], v[202:205], v[226:229]
    s_waitcnt lgkmcnt(3)
    buffer_load_dwordx4 v12, s[8:11], s24 offen nt lds
    v_mfma_f32_16x16x32_bf16 v[226:229], a[88:91], v[238:241], v[226:229]
    s_add_u32 m0, s28, 77824
    ds_read_b64 a[236:237], v191 offset:0
    ds_read_b64 a[228:229], v191 offset:1536
    v_mfma_f32_16x16x32_bf16 v[226:229], a[92:95], v[170:173], v[226:229]
    ds_read_b64 v[86:87], v191 offset:8
    ds_read_b64 a[252:253], v191 offset:1544
    v_mfma_f32_16x16x32_bf16 v[134:137], a[96:99], v[158:161], 0
    ds_read_b64 v[110:111], v123 offset:0
    ds_read_b64 v[102:103], v123 offset:1536
    v_mfma_f32_16x16x32_bf16 v[134:137], a[100:103], v[138:141], v[134:137]
    ds_write2_b32 v150, v236, v237 offset0:152 offset1:220
    v_mfma_f32_16x16x32_bf16 v[134:137], a[104:107], v[166:169], v[134:137]
    buffer_load_dwordx4 v13, s[8:11], s24 offen nt lds
    v_mfma_f32_16x16x32_bf16 v[134:137], a[108:111], v[202:205], v[134:137]
    s_add_u32 m0, s74, 0
    v_cvt_pk_bf16_f32 v183, v183, v183
    v_cvt_pk_bf16_f32 v184, v184, v184
    v_mfma_f32_16x16x32_bf16 v[134:137], a[112:115], v[238:241], v[134:137]
    ds_write2_b32 v150, v182, v183 offset0:32 offset1:100
    v_mfma_f32_16x16x32_bf16 v[134:137], a[116:119], v[170:173], v[134:137]
    s_waitcnt lgkmcnt(6)
    v_cvt_pk_bf16_f32 v185, v185, v185
    v_cvt_pk_f16_f32 v154, v154, v155
    v_mfma_f32_16x16x32_bf16 v[234:237], a[120:123], v[158:161], 0
    s_waitcnt lgkmcnt(4)
    buffer_load_dwordx4 v14, s[8:11], s24 offen nt lds
    v_mfma_f32_16x16x32_bf16 v[234:237], a[124:127], v[138:141], v[234:237]
    s_add_u32 s8, s40, s23
    ds_write2_b32 v150, v184, v185 offset0:168 offset1:236
    v_mfma_f32_16x16x32_bf16 v[234:237], a[128:131], v[166:169], v[234:237]
    s_addc_u32 s9, s41, 0
    v_pk_mul_f16 v183, v154, v154
    v_cvt_pk_f16_f32 v155, v156, v157
    v_mfma_f32_16x16x32_bf16 v[234:237], a[132:135], v[202:205], v[234:237]
    s_sub_u32 s10, s36, s23
    v_pk_mul_f16 v185, v155, v155
    v_cvt_pk_f16_f32 v156, v114, v115
    s_waitcnt vmcnt(5)
    v_mfma_f32_16x16x32_bf16 v[234:237], a[136:139], v[238:241], v[234:237]
    s_cmp_lt_u32 s34, s17
    ds_read_b64 a[230:231], v191 offset:3072
    ds_read_b64 a[238:239], v191 offset:4608
    v_mfma_f32_16x16x32_bf16 v[234:237], a[140:143], v[170:173], v[234:237]
    s_cselect_b32 s10, s10, 0
    ds_read_b64 a[254:255], v191 offset:3080
    ds_read_b64 v[88:89], v191 offset:4616
    v_mfma_f32_16x16x32_bf16 v[190:193], a[0:3], v[158:161], 0
    s_add_u32 m0, s28, 0
    ds_read_b64 v[104:105], v123 offset:3072
    ds_read_b64 v[112:113], v123 offset:4608
    v_mfma_f32_16x16x32_bf16 v[190:193], a[4:7], v[138:141], v[190:193]
    s_mov_b32 s24, s23
    ds_read_b128 v[122:125], v144 offset:0
    ds_read_b128 v[222:225], v145 offset:0
    v_mfma_f32_16x16x32_bf16 v[190:193], a[8:11], v[166:169], v[190:193]
    s_add_u32 s23, s23, s21
    ds_read_b128 v[198:201], v144 offset:128
    v_pk_fma_f16 v183, v156, v156, v183
    v_mfma_f32_16x16x32_bf16 v[190:193], a[12:15], v[202:205], v[190:193]
    s_cmp_ge_u32 s19, 72
    v_cvt_pk_f16_f32 v157, v116, v117
    v_pk_fma_f16 v185, v157, v157, v185
    v_mfma_f32_16x16x32_bf16 v[190:193], a[16:19], v[238:241], v[190:193]
    s_cselect_b32 s34, 72, 0
    ds_read_b128 v[114:117], v145 offset:128
    v_cvt_pk_f16_f32 v232, v214, v215
    v_mfma_f32_16x16x32_bf16 v[190:193], a[20:23], v[170:173], v[190:193]
    v_pk_fma_f16 v183, v232, v232, v183
    v_cvt_pk_f16_f32 v233, v216, v217
    v_pk_fma_f16 v185, v233, v233, v185
    v_cvt_pk_bf16_f32 v244, v126, v127
    v_cvt_pk_bf16_f32 v245, v128, v129
    v_mfma_f32_16x16x32_bf16 v[126:129], a[24:27], v[158:161], 0
    s_cselect_b32 s35, s22, 0
    v_cvt_pk_bf16_f32 v132, v162, v163
    v_cvt_pk_bf16_f32 v133, v164, v165
    v_mfma_f32_16x16x32_bf16 v[126:129], a[28:31], v[138:141], v[126:129]
    s_sub_u32 s19, s19, s34
    v_cvt_pk_bf16_f32 v176, v246, v247
    v_cvt_pk_bf16_f32 v177, v248, v249
    v_mfma_f32_16x16x32_bf16 v[126:129], a[32:35], v[166:169], v[126:129]
    s_waitcnt lgkmcnt(2)
    ds_read_b128 v[162:165], v144 offset:256
    v_cvt_pk_f16_f32 v246, v186, v187
    v_mfma_f32_16x16x32_bf16 v[126:129], a[36:39], v[202:205], v[126:129]
    s_add_u32 s23, s23, s35
    v_pk_mul_f16 v182, v246, v246
    v_cvt_pk_f16_f32 v247, v188, v189
    v_mfma_f32_16x16x32_bf16 v[126:129], a[40:43], v[238:241], v[126:129]
    s_waitcnt lgkmcnt(2)
    v_pk_mul_f16 v184, v247, v247
    v_cvt_pk_f16_f32 v248, v210, v211
    v_mfma_f32_16x16x32_bf16 v[126:129], a[44:47], v[170:173], v[126:129]
    v_pk_fma_f16 v182, v248, v248, v182
    v_cvt_pk_f16_f32 v249, v212, v213
    v_pk_fma_f16 v184, v249, v249, v184
    v_cvt_pk_f16_f32 v230, v178, v179
    v_mfma_f32_16x16x32_bf16 v[210:213], a[48:51], v[158:161], 0
    s_waitcnt lgkmcnt(1)
    ds_read_b128 v[186:189], v145 offset:256
    v_pk_fma_f16 v182, v230, v230, v182
    v_mfma_f32_16x16x32_bf16 v[210:213], a[52:55], v[138:141], v[210:213]
    v_cvt_pk_f16_f32 v231, v180, v181
    v_pk_fma_f16 v184, v231, v231, v184
    v_mfma_f32_16x16x32_bf16 v[210:213], a[56:59], v[166:169], v[210:213]
    v_cvt_pk_f16_f32 v226, v226, v227
    v_pk_mul_f16 v167, v226, v226
    v_mfma_f32_16x16x32_f16 v[138:141], v[40:43], v[182:185], 0
    s_waitcnt lgkmcnt(1)
    v_cvt_pk_f16_f32 v227, v228, v229
    v_pk_mul_f16 v169, v227, v227
    v_mfma_f32_16x16x32_bf16 v[210:213], a[60:63], v[202:205], v[210:213]
    v_cvt_pk_f16_f32 v228, v134, v135
    v_pk_fma_f16 v167, v228, v228, v167
    v_mfma_f32_16x16x32_bf16 v[210:213], a[64:67], v[238:241], v[210:213]
    ds_read_b128 v[202:205], v0 offset:32768
    v_min3_u32 v44, v44, v138, v139
    v_mfma_f32_16x16x32_bf16 v[210:213], a[68:71], v[170:173], v[210:213]
    ds_read_b128 v[170:173], v1 offset:32768
    v_max3_u32 v45, v45, v138, v139
    v_mfma_f32_16x16x32_bf16 v[182:185], v[122:125], a[144:147], 0
    ds_read_b128 v[158:161], v0 offset:32896
    v_cvt_pk_f16_f32 v229, v136, v137
    v_mfma_f32_16x16x32_bf16 v[182:185], v[222:225], a[148:151], v[182:185]
    s_waitcnt lgkmcnt(3)
    ds_read_b128 v[134:137], v1 offset:32896
    v_pk_fma_f16 v169, v229, v229, v169
    v_mfma_f32_16x16x32_bf16 v[182:185], v[198:201], a[152:155], v[182:185]
    ds_read_b128 v[238:241], v0 offset:33024
    v_cvt_pk_f16_f32 v216, v234, v235
    v_mfma_f32_16x16x32_bf16 v[182:185], v[114:117], a[156:159], v[182:185]
    v_rsq_f32 v140, v138
    v_mfma_f32_16x16x32_bf16 v[182:185], v[162:165], a[160:163], v[182:185]
    v_rsq_f32 v141, v139
    v_mfma_f32_16x16x32_bf16 v[182:185], v[186:189], a[164:167], v[182:185]
    v_mul_f32 v140, s31, v140
    v_cvt_pk_f16_f32 v140, v140, v141
    v_mfma_f32_16x16x32_bf16 v[178:181], v[122:125], a[168:171], 0
    s_waitcnt lgkmcnt(4)
    v_pk_mul_f16 v154, v154, v140 op_sel:[0,1] op_sel_hi:[1,1]
    v_pk_mul_f16 v155, v155, v140 op_sel:[0,1] op_sel_hi:[1,1]
    v_mfma_f32_16x16x32_bf16 v[178:181], v[222:225], a[172:175], v[178:181]
    s_waitcnt lgkmcnt(3)
    v_pk_mul_f16 v156, v156, v140 op_sel:[0,1] op_sel_hi:[1,1]
    v_pk_mul_f16 v157, v157, v140 op_sel:[0,1] op_sel_hi:[1,1]
    v_mfma_f32_16x16x32_bf16 v[178:181], v[198:201], a[176:179], v[178:181]
    s_waitcnt lgkmcnt(2)
    v_pk_mul_f16 v232, v232, v140 op_sel:[0,1] op_sel_hi:[1,1]
    v_pk_mul_f16 v233, v233, v140 op_sel:[0,1] op_sel_hi:[1,1]
    v_mfma_f32_16x16x32_bf16 v[178:181], v[114:117], a[180:183], v[178:181]
    s_waitcnt lgkmcnt(1)
    v_pk_mul_f16 v246, v246, v140 op_sel:[0,0] op_sel_hi:[1,0]
    v_pk_mul_f16 v247, v247, v140 op_sel:[0,0] op_sel_hi:[1,0]
    v_mfma_f32_16x16x32_bf16 v[178:181], v[162:165], a[184:187], v[178:181]
    s_waitcnt lgkmcnt(0)
    v_pk_mul_f16 v248, v248, v140 op_sel:[0,0] op_sel_hi:[1,0]
    v_pk_mul_f16 v249, v249, v140 op_sel:[0,0] op_sel_hi:[1,0]
    v_mfma_f32_16x16x32_bf16 v[178:181], v[186:189], a[188:191], v[178:181]
    v_pk_mul_f16 v230, v230, v140 op_sel:[0,0] op_sel_hi:[1,0]
    v_pk_mul_f16 v231, v231, v140 op_sel:[0,0] op_sel_hi:[1,0]
    v_pk_fma_f16 v167, v216, v216, v167
    v_cvt_pk_f16_f32 v217, v236, v237
    v_pk_fma_f16 v169, v217, v217, v169
    v_cvt_pk_f16_f32 v190, v190, v191
    v_pk_mul_f16 v166, v190, v190
    v_cvt_pk_f16_f32 v191, v192, v193
    v_pk_mul_f16 v168, v191, v191
    v_cvt_pk_f16_f32 v192, v126, v127
    v_pk_fma_f16 v166, v192, v192, v166
    v_cvt_pk_f16_f32 v193, v128, v129
    v_mfma_f32_16x16x32_bf16 v[126:129], v[122:125], a[192:195], 0
    ds_read_b128 v[122:125], v1 offset:33024
    v_pk_fma_f16 v168, v193, v193, v168
    v_mfma_f32_16x16x32_bf16 v[126:129], v[222:225], a[196:199], v[126:129]
    v_cvt_pk_f16_f32 v214, v210, v211
    v_pk_fma_f16 v166, v214, v214, v166
    v_mfma_f32_16x16x32_bf16 v[126:129], v[198:201], a[200:203], v[126:129]
    v_cvt_pk_f16_f32 v215, v212, v213
    v_pk_fma_f16 v168, v215, v215, v168
    v_mfma_f32_16x16x32_bf16 v[126:129], v[114:117], a[204:207], v[126:129]
    v_cvt_pk_bf16_f32 v182, v182, v182
    v_cvt_pk_bf16_f32 v183, v183, v183
    v_mfma_f32_16x16x32_f16 v[114:117], v[40:43], v[166:169], 0
    ds_write2_b32 v148, v182, v183 offset0:0 offset1:68
    v_mfma_f32_16x16x32_bf16 v[126:129], v[162:165], a[208:211], v[126:129]
    v_cvt_pk_bf16_f32 v184, v184, v184
    v_cvt_pk_bf16_f32 v185, v185, v185
    v_mfma_f32_16x16x32_bf16 v[126:129], v[186:189], a[212:215], v[126:129]
    ds_write2_b32 v148, v184, v185 offset0:136 offset1:204
    v_mfma_f32_16x16x32_bf16 v[162:165], v[202:205], a[144:147], 0
    s_waitcnt lgkmcnt(2)
    v_rsq_f32 v116, v114
    v_mfma_f32_16x16x32_bf16 v[162:165], v[170:173], a[148:151], v[162:165]
    v_rsq_f32 v117, v115
    v_mfma_f32_16x16x32_bf16 v[162:165], v[158:161], a[152:155], v[162:165]
    v_mul_f32 v116, s31, v116
    v_cvt_pk_f16_f32 v116, v116, v117
    v_mfma_f32_16x16x32_bf16 v[162:165], v[134:137], a[156:159], v[162:165]
    v_pk_mul_f16 v226, v226, v116 op_sel:[0,1] op_sel_hi:[1,1]
    v_pk_mul_f16 v227, v227, v116 op_sel:[0,1] op_sel_hi:[1,1]
    v_mfma_f32_16x16x32_bf16 v[162:165], v[238:241], a[160:163], v[162:165]
    v_pk_mul_f16 v228, v228, v116 op_sel:[0,1] op_sel_hi:[1,1]
    v_pk_mul_f16 v229, v229, v116 op_sel:[0,1] op_sel_hi:[1,1]
    v_mfma_f32_16x16x32_bf16 v[162:165], v[122:125], a[164:167], v[162:165]
    v_pk_mul_f16 v216, v216, v116 op_sel:[0,1] op_sel_hi:[1,1]
    v_pk_mul_f16 v217, v217, v116 op_sel:[0,1] op_sel_hi:[1,1]
    v_mfma_f32_16x16x32_bf16 v[210:213], v[202:205], a[168:171], 0
    v_pk_mul_f16 v190, v190, v116 op_sel:[0,0] op_sel_hi:[1,0]
    v_pk_mul_f16 v191, v191, v116 op_sel:[0,0] op_sel_hi:[1,0]
    v_mfma_f32_16x16x32_bf16 v[210:213], v[170:173], a[172:175], v[210:213]
    v_pk_mul_f16 v192, v192, v116 op_sel:[0,0] op_sel_hi:[1,0]
    v_pk_mul_f16 v193, v193, v116 op_sel:[0,0] op_sel_hi:[1,0]
    v_mfma_f32_16x16x32_bf16 v[210:213], v[158:161], a[176:179], v[210:213]
    v_pk_mul_f16 v214, v214, v116 op_sel:[0,0] op_sel_hi:[1,0]
    v_pk_mul_f16 v215, v215, v116 op_sel:[0,0] op_sel_hi:[1,0]
    v_mfma_f32_16x16x32_bf16 v[210:213], v[134:137], a[180:183], v[210:213]
    v_min3_u32 v44, v44, v114, v115
    v_max3_u32 v45, v45, v114, v115
    v_mfma_f32_16x16x32_bf16 v[210:213], v[238:241], a[184:187], v[210:213]
    v_cvt_pk_bf16_f32 v178, v178, v178
    v_cvt_pk_bf16_f32 v179, v179, v179
    v_mfma_f32_16x16x32_bf16 v[210:213], v[122:125], a[188:191], v[210:213]
    ds_write2_b32 v148, v178, v179 offset0:16 offset1:84
    v_mfma_f32_16x16x32_f16 v[114:117], v[118:121], v[206:209], v[46:49]
    v_cvt_pk_bf16_f32 v180, v180, v180
    v_cvt_pk_bf16_f32 v181, v181, v181
    v_mfma_f32_16x16x32_f16 v[166:169], v[154:157], v[206:209], v[50:53]
    ds_write2_b32 v148, v180, v181 offset0:152 offset1:220
    v_mfma_f32_16x16x32_f16 v[138:141], v[226:229], v[206:209], v[54:57]
    v_cvt_pk_bf16_f32 v126, v126, v126
    v_cvt_pk_bf16_f32 v127, v127, v127
    v_cvt_pk_bf16_f32 v128, v128, v128
    v_mfma_f32_16x16x16_f16 v[114:117], v[196:197], v[194:195], v[114:117]
    v_cvt_pk_bf16_f32 v129, v129, v129
    v_cvt_pk_bf16_f32 v234, v162, v163
    v_cvt_pk_bf16_f32 v235, v164, v165
    v_mfma_f32_16x16x16_f16 v[166:169], v[232:233], v[194:195], v[166:169]
    v_cvt_pk_bf16_f32 v182, v210, v211
    v_cvt_pk_bf16_f32 v183, v212, v213
    v_xor_b32 v0, 65536, v0
    v_mfma_f32_16x16x16_f16 v[138:141], v[216:217], v[194:195], v[138:141]
    v_exp_f32 v114, v114
    v_exp_f32 v115, v115
    v_mfma_f32_16x16x32_bf16 v[162:165], v[202:205], a[192:195], 0
    ds_write2_b32 v148, v126, v127 offset0:32 offset1:100
    v_mfma_f32_16x16x32_bf16 v[162:165], v[170:173], a[196:199], v[162:165]
    v_cvt_pk_bf16_f32 v114, v114, v115
    v_xor_b32 v1, 65536, v1
    v_mfma_f32_16x16x32_bf16 v[162:165], v[158:161], a[200:203], v[162:165]
    ds_write2_b32 v148, v128, v129 offset0:168 offset1:236
    v_mfma_f32_16x16x32_bf16 v[162:165], v[134:137], a[204:207], v[162:165]
    v_exp_f32 v116, v116
    v_mfma_f32_16x16x32_bf16 v[162:165], v[238:241], a[208:211], v[162:165]
    ds_read_b128 v[210:213], v5 offset:0
    ds_read_b128 v[126:129], v5 offset:16
    v_mfma_f32_16x16x32_bf16 v[162:165], v[122:125], a[212:215], v[162:165]
    ds_read_b128 v[122:125], v5 offset:48
    ds_read_b32 v254, v6 offset:192
    v_mfma_f32_16x16x32_bf16 v[170:173], v[218:221], a[216:219], 0
    ds_read2_b32 v[236:237], v6 offset0:0 offset1:0
    v_add_u32 v5, 336, v5
    v_mfma_f32_16x16x32_bf16 v[170:173], v[218:221], a[240:243], v[170:173]
    ds_read2_b32 v[184:185], v6 offset0:16 offset1:16
    v_mfma_f32_16x16x32_bf16 v[170:173], v[218:221], v[90:93], v[170:173]
    ds_read2_b32 v[204:205], v6 offset0:32 offset1:32
    v_cvt_pk_bf16_f32 v202, v162, v163
    v_mfma_f32_16x16x32_bf16 v[134:137], v[218:221], a[220:223], 0
    v_cvt_pk_bf16_f32 v203, v164, v165
    v_add_u32 v6, 272, v6
    v_mfma_f32_16x16x32_bf16 v[134:137], v[218:221], a[244:247], v[134:137]
    v_exp_f32 v117, v117
    v_mfma_f32_16x16x32_bf16 v[134:137], v[218:221], v[94:97], v[134:137]
    v_mov_b32 v148, v170
    v_mov_b32_dpp v148, v171 quad_perm:[0,1,2,3] row_mask:0x2 bank_mask:0xf
    v_mfma_f32_16x16x32_bf16 v[162:165], v[218:221], a[232:235], 0
    s_waitcnt lgkmcnt(5)
    v_exp_f32 v166, v166
    v_mfma_f32_16x16x32_f16 v[170:173], v[210:213], v[246:249], v[24:27]
    s_waitcnt lgkmcnt(3)
    v_exp_f32 v167, v167
    v_mfma_f32_16x16x32_f16 v[170:173], v[126:129], v[154:157], v[170:173]
    s_waitcnt lgkmcnt(2)
    v_mov_b32 v149, v135
    v_cvt_pk_bf16_f32 v115, v116, v117
    v_mfma_f32_16x16x32_f16 v[170:173], v[122:125], v[230:233], v[170:173]
    s_waitcnt lgkmcnt(1)
    v_exp_f32 v168, v168
    v_mfma_f32_16x16x32_f16 v[158:161], v[210:213], v[206:209], v[22:25]
    s_waitcnt lgkmcnt(0)
    v_exp_f32 v169, v169
    v_mfma_f32_16x16x32_f16 v[158:161], v[126:129], v[118:121], v[158:161]
    v_cvt_pk_bf16_f32 v116, v166, v167
    v_cvt_pk_bf16_f32 v117, v168, v169
    v_mfma_f32_16x16x32_f16 v[158:161], v[122:125], v[194:197], v[158:161]
    v_exp_f32 v138, v138
    v_mfma_f32_16x16x32_f16 v[166:169], v[210:213], v[190:193], v[26:29]
    v_exp_f32 v139, v139
    v_mfma_f32_16x16x32_f16 v[166:169], v[126:129], v[226:229], v[166:169]
    v_exp_f32 v140, v140
    v_mfma_f32_16x16x32_f16 v[166:169], v[122:125], v[214:217], v[166:169]
    v_exp_f32 v141, v141
    v_mfma_f32_16x16x32_f16 v[122:125], v[118:121], v[246:249], v[58:61]
    v_mov_b32_dpp v254, v159 quad_perm:[0,1,2,3] row_mask:0x1 bank_mask:0xf
    v_mov_b32_dpp v254, v171 quad_perm:[0,1,2,3] row_mask:0x2 bank_mask:0xf
    v_mfma_f32_16x16x32_f16 v[126:129], v[154:157], v[246:249], v[62:65]
    v_cvt_pk_bf16_f32 v36, v138, v139
    v_cvt_pk_bf16_f32 v37, v140, v141
    v_mfma_f32_16x16x32_f16 v[210:213], v[226:229], v[246:249], v[66:69]
    v_exp_f32 v158, v158
    v_mov_b32_dpp v254, v167 quad_perm:[0,1,2,3] row_mask:0x4 bank_mask:0xf
    v_mfma_f32_16x16x16_f16 v[122:125], v[196:197], v[230:231], v[122:125]
    v_cvt_pk_bf16_f32 v39, v158, 0
    v_exp_f32 v166, v166
    v_mfma_f32_16x16x16_f16 v[126:129], v[232:233], v[230:231], v[126:129]
    v_exp_f32 v254, v254
    v_mfma_f32_16x16x16_f16 v[210:213], v[216:217], v[230:231], v[210:213]
    v_cvt_pk_bf16_f32 v254, v254, v254
    v_exp_f32 v170, v170
    v_mfma_f32_16x16x32_bf16 v[138:141], v[28:31], v[36:39], 0
    ds_write_b16 v8, v254
    v_mfma_f32_16x16x32_bf16 v[138:141], v[28:31], v[114:117], v[138:141]
    v_exp_f32 v122, v122
    v_mfma_f32_16x16x32_f16 v[246:249], v[118:121], v[190:193], v[70:73]
    v_exp_f32 v123, v123
    v_mfma_f32_16x16x32_f16 v[118:121], v[154:157], v[190:193], v[74:77]
    v_exp_f32 v124, v124
    v_mfma_f32_16x16x32_f16 v[154:157], v[226:229], v[190:193], v[78:81]
    v_exp_f32 v125, v125
    v_mfma_f32_16x16x32_bf16 v[226:229], v[234:237], v[36:39], 0
    v_cvt_pk_bf16_f32 v122, v122, v123
    v_exp_f32 v126, v126
    v_mfma_f32_16x16x16_f16 v[246:249], v[196:197], v[214:215], v[246:249]
    v_cvt_pk_bf16_f32 v123, v124, v125
    v_exp_f32 v127, v127
    v_mfma_f32_16x16x16_f16 v[118:121], v[232:233], v[214:215], v[118:121]
    v_cvt_pk_bf16_f32 v124, v126, v127
    v_exp_f32 v128, v128
    v_mfma_f32_16x16x16_f16 v[154:157], v[216:217], v[214:215], v[154:157]
    v_exp_f32 v129, v129
    v_exp_f32 v210, v210
    v_mfma_f32_16x16x32_bf16 v[226:229], v[242:245], v[114:117], v[226:229]
    v_exp_f32 v246, v246
    v_mfma_f32_16x16x32_bf16 v[190:193], v[182:185], v[36:39], 0
    v_exp_f32 v247, v247
    v_mfma_f32_16x16x32_bf16 v[190:193], v[130:133], v[114:117], v[190:193]
    v_cvt_pk_bf16_f32 v246, v246, v247
    v_cvt_pk_bf16_f32 v125, v128, v129
    v_mfma_f32_16x16x32_bf16 v[126:129], v[202:205], v[36:39], 0
    v_exp_f32 v248, v248
    v_mfma_f32_16x16x32_bf16 v[126:129], v[174:177], v[114:117], v[126:129]
    v_exp_f32 v249, v249
    v_mfma_f32_16x16x32_bf16 v[162:165], v[218:221], v[82:85], v[162:165]
    v_cvt_pk_bf16_f32 v247, v248, v249
    v_cvt_pk_bf16_f32 v39, v170, 0
    v_mfma_f32_16x16x32_bf16 v[162:165], v[218:221], v[106:109], v[162:165]
    v_exp_f32 v118, v118
    v_mfma_f32_16x16x32_bf16 v[114:117], v[218:221], a[224:227], 0
    v_exp_f32 v119, v119
    v_mfma_f32_16x16x32_bf16 v[114:117], v[218:221], a[248:251], v[114:117]
    v_exp_f32 v120, v120
    v_mfma_f32_16x16x32_bf16 v[114:117], v[218:221], v[98:101], v[114:117]
    v_exp_f32 v121, v121
    v_mfma_f32_16x16x32_bf16 v[170:173], v[218:221], a[228:231], 0
    v_mov_b32_dpp v148, v162 quad_perm:[0,1,2,3] row_mask:0x4 bank_mask:0xf
    v_mov_b32_dpp v148, v134 quad_perm:[0,1,2,3] row_mask:0x8 bank_mask:0xf
    v_mfma_f32_16x16x32_bf16 v[170:173], v[218:221], a[252:255], v[170:173]
    ds_write_b32 v147, v148 offset:0
    v_mfma_f32_16x16x32_bf16 v[170:173], v[218:221], v[102:105], v[170:173]
    v_mov_b32_dpp v149, v163 quad_perm:[0,1,2,3] row_mask:0x2 bank_mask:0xf
    v_mov_b32_dpp v149, v114 quad_perm:[0,1,2,3] row_mask:0x4 bank_mask:0xf
    v_mfma_f32_16x16x32_bf16 v[162:165], v[218:221], a[236:239], 0
    v_mov_b32_dpp v149, v115 quad_perm:[0,1,2,3] row_mask:0x8 bank_mask:0xf
    v_cvt_pk_bf16_f32 v248, v118, v119
    v_mfma_f32_16x16x32_bf16 v[162:165], v[218:221], v[86:89], v[162:165]
    ds_write_b32 v147, v149 offset:1024
    v_mfma_f32_16x16x32_bf16 v[162:165], v[218:221], v[110:113], v[162:165]
    v_cvt_pk_bf16_f32 v249, v120, v121
    v_exp_f32 v154, v154
    v_exp_f32 v155, v155
    v_exp_f32 v156, v156
    v_exp_f32 v157, v157
    ds_read_b128 v[118:121], v9
    ds_read_b128 v[114:117], v9 offset:64
    v_exp_f32 v211, v211
    v_mov_b32 v254, v162
    v_mov_b32_dpp v254, v170 quad_perm:[0,1,2,3] row_mask:0x2 bank_mask:0xf
    v_mov_b32_dpp v254, v171 quad_perm:[0,1,2,3] row_mask:0x4 bank_mask:0xf
    v_mov_b32_dpp v254, v163 quad_perm:[0,1,2,3] row_mask:0x8 bank_mask:0xf
    v_cvt_pk_bf16_f32 v36, v210, v211
    v_exp_f32 v212, v212
    v_exp_f32 v213, v213
    v_rcp_f32 v138, v138
    v_cvt_pk_bf16_f32 v37, v212, v213
    v_mul_f32 v226, v138, v226
    v_mul_f32 v227, v138, v227
    v_mfma_f32_16x16x32_bf16 v[194:197], v[28:31], v[36:39], 0
    ds_write_b32 v147, v254 offset:2048
    v_mfma_f32_16x16x32_bf16 v[194:197], v[28:31], v[122:125], v[194:197]
    v_cvt_pk_bf16_f32 v134, v226, v227
    v_mul_f32 v228, v138, v228
    v_mfma_f32_16x16x32_bf16 v[206:209], v[234:237], v[36:39], 0
    v_mul_f32 v229, v138, v229
    v_cvt_pk_bf16_f32 v135, v228, v229
    v_mfma_f32_16x16x32_bf16 v[206:209], v[242:245], v[122:125], v[206:209]
    s_waitcnt lgkmcnt(1)
    v_mul_f32 v190, v138, v190
    v_mul_f32 v191, v138, v191
    v_mfma_f32_16x16x32_bf16 v[158:161], v[182:185], v[36:39], 0
    v_rcp_f32 v194, v194
    v_mfma_f32_16x16x32_bf16 v[158:161], v[130:133], v[122:125], v[158:161]
    v_cvt_pk_bf16_f32 v136, v190, v191
    v_mul_f32 v192, v138, v192
    v_mfma_f32_16x16x32_bf16 v[186:189], v[202:205], v[36:39], 0
    v_cvt_pk_bf16_f32 v36, v154, v155
    v_cvt_pk_bf16_f32 v37, v156, v157
    v_mfma_f32_16x16x32_bf16 v[186:189], v[174:177], v[122:125], v[186:189]
    v_cvt_pk_bf16_f32 v39, v166, 0
    v_mul_f32 v206, v194, v206
    v_mfma_f32_16x16x32_bf16 v[122:125], v[118:121], v[28:31], 0
    s_waitcnt lgkmcnt(0)
    v_mul_f32 v207, v194, v207
    v_cvt_pk_bf16_f32 v154, v206, v207
    v_mfma_f32_16x16x32_bf16 v[238:241], v[28:31], v[36:39], 0
    s_barrier
    s_waitcnt vmcnt(0)
    ds_read_b128 v[214:217], v255 offset:0
    v_mfma_f32_16x16x32_bf16 v[238:241], v[28:31], v[246:249], v[238:241]
    s_barrier
    ds_read_b128 v[170:173], v0 offset:20480
    ds_read_b128 v[166:169], v1 offset:20480
    v_mfma_f32_16x16x32_bf16 v[222:225], v[234:237], v[36:39], 0
    ds_read_b128 v[162:165], v0 offset:20608
    buffer_load_dwordx4 v10, s[8:11], 0 offen nt lds
    v_mfma_f32_16x16x32_bf16 v[222:225], v[242:245], v[246:249], v[222:225]
    s_add_u32 m0, s28, 4096
    ds_read_b128 v[210:213], v1 offset:20608
    v_mul_f32 v208, v194, v208
    v_mfma_f32_16x16x32_bf16 v[230:233], v[182:185], v[36:39], 0
    ds_read_b128 v[226:229], v0 offset:20736
    v_mul_f32 v209, v194, v209
    v_mfma_f32_16x16x32_bf16 v[230:233], v[130:133], v[246:249], v[230:233]
    ds_read_b128 v[218:221], v1 offset:20736
    v_cvt_pk_bf16_f32 v155, v208, v209
    v_mfma_f32_16x16x32_bf16 v[178:181], v[202:205], v[36:39], 0
    ds_read_b128 v[198:201], v255 offset:1024
    v_mul_f32 v158, v194, v158
    v_mfma_f32_16x16x32_bf16 v[178:181], v[174:177], v[246:249], v[178:181]
    buffer_load_dwordx4 v11, s[8:11], 0 offen nt lds
    ds_read_b128 v[246:249], v255 offset:2048
    v_mfma_f32_16x16x32_bf16 v[122:125], v[114:117], v[28:31], v[122:125]
    s_waitcnt lgkmcnt(8)
    v_add_f32 v214, v214, v215
    v_add_f32 v216, v216, v217
    v_mfma_f32_16x16x32_bf16 v[250:253], v[118:121], v[242:245], 0
    s_waitcnt lgkmcnt(6)
    v_add_f32 v214, v214, v216
    v_mul_f32 v214, 0xbbaaaaab, v214
    v_mfma_f32_16x16x32_bf16 v[250:253], v[114:117], v[234:237], v[250:253]
    s_add_u32 m0, s28, 8192
    ds_write_b32 v143, v214 offset:0
    v_mfma_f32_16x16x32_bf16 v[234:237], v[118:121], v[130:133], 0
    s_waitcnt lgkmcnt(5)
    v_rcp_f32 v122, v122
    v_mfma_f32_16x16x32_bf16 v[234:237], v[114:117], v[182:185], v[234:237]
    s_waitcnt lgkmcnt(4)
    buffer_load_dwordx4 v12, s[8:11], 0 offen nt lds
    ds_read_b128 v[182:185], v146 offset:0
    v_mfma_f32_16x16x32_bf16 v[242:245], v[118:121], v[174:177], 0
    s_add_u32 m0, s28, 12288
    ds_read_b128 v[118:121], v146 offset:64
    ds_read_b128 v[174:177], v146 offset:128
    v_mfma_f32_16x16x32_bf16 v[242:245], v[114:117], v[202:205], v[242:245]
    s_waitcnt lgkmcnt(5)
    ds_read_b128 v[114:117], v146 offset:192
    v_add_f32 v198, v198, v199
    v_mfma_f32_16x16x32_bf16 v[206:209], a[72:75], v[170:173], 0
    s_waitcnt lgkmcnt(5)
    v_add_f32 v200, v200, v201
    v_add_f32 v198, v198, v200
    v_mfma_f32_16x16x32_bf16 v[206:209], a[76:79], v[166:169], v[206:209]
    s_xor_b32 s28, s28, 65536
    v_mul_f32 v198, 0xbbaaaaab, v198
    v_add_f32 v246, v246, v247
    v_mfma_f32_16x16x32_bf16 v[206:209], a[80:83], v[162:165], v[206:209]
    buffer_load_dwordx4 v13, s[8:11], 0 offen nt lds
    v_add_f32 v248, v248, v249
    v_mfma_f32_16x16x32_bf16 v[206:209], a[84:87], v[210:213], v[206:209]
    s_mov_b32 m0, s29
    ds_write_b32 v143, v198 offset:256
    v_mfma_f32_16x16x32_bf16 v[206:209], a[88:91], v[226:229], v[206:209]
    s_xor_b32 s29, s29, s30
    v_add_f32 v246, v246, v248
    v_mul_f32 v246, 0xbbaaaaab, v246
    v_mfma_f32_16x16x32_bf16 v[206:209], a[92:95], v[218:221], v[206:209]
    s_waitcnt lgkmcnt(4)
    ds_write_b32 v143, v246 offset:512
    v_mul_f32 v250, v250, v122
    v_mfma_f32_16x16x16_bf16 v[246:249], a[216:217], v[152:153], v[182:185]
    v_mul_f32_dpp v250, v234, v122 quad_perm:[0,1,2,3] row_mask:0x2 bank_mask:0xf
    v_mul_f32_dpp v250, v242, v122 quad_perm:[0,1,2,3] row_mask:0x4 bank_mask:0xf
    v_cvt_pk_bf16_f32 v250, v250, v250
    v_mfma_f32_16x16x16_bf16 v[122:125], a[240:241], v[152:153], v[182:185]
    v_mul_f32 v159, v194, v159
    v_cvt_pk_bf16_f32 v156, v158, v159
    v_mul_f32 v160, v194, v160
    v_mfma_f32_16x16x16_bf16 v[202:205], v[90:91], v[152:153], v[182:185]
    v_cvt_pk_bf16_f32 v246, v246, v247
    v_accvgpr_write_b32 a216, v246
    v_cvt_pk_bf16_f32 v248, v248, v249
    v_accvgpr_write_b32 a217, v248
    v_mfma_f32_16x16x32_bf16 v[246:249], a[96:99], v[170:173], 0
    s_waitcnt lgkmcnt(2)
    buffer_load_dwordx4 v14, s[8:11], 0 offen nt lds
    ds_write_b16 v7, v250
    v_mfma_f32_16x16x16_bf16 v[182:185], a[218:219], v[152:153], v[118:121]
    v_cvt_pk_bf16_f32 v122, v122, v123
    v_accvgpr_write_b32 a240, v122
    v_cvt_pk_bf16_f32 v124, v124, v125
    v_mfma_f32_16x16x16_bf16 v[234:237], a[242:243], v[152:153], v[118:121]
    v_accvgpr_write_b32 a241, v124
    v_cvt_pk_bf16_f32 v90, v202, v203
    v_cvt_pk_bf16_f32 v91, v204, v205
    v_mfma_f32_16x16x16_bf16 v[122:125], v[92:93], v[152:153], v[118:121]
    v_cvt_pk_bf16_f32 v182, v182, v183
    v_accvgpr_write_b32 a218, v182
    v_cvt_pk_bf16_f32 v184, v184, v185
    v_mfma_f32_16x16x16_bf16 v[202:205], a[232:233], v[152:153], v[174:177]
    v_accvgpr_write_b32 a219, v184
    v_cvt_pk_bf16_f32 v234, v234, v235
    v_accvgpr_write_b32 a242, v234
    v_mfma_f32_16x16x16_bf16 v[118:121], v[82:83], v[152:153], v[174:177]
    v_cvt_pk_bf16_f32 v236, v236, v237
    v_accvgpr_write_b32 a243, v236
    v_cvt_pk_bf16_f32 v92, v122, v123
    v_mfma_f32_16x16x16_bf16 v[182:185], v[106:107], v[152:153], v[174:177]
    v_cvt_pk_bf16_f32 v93, v124, v125
    v_cvt_pk_bf16_f32 v202, v202, v203
    v_accvgpr_write_b32 a232, v202
    v_mfma_f32_16x16x16_bf16 v[122:125], a[220:221], v[152:153], v[114:117]
    v_cvt_pk_bf16_f32 v204, v204, v205
    v_accvgpr_write_b32 a233, v204
    v_cvt_pk_bf16_f32 v82, v118, v119
    v_mfma_f32_16x16x16_bf16 v[202:205], a[244:245], v[152:153], v[114:117]
    v_cvt_pk_bf16_f32 v83, v120, v121
    v_cvt_pk_bf16_f32 v106, v182, v183
    v_cvt_pk_bf16_f32 v107, v184, v185
    v_mfma_f32_16x16x16_bf16 v[118:121], v[94:95], v[152:153], v[114:117]
    v_cvt_pk_bf16_f32 v122, v122, v123
    v_accvgpr_write_b32 a220, v122
    v_cvt_pk_bf16_f32 v124, v124, v125
    v_accvgpr_write_b32 a221, v124
    v_mfma_f32_16x16x32_bf16 v[246:249], a[100:103], v[166:169], v[246:249]
    ds_read_b128 v[114:117], v146 offset:256
    ds_read_b128 v[122:125], v146 offset:320
    v_mfma_f32_16x16x32_bf16 v[246:249], a[104:107], v[162:165], v[246:249]
    ds_read_b128 v[174:177], v146 offset:384
    v_cvt_pk_bf16_f32 v202, v202, v203
    v_mfma_f32_16x16x32_bf16 v[246:249], a[108:111], v[210:213], v[246:249]
    v_accvgpr_write_b32 a244, v202
    v_cvt_pk_bf16_f32 v204, v204, v205
    v_mfma_f32_16x16x32_bf16 v[246:249], a[112:115], v[226:229], v[246:249]
    v_accvgpr_write_b32 a245, v204
    v_cvt_pk_bf16_f32 v94, v118, v119
    v_mfma_f32_16x16x32_bf16 v[246:249], a[116:119], v[218:221], v[246:249]
    v_cvt_pk_bf16_f32 v95, v120, v121
    v_mul_f32 v161, v194, v161
    v_mfma_f32_16x16x32_bf16 v[196:199], a[120:123], v[170:173], 0
    ds_read_b128 v[118:121], v146 offset:448
    v_cvt_pk_bf16_f32 v157, v160, v161
    v_mfma_f32_16x16x32_bf16 v[196:199], a[124:127], v[166:169], v[196:199]
    ds_write_b128 v3, v[154:157] offset:6144
    v_mfma_f32_16x16x32_bf16 v[196:199], a[128:131], v[162:165], v[196:199]
    s_waitcnt lgkmcnt(3)
    v_mul_f32 v186, v194, v186
    v_mul_f32 v187, v194, v187
    v_cvt_pk_bf16_f32 v150, v186, v187
    v_mfma_f32_16x16x16_bf16 v[154:157], a[222:223], v[152:153], v[114:117]
    v_mul_f32 v188, v194, v188
    v_mul_f32 v189, v194, v189
    v_cvt_pk_bf16_f32 v151, v188, v189
    v_mfma_f32_16x16x16_bf16 v[202:205], a[246:247], v[152:153], v[114:117]
    v_mul_f32 v193, v138, v193
    v_cvt_pk_bf16_f32 v137, v192, v193
    v_mul_f32 v126, v138, v126
    v_mfma_f32_16x16x16_bf16 v[190:193], v[96:97], v[152:153], v[114:117]
    v_cvt_pk_bf16_f32 v154, v154, v155
    v_accvgpr_write_b32 a222, v154
    v_cvt_pk_bf16_f32 v156, v156, v157
    v_mfma_f32_16x16x16_bf16 v[182:185], a[234:235], v[152:153], v[122:125]
    v_accvgpr_write_b32 a223, v156
    v_cvt_pk_bf16_f32 v202, v202, v203
    v_accvgpr_write_b32 a246, v202
    v_mfma_f32_16x16x16_bf16 v[114:117], v[84:85], v[152:153], v[122:125]
    v_cvt_pk_bf16_f32 v204, v204, v205
    v_accvgpr_write_b32 a247, v204
    v_cvt_pk_bf16_f32 v96, v190, v191
    v_mfma_f32_16x16x16_bf16 v[154:157], v[108:109], v[152:153], v[122:125]
    v_cvt_pk_bf16_f32 v97, v192, v193
    v_cvt_pk_bf16_f32 v182, v182, v183
    v_accvgpr_write_b32 a234, v182
    v_cvt_pk_bf16_f32 v184, v184, v185
    v_mfma_f32_16x16x32_bf16 v[196:199], a[132:135], v[210:213], v[196:199]
    s_waitcnt lgkmcnt(0)
    ds_read_b128 v[122:125], v146 offset:512
    ds_write_b128 v3, v[134:137] offset:0
    v_mfma_f32_16x16x16_bf16 v[190:193], a[224:225], v[152:153], v[174:177]
    v_accvgpr_write_b32 a235, v184
    v_cvt_pk_bf16_f32 v84, v114, v115
    v_cvt_pk_bf16_f32 v85, v116, v117
    v_mfma_f32_16x16x16_bf16 v[114:117], a[248:249], v[152:153], v[174:177]
    v_cvt_pk_bf16_f32 v108, v154, v155
    v_cvt_pk_bf16_f32 v109, v156, v157
    v_mul_f32 v127, v138, v127
    v_mfma_f32_16x16x16_bf16 v[154:157], v[98:99], v[152:153], v[174:177]
    v_cvt_pk_bf16_f32 v190, v190, v191
    v_accvgpr_write_b32 a224, v190
    v_cvt_pk_bf16_f32 v192, v192, v193
    v_mfma_f32_16x16x16_bf16 v[202:205], a[226:227], v[152:153], v[118:121]
    v_accvgpr_write_b32 a225, v192
    v_cvt_pk_bf16_f32 v114, v114, v115
    v_accvgpr_write_b32 a248, v114
    v_mfma_f32_16x16x16_bf16 v[190:193], a[250:251], v[152:153], v[118:121]
    v_cvt_pk_bf16_f32 v116, v116, v117
    v_accvgpr_write_b32 a249, v116
    v_cvt_pk_bf16_f32 v98, v154, v155
    v_mfma_f32_16x16x16_bf16 v[114:117], v[100:101], v[152:153], v[118:121]
    v_cvt_pk_bf16_f32 v99, v156, v157
    v_cvt_pk_bf16_f32 v202, v202, v203
    v_accvgpr_write_b32 a226, v202
    v_cvt_pk_bf16_f32 v204, v204, v205
    v_mfma_f32_16x16x32_bf16 v[196:199], a[136:139], v[226:229], v[196:199]
    s_waitcnt lgkmcnt(0)
    ds_read_b128 v[174:177], v146 offset:576
    ds_read_b128 v[182:185], v146 offset:640
    v_accvgpr_write_b32 a227, v204
    v_mfma_f32_16x16x16_bf16 v[118:121], a[236:237], v[152:153], v[122:125]
    v_cvt_pk_bf16_f32 v190, v190, v191
    v_accvgpr_write_b32 a250, v190
    v_cvt_pk_bf16_f32 v192, v192, v193
    v_mfma_f32_16x16x16_bf16 v[202:205], v[86:87], v[152:153], v[122:125]
    v_accvgpr_write_b32 a251, v192
    v_cvt_pk_bf16_f32 v100, v114, v115
    v_cvt_pk_bf16_f32 v101, v116, v117
    v_mfma_f32_16x16x16_bf16 v[114:117], v[110:111], v[152:153], v[122:125]
    v_cvt_pk_bf16_f32 v118, v118, v119
    v_accvgpr_write_b32 a236, v118
    v_cvt_pk_bf16_f32 v120, v120, v121
    v_accvgpr_write_b32 a237, v120
    v_mfma_f32_16x16x32_bf16 v[196:199], a[140:143], v[218:221], v[196:199]
    ds_read_b128 v[122:125], v146 offset:704
    v_cvt_pk_bf16_f32 v86, v202, v203
    v_mfma_f32_16x16x32_bf16 v[154:157], a[0:3], v[170:173], 0
    ds_write_b64 v4, v[150:151] offset:10240
    v_mfma_f32_16x16x32_bf16 v[154:157], a[4:7], v[166:169], v[154:157]
    v_cvt_pk_bf16_f32 v87, v204, v205
    v_cvt_pk_bf16_f32 v110, v114, v115
    v_mfma_f32_16x16x32_bf16 v[154:157], a[8:11], v[162:165], v[154:157]
    s_waitcnt lgkmcnt(2)
    v_cvt_pk_bf16_f32 v111, v116, v117
    v_cvt_pk_bf16_f32 v150, v126, v127
    v_mul_f32 v128, v138, v128
    v_mfma_f32_16x16x16_bf16 v[114:117], a[228:229], v[152:153], v[174:177]
    v_mul_f32 v129, v138, v129
    v_cvt_pk_bf16_f32 v151, v128, v129
    v_add_u32 v7, 16, v7
    v_mfma_f32_16x16x16_bf16 v[126:129], a[252:253], v[152:153], v[174:177]
    v_rcp_f32 v238, v238
    v_cvt_pk_f16_f32 v118, v206, v207
    v_mfma_f32_16x16x16_bf16 v[190:193], v[102:103], v[152:153], v[174:177]
    v_mul_f32 v222, v238, v222
    v_cvt_pk_bf16_f32 v114, v114, v115
    v_accvgpr_write_b32 a228, v114
    v_mfma_f32_16x16x16_bf16 v[202:205], a[230:231], v[152:153], v[182:185]
    v_cvt_pk_bf16_f32 v116, v116, v117
    v_accvgpr_write_b32 a229, v116
    v_cvt_pk_bf16_f32 v126, v126, v127
    v_mfma_f32_16x16x16_bf16 v[114:117], a[254:255], v[152:153], v[182:185]
    v_accvgpr_write_b32 a252, v126
    v_cvt_pk_bf16_f32 v128, v128, v129
    v_accvgpr_write_b32 a253, v128
    v_mfma_f32_16x16x16_bf16 v[126:129], v[104:105], v[152:153], v[182:185]
    v_cvt_pk_bf16_f32 v102, v190, v191
    v_cvt_pk_bf16_f32 v103, v192, v193
    v_cvt_pk_bf16_f32 v202, v202, v203
    v_accvgpr_write_b32 a230, v202
    v_mfma_f32_16x16x32_bf16 v[154:157], a[12:15], v[210:213], v[154:157]
    s_waitcnt lgkmcnt(0)
    ds_write_b64 v4, v[150:151] offset:4096
    v_mfma_f32_16x16x16_bf16 v[190:193], a[238:239], v[152:153], v[122:125]
    v_cvt_pk_bf16_f32 v204, v204, v205
    v_accvgpr_write_b32 a231, v204
    v_cvt_pk_bf16_f32 v114, v114, v115
    v_mfma_f32_16x16x16_bf16 v[202:205], v[88:89], v[152:153], v[122:125]
    v_accvgpr_write_b32 a254, v114
    v_cvt_pk_bf16_f32 v116, v116, v117
    v_accvgpr_write_b32 a255, v116
    v_mfma_f32_16x16x16_bf16 v[114:117], v[112:113], v[152:153], v[122:125]
    v_cvt_pk_bf16_f32 v104, v126, v127
    v_cvt_pk_bf16_f32 v105, v128, v129
    v_cvt_pk_bf16_f32 v190, v190, v191
    v_accvgpr_write_b32 a238, v190
    v_mfma_f32_16x16x32_bf16 v[154:157], a[16:19], v[226:229], v[154:157]
    v_cvt_pk_bf16_f32 v192, v192, v193
    v_accvgpr_write_b32 a239, v192
    v_mfma_f32_16x16x32_bf16 v[154:157], a[20:23], v[218:221], v[154:157]
    v_cvt_pk_bf16_f32 v88, v202, v203
    v_cvt_pk_bf16_f32 v89, v204, v205
    v_mfma_f32_16x16x32_bf16 v[174:177], a[24:27], v[170:173], 0
    v_cvt_pk_bf16_f32 v112, v114, v115
    v_cvt_pk_bf16_f32 v113, v116, v117
    v_mfma_f32_16x16x32_bf16 v[174:177], a[28:31], v[166:169], v[174:177]
    v_mul_f32 v223, v238, v223
    v_cvt_pk_bf16_f32 v114, v222, v223
    v_mfma_f32_16x16x32_bf16 v[174:177], a[32:35], v[162:165], v[174:177]
    v_mul_f32 v224, v238, v224
    v_mul_f32 v225, v238, v225
    v_mfma_f32_16x16x32_bf16 v[174:177], a[36:39], v[210:213], v[174:177]
    v_cvt_pk_bf16_f32 v115, v224, v225
    v_mul_f32 v230, v238, v230
    v_mfma_f32_16x16x32_bf16 v[174:177], a[40:43], v[226:229], v[174:177]
    v_mul_f32 v231, v238, v231
    v_cvt_pk_bf16_f32 v116, v230, v231
    v_mfma_f32_16x16x32_bf16 v[174:177], a[44:47], v[218:221], v[174:177]
    v_mul_f32 v232, v238, v232
    v_mul_f32 v233, v238, v233
    v_mfma_f32_16x16x32_bf16 v[182:185], a[48:51], v[170:173], 0
    v_cvt_pk_bf16_f32 v117, v232, v233
    v_mul_f32 v178, v238, v178
    v_mfma_f32_16x16x32_bf16 v[182:185], a[52:55], v[166:169], v[182:185]
    ds_write_b128 v3, v[114:117] offset:12288
    v_mfma_f32_16x16x32_bf16 v[182:185], a[56:59], v[162:165], v[182:185]
    v_mul_f32 v179, v238, v179
    v_cvt_pk_bf16_f32 v194, v178, v179
    v_mfma_f32_16x16x32_bf16 v[182:185], a[60:63], v[210:213], v[182:185]
    v_mul_f32 v180, v238, v180
    v_mul_f32 v181, v238, v181
    v_mfma_f32_16x16x32_bf16 v[182:185], a[64:67], v[226:229], v[182:185]
    v_cvt_pk_bf16_f32 v195, v180, v181
    v_xor_b32 v3, 65536, v3
    v_mfma_f32_16x16x32_bf16 v[182:185], a[68:71], v[218:221], v[182:185]
    ds_write_b64 v4, v[194:195] offset:16384
    v_mfma_f32_16x16x32_bf16 v[230:233], v[170:173], a[144:147], 0
    v_xor_b32 v4, 65536, v4
    v_pk_mul_f16 v223, v118, v118
    v_mfma_f32_16x16x32_bf16 v[230:233], v[166:169], a[148:151], v[230:233]
    v_cvt_pk_f16_f32 v119, v208, v209
    v_pk_mul_f16 v225, v119, v119
    v_mfma_f32_16x16x32_bf16 v[230:233], v[162:165], a[152:155], v[230:233]
    v_cvt_pk_f16_f32 v120, v246, v247
    v_pk_fma_f16 v223, v120, v120, v223
    v_mfma_f32_16x16x32_bf16 v[230:233], v[210:213], a[156:159], v[230:233]
    v_cvt_pk_f16_f32 v121, v248, v249
    v_pk_fma_f16 v225, v121, v121, v225
    v_mfma_f32_16x16x32_bf16 v[230:233], v[226:229], a[160:163], v[230:233]
    v_cvt_pk_f16_f32 v196, v196, v197
    v_pk_fma_f16 v223, v196, v196, v223
    v_mfma_f32_16x16x32_bf16 v[230:233], v[218:221], a[164:167], v[230:233]
    v_cvt_pk_f16_f32 v197, v198, v199
    v_pk_fma_f16 v225, v197, v197, v225
    v_cvt_pk_f16_f32 v206, v154, v155
    s_waitcnt lgkmcnt(0)
    s_barrier
L_go:
    s_waitcnt lgkmcnt(0)
    s_cmp_eq_u32 s16, 1
    s_cbranch_scc1 L_loop_fast1
    s_cmp_eq_u32 s16, 2
    s_cbranch_scc1 L_loop_fast2
    s_cmp_eq_u32 s16, 3
    s_cbranch_scc1 L_loop_fast3
    s_branch L_loop_fast0
.p2align 6
L_loop_fast0:
    v_mfma_f32_16x16x32_bf16 v[234:237], v[170:173], a[168:171], 0
    s_add_u32 s12, s42, s27
    ds_read_b128 v[242:245], v2 offset:18432
    ds_read_b128 v[246:249], v2 offset:19456
    v_mfma_f32_16x16x32_bf16 v[234:237], v[166:169], a[172:175], v[234:237]
    s_addc_u32 s13, s43, 0
    v_pk_mul_f16 v222, v206, v206
    v_cvt_pk_f16_f32 v207, v156, v157
    v_mfma_f32_16x16x32_bf16 v[234:237], v[162:165], a[176:179], v[234:237]
    s_sub_u32 s14, s36, s27
    v_pk_mul_f16 v224, v207, v207
    v_cvt_pk_f16_f32 v208, v174, v175
    v_mfma_f32_16x16x32_bf16 v[234:237], v[210:213], a[180:183], v[234:237]
    s_cmp_ge_u32 s18, 2
    ds_read_b128 v[134:137], v0 offset:26624
    v_pk_fma_f16 v222, v208, v208, v222
    v_mfma_f32_16x16x32_bf16 v[234:237], v[226:229], a[184:187], v[234:237]
    s_cselect_b32 s14, s14, 0
    ds_read_b128 v[154:157], v1 offset:26624
    v_cvt_pk_f16_f32 v209, v176, v177
    v_mfma_f32_16x16x32_bf16 v[234:237], v[218:221], a[188:191], v[234:237]
    s_add_u32 s34, s18, 2
    ds_read_b128 v[130:133], v0 offset:26752
    v_pk_fma_f16 v224, v209, v209, v224
    v_mfma_f32_16x16x32_bf16 v[114:117], v[170:173], a[192:195], 0
    s_add_u32 s8, s40, s23
    ds_read_b128 v[122:125], v1 offset:26752
    v_cvt_pk_f16_f32 v194, v182, v183
    v_mfma_f32_16x16x32_bf16 v[114:117], v[166:169], a[196:199], v[114:117]
    s_addc_u32 s9, s41, 0
    ds_read_b128 v[126:129], v0 offset:26880
    v_pk_fma_f16 v222, v194, v194, v222
    v_mfma_f32_16x16x32_bf16 v[114:117], v[162:165], a[200:203], v[114:117]
    s_waitcnt lgkmcnt(5)
    ds_read_b128 v[166:169], v1 offset:26880
    v_cvt_pk_f16_f32 v195, v184, v185
    v_mfma_f32_16x16x32_bf16 v[198:201], v[32:35], v[242:245], 0
    s_sub_u32 s10, s36, s23
    v_pk_fma_f16 v224, v195, v195, v224
    v_cvt_pk_bf16_f32 v174, v230, v231
    v_mfma_f32_16x16x32_bf16 v[198:201], v[32:35], v[246:249], v[198:201]
    s_cmp_lt_u32 s34, s17
    v_cvt_pk_bf16_f32 v175, v232, v233
    v_cvt_pk_bf16_f32 v182, v234, v235
    v_mfma_f32_16x16x32_f16 v[170:173], v[40:43], v[222:225], 0
    s_waitcnt lgkmcnt(5)
    v_cvt_pk_bf16_f32 v183, v236, v237
    s_cselect_b32 s10, s10, 0
    v_mfma_f32_16x16x32_bf16 v[114:117], v[210:213], a[204:207], v[114:117]
    s_add_u32 m0, s28, 0
    v_mul_f32 v255, 0x3baaaaab, v198
    v_mul_f32 v254, 0x3baaaaab, v199
    v_mfma_f32_16x16x32_bf16 v[114:117], v[226:229], a[208:211], v[114:117]
    s_mov_b32 s27, s26
    v_rsq_f32 v172, v170
    v_mfma_f32_16x16x32_bf16 v[114:117], v[218:221], a[212:215], v[114:117]
    s_mov_b32 s26, s25
    v_rsq_f32 v173, v171
    v_mfma_f32_16x16x32_bf16 v[162:165], a[72:75], v[134:137], 0
    s_waitcnt lgkmcnt(1)
    v_mul_f32 v172, s31, v172
    v_cvt_pk_f16_f32 v172, v172, v173
    v_mfma_f32_16x16x32_bf16 v[162:165], a[76:79], v[154:157], v[162:165]
    s_mov_b32 s25, s24
    v_cvt_pk_bf16_f32 v114, v114, v115
    v_cvt_pk_bf16_f32 v115, v116, v117
    v_mfma_f32_16x16x32_bf16 v[162:165], a[80:83], v[130:133], v[162:165]
    s_mov_b32 s24, s23
    v_pk_mul_f16 v118, v118, v172 op_sel:[0,1] op_sel_hi:[1,1]
    v_pk_mul_f16 v119, v119, v172 op_sel:[0,1] op_sel_hi:[1,1]
    v_mfma_f32_16x16x32_bf16 v[162:165], a[84:87], v[122:125], v[162:165]
    s_waitcnt lgkmcnt(0)
    v_pk_mul_f16 v120, v120, v172 op_sel:[0,1] op_sel_hi:[1,1]
    v_pk_mul_f16 v121, v121, v172 op_sel:[0,1] op_sel_hi:[1,1]
    v_mfma_f32_16x16x32_bf16 v[162:165], a[88:91], v[126:129], v[162:165]
    v_pk_mul_f16 v196, v196, v172 op_sel:[0,1] op_sel_hi:[1,1]
    v_pk_mul_f16 v197, v197, v172 op_sel:[0,1] op_sel_hi:[1,1]
    v_mfma_f32_16x16x32_bf16 v[162:165], a[92:95], v[166:169], v[162:165]
    v_pk_mul_f16 v206, v206, v172 op_sel:[0,0] op_sel_hi:[1,0]
    v_pk_mul_f16 v207, v207, v172 op_sel:[0,0] op_sel_hi:[1,0]
    v_mfma_f32_16x16x32_bf16 v[210:213], a[96:99], v[134:137], 0
    v_pk_mul_f16 v208, v208, v172 op_sel:[0,0] op_sel_hi:[1,0]
    v_pk_mul_f16 v209, v209, v172 op_sel:[0,0] op_sel_hi:[1,0]
    v_mfma_f32_16x16x32_bf16 v[210:213], a[100:103], v[154:157], v[210:213]
    v_pk_mul_f16 v194, v194, v172 op_sel:[0,0] op_sel_hi:[1,0]
    v_pk_mul_f16 v195, v195, v172 op_sel:[0,0] op_sel_hi:[1,0]
    v_mfma_f32_16x16x32_bf16 v[210:213], a[104:107], v[130:133], v[210:213]
    v_min3_u32 v44, v44, v170, v171
    v_max3_u32 v45, v45, v170, v171
    v_mfma_f32_16x16x32_bf16 v[210:213], a[108:111], v[122:125], v[210:213]
    v_cvt_pk_f16_f32 v170, v162, v163
    v_pk_mul_f16 v163, v170, v170
    v_mfma_f32_16x16x32_bf16 v[210:213], a[112:115], v[126:129], v[210:213]
    v_cvt_pk_f16_f32 v171, v164, v165
    v_pk_mul_f16 v165, v171, v171
    v_mfma_f32_16x16x32_bf16 v[210:213], a[116:119], v[166:169], v[210:213]
    v_rsq_f32 v255, v255
    v_mfma_f32_16x16x32_bf16 v[214:217], a[120:123], v[134:137], 0
    v_rsq_f32 v254, v254
    v_mfma_f32_16x16x32_bf16 v[214:217], a[124:127], v[154:157], v[214:217]
    v_mul_f32 v142, v254, v142
    v_mul_f32 v143, v254, v143
    v_mfma_f32_16x16x32_bf16 v[214:217], a[128:131], v[130:133], v[214:217]
    v_cvt_pk_bf16_f32 v142, v142, v143
    v_cvt_pk_f16_f32 v172, v210, v211
    v_mfma_f32_16x16x32_bf16 v[214:217], a[132:135], v[122:125], v[214:217]
    v_pk_fma_f16 v163, v172, v172, v163
    v_cvt_pk_f16_f32 v173, v212, v213
    v_mfma_f32_16x16x32_bf16 v[214:217], a[136:139], v[126:129], v[214:217]
    v_pk_fma_f16 v165, v173, v173, v165
    v_mul_f32 v144, v254, v144
    v_mfma_f32_16x16x32_bf16 v[214:217], a[140:143], v[166:169], v[214:217]
    v_mul_f32 v145, v254, v145
    v_cvt_pk_bf16_f32 v143, v144, v145
    v_mfma_f32_16x16x32_bf16 v[210:213], a[0:3], v[134:137], 0
    v_mul_f32 v158, v254, v158
    v_mul_f32 v159, v254, v159
    v_mfma_f32_16x16x32_bf16 v[210:213], a[4:7], v[154:157], v[210:213]
    v_cvt_pk_bf16_f32 v144, v158, v159
    v_mul_f32 v160, v254, v160
    v_mfma_f32_16x16x32_bf16 v[210:213], a[8:11], v[130:133], v[210:213]
    v_cvt_pk_f16_f32 v220, v214, v215
    v_pk_fma_f16 v163, v220, v220, v163
    v_mfma_f32_16x16x32_bf16 v[210:213], a[12:15], v[122:125], v[210:213]
    v_cvt_pk_f16_f32 v221, v216, v217
    v_pk_fma_f16 v165, v221, v221, v165
    v_mfma_f32_16x16x32_bf16 v[210:213], a[16:19], v[126:129], v[210:213]
    v_mul_f32 v161, v254, v161
    v_cvt_pk_bf16_f32 v145, v160, v161
    v_mfma_f32_16x16x32_bf16 v[210:213], a[20:23], v[166:169], v[210:213]
    buffer_store_dwordx4 v[142:145], v16, s[12:15], 0 offen nt
    v_mul_f32 v178, v254, v178
    v_mul_f32 v179, v254, v179
    v_cvt_pk_bf16_f32 v116, v178, v179
    v_mul_f32 v180, v254, v180
    v_mfma_f32_16x16x32_bf16 v[142:145], a[24:27], v[134:137], 0
    v_mul_f32 v181, v254, v181
    v_cvt_pk_bf16_f32 v117, v180, v181
    v_mfma_f32_16x16x32_bf16 v[142:145], a[28:31], v[154:157], v[142:145]
    v_cvt_pk_f16_f32 v158, v210, v211
    v_pk_mul_f16 v162, v158, v158
    v_mfma_f32_16x16x32_bf16 v[142:145], a[32:35], v[130:133], v[142:145]
    v_cvt_pk_f16_f32 v159, v212, v213
    v_pk_mul_f16 v164, v159, v159
    v_mfma_f32_16x16x32_bf16 v[142:145], a[36:39], v[122:125], v[142:145]
    v_mul_f32 v254, 0x3baaaaab, v200
    v_mul_f32 v150, v255, v150
    v_mfma_f32_16x16x32_bf16 v[142:145], a[40:43], v[126:129], v[142:145]
    v_rsq_f32 v254, v254
    v_mfma_f32_16x16x32_bf16 v[142:145], a[44:47], v[166:169], v[142:145]
    v_mul_f32 v151, v255, v151
    v_cvt_pk_bf16_f32 v150, v150, v151
    v_mfma_f32_16x16x32_bf16 v[178:181], a[48:51], v[134:137], 0
    v_mul_f32 v152, v255, v152
    v_mul_f32 v153, v255, v153
    v_mfma_f32_16x16x32_bf16 v[178:181], a[52:55], v[154:157], v[178:181]
    v_cvt_pk_bf16_f32 v151, v152, v153
    v_mul_f32 v190, v255, v190
    v_mfma_f32_16x16x32_bf16 v[178:181], a[56:59], v[130:133], v[178:181]
    v_cvt_pk_f16_f32 v160, v142, v143
    v_pk_fma_f16 v162, v160, v160, v162
    v_mfma_f32_16x16x32_bf16 v[178:181], a[60:63], v[122:125], v[178:181]
    v_cvt_pk_f16_f32 v161, v144, v145
    v_pk_fma_f16 v164, v161, v161, v164
    v_mfma_f32_16x16x32_bf16 v[178:181], a[64:67], v[126:129], v[178:181]
    v_mul_f32 v191, v255, v191
    v_cvt_pk_bf16_f32 v152, v190, v191
    v_mfma_f32_16x16x32_bf16 v[178:181], a[68:71], v[166:169], v[178:181]
    v_mul_f32 v192, v255, v192
    v_mul_f32 v193, v255, v193
    v_mfma_f32_16x16x32_bf16 v[142:145], v[134:137], a[144:147], 0
    v_cvt_pk_bf16_f32 v153, v192, v193
    v_mul_f32 v202, v255, v202
    v_mfma_f32_16x16x32_bf16 v[142:145], v[154:157], a[148:151], v[142:145]
    v_mul_f32 v203, v255, v203
    v_cvt_pk_bf16_f32 v202, v202, v203
    v_mfma_f32_16x16x32_bf16 v[142:145], v[130:133], a[152:155], v[142:145]
    v_cvt_pk_f16_f32 v218, v178, v179
    v_pk_fma_f16 v162, v218, v218, v162
    v_mfma_f32_16x16x32_bf16 v[142:145], v[122:125], a[156:159], v[142:145]
    v_cvt_pk_f16_f32 v219, v180, v181
    v_pk_fma_f16 v164, v219, v219, v164
    v_mfma_f32_16x16x32_bf16 v[142:145], v[126:129], a[160:163], v[142:145]
    buffer_store_dwordx2 v[116:117], v19, s[12:15], 0 offen nt
    v_mul_f32 v204, v255, v204
    v_mul_f32 v205, v255, v205
    v_mfma_f32_16x16x32_f16 v[190:193], v[40:43], v[162:165], 0
    v_cvt_pk_bf16_f32 v203, v204, v205
    v_mul_f32 v146, v254, v146
    v_mfma_f32_16x16x32_bf16 v[142:145], v[166:169], a[164:167], v[142:145]
    v_mul_f32 v147, v254, v147
    v_cvt_pk_bf16_f32 v146, v146, v147
    v_mfma_f32_16x16x32_bf16 v[178:181], v[134:137], a[168:171], 0
    v_mul_f32 v148, v254, v148
    v_mul_f32 v149, v254, v149
    v_mfma_f32_16x16x32_bf16 v[178:181], v[154:157], a[172:175], v[178:181]
    v_rsq_f32 v192, v190
    v_mfma_f32_16x16x32_bf16 v[178:181], v[130:133], a[176:179], v[178:181]
    v_cvt_pk_bf16_f32 v176, v142, v143
    v_cvt_pk_bf16_f32 v177, v144, v145
    v_mfma_f32_16x16x32_bf16 v[178:181], v[122:125], a[180:183], v[178:181]
    ds_read_b128 v[142:145], v0 offset:32768
    v_mul_f32 v192, s31, v192
    v_mfma_f32_16x16x32_bf16 v[178:181], v[126:129], a[184:187], v[178:181]
    ds_read_b128 v[162:165], v1 offset:32768
    v_min3_u32 v44, v44, v190, v191
    v_mfma_f32_16x16x32_bf16 v[178:181], v[166:169], a[188:191], v[178:181]
    ds_read_b128 v[210:213], v0 offset:32896
    v_max3_u32 v45, v45, v190, v191
    v_mfma_f32_16x16x32_bf16 v[198:201], v[134:137], a[192:195], 0
    ds_read_b128 v[134:137], v1 offset:32896
    v_cvt_pk_bf16_f32 v147, v148, v149
    v_mfma_f32_16x16x32_bf16 v[198:201], v[154:157], a[196:199], v[198:201]
    ds_read_b128 v[154:157], v0 offset:33024
    v_mul_f32 v138, v254, v138
    v_mfma_f32_16x16x32_bf16 v[198:201], v[130:133], a[200:203], v[198:201]
    ds_read_b128 v[130:133], v1 offset:33024
    v_cvt_pk_bf16_f32 v184, v178, v179
    v_mfma_f32_16x16x32_bf16 v[198:201], v[122:125], a[204:207], v[198:201]
    v_rsq_f32 v193, v191
    v_mfma_f32_16x16x32_bf16 v[198:201], v[126:129], a[208:211], v[198:201]
    v_cvt_pk_f16_f32 v192, v192, v193
    v_cvt_pk_bf16_f32 v185, v180, v181
    v_mfma_f32_16x16x32_bf16 v[198:201], v[166:169], a[212:215], v[198:201]
    s_waitcnt lgkmcnt(5)
    v_pk_mul_f16 v170, v170, v192 op_sel:[0,1] op_sel_hi:[1,1]
    v_pk_mul_f16 v171, v171, v192 op_sel:[0,1] op_sel_hi:[1,1]
    v_mfma_f32_16x16x32_bf16 v[178:181], a[72:75], v[142:145], 0
    s_waitcnt lgkmcnt(4)
    v_pk_mul_f16 v172, v172, v192 op_sel:[0,1] op_sel_hi:[1,1]
    v_pk_mul_f16 v173, v173, v192 op_sel:[0,1] op_sel_hi:[1,1]
    v_mfma_f32_16x16x32_bf16 v[178:181], a[76:79], v[162:165], v[178:181]
    s_waitcnt lgkmcnt(3)
    v_cvt_pk_bf16_f32 v116, v198, v199
    v_cvt_pk_bf16_f32 v117, v200, v201
    v_mfma_f32_16x16x32_bf16 v[178:181], a[80:83], v[210:213], v[178:181]
    s_waitcnt lgkmcnt(2)
    buffer_store_dwordx4 v[150:153], v15, s[12:15], 0 offen nt
    v_pk_mul_f16 v220, v220, v192 op_sel:[0,1] op_sel_hi:[1,1]
    v_pk_mul_f16 v221, v221, v192 op_sel:[0,1] op_sel_hi:[1,1]
    v_pk_mul_f16 v158, v158, v192 op_sel:[0,0] op_sel_hi:[1,0]
    v_pk_mul_f16 v159, v159, v192 op_sel:[0,0] op_sel_hi:[1,0]
    v_mfma_f32_16x16x32_bf16 v[178:181], a[84:87], v[134:137], v[178:181]
    s_waitcnt lgkmcnt(0)
    v_pk_mul_f16 v160, v160, v192 op_sel:[0,0] op_sel_hi:[1,0]
    v_pk_mul_f16 v161, v161, v192 op_sel:[0,0] op_sel_hi:[1,0]
    v_mfma_f32_16x16x32_bf16 v[178:181], a[88:91], v[154:157], v[178:181]
    v_pk_mul_f16 v218, v218, v192 op_sel:[0,0] op_sel_hi:[1,0]
    v_pk_mul_f16 v219, v219, v192 op_sel:[0,0] op_sel_hi:[1,0]
    v_mfma_f32_16x16x32_bf16 v[178:181], a[92:95], v[130:133], v[178:181]
    v_mul_f32 v139, v254, v139
    v_cvt_pk_bf16_f32 v148, v138, v139
    v_mfma_f32_16x16x32_bf16 v[150:153], a[96:99], v[142:145], 0
    v_mul_f32 v140, v254, v140
    v_mul_f32 v141, v254, v141
    v_mfma_f32_16x16x32_bf16 v[150:153], a[100:103], v[162:165], v[150:153]
    v_cvt_pk_bf16_f32 v149, v140, v141
    v_mul_f32 v186, v254, v186
    v_mfma_f32_16x16x32_bf16 v[150:153], a[104:107], v[210:213], v[150:153]
    v_cvt_pk_f16_f32 v178, v178, v179
    v_pk_mul_f16 v191, v178, v178
    v_mfma_f32_16x16x32_bf16 v[150:153], a[108:111], v[134:137], v[150:153]
    v_cvt_pk_f16_f32 v179, v180, v181
    v_pk_mul_f16 v193, v179, v179
    v_mfma_f32_16x16x32_bf16 v[150:153], a[112:115], v[154:157], v[150:153]
    v_mul_f32 v187, v254, v187
    v_cvt_pk_bf16_f32 v204, v186, v187
    v_mfma_f32_16x16x32_bf16 v[150:153], a[116:119], v[130:133], v[150:153]
    v_mul_f32 v188, v254, v188
    v_mul_f32 v189, v254, v189
    v_mfma_f32_16x16x32_bf16 v[138:141], a[120:123], v[142:145], 0
    s_waitcnt vmcnt(3)
    v_cvt_pk_bf16_f32 v205, v188, v189
    v_xor_b32 v0, 65536, v0
    v_mfma_f32_16x16x32_bf16 v[138:141], a[124:127], v[162:165], v[138:141]
    s_barrier
    v_mfma_f32_16x16x32_bf16 v[138:141], a[128:131], v[210:213], v[138:141]
    v_mfma_f32_16x16x32_bf16 v[138:141], a[132:135], v[134:137], v[138:141]
    v_mfma_f32_16x16x32_bf16 v[138:141], a[136:139], v[154:157], v[138:141]
    v_mfma_f32_16x16x32_bf16 v[138:141], a[140:143], v[130:133], v[138:141]
    v_cvt_pk_f16_f32 v180, v150, v151
    v_pk_fma_f16 v191, v180, v180, v191
    v_mfma_f32_16x16x32_bf16 v[186:189], a[0:3], v[142:145], 0
    v_cvt_pk_f16_f32 v181, v152, v153
    v_pk_fma_f16 v193, v181, v181, v193
    v_mfma_f32_16x16x32_bf16 v[186:189], a[4:7], v[162:165], v[186:189]
    buffer_load_dwordx4 v10, s[8:11], 0 offen nt lds
    v_xor_b32 v1, 65536, v1
    v_mfma_f32_16x16x32_bf16 v[186:189], a[8:11], v[210:213], v[186:189]
    s_add_u32 m0, s28, 4096
    v_cvt_pk_f16_f32 v124, v138, v139
    v_pk_fma_f16 v191, v124, v124, v191
    v_mfma_f32_16x16x32_bf16 v[186:189], a[12:15], v[134:137], v[186:189]
    v_cvt_pk_f16_f32 v125, v140, v141
    v_pk_fma_f16 v193, v125, v125, v193
    v_mfma_f32_16x16x32_bf16 v[186:189], a[16:19], v[154:157], v[186:189]
    v_mfma_f32_16x16x32_bf16 v[186:189], a[20:23], v[130:133], v[186:189]
    v_mfma_f32_16x16x32_bf16 v[150:153], a[24:27], v[142:145], 0
    buffer_load_dwordx4 v11, s[8:11], 0 offen nt lds
    s_add_u32 m0, s28, 8192
    v_mfma_f32_16x16x32_bf16 v[150:153], a[28:31], v[162:165], v[150:153]
    v_mfma_f32_16x16x32_bf16 v[150:153], a[32:35], v[210:213], v[150:153]
    v_mfma_f32_16x16x32_bf16 v[150:153], a[36:39], v[134:137], v[150:153]
    v_mfma_f32_16x16x32_bf16 v[150:153], a[40:43], v[154:157], v[150:153]
    v_mfma_f32_16x16x32_bf16 v[150:153], a[44:47], v[130:133], v[150:153]
    buffer_load_dwordx4 v12, s[8:11], 0 offen nt lds
    v_cvt_pk_f16_f32 v186, v186, v187
    v_mfma_f32_16x16x32_bf16 v[138:141], a[48:51], v[142:145], 0
    s_add_u32 m0, s28, 12288
    v_pk_mul_f16 v190, v186, v186
    v_cvt_pk_f16_f32 v187, v188, v189
    v_mfma_f32_16x16x32_bf16 v[138:141], a[52:55], v[162:165], v[138:141]
    s_xor_b32 s28, s28, 65536
    ds_read_b128 v[166:169], v5 offset:0
    ds_read_b128 v[126:129], v5 offset:16
    v_mfma_f32_16x16x32_bf16 v[138:141], a[56:59], v[210:213], v[138:141]
    ds_read_b128 v[198:201], v5 offset:48
    ds_read_b32 v254, v6 offset:192
    v_mfma_f32_16x16x32_bf16 v[138:141], a[60:63], v[134:137], v[138:141]
    v_pk_mul_f16 v192, v187, v187
    v_cvt_pk_f16_f32 v188, v150, v151
    v_mfma_f32_16x16x32_bf16 v[138:141], a[64:67], v[154:157], v[138:141]
    buffer_load_dwordx4 v13, s[8:11], 0 offen nt lds
    v_pk_fma_f16 v190, v188, v188, v190
    v_mfma_f32_16x16x32_bf16 v[138:141], a[68:71], v[130:133], v[138:141]
    s_mov_b32 m0, s29
    v_cvt_pk_f16_f32 v189, v152, v153
    v_pk_fma_f16 v192, v189, v189, v192
    v_mfma_f32_16x16x32_bf16 v[150:153], v[142:145], a[144:147], 0
    s_xor_b32 s29, s29, s30
    v_add_u32 v5, 336, v5
    s_add_u32 s19, s19, s20
    v_mfma_f32_16x16x32_bf16 v[150:153], v[162:165], a[148:151], v[150:153]
    s_add_u32 s23, s23, s21
    v_cvt_pk_f16_f32 v122, v138, v139
    v_pk_fma_f16 v190, v122, v122, v190
    v_mfma_f32_16x16x32_bf16 v[150:153], v[210:213], a[152:155], v[150:153]
    s_cmp_ge_u32 s19, 72
    v_cvt_pk_f16_f32 v123, v140, v141
    v_pk_fma_f16 v192, v123, v123, v192
    v_mfma_f32_16x16x32_bf16 v[150:153], v[134:137], a[156:159], v[150:153]
    s_waitcnt lgkmcnt(2)
    buffer_store_dwordx2 v[202:203], v18, s[12:15], 0 offen nt
    s_cselect_b32 s34, 72, 0
    s_cselect_b32 s35, s22, 0
    v_mfma_f32_16x16x32_f16 v[138:141], v[40:43], v[190:193], 0
    s_sub_u32 s19, s19, s34
    s_add_u32 s23, s23, s35
    s_add_u32 s18, s18, 1
    v_mfma_f32_16x16x32_f16 v[214:217], v[166:169], v[158:161], v[24:27]
    s_cmp_lt_u32 s18, s45
    v_mfma_f32_16x16x32_f16 v[214:217], v[126:129], v[170:173], v[214:217]
    s_waitcnt lgkmcnt(0)
    v_mfma_f32_16x16x32_f16 v[214:217], v[198:201], v[218:221], v[214:217]
    v_rsq_f32 v140, v138
    v_mfma_f32_16x16x32_f16 v[190:193], v[166:169], v[206:209], v[22:25]
    v_rsq_f32 v141, v139
    v_mfma_f32_16x16x32_f16 v[190:193], v[126:129], v[118:121], v[190:193]
    v_mul_f32 v140, s31, v140
    v_cvt_pk_f16_f32 v140, v140, v141
    v_mfma_f32_16x16x32_f16 v[190:193], v[198:201], v[194:197], v[190:193]
    v_pk_mul_f16 v178, v178, v140 op_sel:[0,1] op_sel_hi:[1,1]
    v_pk_mul_f16 v179, v179, v140 op_sel:[0,1] op_sel_hi:[1,1]
    v_mfma_f32_16x16x32_bf16 v[150:153], v[154:157], a[160:163], v[150:153]
    v_pk_mul_f16 v180, v180, v140 op_sel:[0,1] op_sel_hi:[1,1]
    v_pk_mul_f16 v181, v181, v140 op_sel:[0,1] op_sel_hi:[1,1]
    v_mfma_f32_16x16x32_bf16 v[150:153], v[130:133], a[164:167], v[150:153]
    v_pk_mul_f16 v124, v124, v140 op_sel:[0,1] op_sel_hi:[1,1]
    v_pk_mul_f16 v125, v125, v140 op_sel:[0,1] op_sel_hi:[1,1]
    v_mfma_f32_16x16x32_bf16 v[222:225], v[142:145], a[168:171], 0
    v_mov_b32_dpp v254, v191 quad_perm:[0,1,2,3] row_mask:0x1 bank_mask:0xf
    v_mov_b32_dpp v254, v215 quad_perm:[0,1,2,3] row_mask:0x2 bank_mask:0xf
    v_mfma_f32_16x16x32_bf16 v[222:225], v[162:165], a[172:175], v[222:225]
    v_pk_mul_f16 v186, v186, v140 op_sel:[0,0] op_sel_hi:[1,0]
    v_pk_mul_f16 v187, v187, v140 op_sel:[0,0] op_sel_hi:[1,0]
    v_mfma_f32_16x16x32_bf16 v[222:225], v[210:213], a[176:179], v[222:225]
    v_cvt_pk_bf16_f32 v226, v150, v151
    v_cvt_pk_bf16_f32 v227, v152, v153
    v_mfma_f32_16x16x32_bf16 v[222:225], v[134:137], a[180:183], v[222:225]
    v_pk_mul_f16 v188, v188, v140 op_sel:[0,0] op_sel_hi:[1,0]
    v_pk_mul_f16 v189, v189, v140 op_sel:[0,0] op_sel_hi:[1,0]
    v_mfma_f32_16x16x32_f16 v[230:233], v[118:121], v[206:209], v[46:49]
    v_pk_mul_f16 v122, v122, v140 op_sel:[0,0] op_sel_hi:[1,0]
    v_pk_mul_f16 v123, v123, v140 op_sel:[0,0] op_sel_hi:[1,0]
    v_mfma_f32_16x16x32_f16 v[234:237], v[170:173], v[206:209], v[50:53]
    v_min3_u32 v44, v44, v138, v139
    v_max3_u32 v45, v45, v138, v139
    v_mfma_f32_16x16x32_f16 v[138:141], v[178:181], v[206:209], v[54:57]
    v_exp_f32 v214, v214
    v_mfma_f32_16x16x16_f16 v[230:233], v[196:197], v[194:195], v[230:233]
    buffer_store_dwordx4 v[146:149], v17, s[12:15], 0 offen nt
    v_exp_f32 v190, v190
    v_mfma_f32_16x16x16_f16 v[234:237], v[220:221], v[194:195], v[234:237]
    v_cvt_pk_bf16_f32 v39, v190, 0
    v_mfma_f32_16x16x16_f16 v[138:141], v[124:125], v[194:195], v[138:141]
    v_mfma_f32_16x16x32_bf16 v[222:225], v[154:157], a[184:187], v[222:225]
    v_mfma_f32_16x16x32_bf16 v[222:225], v[130:133], a[188:191], v[222:225]
    ds_read_b128 v[146:149], v2 offset:0
    v_mfma_f32_16x16x32_bf16 v[150:153], v[142:145], a[192:195], 0
    ds_read_b128 v[142:145], v2 offset:1024
    v_mfma_f32_16x16x32_bf16 v[150:153], v[162:165], a[196:199], v[150:153]
    ds_read_b128 v[206:209], v2 offset:2048
    v_mfma_f32_16x16x32_bf16 v[150:153], v[210:213], a[200:203], v[150:153]
    ds_read_b128 v[162:165], v2 offset:3072
    v_mfma_f32_16x16x32_bf16 v[150:153], v[134:137], a[204:207], v[150:153]
    ds_read_b128 v[134:137], v2 offset:4096
    v_cvt_pk_bf16_f32 v210, v222, v223
    v_mfma_f32_16x16x32_bf16 v[150:153], v[154:157], a[208:211], v[150:153]
    ds_read_b128 v[154:157], v2 offset:5120
    v_cvt_pk_bf16_f32 v211, v224, v225
    v_mfma_f32_16x16x32_bf16 v[150:153], v[130:133], a[212:215], v[150:153]
    ds_read2_b32 v[228:229], v6 offset0:0 offset1:0
    ds_read2_b32 v[212:213], v6 offset0:16 offset1:16
    v_mfma_f32_16x16x32_f16 v[130:133], v[166:169], v[186:189], v[26:29]
    ds_read2_b32 v[168:169], v6 offset0:32 offset1:32
    v_add_u32 v6, 272, v6
    v_mfma_f32_16x16x32_f16 v[130:133], v[126:129], v[178:181], v[130:133]
    s_waitcnt lgkmcnt(8)
    v_exp_f32 v230, v230
    v_mfma_f32_16x16x32_f16 v[130:133], v[198:201], v[122:125], v[130:133]
    s_waitcnt lgkmcnt(7)
    v_cvt_pk_bf16_f32 v166, v150, v151
    v_cvt_pk_bf16_f32 v167, v152, v153
    v_mfma_f32_16x16x32_bf16 v[150:153], a[216:219], v[146:149], 0
    s_waitcnt lgkmcnt(6)
    v_exp_f32 v231, v231
    v_mfma_f32_16x16x32_bf16 v[150:153], a[220:223], v[142:145], v[150:153]
    s_waitcnt lgkmcnt(5)
    v_exp_f32 v130, v130
    v_mfma_f32_16x16x32_bf16 v[150:153], a[224:227], v[206:209], v[150:153]
    s_waitcnt lgkmcnt(4)
    buffer_store_dwordx2 v[204:205], v20, s[12:15], 0 offen nt
    v_mov_b32_dpp v254, v131 quad_perm:[0,1,2,3] row_mask:0x4 bank_mask:0xf
    v_cvt_pk_bf16_f32 v126, v230, v231
    v_mfma_f32_16x16x32_bf16 v[150:153], a[228:231], v[162:165], v[150:153]
    s_waitcnt lgkmcnt(3)
    v_exp_f32 v254, v254
    v_mfma_f32_16x16x32_bf16 v[150:153], a[232:235], v[134:137], v[150:153]
    s_waitcnt lgkmcnt(1)
    v_exp_f32 v232, v232
    v_mfma_f32_16x16x32_bf16 v[150:153], a[236:239], v[154:157], v[150:153]
    s_waitcnt lgkmcnt(0)
    v_exp_f32 v233, v233
    v_mfma_f32_16x16x32_bf16 v[190:193], a[240:243], v[146:149], 0
    v_cvt_pk_bf16_f32 v254, v254, v254
    v_cvt_pk_bf16_f32 v127, v232, v233
    v_mfma_f32_16x16x32_bf16 v[190:193], a[244:247], v[142:145], v[190:193]
    ds_write_b16 v8, v254
    v_mfma_f32_16x16x32_bf16 v[190:193], a[248:251], v[206:209], v[190:193]
    v_exp_f32 v234, v234
    v_mfma_f32_16x16x32_bf16 v[190:193], a[252:255], v[162:165], v[190:193]
    ds_read_b128 v[198:201], v2 offset:6144
    ds_read_b128 v[230:233], v9
    v_mfma_f32_16x16x32_bf16 v[190:193], v[82:85], v[134:137], v[190:193]
    ds_read_b128 v[222:225], v2 offset:7168
    ds_read_b128 v[238:241], v9 offset:64
    v_mfma_f32_16x16x32_bf16 v[190:193], v[86:89], v[154:157], v[190:193]
    v_exp_f32 v235, v235
    v_mfma_f32_16x16x32_bf16 v[202:205], v[90:93], v[146:149], 0
    ds_read_b128 v[146:149], v2 offset:8192
    ds_read_b128 v[242:245], v2 offset:9216
    v_mfma_f32_16x16x32_bf16 v[202:205], v[94:97], v[142:145], v[202:205]
    v_cvt_pk_bf16_f32 v128, v234, v235
    v_fma_f32 v254, v150, v150, s33
    v_mfma_f32_16x16x32_bf16 v[202:205], v[98:101], v[206:209], v[202:205]
    ds_read_b128 v[206:209], v2 offset:10240
    ds_read_b128 v[246:249], v2 offset:11264
    v_mfma_f32_16x16x32_bf16 v[202:205], v[102:105], v[162:165], v[202:205]
    v_exp_f32 v236, v236
    v_mfma_f32_16x16x32_bf16 v[202:205], v[106:109], v[134:137], v[202:205]
    v_exp_f32 v237, v237
    v_mfma_f32_16x16x32_bf16 v[202:205], v[110:113], v[154:157], v[202:205]
    s_waitcnt lgkmcnt(6)
    v_cvt_pk_bf16_f32 v129, v236, v237
    v_fmac_f32 v254, v151, v151
    v_mfma_f32_16x16x32_bf16 v[142:145], v[230:233], v[28:31], 0
    s_waitcnt lgkmcnt(4)
    v_exp_f32 v138, v138
    v_mfma_f32_16x16x32_bf16 v[142:145], v[238:241], v[28:31], v[142:145]
    buffer_load_dwordx4 v14, s[8:11], 0 offen nt lds
    v_fmac_f32 v254, v152, v152
    v_mfma_f32_16x16x32_bf16 v[134:137], v[230:233], v[174:177], 0
    s_waitcnt lgkmcnt(2)
    v_exp_f32 v139, v139
    v_mfma_f32_16x16x32_bf16 v[134:137], v[238:241], v[226:229], v[134:137]
    v_cvt_pk_bf16_f32 v36, v138, v139
    v_fmac_f32 v254, v153, v153
    v_mfma_f32_16x16x32_bf16 v[154:157], v[230:233], v[182:185], 0
    s_waitcnt lgkmcnt(0)
    v_rcp_f32 v142, v142
    v_mfma_f32_16x16x32_bf16 v[154:157], v[238:241], v[210:213], v[154:157]
    v_exp_f32 v140, v140
    v_mfma_f32_16x16x32_bf16 v[162:165], v[230:233], v[114:117], 0
    v_mul_f32 v134, v134, v142
    v_fmac_f32 v254, v190, v190
    v_mfma_f32_16x16x32_bf16 v[162:165], v[238:241], v[166:169], v[162:165]
    v_exp_f32 v141, v141
    v_mfma_f32_16x16x32_f16 v[230:233], v[118:121], v[158:161], v[58:61]
    v_cvt_pk_bf16_f32 v37, v140, v141
    v_mul_f32_dpp v134, v154, v142 quad_perm:[0,1,2,3] row_mask:0x2 bank_mask:0xf
    v_mfma_f32_16x16x32_f16 v[138:141], v[170:173], v[158:161], v[62:65]
    v_fmac_f32 v254, v191, v191
    v_fmac_f32 v254, v192, v192
    v_mfma_f32_16x16x32_f16 v[154:157], v[178:181], v[158:161], v[66:69]
    v_mul_f32_dpp v134, v162, v142 quad_perm:[0,1,2,3] row_mask:0x4 bank_mask:0xf
    v_cvt_pk_bf16_f32 v134, v134, v134
    v_fmac_f32 v254, v193, v193
    v_mfma_f32_16x16x16_f16 v[230:233], v[196:197], v[218:219], v[230:233]
    v_fmac_f32 v254, v202, v202
    v_fmac_f32 v254, v203, v203
    v_fmac_f32 v254, v204, v204
    v_mfma_f32_16x16x16_f16 v[138:141], v[220:221], v[218:219], v[138:141]
    v_fmac_f32 v254, v205, v205
    v_mfma_f32_16x16x16_f16 v[154:157], v[124:125], v[218:219], v[154:157]
    ds_write_b16 v7, v134
    v_add_u32 v7, 16, v7
    v_mfma_f32_16x16x32_bf16 v[134:137], v[28:31], v[36:39], 0
    v_exp_f32 v230, v230
    v_mfma_f32_16x16x32_bf16 v[134:137], v[28:31], v[126:129], v[134:137]
    v_exp_f32 v231, v231
    v_mfma_f32_16x16x32_bf16 v[158:161], v[226:229], v[36:39], 0
    v_exp_f32 v232, v232
    v_mfma_f32_16x16x32_bf16 v[158:161], v[174:177], v[126:129], v[158:161]
    v_exp_f32 v233, v233
    v_mfma_f32_16x16x32_bf16 v[162:165], v[210:213], v[36:39], 0
    v_cvt_pk_bf16_f32 v230, v230, v231
    v_cvt_pk_bf16_f32 v231, v232, v233
    v_mfma_f32_16x16x32_bf16 v[162:165], v[182:185], v[126:129], v[162:165]
    v_exp_f32 v138, v138
    v_mfma_f32_16x16x32_bf16 v[234:237], v[166:169], v[36:39], 0
    v_exp_f32 v139, v139
    v_mfma_f32_16x16x32_bf16 v[234:237], v[114:117], v[126:129], v[234:237]
    v_cvt_pk_bf16_f32 v232, v138, v139
    v_cvt_pk_bf16_f32 v39, v214, 0
    v_mfma_f32_16x16x32_f16 v[126:129], v[118:121], v[186:189], v[70:73]
    v_exp_f32 v140, v140
    v_mfma_f32_16x16x32_f16 v[118:121], v[170:173], v[186:189], v[74:77]
    v_exp_f32 v141, v141
    v_mfma_f32_16x16x32_bf16 v[142:145], a[216:219], v[198:201], 0
    v_exp_f32 v154, v154
    v_mfma_f32_16x16x32_bf16 v[142:145], a[220:223], v[222:225], v[142:145]
    v_cvt_pk_bf16_f32 v233, v140, v141
    v_exp_f32 v155, v155
    v_mfma_f32_16x16x32_f16 v[138:141], v[178:181], v[186:189], v[78:81]
    v_cvt_pk_bf16_f32 v36, v154, v155
    v_exp_f32 v156, v156
    v_mfma_f32_16x16x16_f16 v[126:129], v[196:197], v[122:123], v[126:129]
    v_exp_f32 v157, v157
    v_mfma_f32_16x16x16_f16 v[118:121], v[220:221], v[122:123], v[118:121]
    v_cvt_pk_bf16_f32 v37, v156, v157
    v_rcp_f32 v134, v134
    v_mfma_f32_16x16x16_f16 v[138:141], v[124:125], v[122:123], v[138:141]
    v_mul_f32 v158, v134, v158
    v_mul_f32 v159, v134, v159
    v_cvt_pk_bf16_f32 v186, v158, v159
    v_mul_f32 v160, v134, v160
    v_mfma_f32_16x16x32_bf16 v[154:157], v[28:31], v[36:39], 0
    v_exp_f32 v126, v126
    v_mfma_f32_16x16x32_bf16 v[154:157], v[28:31], v[230:233], v[154:157]
    v_exp_f32 v127, v127
    v_mfma_f32_16x16x32_bf16 v[194:197], v[226:229], v[36:39], 0
    v_cvt_pk_bf16_f32 v170, v126, v127
    v_mul_f32 v161, v134, v161
    v_mfma_f32_16x16x32_bf16 v[194:197], v[174:177], v[230:233], v[194:197]
    v_exp_f32 v128, v128
    v_mfma_f32_16x16x32_bf16 v[122:125], v[210:213], v[36:39], 0
    v_exp_f32 v129, v129
    v_mfma_f32_16x16x32_bf16 v[122:125], v[182:185], v[230:233], v[122:125]
    v_cvt_pk_bf16_f32 v171, v128, v129
    v_cvt_pk_bf16_f32 v187, v160, v161
    v_mfma_f32_16x16x32_bf16 v[126:129], v[166:169], v[36:39], 0
    ds_write_b64 v3, v[186:187] offset:0
    v_mfma_f32_16x16x32_bf16 v[126:129], v[114:117], v[230:233], v[126:129]
    v_exp_f32 v118, v118
    v_mfma_f32_16x16x32_bf16 v[142:145], a[224:227], v[146:149], v[142:145]
    v_exp_f32 v119, v119
    v_mfma_f32_16x16x32_bf16 v[142:145], a[228:231], v[242:245], v[142:145]
    v_cvt_pk_bf16_f32 v172, v118, v119
    v_cvt_pk_bf16_f32 v39, v130, 0
    v_mfma_f32_16x16x32_bf16 v[142:145], a[232:235], v[206:209], v[142:145]
    v_exp_f32 v120, v120
    v_mfma_f32_16x16x32_bf16 v[142:145], a[236:239], v[246:249], v[142:145]
    v_exp_f32 v121, v121
    v_mfma_f32_16x16x32_bf16 v[158:161], a[240:243], v[198:201], 0
    v_cvt_pk_bf16_f32 v173, v120, v121
    v_mul_f32 v162, v134, v162
    v_mfma_f32_16x16x32_bf16 v[158:161], a[244:247], v[222:225], v[158:161]
    v_exp_f32 v138, v138
    v_mfma_f32_16x16x32_bf16 v[158:161], a[248:251], v[146:149], v[158:161]
    v_exp_f32 v139, v139
    v_mfma_f32_16x16x32_bf16 v[158:161], a[252:255], v[242:245], v[158:161]
    ds_read_b128 v[118:121], v2 offset:12288
    v_cvt_pk_bf16_f32 v36, v138, v139
    v_mfma_f32_16x16x32_bf16 v[158:161], v[82:85], v[206:209], v[158:161]
    ds_read_b128 v[130:133], v2 offset:13312
    v_fma_f32 v255, v142, v142, s33
    v_mfma_f32_16x16x32_bf16 v[158:161], v[86:89], v[246:249], v[158:161]
    ds_read_b128 v[218:221], v2 offset:14336
    v_fmac_f32 v255, v143, v143
    v_mfma_f32_16x16x32_bf16 v[178:181], v[90:93], v[198:201], 0
    ds_read_b128 v[198:201], v2 offset:15360
    v_fmac_f32 v255, v144, v144
    v_mfma_f32_16x16x32_bf16 v[178:181], v[94:97], v[222:225], v[178:181]
    ds_read_b128 v[222:225], v2 offset:16384
    v_fmac_f32 v255, v145, v145
    v_mfma_f32_16x16x32_bf16 v[178:181], v[98:101], v[146:149], v[178:181]
    ds_read_b128 v[230:233], v2 offset:17408
    v_fmac_f32 v255, v158, v158
    v_mfma_f32_16x16x32_bf16 v[178:181], v[102:105], v[242:245], v[178:181]
    v_exp_f32 v140, v140
    v_mfma_f32_16x16x32_bf16 v[178:181], v[106:109], v[206:209], v[178:181]
    v_exp_f32 v141, v141
    v_mfma_f32_16x16x32_bf16 v[178:181], v[110:113], v[246:249], v[178:181]
    s_waitcnt lgkmcnt(5)
    v_cvt_pk_bf16_f32 v37, v140, v141
    v_fmac_f32 v255, v159, v159
    v_mfma_f32_16x16x32_bf16 v[146:149], a[216:219], v[118:121], 0
    s_waitcnt lgkmcnt(4)
    v_fmac_f32 v255, v160, v160
    v_fmac_f32 v255, v161, v161
    v_mfma_f32_16x16x32_bf16 v[242:245], v[28:31], v[36:39], 0
    s_waitcnt lgkmcnt(3)
    v_fmac_f32 v255, v178, v178
    v_fmac_f32 v255, v179, v179
    v_mfma_f32_16x16x32_bf16 v[242:245], v[28:31], v[170:173], v[242:245]
    s_waitcnt lgkmcnt(2)
    v_fmac_f32 v255, v180, v180
    v_fmac_f32 v255, v181, v181
    v_mfma_f32_16x16x32_bf16 v[206:209], v[226:229], v[36:39], 0
    s_waitcnt lgkmcnt(1)
    v_cvt_pk_bf16_f32 v254, v254, v255
    v_mul_f32 v163, v134, v163
    v_mfma_f32_16x16x32_bf16 v[206:209], v[174:177], v[170:173], v[206:209]
    s_waitcnt lgkmcnt(0)
    v_cvt_pk_bf16_f32 v188, v162, v163
    v_mul_f32 v164, v134, v164
    v_mfma_f32_16x16x32_bf16 v[174:177], v[210:213], v[36:39], 0
    v_mul_f32 v165, v134, v165
    v_cvt_pk_bf16_f32 v189, v164, v165
    v_mfma_f32_16x16x32_bf16 v[174:177], v[182:185], v[170:173], v[174:177]
    ds_write_b64 v3, v[188:189] offset:8
    v_mfma_f32_16x16x32_bf16 v[182:185], v[166:169], v[36:39], 0
    v_mul_f32 v234, v134, v234
    v_mul_f32 v235, v134, v235
    v_mfma_f32_16x16x32_bf16 v[182:185], v[114:117], v[170:173], v[182:185]
    v_cvt_pk_bf16_f32 v234, v234, v235
    v_mul_f32 v236, v134, v236
    v_mfma_f32_16x16x32_bf16 v[146:149], a[220:223], v[130:133], v[146:149]
    v_mul_f32 v237, v134, v237
    v_cvt_pk_bf16_f32 v235, v236, v237
    v_mfma_f32_16x16x32_bf16 v[146:149], a[224:227], v[218:221], v[146:149]
    ds_write_b64 v4, v[234:235] offset:4096
    v_mfma_f32_16x16x32_bf16 v[146:149], a[228:231], v[198:201], v[146:149]
    v_rcp_f32 v154, v154
    v_mfma_f32_16x16x32_bf16 v[146:149], a[232:235], v[222:225], v[146:149]
    v_mul_f32 v194, v154, v194
    v_mul_f32 v195, v154, v195
    v_mfma_f32_16x16x32_bf16 v[146:149], a[236:239], v[230:233], v[146:149]
    v_cvt_pk_bf16_f32 v194, v194, v195
    v_mul_f32 v196, v154, v196
    v_mfma_f32_16x16x32_bf16 v[138:141], a[240:243], v[118:121], 0
    v_mul_f32 v197, v154, v197
    v_cvt_pk_bf16_f32 v195, v196, v197
    v_mfma_f32_16x16x32_bf16 v[138:141], a[244:247], v[130:133], v[138:141]
    ds_write_b64 v3, v[194:195] offset:6144
    v_mfma_f32_16x16x32_bf16 v[138:141], a[248:251], v[218:221], v[138:141]
    v_fma_f32 v255, v146, v146, s33
    v_fmac_f32 v255, v147, v147
    v_mfma_f32_16x16x32_bf16 v[138:141], a[252:255], v[198:201], v[138:141]
    ds_read_b128 v[170:173], v0 offset:20480
    v_fmac_f32 v255, v148, v148
    v_mfma_f32_16x16x32_bf16 v[138:141], v[82:85], v[222:225], v[138:141]
    ds_read_b128 v[166:169], v1 offset:20480
    v_fmac_f32 v255, v149, v149
    v_mfma_f32_16x16x32_bf16 v[138:141], v[86:89], v[230:233], v[138:141]
    ds_read_b128 v[162:165], v0 offset:20608
    v_mul_f32 v122, v154, v122
    v_mfma_f32_16x16x32_bf16 v[186:189], v[90:93], v[118:121], 0
    ds_read_b128 v[210:213], v1 offset:20608
    v_mul_f32 v123, v154, v123
    v_mfma_f32_16x16x32_bf16 v[186:189], v[94:97], v[130:133], v[186:189]
    ds_read_b128 v[226:229], v0 offset:20736
    v_cvt_pk_bf16_f32 v196, v122, v123
    v_mfma_f32_16x16x32_bf16 v[186:189], v[98:101], v[218:221], v[186:189]
    ds_read_b128 v[218:221], v1 offset:20736
    v_fmac_f32 v255, v138, v138
    v_mfma_f32_16x16x32_bf16 v[186:189], v[102:105], v[198:201], v[186:189]
    v_fmac_f32 v255, v139, v139
    v_fmac_f32 v255, v140, v140
    v_mfma_f32_16x16x32_bf16 v[186:189], v[106:109], v[222:225], v[186:189]
    v_fmac_f32 v255, v141, v141
    v_mul_f32 v124, v154, v124
    v_mfma_f32_16x16x32_bf16 v[186:189], v[110:113], v[230:233], v[186:189]
    s_waitcnt lgkmcnt(5)
    v_mul_f32 v125, v154, v125
    v_cvt_pk_bf16_f32 v197, v124, v125
    v_mfma_f32_16x16x32_bf16 v[118:121], a[72:75], v[170:173], 0
    s_waitcnt lgkmcnt(4)
    ds_write_b64 v3, v[196:197] offset:6152
    v_mfma_f32_16x16x32_bf16 v[118:121], a[76:79], v[166:169], v[118:121]
    s_waitcnt lgkmcnt(4)
    v_fmac_f32 v255, v186, v186
    v_fmac_f32 v255, v187, v187
    v_mfma_f32_16x16x32_bf16 v[118:121], a[80:83], v[162:165], v[118:121]
    s_waitcnt lgkmcnt(3)
    v_fmac_f32 v255, v188, v188
    v_fmac_f32 v255, v189, v189
    v_mfma_f32_16x16x32_bf16 v[118:121], a[84:87], v[210:213], v[118:121]
    s_waitcnt lgkmcnt(2)
    v_cvt_pk_bf16_f32 v255, v255, v255
    v_mul_f32 v126, v154, v126
    v_mfma_f32_16x16x32_bf16 v[118:121], a[88:91], v[226:229], v[118:121]
    s_waitcnt lgkmcnt(1)
    ds_write_b64 v4, v[254:255] offset:18432
    v_mfma_f32_16x16x32_bf16 v[118:121], a[92:95], v[218:221], v[118:121]
    v_mul_f32 v127, v154, v127
    v_cvt_pk_bf16_f32 v254, v126, v127
    v_mfma_f32_16x16x32_bf16 v[194:197], a[96:99], v[170:173], 0
    v_mul_f32 v128, v154, v128
    v_mul_f32 v129, v154, v129
    v_mfma_f32_16x16x32_bf16 v[194:197], a[100:103], v[166:169], v[194:197]
    v_cvt_pk_bf16_f32 v255, v128, v129
    v_xor_b32 v2, 65536, v2
    v_mfma_f32_16x16x32_bf16 v[194:197], a[104:107], v[162:165], v[194:197]
    ds_write_b64 v4, v[254:255] offset:10240
    v_mfma_f32_16x16x32_bf16 v[194:197], a[108:111], v[210:213], v[194:197]
    v_cvt_pk_f16_f32 v118, v118, v119
    v_pk_mul_f16 v223, v118, v118
    v_mfma_f32_16x16x32_bf16 v[194:197], a[112:115], v[226:229], v[194:197]
    v_cvt_pk_f16_f32 v119, v120, v121
    v_pk_mul_f16 v225, v119, v119
    v_mfma_f32_16x16x32_bf16 v[194:197], a[116:119], v[218:221], v[194:197]
    v_rcp_f32 v242, v242
    v_mfma_f32_16x16x32_bf16 v[114:117], a[120:123], v[170:173], 0
    v_mul_f32 v206, v242, v206
    v_mul_f32 v207, v242, v207
    v_mfma_f32_16x16x32_bf16 v[114:117], a[124:127], v[166:169], v[114:117]
    v_cvt_pk_bf16_f32 v206, v206, v207
    v_mul_f32 v208, v242, v208
    v_mfma_f32_16x16x32_bf16 v[114:117], a[128:131], v[162:165], v[114:117]
    v_cvt_pk_f16_f32 v120, v194, v195
    v_pk_fma_f16 v223, v120, v120, v223
    v_mfma_f32_16x16x32_bf16 v[114:117], a[132:135], v[210:213], v[114:117]
    v_cvt_pk_f16_f32 v121, v196, v197
    v_pk_fma_f16 v225, v121, v121, v225
    v_mfma_f32_16x16x32_bf16 v[114:117], a[136:139], v[226:229], v[114:117]
    v_mul_f32 v209, v242, v209
    v_cvt_pk_bf16_f32 v207, v208, v209
    v_mfma_f32_16x16x32_bf16 v[114:117], a[140:143], v[218:221], v[114:117]
    ds_write_b64 v3, v[206:207] offset:12288
    v_mfma_f32_16x16x32_bf16 v[154:157], a[0:3], v[170:173], 0
    v_mul_f32 v174, v242, v174
    v_mul_f32 v175, v242, v175
    v_mfma_f32_16x16x32_bf16 v[154:157], a[4:7], v[166:169], v[154:157]
    v_cvt_pk_bf16_f32 v208, v174, v175
    v_mul_f32 v176, v242, v176
    v_mfma_f32_16x16x32_bf16 v[154:157], a[8:11], v[162:165], v[154:157]
    v_cvt_pk_f16_f32 v196, v114, v115
    v_pk_fma_f16 v223, v196, v196, v223
    v_mfma_f32_16x16x32_bf16 v[154:157], a[12:15], v[210:213], v[154:157]
    v_cvt_pk_f16_f32 v197, v116, v117
    v_pk_fma_f16 v225, v197, v197, v225
    v_mfma_f32_16x16x32_bf16 v[154:157], a[16:19], v[226:229], v[154:157]
    v_mul_f32 v177, v242, v177
    v_cvt_pk_bf16_f32 v209, v176, v177
    v_mfma_f32_16x16x32_bf16 v[154:157], a[20:23], v[218:221], v[154:157]
    ds_write_b64 v3, v[208:209] offset:12296
    v_mfma_f32_16x16x32_bf16 v[174:177], a[24:27], v[170:173], 0
    v_mul_f32 v182, v242, v182
    v_mul_f32 v183, v242, v183
    v_mfma_f32_16x16x32_bf16 v[174:177], a[28:31], v[166:169], v[174:177]
    v_cvt_pk_bf16_f32 v194, v182, v183
    v_mul_f32 v184, v242, v184
    v_mfma_f32_16x16x32_bf16 v[174:177], a[32:35], v[162:165], v[174:177]
    v_cvt_pk_f16_f32 v206, v154, v155
    v_mul_f32 v185, v242, v185
    v_mfma_f32_16x16x32_bf16 v[174:177], a[36:39], v[210:213], v[174:177]
    v_cvt_pk_bf16_f32 v195, v184, v185
    v_xor_b32 v3, 65536, v3
    v_mfma_f32_16x16x32_bf16 v[174:177], a[40:43], v[226:229], v[174:177]
    ds_write_b64 v4, v[194:195] offset:16384
    v_mfma_f32_16x16x32_bf16 v[174:177], a[44:47], v[218:221], v[174:177]
    v_xor_b32 v4, 65536, v4
    v_mfma_f32_16x16x32_bf16 v[182:185], a[48:51], v[170:173], 0
    v_mfma_f32_16x16x32_bf16 v[182:185], a[52:55], v[166:169], v[182:185]
    v_mfma_f32_16x16x32_bf16 v[182:185], a[56:59], v[162:165], v[182:185]
    v_mfma_f32_16x16x32_bf16 v[182:185], a[60:63], v[210:213], v[182:185]
    v_mfma_f32_16x16x32_bf16 v[182:185], a[64:67], v[226:229], v[182:185]
    v_mfma_f32_16x16x32_bf16 v[182:185], a[68:71], v[218:221], v[182:185]
    v_mfma_f32_16x16x32_bf16 v[230:233], v[170:173], a[144:147], 0
    s_waitcnt lgkmcnt(0)
    v_mfma_f32_16x16x32_bf16 v[230:233], v[166:169], a[148:151], v[230:233]
    s_barrier
    v_mfma_f32_16x16x32_bf16 v[230:233], v[162:165], a[152:155], v[230:233]
    s_nop 0
    v_mfma_f32_16x16x32_bf16 v[230:233], v[210:213], a[156:159], v[230:233]
    s_nop 0
    v_mfma_f32_16x16x32_bf16 v[230:233], v[226:229], a[160:163], v[230:233]
    s_nop 0
    v_mfma_f32_16x16x32_bf16 v[230:233], v[218:221], a[164:167], v[230:233]
    s_cbranch_scc1 L_loop_fast0
    s_branch L_final_fast
.p2align 6
L_loop_fast1:
    v_mfma_f32_16x16x32_bf16 v[234:237], v[170:173], a[168:171], 0
    s_add_u32 s12, s42, s27
    ds_read_b128 v[242:245], v2 offset:18432
    ds_read_b128 v[246:249], v2 offset:19456
    v_mfma_f32_16x16x32_bf16 v[234:237], v[166:169], a[172:175], v[234:237]
    s_addc_u32 s13, s43, 0
    v_pk_mul_f16 v222, v206, v206
    v_cvt_pk_f16_f32 v207, v156, v157
    v_mfma_f32_16x16x32_bf16 v[234:237], v[162:165], a[176:179], v[234:237]
    s_sub_u32 s14, s36, s27
    v_pk_mul_f16 v224, v207, v207
    v_cvt_pk_f16_f32 v208, v174, v175
    v_mfma_f32_16x16x32_bf16 v[234:237], v[210:213], a[180:183], v[234:237]
    s_cmp_ge_u32 s18, 2
    ds_read_b128 v[134:137], v0 offset:26624
    v_pk_fma_f16 v222, v208, v208, v222
    v_mfma_f32_16x16x32_bf16 v[234:237], v[226:229], a[184:187], v[234:237]
    s_cselect_b32 s14, s14, 0
    ds_read_b128 v[154:157], v1 offset:26624
    v_cvt_pk_f16_f32 v209, v176, v177
    v_mfma_f32_16x16x32_bf16 v[234:237], v[218:221], a[188:191], v[234:237]
    s_add_u32 s34, s18, 2
    ds_read_b128 v[130:133], v0 offset:26752
    v_pk_fma_f16 v224, v209, v209, v224
    v_mfma_f32_16x16x32_bf16 v[114:117], v[170:173], a[192:195], 0
    s_add_u32 s8, s40, s23
    ds_read_b128 v[122:125], v1 offset:26752
    v_cvt_pk_f16_f32 v194, v182, v183
    v_mfma_f32_16x16x32_bf16 v[114:117], v[166:169], a[196:199], v[114:117]
    s_addc_u32 s9, s41, 0
    ds_read_b128 v[126:129], v0 offset:26880
    v_pk_fma_f16 v222, v194, v194, v222
    v_mfma_f32_16x16x32_bf16 v[114:117], v[162:165], a[200:203], v[114:117]
    s_waitcnt lgkmcnt(5)
    ds_read_b128 v[166:169], v1 offset:26880
    v_cvt_pk_f16_f32 v195, v184, v185
    v_mfma_f32_16x16x32_bf16 v[198:201], v[32:35], v[242:245], 0
    s_sub_u32 s10, s36, s23
    v_pk_fma_f16 v224, v195, v195, v224
    v_cvt_pk_bf16_f32 v174, v230, v231
    v_mfma_f32_16x16x32_bf16 v[198:201], v[32:35], v[246:249], v[198:201]
    s_cmp_lt_u32 s34, s17
    v_cvt_pk_bf16_f32 v175, v232, v233
    v_cvt_pk_bf16_f32 v182, v234, v235
    v_mfma_f32_16x16x32_f16 v[170:173], v[40:43], v[222:225], 0
    s_waitcnt lgkmcnt(5)
    v_cvt_pk_bf16_f32 v183, v236, v237
    s_cselect_b32 s10, s10, 0
    v_mfma_f32_16x16x32_bf16 v[114:117], v[210:213], a[204:207], v[114:117]
    s_add_u32 m0, s28, 0
    v_mul_f32 v255, 0x3baaaaab, v198
    v_mul_f32 v254, 0x3baaaaab, v199
    v_mfma_f32_16x16x32_bf16 v[114:117], v[226:229], a[208:211], v[114:117]
    s_mov_b32 s27, s26
    v_rsq_f32 v172, v170
    v_mfma_f32_16x16x32_bf16 v[114:117], v[218:221], a[212:215], v[114:117]
    s_mov_b32 s26, s25
    v_rsq_f32 v173, v171
    v_mfma_f32_16x16x32_bf16 v[162:165], a[72:75], v[134:137], 0
    s_waitcnt lgkmcnt(1)
    v_mul_f32 v172, s31, v172
    v_cvt_pk_f16_f32 v172, v172, v173
    v_mfma_f32_16x16x32_bf16 v[162:165], a[76:79], v[154:157], v[162:165]
    s_mov_b32 s25, s24
    v_cvt_pk_bf16_f32 v114, v114, v115
    v_cvt_pk_bf16_f32 v115, v116, v117
    v_mfma_f32_16x16x32_bf16 v[162:165], a[80:83], v[130:133], v[162:165]
    s_mov_b32 s24, s23
    v_pk_mul_f16 v118, v118, v172 op_sel:[0,1] op_sel_hi:[1,1]
    v_pk_mul_f16 v119, v119, v172 op_sel:[0,1] op_sel_hi:[1,1]
    v_mfma_f32_16x16x32_bf16 v[162:165], a[84:87], v[122:125], v[162:165]
    s_waitcnt lgkmcnt(0)
    v_pk_mul_f16 v120, v120, v172 op_sel:[0,1] op_sel_hi:[1,1]
    v_pk_mul_f16 v121, v121, v172 op_sel:[0,1] op_sel_hi:[1,1]
    v_mfma_f32_16x16x32_bf16 v[162:165], a[88:91], v[126:129], v[162:165]
    v_pk_mul_f16 v196, v196, v172 op_sel:[0,1] op_sel_hi:[1,1]
    v_pk_mul_f16 v197, v197, v172 op_sel:[0,1] op_sel_hi:[1,1]
    v_mfma_f32_16x16x32_bf16 v[162:165], a[92:95], v[166:169], v[162:165]
    v_pk_mul_f16 v206, v206, v172 op_sel:[0,0] op_sel_hi:[1,0]
    v_pk_mul_f16 v207, v207, v172 op_sel:[0,0] op_sel_hi:[1,0]
    v_mfma_f32_16x16x32_bf16 v[210:213], a[96:99], v[134:137], 0
    v_pk_mul_f16 v208, v208, v172 op_sel:[0,0] op_sel_hi:[1,0]
    v_pk_mul_f16 v209, v209, v172 op_sel:[0,0] op_sel_hi:[1,0]
    v_mfma_f32_16x16x32_bf16 v[210:213], a[100:103], v[154:157], v[210:213]
    v_pk_mul_f16 v194, v194, v172 op_sel:[0,0] op_sel_hi:[1,0]
    v_pk_mul_f16 v195, v195, v172 op_sel:[0,0] op_sel_hi:[1,0]
    v_mfma_f32_16x16x32_bf16 v[210:213], a[104:107], v[130:133], v[210:213]
    v_min3_u32 v44, v44, v170, v171
    v_max3_u32 v45, v45, v170, v171
    v_mfma_f32_16x16x32_bf16 v[210:213], a[108:111], v[122:125], v[210:213]
    v_cvt_pk_f16_f32 v170, v162, v163
    v_pk_mul_f16 v163, v170, v170
    v_mfma_f32_16x16x32_bf16 v[210:213], a[112:115], v[126:129], v[210:213]
    v_cvt_pk_f16_f32 v171, v164, v165
    v_pk_mul_f16 v165, v171, v171
    v_mfma_f32_16x16x32_bf16 v[210:213], a[116:119], v[166:169], v[210:213]
    v_rsq_f32 v255, v255
    v_mfma_f32_16x16x32_bf16 v[214:217], a[120:123], v[134:137], 0
    v_rsq_f32 v254, v254
    v_mfma_f32_16x16x32_bf16 v[214:217], a[124:127], v[154:157], v[214:217]
    v_mul_f32 v142, v254, v142
    v_mul_f32 v143, v254, v143
    v_mfma_f32_16x16x32_bf16 v[214:217], a[128:131], v[130:133], v[214:217]
    v_cvt_pk_bf16_f32 v142, v142, v143
    v_cvt_pk_f16_f32 v172, v210, v211
    v_mfma_f32_16x16x32_bf16 v[214:217], a[132:135], v[122:125], v[214:217]
    v_pk_fma_f16 v163, v172, v172, v163
    v_cvt_pk_f16_f32 v173, v212, v213
    v_mfma_f32_16x16x32_bf16 v[214:217], a[136:139], v[126:129], v[214:217]
    v_pk_fma_f16 v165, v173, v173, v165
    v_mul_f32 v144, v254, v144
    v_mfma_f32_16x16x32_bf16 v[214:217], a[140:143], v[166:169], v[214:217]
    v_mul_f32 v145, v254, v145
    v_cvt_pk_bf16_f32 v143, v144, v145
    v_mfma_f32_16x16x32_bf16 v[210:213], a[0:3], v[134:137], 0
    v_mul_f32 v158, v254, v158
    v_mul_f32 v159, v254, v159
    v_mfma_f32_16x16x32_bf16 v[210:213], a[4:7], v[154:157], v[210:213]
    v_cvt_pk_bf16_f32 v144, v158, v159
    v_mul_f32 v160, v254, v160
    v_mfma_f32_16x16x32_bf16 v[210:213], a[8:11], v[130:133], v[210:213]
    v_cvt_pk_f16_f32 v220, v214, v215
    v_pk_fma_f16 v163, v220, v220, v163
    v_mfma_f32_16x16x32_bf16 v[210:213], a[12:15], v[122:125], v[210:213]
    v_cvt_pk_f16_f32 v221, v216, v217
    v_pk_fma_f16 v165, v221, v221, v165
    v_mfma_f32_16x16x32_bf16 v[210:213], a[16:19], v[126:129], v[210:213]
    v_mul_f32 v161, v254, v161
    v_cvt_pk_bf16_f32 v145, v160, v161
    v_mfma_f32_16x16x32_bf16 v[210:213], a[20:23], v[166:169], v[210:213]
    buffer_store_dwordx4 v[142:145], v16, s[12:15], 0 offen nt
    v_mul_f32 v178, v254, v178
    v_mul_f32 v179, v254, v179
    v_cvt_pk_bf16_f32 v116, v178, v179
    v_mul_f32 v180, v254, v180
    v_mfma_f32_16x16x32_bf16 v[142:145], a[24:27], v[134:137], 0
    v_mul_f32 v181, v254, v181
    v_cvt_pk_bf16_f32 v117, v180, v181
    v_mfma_f32_16x16x32_bf16 v[142:145], a[28:31], v[154:157], v[142:145]
    v_cvt_pk_f16_f32 v158, v210, v211
    v_pk_mul_f16 v162, v158, v158
    v_mfma_f32_16x16x32_bf16 v[142:145], a[32:35], v[130:133], v[142:145]
    v_cvt_pk_f16_f32 v159, v212, v213
    v_pk_mul_f16 v164, v159, v159
    v_mfma_f32_16x16x32_bf16 v[142:145], a[36:39], v[122:125], v[142:145]
    v_mul_f32 v254, 0x3baaaaab, v200
    v_mul_f32 v150, v255, v150
    v_mfma_f32_16x16x32_bf16 v[142:145], a[40:43], v[126:129], v[142:145]
    v_rsq_f32 v254, v254
    v_mfma_f32_16x16x32_bf16 v[142:145], a[44:47], v[166:169], v[142:145]
    v_mul_f32 v151, v255, v151
    v_cvt_pk_bf16_f32 v150, v150, v151
    v_mfma_f32_16x16x32_bf16 v[178:181], a[48:51], v[134:137], 0
    v_mul_f32 v152, v255, v152
    v_mul_f32 v153, v255, v153
    v_mfma_f32_16x16x32_bf16 v[178:181], a[52:55], v[154:157], v[178:181]
    v_cvt_pk_bf16_f32 v151, v152, v153
    v_mul_f32 v190, v255, v190
    v_mfma_f32_16x16x32_bf16 v[178:181], a[56:59], v[130:133], v[178:181]
    v_cvt_pk_f16_f32 v160, v142, v143
    v_pk_fma_f16 v162, v160, v160, v162
    v_mfma_f32_16x16x32_bf16 v[178:181], a[60:63], v[122:125], v[178:181]
    v_cvt_pk_f16_f32 v161, v144, v145
    v_pk_fma_f16 v164, v161, v161, v164
    v_mfma_f32_16x16x32_bf16 v[178:181], a[64:67], v[126:129], v[178:181]
    v_mul_f32 v191, v255, v191
    v_cvt_pk_bf16_f32 v152, v190, v191
    v_mfma_f32_16x16x32_bf16 v[178:181], a[68:71], v[166:169], v[178:181]
    v_mul_f32 v192, v255, v192
    v_mul_f32 v193, v255, v193
    v_mfma_f32_16x16x32_bf16 v[142:145], v[134:137], a[144:147], 0
    v_cvt_pk_bf16_f32 v153, v192, v193
    v_mul_f32 v202, v255, v202
    v_mfma_f32_16x16x32_bf16 v[142:145], v[154:157], a[148:151], v[142:145]
    v_mul_f32 v203, v255, v203
    v_cvt_pk_bf16_f32 v202, v202, v203
    v_mfma_f32_16x16x32_bf16 v[142:145], v[130:133], a[152:155], v[142:145]
    v_cvt_pk_f16_f32 v218, v178, v179
    v_pk_fma_f16 v162, v218, v218, v162
    v_mfma_f32_16x16x32_bf16 v[142:145], v[122:125], a[156:159], v[142:145]
    v_cvt_pk_f16_f32 v219, v180, v181
    v_pk_fma_f16 v164, v219, v219, v164
    v_mfma_f32_16x16x32_bf16 v[142:145], v[126:129], a[160:163], v[142:145]
    buffer_store_dwordx2 v[116:117], v19, s[12:15], 0 offen nt
    v_mul_f32 v204, v255, v204
    v_mul_f32 v205, v255, v205
    v_mfma_f32_16x16x32_f16 v[190:193], v[40:43], v[162:165], 0
    v_cvt_pk_bf16_f32 v203, v204, v205
    v_mul_f32 v146, v254, v146
    v_mfma_f32_16x16x32_bf16 v[142:145], v[166:169], a[164:167], v[142:145]
    v_mul_f32 v147, v254, v147
    v_cvt_pk_bf16_f32 v146, v146, v147
    v_mfma_f32_16x16x32_bf16 v[178:181], v[134:137], a[168:171], 0
    v_mul_f32 v148, v254, v148
    v_mul_f32 v149, v254, v149
    v_mfma_f32_16x16x32_bf16 v[178:181], v[154:157], a[172:175], v[178:181]
    v_rsq_f32 v192, v190
    v_mfma_f32_16x16x32_bf16 v[178:181], v[130:133], a[176:179], v[178:181]
    v_cvt_pk_bf16_f32 v176, v142, v143
    v_cvt_pk_bf16_f32 v177, v144, v145
    v_mfma_f32_16x16x32_bf16 v[178:181], v[122:125], a[180:183], v[178:181]
    ds_read_b128 v[142:145], v0 offset:32768
    v_mul_f32 v192, s31, v192
    v_mfma_f32_16x16x32_bf16 v[178:181], v[126:129], a[184:187], v[178:181]
    ds_read_b128 v[162:165], v1 offset:32768
    v_min3_u32 v44, v44, v190, v191
    v_mfma_f32_16x16x32_bf16 v[178:181], v[166:169], a[188:191], v[178:181]
    ds_read_b128 v[210:213], v0 offset:32896
    v_max3_u32 v45, v45, v190, v191
    v_mfma_f32_16x16x32_bf16 v[198:201], v[134:137], a[192:195], 0
    ds_read_b128 v[134:137], v1 offset:32896
    v_cvt_pk_bf16_f32 v147, v148, v149
    v_mfma_f32_16x16x32_bf16 v[198:201], v[154:157], a[196:199], v[198:201]
    ds_read_b128 v[154:157], v0 offset:33024
    v_mul_f32 v138, v254, v138
    v_mfma_f32_16x16x32_bf16 v[198:201], v[130:133], a[200:203], v[198:201]
    ds_read_b128 v[130:133], v1 offset:33024
    v_cvt_pk_bf16_f32 v184, v178, v179
    v_mfma_f32_16x16x32_bf16 v[198:201], v[122:125], a[204:207], v[198:201]
    v_rsq_f32 v193, v191
    v_mfma_f32_16x16x32_bf16 v[198:201], v[126:129], a[208:211], v[198:201]
    v_cvt_pk_f16_f32 v192, v192, v193
    v_cvt_pk_bf16_f32 v185, v180, v181
    v_mfma_f32_16x16x32_bf16 v[198:201], v[166:169], a[212:215], v[198:201]
    s_waitcnt lgkmcnt(5)
    v_pk_mul_f16 v170, v170, v192 op_sel:[0,1] op_sel_hi:[1,1]
    v_pk_mul_f16 v171, v171, v192 op_sel:[0,1] op_sel_hi:[1,1]
    v_mfma_f32_16x16x32_bf16 v[178:181], a[72:75], v[142:145], 0
    s_waitcnt lgkmcnt(4)
    v_pk_mul_f16 v172, v172, v192 op_sel:[0,1] op_sel_hi:[1,1]
    v_pk_mul_f16 v173, v173, v192 op_sel:[0,1] op_sel_hi:[1,1]
    v_mfma_f32_16x16x32_bf16 v[178:181], a[76:79], v[162:165], v[178:181]
    s_waitcnt lgkmcnt(3)
    v_cvt_pk_bf16_f32 v116, v198, v199
    v_cvt_pk_bf16_f32 v117, v200, v201
    v_mfma_f32_16x16x32_bf16 v[178:181], a[80:83], v[210:213], v[178:181]
    s_waitcnt lgkmcnt(2)
    buffer_store_dwordx4 v[150:153], v15, s[12:15], 0 offen nt
    v_pk_mul_f16 v220, v220, v192 op_sel:[0,1] op_sel_hi:[1,1]
    v_pk_mul_f16 v221, v221, v192 op_sel:[0,1] op_sel_hi:[1,1]
    v_pk_mul_f16 v158, v158, v192 op_sel:[0,0] op_sel_hi:[1,0]
    v_pk_mul_f16 v159, v159, v192 op_sel:[0,0] op_sel_hi:[1,0]
    v_mfma_f32_16x16x32_bf16 v[178:181], a[84:87], v[134:137], v[178:181]
    s_waitcnt lgkmcnt(0)
    v_pk_mul_f16 v160, v160, v192 op_sel:[0,0] op_sel_hi:[1,0]
    v_pk_mul_f16 v161, v161, v192 op_sel:[0,0] op_sel_hi:[1,0]
    v_mfma_f32_16x16x32_bf16 v[178:181], a[88:91], v[154:157], v[178:181]
    v_pk_mul_f16 v218, v218, v192 op_sel:[0,0] op_sel_hi:[1,0]
    v_pk_mul_f16 v219, v219, v192 op_sel:[0,0] op_sel_hi:[1,0]
    v_mfma_f32_16x16x32_bf16 v[178:181], a[92:95], v[130:133], v[178:181]
    v_mul_f32 v139, v254, v139
    v_cvt_pk_bf16_f32 v148, v138, v139
    v_mfma_f32_16x16x32_bf16 v[150:153], a[96:99], v[142:145], 0
    v_mul_f32 v140, v254, v140
    v_mul_f32 v141, v254, v141
    v_mfma_f32_16x16x32_bf16 v[150:153], a[100:103], v[162:165], v[150:153]
    v_cvt_pk_bf16_f32 v149, v140, v141
    v_mul_f32 v186, v254, v186
    v_mfma_f32_16x16x32_bf16 v[150:153], a[104:107], v[210:213], v[150:153]
    v_cvt_pk_f16_f32 v178, v178, v179
    v_pk_mul_f16 v191, v178, v178
    v_mfma_f32_16x16x32_bf16 v[150:153], a[108:111], v[134:137], v[150:153]
    v_cvt_pk_f16_f32 v179, v180, v181
    v_pk_mul_f16 v193, v179, v179
    v_mfma_f32_16x16x32_bf16 v[150:153], a[112:115], v[154:157], v[150:153]
    v_mul_f32 v187, v254, v187
    v_cvt_pk_bf16_f32 v204, v186, v187
    v_mfma_f32_16x16x32_bf16 v[150:153], a[116:119], v[130:133], v[150:153]
    v_mul_f32 v188, v254, v188
    v_mul_f32 v189, v254, v189
    v_mfma_f32_16x16x32_bf16 v[138:141], a[120:123], v[142:145], 0
    s_waitcnt vmcnt(3)
    v_cvt_pk_bf16_f32 v205, v188, v189
    v_xor_b32 v0, 65536, v0
    v_mfma_f32_16x16x32_bf16 v[138:141], a[124:127], v[162:165], v[138:141]
    v_mfma_f32_16x16x32_bf16 v[138:141], a[128:131], v[210:213], v[138:141]
    s_barrier
    v_mfma_f32_16x16x32_bf16 v[138:141], a[132:135], v[134:137], v[138:141]
    v_mfma_f32_16x16x32_bf16 v[138:141], a[136:139], v[154:157], v[138:141]
    v_mfma_f32_16x16x32_bf16 v[138:141], a[140:143], v[130:133], v[138:141]
    v_cvt_pk_f16_f32 v180, v150, v151
    v_pk_fma_f16 v191, v180, v180, v191
    v_mfma_f32_16x16x32_bf16 v[186:189], a[0:3], v[142:145], 0
    v_cvt_pk_f16_f32 v181, v152, v153
    v_pk_fma_f16 v193, v181, v181, v193
    v_mfma_f32_16x16x32_bf16 v[186:189], a[4:7], v[162:165], v[186:189]
    buffer_load_dwordx4 v10, s[8:11], 0 offen nt lds
    v_xor_b32 v1, 65536, v1
    v_mfma_f32_16x16x32_bf16 v[186:189], a[8:11], v[210:213], v[186:189]
    s_add_u32 m0, s28, 4096
    v_cvt_pk_f16_f32 v124, v138, v139
    v_pk_fma_f16 v191, v124, v124, v191
    v_mfma_f32_16x16x32_bf16 v[186:189], a[12:15], v[134:137], v[186:189]
    v_cvt_pk_f16_f32 v125, v140, v141
    v_pk_fma_f16 v193, v125, v125, v193
    v_mfma_f32_16x16x32_bf16 v[186:189], a[16:19], v[154:157], v[186:189]
    v_mfma_f32_16x16x32_bf16 v[186:189], a[20:23], v[130:133], v[186:189]
    v_mfma_f32_16x16x32_bf16 v[150:153], a[24:27], v[142:145], 0
    buffer_load_dwordx4 v11, s[8:11], 0 offen nt lds
    s_add_u32 m0, s28, 8192
    v_mfma_f32_16x16x32_bf16 v[150:153], a[28:31], v[162:165], v[150:153]
    v_mfma_f32_16x16x32_bf16 v[150:153], a[32:35], v[210:213], v[150:153]
    v_mfma_f32_16x16x32_bf16 v[150:153], a[36:39], v[134:137], v[150:153]
    v_mfma_f32_16x16x32_bf16 v[150:153], a[40:43], v[154:157], v[150:153]
    v_mfma_f32_16x16x32_bf16 v[150:153], a[44:47], v[130:133], v[150:153]
    buffer_load_dwordx4 v12, s[8:11], 0 offen nt lds
    v_cvt_pk_f16_f32 v186, v186, v187
    v_mfma_f32_16x16x32_bf16 v[138:141], a[48:51], v[142:145], 0
    s_add_u32 m0, s28, 12288
    v_pk_mul_f16 v190, v186, v186
    v_cvt_pk_f16_f32 v187, v188, v189
    v_mfma_f32_16x16x32_bf16 v[138:141], a[52:55], v[162:165], v[138:141]
    s_xor_b32 s28, s28, 65536
    ds_read_b128 v[166:169], v5 offset:0
    ds_read_b128 v[126:129], v5 offset:16
    v_mfma_f32_16x16x32_bf16 v[138:141], a[56:59], v[210:213], v[138:141]
    ds_read_b128 v[198:201], v5 offset:48
    ds_read_b32 v254, v6 offset:192
    v_mfma_f32_16x16x32_bf16 v[138:141], a[60:63], v[134:137], v[138:141]
    v_pk_mul_f16 v192, v187, v187
    v_cvt_pk_f16_f32 v188, v150, v151
    v_mfma_f32_16x16x32_bf16 v[138:141], a[64:67], v[154:157], v[138:141]
    buffer_load_dwordx4 v13, s[8:11], 0 offen nt lds
    v_pk_fma_f16 v190, v188, v188, v190
    v_mfma_f32_16x16x32_bf16 v[138:141], a[68:71], v[130:133], v[138:141]
    s_mov_b32 m0, s29
    v_cvt_pk_f16_f32 v189, v152, v153
    v_pk_fma_f16 v192, v189, v189, v192
    v_mfma_f32_16x16x32_bf16 v[150:153], v[142:145], a[144:147], 0
    s_xor_b32 s29, s29, s30
    v_add_u32 v5, 336, v5
    s_add_u32 s19, s19, s20
    v_mfma_f32_16x16x32_bf16 v[150:153], v[162:165], a[148:151], v[150:153]
    s_add_u32 s23, s23, s21
    v_cvt_pk_f16_f32 v122, v138, v139
    v_pk_fma_f16 v190, v122, v122, v190
    v_mfma_f32_16x16x32_bf16 v[150:153], v[210:213], a[152:155], v[150:153]
    s_cmp_ge_u32 s19, 72
    v_cvt_pk_f16_f32 v123, v140, v141
    v_pk_fma_f16 v192, v123, v123, v192
    v_mfma_f32_16x16x32_bf16 v[150:153], v[134:137], a[156:159], v[150:153]
    s_waitcnt lgkmcnt(2)
    buffer_store_dwordx2 v[202:203], v18, s[12:15], 0 offen nt
    s_cselect_b32 s34, 72, 0
    s_cselect_b32 s35, s22, 0
    v_mfma_f32_16x16x32_f16 v[138:141], v[40:43], v[190:193], 0
    s_sub_u32 s19, s19, s34
    s_add_u32 s23, s23, s35
    s_add_u32 s18, s18, 1
    v_mfma_f32_16x16x32_f16 v[214:217], v[166:169], v[158:161], v[24:27]
    s_cmp_lt_u32 s18, s45
    v_mfma_f32_16x16x32_f16 v[214:217], v[126:129], v[170:173], v[214:217]
    s_waitcnt lgkmcnt(0)
    v_mfma_f32_16x16x32_f16 v[214:217], v[198:201], v[218:221], v[214:217]
    v_rsq_f32 v140, v138
    v_mfma_f32_16x16x32_f16 v[190:193], v[166:169], v[206:209], v[22:25]
    v_rsq_f32 v141, v139
    v_mfma_f32_16x16x32_f16 v[190:193], v[126:129], v[118:121], v[190:193]
    v_mul_f32 v140, s31, v140
    v_cvt_pk_f16_f32 v140, v140, v141
    v_mfma_f32_16x16x32_f16 v[190:193], v[198:201], v[194:197], v[190:193]
    v_pk_mul_f16 v178, v178, v140 op_sel:[0,1] op_sel_hi:[1,1]
    v_pk_mul_f16 v179, v179, v140 op_sel:[0,1] op_sel_hi:[1,1]
    v_mfma_f32_16x16x32_bf16 v[150:153], v[154:157], a[160:163], v[150:153]
    v_pk_mul_f16 v180, v180, v140 op_sel:[0,1] op_sel_hi:[1,1]
    v_pk_mul_f16 v181, v181, v140 op_sel:[0,1] op_sel_hi:[1,1]
    v_mfma_f32_16x16x32_bf16 v[150:153], v[130:133], a[164:167], v[150:153]
    v_pk_mul_f16 v124, v124, v140 op_sel:[0,1] op_sel_hi:[1,1]
    v_pk_mul_f16 v125, v125, v140 op_sel:[0,1] op_sel_hi:[1,1]
    v_mfma_f32_16x16x32_bf16 v[222:225], v[142:145], a[168:171], 0
    v_mov_b32_dpp v254, v191 quad_perm:[0,1,2,3] row_mask:0x1 bank_mask:0xf
    v_mov_b32_dpp v254, v215 quad_perm:[0,1,2,3] row_mask:0x2 bank_mask:0xf
    v_mfma_f32_16x16x32_bf16 v[222:225], v[162:165], a[172:175], v[222:225]
    v_pk_mul_f16 v186, v186, v140 op_sel:[0,0] op_sel_hi:[1,0]
    v_pk_mul_f16 v187, v187, v140 op_sel:[0,0] op_sel_hi:[1,0]
    v_mfma_f32_16x16x32_bf16 v[222:225], v[210:213], a[176:179], v[222:225]
    v_cvt_pk_bf16_f32 v226, v150, v151
    v_cvt_pk_bf16_f32 v227, v152, v153
    v_mfma_f32_16x16x32_bf16 v[222:225], v[134:137], a[180:183], v[222:225]
    v_pk_mul_f16 v188, v188, v140 op_sel:[0,0] op_sel_hi:[1,0]
    v_pk_mul_f16 v189, v189, v140 op_sel:[0,0] op_sel_hi:[1,0]
    v_mfma_f32_16x16x32_f16 v[230:233], v[118:121], v[206:209], v[46:49]
    v_pk_mul_f16 v122, v122, v140 op_sel:[0,0] op_sel_hi:[1,0]
    v_pk_mul_f16 v123, v123, v140 op_sel:[0,0] op_sel_hi:[1,0]
    v_mfma_f32_16x16x32_f16 v[234:237], v[170:173], v[206:209], v[50:53]
    v_min3_u32 v44, v44, v138, v139
    v_max3_u32 v45, v45, v138, v139
    v_mfma_f32_16x16x32_f16 v[138:141], v[178:181], v[206:209], v[54:57]
    v_exp_f32 v214, v214
    v_mfma_f32_16x16x16_f16 v[230:233], v[196:197], v[194:195], v[230:233]
    buffer_store_dwordx4 v[146:149], v17, s[12:15], 0 offen nt
    v_exp_f32 v190, v190
    v_mfma_f32_16x16x16_f16 v[234:237], v[220:221], v[194:195], v[234:237]
    v_cvt_pk_bf16_f32 v39, v190, 0
    v_mfma_f32_16x16x16_f16 v[138:141], v[124:125], v[194:195], v[138:141]
    v_mfma_f32_16x16x32_bf16 v[222:225], v[154:157], a[184:187], v[222:225]
    v_mfma_f32_16x16x32_bf16 v[222:225], v[130:133], a[188:191], v[222:225]
    ds_read_b128 v[146:149], v2 offset:0
    v_mfma_f32_16x16x32_bf16 v[150:153], v[142:145], a[192:195], 0
    ds_read_b128 v[142:145], v2 offset:1024
    v_mfma_f32_16x16x32_bf16 v[150:153], v[162:165], a[196:199], v[150:153]
    ds_read_b128 v[206:209], v2 offset:2048
    v_mfma_f32_16x16x32_bf16 v[150:153], v[210:213], a[200:203], v[150:153]
    ds_read_b128 v[162:165], v2 offset:3072
    v_mfma_f32_16x16x32_bf16 v[150:153], v[134:137], a[204:207], v[150:153]
    ds_read_b128 v[134:137], v2 offset:4096
    v_cvt_pk_bf16_f32 v210, v222, v223
    v_mfma_f32_16x16x32_bf16 v[150:153], v[154:157], a[208:211], v[150:153]
    ds_read_b128 v[154:157], v2 offset:5120
    v_cvt_pk_bf16_f32 v211, v224, v225
    v_mfma_f32_16x16x32_bf16 v[150:153], v[130:133], a[212:215], v[150:153]
    ds_read2_b32 v[228:229], v6 offset0:0 offset1:0
    ds_read2_b32 v[212:213], v6 offset0:16 offset1:16
    v_mfma_f32_16x16x32_f16 v[130:133], v[166:169], v[186:189], v[26:29]
    ds_read2_b32 v[168:169], v6 offset0:32 offset1:32
    v_add_u32 v6, 272, v6
    v_mfma_f32_16x16x32_f16 v[130:133], v[126:129], v[178:181], v[130:133]
    s_waitcnt lgkmcnt(8)
    v_exp_f32 v230, v230
    v_mfma_f32_16x16x32_f16 v[130:133], v[198:201], v[122:125], v[130:133]
    s_waitcnt lgkmcnt(7)
    v_cvt_pk_bf16_f32 v166, v150, v151
    v_cvt_pk_bf16_f32 v167, v152, v153
    v_mfma_f32_16x16x32_bf16 v[150:153], a[216:219], v[146:149], 0
    s_waitcnt lgkmcnt(6)
    v_exp_f32 v231, v231
    v_mfma_f32_16x16x32_bf16 v[150:153], a[220:223], v[142:145], v[150:153]
    s_waitcnt lgkmcnt(5)
    v_exp_f32 v130, v130
    v_mfma_f32_16x16x32_bf16 v[150:153], a[224:227], v[206:209], v[150:153]
    s_waitcnt lgkmcnt(4)
    buffer_store_dwordx2 v[204:205], v20, s[12:15], 0 offen nt
    v_mov_b32_dpp v254, v131 quad_perm:[0,1,2,3] row_mask:0x4 bank_mask:0xf
    v_cvt_pk_bf16_f32 v126, v230, v231
    v_mfma_f32_16x16x32_bf16 v[150:153], a[228:231], v[162:165], v[150:153]
    s_waitcnt lgkmcnt(3)
    v_exp_f32 v254, v254
    v_mfma_f32_16x16x32_bf16 v[150:153], a[232:235], v[134:137], v[150:153]
    s_waitcnt lgkmcnt(1)
    v_exp_f32 v232, v232
    v_mfma_f32_16x16x32_bf16 v[150:153], a[236:239], v[154:157], v[150:153]
    s_waitcnt lgkmcnt(0)
    v_exp_f32 v233, v233
    v_mfma_f32_16x16x32_bf16 v[190:193], a[240:243], v[146:149], 0
    v_cvt_pk_bf16_f32 v254, v254, v254
    v_cvt_pk_bf16_f32 v127, v232, v233
    v_mfma_f32_16x16x32_bf16 v[190:193], a[244:247], v[142:145], v[190:193]
    ds_write_b16 v8, v254
    v_mfma_f32_16x16x32_bf16 v[190:193], a[248:251], v[206:209], v[190:193]
    v_exp_f32 v234, v234
    v_mfma_f32_16x16x32_bf16 v[190:193], a[252:255], v[162:165], v[190:193]
    ds_read_b128 v[198:201], v2 offset:6144
    ds_read_b128 v[230:233], v9
    v_mfma_f32_16x16x32_bf16 v[190:193], v[82:85], v[134:137], v[190:193]
    ds_read_b128 v[222:225], v2 offset:7168
    ds_read_b128 v[238:241], v9 offset:64
    v_mfma_f32_16x16x32_bf16 v[190:193], v[86:89], v[154:157], v[190:193]
    v_exp_f32 v235, v235
    v_mfma_f32_16x16x32_bf16 v[202:205], v[90:93], v[146:149], 0
    ds_read_b128 v[146:149], v2 offset:8192
    ds_read_b128 v[242:245], v2 offset:9216
    v_mfma_f32_16x16x32_bf16 v[202:205], v[94:97], v[142:145], v[202:205]
    v_cvt_pk_bf16_f32 v128, v234, v235
    v_fma_f32 v254, v150, v150, s33
    v_mfma_f32_16x16x32_bf16 v[202:205], v[98:101], v[206:209], v[202:205]
    ds_read_b128 v[206:209], v2 offset:10240
    ds_read_b128 v[246:249], v2 offset:11264
    v_mfma_f32_16x16x32_bf16 v[202:205], v[102:105], v[162:165], v[202:205]
    v_exp_f32 v236, v236
    v_mfma_f32_16x16x32_bf16 v[202:205], v[106:109], v[134:137], v[202:205]
    v_exp_f32 v237, v237
    v_mfma_f32_16x16x32_bf16 v[202:205], v[110:113], v[154:157], v[202:205]
    s_waitcnt lgkmcnt(6)
    v_cvt_pk_bf16_f32 v129, v236, v237
    v_fmac_f32 v254, v151, v151
    v_mfma_f32_16x16x32_bf16 v[142:145], v[230:233], v[28:31], 0
    s_waitcnt lgkmcnt(4)
    v_exp_f32 v138, v138
    v_mfma_f32_16x16x32_bf16 v[142:145], v[238:241], v[28:31], v[142:145]
    buffer_load_dwordx4 v14, s[8:11], 0 offen nt lds
    v_fmac_f32 v254, v152, v152
    v_mfma_f32_16x16x32_bf16 v[134:137], v[230:233], v[174:177], 0
    s_waitcnt lgkmcnt(2)
    v_exp_f32 v139, v139
    v_mfma_f32_16x16x32_bf16 v[134:137], v[238:241], v[226:229], v[134:137]
    v_cvt_pk_bf16_f32 v36, v138, v139
    v_fmac_f32 v254, v153, v153
    v_mfma_f32_16x16x32_bf16 v[154:157], v[230:233], v[182:185], 0
    s_waitcnt lgkmcnt(0)
    v_rcp_f32 v142, v142
    v_mfma_f32_16x16x32_bf16 v[154:157], v[238:241], v[210:213], v[154:157]
    v_exp_f32 v140, v140
    v_mfma_f32_16x16x32_bf16 v[162:165], v[230:233], v[114:117], 0
    v_mul_f32 v134, v134, v142
    v_fmac_f32 v254, v190, v190
    v_mfma_f32_16x16x32_bf16 v[162:165], v[238:241], v[166:169], v[162:165]
    v_exp_f32 v141, v141
    v_mfma_f32_16x16x32_f16 v[230:233], v[118:121], v[158:161], v[58:61]
    v_cvt_pk_bf16_f32 v37, v140, v141
    v_mul_f32_dpp v134, v154, v142 quad_perm:[0,1,2,3] row_mask:0x2 bank_mask:0xf
    v_mfma_f32_16x16x32_f16 v[138:141], v[170:173], v[158:161], v[62:65]
    v_fmac_f32 v254, v191, v191
    v_fmac_f32 v254, v192, v192
    v_mfma_f32_16x16x32_f16 v[154:157], v[178:181], v[158:161], v[66:69]
    v_mul_f32_dpp v134, v162, v142 quad_perm:[0,1,2,3] row_mask:0x4 bank_mask:0xf
    v_cvt_pk_bf16_f32 v134, v134, v134
    v_fmac_f32 v254, v193, v193
    v_mfma_f32_16x16x16_f16 v[230:233], v[196:197], v[218:219], v[230:233]
    v_fmac_f32 v254, v202, v202
    v_fmac_f32 v254, v203, v203
    v_fmac_f32 v254, v204, v204
    v_mfma_f32_16x16x16_f16 v[138:141], v[220:221], v[218:219], v[138:141]
    v_fmac_f32 v254, v205, v205
    v_mfma_f32_16x16x16_f16 v[154:157], v[124:125], v[218:219], v[154:157]
    ds_write_b16 v7, v134
    v_add_u32 v7, 16, v7
    v_mfma_f32_16x16x32_bf16 v[134:137], v[28:31], v[36:39], 0
    v_exp_f32 v230, v230
    v_mfma_f32_16x16x32_bf16 v[134:137], v[28:31], v[126:129], v[134:137]
    v_exp_f32 v231, v231
    v_mfma_f32_16x16x32_bf16 v[158:161], v[226:229], v[36:39], 0
    v_exp_f32 v232, v232
    v_mfma_f32_16x16x32_bf16 v[158:161], v[174:177], v[126:129], v[158:161]
    v_exp_f32 v233, v233
    v_mfma_f32_16x16x32_bf16 v[162:165], v[210:213], v[36:39], 0
    v_cvt_pk_bf16_f32 v230, v230, v231
    v_cvt_pk_bf16_f32 v231, v232, v233
    v_mfma_f32_16x16x32_bf16 v[162:165], v[182:185], v[126:129], v[162:165]
    v_exp_f32 v138, v138
    v_mfma_f32_16x16x32_bf16 v[234:237], v[166:169], v[36:39], 0
    v_exp_f32 v139, v139
    v_mfma_f32_16x16x32_bf16 v[234:237], v[114:117], v[126:129], v[234:237]
    v_cvt_pk_bf16_f32 v232, v138, v139
    v_cvt_pk_bf16_f32 v39, v214, 0
    v_mfma_f32_16x16x32_f16 v[126:129], v[118:121], v[186:189], v[70:73]
    v_exp_f32 v140, v140
    v_mfma_f32_16x16x32_f16 v[118:121], v[170:173], v[186:189], v[74:77]
    v_exp_f32 v141, v141
    v_mfma_f32_16x16x32_bf16 v[142:145], a[216:219], v[198:201], 0
    v_exp_f32 v154, v154
    v_mfma_f32_16x16x32_bf16 v[142:145], a[220:223], v[222:225], v[142:145]
    v_cvt_pk_bf16_f32 v233, v140, v141
    v_exp_f32 v155, v155
    v_mfma_f32_16x16x32_f16 v[138:141], v[178:181], v[186:189], v[78:81]
    v_cvt_pk_bf16_f32 v36, v154, v155
    v_exp_f32 v156, v156
    v_mfma_f32_16x16x16_f16 v[126:129], v[196:197], v[122:123], v[126:129]
    v_exp_f32 v157, v157
    v_mfma_f32_16x16x16_f16 v[118:121], v[220:221], v[122:123], v[118:121]
    v_cvt_pk_bf16_f32 v37, v156, v157
    v_rcp_f32 v134, v134
    v_mfma_f32_16x16x16_f16 v[138:141], v[124:125], v[122:123], v[138:141]
    v_mul_f32 v158, v134, v158
    v_mul_f32 v159, v134, v159
    v_cvt_pk_bf16_f32 v186, v158, v159
    v_mul_f32 v160, v134, v160
    v_mfma_f32_16x16x32_bf16 v[154:157], v[28:31], v[36:39], 0
    v_exp_f32 v126, v126
    v_mfma_f32_16x16x32_bf16 v[154:157], v[28:31], v[230:233], v[154:157]
    v_exp_f32 v127, v127
    v_mfma_f32_16x16x32_bf16 v[194:197], v[226:229], v[36:39], 0
    v_cvt_pk_bf16_f32 v170, v126, v127
    v_mul_f32 v161, v134, v161
    v_mfma_f32_16x16x32_bf16 v[194:197], v[174:177], v[230:233], v[194:197]
    v_exp_f32 v128, v128
    v_mfma_f32_16x16x32_bf16 v[122:125], v[210:213], v[36:39], 0
    v_exp_f32 v129, v129
    v_mfma_f32_16x16x32_bf16 v[122:125], v[182:185], v[230:233], v[122:125]
    v_cvt_pk_bf16_f32 v171, v128, v129
    v_cvt_pk_bf16_f32 v187, v160, v161
    v_mfma_f32_16x16x32_bf16 v[126:129], v[166:169], v[36:39], 0
    ds_write_b64 v3, v[186:187] offset:0
    v_mfma_f32_16x16x32_bf16 v[126:129], v[114:117], v[230:233], v[126:129]
    v_exp_f32 v118, v118
    v_mfma_f32_16x16x32_bf16 v[142:145], a[224:227], v[146:149], v[142:145]
    v_exp_f32 v119, v119
    v_mfma_f32_16x16x32_bf16 v[142:145], a[228:231], v[242:245], v[142:145]
    v_cvt_pk_bf16_f32 v172, v118, v119
    v_cvt_pk_bf16_f32 v39, v130, 0
    v_mfma_f32_16x16x32_bf16 v[142:145], a[232:235], v[206:209], v[142:145]
    v_exp_f32 v120, v120
    v_mfma_f32_16x16x32_bf16 v[142:145], a[236:239], v[246:249], v[142:145]
    v_exp_f32 v121, v121
    v_mfma_f32_16x16x32_bf16 v[158:161], a[240:243], v[198:201], 0
    v_cvt_pk_bf16_f32 v173, v120, v121
    v_mul_f32 v162, v134, v162
    v_mfma_f32_16x16x32_bf16 v[158:161], a[244:247], v[222:225], v[158:161]
    v_exp_f32 v138, v138
    v_mfma_f32_16x16x32_bf16 v[158:161], a[248:251], v[146:149], v[158:161]
    v_exp_f32 v139, v139
    v_mfma_f32_16x16x32_bf16 v[158:161], a[252:255], v[242:245], v[158:161]
    ds_read_b128 v[118:121], v2 offset:12288
    v_cvt_pk_bf16_f32 v36, v138, v139
    v_mfma_f32_16x16x32_bf16 v[158:161], v[82:85], v[206:209], v[158:161]
    ds_read_b128 v[130:133], v2 offset:13312
    v_fma_f32 v255, v142, v142, s33
    v_mfma_f32_16x16x32_bf16 v[158:161], v[86:89], v[246:249], v[158:161]
    ds_read_b128 v[218:221], v2 offset:14336
    v_fmac_f32 v255, v143, v143
    v_mfma_f32_16x16x32_bf16 v[178:181], v[90:93], v[198:201], 0
    ds_read_b128 v[198:201], v2 offset:15360
    v_fmac_f32 v255, v144, v144
    v_mfma_f32_16x16x32_bf16 v[178:181], v[94:97], v[222:225], v[178:181]
    ds_read_b128 v[222:225], v2 offset:16384
    v_fmac_f32 v255, v145, v145
    v_mfma_f32_16x16x32_bf16 v[178:181], v[98:101], v[146:149], v[178:181]
    ds_read_b128 v[230:233], v2 offset:17408
    v_fmac_f32 v255, v158, v158
    v_mfma_f32_16x16x32_bf16 v[178:181], v[102:105], v[242:245], v[178:181]
    v_exp_f32 v140, v140
    v_mfma_f32_16x16x32_bf16 v[178:181], v[106:109], v[206:209], v[178:181]
    v_exp_f32 v141, v141
    v_mfma_f32_16x16x32_bf16 v[178:181], v[110:113], v[246:249], v[178:181]
    s_waitcnt lgkmcnt(5)
    v_cvt_pk_bf16_f32 v37, v140, v141
    v_fmac_f32 v255, v159, v159
    v_mfma_f32_16x16x32_bf16 v[146:149], a[216:219], v[118:121], 0
    s_waitcnt lgkmcnt(4)
    v_fmac_f32 v255, v160, v160
    v_fmac_f32 v255, v161, v161
    v_mfma_f32_16x16x32_bf16 v[242:245], v[28:31], v[36:39], 0
    s_waitcnt lgkmcnt(3)
    v_fmac_f32 v255, v178, v178
    v_fmac_f32 v255, v179, v179
    v_mfma_f32_16x16x32_bf16 v[242:245], v[28:31], v[170:173], v[242:245]
    s_waitcnt lgkmcnt(2)
    v_fmac_f32 v255, v180, v180
    v_fmac_f32 v255, v181, v181
    v_mfma_f32_16x16x32_bf16 v[206:209], v[226:229], v[36:39], 0
    s_waitcnt lgkmcnt(1)
    v_cvt_pk_bf16_f32 v254, v254, v255
    v_mul_f32 v163, v134, v163
    v_mfma_f32_16x16x32_bf16 v[206:209], v[174:177], v[170:173], v[206:209]
    s_waitcnt lgkmcnt(0)
    v_cvt_pk_bf16_f32 v188, v162, v163
    v_mul_f32 v164, v134, v164
    v_mfma_f32_16x16x32_bf16 v[174:177], v[210:213], v[36:39], 0
    v_mul_f32 v165, v134, v165
    v_cvt_pk_bf16_f32 v189, v164, v165
    v_mfma_f32_16x16x32_bf16 v[174:177], v[182:185], v[170:173], v[174:177]
    ds_write_b64 v3, v[188:189] offset:8
    v_mfma_f32_16x16x32_bf16 v[182:185], v[166:169], v[36:39], 0
    v_mul_f32 v234, v134, v234
    v_mul_f32 v235, v134, v235
    v_mfma_f32_16x16x32_bf16 v[182:185], v[114:117], v[170:173], v[182:185]
    v_cvt_pk_bf16_f32 v234, v234, v235
    v_mul_f32 v236, v134, v236
    v_mfma_f32_16x16x32_bf16 v[146:149], a[220:223], v[130:133], v[146:149]
    v_mul_f32 v237, v134, v237
    v_cvt_pk_bf16_f32 v235, v236, v237
    v_mfma_f32_16x16x32_bf16 v[146:149], a[224:227], v[218:221], v[146:149]
    ds_write_b64 v4, v[234:235] offset:4096
    v_mfma_f32_16x16x32_bf16 v[146:149], a[228:231], v[198:201], v[146:149]
    v_rcp_f32 v154, v154
    v_mfma_f32_16x16x32_bf16 v[146:149], a[232:235], v[222:225], v[146:149]
    v_mul_f32 v194, v154, v194
    v_mul_f32 v195, v154, v195
    v_mfma_f32_16x16x32_bf16 v[146:149], a[236:239], v[230:233], v[146:149]
    v_cvt_pk_bf16_f32 v194, v194, v195
    v_mul_f32 v196, v154, v196
    v_mfma_f32_16x16x32_bf16 v[138:141], a[240:243], v[118:121], 0
    v_mul_f32 v197, v154, v197
    v_cvt_pk_bf16_f32 v195, v196, v197
    v_mfma_f32_16x16x32_bf16 v[138:141], a[244:247], v[130:133], v[138:141]
    ds_write_b64 v3, v[194:195] offset:6144
    v_mfma_f32_16x16x32_bf16 v[138:141], a[248:251], v[218:221], v[138:141]
    v_fma_f32 v255, v146, v146, s33
    v_fmac_f32 v255, v147, v147
    v_mfma_f32_16x16x32_bf16 v[138:141], a[252:255], v[198:201], v[138:141]
    ds_read_b128 v[170:173], v0 offset:20480
    v_fmac_f32 v255, v148, v148
    v_mfma_f32_16x16x32_bf16 v[138:141], v[82:85], v[222:225], v[138:141]
    ds_read_b128 v[166:169], v1 offset:20480
    v_fmac_f32 v255, v149, v149
    v_mfma_f32_16x16x32_bf16 v[138:141], v[86:89], v[230:233], v[138:141]
    ds_read_b128 v[162:165], v0 offset:20608
    v_mul_f32 v122, v154, v122
    v_mfma_f32_16x16x32_bf16 v[186:189], v[90:93], v[118:121], 0
    ds_read_b128 v[210:213], v1 offset:20608
    v_mul_f32 v123, v154, v123
    v_mfma_f32_16x16x32_bf16 v[186:189], v[94:97], v[130:133], v[186:189]
    ds_read_b128 v[226:229], v0 offset:20736
    v_cvt_pk_bf16_f32 v196, v122, v123
    v_mfma_f32_16x16x32_bf16 v[186:189], v[98:101], v[218:221], v[186:189]
    ds_read_b128 v[218:221], v1 offset:20736
    v_fmac_f32 v255, v138, v138
    v_mfma_f32_16x16x32_bf16 v[186:189], v[102:105], v[198:201], v[186:189]
    v_fmac_f32 v255, v139, v139
    v_fmac_f32 v255, v140, v140
    v_mfma_f32_16x16x32_bf16 v[186:189], v[106:109], v[222:225], v[186:189]
    v_fmac_f32 v255, v141, v141
    v_mul_f32 v124, v154, v124
    v_mfma_f32_16x16x32_bf16 v[186:189], v[110:113], v[230:233], v[186:189]
    s_waitcnt lgkmcnt(5)
    v_mul_f32 v125, v154, v125
    v_cvt_pk_bf16_f32 v197, v124, v125
    v_mfma_f32_16x16x32_bf16 v[118:121], a[72:75], v[170:173], 0
    s_waitcnt lgkmcnt(4)
    ds_write_b64 v3, v[196:197] offset:6152
    v_mfma_f32_16x16x32_bf16 v[118:121], a[76:79], v[166:169], v[118:121]
    s_waitcnt lgkmcnt(4)
    v_fmac_f32 v255, v186, v186
    v_fmac_f32 v255, v187, v187
    v_mfma_f32_16x16x32_bf16 v[118:121], a[80:83], v[162:165], v[118:121]
    s_waitcnt lgkmcnt(3)
    v_fmac_f32 v255, v188, v188
    v_fmac_f32 v255, v189, v189
    v_mfma_f32_16x16x32_bf16 v[118:121], a[84:87], v[210:213], v[118:121]
    s_waitcnt lgkmcnt(2)
    v_cvt_pk_bf16_f32 v255, v255, v255
    v_mul_f32 v126, v154, v126
    v_mfma_f32_16x16x32_bf16 v[118:121], a[88:91], v[226:229], v[118:121]
    s_waitcnt lgkmcnt(1)
    ds_write_b64 v4, v[254:255] offset:18432
    v_mfma_f32_16x16x32_bf16 v[118:121], a[92:95], v[218:221], v[118:121]
    v_mul_f32 v127, v154, v127
    v_cvt_pk_bf16_f32 v254, v126, v127
    v_mfma_f32_16x16x32_bf16 v[194:197], a[96:99], v[170:173], 0
    v_mul_f32 v128, v154, v128
    v_mul_f32 v129, v154, v129
    v_mfma_f32_16x16x32_bf16 v[194:197], a[100:103], v[166:169], v[194:197]
    v_cvt_pk_bf16_f32 v255, v128, v129
    v_xor_b32 v2, 65536, v2
    v_mfma_f32_16x16x32_bf16 v[194:197], a[104:107], v[162:165], v[194:197]
    ds_write_b64 v4, v[254:255] offset:10240
    v_mfma_f32_16x16x32_bf16 v[194:197], a[108:111], v[210:213], v[194:197]
    v_cvt_pk_f16_f32 v118, v118, v119
    v_pk_mul_f16 v223, v118, v118
    v_mfma_f32_16x16x32_bf16 v[194:197], a[112:115], v[226:229], v[194:197]
    v_cvt_pk_f16_f32 v119, v120, v121
    v_pk_mul_f16 v225, v119, v119
    v_mfma_f32_16x16x32_bf16 v[194:197], a[116:119], v[218:221], v[194:197]
    v_rcp_f32 v242, v242
    v_mfma_f32_16x16x32_bf16 v[114:117], a[120:123], v[170:173], 0
    v_mul_f32 v206, v242, v206
    v_mul_f32 v207, v242, v207
    v_mfma_f32_16x16x32_bf16 v[114:117], a[124:127], v[166:169], v[114:117]
    v_cvt_pk_bf16_f32 v206, v206, v207
    v_mul_f32 v208, v242, v208
    v_mfma_f32_16x16x32_bf16 v[114:117], a[128:131], v[162:165], v[114:117]
    v_cvt_pk_f16_f32 v120, v194, v195
    v_pk_fma_f16 v223, v120, v120, v223
    v_mfma_f32_16x16x32_bf16 v[114:117], a[132:135], v[210:213], v[114:117]
    v_cvt_pk_f16_f32 v121, v196, v197
    v_pk_fma_f16 v225, v121, v121, v225
    v_mfma_f32_16x16x32_bf16 v[114:117], a[136:139], v[226:229], v[114:117]
    v_mul_f32 v209, v242, v209
    v_cvt_pk_bf16_f32 v207, v208, v209
    v_mfma_f32_16x16x32_bf16 v[114:117], a[140:143], v[218:221], v[114:117]
    ds_write_b64 v3, v[206:207] offset:12288
    v_mfma_f32_16x16x32_bf16 v[154:157], a[0:3], v[170:173], 0
    v_mul_f32 v174, v242, v174
    v_mul_f32 v175, v242, v175
    v_mfma_f32_16x16x32_bf16 v[154:157], a[4:7], v[166:169], v[154:157]
    v_cvt_pk_bf16_f32 v208, v174, v175
    v_mul_f32 v176, v242, v176
    v_mfma_f32_16x16x32_bf16 v[154:157], a[8:11], v[162:165], v[154:157]
    v_cvt_pk_f16_f32 v196, v114, v115
    v_pk_fma_f16 v223, v196, v196, v223
    v_mfma_f32_16x16x32_bf16 v[154:157], a[12:15], v[210:213], v[154:157]
    v_cvt_pk_f16_f32 v197, v116, v117
    v_pk_fma_f16 v225, v197, v197, v225
    v_mfma_f32_16x16x32_bf16 v[154:157], a[16:19], v[226:229], v[154:157]
    v_mul_f32 v177, v242, v177
    v_cvt_pk_bf16_f32 v209, v176, v177
    v_mfma_f32_16x16x32_bf16 v[154:157], a[20:23], v[218:221], v[154:157]
    ds_write_b64 v3, v[208:209] offset:12296
    v_mfma_f32_16x16x32_bf16 v[174:177], a[24:27], v[170:173], 0
    v_mul_f32 v182, v242, v182
    v_mul_f32 v183, v242, v183
    v_mfma_f32_16x16x32_bf16 v[174:177], a[28:31], v[166:169], v[174:177]
    v_cvt_pk_bf16_f32 v194, v182, v183
    v_mul_f32 v184, v242, v184
    v_mfma_f32_16x16x32_bf16 v[174:177], a[32:35], v[162:165], v[174:177]
    v_cvt_pk_f16_f32 v206, v154, v155
    v_mul_f32 v185, v242, v185
    v_mfma_f32_16x16x32_bf16 v[174:177], a[36:39], v[210:213], v[174:177]
    v_cvt_pk_bf16_f32 v195, v184, v185
    v_xor_b32 v3, 65536, v3
    v_mfma_f32_16x16x32_bf16 v[174:177], a[40:43], v[226:229], v[174:177]
    ds_write_b64 v4, v[194:195] offset:16384
    v_mfma_f32_16x16x32_bf16 v[174:177], a[44:47], v[218:221], v[174:177]
    v_xor_b32 v4, 65536, v4
    v_mfma_f32_16x16x32_bf16 v[182:185], a[48:51], v[170:173], 0
    v_mfma_f32_16x16x32_bf16 v[182:185], a[52:55], v[166:169], v[182:185]
    v_mfma_f32_16x16x32_bf16 v[182:185], a[56:59], v[162:165], v[182:185]
    v_mfma_f32_16x16x32_bf16 v[182:185], a[60:63], v[210:213], v[182:185]
    v_mfma_f32_16x16x32_bf16 v[182:185], a[64:67], v[226:229], v[182:185]
    v_mfma_f32_16x16x32_bf16 v[182:185], a[68:71], v[218:221], v[182:185]
    v_mfma_f32_16x16x32_bf16 v[230:233], v[170:173], a[144:147], 0
    s_waitcnt lgkmcnt(0)
    v_mfma_f32_16x16x32_bf16 v[230:233], v[166:169], a[148:151], v[230:233]
    s_nop 0
    v_mfma_f32_16x16x32_bf16 v[230:233], v[162:165], a[152:155], v[230:233]
    s_barrier
    v_mfma_f32_16x16x32_bf16 v[230:233], v[210:213], a[156:159], v[230:233]
    s_nop 0
    v_mfma_f32_16x16x32_bf16 v[230:233], v[226:229], a[160:163], v[230:233]
    s_nop 0
    v_mfma_f32_16x16x32_bf16 v[230:233], v[218:221], a[164:167], v[230:233]
    s_cbranch_scc1 L_loop_fast1
    s_branch L_final_fast
.p2align 6
L_loop_fast2:
    v_mfma_f32_16x16x32_bf16 v[234:237], v[170:173], a[168:171], 0
    s_add_u32 s12, s42, s27
    ds_read_b128 v[242:245], v2 offset:18432
    ds_read_b128 v[246:249], v2 offset:19456
    v_mfma_f32_16x16x32_bf16 v[234:237], v[166:169], a[172:175], v[234:237]
    s_addc_u32 s13, s43, 0
    v_pk_mul_f16 v222, v206, v206
    v_cvt_pk_f16_f32 v207, v156, v157
    v_mfma_f32_16x16x32_bf16 v[234:237], v[162:165], a[176:179], v[234:237]
    s_sub_u32 s14, s36, s27
    v_pk_mul_f16 v224, v207, v207
    v_cvt_pk_f16_f32 v208, v174, v175
    v_mfma_f32_16x16x32_bf16 v[234:237], v[210:213], a[180:183], v[234:237]
    s_cmp_ge_u32 s18, 2
    ds_read_b128 v[134:137], v0 offset:26624
    v_pk_fma_f16 v222, v208, v208, v222
    v_mfma_f32_16x16x32_bf16 v[234:237], v[226:229], a[184:187], v[234:237]
    s_cselect_b32 s14, s14, 0
    ds_read_b128 v[154:157], v1 offset:26624
    v_cvt_pk_f16_f32 v209, v176, v177
    v_mfma_f32_16x16x32_bf16 v[234:237], v[218:221], a[188:191], v[234:237]
    s_add_u32 s34, s18, 2
    ds_read_b128 v[130:133], v0 offset:26752
    v_pk_fma_f16 v224, v209, v209, v224
    v_mfma_f32_16x16x32_bf16 v[114:117], v[170:173], a[192:195], 0
    s_add_u32 s8, s40, s23
    ds_read_b128 v[122:125], v1 offset:26752
    v_cvt_pk_f16_f32 v194, v182, v183
    v_mfma_f32_16x16x32_bf16 v[114:117], v[166:169], a[196:199], v[114:117]
    s_addc_u32 s9, s41, 0
    ds_read_b128 v[126:129], v0 offset:26880
    v_pk_fma_f16 v222, v194, v194, v222
    v_mfma_f32_16x16x32_bf16 v[114:117], v[162:165], a[200:203], v[114:117]
    s_waitcnt lgkmcnt(5)
    ds_read_b128 v[166:169], v1 offset:26880
    v_cvt_pk_f16_f32 v195, v184, v185
    v_mfma_f32_16x16x32_bf16 v[198:201], v[32:35], v[242:245], 0
    s_sub_u32 s10, s36, s23
    v_pk_fma_f16 v224, v195, v195, v224
    v_cvt_pk_bf16_f32 v174, v230, v231
    v_mfma_f32_16x16x32_bf16 v[198:201], v[32:35], v[246:249], v[198:201]
    s_cmp_lt_u32 s34, s17
    v_cvt_pk_bf16_f32 v175, v232, v233
    v_cvt_pk_bf16_f32 v182, v234, v235
    v_mfma_f32_16x16x32_f16 v[170:173], v[40:43], v[222:225], 0
    s_waitcnt lgkmcnt(5)
    v_cvt_pk_bf16_f32 v183, v236, v237
    s_cselect_b32 s10, s10, 0
    v_mfma_f32_16x16x32_bf16 v[114:117], v[210:213], a[204:207], v[114:117]
    s_add_u32 m0, s28, 0
    v_mul_f32 v255, 0x3baaaaab, v198
    v_mul_f32 v254, 0x3baaaaab, v199
    v_mfma_f32_16x16x32_bf16 v[114:117], v[226:229], a[208:211], v[114:117]
    s_mov_b32 s27, s26
    v_rsq_f32 v172, v170
    v_mfma_f32_16x16x32_bf16 v[114:117], v[218:221], a[212:215], v[114:117]
    s_mov_b32 s26, s25
    v_rsq_f32 v173, v171
    v_mfma_f32_16x16x32_bf16 v[162:165], a[72:75], v[134:137], 0
    s_waitcnt lgkmcnt(1)
    v_mul_f32 v172, s31, v172
    v_cvt_pk_f16_f32 v172, v172, v173
    v_mfma_f32_16x16x32_bf16 v[162:165], a[76:79], v[154:157], v[162:165]
    s_mov_b32 s25, s24
    v_cvt_pk_bf16_f32 v114, v114, v115
    v_cvt_pk_bf16_f32 v115, v116, v117
    v_mfma_f32_16x16x32_bf16 v[162:165], a[80:83], v[130:133], v[162:165]
    s_mov_b32 s24, s23
    v_pk_mul_f16 v118, v118, v172 op_sel:[0,1] op_sel_hi:[1,1]
    v_pk_mul_f16 v119, v119, v172 op_sel:[0,1] op_sel_hi:[1,1]
    v_mfma_f32_16x16x32_bf16 v[162:165], a[84:87], v[122:125], v[162:165]
    s_waitcnt lgkmcnt(0)
    v_pk_mul_f16 v120, v120, v172 op_sel:[0,1] op_sel_hi:[1,1]
    v_pk_mul_f16 v121, v121, v172 op_sel:[0,1] op_sel_hi:[1,1]
    v_mfma_f32_16x16x32_bf16 v[162:165], a[88:91], v[126:129], v[162:165]
    v_pk_mul_f16 v196, v196, v172 op_sel:[0,1] op_sel_hi:[1,1]
    v_pk_mul_f16 v197, v197, v172 op_sel:[0,1] op_sel_hi:[1,1]
    v_mfma_f32_16x16x32_bf16 v[162:165], a[92:95], v[166:169], v[162:165]
    v_pk_mul_f16 v206, v206, v172 op_sel:[0,0] op_sel_hi:[1,0]
    v_pk_mul_f16 v207, v207, v172 op_sel:[0,0] op_sel_hi:[1,0]
    v_mfma_f32_16x16x32_bf16 v[210:213], a[96:99], v[134:137], 0
    v_pk_mul_f16 v208, v208, v172 op_sel:[0,0] op_sel_hi:[1,0]
    v_pk_mul_f16 v209, v209, v172 op_sel:[0,0] op_sel_hi:[1,0]
    v_mfma_f32_16x16x32_bf16 v[210:213], a[100:103], v[154:157], v[210:213]
    v_pk_mul_f16 v194, v194, v172 op_sel:[0,0] op_sel_hi:[1,0]
    v_pk_mul_f16 v195, v195, v172 op_sel:[0,0] op_sel_hi:[1,0]
    v_mfma_f32_16x16x32_bf16 v[210:213], a[104:107], v[130:133], v[210:213]
    v_min3_u32 v44, v44, v170, v171
    v_max3_u32 v45, v45, v170, v171
    v_mfma_f32_16x16x32_bf16 v[210:213], a[108:111], v[122:125], v[210:213]
    v_cvt_pk_f16_f32 v170, v162, v163
    v_pk_mul_f16 v163, v170, v170
    v_mfma_f32_16x16x32_bf16 v[210:213], a[112:115], v[126:129], v[210:213]
    v_cvt_pk_f16_f32 v171, v164, v165
    v_pk_mul_f16 v165, v171, v171
    v_mfma_f32_16x16x32_bf16 v[210:213], a[116:119], v[166:169], v[210:213]
    v_rsq_f32 v255, v255
    v_mfma_f32_16x16x32_bf16 v[214:217], a[120:123], v[134:137], 0
    v_rsq_f32 v254, v254
    v_mfma_f32_16x16x32_bf16 v[214:217], a[124:127], v[154:157], v[214:217]
    v_mul_f32 v142, v254, v142
    v_mul_f32 v143, v254, v143
    v_mfma_f32_16x16x32_bf16 v[214:217], a[128:131], v[130:133], v[214:217]
    v_cvt_pk_bf16_f32 v142, v142, v143
    v_cvt_pk_f16_f32 v172, v210, v211
    v_mfma_f32_16x16x32_bf16 v[214:217], a[132:135], v[122:125], v[214:217]
    v_pk_fma_f16 v163, v172, v172, v163
    v_cvt_pk_f16_f32 v173, v212, v213
    v_mfma_f32_16x16x32_bf16 v[214:217], a[136:139], v[126:129], v[214:217]
    v_pk_fma_f16 v165, v173, v173, v165
    v_mul_f32 v144, v254, v144
    v_mfma_f32_16x16x32_bf16 v[214:217], a[140:143], v[166:169], v[214:217]
    v_mul_f32 v145, v254, v145
    v_cvt_pk_bf16_f32 v143, v144, v145
    v_mfma_f32_16x16x32_bf16 v[210:213], a[0:3], v[134:137], 0
    v_mul_f32 v158, v254, v158
    v_mul_f32 v159, v254, v159
    v_mfma_f32_16x16x32_bf16 v[210:213], a[4:7], v[154:157], v[210:213]
    v_cvt_pk_bf16_f32 v144, v158, v159
    v_mul_f32 v160, v254, v160
    v_mfma_f32_16x16x32_bf16 v[210:213], a[8:11], v[130:133], v[210:213]
    v_cvt_pk_f16_f32 v220, v214, v215
    v_pk_fma_f16 v163, v220, v220, v163
    v_mfma_f32_16x16x32_bf16 v[210:213], a[12:15], v[122:125], v[210:213]
    v_cvt_pk_f16_f32 v221, v216, v217
    v_pk_fma_f16 v165, v221, v221, v165
    v_mfma_f32_16x16x32_bf16 v[210:213], a[16:19], v[126:129], v[210:213]
    v_mul_f32 v161, v254, v161
    v_cvt_pk_bf16_f32 v145, v160, v161
    v_mfma_f32_16x16x32_bf16 v[210:213], a[20:23], v[166:169], v[210:213]
    buffer_store_dwordx4 v[142:145], v16, s[12:15], 0 offen nt
    v_mul_f32 v178, v254, v178
    v_mul_f32 v179, v254, v179
    v_cvt_pk_bf16_f32 v116, v178, v179
    v_mul_f32 v180, v254, v180
    v_mfma_f32_16x16x32_bf16 v[142:145], a[24:27], v[134:137], 0
    v_mul_f32 v181, v254, v181
    v_cvt_pk_bf16_f32 v117, v180, v181
    v_mfma_f32_16x16x32_bf16 v[142:145], a[28:31], v[154:157], v[142:145]
    v_cvt_pk_f16_f32 v158, v210, v211
    v_pk_mul_f16 v162, v158, v158
    v_mfma_f32_16x16x32_bf16 v[142:145], a[32:35], v[130:133], v[142:145]
    v_cvt_pk_f16_f32 v159, v212, v213
    v_pk_mul_f16 v164, v159, v159
    v_mfma_f32_16x16x32_bf16 v[142:145], a[36:39], v[122:125], v[142:145]
    v_mul_f32 v254, 0x3baaaaab, v200
    v_mul_f32 v150, v255, v150
    v_mfma_f32_16x16x32_bf16 v[142:145], a[40:43], v[126:129], v[142:145]
    v_rsq_f32 v254, v254
    v_mfma_f32_16x16x32_bf16 v[142:145], a[44:47], v[166:169], v[142:145]
    v_mul_f32 v151, v255, v151
    v_cvt_pk_bf16_f32 v150, v150, v151
    v_mfma_f32_16x16x32_bf16 v[178:181], a[48:51], v[134:137], 0
    v_mul_f32 v152, v255, v152
    v_mul_f32 v153, v255, v153
    v_mfma_f32_16x16x32_bf16 v[178:181], a[52:55], v[154:157], v[178:181]
    v_cvt_pk_bf16_f32 v151, v152, v153
    v_mul_f32 v190, v255, v190
    v_mfma_f32_16x16x32_bf16 v[178:181], a[56:59], v[130:133], v[178:181]
    v_cvt_pk_f16_f32 v160, v142, v143
    v_pk_fma_f16 v162, v160, v160, v162
    v_mfma_f32_16x16x32_bf16 v[178:181], a[60:63], v[122:125], v[178:181]
    v_cvt_pk_f16_f32 v161, v144, v145
    v_pk_fma_f16 v164, v161, v161, v164
    v_mfma_f32_16x16x32_bf16 v[178:181], a[64:67], v[126:129], v[178:181]
    v_mul_f32 v191, v255, v191
    v_cvt_pk_bf16_f32 v152, v190, v191
    v_mfma_f32_16x16x32_bf16 v[178:181], a[68:71], v[166:169], v[178:181]
    v_mul_f32 v192, v255, v192
    v_mul_f32 v193, v255, v193
    v_mfma_f32_16x16x32_bf16 v[142:145], v[134:137], a[144:147], 0
    v_cvt_pk_bf16_f32 v153, v192, v193
    v_mul_f32 v202, v255, v202
    v_mfma_f32_16x16x32_bf16 v[142:145], v[154:157], a[148:151], v[142:145]
    v_mul_f32 v203, v255, v203
    v_cvt_pk_bf16_f32 v202, v202, v203
    v_mfma_f32_16x16x32_bf16 v[142:145], v[130:133], a[152:155], v[142:145]
    v_cvt_pk_f16_f32 v218, v178, v179
    v_pk_fma_f16 v162, v218, v218, v162
    v_mfma_f32_16x16x32_bf16 v[142:145], v[122:125], a[156:159], v[142:145]
    v_cvt_pk_f16_f32 v219, v180, v181
    v_pk_fma_f16 v164, v219, v219, v164
    v_mfma_f32_16x16x32_bf16 v[142:145], v[126:129], a[160:163], v[142:145]
    buffer_store_dwordx2 v[116:117], v19, s[12:15], 0 offen nt
    v_mul_f32 v204, v255, v204
    v_mul_f32 v205, v255, v205
    v_mfma_f32_16x16x32_f16 v[190:193], v[40:43], v[162:165], 0
    v_cvt_pk_bf16_f32 v203, v204, v205
    v_mul_f32 v146, v254, v146
    v_mfma_f32_16x16x32_bf16 v[142:145], v[166:169], a[164:167], v[142:145]
    v_mul_f32 v147, v254, v147
    v_cvt_pk_bf16_f32 v146, v146, v147
    v_mfma_f32_16x16x32_bf16 v[178:181], v[134:137], a[168:171], 0
    v_mul_f32 v148, v254, v148
    v_mul_f32 v149, v254, v149
    v_mfma_f32_16x16x32_bf16 v[178:181], v[154:157], a[172:175], v[178:181]
    v_rsq_f32 v192, v190
    v_mfma_f32_16x16x32_bf16 v[178:181], v[130:133], a[176:179], v[178:181]
    v_cvt_pk_bf16_f32 v176, v142, v143
    v_cvt_pk_bf16_f32 v177, v144, v145
    v_mfma_f32_16x16x32_bf16 v[178:181], v[122:125], a[180:183], v[178:181]
    ds_read_b128 v[142:145], v0 offset:32768
    v_mul_f32 v192, s31, v192
    v_mfma_f32_16x16x32_bf16 v[178:181], v[126:129], a[184:187], v[178:181]
    ds_read_b128 v[162:165], v1 offset:32768
    v_min3_u32 v44, v44, v190, v191
    v_mfma_f32_16x16x32_bf16 v[178:181], v[166:169], a[188:191], v[178:181]
    ds_read_b128 v[210:213], v0 offset:32896
    v_max3_u32 v45, v45, v190, v191
    v_mfma_f32_16x16x32_bf16 v[198:201], v[134:137], a[192:195], 0
    ds_read_b128 v[134:137], v1 offset:32896
    v_cvt_pk_bf16_f32 v147, v148, v149
    v_mfma_f32_16x16x32_bf16 v[198:201], v[154:157], a[196:199], v[198:201]
    ds_read_b128 v[154:157], v0 offset:33024
    v_mul_f32 v138, v254, v138
    v_mfma_f32_16x16x32_bf16 v[198:201], v[130:133], a[200:203], v[198:201]
    ds_read_b128 v[130:133], v1 offset:33024
    v_cvt_pk_bf16_f32 v184, v178, v179
    v_mfma_f32_16x16x32_bf16 v[198:201], v[122:125], a[204:207], v[198:201]
    v_rsq_f32 v193, v191
    v_mfma_f32_16x16x32_bf16 v[198:201], v[126:129], a[208:211], v[198:201]
    v_cvt_pk_f16_f32 v192, v192, v193
    v_cvt_pk_bf16_f32 v185, v180, v181
    v_mfma_f32_16x16x32_bf16 v[198:201], v[166:169], a[212:215], v[198:201]
    s_waitcnt lgkmcnt(5)
    v_pk_mul_f16 v170, v170, v192 op_sel:[0,1] op_sel_hi:[1,1]
    v_pk_mul_f16 v171, v171, v192 op_sel:[0,1] op_sel_hi:[1,1]
    v_mfma_f32_16x16x32_bf16 v[178:181], a[72:75], v[142:145], 0
    s_waitcnt lgkmcnt(4)
    v_pk_mul_f16 v172, v172, v192 op_sel:[0,1] op_sel_hi:[1,1]
    v_pk_mul_f16 v173, v173, v192 op_sel:[0,1] op_sel_hi:[1,1]
    v_mfma_f32_16x16x32_bf16 v[178:181], a[76:79], v[162:165], v[178:181]
    s_waitcnt lgkmcnt(3)
    v_cvt_pk_bf16_f32 v116, v198, v199
    v_cvt_pk_bf16_f32 v117, v200, v201
    v_mfma_f32_16x16x32_bf16 v[178:181], a[80:83], v[210:213], v[178:181]
    s_waitcnt lgkmcnt(2)
    buffer_store_dwordx4 v[150:153], v15, s[12:15], 0 offen nt
    v_pk_mul_f16 v220, v220, v192 op_sel:[0,1] op_sel_hi:[1,1]
    v_pk_mul_f16 v221, v221, v192 op_sel:[0,1] op_sel_hi:[1,1]
    v_pk_mul_f16 v158, v158, v192 op_sel:[0,0] op_sel_hi:[1,0]
    v_pk_mul_f16 v159, v159, v192 op_sel:[0,0] op_sel_hi:[1,0]
    v_mfma_f32_16x16x32_bf16 v[178:181], a[84:87], v[134:137], v[178:181]
    s_waitcnt lgkmcnt(0)
    v_pk_mul_f16 v160, v160, v192 op_sel:[0,0] op_sel_hi:[1,0]
    v_pk_mul_f16 v161, v161, v192 op_sel:[0,0] op_sel_hi:[1,0]
    v_mfma_f32_16x16x32_bf16 v[178:181], a[88:91], v[154:157], v[178:181]
    v_pk_mul_f16 v218, v218, v192 op_sel:[0,0] op_sel_hi:[1,0]
    v_pk_mul_f16 v219, v219, v192 op_sel:[0,0] op_sel_hi:[1,0]
    v_mfma_f32_16x16x32_bf16 v[178:181], a[92:95], v[130:133], v[178:181]
    v_mul_f32 v139, v254, v139
    v_cvt_pk_bf16_f32 v148, v138, v139
    v_mfma_f32_16x16x32_bf16 v[150:153], a[96:99], v[142:145], 0
    v_mul_f32 v140, v254, v140
    v_mul_f32 v141, v254, v141
    v_mfma_f32_16x16x32_bf16 v[150:153], a[100:103], v[162:165], v[150:153]
    v_cvt_pk_bf16_f32 v149, v140, v141
    v_mul_f32 v186, v254, v186
    v_mfma_f32_16x16x32_bf16 v[150:153], a[104:107], v[210:213], v[150:153]
    v_cvt_pk_f16_f32 v178, v178, v179
    v_pk_mul_f16 v191, v178, v178
    v_mfma_f32_16x16x32_bf16 v[150:153], a[108:111], v[134:137], v[150:153]
    v_cvt_pk_f16_f32 v179, v180, v181
    v_pk_mul_f16 v193, v179, v179
    v_mfma_f32_16x16x32_bf16 v[150:153], a[112:115], v[154:157], v[150:153]
    v_mul_f32 v187, v254, v187
    v_cvt_pk_bf16_f32 v204, v186, v187
    v_mfma_f32_16x16x32_bf16 v[150:153], a[116:119], v[130:133], v[150:153]
    v_mul_f32 v188, v254, v188
    v_mul_f32 v189, v254, v189
    v_mfma_f32_16x16x32_bf16 v[138:141], a[120:123], v[142:145], 0
    s_waitcnt vmcnt(3)
    v_cvt_pk_bf16_f32 v205, v188, v189
    v_xor_b32 v0, 65536, v0
    v_mfma_f32_16x16x32_bf16 v[138:141], a[124:127], v[162:165], v[138:141]
    v_mfma_f32_16x16x32_bf16 v[138:141], a[128:131], v[210:213], v[138:141]
    v_mfma_f32_16x16x32_bf16 v[138:141], a[132:135], v[134:137], v[138:141]
    s_barrier
    v_mfma_f32_16x16x32_bf16 v[138:141], a[136:139], v[154:157], v[138:141]
    v_mfma_f32_16x16x32_bf16 v[138:141], a[140:143], v[130:133], v[138:141]
    v_cvt_pk_f16_f32 v180, v150, v151
    v_pk_fma_f16 v191, v180, v180, v191
    v_mfma_f32_16x16x32_bf16 v[186:189], a[0:3], v[142:145], 0
    v_cvt_pk_f16_f32 v181, v152, v153
    v_pk_fma_f16 v193, v181, v181, v193
    v_mfma_f32_16x16x32_bf16 v[186:189], a[4:7], v[162:165], v[186:189]
    buffer_load_dwordx4 v10, s[8:11], 0 offen nt lds
    v_xor_b32 v1, 65536, v1
    v_mfma_f32_16x16x32_bf16 v[186:189], a[8:11], v[210:213], v[186:189]
    s_add_u32 m0, s28, 4096
    v_cvt_pk_f16_f32 v124, v138, v139
    v_pk_fma_f16 v191, v124, v124, v191
    v_mfma_f32_16x16x32_bf16 v[186:189], a[12:15], v[134:137], v[186:189]
    v_cvt_pk_f16_f32 v125, v140, v141
    v_pk_fma_f16 v193, v125, v125, v193
    v_mfma_f32_16x16x32_bf16 v[186:189], a[16:19], v[154:157], v[186:189]
    v_mfma_f32_16x16x32_bf16 v[186:189], a[20:23], v[130:133], v[186:189]
    v_mfma_f32_16x16x32_bf16 v[150:153], a[24:27], v[142:145], 0
    buffer_load_dwordx4 v11, s[8:11], 0 offen nt lds
    s_add_u32 m0, s28, 8192
    v_mfma_f32_16x16x32_bf16 v[150:153], a[28:31], v[162:165], v[150:153]
    v_mfma_f32_16x16x32_bf16 v[150:153], a[32:35], v[210:213], v[150:153]
    v_mfma_f32_16x16x32_bf16 v[150:153], a[36:39], v[134:137], v[150:153]
    v_mfma_f32_16x16x32_bf16 v[150:153], a[40:43], v[154:157], v[150:153]
    v_mfma_f32_16x16x32_bf16 v[150:153], a[44:47], v[130:133], v[150:153]
    buffer_load_dwordx4 v12, s[8:11], 0 offen nt lds
    v_cvt_pk_f16_f32 v186, v186, v187
    v_mfma_f32_16x16x32_bf16 v[138:141], a[48:51], v[142:145], 0
    s_add_u32 m0, s28, 12288
    v_pk_mul_f16 v190, v186, v186
    v_cvt_pk_f16_f32 v187, v188, v189
    v_mfma_f32_16x16x32_bf16 v[138:141], a[52:55], v[162:165], v[138:141]
    s_xor_b32 s28, s28, 65536
    ds_read_b128 v[166:169], v5 offset:0
    ds_read_b128 v[126:129], v5 offset:16
    v_mfma_f32_16x16x32_bf16 v[138:141], a[56:59], v[210:213], v[138:141]
    ds_read_b128 v[198:201], v5 offset:48
    ds_read_b32 v254, v6 offset:192
    v_mfma_f32_16x16x32_bf16 v[138:141], a[60:63], v[134:137], v[138:141]
    v_pk_mul_f16 v192, v187, v187
    v_cvt_pk_f16_f32 v188, v150, v151
    v_mfma_f32_16x16x32_bf16 v[138:141], a[64:67], v[154:157], v[138:141]
    buffer_load_dwordx4 v13, s[8:11], 0 offen nt lds
    v_pk_fma_f16 v190, v188, v188, v190
    v_mfma_f32_16x16x32_bf16 v[138:141], a[68:71], v[130:133], v[138:141]
    s_mov_b32 m0, s29
    v_cvt_pk_f16_f32 v189, v152, v153
    v_pk_fma_f16 v192, v189, v189, v192
    v_mfma_f32_16x16x32_bf16 v[150:153], v[142:145], a[144:147], 0
    s_xor_b32 s29, s29, s30
    v_add_u32 v5, 336, v5
    s_add_u32 s19, s19, s20
    v_mfma_f32_16x16x32_bf16 v[150:153], v[162:165], a[148:151], v[150:153]
    s_add_u32 s23, s23, s21
    v_cvt_pk_f16_f32 v122, v138, v139
    v_pk_fma_f16 v190, v122, v122, v190
    v_mfma_f32_16x16x32_bf16 v[150:153], v[210:213], a[152:155], v[150:153]
    s_cmp_ge_u32 s19, 72
    v_cvt_pk_f16_f32 v123, v140, v141
    v_pk_fma_f16 v192, v123, v123, v192
    v_mfma_f32_16x16x32_bf16 v[150:153], v[134:137], a[156:159], v[150:153]
    s_waitcnt lgkmcnt(2)
    buffer_store_dwordx2 v[202:203], v18, s[12:15], 0 offen nt
    s_cselect_b32 s34, 72, 0
    s_cselect_b32 s35, s22, 0
    v_mfma_f32_16x16x32_f16 v[138:141], v[40:43], v[190:193], 0
    s_sub_u32 s19, s19, s34
    s_add_u32 s23, s23, s35
    s_add_u32 s18, s18, 1
    v_mfma_f32_16x16x32_f16 v[214:217], v[166:169], v[158:161], v[24:27]
    s_cmp_lt_u32 s18, s45
    v_mfma_f32_16x16x32_f16 v[214:217], v[126:129], v[170:173], v[214:217]
    s_waitcnt lgkmcnt(0)
    v_mfma_f32_16x16x32_f16 v[214:217], v[198:201], v[218:221], v[214:217]
    v_rsq_f32 v140, v138
    v_mfma_f32_16x16x32_f16 v[190:193], v[166:169], v[206:209], v[22:25]
    v_rsq_f32 v141, v139
    v_mfma_f32_16x16x32_f16 v[190:193], v[126:129], v[118:121], v[190:193]
    v_mul_f32 v140, s31, v140
    v_cvt_pk_f16_f32 v140, v140, v141
    v_mfma_f32_16x16x32_f16 v[190:193], v[198:201], v[194:197], v[190:193]
    v_pk_mul_f16 v178, v178, v140 op_sel:[0,1] op_sel_hi:[1,1]
    v_pk_mul_f16 v179, v179, v140 op_sel:[0,1] op_sel_hi:[1,1]
    v_mfma_f32_16x16x32_bf16 v[150:153], v[154:157], a[160:163], v[150:153]
    v_pk_mul_f16 v180, v180, v140 op_sel:[0,1] op_sel_hi:[1,1]
    v_pk_mul_f16 v181, v181, v140 op_sel:[0,1] op_sel_hi:[1,1]
    v_mfma_f32_16x16x32_bf16 v[150:153], v[130:133], a[164:167], v[150:153]
    v_pk_mul_f16 v124, v124, v140 op_sel:[0,1] op_sel_hi:[1,1]
    v_pk_mul_f16 v125, v125, v140 op_sel:[0,1] op_sel_hi:[1,1]
    v_mfma_f32_16x16x32_bf16 v[222:225], v[142:145], a[168:171], 0
    v_mov_b32_dpp v254, v191 quad_perm:[0,1,2,3] row_mask:0x1 bank_mask:0xf
    v_mov_b32_dpp v254, v215 quad_perm:[0,1,2,3] row_mask:0x2 bank_mask:0xf
    v_mfma_f32_16x16x32_bf16 v[222:225], v[162:165], a[172:175], v[222:225]
    v_pk_mul_f16 v186, v186, v140 op_sel:[0,0] op_sel_hi:[1,0]
    v_pk_mul_f16 v187, v187, v140 op_sel:[0,0] op_sel_hi:[1,0]
    v_mfma_f32_16x16x32_bf16 v[222:225], v[210:213], a[176:179], v[222:225]
    v_cvt_pk_bf16_f32 v226, v150, v151
    v_cvt_pk_bf16_f32 v227, v152, v153
    v_mfma_f32_16x16x32_bf16 v[222:225], v[134:137], a[180:183], v[222:225]
    v_pk_mul_f16 v188, v188, v140 op_sel:[0,0] op_sel_hi:[1,0]
    v_pk_mul_f16 v189, v189, v140 op_sel:[0,0] op_sel_hi:[1,0]
    v_mfma_f32_16x16x32_f16 v[230:233], v[118:121], v[206:209], v[46:49]
    v_pk_mul_f16 v122, v122, v140 op_sel:[0,0] op_sel_hi:[1,0]
    v_pk_mul_f16 v123, v123, v140 op_sel:[0,0] op_sel_hi:[1,0]
    v_mfma_f32_16x16x32_f16 v[234:237], v[170:173], v[206:209], v[50:53]
    v_min3_u32 v44, v44, v138, v139
    v_max3_u32 v45, v45, v138, v139
    v_mfma_f32_16x16x32_f16 v[138:141], v[178:181], v[206:209], v[54:57]
    v_exp_f32 v214, v214
    v_mfma_f32_16x16x16_f16 v[230:233], v[196:197], v[194:195], v[230:233]
    buffer_store_dwordx4 v[146:149], v17, s[12:15], 0 offen nt
    v_exp_f32 v190, v190
    v_mfma_f32_16x16x16_f16 v[234:237], v[220:221], v[194:195], v[234:237]
    v_cvt_pk_bf16_f32 v39, v190, 0
    v_mfma_f32_16x16x16_f16 v[138:141], v[124:125], v[194:195], v[138:141]
    v_mfma_f32_16x16x32_bf16 v[222:225], v[154:157], a[184:187], v[222:225]
    v_mfma_f32_16x16x32_bf16 v[222:225], v[130:133], a[188:191], v[222:225]
    ds_read_b128 v[146:149], v2 offset:0
    v_mfma_f32_16x16x32_bf16 v[150:153], v[142:145], a[192:195], 0
    ds_read_b128 v[142:145], v2 offset:1024
    v_mfma_f32_16x16x32_bf16 v[150:153], v[162:165], a[196:199], v[150:153]
    ds_read_b128 v[206:209], v2 offset:2048
    v_mfma_f32_16x16x32_bf16 v[150:153], v[210:213], a[200:203], v[150:153]
    ds_read_b128 v[162:165], v2 offset:3072
    v_mfma_f32_16x16x32_bf16 v[150:153], v[134:137], a[204:207], v[150:153]
    ds_read_b128 v[134:137], v2 offset:4096
    v_cvt_pk_bf16_f32 v210, v222, v223
    v_mfma_f32_16x16x32_bf16 v[150:153], v[154:157], a[208:211], v[150:153]
    ds_read_b128 v[154:157], v2 offset:5120
    v_cvt_pk_bf16_f32 v211, v224, v225
    v_mfma_f32_16x16x32_bf16 v[150:153], v[130:133], a[212:215], v[150:153]
    ds_read2_b32 v[228:229], v6 offset0:0 offset1:0
    ds_read2_b32 v[212:213], v6 offset0:16 offset1:16
    v_mfma_f32_16x16x32_f16 v[130:133], v[166:169], v[186:189], v[26:29]
    ds_read2_b32 v[168:169], v6 offset0:32 offset1:32
    v_add_u32 v6, 272, v6
    v_mfma_f32_16x16x32_f16 v[130:133], v[126:129], v[178:181], v[130:133]
    s_waitcnt lgkmcnt(8)
    v_exp_f32 v230, v230
    v_mfma_f32_16x16x32_f16 v[130:133], v[198:201], v[122:125], v[130:133]
    s_waitcnt lgkmcnt(7)
    v_cvt_pk_bf16_f32 v166, v150, v151
    v_cvt_pk_bf16_f32 v167, v152, v153
    v_mfma_f32_16x16x32_bf16 v[150:153], a[216:219], v[146:149], 0
    s_waitcnt lgkmcnt(6)
    v_exp_f32 v231, v231
    v_mfma_f32_16x16x32_bf16 v[150:153], a[220:223], v[142:145], v[150:153]
    s_waitcnt lgkmcnt(5)
    v_exp_f32 v130, v130
    v_mfma_f32_16x16x32_bf16 v[150:153], a[224:227], v[206:209], v[150:153]
    s_waitcnt lgkmcnt(4)
    buffer_store_dwordx2 v[204:205], v20, s[12:15], 0 offen nt
    v_mov_b32_dpp v254, v131 quad_perm:[0,1,2,3] row_mask:0x4 bank_mask:0xf
    v_cvt_pk_bf16_f32 v126, v230, v231
    v_mfma_f32_16x16x32_bf16 v[150:153], a[228:231], v[162:165], v[150:153]
    s_waitcnt lgkmcnt(3)
    v_exp_f32 v254, v254
    v_mfma_f32_16x16x32_bf16 v[150:153], a[232:235], v[134:137], v[150:153]
    s_waitcnt lgkmcnt(1)
    v_exp_f32 v232, v232
    v_mfma_f32_16x16x32_bf16 v[150:153], a[236:239], v[154:157], v[150:153]
    s_waitcnt lgkmcnt(0)
    v_exp_f32 v233, v233
    v_mfma_f32_16x16x32_bf16 v[190:193], a[240:243], v[146:149], 0
    v_cvt_pk_bf16_f32 v254, v254, v254
    v_cvt_pk_bf16_f32 v127, v232, v233
    v_mfma_f32_16x16x32_bf16 v[190:193], a[244:247], v[142:145], v[190:193]
    ds_write_b16 v8, v254
    v_mfma_f32_16x16x32_bf16 v[190:193], a[248:251], v[206:209], v[190:193]
    v_exp_f32 v234, v234
    v_mfma_f32_16x16x32_bf16 v[190:193], a[252:255], v[162:165], v[190:193]
    ds_read_b128 v[198:201], v2 offset:6144
    ds_read_b128 v[230:233], v9
    v_mfma_f32_16x16x32_bf16 v[190:193], v[82:85], v[134:137], v[190:193]
    ds_read_b128 v[222:225], v2 offset:7168
    ds_read_b128 v[238:241], v9 offset:64
    v_mfma_f32_16x16x32_bf16 v[190:193], v[86:89], v[154:157], v[190:193]
    v_exp_f32 v235, v235
    v_mfma_f32_16x16x32_bf16 v[202:205], v[90:93], v[146:149], 0
    ds_read_b128 v[146:149], v2 offset:8192
    ds_read_b128 v[242:245], v2 offset:9216
    v_mfma_f32_16x16x32_bf16 v[202:205], v[94:97], v[142:145], v[202:205]
    v_cvt_pk_bf16_f32 v128, v234, v235
    v_fma_f32 v254, v150, v150, s33
    v_mfma_f32_16x16x32_bf16 v[202:205], v[98:101], v[206:209], v[202:205]
    ds_read_b128 v[206:209], v2 offset:10240
    ds_read_b128 v[246:249], v2 offset:11264
    v_mfma_f32_16x16x32_bf16 v[202:205], v[102:105], v[162:165], v[202:205]
    v_exp_f32 v236, v236
    v_mfma_f32_16x16x32_bf16 v[202:205], v[106:109], v[134:137], v[202:205]
    v_exp_f32 v237, v237
    v_mfma_f32_16x16x32_bf16 v[202:205], v[110:113], v[154:157], v[202:205]
    s_waitcnt lgkmcnt(6)
    v_cvt_pk_bf16_f32 v129, v236, v237
    v_fmac_f32 v254, v151, v151
    v_mfma_f32_16x16x32_bf16 v[142:145], v[230:233], v[28:31], 0
    s_waitcnt lgkmcnt(4)
    v_exp_f32 v138, v138
    v_mfma_f32_16x16x32_bf16 v[142:145], v[238:241], v[28:31], v[142:145]
    v_fmac_f32 v254, v152, v152
    v_mfma_f32_16x16x32_bf16 v[134:137], v[230:233], v[174:177], 0
    s_waitcnt lgkmcnt(2)
    v_exp_f32 v139, v139
    v_mfma_f32_16x16x32_bf16 v[134:137], v[238:241], v[226:229], v[134:137]
    v_cvt_pk_bf16_f32 v36, v138, v139
    v_fmac_f32 v254, v153, v153
    v_mfma_f32_16x16x32_bf16 v[154:157], v[230:233], v[182:185], 0
    s_waitcnt lgkmcnt(0)
    v_rcp_f32 v142, v142
    v_mfma_f32_16x16x32_bf16 v[154:157], v[238:241], v[210:213], v[154:157]
    v_exp_f32 v140, v140
    v_mfma_f32_16x16x32_bf16 v[162:165], v[230:233], v[114:117], 0
    v_mul_f32 v134, v134, v142
    v_fmac_f32 v254, v190, v190
    v_mfma_f32_16x16x32_bf16 v[162:165], v[238:241], v[166:169], v[162:165]
    v_exp_f32 v141, v141
    v_mfma_f32_16x16x32_f16 v[230:233], v[118:121], v[158:161], v[58:61]
    v_cvt_pk_bf16_f32 v37, v140, v141
    v_mul_f32_dpp v134, v154, v142 quad_perm:[0,1,2,3] row_mask:0x2 bank_mask:0xf
    v_mfma_f32_16x16x32_f16 v[138:141], v[170:173], v[158:161], v[62:65]
    v_fmac_f32 v254, v191, v191
    v_fmac_f32 v254, v192, v192
    v_mfma_f32_16x16x32_f16 v[154:157], v[178:181], v[158:161], v[66:69]
    v_mul_f32_dpp v134, v162, v142 quad_perm:[0,1,2,3] row_mask:0x4 bank_mask:0xf
    v_cvt_pk_bf16_f32 v134, v134, v134
    v_fmac_f32 v254, v193, v193
    v_mfma_f32_16x16x16_f16 v[230:233], v[196:197], v[218:219], v[230:233]
    v_fmac_f32 v254, v202, v202
    v_fmac_f32 v254, v203, v203
    v_fmac_f32 v254, v204, v204
    v_mfma_f32_16x16x16_f16 v[138:141], v[220:221], v[218:219], v[138:141]
    v_fmac_f32 v254, v205, v205
    v_mfma_f32_16x16x16_f16 v[154:157], v[124:125], v[218:219], v[154:157]
    ds_write_b16 v7, v134
    v_add_u32 v7, 16, v7
    v_mfma_f32_16x16x32_bf16 v[134:137], v[28:31], v[36:39], 0
    v_exp_f32 v230, v230
    v_mfma_f32_16x16x32_bf16 v[134:137], v[28:31], v[126:129], v[134:137]
    v_exp_f32 v231, v231
    v_mfma_f32_16x16x32_bf16 v[158:161], v[226:229], v[36:39], 0
    v_exp_f32 v232, v232
    v_mfma_f32_16x16x32_bf16 v[158:161], v[174:177], v[126:129], v[158:161]
    v_exp_f32 v233, v233
    v_mfma_f32_16x16x32_bf16 v[162:165], v[210:213], v[36:39], 0
    v_cvt_pk_bf16_f32 v230, v230, v231
    v_cvt_pk_bf16_f32 v231, v232, v233
    v_mfma_f32_16x16x32_bf16 v[162:165], v[182:185], v[126:129], v[162:165]
    v_exp_f32 v138, v138
    v_mfma_f32_16x16x32_bf16 v[234:237], v[166:169], v[36:39], 0
    v_exp_f32 v139, v139
    v_mfma_f32_16x16x32_bf16 v[234:237], v[114:117], v[126:129], v[234:237]
    v_cvt_pk_bf16_f32 v232, v138, v139
    v_cvt_pk_bf16_f32 v39, v214, 0
    v_mfma_f32_16x16x32_f16 v[126:129], v[118:121], v[186:189], v[70:73]
    v_exp_f32 v140, v140
    v_mfma_f32_16x16x32_f16 v[118:121], v[170:173], v[186:189], v[74:77]
    v_exp_f32 v141, v141
    v_mfma_f32_16x16x32_bf16 v[142:145], a[216:219], v[198:201], 0
    v_exp_f32 v154, v154
    v_mfma_f32_16x16x32_bf16 v[142:145], a[220:223], v[222:225], v[142:145]
    v_cvt_pk_bf16_f32 v233, v140, v141
    v_exp_f32 v155, v155
    v_mfma_f32_16x16x32_f16 v[138:141], v[178:181], v[186:189], v[78:81]
    v_cvt_pk_bf16_f32 v36, v154, v155
    v_exp_f32 v156, v156
    v_mfma_f32_16x16x16_f16 v[126:129], v[196:197], v[122:123], v[126:129]
    v_exp_f32 v157, v157
    v_mfma_f32_16x16x16_f16 v[118:121], v[220:221], v[122:123], v[118:121]
    v_cvt_pk_bf16_f32 v37, v156, v157
    v_rcp_f32 v134, v134
    v_mfma_f32_16x16x16_f16 v[138:141], v[124:125], v[122:123], v[138:141]
    v_mul_f32 v158, v134, v158
    v_mul_f32 v159, v134, v159
    v_cvt_pk_bf16_f32 v186, v158, v159
    v_mul_f32 v160, v134, v160
    v_mfma_f32_16x16x32_bf16 v[154:157], v[28:31], v[36:39], 0
    v_exp_f32 v126, v126
    v_mfma_f32_16x16x32_bf16 v[154:157], v[28:31], v[230:233], v[154:157]
    v_exp_f32 v127, v127
    v_mfma_f32_16x16x32_bf16 v[194:197], v[226:229], v[36:39], 0
    v_cvt_pk_bf16_f32 v170, v126, v127
    v_mul_f32 v161, v134, v161
    v_mfma_f32_16x16x32_bf16 v[194:197], v[174:177], v[230:233], v[194:197]
    v_exp_f32 v128, v128
    v_mfma_f32_16x16x32_bf16 v[122:125], v[210:213], v[36:39], 0
    v_exp_f32 v129, v129
    v_mfma_f32_16x16x32_bf16 v[122:125], v[182:185], v[230:233], v[122:125]
    v_cvt_pk_bf16_f32 v171, v128, v129
    v_cvt_pk_bf16_f32 v187, v160, v161
    v_mfma_f32_16x16x32_bf16 v[126:129], v[166:169], v[36:39], 0
    ds_write_b64 v3, v[186:187] offset:0
    v_mfma_f32_16x16x32_bf16 v[126:129], v[114:117], v[230:233], v[126:129]
    v_exp_f32 v118, v118
    v_mfma_f32_16x16x32_bf16 v[142:145], a[224:227], v[146:149], v[142:145]
    v_exp_f32 v119, v119
    v_mfma_f32_16x16x32_bf16 v[142:145], a[228:231], v[242:245], v[142:145]
    v_cvt_pk_bf16_f32 v172, v118, v119
    v_cvt_pk_bf16_f32 v39, v130, 0
    v_mfma_f32_16x16x32_bf16 v[142:145], a[232:235], v[206:209], v[142:145]
    v_exp_f32 v120, v120
    v_mfma_f32_16x16x32_bf16 v[142:145], a[236:239], v[246:249], v[142:145]
    v_exp_f32 v121, v121
    v_mfma_f32_16x16x32_bf16 v[158:161], a[240:243], v[198:201], 0
    v_cvt_pk_bf16_f32 v173, v120, v121
    v_mul_f32 v162, v134, v162
    v_mfma_f32_16x16x32_bf16 v[158:161], a[244:247], v[222:225], v[158:161]
    v_exp_f32 v138, v138
    v_mfma_f32_16x16x32_bf16 v[158:161], a[248:251], v[146:149], v[158:161]
    v_exp_f32 v139, v139
    v_mfma_f32_16x16x32_bf16 v[158:161], a[252:255], v[242:245], v[158:161]
    ds_read_b128 v[118:121], v2 offset:12288
    v_cvt_pk_bf16_f32 v36, v138, v139
    v_mfma_f32_16x16x32_bf16 v[158:161], v[82:85], v[206:209], v[158:161]
    ds_read_b128 v[130:133], v2 offset:13312
    v_fma_f32 v255, v142, v142, s33
    v_mfma_f32_16x16x32_bf16 v[158:161], v[86:89], v[246:249], v[158:161]
    ds_read_b128 v[218:221], v2 offset:14336
    v_fmac_f32 v255, v143, v143
    v_mfma_f32_16x16x32_bf16 v[178:181], v[90:93], v[198:201], 0
    ds_read_b128 v[198:201], v2 offset:15360
    v_fmac_f32 v255, v144, v144
    v_mfma_f32_16x16x32_bf16 v[178:181], v[94:97], v[222:225], v[178:181]
    ds_read_b128 v[222:225], v2 offset:16384
    v_fmac_f32 v255, v145, v145
    v_mfma_f32_16x16x32_bf16 v[178:181], v[98:101], v[146:149], v[178:181]
    ds_read_b128 v[230:233], v2 offset:17408
    v_fmac_f32 v255, v158, v158
    v_mfma_f32_16x16x32_bf16 v[178:181], v[102:105], v[242:245], v[178:181]
    v_exp_f32 v140, v140
    v_mfma_f32_16x16x32_bf16 v[178:181], v[106:109], v[206:209], v[178:181]
    v_exp_f32 v141, v141
    v_mfma_f32_16x16x32_bf16 v[178:181], v[110:113], v[246:249], v[178:181]
    s_waitcnt lgkmcnt(5)
    v_cvt_pk_bf16_f32 v37, v140, v141
    v_fmac_f32 v255, v159, v159
    v_mfma_f32_16x16x32_bf16 v[146:149], a[216:219], v[118:121], 0
    s_waitcnt lgkmcnt(4)
    v_fmac_f32 v255, v160, v160
    v_fmac_f32 v255, v161, v161
    v_mfma_f32_16x16x32_bf16 v[242:245], v[28:31], v[36:39], 0
    s_waitcnt lgkmcnt(3)
    v_fmac_f32 v255, v178, v178
    v_fmac_f32 v255, v179, v179
    v_mfma_f32_16x16x32_bf16 v[242:245], v[28:31], v[170:173], v[242:245]
    s_waitcnt lgkmcnt(2)
    v_fmac_f32 v255, v180, v180
    v_fmac_f32 v255, v181, v181
    v_mfma_f32_16x16x32_bf16 v[206:209], v[226:229], v[36:39], 0
    s_waitcnt lgkmcnt(1)
    v_cvt_pk_bf16_f32 v254, v254, v255
    v_mul_f32 v163, v134, v163
    v_mfma_f32_16x16x32_bf16 v[206:209], v[174:177], v[170:173], v[206:209]
    s_waitcnt lgkmcnt(0)
    v_cvt_pk_bf16_f32 v188, v162, v163
    v_mul_f32 v164, v134, v164
    v_mfma_f32_16x16x32_bf16 v[174:177], v[210:213], v[36:39], 0
    v_mul_f32 v165, v134, v165
    v_cvt_pk_bf16_f32 v189, v164, v165
    v_mfma_f32_16x16x32_bf16 v[174:177], v[182:185], v[170:173], v[174:177]
    ds_write_b64 v3, v[188:189] offset:8
    v_mfma_f32_16x16x32_bf16 v[182:185], v[166:169], v[36:39], 0
    v_mul_f32 v234, v134, v234
    v_mul_f32 v235, v134, v235
    v_mfma_f32_16x16x32_bf16 v[182:185], v[114:117], v[170:173], v[182:185]
    v_cvt_pk_bf16_f32 v234, v234, v235
    v_mul_f32 v236, v134, v236
    v_mfma_f32_16x16x32_bf16 v[146:149], a[220:223], v[130:133], v[146:149]
    v_mul_f32 v237, v134, v237
    v_cvt_pk_bf16_f32 v235, v236, v237
    v_mfma_f32_16x16x32_bf16 v[146:149], a[224:227], v[218:221], v[146:149]
    ds_write_b64 v4, v[234:235] offset:4096
    v_mfma_f32_16x16x32_bf16 v[146:149], a[228:231], v[198:201], v[146:149]
    v_rcp_f32 v154, v154
    v_mfma_f32_16x16x32_bf16 v[146:149], a[232:235], v[222:225], v[146:149]
    v_mul_f32 v194, v154, v194
    v_mul_f32 v195, v154, v195
    v_mfma_f32_16x16x32_bf16 v[146:149], a[236:239], v[230:233], v[146:149]
    v_cvt_pk_bf16_f32 v194, v194, v195
    v_mul_f32 v196, v154, v196
    v_mfma_f32_16x16x32_bf16 v[138:141], a[240:243], v[118:121], 0
    v_mul_f32 v197, v154, v197
    v_cvt_pk_bf16_f32 v195, v196, v197
    v_mfma_f32_16x16x32_bf16 v[138:141], a[244:247], v[130:133], v[138:141]
    ds_write_b64 v3, v[194:195] offset:6144
    v_mfma_f32_16x16x32_bf16 v[138:141], a[248:251], v[218:221], v[138:141]
    v_fma_f32 v255, v146, v146, s33
    v_fmac_f32 v255, v147, v147
    v_mfma_f32_16x16x32_bf16 v[138:141], a[252:255], v[198:201], v[138:141]
    ds_read_b128 v[170:173], v0 offset:20480
    v_fmac_f32 v255, v148, v148
    v_mfma_f32_16x16x32_bf16 v[138:141], v[82:85], v[222:225], v[138:141]
    ds_read_b128 v[166:169], v1 offset:20480
    v_fmac_f32 v255, v149, v149
    v_mfma_f32_16x16x32_bf16 v[138:141], v[86:89], v[230:233], v[138:141]
    ds_read_b128 v[162:165], v0 offset:20608
    v_mul_f32 v122, v154, v122
    v_mfma_f32_16x16x32_bf16 v[186:189], v[90:93], v[118:121], 0
    ds_read_b128 v[210:213], v1 offset:20608
    v_mul_f32 v123, v154, v123
    v_mfma_f32_16x16x32_bf16 v[186:189], v[94:97], v[130:133], v[186:189]
    ds_read_b128 v[226:229], v0 offset:20736
    v_cvt_pk_bf16_f32 v196, v122, v123
    v_mfma_f32_16x16x32_bf16 v[186:189], v[98:101], v[218:221], v[186:189]
    ds_read_b128 v[218:221], v1 offset:20736
    v_fmac_f32 v255, v138, v138
    v_mfma_f32_16x16x32_bf16 v[186:189], v[102:105], v[198:201], v[186:189]
    v_fmac_f32 v255, v139, v139
    v_fmac_f32 v255, v140, v140
    v_mfma_f32_16x16x32_bf16 v[186:189], v[106:109], v[222:225], v[186:189]
    v_fmac_f32 v255, v141, v141
    v_mul_f32 v124, v154, v124
    v_mfma_f32_16x16x32_bf16 v[186:189], v[110:113], v[230:233], v[186:189]
    s_waitcnt lgkmcnt(5)
    v_mul_f32 v125, v154, v125
    v_cvt_pk_bf16_f32 v197, v124, v125
    v_mfma_f32_16x16x32_bf16 v[118:121], a[72:75], v[170:173], 0
    s_waitcnt lgkmcnt(4)
    ds_write_b64 v3, v[196:197] offset:6152
    v_mfma_f32_16x16x32_bf16 v[118:121], a[76:79], v[166:169], v[118:121]
    s_waitcnt lgkmcnt(4)
    v_fmac_f32 v255, v186, v186
    v_fmac_f32 v255, v187, v187
    v_mfma_f32_16x16x32_bf16 v[118:121], a[80:83], v[162:165], v[118:121]
    s_waitcnt lgkmcnt(3)
    v_fmac_f32 v255, v188, v188
    v_fmac_f32 v255, v189, v189
    v_mfma_f32_16x16x32_bf16 v[118:121], a[84:87], v[210:213], v[118:121]
    s_waitcnt lgkmcnt(2)
    v_cvt_pk_bf16_f32 v255, v255, v255
    v_mul_f32 v126, v154, v126
    v_mfma_f32_16x16x32_bf16 v[118:121], a[88:91], v[226:229], v[118:121]
    s_waitcnt lgkmcnt(1)
    ds_write_b64 v4, v[254:255] offset:18432
    v_mfma_f32_16x16x32_bf16 v[118:121], a[92:95], v[218:221], v[118:121]
    v_mul_f32 v127, v154, v127
    v_cvt_pk_bf16_f32 v254, v126, v127
    v_mfma_f32_16x16x32_bf16 v[194:197], a[96:99], v[170:173], 0
    v_mul_f32 v128, v154, v128
    v_mul_f32 v129, v154, v129
    v_mfma_f32_16x16x32_bf16 v[194:197], a[100:103], v[166:169], v[194:197]
    v_cvt_pk_bf16_f32 v255, v128, v129
    v_xor_b32 v2, 65536, v2
    v_mfma_f32_16x16x32_bf16 v[194:197], a[104:107], v[162:165], v[194:197]
    ds_write_b64 v4, v[254:255] offset:10240
    v_mfma_f32_16x16x32_bf16 v[194:197], a[108:111], v[210:213], v[194:197]
    v_cvt_pk_f16_f32 v118, v118, v119
    v_pk_mul_f16 v223, v118, v118
    v_mfma_f32_16x16x32_bf16 v[194:197], a[112:115], v[226:229], v[194:197]
    v_cvt_pk_f16_f32 v119, v120, v121
    v_pk_mul_f16 v225, v119, v119
    v_mfma_f32_16x16x32_bf16 v[194:197], a[116:119], v[218:221], v[194:197]
    v_rcp_f32 v242, v242
    v_mfma_f32_16x16x32_bf16 v[114:117], a[120:123], v[170:173], 0
    v_mul_f32 v206, v242, v206
    v_mul_f32 v207, v242, v207
    v_mfma_f32_16x16x32_bf16 v[114:117], a[124:127], v[166:169], v[114:117]
    v_cvt_pk_bf16_f32 v206, v206, v207
    v_mul_f32 v208, v242, v208
    v_mfma_f32_16x16x32_bf16 v[114:117], a[128:131], v[162:165], v[114:117]
    v_cvt_pk_f16_f32 v120, v194, v195
    v_pk_fma_f16 v223, v120, v120, v223
    v_mfma_f32_16x16x32_bf16 v[114:117], a[132:135], v[210:213], v[114:117]
    v_cvt_pk_f16_f32 v121, v196, v197
    v_pk_fma_f16 v225, v121, v121, v225
    v_mfma_f32_16x16x32_bf16 v[114:117], a[136:139], v[226:229], v[114:117]
    v_mul_f32 v209, v242, v209
    v_cvt_pk_bf16_f32 v207, v208, v209
    v_mfma_f32_16x16x32_bf16 v[114:117], a[140:143], v[218:221], v[114:117]
    ds_write_b64 v3, v[206:207] offset:12288
    v_mfma_f32_16x16x32_bf16 v[154:157], a[0:3], v[170:173], 0
    v_mul_f32 v174, v242, v174
    v_mul_f32 v175, v242, v175
    v_mfma_f32_16x16x32_bf16 v[154:157], a[4:7], v[166:169], v[154:157]
    v_cvt_pk_bf16_f32 v208, v174, v175
    v_mul_f32 v176, v242, v176
    v_mfma_f32_16x16x32_bf16 v[154:157], a[8:11], v[162:165], v[154:157]
    v_cvt_pk_f16_f32 v196, v114, v115
    v_pk_fma_f16 v223, v196, v196, v223
    v_mfma_f32_16x16x32_bf16 v[154:157], a[12:15], v[210:213], v[154:157]
    v_cvt_pk_f16_f32 v197, v116, v117
    v_pk_fma_f16 v225, v197, v197, v225
    v_mfma_f32_16x16x32_bf16 v[154:157], a[16:19], v[226:229], v[154:157]
    v_mul_f32 v177, v242, v177
    v_cvt_pk_bf16_f32 v209, v176, v177
    v_mfma_f32_16x16x32_bf16 v[154:157], a[20:23], v[218:221], v[154:157]
    ds_write_b64 v3, v[208:209] offset:12296
    v_mfma_f32_16x16x32_bf16 v[174:177], a[24:27], v[170:173], 0
    v_mul_f32 v182, v242, v182
    v_mul_f32 v183, v242, v183
    v_mfma_f32_16x16x32_bf16 v[174:177], a[28:31], v[166:169], v[174:177]
    v_cvt_pk_bf16_f32 v194, v182, v183
    v_mul_f32 v184, v242, v184
    v_mfma_f32_16x16x32_bf16 v[174:177], a[32:35], v[162:165], v[174:177]
    v_cvt_pk_f16_f32 v206, v154, v155
    v_mul_f32 v185, v242, v185
    v_mfma_f32_16x16x32_bf16 v[174:177], a[36:39], v[210:213], v[174:177]
    v_cvt_pk_bf16_f32 v195, v184, v185
    v_xor_b32 v3, 65536, v3
    v_mfma_f32_16x16x32_bf16 v[174:177], a[40:43], v[226:229], v[174:177]
    ds_write_b64 v4, v[194:195] offset:16384
    v_mfma_f32_16x16x32_bf16 v[174:177], a[44:47], v[218:221], v[174:177]
    v_xor_b32 v4, 65536, v4
    v_mfma_f32_16x16x32_bf16 v[182:185], a[48:51], v[170:173], 0
    v_mfma_f32_16x16x32_bf16 v[182:185], a[52:55], v[166:169], v[182:185]
    v_mfma_f32_16x16x32_bf16 v[182:185], a[56:59], v[162:165], v[182:185]
    v_mfma_f32_16x16x32_bf16 v[182:185], a[60:63], v[210:213], v[182:185]
    v_mfma_f32_16x16x32_bf16 v[182:185], a[64:67], v[226:229], v[182:185]
    v_mfma_f32_16x16x32_bf16 v[182:185], a[68:71], v[218:221], v[182:185]
    v_mfma_f32_16x16x32_bf16 v[230:233], v[170:173], a[144:147], 0
    s_waitcnt lgkmcnt(0)
    v_mfma_f32_16x16x32_bf16 v[230:233], v[166:169], a[148:151], v[230:233]
    s_nop 0
    v_mfma_f32_16x16x32_bf16 v[230:233], v[162:165], a[152:155], v[230:233]
    s_nop 0
    v_mfma_f32_16x16x32_bf16 v[230:233], v[210:213], a[156:159], v[230:233]
    s_barrier
    v_mfma_f32_16x16x32_bf16 v[230:233], v[226:229], a[160:163], v[230:233]
    s_nop 0
    v_mfma_f32_16x16x32_bf16 v[230:233], v[218:221], a[164:167], v[230:233]
    s_cbranch_scc1 L_loop_fast2
    s_branch L_final_fast
.p2align 6
L_loop_fast3:
    v_mfma_f32_16x16x32_bf16 v[234:237], v[170:173], a[168:171], 0
    s_add_u32 s12, s42, s27
    ds_read_b128 v[242:245], v2 offset:18432
    ds_read_b128 v[246:249], v2 offset:19456
    v_mfma_f32_16x16x32_bf16 v[234:237], v[166:169], a[172:175], v[234:237]
    s_addc_u32 s13, s43, 0
    v_pk_mul_f16 v222, v206, v206
    v_cvt_pk_f16_f32 v207, v156, v157
    v_mfma_f32_16x16x32_bf16 v[234:237], v[162:165], a[176:179], v[234:237]
    s_sub_u32 s14, s36, s27
    v_pk_mul_f16 v224, v207, v207
    v_cvt_pk_f16_f32 v208, v174, v175
    v_mfma_f32_16x16x32_bf16 v[234:237], v[210:213], a[180:183], v[234:237]
    s_cmp_ge_u32 s18, 2
    ds_read_b128 v[134:137], v0 offset:26624
    v_pk_fma_f16 v222, v208, v208, v222
    v_mfma_f32_16x16x32_bf16 v[234:237], v[226:229], a[184:187], v[234:237]
    s_cselect_b32 s14, s14, 0
    ds_read_b128 v[154:157], v1 offset:26624
    v_cvt_pk_f16_f32 v209, v176, v177
    v_mfma_f32_16x16x32_bf16 v[234:237], v[218:221], a[188:191], v[234:237]
    s_add_u32 s34, s18, 2
    ds_read_b128 v[130:133], v0 offset:26752
    v_pk_fma_f16 v224, v209, v209, v224
    v_mfma_f32_16x16x32_bf16 v[114:117], v[170:173], a[192:195], 0
    s_add_u32 s8, s40, s23
    ds_read_b128 v[122:125], v1 offset:26752
    v_cvt_pk_f16_f32 v194, v182, v183
    v_mfma_f32_16x16x32_bf16 v[114:117], v[166:169], a[196:199], v[114:117]
    s_addc_u32 s9, s41, 0
    ds_read_b128 v[126:129], v0 offset:26880
    v_pk_fma_f16 v222, v194, v194, v222
    v_mfma_f32_16x16x32_bf16 v[114:117], v[162:165], a[200:203], v[114:117]
    s_waitcnt lgkmcnt(5)
    ds_read_b128 v[166:169], v1 offset:26880
    v_cvt_pk_f16_f32 v195, v184, v185
    v_mfma_f32_16x16x32_bf16 v[198:201], v[32:35], v[242:245], 0
    s_sub_u32 s10, s36, s23
    v_pk_fma_f16 v224, v195, v195, v224
    v_cvt_pk_bf16_f32 v174, v230, v231
    v_mfma_f32_16x16x32_bf16 v[198:201], v[32:35], v[246:249], v[198:201]
    s_cmp_lt_u32 s34, s17
    v_cvt_pk_bf16_f32 v175, v232, v233
    v_cvt_pk_bf16_f32 v182, v234, v235
    v_mfma_f32_16x16x32_f16 v[170:173], v[40:43], v[222:225], 0
    s_waitcnt lgkmcnt(5)
    v_cvt_pk_bf16_f32 v183, v236, v237
    s_cselect_b32 s10, s10, 0
    v_mfma_f32_16x16x32_bf16 v[114:117], v[210:213], a[204:207], v[114:117]
    s_add_u32 m0, s28, 0
    v_mul_f32 v255, 0x3baaaaab, v198
    v_mul_f32 v254, 0x3baaaaab, v199
    v_mfma_f32_16x16x32_bf16 v[114:117], v[226:229], a[208:211], v[114:117]
    s_mov_b32 s27, s26
    v_rsq_f32 v172, v170
    v_mfma_f32_16x16x32_bf16 v[114:117], v[218:221], a[212:215], v[114:117]
    s_mov_b32 s26, s25
    v_rsq_f32 v173, v171
    v_mfma_f32_16x16x32_bf16 v[162:165], a[72:75], v[134:137], 0
    s_waitcnt lgkmcnt(1)
    v_mul_f32 v172, s31, v172
    v_cvt_pk_f16_f32 v172, v172, v173
    v_mfma_f32_16x16x32_bf16 v[162:165], a[76:79], v[154:157], v[162:165]
    s_mov_b32 s25, s24
    v_cvt_pk_bf16_f32 v114, v114, v115
    v_cvt_pk_bf16_f32 v115, v116, v117
    v_mfma_f32_16x16x32_bf16 v[162:165], a[80:83], v[130:133], v[162:165]
    s_mov_b32 s24, s23
    v_pk_mul_f16 v118, v118, v172 op_sel:[0,1] op_sel_hi:[1,1]
    v_pk_mul_f16 v119, v119, v172 op_sel:[0,1] op_sel_hi:[1,1]
    v_mfma_f32_16x16x32_bf16 v[162:165], a[84:87], v[122:125], v[162:165]
    s_waitcnt lgkmcnt(0)
    v_pk_mul_f16 v120, v120, v172 op_sel:[0,1] op_sel_hi:[1,1]
    v_pk_mul_f16 v121, v121, v172 op_sel:[0,1] op_sel_hi:[1,1]
    v_mfma_f32_16x16x32_bf16 v[162:165], a[88:91], v[126:129], v[162:165]
    v_pk_mul_f16 v196, v196, v172 op_sel:[0,1] op_sel_hi:[1,1]
    v_pk_mul_f16 v197, v197, v172 op_sel:[0,1] op_sel_hi:[1,1]
    v_mfma_f32_16x16x32_bf16 v[162:165], a[92:95], v[166:169], v[162:165]
    v_pk_mul_f16 v206, v206, v172 op_sel:[0,0] op_sel_hi:[1,0]
    v_pk_mul_f16 v207, v207, v172 op_sel:[0,0] op_sel_hi:[1,0]
    v_mfma_f32_16x16x32_bf16 v[210:213], a[96:99], v[134:137], 0
    v_pk_mul_f16 v208, v208, v172 op_sel:[0,0] op_sel_hi:[1,0]
    v_pk_mul_f16 v209, v209, v172 op_sel:[0,0] op_sel_hi:[1,0]
    v_mfma_f32_16x16x32_bf16 v[210:213], a[100:103], v[154:157], v[210:213]
    v_pk_mul_f16 v194, v194, v172 op_sel:[0,0] op_sel_hi:[1,0]
    v_pk_mul_f16 v195, v195, v172 op_sel:[0,0] op_sel_hi:[1,0]
    v_mfma_f32_16x16x32_bf16 v[210:213], a[104:107], v[130:133], v[210:213]
    v_min3_u32 v44, v44, v170, v171
    v_max3_u32 v45, v45, v170, v171
    v_mfma_f32_16x16x32_bf16 v[210:213], a[108:111], v[122:125], v[210:213]
    v_cvt_pk_f16_f32 v170, v162, v163
    v_pk_mul_f16 v163, v170, v170
    v_mfma_f32_16x16x32_bf16 v[210:213], a[112:115], v[126:129], v[210:213]
    v_cvt_pk_f16_f32 v171, v164, v165
    v_pk_mul_f16 v165, v171, v171
    v_mfma_f32_16x16x32_bf16 v[210:213], a[116:119], v[166:169], v[210:213]
    v_rsq_f32 v255, v255
    v_mfma_f32_16x16x32_bf16 v[214:217], a[120:123], v[134:137], 0
    v_rsq_f32 v254, v254
    v_mfma_f32_16x16x32_bf16 v[214:217], a[124:127], v[154:157], v[214:217]
    v_mul_f32 v142, v254, v142
    v_mul_f32 v143, v254, v143
    v_mfma_f32_16x16x32_bf16 v[214:217], a[128:131], v[130:133], v[214:217]
    v_cvt_pk_bf16_f32 v142, v142, v143
    v_cvt_pk_f16_f32 v172, v210, v211
    v_mfma_f32_16x16x32_bf16 v[214:217], a[132:135], v[122:125], v[214:217]
    v_pk_fma_f16 v163, v172, v172, v163
    v_cvt_pk_f16_f32 v173, v212, v213
    v_mfma_f32_16x16x32_bf16 v[214:217], a[136:139], v[126:129], v[214:217]
    v_pk_fma_f16 v165, v173, v173, v165
    v_mul_f32 v144, v254, v144
    v_mfma_f32_16x16x32_bf16 v[214:217], a[140:143], v[166:169], v[214:217]
    v_mul_f32 v145, v254, v145
    v_cvt_pk_bf16_f32 v143, v144, v145
    v_mfma_f32_16x16x32_bf16 v[210:213], a[0:3], v[134:137], 0
    v_mul_f32 v158, v254, v158
    v_mul_f32 v159, v254, v159
    v_mfma_f32_16x16x32_bf16 v[210:213], a[4:7], v[154:157], v[210:213]
    v_cvt_pk_bf16_f32 v144, v158, v159
    v_mul_f32 v160, v254, v160
    v_mfma_f32_16x16x32_bf16 v[210:213], a[8:11], v[130:133], v[210:213]
    v_cvt_pk_f16_f32 v220, v214, v215
    v_pk_fma_f16 v163, v220, v220, v163
    v_mfma_f32_16x16x32_bf16 v[210:213], a[12:15], v[122:125], v[210:213]
    v_cvt_pk_f16_f32 v221, v216, v217
    v_pk_fma_f16 v165, v221, v221, v165
    v_mfma_f32_16x16x32_bf16 v[210:213], a[16:19], v[126:129], v[210:213]
    v_mul_f32 v161, v254, v161
    v_cvt_pk_bf16_f32 v145, v160, v161
    v_mfma_f32_16x16x32_bf16 v[210:213], a[20:23], v[166:169], v[210:213]
    buffer_store_dwordx4 v[142:145], v16, s[12:15], 0 offen nt
    v_mul_f32 v178, v254, v178
    v_mul_f32 v179, v254, v179
    v_cvt_pk_bf16_f32 v116, v178, v179
    v_mul_f32 v180, v254, v180
    v_mfma_f32_16x16x32_bf16 v[142:145], a[24:27], v[134:137], 0
    v_mul_f32 v181, v254, v181
    v_cvt_pk_bf16_f32 v117, v180, v181
    v_mfma_f32_16x16x32_bf16 v[142:145], a[28:31], v[154:157], v[142:145]
    v_cvt_pk_f16_f32 v158, v210, v211
    v_pk_mul_f16 v162, v158, v158
    v_mfma_f32_16x16x32_bf16 v[142:145], a[32:35], v[130:133], v[142:145]
    v_cvt_pk_f16_f32 v159, v212, v213
    v_pk_mul_f16 v164, v159, v159
    v_mfma_f32_16x16x32_bf16 v[142:145], a[36:39], v[122:125], v[142:145]
    v_mul_f32 v254, 0x3baaaaab, v200
    v_mul_f32 v150, v255, v150
    v_mfma_f32_16x16x32_bf16 v[142:145], a[40:43], v[126:129], v[142:145]
    v_rsq_f32 v254, v254
    v_mfma_f32_16x16x32_bf16 v[142:145], a[44:47], v[166:169], v[142:145]
    v_mul_f32 v151, v255, v151
    v_cvt_pk_bf16_f32 v150, v150, v151
    v_mfma_f32_16x16x32_bf16 v[178:181], a[48:51], v[134:137], 0
    v_mul_f32 v152, v255, v152
    v_mul_f32 v153, v255, v153
    v_mfma_f32_16x16x32_bf16 v[178:181], a[52:55], v[154:157], v[178:181]
    v_cvt_pk_bf16_f32 v151, v152, v153
    v_mul_f32 v190, v255, v190
    v_mfma_f32_16x16x32_bf16 v[178:181], a[56:59], v[130:133], v[178:181]
    v_cvt_pk_f16_f32 v160, v142, v143
    v_pk_fma_f16 v162, v160, v160, v162
    v_mfma_f32_16x16x32_bf16 v[178:181], a[60:63], v[122:125], v[178:181]
    v_cvt_pk_f16_f32 v161, v144, v145
    v_pk_fma_f16 v164, v161, v161, v164
    v_mfma_f32_16x16x32_bf16 v[178:181], a[64:67], v[126:129], v[178:181]
    v_mul_f32 v191, v255, v191
    v_cvt_pk_bf16_f32 v152, v190, v191
    v_mfma_f32_16x16x32_bf16 v[178:181], a[68:71], v[166:169], v[178:181]
    v_mul_f32 v192, v255, v192
    v_mul_f32 v193, v255, v193
    v_mfma_f32_16x16x32_bf16 v[142:145], v[134:137], a[144:147], 0
    v_cvt_pk_bf16_f32 v153, v192, v193
    v_mul_f32 v202, v255, v202
    v_mfma_f32_16x16x32_bf16 v[142:145], v[154:157], a[148:151], v[142:145]
    v_mul_f32 v203, v255, v203
    v_cvt_pk_bf16_f32 v202, v202, v203
    v_mfma_f32_16x16x32_bf16 v[142:145], v[130:133], a[152:155], v[142:145]
    v_cvt_pk_f16_f32 v218, v178, v179
    v_pk_fma_f16 v162, v218, v218, v162
    v_mfma_f32_16x16x32_bf16 v[142:145], v[122:125], a[156:159], v[142:145]
    v_cvt_pk_f16_f32 v219, v180, v181
    v_pk_fma_f16 v164, v219, v219, v164
    v_mfma_f32_16x16x32_bf16 v[142:145], v[126:129], a[160:163], v[142:145]
    buffer_store_dwordx2 v[116:117], v19, s[12:15], 0 offen nt
    v_mul_f32 v204, v255, v204
    v_mul_f32 v205, v255, v205
    v_mfma_f32_16x16x32_f16 v[190:193], v[40:43], v[162:165], 0
    v_cvt_pk_bf16_f32 v203, v204, v205
    v_mul_f32 v146, v254, v146
    v_mfma_f32_16x16x32_bf16 v[142:145], v[166:169], a[164:167], v[142:145]
    v_mul_f32 v147, v254, v147
    v_cvt_pk_bf16_f32 v146, v146, v147
    v_mfma_f32_16x16x32_bf16 v[178:181], v[134:137], a[168:171], 0
    v_mul_f32 v148, v254, v148
    v_mul_f32 v149, v254, v149
    v_mfma_f32_16x16x32_bf16 v[178:181], v[154:157], a[172:175], v[178:181]
    v_rsq_f32 v192, v190
    v_mfma_f32_16x16x32_bf16 v[178:181], v[130:133], a[176:179], v[178:181]
    v_cvt_pk_bf16_f32 v176, v142, v143
    v_cvt_pk_bf16_f32 v177, v144, v145
    v_mfma_f32_16x16x32_bf16 v[178:181], v[122:125], a[180:183], v[178:181]
    ds_read_b128 v[142:145], v0 offset:32768
    v_mul_f32 v192, s31, v192
    v_mfma_f32_16x16x32_bf16 v[178:181], v[126:129], a[184:187], v[178:181]
    ds_read_b128 v[162:165], v1 offset:32768
    v_min3_u32 v44, v44, v190, v191
    v_mfma_f32_16x16x32_bf16 v[178:181], v[166:169], a[188:191], v[178:181]
    ds_read_b128 v[210:213], v0 offset:32896
    v_max3_u32 v45, v45, v190, v191
    v_mfma_f32_16x16x32_bf16 v[198:201], v[134:137], a[192:195], 0
    ds_read_b128 v[134:137], v1 offset:32896
    v_cvt_pk_bf16_f32 v147, v148, v149
    v_mfma_f32_16x16x32_bf16 v[198:201], v[154:157], a[196:199], v[198:201]
    ds_read_b128 v[154:157], v0 offset:33024
    v_mul_f32 v138, v254, v138
    v_mfma_f32_16x16x32_bf16 v[198:201], v[130:133], a[200:203], v[198:201]
    ds_read_b128 v[130:133], v1 offset:33024
    v_cvt_pk_bf16_f32 v184, v178, v179
    v_mfma_f32_16x16x32_bf16 v[198:201], v[122:125], a[204:207], v[198:201]
    v_rsq_f32 v193, v191
    v_mfma_f32_16x16x32_bf16 v[198:201], v[126:129], a[208:211], v[198:201]
    v_cvt_pk_f16_f32 v192, v192, v193
    v_cvt_pk_bf16_f32 v185, v180, v181
    v_mfma_f32_16x16x32_bf16 v[198:201], v[166:169], a[212:215], v[198:201]
    s_waitcnt lgkmcnt(5)
    v_pk_mul_f16 v170, v170, v192 op_sel:[0,1] op_sel_hi:[1,1]
    v_pk_mul_f16 v171, v171, v192 op_sel:[0,1] op_sel_hi:[1,1]
    v_mfma_f32_16x16x32_bf16 v[178:181], a[72:75], v[142:145], 0
    s_waitcnt lgkmcnt(4)
    v_pk_mul_f16 v172, v172, v192 op_sel:[0,1] op_sel_hi:[1,1]
    v_pk_mul_f16 v173, v173, v192 op_sel:[0,1] op_sel_hi:[1,1]
    v_mfma_f32_16x16x32_bf16 v[178:181], a[76:79], v[162:165], v[178:181]
    s_waitcnt lgkmcnt(3)
    v_cvt_pk_bf16_f32 v116, v198, v199
    v_cvt_pk_bf16_f32 v117, v200, v201
    v_mfma_f32_16x16x32_bf16 v[178:181], a[80:83], v[210:213], v[178:181]
    s_waitcnt lgkmcnt(2)
    buffer_store_dwordx4 v[150:153], v15, s[12:15], 0 offen nt
    v_pk_mul_f16 v220, v220, v192 op_sel:[0,1] op_sel_hi:[1,1]
    v_pk_mul_f16 v221, v221, v192 op_sel:[0,1] op_sel_hi:[1,1]
    v_pk_mul_f16 v158, v158, v192 op_sel:[0,0] op_sel_hi:[1,0]
    v_pk_mul_f16 v159, v159, v192 op_sel:[0,0] op_sel_hi:[1,0]
    v_mfma_f32_16x16x32_bf16 v[178:181], a[84:87], v[134:137], v[178:181]
    s_waitcnt lgkmcnt(0)
    v_pk_mul_f16 v160, v160, v192 op_sel:[0,0] op_sel_hi:[1,0]
    v_pk_mul_f16 v161, v161, v192 op_sel:[0,0] op_sel_hi:[1,0]
    v_mfma_f32_16x16x32_bf16 v[178:181], a[88:91], v[154:157], v[178:181]
    v_pk_mul_f16 v218, v218, v192 op_sel:[0,0] op_sel_hi:[1,0]
    v_pk_mul_f16 v219, v219, v192 op_sel:[0,0] op_sel_hi:[1,0]
    v_mfma_f32_16x16x32_bf16 v[178:181], a[92:95], v[130:133], v[178:181]
    v_mul_f32 v139, v254, v139
    v_cvt_pk_bf16_f32 v148, v138, v139
    v_mfma_f32_16x16x32_bf16 v[150:153], a[96:99], v[142:145], 0
    v_mul_f32 v140, v254, v140
    v_mul_f32 v141, v254, v141
    v_mfma_f32_16x16x32_bf16 v[150:153], a[100:103], v[162:165], v[150:153]
    v_cvt_pk_bf16_f32 v149, v140, v141
    v_mul_f32 v186, v254, v186
    v_mfma_f32_16x16x32_bf16 v[150:153], a[104:107], v[210:213], v[150:153]
    v_cvt_pk_f16_f32 v178, v178, v179
    v_pk_mul_f16 v191, v178, v178
    v_mfma_f32_16x16x32_bf16 v[150:153], a[108:111], v[134:137], v[150:153]
    v_cvt_pk_f16_f32 v179, v180, v181
    v_pk_mul_f16 v193, v179, v179
    v_mfma_f32_16x16x32_bf16 v[150:153], a[112:115], v[154:157], v[150:153]
    v_mul_f32 v187, v254, v187
    v_cvt_pk_bf16_f32 v204, v186, v187
    v_mfma_f32_16x16x32_bf16 v[150:153], a[116:119], v[130:133], v[150:153]
    v_mul_f32 v188, v254, v188
    v_mul_f32 v189, v254, v189
    v_mfma_f32_16x16x32_bf16 v[138:141], a[120:123], v[142:145], 0
    s_waitcnt vmcnt(3)
    v_cvt_pk_bf16_f32 v205, v188, v189
    v_xor_b32 v0, 65536, v0
    v_mfma_f32_16x16x32_bf16 v[138:141], a[124:127], v[162:165], v[138:141]
    v_mfma_f32_16x16x32_bf16 v[138:141], a[128:131], v[210:213], v[138:141]
    v_mfma_f32_16x16x32_bf16 v[138:141], a[132:135], v[134:137], v[138:141]
    v_mfma_f32_16x16x32_bf16 v[138:141], a[136:139], v[154:157], v[138:141]
    s_barrier
    v_mfma_f32_16x16x32_bf16 v[138:141], a[140:143], v[130:133], v[138:141]
    v_cvt_pk_f16_f32 v180, v150, v151
    v_pk_fma_f16 v191, v180, v180, v191
    v_mfma_f32_16x16x32_bf16 v[186:189], a[0:3], v[142:145], 0
    v_cvt_pk_f16_f32 v181, v152, v153
    v_pk_fma_f16 v193, v181, v181, v193
    v_mfma_f32_16x16x32_bf16 v[186:189], a[4:7], v[162:165], v[186:189]
    buffer_load_dwordx4 v10, s[8:11], 0 offen nt lds
    v_xor_b32 v1, 65536, v1
    v_mfma_f32_16x16x32_bf16 v[186:189], a[8:11], v[210:213], v[186:189]
    s_add_u32 m0, s28, 4096
    v_cvt_pk_f16_f32 v124, v138, v139
    v_pk_fma_f16 v191, v124, v124, v191
    v_mfma_f32_16x16x32_bf16 v[186:189], a[12:15], v[134:137], v[186:189]
    v_cvt_pk_f16_f32 v125, v140, v141
    v_pk_fma_f16 v193, v125, v125, v193
    v_mfma_f32_16x16x32_bf16 v[186:189], a[16:19], v[154:157], v[186:189]
    v_mfma_f32_16x16x32_bf16 v[186:189], a[20:23], v[130:133], v[186:189]
    v_mfma_f32_16x16x32_bf16 v[150:153], a[24:27], v[142:145], 0
    buffer_load_dwordx4 v11, s[8:11], 0 offen nt lds
    s_add_u32 m0, s28, 8192
    v_mfma_f32_16x16x32_bf16 v[150:153], a[28:31], v[162:165], v[150:153]
    v_mfma_f32_16x16x32_bf16 v[150:153], a[32:35], v[210:213], v[150:153]
    v_mfma_f32_16x16x32_bf16 v[150:153], a[36:39], v[134:137], v[150:153]
    v_mfma_f32_16x16x32_bf16 v[150:153], a[40:43], v[154:157], v[150:153]
    v_mfma_f32_16x16x32_bf16 v[150:153], a[44:47], v[130:133], v[150:153]
    buffer_load_dwordx4 v12, s[8:11], 0 offen nt lds
    v_cvt_pk_f16_f32 v186, v186, v187
    v_mfma_f32_16x16x32_bf16 v[138:141], a[48:51], v[142:145], 0
    s_add_u32 m0, s28, 12288
    v_pk_mul_f16 v190, v186, v186
    v_cvt_pk_f16_f32 v187, v188, v189
    v_mfma_f32_16x16x32_bf16 v[138:141], a[52:55], v[162:165], v[138:141]
    s_xor_b32 s28, s28, 65536
    ds_read_b128 v[166:169], v5 offset:0
    ds_read_b128 v[126:129], v5 offset:16
    v_mfma_f32_16x16x32_bf16 v[138:141], a[56:59], v[210:213], v[138:141]
    ds_read_b128 v[198:201], v5 offset:48
    ds_read_b32 v254, v6 offset:192
    v_mfma_f32_16x16x32_bf16 v[138:141], a[60:63], v[134:137], v[138:141]
    v_pk_mul_f16 v192, v187, v187
    v_cvt_pk_f16_f32 v188, v150, v151
    v_mfma_f32_16x16x32_bf16 v[138:141], a[64:67], v[154:157], v[138:141]
    buffer_load_dwordx4 v13, s[8:11], 0 offen nt lds
    v_pk_fma_f16 v190, v188, v188, v190
    v_mfma_f32_16x16x32_bf16 v[138:141], a[68:71], v[130:133], v[138:141]
    s_mov_b32 m0, s29
    v_cvt_pk_f16_f32 v189, v152, v153
    v_pk_fma_f16 v192, v189, v189, v192
    v_mfma_f32_16x16x32_bf16 v[150:153], v[142:145], a[144:147], 0
    s_xor_b32 s29, s29, s30
    v_add_u32 v5, 336, v5
    s_add_u32 s19, s19, s20
    v_mfma_f32_16x16x32_bf16 v[150:153], v[162:165], a[148:151], v[150:153]
    s_add_u32 s23, s23, s21
    v_cvt_pk_f16_f32 v122, v138, v139
    v_pk_fma_f16 v190, v122, v122, v190
    v_mfma_f32_16x16x32_bf16 v[150:153], v[210:213], a[152:155], v[150:153]
    s_cmp_ge_u32 s19, 72
    v_cvt_pk_f16_f32 v123, v140, v141
    v_pk_fma_f16 v192, v123, v123, v192
    v_mfma_f32_16x16x32_bf16 v[150:153], v[134:137], a[156:159], v[150:153]
    s_waitcnt lgkmcnt(2)
    buffer_store_dwordx2 v[202:203], v18, s[12:15], 0 offen nt
    s_cselect_b32 s34, 72, 0
    s_cselect_b32 s35, s22, 0
    v_mfma_f32_16x16x32_f16 v[138:141], v[40:43], v[190:193], 0
    s_sub_u32 s19, s19, s34
    s_add_u32 s23, s23, s35
    s_add_u32 s18, s18, 1
    v_mfma_f32_16x16x32_f16 v[214:217], v[166:169], v[158:161], v[24:27]
    s_cmp_lt_u32 s18, s45
    v_mfma_f32_16x16x32_f16 v[214:217], v[126:129], v[170:173], v[214:217]
    s_waitcnt lgkmcnt(0)
    v_mfma_f32_16x16x32_f16 v[214:217], v[198:201], v[218:221], v[214:217]
    v_rsq_f32 v140, v138
    v_mfma_f32_16x16x32_f16 v[190:193], v[166:169], v[206:209], v[22:25]
    v_rsq_f32 v141, v139
    v_mfma_f32_16x16x32_f16 v[190:193], v[126:129], v[118:121], v[190:193]
    v_mul_f32 v140, s31, v140
    v_cvt_pk_f16_f32 v140, v140, v141
    v_mfma_f32_16x16x32_f16 v[190:193], v[198:201], v[194:197], v[190:193]
    v_pk_mul_f16 v178, v178, v140 op_sel:[0,1] op_sel_hi:[1,1]
    v_pk_mul_f16 v179, v179, v140 op_sel:[0,1] op_sel_hi:[1,1]
    v_mfma_f32_16x16x32_bf16 v[150:153], v[154:157], a[160:163], v[150:153]
    v_pk_mul_f16 v180, v180, v140 op_sel:[0,1] op_sel_hi:[1,1]
    v_pk_mul_f16 v181, v181, v140 op_sel:[0,1] op_sel_hi:[1,1]
    v_mfma_f32_16x16x32_bf16 v[150:153], v[130:133], a[164:167], v[150:153]
    v_pk_mul_f16 v124, v124, v140 op_sel:[0,1] op_sel_hi:[1,1]
    v_pk_mul_f16 v125, v125, v140 op_sel:[0,1] op_sel_hi:[1,1]
    v_mfma_f32_16x16x32_bf16 v[222:225], v[142:145], a[168:171], 0
    v_mov_b32_dpp v254, v191 quad_perm:[0,1,2,3] row_mask:0x1 bank_mask:0xf
    v_mov_b32_dpp v254, v215 quad_perm:[0,1,2,3] row_mask:0x2 bank_mask:0xf
    v_mfma_f32_16x16x32_bf16 v[222:225], v[162:165], a[172:175], v[222:225]
    v_pk_mul_f16 v186, v186, v140 op_sel:[0,0] op_sel_hi:[1,0]
    v_pk_mul_f16 v187, v187, v140 op_sel:[0,0] op_sel_hi:[1,0]
    v_mfma_f32_16x16x32_bf16 v[222:225], v[210:213], a[176:179], v[222:225]
    v_cvt_pk_bf16_f32 v226, v150, v151
    v_cvt_pk_bf16_f32 v227, v152, v153
    v_mfma_f32_16x16x32_bf16 v[222:225], v[134:137], a[180:183], v[222:225]
    v_pk_mul_f16 v188, v188, v140 op_sel:[0,0] op_sel_hi:[1,0]
    v_pk_mul_f16 v189, v189, v140 op_sel:[0,0] op_sel_hi:[1,0]
    v_mfma_f32_16x16x32_f16 v[230:233], v[118:121], v[206:209], v[46:49]
    v_pk_mul_f16 v122, v122, v140 op_sel:[0,0] op_sel_hi:[1,0]
    v_pk_mul_f16 v123, v123, v140 op_sel:[0,0] op_sel_hi:[1,0]
    v_mfma_f32_16x16x32_f16 v[234:237], v[170:173], v[206:209], v[50:53]
    v_min3_u32 v44, v44, v138, v139
    v_max3_u32 v45, v45, v138, v139
    v_mfma_f32_16x16x32_f16 v[138:141], v[178:181], v[206:209], v[54:57]
    v_exp_f32 v214, v214
    v_mfma_f32_16x16x16_f16 v[230:233], v[196:197], v[194:195], v[230:233]
    buffer_store_dwordx4 v[146:149], v17, s[12:15], 0 offen nt
    v_exp_f32 v190, v190
    v_mfma_f32_16x16x16_f16 v[234:237], v[220:221], v[194:195], v[234:237]
    v_cvt_pk_bf16_f32 v39, v190, 0
    v_mfma_f32_16x16x16_f16 v[138:141], v[124:125], v[194:195], v[138:141]
    v_mfma_f32_16x16x32_bf16 v[222:225], v[154:157], a[184:187], v[222:225]
    v_mfma_f32_16x16x32_bf16 v[222:225], v[130:133], a[188:191], v[222:225]
    ds_read_b128 v[146:149], v2 offset:0
    v_mfma_f32_16x16x32_bf16 v[150:153], v[142:145], a[192:195], 0
    ds_read_b128 v[142:145], v2 offset:1024
    v_mfma_f32_16x16x32_bf16 v[150:153], v[162:165], a[196:199], v[150:153]
    ds_read_b128 v[206:209], v2 offset:2048
    v_mfma_f32_16x16x32_bf16 v[150:153], v[210:213], a[200:203], v[150:153]
    ds_read_b128 v[162:165], v2 offset:3072
    v_mfma_f32_16x16x32_bf16 v[150:153], v[134:137], a[204:207], v[150:153]
    ds_read_b128 v[134:137], v2 offset:4096
    v_cvt_pk_bf16_f32 v210, v222, v223
    v_mfma_f32_16x16x32_bf16 v[150:153], v[154:157], a[208:211], v[150:153]
    ds_read_b128 v[154:157], v2 offset:5120
    v_cvt_pk_bf16_f32 v211, v224, v225
    v_mfma_f32_16x16x32_bf16 v[150:153], v[130:133], a[212:215], v[150:153]
    ds_read2_b32 v[228:229], v6 offset0:0 offset1:0
    ds_read2_b32 v[212:213], v6 offset0:16 offset1:16
    v_mfma_f32_16x16x32_f16 v[130:133], v[166:169], v[186:189], v[26:29]
    ds_read2_b32 v[168:169], v6 offset0:32 offset1:32
    v_add_u32 v6, 272, v6
    v_mfma_f32_16x16x32_f16 v[130:133], v[126:129], v[178:181], v[130:133]
    s_waitcnt lgkmcnt(8)
    v_exp_f32 v230, v230
    v_mfma_f32_16x16x32_f16 v[130:133], v[198:201], v[122:125], v[130:133]
    s_waitcnt lgkmcnt(7)
    v_cvt_pk_bf16_f32 v166, v150, v151
    v_cvt_pk_bf16_f32 v167, v152, v153
    v_mfma_f32_16x16x32_bf16 v[150:153], a[216:219], v[146:149], 0
    s_waitcnt lgkmcnt(6)
    v_exp_f32 v231, v231
    v_mfma_f32_16x16x32_bf16 v[150:153], a[220:223], v[142:145], v[150:153]
    s_waitcnt lgkmcnt(5)
    v_exp_f32 v130, v130
    v_mfma_f32_16x16x32_bf16 v[150:153], a[224:227], v[206:209], v[150:153]
    s_waitcnt lgkmcnt(4)
    buffer_store_dwordx2 v[204:205], v20, s[12:15], 0 offen nt
    v_mov_b32_dpp v254, v131 quad_perm:[0,1,2,3] row_mask:0x4 bank_mask:0xf
    v_cvt_pk_bf16_f32 v126, v230, v231
    v_mfma_f32_16x16x32_bf16 v[150:153], a[228:231], v[162:165], v[150:153]
    s_waitcnt lgkmcnt(3)
    v_exp_f32 v254, v254
    v_mfma_f32_16x16x32_bf16 v[150:153], a[232:235], v[134:137], v[150:153]
    s_waitcnt lgkmcnt(1)
    v_exp_f32 v232, v232
    v_mfma_f32_16x16x32_bf16 v[150:153], a[236:239], v[154:157], v[150:153]
    s_waitcnt lgkmcnt(0)
    v_exp_f32 v233, v233
    v_mfma_f32_16x16x32_bf16 v[190:193], a[240:243], v[146:149], 0
    v_cvt_pk_bf16_f32 v254, v254, v254
    v_cvt_pk_bf16_f32 v127, v232, v233
    v_mfma_f32_16x16x32_bf16 v[190:193], a[244:247], v[142:145], v[190:193]
    ds_write_b16 v8, v254
    v_mfma_f32_16x16x32_bf16 v[190:193], a[248:251], v[206:209], v[190:193]
    v_exp_f32 v234, v234
    v_mfma_f32_16x16x32_bf16 v[190:193], a[252:255], v[162:165], v[190:193]
    ds_read_b128 v[198:201], v2 offset:6144
    ds_read_b128 v[230:233], v9
    v_mfma_f32_16x16x32_bf16 v[190:193], v[82:85], v[134:137], v[190:193]
    ds_read_b128 v[222:225], v2 offset:7168
    ds_read_b128 v[238:241], v9 offset:64
    v_mfma_f32_16x16x32_bf16 v[190:193], v[86:89], v[154:157], v[190:193]
    v_exp_f32 v235, v235
    v_mfma_f32_16x16x32_bf16 v[202:205], v[90:93], v[146:149], 0
    ds_read_b128 v[146:149], v2 offset:8192
    ds_read_b128 v[242:245], v2 offset:9216
    v_mfma_f32_16x16x32_bf16 v[202:205], v[94:97], v[142:145], v[202:205]
    v_cvt_pk_bf16_f32 v128, v234, v235
    v_fma_f32 v254, v150, v150, s33
    v_mfma_f32_16x16x32_bf16 v[202:205], v[98:101], v[206:209], v[202:205]
    ds_read_b128 v[206:209], v2 offset:10240
    ds_read_b128 v[246:249], v2 offset:11264
    v_mfma_f32_16x16x32_bf16 v[202:205], v[102:105], v[162:165], v[202:205]
    v_exp_f32 v236, v236
    v_mfma_f32_16x16x32_bf16 v[202:205], v[106:109], v[134:137], v[202:205]
    v_exp_f32 v237, v237
    v_mfma_f32_16x16x32_bf16 v[202:205], v[110:113], v[154:157], v[202:205]
    s_waitcnt lgkmcnt(6)
    v_cvt_pk_bf16_f32 v129, v236, v237
    v_fmac_f32 v254, v151, v151
    v_mfma_f32_16x16x32_bf16 v[142:145], v[230:233], v[28:31], 0
    s_waitcnt lgkmcnt(4)
    v_exp_f32 v138, v138
    v_mfma_f32_16x16x32_bf16 v[142:145], v[238:241], v[28:31], v[142:145]
    v_fmac_f32 v254, v152, v152
    v_mfma_f32_16x16x32_bf16 v[134:137], v[230:233], v[174:177], 0
    s_waitcnt lgkmcnt(2)
    v_exp_f32 v139, v139
    v_mfma_f32_16x16x32_bf16 v[134:137], v[238:241], v[226:229], v[134:137]
    v_cvt_pk_bf16_f32 v36, v138, v139
    v_fmac_f32 v254, v153, v153
    v_mfma_f32_16x16x32_bf16 v[154:157], v[230:233], v[182:185], 0
    s_waitcnt lgkmcnt(0)
    v_rcp_f32 v142, v142
    v_mfma_f32_16x16x32_bf16 v[154:157], v[238:241], v[210:213], v[154:157]
    v_exp_f32 v140, v140
    v_mfma_f32_16x16x32_bf16 v[162:165], v[230:233], v[114:117], 0
    v_mul_f32 v134, v134, v142
    v_fmac_f32 v254, v190, v190
    v_mfma_f32_16x16x32_bf16 v[162:165], v[238:241], v[166:169], v[162:165]
    v_exp_f32 v141, v141
    v_mfma_f32_16x16x32_f16 v[230:233], v[118:121], v[158:161], v[58:61]
    v_cvt_pk_bf16_f32 v37, v140, v141
    v_mul_f32_dpp v134, v154, v142 quad_perm:[0,1,2,3] row_mask:0x2 bank_mask:0xf
    v_mfma_f32_16x16x32_f16 v[138:141], v[170:173], v[158:161], v[62:65]
    v_fmac_f32 v254, v191, v191
    v_fmac_f32 v254, v192, v192
    v_mfma_f32_16x16x32_f16 v[154:157], v[178:181], v[158:161], v[66:69]
    v_mul_f32_dpp v134, v162, v142 quad_perm:[0,1,2,3] row_mask:0x4 bank_mask:0xf
    v_cvt_pk_bf16_f32 v134, v134, v134
    v_fmac_f32 v254, v193, v193
    v_mfma_f32_16x16x16_f16 v[230:233], v[196:197], v[218:219], v[230:233]
    v_fmac_f32 v254, v202, v202
    v_fmac_f32 v254, v203, v203
    v_fmac_f32 v254, v204, v204
    v_mfma_f32_16x16x16_f16 v[138:141], v[220:221], v[218:219], v[138:141]
    v_fmac_f32 v254, v205, v205
    v_mfma_f32_16x16x16_f16 v[154:157], v[124:125], v[218:219], v[154:157]
    ds_write_b16 v7, v134
    v_add_u32 v7, 16, v7
    v_mfma_f32_16x16x32_bf16 v[134:137], v[28:31], v[36:39], 0
    v_exp_f32 v230, v230
    v_mfma_f32_16x16x32_bf16 v[134:137], v[28:31], v[126:129], v[134:137]
    v_exp_f32 v231, v231
    v_mfma_f32_16x16x32_bf16 v[158:161], v[226:229], v[36:39], 0
    v_exp_f32 v232, v232
    v_mfma_f32_16x16x32_bf16 v[158:161], v[174:177], v[126:129], v[158:161]
    v_exp_f32 v233, v233
    v_mfma_f32_16x16x32_bf16 v[162:165], v[210:213], v[36:39], 0
    v_cvt_pk_bf16_f32 v230, v230, v231
    v_cvt_pk_bf16_f32 v231, v232, v233
    v_mfma_f32_16x16x32_bf16 v[162:165], v[182:185], v[126:129], v[162:165]
    v_exp_f32 v138, v138
    v_mfma_f32_16x16x32_bf16 v[234:237], v[166:169], v[36:39], 0
    v_exp_f32 v139, v139
    v_mfma_f32_16x16x32_bf16 v[234:237], v[114:117], v[126:129], v[234:237]
    v_cvt_pk_bf16_f32 v232, v138, v139
    v_cvt_pk_bf16_f32 v39, v214, 0
    v_mfma_f32_16x16x32_f16 v[126:129], v[118:121], v[186:189], v[70:73]
    v_exp_f32 v140, v140
    v_mfma_f32_16x16x32_f16 v[118:121], v[170:173], v[186:189], v[74:77]
    v_exp_f32 v141, v141
    v_mfma_f32_16x16x32_bf16 v[142:145], a[216:219], v[198:201], 0
    v_exp_f32 v154, v154
    v_mfma_f32_16x16x32_bf16 v[142:145], a[220:223], v[222:225], v[142:145]
    v_cvt_pk_bf16_f32 v233, v140, v141
    v_exp_f32 v155, v155
    v_mfma_f32_16x16x32_f16 v[138:141], v[178:181], v[186:189], v[78:81]
    v_cvt_pk_bf16_f32 v36, v154, v155
    v_exp_f32 v156, v156
    v_mfma_f32_16x16x16_f16 v[126:129], v[196:197], v[122:123], v[126:129]
    v_exp_f32 v157, v157
    v_mfma_f32_16x16x16_f16 v[118:121], v[220:221], v[122:123], v[118:121]
    v_cvt_pk_bf16_f32 v37, v156, v157
    v_rcp_f32 v134, v134
    v_mfma_f32_16x16x16_f16 v[138:141], v[124:125], v[122:123], v[138:141]
    v_mul_f32 v158, v134, v158
    v_mul_f32 v159, v134, v159
    v_cvt_pk_bf16_f32 v186, v158, v159
    v_mul_f32 v160, v134, v160
    v_mfma_f32_16x16x32_bf16 v[154:157], v[28:31], v[36:39], 0
    v_exp_f32 v126, v126
    v_mfma_f32_16x16x32_bf16 v[154:157], v[28:31], v[230:233], v[154:157]
    v_exp_f32 v127, v127
    v_mfma_f32_16x16x32_bf16 v[194:197], v[226:229], v[36:39], 0
    v_cvt_pk_bf16_f32 v170, v126, v127
    v_mul_f32 v161, v134, v161
    v_mfma_f32_16x16x32_bf16 v[194:197], v[174:177], v[230:233], v[194:197]
    v_exp_f32 v128, v128
    v_mfma_f32_16x16x32_bf16 v[122:125], v[210:213], v[36:39], 0
    v_exp_f32 v129, v129
    v_mfma_f32_16x16x32_bf16 v[122:125], v[182:185], v[230:233], v[122:125]
    v_cvt_pk_bf16_f32 v171, v128, v129
    v_cvt_pk_bf16_f32 v187, v160, v161
    v_mfma_f32_16x16x32_bf16 v[126:129], v[166:169], v[36:39], 0
    ds_write_b64 v3, v[186:187] offset:0
    v_mfma_f32_16x16x32_bf16 v[126:129], v[114:117], v[230:233], v[126:129]
    v_exp_f32 v118, v118
    v_mfma_f32_16x16x32_bf16 v[142:145], a[224:227], v[146:149], v[142:145]
    v_exp_f32 v119, v119
    v_mfma_f32_16x16x32_bf16 v[142:145], a[228:231], v[242:245], v[142:145]
    v_cvt_pk_bf16_f32 v172, v118, v119
    v_cvt_pk_bf16_f32 v39, v130, 0
    v_mfma_f32_16x16x32_bf16 v[142:145], a[232:235], v[206:209], v[142:145]
    v_exp_f32 v120, v120
    v_mfma_f32_16x16x32_bf16 v[142:145], a[236:239], v[246:249], v[142:145]
    v_exp_f32 v121, v121
    v_mfma_f32_16x16x32_bf16 v[158:161], a[240:243], v[198:201], 0
    v_cvt_pk_bf16_f32 v173, v120, v121
    v_mul_f32 v162, v134, v162
    v_mfma_f32_16x16x32_bf16 v[158:161], a[244:247], v[222:225], v[158:161]
    v_exp_f32 v138, v138
    v_mfma_f32_16x16x32_bf16 v[158:161], a[248:251], v[146:149], v[158:161]
    v_exp_f32 v139, v139
    v_mfma_f32_16x16x32_bf16 v[158:161], a[252:255], v[242:245], v[158:161]
    ds_read_b128 v[118:121], v2 offset:12288
    v_cvt_pk_bf16_f32 v36, v138, v139
    v_mfma_f32_16x16x32_bf16 v[158:161], v[82:85], v[206:209], v[158:161]
    ds_read_b128 v[130:133], v2 offset:13312
    v_fma_f32 v255, v142, v142, s33
    v_mfma_f32_16x16x32_bf16 v[158:161], v[86:89], v[246:249], v[158:161]
    ds_read_b128 v[218:221], v2 offset:14336
    v_fmac_f32 v255, v143, v143
    v_mfma_f32_16x16x32_bf16 v[178:181], v[90:93], v[198:201], 0
    ds_read_b128 v[198:201], v2 offset:15360
    v_fmac_f32 v255, v144, v144
    v_mfma_f32_16x16x32_bf16 v[178:181], v[94:97], v[222:225], v[178:181]
    ds_read_b128 v[222:225], v2 offset:16384
    v_fmac_f32 v255, v145, v145
    v_mfma_f32_16x16x32_bf16 v[178:181], v[98:101], v[146:149], v[178:181]
    ds_read_b128 v[230:233], v2 offset:17408
    v_fmac_f32 v255, v158, v158
    v_mfma_f32_16x16x32_bf16 v[178:181], v[102:105], v[242:245], v[178:181]
    v_exp_f32 v140, v140
    v_mfma_f32_16x16x32_bf16 v[178:181], v[106:109], v[206:209], v[178:181]
    v_exp_f32 v141, v141
    v_mfma_f32_16x16x32_bf16 v[178:181], v[110:113], v[246:249], v[178:181]
    s_waitcnt lgkmcnt(5)
    v_cvt_pk_bf16_f32 v37, v140, v141
    v_fmac_f32 v255, v159, v159
    v_mfma_f32_16x16x32_bf16 v[146:149], a[216:219], v[118:121], 0
    s_waitcnt lgkmcnt(4)
    v_fmac_f32 v255, v160, v160
    v_fmac_f32 v255, v161, v161
    v_mfma_f32_16x16x32_bf16 v[242:245], v[28:31], v[36:39], 0
    s_waitcnt lgkmcnt(3)
    v_fmac_f32 v255, v178, v178
    v_fmac_f32 v255, v179, v179
    v_mfma_f32_16x16x32_bf16 v[242:245], v[28:31], v[170:173], v[242:245]
    s_waitcnt lgkmcnt(2)
    v_fmac_f32 v255, v180, v180
    v_fmac_f32 v255, v181, v181
    v_mfma_f32_16x16x32_bf16 v[206:209], v[226:229], v[36:39], 0
    s_waitcnt lgkmcnt(1)
    v_cvt_pk_bf16_f32 v254, v254, v255
    v_mul_f32 v163, v134, v163
    v_mfma_f32_16x16x32_bf16 v[206:209], v[174:177], v[170:173], v[206:209]
    s_waitcnt lgkmcnt(0)
    v_cvt_pk_bf16_f32 v188, v162, v163
    v_mul_f32 v164, v134, v164
    v_mfma_f32_16x16x32_bf16 v[174:177], v[210:213], v[36:39], 0
    v_mul_f32 v165, v134, v165
    v_cvt_pk_bf16_f32 v189, v164, v165
    v_mfma_f32_16x16x32_bf16 v[174:177], v[182:185], v[170:173], v[174:177]
    ds_write_b64 v3, v[188:189] offset:8
    v_mfma_f32_16x16x32_bf16 v[182:185], v[166:169], v[36:39], 0
    v_mul_f32 v234, v134, v234
    v_mul_f32 v235, v134, v235
    v_mfma_f32_16x16x32_bf16 v[182:185], v[114:117], v[170:173], v[182:185]
    v_cvt_pk_bf16_f32 v234, v234, v235
    v_mul_f32 v236, v134, v236
    v_mfma_f32_16x16x32_bf16 v[146:149], a[220:223], v[130:133], v[146:149]
    v_mul_f32 v237, v134, v237
    v_cvt_pk_bf16_f32 v235, v236, v237
    v_mfma_f32_16x16x32_bf16 v[146:149], a[224:227], v[218:221], v[146:149]
    ds_write_b64 v4, v[234:235] offset:4096
    v_mfma_f32_16x16x32_bf16 v[146:149], a[228:231], v[198:201], v[146:149]
    v_rcp_f32 v154, v154
    v_mfma_f32_16x16x32_bf16 v[146:149], a[232:235], v[222:225], v[146:149]
    v_mul_f32 v194, v154, v194
    v_mul_f32 v195, v154, v195
    v_mfma_f32_16x16x32_bf16 v[146:149], a[236:239], v[230:233], v[146:149]
    v_cvt_pk_bf16_f32 v194, v194, v195
    v_mul_f32 v196, v154, v196
    v_mfma_f32_16x16x32_bf16 v[138:141], a[240:243], v[118:121], 0
    v_mul_f32 v197, v154, v197
    v_cvt_pk_bf16_f32 v195, v196, v197
    v_mfma_f32_16x16x32_bf16 v[138:141], a[244:247], v[130:133], v[138:141]
    ds_write_b64 v3, v[194:195] offset:6144
    v_mfma_f32_16x16x32_bf16 v[138:141], a[248:251], v[218:221], v[138:141]
    v_fma_f32 v255, v146, v146, s33
    v_fmac_f32 v255, v147, v147
    v_mfma_f32_16x16x32_bf16 v[138:141], a[252:255], v[198:201], v[138:141]
    ds_read_b128 v[170:173], v0 offset:20480
    v_fmac_f32 v255, v148, v148
    v_mfma_f32_16x16x32_bf16 v[138:141], v[82:85], v[222:225], v[138:141]
    ds_read_b128 v[166:169], v1 offset:20480
    v_fmac_f32 v255, v149, v149
    v_mfma_f32_16x16x32_bf16 v[138:141], v[86:89], v[230:233], v[138:141]
    ds_read_b128 v[162:165], v0 offset:20608
    v_mul_f32 v122, v154, v122
    v_mfma_f32_16x16x32_bf16 v[186:189], v[90:93], v[118:121], 0
    ds_read_b128 v[210:213], v1 offset:20608
    v_mul_f32 v123, v154, v123
    v_mfma_f32_16x16x32_bf16 v[186:189], v[94:97], v[130:133], v[186:189]
    ds_read_b128 v[226:229], v0 offset:20736
    v_cvt_pk_bf16_f32 v196, v122, v123
    v_mfma_f32_16x16x32_bf16 v[186:189], v[98:101], v[218:221], v[186:189]
    ds_read_b128 v[218:221], v1 offset:20736
    v_fmac_f32 v255, v138, v138
    v_mfma_f32_16x16x32_bf16 v[186:189], v[102:105], v[198:201], v[186:189]
    v_fmac_f32 v255, v139, v139
    v_fmac_f32 v255, v140, v140
    v_mfma_f32_16x16x32_bf16 v[186:189], v[106:109], v[222:225], v[186:189]
    v_fmac_f32 v255, v141, v141
    v_mul_f32 v124, v154, v124
    v_mfma_f32_16x16x32_bf16 v[186:189], v[110:113], v[230:233], v[186:189]
    s_waitcnt lgkmcnt(5)
    v_mul_f32 v125, v154, v125
    v_cvt_pk_bf16_f32 v197, v124, v125
    v_mfma_f32_16x16x32_bf16 v[118:121], a[72:75], v[170:173], 0
    s_waitcnt lgkmcnt(4)
    ds_write_b64 v3, v[196:197] offset:6152
    v_mfma_f32_16x16x32_bf16 v[118:121], a[76:79], v[166:169], v[118:121]
    s_waitcnt lgkmcnt(4)
    v_fmac_f32 v255, v186, v186
    v_fmac_f32 v255, v187, v187
    v_mfma_f32_16x16x32_bf16 v[118:121], a[80:83], v[162:165], v[118:121]
    s_waitcnt lgkmcnt(3)
    v_fmac_f32 v255, v188, v188
    v_fmac_f32 v255, v189, v189
    v_mfma_f32_16x16x32_bf16 v[118:121], a[84:87], v[210:213], v[118:121]
    s_waitcnt lgkmcnt(2)
    v_cvt_pk_bf16_f32 v255, v255, v255
    v_mul_f32 v126, v154, v126
    v_mfma_f32_16x16x32_bf16 v[118:121], a[88:91], v[226:229], v[118:121]
    s_waitcnt lgkmcnt(1)
    ds_write_b64 v4, v[254:255] offset:18432
    v_mfma_f32_16x16x32_bf16 v[118:121], a[92:95], v[218:221], v[118:121]
    v_mul_f32 v127, v154, v127
    v_cvt_pk_bf16_f32 v254, v126, v127
    v_mfma_f32_16x16x32_bf16 v[194:197], a[96:99], v[170:173], 0
    v_mul_f32 v128, v154, v128
    v_mul_f32 v129, v154, v129
    v_mfma_f32_16x16x32_bf16 v[194:197], a[100:103], v[166:169], v[194:197]
    v_cvt_pk_bf16_f32 v255, v128, v129
    v_xor_b32 v2, 65536, v2
    v_mfma_f32_16x16x32_bf16 v[194:197], a[104:107], v[162:165], v[194:197]
    ds_write_b64 v4, v[254:255] offset:10240
    v_mfma_f32_16x16x32_bf16 v[194:197], a[108:111], v[210:213], v[194:197]
    v_cvt_pk_f16_f32 v118, v118, v119
    v_pk_mul_f16 v223, v118, v118
    v_mfma_f32_16x16x32_bf16 v[194:197], a[112:115], v[226:229], v[194:197]
    v_cvt_pk_f16_f32 v119, v120, v121
    v_pk_mul_f16 v225, v119, v119
    v_mfma_f32_16x16x32_bf16 v[194:197], a[116:119], v[218:221], v[194:197]
    v_rcp_f32 v242, v242
    v_mfma_f32_16x16x32_bf16 v[114:117], a[120:123], v[170:173], 0
    v_mul_f32 v206, v242, v206
    v_mul_f32 v207, v242, v207
    v_mfma_f32_16x16x32_bf16 v[114:117], a[124:127], v[166:169], v[114:117]
    v_cvt_pk_bf16_f32 v206, v206, v207
    v_mul_f32 v208, v242, v208
    v_mfma_f32_16x16x32_bf16 v[114:117], a[128:131], v[162:165], v[114:117]
    v_cvt_pk_f16_f32 v120, v194, v195
    v_pk_fma_f16 v223, v120, v120, v223
    v_mfma_f32_16x16x32_bf16 v[114:117], a[132:135], v[210:213], v[114:117]
    v_cvt_pk_f16_f32 v121, v196, v197
    v_pk_fma_f16 v225, v121, v121, v225
    v_mfma_f32_16x16x32_bf16 v[114:117], a[136:139], v[226:229], v[114:117]
    v_mul_f32 v209, v242, v209
    v_cvt_pk_bf16_f32 v207, v208, v209
    v_mfma_f32_16x16x32_bf16 v[114:117], a[140:143], v[218:221], v[114:117]
    ds_write_b64 v3, v[206:207] offset:12288
    v_mfma_f32_16x16x32_bf16 v[154:157], a[0:3], v[170:173], 0
    v_mul_f32 v174, v242, v174
    v_mul_f32 v175, v242, v175
    v_mfma_f32_16x16x32_bf16 v[154:157], a[4:7], v[166:169], v[154:157]
    v_cvt_pk_bf16_f32 v208, v174, v175
    v_mul_f32 v176, v242, v176
    v_mfma_f32_16x16x32_bf16 v[154:157], a[8:11], v[162:165], v[154:157]
    v_cvt_pk_f16_f32 v196, v114, v115
    v_pk_fma_f16 v223, v196, v196, v223
    v_mfma_f32_16x16x32_bf16 v[154:157], a[12:15], v[210:213], v[154:157]
    v_cvt_pk_f16_f32 v197, v116, v117
    v_pk_fma_f16 v225, v197, v197, v225
    v_mfma_f32_16x16x32_bf16 v[154:157], a[16:19], v[226:229], v[154:157]
    v_mul_f32 v177, v242, v177
    v_cvt_pk_bf16_f32 v209, v176, v177
    v_mfma_f32_16x16x32_bf16 v[154:157], a[20:23], v[218:221], v[154:157]
    ds_write_b64 v3, v[208:209] offset:12296
    v_mfma_f32_16x16x32_bf16 v[174:177], a[24:27], v[170:173], 0
    v_mul_f32 v182, v242, v182
    v_mul_f32 v183, v242, v183
    v_mfma_f32_16x16x32_bf16 v[174:177], a[28:31], v[166:169], v[174:177]
    v_cvt_pk_bf16_f32 v194, v182, v183
    v_mul_f32 v184, v242, v184
    v_mfma_f32_16x16x32_bf16 v[174:177], a[32:35], v[162:165], v[174:177]
    v_cvt_pk_f16_f32 v206, v154, v155
    v_mul_f32 v185, v242, v185
    v_mfma_f32_16x16x32_bf16 v[174:177], a[36:39], v[210:213], v[174:177]
    v_cvt_pk_bf16_f32 v195, v184, v185
    v_xor_b32 v3, 65536, v3
    v_mfma_f32_16x16x32_bf16 v[174:177], a[40:43], v[226:229], v[174:177]
    ds_write_b64 v4, v[194:195] offset:16384
    v_mfma_f32_16x16x32_bf16 v[174:177], a[44:47], v[218:221], v[174:177]
    v_xor_b32 v4, 65536, v4
    v_mfma_f32_16x16x32_bf16 v[182:185], a[48:51], v[170:173], 0
    v_mfma_f32_16x16x32_bf16 v[182:185], a[52:55], v[166:169], v[182:185]
    v_mfma_f32_16x16x32_bf16 v[182:185], a[56:59], v[162:165], v[182:185]
    v_mfma_f32_16x16x32_bf16 v[182:185], a[60:63], v[210:213], v[182:185]
    v_mfma_f32_16x16x32_bf16 v[182:185], a[64:67], v[226:229], v[182:185]
    v_mfma_f32_16x16x32_bf16 v[182:185], a[68:71], v[218:221], v[182:185]
    v_mfma_f32_16x16x32_bf16 v[230:233], v[170:173], a[144:147], 0
    s_waitcnt lgkmcnt(0)
    v_mfma_f32_16x16x32_bf16 v[230:233], v[166:169], a[148:151], v[230:233]
    s_nop 0
    v_mfma_f32_16x16x32_bf16 v[230:233], v[162:165], a[152:155], v[230:233]
    s_nop 0
    v_mfma_f32_16x16x32_bf16 v[230:233], v[210:213], a[156:159], v[230:233]
    s_nop 0
    v_mfma_f32_16x16x32_bf16 v[230:233], v[226:229], a[160:163], v[230:233]
    s_barrier
    v_mfma_f32_16x16x32_bf16 v[230:233], v[218:221], a[164:167], v[230:233]
    s_cbranch_scc1 L_loop_fast3
L_final_fast:
    v_mfma_f32_16x16x32_bf16 v[114:117], v[170:173], a[168:171], 0
    s_mov_b32 s12, s42
    ds_read_b128 v[122:125], v2 offset:18432
    ds_read_b128 v[126:129], v2 offset:19456
    v_mfma_f32_16x16x32_bf16 v[114:117], v[166:169], a[172:175], v[114:117]
    s_mov_b32 s13, s43
    ds_read_b128 v[130:133], v0 offset:26624
    ds_read_b128 v[134:137], v1 offset:26624
    v_mfma_f32_16x16x32_bf16 v[114:117], v[162:165], a[176:179], v[114:117]
    s_mov_b32 s14, s36
    v_bfe_u32 v254, v2, 4, 6
    v_lshrrev_b32 v255, 4, v254
    v_mfma_f32_16x16x32_bf16 v[114:117], v[210:213], a[180:183], v[114:117]
    s_add_u32 s48, s42, s27
    ds_read_b128 v[198:201], v0 offset:26752
    ds_read_b128 v[214:217], v1 offset:26752
    v_mfma_f32_16x16x32_bf16 v[114:117], v[226:229], a[184:187], v[114:117]
    s_addc_u32 s49, s43, 0
    v_and_b32 v154, 15, v254
    v_lshlrev_b32 v155, 9, v255
    v_mfma_f32_16x16x32_bf16 v[114:117], v[218:221], a[188:191], v[114:117]
    s_sub_u32 s50, s36, s27
    ds_read_b128 v[234:237], v0 offset:26880
    ds_read_b128 v[238:241], v1 offset:26880
    v_mfma_f32_16x16x32_bf16 v[242:245], v[170:173], a[192:195], 0
    s_mov_b32 s51, 0x00020000
    v_lshl_add_u32 v155, v154, 4, v155
    v_add_u32 v155, 136704, v155
    v_mfma_f32_16x16x32_bf16 v[242:245], v[166:169], a[196:199], v[242:245]
    s_add_u32 s52, s42, s26
    ds_read_b128 v[166:169], v2 offset:0
    ds_read_b128 v[170:173], v2 offset:1024
    v_mfma_f32_16x16x32_bf16 v[242:245], v[162:165], a[200:203], v[242:245]
    s_waitcnt lgkmcnt(8)
    v_and_b32 v162, 0xffff, v2
    v_add_u32 v162, 148992, v162
    v_mfma_f32_16x16x32_bf16 v[246:249], v[32:35], v[122:125], 0
    s_waitcnt lgkmcnt(6)
    ds_read_b128 v[122:125], v2 offset:2048
    v_and_b32 v163, 0xffff, v4
    v_mfma_f32_16x16x32_bf16 v[246:249], v[32:35], v[126:129], v[246:249]
    s_addc_u32 s53, s43, 0
    ds_read_b128 v[126:129], v2 offset:3072
    v_add_u32 v163, 148992, v163
    v_mfma_f32_16x16x32_bf16 v[242:245], v[210:213], a[204:207], v[242:245]
    s_sub_u32 s54, s36, s26
    ds_read_b128 v[210:213], v2 offset:4096
    v_pk_mul_f16 v222, v206, v206
    v_mfma_f32_16x16x32_bf16 v[242:245], v[226:229], a[208:211], v[242:245]
    s_mov_b32 s55, 0x00020000
    v_mul_f32 v224, 0x3baaaaab, v247
    v_mul_f32 v164, 0x3baaaaab, v248
    v_mfma_f32_16x16x32_bf16 v[242:245], v[218:221], a[212:215], v[242:245]
    s_add_u32 s56, s42, s25
    ds_read_b128 v[218:221], v2 offset:5120
    s_addc_u32 s57, s43, 0
    s_sub_u32 s58, s36, s25
    s_mov_b32 s59, 0x00020000
    v_rsq_f32 v224, v224
    v_rsq_f32 v164, v164
    v_mul_f32 v142, v224, v142
    v_mul_f32 v143, v224, v143
    v_cvt_pk_bf16_f32 v142, v142, v143
    v_mfma_f32_16x16x32_bf16 v[226:229], a[72:75], v[130:133], 0
    s_lshl_b32 s3, s16, 6
    v_mul_f32 v144, v224, v144
    v_mul_f32 v145, v224, v145
    v_mfma_f32_16x16x32_bf16 v[226:229], a[76:79], v[134:137], v[226:229]
    s_waitcnt lgkmcnt(2)
    v_cvt_pk_bf16_f32 v143, v144, v145
    v_mul_f32 v158, v224, v158
    v_mfma_f32_16x16x32_bf16 v[226:229], a[80:83], v[198:201], v[226:229]
    s_lshl_b32 s4, s16, 5
    v_mul_f32 v159, v224, v159
    v_cvt_pk_bf16_f32 v144, v158, v159
    v_mfma_f32_16x16x32_bf16 v[226:229], a[84:87], v[214:217], v[226:229]
    s_add_u32 s4, s4, 256
    v_mul_f32 v160, v224, v160
    v_mul_f32 v161, v224, v161
    v_mfma_f32_16x16x32_bf16 v[226:229], a[88:91], v[234:237], v[226:229]
    s_mul_i32 s5, s16, 8064
    v_cvt_pk_bf16_f32 v145, v160, v161
    v_mul_f32 v178, v224, v178
    v_mfma_f32_16x16x32_bf16 v[226:229], a[92:95], v[238:241], v[226:229]
    s_add_u32 s5, s5, 104448
    buffer_store_dwordx4 v[142:145], v16, s[48:51], 0 offen nt
    v_mul_f32 v179, v224, v179
    v_cvt_pk_bf16_f32 v194, v178, v179
    v_mul_f32 v180, v224, v180
    v_mul_f32 v181, v224, v181
    v_mfma_f32_16x16x32_bf16 v[142:145], a[216:219], v[166:169], 0
    s_waitcnt lgkmcnt(0)
    v_cvt_pk_bf16_f32 v195, v180, v181
    v_mul_f32 v146, v164, v146
    v_mfma_f32_16x16x32_bf16 v[142:145], a[220:223], v[170:173], v[142:145]
    v_mul_f32 v147, v164, v147
    v_cvt_pk_bf16_f32 v146, v146, v147
    v_mfma_f32_16x16x32_bf16 v[142:145], a[224:227], v[122:125], v[142:145]
    v_mul_f32 v148, v164, v148
    v_mul_f32 v149, v164, v149
    v_mfma_f32_16x16x32_bf16 v[142:145], a[228:231], v[126:129], v[142:145]
    v_cvt_pk_bf16_f32 v147, v148, v149
    v_mul_f32 v138, v164, v138
    v_mfma_f32_16x16x32_bf16 v[142:145], a[232:235], v[210:213], v[142:145]
    v_mul_f32 v139, v164, v139
    v_cvt_pk_bf16_f32 v148, v138, v139
    v_mfma_f32_16x16x32_bf16 v[142:145], a[236:239], v[218:221], v[142:145]
    v_mul_f32 v140, v164, v140
    v_mul_f32 v141, v164, v141
    v_mfma_f32_16x16x32_bf16 v[158:161], a[240:243], v[166:169], 0
    v_cvt_pk_bf16_f32 v149, v140, v141
    v_mul_f32 v186, v164, v186
    v_mfma_f32_16x16x32_bf16 v[158:161], a[244:247], v[170:173], v[158:161]
    v_mul_f32 v187, v164, v187
    v_cvt_pk_bf16_f32 v186, v186, v187
    v_mfma_f32_16x16x32_bf16 v[158:161], a[248:251], v[122:125], v[158:161]
    v_mul_f32 v188, v164, v188
    v_mul_f32 v189, v164, v189
    v_mfma_f32_16x16x32_bf16 v[158:161], a[252:255], v[126:129], v[158:161]
    v_cvt_pk_bf16_f32 v187, v188, v189
    v_mul_f32 v224, 0x3baaaaab, v246
    v_mfma_f32_16x16x32_bf16 v[158:161], v[82:85], v[210:213], v[158:161]
    v_rsq_f32 v224, v224
    v_mfma_f32_16x16x32_bf16 v[158:161], v[86:89], v[218:221], v[158:161]
    v_mul_f32 v150, v224, v150
    v_mul_f32 v151, v224, v151
    v_mfma_f32_16x16x32_bf16 v[138:141], v[90:93], v[166:169], 0
    ds_read_b128 v[166:169], v2 offset:6144
    v_cvt_pk_bf16_f32 v150, v150, v151
    v_mfma_f32_16x16x32_bf16 v[138:141], v[94:97], v[170:173], v[138:141]
    ds_read_b128 v[170:173], v2 offset:7168
    v_mul_f32 v152, v224, v152
    v_mfma_f32_16x16x32_bf16 v[138:141], v[98:101], v[122:125], v[138:141]
    ds_read_b128 v[122:125], v2 offset:8192
    buffer_store_dwordx2 v[194:195], v19, s[48:51], 0 offen nt
    v_mul_f32 v153, v224, v153
    v_cvt_pk_bf16_f32 v151, v152, v153
    v_mfma_f32_16x16x32_bf16 v[138:141], v[102:105], v[126:129], v[138:141]
    ds_read_b128 v[126:129], v2 offset:9216
    v_mul_f32 v190, v224, v190
    v_mfma_f32_16x16x32_bf16 v[138:141], v[106:109], v[210:213], v[138:141]
    ds_read_b128 v[178:181], v2 offset:10240
    v_mul_f32 v191, v224, v191
    v_mfma_f32_16x16x32_bf16 v[138:141], v[110:113], v[218:221], v[138:141]
    ds_read_b128 v[210:213], v2 offset:11264
    v_cvt_pk_bf16_f32 v152, v190, v191
    v_mfma_f32_16x16x32_bf16 v[218:221], a[96:99], v[130:133], 0
    v_mul_f32 v192, v224, v192
    v_mul_f32 v193, v224, v193
    v_mfma_f32_16x16x32_bf16 v[218:221], a[100:103], v[134:137], v[218:221]
    s_waitcnt lgkmcnt(5)
    v_cvt_pk_bf16_f32 v153, v192, v193
    v_mul_f32 v202, v224, v202
    v_mfma_f32_16x16x32_bf16 v[190:193], a[216:219], v[166:169], 0
    s_waitcnt lgkmcnt(4)
    v_mul_f32 v203, v224, v203
    v_cvt_pk_bf16_f32 v164, v202, v203
    v_mfma_f32_16x16x32_bf16 v[190:193], a[220:223], v[170:173], v[190:193]
    s_waitcnt lgkmcnt(3)
    v_mul_f32 v204, v224, v204
    v_mul_f32 v205, v224, v205
    v_mfma_f32_16x16x32_bf16 v[190:193], a[224:227], v[122:125], v[190:193]
    v_cvt_pk_bf16_f32 v165, v204, v205
    v_fma_f32 v188, v142, v142, s33
    v_mfma_f32_16x16x32_bf16 v[202:205], a[240:243], v[166:169], 0
    s_waitcnt lgkmcnt(2)
    v_fmac_f32 v188, v143, v143
    v_fmac_f32 v188, v144, v144
    v_mfma_f32_16x16x32_bf16 v[190:193], a[228:231], v[126:129], v[190:193]
    s_waitcnt lgkmcnt(1)
    v_fmac_f32 v188, v145, v145
    v_fmac_f32 v188, v158, v158
    v_mfma_f32_16x16x32_bf16 v[190:193], a[232:235], v[178:181], v[190:193]
    s_waitcnt lgkmcnt(0)
    v_fmac_f32 v188, v159, v159
    v_fmac_f32 v188, v160, v160
    v_mfma_f32_16x16x32_bf16 v[190:193], a[236:239], v[210:213], v[190:193]
    v_fmac_f32 v188, v161, v161
    v_fmac_f32 v188, v138, v138
    v_mfma_f32_16x16x32_bf16 v[202:205], a[244:247], v[170:173], v[202:205]
    v_fmac_f32 v188, v139, v139
    v_fmac_f32 v188, v140, v140
    v_mfma_f32_16x16x32_bf16 v[202:205], a[248:251], v[122:125], v[202:205]
    v_fmac_f32 v188, v141, v141
    v_cvt_pk_f16_f32 v207, v156, v157
    v_mfma_f32_16x16x32_bf16 v[202:205], a[252:255], v[126:129], v[202:205]
    v_fma_f32 v189, v190, v190, s33
    v_fmac_f32 v189, v191, v191
    v_mfma_f32_16x16x32_bf16 v[202:205], v[82:85], v[178:181], v[202:205]
    buffer_store_dwordx4 v[146:149], v17, s[48:51], 0 offen nt
    v_fmac_f32 v189, v192, v192
    v_fmac_f32 v189, v193, v193
    v_pk_mul_f16 v224, v207, v207
    v_cvt_pk_f16_f32 v208, v174, v175
    v_mfma_f32_16x16x32_bf16 v[202:205], v[86:89], v[210:213], v[202:205]
    v_pk_fma_f16 v222, v208, v208, v222
    v_cvt_pk_f16_f32 v209, v176, v177
    v_mfma_f32_16x16x32_bf16 v[146:149], v[90:93], v[166:169], 0
    ds_read_b128 v[166:169], v2 offset:12288
    v_pk_fma_f16 v224, v209, v209, v224
    v_mfma_f32_16x16x32_bf16 v[146:149], v[94:97], v[170:173], v[146:149]
    ds_read_b128 v[170:173], v2 offset:13312
    v_cvt_pk_f16_f32 v194, v182, v183
    v_mfma_f32_16x16x32_bf16 v[146:149], v[98:101], v[122:125], v[146:149]
    ds_read_b128 v[122:125], v2 offset:14336
    v_fmac_f32 v189, v202, v202
    v_mfma_f32_16x16x32_bf16 v[146:149], v[102:105], v[126:129], v[146:149]
    ds_read_b128 v[126:129], v2 offset:15360
    v_fmac_f32 v189, v203, v203
    v_mfma_f32_16x16x32_bf16 v[146:149], v[106:109], v[178:181], v[146:149]
    ds_read_b128 v[174:177], v2 offset:16384
    v_fmac_f32 v189, v204, v204
    v_mfma_f32_16x16x32_bf16 v[146:149], v[110:113], v[210:213], v[146:149]
    ds_read_b128 v[178:181], v2 offset:17408
    v_fmac_f32 v189, v205, v205
    v_mfma_f32_16x16x32_bf16 v[218:221], a[104:107], v[198:201], v[218:221]
    v_pk_fma_f16 v222, v194, v194, v222
    v_cvt_pk_f16_f32 v195, v184, v185
    v_mfma_f32_16x16x32_bf16 v[218:221], a[108:111], v[214:217], v[218:221]
    v_pk_fma_f16 v224, v195, v195, v224
    v_cvt_pk_bf16_f32 v182, v230, v231
    v_mfma_f32_16x16x32_bf16 v[218:221], a[112:115], v[234:237], v[218:221]
    s_waitcnt lgkmcnt(5)
    v_fmac_f32 v189, v146, v146
    v_fmac_f32 v189, v147, v147
    v_mfma_f32_16x16x32_f16 v[210:213], v[40:43], v[222:225], 0
    s_waitcnt lgkmcnt(4)
    v_fmac_f32 v189, v148, v148
    v_fmac_f32 v189, v149, v149
    v_mfma_f32_16x16x32_bf16 v[222:225], a[216:219], v[166:169], 0
    s_waitcnt lgkmcnt(3)
    v_cvt_pk_bf16_f32 v188, v188, v189
    v_cvt_pk_bf16_f32 v189, v189, v189
    v_mfma_f32_16x16x32_bf16 v[222:225], a[220:223], v[170:173], v[222:225]
    s_waitcnt lgkmcnt(2)
    ds_write_b64 v163, v[188:189] offset:0
    v_mfma_f32_16x16x32_bf16 v[222:225], a[224:227], v[122:125], v[222:225]
    s_waitcnt lgkmcnt(1)
    v_rsq_f32 v212, v210
    v_mfma_f32_16x16x32_bf16 v[222:225], a[228:231], v[126:129], v[222:225]
    buffer_store_dwordx2 v[186:187], v20, s[48:51], 0 offen nt
    v_rsq_f32 v213, v211
    v_mfma_f32_16x16x32_bf16 v[222:225], a[232:235], v[174:177], v[222:225]
    v_mul_f32 v212, s31, v212
    v_cvt_pk_f16_f32 v212, v212, v213
    v_mfma_f32_16x16x32_bf16 v[222:225], a[236:239], v[178:181], v[222:225]
    v_cvt_pk_bf16_f32 v183, v232, v233
    v_cvt_pk_bf16_f32 v114, v114, v115
    v_mfma_f32_16x16x32_bf16 v[186:189], a[240:243], v[166:169], 0
    v_cvt_pk_bf16_f32 v115, v116, v117
    v_cvt_pk_bf16_f32 v230, v242, v243
    v_mfma_f32_16x16x32_bf16 v[186:189], a[244:247], v[170:173], v[186:189]
    v_cvt_pk_bf16_f32 v231, v244, v245
    v_pk_mul_f16 v118, v118, v212 op_sel:[0,1] op_sel_hi:[1,1]
    v_mfma_f32_16x16x32_bf16 v[186:189], a[248:251], v[122:125], v[186:189]
    s_waitcnt lgkmcnt(0)
    v_pk_mul_f16 v119, v119, v212 op_sel:[0,1] op_sel_hi:[1,1]
    v_pk_mul_f16 v120, v120, v212 op_sel:[0,1] op_sel_hi:[1,1]
    v_mfma_f32_16x16x32_bf16 v[186:189], a[252:255], v[126:129], v[186:189]
    s_barrier
    ds_read_b128 v[242:245], v162 offset:0
    v_pk_mul_f16 v121, v121, v212 op_sel:[0,1] op_sel_hi:[1,1]
    v_mfma_f32_16x16x32_bf16 v[186:189], v[82:85], v[174:177], v[186:189]
    v_pk_mul_f16 v196, v196, v212 op_sel:[0,1] op_sel_hi:[1,1]
    v_pk_mul_f16 v197, v197, v212 op_sel:[0,1] op_sel_hi:[1,1]
    v_mfma_f32_16x16x32_bf16 v[186:189], v[86:89], v[178:181], v[186:189]
    v_pk_mul_f16 v206, v206, v212 op_sel:[0,0] op_sel_hi:[1,0]
    v_pk_mul_f16 v207, v207, v212 op_sel:[0,0] op_sel_hi:[1,0]
    v_mfma_f32_16x16x32_bf16 v[218:221], a[116:119], v[238:241], v[218:221]
    v_pk_mul_f16 v208, v208, v212 op_sel:[0,0] op_sel_hi:[1,0]
    v_pk_mul_f16 v209, v209, v212 op_sel:[0,0] op_sel_hi:[1,0]
    v_pk_mul_f16 v194, v194, v212 op_sel:[0,0] op_sel_hi:[1,0]
    v_pk_mul_f16 v195, v195, v212 op_sel:[0,0] op_sel_hi:[1,0]
    v_mfma_f32_16x16x32_bf16 v[246:249], v[90:93], v[166:169], 0
    ds_read_b128 v[166:169], v162 offset:1024
    v_min3_u32 v44, v44, v210, v211
    v_mfma_f32_16x16x32_bf16 v[246:249], v[94:97], v[170:173], v[246:249]
    ds_read_b128 v[170:173], v155 offset:0
    v_max3_u32 v45, v45, v210, v211
    v_mfma_f32_16x16x32_bf16 v[246:249], v[98:101], v[122:125], v[246:249]
    ds_read_b128 v[122:125], v155 offset:2048
    v_mov_b32 v156, 0x40000000
    v_mfma_f32_16x16x32_bf16 v[246:249], v[102:105], v[126:129], v[246:249]
    s_waitcnt lgkmcnt(3)
    ds_read_b128 v[126:129], v155 offset:4096
    v_add_u32 v157, 0, v154
    v_mfma_f32_16x16x32_bf16 v[246:249], v[106:109], v[174:177], v[246:249]
    ds_read_b128 v[174:177], v155 offset:6144
    v_mul_u32_u24 v116, s20, v157
    v_mfma_f32_16x16x32_bf16 v[246:249], v[110:113], v[178:181], v[246:249]
    buffer_store_dwordx4 v[150:153], v15, s[48:51], 0 offen nt
    ds_read_b128 v[178:181], v155 offset:8192
    v_add_u32 v116, s38, v116
    v_mul_u32_u24 v116, 911, v116
    v_lshrrev_b32 v116, 16, v116
    v_mul_u32_u24 v116, s22, v116
    v_mad_u32_u24 v116, v157, s21, v116
    v_cmp_gt_u32 vcc, s17, v157
    v_mfma_f32_16x16x32_bf16 v[150:153], v[32:35], v[242:245], 0
    s_waitcnt lgkmcnt(5)
    ds_read_b128 v[210:213], v155 offset:10240
    v_add_u32 v157, s7, v116
    v_mfma_f32_16x16x32_bf16 v[150:153], v[32:35], v[166:169], v[150:153]
    s_waitcnt lgkmcnt(5)
    v_cndmask_b32 v157, v156, v157, vcc
    v_lshl_add_u32 v166, v255, 4, v157
    v_mfma_f32_16x16x32_bf16 v[242:245], a[120:123], v[130:133], 0
    s_waitcnt lgkmcnt(4)
    v_add_u32 v166, s3, v166
    v_lshl_add_u32 v157, v255, 3, v157
    v_mfma_f32_16x16x32_bf16 v[242:245], a[124:127], v[134:137], v[242:245]
    s_waitcnt lgkmcnt(3)
    v_mul_f32 v116, 0x3baaaaab, v151
    v_mul_f32 v117, 0x3baaaaab, v150
    v_mfma_f32_16x16x32_bf16 v[242:245], a[128:131], v[198:201], v[242:245]
    s_waitcnt lgkmcnt(2)
    v_rsq_f32 v116, v116
    v_mfma_f32_16x16x32_bf16 v[242:245], a[132:135], v[214:217], v[242:245]
    s_waitcnt lgkmcnt(1)
    v_mul_f32 v190, v116, v190
    v_mul_f32 v191, v116, v191
    v_mfma_f32_16x16x32_bf16 v[242:245], a[136:139], v[234:237], v[242:245]
    v_cvt_pk_bf16_f32 v150, v190, v191
    v_mul_f32 v192, v116, v192
    v_mfma_f32_16x16x32_bf16 v[242:245], a[140:143], v[238:241], v[242:245]
    v_mul_f32 v193, v116, v193
    v_cvt_pk_bf16_f32 v151, v192, v193
    v_mul_f32 v202, v116, v202
    v_mul_f32 v203, v116, v203
    v_cvt_pk_bf16_f32 v152, v202, v203
    v_mfma_f32_16x16x32_bf16 v[190:193], a[216:219], v[170:173], 0
    s_waitcnt lgkmcnt(0)
    v_mul_f32 v204, v116, v204
    v_mul_f32 v205, v116, v205
    v_mfma_f32_16x16x32_bf16 v[190:193], a[220:223], v[122:125], v[190:193]
    v_cvt_pk_bf16_f32 v153, v204, v205
    v_mul_f32 v146, v116, v146
    v_mfma_f32_16x16x32_bf16 v[190:193], a[224:227], v[126:129], v[190:193]
    v_mul_f32 v147, v116, v147
    v_cvt_pk_bf16_f32 v184, v146, v147
    v_mfma_f32_16x16x32_bf16 v[190:193], a[228:231], v[174:177], v[190:193]
    v_mul_f32 v148, v116, v148
    v_mul_f32 v149, v116, v149
    v_mfma_f32_16x16x32_bf16 v[190:193], a[232:235], v[178:181], v[190:193]
    v_cvt_pk_bf16_f32 v185, v148, v149
    v_add_u32 v157, s4, v157
    v_mfma_f32_16x16x32_bf16 v[190:193], a[236:239], v[210:213], v[190:193]
    buffer_store_dwordx4 v[150:153], v16, s[52:55], 0 offen nt
    v_rsq_f32 v117, v117
    v_fma_f32 v116, v222, v222, s33
    v_mul_f32 v142, v117, v142
    v_mfma_f32_16x16x32_bf16 v[146:149], a[240:243], v[170:173], 0
    v_mul_f32 v143, v117, v143
    v_cvt_pk_bf16_f32 v142, v142, v143
    v_mfma_f32_16x16x32_bf16 v[146:149], a[244:247], v[122:125], v[146:149]
    v_mul_f32 v144, v117, v144
    v_mul_f32 v145, v117, v145
    v_mfma_f32_16x16x32_bf16 v[146:149], a[248:251], v[126:129], v[146:149]
    v_cvt_pk_bf16_f32 v143, v144, v145
    v_mul_f32 v158, v117, v158
    v_mfma_f32_16x16x32_bf16 v[146:149], a[252:255], v[174:177], v[146:149]
    v_mul_f32 v159, v117, v159
    v_cvt_pk_bf16_f32 v144, v158, v159
    v_mfma_f32_16x16x32_bf16 v[146:149], v[82:85], v[178:181], v[146:149]
    v_mul_f32 v160, v117, v160
    v_mul_f32 v161, v117, v161
    v_mfma_f32_16x16x32_bf16 v[146:149], v[86:89], v[210:213], v[146:149]
    v_cvt_pk_bf16_f32 v145, v160, v161
    v_mul_f32 v138, v117, v138
    v_mfma_f32_16x16x32_bf16 v[150:153], v[90:93], v[170:173], 0
    v_mul_f32 v139, v117, v139
    v_cvt_pk_bf16_f32 v168, v138, v139
    v_mfma_f32_16x16x32_bf16 v[150:153], v[94:97], v[122:125], v[150:153]
    v_mul_f32 v140, v117, v140
    v_mul_f32 v141, v117, v141
    v_mfma_f32_16x16x32_bf16 v[150:153], v[98:101], v[126:129], v[150:153]
    v_cvt_pk_bf16_f32 v169, v140, v141
    v_fma_f32 v117, v190, v190, s33
    v_mfma_f32_16x16x32_bf16 v[150:153], v[102:105], v[174:177], v[150:153]
    v_fmac_f32 v117, v191, v191
    v_fmac_f32 v117, v192, v192
    v_mfma_f32_16x16x32_bf16 v[150:153], v[106:109], v[178:181], v[150:153]
    v_fmac_f32 v117, v193, v193
    v_fmac_f32 v117, v146, v146
    v_mfma_f32_16x16x32_bf16 v[150:153], v[110:113], v[210:213], v[150:153]
    v_fmac_f32 v117, v147, v147
    v_fmac_f32 v117, v148, v148
    v_mfma_f32_16x16x32_bf16 v[122:125], a[0:3], v[130:133], 0
    v_fmac_f32 v117, v149, v149
    v_fmac_f32 v116, v223, v223
    v_mfma_f32_16x16x32_bf16 v[122:125], a[4:7], v[134:137], v[122:125]
    v_fmac_f32 v116, v224, v224
    v_fmac_f32 v116, v225, v225
    v_mfma_f32_16x16x32_bf16 v[122:125], a[8:11], v[198:201], v[122:125]
    v_fmac_f32 v117, v150, v150
    v_fmac_f32 v117, v151, v151
    v_mfma_f32_16x16x32_bf16 v[122:125], a[12:15], v[214:217], v[122:125]
    buffer_store_dwordx2 v[184:185], v19, s[52:55], 0 offen nt
    v_fmac_f32 v117, v152, v152
    v_fmac_f32 v117, v153, v153
    v_mfma_f32_16x16x32_bf16 v[122:125], a[16:19], v[234:237], v[122:125]
    v_cvt_pk_bf16_f32 v185, v117, v117
    v_fmac_f32 v116, v186, v186
    v_mfma_f32_16x16x32_bf16 v[122:125], a[20:23], v[238:241], v[122:125]
    v_fmac_f32 v116, v187, v187
    v_fmac_f32 v116, v188, v188
    v_mfma_f32_16x16x32_bf16 v[126:129], a[24:27], v[130:133], 0
    v_fmac_f32 v116, v189, v189
    v_fmac_f32 v116, v246, v246
    v_mfma_f32_16x16x32_bf16 v[126:129], a[28:31], v[134:137], v[126:129]
    v_fmac_f32 v116, v247, v247
    v_fmac_f32 v116, v248, v248
    v_mfma_f32_16x16x32_bf16 v[126:129], a[32:35], v[198:201], v[126:129]
    v_fmac_f32 v116, v249, v249
    v_cvt_pk_bf16_f32 v184, v116, v117
    v_mfma_f32_16x16x32_bf16 v[126:129], a[36:39], v[214:217], v[126:129]
    ds_write_b64 v163, v[184:185] offset:2048
    v_mfma_f32_16x16x32_bf16 v[126:129], a[40:43], v[234:237], v[126:129]
    v_cvt_pk_f16_f32 v122, v122, v123
    v_pk_mul_f16 v138, v122, v122
    v_mfma_f32_16x16x32_bf16 v[126:129], a[44:47], v[238:241], v[126:129]
    v_cvt_pk_f16_f32 v123, v124, v125
    v_pk_mul_f16 v140, v123, v123
    v_mfma_f32_16x16x32_bf16 v[158:161], a[48:51], v[130:133], 0
    v_cvt_pk_f16_f32 v170, v226, v227
    v_pk_mul_f16 v139, v170, v170
    v_mfma_f32_16x16x32_bf16 v[158:161], a[52:55], v[134:137], v[158:161]
    v_cvt_pk_f16_f32 v171, v228, v229
    v_pk_mul_f16 v141, v171, v171
    v_mfma_f32_16x16x32_bf16 v[158:161], a[56:59], v[198:201], v[158:161]
    v_cvt_pk_f16_f32 v124, v126, v127
    v_pk_fma_f16 v138, v124, v124, v138
    v_mfma_f32_16x16x32_bf16 v[158:161], a[60:63], v[214:217], v[158:161]
    v_cvt_pk_f16_f32 v125, v128, v129
    v_pk_fma_f16 v140, v125, v125, v140
    v_mfma_f32_16x16x32_bf16 v[158:161], a[64:67], v[234:237], v[158:161]
    s_waitcnt lgkmcnt(0)
    v_cvt_pk_f16_f32 v172, v218, v219
    v_pk_fma_f16 v139, v172, v172, v139
    v_mfma_f32_16x16x32_bf16 v[158:161], a[68:71], v[238:241], v[158:161]
    s_barrier
    ds_read_b128 v[126:129], v162 offset:2048
    ds_read_b128 v[174:177], v162 offset:3072
    v_mfma_f32_16x16x32_bf16 v[178:181], v[130:133], a[144:147], 0
    v_cvt_pk_f16_f32 v173, v220, v221
    v_pk_fma_f16 v141, v173, v173, v141
    v_mfma_f32_16x16x32_bf16 v[178:181], v[134:137], a[148:151], v[178:181]
    buffer_store_dwordx2 v[164:165], v18, s[48:51], 0 offen nt
    v_cvt_pk_f16_f32 v158, v158, v159
    v_pk_fma_f16 v138, v158, v158, v138
    v_mfma_f32_16x16x32_bf16 v[178:181], v[198:201], a[152:155], v[178:181]
    v_cvt_pk_f16_f32 v159, v160, v161
    v_pk_fma_f16 v140, v159, v159, v140
    v_mfma_f32_16x16x32_bf16 v[178:181], v[214:217], a[156:159], v[178:181]
    v_cvt_pk_f16_f32 v160, v242, v243
    v_pk_fma_f16 v139, v160, v160, v139
    v_mfma_f32_16x16x32_bf16 v[178:181], v[234:237], a[160:163], v[178:181]
    v_cvt_pk_f16_f32 v161, v244, v245
    v_pk_fma_f16 v141, v161, v161, v141
    v_mfma_f32_16x16x32_bf16 v[178:181], v[238:241], a[164:167], v[178:181]
    ds_read_b128 v[202:205], v0 offset:32768
    v_xor_b32 v164, 65536, v2
    v_mfma_f32_16x16x32_f16 v[210:213], v[40:43], v[138:141], 0
    s_waitcnt lgkmcnt(2)
    v_bfe_u32 v165, v154, 1, 2
    v_xor_b32 v165, v165, v255
    v_mfma_f32_16x16x32_bf16 v[138:141], v[32:35], v[126:129], 0
    s_waitcnt lgkmcnt(1)
    v_cvt_pk_bf16_f32 v184, v178, v179
    v_cvt_pk_bf16_f32 v185, v180, v181
    v_mfma_f32_16x16x32_bf16 v[138:141], v[32:35], v[174:177], v[138:141]
    v_rsq_f32 v212, v210
    v_mfma_f32_16x16x32_bf16 v[126:129], v[130:133], a[168:171], 0
    ds_read_b128 v[174:177], v1 offset:32768
    v_mul_f32 v212, s31, v212
    v_mfma_f32_16x16x32_bf16 v[126:129], v[134:137], a[172:175], v[126:129]
    ds_read_b128 v[178:181], v0 offset:32896
    v_min3_u32 v44, v44, v210, v211
    v_mfma_f32_16x16x32_bf16 v[126:129], v[198:201], a[176:179], v[126:129]
    ds_read_b128 v[218:221], v1 offset:32896
    v_mul_f32 v167, 0x3baaaaab, v139
    v_mfma_f32_16x16x32_bf16 v[126:129], v[214:217], a[180:183], v[126:129]
    ds_read_b128 v[226:229], v0 offset:33024
    v_max3_u32 v45, v45, v210, v211
    v_mfma_f32_16x16x32_bf16 v[126:129], v[234:237], a[184:187], v[126:129]
    s_waitcnt lgkmcnt(4)
    v_rsq_f32 v213, v211
    v_mfma_f32_16x16x32_bf16 v[126:129], v[238:241], a[188:191], v[126:129]
    v_cvt_pk_f16_f32 v212, v212, v213
    v_pk_mul_f16 v170, v170, v212 op_sel:[0,1] op_sel_hi:[1,1]
    v_mfma_f32_16x16x32_bf16 v[242:245], v[130:133], a[192:195], 0
    ds_read_b128 v[130:133], v1 offset:33024
    v_pk_mul_f16 v171, v171, v212 op_sel:[0,1] op_sel_hi:[1,1]
    v_mfma_f32_16x16x32_bf16 v[242:245], v[134:137], a[196:199], v[242:245]
    v_rsq_f32 v167, v167
    v_mfma_f32_16x16x32_bf16 v[242:245], v[198:201], a[200:203], v[242:245]
    s_waitcnt lgkmcnt(4)
    buffer_store_dwordx4 v[142:145], v15, s[52:55], 0 offen nt
    v_cvt_pk_bf16_f32 v116, v126, v127
    v_cvt_pk_bf16_f32 v117, v128, v129
    v_mul_f32 v190, v167, v190
    v_mul_f32 v191, v167, v191
    v_mfma_f32_16x16x32_bf16 v[242:245], v[214:217], a[204:207], v[242:245]
    s_waitcnt lgkmcnt(2)
    v_cvt_pk_bf16_f32 v126, v190, v191
    v_mul_f32 v192, v167, v192
    v_mfma_f32_16x16x32_bf16 v[242:245], v[234:237], a[208:211], v[242:245]
    s_waitcnt lgkmcnt(1)
    v_mul_f32 v193, v167, v193
    v_cvt_pk_bf16_f32 v127, v192, v193
    v_mfma_f32_16x16x32_bf16 v[242:245], v[238:241], a[212:215], v[242:245]
    v_mul_f32 v146, v167, v146
    v_mul_f32 v147, v167, v147
    v_mfma_f32_16x16x32_bf16 v[134:137], a[72:75], v[202:205], 0
    v_cvt_pk_bf16_f32 v128, v146, v147
    v_mul_f32 v148, v167, v148
    v_mfma_f32_16x16x32_bf16 v[134:137], a[76:79], v[174:177], v[134:137]
    s_waitcnt lgkmcnt(0)
    v_mul_f32 v149, v167, v149
    v_cvt_pk_bf16_f32 v129, v148, v149
    v_mfma_f32_16x16x32_bf16 v[134:137], a[80:83], v[178:181], v[134:137]
    v_mul_f32 v150, v167, v150
    v_mul_f32 v151, v167, v151
    v_mfma_f32_16x16x32_bf16 v[134:137], a[84:87], v[218:221], v[134:137]
    v_cvt_pk_bf16_f32 v140, v150, v151
    v_mul_f32 v152, v167, v152
    v_mfma_f32_16x16x32_bf16 v[134:137], a[88:91], v[226:229], v[134:137]
    v_mul_f32 v153, v167, v153
    v_cvt_pk_bf16_f32 v141, v152, v153
    v_mfma_f32_16x16x32_bf16 v[134:137], a[92:95], v[130:133], v[134:137]
    v_cvt_pk_bf16_f32 v232, v242, v243
    v_cvt_pk_bf16_f32 v233, v244, v245
    v_mfma_f32_16x16x32_bf16 v[142:145], a[96:99], v[202:205], 0
    v_pk_mul_f16 v172, v172, v212 op_sel:[0,1] op_sel_hi:[1,1]
    v_pk_mul_f16 v173, v173, v212 op_sel:[0,1] op_sel_hi:[1,1]
    v_mfma_f32_16x16x32_bf16 v[142:145], a[100:103], v[174:177], v[142:145]
    v_pk_mul_f16 v160, v160, v212 op_sel:[0,1] op_sel_hi:[1,1]
    v_pk_mul_f16 v161, v161, v212 op_sel:[0,1] op_sel_hi:[1,1]
    v_mfma_f32_16x16x32_bf16 v[142:145], a[104:107], v[178:181], v[142:145]
    v_pk_mul_f16 v122, v122, v212 op_sel:[0,0] op_sel_hi:[1,0]
    v_pk_mul_f16 v123, v123, v212 op_sel:[0,0] op_sel_hi:[1,0]
    v_mfma_f32_16x16x32_bf16 v[142:145], a[108:111], v[218:221], v[142:145]
    v_pk_mul_f16 v124, v124, v212 op_sel:[0,0] op_sel_hi:[1,0]
    v_pk_mul_f16 v125, v125, v212 op_sel:[0,0] op_sel_hi:[1,0]
    v_mfma_f32_16x16x32_bf16 v[142:145], a[112:115], v[226:229], v[142:145]
    v_pk_mul_f16 v158, v158, v212 op_sel:[0,0] op_sel_hi:[1,0]
    v_pk_mul_f16 v159, v159, v212 op_sel:[0,0] op_sel_hi:[1,0]
    v_mfma_f32_16x16x32_bf16 v[142:145], a[116:119], v[130:133], v[142:145]
    v_mul_f32 v138, 0x3baaaaab, v138
    v_lshl_add_u32 v165, v154, 2, v165
    v_mfma_f32_16x16x32_bf16 v[146:149], a[120:123], v[202:205], 0
    buffer_store_dwordx2 v[168:169], v18, s[52:55], 0 offen nt
    v_rsq_f32 v138, v138
    v_mfma_f32_16x16x32_bf16 v[146:149], a[124:127], v[174:177], v[146:149]
    v_mul_f32 v222, v138, v222
    v_mul_f32 v223, v138, v223
    v_mfma_f32_16x16x32_bf16 v[146:149], a[128:131], v[178:181], v[146:149]
    v_cvt_pk_bf16_f32 v150, v222, v223
    v_mul_f32 v224, v138, v224
    v_mfma_f32_16x16x32_bf16 v[146:149], a[132:135], v[218:221], v[146:149]
    v_mul_f32 v225, v138, v225
    v_cvt_pk_bf16_f32 v151, v224, v225
    v_mfma_f32_16x16x32_bf16 v[146:149], a[136:139], v[226:229], v[146:149]
    v_mul_f32 v186, v138, v186
    v_mul_f32 v187, v138, v187
    v_mfma_f32_16x16x32_bf16 v[146:149], a[140:143], v[130:133], v[146:149]
    v_cvt_pk_bf16_f32 v152, v186, v187
    v_mul_f32 v188, v138, v188
    v_mfma_f32_16x16x32_bf16 v[190:193], a[0:3], v[202:205], 0
    v_mul_f32 v189, v138, v189
    v_cvt_pk_bf16_f32 v153, v188, v189
    v_mfma_f32_16x16x32_bf16 v[190:193], a[4:7], v[174:177], v[190:193]
    v_mul_f32 v246, v138, v246
    v_mul_f32 v247, v138, v247
    v_mfma_f32_16x16x32_bf16 v[190:193], a[8:11], v[178:181], v[190:193]
    v_cvt_pk_bf16_f32 v168, v246, v247
    v_mul_f32 v248, v138, v248
    v_mfma_f32_16x16x32_bf16 v[190:193], a[12:15], v[218:221], v[190:193]
    v_mul_f32 v249, v138, v249
    v_cvt_pk_bf16_f32 v169, v248, v249
    v_mfma_f32_16x16x32_bf16 v[190:193], a[16:19], v[226:229], v[190:193]
    v_lshl_add_u32 v167, v165, 4, s5
    v_lshl_add_u32 v138, v165, 3, s5
    v_mfma_f32_16x16x32_bf16 v[190:193], a[20:23], v[130:133], v[190:193]
    v_lshl_add_u32 v139, v254, 4, s5
    v_lshl_add_u32 v254, v254, 3, s5
    v_mfma_f32_16x16x32_bf16 v[186:189], a[24:27], v[202:205], 0
    v_lshlrev_b32 v165, 2, v165
    v_cvt_pk_f16_f32 v134, v134, v135
    v_mfma_f32_16x16x32_bf16 v[186:189], a[28:31], v[174:177], v[186:189]
    ds_permute_b32 v198, v165, v16
    ds_permute_b32 v199, v165, v19
    v_mfma_f32_16x16x32_bf16 v[186:189], a[32:35], v[178:181], v[186:189]
    ds_permute_b32 v200, v165, v17
    ds_permute_b32 v201, v165, v20
    v_mfma_f32_16x16x32_bf16 v[186:189], a[36:39], v[218:221], v[186:189]
    v_cvt_pk_f16_f32 v190, v190, v191
    v_pk_mul_f16 v210, v190, v190
    v_mfma_f32_16x16x32_bf16 v[186:189], a[40:43], v[226:229], v[186:189]
    buffer_store_dwordx4 v[126:129], v166, s[12:15], 0 offen nt
    v_cvt_pk_f16_f32 v191, v192, v193
    v_pk_mul_f16 v212, v191, v191
    v_pk_mul_f16 v211, v134, v134
    v_cvt_pk_f16_f32 v135, v136, v137
    v_mfma_f32_16x16x32_bf16 v[186:189], a[44:47], v[130:133], v[186:189]
    v_pk_mul_f16 v213, v135, v135
    v_cvt_pk_f16_f32 v136, v142, v143
    v_mfma_f32_16x16x32_bf16 v[126:129], a[48:51], v[202:205], 0
    v_pk_fma_f16 v211, v136, v136, v211
    v_cvt_pk_f16_f32 v137, v144, v145
    v_mfma_f32_16x16x32_bf16 v[126:129], a[52:55], v[174:177], v[126:129]
    v_pk_fma_f16 v213, v137, v137, v213
    v_cvt_pk_f16_f32 v144, v146, v147
    v_mfma_f32_16x16x32_bf16 v[126:129], a[56:59], v[178:181], v[126:129]
    s_waitcnt lgkmcnt(2)
    ds_read2_b32 v[216:217], v6 offset0:0 offset1:0
    ds_read2_b32 v[224:225], v6 offset0:16 offset1:16
    v_mfma_f32_16x16x32_bf16 v[126:129], a[60:63], v[218:221], v[126:129]
    s_waitcnt lgkmcnt(2)
    ds_read2_b32 v[236:237], v6 offset0:32 offset1:32
    v_cvt_pk_f16_f32 v192, v186, v187
    v_mfma_f32_16x16x32_bf16 v[126:129], a[64:67], v[226:229], v[126:129]
    v_pk_fma_f16 v210, v192, v192, v210
    v_cvt_pk_f16_f32 v193, v188, v189
    v_mfma_f32_16x16x32_bf16 v[126:129], a[68:71], v[130:133], v[126:129]
    v_pk_fma_f16 v212, v193, v193, v212
    v_pk_fma_f16 v211, v144, v144, v211
    v_mfma_f32_16x16x32_bf16 v[186:189], v[202:205], a[144:147], 0
    v_cvt_pk_f16_f32 v145, v148, v149
    v_pk_fma_f16 v213, v145, v145, v213
    v_mfma_f32_16x16x32_bf16 v[186:189], v[174:177], a[148:151], v[186:189]
    v_add_u32 v154, 16, v154
    v_mul_u32_u24 v165, s20, v154
    v_mfma_f32_16x16x32_bf16 v[186:189], v[178:181], a[152:155], v[186:189]
    v_cvt_pk_f16_f32 v142, v126, v127
    v_pk_fma_f16 v210, v142, v142, v210
    v_mfma_f32_16x16x32_bf16 v[186:189], v[218:221], a[156:159], v[186:189]
    v_cvt_pk_f16_f32 v143, v128, v129
    v_pk_fma_f16 v212, v143, v143, v212
    v_mfma_f32_16x16x32_bf16 v[186:189], v[226:229], a[160:163], v[186:189]
    s_waitcnt lgkmcnt(1)
    v_add_u32 v165, s38, v165
    v_mul_u32_u24 v165, 911, v165
    v_mfma_f32_16x16x32_f16 v[126:129], v[40:43], v[210:213], 0
    s_waitcnt lgkmcnt(0)
    v_lshrrev_b32 v165, 16, v165
    v_mul_u32_u24 v165, s22, v165
    v_mfma_f32_16x16x32_bf16 v[186:189], v[130:133], a[164:167], v[186:189]
    v_mad_u32_u24 v165, v154, s21, v165
    v_cmp_gt_u32 vcc, s17, v154
    v_mfma_f32_16x16x32_bf16 v[146:149], v[202:205], a[168:171], 0
    v_add_u32 v165, s7, v165
    v_min3_u32 v44, v44, v126, v127
    v_mfma_f32_16x16x32_bf16 v[146:149], v[174:177], a[172:175], v[146:149]
    buffer_store_dwordx2 v[140:141], v157, s[12:15], 0 offen nt
    v_rsq_f32 v128, v126
    v_mfma_f32_16x16x32_bf16 v[146:149], v[178:181], a[176:179], v[146:149]
    v_cvt_pk_bf16_f32 v214, v186, v187
    v_cvt_pk_bf16_f32 v215, v188, v189
    v_mfma_f32_16x16x32_bf16 v[146:149], v[218:221], a[180:183], v[146:149]
    v_rsq_f32 v129, v127
    v_mfma_f32_16x16x32_bf16 v[146:149], v[226:229], a[184:187], v[146:149]
    v_mul_f32 v128, s31, v128
    v_cvt_pk_f16_f32 v128, v128, v129
    v_mfma_f32_16x16x32_bf16 v[146:149], v[130:133], a[188:191], v[146:149]
    v_pk_mul_f16 v134, v134, v128 op_sel:[0,1] op_sel_hi:[1,1]
    v_pk_mul_f16 v135, v135, v128 op_sel:[0,1] op_sel_hi:[1,1]
    v_mfma_f32_16x16x32_bf16 v[186:189], v[202:205], a[192:195], 0
    v_pk_mul_f16 v136, v136, v128 op_sel:[0,1] op_sel_hi:[1,1]
    v_pk_mul_f16 v137, v137, v128 op_sel:[0,1] op_sel_hi:[1,1]
    v_mfma_f32_16x16x32_bf16 v[186:189], v[174:177], a[196:199], v[186:189]
    v_pk_mul_f16 v144, v144, v128 op_sel:[0,1] op_sel_hi:[1,1]
    v_pk_mul_f16 v145, v145, v128 op_sel:[0,1] op_sel_hi:[1,1]
    v_mfma_f32_16x16x32_bf16 v[186:189], v[178:181], a[200:203], v[186:189]
    v_cvt_pk_bf16_f32 v222, v146, v147
    v_cvt_pk_bf16_f32 v223, v148, v149
    v_mfma_f32_16x16x32_bf16 v[186:189], v[218:221], a[204:207], v[186:189]
    v_pk_mul_f16 v190, v190, v128 op_sel:[0,0] op_sel_hi:[1,0]
    v_pk_mul_f16 v191, v191, v128 op_sel:[0,0] op_sel_hi:[1,0]
    v_mfma_f32_16x16x32_bf16 v[186:189], v[226:229], a[208:211], v[186:189]
    ds_read_b128 v[146:149], v5 offset:0
    ds_read_b128 v[174:177], v5 offset:16
    v_mfma_f32_16x16x32_f16 v[178:181], v[118:121], v[206:209], v[46:49]
    ds_read_b128 v[202:205], v5 offset:48
    ds_read_b32 v166, v6 offset:192
    v_mfma_f32_16x16x32_f16 v[210:213], v[170:173], v[206:209], v[50:53]
    v_pk_mul_f16 v192, v192, v128 op_sel:[0,0] op_sel_hi:[1,0]
    v_pk_mul_f16 v193, v193, v128 op_sel:[0,0] op_sel_hi:[1,0]
    v_mfma_f32_16x16x32_f16 v[218:221], v[134:137], v[206:209], v[54:57]
    v_pk_mul_f16 v142, v142, v128 op_sel:[0,0] op_sel_hi:[1,0]
    v_pk_mul_f16 v143, v143, v128 op_sel:[0,0] op_sel_hi:[1,0]
    v_max3_u32 v45, v45, v126, v127
    v_mfma_f32_16x16x16_f16 v[178:181], v[196:197], v[194:195], v[178:181]
    v_subrev_u32 v140, 0x3d800000, v44
    v_sub_u32 v141, 0x4a000000, v45
    v_or3_b32 v140, v140, v141, v45
    v_mfma_f32_16x16x16_f16 v[210:213], v[160:161], v[194:195], v[210:213]
    v_lshl_add_u32 v141, s16, 2, v164
    v_cndmask_b32 v165, v156, v165, vcc
    v_lshl_add_u32 v154, v255, 4, v165
    v_mfma_f32_16x16x16_f16 v[218:221], v[144:145], v[194:195], v[218:221]
    v_add_u32 v154, s3, v154
    v_lshl_add_u32 v255, v255, 3, v165
    v_exp_f32 v178, v178
    v_mfma_f32_16x16x32_bf16 v[186:189], v[130:133], a[212:215], v[186:189]
    s_waitcnt lgkmcnt(2)
    buffer_store_dwordx4 v[150:153], v17, s[52:55], 0 offen nt
    ds_write_b32 v141, v140 offset:18432
    v_exp_f32 v179, v179
    v_mfma_f32_16x16x32_f16 v[126:129], v[146:149], v[206:209], v[22:25]
    s_waitcnt lgkmcnt(1)
    v_add_u32 v255, s4, v255
    v_cvt_pk_bf16_f32 v130, v178, v179
    v_mfma_f32_16x16x32_f16 v[126:129], v[174:177], v[118:121], v[126:129]
    v_cvt_pk_bf16_f32 v234, v186, v187
    v_cvt_pk_bf16_f32 v235, v188, v189
    v_mfma_f32_16x16x32_f16 v[126:129], v[202:205], v[194:197], v[126:129]
    v_exp_f32 v180, v180
    v_mfma_f32_16x16x32_f16 v[150:153], v[146:149], v[122:125], v[24:27]
    v_exp_f32 v181, v181
    v_mfma_f32_16x16x32_f16 v[150:153], v[174:177], v[170:173], v[150:153]
    v_exp_f32 v210, v210
    v_mfma_f32_16x16x32_f16 v[150:153], v[202:205], v[158:161], v[150:153]
    v_exp_f32 v211, v211
    v_mfma_f32_16x16x32_f16 v[186:189], v[146:149], v[190:193], v[26:29]
    v_mov_b32_dpp v166, v127 quad_perm:[0,1,2,3] row_mask:0x1 bank_mask:0xf
    v_cvt_pk_bf16_f32 v131, v180, v181
    v_mfma_f32_16x16x32_f16 v[186:189], v[174:177], v[134:137], v[186:189]
    v_exp_f32 v212, v212
    v_mfma_f32_16x16x32_f16 v[186:189], v[202:205], v[142:145], v[186:189]
    v_cvt_pk_bf16_f32 v132, v210, v211
    v_mov_b32_dpp v166, v151 quad_perm:[0,1,2,3] row_mask:0x2 bank_mask:0xf
    v_exp_f32 v213, v213
    v_exp_f32 v218, v218
    v_cvt_pk_bf16_f32 v133, v212, v213
    v_exp_f32 v219, v219
    v_mfma_f32_16x16x32_f16 v[146:149], v[118:121], v[122:125], v[58:61]
    v_exp_f32 v220, v220
    v_mfma_f32_16x16x32_f16 v[174:177], v[170:173], v[122:125], v[62:65]
    v_mov_b32_dpp v166, v187 quad_perm:[0,1,2,3] row_mask:0x4 bank_mask:0xf
    v_cvt_pk_bf16_f32 v36, v218, v219
    v_mfma_f32_16x16x32_f16 v[178:181], v[134:137], v[122:125], v[66:69]
    v_exp_f32 v166, v166
    v_mfma_f32_16x16x16_f16 v[146:149], v[196:197], v[158:159], v[146:149]
    buffer_store_dwordx2 v[168:169], v20, s[52:55], 0 offen nt
    v_exp_f32 v221, v221
    v_mfma_f32_16x16x16_f16 v[174:177], v[160:161], v[158:159], v[174:177]
    v_cvt_pk_bf16_f32 v166, v166, v166
    v_exp_f32 v126, v126
    v_mfma_f32_16x16x16_f16 v[178:181], v[144:145], v[158:159], v[178:181]
    ds_write_b16 v8, v166
    v_cvt_pk_bf16_f32 v37, v220, v221
    v_cvt_pk_bf16_f32 v39, v126, 0
    v_exp_f32 v146, v146
    v_mfma_f32_16x16x32_f16 v[122:125], v[118:121], v[190:193], v[70:73]
    v_exp_f32 v147, v147
    v_mfma_f32_16x16x32_bf16 v[118:121], v[28:31], v[36:39], 0
    v_exp_f32 v148, v148
    v_mfma_f32_16x16x32_bf16 v[118:121], v[28:31], v[130:133], v[118:121]
    v_exp_f32 v149, v149
    v_mfma_f32_16x16x32_bf16 v[126:129], v[214:217], v[36:39], 0
    v_cvt_pk_bf16_f32 v146, v146, v147
    v_cvt_pk_bf16_f32 v147, v148, v149
    v_mfma_f32_16x16x32_bf16 v[126:129], v[182:185], v[130:133], v[126:129]
    v_exp_f32 v174, v174
    v_mfma_f32_16x16x32_bf16 v[202:205], v[222:225], v[36:39], 0
    v_exp_f32 v175, v175
    v_mfma_f32_16x16x32_bf16 v[202:205], v[114:117], v[130:133], v[202:205]
    v_rcp_f32 v118, v118
    v_mfma_f32_16x16x32_bf16 v[206:209], v[234:237], v[36:39], 0
    v_exp_f32 v176, v176
    v_mfma_f32_16x16x32_bf16 v[206:209], v[230:233], v[130:133], v[206:209]
    v_mul_f32 v126, v118, v126
    v_mul_f32 v127, v118, v127
    v_mfma_f32_16x16x32_f16 v[130:133], v[170:173], v[190:193], v[74:77]
    v_cvt_pk_bf16_f32 v126, v126, v127
    v_mul_f32 v128, v118, v128
    v_mfma_f32_16x16x32_f16 v[170:173], v[134:137], v[190:193], v[78:81]
    v_mul_f32 v129, v118, v129
    v_cvt_pk_bf16_f32 v127, v128, v129
    v_mul_f32 v202, v118, v202
    v_mfma_f32_16x16x16_f16 v[122:125], v[196:197], v[142:143], v[122:125]
    v_mul_f32 v203, v118, v203
    v_cvt_pk_bf16_f32 v128, v202, v203
    v_mul_f32 v204, v118, v204
    v_mfma_f32_16x16x16_f16 v[130:133], v[160:161], v[142:143], v[130:133]
    v_mul_f32 v205, v118, v205
    v_cvt_pk_bf16_f32 v129, v204, v205
    v_mul_f32 v206, v118, v206
    v_mfma_f32_16x16x16_f16 v[170:173], v[144:145], v[142:143], v[170:173]
    ds_write_b128 v3, v[126:129] offset:0
    v_mul_f32 v207, v118, v207
    v_cvt_pk_bf16_f32 v140, v206, v207
    v_mul_f32 v208, v118, v208
    v_mul_f32 v209, v118, v209
    v_cvt_pk_bf16_f32 v141, v208, v209
    v_cvt_pk_bf16_f32 v148, v174, v175
    v_exp_f32 v177, v177
    ds_write_b64 v4, v[140:141] offset:4096
    v_cvt_pk_bf16_f32 v149, v176, v177
    v_exp_f32 v178, v178
    v_exp_f32 v179, v179
    v_exp_f32 v180, v180
    v_cvt_pk_bf16_f32 v36, v178, v179
    v_exp_f32 v181, v181
    v_exp_f32 v150, v150
    v_cvt_pk_bf16_f32 v37, v180, v181
    v_cvt_pk_bf16_f32 v39, v150, 0
    v_exp_f32 v122, v122
    v_exp_f32 v123, v123
    v_mfma_f32_16x16x32_bf16 v[118:121], v[28:31], v[36:39], 0
    v_exp_f32 v124, v124
    v_mfma_f32_16x16x32_bf16 v[118:121], v[28:31], v[146:149], v[118:121]
    v_exp_f32 v125, v125
    v_mfma_f32_16x16x32_bf16 v[126:129], v[214:217], v[36:39], 0
    s_waitcnt lgkmcnt(0)
    ds_read_b128 v[134:137], v9
    ds_read_b128 v[142:145], v9 offset:64
    v_mfma_f32_16x16x32_bf16 v[126:129], v[182:185], v[146:149], v[126:129]
    s_barrier
    ds_read_b128 v[150:153], v164 offset:0
    ds_read_b128 v[158:161], v164 offset:1024
    v_mfma_f32_16x16x32_bf16 v[174:177], v[222:225], v[36:39], 0
    v_cvt_pk_bf16_f32 v122, v122, v123
    v_cvt_pk_bf16_f32 v123, v124, v125
    v_mfma_f32_16x16x32_bf16 v[174:177], v[114:117], v[146:149], v[174:177]
    ds_read_b128 v[178:181], v164 offset:2048
    ds_read_b128 v[190:193], v164 offset:3072
    v_mfma_f32_16x16x32_bf16 v[194:197], v[234:237], v[36:39], 0
    v_exp_f32 v130, v130
    v_mfma_f32_16x16x32_bf16 v[194:197], v[230:233], v[146:149], v[194:197]
    ds_read_b128 v[146:149], v164 offset:4096
    ds_read_b128 v[202:205], v164 offset:5120
    v_exp_f32 v131, v131
    v_exp_f32 v132, v132
    v_cvt_pk_bf16_f32 v124, v130, v131
    v_exp_f32 v133, v133
    s_waitcnt lgkmcnt(6)
    v_mfma_f32_16x16x32_bf16 v[206:209], v[134:137], v[28:31], 0
    v_exp_f32 v170, v170
    v_mfma_f32_16x16x32_bf16 v[206:209], v[142:145], v[28:31], v[206:209]
    s_waitcnt lgkmcnt(4)
    v_exp_f32 v171, v171
    v_mfma_f32_16x16x32_bf16 v[210:213], a[216:219], v[150:153], 0
    v_cvt_pk_bf16_f32 v125, v132, v133
    v_cvt_pk_bf16_f32 v36, v170, v171
    v_mfma_f32_16x16x32_bf16 v[210:213], a[220:223], v[158:161], v[210:213]
    s_waitcnt lgkmcnt(2)
    v_exp_f32 v172, v172
    v_mfma_f32_16x16x32_bf16 v[210:213], a[224:227], v[178:181], v[210:213]
    v_exp_f32 v173, v173
    v_mfma_f32_16x16x32_bf16 v[210:213], a[228:231], v[190:193], v[210:213]
    s_waitcnt lgkmcnt(0)
    v_exp_f32 v186, v186
    v_mfma_f32_16x16x32_bf16 v[210:213], a[232:235], v[146:149], v[210:213]
    v_cvt_pk_bf16_f32 v37, v172, v173
    v_cvt_pk_bf16_f32 v39, v186, 0
    v_mfma_f32_16x16x32_bf16 v[210:213], a[236:239], v[202:205], v[210:213]
    v_rcp_f32 v118, v118
    v_mfma_f32_16x16x32_bf16 v[130:133], a[240:243], v[150:153], 0
    v_mul_f32 v126, v118, v126
    v_mul_f32 v127, v118, v127
    v_mfma_f32_16x16x32_bf16 v[130:133], a[244:247], v[158:161], v[130:133]
    v_cvt_pk_bf16_f32 v126, v126, v127
    v_mul_f32 v128, v118, v128
    v_mfma_f32_16x16x32_bf16 v[130:133], a[248:251], v[178:181], v[130:133]
    v_fma_f32 v165, v210, v210, s33
    v_fmac_f32 v165, v211, v211
    v_mfma_f32_16x16x32_bf16 v[130:133], a[252:255], v[190:193], v[130:133]
    v_fmac_f32 v165, v212, v212
    v_fmac_f32 v165, v213, v213
    v_mfma_f32_16x16x32_bf16 v[130:133], v[82:85], v[146:149], v[130:133]
    v_mul_f32 v129, v118, v129
    v_cvt_pk_bf16_f32 v127, v128, v129
    v_mfma_f32_16x16x32_bf16 v[130:133], v[86:89], v[202:205], v[130:133]
    v_mul_f32 v174, v118, v174
    v_mul_f32 v175, v118, v175
    v_mfma_f32_16x16x32_bf16 v[170:173], v[90:93], v[150:153], 0
    v_cvt_pk_bf16_f32 v128, v174, v175
    v_mul_f32 v176, v118, v176
    v_mfma_f32_16x16x32_bf16 v[170:173], v[94:97], v[158:161], v[170:173]
    v_mul_f32 v177, v118, v177
    v_cvt_pk_bf16_f32 v129, v176, v177
    v_mfma_f32_16x16x32_bf16 v[170:173], v[98:101], v[178:181], v[170:173]
    ds_write_b128 v3, v[126:129] offset:6144
    v_mfma_f32_16x16x32_bf16 v[170:173], v[102:105], v[190:193], v[170:173]
    v_fmac_f32 v165, v130, v130
    v_fmac_f32 v165, v131, v131
    v_mfma_f32_16x16x32_bf16 v[170:173], v[106:109], v[146:149], v[170:173]
    v_fmac_f32 v165, v132, v132
    v_fmac_f32 v165, v133, v133
    v_mfma_f32_16x16x32_bf16 v[170:173], v[110:113], v[202:205], v[170:173]
    v_mul_f32 v194, v118, v194
    v_mul_f32 v195, v118, v195
    v_mfma_f32_16x16x32_bf16 v[126:129], v[134:137], v[182:185], 0
    v_cvt_pk_bf16_f32 v140, v194, v195
    v_mul_f32 v196, v118, v196
    v_mfma_f32_16x16x32_bf16 v[126:129], v[142:145], v[214:217], v[126:129]
    v_mul_f32 v197, v118, v197
    v_cvt_pk_bf16_f32 v141, v196, v197
    v_mfma_f32_16x16x32_bf16 v[118:121], v[134:137], v[114:117], 0
    ds_write_b64 v4, v[140:141] offset:10240
    v_mfma_f32_16x16x32_bf16 v[118:121], v[142:145], v[222:225], v[118:121]
    v_rcp_f32 v206, v206
    v_mfma_f32_16x16x32_bf16 v[146:149], v[134:137], v[230:233], 0
    v_fmac_f32 v165, v170, v170
    v_fmac_f32 v165, v171, v171
    v_mfma_f32_16x16x32_bf16 v[146:149], v[142:145], v[234:237], v[146:149]
    v_fmac_f32 v165, v172, v172
    v_fmac_f32 v165, v173, v173
    v_mfma_f32_16x16x32_bf16 v[134:137], v[28:31], v[36:39], 0
    v_cvt_pk_bf16_f32 v140, v165, v165
    v_cvt_pk_bf16_f32 v141, v165, v165
    v_mfma_f32_16x16x32_bf16 v[134:137], v[28:31], v[122:125], v[134:137]
    ds_write_b64 v163, v[140:141] offset:4096
    v_mfma_f32_16x16x32_bf16 v[142:145], v[214:217], v[36:39], 0
    v_mul_f32 v126, v126, v206
    v_mul_f32_dpp v126, v118, v206 quad_perm:[0,1,2,3] row_mask:0x2 bank_mask:0xf
    v_mfma_f32_16x16x32_bf16 v[142:145], v[182:185], v[122:125], v[142:145]
    v_mul_f32_dpp v126, v146, v206 quad_perm:[0,1,2,3] row_mask:0x4 bank_mask:0xf
    v_cvt_pk_bf16_f32 v126, v126, v126
    v_mfma_f32_16x16x32_bf16 v[118:121], v[222:225], v[36:39], 0
    ds_write_b16 v7, v126
    v_mfma_f32_16x16x32_bf16 v[118:121], v[114:117], v[122:125], v[118:121]
    v_rcp_f32 v134, v134
    v_mfma_f32_16x16x32_bf16 v[114:117], v[234:237], v[36:39], 0
    v_mfma_f32_16x16x32_bf16 v[114:117], v[230:233], v[122:125], v[114:117]
    v_mul_f32 v142, v134, v142
    v_mul_f32 v143, v134, v143
    v_cvt_pk_bf16_f32 v122, v142, v143
    v_mul_f32 v144, v134, v144
    v_mul_f32 v145, v134, v145
    v_cvt_pk_bf16_f32 v123, v144, v145
    v_mul_f32 v118, v134, v118
    v_mul_f32 v119, v134, v119
    v_cvt_pk_bf16_f32 v124, v118, v119
    v_mul_f32 v120, v134, v120
    v_mul_f32 v121, v134, v121
    v_cvt_pk_bf16_f32 v125, v120, v121
    ds_write_b128 v3, v[122:125] offset:12288
    s_waitcnt lgkmcnt(1)
    s_barrier
    v_mul_f32 v114, v134, v114
    v_mul_f32 v115, v134, v115
    v_cvt_pk_bf16_f32 v140, v114, v115
    v_mul_f32 v116, v134, v116
    v_mul_f32 v117, v134, v117
    ds_read_b128 v[118:121], v162 offset:4096
    ds_read_b128 v[122:125], v162 offset:5120
    ds_read_b128 v[126:129], v164 offset:6144
    ds_read_b128 v[134:137], v164 offset:7168
    ds_read_b128 v[142:145], v164 offset:8192
    ds_read_b128 v[146:149], v164 offset:9216
    ds_read_b128 v[150:153], v164 offset:10240
    ds_read_b128 v[158:161], v164 offset:11264
    v_cvt_pk_bf16_f32 v141, v116, v117
    ds_write_b64 v4, v[140:141] offset:16384
    s_waitcnt lgkmcnt(8)
    v_mfma_f32_16x16x32_bf16 v[114:117], v[32:35], v[118:121], 0
    s_waitcnt lgkmcnt(6)
    v_mfma_f32_16x16x32_bf16 v[114:117], v[32:35], v[122:125], v[114:117]
    s_waitcnt lgkmcnt(5)
    v_mfma_f32_16x16x32_bf16 v[118:121], a[216:219], v[126:129], 0
    s_waitcnt lgkmcnt(4)
    v_mfma_f32_16x16x32_bf16 v[118:121], a[220:223], v[134:137], v[118:121]
    s_waitcnt lgkmcnt(3)
    v_mfma_f32_16x16x32_bf16 v[118:121], a[224:227], v[142:145], v[118:121]
    s_waitcnt lgkmcnt(2)
    v_mfma_f32_16x16x32_bf16 v[118:121], a[228:231], v[146:149], v[118:121]
    s_waitcnt lgkmcnt(1)
    v_mul_f32 v165, 0x3baaaaab, v114
    v_mfma_f32_16x16x32_bf16 v[118:121], a[232:235], v[150:153], v[118:121]
    v_rsq_f32 v165, v165
    v_mfma_f32_16x16x32_bf16 v[118:121], a[236:239], v[158:161], v[118:121]
    v_mul_f32 v210, v165, v210
    v_mul_f32 v211, v165, v211
    v_mfma_f32_16x16x32_bf16 v[114:117], a[240:243], v[126:129], 0
    v_cvt_pk_bf16_f32 v122, v210, v211
    v_mul_f32 v212, v165, v212
    v_mfma_f32_16x16x32_bf16 v[114:117], a[244:247], v[134:137], v[114:117]
    v_mul_f32 v213, v165, v213
    v_cvt_pk_bf16_f32 v123, v212, v213
    v_mfma_f32_16x16x32_bf16 v[114:117], a[248:251], v[142:145], v[114:117]
    v_mul_f32 v130, v165, v130
    v_mul_f32 v131, v165, v131
    v_mfma_f32_16x16x32_bf16 v[114:117], a[252:255], v[146:149], v[114:117]
    v_cvt_pk_bf16_f32 v124, v130, v131
    v_mul_f32 v132, v165, v132
    v_mfma_f32_16x16x32_bf16 v[114:117], v[82:85], v[150:153], v[114:117]
    v_mul_f32 v133, v165, v133
    v_cvt_pk_bf16_f32 v125, v132, v133
    v_mfma_f32_16x16x32_bf16 v[114:117], v[86:89], v[158:161], v[114:117]
    buffer_store_dwordx4 v[122:125], v15, s[56:59], 0 offen nt
    v_mul_f32 v170, v165, v170
    v_mul_f32 v171, v165, v171
    v_cvt_pk_bf16_f32 v140, v170, v171
    v_mul_f32 v172, v165, v172
    v_mfma_f32_16x16x32_bf16 v[122:125], v[90:93], v[126:129], 0
    ds_read_b128 v[126:129], v155 offset:256
    v_mul_f32 v173, v165, v173
    v_mfma_f32_16x16x32_bf16 v[122:125], v[94:97], v[134:137], v[122:125]
    ds_read_b128 v[130:133], v155 offset:2304
    v_cvt_pk_bf16_f32 v141, v172, v173
    v_mfma_f32_16x16x32_bf16 v[122:125], v[98:101], v[142:145], v[122:125]
    ds_read_b128 v[134:137], v155 offset:4352
    v_fma_f32 v165, v118, v118, s33
    v_mfma_f32_16x16x32_bf16 v[122:125], v[102:105], v[146:149], v[122:125]
    ds_read_b128 v[142:145], v155 offset:6400
    v_fmac_f32 v165, v119, v119
    v_mfma_f32_16x16x32_bf16 v[122:125], v[106:109], v[150:153], v[122:125]
    ds_read_b128 v[146:149], v155 offset:8448
    v_fmac_f32 v165, v120, v120
    v_mfma_f32_16x16x32_bf16 v[122:125], v[110:113], v[158:161], v[122:125]
    ds_read_b128 v[150:153], v155 offset:10496
    v_fmac_f32 v165, v121, v121
    v_fmac_f32 v165, v114, v114
    v_fmac_f32 v165, v115, v115
    v_fmac_f32 v165, v116, v116
    v_fmac_f32 v165, v117, v117
    s_nop 0
    s_nop 0
    s_waitcnt lgkmcnt(5)
    v_mfma_f32_16x16x32_bf16 v[158:161], a[216:219], v[126:129], 0
    v_fmac_f32 v165, v122, v122
    v_fmac_f32 v165, v123, v123
    v_mfma_f32_16x16x32_bf16 v[170:173], a[240:243], v[126:129], 0
    s_waitcnt lgkmcnt(4)
    v_fmac_f32 v165, v124, v124
    v_fmac_f32 v165, v125, v125
    v_mfma_f32_16x16x32_bf16 v[158:161], a[220:223], v[130:133], v[158:161]
    s_waitcnt lgkmcnt(3)
    v_cvt_pk_bf16_f32 v156, v165, v165
    v_cvt_pk_bf16_f32 v157, v165, v165
    v_mfma_f32_16x16x32_bf16 v[158:161], a[224:227], v[134:137], v[158:161]
    s_waitcnt lgkmcnt(2)
    ds_write_b64 v163, v[156:157] offset:6144
    v_mfma_f32_16x16x32_bf16 v[158:161], a[228:231], v[142:145], v[158:161]
    s_waitcnt lgkmcnt(2)
    v_mfma_f32_16x16x32_bf16 v[158:161], a[232:235], v[146:149], v[158:161]
    s_waitcnt lgkmcnt(1)
    v_mfma_f32_16x16x32_bf16 v[158:161], a[236:239], v[150:153], v[158:161]
    v_mfma_f32_16x16x32_bf16 v[170:173], a[244:247], v[130:133], v[170:173]
    buffer_store_dwordx2 v[140:141], v18, s[56:59], 0 offen nt
    v_mfma_f32_16x16x32_bf16 v[170:173], a[248:251], v[134:137], v[170:173]
    v_mfma_f32_16x16x32_bf16 v[170:173], a[252:255], v[142:145], v[170:173]
    v_mfma_f32_16x16x32_bf16 v[170:173], v[82:85], v[146:149], v[170:173]
    s_waitcnt lgkmcnt(0)
    v_mfma_f32_16x16x32_bf16 v[170:173], v[86:89], v[150:153], v[170:173]
    s_barrier
    ds_read_b128 v[174:177], v162 offset:6144
    ds_read_b128 v[178:181], v162 offset:7168
    v_mfma_f32_16x16x32_bf16 v[182:185], v[90:93], v[126:129], 0
    ds_read_b128 v[126:129], v164 offset:12288
    v_fma_f32 v165, v158, v158, s33
    v_mfma_f32_16x16x32_bf16 v[182:185], v[94:97], v[130:133], v[182:185]
    ds_read_b128 v[130:133], v164 offset:13312
    v_fmac_f32 v165, v159, v159
    v_mfma_f32_16x16x32_bf16 v[182:185], v[98:101], v[134:137], v[182:185]
    ds_read_b128 v[134:137], v164 offset:14336
    v_fmac_f32 v165, v160, v160
    v_mfma_f32_16x16x32_bf16 v[182:185], v[102:105], v[142:145], v[182:185]
    ds_read_b128 v[142:145], v164 offset:15360
    v_fmac_f32 v165, v161, v161
    v_mfma_f32_16x16x32_bf16 v[182:185], v[106:109], v[146:149], v[182:185]
    ds_read_b128 v[146:149], v164 offset:16384
    v_fmac_f32 v165, v170, v170
    v_mfma_f32_16x16x32_bf16 v[182:185], v[110:113], v[150:153], v[182:185]
    ds_read_b128 v[150:153], v164 offset:17408
    v_fmac_f32 v165, v171, v171
    v_fmac_f32 v165, v172, v172
    v_fmac_f32 v165, v173, v173
    s_waitcnt lgkmcnt(7)
    v_mfma_f32_16x16x32_bf16 v[186:189], v[32:35], v[174:177], 0
    s_waitcnt lgkmcnt(6)
    v_mfma_f32_16x16x32_bf16 v[186:189], v[32:35], v[178:181], v[186:189]
    s_waitcnt lgkmcnt(5)
    v_fmac_f32 v165, v182, v182
    v_fmac_f32 v165, v183, v183
    v_mfma_f32_16x16x32_bf16 v[174:177], a[216:219], v[126:129], 0
    s_waitcnt lgkmcnt(4)
    v_fmac_f32 v165, v184, v184
    v_fmac_f32 v165, v185, v185
    v_mfma_f32_16x16x32_bf16 v[174:177], a[220:223], v[130:133], v[174:177]
    s_waitcnt lgkmcnt(3)
    v_cvt_pk_bf16_f32 v140, v165, v165
    v_cvt_pk_bf16_f32 v141, v165, v165
    v_mfma_f32_16x16x32_bf16 v[174:177], a[224:227], v[134:137], v[174:177]
    s_waitcnt lgkmcnt(2)
    ds_write_b64 v163, v[140:141] offset:8192
    v_mfma_f32_16x16x32_bf16 v[174:177], a[228:231], v[142:145], v[174:177]
    s_waitcnt lgkmcnt(2)
    v_mul_f32 v165, 0x3baaaaab, v186
    v_mfma_f32_16x16x32_bf16 v[174:177], a[232:235], v[146:149], v[174:177]
    s_waitcnt lgkmcnt(1)
    v_rsq_f32 v165, v165
    v_mfma_f32_16x16x32_bf16 v[174:177], a[236:239], v[150:153], v[174:177]
    v_mul_f32 v118, v165, v118
    v_mul_f32 v119, v165, v119
    v_mfma_f32_16x16x32_bf16 v[178:181], a[240:243], v[126:129], 0
    v_cvt_pk_bf16_f32 v118, v118, v119
    v_mul_f32 v120, v165, v120
    v_mfma_f32_16x16x32_bf16 v[178:181], a[244:247], v[130:133], v[178:181]
    v_mul_f32 v121, v165, v121
    v_cvt_pk_bf16_f32 v119, v120, v121
    v_mfma_f32_16x16x32_bf16 v[178:181], a[248:251], v[134:137], v[178:181]
    v_fma_f32 v140, v174, v174, s33
    v_fmac_f32 v140, v175, v175
    v_mfma_f32_16x16x32_bf16 v[178:181], a[252:255], v[142:145], v[178:181]
    s_waitcnt lgkmcnt(0)
    v_fmac_f32 v140, v176, v176
    v_fmac_f32 v140, v177, v177
    v_mfma_f32_16x16x32_bf16 v[178:181], v[82:85], v[146:149], v[178:181]
    s_barrier
    ds_read_b128 v[186:189], v162 offset:8192
    ds_read_b128 v[190:193], v162 offset:9216
    v_mfma_f32_16x16x32_bf16 v[178:181], v[86:89], v[150:153], v[178:181]
    v_mul_f32 v114, v165, v114
    v_mul_f32 v115, v165, v115
    v_mfma_f32_16x16x32_bf16 v[194:197], v[90:93], v[126:129], 0
    v_cvt_pk_bf16_f32 v120, v114, v115
    v_mul_f32 v116, v165, v116
    v_mfma_f32_16x16x32_bf16 v[194:197], v[94:97], v[130:133], v[194:197]
    v_mul_f32 v117, v165, v117
    v_cvt_pk_bf16_f32 v121, v116, v117
    v_mfma_f32_16x16x32_bf16 v[194:197], v[98:101], v[134:137], v[194:197]
    ds_write_b128 v167, v[118:121] offset:1536
    v_mfma_f32_16x16x32_bf16 v[194:197], v[102:105], v[142:145], v[194:197]
    v_fmac_f32 v140, v178, v178
    v_fmac_f32 v140, v179, v179
    v_mfma_f32_16x16x32_bf16 v[194:197], v[106:109], v[146:149], v[194:197]
    v_fmac_f32 v140, v180, v180
    v_fmac_f32 v140, v181, v181
    v_mfma_f32_16x16x32_bf16 v[194:197], v[110:113], v[150:153], v[194:197]
    s_waitcnt lgkmcnt(1)
    ds_read_b128 v[114:117], v139 offset:1536
    v_mul_f32 v122, v165, v122
    v_mfma_f32_16x16x32_bf16 v[118:121], v[32:35], v[186:189], 0
    v_mul_f32 v123, v165, v123
    v_cvt_pk_bf16_f32 v122, v122, v123
    v_mfma_f32_16x16x32_bf16 v[118:121], v[32:35], v[190:193], v[118:121]
    v_mul_f32 v124, v165, v124
    v_fmac_f32 v140, v194, v194
    v_fmac_f32 v140, v195, v195
    v_fmac_f32 v140, v196, v196
    v_fmac_f32 v140, v197, v197
    v_cvt_pk_bf16_f32 v156, v140, v140
    v_cvt_pk_bf16_f32 v157, v140, v140
    ds_write_b64 v163, v[156:157] offset:0
    v_mul_f32 v123, 0x3baaaaab, v118
    v_rsq_f32 v123, v123
    v_mul_f32 v125, v165, v125
    v_mul_f32 v158, v123, v158
    v_mul_f32 v159, v123, v159
    v_cvt_pk_bf16_f32 v118, v158, v159
    v_mul_f32 v160, v123, v160
    s_waitcnt lgkmcnt(1)
    v_mul_f32 v161, v123, v161
    v_cvt_pk_bf16_f32 v119, v160, v161
    v_mul_f32 v170, v123, v170
    v_mul_f32 v171, v123, v171
    v_cvt_pk_bf16_f32 v120, v170, v171
    v_mul_f32 v172, v123, v172
    v_mul_f32 v173, v123, v173
    v_cvt_pk_bf16_f32 v121, v172, v173
    buffer_store_dwordx4 v[118:121], v154, s[12:15], 0 offen nt
    v_mul_f32 v182, v123, v182
    v_mul_f32 v183, v123, v183
    v_cvt_pk_bf16_f32 v140, v182, v183
    v_mul_f32 v184, v123, v184
    v_mul_f32 v185, v123, v185
    s_waitcnt lgkmcnt(0)
    s_barrier
    ds_read_b128 v[118:121], v162 offset:0
    ds_read_b128 v[126:129], v162 offset:1024
    ds_read_b128 v[130:133], v164 offset:18432
    v_cvt_pk_bf16_f32 v141, v184, v185
    v_cvt_pk_bf16_f32 v123, v124, v125
    ds_write_b64 v138, v[122:123] offset:2560
    buffer_store_dwordx2 v[140:141], v255, s[12:15], 0 offen nt
    ds_read_b64 v[168:169], v254 offset:2560
    s_waitcnt lgkmcnt(4)
    v_mfma_f32_16x16x32_bf16 v[122:125], v[32:35], v[118:121], 0
    s_waitcnt lgkmcnt(3)
    v_mfma_f32_16x16x32_bf16 v[122:125], v[32:35], v[126:129], v[122:125]
    s_waitcnt lgkmcnt(2)
    v_or3_b32 v130, v130, v131, v132
    v_or_b32 v130, v130, v133
    v_cmp_gt_i32 s[46:47], 0, v130
    s_nop 0
    s_nop 0
    s_nop 0
    s_nop 0
    v_mul_f32 v255, 0x3baaaaab, v122
    v_rsq_f32 v255, v255
    s_nop 0
    v_mul_f32 v174, v255, v174
    buffer_store_dwordx4 v[114:117], v198, s[56:59], 0 offen nt
    s_waitcnt lgkmcnt(0)
    v_mul_f32 v175, v255, v175
    v_cvt_pk_bf16_f32 v114, v174, v175
    v_mul_f32 v176, v255, v176
    v_mul_f32 v177, v255, v177
    v_cvt_pk_bf16_f32 v115, v176, v177
    v_mul_f32 v178, v255, v178
    v_mul_f32 v179, v255, v179
    v_cvt_pk_bf16_f32 v116, v178, v179
    v_mul_f32 v180, v255, v180
    v_mul_f32 v181, v255, v181
    v_cvt_pk_bf16_f32 v117, v180, v181
    ds_write_b128 v167, v[114:117] offset:3072
    buffer_store_dwordx2 v[168:169], v199, s[56:59], 0 offen nt
    v_mul_f32 v194, v255, v194
    v_mul_f32 v195, v255, v195
    v_cvt_pk_bf16_f32 v198, v194, v195
    v_mul_f32 v196, v255, v196
    v_mul_f32 v197, v255, v197
    v_cvt_pk_bf16_f32 v199, v196, v197
    ds_read_b128 v[114:117], v139 offset:3072
    ds_write_b64 v138, v[198:199] offset:4096
    ds_read_b64 v[198:199], v254 offset:4096
    s_waitcnt lgkmcnt(2)
    buffer_store_dwordx4 v[114:117], v200, s[56:59], 0 offen nt
    s_waitcnt lgkmcnt(0)
    buffer_store_dwordx2 v[198:199], v201, s[56:59], 0 offen nt
L_end:
    s_nop 1
    s_cmp_lg_u64 s[46:47], 0
    s_cbranch_scc1 L_rerun
L_done:
    s_endpgm
L_slow:
    s_mov_b32 s44, 0xff
    s_branch L_redo
L_rerun:
    s_mov_b32 s44, 0x7f000000
L_redo:
    s_waitcnt vmcnt(0) lgkmcnt(0)
    s_barrier
    v_mbcnt_lo_u32_b32 v0, -1, 0
    v_mbcnt_hi_u32_b32 v0, -1, v0
    v_lshl_add_u32 v0, s16, 6, v0
    s_nop 7
    s_branch L_again
L_edge:
    v_mov_b32 v254, v0
    v_mov_b32 v255, 0x40000000
    s_lshl_b32 s3, s16, 4
    s_load_dwordx4 s[92:95], s[0:1], s3
    v_and_b32 v118, 63, v0
    s_bfe_u32 s3, s2, 0x50003
    s_lshl_b32 s4, s16, 3
    s_lshr_b32 s98, 0x06143a01, s4
    s_and_b32 s98, s98, 0xff
    s_mul_i32 s3, s3, s98
    s_sub_u32 s98, s98, 1
    s_lshr_b32 s4, 0x0048d800, s4
    s_and_b32 s4, s4, 0xff
    s_lshl_b32 s4, s4, 3
    s_max_u32 s4, s4, 6
    s_sub_u32 s4, s4, s98
    s_sub_u32 s4, s4, 1
    s_min_u32 s3, s3, s4
    v_min_u32 v120, s98, v118
    v_add_lshl_u32 v120, v120, s3, 7
    v_mov_b32 v121, 0
    v_lshrrev_b32 v119, 4, v118
    v_and_b32 v130, 15, v118
    s_mov_b32 s10, 100270464
    s_mov_b32 s11, 0x00020000
    s_mov_b32 s50, 36096
    s_mov_b32 s51, 0x00020000
    s_mul_i32 s3, s16, 96
    v_lshl_add_u32 v131, v118, 4, s3
    v_mul_u32_u24 v132, 171, v118
    v_lshrrev_b32 v132, 10, v132
    v_lshrrev_b32 v133, 1, v132
    v_xor_b32 v133, v133, v132
    v_and_b32 v133, 4, v133
    v_mul_u32_u24 v133, 3, v133
    v_xor_b32 v133, v133, v132
    v_mul_u32_u24 v133, 1152, v133
    v_mul_u32_u24 v134, 96, v132
    v_sub_u32 v133, v133, v134
    v_add_u32 v134, v131, v133
    v_add_u32 v133, 64, v118
    v_mul_u32_u24 v133, 171, v133
    v_lshrrev_b32 v133, 10, v133
    v_lshrrev_b32 v135, 1, v133
    v_xor_b32 v135, v135, v133
    v_and_b32 v135, 4, v135
    v_mul_u32_u24 v135, 3, v135
    v_xor_b32 v135, v135, v133
    v_mul_u32_u24 v135, 1152, v135
    v_mul_u32_u24 v136, 96, v133
    v_sub_u32 v135, v135, v136
    v_add_u32 v136, v131, v135
    v_add_u32 v135, 128, v118
    v_mul_u32_u24 v135, 171, v135
    v_lshrrev_b32 v135, 10, v135
    v_lshrrev_b32 v137, 1, v135
    v_xor_b32 v137, v137, v135
    v_and_b32 v137, 4, v137
    v_mul_u32_u24 v137, 3, v137
    v_xor_b32 v137, v137, v135
    v_mul_u32_u24 v137, 1152, v137
    v_mul_u32_u24 v138, 96, v135
    v_sub_u32 v137, v137, v138
    v_add_u32 v138, v131, v137
    s_mul_i32 s68, s16, 6144
    s_add_u32 s69, s68, 65536
    s_cmp_eq_u32 s16, 3
    s_cselect_b32 s68, 136704, s68
    s_cselect_b32 s69, 142848, s69
    s_mov_b32 s70, 193536
    s_mov_b32 s36, 100270464
    s_mov_b32 s22, 1180032
    s_mul_i32 s3, s2, 911
    s_lshr_b32 s3, s3, 16
    s_mul_i32 s35, s3, 72
    s_sub_u32 s38, s2, s35
    s_mul_i32 s3, s3, 1373568
    s_mul_i32 s35, s38, 2688
    s_add_u32 s3, s3, s35
    s_add_u32 s25, s3, 589824
    s_add_u32 s7, s3, 1769472
    s_mov_b32 s20, 31
    s_mov_b32 s21, 4204032
    s_cmp_lt_u32 s2, 244
    s_cselect_b32 s17, 21, 20
    s_mov_b32 s5, 0
    s_mov_b32 s6, 0
    s_cmp_lt_u32 s2, 247
    s_cbranch_scc1 L_inner
    s_mov_b32 s20, 0
    s_mov_b32 s38, 0
    s_sub_u32 s3, s2, 247
    s_and_b32 s3, s3, 3
    s_mul_i32 s3, s3, 7
    s_add_u32 s3, s3, 3
    s_mov_b32 s35, 196224
    s_cmp_lt_u32 s2, 251
    s_cselect_b32 s35, s35, 384
    s_cselect_b32 s6, 1, 0
    s_cselect_b32 s5, 0, 1
    s_mul_i32 s25, s3, s35
    s_mul_i32 s21, s35, 28
    s_cmp_lt_u32 s2, 255
    s_cselect_b32 s17, 18, 1
    s_cselect_b32 s25, s25, 0
    s_cselect_b32 s6, s6, 1
    s_add_u32 s7, s25, 1179648
L_inner:
    s_mul_i32 s3, s5, 99485568
    s_mul_i32 s35, s5, -784896
    v_mov_b32 v131, s3
    v_mov_b32 v137, s35
    s_add_u32 s7, s7, s35
    s_mul_i32 s3, s6, 194688
    s_mul_i32 s35, s6, -1536
    v_mov_b32 v139, s3
    v_mov_b32 v140, s35
    s_add_u32 s7, s7, s35
    v_mul_u32_u24 v141, 2731, v254
    v_bfe_u32 v142, v141, 17, 3
    v_lshrrev_b32 v141, 16, v141
    v_xor_b32 v143, v142, v254
    v_mul_u32_u24 v142, 37, v141
    v_lshrrev_b32 v142, 8, v142
    v_lshlrev_b32 v143, 4, v143
    v_mad_u32_u24 v10, v142, s70, v143
    v_mul_u32_u24 v142, 37, v141
    v_lshrrev_b32 v142, 8, v142
    v_mul_u32_u24 v144, 7, v142
    v_sub_u32 v144, v141, v144
    v_cmp_gt_u32 vcc, 4, v142
    s_nop 1
    v_cndmask_b32 v142, v137, v131, vcc
    v_cmp_gt_u32 vcc, 4, v144
    s_nop 1
    v_cndmask_b32 v144, v140, v139, vcc
    v_add3_u32 v10, v10, v142, v144
    v_mul_u32_u24 v142, s20, v141
    v_add_u32 v142, s38, v142
    v_mul_u32_u24 v142, 911, v142
    v_lshrrev_b32 v142, 16, v142
    v_mul_u32_u24 v142, s22, v142
    v_mad_u32_u24 v142, v141, s21, v142
    v_cmp_gt_u32 vcc, s17, v141
    v_add_u32 v142, s7, v142
    s_nop 0
    v_cndmask_b32 v142, v255, v142, vcc
    v_mul_u32_u24 v141, 384, v141
    v_sub_u32 v141, v143, v141
    v_add_u32 v142, v142, v141
    v_add_u32 v141, 256, v254
    v_mul_u32_u24 v143, 2731, v141
    v_bfe_u32 v144, v143, 17, 3
    v_lshrrev_b32 v143, 16, v143
    v_xor_b32 v141, v144, v141
    v_mul_u32_u24 v144, 37, v143
    v_lshrrev_b32 v144, 8, v144
    v_lshlrev_b32 v141, 4, v141
    v_mad_u32_u24 v11, v144, s70, v141
    v_mul_u32_u24 v144, 37, v143
    v_lshrrev_b32 v144, 8, v144
    v_mul_u32_u24 v145, 7, v144
    v_sub_u32 v145, v143, v145
    v_cmp_gt_u32 vcc, 4, v144
    s_nop 1
    v_cndmask_b32 v144, v137, v131, vcc
    v_cmp_gt_u32 vcc, 4, v145
    s_nop 1
    v_cndmask_b32 v145, v140, v139, vcc
    v_add3_u32 v11, v11, v144, v145
    v_mul_u32_u24 v144, s20, v143
    v_add_u32 v144, s38, v144
    v_mul_u32_u24 v144, 911, v144
    v_lshrrev_b32 v144, 16, v144
    v_mul_u32_u24 v144, s22, v144
    v_mad_u32_u24 v144, v143, s21, v144
    v_cmp_gt_u32 vcc, s17, v143
    v_add_u32 v144, s7, v144
    s_nop 0
    v_cndmask_b32 v144, v255, v144, vcc
    v_mul_u32_u24 v143, 384, v143
    v_sub_u32 v143, v141, v143
    v_add_u32 v144, v144, v143
    s_lshl_b32 s28, s16, 10
    s_add_u32 s28, s28, 20480
    s_waitcnt lgkmcnt(0)
    s_load_dword s101, s[92:93], 0
    s_load_dword s101, s[94:95], 0
    s_cmp_eq_u32 s16, 2
    s_cselect_b64 s[98:99], s[80:81], s[78:79]
    s_cmp_eq_u32 s16, 3
    s_cselect_b64 s[98:99], s[88:89], s[98:99]
    s_mov_b64 s[8:9], s[76:77]
    v_lshl_add_u64 v[120:121], s[98:99], 0, v[120:121]
    s_cmp_eq_u32 s16, 2
    s_cselect_b64 s[98:99], s[84:85], s[82:83]
    s_cmp_eq_u32 s16, 3
    s_cselect_b64 s[98:99], s[86:87], s[98:99]
    v_writelane_b32 v120, s98, 63
    v_writelane_b32 v121, s99, 63
    s_cmp_eq_u32 s16, 0
    s_cbranch_scc1 L_nowue
    global_load_dword a254, v[120:121], off
L_nowue:
    s_add_u32 m0, s28, 128512
    s_nop 0
    buffer_load_dwordx4 v142, s[8:11], 0 offen nt lds
    s_add_u32 m0, s28, 132608
    s_nop 0
    buffer_load_dwordx4 v144, s[8:11], 0 offen nt lds
    s_add_u32 m0, s28, 0
    s_nop 0
    buffer_load_dwordx4 v10, s[8:11], s25 offen nt lds
    s_add_u32 m0, s28, 4096
    s_nop 0
    buffer_load_dwordx4 v11, s[8:11], s25 offen nt lds
    s_mov_b64 s[48:49], s[78:79]
    s_mov_b64 s[52:53], s[80:81]
    s_mov_b64 s[60:61], s[84:85]
    s_mov_b64 s[64:65], s[86:87]
    s_mov_b64 s[56:57], s[88:89]
    s_mov_b64 s[46:47], s[82:83]
    s_load_dwordx2 s[42:43], s[0:1], 72
    s_add_u32 s48, s48, 384
    s_addc_u32 s49, s49, 0
    s_add_u32 m0, s68, 0
    v_add_u32 v141, s16, v118
    v_and_b32 v141, 3, v141
    v_lshlrev_b32 v141, 1, v141
    s_mov_b32 s54, 12288
    s_mov_b32 s55, 0x00020000
    s_mov_b32 s62, 64
    s_mov_b32 s63, 0x00020000
    s_mov_b32 s66, 128
    s_mov_b32 s67, 0x00020000
    s_mov_b32 s58, 676
    s_mov_b32 s59, 0x00020000
    s_mov_b32 s14, 0
    s_mov_b32 s15, 0x00020000
    v_mov_b32 v117, 0
    v_cmp_lt_u32 s[90:91], 7, v130
    v_mov_b32 v115, 0
    v_mov_b32 v125, 0
    v_mov_b32 v121, 0
    v_lshlrev_b32 v120, 1, v118
    v_mul_u32_u24 v114, 12, v130
    s_mul_i32 s71, s16, 192
    v_add_u32 v114, s71, v114
    v_lshlrev_b32 v124, 5, v119
    s_mul_i32 s72, s16, 8064
    s_add_u32 s72, s72, 104448
    s_mul_i32 s73, s16, 6528
    s_add_u32 s73, s73, 38912
    v_lshrrev_b32 v127, 2, v130
    v_and_b32 v123, 1, v127
    v_mul_u32_u24 v123, 0x020202, v123
    v_lshl_or_b32 v123, v123, 8, v123
    v_add_u32 v123, 0x05040100, v123
    v_and_b32 v122, 3, v130
    v_lshrrev_b32 v116, 1, v130
    v_xor_b32 v116, v116, v119
    v_mul_u32_u24 v126, 384, v130
    v_lshl_add_u32 v0, v116, 4, v126
    v_xor_b32 v1, 64, v0
    v_and_b32 v116, 2, v119
    v_add_u32 v116, v116, v119
    v_lshl_add_u32 v116, v116, 2, v127
    v_mul_u32_u24 v116, 96, v116
    v_lshl_add_u32 v116, v122, 3, v116
    v_add_u32 v128, s68, v116
    v_add_u32 v126, s69, v116
    v_add_u32 v129, s72, v116
    v_add_u32 v142, s73, v116
    v_mov_b32 v28, 0x3f803f80
    v_mov_b32 v29, 0x3f803f80
    v_mov_b32 v30, 0x3f803f80
    v_mov_b32 v31, 0x3f803f80
    v_mul_u32_u24 v146, 768, v119
    v_add_u32 v146, v114, v146
    v_add_u32 v146, 157184, v146
    s_mov_b32 s76, 0x3f80
    v_and_b32 v143, 1, v130
    v_lshlrev_b32 v143, 4, v143
    v_lshlrev_b32 v144, v143, s76
    v_mov_b32 v145, 0x3c003c00
    v_mov_b32 v44, 1.0
    v_mov_b32 v45, 1.0
    v_lshlrev_b32 v147, 4, v119
    s_mov_b32 s19, s38
    s_mov_b32 s23, s25
    s_mov_b32 s26, 0
    s_mov_b32 s27, 0
    s_mov_b32 s18, 0
    s_add_u32 s19, s19, s20
    s_add_u32 s23, s23, s21
    s_cmp_ge_u32 s19, 72
    s_cselect_b32 s34, 72, 0
    s_cselect_b32 s35, s22, 0
    s_sub_u32 s19, s19, s34
    s_add_u32 s23, s23, s35
    s_mov_b32 s24, s23
    s_add_u32 s19, s19, s20
    s_add_u32 s23, s23, s21
    s_cmp_ge_u32 s19, 72
    s_cselect_b32 s34, 72, 0
    s_cselect_b32 s35, s22, 0
    s_sub_u32 s19, s19, s34
    s_add_u32 s23, s23, s35
    s_mul_i32 s79, s16, 64
    v_lshl_add_u32 v154, v119, 4, s79
    s_mul_i32 s80, s16, 32
    s_add_u32 s80, s80, 256
    v_lshl_add_u32 v150, v119, 3, s80
    v_add_u32 v148, 0, v130
    v_mul_u32_u24 v155, 37, v148
    v_mul_u32_u24 v116, 384, v148
    v_lshrrev_b32 v155, 8, v155
    v_mad_u32_u24 v116, v155, s70, v116
    v_add_u32 v15, v116, v154
    v_add_u32 v18, v116, v150
    v_mul_u32_u24 v149, 37, v148
    v_lshrrev_b32 v149, 8, v149
    v_mul_u32_u24 v156, 7, v149
    v_sub_u32 v156, v148, v156
    v_add_u32 v153, 16, v130
    v_mul_u32_u24 v152, 37, v153
    v_mul_u32_u24 v116, 384, v153
    v_lshrrev_b32 v152, 8, v152
    v_mad_u32_u24 v116, v152, s70, v116
    v_add_u32 v16, v116, v154
    v_add_u32 v19, v116, v150
    v_mul_u32_u24 v158, 37, v153
    v_lshrrev_b32 v158, 8, v158
    v_mul_u32_u24 v157, 7, v158
    v_sub_u32 v157, v153, v157
    v_add_u32 v151, 32, v130
    v_mul_u32_u24 v116, 37, v151
    v_mul_u32_u24 v159, 384, v151
    v_lshrrev_b32 v116, 8, v116
    v_mad_u32_u24 v159, v116, s70, v159
    v_add_u32 v17, v159, v154
    v_add_u32 v20, v159, v150
    v_mul_u32_u24 v154, 37, v151
    v_lshrrev_b32 v154, 8, v154
    v_mul_u32_u24 v150, 7, v154
    v_sub_u32 v150, v151, v150
    s_mul_i32 s81, s16, 768
    s_add_u32 s81, s81, 157184
    v_mul_u32_u24 v155, 24, v155
    v_lshl_add_u32 v155, v148, 2, v155
    v_add_u32 v22, s81, v155
    v_sub_u32 v23, s81, v155
    v_sub_u32 v155, v22, v147
    v_mul_u32_u24 v152, 24, v152
    v_lshl_add_u32 v152, v153, 2, v152
    v_add_u32 v24, s81, v152
    v_sub_u32 v25, s81, v152
    v_sub_u32 v152, v24, v147
    v_mul_u32_u24 v116, 24, v116
    v_lshl_add_u32 v116, v151, 2, v116
    v_add_u32 v26, s81, v116
    v_sub_u32 v27, s81, v116
    v_sub_u32 v116, v26, v147
    v_mul_u32_u24 v160, 148, v119
    s_mov_b32 s82, -24
    v_add_u32 v159, 0, v160
    v_lshrrev_b32 v159, 8, v159
    v_mad_i32_i24 v46, v159, s82, v155
    v_mad_i32_i24 v58, v159, s82, v152
    v_mad_i32_i24 v70, v159, s82, v116
    v_add_u32 v159, 37, v160
    v_lshrrev_b32 v159, 8, v159
    v_mad_i32_i24 v47, v159, s82, v155
    v_mad_i32_i24 v59, v159, s82, v152
    v_mad_i32_i24 v71, v159, s82, v116
    v_add_u32 v159, 74, v160
    v_lshrrev_b32 v159, 8, v159
    v_mad_i32_i24 v48, v159, s82, v155
    v_mad_i32_i24 v60, v159, s82, v152
    v_mad_i32_i24 v72, v159, s82, v116
    v_add_u32 v159, 111, v160
    v_lshrrev_b32 v159, 8, v159
    v_mad_i32_i24 v49, v159, s82, v155
    v_mad_i32_i24 v61, v159, s82, v152
    v_mad_i32_i24 v73, v159, s82, v116
    v_add_u32 v159, 592, v160
    v_lshrrev_b32 v159, 8, v159
    v_mad_i32_i24 v50, v159, s82, v155
    v_mad_i32_i24 v62, v159, s82, v152
    v_mad_i32_i24 v74, v159, s82, v116
    v_add_u32 v159, 629, v160
    v_lshrrev_b32 v159, 8, v159
    v_mad_i32_i24 v51, v159, s82, v155
    v_mad_i32_i24 v63, v159, s82, v152
    v_mad_i32_i24 v75, v159, s82, v116
    v_add_u32 v159, 666, v160
    v_lshrrev_b32 v159, 8, v159
    v_mad_i32_i24 v52, v159, s82, v155
    v_mad_i32_i24 v64, v159, s82, v152
    v_mad_i32_i24 v76, v159, s82, v116
    v_add_u32 v159, 703, v160
    v_lshrrev_b32 v159, 8, v159
    v_mad_i32_i24 v53, v159, s82, v155
    v_mad_i32_i24 v65, v159, s82, v152
    v_mad_i32_i24 v77, v159, s82, v116
    v_add_u32 v159, 1184, v160
    v_lshrrev_b32 v159, 8, v159
    v_mad_i32_i24 v54, v159, s82, v155
    v_mad_i32_i24 v66, v159, s82, v152
    v_mad_i32_i24 v78, v159, s82, v116
    v_add_u32 v159, 1221, v160
    v_lshrrev_b32 v159, 8, v159
    v_mad_i32_i24 v55, v159, s82, v155
    v_mad_i32_i24 v67, v159, s82, v152
    v_mad_i32_i24 v79, v159, s82, v116
    v_add_u32 v159, 1258, v160
    v_lshrrev_b32 v159, 8, v159
    v_mad_i32_i24 v56, v159, s82, v155
    v_mad_i32_i24 v68, v159, s82, v152
    v_mad_i32_i24 v80, v159, s82, v116
    v_add_u32 v159, 1295, v160
    v_lshrrev_b32 v159, 8, v159
    v_mad_i32_i24 v57, v159, s82, v155
    v_mad_i32_i24 v69, v159, s82, v152
    v_mad_i32_i24 v81, v159, s82, v116
    v_mov_b32 v155, s81
    v_lshlrev_b32 v116, 4, v118
    v_xor_b32 v2, 65536, v116
    v_lshl_add_u32 v3, s16, 10, v116
    s_lshr_b32 s83, s16, 1
    s_and_b32 s84, s16, 1
    s_lshl_b32 s84, s84, 3
    s_lshl_b32 s85, s83, 10
    s_add_u32 s85, s85, s84
    v_add_u32 v4, s85, v116
    s_lshl_b32 s83, s83, 11
    s_add_u32 s83, s83, s84
    s_add_u32 s83, s83, 144896
    s_mul_i32 s86, s16, 2048
    s_add_u32 s86, s86, 136704
    v_lshl_add_u32 v152, v119, 3, s86
    v_mov_b32 v160, s83
    v_mov_b32 v161, 161536
    v_mul_u32_u24 v159, 80, v119
    v_add3_u32 v5, v159, v143, s72
    v_lshl_add_u32 v6, v130, 2, s73
    s_mul_i32 s87, s16, 128
    s_add_u32 s87, s87, 65024
    buffer_load_dwordx4 v134, s[48:51], 0 offen lds
    v_add_u32 v9, s87, v147
    v_lshrrev_b32 v116, 1, v119
    v_mul_u32_u24 v116, 48, v116
    s_mov_b32 s40, s8
    s_mov_b32 s41, s9
    buffer_load_dwordx4 v136, s[48:51], 0 offen offset:1024 lds
    v_lshl_add_u32 v116, v119, 3, v116
    v_lshl_add_u32 v116, v127, 4, v116
    v_lshl_add_u32 v116, v122, 1, v116
    s_mov_b32 s32, 0x2a8cbccc
    s_mov_b32 s33, 0x38fba882
    buffer_load_dwordx4 v138, s[48:51], 0 offen offset:2048 lds
    s_add_u32 s48, s48, 36864
    s_addc_u32 s49, s49, 0
    s_add_u32 m0, s68, 3072
    v_add_u32 v8, s87, v116
    s_add_u32 s75, s28, 16384
    s_cmp_lt_u32 s16, 2
    buffer_load_dwordx4 v134, s[48:51], 0 offen lds
    v_mov_b32 v37, 0
    v_mov_b32 v38, 0
    v_mov_b32 v39, 0
    s_cselect_b32 s29, s75, 160256
    s_cselect_b32 s30, 65536, 0
    buffer_load_dwordx4 v136, s[48:51], 0 offen offset:1024 lds
    v_add_u32 v179, 148992, v0
    v_add_u32 v178, 148992, v1
    v_lshlrev_b32 v180, 4, v130
    s_xor_b32 s74, s29, s30
    s_lshl_b32 s92, s5, 1
    buffer_load_dwordx4 v138, s[48:51], 0 offen offset:2048 lds
    s_add_u32 s48, s48, 36864
    s_addc_u32 s49, s49, 0
    s_add_u32 m0, s69, 0
    s_or_b32 s92, s92, s6
    s_mul_i32 s77, s16, 64
    buffer_load_ushort v116, v120, s[60:63], 0 offen
    v_add_u32 v180, 160256, v180
    s_mul_i32 s78, s16, 32
    s_add_u32 s78, s78, 192
    buffer_load_dwordx3 v[170:172], v114, s[56:59], 0 offen
    v_mul_u32_u24 v188, 336, v130
    s_add_u32 s34, s18, 2
    s_mov_b32 s27, s26
    buffer_load_dwordx4 v[174:177], v124, s[64:67], 0 offen
    v_add3_u32 v188, v188, v159, s72
    v_mul_u32_u24 v187, 272, v130
    v_add3_u32 v187, v187, v147, s73
    v_mul_u32_u24 v186, 1088, v119
    v_add_u32 v186, v186, v6
    v_add_u32 v181, 5376, v188
    v_add_u32 v190, 4352, v187
    v_add_u32 v189, 4352, v186
    v_cmp_gt_u32 s[88:89], 16, v118
    v_mov_b32 v159, 0xf149f2ca
    v_add_u32 v173, 512, v254
    v_mul_u32_u24 v114, 2731, v173
    v_bfe_u32 v120, v114, 17, 3
    v_lshrrev_b32 v114, 16, v114
    v_xor_b32 v173, v120, v173
    v_mul_u32_u24 v120, 37, v114
    v_lshrrev_b32 v120, 8, v120
    v_lshlrev_b32 v173, 4, v173
    v_mad_u32_u24 v12, v120, s70, v173
    v_mul_u32_u24 v173, 37, v114
    v_lshrrev_b32 v173, 8, v173
    v_mul_u32_u24 v191, 7, v173
    v_sub_u32 v191, v114, v191
    v_cmp_gt_u32 vcc, 4, v173
    v_add_u32 v192, 768, v254
    v_mul_u32_u24 v114, 2731, v192
    v_cndmask_b32 v173, v137, v131, vcc
    s_mov_b32 s26, s25
    s_add_u32 s19, s19, s20
    buffer_load_dwordx4 v[166:169], v124, s[64:67], 0 offen offset:16
    v_cmp_gt_u32 vcc, 4, v191
    v_bfe_u32 v120, v114, 17, 3
    v_lshrrev_b32 v114, 16, v114
    v_cndmask_b32 v191, v140, v139, vcc
    v_add3_u32 v12, v12, v173, v191
    v_xor_b32 v192, v120, v192
    v_mul_u32_u24 v120, 37, v114
    v_lshrrev_b32 v120, 8, v120
    v_lshlrev_b32 v192, 4, v192
    v_mad_u32_u24 v13, v120, s70, v192
    v_mul_u32_u24 v120, 37, v114
    v_lshrrev_b32 v120, 8, v120
    v_mul_u32_u24 v191, 7, v120
    v_sub_u32 v191, v114, v191
    v_cmp_gt_u32 vcc, 4, v120
    v_add_u32 v114, 1024, v254
    v_mul_u32_u24 v124, 2731, v114
    v_cndmask_b32 v120, v137, v131, vcc
    v_cmp_gt_u32 vcc, 4, v191
    v_bfe_u32 v173, v124, 17, 3
    v_lshrrev_b32 v124, 16, v124
    v_cndmask_b32 v191, v140, v139, vcc
    v_add3_u32 v13, v13, v120, v191
    v_xor_b32 v114, v173, v114
    v_mul_u32_u24 v173, 37, v124
    v_lshrrev_b32 v173, 8, v173
    v_lshlrev_b32 v114, 4, v114
    v_mad_u32_u24 v14, v173, s70, v114
    v_mul_u32_u24 v120, 37, v124
    v_lshrrev_b32 v120, 8, v120
    v_mul_u32_u24 v114, 7, v120
    v_sub_u32 v114, v124, v114
    v_cmp_gt_u32 vcc, 4, v120
    v_mov_b32 v254, 0xc31044fe
    v_mul_u32_u24 v191, 37, v148
    v_cndmask_b32 v120, v137, v131, vcc
    v_cmp_gt_u32 vcc, 4, v114
    v_lshrrev_b32 v191, 8, v191
    v_mul_u32_u24 v173, 7, v191
    v_cndmask_b32 v114, v140, v139, vcc
    v_add3_u32 v14, v14, v120, v114
    v_cmp_gt_u32 vcc, 48, v124
    v_sub_u32 v173, v148, v173
    v_lshrrev_b32 v191, 2, v191
    v_cndmask_b32 v14, v255, v14, vcc
    v_cmp_gt_u32 vcc, 2, v122
    v_lshrrev_b32 v173, 2, v173
    s_mov_b32 s18, 1
    s_sub_u32 s45, s17, 1
    s_waitcnt vmcnt(9)
    s_barrier
    global_load_ushort v141, v141, s[46:47]
    v_cndmask_b32 v32, 0, v144, vcc
    v_cndmask_b32 v33, v144, 0, vcc
    v_cndmask_b32 v34, 0, v144, vcc
    v_cndmask_b32 v35, v144, 0, vcc
    v_cmp_eq_u32 vcc, 0, v143
    v_and_b32 v191, s5, v191
    v_and_b32 v173, s6, v173
    v_cndmask_b32 v40, 0, v145, vcc
    v_cndmask_b32 v41, v145, 0, vcc
    v_cndmask_b32 v42, 0, v145, vcc
    v_cndmask_b32 v43, v145, 0, vcc
    v_cmp_eq_u32 vcc, v119, v127
    buffer_load_dwordx4 v134, s[48:51], 0 offen lds
    v_lshl_or_b32 v191, v191, 1, v173
    v_cndmask_b32 v144, 0, v32, vcc
    v_cndmask_b32 v145, 0, v33, vcc
    v_mul_u32_u24 v255, 37, v153
    v_lshrrev_b32 v255, 8, v255
    v_mul_u32_u24 v114, 7, v255
    v_sub_u32 v114, v153, v114
    v_lshrrev_b32 v255, 2, v255
    v_lshrrev_b32 v114, 2, v114
    v_and_b32 v255, s5, v255
    v_and_b32 v114, s6, v114
    v_lshl_or_b32 v255, v255, 1, v114
    v_mul_u32_u24 v192, 37, v151
    v_lshrrev_b32 v192, 8, v192
    v_mul_u32_u24 v114, 7, v192
    buffer_load_dwordx4 v136, s[48:51], 0 offen offset:1024 lds
    s_waitcnt vmcnt(10)
    ds_read_b64_tr_b16 a[72:73], v128 offset:0
    ds_read_b64_tr_b16 a[74:75], v128 offset:768
    ds_read_b64_tr_b16 a[96:97], v128 offset:32
    ds_read_b64_tr_b16 a[98:99], v128 offset:800
    ds_read_b64_tr_b16 a[120:121], v128 offset:64
    ds_read_b64_tr_b16 a[122:123], v128 offset:832
    v_sub_u32 v114, v151, v114
    v_lshrrev_b32 v192, 2, v192
    v_lshrrev_b32 v114, 2, v114
    v_and_b32 v192, s5, v192
    v_and_b32 v114, s6, v114
    v_lshl_or_b32 v192, v192, 1, v114
    v_mul_u32_u24 v120, 6, v132
    v_sub_u32 v124, v118, v120
    buffer_load_dwordx4 v138, s[48:51], 0 offen offset:2048 lds
    s_add_u32 s48, s48, 36864
    s_addc_u32 s49, s49, 0
    s_add_u32 m0, s69, 3072
    v_mul_u32_u24 v120, 384, v132
    v_lshl_add_u32 v120, v124, 4, v120
    v_add_u32 v114, s78, v120
    v_add_u32 v120, s77, v120
    v_cmp_gt_i32 vcc, 4, v124
    v_mul_u32_u24 v173, 6, v133
    v_sub_u32 v124, v118, v173
    v_cndmask_b32 v143, v114, v120, vcc
    v_mul_u32_u24 v173, 384, v133
    v_lshl_add_u32 v173, v124, 4, v173
    v_add_u32 v114, s78, v173
    v_add_u32 v173, s77, v173
    buffer_load_dwordx4 v134, s[48:51], 0 offen lds
    v_cmp_gt_i32 vcc, -60, v124
    v_mul_u32_u24 v148, 6, v135
    v_sub_u32 v124, v118, v148
    v_cndmask_b32 v118, v114, v173, vcc
    v_mul_u32_u24 v148, 384, v135
    v_lshl_add_u32 v148, v124, 4, v148
    v_add_u32 v114, s78, v148
    v_add_u32 v148, s77, v148
    v_cmp_gt_i32 vcc, -124, v124
    v_mul_u32_u24 v135, 96, v130
    v_add3_u32 v193, v135, v147, s68
    v_cndmask_b32 v151, v114, v148, vcc
    v_cmp_gt_u32 vcc, 4, v149
    s_waitcnt vmcnt(9)
    ds_read_b64_tr_b16 a[76:77], v128 offset:3072
    ds_read_b64_tr_b16 a[78:79], v128 offset:3840
    s_waitcnt vmcnt(7)
    buffer_load_dwordx4 v136, s[48:51], 0 offen offset:1024 lds
    s_waitcnt vmcnt(7)
    ds_read_b64_tr_b16 a[100:101], v128 offset:3104
    s_waitcnt vmcnt(6)
    ds_read_b64_tr_b16 a[102:103], v128 offset:3872
    ds_read_b64_tr_b16 a[124:125], v128 offset:3136
    ds_read_b64_tr_b16 a[126:127], v128 offset:3904
    v_cndmask_b32 v174, v174, v175, s[90:91]
    v_cndmask_b32 v176, v176, v177, s[90:91]
    v_perm_b32 v132, v176, v174, v123
    v_cndmask_b32 v166, v166, v167, s[90:91]
    v_cndmask_b32 v168, v168, v169, s[90:91]
    v_perm_b32 v133, v168, v166, v123
    v_bfe_u32 v114, v170, v147, 16
    v_bfe_u32 v124, v171, v147, 16
    v_bfe_u32 v120, v172, v147, 16
    v_mfma_f32_16x16x16_bf16 v[174:177], v[116:117], v[114:115], 0
    v_cndmask_b32 v149, v137, v131, vcc
    v_cmp_gt_u32 vcc, 4, v156
    v_lshl_add_u32 v153, v119, 3, v135
    v_mfma_f32_16x16x16_bf16 v[170:173], v[116:117], v[124:125], 0
    v_cndmask_b32 v156, v140, v139, vcc
    v_add3_u32 v15, v15, v149, v156
    v_add3_u32 v18, v18, v149, v156
    v_mfma_f32_16x16x16_bf16 v[166:169], v[116:117], v[120:121], 0
    buffer_load_dwordx4 v138, s[48:51], 0 offen offset:2048 lds
    s_add_u32 s48, s48, 36864
    s_addc_u32 s49, s49, 0
    s_add_u32 m0, s72, 0
    v_max_f32 v174, 0, v174
    v_max_f32 v175, 0, v175
    v_max_f32 v176, 0, v176
    v_max_f32 v177, 0, v177
    v_cvt_pk_bf16_f32 v120, v174, v175
    v_cvt_pk_bf16_f32 v121, v176, v177
    v_max_f32 v170, 0, v170
    s_waitcnt vmcnt(6)
    v_mfma_f32_16x16x16_bf16 v[114:117], v[132:133], v[120:121], 0
    v_max_f32 v171, 0, v171
    v_max_f32 v172, 0, v172
    v_max_f32 v173, 0, v173
    buffer_load_dwordx4 v134, s[48:51], 0 offen lds
    v_cvt_pk_bf16_f32 v120, v170, v171
    v_cvt_pk_bf16_f32 v121, v172, v173
    v_max_f32 v166, 0, v166
    v_max_f32 v167, 0, v167
    v_mfma_f32_16x16x16_bf16 v[174:177], v[132:133], v[120:121], 0
    v_cvt_pk_bf16_f32 v114, v114, v114
    v_and_b32 v114, 0xffff0000, v114
    v_mul_f32 v114, 0xbfb8aa3b, v114
    v_exp_f32 v114, v114
    v_max_f32 v168, 0, v168
    v_add_f32 v114, 1.0, v114
    v_rcp_f32 v114, v114
    v_max_f32 v169, 0, v169
    buffer_load_dwordx4 v136, s[48:51], 0 offen offset:1024 lds
    v_cvt_pk_bf16_f32 v114, v114, v114
    v_and_b32 v114, 0xffff0000, v114
    v_add_f32 v114, -0.5, v114
    v_mul_f32 v114, 0x41b8aa3b, v114
    ds_write_b32 v146, v114 offset:0
    v_cvt_pk_bf16_f32 v174, v174, v174
    v_and_b32 v174, 0xffff0000, v174
    v_mul_f32 v174, 0xbfb8aa3b, v174
    v_exp_f32 v174, v174
    v_cvt_pk_bf16_f32 v120, v166, v167
    v_add_f32 v174, 1.0, v174
    buffer_load_dwordx4 v138, s[48:51], 0 offen offset:2048 lds
    s_add_u32 s48, s48, 36864
    s_addc_u32 s49, s49, 0
    s_add_u32 m0, s72, 3072
    v_rcp_f32 v174, v174
    v_cvt_pk_bf16_f32 v121, v168, v169
    v_cvt_pk_bf16_f32 v174, v174, v174
    s_waitcnt vmcnt(6)
    v_mfma_f32_16x16x16_bf16 v[114:117], v[132:133], v[120:121], 0
    ds_read_b64_tr_b16 a[80:81], v126 offset:0
    ds_read_b64_tr_b16 a[82:83], v126 offset:768
    ds_read_b64_tr_b16 a[104:105], v126 offset:32
    ds_read_b64_tr_b16 a[106:107], v126 offset:800
    ds_read_b64_tr_b16 a[128:129], v126 offset:64
    ds_read_b64_tr_b16 a[130:131], v126 offset:832
    buffer_load_dwordx4 v134, s[48:51], 0 offen lds
    v_and_b32 v174, 0xffff0000, v174
    v_add_f32 v174, -0.5, v174
    v_mul_f32 v174, 0x41b8aa3b, v174
    ds_write_b32 v146, v174 offset:4
    v_cvt_pk_bf16_f32 v114, v114, v114
    v_and_b32 v114, 0xffff0000, v114
    v_mul_f32 v114, 0xbfb8aa3b, v114
    v_exp_f32 v114, v114
    v_lshlrev_b32 v141, 16, v141
    v_add_f32 v114, 1.0, v114
    v_rcp_f32 v114, v114
    buffer_load_dwordx4 v136, s[48:51], 0 offen offset:1024 lds
    v_cvt_pk_bf16_f32 v114, v114, v114
    v_and_b32 v114, 0xffff0000, v114
    v_add_f32 v114, -0.5, v114
    v_mul_f32 v114, 0x41b8aa3b, v114
    ds_write_b32 v146, v114 offset:8
    v_max_f32 v141, 0xc2c80000, v141
    v_min_f32 v141, 0x40930000, v141
    v_mul_f32 v141, 0x3fb8aa3b, v141
    v_exp_f32 v141, v141
    v_cmp_gt_u32 vcc, 4, v158
    v_cvt_pk_bf16_f32 v141, v141, v141
    buffer_load_dwordx4 v138, s[48:51], 0 offen offset:2048 lds
    s_sub_u32 s48, s48, 184704
    s_subb_u32 s49, s49, 0
    s_add_u32 m0, s73, 0
    v_and_b32 v141, 0xffff0000, v141
    v_mul_f32 v156, 0x3fb8aa3b, v141
    v_readfirstlane_b32 s37, v141
    v_readfirstlane_b32 s31, v156
    v_cndmask_b32 v158, v137, v131, vcc
    v_cmp_gt_u32 vcc, 4, v157
    v_add3_u32 v153, v153, 64, s68
    v_add3_u32 v120, v135, v147, s69
    v_cndmask_b32 v157, v140, v139, vcc
    v_add3_u32 v16, v16, v158, v157
    v_add3_u32 v19, v19, v158, v157
    v_cmp_gt_u32 vcc, 4, v154
    s_waitcnt vmcnt(6)
    s_waitcnt lgkmcnt(0)
    s_barrier
    buffer_load_dwordx4 v134, s[48:51], 0 offen lds
    ds_read_b64_tr_b16 a[84:85], v126 offset:3072
    ds_read_b64_tr_b16 a[86:87], v126 offset:3840
    ds_read_b64_tr_b16 a[108:109], v126 offset:3104
    ds_read_b64_tr_b16 a[110:111], v126 offset:3872
    ds_read_b64_tr_b16 a[132:133], v126 offset:3136
    ds_read_b64_tr_b16 a[134:135], v126 offset:3904
    ds_read_b32 v22, v22 offset:0
    ds_read_b32 v23, v23 offset:672
    v_cndmask_b32 v154, v137, v131, vcc
    v_cmp_gt_u32 vcc, 4, v150
    ds_read_b32 v24, v24 offset:0
    ds_read_b32 v25, v25 offset:672
    ds_read_b32 v26, v26 offset:0
    ds_read_b32 v27, v27 offset:672
    buffer_load_dwordx4 v136, s[48:51], 0 offen offset:1024 lds
    ds_read_b32 v46, v46 offset:336
    ds_read_b32 v58, v58 offset:336
    v_cndmask_b32 v150, v140, v139, vcc
    v_add3_u32 v17, v17, v154, v150
    v_add3_u32 v20, v20, v154, v150
    v_cmp_gt_u32 vcc, 2, v119
    ds_read_b32 v70, v70 offset:336
    ds_read_b32 v47, v47 offset:332
    ds_read_b32 v59, v59 offset:332
    ds_read_b32 v71, v71 offset:332
    ds_read_b32 v48, v48 offset:328
    ds_read_b32 v60, v60 offset:328
    v_cndmask_b32 v152, v160, v152, vcc
    buffer_load_dwordx4 v138, s[48:51], 0 offen offset:2048 lds
    ds_read_b32 v72, v72 offset:328
    ds_read_b32 v49, v49 offset:324
    ds_read_b32 v61, v61 offset:324
    ds_read_b32 v73, v73 offset:324
    s_add_u32 s48, s48, 36864
    ds_read_b32 v50, v50 offset:272
    s_addc_u32 s49, s49, 0
    ds_read_b32 v62, v62 offset:272
    s_add_u32 m0, s73, 3072
    ds_read_b32 v74, v74 offset:272
    v_lshl_add_u32 v152, v127, 9, v152
    v_lshl_add_u32 v152, v122, 1, v152
    v_cmp_gt_u32 vcc, 3, v119
    ds_read_b32 v51, v51 offset:268
    s_waitcnt vmcnt(6)
    buffer_load_dwordx4 v134, s[48:51], 0 offen lds
    ds_read_b64_tr_b16 a[88:89], v129 offset:0
    ds_read_b64_tr_b16 a[90:91], v129 offset:768
    ds_read_b64_tr_b16 a[112:113], v129 offset:32
    ds_read_b64_tr_b16 a[114:115], v129 offset:800
    ds_read_b64_tr_b16 a[136:137], v129 offset:64
    ds_read_b64_tr_b16 a[138:139], v129 offset:832
    v_cndmask_b32 v7, v161, v152, vcc
    v_cmp_gt_u32 vcc, 8, v130
    ds_read_b32 v63, v63 offset:268
    ds_read_b32 v75, v75 offset:268
    ds_read_b32 v52, v52 offset:264
    ds_read_b32 v64, v64 offset:264
    v_cndmask_b32 v181, v180, v181, vcc
    buffer_load_dwordx4 v136, s[48:51], 0 offen offset:1024 lds
    ds_read_b32 v76, v76 offset:264
    ds_read_b32 v53, v53 offset:260
    ds_read_b32 v65, v65 offset:260
    ds_read_b32 v77, v77 offset:260
    v_cndmask_b32 v190, v180, v190, vcc
    v_cmp_gt_u32 vcc, 2, v119
    ds_read_b32 v54, v54 offset:208
    ds_read_b32 v66, v66 offset:208
    ds_read_b32 v78, v78 offset:208
    ds_read_b32 v55, v55 offset:204
    v_cndmask_b32 v189, v180, v189, vcc
    ds_read_b32 v67, v67 offset:204
    ds_read_b32 v79, v79 offset:204
    buffer_load_dwordx4 v138, s[48:51], 0 offen offset:2048 lds
    ds_read_b32 v56, v56 offset:200
    ds_read_b32 v68, v68 offset:200
    s_add_u32 s48, s48, 36864
    ds_read_b32 v80, v80 offset:200
    s_addc_u32 s49, s49, 0
    ds_read_b32 v57, v57 offset:196
    s_add_u32 m0, s68, 0
    ds_read_b32 v69, v69 offset:196
    ds_read_b32 v81, v81 offset:196
    ds_read_b32 v155, v155 offset:336
    v_cmp_ne_u32 vcc, s92, v191
    v_lshl_add_u32 v121, v119, 2, 0
    v_mul_u32_u24 v180, 37, v121
    s_waitcnt vmcnt(6)
    buffer_load_dwordx4 v134, s[48:51], 0 offen lds
    ds_read_b64_tr_b16 a[92:93], v129 offset:3072
    ds_read_b64_tr_b16 a[94:95], v129 offset:3840
    ds_read_b64_tr_b16 a[116:117], v129 offset:3104
    ds_read_b64_tr_b16 a[118:119], v129 offset:3872
    ds_read_b64_tr_b16 a[140:141], v129 offset:3136
    ds_read_b64_tr_b16 a[142:143], v129 offset:3904
    v_cndmask_b32 v137, 0, v254, vcc
    s_waitcnt lgkmcnt(14)
    v_add_f32 v22, v22, v137
    v_cmp_ne_u32 vcc, s92, v191
    v_lshrrev_b32 v180, 8, v180
    v_mul_u32_u24 v137, 7, v180
    v_cndmask_b32 v127, 0, v254, vcc
    v_add_f32 v23, v23, v127
    v_cmp_ne_u32 vcc, s92, v255
    buffer_load_dwordx4 v136, s[48:51], 0 offen offset:1024 lds
    v_sub_u32 v137, v121, v137
    v_cndmask_b32 v121, 0, v254, vcc
    v_add_f32 v24, v24, v121
    s_waitcnt lgkmcnt(6)
    v_readfirstlane_b32 s39, v155
    v_cmp_ne_u32 vcc, s92, v255
    v_lshrrev_b32 v180, 2, v180
    v_lshrrev_b32 v137, 2, v137
    v_cndmask_b32 v121, 0, v254, vcc
    v_add_f32 v25, v25, v121
    v_cmp_ne_u32 vcc, s92, v192
    v_and_b32 v180, s5, v180
    v_and_b32 v137, s6, v137
    v_cndmask_b32 v121, 0, v254, vcc
    v_add_f32 v26, v26, v121
    buffer_load_dwordx4 v138, s[48:51], 0 offen offset:2048 lds
    s_add_u32 s48, s48, 36864
    s_addc_u32 s49, s49, 0
    s_add_u32 m0, s68, 3072
    v_cmp_ne_u32 vcc, s92, v192
    v_lshl_or_b32 v180, v180, 1, v137
    v_lshl_add_u32 v137, v119, 2, 1
    v_cndmask_b32 v121, 0, v254, vcc
    v_add_f32 v27, v27, v121
    v_cmp_ne_u32 vcc, v180, v191
    v_mul_u32_u24 v121, 37, v137
    v_lshrrev_b32 v121, 8, v121
    v_cndmask_b32 v127, 0, v254, vcc
    v_add_f32 v46, v46, v127
    v_cmp_ne_u32 vcc, v180, v255
    v_mul_u32_u24 v127, 7, v121
    buffer_load_dwordx4 v134, s[48:51], 0 offen lds
    s_waitcnt vmcnt(7)
    ds_read_b64_tr_b16 a[0:1], v142 offset:0
    ds_read_b64_tr_b16 a[2:3], v142 offset:768
    ds_read_b64_tr_b16 a[24:25], v142 offset:32
    ds_read_b64_tr_b16 a[26:27], v142 offset:800
    ds_read_b64_tr_b16 a[48:49], v142 offset:64
    ds_read_b64_tr_b16 a[50:51], v142 offset:832
    v_cndmask_b32 v129, 0, v254, vcc
    v_add_f32 v58, v58, v129
    v_cmp_ne_u32 vcc, v180, v192
    v_sub_u32 v127, v137, v127
    v_lshrrev_b32 v121, 2, v121
    v_cndmask_b32 v129, 0, v254, vcc
    v_add_f32 v70, v70, v129
    v_lshrrev_b32 v127, 2, v127
    buffer_load_dwordx4 v136, s[48:51], 0 offen offset:1024 lds
    v_and_b32 v121, s5, v121
    v_and_b32 v127, s6, v127
    v_lshl_or_b32 v121, v121, 1, v127
    v_cmp_ne_u32 vcc, v121, v191
    v_lshl_add_u32 v137, v119, 2, 2
    v_mul_u32_u24 v180, 37, v137
    v_cndmask_b32 v127, 0, v254, vcc
    v_add_f32 v47, v47, v127
    v_cmp_ne_u32 vcc, v121, v255
    v_lshrrev_b32 v180, 8, v180
    v_mul_u32_u24 v129, 7, v180
    v_cndmask_b32 v127, 0, v254, vcc
    v_add_f32 v59, v59, v127
    v_cmp_ne_u32 vcc, v121, v192
    v_sub_u32 v129, v137, v129
    buffer_load_dwordx4 v138, s[48:51], 0 offen offset:2048 lds
    s_add_u32 s48, s48, 36864
    s_addc_u32 s49, s49, 0
    s_add_u32 m0, s69, 0
    v_cndmask_b32 v121, 0, v254, vcc
    v_add_f32 v71, v71, v121
    v_lshrrev_b32 v180, 2, v180
    v_lshrrev_b32 v129, 2, v129
    v_and_b32 v180, s5, v180
    v_and_b32 v129, s6, v129
    v_lshl_or_b32 v180, v180, 1, v129
    v_cmp_ne_u32 vcc, v180, v191
    v_lshl_add_u32 v121, v119, 2, 3
    v_mul_u32_u24 v137, 37, v121
    v_cndmask_b32 v127, 0, v254, vcc
    v_add_f32 v48, v48, v127
    buffer_load_dwordx4 v134, s[48:51], 0 offen lds
    s_waitcnt vmcnt(7)
    ds_read_b64_tr_b16 a[4:5], v142 offset:3072
    ds_read_b64_tr_b16 a[6:7], v142 offset:3840
    ds_read_b64_tr_b16 a[28:29], v142 offset:3104
    ds_read_b64_tr_b16 a[30:31], v142 offset:3872
    ds_read_b64_tr_b16 a[52:53], v142 offset:3136
    ds_read_b64_tr_b16 a[54:55], v142 offset:3904
    v_cmp_ne_u32 vcc, v180, v255
    v_lshrrev_b32 v137, 8, v137
    v_mul_u32_u24 v127, 7, v137
    v_cndmask_b32 v142, 0, v254, vcc
    v_add_f32 v60, v60, v142
    v_cmp_ne_u32 vcc, v180, v192
    v_sub_u32 v127, v121, v127
    v_lshrrev_b32 v137, 2, v137
    buffer_load_dwordx4 v136, s[48:51], 0 offen offset:1024 lds
    v_cndmask_b32 v121, 0, v254, vcc
    v_add_f32 v72, v72, v121
    v_lshrrev_b32 v127, 2, v127
    v_and_b32 v137, s5, v137
    v_and_b32 v127, s6, v127
    v_lshl_or_b32 v137, v137, 1, v127
    v_cmp_ne_u32 vcc, v137, v191
    v_lshl_add_u32 v121, v119, 2, 16
    v_mul_u32_u24 v127, 37, v121
    v_cndmask_b32 v142, 0, v254, vcc
    v_add_f32 v49, v49, v142
    v_cmp_ne_u32 vcc, v137, v255
    v_lshrrev_b32 v127, 8, v127
    v_mul_u32_u24 v142, 7, v127
    v_cndmask_b32 v180, 0, v254, vcc
    buffer_load_dwordx4 v138, s[48:51], 0 offen offset:2048 lds
    s_add_u32 s48, s48, 36864
    s_addc_u32 s49, s49, 0
    s_add_u32 m0, s69, 3072
    v_add_f32 v61, v61, v180
    v_cmp_ne_u32 vcc, v137, v192
    v_sub_u32 v142, v121, v142
    v_lshrrev_b32 v127, 2, v127
    v_cndmask_b32 v121, 0, v254, vcc
    v_add_f32 v73, v73, v121
    v_lshrrev_b32 v142, 2, v142
    v_and_b32 v127, s5, v127
    v_and_b32 v142, s6, v142
    v_lshl_or_b32 v127, v127, 1, v142
    v_cmp_ne_u32 vcc, v127, v191
    v_lshl_add_u32 v137, v119, 2, 17
    buffer_load_dwordx4 v134, s[48:51], 0 offen lds
    s_waitcnt vmcnt(7)
    ds_read_b64_tr_b16 a[8:9], v128 offset:0
    ds_read_b64_tr_b16 a[10:11], v128 offset:768
    ds_read_b64_tr_b16 a[32:33], v128 offset:32
    ds_read_b64_tr_b16 a[34:35], v128 offset:800
    ds_read_b64_tr_b16 a[56:57], v128 offset:64
    ds_read_b64_tr_b16 a[58:59], v128 offset:832
    v_cndmask_b32 v121, 0, v254, vcc
    v_add_f32 v50, v50, v121
    v_cmp_ne_u32 vcc, v127, v255
    v_mul_u32_u24 v121, 37, v137
    v_lshrrev_b32 v121, 8, v121
    v_cndmask_b32 v129, 0, v254, vcc
    v_add_f32 v62, v62, v129
    v_cmp_ne_u32 vcc, v127, v192
    buffer_load_dwordx4 v136, s[48:51], 0 offen offset:1024 lds
    v_mul_u32_u24 v180, 7, v121
    v_cndmask_b32 v142, 0, v254, vcc
    v_add_f32 v74, v74, v142
    v_sub_u32 v180, v137, v180
    v_lshrrev_b32 v121, 2, v121
    v_lshrrev_b32 v180, 2, v180
    v_and_b32 v121, s5, v121
    v_and_b32 v180, s6, v180
    v_lshl_or_b32 v121, v121, 1, v180
    v_cmp_ne_u32 vcc, v121, v191
    v_lshl_add_u32 v180, v119, 2, 18
    v_mul_u32_u24 v142, 37, v180
    v_cndmask_b32 v137, 0, v254, vcc
    v_add_f32 v51, v51, v137
    v_cmp_ne_u32 vcc, v121, v255
    buffer_load_dwordx4 v138, s[48:51], 0 offen offset:2048 lds
    s_sub_u32 s48, s48, 183552
    s_subb_u32 s49, s49, 0
    s_add_u32 m0, s68, 0
    s_waitcnt lgkmcnt(0)
    v_cndmask_b32 v137, 0, v254, vcc
    v_add_f32 v63, v63, v137
    v_cmp_ne_u32 vcc, v121, v192
    v_lshrrev_b32 v142, 8, v142
    v_mul_u32_u24 v137, 7, v142
    v_cndmask_b32 v121, 0, v254, vcc
    v_add_f32 v75, v75, v121
    v_sub_u32 v137, v180, v137
    v_lshrrev_b32 v142, 2, v142
    v_lshrrev_b32 v137, 2, v137
    v_and_b32 v142, s5, v142
    buffer_load_dwordx4 v134, s[48:51], 0 offen lds
    s_waitcnt vmcnt(7)
    ds_read_b64_tr_b16 a[12:13], v128 offset:3072
    ds_read_b64_tr_b16 a[14:15], v128 offset:3840
    ds_read_b64_tr_b16 a[36:37], v128 offset:3104
    ds_read_b64_tr_b16 a[38:39], v128 offset:3872
    ds_read_b64_tr_b16 a[60:61], v128 offset:3136
    ds_read_b64_tr_b16 a[62:63], v128 offset:3904
    v_and_b32 v137, s6, v137
    v_lshl_or_b32 v142, v142, 1, v137
    v_cmp_ne_u32 vcc, v142, v191
    v_lshl_add_u32 v137, v119, 2, 19
    v_mul_u32_u24 v180, 37, v137
    v_cndmask_b32 v121, 0, v254, vcc
    v_add_f32 v52, v52, v121
    v_cmp_ne_u32 vcc, v142, v255
    buffer_load_dwordx4 v136, s[48:51], 0 offen offset:1024 lds
    v_lshrrev_b32 v180, 8, v180
    v_cndmask_b32 v121, 0, v254, vcc
    v_add_f32 v64, v64, v121
    v_cmp_ne_u32 vcc, v142, v192
    v_mul_u32_u24 v121, 7, v180
    v_sub_u32 v121, v137, v121
    v_cndmask_b32 v137, 0, v254, vcc
    v_add_f32 v76, v76, v137
    v_lshrrev_b32 v180, 2, v180
    v_lshrrev_b32 v121, 2, v121
    v_and_b32 v180, s5, v180
    v_and_b32 v121, s6, v121
    v_lshl_or_b32 v180, v180, 1, v121
    v_cmp_ne_u32 vcc, v180, v191
    v_lshl_add_u32 v121, v119, 2, 32
    buffer_load_dwordx4 v138, s[48:51], 0 offen offset:2048 lds
    s_add_u32 s48, s48, 36864
    s_addc_u32 s49, s49, 0
    s_add_u32 m0, s68, 3072
    s_waitcnt lgkmcnt(0)
    v_cndmask_b32 v137, 0, v254, vcc
    v_add_f32 v53, v53, v137
    v_cmp_ne_u32 vcc, v180, v255
    v_mul_u32_u24 v137, 37, v121
    v_lshrrev_b32 v137, 8, v137
    v_cndmask_b32 v142, 0, v254, vcc
    v_add_f32 v65, v65, v142
    v_cmp_ne_u32 vcc, v180, v192
    v_mul_u32_u24 v142, 7, v137
    v_sub_u32 v142, v121, v142
    v_cndmask_b32 v121, 0, v254, vcc
    buffer_load_dwordx4 v134, s[48:51], 0 offen lds
    s_waitcnt vmcnt(7)
    ds_read_b64_tr_b16 a[16:17], v126 offset:0
    ds_read_b64_tr_b16 a[18:19], v126 offset:768
    ds_read_b64_tr_b16 a[40:41], v126 offset:32
    ds_read_b64_tr_b16 a[42:43], v126 offset:800
    ds_read_b64_tr_b16 a[64:65], v126 offset:64
    ds_read_b64_tr_b16 a[66:67], v126 offset:832
    v_add_f32 v77, v77, v121
    v_lshrrev_b32 v137, 2, v137
    v_lshrrev_b32 v142, 2, v142
    v_and_b32 v137, s5, v137
    v_and_b32 v142, s6, v142
    v_lshl_or_b32 v137, v137, 1, v142
    v_cmp_ne_u32 vcc, v137, v191
    v_lshl_add_u32 v121, v119, 2, 33
    buffer_load_dwordx4 v136, s[48:51], 0 offen offset:1024 lds
    v_cndmask_b32 v142, 0, v254, vcc
    v_add_f32 v54, v54, v142
    v_cmp_ne_u32 vcc, v137, v255
    v_mul_u32_u24 v142, 37, v121
    v_lshrrev_b32 v142, 8, v142
    v_cndmask_b32 v180, 0, v254, vcc
    v_add_f32 v66, v66, v180
    v_cmp_ne_u32 vcc, v137, v192
    v_mul_u32_u24 v137, 7, v142
    v_sub_u32 v137, v121, v137
    v_cndmask_b32 v121, 0, v254, vcc
    v_add_f32 v78, v78, v121
    v_lshrrev_b32 v142, 2, v142
    v_lshrrev_b32 v137, 2, v137
    v_and_b32 v142, s5, v142
    buffer_load_dwordx4 v138, s[48:51], 0 offen offset:2048 lds
    s_add_u32 s48, s48, 36864
    s_addc_u32 s49, s49, 0
    s_add_u32 m0, s69, 0
    s_waitcnt lgkmcnt(0)
    v_and_b32 v137, s6, v137
    v_lshl_or_b32 v142, v142, 1, v137
    v_cmp_ne_u32 vcc, v142, v191
    v_lshl_add_u32 v121, v119, 2, 34
    v_mul_u32_u24 v127, 37, v121
    v_cndmask_b32 v129, 0, v254, vcc
    v_add_f32 v55, v55, v129
    v_cmp_ne_u32 vcc, v142, v255
    v_lshrrev_b32 v127, 8, v127
    v_mul_u32_u24 v137, 7, v127
    v_cndmask_b32 v180, 0, v254, vcc
    buffer_load_dwordx4 v134, s[48:51], 0 offen lds
    s_waitcnt vmcnt(7)
    ds_read_b64_tr_b16 a[20:21], v126 offset:3072
    ds_read_b64_tr_b16 a[22:23], v126 offset:3840
    ds_read_b64_tr_b16 a[44:45], v126 offset:3104
    ds_read_b64_tr_b16 a[46:47], v126 offset:3872
    ds_read_b64_tr_b16 a[68:69], v126 offset:3136
    ds_read_b64_tr_b16 a[70:71], v126 offset:3904
    v_add_f32 v67, v67, v180
    v_cmp_ne_u32 vcc, v142, v192
    v_sub_u32 v137, v121, v137
    v_lshrrev_b32 v127, 2, v127
    v_cndmask_b32 v121, 0, v254, vcc
    v_add_f32 v79, v79, v121
    v_lshrrev_b32 v137, 2, v137
    v_and_b32 v127, s5, v127
    buffer_load_dwordx4 v136, s[48:51], 0 offen offset:1024 lds
    v_and_b32 v137, s6, v137
    v_lshl_or_b32 v127, v127, 1, v137
    v_cmp_ne_u32 vcc, v127, v191
    v_lshl_add_u32 v121, v119, 2, 35
    v_mul_u32_u24 v142, 37, v121
    v_cndmask_b32 v129, 0, v254, vcc
    v_add_f32 v56, v56, v129
    v_cmp_ne_u32 vcc, v127, v255
    v_lshrrev_b32 v142, 8, v142
    v_mul_u32_u24 v137, 7, v142
    v_cndmask_b32 v129, 0, v254, vcc
    v_add_f32 v68, v68, v129
    v_cmp_ne_u32 vcc, v127, v192
    v_sub_u32 v137, v121, v137
    v_lshrrev_b32 v142, 2, v142
    buffer_load_dwordx4 v138, s[48:51], 0 offen offset:2048 lds
    s_add_u32 s48, s48, 36864
    s_addc_u32 s49, s49, 0
    s_add_u32 m0, s69, 3072
    s_waitcnt lgkmcnt(0)
    v_cndmask_b32 v121, 0, v254, vcc
    v_add_f32 v80, v80, v121
    v_lshrrev_b32 v137, 2, v137
    v_and_b32 v142, s5, v142
    v_and_b32 v137, s6, v137
    v_lshl_or_b32 v142, v142, 1, v137
    v_cmp_ne_u32 vcc, v142, v191
    v_cndmask_b32 v22, v159, v22, s[88:89]
    v_cndmask_b32 v24, v159, v24, s[88:89]
    v_cndmask_b32 v121, 0, v254, vcc
    v_add_f32 v57, v57, v121
    buffer_load_dwordx4 v134, s[48:51], 0 offen lds
    s_waitcnt vmcnt(7)
    ds_read_b64_tr_b16 a[144:145], v128 offset:0
    ds_read_b64_tr_b16 a[146:147], v128 offset:768
    ds_read_b64_tr_b16 a[168:169], v128 offset:32
    ds_read_b64_tr_b16 a[170:171], v128 offset:800
    ds_read_b64_tr_b16 a[192:193], v128 offset:64
    ds_read_b64_tr_b16 a[194:195], v128 offset:832
    v_cmp_ne_u32 vcc, v142, v255
    v_cndmask_b32 v26, v159, v26, s[88:89]
    v_lshl_add_u32 v255, v119, 3, v135
    v_cndmask_b32 v180, 0, v254, vcc
    v_add_f32 v69, v69, v180
    v_cmp_ne_u32 vcc, v142, v192
    v_add3_u32 v255, v255, 64, s69
    v_mov_b32 v122, 0
    buffer_load_dwordx4 v136, s[48:51], 0 offen offset:1024 lds
    v_cndmask_b32 v142, 0, v254, vcc
    v_add_f32 v81, v81, v142
    ds_read_b128 v[166:169], v179 offset:0
    ds_read_b128 v[114:117], v178 offset:0
    ds_read_b128 v[174:177], v179 offset:128
    ds_read_b128 v[130:133], v178 offset:128
    ds_read_b128 v[170:173], v179 offset:256
    ds_read_b128 v[154:157], v178 offset:256
    buffer_load_dwordx4 v138, s[48:51], 0 offen offset:2048 lds
    s_add_u32 s48, s48, 36864
    s_addc_u32 s49, s49, 0
    s_add_u32 m0, s68, 0
    s_waitcnt lgkmcnt(6)
    v_mov_b32 v123, 0
    v_mov_b32 v124, 0
    v_mov_b32 v125, 0
    ds_write_b128 v188, v[122:125] offset:16
    s_waitcnt lgkmcnt(5)
    s_waitcnt vmcnt(6)
    v_mfma_f32_16x16x32_bf16 v[182:185], a[72:75], v[166:169], 0
    s_waitcnt lgkmcnt(4)
    buffer_load_dwordx4 v134, s[48:51], 0 offen lds
    v_mfma_f32_16x16x32_bf16 v[182:185], a[76:79], v[114:117], v[182:185]
    s_waitcnt lgkmcnt(3)
    v_mfma_f32_16x16x32_bf16 v[182:185], a[80:83], v[174:177], v[182:185]
    s_waitcnt lgkmcnt(2)
    ds_read_b64_tr_b16 a[148:149], v128 offset:3072
    ds_read_b64_tr_b16 a[150:151], v128 offset:3840
    v_mfma_f32_16x16x32_bf16 v[182:185], a[84:87], v[130:133], v[182:185]
    s_waitcnt lgkmcnt(3)
    ds_read_b64_tr_b16 a[172:173], v128 offset:3104
    ds_read_b64_tr_b16 a[174:175], v128 offset:3872
    v_mfma_f32_16x16x32_bf16 v[182:185], a[88:91], v[170:173], v[182:185]
    ds_read_b64_tr_b16 a[196:197], v128 offset:3136
    ds_read_b64_tr_b16 a[198:199], v128 offset:3904
    v_mfma_f32_16x16x32_bf16 v[182:185], a[92:95], v[154:157], v[182:185]
    buffer_load_dwordx4 v136, s[48:51], 0 offen offset:1024 lds
    v_mfma_f32_16x16x32_bf16 v[146:149], a[96:99], v[166:169], 0
    ds_write_b64 v188, v[122:123] offset:56
    v_mfma_f32_16x16x32_bf16 v[146:149], a[100:103], v[114:117], v[146:149]
    v_mfma_f32_16x16x32_bf16 v[146:149], a[104:107], v[174:177], v[146:149]
    ds_write_b64 v188, v[122:123] offset:64
    v_mfma_f32_16x16x32_bf16 v[146:149], a[108:111], v[130:133], v[146:149]
    s_waitcnt lgkmcnt(6)
    buffer_load_dwordx4 v138, s[48:51], 0 offen offset:2048 lds
    v_fma_f32 v142, v182, v182, s32
    v_mfma_f32_16x16x32_bf16 v[146:149], a[112:115], v[170:173], v[146:149]
    s_add_u32 s48, s48, 36864
    ds_read_b128 v[210:213], v179 offset:6144
    ds_read_b128 v[226:229], v178 offset:6144
    v_mfma_f32_16x16x32_bf16 v[146:149], a[116:119], v[154:157], v[146:149]
    s_addc_u32 s49, s49, 0
    ds_read_b128 v[218:221], v179 offset:6272
    v_fmac_f32 v142, v183, v183
    v_mfma_f32_16x16x32_bf16 v[198:201], a[120:123], v[166:169], 0
    s_add_u32 m0, s68, 3072
    ds_read_b128 v[206:209], v178 offset:6272
    s_waitcnt vmcnt(6)
    v_mfma_f32_16x16x32_bf16 v[198:201], a[124:127], v[114:117], v[198:201]
    s_waitcnt lgkmcnt(5)
    ds_read_b64_tr_b16 a[152:153], v126 offset:0
    ds_read_b64_tr_b16 a[154:155], v126 offset:768
    v_mfma_f32_16x16x32_bf16 v[198:201], a[128:131], v[174:177], v[198:201]
    buffer_load_dwordx4 v134, s[48:51], 0 offen lds
    ds_read_b64_tr_b16 a[176:177], v126 offset:32
    v_mfma_f32_16x16x32_bf16 v[198:201], a[132:135], v[130:133], v[198:201]
    ds_read_b64_tr_b16 a[178:179], v126 offset:800
    ds_read_b64_tr_b16 a[200:201], v126 offset:64
    v_mfma_f32_16x16x32_bf16 v[198:201], a[136:139], v[170:173], v[198:201]
    ds_read_b64_tr_b16 a[202:203], v126 offset:832
    ds_read_b128 v[230:233], v179 offset:6400
    v_mfma_f32_16x16x32_bf16 v[198:201], a[140:143], v[154:157], v[198:201]
    ds_read_b128 v[202:205], v178 offset:6400
    v_fmac_f32 v142, v184, v184
    v_mfma_f32_16x16x32_bf16 v[214:217], a[0:3], v[166:169], 0
    s_waitcnt lgkmcnt(10)
    ds_write_b128 v181, v[122:125] offset:16
    v_mfma_f32_16x16x32_bf16 v[194:197], a[72:75], v[210:213], 0
    s_waitcnt lgkmcnt(9)
    buffer_load_dwordx4 v136, s[48:51], 0 offen offset:1024 lds
    v_fmac_f32 v142, v185, v185
    v_mfma_f32_16x16x32_bf16 v[194:197], a[76:79], v[226:229], v[194:197]
    s_waitcnt lgkmcnt(7)
    v_fmac_f32 v142, v146, v146
    v_fmac_f32 v142, v147, v147
    v_mfma_f32_16x16x32_bf16 v[194:197], a[80:83], v[218:221], v[194:197]
    s_waitcnt lgkmcnt(6)
    ds_write_b64 v181, v[122:123] offset:56
    v_mfma_f32_16x16x32_bf16 v[194:197], a[84:87], v[206:209], v[194:197]
    s_waitcnt lgkmcnt(5)
    v_fmac_f32 v142, v148, v148
    v_fmac_f32 v142, v149, v149
    v_mfma_f32_16x16x32_bf16 v[134:137], a[96:99], v[210:213], 0
    s_waitcnt lgkmcnt(3)
    ds_write_b64 v181, v[122:123] offset:64
    v_mfma_f32_16x16x32_bf16 v[194:197], a[88:91], v[230:233], v[194:197]
    s_waitcnt lgkmcnt(2)
    buffer_load_dwordx4 v138, s[48:51], 0 offen offset:2048 lds
    v_fmac_f32 v142, v198, v198
    v_mfma_f32_16x16x32_bf16 v[194:197], a[92:95], v[202:205], v[194:197]
    s_waitcnt vmcnt(6)
    ds_read_b64_tr_b16 a[156:157], v126 offset:3072
    ds_read_b64_tr_b16 a[158:159], v126 offset:3840
    v_mfma_f32_16x16x32_bf16 v[134:137], a[100:103], v[226:229], v[134:137]
    s_add_u32 m0, s28, 8192
    ds_read_b64_tr_b16 a[180:181], v126 offset:3104
    ds_read_b64_tr_b16 a[182:183], v126 offset:3872
    v_mfma_f32_16x16x32_bf16 v[134:137], a[104:107], v[218:221], v[134:137]
    ds_read_b64_tr_b16 a[204:205], v126 offset:3136
    ds_read_b64_tr_b16 a[206:207], v126 offset:3904
    v_mfma_f32_16x16x32_bf16 v[134:137], a[108:111], v[206:209], v[134:137]
    v_fmac_f32 v142, v199, v199
    v_fmac_f32 v142, v200, v200
    v_mfma_f32_16x16x32_bf16 v[134:137], a[112:115], v[230:233], v[134:137]
    buffer_load_dwordx4 v12, s[8:11], s25 offen nt lds
    v_mfma_f32_16x16x32_bf16 v[134:137], a[116:119], v[202:205], v[134:137]
    s_add_u32 m0, s28, 12288
    v_fmac_f32 v142, v201, v201
    v_fma_f32 v180, v194, v194, s32
    v_mfma_f32_16x16x32_bf16 v[138:141], a[120:123], v[210:213], 0
    v_fmac_f32 v180, v195, v195
    v_fmac_f32 v180, v196, v196
    v_mfma_f32_16x16x32_bf16 v[138:141], a[124:127], v[226:229], v[138:141]
    v_fmac_f32 v180, v197, v197
    v_fmac_f32 v180, v134, v134
    v_mfma_f32_16x16x32_bf16 v[138:141], a[128:131], v[218:221], v[138:141]
    s_waitcnt lgkmcnt(4)
    v_fmac_f32 v180, v135, v135
    v_fmac_f32 v180, v136, v136
    v_mfma_f32_16x16x32_bf16 v[138:141], a[132:135], v[206:209], v[138:141]
    s_waitcnt lgkmcnt(2)
    buffer_load_dwordx4 v13, s[8:11], s25 offen nt lds
    v_mfma_f32_16x16x32_bf16 v[138:141], a[136:139], v[230:233], v[138:141]
    s_add_u32 m0, s29, 0
    v_fmac_f32 v180, v137, v137
    v_mfma_f32_16x16x32_bf16 v[138:141], a[140:143], v[202:205], v[138:141]
    s_waitcnt lgkmcnt(0)
    v_mfma_f32_16x16x32_bf16 v[214:217], a[4:7], v[114:117], v[214:217]
    v_mfma_f32_16x16x32_bf16 v[214:217], a[8:11], v[174:177], v[214:217]
    v_mfma_f32_16x16x32_bf16 v[214:217], a[12:15], v[130:133], v[214:217]
    buffer_load_dwordx4 v14, s[8:11], s25 offen nt lds
    s_waitcnt vmcnt(6)
    v_mfma_f32_16x16x32_bf16 v[214:217], a[16:19], v[170:173], v[214:217]
    s_add_u32 m0, s69, 0
    ds_read_b64_tr_b16 a[160:161], v128 offset:0
    ds_read_b64_tr_b16 a[162:163], v128 offset:768
    v_mfma_f32_16x16x32_bf16 v[214:217], a[20:23], v[154:157], v[214:217]
    s_cmp_lt_u32 1, s17
    ds_read_b64_tr_b16 a[184:185], v128 offset:32
    ds_read_b64_tr_b16 a[186:187], v128 offset:800
    v_mfma_f32_16x16x32_bf16 v[234:237], a[24:27], v[166:169], 0
    s_cselect_b32 s10, s36, 0
    ds_read_b64_tr_b16 a[208:209], v128 offset:64
    ds_read_b64_tr_b16 a[210:211], v128 offset:832
    v_mfma_f32_16x16x32_bf16 v[234:237], a[28:31], v[114:117], v[234:237]
    s_mov_b32 s25, s24
    v_fmac_f32 v180, v138, v138
    v_fmac_f32 v180, v139, v139
    v_mfma_f32_16x16x32_bf16 v[234:237], a[32:35], v[174:177], v[234:237]
    buffer_load_dwordx4 v143, s[52:55], 0 offen lds
    v_fmac_f32 v180, v140, v140
    v_mfma_f32_16x16x32_bf16 v[234:237], a[36:39], v[130:133], v[234:237]
    v_fmac_f32 v180, v141, v141
    v_fma_f32 v254, v214, v214, s32
    v_mfma_f32_16x16x32_bf16 v[234:237], a[40:43], v[170:173], v[234:237]
    v_fmac_f32 v254, v215, v215
    v_fmac_f32 v254, v216, v216
    v_mfma_f32_16x16x32_bf16 v[234:237], a[44:47], v[154:157], v[234:237]
    v_fmac_f32 v254, v217, v217
    v_xor_b32 v121, 65536, v2
    v_mfma_f32_16x16x32_bf16 v[222:225], a[48:51], v[166:169], 0
    s_waitcnt lgkmcnt(4)
    v_lshrrev_b32 v150, 2, v121
    v_lshrrev_b32 v119, 8, v121
    v_mfma_f32_16x16x32_bf16 v[222:225], a[52:55], v[114:117], v[222:225]
    s_waitcnt lgkmcnt(2)
    buffer_load_dwordx4 v118, s[52:55], 0 offen offset:1024 lds
    v_fmac_f32 v254, v234, v234
    v_mfma_f32_16x16x32_bf16 v[222:225], a[56:59], v[174:177], v[222:225]
    s_waitcnt lgkmcnt(0)
    v_fmac_f32 v254, v235, v235
    v_fmac_f32 v254, v236, v236
    v_mfma_f32_16x16x32_bf16 v[222:225], a[60:63], v[130:133], v[222:225]
    v_fmac_f32 v254, v237, v237
    v_add_u32 v121, 157184, v121
    v_mfma_f32_16x16x32_bf16 v[222:225], a[64:67], v[170:173], v[222:225]
    v_lshl_add_u32 v152, s16, 2, v121
    v_add_u32 v150, 162048, v150
    v_mfma_f32_16x16x32_bf16 v[222:225], a[68:71], v[154:157], v[222:225]
    v_lshlrev_b32 v119, 4, v119
    v_add_u32 v119, 162048, v119
    v_mfma_f32_16x16x32_bf16 v[154:157], a[0:3], v[210:213], 0
    buffer_load_dwordx4 v151, s[52:55], 0 offen offset:2048 lds
    v_or_b32 v130, v32, v33
    v_mfma_f32_16x16x32_bf16 v[154:157], a[4:7], v[226:229], v[154:157]
    s_add_u32 s52, s52, 12288
    s_waitcnt vmcnt(6)
    ds_read_b64_tr_b16 a[164:165], v128 offset:3072
    v_mfma_f32_16x16x32_bf16 v[154:157], a[8:11], v[218:221], v[154:157]
    s_addc_u32 s53, s53, 0
    ds_read_b64_tr_b16 a[166:167], v128 offset:3840
    ds_read_b64_tr_b16 a[188:189], v128 offset:3104
    v_mfma_f32_16x16x32_bf16 v[154:157], a[12:15], v[206:209], v[154:157]
    s_add_u32 m0, s69, 3072
    ds_read_b64_tr_b16 a[190:191], v128 offset:3872
    ds_read_b64_tr_b16 a[212:213], v128 offset:3136
    v_mfma_f32_16x16x32_bf16 v[154:157], a[16:19], v[230:233], v[154:157]
    ds_read_b64_tr_b16 a[214:215], v128 offset:3904
    v_fmac_f32 v254, v222, v222
    v_mfma_f32_16x16x32_bf16 v[154:157], a[20:23], v[202:205], v[154:157]
    buffer_load_dwordx4 v143, s[52:55], 0 offen lds
    v_fmac_f32 v254, v223, v223
    v_mfma_f32_16x16x32_bf16 v[238:241], a[24:27], v[210:213], 0
    v_fmac_f32 v254, v224, v224
    v_fmac_f32 v254, v225, v225
    v_mfma_f32_16x16x32_bf16 v[238:241], a[28:31], v[226:229], v[238:241]
    v_cvt_pk_bf16_f32 v36, v254, v142
    v_and_b32 v130, 0xffff, v130
    v_mfma_f32_16x16x32_bf16 v[238:241], a[32:35], v[218:221], v[238:241]
    v_lshl_or_b32 v130, v130, 16, v130
    v_or_b32 v131, v32, v33
    v_mfma_f32_16x16x32_bf16 v[242:245], v[32:35], v[36:39], 0
    s_waitcnt lgkmcnt(5)
    v_and_b32 v131, 0xffff, v131
    v_lshl_or_b32 v131, v131, 16, v131
    v_mfma_f32_16x16x32_bf16 v[238:241], a[36:39], v[206:209], v[238:241]
    s_waitcnt lgkmcnt(3)
    buffer_load_dwordx4 v118, s[52:55], 0 offen offset:1024 lds
    ds_read_b128 v[170:173], v0 offset:20480
    v_mfma_f32_16x16x32_bf16 v[238:241], a[40:43], v[230:233], v[238:241]
    s_waitcnt lgkmcnt(2)
    ds_read_b128 v[166:169], v1 offset:20480
    v_or_b32 v132, v32, v33
    v_mfma_f32_16x16x32_bf16 v[238:241], a[44:47], v[202:205], v[238:241]
    s_waitcnt lgkmcnt(2)
    ds_read_b128 v[162:165], v0 offset:20608
    v_lshrrev_b32 v132, 16, v132
    v_mfma_f32_16x16x32_bf16 v[246:249], a[48:51], v[210:213], 0
    ds_read_b128 v[210:213], v1 offset:20608
    v_lshl_or_b32 v132, v132, 16, v132
    v_mfma_f32_16x16x32_bf16 v[246:249], a[52:55], v[226:229], v[246:249]
    ds_read_b128 v[226:229], v0 offset:20736
    v_or_b32 v133, v32, v33
    v_mfma_f32_16x16x32_bf16 v[246:249], a[56:59], v[218:221], v[246:249]
    buffer_load_dwordx4 v151, s[52:55], 0 offen offset:2048 lds
    ds_read_b128 v[218:221], v1 offset:20736
    v_mfma_f32_16x16x32_bf16 v[246:249], a[60:63], v[206:209], v[246:249]
    s_add_u32 s52, s52, 12288
    v_rsq_f32 v243, v243
    v_mfma_f32_16x16x32_bf16 v[246:249], a[64:67], v[230:233], v[246:249]
    s_addc_u32 s53, s53, 0
    v_rsq_f32 v242, v242
    v_mfma_f32_16x16x32_bf16 v[246:249], a[68:71], v[202:205], v[246:249]
    s_waitcnt lgkmcnt(5)
    v_mul_f32 v242, s31, v242
    v_mul_f32 v182, v243, v182
    v_mfma_f32_16x16x32_bf16 v[122:125], a[96:99], v[170:173], 0
    s_waitcnt lgkmcnt(4)
    v_mul_f32 v183, v243, v183
    v_cvt_pk_f16_f32 v114, v182, v183
    v_mfma_f32_16x16x32_bf16 v[122:125], a[100:103], v[166:169], v[122:125]
    s_waitcnt lgkmcnt(3)
    v_mul_f32 v184, v243, v184
    v_mul_f32 v185, v243, v185
    v_mfma_f32_16x16x32_bf16 v[122:125], a[104:107], v[162:165], v[122:125]
    s_waitcnt lgkmcnt(2)
    v_cvt_pk_f16_f32 v115, v184, v185
    v_mul_f32 v146, v243, v146
    v_mfma_f32_16x16x32_bf16 v[122:125], a[108:111], v[210:213], v[122:125]
    s_waitcnt lgkmcnt(1)
    v_mul_f32 v147, v243, v147
    v_cvt_pk_f16_f32 v116, v146, v147
    v_mfma_f32_16x16x32_bf16 v[122:125], a[112:115], v[226:229], v[122:125]
    s_waitcnt lgkmcnt(0)
    v_mul_f32 v148, v243, v148
    v_mul_f32 v149, v243, v149
    v_mfma_f32_16x16x32_bf16 v[122:125], a[116:119], v[218:221], v[122:125]
    s_add_u32 m0, s68, 0
    v_cvt_pk_f16_f32 v117, v148, v149
    v_mul_f32 v198, v243, v198
    v_mfma_f32_16x16x32_bf16 v[126:129], a[120:123], v[170:173], 0
    buffer_load_dwordx4 v143, s[52:55], 0 offen lds
    v_mul_f32 v199, v243, v199
    v_mfma_f32_16x16x32_bf16 v[126:129], a[124:127], v[166:169], v[126:129]
    ds_write_b128 v188, v[114:117]
    v_mfma_f32_16x16x32_bf16 v[126:129], a[128:131], v[162:165], v[126:129]
    v_cvt_pk_f16_f32 v232, v198, v199
    v_mul_f32 v200, v243, v200
    v_mfma_f32_16x16x32_bf16 v[126:129], a[132:135], v[210:213], v[126:129]
    v_mul_f32 v201, v243, v201
    v_cvt_pk_f16_f32 v233, v200, v201
    v_mfma_f32_16x16x32_bf16 v[126:129], a[136:139], v[226:229], v[126:129]
    ds_write_b64 v188, v[232:233] offset:48
    v_mfma_f32_16x16x32_bf16 v[126:129], a[140:143], v[218:221], v[126:129]
    v_mul_f32 v214, v242, v214
    v_mul_f32 v215, v242, v215
    v_mfma_f32_16x16x32_bf16 v[174:177], a[24:27], v[170:173], 0
    v_cvt_pk_f16_f32 v114, v214, v215
    v_mul_f32 v216, v242, v216
    v_mfma_f32_16x16x32_bf16 v[174:177], a[28:31], v[166:169], v[174:177]
    v_mul_f32 v217, v242, v217
    v_cvt_pk_f16_f32 v115, v216, v217
    v_mfma_f32_16x16x32_bf16 v[174:177], a[32:35], v[162:165], v[174:177]
    v_mul_f32 v234, v242, v234
    v_mul_f32 v235, v242, v235
    v_mfma_f32_16x16x32_bf16 v[174:177], a[36:39], v[210:213], v[174:177]
    v_cvt_pk_f16_f32 v116, v234, v235
    v_mul_f32 v236, v242, v236
    v_mfma_f32_16x16x32_bf16 v[174:177], a[40:43], v[226:229], v[174:177]
    v_mul_f32 v237, v242, v237
    v_cvt_pk_f16_f32 v117, v236, v237
    v_mfma_f32_16x16x32_bf16 v[174:177], a[44:47], v[218:221], v[174:177]
    ds_write_b128 v188, v[114:117] offset:32
    v_mfma_f32_16x16x32_bf16 v[114:117], a[72:75], v[170:173], 0
    v_mul_f32 v222, v242, v222
    v_mul_f32 v223, v242, v223
    v_mfma_f32_16x16x32_bf16 v[114:117], a[76:79], v[166:169], v[114:117]
    v_cvt_pk_f16_f32 v230, v222, v223
    v_mul_f32 v224, v242, v224
    v_mfma_f32_16x16x32_bf16 v[114:117], a[80:83], v[162:165], v[114:117]
    v_mul_f32 v225, v242, v225
    v_cvt_pk_f16_f32 v231, v224, v225
    v_mfma_f32_16x16x32_bf16 v[114:117], a[84:87], v[210:213], v[114:117]
    ds_write_b64 v188, v[230:231] offset:72
    v_mfma_f32_16x16x32_bf16 v[114:117], a[88:91], v[226:229], v[114:117]
    v_mul_f32 v214, v214, v182
    v_fmac_f32 v214, v215, v183
    v_mfma_f32_16x16x32_bf16 v[114:117], a[92:95], v[218:221], v[114:117]
    v_fmac_f32 v214, v216, v184
    v_fmac_f32 v214, v217, v185
    v_mfma_f32_16x16x32_bf16 v[182:185], a[48:51], v[170:173], 0
    v_fmac_f32 v214, v234, v146
    v_fmac_f32 v214, v235, v147
    v_mfma_f32_16x16x32_bf16 v[182:185], a[52:55], v[166:169], v[182:185]
    v_fmac_f32 v214, v236, v148
    v_fmac_f32 v214, v237, v149
    v_mfma_f32_16x16x32_bf16 v[182:185], a[56:59], v[162:165], v[182:185]
    v_fmac_f32 v214, v222, v198
    v_fmac_f32 v214, v223, v199
    v_mfma_f32_16x16x32_bf16 v[182:185], a[60:63], v[210:213], v[182:185]
    v_fmac_f32 v214, v224, v200
    v_fmac_f32 v214, v225, v201
    v_mfma_f32_16x16x32_bf16 v[182:185], a[64:67], v[226:229], v[182:185]
    v_mov_b32 v142, v214
    v_lshrrev_b32 v133, 16, v133
    v_mfma_f32_16x16x32_bf16 v[182:185], a[68:71], v[218:221], v[182:185]
    v_permlane32_swap_b32 v214, v142
    v_mfma_f32_16x16x32_bf16 v[230:233], v[170:173], a[144:147], 0
    v_add_f32 v214, v214, v142
    v_mov_b32 v142, v214
    v_mfma_f32_16x16x32_bf16 v[230:233], v[166:169], a[148:151], v[230:233]
    v_lshl_or_b32 v133, v133, 16, v133
    v_fma_f32 v254, v154, v154, s32
    v_mfma_f32_16x16x32_bf16 v[230:233], v[162:165], a[152:155], v[230:233]
    v_permlane16_swap_b32 v214, v142
    v_mfma_f32_16x16x32_bf16 v[230:233], v[210:213], a[156:159], v[230:233]
    v_add_f32 v214, v214, v142
    v_add_f32 v214, s39, v214
    v_mfma_f32_16x16x32_bf16 v[230:233], v[226:229], a[160:163], v[230:233]
    v_mov_b32 v215, v159
    v_mov_b32 v216, v159
    v_mfma_f32_16x16x32_bf16 v[230:233], v[218:221], a[164:167], v[230:233]
    v_mov_b32 v217, v159
    v_cndmask_b32 v214, v159, v214, s[88:89]
    v_mfma_f32_16x16x32_bf16 v[146:149], v[170:173], a[168:171], 0
    ds_write_b128 v187, v[214:217] offset:192
    v_mfma_f32_16x16x32_bf16 v[146:149], v[166:169], a[172:175], v[146:149]
    v_fmac_f32 v254, v155, v155
    v_fmac_f32 v254, v156, v156
    v_mfma_f32_16x16x32_bf16 v[146:149], v[162:165], a[176:179], v[146:149]
    v_fmac_f32 v254, v157, v157
    v_fmac_f32 v254, v238, v238
    v_mfma_f32_16x16x32_bf16 v[146:149], v[210:213], a[180:183], v[146:149]
    ds_read_b128 v[206:209], v179 offset:0
    v_fmac_f32 v254, v239, v239
    v_mfma_f32_16x16x32_bf16 v[146:149], v[226:229], a[184:187], v[146:149]
    ds_read_b128 v[214:217], v178 offset:0
    v_fmac_f32 v254, v240, v240
    v_mfma_f32_16x16x32_bf16 v[146:149], v[218:221], a[188:191], v[146:149]
    ds_read_b128 v[198:201], v179 offset:128
    v_fmac_f32 v254, v241, v241
    v_fmac_f32 v254, v246, v246
    v_fmac_f32 v254, v247, v247
    v_fmac_f32 v254, v248, v248
    v_fmac_f32 v254, v249, v249
    v_cvt_pk_bf16_f32 v36, v254, v180
    v_mfma_f32_16x16x32_bf16 v[234:237], v[170:173], a[192:195], 0
    v_fma_f32 v142, v114, v114, s32
    v_fmac_f32 v142, v115, v115
    v_mfma_f32_16x16x32_bf16 v[234:237], v[166:169], a[196:199], v[234:237]
    v_fmac_f32 v142, v116, v116
    v_fmac_f32 v142, v117, v117
    v_mfma_f32_16x16x32_bf16 v[234:237], v[162:165], a[200:203], v[234:237]
    v_fmac_f32 v142, v122, v122
    v_fmac_f32 v142, v123, v123
    v_mfma_f32_16x16x32_bf16 v[234:237], v[210:213], a[204:207], v[234:237]
    s_waitcnt lgkmcnt(2)
    v_fmac_f32 v142, v124, v124
    v_fmac_f32 v142, v125, v125
    v_mfma_f32_16x16x32_bf16 v[234:237], v[226:229], a[208:211], v[234:237]
    s_waitcnt lgkmcnt(1)
    v_fmac_f32 v142, v126, v126
    v_fmac_f32 v142, v127, v127
    v_mfma_f32_16x16x32_bf16 v[234:237], v[218:221], a[212:215], v[234:237]
    v_fmac_f32 v142, v128, v128
    v_fmac_f32 v142, v129, v129
    v_cvt_pk_bf16_f32 v202, v230, v231
    v_cvt_pk_bf16_f32 v203, v232, v233
    v_cvt_pk_bf16_f32 v146, v146, v147
    v_cvt_pk_bf16_f32 v147, v148, v149
    v_xor_b32 v2, 65536, v2
    s_nop 0
    v_cvt_pk_bf16_f32 v222, v234, v235
    v_mfma_f32_16x16x32_bf16 v[230:233], v[32:35], v[36:39], 0
    v_cvt_pk_bf16_f32 v223, v236, v237
    s_nop 0
    s_nop 0
    s_nop 0
    s_nop 0
    s_nop 0
    s_nop 0
    s_nop 0
    v_rsq_f32 v231, v231
    v_rsq_f32 v230, v230
    v_mul_f32 v194, v231, v194
    v_mul_f32 v230, s31, v230
    v_mul_f32 v195, v231, v195
    v_cvt_pk_f16_f32 v234, v194, v195
    v_mul_f32 v196, v231, v196
    v_mul_f32 v197, v231, v197
    v_cvt_pk_f16_f32 v235, v196, v197
    v_mul_f32 v134, v231, v134
    v_mul_f32 v135, v231, v135
    v_cvt_pk_f16_f32 v236, v134, v135
    v_mul_f32 v136, v231, v136
    v_mul_f32 v137, v231, v137
    v_cvt_pk_f16_f32 v237, v136, v137
    v_mul_f32 v138, v231, v138
    v_mul_f32 v139, v231, v139
    v_cvt_pk_f16_f32 v244, v138, v139
    v_mul_f32 v140, v231, v140
    v_mul_f32 v141, v231, v141
    v_cvt_pk_f16_f32 v245, v140, v141
    v_mul_f32 v154, v230, v154
    v_mul_f32 v155, v230, v155
    v_cvt_pk_f16_f32 v250, v154, v155
    v_mul_f32 v156, v230, v156
    v_mul_f32 v157, v230, v157
    v_cvt_pk_f16_f32 v251, v156, v157
    v_mul_f32 v238, v230, v238
    v_mul_f32 v239, v230, v239
    v_cvt_pk_f16_f32 v252, v238, v239
    v_mul_f32 v240, v230, v240
    v_mul_f32 v241, v230, v241
    v_cvt_pk_f16_f32 v253, v240, v241
    v_mul_f32 v246, v230, v246
    v_mul_f32 v247, v230, v247
    v_cvt_pk_f16_f32 v242, v246, v247
    v_mul_f32 v248, v230, v248
    v_mul_f32 v249, v230, v249
    v_cvt_pk_f16_f32 v243, v248, v249
    v_mul_f32 v194, v154, v194
    v_fmac_f32 v194, v155, v195
    v_fmac_f32 v194, v156, v196
    v_fmac_f32 v194, v157, v197
    v_fmac_f32 v194, v238, v134
    v_fmac_f32 v194, v239, v135
    v_mfma_f32_16x16x32_bf16 v[230:233], v[206:209], a[144:147], 0
    s_waitcnt lgkmcnt(0)
    ds_write_b128 v181, v[234:237]
    v_mfma_f32_16x16x32_bf16 v[154:157], a[0:3], v[170:173], 0
    buffer_load_dwordx4 v118, s[52:55], 0 offen offset:1024 lds
    v_fmac_f32 v194, v240, v136
    v_mfma_f32_16x16x32_bf16 v[154:157], a[4:7], v[166:169], v[154:157]
    v_fmac_f32 v194, v241, v137
    v_fmac_f32 v194, v246, v138
    v_mfma_f32_16x16x32_bf16 v[154:157], a[8:11], v[162:165], v[154:157]
    ds_read_b128 v[166:169], v178 offset:128
    ds_read_b128 v[134:137], v179 offset:256
    v_mfma_f32_16x16x32_bf16 v[154:157], a[12:15], v[210:213], v[154:157]
    ds_read_b128 v[170:173], v178 offset:256
    v_fmac_f32 v194, v247, v139
    v_mfma_f32_16x16x32_bf16 v[154:157], a[16:19], v[226:229], v[154:157]
    ds_write_b64 v181, v[244:245] offset:48
    v_mfma_f32_16x16x32_bf16 v[154:157], a[20:23], v[218:221], v[154:157]
    buffer_load_dwordx4 v151, s[52:55], 0 offen offset:2048 lds
    v_fmac_f32 v194, v248, v140
    v_mfma_f32_16x16x32_bf16 v[230:233], v[214:217], a[148:151], v[230:233]
    s_add_u32 s52, s52, 12288
    ds_write_b128 v181, v[250:253] offset:32
    v_mfma_f32_16x16x32_bf16 v[230:233], v[198:201], a[152:155], v[230:233]
    s_addc_u32 s53, s53, 0
    v_fmac_f32 v194, v249, v141
    v_mov_b32 v254, v194
    v_mfma_f32_16x16x32_bf16 v[210:213], v[206:209], a[168:171], 0
    s_add_u32 m0, s68, 3072
    v_permlane32_swap_b32 v194, v254
    v_mfma_f32_16x16x32_bf16 v[210:213], v[214:217], a[172:175], v[210:213]
    s_waitcnt lgkmcnt(3)
    buffer_load_dwordx4 v143, s[52:55], 0 offen lds
    v_add_f32 v194, v194, v254
    v_mfma_f32_16x16x32_bf16 v[230:233], v[166:169], a[156:159], v[230:233]
    s_waitcnt lgkmcnt(2)
    ds_write_b64 v181, v[242:243] offset:72
    v_mfma_f32_16x16x32_bf16 v[230:233], v[134:137], a[160:163], v[230:233]
    v_mov_b32 v254, v194
    v_fma_f32 v148, v154, v154, s32
    v_mfma_f32_16x16x32_bf16 v[230:233], v[170:173], a[164:167], v[230:233]
    v_permlane16_swap_b32 v194, v254
    v_mfma_f32_16x16x32_bf16 v[210:213], v[198:201], a[176:179], v[210:213]
    v_add_f32 v194, v194, v254
    v_add_f32 v194, s39, v194
    v_mfma_f32_16x16x32_bf16 v[210:213], v[166:169], a[180:183], v[210:213]
    buffer_load_dwordx4 v118, s[52:55], 0 offen offset:1024 lds
    ds_read_b128 v[218:221], v179 offset:6144
    v_mfma_f32_16x16x32_bf16 v[210:213], v[134:137], a[184:187], v[210:213]
    ds_read_b128 v[138:141], v178 offset:6144
    v_mov_b32 v195, v159
    v_mfma_f32_16x16x32_bf16 v[210:213], v[170:173], a[188:191], v[210:213]
    ds_read_b128 v[238:241], v179 offset:6272
    v_mov_b32 v196, v159
    v_mfma_f32_16x16x32_bf16 v[234:237], v[206:209], a[192:195], 0
    ds_read_b128 v[162:165], v178 offset:6272
    v_mov_b32 v197, v159
    v_mfma_f32_16x16x32_bf16 v[234:237], v[214:217], a[196:199], v[234:237]
    ds_read_b128 v[214:217], v179 offset:6400
    v_cndmask_b32 v194, v159, v194, s[88:89]
    v_mfma_f32_16x16x32_bf16 v[234:237], v[198:201], a[200:203], v[234:237]
    buffer_load_dwordx4 v151, s[52:55], 0 offen offset:2048 lds
    ds_read_b128 v[226:229], v178 offset:6400
    v_mfma_f32_16x16x32_bf16 v[234:237], v[166:169], a[204:207], v[234:237]
    s_add_u32 s52, s52, 12288
    s_waitcnt vmcnt(9)
    ds_read_b64 a[216:217], v120 offset:0
    v_mfma_f32_16x16x32_bf16 v[234:237], v[134:137], a[208:211], v[234:237]
    s_addc_u32 s53, s53, 0
    ds_read_b64 a[218:219], v120 offset:1536
    ds_read_b64 a[240:241], v120 offset:8
    v_mfma_f32_16x16x32_bf16 v[234:237], v[170:173], a[212:215], v[234:237]
    s_waitcnt lgkmcnt(8)
    ds_read_b64 a[242:243], v120 offset:1544
    ds_read_b64 v[90:91], v255 offset:0
    v_mfma_f32_16x16x32_bf16 v[134:137], v[218:221], a[144:147], 0
    s_waitcnt lgkmcnt(9)
    ds_read_b64 v[92:93], v255 offset:1536
    v_fmac_f32 v148, v155, v155
    v_mfma_f32_16x16x32_bf16 v[134:137], v[138:141], a[148:151], v[134:137]
    s_waitcnt lgkmcnt(9)
    ds_write_b128 v190, v[194:197] offset:192
    v_mfma_f32_16x16x32_bf16 v[134:137], v[238:241], a[152:155], v[134:137]
    s_waitcnt lgkmcnt(8)
    v_fmac_f32 v148, v156, v156
    v_fmac_f32 v148, v157, v157
    v_mfma_f32_16x16x32_bf16 v[134:137], v[162:165], a[156:159], v[134:137]
    s_add_u32 m0, s69, 0
    v_fmac_f32 v148, v174, v174
    v_fmac_f32 v148, v175, v175
    v_mfma_f32_16x16x32_bf16 v[134:137], v[214:217], a[160:163], v[134:137]
    s_waitcnt lgkmcnt(6)
    v_fmac_f32 v148, v176, v176
    v_fmac_f32 v148, v177, v177
    v_mfma_f32_16x16x32_bf16 v[134:137], v[226:229], a[164:167], v[134:137]
    s_waitcnt lgkmcnt(4)
    v_fmac_f32 v148, v182, v182
    v_fmac_f32 v148, v183, v183
    v_mfma_f32_16x16x32_bf16 v[178:181], v[130:133], a[216:219], 0
    s_waitcnt lgkmcnt(2)
    v_fmac_f32 v148, v184, v184
    v_fmac_f32 v148, v185, v185
    v_mfma_f32_16x16x32_bf16 v[178:181], v[130:133], a[240:243], v[178:181]
    s_waitcnt lgkmcnt(1)
    buffer_load_dwordx4 v143, s[52:55], 0 offen lds
    v_cvt_pk_bf16_f32 v36, v148, v142
    v_mfma_f32_16x16x32_bf16 v[178:181], v[130:133], v[90:93], v[178:181]
    v_cvt_pk_bf16_f32 v230, v230, v230
    v_cvt_pk_bf16_f32 v231, v231, v231
    v_mfma_f32_16x16x32_bf16 v[170:173], v[32:35], v[36:39], 0
    ds_write2_b32 v186, v230, v231 offset0:0 offset1:68
    s_waitcnt vmcnt(7)
    v_mfma_f32_16x16x32_bf16 v[166:169], v[218:221], a[168:171], 0
    v_cvt_pk_bf16_f32 v232, v232, v232
    v_cvt_pk_bf16_f32 v233, v233, v233
    v_mfma_f32_16x16x32_bf16 v[166:169], v[138:141], a[172:175], v[166:169]
    buffer_load_dwordx4 v118, s[52:55], 0 offen offset:1024 lds
    ds_read_b64 a[232:233], v120 offset:3072
    v_mfma_f32_16x16x32_bf16 v[166:169], v[238:241], a[176:179], v[166:169]
    ds_read_b64 a[220:221], v120 offset:4608
    ds_read_b64 v[82:83], v120 offset:3080
    v_mfma_f32_16x16x32_bf16 v[166:169], v[162:165], a[180:183], v[166:169]
    ds_read_b64 a[244:245], v120 offset:4616
    ds_read_b64 v[106:107], v255 offset:3072
    v_mfma_f32_16x16x32_bf16 v[166:169], v[214:217], a[184:187], v[166:169]
    ds_read_b64 v[94:95], v255 offset:4608
    v_mov_b32 v254, v178
    v_mfma_f32_16x16x32_bf16 v[166:169], v[226:229], a[188:191], v[166:169]
    ds_write2_b32 v186, v232, v233 offset0:136 offset1:204
    v_mfma_f32_16x16x32_bf16 v[158:161], v[218:221], a[192:195], 0
    buffer_load_dwordx4 v151, s[52:55], 0 offen offset:2048 lds
    v_mov_b32_dpp v254, v179 quad_perm:[0,1,2,3] row_mask:0x2 bank_mask:0xf
    v_mfma_f32_16x16x32_bf16 v[158:161], v[138:141], a[196:199], v[158:161]
    s_add_u32 s52, s52, 12288
    v_rsq_f32 v171, v171
    v_mfma_f32_16x16x32_bf16 v[158:161], v[238:241], a[200:203], v[158:161]
    s_addc_u32 s53, s53, 0
    v_rsq_f32 v170, v170
    v_mfma_f32_16x16x32_bf16 v[158:161], v[162:165], a[204:207], v[158:161]
    s_add_u32 m0, s69, 3072
    v_mul_f32 v170, s31, v170
    v_mul_f32 v114, v171, v114
    v_mfma_f32_16x16x32_bf16 v[158:161], v[214:217], a[208:211], v[158:161]
    s_waitcnt lgkmcnt(3)
    v_mul_f32 v115, v171, v115
    v_cvt_pk_f16_f32 v178, v114, v115
    v_mfma_f32_16x16x32_bf16 v[158:161], v[226:229], a[212:215], v[158:161]
    s_barrier
    s_waitcnt vmcnt(6)
    s_waitcnt lgkmcnt(1)
    buffer_load_dwordx4 v143, s[52:55], 0 offen lds
    ds_read_b64 a[222:223], v193 offset:0
    ds_read_b64 a[234:235], v193 offset:1536
    ds_read_b64 a[246:247], v193 offset:8
    ds_read_b64 v[84:85], v193 offset:1544
    ds_read_b64 v[96:97], v153 offset:0
    ds_read_b64 v[108:109], v153 offset:1536
    ds_read_b128 v[226:229], v0 offset:26624
    ds_read_b128 v[214:217], v1 offset:26624
    ds_read_b128 v[218:221], v0 offset:26752
    ds_read_b128 v[138:141], v1 offset:26752
    buffer_load_dwordx4 v118, s[52:55], 0 offen offset:1024 lds
    ds_read_b128 v[194:197], v0 offset:26880
    ds_read_b128 v[198:201], v1 offset:26880
    v_mul_f32 v116, v171, v116
    v_mul_f32 v117, v171, v117
    s_waitcnt lgkmcnt(11)
    v_mfma_f32_16x16x32_bf16 v[162:165], v[130:133], a[220:223], 0
    s_waitcnt lgkmcnt(9)
    v_cvt_pk_f16_f32 v179, v116, v117
    v_mul_f32 v122, v171, v122
    v_mfma_f32_16x16x32_bf16 v[162:165], v[130:133], a[244:247], v[162:165]
    s_waitcnt lgkmcnt(5)
    v_mul_f32 v123, v171, v123
    v_cvt_pk_f16_f32 v180, v122, v123
    v_mfma_f32_16x16x32_bf16 v[162:165], v[130:133], v[94:97], v[162:165]
    s_waitcnt lgkmcnt(4)
    buffer_load_dwordx4 v151, s[52:55], 0 offen offset:2048 lds
    v_mul_f32 v124, v171, v124
    v_mfma_f32_16x16x32_bf16 v[114:117], v[130:133], a[232:235], 0
    s_add_u32 m0, s28, 65536
    v_mul_f32 v125, v171, v125
    v_cvt_pk_f16_f32 v181, v124, v125
    v_mfma_f32_16x16x32_bf16 v[114:117], v[130:133], v[82:85], v[114:117]
    s_waitcnt lgkmcnt(2)
    v_mov_b32 v118, v163
    s_waitcnt vmcnt(6)
    v_mfma_f32_16x16x32_bf16 v[114:117], v[130:133], v[106:109], v[114:117]
    s_waitcnt lgkmcnt(1)
    ds_read_b64 a[224:225], v193 offset:3072
    ds_read_b64 a[226:227], v193 offset:4608
    v_mfma_f32_16x16x32_bf16 v[122:125], a[72:75], v[226:229], 0
    s_waitcnt lgkmcnt(2)
    ds_read_b64 a[248:249], v193 offset:3080
    ds_read_b64 a[250:251], v193 offset:4616
    v_mfma_f32_16x16x32_bf16 v[122:125], a[76:79], v[214:217], v[122:125]
    buffer_load_dwordx4 v10, s[8:11], s24 offen nt lds
    v_mfma_f32_16x16x32_bf16 v[122:125], a[80:83], v[218:221], v[122:125]
    s_add_u32 m0, s28, 69632
    ds_read_b64 v[98:99], v153 offset:3072
    ds_read_b64 v[100:101], v153 offset:4608
    v_mfma_f32_16x16x32_bf16 v[122:125], a[84:87], v[138:141], v[122:125]
    v_mov_b32_dpp v254, v114 quad_perm:[0,1,2,3] row_mask:0x4 bank_mask:0xf
    v_mov_b32_dpp v254, v162 quad_perm:[0,1,2,3] row_mask:0x8 bank_mask:0xf
    v_mfma_f32_16x16x32_bf16 v[122:125], a[88:91], v[194:197], v[122:125]
    ds_write_b32 v152, v254 offset:0
    v_mfma_f32_16x16x32_bf16 v[122:125], a[92:95], v[198:201], v[122:125]
    v_mov_b32_dpp v118, v115 quad_perm:[0,1,2,3] row_mask:0x2 bank_mask:0xf
    v_mul_f32 v126, v171, v126
    v_mfma_f32_16x16x32_bf16 v[114:117], a[96:99], v[226:229], 0
    buffer_load_dwordx4 v11, s[8:11], s24 offen nt lds
    v_mfma_f32_16x16x32_bf16 v[114:117], a[100:103], v[214:217], v[114:117]
    s_waitcnt lgkmcnt(5)
    v_mul_f32 v127, v171, v127
    v_cvt_pk_f16_f32 v164, v126, v127
    v_mfma_f32_16x16x32_bf16 v[190:193], v[130:133], a[224:227], 0
    s_waitcnt lgkmcnt(3)
    v_mul_f32 v128, v171, v128
    v_mul_f32 v129, v171, v129
    v_mfma_f32_16x16x32_bf16 v[190:193], v[130:133], a[248:251], v[190:193]
    s_add_u32 m0, s28, 73728
    v_cvt_pk_f16_f32 v165, v128, v129
    v_mul_f32 v154, v170, v154
    v_mfma_f32_16x16x32_bf16 v[114:117], a[104:107], v[218:221], v[114:117]
    s_waitcnt lgkmcnt(1)
    v_mul_f32 v155, v170, v155
    v_cvt_pk_f16_f32 v126, v154, v155
    v_mfma_f32_16x16x32_bf16 v[190:193], v[130:133], v[98:101], v[190:193]
    buffer_load_dwordx4 v12, s[8:11], s24 offen nt lds
    v_mfma_f32_16x16x32_bf16 v[114:117], a[108:111], v[138:141], v[114:117]
    s_waitcnt vmcnt(6)
    ds_read_b64 a[236:237], v120 offset:0
    ds_read_b64 a[228:229], v120 offset:1536
    v_mfma_f32_16x16x32_bf16 v[114:117], a[112:115], v[194:197], v[114:117]
    s_add_u32 m0, s28, 77824
    ds_read_b64 v[86:87], v120 offset:8
    ds_read_b64 a[252:253], v120 offset:1544
    v_mfma_f32_16x16x32_bf16 v[114:117], a[116:119], v[198:201], v[114:117]
    ds_read_b64 v[110:111], v255 offset:0
    ds_read_b64 v[102:103], v255 offset:1536
    v_mfma_f32_16x16x32_bf16 v[230:233], a[120:123], v[226:229], 0
    v_mov_b32_dpp v118, v190 quad_perm:[0,1,2,3] row_mask:0x4 bank_mask:0xf
    v_mov_b32_dpp v118, v191 quad_perm:[0,1,2,3] row_mask:0x8 bank_mask:0xf
    v_mfma_f32_16x16x32_bf16 v[230:233], a[124:127], v[214:217], v[230:233]
    buffer_load_dwordx4 v13, s[8:11], s24 offen nt lds
    v_mfma_f32_16x16x32_bf16 v[230:233], a[128:131], v[218:221], v[230:233]
    s_add_u32 m0, s74, 0
    ds_write_b32 v152, v118 offset:1024
    v_mfma_f32_16x16x32_bf16 v[230:233], a[132:135], v[138:141], v[230:233]
    v_mul_f32 v156, v170, v156
    v_mul_f32 v157, v170, v157
    v_mfma_f32_16x16x32_bf16 v[230:233], a[136:139], v[194:197], v[230:233]
    v_cvt_pk_f16_f32 v127, v156, v157
    v_mul_f32 v174, v170, v174
    v_mfma_f32_16x16x32_bf16 v[230:233], a[140:143], v[198:201], v[230:233]
    s_waitcnt lgkmcnt(5)
    v_mul_f32 v175, v170, v175
    v_cvt_pk_f16_f32 v128, v174, v175
    v_mfma_f32_16x16x32_bf16 v[154:157], a[0:3], v[226:229], 0
    s_waitcnt lgkmcnt(3)
    buffer_load_dwordx4 v14, s[8:11], s24 offen nt lds
    v_mfma_f32_16x16x32_bf16 v[154:157], a[4:7], v[214:217], v[154:157]
    s_add_u32 s8, s40, s23
    v_mul_f32 v176, v170, v176
    v_mul_f32 v177, v170, v177
    v_mfma_f32_16x16x32_bf16 v[154:157], a[8:11], v[218:221], v[154:157]
    s_addc_u32 s9, s41, 0
    v_cvt_pk_f16_f32 v129, v176, v177
    v_mul_f32 v182, v170, v182
    v_mfma_f32_16x16x32_bf16 v[154:157], a[12:15], v[138:141], v[154:157]
    s_sub_u32 s10, s36, s23
    v_mul_f32 v183, v170, v183
    v_cvt_pk_f16_f32 v162, v182, v183
    v_mfma_f32_16x16x32_bf16 v[154:157], a[16:19], v[194:197], v[154:157]
    s_cmp_lt_u32 s34, s17
    v_mul_f32 v184, v170, v184
    v_mul_f32 v185, v170, v185
    v_mfma_f32_16x16x32_bf16 v[154:157], a[20:23], v[198:201], v[154:157]
    s_cselect_b32 s10, s10, 0
    v_cvt_pk_f16_f32 v163, v184, v185
    v_cvt_pk_bf16_f32 v210, v210, v210
    v_mfma_f32_16x16x32_bf16 v[170:173], a[24:27], v[226:229], 0
    s_add_u32 m0, s28, 0
    v_cvt_pk_bf16_f32 v211, v211, v211
    s_waitcnt vmcnt(5)
    v_mfma_f32_16x16x32_bf16 v[170:173], a[28:31], v[214:217], v[170:173]
    s_mov_b32 s24, s23
    ds_read_b64 a[230:231], v120 offset:3072
    ds_read_b64 a[238:239], v120 offset:4608
    v_mfma_f32_16x16x32_bf16 v[170:173], a[32:35], v[218:221], v[170:173]
    s_add_u32 s23, s23, s21
    ds_read_b64 a[254:255], v120 offset:3080
    ds_read_b64 v[88:89], v120 offset:4616
    v_mfma_f32_16x16x32_bf16 v[170:173], a[36:39], v[138:141], v[170:173]
    s_cmp_ge_u32 s19, 72
    ds_read_b64 v[104:105], v255 offset:3072
    ds_read_b64 v[112:113], v255 offset:4608
    v_mfma_f32_16x16x32_bf16 v[170:173], a[40:43], v[194:197], v[170:173]
    s_cselect_b32 s34, 72, 0
    ds_write2_b32 v186, v210, v211 offset0:16 offset1:84
    v_mfma_f32_16x16x32_bf16 v[170:173], a[44:47], v[198:201], v[170:173]
    s_cselect_b32 s35, s22, 0
    v_cvt_pk_bf16_f32 v212, v212, v212
    v_cvt_pk_bf16_f32 v213, v213, v213
    v_mfma_f32_16x16x32_bf16 v[190:193], a[48:51], v[226:229], 0
    s_sub_u32 s19, s19, s34
    ds_write2_b32 v186, v212, v213 offset0:152 offset1:220
    v_mfma_f32_16x16x32_bf16 v[190:193], a[52:55], v[214:217], v[190:193]
    s_add_u32 s23, s23, s35
    v_cvt_pk_bf16_f32 v234, v234, v234
    v_cvt_pk_bf16_f32 v235, v235, v235
    v_mfma_f32_16x16x32_bf16 v[190:193], a[56:59], v[218:221], v[190:193]
    s_waitcnt lgkmcnt(6)
    ds_write2_b32 v186, v234, v235 offset0:32 offset1:100
    v_mfma_f32_16x16x32_bf16 v[174:177], v[130:133], a[228:231], 0
    s_waitcnt lgkmcnt(5)
    v_cvt_pk_bf16_f32 v236, v236, v236
    v_cvt_pk_bf16_f32 v237, v237, v237
    v_mfma_f32_16x16x32_bf16 v[174:177], v[130:133], a[252:255], v[174:177]
    s_waitcnt lgkmcnt(3)
    ds_write2_b32 v186, v236, v237 offset0:168 offset1:236
    v_mfma_f32_16x16x32_bf16 v[174:177], v[130:133], v[102:105], v[174:177]
    v_cvt_pk_bf16_f32 v134, v134, v134
    v_cvt_pk_bf16_f32 v135, v135, v135
    v_mfma_f32_16x16x32_bf16 v[210:213], v[130:133], a[236:239], 0
    ds_write2_b32 v189, v134, v135 offset0:0 offset1:68
    v_mfma_f32_16x16x32_bf16 v[210:213], v[130:133], v[86:89], v[210:213]
    v_cvt_pk_bf16_f32 v136, v136, v136
    v_cvt_pk_bf16_f32 v137, v137, v137
    v_mfma_f32_16x16x32_bf16 v[210:213], v[130:133], v[110:113], v[210:213]
    ds_write2_b32 v189, v136, v137 offset0:136 offset1:204
    v_mfma_f32_16x16x32_bf16 v[190:193], a[60:63], v[138:141], v[190:193]
    v_cvt_pk_bf16_f32 v166, v166, v166
    v_cvt_pk_bf16_f32 v167, v167, v167
    v_mfma_f32_16x16x32_bf16 v[190:193], a[64:67], v[194:197], v[190:193]
    ds_write2_b32 v189, v166, v167 offset0:16 offset1:84
    v_mfma_f32_16x16x32_bf16 v[190:193], a[68:71], v[198:201], v[190:193]
    v_cvt_pk_bf16_f32 v168, v168, v168
    v_mov_b32 v118, v210
    v_mfma_f32_16x16x32_bf16 v[134:137], v[226:229], a[144:147], 0
    v_mov_b32_dpp v118, v174 quad_perm:[0,1,2,3] row_mask:0x2 bank_mask:0xf
    v_mov_b32_dpp v118, v175 quad_perm:[0,1,2,3] row_mask:0x4 bank_mask:0xf
    v_mfma_f32_16x16x32_bf16 v[134:137], v[214:217], a[148:151], v[134:137]
    v_mov_b32_dpp v118, v211 quad_perm:[0,1,2,3] row_mask:0x8 bank_mask:0xf
    v_cvt_pk_bf16_f32 v169, v169, v169
    v_mfma_f32_16x16x32_bf16 v[134:137], v[218:221], a[152:155], v[134:137]
    ds_write_b32 v152, v118 offset:2048
    v_mfma_f32_16x16x32_bf16 v[134:137], v[138:141], a[156:159], v[134:137]
    v_cvt_pk_bf16_f32 v158, v158, v158
    v_cvt_pk_bf16_f32 v159, v159, v159
    v_mfma_f32_16x16x32_bf16 v[134:137], v[194:197], a[160:163], v[134:137]
    ds_write2_b32 v189, v168, v169 offset0:152 offset1:220
    v_mfma_f32_16x16x32_bf16 v[134:137], v[198:201], a[164:167], v[134:137]
    v_cvt_pk_bf16_f32 v160, v160, v160
    v_cvt_pk_bf16_f32 v161, v161, v161
    v_mfma_f32_16x16x32_bf16 v[130:133], v[226:229], a[168:171], 0
    ds_write2_b32 v189, v158, v159 offset0:32 offset1:100
    v_mfma_f32_16x16x32_bf16 v[130:133], v[214:217], a[172:175], v[130:133]
    v_fma_f32 v142, v154, v154, s32
    v_fmac_f32 v142, v155, v155
    v_mfma_f32_16x16x32_bf16 v[130:133], v[218:221], a[176:179], v[130:133]
    ds_write2_b32 v189, v160, v161 offset0:168 offset1:236
    v_mfma_f32_16x16x32_bf16 v[130:133], v[138:141], a[180:183], v[130:133]
    s_waitcnt lgkmcnt(3)
    v_cvt_pk_bf16_f32 v204, v134, v135
    v_cvt_pk_bf16_f32 v205, v136, v137
    v_mfma_f32_16x16x32_bf16 v[130:133], v[194:197], a[184:187], v[130:133]
    s_barrier
    ds_read_b128 v[174:177], v0 offset:32768
    ds_read_b128 v[166:169], v1 offset:32768
    v_mfma_f32_16x16x32_bf16 v[130:133], v[198:201], a[188:191], v[130:133]
    ds_read_b128 v[158:161], v0 offset:32896
    ds_read_b128 v[182:185], v121 offset:0
    v_mfma_f32_16x16x32_bf16 v[210:213], v[226:229], a[192:195], 0
    v_fmac_f32 v142, v156, v156
    v_fmac_f32 v142, v157, v157
    v_mfma_f32_16x16x32_bf16 v[210:213], v[214:217], a[196:199], v[210:213]
    ds_read_b128 v[134:137], v1 offset:32896
    ds_read_b128 v[186:189], v0 offset:33024
    v_mfma_f32_16x16x32_bf16 v[210:213], v[218:221], a[200:203], v[210:213]
    v_fmac_f32 v142, v170, v170
    v_fmac_f32 v142, v171, v171
    v_mfma_f32_16x16x32_bf16 v[210:213], v[138:141], a[204:207], v[210:213]
    ds_read_b128 v[138:141], v1 offset:33024
    ds_read_b128 v[218:221], v121 offset:1024
    v_mfma_f32_16x16x32_bf16 v[210:213], v[194:197], a[208:211], v[210:213]
    v_fmac_f32 v142, v172, v172
    v_fmac_f32 v142, v173, v173
    v_mfma_f32_16x16x32_bf16 v[210:213], v[198:201], a[212:215], v[210:213]
    ds_read_b128 v[226:229], v121 offset:2048
    v_fmac_f32 v142, v190, v190
    v_mfma_f32_16x16x32_f16 v[214:217], v[178:181], v[126:129], v[46:49]
    s_waitcnt lgkmcnt(7)
    v_fmac_f32 v142, v191, v191
    v_fmac_f32 v142, v192, v192
    v_mfma_f32_16x16x32_bf16 v[198:201], a[72:75], v[174:177], 0
    s_waitcnt lgkmcnt(5)
    v_add_f32 v182, v182, v183
    v_add_f32 v184, v184, v185
    v_mfma_f32_16x16x32_bf16 v[198:201], a[76:79], v[166:169], v[198:201]
    v_add_f32 v182, v182, v184
    v_mul_f32 v182, 0xbbaaaaab, v182
    v_mfma_f32_16x16x32_bf16 v[198:201], a[80:83], v[158:161], v[198:201]
    s_waitcnt lgkmcnt(3)
    ds_write_b32 v150, v182 offset:0
    v_mfma_f32_16x16x32_bf16 v[198:201], a[84:87], v[134:137], v[198:201]
    v_fmac_f32 v142, v193, v193
    v_fma_f32 v143, v122, v122, s32
    v_mfma_f32_16x16x32_bf16 v[198:201], a[88:91], v[186:189], v[198:201]
    s_waitcnt lgkmcnt(2)
    ds_read_b128 v[182:185], v119 offset:0
    ds_read_b128 v[194:197], v119 offset:64
    v_mfma_f32_16x16x32_bf16 v[198:201], a[92:95], v[138:141], v[198:201]
    v_add_f32 v218, v218, v219
    v_add_f32 v220, v220, v221
    v_mfma_f32_16x16x32_bf16 v[234:237], a[96:99], v[174:177], 0
    s_waitcnt lgkmcnt(3)
    v_add_f32 v218, v218, v220
    v_mul_f32 v218, 0xbbaaaaab, v218
    v_mfma_f32_16x16x32_bf16 v[234:237], a[100:103], v[166:169], v[234:237]
    ds_write_b32 v150, v218 offset:256
    v_mfma_f32_16x16x32_bf16 v[234:237], a[104:107], v[158:161], v[234:237]
    v_add_f32 v226, v226, v227
    v_add_f32 v228, v228, v229
    v_mfma_f32_16x16x32_bf16 v[234:237], a[108:111], v[134:137], v[234:237]
    v_add_f32 v226, v226, v228
    v_mul_f32 v226, 0xbbaaaaab, v226
    v_mfma_f32_16x16x32_bf16 v[234:237], a[112:115], v[186:189], v[234:237]
    ds_write_b32 v150, v226 offset:512
    v_mfma_f32_16x16x32_bf16 v[234:237], a[116:119], v[138:141], v[234:237]
    v_fmac_f32 v143, v123, v123
    v_fmac_f32 v143, v124, v124
    v_mfma_f32_16x16x32_bf16 v[150:153], a[120:123], v[174:177], 0
    s_waitcnt lgkmcnt(2)
    v_fmac_f32 v143, v125, v125
    v_fmac_f32 v143, v114, v114
    v_mfma_f32_16x16x32_bf16 v[150:153], a[124:127], v[166:169], v[150:153]
    v_fmac_f32 v143, v115, v115
    v_fmac_f32 v143, v116, v116
    v_mfma_f32_16x16x32_bf16 v[150:153], a[128:131], v[158:161], v[150:153]
    v_fmac_f32 v143, v117, v117
    v_fmac_f32 v143, v230, v230
    v_mfma_f32_16x16x32_bf16 v[150:153], a[132:135], v[134:137], v[150:153]
    v_fmac_f32 v143, v231, v231
    v_fmac_f32 v143, v232, v232
    v_mfma_f32_16x16x32_bf16 v[150:153], a[136:139], v[186:189], v[150:153]
    v_fmac_f32 v143, v233, v233
    v_cvt_pk_bf16_f32 v36, v142, v143
    v_mfma_f32_16x16x32_bf16 v[150:153], a[140:143], v[138:141], v[150:153]
    v_cvt_pk_bf16_f32 v148, v130, v131
    v_cvt_pk_bf16_f32 v149, v132, v133
    v_mfma_f32_16x16x32_bf16 v[226:229], v[32:35], v[36:39], 0
    v_cvt_pk_bf16_f32 v224, v210, v211
    v_cvt_pk_bf16_f32 v225, v212, v213
    v_mfma_f32_16x16x32_bf16 v[210:213], a[0:3], v[174:177], 0
    v_fma_f32 v142, v198, v198, s32
    v_fmac_f32 v142, v199, v199
    v_mfma_f32_16x16x32_bf16 v[210:213], a[4:7], v[166:169], v[210:213]
    v_fmac_f32 v142, v200, v200
    v_fmac_f32 v142, v201, v201
    v_mfma_f32_16x16x32_bf16 v[210:213], a[8:11], v[158:161], v[210:213]
    v_rsq_f32 v227, v227
    v_mfma_f32_16x16x32_bf16 v[210:213], a[12:15], v[134:137], v[210:213]
    v_rsq_f32 v226, v226
    v_mfma_f32_16x16x32_bf16 v[210:213], a[16:19], v[186:189], v[210:213]
    v_mul_f32 v226, s31, v226
    v_mul_f32 v122, v227, v122
    v_mfma_f32_16x16x32_bf16 v[210:213], a[20:23], v[138:141], v[210:213]
    v_mul_f32 v123, v227, v123
    v_cvt_pk_f16_f32 v122, v122, v123
    v_mfma_f32_16x16x32_bf16 v[130:133], a[24:27], v[174:177], 0
    v_mul_f32 v124, v227, v124
    v_mul_f32 v125, v227, v125
    v_mfma_f32_16x16x32_bf16 v[130:133], a[28:31], v[166:169], v[130:133]
    v_cvt_pk_f16_f32 v123, v124, v125
    v_mul_f32 v114, v227, v114
    v_mfma_f32_16x16x32_bf16 v[130:133], a[32:35], v[158:161], v[130:133]
    v_mul_f32 v115, v227, v115
    v_cvt_pk_f16_f32 v124, v114, v115
    v_mfma_f32_16x16x32_bf16 v[130:133], a[36:39], v[134:137], v[130:133]
    v_mul_f32 v116, v227, v116
    v_mul_f32 v117, v227, v117
    v_mfma_f32_16x16x32_bf16 v[130:133], a[40:43], v[186:189], v[130:133]
    v_cvt_pk_f16_f32 v125, v116, v117
    v_mul_f32 v230, v227, v230
    v_mfma_f32_16x16x32_bf16 v[130:133], a[44:47], v[138:141], v[130:133]
    v_mul_f32 v231, v227, v231
    v_cvt_pk_f16_f32 v208, v230, v231
    v_mfma_f32_16x16x32_bf16 v[114:117], a[48:51], v[174:177], 0
    v_mul_f32 v232, v227, v232
    v_mul_f32 v233, v227, v233
    v_mfma_f32_16x16x32_bf16 v[114:117], a[52:55], v[166:169], v[114:117]
    ds_read_b128 v[218:221], v5 offset:0
    ds_read_b128 v[238:241], v5 offset:16
    v_mfma_f32_16x16x32_bf16 v[114:117], a[56:59], v[158:161], v[114:117]
    ds_read_b32 v254, v6 offset:192
    v_cvt_pk_f16_f32 v209, v232, v233
    v_mfma_f32_16x16x32_bf16 v[114:117], a[60:63], v[134:137], v[114:117]
    v_mul_f32 v154, v226, v154
    v_mul_f32 v155, v226, v155
    v_mfma_f32_16x16x32_bf16 v[114:117], a[64:67], v[186:189], v[114:117]
    v_cvt_pk_f16_f32 v154, v154, v155
    v_mul_f32 v156, v226, v156
    v_mfma_f32_16x16x32_bf16 v[114:117], a[68:71], v[138:141], v[114:117]
    v_mul_f32 v157, v226, v157
    v_cvt_pk_f16_f32 v155, v156, v157
    v_mul_f32 v170, v226, v170
    v_mfma_f32_16x16x16_f16 v[214:217], v[164:165], v[162:163], v[214:217]
    v_mul_f32 v171, v226, v171
    v_cvt_pk_f16_f32 v156, v170, v171
    v_mul_f32 v172, v226, v172
    v_mul_f32 v173, v226, v173
    v_cvt_pk_f16_f32 v157, v172, v173
    v_mfma_f32_16x16x32_bf16 v[170:173], v[174:177], a[144:147], 0
    v_mul_f32 v190, v226, v190
    v_mul_f32 v191, v226, v191
    v_mfma_f32_16x16x32_bf16 v[170:173], v[166:169], a[148:151], v[170:173]
    s_waitcnt lgkmcnt(1)
    v_cvt_pk_f16_f32 v206, v190, v191
    v_mul_f32 v192, v226, v192
    v_mfma_f32_16x16x32_bf16 v[170:173], v[158:161], a[152:155], v[170:173]
    s_waitcnt lgkmcnt(0)
    v_mul_f32 v193, v226, v193
    v_cvt_pk_f16_f32 v207, v192, v193
    v_mfma_f32_16x16x32_bf16 v[170:173], v[134:137], a[156:159], v[170:173]
    v_fma_f32 v143, v210, v210, s32
    v_fmac_f32 v143, v211, v211
    v_mfma_f32_16x16x32_bf16 v[170:173], v[186:189], a[160:163], v[170:173]
    v_fmac_f32 v143, v212, v212
    v_fmac_f32 v143, v213, v213
    v_mfma_f32_16x16x32_bf16 v[170:173], v[138:141], a[164:167], v[170:173]
    v_fmac_f32 v143, v130, v130
    v_fmac_f32 v143, v131, v131
    v_fmac_f32 v143, v132, v132
    v_fmac_f32 v143, v133, v133
    v_fmac_f32 v143, v114, v114
    v_fmac_f32 v143, v115, v115
    v_fmac_f32 v143, v116, v116
    v_fmac_f32 v143, v117, v117
    v_cvt_pk_bf16_f32 v190, v170, v171
    v_cvt_pk_bf16_f32 v191, v172, v173
    v_mfma_f32_16x16x32_f16 v[170:173], v[218:221], v[126:129], v[22:25]
    v_fmac_f32 v142, v234, v234
    v_fmac_f32 v142, v235, v235
    v_mfma_f32_16x16x32_f16 v[170:173], v[238:241], v[178:181], v[170:173]
    v_fmac_f32 v142, v236, v236
    v_fmac_f32 v142, v237, v237
    v_fmac_f32 v142, v150, v150
    v_fmac_f32 v142, v151, v151
    v_fmac_f32 v142, v152, v152
    v_fmac_f32 v142, v153, v153
    v_cvt_pk_bf16_f32 v36, v143, v142
    v_xor_b32 v0, 65536, v0
    v_xor_b32 v1, 65536, v1
    v_mfma_f32_16x16x32_bf16 v[230:233], v[32:35], v[36:39], 0
    s_nop 0
    s_nop 0
    s_nop 0
    s_nop 0
    s_nop 0
    s_nop 0
    s_nop 0
    s_nop 0
    v_rsq_f32 v231, v231
    v_rsq_f32 v230, v230
    v_mul_f32 v198, v231, v198
    v_mul_f32 v230, s31, v230
    v_mul_f32 v199, v231, v199
    v_cvt_pk_f16_f32 v226, v198, v199
    v_mul_f32 v200, v231, v200
    v_mul_f32 v201, v231, v201
    v_cvt_pk_f16_f32 v227, v200, v201
    v_mul_f32 v234, v231, v234
    v_mul_f32 v235, v231, v235
    v_cvt_pk_f16_f32 v228, v234, v235
    v_mul_f32 v236, v231, v236
    v_mul_f32 v237, v231, v237
    v_cvt_pk_f16_f32 v229, v236, v237
    v_mfma_f32_16x16x32_bf16 v[198:201], v[174:177], a[168:171], 0
    v_mul_f32 v150, v231, v150
    v_mul_f32 v151, v231, v151
    v_mfma_f32_16x16x32_bf16 v[198:201], v[166:169], a[172:175], v[198:201]
    v_cvt_pk_f16_f32 v236, v150, v151
    v_mul_f32 v152, v231, v152
    v_mfma_f32_16x16x32_bf16 v[198:201], v[158:161], a[176:179], v[198:201]
    v_mul_f32 v153, v231, v153
    v_cvt_pk_f16_f32 v237, v152, v153
    v_mfma_f32_16x16x32_bf16 v[198:201], v[134:137], a[180:183], v[198:201]
    v_mul_f32 v210, v230, v210
    v_mul_f32 v211, v230, v211
    v_mfma_f32_16x16x32_bf16 v[198:201], v[186:189], a[184:187], v[198:201]
    v_cvt_pk_f16_f32 v150, v210, v211
    v_mul_f32 v212, v230, v212
    v_mfma_f32_16x16x32_f16 v[246:249], v[218:221], v[154:157], v[24:27]
    v_mul_f32 v213, v230, v213
    v_cvt_pk_f16_f32 v151, v212, v213
    v_mfma_f32_16x16x32_f16 v[246:249], v[238:241], v[122:125], v[246:249]
    v_mul_f32 v130, v230, v130
    v_mul_f32 v131, v230, v131
    v_mfma_f32_16x16x32_bf16 v[198:201], v[138:141], a[188:191], v[198:201]
    v_cvt_pk_f16_f32 v152, v130, v131
    v_mul_f32 v132, v230, v132
    v_mul_f32 v133, v230, v133
    v_cvt_pk_f16_f32 v153, v132, v133
    v_mul_f32 v114, v230, v114
    v_mul_f32 v115, v230, v115
    v_cvt_pk_f16_f32 v234, v114, v115
    v_mfma_f32_16x16x32_bf16 v[130:133], v[174:177], a[192:195], 0
    ds_read_b128 v[210:213], v5 offset:48
    v_cvt_pk_bf16_f32 v198, v198, v199
    v_mfma_f32_16x16x32_bf16 v[130:133], v[166:169], a[196:199], v[130:133]
    v_cvt_pk_bf16_f32 v199, v200, v201
    v_mul_f32 v116, v230, v116
    v_mfma_f32_16x16x32_bf16 v[130:133], v[158:161], a[200:203], v[130:133]
    v_mul_f32 v117, v230, v117
    v_cvt_pk_f16_f32 v235, v116, v117
    v_mfma_f32_16x16x32_bf16 v[130:133], v[134:137], a[204:207], v[130:133]
    v_add_u32 v5, 336, v5
    v_mfma_f32_16x16x32_bf16 v[130:133], v[186:189], a[208:211], v[130:133]
    v_mfma_f32_16x16x32_bf16 v[130:133], v[138:141], a[212:215], v[130:133]
    s_waitcnt vmcnt(0)
    ds_read2_b32 v[192:193], v6 offset0:0 offset1:0
    ds_read2_b32 v[200:201], v6 offset0:16 offset1:16
    v_mfma_f32_16x16x32_f16 v[138:141], v[122:125], v[126:129], v[50:53]
    s_barrier
    buffer_load_dwordx4 v10, s[8:11], 0 offen nt lds
    ds_read2_b32 v[160:161], v6 offset0:32 offset1:32
    v_mfma_f32_16x16x32_f16 v[134:137], v[226:229], v[126:129], v[54:57]
    s_add_u32 m0, s28, 4096
    v_cvt_pk_bf16_f32 v158, v130, v131
    v_cvt_pk_bf16_f32 v159, v132, v133
    v_add_u32 v6, 272, v6
    v_mfma_f32_16x16x16_f16 v[138:141], v[208:209], v[162:163], v[138:141]
    v_mfma_f32_16x16x32_f16 v[186:189], v[218:221], v[150:153], v[26:29]
    s_waitcnt lgkmcnt(3)
    v_mfma_f32_16x16x32_f16 v[170:173], v[210:213], v[162:165], v[170:173]
    buffer_load_dwordx4 v11, s[8:11], 0 offen nt lds
    s_add_u32 m0, s28, 8192
    v_mfma_f32_16x16x32_f16 v[246:249], v[210:213], v[206:209], v[246:249]
    v_mfma_f32_16x16x16_f16 v[134:137], v[236:237], v[162:163], v[134:137]
    v_mfma_f32_16x16x32_f16 v[186:189], v[238:241], v[226:229], v[186:189]
    s_waitcnt lgkmcnt(0)
    v_mfma_f32_16x16x32_f16 v[186:189], v[210:213], v[234:237], v[186:189]
    buffer_load_dwordx4 v12, s[8:11], 0 offen nt lds
    v_mov_b32_dpp v254, v171 quad_perm:[0,1,2,3] row_mask:0x1 bank_mask:0xf
    v_max3_f32 v255, v170, v214, v215
    v_mfma_f32_16x16x16_bf16 v[126:129], a[216:217], v[144:145], v[182:185]
    v_mov_b32_dpp v254, v247 quad_perm:[0,1,2,3] row_mask:0x2 bank_mask:0xf
    v_max3_f32 v255, v255, v216, v217
    v_max3_f32 v255, v255, v138, v139
    v_mfma_f32_16x16x16_bf16 v[130:133], a[240:241], v[144:145], v[182:185]
    v_max3_f32 v255, v255, v140, v141
    v_max3_f32 v255, v255, v134, v135
    v_max3_f32 v255, v255, v136, v137
    v_mfma_f32_16x16x16_bf16 v[210:213], v[90:91], v[144:145], v[182:185]
    v_mov_b32 v142, v255
    v_mov_b32_dpp v254, v187 quad_perm:[0,1,2,3] row_mask:0x4 bank_mask:0xf
    v_cvt_pk_bf16_f32 v126, v126, v127
    v_mfma_f32_16x16x16_bf16 v[218:221], a[218:219], v[144:145], v[194:197]
    v_permlane32_swap_b32 v255, v142
    v_max_f32 v255, v255, v142
    v_mfma_f32_16x16x16_bf16 v[166:169], a[242:243], v[144:145], v[194:197]
    v_mov_b32 v142, v255
    v_accvgpr_write_b32 a216, v126
    v_cvt_pk_bf16_f32 v128, v128, v129
    v_mfma_f32_16x16x16_bf16 v[114:117], v[92:93], v[144:145], v[194:197]
    s_add_u32 m0, s28, 12288
    s_xor_b32 s28, s28, 65536
    buffer_load_dwordx4 v13, s[8:11], 0 offen nt lds
    s_mov_b32 m0, s29
    s_xor_b32 s29, s29, s30
    v_permlane16_swap_b32 v255, v142
    v_max_f32 v255, v255, v142
    v_sub_f32 v214, v214, v255
    v_exp_f32 v214, v214
    v_sub_f32 v215, v215, v255
    v_exp_f32 v215, v215
    v_sub_f32 v216, v216, v255
    v_cvt_pk_bf16_f32 v174, v214, v215
    v_exp_f32 v216, v216
    buffer_load_dwordx4 v14, s[8:11], 0 offen nt lds
    v_sub_f32 v217, v217, v255
    v_exp_f32 v217, v217
    v_sub_f32 v138, v138, v255
    v_cvt_pk_bf16_f32 v175, v216, v217
    v_exp_f32 v138, v138
    v_mfma_f32_16x16x32_f16 v[182:185], v[178:181], v[154:157], v[58:61]
    v_sub_f32 v139, v139, v255
    v_exp_f32 v139, v139
    v_sub_f32 v140, v140, v255
    v_cvt_pk_bf16_f32 v176, v138, v139
    v_exp_f32 v140, v140
    v_sub_f32 v141, v141, v255
    v_mfma_f32_16x16x16_f16 v[182:185], v[164:165], v[206:207], v[182:185]
    v_exp_f32 v141, v141
    v_sub_f32 v134, v134, v255
    v_cvt_pk_bf16_f32 v177, v140, v141
    v_exp_f32 v134, v134
    v_mfma_f32_16x16x32_f16 v[138:141], v[122:125], v[154:157], v[62:65]
    v_sub_f32 v135, v135, v255
    v_exp_f32 v135, v135
    v_sub_f32 v136, v136, v255
    v_cvt_pk_bf16_f32 v36, v134, v135
    v_exp_f32 v136, v136
    v_sub_f32 v137, v137, v255
    v_mfma_f32_16x16x16_f16 v[138:141], v[208:209], v[206:207], v[138:141]
    v_exp_f32 v137, v137
    v_sub_f32 v170, v170, v255
    v_cvt_pk_bf16_f32 v37, v136, v137
    v_mfma_f32_16x16x32_f16 v[214:217], v[226:229], v[154:157], v[66:69]
    v_exp_f32 v170, v170
    v_max3_f32 v255, v246, v182, v183
    v_cvt_pk_bf16_f32 v39, v170, 0
    v_max3_f32 v255, v255, v184, v185
    v_max3_f32 v255, v255, v138, v139
    v_mfma_f32_16x16x32_bf16 v[134:137], v[28:31], v[36:39], 0
    v_max3_f32 v255, v255, v140, v141
    v_accvgpr_write_b32 a217, v128
    v_mfma_f32_16x16x32_bf16 v[134:137], v[28:31], v[174:177], v[134:137]
    v_cvt_pk_bf16_f32 v130, v130, v131
    v_accvgpr_write_b32 a240, v130
    v_mfma_f32_16x16x32_bf16 v[154:157], v[190:193], v[36:39], 0
    v_cvt_pk_bf16_f32 v132, v132, v133
    v_accvgpr_write_b32 a241, v132
    v_mfma_f32_16x16x32_bf16 v[154:157], v[202:205], v[174:177], v[154:157]
    v_cvt_pk_bf16_f32 v90, v210, v211
    v_cvt_pk_bf16_f32 v91, v212, v213
    v_mfma_f32_16x16x32_bf16 v[126:129], v[198:201], v[36:39], 0
    ds_read_b128 v[130:133], v119 offset:128
    v_cvt_pk_bf16_f32 v218, v218, v219
    v_mfma_f32_16x16x32_bf16 v[126:129], v[146:149], v[174:177], v[126:129]
    v_rcp_f32 v134, v134
    v_mfma_f32_16x16x32_bf16 v[170:173], v[158:161], v[36:39], 0
    v_mul_f32 v154, v134, v154
    v_mul_f32 v155, v134, v155
    v_mfma_f32_16x16x32_bf16 v[170:173], v[222:225], v[174:177], v[170:173]
    v_cvt_pk_bf16_f32 v154, v154, v155
    v_mul_f32 v156, v134, v156
    v_mul_f32 v157, v134, v157
    v_mfma_f32_16x16x16_f16 v[214:217], v[236:237], v[206:207], v[214:217]
    v_cvt_pk_bf16_f32 v155, v156, v157
    v_mul_f32 v126, v134, v126
    v_mul_f32 v127, v134, v127
    v_cvt_pk_bf16_f32 v156, v126, v127
    v_mul_f32 v128, v134, v128
    v_mul_f32 v129, v134, v129
    v_cvt_pk_bf16_f32 v157, v128, v129
    ds_write_b128 v3, v[154:157] offset:0
    s_waitcnt lgkmcnt(1)
    v_mfma_f32_16x16x16_bf16 v[154:157], a[232:233], v[144:145], v[130:133]
    v_mul_f32 v170, v134, v170
    v_mul_f32 v171, v134, v171
    v_cvt_pk_bf16_f32 v142, v170, v171
    v_mfma_f32_16x16x16_bf16 v[126:129], v[82:83], v[144:145], v[130:133]
    v_mul_f32 v172, v134, v172
    v_mul_f32 v173, v134, v173
    v_cvt_pk_bf16_f32 v143, v172, v173
    v_mfma_f32_16x16x16_bf16 v[134:137], v[106:107], v[144:145], v[130:133]
    ds_write_b64 v4, v[142:143] offset:4096
    v_max3_f32 v255, v255, v214, v215
    v_max3_f32 v255, v255, v216, v217
    v_mov_b32 v142, v255
    v_accvgpr_write_b32 a218, v218
    v_cvt_pk_bf16_f32 v220, v220, v221
    v_permlane32_swap_b32 v255, v142
    v_max_f32 v255, v255, v142
    v_mov_b32 v142, v255
    v_accvgpr_write_b32 a219, v220
    v_cvt_pk_bf16_f32 v166, v166, v167
    v_permlane16_swap_b32 v255, v142
    v_max_f32 v255, v255, v142
    v_sub_f32 v182, v182, v255
    v_exp_f32 v182, v182
    v_sub_f32 v183, v183, v255
    v_exp_f32 v183, v183
    v_sub_f32 v184, v184, v255
    v_cvt_pk_bf16_f32 v130, v182, v183
    v_exp_f32 v184, v184
    v_sub_f32 v185, v185, v255
    v_exp_f32 v185, v185
    v_sub_f32 v138, v138, v255
    v_cvt_pk_bf16_f32 v131, v184, v185
    v_exp_f32 v138, v138
    v_sub_f32 v139, v139, v255
    v_exp_f32 v139, v139
    v_sub_f32 v140, v140, v255
    v_cvt_pk_bf16_f32 v132, v138, v139
    v_exp_f32 v140, v140
    v_sub_f32 v141, v141, v255
    v_exp_f32 v141, v141
    v_sub_f32 v214, v214, v255
    v_cvt_pk_bf16_f32 v133, v140, v141
    v_exp_f32 v214, v214
    v_sub_f32 v215, v215, v255
    v_exp_f32 v215, v215
    v_sub_f32 v216, v216, v255
    v_cvt_pk_bf16_f32 v36, v214, v215
    v_exp_f32 v216, v216
    v_sub_f32 v217, v217, v255
    v_exp_f32 v217, v217
    v_mfma_f32_16x16x32_f16 v[182:185], v[178:181], v[150:153], v[70:73]
    v_cvt_pk_bf16_f32 v37, v216, v217
    v_sub_f32 v246, v246, v255
    v_mfma_f32_16x16x32_f16 v[138:141], v[122:125], v[150:153], v[74:77]
    v_exp_f32 v246, v246
    v_mfma_f32_16x16x32_f16 v[178:181], v[226:229], v[150:153], v[78:81]
    v_cvt_pk_bf16_f32 v39, v246, 0
    v_accvgpr_write_b32 a242, v166
    v_cvt_pk_bf16_f32 v168, v168, v169
    v_mfma_f32_16x16x32_bf16 v[150:153], v[28:31], v[36:39], 0
    v_accvgpr_write_b32 a243, v168
    v_cvt_pk_bf16_f32 v92, v114, v115
    v_mfma_f32_16x16x32_bf16 v[150:153], v[28:31], v[130:133], v[150:153]
    v_cvt_pk_bf16_f32 v93, v116, v117
    v_cvt_pk_bf16_f32 v154, v154, v155
    v_mfma_f32_16x16x32_bf16 v[174:177], v[190:193], v[36:39], 0
    ds_read_b128 v[122:125], v119 offset:192
    v_accvgpr_write_b32 a232, v154
    v_mfma_f32_16x16x32_bf16 v[174:177], v[202:205], v[130:133], v[174:177]
    v_cvt_pk_bf16_f32 v156, v156, v157
    v_accvgpr_write_b32 a233, v156
    v_mfma_f32_16x16x32_bf16 v[194:197], v[198:201], v[36:39], 0
    v_cvt_pk_bf16_f32 v82, v126, v127
    v_cvt_pk_bf16_f32 v83, v128, v129
    v_mfma_f32_16x16x32_bf16 v[194:197], v[146:149], v[130:133], v[194:197]
    v_cvt_pk_bf16_f32 v106, v134, v135
    v_cvt_pk_bf16_f32 v107, v136, v137
    v_mfma_f32_16x16x32_bf16 v[214:217], v[158:161], v[36:39], 0
    ds_read_b128 v[134:137], v119 offset:256
    v_mov_b32 v255, v254
    v_mfma_f32_16x16x32_bf16 v[214:217], v[222:225], v[130:133], v[214:217]
    v_rcp_f32 v150, v150
    v_max_f32_dpp v255, v255, v255 quad_perm:[1,0,3,2] row_mask:0xf bank_mask:0xf
    v_mfma_f32_16x16x16_f16 v[182:185], v[164:165], v[234:235], v[182:185]
    v_mul_f32 v174, v150, v174
    v_max_f32_dpp v255, v255, v255 quad_perm:[2,3,0,1] row_mask:0xf bank_mask:0xf
    v_mul_f32 v175, v150, v175
    v_mfma_f32_16x16x16_f16 v[138:141], v[208:209], v[234:235], v[138:141]
    v_max_f32_dpp v255, v255, v255 row_half_mirror row_mask:0xf bank_mask:0xf
    v_cvt_pk_bf16_f32 v142, v174, v175
    v_mul_f32 v176, v150, v176
    v_mfma_f32_16x16x16_f16 v[178:181], v[236:237], v[234:235], v[178:181]
    s_waitcnt lgkmcnt(1)
    v_max3_f32 v174, v186, v182, v183
    v_max3_f32 v174, v174, v184, v185
    v_mfma_f32_16x16x16_bf16 v[114:117], a[220:221], v[144:145], v[122:125]
    v_max3_f32 v174, v174, v138, v139
    v_max3_f32 v174, v174, v140, v141
    v_max_f32_dpp v255, v255, v255 row_mirror row_mask:0xf bank_mask:0xf
    v_mfma_f32_16x16x16_bf16 v[130:133], a[244:245], v[144:145], v[122:125]
    v_max3_f32 v174, v174, v178, v179
    v_max3_f32 v174, v174, v180, v181
    v_mov_b32 v143, v174
    v_mfma_f32_16x16x16_bf16 v[126:129], v[94:95], v[144:145], v[122:125]
    s_waitcnt lgkmcnt(0)
    v_cvt_pk_bf16_f32 v114, v114, v115
    v_accvgpr_write_b32 a220, v114
    v_mfma_f32_16x16x16_bf16 v[154:157], a[222:223], v[144:145], v[134:137]
    v_cvt_pk_bf16_f32 v116, v116, v117
    v_accvgpr_write_b32 a221, v116
    v_cvt_pk_bf16_f32 v130, v130, v131
    v_mfma_f32_16x16x16_bf16 v[122:125], a[246:247], v[144:145], v[134:137]
    v_accvgpr_write_b32 a244, v130
    v_cvt_pk_bf16_f32 v132, v132, v133
    v_accvgpr_write_b32 a245, v132
    v_mfma_f32_16x16x16_bf16 v[114:117], v[96:97], v[144:145], v[134:137]
    v_cvt_pk_bf16_f32 v94, v126, v127
    v_cvt_pk_bf16_f32 v95, v128, v129
    ds_read_b128 v[126:129], v119 offset:320
    v_cvt_pk_bf16_f32 v154, v154, v155
    v_accvgpr_write_b32 a222, v154
    v_cvt_pk_bf16_f32 v156, v156, v157
    v_accvgpr_write_b32 a223, v156
    v_cvt_pk_bf16_f32 v122, v122, v123
    v_accvgpr_write_b32 a246, v122
    v_cvt_pk_bf16_f32 v124, v124, v125
    v_accvgpr_write_b32 a247, v124
    v_cvt_pk_bf16_f32 v96, v114, v115
    v_cvt_pk_bf16_f32 v97, v116, v117
    ds_read_b128 v[134:137], v119 offset:384
    v_permlane32_swap_b32 v174, v143
    v_max_f32 v174, v174, v143
    v_mov_b32 v143, v174
    v_mov_b32 v151, v255
    v_mul_f32 v177, v150, v177
    v_permlane16_swap_b32 v174, v143
    v_max_f32 v174, v174, v143
    v_sub_f32 v182, v182, v174
    v_exp_f32 v182, v182
    v_sub_f32 v183, v183, v174
    v_exp_f32 v183, v183
    s_waitcnt lgkmcnt(1)
    v_mfma_f32_16x16x16_bf16 v[114:117], a[234:235], v[144:145], v[126:129]
    v_cvt_pk_bf16_f32 v130, v182, v183
    v_sub_f32 v184, v184, v174
    v_sub_f32 v185, v185, v174
    v_mfma_f32_16x16x16_bf16 v[234:237], v[84:85], v[144:145], v[126:129]
    v_exp_f32 v184, v184
    v_sub_f32 v138, v138, v174
    v_mfma_f32_16x16x16_bf16 v[122:125], v[108:109], v[144:145], v[126:129]
    ds_read_b128 v[170:173], v0 offset:20480
    s_waitcnt lgkmcnt(1)
    v_mfma_f32_16x16x16_bf16 v[154:157], a[224:225], v[144:145], v[134:137]
    ds_read_b128 v[166:169], v1 offset:20480
    ds_read_b128 v[162:165], v0 offset:20608
    ds_read_b128 v[210:213], v1 offset:20608
    v_mfma_f32_16x16x16_bf16 v[230:233], a[248:249], v[144:145], v[134:137]
    v_cvt_pk_bf16_f32 v114, v114, v115
    v_accvgpr_write_b32 a234, v114
    v_cvt_pk_bf16_f32 v116, v116, v117
    v_mfma_f32_16x16x16_bf16 v[126:129], v[98:99], v[144:145], v[134:137]
    ds_read_b128 v[226:229], v0 offset:20736
    ds_read_b128 v[218:221], v1 offset:20736
    v_accvgpr_write_b32 a235, v116
    v_cvt_pk_bf16_f32 v84, v234, v235
    v_cvt_pk_bf16_f32 v85, v236, v237
    v_cvt_pk_bf16_f32 v108, v122, v123
    v_cvt_pk_bf16_f32 v109, v124, v125
    ds_read_b128 v[134:137], v119 offset:448
    v_cvt_pk_bf16_f32 v154, v154, v155
    v_accvgpr_write_b32 a224, v154
    v_cvt_pk_bf16_f32 v156, v156, v157
    v_accvgpr_write_b32 a225, v156
    v_cvt_pk_bf16_f32 v230, v230, v231
    v_accvgpr_write_b32 a248, v230
    s_waitcnt lgkmcnt(6)
    v_mfma_f32_16x16x32_bf16 v[114:117], a[72:75], v[170:173], 0
    v_cvt_pk_bf16_f32 v232, v232, v233
    v_accvgpr_write_b32 a249, v232
    v_mfma_f32_16x16x32_bf16 v[122:125], a[96:99], v[170:173], 0
    s_waitcnt lgkmcnt(3)
    v_cvt_pk_bf16_f32 v98, v126, v127
    v_cvt_pk_bf16_f32 v99, v128, v129
    v_mfma_f32_16x16x32_bf16 v[114:117], a[76:79], v[166:169], v[114:117]
    ds_read_b128 v[126:129], v119 offset:512
    v_sub_f32 v139, v139, v174
    v_mfma_f32_16x16x32_bf16 v[114:117], a[80:83], v[162:165], v[114:117]
    s_waitcnt lgkmcnt(2)
    v_exp_f32 v185, v185
    v_mfma_f32_16x16x32_bf16 v[114:117], a[84:87], v[210:213], v[114:117]
    v_cvt_pk_bf16_f32 v131, v184, v185
    v_sub_f32 v140, v140, v174
    v_mfma_f32_16x16x32_bf16 v[114:117], a[88:91], v[226:229], v[114:117]
    s_waitcnt lgkmcnt(1)
    v_exp_f32 v138, v138
    v_sub_f32 v141, v141, v174
    v_mfma_f32_16x16x16_bf16 v[154:157], a[226:227], v[144:145], v[134:137]
    v_exp_f32 v139, v139
    v_sub_f32 v178, v178, v174
    v_mfma_f32_16x16x16_bf16 v[182:185], a[250:251], v[144:145], v[134:137]
    v_cvt_pk_bf16_f32 v132, v138, v139
    v_exp_f32 v140, v140
    v_mfma_f32_16x16x16_bf16 v[234:237], v[100:101], v[144:145], v[134:137]
    v_exp_f32 v141, v141
    v_exp_f32 v178, v178
    v_mfma_f32_16x16x32_bf16 v[114:117], a[92:95], v[218:221], v[114:117]
    s_waitcnt lgkmcnt(0)
    v_cvt_pk_bf16_f32 v154, v154, v155
    v_accvgpr_write_b32 a226, v154
    v_cvt_pk_bf16_f32 v156, v156, v157
    v_mfma_f32_16x16x16_bf16 v[134:137], a[236:237], v[144:145], v[126:129]
    v_accvgpr_write_b32 a227, v156
    v_cvt_pk_bf16_f32 v182, v182, v183
    v_accvgpr_write_b32 a250, v182
    v_mfma_f32_16x16x16_bf16 v[154:157], v[86:87], v[144:145], v[126:129]
    v_cvt_pk_bf16_f32 v184, v184, v185
    v_accvgpr_write_b32 a251, v184
    v_cvt_pk_bf16_f32 v100, v234, v235
    v_mfma_f32_16x16x16_bf16 v[230:233], v[110:111], v[144:145], v[126:129]
    v_cvt_pk_bf16_f32 v101, v236, v237
    v_cvt_pk_bf16_f32 v134, v134, v135
    v_accvgpr_write_b32 a236, v134
    v_cvt_pk_bf16_f32 v136, v136, v137
    v_mfma_f32_16x16x32_bf16 v[122:125], a[100:103], v[166:169], v[122:125]
    ds_read_b128 v[182:185], v119 offset:576
    v_accvgpr_write_b32 a237, v136
    v_mfma_f32_16x16x32_bf16 v[122:125], a[104:107], v[162:165], v[122:125]
    v_cvt_pk_bf16_f32 v86, v154, v155
    v_cvt_pk_bf16_f32 v87, v156, v157
    v_mfma_f32_16x16x32_bf16 v[122:125], a[108:111], v[210:213], v[122:125]
    v_cvt_pk_bf16_f32 v110, v230, v231
    v_cvt_pk_bf16_f32 v111, v232, v233
    v_mfma_f32_16x16x32_bf16 v[122:125], a[112:115], v[226:229], v[122:125]
    ds_read_b128 v[134:137], v119 offset:640
    v_cvt_pk_bf16_f32 v133, v140, v141
    v_mfma_f32_16x16x32_bf16 v[122:125], a[116:119], v[218:221], v[122:125]
    v_sub_f32 v179, v179, v174
    v_sub_f32 v180, v180, v174
    v_mfma_f32_16x16x32_bf16 v[126:129], a[120:123], v[170:173], 0
    v_exp_f32 v179, v179
    v_mfma_f32_16x16x32_bf16 v[126:129], a[124:127], v[166:169], v[126:129]
    v_cvt_pk_bf16_f32 v36, v178, v179
    v_sub_f32 v181, v181, v174
    v_mfma_f32_16x16x32_bf16 v[126:129], a[128:131], v[162:165], v[126:129]
    v_exp_f32 v180, v180
    v_mfma_f32_16x16x32_bf16 v[126:129], a[132:135], v[210:213], v[126:129]
    s_waitcnt lgkmcnt(1)
    v_exp_f32 v181, v181
    v_sub_f32 v186, v186, v174
    v_mfma_f32_16x16x16_bf16 v[138:141], a[228:229], v[144:145], v[182:185]
    v_cvt_pk_bf16_f32 v37, v180, v181
    v_exp_f32 v186, v186
    v_mfma_f32_16x16x16_bf16 v[178:181], a[252:253], v[144:145], v[182:185]
    v_cvt_pk_bf16_f32 v39, v186, 0
    v_permlane32_swap_b32 v255, v151
    v_mfma_f32_16x16x16_bf16 v[186:189], v[102:103], v[144:145], v[182:185]
    v_max_f32 v255, v255, v151
    v_mov_b32 v151, v255
    v_cvt_pk_bf16_f32 v138, v138, v139
    v_accvgpr_write_b32 a228, v138
    v_mfma_f32_16x16x32_bf16 v[154:157], v[28:31], v[36:39], 0
    s_waitcnt lgkmcnt(0)
    v_cvt_pk_bf16_f32 v140, v140, v141
    v_accvgpr_write_b32 a229, v140
    v_mfma_f32_16x16x32_bf16 v[154:157], v[28:31], v[130:133], v[154:157]
    v_cvt_pk_bf16_f32 v178, v178, v179
    v_accvgpr_write_b32 a252, v178
    v_mfma_f32_16x16x32_bf16 v[138:141], v[190:193], v[36:39], 0
    v_cvt_pk_bf16_f32 v180, v180, v181
    v_accvgpr_write_b32 a253, v180
    v_mfma_f32_16x16x32_bf16 v[138:141], v[202:205], v[130:133], v[138:141]
    v_cvt_pk_bf16_f32 v102, v186, v187
    v_cvt_pk_bf16_f32 v103, v188, v189
    v_mfma_f32_16x16x32_bf16 v[178:181], v[198:201], v[36:39], 0
    ds_read_b128 v[186:189], v119 offset:704
    v_cvt_pk_bf16_f32 v143, v176, v177
    v_mfma_f32_16x16x32_bf16 v[178:181], v[146:149], v[130:133], v[178:181]
    v_rcp_f32 v154, v154
    v_mfma_f32_16x16x32_bf16 v[118:121], v[158:161], v[36:39], 0
    v_mul_f32 v138, v154, v138
    v_mul_f32 v139, v154, v139
    v_mfma_f32_16x16x32_bf16 v[118:121], v[222:225], v[130:133], v[118:121]
    v_cvt_pk_bf16_f32 v138, v138, v139
    v_mul_f32 v140, v154, v140
    v_mul_f32 v141, v154, v141
    v_mfma_f32_16x16x16_bf16 v[130:133], a[230:231], v[144:145], v[134:137]
    v_cvt_pk_bf16_f32 v139, v140, v141
    v_mul_f32 v178, v154, v178
    v_mul_f32 v179, v154, v179
    v_mfma_f32_16x16x16_bf16 v[174:177], a[254:255], v[144:145], v[134:137]
    v_cvt_pk_bf16_f32 v140, v178, v179
    v_mul_f32 v180, v154, v180
    v_mul_f32 v181, v154, v181
    v_mfma_f32_16x16x16_bf16 v[182:185], v[104:105], v[144:145], v[134:137]
    v_cvt_pk_bf16_f32 v141, v180, v181
    v_mul_f32 v118, v154, v118
    v_mul_f32 v119, v154, v119
    v_cvt_pk_bf16_f32 v152, v118, v119
    v_mfma_f32_16x16x32_bf16 v[126:129], a[136:139], v[226:229], v[126:129]
    s_waitcnt lgkmcnt(0)
    ds_write_b128 v3, v[138:141] offset:12288
    v_mfma_f32_16x16x16_bf16 v[134:137], a[238:239], v[144:145], v[186:189]
    v_mul_f32 v120, v154, v120
    v_mul_f32 v121, v154, v121
    v_cvt_pk_bf16_f32 v153, v120, v121
    v_mfma_f32_16x16x16_bf16 v[178:181], v[88:89], v[144:145], v[186:189]
    v_cvt_pk_bf16_f32 v130, v130, v131
    v_accvgpr_write_b32 a230, v130
    v_cvt_pk_bf16_f32 v132, v132, v133
    v_mfma_f32_16x16x16_bf16 v[138:141], v[112:113], v[144:145], v[186:189]
    v_accvgpr_write_b32 a231, v132
    v_cvt_pk_bf16_f32 v174, v174, v175
    v_accvgpr_write_b32 a254, v174
    v_cvt_pk_bf16_f32 v176, v176, v177
    v_mfma_f32_16x16x32_bf16 v[126:129], a[140:143], v[218:221], v[126:129]
    ds_write_b64 v4, v[152:153] offset:16384
    v_mfma_f32_16x16x32_bf16 v[154:157], a[0:3], v[170:173], 0
    v_accvgpr_write_b32 a255, v176
    v_cvt_pk_bf16_f32 v104, v182, v183
    v_mfma_f32_16x16x32_bf16 v[154:157], a[4:7], v[166:169], v[154:157]
    v_cvt_pk_bf16_f32 v105, v184, v185
    v_cvt_pk_bf16_f32 v134, v134, v135
    v_mfma_f32_16x16x32_bf16 v[154:157], a[8:11], v[162:165], v[154:157]
    v_accvgpr_write_b32 a238, v134
    v_cvt_pk_bf16_f32 v136, v136, v137
    v_mfma_f32_16x16x32_bf16 v[154:157], a[12:15], v[210:213], v[154:157]
    v_accvgpr_write_b32 a239, v136
    v_cvt_pk_bf16_f32 v88, v178, v179
    v_mfma_f32_16x16x32_bf16 v[154:157], a[16:19], v[226:229], v[154:157]
    v_cvt_pk_bf16_f32 v89, v180, v181
    v_cvt_pk_bf16_f32 v112, v138, v139
    v_mfma_f32_16x16x32_bf16 v[154:157], a[20:23], v[218:221], v[154:157]
    v_cvt_pk_bf16_f32 v113, v140, v141
    v_mul_f32 v194, v150, v194
    v_mfma_f32_16x16x32_bf16 v[174:177], a[24:27], v[170:173], 0
    v_permlane16_swap_b32 v255, v151
    v_mfma_f32_16x16x32_bf16 v[174:177], a[28:31], v[166:169], v[174:177]
    v_max_f32 v255, v255, v151
    v_sub_f32 v254, v254, v255
    v_mfma_f32_16x16x32_bf16 v[174:177], a[32:35], v[162:165], v[174:177]
    v_exp_f32 v254, v254
    v_mfma_f32_16x16x32_bf16 v[174:177], a[36:39], v[210:213], v[174:177]
    v_cvt_pk_bf16_f32 v254, v254, v254
    v_mul_f32 v195, v150, v195
    v_mfma_f32_16x16x32_bf16 v[174:177], a[40:43], v[226:229], v[174:177]
    ds_write_b16 v8, v254
    v_mfma_f32_16x16x32_bf16 v[174:177], a[44:47], v[218:221], v[174:177]
    v_cvt_pk_bf16_f32 v144, v194, v195
    v_mul_f32 v196, v150, v196
    v_mfma_f32_16x16x32_bf16 v[182:185], a[48:51], v[170:173], 0
    ds_read_b128 v[134:137], v9
    ds_read_b128 v[178:181], v9 offset:64
    v_mfma_f32_16x16x32_bf16 v[182:185], a[52:55], v[166:169], v[182:185]
    v_mul_f32 v197, v150, v197
    v_cvt_pk_bf16_f32 v145, v196, v197
    v_mfma_f32_16x16x32_bf16 v[182:185], a[56:59], v[162:165], v[182:185]
    ds_write_b128 v3, v[142:145] offset:6144
    v_mfma_f32_16x16x32_bf16 v[182:185], a[60:63], v[210:213], v[182:185]
    v_mul_f32 v214, v150, v214
    v_mul_f32 v215, v150, v215
    v_mfma_f32_16x16x32_bf16 v[182:185], a[64:67], v[226:229], v[182:185]
    v_cvt_pk_bf16_f32 v254, v214, v215
    v_mul_f32 v216, v150, v216
    v_mfma_f32_16x16x32_bf16 v[182:185], a[68:71], v[218:221], v[182:185]
    v_mul_f32 v217, v150, v217
    v_cvt_pk_bf16_f32 v255, v216, v217
    v_mfma_f32_16x16x32_bf16 v[230:233], v[170:173], a[144:147], 0
    ds_write_b64 v4, v[254:255] offset:10240
    v_mfma_f32_16x16x32_bf16 v[230:233], v[166:169], a[148:151], v[230:233]
    s_waitcnt lgkmcnt(2)
    v_xor_b32 v3, 65536, v3
    v_xor_b32 v4, 65536, v4
    v_mfma_f32_16x16x32_bf16 v[142:145], v[134:137], v[28:31], 0
    v_mfma_f32_16x16x32_bf16 v[142:145], v[178:181], v[28:31], v[142:145]
    v_mfma_f32_16x16x32_bf16 v[130:133], v[134:137], v[202:205], 0
    v_mfma_f32_16x16x32_bf16 v[130:133], v[178:181], v[190:193], v[130:133]
    v_mfma_f32_16x16x32_bf16 v[150:153], v[134:137], v[146:149], 0
    v_mfma_f32_16x16x32_bf16 v[150:153], v[178:181], v[198:201], v[150:153]
    v_mfma_f32_16x16x32_bf16 v[138:141], v[134:137], v[222:225], 0
    v_mfma_f32_16x16x32_bf16 v[138:141], v[178:181], v[158:161], v[138:141]
    v_mfma_f32_16x16x32_bf16 v[230:233], v[162:165], a[152:155], v[230:233]
    v_mfma_f32_16x16x32_bf16 v[230:233], v[210:213], a[156:159], v[230:233]
    v_rcp_f32 v142, v142
    v_mfma_f32_16x16x32_bf16 v[230:233], v[226:229], a[160:163], v[230:233]
    v_mul_f32 v130, v130, v142
    v_mfma_f32_16x16x32_bf16 v[230:233], v[218:221], a[164:167], v[230:233]
    v_mul_f32_dpp v130, v150, v142 quad_perm:[0,1,2,3] row_mask:0x2 bank_mask:0xf
    s_nop 0
    v_mul_f32_dpp v130, v138, v142 quad_perm:[0,1,2,3] row_mask:0x4 bank_mask:0xf
    v_cvt_pk_bf16_f32 v130, v130, v130
    ds_write_b16 v7, v130
    v_add_u32 v7, 16, v7
    s_waitcnt lgkmcnt(0)
    s_barrier
    s_waitcnt lgkmcnt(0)
    s_cmp_eq_u32 s17, 1
    s_cbranch_scc1 L_drain
    s_max_u32 s3, s37, s44
    s_cmp_gt_u32 s3, 0x42000000
    s_cbranch_scc1 L_safe
    v_cvt_pk_f16_f32 v118, v114, v115
    v_pk_mul_f16 v223, v118, v118
    v_cvt_pk_f16_f32 v119, v116, v117
    v_pk_mul_f16 v225, v119, v119
    v_cvt_pk_f16_f32 v120, v122, v123
    v_pk_fma_f16 v223, v120, v120, v223
    v_cvt_pk_f16_f32 v121, v124, v125
    v_pk_fma_f16 v225, v121, v121, v225
    v_cvt_pk_f16_f32 v196, v126, v127
    v_pk_fma_f16 v223, v196, v196, v223
    v_cvt_pk_f16_f32 v197, v128, v129
    v_pk_fma_f16 v225, v197, v197, v225
    v_cvt_pk_f16_f32 v206, v154, v155
    s_nop 7
    s_branch L_go
L_safe:
    v_fma_f32 v130, v114, v114, s32
    v_fmac_f32 v130, v115, v115
    v_fmac_f32 v130, v116, v116
    v_fmac_f32 v130, v117, v117
    v_fmac_f32 v130, v122, v122
    v_fmac_f32 v130, v123, v123
    v_fmac_f32 v130, v124, v124
    v_fmac_f32 v130, v125, v125
    v_fmac_f32 v130, v126, v126
    v_fmac_f32 v130, v127, v127
    v_fmac_f32 v130, v128, v128
    v_fmac_f32 v130, v129, v129
    v_fma_f32 v131, v154, v154, s32
    v_fmac_f32 v131, v155, v155
    v_fmac_f32 v131, v156, v156
    v_fmac_f32 v131, v157, v157
    v_fmac_f32 v131, v174, v174
    s_nop 7
    s_cmp_eq_u32 s16, 1
    s_cbranch_scc1 L_loop_safe1
    s_cmp_eq_u32 s16, 2
    s_cbranch_scc1 L_loop_safe2
    s_cmp_eq_u32 s16, 3
    s_cbranch_scc1 L_loop_safe3
    s_branch L_loop_safe0
.p2align 6
L_loop_safe0:
    v_mfma_f32_16x16x32_bf16 v[194:197], v[170:173], a[168:171], 0
    s_add_u32 s12, s42, s27
    ds_read_b128 v[198:201], v2 offset:18432
    ds_read_b128 v[214:217], v2 offset:19456
    v_mfma_f32_16x16x32_bf16 v[194:197], v[166:169], a[172:175], v[194:197]
    s_addc_u32 s13, s43, 0
    v_fmac_f32 v131, v175, v175
    v_fmac_f32 v131, v176, v176
    v_mfma_f32_16x16x32_bf16 v[194:197], v[162:165], a[176:179], v[194:197]
    s_sub_u32 s14, s36, s27
    v_fmac_f32 v131, v177, v177
    v_fmac_f32 v131, v182, v182
    v_mfma_f32_16x16x32_bf16 v[194:197], v[210:213], a[180:183], v[194:197]
    s_cmp_ge_u32 s18, 2
    v_fmac_f32 v131, v183, v183
    v_fmac_f32 v131, v184, v184
    v_mfma_f32_16x16x32_bf16 v[194:197], v[226:229], a[184:187], v[194:197]
    s_cselect_b32 s14, s14, 0
    ds_read_b128 v[118:121], v0 offset:26624
    v_fmac_f32 v131, v185, v185
    v_mfma_f32_16x16x32_bf16 v[194:197], v[218:221], a[188:191], v[194:197]
    s_add_u32 s34, s18, 2
    ds_read_b128 v[134:137], v1 offset:26624
    v_cvt_pk_bf16_f32 v36, v131, v130
    v_mfma_f32_16x16x32_bf16 v[234:237], v[170:173], a[192:195], 0
    s_add_u32 s8, s40, s23
    ds_read_b128 v[170:173], v0 offset:26752
    v_cvt_pk_bf16_f32 v230, v230, v231
    v_mfma_f32_16x16x32_bf16 v[234:237], v[166:169], a[196:199], v[234:237]
    s_addc_u32 s9, s41, 0
    ds_read_b128 v[166:169], v1 offset:26752
    v_cvt_pk_bf16_f32 v231, v232, v233
    v_mfma_f32_16x16x32_bf16 v[222:225], v[32:35], v[36:39], 0
    s_sub_u32 s10, s36, s23
    v_cvt_pk_bf16_f32 v130, v194, v195
    v_cvt_pk_bf16_f32 v131, v196, v197
    v_mfma_f32_16x16x32_bf16 v[234:237], v[162:165], a[200:203], v[234:237]
    s_waitcnt lgkmcnt(4)
    ds_read_b128 v[194:197], v0 offset:26880
    s_cmp_lt_u32 s34, s17
    v_mfma_f32_16x16x32_bf16 v[206:209], v[32:35], v[198:201], 0
    s_cselect_b32 s10, s10, 0
    v_rsq_f32 v223, v223
    v_mfma_f32_16x16x32_bf16 v[206:209], v[32:35], v[214:217], v[206:209]
    s_add_u32 m0, s28, 0
    v_rsq_f32 v222, v222
    v_mfma_f32_16x16x32_bf16 v[234:237], v[210:213], a[204:207], v[234:237]
    s_waitcnt lgkmcnt(4)
    ds_read_b128 v[198:201], v1 offset:26880
    v_mul_f32 v222, s31, v222
    v_mfma_f32_16x16x32_bf16 v[234:237], v[226:229], a[208:211], v[234:237]
    s_mov_b32 s27, s26
    v_mul_f32 v114, v223, v114
    v_mul_f32 v115, v223, v115
    v_mfma_f32_16x16x32_bf16 v[234:237], v[218:221], a[212:215], v[234:237]
    s_mov_b32 s26, s25
    v_cvt_pk_f16_f32 v218, v114, v115
    v_mul_f32 v116, v223, v116
    v_mfma_f32_16x16x32_bf16 v[226:229], a[72:75], v[118:121], 0
    s_waitcnt lgkmcnt(2)
    v_mul_f32 v117, v223, v117
    v_cvt_pk_f16_f32 v219, v116, v117
    v_mfma_f32_16x16x32_bf16 v[226:229], a[76:79], v[134:137], v[226:229]
    s_mov_b32 s25, s24
    v_cvt_pk_bf16_f32 v114, v234, v235
    v_cvt_pk_bf16_f32 v115, v236, v237
    v_mfma_f32_16x16x32_bf16 v[226:229], a[80:83], v[170:173], v[226:229]
    s_mov_b32 s24, s23
    v_mul_f32 v122, v223, v122
    v_mul_f32 v123, v223, v123
    v_mfma_f32_16x16x32_bf16 v[226:229], a[84:87], v[166:169], v[226:229]
    s_waitcnt lgkmcnt(1)
    v_cvt_pk_f16_f32 v220, v122, v123
    v_mul_f32 v124, v223, v124
    v_mfma_f32_16x16x32_bf16 v[226:229], a[88:91], v[194:197], v[226:229]
    v_mul_f32 v125, v223, v125
    v_cvt_pk_f16_f32 v221, v124, v125
    v_mfma_f32_16x16x32_bf16 v[122:125], a[96:99], v[118:121], 0
    s_waitcnt lgkmcnt(0)
    v_mul_f32 v126, v223, v126
    v_mul_f32 v127, v223, v127
    v_mfma_f32_16x16x32_bf16 v[226:229], a[92:95], v[198:201], v[226:229]
    v_cvt_pk_f16_f32 v164, v126, v127
    v_mul_f32 v128, v223, v128
    v_mfma_f32_16x16x32_bf16 v[122:125], a[100:103], v[134:137], v[122:125]
    v_mul_f32 v129, v223, v129
    v_cvt_pk_f16_f32 v165, v128, v129
    v_mfma_f32_16x16x32_bf16 v[122:125], a[104:107], v[170:173], v[122:125]
    v_mul_f32 v154, v222, v154
    v_mul_f32 v155, v222, v155
    v_mfma_f32_16x16x32_bf16 v[122:125], a[108:111], v[166:169], v[122:125]
    v_cvt_pk_f16_f32 v210, v154, v155
    v_mul_f32 v156, v222, v156
    v_mfma_f32_16x16x32_bf16 v[122:125], a[112:115], v[194:197], v[122:125]
    v_mul_f32 v157, v222, v157
    v_cvt_pk_f16_f32 v211, v156, v157
    v_mfma_f32_16x16x32_bf16 v[122:125], a[116:119], v[198:201], v[122:125]
    v_mul_f32 v174, v222, v174
    v_mul_f32 v175, v222, v175
    v_mfma_f32_16x16x32_bf16 v[126:129], a[120:123], v[118:121], 0
    v_cvt_pk_f16_f32 v212, v174, v175
    v_mul_f32 v176, v222, v176
    v_mfma_f32_16x16x32_bf16 v[126:129], a[124:127], v[134:137], v[126:129]
    v_mul_f32 v177, v222, v177
    v_cvt_pk_f16_f32 v213, v176, v177
    v_mfma_f32_16x16x32_bf16 v[126:129], a[128:131], v[170:173], v[126:129]
    v_mul_f32 v182, v222, v182
    v_mul_f32 v183, v222, v183
    v_mfma_f32_16x16x32_bf16 v[126:129], a[132:135], v[166:169], v[126:129]
    v_cvt_pk_f16_f32 v162, v182, v183
    v_mul_f32 v184, v222, v184
    v_mfma_f32_16x16x32_bf16 v[126:129], a[136:139], v[194:197], v[126:129]
    v_mul_f32 v185, v222, v185
    v_cvt_pk_f16_f32 v163, v184, v185
    v_mfma_f32_16x16x32_bf16 v[126:129], a[140:143], v[198:201], v[126:129]
    v_fma_f32 v116, v226, v226, s32
    v_fmac_f32 v116, v227, v227
    v_mfma_f32_16x16x32_bf16 v[154:157], a[0:3], v[118:121], 0
    v_fmac_f32 v116, v228, v228
    v_fmac_f32 v116, v229, v229
    v_mfma_f32_16x16x32_bf16 v[154:157], a[4:7], v[134:137], v[154:157]
    v_fmac_f32 v116, v122, v122
    v_fmac_f32 v116, v123, v123
    v_mfma_f32_16x16x32_bf16 v[154:157], a[8:11], v[170:173], v[154:157]
    v_fmac_f32 v116, v124, v124
    v_fmac_f32 v116, v125, v125
    v_mfma_f32_16x16x32_bf16 v[154:157], a[12:15], v[166:169], v[154:157]
    v_fmac_f32 v116, v126, v126
    v_fmac_f32 v116, v127, v127
    v_mfma_f32_16x16x32_bf16 v[154:157], a[16:19], v[194:197], v[154:157]
    v_fmac_f32 v116, v128, v128
    v_fmac_f32 v116, v129, v129
    v_mfma_f32_16x16x32_bf16 v[154:157], a[20:23], v[198:201], v[154:157]
    v_mul_f32 v117, 0x3baaaaab, v206
    v_mul_f32 v254, 0x3baaaaab, v207
    v_mfma_f32_16x16x32_bf16 v[174:177], a[24:27], v[118:121], 0
    v_rsq_f32 v117, v117
    v_mfma_f32_16x16x32_bf16 v[174:177], a[28:31], v[134:137], v[174:177]
    v_rsq_f32 v254, v254
    v_mfma_f32_16x16x32_bf16 v[174:177], a[32:35], v[170:173], v[174:177]
    v_mul_f32 v255, 0x3baaaaab, v208
    v_fma_f32 v132, v154, v154, s32
    v_mfma_f32_16x16x32_bf16 v[174:177], a[36:39], v[166:169], v[174:177]
    v_fmac_f32 v132, v155, v155
    v_fmac_f32 v132, v156, v156
    v_mfma_f32_16x16x32_bf16 v[174:177], a[40:43], v[194:197], v[174:177]
    v_fmac_f32 v132, v157, v157
    v_mul_f32 v150, v117, v150
    v_mfma_f32_16x16x32_bf16 v[174:177], a[44:47], v[198:201], v[174:177]
    v_rsq_f32 v255, v255
    v_mfma_f32_16x16x32_bf16 v[182:185], a[48:51], v[118:121], 0
    v_mul_f32 v151, v117, v151
    v_cvt_pk_bf16_f32 v214, v150, v151
    v_mfma_f32_16x16x32_bf16 v[182:185], a[52:55], v[134:137], v[182:185]
    v_mul_f32 v152, v117, v152
    v_mul_f32 v153, v117, v153
    v_mfma_f32_16x16x32_bf16 v[182:185], a[56:59], v[170:173], v[182:185]
    v_fmac_f32 v132, v174, v174
    v_fmac_f32 v132, v175, v175
    v_mfma_f32_16x16x32_bf16 v[182:185], a[60:63], v[166:169], v[182:185]
    v_fmac_f32 v132, v176, v176
    v_fmac_f32 v132, v177, v177
    v_mfma_f32_16x16x32_bf16 v[182:185], a[64:67], v[194:197], v[182:185]
    v_cvt_pk_bf16_f32 v215, v152, v153
    v_mul_f32 v190, v117, v190
    v_mfma_f32_16x16x32_bf16 v[182:185], a[68:71], v[198:201], v[182:185]
    v_mul_f32 v191, v117, v191
    v_cvt_pk_bf16_f32 v216, v190, v191
    v_mfma_f32_16x16x32_bf16 v[150:153], v[118:121], a[144:147], 0
    v_mul_f32 v192, v117, v192
    v_mul_f32 v193, v117, v193
    v_mfma_f32_16x16x32_bf16 v[150:153], v[134:137], a[148:151], v[150:153]
    v_cvt_pk_bf16_f32 v217, v192, v193
    v_mul_f32 v202, v117, v202
    v_mfma_f32_16x16x32_bf16 v[150:153], v[170:173], a[152:155], v[150:153]
    buffer_store_dwordx4 v[214:217], v15, s[12:15], 0 offen nt
    v_fmac_f32 v132, v182, v182
    v_fmac_f32 v132, v183, v183
    v_fmac_f32 v132, v184, v184
    v_fmac_f32 v132, v185, v185
    v_mfma_f32_16x16x32_bf16 v[150:153], v[166:169], a[156:159], v[150:153]
    v_cvt_pk_bf16_f32 v36, v132, v116
    v_mul_f32 v203, v117, v203
    v_mfma_f32_16x16x32_bf16 v[150:153], v[194:197], a[160:163], v[150:153]
    v_cvt_pk_bf16_f32 v116, v202, v203
    v_mul_f32 v204, v117, v204
    v_mfma_f32_16x16x32_bf16 v[190:193], v[32:35], v[36:39], 0
    v_mul_f32 v205, v117, v205
    v_cvt_pk_bf16_f32 v117, v204, v205
    v_mfma_f32_16x16x32_bf16 v[150:153], v[198:201], a[164:167], v[150:153]
    v_mul_f32 v146, v255, v146
    v_mul_f32 v147, v255, v147
    v_mfma_f32_16x16x32_bf16 v[202:205], v[118:121], a[168:171], 0
    v_cvt_pk_bf16_f32 v146, v146, v147
    v_mul_f32 v148, v255, v148
    v_mfma_f32_16x16x32_bf16 v[202:205], v[134:137], a[172:175], v[202:205]
    v_rsq_f32 v191, v191
    v_mfma_f32_16x16x32_bf16 v[202:205], v[170:173], a[176:179], v[202:205]
    v_cvt_pk_bf16_f32 v232, v150, v151
    v_cvt_pk_bf16_f32 v233, v152, v153
    v_mfma_f32_16x16x32_bf16 v[202:205], v[166:169], a[180:183], v[202:205]
    v_rsq_f32 v190, v190
    v_mfma_f32_16x16x32_bf16 v[202:205], v[194:197], a[184:187], v[202:205]
    ds_read_b128 v[150:153], v0 offset:32768
    v_mul_f32 v190, s31, v190
    v_mfma_f32_16x16x32_bf16 v[202:205], v[198:201], a[188:191], v[202:205]
    ds_read_b128 v[206:209], v1 offset:32768
    v_mul_f32 v226, v191, v226
    v_mfma_f32_16x16x32_bf16 v[214:217], v[118:121], a[192:195], 0
    ds_read_b128 v[118:121], v0 offset:32896
    v_mul_f32 v227, v191, v227
    v_mfma_f32_16x16x32_bf16 v[214:217], v[134:137], a[196:199], v[214:217]
    ds_read_b128 v[134:137], v1 offset:32896
    v_cvt_pk_f16_f32 v226, v226, v227
    v_mfma_f32_16x16x32_bf16 v[214:217], v[170:173], a[200:203], v[214:217]
    ds_read_b128 v[170:173], v0 offset:33024
    v_cvt_pk_bf16_f32 v132, v202, v203
    v_mfma_f32_16x16x32_bf16 v[214:217], v[166:169], a[204:207], v[214:217]
    ds_read_b128 v[166:169], v1 offset:33024
    v_cvt_pk_bf16_f32 v133, v204, v205
    v_mfma_f32_16x16x32_bf16 v[214:217], v[194:197], a[208:211], v[214:217]
    v_mul_f32 v228, v191, v228
    v_mul_f32 v229, v191, v229
    v_mfma_f32_16x16x32_bf16 v[214:217], v[198:201], a[212:215], v[214:217]
    v_cvt_pk_f16_f32 v227, v228, v229
    v_mul_f32 v122, v191, v122
    v_mfma_f32_16x16x32_f16 v[194:197], v[218:221], v[210:213], v[46:49]
    s_waitcnt lgkmcnt(5)
    buffer_store_dwordx2 v[116:117], v18, s[12:15], 0 offen nt
    v_mul_f32 v123, v191, v123
    v_cvt_pk_f16_f32 v228, v122, v123
    v_mfma_f32_16x16x32_bf16 v[202:205], a[72:75], v[150:153], 0
    s_waitcnt lgkmcnt(3)
    v_cvt_pk_bf16_f32 v116, v214, v215
    v_cvt_pk_bf16_f32 v117, v216, v217
    v_mfma_f32_16x16x32_bf16 v[202:205], a[76:79], v[206:209], v[202:205]
    s_waitcnt lgkmcnt(2)
    v_mul_f32 v124, v191, v124
    v_mul_f32 v125, v191, v125
    v_mfma_f32_16x16x32_bf16 v[202:205], a[80:83], v[118:121], v[202:205]
    s_waitcnt lgkmcnt(1)
    v_cvt_pk_f16_f32 v229, v124, v125
    v_mul_f32 v126, v191, v126
    v_mfma_f32_16x16x32_bf16 v[202:205], a[84:87], v[134:137], v[202:205]
    s_waitcnt lgkmcnt(0)
    v_mul_f32 v127, v191, v127
    v_cvt_pk_f16_f32 v124, v126, v127
    v_mfma_f32_16x16x32_bf16 v[202:205], a[88:91], v[170:173], v[202:205]
    v_mul_f32 v128, v191, v128
    v_mul_f32 v129, v191, v129
    v_mfma_f32_16x16x32_bf16 v[202:205], a[92:95], v[166:169], v[202:205]
    v_cvt_pk_f16_f32 v125, v128, v129
    v_mul_f32 v154, v190, v154
    v_mfma_f32_16x16x32_bf16 v[126:129], a[96:99], v[150:153], 0
    v_mul_f32 v155, v190, v155
    v_cvt_pk_f16_f32 v154, v154, v155
    v_mfma_f32_16x16x32_bf16 v[126:129], a[100:103], v[206:209], v[126:129]
    v_mul_f32 v156, v190, v156
    v_mul_f32 v157, v190, v157
    v_mfma_f32_16x16x32_bf16 v[126:129], a[104:107], v[118:121], v[126:129]
    v_cvt_pk_f16_f32 v155, v156, v157
    v_mul_f32 v174, v190, v174
    v_mfma_f32_16x16x32_bf16 v[126:129], a[108:111], v[134:137], v[126:129]
    v_mul_f32 v175, v190, v175
    v_cvt_pk_f16_f32 v156, v174, v175
    v_mfma_f32_16x16x32_bf16 v[126:129], a[112:115], v[170:173], v[126:129]
    v_mul_f32 v176, v190, v176
    v_mul_f32 v177, v190, v177
    v_mfma_f32_16x16x32_bf16 v[126:129], a[116:119], v[166:169], v[126:129]
    v_cvt_pk_f16_f32 v157, v176, v177
    v_mul_f32 v182, v190, v182
    v_mfma_f32_16x16x32_bf16 v[174:177], a[120:123], v[150:153], 0
    v_mul_f32 v183, v190, v183
    v_cvt_pk_f16_f32 v122, v182, v183
    v_mfma_f32_16x16x32_bf16 v[174:177], a[124:127], v[206:209], v[174:177]
    v_mul_f32 v184, v190, v184
    v_mul_f32 v185, v190, v185
    v_mfma_f32_16x16x32_bf16 v[174:177], a[128:131], v[118:121], v[174:177]
    v_cvt_pk_f16_f32 v123, v184, v185
    v_fma_f32 v182, v202, v202, s32
    v_mfma_f32_16x16x32_bf16 v[174:177], a[132:135], v[134:137], v[174:177]
    v_fmac_f32 v182, v203, v203
    v_fmac_f32 v182, v204, v204
    v_mfma_f32_16x16x32_bf16 v[174:177], a[136:139], v[170:173], v[174:177]
    v_fmac_f32 v182, v205, v205
    v_fmac_f32 v182, v126, v126
    v_mfma_f32_16x16x32_bf16 v[174:177], a[140:143], v[166:169], v[174:177]
    v_fmac_f32 v182, v127, v127
    v_fmac_f32 v182, v128, v128
    v_mfma_f32_16x16x32_bf16 v[190:193], a[0:3], v[150:153], 0
    v_fmac_f32 v182, v129, v129
    v_mul_f32 v149, v255, v149
    v_mfma_f32_16x16x32_bf16 v[190:193], a[4:7], v[206:209], v[190:193]
    v_cvt_pk_bf16_f32 v147, v148, v149
    v_mul_f32 v138, v255, v138
    v_mfma_f32_16x16x32_bf16 v[190:193], a[8:11], v[118:121], v[190:193]
    v_fmac_f32 v182, v174, v174
    v_fmac_f32 v182, v175, v175
    v_mfma_f32_16x16x32_bf16 v[190:193], a[12:15], v[134:137], v[190:193]
    v_fmac_f32 v182, v176, v176
    v_fmac_f32 v182, v177, v177
    v_mfma_f32_16x16x32_bf16 v[190:193], a[16:19], v[170:173], v[190:193]
    v_mul_f32 v139, v255, v139
    v_cvt_pk_bf16_f32 v148, v138, v139
    v_mfma_f32_16x16x32_bf16 v[190:193], a[20:23], v[166:169], v[190:193]
    v_mul_f32 v140, v255, v140
    v_mul_f32 v141, v255, v141
    v_mfma_f32_16x16x32_bf16 v[198:201], a[24:27], v[150:153], 0
    v_cvt_pk_bf16_f32 v149, v140, v141
    v_mul_f32 v186, v255, v186
    v_mfma_f32_16x16x32_bf16 v[198:201], a[28:31], v[206:209], v[198:201]
    buffer_store_dwordx4 v[146:149], v17, s[12:15], 0 offen nt
    v_mul_f32 v187, v255, v187
    v_fma_f32 v183, v190, v190, s32
    v_fmac_f32 v183, v191, v191
    v_fmac_f32 v183, v192, v192
    v_mfma_f32_16x16x32_bf16 v[198:201], a[32:35], v[118:121], v[198:201]
    v_fmac_f32 v183, v193, v193
    v_cvt_pk_bf16_f32 v184, v186, v187
    v_mfma_f32_16x16x32_bf16 v[198:201], a[36:39], v[134:137], v[198:201]
    v_mul_f32 v188, v255, v188
    v_mul_f32 v189, v255, v189
    v_mfma_f32_16x16x32_bf16 v[198:201], a[40:43], v[170:173], v[198:201]
    v_cvt_pk_bf16_f32 v185, v188, v189
    v_mul_f32 v142, v254, v142
    v_mfma_f32_16x16x32_bf16 v[198:201], a[44:47], v[166:169], v[198:201]
    v_mul_f32 v143, v254, v143
    v_cvt_pk_bf16_f32 v142, v142, v143
    v_mfma_f32_16x16x32_bf16 v[138:141], a[48:51], v[150:153], 0
    v_mul_f32 v144, v254, v144
    v_mul_f32 v145, v254, v145
    v_mfma_f32_16x16x32_bf16 v[138:141], a[52:55], v[206:209], v[138:141]
    v_cvt_pk_bf16_f32 v143, v144, v145
    v_mul_f32 v158, v254, v158
    v_mfma_f32_16x16x32_bf16 v[138:141], a[56:59], v[118:121], v[138:141]
    v_fmac_f32 v183, v198, v198
    v_fmac_f32 v183, v199, v199
    v_mfma_f32_16x16x32_bf16 v[138:141], a[60:63], v[134:137], v[138:141]
    ds_read2_b32 v[216:217], v6 offset0:0 offset1:0
    ds_read2_b32 v[224:225], v6 offset0:16 offset1:16
    v_mfma_f32_16x16x32_bf16 v[138:141], a[64:67], v[170:173], v[138:141]
    ds_read2_b32 v[236:237], v6 offset0:32 offset1:32
    v_fmac_f32 v183, v200, v200
    v_mfma_f32_16x16x32_bf16 v[138:141], a[68:71], v[166:169], v[138:141]
    v_fmac_f32 v183, v201, v201
    v_mul_f32 v159, v254, v159
    v_mfma_f32_16x16x32_bf16 v[146:149], v[150:153], a[144:147], 0
    v_cvt_pk_bf16_f32 v144, v158, v159
    v_mul_f32 v160, v254, v160
    v_mfma_f32_16x16x32_bf16 v[146:149], v[206:209], a[148:151], v[146:149]
    v_mul_f32 v161, v254, v161
    v_cvt_pk_bf16_f32 v145, v160, v161
    v_mfma_f32_16x16x32_bf16 v[146:149], v[118:121], a[152:155], v[146:149]
    v_fmac_f32 v183, v138, v138
    v_fmac_f32 v183, v139, v139
    v_mfma_f32_16x16x32_bf16 v[146:149], v[134:137], a[156:159], v[146:149]
    v_fmac_f32 v183, v140, v140
    v_fmac_f32 v183, v141, v141
    v_mfma_f32_16x16x32_bf16 v[146:149], v[170:173], a[160:163], v[146:149]
    v_cvt_pk_bf16_f32 v36, v183, v182
    v_mul_f32 v178, v254, v178
    v_mfma_f32_16x16x32_bf16 v[146:149], v[166:169], a[164:167], v[146:149]
    s_waitcnt lgkmcnt(1)
    v_mul_f32 v179, v254, v179
    v_cvt_pk_bf16_f32 v178, v178, v179
    v_mfma_f32_16x16x32_bf16 v[158:161], v[32:35], v[36:39], 0
    s_waitcnt lgkmcnt(0)
    buffer_store_dwordx2 v[184:185], v20, s[12:15], 0 offen nt
    v_mul_f32 v180, v254, v180
    v_mul_f32 v181, v254, v181
    v_mfma_f32_16x16x32_bf16 v[186:189], v[150:153], a[168:171], 0
    v_cvt_pk_bf16_f32 v214, v146, v147
    v_cvt_pk_bf16_f32 v215, v148, v149
    v_mfma_f32_16x16x32_bf16 v[186:189], v[206:209], a[172:175], v[186:189]
    v_rsq_f32 v159, v159
    v_mfma_f32_16x16x32_bf16 v[186:189], v[118:121], a[176:179], v[186:189]
    v_rsq_f32 v158, v158
    v_mfma_f32_16x16x32_bf16 v[186:189], v[134:137], a[180:183], v[186:189]
    v_mul_f32 v158, s31, v158
    v_mul_f32 v202, v159, v202
    v_mfma_f32_16x16x32_bf16 v[186:189], v[170:173], a[184:187], v[186:189]
    v_mul_f32 v203, v159, v203
    v_cvt_pk_f16_f32 v146, v202, v203
    v_mfma_f32_16x16x32_bf16 v[186:189], v[166:169], a[188:191], v[186:189]
    v_mul_f32 v204, v159, v204
    v_mul_f32 v205, v159, v205
    v_mfma_f32_16x16x32_bf16 v[182:185], v[150:153], a[192:195], 0
    v_cvt_pk_f16_f32 v147, v204, v205
    v_mul_f32 v126, v159, v126
    v_mfma_f32_16x16x32_bf16 v[182:185], v[206:209], a[196:199], v[182:185]
    ds_read_b128 v[150:153], v5 offset:0
    ds_read_b128 v[202:205], v5 offset:16
    v_mfma_f32_16x16x32_bf16 v[182:185], v[118:121], a[200:203], v[182:185]
    ds_read_b128 v[118:121], v5 offset:48
    ds_read_b32 v254, v6 offset:192
    v_mfma_f32_16x16x32_bf16 v[182:185], v[134:137], a[204:207], v[182:185]
    v_cvt_pk_bf16_f32 v222, v186, v187
    v_cvt_pk_bf16_f32 v223, v188, v189
    v_mfma_f32_16x16x32_bf16 v[182:185], v[170:173], a[208:211], v[182:185]
    v_mul_f32 v127, v159, v127
    v_cvt_pk_f16_f32 v148, v126, v127
    v_mfma_f32_16x16x32_bf16 v[182:185], v[166:169], a[212:215], v[182:185]
    ds_read_b128 v[166:169], v2 offset:0
    ds_read_b128 v[170:173], v2 offset:1024
    v_mfma_f32_16x16x32_f16 v[186:189], v[226:229], v[210:213], v[50:53]
    ds_read_b128 v[134:137], v2 offset:2048
    v_mul_f32 v128, v159, v128
    v_mul_f32 v129, v159, v129
    v_mfma_f32_16x16x16_f16 v[194:197], v[164:165], v[162:163], v[194:197]
    v_cvt_pk_f16_f32 v149, v128, v129
    v_cvt_pk_bf16_f32 v234, v182, v183
    v_cvt_pk_bf16_f32 v235, v184, v185
    v_mul_f32 v174, v159, v174
    v_mfma_f32_16x16x32_f16 v[126:129], v[146:149], v[210:213], v[54:57]
    s_waitcnt lgkmcnt(5)
    v_mul_f32 v175, v159, v175
    v_cvt_pk_f16_f32 v184, v174, v175
    v_mul_f32 v176, v159, v176
    v_mfma_f32_16x16x16_f16 v[186:189], v[124:125], v[162:163], v[186:189]
    v_mul_f32 v177, v159, v177
    v_cvt_pk_f16_f32 v185, v176, v177
    v_mul_f32 v190, v158, v190
    v_mul_f32 v191, v158, v191
    v_mfma_f32_16x16x16_f16 v[126:129], v[184:185], v[162:163], v[126:129]
    v_cvt_pk_f16_f32 v174, v190, v191
    v_mul_f32 v192, v158, v192
    v_mul_f32 v193, v158, v193
    v_cvt_pk_f16_f32 v175, v192, v193
    v_mfma_f32_16x16x32_f16 v[206:209], v[150:153], v[210:213], v[22:25]
    s_waitcnt lgkmcnt(2)
    ds_read_b128 v[210:213], v2 offset:3072
    buffer_store_dwordx4 v[142:145], v16, s[12:15], 0 offen nt
    ds_read_b128 v[238:241], v2 offset:4096
    v_mul_f32 v198, v158, v198
    v_mul_f32 v199, v158, v199
    v_cvt_pk_f16_f32 v176, v198, v199
    v_mfma_f32_16x16x32_f16 v[206:209], v[202:205], v[218:221], v[206:209]
    s_waitcnt lgkmcnt(2)
    v_mul_f32 v200, v158, v200
    v_mul_f32 v201, v158, v201
    v_mfma_f32_16x16x32_f16 v[206:209], v[118:121], v[162:165], v[206:209]
    ds_read_b128 v[142:145], v2 offset:5120
    v_cvt_pk_f16_f32 v177, v200, v201
    v_mul_f32 v138, v158, v138
    v_mul_f32 v139, v158, v139
    v_cvt_pk_f16_f32 v182, v138, v139
    v_mfma_f32_16x16x32_f16 v[198:201], v[150:153], v[154:157], v[24:27]
    v_mul_f32 v140, v158, v140
    v_mul_f32 v141, v158, v141
    v_mfma_f32_16x16x32_f16 v[198:201], v[202:205], v[226:229], v[198:201]
    v_mov_b32_dpp v254, v207 quad_perm:[0,1,2,3] row_mask:0x1 bank_mask:0xf
    v_cvt_pk_f16_f32 v183, v140, v141
    v_mfma_f32_16x16x32_f16 v[198:201], v[118:121], v[122:125], v[198:201]
    v_max3_f32 v255, v206, v194, v195
    v_max3_f32 v255, v255, v196, v197
    v_mfma_f32_16x16x32_f16 v[242:245], v[150:153], v[174:177], v[26:29]
    s_waitcnt lgkmcnt(1)
    v_max3_f32 v255, v255, v186, v187
    v_max3_f32 v255, v255, v188, v189
    v_mfma_f32_16x16x32_f16 v[242:245], v[202:205], v[146:149], v[242:245]
    v_max3_f32 v255, v255, v126, v127
    v_mov_b32_dpp v254, v199 quad_perm:[0,1,2,3] row_mask:0x2 bank_mask:0xf
    v_mfma_f32_16x16x32_f16 v[242:245], v[118:121], v[182:185], v[242:245]
    v_max3_f32 v255, v255, v128, v129
    v_mov_b32 v162, v255
    v_mfma_f32_16x16x32_bf16 v[150:153], a[216:219], v[166:169], 0
    s_waitcnt lgkmcnt(0)
    v_permlane32_swap_b32 v255, v162
    v_mfma_f32_16x16x32_bf16 v[150:153], a[220:223], v[170:173], v[150:153]
    v_max_f32 v255, v255, v162
    v_mov_b32 v162, v255
    v_mfma_f32_16x16x32_bf16 v[150:153], a[224:227], v[134:137], v[150:153]
    v_cvt_pk_bf16_f32 v179, v180, v181
    v_xor_b32 v0, 65536, v0
    v_mfma_f32_16x16x32_bf16 v[150:153], a[228:231], v[210:213], v[150:153]
    s_waitcnt vmcnt(5)
    v_permlane16_swap_b32 v255, v162
    v_mfma_f32_16x16x32_bf16 v[150:153], a[232:235], v[238:241], v[150:153]
    s_barrier
    v_max_f32 v255, v255, v162
    v_sub_f32 v194, v194, v255
    v_mfma_f32_16x16x32_bf16 v[150:153], a[236:239], v[142:145], v[150:153]
    v_exp_f32 v194, v194
    v_mfma_f32_16x16x32_bf16 v[190:193], a[240:243], v[166:169], 0
    v_sub_f32 v195, v195, v255
    v_sub_f32 v196, v196, v255
    v_mfma_f32_16x16x32_bf16 v[190:193], a[244:247], v[170:173], v[190:193]
    buffer_load_dwordx4 v10, s[8:11], 0 offen nt lds
    v_sub_f32 v197, v197, v255
    v_mfma_f32_16x16x32_bf16 v[190:193], a[248:251], v[134:137], v[190:193]
    s_add_u32 m0, s28, 4096
    v_exp_f32 v195, v195
    v_mfma_f32_16x16x32_bf16 v[190:193], a[252:255], v[210:213], v[190:193]
    v_cvt_pk_bf16_f32 v158, v194, v195
    v_sub_f32 v186, v186, v255
    v_mfma_f32_16x16x32_bf16 v[190:193], v[82:85], v[238:241], v[190:193]
    v_exp_f32 v196, v196
    v_mfma_f32_16x16x32_bf16 v[190:193], v[86:89], v[142:145], v[190:193]
    v_exp_f32 v197, v197
    v_mfma_f32_16x16x32_bf16 v[202:205], v[90:93], v[166:169], 0
    ds_read_b128 v[166:169], v2 offset:6144
    buffer_load_dwordx4 v11, s[8:11], 0 offen nt lds
    v_mfma_f32_16x16x32_bf16 v[202:205], v[94:97], v[170:173], v[202:205]
    s_add_u32 m0, s28, 8192
    ds_read_b128 v[170:173], v2 offset:7168
    v_cvt_pk_bf16_f32 v159, v196, v197
    v_mfma_f32_16x16x32_bf16 v[202:205], v[98:101], v[134:137], v[202:205]
    ds_read_b128 v[138:141], v2 offset:8192
    v_sub_f32 v187, v187, v255
    v_mfma_f32_16x16x32_bf16 v[202:205], v[102:105], v[210:213], v[202:205]
    ds_read_b128 v[210:213], v2 offset:9216
    v_sub_f32 v188, v188, v255
    v_mfma_f32_16x16x32_bf16 v[202:205], v[106:109], v[238:241], v[202:205]
    ds_read_b128 v[134:137], v2 offset:10240
    v_sub_f32 v189, v189, v255
    v_mfma_f32_16x16x32_bf16 v[202:205], v[110:113], v[142:145], v[202:205]
    ds_read_b128 v[194:197], v2 offset:11264
    buffer_load_dwordx4 v12, s[8:11], 0 offen nt lds
    v_exp_f32 v186, v186
    v_mfma_f32_16x16x32_f16 v[118:121], v[218:221], v[154:157], v[58:61]
    s_add_u32 m0, s28, 12288
    v_exp_f32 v187, v187
    v_exp_f32 v188, v188
    v_cvt_pk_bf16_f32 v160, v186, v187
    v_exp_f32 v189, v189
    v_sub_f32 v126, v126, v255
    v_mfma_f32_16x16x16_f16 v[118:121], v[164:165], v[122:123], v[118:121]
    v_cvt_pk_bf16_f32 v161, v188, v189
    v_exp_f32 v126, v126
    v_sub_f32 v127, v127, v255
    v_mfma_f32_16x16x32_f16 v[186:189], v[226:229], v[154:157], v[62:65]
    s_xor_b32 s28, s28, 65536
    buffer_load_dwordx4 v13, s[8:11], 0 offen nt lds
    v_exp_f32 v127, v127
    v_sub_f32 v128, v128, v255
    v_cvt_pk_bf16_f32 v36, v126, v127
    v_exp_f32 v128, v128
    v_mfma_f32_16x16x16_f16 v[186:189], v[124:125], v[122:123], v[186:189]
    v_sub_f32 v129, v129, v255
    v_exp_f32 v129, v129
    v_sub_f32 v206, v206, v255
    v_cvt_pk_bf16_f32 v37, v128, v129
    v_mfma_f32_16x16x32_f16 v[126:129], v[146:149], v[154:157], v[66:69]
    s_waitcnt lgkmcnt(0)
    v_exp_f32 v206, v206
    v_mfma_f32_16x16x32_bf16 v[142:145], a[216:219], v[166:169], 0
    s_mov_b32 m0, s29
    v_cvt_pk_bf16_f32 v39, v206, 0
    v_max3_f32 v255, v198, v118, v119
    v_max3_f32 v255, v255, v120, v121
    v_mfma_f32_16x16x16_f16 v[126:129], v[184:185], v[122:123], v[126:129]
    v_max3_f32 v255, v255, v186, v187
    v_max3_f32 v255, v255, v188, v189
    v_xor_b32 v1, 65536, v1
    v_mov_b32_dpp v254, v243 quad_perm:[0,1,2,3] row_mask:0x4 bank_mask:0xf
    v_mfma_f32_16x16x32_bf16 v[154:157], v[28:31], v[36:39], 0
    s_xor_b32 s29, s29, s30
    buffer_store_dwordx2 v[178:179], v19, s[12:15], 0 offen nt
    v_mov_b32 v122, v254
    v_max3_f32 v255, v255, v126, v127
    v_mfma_f32_16x16x32_bf16 v[154:157], v[28:31], v[158:161], v[154:157]
    s_add_u32 s19, s19, s20
    v_max3_f32 v255, v255, v128, v129
    v_mov_b32 v123, v255
    v_mfma_f32_16x16x32_bf16 v[142:145], a[220:223], v[170:173], v[142:145]
    s_add_u32 s23, s23, s21
    v_permlane32_swap_b32 v255, v123
    v_mfma_f32_16x16x32_bf16 v[142:145], a[224:227], v[138:141], v[142:145]
    s_cmp_ge_u32 s19, 72
    v_rcp_f32 v154, v154
    v_mfma_f32_16x16x32_bf16 v[142:145], a[228:231], v[210:213], v[142:145]
    s_cselect_b32 s34, 72, 0
    v_max_f32 v255, v255, v123
    v_mov_b32 v123, v255
    v_mfma_f32_16x16x32_bf16 v[142:145], a[232:235], v[134:137], v[142:145]
    s_cselect_b32 s35, s22, 0
    v_permlane16_swap_b32 v255, v123
    v_mfma_f32_16x16x32_bf16 v[142:145], a[236:239], v[194:197], v[142:145]
    s_sub_u32 s19, s19, s34
    v_max_f32 v255, v255, v123
    v_sub_f32 v118, v118, v255
    v_mfma_f32_16x16x32_bf16 v[178:181], v[214:217], v[36:39], 0
    s_add_u32 s23, s23, s35
    v_exp_f32 v118, v118
    v_mfma_f32_16x16x32_bf16 v[178:181], v[230:233], v[158:161], v[178:181]
    s_add_u32 s18, s18, 1
    v_sub_f32 v119, v119, v255
    v_exp_f32 v119, v119
    v_sub_f32 v120, v120, v255
    v_cvt_pk_bf16_f32 v118, v118, v119
    v_exp_f32 v120, v120
    v_sub_f32 v121, v121, v255
    v_exp_f32 v121, v121
    v_mul_f32 v178, v154, v178
    v_mul_f32 v179, v154, v179
    v_cvt_pk_bf16_f32 v178, v178, v179
    v_mul_f32 v180, v154, v180
    v_mul_f32 v181, v154, v181
    v_cvt_pk_bf16_f32 v179, v180, v181
    v_cvt_pk_bf16_f32 v119, v120, v121
    v_mfma_f32_16x16x32_bf16 v[206:209], v[222:225], v[36:39], 0
    s_cmp_lt_u32 s18, s45
    v_sub_f32 v186, v186, v255
    v_sub_f32 v187, v187, v255
    v_mfma_f32_16x16x32_bf16 v[206:209], v[130:133], v[158:161], v[206:209]
    v_exp_f32 v186, v186
    v_exp_f32 v187, v187
    v_sub_f32 v188, v188, v255
    v_cvt_pk_bf16_f32 v120, v186, v187
    v_exp_f32 v188, v188
    v_sub_f32 v189, v189, v255
    v_exp_f32 v189, v189
    v_sub_f32 v126, v126, v255
    v_mul_f32 v206, v154, v206
    v_mul_f32 v207, v154, v207
    v_cvt_pk_bf16_f32 v180, v206, v207
    v_mul_f32 v208, v154, v208
    v_mul_f32 v209, v154, v209
    v_cvt_pk_bf16_f32 v181, v208, v209
    v_cvt_pk_bf16_f32 v121, v188, v189
    v_mfma_f32_16x16x32_bf16 v[186:189], v[234:237], v[36:39], 0
    buffer_load_dwordx4 v14, s[8:11], 0 offen nt lds
    v_sub_f32 v127, v127, v255
    v_mfma_f32_16x16x32_bf16 v[186:189], v[114:117], v[158:161], v[186:189]
    ds_write_b128 v3, v[178:181] offset:0
    v_mfma_f32_16x16x32_bf16 v[158:161], a[240:243], v[166:169], 0
    v_exp_f32 v126, v126
    v_mfma_f32_16x16x32_bf16 v[158:161], a[244:247], v[170:173], v[158:161]
    v_exp_f32 v127, v127
    v_mfma_f32_16x16x32_bf16 v[158:161], a[248:251], v[138:141], v[158:161]
    v_cvt_pk_bf16_f32 v36, v126, v127
    v_sub_f32 v128, v128, v255
    v_mfma_f32_16x16x32_bf16 v[158:161], a[252:255], v[210:213], v[158:161]
    v_mul_f32 v186, v154, v186
    v_mul_f32 v187, v154, v187
    v_mfma_f32_16x16x32_bf16 v[158:161], v[82:85], v[134:137], v[158:161]
    v_cvt_pk_bf16_f32 v126, v186, v187
    v_mul_f32 v188, v154, v188
    v_mfma_f32_16x16x32_bf16 v[158:161], v[86:89], v[194:197], v[158:161]
    v_mul_f32 v189, v154, v189
    v_cvt_pk_bf16_f32 v127, v188, v189
    v_mfma_f32_16x16x32_bf16 v[178:181], v[90:93], v[166:169], 0
    ds_read_b128 v[166:169], v2 offset:12288
    v_sub_f32 v129, v129, v255
    v_mfma_f32_16x16x32_bf16 v[178:181], v[94:97], v[170:173], v[178:181]
    ds_read_b128 v[170:173], v2 offset:13312
    v_sub_f32 v198, v198, v255
    v_mfma_f32_16x16x32_bf16 v[178:181], v[98:101], v[138:141], v[178:181]
    ds_read_b128 v[154:157], v2 offset:14336
    v_max_f32_dpp v122, v122, v122 quad_perm:[1,0,3,2] row_mask:0xf bank_mask:0xf
    v_mfma_f32_16x16x32_bf16 v[178:181], v[102:105], v[210:213], v[178:181]
    ds_read_b128 v[210:213], v2 offset:15360
    v_max_f32_dpp v122, v122, v122 quad_perm:[2,3,0,1] row_mask:0xf bank_mask:0xf
    v_mfma_f32_16x16x32_bf16 v[178:181], v[106:109], v[134:137], v[178:181]
    ds_read_b128 v[134:137], v2 offset:16384
    v_max_f32_dpp v122, v122, v122 row_half_mirror row_mask:0xf bank_mask:0xf
    v_mfma_f32_16x16x32_bf16 v[178:181], v[110:113], v[194:197], v[178:181]
    ds_read_b128 v[194:197], v2 offset:17408
    ds_write_b64 v4, v[126:127] offset:4096
    v_exp_f32 v128, v128
    v_exp_f32 v129, v129
    v_mfma_f32_16x16x32_f16 v[186:189], v[218:221], v[174:177], v[70:73]
    s_waitcnt lgkmcnt(6)
    v_cvt_pk_bf16_f32 v37, v128, v129
    v_max_f32_dpp v122, v122, v122 row_mirror row_mask:0xf bank_mask:0xf
    v_mfma_f32_16x16x32_f16 v[218:221], v[226:229], v[174:177], v[74:77]
    s_waitcnt lgkmcnt(5)
    v_exp_f32 v198, v198
    v_mfma_f32_16x16x32_f16 v[126:129], v[146:149], v[174:177], v[78:81]
    s_waitcnt lgkmcnt(4)
    v_cvt_pk_bf16_f32 v39, v198, 0
    v_mov_b32 v123, v122
    v_fma_f32 v255, v150, v150, s33
    v_mfma_f32_16x16x32_bf16 v[174:177], v[28:31], v[36:39], 0
    s_waitcnt lgkmcnt(3)
    v_permlane32_swap_b32 v122, v123
    v_mfma_f32_16x16x32_bf16 v[174:177], v[28:31], v[118:121], v[174:177]
    s_waitcnt lgkmcnt(2)
    v_max_f32 v122, v122, v123
    v_mov_b32 v123, v122
    v_mfma_f32_16x16x32_bf16 v[226:229], v[214:217], v[36:39], 0
    s_waitcnt lgkmcnt(0)
    v_permlane16_swap_b32 v122, v123
    v_mfma_f32_16x16x32_bf16 v[226:229], v[230:233], v[118:121], v[226:229]
    v_max_f32 v122, v122, v123
    v_sub_f32 v254, v254, v122
    v_mfma_f32_16x16x32_bf16 v[198:201], v[222:225], v[36:39], 0
    v_exp_f32 v254, v254
    v_mfma_f32_16x16x32_bf16 v[198:201], v[130:133], v[118:121], v[198:201]
    v_cvt_pk_bf16_f32 v254, v254, v254
    v_fmac_f32 v255, v151, v151
    v_mfma_f32_16x16x32_bf16 v[206:209], v[234:237], v[36:39], 0
    ds_write_b16 v8, v254
    v_mfma_f32_16x16x32_bf16 v[206:209], v[114:117], v[118:121], v[206:209]
    v_rcp_f32 v174, v174
    v_fmac_f32 v255, v152, v152
    v_mfma_f32_16x16x16_f16 v[186:189], v[164:165], v[182:183], v[186:189]
    v_mul_f32 v226, v174, v226
    v_mul_f32 v227, v174, v227
    v_cvt_pk_bf16_f32 v122, v226, v227
    v_mfma_f32_16x16x16_f16 v[218:221], v[124:125], v[182:183], v[218:221]
    v_mul_f32 v228, v174, v228
    v_mul_f32 v229, v174, v229
    v_cvt_pk_bf16_f32 v123, v228, v229
    v_mfma_f32_16x16x16_f16 v[126:129], v[184:185], v[182:183], v[126:129]
    v_max3_f32 v254, v242, v186, v187
    v_max3_f32 v254, v254, v188, v189
    v_mul_f32 v198, v174, v198
    v_mul_f32 v199, v174, v199
    v_mfma_f32_16x16x32_bf16 v[146:149], a[216:219], v[166:169], 0
    ds_read_b128 v[182:185], v9
    ds_read_b128 v[118:121], v9 offset:64
    v_mfma_f32_16x16x32_bf16 v[146:149], a[220:223], v[170:173], v[146:149]
    v_max3_f32 v254, v254, v218, v219
    v_max3_f32 v254, v254, v220, v221
    v_mfma_f32_16x16x32_bf16 v[146:149], a[224:227], v[154:157], v[146:149]
    v_max3_f32 v254, v254, v126, v127
    v_max3_f32 v254, v254, v128, v129
    v_mfma_f32_16x16x32_bf16 v[146:149], a[228:231], v[210:213], v[146:149]
    v_mov_b32 v125, v254
    v_cvt_pk_bf16_f32 v124, v198, v199
    v_mfma_f32_16x16x32_bf16 v[146:149], a[232:235], v[134:137], v[146:149]
    v_permlane32_swap_b32 v254, v125
    v_mfma_f32_16x16x32_bf16 v[146:149], a[236:239], v[194:197], v[146:149]
    v_max_f32 v254, v254, v125
    v_mov_b32 v125, v254
    v_mfma_f32_16x16x32_bf16 v[138:141], a[240:243], v[166:169], 0
    v_mul_f32 v200, v174, v200
    v_mul_f32 v201, v174, v201
    v_mfma_f32_16x16x32_bf16 v[138:141], a[244:247], v[170:173], v[138:141]
    v_permlane16_swap_b32 v254, v125
    v_mfma_f32_16x16x32_bf16 v[138:141], a[248:251], v[154:157], v[138:141]
    s_waitcnt lgkmcnt(0)
    v_max_f32 v254, v254, v125
    v_sub_f32 v186, v186, v254
    v_mfma_f32_16x16x32_bf16 v[138:141], a[252:255], v[210:213], v[138:141]
    v_exp_f32 v186, v186
    v_mfma_f32_16x16x32_bf16 v[138:141], v[82:85], v[134:137], v[138:141]
    v_sub_f32 v187, v187, v254
    v_sub_f32 v188, v188, v254
    v_mfma_f32_16x16x32_bf16 v[138:141], v[86:89], v[194:197], v[138:141]
    v_exp_f32 v187, v187
    v_exp_f32 v188, v188
    v_cvt_pk_bf16_f32 v238, v186, v187
    v_sub_f32 v189, v189, v254
    v_exp_f32 v189, v189
    v_sub_f32 v218, v218, v254
    v_cvt_pk_bf16_f32 v239, v188, v189
    v_exp_f32 v218, v218
    v_sub_f32 v219, v219, v254
    v_exp_f32 v219, v219
    v_sub_f32 v220, v220, v254
    v_cvt_pk_bf16_f32 v240, v218, v219
    v_mfma_f32_16x16x32_bf16 v[186:189], v[90:93], v[166:169], 0
    v_exp_f32 v220, v220
    v_mfma_f32_16x16x32_bf16 v[186:189], v[94:97], v[170:173], v[186:189]
    v_sub_f32 v221, v221, v254
    v_sub_f32 v126, v126, v254
    v_mfma_f32_16x16x32_bf16 v[186:189], v[98:101], v[154:157], v[186:189]
    v_exp_f32 v221, v221
    v_mfma_f32_16x16x32_bf16 v[186:189], v[102:105], v[210:213], v[186:189]
    v_cvt_pk_bf16_f32 v241, v220, v221
    v_sub_f32 v127, v127, v254
    v_mfma_f32_16x16x32_bf16 v[186:189], v[106:109], v[134:137], v[186:189]
    v_exp_f32 v126, v126
    v_mfma_f32_16x16x32_bf16 v[186:189], v[110:113], v[194:197], v[186:189]
    ds_read_b128 v[170:173], v0 offset:20480
    ds_read_b128 v[166:169], v1 offset:20480
    v_mfma_f32_16x16x32_bf16 v[154:157], v[182:185], v[28:31], 0
    ds_read_b128 v[162:165], v0 offset:20608
    ds_read_b128 v[210:213], v1 offset:20608
    v_mfma_f32_16x16x32_bf16 v[154:157], v[118:121], v[28:31], v[154:157]
    v_exp_f32 v127, v127
    v_mfma_f32_16x16x32_bf16 v[134:137], v[182:185], v[230:233], 0
    ds_read_b128 v[226:229], v0 offset:20736
    v_cvt_pk_bf16_f32 v36, v126, v127
    v_mfma_f32_16x16x32_bf16 v[134:137], v[118:121], v[214:217], v[134:137]
    ds_read_b128 v[218:221], v1 offset:20736
    v_sub_f32 v128, v128, v254
    v_exp_f32 v128, v128
    v_sub_f32 v129, v129, v254
    v_exp_f32 v129, v129
    v_sub_f32 v242, v242, v254
    v_cvt_pk_bf16_f32 v37, v128, v129
    v_mfma_f32_16x16x32_bf16 v[194:197], v[182:185], v[130:133], 0
    v_exp_f32 v242, v242
    v_mfma_f32_16x16x32_bf16 v[194:197], v[118:121], v[222:225], v[194:197]
    s_waitcnt lgkmcnt(4)
    v_cvt_pk_bf16_f32 v39, v242, 0
    v_cvt_pk_bf16_f32 v125, v200, v201
    v_mfma_f32_16x16x32_bf16 v[198:201], v[182:185], v[114:117], 0
    s_waitcnt lgkmcnt(2)
    ds_write_b128 v3, v[122:125] offset:6144
    v_mfma_f32_16x16x32_bf16 v[126:129], v[28:31], v[36:39], 0
    s_waitcnt lgkmcnt(2)
    v_mul_f32 v206, v174, v206
    v_mul_f32 v207, v174, v207
    v_mfma_f32_16x16x32_bf16 v[126:129], v[28:31], v[238:241], v[126:129]
    s_waitcnt lgkmcnt(1)
    v_cvt_pk_bf16_f32 v206, v206, v207
    v_mul_f32 v208, v174, v208
    v_mfma_f32_16x16x32_bf16 v[122:125], v[214:217], v[36:39], 0
    v_mul_f32 v209, v174, v209
    v_cvt_pk_bf16_f32 v207, v208, v209
    v_mfma_f32_16x16x32_bf16 v[122:125], v[230:233], v[238:241], v[122:125]
    ds_write_b64 v4, v[206:207] offset:10240
    v_mfma_f32_16x16x32_bf16 v[230:233], v[222:225], v[36:39], 0
    v_rcp_f32 v126, v126
    v_mfma_f32_16x16x32_bf16 v[230:233], v[130:133], v[238:241], v[230:233]
    v_fma_f32 v254, v146, v146, s33
    v_fmac_f32 v254, v147, v147
    v_mfma_f32_16x16x32_bf16 v[174:177], v[234:237], v[36:39], 0
    v_fmac_f32 v254, v148, v148
    v_mul_f32 v122, v126, v122
    v_mfma_f32_16x16x32_bf16 v[174:177], v[114:117], v[238:241], v[174:177]
    v_mul_f32 v123, v126, v123
    v_cvt_pk_bf16_f32 v122, v122, v123
    v_mfma_f32_16x16x32_bf16 v[198:201], v[118:121], v[234:237], v[198:201]
    v_mul_f32 v124, v126, v124
    v_mul_f32 v125, v126, v125
    v_mfma_f32_16x16x32_bf16 v[114:117], a[72:75], v[170:173], 0
    v_cvt_pk_bf16_f32 v123, v124, v125
    v_mul_f32 v230, v126, v230
    v_mfma_f32_16x16x32_bf16 v[114:117], a[76:79], v[166:169], v[114:117]
    v_mul_f32 v231, v126, v231
    v_cvt_pk_bf16_f32 v124, v230, v231
    v_mfma_f32_16x16x32_bf16 v[114:117], a[80:83], v[162:165], v[114:117]
    v_mul_f32 v232, v126, v232
    v_mul_f32 v233, v126, v233
    v_mfma_f32_16x16x32_bf16 v[114:117], a[84:87], v[210:213], v[114:117]
    v_cvt_pk_bf16_f32 v125, v232, v233
    v_mul_f32 v174, v126, v174
    v_mfma_f32_16x16x32_bf16 v[114:117], a[88:91], v[226:229], v[114:117]
    ds_write_b128 v3, v[122:125] offset:12288
    v_mfma_f32_16x16x32_bf16 v[114:117], a[92:95], v[218:221], v[114:117]
    v_mul_f32 v175, v126, v175
    v_cvt_pk_bf16_f32 v174, v174, v175
    v_mfma_f32_16x16x32_bf16 v[122:125], a[96:99], v[170:173], 0
    v_mul_f32 v176, v126, v176
    v_mul_f32 v177, v126, v177
    v_mfma_f32_16x16x32_bf16 v[122:125], a[100:103], v[166:169], v[122:125]
    v_cvt_pk_bf16_f32 v175, v176, v177
    v_fmac_f32 v254, v149, v149
    v_mfma_f32_16x16x32_bf16 v[122:125], a[104:107], v[162:165], v[122:125]
    ds_write_b64 v4, v[174:175] offset:16384
    v_mfma_f32_16x16x32_bf16 v[122:125], a[108:111], v[210:213], v[122:125]
    v_fmac_f32 v254, v138, v138
    v_fmac_f32 v254, v139, v139
    v_mfma_f32_16x16x32_bf16 v[122:125], a[112:115], v[226:229], v[122:125]
    v_fmac_f32 v254, v140, v140
    v_fmac_f32 v254, v141, v141
    v_mfma_f32_16x16x32_bf16 v[122:125], a[116:119], v[218:221], v[122:125]
    v_fmac_f32 v254, v186, v186
    v_fmac_f32 v254, v187, v187
    v_mfma_f32_16x16x32_bf16 v[126:129], a[120:123], v[170:173], 0
    v_fmac_f32 v254, v188, v188
    v_fmac_f32 v254, v189, v189
    v_mfma_f32_16x16x32_bf16 v[126:129], a[124:127], v[166:169], v[126:129]
    v_cvt_pk_bf16_f32 v135, v254, v254
    v_fmac_f32 v255, v153, v153
    v_mfma_f32_16x16x32_bf16 v[126:129], a[128:131], v[162:165], v[126:129]
    v_rcp_f32 v154, v154
    v_mfma_f32_16x16x32_bf16 v[126:129], a[132:135], v[210:213], v[126:129]
    v_mul_f32 v134, v134, v154
    v_mul_f32_dpp v134, v194, v154 quad_perm:[0,1,2,3] row_mask:0x2 bank_mask:0xf
    v_mfma_f32_16x16x32_bf16 v[126:129], a[136:139], v[226:229], v[126:129]
    v_mul_f32_dpp v134, v198, v154 quad_perm:[0,1,2,3] row_mask:0x4 bank_mask:0xf
    v_cvt_pk_bf16_f32 v134, v134, v134
    v_mfma_f32_16x16x32_bf16 v[126:129], a[140:143], v[218:221], v[126:129]
    ds_write_b16 v7, v134
    v_mfma_f32_16x16x32_bf16 v[154:157], a[0:3], v[170:173], 0
    v_fmac_f32 v255, v190, v190
    v_fmac_f32 v255, v191, v191
    v_mfma_f32_16x16x32_bf16 v[154:157], a[4:7], v[166:169], v[154:157]
    v_fmac_f32 v255, v192, v192
    v_fmac_f32 v255, v193, v193
    v_mfma_f32_16x16x32_bf16 v[154:157], a[8:11], v[162:165], v[154:157]
    v_fmac_f32 v255, v202, v202
    v_fmac_f32 v255, v203, v203
    v_mfma_f32_16x16x32_bf16 v[154:157], a[12:15], v[210:213], v[154:157]
    v_fmac_f32 v255, v204, v204
    v_fmac_f32 v255, v205, v205
    v_mfma_f32_16x16x32_bf16 v[154:157], a[16:19], v[226:229], v[154:157]
    v_fma_f32 v254, v142, v142, s33
    v_fmac_f32 v254, v143, v143
    v_mfma_f32_16x16x32_bf16 v[154:157], a[20:23], v[218:221], v[154:157]
    v_fmac_f32 v254, v144, v144
    v_fmac_f32 v254, v145, v145
    v_mfma_f32_16x16x32_bf16 v[174:177], a[24:27], v[170:173], 0
    v_fmac_f32 v254, v158, v158
    v_fmac_f32 v254, v159, v159
    v_mfma_f32_16x16x32_bf16 v[174:177], a[28:31], v[166:169], v[174:177]
    v_fmac_f32 v254, v160, v160
    v_fmac_f32 v254, v161, v161
    v_mfma_f32_16x16x32_bf16 v[174:177], a[32:35], v[162:165], v[174:177]
    v_fmac_f32 v254, v178, v178
    v_fmac_f32 v254, v179, v179
    v_mfma_f32_16x16x32_bf16 v[174:177], a[36:39], v[210:213], v[174:177]
    v_fmac_f32 v254, v180, v180
    v_fmac_f32 v254, v181, v181
    v_mfma_f32_16x16x32_bf16 v[174:177], a[40:43], v[226:229], v[174:177]
    v_cvt_pk_bf16_f32 v134, v255, v254
    v_add_u32 v5, 336, v5
    v_mfma_f32_16x16x32_bf16 v[174:177], a[44:47], v[218:221], v[174:177]
    ds_write_b64 v4, v[134:135] offset:18432
    v_mfma_f32_16x16x32_bf16 v[182:185], a[48:51], v[170:173], 0
    v_add_u32 v6, 272, v6
    v_add_u32 v7, 16, v7
    v_mfma_f32_16x16x32_bf16 v[182:185], a[52:55], v[166:169], v[182:185]
    v_fma_f32 v130, v114, v114, s32
    v_fmac_f32 v130, v115, v115
    v_mfma_f32_16x16x32_bf16 v[182:185], a[56:59], v[162:165], v[182:185]
    v_fmac_f32 v130, v116, v116
    v_fmac_f32 v130, v117, v117
    v_mfma_f32_16x16x32_bf16 v[182:185], a[60:63], v[210:213], v[182:185]
    v_fmac_f32 v130, v122, v122
    v_fmac_f32 v130, v123, v123
    v_mfma_f32_16x16x32_bf16 v[182:185], a[64:67], v[226:229], v[182:185]
    v_fmac_f32 v130, v124, v124
    v_fmac_f32 v130, v125, v125
    v_mfma_f32_16x16x32_bf16 v[182:185], a[68:71], v[218:221], v[182:185]
    v_fmac_f32 v130, v126, v126
    v_fmac_f32 v130, v127, v127
    v_mfma_f32_16x16x32_bf16 v[230:233], v[170:173], a[144:147], 0
    s_waitcnt lgkmcnt(0)
    v_fmac_f32 v130, v128, v128
    v_fmac_f32 v130, v129, v129
    v_mfma_f32_16x16x32_bf16 v[230:233], v[166:169], a[148:151], v[230:233]
    s_barrier
    v_fma_f32 v131, v154, v154, s32
    v_fmac_f32 v131, v155, v155
    v_mfma_f32_16x16x32_bf16 v[230:233], v[162:165], a[152:155], v[230:233]
    v_fmac_f32 v131, v156, v156
    v_fmac_f32 v131, v157, v157
    v_mfma_f32_16x16x32_bf16 v[230:233], v[210:213], a[156:159], v[230:233]
    s_nop 0
    v_fmac_f32 v131, v174, v174
    v_xor_b32 v2, 65536, v2
    v_mfma_f32_16x16x32_bf16 v[230:233], v[226:229], a[160:163], v[230:233]
    s_nop 0
    v_xor_b32 v3, 65536, v3
    v_xor_b32 v4, 65536, v4
    v_mfma_f32_16x16x32_bf16 v[230:233], v[218:221], a[164:167], v[230:233]
    s_cbranch_scc1 L_loop_safe0
    s_branch L_final_safe
.p2align 6
L_loop_safe1:
    v_mfma_f32_16x16x32_bf16 v[194:197], v[170:173], a[168:171], 0
    s_add_u32 s12, s42, s27
    ds_read_b128 v[198:201], v2 offset:18432
    ds_read_b128 v[214:217], v2 offset:19456
    v_mfma_f32_16x16x32_bf16 v[194:197], v[166:169], a[172:175], v[194:197]
    s_addc_u32 s13, s43, 0
    v_fmac_f32 v131, v175, v175
    v_fmac_f32 v131, v176, v176
    v_mfma_f32_16x16x32_bf16 v[194:197], v[162:165], a[176:179], v[194:197]
    s_sub_u32 s14, s36, s27
    v_fmac_f32 v131, v177, v177
    v_fmac_f32 v131, v182, v182
    v_mfma_f32_16x16x32_bf16 v[194:197], v[210:213], a[180:183], v[194:197]
    s_cmp_ge_u32 s18, 2
    v_fmac_f32 v131, v183, v183
    v_fmac_f32 v131, v184, v184
    v_mfma_f32_16x16x32_bf16 v[194:197], v[226:229], a[184:187], v[194:197]
    s_cselect_b32 s14, s14, 0
    ds_read_b128 v[118:121], v0 offset:26624
    v_fmac_f32 v131, v185, v185
    v_mfma_f32_16x16x32_bf16 v[194:197], v[218:221], a[188:191], v[194:197]
    s_add_u32 s34, s18, 2
    ds_read_b128 v[134:137], v1 offset:26624
    v_cvt_pk_bf16_f32 v36, v131, v130
    v_mfma_f32_16x16x32_bf16 v[234:237], v[170:173], a[192:195], 0
    s_add_u32 s8, s40, s23
    ds_read_b128 v[170:173], v0 offset:26752
    v_cvt_pk_bf16_f32 v230, v230, v231
    v_mfma_f32_16x16x32_bf16 v[234:237], v[166:169], a[196:199], v[234:237]
    s_addc_u32 s9, s41, 0
    ds_read_b128 v[166:169], v1 offset:26752
    v_cvt_pk_bf16_f32 v231, v232, v233
    v_mfma_f32_16x16x32_bf16 v[222:225], v[32:35], v[36:39], 0
    s_sub_u32 s10, s36, s23
    v_cvt_pk_bf16_f32 v130, v194, v195
    v_cvt_pk_bf16_f32 v131, v196, v197
    v_mfma_f32_16x16x32_bf16 v[234:237], v[162:165], a[200:203], v[234:237]
    s_waitcnt lgkmcnt(4)
    ds_read_b128 v[194:197], v0 offset:26880
    s_cmp_lt_u32 s34, s17
    v_mfma_f32_16x16x32_bf16 v[206:209], v[32:35], v[198:201], 0
    s_cselect_b32 s10, s10, 0
    v_rsq_f32 v223, v223
    v_mfma_f32_16x16x32_bf16 v[206:209], v[32:35], v[214:217], v[206:209]
    s_add_u32 m0, s28, 0
    v_rsq_f32 v222, v222
    v_mfma_f32_16x16x32_bf16 v[234:237], v[210:213], a[204:207], v[234:237]
    s_waitcnt lgkmcnt(4)
    ds_read_b128 v[198:201], v1 offset:26880
    v_mul_f32 v222, s31, v222
    v_mfma_f32_16x16x32_bf16 v[234:237], v[226:229], a[208:211], v[234:237]
    s_mov_b32 s27, s26
    v_mul_f32 v114, v223, v114
    v_mul_f32 v115, v223, v115
    v_mfma_f32_16x16x32_bf16 v[234:237], v[218:221], a[212:215], v[234:237]
    s_mov_b32 s26, s25
    v_cvt_pk_f16_f32 v218, v114, v115
    v_mul_f32 v116, v223, v116
    v_mfma_f32_16x16x32_bf16 v[226:229], a[72:75], v[118:121], 0
    s_waitcnt lgkmcnt(2)
    v_mul_f32 v117, v223, v117
    v_cvt_pk_f16_f32 v219, v116, v117
    v_mfma_f32_16x16x32_bf16 v[226:229], a[76:79], v[134:137], v[226:229]
    s_mov_b32 s25, s24
    v_cvt_pk_bf16_f32 v114, v234, v235
    v_cvt_pk_bf16_f32 v115, v236, v237
    v_mfma_f32_16x16x32_bf16 v[226:229], a[80:83], v[170:173], v[226:229]
    s_mov_b32 s24, s23
    v_mul_f32 v122, v223, v122
    v_mul_f32 v123, v223, v123
    v_mfma_f32_16x16x32_bf16 v[226:229], a[84:87], v[166:169], v[226:229]
    s_waitcnt lgkmcnt(1)
    v_cvt_pk_f16_f32 v220, v122, v123
    v_mul_f32 v124, v223, v124
    v_mfma_f32_16x16x32_bf16 v[226:229], a[88:91], v[194:197], v[226:229]
    v_mul_f32 v125, v223, v125
    v_cvt_pk_f16_f32 v221, v124, v125
    v_mfma_f32_16x16x32_bf16 v[122:125], a[96:99], v[118:121], 0
    s_waitcnt lgkmcnt(0)
    v_mul_f32 v126, v223, v126
    v_mul_f32 v127, v223, v127
    v_mfma_f32_16x16x32_bf16 v[226:229], a[92:95], v[198:201], v[226:229]
    v_cvt_pk_f16_f32 v164, v126, v127
    v_mul_f32 v128, v223, v128
    v_mfma_f32_16x16x32_bf16 v[122:125], a[100:103], v[134:137], v[122:125]
    v_mul_f32 v129, v223, v129
    v_cvt_pk_f16_f32 v165, v128, v129
    v_mfma_f32_16x16x32_bf16 v[122:125], a[104:107], v[170:173], v[122:125]
    v_mul_f32 v154, v222, v154
    v_mul_f32 v155, v222, v155
    v_mfma_f32_16x16x32_bf16 v[122:125], a[108:111], v[166:169], v[122:125]
    v_cvt_pk_f16_f32 v210, v154, v155
    v_mul_f32 v156, v222, v156
    v_mfma_f32_16x16x32_bf16 v[122:125], a[112:115], v[194:197], v[122:125]
    v_mul_f32 v157, v222, v157
    v_cvt_pk_f16_f32 v211, v156, v157
    v_mfma_f32_16x16x32_bf16 v[122:125], a[116:119], v[198:201], v[122:125]
    v_mul_f32 v174, v222, v174
    v_mul_f32 v175, v222, v175
    v_mfma_f32_16x16x32_bf16 v[126:129], a[120:123], v[118:121], 0
    v_cvt_pk_f16_f32 v212, v174, v175
    v_mul_f32 v176, v222, v176
    v_mfma_f32_16x16x32_bf16 v[126:129], a[124:127], v[134:137], v[126:129]
    v_mul_f32 v177, v222, v177
    v_cvt_pk_f16_f32 v213, v176, v177
    v_mfma_f32_16x16x32_bf16 v[126:129], a[128:131], v[170:173], v[126:129]
    v_mul_f32 v182, v222, v182
    v_mul_f32 v183, v222, v183
    v_mfma_f32_16x16x32_bf16 v[126:129], a[132:135], v[166:169], v[126:129]
    v_cvt_pk_f16_f32 v162, v182, v183
    v_mul_f32 v184, v222, v184
    v_mfma_f32_16x16x32_bf16 v[126:129], a[136:139], v[194:197], v[126:129]
    v_mul_f32 v185, v222, v185
    v_cvt_pk_f16_f32 v163, v184, v185
    v_mfma_f32_16x16x32_bf16 v[126:129], a[140:143], v[198:201], v[126:129]
    v_fma_f32 v116, v226, v226, s32
    v_fmac_f32 v116, v227, v227
    v_mfma_f32_16x16x32_bf16 v[154:157], a[0:3], v[118:121], 0
    v_fmac_f32 v116, v228, v228
    v_fmac_f32 v116, v229, v229
    v_mfma_f32_16x16x32_bf16 v[154:157], a[4:7], v[134:137], v[154:157]
    v_fmac_f32 v116, v122, v122
    v_fmac_f32 v116, v123, v123
    v_mfma_f32_16x16x32_bf16 v[154:157], a[8:11], v[170:173], v[154:157]
    v_fmac_f32 v116, v124, v124
    v_fmac_f32 v116, v125, v125
    v_mfma_f32_16x16x32_bf16 v[154:157], a[12:15], v[166:169], v[154:157]
    v_fmac_f32 v116, v126, v126
    v_fmac_f32 v116, v127, v127
    v_mfma_f32_16x16x32_bf16 v[154:157], a[16:19], v[194:197], v[154:157]
    v_fmac_f32 v116, v128, v128
    v_fmac_f32 v116, v129, v129
    v_mfma_f32_16x16x32_bf16 v[154:157], a[20:23], v[198:201], v[154:157]
    v_mul_f32 v117, 0x3baaaaab, v206
    v_mul_f32 v254, 0x3baaaaab, v207
    v_mfma_f32_16x16x32_bf16 v[174:177], a[24:27], v[118:121], 0
    v_rsq_f32 v117, v117
    v_mfma_f32_16x16x32_bf16 v[174:177], a[28:31], v[134:137], v[174:177]
    v_rsq_f32 v254, v254
    v_mfma_f32_16x16x32_bf16 v[174:177], a[32:35], v[170:173], v[174:177]
    v_mul_f32 v255, 0x3baaaaab, v208
    v_fma_f32 v132, v154, v154, s32
    v_mfma_f32_16x16x32_bf16 v[174:177], a[36:39], v[166:169], v[174:177]
    v_fmac_f32 v132, v155, v155
    v_fmac_f32 v132, v156, v156
    v_mfma_f32_16x16x32_bf16 v[174:177], a[40:43], v[194:197], v[174:177]
    v_fmac_f32 v132, v157, v157
    v_mul_f32 v150, v117, v150
    v_mfma_f32_16x16x32_bf16 v[174:177], a[44:47], v[198:201], v[174:177]
    v_rsq_f32 v255, v255
    v_mfma_f32_16x16x32_bf16 v[182:185], a[48:51], v[118:121], 0
    v_mul_f32 v151, v117, v151
    v_cvt_pk_bf16_f32 v214, v150, v151
    v_mfma_f32_16x16x32_bf16 v[182:185], a[52:55], v[134:137], v[182:185]
    v_mul_f32 v152, v117, v152
    v_mul_f32 v153, v117, v153
    v_mfma_f32_16x16x32_bf16 v[182:185], a[56:59], v[170:173], v[182:185]
    v_fmac_f32 v132, v174, v174
    v_fmac_f32 v132, v175, v175
    v_mfma_f32_16x16x32_bf16 v[182:185], a[60:63], v[166:169], v[182:185]
    v_fmac_f32 v132, v176, v176
    v_fmac_f32 v132, v177, v177
    v_mfma_f32_16x16x32_bf16 v[182:185], a[64:67], v[194:197], v[182:185]
    v_cvt_pk_bf16_f32 v215, v152, v153
    v_mul_f32 v190, v117, v190
    v_mfma_f32_16x16x32_bf16 v[182:185], a[68:71], v[198:201], v[182:185]
    v_mul_f32 v191, v117, v191
    v_cvt_pk_bf16_f32 v216, v190, v191
    v_mfma_f32_16x16x32_bf16 v[150:153], v[118:121], a[144:147], 0
    v_mul_f32 v192, v117, v192
    v_mul_f32 v193, v117, v193
    v_mfma_f32_16x16x32_bf16 v[150:153], v[134:137], a[148:151], v[150:153]
    v_cvt_pk_bf16_f32 v217, v192, v193
    v_mul_f32 v202, v117, v202
    v_mfma_f32_16x16x32_bf16 v[150:153], v[170:173], a[152:155], v[150:153]
    buffer_store_dwordx4 v[214:217], v15, s[12:15], 0 offen nt
    v_fmac_f32 v132, v182, v182
    v_fmac_f32 v132, v183, v183
    v_fmac_f32 v132, v184, v184
    v_fmac_f32 v132, v185, v185
    v_mfma_f32_16x16x32_bf16 v[150:153], v[166:169], a[156:159], v[150:153]
    v_cvt_pk_bf16_f32 v36, v132, v116
    v_mul_f32 v203, v117, v203
    v_mfma_f32_16x16x32_bf16 v[150:153], v[194:197], a[160:163], v[150:153]
    v_cvt_pk_bf16_f32 v116, v202, v203
    v_mul_f32 v204, v117, v204
    v_mfma_f32_16x16x32_bf16 v[190:193], v[32:35], v[36:39], 0
    v_mul_f32 v205, v117, v205
    v_cvt_pk_bf16_f32 v117, v204, v205
    v_mfma_f32_16x16x32_bf16 v[150:153], v[198:201], a[164:167], v[150:153]
    v_mul_f32 v146, v255, v146
    v_mul_f32 v147, v255, v147
    v_mfma_f32_16x16x32_bf16 v[202:205], v[118:121], a[168:171], 0
    v_cvt_pk_bf16_f32 v146, v146, v147
    v_mul_f32 v148, v255, v148
    v_mfma_f32_16x16x32_bf16 v[202:205], v[134:137], a[172:175], v[202:205]
    v_rsq_f32 v191, v191
    v_mfma_f32_16x16x32_bf16 v[202:205], v[170:173], a[176:179], v[202:205]
    v_cvt_pk_bf16_f32 v232, v150, v151
    v_cvt_pk_bf16_f32 v233, v152, v153
    v_mfma_f32_16x16x32_bf16 v[202:205], v[166:169], a[180:183], v[202:205]
    v_rsq_f32 v190, v190
    v_mfma_f32_16x16x32_bf16 v[202:205], v[194:197], a[184:187], v[202:205]
    ds_read_b128 v[150:153], v0 offset:32768
    v_mul_f32 v190, s31, v190
    v_mfma_f32_16x16x32_bf16 v[202:205], v[198:201], a[188:191], v[202:205]
    ds_read_b128 v[206:209], v1 offset:32768
    v_mul_f32 v226, v191, v226
    v_mfma_f32_16x16x32_bf16 v[214:217], v[118:121], a[192:195], 0
    ds_read_b128 v[118:121], v0 offset:32896
    v_mul_f32 v227, v191, v227
    v_mfma_f32_16x16x32_bf16 v[214:217], v[134:137], a[196:199], v[214:217]
    ds_read_b128 v[134:137], v1 offset:32896
    v_cvt_pk_f16_f32 v226, v226, v227
    v_mfma_f32_16x16x32_bf16 v[214:217], v[170:173], a[200:203], v[214:217]
    ds_read_b128 v[170:173], v0 offset:33024
    v_cvt_pk_bf16_f32 v132, v202, v203
    v_mfma_f32_16x16x32_bf16 v[214:217], v[166:169], a[204:207], v[214:217]
    ds_read_b128 v[166:169], v1 offset:33024
    v_cvt_pk_bf16_f32 v133, v204, v205
    v_mfma_f32_16x16x32_bf16 v[214:217], v[194:197], a[208:211], v[214:217]
    v_mul_f32 v228, v191, v228
    v_mul_f32 v229, v191, v229
    v_mfma_f32_16x16x32_bf16 v[214:217], v[198:201], a[212:215], v[214:217]
    v_cvt_pk_f16_f32 v227, v228, v229
    v_mul_f32 v122, v191, v122
    v_mfma_f32_16x16x32_f16 v[194:197], v[218:221], v[210:213], v[46:49]
    s_waitcnt lgkmcnt(5)
    buffer_store_dwordx2 v[116:117], v18, s[12:15], 0 offen nt
    v_mul_f32 v123, v191, v123
    v_cvt_pk_f16_f32 v228, v122, v123
    v_mfma_f32_16x16x32_bf16 v[202:205], a[72:75], v[150:153], 0
    s_waitcnt lgkmcnt(3)
    v_cvt_pk_bf16_f32 v116, v214, v215
    v_cvt_pk_bf16_f32 v117, v216, v217
    v_mfma_f32_16x16x32_bf16 v[202:205], a[76:79], v[206:209], v[202:205]
    s_waitcnt lgkmcnt(2)
    v_mul_f32 v124, v191, v124
    v_mul_f32 v125, v191, v125
    v_mfma_f32_16x16x32_bf16 v[202:205], a[80:83], v[118:121], v[202:205]
    s_waitcnt lgkmcnt(1)
    v_cvt_pk_f16_f32 v229, v124, v125
    v_mul_f32 v126, v191, v126
    v_mfma_f32_16x16x32_bf16 v[202:205], a[84:87], v[134:137], v[202:205]
    s_waitcnt lgkmcnt(0)
    v_mul_f32 v127, v191, v127
    v_cvt_pk_f16_f32 v124, v126, v127
    v_mfma_f32_16x16x32_bf16 v[202:205], a[88:91], v[170:173], v[202:205]
    v_mul_f32 v128, v191, v128
    v_mul_f32 v129, v191, v129
    v_mfma_f32_16x16x32_bf16 v[202:205], a[92:95], v[166:169], v[202:205]
    v_cvt_pk_f16_f32 v125, v128, v129
    v_mul_f32 v154, v190, v154
    v_mfma_f32_16x16x32_bf16 v[126:129], a[96:99], v[150:153], 0
    v_mul_f32 v155, v190, v155
    v_cvt_pk_f16_f32 v154, v154, v155
    v_mfma_f32_16x16x32_bf16 v[126:129], a[100:103], v[206:209], v[126:129]
    v_mul_f32 v156, v190, v156
    v_mul_f32 v157, v190, v157
    v_mfma_f32_16x16x32_bf16 v[126:129], a[104:107], v[118:121], v[126:129]
    v_cvt_pk_f16_f32 v155, v156, v157
    v_mul_f32 v174, v190, v174
    v_mfma_f32_16x16x32_bf16 v[126:129], a[108:111], v[134:137], v[126:129]
    v_mul_f32 v175, v190, v175
    v_cvt_pk_f16_f32 v156, v174, v175
    v_mfma_f32_16x16x32_bf16 v[126:129], a[112:115], v[170:173], v[126:129]
    v_mul_f32 v176, v190, v176
    v_mul_f32 v177, v190, v177
    v_mfma_f32_16x16x32_bf16 v[126:129], a[116:119], v[166:169], v[126:129]
    v_cvt_pk_f16_f32 v157, v176, v177
    v_mul_f32 v182, v190, v182
    v_mfma_f32_16x16x32_bf16 v[174:177], a[120:123], v[150:153], 0
    v_mul_f32 v183, v190, v183
    v_cvt_pk_f16_f32 v122, v182, v183
    v_mfma_f32_16x16x32_bf16 v[174:177], a[124:127], v[206:209], v[174:177]
    v_mul_f32 v184, v190, v184
    v_mul_f32 v185, v190, v185
    v_mfma_f32_16x16x32_bf16 v[174:177], a[128:131], v[118:121], v[174:177]
    v_cvt_pk_f16_f32 v123, v184, v185
    v_fma_f32 v182, v202, v202, s32
    v_mfma_f32_16x16x32_bf16 v[174:177], a[132:135], v[134:137], v[174:177]
    v_fmac_f32 v182, v203, v203
    v_fmac_f32 v182, v204, v204
    v_mfma_f32_16x16x32_bf16 v[174:177], a[136:139], v[170:173], v[174:177]
    v_fmac_f32 v182, v205, v205
    v_fmac_f32 v182, v126, v126
    v_mfma_f32_16x16x32_bf16 v[174:177], a[140:143], v[166:169], v[174:177]
    v_fmac_f32 v182, v127, v127
    v_fmac_f32 v182, v128, v128
    v_mfma_f32_16x16x32_bf16 v[190:193], a[0:3], v[150:153], 0
    v_fmac_f32 v182, v129, v129
    v_mul_f32 v149, v255, v149
    v_mfma_f32_16x16x32_bf16 v[190:193], a[4:7], v[206:209], v[190:193]
    v_cvt_pk_bf16_f32 v147, v148, v149
    v_mul_f32 v138, v255, v138
    v_mfma_f32_16x16x32_bf16 v[190:193], a[8:11], v[118:121], v[190:193]
    v_fmac_f32 v182, v174, v174
    v_fmac_f32 v182, v175, v175
    v_mfma_f32_16x16x32_bf16 v[190:193], a[12:15], v[134:137], v[190:193]
    v_fmac_f32 v182, v176, v176
    v_fmac_f32 v182, v177, v177
    v_mfma_f32_16x16x32_bf16 v[190:193], a[16:19], v[170:173], v[190:193]
    v_mul_f32 v139, v255, v139
    v_cvt_pk_bf16_f32 v148, v138, v139
    v_mfma_f32_16x16x32_bf16 v[190:193], a[20:23], v[166:169], v[190:193]
    v_mul_f32 v140, v255, v140
    v_mul_f32 v141, v255, v141
    v_mfma_f32_16x16x32_bf16 v[198:201], a[24:27], v[150:153], 0
    v_cvt_pk_bf16_f32 v149, v140, v141
    v_mul_f32 v186, v255, v186
    v_mfma_f32_16x16x32_bf16 v[198:201], a[28:31], v[206:209], v[198:201]
    buffer_store_dwordx4 v[146:149], v17, s[12:15], 0 offen nt
    v_mul_f32 v187, v255, v187
    v_fma_f32 v183, v190, v190, s32
    v_fmac_f32 v183, v191, v191
    v_fmac_f32 v183, v192, v192
    v_mfma_f32_16x16x32_bf16 v[198:201], a[32:35], v[118:121], v[198:201]
    v_fmac_f32 v183, v193, v193
    v_cvt_pk_bf16_f32 v184, v186, v187
    v_mfma_f32_16x16x32_bf16 v[198:201], a[36:39], v[134:137], v[198:201]
    v_mul_f32 v188, v255, v188
    v_mul_f32 v189, v255, v189
    v_mfma_f32_16x16x32_bf16 v[198:201], a[40:43], v[170:173], v[198:201]
    v_cvt_pk_bf16_f32 v185, v188, v189
    v_mul_f32 v142, v254, v142
    v_mfma_f32_16x16x32_bf16 v[198:201], a[44:47], v[166:169], v[198:201]
    v_mul_f32 v143, v254, v143
    v_cvt_pk_bf16_f32 v142, v142, v143
    v_mfma_f32_16x16x32_bf16 v[138:141], a[48:51], v[150:153], 0
    v_mul_f32 v144, v254, v144
    v_mul_f32 v145, v254, v145
    v_mfma_f32_16x16x32_bf16 v[138:141], a[52:55], v[206:209], v[138:141]
    v_cvt_pk_bf16_f32 v143, v144, v145
    v_mul_f32 v158, v254, v158
    v_mfma_f32_16x16x32_bf16 v[138:141], a[56:59], v[118:121], v[138:141]
    v_fmac_f32 v183, v198, v198
    v_fmac_f32 v183, v199, v199
    v_mfma_f32_16x16x32_bf16 v[138:141], a[60:63], v[134:137], v[138:141]
    ds_read2_b32 v[216:217], v6 offset0:0 offset1:0
    ds_read2_b32 v[224:225], v6 offset0:16 offset1:16
    v_mfma_f32_16x16x32_bf16 v[138:141], a[64:67], v[170:173], v[138:141]
    ds_read2_b32 v[236:237], v6 offset0:32 offset1:32
    v_fmac_f32 v183, v200, v200
    v_mfma_f32_16x16x32_bf16 v[138:141], a[68:71], v[166:169], v[138:141]
    v_fmac_f32 v183, v201, v201
    v_mul_f32 v159, v254, v159
    v_mfma_f32_16x16x32_bf16 v[146:149], v[150:153], a[144:147], 0
    v_cvt_pk_bf16_f32 v144, v158, v159
    v_mul_f32 v160, v254, v160
    v_mfma_f32_16x16x32_bf16 v[146:149], v[206:209], a[148:151], v[146:149]
    v_mul_f32 v161, v254, v161
    v_cvt_pk_bf16_f32 v145, v160, v161
    v_mfma_f32_16x16x32_bf16 v[146:149], v[118:121], a[152:155], v[146:149]
    v_fmac_f32 v183, v138, v138
    v_fmac_f32 v183, v139, v139
    v_mfma_f32_16x16x32_bf16 v[146:149], v[134:137], a[156:159], v[146:149]
    v_fmac_f32 v183, v140, v140
    v_fmac_f32 v183, v141, v141
    v_mfma_f32_16x16x32_bf16 v[146:149], v[170:173], a[160:163], v[146:149]
    v_cvt_pk_bf16_f32 v36, v183, v182
    v_mul_f32 v178, v254, v178
    v_mfma_f32_16x16x32_bf16 v[146:149], v[166:169], a[164:167], v[146:149]
    s_waitcnt lgkmcnt(1)
    v_mul_f32 v179, v254, v179
    v_cvt_pk_bf16_f32 v178, v178, v179
    v_mfma_f32_16x16x32_bf16 v[158:161], v[32:35], v[36:39], 0
    s_waitcnt lgkmcnt(0)
    buffer_store_dwordx2 v[184:185], v20, s[12:15], 0 offen nt
    v_mul_f32 v180, v254, v180
    v_mul_f32 v181, v254, v181
    v_mfma_f32_16x16x32_bf16 v[186:189], v[150:153], a[168:171], 0
    v_cvt_pk_bf16_f32 v214, v146, v147
    v_cvt_pk_bf16_f32 v215, v148, v149
    v_mfma_f32_16x16x32_bf16 v[186:189], v[206:209], a[172:175], v[186:189]
    v_rsq_f32 v159, v159
    v_mfma_f32_16x16x32_bf16 v[186:189], v[118:121], a[176:179], v[186:189]
    v_rsq_f32 v158, v158
    v_mfma_f32_16x16x32_bf16 v[186:189], v[134:137], a[180:183], v[186:189]
    v_mul_f32 v158, s31, v158
    v_mul_f32 v202, v159, v202
    v_mfma_f32_16x16x32_bf16 v[186:189], v[170:173], a[184:187], v[186:189]
    v_mul_f32 v203, v159, v203
    v_cvt_pk_f16_f32 v146, v202, v203
    v_mfma_f32_16x16x32_bf16 v[186:189], v[166:169], a[188:191], v[186:189]
    v_mul_f32 v204, v159, v204
    v_mul_f32 v205, v159, v205
    v_mfma_f32_16x16x32_bf16 v[182:185], v[150:153], a[192:195], 0
    v_cvt_pk_f16_f32 v147, v204, v205
    v_mul_f32 v126, v159, v126
    v_mfma_f32_16x16x32_bf16 v[182:185], v[206:209], a[196:199], v[182:185]
    ds_read_b128 v[150:153], v5 offset:0
    ds_read_b128 v[202:205], v5 offset:16
    v_mfma_f32_16x16x32_bf16 v[182:185], v[118:121], a[200:203], v[182:185]
    ds_read_b128 v[118:121], v5 offset:48
    ds_read_b32 v254, v6 offset:192
    v_mfma_f32_16x16x32_bf16 v[182:185], v[134:137], a[204:207], v[182:185]
    v_cvt_pk_bf16_f32 v222, v186, v187
    v_cvt_pk_bf16_f32 v223, v188, v189
    v_mfma_f32_16x16x32_bf16 v[182:185], v[170:173], a[208:211], v[182:185]
    v_mul_f32 v127, v159, v127
    v_cvt_pk_f16_f32 v148, v126, v127
    v_mfma_f32_16x16x32_bf16 v[182:185], v[166:169], a[212:215], v[182:185]
    ds_read_b128 v[166:169], v2 offset:0
    ds_read_b128 v[170:173], v2 offset:1024
    v_mfma_f32_16x16x32_f16 v[186:189], v[226:229], v[210:213], v[50:53]
    ds_read_b128 v[134:137], v2 offset:2048
    v_mul_f32 v128, v159, v128
    v_mul_f32 v129, v159, v129
    v_mfma_f32_16x16x16_f16 v[194:197], v[164:165], v[162:163], v[194:197]
    v_cvt_pk_f16_f32 v149, v128, v129
    v_cvt_pk_bf16_f32 v234, v182, v183
    v_cvt_pk_bf16_f32 v235, v184, v185
    v_mul_f32 v174, v159, v174
    v_mfma_f32_16x16x32_f16 v[126:129], v[146:149], v[210:213], v[54:57]
    s_waitcnt lgkmcnt(5)
    v_mul_f32 v175, v159, v175
    v_cvt_pk_f16_f32 v184, v174, v175
    v_mul_f32 v176, v159, v176
    v_mfma_f32_16x16x16_f16 v[186:189], v[124:125], v[162:163], v[186:189]
    v_mul_f32 v177, v159, v177
    v_cvt_pk_f16_f32 v185, v176, v177
    v_mul_f32 v190, v158, v190
    v_mul_f32 v191, v158, v191
    v_mfma_f32_16x16x16_f16 v[126:129], v[184:185], v[162:163], v[126:129]
    v_cvt_pk_f16_f32 v174, v190, v191
    v_mul_f32 v192, v158, v192
    v_mul_f32 v193, v158, v193
    v_cvt_pk_f16_f32 v175, v192, v193
    v_mfma_f32_16x16x32_f16 v[206:209], v[150:153], v[210:213], v[22:25]
    s_waitcnt lgkmcnt(2)
    ds_read_b128 v[210:213], v2 offset:3072
    buffer_store_dwordx4 v[142:145], v16, s[12:15], 0 offen nt
    ds_read_b128 v[238:241], v2 offset:4096
    v_mul_f32 v198, v158, v198
    v_mul_f32 v199, v158, v199
    v_cvt_pk_f16_f32 v176, v198, v199
    v_mfma_f32_16x16x32_f16 v[206:209], v[202:205], v[218:221], v[206:209]
    s_waitcnt lgkmcnt(2)
    v_mul_f32 v200, v158, v200
    v_mul_f32 v201, v158, v201
    v_mfma_f32_16x16x32_f16 v[206:209], v[118:121], v[162:165], v[206:209]
    ds_read_b128 v[142:145], v2 offset:5120
    v_cvt_pk_f16_f32 v177, v200, v201
    v_mul_f32 v138, v158, v138
    v_mul_f32 v139, v158, v139
    v_cvt_pk_f16_f32 v182, v138, v139
    v_mfma_f32_16x16x32_f16 v[198:201], v[150:153], v[154:157], v[24:27]
    v_mul_f32 v140, v158, v140
    v_mul_f32 v141, v158, v141
    v_mfma_f32_16x16x32_f16 v[198:201], v[202:205], v[226:229], v[198:201]
    v_mov_b32_dpp v254, v207 quad_perm:[0,1,2,3] row_mask:0x1 bank_mask:0xf
    v_cvt_pk_f16_f32 v183, v140, v141
    v_mfma_f32_16x16x32_f16 v[198:201], v[118:121], v[122:125], v[198:201]
    v_max3_f32 v255, v206, v194, v195
    v_max3_f32 v255, v255, v196, v197
    v_mfma_f32_16x16x32_f16 v[242:245], v[150:153], v[174:177], v[26:29]
    s_waitcnt lgkmcnt(1)
    v_max3_f32 v255, v255, v186, v187
    v_max3_f32 v255, v255, v188, v189
    v_mfma_f32_16x16x32_f16 v[242:245], v[202:205], v[146:149], v[242:245]
    v_max3_f32 v255, v255, v126, v127
    v_mov_b32_dpp v254, v199 quad_perm:[0,1,2,3] row_mask:0x2 bank_mask:0xf
    v_mfma_f32_16x16x32_f16 v[242:245], v[118:121], v[182:185], v[242:245]
    v_max3_f32 v255, v255, v128, v129
    v_mov_b32 v162, v255
    v_mfma_f32_16x16x32_bf16 v[150:153], a[216:219], v[166:169], 0
    s_waitcnt lgkmcnt(0)
    v_permlane32_swap_b32 v255, v162
    v_mfma_f32_16x16x32_bf16 v[150:153], a[220:223], v[170:173], v[150:153]
    v_max_f32 v255, v255, v162
    v_mov_b32 v162, v255
    v_mfma_f32_16x16x32_bf16 v[150:153], a[224:227], v[134:137], v[150:153]
    v_cvt_pk_bf16_f32 v179, v180, v181
    v_xor_b32 v0, 65536, v0
    v_mfma_f32_16x16x32_bf16 v[150:153], a[228:231], v[210:213], v[150:153]
    s_waitcnt vmcnt(5)
    v_permlane16_swap_b32 v255, v162
    v_mfma_f32_16x16x32_bf16 v[150:153], a[232:235], v[238:241], v[150:153]
    v_max_f32 v255, v255, v162
    v_sub_f32 v194, v194, v255
    v_mfma_f32_16x16x32_bf16 v[150:153], a[236:239], v[142:145], v[150:153]
    s_barrier
    v_exp_f32 v194, v194
    v_mfma_f32_16x16x32_bf16 v[190:193], a[240:243], v[166:169], 0
    v_sub_f32 v195, v195, v255
    v_sub_f32 v196, v196, v255
    v_mfma_f32_16x16x32_bf16 v[190:193], a[244:247], v[170:173], v[190:193]
    buffer_load_dwordx4 v10, s[8:11], 0 offen nt lds
    v_sub_f32 v197, v197, v255
    v_mfma_f32_16x16x32_bf16 v[190:193], a[248:251], v[134:137], v[190:193]
    s_add_u32 m0, s28, 4096
    v_exp_f32 v195, v195
    v_mfma_f32_16x16x32_bf16 v[190:193], a[252:255], v[210:213], v[190:193]
    v_cvt_pk_bf16_f32 v158, v194, v195
    v_sub_f32 v186, v186, v255
    v_mfma_f32_16x16x32_bf16 v[190:193], v[82:85], v[238:241], v[190:193]
    v_exp_f32 v196, v196
    v_mfma_f32_16x16x32_bf16 v[190:193], v[86:89], v[142:145], v[190:193]
    v_exp_f32 v197, v197
    v_mfma_f32_16x16x32_bf16 v[202:205], v[90:93], v[166:169], 0
    ds_read_b128 v[166:169], v2 offset:6144
    buffer_load_dwordx4 v11, s[8:11], 0 offen nt lds
    v_mfma_f32_16x16x32_bf16 v[202:205], v[94:97], v[170:173], v[202:205]
    s_add_u32 m0, s28, 8192
    ds_read_b128 v[170:173], v2 offset:7168
    v_cvt_pk_bf16_f32 v159, v196, v197
    v_mfma_f32_16x16x32_bf16 v[202:205], v[98:101], v[134:137], v[202:205]
    ds_read_b128 v[138:141], v2 offset:8192
    v_sub_f32 v187, v187, v255
    v_mfma_f32_16x16x32_bf16 v[202:205], v[102:105], v[210:213], v[202:205]
    ds_read_b128 v[210:213], v2 offset:9216
    v_sub_f32 v188, v188, v255
    v_mfma_f32_16x16x32_bf16 v[202:205], v[106:109], v[238:241], v[202:205]
    ds_read_b128 v[134:137], v2 offset:10240
    v_sub_f32 v189, v189, v255
    v_mfma_f32_16x16x32_bf16 v[202:205], v[110:113], v[142:145], v[202:205]
    ds_read_b128 v[194:197], v2 offset:11264
    buffer_load_dwordx4 v12, s[8:11], 0 offen nt lds
    v_exp_f32 v186, v186
    v_mfma_f32_16x16x32_f16 v[118:121], v[218:221], v[154:157], v[58:61]
    s_add_u32 m0, s28, 12288
    v_exp_f32 v187, v187
    v_exp_f32 v188, v188
    v_cvt_pk_bf16_f32 v160, v186, v187
    v_exp_f32 v189, v189
    v_sub_f32 v126, v126, v255
    v_mfma_f32_16x16x16_f16 v[118:121], v[164:165], v[122:123], v[118:121]
    v_cvt_pk_bf16_f32 v161, v188, v189
    v_exp_f32 v126, v126
    v_sub_f32 v127, v127, v255
    v_mfma_f32_16x16x32_f16 v[186:189], v[226:229], v[154:157], v[62:65]
    s_xor_b32 s28, s28, 65536
    buffer_load_dwordx4 v13, s[8:11], 0 offen nt lds
    v_exp_f32 v127, v127
    v_sub_f32 v128, v128, v255
    v_cvt_pk_bf16_f32 v36, v126, v127
    v_exp_f32 v128, v128
    v_mfma_f32_16x16x16_f16 v[186:189], v[124:125], v[122:123], v[186:189]
    v_sub_f32 v129, v129, v255
    v_exp_f32 v129, v129
    v_sub_f32 v206, v206, v255
    v_cvt_pk_bf16_f32 v37, v128, v129
    v_mfma_f32_16x16x32_f16 v[126:129], v[146:149], v[154:157], v[66:69]
    s_waitcnt lgkmcnt(0)
    v_exp_f32 v206, v206
    v_mfma_f32_16x16x32_bf16 v[142:145], a[216:219], v[166:169], 0
    s_mov_b32 m0, s29
    v_cvt_pk_bf16_f32 v39, v206, 0
    v_max3_f32 v255, v198, v118, v119
    v_max3_f32 v255, v255, v120, v121
    v_mfma_f32_16x16x16_f16 v[126:129], v[184:185], v[122:123], v[126:129]
    v_max3_f32 v255, v255, v186, v187
    v_max3_f32 v255, v255, v188, v189
    v_xor_b32 v1, 65536, v1
    v_mov_b32_dpp v254, v243 quad_perm:[0,1,2,3] row_mask:0x4 bank_mask:0xf
    v_mfma_f32_16x16x32_bf16 v[154:157], v[28:31], v[36:39], 0
    s_xor_b32 s29, s29, s30
    buffer_store_dwordx2 v[178:179], v19, s[12:15], 0 offen nt
    v_mov_b32 v122, v254
    v_max3_f32 v255, v255, v126, v127
    v_mfma_f32_16x16x32_bf16 v[154:157], v[28:31], v[158:161], v[154:157]
    s_add_u32 s19, s19, s20
    v_max3_f32 v255, v255, v128, v129
    v_mov_b32 v123, v255
    v_mfma_f32_16x16x32_bf16 v[142:145], a[220:223], v[170:173], v[142:145]
    s_add_u32 s23, s23, s21
    v_permlane32_swap_b32 v255, v123
    v_mfma_f32_16x16x32_bf16 v[142:145], a[224:227], v[138:141], v[142:145]
    s_cmp_ge_u32 s19, 72
    v_rcp_f32 v154, v154
    v_mfma_f32_16x16x32_bf16 v[142:145], a[228:231], v[210:213], v[142:145]
    s_cselect_b32 s34, 72, 0
    v_max_f32 v255, v255, v123
    v_mov_b32 v123, v255
    v_mfma_f32_16x16x32_bf16 v[142:145], a[232:235], v[134:137], v[142:145]
    s_cselect_b32 s35, s22, 0
    v_permlane16_swap_b32 v255, v123
    v_mfma_f32_16x16x32_bf16 v[142:145], a[236:239], v[194:197], v[142:145]
    s_sub_u32 s19, s19, s34
    v_max_f32 v255, v255, v123
    v_sub_f32 v118, v118, v255
    v_mfma_f32_16x16x32_bf16 v[178:181], v[214:217], v[36:39], 0
    s_add_u32 s23, s23, s35
    v_exp_f32 v118, v118
    v_mfma_f32_16x16x32_bf16 v[178:181], v[230:233], v[158:161], v[178:181]
    s_add_u32 s18, s18, 1
    v_sub_f32 v119, v119, v255
    v_exp_f32 v119, v119
    v_sub_f32 v120, v120, v255
    v_cvt_pk_bf16_f32 v118, v118, v119
    v_exp_f32 v120, v120
    v_sub_f32 v121, v121, v255
    v_exp_f32 v121, v121
    v_mul_f32 v178, v154, v178
    v_mul_f32 v179, v154, v179
    v_cvt_pk_bf16_f32 v178, v178, v179
    v_mul_f32 v180, v154, v180
    v_mul_f32 v181, v154, v181
    v_cvt_pk_bf16_f32 v179, v180, v181
    v_cvt_pk_bf16_f32 v119, v120, v121
    v_mfma_f32_16x16x32_bf16 v[206:209], v[222:225], v[36:39], 0
    s_cmp_lt_u32 s18, s45
    v_sub_f32 v186, v186, v255
    v_sub_f32 v187, v187, v255
    v_mfma_f32_16x16x32_bf16 v[206:209], v[130:133], v[158:161], v[206:209]
    v_exp_f32 v186, v186
    v_exp_f32 v187, v187
    v_sub_f32 v188, v188, v255
    v_cvt_pk_bf16_f32 v120, v186, v187
    v_exp_f32 v188, v188
    v_sub_f32 v189, v189, v255
    v_exp_f32 v189, v189
    v_sub_f32 v126, v126, v255
    v_mul_f32 v206, v154, v206
    v_mul_f32 v207, v154, v207
    v_cvt_pk_bf16_f32 v180, v206, v207
    v_mul_f32 v208, v154, v208
    v_mul_f32 v209, v154, v209
    v_cvt_pk_bf16_f32 v181, v208, v209
    v_cvt_pk_bf16_f32 v121, v188, v189
    v_mfma_f32_16x16x32_bf16 v[186:189], v[234:237], v[36:39], 0
    buffer_load_dwordx4 v14, s[8:11], 0 offen nt lds
    v_sub_f32 v127, v127, v255
    v_mfma_f32_16x16x32_bf16 v[186:189], v[114:117], v[158:161], v[186:189]
    ds_write_b128 v3, v[178:181] offset:0
    v_mfma_f32_16x16x32_bf16 v[158:161], a[240:243], v[166:169], 0
    v_exp_f32 v126, v126
    v_mfma_f32_16x16x32_bf16 v[158:161], a[244:247], v[170:173], v[158:161]
    v_exp_f32 v127, v127
    v_mfma_f32_16x16x32_bf16 v[158:161], a[248:251], v[138:141], v[158:161]
    v_cvt_pk_bf16_f32 v36, v126, v127
    v_sub_f32 v128, v128, v255
    v_mfma_f32_16x16x32_bf16 v[158:161], a[252:255], v[210:213], v[158:161]
    v_mul_f32 v186, v154, v186
    v_mul_f32 v187, v154, v187
    v_mfma_f32_16x16x32_bf16 v[158:161], v[82:85], v[134:137], v[158:161]
    v_cvt_pk_bf16_f32 v126, v186, v187
    v_mul_f32 v188, v154, v188
    v_mfma_f32_16x16x32_bf16 v[158:161], v[86:89], v[194:197], v[158:161]
    v_mul_f32 v189, v154, v189
    v_cvt_pk_bf16_f32 v127, v188, v189
    v_mfma_f32_16x16x32_bf16 v[178:181], v[90:93], v[166:169], 0
    ds_read_b128 v[166:169], v2 offset:12288
    v_sub_f32 v129, v129, v255
    v_mfma_f32_16x16x32_bf16 v[178:181], v[94:97], v[170:173], v[178:181]
    ds_read_b128 v[170:173], v2 offset:13312
    v_sub_f32 v198, v198, v255
    v_mfma_f32_16x16x32_bf16 v[178:181], v[98:101], v[138:141], v[178:181]
    ds_read_b128 v[154:157], v2 offset:14336
    v_max_f32_dpp v122, v122, v122 quad_perm:[1,0,3,2] row_mask:0xf bank_mask:0xf
    v_mfma_f32_16x16x32_bf16 v[178:181], v[102:105], v[210:213], v[178:181]
    ds_read_b128 v[210:213], v2 offset:15360
    v_max_f32_dpp v122, v122, v122 quad_perm:[2,3,0,1] row_mask:0xf bank_mask:0xf
    v_mfma_f32_16x16x32_bf16 v[178:181], v[106:109], v[134:137], v[178:181]
    ds_read_b128 v[134:137], v2 offset:16384
    v_max_f32_dpp v122, v122, v122 row_half_mirror row_mask:0xf bank_mask:0xf
    v_mfma_f32_16x16x32_bf16 v[178:181], v[110:113], v[194:197], v[178:181]
    ds_read_b128 v[194:197], v2 offset:17408
    ds_write_b64 v4, v[126:127] offset:4096
    v_exp_f32 v128, v128
    v_exp_f32 v129, v129
    v_mfma_f32_16x16x32_f16 v[186:189], v[218:221], v[174:177], v[70:73]
    s_waitcnt lgkmcnt(6)
    v_cvt_pk_bf16_f32 v37, v128, v129
    v_max_f32_dpp v122, v122, v122 row_mirror row_mask:0xf bank_mask:0xf
    v_mfma_f32_16x16x32_f16 v[218:221], v[226:229], v[174:177], v[74:77]
    s_waitcnt lgkmcnt(5)
    v_exp_f32 v198, v198
    v_mfma_f32_16x16x32_f16 v[126:129], v[146:149], v[174:177], v[78:81]
    s_waitcnt lgkmcnt(4)
    v_cvt_pk_bf16_f32 v39, v198, 0
    v_mov_b32 v123, v122
    v_fma_f32 v255, v150, v150, s33
    v_mfma_f32_16x16x32_bf16 v[174:177], v[28:31], v[36:39], 0
    s_waitcnt lgkmcnt(3)
    v_permlane32_swap_b32 v122, v123
    v_mfma_f32_16x16x32_bf16 v[174:177], v[28:31], v[118:121], v[174:177]
    s_waitcnt lgkmcnt(2)
    v_max_f32 v122, v122, v123
    v_mov_b32 v123, v122
    v_mfma_f32_16x16x32_bf16 v[226:229], v[214:217], v[36:39], 0
    s_waitcnt lgkmcnt(0)
    v_permlane16_swap_b32 v122, v123
    v_mfma_f32_16x16x32_bf16 v[226:229], v[230:233], v[118:121], v[226:229]
    v_max_f32 v122, v122, v123
    v_sub_f32 v254, v254, v122
    v_mfma_f32_16x16x32_bf16 v[198:201], v[222:225], v[36:39], 0
    v_exp_f32 v254, v254
    v_mfma_f32_16x16x32_bf16 v[198:201], v[130:133], v[118:121], v[198:201]
    v_cvt_pk_bf16_f32 v254, v254, v254
    v_fmac_f32 v255, v151, v151
    v_mfma_f32_16x16x32_bf16 v[206:209], v[234:237], v[36:39], 0
    ds_write_b16 v8, v254
    v_mfma_f32_16x16x32_bf16 v[206:209], v[114:117], v[118:121], v[206:209]
    v_rcp_f32 v174, v174
    v_fmac_f32 v255, v152, v152
    v_mfma_f32_16x16x16_f16 v[186:189], v[164:165], v[182:183], v[186:189]
    v_mul_f32 v226, v174, v226
    v_mul_f32 v227, v174, v227
    v_cvt_pk_bf16_f32 v122, v226, v227
    v_mfma_f32_16x16x16_f16 v[218:221], v[124:125], v[182:183], v[218:221]
    v_mul_f32 v228, v174, v228
    v_mul_f32 v229, v174, v229
    v_cvt_pk_bf16_f32 v123, v228, v229
    v_mfma_f32_16x16x16_f16 v[126:129], v[184:185], v[182:183], v[126:129]
    v_max3_f32 v254, v242, v186, v187
    v_max3_f32 v254, v254, v188, v189
    v_mul_f32 v198, v174, v198
    v_mul_f32 v199, v174, v199
    v_mfma_f32_16x16x32_bf16 v[146:149], a[216:219], v[166:169], 0
    ds_read_b128 v[182:185], v9
    ds_read_b128 v[118:121], v9 offset:64
    v_mfma_f32_16x16x32_bf16 v[146:149], a[220:223], v[170:173], v[146:149]
    v_max3_f32 v254, v254, v218, v219
    v_max3_f32 v254, v254, v220, v221
    v_mfma_f32_16x16x32_bf16 v[146:149], a[224:227], v[154:157], v[146:149]
    v_max3_f32 v254, v254, v126, v127
    v_max3_f32 v254, v254, v128, v129
    v_mfma_f32_16x16x32_bf16 v[146:149], a[228:231], v[210:213], v[146:149]
    v_mov_b32 v125, v254
    v_cvt_pk_bf16_f32 v124, v198, v199
    v_mfma_f32_16x16x32_bf16 v[146:149], a[232:235], v[134:137], v[146:149]
    v_permlane32_swap_b32 v254, v125
    v_mfma_f32_16x16x32_bf16 v[146:149], a[236:239], v[194:197], v[146:149]
    v_max_f32 v254, v254, v125
    v_mov_b32 v125, v254
    v_mfma_f32_16x16x32_bf16 v[138:141], a[240:243], v[166:169], 0
    v_mul_f32 v200, v174, v200
    v_mul_f32 v201, v174, v201
    v_mfma_f32_16x16x32_bf16 v[138:141], a[244:247], v[170:173], v[138:141]
    v_permlane16_swap_b32 v254, v125
    v_mfma_f32_16x16x32_bf16 v[138:141], a[248:251], v[154:157], v[138:141]
    s_waitcnt lgkmcnt(0)
    v_max_f32 v254, v254, v125
    v_sub_f32 v186, v186, v254
    v_mfma_f32_16x16x32_bf16 v[138:141], a[252:255], v[210:213], v[138:141]
    v_exp_f32 v186, v186
    v_mfma_f32_16x16x32_bf16 v[138:141], v[82:85], v[134:137], v[138:141]
    v_sub_f32 v187, v187, v254
    v_sub_f32 v188, v188, v254
    v_mfma_f32_16x16x32_bf16 v[138:141], v[86:89], v[194:197], v[138:141]
    v_exp_f32 v187, v187
    v_exp_f32 v188, v188
    v_cvt_pk_bf16_f32 v238, v186, v187
    v_sub_f32 v189, v189, v254
    v_exp_f32 v189, v189
    v_sub_f32 v218, v218, v254
    v_cvt_pk_bf16_f32 v239, v188, v189
    v_exp_f32 v218, v218
    v_sub_f32 v219, v219, v254
    v_exp_f32 v219, v219
    v_sub_f32 v220, v220, v254
    v_cvt_pk_bf16_f32 v240, v218, v219
    v_mfma_f32_16x16x32_bf16 v[186:189], v[90:93], v[166:169], 0
    v_exp_f32 v220, v220
    v_mfma_f32_16x16x32_bf16 v[186:189], v[94:97], v[170:173], v[186:189]
    v_sub_f32 v221, v221, v254
    v_sub_f32 v126, v126, v254
    v_mfma_f32_16x16x32_bf16 v[186:189], v[98:101], v[154:157], v[186:189]
    v_exp_f32 v221, v221
    v_mfma_f32_16x16x32_bf16 v[186:189], v[102:105], v[210:213], v[186:189]
    v_cvt_pk_bf16_f32 v241, v220, v221
    v_sub_f32 v127, v127, v254
    v_mfma_f32_16x16x32_bf16 v[186:189], v[106:109], v[134:137], v[186:189]
    v_exp_f32 v126, v126
    v_mfma_f32_16x16x32_bf16 v[186:189], v[110:113], v[194:197], v[186:189]
    ds_read_b128 v[170:173], v0 offset:20480
    ds_read_b128 v[166:169], v1 offset:20480
    v_mfma_f32_16x16x32_bf16 v[154:157], v[182:185], v[28:31], 0
    ds_read_b128 v[162:165], v0 offset:20608
    ds_read_b128 v[210:213], v1 offset:20608
    v_mfma_f32_16x16x32_bf16 v[154:157], v[118:121], v[28:31], v[154:157]
    v_exp_f32 v127, v127
    v_mfma_f32_16x16x32_bf16 v[134:137], v[182:185], v[230:233], 0
    ds_read_b128 v[226:229], v0 offset:20736
    v_cvt_pk_bf16_f32 v36, v126, v127
    v_mfma_f32_16x16x32_bf16 v[134:137], v[118:121], v[214:217], v[134:137]
    ds_read_b128 v[218:221], v1 offset:20736
    v_sub_f32 v128, v128, v254
    v_exp_f32 v128, v128
    v_sub_f32 v129, v129, v254
    v_exp_f32 v129, v129
    v_sub_f32 v242, v242, v254
    v_cvt_pk_bf16_f32 v37, v128, v129
    v_mfma_f32_16x16x32_bf16 v[194:197], v[182:185], v[130:133], 0
    v_exp_f32 v242, v242
    v_mfma_f32_16x16x32_bf16 v[194:197], v[118:121], v[222:225], v[194:197]
    s_waitcnt lgkmcnt(4)
    v_cvt_pk_bf16_f32 v39, v242, 0
    v_cvt_pk_bf16_f32 v125, v200, v201
    v_mfma_f32_16x16x32_bf16 v[198:201], v[182:185], v[114:117], 0
    s_waitcnt lgkmcnt(2)
    ds_write_b128 v3, v[122:125] offset:6144
    v_mfma_f32_16x16x32_bf16 v[126:129], v[28:31], v[36:39], 0
    s_waitcnt lgkmcnt(2)
    v_mul_f32 v206, v174, v206
    v_mul_f32 v207, v174, v207
    v_mfma_f32_16x16x32_bf16 v[126:129], v[28:31], v[238:241], v[126:129]
    s_waitcnt lgkmcnt(1)
    v_cvt_pk_bf16_f32 v206, v206, v207
    v_mul_f32 v208, v174, v208
    v_mfma_f32_16x16x32_bf16 v[122:125], v[214:217], v[36:39], 0
    v_mul_f32 v209, v174, v209
    v_cvt_pk_bf16_f32 v207, v208, v209
    v_mfma_f32_16x16x32_bf16 v[122:125], v[230:233], v[238:241], v[122:125]
    ds_write_b64 v4, v[206:207] offset:10240
    v_mfma_f32_16x16x32_bf16 v[230:233], v[222:225], v[36:39], 0
    v_rcp_f32 v126, v126
    v_mfma_f32_16x16x32_bf16 v[230:233], v[130:133], v[238:241], v[230:233]
    v_fma_f32 v254, v146, v146, s33
    v_fmac_f32 v254, v147, v147
    v_mfma_f32_16x16x32_bf16 v[174:177], v[234:237], v[36:39], 0
    v_fmac_f32 v254, v148, v148
    v_mul_f32 v122, v126, v122
    v_mfma_f32_16x16x32_bf16 v[174:177], v[114:117], v[238:241], v[174:177]
    v_mul_f32 v123, v126, v123
    v_cvt_pk_bf16_f32 v122, v122, v123
    v_mfma_f32_16x16x32_bf16 v[198:201], v[118:121], v[234:237], v[198:201]
    v_mul_f32 v124, v126, v124
    v_mul_f32 v125, v126, v125
    v_mfma_f32_16x16x32_bf16 v[114:117], a[72:75], v[170:173], 0
    v_cvt_pk_bf16_f32 v123, v124, v125
    v_mul_f32 v230, v126, v230
    v_mfma_f32_16x16x32_bf16 v[114:117], a[76:79], v[166:169], v[114:117]
    v_mul_f32 v231, v126, v231
    v_cvt_pk_bf16_f32 v124, v230, v231
    v_mfma_f32_16x16x32_bf16 v[114:117], a[80:83], v[162:165], v[114:117]
    v_mul_f32 v232, v126, v232
    v_mul_f32 v233, v126, v233
    v_mfma_f32_16x16x32_bf16 v[114:117], a[84:87], v[210:213], v[114:117]
    v_cvt_pk_bf16_f32 v125, v232, v233
    v_mul_f32 v174, v126, v174
    v_mfma_f32_16x16x32_bf16 v[114:117], a[88:91], v[226:229], v[114:117]
    ds_write_b128 v3, v[122:125] offset:12288
    v_mfma_f32_16x16x32_bf16 v[114:117], a[92:95], v[218:221], v[114:117]
    v_mul_f32 v175, v126, v175
    v_cvt_pk_bf16_f32 v174, v174, v175
    v_mfma_f32_16x16x32_bf16 v[122:125], a[96:99], v[170:173], 0
    v_mul_f32 v176, v126, v176
    v_mul_f32 v177, v126, v177
    v_mfma_f32_16x16x32_bf16 v[122:125], a[100:103], v[166:169], v[122:125]
    v_cvt_pk_bf16_f32 v175, v176, v177
    v_fmac_f32 v254, v149, v149
    v_mfma_f32_16x16x32_bf16 v[122:125], a[104:107], v[162:165], v[122:125]
    ds_write_b64 v4, v[174:175] offset:16384
    v_mfma_f32_16x16x32_bf16 v[122:125], a[108:111], v[210:213], v[122:125]
    v_fmac_f32 v254, v138, v138
    v_fmac_f32 v254, v139, v139
    v_mfma_f32_16x16x32_bf16 v[122:125], a[112:115], v[226:229], v[122:125]
    v_fmac_f32 v254, v140, v140
    v_fmac_f32 v254, v141, v141
    v_mfma_f32_16x16x32_bf16 v[122:125], a[116:119], v[218:221], v[122:125]
    v_fmac_f32 v254, v186, v186
    v_fmac_f32 v254, v187, v187
    v_mfma_f32_16x16x32_bf16 v[126:129], a[120:123], v[170:173], 0
    v_fmac_f32 v254, v188, v188
    v_fmac_f32 v254, v189, v189
    v_mfma_f32_16x16x32_bf16 v[126:129], a[124:127], v[166:169], v[126:129]
    v_cvt_pk_bf16_f32 v135, v254, v254
    v_fmac_f32 v255, v153, v153
    v_mfma_f32_16x16x32_bf16 v[126:129], a[128:131], v[162:165], v[126:129]
    v_rcp_f32 v154, v154
    v_mfma_f32_16x16x32_bf16 v[126:129], a[132:135], v[210:213], v[126:129]
    v_mul_f32 v134, v134, v154
    v_mul_f32_dpp v134, v194, v154 quad_perm:[0,1,2,3] row_mask:0x2 bank_mask:0xf
    v_mfma_f32_16x16x32_bf16 v[126:129], a[136:139], v[226:229], v[126:129]
    v_mul_f32_dpp v134, v198, v154 quad_perm:[0,1,2,3] row_mask:0x4 bank_mask:0xf
    v_cvt_pk_bf16_f32 v134, v134, v134
    v_mfma_f32_16x16x32_bf16 v[126:129], a[140:143], v[218:221], v[126:129]
    ds_write_b16 v7, v134
    v_mfma_f32_16x16x32_bf16 v[154:157], a[0:3], v[170:173], 0
    v_fmac_f32 v255, v190, v190
    v_fmac_f32 v255, v191, v191
    v_mfma_f32_16x16x32_bf16 v[154:157], a[4:7], v[166:169], v[154:157]
    v_fmac_f32 v255, v192, v192
    v_fmac_f32 v255, v193, v193
    v_mfma_f32_16x16x32_bf16 v[154:157], a[8:11], v[162:165], v[154:157]
    v_fmac_f32 v255, v202, v202
    v_fmac_f32 v255, v203, v203
    v_mfma_f32_16x16x32_bf16 v[154:157], a[12:15], v[210:213], v[154:157]
    v_fmac_f32 v255, v204, v204
    v_fmac_f32 v255, v205, v205
    v_mfma_f32_16x16x32_bf16 v[154:157], a[16:19], v[226:229], v[154:157]
    v_fma_f32 v254, v142, v142, s33
    v_fmac_f32 v254, v143, v143
    v_mfma_f32_16x16x32_bf16 v[154:157], a[20:23], v[218:221], v[154:157]
    v_fmac_f32 v254, v144, v144
    v_fmac_f32 v254, v145, v145
    v_mfma_f32_16x16x32_bf16 v[174:177], a[24:27], v[170:173], 0
    v_fmac_f32 v254, v158, v158
    v_fmac_f32 v254, v159, v159
    v_mfma_f32_16x16x32_bf16 v[174:177], a[28:31], v[166:169], v[174:177]
    v_fmac_f32 v254, v160, v160
    v_fmac_f32 v254, v161, v161
    v_mfma_f32_16x16x32_bf16 v[174:177], a[32:35], v[162:165], v[174:177]
    v_fmac_f32 v254, v178, v178
    v_fmac_f32 v254, v179, v179
    v_mfma_f32_16x16x32_bf16 v[174:177], a[36:39], v[210:213], v[174:177]
    v_fmac_f32 v254, v180, v180
    v_fmac_f32 v254, v181, v181
    v_mfma_f32_16x16x32_bf16 v[174:177], a[40:43], v[226:229], v[174:177]
    v_cvt_pk_bf16_f32 v134, v255, v254
    v_add_u32 v5, 336, v5
    v_mfma_f32_16x16x32_bf16 v[174:177], a[44:47], v[218:221], v[174:177]
    ds_write_b64 v4, v[134:135] offset:18432
    v_mfma_f32_16x16x32_bf16 v[182:185], a[48:51], v[170:173], 0
    v_add_u32 v6, 272, v6
    v_add_u32 v7, 16, v7
    v_mfma_f32_16x16x32_bf16 v[182:185], a[52:55], v[166:169], v[182:185]
    v_fma_f32 v130, v114, v114, s32
    v_fmac_f32 v130, v115, v115
    v_mfma_f32_16x16x32_bf16 v[182:185], a[56:59], v[162:165], v[182:185]
    v_fmac_f32 v130, v116, v116
    v_fmac_f32 v130, v117, v117
    v_mfma_f32_16x16x32_bf16 v[182:185], a[60:63], v[210:213], v[182:185]
    v_fmac_f32 v130, v122, v122
    v_fmac_f32 v130, v123, v123
    v_mfma_f32_16x16x32_bf16 v[182:185], a[64:67], v[226:229], v[182:185]
    v_fmac_f32 v130, v124, v124
    v_fmac_f32 v130, v125, v125
    v_mfma_f32_16x16x32_bf16 v[182:185], a[68:71], v[218:221], v[182:185]
    v_fmac_f32 v130, v126, v126
    v_fmac_f32 v130, v127, v127
    v_mfma_f32_16x16x32_bf16 v[230:233], v[170:173], a[144:147], 0
    s_waitcnt lgkmcnt(0)
    v_fmac_f32 v130, v128, v128
    v_fmac_f32 v130, v129, v129
    v_mfma_f32_16x16x32_bf16 v[230:233], v[166:169], a[148:151], v[230:233]
    v_fma_f32 v131, v154, v154, s32
    v_fmac_f32 v131, v155, v155
    v_mfma_f32_16x16x32_bf16 v[230:233], v[162:165], a[152:155], v[230:233]
    s_barrier
    v_fmac_f32 v131, v156, v156
    v_fmac_f32 v131, v157, v157
    v_mfma_f32_16x16x32_bf16 v[230:233], v[210:213], a[156:159], v[230:233]
    s_nop 0
    v_fmac_f32 v131, v174, v174
    v_xor_b32 v2, 65536, v2
    v_mfma_f32_16x16x32_bf16 v[230:233], v[226:229], a[160:163], v[230:233]
    s_nop 0
    v_xor_b32 v3, 65536, v3
    v_xor_b32 v4, 65536, v4
    v_mfma_f32_16x16x32_bf16 v[230:233], v[218:221], a[164:167], v[230:233]
    s_cbranch_scc1 L_loop_safe1
    s_branch L_final_safe
.p2align 6
L_loop_safe2:
    v_mfma_f32_16x16x32_bf16 v[194:197], v[170:173], a[168:171], 0
    s_add_u32 s12, s42, s27
    ds_read_b128 v[198:201], v2 offset:18432
    ds_read_b128 v[214:217], v2 offset:19456
    v_mfma_f32_16x16x32_bf16 v[194:197], v[166:169], a[172:175], v[194:197]
    s_addc_u32 s13, s43, 0
    v_fmac_f32 v131, v175, v175
    v_fmac_f32 v131, v176, v176
    v_mfma_f32_16x16x32_bf16 v[194:197], v[162:165], a[176:179], v[194:197]
    s_sub_u32 s14, s36, s27
    v_fmac_f32 v131, v177, v177
    v_fmac_f32 v131, v182, v182
    v_mfma_f32_16x16x32_bf16 v[194:197], v[210:213], a[180:183], v[194:197]
    s_cmp_ge_u32 s18, 2
    v_fmac_f32 v131, v183, v183
    v_fmac_f32 v131, v184, v184
    v_mfma_f32_16x16x32_bf16 v[194:197], v[226:229], a[184:187], v[194:197]
    s_cselect_b32 s14, s14, 0
    ds_read_b128 v[118:121], v0 offset:26624
    v_fmac_f32 v131, v185, v185
    v_mfma_f32_16x16x32_bf16 v[194:197], v[218:221], a[188:191], v[194:197]
    s_add_u32 s34, s18, 2
    ds_read_b128 v[134:137], v1 offset:26624
    v_cvt_pk_bf16_f32 v36, v131, v130
    v_mfma_f32_16x16x32_bf16 v[234:237], v[170:173], a[192:195], 0
    s_add_u32 s8, s40, s23
    ds_read_b128 v[170:173], v0 offset:26752
    v_cvt_pk_bf16_f32 v230, v230, v231
    v_mfma_f32_16x16x32_bf16 v[234:237], v[166:169], a[196:199], v[234:237]
    s_addc_u32 s9, s41, 0
    ds_read_b128 v[166:169], v1 offset:26752
    v_cvt_pk_bf16_f32 v231, v232, v233
    v_mfma_f32_16x16x32_bf16 v[222:225], v[32:35], v[36:39], 0
    s_sub_u32 s10, s36, s23
    v_cvt_pk_bf16_f32 v130, v194, v195
    v_cvt_pk_bf16_f32 v131, v196, v197
    v_mfma_f32_16x16x32_bf16 v[234:237], v[162:165], a[200:203], v[234:237]
    s_waitcnt lgkmcnt(4)
    ds_read_b128 v[194:197], v0 offset:26880
    s_cmp_lt_u32 s34, s17
    v_mfma_f32_16x16x32_bf16 v[206:209], v[32:35], v[198:201], 0
    s_cselect_b32 s10, s10, 0
    v_rsq_f32 v223, v223
    v_mfma_f32_16x16x32_bf16 v[206:209], v[32:35], v[214:217], v[206:209]
    s_add_u32 m0, s28, 0
    v_rsq_f32 v222, v222
    v_mfma_f32_16x16x32_bf16 v[234:237], v[210:213], a[204:207], v[234:237]
    s_waitcnt lgkmcnt(4)
    ds_read_b128 v[198:201], v1 offset:26880
    v_mul_f32 v222, s31, v222
    v_mfma_f32_16x16x32_bf16 v[234:237], v[226:229], a[208:211], v[234:237]
    s_mov_b32 s27, s26
    v_mul_f32 v114, v223, v114
    v_mul_f32 v115, v223, v115
    v_mfma_f32_16x16x32_bf16 v[234:237], v[218:221], a[212:215], v[234:237]
    s_mov_b32 s26, s25
    v_cvt_pk_f16_f32 v218, v114, v115
    v_mul_f32 v116, v223, v116
    v_mfma_f32_16x16x32_bf16 v[226:229], a[72:75], v[118:121], 0
    s_waitcnt lgkmcnt(2)
    v_mul_f32 v117, v223, v117
    v_cvt_pk_f16_f32 v219, v116, v117
    v_mfma_f32_16x16x32_bf16 v[226:229], a[76:79], v[134:137], v[226:229]
    s_mov_b32 s25, s24
    v_cvt_pk_bf16_f32 v114, v234, v235
    v_cvt_pk_bf16_f32 v115, v236, v237
    v_mfma_f32_16x16x32_bf16 v[226:229], a[80:83], v[170:173], v[226:229]
    s_mov_b32 s24, s23
    v_mul_f32 v122, v223, v122
    v_mul_f32 v123, v223, v123
    v_mfma_f32_16x16x32_bf16 v[226:229], a[84:87], v[166:169], v[226:229]
    s_waitcnt lgkmcnt(1)
    v_cvt_pk_f16_f32 v220, v122, v123
    v_mul_f32 v124, v223, v124
    v_mfma_f32_16x16x32_bf16 v[226:229], a[88:91], v[194:197], v[226:229]
    v_mul_f32 v125, v223, v125
    v_cvt_pk_f16_f32 v221, v124, v125
    v_mfma_f32_16x16x32_bf16 v[122:125], a[96:99], v[118:121], 0
    s_waitcnt lgkmcnt(0)
    v_mul_f32 v126, v223, v126
    v_mul_f32 v127, v223, v127
    v_mfma_f32_16x16x32_bf16 v[226:229], a[92:95], v[198:201], v[226:229]
    v_cvt_pk_f16_f32 v164, v126, v127
    v_mul_f32 v128, v223, v128
    v_mfma_f32_16x16x32_bf16 v[122:125], a[100:103], v[134:137], v[122:125]
    v_mul_f32 v129, v223, v129
    v_cvt_pk_f16_f32 v165, v128, v129
    v_mfma_f32_16x16x32_bf16 v[122:125], a[104:107], v[170:173], v[122:125]
    v_mul_f32 v154, v222, v154
    v_mul_f32 v155, v222, v155
    v_mfma_f32_16x16x32_bf16 v[122:125], a[108:111], v[166:169], v[122:125]
    v_cvt_pk_f16_f32 v210, v154, v155
    v_mul_f32 v156, v222, v156
    v_mfma_f32_16x16x32_bf16 v[122:125], a[112:115], v[194:197], v[122:125]
    v_mul_f32 v157, v222, v157
    v_cvt_pk_f16_f32 v211, v156, v157
    v_mfma_f32_16x16x32_bf16 v[122:125], a[116:119], v[198:201], v[122:125]
    v_mul_f32 v174, v222, v174
    v_mul_f32 v175, v222, v175
    v_mfma_f32_16x16x32_bf16 v[126:129], a[120:123], v[118:121], 0
    v_cvt_pk_f16_f32 v212, v174, v175
    v_mul_f32 v176, v222, v176
    v_mfma_f32_16x16x32_bf16 v[126:129], a[124:127], v[134:137], v[126:129]
    v_mul_f32 v177, v222, v177
    v_cvt_pk_f16_f32 v213, v176, v177
    v_mfma_f32_16x16x32_bf16 v[126:129], a[128:131], v[170:173], v[126:129]
    v_mul_f32 v182, v222, v182
    v_mul_f32 v183, v222, v183
    v_mfma_f32_16x16x32_bf16 v[126:129], a[132:135], v[166:169], v[126:129]
    v_cvt_pk_f16_f32 v162, v182, v183
    v_mul_f32 v184, v222, v184
    v_mfma_f32_16x16x32_bf16 v[126:129], a[136:139], v[194:197], v[126:129]
    v_mul_f32 v185, v222, v185
    v_cvt_pk_f16_f32 v163, v184, v185
    v_mfma_f32_16x16x32_bf16 v[126:129], a[140:143], v[198:201], v[126:129]
    v_fma_f32 v116, v226, v226, s32
    v_fmac_f32 v116, v227, v227
    v_mfma_f32_16x16x32_bf16 v[154:157], a[0:3], v[118:121], 0
    v_fmac_f32 v116, v228, v228
    v_fmac_f32 v116, v229, v229
    v_mfma_f32_16x16x32_bf16 v[154:157], a[4:7], v[134:137], v[154:157]
    v_fmac_f32 v116, v122, v122
    v_fmac_f32 v116, v123, v123
    v_mfma_f32_16x16x32_bf16 v[154:157], a[8:11], v[170:173], v[154:157]
    v_fmac_f32 v116, v124, v124
    v_fmac_f32 v116, v125, v125
    v_mfma_f32_16x16x32_bf16 v[154:157], a[12:15], v[166:169], v[154:157]
    v_fmac_f32 v116, v126, v126
    v_fmac_f32 v116, v127, v127
    v_mfma_f32_16x16x32_bf16 v[154:157], a[16:19], v[194:197], v[154:157]
    v_fmac_f32 v116, v128, v128
    v_fmac_f32 v116, v129, v129
    v_mfma_f32_16x16x32_bf16 v[154:157], a[20:23], v[198:201], v[154:157]
    v_mul_f32 v117, 0x3baaaaab, v206
    v_mul_f32 v254, 0x3baaaaab, v207
    v_mfma_f32_16x16x32_bf16 v[174:177], a[24:27], v[118:121], 0
    v_rsq_f32 v117, v117
    v_mfma_f32_16x16x32_bf16 v[174:177], a[28:31], v[134:137], v[174:177]
    v_rsq_f32 v254, v254
    v_mfma_f32_16x16x32_bf16 v[174:177], a[32:35], v[170:173], v[174:177]
    v_mul_f32 v255, 0x3baaaaab, v208
    v_fma_f32 v132, v154, v154, s32
    v_mfma_f32_16x16x32_bf16 v[174:177], a[36:39], v[166:169], v[174:177]
    v_fmac_f32 v132, v155, v155
    v_fmac_f32 v132, v156, v156
    v_mfma_f32_16x16x32_bf16 v[174:177], a[40:43], v[194:197], v[174:177]
    v_fmac_f32 v132, v157, v157
    v_mul_f32 v150, v117, v150
    v_mfma_f32_16x16x32_bf16 v[174:177], a[44:47], v[198:201], v[174:177]
    v_rsq_f32 v255, v255
    v_mfma_f32_16x16x32_bf16 v[182:185], a[48:51], v[118:121], 0
    v_mul_f32 v151, v117, v151
    v_cvt_pk_bf16_f32 v214, v150, v151
    v_mfma_f32_16x16x32_bf16 v[182:185], a[52:55], v[134:137], v[182:185]
    v_mul_f32 v152, v117, v152
    v_mul_f32 v153, v117, v153
    v_mfma_f32_16x16x32_bf16 v[182:185], a[56:59], v[170:173], v[182:185]
    v_fmac_f32 v132, v174, v174
    v_fmac_f32 v132, v175, v175
    v_mfma_f32_16x16x32_bf16 v[182:185], a[60:63], v[166:169], v[182:185]
    v_fmac_f32 v132, v176, v176
    v_fmac_f32 v132, v177, v177
    v_mfma_f32_16x16x32_bf16 v[182:185], a[64:67], v[194:197], v[182:185]
    v_cvt_pk_bf16_f32 v215, v152, v153
    v_mul_f32 v190, v117, v190
    v_mfma_f32_16x16x32_bf16 v[182:185], a[68:71], v[198:201], v[182:185]
    v_mul_f32 v191, v117, v191
    v_cvt_pk_bf16_f32 v216, v190, v191
    v_mfma_f32_16x16x32_bf16 v[150:153], v[118:121], a[144:147], 0
    v_mul_f32 v192, v117, v192
    v_mul_f32 v193, v117, v193
    v_mfma_f32_16x16x32_bf16 v[150:153], v[134:137], a[148:151], v[150:153]
    v_cvt_pk_bf16_f32 v217, v192, v193
    v_mul_f32 v202, v117, v202
    v_mfma_f32_16x16x32_bf16 v[150:153], v[170:173], a[152:155], v[150:153]
    buffer_store_dwordx4 v[214:217], v15, s[12:15], 0 offen nt
    v_fmac_f32 v132, v182, v182
    v_fmac_f32 v132, v183, v183
    v_fmac_f32 v132, v184, v184
    v_fmac_f32 v132, v185, v185
    v_mfma_f32_16x16x32_bf16 v[150:153], v[166:169], a[156:159], v[150:153]
    v_cvt_pk_bf16_f32 v36, v132, v116
    v_mul_f32 v203, v117, v203
    v_mfma_f32_16x16x32_bf16 v[150:153], v[194:197], a[160:163], v[150:153]
    v_cvt_pk_bf16_f32 v116, v202, v203
    v_mul_f32 v204, v117, v204
    v_mfma_f32_16x16x32_bf16 v[190:193], v[32:35], v[36:39], 0
    v_mul_f32 v205, v117, v205
    v_cvt_pk_bf16_f32 v117, v204, v205
    v_mfma_f32_16x16x32_bf16 v[150:153], v[198:201], a[164:167], v[150:153]
    v_mul_f32 v146, v255, v146
    v_mul_f32 v147, v255, v147
    v_mfma_f32_16x16x32_bf16 v[202:205], v[118:121], a[168:171], 0
    v_cvt_pk_bf16_f32 v146, v146, v147
    v_mul_f32 v148, v255, v148
    v_mfma_f32_16x16x32_bf16 v[202:205], v[134:137], a[172:175], v[202:205]
    v_rsq_f32 v191, v191
    v_mfma_f32_16x16x32_bf16 v[202:205], v[170:173], a[176:179], v[202:205]
    v_cvt_pk_bf16_f32 v232, v150, v151
    v_cvt_pk_bf16_f32 v233, v152, v153
    v_mfma_f32_16x16x32_bf16 v[202:205], v[166:169], a[180:183], v[202:205]
    v_rsq_f32 v190, v190
    v_mfma_f32_16x16x32_bf16 v[202:205], v[194:197], a[184:187], v[202:205]
    ds_read_b128 v[150:153], v0 offset:32768
    v_mul_f32 v190, s31, v190
    v_mfma_f32_16x16x32_bf16 v[202:205], v[198:201], a[188:191], v[202:205]
    ds_read_b128 v[206:209], v1 offset:32768
    v_mul_f32 v226, v191, v226
    v_mfma_f32_16x16x32_bf16 v[214:217], v[118:121], a[192:195], 0
    ds_read_b128 v[118:121], v0 offset:32896
    v_mul_f32 v227, v191, v227
    v_mfma_f32_16x16x32_bf16 v[214:217], v[134:137], a[196:199], v[214:217]
    ds_read_b128 v[134:137], v1 offset:32896
    v_cvt_pk_f16_f32 v226, v226, v227
    v_mfma_f32_16x16x32_bf16 v[214:217], v[170:173], a[200:203], v[214:217]
    ds_read_b128 v[170:173], v0 offset:33024
    v_cvt_pk_bf16_f32 v132, v202, v203
    v_mfma_f32_16x16x32_bf16 v[214:217], v[166:169], a[204:207], v[214:217]
    ds_read_b128 v[166:169], v1 offset:33024
    v_cvt_pk_bf16_f32 v133, v204, v205
    v_mfma_f32_16x16x32_bf16 v[214:217], v[194:197], a[208:211], v[214:217]
    v_mul_f32 v228, v191, v228
    v_mul_f32 v229, v191, v229
    v_mfma_f32_16x16x32_bf16 v[214:217], v[198:201], a[212:215], v[214:217]
    v_cvt_pk_f16_f32 v227, v228, v229
    v_mul_f32 v122, v191, v122
    v_mfma_f32_16x16x32_f16 v[194:197], v[218:221], v[210:213], v[46:49]
    s_waitcnt lgkmcnt(5)
    buffer_store_dwordx2 v[116:117], v18, s[12:15], 0 offen nt
    v_mul_f32 v123, v191, v123
    v_cvt_pk_f16_f32 v228, v122, v123
    v_mfma_f32_16x16x32_bf16 v[202:205], a[72:75], v[150:153], 0
    s_waitcnt lgkmcnt(3)
    v_cvt_pk_bf16_f32 v116, v214, v215
    v_cvt_pk_bf16_f32 v117, v216, v217
    v_mfma_f32_16x16x32_bf16 v[202:205], a[76:79], v[206:209], v[202:205]
    s_waitcnt lgkmcnt(2)
    v_mul_f32 v124, v191, v124
    v_mul_f32 v125, v191, v125
    v_mfma_f32_16x16x32_bf16 v[202:205], a[80:83], v[118:121], v[202:205]
    s_waitcnt lgkmcnt(1)
    v_cvt_pk_f16_f32 v229, v124, v125
    v_mul_f32 v126, v191, v126
    v_mfma_f32_16x16x32_bf16 v[202:205], a[84:87], v[134:137], v[202:205]
    s_waitcnt lgkmcnt(0)
    v_mul_f32 v127, v191, v127
    v_cvt_pk_f16_f32 v124, v126, v127
    v_mfma_f32_16x16x32_bf16 v[202:205], a[88:91], v[170:173], v[202:205]
    v_mul_f32 v128, v191, v128
    v_mul_f32 v129, v191, v129
    v_mfma_f32_16x16x32_bf16 v[202:205], a[92:95], v[166:169], v[202:205]
    v_cvt_pk_f16_f32 v125, v128, v129
    v_mul_f32 v154, v190, v154
    v_mfma_f32_16x16x32_bf16 v[126:129], a[96:99], v[150:153], 0
    v_mul_f32 v155, v190, v155
    v_cvt_pk_f16_f32 v154, v154, v155
    v_mfma_f32_16x16x32_bf16 v[126:129], a[100:103], v[206:209], v[126:129]
    v_mul_f32 v156, v190, v156
    v_mul_f32 v157, v190, v157
    v_mfma_f32_16x16x32_bf16 v[126:129], a[104:107], v[118:121], v[126:129]
    v_cvt_pk_f16_f32 v155, v156, v157
    v_mul_f32 v174, v190, v174
    v_mfma_f32_16x16x32_bf16 v[126:129], a[108:111], v[134:137], v[126:129]
    v_mul_f32 v175, v190, v175
    v_cvt_pk_f16_f32 v156, v174, v175
    v_mfma_f32_16x16x32_bf16 v[126:129], a[112:115], v[170:173], v[126:129]
    v_mul_f32 v176, v190, v176
    v_mul_f32 v177, v190, v177
    v_mfma_f32_16x16x32_bf16 v[126:129], a[116:119], v[166:169], v[126:129]
    v_cvt_pk_f16_f32 v157, v176, v177
    v_mul_f32 v182, v190, v182
    v_mfma_f32_16x16x32_bf16 v[174:177], a[120:123], v[150:153], 0
    v_mul_f32 v183, v190, v183
    v_cvt_pk_f16_f32 v122, v182, v183
    v_mfma_f32_16x16x32_bf16 v[174:177], a[124:127], v[206:209], v[174:177]
    v_mul_f32 v184, v190, v184
    v_mul_f32 v185, v190, v185
    v_mfma_f32_16x16x32_bf16 v[174:177], a[128:131], v[118:121], v[174:177]
    v_cvt_pk_f16_f32 v123, v184, v185
    v_fma_f32 v182, v202, v202, s32
    v_mfma_f32_16x16x32_bf16 v[174:177], a[132:135], v[134:137], v[174:177]
    v_fmac_f32 v182, v203, v203
    v_fmac_f32 v182, v204, v204
    v_mfma_f32_16x16x32_bf16 v[174:177], a[136:139], v[170:173], v[174:177]
    v_fmac_f32 v182, v205, v205
    v_fmac_f32 v182, v126, v126
    v_mfma_f32_16x16x32_bf16 v[174:177], a[140:143], v[166:169], v[174:177]
    v_fmac_f32 v182, v127, v127
    v_fmac_f32 v182, v128, v128
    v_mfma_f32_16x16x32_bf16 v[190:193], a[0:3], v[150:153], 0
    v_fmac_f32 v182, v129, v129
    v_mul_f32 v149, v255, v149
    v_mfma_f32_16x16x32_bf16 v[190:193], a[4:7], v[206:209], v[190:193]
    v_cvt_pk_bf16_f32 v147, v148, v149
    v_mul_f32 v138, v255, v138
    v_mfma_f32_16x16x32_bf16 v[190:193], a[8:11], v[118:121], v[190:193]
    v_fmac_f32 v182, v174, v174
    v_fmac_f32 v182, v175, v175
    v_mfma_f32_16x16x32_bf16 v[190:193], a[12:15], v[134:137], v[190:193]
    v_fmac_f32 v182, v176, v176
    v_fmac_f32 v182, v177, v177
    v_mfma_f32_16x16x32_bf16 v[190:193], a[16:19], v[170:173], v[190:193]
    v_mul_f32 v139, v255, v139
    v_cvt_pk_bf16_f32 v148, v138, v139
    v_mfma_f32_16x16x32_bf16 v[190:193], a[20:23], v[166:169], v[190:193]
    v_mul_f32 v140, v255, v140
    v_mul_f32 v141, v255, v141
    v_mfma_f32_16x16x32_bf16 v[198:201], a[24:27], v[150:153], 0
    v_cvt_pk_bf16_f32 v149, v140, v141
    v_mul_f32 v186, v255, v186
    v_mfma_f32_16x16x32_bf16 v[198:201], a[28:31], v[206:209], v[198:201]
    buffer_store_dwordx4 v[146:149], v17, s[12:15], 0 offen nt
    v_mul_f32 v187, v255, v187
    v_fma_f32 v183, v190, v190, s32
    v_fmac_f32 v183, v191, v191
    v_fmac_f32 v183, v192, v192
    v_mfma_f32_16x16x32_bf16 v[198:201], a[32:35], v[118:121], v[198:201]
    v_fmac_f32 v183, v193, v193
    v_cvt_pk_bf16_f32 v184, v186, v187
    v_mfma_f32_16x16x32_bf16 v[198:201], a[36:39], v[134:137], v[198:201]
    v_mul_f32 v188, v255, v188
    v_mul_f32 v189, v255, v189
    v_mfma_f32_16x16x32_bf16 v[198:201], a[40:43], v[170:173], v[198:201]
    v_cvt_pk_bf16_f32 v185, v188, v189
    v_mul_f32 v142, v254, v142
    v_mfma_f32_16x16x32_bf16 v[198:201], a[44:47], v[166:169], v[198:201]
    v_mul_f32 v143, v254, v143
    v_cvt_pk_bf16_f32 v142, v142, v143
    v_mfma_f32_16x16x32_bf16 v[138:141], a[48:51], v[150:153], 0
    v_mul_f32 v144, v254, v144
    v_mul_f32 v145, v254, v145
    v_mfma_f32_16x16x32_bf16 v[138:141], a[52:55], v[206:209], v[138:141]
    v_cvt_pk_bf16_f32 v143, v144, v145
    v_mul_f32 v158, v254, v158
    v_mfma_f32_16x16x32_bf16 v[138:141], a[56:59], v[118:121], v[138:141]
    v_fmac_f32 v183, v198, v198
    v_fmac_f32 v183, v199, v199
    v_mfma_f32_16x16x32_bf16 v[138:141], a[60:63], v[134:137], v[138:141]
    ds_read2_b32 v[216:217], v6 offset0:0 offset1:0
    ds_read2_b32 v[224:225], v6 offset0:16 offset1:16
    v_mfma_f32_16x16x32_bf16 v[138:141], a[64:67], v[170:173], v[138:141]
    ds_read2_b32 v[236:237], v6 offset0:32 offset1:32
    v_fmac_f32 v183, v200, v200
    v_mfma_f32_16x16x32_bf16 v[138:141], a[68:71], v[166:169], v[138:141]
    v_fmac_f32 v183, v201, v201
    v_mul_f32 v159, v254, v159
    v_mfma_f32_16x16x32_bf16 v[146:149], v[150:153], a[144:147], 0
    v_cvt_pk_bf16_f32 v144, v158, v159
    v_mul_f32 v160, v254, v160
    v_mfma_f32_16x16x32_bf16 v[146:149], v[206:209], a[148:151], v[146:149]
    v_mul_f32 v161, v254, v161
    v_cvt_pk_bf16_f32 v145, v160, v161
    v_mfma_f32_16x16x32_bf16 v[146:149], v[118:121], a[152:155], v[146:149]
    v_fmac_f32 v183, v138, v138
    v_fmac_f32 v183, v139, v139
    v_mfma_f32_16x16x32_bf16 v[146:149], v[134:137], a[156:159], v[146:149]
    v_fmac_f32 v183, v140, v140
    v_fmac_f32 v183, v141, v141
    v_mfma_f32_16x16x32_bf16 v[146:149], v[170:173], a[160:163], v[146:149]
    v_cvt_pk_bf16_f32 v36, v183, v182
    v_mul_f32 v178, v254, v178
    v_mfma_f32_16x16x32_bf16 v[146:149], v[166:169], a[164:167], v[146:149]
    s_waitcnt lgkmcnt(1)
    v_mul_f32 v179, v254, v179
    v_cvt_pk_bf16_f32 v178, v178, v179
    v_mfma_f32_16x16x32_bf16 v[158:161], v[32:35], v[36:39], 0
    s_waitcnt lgkmcnt(0)
    buffer_store_dwordx2 v[184:185], v20, s[12:15], 0 offen nt
    v_mul_f32 v180, v254, v180
    v_mul_f32 v181, v254, v181
    v_mfma_f32_16x16x32_bf16 v[186:189], v[150:153], a[168:171], 0
    v_cvt_pk_bf16_f32 v214, v146, v147
    v_cvt_pk_bf16_f32 v215, v148, v149
    v_mfma_f32_16x16x32_bf16 v[186:189], v[206:209], a[172:175], v[186:189]
    v_rsq_f32 v159, v159
    v_mfma_f32_16x16x32_bf16 v[186:189], v[118:121], a[176:179], v[186:189]
    v_rsq_f32 v158, v158
    v_mfma_f32_16x16x32_bf16 v[186:189], v[134:137], a[180:183], v[186:189]
    v_mul_f32 v158, s31, v158
    v_mul_f32 v202, v159, v202
    v_mfma_f32_16x16x32_bf16 v[186:189], v[170:173], a[184:187], v[186:189]
    v_mul_f32 v203, v159, v203
    v_cvt_pk_f16_f32 v146, v202, v203
    v_mfma_f32_16x16x32_bf16 v[186:189], v[166:169], a[188:191], v[186:189]
    v_mul_f32 v204, v159, v204
    v_mul_f32 v205, v159, v205
    v_mfma_f32_16x16x32_bf16 v[182:185], v[150:153], a[192:195], 0
    v_cvt_pk_f16_f32 v147, v204, v205
    v_mul_f32 v126, v159, v126
    v_mfma_f32_16x16x32_bf16 v[182:185], v[206:209], a[196:199], v[182:185]
    ds_read_b128 v[150:153], v5 offset:0
    ds_read_b128 v[202:205], v5 offset:16
    v_mfma_f32_16x16x32_bf16 v[182:185], v[118:121], a[200:203], v[182:185]
    ds_read_b128 v[118:121], v5 offset:48
    ds_read_b32 v254, v6 offset:192
    v_mfma_f32_16x16x32_bf16 v[182:185], v[134:137], a[204:207], v[182:185]
    v_cvt_pk_bf16_f32 v222, v186, v187
    v_cvt_pk_bf16_f32 v223, v188, v189
    v_mfma_f32_16x16x32_bf16 v[182:185], v[170:173], a[208:211], v[182:185]
    v_mul_f32 v127, v159, v127
    v_cvt_pk_f16_f32 v148, v126, v127
    v_mfma_f32_16x16x32_bf16 v[182:185], v[166:169], a[212:215], v[182:185]
    ds_read_b128 v[166:169], v2 offset:0
    ds_read_b128 v[170:173], v2 offset:1024
    v_mfma_f32_16x16x32_f16 v[186:189], v[226:229], v[210:213], v[50:53]
    ds_read_b128 v[134:137], v2 offset:2048
    v_mul_f32 v128, v159, v128
    v_mul_f32 v129, v159, v129
    v_mfma_f32_16x16x16_f16 v[194:197], v[164:165], v[162:163], v[194:197]
    v_cvt_pk_f16_f32 v149, v128, v129
    v_cvt_pk_bf16_f32 v234, v182, v183
    v_cvt_pk_bf16_f32 v235, v184, v185
    v_mul_f32 v174, v159, v174
    v_mfma_f32_16x16x32_f16 v[126:129], v[146:149], v[210:213], v[54:57]
    s_waitcnt lgkmcnt(5)
    v_mul_f32 v175, v159, v175
    v_cvt_pk_f16_f32 v184, v174, v175
    v_mul_f32 v176, v159, v176
    v_mfma_f32_16x16x16_f16 v[186:189], v[124:125], v[162:163], v[186:189]
    v_mul_f32 v177, v159, v177
    v_cvt_pk_f16_f32 v185, v176, v177
    v_mul_f32 v190, v158, v190
    v_mul_f32 v191, v158, v191
    v_mfma_f32_16x16x16_f16 v[126:129], v[184:185], v[162:163], v[126:129]
    v_cvt_pk_f16_f32 v174, v190, v191
    v_mul_f32 v192, v158, v192
    v_mul_f32 v193, v158, v193
    v_cvt_pk_f16_f32 v175, v192, v193
    v_mfma_f32_16x16x32_f16 v[206:209], v[150:153], v[210:213], v[22:25]
    s_waitcnt lgkmcnt(2)
    ds_read_b128 v[210:213], v2 offset:3072
    buffer_store_dwordx4 v[142:145], v16, s[12:15], 0 offen nt
    ds_read_b128 v[238:241], v2 offset:4096
    v_mul_f32 v198, v158, v198
    v_mul_f32 v199, v158, v199
    v_cvt_pk_f16_f32 v176, v198, v199
    v_mfma_f32_16x16x32_f16 v[206:209], v[202:205], v[218:221], v[206:209]
    s_waitcnt lgkmcnt(2)
    v_mul_f32 v200, v158, v200
    v_mul_f32 v201, v158, v201
    v_mfma_f32_16x16x32_f16 v[206:209], v[118:121], v[162:165], v[206:209]
    ds_read_b128 v[142:145], v2 offset:5120
    v_cvt_pk_f16_f32 v177, v200, v201
    v_mul_f32 v138, v158, v138
    v_mul_f32 v139, v158, v139
    v_cvt_pk_f16_f32 v182, v138, v139
    v_mfma_f32_16x16x32_f16 v[198:201], v[150:153], v[154:157], v[24:27]
    v_mul_f32 v140, v158, v140
    v_mul_f32 v141, v158, v141
    v_mfma_f32_16x16x32_f16 v[198:201], v[202:205], v[226:229], v[198:201]
    v_mov_b32_dpp v254, v207 quad_perm:[0,1,2,3] row_mask:0x1 bank_mask:0xf
    v_cvt_pk_f16_f32 v183, v140, v141
    v_mfma_f32_16x16x32_f16 v[198:201], v[118:121], v[122:125], v[198:201]
    v_max3_f32 v255, v206, v194, v195
    v_max3_f32 v255, v255, v196, v197
    v_mfma_f32_16x16x32_f16 v[242:245], v[150:153], v[174:177], v[26:29]
    s_waitcnt lgkmcnt(1)
    v_max3_f32 v255, v255, v186, v187
    v_max3_f32 v255, v255, v188, v189
    v_mfma_f32_16x16x32_f16 v[242:245], v[202:205], v[146:149], v[242:245]
    v_max3_f32 v255, v255, v126, v127
    v_mov_b32_dpp v254, v199 quad_perm:[0,1,2,3] row_mask:0x2 bank_mask:0xf
    v_mfma_f32_16x16x32_f16 v[242:245], v[118:121], v[182:185], v[242:245]
    v_max3_f32 v255, v255, v128, v129
    v_mov_b32 v162, v255
    v_mfma_f32_16x16x32_bf16 v[150:153], a[216:219], v[166:169], 0
    s_waitcnt lgkmcnt(0)
    v_permlane32_swap_b32 v255, v162
    v_mfma_f32_16x16x32_bf16 v[150:153], a[220:223], v[170:173], v[150:153]
    v_max_f32 v255, v255, v162
    v_mov_b32 v162, v255
    v_mfma_f32_16x16x32_bf16 v[150:153], a[224:227], v[134:137], v[150:153]
    v_cvt_pk_bf16_f32 v179, v180, v181
    v_xor_b32 v0, 65536, v0
    v_mfma_f32_16x16x32_bf16 v[150:153], a[228:231], v[210:213], v[150:153]
    s_waitcnt vmcnt(5)
    v_permlane16_swap_b32 v255, v162
    v_mfma_f32_16x16x32_bf16 v[150:153], a[232:235], v[238:241], v[150:153]
    v_max_f32 v255, v255, v162
    v_sub_f32 v194, v194, v255
    v_mfma_f32_16x16x32_bf16 v[150:153], a[236:239], v[142:145], v[150:153]
    v_exp_f32 v194, v194
    v_mfma_f32_16x16x32_bf16 v[190:193], a[240:243], v[166:169], 0
    s_barrier
    v_sub_f32 v195, v195, v255
    v_sub_f32 v196, v196, v255
    v_mfma_f32_16x16x32_bf16 v[190:193], a[244:247], v[170:173], v[190:193]
    buffer_load_dwordx4 v10, s[8:11], 0 offen nt lds
    v_sub_f32 v197, v197, v255
    v_mfma_f32_16x16x32_bf16 v[190:193], a[248:251], v[134:137], v[190:193]
    s_add_u32 m0, s28, 4096
    v_exp_f32 v195, v195
    v_mfma_f32_16x16x32_bf16 v[190:193], a[252:255], v[210:213], v[190:193]
    v_cvt_pk_bf16_f32 v158, v194, v195
    v_sub_f32 v186, v186, v255
    v_mfma_f32_16x16x32_bf16 v[190:193], v[82:85], v[238:241], v[190:193]
    v_exp_f32 v196, v196
    v_mfma_f32_16x16x32_bf16 v[190:193], v[86:89], v[142:145], v[190:193]
    v_exp_f32 v197, v197
    v_mfma_f32_16x16x32_bf16 v[202:205], v[90:93], v[166:169], 0
    ds_read_b128 v[166:169], v2 offset:6144
    buffer_load_dwordx4 v11, s[8:11], 0 offen nt lds
    v_mfma_f32_16x16x32_bf16 v[202:205], v[94:97], v[170:173], v[202:205]
    s_add_u32 m0, s28, 8192
    ds_read_b128 v[170:173], v2 offset:7168
    v_cvt_pk_bf16_f32 v159, v196, v197
    v_mfma_f32_16x16x32_bf16 v[202:205], v[98:101], v[134:137], v[202:205]
    ds_read_b128 v[138:141], v2 offset:8192
    v_sub_f32 v187, v187, v255
    v_mfma_f32_16x16x32_bf16 v[202:205], v[102:105], v[210:213], v[202:205]
    ds_read_b128 v[210:213], v2 offset:9216
    v_sub_f32 v188, v188, v255
    v_mfma_f32_16x16x32_bf16 v[202:205], v[106:109], v[238:241], v[202:205]
    ds_read_b128 v[134:137], v2 offset:10240
    v_sub_f32 v189, v189, v255
    v_mfma_f32_16x16x32_bf16 v[202:205], v[110:113], v[142:145], v[202:205]
    ds_read_b128 v[194:197], v2 offset:11264
    buffer_load_dwordx4 v12, s[8:11], 0 offen nt lds
    v_exp_f32 v186, v186
    v_mfma_f32_16x16x32_f16 v[118:121], v[218:221], v[154:157], v[58:61]
    s_add_u32 m0, s28, 12288
    v_exp_f32 v187, v187
    v_exp_f32 v188, v188
    v_cvt_pk_bf16_f32 v160, v186, v187
    v_exp_f32 v189, v189
    v_sub_f32 v126, v126, v255
    v_mfma_f32_16x16x16_f16 v[118:121], v[164:165], v[122:123], v[118:121]
    v_cvt_pk_bf16_f32 v161, v188, v189
    v_exp_f32 v126, v126
    v_sub_f32 v127, v127, v255
    v_mfma_f32_16x16x32_f16 v[186:189], v[226:229], v[154:157], v[62:65]
    s_xor_b32 s28, s28, 65536
    buffer_load_dwordx4 v13, s[8:11], 0 offen nt lds
    v_exp_f32 v127, v127
    v_sub_f32 v128, v128, v255
    v_cvt_pk_bf16_f32 v36, v126, v127
    v_exp_f32 v128, v128
    v_mfma_f32_16x16x16_f16 v[186:189], v[124:125], v[122:123], v[186:189]
    v_sub_f32 v129, v129, v255
    v_exp_f32 v129, v129
    v_sub_f32 v206, v206, v255
    v_cvt_pk_bf16_f32 v37, v128, v129
    v_mfma_f32_16x16x32_f16 v[126:129], v[146:149], v[154:157], v[66:69]
    s_waitcnt lgkmcnt(0)
    v_exp_f32 v206, v206
    v_mfma_f32_16x16x32_bf16 v[142:145], a[216:219], v[166:169], 0
    s_mov_b32 m0, s29
    v_cvt_pk_bf16_f32 v39, v206, 0
    v_max3_f32 v255, v198, v118, v119
    v_max3_f32 v255, v255, v120, v121
    v_mfma_f32_16x16x16_f16 v[126:129], v[184:185], v[122:123], v[126:129]
    v_max3_f32 v255, v255, v186, v187
    v_max3_f32 v255, v255, v188, v189
    v_xor_b32 v1, 65536, v1
    v_mov_b32_dpp v254, v243 quad_perm:[0,1,2,3] row_mask:0x4 bank_mask:0xf
    v_mfma_f32_16x16x32_bf16 v[154:157], v[28:31], v[36:39], 0
    s_xor_b32 s29, s29, s30
    buffer_store_dwordx2 v[178:179], v19, s[12:15], 0 offen nt
    v_mov_b32 v122, v254
    v_max3_f32 v255, v255, v126, v127
    v_mfma_f32_16x16x32_bf16 v[154:157], v[28:31], v[158:161], v[154:157]
    s_add_u32 s19, s19, s20
    v_max3_f32 v255, v255, v128, v129
    v_mov_b32 v123, v255
    v_mfma_f32_16x16x32_bf16 v[142:145], a[220:223], v[170:173], v[142:145]
    s_add_u32 s23, s23, s21
    v_permlane32_swap_b32 v255, v123
    v_mfma_f32_16x16x32_bf16 v[142:145], a[224:227], v[138:141], v[142:145]
    s_cmp_ge_u32 s19, 72
    v_rcp_f32 v154, v154
    v_mfma_f32_16x16x32_bf16 v[142:145], a[228:231], v[210:213], v[142:145]
    s_cselect_b32 s34, 72, 0
    v_max_f32 v255, v255, v123
    v_mov_b32 v123, v255
    v_mfma_f32_16x16x32_bf16 v[142:145], a[232:235], v[134:137], v[142:145]
    s_cselect_b32 s35, s22, 0
    v_permlane16_swap_b32 v255, v123
    v_mfma_f32_16x16x32_bf16 v[142:145], a[236:239], v[194:197], v[142:145]
    s_sub_u32 s19, s19, s34
    v_max_f32 v255, v255, v123
    v_sub_f32 v118, v118, v255
    v_mfma_f32_16x16x32_bf16 v[178:181], v[214:217], v[36:39], 0
    s_add_u32 s23, s23, s35
    v_exp_f32 v118, v118
    v_mfma_f32_16x16x32_bf16 v[178:181], v[230:233], v[158:161], v[178:181]
    s_add_u32 s18, s18, 1
    v_sub_f32 v119, v119, v255
    v_exp_f32 v119, v119
    v_sub_f32 v120, v120, v255
    v_cvt_pk_bf16_f32 v118, v118, v119
    v_exp_f32 v120, v120
    v_sub_f32 v121, v121, v255
    v_exp_f32 v121, v121
    v_mul_f32 v178, v154, v178
    v_mul_f32 v179, v154, v179
    v_cvt_pk_bf16_f32 v178, v178, v179
    v_mul_f32 v180, v154, v180
    v_mul_f32 v181, v154, v181
    v_cvt_pk_bf16_f32 v179, v180, v181
    v_cvt_pk_bf16_f32 v119, v120, v121
    v_mfma_f32_16x16x32_bf16 v[206:209], v[222:225], v[36:39], 0
    s_cmp_lt_u32 s18, s45
    v_sub_f32 v186, v186, v255
    v_sub_f32 v187, v187, v255
    v_mfma_f32_16x16x32_bf16 v[206:209], v[130:133], v[158:161], v[206:209]
    v_exp_f32 v186, v186
    v_exp_f32 v187, v187
    v_sub_f32 v188, v188, v255
    v_cvt_pk_bf16_f32 v120, v186, v187
    v_exp_f32 v188, v188
    v_sub_f32 v189, v189, v255
    v_exp_f32 v189, v189
    v_sub_f32 v126, v126, v255
    v_mul_f32 v206, v154, v206
    v_mul_f32 v207, v154, v207
    v_cvt_pk_bf16_f32 v180, v206, v207
    v_mul_f32 v208, v154, v208
    v_mul_f32 v209, v154, v209
    v_cvt_pk_bf16_f32 v181, v208, v209
    v_cvt_pk_bf16_f32 v121, v188, v189
    v_mfma_f32_16x16x32_bf16 v[186:189], v[234:237], v[36:39], 0
    v_sub_f32 v127, v127, v255
    v_mfma_f32_16x16x32_bf16 v[186:189], v[114:117], v[158:161], v[186:189]
    ds_write_b128 v3, v[178:181] offset:0
    v_mfma_f32_16x16x32_bf16 v[158:161], a[240:243], v[166:169], 0
    v_exp_f32 v126, v126
    v_mfma_f32_16x16x32_bf16 v[158:161], a[244:247], v[170:173], v[158:161]
    v_exp_f32 v127, v127
    v_mfma_f32_16x16x32_bf16 v[158:161], a[248:251], v[138:141], v[158:161]
    v_cvt_pk_bf16_f32 v36, v126, v127
    v_sub_f32 v128, v128, v255
    v_mfma_f32_16x16x32_bf16 v[158:161], a[252:255], v[210:213], v[158:161]
    v_mul_f32 v186, v154, v186
    v_mul_f32 v187, v154, v187
    v_mfma_f32_16x16x32_bf16 v[158:161], v[82:85], v[134:137], v[158:161]
    v_cvt_pk_bf16_f32 v126, v186, v187
    v_mul_f32 v188, v154, v188
    v_mfma_f32_16x16x32_bf16 v[158:161], v[86:89], v[194:197], v[158:161]
    v_mul_f32 v189, v154, v189
    v_cvt_pk_bf16_f32 v127, v188, v189
    v_mfma_f32_16x16x32_bf16 v[178:181], v[90:93], v[166:169], 0
    ds_read_b128 v[166:169], v2 offset:12288
    v_sub_f32 v129, v129, v255
    v_mfma_f32_16x16x32_bf16 v[178:181], v[94:97], v[170:173], v[178:181]
    ds_read_b128 v[170:173], v2 offset:13312
    v_sub_f32 v198, v198, v255
    v_mfma_f32_16x16x32_bf16 v[178:181], v[98:101], v[138:141], v[178:181]
    ds_read_b128 v[154:157], v2 offset:14336
    v_max_f32_dpp v122, v122, v122 quad_perm:[1,0,3,2] row_mask:0xf bank_mask:0xf
    v_mfma_f32_16x16x32_bf16 v[178:181], v[102:105], v[210:213], v[178:181]
    ds_read_b128 v[210:213], v2 offset:15360
    v_max_f32_dpp v122, v122, v122 quad_perm:[2,3,0,1] row_mask:0xf bank_mask:0xf
    v_mfma_f32_16x16x32_bf16 v[178:181], v[106:109], v[134:137], v[178:181]
    ds_read_b128 v[134:137], v2 offset:16384
    v_max_f32_dpp v122, v122, v122 row_half_mirror row_mask:0xf bank_mask:0xf
    v_mfma_f32_16x16x32_bf16 v[178:181], v[110:113], v[194:197], v[178:181]
    ds_read_b128 v[194:197], v2 offset:17408
    ds_write_b64 v4, v[126:127] offset:4096
    v_exp_f32 v128, v128
    v_exp_f32 v129, v129
    v_mfma_f32_16x16x32_f16 v[186:189], v[218:221], v[174:177], v[70:73]
    s_waitcnt lgkmcnt(6)
    v_cvt_pk_bf16_f32 v37, v128, v129
    v_max_f32_dpp v122, v122, v122 row_mirror row_mask:0xf bank_mask:0xf
    v_mfma_f32_16x16x32_f16 v[218:221], v[226:229], v[174:177], v[74:77]
    s_waitcnt lgkmcnt(5)
    v_exp_f32 v198, v198
    v_mfma_f32_16x16x32_f16 v[126:129], v[146:149], v[174:177], v[78:81]
    s_waitcnt lgkmcnt(4)
    v_cvt_pk_bf16_f32 v39, v198, 0
    v_mov_b32 v123, v122
    v_fma_f32 v255, v150, v150, s33
    v_mfma_f32_16x16x32_bf16 v[174:177], v[28:31], v[36:39], 0
    s_waitcnt lgkmcnt(3)
    v_permlane32_swap_b32 v122, v123
    v_mfma_f32_16x16x32_bf16 v[174:177], v[28:31], v[118:121], v[174:177]
    s_waitcnt lgkmcnt(2)
    v_max_f32 v122, v122, v123
    v_mov_b32 v123, v122
    v_mfma_f32_16x16x32_bf16 v[226:229], v[214:217], v[36:39], 0
    s_waitcnt lgkmcnt(0)
    v_permlane16_swap_b32 v122, v123
    v_mfma_f32_16x16x32_bf16 v[226:229], v[230:233], v[118:121], v[226:229]
    v_max_f32 v122, v122, v123
    v_sub_f32 v254, v254, v122
    v_mfma_f32_16x16x32_bf16 v[198:201], v[222:225], v[36:39], 0
    v_exp_f32 v254, v254
    v_mfma_f32_16x16x32_bf16 v[198:201], v[130:133], v[118:121], v[198:201]
    v_cvt_pk_bf16_f32 v254, v254, v254
    v_fmac_f32 v255, v151, v151
    v_mfma_f32_16x16x32_bf16 v[206:209], v[234:237], v[36:39], 0
    ds_write_b16 v8, v254
    v_mfma_f32_16x16x32_bf16 v[206:209], v[114:117], v[118:121], v[206:209]
    v_rcp_f32 v174, v174
    v_fmac_f32 v255, v152, v152
    v_mfma_f32_16x16x16_f16 v[186:189], v[164:165], v[182:183], v[186:189]
    v_mul_f32 v226, v174, v226
    v_mul_f32 v227, v174, v227
    v_cvt_pk_bf16_f32 v122, v226, v227
    v_mfma_f32_16x16x16_f16 v[218:221], v[124:125], v[182:183], v[218:221]
    v_mul_f32 v228, v174, v228
    v_mul_f32 v229, v174, v229
    v_cvt_pk_bf16_f32 v123, v228, v229
    v_mfma_f32_16x16x16_f16 v[126:129], v[184:185], v[182:183], v[126:129]
    v_max3_f32 v254, v242, v186, v187
    v_max3_f32 v254, v254, v188, v189
    v_mul_f32 v198, v174, v198
    v_mul_f32 v199, v174, v199
    v_mfma_f32_16x16x32_bf16 v[146:149], a[216:219], v[166:169], 0
    ds_read_b128 v[182:185], v9
    ds_read_b128 v[118:121], v9 offset:64
    v_mfma_f32_16x16x32_bf16 v[146:149], a[220:223], v[170:173], v[146:149]
    v_max3_f32 v254, v254, v218, v219
    v_max3_f32 v254, v254, v220, v221
    v_mfma_f32_16x16x32_bf16 v[146:149], a[224:227], v[154:157], v[146:149]
    v_max3_f32 v254, v254, v126, v127
    v_max3_f32 v254, v254, v128, v129
    v_mfma_f32_16x16x32_bf16 v[146:149], a[228:231], v[210:213], v[146:149]
    v_mov_b32 v125, v254
    v_cvt_pk_bf16_f32 v124, v198, v199
    v_mfma_f32_16x16x32_bf16 v[146:149], a[232:235], v[134:137], v[146:149]
    v_permlane32_swap_b32 v254, v125
    v_mfma_f32_16x16x32_bf16 v[146:149], a[236:239], v[194:197], v[146:149]
    v_max_f32 v254, v254, v125
    v_mov_b32 v125, v254
    v_mfma_f32_16x16x32_bf16 v[138:141], a[240:243], v[166:169], 0
    v_mul_f32 v200, v174, v200
    v_mul_f32 v201, v174, v201
    v_mfma_f32_16x16x32_bf16 v[138:141], a[244:247], v[170:173], v[138:141]
    v_permlane16_swap_b32 v254, v125
    v_mfma_f32_16x16x32_bf16 v[138:141], a[248:251], v[154:157], v[138:141]
    s_waitcnt lgkmcnt(0)
    v_max_f32 v254, v254, v125
    v_sub_f32 v186, v186, v254
    v_mfma_f32_16x16x32_bf16 v[138:141], a[252:255], v[210:213], v[138:141]
    v_exp_f32 v186, v186
    v_mfma_f32_16x16x32_bf16 v[138:141], v[82:85], v[134:137], v[138:141]
    v_sub_f32 v187, v187, v254
    v_sub_f32 v188, v188, v254
    v_mfma_f32_16x16x32_bf16 v[138:141], v[86:89], v[194:197], v[138:141]
    v_exp_f32 v187, v187
    v_exp_f32 v188, v188
    v_cvt_pk_bf16_f32 v238, v186, v187
    v_sub_f32 v189, v189, v254
    v_exp_f32 v189, v189
    v_sub_f32 v218, v218, v254
    v_cvt_pk_bf16_f32 v239, v188, v189
    v_exp_f32 v218, v218
    v_sub_f32 v219, v219, v254
    v_exp_f32 v219, v219
    v_sub_f32 v220, v220, v254
    v_cvt_pk_bf16_f32 v240, v218, v219
    v_mfma_f32_16x16x32_bf16 v[186:189], v[90:93], v[166:169], 0
    v_exp_f32 v220, v220
    v_mfma_f32_16x16x32_bf16 v[186:189], v[94:97], v[170:173], v[186:189]
    v_sub_f32 v221, v221, v254
    v_sub_f32 v126, v126, v254
    v_mfma_f32_16x16x32_bf16 v[186:189], v[98:101], v[154:157], v[186:189]
    v_exp_f32 v221, v221
    v_mfma_f32_16x16x32_bf16 v[186:189], v[102:105], v[210:213], v[186:189]
    v_cvt_pk_bf16_f32 v241, v220, v221
    v_sub_f32 v127, v127, v254
    v_mfma_f32_16x16x32_bf16 v[186:189], v[106:109], v[134:137], v[186:189]
    v_exp_f32 v126, v126
    v_mfma_f32_16x16x32_bf16 v[186:189], v[110:113], v[194:197], v[186:189]
    ds_read_b128 v[170:173], v0 offset:20480
    ds_read_b128 v[166:169], v1 offset:20480
    v_mfma_f32_16x16x32_bf16 v[154:157], v[182:185], v[28:31], 0
    ds_read_b128 v[162:165], v0 offset:20608
    ds_read_b128 v[210:213], v1 offset:20608
    v_mfma_f32_16x16x32_bf16 v[154:157], v[118:121], v[28:31], v[154:157]
    v_exp_f32 v127, v127
    v_mfma_f32_16x16x32_bf16 v[134:137], v[182:185], v[230:233], 0
    ds_read_b128 v[226:229], v0 offset:20736
    v_cvt_pk_bf16_f32 v36, v126, v127
    v_mfma_f32_16x16x32_bf16 v[134:137], v[118:121], v[214:217], v[134:137]
    ds_read_b128 v[218:221], v1 offset:20736
    v_sub_f32 v128, v128, v254
    v_exp_f32 v128, v128
    v_sub_f32 v129, v129, v254
    v_exp_f32 v129, v129
    v_sub_f32 v242, v242, v254
    v_cvt_pk_bf16_f32 v37, v128, v129
    v_mfma_f32_16x16x32_bf16 v[194:197], v[182:185], v[130:133], 0
    v_exp_f32 v242, v242
    v_mfma_f32_16x16x32_bf16 v[194:197], v[118:121], v[222:225], v[194:197]
    s_waitcnt lgkmcnt(4)
    v_cvt_pk_bf16_f32 v39, v242, 0
    v_cvt_pk_bf16_f32 v125, v200, v201
    v_mfma_f32_16x16x32_bf16 v[198:201], v[182:185], v[114:117], 0
    s_waitcnt lgkmcnt(2)
    ds_write_b128 v3, v[122:125] offset:6144
    v_mfma_f32_16x16x32_bf16 v[126:129], v[28:31], v[36:39], 0
    s_waitcnt lgkmcnt(2)
    v_mul_f32 v206, v174, v206
    v_mul_f32 v207, v174, v207
    v_mfma_f32_16x16x32_bf16 v[126:129], v[28:31], v[238:241], v[126:129]
    s_waitcnt lgkmcnt(1)
    v_cvt_pk_bf16_f32 v206, v206, v207
    v_mul_f32 v208, v174, v208
    v_mfma_f32_16x16x32_bf16 v[122:125], v[214:217], v[36:39], 0
    v_mul_f32 v209, v174, v209
    v_cvt_pk_bf16_f32 v207, v208, v209
    v_mfma_f32_16x16x32_bf16 v[122:125], v[230:233], v[238:241], v[122:125]
    ds_write_b64 v4, v[206:207] offset:10240
    v_mfma_f32_16x16x32_bf16 v[230:233], v[222:225], v[36:39], 0
    v_rcp_f32 v126, v126
    v_mfma_f32_16x16x32_bf16 v[230:233], v[130:133], v[238:241], v[230:233]
    v_fma_f32 v254, v146, v146, s33
    v_fmac_f32 v254, v147, v147
    v_mfma_f32_16x16x32_bf16 v[174:177], v[234:237], v[36:39], 0
    v_fmac_f32 v254, v148, v148
    v_mul_f32 v122, v126, v122
    v_mfma_f32_16x16x32_bf16 v[174:177], v[114:117], v[238:241], v[174:177]
    v_mul_f32 v123, v126, v123
    v_cvt_pk_bf16_f32 v122, v122, v123
    v_mfma_f32_16x16x32_bf16 v[198:201], v[118:121], v[234:237], v[198:201]
    v_mul_f32 v124, v126, v124
    v_mul_f32 v125, v126, v125
    v_mfma_f32_16x16x32_bf16 v[114:117], a[72:75], v[170:173], 0
    v_cvt_pk_bf16_f32 v123, v124, v125
    v_mul_f32 v230, v126, v230
    v_mfma_f32_16x16x32_bf16 v[114:117], a[76:79], v[166:169], v[114:117]
    v_mul_f32 v231, v126, v231
    v_cvt_pk_bf16_f32 v124, v230, v231
    v_mfma_f32_16x16x32_bf16 v[114:117], a[80:83], v[162:165], v[114:117]
    v_mul_f32 v232, v126, v232
    v_mul_f32 v233, v126, v233
    v_mfma_f32_16x16x32_bf16 v[114:117], a[84:87], v[210:213], v[114:117]
    v_cvt_pk_bf16_f32 v125, v232, v233
    v_mul_f32 v174, v126, v174
    v_mfma_f32_16x16x32_bf16 v[114:117], a[88:91], v[226:229], v[114:117]
    ds_write_b128 v3, v[122:125] offset:12288
    v_mfma_f32_16x16x32_bf16 v[114:117], a[92:95], v[218:221], v[114:117]
    v_mul_f32 v175, v126, v175
    v_cvt_pk_bf16_f32 v174, v174, v175
    v_mfma_f32_16x16x32_bf16 v[122:125], a[96:99], v[170:173], 0
    v_mul_f32 v176, v126, v176
    v_mul_f32 v177, v126, v177
    v_mfma_f32_16x16x32_bf16 v[122:125], a[100:103], v[166:169], v[122:125]
    v_cvt_pk_bf16_f32 v175, v176, v177
    v_fmac_f32 v254, v149, v149
    v_mfma_f32_16x16x32_bf16 v[122:125], a[104:107], v[162:165], v[122:125]
    ds_write_b64 v4, v[174:175] offset:16384
    v_mfma_f32_16x16x32_bf16 v[122:125], a[108:111], v[210:213], v[122:125]
    v_fmac_f32 v254, v138, v138
    v_fmac_f32 v254, v139, v139
    v_mfma_f32_16x16x32_bf16 v[122:125], a[112:115], v[226:229], v[122:125]
    v_fmac_f32 v254, v140, v140
    v_fmac_f32 v254, v141, v141
    v_mfma_f32_16x16x32_bf16 v[122:125], a[116:119], v[218:221], v[122:125]
    v_fmac_f32 v254, v186, v186
    v_fmac_f32 v254, v187, v187
    v_mfma_f32_16x16x32_bf16 v[126:129], a[120:123], v[170:173], 0
    v_fmac_f32 v254, v188, v188
    v_fmac_f32 v254, v189, v189
    v_mfma_f32_16x16x32_bf16 v[126:129], a[124:127], v[166:169], v[126:129]
    v_cvt_pk_bf16_f32 v135, v254, v254
    v_fmac_f32 v255, v153, v153
    v_mfma_f32_16x16x32_bf16 v[126:129], a[128:131], v[162:165], v[126:129]
    v_rcp_f32 v154, v154
    v_mfma_f32_16x16x32_bf16 v[126:129], a[132:135], v[210:213], v[126:129]
    v_mul_f32 v134, v134, v154
    v_mul_f32_dpp v134, v194, v154 quad_perm:[0,1,2,3] row_mask:0x2 bank_mask:0xf
    v_mfma_f32_16x16x32_bf16 v[126:129], a[136:139], v[226:229], v[126:129]
    v_mul_f32_dpp v134, v198, v154 quad_perm:[0,1,2,3] row_mask:0x4 bank_mask:0xf
    v_cvt_pk_bf16_f32 v134, v134, v134
    v_mfma_f32_16x16x32_bf16 v[126:129], a[140:143], v[218:221], v[126:129]
    ds_write_b16 v7, v134
    v_mfma_f32_16x16x32_bf16 v[154:157], a[0:3], v[170:173], 0
    v_fmac_f32 v255, v190, v190
    v_fmac_f32 v255, v191, v191
    v_mfma_f32_16x16x32_bf16 v[154:157], a[4:7], v[166:169], v[154:157]
    v_fmac_f32 v255, v192, v192
    v_fmac_f32 v255, v193, v193
    v_mfma_f32_16x16x32_bf16 v[154:157], a[8:11], v[162:165], v[154:157]
    v_fmac_f32 v255, v202, v202
    v_fmac_f32 v255, v203, v203
    v_mfma_f32_16x16x32_bf16 v[154:157], a[12:15], v[210:213], v[154:157]
    v_fmac_f32 v255, v204, v204
    v_fmac_f32 v255, v205, v205
    v_mfma_f32_16x16x32_bf16 v[154:157], a[16:19], v[226:229], v[154:157]
    v_fma_f32 v254, v142, v142, s33
    v_fmac_f32 v254, v143, v143
    v_mfma_f32_16x16x32_bf16 v[154:157], a[20:23], v[218:221], v[154:157]
    v_fmac_f32 v254, v144, v144
    v_fmac_f32 v254, v145, v145
    v_mfma_f32_16x16x32_bf16 v[174:177], a[24:27], v[170:173], 0
    v_fmac_f32 v254, v158, v158
    v_fmac_f32 v254, v159, v159
    v_mfma_f32_16x16x32_bf16 v[174:177], a[28:31], v[166:169], v[174:177]
    v_fmac_f32 v254, v160, v160
    v_fmac_f32 v254, v161, v161
    v_mfma_f32_16x16x32_bf16 v[174:177], a[32:35], v[162:165], v[174:177]
    v_fmac_f32 v254, v178, v178
    v_fmac_f32 v254, v179, v179
    v_mfma_f32_16x16x32_bf16 v[174:177], a[36:39], v[210:213], v[174:177]
    v_fmac_f32 v254, v180, v180
    v_fmac_f32 v254, v181, v181
    v_mfma_f32_16x16x32_bf16 v[174:177], a[40:43], v[226:229], v[174:177]
    v_cvt_pk_bf16_f32 v134, v255, v254
    v_add_u32 v5, 336, v5
    v_mfma_f32_16x16x32_bf16 v[174:177], a[44:47], v[218:221], v[174:177]
    ds_write_b64 v4, v[134:135] offset:18432
    v_mfma_f32_16x16x32_bf16 v[182:185], a[48:51], v[170:173], 0
    v_add_u32 v6, 272, v6
    v_add_u32 v7, 16, v7
    v_mfma_f32_16x16x32_bf16 v[182:185], a[52:55], v[166:169], v[182:185]
    v_fma_f32 v130, v114, v114, s32
    v_fmac_f32 v130, v115, v115
    v_mfma_f32_16x16x32_bf16 v[182:185], a[56:59], v[162:165], v[182:185]
    v_fmac_f32 v130, v116, v116
    v_fmac_f32 v130, v117, v117
    v_mfma_f32_16x16x32_bf16 v[182:185], a[60:63], v[210:213], v[182:185]
    v_fmac_f32 v130, v122, v122
    v_fmac_f32 v130, v123, v123
    v_mfma_f32_16x16x32_bf16 v[182:185], a[64:67], v[226:229], v[182:185]
    v_fmac_f32 v130, v124, v124
    v_fmac_f32 v130, v125, v125
    v_mfma_f32_16x16x32_bf16 v[182:185], a[68:71], v[218:221], v[182:185]
    v_fmac_f32 v130, v126, v126
    v_fmac_f32 v130, v127, v127
    v_mfma_f32_16x16x32_bf16 v[230:233], v[170:173], a[144:147], 0
    s_waitcnt lgkmcnt(0)
    v_fmac_f32 v130, v128, v128
    v_fmac_f32 v130, v129, v129
    v_mfma_f32_16x16x32_bf16 v[230:233], v[166:169], a[148:151], v[230:233]
    v_fma_f32 v131, v154, v154, s32
    v_fmac_f32 v131, v155, v155
    v_mfma_f32_16x16x32_bf16 v[230:233], v[162:165], a[152:155], v[230:233]
    v_fmac_f32 v131, v156, v156
    v_fmac_f32 v131, v157, v157
    v_mfma_f32_16x16x32_bf16 v[230:233], v[210:213], a[156:159], v[230:233]
    s_barrier
    v_fmac_f32 v131, v174, v174
    v_xor_b32 v2, 65536, v2
    v_mfma_f32_16x16x32_bf16 v[230:233], v[226:229], a[160:163], v[230:233]
    s_nop 0
    v_xor_b32 v3, 65536, v3
    v_xor_b32 v4, 65536, v4
    v_mfma_f32_16x16x32_bf16 v[230:233], v[218:221], a[164:167], v[230:233]
    s_cbranch_scc1 L_loop_safe2
    s_branch L_final_safe
.p2align 6
L_loop_safe3:
    v_mfma_f32_16x16x32_bf16 v[194:197], v[170:173], a[168:171], 0
    s_add_u32 s12, s42, s27
    ds_read_b128 v[198:201], v2 offset:18432
    ds_read_b128 v[214:217], v2 offset:19456
    v_mfma_f32_16x16x32_bf16 v[194:197], v[166:169], a[172:175], v[194:197]
    s_addc_u32 s13, s43, 0
    v_fmac_f32 v131, v175, v175
    v_fmac_f32 v131, v176, v176
    v_mfma_f32_16x16x32_bf16 v[194:197], v[162:165], a[176:179], v[194:197]
    s_sub_u32 s14, s36, s27
    v_fmac_f32 v131, v177, v177
    v_fmac_f32 v131, v182, v182
    v_mfma_f32_16x16x32_bf16 v[194:197], v[210:213], a[180:183], v[194:197]
    s_cmp_ge_u32 s18, 2
    v_fmac_f32 v131, v183, v183
    v_fmac_f32 v131, v184, v184
    v_mfma_f32_16x16x32_bf16 v[194:197], v[226:229], a[184:187], v[194:197]
    s_cselect_b32 s14, s14, 0
    ds_read_b128 v[118:121], v0 offset:26624
    v_fmac_f32 v131, v185, v185
    v_mfma_f32_16x16x32_bf16 v[194:197], v[218:221], a[188:191], v[194:197]
    s_add_u32 s34, s18, 2
    ds_read_b128 v[134:137], v1 offset:26624
    v_cvt_pk_bf16_f32 v36, v131, v130
    v_mfma_f32_16x16x32_bf16 v[234:237], v[170:173], a[192:195], 0
    s_add_u32 s8, s40, s23
    ds_read_b128 v[170:173], v0 offset:26752
    v_cvt_pk_bf16_f32 v230, v230, v231
    v_mfma_f32_16x16x32_bf16 v[234:237], v[166:169], a[196:199], v[234:237]
    s_addc_u32 s9, s41, 0
    ds_read_b128 v[166:169], v1 offset:26752
    v_cvt_pk_bf16_f32 v231, v232, v233
    v_mfma_f32_16x16x32_bf16 v[222:225], v[32:35], v[36:39], 0
    s_sub_u32 s10, s36, s23
    v_cvt_pk_bf16_f32 v130, v194, v195
    v_cvt_pk_bf16_f32 v131, v196, v197
    v_mfma_f32_16x16x32_bf16 v[234:237], v[162:165], a[200:203], v[234:237]
    s_waitcnt lgkmcnt(4)
    ds_read_b128 v[194:197], v0 offset:26880
    s_cmp_lt_u32 s34, s17
    v_mfma_f32_16x16x32_bf16 v[206:209], v[32:35], v[198:201], 0
    s_cselect_b32 s10, s10, 0
    v_rsq_f32 v223, v223
    v_mfma_f32_16x16x32_bf16 v[206:209], v[32:35], v[214:217], v[206:209]
    s_add_u32 m0, s28, 0
    v_rsq_f32 v222, v222
    v_mfma_f32_16x16x32_bf16 v[234:237], v[210:213], a[204:207], v[234:237]
    s_waitcnt lgkmcnt(4)
    ds_read_b128 v[198:201], v1 offset:26880
    v_mul_f32 v222, s31, v222
    v_mfma_f32_16x16x32_bf16 v[234:237], v[226:229], a[208:211], v[234:237]
    s_mov_b32 s27, s26
    v_mul_f32 v114, v223, v114
    v_mul_f32 v115, v223, v115
    v_mfma_f32_16x16x32_bf16 v[234:237], v[218:221], a[212:215], v[234:237]
    s_mov_b32 s26, s25
    v_cvt_pk_f16_f32 v218, v114, v115
    v_mul_f32 v116, v223, v116
    v_mfma_f32_16x16x32_bf16 v[226:229], a[72:75], v[118:121], 0
    s_waitcnt lgkmcnt(2)
    v_mul_f32 v117, v223, v117
    v_cvt_pk_f16_f32 v219, v116, v117
    v_mfma_f32_16x16x32_bf16 v[226:229], a[76:79], v[134:137], v[226:229]
    s_mov_b32 s25, s24
    v_cvt_pk_bf16_f32 v114, v234, v235
    v_cvt_pk_bf16_f32 v115, v236, v237
    v_mfma_f32_16x16x32_bf16 v[226:229], a[80:83], v[170:173], v[226:229]
    s_mov_b32 s24, s23
    v_mul_f32 v122, v223, v122
    v_mul_f32 v123, v223, v123
    v_mfma_f32_16x16x32_bf16 v[226:229], a[84:87], v[166:169], v[226:229]
    s_waitcnt lgkmcnt(1)
    v_cvt_pk_f16_f32 v220, v122, v123
    v_mul_f32 v124, v223, v124
    v_mfma_f32_16x16x32_bf16 v[226:229], a[88:91], v[194:197], v[226:229]
    v_mul_f32 v125, v223, v125
    v_cvt_pk_f16_f32 v221, v124, v125
    v_mfma_f32_16x16x32_bf16 v[122:125], a[96:99], v[118:121], 0
    s_waitcnt lgkmcnt(0)
    v_mul_f32 v126, v223, v126
    v_mul_f32 v127, v223, v127
    v_mfma_f32_16x16x32_bf16 v[226:229], a[92:95], v[198:201], v[226:229]
    v_cvt_pk_f16_f32 v164, v126, v127
    v_mul_f32 v128, v223, v128
    v_mfma_f32_16x16x32_bf16 v[122:125], a[100:103], v[134:137], v[122:125]
    v_mul_f32 v129, v223, v129
    v_cvt_pk_f16_f32 v165, v128, v129
    v_mfma_f32_16x16x32_bf16 v[122:125], a[104:107], v[170:173], v[122:125]
    v_mul_f32 v154, v222, v154
    v_mul_f32 v155, v222, v155
    v_mfma_f32_16x16x32_bf16 v[122:125], a[108:111], v[166:169], v[122:125]
    v_cvt_pk_f16_f32 v210, v154, v155
    v_mul_f32 v156, v222, v156
    v_mfma_f32_16x16x32_bf16 v[122:125], a[112:115], v[194:197], v[122:125]
    v_mul_f32 v157, v222, v157
    v_cvt_pk_f16_f32 v211, v156, v157
    v_mfma_f32_16x16x32_bf16 v[122:125], a[116:119], v[198:201], v[122:125]
    v_mul_f32 v174, v222, v174
    v_mul_f32 v175, v222, v175
    v_mfma_f32_16x16x32_bf16 v[126:129], a[120:123], v[118:121], 0
    v_cvt_pk_f16_f32 v212, v174, v175
    v_mul_f32 v176, v222, v176
    v_mfma_f32_16x16x32_bf16 v[126:129], a[124:127], v[134:137], v[126:129]
    v_mul_f32 v177, v222, v177
    v_cvt_pk_f16_f32 v213, v176, v177
    v_mfma_f32_16x16x32_bf16 v[126:129], a[128:131], v[170:173], v[126:129]
    v_mul_f32 v182, v222, v182
    v_mul_f32 v183, v222, v183
    v_mfma_f32_16x16x32_bf16 v[126:129], a[132:135], v[166:169], v[126:129]
    v_cvt_pk_f16_f32 v162, v182, v183
    v_mul_f32 v184, v222, v184
    v_mfma_f32_16x16x32_bf16 v[126:129], a[136:139], v[194:197], v[126:129]
    v_mul_f32 v185, v222, v185
    v_cvt_pk_f16_f32 v163, v184, v185
    v_mfma_f32_16x16x32_bf16 v[126:129], a[140:143], v[198:201], v[126:129]
    v_fma_f32 v116, v226, v226, s32
    v_fmac_f32 v116, v227, v227
    v_mfma_f32_16x16x32_bf16 v[154:157], a[0:3], v[118:121], 0
    v_fmac_f32 v116, v228, v228
    v_fmac_f32 v116, v229, v229
    v_mfma_f32_16x16x32_bf16 v[154:157], a[4:7], v[134:137], v[154:157]
    v_fmac_f32 v116, v122, v122
    v_fmac_f32 v116, v123, v123
    v_mfma_f32_16x16x32_bf16 v[154:157], a[8:11], v[170:173], v[154:157]
    v_fmac_f32 v116, v124, v124
    v_fmac_f32 v116, v125, v125
    v_mfma_f32_16x16x32_bf16 v[154:157], a[12:15], v[166:169], v[154:157]
    v_fmac_f32 v116, v126, v126
    v_fmac_f32 v116, v127, v127
    v_mfma_f32_16x16x32_bf16 v[154:157], a[16:19], v[194:197], v[154:157]
    v_fmac_f32 v116, v128, v128
    v_fmac_f32 v116, v129, v129
    v_mfma_f32_16x16x32_bf16 v[154:157], a[20:23], v[198:201], v[154:157]
    v_mul_f32 v117, 0x3baaaaab, v206
    v_mul_f32 v254, 0x3baaaaab, v207
    v_mfma_f32_16x16x32_bf16 v[174:177], a[24:27], v[118:121], 0
    v_rsq_f32 v117, v117
    v_mfma_f32_16x16x32_bf16 v[174:177], a[28:31], v[134:137], v[174:177]
    v_rsq_f32 v254, v254
    v_mfma_f32_16x16x32_bf16 v[174:177], a[32:35], v[170:173], v[174:177]
    v_mul_f32 v255, 0x3baaaaab, v208
    v_fma_f32 v132, v154, v154, s32
    v_mfma_f32_16x16x32_bf16 v[174:177], a[36:39], v[166:169], v[174:177]
    v_fmac_f32 v132, v155, v155
    v_fmac_f32 v132, v156, v156
    v_mfma_f32_16x16x32_bf16 v[174:177], a[40:43], v[194:197], v[174:177]
    v_fmac_f32 v132, v157, v157
    v_mul_f32 v150, v117, v150
    v_mfma_f32_16x16x32_bf16 v[174:177], a[44:47], v[198:201], v[174:177]
    v_rsq_f32 v255, v255
    v_mfma_f32_16x16x32_bf16 v[182:185], a[48:51], v[118:121], 0
    v_mul_f32 v151, v117, v151
    v_cvt_pk_bf16_f32 v214, v150, v151
    v_mfma_f32_16x16x32_bf16 v[182:185], a[52:55], v[134:137], v[182:185]
    v_mul_f32 v152, v117, v152
    v_mul_f32 v153, v117, v153
    v_mfma_f32_16x16x32_bf16 v[182:185], a[56:59], v[170:173], v[182:185]
    v_fmac_f32 v132, v174, v174
    v_fmac_f32 v132, v175, v175
    v_mfma_f32_16x16x32_bf16 v[182:185], a[60:63], v[166:169], v[182:185]
    v_fmac_f32 v132, v176, v176
    v_fmac_f32 v132, v177, v177
    v_mfma_f32_16x16x32_bf16 v[182:185], a[64:67], v[194:197], v[182:185]
    v_cvt_pk_bf16_f32 v215, v152, v153
    v_mul_f32 v190, v117, v190
    v_mfma_f32_16x16x32_bf16 v[182:185], a[68:71], v[198:201], v[182:185]
    v_mul_f32 v191, v117, v191
    v_cvt_pk_bf16_f32 v216, v190, v191
    v_mfma_f32_16x16x32_bf16 v[150:153], v[118:121], a[144:147], 0
    v_mul_f32 v192, v117, v192
    v_mul_f32 v193, v117, v193
    v_mfma_f32_16x16x32_bf16 v[150:153], v[134:137], a[148:151], v[150:153]
    v_cvt_pk_bf16_f32 v217, v192, v193
    v_mul_f32 v202, v117, v202
    v_mfma_f32_16x16x32_bf16 v[150:153], v[170:173], a[152:155], v[150:153]
    buffer_store_dwordx4 v[214:217], v15, s[12:15], 0 offen nt
    v_fmac_f32 v132, v182, v182
    v_fmac_f32 v132, v183, v183
    v_fmac_f32 v132, v184, v184
    v_fmac_f32 v132, v185, v185
    v_mfma_f32_16x16x32_bf16 v[150:153], v[166:169], a[156:159], v[150:153]
    v_cvt_pk_bf16_f32 v36, v132, v116
    v_mul_f32 v203, v117, v203
    v_mfma_f32_16x16x32_bf16 v[150:153], v[194:197], a[160:163], v[150:153]
    v_cvt_pk_bf16_f32 v116, v202, v203
    v_mul_f32 v204, v117, v204
    v_mfma_f32_16x16x32_bf16 v[190:193], v[32:35], v[36:39], 0
    v_mul_f32 v205, v117, v205
    v_cvt_pk_bf16_f32 v117, v204, v205
    v_mfma_f32_16x16x32_bf16 v[150:153], v[198:201], a[164:167], v[150:153]
    v_mul_f32 v146, v255, v146
    v_mul_f32 v147, v255, v147
    v_mfma_f32_16x16x32_bf16 v[202:205], v[118:121], a[168:171], 0
    v_cvt_pk_bf16_f32 v146, v146, v147
    v_mul_f32 v148, v255, v148
    v_mfma_f32_16x16x32_bf16 v[202:205], v[134:137], a[172:175], v[202:205]
    v_rsq_f32 v191, v191
    v_mfma_f32_16x16x32_bf16 v[202:205], v[170:173], a[176:179], v[202:205]
    v_cvt_pk_bf16_f32 v232, v150, v151
    v_cvt_pk_bf16_f32 v233, v152, v153
    v_mfma_f32_16x16x32_bf16 v[202:205], v[166:169], a[180:183], v[202:205]
    v_rsq_f32 v190, v190
    v_mfma_f32_16x16x32_bf16 v[202:205], v[194:197], a[184:187], v[202:205]
    ds_read_b128 v[150:153], v0 offset:32768
    v_mul_f32 v190, s31, v190
    v_mfma_f32_16x16x32_bf16 v[202:205], v[198:201], a[188:191], v[202:205]
    ds_read_b128 v[206:209], v1 offset:32768
    v_mul_f32 v226, v191, v226
    v_mfma_f32_16x16x32_bf16 v[214:217], v[118:121], a[192:195], 0
    ds_read_b128 v[118:121], v0 offset:32896
    v_mul_f32 v227, v191, v227
    v_mfma_f32_16x16x32_bf16 v[214:217], v[134:137], a[196:199], v[214:217]
    ds_read_b128 v[134:137], v1 offset:32896
    v_cvt_pk_f16_f32 v226, v226, v227
    v_mfma_f32_16x16x32_bf16 v[214:217], v[170:173], a[200:203], v[214:217]
    ds_read_b128 v[170:173], v0 offset:33024
    v_cvt_pk_bf16_f32 v132, v202, v203
    v_mfma_f32_16x16x32_bf16 v[214:217], v[166:169], a[204:207], v[214:217]
    ds_read_b128 v[166:169], v1 offset:33024
    v_cvt_pk_bf16_f32 v133, v204, v205
    v_mfma_f32_16x16x32_bf16 v[214:217], v[194:197], a[208:211], v[214:217]
    v_mul_f32 v228, v191, v228
    v_mul_f32 v229, v191, v229
    v_mfma_f32_16x16x32_bf16 v[214:217], v[198:201], a[212:215], v[214:217]
    v_cvt_pk_f16_f32 v227, v228, v229
    v_mul_f32 v122, v191, v122
    v_mfma_f32_16x16x32_f16 v[194:197], v[218:221], v[210:213], v[46:49]
    s_waitcnt lgkmcnt(5)
    buffer_store_dwordx2 v[116:117], v18, s[12:15], 0 offen nt
    v_mul_f32 v123, v191, v123
    v_cvt_pk_f16_f32 v228, v122, v123
    v_mfma_f32_16x16x32_bf16 v[202:205], a[72:75], v[150:153], 0
    s_waitcnt lgkmcnt(3)
    v_cvt_pk_bf16_f32 v116, v214, v215
    v_cvt_pk_bf16_f32 v117, v216, v217
    v_mfma_f32_16x16x32_bf16 v[202:205], a[76:79], v[206:209], v[202:205]
    s_waitcnt lgkmcnt(2)
    v_mul_f32 v124, v191, v124
    v_mul_f32 v125, v191, v125
    v_mfma_f32_16x16x32_bf16 v[202:205], a[80:83], v[118:121], v[202:205]
    s_waitcnt lgkmcnt(1)
    v_cvt_pk_f16_f32 v229, v124, v125
    v_mul_f32 v126, v191, v126
    v_mfma_f32_16x16x32_bf16 v[202:205], a[84:87], v[134:137], v[202:205]
    s_waitcnt lgkmcnt(0)
    v_mul_f32 v127, v191, v127
    v_cvt_pk_f16_f32 v124, v126, v127
    v_mfma_f32_16x16x32_bf16 v[202:205], a[88:91], v[170:173], v[202:205]
    v_mul_f32 v128, v191, v128
    v_mul_f32 v129, v191, v129
    v_mfma_f32_16x16x32_bf16 v[202:205], a[92:95], v[166:169], v[202:205]
    v_cvt_pk_f16_f32 v125, v128, v129
    v_mul_f32 v154, v190, v154
    v_mfma_f32_16x16x32_bf16 v[126:129], a[96:99], v[150:153], 0
    v_mul_f32 v155, v190, v155
    v_cvt_pk_f16_f32 v154, v154, v155
    v_mfma_f32_16x16x32_bf16 v[126:129], a[100:103], v[206:209], v[126:129]
    v_mul_f32 v156, v190, v156
    v_mul_f32 v157, v190, v157
    v_mfma_f32_16x16x32_bf16 v[126:129], a[104:107], v[118:121], v[126:129]
    v_cvt_pk_f16_f32 v155, v156, v157
    v_mul_f32 v174, v190, v174
    v_mfma_f32_16x16x32_bf16 v[126:129], a[108:111], v[134:137], v[126:129]
    v_mul_f32 v175, v190, v175
    v_cvt_pk_f16_f32 v156, v174, v175
    v_mfma_f32_16x16x32_bf16 v[126:129], a[112:115], v[170:173], v[126:129]
    v_mul_f32 v176, v190, v176
    v_mul_f32 v177, v190, v177
    v_mfma_f32_16x16x32_bf16 v[126:129], a[116:119], v[166:169], v[126:129]
    v_cvt_pk_f16_f32 v157, v176, v177
    v_mul_f32 v182, v190, v182
    v_mfma_f32_16x16x32_bf16 v[174:177], a[120:123], v[150:153], 0
    v_mul_f32 v183, v190, v183
    v_cvt_pk_f16_f32 v122, v182, v183
    v_mfma_f32_16x16x32_bf16 v[174:177], a[124:127], v[206:209], v[174:177]
    v_mul_f32 v184, v190, v184
    v_mul_f32 v185, v190, v185
    v_mfma_f32_16x16x32_bf16 v[174:177], a[128:131], v[118:121], v[174:177]
    v_cvt_pk_f16_f32 v123, v184, v185
    v_fma_f32 v182, v202, v202, s32
    v_mfma_f32_16x16x32_bf16 v[174:177], a[132:135], v[134:137], v[174:177]
    v_fmac_f32 v182, v203, v203
    v_fmac_f32 v182, v204, v204
    v_mfma_f32_16x16x32_bf16 v[174:177], a[136:139], v[170:173], v[174:177]
    v_fmac_f32 v182, v205, v205
    v_fmac_f32 v182, v126, v126
    v_mfma_f32_16x16x32_bf16 v[174:177], a[140:143], v[166:169], v[174:177]
    v_fmac_f32 v182, v127, v127
    v_fmac_f32 v182, v128, v128
    v_mfma_f32_16x16x32_bf16 v[190:193], a[0:3], v[150:153], 0
    v_fmac_f32 v182, v129, v129
    v_mul_f32 v149, v255, v149
    v_mfma_f32_16x16x32_bf16 v[190:193], a[4:7], v[206:209], v[190:193]
    v_cvt_pk_bf16_f32 v147, v148, v149
    v_mul_f32 v138, v255, v138
    v_mfma_f32_16x16x32_bf16 v[190:193], a[8:11], v[118:121], v[190:193]
    v_fmac_f32 v182, v174, v174
    v_fmac_f32 v182, v175, v175
    v_mfma_f32_16x16x32_bf16 v[190:193], a[12:15], v[134:137], v[190:193]
    v_fmac_f32 v182, v176, v176
    v_fmac_f32 v182, v177, v177
    v_mfma_f32_16x16x32_bf16 v[190:193], a[16:19], v[170:173], v[190:193]
    v_mul_f32 v139, v255, v139
    v_cvt_pk_bf16_f32 v148, v138, v139
    v_mfma_f32_16x16x32_bf16 v[190:193], a[20:23], v[166:169], v[190:193]
    v_mul_f32 v140, v255, v140
    v_mul_f32 v141, v255, v141
    v_mfma_f32_16x16x32_bf16 v[198:201], a[24:27], v[150:153], 0
    v_cvt_pk_bf16_f32 v149, v140, v141
    v_mul_f32 v186, v255, v186
    v_mfma_f32_16x16x32_bf16 v[198:201], a[28:31], v[206:209], v[198:201]
    buffer_store_dwordx4 v[146:149], v17, s[12:15], 0 offen nt
    v_mul_f32 v187, v255, v187
    v_fma_f32 v183, v190, v190, s32
    v_fmac_f32 v183, v191, v191
    v_fmac_f32 v183, v192, v192
    v_mfma_f32_16x16x32_bf16 v[198:201], a[32:35], v[118:121], v[198:201]
    v_fmac_f32 v183, v193, v193
    v_cvt_pk_bf16_f32 v184, v186, v187
    v_mfma_f32_16x16x32_bf16 v[198:201], a[36:39], v[134:137], v[198:201]
    v_mul_f32 v188, v255, v188
    v_mul_f32 v189, v255, v189
    v_mfma_f32_16x16x32_bf16 v[198:201], a[40:43], v[170:173], v[198:201]
    v_cvt_pk_bf16_f32 v185, v188, v189
    v_mul_f32 v142, v254, v142
    v_mfma_f32_16x16x32_bf16 v[198:201], a[44:47], v[166:169], v[198:201]
    v_mul_f32 v143, v254, v143
    v_cvt_pk_bf16_f32 v142, v142, v143
    v_mfma_f32_16x16x32_bf16 v[138:141], a[48:51], v[150:153], 0
    v_mul_f32 v144, v254, v144
    v_mul_f32 v145, v254, v145
    v_mfma_f32_16x16x32_bf16 v[138:141], a[52:55], v[206:209], v[138:141]
    v_cvt_pk_bf16_f32 v143, v144, v145
    v_mul_f32 v158, v254, v158
    v_mfma_f32_16x16x32_bf16 v[138:141], a[56:59], v[118:121], v[138:141]
    v_fmac_f32 v183, v198, v198
    v_fmac_f32 v183, v199, v199
    v_mfma_f32_16x16x32_bf16 v[138:141], a[60:63], v[134:137], v[138:141]
    ds_read2_b32 v[216:217], v6 offset0:0 offset1:0
    ds_read2_b32 v[224:225], v6 offset0:16 offset1:16
    v_mfma_f32_16x16x32_bf16 v[138:141], a[64:67], v[170:173], v[138:141]
    ds_read2_b32 v[236:237], v6 offset0:32 offset1:32
    v_fmac_f32 v183, v200, v200
    v_mfma_f32_16x16x32_bf16 v[138:141], a[68:71], v[166:169], v[138:141]
    v_fmac_f32 v183, v201, v201
    v_mul_f32 v159, v254, v159
    v_mfma_f32_16x16x32_bf16 v[146:149], v[150:153], a[144:147], 0
    v_cvt_pk_bf16_f32 v144, v158, v159
    v_mul_f32 v160, v254, v160
    v_mfma_f32_16x16x32_bf16 v[146:149], v[206:209], a[148:151], v[146:149]
    v_mul_f32 v161, v254, v161
    v_cvt_pk_bf16_f32 v145, v160, v161
    v_mfma_f32_16x16x32_bf16 v[146:149], v[118:121], a[152:155], v[146:149]
    v_fmac_f32 v183, v138, v138
    v_fmac_f32 v183, v139, v139
    v_mfma_f32_16x16x32_bf16 v[146:149], v[134:137], a[156:159], v[146:149]
    v_fmac_f32 v183, v140, v140
    v_fmac_f32 v183, v141, v141
    v_mfma_f32_16x16x32_bf16 v[146:149], v[170:173], a[160:163], v[146:149]
    v_cvt_pk_bf16_f32 v36, v183, v182
    v_mul_f32 v178, v254, v178
    v_mfma_f32_16x16x32_bf16 v[146:149], v[166:169], a[164:167], v[146:149]
    s_waitcnt lgkmcnt(1)
    v_mul_f32 v179, v254, v179
    v_cvt_pk_bf16_f32 v178, v178, v179
    v_mfma_f32_16x16x32_bf16 v[158:161], v[32:35], v[36:39], 0
    s_waitcnt lgkmcnt(0)
    buffer_store_dwordx2 v[184:185], v20, s[12:15], 0 offen nt
    v_mul_f32 v180, v254, v180
    v_mul_f32 v181, v254, v181
    v_mfma_f32_16x16x32_bf16 v[186:189], v[150:153], a[168:171], 0
    v_cvt_pk_bf16_f32 v214, v146, v147
    v_cvt_pk_bf16_f32 v215, v148, v149
    v_mfma_f32_16x16x32_bf16 v[186:189], v[206:209], a[172:175], v[186:189]
    v_rsq_f32 v159, v159
    v_mfma_f32_16x16x32_bf16 v[186:189], v[118:121], a[176:179], v[186:189]
    v_rsq_f32 v158, v158
    v_mfma_f32_16x16x32_bf16 v[186:189], v[134:137], a[180:183], v[186:189]
    v_mul_f32 v158, s31, v158
    v_mul_f32 v202, v159, v202
    v_mfma_f32_16x16x32_bf16 v[186:189], v[170:173], a[184:187], v[186:189]
    v_mul_f32 v203, v159, v203
    v_cvt_pk_f16_f32 v146, v202, v203
    v_mfma_f32_16x16x32_bf16 v[186:189], v[166:169], a[188:191], v[186:189]
    v_mul_f32 v204, v159, v204
    v_mul_f32 v205, v159, v205
    v_mfma_f32_16x16x32_bf16 v[182:185], v[150:153], a[192:195], 0
    v_cvt_pk_f16_f32 v147, v204, v205
    v_mul_f32 v126, v159, v126
    v_mfma_f32_16x16x32_bf16 v[182:185], v[206:209], a[196:199], v[182:185]
    ds_read_b128 v[150:153], v5 offset:0
    ds_read_b128 v[202:205], v5 offset:16
    v_mfma_f32_16x16x32_bf16 v[182:185], v[118:121], a[200:203], v[182:185]
    ds_read_b128 v[118:121], v5 offset:48
    ds_read_b32 v254, v6 offset:192
    v_mfma_f32_16x16x32_bf16 v[182:185], v[134:137], a[204:207], v[182:185]
    v_cvt_pk_bf16_f32 v222, v186, v187
    v_cvt_pk_bf16_f32 v223, v188, v189
    v_mfma_f32_16x16x32_bf16 v[182:185], v[170:173], a[208:211], v[182:185]
    v_mul_f32 v127, v159, v127
    v_cvt_pk_f16_f32 v148, v126, v127
    v_mfma_f32_16x16x32_bf16 v[182:185], v[166:169], a[212:215], v[182:185]
    ds_read_b128 v[166:169], v2 offset:0
    ds_read_b128 v[170:173], v2 offset:1024
    v_mfma_f32_16x16x32_f16 v[186:189], v[226:229], v[210:213], v[50:53]
    ds_read_b128 v[134:137], v2 offset:2048
    v_mul_f32 v128, v159, v128
    v_mul_f32 v129, v159, v129
    v_mfma_f32_16x16x16_f16 v[194:197], v[164:165], v[162:163], v[194:197]
    v_cvt_pk_f16_f32 v149, v128, v129
    v_cvt_pk_bf16_f32 v234, v182, v183
    v_cvt_pk_bf16_f32 v235, v184, v185
    v_mul_f32 v174, v159, v174
    v_mfma_f32_16x16x32_f16 v[126:129], v[146:149], v[210:213], v[54:57]
    s_waitcnt lgkmcnt(5)
    v_mul_f32 v175, v159, v175
    v_cvt_pk_f16_f32 v184, v174, v175
    v_mul_f32 v176, v159, v176
    v_mfma_f32_16x16x16_f16 v[186:189], v[124:125], v[162:163], v[186:189]
    v_mul_f32 v177, v159, v177
    v_cvt_pk_f16_f32 v185, v176, v177
    v_mul_f32 v190, v158, v190
    v_mul_f32 v191, v158, v191
    v_mfma_f32_16x16x16_f16 v[126:129], v[184:185], v[162:163], v[126:129]
    v_cvt_pk_f16_f32 v174, v190, v191
    v_mul_f32 v192, v158, v192
    v_mul_f32 v193, v158, v193
    v_cvt_pk_f16_f32 v175, v192, v193
    v_mfma_f32_16x16x32_f16 v[206:209], v[150:153], v[210:213], v[22:25]
    s_waitcnt lgkmcnt(2)
    ds_read_b128 v[210:213], v2 offset:3072
    buffer_store_dwordx4 v[142:145], v16, s[12:15], 0 offen nt
    ds_read_b128 v[238:241], v2 offset:4096
    v_mul_f32 v198, v158, v198
    v_mul_f32 v199, v158, v199
    v_cvt_pk_f16_f32 v176, v198, v199
    v_mfma_f32_16x16x32_f16 v[206:209], v[202:205], v[218:221], v[206:209]
    s_waitcnt lgkmcnt(2)
    v_mul_f32 v200, v158, v200
    v_mul_f32 v201, v158, v201
    v_mfma_f32_16x16x32_f16 v[206:209], v[118:121], v[162:165], v[206:209]
    ds_read_b128 v[142:145], v2 offset:5120
    v_cvt_pk_f16_f32 v177, v200, v201
    v_mul_f32 v138, v158, v138
    v_mul_f32 v139, v158, v139
    v_cvt_pk_f16_f32 v182, v138, v139
    v_mfma_f32_16x16x32_f16 v[198:201], v[150:153], v[154:157], v[24:27]
    v_mul_f32 v140, v158, v140
    v_mul_f32 v141, v158, v141
    v_mfma_f32_16x16x32_f16 v[198:201], v[202:205], v[226:229], v[198:201]
    v_mov_b32_dpp v254, v207 quad_perm:[0,1,2,3] row_mask:0x1 bank_mask:0xf
    v_cvt_pk_f16_f32 v183, v140, v141
    v_mfma_f32_16x16x32_f16 v[198:201], v[118:121], v[122:125], v[198:201]
    v_max3_f32 v255, v206, v194, v195
    v_max3_f32 v255, v255, v196, v197
    v_mfma_f32_16x16x32_f16 v[242:245], v[150:153], v[174:177], v[26:29]
    s_waitcnt lgkmcnt(1)
    v_max3_f32 v255, v255, v186, v187
    v_max3_f32 v255, v255, v188, v189
    v_mfma_f32_16x16x32_f16 v[242:245], v[202:205], v[146:149], v[242:245]
    v_max3_f32 v255, v255, v126, v127
    v_mov_b32_dpp v254, v199 quad_perm:[0,1,2,3] row_mask:0x2 bank_mask:0xf
    v_mfma_f32_16x16x32_f16 v[242:245], v[118:121], v[182:185], v[242:245]
    v_max3_f32 v255, v255, v128, v129
    v_mov_b32 v162, v255
    v_mfma_f32_16x16x32_bf16 v[150:153], a[216:219], v[166:169], 0
    s_waitcnt lgkmcnt(0)
    v_permlane32_swap_b32 v255, v162
    v_mfma_f32_16x16x32_bf16 v[150:153], a[220:223], v[170:173], v[150:153]
    v_max_f32 v255, v255, v162
    v_mov_b32 v162, v255
    v_mfma_f32_16x16x32_bf16 v[150:153], a[224:227], v[134:137], v[150:153]
    v_cvt_pk_bf16_f32 v179, v180, v181
    v_xor_b32 v0, 65536, v0
    v_mfma_f32_16x16x32_bf16 v[150:153], a[228:231], v[210:213], v[150:153]
    s_waitcnt vmcnt(5)
    v_permlane16_swap_b32 v255, v162
    v_mfma_f32_16x16x32_bf16 v[150:153], a[232:235], v[238:241], v[150:153]
    v_max_f32 v255, v255, v162
    v_sub_f32 v194, v194, v255
    v_mfma_f32_16x16x32_bf16 v[150:153], a[236:239], v[142:145], v[150:153]
    v_exp_f32 v194, v194
    v_mfma_f32_16x16x32_bf16 v[190:193], a[240:243], v[166:169], 0
    v_sub_f32 v195, v195, v255
    v_sub_f32 v196, v196, v255
    v_mfma_f32_16x16x32_bf16 v[190:193], a[244:247], v[170:173], v[190:193]
    s_barrier
    buffer_load_dwordx4 v10, s[8:11], 0 offen nt lds
    v_sub_f32 v197, v197, v255
    v_mfma_f32_16x16x32_bf16 v[190:193], a[248:251], v[134:137], v[190:193]
    s_add_u32 m0, s28, 4096
    v_exp_f32 v195, v195
    v_mfma_f32_16x16x32_bf16 v[190:193], a[252:255], v[210:213], v[190:193]
    v_cvt_pk_bf16_f32 v158, v194, v195
    v_sub_f32 v186, v186, v255
    v_mfma_f32_16x16x32_bf16 v[190:193], v[82:85], v[238:241], v[190:193]
    v_exp_f32 v196, v196
    v_mfma_f32_16x16x32_bf16 v[190:193], v[86:89], v[142:145], v[190:193]
    v_exp_f32 v197, v197
    v_mfma_f32_16x16x32_bf16 v[202:205], v[90:93], v[166:169], 0
    ds_read_b128 v[166:169], v2 offset:6144
    buffer_load_dwordx4 v11, s[8:11], 0 offen nt lds
    v_mfma_f32_16x16x32_bf16 v[202:205], v[94:97], v[170:173], v[202:205]
    s_add_u32 m0, s28, 8192
    ds_read_b128 v[170:173], v2 offset:7168
    v_cvt_pk_bf16_f32 v159, v196, v197
    v_mfma_f32_16x16x32_bf16 v[202:205], v[98:101], v[134:137], v[202:205]
    ds_read_b128 v[138:141], v2 offset:8192
    v_sub_f32 v187, v187, v255
    v_mfma_f32_16x16x32_bf16 v[202:205], v[102:105], v[210:213], v[202:205]
    ds_read_b128 v[210:213], v2 offset:9216
    v_sub_f32 v188, v188, v255
    v_mfma_f32_16x16x32_bf16 v[202:205], v[106:109], v[238:241], v[202:205]
    ds_read_b128 v[134:137], v2 offset:10240
    v_sub_f32 v189, v189, v255
    v_mfma_f32_16x16x32_bf16 v[202:205], v[110:113], v[142:145], v[202:205]
    ds_read_b128 v[194:197], v2 offset:11264
    buffer_load_dwordx4 v12, s[8:11], 0 offen nt lds
    v_exp_f32 v186, v186
    v_mfma_f32_16x16x32_f16 v[118:121], v[218:221], v[154:157], v[58:61]
    s_add_u32 m0, s28, 12288
    v_exp_f32 v187, v187
    v_exp_f32 v188, v188
    v_cvt_pk_bf16_f32 v160, v186, v187
    v_exp_f32 v189, v189
    v_sub_f32 v126, v126, v255
    v_mfma_f32_16x16x16_f16 v[118:121], v[164:165], v[122:123], v[118:121]
    v_cvt_pk_bf16_f32 v161, v188, v189
    v_exp_f32 v126, v126
    v_sub_f32 v127, v127, v255
    v_mfma_f32_16x16x32_f16 v[186:189], v[226:229], v[154:157], v[62:65]
    s_xor_b32 s28, s28, 65536
    buffer_load_dwordx4 v13, s[8:11], 0 offen nt lds
    v_exp_f32 v127, v127
    v_sub_f32 v128, v128, v255
    v_cvt_pk_bf16_f32 v36, v126, v127
    v_exp_f32 v128, v128
    v_mfma_f32_16x16x16_f16 v[186:189], v[124:125], v[122:123], v[186:189]
    v_sub_f32 v129, v129, v255
    v_exp_f32 v129, v129
    v_sub_f32 v206, v206, v255
    v_cvt_pk_bf16_f32 v37, v128, v129
    v_mfma_f32_16x16x32_f16 v[126:129], v[146:149], v[154:157], v[66:69]
    s_waitcnt lgkmcnt(0)
    v_exp_f32 v206, v206
    v_mfma_f32_16x16x32_bf16 v[142:145], a[216:219], v[166:169], 0
    s_mov_b32 m0, s29
    v_cvt_pk_bf16_f32 v39, v206, 0
    v_max3_f32 v255, v198, v118, v119
    v_max3_f32 v255, v255, v120, v121
    v_mfma_f32_16x16x16_f16 v[126:129], v[184:185], v[122:123], v[126:129]
    v_max3_f32 v255, v255, v186, v187
    v_max3_f32 v255, v255, v188, v189
    v_xor_b32 v1, 65536, v1
    v_mov_b32_dpp v254, v243 quad_perm:[0,1,2,3] row_mask:0x4 bank_mask:0xf
    v_mfma_f32_16x16x32_bf16 v[154:157], v[28:31], v[36:39], 0
    s_xor_b32 s29, s29, s30
    buffer_store_dwordx2 v[178:179], v19, s[12:15], 0 offen nt
    v_mov_b32 v122, v254
    v_max3_f32 v255, v255, v126, v127
    v_mfma_f32_16x16x32_bf16 v[154:157], v[28:31], v[158:161], v[154:157]
    s_add_u32 s19, s19, s20
    v_max3_f32 v255, v255, v128, v129
    v_mov_b32 v123, v255
    v_mfma_f32_16x16x32_bf16 v[142:145], a[220:223], v[170:173], v[142:145]
    s_add_u32 s23, s23, s21
    v_permlane32_swap_b32 v255, v123
    v_mfma_f32_16x16x32_bf16 v[142:145], a[224:227], v[138:141], v[142:145]
    s_cmp_ge_u32 s19, 72
    v_rcp_f32 v154, v154
    v_mfma_f32_16x16x32_bf16 v[142:145], a[228:231], v[210:213], v[142:145]
    s_cselect_b32 s34, 72, 0
    v_max_f32 v255, v255, v123
    v_mov_b32 v123, v255
    v_mfma_f32_16x16x32_bf16 v[142:145], a[232:235], v[134:137], v[142:145]
    s_cselect_b32 s35, s22, 0
    v_permlane16_swap_b32 v255, v123
    v_mfma_f32_16x16x32_bf16 v[142:145], a[236:239], v[194:197], v[142:145]
    s_sub_u32 s19, s19, s34
    v_max_f32 v255, v255, v123
    v_sub_f32 v118, v118, v255
    v_mfma_f32_16x16x32_bf16 v[178:181], v[214:217], v[36:39], 0
    s_add_u32 s23, s23, s35
    v_exp_f32 v118, v118
    v_mfma_f32_16x16x32_bf16 v[178:181], v[230:233], v[158:161], v[178:181]
    s_add_u32 s18, s18, 1
    v_sub_f32 v119, v119, v255
    v_exp_f32 v119, v119
    v_sub_f32 v120, v120, v255
    v_cvt_pk_bf16_f32 v118, v118, v119
    v_exp_f32 v120, v120
    v_sub_f32 v121, v121, v255
    v_exp_f32 v121, v121
    v_mul_f32 v178, v154, v178
    v_mul_f32 v179, v154, v179
    v_cvt_pk_bf16_f32 v178, v178, v179
    v_mul_f32 v180, v154, v180
    v_mul_f32 v181, v154, v181
    v_cvt_pk_bf16_f32 v179, v180, v181
    v_cvt_pk_bf16_f32 v119, v120, v121
    v_mfma_f32_16x16x32_bf16 v[206:209], v[222:225], v[36:39], 0
    s_cmp_lt_u32 s18, s45
    v_sub_f32 v186, v186, v255
    v_sub_f32 v187, v187, v255
    v_mfma_f32_16x16x32_bf16 v[206:209], v[130:133], v[158:161], v[206:209]
    v_exp_f32 v186, v186
    v_exp_f32 v187, v187
    v_sub_f32 v188, v188, v255
    v_cvt_pk_bf16_f32 v120, v186, v187
    v_exp_f32 v188, v188
    v_sub_f32 v189, v189, v255
    v_exp_f32 v189, v189
    v_sub_f32 v126, v126, v255
    v_mul_f32 v206, v154, v206
    v_mul_f32 v207, v154, v207
    v_cvt_pk_bf16_f32 v180, v206, v207
    v_mul_f32 v208, v154, v208
    v_mul_f32 v209, v154, v209
    v_cvt_pk_bf16_f32 v181, v208, v209
    v_cvt_pk_bf16_f32 v121, v188, v189
    v_mfma_f32_16x16x32_bf16 v[186:189], v[234:237], v[36:39], 0
    v_sub_f32 v127, v127, v255
    v_mfma_f32_16x16x32_bf16 v[186:189], v[114:117], v[158:161], v[186:189]
    ds_write_b128 v3, v[178:181] offset:0
    v_mfma_f32_16x16x32_bf16 v[158:161], a[240:243], v[166:169], 0
    v_exp_f32 v126, v126
    v_mfma_f32_16x16x32_bf16 v[158:161], a[244:247], v[170:173], v[158:161]
    v_exp_f32 v127, v127
    v_mfma_f32_16x16x32_bf16 v[158:161], a[248:251], v[138:141], v[158:161]
    v_cvt_pk_bf16_f32 v36, v126, v127
    v_sub_f32 v128, v128, v255
    v_mfma_f32_16x16x32_bf16 v[158:161], a[252:255], v[210:213], v[158:161]
    v_mul_f32 v186, v154, v186
    v_mul_f32 v187, v154, v187
    v_mfma_f32_16x16x32_bf16 v[158:161], v[82:85], v[134:137], v[158:161]
    v_cvt_pk_bf16_f32 v126, v186, v187
    v_mul_f32 v188, v154, v188
    v_mfma_f32_16x16x32_bf16 v[158:161], v[86:89], v[194:197], v[158:161]
    v_mul_f32 v189, v154, v189
    v_cvt_pk_bf16_f32 v127, v188, v189
    v_mfma_f32_16x16x32_bf16 v[178:181], v[90:93], v[166:169], 0
    ds_read_b128 v[166:169], v2 offset:12288
    v_sub_f32 v129, v129, v255
    v_mfma_f32_16x16x32_bf16 v[178:181], v[94:97], v[170:173], v[178:181]
    ds_read_b128 v[170:173], v2 offset:13312
    v_sub_f32 v198, v198, v255
    v_mfma_f32_16x16x32_bf16 v[178:181], v[98:101], v[138:141], v[178:181]
    ds_read_b128 v[154:157], v2 offset:14336
    v_max_f32_dpp v122, v122, v122 quad_perm:[1,0,3,2] row_mask:0xf bank_mask:0xf
    v_mfma_f32_16x16x32_bf16 v[178:181], v[102:105], v[210:213], v[178:181]
    ds_read_b128 v[210:213], v2 offset:15360
    v_max_f32_dpp v122, v122, v122 quad_perm:[2,3,0,1] row_mask:0xf bank_mask:0xf
    v_mfma_f32_16x16x32_bf16 v[178:181], v[106:109], v[134:137], v[178:181]
    ds_read_b128 v[134:137], v2 offset:16384
    v_max_f32_dpp v122, v122, v122 row_half_mirror row_mask:0xf bank_mask:0xf
    v_mfma_f32_16x16x32_bf16 v[178:181], v[110:113], v[194:197], v[178:181]
    ds_read_b128 v[194:197], v2 offset:17408
    ds_write_b64 v4, v[126:127] offset:4096
    v_exp_f32 v128, v128
    v_exp_f32 v129, v129
    v_mfma_f32_16x16x32_f16 v[186:189], v[218:221], v[174:177], v[70:73]
    s_waitcnt lgkmcnt(6)
    v_cvt_pk_bf16_f32 v37, v128, v129
    v_max_f32_dpp v122, v122, v122 row_mirror row_mask:0xf bank_mask:0xf
    v_mfma_f32_16x16x32_f16 v[218:221], v[226:229], v[174:177], v[74:77]
    s_waitcnt lgkmcnt(5)
    v_exp_f32 v198, v198
    v_mfma_f32_16x16x32_f16 v[126:129], v[146:149], v[174:177], v[78:81]
    s_waitcnt lgkmcnt(4)
    v_cvt_pk_bf16_f32 v39, v198, 0
    v_mov_b32 v123, v122
    v_fma_f32 v255, v150, v150, s33
    v_mfma_f32_16x16x32_bf16 v[174:177], v[28:31], v[36:39], 0
    s_waitcnt lgkmcnt(3)
    v_permlane32_swap_b32 v122, v123
    v_mfma_f32_16x16x32_bf16 v[174:177], v[28:31], v[118:121], v[174:177]
    s_waitcnt lgkmcnt(2)
    v_max_f32 v122, v122, v123
    v_mov_b32 v123, v122
    v_mfma_f32_16x16x32_bf16 v[226:229], v[214:217], v[36:39], 0
    s_waitcnt lgkmcnt(0)
    v_permlane16_swap_b32 v122, v123
    v_mfma_f32_16x16x32_bf16 v[226:229], v[230:233], v[118:121], v[226:229]
    v_max_f32 v122, v122, v123
    v_sub_f32 v254, v254, v122
    v_mfma_f32_16x16x32_bf16 v[198:201], v[222:225], v[36:39], 0
    v_exp_f32 v254, v254
    v_mfma_f32_16x16x32_bf16 v[198:201], v[130:133], v[118:121], v[198:201]
    v_cvt_pk_bf16_f32 v254, v254, v254
    v_fmac_f32 v255, v151, v151
    v_mfma_f32_16x16x32_bf16 v[206:209], v[234:237], v[36:39], 0
    ds_write_b16 v8, v254
    v_mfma_f32_16x16x32_bf16 v[206:209], v[114:117], v[118:121], v[206:209]
    v_rcp_f32 v174, v174
    v_fmac_f32 v255, v152, v152
    v_mfma_f32_16x16x16_f16 v[186:189], v[164:165], v[182:183], v[186:189]
    v_mul_f32 v226, v174, v226
    v_mul_f32 v227, v174, v227
    v_cvt_pk_bf16_f32 v122, v226, v227
    v_mfma_f32_16x16x16_f16 v[218:221], v[124:125], v[182:183], v[218:221]
    v_mul_f32 v228, v174, v228
    v_mul_f32 v229, v174, v229
    v_cvt_pk_bf16_f32 v123, v228, v229
    v_mfma_f32_16x16x16_f16 v[126:129], v[184:185], v[182:183], v[126:129]
    v_max3_f32 v254, v242, v186, v187
    v_max3_f32 v254, v254, v188, v189
    v_mul_f32 v198, v174, v198
    v_mul_f32 v199, v174, v199
    v_mfma_f32_16x16x32_bf16 v[146:149], a[216:219], v[166:169], 0
    ds_read_b128 v[182:185], v9
    ds_read_b128 v[118:121], v9 offset:64
    v_mfma_f32_16x16x32_bf16 v[146:149], a[220:223], v[170:173], v[146:149]
    v_max3_f32 v254, v254, v218, v219
    v_max3_f32 v254, v254, v220, v221
    v_mfma_f32_16x16x32_bf16 v[146:149], a[224:227], v[154:157], v[146:149]
    v_max3_f32 v254, v254, v126, v127
    v_max3_f32 v254, v254, v128, v129
    v_mfma_f32_16x16x32_bf16 v[146:149], a[228:231], v[210:213], v[146:149]
    v_mov_b32 v125, v254
    v_cvt_pk_bf16_f32 v124, v198, v199
    v_mfma_f32_16x16x32_bf16 v[146:149], a[232:235], v[134:137], v[146:149]
    v_permlane32_swap_b32 v254, v125
    v_mfma_f32_16x16x32_bf16 v[146:149], a[236:239], v[194:197], v[146:149]
    v_max_f32 v254, v254, v125
    v_mov_b32 v125, v254
    v_mfma_f32_16x16x32_bf16 v[138:141], a[240:243], v[166:169], 0
    v_mul_f32 v200, v174, v200
    v_mul_f32 v201, v174, v201
    v_mfma_f32_16x16x32_bf16 v[138:141], a[244:247], v[170:173], v[138:141]
    v_permlane16_swap_b32 v254, v125
    v_mfma_f32_16x16x32_bf16 v[138:141], a[248:251], v[154:157], v[138:141]
    s_waitcnt lgkmcnt(0)
    v_max_f32 v254, v254, v125
    v_sub_f32 v186, v186, v254
    v_mfma_f32_16x16x32_bf16 v[138:141], a[252:255], v[210:213], v[138:141]
    v_exp_f32 v186, v186
    v_mfma_f32_16x16x32_bf16 v[138:141], v[82:85], v[134:137], v[138:141]
    v_sub_f32 v187, v187, v254
    v_sub_f32 v188, v188, v254
    v_mfma_f32_16x16x32_bf16 v[138:141], v[86:89], v[194:197], v[138:141]
    v_exp_f32 v187, v187
    v_exp_f32 v188, v188
    v_cvt_pk_bf16_f32 v238, v186, v187
    v_sub_f32 v189, v189, v254
    v_exp_f32 v189, v189
    v_sub_f32 v218, v218, v254
    v_cvt_pk_bf16_f32 v239, v188, v189
    v_exp_f32 v218, v218
    v_sub_f32 v219, v219, v254
    v_exp_f32 v219, v219
    v_sub_f32 v220, v220, v254
    v_cvt_pk_bf16_f32 v240, v218, v219
    v_mfma_f32_16x16x32_bf16 v[186:189], v[90:93], v[166:169], 0
    v_exp_f32 v220, v220
    v_mfma_f32_16x16x32_bf16 v[186:189], v[94:97], v[170:173], v[186:189]
    v_sub_f32 v221, v221, v254
    v_sub_f32 v126, v126, v254
    v_mfma_f32_16x16x32_bf16 v[186:189], v[98:101], v[154:157], v[186:189]
    v_exp_f32 v221, v221
    v_mfma_f32_16x16x32_bf16 v[186:189], v[102:105], v[210:213], v[186:189]
    v_cvt_pk_bf16_f32 v241, v220, v221
    v_sub_f32 v127, v127, v254
    v_mfma_f32_16x16x32_bf16 v[186:189], v[106:109], v[134:137], v[186:189]
    v_exp_f32 v126, v126
    v_mfma_f32_16x16x32_bf16 v[186:189], v[110:113], v[194:197], v[186:189]
    ds_read_b128 v[170:173], v0 offset:20480
    ds_read_b128 v[166:169], v1 offset:20480
    v_mfma_f32_16x16x32_bf16 v[154:157], v[182:185], v[28:31], 0
    ds_read_b128 v[162:165], v0 offset:20608
    ds_read_b128 v[210:213], v1 offset:20608
    v_mfma_f32_16x16x32_bf16 v[154:157], v[118:121], v[28:31], v[154:157]
    v_exp_f32 v127, v127
    v_mfma_f32_16x16x32_bf16 v[134:137], v[182:185], v[230:233], 0
    ds_read_b128 v[226:229], v0 offset:20736
    v_cvt_pk_bf16_f32 v36, v126, v127
    v_mfma_f32_16x16x32_bf16 v[134:137], v[118:121], v[214:217], v[134:137]
    ds_read_b128 v[218:221], v1 offset:20736
    v_sub_f32 v128, v128, v254
    v_exp_f32 v128, v128
    v_sub_f32 v129, v129, v254
    v_exp_f32 v129, v129
    v_sub_f32 v242, v242, v254
    v_cvt_pk_bf16_f32 v37, v128, v129
    v_mfma_f32_16x16x32_bf16 v[194:197], v[182:185], v[130:133], 0
    v_exp_f32 v242, v242
    v_mfma_f32_16x16x32_bf16 v[194:197], v[118:121], v[222:225], v[194:197]
    s_waitcnt lgkmcnt(4)
    v_cvt_pk_bf16_f32 v39, v242, 0
    v_cvt_pk_bf16_f32 v125, v200, v201
    v_mfma_f32_16x16x32_bf16 v[198:201], v[182:185], v[114:117], 0
    s_waitcnt lgkmcnt(2)
    ds_write_b128 v3, v[122:125] offset:6144
    v_mfma_f32_16x16x32_bf16 v[126:129], v[28:31], v[36:39], 0
    s_waitcnt lgkmcnt(2)
    v_mul_f32 v206, v174, v206
    v_mul_f32 v207, v174, v207
    v_mfma_f32_16x16x32_bf16 v[126:129], v[28:31], v[238:241], v[126:129]
    s_waitcnt lgkmcnt(1)
    v_cvt_pk_bf16_f32 v206, v206, v207
    v_mul_f32 v208, v174, v208
    v_mfma_f32_16x16x32_bf16 v[122:125], v[214:217], v[36:39], 0
    v_mul_f32 v209, v174, v209
    v_cvt_pk_bf16_f32 v207, v208, v209
    v_mfma_f32_16x16x32_bf16 v[122:125], v[230:233], v[238:241], v[122:125]
    ds_write_b64 v4, v[206:207] offset:10240
    v_mfma_f32_16x16x32_bf16 v[230:233], v[222:225], v[36:39], 0
    v_rcp_f32 v126, v126
    v_mfma_f32_16x16x32_bf16 v[230:233], v[130:133], v[238:241], v[230:233]
    v_fma_f32 v254, v146, v146, s33
    v_fmac_f32 v254, v147, v147
    v_mfma_f32_16x16x32_bf16 v[174:177], v[234:237], v[36:39], 0
    v_fmac_f32 v254, v148, v148
    v_mul_f32 v122, v126, v122
    v_mfma_f32_16x16x32_bf16 v[174:177], v[114:117], v[238:241], v[174:177]
    v_mul_f32 v123, v126, v123
    v_cvt_pk_bf16_f32 v122, v122, v123
    v_mfma_f32_16x16x32_bf16 v[198:201], v[118:121], v[234:237], v[198:201]
    v_mul_f32 v124, v126, v124
    v_mul_f32 v125, v126, v125
    v_mfma_f32_16x16x32_bf16 v[114:117], a[72:75], v[170:173], 0
    v_cvt_pk_bf16_f32 v123, v124, v125
    v_mul_f32 v230, v126, v230
    v_mfma_f32_16x16x32_bf16 v[114:117], a[76:79], v[166:169], v[114:117]
    v_mul_f32 v231, v126, v231
    v_cvt_pk_bf16_f32 v124, v230, v231
    v_mfma_f32_16x16x32_bf16 v[114:117], a[80:83], v[162:165], v[114:117]
    v_mul_f32 v232, v126, v232
    v_mul_f32 v233, v126, v233
    v_mfma_f32_16x16x32_bf16 v[114:117], a[84:87], v[210:213], v[114:117]
    v_cvt_pk_bf16_f32 v125, v232, v233
    v_mul_f32 v174, v126, v174
    v_mfma_f32_16x16x32_bf16 v[114:117], a[88:91], v[226:229], v[114:117]
    ds_write_b128 v3, v[122:125] offset:12288
    v_mfma_f32_16x16x32_bf16 v[114:117], a[92:95], v[218:221], v[114:117]
    v_mul_f32 v175, v126, v175
    v_cvt_pk_bf16_f32 v174, v174, v175
    v_mfma_f32_16x16x32_bf16 v[122:125], a[96:99], v[170:173], 0
    v_mul_f32 v176, v126, v176
    v_mul_f32 v177, v126, v177
    v_mfma_f32_16x16x32_bf16 v[122:125], a[100:103], v[166:169], v[122:125]
    v_cvt_pk_bf16_f32 v175, v176, v177
    v_fmac_f32 v254, v149, v149
    v_mfma_f32_16x16x32_bf16 v[122:125], a[104:107], v[162:165], v[122:125]
    ds_write_b64 v4, v[174:175] offset:16384
    v_mfma_f32_16x16x32_bf16 v[122:125], a[108:111], v[210:213], v[122:125]
    v_fmac_f32 v254, v138, v138
    v_fmac_f32 v254, v139, v139
    v_mfma_f32_16x16x32_bf16 v[122:125], a[112:115], v[226:229], v[122:125]
    v_fmac_f32 v254, v140, v140
    v_fmac_f32 v254, v141, v141
    v_mfma_f32_16x16x32_bf16 v[122:125], a[116:119], v[218:221], v[122:125]
    v_fmac_f32 v254, v186, v186
    v_fmac_f32 v254, v187, v187
    v_mfma_f32_16x16x32_bf16 v[126:129], a[120:123], v[170:173], 0
    v_fmac_f32 v254, v188, v188
    v_fmac_f32 v254, v189, v189
    v_mfma_f32_16x16x32_bf16 v[126:129], a[124:127], v[166:169], v[126:129]
    v_cvt_pk_bf16_f32 v135, v254, v254
    v_fmac_f32 v255, v153, v153
    v_mfma_f32_16x16x32_bf16 v[126:129], a[128:131], v[162:165], v[126:129]
    v_rcp_f32 v154, v154
    v_mfma_f32_16x16x32_bf16 v[126:129], a[132:135], v[210:213], v[126:129]
    v_mul_f32 v134, v134, v154
    v_mul_f32_dpp v134, v194, v154 quad_perm:[0,1,2,3] row_mask:0x2 bank_mask:0xf
    v_mfma_f32_16x16x32_bf16 v[126:129], a[136:139], v[226:229], v[126:129]
    v_mul_f32_dpp v134, v198, v154 quad_perm:[0,1,2,3] row_mask:0x4 bank_mask:0xf
    v_cvt_pk_bf16_f32 v134, v134, v134
    v_mfma_f32_16x16x32_bf16 v[126:129], a[140:143], v[218:221], v[126:129]
    ds_write_b16 v7, v134
    v_mfma_f32_16x16x32_bf16 v[154:157], a[0:3], v[170:173], 0
    v_fmac_f32 v255, v190, v190
    v_fmac_f32 v255, v191, v191
    v_mfma_f32_16x16x32_bf16 v[154:157], a[4:7], v[166:169], v[154:157]
    v_fmac_f32 v255, v192, v192
    v_fmac_f32 v255, v193, v193
    v_mfma_f32_16x16x32_bf16 v[154:157], a[8:11], v[162:165], v[154:157]
    v_fmac_f32 v255, v202, v202
    v_fmac_f32 v255, v203, v203
    v_mfma_f32_16x16x32_bf16 v[154:157], a[12:15], v[210:213], v[154:157]
    v_fmac_f32 v255, v204, v204
    v_fmac_f32 v255, v205, v205
    v_mfma_f32_16x16x32_bf16 v[154:157], a[16:19], v[226:229], v[154:157]
    v_fma_f32 v254, v142, v142, s33
    v_fmac_f32 v254, v143, v143
    v_mfma_f32_16x16x32_bf16 v[154:157], a[20:23], v[218:221], v[154:157]
    v_fmac_f32 v254, v144, v144
    v_fmac_f32 v254, v145, v145
    v_mfma_f32_16x16x32_bf16 v[174:177], a[24:27], v[170:173], 0
    v_fmac_f32 v254, v158, v158
    v_fmac_f32 v254, v159, v159
    v_mfma_f32_16x16x32_bf16 v[174:177], a[28:31], v[166:169], v[174:177]
    v_fmac_f32 v254, v160, v160
    v_fmac_f32 v254, v161, v161
    v_mfma_f32_16x16x32_bf16 v[174:177], a[32:35], v[162:165], v[174:177]
    v_fmac_f32 v254, v178, v178
    v_fmac_f32 v254, v179, v179
    v_mfma_f32_16x16x32_bf16 v[174:177], a[36:39], v[210:213], v[174:177]
    v_fmac_f32 v254, v180, v180
    v_fmac_f32 v254, v181, v181
    v_mfma_f32_16x16x32_bf16 v[174:177], a[40:43], v[226:229], v[174:177]
    v_cvt_pk_bf16_f32 v134, v255, v254
    v_add_u32 v5, 336, v5
    v_mfma_f32_16x16x32_bf16 v[174:177], a[44:47], v[218:221], v[174:177]
    ds_write_b64 v4, v[134:135] offset:18432
    v_mfma_f32_16x16x32_bf16 v[182:185], a[48:51], v[170:173], 0
    v_add_u32 v6, 272, v6
    v_add_u32 v7, 16, v7
    v_mfma_f32_16x16x32_bf16 v[182:185], a[52:55], v[166:169], v[182:185]
    v_fma_f32 v130, v114, v114, s32
    v_fmac_f32 v130, v115, v115
    v_mfma_f32_16x16x32_bf16 v[182:185], a[56:59], v[162:165], v[182:185]
    v_fmac_f32 v130, v116, v116
    v_fmac_f32 v130, v117, v117
    v_mfma_f32_16x16x32_bf16 v[182:185], a[60:63], v[210:213], v[182:185]
    v_fmac_f32 v130, v122, v122
    v_fmac_f32 v130, v123, v123
    v_mfma_f32_16x16x32_bf16 v[182:185], a[64:67], v[226:229], v[182:185]
    v_fmac_f32 v130, v124, v124
    v_fmac_f32 v130, v125, v125
    v_mfma_f32_16x16x32_bf16 v[182:185], a[68:71], v[218:221], v[182:185]
    v_fmac_f32 v130, v126, v126
    v_fmac_f32 v130, v127, v127
    v_mfma_f32_16x16x32_bf16 v[230:233], v[170:173], a[144:147], 0
    s_waitcnt lgkmcnt(0)
    v_fmac_f32 v130, v128, v128
    v_fmac_f32 v130, v129, v129
    v_mfma_f32_16x16x32_bf16 v[230:233], v[166:169], a[148:151], v[230:233]
    v_fma_f32 v131, v154, v154, s32
    v_fmac_f32 v131, v155, v155
    v_mfma_f32_16x16x32_bf16 v[230:233], v[162:165], a[152:155], v[230:233]
    v_fmac_f32 v131, v156, v156
    v_fmac_f32 v131, v157, v157
    v_mfma_f32_16x16x32_bf16 v[230:233], v[210:213], a[156:159], v[230:233]
    s_nop 0
    v_fmac_f32 v131, v174, v174
    v_xor_b32 v2, 65536, v2
    v_mfma_f32_16x16x32_bf16 v[230:233], v[226:229], a[160:163], v[230:233]
    s_barrier
    v_xor_b32 v3, 65536, v3
    v_xor_b32 v4, 65536, v4
    v_mfma_f32_16x16x32_bf16 v[230:233], v[218:221], a[164:167], v[230:233]
    s_cbranch_scc1 L_loop_safe3
L_final_safe:
    v_mfma_f32_16x16x32_bf16 v[118:121], v[170:173], a[168:171], 0
    s_mov_b32 s12, s42
    ds_read_b128 v[134:137], v2 offset:18432
    ds_read_b128 v[194:197], v2 offset:19456
    v_mfma_f32_16x16x32_bf16 v[118:121], v[166:169], a[172:175], v[118:121]
    s_mov_b32 s13, s43
    ds_read_b128 v[198:201], v0 offset:26624
    ds_read_b128 v[206:209], v1 offset:26624
    v_mfma_f32_16x16x32_bf16 v[118:121], v[162:165], a[176:179], v[118:121]
    s_mov_b32 s14, s36
    v_bfe_u32 v254, v2, 4, 6
    v_lshrrev_b32 v255, 4, v254
    v_mfma_f32_16x16x32_bf16 v[118:121], v[210:213], a[180:183], v[118:121]
    s_add_u32 s48, s42, s27
    ds_read_b128 v[214:217], v0 offset:26752
    ds_read_b128 v[222:225], v1 offset:26752
    v_mfma_f32_16x16x32_bf16 v[118:121], v[226:229], a[184:187], v[118:121]
    s_addc_u32 s49, s43, 0
    v_and_b32 v132, 15, v254
    v_lshlrev_b32 v133, 9, v255
    v_mfma_f32_16x16x32_bf16 v[118:121], v[218:221], a[188:191], v[118:121]
    s_sub_u32 s50, s36, s27
    ds_read_b128 v[234:237], v0 offset:26880
    s_mov_b32 s51, 0x00020000
    s_add_u32 s52, s42, s26
    s_addc_u32 s53, s43, 0
    s_sub_u32 s54, s36, s26
    s_mov_b32 s55, 0x00020000
    s_add_u32 s56, s42, s25
    s_addc_u32 s57, s43, 0
    s_sub_u32 s58, s36, s25
    s_mov_b32 s59, 0x00020000
    v_lshl_add_u32 v133, v132, 4, v133
    v_add_u32 v133, 136704, v133
    v_and_b32 v238, 0xffff, v2
    v_add_u32 v238, 148992, v238
    v_and_b32 v239, 0xffff, v4
    v_add_u32 v239, 148992, v239
    v_fmac_f32 v131, v175, v175
    v_fmac_f32 v131, v176, v176
    v_fmac_f32 v131, v177, v177
    v_fmac_f32 v131, v182, v182
    v_fmac_f32 v131, v183, v183
    v_fmac_f32 v131, v184, v184
    v_fmac_f32 v131, v185, v185
    v_cvt_pk_bf16_f32 v36, v131, v130
    v_cvt_pk_bf16_f32 v230, v230, v231
    v_cvt_pk_bf16_f32 v231, v232, v233
    v_mfma_f32_16x16x32_bf16 v[242:245], v[32:35], v[36:39], 0
    v_cvt_pk_bf16_f32 v118, v118, v119
    v_cvt_pk_bf16_f32 v119, v120, v121
    v_mfma_f32_16x16x32_bf16 v[246:249], v[170:173], a[192:195], 0
    s_waitcnt lgkmcnt(0)
    ds_read_b128 v[170:173], v1 offset:26880
    v_mov_b32 v240, 0x40000000
    v_mfma_f32_16x16x32_bf16 v[246:249], v[166:169], a[196:199], v[246:249]
    s_lshl_b32 s3, s16, 6
    v_rsq_f32 v243, v243
    v_mfma_f32_16x16x32_bf16 v[246:249], v[162:165], a[200:203], v[246:249]
    s_lshl_b32 s4, s16, 5
    ds_read_b128 v[162:165], v2 offset:0
    v_mul_f32 v114, v243, v114
    v_mfma_f32_16x16x32_bf16 v[246:249], v[210:213], a[204:207], v[246:249]
    s_add_u32 s4, s4, 256
    ds_read_b128 v[166:169], v2 offset:1024
    v_mul_f32 v115, v243, v115
    v_mfma_f32_16x16x32_bf16 v[246:249], v[226:229], a[208:211], v[246:249]
    s_mul_i32 s5, s16, 8064
    ds_read_b128 v[210:213], v2 offset:2048
    v_cvt_pk_f16_f32 v114, v114, v115
    v_mfma_f32_16x16x32_bf16 v[226:229], v[32:35], v[134:137], 0
    s_add_u32 s5, s5, 104448
    ds_read_b128 v[134:137], v2 offset:3072
    v_mul_f32 v116, v243, v116
    v_mfma_f32_16x16x32_bf16 v[226:229], v[32:35], v[194:197], v[226:229]
    ds_read_b128 v[194:197], v2 offset:4096
    v_mul_f32 v117, v243, v117
    v_mfma_f32_16x16x32_bf16 v[246:249], v[218:221], a[212:215], v[246:249]
    ds_read_b128 v[218:221], v2 offset:5120
    v_rsq_f32 v242, v242
    v_cvt_pk_f16_f32 v115, v116, v117
    v_mul_f32 v242, s31, v242
    v_mul_f32 v122, v243, v122
    v_mul_f32 v241, 0x3baaaaab, v227
    v_rsq_f32 v241, v241
    v_mul_f32 v116, 0x3baaaaab, v228
    v_mul_f32 v142, v241, v142
    v_mul_f32 v143, v241, v143
    v_cvt_pk_bf16_f32 v142, v142, v143
    v_mul_f32 v144, v241, v144
    v_mul_f32 v145, v241, v145
    v_cvt_pk_bf16_f32 v143, v144, v145
    v_mfma_f32_16x16x32_bf16 v[250:253], a[72:75], v[198:201], 0
    s_waitcnt lgkmcnt(3)
    v_mul_f32 v158, v241, v158
    v_mul_f32 v159, v241, v159
    v_mfma_f32_16x16x32_bf16 v[250:253], a[76:79], v[206:209], v[250:253]
    s_waitcnt lgkmcnt(2)
    v_cvt_pk_bf16_f32 v144, v158, v159
    v_mul_f32 v160, v241, v160
    v_mfma_f32_16x16x32_bf16 v[250:253], a[80:83], v[214:217], v[250:253]
    s_waitcnt lgkmcnt(1)
    v_mul_f32 v161, v241, v161
    v_cvt_pk_bf16_f32 v145, v160, v161
    v_mfma_f32_16x16x32_bf16 v[250:253], a[84:87], v[222:225], v[250:253]
    s_waitcnt lgkmcnt(0)
    buffer_store_dwordx4 v[142:145], v16, s[48:51], 0 offen nt
    v_mul_f32 v178, v241, v178
    v_mul_f32 v179, v241, v179
    v_cvt_pk_bf16_f32 v120, v178, v179
    v_mul_f32 v180, v241, v180
    v_mfma_f32_16x16x32_bf16 v[142:145], a[216:219], v[162:165], 0
    v_mul_f32 v181, v241, v181
    v_cvt_pk_bf16_f32 v121, v180, v181
    v_mfma_f32_16x16x32_bf16 v[142:145], a[220:223], v[166:169], v[142:145]
    v_rsq_f32 v116, v116
    v_mfma_f32_16x16x32_bf16 v[142:145], a[224:227], v[210:213], v[142:145]
    v_mul_f32 v146, v116, v146
    v_mul_f32 v147, v116, v147
    v_mfma_f32_16x16x32_bf16 v[142:145], a[228:231], v[134:137], v[142:145]
    v_cvt_pk_bf16_f32 v146, v146, v147
    v_mul_f32 v148, v116, v148
    v_mfma_f32_16x16x32_bf16 v[142:145], a[232:235], v[194:197], v[142:145]
    v_mul_f32 v149, v116, v149
    v_cvt_pk_bf16_f32 v147, v148, v149
    v_mfma_f32_16x16x32_bf16 v[142:145], a[236:239], v[218:221], v[142:145]
    v_mul_f32 v138, v116, v138
    v_mul_f32 v139, v116, v139
    v_mfma_f32_16x16x32_bf16 v[158:161], a[240:243], v[162:165], 0
    v_cvt_pk_bf16_f32 v148, v138, v139
    v_mul_f32 v140, v116, v140
    v_mfma_f32_16x16x32_bf16 v[158:161], a[244:247], v[166:169], v[158:161]
    v_mul_f32 v141, v116, v141
    v_cvt_pk_bf16_f32 v149, v140, v141
    v_mfma_f32_16x16x32_bf16 v[158:161], a[248:251], v[210:213], v[158:161]
    v_mul_f32 v186, v116, v186
    v_mul_f32 v187, v116, v187
    v_mfma_f32_16x16x32_bf16 v[158:161], a[252:255], v[134:137], v[158:161]
    v_cvt_pk_bf16_f32 v130, v186, v187
    v_mul_f32 v188, v116, v188
    v_mfma_f32_16x16x32_bf16 v[158:161], v[82:85], v[194:197], v[158:161]
    v_mul_f32 v189, v116, v189
    v_cvt_pk_bf16_f32 v131, v188, v189
    v_mfma_f32_16x16x32_bf16 v[158:161], v[86:89], v[218:221], v[158:161]
    v_mul_f32 v241, 0x3baaaaab, v226
    v_fma_f32 v232, v142, v142, s33
    v_mfma_f32_16x16x32_bf16 v[138:141], v[90:93], v[162:165], 0
    ds_read_b128 v[162:165], v2 offset:6144
    v_fmac_f32 v232, v143, v143
    v_mfma_f32_16x16x32_bf16 v[138:141], v[94:97], v[166:169], v[138:141]
    ds_read_b128 v[166:169], v2 offset:7168
    v_fmac_f32 v232, v144, v144
    v_mfma_f32_16x16x32_bf16 v[138:141], v[98:101], v[210:213], v[138:141]
    ds_read_b128 v[178:181], v2 offset:8192
    buffer_store_dwordx2 v[120:121], v19, s[48:51], 0 offen nt
    v_rsq_f32 v241, v241
    v_mfma_f32_16x16x32_bf16 v[138:141], v[102:105], v[134:137], v[138:141]
    ds_read_b128 v[134:137], v2 offset:9216
    v_mul_f32 v150, v241, v150
    v_mfma_f32_16x16x32_bf16 v[138:141], v[106:109], v[194:197], v[138:141]
    ds_read_b128 v[186:189], v2 offset:10240
    v_mul_f32 v151, v241, v151
    v_mfma_f32_16x16x32_bf16 v[138:141], v[110:113], v[218:221], v[138:141]
    ds_read_b128 v[194:197], v2 offset:11264
    v_cvt_pk_bf16_f32 v150, v150, v151
    v_mfma_f32_16x16x32_bf16 v[250:253], a[88:91], v[234:237], v[250:253]
    v_mul_f32 v152, v241, v152
    v_mul_f32 v153, v241, v153
    v_mfma_f32_16x16x32_bf16 v[250:253], a[92:95], v[170:173], v[250:253]
    s_waitcnt lgkmcnt(5)
    v_cvt_pk_bf16_f32 v151, v152, v153
    v_mul_f32 v190, v241, v190
    v_mfma_f32_16x16x32_bf16 v[210:213], a[216:219], v[162:165], 0
    s_waitcnt lgkmcnt(4)
    v_mul_f32 v191, v241, v191
    v_cvt_pk_bf16_f32 v152, v190, v191
    v_mfma_f32_16x16x32_bf16 v[210:213], a[220:223], v[166:169], v[210:213]
    s_waitcnt lgkmcnt(3)
    v_mul_f32 v192, v241, v192
    v_mul_f32 v193, v241, v193
    v_mfma_f32_16x16x32_bf16 v[210:213], a[224:227], v[178:181], v[210:213]
    v_cvt_pk_bf16_f32 v153, v192, v193
    v_mul_f32 v202, v241, v202
    v_mfma_f32_16x16x32_bf16 v[190:193], a[240:243], v[162:165], 0
    s_waitcnt lgkmcnt(2)
    v_mul_f32 v203, v241, v203
    v_cvt_pk_bf16_f32 v120, v202, v203
    v_mfma_f32_16x16x32_bf16 v[210:213], a[228:231], v[134:137], v[210:213]
    s_waitcnt lgkmcnt(1)
    v_mul_f32 v204, v241, v204
    v_mul_f32 v205, v241, v205
    v_mfma_f32_16x16x32_bf16 v[210:213], a[232:235], v[186:189], v[210:213]
    s_waitcnt lgkmcnt(0)
    v_cvt_pk_bf16_f32 v121, v204, v205
    v_fmac_f32 v232, v145, v145
    v_mfma_f32_16x16x32_bf16 v[210:213], a[236:239], v[194:197], v[210:213]
    v_fmac_f32 v232, v158, v158
    v_fmac_f32 v232, v159, v159
    v_mfma_f32_16x16x32_bf16 v[190:193], a[244:247], v[166:169], v[190:193]
    v_fmac_f32 v232, v160, v160
    v_fmac_f32 v232, v161, v161
    v_mfma_f32_16x16x32_bf16 v[190:193], a[248:251], v[178:181], v[190:193]
    v_fmac_f32 v232, v138, v138
    v_fmac_f32 v232, v139, v139
    v_mfma_f32_16x16x32_bf16 v[190:193], a[252:255], v[134:137], v[190:193]
    v_fma_f32 v241, v210, v210, s33
    v_fmac_f32 v241, v211, v211
    v_mfma_f32_16x16x32_bf16 v[190:193], v[82:85], v[186:189], v[190:193]
    buffer_store_dwordx4 v[146:149], v17, s[48:51], 0 offen nt
    v_fmac_f32 v241, v212, v212
    v_fmac_f32 v241, v213, v213
    v_fmac_f32 v232, v140, v140
    v_fmac_f32 v232, v141, v141
    v_mfma_f32_16x16x32_bf16 v[190:193], v[86:89], v[194:197], v[190:193]
    v_cvt_pk_bf16_f32 v146, v246, v247
    v_cvt_pk_bf16_f32 v147, v248, v249
    v_mfma_f32_16x16x32_bf16 v[202:205], v[90:93], v[162:165], 0
    ds_read_b128 v[162:165], v2 offset:12288
    v_mul_f32 v123, v243, v123
    v_mfma_f32_16x16x32_bf16 v[202:205], v[94:97], v[166:169], v[202:205]
    ds_read_b128 v[166:169], v2 offset:13312
    v_cvt_pk_f16_f32 v116, v122, v123
    v_mfma_f32_16x16x32_bf16 v[202:205], v[98:101], v[178:181], v[202:205]
    ds_read_b128 v[178:181], v2 offset:14336
    v_fmac_f32 v241, v190, v190
    v_mfma_f32_16x16x32_bf16 v[202:205], v[102:105], v[134:137], v[202:205]
    ds_read_b128 v[134:137], v2 offset:15360
    v_fmac_f32 v241, v191, v191
    v_mfma_f32_16x16x32_bf16 v[202:205], v[106:109], v[186:189], v[202:205]
    ds_read_b128 v[186:189], v2 offset:16384
    v_fmac_f32 v241, v192, v192
    v_mfma_f32_16x16x32_bf16 v[202:205], v[110:113], v[194:197], v[202:205]
    ds_read_b128 v[194:197], v2 offset:17408
    v_fmac_f32 v241, v193, v193
    v_mfma_f32_16x16x32_bf16 v[218:221], a[96:99], v[198:201], 0
    v_mul_f32 v124, v243, v124
    v_mul_f32 v125, v243, v125
    v_mfma_f32_16x16x32_bf16 v[218:221], a[100:103], v[206:209], v[218:221]
    v_cvt_pk_f16_f32 v117, v124, v125
    v_mul_f32 v126, v243, v126
    v_mfma_f32_16x16x32_bf16 v[218:221], a[104:107], v[214:217], v[218:221]
    s_waitcnt lgkmcnt(5)
    v_fmac_f32 v241, v202, v202
    v_fmac_f32 v241, v203, v203
    v_mfma_f32_16x16x32_bf16 v[218:221], a[108:111], v[222:225], v[218:221]
    s_waitcnt lgkmcnt(4)
    v_fmac_f32 v241, v204, v204
    v_fmac_f32 v241, v205, v205
    v_mfma_f32_16x16x32_bf16 v[218:221], a[112:115], v[234:237], v[218:221]
    s_waitcnt lgkmcnt(3)
    v_cvt_pk_bf16_f32 v148, v232, v241
    v_cvt_pk_bf16_f32 v149, v241, v241
    v_mfma_f32_16x16x32_bf16 v[218:221], a[116:119], v[170:173], v[218:221]
    s_waitcnt lgkmcnt(2)
    ds_write_b64 v239, v[148:149] offset:0
    v_mfma_f32_16x16x32_bf16 v[122:125], a[216:219], v[162:165], 0
    s_waitcnt lgkmcnt(1)
    v_mul_f32 v127, v243, v127
    v_cvt_pk_f16_f32 v228, v126, v127
    v_mfma_f32_16x16x32_bf16 v[122:125], a[220:223], v[166:169], v[122:125]
    buffer_store_dwordx2 v[130:131], v20, s[48:51], 0 offen nt
    v_mul_f32 v128, v243, v128
    v_mul_f32 v129, v243, v129
    v_mfma_f32_16x16x32_bf16 v[122:125], a[224:227], v[178:181], v[122:125]
    v_cvt_pk_f16_f32 v229, v128, v129
    v_mul_f32 v154, v242, v154
    v_mfma_f32_16x16x32_bf16 v[122:125], a[228:231], v[134:137], v[122:125]
    v_mul_f32 v155, v242, v155
    v_cvt_pk_f16_f32 v126, v154, v155
    v_mfma_f32_16x16x32_bf16 v[122:125], a[232:235], v[186:189], v[122:125]
    v_mul_f32 v156, v242, v156
    v_mul_f32 v157, v242, v157
    v_mfma_f32_16x16x32_bf16 v[122:125], a[236:239], v[194:197], v[122:125]
    v_cvt_pk_f16_f32 v127, v156, v157
    v_mul_f32 v174, v242, v174
    v_mfma_f32_16x16x32_bf16 v[154:157], a[240:243], v[162:165], 0
    s_waitcnt lgkmcnt(0)
    v_mul_f32 v175, v242, v175
    v_cvt_pk_f16_f32 v128, v174, v175
    v_mfma_f32_16x16x32_bf16 v[154:157], a[244:247], v[166:169], v[154:157]
    s_barrier
    ds_read_b128 v[246:249], v238 offset:0
    v_mul_f32 v176, v242, v176
    v_mfma_f32_16x16x32_bf16 v[154:157], a[248:251], v[178:181], v[154:157]
    v_mul_f32 v177, v242, v177
    v_cvt_pk_f16_f32 v129, v176, v177
    v_mfma_f32_16x16x32_bf16 v[154:157], a[252:255], v[134:137], v[154:157]
    v_mul_f32 v182, v242, v182
    v_mul_f32 v183, v242, v183
    v_mfma_f32_16x16x32_bf16 v[154:157], v[82:85], v[186:189], v[154:157]
    v_cvt_pk_f16_f32 v226, v182, v183
    v_mul_f32 v184, v242, v184
    v_mfma_f32_16x16x32_bf16 v[154:157], v[86:89], v[194:197], v[154:157]
    v_mul_f32 v185, v242, v185
    v_cvt_pk_f16_f32 v227, v184, v185
    v_mfma_f32_16x16x32_bf16 v[174:177], v[90:93], v[162:165], 0
    ds_read_b128 v[162:165], v238 offset:1024
    v_add_u32 v241, 0, v132
    v_mfma_f32_16x16x32_bf16 v[174:177], v[94:97], v[166:169], v[174:177]
    ds_read_b128 v[166:169], v133 offset:0
    v_mul_u32_u24 v130, s20, v241
    v_mfma_f32_16x16x32_bf16 v[174:177], v[98:101], v[178:181], v[174:177]
    v_add_u32 v130, s38, v130
    v_mul_u32_u24 v130, 911, v130
    v_mfma_f32_16x16x32_bf16 v[174:177], v[102:105], v[134:137], v[174:177]
    s_waitcnt lgkmcnt(2)
    ds_read_b128 v[134:137], v133 offset:2048
    v_lshrrev_b32 v130, 16, v130
    v_mfma_f32_16x16x32_bf16 v[174:177], v[106:109], v[186:189], v[174:177]
    ds_read_b128 v[178:181], v133 offset:4096
    v_mul_u32_u24 v130, s22, v130
    v_mfma_f32_16x16x32_bf16 v[174:177], v[110:113], v[194:197], v[174:177]
    ds_read_b128 v[182:185], v133 offset:6144
    buffer_store_dwordx4 v[150:153], v15, s[48:51], 0 offen nt
    ds_read_b128 v[186:189], v133 offset:8192
    v_mad_u32_u24 v130, v241, s21, v130
    v_cmp_gt_u32 vcc, s17, v241
    v_add_u32 v241, s7, v130
    v_mfma_f32_16x16x32_bf16 v[150:153], v[32:35], v[246:249], 0
    ds_read_b128 v[194:197], v133 offset:10240
    s_waitcnt lgkmcnt(6)
    v_mfma_f32_16x16x32_bf16 v[150:153], v[32:35], v[162:165], v[150:153]
    v_cndmask_b32 v241, v240, v241, vcc
    v_lshl_add_u32 v130, v255, 4, v241
    v_mfma_f32_16x16x32_bf16 v[162:165], a[120:123], v[198:201], 0
    s_waitcnt lgkmcnt(5)
    v_add_u32 v130, s3, v130
    v_lshl_add_u32 v241, v255, 3, v241
    v_mfma_f32_16x16x32_bf16 v[162:165], a[124:127], v[206:209], v[162:165]
    v_add_u32 v241, s4, v241
    v_mul_f32 v131, 0x3baaaaab, v151
    v_mfma_f32_16x16x32_bf16 v[162:165], a[128:131], v[214:217], v[162:165]
    s_waitcnt lgkmcnt(4)
    v_rsq_f32 v131, v131
    v_mfma_f32_16x16x32_bf16 v[162:165], a[132:135], v[222:225], v[162:165]
    s_waitcnt lgkmcnt(3)
    v_mul_f32 v210, v131, v210
    v_mul_f32 v211, v131, v211
    v_mfma_f32_16x16x32_bf16 v[162:165], a[136:139], v[234:237], v[162:165]
    s_waitcnt lgkmcnt(1)
    v_cvt_pk_bf16_f32 v210, v210, v211
    v_mul_f32 v212, v131, v212
    v_mfma_f32_16x16x32_bf16 v[162:165], a[140:143], v[170:173], v[162:165]
    v_mul_f32 v213, v131, v213
    v_cvt_pk_bf16_f32 v211, v212, v213
    v_mul_f32 v190, v131, v190
    v_mul_f32 v191, v131, v191
    v_cvt_pk_bf16_f32 v212, v190, v191
    v_mfma_f32_16x16x32_bf16 v[242:245], a[216:219], v[166:169], 0
    s_waitcnt lgkmcnt(0)
    v_mul_f32 v192, v131, v192
    v_mul_f32 v193, v131, v193
    v_mfma_f32_16x16x32_bf16 v[242:245], a[220:223], v[134:137], v[242:245]
    v_cvt_pk_bf16_f32 v213, v192, v193
    v_mul_f32 v202, v131, v202
    v_mfma_f32_16x16x32_bf16 v[242:245], a[224:227], v[178:181], v[242:245]
    v_mul_f32 v203, v131, v203
    v_cvt_pk_bf16_f32 v148, v202, v203
    v_mfma_f32_16x16x32_bf16 v[242:245], a[228:231], v[182:185], v[242:245]
    v_mul_f32 v204, v131, v204
    v_mul_f32 v205, v131, v205
    v_mfma_f32_16x16x32_bf16 v[242:245], a[232:235], v[186:189], v[242:245]
    v_cvt_pk_bf16_f32 v149, v204, v205
    v_mul_f32 v131, 0x3baaaaab, v150
    v_mfma_f32_16x16x32_bf16 v[242:245], a[236:239], v[194:197], v[242:245]
    v_rsq_f32 v131, v131
    v_mfma_f32_16x16x32_bf16 v[150:153], a[240:243], v[166:169], 0
    buffer_store_dwordx4 v[210:213], v16, s[52:55], 0 offen nt
    v_mul_f32 v142, v131, v142
    v_mul_f32 v143, v131, v143
    v_cvt_pk_bf16_f32 v142, v142, v143
    v_mul_f32 v144, v131, v144
    v_mfma_f32_16x16x32_bf16 v[150:153], a[244:247], v[134:137], v[150:153]
    v_mul_f32 v145, v131, v145
    v_cvt_pk_bf16_f32 v143, v144, v145
    v_mfma_f32_16x16x32_bf16 v[150:153], a[248:251], v[178:181], v[150:153]
    v_mul_f32 v158, v131, v158
    v_mul_f32 v159, v131, v159
    v_mfma_f32_16x16x32_bf16 v[150:153], a[252:255], v[182:185], v[150:153]
    v_cvt_pk_bf16_f32 v144, v158, v159
    v_mul_f32 v160, v131, v160
    v_mfma_f32_16x16x32_bf16 v[150:153], v[82:85], v[186:189], v[150:153]
    v_mul_f32 v161, v131, v161
    v_cvt_pk_bf16_f32 v145, v160, v161
    v_mfma_f32_16x16x32_bf16 v[150:153], v[86:89], v[194:197], v[150:153]
    v_mul_f32 v138, v131, v138
    v_mul_f32 v139, v131, v139
    v_mfma_f32_16x16x32_bf16 v[158:161], v[90:93], v[166:169], 0
    v_cvt_pk_bf16_f32 v138, v138, v139
    v_mul_f32 v140, v131, v140
    v_mfma_f32_16x16x32_bf16 v[158:161], v[94:97], v[134:137], v[158:161]
    v_mul_f32 v141, v131, v141
    v_cvt_pk_bf16_f32 v139, v140, v141
    v_mfma_f32_16x16x32_bf16 v[158:161], v[98:101], v[178:181], v[158:161]
    v_fma_f32 v131, v242, v242, s33
    v_fmac_f32 v131, v243, v243
    v_mfma_f32_16x16x32_bf16 v[158:161], v[102:105], v[182:185], v[158:161]
    v_fmac_f32 v131, v244, v244
    v_fmac_f32 v131, v245, v245
    v_mfma_f32_16x16x32_bf16 v[158:161], v[106:109], v[186:189], v[158:161]
    v_fmac_f32 v131, v150, v150
    v_fmac_f32 v131, v151, v151
    v_mfma_f32_16x16x32_bf16 v[158:161], v[110:113], v[194:197], v[158:161]
    v_fmac_f32 v131, v152, v152
    v_fmac_f32 v131, v153, v153
    v_mfma_f32_16x16x32_bf16 v[134:137], a[0:3], v[198:201], 0
    v_fma_f32 v140, v122, v122, s33
    v_fmac_f32 v140, v123, v123
    v_mfma_f32_16x16x32_bf16 v[134:137], a[4:7], v[206:209], v[134:137]
    v_fmac_f32 v140, v124, v124
    v_fmac_f32 v140, v125, v125
    v_mfma_f32_16x16x32_bf16 v[134:137], a[8:11], v[214:217], v[134:137]
    v_fmac_f32 v131, v158, v158
    v_fmac_f32 v131, v159, v159
    v_mfma_f32_16x16x32_bf16 v[134:137], a[12:15], v[222:225], v[134:137]
    v_fmac_f32 v131, v160, v160
    v_fmac_f32 v131, v161, v161
    v_mfma_f32_16x16x32_bf16 v[134:137], a[16:19], v[234:237], v[134:137]
    buffer_store_dwordx2 v[148:149], v19, s[52:55], 0 offen nt
    v_cvt_pk_bf16_f32 v141, v131, v131
    v_fmac_f32 v140, v154, v154
    v_mfma_f32_16x16x32_bf16 v[134:137], a[20:23], v[170:173], v[134:137]
    v_fmac_f32 v140, v155, v155
    v_fmac_f32 v140, v156, v156
    v_mfma_f32_16x16x32_bf16 v[166:169], a[24:27], v[198:201], 0
    v_fmac_f32 v140, v157, v157
    v_fmac_f32 v140, v174, v174
    v_mfma_f32_16x16x32_bf16 v[166:169], a[28:31], v[206:209], v[166:169]
    v_fmac_f32 v140, v175, v175
    v_fmac_f32 v140, v176, v176
    v_mfma_f32_16x16x32_bf16 v[166:169], a[32:35], v[214:217], v[166:169]
    v_fmac_f32 v140, v177, v177
    v_cvt_pk_bf16_f32 v140, v140, v131
    v_mfma_f32_16x16x32_bf16 v[166:169], a[36:39], v[222:225], v[166:169]
    ds_write_b64 v239, v[140:141] offset:2048
    v_mfma_f32_16x16x32_bf16 v[166:169], a[40:43], v[234:237], v[166:169]
    v_fma_f32 v131, v134, v134, s32
    v_fmac_f32 v131, v135, v135
    v_mfma_f32_16x16x32_bf16 v[166:169], a[44:47], v[170:173], v[166:169]
    v_fmac_f32 v131, v136, v136
    v_fmac_f32 v131, v137, v137
    v_mfma_f32_16x16x32_bf16 v[178:181], a[48:51], v[198:201], 0
    v_fma_f32 v140, v250, v250, s32
    v_fmac_f32 v140, v251, v251
    v_mfma_f32_16x16x32_bf16 v[178:181], a[52:55], v[206:209], v[178:181]
    v_fmac_f32 v140, v252, v252
    v_fmac_f32 v140, v253, v253
    v_mfma_f32_16x16x32_bf16 v[178:181], a[56:59], v[214:217], v[178:181]
    v_fmac_f32 v131, v166, v166
    v_fmac_f32 v131, v167, v167
    v_mfma_f32_16x16x32_bf16 v[178:181], a[60:63], v[222:225], v[178:181]
    v_fmac_f32 v131, v168, v168
    v_fmac_f32 v131, v169, v169
    v_mfma_f32_16x16x32_bf16 v[178:181], a[64:67], v[234:237], v[178:181]
    s_waitcnt lgkmcnt(0)
    v_fmac_f32 v140, v218, v218
    v_fmac_f32 v140, v219, v219
    v_mfma_f32_16x16x32_bf16 v[178:181], a[68:71], v[170:173], v[178:181]
    s_barrier
    ds_read_b128 v[182:185], v238 offset:2048
    ds_read_b128 v[186:189], v238 offset:3072
    v_mfma_f32_16x16x32_bf16 v[190:193], v[198:201], a[144:147], 0
    v_fmac_f32 v140, v220, v220
    v_fmac_f32 v140, v221, v221
    v_mfma_f32_16x16x32_bf16 v[190:193], v[206:209], a[148:151], v[190:193]
    v_fmac_f32 v140, v162, v162
    v_fmac_f32 v131, v178, v178
    v_mfma_f32_16x16x32_bf16 v[190:193], v[214:217], a[152:155], v[190:193]
    buffer_store_dwordx2 v[120:121], v18, s[48:51], 0 offen nt
    v_fmac_f32 v131, v179, v179
    v_fmac_f32 v131, v180, v180
    v_mfma_f32_16x16x32_bf16 v[190:193], v[222:225], a[156:159], v[190:193]
    v_fmac_f32 v131, v181, v181
    v_fmac_f32 v140, v163, v163
    v_mfma_f32_16x16x32_bf16 v[190:193], v[234:237], a[160:163], v[190:193]
    v_fmac_f32 v140, v164, v164
    v_fmac_f32 v140, v165, v165
    v_mfma_f32_16x16x32_bf16 v[190:193], v[170:173], a[164:167], v[190:193]
    ds_read_b128 v[194:197], v0 offset:32768
    v_cvt_pk_bf16_f32 v36, v131, v140
    v_mfma_f32_16x16x32_bf16 v[202:205], v[198:201], a[168:171], 0
    s_waitcnt lgkmcnt(2)
    v_xor_b32 v131, 65536, v2
    v_bfe_u32 v120, v132, 1, 2
    v_mfma_f32_16x16x32_bf16 v[202:205], v[206:209], a[172:175], v[202:205]
    s_waitcnt lgkmcnt(1)
    v_cvt_pk_bf16_f32 v232, v190, v191
    v_cvt_pk_bf16_f32 v233, v192, v193
    v_mfma_f32_16x16x32_bf16 v[202:205], v[214:217], a[176:179], v[202:205]
    v_xor_b32 v120, v120, v255
    v_lshl_add_u32 v120, v132, 2, v120
    v_mfma_f32_16x16x32_bf16 v[202:205], v[222:225], a[180:183], v[202:205]
    v_lshl_add_u32 v140, v120, 4, s5
    v_lshl_add_u32 v141, v120, 3, s5
    v_mfma_f32_16x16x32_bf16 v[202:205], v[234:237], a[184:187], v[202:205]
    v_lshl_add_u32 v190, v254, 4, s5
    v_lshl_add_u32 v254, v254, 3, s5
    v_mfma_f32_16x16x32_bf16 v[202:205], v[170:173], a[188:191], v[202:205]
    v_lshlrev_b32 v120, 2, v120
    ds_permute_b32 v191, v120, v16
    ds_permute_b32 v192, v120, v19
    ds_permute_b32 v193, v120, v17
    ds_permute_b32 v210, v120, v20
    v_subrev_u32 v148, 0x3d800000, v44
    v_sub_u32 v149, 0x4a000000, v45
    v_or3_b32 v148, v148, v149, v45
    v_cvt_pk_bf16_f32 v120, v202, v203
    v_cvt_pk_bf16_f32 v121, v204, v205
    v_lshl_add_u32 v149, s16, 2, v131
    ds_write_b32 v149, v148 offset:18432
    v_add_u32 v132, 16, v132
    v_mul_u32_u24 v148, s20, v132
    v_add_u32 v148, s38, v148
    v_mul_u32_u24 v148, 911, v148
    v_lshrrev_b32 v148, 16, v148
    v_mul_u32_u24 v148, s22, v148
    v_mad_u32_u24 v148, v132, s21, v148
    v_cmp_gt_u32 vcc, s17, v132
    buffer_store_dwordx4 v[142:145], v15, s[52:55], 0 offen nt
    v_add_u32 v132, s7, v148
    v_cndmask_b32 v132, v240, v132, vcc
    v_lshl_add_u32 v240, v255, 4, v132
    v_add_u32 v240, s3, v240
    v_lshl_add_u32 v255, v255, 3, v132
    v_mfma_f32_16x16x32_bf16 v[142:145], v[32:35], v[36:39], 0
    v_add_u32 v255, s4, v255
    s_nop 0
    s_nop 0
    s_nop 0
    s_nop 0
    s_nop 0
    s_nop 0
    s_nop 0
    v_rsq_f32 v143, v143
    v_rsq_f32 v142, v142
    v_mul_f32 v250, v143, v250
    v_mul_f32 v142, s31, v142
    v_mul_f32 v251, v143, v251
    v_cvt_pk_f16_f32 v202, v250, v251
    v_mul_f32 v252, v143, v252
    v_mul_f32 v253, v143, v253
    v_cvt_pk_f16_f32 v203, v252, v253
    v_mfma_f32_16x16x32_bf16 v[246:249], v[32:35], v[182:185], 0
    s_waitcnt lgkmcnt(0)
    ds_read_b128 v[182:185], v1 offset:32768
    v_mul_f32 v218, v143, v218
    v_mfma_f32_16x16x32_bf16 v[246:249], v[32:35], v[186:189], v[246:249]
    ds_read_b128 v[186:189], v0 offset:32896
    v_mul_f32 v219, v143, v219
    v_cvt_pk_f16_f32 v204, v218, v219
    v_mul_f32 v220, v143, v220
    v_mul_f32 v221, v143, v221
    v_cvt_pk_f16_f32 v205, v220, v221
    v_mfma_f32_16x16x32_bf16 v[218:221], v[198:201], a[192:195], 0
    ds_read_b128 v[198:201], v1 offset:32896
    v_mul_f32 v132, 0x3baaaaab, v247
    v_mfma_f32_16x16x32_bf16 v[218:221], v[206:209], a[196:199], v[218:221]
    ds_read_b128 v[206:209], v0 offset:33024
    v_mul_f32 v162, v143, v162
    v_mfma_f32_16x16x32_bf16 v[218:221], v[214:217], a[200:203], v[218:221]
    ds_read_b128 v[214:217], v1 offset:33024
    v_mul_f32 v163, v143, v163
    v_mfma_f32_16x16x32_bf16 v[218:221], v[222:225], a[204:207], v[218:221]
    v_rsq_f32 v132, v132
    v_mfma_f32_16x16x32_bf16 v[218:221], v[234:237], a[208:211], v[218:221]
    v_mul_f32 v242, v132, v242
    v_mul_f32 v243, v132, v243
    v_mfma_f32_16x16x32_bf16 v[218:221], v[170:173], a[212:215], v[218:221]
    s_waitcnt lgkmcnt(4)
    v_cvt_pk_bf16_f32 v170, v242, v243
    v_mul_f32 v244, v132, v244
    v_mfma_f32_16x16x32_bf16 v[222:225], a[72:75], v[194:197], 0
    s_waitcnt lgkmcnt(3)
    buffer_store_dwordx2 v[138:139], v18, s[52:55], 0 offen nt
    v_mul_f32 v245, v132, v245
    v_cvt_pk_bf16_f32 v171, v244, v245
    v_mfma_f32_16x16x32_bf16 v[222:225], a[76:79], v[182:185], v[222:225]
    s_waitcnt lgkmcnt(2)
    v_mul_f32 v150, v132, v150
    v_mul_f32 v151, v132, v151
    v_mfma_f32_16x16x32_bf16 v[222:225], a[80:83], v[186:189], v[222:225]
    s_waitcnt lgkmcnt(1)
    v_cvt_pk_bf16_f32 v172, v150, v151
    v_mul_f32 v152, v132, v152
    v_mfma_f32_16x16x32_bf16 v[222:225], a[84:87], v[198:201], v[222:225]
    s_waitcnt lgkmcnt(0)
    v_mul_f32 v153, v132, v153
    v_cvt_pk_bf16_f32 v173, v152, v153
    v_mfma_f32_16x16x32_bf16 v[222:225], a[88:91], v[206:209], v[222:225]
    v_mul_f32 v158, v132, v158
    v_mul_f32 v159, v132, v159
    v_mfma_f32_16x16x32_bf16 v[222:225], a[92:95], v[214:217], v[222:225]
    v_cvt_pk_bf16_f32 v138, v158, v159
    v_mul_f32 v160, v132, v160
    v_mfma_f32_16x16x32_bf16 v[150:153], a[96:99], v[194:197], 0
    v_mul_f32 v161, v132, v161
    v_cvt_pk_bf16_f32 v139, v160, v161
    v_mfma_f32_16x16x32_bf16 v[150:153], a[100:103], v[182:185], v[150:153]
    v_cvt_pk_bf16_f32 v148, v218, v219
    v_cvt_pk_bf16_f32 v149, v220, v221
    v_mfma_f32_16x16x32_bf16 v[150:153], a[104:107], v[186:189], v[150:153]
    v_cvt_pk_f16_f32 v160, v162, v163
    v_mul_f32 v164, v143, v164
    v_mfma_f32_16x16x32_bf16 v[150:153], a[108:111], v[198:201], v[150:153]
    v_mul_f32 v165, v143, v165
    v_cvt_pk_f16_f32 v161, v164, v165
    v_mfma_f32_16x16x32_bf16 v[150:153], a[112:115], v[206:209], v[150:153]
    v_mul_f32 v134, v142, v134
    v_mul_f32 v135, v142, v135
    v_mfma_f32_16x16x32_bf16 v[150:153], a[116:119], v[214:217], v[150:153]
    v_cvt_pk_f16_f32 v134, v134, v135
    v_mul_f32 v136, v142, v136
    v_mfma_f32_16x16x32_bf16 v[162:165], a[120:123], v[194:197], 0
    v_mul_f32 v137, v142, v137
    v_cvt_pk_f16_f32 v135, v136, v137
    v_mfma_f32_16x16x32_bf16 v[162:165], a[124:127], v[182:185], v[162:165]
    v_mul_f32 v166, v142, v166
    v_mul_f32 v167, v142, v167
    v_mfma_f32_16x16x32_bf16 v[162:165], a[128:131], v[186:189], v[162:165]
    v_cvt_pk_f16_f32 v136, v166, v167
    v_mul_f32 v168, v142, v168
    v_mfma_f32_16x16x32_bf16 v[162:165], a[132:135], v[198:201], v[162:165]
    v_mul_f32 v169, v142, v169
    v_cvt_pk_f16_f32 v137, v168, v169
    v_mfma_f32_16x16x32_bf16 v[162:165], a[136:139], v[206:209], v[162:165]
    buffer_store_dwordx4 v[170:173], v130, s[12:15], 0 offen nt
    v_mul_f32 v178, v142, v178
    v_mul_f32 v179, v142, v179
    v_cvt_pk_f16_f32 v158, v178, v179
    v_mul_f32 v180, v142, v180
    v_mfma_f32_16x16x32_bf16 v[162:165], a[140:143], v[214:217], v[162:165]
    v_mul_f32 v181, v142, v181
    v_cvt_pk_f16_f32 v159, v180, v181
    v_mfma_f32_16x16x32_bf16 v[142:145], a[0:3], v[194:197], 0
    v_mul_f32 v130, 0x3baaaaab, v246
    v_fma_f32 v132, v222, v222, s32
    v_mfma_f32_16x16x32_bf16 v[142:145], a[4:7], v[182:185], v[142:145]
    v_rsq_f32 v130, v130
    v_mfma_f32_16x16x32_bf16 v[142:145], a[8:11], v[186:189], v[142:145]
    v_mul_f32 v122, v130, v122
    v_mul_f32 v123, v130, v123
    v_mfma_f32_16x16x32_bf16 v[142:145], a[12:15], v[198:201], v[142:145]
    v_cvt_pk_bf16_f32 v122, v122, v123
    v_mul_f32 v124, v130, v124
    v_mfma_f32_16x16x32_bf16 v[142:145], a[16:19], v[206:209], v[142:145]
    v_mul_f32 v125, v130, v125
    v_cvt_pk_bf16_f32 v123, v124, v125
    v_mfma_f32_16x16x32_bf16 v[142:145], a[20:23], v[214:217], v[142:145]
    v_mul_f32 v154, v130, v154
    v_mul_f32 v155, v130, v155
    v_mfma_f32_16x16x32_bf16 v[166:169], a[24:27], v[194:197], 0
    v_cvt_pk_bf16_f32 v124, v154, v155
    v_mul_f32 v156, v130, v156
    v_mfma_f32_16x16x32_bf16 v[166:169], a[28:31], v[182:185], v[166:169]
    v_mul_f32 v157, v130, v157
    v_cvt_pk_bf16_f32 v125, v156, v157
    v_mfma_f32_16x16x32_bf16 v[166:169], a[32:35], v[186:189], v[166:169]
    v_mul_f32 v174, v130, v174
    v_mul_f32 v175, v130, v175
    v_mfma_f32_16x16x32_bf16 v[166:169], a[36:39], v[198:201], v[166:169]
    v_cvt_pk_bf16_f32 v212, v174, v175
    v_mul_f32 v176, v130, v176
    v_mfma_f32_16x16x32_bf16 v[166:169], a[40:43], v[206:209], v[166:169]
    v_mul_f32 v177, v130, v177
    v_cvt_pk_bf16_f32 v213, v176, v177
    v_mfma_f32_16x16x32_bf16 v[166:169], a[44:47], v[214:217], v[166:169]
    v_fma_f32 v130, v142, v142, s32
    v_fmac_f32 v130, v143, v143
    v_mfma_f32_16x16x32_bf16 v[154:157], a[48:51], v[194:197], 0
    v_fmac_f32 v130, v144, v144
    v_fmac_f32 v130, v145, v145
    v_mfma_f32_16x16x32_bf16 v[154:157], a[52:55], v[182:185], v[154:157]
    v_fmac_f32 v132, v223, v223
    v_fmac_f32 v132, v224, v224
    v_mfma_f32_16x16x32_bf16 v[154:157], a[56:59], v[186:189], v[154:157]
    ds_read2_b32 v[172:173], v6 offset0:0 offset1:0
    ds_read2_b32 v[176:177], v6 offset0:16 offset1:16
    v_mfma_f32_16x16x32_bf16 v[154:157], a[60:63], v[198:201], v[154:157]
    ds_read2_b32 v[180:181], v6 offset0:32 offset1:32
    buffer_store_dwordx2 v[138:139], v241, s[12:15], 0 offen nt
    v_fmac_f32 v130, v166, v166
    v_fmac_f32 v130, v167, v167
    v_mfma_f32_16x16x32_bf16 v[154:157], a[64:67], v[206:209], v[154:157]
    v_fmac_f32 v130, v168, v168
    v_fmac_f32 v130, v169, v169
    v_mfma_f32_16x16x32_bf16 v[154:157], a[68:71], v[214:217], v[154:157]
    v_fmac_f32 v132, v225, v225
    v_fmac_f32 v132, v150, v150
    v_mfma_f32_16x16x32_bf16 v[218:221], v[194:197], a[144:147], 0
    v_fmac_f32 v132, v151, v151
    v_fmac_f32 v132, v152, v152
    v_mfma_f32_16x16x32_bf16 v[218:221], v[182:185], a[148:151], v[218:221]
    v_fmac_f32 v132, v153, v153
    v_fmac_f32 v132, v162, v162
    v_mfma_f32_16x16x32_bf16 v[218:221], v[186:189], a[152:155], v[218:221]
    v_fmac_f32 v130, v154, v154
    v_fmac_f32 v130, v155, v155
    v_mfma_f32_16x16x32_bf16 v[218:221], v[198:201], a[156:159], v[218:221]
    s_waitcnt lgkmcnt(1)
    v_fmac_f32 v130, v156, v156
    v_fmac_f32 v130, v157, v157
    v_mfma_f32_16x16x32_bf16 v[218:221], v[206:209], a[160:163], v[218:221]
    s_waitcnt lgkmcnt(0)
    v_fmac_f32 v132, v163, v163
    v_fmac_f32 v132, v164, v164
    v_mfma_f32_16x16x32_bf16 v[218:221], v[214:217], a[164:167], v[218:221]
    v_fmac_f32 v132, v165, v165
    v_cvt_pk_bf16_f32 v36, v130, v132
    v_mfma_f32_16x16x32_bf16 v[234:237], v[194:197], a[168:171], 0
    v_mfma_f32_16x16x32_bf16 v[234:237], v[182:185], a[172:175], v[234:237]
    v_mfma_f32_16x16x32_bf16 v[242:245], v[32:35], v[36:39], 0
    v_mfma_f32_16x16x32_bf16 v[234:237], v[186:189], a[176:179], v[234:237]
    v_mfma_f32_16x16x32_bf16 v[234:237], v[198:201], a[180:183], v[234:237]
    v_mfma_f32_16x16x32_bf16 v[234:237], v[206:209], a[184:187], v[234:237]
    v_cvt_pk_bf16_f32 v170, v218, v219
    v_cvt_pk_bf16_f32 v171, v220, v221
    v_mfma_f32_16x16x32_bf16 v[234:237], v[214:217], a[188:191], v[234:237]
    v_mfma_f32_16x16x32_bf16 v[218:221], v[194:197], a[192:195], 0
    buffer_store_dwordx4 v[122:125], v17, s[52:55], 0 offen nt
    v_rsq_f32 v243, v243
    v_rsq_f32 v242, v242
    v_mfma_f32_16x16x32_bf16 v[218:221], v[182:185], a[196:199], v[218:221]
    v_mul_f32 v242, s31, v242
    v_mul_f32 v222, v243, v222
    v_mfma_f32_16x16x32_bf16 v[218:221], v[186:189], a[200:203], v[218:221]
    v_cvt_pk_bf16_f32 v174, v234, v235
    v_cvt_pk_bf16_f32 v175, v236, v237
    v_mfma_f32_16x16x32_bf16 v[218:221], v[198:201], a[204:207], v[218:221]
    v_mul_f32 v223, v243, v223
    v_cvt_pk_f16_f32 v122, v222, v223
    v_mfma_f32_16x16x32_bf16 v[218:221], v[206:209], a[208:211], v[218:221]
    ds_read_b128 v[182:185], v5 offset:0
    ds_read_b128 v[186:189], v5 offset:16
    v_mfma_f32_16x16x32_f16 v[194:197], v[114:117], v[126:129], v[46:49]
    ds_read_b128 v[198:201], v5 offset:48
    ds_read_b32 v241, v6 offset:192
    v_mfma_f32_16x16x32_f16 v[206:209], v[202:205], v[126:129], v[50:53]
    v_mul_f32 v224, v243, v224
    v_mul_f32 v225, v243, v225
    v_mfma_f32_16x16x32_bf16 v[218:221], v[214:217], a[212:215], v[218:221]
    v_cvt_pk_f16_f32 v123, v224, v225
    v_mul_f32 v150, v243, v150
    v_mul_f32 v151, v243, v151
    v_mfma_f32_16x16x16_f16 v[194:197], v[228:229], v[226:227], v[194:197]
    v_cvt_pk_f16_f32 v124, v150, v151
    v_mul_f32 v152, v243, v152
    v_mul_f32 v153, v243, v153
    v_mfma_f32_16x16x16_f16 v[206:209], v[160:161], v[226:227], v[206:209]
    v_cvt_pk_bf16_f32 v178, v218, v219
    v_cvt_pk_bf16_f32 v179, v220, v221
    v_cvt_pk_f16_f32 v125, v152, v153
    v_mul_f32 v162, v243, v162
    v_mul_f32 v163, v243, v163
    v_mfma_f32_16x16x32_f16 v[150:153], v[122:125], v[126:129], v[54:57]
    v_cvt_pk_f16_f32 v216, v162, v163
    s_waitcnt lgkmcnt(3)
    v_mfma_f32_16x16x32_f16 v[218:221], v[182:185], v[126:129], v[22:25]
    s_waitcnt lgkmcnt(2)
    v_mul_f32 v164, v243, v164
    v_mul_f32 v165, v243, v165
    v_mfma_f32_16x16x32_f16 v[218:221], v[186:189], v[114:117], v[218:221]
    s_waitcnt lgkmcnt(0)
    v_cvt_pk_f16_f32 v217, v164, v165
    v_mul_f32 v142, v242, v142
    v_mfma_f32_16x16x32_f16 v[218:221], v[198:201], v[226:229], v[218:221]
    v_mul_f32 v143, v242, v143
    v_cvt_pk_f16_f32 v126, v142, v143
    v_mfma_f32_16x16x32_f16 v[162:165], v[182:185], v[134:137], v[24:27]
    v_mul_f32 v144, v242, v144
    v_mul_f32 v145, v242, v145
    v_mfma_f32_16x16x32_f16 v[162:165], v[186:189], v[202:205], v[162:165]
    buffer_store_dwordx2 v[212:213], v20, s[52:55], 0 offen nt
    v_cvt_pk_f16_f32 v127, v144, v145
    v_mov_b32_dpp v241, v219 quad_perm:[0,1,2,3] row_mask:0x1 bank_mask:0xf
    v_mfma_f32_16x16x32_f16 v[162:165], v[198:201], v[158:161], v[162:165]
    v_mul_f32 v166, v242, v166
    v_mul_f32 v167, v242, v167
    v_cvt_pk_f16_f32 v128, v166, v167
    v_mfma_f32_16x16x16_f16 v[150:153], v[216:217], v[226:227], v[150:153]
    v_mul_f32 v168, v242, v168
    v_mul_f32 v169, v242, v169
    v_cvt_pk_f16_f32 v129, v168, v169
    v_mul_f32 v154, v242, v154
    v_mov_b32_dpp v241, v163 quad_perm:[0,1,2,3] row_mask:0x2 bank_mask:0xf
    v_mfma_f32_16x16x32_f16 v[142:145], v[182:185], v[126:129], v[26:29]
    v_mul_f32 v155, v242, v155
    v_cvt_pk_f16_f32 v214, v154, v155
    v_mfma_f32_16x16x32_f16 v[142:145], v[186:189], v[122:125], v[142:145]
    v_mul_f32 v156, v242, v156
    v_mul_f32 v157, v242, v157
    v_cvt_pk_f16_f32 v215, v156, v157
    v_max3_f32 v130, v218, v194, v195
    v_max3_f32 v130, v130, v196, v197
    v_mfma_f32_16x16x32_f16 v[142:145], v[198:201], v[214:217], v[142:145]
    v_max3_f32 v130, v130, v206, v207
    v_max3_f32 v130, v130, v208, v209
    v_max3_f32 v130, v130, v150, v151
    v_max3_f32 v130, v130, v152, v153
    v_mov_b32 v132, v130
    s_nop 0
    s_nop 0
    v_permlane32_swap_b32 v130, v132
    v_mov_b32_dpp v241, v143 quad_perm:[0,1,2,3] row_mask:0x4 bank_mask:0xf
    v_mov_b32 v138, v241
    v_max_f32 v130, v130, v132
    v_mov_b32 v132, v130
    v_max_f32_dpp v138, v138, v138 quad_perm:[1,0,3,2] row_mask:0xf bank_mask:0xf
    s_nop 0
    v_permlane16_swap_b32 v130, v132
    v_max_f32_dpp v138, v138, v138 quad_perm:[2,3,0,1] row_mask:0xf bank_mask:0xf
    v_max_f32 v130, v130, v132
    v_sub_f32 v194, v194, v130
    v_max_f32_dpp v138, v138, v138 row_half_mirror row_mask:0xf bank_mask:0xf
    v_exp_f32 v194, v194
    v_sub_f32 v195, v195, v130
    v_max_f32_dpp v138, v138, v138 row_mirror row_mask:0xf bank_mask:0xf
    v_mov_b32 v132, v138
    v_exp_f32 v195, v195
    v_sub_f32 v196, v196, v130
    v_permlane32_swap_b32 v138, v132
    v_max_f32 v138, v138, v132
    v_mov_b32 v132, v138
    v_cvt_pk_bf16_f32 v154, v194, v195
    v_exp_f32 v196, v196
    v_permlane16_swap_b32 v138, v132
    v_max_f32 v138, v138, v132
    v_sub_f32 v241, v241, v138
    v_exp_f32 v241, v241
    v_sub_f32 v197, v197, v130
    v_cvt_pk_bf16_f32 v241, v241, v241
    ds_write_b16 v8, v241
    v_exp_f32 v197, v197
    v_sub_f32 v206, v206, v130
    v_cvt_pk_bf16_f32 v155, v196, v197
    v_exp_f32 v206, v206
    v_sub_f32 v207, v207, v130
    v_exp_f32 v207, v207
    v_sub_f32 v208, v208, v130
    v_cvt_pk_bf16_f32 v156, v206, v207
    v_exp_f32 v208, v208
    v_sub_f32 v209, v209, v130
    v_exp_f32 v209, v209
    v_sub_f32 v150, v150, v130
    v_cvt_pk_bf16_f32 v157, v208, v209
    v_exp_f32 v150, v150
    v_sub_f32 v151, v151, v130
    v_exp_f32 v151, v151
    v_mfma_f32_16x16x32_f16 v[166:169], v[114:117], v[134:137], v[58:61]
    v_cvt_pk_bf16_f32 v36, v150, v151
    v_sub_f32 v152, v152, v130
    v_mfma_f32_16x16x32_f16 v[182:185], v[202:205], v[134:137], v[62:65]
    v_exp_f32 v152, v152
    v_mfma_f32_16x16x32_f16 v[186:189], v[122:125], v[134:137], v[66:69]
    v_sub_f32 v153, v153, v130
    v_exp_f32 v153, v153
    v_mfma_f32_16x16x16_f16 v[166:169], v[228:229], v[158:159], v[166:169]
    v_cvt_pk_bf16_f32 v37, v152, v153
    v_sub_f32 v218, v218, v130
    v_mfma_f32_16x16x16_f16 v[182:185], v[160:161], v[158:159], v[182:185]
    v_exp_f32 v218, v218
    v_mfma_f32_16x16x16_f16 v[186:189], v[216:217], v[158:159], v[186:189]
    v_cvt_pk_bf16_f32 v39, v218, 0
    s_nop 0
    s_nop 0
    v_max3_f32 v241, v162, v166, v167
    v_mfma_f32_16x16x32_bf16 v[134:137], v[28:31], v[36:39], 0
    v_max3_f32 v241, v241, v168, v169
    v_max3_f32 v241, v241, v182, v183
    v_mfma_f32_16x16x32_bf16 v[134:137], v[28:31], v[154:157], v[134:137]
    v_max3_f32 v241, v241, v184, v185
    v_max3_f32 v241, v241, v186, v187
    v_mfma_f32_16x16x32_bf16 v[150:153], v[170:173], v[36:39], 0
    v_max3_f32 v241, v241, v188, v189
    v_mov_b32 v130, v241
    v_mfma_f32_16x16x32_bf16 v[150:153], v[230:233], v[154:157], v[150:153]
    v_mfma_f32_16x16x32_bf16 v[194:197], v[174:177], v[36:39], 0
    v_permlane32_swap_b32 v241, v130
    v_mfma_f32_16x16x32_bf16 v[194:197], v[118:121], v[154:157], v[194:197]
    v_rcp_f32 v134, v134
    v_mfma_f32_16x16x32_bf16 v[198:201], v[178:181], v[36:39], 0
    v_max_f32 v241, v241, v130
    v_mov_b32 v130, v241
    v_mfma_f32_16x16x32_bf16 v[198:201], v[146:149], v[154:157], v[198:201]
    v_mul_f32 v150, v134, v150
    v_mul_f32 v151, v134, v151
    v_cvt_pk_bf16_f32 v150, v150, v151
    v_mul_f32 v152, v134, v152
    v_mul_f32 v153, v134, v153
    v_cvt_pk_bf16_f32 v151, v152, v153
    v_mul_f32 v194, v134, v194
    v_mul_f32 v195, v134, v195
    v_cvt_pk_bf16_f32 v152, v194, v195
    v_mul_f32 v196, v134, v196
    v_mul_f32 v197, v134, v197
    v_cvt_pk_bf16_f32 v153, v196, v197
    ds_write_b128 v3, v[150:153] offset:0
    v_mul_f32 v198, v134, v198
    v_mul_f32 v199, v134, v199
    v_cvt_pk_bf16_f32 v138, v198, v199
    v_mul_f32 v200, v134, v200
    v_mul_f32 v201, v134, v201
    v_cvt_pk_bf16_f32 v139, v200, v201
    v_permlane16_swap_b32 v241, v130
    ds_write_b64 v4, v[138:139] offset:4096
    v_max_f32 v241, v241, v130
    v_sub_f32 v166, v166, v241
    v_exp_f32 v166, v166
    v_mfma_f32_16x16x32_f16 v[134:137], v[114:117], v[126:129], v[70:73]
    v_sub_f32 v167, v167, v241
    v_sub_f32 v168, v168, v241
    v_mfma_f32_16x16x32_f16 v[114:117], v[202:205], v[126:129], v[74:77]
    v_exp_f32 v167, v167
    v_mfma_f32_16x16x32_f16 v[150:153], v[122:125], v[126:129], v[78:81]
    v_cvt_pk_bf16_f32 v122, v166, v167
    v_exp_f32 v168, v168
    v_mfma_f32_16x16x16_f16 v[134:137], v[228:229], v[214:215], v[134:137]
    v_sub_f32 v169, v169, v241
    v_exp_f32 v169, v169
    v_mfma_f32_16x16x16_f16 v[114:117], v[160:161], v[214:215], v[114:117]
    v_cvt_pk_bf16_f32 v123, v168, v169
    v_sub_f32 v182, v182, v241
    v_sub_f32 v183, v183, v241
    v_mfma_f32_16x16x16_f16 v[150:153], v[216:217], v[214:215], v[150:153]
    s_waitcnt lgkmcnt(0)
    s_barrier
    ds_read_b128 v[126:129], v131 offset:0
    ds_read_b128 v[154:157], v131 offset:1024
    ds_read_b128 v[158:161], v131 offset:2048
    ds_read_b128 v[166:169], v131 offset:3072
    ds_read_b128 v[194:197], v131 offset:4096
    ds_read_b128 v[198:201], v131 offset:5120
    v_exp_f32 v182, v182
    v_exp_f32 v183, v183
    v_sub_f32 v184, v184, v241
    v_cvt_pk_bf16_f32 v124, v182, v183
    v_exp_f32 v184, v184
    v_sub_f32 v185, v185, v241
    v_exp_f32 v185, v185
    v_sub_f32 v186, v186, v241
    v_cvt_pk_bf16_f32 v125, v184, v185
    v_exp_f32 v186, v186
    s_waitcnt lgkmcnt(4)
    v_mfma_f32_16x16x32_bf16 v[182:185], a[216:219], v[126:129], 0
    s_waitcnt lgkmcnt(3)
    v_sub_f32 v187, v187, v241
    v_sub_f32 v188, v188, v241
    v_mfma_f32_16x16x32_bf16 v[182:185], a[220:223], v[154:157], v[182:185]
    s_waitcnt lgkmcnt(2)
    v_exp_f32 v187, v187
    v_mfma_f32_16x16x32_bf16 v[182:185], a[224:227], v[158:161], v[182:185]
    s_waitcnt lgkmcnt(1)
    v_cvt_pk_bf16_f32 v36, v186, v187
    v_sub_f32 v189, v189, v241
    v_mfma_f32_16x16x32_bf16 v[182:185], a[228:231], v[166:169], v[182:185]
    s_waitcnt lgkmcnt(0)
    v_exp_f32 v188, v188
    v_mfma_f32_16x16x32_bf16 v[182:185], a[232:235], v[194:197], v[182:185]
    v_exp_f32 v189, v189
    v_mfma_f32_16x16x32_bf16 v[182:185], a[236:239], v[198:201], v[182:185]
    v_cvt_pk_bf16_f32 v37, v188, v189
    v_sub_f32 v162, v162, v241
    v_mfma_f32_16x16x32_bf16 v[186:189], a[240:243], v[126:129], 0
    v_exp_f32 v162, v162
    v_mfma_f32_16x16x32_bf16 v[186:189], a[244:247], v[154:157], v[186:189]
    v_cvt_pk_bf16_f32 v39, v162, 0
    v_max3_f32 v241, v142, v134, v135
    v_mfma_f32_16x16x32_bf16 v[186:189], a[248:251], v[158:161], v[186:189]
    v_max3_f32 v241, v241, v136, v137
    v_max3_f32 v241, v241, v114, v115
    v_mfma_f32_16x16x32_bf16 v[186:189], a[252:255], v[166:169], v[186:189]
    v_max3_f32 v241, v241, v116, v117
    v_max3_f32 v241, v241, v150, v151
    v_mfma_f32_16x16x32_bf16 v[186:189], v[82:85], v[194:197], v[186:189]
    v_max3_f32 v241, v241, v152, v153
    v_mov_b32 v130, v241
    v_mfma_f32_16x16x32_bf16 v[186:189], v[86:89], v[198:201], v[186:189]
    v_fma_f32 v132, v182, v182, s33
    v_fmac_f32 v132, v183, v183
    v_mfma_f32_16x16x32_bf16 v[162:165], v[90:93], v[126:129], 0
    v_permlane32_swap_b32 v241, v130
    v_mfma_f32_16x16x32_bf16 v[162:165], v[94:97], v[154:157], v[162:165]
    v_max_f32 v241, v241, v130
    v_mov_b32 v130, v241
    v_mfma_f32_16x16x32_bf16 v[162:165], v[98:101], v[158:161], v[162:165]
    v_fmac_f32 v132, v184, v184
    v_fmac_f32 v132, v185, v185
    v_mfma_f32_16x16x32_bf16 v[162:165], v[102:105], v[166:169], v[162:165]
    v_permlane16_swap_b32 v241, v130
    v_mfma_f32_16x16x32_bf16 v[162:165], v[106:109], v[194:197], v[162:165]
    v_max_f32 v241, v241, v130
    v_sub_f32 v134, v134, v241
    v_mfma_f32_16x16x32_bf16 v[162:165], v[110:113], v[198:201], v[162:165]
    v_exp_f32 v134, v134
    v_mfma_f32_16x16x32_bf16 v[126:129], v[28:31], v[36:39], 0
    v_sub_f32 v135, v135, v241
    v_sub_f32 v136, v136, v241
    v_mfma_f32_16x16x32_bf16 v[126:129], v[28:31], v[122:125], v[126:129]
    v_exp_f32 v135, v135
    v_mfma_f32_16x16x32_bf16 v[154:157], v[170:173], v[36:39], 0
    v_cvt_pk_bf16_f32 v134, v134, v135
    v_sub_f32 v137, v137, v241
    v_mfma_f32_16x16x32_bf16 v[154:157], v[230:233], v[122:125], v[154:157]
    v_exp_f32 v136, v136
    v_mfma_f32_16x16x32_bf16 v[158:161], v[174:177], v[36:39], 0
    v_exp_f32 v137, v137
    v_mfma_f32_16x16x32_bf16 v[158:161], v[118:121], v[122:125], v[158:161]
    ds_read_b128 v[166:169], v9
    ds_read_b128 v[194:197], v9 offset:64
    v_mfma_f32_16x16x32_bf16 v[198:201], v[178:181], v[36:39], 0
    v_cvt_pk_bf16_f32 v135, v136, v137
    v_sub_f32 v114, v114, v241
    v_mfma_f32_16x16x32_bf16 v[198:201], v[146:149], v[122:125], v[198:201]
    v_exp_f32 v114, v114
    v_sub_f32 v115, v115, v241
    v_exp_f32 v115, v115
    v_sub_f32 v116, v116, v241
    v_cvt_pk_bf16_f32 v136, v114, v115
    v_exp_f32 v116, v116
    v_sub_f32 v117, v117, v241
    v_exp_f32 v117, v117
    v_sub_f32 v150, v150, v241
    v_cvt_pk_bf16_f32 v137, v116, v117
    v_exp_f32 v150, v150
    v_sub_f32 v151, v151, v241
    v_exp_f32 v151, v151
    v_sub_f32 v152, v152, v241
    s_waitcnt lgkmcnt(1)
    v_mfma_f32_16x16x32_bf16 v[114:117], v[166:169], v[28:31], 0
    s_waitcnt lgkmcnt(0)
    v_cvt_pk_bf16_f32 v36, v150, v151
    v_sub_f32 v153, v153, v241
    v_mfma_f32_16x16x32_bf16 v[114:117], v[194:197], v[28:31], v[114:117]
    v_exp_f32 v152, v152
    v_mfma_f32_16x16x32_bf16 v[122:125], v[166:169], v[230:233], 0
    v_exp_f32 v153, v153
    v_mfma_f32_16x16x32_bf16 v[122:125], v[194:197], v[170:173], v[122:125]
    v_cvt_pk_bf16_f32 v37, v152, v153
    v_sub_f32 v142, v142, v241
    v_mfma_f32_16x16x32_bf16 v[150:153], v[166:169], v[118:121], 0
    v_exp_f32 v142, v142
    v_mfma_f32_16x16x32_bf16 v[150:153], v[194:197], v[174:177], v[150:153]
    v_cvt_pk_bf16_f32 v39, v142, 0
    v_fmac_f32 v132, v186, v186
    v_mfma_f32_16x16x32_bf16 v[142:145], v[166:169], v[146:149], 0
    v_rcp_f32 v126, v126
    v_mfma_f32_16x16x32_bf16 v[142:145], v[194:197], v[178:181], v[142:145]
    v_fmac_f32 v132, v187, v187
    v_fmac_f32 v132, v188, v188
    v_mfma_f32_16x16x32_bf16 v[166:169], v[28:31], v[36:39], 0
    v_fmac_f32 v132, v189, v189
    v_fmac_f32 v132, v162, v162
    v_mfma_f32_16x16x32_bf16 v[166:169], v[28:31], v[134:137], v[166:169]
    v_fmac_f32 v132, v163, v163
    v_fmac_f32 v132, v164, v164
    v_mfma_f32_16x16x32_bf16 v[194:197], v[170:173], v[36:39], 0
    v_fmac_f32 v132, v165, v165
    v_cvt_pk_bf16_f32 v138, v132, v132
    v_mfma_f32_16x16x32_bf16 v[194:197], v[230:233], v[134:137], v[194:197]
    v_cvt_pk_bf16_f32 v139, v132, v132
    v_mul_f32 v154, v126, v154
    v_mfma_f32_16x16x32_bf16 v[170:173], v[174:177], v[36:39], 0
    ds_write_b64 v239, v[138:139] offset:4096
    v_mfma_f32_16x16x32_bf16 v[170:173], v[118:121], v[134:137], v[170:173]
    v_rcp_f32 v166, v166
    v_mfma_f32_16x16x32_bf16 v[118:121], v[178:181], v[36:39], 0
    v_mul_f32 v155, v126, v155
    v_mul_f32 v194, v166, v194
    v_mfma_f32_16x16x32_bf16 v[118:121], v[146:149], v[134:137], v[118:121]
    v_mul_f32 v195, v166, v195
    v_cvt_pk_bf16_f32 v134, v194, v195
    v_mul_f32 v196, v166, v196
    v_mul_f32 v197, v166, v197
    v_cvt_pk_bf16_f32 v135, v196, v197
    v_mul_f32 v170, v166, v170
    v_mul_f32 v171, v166, v171
    v_cvt_pk_bf16_f32 v136, v170, v171
    v_mul_f32 v172, v166, v172
    v_mul_f32 v173, v166, v173
    v_cvt_pk_bf16_f32 v137, v172, v173
    ds_write_b128 v3, v[134:137] offset:12288
    v_mul_f32 v118, v166, v118
    v_mul_f32 v119, v166, v119
    v_cvt_pk_bf16_f32 v138, v118, v119
    v_mul_f32 v120, v166, v120
    v_mul_f32 v121, v166, v121
    v_cvt_pk_bf16_f32 v139, v120, v121
    v_cvt_pk_bf16_f32 v118, v154, v155
    ds_write_b64 v4, v[138:139] offset:16384
    v_mul_f32 v156, v126, v156
    v_mul_f32 v157, v126, v157
    v_cvt_pk_bf16_f32 v119, v156, v157
    v_mul_f32 v158, v126, v158
    v_mul_f32 v159, v126, v159
    v_cvt_pk_bf16_f32 v120, v158, v159
    v_mul_f32 v160, v126, v160
    v_mul_f32 v161, v126, v161
    v_cvt_pk_bf16_f32 v121, v160, v161
    ds_write_b128 v3, v[118:121] offset:6144
    v_mul_f32 v198, v126, v198
    v_mul_f32 v199, v126, v199
    v_cvt_pk_bf16_f32 v138, v198, v199
    v_mul_f32 v200, v126, v200
    v_mul_f32 v201, v126, v201
    v_cvt_pk_bf16_f32 v139, v200, v201
    v_rcp_f32 v114, v114
    ds_write_b64 v4, v[138:139] offset:10240
    v_mul_f32 v122, v122, v114
    v_mul_f32_dpp v122, v150, v114 quad_perm:[0,1,2,3] row_mask:0x2 bank_mask:0xf
    v_mul_f32_dpp v122, v142, v114 quad_perm:[0,1,2,3] row_mask:0x4 bank_mask:0xf
    v_cvt_pk_bf16_f32 v122, v122, v122
    ds_write_b16 v7, v122
    s_waitcnt lgkmcnt(0)
    s_barrier
    ds_read_b128 v[114:117], v238 offset:4096
    ds_read_b128 v[118:121], v238 offset:5120
    ds_read_b128 v[122:125], v131 offset:6144
    ds_read_b128 v[126:129], v131 offset:7168
    ds_read_b128 v[134:137], v131 offset:8192
    ds_read_b128 v[142:145], v131 offset:9216
    ds_read_b128 v[146:149], v131 offset:10240
    ds_read_b128 v[150:153], v131 offset:11264
    s_waitcnt lgkmcnt(7)
    v_mfma_f32_16x16x32_bf16 v[154:157], v[32:35], v[114:117], 0
    s_waitcnt lgkmcnt(6)
    v_mfma_f32_16x16x32_bf16 v[154:157], v[32:35], v[118:121], v[154:157]
    s_waitcnt lgkmcnt(4)
    v_mfma_f32_16x16x32_bf16 v[114:117], a[216:219], v[122:125], 0
    s_waitcnt lgkmcnt(3)
    v_mfma_f32_16x16x32_bf16 v[114:117], a[220:223], v[126:129], v[114:117]
    s_waitcnt lgkmcnt(2)
    v_mfma_f32_16x16x32_bf16 v[114:117], a[224:227], v[134:137], v[114:117]
    s_waitcnt lgkmcnt(1)
    v_mfma_f32_16x16x32_bf16 v[114:117], a[228:231], v[142:145], v[114:117]
    s_waitcnt lgkmcnt(0)
    v_mul_f32 v241, 0x3baaaaab, v154
    v_mfma_f32_16x16x32_bf16 v[114:117], a[232:235], v[146:149], v[114:117]
    v_rsq_f32 v241, v241
    v_mfma_f32_16x16x32_bf16 v[114:117], a[236:239], v[150:153], v[114:117]
    v_mul_f32 v182, v241, v182
    v_mul_f32 v183, v241, v183
    v_mfma_f32_16x16x32_bf16 v[118:121], a[240:243], v[122:125], 0
    v_cvt_pk_bf16_f32 v154, v182, v183
    v_mul_f32 v184, v241, v184
    v_mfma_f32_16x16x32_bf16 v[118:121], a[244:247], v[126:129], v[118:121]
    v_mul_f32 v185, v241, v185
    v_cvt_pk_bf16_f32 v155, v184, v185
    v_mfma_f32_16x16x32_bf16 v[118:121], a[248:251], v[134:137], v[118:121]
    v_mul_f32 v186, v241, v186
    v_mul_f32 v187, v241, v187
    v_mfma_f32_16x16x32_bf16 v[118:121], a[252:255], v[142:145], v[118:121]
    v_cvt_pk_bf16_f32 v156, v186, v187
    v_mul_f32 v188, v241, v188
    v_mfma_f32_16x16x32_bf16 v[118:121], v[82:85], v[146:149], v[118:121]
    v_mul_f32 v189, v241, v189
    v_cvt_pk_bf16_f32 v157, v188, v189
    v_mfma_f32_16x16x32_bf16 v[118:121], v[86:89], v[150:153], v[118:121]
    buffer_store_dwordx4 v[154:157], v15, s[56:59], 0 offen nt
    v_mul_f32 v162, v241, v162
    v_mul_f32 v163, v241, v163
    v_cvt_pk_bf16_f32 v138, v162, v163
    v_mul_f32 v164, v241, v164
    v_mfma_f32_16x16x32_bf16 v[154:157], v[90:93], v[122:125], 0
    ds_read_b128 v[122:125], v133 offset:256
    v_mul_f32 v165, v241, v165
    v_mfma_f32_16x16x32_bf16 v[154:157], v[94:97], v[126:129], v[154:157]
    ds_read_b128 v[126:129], v133 offset:2304
    v_cvt_pk_bf16_f32 v139, v164, v165
    v_mfma_f32_16x16x32_bf16 v[154:157], v[98:101], v[134:137], v[154:157]
    ds_read_b128 v[134:137], v133 offset:4352
    v_fma_f32 v241, v114, v114, s33
    v_mfma_f32_16x16x32_bf16 v[154:157], v[102:105], v[142:145], v[154:157]
    ds_read_b128 v[142:145], v133 offset:6400
    v_fmac_f32 v241, v115, v115
    v_mfma_f32_16x16x32_bf16 v[154:157], v[106:109], v[146:149], v[154:157]
    ds_read_b128 v[146:149], v133 offset:8448
    v_fmac_f32 v241, v116, v116
    v_mfma_f32_16x16x32_bf16 v[154:157], v[110:113], v[150:153], v[154:157]
    ds_read_b128 v[150:153], v133 offset:10496
    v_fmac_f32 v241, v117, v117
    v_fmac_f32 v241, v118, v118
    v_fmac_f32 v241, v119, v119
    v_fmac_f32 v241, v120, v120
    v_fmac_f32 v241, v121, v121
    s_nop 0
    s_nop 0
    s_waitcnt lgkmcnt(5)
    v_mfma_f32_16x16x32_bf16 v[158:161], a[216:219], v[122:125], 0
    v_fmac_f32 v241, v154, v154
    v_fmac_f32 v241, v155, v155
    v_mfma_f32_16x16x32_bf16 v[162:165], a[240:243], v[122:125], 0
    s_waitcnt lgkmcnt(4)
    v_fmac_f32 v241, v156, v156
    v_fmac_f32 v241, v157, v157
    v_mfma_f32_16x16x32_bf16 v[158:161], a[220:223], v[126:129], v[158:161]
    s_waitcnt lgkmcnt(3)
    v_cvt_pk_bf16_f32 v132, v241, v241
    v_cvt_pk_bf16_f32 v133, v241, v241
    v_mfma_f32_16x16x32_bf16 v[158:161], a[224:227], v[134:137], v[158:161]
    s_waitcnt lgkmcnt(2)
    ds_write_b64 v239, v[132:133] offset:6144
    v_mfma_f32_16x16x32_bf16 v[158:161], a[228:231], v[142:145], v[158:161]
    s_waitcnt lgkmcnt(2)
    v_mfma_f32_16x16x32_bf16 v[158:161], a[232:235], v[146:149], v[158:161]
    s_waitcnt lgkmcnt(1)
    v_mfma_f32_16x16x32_bf16 v[158:161], a[236:239], v[150:153], v[158:161]
    v_mfma_f32_16x16x32_bf16 v[162:165], a[244:247], v[126:129], v[162:165]
    buffer_store_dwordx2 v[138:139], v18, s[56:59], 0 offen nt
    v_mfma_f32_16x16x32_bf16 v[162:165], a[248:251], v[134:137], v[162:165]
    v_mfma_f32_16x16x32_bf16 v[162:165], a[252:255], v[142:145], v[162:165]
    v_mfma_f32_16x16x32_bf16 v[162:165], v[82:85], v[146:149], v[162:165]
    s_waitcnt lgkmcnt(0)
    v_mfma_f32_16x16x32_bf16 v[162:165], v[86:89], v[150:153], v[162:165]
    s_barrier
    ds_read_b128 v[166:169], v238 offset:6144
    ds_read_b128 v[170:173], v238 offset:7168
    v_mfma_f32_16x16x32_bf16 v[174:177], v[90:93], v[122:125], 0
    ds_read_b128 v[122:125], v131 offset:12288
    v_fma_f32 v241, v158, v158, s33
    v_mfma_f32_16x16x32_bf16 v[174:177], v[94:97], v[126:129], v[174:177]
    ds_read_b128 v[126:129], v131 offset:13312
    v_fmac_f32 v241, v159, v159
    v_mfma_f32_16x16x32_bf16 v[174:177], v[98:101], v[134:137], v[174:177]
    ds_read_b128 v[134:137], v131 offset:14336
    v_fmac_f32 v241, v160, v160
    v_mfma_f32_16x16x32_bf16 v[174:177], v[102:105], v[142:145], v[174:177]
    ds_read_b128 v[142:145], v131 offset:15360
    v_fmac_f32 v241, v161, v161
    v_mfma_f32_16x16x32_bf16 v[174:177], v[106:109], v[146:149], v[174:177]
    ds_read_b128 v[146:149], v131 offset:16384
    v_fmac_f32 v241, v162, v162
    v_mfma_f32_16x16x32_bf16 v[174:177], v[110:113], v[150:153], v[174:177]
    ds_read_b128 v[150:153], v131 offset:17408
    v_fmac_f32 v241, v163, v163
    v_fmac_f32 v241, v164, v164
    v_fmac_f32 v241, v165, v165
    s_waitcnt lgkmcnt(7)
    v_mfma_f32_16x16x32_bf16 v[178:181], v[32:35], v[166:169], 0
    s_waitcnt lgkmcnt(6)
    v_mfma_f32_16x16x32_bf16 v[178:181], v[32:35], v[170:173], v[178:181]
    s_waitcnt lgkmcnt(5)
    v_fmac_f32 v241, v174, v174
    v_fmac_f32 v241, v175, v175
    v_mfma_f32_16x16x32_bf16 v[166:169], a[216:219], v[122:125], 0
    s_waitcnt lgkmcnt(4)
    v_fmac_f32 v241, v176, v176
    v_fmac_f32 v241, v177, v177
    v_mfma_f32_16x16x32_bf16 v[166:169], a[220:223], v[126:129], v[166:169]
    s_waitcnt lgkmcnt(3)
    v_cvt_pk_bf16_f32 v138, v241, v241
    v_cvt_pk_bf16_f32 v139, v241, v241
    v_mfma_f32_16x16x32_bf16 v[166:169], a[224:227], v[134:137], v[166:169]
    s_waitcnt lgkmcnt(2)
    ds_write_b64 v239, v[138:139] offset:8192
    v_mfma_f32_16x16x32_bf16 v[166:169], a[228:231], v[142:145], v[166:169]
    s_waitcnt lgkmcnt(2)
    v_mul_f32 v241, 0x3baaaaab, v178
    v_mfma_f32_16x16x32_bf16 v[166:169], a[232:235], v[146:149], v[166:169]
    s_waitcnt lgkmcnt(1)
    v_rsq_f32 v241, v241
    v_mfma_f32_16x16x32_bf16 v[166:169], a[236:239], v[150:153], v[166:169]
    v_mul_f32 v114, v241, v114
    v_mul_f32 v115, v241, v115
    v_mfma_f32_16x16x32_bf16 v[170:173], a[240:243], v[122:125], 0
    v_cvt_pk_bf16_f32 v114, v114, v115
    v_mul_f32 v116, v241, v116
    v_mfma_f32_16x16x32_bf16 v[170:173], a[244:247], v[126:129], v[170:173]
    v_mul_f32 v117, v241, v117
    v_cvt_pk_bf16_f32 v115, v116, v117
    v_mfma_f32_16x16x32_bf16 v[170:173], a[248:251], v[134:137], v[170:173]
    v_fma_f32 v138, v166, v166, s33
    v_fmac_f32 v138, v167, v167
    v_mfma_f32_16x16x32_bf16 v[170:173], a[252:255], v[142:145], v[170:173]
    s_waitcnt lgkmcnt(0)
    v_fmac_f32 v138, v168, v168
    v_fmac_f32 v138, v169, v169
    v_mfma_f32_16x16x32_bf16 v[170:173], v[82:85], v[146:149], v[170:173]
    s_barrier
    ds_read_b128 v[178:181], v238 offset:8192
    ds_read_b128 v[182:185], v238 offset:9216
    v_mfma_f32_16x16x32_bf16 v[170:173], v[86:89], v[150:153], v[170:173]
    v_mul_f32 v118, v241, v118
    v_mul_f32 v119, v241, v119
    v_mfma_f32_16x16x32_bf16 v[186:189], v[90:93], v[122:125], 0
    v_cvt_pk_bf16_f32 v116, v118, v119
    v_mul_f32 v120, v241, v120
    v_mfma_f32_16x16x32_bf16 v[186:189], v[94:97], v[126:129], v[186:189]
    v_mul_f32 v121, v241, v121
    v_cvt_pk_bf16_f32 v117, v120, v121
    v_mfma_f32_16x16x32_bf16 v[186:189], v[98:101], v[134:137], v[186:189]
    ds_write_b128 v140, v[114:117] offset:1536
    v_mfma_f32_16x16x32_bf16 v[186:189], v[102:105], v[142:145], v[186:189]
    v_fmac_f32 v138, v170, v170
    v_fmac_f32 v138, v171, v171
    v_mfma_f32_16x16x32_bf16 v[186:189], v[106:109], v[146:149], v[186:189]
    v_fmac_f32 v138, v172, v172
    v_fmac_f32 v138, v173, v173
    v_mfma_f32_16x16x32_bf16 v[186:189], v[110:113], v[150:153], v[186:189]
    s_waitcnt lgkmcnt(1)
    ds_read_b128 v[114:117], v190 offset:1536
    v_mul_f32 v154, v241, v154
    v_mfma_f32_16x16x32_bf16 v[118:121], v[32:35], v[178:181], 0
    v_mul_f32 v155, v241, v155
    v_cvt_pk_bf16_f32 v154, v154, v155
    v_mfma_f32_16x16x32_bf16 v[118:121], v[32:35], v[182:185], v[118:121]
    v_mul_f32 v156, v241, v156
    v_fmac_f32 v138, v186, v186
    v_fmac_f32 v138, v187, v187
    v_fmac_f32 v138, v188, v188
    v_fmac_f32 v138, v189, v189
    v_cvt_pk_bf16_f32 v132, v138, v138
    v_cvt_pk_bf16_f32 v133, v138, v138
    ds_write_b64 v239, v[132:133] offset:0
    v_mul_f32 v155, 0x3baaaaab, v118
    v_rsq_f32 v155, v155
    v_mul_f32 v157, v241, v157
    v_mul_f32 v158, v155, v158
    v_mul_f32 v159, v155, v159
    v_cvt_pk_bf16_f32 v118, v158, v159
    v_mul_f32 v160, v155, v160
    s_waitcnt lgkmcnt(1)
    v_mul_f32 v161, v155, v161
    v_cvt_pk_bf16_f32 v119, v160, v161
    v_mul_f32 v162, v155, v162
    v_mul_f32 v163, v155, v163
    v_cvt_pk_bf16_f32 v120, v162, v163
    v_mul_f32 v164, v155, v164
    v_mul_f32 v165, v155, v165
    v_cvt_pk_bf16_f32 v121, v164, v165
    buffer_store_dwordx4 v[118:121], v240, s[12:15], 0 offen nt
    v_mul_f32 v174, v155, v174
    v_mul_f32 v175, v155, v175
    v_cvt_pk_bf16_f32 v138, v174, v175
    v_mul_f32 v176, v155, v176
    v_mul_f32 v177, v155, v177
    s_waitcnt lgkmcnt(0)
    s_barrier
    ds_read_b128 v[118:121], v238 offset:0
    ds_read_b128 v[122:125], v238 offset:1024
    ds_read_b128 v[126:129], v131 offset:18432
    v_cvt_pk_bf16_f32 v139, v176, v177
    v_cvt_pk_bf16_f32 v155, v156, v157
    ds_write_b64 v141, v[154:155] offset:2560
    buffer_store_dwordx2 v[138:139], v255, s[12:15], 0 offen nt
    ds_read_b64 v[212:213], v254 offset:2560
    s_waitcnt lgkmcnt(4)
    v_mfma_f32_16x16x32_bf16 v[130:133], v[32:35], v[118:121], 0
    s_waitcnt lgkmcnt(3)
    v_mfma_f32_16x16x32_bf16 v[130:133], v[32:35], v[122:125], v[130:133]
    s_waitcnt lgkmcnt(2)
    v_or3_b32 v126, v126, v127, v128
    v_or_b32 v126, v126, v129
    v_cmp_gt_i32 s[46:47], 0, v126
    s_nop 0
    s_nop 0
    s_nop 0
    s_nop 0
    v_mul_f32 v255, 0x3baaaaab, v130
    v_rsq_f32 v255, v255
    s_nop 0
    v_mul_f32 v166, v255, v166
    buffer_store_dwordx4 v[114:117], v191, s[56:59], 0 offen nt
    s_waitcnt lgkmcnt(0)
    v_mul_f32 v167, v255, v167
    v_cvt_pk_bf16_f32 v114, v166, v167
    v_mul_f32 v168, v255, v168
    v_mul_f32 v169, v255, v169
    v_cvt_pk_bf16_f32 v115, v168, v169
    v_mul_f32 v170, v255, v170
    v_mul_f32 v171, v255, v171
    v_cvt_pk_bf16_f32 v116, v170, v171
    v_mul_f32 v172, v255, v172
    v_mul_f32 v173, v255, v173
    v_cvt_pk_bf16_f32 v117, v172, v173
    ds_write_b128 v140, v[114:117] offset:3072
    buffer_store_dwordx2 v[212:213], v192, s[56:59], 0 offen nt
    v_mul_f32 v186, v255, v186
    v_mul_f32 v187, v255, v187
    v_cvt_pk_bf16_f32 v186, v186, v187
    v_mul_f32 v188, v255, v188
    v_mul_f32 v189, v255, v189
    v_cvt_pk_bf16_f32 v187, v188, v189
    ds_read_b128 v[114:117], v190 offset:3072
    ds_write_b64 v141, v[186:187] offset:4096
    ds_read_b64 v[212:213], v254 offset:4096
    s_waitcnt lgkmcnt(2)
    buffer_store_dwordx4 v[114:117], v193, s[56:59], 0 offen nt
    s_waitcnt lgkmcnt(0)
    buffer_store_dwordx2 v[212:213], v210, s[56:59], 0 offen nt
    s_branch L_end
L_drain:
    ds_read_b128 v[114:117], v2 offset:18432
    ds_read_b128 v[118:121], v2 offset:19456
    ds_read_b128 v[122:125], v2 offset:0
    s_mul_i32 s5, s16, 8064
    s_mov_b32 s12, s42
    ds_read_b128 v[126:129], v2 offset:1024
    s_mov_b32 s13, s43
    s_cmp_ge_u32 s18, 2
    s_cselect_b32 s14, s36, 0
    ds_read_b128 v[130:133], v2 offset:2048
    s_add_u32 s5, s5, 104448
    s_lshl_b32 s3, s16, 6
    s_lshl_b32 s4, s16, 5
    ds_read_b128 v[134:137], v2 offset:3072
    s_add_u32 s4, s4, 256
    ds_read_b128 v[154:157], v2 offset:4096
    ds_read_b128 v[162:165], v2 offset:5120
    v_bfe_u32 v254, v2, 4, 6
    v_lshrrev_b32 v255, 4, v254
    v_and_b32 v166, 15, v254
    v_lshlrev_b32 v167, 9, v255
    v_lshl_add_u32 v167, v166, 4, v167
    v_add_u32 v167, 136704, v167
    v_xor_b32 v168, 65536, v2
    v_bfe_u32 v169, v166, 1, 2
    s_waitcnt lgkmcnt(7)
    v_mfma_f32_16x16x32_bf16 v[170:173], v[32:35], v[114:117], 0
    s_waitcnt lgkmcnt(5)
    v_xor_b32 v169, v169, v255
    v_lshl_add_u32 v169, v166, 2, v169
    v_mfma_f32_16x16x32_bf16 v[170:173], v[32:35], v[118:121], v[170:173]
    s_waitcnt lgkmcnt(4)
    v_lshl_add_u32 v114, v169, 4, s5
    v_lshl_add_u32 v115, v169, 3, s5
    v_lshl_add_u32 v116, v254, 4, s5
    v_mfma_f32_16x16x32_bf16 v[118:121], a[216:219], v[122:125], 0
    s_waitcnt lgkmcnt(3)
    v_lshl_add_u32 v117, v254, 3, s5
    v_lshlrev_b32 v169, 2, v169
    v_mul_f32 v170, 0x3baaaaab, v170
    v_mfma_f32_16x16x32_bf16 v[118:121], a[220:223], v[126:129], v[118:121]
    s_waitcnt lgkmcnt(2)
    ds_permute_b32 v173, v169, v15
    ds_permute_b32 v174, v169, v18
    v_rsq_f32 v170, v170
    v_mfma_f32_16x16x32_bf16 v[118:121], a[224:227], v[130:133], v[118:121]
    s_waitcnt lgkmcnt(2)
    ds_permute_b32 v175, v169, v16
    ds_permute_b32 v176, v169, v19
    v_mul_f32 v150, v170, v150
    v_mfma_f32_16x16x32_bf16 v[118:121], a[228:231], v[134:137], v[118:121]
    ds_permute_b32 v177, v169, v17
    ds_permute_b32 v182, v169, v20
    v_mul_f32 v151, v170, v151
    v_mfma_f32_16x16x32_bf16 v[118:121], a[232:235], v[154:157], v[118:121]
    v_cvt_pk_bf16_f32 v150, v150, v151
    v_mul_f32 v152, v170, v152
    v_mul_f32 v153, v170, v153
    v_mfma_f32_16x16x32_bf16 v[118:121], a[236:239], v[162:165], v[118:121]
    v_cvt_pk_bf16_f32 v151, v152, v153
    v_mul_f32 v190, v170, v190
    v_mul_f32 v191, v170, v191
    v_mfma_f32_16x16x32_bf16 v[194:197], a[240:243], v[122:125], 0
    v_cvt_pk_bf16_f32 v152, v190, v191
    v_mul_f32 v192, v170, v192
    v_mul_f32 v193, v170, v193
    v_mfma_f32_16x16x32_bf16 v[194:197], a[244:247], v[126:129], v[194:197]
    s_waitcnt lgkmcnt(5)
    v_cvt_pk_bf16_f32 v153, v192, v193
    v_mul_f32 v202, v170, v202
    v_mul_f32 v203, v170, v203
    v_mfma_f32_16x16x32_bf16 v[194:197], a[248:251], v[130:133], v[194:197]
    s_waitcnt lgkmcnt(4)
    ds_read_b128 v[190:193], v2 offset:6144
    v_cvt_pk_bf16_f32 v184, v202, v203
    v_mul_f32 v204, v170, v204
    v_mfma_f32_16x16x32_bf16 v[194:197], a[252:255], v[134:137], v[194:197]
    s_waitcnt lgkmcnt(3)
    ds_read_b128 v[198:201], v2 offset:7168
    v_mul_f32 v205, v170, v205
    v_cvt_pk_bf16_f32 v185, v204, v205
    v_mfma_f32_16x16x32_bf16 v[194:197], v[82:85], v[154:157], v[194:197]
    s_waitcnt lgkmcnt(2)
    ds_read_b128 v[202:205], v2 offset:8192
    v_fma_f32 v169, v118, v118, s33
    v_fmac_f32 v169, v119, v119
    v_mfma_f32_16x16x32_bf16 v[194:197], v[86:89], v[162:165], v[194:197]
    ds_read_b128 v[206:209], v2 offset:9216
    v_fmac_f32 v169, v120, v120
    v_fmac_f32 v169, v121, v121
    v_mfma_f32_16x16x32_bf16 v[210:213], v[90:93], v[122:125], 0
    ds_read_b128 v[122:125], v2 offset:10240
    v_mul_f32 v183, 0x3baaaaab, v171
    v_rsq_f32 v183, v183
    v_mfma_f32_16x16x32_bf16 v[210:213], v[94:97], v[126:129], v[210:213]
    ds_read_b128 v[126:129], v2 offset:11264
    v_fmac_f32 v169, v194, v194
    v_fmac_f32 v169, v195, v195
    v_mfma_f32_16x16x32_bf16 v[210:213], v[98:101], v[130:133], v[210:213]
    s_waitcnt lgkmcnt(5)
    buffer_store_dwordx4 v[150:153], v15, s[12:15], s27 offen nt
    v_fmac_f32 v169, v196, v196
    v_fmac_f32 v169, v197, v197
    v_mul_f32 v142, v183, v142
    v_mfma_f32_16x16x32_bf16 v[210:213], v[102:105], v[134:137], v[210:213]
    s_waitcnt lgkmcnt(4)
    v_mul_f32 v143, v183, v143
    v_cvt_pk_bf16_f32 v130, v142, v143
    v_mul_f32 v144, v183, v144
    v_mfma_f32_16x16x32_bf16 v[210:213], v[106:109], v[154:157], v[210:213]
    s_waitcnt lgkmcnt(3)
    v_mul_f32 v145, v183, v145
    v_cvt_pk_bf16_f32 v131, v144, v145
    v_mul_f32 v158, v183, v158
    v_mfma_f32_16x16x32_bf16 v[210:213], v[110:113], v[162:165], v[210:213]
    s_waitcnt lgkmcnt(2)
    v_mul_f32 v159, v183, v159
    v_cvt_pk_bf16_f32 v132, v158, v159
    v_mul_f32 v160, v183, v160
    v_mfma_f32_16x16x32_bf16 v[134:137], a[216:219], v[190:193], 0
    s_waitcnt lgkmcnt(1)
    v_mul_f32 v161, v183, v161
    v_cvt_pk_bf16_f32 v133, v160, v161
    v_fmac_f32 v169, v210, v210
    v_mfma_f32_16x16x32_bf16 v[134:137], a[220:223], v[198:201], v[134:137]
    s_waitcnt lgkmcnt(0)
    v_fmac_f32 v169, v211, v211
    v_fmac_f32 v169, v212, v212
    v_fmac_f32 v169, v213, v213
    v_mfma_f32_16x16x32_bf16 v[134:137], a[224:227], v[202:205], v[134:137]
    v_mul_f32 v178, v183, v178
    v_mul_f32 v179, v183, v179
    v_cvt_pk_bf16_f32 v170, v178, v179
    v_mfma_f32_16x16x32_bf16 v[134:137], a[228:231], v[206:209], v[134:137]
    v_mul_f32 v180, v183, v180
    v_mul_f32 v181, v183, v181
    v_cvt_pk_bf16_f32 v171, v180, v181
    v_mfma_f32_16x16x32_bf16 v[134:137], a[232:235], v[122:125], v[134:137]
    v_subrev_u32 v183, 0x3d800000, v44
    v_sub_u32 v142, 0x4a000000, v45
    v_or3_b32 v183, v183, v142, v45
    v_mfma_f32_16x16x32_bf16 v[134:137], a[236:239], v[126:129], v[134:137]
    v_lshl_add_u32 v142, s16, 2, v168
    v_mul_f32 v172, 0x3baaaaab, v172
    v_rsq_f32 v172, v172
    v_mfma_f32_16x16x32_bf16 v[150:153], a[240:243], v[190:193], 0
    ds_write_b32 v142, v183 offset:18432
    v_mul_f32 v146, v172, v146
    v_mfma_f32_16x16x32_bf16 v[150:153], a[244:247], v[198:201], v[150:153]
    v_mul_f32 v147, v172, v147
    v_fma_f32 v183, v134, v134, s33
    v_fmac_f32 v183, v135, v135
    v_mfma_f32_16x16x32_bf16 v[150:153], a[248:251], v[202:205], v[150:153]
    ds_read_b128 v[142:145], v2 offset:12288
    v_fmac_f32 v183, v136, v136
    v_fmac_f32 v183, v137, v137
    v_mfma_f32_16x16x32_bf16 v[150:153], a[252:255], v[206:209], v[150:153]
    ds_read_b128 v[154:157], v2 offset:13312
    v_cvt_pk_bf16_f32 v146, v146, v147
    v_mul_f32 v148, v172, v148
    v_mfma_f32_16x16x32_bf16 v[150:153], v[82:85], v[122:125], v[150:153]
    ds_read_b128 v[158:161], v2 offset:14336
    v_mul_f32 v149, v172, v149
    v_cvt_pk_bf16_f32 v147, v148, v149
    v_mfma_f32_16x16x32_bf16 v[150:153], v[86:89], v[126:129], v[150:153]
    ds_read_b128 v[162:165], v2 offset:15360
    v_mul_f32 v138, v172, v138
    v_mul_f32 v139, v172, v139
    v_mfma_f32_16x16x32_bf16 v[178:181], v[90:93], v[190:193], 0
    ds_read_b128 v[190:193], v2 offset:16384
    v_cvt_pk_bf16_f32 v148, v138, v139
    v_mul_f32 v140, v172, v140
    v_mfma_f32_16x16x32_bf16 v[178:181], v[94:97], v[198:201], v[178:181]
    ds_read_b128 v[198:201], v2 offset:17408
    v_fmac_f32 v183, v150, v150
    v_fmac_f32 v183, v151, v151
    v_mfma_f32_16x16x32_bf16 v[178:181], v[98:101], v[202:205], v[178:181]
    buffer_store_dwordx2 v[184:185], v18, s[12:15], s27 offen nt
    v_fmac_f32 v183, v152, v152
    v_mfma_f32_16x16x32_bf16 v[178:181], v[102:105], v[206:209], v[178:181]
    s_waitcnt lgkmcnt(5)
    v_fmac_f32 v183, v153, v153
    v_mul_f32 v141, v172, v141
    v_cvt_pk_bf16_f32 v149, v140, v141
    v_mfma_f32_16x16x32_bf16 v[178:181], v[106:109], v[122:125], v[178:181]
    s_waitcnt lgkmcnt(4)
    ds_write_b128 v114, v[146:149] offset:3072
    v_mfma_f32_16x16x32_bf16 v[178:181], v[110:113], v[126:129], v[178:181]
    s_waitcnt lgkmcnt(3)
    v_mul_f32 v186, v172, v186
    v_mul_f32 v187, v172, v187
    v_cvt_pk_bf16_f32 v184, v186, v187
    v_mfma_f32_16x16x32_bf16 v[122:125], a[216:219], v[142:145], 0
    s_waitcnt lgkmcnt(2)
    v_mul_f32 v188, v172, v188
    v_mul_f32 v189, v172, v189
    v_fmac_f32 v183, v178, v178
    v_mfma_f32_16x16x32_bf16 v[122:125], a[220:223], v[154:157], v[122:125]
    s_waitcnt lgkmcnt(1)
    ds_read_b128 v[126:129], v116 offset:3072
    v_fmac_f32 v183, v179, v179
    v_fmac_f32 v183, v180, v180
    v_mfma_f32_16x16x32_bf16 v[122:125], a[224:227], v[158:161], v[122:125]
    v_fmac_f32 v183, v181, v181
    v_cvt_pk_bf16_f32 v186, v169, v183
    v_cvt_pk_bf16_f32 v187, v183, v183
    v_mfma_f32_16x16x32_bf16 v[122:125], a[228:231], v[162:165], v[122:125]
    ds_write_b64 v4, v[186:187] offset:0
    v_mfma_f32_16x16x32_bf16 v[122:125], a[232:235], v[190:193], v[122:125]
    v_cvt_pk_bf16_f32 v185, v188, v189
    v_mov_b32 v172, 0x40000000
    v_lshrrev_b32 v169, 2, v254
    v_mfma_f32_16x16x32_bf16 v[122:125], a[236:239], v[198:201], v[122:125]
    ds_write_b64 v115, v[184:185] offset:4096
    v_mfma_f32_16x16x32_bf16 v[138:141], a[240:243], v[142:145], 0
    v_lshrrev_b32 v183, 3, v254
    v_xor_b32 v183, v183, v254
    v_and_b32 v183, 3, v183
    v_mfma_f32_16x16x32_bf16 v[138:141], a[244:247], v[154:157], v[138:141]
    ds_read_b64 v[184:185], v117 offset:4096
    v_add_u32 v169, 0, v169
    v_fma_f32 v254, v122, v122, s33
    v_mfma_f32_16x16x32_bf16 v[138:141], a[248:251], v[158:161], v[138:141]
    s_waitcnt lgkmcnt(3)
    ds_read_b128 v[146:149], v167 offset:0
    v_fmac_f32 v254, v123, v123
    v_fmac_f32 v254, v124, v124
    v_mfma_f32_16x16x32_bf16 v[138:141], a[252:255], v[162:165], v[138:141]
    ds_read_b128 v[186:189], v167 offset:2048
    v_fmac_f32 v254, v125, v125
    v_mul_u32_u24 v202, s20, v169
    v_mfma_f32_16x16x32_bf16 v[138:141], v[82:85], v[190:193], v[138:141]
    s_waitcnt lgkmcnt(4)
    ds_read_b128 v[206:209], v167 offset:4096
    v_add_u32 v202, s38, v202
    v_mul_u32_u24 v202, 911, v202
    v_mfma_f32_16x16x32_bf16 v[138:141], v[86:89], v[198:201], v[138:141]
    s_barrier
    ds_read_b128 v[214:217], v168 offset:0
    ds_read_b128 v[218:221], v168 offset:1024
    v_lshrrev_b32 v202, 16, v202
    v_mfma_f32_16x16x32_bf16 v[222:225], v[90:93], v[142:145], 0
    ds_read_b128 v[142:145], v167 offset:6144
    ds_read_b128 v[226:229], v167 offset:8192
    v_mul_u32_u24 v202, s22, v202
    v_mfma_f32_16x16x32_bf16 v[222:225], v[94:97], v[154:157], v[222:225]
    ds_read_b128 v[154:157], v167 offset:10240
    v_fmac_f32 v254, v138, v138
    v_fmac_f32 v254, v139, v139
    v_mfma_f32_16x16x32_bf16 v[222:225], v[98:101], v[158:161], v[222:225]
    s_waitcnt lgkmcnt(8)
    buffer_store_dwordx4 v[130:133], v16, s[12:15], s27 offen nt
    ds_read_b128 v[158:161], v168 offset:18432
    v_fmac_f32 v254, v140, v140
    v_fmac_f32 v254, v141, v141
    v_mfma_f32_16x16x32_bf16 v[222:225], v[102:105], v[162:165], v[222:225]
    s_waitcnt lgkmcnt(7)
    v_mad_u32_u24 v202, v169, s21, v202
    v_cmp_gt_u32 vcc, s17, v169
    v_add_u32 v169, s7, v202
    v_mfma_f32_16x16x32_bf16 v[222:225], v[106:109], v[190:193], v[222:225]
    s_waitcnt lgkmcnt(6)
    v_cndmask_b32 v169, v172, v169, vcc
    v_lshl_add_u32 v130, v183, 4, v169
    v_add_u32 v130, s3, v130
    v_mfma_f32_16x16x32_bf16 v[222:225], v[110:113], v[198:201], v[222:225]
    s_waitcnt lgkmcnt(4)
    v_lshl_add_u32 v183, v183, 3, v169
    v_add_u32 v183, s4, v183
    v_mfma_f32_16x16x32_bf16 v[162:165], v[32:35], v[214:217], 0
    s_waitcnt lgkmcnt(3)
    v_add_u32 v166, 16, v166
    v_mul_u32_u24 v169, s20, v166
    v_mfma_f32_16x16x32_bf16 v[162:165], v[32:35], v[218:221], v[162:165]
    s_waitcnt lgkmcnt(2)
    v_fmac_f32 v254, v222, v222
    v_fmac_f32 v254, v223, v223
    v_fmac_f32 v254, v224, v224
    v_mfma_f32_16x16x32_bf16 v[190:193], a[216:219], v[146:149], 0
    s_waitcnt lgkmcnt(1)
    v_fmac_f32 v254, v225, v225
    v_cvt_pk_bf16_f32 v132, v254, v254
    v_cvt_pk_bf16_f32 v133, v254, v254
    v_mfma_f32_16x16x32_bf16 v[190:193], a[220:223], v[186:189], v[190:193]
    s_waitcnt lgkmcnt(0)
    ds_write_b64 v4, v[132:133] offset:2048
    v_mfma_f32_16x16x32_bf16 v[190:193], a[224:227], v[206:209], v[190:193]
    v_add_u32 v169, s38, v169
    v_mul_u32_u24 v254, 911, v169
    v_lshrrev_b32 v254, 16, v254
    v_mfma_f32_16x16x32_bf16 v[190:193], a[228:231], v[142:145], v[190:193]
    v_mul_u32_u24 v254, s22, v254
    v_mad_u32_u24 v254, v166, s21, v254
    v_cmp_gt_u32 vcc, s17, v166
    v_mfma_f32_16x16x32_bf16 v[190:193], a[232:235], v[226:229], v[190:193]
    v_add_u32 v254, s7, v254
    v_cndmask_b32 v254, v172, v254, vcc
    v_lshl_add_u32 v131, v255, 4, v254
    v_mfma_f32_16x16x32_bf16 v[190:193], a[236:239], v[154:157], v[190:193]
    v_add_u32 v131, s3, v131
    v_lshl_add_u32 v254, v255, 3, v254
    v_add_u32 v254, s4, v254
    v_mfma_f32_16x16x32_bf16 v[198:201], a[240:243], v[146:149], 0
    v_mul_f32 v255, 0x3baaaaab, v162
    v_mul_f32 v132, 0x3baaaaab, v163
    v_rsq_f32 v255, v255
    v_mfma_f32_16x16x32_bf16 v[198:201], a[244:247], v[186:189], v[198:201]
    buffer_store_dwordx2 v[170:171], v19, s[12:15], s27 offen nt
    v_fma_f32 v133, v190, v190, s33
    v_mfma_f32_16x16x32_bf16 v[198:201], a[248:251], v[206:209], v[198:201]
    ds_read_b128 v[162:165], v167 offset:256
    v_fmac_f32 v133, v191, v191
    v_fmac_f32 v133, v192, v192
    v_mfma_f32_16x16x32_bf16 v[198:201], a[252:255], v[142:145], v[198:201]
    ds_read_b128 v[202:205], v167 offset:2304
    v_fmac_f32 v133, v193, v193
    v_mul_f32 v118, v255, v118
    v_mfma_f32_16x16x32_bf16 v[198:201], v[82:85], v[226:229], v[198:201]
    ds_read_b128 v[214:217], v167 offset:4352
    v_mul_f32 v119, v255, v119
    v_cvt_pk_bf16_f32 v118, v118, v119
    v_mfma_f32_16x16x32_bf16 v[198:201], v[86:89], v[154:157], v[198:201]
    ds_read_b128 v[218:221], v167 offset:6400
    v_mul_f32 v120, v255, v120
    v_mul_f32 v121, v255, v121
    v_mfma_f32_16x16x32_bf16 v[230:233], v[90:93], v[146:149], 0
    ds_read_b128 v[146:149], v167 offset:8448
    v_cvt_pk_bf16_f32 v119, v120, v121
    v_mul_f32 v194, v255, v194
    v_mfma_f32_16x16x32_bf16 v[230:233], v[94:97], v[186:189], v[230:233]
    ds_read_b128 v[186:189], v167 offset:10496
    v_fmac_f32 v133, v198, v198
    v_fmac_f32 v133, v199, v199
    v_mfma_f32_16x16x32_bf16 v[230:233], v[98:101], v[206:209], v[230:233]
    v_fmac_f32 v133, v200, v200
    v_fmac_f32 v133, v201, v201
    v_mul_f32 v195, v255, v195
    v_mfma_f32_16x16x32_bf16 v[230:233], v[102:105], v[142:145], v[230:233]
    s_waitcnt lgkmcnt(5)
    v_cvt_pk_bf16_f32 v120, v194, v195
    v_mul_f32 v196, v255, v196
    v_mul_f32 v197, v255, v197
    v_mfma_f32_16x16x32_bf16 v[230:233], v[106:109], v[226:229], v[230:233]
    s_waitcnt lgkmcnt(4)
    v_cvt_pk_bf16_f32 v121, v196, v197
    v_mul_f32 v210, v255, v210
    v_mul_f32 v211, v255, v211
    v_mfma_f32_16x16x32_bf16 v[230:233], v[110:113], v[154:157], v[230:233]
    s_waitcnt lgkmcnt(3)
    ds_write_b128 v114, v[118:121] offset:4608
    v_mfma_f32_16x16x32_bf16 v[118:121], a[216:219], v[162:165], 0
    s_waitcnt lgkmcnt(2)
    v_cvt_pk_bf16_f32 v210, v210, v211
    v_mul_f32 v212, v255, v212
    v_mul_f32 v213, v255, v213
    v_mfma_f32_16x16x32_bf16 v[118:121], a[220:223], v[202:205], v[118:121]
    s_waitcnt lgkmcnt(1)
    v_fmac_f32 v133, v230, v230
    v_fmac_f32 v133, v231, v231
    v_fmac_f32 v133, v232, v232
    v_mfma_f32_16x16x32_bf16 v[118:121], a[224:227], v[214:217], v[118:121]
    buffer_store_dwordx4 v[126:129], v177, s[12:15], s27 offen nt
    ds_read_b128 v[142:145], v116 offset:4608
    v_fmac_f32 v133, v233, v233
    v_cvt_pk_bf16_f32 v166, v133, v133
    v_mfma_f32_16x16x32_bf16 v[118:121], a[228:231], v[218:221], v[118:121]
    v_cvt_pk_bf16_f32 v167, v133, v133
    v_cvt_pk_bf16_f32 v211, v212, v213
    v_rsq_f32 v132, v132
    v_mfma_f32_16x16x32_bf16 v[118:121], a[232:235], v[146:149], v[118:121]
    ds_write_b64 v4, v[166:167] offset:4096
    v_mfma_f32_16x16x32_bf16 v[118:121], a[236:239], v[186:189], v[118:121]
    v_mul_f32 v134, v132, v134
    v_mul_f32 v135, v132, v135
    v_cvt_pk_bf16_f32 v126, v134, v135
    v_mfma_f32_16x16x32_bf16 v[154:157], a[240:243], v[162:165], 0
    buffer_store_dwordx2 v[184:185], v182, s[12:15], s27 offen nt
    v_mul_f32 v136, v132, v136
    v_mfma_f32_16x16x32_bf16 v[154:157], a[244:247], v[202:205], v[154:157]
    s_mov_b32 s14, s36
    ds_write_b64 v115, v[210:211] offset:5632
    v_mfma_f32_16x16x32_bf16 v[154:157], a[248:251], v[214:217], v[154:157]
    s_waitcnt lgkmcnt(2)
    v_fma_f32 v255, v118, v118, s33
    v_fmac_f32 v255, v119, v119
    v_fmac_f32 v255, v120, v120
    v_mfma_f32_16x16x32_bf16 v[154:157], a[252:255], v[218:221], v[154:157]
    ds_read_b64 v[184:185], v117 offset:5632
    v_fmac_f32 v255, v121, v121
    v_mul_f32 v137, v132, v137
    v_mfma_f32_16x16x32_bf16 v[154:157], v[82:85], v[146:149], v[154:157]
    buffer_store_dwordx4 v[142:145], v173, s[12:15], s26 offen nt
    v_cvt_pk_bf16_f32 v127, v136, v137
    v_mul_f32 v150, v132, v150
    v_mul_f32 v151, v132, v151
    v_mfma_f32_16x16x32_bf16 v[154:157], v[86:89], v[186:189], v[154:157]
    s_waitcnt lgkmcnt(2)
    v_cvt_pk_bf16_f32 v128, v150, v151
    v_mul_f32 v152, v132, v152
    v_mul_f32 v153, v132, v153
    v_mfma_f32_16x16x32_bf16 v[134:137], v[90:93], v[162:165], 0
    s_barrier
    ds_read_b128 v[142:145], v168 offset:2048
    ds_read_b128 v[162:165], v168 offset:3072
    v_fmac_f32 v255, v154, v154
    v_mfma_f32_16x16x32_bf16 v[134:137], v[94:97], v[202:205], v[134:137]
    ds_read_b128 v[170:173], v168 offset:4096
    ds_read_b128 v[194:197], v168 offset:5120
    v_fmac_f32 v255, v155, v155
    v_mfma_f32_16x16x32_bf16 v[134:137], v[98:101], v[214:217], v[134:137]
    v_fmac_f32 v255, v156, v156
    v_fmac_f32 v255, v157, v157
    v_cvt_pk_bf16_f32 v129, v152, v153
    v_mfma_f32_16x16x32_bf16 v[134:137], v[102:105], v[218:221], v[134:137]
    s_waitcnt lgkmcnt(4)
    buffer_store_dwordx2 v[184:185], v174, s[12:15], s26 offen nt
    v_mul_f32 v178, v132, v178
    v_mfma_f32_16x16x32_bf16 v[134:137], v[106:109], v[146:149], v[134:137]
    ds_write_b128 v114, v[126:129] offset:6144
    v_mfma_f32_16x16x32_bf16 v[134:137], v[110:113], v[186:189], v[134:137]
    v_mul_f32 v179, v132, v179
    v_cvt_pk_bf16_f32 v184, v178, v179
    v_mul_f32 v180, v132, v180
    s_waitcnt lgkmcnt(4)
    v_mfma_f32_16x16x32_bf16 v[126:129], v[32:35], v[142:145], 0
    s_waitcnt lgkmcnt(3)
    v_mul_f32 v181, v132, v181
    v_cvt_pk_bf16_f32 v185, v180, v181
    v_mfma_f32_16x16x32_bf16 v[126:129], v[32:35], v[162:165], v[126:129]
    s_waitcnt lgkmcnt(1)
    ds_read_b128 v[142:145], v116 offset:6144
    v_fmac_f32 v255, v134, v134
    v_mfma_f32_16x16x32_bf16 v[146:149], v[32:35], v[170:173], 0
    ds_write_b64 v115, v[184:185] offset:7168
    v_mfma_f32_16x16x32_bf16 v[146:149], v[32:35], v[194:197], v[146:149]
    v_fmac_f32 v255, v135, v135
    v_fmac_f32 v255, v136, v136
    v_fmac_f32 v255, v137, v137
    v_cvt_pk_bf16_f32 v132, v255, v255
    v_cvt_pk_bf16_f32 v133, v255, v255
    ds_write_b64 v4, v[132:133] offset:6144
    v_mul_f32 v255, 0x3baaaaab, v126
    v_rsq_f32 v255, v255
    ds_read_b64 v[132:133], v117 offset:7168
    v_mul_f32 v122, v255, v122
    v_mul_f32 v123, v255, v123
    v_cvt_pk_bf16_f32 v122, v122, v123
    v_mul_f32 v124, v255, v124
    v_mul_f32 v125, v255, v125
    s_waitcnt lgkmcnt(3)
    buffer_store_dwordx4 v[142:145], v175, s[12:15], s26 offen nt
    v_cvt_pk_bf16_f32 v123, v124, v125
    v_mul_f32 v138, v255, v138
    v_mul_f32 v139, v255, v139
    v_cvt_pk_bf16_f32 v124, v138, v139
    v_mul_f32 v140, v255, v140
    v_mul_f32 v141, v255, v141
    v_cvt_pk_bf16_f32 v125, v140, v141
    ds_write_b128 v114, v[122:125] offset:0
    s_waitcnt lgkmcnt(2)
    s_barrier
    v_mul_f32 v222, v255, v222
    v_mul_f32 v223, v255, v223
    v_cvt_pk_bf16_f32 v184, v222, v223
    v_mul_f32 v224, v255, v224
    s_waitcnt lgkmcnt(1)
    ds_read_b128 v[122:125], v168 offset:6144
    ds_read_b128 v[126:129], v168 offset:7168
    buffer_store_dwordx2 v[132:133], v176, s[12:15], s26 offen nt
    ds_read_b128 v[138:141], v116 offset:0
    v_mul_f32 v225, v255, v225
    v_cvt_pk_bf16_f32 v185, v224, v225
    ds_write_b64 v115, v[184:185] offset:1024
    v_mul_f32 v255, 0x3baaaaab, v146
    v_rsq_f32 v255, v255
    ds_read_b64 v[132:133], v117 offset:1024
    v_mul_f32 v190, v255, v190
    v_mul_f32 v191, v255, v191
    v_cvt_pk_bf16_f32 v142, v190, v191
    v_mul_f32 v192, v255, v192
    v_mul_f32 v193, v255, v193
    v_cvt_pk_bf16_f32 v143, v192, v193
    v_mul_f32 v198, v255, v198
    v_mul_f32 v199, v255, v199
    v_cvt_pk_bf16_f32 v144, v198, v199
    v_mul_f32 v200, v255, v200
    v_mul_f32 v201, v255, v201
    v_cvt_pk_bf16_f32 v145, v200, v201
    s_waitcnt lgkmcnt(4)
    v_mfma_f32_16x16x32_bf16 v[146:149], v[32:35], v[122:125], 0
    s_waitcnt lgkmcnt(3)
    ds_write_b128 v114, v[142:145] offset:1536
    v_mfma_f32_16x16x32_bf16 v[146:149], v[32:35], v[126:129], v[146:149]
    s_waitcnt lgkmcnt(2)
    buffer_store_dwordx4 v[138:141], v177, s[12:15], s26 offen nt
    v_mul_f32 v230, v255, v230
    v_mul_f32 v231, v255, v231
    v_cvt_pk_bf16_f32 v184, v230, v231
    ds_read_b128 v[122:125], v116 offset:1536
    s_waitcnt lgkmcnt(2)
    v_mul_f32 v232, v255, v232
    v_mul_f32 v233, v255, v233
    v_cvt_pk_bf16_f32 v185, v232, v233
    ds_write_b64 v115, v[184:185] offset:2560
    v_mul_f32 v255, 0x3baaaaab, v146
    buffer_store_dwordx2 v[132:133], v182, s[12:15], s26 offen nt
    ds_read_b64 v[184:185], v117 offset:2560
    v_rsq_f32 v255, v255
    v_or3_b32 v158, v158, v159, v160
    v_mul_f32 v118, v255, v118
    v_mul_f32 v119, v255, v119
    v_cvt_pk_bf16_f32 v114, v118, v119
    v_mul_f32 v120, v255, v120
    v_mul_f32 v121, v255, v121
    v_cvt_pk_bf16_f32 v115, v120, v121
    v_mul_f32 v154, v255, v154
    v_mul_f32 v155, v255, v155
    v_cvt_pk_bf16_f32 v116, v154, v155
    v_mul_f32 v156, v255, v156
    v_mul_f32 v157, v255, v157
    s_waitcnt lgkmcnt(2)
    buffer_store_dwordx4 v[122:125], v130, s[12:15], 0 offen nt
    v_cvt_pk_bf16_f32 v117, v156, v157
    v_mul_f32 v134, v255, v134
    v_mul_f32 v135, v255, v135
    v_cvt_pk_bf16_f32 v132, v134, v135
    v_mul_f32 v136, v255, v136
    v_mul_f32 v137, v255, v137
    v_cvt_pk_bf16_f32 v133, v136, v137
    v_or_b32 v158, v158, v161
    v_cmp_gt_i32 s[46:47], 0, v158
    s_waitcnt lgkmcnt(0)
    buffer_store_dwordx2 v[184:185], v183, s[12:15], 0 offen nt
    buffer_store_dwordx4 v[114:117], v131, s[12:15], 0 offen nt
    buffer_store_dwordx2 v[132:133], v254, s[12:15], 0 offen nt
    s_branch L_end
.section .rodata,"a"
.p2align 6
.amdhsa_kernel standalone__window_attn_swin_v2__vision_kernel
  .amdhsa_next_free_vgpr 512
  .amdhsa_next_free_sgpr 102
  .amdhsa_accum_offset 256
  .amdhsa_group_segment_fixed_size 0
  .amdhsa_kernarg_size 96
  .amdhsa_user_sgpr_count 2
  .amdhsa_user_sgpr_kernarg_segment_ptr 1
  .amdhsa_system_sgpr_workgroup_id_x 1
  .amdhsa_float_denorm_mode_32 3
.end_amdhsa_kernel
```

```asm
; @launch grid=(256,1,1) block=(256,1,1) lds=163840
.amdgcn_target "amdgcn-amd-amdhsa--gfx950"
.text
.globl standalone__window_attn_swin_v2__vision_kernel
.p2align 12
.p2align 8
.type standalone__window_attn_swin_v2__vision_kernel,@function
standalone__window_attn_swin_v2__vision_kernel:
    s_mov_b32 s44, 0
L_again:
    s_load_dwordx16 s[76:91], s[0:1], 0
    v_readfirstlane_b32 s16, v0
    s_cmp_ge_u32 s2, 256
    s_cbranch_scc1 L_done
    s_lshr_b32 s16, s16, 6
    s_cbranch_scc1 L_nopf
    s_getpc_b64 s[96:97]
    s_bfe_u32 s3, s2, 0x30003
    s_mul_i32 s3, s3, 44
    v_cmp_gt_u32 vcc, 20, v0
    v_add_u32 v128, s3, v0
    v_mov_b32 v129, 0
    v_cndmask_b32 v128, v128, v0, vcc
    v_lshlrev_b32 v128, 7, v128
    v_lshl_add_u64 v[128:129], s[96:97], 0, v[128:129]
    global_load_dword a255, v[128:129], off offset:992
L_nopf:
    s_max_u32 s3, s2, s44
    s_cmp_ge_u32 s3, 247
    s_cbranch_scc1 L_edge
    v_mov_b32 v128, v0
    v_mov_b32 v129, 0x40000000
    v_and_b32 v130, 63, v0
    s_bfe_u32 s3, s2, 0x50003
    s_lshl_b32 s4, s16, 3
    s_lshr_b32 s98, 0x06143a01, s4
    s_and_b32 s98, s98, 0xff
    s_mul_i32 s3, s3, s98
    s_sub_u32 s98, s98, 1
    s_lshr_b32 s4, 0x0048d800, s4
    s_and_b32 s4, s4, 0xff
    s_lshl_b32 s4, s4, 3
    s_max_u32 s4, s4, 6
    s_sub_u32 s4, s4, s98
    s_sub_u32 s4, s4, 1
    s_min_u32 s3, s3, s4
    v_min_u32 v132, s98, v130
    v_add_lshl_u32 v132, v132, s3, 7
    v_mov_b32 v133, 0
    v_lshrrev_b32 v131, 4, v130
    v_and_b32 v134, 15, v130
    s_mov_b32 s10, 100270464
    s_mov_b32 s11, 0x00020000
    s_mov_b32 s50, 36096
    s_mov_b32 s51, 0x00020000
    s_mul_i32 s3, s16, 96
    v_lshl_add_u32 v135, v130, 4, s3
    v_mul_u32_u24 v148, 171, v130
    v_lshrrev_b32 v148, 10, v148
    v_lshrrev_b32 v149, 1, v148
    v_xor_b32 v149, v149, v148
    v_and_b32 v149, 4, v149
    v_mul_u32_u24 v149, 3, v149
    v_xor_b32 v149, v149, v148
    v_mul_u32_u24 v149, 1152, v149
    v_mul_u32_u24 v150, 96, v148
    v_sub_u32 v149, v149, v150
    v_add_u32 v150, v135, v149
    v_add_u32 v149, 64, v130
    v_mul_u32_u24 v149, 171, v149
    v_lshrrev_b32 v149, 10, v149
    v_lshrrev_b32 v151, 1, v149
    v_xor_b32 v151, v151, v149
    v_and_b32 v151, 4, v151
    v_mul_u32_u24 v151, 3, v151
    v_xor_b32 v151, v151, v149
    v_mul_u32_u24 v151, 1152, v151
    v_mul_u32_u24 v164, 96, v149
    v_sub_u32 v151, v151, v164
    v_add_u32 v164, v135, v151
    v_add_u32 v151, 128, v130
    v_mul_u32_u24 v151, 171, v151
    v_lshrrev_b32 v151, 10, v151
    v_lshrrev_b32 v165, 1, v151
    v_xor_b32 v165, v165, v151
    v_and_b32 v165, 4, v165
    v_mul_u32_u24 v165, 3, v165
    v_xor_b32 v165, v165, v151
    v_mul_u32_u24 v165, 1152, v165
    v_mul_u32_u24 v166, 96, v151
    v_sub_u32 v165, v165, v166
    v_add_u32 v166, v135, v165
    s_mul_i32 s68, s16, 6144
    s_add_u32 s69, s68, 65536
    s_cmp_eq_u32 s16, 3
    s_cselect_b32 s68, 149696, s68
    s_cselect_b32 s69, 155840, s69
    s_waitcnt lgkmcnt(0)
    s_cmp_eq_u32 s16, 2
    s_cselect_b64 s[98:99], s[80:81], s[78:79]
    s_cmp_eq_u32 s16, 3
    s_cselect_b64 s[98:99], s[88:89], s[98:99]
    s_mov_b64 s[8:9], s[76:77]
    v_lshl_add_u64 v[132:133], s[98:99], 0, v[132:133]
    s_cmp_eq_u32 s16, 2
    s_cselect_b64 s[98:99], s[84:85], s[82:83]
    s_cmp_eq_u32 s16, 3
    s_cselect_b64 s[98:99], s[86:87], s[98:99]
    v_writelane_b32 v132, s98, 63
    v_writelane_b32 v133, s99, 63
    s_cmp_eq_u32 s16, 0
    s_cbranch_scc1 L_nowu
    global_load_dword a254, v[132:133], off
L_nowu:
    s_mov_b64 s[48:49], s[78:79]
    s_mov_b64 s[52:53], s[80:81]
    s_mov_b64 s[60:61], s[84:85]
    s_mov_b64 s[64:65], s[86:87]
    s_mov_b64 s[56:57], s[88:89]
    s_mov_b64 s[46:47], s[82:83]
    s_load_dwordx4 s[40:43], s[0:1], 72
    s_add_u32 s48, s48, 384
    s_addc_u32 s49, s49, 0
    s_add_u32 m0, s68, 0
    v_add_u32 v165, s16, v130
    v_and_b32 v165, 3, v165
    v_lshlrev_b32 v165, 1, v165
    s_mov_b32 s54, 12288
    s_mov_b32 s55, 0x00020000
    s_mov_b32 s62, 64
    s_mov_b32 s63, 0x00020000
    s_mov_b32 s66, 128
    s_mov_b32 s67, 0x00020000
    s_mov_b32 s58, 676
    s_mov_b32 s59, 0x00020000
    s_mov_b32 s14, 0
    s_mov_b32 s15, 0x00020000
    v_mov_b32 v133, 0
    v_cmp_lt_u32 s[92:93], 7, v134
    v_mov_b32 v135, 0
    v_mov_b32 v119, 0
    v_mov_b32 v117, 0
    v_lshlrev_b32 v167, 1, v130
    v_mul_u32_u24 v116, 12, v134
    s_mul_i32 s71, s16, 192
    v_add_u32 v116, s71, v116
    v_lshlrev_b32 v120, 5, v131
    s_mul_i32 s72, s16, 9408
    s_add_u32 s72, s72, 104448
    s_mul_i32 s73, s16, 7616
    s_add_u32 s73, s73, 38912
    s_cmp_eq_u32 s16, 3
    s_cselect_b32 s73, 142080, s73
    s_mov_b32 s70, 193536
    s_mov_b32 s36, 100270464
    s_mov_b32 s22, 1180032
    s_mul_i32 s3, s2, 911
    s_lshr_b32 s3, s3, 16
    s_mul_i32 s35, s3, 72
    s_sub_u32 s38, s2, s35
    s_mul_i32 s3, s3, 1373568
    s_mul_i32 s35, s38, 2688
    s_add_u32 s3, s3, s35
    s_add_u32 s25, s3, 589824
    s_add_u32 s7, s3, 1769472
    s_mov_b32 s20, 31
    s_mov_b32 s21, 4204032
    s_mov_b32 s17, 20
    s_cmp_lt_u32 s2, 240
    s_cselect_b32 s45, 28, 24
    s_bfm_b32 s34, s45, 0
    s_and_b32 s4, s2, 7
    s_sub_u32 s4, 0, s4
    s_lshl_b32 s28, s16, 10
    s_add_u32 s28, s28, 20480
    buffer_load_dwordx4 v150, s[48:51], 0 offen lds
    v_mul_u32_u24 v118, 2731, v128
    v_bfe_u32 v121, v118, 17, 3
    v_lshrrev_b32 v118, 16, v118
    s_mov_b32 s76, 0x3f80
    s_mov_b32 s19, s38
    buffer_load_dwordx4 v164, s[48:51], 0 offen offset:1024 lds
    v_xor_b32 v132, v121, v128
    v_mul_u32_u24 v121, 37, v118
    v_lshrrev_b32 v121, 8, v121
    s_mov_b32 s23, s25
    s_mov_b32 s26, 0
    buffer_load_dwordx4 v166, s[48:51], 0 offen offset:2048 lds
    s_add_u32 m0, s28, 65536
    s_add_u32 s48, s48, 36864
    s_addc_u32 s49, s49, 0
    v_lshlrev_b32 v132, 4, v132
    v_mad_u32_u24 v10, v121, s70, v132
    v_mul_u32_u24 v121, s20, v118
    v_add_u32 v121, s38, v121
    v_mul_u32_u24 v122, 911, v121
    v_lshrrev_b32 v122, 16, v122
    v_mul_u32_u24 v122, s22, v122
    v_mad_u32_u24 v122, v118, s21, v122
    v_bfe_u32 v121, s34, v118, 1
    v_cmp_ne_u32 vcc, 0, v121
    v_add_u32 v121, s7, v122
    v_mul_u32_u24 v118, 384, v118
    v_cndmask_b32 v121, v129, v121, vcc
    v_sub_u32 v118, v132, v118
    v_add_u32 v121, v121, v118
    s_mov_b32 s27, 0
    s_mov_b32 s18, 0
    buffer_load_dwordx4 v121, s[8:11], 0 offen nt lds
    s_add_u32 m0, s28, 69632
    v_add_u32 v132, 256, v128
    v_mul_u32_u24 v121, 2731, v132
    v_bfe_u32 v118, v121, 17, 3
    v_lshrrev_b32 v121, 16, v121
    v_xor_b32 v132, v118, v132
    v_mul_u32_u24 v118, 37, v121
    v_lshrrev_b32 v118, 8, v118
    v_lshlrev_b32 v132, 4, v132
    v_mad_u32_u24 v11, v118, s70, v132
    v_min_u32 v124, 20, v121
    v_add_u32 v118, 12, v121
    v_lshrrev_b32 v118, 5, v118
    v_sub_u32 v122, v121, v124
    v_mad_i32_i24 v122, v118, s4, v122
    v_mul_u32_u24 v123, s20, v124
    v_add3_u32 v123, v123, v122, s38
    v_mul_u32_u24 v118, 911, v123
    v_lshrrev_b32 v118, 16, v118
    v_mul_u32_u24 v118, s22, v118
    v_mad_u32_u24 v118, v124, s21, v118
    v_bfe_u32 v123, s34, v121, 1
    v_cmp_ne_u32 vcc, 0, v123
    v_mul_i32_i24 v122, 2688, v122
    v_add3_u32 v122, v118, v122, s7
    v_cndmask_b32 v122, v129, v122, vcc
    v_mul_u32_u24 v118, 384, v121
    v_sub_u32 v118, v132, v118
    v_add_u32 v122, v122, v118
    s_add_u32 s19, s19, s20
    s_add_u32 s23, s23, s21
    buffer_load_dwordx4 v122, s[8:11], 0 offen lds
    s_add_u32 m0, s28, 73728
    v_add_u32 v132, 512, v128
    v_mul_u32_u24 v121, 2731, v132
    v_bfe_u32 v118, v121, 17, 3
    v_lshrrev_b32 v121, 16, v121
    v_xor_b32 v132, v118, v132
    v_mul_u32_u24 v118, 37, v121
    v_lshrrev_b32 v118, 8, v118
    v_lshlrev_b32 v132, 4, v132
    v_mad_u32_u24 v12, v118, s70, v132
    v_min_u32 v124, 20, v121
    v_add_u32 v118, 12, v121
    v_lshrrev_b32 v118, 5, v118
    v_sub_u32 v122, v121, v124
    v_mad_i32_i24 v122, v118, s4, v122
    v_mul_u32_u24 v123, s20, v124
    v_add3_u32 v123, v123, v122, s38
    v_mul_u32_u24 v118, 911, v123
    v_lshrrev_b32 v118, 16, v118
    v_mul_u32_u24 v118, s22, v118
    v_mad_u32_u24 v118, v124, s21, v118
    v_bfe_u32 v123, s34, v121, 1
    v_cmp_ne_u32 vcc, 0, v123
    v_mul_i32_i24 v122, 2688, v122
    v_add3_u32 v122, v118, v122, s7
    v_cndmask_b32 v122, v129, v122, vcc
    v_mul_u32_u24 v118, 384, v121
    v_sub_u32 v118, v132, v118
    v_add_u32 v122, v122, v118
    s_cmp_ge_u32 s19, 72
    s_cselect_b32 s34, 72, 0
    buffer_load_dwordx4 v122, s[8:11], 0 offen lds
    v_lshrrev_b32 v122, 2, v134
    v_and_b32 v121, 1, v122
    v_mul_u32_u24 v121, 0x020202, v121
    v_lshl_or_b32 v121, v121, 8, v121
    v_add_u32 v121, 0x05040100, v121
    v_and_b32 v118, 3, v134
    v_lshrrev_b32 v123, 1, v134
    v_xor_b32 v123, v123, v131
    v_mul_u32_u24 v132, 384, v134
    v_lshl_add_u32 v0, v123, 4, v132
    v_xor_b32 v1, 64, v0
    v_and_b32 v123, 2, v131
    v_add_u32 v123, v123, v131
    v_lshl_add_u32 v123, v123, 2, v122
    v_mul_u32_u24 v123, 96, v123
    v_lshl_add_u32 v123, v118, 3, v123
    v_add_u32 v136, s68, v123
    v_add_u32 v137, s69, v123
    v_add_u32 v124, s72, v123
    v_add_u32 v138, s73, v123
    v_mov_b32 v28, 0x3f803f80
    v_mov_b32 v29, 0x3f803f80
    v_mov_b32 v30, 0x3f803f80
    v_mov_b32 v31, 0x3f803f80
    v_mul_u32_u24 v123, 768, v131
    v_add_u32 v123, v116, v123
    v_add_u32 v123, 98304, v123
    v_and_b32 v132, 1, v134
    v_lshlrev_b32 v132, 4, v132
    v_lshlrev_b32 v125, v132, s76
    v_mov_b32 v139, 0x3c003c00
    v_mov_b32 v44, 1.0
    v_mov_b32 v45, 1.0
    v_lshlrev_b32 v144, 4, v131
    s_cselect_b32 s35, s22, 0
    s_add_u32 m0, s28, 0
    s_sub_u32 s19, s19, s34
    buffer_load_dwordx4 v10, s[8:11], s25 offen nt lds
    s_add_u32 m0, s28, 4096
    s_add_u32 s23, s23, s35
    s_mov_b32 s24, s23
    s_add_u32 s19, s19, s20
    s_add_u32 s23, s23, s21
    s_cmp_ge_u32 s19, 72
    s_cselect_b32 s34, 72, 0
    s_cselect_b32 s35, s22, 0
    s_sub_u32 s19, s19, s34
    s_add_u32 s23, s23, s35
    s_mul_i32 s79, s16, 64
    v_lshl_add_u32 v146, v131, 4, s79
    s_mul_i32 s80, s16, 32
    s_add_u32 s80, s80, 256
    v_lshl_add_u32 v127, v131, 3, s80
    v_add_u32 v147, 0, v134
    v_mul_u32_u24 v145, 37, v147
    v_mul_u32_u24 v126, 384, v147
    v_lshrrev_b32 v145, 8, v145
    v_mad_u32_u24 v126, v145, s70, v126
    v_add_u32 v15, v126, v146
    v_add_u32 v18, v126, v127
    v_add_u32 v142, 16, v134
    v_mul_u32_u24 v140, 37, v142
    v_mul_u32_u24 v126, 384, v142
    v_lshrrev_b32 v140, 8, v140
    v_mad_u32_u24 v126, v140, s70, v126
    v_add_u32 v16, v126, v146
    v_add_u32 v19, v126, v127
    v_add_u32 v126, 32, v134
    v_mul_u32_u24 v143, 37, v126
    v_mul_u32_u24 v141, 384, v126
    v_lshrrev_b32 v143, 8, v143
    v_mad_u32_u24 v141, v143, s70, v141
    v_add_u32 v17, v141, v146
    v_add_u32 v20, v141, v127
    s_mul_i32 s81, s16, 768
    s_add_u32 s81, s81, 98304
    v_mul_u32_u24 v127, 24, v145
    v_lshl_add_u32 v127, v147, 2, v127
    v_add_u32 v22, s81, v127
    v_sub_u32 v23, s81, v127
    v_sub_u32 v145, v22, v144
    v_mul_u32_u24 v127, 24, v140
    v_lshl_add_u32 v127, v142, 2, v127
    v_add_u32 v24, s81, v127
    v_sub_u32 v25, s81, v127
    v_sub_u32 v127, v24, v144
    v_mul_u32_u24 v146, 24, v143
    v_lshl_add_u32 v146, v126, 2, v146
    v_add_u32 v26, s81, v146
    v_sub_u32 v27, s81, v146
    v_sub_u32 v126, v26, v144
    v_mul_u32_u24 v147, 148, v131
    s_mov_b32 s82, -24
    v_add_u32 v146, 0, v147
    v_lshrrev_b32 v146, 8, v146
    v_mad_i32_i24 v48, v146, s82, v145
    v_mad_i32_i24 v60, v146, s82, v127
    v_mad_i32_i24 v72, v146, s82, v126
    v_add_u32 v146, 37, v147
    v_lshrrev_b32 v146, 8, v146
    v_mad_i32_i24 v49, v146, s82, v145
    v_mad_i32_i24 v61, v146, s82, v127
    v_mad_i32_i24 v73, v146, s82, v126
    v_add_u32 v146, 74, v147
    v_lshrrev_b32 v146, 8, v146
    v_mad_i32_i24 v50, v146, s82, v145
    v_mad_i32_i24 v62, v146, s82, v127
    v_mad_i32_i24 v74, v146, s82, v126
    v_add_u32 v146, 111, v147
    v_lshrrev_b32 v146, 8, v146
    v_mad_i32_i24 v51, v146, s82, v145
    v_mad_i32_i24 v63, v146, s82, v127
    v_mad_i32_i24 v75, v146, s82, v126
    v_add_u32 v146, 592, v147
    v_lshrrev_b32 v146, 8, v146
    v_mad_i32_i24 v52, v146, s82, v145
    v_mad_i32_i24 v64, v146, s82, v127
    v_mad_i32_i24 v76, v146, s82, v126
    v_add_u32 v146, 629, v147
    v_lshrrev_b32 v146, 8, v146
    v_mad_i32_i24 v53, v146, s82, v145
    v_mad_i32_i24 v65, v146, s82, v127
    v_mad_i32_i24 v77, v146, s82, v126
    v_add_u32 v146, 666, v147
    v_lshrrev_b32 v146, 8, v146
    v_mad_i32_i24 v54, v146, s82, v145
    v_mad_i32_i24 v66, v146, s82, v127
    v_mad_i32_i24 v78, v146, s82, v126
    v_add_u32 v146, 703, v147
    v_lshrrev_b32 v146, 8, v146
    v_mad_i32_i24 v55, v146, s82, v145
    v_mad_i32_i24 v67, v146, s82, v127
    v_mad_i32_i24 v79, v146, s82, v126
    v_add_u32 v146, 1184, v147
    v_lshrrev_b32 v146, 8, v146
    v_mad_i32_i24 v56, v146, s82, v145
    v_mad_i32_i24 v68, v146, s82, v127
    v_mad_i32_i24 v80, v146, s82, v126
    v_add_u32 v146, 1221, v147
    v_lshrrev_b32 v146, 8, v146
    v_mad_i32_i24 v57, v146, s82, v145
    v_mad_i32_i24 v69, v146, s82, v127
    v_mad_i32_i24 v81, v146, s82, v126
    v_add_u32 v146, 1258, v147
    v_lshrrev_b32 v146, 8, v146
    v_mad_i32_i24 v58, v146, s82, v145
    v_mad_i32_i24 v70, v146, s82, v127
    v_mad_i32_i24 v82, v146, s82, v126
    v_add_u32 v146, 1295, v147
    v_lshrrev_b32 v146, 8, v146
    v_mad_i32_i24 v59, v146, s82, v145
    v_mad_i32_i24 v71, v146, s82, v127
    v_mad_i32_i24 v83, v146, s82, v126
    v_mov_b32 v126, s81
    v_lshlrev_b32 v127, 4, v130
    v_xor_b32 v2, 65536, v127
    v_lshl_add_u32 v3, s16, 10, v127
    s_lshr_b32 s83, s16, 1
    s_and_b32 s84, s16, 1
    s_lshl_b32 s84, s84, 3
    s_lshl_b32 s85, s83, 10
    s_add_u32 s85, s85, s84
    v_add_u32 v4, s85, v127
    s_lshl_b32 s83, s83, 11
    s_add_u32 s83, s83, s84
    s_add_u32 s83, s83, 157888
    s_mul_i32 s86, s16, 2048
    s_add_u32 s86, s86, 149696
    v_lshl_add_u32 v145, v131, 3, s86
    v_mov_b32 v147, s83
    s_mul_i32 s87, s16, 128
    s_add_u32 s87, s87, 61760
    buffer_load_dwordx4 v11, s[8:11], s25 offen nt lds
    s_add_u32 m0, s68, 3072
    v_mov_b32 v140, 163264
    s_mov_b32 s32, 0x2a8cbccc
    s_mov_b32 s33, 0x38fba882
    buffer_load_dwordx4 v150, s[48:51], 0 offen lds
    v_mul_u32_u24 v127, 80, v131
    v_add3_u32 v5, v127, v132, s72
    v_lshl_add_u32 v6, v134, 2, s73
    s_add_u32 s75, s28, 16384
    s_cmp_lt_u32 s16, 2
    buffer_load_dwordx4 v164, s[48:51], 0 offen offset:1024 lds
    v_add_u32 v9, s87, v144
    v_lshrrev_b32 v146, 1, v131
    v_mul_u32_u24 v146, 48, v146
    s_cselect_b32 s29, s75, 161984
    s_cselect_b32 s30, 65536, 0
    buffer_load_dwordx4 v166, s[48:51], 0 offen offset:2048 lds
    s_add_u32 s48, s48, 36864
    s_addc_u32 s49, s49, 0
    s_add_u32 m0, s69, 0
    v_lshl_add_u32 v146, v131, 3, v146
    v_lshl_add_u32 v146, v122, 4, v146
    v_lshl_add_u32 v146, v118, 1, v146
    v_add_u32 v8, s87, v146
    v_mov_b32 v37, 0
    v_mov_b32 v38, 0
    v_mov_b32 v39, 0
    v_add_u32 v160, 86016, v0
    v_add_u32 v161, 86016, v1
    v_lshlrev_b32 v163, 4, v134
    v_add_u32 v163, 161984, v163
    v_mul_u32_u24 v168, 336, v134
    s_waitcnt vmcnt(8)
    s_xor_b32 s74, s29, s30
    ds_read_b64_tr_b16 a[72:73], v136 offset:0
    buffer_load_dwordx4 v150, s[48:51], 0 offen lds
    ds_read_b64_tr_b16 a[74:75], v136 offset:768
    ds_read_b64_tr_b16 a[96:97], v136 offset:32
    ds_read_b64_tr_b16 a[98:99], v136 offset:800
    ds_read_b64_tr_b16 a[120:121], v136 offset:64
    ds_read_b64_tr_b16 a[122:123], v136 offset:832
    v_add3_u32 v168, v168, v127, s72
    v_mul_u32_u24 v152, 272, v134
    v_add3_u32 v152, v152, v144, s73
    v_mul_u32_u24 v170, 1088, v131
    v_add_u32 v170, v170, v6
    v_add_u32 v162, 5376, v168
    v_add_u32 v169, 4352, v152
    v_add_u32 v171, 4352, v170
    v_cmp_gt_u32 s[88:89], 16, v130
    v_mov_b32 v153, 0xf149f2ca
    v_add_u32 v154, 768, v128
    v_mul_u32_u24 v146, 2731, v154
    v_bfe_u32 v127, v146, 17, 3
    v_lshrrev_b32 v146, 16, v146
    v_xor_b32 v154, v127, v154
    v_mul_u32_u24 v127, 37, v146
    v_lshrrev_b32 v127, 8, v127
    v_lshlrev_b32 v154, 4, v154
    v_mad_u32_u24 v13, v127, s70, v154
    v_add_u32 v128, 1024, v128
    v_mul_u32_u24 v127, 2731, v128
    v_bfe_u32 v146, v127, 17, 3
    v_lshrrev_b32 v127, 16, v127
    v_xor_b32 v128, v146, v128
    v_mul_u32_u24 v146, 37, v127
    v_lshrrev_b32 v146, 8, v146
    v_lshlrev_b32 v128, 4, v128
    v_mad_u32_u24 v14, v146, s70, v128
    v_cmp_gt_u32 vcc, 48, v127
    s_mul_i32 s77, s16, 64
    s_mul_i32 s78, s16, 32
    v_cndmask_b32 v14, v129, v14, vcc
    v_cmp_gt_u32 vcc, 2, v118
    s_add_u32 s78, s78, 192
    v_mul_u32_u24 v146, 6, v148
    v_cndmask_b32 v32, 0, v125, vcc
    v_cndmask_b32 v33, v125, 0, vcc
    v_cndmask_b32 v34, 0, v125, vcc
    v_cndmask_b32 v35, v125, 0, vcc
    v_cmp_eq_u32 vcc, 0, v132
    v_sub_u32 v125, v130, v146
    v_mul_u32_u24 v146, 384, v148
    v_cndmask_b32 v40, 0, v139, vcc
    v_cndmask_b32 v41, v139, 0, vcc
    v_cndmask_b32 v42, 0, v139, vcc
    v_cndmask_b32 v43, v139, 0, vcc
    v_cmp_eq_u32 vcc, v131, v122
    v_lshl_add_u32 v146, v125, 4, v146
    v_add_u32 v127, s78, v146
    v_cndmask_b32 v128, 0, v32, vcc
    v_cndmask_b32 v129, 0, v33, vcc
    v_add_u32 v146, s77, v146
    v_cmp_gt_i32 vcc, 4, v125
    v_mul_u32_u24 v148, 6, v149
    v_sub_u32 v139, v130, v148
    v_cndmask_b32 v172, v127, v146, vcc
    v_mul_u32_u24 v148, 384, v149
    v_lshl_add_u32 v148, v139, 4, v148
    v_add_u32 v146, s78, v148
    v_add_u32 v148, s77, v148
    v_cmp_gt_i32 vcc, -60, v139
    v_mul_u32_u24 v127, 6, v151
    v_sub_u32 v125, v130, v127
    v_cndmask_b32 v130, v146, v148, vcc
    v_mul_u32_u24 v127, 384, v151
    v_lshl_add_u32 v127, v125, 4, v127
    v_add_u32 v139, s78, v127
    v_add_u32 v127, s77, v127
    v_cmp_gt_i32 vcc, -124, v125
    v_mul_u32_u24 v146, 96, v134
    v_add3_u32 v173, v146, v144, s68
    v_cndmask_b32 v139, v139, v127, vcc
    v_cmp_gt_u32 vcc, 2, v131
    v_lshl_add_u32 v174, v131, 3, v146
    v_add3_u32 v174, v174, 64, s68
    v_cndmask_b32 v145, v147, v145, vcc
    v_lshl_add_u32 v145, v122, 9, v145
    v_lshl_add_u32 v145, v118, 1, v145
    v_cmp_gt_u32 vcc, 3, v131
    v_add3_u32 v148, v146, v144, s69
    v_lshl_add_u32 v175, v131, 3, v146
    v_cndmask_b32 v7, v140, v145, vcc
    v_cmp_gt_u32 vcc, 12, v134
    v_add3_u32 v175, v175, 64, s69
    v_add_u32 v134, 16, v134
    v_cndmask_b32 v162, v163, v162, vcc
    v_cndmask_b32 v169, v163, v169, vcc
    v_cmp_gt_u32 vcc, 3, v131
    v_cmp_gt_u32 s[94:95], s45, v134
    v_cmp_ne_u32 s[96:97], 0, v132
    v_cndmask_b32 v171, v163, v171, vcc
    v_cmp_lt_u32 s[98:99], 1, v118
    v_cmp_eq_u32 vcc, v131, v122
    v_sub_u32 v149, v152, v144
    v_sub_u32 v131, v169, v144
    v_cndmask_b32 v149, v163, v149, vcc
    v_cndmask_b32 v131, v163, v131, vcc
    s_add_u32 s34, s18, 2
    s_mov_b32 s27, s26
    s_mov_b32 s26, s25
    s_add_u32 s19, s19, s20
    s_mov_b32 s18, 1
    s_mov_b32 s71, 1
    s_and_b32 s77, s2, 0xf8
    s_add_u32 s77, s77, 4940
    s_mul_i32 s78, s77, 58255
    s_lshr_b32 s78, s78, 22
    buffer_load_dwordx4 v164, s[48:51], 0 offen offset:1024 lds
    buffer_load_dwordx4 v166, s[48:51], 0 offen offset:2048 lds
    s_add_u32 s48, s48, 36864
    s_addc_u32 s49, s49, 0
    s_add_u32 m0, s69, 3072
    s_nop 0
    buffer_load_dwordx4 v150, s[48:51], 0 offen lds
    buffer_load_dwordx4 v164, s[48:51], 0 offen offset:1024 lds
    buffer_load_dwordx4 v166, s[48:51], 0 offen offset:2048 lds
    s_waitcnt vmcnt(9)
    s_barrier
    ds_read_b128 v[140:143], v160 offset:6144
    ds_read_b128 v[232:235], v161 offset:6144
    ds_read_b128 v[180:183], v160 offset:6272
    s_add_u32 s48, s48, 36864
    s_addc_u32 s49, s49, 0
    ds_read_b128 v[184:187], v161 offset:6272
    s_add_u32 m0, s72, 0
    ds_read_b128 v[248:251], v160 offset:6400
    ds_read_b128 v[176:179], v161 offset:6400
    buffer_load_ushort v132, v167, s[60:63], 0 offen
    s_mov_b64 s[60:61], s[8:9]
    ds_read_b128 v[156:159], v0 offset:20480
    s_sub_u32 s62, s45, s17
    s_sub_u32 s45, s17, 1
    s_bfm_b32 s63, s17, 0
    ds_read_b128 v[192:195], v1 offset:20480
    s_waitcnt lgkmcnt(7)
    v_mfma_f32_16x16x32_bf16 v[188:191], a[72:75], v[140:143], 0
    s_min_u32 s70, s62, 4
    ds_read_b128 v[216:219], v0 offset:20608
    s_lshr_b32 s83, s44, 8
    v_mfma_f32_16x16x32_bf16 v[220:223], a[96:99], v[140:143], 0
    s_cselect_b32 s70, 0, s70
    ds_read_b128 v[200:203], v1 offset:20608
    v_mfma_f32_16x16x32_bf16 v[228:231], a[120:123], v[140:143], 0
    s_waitcnt lgkmcnt(5)
    buffer_load_dwordx3 v[208:210], v116, s[56:59], 0 offen
    ds_read_b128 v[212:215], v0 offset:20736
    ds_read_b128 v[196:199], v1 offset:20736
    ds_read_b128 v[204:207], v160 offset:6144
    s_waitcnt lgkmcnt(6)
    v_mfma_f32_16x16x32_bf16 v[240:243], a[72:75], v[156:159], 0
    ds_read_b128 v[224:227], v160 offset:0
    v_mfma_f32_16x16x32_bf16 v[140:143], a[96:99], v[156:159], 0
    s_waitcnt vmcnt(8)
    buffer_load_dwordx4 v[236:239], v120, s[64:67], 0 offen
    ds_read_b64_tr_b16 a[76:77], v136 offset:3072
    ds_read_b64_tr_b16 a[78:79], v136 offset:3840
    ds_read_b64_tr_b16 a[100:101], v136 offset:3104
    ds_read_b64_tr_b16 a[102:103], v136 offset:3872
    ds_read_b64_tr_b16 a[124:125], v136 offset:3136
    ds_read_b64_tr_b16 a[126:127], v136 offset:3904
    global_load_ushort v165, v165, s[46:47]
    s_waitcnt lgkmcnt(4)
    v_mfma_f32_16x16x32_bf16 v[188:191], a[76:79], v[232:235], v[188:191]
    v_mfma_f32_16x16x32_bf16 v[240:243], a[76:79], v[192:195], v[240:243]
    s_waitcnt lgkmcnt(2)
    v_mfma_f32_16x16x32_bf16 v[220:223], a[100:103], v[232:235], v[220:223]
    s_waitcnt lgkmcnt(0)
    buffer_load_dwordx4 v150, s[48:51], 0 offen lds
    v_mfma_f32_16x16x32_bf16 v[228:231], a[124:127], v[232:235], v[228:231]
    ds_read_b128 v[232:235], v161 offset:6144
    v_mfma_f32_16x16x32_bf16 v[140:143], a[100:103], v[192:195], v[140:143]
    s_waitcnt vmcnt(8)
    ds_read_b64_tr_b16 a[80:81], v137 offset:0
    ds_read_b64_tr_b16 a[82:83], v137 offset:768
    ds_read_b64_tr_b16 a[104:105], v137 offset:32
    ds_read_b64_tr_b16 a[106:107], v137 offset:800
    buffer_load_dwordx4 v164, s[48:51], 0 offen offset:1024 lds
    ds_read_b64_tr_b16 a[128:129], v137 offset:64
    ds_read_b64_tr_b16 a[130:131], v137 offset:832
    buffer_load_dwordx4 v166, s[48:51], 0 offen offset:2048 lds
    s_waitcnt lgkmcnt(4)
    v_mfma_f32_16x16x32_bf16 v[188:191], a[80:83], v[180:183], v[188:191]
    s_waitcnt lgkmcnt(2)
    s_add_u32 s48, s48, 36864
    s_addc_u32 s49, s49, 0
    v_mfma_f32_16x16x32_bf16 v[220:223], a[104:107], v[180:183], v[220:223]
    s_waitcnt lgkmcnt(0)
    s_add_u32 m0, s72, 3072
    s_mov_b32 s72, 2
    v_mfma_f32_16x16x32_bf16 v[228:231], a[128:131], v[180:183], v[228:231]
    ds_read_b128 v[180:183], v160 offset:6272
    v_mfma_f32_16x16x32_bf16 v[240:243], a[80:83], v[216:219], v[240:243]
    v_mfma_f32_16x16x32_bf16 v[140:143], a[104:107], v[216:219], v[140:143]
    buffer_load_dwordx4 v150, s[48:51], 0 offen lds
    s_waitcnt vmcnt(8)
    ds_read_b64_tr_b16 a[84:85], v137 offset:3072
    ds_read_b64_tr_b16 a[86:87], v137 offset:3840
    ds_read_b64_tr_b16 a[108:109], v137 offset:3104
    ds_read_b64_tr_b16 a[110:111], v137 offset:3872
    ds_read_b64_tr_b16 a[132:133], v137 offset:3136
    ds_read_b64_tr_b16 a[134:135], v137 offset:3904
    s_waitcnt vmcnt(6)
    buffer_load_dwordx4 v164, s[48:51], 0 offen offset:1024 lds
    v_bfe_u32 v134, v208, v144, 16
    v_bfe_u32 v118, v209, v144, 16
    v_bfe_u32 v116, v210, v144, 16
    s_waitcnt lgkmcnt(4)
    v_mfma_f32_16x16x32_bf16 v[188:191], a[84:87], v[184:187], v[188:191]
    s_waitcnt vmcnt(6)
    v_cndmask_b32 v236, v236, v237, s[92:93]
    v_cndmask_b32 v238, v238, v239, s[92:93]
    v_perm_b32 v154, v238, v236, v121
    v_mfma_f32_16x16x16_bf16 v[144:147], v[132:133], v[134:135], 0
    v_mfma_f32_16x16x32_bf16 v[240:243], a[84:87], v[200:203], v[240:243]
    s_waitcnt lgkmcnt(0)
    buffer_load_dwordx4 v166, s[48:51], 0 offen offset:2048 lds
    s_sub_u32 s48, s48, 184704
    v_mfma_f32_16x16x32_bf16 v[220:223], a[108:111], v[184:187], v[220:223]
    s_subb_u32 s49, s49, 0
    s_add_u32 m0, s73, 0
    s_waitcnt vmcnt(6)
    v_mfma_f32_16x16x32_bf16 v[228:231], a[132:135], v[184:187], v[228:231]
    ds_read_b128 v[184:187], v161 offset:6272
    v_max_f32 v144, 0, v144
    v_mfma_f32_16x16x32_bf16 v[140:143], a[108:111], v[200:203], v[140:143]
    v_max_f32 v145, 0, v145
    v_max_f32 v146, 0, v146
    v_max_f32 v147, 0, v147
    v_cvt_pk_bf16_f32 v134, v144, v145
    v_mfma_f32_16x16x16_bf16 v[236:239], v[132:133], v[118:119], 0
    buffer_load_dwordx4 v150, s[48:51], 0 offen lds
    v_cvt_pk_bf16_f32 v135, v146, v147
    v_lshlrev_b32 v165, 16, v165
    v_max_f32 v165, 0xc2c80000, v165
    v_min_f32 v165, 0x40930000, v165
    v_mul_f32 v165, 0x3fb8aa3b, v165
    v_exp_f32 v165, v165
    s_nop 0
    v_max_f32 v236, 0, v236
    v_max_f32 v237, 0, v237
    v_max_f32 v238, 0, v238
    v_max_f32 v239, 0, v239
    v_cvt_pk_bf16_f32 v236, v236, v237
    v_mfma_f32_16x16x16_bf16 v[208:211], v[132:133], v[116:117], 0
    v_cvt_pk_bf16_f32 v237, v238, v239
    v_cvt_pk_bf16_f32 v165, v165, v165
    v_and_b32 v165, 0xffff0000, v165
    v_mul_f32 v151, 0x3fb8aa3b, v165
    v_mfma_f32_16x16x32_bf16 v[144:147], a[120:123], v[156:159], 0
    s_waitcnt lgkmcnt(0)
    buffer_load_dwordx4 v[156:159], v120, s[64:67], 0 offen offset:16
    v_readfirstlane_b32 s37, v165
    v_mfma_f32_16x16x32_bf16 v[144:147], a[124:127], v[192:195], v[144:147]
    buffer_load_dwordx4 v164, s[48:51], 0 offen offset:1024 lds
    ds_read_b128 v[116:119], v161 offset:0
    v_mfma_f32_16x16x32_bf16 v[144:147], a[128:131], v[216:219], v[144:147]
    ds_read_b128 v[192:195], v160 offset:128
    v_max_f32 v208, 0, v208
    v_mfma_f32_16x16x32_bf16 v[144:147], a[132:135], v[200:203], v[144:147]
    ds_read_b128 v[216:219], v161 offset:128
    v_max_f32 v209, 0, v209
    v_max_f32 v210, 0, v210
    v_max_f32 v211, 0, v211
    v_cvt_pk_bf16_f32 v238, v208, v209
    v_cvt_pk_bf16_f32 v239, v210, v211
    v_readfirstlane_b32 s31, v151
    v_mfma_f32_16x16x32_bf16 v[200:203], a[72:75], v[224:227], 0
    buffer_load_dwordx4 v166, s[48:51], 0 offen offset:2048 lds
    s_waitcnt vmcnt(7)
    ds_read_b64_tr_b16 a[88:89], v124 offset:0
    ds_read_b64_tr_b16 a[90:91], v124 offset:768
    ds_read_b64_tr_b16 a[112:113], v124 offset:32
    s_waitcnt lgkmcnt(5)
    v_mfma_f32_16x16x32_bf16 v[200:203], a[76:79], v[116:119], v[200:203]
    s_add_u32 s48, s48, 36864
    s_waitcnt lgkmcnt(4)
    ds_read_b64_tr_b16 a[114:115], v124 offset:800
    v_mfma_f32_16x16x32_bf16 v[200:203], a[80:83], v[192:195], v[200:203]
    s_addc_u32 s49, s49, 0
    s_waitcnt lgkmcnt(4)
    ds_read_b64_tr_b16 a[136:137], v124 offset:64
    v_mfma_f32_16x16x32_bf16 v[200:203], a[84:87], v[216:219], v[200:203]
    s_add_u32 m0, s73, 3072
    ds_read_b64_tr_b16 a[138:139], v124 offset:832
    s_mov_b32 s73, 3
    buffer_load_dwordx4 v150, s[48:51], 0 offen lds
    v_mul_f32 v151, 0x3e000000, v165
    v_cmp_lt_f32 s[90:91], 4.0, v151
    s_nop 0
    s_nop 0
    s_cmp_lg_u64 s[90:91], 0
    s_cbranch_scc1 L_slow
    s_waitcnt lgkmcnt(4)
    v_mfma_f32_16x16x32_bf16 v[188:191], a[88:91], v[248:251], v[188:191]
    s_waitcnt lgkmcnt(3)
    v_mfma_f32_16x16x32_bf16 v[240:243], a[88:91], v[212:215], v[240:243]
    s_waitcnt lgkmcnt(2)
    v_mfma_f32_16x16x32_bf16 v[220:223], a[112:115], v[248:251], v[220:223]
    s_waitcnt lgkmcnt(1)
    v_mfma_f32_16x16x32_bf16 v[140:143], a[112:115], v[212:215], v[140:143]
    s_waitcnt lgkmcnt(0)
    buffer_load_dwordx4 v164, s[48:51], 0 offen offset:1024 lds
    v_mfma_f32_16x16x32_bf16 v[228:231], a[136:139], v[248:251], v[228:231]
    ds_read_b128 v[208:211], v160 offset:6400
    v_mfma_f32_16x16x32_bf16 v[144:147], a[136:139], v[212:215], v[144:147]
    ds_read_b128 v[248:251], v160 offset:256
    buffer_load_dwordx4 v166, s[48:51], 0 offen offset:2048 lds
    s_add_u32 s48, s48, 36864
    s_addc_u32 s49, s49, 0
    s_waitcnt vmcnt(7)
    ds_read_b64_tr_b16 a[92:93], v124 offset:3072
    ds_read_b64_tr_b16 a[94:95], v124 offset:3840
    ds_read_b64_tr_b16 a[116:117], v124 offset:3104
    ds_read_b64_tr_b16 a[118:119], v124 offset:3872
    ds_read_b64_tr_b16 a[140:141], v124 offset:3136
    ds_read_b64_tr_b16 a[142:143], v124 offset:3904
    s_add_u32 m0, s68, 0
    v_mov_b32 v212, 0
    s_waitcnt lgkmcnt(6)
    v_mfma_f32_16x16x32_bf16 v[200:203], a[88:91], v[248:251], v[200:203]
    v_mov_b32 v213, 0
    v_mov_b32 v214, 0
    buffer_load_dwordx4 v150, s[48:51], 0 offen lds
    v_mov_b32 v215, 0
    v_mov_b32 v244, v153
    v_mov_b32 v245, v153
    v_mov_b32 v246, v153
    v_mov_b32 v247, v153
    s_waitcnt lgkmcnt(4)
    v_mfma_f32_16x16x32_bf16 v[188:191], a[92:95], v[176:179], v[188:191]
    s_waitcnt lgkmcnt(3)
    v_mfma_f32_16x16x32_bf16 v[240:243], a[92:95], v[196:199], v[240:243]
    s_waitcnt lgkmcnt(0)
    v_mfma_f32_16x16x32_bf16 v[220:223], a[116:119], v[176:179], v[220:223]
    v_mfma_f32_16x16x32_bf16 v[228:231], a[140:143], v[176:179], v[228:231]
    buffer_load_dwordx4 v164, s[48:51], 0 offen offset:1024 lds
    v_mfma_f32_16x16x32_bf16 v[140:143], a[116:119], v[196:199], v[140:143]
    s_waitcnt vmcnt(7)
    v_cndmask_b32 v156, v156, v157, s[92:93]
    v_cndmask_b32 v158, v158, v159, s[92:93]
    v_mfma_f32_16x16x32_bf16 v[144:147], a[140:143], v[196:199], v[144:147]
    ds_read_b128 v[176:179], v161 offset:6400
    v_perm_b32 v155, v158, v156, v121
    v_cvt_pk_f16_f32 v196, v188, v189
    v_pk_mul_f16 v157, v196, v196
    v_cvt_pk_f16_f32 v197, v190, v191
    v_pk_mul_f16 v159, v197, v197
    v_cvt_pk_f16_f32 v198, v220, v221
    v_pk_fma_f16 v157, v198, v198, v157
    v_cvt_pk_f16_f32 v199, v222, v223
    v_mfma_f32_16x16x16_bf16 v[188:191], v[154:155], v[134:135], 0
    v_pk_fma_f16 v159, v199, v199, v159
    v_cvt_pk_f16_f32 v254, v228, v229
    v_pk_fma_f16 v157, v254, v254, v157
    v_mfma_f32_16x16x16_bf16 v[220:223], v[154:155], v[236:237], 0
    v_cvt_pk_f16_f32 v255, v230, v231
    v_pk_fma_f16 v159, v255, v255, v159
    v_cvt_pk_f16_f32 v120, v240, v241
    v_mfma_f32_16x16x16_bf16 v[132:135], v[154:155], v[238:239], 0
    v_cvt_pk_bf16_f32 v188, v188, v188
    v_and_b32 v188, 0xffff0000, v188
    v_mul_f32 v188, 0xbfb8aa3b, v188
    v_pk_mul_f16 v125, v120, v120
    v_mfma_f32_16x16x32_bf16 v[228:231], a[96:99], v[224:227], 0
    s_waitcnt lgkmcnt(0)
    buffer_load_dwordx4 v166, s[48:51], 0 offen offset:2048 lds
    ds_read_b128 v[236:239], v161 offset:256
    v_mfma_f32_16x16x32_bf16 v[228:231], a[100:103], v[116:119], v[228:231]
    s_add_u32 s48, s48, 36864
    s_waitcnt vmcnt(6)
    ds_read_b64_tr_b16 a[0:1], v138 offset:0
    v_mfma_f32_16x16x32_bf16 v[228:231], a[104:107], v[192:195], v[228:231]
    s_addc_u32 s49, s49, 0
    ds_read_b64_tr_b16 a[2:3], v138 offset:768
    ds_read_b64_tr_b16 a[24:25], v138 offset:32
    v_mfma_f32_16x16x32_bf16 v[228:231], a[108:111], v[216:219], v[228:231]
    s_add_u32 m0, s68, 3072
    ds_read_b64_tr_b16 a[26:27], v138 offset:800
    ds_read_b64_tr_b16 a[48:49], v138 offset:64
    v_mfma_f32_16x16x32_bf16 v[228:231], a[112:115], v[248:251], v[228:231]
    ds_read_b64_tr_b16 a[50:51], v138 offset:832
    buffer_load_dwordx4 v150, s[48:51], 0 offen lds
    v_exp_f32 v188, v188
    v_cvt_pk_bf16_f32 v220, v220, v220
    v_add_f32 v188, 1.0, v188
    s_waitcnt lgkmcnt(6)
    v_mfma_f32_16x16x32_bf16 v[200:203], a[92:95], v[236:239], v[200:203]
    v_rcp_f32 v188, v188
    v_mfma_f32_16x16x32_bf16 v[228:231], a[116:119], v[236:239], v[228:231]
    v_cvt_pk_bf16_f32 v188, v188, v188
    v_and_b32 v188, 0xffff0000, v188
    v_add_f32 v188, -0.5, v188
    v_mul_f32 v188, 0x41b8aa3b, v188
    ds_write_b32 v123, v188 offset:0
    v_mfma_f32_16x16x32_bf16 v[188:191], a[120:123], v[224:227], 0
    s_waitcnt lgkmcnt(1)
    buffer_load_dwordx4 v164, s[48:51], 0 offen offset:1024 lds
    v_and_b32 v220, 0xffff0000, v220
    v_mfma_f32_16x16x32_bf16 v[188:191], a[124:127], v[116:119], v[188:191]
    v_mul_f32 v220, 0xbfb8aa3b, v220
    v_cvt_pk_bf16_f32 v132, v132, v132
    v_mfma_f32_16x16x32_bf16 v[188:191], a[128:131], v[192:195], v[188:191]
    v_exp_f32 v220, v220
    v_mfma_f32_16x16x32_bf16 v[188:191], a[132:135], v[216:219], v[188:191]
    v_add_f32 v220, 1.0, v220
    v_and_b32 v132, 0xffff0000, v132
    s_waitcnt vmcnt(5)
    v_mfma_f32_16x16x32_bf16 v[188:191], a[136:139], v[248:251], v[188:191]
    ds_read_b64_tr_b16 a[4:5], v138 offset:3072
    ds_read_b64_tr_b16 a[6:7], v138 offset:3840
    v_mfma_f32_16x16x32_bf16 v[188:191], a[140:143], v[236:239], v[188:191]
    buffer_load_dwordx4 v166, s[48:51], 0 offen offset:2048 lds
    ds_read_b64_tr_b16 a[28:29], v138 offset:3104
    ds_read_b64_tr_b16 a[30:31], v138 offset:3872
    ds_read_b64_tr_b16 a[52:53], v138 offset:3136
    ds_read_b64_tr_b16 a[54:55], v138 offset:3904
    ds_write_b128 v168, v[212:215] offset:16
    s_add_u32 s48, s48, 36864
    s_addc_u32 s49, s49, 0
    s_add_u32 m0, s69, 0
    v_rcp_f32 v220, v220
    v_mul_f32 v132, 0xbfb8aa3b, v132
    v_cvt_pk_bf16_f32 v220, v220, v220
    buffer_load_dwordx4 v150, s[48:51], 0 offen lds
    ds_write_b64 v168, v[212:213] offset:56
    v_and_b32 v220, 0xffff0000, v220
    v_add_f32 v220, -0.5, v220
    v_mul_f32 v220, 0x41b8aa3b, v220
    ds_write_b32 v123, v220 offset:4
    v_exp_f32 v132, v132
    v_cvt_pk_f16_f32 v121, v242, v243
    v_add_f32 v132, 1.0, v132
    v_rcp_f32 v132, v132
    buffer_load_dwordx4 v164, s[48:51], 0 offen offset:1024 lds
    ds_write_b64 v168, v[212:213] offset:64
    v_cvt_pk_bf16_f32 v132, v132, v132
    v_and_b32 v132, 0xffff0000, v132
    v_add_f32 v132, -0.5, v132
    v_mul_f32 v132, 0x41b8aa3b, v132
    ds_write_b32 v123, v132 offset:8
    v_mfma_f32_16x16x32_bf16 v[132:135], a[0:3], v[224:227], 0
    s_waitcnt lgkmcnt(2)
    v_pk_mul_f16 v127, v121, v121
    v_cvt_pk_f16_f32 v122, v140, v141
    v_mfma_f32_16x16x32_bf16 v[132:135], a[4:7], v[116:119], v[132:135]
    ds_write_b128 v162, v[212:215] offset:16
    buffer_load_dwordx4 v166, s[48:51], 0 offen offset:2048 lds
    s_add_u32 s48, s48, 36864
    s_addc_u32 s49, s49, 0
    s_waitcnt vmcnt(6)
    s_add_u32 m0, s69, 3072
    v_pk_fma_f16 v125, v122, v122, v125
    v_cvt_pk_f16_f32 v123, v142, v143
    v_mfma_f32_16x16x32_bf16 v[140:143], a[24:27], v[224:227], 0
    ds_read_b64_tr_b16 a[8:9], v136 offset:0
    ds_read_b64_tr_b16 a[10:11], v136 offset:768
    v_mfma_f32_16x16x32_bf16 v[140:143], a[28:31], v[116:119], v[140:143]
    s_waitcnt lgkmcnt(3)
    s_barrier
    ds_read_b64_tr_b16 a[32:33], v136 offset:32
    ds_read_b64_tr_b16 a[34:35], v136 offset:800
    ds_read_b64_tr_b16 a[56:57], v136 offset:64
    ds_read_b64_tr_b16 a[58:59], v136 offset:832
    ds_read_b32 v22, v22 offset:0
    buffer_load_dwordx4 v150, s[48:51], 0 offen lds
    ds_read_b32 v23, v23 offset:672
    ds_read_b32 v24, v24 offset:0
    ds_read_b32 v25, v25 offset:672
    ds_read_b32 v26, v26 offset:0
    ds_read_b32 v27, v27 offset:672
    ds_read_b32 v48, v48 offset:336
    ds_read_b32 v60, v60 offset:336
    ds_read_b32 v72, v72 offset:336
    ds_read_b32 v49, v49 offset:332
    s_waitcnt lgkmcnt(14)
    v_mfma_f32_16x16x32_bf16 v[132:135], a[8:11], v[192:195], v[132:135]
    ds_read_b32 v61, v61 offset:332
    s_waitcnt lgkmcnt(13)
    v_mfma_f32_16x16x32_bf16 v[140:143], a[32:35], v[192:195], v[140:143]
    s_waitcnt lgkmcnt(11)
    s_waitcnt lgkmcnt(10)
    buffer_load_dwordx4 v164, s[48:51], 0 offen offset:1024 lds
    ds_read_b32 v73, v73 offset:332
    s_waitcnt lgkmcnt(9)
    ds_read_b32 v50, v50 offset:328
    s_waitcnt lgkmcnt(8)
    ds_read_b32 v62, v62 offset:328
    ds_read_b32 v74, v74 offset:328
    ds_read_b32 v51, v51 offset:324
    ds_read_b32 v63, v63 offset:324
    ds_read_b32 v75, v75 offset:324
    ds_read_b32 v52, v52 offset:272
    ds_read_b32 v64, v64 offset:272
    ds_read_b32 v76, v76 offset:272
    ds_read_b32 v53, v53 offset:268
    ds_read_b32 v65, v65 offset:268
    buffer_load_dwordx4 v166, s[48:51], 0 offen offset:2048 lds
    ds_read_b32 v77, v77 offset:268
    s_sub_u32 s48, s48, 183552
    ds_read_b32 v54, v54 offset:264
    s_waitcnt vmcnt(6)
    ds_read_b64_tr_b16 a[12:13], v136 offset:3072
    s_subb_u32 s49, s49, 0
    ds_read_b64_tr_b16 a[14:15], v136 offset:3840
    s_add_u32 m0, s68, 0
    ds_read_b64_tr_b16 a[36:37], v136 offset:3104
    ds_read_b64_tr_b16 a[38:39], v136 offset:3872
    ds_read_b64_tr_b16 a[60:61], v136 offset:3136
    ds_read_b64_tr_b16 a[62:63], v136 offset:3904
    ds_read_b32 v66, v66 offset:264
    buffer_load_dwordx4 v150, s[48:51], 0 offen lds
    ds_read_b32 v78, v78 offset:264
    ds_read_b32 v55, v55 offset:260
    ds_read_b32 v67, v67 offset:260
    ds_read_b32 v79, v79 offset:260
    ds_read_b32 v56, v56 offset:208
    ds_read_b32 v68, v68 offset:208
    ds_read_b32 v80, v80 offset:208
    s_waitcnt lgkmcnt(12)
    v_mfma_f32_16x16x32_bf16 v[132:135], a[12:15], v[216:219], v[132:135]
    s_waitcnt lgkmcnt(10)
    ds_read_b32 v57, v57 offset:204
    ds_read_b32 v69, v69 offset:204
    v_mfma_f32_16x16x32_bf16 v[140:143], a[36:39], v[216:219], v[140:143]
    s_waitcnt lgkmcnt(10)
    buffer_load_dwordx4 v164, s[48:51], 0 offen offset:1024 lds
    ds_read_b32 v81, v81 offset:204
    ds_read_b32 v58, v58 offset:200
    ds_read_b32 v70, v70 offset:200
    ds_read_b32 v82, v82 offset:200
    ds_read_b32 v59, v59 offset:196
    ds_read_b32 v71, v71 offset:196
    ds_read_b32 v83, v83 offset:196
    ds_read_b32 v126, v126 offset:336
    v_cndmask_b32 v22, v153, v22, s[88:89]
    v_cndmask_b32 v24, v153, v24, s[88:89]
    v_cndmask_b32 v26, v153, v26, s[88:89]
    ds_write_b64 v162, v[212:213] offset:56
    buffer_load_dwordx4 v166, s[48:51], 0 offen offset:2048 lds
    s_add_u32 s48, s48, 36864
    s_addc_u32 s49, s49, 0
    s_add_u32 m0, s68, 3072
    ds_write_b64 v162, v[212:213] offset:64
    s_waitcnt vmcnt(6)
    v_pk_fma_f16 v127, v123, v123, v127
    v_cvt_pk_f16_f32 v214, v144, v145
    v_mfma_f32_16x16x32_bf16 v[220:223], a[48:51], v[224:227], 0
    s_waitcnt lgkmcnt(3)
    ds_read_b64_tr_b16 a[16:17], v137 offset:0
    ds_read_b64_tr_b16 a[18:19], v137 offset:768
    v_mfma_f32_16x16x32_bf16 v[220:223], a[52:55], v[116:119], v[220:223]
    s_waitcnt lgkmcnt(4)
    ds_read_b64_tr_b16 a[40:41], v137 offset:32
    ds_read_b64_tr_b16 a[42:43], v137 offset:800
    v_mfma_f32_16x16x32_bf16 v[220:223], a[56:59], v[192:195], v[220:223]
    buffer_load_dwordx4 v150, s[48:51], 0 offen lds
    ds_read_b64_tr_b16 a[64:65], v137 offset:64
    v_mfma_f32_16x16x32_bf16 v[220:223], a[60:63], v[216:219], v[220:223]
    ds_read_b64_tr_b16 a[66:67], v137 offset:832
    ds_read_b128 v[240:243], v160 offset:6144
    ds_read_b128 v[116:119], v161 offset:6144
    ds_read_b128 v[192:195], v160 offset:6272
    ds_read_b128 v[216:219], v161 offset:6272
    v_readfirstlane_b32 s39, v126
    ds_write_b128 v152, v[244:247] offset:192
    s_waitcnt lgkmcnt(7)
    v_mfma_f32_16x16x32_bf16 v[132:135], a[16:19], v[248:251], v[132:135]
    buffer_load_dwordx4 v164, s[48:51], 0 offen offset:1024 lds
    v_pk_fma_f16 v125, v214, v214, v125
    v_mfma_f32_16x16x32_bf16 v[140:143], a[40:43], v[248:251], v[140:143]
    ds_write_b128 v169, v[244:247] offset:192
    s_waitcnt lgkmcnt(2)
    v_mfma_f32_16x16x32_bf16 v[220:223], a[64:67], v[248:251], v[220:223]
    v_cvt_pk_f16_f32 v215, v146, v147
    v_pk_fma_f16 v127, v215, v215, v127
    v_mfma_f32_16x16x32_bf16 v[144:147], a[0:3], v[240:243], 0
    v_cvt_pk_f16_f32 v200, v200, v201
    v_pk_mul_f16 v225, v200, v200
    v_mfma_f32_16x16x32_bf16 v[144:147], a[4:7], v[116:119], v[144:147]
    buffer_load_dwordx4 v166, s[48:51], 0 offen offset:2048 lds
    s_waitcnt vmcnt(6)
    v_mfma_f32_16x16x32_bf16 v[144:147], a[8:11], v[192:195], v[144:147]
    s_add_u32 s48, s48, 36864
    ds_read_b64_tr_b16 a[20:21], v137 offset:3072
    ds_read_b64_tr_b16 a[22:23], v137 offset:3840
    v_mfma_f32_16x16x32_bf16 v[144:147], a[12:15], v[216:219], v[144:147]
    s_addc_u32 s49, s49, 0
    ds_read_b64_tr_b16 a[44:45], v137 offset:3104
    ds_read_b64_tr_b16 a[46:47], v137 offset:3872
    v_mfma_f32_16x16x32_bf16 v[248:251], a[24:27], v[240:243], 0
    s_add_u32 m0, s69, 0
    ds_read_b64_tr_b16 a[68:69], v137 offset:3136
    ds_read_b64_tr_b16 a[70:71], v137 offset:3904
    v_mfma_f32_16x16x32_bf16 v[248:251], a[28:31], v[116:119], v[248:251]
    ds_read_b128 v[152:155], v160 offset:6400
    v_cvt_pk_f16_f32 v201, v202, v203
    v_mfma_f32_16x16x32_bf16 v[248:251], a[32:35], v[192:195], v[248:251]
    buffer_load_dwordx4 v150, s[48:51], 0 offen lds
    v_pk_mul_f16 v227, v201, v201
    v_mfma_f32_16x16x32_bf16 v[248:251], a[36:39], v[216:219], v[248:251]
    v_cvt_pk_f16_f32 v202, v228, v229
    v_pk_fma_f16 v225, v202, v202, v225
    v_cvt_pk_f16_f32 v203, v230, v231
    v_pk_fma_f16 v227, v203, v203, v227
    s_waitcnt lgkmcnt(5)
    v_mfma_f32_16x16x32_bf16 v[132:135], a[20:23], v[236:239], v[132:135]
    v_cvt_pk_f16_f32 v230, v188, v189
    s_waitcnt lgkmcnt(3)
    v_mfma_f32_16x16x32_bf16 v[140:143], a[44:47], v[236:239], v[140:143]
    v_pk_fma_f16 v225, v230, v230, v225
    s_waitcnt lgkmcnt(1)
    v_mfma_f32_16x16x32_bf16 v[220:223], a[68:71], v[236:239], v[220:223]
    buffer_load_dwordx4 v164, s[48:51], 0 offen offset:1024 lds
    ds_read_b128 v[236:239], v161 offset:6400
    s_waitcnt lgkmcnt(1)
    v_mfma_f32_16x16x32_bf16 v[144:147], a[16:19], v[152:155], v[144:147]
    v_cvt_pk_f16_f32 v231, v190, v191
    v_pk_fma_f16 v227, v231, v231, v227
    v_mfma_f32_16x16x32_bf16 v[248:251], a[40:43], v[152:155], v[248:251]
    v_cvt_pk_f16_f32 v132, v132, v133
    v_pk_mul_f16 v224, v132, v132
    v_mfma_f32_16x16x32_bf16 v[188:191], a[48:51], v[240:243], 0
    ds_read_b128 v[240:243], v0 offset:20480
    v_cvt_pk_f16_f32 v133, v134, v135
    v_mfma_f32_16x16x32_bf16 v[188:191], a[52:55], v[116:119], v[188:191]
    ds_read_b128 v[116:119], v1 offset:20480
    v_pk_mul_f16 v226, v133, v133
    v_mfma_f32_16x16x32_bf16 v[188:191], a[56:59], v[192:195], v[188:191]
    s_waitcnt vmcnt(5)
    buffer_load_dwordx4 v166, s[48:51], 0 offen offset:2048 lds
    ds_read_b64_tr_b16 a[144:145], v136 offset:0
    v_mfma_f32_16x16x32_bf16 v[188:191], a[60:63], v[216:219], v[188:191]
    s_waitcnt lgkmcnt(3)
    ds_read_b64_tr_b16 a[146:147], v136 offset:768
    ds_read_b64_tr_b16 a[168:169], v136 offset:32
    v_mfma_f32_16x16x32_bf16 v[144:147], a[20:23], v[236:239], v[144:147]
    s_add_u32 s48, s48, 36864
    ds_read_b64_tr_b16 a[170:171], v136 offset:800
    ds_read_b64_tr_b16 a[192:193], v136 offset:64
    v_mfma_f32_16x16x32_bf16 v[248:251], a[44:47], v[236:239], v[248:251]
    s_addc_u32 s49, s49, 0
    ds_read_b64_tr_b16 a[194:195], v136 offset:832
    ds_read_b128 v[192:195], v0 offset:20608
    v_mfma_f32_16x16x32_bf16 v[188:191], a[64:67], v[152:155], v[188:191]
    s_waitcnt lgkmcnt(8)
    ds_read_b128 v[244:247], v1 offset:20608
    ds_read_b128 v[216:219], v0 offset:20736
    v_mfma_f32_16x16x32_bf16 v[188:191], a[68:71], v[236:239], v[188:191]
    s_add_u32 m0, s69, 3072
    ds_read_b128 v[236:239], v1 offset:20736
    buffer_load_dwordx4 v150, s[48:51], 0 offen lds
    v_cvt_pk_f16_f32 v134, v140, v141
    v_pk_fma_f16 v224, v134, v134, v224
    v_cvt_pk_f16_f32 v135, v142, v143
    v_pk_fma_f16 v226, v135, v135, v226
    v_cvt_pk_f16_f32 v228, v220, v221
    v_pk_fma_f16 v224, v228, v228, v224
    v_cvt_pk_f16_f32 v229, v222, v223
    v_mfma_f32_16x16x32_bf16 v[152:155], a[0:3], v[240:243], 0
    s_waitcnt lgkmcnt(7)
    v_pk_fma_f16 v226, v229, v229, v226
    v_cvt_pk_f16_f32 v144, v144, v145
    v_mfma_f32_16x16x32_bf16 v[152:155], a[4:7], v[116:119], v[152:155]
    v_pk_mul_f16 v156, v144, v144
    s_waitcnt lgkmcnt(3)
    v_mfma_f32_16x16x32_bf16 v[152:155], a[8:11], v[192:195], v[152:155]
    buffer_load_dwordx4 v164, s[48:51], 0 offen offset:1024 lds
    s_waitcnt lgkmcnt(1)
    v_mfma_f32_16x16x32_bf16 v[152:155], a[12:15], v[244:247], v[152:155]
    s_waitcnt lgkmcnt(0)
    v_cvt_pk_f16_f32 v145, v146, v147
    v_pk_mul_f16 v158, v145, v145
    v_mfma_f32_16x16x32_bf16 v[152:155], a[16:19], v[216:219], v[152:155]
    v_cvt_pk_f16_f32 v146, v248, v249
    v_pk_fma_f16 v156, v146, v146, v156
    v_mfma_f32_16x16x32_bf16 v[152:155], a[20:23], v[236:239], v[152:155]
    v_cvt_pk_f16_f32 v147, v250, v251
    v_pk_fma_f16 v158, v147, v147, v158
    v_cvt_pk_f16_f32 v252, v188, v189
    v_pk_fma_f16 v156, v252, v252, v156
    v_cvt_pk_f16_f32 v253, v190, v191
    v_mfma_f32_16x16x32_f16 v[248:251], v[40:43], v[224:227], 0
    buffer_load_dwordx4 v166, s[48:51], 0 offen offset:2048 lds
    v_pk_fma_f16 v158, v253, v253, v158
    v_mfma_f32_16x16x32_bf16 v[188:191], v[204:207], a[144:147], 0
    s_add_u32 s48, s48, 36864
    s_addc_u32 s49, s49, 0
    s_add_u32 m0, s68, 0
    v_cvt_pk_f16_f32 v140, v152, v153
    s_waitcnt vmcnt(6)
    ds_read_b64_tr_b16 a[148:149], v136 offset:3072
    ds_read_b64_tr_b16 a[150:151], v136 offset:3840
    ds_read_b64_tr_b16 a[172:173], v136 offset:3104
    ds_read_b64_tr_b16 a[174:175], v136 offset:3872
    ds_read_b64_tr_b16 a[196:197], v136 offset:3136
    ds_read_b64_tr_b16 a[198:199], v136 offset:3904
    v_rsq_f32 v250, v248
    buffer_load_dwordx4 v150, s[48:51], 0 offen lds
    v_rsq_f32 v251, v249
    v_mul_f32 v250, s31, v250
    v_cvt_pk_f16_f32 v250, v250, v251
    v_pk_mul_f16 v200, v200, v250 op_sel:[0,1] op_sel_hi:[1,1]
    v_pk_mul_f16 v201, v201, v250 op_sel:[0,1] op_sel_hi:[1,1]
    v_pk_mul_f16 v202, v202, v250 op_sel:[0,1] op_sel_hi:[1,1]
    v_pk_mul_f16 v203, v203, v250 op_sel:[0,1] op_sel_hi:[1,1]
    v_pk_mul_f16 v230, v230, v250 op_sel:[0,1] op_sel_hi:[1,1]
    v_pk_mul_f16 v231, v231, v250 op_sel:[0,1] op_sel_hi:[1,1]
    v_pk_mul_f16 v132, v132, v250 op_sel:[0,0] op_sel_hi:[1,0]
    v_pk_mul_f16 v133, v133, v250 op_sel:[0,0] op_sel_hi:[1,0]
    v_pk_mul_f16 v134, v134, v250 op_sel:[0,0] op_sel_hi:[1,0]
    s_waitcnt lgkmcnt(4)
    v_mfma_f32_16x16x32_bf16 v[188:191], v[232:235], a[148:151], v[188:191]
    s_waitcnt lgkmcnt(2)
    ds_write_b128 v168, v[200:203]
    buffer_load_dwordx4 v164, s[48:51], 0 offen offset:1024 lds
    v_pk_mul_f16 v135, v135, v250 op_sel:[0,0] op_sel_hi:[1,0]
    v_pk_mul_f16 v228, v228, v250 op_sel:[0,0] op_sel_hi:[1,0]
    v_pk_mul_f16 v229, v229, v250 op_sel:[0,0] op_sel_hi:[1,0]
    v_min3_u32 v44, v44, v248, v249
    v_max3_u32 v45, v45, v248, v249
    v_mfma_f32_16x16x32_f16 v[248:251], v[40:43], v[156:159], 0
    s_waitcnt lgkmcnt(1)
    v_pk_mul_f16 v124, v140, v140
    v_cvt_pk_f16_f32 v141, v154, v155
    v_mfma_f32_16x16x32_f16 v[152:155], v[200:203], v[132:135], 0
    ds_write_b64 v168, v[230:231] offset:48
    v_mfma_f32_16x16x32_bf16 v[200:203], v[204:207], a[168:171], 0
    v_pk_mul_f16 v126, v141, v141
    v_mfma_f32_16x16x32_bf16 v[200:203], v[232:235], a[172:175], v[200:203]
    buffer_load_dwordx4 v166, s[48:51], 0 offen offset:2048 lds
    ds_write_b128 v168, v[132:135] offset:32
    s_waitcnt vmcnt(6)
    v_mfma_f32_16x16x16_f16 v[152:155], v[230:231], v[228:229], v[152:155]
    v_rsq_f32 v250, v248
    v_rsq_f32 v251, v249
    v_mfma_f32_16x16x32_bf16 v[132:135], v[204:207], a[192:195], 0
    s_add_u32 s48, s48, 36864
    v_mul_f32 v250, s31, v250
    v_cvt_pk_f16_f32 v250, v250, v251
    v_mfma_f32_16x16x32_bf16 v[132:135], v[232:235], a[196:199], v[132:135]
    s_addc_u32 s49, s49, 0
    ds_read_b64_tr_b16 a[152:153], v137 offset:0
    ds_read_b64_tr_b16 a[154:155], v137 offset:768
    v_mfma_f32_16x16x32_bf16 v[156:159], a[24:27], v[240:243], 0
    s_add_u32 m0, s68, 3072
    ds_read_b64_tr_b16 a[176:177], v137 offset:32
    buffer_load_dwordx4 v150, s[48:51], 0 offen lds
    v_mfma_f32_16x16x32_bf16 v[156:159], a[28:31], v[116:119], v[156:159]
    ds_read_b64_tr_b16 a[178:179], v137 offset:800
    ds_read_b64_tr_b16 a[200:201], v137 offset:64
    v_mfma_f32_16x16x32_bf16 v[156:159], a[32:35], v[192:195], v[156:159]
    ds_read_b64_tr_b16 a[202:203], v137 offset:832
    v_cndmask_b32 v152, v152, v153, s[96:97]
    v_mfma_f32_16x16x32_bf16 v[156:159], a[36:39], v[244:247], v[156:159]
    ds_write_b64 v168, v[228:229] offset:72
    v_mfma_f32_16x16x32_bf16 v[156:159], a[40:43], v[216:219], v[156:159]
    v_cndmask_b32 v154, v154, v155, s[96:97]
    v_cndmask_b32 v152, v152, v154, s[98:99]
    v_mfma_f32_16x16x32_bf16 v[156:159], a[44:47], v[236:239], v[156:159]
    s_waitcnt lgkmcnt(5)
    buffer_load_dwordx4 v164, s[48:51], 0 offen offset:1024 lds
    v_add_f32 v152, s39, v152
    v_mfma_f32_16x16x32_bf16 v[188:191], v[180:183], a[152:155], v[188:191]
    s_waitcnt lgkmcnt(4)
    ds_write_b32 v149, v152 offset:192
    v_mfma_f32_16x16x32_bf16 v[232:235], a[48:51], v[240:243], 0
    s_waitcnt lgkmcnt(3)
    v_pk_mul_f16 v196, v196, v250 op_sel:[0,1] op_sel_hi:[1,1]
    v_pk_mul_f16 v197, v197, v250 op_sel:[0,1] op_sel_hi:[1,1]
    v_mfma_f32_16x16x32_bf16 v[200:203], v[180:183], a[176:179], v[200:203]
    s_waitcnt lgkmcnt(2)
    ds_read_b128 v[240:243], v160 offset:0
    v_pk_mul_f16 v198, v198, v250 op_sel:[0,1] op_sel_hi:[1,1]
    v_mfma_f32_16x16x32_bf16 v[132:135], v[180:183], a[200:203], v[132:135]
    v_pk_mul_f16 v199, v199, v250 op_sel:[0,1] op_sel_hi:[1,1]
    v_pk_mul_f16 v254, v254, v250 op_sel:[0,1] op_sel_hi:[1,1]
    v_mfma_f32_16x16x32_bf16 v[232:235], a[52:55], v[116:119], v[232:235]
    buffer_load_dwordx4 v166, s[48:51], 0 offen offset:2048 lds
    s_waitcnt vmcnt(6)
    v_mfma_f32_16x16x32_bf16 v[232:235], a[56:59], v[192:195], v[232:235]
    s_add_u32 m0, s28, 8192
    ds_read_b64_tr_b16 a[156:157], v137 offset:3072
    ds_read_b64_tr_b16 a[158:159], v137 offset:3840
    v_mfma_f32_16x16x32_bf16 v[232:235], a[60:63], v[244:247], v[232:235]
    ds_read_b64_tr_b16 a[180:181], v137 offset:3104
    ds_read_b64_tr_b16 a[182:183], v137 offset:3872
    v_mfma_f32_16x16x32_bf16 v[232:235], a[64:67], v[216:219], v[232:235]
    ds_read_b64_tr_b16 a[204:205], v137 offset:3136
    ds_read_b64_tr_b16 a[206:207], v137 offset:3904
    v_mfma_f32_16x16x32_bf16 v[232:235], a[68:71], v[236:239], v[232:235]
    s_waitcnt lgkmcnt(6)
    ds_read_b128 v[236:239], v161 offset:0
    ds_read_b128 v[180:183], v160 offset:128
    v_mfma_f32_16x16x32_bf16 v[216:219], v[240:243], a[144:147], 0
    buffer_load_dwordx4 v12, s[8:11], s25 offen nt lds
    v_mfma_f32_16x16x32_bf16 v[116:119], v[240:243], a[168:171], 0
    s_add_u32 m0, s28, 12288
    ds_read_b128 v[164:167], v161 offset:128
    ds_read_b128 v[204:207], v160 offset:256
    v_mfma_f32_16x16x32_bf16 v[192:195], v[240:243], a[192:195], 0
    s_waitcnt lgkmcnt(9)
    s_waitcnt lgkmcnt(8)
    ds_read_b128 v[240:243], v161 offset:256
    v_mfma_f32_16x16x32_bf16 v[188:191], v[184:187], a[156:159], v[188:191]
    s_waitcnt lgkmcnt(8)
    s_waitcnt lgkmcnt(7)
    ds_read_b128 v[152:155], v0 offset:20480
    v_mfma_f32_16x16x32_bf16 v[200:203], v[184:187], a[180:183], v[200:203]
    s_waitcnt lgkmcnt(7)
    s_waitcnt lgkmcnt(6)
    v_pk_mul_f16 v255, v255, v250 op_sel:[0,1] op_sel_hi:[1,1]
    v_mfma_f32_16x16x32_bf16 v[132:135], v[184:187], a[204:207], v[132:135]
    s_waitcnt lgkmcnt(5)
    buffer_load_dwordx4 v13, s[8:11], s25 offen nt lds
    v_mfma_f32_16x16x32_bf16 v[216:219], v[236:239], a[148:151], v[216:219]
    s_waitcnt lgkmcnt(4)
    ds_write_b128 v162, v[196:199]
    v_mfma_f32_16x16x32_bf16 v[216:219], v[180:183], a[152:155], v[216:219]
    s_waitcnt lgkmcnt(3)
    v_pk_mul_f16 v144, v144, v250 op_sel:[0,0] op_sel_hi:[1,0]
    v_pk_mul_f16 v145, v145, v250 op_sel:[0,0] op_sel_hi:[1,0]
    v_mfma_f32_16x16x32_bf16 v[216:219], v[164:167], a[156:159], v[216:219]
    s_add_u32 m0, s29, 0
    v_pk_mul_f16 v146, v146, v250 op_sel:[0,0] op_sel_hi:[1,0]
    v_pk_mul_f16 v147, v147, v250 op_sel:[0,0] op_sel_hi:[1,0]
    v_mfma_f32_16x16x32_bf16 v[116:119], v[236:239], a[172:175], v[116:119]
    s_waitcnt lgkmcnt(1)
    buffer_load_dwordx4 v14, s[8:11], s25 offen nt lds
    v_mfma_f32_16x16x32_f16 v[184:187], v[196:199], v[144:147], 0
    s_waitcnt vmcnt(6)
    ds_read_b64_tr_b16 a[160:161], v136 offset:0
    ds_read_b64_tr_b16 a[162:163], v136 offset:768
    v_mfma_f32_16x16x32_bf16 v[116:119], v[180:183], a[176:179], v[116:119]
    s_add_u32 m0, s69, 0
    ds_read_b64_tr_b16 a[184:185], v136 offset:32
    ds_read_b64_tr_b16 a[186:187], v136 offset:800
    v_mfma_f32_16x16x32_bf16 v[116:119], v[164:167], a[180:183], v[116:119]
    s_lshr_b32 s10, s17, 1
    ds_read_b64_tr_b16 a[208:209], v136 offset:64
    ds_read_b64_tr_b16 a[210:211], v136 offset:832
    v_mfma_f32_16x16x32_bf16 v[192:195], v[236:239], a[196:199], v[192:195]
    s_cselect_b32 s10, s36, 0
    ds_read_b128 v[196:199], v1 offset:20480
    v_pk_mul_f16 v252, v252, v250 op_sel:[0,0] op_sel_hi:[1,0]
    v_mfma_f32_16x16x32_bf16 v[192:195], v[180:183], a[200:203], v[192:195]
    s_mov_b32 s25, s24
    buffer_load_dwordx4 v172, s[52:55], 0 offen lds
    ds_read_b128 v[180:183], v0 offset:20608
    v_mfma_f32_16x16x32_bf16 v[192:195], v[164:167], a[204:207], v[192:195]
    ds_read_b128 v[164:167], v1 offset:20608
    v_pk_mul_f16 v253, v253, v250 op_sel:[0,0] op_sel_hi:[1,0]
    v_mfma_f32_16x16x32_bf16 v[236:239], v[152:155], a[144:147], 0
    s_waitcnt lgkmcnt(8)
    ds_write_b64 v162, v[254:255] offset:48
    v_mfma_f32_16x16x16_f16 v[184:187], v[254:255], v[252:253], v[184:187]
    v_cndmask_b32 v248, 1.0, v248, s[94:95]
    v_cndmask_b32 v249, 1.0, v249, s[94:95]
    v_min3_u32 v44, v44, v248, v249
    v_max3_u32 v45, v45, v248, v249
    v_mfma_f32_16x16x32_bf16 v[248:251], v[152:155], a[168:171], 0
    s_waitcnt lgkmcnt(4)
    ds_write_b128 v162, v[144:147] offset:32
    v_mfma_f32_16x16x32_bf16 v[188:191], v[208:211], a[160:163], v[188:191]
    s_waitcnt lgkmcnt(3)
    buffer_load_dwordx4 v130, s[52:55], 0 offen offset:1024 lds
    v_cndmask_b32 v184, v184, v185, s[96:97]
    v_mfma_f32_16x16x32_bf16 v[200:203], v[208:211], a[184:187], v[200:203]
    s_waitcnt lgkmcnt(2)
    v_cndmask_b32 v186, v186, v187, s[96:97]
    v_cndmask_b32 v184, v184, v186, s[98:99]
    v_mfma_f32_16x16x32_bf16 v[132:135], v[208:211], a[208:211], v[132:135]
    ds_write_b64 v162, v[252:253] offset:72
    v_mfma_f32_16x16x32_bf16 v[216:219], v[204:207], a[160:163], v[216:219]
    v_add_f32 v184, s39, v184
    v_cvt_pk_f16_f32 v142, v156, v157
    v_mfma_f32_16x16x32_bf16 v[116:119], v[204:207], a[184:187], v[116:119]
    ds_write_b32 v131, v184 offset:192
    v_mfma_f32_16x16x32_bf16 v[192:195], v[204:207], a[208:211], v[192:195]
    buffer_load_dwordx4 v139, s[52:55], 0 offen offset:2048 lds
    s_waitcnt vmcnt(6)
    v_mfma_f32_16x16x32_bf16 v[236:239], v[196:199], a[148:151], v[236:239]
    s_add_u32 s52, s52, 12288
    ds_read_b64_tr_b16 a[164:165], v136 offset:3072
    ds_read_b64_tr_b16 a[166:167], v136 offset:3840
    v_mfma_f32_16x16x32_bf16 v[236:239], v[180:183], a[152:155], v[236:239]
    s_addc_u32 s53, s53, 0
    ds_read_b64_tr_b16 a[188:189], v136 offset:3104
    ds_read_b64_tr_b16 a[190:191], v136 offset:3872
    v_mfma_f32_16x16x32_bf16 v[236:239], v[164:167], a[156:159], v[236:239]
    s_add_u32 m0, s69, 3072
    ds_read_b64_tr_b16 a[212:213], v136 offset:3136
    ds_read_b64_tr_b16 a[214:215], v136 offset:3904
    v_mfma_f32_16x16x32_bf16 v[248:251], v[196:199], a[172:175], v[248:251]
    ds_read_b128 v[160:163], v0 offset:20736
    v_pk_fma_f16 v124, v142, v142, v124
    v_mfma_f32_16x16x32_bf16 v[248:251], v[180:183], a[176:179], v[248:251]
    buffer_load_dwordx4 v172, s[52:55], 0 offen lds
    v_cvt_pk_f16_f32 v143, v158, v159
    v_mfma_f32_16x16x32_bf16 v[248:251], v[164:167], a[180:183], v[248:251]
    v_pk_fma_f16 v126, v143, v143, v126
    v_cvt_pk_f16_f32 v212, v232, v233
    v_mfma_f32_16x16x32_bf16 v[144:147], v[152:155], a[192:195], 0
    s_waitcnt lgkmcnt(6)
    v_pk_fma_f16 v124, v212, v212, v124
    v_cvt_pk_f16_f32 v213, v234, v235
    v_mfma_f32_16x16x32_bf16 v[144:147], v[196:199], a[196:199], v[144:147]
    s_waitcnt lgkmcnt(4)
    v_pk_fma_f16 v126, v213, v213, v126
    v_xor_b32 v131, 65536, v2
    v_mfma_f32_16x16x32_bf16 v[188:191], v[176:179], a[164:167], v[188:191]
    s_waitcnt lgkmcnt(2)
    v_lshrrev_b32 v150, 2, v131
    v_lshrrev_b32 v149, 8, v131
    v_mfma_f32_16x16x32_f16 v[232:235], v[40:43], v[124:127], 0
    s_waitcnt lgkmcnt(0)
    buffer_load_dwordx4 v130, s[52:55], 0 offen offset:1024 lds
    v_lshl_add_u32 v151, s16, 2, v131
    v_mfma_f32_16x16x32_bf16 v[200:203], v[176:179], a[188:191], v[200:203]
    v_cvt_pk_bf16_f32 v188, v188, v188
    v_cvt_pk_bf16_f32 v189, v189, v189
    v_mfma_f32_16x16x32_bf16 v[132:135], v[176:179], a[212:215], v[132:135]
    ds_write2_b32 v171, v188, v189 offset0:0 offset1:68
    v_mfma_f32_16x16x32_bf16 v[216:219], v[240:243], a[164:167], v[216:219]
    v_cvt_pk_bf16_f32 v190, v190, v190
    v_cvt_pk_bf16_f32 v191, v191, v191
    v_mfma_f32_16x16x32_bf16 v[116:119], v[240:243], a[188:191], v[116:119]
    ds_write2_b32 v171, v190, v191 offset0:136 offset1:204
    v_mfma_f32_16x16x32_bf16 v[192:195], v[240:243], a[212:215], v[192:195]
    buffer_load_dwordx4 v139, s[52:55], 0 offen offset:2048 lds
    v_cvt_pk_bf16_f32 v200, v200, v200
    v_mfma_f32_16x16x32_bf16 v[236:239], v[160:163], a[160:163], v[236:239]
    s_add_u32 s52, s52, 12288
    ds_read_b128 v[240:243], v1 offset:20736
    v_cvt_pk_bf16_f32 v201, v201, v201
    v_mfma_f32_16x16x32_bf16 v[248:251], v[160:163], a[184:187], v[248:251]
    s_addc_u32 s53, s53, 0
    ds_write2_b32 v171, v200, v201 offset0:16 offset1:84
    v_mfma_f32_16x16x32_bf16 v[144:147], v[180:183], a[200:203], v[144:147]
    s_add_u32 m0, s68, 0
    v_cvt_pk_bf16_f32 v202, v202, v202
    v_cvt_pk_bf16_f32 v203, v203, v203
    v_mfma_f32_16x16x32_bf16 v[144:147], v[164:167], a[204:207], v[144:147]
    ds_write2_b32 v171, v202, v203 offset0:152 offset1:220
    v_mfma_f32_16x16x32_bf16 v[144:147], v[160:163], a[208:211], v[144:147]
    v_cvt_pk_bf16_f32 v132, v132, v132
    v_cvt_pk_bf16_f32 v133, v133, v133
    v_cvt_pk_bf16_f32 v134, v134, v134
    v_cvt_pk_bf16_f32 v135, v135, v135
    ds_write2_b32 v171, v132, v133 offset0:32 offset1:100
    s_waitcnt lgkmcnt(2)
    v_mfma_f32_16x16x32_bf16 v[236:239], v[240:243], a[164:167], v[236:239]
    v_rsq_f32 v234, v232
    v_mfma_f32_16x16x32_bf16 v[248:251], v[240:243], a[188:191], v[248:251]
    ds_write2_b32 v171, v134, v135 offset0:168 offset1:236
    v_mfma_f32_16x16x32_bf16 v[144:147], v[240:243], a[212:215], v[144:147]
    v_rsq_f32 v235, v233
    v_mul_f32 v234, s31, v234
    v_cvt_pk_f16_f32 v234, v234, v235
    v_pk_mul_f16 v120, v120, v234 op_sel:[0,1] op_sel_hi:[1,1]
    v_pk_mul_f16 v121, v121, v234 op_sel:[0,1] op_sel_hi:[1,1]
    v_pk_mul_f16 v122, v122, v234 op_sel:[0,1] op_sel_hi:[1,1]
    v_pk_mul_f16 v123, v123, v234 op_sel:[0,1] op_sel_hi:[1,1]
    v_pk_mul_f16 v214, v214, v234 op_sel:[0,1] op_sel_hi:[1,1]
    v_pk_mul_f16 v215, v215, v234 op_sel:[0,1] op_sel_hi:[1,1]
    v_pk_mul_f16 v140, v140, v234 op_sel:[0,0] op_sel_hi:[1,0]
    v_pk_mul_f16 v141, v141, v234 op_sel:[0,0] op_sel_hi:[1,0]
    v_pk_mul_f16 v142, v142, v234 op_sel:[0,0] op_sel_hi:[1,0]
    v_pk_mul_f16 v143, v143, v234 op_sel:[0,0] op_sel_hi:[1,0]
    v_pk_mul_f16 v212, v212, v234 op_sel:[0,0] op_sel_hi:[1,0]
    v_pk_mul_f16 v213, v213, v234 op_sel:[0,0] op_sel_hi:[1,0]
    v_mfma_f32_16x16x32_f16 v[132:135], v[120:123], v[140:143], v[48:51]
    v_min3_u32 v44, v44, v232, v233
    v_max3_u32 v45, v45, v232, v233
    v_cvt_pk_bf16_f32 v216, v216, v216
    v_cvt_pk_bf16_f32 v217, v217, v217
    v_cvt_pk_bf16_f32 v218, v218, v218
    v_cvt_pk_bf16_f32 v219, v219, v219
    v_mfma_f32_16x16x16_f16 v[132:135], v[214:215], v[212:213], v[132:135]
    ds_write2_b32 v170, v216, v217 offset0:0 offset1:68
    v_cvt_pk_bf16_f32 v116, v116, v116
    v_cvt_pk_bf16_f32 v117, v117, v117
    v_cvt_pk_bf16_f32 v118, v118, v118
    ds_write2_b32 v170, v218, v219 offset0:136 offset1:204
    v_cvt_pk_bf16_f32 v119, v119, v119
    v_cvt_pk_bf16_f32 v192, v192, v192
    v_cvt_pk_bf16_f32 v193, v193, v193
    ds_write2_b32 v170, v116, v117 offset0:16 offset1:84
    v_cvt_pk_bf16_f32 v194, v194, v194
    v_cvt_pk_bf16_f32 v195, v195, v195
    v_cvt_pk_bf16_f32 v116, v236, v237
    ds_write2_b32 v170, v118, v119 offset0:152 offset1:220
    v_cvt_pk_bf16_f32 v117, v238, v239
    v_cvt_pk_bf16_f32 v164, v248, v249
    v_cvt_pk_bf16_f32 v165, v250, v251
    ds_write2_b32 v170, v192, v193 offset0:32 offset1:100
    v_cvt_pk_bf16_f32 v144, v144, v145
    v_cvt_pk_bf16_f32 v145, v146, v147
    v_exp_f32 v132, v132
    ds_write2_b32 v170, v194, v195 offset0:168 offset1:236
    v_exp_f32 v133, v133
    v_exp_f32 v134, v134
    v_cvt_pk_bf16_f32 v136, v132, v133
    v_exp_f32 v135, v135
    v_add_u32 v150, 62784, v150
    v_cvt_pk_bf16_f32 v137, v134, v135
    v_lshlrev_b32 v149, 4, v149
    v_add_u32 v149, 62784, v149
    v_or_b32 v132, v32, v33
    v_and_b32 v132, 0xffff, v132
    v_lshl_or_b32 v132, v132, 16, v132
    v_or_b32 v133, v32, v33
    v_and_b32 v133, 0xffff, v133
    v_lshl_or_b32 v133, v133, 16, v133
    v_or_b32 v134, v32, v33
    v_lshrrev_b32 v134, 16, v134
    v_lshl_or_b32 v134, v134, 16, v134
    v_or_b32 v135, v32, v33
    v_lshrrev_b32 v135, 16, v135
    v_lshl_or_b32 v135, v135, 16, v135
    v_xor_b32 v2, 65536, v2
    buffer_load_dwordx4 v172, s[52:55], 0 offen lds
    buffer_load_dwordx4 v130, s[52:55], 0 offen offset:1024 lds
    buffer_load_dwordx4 v139, s[52:55], 0 offen offset:2048 lds
    s_waitcnt vmcnt(9)
    s_barrier
    s_barrier
    ds_read_b128 v[248:251], v0 offset:26624
    ds_read_b128 v[232:235], v1 offset:26624
    ds_read_b128 v[160:163], v0 offset:26752
    s_add_u32 s52, s52, 12288
    s_addc_u32 s53, s53, 0
    ds_read_b128 v[216:219], v1 offset:26752
    s_add_u32 m0, s68, 3072
    s_mul_i32 s68, s78, 72
    s_sub_u32 s68, s77, s68
    ds_read_b128 v[192:195], v0 offset:26880
    s_mul_i32 s78, s78, 1373568
    s_mul_i32 s77, s68, 2688
    s_add_u32 s77, s77, s78
    ds_read_b128 v[168:171], v1 offset:26880
    buffer_load_dwordx4 v172, s[52:55], 0 offen lds
    s_waitcnt lgkmcnt(5)
    v_mfma_f32_16x16x32_bf16 v[240:243], a[72:75], v[248:251], 0
    s_waitcnt lgkmcnt(4)
    v_mfma_f32_16x16x32_bf16 v[240:243], a[76:79], v[232:235], v[240:243]
    s_waitcnt lgkmcnt(2)
    v_mfma_f32_16x16x32_bf16 v[240:243], a[80:83], v[160:163], v[240:243]
    s_waitcnt lgkmcnt(1)
    v_mfma_f32_16x16x32_bf16 v[240:243], a[84:87], v[216:219], v[240:243]
    s_waitcnt lgkmcnt(0)
    buffer_load_dwordx4 v130, s[52:55], 0 offen offset:1024 lds
    v_mfma_f32_16x16x32_bf16 v[240:243], a[88:91], v[192:195], v[240:243]
    v_mfma_f32_16x16x32_bf16 v[240:243], a[92:95], v[168:171], v[240:243]
    v_mfma_f32_16x16x32_bf16 v[180:183], a[96:99], v[248:251], 0
    s_waitcnt vmcnt(8)
    ds_read_b64 a[216:217], v148 offset:0
    ds_read_b64 a[218:219], v148 offset:1536
    v_mfma_f32_16x16x32_bf16 v[180:183], a[100:103], v[232:235], v[180:183]
    ds_read_b64 a[240:241], v148 offset:8
    ds_read_b64 a[242:243], v148 offset:1544
    v_mfma_f32_16x16x32_bf16 v[180:183], a[104:107], v[160:163], v[180:183]
    buffer_load_dwordx4 v139, s[52:55], 0 offen offset:2048 lds
    ds_read_b64 v[92:93], v175 offset:0
    v_mfma_f32_16x16x32_bf16 v[180:183], a[108:111], v[216:219], v[180:183]
    s_add_u32 s52, s52, 12288
    ds_read_b64 v[94:95], v175 offset:1536
    v_cvt_pk_f16_f32 v240, v240, v241
    v_mfma_f32_16x16x32_bf16 v[180:183], a[112:115], v[192:195], v[180:183]
    s_addc_u32 s53, s53, 0
    v_pk_mul_f16 v237, v240, v240
    v_cvt_pk_f16_f32 v241, v242, v243
    v_mfma_f32_16x16x32_bf16 v[180:183], a[116:119], v[168:171], v[180:183]
    s_add_u32 m0, s69, 0
    v_pk_mul_f16 v239, v241, v241
    v_mfma_f32_16x16x32_bf16 v[176:179], a[120:123], v[248:251], 0
    s_waitcnt lgkmcnt(5)
    v_mfma_f32_16x16x32_bf16 v[176:179], a[124:127], v[232:235], v[176:179]
    s_waitcnt lgkmcnt(3)
    v_mfma_f32_16x16x32_bf16 v[176:179], a[128:131], v[160:163], v[176:179]
    s_waitcnt lgkmcnt(2)
    v_cvt_pk_f16_f32 v242, v180, v181
    v_pk_fma_f16 v237, v242, v242, v237
    v_mfma_f32_16x16x32_bf16 v[176:179], a[132:135], v[216:219], v[176:179]
    s_waitcnt lgkmcnt(0)
    buffer_load_dwordx4 v172, s[52:55], 0 offen lds
    v_cvt_pk_f16_f32 v243, v182, v183
    v_mfma_f32_16x16x32_bf16 v[176:179], a[136:139], v[192:195], v[176:179]
    v_pk_fma_f16 v239, v243, v243, v239
    v_mfma_f32_16x16x32_bf16 v[176:179], a[140:143], v[168:171], v[176:179]
    v_mfma_f32_16x16x32_bf16 v[180:183], a[0:3], v[248:251], 0
    v_mfma_f32_16x16x32_bf16 v[180:183], a[4:7], v[232:235], v[180:183]
    s_waitcnt vmcnt(7)
    ds_read_b64 a[232:233], v148 offset:3072
    ds_read_b64 a[220:221], v148 offset:4608
    v_mfma_f32_16x16x32_bf16 v[180:183], a[8:11], v[160:163], v[180:183]
    buffer_load_dwordx4 v130, s[52:55], 0 offen offset:1024 lds
    ds_read_b64 v[84:85], v148 offset:3080
    v_mfma_f32_16x16x32_bf16 v[180:183], a[12:15], v[216:219], v[180:183]
    ds_read_b64 a[244:245], v148 offset:4616
    ds_read_b64 v[108:109], v175 offset:3072
    v_mfma_f32_16x16x32_bf16 v[180:183], a[16:19], v[192:195], v[180:183]
    ds_read_b64 v[96:97], v175 offset:4608
    v_cvt_pk_f16_f32 v126, v176, v177
    v_mfma_f32_16x16x32_bf16 v[180:183], a[20:23], v[168:171], v[180:183]
    v_pk_fma_f16 v237, v126, v126, v237
    v_cvt_pk_f16_f32 v127, v178, v179
    v_mfma_f32_16x16x32_bf16 v[176:179], a[24:27], v[248:251], 0
    v_pk_fma_f16 v239, v127, v127, v239
    v_mfma_f32_16x16x32_bf16 v[176:179], a[28:31], v[232:235], v[176:179]
    s_waitcnt lgkmcnt(5)
    buffer_load_dwordx4 v139, s[52:55], 0 offen offset:2048 lds
    s_add_u32 s52, s52, 12288
    v_mfma_f32_16x16x32_bf16 v[176:179], a[32:35], v[160:163], v[176:179]
    s_addc_u32 s53, s53, 0
    v_cvt_pk_f16_f32 v180, v180, v181
    v_pk_mul_f16 v236, v180, v180
    v_mfma_f32_16x16x32_bf16 v[176:179], a[36:39], v[216:219], v[176:179]
    s_add_u32 m0, s69, 3072
    v_cvt_pk_f16_f32 v181, v182, v183
    v_pk_mul_f16 v238, v181, v181
    v_mfma_f32_16x16x32_bf16 v[176:179], a[40:43], v[192:195], v[176:179]
    s_waitcnt lgkmcnt(0)
    s_add_u32 s69, s77, 589824
    v_mfma_f32_16x16x32_bf16 v[176:179], a[44:47], v[168:171], v[176:179]
    v_mfma_f32_16x16x32_bf16 v[200:203], a[48:51], v[248:251], 0
    buffer_load_dwordx4 v172, s[52:55], 0 offen lds
    v_mfma_f32_16x16x32_bf16 v[200:203], a[52:55], v[232:235], v[200:203]
    v_mfma_f32_16x16x32_bf16 v[200:203], a[56:59], v[160:163], v[200:203]
    s_waitcnt vmcnt(7)
    ds_read_b64 a[222:223], v173 offset:0
    ds_read_b64 a[234:235], v173 offset:1536
    v_mfma_f32_16x16x32_bf16 v[200:203], a[60:63], v[216:219], v[200:203]
    ds_read_b64 a[246:247], v173 offset:8
    ds_read_b64 v[86:87], v173 offset:1544
    v_mfma_f32_16x16x32_bf16 v[200:203], a[64:67], v[192:195], v[200:203]
    ds_read_b64 v[98:99], v174 offset:0
    ds_read_b64 v[110:111], v174 offset:1536
    v_mfma_f32_16x16x32_bf16 v[200:203], a[68:71], v[168:171], v[200:203]
    buffer_load_dwordx4 v130, s[52:55], 0 offen offset:1024 lds
    v_cvt_pk_f16_f32 v182, v176, v177
    v_mfma_f32_16x16x32_bf16 v[188:191], v[248:251], a[144:147], 0
    v_pk_fma_f16 v236, v182, v182, v236
    v_cvt_pk_f16_f32 v183, v178, v179
    v_mfma_f32_16x16x32_bf16 v[188:191], v[232:235], a[148:151], v[188:191]
    v_pk_fma_f16 v238, v183, v183, v238
    v_mfma_f32_16x16x32_bf16 v[188:191], v[160:163], a[152:155], v[188:191]
    s_waitcnt lgkmcnt(5)
    v_cvt_pk_f16_f32 v124, v200, v201
    v_pk_fma_f16 v236, v124, v124, v236
    v_mfma_f32_16x16x32_bf16 v[188:191], v[216:219], a[156:159], v[188:191]
    s_waitcnt lgkmcnt(3)
    v_cvt_pk_f16_f32 v125, v202, v203
    v_pk_fma_f16 v238, v125, v125, v238
    v_mfma_f32_16x16x32_bf16 v[188:191], v[192:195], a[160:163], v[188:191]
    s_waitcnt lgkmcnt(1)
    buffer_load_dwordx4 v139, s[52:55], 0 offen offset:2048 lds
    s_add_u32 m0, s28, 65536
    v_mfma_f32_16x16x32_f16 v[176:179], v[40:43], v[236:239], 0
    s_waitcnt lgkmcnt(0)
    v_mfma_f32_16x16x32_bf16 v[188:191], v[168:171], a[164:167], v[188:191]
    ds_read_b128 v[236:239], v0 offset:32768
    v_mfma_f32_16x16x32_bf16 v[196:199], v[248:251], a[168:171], 0
    ds_read_b128 v[200:203], v1 offset:32768
    v_mfma_f32_16x16x32_bf16 v[196:199], v[232:235], a[172:175], v[196:199]
    ds_read_b128 v[184:187], v0 offset:32896
    s_waitcnt vmcnt(6)
    v_mfma_f32_16x16x32_bf16 v[196:199], v[160:163], a[176:179], v[196:199]
    buffer_load_dwordx4 v10, s[8:11], s24 offen nt lds
    v_mfma_f32_16x16x32_bf16 v[196:199], v[216:219], a[180:183], v[196:199]
    s_add_u32 m0, s28, 69632
    ds_read_b64 a[224:225], v173 offset:3072
    ds_read_b64 a[226:227], v173 offset:4608
    v_mfma_f32_16x16x32_bf16 v[196:199], v[192:195], a[184:187], v[196:199]
    ds_read_b64 a[248:249], v173 offset:3080
    ds_read_b64 a[250:251], v173 offset:4616
    v_mfma_f32_16x16x32_bf16 v[196:199], v[168:171], a[188:191], v[196:199]
    s_waitcnt lgkmcnt(6)
    ds_read_b64 v[100:101], v174 offset:3072
    ds_read_b64 v[102:103], v174 offset:4608
    v_mfma_f32_16x16x32_bf16 v[204:207], v[248:251], a[192:195], 0
    s_waitcnt lgkmcnt(7)
    ds_read_b128 v[152:155], v1 offset:32896
    ds_read_b128 v[248:251], v0 offset:33024
    v_mfma_f32_16x16x32_bf16 v[204:207], v[232:235], a[196:199], v[204:207]
    s_waitcnt lgkmcnt(8)
    buffer_load_dwordx4 v11, s[8:11], s24 offen nt lds
    v_mfma_f32_16x16x32_bf16 v[204:207], v[160:163], a[200:203], v[204:207]
    s_add_u32 m0, s28, 73728
    ds_read_b128 v[232:235], v1 offset:33024
    v_min3_u32 v44, v44, v176, v177
    v_mfma_f32_16x16x32_bf16 v[204:207], v[216:219], a[204:207], v[204:207]
    s_waitcnt lgkmcnt(8)
    v_rsq_f32 v178, v176
    v_mfma_f32_16x16x32_bf16 v[204:207], v[192:195], a[208:211], v[204:207]
    s_waitcnt lgkmcnt(6)
    v_rsq_f32 v179, v177
    v_mfma_f32_16x16x32_bf16 v[204:207], v[168:171], a[212:215], v[204:207]
    s_waitcnt lgkmcnt(4)
    v_mul_f32 v178, s31, v178
    v_cvt_pk_f16_f32 v178, v178, v179
    v_mfma_f32_16x16x32_bf16 v[160:163], a[72:75], v[236:239], 0
    s_waitcnt lgkmcnt(2)
    buffer_load_dwordx4 v12, s[8:11], s24 offen nt lds
    v_mfma_f32_16x16x32_bf16 v[160:163], a[76:79], v[200:203], v[160:163]
    s_add_u32 m0, s28, 77824
    v_pk_mul_f16 v240, v240, v178 op_sel:[0,1] op_sel_hi:[1,1]
    v_pk_mul_f16 v241, v241, v178 op_sel:[0,1] op_sel_hi:[1,1]
    v_mfma_f32_16x16x32_bf16 v[160:163], a[80:83], v[184:187], v[160:163]
    s_waitcnt vmcnt(6)
    ds_read_b64 a[236:237], v148 offset:0
    ds_read_b64 a[228:229], v148 offset:1536
    v_mfma_f32_16x16x32_bf16 v[160:163], a[84:87], v[152:155], v[160:163]
    s_waitcnt lgkmcnt(2)
    ds_read_b64 v[88:89], v148 offset:8
    ds_read_b64 a[252:253], v148 offset:1544
    v_mfma_f32_16x16x32_bf16 v[160:163], a[88:91], v[248:251], v[160:163]
    ds_read_b64 v[112:113], v175 offset:0
    ds_read_b64 v[104:105], v175 offset:1536
    v_mfma_f32_16x16x32_bf16 v[160:163], a[92:95], v[232:235], v[160:163]
    buffer_load_dwordx4 v13, s[8:11], s24 offen nt lds
    v_mfma_f32_16x16x32_bf16 v[192:195], a[96:99], v[236:239], 0
    s_add_u32 m0, s74, 0
    v_pk_mul_f16 v242, v242, v178 op_sel:[0,1] op_sel_hi:[1,1]
    v_pk_mul_f16 v243, v243, v178 op_sel:[0,1] op_sel_hi:[1,1]
    v_mfma_f32_16x16x32_bf16 v[192:195], a[100:103], v[200:203], v[192:195]
    v_pk_mul_f16 v126, v126, v178 op_sel:[0,1] op_sel_hi:[1,1]
    v_pk_mul_f16 v127, v127, v178 op_sel:[0,1] op_sel_hi:[1,1]
    v_mfma_f32_16x16x32_bf16 v[192:195], a[104:107], v[184:187], v[192:195]
    s_waitcnt lgkmcnt(5)
    v_pk_mul_f16 v180, v180, v178 op_sel:[0,0] op_sel_hi:[1,0]
    v_pk_mul_f16 v181, v181, v178 op_sel:[0,0] op_sel_hi:[1,0]
    v_mfma_f32_16x16x32_bf16 v[192:195], a[108:111], v[152:155], v[192:195]
    s_waitcnt lgkmcnt(3)
    v_pk_mul_f16 v182, v182, v178 op_sel:[0,0] op_sel_hi:[1,0]
    v_pk_mul_f16 v183, v183, v178 op_sel:[0,0] op_sel_hi:[1,0]
    v_mfma_f32_16x16x32_bf16 v[192:195], a[112:115], v[248:251], v[192:195]
    s_waitcnt lgkmcnt(1)
    buffer_load_dwordx4 v14, s[8:11], s24 offen nt lds
    v_mfma_f32_16x16x32_bf16 v[192:195], a[116:119], v[232:235], v[192:195]
    s_add_u32 s8, s60, s23
    v_pk_mul_f16 v124, v124, v178 op_sel:[0,0] op_sel_hi:[1,0]
    v_pk_mul_f16 v125, v125, v178 op_sel:[0,0] op_sel_hi:[1,0]
    v_mfma_f32_16x16x32_bf16 v[168:171], a[120:123], v[236:239], 0
    s_addc_u32 s9, s61, 0
    v_max3_u32 v45, v45, v176, v177
    v_cvt_pk_bf16_f32 v118, v188, v189
    v_mfma_f32_16x16x32_bf16 v[168:171], a[124:127], v[200:203], v[168:171]
    s_sub_u32 s10, s36, s23
    v_cvt_pk_bf16_f32 v119, v190, v191
    v_cvt_pk_bf16_f32 v166, v196, v197
    v_mfma_f32_16x16x32_bf16 v[168:171], a[128:131], v[184:187], v[168:171]
    s_cmp_lt_u32 s34, s17
    v_cvt_pk_bf16_f32 v167, v198, v199
    v_cvt_pk_bf16_f32 v146, v204, v205
    v_mfma_f32_16x16x32_bf16 v[168:171], a[132:135], v[152:155], v[168:171]
    s_cselect_b32 s10, s10, 0
    v_cvt_pk_bf16_f32 v147, v206, v207
    v_cvt_pk_f16_f32 v172, v160, v161
    v_mfma_f32_16x16x32_bf16 v[168:171], a[136:139], v[248:251], v[168:171]
    s_add_u32 m0, s28, 0
    v_pk_mul_f16 v161, v172, v172
    s_waitcnt vmcnt(5)
    v_mfma_f32_16x16x32_bf16 v[168:171], a[140:143], v[232:235], v[168:171]
    s_mov_b32 s24, s23
    ds_read_b64 a[230:231], v148 offset:3072
    ds_read_b64 a[238:239], v148 offset:4608
    v_mfma_f32_16x16x32_bf16 v[216:219], a[0:3], v[236:239], 0
    s_add_u32 s23, s23, s21
    ds_read_b64 a[254:255], v148 offset:3080
    ds_read_b64 v[90:91], v148 offset:4616
    v_mfma_f32_16x16x32_bf16 v[216:219], a[4:7], v[200:203], v[216:219]
    s_cmp_ge_u32 s19, 72
    ds_read_b64 v[106:107], v175 offset:3072
    ds_read_b64 v[114:115], v175 offset:4608
    v_mfma_f32_16x16x32_bf16 v[216:219], a[8:11], v[184:187], v[216:219]
    s_cselect_b32 s34, 72, 0
    v_cvt_pk_f16_f32 v173, v162, v163
    v_pk_mul_f16 v163, v173, v173
    v_mfma_f32_16x16x32_bf16 v[216:219], a[12:15], v[152:155], v[216:219]
    s_cselect_b32 s35, s22, 0
    v_cvt_pk_f16_f32 v174, v192, v193
    v_pk_fma_f16 v161, v174, v174, v161
    v_mfma_f32_16x16x32_bf16 v[216:219], a[16:19], v[248:251], v[216:219]
    s_sub_u32 s19, s19, s34
    v_cvt_pk_f16_f32 v175, v194, v195
    v_pk_fma_f16 v163, v175, v175, v163
    v_mfma_f32_16x16x32_bf16 v[216:219], a[20:23], v[232:235], v[216:219]
    s_waitcnt lgkmcnt(5)
    v_cvt_pk_f16_f32 v178, v168, v169
    v_pk_fma_f16 v161, v178, v178, v161
    v_mfma_f32_16x16x32_bf16 v[192:195], a[24:27], v[236:239], 0
    s_waitcnt lgkmcnt(3)
    v_cvt_pk_f16_f32 v179, v170, v171
    v_pk_fma_f16 v163, v179, v179, v163
    v_mfma_f32_16x16x32_bf16 v[192:195], a[28:31], v[200:203], v[192:195]
    s_add_u32 s23, s23, s35
    v_cvt_pk_f16_f32 v168, v216, v217
    v_pk_mul_f16 v160, v168, v168
    v_mfma_f32_16x16x32_bf16 v[192:195], a[32:35], v[184:187], v[192:195]
    s_waitcnt lgkmcnt(0)
    v_cvt_pk_f16_f32 v169, v218, v219
    v_pk_mul_f16 v162, v169, v169
    v_mfma_f32_16x16x32_bf16 v[192:195], a[36:39], v[152:155], v[192:195]
    v_xor_b32 v0, 65536, v0
    v_xor_b32 v1, 65536, v1
    v_mfma_f32_16x16x32_bf16 v[192:195], a[40:43], v[248:251], v[192:195]
    v_mfma_f32_16x16x32_bf16 v[192:195], a[44:47], v[232:235], v[192:195]
    v_mfma_f32_16x16x32_bf16 v[204:207], a[48:51], v[236:239], 0
    v_mfma_f32_16x16x32_bf16 v[204:207], a[52:55], v[200:203], v[204:207]
    v_mfma_f32_16x16x32_bf16 v[204:207], a[56:59], v[184:187], v[204:207]
    v_mfma_f32_16x16x32_bf16 v[204:207], a[60:63], v[152:155], v[204:207]
    v_mfma_f32_16x16x32_bf16 v[204:207], a[64:67], v[248:251], v[204:207]
    v_mfma_f32_16x16x32_bf16 v[204:207], a[68:71], v[232:235], v[204:207]
    v_mfma_f32_16x16x32_bf16 v[188:191], v[236:239], a[144:147], 0
    v_mfma_f32_16x16x32_bf16 v[188:191], v[200:203], a[148:151], v[188:191]
    v_cvt_pk_f16_f32 v170, v192, v193
    v_pk_fma_f16 v160, v170, v170, v160
    v_mfma_f32_16x16x32_bf16 v[188:191], v[184:187], a[152:155], v[188:191]
    ds_read_b128 v[216:219], v5 offset:0
    ds_read_b128 v[196:199], v5 offset:16
    v_mfma_f32_16x16x32_bf16 v[188:191], v[152:155], a[156:159], v[188:191]
    ds_read_b128 v[156:159], v5 offset:48
    ds_read_b32 v130, v6 offset:192
    v_mfma_f32_16x16x32_bf16 v[188:191], v[248:251], a[160:163], v[188:191]
    v_cvt_pk_f16_f32 v171, v194, v195
    v_pk_fma_f16 v162, v171, v171, v162
    v_mfma_f32_16x16x32_bf16 v[188:191], v[232:235], a[164:167], v[188:191]
    v_cvt_pk_f16_f32 v176, v204, v205
    v_pk_fma_f16 v160, v176, v176, v160
    v_mfma_f32_16x16x32_f16 v[192:195], v[240:243], v[140:143], v[52:55]
    v_cvt_pk_f16_f32 v177, v206, v207
    v_pk_fma_f16 v162, v177, v177, v162
    v_mfma_f32_16x16x32_bf16 v[204:207], v[236:239], a[168:171], 0
    v_add_u32 v5, 336, v5
    v_mfma_f32_16x16x32_f16 v[208:211], v[40:43], v[160:163], 0
    s_waitcnt lgkmcnt(3)
    v_cvt_pk_bf16_f32 v188, v188, v189
    v_cvt_pk_bf16_f32 v189, v190, v191
    v_mfma_f32_16x16x32_f16 v[160:163], v[216:219], v[140:143], v[22:25]
    s_waitcnt lgkmcnt(1)
    v_mfma_f32_16x16x32_f16 v[160:163], v[196:199], v[120:123], v[160:163]
    s_waitcnt lgkmcnt(0)
    v_mfma_f32_16x16x32_f16 v[160:163], v[156:159], v[212:215], v[160:163]
    v_rsq_f32 v210, v208
    v_min3_u32 v44, v44, v208, v209
    v_mfma_f32_16x16x16_f16 v[192:195], v[126:127], v[212:213], v[192:195]
    v_rsq_f32 v211, v209
    v_mul_f32 v210, s31, v210
    v_cvt_pk_f16_f32 v210, v210, v211
    v_mfma_f32_16x16x32_bf16 v[204:207], v[200:203], a[172:175], v[204:207]
    v_pk_mul_f16 v172, v172, v210 op_sel:[0,1] op_sel_hi:[1,1]
    v_mov_b32_dpp v130, v161 quad_perm:[0,1,2,3] row_mask:0x1 bank_mask:0xf
    v_mfma_f32_16x16x32_bf16 v[204:207], v[184:187], a[176:179], v[204:207]
    v_pk_mul_f16 v173, v173, v210 op_sel:[0,1] op_sel_hi:[1,1]
    v_pk_mul_f16 v174, v174, v210 op_sel:[0,1] op_sel_hi:[1,1]
    v_mfma_f32_16x16x32_bf16 v[204:207], v[152:155], a[180:183], v[204:207]
    ds_read2_b32 v[190:191], v6 offset0:0 offset1:0
    ds_read2_b32 v[162:163], v6 offset0:16 offset1:16
    v_mfma_f32_16x16x32_bf16 v[204:207], v[248:251], a[184:187], v[204:207]
    ds_read2_b32 v[230:231], v6 offset0:32 offset1:32
    v_pk_mul_f16 v175, v175, v210 op_sel:[0,1] op_sel_hi:[1,1]
    v_mfma_f32_16x16x32_bf16 v[204:207], v[232:235], a[188:191], v[204:207]
    v_pk_mul_f16 v178, v178, v210 op_sel:[0,1] op_sel_hi:[1,1]
    v_pk_mul_f16 v179, v179, v210 op_sel:[0,1] op_sel_hi:[1,1]
    v_pk_mul_f16 v168, v168, v210 op_sel:[0,0] op_sel_hi:[1,0]
    v_pk_mul_f16 v169, v169, v210 op_sel:[0,0] op_sel_hi:[1,0]
    v_pk_mul_f16 v170, v170, v210 op_sel:[0,0] op_sel_hi:[1,0]
    v_pk_mul_f16 v171, v171, v210 op_sel:[0,0] op_sel_hi:[1,0]
    v_pk_mul_f16 v176, v176, v210 op_sel:[0,0] op_sel_hi:[1,0]
    v_pk_mul_f16 v177, v177, v210 op_sel:[0,0] op_sel_hi:[1,0]
    v_max3_u32 v45, v45, v208, v209
    v_mfma_f32_16x16x32_f16 v[208:211], v[172:175], v[140:143], v[56:59]
    v_exp_f32 v192, v192
    v_mfma_f32_16x16x32_bf16 v[140:143], v[236:239], a[192:195], 0
    v_exp_f32 v193, v193
    v_mfma_f32_16x16x32_bf16 v[140:143], v[200:203], a[196:199], v[140:143]
    s_waitcnt lgkmcnt(1)
    v_cvt_pk_bf16_f32 v138, v192, v193
    v_exp_f32 v194, v194
    v_mfma_f32_16x16x16_f16 v[208:211], v[178:179], v[212:213], v[208:211]
    v_exp_f32 v195, v195
    v_exp_f32 v160, v160
    v_mfma_f32_16x16x32_f16 v[236:239], v[216:219], v[168:171], v[26:29]
    s_waitcnt lgkmcnt(0)
    v_cvt_pk_bf16_f32 v139, v194, v195
    v_cvt_pk_bf16_f32 v39, v160, 0
    v_mfma_f32_16x16x32_f16 v[236:239], v[196:199], v[172:175], v[236:239]
    v_cvt_pk_bf16_f32 v160, v204, v205
    v_cvt_pk_bf16_f32 v161, v206, v207
    v_mfma_f32_16x16x32_f16 v[236:239], v[156:159], v[176:179], v[236:239]
    v_exp_f32 v208, v208
    v_mfma_f32_16x16x32_bf16 v[140:143], v[184:187], a[200:203], v[140:143]
    v_exp_f32 v209, v209
    v_mfma_f32_16x16x32_bf16 v[140:143], v[152:155], a[204:207], v[140:143]
    v_cvt_pk_bf16_f32 v36, v208, v209
    v_add_u32 v6, 272, v6
    v_mfma_f32_16x16x32_bf16 v[140:143], v[248:251], a[208:211], v[140:143]
    v_exp_f32 v210, v210
    v_mfma_f32_16x16x32_bf16 v[140:143], v[232:235], a[212:215], v[140:143]
    v_exp_f32 v211, v211
    v_mfma_f32_16x16x32_f16 v[248:251], v[216:219], v[180:183], v[24:27]
    v_exp_f32 v236, v236
    v_mfma_f32_16x16x32_f16 v[248:251], v[196:199], v[240:243], v[248:251]
    v_cvt_pk_bf16_f32 v37, v210, v211
    v_mfma_f32_16x16x32_f16 v[248:251], v[156:159], v[124:127], v[248:251]
    v_mfma_f32_16x16x32_f16 v[232:235], v[120:123], v[180:183], v[60:63]
    v_mfma_f32_16x16x32_bf16 v[192:195], v[28:31], v[36:39], 0
    v_cvt_pk_bf16_f32 v228, v140, v141
    v_cvt_pk_bf16_f32 v229, v142, v143
    v_mfma_f32_16x16x32_bf16 v[192:195], v[28:31], v[136:139], v[192:195]
    v_mfma_f32_16x16x32_bf16 v[216:219], v[188:191], v[36:39], 0
    v_mfma_f32_16x16x32_bf16 v[216:219], v[116:119], v[136:139], v[216:219]
    v_mfma_f32_16x16x32_bf16 v[140:143], v[160:163], v[36:39], 0
    v_exp_f32 v248, v248
    v_mfma_f32_16x16x32_bf16 v[140:143], v[164:167], v[136:139], v[140:143]
    v_mov_b32_dpp v130, v249 quad_perm:[0,1,2,3] row_mask:0x2 bank_mask:0xf
    v_mov_b32_dpp v130, v237 quad_perm:[0,1,2,3] row_mask:0x4 bank_mask:0xf
    v_mfma_f32_16x16x32_bf16 v[200:203], v[228:231], v[36:39], 0
    v_rcp_f32 v192, v192
    v_mfma_f32_16x16x32_bf16 v[200:203], v[144:147], v[136:139], v[200:203]
    v_mul_f32 v216, v192, v216
    v_mul_f32 v217, v192, v217
    v_mfma_f32_16x16x32_f16 v[136:139], v[240:243], v[180:183], v[64:67]
    v_cvt_pk_bf16_f32 v216, v216, v217
    v_mul_f32 v218, v192, v218
    v_mfma_f32_16x16x32_f16 v[184:187], v[172:175], v[180:183], v[68:71]
    v_mul_f32 v219, v192, v219
    v_cvt_pk_bf16_f32 v217, v218, v219
    v_mul_f32 v140, v192, v140
    v_mfma_f32_16x16x16_f16 v[232:235], v[214:215], v[124:125], v[232:235]
    v_mul_f32 v141, v192, v141
    v_cvt_pk_bf16_f32 v218, v140, v141
    v_mul_f32 v142, v192, v142
    v_mfma_f32_16x16x16_f16 v[136:139], v[126:127], v[124:125], v[136:139]
    v_mul_f32 v143, v192, v143
    v_cvt_pk_bf16_f32 v219, v142, v143
    v_mul_f32 v200, v192, v200
    v_mfma_f32_16x16x16_f16 v[184:187], v[178:179], v[124:125], v[184:187]
    v_mul_f32 v201, v192, v201
    v_cvt_pk_bf16_f32 v238, v200, v201
    v_mul_f32 v202, v192, v202
    v_mul_f32 v203, v192, v203
    v_mfma_f32_16x16x32_bf16 v[140:143], v[132:135], a[216:219], 0
    v_cvt_pk_bf16_f32 v239, v202, v203
    v_cvt_pk_bf16_f32 v39, v248, 0
    v_mfma_f32_16x16x32_bf16 v[140:143], v[132:135], a[240:243], v[140:143]
    v_exp_f32 v130, v130
    v_mfma_f32_16x16x32_bf16 v[140:143], v[132:135], v[92:95], v[140:143]
    v_exp_f32 v232, v232
    v_mfma_f32_16x16x32_f16 v[180:183], v[120:123], v[168:171], v[72:75]
    v_exp_f32 v233, v233
    v_mfma_f32_16x16x32_bf16 v[248:251], v[132:135], a[220:223], 0
    v_cvt_pk_bf16_f32 v130, v130, v130
    v_cvt_pk_bf16_f32 v120, v232, v233
    v_mfma_f32_16x16x32_bf16 v[248:251], v[132:135], a[244:247], v[248:251]
    ds_write_b16 v8, v130
    v_mov_b32 v130, v140
    v_mfma_f32_16x16x16_f16 v[180:183], v[214:215], v[176:177], v[180:183]
    v_mov_b32_dpp v130, v141 quad_perm:[0,1,2,3] row_mask:0x2 bank_mask:0xf
    v_exp_f32 v234, v234
    v_mfma_f32_16x16x32_bf16 v[248:251], v[132:135], v[96:99], v[248:251]
    v_exp_f32 v235, v235
    v_mfma_f32_16x16x32_bf16 v[140:143], v[132:135], a[232:235], 0
    v_exp_f32 v136, v136
    v_mfma_f32_16x16x32_f16 v[192:195], v[240:243], v[168:171], v[76:79]
    v_exp_f32 v137, v137
    v_mfma_f32_16x16x32_bf16 v[140:143], v[132:135], v[84:87], v[140:143]
    v_exp_f32 v180, v180
    v_mfma_f32_16x16x32_bf16 v[140:143], v[132:135], v[108:111], v[140:143]
    v_mov_b32 v148, v249
    v_cvt_pk_bf16_f32 v121, v234, v235
    v_cvt_pk_bf16_f32 v122, v136, v137
    v_mfma_f32_16x16x16_f16 v[192:195], v[126:127], v[176:177], v[192:195]
    v_exp_f32 v181, v181
    v_exp_f32 v182, v182
    v_mfma_f32_16x16x32_bf16 v[232:235], v[132:135], a[224:227], 0
    ds_read_b128 v[124:127], v9
    ds_read_b128 v[240:243], v9 offset:64
    v_mfma_f32_16x16x32_bf16 v[232:235], v[132:135], a[248:251], v[232:235]
    v_mov_b32_dpp v130, v140 quad_perm:[0,1,2,3] row_mask:0x4 bank_mask:0xf
    v_mov_b32_dpp v130, v248 quad_perm:[0,1,2,3] row_mask:0x8 bank_mask:0xf
    v_mfma_f32_16x16x32_bf16 v[232:235], v[132:135], v[100:103], v[232:235]
    ds_write_b32 v151, v130 offset:18432
    v_mfma_f32_16x16x32_bf16 v[200:203], v[132:135], a[228:231], 0
    v_mov_b32_dpp v148, v141 quad_perm:[0,1,2,3] row_mask:0x2 bank_mask:0xf
    v_cvt_pk_bf16_f32 v140, v180, v181
    v_mfma_f32_16x16x32_bf16 v[200:203], v[132:135], a[252:255], v[200:203]
    v_exp_f32 v183, v183
    v_mfma_f32_16x16x32_bf16 v[200:203], v[132:135], v[104:107], v[200:203]
    v_exp_f32 v192, v192
    v_mfma_f32_16x16x32_bf16 v[248:251], v[132:135], a[236:239], 0
    s_waitcnt lgkmcnt(2)
    v_mov_b32_dpp v148, v232 quad_perm:[0,1,2,3] row_mask:0x4 bank_mask:0xf
    v_mov_b32_dpp v148, v233 quad_perm:[0,1,2,3] row_mask:0x8 bank_mask:0xf
    v_mfma_f32_16x16x32_bf16 v[232:235], v[124:127], v[28:31], 0
    s_waitcnt lgkmcnt(1)
    ds_write_b32 v151, v148 offset:19456
    v_mfma_f32_16x16x32_bf16 v[232:235], v[240:243], v[28:31], v[232:235]
    v_exp_f32 v193, v193
    v_mfma_f32_16x16x32_bf16 v[212:215], v[124:127], v[116:119], 0
    v_cvt_pk_bf16_f32 v141, v182, v183
    v_cvt_pk_bf16_f32 v142, v192, v193
    v_mfma_f32_16x16x32_bf16 v[212:215], v[240:243], v[188:191], v[212:215]
    v_exp_f32 v194, v194
    v_mfma_f32_16x16x32_bf16 v[180:183], v[124:127], v[164:167], 0
    v_exp_f32 v195, v195
    v_mfma_f32_16x16x32_bf16 v[180:183], v[240:243], v[160:163], v[180:183]
    v_rcp_f32 v232, v232
    v_mfma_f32_16x16x32_bf16 v[196:199], v[124:127], v[144:147], 0
    v_exp_f32 v138, v138
    v_mfma_f32_16x16x32_bf16 v[196:199], v[240:243], v[228:231], v[196:199]
    v_mul_f32 v212, v212, v232
    v_cvt_pk_bf16_f32 v143, v194, v195
    v_mfma_f32_16x16x32_bf16 v[248:251], v[132:135], v[88:91], v[248:251]
    v_exp_f32 v139, v139
    v_mfma_f32_16x16x32_bf16 v[248:251], v[132:135], v[112:115], v[248:251]
    v_mul_f32_dpp v212, v180, v232 quad_perm:[0,1,2,3] row_mask:0x2 bank_mask:0xf
    v_cvt_pk_bf16_f32 v123, v138, v139
    v_exp_f32 v184, v184
    v_mfma_f32_16x16x32_f16 v[132:135], v[172:175], v[168:171], v[80:83]
    v_mul_f32_dpp v212, v196, v232 quad_perm:[0,1,2,3] row_mask:0x4 bank_mask:0xf
    v_cvt_pk_bf16_f32 v212, v212, v212
    v_exp_f32 v185, v185
    v_exp_f32 v186, v186
    v_mov_b32 v130, v248
    v_mov_b32_dpp v130, v200 quad_perm:[0,1,2,3] row_mask:0x2 bank_mask:0xf
    v_mfma_f32_16x16x16_f16 v[132:135], v[178:179], v[176:177], v[132:135]
    v_mov_b32_dpp v130, v201 quad_perm:[0,1,2,3] row_mask:0x4 bank_mask:0xf
    v_mov_b32_dpp v130, v249 quad_perm:[0,1,2,3] row_mask:0x8 bank_mask:0xf
    v_cvt_pk_bf16_f32 v36, v184, v185
    v_exp_f32 v187, v187
    ds_write_b32 v151, v130 offset:63552
    v_cvt_pk_bf16_f32 v37, v186, v187
    s_nop 0
    s_nop 0
    v_mfma_f32_16x16x32_bf16 v[168:171], v[28:31], v[36:39], 0
    v_exp_f32 v132, v132
    v_mfma_f32_16x16x32_bf16 v[168:171], v[28:31], v[120:123], v[168:171]
    v_exp_f32 v133, v133
    v_mfma_f32_16x16x32_bf16 v[192:195], v[188:191], v[36:39], 0
    v_exp_f32 v134, v134
    v_mfma_f32_16x16x32_bf16 v[192:195], v[116:119], v[120:123], v[192:195]
    v_exp_f32 v135, v135
    v_mfma_f32_16x16x32_bf16 v[180:183], v[160:163], v[36:39], 0
    v_mfma_f32_16x16x32_bf16 v[180:183], v[164:167], v[120:123], v[180:183]
    s_waitcnt lgkmcnt(0)
    v_rcp_f32 v168, v168
    v_mfma_f32_16x16x32_bf16 v[176:179], v[228:231], v[36:39], 0
    s_barrier
    ds_read_b128 v[240:243], v131 offset:18432
    ds_read_b128 v[124:127], v131 offset:19456
    v_mfma_f32_16x16x32_bf16 v[176:179], v[144:147], v[120:123], v[176:179]
    ds_read_b128 v[120:123], v131 offset:63552
    ds_write_b128 v3, v[216:219] offset:0
    v_cvt_pk_bf16_f32 v36, v132, v133
    v_cvt_pk_bf16_f32 v37, v134, v135
    v_cvt_pk_bf16_f32 v39, v236, 0
    v_mul_f32 v192, v168, v192
    v_mul_f32 v193, v168, v193
    v_mfma_f32_16x16x32_bf16 v[216:219], v[28:31], v[36:39], 0
    v_cvt_pk_bf16_f32 v132, v192, v193
    v_mul_f32 v194, v168, v194
    v_mfma_f32_16x16x32_bf16 v[216:219], v[28:31], v[140:143], v[216:219]
    ds_write_b64 v4, v[238:239] offset:4096
    v_mfma_f32_16x16x32_bf16 v[200:203], v[188:191], v[36:39], 0
    s_waitcnt lgkmcnt(3)
    s_waitcnt vmcnt(0)
    v_add_f32 v240, v240, v241
    v_mfma_f32_16x16x32_bf16 v[200:203], v[116:119], v[140:143], v[200:203]
    s_barrier
    ds_read_b128 v[232:235], v0 offset:20480
    ds_read_b128 v[248:251], v1 offset:20480
    v_mfma_f32_16x16x32_bf16 v[236:239], v[160:163], v[36:39], 0
    s_waitcnt lgkmcnt(3)
    ds_read_b128 v[160:163], v0 offset:20608
    ds_read_b128 v[136:139], v1 offset:20608
    v_mfma_f32_16x16x32_bf16 v[236:239], v[164:167], v[140:143], v[236:239]
    buffer_load_dwordx4 v10, s[8:11], 0 offen nt lds
    ds_read_b128 v[116:119], v0 offset:20736
    v_mfma_f32_16x16x32_bf16 v[164:167], v[228:231], v[36:39], 0
    s_add_u32 m0, s28, 4096
    v_add_f32 v242, v242, v243
    v_add_f32 v240, v240, v242
    v_mfma_f32_16x16x32_bf16 v[164:167], v[144:147], v[140:143], v[164:167]
    ds_read_b128 v[172:175], v1 offset:20736
    ds_write_b16 v7, v212
    v_mul_f32 v240, 0xbbaaaaab, v240
    ds_write_b32 v150, v240 offset:0
    s_waitcnt lgkmcnt(6)
    v_mfma_f32_16x16x32_bf16 v[240:243], a[72:75], v[232:235], 0
    buffer_load_dwordx4 v11, s[8:11], 0 offen nt lds
    v_add_f32 v124, v124, v125
    v_mfma_f32_16x16x32_bf16 v[240:243], a[76:79], v[248:251], v[240:243]
    s_waitcnt lgkmcnt(4)
    ds_read_b128 v[144:147], v149 offset:0
    ds_read_b128 v[184:187], v149 offset:64
    v_mfma_f32_16x16x32_bf16 v[240:243], a[80:83], v[160:163], v[240:243]
    s_add_u32 m0, s28, 8192
    ds_read_b128 v[188:191], v149 offset:128
    v_add_f32 v126, v126, v127
    v_mfma_f32_16x16x32_bf16 v[240:243], a[84:87], v[136:139], v[240:243]
    s_waitcnt lgkmcnt(6)
    v_add_f32 v124, v124, v126
    v_mul_f32 v124, 0xbbaaaaab, v124
    v_mfma_f32_16x16x32_bf16 v[240:243], a[88:91], v[116:119], v[240:243]
    s_waitcnt lgkmcnt(4)
    ds_write_b32 v150, v124 offset:256
    v_mfma_f32_16x16x32_bf16 v[240:243], a[92:95], v[172:175], v[240:243]
    buffer_load_dwordx4 v12, s[8:11], 0 offen nt lds
    v_add_f32 v120, v120, v121
    v_mfma_f32_16x16x32_bf16 v[140:143], a[96:99], v[232:235], 0
    s_add_u32 m0, s28, 12288
    v_add_f32 v122, v122, v123
    v_add_f32 v120, v120, v122
    v_mfma_f32_16x16x32_bf16 v[140:143], a[100:103], v[248:251], v[140:143]
    s_waitcnt lgkmcnt(3)
    v_mul_f32 v120, 0xbbaaaaab, v120
    v_rcp_f32 v216, v216
    v_mfma_f32_16x16x16_bf16 v[212:215], a[216:217], v[128:129], v[144:147]
    v_mul_f32 v200, v216, v200
    v_mul_f32 v201, v216, v201
    v_cvt_pk_bf16_f32 v200, v200, v201
    v_mfma_f32_16x16x16_bf16 v[196:199], a[240:241], v[128:129], v[144:147]
    v_mul_f32 v202, v216, v202
    v_mul_f32 v203, v216, v203
    v_cvt_pk_bf16_f32 v201, v202, v203
    v_mfma_f32_16x16x16_bf16 v[124:127], v[92:93], v[128:129], v[144:147]
    v_cvt_pk_bf16_f32 v212, v212, v213
    v_accvgpr_write_b32 a216, v212
    v_cvt_pk_bf16_f32 v214, v214, v215
    v_accvgpr_write_b32 a217, v214
    v_mfma_f32_16x16x32_bf16 v[140:143], a[104:107], v[160:163], v[140:143]
    s_waitcnt lgkmcnt(0)
    buffer_load_dwordx4 v13, s[8:11], 0 offen nt lds
    ds_write_b32 v150, v120 offset:512
    v_mfma_f32_16x16x16_bf16 v[144:147], a[218:219], v[128:129], v[184:187]
    v_cvt_pk_bf16_f32 v196, v196, v197
    v_accvgpr_write_b32 a240, v196
    v_cvt_pk_bf16_f32 v198, v198, v199
    v_mfma_f32_16x16x16_bf16 v[120:123], a[242:243], v[128:129], v[184:187]
    v_accvgpr_write_b32 a241, v198
    v_cvt_pk_bf16_f32 v92, v124, v125
    v_cvt_pk_bf16_f32 v93, v126, v127
    v_mfma_f32_16x16x16_bf16 v[124:127], v[94:95], v[128:129], v[184:187]
    v_cvt_pk_bf16_f32 v144, v144, v145
    v_accvgpr_write_b32 a218, v144
    v_cvt_pk_bf16_f32 v146, v146, v147
    v_mfma_f32_16x16x16_bf16 v[212:215], a[232:233], v[128:129], v[188:191]
    v_accvgpr_write_b32 a219, v146
    v_cvt_pk_bf16_f32 v120, v120, v121
    v_accvgpr_write_b32 a242, v120
    v_mfma_f32_16x16x16_bf16 v[144:147], v[84:85], v[128:129], v[188:191]
    v_cvt_pk_bf16_f32 v122, v122, v123
    v_accvgpr_write_b32 a243, v122
    v_cvt_pk_bf16_f32 v94, v124, v125
    v_mfma_f32_16x16x16_bf16 v[120:123], v[108:109], v[128:129], v[188:191]
    v_cvt_pk_bf16_f32 v95, v126, v127
    v_cvt_pk_bf16_f32 v212, v212, v213
    v_accvgpr_write_b32 a232, v212
    v_cvt_pk_bf16_f32 v214, v214, v215
    v_mfma_f32_16x16x32_bf16 v[140:143], a[108:111], v[136:139], v[140:143]
    s_mov_b32 m0, s29
    ds_read_b128 v[188:191], v149 offset:192
    buffer_load_dwordx4 v14, s[8:11], 0 offen nt lds
    v_mfma_f32_16x16x32_bf16 v[140:143], a[112:115], v[116:119], v[140:143]
    s_xor_b32 s28, s28, 65536
    ds_read_b128 v[124:127], v149 offset:256
    v_accvgpr_write_b32 a233, v214
    v_mfma_f32_16x16x32_bf16 v[140:143], a[116:119], v[172:175], v[140:143]
    s_xor_b32 s29, s29, s30
    v_cvt_pk_bf16_f32 v84, v144, v145
    v_cvt_pk_bf16_f32 v85, v146, v147
    v_mfma_f32_16x16x32_bf16 v[144:147], a[120:123], v[232:235], 0
    v_cvt_pk_bf16_f32 v108, v120, v121
    v_cvt_pk_bf16_f32 v109, v122, v123
    v_mfma_f32_16x16x32_bf16 v[144:147], a[124:127], v[248:251], v[144:147]
    ds_read_b128 v[120:123], v149 offset:320
    v_mul_f32 v236, v216, v236
    v_mfma_f32_16x16x32_bf16 v[144:147], a[128:131], v[160:163], v[144:147]
    v_mul_f32 v237, v216, v237
    v_cvt_pk_bf16_f32 v202, v236, v237
    v_mfma_f32_16x16x32_bf16 v[144:147], a[132:135], v[136:139], v[144:147]
    s_waitcnt lgkmcnt(2)
    v_mul_f32 v238, v216, v238
    v_mul_f32 v239, v216, v239
    v_cvt_pk_bf16_f32 v203, v238, v239
    v_mfma_f32_16x16x16_bf16 v[236:239], a[220:221], v[128:129], v[188:191]
    v_mul_f32 v164, v216, v164
    v_mul_f32 v165, v216, v165
    v_cvt_pk_bf16_f32 v130, v164, v165
    v_mfma_f32_16x16x16_bf16 v[184:187], a[244:245], v[128:129], v[188:191]
    v_mul_f32 v166, v216, v166
    v_mul_f32 v167, v216, v167
    v_cvt_pk_bf16_f32 v131, v166, v167
    v_mfma_f32_16x16x16_bf16 v[164:167], v[96:97], v[128:129], v[188:191]
    v_cvt_pk_bf16_f32 v236, v236, v237
    v_accvgpr_write_b32 a220, v236
    v_cvt_pk_bf16_f32 v238, v238, v239
    v_accvgpr_write_b32 a221, v238
    v_mfma_f32_16x16x32_bf16 v[144:147], a[136:139], v[116:119], v[144:147]
    s_waitcnt lgkmcnt(0)
    ds_write_b128 v3, v[200:203] offset:12288
    v_mfma_f32_16x16x16_bf16 v[216:219], a[222:223], v[128:129], v[124:127]
    v_cvt_pk_bf16_f32 v184, v184, v185
    v_accvgpr_write_b32 a244, v184
    v_cvt_pk_bf16_f32 v186, v186, v187
    v_mfma_f32_16x16x16_bf16 v[188:191], a[246:247], v[128:129], v[124:127]
    v_accvgpr_write_b32 a245, v186
    v_cvt_pk_bf16_f32 v96, v164, v165
    v_cvt_pk_bf16_f32 v97, v166, v167
    v_mfma_f32_16x16x16_bf16 v[236:239], v[98:99], v[128:129], v[124:127]
    v_cvt_pk_bf16_f32 v216, v216, v217
    v_accvgpr_write_b32 a222, v216
    v_cvt_pk_bf16_f32 v218, v218, v219
    v_mfma_f32_16x16x16_bf16 v[164:167], a[234:235], v[128:129], v[120:123]
    v_accvgpr_write_b32 a223, v218
    v_cvt_pk_bf16_f32 v188, v188, v189
    v_accvgpr_write_b32 a246, v188
    v_mfma_f32_16x16x16_bf16 v[216:219], v[86:87], v[128:129], v[120:123]
    v_cvt_pk_bf16_f32 v190, v190, v191
    v_accvgpr_write_b32 a247, v190
    v_cvt_pk_bf16_f32 v98, v236, v237
    v_mfma_f32_16x16x16_bf16 v[124:127], v[110:111], v[128:129], v[120:123]
    v_cvt_pk_bf16_f32 v99, v238, v239
    v_cvt_pk_bf16_f32 v164, v164, v165
    v_accvgpr_write_b32 a234, v164
    v_cvt_pk_bf16_f32 v166, v166, v167
    v_mfma_f32_16x16x32_bf16 v[144:147], a[140:143], v[172:175], v[144:147]
    ds_read_b128 v[236:239], v149 offset:384
    ds_read_b128 v[188:191], v149 offset:448
    v_mfma_f32_16x16x32_bf16 v[152:155], a[0:3], v[232:235], 0
    ds_write_b64 v4, v[130:131] offset:16384
    v_mfma_f32_16x16x32_bf16 v[152:155], a[4:7], v[248:251], v[152:155]
    v_accvgpr_write_b32 a235, v166
    v_cvt_pk_bf16_f32 v86, v216, v217
    v_mfma_f32_16x16x32_bf16 v[152:155], a[8:11], v[160:163], v[152:155]
    v_cvt_pk_bf16_f32 v87, v218, v219
    v_cvt_pk_bf16_f32 v110, v124, v125
    v_mfma_f32_16x16x32_bf16 v[152:155], a[12:15], v[136:139], v[152:155]
    v_cvt_pk_bf16_f32 v111, v126, v127
    v_mul_f32 v195, v168, v195
    v_mfma_f32_16x16x32_bf16 v[152:155], a[16:19], v[116:119], v[152:155]
    ds_read_b128 v[120:123], v149 offset:512
    v_cvt_pk_bf16_f32 v133, v194, v195
    v_mfma_f32_16x16x32_bf16 v[152:155], a[20:23], v[172:175], v[152:155]
    s_waitcnt lgkmcnt(2)
    v_mul_f32 v180, v168, v180
    v_mul_f32 v181, v168, v181
    v_cvt_pk_bf16_f32 v134, v180, v181
    v_mfma_f32_16x16x16_bf16 v[164:167], a[224:225], v[128:129], v[236:239]
    v_mul_f32 v182, v168, v182
    v_mul_f32 v183, v168, v183
    v_cvt_pk_bf16_f32 v135, v182, v183
    v_mfma_f32_16x16x16_bf16 v[180:183], a[248:249], v[128:129], v[236:239]
    v_mul_f32 v176, v168, v176
    v_mul_f32 v177, v168, v177
    v_cvt_pk_bf16_f32 v130, v176, v177
    v_mfma_f32_16x16x16_bf16 v[192:195], v[100:101], v[128:129], v[236:239]
    v_cvt_pk_bf16_f32 v164, v164, v165
    v_accvgpr_write_b32 a224, v164
    v_cvt_pk_bf16_f32 v166, v166, v167
    v_mfma_f32_16x16x16_bf16 v[216:219], a[226:227], v[128:129], v[188:191]
    v_accvgpr_write_b32 a225, v166
    v_cvt_pk_bf16_f32 v180, v180, v181
    v_accvgpr_write_b32 a248, v180
    v_mfma_f32_16x16x16_bf16 v[236:239], a[250:251], v[128:129], v[188:191]
    v_cvt_pk_bf16_f32 v182, v182, v183
    v_accvgpr_write_b32 a249, v182
    v_cvt_pk_bf16_f32 v100, v192, v193
    v_mfma_f32_16x16x16_bf16 v[124:127], v[102:103], v[128:129], v[188:191]
    v_cvt_pk_bf16_f32 v101, v194, v195
    v_cvt_pk_bf16_f32 v216, v216, v217
    v_accvgpr_write_b32 a226, v216
    v_cvt_pk_bf16_f32 v218, v218, v219
    v_mfma_f32_16x16x32_bf16 v[156:159], a[24:27], v[232:235], 0
    s_waitcnt lgkmcnt(0)
    ds_read_b128 v[164:167], v149 offset:576
    ds_write_b128 v3, v[132:135] offset:6144
    v_mfma_f32_16x16x16_bf16 v[192:195], a[236:237], v[128:129], v[120:123]
    v_accvgpr_write_b32 a227, v218
    v_cvt_pk_bf16_f32 v236, v236, v237
    v_accvgpr_write_b32 a250, v236
    v_mfma_f32_16x16x16_bf16 v[132:135], v[88:89], v[128:129], v[120:123]
    v_cvt_pk_bf16_f32 v238, v238, v239
    v_accvgpr_write_b32 a251, v238
    v_cvt_pk_bf16_f32 v102, v124, v125
    v_mfma_f32_16x16x16_bf16 v[180:183], v[112:113], v[128:129], v[120:123]
    v_cvt_pk_bf16_f32 v103, v126, v127
    v_cvt_pk_bf16_f32 v192, v192, v193
    v_accvgpr_write_b32 a236, v192
    v_cvt_pk_bf16_f32 v194, v194, v195
    v_mfma_f32_16x16x32_bf16 v[156:159], a[28:31], v[248:251], v[156:159]
    ds_read_b128 v[236:239], v149 offset:640
    v_accvgpr_write_b32 a237, v194
    v_mfma_f32_16x16x32_bf16 v[156:159], a[32:35], v[160:163], v[156:159]
    s_waitcnt lgkmcnt(1)
    v_cvt_pk_bf16_f32 v88, v132, v133
    v_cvt_pk_bf16_f32 v89, v134, v135
    v_cvt_pk_bf16_f32 v112, v180, v181
    v_mfma_f32_16x16x16_bf16 v[132:135], a[228:229], v[128:129], v[164:167]
    v_cvt_pk_bf16_f32 v113, v182, v183
    v_mul_f32 v178, v168, v178
    v_mul_f32 v179, v168, v179
    v_mfma_f32_16x16x16_bf16 v[192:195], a[252:253], v[128:129], v[164:167]
    v_cvt_pk_bf16_f32 v131, v178, v179
    v_cvt_pk_f16_f32 v120, v240, v241
    v_pk_mul_f16 v125, v120, v120
    v_mfma_f32_16x16x16_bf16 v[180:183], v[104:105], v[128:129], v[164:167]
    v_cvt_pk_bf16_f32 v132, v132, v133
    v_accvgpr_write_b32 a228, v132
    v_cvt_pk_bf16_f32 v134, v134, v135
    v_accvgpr_write_b32 a229, v134
    v_mfma_f32_16x16x32_bf16 v[156:159], a[36:39], v[136:139], v[156:159]
    ds_read_b128 v[132:135], v149 offset:704
    v_cvt_pk_bf16_f32 v192, v192, v193
    v_mfma_f32_16x16x32_bf16 v[156:159], a[40:43], v[116:119], v[156:159]
    s_waitcnt lgkmcnt(1)
    ds_write_b64 v4, v[130:131] offset:10240
    v_mfma_f32_16x16x16_bf16 v[164:167], a[230:231], v[128:129], v[236:239]
    v_accvgpr_write_b32 a252, v192
    v_cvt_pk_bf16_f32 v194, v194, v195
    v_accvgpr_write_b32 a253, v194
    v_mfma_f32_16x16x16_bf16 v[148:151], a[254:255], v[128:129], v[236:239]
    v_cvt_pk_bf16_f32 v104, v180, v181
    v_cvt_pk_bf16_f32 v105, v182, v183
    v_cvt_pk_f16_f32 v121, v242, v243
    v_mfma_f32_16x16x16_bf16 v[180:183], v[106:107], v[128:129], v[236:239]
    v_cvt_pk_bf16_f32 v164, v164, v165
    v_accvgpr_write_b32 a230, v164
    v_cvt_pk_bf16_f32 v166, v166, v167
    v_accvgpr_write_b32 a231, v166
    v_mfma_f32_16x16x32_bf16 v[156:159], a[44:47], v[172:175], v[156:159]
    v_cvt_pk_bf16_f32 v148, v148, v149
    s_waitcnt lgkmcnt(1)
    v_accvgpr_write_b32 a254, v148
    v_mfma_f32_16x16x16_bf16 v[164:167], a[238:239], v[128:129], v[132:135]
    v_cvt_pk_bf16_f32 v150, v150, v151
    v_accvgpr_write_b32 a255, v150
    v_cvt_pk_bf16_f32 v106, v180, v181
    v_mfma_f32_16x16x16_bf16 v[148:151], v[90:91], v[128:129], v[132:135]
    v_cvt_pk_bf16_f32 v107, v182, v183
    v_pk_mul_f16 v127, v121, v121
    v_cvt_pk_f16_f32 v122, v140, v141
    v_mfma_f32_16x16x16_bf16 v[180:183], v[114:115], v[128:129], v[132:135]
    s_waitcnt lgkmcnt(0)
    s_barrier
    v_cvt_pk_bf16_f32 v164, v164, v165
    v_accvgpr_write_b32 a238, v164
    v_cvt_pk_bf16_f32 v166, v166, v167
    v_accvgpr_write_b32 a239, v166
    v_cvt_pk_bf16_f32 v90, v148, v149
    v_cvt_pk_bf16_f32 v91, v150, v151
    v_cvt_pk_bf16_f32 v114, v180, v181
    v_cvt_pk_bf16_f32 v115, v182, v183
    v_pk_fma_f16 v125, v122, v122, v125
    v_add_u32 v7, 16, v7
    v_xor_b32 v3, 65536, v3
    v_xor_b32 v4, 65536, v4
L_go:
    s_waitcnt lgkmcnt(0)
    s_and_b32 s3, s2, 0xf8
    s_add_u32 s64, s42, s3
    s_addc_u32 s65, s43, 0
    s_mov_b32 s67, 0x00020000
    s_cmp_eq_u32 s16, 1
    s_cbranch_scc1 L_loop_fast1
    s_cmp_eq_u32 s16, 2
    s_cbranch_scc1 L_loop_fast2
    s_cmp_eq_u32 s16, 3
    s_cbranch_scc1 L_loop_fast3
    s_branch L_loop_fast0
.p2align 6
L_loop_fast0:
    v_mfma_f32_16x16x32_bf16 v[164:167], a[48:51], v[232:235], 0
    s_add_u32 s12, s40, s27
    ds_read_b128 v[168:171], v2 offset:18432
    ds_read_b128 v[180:183], v2 offset:19456
    v_mfma_f32_16x16x32_bf16 v[164:167], a[52:55], v[248:251], v[164:167]
    s_addc_u32 s13, s41, 0
    v_cvt_pk_f16_f32 v123, v142, v143
    v_pk_fma_f16 v127, v123, v123, v127
    v_mfma_f32_16x16x32_bf16 v[164:167], a[56:59], v[160:163], v[164:167]
    s_sub_u32 s14, s36, s27
    v_cvt_pk_f16_f32 v150, v144, v145
    v_pk_fma_f16 v125, v150, v150, v125
    v_mfma_f32_16x16x32_bf16 v[164:167], a[60:63], v[136:139], v[164:167]
    s_cmp_ge_u32 s18, 2
    v_cvt_pk_f16_f32 v151, v146, v147
    v_pk_fma_f16 v127, v151, v151, v127
    v_mfma_f32_16x16x32_bf16 v[164:167], a[64:67], v[116:119], v[164:167]
    s_cselect_b32 s14, s14, 0
    v_cvt_pk_f16_f32 v220, v152, v153
    v_pk_mul_f16 v124, v220, v220
    v_mfma_f32_16x16x32_bf16 v[164:167], a[68:71], v[172:175], v[164:167]
    s_sub_u32 s82, s72, s71
    v_cvt_pk_f16_f32 v221, v154, v155
    v_pk_mul_f16 v126, v221, v221
    v_mfma_f32_16x16x32_bf16 v[184:187], v[232:235], a[144:147], 0
    s_mul_i32 s74, s82, 336
    v_cvt_pk_f16_f32 v222, v156, v157
    v_pk_fma_f16 v124, v222, v222, v124
    v_mfma_f32_16x16x32_bf16 v[184:187], v[248:251], a[148:151], v[184:187]
    s_mul_i32 s75, s82, 272
    v_cvt_pk_f16_f32 v223, v158, v159
    v_pk_fma_f16 v126, v223, v223, v126
    v_mfma_f32_16x16x32_bf16 v[184:187], v[160:163], a[152:155], v[184:187]
    s_waitcnt lgkmcnt(0)
    v_cvt_pk_f16_f32 v148, v164, v165
    v_pk_fma_f16 v124, v148, v148, v124
    v_mfma_f32_16x16x32_bf16 v[140:143], v[32:35], v[168:171], 0
    s_mul_i32 s76, s82, 16
    v_cvt_pk_f16_f32 v149, v166, v167
    v_pk_fma_f16 v126, v149, v149, v126
    v_mfma_f32_16x16x32_bf16 v[140:143], v[32:35], v[180:183], v[140:143]
    s_add_u32 s34, s18, 2
    s_add_u32 s8, s60, s23
    s_addc_u32 s9, s61, 0
    v_mfma_f32_16x16x32_f16 v[144:147], v[40:43], v[124:127], 0
    s_sub_u32 s10, s36, s23
    s_cmp_le_u32 s34, s45
    s_cselect_b32 s10, s10, 0
    v_mfma_f32_16x16x32_bf16 v[184:187], v[136:139], a[156:159], v[184:187]
    s_add_u32 m0, s28, 0
    v_mul_f32 v140, 0x3baaaaab, v140
    v_mul_f32 v141, 0x3baaaaab, v141
    v_mfma_f32_16x16x32_bf16 v[184:187], v[116:119], a[160:163], v[184:187]
    s_mov_b32 s27, s26
    ds_read_b128 v[180:183], v0 offset:26624
    v_min3_u32 v44, v44, v144, v145
    v_mfma_f32_16x16x32_bf16 v[184:187], v[172:175], a[164:167], v[184:187]
    s_mov_b32 s26, s25
    ds_read_b128 v[124:127], v1 offset:26624
    v_max3_u32 v45, v45, v144, v145
    v_mfma_f32_16x16x32_bf16 v[164:167], v[232:235], a[168:171], 0
    s_mov_b32 s25, s24
    ds_read_b128 v[168:171], v0 offset:26752
    v_mul_f32 v142, 0x3baaaaab, v142
    v_mfma_f32_16x16x32_bf16 v[164:167], v[248:251], a[172:175], v[164:167]
    s_mov_b32 s24, s23
    ds_read_b128 v[152:155], v1 offset:26752
    v_cvt_pk_bf16_f32 v184, v184, v185
    v_mfma_f32_16x16x32_bf16 v[164:167], v[160:163], a[176:179], v[164:167]
    s_ff1_i32_b32 s80, s100
    ds_read_b128 v[156:159], v0 offset:26880
    v_cvt_pk_bf16_f32 v185, v186, v187
    v_mfma_f32_16x16x32_bf16 v[164:167], v[136:139], a[180:183], v[164:167]
    s_mov_b32 s71, s72
    ds_read_b128 v[192:195], v1 offset:26880
    s_mov_b32 s72, s73
    v_mfma_f32_16x16x32_bf16 v[164:167], v[116:119], a[184:187], v[164:167]
    v_rsq_f32 v146, v144
    v_mfma_f32_16x16x32_bf16 v[164:167], v[172:175], a[188:191], v[164:167]
    v_rsq_f32 v147, v145
    v_mfma_f32_16x16x32_bf16 v[204:207], v[232:235], a[192:195], 0
    s_waitcnt lgkmcnt(5)
    v_rsq_f32 v140, v140
    v_mfma_f32_16x16x32_bf16 v[204:207], v[248:251], a[196:199], v[204:207]
    s_waitcnt lgkmcnt(4)
    v_mul_f32 v146, s31, v146
    v_cvt_pk_f16_f32 v146, v146, v147
    v_mfma_f32_16x16x32_bf16 v[204:207], v[160:163], a[200:203], v[204:207]
    s_waitcnt lgkmcnt(3)
    v_cvt_pk_bf16_f32 v144, v164, v165
    v_cvt_pk_bf16_f32 v145, v166, v167
    v_mfma_f32_16x16x32_bf16 v[204:207], v[136:139], a[204:207], v[204:207]
    s_waitcnt lgkmcnt(2)
    v_pk_mul_f16 v120, v120, v146 op_sel:[0,1] op_sel_hi:[1,1]
    v_pk_mul_f16 v121, v121, v146 op_sel:[0,1] op_sel_hi:[1,1]
    v_mfma_f32_16x16x32_bf16 v[204:207], v[116:119], a[208:211], v[204:207]
    s_waitcnt lgkmcnt(1)
    v_pk_mul_f16 v122, v122, v146 op_sel:[0,1] op_sel_hi:[1,1]
    v_pk_mul_f16 v123, v123, v146 op_sel:[0,1] op_sel_hi:[1,1]
    v_mfma_f32_16x16x32_bf16 v[204:207], v[172:175], a[212:215], v[204:207]
    s_waitcnt lgkmcnt(0)
    v_pk_mul_f16 v150, v150, v146 op_sel:[0,1] op_sel_hi:[1,1]
    v_pk_mul_f16 v151, v151, v146 op_sel:[0,1] op_sel_hi:[1,1]
    v_mfma_f32_16x16x32_bf16 v[116:119], a[72:75], v[180:183], 0
    v_pk_mul_f16 v220, v220, v146 op_sel:[0,0] op_sel_hi:[1,0]
    v_pk_mul_f16 v221, v221, v146 op_sel:[0,0] op_sel_hi:[1,0]
    v_mfma_f32_16x16x32_bf16 v[116:119], a[76:79], v[124:127], v[116:119]
    v_pk_mul_f16 v222, v222, v146 op_sel:[0,0] op_sel_hi:[1,0]
    v_cvt_pk_bf16_f32 v136, v204, v205
    v_mfma_f32_16x16x32_bf16 v[116:119], a[80:83], v[168:171], v[116:119]
    v_cvt_pk_bf16_f32 v137, v206, v207
    v_pk_mul_f16 v223, v223, v146 op_sel:[0,0] op_sel_hi:[1,0]
    v_mfma_f32_16x16x32_bf16 v[116:119], a[84:87], v[152:155], v[116:119]
    v_pk_mul_f16 v148, v148, v146 op_sel:[0,0] op_sel_hi:[1,0]
    v_pk_mul_f16 v149, v149, v146 op_sel:[0,0] op_sel_hi:[1,0]
    v_mfma_f32_16x16x32_bf16 v[116:119], a[88:91], v[156:159], v[116:119]
    v_rsq_f32 v141, v141
    v_mfma_f32_16x16x32_bf16 v[116:119], a[92:95], v[192:195], v[116:119]
    v_rsq_f32 v142, v142
    v_mfma_f32_16x16x32_bf16 v[160:163], a[96:99], v[180:183], 0
    v_mul_f32 v128, v140, v128
    v_mul_f32 v129, v140, v129
    v_mfma_f32_16x16x32_bf16 v[160:163], a[100:103], v[124:127], v[160:163]
    v_cvt_pk_bf16_f32 v128, v128, v129
    v_mul_f32 v130, v140, v130
    v_mfma_f32_16x16x32_bf16 v[160:163], a[104:107], v[168:171], v[160:163]
    v_cvt_pk_f16_f32 v164, v116, v117
    v_pk_mul_f16 v117, v164, v164
    v_mfma_f32_16x16x32_bf16 v[160:163], a[108:111], v[152:155], v[160:163]
    v_cvt_pk_f16_f32 v165, v118, v119
    v_pk_mul_f16 v119, v165, v165
    v_mfma_f32_16x16x32_bf16 v[160:163], a[112:115], v[156:159], v[160:163]
    v_mul_f32 v131, v140, v131
    v_cvt_pk_bf16_f32 v129, v130, v131
    v_mfma_f32_16x16x32_bf16 v[160:163], a[116:119], v[192:195], v[160:163]
    v_mul_f32 v188, v140, v188
    v_mul_f32 v189, v140, v189
    v_mfma_f32_16x16x32_bf16 v[172:175], a[120:123], v[180:183], 0
    v_cvt_pk_bf16_f32 v130, v188, v189
    v_mul_f32 v190, v140, v190
    v_mfma_f32_16x16x32_bf16 v[172:175], a[124:127], v[124:127], v[172:175]
    v_mul_f32 v191, v140, v191
    v_cvt_pk_bf16_f32 v131, v190, v191
    v_mfma_f32_16x16x32_bf16 v[172:175], a[128:131], v[168:171], v[172:175]
    buffer_store_dwordx4 v[128:131], v15, s[12:15], 0 offen nt
    v_cvt_pk_f16_f32 v166, v160, v161
    v_pk_fma_f16 v117, v166, v166, v117
    v_cvt_pk_f16_f32 v167, v162, v163
    v_pk_fma_f16 v119, v167, v167, v119
    v_mfma_f32_16x16x32_bf16 v[172:175], a[132:135], v[152:155], v[172:175]
    v_mul_f32 v176, v140, v176
    v_mul_f32 v177, v140, v177
    v_mfma_f32_16x16x32_bf16 v[172:175], a[136:139], v[156:159], v[172:175]
    v_cvt_pk_bf16_f32 v138, v176, v177
    v_mul_f32 v178, v140, v178
    v_mfma_f32_16x16x32_bf16 v[172:175], a[140:143], v[192:195], v[172:175]
    v_mul_f32 v179, v140, v179
    v_cvt_pk_bf16_f32 v139, v178, v179
    v_mfma_f32_16x16x32_bf16 v[128:131], a[0:3], v[180:183], 0
    v_mul_f32 v196, v141, v196
    v_mul_f32 v197, v141, v197
    v_mfma_f32_16x16x32_bf16 v[128:131], a[4:7], v[124:127], v[128:131]
    v_cvt_pk_bf16_f32 v160, v196, v197
    v_mul_f32 v198, v141, v198
    v_mfma_f32_16x16x32_bf16 v[128:131], a[8:11], v[168:171], v[128:131]
    v_cvt_pk_f16_f32 v206, v172, v173
    v_pk_fma_f16 v117, v206, v206, v117
    v_mfma_f32_16x16x32_bf16 v[128:131], a[12:15], v[152:155], v[128:131]
    v_cvt_pk_f16_f32 v207, v174, v175
    v_pk_fma_f16 v119, v207, v207, v119
    v_mfma_f32_16x16x32_bf16 v[128:131], a[16:19], v[156:159], v[128:131]
    v_mul_f32 v199, v141, v199
    v_cvt_pk_bf16_f32 v161, v198, v199
    v_mfma_f32_16x16x32_bf16 v[128:131], a[20:23], v[192:195], v[128:131]
    v_mul_f32 v132, v141, v132
    v_mul_f32 v133, v141, v133
    v_mfma_f32_16x16x32_bf16 v[172:175], a[24:27], v[180:183], 0
    v_cvt_pk_bf16_f32 v162, v132, v133
    v_mul_f32 v134, v141, v134
    v_mfma_f32_16x16x32_bf16 v[172:175], a[28:31], v[124:127], v[172:175]
    v_mul_f32 v135, v141, v135
    v_cvt_pk_bf16_f32 v163, v134, v135
    v_mfma_f32_16x16x32_bf16 v[172:175], a[32:35], v[168:171], v[172:175]
    v_cvt_pk_f16_f32 v128, v128, v129
    v_pk_mul_f16 v116, v128, v128
    v_mfma_f32_16x16x32_bf16 v[172:175], a[36:39], v[152:155], v[172:175]
    v_cvt_pk_f16_f32 v129, v130, v131
    v_pk_mul_f16 v118, v129, v129
    v_mfma_f32_16x16x32_bf16 v[172:175], a[40:43], v[156:159], v[172:175]
    v_mul_f32 v212, v141, v212
    v_mul_f32 v213, v141, v213
    v_mfma_f32_16x16x32_bf16 v[172:175], a[44:47], v[192:195], v[172:175]
    v_cvt_pk_bf16_f32 v140, v212, v213
    v_mul_f32 v214, v141, v214
    v_mfma_f32_16x16x32_bf16 v[132:135], a[48:51], v[180:183], 0
    v_mul_f32 v215, v141, v215
    v_cvt_pk_bf16_f32 v141, v214, v215
    v_mfma_f32_16x16x32_bf16 v[132:135], a[52:55], v[124:127], v[132:135]
    buffer_store_dwordx2 v[138:139], v18, s[12:15], 0 offen nt
    v_mul_f32 v200, v142, v200
    v_cvt_pk_f16_f32 v130, v172, v173
    v_mfma_f32_16x16x32_bf16 v[132:135], a[56:59], v[168:171], v[132:135]
    v_pk_fma_f16 v116, v130, v130, v116
    v_cvt_pk_f16_f32 v131, v174, v175
    v_mfma_f32_16x16x32_bf16 v[132:135], a[60:63], v[152:155], v[132:135]
    v_pk_fma_f16 v118, v131, v131, v118
    v_mul_f32 v201, v142, v201
    v_mfma_f32_16x16x32_bf16 v[132:135], a[64:67], v[156:159], v[132:135]
    v_cvt_pk_bf16_f32 v172, v200, v201
    v_mul_f32 v202, v142, v202
    v_mfma_f32_16x16x32_bf16 v[132:135], a[68:71], v[192:195], v[132:135]
    v_mul_f32 v203, v142, v203
    v_cvt_pk_bf16_f32 v173, v202, v203
    v_mfma_f32_16x16x32_bf16 v[176:179], v[180:183], a[144:147], 0
    v_mul_f32 v216, v142, v216
    v_mul_f32 v217, v142, v217
    v_mfma_f32_16x16x32_bf16 v[176:179], v[124:127], a[148:151], v[176:179]
    v_cvt_pk_bf16_f32 v174, v216, v217
    v_mul_f32 v218, v142, v218
    v_mfma_f32_16x16x32_bf16 v[176:179], v[168:171], a[152:155], v[176:179]
    v_cvt_pk_f16_f32 v204, v132, v133
    v_pk_fma_f16 v116, v204, v204, v116
    v_mfma_f32_16x16x32_bf16 v[176:179], v[152:155], a[156:159], v[176:179]
    v_cvt_pk_f16_f32 v205, v134, v135
    v_pk_fma_f16 v118, v205, v205, v118
    v_mfma_f32_16x16x32_bf16 v[176:179], v[156:159], a[160:163], v[176:179]
    ds_read_b128 v[132:135], v0 offset:32768
    v_mul_f32 v219, v142, v219
    v_mfma_f32_16x16x32_f16 v[188:191], v[40:43], v[116:119], 0
    v_cvt_pk_bf16_f32 v175, v218, v219
    v_mul_f32 v208, v142, v208
    v_mfma_f32_16x16x32_bf16 v[176:179], v[192:195], a[164:167], v[176:179]
    ds_read_b128 v[116:119], v1 offset:32768
    v_mul_f32 v209, v142, v209
    v_mfma_f32_16x16x32_bf16 v[196:199], v[180:183], a[168:171], 0
    ds_read_b128 v[200:203], v0 offset:32896
    v_cvt_pk_bf16_f32 v208, v208, v209
    v_mfma_f32_16x16x32_bf16 v[196:199], v[124:127], a[172:175], v[196:199]
    ds_read_b128 v[212:215], v1 offset:32896
    v_min3_u32 v44, v44, v188, v189
    v_mfma_f32_16x16x32_bf16 v[196:199], v[168:171], a[176:179], v[196:199]
    ds_read_b128 v[216:219], v0 offset:33024
    v_cvt_pk_bf16_f32 v186, v176, v177
    v_mfma_f32_16x16x32_bf16 v[196:199], v[152:155], a[180:183], v[196:199]
    ds_read_b128 v[224:227], v1 offset:33024
    v_cvt_pk_bf16_f32 v187, v178, v179
    v_mfma_f32_16x16x32_bf16 v[196:199], v[156:159], a[184:187], v[196:199]
    v_rsq_f32 v190, v188
    v_mfma_f32_16x16x32_bf16 v[196:199], v[192:195], a[188:191], v[196:199]
    s_waitcnt lgkmcnt(5)
    buffer_store_dwordx4 v[160:163], v16, s[12:15], 0 offen nt
    v_rsq_f32 v191, v189
    v_mul_f32 v190, s31, v190
    v_cvt_pk_f16_f32 v190, v190, v191
    v_mfma_f32_16x16x32_bf16 v[160:163], v[180:183], a[192:195], 0
    s_waitcnt lgkmcnt(4)
    v_pk_mul_f16 v164, v164, v190 op_sel:[0,1] op_sel_hi:[1,1]
    v_cvt_pk_bf16_f32 v146, v196, v197
    v_mfma_f32_16x16x32_bf16 v[160:163], v[124:127], a[196:199], v[160:163]
    s_waitcnt lgkmcnt(3)
    v_cvt_pk_bf16_f32 v147, v198, v199
    v_pk_mul_f16 v165, v165, v190 op_sel:[0,1] op_sel_hi:[1,1]
    v_mfma_f32_16x16x32_bf16 v[160:163], v[168:171], a[200:203], v[160:163]
    s_waitcnt lgkmcnt(2)
    v_pk_mul_f16 v166, v166, v190 op_sel:[0,1] op_sel_hi:[1,1]
    v_pk_mul_f16 v167, v167, v190 op_sel:[0,1] op_sel_hi:[1,1]
    v_mfma_f32_16x16x32_bf16 v[160:163], v[152:155], a[204:207], v[160:163]
    s_waitcnt lgkmcnt(1)
    v_pk_mul_f16 v206, v206, v190 op_sel:[0,1] op_sel_hi:[1,1]
    v_pk_mul_f16 v207, v207, v190 op_sel:[0,1] op_sel_hi:[1,1]
    v_mfma_f32_16x16x32_bf16 v[160:163], v[156:159], a[208:211], v[160:163]
    s_waitcnt lgkmcnt(0)
    v_pk_mul_f16 v128, v128, v190 op_sel:[0,0] op_sel_hi:[1,0]
    v_pk_mul_f16 v129, v129, v190 op_sel:[0,0] op_sel_hi:[1,0]
    v_mfma_f32_16x16x32_bf16 v[160:163], v[192:195], a[212:215], v[160:163]
    s_waitcnt vmcnt(3)
    ds_write_b16 v8, v46 offset:512
    v_mfma_f32_16x16x32_bf16 v[124:127], a[72:75], v[132:135], 0
    v_mov_b32 v46, 1
    v_pk_mul_f16 v130, v130, v190 op_sel:[0,0] op_sel_hi:[1,0]
    v_mfma_f32_16x16x32_bf16 v[124:127], a[76:79], v[116:119], v[124:127]
    v_pk_mul_f16 v131, v131, v190 op_sel:[0,0] op_sel_hi:[1,0]
    v_pk_mul_f16 v204, v204, v190 op_sel:[0,0] op_sel_hi:[1,0]
    v_mfma_f32_16x16x32_bf16 v[124:127], a[80:83], v[200:203], v[124:127]
    v_cvt_pk_bf16_f32 v138, v160, v161
    v_cvt_pk_bf16_f32 v139, v162, v163
    v_mfma_f32_16x16x32_bf16 v[124:127], a[84:87], v[212:215], v[124:127]
    v_pk_mul_f16 v205, v205, v190 op_sel:[0,0] op_sel_hi:[1,0]
    v_max3_u32 v45, v45, v188, v189
    v_mfma_f32_16x16x32_bf16 v[124:127], a[88:91], v[216:219], v[124:127]
    v_mul_f32 v210, v142, v210
    v_mul_f32 v211, v142, v211
    v_mfma_f32_16x16x32_bf16 v[124:127], a[92:95], v[224:227], v[124:127]
    v_cvt_pk_bf16_f32 v209, v210, v211
    v_xor_b32 v0, 65536, v0
    v_mfma_f32_16x16x32_bf16 v[152:155], a[96:99], v[132:135], 0
    v_xor_b32 v1, 65536, v1
    v_mfma_f32_16x16x32_bf16 v[152:155], a[100:103], v[116:119], v[152:155]
    s_waitcnt lgkmcnt(0)
    v_mfma_f32_16x16x32_bf16 v[152:155], a[104:107], v[200:203], v[152:155]
    s_barrier
    v_mfma_f32_16x16x32_bf16 v[152:155], a[108:111], v[212:215], v[152:155]
    s_nop 0
    v_mfma_f32_16x16x32_bf16 v[152:155], a[112:115], v[216:219], v[152:155]
    s_nop 0
    v_mfma_f32_16x16x32_bf16 v[152:155], a[116:119], v[224:227], v[152:155]
    s_nop 0
    v_mfma_f32_16x16x32_bf16 v[156:159], a[120:123], v[132:135], 0
    buffer_load_dwordx4 v10, s[8:11], 0 offen nt lds
    ds_read_u16 v142, v9 offset:512
    v_mfma_f32_16x16x32_bf16 v[156:159], a[124:127], v[116:119], v[156:159]
    s_add_u32 m0, s28, 4096
    v_cvt_pk_f16_f32 v124, v124, v125
    v_pk_mul_f16 v161, v124, v124
    v_mfma_f32_16x16x32_bf16 v[156:159], a[128:131], v[200:203], v[156:159]
    v_cvt_pk_f16_f32 v125, v126, v127
    v_pk_mul_f16 v163, v125, v125
    v_mfma_f32_16x16x32_bf16 v[156:159], a[132:135], v[212:215], v[156:159]
    v_cvt_pk_f16_f32 v126, v152, v153
    v_pk_fma_f16 v161, v126, v126, v161
    v_mfma_f32_16x16x32_bf16 v[156:159], a[136:139], v[216:219], v[156:159]
    v_cvt_pk_f16_f32 v127, v154, v155
    v_pk_fma_f16 v163, v127, v127, v163
    v_mfma_f32_16x16x32_bf16 v[156:159], a[140:143], v[224:227], v[156:159]
    buffer_load_dwordx4 v11, s[8:11], 0 offen nt lds
    s_add_u32 m0, s28, 8192
    v_mfma_f32_16x16x32_bf16 v[152:155], a[0:3], v[132:135], 0
    v_mfma_f32_16x16x32_bf16 v[152:155], a[4:7], v[116:119], v[152:155]
    v_mfma_f32_16x16x32_bf16 v[152:155], a[8:11], v[200:203], v[152:155]
    s_waitcnt lgkmcnt(0)
    v_readfirstlane_b32 s77, v142
    v_mfma_f32_16x16x32_bf16 v[152:155], a[12:15], v[212:215], v[152:155]
    v_cvt_pk_f16_f32 v170, v156, v157
    v_pk_fma_f16 v161, v170, v170, v161
    v_mfma_f32_16x16x32_bf16 v[152:155], a[16:19], v[216:219], v[152:155]
    buffer_load_dwordx4 v12, s[8:11], 0 offen nt lds
    v_cvt_pk_f16_f32 v171, v158, v159
    v_mfma_f32_16x16x32_bf16 v[152:155], a[20:23], v[224:227], v[152:155]
    s_add_u32 m0, s28, 12288
    v_pk_fma_f16 v163, v171, v171, v163
    s_xor_b32 s28, s28, 65536
    v_mfma_f32_16x16x32_bf16 v[156:159], a[24:27], v[132:135], 0
    v_mfma_f32_16x16x32_bf16 v[156:159], a[28:31], v[116:119], v[156:159]
    v_mfma_f32_16x16x32_bf16 v[156:159], a[32:35], v[200:203], v[156:159]
    v_mfma_f32_16x16x32_bf16 v[156:159], a[36:39], v[212:215], v[156:159]
    buffer_load_dwordx4 v13, s[8:11], 0 offen nt lds
    v_cvt_pk_f16_f32 v152, v152, v153
    v_mfma_f32_16x16x32_bf16 v[156:159], a[40:43], v[216:219], v[156:159]
    s_mov_b32 m0, s29
    v_pk_mul_f16 v160, v152, v152
    v_cvt_pk_f16_f32 v153, v154, v155
    v_mfma_f32_16x16x32_bf16 v[156:159], a[44:47], v[224:227], v[156:159]
    s_xor_b32 s29, s29, s30
    v_pk_mul_f16 v162, v153, v153
    s_add_u32 s19, s19, s20
    v_mfma_f32_16x16x32_bf16 v[176:179], a[48:51], v[132:135], 0
    s_add_u32 s23, s23, s21
    s_cmp_ge_u32 s19, 72
    s_cselect_b32 s34, 72, 0
    v_mfma_f32_16x16x32_bf16 v[176:179], a[52:55], v[116:119], v[176:179]
    s_cselect_b32 s35, s22, 0
    v_cvt_pk_f16_f32 v154, v156, v157
    v_pk_fma_f16 v160, v154, v154, v160
    v_mfma_f32_16x16x32_bf16 v[176:179], a[56:59], v[200:203], v[176:179]
    s_sub_u32 s19, s19, s34
    buffer_load_dwordx4 v14, s[8:11], 0 offen nt lds
    v_cvt_pk_f16_f32 v155, v158, v159
    v_mfma_f32_16x16x32_bf16 v[176:179], a[60:63], v[212:215], v[176:179]
    s_add_u32 s23, s23, s35
    v_pk_fma_f16 v162, v155, v155, v162
    s_cmp_lg_u32 s83, 0
    v_mfma_f32_16x16x32_bf16 v[176:179], a[64:67], v[216:219], v[176:179]
    s_cselect_b32 s77, s80, s77
    ds_read_b128 v[156:159], v5 offset:0
    ds_read_b128 v[180:183], v5 offset:16
    v_mfma_f32_16x16x32_bf16 v[176:179], a[68:71], v[224:227], v[176:179]
    s_mul_i32 s78, s77, 2688
    ds_read_b128 v[188:191], v5 offset:48
    ds_read_b32 v210, v6 offset:192
    v_mfma_f32_16x16x32_bf16 v[192:195], v[132:135], a[144:147], 0
    s_add_u32 s78, s78, s69
    v_add_u32 v5, s74, v5
    s_add_u32 s80, s77, s68
    v_mfma_f32_16x16x32_bf16 v[192:195], v[116:119], a[148:151], v[192:195]
    s_cmp_ge_u32 s80, 72
    buffer_store_dwordx2 v[140:141], v19, s[12:15], 0 offen nt
    v_cvt_pk_f16_f32 v168, v176, v177
    v_pk_fma_f16 v160, v168, v168, v160
    v_mfma_f32_16x16x32_bf16 v[192:195], v[200:203], a[152:155], v[192:195]
    s_cselect_b32 s80, s22, 0
    v_cvt_pk_f16_f32 v169, v178, v179
    v_pk_fma_f16 v162, v169, v169, v162
    v_mfma_f32_16x16x32_bf16 v[192:195], v[212:215], a[156:159], v[192:195]
    s_add_u32 s78, s78, s80
    s_add_u32 s80, s77, 20
    s_add_u32 s34, s18, 3
    v_mfma_f32_16x16x32_f16 v[140:143], v[40:43], v[160:163], 0
    s_cmp_lt_u32 s77, s62
    s_cselect_b32 s79, 1, 0
    s_cselect_b32 s78, s78, 0
    v_mfma_f32_16x16x32_bf16 v[192:195], v[216:219], a[160:163], v[192:195]
    s_waitcnt lgkmcnt(3)
    s_cmp_lt_u32 s34, s17
    s_cselect_b32 s23, s23, s78
    v_mfma_f32_16x16x32_f16 v[160:163], v[156:159], v[220:223], v[22:25]
    s_waitcnt lgkmcnt(1)
    v_rsq_f32 v142, v140
    v_mfma_f32_16x16x32_f16 v[160:163], v[180:183], v[120:123], v[160:163]
    s_cselect_b32 s73, s34, s80
    v_rsq_f32 v143, v141
    v_mfma_f32_16x16x32_f16 v[160:163], v[188:191], v[148:151], v[160:163]
    s_waitcnt lgkmcnt(0)
    v_mul_f32 v142, s31, v142
    v_cvt_pk_f16_f32 v142, v142, v143
    v_mfma_f32_16x16x32_f16 v[228:231], v[156:159], v[128:131], v[24:27]
    s_cselect_b32 s79, 0, s79
    v_pk_mul_f16 v124, v124, v142 op_sel:[0,1] op_sel_hi:[1,1]
    v_pk_mul_f16 v125, v125, v142 op_sel:[0,1] op_sel_hi:[1,1]
    v_mfma_f32_16x16x32_f16 v[228:231], v[180:183], v[164:167], v[228:231]
    s_cselect_b32 s81, 0, 1
    v_mov_b32_dpp v210, v161 quad_perm:[0,1,2,3] row_mask:0x1 bank_mask:0xf
    v_pk_mul_f16 v126, v126, v142 op_sel:[0,1] op_sel_hi:[1,1]
    v_mfma_f32_16x16x32_f16 v[228:231], v[188:191], v[204:207], v[228:231]
    s_add_u32 s80, s77, 1
    v_pk_mul_f16 v127, v127, v142 op_sel:[0,1] op_sel_hi:[1,1]
    v_pk_mul_f16 v170, v170, v142 op_sel:[0,1] op_sel_hi:[1,1]
    v_mfma_f32_16x16x32_bf16 v[192:195], v[224:227], a[164:167], v[192:195]
    s_mul_i32 s80, s80, s81
    v_pk_mul_f16 v171, v171, v142 op_sel:[0,1] op_sel_hi:[1,1]
    v_pk_mul_f16 v152, v152, v142 op_sel:[0,0] op_sel_hi:[1,0]
    v_mfma_f32_16x16x32_bf16 v[176:179], v[132:135], a[168:171], 0
    s_cmp_lt_u32 s80, s62
    v_mov_b32_dpp v210, v229 quad_perm:[0,1,2,3] row_mask:0x2 bank_mask:0xf
    v_pk_mul_f16 v153, v153, v142 op_sel:[0,0] op_sel_hi:[1,0]
    v_mfma_f32_16x16x32_f16 v[196:199], v[120:123], v[220:223], v[48:51]
    s_cselect_b32 s70, s70, 0
    v_cvt_pk_bf16_f32 v192, v192, v193
    v_cvt_pk_bf16_f32 v193, v194, v195
    v_mfma_f32_16x16x32_f16 v[232:235], v[164:167], v[220:223], v[52:55]
    s_cselect_b32 s62, s62, 0
    v_pk_mul_f16 v154, v154, v142 op_sel:[0,0] op_sel_hi:[1,0]
    v_pk_mul_f16 v155, v155, v142 op_sel:[0,0] op_sel_hi:[1,0]
    v_mfma_f32_16x16x32_f16 v[236:239], v[124:127], v[220:223], v[56:59]
    s_add_u32 s80, s18, 4
    v_pk_mul_f16 v168, v168, v142 op_sel:[0,0] op_sel_hi:[1,0]
    v_pk_mul_f16 v169, v169, v142 op_sel:[0,0] op_sel_hi:[1,0]
    v_min3_u32 v44, v44, v140, v141
    v_mfma_f32_16x16x16_f16 v[196:199], v[150:151], v[148:149], v[196:199]
    v_max3_u32 v45, v45, v140, v141
    v_exp_f32 v228, v228
    v_mfma_f32_16x16x16_f16 v[232:235], v[206:207], v[148:149], v[232:235]
    v_exp_f32 v160, v160
    s_cmp_ge_u32 s80, s17
    v_mfma_f32_16x16x16_f16 v[236:239], v[170:171], v[148:149], v[236:239]
    buffer_store_dwordx4 v[172:175], v17, s[12:15], 0 offen nt
    v_cvt_pk_bf16_f32 v39, v160, 0
    v_exp_f32 v196, v196
    s_cselect_b32 s66, s70, 0
    v_mfma_f32_16x16x32_bf16 v[176:179], v[116:119], a[172:175], v[176:179]
    s_lshl_b32 s80, s79, s73
    v_exp_f32 v197, v197
    v_mfma_f32_16x16x32_bf16 v[176:179], v[200:203], a[176:179], v[176:179]
    s_or_b32 s63, s63, s80
    v_exp_f32 v198, v198
    v_mfma_f32_16x16x32_bf16 v[176:179], v[212:215], a[180:183], v[176:179]
    s_sub_u32 s80, s100, s81
    ds_read_b128 v[140:143], v2 offset:0
    v_cvt_pk_bf16_f32 v160, v196, v197
    v_mfma_f32_16x16x32_bf16 v[176:179], v[216:219], a[184:187], v[176:179]
    s_and_b32 s100, s100, s80
    ds_read_b128 v[172:175], v2 offset:1024
    s_add_u32 s45, s45, s79
    v_mfma_f32_16x16x32_bf16 v[176:179], v[224:227], a[188:191], v[176:179]
    s_add_u32 s18, s18, 1
    ds_read_b128 v[220:223], v2 offset:2048
    s_cmp_lt_u32 s18, s45
    v_mfma_f32_16x16x32_bf16 v[240:243], v[132:135], a[192:195], 0
    ds_read_b128 v[132:135], v2 offset:3072
    v_mfma_f32_16x16x32_bf16 v[240:243], v[116:119], a[196:199], v[240:243]
    ds_read_b128 v[116:119], v2 offset:4096
    ds_read2_b32 v[194:195], v6 offset0:0 offset1:0
    v_mfma_f32_16x16x32_bf16 v[240:243], v[200:203], a[200:203], v[240:243]
    ds_read_b128 v[244:247], v2 offset:5120
    ds_read2_b32 v[202:203], v6 offset0:16 offset1:16
    v_mfma_f32_16x16x32_bf16 v[240:243], v[212:215], a[204:207], v[240:243]
    v_cvt_pk_bf16_f32 v200, v176, v177
    v_cvt_pk_bf16_f32 v201, v178, v179
    v_mfma_f32_16x16x32_bf16 v[240:243], v[216:219], a[208:211], v[240:243]
    ds_read2_b32 v[214:215], v6 offset0:32 offset1:32
    v_add_u32 v6, s75, v6
    v_mfma_f32_16x16x32_bf16 v[240:243], v[224:227], a[212:215], v[240:243]
    s_waitcnt lgkmcnt(8)
    v_exp_f32 v199, v199
    v_mfma_f32_16x16x32_f16 v[176:179], v[120:123], v[128:131], v[60:63]
    s_waitcnt lgkmcnt(7)
    v_exp_f32 v232, v232
    v_mfma_f32_16x16x32_f16 v[216:219], v[164:167], v[128:131], v[64:67]
    s_waitcnt lgkmcnt(6)
    v_exp_f32 v233, v233
    v_mfma_f32_16x16x32_f16 v[224:227], v[124:127], v[128:131], v[68:71]
    s_waitcnt lgkmcnt(5)
    v_cvt_pk_bf16_f32 v212, v240, v241
    v_cvt_pk_bf16_f32 v213, v242, v243
    v_cvt_pk_bf16_f32 v161, v198, v199
    v_mfma_f32_16x16x16_f16 v[176:179], v[150:151], v[204:205], v[176:179]
    v_cvt_pk_bf16_f32 v162, v232, v233
    v_exp_f32 v234, v234
    v_mfma_f32_16x16x16_f16 v[216:219], v[206:207], v[204:205], v[216:219]
    v_exp_f32 v235, v235
    v_mfma_f32_16x16x16_f16 v[224:227], v[170:171], v[204:205], v[224:227]
    buffer_atomic_add v46, v10, s[64:67], 0 offen sc0 sc1
    buffer_store_dwordx2 v[208:209], v20, s[12:15], 0 offen nt
    v_exp_f32 v236, v236
    v_mfma_f32_16x16x32_f16 v[240:243], v[156:159], v[152:155], v[26:29]
    s_waitcnt lgkmcnt(0)
    v_exp_f32 v176, v176
    v_mfma_f32_16x16x32_f16 v[240:243], v[180:183], v[124:127], v[240:243]
    v_exp_f32 v177, v177
    v_mfma_f32_16x16x32_f16 v[240:243], v[188:191], v[168:171], v[240:243]
    v_cvt_pk_bf16_f32 v156, v176, v177
    v_cvt_pk_bf16_f32 v163, v234, v235
    v_mfma_f32_16x16x32_bf16 v[128:131], a[216:219], v[140:143], 0
    v_exp_f32 v178, v178
    v_mfma_f32_16x16x32_bf16 v[128:131], a[220:223], v[172:175], v[128:131]
    v_exp_f32 v179, v179
    v_mfma_f32_16x16x32_bf16 v[128:131], a[224:227], v[220:223], v[128:131]
    v_exp_f32 v216, v216
    v_mfma_f32_16x16x32_bf16 v[128:131], a[228:231], v[132:135], v[128:131]
    v_cvt_pk_bf16_f32 v157, v178, v179
    v_mov_b32_dpp v210, v241 quad_perm:[0,1,2,3] row_mask:0x4 bank_mask:0xf
    v_mfma_f32_16x16x32_bf16 v[128:131], a[232:235], v[116:119], v[128:131]
    v_exp_f32 v217, v217
    v_mfma_f32_16x16x32_bf16 v[128:131], a[236:239], v[244:247], v[128:131]
    v_exp_f32 v218, v218
    v_mfma_f32_16x16x32_bf16 v[188:191], a[240:243], v[140:143], 0
    v_exp_f32 v219, v219
    v_mfma_f32_16x16x32_bf16 v[188:191], a[244:247], v[172:175], v[188:191]
    v_cvt_pk_bf16_f32 v158, v216, v217
    v_cvt_pk_bf16_f32 v159, v218, v219
    v_mfma_f32_16x16x32_bf16 v[188:191], a[248:251], v[220:223], v[188:191]
    ds_read_b128 v[180:183], v2 offset:6144
    v_fma_f32 v241, v128, v128, s33
    v_mfma_f32_16x16x32_bf16 v[188:191], a[252:255], v[132:135], v[188:191]
    ds_read_b128 v[216:219], v2 offset:7168
    v_fmac_f32 v241, v129, v129
    v_mfma_f32_16x16x32_bf16 v[188:191], v[84:87], v[116:119], v[188:191]
    ds_read_b128 v[232:235], v2 offset:8192
    v_fmac_f32 v241, v130, v130
    v_mfma_f32_16x16x32_bf16 v[188:191], v[88:91], v[244:247], v[188:191]
    ds_read_b128 v[248:251], v2 offset:9216
    v_fmac_f32 v241, v131, v131
    v_mfma_f32_16x16x32_bf16 v[176:179], v[92:95], v[140:143], 0
    ds_read_b128 v[140:143], v2 offset:10240
    v_mfma_f32_16x16x32_bf16 v[176:179], v[96:99], v[172:175], v[176:179]
    ds_read_b128 v[172:175], v2 offset:11264
    v_mfma_f32_16x16x32_bf16 v[176:179], v[100:103], v[220:223], v[176:179]
    v_exp_f32 v224, v224
    v_mfma_f32_16x16x32_bf16 v[176:179], v[104:107], v[132:135], v[176:179]
    v_exp_f32 v225, v225
    v_mfma_f32_16x16x32_bf16 v[176:179], v[108:111], v[116:119], v[176:179]
    s_waitcnt lgkmcnt(5)
    v_exp_f32 v226, v226
    v_mfma_f32_16x16x32_bf16 v[176:179], v[112:115], v[244:247], v[176:179]
    s_waitcnt lgkmcnt(4)
    v_exp_f32 v227, v227
    v_mfma_f32_16x16x32_f16 v[116:119], v[120:123], v[152:155], v[72:75]
    s_waitcnt lgkmcnt(3)
    v_exp_f32 v210, v210
    v_mfma_f32_16x16x32_f16 v[120:123], v[164:167], v[152:155], v[76:79]
    s_waitcnt lgkmcnt(2)
    v_cvt_pk_bf16_f32 v210, v210, v210
    v_fmac_f32 v241, v188, v188
    v_mfma_f32_16x16x32_f16 v[132:135], v[124:127], v[152:155], v[80:83]
    s_waitcnt lgkmcnt(1)
    ds_write_b16 v8, v210
    v_fmac_f32 v241, v189, v189
    v_mfma_f32_16x16x16_f16 v[116:119], v[150:151], v[168:169], v[116:119]
    v_exp_f32 v237, v237
    v_fmac_f32 v241, v190, v190
    v_mfma_f32_16x16x16_f16 v[120:123], v[206:207], v[168:169], v[120:123]
    v_cvt_pk_bf16_f32 v36, v236, v237
    v_exp_f32 v238, v238
    v_mfma_f32_16x16x16_f16 v[132:135], v[170:171], v[168:169], v[132:135]
    v_exp_f32 v239, v239
    v_exp_f32 v240, v240
    v_mfma_f32_16x16x32_bf16 v[196:199], a[216:219], v[180:183], 0
    s_waitcnt lgkmcnt(1)
    ds_read_b128 v[124:127], v9
    ds_read_b128 v[148:151], v9 offset:64
    v_mfma_f32_16x16x32_bf16 v[196:199], a[220:223], v[216:219], v[196:199]
    v_cvt_pk_bf16_f32 v37, v238, v239
    v_fmac_f32 v241, v191, v191
    v_mfma_f32_16x16x32_bf16 v[196:199], a[224:227], v[232:235], v[196:199]
    v_exp_f32 v116, v116
    v_mfma_f32_16x16x32_bf16 v[152:155], v[28:31], v[36:39], 0
    v_exp_f32 v117, v117
    v_mfma_f32_16x16x32_bf16 v[152:155], v[28:31], v[160:163], v[152:155]
    v_cvt_pk_bf16_f32 v116, v116, v117
    v_fmac_f32 v241, v176, v176
    v_mfma_f32_16x16x32_bf16 v[164:167], v[192:195], v[36:39], 0
    v_exp_f32 v118, v118
    v_mfma_f32_16x16x32_bf16 v[164:167], v[184:187], v[160:163], v[164:167]
    v_exp_f32 v119, v119
    v_mfma_f32_16x16x32_bf16 v[168:171], v[200:203], v[36:39], 0
    v_cvt_pk_bf16_f32 v117, v118, v119
    v_fmac_f32 v241, v177, v177
    v_mfma_f32_16x16x32_bf16 v[168:171], v[144:147], v[160:163], v[168:171]
    s_waitcnt lgkmcnt(0)
    v_exp_f32 v120, v120
    v_mfma_f32_16x16x32_bf16 v[204:207], v[212:215], v[36:39], 0
    v_cvt_pk_bf16_f32 v36, v224, v225
    v_cvt_pk_bf16_f32 v37, v226, v227
    v_mfma_f32_16x16x32_bf16 v[204:207], v[136:139], v[160:163], v[204:207]
    v_cvt_pk_bf16_f32 v39, v228, 0
    v_fmac_f32 v241, v178, v178
    v_mfma_f32_16x16x32_bf16 v[220:223], v[124:127], v[28:31], 0
    v_exp_f32 v121, v121
    v_mfma_f32_16x16x32_bf16 v[160:163], v[28:31], v[36:39], 0
    v_cvt_pk_bf16_f32 v118, v120, v121
    v_fmac_f32 v241, v179, v179
    v_mfma_f32_16x16x32_bf16 v[160:163], v[28:31], v[156:159], v[160:163]
    v_exp_f32 v122, v122
    v_mfma_f32_16x16x32_bf16 v[208:211], v[192:195], v[36:39], 0
    v_exp_f32 v123, v123
    v_mfma_f32_16x16x32_bf16 v[208:211], v[184:187], v[156:159], v[208:211]
    v_exp_f32 v132, v132
    v_mfma_f32_16x16x32_bf16 v[224:227], v[200:203], v[36:39], 0
    v_exp_f32 v133, v133
    v_mfma_f32_16x16x32_bf16 v[224:227], v[144:147], v[156:159], v[224:227]
    v_exp_f32 v134, v134
    v_mfma_f32_16x16x32_bf16 v[228:231], v[212:215], v[36:39], 0
    v_cvt_pk_bf16_f32 v119, v122, v123
    v_cvt_pk_bf16_f32 v36, v132, v133
    v_mfma_f32_16x16x32_bf16 v[228:231], v[136:139], v[156:159], v[228:231]
    v_exp_f32 v135, v135
    v_mfma_f32_16x16x32_bf16 v[220:223], v[148:151], v[28:31], v[220:223]
    v_cvt_pk_bf16_f32 v37, v134, v135
    v_cvt_pk_bf16_f32 v39, v240, 0
    v_mfma_f32_16x16x32_bf16 v[120:123], v[124:127], v[184:187], 0
    v_rcp_f32 v160, v160
    v_mfma_f32_16x16x32_bf16 v[156:159], v[28:31], v[36:39], 0
    v_mul_f32 v208, v160, v208
    v_mul_f32 v209, v160, v209
    v_mfma_f32_16x16x32_bf16 v[156:159], v[28:31], v[116:119], v[156:159]
    v_cvt_pk_bf16_f32 v132, v208, v209
    v_mul_f32 v210, v160, v210
    v_mfma_f32_16x16x32_bf16 v[236:239], v[192:195], v[36:39], 0
    v_mul_f32 v211, v160, v211
    v_cvt_pk_bf16_f32 v133, v210, v211
    v_mfma_f32_16x16x32_bf16 v[236:239], v[184:187], v[116:119], v[236:239]
    ds_write_b64 v3, v[132:133] offset:6144
    v_mfma_f32_16x16x32_bf16 v[184:187], v[200:203], v[36:39], 0
    v_mul_f32 v224, v160, v224
    v_mul_f32 v225, v160, v225
    v_mfma_f32_16x16x32_bf16 v[184:187], v[144:147], v[116:119], v[184:187]
    v_cvt_pk_bf16_f32 v134, v224, v225
    v_mul_f32 v226, v160, v226
    v_mfma_f32_16x16x32_bf16 v[244:247], v[212:215], v[36:39], 0
    v_mul_f32 v227, v160, v227
    v_cvt_pk_bf16_f32 v135, v226, v227
    v_mfma_f32_16x16x32_bf16 v[244:247], v[136:139], v[116:119], v[244:247]
    ds_write_b64 v3, v[134:135] offset:6152
    v_mfma_f32_16x16x32_bf16 v[120:123], v[148:151], v[192:195], v[120:123]
    v_mul_f32 v228, v160, v228
    v_mul_f32 v229, v160, v229
    v_mfma_f32_16x16x32_bf16 v[192:195], v[124:127], v[144:147], 0
    v_cvt_pk_bf16_f32 v228, v228, v229
    v_mul_f32 v230, v160, v230
    v_mfma_f32_16x16x32_bf16 v[192:195], v[148:151], v[200:203], v[192:195]
    v_mul_f32 v231, v160, v231
    v_cvt_pk_bf16_f32 v229, v230, v231
    v_mfma_f32_16x16x32_bf16 v[144:147], v[124:127], v[136:139], 0
    ds_write_b64 v4, v[228:229] offset:10240
    v_mfma_f32_16x16x32_bf16 v[144:147], v[148:151], v[212:215], v[144:147]
    v_rcp_f32 v152, v152
    v_mfma_f32_16x16x32_bf16 v[196:199], a[228:231], v[248:251], v[196:199]
    v_mul_f32 v164, v152, v164
    v_mul_f32 v165, v152, v165
    v_mfma_f32_16x16x32_bf16 v[196:199], a[232:235], v[140:143], v[196:199]
    v_cvt_pk_bf16_f32 v116, v164, v165
    v_mul_f32 v166, v152, v166
    v_mfma_f32_16x16x32_bf16 v[196:199], a[236:239], v[172:175], v[196:199]
    v_mul_f32 v167, v152, v167
    v_cvt_pk_bf16_f32 v117, v166, v167
    v_mfma_f32_16x16x32_bf16 v[132:135], a[240:243], v[180:183], 0
    ds_write_b64 v3, v[116:117] offset:0
    v_mfma_f32_16x16x32_bf16 v[132:135], a[244:247], v[216:219], v[132:135]
    v_mul_f32 v168, v152, v168
    v_mul_f32 v169, v152, v169
    v_mfma_f32_16x16x32_bf16 v[132:135], a[248:251], v[232:235], v[132:135]
    ds_read_b128 v[124:127], v2 offset:12288
    v_fma_f32 v121, v196, v196, s33
    v_mfma_f32_16x16x32_bf16 v[132:135], a[252:255], v[248:251], v[132:135]
    ds_read_b128 v[148:151], v2 offset:13312
    v_fmac_f32 v121, v197, v197
    v_mfma_f32_16x16x32_bf16 v[132:135], v[84:87], v[140:143], v[132:135]
    ds_read_b128 v[164:167], v2 offset:14336
    v_fmac_f32 v121, v198, v198
    v_mfma_f32_16x16x32_bf16 v[132:135], v[88:91], v[172:175], v[132:135]
    ds_read_b128 v[224:227], v2 offset:15360
    v_fmac_f32 v121, v199, v199
    v_mfma_f32_16x16x32_bf16 v[212:215], v[92:95], v[180:183], 0
    ds_read_b128 v[180:183], v2 offset:16384
    v_cvt_pk_bf16_f32 v118, v168, v169
    v_mfma_f32_16x16x32_bf16 v[212:215], v[96:99], v[216:219], v[212:215]
    ds_read_b128 v[228:231], v2 offset:17408
    v_mul_f32 v170, v152, v170
    v_mfma_f32_16x16x32_bf16 v[212:215], v[100:103], v[232:235], v[212:215]
    v_fmac_f32 v121, v132, v132
    v_fmac_f32 v121, v133, v133
    v_mfma_f32_16x16x32_bf16 v[212:215], v[104:107], v[248:251], v[212:215]
    v_fmac_f32 v121, v134, v134
    v_fmac_f32 v121, v135, v135
    v_mfma_f32_16x16x32_bf16 v[212:215], v[108:111], v[140:143], v[212:215]
    s_waitcnt lgkmcnt(5)
    v_mul_f32 v171, v152, v171
    v_cvt_pk_bf16_f32 v119, v170, v171
    v_mfma_f32_16x16x32_bf16 v[212:215], v[112:115], v[172:175], v[212:215]
    s_waitcnt lgkmcnt(4)
    ds_write_b64 v3, v[118:119] offset:8
    v_mfma_f32_16x16x32_bf16 v[200:203], a[216:219], v[124:127], 0
    s_waitcnt lgkmcnt(3)
    v_mul_f32 v204, v152, v204
    v_mul_f32 v205, v152, v205
    v_mfma_f32_16x16x32_bf16 v[200:203], a[220:223], v[148:151], v[200:203]
    s_waitcnt lgkmcnt(2)
    ds_read_b128 v[232:235], v0 offset:20480
    v_fmac_f32 v121, v212, v212
    v_mfma_f32_16x16x32_bf16 v[200:203], a[224:227], v[164:167], v[200:203]
    s_waitcnt lgkmcnt(2)
    ds_read_b128 v[248:251], v1 offset:20480
    v_fmac_f32 v121, v213, v213
    v_mfma_f32_16x16x32_bf16 v[200:203], a[228:231], v[224:227], v[200:203]
    ds_read_b128 v[160:163], v0 offset:20608
    v_fmac_f32 v121, v214, v214
    v_mfma_f32_16x16x32_bf16 v[200:203], a[232:235], v[180:183], v[200:203]
    ds_read_b128 v[136:139], v1 offset:20608
    v_fmac_f32 v121, v215, v215
    v_mfma_f32_16x16x32_bf16 v[200:203], a[236:239], v[228:231], v[200:203]
    ds_read_b128 v[116:119], v0 offset:20736
    v_cvt_pk_bf16_f32 v158, v241, v121
    v_mfma_f32_16x16x32_bf16 v[216:219], a[240:243], v[124:127], 0
    ds_read_b128 v[172:175], v1 offset:20736
    v_cvt_pk_bf16_f32 v204, v204, v205
    v_mfma_f32_16x16x32_bf16 v[216:219], a[244:247], v[148:151], v[216:219]
    v_mul_f32 v206, v152, v206
    v_mul_f32 v207, v152, v207
    v_mfma_f32_16x16x32_bf16 v[216:219], a[248:251], v[164:167], v[216:219]
    v_fma_f32 v157, v200, v200, s33
    v_fmac_f32 v157, v201, v201
    v_mfma_f32_16x16x32_bf16 v[216:219], a[252:255], v[224:227], v[216:219]
    s_waitcnt lgkmcnt(5)
    v_fmac_f32 v157, v202, v202
    v_fmac_f32 v157, v203, v203
    v_mfma_f32_16x16x32_bf16 v[216:219], v[84:87], v[180:183], v[216:219]
    s_waitcnt lgkmcnt(4)
    v_cvt_pk_bf16_f32 v205, v206, v207
    v_xor_b32 v2, 65536, v2
    v_mfma_f32_16x16x32_bf16 v[216:219], v[88:91], v[228:231], v[216:219]
    s_waitcnt lgkmcnt(3)
    ds_write_b64 v4, v[204:205] offset:4096
    v_mfma_f32_16x16x32_bf16 v[208:211], v[92:95], v[124:127], 0
    s_waitcnt lgkmcnt(2)
    v_rcp_f32 v220, v220
    v_mfma_f32_16x16x32_bf16 v[208:211], v[96:99], v[148:151], v[208:211]
    s_waitcnt lgkmcnt(1)
    v_rcp_f32 v156, v156
    v_mfma_f32_16x16x32_bf16 v[208:211], v[100:103], v[164:167], v[208:211]
    v_fmac_f32 v157, v216, v216
    v_fmac_f32 v157, v217, v217
    v_mfma_f32_16x16x32_bf16 v[208:211], v[104:107], v[224:227], v[208:211]
    v_fmac_f32 v157, v218, v218
    v_fmac_f32 v157, v219, v219
    v_mfma_f32_16x16x32_bf16 v[208:211], v[108:111], v[180:183], v[208:211]
    v_mul_f32 v120, v120, v220
    v_mul_f32_dpp v120, v192, v220 quad_perm:[0,1,2,3] row_mask:0x2 bank_mask:0xf
    v_mfma_f32_16x16x32_bf16 v[208:211], v[112:115], v[228:231], v[208:211]
    v_mul_f32_dpp v120, v144, v220 quad_perm:[0,1,2,3] row_mask:0x4 bank_mask:0xf
    v_cvt_pk_bf16_f32 v120, v120, v120
    v_mfma_f32_16x16x32_bf16 v[124:127], a[72:75], v[232:235], 0
    ds_write_b16 v7, v120
    v_mfma_f32_16x16x32_bf16 v[124:127], a[76:79], v[248:251], v[124:127]
    v_mul_f32 v236, v156, v236
    v_mul_f32 v237, v156, v237
    v_mfma_f32_16x16x32_bf16 v[124:127], a[80:83], v[160:163], v[124:127]
    v_fmac_f32 v157, v208, v208
    v_fmac_f32 v157, v209, v209
    v_mfma_f32_16x16x32_bf16 v[124:127], a[84:87], v[136:139], v[124:127]
    v_fmac_f32 v157, v210, v210
    v_fmac_f32 v157, v211, v211
    v_mfma_f32_16x16x32_bf16 v[124:127], a[88:91], v[116:119], v[124:127]
    v_cvt_pk_bf16_f32 v159, v157, v157
    v_cvt_pk_bf16_f32 v120, v236, v237
    v_mfma_f32_16x16x32_bf16 v[124:127], a[92:95], v[172:175], v[124:127]
    ds_write_b64 v4, v[158:159] offset:18432
    v_mfma_f32_16x16x32_bf16 v[140:143], a[96:99], v[232:235], 0
    v_mul_f32 v238, v156, v238
    v_mul_f32 v239, v156, v239
    v_mfma_f32_16x16x32_bf16 v[140:143], a[100:103], v[248:251], v[140:143]
    v_cvt_pk_bf16_f32 v121, v238, v239
    v_mul_f32 v184, v156, v184
    v_mfma_f32_16x16x32_bf16 v[140:143], a[104:107], v[160:163], v[140:143]
    ds_write_b64 v3, v[120:121] offset:12288
    v_mfma_f32_16x16x32_bf16 v[140:143], a[108:111], v[136:139], v[140:143]
    v_mul_f32 v185, v156, v185
    v_cvt_pk_bf16_f32 v122, v184, v185
    v_mfma_f32_16x16x32_bf16 v[140:143], a[112:115], v[116:119], v[140:143]
    v_mul_f32 v186, v156, v186
    v_mul_f32 v187, v156, v187
    v_mfma_f32_16x16x32_bf16 v[140:143], a[116:119], v[172:175], v[140:143]
    v_cvt_pk_bf16_f32 v123, v186, v187
    v_mul_f32 v244, v156, v244
    v_mfma_f32_16x16x32_bf16 v[144:147], a[120:123], v[232:235], 0
    ds_write_b64 v3, v[122:123] offset:12296
    v_mfma_f32_16x16x32_bf16 v[144:147], a[124:127], v[248:251], v[144:147]
    v_mul_f32 v245, v156, v245
    v_cvt_pk_bf16_f32 v244, v244, v245
    v_mfma_f32_16x16x32_bf16 v[144:147], a[128:131], v[160:163], v[144:147]
    v_mul_f32 v246, v156, v246
    v_mul_f32 v247, v156, v247
    v_mfma_f32_16x16x32_bf16 v[144:147], a[132:135], v[136:139], v[144:147]
    v_cvt_pk_bf16_f32 v245, v246, v247
    v_add_u32 v7, s76, v7
    v_mfma_f32_16x16x32_bf16 v[144:147], a[136:139], v[116:119], v[144:147]
    ds_write_b64 v4, v[244:245] offset:16384
    v_mfma_f32_16x16x32_bf16 v[144:147], a[140:143], v[172:175], v[144:147]
    v_cvt_pk_f16_f32 v120, v124, v125
    v_pk_mul_f16 v125, v120, v120
    v_mfma_f32_16x16x32_bf16 v[152:155], a[0:3], v[232:235], 0
    v_cvt_pk_f16_f32 v121, v126, v127
    v_pk_mul_f16 v127, v121, v121
    v_mfma_f32_16x16x32_bf16 v[152:155], a[4:7], v[248:251], v[152:155]
    v_cvt_pk_f16_f32 v122, v140, v141
    v_pk_fma_f16 v125, v122, v122, v125
    v_mfma_f32_16x16x32_bf16 v[152:155], a[8:11], v[160:163], v[152:155]
    v_xor_b32 v3, 65536, v3
    v_xor_b32 v4, 65536, v4
    v_mfma_f32_16x16x32_bf16 v[152:155], a[12:15], v[136:139], v[152:155]
    v_mfma_f32_16x16x32_bf16 v[152:155], a[16:19], v[116:119], v[152:155]
    v_mfma_f32_16x16x32_bf16 v[152:155], a[20:23], v[172:175], v[152:155]
    s_waitcnt lgkmcnt(0)
    v_mfma_f32_16x16x32_bf16 v[156:159], a[24:27], v[232:235], 0
    s_barrier
    v_mfma_f32_16x16x32_bf16 v[156:159], a[28:31], v[248:251], v[156:159]
    s_nop 0
    v_mfma_f32_16x16x32_bf16 v[156:159], a[32:35], v[160:163], v[156:159]
    s_nop 0
    v_mfma_f32_16x16x32_bf16 v[156:159], a[36:39], v[136:139], v[156:159]
    s_nop 0
    v_mfma_f32_16x16x32_bf16 v[156:159], a[40:43], v[116:119], v[156:159]
    v_mfma_f32_16x16x32_bf16 v[156:159], a[44:47], v[172:175], v[156:159]
    s_cbranch_scc1 L_loop_fast0
    s_branch L_final_fast
.p2align 6
L_loop_fast1:
    v_mfma_f32_16x16x32_bf16 v[164:167], a[48:51], v[232:235], 0
    s_add_u32 s12, s40, s27
    ds_read_b128 v[168:171], v2 offset:18432
    ds_read_b128 v[180:183], v2 offset:19456
    v_mfma_f32_16x16x32_bf16 v[164:167], a[52:55], v[248:251], v[164:167]
    s_addc_u32 s13, s41, 0
    v_cvt_pk_f16_f32 v123, v142, v143
    v_pk_fma_f16 v127, v123, v123, v127
    v_mfma_f32_16x16x32_bf16 v[164:167], a[56:59], v[160:163], v[164:167]
    s_sub_u32 s14, s36, s27
    v_cvt_pk_f16_f32 v150, v144, v145
    v_pk_fma_f16 v125, v150, v150, v125
    v_mfma_f32_16x16x32_bf16 v[164:167], a[60:63], v[136:139], v[164:167]
    s_cmp_ge_u32 s18, 2
    v_cvt_pk_f16_f32 v151, v146, v147
    v_pk_fma_f16 v127, v151, v151, v127
    v_mfma_f32_16x16x32_bf16 v[164:167], a[64:67], v[116:119], v[164:167]
    s_cselect_b32 s14, s14, 0
    v_cvt_pk_f16_f32 v220, v152, v153
    v_pk_mul_f16 v124, v220, v220
    v_mfma_f32_16x16x32_bf16 v[164:167], a[68:71], v[172:175], v[164:167]
    s_sub_u32 s82, s72, s71
    v_cvt_pk_f16_f32 v221, v154, v155
    v_pk_mul_f16 v126, v221, v221
    v_mfma_f32_16x16x32_bf16 v[184:187], v[232:235], a[144:147], 0
    s_mul_i32 s74, s82, 336
    v_cvt_pk_f16_f32 v222, v156, v157
    v_pk_fma_f16 v124, v222, v222, v124
    v_mfma_f32_16x16x32_bf16 v[184:187], v[248:251], a[148:151], v[184:187]
    s_mul_i32 s75, s82, 272
    v_cvt_pk_f16_f32 v223, v158, v159
    v_pk_fma_f16 v126, v223, v223, v126
    v_mfma_f32_16x16x32_bf16 v[184:187], v[160:163], a[152:155], v[184:187]
    s_waitcnt lgkmcnt(0)
    v_cvt_pk_f16_f32 v148, v164, v165
    v_pk_fma_f16 v124, v148, v148, v124
    v_mfma_f32_16x16x32_bf16 v[140:143], v[32:35], v[168:171], 0
    s_mul_i32 s76, s82, 16
    v_cvt_pk_f16_f32 v149, v166, v167
    v_pk_fma_f16 v126, v149, v149, v126
    v_mfma_f32_16x16x32_bf16 v[140:143], v[32:35], v[180:183], v[140:143]
    s_add_u32 s34, s18, 2
    s_add_u32 s8, s60, s23
    s_addc_u32 s9, s61, 0
    v_mfma_f32_16x16x32_f16 v[144:147], v[40:43], v[124:127], 0
    s_sub_u32 s10, s36, s23
    s_cmp_le_u32 s34, s45
    s_cselect_b32 s10, s10, 0
    v_mfma_f32_16x16x32_bf16 v[184:187], v[136:139], a[156:159], v[184:187]
    s_add_u32 m0, s28, 0
    v_mul_f32 v140, 0x3baaaaab, v140
    v_mul_f32 v141, 0x3baaaaab, v141
    v_mfma_f32_16x16x32_bf16 v[184:187], v[116:119], a[160:163], v[184:187]
    s_mov_b32 s27, s26
    ds_read_b128 v[180:183], v0 offset:26624
    v_min3_u32 v44, v44, v144, v145
    v_mfma_f32_16x16x32_bf16 v[184:187], v[172:175], a[164:167], v[184:187]
    s_mov_b32 s26, s25
    ds_read_b128 v[124:127], v1 offset:26624
    v_max3_u32 v45, v45, v144, v145
    v_mfma_f32_16x16x32_bf16 v[164:167], v[232:235], a[168:171], 0
    s_mov_b32 s25, s24
    ds_read_b128 v[168:171], v0 offset:26752
    v_mul_f32 v142, 0x3baaaaab, v142
    v_mfma_f32_16x16x32_bf16 v[164:167], v[248:251], a[172:175], v[164:167]
    s_mov_b32 s24, s23
    ds_read_b128 v[152:155], v1 offset:26752
    v_cvt_pk_bf16_f32 v184, v184, v185
    v_mfma_f32_16x16x32_bf16 v[164:167], v[160:163], a[176:179], v[164:167]
    s_ff1_i32_b32 s80, s100
    ds_read_b128 v[156:159], v0 offset:26880
    v_cvt_pk_bf16_f32 v185, v186, v187
    v_mfma_f32_16x16x32_bf16 v[164:167], v[136:139], a[180:183], v[164:167]
    s_mov_b32 s71, s72
    ds_read_b128 v[192:195], v1 offset:26880
    s_mov_b32 s72, s73
    v_mfma_f32_16x16x32_bf16 v[164:167], v[116:119], a[184:187], v[164:167]
    v_rsq_f32 v146, v144
    v_mfma_f32_16x16x32_bf16 v[164:167], v[172:175], a[188:191], v[164:167]
    v_rsq_f32 v147, v145
    v_mfma_f32_16x16x32_bf16 v[204:207], v[232:235], a[192:195], 0
    s_waitcnt lgkmcnt(5)
    v_rsq_f32 v140, v140
    v_mfma_f32_16x16x32_bf16 v[204:207], v[248:251], a[196:199], v[204:207]
    s_waitcnt lgkmcnt(4)
    v_mul_f32 v146, s31, v146
    v_cvt_pk_f16_f32 v146, v146, v147
    v_mfma_f32_16x16x32_bf16 v[204:207], v[160:163], a[200:203], v[204:207]
    s_waitcnt lgkmcnt(3)
    v_cvt_pk_bf16_f32 v144, v164, v165
    v_cvt_pk_bf16_f32 v145, v166, v167
    v_mfma_f32_16x16x32_bf16 v[204:207], v[136:139], a[204:207], v[204:207]
    s_waitcnt lgkmcnt(2)
    v_pk_mul_f16 v120, v120, v146 op_sel:[0,1] op_sel_hi:[1,1]
    v_pk_mul_f16 v121, v121, v146 op_sel:[0,1] op_sel_hi:[1,1]
    v_mfma_f32_16x16x32_bf16 v[204:207], v[116:119], a[208:211], v[204:207]
    s_waitcnt lgkmcnt(1)
    v_pk_mul_f16 v122, v122, v146 op_sel:[0,1] op_sel_hi:[1,1]
    v_pk_mul_f16 v123, v123, v146 op_sel:[0,1] op_sel_hi:[1,1]
    v_mfma_f32_16x16x32_bf16 v[204:207], v[172:175], a[212:215], v[204:207]
    s_waitcnt lgkmcnt(0)
    v_pk_mul_f16 v150, v150, v146 op_sel:[0,1] op_sel_hi:[1,1]
    v_pk_mul_f16 v151, v151, v146 op_sel:[0,1] op_sel_hi:[1,1]
    v_mfma_f32_16x16x32_bf16 v[116:119], a[72:75], v[180:183], 0
    v_pk_mul_f16 v220, v220, v146 op_sel:[0,0] op_sel_hi:[1,0]
    v_pk_mul_f16 v221, v221, v146 op_sel:[0,0] op_sel_hi:[1,0]
    v_mfma_f32_16x16x32_bf16 v[116:119], a[76:79], v[124:127], v[116:119]
    v_pk_mul_f16 v222, v222, v146 op_sel:[0,0] op_sel_hi:[1,0]
    v_cvt_pk_bf16_f32 v136, v204, v205
    v_mfma_f32_16x16x32_bf16 v[116:119], a[80:83], v[168:171], v[116:119]
    v_cvt_pk_bf16_f32 v137, v206, v207
    v_pk_mul_f16 v223, v223, v146 op_sel:[0,0] op_sel_hi:[1,0]
    v_mfma_f32_16x16x32_bf16 v[116:119], a[84:87], v[152:155], v[116:119]
    v_pk_mul_f16 v148, v148, v146 op_sel:[0,0] op_sel_hi:[1,0]
    v_pk_mul_f16 v149, v149, v146 op_sel:[0,0] op_sel_hi:[1,0]
    v_mfma_f32_16x16x32_bf16 v[116:119], a[88:91], v[156:159], v[116:119]
    v_rsq_f32 v141, v141
    v_mfma_f32_16x16x32_bf16 v[116:119], a[92:95], v[192:195], v[116:119]
    v_rsq_f32 v142, v142
    v_mfma_f32_16x16x32_bf16 v[160:163], a[96:99], v[180:183], 0
    v_mul_f32 v128, v140, v128
    v_mul_f32 v129, v140, v129
    v_mfma_f32_16x16x32_bf16 v[160:163], a[100:103], v[124:127], v[160:163]
    v_cvt_pk_bf16_f32 v128, v128, v129
    v_mul_f32 v130, v140, v130
    v_mfma_f32_16x16x32_bf16 v[160:163], a[104:107], v[168:171], v[160:163]
    v_cvt_pk_f16_f32 v164, v116, v117
    v_pk_mul_f16 v117, v164, v164
    v_mfma_f32_16x16x32_bf16 v[160:163], a[108:111], v[152:155], v[160:163]
    v_cvt_pk_f16_f32 v165, v118, v119
    v_pk_mul_f16 v119, v165, v165
    v_mfma_f32_16x16x32_bf16 v[160:163], a[112:115], v[156:159], v[160:163]
    v_mul_f32 v131, v140, v131
    v_cvt_pk_bf16_f32 v129, v130, v131
    v_mfma_f32_16x16x32_bf16 v[160:163], a[116:119], v[192:195], v[160:163]
    v_mul_f32 v188, v140, v188
    v_mul_f32 v189, v140, v189
    v_mfma_f32_16x16x32_bf16 v[172:175], a[120:123], v[180:183], 0
    v_cvt_pk_bf16_f32 v130, v188, v189
    v_mul_f32 v190, v140, v190
    v_mfma_f32_16x16x32_bf16 v[172:175], a[124:127], v[124:127], v[172:175]
    v_mul_f32 v191, v140, v191
    v_cvt_pk_bf16_f32 v131, v190, v191
    v_mfma_f32_16x16x32_bf16 v[172:175], a[128:131], v[168:171], v[172:175]
    buffer_store_dwordx4 v[128:131], v15, s[12:15], 0 offen nt
    v_cvt_pk_f16_f32 v166, v160, v161
    v_pk_fma_f16 v117, v166, v166, v117
    v_cvt_pk_f16_f32 v167, v162, v163
    v_pk_fma_f16 v119, v167, v167, v119
    v_mfma_f32_16x16x32_bf16 v[172:175], a[132:135], v[152:155], v[172:175]
    v_mul_f32 v176, v140, v176
    v_mul_f32 v177, v140, v177
    v_mfma_f32_16x16x32_bf16 v[172:175], a[136:139], v[156:159], v[172:175]
    v_cvt_pk_bf16_f32 v138, v176, v177
    v_mul_f32 v178, v140, v178
    v_mfma_f32_16x16x32_bf16 v[172:175], a[140:143], v[192:195], v[172:175]
    v_mul_f32 v179, v140, v179
    v_cvt_pk_bf16_f32 v139, v178, v179
    v_mfma_f32_16x16x32_bf16 v[128:131], a[0:3], v[180:183], 0
    v_mul_f32 v196, v141, v196
    v_mul_f32 v197, v141, v197
    v_mfma_f32_16x16x32_bf16 v[128:131], a[4:7], v[124:127], v[128:131]
    v_cvt_pk_bf16_f32 v160, v196, v197
    v_mul_f32 v198, v141, v198
    v_mfma_f32_16x16x32_bf16 v[128:131], a[8:11], v[168:171], v[128:131]
    v_cvt_pk_f16_f32 v206, v172, v173
    v_pk_fma_f16 v117, v206, v206, v117
    v_mfma_f32_16x16x32_bf16 v[128:131], a[12:15], v[152:155], v[128:131]
    v_cvt_pk_f16_f32 v207, v174, v175
    v_pk_fma_f16 v119, v207, v207, v119
    v_mfma_f32_16x16x32_bf16 v[128:131], a[16:19], v[156:159], v[128:131]
    v_mul_f32 v199, v141, v199
    v_cvt_pk_bf16_f32 v161, v198, v199
    v_mfma_f32_16x16x32_bf16 v[128:131], a[20:23], v[192:195], v[128:131]
    v_mul_f32 v132, v141, v132
    v_mul_f32 v133, v141, v133
    v_mfma_f32_16x16x32_bf16 v[172:175], a[24:27], v[180:183], 0
    v_cvt_pk_bf16_f32 v162, v132, v133
    v_mul_f32 v134, v141, v134
    v_mfma_f32_16x16x32_bf16 v[172:175], a[28:31], v[124:127], v[172:175]
    v_mul_f32 v135, v141, v135
    v_cvt_pk_bf16_f32 v163, v134, v135
    v_mfma_f32_16x16x32_bf16 v[172:175], a[32:35], v[168:171], v[172:175]
    v_cvt_pk_f16_f32 v128, v128, v129
    v_pk_mul_f16 v116, v128, v128
    v_mfma_f32_16x16x32_bf16 v[172:175], a[36:39], v[152:155], v[172:175]
    v_cvt_pk_f16_f32 v129, v130, v131
    v_pk_mul_f16 v118, v129, v129
    v_mfma_f32_16x16x32_bf16 v[172:175], a[40:43], v[156:159], v[172:175]
    v_mul_f32 v212, v141, v212
    v_mul_f32 v213, v141, v213
    v_mfma_f32_16x16x32_bf16 v[172:175], a[44:47], v[192:195], v[172:175]
    v_cvt_pk_bf16_f32 v140, v212, v213
    v_mul_f32 v214, v141, v214
    v_mfma_f32_16x16x32_bf16 v[132:135], a[48:51], v[180:183], 0
    v_mul_f32 v215, v141, v215
    v_cvt_pk_bf16_f32 v141, v214, v215
    v_mfma_f32_16x16x32_bf16 v[132:135], a[52:55], v[124:127], v[132:135]
    buffer_store_dwordx2 v[138:139], v18, s[12:15], 0 offen nt
    v_mul_f32 v200, v142, v200
    v_cvt_pk_f16_f32 v130, v172, v173
    v_mfma_f32_16x16x32_bf16 v[132:135], a[56:59], v[168:171], v[132:135]
    v_pk_fma_f16 v116, v130, v130, v116
    v_cvt_pk_f16_f32 v131, v174, v175
    v_mfma_f32_16x16x32_bf16 v[132:135], a[60:63], v[152:155], v[132:135]
    v_pk_fma_f16 v118, v131, v131, v118
    v_mul_f32 v201, v142, v201
    v_mfma_f32_16x16x32_bf16 v[132:135], a[64:67], v[156:159], v[132:135]
    v_cvt_pk_bf16_f32 v172, v200, v201
    v_mul_f32 v202, v142, v202
    v_mfma_f32_16x16x32_bf16 v[132:135], a[68:71], v[192:195], v[132:135]
    v_mul_f32 v203, v142, v203
    v_cvt_pk_bf16_f32 v173, v202, v203
    v_mfma_f32_16x16x32_bf16 v[176:179], v[180:183], a[144:147], 0
    v_mul_f32 v216, v142, v216
    v_mul_f32 v217, v142, v217
    v_mfma_f32_16x16x32_bf16 v[176:179], v[124:127], a[148:151], v[176:179]
    v_cvt_pk_bf16_f32 v174, v216, v217
    v_mul_f32 v218, v142, v218
    v_mfma_f32_16x16x32_bf16 v[176:179], v[168:171], a[152:155], v[176:179]
    v_cvt_pk_f16_f32 v204, v132, v133
    v_pk_fma_f16 v116, v204, v204, v116
    v_mfma_f32_16x16x32_bf16 v[176:179], v[152:155], a[156:159], v[176:179]
    v_cvt_pk_f16_f32 v205, v134, v135
    v_pk_fma_f16 v118, v205, v205, v118
    v_mfma_f32_16x16x32_bf16 v[176:179], v[156:159], a[160:163], v[176:179]
    ds_read_b128 v[132:135], v0 offset:32768
    v_mul_f32 v219, v142, v219
    v_mfma_f32_16x16x32_f16 v[188:191], v[40:43], v[116:119], 0
    v_cvt_pk_bf16_f32 v175, v218, v219
    v_mul_f32 v208, v142, v208
    v_mfma_f32_16x16x32_bf16 v[176:179], v[192:195], a[164:167], v[176:179]
    ds_read_b128 v[116:119], v1 offset:32768
    v_mul_f32 v209, v142, v209
    v_mfma_f32_16x16x32_bf16 v[196:199], v[180:183], a[168:171], 0
    ds_read_b128 v[200:203], v0 offset:32896
    v_cvt_pk_bf16_f32 v208, v208, v209
    v_mfma_f32_16x16x32_bf16 v[196:199], v[124:127], a[172:175], v[196:199]
    ds_read_b128 v[212:215], v1 offset:32896
    v_min3_u32 v44, v44, v188, v189
    v_mfma_f32_16x16x32_bf16 v[196:199], v[168:171], a[176:179], v[196:199]
    ds_read_b128 v[216:219], v0 offset:33024
    v_cvt_pk_bf16_f32 v186, v176, v177
    v_mfma_f32_16x16x32_bf16 v[196:199], v[152:155], a[180:183], v[196:199]
    ds_read_b128 v[224:227], v1 offset:33024
    v_cvt_pk_bf16_f32 v187, v178, v179
    v_mfma_f32_16x16x32_bf16 v[196:199], v[156:159], a[184:187], v[196:199]
    v_rsq_f32 v190, v188
    v_mfma_f32_16x16x32_bf16 v[196:199], v[192:195], a[188:191], v[196:199]
    s_waitcnt lgkmcnt(5)
    buffer_store_dwordx4 v[160:163], v16, s[12:15], 0 offen nt
    v_rsq_f32 v191, v189
    v_mul_f32 v190, s31, v190
    v_cvt_pk_f16_f32 v190, v190, v191
    v_mfma_f32_16x16x32_bf16 v[160:163], v[180:183], a[192:195], 0
    s_waitcnt lgkmcnt(4)
    v_pk_mul_f16 v164, v164, v190 op_sel:[0,1] op_sel_hi:[1,1]
    v_cvt_pk_bf16_f32 v146, v196, v197
    v_mfma_f32_16x16x32_bf16 v[160:163], v[124:127], a[196:199], v[160:163]
    s_waitcnt lgkmcnt(3)
    v_cvt_pk_bf16_f32 v147, v198, v199
    v_pk_mul_f16 v165, v165, v190 op_sel:[0,1] op_sel_hi:[1,1]
    v_mfma_f32_16x16x32_bf16 v[160:163], v[168:171], a[200:203], v[160:163]
    s_waitcnt lgkmcnt(2)
    v_pk_mul_f16 v166, v166, v190 op_sel:[0,1] op_sel_hi:[1,1]
    v_pk_mul_f16 v167, v167, v190 op_sel:[0,1] op_sel_hi:[1,1]
    v_mfma_f32_16x16x32_bf16 v[160:163], v[152:155], a[204:207], v[160:163]
    s_waitcnt lgkmcnt(1)
    v_pk_mul_f16 v206, v206, v190 op_sel:[0,1] op_sel_hi:[1,1]
    v_pk_mul_f16 v207, v207, v190 op_sel:[0,1] op_sel_hi:[1,1]
    v_mfma_f32_16x16x32_bf16 v[160:163], v[156:159], a[208:211], v[160:163]
    s_waitcnt lgkmcnt(0)
    v_pk_mul_f16 v128, v128, v190 op_sel:[0,0] op_sel_hi:[1,0]
    v_pk_mul_f16 v129, v129, v190 op_sel:[0,0] op_sel_hi:[1,0]
    v_mfma_f32_16x16x32_bf16 v[160:163], v[192:195], a[212:215], v[160:163]
    s_waitcnt vmcnt(3)
    ds_write_b16 v8, v46 offset:512
    v_mfma_f32_16x16x32_bf16 v[124:127], a[72:75], v[132:135], 0
    s_nop 0
    v_pk_mul_f16 v130, v130, v190 op_sel:[0,0] op_sel_hi:[1,0]
    v_mfma_f32_16x16x32_bf16 v[124:127], a[76:79], v[116:119], v[124:127]
    v_pk_mul_f16 v131, v131, v190 op_sel:[0,0] op_sel_hi:[1,0]
    v_pk_mul_f16 v204, v204, v190 op_sel:[0,0] op_sel_hi:[1,0]
    v_mfma_f32_16x16x32_bf16 v[124:127], a[80:83], v[200:203], v[124:127]
    v_cvt_pk_bf16_f32 v138, v160, v161
    v_cvt_pk_bf16_f32 v139, v162, v163
    v_mfma_f32_16x16x32_bf16 v[124:127], a[84:87], v[212:215], v[124:127]
    v_pk_mul_f16 v205, v205, v190 op_sel:[0,0] op_sel_hi:[1,0]
    v_max3_u32 v45, v45, v188, v189
    v_mfma_f32_16x16x32_bf16 v[124:127], a[88:91], v[216:219], v[124:127]
    v_mul_f32 v210, v142, v210
    v_mul_f32 v211, v142, v211
    v_mfma_f32_16x16x32_bf16 v[124:127], a[92:95], v[224:227], v[124:127]
    v_cvt_pk_bf16_f32 v209, v210, v211
    v_xor_b32 v0, 65536, v0
    v_mfma_f32_16x16x32_bf16 v[152:155], a[96:99], v[132:135], 0
    v_xor_b32 v1, 65536, v1
    v_mfma_f32_16x16x32_bf16 v[152:155], a[100:103], v[116:119], v[152:155]
    s_waitcnt lgkmcnt(0)
    v_mfma_f32_16x16x32_bf16 v[152:155], a[104:107], v[200:203], v[152:155]
    s_nop 0
    v_mfma_f32_16x16x32_bf16 v[152:155], a[108:111], v[212:215], v[152:155]
    s_barrier
    v_mfma_f32_16x16x32_bf16 v[152:155], a[112:115], v[216:219], v[152:155]
    s_nop 0
    v_mfma_f32_16x16x32_bf16 v[152:155], a[116:119], v[224:227], v[152:155]
    s_nop 0
    v_mfma_f32_16x16x32_bf16 v[156:159], a[120:123], v[132:135], 0
    buffer_load_dwordx4 v10, s[8:11], 0 offen nt lds
    ds_read_u16 v142, v9 offset:384
    v_mfma_f32_16x16x32_bf16 v[156:159], a[124:127], v[116:119], v[156:159]
    s_add_u32 m0, s28, 4096
    v_cvt_pk_f16_f32 v124, v124, v125
    v_pk_mul_f16 v161, v124, v124
    v_mfma_f32_16x16x32_bf16 v[156:159], a[128:131], v[200:203], v[156:159]
    v_cvt_pk_f16_f32 v125, v126, v127
    v_pk_mul_f16 v163, v125, v125
    v_mfma_f32_16x16x32_bf16 v[156:159], a[132:135], v[212:215], v[156:159]
    v_cvt_pk_f16_f32 v126, v152, v153
    v_pk_fma_f16 v161, v126, v126, v161
    v_mfma_f32_16x16x32_bf16 v[156:159], a[136:139], v[216:219], v[156:159]
    v_cvt_pk_f16_f32 v127, v154, v155
    v_pk_fma_f16 v163, v127, v127, v163
    v_mfma_f32_16x16x32_bf16 v[156:159], a[140:143], v[224:227], v[156:159]
    buffer_load_dwordx4 v11, s[8:11], 0 offen nt lds
    s_add_u32 m0, s28, 8192
    v_mfma_f32_16x16x32_bf16 v[152:155], a[0:3], v[132:135], 0
    v_mfma_f32_16x16x32_bf16 v[152:155], a[4:7], v[116:119], v[152:155]
    v_mfma_f32_16x16x32_bf16 v[152:155], a[8:11], v[200:203], v[152:155]
    s_waitcnt lgkmcnt(0)
    v_readfirstlane_b32 s77, v142
    v_mfma_f32_16x16x32_bf16 v[152:155], a[12:15], v[212:215], v[152:155]
    v_cvt_pk_f16_f32 v170, v156, v157
    v_pk_fma_f16 v161, v170, v170, v161
    v_mfma_f32_16x16x32_bf16 v[152:155], a[16:19], v[216:219], v[152:155]
    buffer_load_dwordx4 v12, s[8:11], 0 offen nt lds
    v_cvt_pk_f16_f32 v171, v158, v159
    v_mfma_f32_16x16x32_bf16 v[152:155], a[20:23], v[224:227], v[152:155]
    s_add_u32 m0, s28, 12288
    v_pk_fma_f16 v163, v171, v171, v163
    s_xor_b32 s28, s28, 65536
    v_mfma_f32_16x16x32_bf16 v[156:159], a[24:27], v[132:135], 0
    v_mfma_f32_16x16x32_bf16 v[156:159], a[28:31], v[116:119], v[156:159]
    v_mfma_f32_16x16x32_bf16 v[156:159], a[32:35], v[200:203], v[156:159]
    v_mfma_f32_16x16x32_bf16 v[156:159], a[36:39], v[212:215], v[156:159]
    buffer_load_dwordx4 v13, s[8:11], 0 offen nt lds
    v_cvt_pk_f16_f32 v152, v152, v153
    v_mfma_f32_16x16x32_bf16 v[156:159], a[40:43], v[216:219], v[156:159]
    s_mov_b32 m0, s29
    v_pk_mul_f16 v160, v152, v152
    v_cvt_pk_f16_f32 v153, v154, v155
    v_mfma_f32_16x16x32_bf16 v[156:159], a[44:47], v[224:227], v[156:159]
    s_xor_b32 s29, s29, s30
    v_pk_mul_f16 v162, v153, v153
    s_add_u32 s19, s19, s20
    v_mfma_f32_16x16x32_bf16 v[176:179], a[48:51], v[132:135], 0
    s_add_u32 s23, s23, s21
    s_cmp_ge_u32 s19, 72
    s_cselect_b32 s34, 72, 0
    v_mfma_f32_16x16x32_bf16 v[176:179], a[52:55], v[116:119], v[176:179]
    s_cselect_b32 s35, s22, 0
    v_cvt_pk_f16_f32 v154, v156, v157
    v_pk_fma_f16 v160, v154, v154, v160
    v_mfma_f32_16x16x32_bf16 v[176:179], a[56:59], v[200:203], v[176:179]
    s_sub_u32 s19, s19, s34
    buffer_load_dwordx4 v14, s[8:11], 0 offen nt lds
    v_cvt_pk_f16_f32 v155, v158, v159
    v_mfma_f32_16x16x32_bf16 v[176:179], a[60:63], v[212:215], v[176:179]
    s_add_u32 s23, s23, s35
    v_pk_fma_f16 v162, v155, v155, v162
    s_cmp_lg_u32 s83, 0
    v_mfma_f32_16x16x32_bf16 v[176:179], a[64:67], v[216:219], v[176:179]
    s_cselect_b32 s77, s80, s77
    ds_read_b128 v[156:159], v5 offset:0
    ds_read_b128 v[180:183], v5 offset:16
    v_mfma_f32_16x16x32_bf16 v[176:179], a[68:71], v[224:227], v[176:179]
    s_mul_i32 s78, s77, 2688
    ds_read_b128 v[188:191], v5 offset:48
    ds_read_b32 v210, v6 offset:192
    v_mfma_f32_16x16x32_bf16 v[192:195], v[132:135], a[144:147], 0
    s_add_u32 s78, s78, s69
    v_add_u32 v5, s74, v5
    s_add_u32 s80, s77, s68
    v_mfma_f32_16x16x32_bf16 v[192:195], v[116:119], a[148:151], v[192:195]
    s_cmp_ge_u32 s80, 72
    buffer_store_dwordx2 v[140:141], v19, s[12:15], 0 offen nt
    v_cvt_pk_f16_f32 v168, v176, v177
    v_pk_fma_f16 v160, v168, v168, v160
    v_mfma_f32_16x16x32_bf16 v[192:195], v[200:203], a[152:155], v[192:195]
    s_cselect_b32 s80, s22, 0
    v_cvt_pk_f16_f32 v169, v178, v179
    v_pk_fma_f16 v162, v169, v169, v162
    v_mfma_f32_16x16x32_bf16 v[192:195], v[212:215], a[156:159], v[192:195]
    s_add_u32 s78, s78, s80
    s_add_u32 s80, s77, 20
    s_add_u32 s34, s18, 3
    v_mfma_f32_16x16x32_f16 v[140:143], v[40:43], v[160:163], 0
    s_cmp_lt_u32 s77, s62
    s_cselect_b32 s79, 1, 0
    s_cselect_b32 s78, s78, 0
    v_mfma_f32_16x16x32_bf16 v[192:195], v[216:219], a[160:163], v[192:195]
    s_waitcnt lgkmcnt(3)
    s_cmp_lt_u32 s34, s17
    s_cselect_b32 s23, s23, s78
    v_mfma_f32_16x16x32_f16 v[160:163], v[156:159], v[220:223], v[22:25]
    s_waitcnt lgkmcnt(1)
    v_rsq_f32 v142, v140
    v_mfma_f32_16x16x32_f16 v[160:163], v[180:183], v[120:123], v[160:163]
    s_cselect_b32 s73, s34, s80
    v_rsq_f32 v143, v141
    v_mfma_f32_16x16x32_f16 v[160:163], v[188:191], v[148:151], v[160:163]
    s_waitcnt lgkmcnt(0)
    v_mul_f32 v142, s31, v142
    v_cvt_pk_f16_f32 v142, v142, v143
    v_mfma_f32_16x16x32_f16 v[228:231], v[156:159], v[128:131], v[24:27]
    s_cselect_b32 s79, 0, s79
    v_pk_mul_f16 v124, v124, v142 op_sel:[0,1] op_sel_hi:[1,1]
    v_pk_mul_f16 v125, v125, v142 op_sel:[0,1] op_sel_hi:[1,1]
    v_mfma_f32_16x16x32_f16 v[228:231], v[180:183], v[164:167], v[228:231]
    s_cselect_b32 s81, 0, 1
    v_mov_b32_dpp v210, v161 quad_perm:[0,1,2,3] row_mask:0x1 bank_mask:0xf
    v_pk_mul_f16 v126, v126, v142 op_sel:[0,1] op_sel_hi:[1,1]
    v_mfma_f32_16x16x32_f16 v[228:231], v[188:191], v[204:207], v[228:231]
    s_add_u32 s80, s77, 1
    v_pk_mul_f16 v127, v127, v142 op_sel:[0,1] op_sel_hi:[1,1]
    v_pk_mul_f16 v170, v170, v142 op_sel:[0,1] op_sel_hi:[1,1]
    v_mfma_f32_16x16x32_bf16 v[192:195], v[224:227], a[164:167], v[192:195]
    s_mul_i32 s80, s80, s81
    v_pk_mul_f16 v171, v171, v142 op_sel:[0,1] op_sel_hi:[1,1]
    v_pk_mul_f16 v152, v152, v142 op_sel:[0,0] op_sel_hi:[1,0]
    v_mfma_f32_16x16x32_bf16 v[176:179], v[132:135], a[168:171], 0
    s_cmp_lt_u32 s80, s62
    v_mov_b32_dpp v210, v229 quad_perm:[0,1,2,3] row_mask:0x2 bank_mask:0xf
    v_pk_mul_f16 v153, v153, v142 op_sel:[0,0] op_sel_hi:[1,0]
    v_mfma_f32_16x16x32_f16 v[196:199], v[120:123], v[220:223], v[48:51]
    s_cselect_b32 s70, s70, 0
    v_cvt_pk_bf16_f32 v192, v192, v193
    v_cvt_pk_bf16_f32 v193, v194, v195
    v_mfma_f32_16x16x32_f16 v[232:235], v[164:167], v[220:223], v[52:55]
    s_cselect_b32 s62, s62, 0
    v_pk_mul_f16 v154, v154, v142 op_sel:[0,0] op_sel_hi:[1,0]
    v_pk_mul_f16 v155, v155, v142 op_sel:[0,0] op_sel_hi:[1,0]
    v_mfma_f32_16x16x32_f16 v[236:239], v[124:127], v[220:223], v[56:59]
    s_add_u32 s80, s18, 4
    v_pk_mul_f16 v168, v168, v142 op_sel:[0,0] op_sel_hi:[1,0]
    v_pk_mul_f16 v169, v169, v142 op_sel:[0,0] op_sel_hi:[1,0]
    v_min3_u32 v44, v44, v140, v141
    v_mfma_f32_16x16x16_f16 v[196:199], v[150:151], v[148:149], v[196:199]
    v_max3_u32 v45, v45, v140, v141
    v_exp_f32 v228, v228
    v_mfma_f32_16x16x16_f16 v[232:235], v[206:207], v[148:149], v[232:235]
    v_exp_f32 v160, v160
    s_cmp_ge_u32 s80, s17
    v_mfma_f32_16x16x16_f16 v[236:239], v[170:171], v[148:149], v[236:239]
    buffer_store_dwordx4 v[172:175], v17, s[12:15], 0 offen nt
    v_cvt_pk_bf16_f32 v39, v160, 0
    v_exp_f32 v196, v196
    s_cselect_b32 s66, s70, 0
    v_mfma_f32_16x16x32_bf16 v[176:179], v[116:119], a[172:175], v[176:179]
    s_lshl_b32 s80, s79, s73
    v_exp_f32 v197, v197
    v_mfma_f32_16x16x32_bf16 v[176:179], v[200:203], a[176:179], v[176:179]
    s_or_b32 s63, s63, s80
    v_exp_f32 v198, v198
    v_mfma_f32_16x16x32_bf16 v[176:179], v[212:215], a[180:183], v[176:179]
    s_sub_u32 s80, s100, s81
    ds_read_b128 v[140:143], v2 offset:0
    v_cvt_pk_bf16_f32 v160, v196, v197
    v_mfma_f32_16x16x32_bf16 v[176:179], v[216:219], a[184:187], v[176:179]
    s_and_b32 s100, s100, s80
    ds_read_b128 v[172:175], v2 offset:1024
    s_add_u32 s45, s45, s79
    v_mfma_f32_16x16x32_bf16 v[176:179], v[224:227], a[188:191], v[176:179]
    s_add_u32 s18, s18, 1
    ds_read_b128 v[220:223], v2 offset:2048
    s_cmp_lt_u32 s18, s45
    v_mfma_f32_16x16x32_bf16 v[240:243], v[132:135], a[192:195], 0
    ds_read_b128 v[132:135], v2 offset:3072
    v_mfma_f32_16x16x32_bf16 v[240:243], v[116:119], a[196:199], v[240:243]
    ds_read_b128 v[116:119], v2 offset:4096
    ds_read2_b32 v[194:195], v6 offset0:0 offset1:0
    v_mfma_f32_16x16x32_bf16 v[240:243], v[200:203], a[200:203], v[240:243]
    ds_read_b128 v[244:247], v2 offset:5120
    ds_read2_b32 v[202:203], v6 offset0:16 offset1:16
    v_mfma_f32_16x16x32_bf16 v[240:243], v[212:215], a[204:207], v[240:243]
    v_cvt_pk_bf16_f32 v200, v176, v177
    v_cvt_pk_bf16_f32 v201, v178, v179
    v_mfma_f32_16x16x32_bf16 v[240:243], v[216:219], a[208:211], v[240:243]
    ds_read2_b32 v[214:215], v6 offset0:32 offset1:32
    v_add_u32 v6, s75, v6
    v_mfma_f32_16x16x32_bf16 v[240:243], v[224:227], a[212:215], v[240:243]
    s_waitcnt lgkmcnt(8)
    v_exp_f32 v199, v199
    v_mfma_f32_16x16x32_f16 v[176:179], v[120:123], v[128:131], v[60:63]
    s_waitcnt lgkmcnt(7)
    v_exp_f32 v232, v232
    v_mfma_f32_16x16x32_f16 v[216:219], v[164:167], v[128:131], v[64:67]
    s_waitcnt lgkmcnt(6)
    v_exp_f32 v233, v233
    v_mfma_f32_16x16x32_f16 v[224:227], v[124:127], v[128:131], v[68:71]
    s_waitcnt lgkmcnt(5)
    v_cvt_pk_bf16_f32 v212, v240, v241
    v_cvt_pk_bf16_f32 v213, v242, v243
    v_cvt_pk_bf16_f32 v161, v198, v199
    v_mfma_f32_16x16x16_f16 v[176:179], v[150:151], v[204:205], v[176:179]
    v_cvt_pk_bf16_f32 v162, v232, v233
    v_exp_f32 v234, v234
    v_mfma_f32_16x16x16_f16 v[216:219], v[206:207], v[204:205], v[216:219]
    v_exp_f32 v235, v235
    v_mfma_f32_16x16x16_f16 v[224:227], v[170:171], v[204:205], v[224:227]
    s_nop 0
    buffer_store_dwordx2 v[208:209], v20, s[12:15], 0 offen nt
    v_exp_f32 v236, v236
    v_mfma_f32_16x16x32_f16 v[240:243], v[156:159], v[152:155], v[26:29]
    s_waitcnt lgkmcnt(0)
    v_exp_f32 v176, v176
    v_mfma_f32_16x16x32_f16 v[240:243], v[180:183], v[124:127], v[240:243]
    v_exp_f32 v177, v177
    v_mfma_f32_16x16x32_f16 v[240:243], v[188:191], v[168:171], v[240:243]
    v_cvt_pk_bf16_f32 v156, v176, v177
    v_cvt_pk_bf16_f32 v163, v234, v235
    v_mfma_f32_16x16x32_bf16 v[128:131], a[216:219], v[140:143], 0
    v_exp_f32 v178, v178
    v_mfma_f32_16x16x32_bf16 v[128:131], a[220:223], v[172:175], v[128:131]
    v_exp_f32 v179, v179
    v_mfma_f32_16x16x32_bf16 v[128:131], a[224:227], v[220:223], v[128:131]
    v_exp_f32 v216, v216
    v_mfma_f32_16x16x32_bf16 v[128:131], a[228:231], v[132:135], v[128:131]
    v_cvt_pk_bf16_f32 v157, v178, v179
    v_mov_b32_dpp v210, v241 quad_perm:[0,1,2,3] row_mask:0x4 bank_mask:0xf
    v_mfma_f32_16x16x32_bf16 v[128:131], a[232:235], v[116:119], v[128:131]
    v_exp_f32 v217, v217
    v_mfma_f32_16x16x32_bf16 v[128:131], a[236:239], v[244:247], v[128:131]
    v_exp_f32 v218, v218
    v_mfma_f32_16x16x32_bf16 v[188:191], a[240:243], v[140:143], 0
    v_exp_f32 v219, v219
    v_mfma_f32_16x16x32_bf16 v[188:191], a[244:247], v[172:175], v[188:191]
    v_cvt_pk_bf16_f32 v158, v216, v217
    v_cvt_pk_bf16_f32 v159, v218, v219
    v_mfma_f32_16x16x32_bf16 v[188:191], a[248:251], v[220:223], v[188:191]
    ds_read_b128 v[180:183], v2 offset:6144
    v_fma_f32 v241, v128, v128, s33
    v_mfma_f32_16x16x32_bf16 v[188:191], a[252:255], v[132:135], v[188:191]
    ds_read_b128 v[216:219], v2 offset:7168
    v_fmac_f32 v241, v129, v129
    v_mfma_f32_16x16x32_bf16 v[188:191], v[84:87], v[116:119], v[188:191]
    ds_read_b128 v[232:235], v2 offset:8192
    v_fmac_f32 v241, v130, v130
    v_mfma_f32_16x16x32_bf16 v[188:191], v[88:91], v[244:247], v[188:191]
    ds_read_b128 v[248:251], v2 offset:9216
    v_fmac_f32 v241, v131, v131
    v_mfma_f32_16x16x32_bf16 v[176:179], v[92:95], v[140:143], 0
    ds_read_b128 v[140:143], v2 offset:10240
    v_mfma_f32_16x16x32_bf16 v[176:179], v[96:99], v[172:175], v[176:179]
    ds_read_b128 v[172:175], v2 offset:11264
    v_mfma_f32_16x16x32_bf16 v[176:179], v[100:103], v[220:223], v[176:179]
    v_exp_f32 v224, v224
    v_mfma_f32_16x16x32_bf16 v[176:179], v[104:107], v[132:135], v[176:179]
    v_exp_f32 v225, v225
    v_mfma_f32_16x16x32_bf16 v[176:179], v[108:111], v[116:119], v[176:179]
    s_waitcnt lgkmcnt(5)
    v_exp_f32 v226, v226
    v_mfma_f32_16x16x32_bf16 v[176:179], v[112:115], v[244:247], v[176:179]
    s_waitcnt lgkmcnt(4)
    v_exp_f32 v227, v227
    v_mfma_f32_16x16x32_f16 v[116:119], v[120:123], v[152:155], v[72:75]
    s_waitcnt lgkmcnt(3)
    v_exp_f32 v210, v210
    v_mfma_f32_16x16x32_f16 v[120:123], v[164:167], v[152:155], v[76:79]
    s_waitcnt lgkmcnt(2)
    v_cvt_pk_bf16_f32 v210, v210, v210
    v_fmac_f32 v241, v188, v188
    v_mfma_f32_16x16x32_f16 v[132:135], v[124:127], v[152:155], v[80:83]
    s_waitcnt lgkmcnt(1)
    ds_write_b16 v8, v210
    v_fmac_f32 v241, v189, v189
    v_mfma_f32_16x16x16_f16 v[116:119], v[150:151], v[168:169], v[116:119]
    v_exp_f32 v237, v237
    v_fmac_f32 v241, v190, v190
    v_mfma_f32_16x16x16_f16 v[120:123], v[206:207], v[168:169], v[120:123]
    v_cvt_pk_bf16_f32 v36, v236, v237
    v_exp_f32 v238, v238
    v_mfma_f32_16x16x16_f16 v[132:135], v[170:171], v[168:169], v[132:135]
    v_exp_f32 v239, v239
    v_exp_f32 v240, v240
    v_mfma_f32_16x16x32_bf16 v[196:199], a[216:219], v[180:183], 0
    s_waitcnt lgkmcnt(1)
    ds_read_b128 v[124:127], v9
    ds_read_b128 v[148:151], v9 offset:64
    v_mfma_f32_16x16x32_bf16 v[196:199], a[220:223], v[216:219], v[196:199]
    v_cvt_pk_bf16_f32 v37, v238, v239
    v_fmac_f32 v241, v191, v191
    v_mfma_f32_16x16x32_bf16 v[196:199], a[224:227], v[232:235], v[196:199]
    v_exp_f32 v116, v116
    v_mfma_f32_16x16x32_bf16 v[152:155], v[28:31], v[36:39], 0
    v_exp_f32 v117, v117
    v_mfma_f32_16x16x32_bf16 v[152:155], v[28:31], v[160:163], v[152:155]
    v_cvt_pk_bf16_f32 v116, v116, v117
    v_fmac_f32 v241, v176, v176
    v_mfma_f32_16x16x32_bf16 v[164:167], v[192:195], v[36:39], 0
    v_exp_f32 v118, v118
    v_mfma_f32_16x16x32_bf16 v[164:167], v[184:187], v[160:163], v[164:167]
    v_exp_f32 v119, v119
    v_mfma_f32_16x16x32_bf16 v[168:171], v[200:203], v[36:39], 0
    v_cvt_pk_bf16_f32 v117, v118, v119
    v_fmac_f32 v241, v177, v177
    v_mfma_f32_16x16x32_bf16 v[168:171], v[144:147], v[160:163], v[168:171]
    s_waitcnt lgkmcnt(0)
    v_exp_f32 v120, v120
    v_mfma_f32_16x16x32_bf16 v[204:207], v[212:215], v[36:39], 0
    v_cvt_pk_bf16_f32 v36, v224, v225
    v_cvt_pk_bf16_f32 v37, v226, v227
    v_mfma_f32_16x16x32_bf16 v[204:207], v[136:139], v[160:163], v[204:207]
    v_cvt_pk_bf16_f32 v39, v228, 0
    v_fmac_f32 v241, v178, v178
    v_mfma_f32_16x16x32_bf16 v[220:223], v[124:127], v[28:31], 0
    v_exp_f32 v121, v121
    v_mfma_f32_16x16x32_bf16 v[160:163], v[28:31], v[36:39], 0
    v_cvt_pk_bf16_f32 v118, v120, v121
    v_fmac_f32 v241, v179, v179
    v_mfma_f32_16x16x32_bf16 v[160:163], v[28:31], v[156:159], v[160:163]
    v_exp_f32 v122, v122
    v_mfma_f32_16x16x32_bf16 v[208:211], v[192:195], v[36:39], 0
    v_exp_f32 v123, v123
    v_mfma_f32_16x16x32_bf16 v[208:211], v[184:187], v[156:159], v[208:211]
    v_exp_f32 v132, v132
    v_mfma_f32_16x16x32_bf16 v[224:227], v[200:203], v[36:39], 0
    v_exp_f32 v133, v133
    v_mfma_f32_16x16x32_bf16 v[224:227], v[144:147], v[156:159], v[224:227]
    v_exp_f32 v134, v134
    v_mfma_f32_16x16x32_bf16 v[228:231], v[212:215], v[36:39], 0
    v_cvt_pk_bf16_f32 v119, v122, v123
    v_cvt_pk_bf16_f32 v36, v132, v133
    v_mfma_f32_16x16x32_bf16 v[228:231], v[136:139], v[156:159], v[228:231]
    v_exp_f32 v135, v135
    v_mfma_f32_16x16x32_bf16 v[220:223], v[148:151], v[28:31], v[220:223]
    v_cvt_pk_bf16_f32 v37, v134, v135
    v_cvt_pk_bf16_f32 v39, v240, 0
    v_mfma_f32_16x16x32_bf16 v[120:123], v[124:127], v[184:187], 0
    v_rcp_f32 v160, v160
    v_mfma_f32_16x16x32_bf16 v[156:159], v[28:31], v[36:39], 0
    v_mul_f32 v208, v160, v208
    v_mul_f32 v209, v160, v209
    v_mfma_f32_16x16x32_bf16 v[156:159], v[28:31], v[116:119], v[156:159]
    v_cvt_pk_bf16_f32 v132, v208, v209
    v_mul_f32 v210, v160, v210
    v_mfma_f32_16x16x32_bf16 v[236:239], v[192:195], v[36:39], 0
    v_mul_f32 v211, v160, v211
    v_cvt_pk_bf16_f32 v133, v210, v211
    v_mfma_f32_16x16x32_bf16 v[236:239], v[184:187], v[116:119], v[236:239]
    ds_write_b64 v3, v[132:133] offset:6144
    v_mfma_f32_16x16x32_bf16 v[184:187], v[200:203], v[36:39], 0
    v_mul_f32 v224, v160, v224
    v_mul_f32 v225, v160, v225
    v_mfma_f32_16x16x32_bf16 v[184:187], v[144:147], v[116:119], v[184:187]
    v_cvt_pk_bf16_f32 v134, v224, v225
    v_mul_f32 v226, v160, v226
    v_mfma_f32_16x16x32_bf16 v[244:247], v[212:215], v[36:39], 0
    v_mul_f32 v227, v160, v227
    v_cvt_pk_bf16_f32 v135, v226, v227
    v_mfma_f32_16x16x32_bf16 v[244:247], v[136:139], v[116:119], v[244:247]
    ds_write_b64 v3, v[134:135] offset:6152
    v_mfma_f32_16x16x32_bf16 v[120:123], v[148:151], v[192:195], v[120:123]
    v_mul_f32 v228, v160, v228
    v_mul_f32 v229, v160, v229
    v_mfma_f32_16x16x32_bf16 v[192:195], v[124:127], v[144:147], 0
    v_cvt_pk_bf16_f32 v228, v228, v229
    v_mul_f32 v230, v160, v230
    v_mfma_f32_16x16x32_bf16 v[192:195], v[148:151], v[200:203], v[192:195]
    v_mul_f32 v231, v160, v231
    v_cvt_pk_bf16_f32 v229, v230, v231
    v_mfma_f32_16x16x32_bf16 v[144:147], v[124:127], v[136:139], 0
    ds_write_b64 v4, v[228:229] offset:10240
    v_mfma_f32_16x16x32_bf16 v[144:147], v[148:151], v[212:215], v[144:147]
    v_rcp_f32 v152, v152
    v_mfma_f32_16x16x32_bf16 v[196:199], a[228:231], v[248:251], v[196:199]
    v_mul_f32 v164, v152, v164
    v_mul_f32 v165, v152, v165
    v_mfma_f32_16x16x32_bf16 v[196:199], a[232:235], v[140:143], v[196:199]
    v_cvt_pk_bf16_f32 v116, v164, v165
    v_mul_f32 v166, v152, v166
    v_mfma_f32_16x16x32_bf16 v[196:199], a[236:239], v[172:175], v[196:199]
    v_mul_f32 v167, v152, v167
    v_cvt_pk_bf16_f32 v117, v166, v167
    v_mfma_f32_16x16x32_bf16 v[132:135], a[240:243], v[180:183], 0
    ds_write_b64 v3, v[116:117] offset:0
    v_mfma_f32_16x16x32_bf16 v[132:135], a[244:247], v[216:219], v[132:135]
    v_mul_f32 v168, v152, v168
    v_mul_f32 v169, v152, v169
    v_mfma_f32_16x16x32_bf16 v[132:135], a[248:251], v[232:235], v[132:135]
    ds_read_b128 v[124:127], v2 offset:12288
    v_fma_f32 v121, v196, v196, s33
    v_mfma_f32_16x16x32_bf16 v[132:135], a[252:255], v[248:251], v[132:135]
    ds_read_b128 v[148:151], v2 offset:13312
    v_fmac_f32 v121, v197, v197
    v_mfma_f32_16x16x32_bf16 v[132:135], v[84:87], v[140:143], v[132:135]
    ds_read_b128 v[164:167], v2 offset:14336
    v_fmac_f32 v121, v198, v198
    v_mfma_f32_16x16x32_bf16 v[132:135], v[88:91], v[172:175], v[132:135]
    ds_read_b128 v[224:227], v2 offset:15360
    v_fmac_f32 v121, v199, v199
    v_mfma_f32_16x16x32_bf16 v[212:215], v[92:95], v[180:183], 0
    ds_read_b128 v[180:183], v2 offset:16384
    v_cvt_pk_bf16_f32 v118, v168, v169
    v_mfma_f32_16x16x32_bf16 v[212:215], v[96:99], v[216:219], v[212:215]
    ds_read_b128 v[228:231], v2 offset:17408
    v_mul_f32 v170, v152, v170
    v_mfma_f32_16x16x32_bf16 v[212:215], v[100:103], v[232:235], v[212:215]
    v_fmac_f32 v121, v132, v132
    v_fmac_f32 v121, v133, v133
    v_mfma_f32_16x16x32_bf16 v[212:215], v[104:107], v[248:251], v[212:215]
    v_fmac_f32 v121, v134, v134
    v_fmac_f32 v121, v135, v135
    v_mfma_f32_16x16x32_bf16 v[212:215], v[108:111], v[140:143], v[212:215]
    s_waitcnt lgkmcnt(5)
    v_mul_f32 v171, v152, v171
    v_cvt_pk_bf16_f32 v119, v170, v171
    v_mfma_f32_16x16x32_bf16 v[212:215], v[112:115], v[172:175], v[212:215]
    s_waitcnt lgkmcnt(4)
    ds_write_b64 v3, v[118:119] offset:8
    v_mfma_f32_16x16x32_bf16 v[200:203], a[216:219], v[124:127], 0
    s_waitcnt lgkmcnt(3)
    v_mul_f32 v204, v152, v204
    v_mul_f32 v205, v152, v205
    v_mfma_f32_16x16x32_bf16 v[200:203], a[220:223], v[148:151], v[200:203]
    s_waitcnt lgkmcnt(2)
    ds_read_b128 v[232:235], v0 offset:20480
    v_fmac_f32 v121, v212, v212
    v_mfma_f32_16x16x32_bf16 v[200:203], a[224:227], v[164:167], v[200:203]
    s_waitcnt lgkmcnt(2)
    ds_read_b128 v[248:251], v1 offset:20480
    v_fmac_f32 v121, v213, v213
    v_mfma_f32_16x16x32_bf16 v[200:203], a[228:231], v[224:227], v[200:203]
    ds_read_b128 v[160:163], v0 offset:20608
    v_fmac_f32 v121, v214, v214
    v_mfma_f32_16x16x32_bf16 v[200:203], a[232:235], v[180:183], v[200:203]
    ds_read_b128 v[136:139], v1 offset:20608
    v_fmac_f32 v121, v215, v215
    v_mfma_f32_16x16x32_bf16 v[200:203], a[236:239], v[228:231], v[200:203]
    ds_read_b128 v[116:119], v0 offset:20736
    v_cvt_pk_bf16_f32 v158, v241, v121
    v_mfma_f32_16x16x32_bf16 v[216:219], a[240:243], v[124:127], 0
    ds_read_b128 v[172:175], v1 offset:20736
    v_cvt_pk_bf16_f32 v204, v204, v205
    v_mfma_f32_16x16x32_bf16 v[216:219], a[244:247], v[148:151], v[216:219]
    v_mul_f32 v206, v152, v206
    v_mul_f32 v207, v152, v207
    v_mfma_f32_16x16x32_bf16 v[216:219], a[248:251], v[164:167], v[216:219]
    v_fma_f32 v157, v200, v200, s33
    v_fmac_f32 v157, v201, v201
    v_mfma_f32_16x16x32_bf16 v[216:219], a[252:255], v[224:227], v[216:219]
    s_waitcnt lgkmcnt(5)
    v_fmac_f32 v157, v202, v202
    v_fmac_f32 v157, v203, v203
    v_mfma_f32_16x16x32_bf16 v[216:219], v[84:87], v[180:183], v[216:219]
    s_waitcnt lgkmcnt(4)
    v_cvt_pk_bf16_f32 v205, v206, v207
    v_xor_b32 v2, 65536, v2
    v_mfma_f32_16x16x32_bf16 v[216:219], v[88:91], v[228:231], v[216:219]
    s_waitcnt lgkmcnt(3)
    ds_write_b64 v4, v[204:205] offset:4096
    v_mfma_f32_16x16x32_bf16 v[208:211], v[92:95], v[124:127], 0
    s_waitcnt lgkmcnt(2)
    v_rcp_f32 v220, v220
    v_mfma_f32_16x16x32_bf16 v[208:211], v[96:99], v[148:151], v[208:211]
    s_waitcnt lgkmcnt(1)
    v_rcp_f32 v156, v156
    v_mfma_f32_16x16x32_bf16 v[208:211], v[100:103], v[164:167], v[208:211]
    v_fmac_f32 v157, v216, v216
    v_fmac_f32 v157, v217, v217
    v_mfma_f32_16x16x32_bf16 v[208:211], v[104:107], v[224:227], v[208:211]
    v_fmac_f32 v157, v218, v218
    v_fmac_f32 v157, v219, v219
    v_mfma_f32_16x16x32_bf16 v[208:211], v[108:111], v[180:183], v[208:211]
    v_mul_f32 v120, v120, v220
    v_mul_f32_dpp v120, v192, v220 quad_perm:[0,1,2,3] row_mask:0x2 bank_mask:0xf
    v_mfma_f32_16x16x32_bf16 v[208:211], v[112:115], v[228:231], v[208:211]
    v_mul_f32_dpp v120, v144, v220 quad_perm:[0,1,2,3] row_mask:0x4 bank_mask:0xf
    v_cvt_pk_bf16_f32 v120, v120, v120
    v_mfma_f32_16x16x32_bf16 v[124:127], a[72:75], v[232:235], 0
    ds_write_b16 v7, v120
    v_mfma_f32_16x16x32_bf16 v[124:127], a[76:79], v[248:251], v[124:127]
    v_mul_f32 v236, v156, v236
    v_mul_f32 v237, v156, v237
    v_mfma_f32_16x16x32_bf16 v[124:127], a[80:83], v[160:163], v[124:127]
    v_fmac_f32 v157, v208, v208
    v_fmac_f32 v157, v209, v209
    v_mfma_f32_16x16x32_bf16 v[124:127], a[84:87], v[136:139], v[124:127]
    v_fmac_f32 v157, v210, v210
    v_fmac_f32 v157, v211, v211
    v_mfma_f32_16x16x32_bf16 v[124:127], a[88:91], v[116:119], v[124:127]
    v_cvt_pk_bf16_f32 v159, v157, v157
    v_cvt_pk_bf16_f32 v120, v236, v237
    v_mfma_f32_16x16x32_bf16 v[124:127], a[92:95], v[172:175], v[124:127]
    ds_write_b64 v4, v[158:159] offset:18432
    v_mfma_f32_16x16x32_bf16 v[140:143], a[96:99], v[232:235], 0
    v_mul_f32 v238, v156, v238
    v_mul_f32 v239, v156, v239
    v_mfma_f32_16x16x32_bf16 v[140:143], a[100:103], v[248:251], v[140:143]
    v_cvt_pk_bf16_f32 v121, v238, v239
    v_mul_f32 v184, v156, v184
    v_mfma_f32_16x16x32_bf16 v[140:143], a[104:107], v[160:163], v[140:143]
    ds_write_b64 v3, v[120:121] offset:12288
    v_mfma_f32_16x16x32_bf16 v[140:143], a[108:111], v[136:139], v[140:143]
    v_mul_f32 v185, v156, v185
    v_cvt_pk_bf16_f32 v122, v184, v185
    v_mfma_f32_16x16x32_bf16 v[140:143], a[112:115], v[116:119], v[140:143]
    v_mul_f32 v186, v156, v186
    v_mul_f32 v187, v156, v187
    v_mfma_f32_16x16x32_bf16 v[140:143], a[116:119], v[172:175], v[140:143]
    v_cvt_pk_bf16_f32 v123, v186, v187
    v_mul_f32 v244, v156, v244
    v_mfma_f32_16x16x32_bf16 v[144:147], a[120:123], v[232:235], 0
    ds_write_b64 v3, v[122:123] offset:12296
    v_mfma_f32_16x16x32_bf16 v[144:147], a[124:127], v[248:251], v[144:147]
    v_mul_f32 v245, v156, v245
    v_cvt_pk_bf16_f32 v244, v244, v245
    v_mfma_f32_16x16x32_bf16 v[144:147], a[128:131], v[160:163], v[144:147]
    v_mul_f32 v246, v156, v246
    v_mul_f32 v247, v156, v247
    v_mfma_f32_16x16x32_bf16 v[144:147], a[132:135], v[136:139], v[144:147]
    v_cvt_pk_bf16_f32 v245, v246, v247
    v_add_u32 v7, s76, v7
    v_mfma_f32_16x16x32_bf16 v[144:147], a[136:139], v[116:119], v[144:147]
    ds_write_b64 v4, v[244:245] offset:16384
    v_mfma_f32_16x16x32_bf16 v[144:147], a[140:143], v[172:175], v[144:147]
    v_cvt_pk_f16_f32 v120, v124, v125
    v_pk_mul_f16 v125, v120, v120
    v_mfma_f32_16x16x32_bf16 v[152:155], a[0:3], v[232:235], 0
    v_cvt_pk_f16_f32 v121, v126, v127
    v_pk_mul_f16 v127, v121, v121
    v_mfma_f32_16x16x32_bf16 v[152:155], a[4:7], v[248:251], v[152:155]
    v_cvt_pk_f16_f32 v122, v140, v141
    v_pk_fma_f16 v125, v122, v122, v125
    v_mfma_f32_16x16x32_bf16 v[152:155], a[8:11], v[160:163], v[152:155]
    v_xor_b32 v3, 65536, v3
    v_xor_b32 v4, 65536, v4
    v_mfma_f32_16x16x32_bf16 v[152:155], a[12:15], v[136:139], v[152:155]
    v_mfma_f32_16x16x32_bf16 v[152:155], a[16:19], v[116:119], v[152:155]
    v_mfma_f32_16x16x32_bf16 v[152:155], a[20:23], v[172:175], v[152:155]
    s_waitcnt lgkmcnt(0)
    v_mfma_f32_16x16x32_bf16 v[156:159], a[24:27], v[232:235], 0
    s_nop 0
    v_mfma_f32_16x16x32_bf16 v[156:159], a[28:31], v[248:251], v[156:159]
    s_barrier
    v_mfma_f32_16x16x32_bf16 v[156:159], a[32:35], v[160:163], v[156:159]
    s_nop 0
    v_mfma_f32_16x16x32_bf16 v[156:159], a[36:39], v[136:139], v[156:159]
    s_nop 0
    v_mfma_f32_16x16x32_bf16 v[156:159], a[40:43], v[116:119], v[156:159]
    v_mfma_f32_16x16x32_bf16 v[156:159], a[44:47], v[172:175], v[156:159]
    s_cbranch_scc1 L_loop_fast1
    s_branch L_final_fast
.p2align 6
L_loop_fast2:
    v_mfma_f32_16x16x32_bf16 v[164:167], a[48:51], v[232:235], 0
    s_add_u32 s12, s40, s27
    ds_read_b128 v[168:171], v2 offset:18432
    ds_read_b128 v[180:183], v2 offset:19456
    v_mfma_f32_16x16x32_bf16 v[164:167], a[52:55], v[248:251], v[164:167]
    s_addc_u32 s13, s41, 0
    v_cvt_pk_f16_f32 v123, v142, v143
    v_pk_fma_f16 v127, v123, v123, v127
    v_mfma_f32_16x16x32_bf16 v[164:167], a[56:59], v[160:163], v[164:167]
    s_sub_u32 s14, s36, s27
    v_cvt_pk_f16_f32 v150, v144, v145
    v_pk_fma_f16 v125, v150, v150, v125
    v_mfma_f32_16x16x32_bf16 v[164:167], a[60:63], v[136:139], v[164:167]
    s_cmp_ge_u32 s18, 2
    v_cvt_pk_f16_f32 v151, v146, v147
    v_pk_fma_f16 v127, v151, v151, v127
    v_mfma_f32_16x16x32_bf16 v[164:167], a[64:67], v[116:119], v[164:167]
    s_cselect_b32 s14, s14, 0
    v_cvt_pk_f16_f32 v220, v152, v153
    v_pk_mul_f16 v124, v220, v220
    v_mfma_f32_16x16x32_bf16 v[164:167], a[68:71], v[172:175], v[164:167]
    s_sub_u32 s82, s72, s71
    v_cvt_pk_f16_f32 v221, v154, v155
    v_pk_mul_f16 v126, v221, v221
    v_mfma_f32_16x16x32_bf16 v[184:187], v[232:235], a[144:147], 0
    s_mul_i32 s74, s82, 336
    v_cvt_pk_f16_f32 v222, v156, v157
    v_pk_fma_f16 v124, v222, v222, v124
    v_mfma_f32_16x16x32_bf16 v[184:187], v[248:251], a[148:151], v[184:187]
    s_mul_i32 s75, s82, 272
    v_cvt_pk_f16_f32 v223, v158, v159
    v_pk_fma_f16 v126, v223, v223, v126
    v_mfma_f32_16x16x32_bf16 v[184:187], v[160:163], a[152:155], v[184:187]
    s_waitcnt lgkmcnt(0)
    v_cvt_pk_f16_f32 v148, v164, v165
    v_pk_fma_f16 v124, v148, v148, v124
    v_mfma_f32_16x16x32_bf16 v[140:143], v[32:35], v[168:171], 0
    s_mul_i32 s76, s82, 16
    v_cvt_pk_f16_f32 v149, v166, v167
    v_pk_fma_f16 v126, v149, v149, v126
    v_mfma_f32_16x16x32_bf16 v[140:143], v[32:35], v[180:183], v[140:143]
    s_add_u32 s34, s18, 2
    s_add_u32 s8, s60, s23
    s_addc_u32 s9, s61, 0
    v_mfma_f32_16x16x32_f16 v[144:147], v[40:43], v[124:127], 0
    s_sub_u32 s10, s36, s23
    s_cmp_le_u32 s34, s45
    s_cselect_b32 s10, s10, 0
    v_mfma_f32_16x16x32_bf16 v[184:187], v[136:139], a[156:159], v[184:187]
    s_add_u32 m0, s28, 0
    v_mul_f32 v140, 0x3baaaaab, v140
    v_mul_f32 v141, 0x3baaaaab, v141
    v_mfma_f32_16x16x32_bf16 v[184:187], v[116:119], a[160:163], v[184:187]
    s_mov_b32 s27, s26
    ds_read_b128 v[180:183], v0 offset:26624
    v_min3_u32 v44, v44, v144, v145
    v_mfma_f32_16x16x32_bf16 v[184:187], v[172:175], a[164:167], v[184:187]
    s_mov_b32 s26, s25
    ds_read_b128 v[124:127], v1 offset:26624
    v_max3_u32 v45, v45, v144, v145
    v_mfma_f32_16x16x32_bf16 v[164:167], v[232:235], a[168:171], 0
    s_mov_b32 s25, s24
    ds_read_b128 v[168:171], v0 offset:26752
    v_mul_f32 v142, 0x3baaaaab, v142
    v_mfma_f32_16x16x32_bf16 v[164:167], v[248:251], a[172:175], v[164:167]
    s_mov_b32 s24, s23
    ds_read_b128 v[152:155], v1 offset:26752
    v_cvt_pk_bf16_f32 v184, v184, v185
    v_mfma_f32_16x16x32_bf16 v[164:167], v[160:163], a[176:179], v[164:167]
    s_ff1_i32_b32 s80, s100
    ds_read_b128 v[156:159], v0 offset:26880
    v_cvt_pk_bf16_f32 v185, v186, v187
    v_mfma_f32_16x16x32_bf16 v[164:167], v[136:139], a[180:183], v[164:167]
    s_mov_b32 s71, s72
    ds_read_b128 v[192:195], v1 offset:26880
    s_mov_b32 s72, s73
    v_mfma_f32_16x16x32_bf16 v[164:167], v[116:119], a[184:187], v[164:167]
    v_rsq_f32 v146, v144
    v_mfma_f32_16x16x32_bf16 v[164:167], v[172:175], a[188:191], v[164:167]
    v_rsq_f32 v147, v145
    v_mfma_f32_16x16x32_bf16 v[204:207], v[232:235], a[192:195], 0
    s_waitcnt lgkmcnt(5)
    v_rsq_f32 v140, v140
    v_mfma_f32_16x16x32_bf16 v[204:207], v[248:251], a[196:199], v[204:207]
    s_waitcnt lgkmcnt(4)
    v_mul_f32 v146, s31, v146
    v_cvt_pk_f16_f32 v146, v146, v147
    v_mfma_f32_16x16x32_bf16 v[204:207], v[160:163], a[200:203], v[204:207]
    s_waitcnt lgkmcnt(3)
    v_cvt_pk_bf16_f32 v144, v164, v165
    v_cvt_pk_bf16_f32 v145, v166, v167
    v_mfma_f32_16x16x32_bf16 v[204:207], v[136:139], a[204:207], v[204:207]
    s_waitcnt lgkmcnt(2)
    v_pk_mul_f16 v120, v120, v146 op_sel:[0,1] op_sel_hi:[1,1]
    v_pk_mul_f16 v121, v121, v146 op_sel:[0,1] op_sel_hi:[1,1]
    v_mfma_f32_16x16x32_bf16 v[204:207], v[116:119], a[208:211], v[204:207]
    s_waitcnt lgkmcnt(1)
    v_pk_mul_f16 v122, v122, v146 op_sel:[0,1] op_sel_hi:[1,1]
    v_pk_mul_f16 v123, v123, v146 op_sel:[0,1] op_sel_hi:[1,1]
    v_mfma_f32_16x16x32_bf16 v[204:207], v[172:175], a[212:215], v[204:207]
    s_waitcnt lgkmcnt(0)
    v_pk_mul_f16 v150, v150, v146 op_sel:[0,1] op_sel_hi:[1,1]
    v_pk_mul_f16 v151, v151, v146 op_sel:[0,1] op_sel_hi:[1,1]
    v_mfma_f32_16x16x32_bf16 v[116:119], a[72:75], v[180:183], 0
    v_pk_mul_f16 v220, v220, v146 op_sel:[0,0] op_sel_hi:[1,0]
    v_pk_mul_f16 v221, v221, v146 op_sel:[0,0] op_sel_hi:[1,0]
    v_mfma_f32_16x16x32_bf16 v[116:119], a[76:79], v[124:127], v[116:119]
    v_pk_mul_f16 v222, v222, v146 op_sel:[0,0] op_sel_hi:[1,0]
    v_cvt_pk_bf16_f32 v136, v204, v205
    v_mfma_f32_16x16x32_bf16 v[116:119], a[80:83], v[168:171], v[116:119]
    v_cvt_pk_bf16_f32 v137, v206, v207
    v_pk_mul_f16 v223, v223, v146 op_sel:[0,0] op_sel_hi:[1,0]
    v_mfma_f32_16x16x32_bf16 v[116:119], a[84:87], v[152:155], v[116:119]
    v_pk_mul_f16 v148, v148, v146 op_sel:[0,0] op_sel_hi:[1,0]
    v_pk_mul_f16 v149, v149, v146 op_sel:[0,0] op_sel_hi:[1,0]
    v_mfma_f32_16x16x32_bf16 v[116:119], a[88:91], v[156:159], v[116:119]
    v_rsq_f32 v141, v141
    v_mfma_f32_16x16x32_bf16 v[116:119], a[92:95], v[192:195], v[116:119]
    v_rsq_f32 v142, v142
    v_mfma_f32_16x16x32_bf16 v[160:163], a[96:99], v[180:183], 0
    v_mul_f32 v128, v140, v128
    v_mul_f32 v129, v140, v129
    v_mfma_f32_16x16x32_bf16 v[160:163], a[100:103], v[124:127], v[160:163]
    v_cvt_pk_bf16_f32 v128, v128, v129
    v_mul_f32 v130, v140, v130
    v_mfma_f32_16x16x32_bf16 v[160:163], a[104:107], v[168:171], v[160:163]
    v_cvt_pk_f16_f32 v164, v116, v117
    v_pk_mul_f16 v117, v164, v164
    v_mfma_f32_16x16x32_bf16 v[160:163], a[108:111], v[152:155], v[160:163]
    v_cvt_pk_f16_f32 v165, v118, v119
    v_pk_mul_f16 v119, v165, v165
    v_mfma_f32_16x16x32_bf16 v[160:163], a[112:115], v[156:159], v[160:163]
    v_mul_f32 v131, v140, v131
    v_cvt_pk_bf16_f32 v129, v130, v131
    v_mfma_f32_16x16x32_bf16 v[160:163], a[116:119], v[192:195], v[160:163]
    v_mul_f32 v188, v140, v188
    v_mul_f32 v189, v140, v189
    v_mfma_f32_16x16x32_bf16 v[172:175], a[120:123], v[180:183], 0
    v_cvt_pk_bf16_f32 v130, v188, v189
    v_mul_f32 v190, v140, v190
    v_mfma_f32_16x16x32_bf16 v[172:175], a[124:127], v[124:127], v[172:175]
    v_mul_f32 v191, v140, v191
    v_cvt_pk_bf16_f32 v131, v190, v191
    v_mfma_f32_16x16x32_bf16 v[172:175], a[128:131], v[168:171], v[172:175]
    buffer_store_dwordx4 v[128:131], v15, s[12:15], 0 offen nt
    v_cvt_pk_f16_f32 v166, v160, v161
    v_pk_fma_f16 v117, v166, v166, v117
    v_cvt_pk_f16_f32 v167, v162, v163
    v_pk_fma_f16 v119, v167, v167, v119
    v_mfma_f32_16x16x32_bf16 v[172:175], a[132:135], v[152:155], v[172:175]
    v_mul_f32 v176, v140, v176
    v_mul_f32 v177, v140, v177
    v_mfma_f32_16x16x32_bf16 v[172:175], a[136:139], v[156:159], v[172:175]
    v_cvt_pk_bf16_f32 v138, v176, v177
    v_mul_f32 v178, v140, v178
    v_mfma_f32_16x16x32_bf16 v[172:175], a[140:143], v[192:195], v[172:175]
    v_mul_f32 v179, v140, v179
    v_cvt_pk_bf16_f32 v139, v178, v179
    v_mfma_f32_16x16x32_bf16 v[128:131], a[0:3], v[180:183], 0
    v_mul_f32 v196, v141, v196
    v_mul_f32 v197, v141, v197
    v_mfma_f32_16x16x32_bf16 v[128:131], a[4:7], v[124:127], v[128:131]
    v_cvt_pk_bf16_f32 v160, v196, v197
    v_mul_f32 v198, v141, v198
    v_mfma_f32_16x16x32_bf16 v[128:131], a[8:11], v[168:171], v[128:131]
    v_cvt_pk_f16_f32 v206, v172, v173
    v_pk_fma_f16 v117, v206, v206, v117
    v_mfma_f32_16x16x32_bf16 v[128:131], a[12:15], v[152:155], v[128:131]
    v_cvt_pk_f16_f32 v207, v174, v175
    v_pk_fma_f16 v119, v207, v207, v119
    v_mfma_f32_16x16x32_bf16 v[128:131], a[16:19], v[156:159], v[128:131]
    v_mul_f32 v199, v141, v199
    v_cvt_pk_bf16_f32 v161, v198, v199
    v_mfma_f32_16x16x32_bf16 v[128:131], a[20:23], v[192:195], v[128:131]
    v_mul_f32 v132, v141, v132
    v_mul_f32 v133, v141, v133
    v_mfma_f32_16x16x32_bf16 v[172:175], a[24:27], v[180:183], 0
    v_cvt_pk_bf16_f32 v162, v132, v133
    v_mul_f32 v134, v141, v134
    v_mfma_f32_16x16x32_bf16 v[172:175], a[28:31], v[124:127], v[172:175]
    v_mul_f32 v135, v141, v135
    v_cvt_pk_bf16_f32 v163, v134, v135
    v_mfma_f32_16x16x32_bf16 v[172:175], a[32:35], v[168:171], v[172:175]
    v_cvt_pk_f16_f32 v128, v128, v129
    v_pk_mul_f16 v116, v128, v128
    v_mfma_f32_16x16x32_bf16 v[172:175], a[36:39], v[152:155], v[172:175]
    v_cvt_pk_f16_f32 v129, v130, v131
    v_pk_mul_f16 v118, v129, v129
    v_mfma_f32_16x16x32_bf16 v[172:175], a[40:43], v[156:159], v[172:175]
    v_mul_f32 v212, v141, v212
    v_mul_f32 v213, v141, v213
    v_mfma_f32_16x16x32_bf16 v[172:175], a[44:47], v[192:195], v[172:175]
    v_cvt_pk_bf16_f32 v140, v212, v213
    v_mul_f32 v214, v141, v214
    v_mfma_f32_16x16x32_bf16 v[132:135], a[48:51], v[180:183], 0
    v_mul_f32 v215, v141, v215
    v_cvt_pk_bf16_f32 v141, v214, v215
    v_mfma_f32_16x16x32_bf16 v[132:135], a[52:55], v[124:127], v[132:135]
    buffer_store_dwordx2 v[138:139], v18, s[12:15], 0 offen nt
    v_mul_f32 v200, v142, v200
    v_cvt_pk_f16_f32 v130, v172, v173
    v_mfma_f32_16x16x32_bf16 v[132:135], a[56:59], v[168:171], v[132:135]
    v_pk_fma_f16 v116, v130, v130, v116
    v_cvt_pk_f16_f32 v131, v174, v175
    v_mfma_f32_16x16x32_bf16 v[132:135], a[60:63], v[152:155], v[132:135]
    v_pk_fma_f16 v118, v131, v131, v118
    v_mul_f32 v201, v142, v201
    v_mfma_f32_16x16x32_bf16 v[132:135], a[64:67], v[156:159], v[132:135]
    v_cvt_pk_bf16_f32 v172, v200, v201
    v_mul_f32 v202, v142, v202
    v_mfma_f32_16x16x32_bf16 v[132:135], a[68:71], v[192:195], v[132:135]
    v_mul_f32 v203, v142, v203
    v_cvt_pk_bf16_f32 v173, v202, v203
    v_mfma_f32_16x16x32_bf16 v[176:179], v[180:183], a[144:147], 0
    v_mul_f32 v216, v142, v216
    v_mul_f32 v217, v142, v217
    v_mfma_f32_16x16x32_bf16 v[176:179], v[124:127], a[148:151], v[176:179]
    v_cvt_pk_bf16_f32 v174, v216, v217
    v_mul_f32 v218, v142, v218
    v_mfma_f32_16x16x32_bf16 v[176:179], v[168:171], a[152:155], v[176:179]
    v_cvt_pk_f16_f32 v204, v132, v133
    v_pk_fma_f16 v116, v204, v204, v116
    v_mfma_f32_16x16x32_bf16 v[176:179], v[152:155], a[156:159], v[176:179]
    v_cvt_pk_f16_f32 v205, v134, v135
    v_pk_fma_f16 v118, v205, v205, v118
    v_mfma_f32_16x16x32_bf16 v[176:179], v[156:159], a[160:163], v[176:179]
    ds_read_b128 v[132:135], v0 offset:32768
    v_mul_f32 v219, v142, v219
    v_mfma_f32_16x16x32_f16 v[188:191], v[40:43], v[116:119], 0
    v_cvt_pk_bf16_f32 v175, v218, v219
    v_mul_f32 v208, v142, v208
    v_mfma_f32_16x16x32_bf16 v[176:179], v[192:195], a[164:167], v[176:179]
    ds_read_b128 v[116:119], v1 offset:32768
    v_mul_f32 v209, v142, v209
    v_mfma_f32_16x16x32_bf16 v[196:199], v[180:183], a[168:171], 0
    ds_read_b128 v[200:203], v0 offset:32896
    v_cvt_pk_bf16_f32 v208, v208, v209
    v_mfma_f32_16x16x32_bf16 v[196:199], v[124:127], a[172:175], v[196:199]
    ds_read_b128 v[212:215], v1 offset:32896
    v_min3_u32 v44, v44, v188, v189
    v_mfma_f32_16x16x32_bf16 v[196:199], v[168:171], a[176:179], v[196:199]
    ds_read_b128 v[216:219], v0 offset:33024
    v_cvt_pk_bf16_f32 v186, v176, v177
    v_mfma_f32_16x16x32_bf16 v[196:199], v[152:155], a[180:183], v[196:199]
    ds_read_b128 v[224:227], v1 offset:33024
    v_cvt_pk_bf16_f32 v187, v178, v179
    v_mfma_f32_16x16x32_bf16 v[196:199], v[156:159], a[184:187], v[196:199]
    v_rsq_f32 v190, v188
    v_mfma_f32_16x16x32_bf16 v[196:199], v[192:195], a[188:191], v[196:199]
    s_waitcnt lgkmcnt(5)
    buffer_store_dwordx4 v[160:163], v16, s[12:15], 0 offen nt
    v_rsq_f32 v191, v189
    v_mul_f32 v190, s31, v190
    v_cvt_pk_f16_f32 v190, v190, v191
    v_mfma_f32_16x16x32_bf16 v[160:163], v[180:183], a[192:195], 0
    s_waitcnt lgkmcnt(4)
    v_pk_mul_f16 v164, v164, v190 op_sel:[0,1] op_sel_hi:[1,1]
    v_cvt_pk_bf16_f32 v146, v196, v197
    v_mfma_f32_16x16x32_bf16 v[160:163], v[124:127], a[196:199], v[160:163]
    s_waitcnt lgkmcnt(3)
    v_cvt_pk_bf16_f32 v147, v198, v199
    v_pk_mul_f16 v165, v165, v190 op_sel:[0,1] op_sel_hi:[1,1]
    v_mfma_f32_16x16x32_bf16 v[160:163], v[168:171], a[200:203], v[160:163]
    s_waitcnt lgkmcnt(2)
    v_pk_mul_f16 v166, v166, v190 op_sel:[0,1] op_sel_hi:[1,1]
    v_pk_mul_f16 v167, v167, v190 op_sel:[0,1] op_sel_hi:[1,1]
    v_mfma_f32_16x16x32_bf16 v[160:163], v[152:155], a[204:207], v[160:163]
    s_waitcnt lgkmcnt(1)
    v_pk_mul_f16 v206, v206, v190 op_sel:[0,1] op_sel_hi:[1,1]
    v_pk_mul_f16 v207, v207, v190 op_sel:[0,1] op_sel_hi:[1,1]
    v_mfma_f32_16x16x32_bf16 v[160:163], v[156:159], a[208:211], v[160:163]
    s_waitcnt lgkmcnt(0)
    v_pk_mul_f16 v128, v128, v190 op_sel:[0,0] op_sel_hi:[1,0]
    v_pk_mul_f16 v129, v129, v190 op_sel:[0,0] op_sel_hi:[1,0]
    v_mfma_f32_16x16x32_bf16 v[160:163], v[192:195], a[212:215], v[160:163]
    s_waitcnt vmcnt(3)
    ds_write_b16 v8, v46 offset:512
    v_mfma_f32_16x16x32_bf16 v[124:127], a[72:75], v[132:135], 0
    s_nop 0
    v_pk_mul_f16 v130, v130, v190 op_sel:[0,0] op_sel_hi:[1,0]
    v_mfma_f32_16x16x32_bf16 v[124:127], a[76:79], v[116:119], v[124:127]
    v_pk_mul_f16 v131, v131, v190 op_sel:[0,0] op_sel_hi:[1,0]
    v_pk_mul_f16 v204, v204, v190 op_sel:[0,0] op_sel_hi:[1,0]
    v_mfma_f32_16x16x32_bf16 v[124:127], a[80:83], v[200:203], v[124:127]
    v_cvt_pk_bf16_f32 v138, v160, v161
    v_cvt_pk_bf16_f32 v139, v162, v163
    v_mfma_f32_16x16x32_bf16 v[124:127], a[84:87], v[212:215], v[124:127]
    v_pk_mul_f16 v205, v205, v190 op_sel:[0,0] op_sel_hi:[1,0]
    v_max3_u32 v45, v45, v188, v189
    v_mfma_f32_16x16x32_bf16 v[124:127], a[88:91], v[216:219], v[124:127]
    v_mul_f32 v210, v142, v210
    v_mul_f32 v211, v142, v211
    v_mfma_f32_16x16x32_bf16 v[124:127], a[92:95], v[224:227], v[124:127]
    v_cvt_pk_bf16_f32 v209, v210, v211
    v_xor_b32 v0, 65536, v0
    v_mfma_f32_16x16x32_bf16 v[152:155], a[96:99], v[132:135], 0
    v_xor_b32 v1, 65536, v1
    v_mfma_f32_16x16x32_bf16 v[152:155], a[100:103], v[116:119], v[152:155]
    s_waitcnt lgkmcnt(0)
    v_mfma_f32_16x16x32_bf16 v[152:155], a[104:107], v[200:203], v[152:155]
    s_nop 0
    v_mfma_f32_16x16x32_bf16 v[152:155], a[108:111], v[212:215], v[152:155]
    s_nop 0
    v_mfma_f32_16x16x32_bf16 v[152:155], a[112:115], v[216:219], v[152:155]
    s_barrier
    v_mfma_f32_16x16x32_bf16 v[152:155], a[116:119], v[224:227], v[152:155]
    s_nop 0
    v_mfma_f32_16x16x32_bf16 v[156:159], a[120:123], v[132:135], 0
    buffer_load_dwordx4 v10, s[8:11], 0 offen nt lds
    ds_read_u16 v142, v9 offset:256
    v_mfma_f32_16x16x32_bf16 v[156:159], a[124:127], v[116:119], v[156:159]
    s_add_u32 m0, s28, 4096
    v_cvt_pk_f16_f32 v124, v124, v125
    v_pk_mul_f16 v161, v124, v124
    v_mfma_f32_16x16x32_bf16 v[156:159], a[128:131], v[200:203], v[156:159]
    v_cvt_pk_f16_f32 v125, v126, v127
    v_pk_mul_f16 v163, v125, v125
    v_mfma_f32_16x16x32_bf16 v[156:159], a[132:135], v[212:215], v[156:159]
    v_cvt_pk_f16_f32 v126, v152, v153
    v_pk_fma_f16 v161, v126, v126, v161
    v_mfma_f32_16x16x32_bf16 v[156:159], a[136:139], v[216:219], v[156:159]
    v_cvt_pk_f16_f32 v127, v154, v155
    v_pk_fma_f16 v163, v127, v127, v163
    v_mfma_f32_16x16x32_bf16 v[156:159], a[140:143], v[224:227], v[156:159]
    buffer_load_dwordx4 v11, s[8:11], 0 offen nt lds
    s_add_u32 m0, s28, 8192
    v_mfma_f32_16x16x32_bf16 v[152:155], a[0:3], v[132:135], 0
    v_mfma_f32_16x16x32_bf16 v[152:155], a[4:7], v[116:119], v[152:155]
    v_mfma_f32_16x16x32_bf16 v[152:155], a[8:11], v[200:203], v[152:155]
    s_waitcnt lgkmcnt(0)
    v_readfirstlane_b32 s77, v142
    v_mfma_f32_16x16x32_bf16 v[152:155], a[12:15], v[212:215], v[152:155]
    v_cvt_pk_f16_f32 v170, v156, v157
    v_pk_fma_f16 v161, v170, v170, v161
    v_mfma_f32_16x16x32_bf16 v[152:155], a[16:19], v[216:219], v[152:155]
    buffer_load_dwordx4 v12, s[8:11], 0 offen nt lds
    v_cvt_pk_f16_f32 v171, v158, v159
    v_mfma_f32_16x16x32_bf16 v[152:155], a[20:23], v[224:227], v[152:155]
    s_add_u32 m0, s28, 12288
    v_pk_fma_f16 v163, v171, v171, v163
    s_xor_b32 s28, s28, 65536
    v_mfma_f32_16x16x32_bf16 v[156:159], a[24:27], v[132:135], 0
    v_mfma_f32_16x16x32_bf16 v[156:159], a[28:31], v[116:119], v[156:159]
    v_mfma_f32_16x16x32_bf16 v[156:159], a[32:35], v[200:203], v[156:159]
    v_mfma_f32_16x16x32_bf16 v[156:159], a[36:39], v[212:215], v[156:159]
    buffer_load_dwordx4 v13, s[8:11], 0 offen nt lds
    v_cvt_pk_f16_f32 v152, v152, v153
    v_mfma_f32_16x16x32_bf16 v[156:159], a[40:43], v[216:219], v[156:159]
    s_mov_b32 m0, s29
    v_pk_mul_f16 v160, v152, v152
    v_cvt_pk_f16_f32 v153, v154, v155
    v_mfma_f32_16x16x32_bf16 v[156:159], a[44:47], v[224:227], v[156:159]
    s_xor_b32 s29, s29, s30
    v_pk_mul_f16 v162, v153, v153
    s_add_u32 s19, s19, s20
    v_mfma_f32_16x16x32_bf16 v[176:179], a[48:51], v[132:135], 0
    s_add_u32 s23, s23, s21
    s_cmp_ge_u32 s19, 72
    s_cselect_b32 s34, 72, 0
    v_mfma_f32_16x16x32_bf16 v[176:179], a[52:55], v[116:119], v[176:179]
    s_cselect_b32 s35, s22, 0
    v_cvt_pk_f16_f32 v154, v156, v157
    v_pk_fma_f16 v160, v154, v154, v160
    v_mfma_f32_16x16x32_bf16 v[176:179], a[56:59], v[200:203], v[176:179]
    s_sub_u32 s19, s19, s34
    buffer_load_dwordx4 v14, s[8:11], 0 offen nt lds
    v_cvt_pk_f16_f32 v155, v158, v159
    v_mfma_f32_16x16x32_bf16 v[176:179], a[60:63], v[212:215], v[176:179]
    s_add_u32 s23, s23, s35
    v_pk_fma_f16 v162, v155, v155, v162
    s_cmp_lg_u32 s83, 0
    v_mfma_f32_16x16x32_bf16 v[176:179], a[64:67], v[216:219], v[176:179]
    s_cselect_b32 s77, s80, s77
    ds_read_b128 v[156:159], v5 offset:0
    ds_read_b128 v[180:183], v5 offset:16
    v_mfma_f32_16x16x32_bf16 v[176:179], a[68:71], v[224:227], v[176:179]
    s_mul_i32 s78, s77, 2688
    ds_read_b128 v[188:191], v5 offset:48
    ds_read_b32 v210, v6 offset:192
    v_mfma_f32_16x16x32_bf16 v[192:195], v[132:135], a[144:147], 0
    s_add_u32 s78, s78, s69
    v_add_u32 v5, s74, v5
    s_add_u32 s80, s77, s68
    v_mfma_f32_16x16x32_bf16 v[192:195], v[116:119], a[148:151], v[192:195]
    s_cmp_ge_u32 s80, 72
    buffer_store_dwordx2 v[140:141], v19, s[12:15], 0 offen nt
    v_cvt_pk_f16_f32 v168, v176, v177
    v_pk_fma_f16 v160, v168, v168, v160
    v_mfma_f32_16x16x32_bf16 v[192:195], v[200:203], a[152:155], v[192:195]
    s_cselect_b32 s80, s22, 0
    v_cvt_pk_f16_f32 v169, v178, v179
    v_pk_fma_f16 v162, v169, v169, v162
    v_mfma_f32_16x16x32_bf16 v[192:195], v[212:215], a[156:159], v[192:195]
    s_add_u32 s78, s78, s80
    s_add_u32 s80, s77, 20
    s_add_u32 s34, s18, 3
    v_mfma_f32_16x16x32_f16 v[140:143], v[40:43], v[160:163], 0
    s_cmp_lt_u32 s77, s62
    s_cselect_b32 s79, 1, 0
    s_cselect_b32 s78, s78, 0
    v_mfma_f32_16x16x32_bf16 v[192:195], v[216:219], a[160:163], v[192:195]
    s_waitcnt lgkmcnt(3)
    s_cmp_lt_u32 s34, s17
    s_cselect_b32 s23, s23, s78
    v_mfma_f32_16x16x32_f16 v[160:163], v[156:159], v[220:223], v[22:25]
    s_waitcnt lgkmcnt(1)
    v_rsq_f32 v142, v140
    v_mfma_f32_16x16x32_f16 v[160:163], v[180:183], v[120:123], v[160:163]
    s_cselect_b32 s73, s34, s80
    v_rsq_f32 v143, v141
    v_mfma_f32_16x16x32_f16 v[160:163], v[188:191], v[148:151], v[160:163]
    s_waitcnt lgkmcnt(0)
    v_mul_f32 v142, s31, v142
    v_cvt_pk_f16_f32 v142, v142, v143
    v_mfma_f32_16x16x32_f16 v[228:231], v[156:159], v[128:131], v[24:27]
    s_cselect_b32 s79, 0, s79
    v_pk_mul_f16 v124, v124, v142 op_sel:[0,1] op_sel_hi:[1,1]
    v_pk_mul_f16 v125, v125, v142 op_sel:[0,1] op_sel_hi:[1,1]
    v_mfma_f32_16x16x32_f16 v[228:231], v[180:183], v[164:167], v[228:231]
    s_cselect_b32 s81, 0, 1
    v_mov_b32_dpp v210, v161 quad_perm:[0,1,2,3] row_mask:0x1 bank_mask:0xf
    v_pk_mul_f16 v126, v126, v142 op_sel:[0,1] op_sel_hi:[1,1]
    v_mfma_f32_16x16x32_f16 v[228:231], v[188:191], v[204:207], v[228:231]
    s_add_u32 s80, s77, 1
    v_pk_mul_f16 v127, v127, v142 op_sel:[0,1] op_sel_hi:[1,1]
    v_pk_mul_f16 v170, v170, v142 op_sel:[0,1] op_sel_hi:[1,1]
    v_mfma_f32_16x16x32_bf16 v[192:195], v[224:227], a[164:167], v[192:195]
    s_mul_i32 s80, s80, s81
    v_pk_mul_f16 v171, v171, v142 op_sel:[0,1] op_sel_hi:[1,1]
    v_pk_mul_f16 v152, v152, v142 op_sel:[0,0] op_sel_hi:[1,0]
    v_mfma_f32_16x16x32_bf16 v[176:179], v[132:135], a[168:171], 0
    s_cmp_lt_u32 s80, s62
    v_mov_b32_dpp v210, v229 quad_perm:[0,1,2,3] row_mask:0x2 bank_mask:0xf
    v_pk_mul_f16 v153, v153, v142 op_sel:[0,0] op_sel_hi:[1,0]
    v_mfma_f32_16x16x32_f16 v[196:199], v[120:123], v[220:223], v[48:51]
    s_cselect_b32 s70, s70, 0
    v_cvt_pk_bf16_f32 v192, v192, v193
    v_cvt_pk_bf16_f32 v193, v194, v195
    v_mfma_f32_16x16x32_f16 v[232:235], v[164:167], v[220:223], v[52:55]
    s_cselect_b32 s62, s62, 0
    v_pk_mul_f16 v154, v154, v142 op_sel:[0,0] op_sel_hi:[1,0]
    v_pk_mul_f16 v155, v155, v142 op_sel:[0,0] op_sel_hi:[1,0]
    v_mfma_f32_16x16x32_f16 v[236:239], v[124:127], v[220:223], v[56:59]
    s_add_u32 s80, s18, 4
    v_pk_mul_f16 v168, v168, v142 op_sel:[0,0] op_sel_hi:[1,0]
    v_pk_mul_f16 v169, v169, v142 op_sel:[0,0] op_sel_hi:[1,0]
    v_min3_u32 v44, v44, v140, v141
    v_mfma_f32_16x16x16_f16 v[196:199], v[150:151], v[148:149], v[196:199]
    v_max3_u32 v45, v45, v140, v141
    v_exp_f32 v228, v228
    v_mfma_f32_16x16x16_f16 v[232:235], v[206:207], v[148:149], v[232:235]
    v_exp_f32 v160, v160
    s_cmp_ge_u32 s80, s17
    v_mfma_f32_16x16x16_f16 v[236:239], v[170:171], v[148:149], v[236:239]
    buffer_store_dwordx4 v[172:175], v17, s[12:15], 0 offen nt
    v_cvt_pk_bf16_f32 v39, v160, 0
    v_exp_f32 v196, v196
    s_cselect_b32 s66, s70, 0
    v_mfma_f32_16x16x32_bf16 v[176:179], v[116:119], a[172:175], v[176:179]
    s_lshl_b32 s80, s79, s73
    v_exp_f32 v197, v197
    v_mfma_f32_16x16x32_bf16 v[176:179], v[200:203], a[176:179], v[176:179]
    s_or_b32 s63, s63, s80
    v_exp_f32 v198, v198
    v_mfma_f32_16x16x32_bf16 v[176:179], v[212:215], a[180:183], v[176:179]
    s_sub_u32 s80, s100, s81
    ds_read_b128 v[140:143], v2 offset:0
    v_cvt_pk_bf16_f32 v160, v196, v197
    v_mfma_f32_16x16x32_bf16 v[176:179], v[216:219], a[184:187], v[176:179]
    s_and_b32 s100, s100, s80
    ds_read_b128 v[172:175], v2 offset:1024
    s_add_u32 s45, s45, s79
    v_mfma_f32_16x16x32_bf16 v[176:179], v[224:227], a[188:191], v[176:179]
    s_add_u32 s18, s18, 1
    ds_read_b128 v[220:223], v2 offset:2048
    s_cmp_lt_u32 s18, s45
    v_mfma_f32_16x16x32_bf16 v[240:243], v[132:135], a[192:195], 0
    ds_read_b128 v[132:135], v2 offset:3072
    v_mfma_f32_16x16x32_bf16 v[240:243], v[116:119], a[196:199], v[240:243]
    ds_read_b128 v[116:119], v2 offset:4096
    ds_read2_b32 v[194:195], v6 offset0:0 offset1:0
    v_mfma_f32_16x16x32_bf16 v[240:243], v[200:203], a[200:203], v[240:243]
    ds_read_b128 v[244:247], v2 offset:5120
    ds_read2_b32 v[202:203], v6 offset0:16 offset1:16
    v_mfma_f32_16x16x32_bf16 v[240:243], v[212:215], a[204:207], v[240:243]
    v_cvt_pk_bf16_f32 v200, v176, v177
    v_cvt_pk_bf16_f32 v201, v178, v179
    v_mfma_f32_16x16x32_bf16 v[240:243], v[216:219], a[208:211], v[240:243]
    ds_read2_b32 v[214:215], v6 offset0:32 offset1:32
    v_add_u32 v6, s75, v6
    v_mfma_f32_16x16x32_bf16 v[240:243], v[224:227], a[212:215], v[240:243]
    s_waitcnt lgkmcnt(8)
    v_exp_f32 v199, v199
    v_mfma_f32_16x16x32_f16 v[176:179], v[120:123], v[128:131], v[60:63]
    s_waitcnt lgkmcnt(7)
    v_exp_f32 v232, v232
    v_mfma_f32_16x16x32_f16 v[216:219], v[164:167], v[128:131], v[64:67]
    s_waitcnt lgkmcnt(6)
    v_exp_f32 v233, v233
    v_mfma_f32_16x16x32_f16 v[224:227], v[124:127], v[128:131], v[68:71]
    s_waitcnt lgkmcnt(5)
    v_cvt_pk_bf16_f32 v212, v240, v241
    v_cvt_pk_bf16_f32 v213, v242, v243
    v_cvt_pk_bf16_f32 v161, v198, v199
    v_mfma_f32_16x16x16_f16 v[176:179], v[150:151], v[204:205], v[176:179]
    v_cvt_pk_bf16_f32 v162, v232, v233
    v_exp_f32 v234, v234
    v_mfma_f32_16x16x16_f16 v[216:219], v[206:207], v[204:205], v[216:219]
    v_exp_f32 v235, v235
    v_mfma_f32_16x16x16_f16 v[224:227], v[170:171], v[204:205], v[224:227]
    s_nop 0
    buffer_store_dwordx2 v[208:209], v20, s[12:15], 0 offen nt
    v_exp_f32 v236, v236
    v_mfma_f32_16x16x32_f16 v[240:243], v[156:159], v[152:155], v[26:29]
    s_waitcnt lgkmcnt(0)
    v_exp_f32 v176, v176
    v_mfma_f32_16x16x32_f16 v[240:243], v[180:183], v[124:127], v[240:243]
    v_exp_f32 v177, v177
    v_mfma_f32_16x16x32_f16 v[240:243], v[188:191], v[168:171], v[240:243]
    v_cvt_pk_bf16_f32 v156, v176, v177
    v_cvt_pk_bf16_f32 v163, v234, v235
    v_mfma_f32_16x16x32_bf16 v[128:131], a[216:219], v[140:143], 0
    v_exp_f32 v178, v178
    v_mfma_f32_16x16x32_bf16 v[128:131], a[220:223], v[172:175], v[128:131]
    v_exp_f32 v179, v179
    v_mfma_f32_16x16x32_bf16 v[128:131], a[224:227], v[220:223], v[128:131]
    v_exp_f32 v216, v216
    v_mfma_f32_16x16x32_bf16 v[128:131], a[228:231], v[132:135], v[128:131]
    v_cvt_pk_bf16_f32 v157, v178, v179
    v_mov_b32_dpp v210, v241 quad_perm:[0,1,2,3] row_mask:0x4 bank_mask:0xf
    v_mfma_f32_16x16x32_bf16 v[128:131], a[232:235], v[116:119], v[128:131]
    v_exp_f32 v217, v217
    v_mfma_f32_16x16x32_bf16 v[128:131], a[236:239], v[244:247], v[128:131]
    v_exp_f32 v218, v218
    v_mfma_f32_16x16x32_bf16 v[188:191], a[240:243], v[140:143], 0
    v_exp_f32 v219, v219
    v_mfma_f32_16x16x32_bf16 v[188:191], a[244:247], v[172:175], v[188:191]
    v_cvt_pk_bf16_f32 v158, v216, v217
    v_cvt_pk_bf16_f32 v159, v218, v219
    v_mfma_f32_16x16x32_bf16 v[188:191], a[248:251], v[220:223], v[188:191]
    ds_read_b128 v[180:183], v2 offset:6144
    v_fma_f32 v241, v128, v128, s33
    v_mfma_f32_16x16x32_bf16 v[188:191], a[252:255], v[132:135], v[188:191]
    ds_read_b128 v[216:219], v2 offset:7168
    v_fmac_f32 v241, v129, v129
    v_mfma_f32_16x16x32_bf16 v[188:191], v[84:87], v[116:119], v[188:191]
    ds_read_b128 v[232:235], v2 offset:8192
    v_fmac_f32 v241, v130, v130
    v_mfma_f32_16x16x32_bf16 v[188:191], v[88:91], v[244:247], v[188:191]
    ds_read_b128 v[248:251], v2 offset:9216
    v_fmac_f32 v241, v131, v131
    v_mfma_f32_16x16x32_bf16 v[176:179], v[92:95], v[140:143], 0
    ds_read_b128 v[140:143], v2 offset:10240
    v_mfma_f32_16x16x32_bf16 v[176:179], v[96:99], v[172:175], v[176:179]
    ds_read_b128 v[172:175], v2 offset:11264
    v_mfma_f32_16x16x32_bf16 v[176:179], v[100:103], v[220:223], v[176:179]
    v_exp_f32 v224, v224
    v_mfma_f32_16x16x32_bf16 v[176:179], v[104:107], v[132:135], v[176:179]
    v_exp_f32 v225, v225
    v_mfma_f32_16x16x32_bf16 v[176:179], v[108:111], v[116:119], v[176:179]
    s_waitcnt lgkmcnt(5)
    v_exp_f32 v226, v226
    v_mfma_f32_16x16x32_bf16 v[176:179], v[112:115], v[244:247], v[176:179]
    s_waitcnt lgkmcnt(4)
    v_exp_f32 v227, v227
    v_mfma_f32_16x16x32_f16 v[116:119], v[120:123], v[152:155], v[72:75]
    s_waitcnt lgkmcnt(3)
    v_exp_f32 v210, v210
    v_mfma_f32_16x16x32_f16 v[120:123], v[164:167], v[152:155], v[76:79]
    s_waitcnt lgkmcnt(2)
    v_cvt_pk_bf16_f32 v210, v210, v210
    v_fmac_f32 v241, v188, v188
    v_mfma_f32_16x16x32_f16 v[132:135], v[124:127], v[152:155], v[80:83]
    s_waitcnt lgkmcnt(1)
    ds_write_b16 v8, v210
    v_fmac_f32 v241, v189, v189
    v_mfma_f32_16x16x16_f16 v[116:119], v[150:151], v[168:169], v[116:119]
    v_exp_f32 v237, v237
    v_fmac_f32 v241, v190, v190
    v_mfma_f32_16x16x16_f16 v[120:123], v[206:207], v[168:169], v[120:123]
    v_cvt_pk_bf16_f32 v36, v236, v237
    v_exp_f32 v238, v238
    v_mfma_f32_16x16x16_f16 v[132:135], v[170:171], v[168:169], v[132:135]
    v_exp_f32 v239, v239
    v_exp_f32 v240, v240
    v_mfma_f32_16x16x32_bf16 v[196:199], a[216:219], v[180:183], 0
    s_waitcnt lgkmcnt(1)
    ds_read_b128 v[124:127], v9
    ds_read_b128 v[148:151], v9 offset:64
    v_mfma_f32_16x16x32_bf16 v[196:199], a[220:223], v[216:219], v[196:199]
    v_cvt_pk_bf16_f32 v37, v238, v239
    v_fmac_f32 v241, v191, v191
    v_mfma_f32_16x16x32_bf16 v[196:199], a[224:227], v[232:235], v[196:199]
    v_exp_f32 v116, v116
    v_mfma_f32_16x16x32_bf16 v[152:155], v[28:31], v[36:39], 0
    v_exp_f32 v117, v117
    v_mfma_f32_16x16x32_bf16 v[152:155], v[28:31], v[160:163], v[152:155]
    v_cvt_pk_bf16_f32 v116, v116, v117
    v_fmac_f32 v241, v176, v176
    v_mfma_f32_16x16x32_bf16 v[164:167], v[192:195], v[36:39], 0
    v_exp_f32 v118, v118
    v_mfma_f32_16x16x32_bf16 v[164:167], v[184:187], v[160:163], v[164:167]
    v_exp_f32 v119, v119
    v_mfma_f32_16x16x32_bf16 v[168:171], v[200:203], v[36:39], 0
    v_cvt_pk_bf16_f32 v117, v118, v119
    v_fmac_f32 v241, v177, v177
    v_mfma_f32_16x16x32_bf16 v[168:171], v[144:147], v[160:163], v[168:171]
    s_waitcnt lgkmcnt(0)
    v_exp_f32 v120, v120
    v_mfma_f32_16x16x32_bf16 v[204:207], v[212:215], v[36:39], 0
    v_cvt_pk_bf16_f32 v36, v224, v225
    v_cvt_pk_bf16_f32 v37, v226, v227
    v_mfma_f32_16x16x32_bf16 v[204:207], v[136:139], v[160:163], v[204:207]
    v_cvt_pk_bf16_f32 v39, v228, 0
    v_fmac_f32 v241, v178, v178
    v_mfma_f32_16x16x32_bf16 v[220:223], v[124:127], v[28:31], 0
    v_exp_f32 v121, v121
    v_mfma_f32_16x16x32_bf16 v[160:163], v[28:31], v[36:39], 0
    v_cvt_pk_bf16_f32 v118, v120, v121
    v_fmac_f32 v241, v179, v179
    v_mfma_f32_16x16x32_bf16 v[160:163], v[28:31], v[156:159], v[160:163]
    v_exp_f32 v122, v122
    v_mfma_f32_16x16x32_bf16 v[208:211], v[192:195], v[36:39], 0
    v_exp_f32 v123, v123
    v_mfma_f32_16x16x32_bf16 v[208:211], v[184:187], v[156:159], v[208:211]
    v_exp_f32 v132, v132
    v_mfma_f32_16x16x32_bf16 v[224:227], v[200:203], v[36:39], 0
    v_exp_f32 v133, v133
    v_mfma_f32_16x16x32_bf16 v[224:227], v[144:147], v[156:159], v[224:227]
    v_exp_f32 v134, v134
    v_mfma_f32_16x16x32_bf16 v[228:231], v[212:215], v[36:39], 0
    v_cvt_pk_bf16_f32 v119, v122, v123
    v_cvt_pk_bf16_f32 v36, v132, v133
    v_mfma_f32_16x16x32_bf16 v[228:231], v[136:139], v[156:159], v[228:231]
    v_exp_f32 v135, v135
    v_mfma_f32_16x16x32_bf16 v[220:223], v[148:151], v[28:31], v[220:223]
    v_cvt_pk_bf16_f32 v37, v134, v135
    v_cvt_pk_bf16_f32 v39, v240, 0
    v_mfma_f32_16x16x32_bf16 v[120:123], v[124:127], v[184:187], 0
    v_rcp_f32 v160, v160
    v_mfma_f32_16x16x32_bf16 v[156:159], v[28:31], v[36:39], 0
    v_mul_f32 v208, v160, v208
    v_mul_f32 v209, v160, v209
    v_mfma_f32_16x16x32_bf16 v[156:159], v[28:31], v[116:119], v[156:159]
    v_cvt_pk_bf16_f32 v132, v208, v209
    v_mul_f32 v210, v160, v210
    v_mfma_f32_16x16x32_bf16 v[236:239], v[192:195], v[36:39], 0
    v_mul_f32 v211, v160, v211
    v_cvt_pk_bf16_f32 v133, v210, v211
    v_mfma_f32_16x16x32_bf16 v[236:239], v[184:187], v[116:119], v[236:239]
    ds_write_b64 v3, v[132:133] offset:6144
    v_mfma_f32_16x16x32_bf16 v[184:187], v[200:203], v[36:39], 0
    v_mul_f32 v224, v160, v224
    v_mul_f32 v225, v160, v225
    v_mfma_f32_16x16x32_bf16 v[184:187], v[144:147], v[116:119], v[184:187]
    v_cvt_pk_bf16_f32 v134, v224, v225
    v_mul_f32 v226, v160, v226
    v_mfma_f32_16x16x32_bf16 v[244:247], v[212:215], v[36:39], 0
    v_mul_f32 v227, v160, v227
    v_cvt_pk_bf16_f32 v135, v226, v227
    v_mfma_f32_16x16x32_bf16 v[244:247], v[136:139], v[116:119], v[244:247]
    ds_write_b64 v3, v[134:135] offset:6152
    v_mfma_f32_16x16x32_bf16 v[120:123], v[148:151], v[192:195], v[120:123]
    v_mul_f32 v228, v160, v228
    v_mul_f32 v229, v160, v229
    v_mfma_f32_16x16x32_bf16 v[192:195], v[124:127], v[144:147], 0
    v_cvt_pk_bf16_f32 v228, v228, v229
    v_mul_f32 v230, v160, v230
    v_mfma_f32_16x16x32_bf16 v[192:195], v[148:151], v[200:203], v[192:195]
    v_mul_f32 v231, v160, v231
    v_cvt_pk_bf16_f32 v229, v230, v231
    v_mfma_f32_16x16x32_bf16 v[144:147], v[124:127], v[136:139], 0
    ds_write_b64 v4, v[228:229] offset:10240
    v_mfma_f32_16x16x32_bf16 v[144:147], v[148:151], v[212:215], v[144:147]
    v_rcp_f32 v152, v152
    v_mfma_f32_16x16x32_bf16 v[196:199], a[228:231], v[248:251], v[196:199]
    v_mul_f32 v164, v152, v164
    v_mul_f32 v165, v152, v165
    v_mfma_f32_16x16x32_bf16 v[196:199], a[232:235], v[140:143], v[196:199]
    v_cvt_pk_bf16_f32 v116, v164, v165
    v_mul_f32 v166, v152, v166
    v_mfma_f32_16x16x32_bf16 v[196:199], a[236:239], v[172:175], v[196:199]
    v_mul_f32 v167, v152, v167
    v_cvt_pk_bf16_f32 v117, v166, v167
    v_mfma_f32_16x16x32_bf16 v[132:135], a[240:243], v[180:183], 0
    ds_write_b64 v3, v[116:117] offset:0
    v_mfma_f32_16x16x32_bf16 v[132:135], a[244:247], v[216:219], v[132:135]
    v_mul_f32 v168, v152, v168
    v_mul_f32 v169, v152, v169
    v_mfma_f32_16x16x32_bf16 v[132:135], a[248:251], v[232:235], v[132:135]
    ds_read_b128 v[124:127], v2 offset:12288
    v_fma_f32 v121, v196, v196, s33
    v_mfma_f32_16x16x32_bf16 v[132:135], a[252:255], v[248:251], v[132:135]
    ds_read_b128 v[148:151], v2 offset:13312
    v_fmac_f32 v121, v197, v197
    v_mfma_f32_16x16x32_bf16 v[132:135], v[84:87], v[140:143], v[132:135]
    ds_read_b128 v[164:167], v2 offset:14336
    v_fmac_f32 v121, v198, v198
    v_mfma_f32_16x16x32_bf16 v[132:135], v[88:91], v[172:175], v[132:135]
    ds_read_b128 v[224:227], v2 offset:15360
    v_fmac_f32 v121, v199, v199
    v_mfma_f32_16x16x32_bf16 v[212:215], v[92:95], v[180:183], 0
    ds_read_b128 v[180:183], v2 offset:16384
    v_cvt_pk_bf16_f32 v118, v168, v169
    v_mfma_f32_16x16x32_bf16 v[212:215], v[96:99], v[216:219], v[212:215]
    ds_read_b128 v[228:231], v2 offset:17408
    v_mul_f32 v170, v152, v170
    v_mfma_f32_16x16x32_bf16 v[212:215], v[100:103], v[232:235], v[212:215]
    v_fmac_f32 v121, v132, v132
    v_fmac_f32 v121, v133, v133
    v_mfma_f32_16x16x32_bf16 v[212:215], v[104:107], v[248:251], v[212:215]
    v_fmac_f32 v121, v134, v134
    v_fmac_f32 v121, v135, v135
    v_mfma_f32_16x16x32_bf16 v[212:215], v[108:111], v[140:143], v[212:215]
    s_waitcnt lgkmcnt(5)
    v_mul_f32 v171, v152, v171
    v_cvt_pk_bf16_f32 v119, v170, v171
    v_mfma_f32_16x16x32_bf16 v[212:215], v[112:115], v[172:175], v[212:215]
    s_waitcnt lgkmcnt(4)
    ds_write_b64 v3, v[118:119] offset:8
    v_mfma_f32_16x16x32_bf16 v[200:203], a[216:219], v[124:127], 0
    s_waitcnt lgkmcnt(3)
    v_mul_f32 v204, v152, v204
    v_mul_f32 v205, v152, v205
    v_mfma_f32_16x16x32_bf16 v[200:203], a[220:223], v[148:151], v[200:203]
    s_waitcnt lgkmcnt(2)
    ds_read_b128 v[232:235], v0 offset:20480
    v_fmac_f32 v121, v212, v212
    v_mfma_f32_16x16x32_bf16 v[200:203], a[224:227], v[164:167], v[200:203]
    s_waitcnt lgkmcnt(2)
    ds_read_b128 v[248:251], v1 offset:20480
    v_fmac_f32 v121, v213, v213
    v_mfma_f32_16x16x32_bf16 v[200:203], a[228:231], v[224:227], v[200:203]
    ds_read_b128 v[160:163], v0 offset:20608
    v_fmac_f32 v121, v214, v214
    v_mfma_f32_16x16x32_bf16 v[200:203], a[232:235], v[180:183], v[200:203]
    ds_read_b128 v[136:139], v1 offset:20608
    v_fmac_f32 v121, v215, v215
    v_mfma_f32_16x16x32_bf16 v[200:203], a[236:239], v[228:231], v[200:203]
    ds_read_b128 v[116:119], v0 offset:20736
    v_cvt_pk_bf16_f32 v158, v241, v121
    v_mfma_f32_16x16x32_bf16 v[216:219], a[240:243], v[124:127], 0
    ds_read_b128 v[172:175], v1 offset:20736
    v_cvt_pk_bf16_f32 v204, v204, v205
    v_mfma_f32_16x16x32_bf16 v[216:219], a[244:247], v[148:151], v[216:219]
    v_mul_f32 v206, v152, v206
    v_mul_f32 v207, v152, v207
    v_mfma_f32_16x16x32_bf16 v[216:219], a[248:251], v[164:167], v[216:219]
    v_fma_f32 v157, v200, v200, s33
    v_fmac_f32 v157, v201, v201
    v_mfma_f32_16x16x32_bf16 v[216:219], a[252:255], v[224:227], v[216:219]
    s_waitcnt lgkmcnt(5)
    v_fmac_f32 v157, v202, v202
    v_fmac_f32 v157, v203, v203
    v_mfma_f32_16x16x32_bf16 v[216:219], v[84:87], v[180:183], v[216:219]
    s_waitcnt lgkmcnt(4)
    v_cvt_pk_bf16_f32 v205, v206, v207
    v_xor_b32 v2, 65536, v2
    v_mfma_f32_16x16x32_bf16 v[216:219], v[88:91], v[228:231], v[216:219]
    s_waitcnt lgkmcnt(3)
    ds_write_b64 v4, v[204:205] offset:4096
    v_mfma_f32_16x16x32_bf16 v[208:211], v[92:95], v[124:127], 0
    s_waitcnt lgkmcnt(2)
    v_rcp_f32 v220, v220
    v_mfma_f32_16x16x32_bf16 v[208:211], v[96:99], v[148:151], v[208:211]
    s_waitcnt lgkmcnt(1)
    v_rcp_f32 v156, v156
    v_mfma_f32_16x16x32_bf16 v[208:211], v[100:103], v[164:167], v[208:211]
    v_fmac_f32 v157, v216, v216
    v_fmac_f32 v157, v217, v217
    v_mfma_f32_16x16x32_bf16 v[208:211], v[104:107], v[224:227], v[208:211]
    v_fmac_f32 v157, v218, v218
    v_fmac_f32 v157, v219, v219
    v_mfma_f32_16x16x32_bf16 v[208:211], v[108:111], v[180:183], v[208:211]
    v_mul_f32 v120, v120, v220
    v_mul_f32_dpp v120, v192, v220 quad_perm:[0,1,2,3] row_mask:0x2 bank_mask:0xf
    v_mfma_f32_16x16x32_bf16 v[208:211], v[112:115], v[228:231], v[208:211]
    v_mul_f32_dpp v120, v144, v220 quad_perm:[0,1,2,3] row_mask:0x4 bank_mask:0xf
    v_cvt_pk_bf16_f32 v120, v120, v120
    v_mfma_f32_16x16x32_bf16 v[124:127], a[72:75], v[232:235], 0
    ds_write_b16 v7, v120
    v_mfma_f32_16x16x32_bf16 v[124:127], a[76:79], v[248:251], v[124:127]
    v_mul_f32 v236, v156, v236
    v_mul_f32 v237, v156, v237
    v_mfma_f32_16x16x32_bf16 v[124:127], a[80:83], v[160:163], v[124:127]
    v_fmac_f32 v157, v208, v208
    v_fmac_f32 v157, v209, v209
    v_mfma_f32_16x16x32_bf16 v[124:127], a[84:87], v[136:139], v[124:127]
    v_fmac_f32 v157, v210, v210
    v_fmac_f32 v157, v211, v211
    v_mfma_f32_16x16x32_bf16 v[124:127], a[88:91], v[116:119], v[124:127]
    v_cvt_pk_bf16_f32 v159, v157, v157
    v_cvt_pk_bf16_f32 v120, v236, v237
    v_mfma_f32_16x16x32_bf16 v[124:127], a[92:95], v[172:175], v[124:127]
    ds_write_b64 v4, v[158:159] offset:18432
    v_mfma_f32_16x16x32_bf16 v[140:143], a[96:99], v[232:235], 0
    v_mul_f32 v238, v156, v238
    v_mul_f32 v239, v156, v239
    v_mfma_f32_16x16x32_bf16 v[140:143], a[100:103], v[248:251], v[140:143]
    v_cvt_pk_bf16_f32 v121, v238, v239
    v_mul_f32 v184, v156, v184
    v_mfma_f32_16x16x32_bf16 v[140:143], a[104:107], v[160:163], v[140:143]
    ds_write_b64 v3, v[120:121] offset:12288
    v_mfma_f32_16x16x32_bf16 v[140:143], a[108:111], v[136:139], v[140:143]
    v_mul_f32 v185, v156, v185
    v_cvt_pk_bf16_f32 v122, v184, v185
    v_mfma_f32_16x16x32_bf16 v[140:143], a[112:115], v[116:119], v[140:143]
    v_mul_f32 v186, v156, v186
    v_mul_f32 v187, v156, v187
    v_mfma_f32_16x16x32_bf16 v[140:143], a[116:119], v[172:175], v[140:143]
    v_cvt_pk_bf16_f32 v123, v186, v187
    v_mul_f32 v244, v156, v244
    v_mfma_f32_16x16x32_bf16 v[144:147], a[120:123], v[232:235], 0
    ds_write_b64 v3, v[122:123] offset:12296
    v_mfma_f32_16x16x32_bf16 v[144:147], a[124:127], v[248:251], v[144:147]
    v_mul_f32 v245, v156, v245
    v_cvt_pk_bf16_f32 v244, v244, v245
    v_mfma_f32_16x16x32_bf16 v[144:147], a[128:131], v[160:163], v[144:147]
    v_mul_f32 v246, v156, v246
    v_mul_f32 v247, v156, v247
    v_mfma_f32_16x16x32_bf16 v[144:147], a[132:135], v[136:139], v[144:147]
    v_cvt_pk_bf16_f32 v245, v246, v247
    v_add_u32 v7, s76, v7
    v_mfma_f32_16x16x32_bf16 v[144:147], a[136:139], v[116:119], v[144:147]
    ds_write_b64 v4, v[244:245] offset:16384
    v_mfma_f32_16x16x32_bf16 v[144:147], a[140:143], v[172:175], v[144:147]
    v_cvt_pk_f16_f32 v120, v124, v125
    v_pk_mul_f16 v125, v120, v120
    v_mfma_f32_16x16x32_bf16 v[152:155], a[0:3], v[232:235], 0
    v_cvt_pk_f16_f32 v121, v126, v127
    v_pk_mul_f16 v127, v121, v121
    v_mfma_f32_16x16x32_bf16 v[152:155], a[4:7], v[248:251], v[152:155]
    v_cvt_pk_f16_f32 v122, v140, v141
    v_pk_fma_f16 v125, v122, v122, v125
    v_mfma_f32_16x16x32_bf16 v[152:155], a[8:11], v[160:163], v[152:155]
    v_xor_b32 v3, 65536, v3
    v_xor_b32 v4, 65536, v4
    v_mfma_f32_16x16x32_bf16 v[152:155], a[12:15], v[136:139], v[152:155]
    v_mfma_f32_16x16x32_bf16 v[152:155], a[16:19], v[116:119], v[152:155]
    v_mfma_f32_16x16x32_bf16 v[152:155], a[20:23], v[172:175], v[152:155]
    s_waitcnt lgkmcnt(0)
    v_mfma_f32_16x16x32_bf16 v[156:159], a[24:27], v[232:235], 0
    s_nop 0
    v_mfma_f32_16x16x32_bf16 v[156:159], a[28:31], v[248:251], v[156:159]
    s_nop 0
    v_mfma_f32_16x16x32_bf16 v[156:159], a[32:35], v[160:163], v[156:159]
    s_barrier
    v_mfma_f32_16x16x32_bf16 v[156:159], a[36:39], v[136:139], v[156:159]
    s_nop 0
    v_mfma_f32_16x16x32_bf16 v[156:159], a[40:43], v[116:119], v[156:159]
    v_mfma_f32_16x16x32_bf16 v[156:159], a[44:47], v[172:175], v[156:159]
    s_cbranch_scc1 L_loop_fast2
    s_branch L_final_fast
.p2align 6
L_loop_fast3:
    v_mfma_f32_16x16x32_bf16 v[164:167], a[48:51], v[232:235], 0
    s_add_u32 s12, s40, s27
    ds_read_b128 v[168:171], v2 offset:18432
    ds_read_b128 v[180:183], v2 offset:19456
    v_mfma_f32_16x16x32_bf16 v[164:167], a[52:55], v[248:251], v[164:167]
    s_addc_u32 s13, s41, 0
    v_cvt_pk_f16_f32 v123, v142, v143
    v_pk_fma_f16 v127, v123, v123, v127
    v_mfma_f32_16x16x32_bf16 v[164:167], a[56:59], v[160:163], v[164:167]
    s_sub_u32 s14, s36, s27
    v_cvt_pk_f16_f32 v150, v144, v145
    v_pk_fma_f16 v125, v150, v150, v125
    v_mfma_f32_16x16x32_bf16 v[164:167], a[60:63], v[136:139], v[164:167]
    s_cmp_ge_u32 s18, 2
    v_cvt_pk_f16_f32 v151, v146, v147
    v_pk_fma_f16 v127, v151, v151, v127
    v_mfma_f32_16x16x32_bf16 v[164:167], a[64:67], v[116:119], v[164:167]
    s_cselect_b32 s14, s14, 0
    v_cvt_pk_f16_f32 v220, v152, v153
    v_pk_mul_f16 v124, v220, v220
    v_mfma_f32_16x16x32_bf16 v[164:167], a[68:71], v[172:175], v[164:167]
    s_sub_u32 s82, s72, s71
    v_cvt_pk_f16_f32 v221, v154, v155
    v_pk_mul_f16 v126, v221, v221
    v_mfma_f32_16x16x32_bf16 v[184:187], v[232:235], a[144:147], 0
    s_mul_i32 s74, s82, 336
    v_cvt_pk_f16_f32 v222, v156, v157
    v_pk_fma_f16 v124, v222, v222, v124
    v_mfma_f32_16x16x32_bf16 v[184:187], v[248:251], a[148:151], v[184:187]
    s_mul_i32 s75, s82, 272
    v_cvt_pk_f16_f32 v223, v158, v159
    v_pk_fma_f16 v126, v223, v223, v126
    v_mfma_f32_16x16x32_bf16 v[184:187], v[160:163], a[152:155], v[184:187]
    s_waitcnt lgkmcnt(0)
    v_cvt_pk_f16_f32 v148, v164, v165
    v_pk_fma_f16 v124, v148, v148, v124
    v_mfma_f32_16x16x32_bf16 v[140:143], v[32:35], v[168:171], 0
    s_mul_i32 s76, s82, 16
    v_cvt_pk_f16_f32 v149, v166, v167
    v_pk_fma_f16 v126, v149, v149, v126
    v_mfma_f32_16x16x32_bf16 v[140:143], v[32:35], v[180:183], v[140:143]
    s_add_u32 s34, s18, 2
    s_add_u32 s8, s60, s23
    s_addc_u32 s9, s61, 0
    v_mfma_f32_16x16x32_f16 v[144:147], v[40:43], v[124:127], 0
    s_sub_u32 s10, s36, s23
    s_cmp_le_u32 s34, s45
    s_cselect_b32 s10, s10, 0
    v_mfma_f32_16x16x32_bf16 v[184:187], v[136:139], a[156:159], v[184:187]
    s_add_u32 m0, s28, 0
    v_mul_f32 v140, 0x3baaaaab, v140
    v_mul_f32 v141, 0x3baaaaab, v141
    v_mfma_f32_16x16x32_bf16 v[184:187], v[116:119], a[160:163], v[184:187]
    s_mov_b32 s27, s26
    ds_read_b128 v[180:183], v0 offset:26624
    v_min3_u32 v44, v44, v144, v145
    v_mfma_f32_16x16x32_bf16 v[184:187], v[172:175], a[164:167], v[184:187]
    s_mov_b32 s26, s25
    ds_read_b128 v[124:127], v1 offset:26624
    v_max3_u32 v45, v45, v144, v145
    v_mfma_f32_16x16x32_bf16 v[164:167], v[232:235], a[168:171], 0
    s_mov_b32 s25, s24
    ds_read_b128 v[168:171], v0 offset:26752
    v_mul_f32 v142, 0x3baaaaab, v142
    v_mfma_f32_16x16x32_bf16 v[164:167], v[248:251], a[172:175], v[164:167]
    s_mov_b32 s24, s23
    ds_read_b128 v[152:155], v1 offset:26752
    v_cvt_pk_bf16_f32 v184, v184, v185
    v_mfma_f32_16x16x32_bf16 v[164:167], v[160:163], a[176:179], v[164:167]
    s_ff1_i32_b32 s80, s100
    ds_read_b128 v[156:159], v0 offset:26880
    v_cvt_pk_bf16_f32 v185, v186, v187
    v_mfma_f32_16x16x32_bf16 v[164:167], v[136:139], a[180:183], v[164:167]
    s_mov_b32 s71, s72
    ds_read_b128 v[192:195], v1 offset:26880
    s_mov_b32 s72, s73
    v_mfma_f32_16x16x32_bf16 v[164:167], v[116:119], a[184:187], v[164:167]
    v_rsq_f32 v146, v144
    v_mfma_f32_16x16x32_bf16 v[164:167], v[172:175], a[188:191], v[164:167]
    v_rsq_f32 v147, v145
    v_mfma_f32_16x16x32_bf16 v[204:207], v[232:235], a[192:195], 0
    s_waitcnt lgkmcnt(5)
    v_rsq_f32 v140, v140
    v_mfma_f32_16x16x32_bf16 v[204:207], v[248:251], a[196:199], v[204:207]
    s_waitcnt lgkmcnt(4)
    v_mul_f32 v146, s31, v146
    v_cvt_pk_f16_f32 v146, v146, v147
    v_mfma_f32_16x16x32_bf16 v[204:207], v[160:163], a[200:203], v[204:207]
    s_waitcnt lgkmcnt(3)
    v_cvt_pk_bf16_f32 v144, v164, v165
    v_cvt_pk_bf16_f32 v145, v166, v167
    v_mfma_f32_16x16x32_bf16 v[204:207], v[136:139], a[204:207], v[204:207]
    s_waitcnt lgkmcnt(2)
    v_pk_mul_f16 v120, v120, v146 op_sel:[0,1] op_sel_hi:[1,1]
    v_pk_mul_f16 v121, v121, v146 op_sel:[0,1] op_sel_hi:[1,1]
    v_mfma_f32_16x16x32_bf16 v[204:207], v[116:119], a[208:211], v[204:207]
    s_waitcnt lgkmcnt(1)
    v_pk_mul_f16 v122, v122, v146 op_sel:[0,1] op_sel_hi:[1,1]
    v_pk_mul_f16 v123, v123, v146 op_sel:[0,1] op_sel_hi:[1,1]
    v_mfma_f32_16x16x32_bf16 v[204:207], v[172:175], a[212:215], v[204:207]
    s_waitcnt lgkmcnt(0)
    v_pk_mul_f16 v150, v150, v146 op_sel:[0,1] op_sel_hi:[1,1]
    v_pk_mul_f16 v151, v151, v146 op_sel:[0,1] op_sel_hi:[1,1]
    v_mfma_f32_16x16x32_bf16 v[116:119], a[72:75], v[180:183], 0
    v_pk_mul_f16 v220, v220, v146 op_sel:[0,0] op_sel_hi:[1,0]
    v_pk_mul_f16 v221, v221, v146 op_sel:[0,0] op_sel_hi:[1,0]
    v_mfma_f32_16x16x32_bf16 v[116:119], a[76:79], v[124:127], v[116:119]
    v_pk_mul_f16 v222, v222, v146 op_sel:[0,0] op_sel_hi:[1,0]
    v_cvt_pk_bf16_f32 v136, v204, v205
    v_mfma_f32_16x16x32_bf16 v[116:119], a[80:83], v[168:171], v[116:119]
    v_cvt_pk_bf16_f32 v137, v206, v207
    v_pk_mul_f16 v223, v223, v146 op_sel:[0,0] op_sel_hi:[1,0]
    v_mfma_f32_16x16x32_bf16 v[116:119], a[84:87], v[152:155], v[116:119]
    v_pk_mul_f16 v148, v148, v146 op_sel:[0,0] op_sel_hi:[1,0]
    v_pk_mul_f16 v149, v149, v146 op_sel:[0,0] op_sel_hi:[1,0]
    v_mfma_f32_16x16x32_bf16 v[116:119], a[88:91], v[156:159], v[116:119]
    v_rsq_f32 v141, v141
    v_mfma_f32_16x16x32_bf16 v[116:119], a[92:95], v[192:195], v[116:119]
    v_rsq_f32 v142, v142
    v_mfma_f32_16x16x32_bf16 v[160:163], a[96:99], v[180:183], 0
    v_mul_f32 v128, v140, v128
    v_mul_f32 v129, v140, v129
    v_mfma_f32_16x16x32_bf16 v[160:163], a[100:103], v[124:127], v[160:163]
    v_cvt_pk_bf16_f32 v128, v128, v129
    v_mul_f32 v130, v140, v130
    v_mfma_f32_16x16x32_bf16 v[160:163], a[104:107], v[168:171], v[160:163]
    v_cvt_pk_f16_f32 v164, v116, v117
    v_pk_mul_f16 v117, v164, v164
    v_mfma_f32_16x16x32_bf16 v[160:163], a[108:111], v[152:155], v[160:163]
    v_cvt_pk_f16_f32 v165, v118, v119
    v_pk_mul_f16 v119, v165, v165
    v_mfma_f32_16x16x32_bf16 v[160:163], a[112:115], v[156:159], v[160:163]
    v_mul_f32 v131, v140, v131
    v_cvt_pk_bf16_f32 v129, v130, v131
    v_mfma_f32_16x16x32_bf16 v[160:163], a[116:119], v[192:195], v[160:163]
    v_mul_f32 v188, v140, v188
    v_mul_f32 v189, v140, v189
    v_mfma_f32_16x16x32_bf16 v[172:175], a[120:123], v[180:183], 0
    v_cvt_pk_bf16_f32 v130, v188, v189
    v_mul_f32 v190, v140, v190
    v_mfma_f32_16x16x32_bf16 v[172:175], a[124:127], v[124:127], v[172:175]
    v_mul_f32 v191, v140, v191
    v_cvt_pk_bf16_f32 v131, v190, v191
    v_mfma_f32_16x16x32_bf16 v[172:175], a[128:131], v[168:171], v[172:175]
    buffer_store_dwordx4 v[128:131], v15, s[12:15], 0 offen nt
    v_cvt_pk_f16_f32 v166, v160, v161
    v_pk_fma_f16 v117, v166, v166, v117
    v_cvt_pk_f16_f32 v167, v162, v163
    v_pk_fma_f16 v119, v167, v167, v119
    v_mfma_f32_16x16x32_bf16 v[172:175], a[132:135], v[152:155], v[172:175]
    v_mul_f32 v176, v140, v176
    v_mul_f32 v177, v140, v177
    v_mfma_f32_16x16x32_bf16 v[172:175], a[136:139], v[156:159], v[172:175]
    v_cvt_pk_bf16_f32 v138, v176, v177
    v_mul_f32 v178, v140, v178
    v_mfma_f32_16x16x32_bf16 v[172:175], a[140:143], v[192:195], v[172:175]
    v_mul_f32 v179, v140, v179
    v_cvt_pk_bf16_f32 v139, v178, v179
    v_mfma_f32_16x16x32_bf16 v[128:131], a[0:3], v[180:183], 0
    v_mul_f32 v196, v141, v196
    v_mul_f32 v197, v141, v197
    v_mfma_f32_16x16x32_bf16 v[128:131], a[4:7], v[124:127], v[128:131]
    v_cvt_pk_bf16_f32 v160, v196, v197
    v_mul_f32 v198, v141, v198
    v_mfma_f32_16x16x32_bf16 v[128:131], a[8:11], v[168:171], v[128:131]
    v_cvt_pk_f16_f32 v206, v172, v173
    v_pk_fma_f16 v117, v206, v206, v117
    v_mfma_f32_16x16x32_bf16 v[128:131], a[12:15], v[152:155], v[128:131]
    v_cvt_pk_f16_f32 v207, v174, v175
    v_pk_fma_f16 v119, v207, v207, v119
    v_mfma_f32_16x16x32_bf16 v[128:131], a[16:19], v[156:159], v[128:131]
    v_mul_f32 v199, v141, v199
    v_cvt_pk_bf16_f32 v161, v198, v199
    v_mfma_f32_16x16x32_bf16 v[128:131], a[20:23], v[192:195], v[128:131]
    v_mul_f32 v132, v141, v132
    v_mul_f32 v133, v141, v133
    v_mfma_f32_16x16x32_bf16 v[172:175], a[24:27], v[180:183], 0
    v_cvt_pk_bf16_f32 v162, v132, v133
    v_mul_f32 v134, v141, v134
    v_mfma_f32_16x16x32_bf16 v[172:175], a[28:31], v[124:127], v[172:175]
    v_mul_f32 v135, v141, v135
    v_cvt_pk_bf16_f32 v163, v134, v135
    v_mfma_f32_16x16x32_bf16 v[172:175], a[32:35], v[168:171], v[172:175]
    v_cvt_pk_f16_f32 v128, v128, v129
    v_pk_mul_f16 v116, v128, v128
    v_mfma_f32_16x16x32_bf16 v[172:175], a[36:39], v[152:155], v[172:175]
    v_cvt_pk_f16_f32 v129, v130, v131
    v_pk_mul_f16 v118, v129, v129
    v_mfma_f32_16x16x32_bf16 v[172:175], a[40:43], v[156:159], v[172:175]
    v_mul_f32 v212, v141, v212
    v_mul_f32 v213, v141, v213
    v_mfma_f32_16x16x32_bf16 v[172:175], a[44:47], v[192:195], v[172:175]
    v_cvt_pk_bf16_f32 v140, v212, v213
    v_mul_f32 v214, v141, v214
    v_mfma_f32_16x16x32_bf16 v[132:135], a[48:51], v[180:183], 0
    v_mul_f32 v215, v141, v215
    v_cvt_pk_bf16_f32 v141, v214, v215
    v_mfma_f32_16x16x32_bf16 v[132:135], a[52:55], v[124:127], v[132:135]
    buffer_store_dwordx2 v[138:139], v18, s[12:15], 0 offen nt
    v_mul_f32 v200, v142, v200
    v_cvt_pk_f16_f32 v130, v172, v173
    v_mfma_f32_16x16x32_bf16 v[132:135], a[56:59], v[168:171], v[132:135]
    v_pk_fma_f16 v116, v130, v130, v116
    v_cvt_pk_f16_f32 v131, v174, v175
    v_mfma_f32_16x16x32_bf16 v[132:135], a[60:63], v[152:155], v[132:135]
    v_pk_fma_f16 v118, v131, v131, v118
    v_mul_f32 v201, v142, v201
    v_mfma_f32_16x16x32_bf16 v[132:135], a[64:67], v[156:159], v[132:135]
    v_cvt_pk_bf16_f32 v172, v200, v201
    v_mul_f32 v202, v142, v202
    v_mfma_f32_16x16x32_bf16 v[132:135], a[68:71], v[192:195], v[132:135]
    v_mul_f32 v203, v142, v203
    v_cvt_pk_bf16_f32 v173, v202, v203
    v_mfma_f32_16x16x32_bf16 v[176:179], v[180:183], a[144:147], 0
    v_mul_f32 v216, v142, v216
    v_mul_f32 v217, v142, v217
    v_mfma_f32_16x16x32_bf16 v[176:179], v[124:127], a[148:151], v[176:179]
    v_cvt_pk_bf16_f32 v174, v216, v217
    v_mul_f32 v218, v142, v218
    v_mfma_f32_16x16x32_bf16 v[176:179], v[168:171], a[152:155], v[176:179]
    v_cvt_pk_f16_f32 v204, v132, v133
    v_pk_fma_f16 v116, v204, v204, v116
    v_mfma_f32_16x16x32_bf16 v[176:179], v[152:155], a[156:159], v[176:179]
    v_cvt_pk_f16_f32 v205, v134, v135
    v_pk_fma_f16 v118, v205, v205, v118
    v_mfma_f32_16x16x32_bf16 v[176:179], v[156:159], a[160:163], v[176:179]
    ds_read_b128 v[132:135], v0 offset:32768
    v_mul_f32 v219, v142, v219
    v_mfma_f32_16x16x32_f16 v[188:191], v[40:43], v[116:119], 0
    v_cvt_pk_bf16_f32 v175, v218, v219
    v_mul_f32 v208, v142, v208
    v_mfma_f32_16x16x32_bf16 v[176:179], v[192:195], a[164:167], v[176:179]
    ds_read_b128 v[116:119], v1 offset:32768
    v_mul_f32 v209, v142, v209
    v_mfma_f32_16x16x32_bf16 v[196:199], v[180:183], a[168:171], 0
    ds_read_b128 v[200:203], v0 offset:32896
    v_cvt_pk_bf16_f32 v208, v208, v209
    v_mfma_f32_16x16x32_bf16 v[196:199], v[124:127], a[172:175], v[196:199]
    ds_read_b128 v[212:215], v1 offset:32896
    v_min3_u32 v44, v44, v188, v189
    v_mfma_f32_16x16x32_bf16 v[196:199], v[168:171], a[176:179], v[196:199]
    ds_read_b128 v[216:219], v0 offset:33024
    v_cvt_pk_bf16_f32 v186, v176, v177
    v_mfma_f32_16x16x32_bf16 v[196:199], v[152:155], a[180:183], v[196:199]
    ds_read_b128 v[224:227], v1 offset:33024
    v_cvt_pk_bf16_f32 v187, v178, v179
    v_mfma_f32_16x16x32_bf16 v[196:199], v[156:159], a[184:187], v[196:199]
    v_rsq_f32 v190, v188
    v_mfma_f32_16x16x32_bf16 v[196:199], v[192:195], a[188:191], v[196:199]
    s_waitcnt lgkmcnt(5)
    buffer_store_dwordx4 v[160:163], v16, s[12:15], 0 offen nt
    v_rsq_f32 v191, v189
    v_mul_f32 v190, s31, v190
    v_cvt_pk_f16_f32 v190, v190, v191
    v_mfma_f32_16x16x32_bf16 v[160:163], v[180:183], a[192:195], 0
    s_waitcnt lgkmcnt(4)
    v_pk_mul_f16 v164, v164, v190 op_sel:[0,1] op_sel_hi:[1,1]
    v_cvt_pk_bf16_f32 v146, v196, v197
    v_mfma_f32_16x16x32_bf16 v[160:163], v[124:127], a[196:199], v[160:163]
    s_waitcnt lgkmcnt(3)
    v_cvt_pk_bf16_f32 v147, v198, v199
    v_pk_mul_f16 v165, v165, v190 op_sel:[0,1] op_sel_hi:[1,1]
    v_mfma_f32_16x16x32_bf16 v[160:163], v[168:171], a[200:203], v[160:163]
    s_waitcnt lgkmcnt(2)
    v_pk_mul_f16 v166, v166, v190 op_sel:[0,1] op_sel_hi:[1,1]
    v_pk_mul_f16 v167, v167, v190 op_sel:[0,1] op_sel_hi:[1,1]
    v_mfma_f32_16x16x32_bf16 v[160:163], v[152:155], a[204:207], v[160:163]
    s_waitcnt lgkmcnt(1)
    v_pk_mul_f16 v206, v206, v190 op_sel:[0,1] op_sel_hi:[1,1]
    v_pk_mul_f16 v207, v207, v190 op_sel:[0,1] op_sel_hi:[1,1]
    v_mfma_f32_16x16x32_bf16 v[160:163], v[156:159], a[208:211], v[160:163]
    s_waitcnt lgkmcnt(0)
    v_pk_mul_f16 v128, v128, v190 op_sel:[0,0] op_sel_hi:[1,0]
    v_pk_mul_f16 v129, v129, v190 op_sel:[0,0] op_sel_hi:[1,0]
    v_mfma_f32_16x16x32_bf16 v[160:163], v[192:195], a[212:215], v[160:163]
    s_waitcnt vmcnt(3)
    ds_write_b16 v8, v46 offset:512
    v_mfma_f32_16x16x32_bf16 v[124:127], a[72:75], v[132:135], 0
    s_nop 0
    v_pk_mul_f16 v130, v130, v190 op_sel:[0,0] op_sel_hi:[1,0]
    v_mfma_f32_16x16x32_bf16 v[124:127], a[76:79], v[116:119], v[124:127]
    v_pk_mul_f16 v131, v131, v190 op_sel:[0,0] op_sel_hi:[1,0]
    v_pk_mul_f16 v204, v204, v190 op_sel:[0,0] op_sel_hi:[1,0]
    v_mfma_f32_16x16x32_bf16 v[124:127], a[80:83], v[200:203], v[124:127]
    v_cvt_pk_bf16_f32 v138, v160, v161
    v_cvt_pk_bf16_f32 v139, v162, v163
    v_mfma_f32_16x16x32_bf16 v[124:127], a[84:87], v[212:215], v[124:127]
    v_pk_mul_f16 v205, v205, v190 op_sel:[0,0] op_sel_hi:[1,0]
    v_max3_u32 v45, v45, v188, v189
    v_mfma_f32_16x16x32_bf16 v[124:127], a[88:91], v[216:219], v[124:127]
    v_mul_f32 v210, v142, v210
    v_mul_f32 v211, v142, v211
    v_mfma_f32_16x16x32_bf16 v[124:127], a[92:95], v[224:227], v[124:127]
    v_cvt_pk_bf16_f32 v209, v210, v211
    v_xor_b32 v0, 65536, v0
    v_mfma_f32_16x16x32_bf16 v[152:155], a[96:99], v[132:135], 0
    v_xor_b32 v1, 65536, v1
    v_mfma_f32_16x16x32_bf16 v[152:155], a[100:103], v[116:119], v[152:155]
    s_waitcnt lgkmcnt(0)
    v_mfma_f32_16x16x32_bf16 v[152:155], a[104:107], v[200:203], v[152:155]
    s_nop 0
    v_mfma_f32_16x16x32_bf16 v[152:155], a[108:111], v[212:215], v[152:155]
    s_nop 0
    v_mfma_f32_16x16x32_bf16 v[152:155], a[112:115], v[216:219], v[152:155]
    s_nop 0
    v_mfma_f32_16x16x32_bf16 v[152:155], a[116:119], v[224:227], v[152:155]
    s_barrier
    v_mfma_f32_16x16x32_bf16 v[156:159], a[120:123], v[132:135], 0
    buffer_load_dwordx4 v10, s[8:11], 0 offen nt lds
    ds_read_u16 v142, v9 offset:128
    v_mfma_f32_16x16x32_bf16 v[156:159], a[124:127], v[116:119], v[156:159]
    s_add_u32 m0, s28, 4096
    v_cvt_pk_f16_f32 v124, v124, v125
    v_pk_mul_f16 v161, v124, v124
    v_mfma_f32_16x16x32_bf16 v[156:159], a[128:131], v[200:203], v[156:159]
    v_cvt_pk_f16_f32 v125, v126, v127
    v_pk_mul_f16 v163, v125, v125
    v_mfma_f32_16x16x32_bf16 v[156:159], a[132:135], v[212:215], v[156:159]
    v_cvt_pk_f16_f32 v126, v152, v153
    v_pk_fma_f16 v161, v126, v126, v161
    v_mfma_f32_16x16x32_bf16 v[156:159], a[136:139], v[216:219], v[156:159]
    v_cvt_pk_f16_f32 v127, v154, v155
    v_pk_fma_f16 v163, v127, v127, v163
    v_mfma_f32_16x16x32_bf16 v[156:159], a[140:143], v[224:227], v[156:159]
    buffer_load_dwordx4 v11, s[8:11], 0 offen nt lds
    s_add_u32 m0, s28, 8192
    v_mfma_f32_16x16x32_bf16 v[152:155], a[0:3], v[132:135], 0
    v_mfma_f32_16x16x32_bf16 v[152:155], a[4:7], v[116:119], v[152:155]
    v_mfma_f32_16x16x32_bf16 v[152:155], a[8:11], v[200:203], v[152:155]
    s_waitcnt lgkmcnt(0)
    v_readfirstlane_b32 s77, v142
    v_mfma_f32_16x16x32_bf16 v[152:155], a[12:15], v[212:215], v[152:155]
    v_cvt_pk_f16_f32 v170, v156, v157
    v_pk_fma_f16 v161, v170, v170, v161
    v_mfma_f32_16x16x32_bf16 v[152:155], a[16:19], v[216:219], v[152:155]
    buffer_load_dwordx4 v12, s[8:11], 0 offen nt lds
    v_cvt_pk_f16_f32 v171, v158, v159
    v_mfma_f32_16x16x32_bf16 v[152:155], a[20:23], v[224:227], v[152:155]
    s_add_u32 m0, s28, 12288
    v_pk_fma_f16 v163, v171, v171, v163
    s_xor_b32 s28, s28, 65536
    v_mfma_f32_16x16x32_bf16 v[156:159], a[24:27], v[132:135], 0
    v_mfma_f32_16x16x32_bf16 v[156:159], a[28:31], v[116:119], v[156:159]
    v_mfma_f32_16x16x32_bf16 v[156:159], a[32:35], v[200:203], v[156:159]
    v_mfma_f32_16x16x32_bf16 v[156:159], a[36:39], v[212:215], v[156:159]
    buffer_load_dwordx4 v13, s[8:11], 0 offen nt lds
    v_cvt_pk_f16_f32 v152, v152, v153
    v_mfma_f32_16x16x32_bf16 v[156:159], a[40:43], v[216:219], v[156:159]
    s_mov_b32 m0, s29
    v_pk_mul_f16 v160, v152, v152
    v_cvt_pk_f16_f32 v153, v154, v155
    v_mfma_f32_16x16x32_bf16 v[156:159], a[44:47], v[224:227], v[156:159]
    s_xor_b32 s29, s29, s30
    v_pk_mul_f16 v162, v153, v153
    s_add_u32 s19, s19, s20
    v_mfma_f32_16x16x32_bf16 v[176:179], a[48:51], v[132:135], 0
    s_add_u32 s23, s23, s21
    s_cmp_ge_u32 s19, 72
    s_cselect_b32 s34, 72, 0
    v_mfma_f32_16x16x32_bf16 v[176:179], a[52:55], v[116:119], v[176:179]
    s_cselect_b32 s35, s22, 0
    v_cvt_pk_f16_f32 v154, v156, v157
    v_pk_fma_f16 v160, v154, v154, v160
    v_mfma_f32_16x16x32_bf16 v[176:179], a[56:59], v[200:203], v[176:179]
    s_sub_u32 s19, s19, s34
    buffer_load_dwordx4 v14, s[8:11], 0 offen nt lds
    v_cvt_pk_f16_f32 v155, v158, v159
    v_mfma_f32_16x16x32_bf16 v[176:179], a[60:63], v[212:215], v[176:179]
    s_add_u32 s23, s23, s35
    v_pk_fma_f16 v162, v155, v155, v162
    s_cmp_lg_u32 s83, 0
    v_mfma_f32_16x16x32_bf16 v[176:179], a[64:67], v[216:219], v[176:179]
    s_cselect_b32 s77, s80, s77
    ds_read_b128 v[156:159], v5 offset:0
    ds_read_b128 v[180:183], v5 offset:16
    v_mfma_f32_16x16x32_bf16 v[176:179], a[68:71], v[224:227], v[176:179]
    s_mul_i32 s78, s77, 2688
    ds_read_b128 v[188:191], v5 offset:48
    ds_read_b32 v210, v6 offset:192
    v_mfma_f32_16x16x32_bf16 v[192:195], v[132:135], a[144:147], 0
    s_add_u32 s78, s78, s69
    v_add_u32 v5, s74, v5
    s_add_u32 s80, s77, s68
    v_mfma_f32_16x16x32_bf16 v[192:195], v[116:119], a[148:151], v[192:195]
    s_cmp_ge_u32 s80, 72
    buffer_store_dwordx2 v[140:141], v19, s[12:15], 0 offen nt
    v_cvt_pk_f16_f32 v168, v176, v177
    v_pk_fma_f16 v160, v168, v168, v160
    v_mfma_f32_16x16x32_bf16 v[192:195], v[200:203], a[152:155], v[192:195]
    s_cselect_b32 s80, s22, 0
    v_cvt_pk_f16_f32 v169, v178, v179
    v_pk_fma_f16 v162, v169, v169, v162
    v_mfma_f32_16x16x32_bf16 v[192:195], v[212:215], a[156:159], v[192:195]
    s_add_u32 s78, s78, s80
    s_add_u32 s80, s77, 20
    s_add_u32 s34, s18, 3
    v_mfma_f32_16x16x32_f16 v[140:143], v[40:43], v[160:163], 0
    s_cmp_lt_u32 s77, s62
    s_cselect_b32 s79, 1, 0
    s_cselect_b32 s78, s78, 0
    v_mfma_f32_16x16x32_bf16 v[192:195], v[216:219], a[160:163], v[192:195]
    s_waitcnt lgkmcnt(3)
    s_cmp_lt_u32 s34, s17
    s_cselect_b32 s23, s23, s78
    v_mfma_f32_16x16x32_f16 v[160:163], v[156:159], v[220:223], v[22:25]
    s_waitcnt lgkmcnt(1)
    v_rsq_f32 v142, v140
    v_mfma_f32_16x16x32_f16 v[160:163], v[180:183], v[120:123], v[160:163]
    s_cselect_b32 s73, s34, s80
    v_rsq_f32 v143, v141
    v_mfma_f32_16x16x32_f16 v[160:163], v[188:191], v[148:151], v[160:163]
    s_waitcnt lgkmcnt(0)
    v_mul_f32 v142, s31, v142
    v_cvt_pk_f16_f32 v142, v142, v143
    v_mfma_f32_16x16x32_f16 v[228:231], v[156:159], v[128:131], v[24:27]
    s_cselect_b32 s79, 0, s79
    v_pk_mul_f16 v124, v124, v142 op_sel:[0,1] op_sel_hi:[1,1]
    v_pk_mul_f16 v125, v125, v142 op_sel:[0,1] op_sel_hi:[1,1]
    v_mfma_f32_16x16x32_f16 v[228:231], v[180:183], v[164:167], v[228:231]
    s_cselect_b32 s81, 0, 1
    v_mov_b32_dpp v210, v161 quad_perm:[0,1,2,3] row_mask:0x1 bank_mask:0xf
    v_pk_mul_f16 v126, v126, v142 op_sel:[0,1] op_sel_hi:[1,1]
    v_mfma_f32_16x16x32_f16 v[228:231], v[188:191], v[204:207], v[228:231]
    s_add_u32 s80, s77, 1
    v_pk_mul_f16 v127, v127, v142 op_sel:[0,1] op_sel_hi:[1,1]
    v_pk_mul_f16 v170, v170, v142 op_sel:[0,1] op_sel_hi:[1,1]
    v_mfma_f32_16x16x32_bf16 v[192:195], v[224:227], a[164:167], v[192:195]
    s_mul_i32 s80, s80, s81
    v_pk_mul_f16 v171, v171, v142 op_sel:[0,1] op_sel_hi:[1,1]
    v_pk_mul_f16 v152, v152, v142 op_sel:[0,0] op_sel_hi:[1,0]
    v_mfma_f32_16x16x32_bf16 v[176:179], v[132:135], a[168:171], 0
    s_cmp_lt_u32 s80, s62
    v_mov_b32_dpp v210, v229 quad_perm:[0,1,2,3] row_mask:0x2 bank_mask:0xf
    v_pk_mul_f16 v153, v153, v142 op_sel:[0,0] op_sel_hi:[1,0]
    v_mfma_f32_16x16x32_f16 v[196:199], v[120:123], v[220:223], v[48:51]
    s_cselect_b32 s70, s70, 0
    v_cvt_pk_bf16_f32 v192, v192, v193
    v_cvt_pk_bf16_f32 v193, v194, v195
    v_mfma_f32_16x16x32_f16 v[232:235], v[164:167], v[220:223], v[52:55]
    s_cselect_b32 s62, s62, 0
    v_pk_mul_f16 v154, v154, v142 op_sel:[0,0] op_sel_hi:[1,0]
    v_pk_mul_f16 v155, v155, v142 op_sel:[0,0] op_sel_hi:[1,0]
    v_mfma_f32_16x16x32_f16 v[236:239], v[124:127], v[220:223], v[56:59]
    s_add_u32 s80, s18, 4
    v_pk_mul_f16 v168, v168, v142 op_sel:[0,0] op_sel_hi:[1,0]
    v_pk_mul_f16 v169, v169, v142 op_sel:[0,0] op_sel_hi:[1,0]
    v_min3_u32 v44, v44, v140, v141
    v_mfma_f32_16x16x16_f16 v[196:199], v[150:151], v[148:149], v[196:199]
    v_max3_u32 v45, v45, v140, v141
    v_exp_f32 v228, v228
    v_mfma_f32_16x16x16_f16 v[232:235], v[206:207], v[148:149], v[232:235]
    v_exp_f32 v160, v160
    s_cmp_ge_u32 s80, s17
    v_mfma_f32_16x16x16_f16 v[236:239], v[170:171], v[148:149], v[236:239]
    buffer_store_dwordx4 v[172:175], v17, s[12:15], 0 offen nt
    v_cvt_pk_bf16_f32 v39, v160, 0
    v_exp_f32 v196, v196
    s_cselect_b32 s66, s70, 0
    v_mfma_f32_16x16x32_bf16 v[176:179], v[116:119], a[172:175], v[176:179]
    s_lshl_b32 s80, s79, s73
    v_exp_f32 v197, v197
    v_mfma_f32_16x16x32_bf16 v[176:179], v[200:203], a[176:179], v[176:179]
    s_or_b32 s63, s63, s80
    v_exp_f32 v198, v198
    v_mfma_f32_16x16x32_bf16 v[176:179], v[212:215], a[180:183], v[176:179]
    s_sub_u32 s80, s100, s81
    ds_read_b128 v[140:143], v2 offset:0
    v_cvt_pk_bf16_f32 v160, v196, v197
    v_mfma_f32_16x16x32_bf16 v[176:179], v[216:219], a[184:187], v[176:179]
    s_and_b32 s100, s100, s80
    ds_read_b128 v[172:175], v2 offset:1024
    s_add_u32 s45, s45, s79
    v_mfma_f32_16x16x32_bf16 v[176:179], v[224:227], a[188:191], v[176:179]
    s_add_u32 s18, s18, 1
    ds_read_b128 v[220:223], v2 offset:2048
    s_cmp_lt_u32 s18, s45
    v_mfma_f32_16x16x32_bf16 v[240:243], v[132:135], a[192:195], 0
    ds_read_b128 v[132:135], v2 offset:3072
    v_mfma_f32_16x16x32_bf16 v[240:243], v[116:119], a[196:199], v[240:243]
    ds_read_b128 v[116:119], v2 offset:4096
    ds_read2_b32 v[194:195], v6 offset0:0 offset1:0
    v_mfma_f32_16x16x32_bf16 v[240:243], v[200:203], a[200:203], v[240:243]
    ds_read_b128 v[244:247], v2 offset:5120
    ds_read2_b32 v[202:203], v6 offset0:16 offset1:16
    v_mfma_f32_16x16x32_bf16 v[240:243], v[212:215], a[204:207], v[240:243]
    v_cvt_pk_bf16_f32 v200, v176, v177
    v_cvt_pk_bf16_f32 v201, v178, v179
    v_mfma_f32_16x16x32_bf16 v[240:243], v[216:219], a[208:211], v[240:243]
    ds_read2_b32 v[214:215], v6 offset0:32 offset1:32
    v_add_u32 v6, s75, v6
    v_mfma_f32_16x16x32_bf16 v[240:243], v[224:227], a[212:215], v[240:243]
    s_waitcnt lgkmcnt(8)
    v_exp_f32 v199, v199
    v_mfma_f32_16x16x32_f16 v[176:179], v[120:123], v[128:131], v[60:63]
    s_waitcnt lgkmcnt(7)
    v_exp_f32 v232, v232
    v_mfma_f32_16x16x32_f16 v[216:219], v[164:167], v[128:131], v[64:67]
    s_waitcnt lgkmcnt(6)
    v_exp_f32 v233, v233
    v_mfma_f32_16x16x32_f16 v[224:227], v[124:127], v[128:131], v[68:71]
    s_waitcnt lgkmcnt(5)
    v_cvt_pk_bf16_f32 v212, v240, v241
    v_cvt_pk_bf16_f32 v213, v242, v243
    v_cvt_pk_bf16_f32 v161, v198, v199
    v_mfma_f32_16x16x16_f16 v[176:179], v[150:151], v[204:205], v[176:179]
    v_cvt_pk_bf16_f32 v162, v232, v233
    v_exp_f32 v234, v234
    v_mfma_f32_16x16x16_f16 v[216:219], v[206:207], v[204:205], v[216:219]
    v_exp_f32 v235, v235
    v_mfma_f32_16x16x16_f16 v[224:227], v[170:171], v[204:205], v[224:227]
    s_nop 0
    buffer_store_dwordx2 v[208:209], v20, s[12:15], 0 offen nt
    v_exp_f32 v236, v236
    v_mfma_f32_16x16x32_f16 v[240:243], v[156:159], v[152:155], v[26:29]
    s_waitcnt lgkmcnt(0)
    v_exp_f32 v176, v176
    v_mfma_f32_16x16x32_f16 v[240:243], v[180:183], v[124:127], v[240:243]
    v_exp_f32 v177, v177
    v_mfma_f32_16x16x32_f16 v[240:243], v[188:191], v[168:171], v[240:243]
    v_cvt_pk_bf16_f32 v156, v176, v177
    v_cvt_pk_bf16_f32 v163, v234, v235
    v_mfma_f32_16x16x32_bf16 v[128:131], a[216:219], v[140:143], 0
    v_exp_f32 v178, v178
    v_mfma_f32_16x16x32_bf16 v[128:131], a[220:223], v[172:175], v[128:131]
    v_exp_f32 v179, v179
    v_mfma_f32_16x16x32_bf16 v[128:131], a[224:227], v[220:223], v[128:131]
    v_exp_f32 v216, v216
    v_mfma_f32_16x16x32_bf16 v[128:131], a[228:231], v[132:135], v[128:131]
    v_cvt_pk_bf16_f32 v157, v178, v179
    v_mov_b32_dpp v210, v241 quad_perm:[0,1,2,3] row_mask:0x4 bank_mask:0xf
    v_mfma_f32_16x16x32_bf16 v[128:131], a[232:235], v[116:119], v[128:131]
    v_exp_f32 v217, v217
    v_mfma_f32_16x16x32_bf16 v[128:131], a[236:239], v[244:247], v[128:131]
    v_exp_f32 v218, v218
    v_mfma_f32_16x16x32_bf16 v[188:191], a[240:243], v[140:143], 0
    v_exp_f32 v219, v219
    v_mfma_f32_16x16x32_bf16 v[188:191], a[244:247], v[172:175], v[188:191]
    v_cvt_pk_bf16_f32 v158, v216, v217
    v_cvt_pk_bf16_f32 v159, v218, v219
    v_mfma_f32_16x16x32_bf16 v[188:191], a[248:251], v[220:223], v[188:191]
    ds_read_b128 v[180:183], v2 offset:6144
    v_fma_f32 v241, v128, v128, s33
    v_mfma_f32_16x16x32_bf16 v[188:191], a[252:255], v[132:135], v[188:191]
    ds_read_b128 v[216:219], v2 offset:7168
    v_fmac_f32 v241, v129, v129
    v_mfma_f32_16x16x32_bf16 v[188:191], v[84:87], v[116:119], v[188:191]
    ds_read_b128 v[232:235], v2 offset:8192
    v_fmac_f32 v241, v130, v130
    v_mfma_f32_16x16x32_bf16 v[188:191], v[88:91], v[244:247], v[188:191]
    ds_read_b128 v[248:251], v2 offset:9216
    v_fmac_f32 v241, v131, v131
    v_mfma_f32_16x16x32_bf16 v[176:179], v[92:95], v[140:143], 0
    ds_read_b128 v[140:143], v2 offset:10240
    v_mfma_f32_16x16x32_bf16 v[176:179], v[96:99], v[172:175], v[176:179]
    ds_read_b128 v[172:175], v2 offset:11264
    v_mfma_f32_16x16x32_bf16 v[176:179], v[100:103], v[220:223], v[176:179]
    v_exp_f32 v224, v224
    v_mfma_f32_16x16x32_bf16 v[176:179], v[104:107], v[132:135], v[176:179]
    v_exp_f32 v225, v225
    v_mfma_f32_16x16x32_bf16 v[176:179], v[108:111], v[116:119], v[176:179]
    s_waitcnt lgkmcnt(5)
    v_exp_f32 v226, v226
    v_mfma_f32_16x16x32_bf16 v[176:179], v[112:115], v[244:247], v[176:179]
    s_waitcnt lgkmcnt(4)
    v_exp_f32 v227, v227
    v_mfma_f32_16x16x32_f16 v[116:119], v[120:123], v[152:155], v[72:75]
    s_waitcnt lgkmcnt(3)
    v_exp_f32 v210, v210
    v_mfma_f32_16x16x32_f16 v[120:123], v[164:167], v[152:155], v[76:79]
    s_waitcnt lgkmcnt(2)
    v_cvt_pk_bf16_f32 v210, v210, v210
    v_fmac_f32 v241, v188, v188
    v_mfma_f32_16x16x32_f16 v[132:135], v[124:127], v[152:155], v[80:83]
    s_waitcnt lgkmcnt(1)
    ds_write_b16 v8, v210
    v_fmac_f32 v241, v189, v189
    v_mfma_f32_16x16x16_f16 v[116:119], v[150:151], v[168:169], v[116:119]
    v_exp_f32 v237, v237
    v_fmac_f32 v241, v190, v190
    v_mfma_f32_16x16x16_f16 v[120:123], v[206:207], v[168:169], v[120:123]
    v_cvt_pk_bf16_f32 v36, v236, v237
    v_exp_f32 v238, v238
    v_mfma_f32_16x16x16_f16 v[132:135], v[170:171], v[168:169], v[132:135]
    v_exp_f32 v239, v239
    v_exp_f32 v240, v240
    v_mfma_f32_16x16x32_bf16 v[196:199], a[216:219], v[180:183], 0
    s_waitcnt lgkmcnt(1)
    ds_read_b128 v[124:127], v9
    ds_read_b128 v[148:151], v9 offset:64
    v_mfma_f32_16x16x32_bf16 v[196:199], a[220:223], v[216:219], v[196:199]
    v_cvt_pk_bf16_f32 v37, v238, v239
    v_fmac_f32 v241, v191, v191
    v_mfma_f32_16x16x32_bf16 v[196:199], a[224:227], v[232:235], v[196:199]
    v_exp_f32 v116, v116
    v_mfma_f32_16x16x32_bf16 v[152:155], v[28:31], v[36:39], 0
    v_exp_f32 v117, v117
    v_mfma_f32_16x16x32_bf16 v[152:155], v[28:31], v[160:163], v[152:155]
    v_cvt_pk_bf16_f32 v116, v116, v117
    v_fmac_f32 v241, v176, v176
    v_mfma_f32_16x16x32_bf16 v[164:167], v[192:195], v[36:39], 0
    v_exp_f32 v118, v118
    v_mfma_f32_16x16x32_bf16 v[164:167], v[184:187], v[160:163], v[164:167]
    v_exp_f32 v119, v119
    v_mfma_f32_16x16x32_bf16 v[168:171], v[200:203], v[36:39], 0
    v_cvt_pk_bf16_f32 v117, v118, v119
    v_fmac_f32 v241, v177, v177
    v_mfma_f32_16x16x32_bf16 v[168:171], v[144:147], v[160:163], v[168:171]
    s_waitcnt lgkmcnt(0)
    v_exp_f32 v120, v120
    v_mfma_f32_16x16x32_bf16 v[204:207], v[212:215], v[36:39], 0
    v_cvt_pk_bf16_f32 v36, v224, v225
    v_cvt_pk_bf16_f32 v37, v226, v227
    v_mfma_f32_16x16x32_bf16 v[204:207], v[136:139], v[160:163], v[204:207]
    v_cvt_pk_bf16_f32 v39, v228, 0
    v_fmac_f32 v241, v178, v178
    v_mfma_f32_16x16x32_bf16 v[220:223], v[124:127], v[28:31], 0
    v_exp_f32 v121, v121
    v_mfma_f32_16x16x32_bf16 v[160:163], v[28:31], v[36:39], 0
    v_cvt_pk_bf16_f32 v118, v120, v121
    v_fmac_f32 v241, v179, v179
    v_mfma_f32_16x16x32_bf16 v[160:163], v[28:31], v[156:159], v[160:163]
    v_exp_f32 v122, v122
    v_mfma_f32_16x16x32_bf16 v[208:211], v[192:195], v[36:39], 0
    v_exp_f32 v123, v123
    v_mfma_f32_16x16x32_bf16 v[208:211], v[184:187], v[156:159], v[208:211]
    v_exp_f32 v132, v132
    v_mfma_f32_16x16x32_bf16 v[224:227], v[200:203], v[36:39], 0
    v_exp_f32 v133, v133
    v_mfma_f32_16x16x32_bf16 v[224:227], v[144:147], v[156:159], v[224:227]
    v_exp_f32 v134, v134
    v_mfma_f32_16x16x32_bf16 v[228:231], v[212:215], v[36:39], 0
    v_cvt_pk_bf16_f32 v119, v122, v123
    v_cvt_pk_bf16_f32 v36, v132, v133
    v_mfma_f32_16x16x32_bf16 v[228:231], v[136:139], v[156:159], v[228:231]
    v_exp_f32 v135, v135
    v_mfma_f32_16x16x32_bf16 v[220:223], v[148:151], v[28:31], v[220:223]
    v_cvt_pk_bf16_f32 v37, v134, v135
    v_cvt_pk_bf16_f32 v39, v240, 0
    v_mfma_f32_16x16x32_bf16 v[120:123], v[124:127], v[184:187], 0
    v_rcp_f32 v160, v160
    v_mfma_f32_16x16x32_bf16 v[156:159], v[28:31], v[36:39], 0
    v_mul_f32 v208, v160, v208
    v_mul_f32 v209, v160, v209
    v_mfma_f32_16x16x32_bf16 v[156:159], v[28:31], v[116:119], v[156:159]
    v_cvt_pk_bf16_f32 v132, v208, v209
    v_mul_f32 v210, v160, v210
    v_mfma_f32_16x16x32_bf16 v[236:239], v[192:195], v[36:39], 0
    v_mul_f32 v211, v160, v211
    v_cvt_pk_bf16_f32 v133, v210, v211
    v_mfma_f32_16x16x32_bf16 v[236:239], v[184:187], v[116:119], v[236:239]
    ds_write_b64 v3, v[132:133] offset:6144
    v_mfma_f32_16x16x32_bf16 v[184:187], v[200:203], v[36:39], 0
    v_mul_f32 v224, v160, v224
    v_mul_f32 v225, v160, v225
    v_mfma_f32_16x16x32_bf16 v[184:187], v[144:147], v[116:119], v[184:187]
    v_cvt_pk_bf16_f32 v134, v224, v225
    v_mul_f32 v226, v160, v226
    v_mfma_f32_16x16x32_bf16 v[244:247], v[212:215], v[36:39], 0
    v_mul_f32 v227, v160, v227
    v_cvt_pk_bf16_f32 v135, v226, v227
    v_mfma_f32_16x16x32_bf16 v[244:247], v[136:139], v[116:119], v[244:247]
    ds_write_b64 v3, v[134:135] offset:6152
    v_mfma_f32_16x16x32_bf16 v[120:123], v[148:151], v[192:195], v[120:123]
    v_mul_f32 v228, v160, v228
    v_mul_f32 v229, v160, v229
    v_mfma_f32_16x16x32_bf16 v[192:195], v[124:127], v[144:147], 0
    v_cvt_pk_bf16_f32 v228, v228, v229
    v_mul_f32 v230, v160, v230
    v_mfma_f32_16x16x32_bf16 v[192:195], v[148:151], v[200:203], v[192:195]
    v_mul_f32 v231, v160, v231
    v_cvt_pk_bf16_f32 v229, v230, v231
    v_mfma_f32_16x16x32_bf16 v[144:147], v[124:127], v[136:139], 0
    ds_write_b64 v4, v[228:229] offset:10240
    v_mfma_f32_16x16x32_bf16 v[144:147], v[148:151], v[212:215], v[144:147]
    v_rcp_f32 v152, v152
    v_mfma_f32_16x16x32_bf16 v[196:199], a[228:231], v[248:251], v[196:199]
    v_mul_f32 v164, v152, v164
    v_mul_f32 v165, v152, v165
    v_mfma_f32_16x16x32_bf16 v[196:199], a[232:235], v[140:143], v[196:199]
    v_cvt_pk_bf16_f32 v116, v164, v165
    v_mul_f32 v166, v152, v166
    v_mfma_f32_16x16x32_bf16 v[196:199], a[236:239], v[172:175], v[196:199]
    v_mul_f32 v167, v152, v167
    v_cvt_pk_bf16_f32 v117, v166, v167
    v_mfma_f32_16x16x32_bf16 v[132:135], a[240:243], v[180:183], 0
    ds_write_b64 v3, v[116:117] offset:0
    v_mfma_f32_16x16x32_bf16 v[132:135], a[244:247], v[216:219], v[132:135]
    v_mul_f32 v168, v152, v168
    v_mul_f32 v169, v152, v169
    v_mfma_f32_16x16x32_bf16 v[132:135], a[248:251], v[232:235], v[132:135]
    ds_read_b128 v[124:127], v2 offset:12288
    v_fma_f32 v121, v196, v196, s33
    v_mfma_f32_16x16x32_bf16 v[132:135], a[252:255], v[248:251], v[132:135]
    ds_read_b128 v[148:151], v2 offset:13312
    v_fmac_f32 v121, v197, v197
    v_mfma_f32_16x16x32_bf16 v[132:135], v[84:87], v[140:143], v[132:135]
    ds_read_b128 v[164:167], v2 offset:14336
    v_fmac_f32 v121, v198, v198
    v_mfma_f32_16x16x32_bf16 v[132:135], v[88:91], v[172:175], v[132:135]
    ds_read_b128 v[224:227], v2 offset:15360
    v_fmac_f32 v121, v199, v199
    v_mfma_f32_16x16x32_bf16 v[212:215], v[92:95], v[180:183], 0
    ds_read_b128 v[180:183], v2 offset:16384
    v_cvt_pk_bf16_f32 v118, v168, v169
    v_mfma_f32_16x16x32_bf16 v[212:215], v[96:99], v[216:219], v[212:215]
    ds_read_b128 v[228:231], v2 offset:17408
    v_mul_f32 v170, v152, v170
    v_mfma_f32_16x16x32_bf16 v[212:215], v[100:103], v[232:235], v[212:215]
    v_fmac_f32 v121, v132, v132
    v_fmac_f32 v121, v133, v133
    v_mfma_f32_16x16x32_bf16 v[212:215], v[104:107], v[248:251], v[212:215]
    v_fmac_f32 v121, v134, v134
    v_fmac_f32 v121, v135, v135
    v_mfma_f32_16x16x32_bf16 v[212:215], v[108:111], v[140:143], v[212:215]
    s_waitcnt lgkmcnt(5)
    v_mul_f32 v171, v152, v171
    v_cvt_pk_bf16_f32 v119, v170, v171
    v_mfma_f32_16x16x32_bf16 v[212:215], v[112:115], v[172:175], v[212:215]
    s_waitcnt lgkmcnt(4)
    ds_write_b64 v3, v[118:119] offset:8
    v_mfma_f32_16x16x32_bf16 v[200:203], a[216:219], v[124:127], 0
    s_waitcnt lgkmcnt(3)
    v_mul_f32 v204, v152, v204
    v_mul_f32 v205, v152, v205
    v_mfma_f32_16x16x32_bf16 v[200:203], a[220:223], v[148:151], v[200:203]
    s_waitcnt lgkmcnt(2)
    ds_read_b128 v[232:235], v0 offset:20480
    v_fmac_f32 v121, v212, v212
    v_mfma_f32_16x16x32_bf16 v[200:203], a[224:227], v[164:167], v[200:203]
    s_waitcnt lgkmcnt(2)
    ds_read_b128 v[248:251], v1 offset:20480
    v_fmac_f32 v121, v213, v213
    v_mfma_f32_16x16x32_bf16 v[200:203], a[228:231], v[224:227], v[200:203]
    ds_read_b128 v[160:163], v0 offset:20608
    v_fmac_f32 v121, v214, v214
    v_mfma_f32_16x16x32_bf16 v[200:203], a[232:235], v[180:183], v[200:203]
    ds_read_b128 v[136:139], v1 offset:20608
    v_fmac_f32 v121, v215, v215
    v_mfma_f32_16x16x32_bf16 v[200:203], a[236:239], v[228:231], v[200:203]
    ds_read_b128 v[116:119], v0 offset:20736
    v_cvt_pk_bf16_f32 v158, v241, v121
    v_mfma_f32_16x16x32_bf16 v[216:219], a[240:243], v[124:127], 0
    ds_read_b128 v[172:175], v1 offset:20736
    v_cvt_pk_bf16_f32 v204, v204, v205
    v_mfma_f32_16x16x32_bf16 v[216:219], a[244:247], v[148:151], v[216:219]
    v_mul_f32 v206, v152, v206
    v_mul_f32 v207, v152, v207
    v_mfma_f32_16x16x32_bf16 v[216:219], a[248:251], v[164:167], v[216:219]
    v_fma_f32 v157, v200, v200, s33
    v_fmac_f32 v157, v201, v201
    v_mfma_f32_16x16x32_bf16 v[216:219], a[252:255], v[224:227], v[216:219]
    s_waitcnt lgkmcnt(5)
    v_fmac_f32 v157, v202, v202
    v_fmac_f32 v157, v203, v203
    v_mfma_f32_16x16x32_bf16 v[216:219], v[84:87], v[180:183], v[216:219]
    s_waitcnt lgkmcnt(4)
    v_cvt_pk_bf16_f32 v205, v206, v207
    v_xor_b32 v2, 65536, v2
    v_mfma_f32_16x16x32_bf16 v[216:219], v[88:91], v[228:231], v[216:219]
    s_waitcnt lgkmcnt(3)
    ds_write_b64 v4, v[204:205] offset:4096
    v_mfma_f32_16x16x32_bf16 v[208:211], v[92:95], v[124:127], 0
    s_waitcnt lgkmcnt(2)
    v_rcp_f32 v220, v220
    v_mfma_f32_16x16x32_bf16 v[208:211], v[96:99], v[148:151], v[208:211]
    s_waitcnt lgkmcnt(1)
    v_rcp_f32 v156, v156
    v_mfma_f32_16x16x32_bf16 v[208:211], v[100:103], v[164:167], v[208:211]
    v_fmac_f32 v157, v216, v216
    v_fmac_f32 v157, v217, v217
    v_mfma_f32_16x16x32_bf16 v[208:211], v[104:107], v[224:227], v[208:211]
    v_fmac_f32 v157, v218, v218
    v_fmac_f32 v157, v219, v219
    v_mfma_f32_16x16x32_bf16 v[208:211], v[108:111], v[180:183], v[208:211]
    v_mul_f32 v120, v120, v220
    v_mul_f32_dpp v120, v192, v220 quad_perm:[0,1,2,3] row_mask:0x2 bank_mask:0xf
    v_mfma_f32_16x16x32_bf16 v[208:211], v[112:115], v[228:231], v[208:211]
    v_mul_f32_dpp v120, v144, v220 quad_perm:[0,1,2,3] row_mask:0x4 bank_mask:0xf
    v_cvt_pk_bf16_f32 v120, v120, v120
    v_mfma_f32_16x16x32_bf16 v[124:127], a[72:75], v[232:235], 0
    ds_write_b16 v7, v120
    v_mfma_f32_16x16x32_bf16 v[124:127], a[76:79], v[248:251], v[124:127]
    v_mul_f32 v236, v156, v236
    v_mul_f32 v237, v156, v237
    v_mfma_f32_16x16x32_bf16 v[124:127], a[80:83], v[160:163], v[124:127]
    v_fmac_f32 v157, v208, v208
    v_fmac_f32 v157, v209, v209
    v_mfma_f32_16x16x32_bf16 v[124:127], a[84:87], v[136:139], v[124:127]
    v_fmac_f32 v157, v210, v210
    v_fmac_f32 v157, v211, v211
    v_mfma_f32_16x16x32_bf16 v[124:127], a[88:91], v[116:119], v[124:127]
    v_cvt_pk_bf16_f32 v159, v157, v157
    v_cvt_pk_bf16_f32 v120, v236, v237
    v_mfma_f32_16x16x32_bf16 v[124:127], a[92:95], v[172:175], v[124:127]
    ds_write_b64 v4, v[158:159] offset:18432
    v_mfma_f32_16x16x32_bf16 v[140:143], a[96:99], v[232:235], 0
    v_mul_f32 v238, v156, v238
    v_mul_f32 v239, v156, v239
    v_mfma_f32_16x16x32_bf16 v[140:143], a[100:103], v[248:251], v[140:143]
    v_cvt_pk_bf16_f32 v121, v238, v239
    v_mul_f32 v184, v156, v184
    v_mfma_f32_16x16x32_bf16 v[140:143], a[104:107], v[160:163], v[140:143]
    ds_write_b64 v3, v[120:121] offset:12288
    v_mfma_f32_16x16x32_bf16 v[140:143], a[108:111], v[136:139], v[140:143]
    v_mul_f32 v185, v156, v185
    v_cvt_pk_bf16_f32 v122, v184, v185
    v_mfma_f32_16x16x32_bf16 v[140:143], a[112:115], v[116:119], v[140:143]
    v_mul_f32 v186, v156, v186
    v_mul_f32 v187, v156, v187
    v_mfma_f32_16x16x32_bf16 v[140:143], a[116:119], v[172:175], v[140:143]
    v_cvt_pk_bf16_f32 v123, v186, v187
    v_mul_f32 v244, v156, v244
    v_mfma_f32_16x16x32_bf16 v[144:147], a[120:123], v[232:235], 0
    ds_write_b64 v3, v[122:123] offset:12296
    v_mfma_f32_16x16x32_bf16 v[144:147], a[124:127], v[248:251], v[144:147]
    v_mul_f32 v245, v156, v245
    v_cvt_pk_bf16_f32 v244, v244, v245
    v_mfma_f32_16x16x32_bf16 v[144:147], a[128:131], v[160:163], v[144:147]
    v_mul_f32 v246, v156, v246
    v_mul_f32 v247, v156, v247
    v_mfma_f32_16x16x32_bf16 v[144:147], a[132:135], v[136:139], v[144:147]
    v_cvt_pk_bf16_f32 v245, v246, v247
    v_add_u32 v7, s76, v7
    v_mfma_f32_16x16x32_bf16 v[144:147], a[136:139], v[116:119], v[144:147]
    ds_write_b64 v4, v[244:245] offset:16384
    v_mfma_f32_16x16x32_bf16 v[144:147], a[140:143], v[172:175], v[144:147]
    v_cvt_pk_f16_f32 v120, v124, v125
    v_pk_mul_f16 v125, v120, v120
    v_mfma_f32_16x16x32_bf16 v[152:155], a[0:3], v[232:235], 0
    v_cvt_pk_f16_f32 v121, v126, v127
    v_pk_mul_f16 v127, v121, v121
    v_mfma_f32_16x16x32_bf16 v[152:155], a[4:7], v[248:251], v[152:155]
    v_cvt_pk_f16_f32 v122, v140, v141
    v_pk_fma_f16 v125, v122, v122, v125
    v_mfma_f32_16x16x32_bf16 v[152:155], a[8:11], v[160:163], v[152:155]
    v_xor_b32 v3, 65536, v3
    v_xor_b32 v4, 65536, v4
    v_mfma_f32_16x16x32_bf16 v[152:155], a[12:15], v[136:139], v[152:155]
    v_mfma_f32_16x16x32_bf16 v[152:155], a[16:19], v[116:119], v[152:155]
    v_mfma_f32_16x16x32_bf16 v[152:155], a[20:23], v[172:175], v[152:155]
    s_waitcnt lgkmcnt(0)
    v_mfma_f32_16x16x32_bf16 v[156:159], a[24:27], v[232:235], 0
    s_nop 0
    v_mfma_f32_16x16x32_bf16 v[156:159], a[28:31], v[248:251], v[156:159]
    s_nop 0
    v_mfma_f32_16x16x32_bf16 v[156:159], a[32:35], v[160:163], v[156:159]
    s_nop 0
    v_mfma_f32_16x16x32_bf16 v[156:159], a[36:39], v[136:139], v[156:159]
    s_barrier
    v_mfma_f32_16x16x32_bf16 v[156:159], a[40:43], v[116:119], v[156:159]
    v_mfma_f32_16x16x32_bf16 v[156:159], a[44:47], v[172:175], v[156:159]
    s_cbranch_scc1 L_loop_fast3
L_final_fast:
    v_mfma_f32_16x16x32_bf16 v[148:151], a[48:51], v[232:235], 0
    s_mov_b32 s12, s40
    ds_read_b128 v[164:167], v2 offset:18432
    ds_read_b128 v[168:171], v2 offset:19456
    v_mfma_f32_16x16x32_bf16 v[148:151], a[52:55], v[248:251], v[148:151]
    s_mov_b32 s13, s41
    v_cvt_pk_f16_f32 v123, v142, v143
    v_pk_fma_f16 v127, v123, v123, v127
    v_mfma_f32_16x16x32_bf16 v[148:151], a[56:59], v[160:163], v[148:151]
    s_mov_b32 s14, s36
    v_cvt_pk_f16_f32 v142, v144, v145
    v_pk_fma_f16 v125, v142, v142, v125
    v_mfma_f32_16x16x32_bf16 v[148:151], a[60:63], v[136:139], v[148:151]
    s_add_u32 s48, s40, s27
    v_cvt_pk_f16_f32 v143, v146, v147
    v_pk_fma_f16 v127, v143, v143, v127
    v_mfma_f32_16x16x32_bf16 v[148:151], a[64:67], v[116:119], v[148:151]
    s_addc_u32 s49, s41, 0
    v_cvt_pk_f16_f32 v144, v152, v153
    v_pk_mul_f16 v124, v144, v144
    v_mfma_f32_16x16x32_bf16 v[148:151], a[68:71], v[172:175], v[148:151]
    s_sub_u32 s50, s36, s27
    v_cvt_pk_f16_f32 v145, v154, v155
    v_pk_mul_f16 v126, v145, v145
    v_mfma_f32_16x16x32_bf16 v[152:155], v[232:235], a[144:147], 0
    s_mov_b32 s51, 0x00020000
    v_cvt_pk_f16_f32 v146, v156, v157
    v_pk_fma_f16 v124, v146, v146, v124
    v_mfma_f32_16x16x32_bf16 v[152:155], v[248:251], a[148:151], v[152:155]
    s_waitcnt lgkmcnt(0)
    v_cvt_pk_f16_f32 v147, v158, v159
    v_pk_fma_f16 v126, v147, v147, v126
    v_mfma_f32_16x16x32_bf16 v[156:159], v[32:35], v[164:167], 0
    s_add_u32 s52, s40, s26
    v_cvt_pk_f16_f32 v140, v148, v149
    v_pk_fma_f16 v124, v140, v140, v124
    v_mfma_f32_16x16x32_bf16 v[156:159], v[32:35], v[168:171], v[156:159]
    s_addc_u32 s53, s41, 0
    v_cvt_pk_f16_f32 v141, v150, v151
    v_pk_fma_f16 v126, v141, v141, v126
    v_mfma_f32_16x16x32_bf16 v[152:155], v[160:163], a[152:155], v[152:155]
    s_sub_u32 s54, s36, s26
    v_mov_b32 v148, 0x40000000
    v_bfe_u32 v149, v2, 4, 6
    v_mfma_f32_16x16x32_f16 v[164:167], v[40:43], v[124:127], 0
    s_mov_b32 s55, 0x00020000
    v_mul_f32 v150, 0x3baaaaab, v156
    v_mul_f32 v151, 0x3baaaaab, v157
    v_mfma_f32_16x16x32_bf16 v[152:155], v[136:139], a[156:159], v[152:155]
    s_add_u32 s56, s40, s25
    v_rsq_f32 v150, v150
    v_mfma_f32_16x16x32_bf16 v[152:155], v[116:119], a[160:163], v[152:155]
    s_addc_u32 s57, s41, 0
    v_mul_f32 v128, v150, v128
    v_mul_f32 v129, v150, v129
    v_mfma_f32_16x16x32_bf16 v[152:155], v[172:175], a[164:167], v[152:155]
    s_sub_u32 s58, s36, s25
    v_cvt_pk_bf16_f32 v124, v128, v129
    v_mul_f32 v130, v150, v130
    v_mfma_f32_16x16x32_bf16 v[168:171], v[232:235], a[168:171], 0
    s_mov_b32 s59, 0x00020000
    v_mul_f32 v131, v150, v131
    v_cvt_pk_bf16_f32 v125, v130, v131
    v_mfma_f32_16x16x32_bf16 v[168:171], v[248:251], a[172:175], v[168:171]
    s_and_b32 s6, s2, 7
    v_mul_f32 v188, v150, v188
    v_mul_f32 v189, v150, v189
    v_mfma_f32_16x16x32_bf16 v[168:171], v[160:163], a[176:179], v[168:171]
    s_sub_u32 s6, 0, s6
    v_cvt_pk_bf16_f32 v126, v188, v189
    v_mul_f32 v190, v150, v190
    v_mfma_f32_16x16x32_bf16 v[168:171], v[136:139], a[180:183], v[168:171]
    s_lshl_b32 s3, s16, 6
    v_mul_f32 v191, v150, v191
    v_cvt_pk_bf16_f32 v127, v190, v191
    v_mfma_f32_16x16x32_bf16 v[168:171], v[116:119], a[184:187], v[168:171]
    s_lshl_b32 s4, s16, 5
    ds_read_b128 v[128:131], v0 offset:26624
    buffer_store_dwordx4 v[124:127], v15, s[48:51], 0 offen nt
    v_mul_f32 v176, v150, v176
    v_mul_f32 v177, v150, v177
    v_cvt_pk_bf16_f32 v166, v176, v177
    v_mul_f32 v178, v150, v178
    v_mfma_f32_16x16x32_bf16 v[168:171], v[172:175], a[188:191], v[168:171]
    s_add_u32 s4, s4, 256
    ds_read_b128 v[124:127], v1 offset:26624
    v_mul_f32 v179, v150, v179
    v_mfma_f32_16x16x32_bf16 v[180:183], v[232:235], a[192:195], 0
    s_mul_i32 s5, s16, 9408
    ds_read_b128 v[184:187], v0 offset:26752
    v_cvt_pk_bf16_f32 v167, v178, v179
    v_mfma_f32_16x16x32_bf16 v[180:183], v[248:251], a[196:199], v[180:183]
    s_add_u32 s5, s5, 104448
    ds_read_b128 v[176:179], v1 offset:26752
    v_cvt_pk_bf16_f32 v152, v152, v153
    v_mfma_f32_16x16x32_bf16 v[180:183], v[160:163], a[200:203], v[180:183]
    ds_read_b128 v[160:163], v0 offset:26880
    v_cvt_pk_bf16_f32 v153, v154, v155
    v_mfma_f32_16x16x32_bf16 v[180:183], v[136:139], a[204:207], v[180:183]
    ds_read_b128 v[136:139], v1 offset:26880
    v_cvt_pk_bf16_f32 v156, v168, v169
    v_mfma_f32_16x16x32_bf16 v[180:183], v[116:119], a[208:211], v[180:183]
    s_waitcnt lgkmcnt(5)
    ds_read_b128 v[116:119], v2 offset:0
    ds_read_b128 v[188:191], v2 offset:1024
    v_mfma_f32_16x16x32_bf16 v[180:183], v[172:175], a[212:215], v[180:183]
    ds_read_b128 v[172:175], v2 offset:2048
    ds_read_b128 v[192:195], v2 offset:3072
    v_mfma_f32_16x16x32_bf16 v[204:207], a[72:75], v[128:131], 0
    s_waitcnt lgkmcnt(8)
    v_rsq_f32 v151, v151
    v_mfma_f32_16x16x32_bf16 v[204:207], a[76:79], v[124:127], v[204:207]
    s_waitcnt lgkmcnt(7)
    ds_read_b128 v[220:223], v2 offset:4096
    ds_read_b128 v[224:227], v2 offset:5120
    v_mfma_f32_16x16x32_bf16 v[204:207], a[80:83], v[184:187], v[204:207]
    s_waitcnt lgkmcnt(8)
    v_mul_f32 v196, v151, v196
    v_mul_f32 v197, v151, v197
    v_mfma_f32_16x16x32_bf16 v[204:207], a[84:87], v[176:179], v[204:207]
    s_waitcnt lgkmcnt(7)
    v_cvt_pk_bf16_f32 v196, v196, v197
    v_mul_f32 v198, v151, v198
    v_mfma_f32_16x16x32_bf16 v[204:207], a[88:91], v[160:163], v[204:207]
    s_waitcnt lgkmcnt(6)
    v_mul_f32 v199, v151, v199
    v_cvt_pk_bf16_f32 v197, v198, v199
    v_mfma_f32_16x16x32_bf16 v[204:207], a[92:95], v[136:139], v[204:207]
    s_waitcnt lgkmcnt(4)
    v_mul_f32 v132, v151, v132
    v_mul_f32 v133, v151, v133
    v_mfma_f32_16x16x32_bf16 v[228:231], a[216:219], v[116:119], 0
    s_waitcnt lgkmcnt(2)
    v_cvt_pk_bf16_f32 v198, v132, v133
    v_mul_f32 v134, v151, v134
    v_mfma_f32_16x16x32_bf16 v[228:231], a[220:223], v[188:191], v[228:231]
    v_mul_f32 v135, v151, v135
    v_cvt_pk_bf16_f32 v199, v134, v135
    v_mfma_f32_16x16x32_bf16 v[228:231], a[224:227], v[172:175], v[228:231]
    s_waitcnt lgkmcnt(0)
    buffer_store_dwordx2 v[166:167], v18, s[48:51], 0 offen nt
    v_mul_f32 v212, v151, v212
    v_mul_f32 v213, v151, v213
    v_mfma_f32_16x16x32_bf16 v[228:231], a[228:231], v[192:195], v[228:231]
    v_cvt_pk_bf16_f32 v150, v212, v213
    v_mul_f32 v214, v151, v214
    v_mfma_f32_16x16x32_bf16 v[228:231], a[232:235], v[220:223], v[228:231]
    v_mul_f32 v215, v151, v215
    v_cvt_pk_bf16_f32 v151, v214, v215
    v_mfma_f32_16x16x32_bf16 v[228:231], a[236:239], v[224:227], v[228:231]
    v_rsq_f32 v166, v164
    v_mfma_f32_16x16x32_bf16 v[132:135], a[240:243], v[116:119], 0
    v_rsq_f32 v167, v165
    v_mfma_f32_16x16x32_bf16 v[132:135], a[244:247], v[188:191], v[132:135]
    v_mul_f32 v166, s31, v166
    v_cvt_pk_f16_f32 v166, v166, v167
    v_mfma_f32_16x16x32_bf16 v[132:135], a[248:251], v[172:175], v[132:135]
    v_cvt_pk_bf16_f32 v157, v170, v171
    v_fma_f32 v159, v228, v228, s33
    v_mfma_f32_16x16x32_bf16 v[132:135], a[252:255], v[192:195], v[132:135]
    v_fmac_f32 v159, v229, v229
    v_fmac_f32 v159, v230, v230
    v_mfma_f32_16x16x32_bf16 v[132:135], v[84:87], v[220:223], v[132:135]
    v_fmac_f32 v159, v231, v231
    v_cvt_pk_bf16_f32 v168, v180, v181
    v_mfma_f32_16x16x32_bf16 v[132:135], v[88:91], v[224:227], v[132:135]
    ds_read_b128 v[212:215], v2 offset:6144
    v_cvt_pk_bf16_f32 v169, v182, v183
    v_mfma_f32_16x16x32_bf16 v[180:183], v[92:95], v[116:119], 0
    ds_read_b128 v[116:119], v2 offset:7168
    v_pk_mul_f16 v120, v120, v166 op_sel:[0,1] op_sel_hi:[1,1]
    v_mfma_f32_16x16x32_bf16 v[180:183], v[96:99], v[188:191], v[180:183]
    ds_read_b128 v[188:191], v2 offset:8192
    v_pk_mul_f16 v121, v121, v166 op_sel:[0,1] op_sel_hi:[1,1]
    v_mfma_f32_16x16x32_bf16 v[180:183], v[100:103], v[172:175], v[180:183]
    ds_read_b128 v[172:175], v2 offset:9216
    v_fmac_f32 v159, v132, v132
    v_mfma_f32_16x16x32_bf16 v[180:183], v[104:107], v[192:195], v[180:183]
    ds_read_b128 v[192:195], v2 offset:10240
    v_fmac_f32 v159, v133, v133
    v_mfma_f32_16x16x32_bf16 v[180:183], v[108:111], v[220:223], v[180:183]
    ds_read_b128 v[220:223], v2 offset:11264
    v_fmac_f32 v159, v134, v134
    v_mfma_f32_16x16x32_bf16 v[180:183], v[112:115], v[224:227], v[180:183]
    v_fmac_f32 v159, v135, v135
    v_pk_mul_f16 v122, v122, v166 op_sel:[0,1] op_sel_hi:[1,1]
    v_mfma_f32_16x16x32_bf16 v[224:227], a[96:99], v[128:131], 0
    s_waitcnt lgkmcnt(5)
    buffer_store_dwordx4 v[196:199], v16, s[48:51], 0 offen nt
    v_pk_mul_f16 v123, v123, v166 op_sel:[0,1] op_sel_hi:[1,1]
    v_pk_mul_f16 v142, v142, v166 op_sel:[0,1] op_sel_hi:[1,1]
    v_pk_mul_f16 v143, v143, v166 op_sel:[0,1] op_sel_hi:[1,1]
    v_fmac_f32 v159, v180, v180
    v_mfma_f32_16x16x32_bf16 v[224:227], a[100:103], v[124:127], v[224:227]
    s_waitcnt lgkmcnt(3)
    v_fmac_f32 v159, v181, v181
    v_fmac_f32 v159, v182, v182
    v_mfma_f32_16x16x32_bf16 v[196:199], a[216:219], v[212:215], 0
    s_waitcnt lgkmcnt(2)
    v_fmac_f32 v159, v183, v183
    v_pk_mul_f16 v144, v144, v166 op_sel:[0,0] op_sel_hi:[1,0]
    v_mfma_f32_16x16x32_bf16 v[196:199], a[220:223], v[116:119], v[196:199]
    s_waitcnt lgkmcnt(1)
    v_pk_mul_f16 v145, v145, v166 op_sel:[0,0] op_sel_hi:[1,0]
    v_pk_mul_f16 v146, v146, v166 op_sel:[0,0] op_sel_hi:[1,0]
    v_mfma_f32_16x16x32_bf16 v[196:199], a[224:227], v[188:191], v[196:199]
    s_waitcnt lgkmcnt(0)
    v_pk_mul_f16 v147, v147, v166 op_sel:[0,0] op_sel_hi:[1,0]
    v_pk_mul_f16 v140, v140, v166 op_sel:[0,0] op_sel_hi:[1,0]
    v_mfma_f32_16x16x32_bf16 v[196:199], a[228:231], v[172:175], v[196:199]
    v_pk_mul_f16 v141, v141, v166 op_sel:[0,0] op_sel_hi:[1,0]
    v_min3_u32 v44, v44, v164, v165
    v_mfma_f32_16x16x32_bf16 v[196:199], a[232:235], v[192:195], v[196:199]
    v_max3_u32 v45, v45, v164, v165
    v_cvt_pk_f16_f32 v164, v204, v205
    v_mfma_f32_16x16x32_bf16 v[196:199], a[236:239], v[220:223], v[196:199]
    v_pk_mul_f16 v205, v164, v164
    v_cvt_pk_f16_f32 v165, v206, v207
    v_mfma_f32_16x16x32_bf16 v[232:235], a[240:243], v[212:215], 0
    v_pk_mul_f16 v207, v165, v165
    v_lshrrev_b32 v236, 4, v149
    v_mfma_f32_16x16x32_bf16 v[232:235], a[244:247], v[116:119], v[232:235]
    v_and_b32 v237, 15, v149
    v_add_u32 v154, 0, v237
    v_mfma_f32_16x16x32_bf16 v[232:235], a[248:251], v[188:191], v[232:235]
    v_fma_f32 v155, v196, v196, s33
    v_fmac_f32 v155, v197, v197
    v_mfma_f32_16x16x32_bf16 v[232:235], a[252:255], v[172:175], v[232:235]
    v_fmac_f32 v155, v198, v198
    v_fmac_f32 v155, v199, v199
    v_mfma_f32_16x16x32_bf16 v[232:235], v[84:87], v[192:195], v[232:235]
    v_mul_u32_u24 v166, s20, v154
    v_add_u32 v166, s38, v166
    v_mfma_f32_16x16x32_bf16 v[232:235], v[88:91], v[220:223], v[232:235]
    v_mul_u32_u24 v167, 911, v166
    v_lshrrev_b32 v167, 16, v167
    v_mfma_f32_16x16x32_bf16 v[240:243], v[92:95], v[212:215], 0
    v_mul_u32_u24 v167, s22, v167
    v_mad_u32_u24 v167, v154, s21, v167
    v_mfma_f32_16x16x32_bf16 v[240:243], v[96:99], v[116:119], v[240:243]
    v_bfe_u32 v166, s63, v154, 1
    v_cmp_ne_u32 vcc, 0, v166
    v_mfma_f32_16x16x32_bf16 v[240:243], v[100:103], v[188:191], v[240:243]
    buffer_store_dwordx2 v[150:151], v19, s[48:51], 0 offen nt
    v_fmac_f32 v155, v232, v232
    v_fmac_f32 v155, v233, v233
    v_mfma_f32_16x16x32_bf16 v[240:243], v[104:107], v[172:175], v[240:243]
    v_fmac_f32 v155, v234, v234
    v_fmac_f32 v155, v235, v235
    v_mfma_f32_16x16x32_bf16 v[240:243], v[108:111], v[192:195], v[240:243]
    v_add_u32 v154, s7, v167
    v_cndmask_b32 v154, v148, v154, vcc
    v_mfma_f32_16x16x32_bf16 v[240:243], v[112:115], v[220:223], v[240:243]
    v_lshl_add_u32 v238, v236, 4, v154
    v_add_u32 v238, s3, v238
    v_mfma_f32_16x16x32_bf16 v[224:227], a[104:107], v[184:187], v[224:227]
    v_lshl_add_u32 v239, v236, 3, v154
    v_add_u32 v239, s4, v239
    v_mfma_f32_16x16x32_bf16 v[224:227], a[108:111], v[176:179], v[224:227]
    v_lshlrev_b32 v150, 9, v236
    v_lshl_add_u32 v150, v237, 4, v150
    v_mfma_f32_16x16x32_bf16 v[224:227], a[112:115], v[160:163], v[224:227]
    v_fmac_f32 v155, v240, v240
    v_fmac_f32 v155, v241, v241
    v_mfma_f32_16x16x32_bf16 v[224:227], a[116:119], v[136:139], v[224:227]
    v_fmac_f32 v155, v242, v242
    v_fmac_f32 v155, v243, v243
    v_mfma_f32_16x16x32_bf16 v[116:119], a[120:123], v[128:131], 0
    v_cvt_pk_bf16_f32 v154, v159, v155
    v_cvt_pk_bf16_f32 v155, v155, v155
    v_mfma_f32_16x16x32_bf16 v[116:119], a[124:127], v[124:127], v[116:119]
    v_add_u32 v150, 149696, v150
    v_and_b32 v151, 0xffff, v2
    v_mfma_f32_16x16x32_bf16 v[116:119], a[128:131], v[184:187], v[116:119]
    v_cvt_pk_f16_f32 v166, v224, v225
    v_pk_fma_f16 v205, v166, v166, v205
    v_mfma_f32_16x16x32_bf16 v[116:119], a[132:135], v[176:179], v[116:119]
    v_cvt_pk_f16_f32 v167, v226, v227
    v_pk_fma_f16 v207, v167, v167, v207
    v_mfma_f32_16x16x32_bf16 v[116:119], a[136:139], v[160:163], v[116:119]
    v_add_u32 v151, 38912, v151
    v_and_b32 v172, 0xffff, v4
    v_mfma_f32_16x16x32_bf16 v[116:119], a[140:143], v[136:139], v[116:119]
    v_add_u32 v172, 38912, v172
    v_mul_f32 v158, 0x3baaaaab, v158
    v_mfma_f32_16x16x32_bf16 v[188:191], a[0:3], v[128:131], 0
    ds_write_b64 v172, v[154:155] offset:0
    v_mfma_f32_16x16x32_bf16 v[188:191], a[4:7], v[124:127], v[188:191]
    v_rsq_f32 v158, v158
    v_mfma_f32_16x16x32_bf16 v[188:191], a[8:11], v[184:187], v[188:191]
    v_mul_f32 v200, v158, v200
    v_cvt_pk_f16_f32 v194, v116, v117
    v_mfma_f32_16x16x32_bf16 v[188:191], a[12:15], v[176:179], v[188:191]
    v_pk_fma_f16 v205, v194, v194, v205
    v_cvt_pk_f16_f32 v195, v118, v119
    v_mfma_f32_16x16x32_bf16 v[188:191], a[16:19], v[160:163], v[188:191]
    v_pk_fma_f16 v207, v195, v195, v207
    v_mul_f32 v201, v158, v201
    v_mfma_f32_16x16x32_bf16 v[188:191], a[20:23], v[136:139], v[188:191]
    v_cvt_pk_bf16_f32 v116, v200, v201
    v_mul_f32 v202, v158, v202
    v_mfma_f32_16x16x32_bf16 v[212:215], a[24:27], v[128:131], 0
    v_mul_f32 v203, v158, v203
    v_cvt_pk_bf16_f32 v117, v202, v203
    v_mfma_f32_16x16x32_bf16 v[212:215], a[28:31], v[124:127], v[212:215]
    s_waitcnt lgkmcnt(0)
    v_mul_f32 v216, v158, v216
    v_cvt_pk_f16_f32 v188, v188, v189
    v_mfma_f32_16x16x32_bf16 v[212:215], a[32:35], v[184:187], v[212:215]
    s_barrier
    ds_read_b128 v[200:203], v151 offset:0
    ds_read_b128 v[220:223], v151 offset:1024
    v_mfma_f32_16x16x32_bf16 v[212:215], a[36:39], v[176:179], v[212:215]
    v_pk_mul_f16 v204, v188, v188
    v_cvt_pk_f16_f32 v189, v190, v191
    v_mfma_f32_16x16x32_bf16 v[212:215], a[40:43], v[160:163], v[212:215]
    v_pk_mul_f16 v206, v189, v189
    v_mul_f32 v217, v158, v217
    v_mfma_f32_16x16x32_bf16 v[212:215], a[44:47], v[136:139], v[212:215]
    v_cvt_pk_bf16_f32 v118, v216, v217
    v_mul_f32 v218, v158, v218
    v_mfma_f32_16x16x32_bf16 v[224:227], a[48:51], v[128:131], 0
    v_mul_f32 v219, v158, v219
    v_cvt_pk_bf16_f32 v119, v218, v219
    v_mfma_f32_16x16x32_bf16 v[224:227], a[52:55], v[124:127], v[224:227]
    buffer_store_dwordx4 v[116:119], v17, s[48:51], 0 offen nt
    v_mul_f32 v208, v158, v208
    v_cvt_pk_f16_f32 v190, v212, v213
    v_pk_fma_f16 v204, v190, v190, v204
    v_cvt_pk_f16_f32 v191, v214, v215
    v_mfma_f32_16x16x32_bf16 v[224:227], a[56:59], v[184:187], v[224:227]
    s_waitcnt lgkmcnt(0)
    v_pk_fma_f16 v206, v191, v191, v206
    v_mul_f32 v209, v158, v209
    v_mfma_f32_16x16x32_bf16 v[116:119], v[32:35], v[200:203], 0
    v_cvt_pk_bf16_f32 v174, v208, v209
    v_mul_f32 v210, v158, v210
    v_mfma_f32_16x16x32_bf16 v[116:119], v[32:35], v[220:223], v[116:119]
    v_mul_f32 v211, v158, v211
    v_cvt_pk_bf16_f32 v175, v210, v211
    v_mfma_f32_16x16x32_bf16 v[224:227], a[60:63], v[176:179], v[224:227]
    v_add_u32 v173, 16, v237
    v_min_u32 v200, 20, v173
    v_mfma_f32_16x16x32_bf16 v[224:227], a[64:67], v[160:163], v[224:227]
    v_add_u32 v201, 12, v173
    v_lshrrev_b32 v201, 5, v201
    v_mfma_f32_16x16x32_bf16 v[224:227], a[68:71], v[136:139], v[224:227]
    v_mul_f32 v154, 0x3baaaaab, v117
    v_mul_f32 v155, 0x3baaaaab, v116
    v_mfma_f32_16x16x32_bf16 v[116:119], v[128:131], a[144:147], 0
    v_rsq_f32 v154, v154
    v_mfma_f32_16x16x32_bf16 v[116:119], v[124:127], a[148:151], v[116:119]
    v_mul_f32 v196, v154, v196
    v_mul_f32 v197, v154, v197
    v_mfma_f32_16x16x32_bf16 v[116:119], v[184:187], a[152:155], v[116:119]
    v_cvt_pk_bf16_f32 v196, v196, v197
    v_mul_f32 v198, v154, v198
    v_mfma_f32_16x16x32_bf16 v[116:119], v[176:179], a[156:159], v[116:119]
    v_mul_f32 v199, v154, v199
    v_cvt_pk_bf16_f32 v197, v198, v199
    v_mfma_f32_16x16x32_bf16 v[116:119], v[160:163], a[160:163], v[116:119]
    v_mul_f32 v232, v154, v232
    v_mul_f32 v233, v154, v233
    v_mfma_f32_16x16x32_bf16 v[116:119], v[136:139], a[164:167], v[116:119]
    v_cvt_pk_bf16_f32 v198, v232, v233
    v_mul_f32 v234, v154, v234
    v_mfma_f32_16x16x32_bf16 v[208:211], v[128:131], a[168:171], 0
    v_mul_f32 v235, v154, v235
    v_cvt_pk_bf16_f32 v199, v234, v235
    v_mfma_f32_16x16x32_bf16 v[208:211], v[124:127], a[172:175], v[208:211]
    v_mul_f32 v240, v154, v240
    v_mul_f32 v241, v154, v241
    v_mfma_f32_16x16x32_bf16 v[208:211], v[184:187], a[176:179], v[208:211]
    v_cvt_pk_bf16_f32 v170, v240, v241
    v_mul_f32 v242, v154, v242
    v_mfma_f32_16x16x32_bf16 v[208:211], v[176:179], a[180:183], v[208:211]
    buffer_store_dwordx4 v[196:199], v16, s[52:55], 0 offen nt
    v_mul_f32 v243, v154, v243
    v_cvt_pk_bf16_f32 v171, v242, v243
    v_rsq_f32 v155, v155
    v_mfma_f32_16x16x32_bf16 v[208:211], v[160:163], a[184:187], v[208:211]
    ds_read_b128 v[196:199], v0 offset:32768
    v_mul_f32 v228, v155, v228
    v_mfma_f32_16x16x32_bf16 v[208:211], v[136:139], a[188:191], v[208:211]
    ds_read_b128 v[212:215], v1 offset:32768
    v_mul_f32 v229, v155, v229
    v_mfma_f32_16x16x32_bf16 v[216:219], v[128:131], a[192:195], 0
    ds_read_b128 v[128:131], v0 offset:32896
    v_cvt_pk_bf16_f32 v220, v228, v229
    v_mfma_f32_16x16x32_bf16 v[216:219], v[124:127], a[196:199], v[216:219]
    ds_read_b128 v[124:127], v1 offset:32896
    v_mul_f32 v230, v155, v230
    v_mfma_f32_16x16x32_bf16 v[216:219], v[184:187], a[200:203], v[216:219]
    ds_read_b128 v[184:187], v0 offset:33024
    v_mul_f32 v231, v155, v231
    v_mfma_f32_16x16x32_bf16 v[216:219], v[176:179], a[204:207], v[216:219]
    ds_read_b128 v[176:179], v1 offset:33024
    v_cvt_pk_bf16_f32 v221, v230, v231
    v_mfma_f32_16x16x32_bf16 v[216:219], v[160:163], a[208:211], v[216:219]
    v_mul_f32 v132, v155, v132
    v_mul_f32 v133, v155, v133
    v_mfma_f32_16x16x32_bf16 v[216:219], v[136:139], a[212:215], v[216:219]
    s_waitcnt lgkmcnt(5)
    v_cvt_pk_bf16_f32 v222, v132, v133
    v_mul_f32 v134, v155, v134
    v_mfma_f32_16x16x32_bf16 v[136:139], a[72:75], v[196:199], 0
    s_waitcnt lgkmcnt(4)
    v_mul_f32 v135, v155, v135
    v_cvt_pk_bf16_f32 v223, v134, v135
    v_mfma_f32_16x16x32_bf16 v[136:139], a[76:79], v[212:215], v[136:139]
    s_waitcnt lgkmcnt(3)
    v_mul_f32 v180, v155, v180
    v_mul_f32 v181, v155, v181
    v_mfma_f32_16x16x32_bf16 v[136:139], a[80:83], v[128:131], v[136:139]
    s_waitcnt lgkmcnt(2)
    v_cvt_pk_bf16_f32 v202, v180, v181
    v_mul_f32 v182, v155, v182
    v_mfma_f32_16x16x32_bf16 v[136:139], a[84:87], v[124:127], v[136:139]
    s_waitcnt lgkmcnt(1)
    v_mul_f32 v183, v155, v183
    v_cvt_pk_bf16_f32 v203, v182, v183
    v_mfma_f32_16x16x32_bf16 v[136:139], a[88:91], v[184:187], v[136:139]
    s_waitcnt lgkmcnt(0)
    v_cvt_pk_bf16_f32 v154, v116, v117
    v_cvt_pk_bf16_f32 v155, v118, v119
    v_mfma_f32_16x16x32_bf16 v[136:139], a[92:95], v[176:179], v[136:139]
    v_cvt_pk_f16_f32 v192, v224, v225
    v_pk_fma_f16 v204, v192, v192, v204
    v_mfma_f32_16x16x32_bf16 v[116:119], a[96:99], v[196:199], 0
    v_cvt_pk_f16_f32 v193, v226, v227
    v_pk_fma_f16 v206, v193, v193, v206
    v_mfma_f32_16x16x32_bf16 v[116:119], a[100:103], v[212:215], v[116:119]
    buffer_store_dwordx2 v[170:171], v19, s[52:55], 0 offen nt
    v_cvt_pk_bf16_f32 v158, v208, v209
    v_cvt_pk_bf16_f32 v159, v210, v211
    v_mfma_f32_16x16x32_f16 v[132:135], v[40:43], v[204:207], 0
    v_cvt_pk_bf16_f32 v170, v216, v217
    v_cvt_pk_bf16_f32 v171, v218, v219
    v_mfma_f32_16x16x32_bf16 v[116:119], a[104:107], v[128:131], v[116:119]
    v_cvt_pk_f16_f32 v136, v136, v137
    v_pk_mul_f16 v161, v136, v136
    v_mfma_f32_16x16x32_bf16 v[116:119], a[108:111], v[124:127], v[116:119]
    ds_read_b128 v[180:183], v5 offset:0
    ds_read_b128 v[204:207], v5 offset:16
    v_mfma_f32_16x16x32_bf16 v[116:119], a[112:115], v[184:187], v[116:119]
    ds_read_b128 v[208:211], v5 offset:48
    ds_read_b32 v216, v6 offset:192
    v_mfma_f32_16x16x32_bf16 v[116:119], a[116:119], v[176:179], v[116:119]
    v_rsq_f32 v134, v132
    v_mfma_f32_16x16x32_bf16 v[224:227], a[120:123], v[196:199], 0
    v_rsq_f32 v135, v133
    v_mfma_f32_16x16x32_bf16 v[224:227], a[124:127], v[212:215], v[224:227]
    v_mul_f32 v134, s31, v134
    v_cvt_pk_f16_f32 v134, v134, v135
    v_mfma_f32_16x16x32_bf16 v[224:227], a[128:131], v[128:131], v[224:227]
    v_pk_mul_f16 v164, v164, v134 op_sel:[0,1] op_sel_hi:[1,1]
    v_pk_mul_f16 v165, v165, v134 op_sel:[0,1] op_sel_hi:[1,1]
    v_mfma_f32_16x16x32_bf16 v[224:227], a[132:135], v[124:127], v[224:227]
    v_pk_mul_f16 v166, v166, v134 op_sel:[0,1] op_sel_hi:[1,1]
    v_pk_mul_f16 v167, v167, v134 op_sel:[0,1] op_sel_hi:[1,1]
    v_mfma_f32_16x16x32_bf16 v[224:227], a[136:139], v[184:187], v[224:227]
    s_waitcnt lgkmcnt(2)
    v_pk_mul_f16 v194, v194, v134 op_sel:[0,1] op_sel_hi:[1,1]
    v_pk_mul_f16 v195, v195, v134 op_sel:[0,1] op_sel_hi:[1,1]
    v_mfma_f32_16x16x32_bf16 v[224:227], a[140:143], v[176:179], v[224:227]
    s_waitcnt lgkmcnt(0)
    v_pk_mul_f16 v188, v188, v134 op_sel:[0,0] op_sel_hi:[1,0]
    v_pk_mul_f16 v189, v189, v134 op_sel:[0,0] op_sel_hi:[1,0]
    v_mfma_f32_16x16x32_bf16 v[228:231], a[0:3], v[196:199], 0
    v_pk_mul_f16 v190, v190, v134 op_sel:[0,0] op_sel_hi:[1,0]
    v_pk_mul_f16 v191, v191, v134 op_sel:[0,0] op_sel_hi:[1,0]
    v_mfma_f32_16x16x32_bf16 v[228:231], a[4:7], v[212:215], v[228:231]
    v_pk_mul_f16 v192, v192, v134 op_sel:[0,0] op_sel_hi:[1,0]
    v_pk_mul_f16 v193, v193, v134 op_sel:[0,0] op_sel_hi:[1,0]
    v_mfma_f32_16x16x32_bf16 v[228:231], a[8:11], v[128:131], v[228:231]
    v_min3_u32 v44, v44, v132, v133
    v_max3_u32 v45, v45, v132, v133
    v_mfma_f32_16x16x32_bf16 v[228:231], a[12:15], v[124:127], v[228:231]
    v_cvt_pk_f16_f32 v137, v138, v139
    v_pk_mul_f16 v163, v137, v137
    v_mfma_f32_16x16x32_bf16 v[228:231], a[16:19], v[184:187], v[228:231]
    buffer_store_dwordx4 v[220:223], v15, s[52:55], 0 offen nt
    v_cvt_pk_f16_f32 v138, v116, v117
    v_pk_fma_f16 v161, v138, v138, v161
    v_cvt_pk_f16_f32 v139, v118, v119
    v_pk_fma_f16 v163, v139, v139, v163
    v_mfma_f32_16x16x32_bf16 v[228:231], a[20:23], v[176:179], v[228:231]
    v_cvt_pk_f16_f32 v134, v224, v225
    v_pk_fma_f16 v161, v134, v134, v161
    v_mfma_f32_16x16x32_bf16 v[116:119], a[24:27], v[196:199], 0
    v_cvt_pk_f16_f32 v135, v226, v227
    v_pk_fma_f16 v163, v135, v135, v163
    v_mfma_f32_16x16x32_bf16 v[116:119], a[28:31], v[212:215], v[116:119]
    v_sub_u32 v132, v173, v200
    v_mad_i32_i24 v132, v201, s6, v132
    v_mfma_f32_16x16x32_bf16 v[116:119], a[32:35], v[128:131], v[116:119]
    v_cvt_pk_f16_f32 v220, v228, v229
    v_pk_mul_f16 v160, v220, v220
    v_mfma_f32_16x16x32_bf16 v[116:119], a[36:39], v[124:127], v[116:119]
    v_cvt_pk_f16_f32 v221, v230, v231
    v_pk_mul_f16 v162, v221, v221
    v_mfma_f32_16x16x32_bf16 v[116:119], a[40:43], v[184:187], v[116:119]
    ds_read2_b32 v[226:227], v6 offset0:0 offset1:0
    ds_read2_b32 v[230:231], v6 offset0:16 offset1:16
    v_mfma_f32_16x16x32_bf16 v[116:119], a[44:47], v[176:179], v[116:119]
    ds_read2_b32 v[218:219], v6 offset0:32 offset1:32
    v_mul_u32_u24 v133, s20, v200
    v_mfma_f32_16x16x32_bf16 v[232:235], a[48:51], v[196:199], 0
    v_add3_u32 v133, v133, v132, s38
    v_mul_u32_u24 v201, 911, v133
    v_mfma_f32_16x16x32_bf16 v[232:235], a[52:55], v[212:215], v[232:235]
    v_lshrrev_b32 v201, 16, v201
    v_mul_u32_u24 v201, s22, v201
    v_mfma_f32_16x16x32_bf16 v[232:235], a[56:59], v[128:131], v[232:235]
    v_cvt_pk_f16_f32 v222, v116, v117
    v_pk_fma_f16 v160, v222, v222, v160
    v_mfma_f32_16x16x32_bf16 v[232:235], a[60:63], v[124:127], v[232:235]
    v_cvt_pk_f16_f32 v223, v118, v119
    v_pk_fma_f16 v162, v223, v223, v162
    v_mfma_f32_16x16x32_bf16 v[232:235], a[64:67], v[184:187], v[232:235]
    v_mad_u32_u24 v201, v200, s21, v201
    v_bfe_u32 v133, s63, v173, 1
    v_mfma_f32_16x16x32_bf16 v[232:235], a[68:71], v[176:179], v[232:235]
    s_waitcnt lgkmcnt(1)
    v_cmp_ne_u32 vcc, 0, v133
    v_mul_i32_i24 v132, 2688, v132
    v_mfma_f32_16x16x32_f16 v[116:119], v[180:183], v[144:147], v[22:25]
    s_waitcnt lgkmcnt(0)
    v_add3_u32 v173, v201, v132, s7
    v_cndmask_b32 v173, v148, v173, vcc
    v_mfma_f32_16x16x32_f16 v[116:119], v[204:207], v[120:123], v[116:119]
    v_cvt_pk_f16_f32 v132, v232, v233
    v_pk_fma_f16 v160, v132, v132, v160
    v_mfma_f32_16x16x32_f16 v[116:119], v[208:211], v[140:143], v[116:119]
    buffer_store_dwordx2 v[202:203], v18, s[52:55], 0 offen nt
    v_cvt_pk_f16_f32 v133, v234, v235
    v_pk_fma_f16 v162, v133, v133, v162
    v_mfma_f32_16x16x32_bf16 v[232:235], v[196:199], a[144:147], 0
    v_lshl_add_u32 v148, v236, 4, v173
    v_add_u32 v148, s3, v148
    v_mfma_f32_16x16x32_f16 v[200:203], v[40:43], v[160:163], 0
    v_lshl_add_u32 v173, v236, 3, v173
    v_add_u32 v173, s4, v173
    v_mfma_f32_16x16x32_f16 v[160:163], v[180:183], v[188:191], v[24:27]
    v_mov_b32_dpp v216, v117 quad_perm:[0,1,2,3] row_mask:0x1 bank_mask:0xf
    v_xor_b32 v117, 65536, v2
    v_mfma_f32_16x16x32_f16 v[160:163], v[204:207], v[164:167], v[160:163]
    v_exp_f32 v116, v116
    v_mfma_f32_16x16x32_f16 v[160:163], v[208:211], v[192:195], v[160:163]
    v_rsq_f32 v202, v200
    v_mfma_f32_16x16x32_bf16 v[232:235], v[212:215], a[148:151], v[232:235]
    v_rsq_f32 v203, v201
    v_mfma_f32_16x16x32_bf16 v[232:235], v[128:131], a[152:155], v[232:235]
    v_mul_f32 v202, s31, v202
    v_cvt_pk_f16_f32 v202, v202, v203
    v_mfma_f32_16x16x32_bf16 v[232:235], v[124:127], a[156:159], v[232:235]
    v_pk_mul_f16 v136, v136, v202 op_sel:[0,1] op_sel_hi:[1,1]
    v_pk_mul_f16 v137, v137, v202 op_sel:[0,1] op_sel_hi:[1,1]
    v_mfma_f32_16x16x32_f16 v[240:243], v[120:123], v[144:147], v[48:51]
    v_pk_mul_f16 v138, v138, v202 op_sel:[0,1] op_sel_hi:[1,1]
    v_pk_mul_f16 v139, v139, v202 op_sel:[0,1] op_sel_hi:[1,1]
    v_mfma_f32_16x16x32_f16 v[244:247], v[164:167], v[144:147], v[52:55]
    v_pk_mul_f16 v134, v134, v202 op_sel:[0,1] op_sel_hi:[1,1]
    v_pk_mul_f16 v135, v135, v202 op_sel:[0,1] op_sel_hi:[1,1]
    v_mfma_f32_16x16x32_f16 v[248:251], v[136:139], v[144:147], v[56:59]
    v_pk_mul_f16 v220, v220, v202 op_sel:[0,0] op_sel_hi:[1,0]
    v_pk_mul_f16 v221, v221, v202 op_sel:[0,0] op_sel_hi:[1,0]
    v_pk_mul_f16 v222, v222, v202 op_sel:[0,0] op_sel_hi:[1,0]
    v_mfma_f32_16x16x16_f16 v[240:243], v[142:143], v[140:141], v[240:243]
    v_pk_mul_f16 v223, v223, v202 op_sel:[0,0] op_sel_hi:[1,0]
    v_pk_mul_f16 v132, v132, v202 op_sel:[0,0] op_sel_hi:[1,0]
    v_pk_mul_f16 v133, v133, v202 op_sel:[0,0] op_sel_hi:[1,0]
    v_min3_u32 v44, v44, v200, v201
    v_mfma_f32_16x16x32_f16 v[144:147], v[180:183], v[220:223], v[26:29]
    v_max3_u32 v45, v45, v200, v201
    v_mov_b32_dpp v216, v161 quad_perm:[0,1,2,3] row_mask:0x2 bank_mask:0xf
    v_mfma_f32_16x16x32_f16 v[144:147], v[204:207], v[136:139], v[144:147]
    v_exp_f32 v240, v240
    v_mfma_f32_16x16x32_f16 v[144:147], v[208:211], v[132:135], v[144:147]
    v_exp_f32 v241, v241
    v_cvt_pk_bf16_f32 v39, v116, 0
    v_mfma_f32_16x16x16_f16 v[244:247], v[194:195], v[140:141], v[244:247]
    v_cvt_pk_bf16_f32 v180, v240, v241
    v_exp_f32 v242, v242
    v_mfma_f32_16x16x16_f16 v[248:251], v[134:135], v[140:141], v[248:251]
    v_exp_f32 v243, v243
    v_subrev_u32 v217, 0x3d800000, v44
    v_mov_b32_dpp v216, v145 quad_perm:[0,1,2,3] row_mask:0x4 bank_mask:0xf
    v_mfma_f32_16x16x32_bf16 v[232:235], v[184:187], a[160:163], v[232:235]
    buffer_store_dwordx2 v[174:175], v20, s[48:51], 0 offen nt
    v_cvt_pk_bf16_f32 v181, v242, v243
    v_sub_u32 v140, 0x4a000000, v45
    v_mfma_f32_16x16x32_bf16 v[232:235], v[176:179], a[164:167], v[232:235]
    v_exp_f32 v244, v244
    v_mfma_f32_16x16x32_bf16 v[200:203], v[196:199], a[168:171], 0
    v_exp_f32 v245, v245
    v_mfma_f32_16x16x32_bf16 v[200:203], v[212:215], a[172:175], v[200:203]
    v_cvt_pk_bf16_f32 v182, v244, v245
    v_or3_b32 v217, v217, v140, v45
    v_mfma_f32_16x16x32_bf16 v[200:203], v[128:131], a[176:179], v[200:203]
    v_exp_f32 v246, v246
    v_mfma_f32_16x16x32_bf16 v[200:203], v[124:127], a[180:183], v[200:203]
    v_cvt_pk_bf16_f32 v224, v232, v233
    v_cvt_pk_bf16_f32 v225, v234, v235
    v_mfma_f32_16x16x32_bf16 v[200:203], v[184:187], a[184:187], v[200:203]
    v_exp_f32 v247, v247
    v_mfma_f32_16x16x32_bf16 v[200:203], v[176:179], a[188:191], v[200:203]
    ds_read_b128 v[204:207], v2 offset:12288
    ds_read_b128 v[208:211], v2 offset:13312
    v_mfma_f32_16x16x32_bf16 v[232:235], v[196:199], a[192:195], 0
    ds_read_b128 v[196:199], v2 offset:14336
    ds_read_b128 v[240:243], v2 offset:15360
    v_mfma_f32_16x16x32_bf16 v[232:235], v[212:215], a[196:199], v[232:235]
    v_cvt_pk_bf16_f32 v183, v246, v247
    v_lshl_add_u32 v140, s16, 2, v117
    v_mfma_f32_16x16x32_f16 v[212:215], v[120:123], v[188:191], v[60:63]
    ds_read_b128 v[244:247], v2 offset:16384
    ds_read_b128 v[252:255], v2 offset:17408
    v_mfma_f32_16x16x32_bf16 v[232:235], v[128:131], a[200:203], v[232:235]
    v_cvt_pk_bf16_f32 v228, v200, v201
    v_cvt_pk_bf16_f32 v229, v202, v203
    v_mfma_f32_16x16x32_f16 v[128:131], v[164:167], v[188:191], v[64:67]
    ds_write_b32 v140, v217 offset:18432
    v_bfe_u32 v140, v237, 1, 2
    v_mfma_f32_16x16x16_f16 v[212:215], v[142:143], v[192:193], v[212:215]
    v_exp_f32 v248, v248
    v_exp_f32 v249, v249
    v_mfma_f32_16x16x32_bf16 v[232:235], v[124:127], a[204:207], v[232:235]
    s_waitcnt lgkmcnt(4)
    v_cvt_pk_bf16_f32 v36, v248, v249
    v_xor_b32 v140, v140, v236
    v_mfma_f32_16x16x32_f16 v[124:127], v[136:139], v[188:191], v[68:71]
    s_waitcnt lgkmcnt(3)
    v_exp_f32 v250, v250
    v_lshl_add_u32 v140, v237, 2, v140
    v_mfma_f32_16x16x16_f16 v[128:131], v[194:195], v[192:193], v[128:131]
    v_exp_f32 v251, v251
    v_exp_f32 v216, v216
    v_mfma_f32_16x16x16_f16 v[124:127], v[134:135], v[192:193], v[124:127]
    v_cvt_pk_bf16_f32 v37, v250, v251
    v_cvt_pk_bf16_f32 v216, v216, v216
    v_exp_f32 v144, v144
    v_mfma_f32_16x16x32_bf16 v[188:191], v[28:31], v[36:39], 0
    s_waitcnt lgkmcnt(0)
    ds_write_b16 v8, v216
    v_mfma_f32_16x16x32_bf16 v[188:191], v[28:31], v[180:183], v[188:191]
    v_exp_f32 v212, v212
    v_mfma_f32_16x16x32_bf16 v[200:203], v[224:227], v[36:39], 0
    v_exp_f32 v213, v213
    v_mfma_f32_16x16x32_bf16 v[200:203], v[152:155], v[180:183], v[200:203]
    v_cvt_pk_bf16_f32 v212, v212, v213
    v_lshl_add_u32 v174, v140, 4, s5
    v_mfma_f32_16x16x32_bf16 v[248:251], v[228:231], v[36:39], 0
    v_exp_f32 v214, v214
    v_mfma_f32_16x16x32_bf16 v[248:251], v[156:159], v[180:183], v[248:251]
    v_rcp_f32 v188, v188
    v_mfma_f32_16x16x32_bf16 v[232:235], v[184:187], a[208:211], v[232:235]
    v_exp_f32 v215, v215
    v_mfma_f32_16x16x32_bf16 v[232:235], v[176:179], a[212:215], v[232:235]
    v_mul_f32 v200, v188, v200
    v_mul_f32 v201, v188, v201
    v_mfma_f32_16x16x32_bf16 v[176:179], a[216:219], v[204:207], 0
    v_cvt_pk_bf16_f32 v184, v200, v201
    v_mul_f32 v202, v188, v202
    v_mfma_f32_16x16x32_bf16 v[176:179], a[220:223], v[208:211], v[176:179]
    v_mul_f32 v203, v188, v203
    v_cvt_pk_bf16_f32 v185, v202, v203
    v_mfma_f32_16x16x32_bf16 v[176:179], a[224:227], v[196:199], v[176:179]
    v_cvt_pk_bf16_f32 v216, v232, v233
    v_cvt_pk_bf16_f32 v217, v234, v235
    v_mfma_f32_16x16x32_bf16 v[176:179], a[228:231], v[240:243], v[176:179]
    v_mul_f32 v248, v188, v248
    v_mul_f32 v249, v188, v249
    v_mfma_f32_16x16x32_bf16 v[200:203], v[216:219], v[36:39], 0
    v_cvt_pk_bf16_f32 v186, v248, v249
    v_mul_f32 v250, v188, v250
    v_mfma_f32_16x16x32_bf16 v[200:203], v[168:171], v[180:183], v[200:203]
    v_mul_f32 v251, v188, v251
    v_cvt_pk_bf16_f32 v187, v250, v251
    v_mfma_f32_16x16x32_bf16 v[176:179], a[232:235], v[244:247], v[176:179]
    ds_write_b128 v3, v[184:187] offset:0
    v_mfma_f32_16x16x32_bf16 v[176:179], a[236:239], v[252:255], v[176:179]
    v_cvt_pk_bf16_f32 v213, v214, v215
    v_lshl_add_u32 v175, v140, 3, s5
    v_mfma_f32_16x16x32_bf16 v[180:183], a[240:243], v[204:207], 0
    v_mul_f32 v200, v188, v200
    v_mul_f32 v201, v188, v201
    v_mfma_f32_16x16x32_bf16 v[180:183], a[244:247], v[208:211], v[180:183]
    v_cvt_pk_bf16_f32 v192, v200, v201
    v_mul_f32 v202, v188, v202
    v_mfma_f32_16x16x32_bf16 v[180:183], a[248:251], v[196:199], v[180:183]
    v_fma_f32 v236, v176, v176, s33
    v_fmac_f32 v236, v177, v177
    v_mfma_f32_16x16x32_bf16 v[180:183], a[252:255], v[240:243], v[180:183]
    v_fmac_f32 v236, v178, v178
    v_fmac_f32 v236, v179, v179
    v_mfma_f32_16x16x32_bf16 v[180:183], v[84:87], v[244:247], v[180:183]
    v_mul_f32 v203, v188, v203
    v_cvt_pk_bf16_f32 v193, v202, v203
    v_mfma_f32_16x16x32_bf16 v[180:183], v[88:91], v[252:255], v[180:183]
    ds_read_b128 v[184:187], v150 offset:0
    v_lshl_add_u32 v237, v149, 4, s5
    v_mfma_f32_16x16x32_bf16 v[188:191], v[92:95], v[204:207], 0
    ds_read_b128 v[200:203], v150 offset:2048
    v_lshl_add_u32 v149, v149, 3, s5
    v_mfma_f32_16x16x32_bf16 v[188:191], v[96:99], v[208:211], v[188:191]
    ds_read_b128 v[204:207], v150 offset:4096
    v_lshlrev_b32 v140, 2, v140
    v_mfma_f32_16x16x32_bf16 v[188:191], v[100:103], v[196:199], v[188:191]
    ds_read_b128 v[196:199], v150 offset:6144
    ds_permute_b32 v116, v140, v15
    v_mfma_f32_16x16x32_bf16 v[188:191], v[104:107], v[240:243], v[188:191]
    ds_read_b128 v[208:211], v150 offset:8192
    ds_permute_b32 v118, v140, v18
    v_mfma_f32_16x16x32_bf16 v[188:191], v[108:111], v[244:247], v[188:191]
    ds_read_b128 v[232:235], v150 offset:10240
    ds_permute_b32 v119, v140, v17
    v_mfma_f32_16x16x32_bf16 v[188:191], v[112:115], v[252:255], v[188:191]
    ds_write_b64 v4, v[192:193] offset:4096
    s_waitcnt lgkmcnt(9)
    v_mfma_f32_16x16x32_bf16 v[240:243], a[216:219], v[184:187], 0
    s_waitcnt lgkmcnt(8)
    v_exp_f32 v128, v128
    v_mfma_f32_16x16x32_f16 v[244:247], v[120:123], v[220:223], v[72:75]
    s_waitcnt lgkmcnt(7)
    ds_permute_b32 v192, v140, v20
    v_fmac_f32 v236, v180, v180
    v_mfma_f32_16x16x32_bf16 v[240:243], a[220:223], v[200:203], v[240:243]
    s_waitcnt lgkmcnt(7)
    v_exp_f32 v129, v129
    v_fmac_f32 v236, v181, v181
    v_mfma_f32_16x16x16_f16 v[244:247], v[142:143], v[132:133], v[244:247]
    v_fmac_f32 v236, v182, v182
    v_fmac_f32 v236, v183, v183
    v_fmac_f32 v236, v188, v188
    v_fmac_f32 v236, v189, v189
    v_mfma_f32_16x16x32_bf16 v[240:243], a[224:227], v[204:207], v[240:243]
    s_waitcnt lgkmcnt(2)
    v_fmac_f32 v236, v190, v190
    v_fmac_f32 v236, v191, v191
    v_mfma_f32_16x16x32_bf16 v[240:243], a[228:231], v[196:199], v[240:243]
    v_exp_f32 v244, v244
    v_mfma_f32_16x16x32_bf16 v[240:243], a[232:235], v[208:211], v[240:243]
    v_exp_f32 v245, v245
    v_mfma_f32_16x16x32_bf16 v[240:243], a[236:239], v[232:235], v[240:243]
    s_waitcnt lgkmcnt(0)
    v_cvt_pk_bf16_f32 v120, v244, v245
    v_cvt_pk_bf16_f32 v214, v128, v129
    v_mfma_f32_16x16x32_bf16 v[140:143], a[240:243], v[184:187], 0
    v_exp_f32 v246, v246
    v_mfma_f32_16x16x32_bf16 v[140:143], a[244:247], v[200:203], v[140:143]
    v_exp_f32 v247, v247
    v_mfma_f32_16x16x32_bf16 v[140:143], a[248:251], v[204:207], v[140:143]
    v_fma_f32 v123, v240, v240, s33
    v_fmac_f32 v123, v241, v241
    v_mfma_f32_16x16x32_bf16 v[140:143], a[252:255], v[196:199], v[140:143]
    v_fmac_f32 v123, v242, v242
    v_fmac_f32 v123, v243, v243
    v_mfma_f32_16x16x32_bf16 v[140:143], v[84:87], v[208:211], v[140:143]
    v_exp_f32 v130, v130
    v_mfma_f32_16x16x32_bf16 v[140:143], v[88:91], v[232:235], v[140:143]
    v_exp_f32 v131, v131
    v_mfma_f32_16x16x32_bf16 v[248:251], v[92:95], v[184:187], 0
    v_cvt_pk_bf16_f32 v121, v246, v247
    v_cvt_pk_bf16_f32 v215, v130, v131
    v_mfma_f32_16x16x32_bf16 v[248:251], v[96:99], v[200:203], v[248:251]
    v_exp_f32 v124, v124
    v_mfma_f32_16x16x32_f16 v[128:131], v[164:167], v[220:223], v[76:79]
    v_exp_f32 v125, v125
    v_mfma_f32_16x16x32_bf16 v[248:251], v[100:103], v[204:207], v[248:251]
    v_fmac_f32 v123, v140, v140
    v_fmac_f32 v123, v141, v141
    v_mfma_f32_16x16x32_bf16 v[248:251], v[104:107], v[196:199], v[248:251]
    v_fmac_f32 v123, v142, v142
    v_fmac_f32 v123, v143, v143
    v_cvt_pk_bf16_f32 v36, v124, v125
    v_mfma_f32_16x16x16_f16 v[128:131], v[194:195], v[132:133], v[128:131]
    v_exp_f32 v126, v126
    v_exp_f32 v127, v127
    v_mfma_f32_16x16x32_f16 v[164:167], v[136:139], v[220:223], v[80:83]
    v_exp_f32 v160, v160
    v_mfma_f32_16x16x32_bf16 v[248:251], v[108:111], v[208:211], v[248:251]
    v_cvt_pk_bf16_f32 v37, v126, v127
    v_cvt_pk_bf16_f32 v39, v160, 0
    v_mfma_f32_16x16x32_bf16 v[248:251], v[112:115], v[232:235], v[248:251]
    v_exp_f32 v128, v128
    v_mfma_f32_16x16x16_f16 v[164:167], v[134:135], v[132:133], v[164:167]
    v_exp_f32 v129, v129
    v_exp_f32 v130, v130
    v_mfma_f32_16x16x32_bf16 v[124:127], v[28:31], v[36:39], 0
    v_exp_f32 v131, v131
    v_mfma_f32_16x16x32_bf16 v[124:127], v[28:31], v[212:215], v[124:127]
    v_cvt_pk_bf16_f32 v122, v128, v129
    v_fmac_f32 v123, v248, v248
    v_mfma_f32_16x16x32_bf16 v[132:135], v[224:227], v[36:39], 0
    v_fmac_f32 v123, v249, v249
    v_fmac_f32 v123, v250, v250
    v_mfma_f32_16x16x32_bf16 v[132:135], v[152:155], v[212:215], v[132:135]
    v_fmac_f32 v123, v251, v251
    v_cvt_pk_bf16_f32 v128, v236, v123
    v_mfma_f32_16x16x32_bf16 v[136:139], v[228:231], v[36:39], 0
    v_cvt_pk_bf16_f32 v129, v123, v123
    v_cvt_pk_bf16_f32 v123, v130, v131
    v_mfma_f32_16x16x32_bf16 v[136:139], v[156:159], v[212:215], v[136:139]
    ds_write_b64 v172, v[128:129] offset:2048
    v_mfma_f32_16x16x32_bf16 v[128:131], v[216:219], v[36:39], 0
    v_exp_f32 v164, v164
    v_mfma_f32_16x16x32_bf16 v[128:131], v[168:171], v[212:215], v[128:131]
    v_exp_f32 v165, v165
    v_exp_f32 v166, v166
    v_cvt_pk_bf16_f32 v36, v164, v165
    v_exp_f32 v167, v167
    ds_read_b128 v[160:163], v9
    ds_read_b128 v[184:187], v9 offset:64
    v_cvt_pk_bf16_f32 v37, v166, v167
    v_cvt_pk_bf16_f32 v39, v144, 0
    v_rcp_f32 v124, v124
    s_nop 0
    v_mfma_f32_16x16x32_bf16 v[144:147], v[28:31], v[36:39], 0
    s_waitcnt lgkmcnt(2)
    v_mul_f32 v132, v124, v132
    v_mul_f32 v133, v124, v133
    v_mfma_f32_16x16x32_bf16 v[144:147], v[28:31], v[120:123], v[144:147]
    s_barrier
    ds_read_b128 v[164:167], v151 offset:2048
    ds_read_b128 v[196:199], v151 offset:3072
    v_mfma_f32_16x16x32_bf16 v[200:203], v[224:227], v[36:39], 0
    s_barrier
    ds_read_b128 v[204:207], v117 offset:0
    ds_read_b128 v[208:211], v117 offset:1024
    v_mfma_f32_16x16x32_bf16 v[200:203], v[152:155], v[120:123], v[200:203]
    v_cvt_pk_bf16_f32 v132, v132, v133
    v_mul_f32 v134, v124, v134
    v_mfma_f32_16x16x32_bf16 v[212:215], v[228:231], v[36:39], 0
    ds_read_b128 v[220:223], v117 offset:2048
    ds_read_b128 v[232:235], v117 offset:3072
    v_mfma_f32_16x16x32_bf16 v[212:215], v[156:159], v[120:123], v[212:215]
    s_waitcnt lgkmcnt(6)
    v_mul_f32 v135, v124, v135
    v_cvt_pk_bf16_f32 v133, v134, v135
    v_mfma_f32_16x16x32_bf16 v[244:247], v[216:219], v[36:39], 0
    v_mul_f32 v136, v124, v136
    v_mul_f32 v137, v124, v137
    v_mfma_f32_16x16x32_bf16 v[244:247], v[168:171], v[120:123], v[244:247]
    ds_read_b128 v[120:123], v117 offset:4096
    v_cvt_pk_bf16_f32 v134, v136, v137
    v_mul_f32 v138, v124, v138
    v_mul_f32 v139, v124, v139
    v_cvt_pk_bf16_f32 v135, v138, v139
    v_mfma_f32_16x16x32_bf16 v[136:139], v[160:163], v[28:31], 0
    s_waitcnt lgkmcnt(3)
    ds_write_b128 v3, v[132:135] offset:6144
    v_mfma_f32_16x16x32_bf16 v[132:135], v[32:35], v[164:167], 0
    s_waitcnt lgkmcnt(3)
    v_mul_f32 v128, v124, v128
    v_mul_f32 v129, v124, v129
    v_mfma_f32_16x16x32_bf16 v[132:135], v[32:35], v[196:199], v[132:135]
    s_waitcnt lgkmcnt(2)
    v_cvt_pk_bf16_f32 v128, v128, v129
    v_mul_f32 v130, v124, v130
    v_mfma_f32_16x16x32_bf16 v[136:139], v[184:187], v[28:31], v[136:139]
    ds_read_b128 v[164:167], v117 offset:5120
    v_mul_f32 v131, v124, v131
    v_mfma_f32_16x16x32_bf16 v[124:127], v[160:163], v[152:155], 0
    s_waitcnt lgkmcnt(2)
    v_mul_f32 v236, 0x3baaaaab, v132
    v_cvt_pk_bf16_f32 v129, v130, v131
    v_mfma_f32_16x16x32_bf16 v[124:127], v[184:187], v[224:227], v[124:127]
    ds_write_b64 v4, v[128:129] offset:10240
    v_mfma_f32_16x16x32_bf16 v[128:131], v[160:163], v[156:159], 0
    v_rsq_f32 v236, v236
    v_mfma_f32_16x16x32_bf16 v[128:131], v[184:187], v[228:231], v[128:131]
    v_mul_f32 v176, v236, v176
    v_mul_f32 v177, v236, v177
    v_mfma_f32_16x16x32_bf16 v[152:155], v[160:163], v[168:171], 0
    v_cvt_pk_bf16_f32 v156, v176, v177
    v_mul_f32 v178, v236, v178
    v_mfma_f32_16x16x32_bf16 v[152:155], v[184:187], v[216:219], v[152:155]
    v_mul_f32 v179, v236, v179
    v_cvt_pk_bf16_f32 v157, v178, v179
    v_mfma_f32_16x16x32_bf16 v[160:163], a[216:219], v[204:207], 0
    s_waitcnt lgkmcnt(1)
    v_mul_f32 v180, v236, v180
    v_mul_f32 v181, v236, v181
    v_mfma_f32_16x16x32_bf16 v[160:163], a[220:223], v[208:211], v[160:163]
    v_cvt_pk_bf16_f32 v158, v180, v181
    v_mul_f32 v182, v236, v182
    v_mfma_f32_16x16x32_bf16 v[160:163], a[224:227], v[220:223], v[160:163]
    v_mul_f32 v183, v236, v183
    v_cvt_pk_bf16_f32 v159, v182, v183
    v_mfma_f32_16x16x32_bf16 v[160:163], a[228:231], v[232:235], v[160:163]
    buffer_store_dwordx4 v[156:159], v17, s[52:55], 0 offen nt
    v_mul_f32 v188, v236, v188
    v_mul_f32 v189, v236, v189
    v_cvt_pk_bf16_f32 v126, v188, v189
    v_mul_f32 v190, v236, v190
    v_mfma_f32_16x16x32_bf16 v[160:163], a[232:235], v[120:123], v[160:163]
    v_mul_f32 v191, v236, v191
    v_cvt_pk_bf16_f32 v127, v190, v191
    v_mfma_f32_16x16x32_bf16 v[160:163], a[236:239], v[164:167], v[160:163]
    v_rcp_f32 v144, v144
    v_mfma_f32_16x16x32_bf16 v[156:159], a[240:243], v[204:207], 0
    v_mul_f32 v200, v144, v200
    v_mul_f32 v201, v144, v201
    v_mfma_f32_16x16x32_bf16 v[156:159], a[244:247], v[208:211], v[156:159]
    v_cvt_pk_bf16_f32 v168, v200, v201
    v_mul_f32 v202, v144, v202
    v_mfma_f32_16x16x32_bf16 v[156:159], a[248:251], v[220:223], v[156:159]
    v_fma_f32 v236, v160, v160, s33
    v_fmac_f32 v236, v161, v161
    v_mfma_f32_16x16x32_bf16 v[156:159], a[252:255], v[232:235], v[156:159]
    v_fmac_f32 v236, v162, v162
    v_fmac_f32 v236, v163, v163
    v_mfma_f32_16x16x32_bf16 v[156:159], v[84:87], v[120:123], v[156:159]
    v_mul_f32 v203, v144, v203
    v_cvt_pk_bf16_f32 v169, v202, v203
    v_mfma_f32_16x16x32_bf16 v[156:159], v[88:91], v[164:167], v[156:159]
    v_mul_f32 v212, v144, v212
    v_mul_f32 v213, v144, v213
    v_mfma_f32_16x16x32_bf16 v[176:179], v[92:95], v[204:207], 0
    v_cvt_pk_bf16_f32 v170, v212, v213
    v_mul_f32 v214, v144, v214
    v_mfma_f32_16x16x32_bf16 v[176:179], v[96:99], v[208:211], v[176:179]
    v_mul_f32 v215, v144, v215
    v_cvt_pk_bf16_f32 v171, v214, v215
    v_mfma_f32_16x16x32_bf16 v[176:179], v[100:103], v[220:223], v[176:179]
    ds_write_b128 v3, v[168:171] offset:12288
    v_mfma_f32_16x16x32_bf16 v[176:179], v[104:107], v[232:235], v[176:179]
    v_fmac_f32 v236, v156, v156
    v_fmac_f32 v236, v157, v157
    v_mfma_f32_16x16x32_bf16 v[176:179], v[108:111], v[120:123], v[176:179]
    v_fmac_f32 v236, v158, v158
    v_fmac_f32 v236, v159, v159
    v_mfma_f32_16x16x32_bf16 v[176:179], v[112:115], v[164:167], v[176:179]
    buffer_store_dwordx2 v[126:127], v20, s[52:55], 0 offen nt
    v_mul_f32 v244, v144, v244
    v_mul_f32 v245, v144, v245
    v_cvt_pk_bf16_f32 v244, v244, v245
    v_mul_f32 v246, v144, v246
    v_mul_f32 v247, v144, v247
    v_cvt_pk_bf16_f32 v245, v246, v247
    ds_write_b64 v4, v[244:245] offset:16384
    v_fmac_f32 v236, v176, v176
    v_fmac_f32 v236, v177, v177
    v_fmac_f32 v236, v178, v178
    v_fmac_f32 v236, v179, v179
    v_cvt_pk_bf16_f32 v126, v236, v236
    v_cvt_pk_bf16_f32 v127, v236, v236
    ds_write_b64 v172, v[126:127] offset:7616
    v_rcp_f32 v136, v136
    v_mul_f32 v236, 0x3baaaaab, v133
    v_mul_f32 v124, v124, v136
    v_mul_f32_dpp v124, v128, v136 quad_perm:[0,1,2,3] row_mask:0x2 bank_mask:0xf
    v_mul_f32_dpp v124, v152, v136 quad_perm:[0,1,2,3] row_mask:0x4 bank_mask:0xf
    v_cvt_pk_bf16_f32 v124, v124, v124
    ds_write_b16 v7, v124
    v_rsq_f32 v236, v236
    s_nop 0
    v_mul_f32 v240, v236, v240
    v_mul_f32 v241, v236, v241
    v_cvt_pk_bf16_f32 v120, v240, v241
    v_mul_f32 v242, v236, v242
    v_mul_f32 v243, v236, v243
    v_cvt_pk_bf16_f32 v121, v242, v243
    v_mul_f32 v140, v236, v140
    v_mul_f32 v141, v236, v141
    v_cvt_pk_bf16_f32 v122, v140, v141
    v_mul_f32 v142, v236, v142
    v_mul_f32 v143, v236, v143
    v_cvt_pk_bf16_f32 v123, v142, v143
    v_mul_f32 v248, v236, v248
    v_mul_f32 v249, v236, v249
    v_cvt_pk_bf16_f32 v194, v248, v249
    v_mul_f32 v250, v236, v250
    v_mul_f32 v251, v236, v251
    v_cvt_pk_bf16_f32 v195, v250, v251
    s_waitcnt lgkmcnt(0)
    s_barrier
    ds_read_b128 v[124:127], v151 offset:7616
    ds_read_b128 v[128:131], v151 offset:8640
    ds_read_b128 v[132:135], v117 offset:6144
    ds_read_b128 v[136:139], v117 offset:7168
    ds_read_b128 v[140:143], v117 offset:8192
    buffer_store_dwordx4 v[120:123], v238, s[12:15], 0 offen nt
    ds_read_b128 v[144:147], v117 offset:9216
    ds_read_b128 v[152:155], v117 offset:10240
    ds_read_b128 v[164:167], v117 offset:11264
    s_waitcnt lgkmcnt(7)
    v_mfma_f32_16x16x32_bf16 v[120:123], v[32:35], v[124:127], 0
    s_waitcnt lgkmcnt(6)
    v_mfma_f32_16x16x32_bf16 v[120:123], v[32:35], v[128:131], v[120:123]
    s_waitcnt lgkmcnt(4)
    v_mfma_f32_16x16x32_bf16 v[124:127], a[216:219], v[132:135], 0
    s_waitcnt lgkmcnt(3)
    v_mfma_f32_16x16x32_bf16 v[124:127], a[220:223], v[136:139], v[124:127]
    s_waitcnt lgkmcnt(2)
    v_mfma_f32_16x16x32_bf16 v[124:127], a[224:227], v[140:143], v[124:127]
    s_waitcnt lgkmcnt(1)
    v_mfma_f32_16x16x32_bf16 v[124:127], a[228:231], v[144:147], v[124:127]
    s_waitcnt lgkmcnt(0)
    v_mul_f32 v193, 0x3baaaaab, v120
    v_mfma_f32_16x16x32_bf16 v[124:127], a[232:235], v[152:155], v[124:127]
    v_rsq_f32 v193, v193
    v_mfma_f32_16x16x32_bf16 v[124:127], a[236:239], v[164:167], v[124:127]
    v_mul_f32 v160, v193, v160
    v_mul_f32 v161, v193, v161
    v_mfma_f32_16x16x32_bf16 v[120:123], a[240:243], v[132:135], 0
    v_cvt_pk_bf16_f32 v128, v160, v161
    v_mul_f32 v162, v193, v162
    v_mfma_f32_16x16x32_bf16 v[120:123], a[244:247], v[136:139], v[120:123]
    v_mul_f32 v163, v193, v163
    v_cvt_pk_bf16_f32 v129, v162, v163
    v_mfma_f32_16x16x32_bf16 v[120:123], a[248:251], v[140:143], v[120:123]
    v_fma_f32 v236, v124, v124, s33
    v_fmac_f32 v236, v125, v125
    v_mfma_f32_16x16x32_bf16 v[120:123], a[252:255], v[144:147], v[120:123]
    v_fmac_f32 v236, v126, v126
    v_fmac_f32 v236, v127, v127
    v_mfma_f32_16x16x32_bf16 v[120:123], v[84:87], v[152:155], v[120:123]
    buffer_store_dwordx2 v[194:195], v239, s[12:15], 0 offen nt
    v_mul_f32 v156, v193, v156
    v_mul_f32 v157, v193, v157
    v_mfma_f32_16x16x32_bf16 v[120:123], v[88:91], v[164:167], v[120:123]
    ds_read_b128 v[160:163], v150 offset:256
    v_cvt_pk_bf16_f32 v130, v156, v157
    v_mfma_f32_16x16x32_bf16 v[168:171], v[92:95], v[132:135], 0
    ds_read_b128 v[132:135], v150 offset:2304
    v_mul_f32 v158, v193, v158
    v_mfma_f32_16x16x32_bf16 v[168:171], v[96:99], v[136:139], v[168:171]
    ds_read_b128 v[136:139], v150 offset:4352
    v_mul_f32 v159, v193, v159
    v_mfma_f32_16x16x32_bf16 v[168:171], v[100:103], v[140:143], v[168:171]
    ds_read_b128 v[140:143], v150 offset:6400
    v_fmac_f32 v236, v120, v120
    v_mfma_f32_16x16x32_bf16 v[168:171], v[104:107], v[144:147], v[168:171]
    ds_read_b128 v[144:147], v150 offset:8448
    v_fmac_f32 v236, v121, v121
    v_mfma_f32_16x16x32_bf16 v[168:171], v[108:111], v[152:155], v[168:171]
    ds_read_b128 v[152:155], v150 offset:10496
    v_fmac_f32 v236, v122, v122
    v_mfma_f32_16x16x32_bf16 v[168:171], v[112:115], v[164:167], v[168:171]
    v_fmac_f32 v236, v123, v123
    s_waitcnt lgkmcnt(5)
    v_mfma_f32_16x16x32_bf16 v[164:167], a[216:219], v[160:163], 0
    v_cvt_pk_bf16_f32 v131, v158, v159
    v_mul_f32 v176, v193, v176
    v_mfma_f32_16x16x32_bf16 v[156:159], a[240:243], v[160:163], 0
    s_waitcnt lgkmcnt(4)
    ds_write_b128 v174, v[128:131] offset:0
    v_mfma_f32_16x16x32_bf16 v[164:167], a[220:223], v[132:135], v[164:167]
    s_waitcnt lgkmcnt(3)
    v_fmac_f32 v236, v168, v168
    v_fmac_f32 v236, v169, v169
    v_mfma_f32_16x16x32_bf16 v[164:167], a[224:227], v[136:139], v[164:167]
    s_waitcnt lgkmcnt(2)
    v_fmac_f32 v236, v170, v170
    v_fmac_f32 v236, v171, v171
    v_mfma_f32_16x16x32_bf16 v[164:167], a[228:231], v[140:143], v[164:167]
    s_waitcnt lgkmcnt(1)
    ds_read_b128 v[128:131], v237 offset:0
    v_cvt_pk_bf16_f32 v194, v236, v236
    v_mfma_f32_16x16x32_bf16 v[164:167], a[232:235], v[144:147], v[164:167]
    v_cvt_pk_bf16_f32 v195, v236, v236
    v_mul_f32 v177, v193, v177
    v_mfma_f32_16x16x32_bf16 v[164:167], a[236:239], v[152:155], v[164:167]
    ds_write_b64 v172, v[194:195] offset:9664
    v_mfma_f32_16x16x32_bf16 v[156:159], a[244:247], v[132:135], v[156:159]
    v_cvt_pk_bf16_f32 v194, v176, v177
    v_mul_f32 v178, v193, v178
    v_mfma_f32_16x16x32_bf16 v[156:159], a[248:251], v[136:139], v[156:159]
    v_mul_f32 v179, v193, v179
    v_cvt_pk_bf16_f32 v195, v178, v179
    v_mfma_f32_16x16x32_bf16 v[156:159], a[252:255], v[140:143], v[156:159]
    ds_write_b64 v175, v[194:195] offset:1024
    v_mfma_f32_16x16x32_bf16 v[156:159], v[84:87], v[144:147], v[156:159]
    s_waitcnt lgkmcnt(2)
    buffer_store_dwordx4 v[128:131], v116, s[56:59], 0 offen nt
    v_fma_f32 v150, v164, v164, s33
    v_fmac_f32 v150, v165, v165
    v_fmac_f32 v150, v166, v166
    v_fmac_f32 v150, v167, v167
    v_mfma_f32_16x16x32_bf16 v[156:159], v[88:91], v[152:155], v[156:159]
    ds_read_b64 v[194:195], v149 offset:1024
    v_mfma_f32_16x16x32_bf16 v[128:131], v[92:95], v[160:163], 0
    s_waitcnt lgkmcnt(2)
    v_mfma_f32_16x16x32_bf16 v[128:131], v[96:99], v[132:135], v[128:131]
    s_barrier
    ds_read_b128 v[132:135], v151 offset:9664
    ds_read_b128 v[160:163], v151 offset:10688
    v_mfma_f32_16x16x32_bf16 v[128:131], v[100:103], v[136:139], v[128:131]
    ds_read_b128 v[136:139], v117 offset:12288
    ds_read_b128 v[176:179], v117 offset:13312
    v_mfma_f32_16x16x32_bf16 v[128:131], v[104:107], v[140:143], v[128:131]
    v_fmac_f32 v150, v156, v156
    v_fmac_f32 v150, v157, v157
    v_mfma_f32_16x16x32_bf16 v[128:131], v[108:111], v[144:147], v[128:131]
    ds_read_b128 v[140:143], v117 offset:14336
    ds_read_b128 v[144:147], v117 offset:15360
    v_mfma_f32_16x16x32_bf16 v[128:131], v[112:115], v[152:155], v[128:131]
    ds_read_b128 v[152:155], v117 offset:16384
    s_waitcnt lgkmcnt(7)
    buffer_store_dwordx2 v[194:195], v118, s[56:59], 0 offen nt
    ds_read_b128 v[180:183], v117 offset:17408
    v_fmac_f32 v150, v158, v158
    v_fmac_f32 v150, v159, v159
    s_nop 0
    s_waitcnt lgkmcnt(7)
    v_mfma_f32_16x16x32_bf16 v[184:187], v[32:35], v[132:135], 0
    s_waitcnt lgkmcnt(6)
    v_fmac_f32 v150, v128, v128
    v_fmac_f32 v150, v129, v129
    v_mfma_f32_16x16x32_bf16 v[184:187], v[32:35], v[160:163], v[184:187]
    s_waitcnt lgkmcnt(4)
    v_fmac_f32 v150, v130, v130
    v_fmac_f32 v150, v131, v131
    v_mfma_f32_16x16x32_bf16 v[132:135], a[216:219], v[136:139], 0
    v_cvt_pk_bf16_f32 v194, v150, v150
    v_cvt_pk_bf16_f32 v195, v150, v150
    v_mfma_f32_16x16x32_bf16 v[132:135], a[220:223], v[176:179], v[132:135]
    s_waitcnt lgkmcnt(2)
    ds_write_b64 v172, v[194:195] offset:17280
    v_mfma_f32_16x16x32_bf16 v[132:135], a[224:227], v[140:143], v[132:135]
    s_waitcnt lgkmcnt(2)
    v_mul_f32 v150, 0x3baaaaab, v184
    v_mfma_f32_16x16x32_bf16 v[132:135], a[228:231], v[144:147], v[132:135]
    s_waitcnt lgkmcnt(1)
    v_rsq_f32 v150, v150
    v_mfma_f32_16x16x32_bf16 v[132:135], a[232:235], v[152:155], v[132:135]
    v_mul_f32 v124, v150, v124
    v_mul_f32 v125, v150, v125
    v_mfma_f32_16x16x32_bf16 v[132:135], a[236:239], v[180:183], v[132:135]
    v_cvt_pk_bf16_f32 v124, v124, v125
    v_mul_f32 v126, v150, v126
    v_mfma_f32_16x16x32_bf16 v[160:163], a[240:243], v[136:139], 0
    v_mul_f32 v127, v150, v127
    v_cvt_pk_bf16_f32 v125, v126, v127
    v_mfma_f32_16x16x32_bf16 v[160:163], a[244:247], v[176:179], v[160:163]
    v_mul_f32 v120, v150, v120
    v_mul_f32 v121, v150, v121
    v_mfma_f32_16x16x32_bf16 v[160:163], a[248:251], v[140:143], v[160:163]
    v_cvt_pk_bf16_f32 v126, v120, v121
    v_mul_f32 v122, v150, v122
    v_mfma_f32_16x16x32_bf16 v[160:163], a[252:255], v[144:147], v[160:163]
    v_mul_f32 v123, v150, v123
    v_cvt_pk_bf16_f32 v127, v122, v123
    v_mfma_f32_16x16x32_bf16 v[160:163], v[84:87], v[152:155], v[160:163]
    buffer_store_dwordx4 v[124:127], v16, s[56:59], 0 offen nt
    v_mul_f32 v168, v150, v168
    v_mul_f32 v169, v150, v169
    v_cvt_pk_bf16_f32 v194, v168, v169
    v_mul_f32 v170, v150, v170
    v_mfma_f32_16x16x32_bf16 v[160:163], v[88:91], v[180:183], v[160:163]
    v_mul_f32 v171, v150, v171
    v_cvt_pk_bf16_f32 v195, v170, v171
    v_mfma_f32_16x16x32_bf16 v[120:123], v[92:95], v[136:139], 0
    v_fma_f32 v150, v132, v132, s33
    v_fmac_f32 v150, v133, v133
    v_mfma_f32_16x16x32_bf16 v[120:123], v[96:99], v[176:179], v[120:123]
    v_fmac_f32 v150, v134, v134
    v_fmac_f32 v150, v135, v135
    v_mfma_f32_16x16x32_bf16 v[120:123], v[100:103], v[140:143], v[120:123]
    v_fmac_f32 v150, v160, v160
    v_fmac_f32 v150, v161, v161
    v_mfma_f32_16x16x32_bf16 v[120:123], v[104:107], v[144:147], v[120:123]
    v_fmac_f32 v150, v162, v162
    v_fmac_f32 v150, v163, v163
    v_mfma_f32_16x16x32_bf16 v[120:123], v[108:111], v[152:155], v[120:123]
    v_mfma_f32_16x16x32_bf16 v[120:123], v[112:115], v[180:183], v[120:123]
    s_nop 0
    s_nop 0
    s_nop 0
    s_nop 0
    s_nop 0
    s_nop 0
    s_nop 0
    s_nop 0
    v_fmac_f32 v150, v120, v120
    v_fmac_f32 v150, v121, v121
    v_fmac_f32 v150, v122, v122
    v_fmac_f32 v150, v123, v123
    v_cvt_pk_bf16_f32 v238, v150, v150
    v_cvt_pk_bf16_f32 v239, v150, v150
    ds_write_b64 v172, v[238:239] offset:15232
    buffer_store_dwordx2 v[194:195], v19, s[56:59], 0 offen nt
    s_waitcnt lgkmcnt(0)
    s_barrier
    ds_read_b128 v[124:127], v151 offset:15232
    ds_read_b128 v[136:139], v151 offset:16256
    ds_read_b128 v[140:143], v151 offset:17280
    ds_read_b128 v[144:147], v151 offset:18304
    ds_read_b128 v[152:155], v117 offset:18432
    s_waitcnt lgkmcnt(4)
    v_mfma_f32_16x16x32_bf16 v[168:171], v[32:35], v[124:127], 0
    s_waitcnt lgkmcnt(3)
    v_mfma_f32_16x16x32_bf16 v[168:171], v[32:35], v[136:139], v[168:171]
    s_waitcnt lgkmcnt(1)
    v_mfma_f32_16x16x32_bf16 v[124:127], v[32:35], v[140:143], 0
    s_waitcnt lgkmcnt(0)
    v_or3_b32 v152, v152, v153, v154
    v_or_b32 v152, v152, v155
    v_mfma_f32_16x16x32_bf16 v[124:127], v[32:35], v[144:147], v[124:127]
    v_cmp_gt_i32 s[46:47], 0, v152
    s_nop 0
    v_mul_f32 v172, 0x3baaaaab, v168
    v_rsq_f32 v172, v172
    s_nop 0
    v_mul_f32 v132, v172, v132
    v_mul_f32 v133, v172, v133
    v_cvt_pk_bf16_f32 v132, v132, v133
    v_mul_f32 v133, 0x3baaaaab, v124
    v_rsq_f32 v133, v133
    v_mul_f32 v134, v172, v134
    v_mul_f32 v164, v133, v164
    v_mul_f32 v165, v133, v165
    v_cvt_pk_bf16_f32 v124, v164, v165
    v_mul_f32 v166, v133, v166
    v_mul_f32 v167, v133, v167
    v_cvt_pk_bf16_f32 v125, v166, v167
    v_mul_f32 v156, v133, v156
    v_mul_f32 v157, v133, v157
    v_cvt_pk_bf16_f32 v126, v156, v157
    v_mul_f32 v158, v133, v158
    v_mul_f32 v159, v133, v159
    v_cvt_pk_bf16_f32 v127, v158, v159
    buffer_store_dwordx4 v[124:127], v148, s[12:15], 0 offen nt
    v_mul_f32 v128, v133, v128
    v_mul_f32 v129, v133, v129
    v_cvt_pk_bf16_f32 v116, v128, v129
    v_mul_f32 v130, v133, v130
    v_mul_f32 v131, v133, v131
    v_cvt_pk_bf16_f32 v117, v130, v131
    v_mul_f32 v135, v172, v135
    v_cvt_pk_bf16_f32 v133, v134, v135
    v_mul_f32 v160, v172, v160
    v_mul_f32 v161, v172, v161
    v_cvt_pk_bf16_f32 v134, v160, v161
    v_mul_f32 v162, v172, v162
    v_mul_f32 v163, v172, v163
    v_cvt_pk_bf16_f32 v135, v162, v163
    ds_write_b128 v174, v[132:135] offset:3072
    v_mul_f32 v120, v172, v120
    v_mul_f32 v121, v172, v121
    v_cvt_pk_bf16_f32 v120, v120, v121
    v_mul_f32 v122, v172, v122
    v_mul_f32 v123, v172, v123
    v_cvt_pk_bf16_f32 v121, v122, v123
    buffer_store_dwordx2 v[116:117], v173, s[12:15], 0 offen nt
    ds_read_b128 v[124:127], v237 offset:3072
    ds_write_b64 v175, v[120:121] offset:4096
    ds_read_b64 v[194:195], v149 offset:4096
    s_waitcnt lgkmcnt(2)
    buffer_store_dwordx4 v[124:127], v119, s[56:59], 0 offen nt
    s_waitcnt lgkmcnt(0)
    buffer_store_dwordx2 v[194:195], v192, s[56:59], 0 offen nt
L_end:
    s_nop 1
    s_cmp_lg_u64 s[46:47], 0
    s_cbranch_scc1 L_rerun
L_done:
    s_endpgm
L_slow:
    s_mov_b32 s44, 0xff
    s_branch L_redo
L_rerun:
    s_mov_b32 s44, 0x7f000000
    s_lshr_b32 s100, s63, 20
L_redo:
    s_waitcnt vmcnt(0) lgkmcnt(0)
    s_barrier
    v_mbcnt_lo_u32_b32 v0, -1, 0
    v_mbcnt_hi_u32_b32 v0, -1, v0
    v_lshl_add_u32 v0, s16, 6, v0
    s_nop 7
    s_branch L_again
L_edge:
    v_mov_b32 v120, v0
    v_mov_b32 v121, 0x40000000
    s_lshl_b32 s3, s16, 4
    s_load_dwordx4 s[92:95], s[0:1], s3
    v_and_b32 v122, 63, v0
    s_bfe_u32 s3, s2, 0x50003
    s_lshl_b32 s4, s16, 3
    s_lshr_b32 s98, 0x06143a01, s4
    s_and_b32 s98, s98, 0xff
    s_mul_i32 s3, s3, s98
    s_sub_u32 s98, s98, 1
    s_lshr_b32 s4, 0x0048d800, s4
    s_and_b32 s4, s4, 0xff
    s_lshl_b32 s4, s4, 3
    s_max_u32 s4, s4, 6
    s_sub_u32 s4, s4, s98
    s_sub_u32 s4, s4, 1
    s_min_u32 s3, s3, s4
    v_min_u32 v124, s98, v122
    v_add_lshl_u32 v124, v124, s3, 7
    v_mov_b32 v125, 0
    v_lshrrev_b32 v123, 4, v122
    v_and_b32 v126, 15, v122
    s_mov_b32 s10, 100270464
    s_mov_b32 s11, 0x00020000
    s_mov_b32 s50, 36096
    s_mov_b32 s51, 0x00020000
    s_mul_i32 s3, s16, 96
    v_lshl_add_u32 v127, v122, 4, s3
    v_mul_u32_u24 v128, 171, v122
    v_lshrrev_b32 v128, 10, v128
    v_lshrrev_b32 v129, 1, v128
    v_xor_b32 v129, v129, v128
    v_and_b32 v129, 4, v129
    v_mul_u32_u24 v129, 3, v129
    v_xor_b32 v129, v129, v128
    v_mul_u32_u24 v129, 1152, v129
    v_mul_u32_u24 v130, 96, v128
    v_sub_u32 v129, v129, v130
    v_add_u32 v130, v127, v129
    v_add_u32 v129, 64, v122
    v_mul_u32_u24 v129, 171, v129
    v_lshrrev_b32 v129, 10, v129
    v_lshrrev_b32 v131, 1, v129
    v_xor_b32 v131, v131, v129
    v_and_b32 v131, 4, v131
    v_mul_u32_u24 v131, 3, v131
    v_xor_b32 v131, v131, v129
    v_mul_u32_u24 v131, 1152, v131
    v_mul_u32_u24 v132, 96, v129
    v_sub_u32 v131, v131, v132
    v_add_u32 v132, v127, v131
    v_add_u32 v131, 128, v122
    v_mul_u32_u24 v131, 171, v131
    v_lshrrev_b32 v131, 10, v131
    v_lshrrev_b32 v133, 1, v131
    v_xor_b32 v133, v133, v131
    v_and_b32 v133, 4, v133
    v_mul_u32_u24 v133, 3, v133
    v_xor_b32 v133, v133, v131
    v_mul_u32_u24 v133, 1152, v133
    v_mul_u32_u24 v134, 96, v131
    v_sub_u32 v133, v133, v134
    v_add_u32 v134, v127, v133
    s_mul_i32 s68, s16, 6144
    s_add_u32 s69, s68, 65536
    s_cmp_eq_u32 s16, 3
    s_cselect_b32 s68, 149696, s68
    s_cselect_b32 s69, 155840, s69
    s_mov_b32 s70, 193536
    s_mov_b32 s36, 100270464
    s_mov_b32 s22, 1180032
    s_mul_i32 s3, s2, 911
    s_lshr_b32 s3, s3, 16
    s_mul_i32 s35, s3, 72
    s_sub_u32 s38, s2, s35
    s_mul_i32 s3, s3, 1373568
    s_mul_i32 s35, s38, 2688
    s_add_u32 s3, s3, s35
    s_add_u32 s25, s3, 589824
    s_add_u32 s7, s3, 1769472
    s_mov_b32 s20, 31
    s_mov_b32 s21, 4204032
    s_mov_b32 s17, 20
    s_cmp_lt_u32 s2, 240
    s_cselect_b32 s45, 28, 24
    s_mov_b32 s5, 0
    s_mov_b32 s6, 0
    s_cmp_lt_u32 s2, 247
    s_cbranch_scc1 L_inner
    s_mov_b32 s20, 0
    s_mov_b32 s38, 0
    s_sub_u32 s3, s2, 247
    s_and_b32 s3, s3, 3
    s_mul_i32 s3, s3, 7
    s_add_u32 s3, s3, 3
    s_mov_b32 s35, 196224
    s_cmp_lt_u32 s2, 251
    s_cselect_b32 s35, s35, 384
    s_cselect_b32 s6, 1, 0
    s_cselect_b32 s5, 0, 1
    s_mul_i32 s25, s3, s35
    s_mul_i32 s21, s35, 28
    s_cmp_lt_u32 s2, 255
    s_cselect_b32 s17, 18, 1
    s_cselect_b32 s45, 18, 1
    s_cselect_b32 s25, s25, 0
    s_cselect_b32 s6, s6, 1
    s_add_u32 s7, s25, 1179648
L_inner:
    s_mul_i32 s3, s5, 99485568
    s_mul_i32 s35, s5, -784896
    v_mov_b32 v127, s3
    v_mov_b32 v133, s35
    s_add_u32 s7, s7, s35
    s_mul_i32 s3, s6, 194688
    s_mul_i32 s35, s6, -1536
    v_mov_b32 v135, s3
    v_mov_b32 v164, s35
    s_add_u32 s7, s7, s35
    s_bfm_b32 s34, s45, 0
    s_and_b32 s4, s2, 7
    s_sub_u32 s4, 0, s4
    v_mul_u32_u24 v165, 2731, v120
    v_bfe_u32 v166, v165, 17, 3
    v_lshrrev_b32 v165, 16, v165
    v_xor_b32 v167, v166, v120
    v_mul_u32_u24 v166, 37, v165
    v_lshrrev_b32 v166, 8, v166
    v_lshlrev_b32 v167, 4, v167
    v_mad_u32_u24 v10, v166, s70, v167
    v_mul_u32_u24 v166, 37, v165
    v_lshrrev_b32 v166, 8, v166
    v_mul_u32_u24 v168, 7, v166
    v_sub_u32 v168, v165, v168
    v_cmp_gt_u32 vcc, 4, v166
    s_nop 1
    v_cndmask_b32 v166, v133, v127, vcc
    v_cmp_gt_u32 vcc, 4, v168
    s_nop 1
    v_cndmask_b32 v168, v164, v135, vcc
    v_add3_u32 v10, v10, v166, v168
    v_mul_u32_u24 v166, s20, v165
    v_add_u32 v166, s38, v166
    v_mul_u32_u24 v168, 911, v166
    v_lshrrev_b32 v168, 16, v168
    v_mul_u32_u24 v168, s22, v168
    v_mad_u32_u24 v168, v165, s21, v168
    v_bfe_u32 v166, s34, v165, 1
    v_cmp_ne_u32 vcc, 0, v166
    v_add_u32 v166, s7, v168
    s_nop 0
    v_cndmask_b32 v166, v121, v166, vcc
    v_mul_u32_u24 v165, 384, v165
    v_sub_u32 v165, v167, v165
    v_add_u32 v166, v166, v165
    v_add_u32 v165, 256, v120
    v_mul_u32_u24 v167, 2731, v165
    v_bfe_u32 v168, v167, 17, 3
    v_lshrrev_b32 v167, 16, v167
    v_xor_b32 v165, v168, v165
    v_mul_u32_u24 v168, 37, v167
    v_lshrrev_b32 v168, 8, v168
    v_lshlrev_b32 v165, 4, v165
    v_mad_u32_u24 v11, v168, s70, v165
    v_mul_u32_u24 v168, 37, v167
    v_lshrrev_b32 v168, 8, v168
    v_mul_u32_u24 v169, 7, v168
    v_sub_u32 v169, v167, v169
    v_cmp_gt_u32 vcc, 4, v168
    s_nop 1
    v_cndmask_b32 v168, v133, v127, vcc
    v_cmp_gt_u32 vcc, 4, v169
    s_nop 1
    v_cndmask_b32 v169, v164, v135, vcc
    v_add3_u32 v11, v11, v168, v169
    v_min_u32 v168, 20, v167
    v_add_u32 v169, 12, v167
    v_lshrrev_b32 v169, 5, v169
    v_sub_u32 v170, v167, v168
    v_mad_i32_i24 v170, v169, s4, v170
    v_mul_u32_u24 v171, s20, v168
    v_add3_u32 v171, v171, v170, s38
    v_mul_u32_u24 v169, 911, v171
    v_lshrrev_b32 v169, 16, v169
    v_mul_u32_u24 v169, s22, v169
    v_mad_u32_u24 v169, v168, s21, v169
    v_bfe_u32 v171, s34, v167, 1
    v_cmp_ne_u32 vcc, 0, v171
    v_mul_i32_i24 v170, 2688, v170
    v_add3_u32 v168, v169, v170, s7
    v_cndmask_b32 v168, v121, v168, vcc
    v_mul_u32_u24 v167, 384, v167
    v_sub_u32 v167, v165, v167
    v_add_u32 v168, v168, v167
    v_add_u32 v165, 512, v120
    v_mul_u32_u24 v167, 2731, v165
    v_bfe_u32 v169, v167, 17, 3
    v_lshrrev_b32 v167, 16, v167
    v_xor_b32 v165, v169, v165
    v_mul_u32_u24 v169, 37, v167
    v_lshrrev_b32 v169, 8, v169
    v_lshlrev_b32 v165, 4, v165
    v_mad_u32_u24 v12, v169, s70, v165
    v_mul_u32_u24 v169, 37, v167
    v_lshrrev_b32 v169, 8, v169
    v_mul_u32_u24 v170, 7, v169
    v_sub_u32 v170, v167, v170
    v_cmp_gt_u32 vcc, 4, v169
    s_nop 1
    v_cndmask_b32 v169, v133, v127, vcc
    v_cmp_gt_u32 vcc, 4, v170
    s_nop 1
    v_cndmask_b32 v170, v164, v135, vcc
    v_add3_u32 v12, v12, v169, v170
    v_min_u32 v169, 20, v167
    v_add_u32 v170, 12, v167
    v_lshrrev_b32 v170, 5, v170
    v_sub_u32 v171, v167, v169
    v_mad_i32_i24 v171, v170, s4, v171
    v_mul_u32_u24 v176, s20, v169
    v_add3_u32 v176, v176, v171, s38
    v_mul_u32_u24 v170, 911, v176
    v_lshrrev_b32 v170, 16, v170
    v_mul_u32_u24 v170, s22, v170
    v_mad_u32_u24 v170, v169, s21, v170
    v_bfe_u32 v176, s34, v167, 1
    v_cmp_ne_u32 vcc, 0, v176
    v_mul_i32_i24 v171, 2688, v171
    v_add3_u32 v169, v170, v171, s7
    v_cndmask_b32 v169, v121, v169, vcc
    v_mul_u32_u24 v167, 384, v167
    v_sub_u32 v167, v165, v167
    v_add_u32 v169, v169, v167
    s_lshl_b32 s28, s16, 10
    s_add_u32 s28, s28, 20480
    s_waitcnt lgkmcnt(0)
    s_load_dword s101, s[92:93], 0
    s_load_dword s101, s[94:95], 0
    s_cmp_eq_u32 s16, 2
    s_cselect_b64 s[98:99], s[80:81], s[78:79]
    s_cmp_eq_u32 s16, 3
    s_cselect_b64 s[98:99], s[88:89], s[98:99]
    s_mov_b64 s[8:9], s[76:77]
    v_lshl_add_u64 v[124:125], s[98:99], 0, v[124:125]
    s_cmp_eq_u32 s16, 2
    s_cselect_b64 s[98:99], s[84:85], s[82:83]
    s_cmp_eq_u32 s16, 3
    s_cselect_b64 s[98:99], s[86:87], s[98:99]
    v_writelane_b32 v124, s98, 63
    v_writelane_b32 v125, s99, 63
    s_cmp_eq_u32 s16, 0
    s_cbranch_scc1 L_nowue
    global_load_dword a254, v[124:125], off
L_nowue:
    s_add_u32 m0, s28, 65536
    s_nop 0
    buffer_load_dwordx4 v166, s[8:11], 0 offen nt lds
    s_add_u32 m0, s28, 69632
    s_nop 0
    buffer_load_dwordx4 v168, s[8:11], 0 offen lds
    s_add_u32 m0, s28, 73728
    s_nop 0
    buffer_load_dwordx4 v169, s[8:11], 0 offen lds
    s_add_u32 m0, s28, 0
    s_nop 0
    buffer_load_dwordx4 v10, s[8:11], s25 offen nt lds
    s_add_u32 m0, s28, 4096
    s_nop 0
    buffer_load_dwordx4 v11, s[8:11], s25 offen nt lds
    s_mov_b64 s[48:49], s[78:79]
    s_mov_b64 s[52:53], s[80:81]
    s_mov_b64 s[60:61], s[84:85]
    s_mov_b64 s[64:65], s[86:87]
    s_mov_b64 s[56:57], s[88:89]
    s_mov_b64 s[46:47], s[82:83]
    s_load_dwordx4 s[40:43], s[0:1], 72
    s_add_u32 s48, s48, 384
    s_addc_u32 s49, s49, 0
    s_add_u32 m0, s68, 0
    v_add_u32 v124, s16, v122
    v_and_b32 v124, 3, v124
    v_lshlrev_b32 v124, 1, v124
    s_mov_b32 s54, 12288
    s_mov_b32 s55, 0x00020000
    s_mov_b32 s62, 64
    s_mov_b32 s63, 0x00020000
    s_mov_b32 s66, 128
    s_mov_b32 s67, 0x00020000
    s_mov_b32 s58, 676
    s_mov_b32 s59, 0x00020000
    s_mov_b32 s14, 0
    s_mov_b32 s15, 0x00020000
    v_mov_b32 v167, 0
    v_cmp_lt_u32 s[90:91], 7, v126
    v_mov_b32 v117, 0
    v_mov_b32 v165, 0
    v_mov_b32 v119, 0
    v_lshlrev_b32 v116, 1, v122
    v_mul_u32_u24 v125, 12, v126
    s_mul_i32 s71, s16, 192
    v_add_u32 v125, s71, v125
    v_lshlrev_b32 v118, 5, v123
    s_mul_i32 s72, s16, 9408
    s_add_u32 s72, s72, 104448
    s_mul_i32 s73, s16, 7616
    s_add_u32 s73, s73, 38912
    s_cmp_eq_u32 s16, 3
    s_cselect_b32 s73, 142080, s73
    v_lshrrev_b32 v136, 2, v126
    v_and_b32 v137, 1, v136
    v_mul_u32_u24 v137, 0x020202, v137
    v_lshl_or_b32 v137, v137, 8, v137
    v_add_u32 v137, 0x05040100, v137
    v_and_b32 v139, 3, v126
    v_lshrrev_b32 v166, 1, v126
    v_xor_b32 v138, v166, v123
    v_mul_u32_u24 v166, 384, v126
    v_lshl_add_u32 v0, v138, 4, v166
    v_xor_b32 v1, 64, v0
    v_and_b32 v138, 2, v123
    v_add_u32 v138, v138, v123
    v_lshl_add_u32 v138, v138, 2, v136
    v_mul_u32_u24 v138, 96, v138
    v_lshl_add_u32 v138, v139, 3, v138
    v_add_u32 v140, s68, v138
    v_add_u32 v141, s69, v138
    v_add_u32 v143, s72, v138
    v_add_u32 v142, s73, v138
    v_mov_b32 v28, 0x3f803f80
    v_mov_b32 v29, 0x3f803f80
    v_mov_b32 v30, 0x3f803f80
    v_mov_b32 v31, 0x3f803f80
    v_mul_u32_u24 v138, 768, v123
    v_add_u32 v138, v125, v138
    v_add_u32 v138, 98304, v138
    s_mov_b32 s76, 0x3f80
    v_and_b32 v144, 1, v126
    v_lshlrev_b32 v144, 4, v144
    v_lshlrev_b32 v146, v144, s76
    v_mov_b32 v145, 0x3c003c00
    v_mov_b32 v44, 1.0
    v_mov_b32 v45, 1.0
    v_lshlrev_b32 v147, 4, v123
    s_mov_b32 s19, s38
    s_mov_b32 s23, s25
    s_mov_b32 s26, 0
    s_mov_b32 s27, 0
    s_mov_b32 s18, 0
    s_add_u32 s19, s19, s20
    s_add_u32 s23, s23, s21
    s_cmp_ge_u32 s19, 72
    s_cselect_b32 s34, 72, 0
    s_cselect_b32 s35, s22, 0
    s_sub_u32 s19, s19, s34
    s_add_u32 s23, s23, s35
    s_mov_b32 s24, s23
    s_add_u32 s19, s19, s20
    s_add_u32 s23, s23, s21
    s_cmp_ge_u32 s19, 72
    s_cselect_b32 s34, 72, 0
    s_cselect_b32 s35, s22, 0
    s_sub_u32 s19, s19, s34
    s_add_u32 s23, s23, s35
    s_mul_i32 s79, s16, 64
    v_lshl_add_u32 v166, v123, 4, s79
    s_mul_i32 s80, s16, 32
    s_add_u32 s80, s80, 256
    v_lshl_add_u32 v148, v123, 3, s80
    v_add_u32 v150, 0, v126
    v_mul_u32_u24 v151, 37, v150
    v_mul_u32_u24 v149, 384, v150
    v_lshrrev_b32 v151, 8, v151
    v_mad_u32_u24 v149, v151, s70, v149
    v_add_u32 v15, v149, v166
    v_add_u32 v18, v149, v148
    v_mul_u32_u24 v152, 37, v150
    v_lshrrev_b32 v152, 8, v152
    v_mul_u32_u24 v149, 7, v152
    v_sub_u32 v149, v150, v149
    v_add_u32 v154, 16, v126
    v_mul_u32_u24 v153, 37, v154
    v_mul_u32_u24 v155, 384, v154
    v_lshrrev_b32 v153, 8, v153
    v_mad_u32_u24 v155, v153, s70, v155
    v_add_u32 v16, v155, v166
    v_add_u32 v19, v155, v148
    v_mul_u32_u24 v155, 37, v154
    v_lshrrev_b32 v155, 8, v155
    v_mul_u32_u24 v156, 7, v155
    v_sub_u32 v156, v154, v156
    v_add_u32 v157, 32, v126
    v_mul_u32_u24 v159, 37, v157
    v_mul_u32_u24 v158, 384, v157
    v_lshrrev_b32 v159, 8, v159
    v_mad_u32_u24 v158, v159, s70, v158
    v_add_u32 v17, v158, v166
    v_add_u32 v20, v158, v148
    v_mul_u32_u24 v158, 37, v157
    v_lshrrev_b32 v158, 8, v158
    v_mul_u32_u24 v148, 7, v158
    v_sub_u32 v148, v157, v148
    s_mul_i32 s81, s16, 768
    s_add_u32 s81, s81, 98304
    v_mul_u32_u24 v151, 24, v151
    v_lshl_add_u32 v151, v150, 2, v151
    v_add_u32 v22, s81, v151
    v_sub_u32 v23, s81, v151
    v_sub_u32 v166, v22, v147
    v_mul_u32_u24 v151, 24, v153
    v_lshl_add_u32 v151, v154, 2, v151
    v_add_u32 v24, s81, v151
    v_sub_u32 v25, s81, v151
    v_sub_u32 v151, v24, v147
    v_mul_u32_u24 v153, 24, v159
    v_lshl_add_u32 v153, v157, 2, v153
    v_add_u32 v26, s81, v153
    v_sub_u32 v27, s81, v153
    v_sub_u32 v153, v26, v147
    v_mul_u32_u24 v159, 148, v123
    s_mov_b32 s82, -24
    v_add_u32 v160, 0, v159
    v_lshrrev_b32 v160, 8, v160
    v_mad_i32_i24 v48, v160, s82, v166
    v_mad_i32_i24 v60, v160, s82, v151
    v_mad_i32_i24 v72, v160, s82, v153
    v_add_u32 v160, 37, v159
    v_lshrrev_b32 v160, 8, v160
    v_mad_i32_i24 v49, v160, s82, v166
    v_mad_i32_i24 v61, v160, s82, v151
    v_mad_i32_i24 v73, v160, s82, v153
    v_add_u32 v160, 74, v159
    v_lshrrev_b32 v160, 8, v160
    v_mad_i32_i24 v50, v160, s82, v166
    v_mad_i32_i24 v62, v160, s82, v151
    v_mad_i32_i24 v74, v160, s82, v153
    v_add_u32 v160, 111, v159
    v_lshrrev_b32 v160, 8, v160
    v_mad_i32_i24 v51, v160, s82, v166
    v_mad_i32_i24 v63, v160, s82, v151
    v_mad_i32_i24 v75, v160, s82, v153
    v_add_u32 v160, 592, v159
    v_lshrrev_b32 v160, 8, v160
    v_mad_i32_i24 v52, v160, s82, v166
    v_mad_i32_i24 v64, v160, s82, v151
    v_mad_i32_i24 v76, v160, s82, v153
    v_add_u32 v160, 629, v159
    v_lshrrev_b32 v160, 8, v160
    v_mad_i32_i24 v53, v160, s82, v166
    v_mad_i32_i24 v65, v160, s82, v151
    v_mad_i32_i24 v77, v160, s82, v153
    v_add_u32 v160, 666, v159
    v_lshrrev_b32 v160, 8, v160
    v_mad_i32_i24 v54, v160, s82, v166
    v_mad_i32_i24 v66, v160, s82, v151
    v_mad_i32_i24 v78, v160, s82, v153
    v_add_u32 v160, 703, v159
    v_lshrrev_b32 v160, 8, v160
    v_mad_i32_i24 v55, v160, s82, v166
    v_mad_i32_i24 v67, v160, s82, v151
    v_mad_i32_i24 v79, v160, s82, v153
    v_add_u32 v160, 1184, v159
    v_lshrrev_b32 v160, 8, v160
    v_mad_i32_i24 v56, v160, s82, v166
    v_mad_i32_i24 v68, v160, s82, v151
    v_mad_i32_i24 v80, v160, s82, v153
    v_add_u32 v160, 1221, v159
    v_lshrrev_b32 v160, 8, v160
    v_mad_i32_i24 v57, v160, s82, v166
    v_mad_i32_i24 v69, v160, s82, v151
    v_mad_i32_i24 v81, v160, s82, v153
    v_add_u32 v160, 1258, v159
    v_lshrrev_b32 v160, 8, v160
    v_mad_i32_i24 v58, v160, s82, v166
    v_mad_i32_i24 v70, v160, s82, v151
    v_mad_i32_i24 v82, v160, s82, v153
    v_add_u32 v159, 1295, v159
    v_lshrrev_b32 v159, 8, v159
    v_mad_i32_i24 v59, v159, s82, v166
    v_mad_i32_i24 v71, v159, s82, v151
    v_mad_i32_i24 v83, v159, s82, v153
    v_mov_b32 v159, s81
    v_lshlrev_b32 v151, 4, v122
    v_xor_b32 v2, 65536, v151
    v_lshl_add_u32 v3, s16, 10, v151
    s_lshr_b32 s83, s16, 1
    s_and_b32 s84, s16, 1
    s_lshl_b32 s84, s84, 3
    s_lshl_b32 s85, s83, 10
    s_add_u32 s85, s85, s84
    v_add_u32 v4, s85, v151
    s_lshl_b32 s83, s83, 11
    s_add_u32 s83, s83, s84
    s_add_u32 s83, s83, 157888
    s_mul_i32 s86, s16, 2048
    s_add_u32 s86, s86, 149696
    v_lshl_add_u32 v160, v123, 3, s86
    v_mov_b32 v153, s83
    v_mov_b32 v161, 163264
    v_mul_u32_u24 v151, 80, v123
    s_mul_i32 s87, s16, 128
    s_add_u32 s87, s87, 61760
    buffer_load_dwordx4 v130, s[48:51], 0 offen lds
    v_add3_u32 v5, v151, v144, s72
    v_lshl_add_u32 v6, v126, 2, s73
    v_add_u32 v9, s87, v147
    s_mov_b32 s32, 0x2a8cbccc
    s_mov_b32 s33, 0x38fba882
    buffer_load_dwordx4 v132, s[48:51], 0 offen offset:1024 lds
    v_lshrrev_b32 v166, 1, v123
    v_mul_u32_u24 v166, 48, v166
    v_lshl_add_u32 v166, v123, 3, v166
    s_add_u32 s75, s28, 16384
    s_cmp_lt_u32 s16, 2
    buffer_load_dwordx4 v134, s[48:51], 0 offen offset:2048 lds
    v_lshl_add_u32 v166, v136, 4, v166
    v_lshl_add_u32 v166, v139, 1, v166
    v_add_u32 v8, s87, v166
    v_mov_b32 v37, 0
    v_mov_b32 v38, 0
    v_mov_b32 v39, 0
    v_add_u32 v168, 86016, v0
    v_add_u32 v169, 86016, v1
    v_lshlrev_b32 v162, 4, v126
    v_add_u32 v162, 161984, v162
    v_mul_u32_u24 v171, 336, v126
    v_add3_u32 v171, v171, v151, s72
    v_mul_u32_u24 v176, 272, v126
    v_add3_u32 v176, v176, v147, s73
    v_mul_u32_u24 v170, 1088, v123
    v_add_u32 v170, v170, v6
    v_add_u32 v178, 5376, v171
    v_add_u32 v179, 4352, v176
    v_add_u32 v177, 4352, v170
    v_cmp_gt_u32 s[88:89], 16, v122
    v_mov_b32 v180, 0xf149f2ca
    v_add_u32 v151, 768, v120
    v_mul_u32_u24 v163, 2731, v151
    v_bfe_u32 v166, v163, 17, 3
    v_lshrrev_b32 v163, 16, v163
    v_xor_b32 v151, v166, v151
    v_mul_u32_u24 v166, 37, v163
    v_lshrrev_b32 v166, 8, v166
    v_lshlrev_b32 v151, 4, v151
    v_mad_u32_u24 v13, v166, s70, v151
    v_mul_u32_u24 v151, 37, v163
    v_lshrrev_b32 v151, 8, v151
    v_mul_u32_u24 v166, 7, v151
    v_sub_u32 v166, v163, v166
    v_cmp_gt_u32 vcc, 4, v151
    v_add_u32 v163, 1024, v120
    v_mul_u32_u24 v181, 2731, v163
    v_cndmask_b32 v151, v133, v127, vcc
    v_cmp_gt_u32 vcc, 4, v166
    v_bfe_u32 v120, v181, 17, 3
    v_lshrrev_b32 v181, 16, v181
    v_cndmask_b32 v166, v164, v135, vcc
    v_add3_u32 v13, v13, v151, v166
    v_xor_b32 v163, v120, v163
    v_mul_u32_u24 v120, 37, v181
    v_lshrrev_b32 v120, 8, v120
    v_lshlrev_b32 v163, 4, v163
    v_mad_u32_u24 v14, v120, s70, v163
    v_mul_u32_u24 v120, 37, v181
    v_lshrrev_b32 v120, 8, v120
    v_mul_u32_u24 v151, 7, v120
    v_sub_u32 v151, v181, v151
    v_cmp_gt_u32 vcc, 4, v120
    s_cselect_b32 s29, s75, 161984
    s_cselect_b32 s30, 65536, 0
    s_add_u32 s48, s48, 36864
    s_addc_u32 s49, s49, 0
    s_add_u32 m0, s68, 3072
    v_cndmask_b32 v120, v133, v127, vcc
    s_xor_b32 s74, s29, s30
    s_lshl_b32 s92, s5, 1
    buffer_load_dwordx4 v130, s[48:51], 0 offen lds
    v_cmp_gt_u32 vcc, 4, v151
    s_or_b32 s92, s92, s6
    v_mov_b32 v163, 0xc31044fe
    s_mul_i32 s77, s16, 64
    s_mul_i32 s78, s16, 32
    buffer_load_dwordx4 v132, s[48:51], 0 offen offset:1024 lds
    v_cndmask_b32 v151, v164, v135, vcc
    v_add3_u32 v14, v14, v120, v151
    v_cmp_gt_u32 vcc, 48, v181
    s_add_u32 s78, s78, 192
    s_add_u32 s34, s18, 2
    buffer_load_dwordx4 v134, s[48:51], 0 offen offset:2048 lds
    s_add_u32 s48, s48, 36864
    s_addc_u32 s49, s49, 0
    s_add_u32 m0, s69, 0
    s_mov_b32 s27, s26
    s_mov_b32 s26, s25
    buffer_load_ushort v166, v116, s[60:63], 0 offen
    s_mov_b64 s[60:61], s[8:9]
    s_add_u32 s19, s19, s20
    s_mov_b32 s18, 1
    buffer_load_dwordx3 v[172:174], v125, s[56:59], 0 offen
    v_cndmask_b32 v14, v121, v14, vcc
    s_sub_u32 s62, s45, s17
    s_sub_u32 s45, s17, 1
    buffer_load_dwordx4 v[184:187], v118, s[64:67], 0 offen
    v_cmp_gt_u32 vcc, 2, v139
    s_bfm_b32 s63, s17, 0
    s_min_u32 s70, s62, 4
    buffer_load_dwordx4 v[188:191], v118, s[64:67], 0 offen offset:16
    v_cndmask_b32 v32, 0, v146, vcc
    v_cndmask_b32 v33, v146, 0, vcc
    v_cndmask_b32 v34, 0, v146, vcc
    v_cndmask_b32 v35, v146, 0, vcc
    v_cmp_eq_u32 vcc, 0, v144
    v_mul_u32_u24 v120, 37, v150
    v_lshrrev_b32 v120, 8, v120
    v_cndmask_b32 v40, 0, v145, vcc
    v_cndmask_b32 v41, v145, 0, vcc
    v_cndmask_b32 v42, 0, v145, vcc
    v_cndmask_b32 v43, v145, 0, vcc
    v_cmp_eq_u32 vcc, v123, v136
    v_mul_u32_u24 v121, 7, v120
    v_sub_u32 v121, v150, v121
    v_cndmask_b32 v182, 0, v32, vcc
    v_cndmask_b32 v183, 0, v33, vcc
    v_lshrrev_b32 v120, 2, v120
    v_lshrrev_b32 v121, 2, v121
    s_lshr_b32 s83, s44, 8
    s_cselect_b32 s70, 0, s70
    s_waitcnt vmcnt(9)
    s_barrier
    global_load_ushort v124, v124, s[46:47]
    v_and_b32 v120, s5, v120
    v_and_b32 v121, s6, v121
    v_lshl_or_b32 v120, v120, 1, v121
    v_mul_u32_u24 v181, 37, v154
    v_lshrrev_b32 v181, 8, v181
    v_mul_u32_u24 v121, 7, v181
    v_sub_u32 v121, v154, v121
    v_lshrrev_b32 v181, 2, v181
    v_lshrrev_b32 v121, 2, v121
    v_and_b32 v181, s5, v181
    v_and_b32 v121, s6, v121
    v_lshl_or_b32 v181, v181, 1, v121
    s_mov_b32 s71, 1
    buffer_load_dwordx4 v130, s[48:51], 0 offen lds
    v_mul_u32_u24 v121, 37, v157
    v_lshrrev_b32 v121, 8, v121
    v_mul_u32_u24 v125, 7, v121
    v_sub_u32 v125, v157, v125
    v_lshrrev_b32 v121, 2, v121
    v_lshrrev_b32 v125, 2, v125
    v_and_b32 v121, s5, v121
    v_and_b32 v125, s6, v125
    v_lshl_or_b32 v121, v121, 1, v125
    v_mul_u32_u24 v125, 6, v128
    v_sub_u32 v154, v122, v125
    v_mul_u32_u24 v125, 384, v128
    v_lshl_add_u32 v125, v154, 4, v125
    v_add_u32 v128, s78, v125
    v_add_u32 v125, s77, v125
    buffer_load_dwordx4 v132, s[48:51], 0 offen offset:1024 lds
    s_waitcnt vmcnt(10)
    ds_read_b64_tr_b16 a[72:73], v140 offset:0
    ds_read_b64_tr_b16 a[74:75], v140 offset:768
    ds_read_b64_tr_b16 a[96:97], v140 offset:32
    ds_read_b64_tr_b16 a[98:99], v140 offset:800
    ds_read_b64_tr_b16 a[120:121], v140 offset:64
    ds_read_b64_tr_b16 a[122:123], v140 offset:832
    v_cmp_gt_i32 vcc, 4, v154
    v_mul_u32_u24 v154, 6, v129
    v_sub_u32 v157, v122, v154
    v_cndmask_b32 v128, v128, v125, vcc
    v_mul_u32_u24 v154, 384, v129
    v_lshl_add_u32 v154, v157, 4, v154
    v_add_u32 v125, s78, v154
    v_add_u32 v154, s77, v154
    v_cmp_gt_i32 vcc, -60, v157
    v_mul_u32_u24 v157, 6, v131
    v_sub_u32 v122, v122, v157
    v_cndmask_b32 v129, v125, v154, vcc
    v_mul_u32_u24 v157, 384, v131
    v_lshl_add_u32 v157, v122, 4, v157
    v_add_u32 v125, s78, v157
    v_add_u32 v157, s77, v157
    v_cmp_gt_i32 vcc, -124, v122
    v_mul_u32_u24 v122, 96, v126
    v_add3_u32 v192, v122, v147, s68
    v_cndmask_b32 v131, v125, v157, vcc
    v_cmp_gt_u32 vcc, 4, v152
    v_lshl_add_u32 v193, v123, 3, v122
    v_add3_u32 v193, v193, 64, s68
    v_cndmask_b32 v152, v133, v127, vcc
    v_cmp_gt_u32 vcc, 4, v149
    v_add3_u32 v194, v122, v147, s69
    v_lshl_add_u32 v195, v123, 3, v122
    v_cndmask_b32 v149, v164, v135, vcc
    v_add3_u32 v15, v15, v152, v149
    s_and_b32 s77, s2, 0xf8
    s_add_u32 s77, s77, 4940
    buffer_load_dwordx4 v134, s[48:51], 0 offen offset:2048 lds
    s_add_u32 s48, s48, 36864
    s_addc_u32 s49, s49, 0
    s_add_u32 m0, s69, 3072
    v_add3_u32 v18, v18, v152, v149
    v_cmp_gt_u32 vcc, 4, v155
    v_add3_u32 v195, v195, 64, s69
    s_mul_i32 s78, s77, 58255
    v_cndmask_b32 v155, v133, v127, vcc
    v_cmp_gt_u32 vcc, 4, v156
    s_lshr_b32 s78, s78, 22
    s_nop 0
    v_cndmask_b32 v156, v164, v135, vcc
    v_add3_u32 v16, v16, v155, v156
    v_add3_u32 v19, v19, v155, v156
    v_cmp_gt_u32 vcc, 4, v158
    buffer_load_dwordx4 v130, s[48:51], 0 offen lds
    s_nop 0
    v_cndmask_b32 v158, v133, v127, vcc
    v_cmp_gt_u32 vcc, 4, v148
    s_nop 0
    s_nop 0
    v_cndmask_b32 v148, v164, v135, vcc
    v_add3_u32 v17, v17, v158, v148
    v_add3_u32 v20, v20, v158, v148
    v_cmp_gt_u32 vcc, 2, v123
    s_nop 0
    s_nop 0
    v_cndmask_b32 v160, v153, v160, vcc
    v_lshl_add_u32 v160, v136, 9, v160
    v_lshl_add_u32 v160, v139, 1, v160
    v_cmp_gt_u32 vcc, 3, v123
    s_waitcnt vmcnt(9)
    buffer_load_dwordx4 v132, s[48:51], 0 offen offset:1024 lds
    ds_read_b64_tr_b16 a[76:77], v140 offset:3072
    s_waitcnt vmcnt(8)
    ds_read_b64_tr_b16 a[78:79], v140 offset:3840
    s_waitcnt vmcnt(7)
    ds_read_b64_tr_b16 a[100:101], v140 offset:3104
    s_waitcnt vmcnt(6)
    ds_read_b64_tr_b16 a[102:103], v140 offset:3872
    ds_read_b64_tr_b16 a[124:125], v140 offset:3136
    ds_read_b64_tr_b16 a[126:127], v140 offset:3904
    v_cndmask_b32 v184, v184, v185, s[90:91]
    v_cndmask_b32 v186, v186, v187, s[90:91]
    v_perm_b32 v136, v186, v184, v137
    v_cndmask_b32 v188, v188, v189, s[90:91]
    v_cndmask_b32 v190, v190, v191, s[90:91]
    v_perm_b32 v137, v190, v188, v137
    buffer_load_dwordx4 v134, s[48:51], 0 offen offset:2048 lds
    s_waitcnt vmcnt(6)
    s_add_u32 s48, s48, 36864
    s_addc_u32 s49, s49, 0
    s_add_u32 m0, s72, 0
    v_bfe_u32 v116, v172, v147, 16
    v_bfe_u32 v164, v173, v147, 16
    v_bfe_u32 v118, v174, v147, 16
    v_mfma_f32_16x16x16_bf16 v[144:147], v[166:167], v[116:117], 0
    v_lshlrev_b32 v124, 16, v124
    v_max_f32 v124, 0xc2c80000, v124
    v_min_f32 v124, 0x40930000, v124
    v_mfma_f32_16x16x16_bf16 v[148:151], v[166:167], v[164:165], 0
    v_mul_f32 v124, 0x3fb8aa3b, v124
    v_exp_f32 v124, v124
    v_mfma_f32_16x16x16_bf16 v[152:155], v[166:167], v[118:119], 0
    buffer_load_dwordx4 v130, s[48:51], 0 offen lds
    v_max_f32 v144, 0, v144
    v_max_f32 v145, 0, v145
    v_max_f32 v146, 0, v146
    v_max_f32 v147, 0, v147
    v_cvt_pk_bf16_f32 v156, v144, v145
    v_cvt_pk_bf16_f32 v157, v146, v147
    v_max_f32 v148, 0, v148
    v_max_f32 v149, 0, v149
    v_mfma_f32_16x16x16_bf16 v[116:119], v[136:137], v[156:157], 0
    v_max_f32 v150, 0, v150
    v_max_f32 v151, 0, v151
    v_cvt_pk_bf16_f32 v156, v148, v149
    v_cvt_pk_bf16_f32 v157, v150, v151
    v_max_f32 v152, 0, v152
    v_max_f32 v153, 0, v153
    v_mfma_f32_16x16x16_bf16 v[144:147], v[136:137], v[156:157], 0
    buffer_load_dwordx4 v132, s[48:51], 0 offen offset:1024 lds
    v_cvt_pk_bf16_f32 v116, v116, v116
    v_and_b32 v116, 0xffff0000, v116
    v_mul_f32 v116, 0xbfb8aa3b, v116
    v_exp_f32 v116, v116
    v_max_f32 v154, 0, v154
    v_add_f32 v116, 1.0, v116
    v_rcp_f32 v116, v116
    v_cvt_pk_bf16_f32 v144, v144, v144
    v_cvt_pk_bf16_f32 v116, v116, v116
    v_and_b32 v116, 0xffff0000, v116
    v_add_f32 v116, -0.5, v116
    v_mul_f32 v116, 0x41b8aa3b, v116
    ds_write_b32 v138, v116 offset:0
    buffer_load_dwordx4 v134, s[48:51], 0 offen offset:2048 lds
    s_add_u32 s48, s48, 36864
    s_addc_u32 s49, s49, 0
    s_add_u32 m0, s72, 3072
    v_and_b32 v144, 0xffff0000, v144
    v_mul_f32 v144, 0xbfb8aa3b, v144
    v_exp_f32 v144, v144
    v_max_f32 v155, 0, v155
    v_add_f32 v144, 1.0, v144
    v_rcp_f32 v144, v144
    v_cvt_pk_bf16_f32 v152, v152, v153
    v_cvt_pk_bf16_f32 v144, v144, v144
    v_and_b32 v144, 0xffff0000, v144
    v_add_f32 v144, -0.5, v144
    s_waitcnt vmcnt(6)
    s_mov_b32 s72, 2
    buffer_load_dwordx4 v130, s[48:51], 0 offen lds
    ds_read_b64_tr_b16 a[80:81], v141 offset:0
    ds_read_b64_tr_b16 a[82:83], v141 offset:768
    ds_read_b64_tr_b16 a[104:105], v141 offset:32
    ds_read_b64_tr_b16 a[106:107], v141 offset:800
    ds_read_b64_tr_b16 a[128:129], v141 offset:64
    ds_read_b64_tr_b16 a[130:131], v141 offset:832
    v_mul_f32 v144, 0x41b8aa3b, v144
    ds_write_b32 v138, v144 offset:4
    v_cvt_pk_bf16_f32 v153, v154, v155
    v_cvt_pk_bf16_f32 v124, v124, v124
    v_and_b32 v124, 0xffff0000, v124
    v_mfma_f32_16x16x16_bf16 v[116:119], v[136:137], v[152:153], 0
    buffer_load_dwordx4 v132, s[48:51], 0 offen offset:1024 lds
    v_mul_f32 v122, 0x3fb8aa3b, v124
    v_readfirstlane_b32 s37, v124
    v_readfirstlane_b32 s31, v122
    v_cndmask_b32 v7, v161, v160, vcc
    v_cmp_gt_u32 vcc, 12, v126
    s_nop 0
    s_nop 0
    v_cvt_pk_bf16_f32 v116, v116, v116
    v_and_b32 v116, 0xffff0000, v116
    v_mul_f32 v116, 0xbfb8aa3b, v116
    v_exp_f32 v116, v116
    v_cndmask_b32 v178, v162, v178, vcc
    v_add_f32 v116, 1.0, v116
    v_rcp_f32 v116, v116
    buffer_load_dwordx4 v134, s[48:51], 0 offen offset:2048 lds
    s_sub_u32 s48, s48, 184704
    s_subb_u32 s49, s49, 0
    s_add_u32 m0, s73, 0
    v_cvt_pk_bf16_f32 v116, v116, v116
    v_and_b32 v116, 0xffff0000, v116
    v_add_f32 v116, -0.5, v116
    v_mul_f32 v116, 0x41b8aa3b, v116
    ds_write_b32 v138, v116 offset:8
    v_cndmask_b32 v179, v162, v179, vcc
    v_cmp_gt_u32 vcc, 3, v123
    s_nop 0
    s_waitcnt vmcnt(6)
    buffer_load_dwordx4 v130, s[48:51], 0 offen lds
    ds_read_b64_tr_b16 a[84:85], v141 offset:3072
    ds_read_b64_tr_b16 a[86:87], v141 offset:3840
    ds_read_b64_tr_b16 a[108:109], v141 offset:3104
    ds_read_b64_tr_b16 a[110:111], v141 offset:3872
    ds_read_b64_tr_b16 a[132:133], v141 offset:3136
    ds_read_b64_tr_b16 a[134:135], v141 offset:3904
    v_cndmask_b32 v177, v162, v177, vcc
    v_cmp_ne_u32 vcc, s92, v120
    s_nop 0
    s_nop 0
    v_cndmask_b32 v122, 0, v163, vcc
    v_cmp_ne_u32 vcc, s92, v120
    s_nop 0
    s_nop 0
    v_cndmask_b32 v133, 0, v163, vcc
    buffer_load_dwordx4 v132, s[48:51], 0 offen offset:1024 lds
    v_cmp_ne_u32 vcc, s92, v181
    s_waitcnt lgkmcnt(6)
    s_barrier
    ds_read_b32 v22, v22 offset:0
    ds_read_b32 v23, v23 offset:672
    ds_read_b32 v24, v24 offset:0
    ds_read_b32 v25, v25 offset:672
    ds_read_b32 v26, v26 offset:0
    ds_read_b32 v27, v27 offset:672
    ds_read_b32 v48, v48 offset:336
    ds_read_b32 v60, v60 offset:336
    ds_read_b32 v72, v72 offset:336
    ds_read_b32 v49, v49 offset:332
    buffer_load_dwordx4 v134, s[48:51], 0 offen offset:2048 lds
    ds_read_b32 v61, v61 offset:332
    ds_read_b32 v73, v73 offset:332
    ds_read_b32 v50, v50 offset:328
    s_add_u32 s48, s48, 36864
    ds_read_b32 v62, v62 offset:328
    s_addc_u32 s49, s49, 0
    ds_read_b32 v74, v74 offset:328
    s_add_u32 m0, s73, 3072
    ds_read_b32 v51, v51 offset:324
    s_mov_b32 s73, 3
    ds_read_b32 v63, v63 offset:324
    ds_read_b32 v75, v75 offset:324
    s_waitcnt lgkmcnt(15)
    s_waitcnt vmcnt(6)
    ds_read_b64_tr_b16 a[88:89], v143 offset:0
    buffer_load_dwordx4 v130, s[48:51], 0 offen lds
    ds_read_b64_tr_b16 a[90:91], v143 offset:768
    ds_read_b64_tr_b16 a[112:113], v143 offset:32
    ds_read_b64_tr_b16 a[114:115], v143 offset:800
    ds_read_b64_tr_b16 a[136:137], v143 offset:64
    ds_read_b64_tr_b16 a[138:139], v143 offset:832
    ds_read_b32 v52, v52 offset:272
    ds_read_b32 v64, v64 offset:272
    ds_read_b32 v76, v76 offset:272
    ds_read_b32 v53, v53 offset:268
    buffer_load_dwordx4 v132, s[48:51], 0 offen offset:1024 lds
    ds_read_b32 v65, v65 offset:268
    ds_read_b32 v77, v77 offset:268
    ds_read_b32 v54, v54 offset:264
    ds_read_b32 v66, v66 offset:264
    ds_read_b32 v78, v78 offset:264
    ds_read_b32 v55, v55 offset:260
    ds_read_b32 v67, v67 offset:260
    ds_read_b32 v79, v79 offset:260
    ds_read_b32 v56, v56 offset:208
    buffer_load_dwordx4 v134, s[48:51], 0 offen offset:2048 lds
    ds_read_b32 v68, v68 offset:208
    ds_read_b32 v80, v80 offset:208
    ds_read_b32 v57, v57 offset:204
    s_add_u32 s48, s48, 36864
    ds_read_b32 v69, v69 offset:204
    s_addc_u32 s49, s49, 0
    ds_read_b32 v81, v81 offset:204
    s_add_u32 m0, s68, 0
    ds_read_b32 v58, v58 offset:200
    ds_read_b32 v70, v70 offset:200
    ds_read_b32 v82, v82 offset:200
    ds_read_b32 v59, v59 offset:196
    buffer_load_dwordx4 v130, s[48:51], 0 offen lds
    s_waitcnt vmcnt(7)
    ds_read_b64_tr_b16 a[92:93], v143 offset:3072
    ds_read_b64_tr_b16 a[94:95], v143 offset:3840
    ds_read_b64_tr_b16 a[116:117], v143 offset:3104
    ds_read_b64_tr_b16 a[118:119], v143 offset:3872
    ds_read_b64_tr_b16 a[140:141], v143 offset:3136
    ds_read_b64_tr_b16 a[142:143], v143 offset:3904
    ds_read_b32 v71, v71 offset:196
    ds_read_b32 v83, v83 offset:196
    ds_read_b32 v159, v159 offset:336
    buffer_load_dwordx4 v132, s[48:51], 0 offen offset:1024 lds
    v_add_f32 v22, v22, v122
    v_add_f32 v23, v23, v133
    v_cndmask_b32 v122, 0, v163, vcc
    v_add_f32 v24, v24, v122
    v_cmp_ne_u32 vcc, s92, v181
    v_lshl_add_u32 v143, v123, 2, 0
    v_mul_u32_u24 v122, 37, v143
    v_cndmask_b32 v133, 0, v163, vcc
    s_waitcnt lgkmcnt(9)
    v_add_f32 v25, v25, v133
    v_cmp_ne_u32 vcc, s92, v121
    v_lshrrev_b32 v122, 8, v122
    v_mul_u32_u24 v133, 7, v122
    v_cndmask_b32 v135, 0, v163, vcc
    v_add_f32 v26, v26, v135
    buffer_load_dwordx4 v134, s[48:51], 0 offen offset:2048 lds
    s_add_u32 s48, s48, 36864
    s_addc_u32 s49, s49, 0
    s_add_u32 m0, s68, 3072
    v_cmp_ne_u32 vcc, s92, v121
    v_sub_u32 v133, v143, v133
    v_lshrrev_b32 v122, 2, v122
    s_waitcnt lgkmcnt(0)
    v_readfirstlane_b32 s39, v159
    v_cndmask_b32 v135, 0, v163, vcc
    v_add_f32 v27, v27, v135
    v_lshrrev_b32 v133, 2, v133
    v_and_b32 v122, s5, v122
    v_and_b32 v133, s6, v133
    v_lshl_or_b32 v122, v122, 1, v133
    v_cmp_ne_u32 vcc, v122, v120
    buffer_load_dwordx4 v130, s[48:51], 0 offen lds
    s_waitcnt vmcnt(7)
    ds_read_b64_tr_b16 a[0:1], v142 offset:0
    ds_read_b64_tr_b16 a[2:3], v142 offset:768
    ds_read_b64_tr_b16 a[24:25], v142 offset:32
    ds_read_b64_tr_b16 a[26:27], v142 offset:800
    ds_read_b64_tr_b16 a[48:49], v142 offset:64
    ds_read_b64_tr_b16 a[50:51], v142 offset:832
    v_cndmask_b32 v143, 0, v163, vcc
    v_add_f32 v48, v48, v143
    v_cmp_ne_u32 vcc, v122, v181
    v_lshl_add_u32 v143, v123, 2, 1
    v_mul_u32_u24 v135, 37, v143
    v_cndmask_b32 v133, 0, v163, vcc
    v_add_f32 v60, v60, v133
    v_cmp_ne_u32 vcc, v122, v121
    buffer_load_dwordx4 v132, s[48:51], 0 offen offset:1024 lds
    v_lshrrev_b32 v135, 8, v135
    v_cndmask_b32 v122, 0, v163, vcc
    v_add_f32 v72, v72, v122
    v_mul_u32_u24 v122, 7, v135
    v_sub_u32 v122, v143, v122
    v_lshrrev_b32 v135, 2, v135
    v_lshrrev_b32 v122, 2, v122
    v_and_b32 v135, s5, v135
    v_and_b32 v122, s6, v122
    v_lshl_or_b32 v135, v135, 1, v122
    v_cmp_ne_u32 vcc, v135, v120
    v_lshl_add_u32 v122, v123, 2, 2
    v_mul_u32_u24 v143, 37, v122
    v_cndmask_b32 v133, 0, v163, vcc
    v_add_f32 v49, v49, v133
    buffer_load_dwordx4 v134, s[48:51], 0 offen offset:2048 lds
    s_add_u32 s48, s48, 36864
    s_addc_u32 s49, s49, 0
    s_add_u32 m0, s69, 0
    v_cmp_ne_u32 vcc, v135, v181
    v_lshrrev_b32 v143, 8, v143
    v_mul_u32_u24 v133, 7, v143
    v_cndmask_b32 v160, 0, v163, vcc
    v_add_f32 v61, v61, v160
    v_cmp_ne_u32 vcc, v135, v121
    v_sub_u32 v133, v122, v133
    v_lshrrev_b32 v143, 2, v143
    v_cndmask_b32 v122, 0, v163, vcc
    v_add_f32 v73, v73, v122
    v_lshrrev_b32 v133, 2, v133
    v_and_b32 v143, s5, v143
    buffer_load_dwordx4 v130, s[48:51], 0 offen lds
    s_waitcnt vmcnt(7)
    ds_read_b64_tr_b16 a[4:5], v142 offset:3072
    ds_read_b64_tr_b16 a[6:7], v142 offset:3840
    ds_read_b64_tr_b16 a[28:29], v142 offset:3104
    ds_read_b64_tr_b16 a[30:31], v142 offset:3872
    ds_read_b64_tr_b16 a[52:53], v142 offset:3136
    ds_read_b64_tr_b16 a[54:55], v142 offset:3904
    v_and_b32 v133, s6, v133
    v_lshl_or_b32 v143, v143, 1, v133
    v_cmp_ne_u32 vcc, v143, v120
    v_lshl_add_u32 v122, v123, 2, 3
    v_mul_u32_u24 v133, 37, v122
    v_cndmask_b32 v142, 0, v163, vcc
    v_add_f32 v50, v50, v142
    v_cmp_ne_u32 vcc, v143, v181
    buffer_load_dwordx4 v132, s[48:51], 0 offen offset:1024 lds
    v_lshrrev_b32 v133, 8, v133
    v_cndmask_b32 v135, 0, v163, vcc
    v_add_f32 v62, v62, v135
    v_cmp_ne_u32 vcc, v143, v121
    v_mul_u32_u24 v135, 7, v133
    v_sub_u32 v135, v122, v135
    v_cndmask_b32 v122, 0, v163, vcc
    v_add_f32 v74, v74, v122
    v_lshrrev_b32 v133, 2, v133
    v_lshrrev_b32 v135, 2, v135
    v_and_b32 v133, s5, v133
    v_and_b32 v135, s6, v135
    v_lshl_or_b32 v133, v133, 1, v135
    v_cmp_ne_u32 vcc, v133, v120
    v_lshl_add_u32 v122, v123, 2, 16
    buffer_load_dwordx4 v134, s[48:51], 0 offen offset:2048 lds
    s_add_u32 s48, s48, 36864
    s_addc_u32 s49, s49, 0
    s_add_u32 m0, s69, 3072
    v_cndmask_b32 v135, 0, v163, vcc
    v_add_f32 v51, v51, v135
    v_cmp_ne_u32 vcc, v133, v181
    v_mul_u32_u24 v135, 37, v122
    v_lshrrev_b32 v135, 8, v135
    v_cndmask_b32 v142, 0, v163, vcc
    v_add_f32 v63, v63, v142
    v_cmp_ne_u32 vcc, v133, v121
    v_mul_u32_u24 v133, 7, v135
    v_sub_u32 v133, v122, v133
    v_cndmask_b32 v122, 0, v163, vcc
    v_add_f32 v75, v75, v122
    buffer_load_dwordx4 v130, s[48:51], 0 offen lds
    s_waitcnt vmcnt(7)
    ds_read_b64_tr_b16 a[8:9], v140 offset:0
    ds_read_b64_tr_b16 a[10:11], v140 offset:768
    ds_read_b64_tr_b16 a[32:33], v140 offset:32
    ds_read_b64_tr_b16 a[34:35], v140 offset:800
    ds_read_b64_tr_b16 a[56:57], v140 offset:64
    ds_read_b64_tr_b16 a[58:59], v140 offset:832
    v_lshrrev_b32 v135, 2, v135
    v_lshrrev_b32 v133, 2, v133
    v_and_b32 v135, s5, v135
    v_and_b32 v133, s6, v133
    v_lshl_or_b32 v135, v135, 1, v133
    v_cmp_ne_u32 vcc, v135, v120
    v_lshl_add_u32 v122, v123, 2, 17
    v_mul_u32_u24 v142, 37, v122
    buffer_load_dwordx4 v132, s[48:51], 0 offen offset:1024 lds
    v_cndmask_b32 v133, 0, v163, vcc
    v_add_f32 v52, v52, v133
    v_cmp_ne_u32 vcc, v135, v181
    v_lshrrev_b32 v142, 8, v142
    v_mul_u32_u24 v143, 7, v142
    v_cndmask_b32 v133, 0, v163, vcc
    v_add_f32 v64, v64, v133
    v_cmp_ne_u32 vcc, v135, v121
    v_sub_u32 v143, v122, v143
    v_lshrrev_b32 v142, 2, v142
    v_cndmask_b32 v122, 0, v163, vcc
    v_add_f32 v76, v76, v122
    v_lshrrev_b32 v143, 2, v143
    v_and_b32 v142, s5, v142
    v_and_b32 v143, s6, v143
    buffer_load_dwordx4 v134, s[48:51], 0 offen offset:2048 lds
    s_sub_u32 s48, s48, 183552
    s_subb_u32 s49, s49, 0
    s_add_u32 m0, s68, 0
    s_waitcnt lgkmcnt(0)
    v_lshl_or_b32 v142, v142, 1, v143
    v_cmp_ne_u32 vcc, v142, v120
    v_lshl_add_u32 v122, v123, 2, 18
    v_mul_u32_u24 v133, 37, v122
    v_cndmask_b32 v143, 0, v163, vcc
    v_add_f32 v53, v53, v143
    v_cmp_ne_u32 vcc, v142, v181
    v_lshrrev_b32 v133, 8, v133
    v_mul_u32_u24 v135, 7, v133
    v_cndmask_b32 v143, 0, v163, vcc
    v_add_f32 v65, v65, v143
    buffer_load_dwordx4 v130, s[48:51], 0 offen lds
    s_waitcnt vmcnt(7)
    ds_read_b64_tr_b16 a[12:13], v140 offset:3072
    ds_read_b64_tr_b16 a[14:15], v140 offset:3840
    ds_read_b64_tr_b16 a[36:37], v140 offset:3104
    ds_read_b64_tr_b16 a[38:39], v140 offset:3872
    ds_read_b64_tr_b16 a[60:61], v140 offset:3136
    ds_read_b64_tr_b16 a[62:63], v140 offset:3904
    v_cmp_ne_u32 vcc, v142, v121
    v_sub_u32 v135, v122, v135
    v_lshrrev_b32 v133, 2, v133
    v_cndmask_b32 v122, 0, v163, vcc
    v_add_f32 v77, v77, v122
    v_lshrrev_b32 v135, 2, v135
    v_and_b32 v133, s5, v133
    v_and_b32 v135, s6, v135
    buffer_load_dwordx4 v132, s[48:51], 0 offen offset:1024 lds
    v_lshl_or_b32 v133, v133, 1, v135
    v_cmp_ne_u32 vcc, v133, v120
    v_lshl_add_u32 v122, v123, 2, 19
    v_mul_u32_u24 v135, 37, v122
    v_cndmask_b32 v142, 0, v163, vcc
    v_add_f32 v54, v54, v142
    v_cmp_ne_u32 vcc, v133, v181
    v_lshrrev_b32 v135, 8, v135
    v_mul_u32_u24 v143, 7, v135
    v_cndmask_b32 v142, 0, v163, vcc
    v_add_f32 v66, v66, v142
    v_cmp_ne_u32 vcc, v133, v121
    v_sub_u32 v143, v122, v143
    v_lshrrev_b32 v135, 2, v135
    v_cndmask_b32 v122, 0, v163, vcc
    buffer_load_dwordx4 v134, s[48:51], 0 offen offset:2048 lds
    s_add_u32 s48, s48, 36864
    s_addc_u32 s49, s49, 0
    s_add_u32 m0, s68, 3072
    s_waitcnt lgkmcnt(0)
    v_add_f32 v78, v78, v122
    v_lshrrev_b32 v143, 2, v143
    v_and_b32 v135, s5, v135
    v_and_b32 v143, s6, v143
    v_lshl_or_b32 v135, v135, 1, v143
    v_cmp_ne_u32 vcc, v135, v120
    v_lshl_add_u32 v122, v123, 2, 32
    v_mul_u32_u24 v142, 37, v122
    v_cndmask_b32 v133, 0, v163, vcc
    v_add_f32 v55, v55, v133
    v_cmp_ne_u32 vcc, v135, v181
    buffer_load_dwordx4 v130, s[48:51], 0 offen lds
    s_waitcnt vmcnt(7)
    ds_read_b64_tr_b16 a[16:17], v141 offset:0
    ds_read_b64_tr_b16 a[18:19], v141 offset:768
    ds_read_b64_tr_b16 a[40:41], v141 offset:32
    ds_read_b64_tr_b16 a[42:43], v141 offset:800
    ds_read_b64_tr_b16 a[64:65], v141 offset:64
    ds_read_b64_tr_b16 a[66:67], v141 offset:832
    v_cndmask_b32 v133, 0, v163, vcc
    v_add_f32 v67, v67, v133
    v_cmp_ne_u32 vcc, v135, v121
    v_lshrrev_b32 v142, 8, v142
    v_mul_u32_u24 v133, 7, v142
    v_cndmask_b32 v143, 0, v163, vcc
    v_add_f32 v79, v79, v143
    v_sub_u32 v133, v122, v133
    buffer_load_dwordx4 v132, s[48:51], 0 offen offset:1024 lds
    v_lshrrev_b32 v142, 2, v142
    v_lshrrev_b32 v133, 2, v133
    v_and_b32 v142, s5, v142
    v_and_b32 v133, s6, v133
    v_lshl_or_b32 v142, v142, 1, v133
    v_cmp_ne_u32 vcc, v142, v120
    v_lshl_add_u32 v143, v123, 2, 33
    v_mul_u32_u24 v122, 37, v143
    v_cndmask_b32 v133, 0, v163, vcc
    v_add_f32 v56, v56, v133
    v_cmp_ne_u32 vcc, v142, v181
    v_lshrrev_b32 v122, 8, v122
    v_mul_u32_u24 v133, 7, v122
    v_cndmask_b32 v135, 0, v163, vcc
    v_add_f32 v68, v68, v135
    buffer_load_dwordx4 v134, s[48:51], 0 offen offset:2048 lds
    s_add_u32 s48, s48, 36864
    s_addc_u32 s49, s49, 0
    s_add_u32 m0, s69, 0
    s_waitcnt lgkmcnt(0)
    v_cmp_ne_u32 vcc, v142, v121
    v_sub_u32 v133, v143, v133
    v_lshrrev_b32 v122, 2, v122
    v_cndmask_b32 v135, 0, v163, vcc
    v_add_f32 v80, v80, v135
    v_lshrrev_b32 v133, 2, v133
    v_and_b32 v122, s5, v122
    v_and_b32 v133, s6, v133
    v_lshl_or_b32 v122, v122, 1, v133
    v_cmp_ne_u32 vcc, v122, v120
    v_lshl_add_u32 v133, v123, 2, 34
    buffer_load_dwordx4 v130, s[48:51], 0 offen lds
    s_waitcnt vmcnt(7)
    ds_read_b64_tr_b16 a[20:21], v141 offset:3072
    ds_read_b64_tr_b16 a[22:23], v141 offset:3840
    ds_read_b64_tr_b16 a[44:45], v141 offset:3104
    ds_read_b64_tr_b16 a[46:47], v141 offset:3872
    ds_read_b64_tr_b16 a[68:69], v141 offset:3136
    ds_read_b64_tr_b16 a[70:71], v141 offset:3904
    v_cndmask_b32 v135, 0, v163, vcc
    v_add_f32 v57, v57, v135
    v_cmp_ne_u32 vcc, v122, v181
    v_mul_u32_u24 v135, 37, v133
    v_lshrrev_b32 v135, 8, v135
    v_cndmask_b32 v142, 0, v163, vcc
    v_add_f32 v69, v69, v142
    v_cmp_ne_u32 vcc, v122, v121
    buffer_load_dwordx4 v132, s[48:51], 0 offen offset:1024 lds
    v_mul_u32_u24 v142, 7, v135
    v_cndmask_b32 v122, 0, v163, vcc
    v_add_f32 v81, v81, v122
    v_sub_u32 v142, v133, v142
    v_lshrrev_b32 v135, 2, v135
    v_lshrrev_b32 v142, 2, v142
    v_and_b32 v135, s5, v135
    v_and_b32 v142, s6, v142
    v_lshl_or_b32 v135, v135, 1, v142
    v_cmp_ne_u32 vcc, v135, v120
    v_lshl_add_u32 v133, v123, 2, 35
    v_mul_u32_u24 v142, 37, v133
    v_cndmask_b32 v143, 0, v163, vcc
    v_add_f32 v58, v58, v143
    v_cmp_ne_u32 vcc, v135, v181
    buffer_load_dwordx4 v134, s[48:51], 0 offen offset:2048 lds
    s_add_u32 s48, s48, 36864
    s_addc_u32 s49, s49, 0
    s_add_u32 m0, s69, 3072
    s_waitcnt lgkmcnt(0)
    v_cndmask_b32 v143, 0, v163, vcc
    v_add_f32 v70, v70, v143
    v_cmp_ne_u32 vcc, v135, v121
    v_lshrrev_b32 v142, 8, v142
    v_mul_u32_u24 v143, 7, v142
    v_cndmask_b32 v135, 0, v163, vcc
    v_add_f32 v82, v82, v135
    v_sub_u32 v143, v133, v143
    v_lshrrev_b32 v142, 2, v142
    v_lshrrev_b32 v143, 2, v143
    v_and_b32 v142, s5, v142
    buffer_load_dwordx4 v130, s[48:51], 0 offen lds
    s_waitcnt vmcnt(7)
    ds_read_b64_tr_b16 a[144:145], v140 offset:0
    ds_read_b64_tr_b16 a[146:147], v140 offset:768
    ds_read_b64_tr_b16 a[168:169], v140 offset:32
    ds_read_b64_tr_b16 a[170:171], v140 offset:800
    ds_read_b64_tr_b16 a[192:193], v140 offset:64
    ds_read_b64_tr_b16 a[194:195], v140 offset:832
    v_and_b32 v143, s6, v143
    v_lshl_or_b32 v142, v142, 1, v143
    v_cmp_ne_u32 vcc, v142, v120
    v_cndmask_b32 v22, v180, v22, s[88:89]
    v_cndmask_b32 v24, v180, v24, s[88:89]
    v_cndmask_b32 v143, 0, v163, vcc
    v_add_f32 v59, v59, v143
    v_cmp_ne_u32 vcc, v142, v181
    buffer_load_dwordx4 v132, s[48:51], 0 offen offset:1024 lds
    v_cndmask_b32 v26, v180, v26, s[88:89]
    v_cndmask_b32 v143, 0, v163, vcc
    v_add_f32 v71, v71, v143
    v_cmp_ne_u32 vcc, v142, v121
    v_mov_b32 v116, 0
    v_mov_b32 v117, 0
    v_cndmask_b32 v181, 0, v163, vcc
    v_add_f32 v83, v83, v181
    ds_read_b128 v[120:123], v168 offset:0
    ds_read_b128 v[144:147], v169 offset:0
    ds_read_b128 v[136:139], v168 offset:128
    ds_read_b128 v[124:127], v169 offset:128
    buffer_load_dwordx4 v134, s[48:51], 0 offen offset:2048 lds
    s_add_u32 s48, s48, 36864
    ds_read_b128 v[148:151], v168 offset:256
    s_addc_u32 s49, s49, 0
    s_add_u32 m0, s68, 0
    s_waitcnt lgkmcnt(5)
    ds_read_b128 v[152:155], v169 offset:256
    v_mov_b32 v118, 0
    v_mov_b32 v119, 0
    ds_write_b128 v171, v[116:119] offset:16
    buffer_load_dwordx4 v130, s[48:51], 0 offen lds
    s_waitcnt vmcnt(7)
    s_waitcnt lgkmcnt(6)
    v_mfma_f32_16x16x32_bf16 v[164:167], a[72:75], v[120:123], 0
    s_waitcnt lgkmcnt(5)
    v_mfma_f32_16x16x32_bf16 v[164:167], a[76:79], v[144:147], v[164:167]
    s_waitcnt lgkmcnt(3)
    ds_read_b64_tr_b16 a[148:149], v140 offset:3072
    ds_read_b64_tr_b16 a[150:151], v140 offset:3840
    v_mfma_f32_16x16x32_bf16 v[164:167], a[80:83], v[136:139], v[164:167]
    s_waitcnt lgkmcnt(4)
    ds_read_b64_tr_b16 a[172:173], v140 offset:3104
    ds_read_b64_tr_b16 a[174:175], v140 offset:3872
    v_mfma_f32_16x16x32_bf16 v[164:167], a[84:87], v[124:127], v[164:167]
    s_waitcnt lgkmcnt(5)
    ds_read_b64_tr_b16 a[196:197], v140 offset:3136
    buffer_load_dwordx4 v132, s[48:51], 0 offen offset:1024 lds
    v_mfma_f32_16x16x32_bf16 v[164:167], a[88:91], v[148:151], v[164:167]
    ds_read_b64_tr_b16 a[198:199], v140 offset:3904
    v_mfma_f32_16x16x32_bf16 v[164:167], a[92:95], v[152:155], v[164:167]
    ds_write_b64 v171, v[116:117] offset:56
    v_mfma_f32_16x16x32_bf16 v[184:187], a[96:99], v[120:123], 0
    v_mfma_f32_16x16x32_bf16 v[184:187], a[100:103], v[144:147], v[184:187]
    ds_write_b64 v171, v[116:117] offset:64
    v_mfma_f32_16x16x32_bf16 v[184:187], a[104:107], v[136:139], v[184:187]
    s_waitcnt lgkmcnt(6)
    buffer_load_dwordx4 v134, s[48:51], 0 offen offset:2048 lds
    s_add_u32 s48, s48, 36864
    v_mfma_f32_16x16x32_bf16 v[184:187], a[108:111], v[124:127], v[184:187]
    s_addc_u32 s49, s49, 0
    ds_read_b128 v[156:159], v168 offset:6144
    v_fma_f32 v181, v164, v164, s32
    v_mfma_f32_16x16x32_bf16 v[184:187], a[112:115], v[148:151], v[184:187]
    s_add_u32 m0, s68, 3072
    ds_read_b128 v[172:175], v169 offset:6144
    v_fmac_f32 v181, v165, v165
    v_mfma_f32_16x16x32_bf16 v[184:187], a[116:119], v[152:155], v[184:187]
    s_waitcnt lgkmcnt(4)
    ds_read_b128 v[188:191], v168 offset:6272
    v_fmac_f32 v181, v166, v166
    s_waitcnt vmcnt(6)
    v_mfma_f32_16x16x32_bf16 v[196:199], a[120:123], v[120:123], 0
    ds_read_b64_tr_b16 a[152:153], v141 offset:0
    buffer_load_dwordx4 v130, s[48:51], 0 offen lds
    v_mfma_f32_16x16x32_bf16 v[196:199], a[124:127], v[144:147], v[196:199]
    ds_read_b64_tr_b16 a[154:155], v141 offset:768
    ds_read_b64_tr_b16 a[176:177], v141 offset:32
    v_mfma_f32_16x16x32_bf16 v[196:199], a[128:131], v[136:139], v[196:199]
    ds_read_b64_tr_b16 a[178:179], v141 offset:800
    ds_read_b64_tr_b16 a[200:201], v141 offset:64
    v_mfma_f32_16x16x32_bf16 v[196:199], a[132:135], v[124:127], v[196:199]
    ds_read_b64_tr_b16 a[202:203], v141 offset:832
    ds_read_b128 v[204:207], v169 offset:6272
    v_mfma_f32_16x16x32_bf16 v[196:199], a[136:139], v[148:151], v[196:199]
    s_waitcnt lgkmcnt(9)
    ds_read_b128 v[200:203], v168 offset:6400
    ds_read_b128 v[212:215], v169 offset:6400
    v_mfma_f32_16x16x32_bf16 v[196:199], a[140:143], v[152:155], v[196:199]
    s_waitcnt lgkmcnt(10)
    buffer_load_dwordx4 v132, s[48:51], 0 offen offset:1024 lds
    v_fmac_f32 v181, v167, v167
    v_mfma_f32_16x16x32_bf16 v[208:211], a[72:75], v[156:159], 0
    s_waitcnt lgkmcnt(9)
    ds_write_b128 v178, v[116:119] offset:16
    v_mfma_f32_16x16x32_bf16 v[208:211], a[76:79], v[172:175], v[208:211]
    s_waitcnt lgkmcnt(9)
    v_fmac_f32 v181, v184, v184
    v_fmac_f32 v181, v185, v185
    v_mfma_f32_16x16x32_bf16 v[208:211], a[80:83], v[188:191], v[208:211]
    s_waitcnt lgkmcnt(7)
    v_fmac_f32 v181, v186, v186
    v_fmac_f32 v181, v187, v187
    v_mfma_f32_16x16x32_bf16 v[216:219], a[96:99], v[156:159], 0
    s_waitcnt lgkmcnt(5)
    buffer_load_dwordx4 v134, s[48:51], 0 offen offset:2048 lds
    v_fmac_f32 v181, v196, v196
    v_mfma_f32_16x16x32_bf16 v[216:219], a[100:103], v[172:175], v[216:219]
    s_waitcnt lgkmcnt(3)
    ds_write_b64 v178, v[116:117] offset:56
    v_mfma_f32_16x16x32_bf16 v[208:211], a[84:87], v[204:207], v[208:211]
    s_waitcnt lgkmcnt(2)
    v_fmac_f32 v181, v197, v197
    v_fmac_f32 v181, v198, v198
    v_mfma_f32_16x16x32_bf16 v[208:211], a[88:91], v[200:203], v[208:211]
    s_waitcnt vmcnt(6)
    ds_read_b64_tr_b16 a[156:157], v141 offset:3072
    ds_read_b64_tr_b16 a[158:159], v141 offset:3840
    v_mfma_f32_16x16x32_bf16 v[208:211], a[92:95], v[212:215], v[208:211]
    s_add_u32 m0, s28, 8192
    ds_read_b64_tr_b16 a[180:181], v141 offset:3104
    ds_read_b64_tr_b16 a[182:183], v141 offset:3872
    v_mfma_f32_16x16x32_bf16 v[216:219], a[104:107], v[188:191], v[216:219]
    buffer_load_dwordx4 v12, s[8:11], s25 offen nt lds
    v_mfma_f32_16x16x32_bf16 v[216:219], a[108:111], v[204:207], v[216:219]
    s_add_u32 m0, s28, 12288
    ds_read_b64_tr_b16 a[204:205], v141 offset:3136
    ds_read_b64_tr_b16 a[206:207], v141 offset:3904
    v_mfma_f32_16x16x32_bf16 v[216:219], a[112:115], v[200:203], v[216:219]
    ds_write_b64 v178, v[116:117] offset:64
    v_mfma_f32_16x16x32_bf16 v[216:219], a[116:119], v[212:215], v[216:219]
    v_fmac_f32 v181, v199, v199
    v_fma_f32 v130, v208, v208, s32
    v_mfma_f32_16x16x32_bf16 v[132:135], a[120:123], v[156:159], 0
    v_fmac_f32 v130, v209, v209
    v_fmac_f32 v130, v210, v210
    v_mfma_f32_16x16x32_bf16 v[132:135], a[124:127], v[172:175], v[132:135]
    s_waitcnt lgkmcnt(6)
    buffer_load_dwordx4 v13, s[8:11], s25 offen nt lds
    v_mfma_f32_16x16x32_bf16 v[132:135], a[128:131], v[188:191], v[132:135]
    s_add_u32 m0, s29, 0
    v_fmac_f32 v130, v211, v211
    v_fmac_f32 v130, v216, v216
    v_mfma_f32_16x16x32_bf16 v[132:135], a[132:135], v[204:207], v[132:135]
    s_waitcnt lgkmcnt(3)
    v_fmac_f32 v130, v217, v217
    v_fmac_f32 v130, v218, v218
    v_mfma_f32_16x16x32_bf16 v[132:135], a[136:139], v[200:203], v[132:135]
    s_waitcnt lgkmcnt(2)
    v_fmac_f32 v130, v219, v219
    v_mfma_f32_16x16x32_bf16 v[132:135], a[140:143], v[212:215], v[132:135]
    s_waitcnt lgkmcnt(0)
    v_mfma_f32_16x16x32_bf16 v[220:223], a[0:3], v[120:123], 0
    buffer_load_dwordx4 v14, s[8:11], s25 offen nt lds
    v_mfma_f32_16x16x32_bf16 v[220:223], a[4:7], v[144:147], v[220:223]
    s_add_u32 m0, s69, 0
    s_lshr_b32 s10, s17, 1
    s_cselect_b32 s10, s36, 0
    v_mfma_f32_16x16x32_bf16 v[220:223], a[8:11], v[136:139], v[220:223]
    s_waitcnt vmcnt(6)
    ds_read_b64_tr_b16 a[160:161], v140 offset:0
    ds_read_b64_tr_b16 a[162:163], v140 offset:768
    v_mfma_f32_16x16x32_bf16 v[220:223], a[12:15], v[124:127], v[220:223]
    s_mov_b32 s25, s24
    ds_read_b64_tr_b16 a[184:185], v140 offset:32
    ds_read_b64_tr_b16 a[186:187], v140 offset:800
    v_mfma_f32_16x16x32_bf16 v[220:223], a[16:19], v[148:151], v[220:223]
    ds_read_b64_tr_b16 a[208:209], v140 offset:64
    ds_read_b64_tr_b16 a[210:211], v140 offset:832
    v_mfma_f32_16x16x32_bf16 v[220:223], a[20:23], v[152:155], v[220:223]
    buffer_load_dwordx4 v128, s[52:55], 0 offen lds
    v_fmac_f32 v130, v132, v132
    v_mfma_f32_16x16x32_bf16 v[224:227], a[24:27], v[120:123], 0
    v_fmac_f32 v130, v133, v133
    v_fmac_f32 v130, v134, v134
    v_mfma_f32_16x16x32_bf16 v[224:227], a[28:31], v[144:147], v[224:227]
    v_fmac_f32 v130, v135, v135
    v_xor_b32 v228, 65536, v2
    v_mfma_f32_16x16x32_bf16 v[224:227], a[32:35], v[136:139], v[224:227]
    v_fma_f32 v229, v220, v220, s32
    v_fmac_f32 v229, v221, v221
    v_mfma_f32_16x16x32_bf16 v[224:227], a[36:39], v[124:127], v[224:227]
    v_fmac_f32 v229, v222, v222
    v_fmac_f32 v229, v223, v223
    v_mfma_f32_16x16x32_bf16 v[224:227], a[40:43], v[148:151], v[224:227]
    s_waitcnt lgkmcnt(4)
    buffer_load_dwordx4 v129, s[52:55], 0 offen offset:1024 lds
    v_lshrrev_b32 v230, 2, v228
    v_mfma_f32_16x16x32_bf16 v[224:227], a[44:47], v[152:155], v[224:227]
    s_waitcnt lgkmcnt(2)
    v_lshrrev_b32 v231, 8, v228
    v_lshl_add_u32 v240, s16, 2, v228
    v_mfma_f32_16x16x32_bf16 v[236:239], a[48:51], v[120:123], 0
    s_waitcnt lgkmcnt(0)
    v_add_u32 v230, 62784, v230
    v_lshlrev_b32 v231, 4, v231
    v_mfma_f32_16x16x32_bf16 v[236:239], a[52:55], v[144:147], v[236:239]
    v_fmac_f32 v229, v224, v224
    v_fmac_f32 v229, v225, v225
    v_mfma_f32_16x16x32_bf16 v[236:239], a[56:59], v[136:139], v[236:239]
    v_fmac_f32 v229, v226, v226
    v_fmac_f32 v229, v227, v227
    v_mfma_f32_16x16x32_bf16 v[236:239], a[60:63], v[124:127], v[236:239]
    buffer_load_dwordx4 v131, s[52:55], 0 offen offset:2048 lds
    v_add_u32 v231, 62784, v231
    v_mfma_f32_16x16x32_bf16 v[236:239], a[64:67], v[148:151], v[236:239]
    s_waitcnt vmcnt(6)
    ds_read_b64_tr_b16 a[164:165], v140 offset:3072
    ds_read_b64_tr_b16 a[166:167], v140 offset:3840
    v_mfma_f32_16x16x32_bf16 v[236:239], a[68:71], v[152:155], v[236:239]
    s_add_u32 s52, s52, 12288
    ds_read_b64_tr_b16 a[188:189], v140 offset:3104
    ds_read_b64_tr_b16 a[190:191], v140 offset:3872
    v_mfma_f32_16x16x32_bf16 v[120:123], a[0:3], v[156:159], 0
    s_addc_u32 s53, s53, 0
    ds_read_b64_tr_b16 a[212:213], v140 offset:3136
    ds_read_b64_tr_b16 a[214:215], v140 offset:3904
    v_mfma_f32_16x16x32_bf16 v[120:123], a[4:7], v[172:175], v[120:123]
    s_add_u32 m0, s69, 3072
    v_fmac_f32 v229, v236, v236
    v_fmac_f32 v229, v237, v237
    v_mfma_f32_16x16x32_bf16 v[120:123], a[8:11], v[188:191], v[120:123]
    buffer_load_dwordx4 v128, s[52:55], 0 offen lds
    v_fmac_f32 v229, v238, v238
    v_mfma_f32_16x16x32_bf16 v[120:123], a[12:15], v[204:207], v[120:123]
    v_fmac_f32 v229, v239, v239
    v_cvt_pk_bf16_f32 v36, v229, v181
    v_mfma_f32_16x16x32_bf16 v[120:123], a[16:19], v[200:203], v[120:123]
    v_or_b32 v124, v32, v33
    v_and_b32 v124, 0xffff, v124
    v_mfma_f32_16x16x32_bf16 v[152:155], v[32:35], v[36:39], 0
    v_lshl_or_b32 v124, v124, 16, v124
    v_or_b32 v125, v32, v33
    v_mfma_f32_16x16x32_bf16 v[120:123], a[20:23], v[212:215], v[120:123]
    s_waitcnt lgkmcnt(4)
    v_and_b32 v125, 0xffff, v125
    v_lshl_or_b32 v125, v125, 16, v125
    v_mfma_f32_16x16x32_bf16 v[244:247], a[24:27], v[156:159], 0
    s_waitcnt lgkmcnt(2)
    buffer_load_dwordx4 v129, s[52:55], 0 offen offset:1024 lds
    v_or_b32 v126, v32, v33
    v_mfma_f32_16x16x32_bf16 v[244:247], a[28:31], v[172:175], v[244:247]
    s_waitcnt lgkmcnt(0)
    v_rsq_f32 v153, v153
    v_mfma_f32_16x16x32_bf16 v[244:247], a[32:35], v[188:191], v[244:247]
    v_rsq_f32 v152, v152
    v_mfma_f32_16x16x32_bf16 v[244:247], a[36:39], v[204:207], v[244:247]
    ds_read_b128 v[232:235], v0 offset:20480
    v_mul_f32 v152, s31, v152
    v_mfma_f32_16x16x32_bf16 v[244:247], a[40:43], v[200:203], v[244:247]
    ds_read_b128 v[248:251], v1 offset:20480
    v_mul_f32 v164, v153, v164
    v_mfma_f32_16x16x32_bf16 v[244:247], a[44:47], v[212:215], v[244:247]
    buffer_load_dwordx4 v131, s[52:55], 0 offen offset:2048 lds
    ds_read_b128 v[160:163], v0 offset:20608
    v_mfma_f32_16x16x32_bf16 v[252:255], a[48:51], v[156:159], 0
    s_add_u32 s52, s52, 12288
    ds_read_b128 v[136:139], v1 offset:20608
    v_mul_f32 v165, v153, v165
    v_mfma_f32_16x16x32_bf16 v[252:255], a[52:55], v[172:175], v[252:255]
    s_addc_u32 s53, s53, 0
    ds_read_b128 v[116:119], v0 offset:20736
    v_cvt_pk_f16_f32 v144, v164, v165
    v_mfma_f32_16x16x32_bf16 v[252:255], a[56:59], v[188:191], v[252:255]
    s_add_u32 m0, s68, 0
    ds_read_b128 v[172:175], v1 offset:20736
    v_mul_f32 v166, v153, v166
    v_mfma_f32_16x16x32_bf16 v[252:255], a[60:63], v[204:207], v[252:255]
    v_mul_f32 v167, v153, v167
    v_cvt_pk_f16_f32 v145, v166, v167
    v_mfma_f32_16x16x32_bf16 v[252:255], a[64:67], v[200:203], v[252:255]
    buffer_load_dwordx4 v128, s[52:55], 0 offen lds
    v_mul_f32 v184, v153, v184
    v_mfma_f32_16x16x32_bf16 v[252:255], a[68:71], v[212:215], v[252:255]
    s_waitcnt lgkmcnt(5)
    v_mul_f32 v185, v153, v185
    v_cvt_pk_f16_f32 v146, v184, v185
    v_mfma_f32_16x16x32_bf16 v[140:143], a[96:99], v[232:235], 0
    s_waitcnt lgkmcnt(4)
    v_mul_f32 v186, v153, v186
    v_mul_f32 v187, v153, v187
    v_mfma_f32_16x16x32_bf16 v[140:143], a[100:103], v[248:251], v[140:143]
    s_waitcnt lgkmcnt(3)
    v_cvt_pk_f16_f32 v147, v186, v187
    v_mul_f32 v196, v153, v196
    v_mfma_f32_16x16x32_bf16 v[140:143], a[104:107], v[160:163], v[140:143]
    s_waitcnt lgkmcnt(2)
    ds_write_b128 v171, v[144:147]
    v_mfma_f32_16x16x32_bf16 v[140:143], a[108:111], v[136:139], v[140:143]
    s_waitcnt lgkmcnt(1)
    v_mul_f32 v197, v153, v197
    v_cvt_pk_f16_f32 v190, v196, v197
    v_mfma_f32_16x16x32_bf16 v[140:143], a[112:115], v[116:119], v[140:143]
    v_mul_f32 v198, v153, v198
    v_mul_f32 v199, v153, v199
    v_mfma_f32_16x16x32_bf16 v[140:143], a[116:119], v[172:175], v[140:143]
    v_cvt_pk_f16_f32 v191, v198, v199
    v_mul_f32 v220, v152, v220
    v_mfma_f32_16x16x32_bf16 v[144:147], a[120:123], v[232:235], 0
    ds_write_b64 v171, v[190:191] offset:48
    v_mfma_f32_16x16x32_bf16 v[144:147], a[124:127], v[248:251], v[144:147]
    v_mul_f32 v221, v152, v221
    v_cvt_pk_f16_f32 v148, v220, v221
    v_mfma_f32_16x16x32_bf16 v[144:147], a[128:131], v[160:163], v[144:147]
    v_mul_f32 v222, v152, v222
    v_mul_f32 v223, v152, v223
    v_mfma_f32_16x16x32_bf16 v[144:147], a[132:135], v[136:139], v[144:147]
    v_cvt_pk_f16_f32 v149, v222, v223
    v_mul_f32 v224, v152, v224
    v_mfma_f32_16x16x32_bf16 v[144:147], a[136:139], v[116:119], v[144:147]
    v_mul_f32 v225, v152, v225
    v_cvt_pk_f16_f32 v150, v224, v225
    v_mfma_f32_16x16x32_bf16 v[144:147], a[140:143], v[172:175], v[144:147]
    v_mul_f32 v226, v152, v226
    v_mul_f32 v227, v152, v227
    v_mfma_f32_16x16x32_bf16 v[156:159], a[24:27], v[232:235], 0
    v_cvt_pk_f16_f32 v151, v226, v227
    v_mul_f32 v236, v152, v236
    v_mfma_f32_16x16x32_bf16 v[156:159], a[28:31], v[248:251], v[156:159]
    ds_write_b128 v171, v[148:151] offset:32
    v_mfma_f32_16x16x32_bf16 v[148:151], a[72:75], v[232:235], 0
    v_mul_f32 v237, v152, v237
    v_cvt_pk_f16_f32 v188, v236, v237
    v_mfma_f32_16x16x32_bf16 v[148:151], a[76:79], v[248:251], v[148:151]
    v_mul_f32 v238, v152, v238
    v_mul_f32 v239, v152, v239
    v_mfma_f32_16x16x32_bf16 v[148:151], a[80:83], v[160:163], v[148:151]
    v_cvt_pk_f16_f32 v189, v238, v239
    v_mul_f32 v152, v220, v164
    v_mfma_f32_16x16x32_bf16 v[148:151], a[84:87], v[136:139], v[148:151]
    ds_write_b64 v171, v[188:189] offset:72
    v_mfma_f32_16x16x32_bf16 v[148:151], a[88:91], v[116:119], v[148:151]
    v_fmac_f32 v152, v221, v165
    v_fmac_f32 v152, v222, v166
    v_mfma_f32_16x16x32_bf16 v[148:151], a[92:95], v[172:175], v[148:151]
    v_fmac_f32 v152, v223, v167
    v_fmac_f32 v152, v224, v184
    v_mfma_f32_16x16x32_bf16 v[156:159], a[32:35], v[160:163], v[156:159]
    v_fmac_f32 v152, v225, v185
    v_fmac_f32 v152, v226, v186
    v_mfma_f32_16x16x32_bf16 v[156:159], a[36:39], v[136:139], v[156:159]
    v_fmac_f32 v152, v227, v187
    v_fmac_f32 v152, v236, v196
    v_mfma_f32_16x16x32_bf16 v[156:159], a[40:43], v[116:119], v[156:159]
    v_fmac_f32 v152, v237, v197
    v_fmac_f32 v152, v238, v198
    v_mfma_f32_16x16x32_bf16 v[156:159], a[44:47], v[172:175], v[156:159]
    v_fmac_f32 v152, v239, v199
    v_mov_b32 v171, v152
    v_mfma_f32_16x16x32_bf16 v[164:167], a[48:51], v[232:235], 0
    v_lshrrev_b32 v126, 16, v126
    v_lshl_or_b32 v126, v126, 16, v126
    v_mfma_f32_16x16x32_bf16 v[164:167], a[52:55], v[248:251], v[164:167]
    v_permlane32_swap_b32 v152, v171
    v_mfma_f32_16x16x32_bf16 v[164:167], a[56:59], v[160:163], v[164:167]
    v_add_f32 v152, v152, v171
    v_mov_b32 v171, v152
    v_mfma_f32_16x16x32_bf16 v[164:167], a[60:63], v[136:139], v[164:167]
    v_or_b32 v127, v32, v33
    v_lshrrev_b32 v127, 16, v127
    v_mfma_f32_16x16x32_bf16 v[164:167], a[64:67], v[116:119], v[164:167]
    v_permlane16_swap_b32 v152, v171
    v_mfma_f32_16x16x32_bf16 v[164:167], a[68:71], v[172:175], v[164:167]
    v_add_f32 v152, v152, v171
    v_add_f32 v152, s39, v152
    v_mfma_f32_16x16x32_bf16 v[184:187], v[232:235], a[144:147], 0
    v_mov_b32 v153, v180
    v_mov_b32 v154, v180
    v_mfma_f32_16x16x32_bf16 v[184:187], v[248:251], a[148:151], v[184:187]
    v_mov_b32 v155, v180
    v_cndmask_b32 v152, v180, v152, s[88:89]
    v_mfma_f32_16x16x32_bf16 v[184:187], v[160:163], a[152:155], v[184:187]
    ds_write_b128 v176, v[152:155] offset:192
    v_mfma_f32_16x16x32_bf16 v[184:187], v[136:139], a[156:159], v[184:187]
    v_lshl_or_b32 v127, v127, 16, v127
    v_fma_f32 v171, v120, v120, s32
    v_mfma_f32_16x16x32_bf16 v[184:187], v[116:119], a[160:163], v[184:187]
    v_fmac_f32 v171, v121, v121
    v_fmac_f32 v171, v122, v122
    v_mfma_f32_16x16x32_bf16 v[184:187], v[172:175], a[164:167], v[184:187]
    v_fmac_f32 v171, v123, v123
    v_fmac_f32 v171, v244, v244
    v_mfma_f32_16x16x32_bf16 v[152:155], v[232:235], a[168:171], 0
    v_fmac_f32 v171, v245, v245
    v_fmac_f32 v171, v246, v246
    v_mfma_f32_16x16x32_bf16 v[152:155], v[248:251], a[172:175], v[152:155]
    v_fmac_f32 v171, v247, v247
    v_fmac_f32 v171, v252, v252
    v_mfma_f32_16x16x32_bf16 v[152:155], v[160:163], a[176:179], v[152:155]
    v_fmac_f32 v171, v253, v253
    v_fmac_f32 v171, v254, v254
    v_mfma_f32_16x16x32_bf16 v[152:155], v[136:139], a[180:183], v[152:155]
    ds_read_b128 v[188:191], v168 offset:0
    v_fmac_f32 v171, v255, v255
    v_mfma_f32_16x16x32_bf16 v[152:155], v[116:119], a[184:187], v[152:155]
    ds_read_b128 v[196:199], v169 offset:0
    v_cvt_pk_bf16_f32 v36, v171, v130
    v_mfma_f32_16x16x32_bf16 v[152:155], v[172:175], a[188:191], v[152:155]
    ds_read_b128 v[200:203], v168 offset:128
    v_fma_f32 v130, v148, v148, s32
    v_fmac_f32 v130, v149, v149
    v_fmac_f32 v130, v150, v150
    v_fmac_f32 v130, v151, v151
    v_fmac_f32 v130, v140, v140
    v_fmac_f32 v130, v141, v141
    v_fmac_f32 v130, v142, v142
    v_fmac_f32 v130, v143, v143
    v_fmac_f32 v130, v144, v144
    v_fmac_f32 v130, v145, v145
    v_fmac_f32 v130, v146, v146
    v_fmac_f32 v130, v147, v147
    v_cvt_pk_bf16_f32 v204, v184, v185
    v_mfma_f32_16x16x32_bf16 v[212:215], v[32:35], v[36:39], 0
    v_cvt_pk_bf16_f32 v205, v186, v187
    v_cvt_pk_bf16_f32 v184, v152, v153
    v_mfma_f32_16x16x32_bf16 v[220:223], v[232:235], a[192:195], 0
    v_cvt_pk_bf16_f32 v185, v154, v155
    v_xor_b32 v2, 65536, v2
    v_mfma_f32_16x16x32_bf16 v[220:223], v[248:251], a[196:199], v[220:223]
    s_waitcnt lgkmcnt(2)
    v_mfma_f32_16x16x32_bf16 v[220:223], v[160:163], a[200:203], v[220:223]
    s_waitcnt lgkmcnt(1)
    v_rsq_f32 v213, v213
    v_mfma_f32_16x16x32_bf16 v[220:223], v[136:139], a[204:207], v[220:223]
    s_waitcnt lgkmcnt(0)
    v_rsq_f32 v212, v212
    v_mfma_f32_16x16x32_bf16 v[220:223], v[116:119], a[208:211], v[220:223]
    v_mul_f32 v212, s31, v212
    v_mul_f32 v208, v213, v208
    v_mfma_f32_16x16x32_bf16 v[220:223], v[172:175], a[212:215], v[220:223]
    v_mul_f32 v209, v213, v209
    v_cvt_pk_f16_f32 v152, v208, v209
    v_mul_f32 v210, v213, v210
    v_mul_f32 v211, v213, v211
    v_cvt_pk_f16_f32 v153, v210, v211
    v_mul_f32 v216, v213, v216
    v_mul_f32 v217, v213, v217
    v_cvt_pk_f16_f32 v154, v216, v217
    v_mul_f32 v218, v213, v218
    v_mul_f32 v219, v213, v219
    v_cvt_pk_f16_f32 v155, v218, v219
    v_mul_f32 v132, v213, v132
    v_mul_f32 v133, v213, v133
    v_cvt_pk_f16_f32 v226, v132, v133
    v_mul_f32 v134, v213, v134
    v_mul_f32 v135, v213, v135
    v_cvt_pk_f16_f32 v227, v134, v135
    v_mul_f32 v120, v212, v120
    v_mul_f32 v121, v212, v121
    v_cvt_pk_f16_f32 v236, v120, v121
    v_mul_f32 v122, v212, v122
    v_mul_f32 v123, v212, v123
    v_cvt_pk_f16_f32 v237, v122, v123
    v_mul_f32 v244, v212, v244
    v_mul_f32 v245, v212, v245
    v_cvt_pk_f16_f32 v238, v244, v245
    v_mul_f32 v246, v212, v246
    v_mul_f32 v247, v212, v247
    v_cvt_pk_f16_f32 v239, v246, v247
    v_mul_f32 v252, v212, v252
    v_mul_f32 v253, v212, v253
    v_cvt_pk_f16_f32 v224, v252, v253
    v_mul_f32 v254, v212, v254
    v_mul_f32 v255, v212, v255
    v_cvt_pk_f16_f32 v225, v254, v255
    v_mul_f32 v120, v120, v208
    v_fmac_f32 v120, v121, v209
    v_fmac_f32 v120, v122, v210
    v_fmac_f32 v120, v123, v211
    v_fmac_f32 v120, v244, v216
    v_fmac_f32 v120, v245, v217
    v_fmac_f32 v120, v246, v218
    v_mfma_f32_16x16x32_bf16 v[208:211], v[188:191], a[144:147], 0
    ds_write_b128 v178, v[152:155]
    v_mfma_f32_16x16x32_bf16 v[152:155], a[0:3], v[232:235], 0
    buffer_load_dwordx4 v129, s[52:55], 0 offen offset:1024 lds
    v_fmac_f32 v120, v247, v219
    v_mfma_f32_16x16x32_bf16 v[152:155], a[4:7], v[248:251], v[152:155]
    v_fmac_f32 v120, v252, v132
    v_fmac_f32 v120, v253, v133
    v_mfma_f32_16x16x32_bf16 v[152:155], a[8:11], v[160:163], v[152:155]
    ds_read_b128 v[160:163], v169 offset:128
    ds_read_b128 v[212:215], v168 offset:256
    v_mfma_f32_16x16x32_bf16 v[152:155], a[12:15], v[136:139], v[152:155]
    ds_read_b128 v[136:139], v169 offset:256
    v_fmac_f32 v120, v254, v134
    v_mfma_f32_16x16x32_bf16 v[152:155], a[16:19], v[116:119], v[152:155]
    ds_write_b64 v178, v[226:227] offset:48
    v_mfma_f32_16x16x32_bf16 v[152:155], a[20:23], v[172:175], v[152:155]
    buffer_load_dwordx4 v131, s[52:55], 0 offen offset:2048 lds
    v_fmac_f32 v120, v255, v135
    v_mfma_f32_16x16x32_bf16 v[208:211], v[196:199], a[148:151], v[208:211]
    s_add_u32 s52, s52, 12288
    ds_write_b128 v178, v[236:239] offset:32
    v_mfma_f32_16x16x32_bf16 v[208:211], v[200:203], a[152:155], v[208:211]
    s_addc_u32 s53, s53, 0
    v_mov_b32 v171, v120
    v_fma_f32 v229, v152, v152, s32
    v_mfma_f32_16x16x32_bf16 v[116:119], v[188:191], a[168:171], 0
    s_add_u32 m0, s68, 3072
    v_permlane32_swap_b32 v120, v171
    v_mfma_f32_16x16x32_bf16 v[116:119], v[196:199], a[172:175], v[116:119]
    s_waitcnt lgkmcnt(3)
    buffer_load_dwordx4 v128, s[52:55], 0 offen lds
    v_add_f32 v120, v120, v171
    v_mfma_f32_16x16x32_bf16 v[208:211], v[160:163], a[156:159], v[208:211]
    s_mul_i32 s68, s78, 72
    ds_write_b64 v178, v[224:225] offset:72
    v_mfma_f32_16x16x32_bf16 v[208:211], v[212:215], a[160:163], v[208:211]
    s_waitcnt lgkmcnt(2)
    v_mov_b32 v171, v120
    v_fmac_f32 v229, v153, v153
    v_mfma_f32_16x16x32_bf16 v[208:211], v[136:139], a[164:167], v[208:211]
    s_sub_u32 s68, s77, s68
    v_permlane16_swap_b32 v120, v171
    v_mfma_f32_16x16x32_bf16 v[116:119], v[200:203], a[176:179], v[116:119]
    s_mul_i32 s78, s78, 1373568
    v_add_f32 v120, v120, v171
    v_add_f32 v120, s39, v120
    v_mfma_f32_16x16x32_bf16 v[116:119], v[160:163], a[180:183], v[116:119]
    s_mul_i32 s77, s68, 2688
    buffer_load_dwordx4 v129, s[52:55], 0 offen offset:1024 lds
    ds_read_b128 v[132:135], v168 offset:6144
    v_mfma_f32_16x16x32_bf16 v[116:119], v[212:215], a[184:187], v[116:119]
    s_add_u32 s77, s77, s78
    ds_read_b128 v[216:219], v169 offset:6144
    v_mov_b32 v121, v180
    v_mfma_f32_16x16x32_bf16 v[116:119], v[136:139], a[188:191], v[116:119]
    ds_read_b128 v[172:175], v168 offset:6272
    v_mov_b32 v122, v180
    v_mfma_f32_16x16x32_bf16 v[224:227], v[188:191], a[192:195], 0
    ds_read_b128 v[232:235], v169 offset:6272
    v_mov_b32 v123, v180
    v_mfma_f32_16x16x32_bf16 v[224:227], v[196:199], a[196:199], v[224:227]
    ds_read_b128 v[188:191], v168 offset:6400
    v_cndmask_b32 v120, v180, v120, s[88:89]
    v_mfma_f32_16x16x32_bf16 v[224:227], v[200:203], a[200:203], v[224:227]
    buffer_load_dwordx4 v131, s[52:55], 0 offen offset:2048 lds
    ds_read_b128 v[196:199], v169 offset:6400
    v_mfma_f32_16x16x32_bf16 v[224:227], v[160:163], a[204:207], v[224:227]
    s_add_u32 s52, s52, 12288
    ds_write_b128 v179, v[120:123] offset:192
    s_waitcnt vmcnt(9)
    v_mfma_f32_16x16x32_bf16 v[224:227], v[212:215], a[208:211], v[224:227]
    s_waitcnt lgkmcnt(6)
    v_fmac_f32 v229, v154, v154
    v_fmac_f32 v229, v155, v155
    v_mfma_f32_16x16x32_bf16 v[224:227], v[136:139], a[212:215], v[224:227]
    s_addc_u32 s53, s53, 0
    v_fmac_f32 v229, v156, v156
    v_fmac_f32 v229, v157, v157
    v_mfma_f32_16x16x32_bf16 v[120:123], v[132:135], a[144:147], 0
    s_waitcnt lgkmcnt(4)
    ds_read_b64 a[216:217], v194 offset:0
    ds_read_b64 a[218:219], v194 offset:1536
    v_mfma_f32_16x16x32_bf16 v[120:123], v[216:219], a[148:151], v[120:123]
    s_add_u32 m0, s69, 0
    ds_read_b64 a[240:241], v194 offset:8
    ds_read_b64 a[242:243], v194 offset:1544
    v_mfma_f32_16x16x32_bf16 v[120:123], v[172:175], a[152:155], v[120:123]
    s_waitcnt lgkmcnt(6)
    ds_read_b64 v[92:93], v195 offset:0
    ds_read_b64 v[94:95], v195 offset:1536
    v_mfma_f32_16x16x32_bf16 v[120:123], v[232:235], a[156:159], v[120:123]
    s_waitcnt lgkmcnt(7)
    v_fmac_f32 v229, v158, v158
    v_fmac_f32 v229, v159, v159
    v_mfma_f32_16x16x32_bf16 v[120:123], v[188:191], a[160:163], v[120:123]
    v_fmac_f32 v229, v164, v164
    v_fmac_f32 v229, v165, v165
    v_mfma_f32_16x16x32_bf16 v[120:123], v[196:199], a[164:167], v[120:123]
    v_fmac_f32 v229, v166, v166
    v_fmac_f32 v229, v167, v167
    v_mfma_f32_16x16x32_bf16 v[136:139], v[132:135], a[168:171], 0
    v_cvt_pk_bf16_f32 v36, v229, v130
    v_cvt_pk_bf16_f32 v168, v220, v221
    v_mfma_f32_16x16x32_bf16 v[136:139], v[216:219], a[172:175], v[136:139]
    v_cvt_pk_bf16_f32 v169, v222, v223
    v_cvt_pk_bf16_f32 v208, v208, v208
    v_mfma_f32_16x16x32_bf16 v[200:203], v[32:35], v[36:39], 0
    s_waitcnt lgkmcnt(4)
    v_cvt_pk_bf16_f32 v209, v209, v209
    v_cvt_pk_bf16_f32 v210, v210, v210
    v_mfma_f32_16x16x32_bf16 v[160:163], v[124:127], a[216:219], 0
    s_waitcnt lgkmcnt(2)
    ds_write2_b32 v170, v208, v209 offset0:0 offset1:68
    s_waitcnt vmcnt(6)
    v_mfma_f32_16x16x32_bf16 v[160:163], v[124:127], a[240:243], v[160:163]
    s_waitcnt lgkmcnt(1)
    buffer_load_dwordx4 v128, s[52:55], 0 offen lds
    v_cvt_pk_bf16_f32 v211, v211, v211
    v_mfma_f32_16x16x32_bf16 v[160:163], v[124:127], v[92:95], v[160:163]
    ds_read_b64 a[232:233], v194 offset:3072
    ds_read_b64 a[220:221], v194 offset:4608
    v_mfma_f32_16x16x32_bf16 v[136:139], v[172:175], a[176:179], v[136:139]
    ds_read_b64 v[84:85], v194 offset:3080
    ds_read_b64 a[244:245], v194 offset:4616
    v_mfma_f32_16x16x32_bf16 v[136:139], v[232:235], a[180:183], v[136:139]
    ds_read_b64 v[108:109], v195 offset:3072
    ds_read_b64 v[96:97], v195 offset:4608
    v_mfma_f32_16x16x32_bf16 v[136:139], v[188:191], a[184:187], v[136:139]
    ds_write2_b32 v170, v210, v211 offset0:136 offset1:204
    v_mfma_f32_16x16x32_bf16 v[136:139], v[196:199], a[188:191], v[136:139]
    buffer_load_dwordx4 v129, s[52:55], 0 offen offset:1024 lds
    v_mov_b32 v171, v160
    v_mfma_f32_16x16x32_bf16 v[208:211], v[132:135], a[192:195], 0
    v_mov_b32_dpp v171, v161 quad_perm:[0,1,2,3] row_mask:0x2 bank_mask:0xf
    v_cvt_pk_bf16_f32 v116, v116, v116
    v_mfma_f32_16x16x32_bf16 v[208:211], v[216:219], a[196:199], v[208:211]
    v_rsq_f32 v201, v201
    v_mfma_f32_16x16x32_bf16 v[208:211], v[172:175], a[200:203], v[208:211]
    s_waitcnt lgkmcnt(6)
    v_rsq_f32 v200, v200
    v_mfma_f32_16x16x32_bf16 v[208:211], v[232:235], a[204:207], v[208:211]
    s_waitcnt lgkmcnt(4)
    v_mul_f32 v200, s31, v200
    v_mul_f32 v148, v201, v148
    v_mfma_f32_16x16x32_bf16 v[208:211], v[188:191], a[208:211], v[208:211]
    s_waitcnt lgkmcnt(2)
    buffer_load_dwordx4 v131, s[52:55], 0 offen offset:2048 lds
    v_mul_f32 v149, v201, v149
    v_mfma_f32_16x16x32_bf16 v[208:211], v[196:199], a[212:215], v[208:211]
    s_barrier
    s_barrier
    s_waitcnt vmcnt(6)
    ds_read_b64 a[222:223], v192 offset:0
    ds_read_b64 a[234:235], v192 offset:1536
    ds_read_b64 a[246:247], v192 offset:8
    ds_read_b64 v[86:87], v192 offset:1544
    ds_read_b64 v[98:99], v193 offset:0
    ds_read_b64 v[110:111], v193 offset:1536
    ds_read_b128 v[132:135], v0 offset:26624
    s_add_u32 s52, s52, 12288
    s_addc_u32 s53, s53, 0
    ds_read_b128 v[160:163], v1 offset:26624
    s_add_u32 m0, s69, 3072
    s_waitcnt lgkmcnt(8)
    buffer_load_dwordx4 v128, s[52:55], 0 offen lds
    ds_read_b128 v[172:175], v0 offset:26752
    s_add_u32 s69, s77, 589824
    ds_read_b128 v[196:199], v1 offset:26752
    ds_read_b128 v[212:215], v0 offset:26880
    ds_read_b128 v[188:191], v1 offset:26880
    v_cvt_pk_f16_f32 v148, v148, v149
    v_mul_f32 v150, v201, v150
    s_waitcnt lgkmcnt(11)
    v_mfma_f32_16x16x32_bf16 v[216:219], v[124:127], a[220:223], 0
    s_waitcnt lgkmcnt(9)
    buffer_load_dwordx4 v129, s[52:55], 0 offen offset:1024 lds
    v_mul_f32 v151, v201, v151
    v_mfma_f32_16x16x32_bf16 v[216:219], v[124:127], a[244:247], v[216:219]
    s_waitcnt lgkmcnt(5)
    v_cvt_pk_f16_f32 v149, v150, v151
    v_mul_f32 v140, v201, v140
    v_mfma_f32_16x16x32_bf16 v[216:219], v[124:127], v[96:99], v[216:219]
    s_waitcnt lgkmcnt(4)
    v_mul_f32 v141, v201, v141
    v_cvt_pk_f16_f32 v150, v140, v141
    v_mfma_f32_16x16x32_bf16 v[220:223], v[124:127], a[232:235], 0
    s_waitcnt lgkmcnt(3)
    v_mul_f32 v142, v201, v142
    v_mul_f32 v143, v201, v143
    v_mfma_f32_16x16x32_bf16 v[220:223], v[124:127], v[84:87], v[220:223]
    s_waitcnt lgkmcnt(2)
    v_mov_b32 v229, v217
    v_cvt_pk_f16_f32 v151, v142, v143
    v_mfma_f32_16x16x32_bf16 v[220:223], v[124:127], v[108:111], v[220:223]
    s_waitcnt vmcnt(5)
    buffer_load_dwordx4 v131, s[52:55], 0 offen offset:2048 lds
    ds_read_b64 a[224:225], v192 offset:3072
    v_mfma_f32_16x16x32_bf16 v[128:131], a[72:75], v[132:135], 0
    s_add_u32 m0, s28, 65536
    ds_read_b64 a[226:227], v192 offset:4608
    ds_read_b64 a[248:249], v192 offset:3080
    v_mfma_f32_16x16x32_bf16 v[128:131], a[76:79], v[160:163], v[128:131]
    s_waitcnt lgkmcnt(3)
    ds_read_b64 a[250:251], v192 offset:4616
    ds_read_b64 v[100:101], v193 offset:3072
    v_mfma_f32_16x16x32_bf16 v[128:131], a[80:83], v[172:175], v[128:131]
    ds_read_b64 v[102:103], v193 offset:4608
    v_mov_b32_dpp v171, v220 quad_perm:[0,1,2,3] row_mask:0x4 bank_mask:0xf
    v_mfma_f32_16x16x32_bf16 v[128:131], a[84:87], v[196:199], v[128:131]
    v_mov_b32_dpp v171, v216 quad_perm:[0,1,2,3] row_mask:0x8 bank_mask:0xf
    v_mov_b32_dpp v229, v221 quad_perm:[0,1,2,3] row_mask:0x2 bank_mask:0xf
    v_mfma_f32_16x16x32_bf16 v[128:131], a[88:91], v[212:215], v[128:131]
    buffer_load_dwordx4 v10, s[8:11], s24 offen nt lds
    v_mfma_f32_16x16x32_bf16 v[128:131], a[92:95], v[188:191], v[128:131]
    s_add_u32 m0, s28, 69632
    ds_write_b32 v240, v171 offset:18432
    v_mfma_f32_16x16x32_bf16 v[140:143], a[96:99], v[132:135], 0
    v_mul_f32 v144, v201, v144
    v_mul_f32 v145, v201, v145
    v_mfma_f32_16x16x32_bf16 v[140:143], a[100:103], v[160:163], v[140:143]
    s_waitcnt lgkmcnt(6)
    v_cvt_pk_f16_f32 v218, v144, v145
    v_mul_f32 v146, v201, v146
    v_mfma_f32_16x16x32_bf16 v[140:143], a[104:107], v[172:175], v[140:143]
    s_waitcnt lgkmcnt(4)
    v_mul_f32 v147, v201, v147
    v_cvt_pk_f16_f32 v219, v146, v147
    v_mfma_f32_16x16x32_bf16 v[144:147], v[124:127], a[224:227], 0
    s_waitcnt lgkmcnt(2)
    buffer_load_dwordx4 v11, s[8:11], s24 offen nt lds
    v_mfma_f32_16x16x32_bf16 v[144:147], v[124:127], a[248:251], v[144:147]
    s_waitcnt lgkmcnt(1)
    v_mul_f32 v152, v200, v152
    v_mul_f32 v153, v200, v153
    v_mfma_f32_16x16x32_bf16 v[144:147], v[124:127], v[100:103], v[144:147]
    s_add_u32 m0, s28, 73728
    v_cvt_pk_f16_f32 v152, v152, v153
    v_mul_f32 v154, v200, v154
    v_mfma_f32_16x16x32_bf16 v[140:143], a[108:111], v[196:199], v[140:143]
    v_mul_f32 v155, v200, v155
    v_cvt_pk_f16_f32 v153, v154, v155
    v_mfma_f32_16x16x32_bf16 v[140:143], a[112:115], v[212:215], v[140:143]
    v_mul_f32 v156, v200, v156
    v_mov_b32_dpp v229, v144 quad_perm:[0,1,2,3] row_mask:0x4 bank_mask:0xf
    v_mfma_f32_16x16x32_bf16 v[140:143], a[116:119], v[188:191], v[140:143]
    buffer_load_dwordx4 v12, s[8:11], s24 offen nt lds
    v_mfma_f32_16x16x32_bf16 v[220:223], a[120:123], v[132:135], 0
    s_add_u32 m0, s28, 77824
    v_mov_b32_dpp v229, v145 quad_perm:[0,1,2,3] row_mask:0x8 bank_mask:0xf
    v_mul_f32 v157, v200, v157
    v_mfma_f32_16x16x32_bf16 v[220:223], a[124:127], v[160:163], v[220:223]
    ds_write_b32 v240, v229 offset:19456
    s_waitcnt vmcnt(6)
    v_mfma_f32_16x16x32_bf16 v[220:223], a[128:131], v[172:175], v[220:223]
    v_cvt_pk_f16_f32 v154, v156, v157
    v_mul_f32 v158, v200, v158
    v_mfma_f32_16x16x32_bf16 v[220:223], a[132:135], v[196:199], v[220:223]
    ds_read_b64 a[236:237], v194 offset:0
    ds_read_b64 a[228:229], v194 offset:1536
    v_mfma_f32_16x16x32_bf16 v[220:223], a[136:139], v[212:215], v[220:223]
    buffer_load_dwordx4 v13, s[8:11], s24 offen nt lds
    v_mfma_f32_16x16x32_bf16 v[220:223], a[140:143], v[188:191], v[220:223]
    s_add_u32 m0, s74, 0
    ds_read_b64 v[88:89], v194 offset:8
    ds_read_b64 a[252:253], v194 offset:1544
    v_mfma_f32_16x16x32_bf16 v[144:147], a[0:3], v[132:135], 0
    ds_read_b64 v[112:113], v195 offset:0
    ds_read_b64 v[104:105], v195 offset:1536
    v_mfma_f32_16x16x32_bf16 v[144:147], a[4:7], v[160:163], v[144:147]
    v_mul_f32 v159, v200, v159
    v_cvt_pk_f16_f32 v155, v158, v159
    v_mfma_f32_16x16x32_bf16 v[144:147], a[8:11], v[172:175], v[144:147]
    v_mul_f32 v164, v200, v164
    v_mul_f32 v165, v200, v165
    v_mfma_f32_16x16x32_bf16 v[144:147], a[12:15], v[196:199], v[144:147]
    buffer_load_dwordx4 v14, s[8:11], s24 offen nt lds
    v_mfma_f32_16x16x32_bf16 v[144:147], a[16:19], v[212:215], v[144:147]
    s_add_u32 s8, s60, s23
    v_cvt_pk_f16_f32 v216, v164, v165
    v_mul_f32 v166, v200, v166
    v_mfma_f32_16x16x32_bf16 v[144:147], a[20:23], v[188:191], v[144:147]
    s_addc_u32 s9, s61, 0
    v_mul_f32 v167, v200, v167
    v_cvt_pk_f16_f32 v217, v166, v167
    v_mfma_f32_16x16x32_bf16 v[156:159], a[24:27], v[132:135], 0
    s_sub_u32 s10, s36, s23
    v_cvt_pk_bf16_f32 v117, v117, v117
    v_cvt_pk_bf16_f32 v118, v118, v118
    v_mfma_f32_16x16x32_bf16 v[156:159], a[28:31], v[160:163], v[156:159]
    s_cmp_lt_u32 s34, s17
    ds_write2_b32 v170, v116, v117 offset0:16 offset1:84
    v_mfma_f32_16x16x32_bf16 v[156:159], a[32:35], v[172:175], v[156:159]
    s_cselect_b32 s10, s10, 0
    v_cvt_pk_bf16_f32 v119, v119, v119
    v_cvt_pk_bf16_f32 v224, v224, v224
    v_mfma_f32_16x16x32_bf16 v[156:159], a[36:39], v[196:199], v[156:159]
    s_waitcnt vmcnt(5)
    ds_read_b64 a[230:231], v194 offset:3072
    ds_read_b64 a[238:239], v194 offset:4608
    v_mfma_f32_16x16x32_bf16 v[156:159], a[40:43], v[212:215], v[156:159]
    s_add_u32 m0, s28, 0
    ds_read_b64 a[254:255], v194 offset:3080
    ds_read_b64 v[90:91], v194 offset:4616
    v_mfma_f32_16x16x32_bf16 v[156:159], a[44:47], v[188:191], v[156:159]
    s_mov_b32 s24, s23
    ds_read_b64 v[106:107], v195 offset:3072
    ds_read_b64 v[114:115], v195 offset:4608
    v_mfma_f32_16x16x32_bf16 v[164:167], a[48:51], v[132:135], 0
    s_add_u32 s23, s23, s21
    ds_write2_b32 v170, v118, v119 offset0:152 offset1:220
    v_mfma_f32_16x16x32_bf16 v[164:167], a[52:55], v[160:163], v[164:167]
    s_cmp_ge_u32 s19, 72
    v_cvt_pk_bf16_f32 v225, v225, v225
    v_cvt_pk_bf16_f32 v226, v226, v226
    v_mfma_f32_16x16x32_bf16 v[164:167], a[56:59], v[172:175], v[164:167]
    s_cselect_b32 s34, 72, 0
    ds_write2_b32 v170, v224, v225 offset0:32 offset1:100
    v_mfma_f32_16x16x32_bf16 v[164:167], a[60:63], v[196:199], v[164:167]
    s_cselect_b32 s35, s22, 0
    v_cvt_pk_bf16_f32 v227, v227, v227
    v_cvt_pk_bf16_f32 v120, v120, v120
    v_mfma_f32_16x16x32_bf16 v[164:167], a[64:67], v[212:215], v[164:167]
    s_waitcnt lgkmcnt(6)
    ds_write2_b32 v170, v226, v227 offset0:168 offset1:236
    v_mfma_f32_16x16x32_bf16 v[116:119], v[124:127], a[228:231], 0
    s_waitcnt lgkmcnt(5)
    v_cvt_pk_bf16_f32 v121, v121, v121
    v_cvt_pk_bf16_f32 v122, v122, v122
    v_mfma_f32_16x16x32_bf16 v[116:119], v[124:127], a[252:255], v[116:119]
    s_waitcnt lgkmcnt(3)
    ds_write2_b32 v177, v120, v121 offset0:0 offset1:68
    v_mfma_f32_16x16x32_bf16 v[116:119], v[124:127], v[104:107], v[116:119]
    s_sub_u32 s19, s19, s34
    v_cvt_pk_bf16_f32 v123, v123, v123
    v_cvt_pk_bf16_f32 v136, v136, v136
    v_mfma_f32_16x16x32_bf16 v[192:195], v[124:127], a[236:239], 0
    s_add_u32 s23, s23, s35
    ds_write2_b32 v177, v122, v123 offset0:136 offset1:204
    v_mfma_f32_16x16x32_bf16 v[192:195], v[124:127], v[88:91], v[192:195]
    v_cvt_pk_bf16_f32 v137, v137, v137
    v_cvt_pk_bf16_f32 v138, v138, v138
    v_mfma_f32_16x16x32_bf16 v[192:195], v[124:127], v[112:115], v[192:195]
    ds_write2_b32 v177, v136, v137 offset0:16 offset1:84
    v_mfma_f32_16x16x32_bf16 v[164:167], a[68:71], v[188:191], v[164:167]
    v_cvt_pk_bf16_f32 v139, v139, v139
    v_cvt_pk_bf16_f32 v208, v208, v208
    v_mfma_f32_16x16x32_bf16 v[120:123], v[132:135], a[144:147], 0
    ds_write2_b32 v177, v138, v139 offset0:152 offset1:220
    v_mfma_f32_16x16x32_bf16 v[120:123], v[160:163], a[148:151], v[120:123]
    v_cvt_pk_bf16_f32 v209, v209, v209
    v_mov_b32 v229, v192
    v_mfma_f32_16x16x32_bf16 v[120:123], v[172:175], a[152:155], v[120:123]
    ds_write2_b32 v177, v208, v209 offset0:32 offset1:100
    v_mfma_f32_16x16x32_bf16 v[120:123], v[196:199], a[156:159], v[120:123]
    v_mov_b32_dpp v229, v116 quad_perm:[0,1,2,3] row_mask:0x2 bank_mask:0xf
    v_mov_b32_dpp v229, v117 quad_perm:[0,1,2,3] row_mask:0x4 bank_mask:0xf
    v_mfma_f32_16x16x32_bf16 v[120:123], v[212:215], a[160:163], v[120:123]
    v_mov_b32_dpp v229, v193 quad_perm:[0,1,2,3] row_mask:0x8 bank_mask:0xf
    v_cvt_pk_bf16_f32 v210, v210, v210
    v_mfma_f32_16x16x32_bf16 v[120:123], v[188:191], a[164:167], v[120:123]
    ds_write_b32 v240, v229 offset:63552
    v_mfma_f32_16x16x32_bf16 v[116:119], v[132:135], a[168:171], 0
    v_cvt_pk_bf16_f32 v211, v211, v211
    v_fma_f32 v229, v144, v144, s32
    v_mfma_f32_16x16x32_bf16 v[116:119], v[160:163], a[172:175], v[116:119]
    ds_write2_b32 v177, v210, v211 offset0:168 offset1:236
    v_mfma_f32_16x16x32_bf16 v[116:119], v[172:175], a[176:179], v[116:119]
    v_fmac_f32 v229, v145, v145
    v_cvt_pk_bf16_f32 v206, v120, v121
    v_mfma_f32_16x16x32_bf16 v[116:119], v[196:199], a[180:183], v[116:119]
    ds_read_b128 v[124:127], v0 offset:32768
    v_cvt_pk_bf16_f32 v207, v122, v123
    v_mfma_f32_16x16x32_bf16 v[116:119], v[212:215], a[184:187], v[116:119]
    ds_read_b128 v[136:139], v1 offset:32768
    v_fmac_f32 v229, v146, v146
    v_mfma_f32_16x16x32_bf16 v[116:119], v[188:191], a[188:191], v[116:119]
    ds_read_b128 v[120:123], v0 offset:32896
    v_fmac_f32 v229, v147, v147
    v_mfma_f32_16x16x32_bf16 v[176:179], v[132:135], a[192:195], 0
    s_waitcnt lgkmcnt(4)
    ds_read_b128 v[132:135], v1 offset:32896
    v_fmac_f32 v229, v156, v156
    v_mfma_f32_16x16x32_bf16 v[176:179], v[160:163], a[196:199], v[176:179]
    s_barrier
    ds_read_b128 v[160:163], v0 offset:33024
    ds_read_b128 v[192:195], v228 offset:18432
    v_mfma_f32_16x16x32_bf16 v[176:179], v[172:175], a[200:203], v[176:179]
    ds_read_b128 v[172:175], v1 offset:33024
    ds_read_b128 v[200:203], v228 offset:19456
    v_mfma_f32_16x16x32_bf16 v[176:179], v[196:199], a[204:207], v[176:179]
    v_fmac_f32 v229, v157, v157
    v_fmac_f32 v229, v158, v158
    v_mfma_f32_16x16x32_bf16 v[176:179], v[212:215], a[208:211], v[176:179]
    ds_read_b128 v[196:199], v228 offset:63552
    v_fmac_f32 v229, v159, v159
    v_mfma_f32_16x16x32_bf16 v[176:179], v[188:191], a[212:215], v[176:179]
    s_waitcnt lgkmcnt(8)
    v_fmac_f32 v229, v164, v164
    v_fmac_f32 v229, v165, v165
    v_mfma_f32_16x16x32_bf16 v[188:191], a[72:75], v[124:127], 0
    s_waitcnt lgkmcnt(7)
    v_fmac_f32 v229, v166, v166
    v_fmac_f32 v229, v167, v167
    v_mfma_f32_16x16x32_bf16 v[188:191], a[76:79], v[136:139], v[188:191]
    s_waitcnt lgkmcnt(6)
    v_fma_f32 v228, v128, v128, s32
    v_fmac_f32 v228, v129, v129
    v_mfma_f32_16x16x32_bf16 v[188:191], a[80:83], v[120:123], v[188:191]
    s_waitcnt lgkmcnt(5)
    v_fmac_f32 v228, v130, v130
    v_fmac_f32 v228, v131, v131
    v_mfma_f32_16x16x32_bf16 v[188:191], a[84:87], v[132:135], v[188:191]
    s_waitcnt lgkmcnt(3)
    v_add_f32 v192, v192, v193
    v_add_f32 v194, v194, v195
    v_mfma_f32_16x16x32_bf16 v[188:191], a[88:91], v[160:163], v[188:191]
    s_waitcnt lgkmcnt(1)
    v_add_f32 v192, v192, v194
    v_mul_f32 v192, 0xbbaaaaab, v192
    v_mfma_f32_16x16x32_bf16 v[188:191], a[92:95], v[172:175], v[188:191]
    ds_write_b32 v230, v192 offset:0
    v_mfma_f32_16x16x32_bf16 v[208:211], a[96:99], v[124:127], 0
    s_waitcnt lgkmcnt(1)
    v_add_f32 v200, v200, v201
    v_add_f32 v202, v202, v203
    v_mfma_f32_16x16x32_bf16 v[208:211], a[100:103], v[136:139], v[208:211]
    ds_read_b128 v[192:195], v231 offset:0
    ds_read_b128 v[212:215], v231 offset:64
    v_mfma_f32_16x16x32_bf16 v[208:211], a[104:107], v[120:123], v[208:211]
    v_add_f32 v200, v200, v202
    v_mul_f32 v200, 0xbbaaaaab, v200
    v_mfma_f32_16x16x32_bf16 v[208:211], a[108:111], v[132:135], v[208:211]
    ds_write_b32 v230, v200 offset:256
    v_mfma_f32_16x16x32_bf16 v[208:211], a[112:115], v[160:163], v[208:211]
    v_add_f32 v196, v196, v197
    v_add_f32 v198, v198, v199
    v_mfma_f32_16x16x32_bf16 v[208:211], a[116:119], v[172:175], v[208:211]
    v_add_f32 v196, v196, v198
    v_mul_f32 v196, 0xbbaaaaab, v196
    v_mfma_f32_16x16x32_bf16 v[200:203], a[120:123], v[124:127], 0
    ds_write_b32 v230, v196 offset:512
    v_mfma_f32_16x16x32_bf16 v[200:203], a[124:127], v[136:139], v[200:203]
    v_fmac_f32 v228, v140, v140
    v_fmac_f32 v228, v141, v141
    v_mfma_f32_16x16x32_bf16 v[200:203], a[128:131], v[120:123], v[200:203]
    v_fmac_f32 v228, v142, v142
    v_fmac_f32 v228, v143, v143
    v_mfma_f32_16x16x32_bf16 v[200:203], a[132:135], v[132:135], v[200:203]
    s_waitcnt lgkmcnt(2)
    v_fmac_f32 v228, v220, v220
    v_fmac_f32 v228, v221, v221
    v_mfma_f32_16x16x32_bf16 v[200:203], a[136:139], v[160:163], v[200:203]
    v_fmac_f32 v228, v222, v222
    v_fmac_f32 v228, v223, v223
    v_mfma_f32_16x16x32_bf16 v[200:203], a[140:143], v[172:175], v[200:203]
    v_cvt_pk_bf16_f32 v36, v229, v228
    v_cvt_pk_bf16_f32 v186, v116, v117
    v_mfma_f32_16x16x32_bf16 v[196:199], a[0:3], v[124:127], 0
    v_cvt_pk_bf16_f32 v187, v118, v119
    v_cvt_pk_bf16_f32 v170, v176, v177
    v_mfma_f32_16x16x32_bf16 v[116:119], v[32:35], v[36:39], 0
    v_cvt_pk_bf16_f32 v171, v178, v179
    v_fma_f32 v180, v188, v188, s32
    v_mfma_f32_16x16x32_bf16 v[196:199], a[4:7], v[136:139], v[196:199]
    v_fmac_f32 v180, v189, v189
    v_fmac_f32 v180, v190, v190
    v_mfma_f32_16x16x32_bf16 v[196:199], a[8:11], v[120:123], v[196:199]
    v_fmac_f32 v180, v191, v191
    v_fmac_f32 v180, v208, v208
    v_mfma_f32_16x16x32_bf16 v[196:199], a[12:15], v[132:135], v[196:199]
    v_rsq_f32 v117, v117
    v_mfma_f32_16x16x32_bf16 v[196:199], a[16:19], v[160:163], v[196:199]
    v_rsq_f32 v116, v116
    v_mfma_f32_16x16x32_bf16 v[196:199], a[20:23], v[172:175], v[196:199]
    v_mul_f32 v116, s31, v116
    v_mul_f32 v128, v117, v128
    v_mfma_f32_16x16x32_bf16 v[176:179], a[24:27], v[124:127], 0
    v_mul_f32 v129, v117, v129
    v_cvt_pk_f16_f32 v128, v128, v129
    v_mfma_f32_16x16x32_bf16 v[176:179], a[28:31], v[136:139], v[176:179]
    v_mul_f32 v130, v117, v130
    v_mul_f32 v131, v117, v131
    v_mfma_f32_16x16x32_bf16 v[176:179], a[32:35], v[120:123], v[176:179]
    v_cvt_pk_f16_f32 v129, v130, v131
    v_mul_f32 v140, v117, v140
    v_mfma_f32_16x16x32_bf16 v[176:179], a[36:39], v[132:135], v[176:179]
    v_mul_f32 v141, v117, v141
    v_cvt_pk_f16_f32 v130, v140, v141
    v_mfma_f32_16x16x32_bf16 v[176:179], a[40:43], v[160:163], v[176:179]
    v_mul_f32 v142, v117, v142
    v_mul_f32 v143, v117, v143
    v_mfma_f32_16x16x32_bf16 v[176:179], a[44:47], v[172:175], v[176:179]
    v_cvt_pk_f16_f32 v131, v142, v143
    v_mul_f32 v220, v117, v220
    v_mfma_f32_16x16x32_bf16 v[140:143], a[48:51], v[124:127], 0
    v_mul_f32 v221, v117, v221
    v_cvt_pk_f16_f32 v226, v220, v221
    v_mfma_f32_16x16x32_bf16 v[140:143], a[52:55], v[136:139], v[140:143]
    v_mul_f32 v222, v117, v222
    v_mul_f32 v223, v117, v223
    v_mfma_f32_16x16x32_bf16 v[140:143], a[56:59], v[120:123], v[140:143]
    v_cvt_pk_f16_f32 v227, v222, v223
    v_mul_f32 v144, v116, v144
    v_mfma_f32_16x16x32_bf16 v[140:143], a[60:63], v[132:135], v[140:143]
    v_mul_f32 v145, v116, v145
    v_cvt_pk_f16_f32 v144, v144, v145
    v_mfma_f32_16x16x32_bf16 v[140:143], a[64:67], v[160:163], v[140:143]
    ds_read_b128 v[220:223], v5 offset:0
    ds_read_b128 v[236:239], v5 offset:16
    v_mfma_f32_16x16x32_bf16 v[140:143], a[68:71], v[172:175], v[140:143]
    ds_read_b128 v[232:235], v5 offset:48
    ds_read_b32 v181, v6 offset:192
    v_mul_f32 v146, v116, v146
    v_mul_f32 v147, v116, v147
    v_cvt_pk_f16_f32 v145, v146, v147
    v_mul_f32 v156, v116, v156
    v_mul_f32 v157, v116, v157
    v_cvt_pk_f16_f32 v146, v156, v157
    v_mul_f32 v158, v116, v158
    v_mul_f32 v159, v116, v159
    v_cvt_pk_f16_f32 v147, v158, v159
    v_mfma_f32_16x16x32_bf16 v[156:159], v[124:127], a[144:147], 0
    v_mul_f32 v164, v116, v164
    v_mul_f32 v165, v116, v165
    v_mfma_f32_16x16x32_bf16 v[156:159], v[136:139], a[148:151], v[156:159]
    v_cvt_pk_f16_f32 v224, v164, v165
    v_mul_f32 v166, v116, v166
    v_mfma_f32_16x16x32_bf16 v[156:159], v[120:123], a[152:155], v[156:159]
    v_mul_f32 v167, v116, v167
    v_cvt_pk_f16_f32 v225, v166, v167
    v_mfma_f32_16x16x32_bf16 v[156:159], v[132:135], a[156:159], v[156:159]
    s_waitcnt lgkmcnt(3)
    v_fma_f32 v228, v196, v196, s32
    v_fmac_f32 v228, v197, v197
    v_mfma_f32_16x16x32_bf16 v[156:159], v[160:163], a[160:163], v[156:159]
    s_waitcnt lgkmcnt(1)
    v_fmac_f32 v228, v198, v198
    v_fmac_f32 v228, v199, v199
    v_mfma_f32_16x16x32_bf16 v[156:159], v[172:175], a[164:167], v[156:159]
    v_fmac_f32 v228, v176, v176
    v_fmac_f32 v228, v177, v177
    v_fmac_f32 v228, v178, v178
    v_fmac_f32 v228, v179, v179
    v_fmac_f32 v228, v140, v140
    v_fmac_f32 v228, v141, v141
    v_fmac_f32 v228, v142, v142
    v_fmac_f32 v228, v143, v143
    v_cvt_pk_bf16_f32 v156, v156, v157
    v_cvt_pk_bf16_f32 v157, v158, v159
    v_mfma_f32_16x16x32_bf16 v[116:119], v[124:127], a[168:171], 0
    s_waitcnt lgkmcnt(0)
    v_fmac_f32 v180, v209, v209
    v_fmac_f32 v180, v210, v210
    v_mfma_f32_16x16x32_bf16 v[116:119], v[136:139], a[172:175], v[116:119]
    v_fmac_f32 v180, v211, v211
    v_fmac_f32 v180, v200, v200
    v_mfma_f32_16x16x32_bf16 v[116:119], v[120:123], a[176:179], v[116:119]
    v_fmac_f32 v180, v201, v201
    v_fmac_f32 v180, v202, v202
    v_mfma_f32_16x16x32_bf16 v[116:119], v[132:135], a[180:183], v[116:119]
    v_fmac_f32 v180, v203, v203
    v_cvt_pk_bf16_f32 v36, v228, v180
    v_mfma_f32_16x16x32_bf16 v[116:119], v[160:163], a[184:187], v[116:119]
    v_add_u32 v5, 336, v5
    v_xor_b32 v0, 65536, v0
    v_mfma_f32_16x16x32_bf16 v[116:119], v[172:175], a[188:191], v[116:119]
    v_xor_b32 v1, 65536, v1
    s_nop 0
    s_nop 0
    s_nop 0
    s_nop 0
    s_nop 0
    s_nop 0
    s_nop 0
    v_cvt_pk_bf16_f32 v164, v116, v117
    v_cvt_pk_bf16_f32 v165, v118, v119
    v_mfma_f32_16x16x32_bf16 v[116:119], v[32:35], v[36:39], 0
    s_nop 0
    s_nop 0
    s_nop 0
    s_nop 0
    s_nop 0
    s_nop 0
    s_nop 0
    s_nop 0
    v_rsq_f32 v117, v117
    v_rsq_f32 v116, v116
    v_mul_f32 v188, v117, v188
    v_mul_f32 v116, s31, v116
    v_mul_f32 v189, v117, v189
    v_cvt_pk_f16_f32 v188, v188, v189
    v_mul_f32 v190, v117, v190
    v_mul_f32 v191, v117, v191
    v_cvt_pk_f16_f32 v189, v190, v191
    v_mfma_f32_16x16x32_bf16 v[240:243], v[124:127], a[192:195], 0
    v_mul_f32 v208, v117, v208
    v_mul_f32 v209, v117, v209
    v_mfma_f32_16x16x32_bf16 v[240:243], v[136:139], a[196:199], v[240:243]
    ds_read2_b32 v[158:159], v6 offset0:0 offset1:0
    ds_read2_b32 v[166:167], v6 offset0:16 offset1:16
    v_mfma_f32_16x16x32_bf16 v[240:243], v[120:123], a[200:203], v[240:243]
    ds_read2_b32 v[122:123], v6 offset0:32 offset1:32
    v_cvt_pk_f16_f32 v190, v208, v209
    v_mfma_f32_16x16x32_bf16 v[240:243], v[132:135], a[204:207], v[240:243]
    v_mul_f32 v210, v117, v210
    v_mul_f32 v211, v117, v211
    v_mfma_f32_16x16x32_bf16 v[240:243], v[160:163], a[208:211], v[240:243]
    v_cvt_pk_f16_f32 v191, v210, v211
    v_mul_f32 v200, v117, v200
    v_mfma_f32_16x16x32_f16 v[124:127], v[220:223], v[152:155], v[22:25]
    v_mul_f32 v201, v117, v201
    v_cvt_pk_f16_f32 v134, v200, v201
    v_mfma_f32_16x16x32_f16 v[124:127], v[236:239], v[148:151], v[124:127]
    v_mul_f32 v202, v117, v202
    v_mul_f32 v203, v117, v203
    v_mfma_f32_16x16x32_f16 v[124:127], v[232:235], v[216:219], v[124:127]
    v_cvt_pk_f16_f32 v135, v202, v203
    v_mul_f32 v196, v116, v196
    v_mfma_f32_16x16x32_bf16 v[240:243], v[172:175], a[212:215], v[240:243]
    v_mul_f32 v197, v116, v197
    v_cvt_pk_f16_f32 v160, v196, v197
    v_mfma_f32_16x16x32_f16 v[136:139], v[220:223], v[144:147], v[24:27]
    s_waitcnt lgkmcnt(1)
    v_mul_f32 v198, v116, v198
    v_mul_f32 v199, v116, v199
    v_mfma_f32_16x16x32_f16 v[136:139], v[236:239], v[128:131], v[136:139]
    s_waitcnt lgkmcnt(0)
    v_cvt_pk_bf16_f32 v120, v240, v241
    v_cvt_pk_bf16_f32 v121, v242, v243
    v_mfma_f32_16x16x32_f16 v[136:139], v[232:235], v[224:227], v[136:139]
    s_waitcnt vmcnt(0)
    v_cvt_pk_f16_f32 v161, v198, v199
    v_mul_f32 v176, v116, v176
    v_mfma_f32_16x16x32_f16 v[172:175], v[148:151], v[152:155], v[48:51]
    s_barrier
    buffer_load_dwordx4 v10, s[8:11], 0 offen nt lds
    v_mul_f32 v177, v116, v177
    v_mfma_f32_16x16x32_f16 v[196:199], v[128:131], v[152:155], v[52:55]
    s_add_u32 m0, s28, 4096
    v_cvt_pk_f16_f32 v162, v176, v177
    v_mul_f32 v178, v116, v178
    v_mfma_f32_16x16x32_f16 v[200:203], v[188:191], v[152:155], v[56:59]
    v_mul_f32 v179, v116, v179
    v_cvt_pk_f16_f32 v163, v178, v179
    v_mul_f32 v140, v116, v140
    v_mfma_f32_16x16x16_f16 v[172:175], v[218:219], v[216:217], v[172:175]
    v_mul_f32 v141, v116, v141
    v_cvt_pk_f16_f32 v132, v140, v141
    v_mul_f32 v142, v116, v142
    v_mfma_f32_16x16x16_f16 v[196:199], v[226:227], v[216:217], v[196:199]
    v_mul_f32 v143, v116, v143
    v_cvt_pk_f16_f32 v133, v142, v143
    v_mov_b32_dpp v181, v125 quad_perm:[0,1,2,3] row_mask:0x1 bank_mask:0xf
    v_mfma_f32_16x16x16_f16 v[200:203], v[134:135], v[216:217], v[200:203]
    v_mov_b32_dpp v181, v137 quad_perm:[0,1,2,3] row_mask:0x2 bank_mask:0xf
    v_max3_f32 v180, v124, v172, v173
    v_max3_f32 v180, v180, v174, v175
    v_add_u32 v6, 272, v6
    v_mfma_f32_16x16x32_f16 v[152:155], v[220:223], v[160:163], v[26:29]
    buffer_load_dwordx4 v11, s[8:11], 0 offen nt lds
    v_max3_f32 v180, v180, v196, v197
    v_mfma_f32_16x16x32_f16 v[152:155], v[236:239], v[188:191], v[152:155]
    s_add_u32 m0, s28, 8192
    v_max3_f32 v180, v180, v198, v199
    v_max3_f32 v180, v180, v200, v201
    v_mfma_f32_16x16x32_f16 v[152:155], v[232:235], v[132:135], v[152:155]
    v_max3_f32 v180, v180, v202, v203
    v_mov_b32 v216, v180
    v_mfma_f32_16x16x16_bf16 v[116:119], a[216:217], v[182:183], v[192:195]
    v_mfma_f32_16x16x16_bf16 v[140:143], a[240:241], v[182:183], v[192:195]
    v_permlane32_swap_b32 v180, v216
    v_max_f32 v180, v180, v216
    v_mfma_f32_16x16x16_bf16 v[176:179], v[92:93], v[182:183], v[192:195]
    v_mov_b32 v216, v180
    v_mov_b32_dpp v181, v153 quad_perm:[0,1,2,3] row_mask:0x4 bank_mask:0xf
    v_mov_b32 v217, v181
    v_mfma_f32_16x16x16_bf16 v[208:211], a[218:219], v[182:183], v[212:215]
    v_permlane16_swap_b32 v180, v216
    v_max_f32 v180, v180, v216
    v_mfma_f32_16x16x16_bf16 v[192:195], a[242:243], v[182:183], v[212:215]
    v_sub_f32 v172, v172, v180
    v_exp_f32 v172, v172
    v_mfma_f32_16x16x16_bf16 v[220:223], v[94:95], v[182:183], v[212:215]
    buffer_load_dwordx4 v12, s[8:11], 0 offen nt lds
    s_add_u32 m0, s28, 12288
    s_xor_b32 s28, s28, 65536
    v_sub_f32 v173, v173, v180
    v_exp_f32 v173, v173
    v_sub_f32 v174, v174, v180
    v_cvt_pk_bf16_f32 v172, v172, v173
    v_exp_f32 v174, v174
    v_sub_f32 v175, v175, v180
    v_exp_f32 v175, v175
    v_sub_f32 v196, v196, v180
    v_cvt_pk_bf16_f32 v173, v174, v175
    v_exp_f32 v196, v196
    v_mfma_f32_16x16x32_f16 v[212:215], v[148:151], v[144:147], v[60:63]
    buffer_load_dwordx4 v13, s[8:11], 0 offen nt lds
    s_mov_b32 m0, s29
    s_xor_b32 s29, s29, s30
    v_sub_f32 v197, v197, v180
    v_exp_f32 v197, v197
    v_sub_f32 v198, v198, v180
    v_mfma_f32_16x16x16_f16 v[212:215], v[218:219], v[224:225], v[212:215]
    v_cvt_pk_bf16_f32 v174, v196, v197
    v_exp_f32 v198, v198
    v_sub_f32 v199, v199, v180
    v_mfma_f32_16x16x32_f16 v[232:235], v[128:131], v[144:147], v[64:67]
    v_exp_f32 v199, v199
    buffer_load_dwordx4 v14, s[8:11], 0 offen nt lds
    v_cvt_pk_bf16_f32 v175, v198, v199
    v_sub_f32 v200, v200, v180
    v_exp_f32 v200, v200
    v_mfma_f32_16x16x32_f16 v[196:199], v[188:191], v[144:147], v[68:71]
    v_sub_f32 v201, v201, v180
    v_exp_f32 v201, v201
    v_mfma_f32_16x16x16_f16 v[232:235], v[226:227], v[224:225], v[232:235]
    v_cvt_pk_bf16_f32 v36, v200, v201
    v_sub_f32 v202, v202, v180
    v_exp_f32 v202, v202
    v_mfma_f32_16x16x16_f16 v[196:199], v[134:135], v[224:225], v[196:199]
    v_sub_f32 v203, v203, v180
    v_exp_f32 v203, v203
    v_sub_f32 v124, v124, v180
    v_cvt_pk_bf16_f32 v37, v202, v203
    v_exp_f32 v124, v124
    v_cvt_pk_bf16_f32 v116, v116, v117
    v_cvt_pk_bf16_f32 v39, v124, 0
    v_accvgpr_write_b32 a216, v116
    v_cvt_pk_bf16_f32 v118, v118, v119
    v_mfma_f32_16x16x32_bf16 v[124:127], v[28:31], v[36:39], 0
    v_accvgpr_write_b32 a217, v118
    v_cvt_pk_bf16_f32 v140, v140, v141
    v_mfma_f32_16x16x32_bf16 v[124:127], v[28:31], v[172:175], v[124:127]
    v_accvgpr_write_b32 a240, v140
    v_cvt_pk_bf16_f32 v142, v142, v143
    v_mfma_f32_16x16x32_bf16 v[116:119], v[156:159], v[36:39], 0
    v_accvgpr_write_b32 a241, v142
    v_cvt_pk_bf16_f32 v92, v176, v177
    v_mfma_f32_16x16x32_bf16 v[116:119], v[204:207], v[172:175], v[116:119]
    v_cvt_pk_bf16_f32 v93, v178, v179
    v_cvt_pk_bf16_f32 v208, v208, v209
    v_mfma_f32_16x16x32_bf16 v[140:143], v[164:167], v[36:39], 0
    ds_read_b128 v[144:147], v231 offset:128
    v_accvgpr_write_b32 a218, v208
    v_mfma_f32_16x16x32_bf16 v[140:143], v[184:187], v[172:175], v[140:143]
    v_rcp_f32 v124, v124
    v_mfma_f32_16x16x32_bf16 v[176:179], v[120:123], v[36:39], 0
    v_mul_f32 v116, v124, v116
    v_mul_f32 v117, v124, v117
    v_mfma_f32_16x16x32_bf16 v[176:179], v[168:171], v[172:175], v[176:179]
    v_cvt_pk_bf16_f32 v116, v116, v117
    v_mul_f32 v118, v124, v118
    v_mul_f32 v119, v124, v119
    v_cvt_pk_bf16_f32 v117, v118, v119
    v_mul_f32 v140, v124, v140
    v_mul_f32 v141, v124, v141
    v_cvt_pk_bf16_f32 v118, v140, v141
    v_mul_f32 v142, v124, v142
    v_mul_f32 v143, v124, v143
    v_cvt_pk_bf16_f32 v119, v142, v143
    ds_write_b128 v3, v[116:119] offset:0
    s_waitcnt lgkmcnt(1)
    v_mfma_f32_16x16x16_bf16 v[116:119], a[232:233], v[182:183], v[144:147]
    v_mul_f32 v176, v124, v176
    v_mul_f32 v177, v124, v177
    v_cvt_pk_bf16_f32 v208, v176, v177
    v_mfma_f32_16x16x16_bf16 v[140:143], v[84:85], v[182:183], v[144:147]
    v_mul_f32 v178, v124, v178
    v_mul_f32 v179, v124, v179
    v_cvt_pk_bf16_f32 v209, v178, v179
    v_mfma_f32_16x16x16_bf16 v[124:127], v[108:109], v[182:183], v[144:147]
    ds_write_b64 v4, v[208:209] offset:4096
    v_cvt_pk_bf16_f32 v210, v210, v211
    v_accvgpr_write_b32 a219, v210
    v_cvt_pk_bf16_f32 v192, v192, v193
    v_accvgpr_write_b32 a242, v192
    v_cvt_pk_bf16_f32 v194, v194, v195
    v_accvgpr_write_b32 a243, v194
    v_cvt_pk_bf16_f32 v94, v220, v221
    v_cvt_pk_bf16_f32 v95, v222, v223
    ds_read_b128 v[144:147], v231 offset:192
    v_cvt_pk_bf16_f32 v116, v116, v117
    v_accvgpr_write_b32 a232, v116
    v_cvt_pk_bf16_f32 v118, v118, v119
    v_accvgpr_write_b32 a233, v118
    v_cvt_pk_bf16_f32 v84, v140, v141
    v_cvt_pk_bf16_f32 v85, v142, v143
    v_cvt_pk_bf16_f32 v108, v124, v125
    v_cvt_pk_bf16_f32 v109, v126, v127
    ds_read_b128 v[116:119], v231 offset:256
    v_max_f32_dpp v217, v217, v217 quad_perm:[1,0,3,2] row_mask:0xf bank_mask:0xf
    v_max3_f32 v180, v136, v212, v213
    v_max3_f32 v180, v180, v214, v215
    v_max_f32_dpp v217, v217, v217 quad_perm:[2,3,0,1] row_mask:0xf bank_mask:0xf
    v_max3_f32 v180, v180, v232, v233
    v_max3_f32 v180, v180, v234, v235
    v_max_f32_dpp v217, v217, v217 row_half_mirror row_mask:0xf bank_mask:0xf
    v_max3_f32 v180, v180, v196, v197
    v_max3_f32 v180, v180, v198, v199
    v_max_f32_dpp v217, v217, v217 row_mirror row_mask:0xf bank_mask:0xf
    v_mov_b32 v216, v217
    v_mov_b32 v224, v180
    s_nop 0
    v_permlane32_swap_b32 v217, v216
    v_max_f32 v217, v217, v216
    s_waitcnt lgkmcnt(1)
    v_mfma_f32_16x16x16_bf16 v[124:127], a[220:221], v[182:183], v[144:147]
    v_mov_b32 v216, v217
    v_permlane32_swap_b32 v180, v224
    v_mfma_f32_16x16x16_bf16 v[172:175], a[244:245], v[182:183], v[144:147]
    v_permlane16_swap_b32 v217, v216
    v_max_f32 v217, v217, v216
    v_mfma_f32_16x16x16_bf16 v[140:143], v[96:97], v[182:183], v[144:147]
    v_sub_f32 v181, v181, v217
    s_waitcnt lgkmcnt(0)
    v_cvt_pk_bf16_f32 v124, v124, v125
    v_mfma_f32_16x16x16_bf16 v[176:179], a[222:223], v[182:183], v[116:119]
    v_accvgpr_write_b32 a220, v124
    v_cvt_pk_bf16_f32 v126, v126, v127
    v_accvgpr_write_b32 a221, v126
    v_mfma_f32_16x16x16_bf16 v[124:127], a[246:247], v[182:183], v[116:119]
    v_cvt_pk_bf16_f32 v172, v172, v173
    v_accvgpr_write_b32 a244, v172
    v_cvt_pk_bf16_f32 v174, v174, v175
    v_mfma_f32_16x16x16_bf16 v[144:147], v[98:99], v[182:183], v[116:119]
    v_accvgpr_write_b32 a245, v174
    v_cvt_pk_bf16_f32 v96, v140, v141
    v_cvt_pk_bf16_f32 v97, v142, v143
    ds_read_b128 v[140:143], v231 offset:320
    v_cvt_pk_bf16_f32 v176, v176, v177
    v_accvgpr_write_b32 a222, v176
    v_cvt_pk_bf16_f32 v178, v178, v179
    v_accvgpr_write_b32 a223, v178
    v_cvt_pk_bf16_f32 v124, v124, v125
    v_accvgpr_write_b32 a246, v124
    v_cvt_pk_bf16_f32 v126, v126, v127
    v_accvgpr_write_b32 a247, v126
    v_cvt_pk_bf16_f32 v98, v144, v145
    v_cvt_pk_bf16_f32 v99, v146, v147
    ds_read_b128 v[116:119], v231 offset:384
    v_exp_f32 v181, v181
    v_max_f32 v180, v180, v224
    v_cvt_pk_bf16_f32 v181, v181, v181
    ds_write_b16 v8, v181
    v_mov_b32 v224, v180
    ds_read_b128 v[124:127], v9
    ds_read_b128 v[172:175], v9 offset:64
    v_permlane16_swap_b32 v180, v224
    s_waitcnt lgkmcnt(4)
    v_mfma_f32_16x16x16_bf16 v[144:147], a[234:235], v[182:183], v[140:143]
    v_max_f32 v180, v180, v224
    v_sub_f32 v212, v212, v180
    v_sub_f32 v213, v213, v180
    v_mfma_f32_16x16x16_bf16 v[192:195], v[86:87], v[182:183], v[140:143]
    v_exp_f32 v212, v212
    v_sub_f32 v214, v214, v180
    v_mfma_f32_16x16x16_bf16 v[200:203], v[110:111], v[182:183], v[140:143]
    v_exp_f32 v213, v213
    s_waitcnt lgkmcnt(3)
    v_mfma_f32_16x16x16_bf16 v[176:179], a[224:225], v[182:183], v[116:119]
    v_cvt_pk_bf16_f32 v144, v144, v145
    v_accvgpr_write_b32 a234, v144
    v_cvt_pk_bf16_f32 v146, v146, v147
    v_mfma_f32_16x16x16_bf16 v[140:143], a[248:249], v[182:183], v[116:119]
    v_accvgpr_write_b32 a235, v146
    v_cvt_pk_bf16_f32 v86, v192, v193
    v_cvt_pk_bf16_f32 v87, v194, v195
    v_mfma_f32_16x16x16_bf16 v[144:147], v[100:101], v[182:183], v[116:119]
    v_cvt_pk_bf16_f32 v110, v200, v201
    v_cvt_pk_bf16_f32 v111, v202, v203
    s_waitcnt lgkmcnt(1)
    v_cvt_pk_bf16_f32 v176, v176, v177
    v_mfma_f32_16x16x32_bf16 v[116:119], v[124:127], v[28:31], 0
    s_waitcnt lgkmcnt(0)
    ds_read_b128 v[192:195], v231 offset:448
    v_accvgpr_write_b32 a224, v176
    v_mfma_f32_16x16x32_bf16 v[116:119], v[172:175], v[28:31], v[116:119]
    v_cvt_pk_bf16_f32 v178, v178, v179
    v_accvgpr_write_b32 a225, v178
    v_mfma_f32_16x16x32_bf16 v[176:179], v[124:127], v[204:207], 0
    v_cvt_pk_bf16_f32 v140, v140, v141
    v_accvgpr_write_b32 a248, v140
    v_mfma_f32_16x16x32_bf16 v[176:179], v[172:175], v[156:159], v[176:179]
    v_cvt_pk_bf16_f32 v142, v142, v143
    v_accvgpr_write_b32 a249, v142
    v_mfma_f32_16x16x32_bf16 v[200:203], v[124:127], v[184:187], 0
    v_cvt_pk_bf16_f32 v100, v144, v145
    v_cvt_pk_bf16_f32 v101, v146, v147
    v_mfma_f32_16x16x32_bf16 v[200:203], v[172:175], v[164:167], v[200:203]
    ds_read_b128 v[140:143], v231 offset:512
    v_cvt_pk_bf16_f32 v208, v212, v213
    v_mfma_f32_16x16x32_bf16 v[144:147], v[124:127], v[168:171], 0
    v_rcp_f32 v116, v116
    v_mfma_f32_16x16x32_bf16 v[144:147], v[172:175], v[120:123], v[144:147]
    v_mul_f32 v176, v176, v116
    s_waitcnt lgkmcnt(1)
    v_sub_f32 v215, v215, v180
    v_mfma_f32_16x16x16_bf16 v[124:127], a[226:227], v[182:183], v[192:195]
    v_mul_f32_dpp v176, v200, v116 quad_perm:[0,1,2,3] row_mask:0x2 bank_mask:0xf
    v_exp_f32 v214, v214
    v_mfma_f32_16x16x16_bf16 v[172:175], a[250:251], v[182:183], v[192:195]
    v_exp_f32 v215, v215
    v_mul_f32_dpp v176, v144, v116 quad_perm:[0,1,2,3] row_mask:0x4 bank_mask:0xf
    v_mfma_f32_16x16x16_bf16 v[116:119], v[102:103], v[182:183], v[192:195]
    v_cvt_pk_bf16_f32 v176, v176, v176
    ds_write_b16 v7, v176
    v_cvt_pk_bf16_f32 v124, v124, v125
    v_accvgpr_write_b32 a226, v124
    v_cvt_pk_bf16_f32 v126, v126, v127
    s_waitcnt lgkmcnt(1)
    v_mfma_f32_16x16x16_bf16 v[144:147], a[236:237], v[182:183], v[140:143]
    v_accvgpr_write_b32 a227, v126
    v_cvt_pk_bf16_f32 v172, v172, v173
    v_accvgpr_write_b32 a250, v172
    v_mfma_f32_16x16x16_bf16 v[124:127], v[88:89], v[182:183], v[140:143]
    v_cvt_pk_bf16_f32 v174, v174, v175
    v_accvgpr_write_b32 a251, v174
    v_cvt_pk_bf16_f32 v102, v116, v117
    v_mfma_f32_16x16x16_bf16 v[172:175], v[112:113], v[182:183], v[140:143]
    v_cvt_pk_bf16_f32 v103, v118, v119
    ds_read_b128 v[116:119], v231 offset:576
    v_cvt_pk_bf16_f32 v144, v144, v145
    v_accvgpr_write_b32 a236, v144
    v_cvt_pk_bf16_f32 v146, v146, v147
    v_accvgpr_write_b32 a237, v146
    v_cvt_pk_bf16_f32 v88, v124, v125
    v_cvt_pk_bf16_f32 v89, v126, v127
    v_cvt_pk_bf16_f32 v112, v172, v173
    v_cvt_pk_bf16_f32 v113, v174, v175
    ds_read_b128 v[124:127], v231 offset:640
    v_cvt_pk_bf16_f32 v209, v214, v215
    v_sub_f32 v232, v232, v180
    v_exp_f32 v232, v232
    v_sub_f32 v233, v233, v180
    v_exp_f32 v233, v233
    v_sub_f32 v234, v234, v180
    v_cvt_pk_bf16_f32 v210, v232, v233
    v_exp_f32 v234, v234
    v_sub_f32 v235, v235, v180
    v_exp_f32 v235, v235
    v_sub_f32 v196, v196, v180
    v_cvt_pk_bf16_f32 v211, v234, v235
    s_waitcnt lgkmcnt(1)
    v_mfma_f32_16x16x16_bf16 v[140:143], a[228:229], v[182:183], v[116:119]
    v_exp_f32 v196, v196
    v_sub_f32 v197, v197, v180
    v_mfma_f32_16x16x16_bf16 v[144:147], a[252:253], v[182:183], v[116:119]
    v_exp_f32 v197, v197
    v_sub_f32 v198, v198, v180
    v_mfma_f32_16x16x16_bf16 v[172:175], v[104:105], v[182:183], v[116:119]
    v_cvt_pk_bf16_f32 v36, v196, v197
    s_waitcnt lgkmcnt(0)
    v_cvt_pk_bf16_f32 v140, v140, v141
    v_mfma_f32_16x16x16_bf16 v[176:179], a[230:231], v[182:183], v[124:127]
    v_accvgpr_write_b32 a228, v140
    v_cvt_pk_bf16_f32 v142, v142, v143
    v_accvgpr_write_b32 a229, v142
    v_mfma_f32_16x16x16_bf16 v[116:119], a[254:255], v[182:183], v[124:127]
    v_cvt_pk_bf16_f32 v144, v144, v145
    v_accvgpr_write_b32 a252, v144
    v_cvt_pk_bf16_f32 v146, v146, v147
    v_mfma_f32_16x16x16_bf16 v[140:143], v[106:107], v[182:183], v[124:127]
    v_accvgpr_write_b32 a253, v146
    v_cvt_pk_bf16_f32 v104, v172, v173
    v_cvt_pk_bf16_f32 v105, v174, v175
    ds_read_b128 v[144:147], v231 offset:704
    v_cvt_pk_bf16_f32 v176, v176, v177
    v_accvgpr_write_b32 a230, v176
    v_cvt_pk_bf16_f32 v178, v178, v179
    v_accvgpr_write_b32 a231, v178
    v_cvt_pk_bf16_f32 v116, v116, v117
    v_accvgpr_write_b32 a254, v116
    v_cvt_pk_bf16_f32 v118, v118, v119
    v_accvgpr_write_b32 a255, v118
    v_cvt_pk_bf16_f32 v106, v140, v141
    v_cvt_pk_bf16_f32 v107, v142, v143
    v_exp_f32 v198, v198
    v_sub_f32 v199, v199, v180
    v_exp_f32 v199, v199
    v_mfma_f32_16x16x32_f16 v[124:127], v[148:151], v[160:163], v[72:75]
    v_cvt_pk_bf16_f32 v37, v198, v199
    v_sub_f32 v136, v136, v180
    v_mfma_f32_16x16x32_f16 v[140:143], v[128:131], v[160:163], v[76:79]
    v_exp_f32 v136, v136
    v_mfma_f32_16x16x32_f16 v[128:131], v[188:191], v[160:163], v[80:83]
    v_cvt_pk_bf16_f32 v39, v136, 0
    v_add_u32 v7, 16, v7
    v_mfma_f32_16x16x16_f16 v[124:127], v[218:219], v[132:133], v[124:127]
    v_mfma_f32_16x16x32_bf16 v[176:179], v[28:31], v[36:39], 0
    s_waitcnt lgkmcnt(0)
    v_mfma_f32_16x16x32_bf16 v[176:179], v[28:31], v[208:211], v[176:179]
    v_mfma_f32_16x16x32_bf16 v[116:119], v[156:159], v[36:39], 0
    v_mfma_f32_16x16x32_bf16 v[116:119], v[204:207], v[208:211], v[116:119]
    v_mfma_f32_16x16x32_bf16 v[188:191], v[164:167], v[36:39], 0
    v_mfma_f32_16x16x32_bf16 v[188:191], v[184:187], v[208:211], v[188:191]
    v_mfma_f32_16x16x32_bf16 v[192:195], v[120:123], v[36:39], 0
    v_max3_f32 v153, v152, v124, v125
    v_max3_f32 v153, v153, v126, v127
    v_mfma_f32_16x16x32_bf16 v[192:195], v[168:171], v[208:211], v[192:195]
    v_rcp_f32 v176, v176
    v_mfma_f32_16x16x16_f16 v[140:143], v[226:227], v[132:133], v[140:143]
    v_mul_f32 v116, v176, v116
    v_mul_f32 v117, v176, v117
    v_cvt_pk_bf16_f32 v180, v116, v117
    v_mfma_f32_16x16x16_f16 v[128:131], v[134:135], v[132:133], v[128:131]
    v_mul_f32 v118, v176, v118
    v_mul_f32 v119, v176, v119
    v_cvt_pk_bf16_f32 v181, v118, v119
    v_mfma_f32_16x16x16_bf16 v[116:119], a[238:239], v[182:183], v[144:147]
    v_max3_f32 v153, v153, v140, v141
    v_max3_f32 v153, v153, v142, v143
    v_mul_f32 v188, v176, v188
    v_mfma_f32_16x16x16_bf16 v[136:139], v[90:91], v[182:183], v[144:147]
    v_max3_f32 v153, v153, v128, v129
    v_max3_f32 v153, v153, v130, v131
    v_mov_b32 v154, v153
    v_mfma_f32_16x16x16_bf16 v[132:135], v[114:115], v[182:183], v[144:147]
    v_cvt_pk_bf16_f32 v116, v116, v117
    v_accvgpr_write_b32 a238, v116
    v_cvt_pk_bf16_f32 v118, v118, v119
    v_accvgpr_write_b32 a239, v118
    v_cvt_pk_bf16_f32 v90, v136, v137
    v_cvt_pk_bf16_f32 v91, v138, v139
    v_permlane32_swap_b32 v153, v154
    v_max_f32 v153, v153, v154
    v_cvt_pk_bf16_f32 v114, v132, v133
    v_cvt_pk_bf16_f32 v115, v134, v135
    v_mov_b32 v154, v153
    v_mul_f32 v189, v176, v189
    v_cvt_pk_bf16_f32 v182, v188, v189
    v_permlane16_swap_b32 v153, v154
    v_max_f32 v153, v153, v154
    v_sub_f32 v124, v124, v153
    v_exp_f32 v124, v124
    v_sub_f32 v125, v125, v153
    v_exp_f32 v125, v125
    v_sub_f32 v126, v126, v153
    v_cvt_pk_bf16_f32 v124, v124, v125
    v_exp_f32 v126, v126
    ds_read_b128 v[232:235], v0 offset:20480
    ds_read_b128 v[248:251], v1 offset:20480
    ds_read_b128 v[160:163], v0 offset:20608
    ds_read_b128 v[136:139], v1 offset:20608
    ds_read_b128 v[116:119], v0 offset:20736
    ds_read_b128 v[172:175], v1 offset:20736
    v_sub_f32 v127, v127, v153
    v_exp_f32 v127, v127
    v_sub_f32 v140, v140, v153
    v_cvt_pk_bf16_f32 v125, v126, v127
    v_exp_f32 v140, v140
    v_sub_f32 v141, v141, v153
    v_exp_f32 v141, v141
    v_sub_f32 v142, v142, v153
    v_cvt_pk_bf16_f32 v126, v140, v141
    v_exp_f32 v142, v142
    s_waitcnt lgkmcnt(5)
    v_mfma_f32_16x16x32_bf16 v[148:151], a[72:75], v[232:235], 0
    s_waitcnt lgkmcnt(3)
    v_sub_f32 v143, v143, v153
    v_sub_f32 v128, v128, v153
    v_mfma_f32_16x16x32_bf16 v[148:151], a[76:79], v[248:251], v[148:151]
    s_waitcnt lgkmcnt(2)
    v_exp_f32 v143, v143
    v_mfma_f32_16x16x32_bf16 v[148:151], a[80:83], v[160:163], v[148:151]
    s_waitcnt lgkmcnt(1)
    v_cvt_pk_bf16_f32 v127, v142, v143
    v_sub_f32 v129, v129, v153
    v_mfma_f32_16x16x32_bf16 v[148:151], a[84:87], v[136:139], v[148:151]
    s_waitcnt lgkmcnt(0)
    v_exp_f32 v128, v128
    v_mfma_f32_16x16x32_bf16 v[148:151], a[88:91], v[116:119], v[148:151]
    v_exp_f32 v129, v129
    v_mfma_f32_16x16x32_bf16 v[148:151], a[92:95], v[172:175], v[148:151]
    v_cvt_pk_bf16_f32 v36, v128, v129
    v_sub_f32 v130, v130, v153
    v_mfma_f32_16x16x32_bf16 v[140:143], a[96:99], v[232:235], 0
    v_exp_f32 v130, v130
    v_mfma_f32_16x16x32_bf16 v[140:143], a[100:103], v[248:251], v[140:143]
    v_sub_f32 v131, v131, v153
    v_sub_f32 v152, v152, v153
    v_mfma_f32_16x16x32_bf16 v[140:143], a[104:107], v[160:163], v[140:143]
    v_exp_f32 v131, v131
    v_mfma_f32_16x16x32_bf16 v[140:143], a[108:111], v[136:139], v[140:143]
    v_cvt_pk_bf16_f32 v37, v130, v131
    v_mul_f32 v190, v176, v190
    v_mfma_f32_16x16x32_bf16 v[140:143], a[112:115], v[116:119], v[140:143]
    v_exp_f32 v152, v152
    v_mfma_f32_16x16x32_bf16 v[140:143], a[116:119], v[172:175], v[140:143]
    v_cvt_pk_bf16_f32 v39, v152, 0
    v_mul_f32 v191, v176, v191
    v_mfma_f32_16x16x32_bf16 v[144:147], a[120:123], v[232:235], 0
    v_cvt_pk_bf16_f32 v183, v190, v191
    v_mul_f32 v192, v176, v192
    v_mfma_f32_16x16x32_bf16 v[128:131], v[28:31], v[36:39], 0
    ds_write_b128 v3, v[180:183] offset:6144
    v_mfma_f32_16x16x32_bf16 v[128:131], v[28:31], v[124:127], v[128:131]
    v_mul_f32 v193, v176, v193
    v_cvt_pk_bf16_f32 v192, v192, v193
    v_mfma_f32_16x16x32_bf16 v[132:135], v[156:159], v[36:39], 0
    v_mul_f32 v194, v176, v194
    v_mul_f32 v195, v176, v195
    v_mfma_f32_16x16x32_bf16 v[132:135], v[204:207], v[124:127], v[132:135]
    v_cvt_pk_bf16_f32 v193, v194, v195
    v_mfma_f32_16x16x32_bf16 v[156:159], v[164:167], v[36:39], 0
    ds_write_b64 v4, v[192:193] offset:10240
    v_mfma_f32_16x16x32_bf16 v[156:159], v[184:187], v[124:127], v[156:159]
    v_rcp_f32 v128, v128
    v_mfma_f32_16x16x32_bf16 v[164:167], v[120:123], v[36:39], 0
    v_mfma_f32_16x16x32_bf16 v[164:167], v[168:171], v[124:127], v[164:167]
    v_mfma_f32_16x16x32_bf16 v[144:147], a[124:127], v[248:251], v[144:147]
    v_mul_f32 v132, v128, v132
    v_mul_f32 v133, v128, v133
    v_mfma_f32_16x16x32_bf16 v[144:147], a[128:131], v[160:163], v[144:147]
    v_cvt_pk_bf16_f32 v120, v132, v133
    v_mul_f32 v134, v128, v134
    v_mfma_f32_16x16x32_bf16 v[144:147], a[132:135], v[136:139], v[144:147]
    v_mul_f32 v135, v128, v135
    v_cvt_pk_bf16_f32 v121, v134, v135
    v_mfma_f32_16x16x32_bf16 v[144:147], a[136:139], v[116:119], v[144:147]
    v_mul_f32 v156, v128, v156
    v_mul_f32 v157, v128, v157
    v_mfma_f32_16x16x32_bf16 v[144:147], a[140:143], v[172:175], v[144:147]
    v_cvt_pk_bf16_f32 v122, v156, v157
    v_mul_f32 v158, v128, v158
    v_mfma_f32_16x16x32_bf16 v[152:155], a[0:3], v[232:235], 0
    v_mul_f32 v159, v128, v159
    v_cvt_pk_bf16_f32 v123, v158, v159
    v_mfma_f32_16x16x32_bf16 v[152:155], a[4:7], v[248:251], v[152:155]
    ds_write_b128 v3, v[120:123] offset:12288
    v_mfma_f32_16x16x32_bf16 v[152:155], a[8:11], v[160:163], v[152:155]
    v_mul_f32 v164, v128, v164
    v_mul_f32 v165, v128, v165
    v_mfma_f32_16x16x32_bf16 v[152:155], a[12:15], v[136:139], v[152:155]
    v_cvt_pk_bf16_f32 v164, v164, v165
    v_mul_f32 v166, v128, v166
    v_mfma_f32_16x16x32_bf16 v[152:155], a[16:19], v[116:119], v[152:155]
    v_mul_f32 v167, v128, v167
    v_cvt_pk_bf16_f32 v165, v166, v167
    v_mfma_f32_16x16x32_bf16 v[152:155], a[20:23], v[172:175], v[152:155]
    ds_write_b64 v4, v[164:165] offset:16384
    v_mfma_f32_16x16x32_bf16 v[156:159], a[24:27], v[232:235], 0
    v_xor_b32 v3, 65536, v3
    v_xor_b32 v4, 65536, v4
    v_mfma_f32_16x16x32_bf16 v[156:159], a[28:31], v[248:251], v[156:159]
    v_mfma_f32_16x16x32_bf16 v[156:159], a[32:35], v[160:163], v[156:159]
    v_mfma_f32_16x16x32_bf16 v[156:159], a[36:39], v[136:139], v[156:159]
    v_mfma_f32_16x16x32_bf16 v[156:159], a[40:43], v[116:119], v[156:159]
    v_mfma_f32_16x16x32_bf16 v[156:159], a[44:47], v[172:175], v[156:159]
    s_waitcnt lgkmcnt(0)
    s_barrier
    s_waitcnt lgkmcnt(0)
    s_cmp_eq_u32 s45, 0
    s_cbranch_scc1 L_drain
    s_max_u32 s3, s37, s44
    s_cmp_gt_u32 s3, 0x42000000
    s_cbranch_scc1 L_safe
    v_cvt_pk_f16_f32 v120, v148, v149
    v_pk_mul_f16 v125, v120, v120
    v_cvt_pk_f16_f32 v121, v150, v151
    v_pk_mul_f16 v127, v121, v121
    v_cvt_pk_f16_f32 v122, v140, v141
    v_pk_fma_f16 v125, v122, v122, v125
    s_nop 7
    s_branch L_go
L_safe:
    v_fma_f32 v164, v148, v148, s32
    v_fmac_f32 v164, v149, v149
    v_fmac_f32 v164, v150, v150
    v_fmac_f32 v164, v151, v151
    v_fmac_f32 v164, v140, v140
    v_fmac_f32 v164, v141, v141
    v_fmac_f32 v164, v142, v142
    v_fmac_f32 v164, v143, v143
    s_nop 7
    s_and_b32 s3, s2, 0xf8
    s_add_u32 s64, s42, s3
    s_addc_u32 s65, s43, 0
    s_mov_b32 s67, 0x00020000
    s_cmp_eq_u32 s16, 1
    s_cbranch_scc1 L_loop_safe1
    s_cmp_eq_u32 s16, 2
    s_cbranch_scc1 L_loop_safe2
    s_cmp_eq_u32 s16, 3
    s_cbranch_scc1 L_loop_safe3
    s_branch L_loop_safe0
.p2align 6
L_loop_safe0:
    v_mfma_f32_16x16x32_bf16 v[124:127], a[48:51], v[232:235], 0
    s_add_u32 s12, s40, s27
    ds_read_b128 v[120:123], v2 offset:18432
    ds_read_b128 v[168:171], v2 offset:19456
    v_mfma_f32_16x16x32_bf16 v[124:127], a[52:55], v[248:251], v[124:127]
    s_addc_u32 s13, s41, 0
    v_fmac_f32 v164, v144, v144
    v_fmac_f32 v164, v145, v145
    v_mfma_f32_16x16x32_bf16 v[124:127], a[56:59], v[160:163], v[124:127]
    s_sub_u32 s14, s36, s27
    v_fmac_f32 v164, v146, v146
    v_fmac_f32 v164, v147, v147
    v_mfma_f32_16x16x32_bf16 v[124:127], a[60:63], v[136:139], v[124:127]
    s_cmp_ge_u32 s18, 2
    v_fma_f32 v165, v152, v152, s32
    v_fmac_f32 v165, v153, v153
    v_mfma_f32_16x16x32_bf16 v[124:127], a[64:67], v[116:119], v[124:127]
    s_cselect_b32 s14, s14, 0
    v_fmac_f32 v165, v154, v154
    v_fmac_f32 v165, v155, v155
    v_mfma_f32_16x16x32_bf16 v[124:127], a[68:71], v[172:175], v[124:127]
    s_sub_u32 s82, s72, s71
    v_fmac_f32 v165, v156, v156
    v_fmac_f32 v165, v157, v157
    v_mfma_f32_16x16x32_bf16 v[180:183], v[232:235], a[144:147], 0
    s_mul_i32 s74, s82, 336
    v_fmac_f32 v165, v158, v158
    v_fmac_f32 v165, v159, v159
    v_mfma_f32_16x16x32_bf16 v[180:183], v[248:251], a[148:151], v[180:183]
    s_mul_i32 s75, s82, 272
    v_fmac_f32 v165, v124, v124
    v_fmac_f32 v165, v125, v125
    v_mfma_f32_16x16x32_bf16 v[180:183], v[160:163], a[152:155], v[180:183]
    s_waitcnt lgkmcnt(0)
    v_fmac_f32 v165, v126, v126
    v_fmac_f32 v165, v127, v127
    v_mfma_f32_16x16x32_bf16 v[184:187], v[32:35], v[120:123], 0
    s_mul_i32 s76, s82, 16
    v_cvt_pk_bf16_f32 v36, v165, v164
    s_add_u32 s34, s18, 2
    v_mfma_f32_16x16x32_bf16 v[184:187], v[32:35], v[168:171], v[184:187]
    s_add_u32 s8, s60, s23
    s_addc_u32 s9, s61, 0
    s_sub_u32 s10, s36, s23
    v_mfma_f32_16x16x32_bf16 v[168:171], v[32:35], v[36:39], 0
    s_cmp_le_u32 s34, s45
    s_cselect_b32 s10, s10, 0
    s_add_u32 m0, s28, 0
    v_mfma_f32_16x16x32_bf16 v[180:183], v[136:139], a[156:159], v[180:183]
    s_mov_b32 s27, s26
    v_mul_f32 v166, 0x3baaaaab, v184
    v_mul_f32 v184, 0x3baaaaab, v185
    v_mfma_f32_16x16x32_bf16 v[180:183], v[116:119], a[160:163], v[180:183]
    s_mov_b32 s26, s25
    v_rsq_f32 v169, v169
    v_mfma_f32_16x16x32_bf16 v[180:183], v[172:175], a[164:167], v[180:183]
    s_mov_b32 s25, s24
    v_rsq_f32 v168, v168
    v_mfma_f32_16x16x32_bf16 v[120:123], v[232:235], a[168:171], 0
    s_mov_b32 s24, s23
    v_mul_f32 v168, s31, v168
    v_mul_f32 v148, v169, v148
    v_mfma_f32_16x16x32_bf16 v[120:123], v[248:251], a[172:175], v[120:123]
    s_ff1_i32_b32 s80, s100
    v_cvt_pk_bf16_f32 v164, v180, v181
    v_cvt_pk_bf16_f32 v165, v182, v183
    v_mfma_f32_16x16x32_bf16 v[120:123], v[160:163], a[176:179], v[120:123]
    s_mov_b32 s71, s72
    ds_read_b128 v[180:183], v0 offset:26624
    v_mul_f32 v149, v169, v149
    v_mfma_f32_16x16x32_bf16 v[120:123], v[136:139], a[180:183], v[120:123]
    s_mov_b32 s72, s73
    ds_read_b128 v[192:195], v1 offset:26624
    v_cvt_pk_f16_f32 v148, v148, v149
    v_mfma_f32_16x16x32_bf16 v[120:123], v[116:119], a[184:187], v[120:123]
    ds_read_b128 v[204:207], v0 offset:26752
    v_mul_f32 v150, v169, v150
    v_mfma_f32_16x16x32_bf16 v[120:123], v[172:175], a[188:191], v[120:123]
    ds_read_b128 v[220:223], v1 offset:26752
    v_mul_f32 v151, v169, v151
    v_cvt_pk_f16_f32 v149, v150, v151
    v_mul_f32 v140, v169, v140
    v_mul_f32 v141, v169, v141
    v_cvt_pk_f16_f32 v150, v140, v141
    v_mfma_f32_16x16x32_bf16 v[224:227], v[232:235], a[192:195], 0
    ds_read_b128 v[228:231], v0 offset:26880
    v_cvt_pk_bf16_f32 v140, v120, v121
    v_mfma_f32_16x16x32_bf16 v[224:227], v[248:251], a[196:199], v[224:227]
    ds_read_b128 v[232:235], v1 offset:26880
    v_cvt_pk_bf16_f32 v141, v122, v123
    v_mfma_f32_16x16x32_bf16 v[224:227], v[160:163], a[200:203], v[224:227]
    v_mul_f32 v142, v169, v142
    v_mul_f32 v143, v169, v143
    v_mfma_f32_16x16x32_bf16 v[224:227], v[136:139], a[204:207], v[224:227]
    s_waitcnt lgkmcnt(5)
    v_cvt_pk_f16_f32 v151, v142, v143
    v_mul_f32 v144, v169, v144
    v_mfma_f32_16x16x32_bf16 v[224:227], v[116:119], a[208:211], v[224:227]
    s_waitcnt lgkmcnt(4)
    v_mul_f32 v145, v169, v145
    v_cvt_pk_f16_f32 v122, v144, v145
    v_mfma_f32_16x16x32_bf16 v[224:227], v[172:175], a[212:215], v[224:227]
    s_waitcnt lgkmcnt(3)
    v_mul_f32 v146, v169, v146
    v_mul_f32 v147, v169, v147
    v_mfma_f32_16x16x32_bf16 v[116:119], a[72:75], v[180:183], 0
    s_waitcnt lgkmcnt(2)
    v_cvt_pk_f16_f32 v123, v146, v147
    v_mul_f32 v152, v168, v152
    v_mfma_f32_16x16x32_bf16 v[116:119], a[76:79], v[192:195], v[116:119]
    v_cvt_pk_bf16_f32 v144, v224, v225
    v_cvt_pk_bf16_f32 v145, v226, v227
    v_mfma_f32_16x16x32_bf16 v[116:119], a[80:83], v[204:207], v[116:119]
    s_waitcnt lgkmcnt(1)
    v_mul_f32 v153, v168, v153
    v_cvt_pk_f16_f32 v244, v152, v153
    v_mfma_f32_16x16x32_bf16 v[116:119], a[84:87], v[220:223], v[116:119]
    s_waitcnt lgkmcnt(0)
    v_mul_f32 v154, v168, v154
    v_mul_f32 v155, v168, v155
    v_mfma_f32_16x16x32_bf16 v[116:119], a[88:91], v[228:231], v[116:119]
    v_cvt_pk_f16_f32 v245, v154, v155
    v_mul_f32 v156, v168, v156
    v_mfma_f32_16x16x32_bf16 v[116:119], a[92:95], v[232:235], v[116:119]
    v_mul_f32 v157, v168, v157
    v_cvt_pk_f16_f32 v246, v156, v157
    v_mfma_f32_16x16x32_bf16 v[136:139], a[96:99], v[180:183], 0
    v_mul_f32 v158, v168, v158
    v_mul_f32 v159, v168, v159
    v_mfma_f32_16x16x32_bf16 v[136:139], a[100:103], v[192:195], v[136:139]
    v_cvt_pk_f16_f32 v247, v158, v159
    v_mul_f32 v124, v168, v124
    v_mfma_f32_16x16x32_bf16 v[136:139], a[104:107], v[204:207], v[136:139]
    v_mul_f32 v125, v168, v125
    v_cvt_pk_f16_f32 v120, v124, v125
    v_mfma_f32_16x16x32_bf16 v[136:139], a[108:111], v[220:223], v[136:139]
    v_mul_f32 v126, v168, v126
    v_mul_f32 v127, v168, v127
    v_mfma_f32_16x16x32_bf16 v[136:139], a[112:115], v[228:231], v[136:139]
    v_cvt_pk_f16_f32 v121, v126, v127
    v_fma_f32 v167, v116, v116, s32
    v_mfma_f32_16x16x32_bf16 v[136:139], a[116:119], v[232:235], v[136:139]
    v_fmac_f32 v167, v117, v117
    v_fmac_f32 v167, v118, v118
    v_mfma_f32_16x16x32_bf16 v[152:155], a[120:123], v[180:183], 0
    v_fmac_f32 v167, v119, v119
    v_mul_f32 v142, 0x3baaaaab, v186
    v_mfma_f32_16x16x32_bf16 v[152:155], a[124:127], v[192:195], v[152:155]
    v_rsq_f32 v166, v166
    v_mfma_f32_16x16x32_bf16 v[152:155], a[128:131], v[204:207], v[152:155]
    v_fmac_f32 v167, v136, v136
    v_fmac_f32 v167, v137, v137
    v_mfma_f32_16x16x32_bf16 v[152:155], a[132:135], v[220:223], v[152:155]
    v_fmac_f32 v167, v138, v138
    v_fmac_f32 v167, v139, v139
    v_mfma_f32_16x16x32_bf16 v[152:155], a[136:139], v[228:231], v[152:155]
    v_rsq_f32 v184, v184
    v_mfma_f32_16x16x32_bf16 v[152:155], a[140:143], v[232:235], v[152:155]
    v_rsq_f32 v142, v142
    v_mfma_f32_16x16x32_bf16 v[156:159], a[0:3], v[180:183], 0
    v_mul_f32 v128, v166, v128
    v_mul_f32 v129, v166, v129
    v_mfma_f32_16x16x32_bf16 v[156:159], a[4:7], v[192:195], v[156:159]
    v_cvt_pk_bf16_f32 v124, v128, v129
    v_mul_f32 v130, v166, v130
    v_mfma_f32_16x16x32_bf16 v[156:159], a[8:11], v[204:207], v[156:159]
    v_fmac_f32 v167, v152, v152
    v_fmac_f32 v167, v153, v153
    v_mfma_f32_16x16x32_bf16 v[156:159], a[12:15], v[220:223], v[156:159]
    v_fmac_f32 v167, v154, v154
    v_fmac_f32 v167, v155, v155
    v_mfma_f32_16x16x32_bf16 v[156:159], a[16:19], v[228:231], v[156:159]
    v_mul_f32 v131, v166, v131
    v_cvt_pk_bf16_f32 v125, v130, v131
    v_mfma_f32_16x16x32_bf16 v[156:159], a[20:23], v[232:235], v[156:159]
    v_mul_f32 v188, v166, v188
    v_mul_f32 v189, v166, v189
    v_mfma_f32_16x16x32_bf16 v[168:171], a[24:27], v[180:183], 0
    v_cvt_pk_bf16_f32 v126, v188, v189
    v_mul_f32 v190, v166, v190
    v_mfma_f32_16x16x32_bf16 v[168:171], a[28:31], v[192:195], v[168:171]
    v_mul_f32 v191, v166, v191
    v_cvt_pk_bf16_f32 v127, v190, v191
    v_mfma_f32_16x16x32_bf16 v[168:171], a[32:35], v[204:207], v[168:171]
    buffer_store_dwordx4 v[124:127], v15, s[12:15], 0 offen nt
    v_fma_f32 v143, v156, v156, s32
    v_fmac_f32 v143, v157, v157
    v_fmac_f32 v143, v158, v158
    v_fmac_f32 v143, v159, v159
    v_mfma_f32_16x16x32_bf16 v[168:171], a[36:39], v[220:223], v[168:171]
    v_mul_f32 v176, v166, v176
    v_mul_f32 v177, v166, v177
    v_mfma_f32_16x16x32_bf16 v[168:171], a[40:43], v[228:231], v[168:171]
    v_cvt_pk_bf16_f32 v146, v176, v177
    v_mul_f32 v178, v166, v178
    v_mfma_f32_16x16x32_bf16 v[168:171], a[44:47], v[232:235], v[168:171]
    v_mul_f32 v179, v166, v179
    v_cvt_pk_bf16_f32 v147, v178, v179
    v_mfma_f32_16x16x32_bf16 v[172:175], a[48:51], v[180:183], 0
    v_mul_f32 v200, v142, v200
    v_mul_f32 v201, v142, v201
    v_mfma_f32_16x16x32_bf16 v[172:175], a[52:55], v[192:195], v[172:175]
    v_cvt_pk_bf16_f32 v124, v200, v201
    v_mul_f32 v202, v142, v202
    v_mfma_f32_16x16x32_bf16 v[172:175], a[56:59], v[204:207], v[172:175]
    v_fmac_f32 v143, v168, v168
    v_fmac_f32 v143, v169, v169
    v_mfma_f32_16x16x32_bf16 v[172:175], a[60:63], v[220:223], v[172:175]
    v_fmac_f32 v143, v170, v170
    v_fmac_f32 v143, v171, v171
    v_mfma_f32_16x16x32_bf16 v[172:175], a[64:67], v[228:231], v[172:175]
    v_mul_f32 v203, v142, v203
    v_cvt_pk_bf16_f32 v125, v202, v203
    v_mfma_f32_16x16x32_bf16 v[172:175], a[68:71], v[232:235], v[172:175]
    v_mul_f32 v216, v142, v216
    v_mul_f32 v217, v142, v217
    v_mfma_f32_16x16x32_bf16 v[128:131], v[180:183], a[144:147], 0
    v_cvt_pk_bf16_f32 v126, v216, v217
    v_mul_f32 v218, v142, v218
    v_mfma_f32_16x16x32_bf16 v[128:131], v[192:195], a[148:151], v[128:131]
    v_mul_f32 v219, v142, v219
    v_cvt_pk_bf16_f32 v127, v218, v219
    v_mfma_f32_16x16x32_bf16 v[128:131], v[204:207], a[152:155], v[128:131]
    v_fmac_f32 v143, v172, v172
    v_fmac_f32 v143, v173, v173
    v_mfma_f32_16x16x32_bf16 v[128:131], v[220:223], a[156:159], v[128:131]
    v_fmac_f32 v143, v174, v174
    v_fmac_f32 v143, v175, v175
    v_mfma_f32_16x16x32_bf16 v[128:131], v[228:231], a[160:163], v[128:131]
    v_cvt_pk_bf16_f32 v36, v143, v167
    v_mul_f32 v208, v142, v208
    v_mfma_f32_16x16x32_bf16 v[128:131], v[232:235], a[164:167], v[128:131]
    v_mul_f32 v209, v142, v209
    v_cvt_pk_bf16_f32 v186, v208, v209
    v_mfma_f32_16x16x32_bf16 v[176:179], v[32:35], v[36:39], 0
    v_mul_f32 v210, v142, v210
    v_mul_f32 v211, v142, v211
    v_mfma_f32_16x16x32_bf16 v[160:163], v[180:183], a[168:171], 0
    buffer_store_dwordx2 v[146:147], v18, s[12:15], 0 offen nt
    v_cvt_pk_bf16_f32 v187, v210, v211
    v_cvt_pk_bf16_f32 v166, v128, v129
    v_mfma_f32_16x16x32_bf16 v[160:163], v[192:195], a[172:175], v[160:163]
    v_cvt_pk_bf16_f32 v167, v130, v131
    v_mul_f32 v196, v184, v196
    v_mfma_f32_16x16x32_bf16 v[160:163], v[204:207], a[176:179], v[160:163]
    ds_read_b128 v[200:203], v0 offset:32768
    v_mul_f32 v197, v184, v197
    v_mfma_f32_16x16x32_bf16 v[160:163], v[220:223], a[180:183], v[160:163]
    ds_read_b128 v[208:211], v1 offset:32768
    v_cvt_pk_bf16_f32 v128, v196, v197
    v_mfma_f32_16x16x32_bf16 v[160:163], v[228:231], a[184:187], v[160:163]
    ds_read_b128 v[216:219], v0 offset:32896
    v_mul_f32 v198, v184, v198
    v_mfma_f32_16x16x32_bf16 v[160:163], v[232:235], a[188:191], v[160:163]
    ds_read_b128 v[224:227], v1 offset:32896
    v_mul_f32 v199, v184, v199
    v_mfma_f32_16x16x32_bf16 v[188:191], v[180:183], a[192:195], 0
    ds_read_b128 v[180:183], v0 offset:33024
    v_cvt_pk_bf16_f32 v129, v198, v199
    v_mfma_f32_16x16x32_bf16 v[188:191], v[192:195], a[196:199], v[188:191]
    ds_read_b128 v[192:195], v1 offset:33024
    v_mul_f32 v132, v184, v132
    v_mfma_f32_16x16x32_bf16 v[188:191], v[204:207], a[200:203], v[188:191]
    v_rsq_f32 v177, v177
    v_mfma_f32_16x16x32_bf16 v[188:191], v[220:223], a[204:207], v[188:191]
    v_rsq_f32 v176, v176
    v_mfma_f32_16x16x32_bf16 v[188:191], v[228:231], a[208:211], v[188:191]
    s_waitcnt lgkmcnt(5)
    v_mul_f32 v176, s31, v176
    v_cvt_pk_bf16_f32 v142, v160, v161
    v_mfma_f32_16x16x32_bf16 v[188:191], v[232:235], a[212:215], v[188:191]
    s_waitcnt lgkmcnt(4)
    v_cvt_pk_bf16_f32 v143, v162, v163
    v_mul_f32 v116, v177, v116
    v_mfma_f32_16x16x32_bf16 v[196:199], a[72:75], v[200:203], 0
    s_waitcnt lgkmcnt(3)
    v_mul_f32 v117, v177, v117
    v_cvt_pk_f16_f32 v116, v116, v117
    v_mfma_f32_16x16x32_bf16 v[196:199], a[76:79], v[208:211], v[196:199]
    s_waitcnt lgkmcnt(2)
    v_cvt_pk_bf16_f32 v146, v188, v189
    v_cvt_pk_bf16_f32 v147, v190, v191
    v_mfma_f32_16x16x32_bf16 v[196:199], a[80:83], v[216:219], v[196:199]
    s_waitcnt lgkmcnt(1)
    v_mul_f32 v118, v177, v118
    v_mul_f32 v119, v177, v119
    v_mfma_f32_16x16x32_bf16 v[196:199], a[84:87], v[224:227], v[196:199]
    s_waitcnt lgkmcnt(0)
    v_cvt_pk_f16_f32 v117, v118, v119
    v_mul_f32 v136, v177, v136
    v_mfma_f32_16x16x32_bf16 v[196:199], a[88:91], v[180:183], v[196:199]
    v_mul_f32 v137, v177, v137
    v_cvt_pk_f16_f32 v118, v136, v137
    v_mfma_f32_16x16x32_bf16 v[196:199], a[92:95], v[192:195], v[196:199]
    buffer_store_dwordx4 v[124:127], v17, s[12:15], 0 offen nt
    v_mul_f32 v138, v177, v138
    v_mul_f32 v139, v177, v139
    v_cvt_pk_f16_f32 v119, v138, v139
    v_mul_f32 v152, v177, v152
    v_mfma_f32_16x16x32_bf16 v[136:139], a[96:99], v[200:203], 0
    v_mul_f32 v153, v177, v153
    v_cvt_pk_f16_f32 v126, v152, v153
    v_mfma_f32_16x16x32_bf16 v[136:139], a[100:103], v[208:211], v[136:139]
    v_mul_f32 v154, v177, v154
    v_mul_f32 v155, v177, v155
    v_mfma_f32_16x16x32_bf16 v[136:139], a[104:107], v[216:219], v[136:139]
    v_cvt_pk_f16_f32 v127, v154, v155
    v_mul_f32 v156, v176, v156
    v_mfma_f32_16x16x32_bf16 v[136:139], a[108:111], v[224:227], v[136:139]
    v_mul_f32 v157, v176, v157
    v_cvt_pk_f16_f32 v160, v156, v157
    v_mfma_f32_16x16x32_bf16 v[136:139], a[112:115], v[180:183], v[136:139]
    s_waitcnt vmcnt(3)
    ds_write_b16 v8, v46 offset:512
    v_mfma_f32_16x16x32_bf16 v[136:139], a[116:119], v[192:195], v[136:139]
    v_mov_b32 v46, 1
    v_mul_f32 v158, v176, v158
    v_mfma_f32_16x16x32_bf16 v[204:207], a[120:123], v[200:203], 0
    v_mul_f32 v159, v176, v159
    v_cvt_pk_f16_f32 v161, v158, v159
    v_mfma_f32_16x16x32_bf16 v[204:207], a[124:127], v[208:211], v[204:207]
    v_mul_f32 v168, v176, v168
    v_mul_f32 v169, v176, v169
    v_mfma_f32_16x16x32_bf16 v[204:207], a[128:131], v[216:219], v[204:207]
    v_cvt_pk_f16_f32 v162, v168, v169
    v_mul_f32 v170, v176, v170
    v_mfma_f32_16x16x32_bf16 v[204:207], a[132:135], v[224:227], v[204:207]
    v_mul_f32 v171, v176, v171
    v_cvt_pk_f16_f32 v163, v170, v171
    v_mfma_f32_16x16x32_bf16 v[204:207], a[136:139], v[180:183], v[204:207]
    v_mul_f32 v172, v176, v172
    v_mul_f32 v173, v176, v173
    v_mfma_f32_16x16x32_bf16 v[204:207], a[140:143], v[192:195], v[204:207]
    v_cvt_pk_f16_f32 v124, v172, v173
    v_mul_f32 v174, v176, v174
    v_mfma_f32_16x16x32_bf16 v[236:239], a[0:3], v[200:203], 0
    s_waitcnt lgkmcnt(0)
    v_mul_f32 v175, v176, v175
    v_cvt_pk_f16_f32 v125, v174, v175
    v_mfma_f32_16x16x32_bf16 v[236:239], a[4:7], v[208:211], v[236:239]
    s_barrier
    v_fma_f32 v185, v196, v196, s32
    v_fmac_f32 v185, v197, v197
    v_mfma_f32_16x16x32_bf16 v[236:239], a[8:11], v[216:219], v[236:239]
    s_nop 0
    v_fmac_f32 v185, v198, v198
    v_fmac_f32 v185, v199, v199
    v_mfma_f32_16x16x32_bf16 v[236:239], a[12:15], v[224:227], v[236:239]
    s_nop 0
    v_fmac_f32 v185, v136, v136
    v_fmac_f32 v185, v137, v137
    v_mfma_f32_16x16x32_bf16 v[236:239], a[16:19], v[180:183], v[236:239]
    s_nop 0
    buffer_load_dwordx4 v10, s[8:11], 0 offen nt lds
    ds_read_u16 v131, v9 offset:512
    v_mfma_f32_16x16x32_bf16 v[236:239], a[20:23], v[192:195], v[236:239]
    s_add_u32 m0, s28, 4096
    v_fmac_f32 v185, v138, v138
    v_fmac_f32 v185, v139, v139
    v_mfma_f32_16x16x32_bf16 v[176:179], a[24:27], v[200:203], 0
    v_fmac_f32 v185, v204, v204
    v_fmac_f32 v185, v205, v205
    v_mfma_f32_16x16x32_bf16 v[176:179], a[28:31], v[208:211], v[176:179]
    v_fmac_f32 v185, v206, v206
    v_fma_f32 v152, v236, v236, s32
    v_mfma_f32_16x16x32_bf16 v[176:179], a[32:35], v[216:219], v[176:179]
    v_fmac_f32 v152, v237, v237
    v_fmac_f32 v152, v238, v238
    v_mfma_f32_16x16x32_bf16 v[176:179], a[36:39], v[224:227], v[176:179]
    buffer_load_dwordx4 v11, s[8:11], 0 offen nt lds
    v_fmac_f32 v152, v239, v239
    v_mfma_f32_16x16x32_bf16 v[176:179], a[40:43], v[180:183], v[176:179]
    s_add_u32 m0, s28, 8192
    v_fmac_f32 v185, v207, v207
    v_mul_f32 v133, v184, v133
    v_mfma_f32_16x16x32_bf16 v[176:179], a[44:47], v[192:195], v[176:179]
    v_cvt_pk_bf16_f32 v130, v132, v133
    v_mul_f32 v134, v184, v134
    v_mfma_f32_16x16x32_bf16 v[188:191], a[48:51], v[200:203], 0
    s_waitcnt lgkmcnt(0)
    v_readfirstlane_b32 s77, v131
    v_mul_f32 v135, v184, v135
    v_mfma_f32_16x16x32_bf16 v[188:191], a[52:55], v[208:211], v[188:191]
    v_cvt_pk_bf16_f32 v131, v134, v135
    v_fmac_f32 v152, v176, v176
    v_mfma_f32_16x16x32_bf16 v[188:191], a[56:59], v[216:219], v[188:191]
    buffer_load_dwordx4 v12, s[8:11], 0 offen nt lds
    v_fmac_f32 v152, v177, v177
    v_mfma_f32_16x16x32_bf16 v[188:191], a[60:63], v[224:227], v[188:191]
    s_add_u32 m0, s28, 12288
    v_fmac_f32 v152, v178, v178
    v_fmac_f32 v152, v179, v179
    v_mfma_f32_16x16x32_bf16 v[188:191], a[64:67], v[180:183], v[188:191]
    s_xor_b32 s28, s28, 65536
    ds_read2_b32 v[154:155], v6 offset0:0 offset1:0
    ds_read2_b32 v[158:159], v6 offset0:16 offset1:16
    v_mfma_f32_16x16x32_bf16 v[188:191], a[68:71], v[192:195], v[188:191]
    ds_read2_b32 v[170:171], v6 offset0:32 offset1:32
    v_mul_f32 v212, v184, v212
    v_mfma_f32_16x16x32_bf16 v[132:135], v[200:203], a[144:147], 0
    v_mul_f32 v213, v184, v213
    v_cvt_pk_bf16_f32 v240, v212, v213
    v_mfma_f32_16x16x32_bf16 v[132:135], v[208:211], a[148:151], v[132:135]
    buffer_load_dwordx4 v13, s[8:11], 0 offen nt lds
    v_mul_f32 v214, v184, v214
    v_mfma_f32_16x16x32_bf16 v[132:135], v[216:219], a[152:155], v[132:135]
    s_mov_b32 m0, s29
    v_fmac_f32 v152, v188, v188
    v_fmac_f32 v152, v189, v189
    v_mfma_f32_16x16x32_bf16 v[132:135], v[224:227], a[156:159], v[132:135]
    s_xor_b32 s29, s29, s30
    v_fmac_f32 v152, v190, v190
    v_fmac_f32 v152, v191, v191
    v_mfma_f32_16x16x32_bf16 v[132:135], v[180:183], a[160:163], v[132:135]
    s_add_u32 s19, s19, s20
    v_cvt_pk_bf16_f32 v36, v152, v185
    v_mul_f32 v215, v184, v215
    v_mfma_f32_16x16x32_bf16 v[132:135], v[192:195], a[164:167], v[132:135]
    s_add_u32 s23, s23, s21
    v_cvt_pk_bf16_f32 v241, v214, v215
    v_xor_b32 v0, 65536, v0
    v_mfma_f32_16x16x32_bf16 v[232:235], v[32:35], v[36:39], 0
    s_cmp_ge_u32 s19, 72
    buffer_load_dwordx4 v14, s[8:11], 0 offen nt lds
    v_xor_b32 v1, 65536, v1
    v_mfma_f32_16x16x32_bf16 v[212:215], v[200:203], a[168:171], 0
    s_cselect_b32 s34, 72, 0
    v_cvt_pk_bf16_f32 v152, v132, v133
    v_cvt_pk_bf16_f32 v153, v134, v135
    v_mfma_f32_16x16x32_bf16 v[212:215], v[208:211], a[172:175], v[212:215]
    s_cselect_b32 s35, s22, 0
    v_rsq_f32 v233, v233
    v_mfma_f32_16x16x32_bf16 v[212:215], v[216:219], a[176:179], v[212:215]
    s_sub_u32 s19, s19, s34
    v_rsq_f32 v232, v232
    v_mfma_f32_16x16x32_bf16 v[212:215], v[224:227], a[180:183], v[212:215]
    s_add_u32 s23, s23, s35
    v_mul_f32 v232, s31, v232
    v_mul_f32 v196, v233, v196
    v_mfma_f32_16x16x32_bf16 v[212:215], v[180:183], a[184:187], v[212:215]
    s_cmp_lg_u32 s83, 0
    buffer_store_dwordx2 v[186:187], v20, s[12:15], 0 offen nt
    v_mul_f32 v197, v233, v197
    v_cvt_pk_f16_f32 v172, v196, v197
    v_mfma_f32_16x16x32_bf16 v[212:215], v[192:195], a[188:191], v[212:215]
    s_cselect_b32 s77, s80, s77
    v_mul_f32 v198, v233, v198
    v_mul_f32 v199, v233, v199
    v_mfma_f32_16x16x32_bf16 v[248:251], v[200:203], a[192:195], 0
    s_mul_i32 s78, s77, 2688
    v_cvt_pk_f16_f32 v173, v198, v199
    v_mul_f32 v136, v233, v136
    v_mfma_f32_16x16x32_bf16 v[248:251], v[208:211], a[196:199], v[248:251]
    s_add_u32 s78, s78, s69
    v_cvt_pk_bf16_f32 v156, v212, v213
    v_cvt_pk_bf16_f32 v157, v214, v215
    v_mfma_f32_16x16x32_bf16 v[248:251], v[216:219], a[200:203], v[248:251]
    s_add_u32 s80, s77, s68
    ds_read_b128 v[228:231], v5 offset:0
    ds_read_b128 v[220:223], v5 offset:16
    v_mfma_f32_16x16x32_bf16 v[248:251], v[224:227], a[204:207], v[248:251]
    s_cmp_ge_u32 s80, 72
    ds_read_b128 v[224:227], v5 offset:48
    ds_read_b32 v242, v6 offset:192
    v_mfma_f32_16x16x32_bf16 v[248:251], v[180:183], a[208:211], v[248:251]
    s_cselect_b32 s80, s22, 0
    v_mul_f32 v137, v233, v137
    v_cvt_pk_f16_f32 v174, v136, v137
    v_mfma_f32_16x16x32_bf16 v[248:251], v[192:195], a[212:215], v[248:251]
    s_add_u32 s78, s78, s80
    ds_read_b128 v[192:195], v2 offset:0
    ds_read_b128 v[184:187], v2 offset:1024
    v_mfma_f32_16x16x32_f16 v[216:219], v[148:151], v[244:247], v[48:51]
    s_add_u32 s80, s77, 20
    ds_read_b128 v[132:135], v2 offset:2048
    v_mul_f32 v138, v233, v138
    v_mfma_f32_16x16x32_f16 v[212:215], v[116:119], v[244:247], v[52:55]
    s_add_u32 s34, s18, 3
    v_cvt_pk_bf16_f32 v168, v248, v249
    v_cvt_pk_bf16_f32 v169, v250, v251
    v_mul_f32 v139, v233, v139
    v_mfma_f32_16x16x16_f16 v[216:219], v[122:123], v[120:121], v[216:219]
    v_cvt_pk_f16_f32 v175, v138, v139
    v_mul_f32 v204, v233, v204
    v_mul_f32 v205, v233, v205
    v_mfma_f32_16x16x16_f16 v[212:215], v[126:127], v[120:121], v[212:215]
    v_cvt_pk_f16_f32 v138, v204, v205
    v_mul_f32 v206, v233, v206
    v_mul_f32 v207, v233, v207
    v_cvt_pk_f16_f32 v139, v206, v207
    v_mfma_f32_16x16x32_f16 v[208:211], v[172:175], v[244:247], v[56:59]
    s_cmp_lt_u32 s77, s62
    v_mul_f32 v236, v232, v236
    v_mul_f32 v237, v232, v237
    v_cvt_pk_f16_f32 v180, v236, v237
    v_mul_f32 v238, v232, v238
    v_mul_f32 v239, v232, v239
    v_mfma_f32_16x16x16_f16 v[208:211], v[138:139], v[120:121], v[208:211]
    v_cvt_pk_f16_f32 v181, v238, v239
    v_mul_f32 v176, v232, v176
    v_mul_f32 v177, v232, v177
    s_waitcnt lgkmcnt(1)
    v_mfma_f32_16x16x32_f16 v[236:239], v[228:231], v[244:247], v[22:25]
    s_cselect_b32 s79, 1, 0
    ds_read_b128 v[196:199], v2 offset:3072
    v_cvt_pk_f16_f32 v182, v176, v177
    v_mfma_f32_16x16x32_f16 v[236:239], v[220:223], v[148:151], v[236:239]
    s_cselect_b32 s78, s78, 0
    v_mul_f32 v178, v232, v178
    v_mul_f32 v179, v232, v179
    v_mfma_f32_16x16x32_f16 v[236:239], v[224:227], v[120:123], v[236:239]
    s_cmp_lt_u32 s34, s17
    ds_read_b128 v[204:207], v2 offset:4096
    buffer_store_dwordx4 v[128:131], v16, s[12:15], 0 offen nt
    ds_read_b128 v[200:203], v2 offset:5120
    v_cvt_pk_f16_f32 v183, v178, v179
    v_mul_f32 v188, v232, v188
    v_mul_f32 v189, v232, v189
    v_cvt_pk_f16_f32 v136, v188, v189
    v_mul_f32 v190, v232, v190
    v_mul_f32 v191, v232, v191
    v_mfma_f32_16x16x32_f16 v[232:235], v[228:231], v[160:163], v[24:27]
    s_cselect_b32 s23, s23, s78
    v_cvt_pk_f16_f32 v137, v190, v191
    v_mov_b32_dpp v242, v237 quad_perm:[0,1,2,3] row_mask:0x1 bank_mask:0xf
    v_mfma_f32_16x16x32_f16 v[232:235], v[220:223], v[116:119], v[232:235]
    s_cselect_b32 s73, s34, s80
    v_max3_f32 v243, v236, v216, v217
    v_max3_f32 v243, v243, v218, v219
    v_mfma_f32_16x16x32_f16 v[232:235], v[224:227], v[124:127], v[232:235]
    s_cselect_b32 s79, 0, s79
    v_max3_f32 v243, v243, v212, v213
    v_max3_f32 v243, v243, v214, v215
    v_max3_f32 v243, v243, v208, v209
    v_max3_f32 v243, v243, v210, v211
    v_mov_b32 v120, v243
    v_add_u32 v5, s74, v5
    v_add_u32 v6, s75, v6
    v_mov_b32_dpp v242, v233 quad_perm:[0,1,2,3] row_mask:0x2 bank_mask:0xf
    v_permlane32_swap_b32 v243, v120
    v_max_f32 v243, v243, v120
    v_mfma_f32_16x16x32_f16 v[244:247], v[228:231], v[180:183], v[26:29]
    s_cselect_b32 s81, 0, 1
    v_mov_b32 v120, v243
    s_add_u32 s80, s77, 1
    v_mfma_f32_16x16x32_f16 v[244:247], v[220:223], v[172:175], v[244:247]
    s_mul_i32 s80, s80, s81
    v_permlane16_swap_b32 v243, v120
    v_mfma_f32_16x16x32_f16 v[244:247], v[224:227], v[136:139], v[244:247]
    s_cmp_lt_u32 s80, s62
    v_max_f32 v243, v243, v120
    v_sub_f32 v216, v216, v243
    v_mfma_f32_16x16x32_bf16 v[128:131], a[216:219], v[192:195], 0
    s_cselect_b32 s70, s70, 0
    v_exp_f32 v216, v216
    v_mfma_f32_16x16x32_bf16 v[128:131], a[220:223], v[184:187], v[128:131]
    s_waitcnt lgkmcnt(0)
    v_sub_f32 v217, v217, v243
    v_sub_f32 v218, v218, v243
    v_mfma_f32_16x16x32_bf16 v[128:131], a[224:227], v[132:135], v[128:131]
    s_cselect_b32 s62, s62, 0
    v_exp_f32 v217, v217
    v_mfma_f32_16x16x32_bf16 v[128:131], a[228:231], v[196:199], v[128:131]
    s_add_u32 s80, s18, 4
    v_cvt_pk_bf16_f32 v216, v216, v217
    v_sub_f32 v219, v219, v243
    v_mfma_f32_16x16x32_bf16 v[128:131], a[232:235], v[204:207], v[128:131]
    s_cmp_ge_u32 s80, s17
    v_exp_f32 v218, v218
    v_mfma_f32_16x16x32_bf16 v[128:131], a[236:239], v[200:203], v[128:131]
    s_cselect_b32 s66, s70, 0
    v_exp_f32 v219, v219
    v_mfma_f32_16x16x32_bf16 v[188:191], a[240:243], v[192:195], 0
    s_lshl_b32 s80, s79, s73
    v_cvt_pk_bf16_f32 v217, v218, v219
    v_sub_f32 v212, v212, v243
    v_mfma_f32_16x16x32_bf16 v[188:191], a[244:247], v[184:187], v[188:191]
    s_or_b32 s63, s63, s80
    buffer_atomic_add v46, v10, s[64:67], 0 offen sc0 sc1
    buffer_store_dwordx2 v[240:241], v19, s[12:15], 0 offen nt
    v_exp_f32 v212, v212
    v_mfma_f32_16x16x32_f16 v[220:223], v[148:151], v[160:163], v[60:63]
    s_sub_u32 s80, s100, s81
    v_sub_f32 v213, v213, v243
    v_sub_f32 v214, v214, v243
    v_mfma_f32_16x16x32_bf16 v[188:191], a[248:251], v[132:135], v[188:191]
    s_and_b32 s100, s100, s80
    v_exp_f32 v213, v213
    v_sub_f32 v215, v215, v243
    v_mfma_f32_16x16x16_f16 v[220:223], v[122:123], v[124:125], v[220:223]
    v_cvt_pk_bf16_f32 v218, v212, v213
    v_exp_f32 v214, v214
    v_sub_f32 v208, v208, v243
    v_mfma_f32_16x16x32_f16 v[224:227], v[116:119], v[160:163], v[64:67]
    s_add_u32 s45, s45, s79
    v_exp_f32 v215, v215
    v_mfma_f32_16x16x32_bf16 v[188:191], a[252:255], v[196:199], v[188:191]
    s_add_u32 s18, s18, 1
    v_cvt_pk_bf16_f32 v219, v214, v215
    v_sub_f32 v209, v209, v243
    v_sub_f32 v210, v210, v243
    v_mfma_f32_16x16x16_f16 v[224:227], v[126:127], v[124:125], v[224:227]
    v_exp_f32 v208, v208
    v_exp_f32 v209, v209
    v_mfma_f32_16x16x32_f16 v[212:215], v[172:175], v[160:163], v[68:71]
    s_cmp_lt_u32 s18, s45
    v_cvt_pk_bf16_f32 v36, v208, v209
    v_sub_f32 v211, v211, v243
    v_mfma_f32_16x16x32_bf16 v[188:191], v[84:87], v[204:207], v[188:191]
    v_exp_f32 v210, v210
    v_mfma_f32_16x16x32_bf16 v[188:191], v[88:91], v[200:203], v[188:191]
    v_exp_f32 v211, v211
    v_sub_f32 v236, v236, v243
    v_mfma_f32_16x16x16_f16 v[212:215], v[138:139], v[124:125], v[212:215]
    v_cvt_pk_bf16_f32 v37, v210, v211
    v_exp_f32 v236, v236
    v_mov_b32_dpp v242, v245 quad_perm:[0,1,2,3] row_mask:0x4 bank_mask:0xf
    v_mfma_f32_16x16x32_bf16 v[176:179], v[92:95], v[192:195], 0
    ds_read_b128 v[160:163], v2 offset:6144
    v_cvt_pk_bf16_f32 v39, v236, 0
    v_mfma_f32_16x16x32_bf16 v[176:179], v[96:99], v[184:187], v[176:179]
    ds_read_b128 v[184:187], v2 offset:7168
    v_mov_b32 v120, v242
    v_mfma_f32_16x16x32_bf16 v[192:195], v[28:31], v[36:39], 0
    v_max3_f32 v121, v232, v220, v221
    v_max_f32_dpp v120, v120, v120 quad_perm:[1,0,3,2] row_mask:0xf bank_mask:0xf
    v_mfma_f32_16x16x32_bf16 v[192:195], v[28:31], v[216:219], v[192:195]
    v_max3_f32 v121, v121, v222, v223
    v_max_f32_dpp v120, v120, v120 quad_perm:[2,3,0,1] row_mask:0xf bank_mask:0xf
    v_mfma_f32_16x16x32_bf16 v[208:211], v[152:155], v[36:39], 0
    v_max3_f32 v121, v121, v224, v225
    v_max_f32_dpp v120, v120, v120 row_half_mirror row_mask:0xf bank_mask:0xf
    v_mfma_f32_16x16x32_bf16 v[208:211], v[164:167], v[216:219], v[208:211]
    v_max3_f32 v121, v121, v226, v227
    v_max_f32_dpp v120, v120, v120 row_mirror row_mask:0xf bank_mask:0xf
    v_mfma_f32_16x16x32_bf16 v[176:179], v[100:103], v[132:135], v[176:179]
    ds_read_b128 v[228:231], v2 offset:8192
    v_mov_b32 v124, v120
    v_mfma_f32_16x16x32_bf16 v[176:179], v[104:107], v[196:199], v[176:179]
    ds_read_b128 v[236:239], v2 offset:9216
    v_max3_f32 v121, v121, v212, v213
    v_mfma_f32_16x16x32_bf16 v[176:179], v[108:111], v[204:207], v[176:179]
    s_waitcnt lgkmcnt(3)
    ds_read_b128 v[204:207], v2 offset:10240
    v_max3_f32 v121, v121, v214, v215
    v_mfma_f32_16x16x32_bf16 v[176:179], v[112:115], v[200:203], v[176:179]
    s_waitcnt lgkmcnt(3)
    ds_read_b128 v[200:203], v2 offset:11264
    v_rcp_f32 v192, v192
    v_permlane32_swap_b32 v120, v124
    v_mul_f32 v208, v192, v208
    v_mul_f32 v209, v192, v209
    v_cvt_pk_bf16_f32 v132, v208, v209
    v_mul_f32 v210, v192, v210
    v_mul_f32 v211, v192, v211
    v_cvt_pk_bf16_f32 v133, v210, v211
    v_max_f32 v120, v120, v124
    v_mfma_f32_16x16x32_bf16 v[196:199], v[156:159], v[36:39], 0
    v_mov_b32 v124, v120
    v_mov_b32 v125, v121
    v_mfma_f32_16x16x32_bf16 v[196:199], v[140:143], v[216:219], v[196:199]
    s_waitcnt lgkmcnt(3)
    v_permlane16_swap_b32 v120, v124
    v_max_f32 v120, v120, v124
    v_sub_f32 v242, v242, v120
    v_exp_f32 v242, v242
    v_permlane32_swap_b32 v121, v125
    v_cvt_pk_bf16_f32 v242, v242, v242
    v_max_f32 v121, v121, v125
    v_mul_f32 v196, v192, v196
    v_mul_f32 v197, v192, v197
    v_cvt_pk_bf16_f32 v134, v196, v197
    v_mul_f32 v198, v192, v198
    v_mul_f32 v199, v192, v199
    v_cvt_pk_bf16_f32 v135, v198, v199
    v_mov_b32 v125, v121
    v_fma_f32 v120, v128, v128, s33
    v_fmac_f32 v120, v129, v129
    v_permlane16_swap_b32 v121, v125
    v_max_f32 v121, v121, v125
    v_sub_f32 v220, v220, v121
    v_exp_f32 v220, v220
    v_sub_f32 v221, v221, v121
    v_exp_f32 v221, v221
    v_sub_f32 v222, v222, v121
    v_cvt_pk_bf16_f32 v208, v220, v221
    v_exp_f32 v222, v222
    v_sub_f32 v223, v223, v121
    v_exp_f32 v223, v223
    v_sub_f32 v224, v224, v121
    v_cvt_pk_bf16_f32 v209, v222, v223
    v_mfma_f32_16x16x32_bf16 v[220:223], v[168:171], v[36:39], 0
    s_waitcnt lgkmcnt(0)
    ds_write_b16 v8, v242
    v_mfma_f32_16x16x32_bf16 v[220:223], v[144:147], v[216:219], v[220:223]
    v_exp_f32 v224, v224
    v_mfma_f32_16x16x32_bf16 v[196:199], a[216:219], v[160:163], 0
    ds_write_b128 v3, v[132:135] offset:0
    v_mfma_f32_16x16x32_bf16 v[196:199], a[220:223], v[184:187], v[196:199]
    v_sub_f32 v225, v225, v121
    v_sub_f32 v226, v226, v121
    v_mfma_f32_16x16x32_bf16 v[196:199], a[224:227], v[228:231], v[196:199]
    v_exp_f32 v225, v225
    v_mfma_f32_16x16x32_bf16 v[196:199], a[228:231], v[236:239], v[196:199]
    ds_read_b128 v[240:243], v9
    v_mul_f32 v220, v192, v220
    v_mfma_f32_16x16x32_bf16 v[196:199], a[232:235], v[204:207], v[196:199]
    v_mul_f32 v221, v192, v221
    v_cvt_pk_bf16_f32 v124, v220, v221
    v_mfma_f32_16x16x32_bf16 v[196:199], a[236:239], v[200:203], v[196:199]
    v_mul_f32 v222, v192, v222
    v_mul_f32 v223, v192, v223
    v_cvt_pk_bf16_f32 v125, v222, v223
    v_mfma_f32_16x16x32_bf16 v[132:135], a[240:243], v[160:163], 0
    ds_write_b64 v4, v[124:125] offset:4096
    v_mfma_f32_16x16x32_bf16 v[132:135], a[244:247], v[184:187], v[132:135]
    v_cvt_pk_bf16_f32 v210, v224, v225
    v_sub_f32 v227, v227, v121
    v_mfma_f32_16x16x32_bf16 v[132:135], a[248:251], v[228:231], v[132:135]
    v_exp_f32 v226, v226
    v_mfma_f32_16x16x32_bf16 v[132:135], a[252:255], v[236:239], v[132:135]
    v_exp_f32 v227, v227
    v_mfma_f32_16x16x32_bf16 v[132:135], v[84:87], v[204:207], v[132:135]
    s_waitcnt lgkmcnt(1)
    v_cvt_pk_bf16_f32 v211, v226, v227
    v_sub_f32 v212, v212, v121
    v_mfma_f32_16x16x32_bf16 v[132:135], v[88:91], v[200:203], v[132:135]
    ds_read_b128 v[192:195], v9 offset:64
    v_exp_f32 v212, v212
    v_sub_f32 v213, v213, v121
    v_exp_f32 v213, v213
    v_sub_f32 v214, v214, v121
    v_cvt_pk_bf16_f32 v36, v212, v213
    v_exp_f32 v214, v214
    v_sub_f32 v215, v215, v121
    v_exp_f32 v215, v215
    v_sub_f32 v232, v232, v121
    v_cvt_pk_bf16_f32 v37, v214, v215
    v_mfma_f32_16x16x32_f16 v[220:223], v[148:151], v[180:183], v[72:75]
    v_exp_f32 v232, v232
    v_mfma_f32_16x16x32_f16 v[148:151], v[116:119], v[180:183], v[76:79]
    v_cvt_pk_bf16_f32 v39, v232, 0
    v_fmac_f32 v120, v130, v130
    v_mfma_f32_16x16x32_f16 v[224:227], v[172:175], v[180:183], v[80:83]
    v_fmac_f32 v120, v131, v131
    v_fmac_f32 v120, v188, v188
    v_mfma_f32_16x16x32_bf16 v[180:183], v[28:31], v[36:39], 0
    s_waitcnt lgkmcnt(0)
    v_fmac_f32 v120, v189, v189
    v_fmac_f32 v120, v190, v190
    v_mfma_f32_16x16x32_bf16 v[180:183], v[28:31], v[208:211], v[180:183]
    v_fmac_f32 v120, v191, v191
    v_fmac_f32 v120, v176, v176
    v_mfma_f32_16x16x32_bf16 v[116:119], v[152:155], v[36:39], 0
    v_fmac_f32 v120, v177, v177
    v_fmac_f32 v120, v178, v178
    v_mfma_f32_16x16x32_bf16 v[116:119], v[164:167], v[208:211], v[116:119]
    v_fmac_f32 v120, v179, v179
    v_fma_f32 v121, v196, v196, s33
    v_mfma_f32_16x16x32_bf16 v[172:175], v[156:159], v[36:39], 0
    v_rcp_f32 v180, v180
    v_mfma_f32_16x16x32_bf16 v[172:175], v[140:143], v[208:211], v[172:175]
    v_fmac_f32 v121, v197, v197
    v_fmac_f32 v121, v198, v198
    v_fmac_f32 v121, v199, v199
    v_mfma_f32_16x16x16_f16 v[220:223], v[122:123], v[136:137], v[220:223]
    v_mul_f32 v116, v180, v116
    v_mul_f32 v117, v180, v117
    v_cvt_pk_bf16_f32 v116, v116, v117
    v_mfma_f32_16x16x16_f16 v[148:151], v[126:127], v[136:137], v[148:151]
    v_mul_f32 v118, v180, v118
    v_mul_f32 v119, v180, v119
    v_cvt_pk_bf16_f32 v117, v118, v119
    v_mul_f32 v172, v180, v172
    v_mfma_f32_16x16x32_bf16 v[124:127], v[168:171], v[36:39], 0
    v_max3_f32 v122, v244, v220, v221
    v_max3_f32 v122, v122, v222, v223
    v_mfma_f32_16x16x32_bf16 v[124:127], v[144:147], v[208:211], v[124:127]
    v_max3_f32 v122, v122, v148, v149
    v_max3_f32 v122, v122, v150, v151
    v_mul_f32 v173, v180, v173
    v_mfma_f32_16x16x16_f16 v[224:227], v[138:139], v[136:137], v[224:227]
    v_cvt_pk_bf16_f32 v118, v172, v173
    v_mul_f32 v174, v180, v174
    v_mul_f32 v175, v180, v175
    v_cvt_pk_bf16_f32 v119, v174, v175
    v_mfma_f32_16x16x32_bf16 v[212:215], v[92:95], v[160:163], 0
    ds_read_b128 v[136:139], v2 offset:12288
    v_mul_f32 v124, v180, v124
    v_mfma_f32_16x16x32_bf16 v[212:215], v[96:99], v[184:187], v[212:215]
    ds_read_b128 v[160:163], v2 offset:13312
    v_max3_f32 v122, v122, v224, v225
    v_mfma_f32_16x16x32_bf16 v[212:215], v[100:103], v[228:231], v[212:215]
    ds_read_b128 v[172:175], v2 offset:14336
    v_max3_f32 v122, v122, v226, v227
    v_mfma_f32_16x16x32_bf16 v[212:215], v[104:107], v[236:239], v[212:215]
    ds_read_b128 v[184:187], v2 offset:15360
    v_mov_b32 v123, v122
    v_mfma_f32_16x16x32_bf16 v[212:215], v[108:111], v[204:207], v[212:215]
    ds_read_b128 v[204:207], v2 offset:16384
    v_mul_f32 v125, v180, v125
    v_mfma_f32_16x16x32_bf16 v[212:215], v[112:115], v[200:203], v[212:215]
    ds_read_b128 v[228:231], v2 offset:17408
    v_cvt_pk_bf16_f32 v124, v124, v125
    v_mfma_f32_16x16x32_bf16 v[236:239], v[240:243], v[28:31], 0
    ds_write_b128 v3, v[116:119] offset:6144
    v_mfma_f32_16x16x32_bf16 v[236:239], v[192:195], v[28:31], v[236:239]
    s_waitcnt lgkmcnt(6)
    v_permlane32_swap_b32 v122, v123
    v_mfma_f32_16x16x32_bf16 v[200:203], a[216:219], v[136:139], 0
    s_waitcnt lgkmcnt(5)
    v_max_f32 v122, v122, v123
    v_mov_b32 v123, v122
    v_mfma_f32_16x16x32_bf16 v[200:203], a[220:223], v[160:163], v[200:203]
    s_waitcnt lgkmcnt(4)
    v_rcp_f32 v236, v236
    v_mfma_f32_16x16x32_bf16 v[200:203], a[224:227], v[172:175], v[200:203]
    s_waitcnt lgkmcnt(3)
    v_permlane16_swap_b32 v122, v123
    v_mfma_f32_16x16x32_bf16 v[200:203], a[228:231], v[184:187], v[200:203]
    s_waitcnt lgkmcnt(2)
    v_max_f32 v122, v122, v123
    v_sub_f32 v220, v220, v122
    v_mfma_f32_16x16x32_bf16 v[200:203], a[232:235], v[204:207], v[200:203]
    s_waitcnt lgkmcnt(1)
    v_exp_f32 v220, v220
    v_mfma_f32_16x16x32_bf16 v[200:203], a[236:239], v[228:231], v[200:203]
    v_sub_f32 v221, v221, v122
    v_sub_f32 v222, v222, v122
    v_mfma_f32_16x16x32_bf16 v[216:219], a[240:243], v[136:139], 0
    v_exp_f32 v221, v221
    v_mfma_f32_16x16x32_bf16 v[216:219], a[244:247], v[160:163], v[216:219]
    v_cvt_pk_bf16_f32 v220, v220, v221
    v_sub_f32 v223, v223, v122
    v_mfma_f32_16x16x32_bf16 v[216:219], a[248:251], v[172:175], v[216:219]
    v_exp_f32 v222, v222
    v_mfma_f32_16x16x32_bf16 v[216:219], a[252:255], v[184:187], v[216:219]
    v_exp_f32 v223, v223
    v_mfma_f32_16x16x32_bf16 v[216:219], v[84:87], v[204:207], v[216:219]
    v_cvt_pk_bf16_f32 v221, v222, v223
    v_sub_f32 v148, v148, v122
    v_mfma_f32_16x16x32_bf16 v[216:219], v[88:91], v[228:231], v[216:219]
    v_exp_f32 v148, v148
    v_mfma_f32_16x16x32_bf16 v[208:211], v[92:95], v[136:139], 0
    v_sub_f32 v149, v149, v122
    v_sub_f32 v150, v150, v122
    v_mfma_f32_16x16x32_bf16 v[208:211], v[96:99], v[160:163], v[208:211]
    v_exp_f32 v149, v149
    v_mfma_f32_16x16x32_bf16 v[208:211], v[100:103], v[172:175], v[208:211]
    v_cvt_pk_bf16_f32 v222, v148, v149
    v_sub_f32 v151, v151, v122
    v_mfma_f32_16x16x32_bf16 v[208:211], v[104:107], v[184:187], v[208:211]
    v_exp_f32 v150, v150
    v_mfma_f32_16x16x32_bf16 v[208:211], v[108:111], v[204:207], v[208:211]
    v_exp_f32 v151, v151
    v_mfma_f32_16x16x32_bf16 v[208:211], v[112:115], v[228:231], v[208:211]
    ds_read_b128 v[232:235], v0 offset:20480
    ds_read_b128 v[248:251], v1 offset:20480
    v_mfma_f32_16x16x32_bf16 v[184:187], v[240:243], v[164:167], 0
    ds_read_b128 v[160:163], v0 offset:20608
    ds_read_b128 v[136:139], v1 offset:20608
    v_mfma_f32_16x16x32_bf16 v[184:187], v[192:195], v[152:155], v[184:187]
    v_cvt_pk_bf16_f32 v223, v150, v151
    v_sub_f32 v224, v224, v122
    v_mfma_f32_16x16x32_bf16 v[148:151], v[240:243], v[140:143], 0
    ds_read_b128 v[116:119], v0 offset:20736
    v_sub_f32 v225, v225, v122
    v_mfma_f32_16x16x32_bf16 v[148:151], v[192:195], v[156:159], v[148:151]
    ds_read_b128 v[172:175], v1 offset:20736
    v_exp_f32 v224, v224
    v_mul_f32 v184, v184, v236
    v_exp_f32 v225, v225
    v_sub_f32 v226, v226, v122
    v_cvt_pk_bf16_f32 v36, v224, v225
    v_exp_f32 v226, v226
    v_sub_f32 v227, v227, v122
    v_mul_f32_dpp v184, v148, v236 quad_perm:[0,1,2,3] row_mask:0x2 bank_mask:0xf
    v_mfma_f32_16x16x32_bf16 v[204:207], v[240:243], v[144:147], 0
    s_waitcnt lgkmcnt(4)
    v_exp_f32 v227, v227
    v_mfma_f32_16x16x32_bf16 v[204:207], v[192:195], v[168:171], v[204:207]
    s_waitcnt lgkmcnt(2)
    v_cvt_pk_bf16_f32 v37, v226, v227
    v_sub_f32 v244, v244, v122
    v_mfma_f32_16x16x32_bf16 v[148:151], a[72:75], v[232:235], 0
    v_exp_f32 v244, v244
    v_mfma_f32_16x16x32_bf16 v[148:151], a[76:79], v[248:251], v[148:151]
    s_waitcnt lgkmcnt(1)
    v_cvt_pk_bf16_f32 v39, v244, 0
    v_mul_f32_dpp v184, v204, v236 quad_perm:[0,1,2,3] row_mask:0x4 bank_mask:0xf
    v_mfma_f32_16x16x32_bf16 v[148:151], a[80:83], v[160:163], v[148:151]
    s_waitcnt lgkmcnt(0)
    v_cvt_pk_bf16_f32 v184, v184, v184
    v_mul_f32 v126, v180, v126
    v_mfma_f32_16x16x32_bf16 v[192:195], v[28:31], v[36:39], 0
    ds_write_b16 v7, v184
    v_mfma_f32_16x16x32_bf16 v[192:195], v[28:31], v[220:223], v[192:195]
    v_mul_f32 v127, v180, v127
    v_cvt_pk_bf16_f32 v125, v126, v127
    v_mfma_f32_16x16x32_bf16 v[180:183], v[152:155], v[36:39], 0
    ds_write_b64 v4, v[124:125] offset:10240
    v_mfma_f32_16x16x32_bf16 v[180:183], v[164:167], v[220:223], v[180:183]
    v_fma_f32 v122, v200, v200, s33
    v_fmac_f32 v122, v201, v201
    v_mfma_f32_16x16x32_bf16 v[124:127], v[156:159], v[36:39], 0
    v_rcp_f32 v192, v192
    v_mfma_f32_16x16x32_bf16 v[124:127], v[140:143], v[220:223], v[124:127]
    v_fmac_f32 v122, v202, v202
    v_fmac_f32 v122, v203, v203
    v_mfma_f32_16x16x32_bf16 v[152:155], v[168:171], v[36:39], 0
    v_mul_f32 v180, v192, v180
    v_mul_f32 v181, v192, v181
    v_mfma_f32_16x16x32_bf16 v[152:155], v[144:147], v[220:223], v[152:155]
    v_cvt_pk_bf16_f32 v144, v180, v181
    v_mul_f32 v182, v192, v182
    v_mfma_f32_16x16x32_bf16 v[148:151], a[84:87], v[136:139], v[148:151]
    v_mul_f32 v183, v192, v183
    v_cvt_pk_bf16_f32 v145, v182, v183
    v_mfma_f32_16x16x32_bf16 v[148:151], a[88:91], v[116:119], v[148:151]
    v_mul_f32 v124, v192, v124
    v_mul_f32 v125, v192, v125
    v_mfma_f32_16x16x32_bf16 v[148:151], a[92:95], v[172:175], v[148:151]
    v_cvt_pk_bf16_f32 v146, v124, v125
    v_mul_f32 v126, v192, v126
    v_mfma_f32_16x16x32_bf16 v[140:143], a[96:99], v[232:235], 0
    v_mul_f32 v127, v192, v127
    v_cvt_pk_bf16_f32 v147, v126, v127
    v_mfma_f32_16x16x32_bf16 v[140:143], a[100:103], v[248:251], v[140:143]
    ds_write_b128 v3, v[144:147] offset:12288
    v_mfma_f32_16x16x32_bf16 v[140:143], a[104:107], v[160:163], v[140:143]
    v_mul_f32 v152, v192, v152
    v_mul_f32 v153, v192, v153
    v_mfma_f32_16x16x32_bf16 v[140:143], a[108:111], v[136:139], v[140:143]
    v_cvt_pk_bf16_f32 v152, v152, v153
    v_mul_f32 v154, v192, v154
    v_mfma_f32_16x16x32_bf16 v[140:143], a[112:115], v[116:119], v[140:143]
    v_mul_f32 v155, v192, v155
    v_cvt_pk_bf16_f32 v153, v154, v155
    v_mfma_f32_16x16x32_bf16 v[140:143], a[116:119], v[172:175], v[140:143]
    ds_write_b64 v4, v[152:153] offset:16384
    v_mfma_f32_16x16x32_bf16 v[144:147], a[120:123], v[232:235], 0
    v_fmac_f32 v122, v216, v216
    v_fmac_f32 v122, v217, v217
    v_mfma_f32_16x16x32_bf16 v[144:147], a[124:127], v[248:251], v[144:147]
    v_fmac_f32 v122, v218, v218
    v_fmac_f32 v122, v219, v219
    v_mfma_f32_16x16x32_bf16 v[144:147], a[128:131], v[160:163], v[144:147]
    v_fmac_f32 v122, v208, v208
    v_fmac_f32 v122, v209, v209
    v_mfma_f32_16x16x32_bf16 v[144:147], a[132:135], v[136:139], v[144:147]
    v_fmac_f32 v122, v210, v210
    v_fmac_f32 v122, v211, v211
    v_mfma_f32_16x16x32_bf16 v[144:147], a[136:139], v[116:119], v[144:147]
    v_cvt_pk_bf16_f32 v123, v122, v122
    v_fmac_f32 v121, v132, v132
    v_mfma_f32_16x16x32_bf16 v[144:147], a[140:143], v[172:175], v[144:147]
    v_fmac_f32 v121, v133, v133
    v_fmac_f32 v121, v134, v134
    v_mfma_f32_16x16x32_bf16 v[152:155], a[0:3], v[232:235], 0
    v_fmac_f32 v121, v135, v135
    v_fmac_f32 v121, v212, v212
    v_mfma_f32_16x16x32_bf16 v[152:155], a[4:7], v[248:251], v[152:155]
    v_fmac_f32 v121, v213, v213
    v_fmac_f32 v121, v214, v214
    v_mfma_f32_16x16x32_bf16 v[152:155], a[8:11], v[160:163], v[152:155]
    v_fmac_f32 v121, v215, v215
    v_cvt_pk_bf16_f32 v122, v120, v121
    v_mfma_f32_16x16x32_bf16 v[152:155], a[12:15], v[136:139], v[152:155]
    ds_write_b64 v4, v[122:123] offset:18432
    v_mfma_f32_16x16x32_bf16 v[152:155], a[16:19], v[116:119], v[152:155]
    v_add_u32 v7, s76, v7
    v_fma_f32 v164, v148, v148, s32
    v_mfma_f32_16x16x32_bf16 v[152:155], a[20:23], v[172:175], v[152:155]
    v_fmac_f32 v164, v149, v149
    v_fmac_f32 v164, v150, v150
    v_mfma_f32_16x16x32_bf16 v[156:159], a[24:27], v[232:235], 0
    v_fmac_f32 v164, v151, v151
    v_fmac_f32 v164, v140, v140
    v_mfma_f32_16x16x32_bf16 v[156:159], a[28:31], v[248:251], v[156:159]
    v_fmac_f32 v164, v141, v141
    v_fmac_f32 v164, v142, v142
    v_mfma_f32_16x16x32_bf16 v[156:159], a[32:35], v[160:163], v[156:159]
    v_fmac_f32 v164, v143, v143
    v_xor_b32 v2, 65536, v2
    v_mfma_f32_16x16x32_bf16 v[156:159], a[36:39], v[136:139], v[156:159]
    v_xor_b32 v3, 65536, v3
    v_xor_b32 v4, 65536, v4
    v_mfma_f32_16x16x32_bf16 v[156:159], a[40:43], v[116:119], v[156:159]
    s_waitcnt lgkmcnt(0)
    s_barrier
    s_nop 0
    s_nop 0
    s_nop 0
    v_mfma_f32_16x16x32_bf16 v[156:159], a[44:47], v[172:175], v[156:159]
    s_cbranch_scc1 L_loop_safe0
    s_branch L_final_safe
.p2align 6
L_loop_safe1:
    v_mfma_f32_16x16x32_bf16 v[124:127], a[48:51], v[232:235], 0
    s_add_u32 s12, s40, s27
    ds_read_b128 v[120:123], v2 offset:18432
    ds_read_b128 v[168:171], v2 offset:19456
    v_mfma_f32_16x16x32_bf16 v[124:127], a[52:55], v[248:251], v[124:127]
    s_addc_u32 s13, s41, 0
    v_fmac_f32 v164, v144, v144
    v_fmac_f32 v164, v145, v145
    v_mfma_f32_16x16x32_bf16 v[124:127], a[56:59], v[160:163], v[124:127]
    s_sub_u32 s14, s36, s27
    v_fmac_f32 v164, v146, v146
    v_fmac_f32 v164, v147, v147
    v_mfma_f32_16x16x32_bf16 v[124:127], a[60:63], v[136:139], v[124:127]
    s_cmp_ge_u32 s18, 2
    v_fma_f32 v165, v152, v152, s32
    v_fmac_f32 v165, v153, v153
    v_mfma_f32_16x16x32_bf16 v[124:127], a[64:67], v[116:119], v[124:127]
    s_cselect_b32 s14, s14, 0
    v_fmac_f32 v165, v154, v154
    v_fmac_f32 v165, v155, v155
    v_mfma_f32_16x16x32_bf16 v[124:127], a[68:71], v[172:175], v[124:127]
    s_sub_u32 s82, s72, s71
    v_fmac_f32 v165, v156, v156
    v_fmac_f32 v165, v157, v157
    v_mfma_f32_16x16x32_bf16 v[180:183], v[232:235], a[144:147], 0
    s_mul_i32 s74, s82, 336
    v_fmac_f32 v165, v158, v158
    v_fmac_f32 v165, v159, v159
    v_mfma_f32_16x16x32_bf16 v[180:183], v[248:251], a[148:151], v[180:183]
    s_mul_i32 s75, s82, 272
    v_fmac_f32 v165, v124, v124
    v_fmac_f32 v165, v125, v125
    v_mfma_f32_16x16x32_bf16 v[180:183], v[160:163], a[152:155], v[180:183]
    s_waitcnt lgkmcnt(0)
    v_fmac_f32 v165, v126, v126
    v_fmac_f32 v165, v127, v127
    v_mfma_f32_16x16x32_bf16 v[184:187], v[32:35], v[120:123], 0
    s_mul_i32 s76, s82, 16
    v_cvt_pk_bf16_f32 v36, v165, v164
    s_add_u32 s34, s18, 2
    v_mfma_f32_16x16x32_bf16 v[184:187], v[32:35], v[168:171], v[184:187]
    s_add_u32 s8, s60, s23
    s_addc_u32 s9, s61, 0
    s_sub_u32 s10, s36, s23
    v_mfma_f32_16x16x32_bf16 v[168:171], v[32:35], v[36:39], 0
    s_cmp_le_u32 s34, s45
    s_cselect_b32 s10, s10, 0
    s_add_u32 m0, s28, 0
    v_mfma_f32_16x16x32_bf16 v[180:183], v[136:139], a[156:159], v[180:183]
    s_mov_b32 s27, s26
    v_mul_f32 v166, 0x3baaaaab, v184
    v_mul_f32 v184, 0x3baaaaab, v185
    v_mfma_f32_16x16x32_bf16 v[180:183], v[116:119], a[160:163], v[180:183]
    s_mov_b32 s26, s25
    v_rsq_f32 v169, v169
    v_mfma_f32_16x16x32_bf16 v[180:183], v[172:175], a[164:167], v[180:183]
    s_mov_b32 s25, s24
    v_rsq_f32 v168, v168
    v_mfma_f32_16x16x32_bf16 v[120:123], v[232:235], a[168:171], 0
    s_mov_b32 s24, s23
    v_mul_f32 v168, s31, v168
    v_mul_f32 v148, v169, v148
    v_mfma_f32_16x16x32_bf16 v[120:123], v[248:251], a[172:175], v[120:123]
    s_ff1_i32_b32 s80, s100
    v_cvt_pk_bf16_f32 v164, v180, v181
    v_cvt_pk_bf16_f32 v165, v182, v183
    v_mfma_f32_16x16x32_bf16 v[120:123], v[160:163], a[176:179], v[120:123]
    s_mov_b32 s71, s72
    ds_read_b128 v[180:183], v0 offset:26624
    v_mul_f32 v149, v169, v149
    v_mfma_f32_16x16x32_bf16 v[120:123], v[136:139], a[180:183], v[120:123]
    s_mov_b32 s72, s73
    ds_read_b128 v[192:195], v1 offset:26624
    v_cvt_pk_f16_f32 v148, v148, v149
    v_mfma_f32_16x16x32_bf16 v[120:123], v[116:119], a[184:187], v[120:123]
    ds_read_b128 v[204:207], v0 offset:26752
    v_mul_f32 v150, v169, v150
    v_mfma_f32_16x16x32_bf16 v[120:123], v[172:175], a[188:191], v[120:123]
    ds_read_b128 v[220:223], v1 offset:26752
    v_mul_f32 v151, v169, v151
    v_cvt_pk_f16_f32 v149, v150, v151
    v_mul_f32 v140, v169, v140
    v_mul_f32 v141, v169, v141
    v_cvt_pk_f16_f32 v150, v140, v141
    v_mfma_f32_16x16x32_bf16 v[224:227], v[232:235], a[192:195], 0
    ds_read_b128 v[228:231], v0 offset:26880
    v_cvt_pk_bf16_f32 v140, v120, v121
    v_mfma_f32_16x16x32_bf16 v[224:227], v[248:251], a[196:199], v[224:227]
    ds_read_b128 v[232:235], v1 offset:26880
    v_cvt_pk_bf16_f32 v141, v122, v123
    v_mfma_f32_16x16x32_bf16 v[224:227], v[160:163], a[200:203], v[224:227]
    v_mul_f32 v142, v169, v142
    v_mul_f32 v143, v169, v143
    v_mfma_f32_16x16x32_bf16 v[224:227], v[136:139], a[204:207], v[224:227]
    s_waitcnt lgkmcnt(5)
    v_cvt_pk_f16_f32 v151, v142, v143
    v_mul_f32 v144, v169, v144
    v_mfma_f32_16x16x32_bf16 v[224:227], v[116:119], a[208:211], v[224:227]
    s_waitcnt lgkmcnt(4)
    v_mul_f32 v145, v169, v145
    v_cvt_pk_f16_f32 v122, v144, v145
    v_mfma_f32_16x16x32_bf16 v[224:227], v[172:175], a[212:215], v[224:227]
    s_waitcnt lgkmcnt(3)
    v_mul_f32 v146, v169, v146
    v_mul_f32 v147, v169, v147
    v_mfma_f32_16x16x32_bf16 v[116:119], a[72:75], v[180:183], 0
    s_waitcnt lgkmcnt(2)
    v_cvt_pk_f16_f32 v123, v146, v147
    v_mul_f32 v152, v168, v152
    v_mfma_f32_16x16x32_bf16 v[116:119], a[76:79], v[192:195], v[116:119]
    v_cvt_pk_bf16_f32 v144, v224, v225
    v_cvt_pk_bf16_f32 v145, v226, v227
    v_mfma_f32_16x16x32_bf16 v[116:119], a[80:83], v[204:207], v[116:119]
    s_waitcnt lgkmcnt(1)
    v_mul_f32 v153, v168, v153
    v_cvt_pk_f16_f32 v244, v152, v153
    v_mfma_f32_16x16x32_bf16 v[116:119], a[84:87], v[220:223], v[116:119]
    s_waitcnt lgkmcnt(0)
    v_mul_f32 v154, v168, v154
    v_mul_f32 v155, v168, v155
    v_mfma_f32_16x16x32_bf16 v[116:119], a[88:91], v[228:231], v[116:119]
    v_cvt_pk_f16_f32 v245, v154, v155
    v_mul_f32 v156, v168, v156
    v_mfma_f32_16x16x32_bf16 v[116:119], a[92:95], v[232:235], v[116:119]
    v_mul_f32 v157, v168, v157
    v_cvt_pk_f16_f32 v246, v156, v157
    v_mfma_f32_16x16x32_bf16 v[136:139], a[96:99], v[180:183], 0
    v_mul_f32 v158, v168, v158
    v_mul_f32 v159, v168, v159
    v_mfma_f32_16x16x32_bf16 v[136:139], a[100:103], v[192:195], v[136:139]
    v_cvt_pk_f16_f32 v247, v158, v159
    v_mul_f32 v124, v168, v124
    v_mfma_f32_16x16x32_bf16 v[136:139], a[104:107], v[204:207], v[136:139]
    v_mul_f32 v125, v168, v125
    v_cvt_pk_f16_f32 v120, v124, v125
    v_mfma_f32_16x16x32_bf16 v[136:139], a[108:111], v[220:223], v[136:139]
    v_mul_f32 v126, v168, v126
    v_mul_f32 v127, v168, v127
    v_mfma_f32_16x16x32_bf16 v[136:139], a[112:115], v[228:231], v[136:139]
    v_cvt_pk_f16_f32 v121, v126, v127
    v_fma_f32 v167, v116, v116, s32
    v_mfma_f32_16x16x32_bf16 v[136:139], a[116:119], v[232:235], v[136:139]
    v_fmac_f32 v167, v117, v117
    v_fmac_f32 v167, v118, v118
    v_mfma_f32_16x16x32_bf16 v[152:155], a[120:123], v[180:183], 0
    v_fmac_f32 v167, v119, v119
    v_mul_f32 v142, 0x3baaaaab, v186
    v_mfma_f32_16x16x32_bf16 v[152:155], a[124:127], v[192:195], v[152:155]
    v_rsq_f32 v166, v166
    v_mfma_f32_16x16x32_bf16 v[152:155], a[128:131], v[204:207], v[152:155]
    v_fmac_f32 v167, v136, v136
    v_fmac_f32 v167, v137, v137
    v_mfma_f32_16x16x32_bf16 v[152:155], a[132:135], v[220:223], v[152:155]
    v_fmac_f32 v167, v138, v138
    v_fmac_f32 v167, v139, v139
    v_mfma_f32_16x16x32_bf16 v[152:155], a[136:139], v[228:231], v[152:155]
    v_rsq_f32 v184, v184
    v_mfma_f32_16x16x32_bf16 v[152:155], a[140:143], v[232:235], v[152:155]
    v_rsq_f32 v142, v142
    v_mfma_f32_16x16x32_bf16 v[156:159], a[0:3], v[180:183], 0
    v_mul_f32 v128, v166, v128
    v_mul_f32 v129, v166, v129
    v_mfma_f32_16x16x32_bf16 v[156:159], a[4:7], v[192:195], v[156:159]
    v_cvt_pk_bf16_f32 v124, v128, v129
    v_mul_f32 v130, v166, v130
    v_mfma_f32_16x16x32_bf16 v[156:159], a[8:11], v[204:207], v[156:159]
    v_fmac_f32 v167, v152, v152
    v_fmac_f32 v167, v153, v153
    v_mfma_f32_16x16x32_bf16 v[156:159], a[12:15], v[220:223], v[156:159]
    v_fmac_f32 v167, v154, v154
    v_fmac_f32 v167, v155, v155
    v_mfma_f32_16x16x32_bf16 v[156:159], a[16:19], v[228:231], v[156:159]
    v_mul_f32 v131, v166, v131
    v_cvt_pk_bf16_f32 v125, v130, v131
    v_mfma_f32_16x16x32_bf16 v[156:159], a[20:23], v[232:235], v[156:159]
    v_mul_f32 v188, v166, v188
    v_mul_f32 v189, v166, v189
    v_mfma_f32_16x16x32_bf16 v[168:171], a[24:27], v[180:183], 0
    v_cvt_pk_bf16_f32 v126, v188, v189
    v_mul_f32 v190, v166, v190
    v_mfma_f32_16x16x32_bf16 v[168:171], a[28:31], v[192:195], v[168:171]
    v_mul_f32 v191, v166, v191
    v_cvt_pk_bf16_f32 v127, v190, v191
    v_mfma_f32_16x16x32_bf16 v[168:171], a[32:35], v[204:207], v[168:171]
    buffer_store_dwordx4 v[124:127], v15, s[12:15], 0 offen nt
    v_fma_f32 v143, v156, v156, s32
    v_fmac_f32 v143, v157, v157
    v_fmac_f32 v143, v158, v158
    v_fmac_f32 v143, v159, v159
    v_mfma_f32_16x16x32_bf16 v[168:171], a[36:39], v[220:223], v[168:171]
    v_mul_f32 v176, v166, v176
    v_mul_f32 v177, v166, v177
    v_mfma_f32_16x16x32_bf16 v[168:171], a[40:43], v[228:231], v[168:171]
    v_cvt_pk_bf16_f32 v146, v176, v177
    v_mul_f32 v178, v166, v178
    v_mfma_f32_16x16x32_bf16 v[168:171], a[44:47], v[232:235], v[168:171]
    v_mul_f32 v179, v166, v179
    v_cvt_pk_bf16_f32 v147, v178, v179
    v_mfma_f32_16x16x32_bf16 v[172:175], a[48:51], v[180:183], 0
    v_mul_f32 v200, v142, v200
    v_mul_f32 v201, v142, v201
    v_mfma_f32_16x16x32_bf16 v[172:175], a[52:55], v[192:195], v[172:175]
    v_cvt_pk_bf16_f32 v124, v200, v201
    v_mul_f32 v202, v142, v202
    v_mfma_f32_16x16x32_bf16 v[172:175], a[56:59], v[204:207], v[172:175]
    v_fmac_f32 v143, v168, v168
    v_fmac_f32 v143, v169, v169
    v_mfma_f32_16x16x32_bf16 v[172:175], a[60:63], v[220:223], v[172:175]
    v_fmac_f32 v143, v170, v170
    v_fmac_f32 v143, v171, v171
    v_mfma_f32_16x16x32_bf16 v[172:175], a[64:67], v[228:231], v[172:175]
    v_mul_f32 v203, v142, v203
    v_cvt_pk_bf16_f32 v125, v202, v203
    v_mfma_f32_16x16x32_bf16 v[172:175], a[68:71], v[232:235], v[172:175]
    v_mul_f32 v216, v142, v216
    v_mul_f32 v217, v142, v217
    v_mfma_f32_16x16x32_bf16 v[128:131], v[180:183], a[144:147], 0
    v_cvt_pk_bf16_f32 v126, v216, v217
    v_mul_f32 v218, v142, v218
    v_mfma_f32_16x16x32_bf16 v[128:131], v[192:195], a[148:151], v[128:131]
    v_mul_f32 v219, v142, v219
    v_cvt_pk_bf16_f32 v127, v218, v219
    v_mfma_f32_16x16x32_bf16 v[128:131], v[204:207], a[152:155], v[128:131]
    v_fmac_f32 v143, v172, v172
    v_fmac_f32 v143, v173, v173
    v_mfma_f32_16x16x32_bf16 v[128:131], v[220:223], a[156:159], v[128:131]
    v_fmac_f32 v143, v174, v174
    v_fmac_f32 v143, v175, v175
    v_mfma_f32_16x16x32_bf16 v[128:131], v[228:231], a[160:163], v[128:131]
    v_cvt_pk_bf16_f32 v36, v143, v167
    v_mul_f32 v208, v142, v208
    v_mfma_f32_16x16x32_bf16 v[128:131], v[232:235], a[164:167], v[128:131]
    v_mul_f32 v209, v142, v209
    v_cvt_pk_bf16_f32 v186, v208, v209
    v_mfma_f32_16x16x32_bf16 v[176:179], v[32:35], v[36:39], 0
    v_mul_f32 v210, v142, v210
    v_mul_f32 v211, v142, v211
    v_mfma_f32_16x16x32_bf16 v[160:163], v[180:183], a[168:171], 0
    buffer_store_dwordx2 v[146:147], v18, s[12:15], 0 offen nt
    v_cvt_pk_bf16_f32 v187, v210, v211
    v_cvt_pk_bf16_f32 v166, v128, v129
    v_mfma_f32_16x16x32_bf16 v[160:163], v[192:195], a[172:175], v[160:163]
    v_cvt_pk_bf16_f32 v167, v130, v131
    v_mul_f32 v196, v184, v196
    v_mfma_f32_16x16x32_bf16 v[160:163], v[204:207], a[176:179], v[160:163]
    ds_read_b128 v[200:203], v0 offset:32768
    v_mul_f32 v197, v184, v197
    v_mfma_f32_16x16x32_bf16 v[160:163], v[220:223], a[180:183], v[160:163]
    ds_read_b128 v[208:211], v1 offset:32768
    v_cvt_pk_bf16_f32 v128, v196, v197
    v_mfma_f32_16x16x32_bf16 v[160:163], v[228:231], a[184:187], v[160:163]
    ds_read_b128 v[216:219], v0 offset:32896
    v_mul_f32 v198, v184, v198
    v_mfma_f32_16x16x32_bf16 v[160:163], v[232:235], a[188:191], v[160:163]
    ds_read_b128 v[224:227], v1 offset:32896
    v_mul_f32 v199, v184, v199
    v_mfma_f32_16x16x32_bf16 v[188:191], v[180:183], a[192:195], 0
    ds_read_b128 v[180:183], v0 offset:33024
    v_cvt_pk_bf16_f32 v129, v198, v199
    v_mfma_f32_16x16x32_bf16 v[188:191], v[192:195], a[196:199], v[188:191]
    ds_read_b128 v[192:195], v1 offset:33024
    v_mul_f32 v132, v184, v132
    v_mfma_f32_16x16x32_bf16 v[188:191], v[204:207], a[200:203], v[188:191]
    v_rsq_f32 v177, v177
    v_mfma_f32_16x16x32_bf16 v[188:191], v[220:223], a[204:207], v[188:191]
    v_rsq_f32 v176, v176
    v_mfma_f32_16x16x32_bf16 v[188:191], v[228:231], a[208:211], v[188:191]
    s_waitcnt lgkmcnt(5)
    v_mul_f32 v176, s31, v176
    v_cvt_pk_bf16_f32 v142, v160, v161
    v_mfma_f32_16x16x32_bf16 v[188:191], v[232:235], a[212:215], v[188:191]
    s_waitcnt lgkmcnt(4)
    v_cvt_pk_bf16_f32 v143, v162, v163
    v_mul_f32 v116, v177, v116
    v_mfma_f32_16x16x32_bf16 v[196:199], a[72:75], v[200:203], 0
    s_waitcnt lgkmcnt(3)
    v_mul_f32 v117, v177, v117
    v_cvt_pk_f16_f32 v116, v116, v117
    v_mfma_f32_16x16x32_bf16 v[196:199], a[76:79], v[208:211], v[196:199]
    s_waitcnt lgkmcnt(2)
    v_cvt_pk_bf16_f32 v146, v188, v189
    v_cvt_pk_bf16_f32 v147, v190, v191
    v_mfma_f32_16x16x32_bf16 v[196:199], a[80:83], v[216:219], v[196:199]
    s_waitcnt lgkmcnt(1)
    v_mul_f32 v118, v177, v118
    v_mul_f32 v119, v177, v119
    v_mfma_f32_16x16x32_bf16 v[196:199], a[84:87], v[224:227], v[196:199]
    s_waitcnt lgkmcnt(0)
    v_cvt_pk_f16_f32 v117, v118, v119
    v_mul_f32 v136, v177, v136
    v_mfma_f32_16x16x32_bf16 v[196:199], a[88:91], v[180:183], v[196:199]
    v_mul_f32 v137, v177, v137
    v_cvt_pk_f16_f32 v118, v136, v137
    v_mfma_f32_16x16x32_bf16 v[196:199], a[92:95], v[192:195], v[196:199]
    buffer_store_dwordx4 v[124:127], v17, s[12:15], 0 offen nt
    v_mul_f32 v138, v177, v138
    v_mul_f32 v139, v177, v139
    v_cvt_pk_f16_f32 v119, v138, v139
    v_mul_f32 v152, v177, v152
    v_mfma_f32_16x16x32_bf16 v[136:139], a[96:99], v[200:203], 0
    v_mul_f32 v153, v177, v153
    v_cvt_pk_f16_f32 v126, v152, v153
    v_mfma_f32_16x16x32_bf16 v[136:139], a[100:103], v[208:211], v[136:139]
    v_mul_f32 v154, v177, v154
    v_mul_f32 v155, v177, v155
    v_mfma_f32_16x16x32_bf16 v[136:139], a[104:107], v[216:219], v[136:139]
    v_cvt_pk_f16_f32 v127, v154, v155
    v_mul_f32 v156, v176, v156
    v_mfma_f32_16x16x32_bf16 v[136:139], a[108:111], v[224:227], v[136:139]
    v_mul_f32 v157, v176, v157
    v_cvt_pk_f16_f32 v160, v156, v157
    v_mfma_f32_16x16x32_bf16 v[136:139], a[112:115], v[180:183], v[136:139]
    s_waitcnt vmcnt(3)
    ds_write_b16 v8, v46 offset:512
    v_mfma_f32_16x16x32_bf16 v[136:139], a[116:119], v[192:195], v[136:139]
    s_nop 0
    v_mul_f32 v158, v176, v158
    v_mfma_f32_16x16x32_bf16 v[204:207], a[120:123], v[200:203], 0
    v_mul_f32 v159, v176, v159
    v_cvt_pk_f16_f32 v161, v158, v159
    v_mfma_f32_16x16x32_bf16 v[204:207], a[124:127], v[208:211], v[204:207]
    v_mul_f32 v168, v176, v168
    v_mul_f32 v169, v176, v169
    v_mfma_f32_16x16x32_bf16 v[204:207], a[128:131], v[216:219], v[204:207]
    v_cvt_pk_f16_f32 v162, v168, v169
    v_mul_f32 v170, v176, v170
    v_mfma_f32_16x16x32_bf16 v[204:207], a[132:135], v[224:227], v[204:207]
    v_mul_f32 v171, v176, v171
    v_cvt_pk_f16_f32 v163, v170, v171
    v_mfma_f32_16x16x32_bf16 v[204:207], a[136:139], v[180:183], v[204:207]
    v_mul_f32 v172, v176, v172
    v_mul_f32 v173, v176, v173
    v_mfma_f32_16x16x32_bf16 v[204:207], a[140:143], v[192:195], v[204:207]
    v_cvt_pk_f16_f32 v124, v172, v173
    v_mul_f32 v174, v176, v174
    v_mfma_f32_16x16x32_bf16 v[236:239], a[0:3], v[200:203], 0
    s_waitcnt lgkmcnt(0)
    v_mul_f32 v175, v176, v175
    v_cvt_pk_f16_f32 v125, v174, v175
    v_mfma_f32_16x16x32_bf16 v[236:239], a[4:7], v[208:211], v[236:239]
    s_nop 0
    v_fma_f32 v185, v196, v196, s32
    v_fmac_f32 v185, v197, v197
    v_mfma_f32_16x16x32_bf16 v[236:239], a[8:11], v[216:219], v[236:239]
    s_barrier
    v_fmac_f32 v185, v198, v198
    v_fmac_f32 v185, v199, v199
    v_mfma_f32_16x16x32_bf16 v[236:239], a[12:15], v[224:227], v[236:239]
    s_nop 0
    v_fmac_f32 v185, v136, v136
    v_fmac_f32 v185, v137, v137
    v_mfma_f32_16x16x32_bf16 v[236:239], a[16:19], v[180:183], v[236:239]
    s_nop 0
    buffer_load_dwordx4 v10, s[8:11], 0 offen nt lds
    ds_read_u16 v131, v9 offset:384
    v_mfma_f32_16x16x32_bf16 v[236:239], a[20:23], v[192:195], v[236:239]
    s_add_u32 m0, s28, 4096
    v_fmac_f32 v185, v138, v138
    v_fmac_f32 v185, v139, v139
    v_mfma_f32_16x16x32_bf16 v[176:179], a[24:27], v[200:203], 0
    v_fmac_f32 v185, v204, v204
    v_fmac_f32 v185, v205, v205
    v_mfma_f32_16x16x32_bf16 v[176:179], a[28:31], v[208:211], v[176:179]
    v_fmac_f32 v185, v206, v206
    v_fma_f32 v152, v236, v236, s32
    v_mfma_f32_16x16x32_bf16 v[176:179], a[32:35], v[216:219], v[176:179]
    v_fmac_f32 v152, v237, v237
    v_fmac_f32 v152, v238, v238
    v_mfma_f32_16x16x32_bf16 v[176:179], a[36:39], v[224:227], v[176:179]
    buffer_load_dwordx4 v11, s[8:11], 0 offen nt lds
    v_fmac_f32 v152, v239, v239
    v_mfma_f32_16x16x32_bf16 v[176:179], a[40:43], v[180:183], v[176:179]
    s_add_u32 m0, s28, 8192
    v_fmac_f32 v185, v207, v207
    v_mul_f32 v133, v184, v133
    v_mfma_f32_16x16x32_bf16 v[176:179], a[44:47], v[192:195], v[176:179]
    v_cvt_pk_bf16_f32 v130, v132, v133
    v_mul_f32 v134, v184, v134
    v_mfma_f32_16x16x32_bf16 v[188:191], a[48:51], v[200:203], 0
    s_waitcnt lgkmcnt(0)
    v_readfirstlane_b32 s77, v131
    v_mul_f32 v135, v184, v135
    v_mfma_f32_16x16x32_bf16 v[188:191], a[52:55], v[208:211], v[188:191]
    v_cvt_pk_bf16_f32 v131, v134, v135
    v_fmac_f32 v152, v176, v176
    v_mfma_f32_16x16x32_bf16 v[188:191], a[56:59], v[216:219], v[188:191]
    buffer_load_dwordx4 v12, s[8:11], 0 offen nt lds
    v_fmac_f32 v152, v177, v177
    v_mfma_f32_16x16x32_bf16 v[188:191], a[60:63], v[224:227], v[188:191]
    s_add_u32 m0, s28, 12288
    v_fmac_f32 v152, v178, v178
    v_fmac_f32 v152, v179, v179
    v_mfma_f32_16x16x32_bf16 v[188:191], a[64:67], v[180:183], v[188:191]
    s_xor_b32 s28, s28, 65536
    ds_read2_b32 v[154:155], v6 offset0:0 offset1:0
    ds_read2_b32 v[158:159], v6 offset0:16 offset1:16
    v_mfma_f32_16x16x32_bf16 v[188:191], a[68:71], v[192:195], v[188:191]
    ds_read2_b32 v[170:171], v6 offset0:32 offset1:32
    v_mul_f32 v212, v184, v212
    v_mfma_f32_16x16x32_bf16 v[132:135], v[200:203], a[144:147], 0
    v_mul_f32 v213, v184, v213
    v_cvt_pk_bf16_f32 v240, v212, v213
    v_mfma_f32_16x16x32_bf16 v[132:135], v[208:211], a[148:151], v[132:135]
    buffer_load_dwordx4 v13, s[8:11], 0 offen nt lds
    v_mul_f32 v214, v184, v214
    v_mfma_f32_16x16x32_bf16 v[132:135], v[216:219], a[152:155], v[132:135]
    s_mov_b32 m0, s29
    v_fmac_f32 v152, v188, v188
    v_fmac_f32 v152, v189, v189
    v_mfma_f32_16x16x32_bf16 v[132:135], v[224:227], a[156:159], v[132:135]
    s_xor_b32 s29, s29, s30
    v_fmac_f32 v152, v190, v190
    v_fmac_f32 v152, v191, v191
    v_mfma_f32_16x16x32_bf16 v[132:135], v[180:183], a[160:163], v[132:135]
    s_add_u32 s19, s19, s20
    v_cvt_pk_bf16_f32 v36, v152, v185
    v_mul_f32 v215, v184, v215
    v_mfma_f32_16x16x32_bf16 v[132:135], v[192:195], a[164:167], v[132:135]
    s_add_u32 s23, s23, s21
    v_cvt_pk_bf16_f32 v241, v214, v215
    v_xor_b32 v0, 65536, v0
    v_mfma_f32_16x16x32_bf16 v[232:235], v[32:35], v[36:39], 0
    s_cmp_ge_u32 s19, 72
    buffer_load_dwordx4 v14, s[8:11], 0 offen nt lds
    v_xor_b32 v1, 65536, v1
    v_mfma_f32_16x16x32_bf16 v[212:215], v[200:203], a[168:171], 0
    s_cselect_b32 s34, 72, 0
    v_cvt_pk_bf16_f32 v152, v132, v133
    v_cvt_pk_bf16_f32 v153, v134, v135
    v_mfma_f32_16x16x32_bf16 v[212:215], v[208:211], a[172:175], v[212:215]
    s_cselect_b32 s35, s22, 0
    v_rsq_f32 v233, v233
    v_mfma_f32_16x16x32_bf16 v[212:215], v[216:219], a[176:179], v[212:215]
    s_sub_u32 s19, s19, s34
    v_rsq_f32 v232, v232
    v_mfma_f32_16x16x32_bf16 v[212:215], v[224:227], a[180:183], v[212:215]
    s_add_u32 s23, s23, s35
    v_mul_f32 v232, s31, v232
    v_mul_f32 v196, v233, v196
    v_mfma_f32_16x16x32_bf16 v[212:215], v[180:183], a[184:187], v[212:215]
    s_cmp_lg_u32 s83, 0
    buffer_store_dwordx2 v[186:187], v20, s[12:15], 0 offen nt
    v_mul_f32 v197, v233, v197
    v_cvt_pk_f16_f32 v172, v196, v197
    v_mfma_f32_16x16x32_bf16 v[212:215], v[192:195], a[188:191], v[212:215]
    s_cselect_b32 s77, s80, s77
    v_mul_f32 v198, v233, v198
    v_mul_f32 v199, v233, v199
    v_mfma_f32_16x16x32_bf16 v[248:251], v[200:203], a[192:195], 0
    s_mul_i32 s78, s77, 2688
    v_cvt_pk_f16_f32 v173, v198, v199
    v_mul_f32 v136, v233, v136
    v_mfma_f32_16x16x32_bf16 v[248:251], v[208:211], a[196:199], v[248:251]
    s_add_u32 s78, s78, s69
    v_cvt_pk_bf16_f32 v156, v212, v213
    v_cvt_pk_bf16_f32 v157, v214, v215
    v_mfma_f32_16x16x32_bf16 v[248:251], v[216:219], a[200:203], v[248:251]
    s_add_u32 s80, s77, s68
    ds_read_b128 v[228:231], v5 offset:0
    ds_read_b128 v[220:223], v5 offset:16
    v_mfma_f32_16x16x32_bf16 v[248:251], v[224:227], a[204:207], v[248:251]
    s_cmp_ge_u32 s80, 72
    ds_read_b128 v[224:227], v5 offset:48
    ds_read_b32 v242, v6 offset:192
    v_mfma_f32_16x16x32_bf16 v[248:251], v[180:183], a[208:211], v[248:251]
    s_cselect_b32 s80, s22, 0
    v_mul_f32 v137, v233, v137
    v_cvt_pk_f16_f32 v174, v136, v137
    v_mfma_f32_16x16x32_bf16 v[248:251], v[192:195], a[212:215], v[248:251]
    s_add_u32 s78, s78, s80
    ds_read_b128 v[192:195], v2 offset:0
    ds_read_b128 v[184:187], v2 offset:1024
    v_mfma_f32_16x16x32_f16 v[216:219], v[148:151], v[244:247], v[48:51]
    s_add_u32 s80, s77, 20
    ds_read_b128 v[132:135], v2 offset:2048
    v_mul_f32 v138, v233, v138
    v_mfma_f32_16x16x32_f16 v[212:215], v[116:119], v[244:247], v[52:55]
    s_add_u32 s34, s18, 3
    v_cvt_pk_bf16_f32 v168, v248, v249
    v_cvt_pk_bf16_f32 v169, v250, v251
    v_mul_f32 v139, v233, v139
    v_mfma_f32_16x16x16_f16 v[216:219], v[122:123], v[120:121], v[216:219]
    v_cvt_pk_f16_f32 v175, v138, v139
    v_mul_f32 v204, v233, v204
    v_mul_f32 v205, v233, v205
    v_mfma_f32_16x16x16_f16 v[212:215], v[126:127], v[120:121], v[212:215]
    v_cvt_pk_f16_f32 v138, v204, v205
    v_mul_f32 v206, v233, v206
    v_mul_f32 v207, v233, v207
    v_cvt_pk_f16_f32 v139, v206, v207
    v_mfma_f32_16x16x32_f16 v[208:211], v[172:175], v[244:247], v[56:59]
    s_cmp_lt_u32 s77, s62
    v_mul_f32 v236, v232, v236
    v_mul_f32 v237, v232, v237
    v_cvt_pk_f16_f32 v180, v236, v237
    v_mul_f32 v238, v232, v238
    v_mul_f32 v239, v232, v239
    v_mfma_f32_16x16x16_f16 v[208:211], v[138:139], v[120:121], v[208:211]
    v_cvt_pk_f16_f32 v181, v238, v239
    v_mul_f32 v176, v232, v176
    v_mul_f32 v177, v232, v177
    s_waitcnt lgkmcnt(1)
    v_mfma_f32_16x16x32_f16 v[236:239], v[228:231], v[244:247], v[22:25]
    s_cselect_b32 s79, 1, 0
    ds_read_b128 v[196:199], v2 offset:3072
    v_cvt_pk_f16_f32 v182, v176, v177
    v_mfma_f32_16x16x32_f16 v[236:239], v[220:223], v[148:151], v[236:239]
    s_cselect_b32 s78, s78, 0
    v_mul_f32 v178, v232, v178
    v_mul_f32 v179, v232, v179
    v_mfma_f32_16x16x32_f16 v[236:239], v[224:227], v[120:123], v[236:239]
    s_cmp_lt_u32 s34, s17
    ds_read_b128 v[204:207], v2 offset:4096
    buffer_store_dwordx4 v[128:131], v16, s[12:15], 0 offen nt
    ds_read_b128 v[200:203], v2 offset:5120
    v_cvt_pk_f16_f32 v183, v178, v179
    v_mul_f32 v188, v232, v188
    v_mul_f32 v189, v232, v189
    v_cvt_pk_f16_f32 v136, v188, v189
    v_mul_f32 v190, v232, v190
    v_mul_f32 v191, v232, v191
    v_mfma_f32_16x16x32_f16 v[232:235], v[228:231], v[160:163], v[24:27]
    s_cselect_b32 s23, s23, s78
    v_cvt_pk_f16_f32 v137, v190, v191
    v_mov_b32_dpp v242, v237 quad_perm:[0,1,2,3] row_mask:0x1 bank_mask:0xf
    v_mfma_f32_16x16x32_f16 v[232:235], v[220:223], v[116:119], v[232:235]
    s_cselect_b32 s73, s34, s80
    v_max3_f32 v243, v236, v216, v217
    v_max3_f32 v243, v243, v218, v219
    v_mfma_f32_16x16x32_f16 v[232:235], v[224:227], v[124:127], v[232:235]
    s_cselect_b32 s79, 0, s79
    v_max3_f32 v243, v243, v212, v213
    v_max3_f32 v243, v243, v214, v215
    v_max3_f32 v243, v243, v208, v209
    v_max3_f32 v243, v243, v210, v211
    v_mov_b32 v120, v243
    v_add_u32 v5, s74, v5
    v_add_u32 v6, s75, v6
    v_mov_b32_dpp v242, v233 quad_perm:[0,1,2,3] row_mask:0x2 bank_mask:0xf
    v_permlane32_swap_b32 v243, v120
    v_max_f32 v243, v243, v120
    v_mfma_f32_16x16x32_f16 v[244:247], v[228:231], v[180:183], v[26:29]
    s_cselect_b32 s81, 0, 1
    v_mov_b32 v120, v243
    s_add_u32 s80, s77, 1
    v_mfma_f32_16x16x32_f16 v[244:247], v[220:223], v[172:175], v[244:247]
    s_mul_i32 s80, s80, s81
    v_permlane16_swap_b32 v243, v120
    v_mfma_f32_16x16x32_f16 v[244:247], v[224:227], v[136:139], v[244:247]
    s_cmp_lt_u32 s80, s62
    v_max_f32 v243, v243, v120
    v_sub_f32 v216, v216, v243
    v_mfma_f32_16x16x32_bf16 v[128:131], a[216:219], v[192:195], 0
    s_cselect_b32 s70, s70, 0
    v_exp_f32 v216, v216
    v_mfma_f32_16x16x32_bf16 v[128:131], a[220:223], v[184:187], v[128:131]
    s_waitcnt lgkmcnt(0)
    v_sub_f32 v217, v217, v243
    v_sub_f32 v218, v218, v243
    v_mfma_f32_16x16x32_bf16 v[128:131], a[224:227], v[132:135], v[128:131]
    s_cselect_b32 s62, s62, 0
    v_exp_f32 v217, v217
    v_mfma_f32_16x16x32_bf16 v[128:131], a[228:231], v[196:199], v[128:131]
    s_add_u32 s80, s18, 4
    v_cvt_pk_bf16_f32 v216, v216, v217
    v_sub_f32 v219, v219, v243
    v_mfma_f32_16x16x32_bf16 v[128:131], a[232:235], v[204:207], v[128:131]
    s_cmp_ge_u32 s80, s17
    v_exp_f32 v218, v218
    v_mfma_f32_16x16x32_bf16 v[128:131], a[236:239], v[200:203], v[128:131]
    s_cselect_b32 s66, s70, 0
    v_exp_f32 v219, v219
    v_mfma_f32_16x16x32_bf16 v[188:191], a[240:243], v[192:195], 0
    s_lshl_b32 s80, s79, s73
    v_cvt_pk_bf16_f32 v217, v218, v219
    v_sub_f32 v212, v212, v243
    v_mfma_f32_16x16x32_bf16 v[188:191], a[244:247], v[184:187], v[188:191]
    s_or_b32 s63, s63, s80
    s_nop 0
    buffer_store_dwordx2 v[240:241], v19, s[12:15], 0 offen nt
    v_exp_f32 v212, v212
    v_mfma_f32_16x16x32_f16 v[220:223], v[148:151], v[160:163], v[60:63]
    s_sub_u32 s80, s100, s81
    v_sub_f32 v213, v213, v243
    v_sub_f32 v214, v214, v243
    v_mfma_f32_16x16x32_bf16 v[188:191], a[248:251], v[132:135], v[188:191]
    s_and_b32 s100, s100, s80
    v_exp_f32 v213, v213
    v_sub_f32 v215, v215, v243
    v_mfma_f32_16x16x16_f16 v[220:223], v[122:123], v[124:125], v[220:223]
    v_cvt_pk_bf16_f32 v218, v212, v213
    v_exp_f32 v214, v214
    v_sub_f32 v208, v208, v243
    v_mfma_f32_16x16x32_f16 v[224:227], v[116:119], v[160:163], v[64:67]
    s_add_u32 s45, s45, s79
    v_exp_f32 v215, v215
    v_mfma_f32_16x16x32_bf16 v[188:191], a[252:255], v[196:199], v[188:191]
    s_add_u32 s18, s18, 1
    v_cvt_pk_bf16_f32 v219, v214, v215
    v_sub_f32 v209, v209, v243
    v_sub_f32 v210, v210, v243
    v_mfma_f32_16x16x16_f16 v[224:227], v[126:127], v[124:125], v[224:227]
    v_exp_f32 v208, v208
    v_exp_f32 v209, v209
    v_mfma_f32_16x16x32_f16 v[212:215], v[172:175], v[160:163], v[68:71]
    s_cmp_lt_u32 s18, s45
    v_cvt_pk_bf16_f32 v36, v208, v209
    v_sub_f32 v211, v211, v243
    v_mfma_f32_16x16x32_bf16 v[188:191], v[84:87], v[204:207], v[188:191]
    v_exp_f32 v210, v210
    v_mfma_f32_16x16x32_bf16 v[188:191], v[88:91], v[200:203], v[188:191]
    v_exp_f32 v211, v211
    v_sub_f32 v236, v236, v243
    v_mfma_f32_16x16x16_f16 v[212:215], v[138:139], v[124:125], v[212:215]
    v_cvt_pk_bf16_f32 v37, v210, v211
    v_exp_f32 v236, v236
    v_mov_b32_dpp v242, v245 quad_perm:[0,1,2,3] row_mask:0x4 bank_mask:0xf
    v_mfma_f32_16x16x32_bf16 v[176:179], v[92:95], v[192:195], 0
    ds_read_b128 v[160:163], v2 offset:6144
    v_cvt_pk_bf16_f32 v39, v236, 0
    v_mfma_f32_16x16x32_bf16 v[176:179], v[96:99], v[184:187], v[176:179]
    ds_read_b128 v[184:187], v2 offset:7168
    v_mov_b32 v120, v242
    v_mfma_f32_16x16x32_bf16 v[192:195], v[28:31], v[36:39], 0
    v_max3_f32 v121, v232, v220, v221
    v_max_f32_dpp v120, v120, v120 quad_perm:[1,0,3,2] row_mask:0xf bank_mask:0xf
    v_mfma_f32_16x16x32_bf16 v[192:195], v[28:31], v[216:219], v[192:195]
    v_max3_f32 v121, v121, v222, v223
    v_max_f32_dpp v120, v120, v120 quad_perm:[2,3,0,1] row_mask:0xf bank_mask:0xf
    v_mfma_f32_16x16x32_bf16 v[208:211], v[152:155], v[36:39], 0
    v_max3_f32 v121, v121, v224, v225
    v_max_f32_dpp v120, v120, v120 row_half_mirror row_mask:0xf bank_mask:0xf
    v_mfma_f32_16x16x32_bf16 v[208:211], v[164:167], v[216:219], v[208:211]
    v_max3_f32 v121, v121, v226, v227
    v_max_f32_dpp v120, v120, v120 row_mirror row_mask:0xf bank_mask:0xf
    v_mfma_f32_16x16x32_bf16 v[176:179], v[100:103], v[132:135], v[176:179]
    ds_read_b128 v[228:231], v2 offset:8192
    v_mov_b32 v124, v120
    v_mfma_f32_16x16x32_bf16 v[176:179], v[104:107], v[196:199], v[176:179]
    ds_read_b128 v[236:239], v2 offset:9216
    v_max3_f32 v121, v121, v212, v213
    v_mfma_f32_16x16x32_bf16 v[176:179], v[108:111], v[204:207], v[176:179]
    s_waitcnt lgkmcnt(3)
    ds_read_b128 v[204:207], v2 offset:10240
    v_max3_f32 v121, v121, v214, v215
    v_mfma_f32_16x16x32_bf16 v[176:179], v[112:115], v[200:203], v[176:179]
    s_waitcnt lgkmcnt(3)
    ds_read_b128 v[200:203], v2 offset:11264
    v_rcp_f32 v192, v192
    v_permlane32_swap_b32 v120, v124
    v_mul_f32 v208, v192, v208
    v_mul_f32 v209, v192, v209
    v_cvt_pk_bf16_f32 v132, v208, v209
    v_mul_f32 v210, v192, v210
    v_mul_f32 v211, v192, v211
    v_cvt_pk_bf16_f32 v133, v210, v211
    v_max_f32 v120, v120, v124
    v_mfma_f32_16x16x32_bf16 v[196:199], v[156:159], v[36:39], 0
    v_mov_b32 v124, v120
    v_mov_b32 v125, v121
    v_mfma_f32_16x16x32_bf16 v[196:199], v[140:143], v[216:219], v[196:199]
    s_waitcnt lgkmcnt(3)
    v_permlane16_swap_b32 v120, v124
    v_max_f32 v120, v120, v124
    v_sub_f32 v242, v242, v120
    v_exp_f32 v242, v242
    v_permlane32_swap_b32 v121, v125
    v_cvt_pk_bf16_f32 v242, v242, v242
    v_max_f32 v121, v121, v125
    v_mul_f32 v196, v192, v196
    v_mul_f32 v197, v192, v197
    v_cvt_pk_bf16_f32 v134, v196, v197
    v_mul_f32 v198, v192, v198
    v_mul_f32 v199, v192, v199
    v_cvt_pk_bf16_f32 v135, v198, v199
    v_mov_b32 v125, v121
    v_fma_f32 v120, v128, v128, s33
    v_fmac_f32 v120, v129, v129
    v_permlane16_swap_b32 v121, v125
    v_max_f32 v121, v121, v125
    v_sub_f32 v220, v220, v121
    v_exp_f32 v220, v220
    v_sub_f32 v221, v221, v121
    v_exp_f32 v221, v221
    v_sub_f32 v222, v222, v121
    v_cvt_pk_bf16_f32 v208, v220, v221
    v_exp_f32 v222, v222
    v_sub_f32 v223, v223, v121
    v_exp_f32 v223, v223
    v_sub_f32 v224, v224, v121
    v_cvt_pk_bf16_f32 v209, v222, v223
    v_mfma_f32_16x16x32_bf16 v[220:223], v[168:171], v[36:39], 0
    s_waitcnt lgkmcnt(0)
    ds_write_b16 v8, v242
    v_mfma_f32_16x16x32_bf16 v[220:223], v[144:147], v[216:219], v[220:223]
    v_exp_f32 v224, v224
    v_mfma_f32_16x16x32_bf16 v[196:199], a[216:219], v[160:163], 0
    ds_write_b128 v3, v[132:135] offset:0
    v_mfma_f32_16x16x32_bf16 v[196:199], a[220:223], v[184:187], v[196:199]
    v_sub_f32 v225, v225, v121
    v_sub_f32 v226, v226, v121
    v_mfma_f32_16x16x32_bf16 v[196:199], a[224:227], v[228:231], v[196:199]
    v_exp_f32 v225, v225
    v_mfma_f32_16x16x32_bf16 v[196:199], a[228:231], v[236:239], v[196:199]
    ds_read_b128 v[240:243], v9
    v_mul_f32 v220, v192, v220
    v_mfma_f32_16x16x32_bf16 v[196:199], a[232:235], v[204:207], v[196:199]
    v_mul_f32 v221, v192, v221
    v_cvt_pk_bf16_f32 v124, v220, v221
    v_mfma_f32_16x16x32_bf16 v[196:199], a[236:239], v[200:203], v[196:199]
    v_mul_f32 v222, v192, v222
    v_mul_f32 v223, v192, v223
    v_cvt_pk_bf16_f32 v125, v222, v223
    v_mfma_f32_16x16x32_bf16 v[132:135], a[240:243], v[160:163], 0
    ds_write_b64 v4, v[124:125] offset:4096
    v_mfma_f32_16x16x32_bf16 v[132:135], a[244:247], v[184:187], v[132:135]
    v_cvt_pk_bf16_f32 v210, v224, v225
    v_sub_f32 v227, v227, v121
    v_mfma_f32_16x16x32_bf16 v[132:135], a[248:251], v[228:231], v[132:135]
    v_exp_f32 v226, v226
    v_mfma_f32_16x16x32_bf16 v[132:135], a[252:255], v[236:239], v[132:135]
    v_exp_f32 v227, v227
    v_mfma_f32_16x16x32_bf16 v[132:135], v[84:87], v[204:207], v[132:135]
    s_waitcnt lgkmcnt(1)
    v_cvt_pk_bf16_f32 v211, v226, v227
    v_sub_f32 v212, v212, v121
    v_mfma_f32_16x16x32_bf16 v[132:135], v[88:91], v[200:203], v[132:135]
    ds_read_b128 v[192:195], v9 offset:64
    v_exp_f32 v212, v212
    v_sub_f32 v213, v213, v121
    v_exp_f32 v213, v213
    v_sub_f32 v214, v214, v121
    v_cvt_pk_bf16_f32 v36, v212, v213
    v_exp_f32 v214, v214
    v_sub_f32 v215, v215, v121
    v_exp_f32 v215, v215
    v_sub_f32 v232, v232, v121
    v_cvt_pk_bf16_f32 v37, v214, v215
    v_mfma_f32_16x16x32_f16 v[220:223], v[148:151], v[180:183], v[72:75]
    v_exp_f32 v232, v232
    v_mfma_f32_16x16x32_f16 v[148:151], v[116:119], v[180:183], v[76:79]
    v_cvt_pk_bf16_f32 v39, v232, 0
    v_fmac_f32 v120, v130, v130
    v_mfma_f32_16x16x32_f16 v[224:227], v[172:175], v[180:183], v[80:83]
    v_fmac_f32 v120, v131, v131
    v_fmac_f32 v120, v188, v188
    v_mfma_f32_16x16x32_bf16 v[180:183], v[28:31], v[36:39], 0
    s_waitcnt lgkmcnt(0)
    v_fmac_f32 v120, v189, v189
    v_fmac_f32 v120, v190, v190
    v_mfma_f32_16x16x32_bf16 v[180:183], v[28:31], v[208:211], v[180:183]
    v_fmac_f32 v120, v191, v191
    v_fmac_f32 v120, v176, v176
    v_mfma_f32_16x16x32_bf16 v[116:119], v[152:155], v[36:39], 0
    v_fmac_f32 v120, v177, v177
    v_fmac_f32 v120, v178, v178
    v_mfma_f32_16x16x32_bf16 v[116:119], v[164:167], v[208:211], v[116:119]
    v_fmac_f32 v120, v179, v179
    v_fma_f32 v121, v196, v196, s33
    v_mfma_f32_16x16x32_bf16 v[172:175], v[156:159], v[36:39], 0
    v_rcp_f32 v180, v180
    v_mfma_f32_16x16x32_bf16 v[172:175], v[140:143], v[208:211], v[172:175]
    v_fmac_f32 v121, v197, v197
    v_fmac_f32 v121, v198, v198
    v_fmac_f32 v121, v199, v199
    v_mfma_f32_16x16x16_f16 v[220:223], v[122:123], v[136:137], v[220:223]
    v_mul_f32 v116, v180, v116
    v_mul_f32 v117, v180, v117
    v_cvt_pk_bf16_f32 v116, v116, v117
    v_mfma_f32_16x16x16_f16 v[148:151], v[126:127], v[136:137], v[148:151]
    v_mul_f32 v118, v180, v118
    v_mul_f32 v119, v180, v119
    v_cvt_pk_bf16_f32 v117, v118, v119
    v_mul_f32 v172, v180, v172
    v_mfma_f32_16x16x32_bf16 v[124:127], v[168:171], v[36:39], 0
    v_max3_f32 v122, v244, v220, v221
    v_max3_f32 v122, v122, v222, v223
    v_mfma_f32_16x16x32_bf16 v[124:127], v[144:147], v[208:211], v[124:127]
    v_max3_f32 v122, v122, v148, v149
    v_max3_f32 v122, v122, v150, v151
    v_mul_f32 v173, v180, v173
    v_mfma_f32_16x16x16_f16 v[224:227], v[138:139], v[136:137], v[224:227]
    v_cvt_pk_bf16_f32 v118, v172, v173
    v_mul_f32 v174, v180, v174
    v_mul_f32 v175, v180, v175
    v_cvt_pk_bf16_f32 v119, v174, v175
    v_mfma_f32_16x16x32_bf16 v[212:215], v[92:95], v[160:163], 0
    ds_read_b128 v[136:139], v2 offset:12288
    v_mul_f32 v124, v180, v124
    v_mfma_f32_16x16x32_bf16 v[212:215], v[96:99], v[184:187], v[212:215]
    ds_read_b128 v[160:163], v2 offset:13312
    v_max3_f32 v122, v122, v224, v225
    v_mfma_f32_16x16x32_bf16 v[212:215], v[100:103], v[228:231], v[212:215]
    ds_read_b128 v[172:175], v2 offset:14336
    v_max3_f32 v122, v122, v226, v227
    v_mfma_f32_16x16x32_bf16 v[212:215], v[104:107], v[236:239], v[212:215]
    ds_read_b128 v[184:187], v2 offset:15360
    v_mov_b32 v123, v122
    v_mfma_f32_16x16x32_bf16 v[212:215], v[108:111], v[204:207], v[212:215]
    ds_read_b128 v[204:207], v2 offset:16384
    v_mul_f32 v125, v180, v125
    v_mfma_f32_16x16x32_bf16 v[212:215], v[112:115], v[200:203], v[212:215]
    ds_read_b128 v[228:231], v2 offset:17408
    v_cvt_pk_bf16_f32 v124, v124, v125
    v_mfma_f32_16x16x32_bf16 v[236:239], v[240:243], v[28:31], 0
    ds_write_b128 v3, v[116:119] offset:6144
    v_mfma_f32_16x16x32_bf16 v[236:239], v[192:195], v[28:31], v[236:239]
    s_waitcnt lgkmcnt(6)
    v_permlane32_swap_b32 v122, v123
    v_mfma_f32_16x16x32_bf16 v[200:203], a[216:219], v[136:139], 0
    s_waitcnt lgkmcnt(5)
    v_max_f32 v122, v122, v123
    v_mov_b32 v123, v122
    v_mfma_f32_16x16x32_bf16 v[200:203], a[220:223], v[160:163], v[200:203]
    s_waitcnt lgkmcnt(4)
    v_rcp_f32 v236, v236
    v_mfma_f32_16x16x32_bf16 v[200:203], a[224:227], v[172:175], v[200:203]
    s_waitcnt lgkmcnt(3)
    v_permlane16_swap_b32 v122, v123
    v_mfma_f32_16x16x32_bf16 v[200:203], a[228:231], v[184:187], v[200:203]
    s_waitcnt lgkmcnt(2)
    v_max_f32 v122, v122, v123
    v_sub_f32 v220, v220, v122
    v_mfma_f32_16x16x32_bf16 v[200:203], a[232:235], v[204:207], v[200:203]
    s_waitcnt lgkmcnt(1)
    v_exp_f32 v220, v220
    v_mfma_f32_16x16x32_bf16 v[200:203], a[236:239], v[228:231], v[200:203]
    v_sub_f32 v221, v221, v122
    v_sub_f32 v222, v222, v122
    v_mfma_f32_16x16x32_bf16 v[216:219], a[240:243], v[136:139], 0
    v_exp_f32 v221, v221
    v_mfma_f32_16x16x32_bf16 v[216:219], a[244:247], v[160:163], v[216:219]
    v_cvt_pk_bf16_f32 v220, v220, v221
    v_sub_f32 v223, v223, v122
    v_mfma_f32_16x16x32_bf16 v[216:219], a[248:251], v[172:175], v[216:219]
    v_exp_f32 v222, v222
    v_mfma_f32_16x16x32_bf16 v[216:219], a[252:255], v[184:187], v[216:219]
    v_exp_f32 v223, v223
    v_mfma_f32_16x16x32_bf16 v[216:219], v[84:87], v[204:207], v[216:219]
    v_cvt_pk_bf16_f32 v221, v222, v223
    v_sub_f32 v148, v148, v122
    v_mfma_f32_16x16x32_bf16 v[216:219], v[88:91], v[228:231], v[216:219]
    v_exp_f32 v148, v148
    v_mfma_f32_16x16x32_bf16 v[208:211], v[92:95], v[136:139], 0
    v_sub_f32 v149, v149, v122
    v_sub_f32 v150, v150, v122
    v_mfma_f32_16x16x32_bf16 v[208:211], v[96:99], v[160:163], v[208:211]
    v_exp_f32 v149, v149
    v_mfma_f32_16x16x32_bf16 v[208:211], v[100:103], v[172:175], v[208:211]
    v_cvt_pk_bf16_f32 v222, v148, v149
    v_sub_f32 v151, v151, v122
    v_mfma_f32_16x16x32_bf16 v[208:211], v[104:107], v[184:187], v[208:211]
    v_exp_f32 v150, v150
    v_mfma_f32_16x16x32_bf16 v[208:211], v[108:111], v[204:207], v[208:211]
    v_exp_f32 v151, v151
    v_mfma_f32_16x16x32_bf16 v[208:211], v[112:115], v[228:231], v[208:211]
    ds_read_b128 v[232:235], v0 offset:20480
    ds_read_b128 v[248:251], v1 offset:20480
    v_mfma_f32_16x16x32_bf16 v[184:187], v[240:243], v[164:167], 0
    ds_read_b128 v[160:163], v0 offset:20608
    ds_read_b128 v[136:139], v1 offset:20608
    v_mfma_f32_16x16x32_bf16 v[184:187], v[192:195], v[152:155], v[184:187]
    v_cvt_pk_bf16_f32 v223, v150, v151
    v_sub_f32 v224, v224, v122
    v_mfma_f32_16x16x32_bf16 v[148:151], v[240:243], v[140:143], 0
    ds_read_b128 v[116:119], v0 offset:20736
    v_sub_f32 v225, v225, v122
    v_mfma_f32_16x16x32_bf16 v[148:151], v[192:195], v[156:159], v[148:151]
    ds_read_b128 v[172:175], v1 offset:20736
    v_exp_f32 v224, v224
    v_mul_f32 v184, v184, v236
    v_exp_f32 v225, v225
    v_sub_f32 v226, v226, v122
    v_cvt_pk_bf16_f32 v36, v224, v225
    v_exp_f32 v226, v226
    v_sub_f32 v227, v227, v122
    v_mul_f32_dpp v184, v148, v236 quad_perm:[0,1,2,3] row_mask:0x2 bank_mask:0xf
    v_mfma_f32_16x16x32_bf16 v[204:207], v[240:243], v[144:147], 0
    s_waitcnt lgkmcnt(4)
    v_exp_f32 v227, v227
    v_mfma_f32_16x16x32_bf16 v[204:207], v[192:195], v[168:171], v[204:207]
    s_waitcnt lgkmcnt(2)
    v_cvt_pk_bf16_f32 v37, v226, v227
    v_sub_f32 v244, v244, v122
    v_mfma_f32_16x16x32_bf16 v[148:151], a[72:75], v[232:235], 0
    v_exp_f32 v244, v244
    v_mfma_f32_16x16x32_bf16 v[148:151], a[76:79], v[248:251], v[148:151]
    s_waitcnt lgkmcnt(1)
    v_cvt_pk_bf16_f32 v39, v244, 0
    v_mul_f32_dpp v184, v204, v236 quad_perm:[0,1,2,3] row_mask:0x4 bank_mask:0xf
    v_mfma_f32_16x16x32_bf16 v[148:151], a[80:83], v[160:163], v[148:151]
    s_waitcnt lgkmcnt(0)
    v_cvt_pk_bf16_f32 v184, v184, v184
    v_mul_f32 v126, v180, v126
    v_mfma_f32_16x16x32_bf16 v[192:195], v[28:31], v[36:39], 0
    ds_write_b16 v7, v184
    v_mfma_f32_16x16x32_bf16 v[192:195], v[28:31], v[220:223], v[192:195]
    v_mul_f32 v127, v180, v127
    v_cvt_pk_bf16_f32 v125, v126, v127
    v_mfma_f32_16x16x32_bf16 v[180:183], v[152:155], v[36:39], 0
    ds_write_b64 v4, v[124:125] offset:10240
    v_mfma_f32_16x16x32_bf16 v[180:183], v[164:167], v[220:223], v[180:183]
    v_fma_f32 v122, v200, v200, s33
    v_fmac_f32 v122, v201, v201
    v_mfma_f32_16x16x32_bf16 v[124:127], v[156:159], v[36:39], 0
    v_rcp_f32 v192, v192
    v_mfma_f32_16x16x32_bf16 v[124:127], v[140:143], v[220:223], v[124:127]
    v_fmac_f32 v122, v202, v202
    v_fmac_f32 v122, v203, v203
    v_mfma_f32_16x16x32_bf16 v[152:155], v[168:171], v[36:39], 0
    v_mul_f32 v180, v192, v180
    v_mul_f32 v181, v192, v181
    v_mfma_f32_16x16x32_bf16 v[152:155], v[144:147], v[220:223], v[152:155]
    v_cvt_pk_bf16_f32 v144, v180, v181
    v_mul_f32 v182, v192, v182
    v_mfma_f32_16x16x32_bf16 v[148:151], a[84:87], v[136:139], v[148:151]
    v_mul_f32 v183, v192, v183
    v_cvt_pk_bf16_f32 v145, v182, v183
    v_mfma_f32_16x16x32_bf16 v[148:151], a[88:91], v[116:119], v[148:151]
    v_mul_f32 v124, v192, v124
    v_mul_f32 v125, v192, v125
    v_mfma_f32_16x16x32_bf16 v[148:151], a[92:95], v[172:175], v[148:151]
    v_cvt_pk_bf16_f32 v146, v124, v125
    v_mul_f32 v126, v192, v126
    v_mfma_f32_16x16x32_bf16 v[140:143], a[96:99], v[232:235], 0
    v_mul_f32 v127, v192, v127
    v_cvt_pk_bf16_f32 v147, v126, v127
    v_mfma_f32_16x16x32_bf16 v[140:143], a[100:103], v[248:251], v[140:143]
    ds_write_b128 v3, v[144:147] offset:12288
    v_mfma_f32_16x16x32_bf16 v[140:143], a[104:107], v[160:163], v[140:143]
    v_mul_f32 v152, v192, v152
    v_mul_f32 v153, v192, v153
    v_mfma_f32_16x16x32_bf16 v[140:143], a[108:111], v[136:139], v[140:143]
    v_cvt_pk_bf16_f32 v152, v152, v153
    v_mul_f32 v154, v192, v154
    v_mfma_f32_16x16x32_bf16 v[140:143], a[112:115], v[116:119], v[140:143]
    v_mul_f32 v155, v192, v155
    v_cvt_pk_bf16_f32 v153, v154, v155
    v_mfma_f32_16x16x32_bf16 v[140:143], a[116:119], v[172:175], v[140:143]
    ds_write_b64 v4, v[152:153] offset:16384
    v_mfma_f32_16x16x32_bf16 v[144:147], a[120:123], v[232:235], 0
    v_fmac_f32 v122, v216, v216
    v_fmac_f32 v122, v217, v217
    v_mfma_f32_16x16x32_bf16 v[144:147], a[124:127], v[248:251], v[144:147]
    v_fmac_f32 v122, v218, v218
    v_fmac_f32 v122, v219, v219
    v_mfma_f32_16x16x32_bf16 v[144:147], a[128:131], v[160:163], v[144:147]
    v_fmac_f32 v122, v208, v208
    v_fmac_f32 v122, v209, v209
    v_mfma_f32_16x16x32_bf16 v[144:147], a[132:135], v[136:139], v[144:147]
    v_fmac_f32 v122, v210, v210
    v_fmac_f32 v122, v211, v211
    v_mfma_f32_16x16x32_bf16 v[144:147], a[136:139], v[116:119], v[144:147]
    v_cvt_pk_bf16_f32 v123, v122, v122
    v_fmac_f32 v121, v132, v132
    v_mfma_f32_16x16x32_bf16 v[144:147], a[140:143], v[172:175], v[144:147]
    v_fmac_f32 v121, v133, v133
    v_fmac_f32 v121, v134, v134
    v_mfma_f32_16x16x32_bf16 v[152:155], a[0:3], v[232:235], 0
    v_fmac_f32 v121, v135, v135
    v_fmac_f32 v121, v212, v212
    v_mfma_f32_16x16x32_bf16 v[152:155], a[4:7], v[248:251], v[152:155]
    v_fmac_f32 v121, v213, v213
    v_fmac_f32 v121, v214, v214
    v_mfma_f32_16x16x32_bf16 v[152:155], a[8:11], v[160:163], v[152:155]
    v_fmac_f32 v121, v215, v215
    v_cvt_pk_bf16_f32 v122, v120, v121
    v_mfma_f32_16x16x32_bf16 v[152:155], a[12:15], v[136:139], v[152:155]
    ds_write_b64 v4, v[122:123] offset:18432
    v_mfma_f32_16x16x32_bf16 v[152:155], a[16:19], v[116:119], v[152:155]
    v_add_u32 v7, s76, v7
    v_fma_f32 v164, v148, v148, s32
    v_mfma_f32_16x16x32_bf16 v[152:155], a[20:23], v[172:175], v[152:155]
    v_fmac_f32 v164, v149, v149
    v_fmac_f32 v164, v150, v150
    v_mfma_f32_16x16x32_bf16 v[156:159], a[24:27], v[232:235], 0
    v_fmac_f32 v164, v151, v151
    v_fmac_f32 v164, v140, v140
    v_mfma_f32_16x16x32_bf16 v[156:159], a[28:31], v[248:251], v[156:159]
    v_fmac_f32 v164, v141, v141
    v_fmac_f32 v164, v142, v142
    v_mfma_f32_16x16x32_bf16 v[156:159], a[32:35], v[160:163], v[156:159]
    v_fmac_f32 v164, v143, v143
    v_xor_b32 v2, 65536, v2
    v_mfma_f32_16x16x32_bf16 v[156:159], a[36:39], v[136:139], v[156:159]
    v_xor_b32 v3, 65536, v3
    v_xor_b32 v4, 65536, v4
    v_mfma_f32_16x16x32_bf16 v[156:159], a[40:43], v[116:119], v[156:159]
    s_waitcnt lgkmcnt(0)
    s_nop 0
    s_barrier
    s_nop 0
    s_nop 0
    v_mfma_f32_16x16x32_bf16 v[156:159], a[44:47], v[172:175], v[156:159]
    s_cbranch_scc1 L_loop_safe1
    s_branch L_final_safe
.p2align 6
L_loop_safe2:
    v_mfma_f32_16x16x32_bf16 v[124:127], a[48:51], v[232:235], 0
    s_add_u32 s12, s40, s27
    ds_read_b128 v[120:123], v2 offset:18432
    ds_read_b128 v[168:171], v2 offset:19456
    v_mfma_f32_16x16x32_bf16 v[124:127], a[52:55], v[248:251], v[124:127]
    s_addc_u32 s13, s41, 0
    v_fmac_f32 v164, v144, v144
    v_fmac_f32 v164, v145, v145
    v_mfma_f32_16x16x32_bf16 v[124:127], a[56:59], v[160:163], v[124:127]
    s_sub_u32 s14, s36, s27
    v_fmac_f32 v164, v146, v146
    v_fmac_f32 v164, v147, v147
    v_mfma_f32_16x16x32_bf16 v[124:127], a[60:63], v[136:139], v[124:127]
    s_cmp_ge_u32 s18, 2
    v_fma_f32 v165, v152, v152, s32
    v_fmac_f32 v165, v153, v153
    v_mfma_f32_16x16x32_bf16 v[124:127], a[64:67], v[116:119], v[124:127]
    s_cselect_b32 s14, s14, 0
    v_fmac_f32 v165, v154, v154
    v_fmac_f32 v165, v155, v155
    v_mfma_f32_16x16x32_bf16 v[124:127], a[68:71], v[172:175], v[124:127]
    s_sub_u32 s82, s72, s71
    v_fmac_f32 v165, v156, v156
    v_fmac_f32 v165, v157, v157
    v_mfma_f32_16x16x32_bf16 v[180:183], v[232:235], a[144:147], 0
    s_mul_i32 s74, s82, 336
    v_fmac_f32 v165, v158, v158
    v_fmac_f32 v165, v159, v159
    v_mfma_f32_16x16x32_bf16 v[180:183], v[248:251], a[148:151], v[180:183]
    s_mul_i32 s75, s82, 272
    v_fmac_f32 v165, v124, v124
    v_fmac_f32 v165, v125, v125
    v_mfma_f32_16x16x32_bf16 v[180:183], v[160:163], a[152:155], v[180:183]
    s_waitcnt lgkmcnt(0)
    v_fmac_f32 v165, v126, v126
    v_fmac_f32 v165, v127, v127
    v_mfma_f32_16x16x32_bf16 v[184:187], v[32:35], v[120:123], 0
    s_mul_i32 s76, s82, 16
    v_cvt_pk_bf16_f32 v36, v165, v164
    s_add_u32 s34, s18, 2
    v_mfma_f32_16x16x32_bf16 v[184:187], v[32:35], v[168:171], v[184:187]
    s_add_u32 s8, s60, s23
    s_addc_u32 s9, s61, 0
    s_sub_u32 s10, s36, s23
    v_mfma_f32_16x16x32_bf16 v[168:171], v[32:35], v[36:39], 0
    s_cmp_le_u32 s34, s45
    s_cselect_b32 s10, s10, 0
    s_add_u32 m0, s28, 0
    v_mfma_f32_16x16x32_bf16 v[180:183], v[136:139], a[156:159], v[180:183]
    s_mov_b32 s27, s26
    v_mul_f32 v166, 0x3baaaaab, v184
    v_mul_f32 v184, 0x3baaaaab, v185
    v_mfma_f32_16x16x32_bf16 v[180:183], v[116:119], a[160:163], v[180:183]
    s_mov_b32 s26, s25
    v_rsq_f32 v169, v169
    v_mfma_f32_16x16x32_bf16 v[180:183], v[172:175], a[164:167], v[180:183]
    s_mov_b32 s25, s24
    v_rsq_f32 v168, v168
    v_mfma_f32_16x16x32_bf16 v[120:123], v[232:235], a[168:171], 0
    s_mov_b32 s24, s23
    v_mul_f32 v168, s31, v168
    v_mul_f32 v148, v169, v148
    v_mfma_f32_16x16x32_bf16 v[120:123], v[248:251], a[172:175], v[120:123]
    s_ff1_i32_b32 s80, s100
    v_cvt_pk_bf16_f32 v164, v180, v181
    v_cvt_pk_bf16_f32 v165, v182, v183
    v_mfma_f32_16x16x32_bf16 v[120:123], v[160:163], a[176:179], v[120:123]
    s_mov_b32 s71, s72
    ds_read_b128 v[180:183], v0 offset:26624
    v_mul_f32 v149, v169, v149
    v_mfma_f32_16x16x32_bf16 v[120:123], v[136:139], a[180:183], v[120:123]
    s_mov_b32 s72, s73
    ds_read_b128 v[192:195], v1 offset:26624
    v_cvt_pk_f16_f32 v148, v148, v149
    v_mfma_f32_16x16x32_bf16 v[120:123], v[116:119], a[184:187], v[120:123]
    ds_read_b128 v[204:207], v0 offset:26752
    v_mul_f32 v150, v169, v150
    v_mfma_f32_16x16x32_bf16 v[120:123], v[172:175], a[188:191], v[120:123]
    ds_read_b128 v[220:223], v1 offset:26752
    v_mul_f32 v151, v169, v151
    v_cvt_pk_f16_f32 v149, v150, v151
    v_mul_f32 v140, v169, v140
    v_mul_f32 v141, v169, v141
    v_cvt_pk_f16_f32 v150, v140, v141
    v_mfma_f32_16x16x32_bf16 v[224:227], v[232:235], a[192:195], 0
    ds_read_b128 v[228:231], v0 offset:26880
    v_cvt_pk_bf16_f32 v140, v120, v121
    v_mfma_f32_16x16x32_bf16 v[224:227], v[248:251], a[196:199], v[224:227]
    ds_read_b128 v[232:235], v1 offset:26880
    v_cvt_pk_bf16_f32 v141, v122, v123
    v_mfma_f32_16x16x32_bf16 v[224:227], v[160:163], a[200:203], v[224:227]
    v_mul_f32 v142, v169, v142
    v_mul_f32 v143, v169, v143
    v_mfma_f32_16x16x32_bf16 v[224:227], v[136:139], a[204:207], v[224:227]
    s_waitcnt lgkmcnt(5)
    v_cvt_pk_f16_f32 v151, v142, v143
    v_mul_f32 v144, v169, v144
    v_mfma_f32_16x16x32_bf16 v[224:227], v[116:119], a[208:211], v[224:227]
    s_waitcnt lgkmcnt(4)
    v_mul_f32 v145, v169, v145
    v_cvt_pk_f16_f32 v122, v144, v145
    v_mfma_f32_16x16x32_bf16 v[224:227], v[172:175], a[212:215], v[224:227]
    s_waitcnt lgkmcnt(3)
    v_mul_f32 v146, v169, v146
    v_mul_f32 v147, v169, v147
    v_mfma_f32_16x16x32_bf16 v[116:119], a[72:75], v[180:183], 0
    s_waitcnt lgkmcnt(2)
    v_cvt_pk_f16_f32 v123, v146, v147
    v_mul_f32 v152, v168, v152
    v_mfma_f32_16x16x32_bf16 v[116:119], a[76:79], v[192:195], v[116:119]
    v_cvt_pk_bf16_f32 v144, v224, v225
    v_cvt_pk_bf16_f32 v145, v226, v227
    v_mfma_f32_16x16x32_bf16 v[116:119], a[80:83], v[204:207], v[116:119]
    s_waitcnt lgkmcnt(1)
    v_mul_f32 v153, v168, v153
    v_cvt_pk_f16_f32 v244, v152, v153
    v_mfma_f32_16x16x32_bf16 v[116:119], a[84:87], v[220:223], v[116:119]
    s_waitcnt lgkmcnt(0)
    v_mul_f32 v154, v168, v154
    v_mul_f32 v155, v168, v155
    v_mfma_f32_16x16x32_bf16 v[116:119], a[88:91], v[228:231], v[116:119]
    v_cvt_pk_f16_f32 v245, v154, v155
    v_mul_f32 v156, v168, v156
    v_mfma_f32_16x16x32_bf16 v[116:119], a[92:95], v[232:235], v[116:119]
    v_mul_f32 v157, v168, v157
    v_cvt_pk_f16_f32 v246, v156, v157
    v_mfma_f32_16x16x32_bf16 v[136:139], a[96:99], v[180:183], 0
    v_mul_f32 v158, v168, v158
    v_mul_f32 v159, v168, v159
    v_mfma_f32_16x16x32_bf16 v[136:139], a[100:103], v[192:195], v[136:139]
    v_cvt_pk_f16_f32 v247, v158, v159
    v_mul_f32 v124, v168, v124
    v_mfma_f32_16x16x32_bf16 v[136:139], a[104:107], v[204:207], v[136:139]
    v_mul_f32 v125, v168, v125
    v_cvt_pk_f16_f32 v120, v124, v125
    v_mfma_f32_16x16x32_bf16 v[136:139], a[108:111], v[220:223], v[136:139]
    v_mul_f32 v126, v168, v126
    v_mul_f32 v127, v168, v127
    v_mfma_f32_16x16x32_bf16 v[136:139], a[112:115], v[228:231], v[136:139]
    v_cvt_pk_f16_f32 v121, v126, v127
    v_fma_f32 v167, v116, v116, s32
    v_mfma_f32_16x16x32_bf16 v[136:139], a[116:119], v[232:235], v[136:139]
    v_fmac_f32 v167, v117, v117
    v_fmac_f32 v167, v118, v118
    v_mfma_f32_16x16x32_bf16 v[152:155], a[120:123], v[180:183], 0
    v_fmac_f32 v167, v119, v119
    v_mul_f32 v142, 0x3baaaaab, v186
    v_mfma_f32_16x16x32_bf16 v[152:155], a[124:127], v[192:195], v[152:155]
    v_rsq_f32 v166, v166
    v_mfma_f32_16x16x32_bf16 v[152:155], a[128:131], v[204:207], v[152:155]
    v_fmac_f32 v167, v136, v136
    v_fmac_f32 v167, v137, v137
    v_mfma_f32_16x16x32_bf16 v[152:155], a[132:135], v[220:223], v[152:155]
    v_fmac_f32 v167, v138, v138
    v_fmac_f32 v167, v139, v139
    v_mfma_f32_16x16x32_bf16 v[152:155], a[136:139], v[228:231], v[152:155]
    v_rsq_f32 v184, v184
    v_mfma_f32_16x16x32_bf16 v[152:155], a[140:143], v[232:235], v[152:155]
    v_rsq_f32 v142, v142
    v_mfma_f32_16x16x32_bf16 v[156:159], a[0:3], v[180:183], 0
    v_mul_f32 v128, v166, v128
    v_mul_f32 v129, v166, v129
    v_mfma_f32_16x16x32_bf16 v[156:159], a[4:7], v[192:195], v[156:159]
    v_cvt_pk_bf16_f32 v124, v128, v129
    v_mul_f32 v130, v166, v130
    v_mfma_f32_16x16x32_bf16 v[156:159], a[8:11], v[204:207], v[156:159]
    v_fmac_f32 v167, v152, v152
    v_fmac_f32 v167, v153, v153
    v_mfma_f32_16x16x32_bf16 v[156:159], a[12:15], v[220:223], v[156:159]
    v_fmac_f32 v167, v154, v154
    v_fmac_f32 v167, v155, v155
    v_mfma_f32_16x16x32_bf16 v[156:159], a[16:19], v[228:231], v[156:159]
    v_mul_f32 v131, v166, v131
    v_cvt_pk_bf16_f32 v125, v130, v131
    v_mfma_f32_16x16x32_bf16 v[156:159], a[20:23], v[232:235], v[156:159]
    v_mul_f32 v188, v166, v188
    v_mul_f32 v189, v166, v189
    v_mfma_f32_16x16x32_bf16 v[168:171], a[24:27], v[180:183], 0
    v_cvt_pk_bf16_f32 v126, v188, v189
    v_mul_f32 v190, v166, v190
    v_mfma_f32_16x16x32_bf16 v[168:171], a[28:31], v[192:195], v[168:171]
    v_mul_f32 v191, v166, v191
    v_cvt_pk_bf16_f32 v127, v190, v191
    v_mfma_f32_16x16x32_bf16 v[168:171], a[32:35], v[204:207], v[168:171]
    buffer_store_dwordx4 v[124:127], v15, s[12:15], 0 offen nt
    v_fma_f32 v143, v156, v156, s32
    v_fmac_f32 v143, v157, v157
    v_fmac_f32 v143, v158, v158
    v_fmac_f32 v143, v159, v159
    v_mfma_f32_16x16x32_bf16 v[168:171], a[36:39], v[220:223], v[168:171]
    v_mul_f32 v176, v166, v176
    v_mul_f32 v177, v166, v177
    v_mfma_f32_16x16x32_bf16 v[168:171], a[40:43], v[228:231], v[168:171]
    v_cvt_pk_bf16_f32 v146, v176, v177
    v_mul_f32 v178, v166, v178
    v_mfma_f32_16x16x32_bf16 v[168:171], a[44:47], v[232:235], v[168:171]
    v_mul_f32 v179, v166, v179
    v_cvt_pk_bf16_f32 v147, v178, v179
    v_mfma_f32_16x16x32_bf16 v[172:175], a[48:51], v[180:183], 0
    v_mul_f32 v200, v142, v200
    v_mul_f32 v201, v142, v201
    v_mfma_f32_16x16x32_bf16 v[172:175], a[52:55], v[192:195], v[172:175]
    v_cvt_pk_bf16_f32 v124, v200, v201
    v_mul_f32 v202, v142, v202
    v_mfma_f32_16x16x32_bf16 v[172:175], a[56:59], v[204:207], v[172:175]
    v_fmac_f32 v143, v168, v168
    v_fmac_f32 v143, v169, v169
    v_mfma_f32_16x16x32_bf16 v[172:175], a[60:63], v[220:223], v[172:175]
    v_fmac_f32 v143, v170, v170
    v_fmac_f32 v143, v171, v171
    v_mfma_f32_16x16x32_bf16 v[172:175], a[64:67], v[228:231], v[172:175]
    v_mul_f32 v203, v142, v203
    v_cvt_pk_bf16_f32 v125, v202, v203
    v_mfma_f32_16x16x32_bf16 v[172:175], a[68:71], v[232:235], v[172:175]
    v_mul_f32 v216, v142, v216
    v_mul_f32 v217, v142, v217
    v_mfma_f32_16x16x32_bf16 v[128:131], v[180:183], a[144:147], 0
    v_cvt_pk_bf16_f32 v126, v216, v217
    v_mul_f32 v218, v142, v218
    v_mfma_f32_16x16x32_bf16 v[128:131], v[192:195], a[148:151], v[128:131]
    v_mul_f32 v219, v142, v219
    v_cvt_pk_bf16_f32 v127, v218, v219
    v_mfma_f32_16x16x32_bf16 v[128:131], v[204:207], a[152:155], v[128:131]
    v_fmac_f32 v143, v172, v172
    v_fmac_f32 v143, v173, v173
    v_mfma_f32_16x16x32_bf16 v[128:131], v[220:223], a[156:159], v[128:131]
    v_fmac_f32 v143, v174, v174
    v_fmac_f32 v143, v175, v175
    v_mfma_f32_16x16x32_bf16 v[128:131], v[228:231], a[160:163], v[128:131]
    v_cvt_pk_bf16_f32 v36, v143, v167
    v_mul_f32 v208, v142, v208
    v_mfma_f32_16x16x32_bf16 v[128:131], v[232:235], a[164:167], v[128:131]
    v_mul_f32 v209, v142, v209
    v_cvt_pk_bf16_f32 v186, v208, v209
    v_mfma_f32_16x16x32_bf16 v[176:179], v[32:35], v[36:39], 0
    v_mul_f32 v210, v142, v210
    v_mul_f32 v211, v142, v211
    v_mfma_f32_16x16x32_bf16 v[160:163], v[180:183], a[168:171], 0
    buffer_store_dwordx2 v[146:147], v18, s[12:15], 0 offen nt
    v_cvt_pk_bf16_f32 v187, v210, v211
    v_cvt_pk_bf16_f32 v166, v128, v129
    v_mfma_f32_16x16x32_bf16 v[160:163], v[192:195], a[172:175], v[160:163]
    v_cvt_pk_bf16_f32 v167, v130, v131
    v_mul_f32 v196, v184, v196
    v_mfma_f32_16x16x32_bf16 v[160:163], v[204:207], a[176:179], v[160:163]
    ds_read_b128 v[200:203], v0 offset:32768
    v_mul_f32 v197, v184, v197
    v_mfma_f32_16x16x32_bf16 v[160:163], v[220:223], a[180:183], v[160:163]
    ds_read_b128 v[208:211], v1 offset:32768
    v_cvt_pk_bf16_f32 v128, v196, v197
    v_mfma_f32_16x16x32_bf16 v[160:163], v[228:231], a[184:187], v[160:163]
    ds_read_b128 v[216:219], v0 offset:32896
    v_mul_f32 v198, v184, v198
    v_mfma_f32_16x16x32_bf16 v[160:163], v[232:235], a[188:191], v[160:163]
    ds_read_b128 v[224:227], v1 offset:32896
    v_mul_f32 v199, v184, v199
    v_mfma_f32_16x16x32_bf16 v[188:191], v[180:183], a[192:195], 0
    ds_read_b128 v[180:183], v0 offset:33024
    v_cvt_pk_bf16_f32 v129, v198, v199
    v_mfma_f32_16x16x32_bf16 v[188:191], v[192:195], a[196:199], v[188:191]
    ds_read_b128 v[192:195], v1 offset:33024
    v_mul_f32 v132, v184, v132
    v_mfma_f32_16x16x32_bf16 v[188:191], v[204:207], a[200:203], v[188:191]
    v_rsq_f32 v177, v177
    v_mfma_f32_16x16x32_bf16 v[188:191], v[220:223], a[204:207], v[188:191]
    v_rsq_f32 v176, v176
    v_mfma_f32_16x16x32_bf16 v[188:191], v[228:231], a[208:211], v[188:191]
    s_waitcnt lgkmcnt(5)
    v_mul_f32 v176, s31, v176
    v_cvt_pk_bf16_f32 v142, v160, v161
    v_mfma_f32_16x16x32_bf16 v[188:191], v[232:235], a[212:215], v[188:191]
    s_waitcnt lgkmcnt(4)
    v_cvt_pk_bf16_f32 v143, v162, v163
    v_mul_f32 v116, v177, v116
    v_mfma_f32_16x16x32_bf16 v[196:199], a[72:75], v[200:203], 0
    s_waitcnt lgkmcnt(3)
    v_mul_f32 v117, v177, v117
    v_cvt_pk_f16_f32 v116, v116, v117
    v_mfma_f32_16x16x32_bf16 v[196:199], a[76:79], v[208:211], v[196:199]
    s_waitcnt lgkmcnt(2)
    v_cvt_pk_bf16_f32 v146, v188, v189
    v_cvt_pk_bf16_f32 v147, v190, v191
    v_mfma_f32_16x16x32_bf16 v[196:199], a[80:83], v[216:219], v[196:199]
    s_waitcnt lgkmcnt(1)
    v_mul_f32 v118, v177, v118
    v_mul_f32 v119, v177, v119
    v_mfma_f32_16x16x32_bf16 v[196:199], a[84:87], v[224:227], v[196:199]
    s_waitcnt lgkmcnt(0)
    v_cvt_pk_f16_f32 v117, v118, v119
    v_mul_f32 v136, v177, v136
    v_mfma_f32_16x16x32_bf16 v[196:199], a[88:91], v[180:183], v[196:199]
    v_mul_f32 v137, v177, v137
    v_cvt_pk_f16_f32 v118, v136, v137
    v_mfma_f32_16x16x32_bf16 v[196:199], a[92:95], v[192:195], v[196:199]
    buffer_store_dwordx4 v[124:127], v17, s[12:15], 0 offen nt
    v_mul_f32 v138, v177, v138
    v_mul_f32 v139, v177, v139
    v_cvt_pk_f16_f32 v119, v138, v139
    v_mul_f32 v152, v177, v152
    v_mfma_f32_16x16x32_bf16 v[136:139], a[96:99], v[200:203], 0
    v_mul_f32 v153, v177, v153
    v_cvt_pk_f16_f32 v126, v152, v153
    v_mfma_f32_16x16x32_bf16 v[136:139], a[100:103], v[208:211], v[136:139]
    v_mul_f32 v154, v177, v154
    v_mul_f32 v155, v177, v155
    v_mfma_f32_16x16x32_bf16 v[136:139], a[104:107], v[216:219], v[136:139]
    v_cvt_pk_f16_f32 v127, v154, v155
    v_mul_f32 v156, v176, v156
    v_mfma_f32_16x16x32_bf16 v[136:139], a[108:111], v[224:227], v[136:139]
    v_mul_f32 v157, v176, v157
    v_cvt_pk_f16_f32 v160, v156, v157
    v_mfma_f32_16x16x32_bf16 v[136:139], a[112:115], v[180:183], v[136:139]
    s_waitcnt vmcnt(3)
    ds_write_b16 v8, v46 offset:512
    v_mfma_f32_16x16x32_bf16 v[136:139], a[116:119], v[192:195], v[136:139]
    s_nop 0
    v_mul_f32 v158, v176, v158
    v_mfma_f32_16x16x32_bf16 v[204:207], a[120:123], v[200:203], 0
    v_mul_f32 v159, v176, v159
    v_cvt_pk_f16_f32 v161, v158, v159
    v_mfma_f32_16x16x32_bf16 v[204:207], a[124:127], v[208:211], v[204:207]
    v_mul_f32 v168, v176, v168
    v_mul_f32 v169, v176, v169
    v_mfma_f32_16x16x32_bf16 v[204:207], a[128:131], v[216:219], v[204:207]
    v_cvt_pk_f16_f32 v162, v168, v169
    v_mul_f32 v170, v176, v170
    v_mfma_f32_16x16x32_bf16 v[204:207], a[132:135], v[224:227], v[204:207]
    v_mul_f32 v171, v176, v171
    v_cvt_pk_f16_f32 v163, v170, v171
    v_mfma_f32_16x16x32_bf16 v[204:207], a[136:139], v[180:183], v[204:207]
    v_mul_f32 v172, v176, v172
    v_mul_f32 v173, v176, v173
    v_mfma_f32_16x16x32_bf16 v[204:207], a[140:143], v[192:195], v[204:207]
    v_cvt_pk_f16_f32 v124, v172, v173
    v_mul_f32 v174, v176, v174
    v_mfma_f32_16x16x32_bf16 v[236:239], a[0:3], v[200:203], 0
    s_waitcnt lgkmcnt(0)
    v_mul_f32 v175, v176, v175
    v_cvt_pk_f16_f32 v125, v174, v175
    v_mfma_f32_16x16x32_bf16 v[236:239], a[4:7], v[208:211], v[236:239]
    s_nop 0
    v_fma_f32 v185, v196, v196, s32
    v_fmac_f32 v185, v197, v197
    v_mfma_f32_16x16x32_bf16 v[236:239], a[8:11], v[216:219], v[236:239]
    s_nop 0
    v_fmac_f32 v185, v198, v198
    v_fmac_f32 v185, v199, v199
    v_mfma_f32_16x16x32_bf16 v[236:239], a[12:15], v[224:227], v[236:239]
    s_barrier
    v_fmac_f32 v185, v136, v136
    v_fmac_f32 v185, v137, v137
    v_mfma_f32_16x16x32_bf16 v[236:239], a[16:19], v[180:183], v[236:239]
    s_nop 0
    buffer_load_dwordx4 v10, s[8:11], 0 offen nt lds
    ds_read_u16 v131, v9 offset:256
    v_mfma_f32_16x16x32_bf16 v[236:239], a[20:23], v[192:195], v[236:239]
    s_add_u32 m0, s28, 4096
    v_fmac_f32 v185, v138, v138
    v_fmac_f32 v185, v139, v139
    v_mfma_f32_16x16x32_bf16 v[176:179], a[24:27], v[200:203], 0
    v_fmac_f32 v185, v204, v204
    v_fmac_f32 v185, v205, v205
    v_mfma_f32_16x16x32_bf16 v[176:179], a[28:31], v[208:211], v[176:179]
    v_fmac_f32 v185, v206, v206
    v_fma_f32 v152, v236, v236, s32
    v_mfma_f32_16x16x32_bf16 v[176:179], a[32:35], v[216:219], v[176:179]
    v_fmac_f32 v152, v237, v237
    v_fmac_f32 v152, v238, v238
    v_mfma_f32_16x16x32_bf16 v[176:179], a[36:39], v[224:227], v[176:179]
    buffer_load_dwordx4 v11, s[8:11], 0 offen nt lds
    v_fmac_f32 v152, v239, v239
    v_mfma_f32_16x16x32_bf16 v[176:179], a[40:43], v[180:183], v[176:179]
    s_add_u32 m0, s28, 8192
    v_fmac_f32 v185, v207, v207
    v_mul_f32 v133, v184, v133
    v_mfma_f32_16x16x32_bf16 v[176:179], a[44:47], v[192:195], v[176:179]
    v_cvt_pk_bf16_f32 v130, v132, v133
    v_mul_f32 v134, v184, v134
    v_mfma_f32_16x16x32_bf16 v[188:191], a[48:51], v[200:203], 0
    s_waitcnt lgkmcnt(0)
    v_readfirstlane_b32 s77, v131
    v_mul_f32 v135, v184, v135
    v_mfma_f32_16x16x32_bf16 v[188:191], a[52:55], v[208:211], v[188:191]
    v_cvt_pk_bf16_f32 v131, v134, v135
    v_fmac_f32 v152, v176, v176
    v_mfma_f32_16x16x32_bf16 v[188:191], a[56:59], v[216:219], v[188:191]
    buffer_load_dwordx4 v12, s[8:11], 0 offen nt lds
    v_fmac_f32 v152, v177, v177
    v_mfma_f32_16x16x32_bf16 v[188:191], a[60:63], v[224:227], v[188:191]
    s_add_u32 m0, s28, 12288
    v_fmac_f32 v152, v178, v178
    v_fmac_f32 v152, v179, v179
    v_mfma_f32_16x16x32_bf16 v[188:191], a[64:67], v[180:183], v[188:191]
    s_xor_b32 s28, s28, 65536
    ds_read2_b32 v[154:155], v6 offset0:0 offset1:0
    ds_read2_b32 v[158:159], v6 offset0:16 offset1:16
    v_mfma_f32_16x16x32_bf16 v[188:191], a[68:71], v[192:195], v[188:191]
    ds_read2_b32 v[170:171], v6 offset0:32 offset1:32
    v_mul_f32 v212, v184, v212
    v_mfma_f32_16x16x32_bf16 v[132:135], v[200:203], a[144:147], 0
    v_mul_f32 v213, v184, v213
    v_cvt_pk_bf16_f32 v240, v212, v213
    v_mfma_f32_16x16x32_bf16 v[132:135], v[208:211], a[148:151], v[132:135]
    buffer_load_dwordx4 v13, s[8:11], 0 offen nt lds
    v_mul_f32 v214, v184, v214
    v_mfma_f32_16x16x32_bf16 v[132:135], v[216:219], a[152:155], v[132:135]
    s_mov_b32 m0, s29
    v_fmac_f32 v152, v188, v188
    v_fmac_f32 v152, v189, v189
    v_mfma_f32_16x16x32_bf16 v[132:135], v[224:227], a[156:159], v[132:135]
    s_xor_b32 s29, s29, s30
    v_fmac_f32 v152, v190, v190
    v_fmac_f32 v152, v191, v191
    v_mfma_f32_16x16x32_bf16 v[132:135], v[180:183], a[160:163], v[132:135]
    s_add_u32 s19, s19, s20
    v_cvt_pk_bf16_f32 v36, v152, v185
    v_mul_f32 v215, v184, v215
    v_mfma_f32_16x16x32_bf16 v[132:135], v[192:195], a[164:167], v[132:135]
    s_add_u32 s23, s23, s21
    v_cvt_pk_bf16_f32 v241, v214, v215
    v_xor_b32 v0, 65536, v0
    v_mfma_f32_16x16x32_bf16 v[232:235], v[32:35], v[36:39], 0
    s_cmp_ge_u32 s19, 72
    buffer_load_dwordx4 v14, s[8:11], 0 offen nt lds
    v_xor_b32 v1, 65536, v1
    v_mfma_f32_16x16x32_bf16 v[212:215], v[200:203], a[168:171], 0
    s_cselect_b32 s34, 72, 0
    v_cvt_pk_bf16_f32 v152, v132, v133
    v_cvt_pk_bf16_f32 v153, v134, v135
    v_mfma_f32_16x16x32_bf16 v[212:215], v[208:211], a[172:175], v[212:215]
    s_cselect_b32 s35, s22, 0
    v_rsq_f32 v233, v233
    v_mfma_f32_16x16x32_bf16 v[212:215], v[216:219], a[176:179], v[212:215]
    s_sub_u32 s19, s19, s34
    v_rsq_f32 v232, v232
    v_mfma_f32_16x16x32_bf16 v[212:215], v[224:227], a[180:183], v[212:215]
    s_add_u32 s23, s23, s35
    v_mul_f32 v232, s31, v232
    v_mul_f32 v196, v233, v196
    v_mfma_f32_16x16x32_bf16 v[212:215], v[180:183], a[184:187], v[212:215]
    s_cmp_lg_u32 s83, 0
    buffer_store_dwordx2 v[186:187], v20, s[12:15], 0 offen nt
    v_mul_f32 v197, v233, v197
    v_cvt_pk_f16_f32 v172, v196, v197
    v_mfma_f32_16x16x32_bf16 v[212:215], v[192:195], a[188:191], v[212:215]
    s_cselect_b32 s77, s80, s77
    v_mul_f32 v198, v233, v198
    v_mul_f32 v199, v233, v199
    v_mfma_f32_16x16x32_bf16 v[248:251], v[200:203], a[192:195], 0
    s_mul_i32 s78, s77, 2688
    v_cvt_pk_f16_f32 v173, v198, v199
    v_mul_f32 v136, v233, v136
    v_mfma_f32_16x16x32_bf16 v[248:251], v[208:211], a[196:199], v[248:251]
    s_add_u32 s78, s78, s69
    v_cvt_pk_bf16_f32 v156, v212, v213
    v_cvt_pk_bf16_f32 v157, v214, v215
    v_mfma_f32_16x16x32_bf16 v[248:251], v[216:219], a[200:203], v[248:251]
    s_add_u32 s80, s77, s68
    ds_read_b128 v[228:231], v5 offset:0
    ds_read_b128 v[220:223], v5 offset:16
    v_mfma_f32_16x16x32_bf16 v[248:251], v[224:227], a[204:207], v[248:251]
    s_cmp_ge_u32 s80, 72
    ds_read_b128 v[224:227], v5 offset:48
    ds_read_b32 v242, v6 offset:192
    v_mfma_f32_16x16x32_bf16 v[248:251], v[180:183], a[208:211], v[248:251]
    s_cselect_b32 s80, s22, 0
    v_mul_f32 v137, v233, v137
    v_cvt_pk_f16_f32 v174, v136, v137
    v_mfma_f32_16x16x32_bf16 v[248:251], v[192:195], a[212:215], v[248:251]
    s_add_u32 s78, s78, s80
    ds_read_b128 v[192:195], v2 offset:0
    ds_read_b128 v[184:187], v2 offset:1024
    v_mfma_f32_16x16x32_f16 v[216:219], v[148:151], v[244:247], v[48:51]
    s_add_u32 s80, s77, 20
    ds_read_b128 v[132:135], v2 offset:2048
    v_mul_f32 v138, v233, v138
    v_mfma_f32_16x16x32_f16 v[212:215], v[116:119], v[244:247], v[52:55]
    s_add_u32 s34, s18, 3
    v_cvt_pk_bf16_f32 v168, v248, v249
    v_cvt_pk_bf16_f32 v169, v250, v251
    v_mul_f32 v139, v233, v139
    v_mfma_f32_16x16x16_f16 v[216:219], v[122:123], v[120:121], v[216:219]
    v_cvt_pk_f16_f32 v175, v138, v139
    v_mul_f32 v204, v233, v204
    v_mul_f32 v205, v233, v205
    v_mfma_f32_16x16x16_f16 v[212:215], v[126:127], v[120:121], v[212:215]
    v_cvt_pk_f16_f32 v138, v204, v205
    v_mul_f32 v206, v233, v206
    v_mul_f32 v207, v233, v207
    v_cvt_pk_f16_f32 v139, v206, v207
    v_mfma_f32_16x16x32_f16 v[208:211], v[172:175], v[244:247], v[56:59]
    s_cmp_lt_u32 s77, s62
    v_mul_f32 v236, v232, v236
    v_mul_f32 v237, v232, v237
    v_cvt_pk_f16_f32 v180, v236, v237
    v_mul_f32 v238, v232, v238
    v_mul_f32 v239, v232, v239
    v_mfma_f32_16x16x16_f16 v[208:211], v[138:139], v[120:121], v[208:211]
    v_cvt_pk_f16_f32 v181, v238, v239
    v_mul_f32 v176, v232, v176
    v_mul_f32 v177, v232, v177
    s_waitcnt lgkmcnt(1)
    v_mfma_f32_16x16x32_f16 v[236:239], v[228:231], v[244:247], v[22:25]
    s_cselect_b32 s79, 1, 0
    ds_read_b128 v[196:199], v2 offset:3072
    v_cvt_pk_f16_f32 v182, v176, v177
    v_mfma_f32_16x16x32_f16 v[236:239], v[220:223], v[148:151], v[236:239]
    s_cselect_b32 s78, s78, 0
    v_mul_f32 v178, v232, v178
    v_mul_f32 v179, v232, v179
    v_mfma_f32_16x16x32_f16 v[236:239], v[224:227], v[120:123], v[236:239]
    s_cmp_lt_u32 s34, s17
    ds_read_b128 v[204:207], v2 offset:4096
    buffer_store_dwordx4 v[128:131], v16, s[12:15], 0 offen nt
    ds_read_b128 v[200:203], v2 offset:5120
    v_cvt_pk_f16_f32 v183, v178, v179
    v_mul_f32 v188, v232, v188
    v_mul_f32 v189, v232, v189
    v_cvt_pk_f16_f32 v136, v188, v189
    v_mul_f32 v190, v232, v190
    v_mul_f32 v191, v232, v191
    v_mfma_f32_16x16x32_f16 v[232:235], v[228:231], v[160:163], v[24:27]
    s_cselect_b32 s23, s23, s78
    v_cvt_pk_f16_f32 v137, v190, v191
    v_mov_b32_dpp v242, v237 quad_perm:[0,1,2,3] row_mask:0x1 bank_mask:0xf
    v_mfma_f32_16x16x32_f16 v[232:235], v[220:223], v[116:119], v[232:235]
    s_cselect_b32 s73, s34, s80
    v_max3_f32 v243, v236, v216, v217
    v_max3_f32 v243, v243, v218, v219
    v_mfma_f32_16x16x32_f16 v[232:235], v[224:227], v[124:127], v[232:235]
    s_cselect_b32 s79, 0, s79
    v_max3_f32 v243, v243, v212, v213
    v_max3_f32 v243, v243, v214, v215
    v_max3_f32 v243, v243, v208, v209
    v_max3_f32 v243, v243, v210, v211
    v_mov_b32 v120, v243
    v_add_u32 v5, s74, v5
    v_add_u32 v6, s75, v6
    v_mov_b32_dpp v242, v233 quad_perm:[0,1,2,3] row_mask:0x2 bank_mask:0xf
    v_permlane32_swap_b32 v243, v120
    v_max_f32 v243, v243, v120
    v_mfma_f32_16x16x32_f16 v[244:247], v[228:231], v[180:183], v[26:29]
    s_cselect_b32 s81, 0, 1
    v_mov_b32 v120, v243
    s_add_u32 s80, s77, 1
    v_mfma_f32_16x16x32_f16 v[244:247], v[220:223], v[172:175], v[244:247]
    s_mul_i32 s80, s80, s81
    v_permlane16_swap_b32 v243, v120
    v_mfma_f32_16x16x32_f16 v[244:247], v[224:227], v[136:139], v[244:247]
    s_cmp_lt_u32 s80, s62
    v_max_f32 v243, v243, v120
    v_sub_f32 v216, v216, v243
    v_mfma_f32_16x16x32_bf16 v[128:131], a[216:219], v[192:195], 0
    s_cselect_b32 s70, s70, 0
    v_exp_f32 v216, v216
    v_mfma_f32_16x16x32_bf16 v[128:131], a[220:223], v[184:187], v[128:131]
    s_waitcnt lgkmcnt(0)
    v_sub_f32 v217, v217, v243
    v_sub_f32 v218, v218, v243
    v_mfma_f32_16x16x32_bf16 v[128:131], a[224:227], v[132:135], v[128:131]
    s_cselect_b32 s62, s62, 0
    v_exp_f32 v217, v217
    v_mfma_f32_16x16x32_bf16 v[128:131], a[228:231], v[196:199], v[128:131]
    s_add_u32 s80, s18, 4
    v_cvt_pk_bf16_f32 v216, v216, v217
    v_sub_f32 v219, v219, v243
    v_mfma_f32_16x16x32_bf16 v[128:131], a[232:235], v[204:207], v[128:131]
    s_cmp_ge_u32 s80, s17
    v_exp_f32 v218, v218
    v_mfma_f32_16x16x32_bf16 v[128:131], a[236:239], v[200:203], v[128:131]
    s_cselect_b32 s66, s70, 0
    v_exp_f32 v219, v219
    v_mfma_f32_16x16x32_bf16 v[188:191], a[240:243], v[192:195], 0
    s_lshl_b32 s80, s79, s73
    v_cvt_pk_bf16_f32 v217, v218, v219
    v_sub_f32 v212, v212, v243
    v_mfma_f32_16x16x32_bf16 v[188:191], a[244:247], v[184:187], v[188:191]
    s_or_b32 s63, s63, s80
    s_nop 0
    buffer_store_dwordx2 v[240:241], v19, s[12:15], 0 offen nt
    v_exp_f32 v212, v212
    v_mfma_f32_16x16x32_f16 v[220:223], v[148:151], v[160:163], v[60:63]
    s_sub_u32 s80, s100, s81
    v_sub_f32 v213, v213, v243
    v_sub_f32 v214, v214, v243
    v_mfma_f32_16x16x32_bf16 v[188:191], a[248:251], v[132:135], v[188:191]
    s_and_b32 s100, s100, s80
    v_exp_f32 v213, v213
    v_sub_f32 v215, v215, v243
    v_mfma_f32_16x16x16_f16 v[220:223], v[122:123], v[124:125], v[220:223]
    v_cvt_pk_bf16_f32 v218, v212, v213
    v_exp_f32 v214, v214
    v_sub_f32 v208, v208, v243
    v_mfma_f32_16x16x32_f16 v[224:227], v[116:119], v[160:163], v[64:67]
    s_add_u32 s45, s45, s79
    v_exp_f32 v215, v215
    v_mfma_f32_16x16x32_bf16 v[188:191], a[252:255], v[196:199], v[188:191]
    s_add_u32 s18, s18, 1
    v_cvt_pk_bf16_f32 v219, v214, v215
    v_sub_f32 v209, v209, v243
    v_sub_f32 v210, v210, v243
    v_mfma_f32_16x16x16_f16 v[224:227], v[126:127], v[124:125], v[224:227]
    v_exp_f32 v208, v208
    v_exp_f32 v209, v209
    v_mfma_f32_16x16x32_f16 v[212:215], v[172:175], v[160:163], v[68:71]
    s_cmp_lt_u32 s18, s45
    v_cvt_pk_bf16_f32 v36, v208, v209
    v_sub_f32 v211, v211, v243
    v_mfma_f32_16x16x32_bf16 v[188:191], v[84:87], v[204:207], v[188:191]
    v_exp_f32 v210, v210
    v_mfma_f32_16x16x32_bf16 v[188:191], v[88:91], v[200:203], v[188:191]
    v_exp_f32 v211, v211
    v_sub_f32 v236, v236, v243
    v_mfma_f32_16x16x16_f16 v[212:215], v[138:139], v[124:125], v[212:215]
    v_cvt_pk_bf16_f32 v37, v210, v211
    v_exp_f32 v236, v236
    v_mov_b32_dpp v242, v245 quad_perm:[0,1,2,3] row_mask:0x4 bank_mask:0xf
    v_mfma_f32_16x16x32_bf16 v[176:179], v[92:95], v[192:195], 0
    ds_read_b128 v[160:163], v2 offset:6144
    v_cvt_pk_bf16_f32 v39, v236, 0
    v_mfma_f32_16x16x32_bf16 v[176:179], v[96:99], v[184:187], v[176:179]
    ds_read_b128 v[184:187], v2 offset:7168
    v_mov_b32 v120, v242
    v_mfma_f32_16x16x32_bf16 v[192:195], v[28:31], v[36:39], 0
    v_max3_f32 v121, v232, v220, v221
    v_max_f32_dpp v120, v120, v120 quad_perm:[1,0,3,2] row_mask:0xf bank_mask:0xf
    v_mfma_f32_16x16x32_bf16 v[192:195], v[28:31], v[216:219], v[192:195]
    v_max3_f32 v121, v121, v222, v223
    v_max_f32_dpp v120, v120, v120 quad_perm:[2,3,0,1] row_mask:0xf bank_mask:0xf
    v_mfma_f32_16x16x32_bf16 v[208:211], v[152:155], v[36:39], 0
    v_max3_f32 v121, v121, v224, v225
    v_max_f32_dpp v120, v120, v120 row_half_mirror row_mask:0xf bank_mask:0xf
    v_mfma_f32_16x16x32_bf16 v[208:211], v[164:167], v[216:219], v[208:211]
    v_max3_f32 v121, v121, v226, v227
    v_max_f32_dpp v120, v120, v120 row_mirror row_mask:0xf bank_mask:0xf
    v_mfma_f32_16x16x32_bf16 v[176:179], v[100:103], v[132:135], v[176:179]
    ds_read_b128 v[228:231], v2 offset:8192
    v_mov_b32 v124, v120
    v_mfma_f32_16x16x32_bf16 v[176:179], v[104:107], v[196:199], v[176:179]
    ds_read_b128 v[236:239], v2 offset:9216
    v_max3_f32 v121, v121, v212, v213
    v_mfma_f32_16x16x32_bf16 v[176:179], v[108:111], v[204:207], v[176:179]
    s_waitcnt lgkmcnt(3)
    ds_read_b128 v[204:207], v2 offset:10240
    v_max3_f32 v121, v121, v214, v215
    v_mfma_f32_16x16x32_bf16 v[176:179], v[112:115], v[200:203], v[176:179]
    s_waitcnt lgkmcnt(3)
    ds_read_b128 v[200:203], v2 offset:11264
    v_rcp_f32 v192, v192
    v_permlane32_swap_b32 v120, v124
    v_mul_f32 v208, v192, v208
    v_mul_f32 v209, v192, v209
    v_cvt_pk_bf16_f32 v132, v208, v209
    v_mul_f32 v210, v192, v210
    v_mul_f32 v211, v192, v211
    v_cvt_pk_bf16_f32 v133, v210, v211
    v_max_f32 v120, v120, v124
    v_mfma_f32_16x16x32_bf16 v[196:199], v[156:159], v[36:39], 0
    v_mov_b32 v124, v120
    v_mov_b32 v125, v121
    v_mfma_f32_16x16x32_bf16 v[196:199], v[140:143], v[216:219], v[196:199]
    s_waitcnt lgkmcnt(3)
    v_permlane16_swap_b32 v120, v124
    v_max_f32 v120, v120, v124
    v_sub_f32 v242, v242, v120
    v_exp_f32 v242, v242
    v_permlane32_swap_b32 v121, v125
    v_cvt_pk_bf16_f32 v242, v242, v242
    v_max_f32 v121, v121, v125
    v_mul_f32 v196, v192, v196
    v_mul_f32 v197, v192, v197
    v_cvt_pk_bf16_f32 v134, v196, v197
    v_mul_f32 v198, v192, v198
    v_mul_f32 v199, v192, v199
    v_cvt_pk_bf16_f32 v135, v198, v199
    v_mov_b32 v125, v121
    v_fma_f32 v120, v128, v128, s33
    v_fmac_f32 v120, v129, v129
    v_permlane16_swap_b32 v121, v125
    v_max_f32 v121, v121, v125
    v_sub_f32 v220, v220, v121
    v_exp_f32 v220, v220
    v_sub_f32 v221, v221, v121
    v_exp_f32 v221, v221
    v_sub_f32 v222, v222, v121
    v_cvt_pk_bf16_f32 v208, v220, v221
    v_exp_f32 v222, v222
    v_sub_f32 v223, v223, v121
    v_exp_f32 v223, v223
    v_sub_f32 v224, v224, v121
    v_cvt_pk_bf16_f32 v209, v222, v223
    v_mfma_f32_16x16x32_bf16 v[220:223], v[168:171], v[36:39], 0
    s_waitcnt lgkmcnt(0)
    ds_write_b16 v8, v242
    v_mfma_f32_16x16x32_bf16 v[220:223], v[144:147], v[216:219], v[220:223]
    v_exp_f32 v224, v224
    v_mfma_f32_16x16x32_bf16 v[196:199], a[216:219], v[160:163], 0
    ds_write_b128 v3, v[132:135] offset:0
    v_mfma_f32_16x16x32_bf16 v[196:199], a[220:223], v[184:187], v[196:199]
    v_sub_f32 v225, v225, v121
    v_sub_f32 v226, v226, v121
    v_mfma_f32_16x16x32_bf16 v[196:199], a[224:227], v[228:231], v[196:199]
    v_exp_f32 v225, v225
    v_mfma_f32_16x16x32_bf16 v[196:199], a[228:231], v[236:239], v[196:199]
    ds_read_b128 v[240:243], v9
    v_mul_f32 v220, v192, v220
    v_mfma_f32_16x16x32_bf16 v[196:199], a[232:235], v[204:207], v[196:199]
    v_mul_f32 v221, v192, v221
    v_cvt_pk_bf16_f32 v124, v220, v221
    v_mfma_f32_16x16x32_bf16 v[196:199], a[236:239], v[200:203], v[196:199]
    v_mul_f32 v222, v192, v222
    v_mul_f32 v223, v192, v223
    v_cvt_pk_bf16_f32 v125, v222, v223
    v_mfma_f32_16x16x32_bf16 v[132:135], a[240:243], v[160:163], 0
    ds_write_b64 v4, v[124:125] offset:4096
    v_mfma_f32_16x16x32_bf16 v[132:135], a[244:247], v[184:187], v[132:135]
    v_cvt_pk_bf16_f32 v210, v224, v225
    v_sub_f32 v227, v227, v121
    v_mfma_f32_16x16x32_bf16 v[132:135], a[248:251], v[228:231], v[132:135]
    v_exp_f32 v226, v226
    v_mfma_f32_16x16x32_bf16 v[132:135], a[252:255], v[236:239], v[132:135]
    v_exp_f32 v227, v227
    v_mfma_f32_16x16x32_bf16 v[132:135], v[84:87], v[204:207], v[132:135]
    s_waitcnt lgkmcnt(1)
    v_cvt_pk_bf16_f32 v211, v226, v227
    v_sub_f32 v212, v212, v121
    v_mfma_f32_16x16x32_bf16 v[132:135], v[88:91], v[200:203], v[132:135]
    ds_read_b128 v[192:195], v9 offset:64
    v_exp_f32 v212, v212
    v_sub_f32 v213, v213, v121
    v_exp_f32 v213, v213
    v_sub_f32 v214, v214, v121
    v_cvt_pk_bf16_f32 v36, v212, v213
    v_exp_f32 v214, v214
    v_sub_f32 v215, v215, v121
    v_exp_f32 v215, v215
    v_sub_f32 v232, v232, v121
    v_cvt_pk_bf16_f32 v37, v214, v215
    v_mfma_f32_16x16x32_f16 v[220:223], v[148:151], v[180:183], v[72:75]
    v_exp_f32 v232, v232
    v_mfma_f32_16x16x32_f16 v[148:151], v[116:119], v[180:183], v[76:79]
    v_cvt_pk_bf16_f32 v39, v232, 0
    v_fmac_f32 v120, v130, v130
    v_mfma_f32_16x16x32_f16 v[224:227], v[172:175], v[180:183], v[80:83]
    v_fmac_f32 v120, v131, v131
    v_fmac_f32 v120, v188, v188
    v_mfma_f32_16x16x32_bf16 v[180:183], v[28:31], v[36:39], 0
    s_waitcnt lgkmcnt(0)
    v_fmac_f32 v120, v189, v189
    v_fmac_f32 v120, v190, v190
    v_mfma_f32_16x16x32_bf16 v[180:183], v[28:31], v[208:211], v[180:183]
    v_fmac_f32 v120, v191, v191
    v_fmac_f32 v120, v176, v176
    v_mfma_f32_16x16x32_bf16 v[116:119], v[152:155], v[36:39], 0
    v_fmac_f32 v120, v177, v177
    v_fmac_f32 v120, v178, v178
    v_mfma_f32_16x16x32_bf16 v[116:119], v[164:167], v[208:211], v[116:119]
    v_fmac_f32 v120, v179, v179
    v_fma_f32 v121, v196, v196, s33
    v_mfma_f32_16x16x32_bf16 v[172:175], v[156:159], v[36:39], 0
    v_rcp_f32 v180, v180
    v_mfma_f32_16x16x32_bf16 v[172:175], v[140:143], v[208:211], v[172:175]
    v_fmac_f32 v121, v197, v197
    v_fmac_f32 v121, v198, v198
    v_fmac_f32 v121, v199, v199
    v_mfma_f32_16x16x16_f16 v[220:223], v[122:123], v[136:137], v[220:223]
    v_mul_f32 v116, v180, v116
    v_mul_f32 v117, v180, v117
    v_cvt_pk_bf16_f32 v116, v116, v117
    v_mfma_f32_16x16x16_f16 v[148:151], v[126:127], v[136:137], v[148:151]
    v_mul_f32 v118, v180, v118
    v_mul_f32 v119, v180, v119
    v_cvt_pk_bf16_f32 v117, v118, v119
    v_mul_f32 v172, v180, v172
    v_mfma_f32_16x16x32_bf16 v[124:127], v[168:171], v[36:39], 0
    v_max3_f32 v122, v244, v220, v221
    v_max3_f32 v122, v122, v222, v223
    v_mfma_f32_16x16x32_bf16 v[124:127], v[144:147], v[208:211], v[124:127]
    v_max3_f32 v122, v122, v148, v149
    v_max3_f32 v122, v122, v150, v151
    v_mul_f32 v173, v180, v173
    v_mfma_f32_16x16x16_f16 v[224:227], v[138:139], v[136:137], v[224:227]
    v_cvt_pk_bf16_f32 v118, v172, v173
    v_mul_f32 v174, v180, v174
    v_mul_f32 v175, v180, v175
    v_cvt_pk_bf16_f32 v119, v174, v175
    v_mfma_f32_16x16x32_bf16 v[212:215], v[92:95], v[160:163], 0
    ds_read_b128 v[136:139], v2 offset:12288
    v_mul_f32 v124, v180, v124
    v_mfma_f32_16x16x32_bf16 v[212:215], v[96:99], v[184:187], v[212:215]
    ds_read_b128 v[160:163], v2 offset:13312
    v_max3_f32 v122, v122, v224, v225
    v_mfma_f32_16x16x32_bf16 v[212:215], v[100:103], v[228:231], v[212:215]
    ds_read_b128 v[172:175], v2 offset:14336
    v_max3_f32 v122, v122, v226, v227
    v_mfma_f32_16x16x32_bf16 v[212:215], v[104:107], v[236:239], v[212:215]
    ds_read_b128 v[184:187], v2 offset:15360
    v_mov_b32 v123, v122
    v_mfma_f32_16x16x32_bf16 v[212:215], v[108:111], v[204:207], v[212:215]
    ds_read_b128 v[204:207], v2 offset:16384
    v_mul_f32 v125, v180, v125
    v_mfma_f32_16x16x32_bf16 v[212:215], v[112:115], v[200:203], v[212:215]
    ds_read_b128 v[228:231], v2 offset:17408
    v_cvt_pk_bf16_f32 v124, v124, v125
    v_mfma_f32_16x16x32_bf16 v[236:239], v[240:243], v[28:31], 0
    ds_write_b128 v3, v[116:119] offset:6144
    v_mfma_f32_16x16x32_bf16 v[236:239], v[192:195], v[28:31], v[236:239]
    s_waitcnt lgkmcnt(6)
    v_permlane32_swap_b32 v122, v123
    v_mfma_f32_16x16x32_bf16 v[200:203], a[216:219], v[136:139], 0
    s_waitcnt lgkmcnt(5)
    v_max_f32 v122, v122, v123
    v_mov_b32 v123, v122
    v_mfma_f32_16x16x32_bf16 v[200:203], a[220:223], v[160:163], v[200:203]
    s_waitcnt lgkmcnt(4)
    v_rcp_f32 v236, v236
    v_mfma_f32_16x16x32_bf16 v[200:203], a[224:227], v[172:175], v[200:203]
    s_waitcnt lgkmcnt(3)
    v_permlane16_swap_b32 v122, v123
    v_mfma_f32_16x16x32_bf16 v[200:203], a[228:231], v[184:187], v[200:203]
    s_waitcnt lgkmcnt(2)
    v_max_f32 v122, v122, v123
    v_sub_f32 v220, v220, v122
    v_mfma_f32_16x16x32_bf16 v[200:203], a[232:235], v[204:207], v[200:203]
    s_waitcnt lgkmcnt(1)
    v_exp_f32 v220, v220
    v_mfma_f32_16x16x32_bf16 v[200:203], a[236:239], v[228:231], v[200:203]
    v_sub_f32 v221, v221, v122
    v_sub_f32 v222, v222, v122
    v_mfma_f32_16x16x32_bf16 v[216:219], a[240:243], v[136:139], 0
    v_exp_f32 v221, v221
    v_mfma_f32_16x16x32_bf16 v[216:219], a[244:247], v[160:163], v[216:219]
    v_cvt_pk_bf16_f32 v220, v220, v221
    v_sub_f32 v223, v223, v122
    v_mfma_f32_16x16x32_bf16 v[216:219], a[248:251], v[172:175], v[216:219]
    v_exp_f32 v222, v222
    v_mfma_f32_16x16x32_bf16 v[216:219], a[252:255], v[184:187], v[216:219]
    v_exp_f32 v223, v223
    v_mfma_f32_16x16x32_bf16 v[216:219], v[84:87], v[204:207], v[216:219]
    v_cvt_pk_bf16_f32 v221, v222, v223
    v_sub_f32 v148, v148, v122
    v_mfma_f32_16x16x32_bf16 v[216:219], v[88:91], v[228:231], v[216:219]
    v_exp_f32 v148, v148
    v_mfma_f32_16x16x32_bf16 v[208:211], v[92:95], v[136:139], 0
    v_sub_f32 v149, v149, v122
    v_sub_f32 v150, v150, v122
    v_mfma_f32_16x16x32_bf16 v[208:211], v[96:99], v[160:163], v[208:211]
    v_exp_f32 v149, v149
    v_mfma_f32_16x16x32_bf16 v[208:211], v[100:103], v[172:175], v[208:211]
    v_cvt_pk_bf16_f32 v222, v148, v149
    v_sub_f32 v151, v151, v122
    v_mfma_f32_16x16x32_bf16 v[208:211], v[104:107], v[184:187], v[208:211]
    v_exp_f32 v150, v150
    v_mfma_f32_16x16x32_bf16 v[208:211], v[108:111], v[204:207], v[208:211]
    v_exp_f32 v151, v151
    v_mfma_f32_16x16x32_bf16 v[208:211], v[112:115], v[228:231], v[208:211]
    ds_read_b128 v[232:235], v0 offset:20480
    ds_read_b128 v[248:251], v1 offset:20480
    v_mfma_f32_16x16x32_bf16 v[184:187], v[240:243], v[164:167], 0
    ds_read_b128 v[160:163], v0 offset:20608
    ds_read_b128 v[136:139], v1 offset:20608
    v_mfma_f32_16x16x32_bf16 v[184:187], v[192:195], v[152:155], v[184:187]
    v_cvt_pk_bf16_f32 v223, v150, v151
    v_sub_f32 v224, v224, v122
    v_mfma_f32_16x16x32_bf16 v[148:151], v[240:243], v[140:143], 0
    ds_read_b128 v[116:119], v0 offset:20736
    v_sub_f32 v225, v225, v122
    v_mfma_f32_16x16x32_bf16 v[148:151], v[192:195], v[156:159], v[148:151]
    ds_read_b128 v[172:175], v1 offset:20736
    v_exp_f32 v224, v224
    v_mul_f32 v184, v184, v236
    v_exp_f32 v225, v225
    v_sub_f32 v226, v226, v122
    v_cvt_pk_bf16_f32 v36, v224, v225
    v_exp_f32 v226, v226
    v_sub_f32 v227, v227, v122
    v_mul_f32_dpp v184, v148, v236 quad_perm:[0,1,2,3] row_mask:0x2 bank_mask:0xf
    v_mfma_f32_16x16x32_bf16 v[204:207], v[240:243], v[144:147], 0
    s_waitcnt lgkmcnt(4)
    v_exp_f32 v227, v227
    v_mfma_f32_16x16x32_bf16 v[204:207], v[192:195], v[168:171], v[204:207]
    s_waitcnt lgkmcnt(2)
    v_cvt_pk_bf16_f32 v37, v226, v227
    v_sub_f32 v244, v244, v122
    v_mfma_f32_16x16x32_bf16 v[148:151], a[72:75], v[232:235], 0
    v_exp_f32 v244, v244
    v_mfma_f32_16x16x32_bf16 v[148:151], a[76:79], v[248:251], v[148:151]
    s_waitcnt lgkmcnt(1)
    v_cvt_pk_bf16_f32 v39, v244, 0
    v_mul_f32_dpp v184, v204, v236 quad_perm:[0,1,2,3] row_mask:0x4 bank_mask:0xf
    v_mfma_f32_16x16x32_bf16 v[148:151], a[80:83], v[160:163], v[148:151]
    s_waitcnt lgkmcnt(0)
    v_cvt_pk_bf16_f32 v184, v184, v184
    v_mul_f32 v126, v180, v126
    v_mfma_f32_16x16x32_bf16 v[192:195], v[28:31], v[36:39], 0
    ds_write_b16 v7, v184
    v_mfma_f32_16x16x32_bf16 v[192:195], v[28:31], v[220:223], v[192:195]
    v_mul_f32 v127, v180, v127
    v_cvt_pk_bf16_f32 v125, v126, v127
    v_mfma_f32_16x16x32_bf16 v[180:183], v[152:155], v[36:39], 0
    ds_write_b64 v4, v[124:125] offset:10240
    v_mfma_f32_16x16x32_bf16 v[180:183], v[164:167], v[220:223], v[180:183]
    v_fma_f32 v122, v200, v200, s33
    v_fmac_f32 v122, v201, v201
    v_mfma_f32_16x16x32_bf16 v[124:127], v[156:159], v[36:39], 0
    v_rcp_f32 v192, v192
    v_mfma_f32_16x16x32_bf16 v[124:127], v[140:143], v[220:223], v[124:127]
    v_fmac_f32 v122, v202, v202
    v_fmac_f32 v122, v203, v203
    v_mfma_f32_16x16x32_bf16 v[152:155], v[168:171], v[36:39], 0
    v_mul_f32 v180, v192, v180
    v_mul_f32 v181, v192, v181
    v_mfma_f32_16x16x32_bf16 v[152:155], v[144:147], v[220:223], v[152:155]
    v_cvt_pk_bf16_f32 v144, v180, v181
    v_mul_f32 v182, v192, v182
    v_mfma_f32_16x16x32_bf16 v[148:151], a[84:87], v[136:139], v[148:151]
    v_mul_f32 v183, v192, v183
    v_cvt_pk_bf16_f32 v145, v182, v183
    v_mfma_f32_16x16x32_bf16 v[148:151], a[88:91], v[116:119], v[148:151]
    v_mul_f32 v124, v192, v124
    v_mul_f32 v125, v192, v125
    v_mfma_f32_16x16x32_bf16 v[148:151], a[92:95], v[172:175], v[148:151]
    v_cvt_pk_bf16_f32 v146, v124, v125
    v_mul_f32 v126, v192, v126
    v_mfma_f32_16x16x32_bf16 v[140:143], a[96:99], v[232:235], 0
    v_mul_f32 v127, v192, v127
    v_cvt_pk_bf16_f32 v147, v126, v127
    v_mfma_f32_16x16x32_bf16 v[140:143], a[100:103], v[248:251], v[140:143]
    ds_write_b128 v3, v[144:147] offset:12288
    v_mfma_f32_16x16x32_bf16 v[140:143], a[104:107], v[160:163], v[140:143]
    v_mul_f32 v152, v192, v152
    v_mul_f32 v153, v192, v153
    v_mfma_f32_16x16x32_bf16 v[140:143], a[108:111], v[136:139], v[140:143]
    v_cvt_pk_bf16_f32 v152, v152, v153
    v_mul_f32 v154, v192, v154
    v_mfma_f32_16x16x32_bf16 v[140:143], a[112:115], v[116:119], v[140:143]
    v_mul_f32 v155, v192, v155
    v_cvt_pk_bf16_f32 v153, v154, v155
    v_mfma_f32_16x16x32_bf16 v[140:143], a[116:119], v[172:175], v[140:143]
    ds_write_b64 v4, v[152:153] offset:16384
    v_mfma_f32_16x16x32_bf16 v[144:147], a[120:123], v[232:235], 0
    v_fmac_f32 v122, v216, v216
    v_fmac_f32 v122, v217, v217
    v_mfma_f32_16x16x32_bf16 v[144:147], a[124:127], v[248:251], v[144:147]
    v_fmac_f32 v122, v218, v218
    v_fmac_f32 v122, v219, v219
    v_mfma_f32_16x16x32_bf16 v[144:147], a[128:131], v[160:163], v[144:147]
    v_fmac_f32 v122, v208, v208
    v_fmac_f32 v122, v209, v209
    v_mfma_f32_16x16x32_bf16 v[144:147], a[132:135], v[136:139], v[144:147]
    v_fmac_f32 v122, v210, v210
    v_fmac_f32 v122, v211, v211
    v_mfma_f32_16x16x32_bf16 v[144:147], a[136:139], v[116:119], v[144:147]
    v_cvt_pk_bf16_f32 v123, v122, v122
    v_fmac_f32 v121, v132, v132
    v_mfma_f32_16x16x32_bf16 v[144:147], a[140:143], v[172:175], v[144:147]
    v_fmac_f32 v121, v133, v133
    v_fmac_f32 v121, v134, v134
    v_mfma_f32_16x16x32_bf16 v[152:155], a[0:3], v[232:235], 0
    v_fmac_f32 v121, v135, v135
    v_fmac_f32 v121, v212, v212
    v_mfma_f32_16x16x32_bf16 v[152:155], a[4:7], v[248:251], v[152:155]
    v_fmac_f32 v121, v213, v213
    v_fmac_f32 v121, v214, v214
    v_mfma_f32_16x16x32_bf16 v[152:155], a[8:11], v[160:163], v[152:155]
    v_fmac_f32 v121, v215, v215
    v_cvt_pk_bf16_f32 v122, v120, v121
    v_mfma_f32_16x16x32_bf16 v[152:155], a[12:15], v[136:139], v[152:155]
    ds_write_b64 v4, v[122:123] offset:18432
    v_mfma_f32_16x16x32_bf16 v[152:155], a[16:19], v[116:119], v[152:155]
    v_add_u32 v7, s76, v7
    v_fma_f32 v164, v148, v148, s32
    v_mfma_f32_16x16x32_bf16 v[152:155], a[20:23], v[172:175], v[152:155]
    v_fmac_f32 v164, v149, v149
    v_fmac_f32 v164, v150, v150
    v_mfma_f32_16x16x32_bf16 v[156:159], a[24:27], v[232:235], 0
    v_fmac_f32 v164, v151, v151
    v_fmac_f32 v164, v140, v140
    v_mfma_f32_16x16x32_bf16 v[156:159], a[28:31], v[248:251], v[156:159]
    v_fmac_f32 v164, v141, v141
    v_fmac_f32 v164, v142, v142
    v_mfma_f32_16x16x32_bf16 v[156:159], a[32:35], v[160:163], v[156:159]
    v_fmac_f32 v164, v143, v143
    v_xor_b32 v2, 65536, v2
    v_mfma_f32_16x16x32_bf16 v[156:159], a[36:39], v[136:139], v[156:159]
    v_xor_b32 v3, 65536, v3
    v_xor_b32 v4, 65536, v4
    v_mfma_f32_16x16x32_bf16 v[156:159], a[40:43], v[116:119], v[156:159]
    s_waitcnt lgkmcnt(0)
    s_nop 0
    s_nop 0
    s_barrier
    s_nop 0
    v_mfma_f32_16x16x32_bf16 v[156:159], a[44:47], v[172:175], v[156:159]
    s_cbranch_scc1 L_loop_safe2
    s_branch L_final_safe
.p2align 6
L_loop_safe3:
    v_mfma_f32_16x16x32_bf16 v[124:127], a[48:51], v[232:235], 0
    s_add_u32 s12, s40, s27
    ds_read_b128 v[120:123], v2 offset:18432
    ds_read_b128 v[168:171], v2 offset:19456
    v_mfma_f32_16x16x32_bf16 v[124:127], a[52:55], v[248:251], v[124:127]
    s_addc_u32 s13, s41, 0
    v_fmac_f32 v164, v144, v144
    v_fmac_f32 v164, v145, v145
    v_mfma_f32_16x16x32_bf16 v[124:127], a[56:59], v[160:163], v[124:127]
    s_sub_u32 s14, s36, s27
    v_fmac_f32 v164, v146, v146
    v_fmac_f32 v164, v147, v147
    v_mfma_f32_16x16x32_bf16 v[124:127], a[60:63], v[136:139], v[124:127]
    s_cmp_ge_u32 s18, 2
    v_fma_f32 v165, v152, v152, s32
    v_fmac_f32 v165, v153, v153
    v_mfma_f32_16x16x32_bf16 v[124:127], a[64:67], v[116:119], v[124:127]
    s_cselect_b32 s14, s14, 0
    v_fmac_f32 v165, v154, v154
    v_fmac_f32 v165, v155, v155
    v_mfma_f32_16x16x32_bf16 v[124:127], a[68:71], v[172:175], v[124:127]
    s_sub_u32 s82, s72, s71
    v_fmac_f32 v165, v156, v156
    v_fmac_f32 v165, v157, v157
    v_mfma_f32_16x16x32_bf16 v[180:183], v[232:235], a[144:147], 0
    s_mul_i32 s74, s82, 336
    v_fmac_f32 v165, v158, v158
    v_fmac_f32 v165, v159, v159
    v_mfma_f32_16x16x32_bf16 v[180:183], v[248:251], a[148:151], v[180:183]
    s_mul_i32 s75, s82, 272
    v_fmac_f32 v165, v124, v124
    v_fmac_f32 v165, v125, v125
    v_mfma_f32_16x16x32_bf16 v[180:183], v[160:163], a[152:155], v[180:183]
    s_waitcnt lgkmcnt(0)
    v_fmac_f32 v165, v126, v126
    v_fmac_f32 v165, v127, v127
    v_mfma_f32_16x16x32_bf16 v[184:187], v[32:35], v[120:123], 0
    s_mul_i32 s76, s82, 16
    v_cvt_pk_bf16_f32 v36, v165, v164
    s_add_u32 s34, s18, 2
    v_mfma_f32_16x16x32_bf16 v[184:187], v[32:35], v[168:171], v[184:187]
    s_add_u32 s8, s60, s23
    s_addc_u32 s9, s61, 0
    s_sub_u32 s10, s36, s23
    v_mfma_f32_16x16x32_bf16 v[168:171], v[32:35], v[36:39], 0
    s_cmp_le_u32 s34, s45
    s_cselect_b32 s10, s10, 0
    s_add_u32 m0, s28, 0
    v_mfma_f32_16x16x32_bf16 v[180:183], v[136:139], a[156:159], v[180:183]
    s_mov_b32 s27, s26
    v_mul_f32 v166, 0x3baaaaab, v184
    v_mul_f32 v184, 0x3baaaaab, v185
    v_mfma_f32_16x16x32_bf16 v[180:183], v[116:119], a[160:163], v[180:183]
    s_mov_b32 s26, s25
    v_rsq_f32 v169, v169
    v_mfma_f32_16x16x32_bf16 v[180:183], v[172:175], a[164:167], v[180:183]
    s_mov_b32 s25, s24
    v_rsq_f32 v168, v168
    v_mfma_f32_16x16x32_bf16 v[120:123], v[232:235], a[168:171], 0
    s_mov_b32 s24, s23
    v_mul_f32 v168, s31, v168
    v_mul_f32 v148, v169, v148
    v_mfma_f32_16x16x32_bf16 v[120:123], v[248:251], a[172:175], v[120:123]
    s_ff1_i32_b32 s80, s100
    v_cvt_pk_bf16_f32 v164, v180, v181
    v_cvt_pk_bf16_f32 v165, v182, v183
    v_mfma_f32_16x16x32_bf16 v[120:123], v[160:163], a[176:179], v[120:123]
    s_mov_b32 s71, s72
    ds_read_b128 v[180:183], v0 offset:26624
    v_mul_f32 v149, v169, v149
    v_mfma_f32_16x16x32_bf16 v[120:123], v[136:139], a[180:183], v[120:123]
    s_mov_b32 s72, s73
    ds_read_b128 v[192:195], v1 offset:26624
    v_cvt_pk_f16_f32 v148, v148, v149
    v_mfma_f32_16x16x32_bf16 v[120:123], v[116:119], a[184:187], v[120:123]
    ds_read_b128 v[204:207], v0 offset:26752
    v_mul_f32 v150, v169, v150
    v_mfma_f32_16x16x32_bf16 v[120:123], v[172:175], a[188:191], v[120:123]
    ds_read_b128 v[220:223], v1 offset:26752
    v_mul_f32 v151, v169, v151
    v_cvt_pk_f16_f32 v149, v150, v151
    v_mul_f32 v140, v169, v140
    v_mul_f32 v141, v169, v141
    v_cvt_pk_f16_f32 v150, v140, v141
    v_mfma_f32_16x16x32_bf16 v[224:227], v[232:235], a[192:195], 0
    ds_read_b128 v[228:231], v0 offset:26880
    v_cvt_pk_bf16_f32 v140, v120, v121
    v_mfma_f32_16x16x32_bf16 v[224:227], v[248:251], a[196:199], v[224:227]
    ds_read_b128 v[232:235], v1 offset:26880
    v_cvt_pk_bf16_f32 v141, v122, v123
    v_mfma_f32_16x16x32_bf16 v[224:227], v[160:163], a[200:203], v[224:227]
    v_mul_f32 v142, v169, v142
    v_mul_f32 v143, v169, v143
    v_mfma_f32_16x16x32_bf16 v[224:227], v[136:139], a[204:207], v[224:227]
    s_waitcnt lgkmcnt(5)
    v_cvt_pk_f16_f32 v151, v142, v143
    v_mul_f32 v144, v169, v144
    v_mfma_f32_16x16x32_bf16 v[224:227], v[116:119], a[208:211], v[224:227]
    s_waitcnt lgkmcnt(4)
    v_mul_f32 v145, v169, v145
    v_cvt_pk_f16_f32 v122, v144, v145
    v_mfma_f32_16x16x32_bf16 v[224:227], v[172:175], a[212:215], v[224:227]
    s_waitcnt lgkmcnt(3)
    v_mul_f32 v146, v169, v146
    v_mul_f32 v147, v169, v147
    v_mfma_f32_16x16x32_bf16 v[116:119], a[72:75], v[180:183], 0
    s_waitcnt lgkmcnt(2)
    v_cvt_pk_f16_f32 v123, v146, v147
    v_mul_f32 v152, v168, v152
    v_mfma_f32_16x16x32_bf16 v[116:119], a[76:79], v[192:195], v[116:119]
    v_cvt_pk_bf16_f32 v144, v224, v225
    v_cvt_pk_bf16_f32 v145, v226, v227
    v_mfma_f32_16x16x32_bf16 v[116:119], a[80:83], v[204:207], v[116:119]
    s_waitcnt lgkmcnt(1)
    v_mul_f32 v153, v168, v153
    v_cvt_pk_f16_f32 v244, v152, v153
    v_mfma_f32_16x16x32_bf16 v[116:119], a[84:87], v[220:223], v[116:119]
    s_waitcnt lgkmcnt(0)
    v_mul_f32 v154, v168, v154
    v_mul_f32 v155, v168, v155
    v_mfma_f32_16x16x32_bf16 v[116:119], a[88:91], v[228:231], v[116:119]
    v_cvt_pk_f16_f32 v245, v154, v155
    v_mul_f32 v156, v168, v156
    v_mfma_f32_16x16x32_bf16 v[116:119], a[92:95], v[232:235], v[116:119]
    v_mul_f32 v157, v168, v157
    v_cvt_pk_f16_f32 v246, v156, v157
    v_mfma_f32_16x16x32_bf16 v[136:139], a[96:99], v[180:183], 0
    v_mul_f32 v158, v168, v158
    v_mul_f32 v159, v168, v159
    v_mfma_f32_16x16x32_bf16 v[136:139], a[100:103], v[192:195], v[136:139]
    v_cvt_pk_f16_f32 v247, v158, v159
    v_mul_f32 v124, v168, v124
    v_mfma_f32_16x16x32_bf16 v[136:139], a[104:107], v[204:207], v[136:139]
    v_mul_f32 v125, v168, v125
    v_cvt_pk_f16_f32 v120, v124, v125
    v_mfma_f32_16x16x32_bf16 v[136:139], a[108:111], v[220:223], v[136:139]
    v_mul_f32 v126, v168, v126
    v_mul_f32 v127, v168, v127
    v_mfma_f32_16x16x32_bf16 v[136:139], a[112:115], v[228:231], v[136:139]
    v_cvt_pk_f16_f32 v121, v126, v127
    v_fma_f32 v167, v116, v116, s32
    v_mfma_f32_16x16x32_bf16 v[136:139], a[116:119], v[232:235], v[136:139]
    v_fmac_f32 v167, v117, v117
    v_fmac_f32 v167, v118, v118
    v_mfma_f32_16x16x32_bf16 v[152:155], a[120:123], v[180:183], 0
    v_fmac_f32 v167, v119, v119
    v_mul_f32 v142, 0x3baaaaab, v186
    v_mfma_f32_16x16x32_bf16 v[152:155], a[124:127], v[192:195], v[152:155]
    v_rsq_f32 v166, v166
    v_mfma_f32_16x16x32_bf16 v[152:155], a[128:131], v[204:207], v[152:155]
    v_fmac_f32 v167, v136, v136
    v_fmac_f32 v167, v137, v137
    v_mfma_f32_16x16x32_bf16 v[152:155], a[132:135], v[220:223], v[152:155]
    v_fmac_f32 v167, v138, v138
    v_fmac_f32 v167, v139, v139
    v_mfma_f32_16x16x32_bf16 v[152:155], a[136:139], v[228:231], v[152:155]
    v_rsq_f32 v184, v184
    v_mfma_f32_16x16x32_bf16 v[152:155], a[140:143], v[232:235], v[152:155]
    v_rsq_f32 v142, v142
    v_mfma_f32_16x16x32_bf16 v[156:159], a[0:3], v[180:183], 0
    v_mul_f32 v128, v166, v128
    v_mul_f32 v129, v166, v129
    v_mfma_f32_16x16x32_bf16 v[156:159], a[4:7], v[192:195], v[156:159]
    v_cvt_pk_bf16_f32 v124, v128, v129
    v_mul_f32 v130, v166, v130
    v_mfma_f32_16x16x32_bf16 v[156:159], a[8:11], v[204:207], v[156:159]
    v_fmac_f32 v167, v152, v152
    v_fmac_f32 v167, v153, v153
    v_mfma_f32_16x16x32_bf16 v[156:159], a[12:15], v[220:223], v[156:159]
    v_fmac_f32 v167, v154, v154
    v_fmac_f32 v167, v155, v155
    v_mfma_f32_16x16x32_bf16 v[156:159], a[16:19], v[228:231], v[156:159]
    v_mul_f32 v131, v166, v131
    v_cvt_pk_bf16_f32 v125, v130, v131
    v_mfma_f32_16x16x32_bf16 v[156:159], a[20:23], v[232:235], v[156:159]
    v_mul_f32 v188, v166, v188
    v_mul_f32 v189, v166, v189
    v_mfma_f32_16x16x32_bf16 v[168:171], a[24:27], v[180:183], 0
    v_cvt_pk_bf16_f32 v126, v188, v189
    v_mul_f32 v190, v166, v190
    v_mfma_f32_16x16x32_bf16 v[168:171], a[28:31], v[192:195], v[168:171]
    v_mul_f32 v191, v166, v191
    v_cvt_pk_bf16_f32 v127, v190, v191
    v_mfma_f32_16x16x32_bf16 v[168:171], a[32:35], v[204:207], v[168:171]
    buffer_store_dwordx4 v[124:127], v15, s[12:15], 0 offen nt
    v_fma_f32 v143, v156, v156, s32
    v_fmac_f32 v143, v157, v157
    v_fmac_f32 v143, v158, v158
    v_fmac_f32 v143, v159, v159
    v_mfma_f32_16x16x32_bf16 v[168:171], a[36:39], v[220:223], v[168:171]
    v_mul_f32 v176, v166, v176
    v_mul_f32 v177, v166, v177
    v_mfma_f32_16x16x32_bf16 v[168:171], a[40:43], v[228:231], v[168:171]
    v_cvt_pk_bf16_f32 v146, v176, v177
    v_mul_f32 v178, v166, v178
    v_mfma_f32_16x16x32_bf16 v[168:171], a[44:47], v[232:235], v[168:171]
    v_mul_f32 v179, v166, v179
    v_cvt_pk_bf16_f32 v147, v178, v179
    v_mfma_f32_16x16x32_bf16 v[172:175], a[48:51], v[180:183], 0
    v_mul_f32 v200, v142, v200
    v_mul_f32 v201, v142, v201
    v_mfma_f32_16x16x32_bf16 v[172:175], a[52:55], v[192:195], v[172:175]
    v_cvt_pk_bf16_f32 v124, v200, v201
    v_mul_f32 v202, v142, v202
    v_mfma_f32_16x16x32_bf16 v[172:175], a[56:59], v[204:207], v[172:175]
    v_fmac_f32 v143, v168, v168
    v_fmac_f32 v143, v169, v169
    v_mfma_f32_16x16x32_bf16 v[172:175], a[60:63], v[220:223], v[172:175]
    v_fmac_f32 v143, v170, v170
    v_fmac_f32 v143, v171, v171
    v_mfma_f32_16x16x32_bf16 v[172:175], a[64:67], v[228:231], v[172:175]
    v_mul_f32 v203, v142, v203
    v_cvt_pk_bf16_f32 v125, v202, v203
    v_mfma_f32_16x16x32_bf16 v[172:175], a[68:71], v[232:235], v[172:175]
    v_mul_f32 v216, v142, v216
    v_mul_f32 v217, v142, v217
    v_mfma_f32_16x16x32_bf16 v[128:131], v[180:183], a[144:147], 0
    v_cvt_pk_bf16_f32 v126, v216, v217
    v_mul_f32 v218, v142, v218
    v_mfma_f32_16x16x32_bf16 v[128:131], v[192:195], a[148:151], v[128:131]
    v_mul_f32 v219, v142, v219
    v_cvt_pk_bf16_f32 v127, v218, v219
    v_mfma_f32_16x16x32_bf16 v[128:131], v[204:207], a[152:155], v[128:131]
    v_fmac_f32 v143, v172, v172
    v_fmac_f32 v143, v173, v173
    v_mfma_f32_16x16x32_bf16 v[128:131], v[220:223], a[156:159], v[128:131]
    v_fmac_f32 v143, v174, v174
    v_fmac_f32 v143, v175, v175
    v_mfma_f32_16x16x32_bf16 v[128:131], v[228:231], a[160:163], v[128:131]
    v_cvt_pk_bf16_f32 v36, v143, v167
    v_mul_f32 v208, v142, v208
    v_mfma_f32_16x16x32_bf16 v[128:131], v[232:235], a[164:167], v[128:131]
    v_mul_f32 v209, v142, v209
    v_cvt_pk_bf16_f32 v186, v208, v209
    v_mfma_f32_16x16x32_bf16 v[176:179], v[32:35], v[36:39], 0
    v_mul_f32 v210, v142, v210
    v_mul_f32 v211, v142, v211
    v_mfma_f32_16x16x32_bf16 v[160:163], v[180:183], a[168:171], 0
    buffer_store_dwordx2 v[146:147], v18, s[12:15], 0 offen nt
    v_cvt_pk_bf16_f32 v187, v210, v211
    v_cvt_pk_bf16_f32 v166, v128, v129
    v_mfma_f32_16x16x32_bf16 v[160:163], v[192:195], a[172:175], v[160:163]
    v_cvt_pk_bf16_f32 v167, v130, v131
    v_mul_f32 v196, v184, v196
    v_mfma_f32_16x16x32_bf16 v[160:163], v[204:207], a[176:179], v[160:163]
    ds_read_b128 v[200:203], v0 offset:32768
    v_mul_f32 v197, v184, v197
    v_mfma_f32_16x16x32_bf16 v[160:163], v[220:223], a[180:183], v[160:163]
    ds_read_b128 v[208:211], v1 offset:32768
    v_cvt_pk_bf16_f32 v128, v196, v197
    v_mfma_f32_16x16x32_bf16 v[160:163], v[228:231], a[184:187], v[160:163]
    ds_read_b128 v[216:219], v0 offset:32896
    v_mul_f32 v198, v184, v198
    v_mfma_f32_16x16x32_bf16 v[160:163], v[232:235], a[188:191], v[160:163]
    ds_read_b128 v[224:227], v1 offset:32896
    v_mul_f32 v199, v184, v199
    v_mfma_f32_16x16x32_bf16 v[188:191], v[180:183], a[192:195], 0
    ds_read_b128 v[180:183], v0 offset:33024
    v_cvt_pk_bf16_f32 v129, v198, v199
    v_mfma_f32_16x16x32_bf16 v[188:191], v[192:195], a[196:199], v[188:191]
    ds_read_b128 v[192:195], v1 offset:33024
    v_mul_f32 v132, v184, v132
    v_mfma_f32_16x16x32_bf16 v[188:191], v[204:207], a[200:203], v[188:191]
    v_rsq_f32 v177, v177
    v_mfma_f32_16x16x32_bf16 v[188:191], v[220:223], a[204:207], v[188:191]
    v_rsq_f32 v176, v176
    v_mfma_f32_16x16x32_bf16 v[188:191], v[228:231], a[208:211], v[188:191]
    s_waitcnt lgkmcnt(5)
    v_mul_f32 v176, s31, v176
    v_cvt_pk_bf16_f32 v142, v160, v161
    v_mfma_f32_16x16x32_bf16 v[188:191], v[232:235], a[212:215], v[188:191]
    s_waitcnt lgkmcnt(4)
    v_cvt_pk_bf16_f32 v143, v162, v163
    v_mul_f32 v116, v177, v116
    v_mfma_f32_16x16x32_bf16 v[196:199], a[72:75], v[200:203], 0
    s_waitcnt lgkmcnt(3)
    v_mul_f32 v117, v177, v117
    v_cvt_pk_f16_f32 v116, v116, v117
    v_mfma_f32_16x16x32_bf16 v[196:199], a[76:79], v[208:211], v[196:199]
    s_waitcnt lgkmcnt(2)
    v_cvt_pk_bf16_f32 v146, v188, v189
    v_cvt_pk_bf16_f32 v147, v190, v191
    v_mfma_f32_16x16x32_bf16 v[196:199], a[80:83], v[216:219], v[196:199]
    s_waitcnt lgkmcnt(1)
    v_mul_f32 v118, v177, v118
    v_mul_f32 v119, v177, v119
    v_mfma_f32_16x16x32_bf16 v[196:199], a[84:87], v[224:227], v[196:199]
    s_waitcnt lgkmcnt(0)
    v_cvt_pk_f16_f32 v117, v118, v119
    v_mul_f32 v136, v177, v136
    v_mfma_f32_16x16x32_bf16 v[196:199], a[88:91], v[180:183], v[196:199]
    v_mul_f32 v137, v177, v137
    v_cvt_pk_f16_f32 v118, v136, v137
    v_mfma_f32_16x16x32_bf16 v[196:199], a[92:95], v[192:195], v[196:199]
    buffer_store_dwordx4 v[124:127], v17, s[12:15], 0 offen nt
    v_mul_f32 v138, v177, v138
    v_mul_f32 v139, v177, v139
    v_cvt_pk_f16_f32 v119, v138, v139
    v_mul_f32 v152, v177, v152
    v_mfma_f32_16x16x32_bf16 v[136:139], a[96:99], v[200:203], 0
    v_mul_f32 v153, v177, v153
    v_cvt_pk_f16_f32 v126, v152, v153
    v_mfma_f32_16x16x32_bf16 v[136:139], a[100:103], v[208:211], v[136:139]
    v_mul_f32 v154, v177, v154
    v_mul_f32 v155, v177, v155
    v_mfma_f32_16x16x32_bf16 v[136:139], a[104:107], v[216:219], v[136:139]
    v_cvt_pk_f16_f32 v127, v154, v155
    v_mul_f32 v156, v176, v156
    v_mfma_f32_16x16x32_bf16 v[136:139], a[108:111], v[224:227], v[136:139]
    v_mul_f32 v157, v176, v157
    v_cvt_pk_f16_f32 v160, v156, v157
    v_mfma_f32_16x16x32_bf16 v[136:139], a[112:115], v[180:183], v[136:139]
    s_waitcnt vmcnt(3)
    ds_write_b16 v8, v46 offset:512
    v_mfma_f32_16x16x32_bf16 v[136:139], a[116:119], v[192:195], v[136:139]
    s_nop 0
    v_mul_f32 v158, v176, v158
    v_mfma_f32_16x16x32_bf16 v[204:207], a[120:123], v[200:203], 0
    v_mul_f32 v159, v176, v159
    v_cvt_pk_f16_f32 v161, v158, v159
    v_mfma_f32_16x16x32_bf16 v[204:207], a[124:127], v[208:211], v[204:207]
    v_mul_f32 v168, v176, v168
    v_mul_f32 v169, v176, v169
    v_mfma_f32_16x16x32_bf16 v[204:207], a[128:131], v[216:219], v[204:207]
    v_cvt_pk_f16_f32 v162, v168, v169
    v_mul_f32 v170, v176, v170
    v_mfma_f32_16x16x32_bf16 v[204:207], a[132:135], v[224:227], v[204:207]
    v_mul_f32 v171, v176, v171
    v_cvt_pk_f16_f32 v163, v170, v171
    v_mfma_f32_16x16x32_bf16 v[204:207], a[136:139], v[180:183], v[204:207]
    v_mul_f32 v172, v176, v172
    v_mul_f32 v173, v176, v173
    v_mfma_f32_16x16x32_bf16 v[204:207], a[140:143], v[192:195], v[204:207]
    v_cvt_pk_f16_f32 v124, v172, v173
    v_mul_f32 v174, v176, v174
    v_mfma_f32_16x16x32_bf16 v[236:239], a[0:3], v[200:203], 0
    s_waitcnt lgkmcnt(0)
    v_mul_f32 v175, v176, v175
    v_cvt_pk_f16_f32 v125, v174, v175
    v_mfma_f32_16x16x32_bf16 v[236:239], a[4:7], v[208:211], v[236:239]
    s_nop 0
    v_fma_f32 v185, v196, v196, s32
    v_fmac_f32 v185, v197, v197
    v_mfma_f32_16x16x32_bf16 v[236:239], a[8:11], v[216:219], v[236:239]
    s_nop 0
    v_fmac_f32 v185, v198, v198
    v_fmac_f32 v185, v199, v199
    v_mfma_f32_16x16x32_bf16 v[236:239], a[12:15], v[224:227], v[236:239]
    s_nop 0
    v_fmac_f32 v185, v136, v136
    v_fmac_f32 v185, v137, v137
    v_mfma_f32_16x16x32_bf16 v[236:239], a[16:19], v[180:183], v[236:239]
    s_barrier
    buffer_load_dwordx4 v10, s[8:11], 0 offen nt lds
    ds_read_u16 v131, v9 offset:128
    v_mfma_f32_16x16x32_bf16 v[236:239], a[20:23], v[192:195], v[236:239]
    s_add_u32 m0, s28, 4096
    v_fmac_f32 v185, v138, v138
    v_fmac_f32 v185, v139, v139
    v_mfma_f32_16x16x32_bf16 v[176:179], a[24:27], v[200:203], 0
    v_fmac_f32 v185, v204, v204
    v_fmac_f32 v185, v205, v205
    v_mfma_f32_16x16x32_bf16 v[176:179], a[28:31], v[208:211], v[176:179]
    v_fmac_f32 v185, v206, v206
    v_fma_f32 v152, v236, v236, s32
    v_mfma_f32_16x16x32_bf16 v[176:179], a[32:35], v[216:219], v[176:179]
    v_fmac_f32 v152, v237, v237
    v_fmac_f32 v152, v238, v238
    v_mfma_f32_16x16x32_bf16 v[176:179], a[36:39], v[224:227], v[176:179]
    buffer_load_dwordx4 v11, s[8:11], 0 offen nt lds
    v_fmac_f32 v152, v239, v239
    v_mfma_f32_16x16x32_bf16 v[176:179], a[40:43], v[180:183], v[176:179]
    s_add_u32 m0, s28, 8192
    v_fmac_f32 v185, v207, v207
    v_mul_f32 v133, v184, v133
    v_mfma_f32_16x16x32_bf16 v[176:179], a[44:47], v[192:195], v[176:179]
    v_cvt_pk_bf16_f32 v130, v132, v133
    v_mul_f32 v134, v184, v134
    v_mfma_f32_16x16x32_bf16 v[188:191], a[48:51], v[200:203], 0
    s_waitcnt lgkmcnt(0)
    v_readfirstlane_b32 s77, v131
    v_mul_f32 v135, v184, v135
    v_mfma_f32_16x16x32_bf16 v[188:191], a[52:55], v[208:211], v[188:191]
    v_cvt_pk_bf16_f32 v131, v134, v135
    v_fmac_f32 v152, v176, v176
    v_mfma_f32_16x16x32_bf16 v[188:191], a[56:59], v[216:219], v[188:191]
    buffer_load_dwordx4 v12, s[8:11], 0 offen nt lds
    v_fmac_f32 v152, v177, v177
    v_mfma_f32_16x16x32_bf16 v[188:191], a[60:63], v[224:227], v[188:191]
    s_add_u32 m0, s28, 12288
    v_fmac_f32 v152, v178, v178
    v_fmac_f32 v152, v179, v179
    v_mfma_f32_16x16x32_bf16 v[188:191], a[64:67], v[180:183], v[188:191]
    s_xor_b32 s28, s28, 65536
    ds_read2_b32 v[154:155], v6 offset0:0 offset1:0
    ds_read2_b32 v[158:159], v6 offset0:16 offset1:16
    v_mfma_f32_16x16x32_bf16 v[188:191], a[68:71], v[192:195], v[188:191]
    ds_read2_b32 v[170:171], v6 offset0:32 offset1:32
    v_mul_f32 v212, v184, v212
    v_mfma_f32_16x16x32_bf16 v[132:135], v[200:203], a[144:147], 0
    v_mul_f32 v213, v184, v213
    v_cvt_pk_bf16_f32 v240, v212, v213
    v_mfma_f32_16x16x32_bf16 v[132:135], v[208:211], a[148:151], v[132:135]
    buffer_load_dwordx4 v13, s[8:11], 0 offen nt lds
    v_mul_f32 v214, v184, v214
    v_mfma_f32_16x16x32_bf16 v[132:135], v[216:219], a[152:155], v[132:135]
    s_mov_b32 m0, s29
    v_fmac_f32 v152, v188, v188
    v_fmac_f32 v152, v189, v189
    v_mfma_f32_16x16x32_bf16 v[132:135], v[224:227], a[156:159], v[132:135]
    s_xor_b32 s29, s29, s30
    v_fmac_f32 v152, v190, v190
    v_fmac_f32 v152, v191, v191
    v_mfma_f32_16x16x32_bf16 v[132:135], v[180:183], a[160:163], v[132:135]
    s_add_u32 s19, s19, s20
    v_cvt_pk_bf16_f32 v36, v152, v185
    v_mul_f32 v215, v184, v215
    v_mfma_f32_16x16x32_bf16 v[132:135], v[192:195], a[164:167], v[132:135]
    s_add_u32 s23, s23, s21
    v_cvt_pk_bf16_f32 v241, v214, v215
    v_xor_b32 v0, 65536, v0
    v_mfma_f32_16x16x32_bf16 v[232:235], v[32:35], v[36:39], 0
    s_cmp_ge_u32 s19, 72
    buffer_load_dwordx4 v14, s[8:11], 0 offen nt lds
    v_xor_b32 v1, 65536, v1
    v_mfma_f32_16x16x32_bf16 v[212:215], v[200:203], a[168:171], 0
    s_cselect_b32 s34, 72, 0
    v_cvt_pk_bf16_f32 v152, v132, v133
    v_cvt_pk_bf16_f32 v153, v134, v135
    v_mfma_f32_16x16x32_bf16 v[212:215], v[208:211], a[172:175], v[212:215]
    s_cselect_b32 s35, s22, 0
    v_rsq_f32 v233, v233
    v_mfma_f32_16x16x32_bf16 v[212:215], v[216:219], a[176:179], v[212:215]
    s_sub_u32 s19, s19, s34
    v_rsq_f32 v232, v232
    v_mfma_f32_16x16x32_bf16 v[212:215], v[224:227], a[180:183], v[212:215]
    s_add_u32 s23, s23, s35
    v_mul_f32 v232, s31, v232
    v_mul_f32 v196, v233, v196
    v_mfma_f32_16x16x32_bf16 v[212:215], v[180:183], a[184:187], v[212:215]
    s_cmp_lg_u32 s83, 0
    buffer_store_dwordx2 v[186:187], v20, s[12:15], 0 offen nt
    v_mul_f32 v197, v233, v197
    v_cvt_pk_f16_f32 v172, v196, v197
    v_mfma_f32_16x16x32_bf16 v[212:215], v[192:195], a[188:191], v[212:215]
    s_cselect_b32 s77, s80, s77
    v_mul_f32 v198, v233, v198
    v_mul_f32 v199, v233, v199
    v_mfma_f32_16x16x32_bf16 v[248:251], v[200:203], a[192:195], 0
    s_mul_i32 s78, s77, 2688
    v_cvt_pk_f16_f32 v173, v198, v199
    v_mul_f32 v136, v233, v136
    v_mfma_f32_16x16x32_bf16 v[248:251], v[208:211], a[196:199], v[248:251]
    s_add_u32 s78, s78, s69
    v_cvt_pk_bf16_f32 v156, v212, v213
    v_cvt_pk_bf16_f32 v157, v214, v215
    v_mfma_f32_16x16x32_bf16 v[248:251], v[216:219], a[200:203], v[248:251]
    s_add_u32 s80, s77, s68
    ds_read_b128 v[228:231], v5 offset:0
    ds_read_b128 v[220:223], v5 offset:16
    v_mfma_f32_16x16x32_bf16 v[248:251], v[224:227], a[204:207], v[248:251]
    s_cmp_ge_u32 s80, 72
    ds_read_b128 v[224:227], v5 offset:48
    ds_read_b32 v242, v6 offset:192
    v_mfma_f32_16x16x32_bf16 v[248:251], v[180:183], a[208:211], v[248:251]
    s_cselect_b32 s80, s22, 0
    v_mul_f32 v137, v233, v137
    v_cvt_pk_f16_f32 v174, v136, v137
    v_mfma_f32_16x16x32_bf16 v[248:251], v[192:195], a[212:215], v[248:251]
    s_add_u32 s78, s78, s80
    ds_read_b128 v[192:195], v2 offset:0
    ds_read_b128 v[184:187], v2 offset:1024
    v_mfma_f32_16x16x32_f16 v[216:219], v[148:151], v[244:247], v[48:51]
    s_add_u32 s80, s77, 20
    ds_read_b128 v[132:135], v2 offset:2048
    v_mul_f32 v138, v233, v138
    v_mfma_f32_16x16x32_f16 v[212:215], v[116:119], v[244:247], v[52:55]
    s_add_u32 s34, s18, 3
    v_cvt_pk_bf16_f32 v168, v248, v249
    v_cvt_pk_bf16_f32 v169, v250, v251
    v_mul_f32 v139, v233, v139
    v_mfma_f32_16x16x16_f16 v[216:219], v[122:123], v[120:121], v[216:219]
    v_cvt_pk_f16_f32 v175, v138, v139
    v_mul_f32 v204, v233, v204
    v_mul_f32 v205, v233, v205
    v_mfma_f32_16x16x16_f16 v[212:215], v[126:127], v[120:121], v[212:215]
    v_cvt_pk_f16_f32 v138, v204, v205
    v_mul_f32 v206, v233, v206
    v_mul_f32 v207, v233, v207
    v_cvt_pk_f16_f32 v139, v206, v207
    v_mfma_f32_16x16x32_f16 v[208:211], v[172:175], v[244:247], v[56:59]
    s_cmp_lt_u32 s77, s62
    v_mul_f32 v236, v232, v236
    v_mul_f32 v237, v232, v237
    v_cvt_pk_f16_f32 v180, v236, v237
    v_mul_f32 v238, v232, v238
    v_mul_f32 v239, v232, v239
    v_mfma_f32_16x16x16_f16 v[208:211], v[138:139], v[120:121], v[208:211]
    v_cvt_pk_f16_f32 v181, v238, v239
    v_mul_f32 v176, v232, v176
    v_mul_f32 v177, v232, v177
    s_waitcnt lgkmcnt(1)
    v_mfma_f32_16x16x32_f16 v[236:239], v[228:231], v[244:247], v[22:25]
    s_cselect_b32 s79, 1, 0
    ds_read_b128 v[196:199], v2 offset:3072
    v_cvt_pk_f16_f32 v182, v176, v177
    v_mfma_f32_16x16x32_f16 v[236:239], v[220:223], v[148:151], v[236:239]
    s_cselect_b32 s78, s78, 0
    v_mul_f32 v178, v232, v178
    v_mul_f32 v179, v232, v179
    v_mfma_f32_16x16x32_f16 v[236:239], v[224:227], v[120:123], v[236:239]
    s_cmp_lt_u32 s34, s17
    ds_read_b128 v[204:207], v2 offset:4096
    buffer_store_dwordx4 v[128:131], v16, s[12:15], 0 offen nt
    ds_read_b128 v[200:203], v2 offset:5120
    v_cvt_pk_f16_f32 v183, v178, v179
    v_mul_f32 v188, v232, v188
    v_mul_f32 v189, v232, v189
    v_cvt_pk_f16_f32 v136, v188, v189
    v_mul_f32 v190, v232, v190
    v_mul_f32 v191, v232, v191
    v_mfma_f32_16x16x32_f16 v[232:235], v[228:231], v[160:163], v[24:27]
    s_cselect_b32 s23, s23, s78
    v_cvt_pk_f16_f32 v137, v190, v191
    v_mov_b32_dpp v242, v237 quad_perm:[0,1,2,3] row_mask:0x1 bank_mask:0xf
    v_mfma_f32_16x16x32_f16 v[232:235], v[220:223], v[116:119], v[232:235]
    s_cselect_b32 s73, s34, s80
    v_max3_f32 v243, v236, v216, v217
    v_max3_f32 v243, v243, v218, v219
    v_mfma_f32_16x16x32_f16 v[232:235], v[224:227], v[124:127], v[232:235]
    s_cselect_b32 s79, 0, s79
    v_max3_f32 v243, v243, v212, v213
    v_max3_f32 v243, v243, v214, v215
    v_max3_f32 v243, v243, v208, v209
    v_max3_f32 v243, v243, v210, v211
    v_mov_b32 v120, v243
    v_add_u32 v5, s74, v5
    v_add_u32 v6, s75, v6
    v_mov_b32_dpp v242, v233 quad_perm:[0,1,2,3] row_mask:0x2 bank_mask:0xf
    v_permlane32_swap_b32 v243, v120
    v_max_f32 v243, v243, v120
    v_mfma_f32_16x16x32_f16 v[244:247], v[228:231], v[180:183], v[26:29]
    s_cselect_b32 s81, 0, 1
    v_mov_b32 v120, v243
    s_add_u32 s80, s77, 1
    v_mfma_f32_16x16x32_f16 v[244:247], v[220:223], v[172:175], v[244:247]
    s_mul_i32 s80, s80, s81
    v_permlane16_swap_b32 v243, v120
    v_mfma_f32_16x16x32_f16 v[244:247], v[224:227], v[136:139], v[244:247]
    s_cmp_lt_u32 s80, s62
    v_max_f32 v243, v243, v120
    v_sub_f32 v216, v216, v243
    v_mfma_f32_16x16x32_bf16 v[128:131], a[216:219], v[192:195], 0
    s_cselect_b32 s70, s70, 0
    v_exp_f32 v216, v216
    v_mfma_f32_16x16x32_bf16 v[128:131], a[220:223], v[184:187], v[128:131]
    s_waitcnt lgkmcnt(0)
    v_sub_f32 v217, v217, v243
    v_sub_f32 v218, v218, v243
    v_mfma_f32_16x16x32_bf16 v[128:131], a[224:227], v[132:135], v[128:131]
    s_cselect_b32 s62, s62, 0
    v_exp_f32 v217, v217
    v_mfma_f32_16x16x32_bf16 v[128:131], a[228:231], v[196:199], v[128:131]
    s_add_u32 s80, s18, 4
    v_cvt_pk_bf16_f32 v216, v216, v217
    v_sub_f32 v219, v219, v243
    v_mfma_f32_16x16x32_bf16 v[128:131], a[232:235], v[204:207], v[128:131]
    s_cmp_ge_u32 s80, s17
    v_exp_f32 v218, v218
    v_mfma_f32_16x16x32_bf16 v[128:131], a[236:239], v[200:203], v[128:131]
    s_cselect_b32 s66, s70, 0
    v_exp_f32 v219, v219
    v_mfma_f32_16x16x32_bf16 v[188:191], a[240:243], v[192:195], 0
    s_lshl_b32 s80, s79, s73
    v_cvt_pk_bf16_f32 v217, v218, v219
    v_sub_f32 v212, v212, v243
    v_mfma_f32_16x16x32_bf16 v[188:191], a[244:247], v[184:187], v[188:191]
    s_or_b32 s63, s63, s80
    s_nop 0
    buffer_store_dwordx2 v[240:241], v19, s[12:15], 0 offen nt
    v_exp_f32 v212, v212
    v_mfma_f32_16x16x32_f16 v[220:223], v[148:151], v[160:163], v[60:63]
    s_sub_u32 s80, s100, s81
    v_sub_f32 v213, v213, v243
    v_sub_f32 v214, v214, v243
    v_mfma_f32_16x16x32_bf16 v[188:191], a[248:251], v[132:135], v[188:191]
    s_and_b32 s100, s100, s80
    v_exp_f32 v213, v213
    v_sub_f32 v215, v215, v243
    v_mfma_f32_16x16x16_f16 v[220:223], v[122:123], v[124:125], v[220:223]
    v_cvt_pk_bf16_f32 v218, v212, v213
    v_exp_f32 v214, v214
    v_sub_f32 v208, v208, v243
    v_mfma_f32_16x16x32_f16 v[224:227], v[116:119], v[160:163], v[64:67]
    s_add_u32 s45, s45, s79
    v_exp_f32 v215, v215
    v_mfma_f32_16x16x32_bf16 v[188:191], a[252:255], v[196:199], v[188:191]
    s_add_u32 s18, s18, 1
    v_cvt_pk_bf16_f32 v219, v214, v215
    v_sub_f32 v209, v209, v243
    v_sub_f32 v210, v210, v243
    v_mfma_f32_16x16x16_f16 v[224:227], v[126:127], v[124:125], v[224:227]
    v_exp_f32 v208, v208
    v_exp_f32 v209, v209
    v_mfma_f32_16x16x32_f16 v[212:215], v[172:175], v[160:163], v[68:71]
    s_cmp_lt_u32 s18, s45
    v_cvt_pk_bf16_f32 v36, v208, v209
    v_sub_f32 v211, v211, v243
    v_mfma_f32_16x16x32_bf16 v[188:191], v[84:87], v[204:207], v[188:191]
    v_exp_f32 v210, v210
    v_mfma_f32_16x16x32_bf16 v[188:191], v[88:91], v[200:203], v[188:191]
    v_exp_f32 v211, v211
    v_sub_f32 v236, v236, v243
    v_mfma_f32_16x16x16_f16 v[212:215], v[138:139], v[124:125], v[212:215]
    v_cvt_pk_bf16_f32 v37, v210, v211
    v_exp_f32 v236, v236
    v_mov_b32_dpp v242, v245 quad_perm:[0,1,2,3] row_mask:0x4 bank_mask:0xf
    v_mfma_f32_16x16x32_bf16 v[176:179], v[92:95], v[192:195], 0
    ds_read_b128 v[160:163], v2 offset:6144
    v_cvt_pk_bf16_f32 v39, v236, 0
    v_mfma_f32_16x16x32_bf16 v[176:179], v[96:99], v[184:187], v[176:179]
    ds_read_b128 v[184:187], v2 offset:7168
    v_mov_b32 v120, v242
    v_mfma_f32_16x16x32_bf16 v[192:195], v[28:31], v[36:39], 0
    v_max3_f32 v121, v232, v220, v221
    v_max_f32_dpp v120, v120, v120 quad_perm:[1,0,3,2] row_mask:0xf bank_mask:0xf
    v_mfma_f32_16x16x32_bf16 v[192:195], v[28:31], v[216:219], v[192:195]
    v_max3_f32 v121, v121, v222, v223
    v_max_f32_dpp v120, v120, v120 quad_perm:[2,3,0,1] row_mask:0xf bank_mask:0xf
    v_mfma_f32_16x16x32_bf16 v[208:211], v[152:155], v[36:39], 0
    v_max3_f32 v121, v121, v224, v225
    v_max_f32_dpp v120, v120, v120 row_half_mirror row_mask:0xf bank_mask:0xf
    v_mfma_f32_16x16x32_bf16 v[208:211], v[164:167], v[216:219], v[208:211]
    v_max3_f32 v121, v121, v226, v227
    v_max_f32_dpp v120, v120, v120 row_mirror row_mask:0xf bank_mask:0xf
    v_mfma_f32_16x16x32_bf16 v[176:179], v[100:103], v[132:135], v[176:179]
    ds_read_b128 v[228:231], v2 offset:8192
    v_mov_b32 v124, v120
    v_mfma_f32_16x16x32_bf16 v[176:179], v[104:107], v[196:199], v[176:179]
    ds_read_b128 v[236:239], v2 offset:9216
    v_max3_f32 v121, v121, v212, v213
    v_mfma_f32_16x16x32_bf16 v[176:179], v[108:111], v[204:207], v[176:179]
    s_waitcnt lgkmcnt(3)
    ds_read_b128 v[204:207], v2 offset:10240
    v_max3_f32 v121, v121, v214, v215
    v_mfma_f32_16x16x32_bf16 v[176:179], v[112:115], v[200:203], v[176:179]
    s_waitcnt lgkmcnt(3)
    ds_read_b128 v[200:203], v2 offset:11264
    v_rcp_f32 v192, v192
    v_permlane32_swap_b32 v120, v124
    v_mul_f32 v208, v192, v208
    v_mul_f32 v209, v192, v209
    v_cvt_pk_bf16_f32 v132, v208, v209
    v_mul_f32 v210, v192, v210
    v_mul_f32 v211, v192, v211
    v_cvt_pk_bf16_f32 v133, v210, v211
    v_max_f32 v120, v120, v124
    v_mfma_f32_16x16x32_bf16 v[196:199], v[156:159], v[36:39], 0
    v_mov_b32 v124, v120
    v_mov_b32 v125, v121
    v_mfma_f32_16x16x32_bf16 v[196:199], v[140:143], v[216:219], v[196:199]
    s_waitcnt lgkmcnt(3)
    v_permlane16_swap_b32 v120, v124
    v_max_f32 v120, v120, v124
    v_sub_f32 v242, v242, v120
    v_exp_f32 v242, v242
    v_permlane32_swap_b32 v121, v125
    v_cvt_pk_bf16_f32 v242, v242, v242
    v_max_f32 v121, v121, v125
    v_mul_f32 v196, v192, v196
    v_mul_f32 v197, v192, v197
    v_cvt_pk_bf16_f32 v134, v196, v197
    v_mul_f32 v198, v192, v198
    v_mul_f32 v199, v192, v199
    v_cvt_pk_bf16_f32 v135, v198, v199
    v_mov_b32 v125, v121
    v_fma_f32 v120, v128, v128, s33
    v_fmac_f32 v120, v129, v129
    v_permlane16_swap_b32 v121, v125
    v_max_f32 v121, v121, v125
    v_sub_f32 v220, v220, v121
    v_exp_f32 v220, v220
    v_sub_f32 v221, v221, v121
    v_exp_f32 v221, v221
    v_sub_f32 v222, v222, v121
    v_cvt_pk_bf16_f32 v208, v220, v221
    v_exp_f32 v222, v222
    v_sub_f32 v223, v223, v121
    v_exp_f32 v223, v223
    v_sub_f32 v224, v224, v121
    v_cvt_pk_bf16_f32 v209, v222, v223
    v_mfma_f32_16x16x32_bf16 v[220:223], v[168:171], v[36:39], 0
    s_waitcnt lgkmcnt(0)
    ds_write_b16 v8, v242
    v_mfma_f32_16x16x32_bf16 v[220:223], v[144:147], v[216:219], v[220:223]
    v_exp_f32 v224, v224
    v_mfma_f32_16x16x32_bf16 v[196:199], a[216:219], v[160:163], 0
    ds_write_b128 v3, v[132:135] offset:0
    v_mfma_f32_16x16x32_bf16 v[196:199], a[220:223], v[184:187], v[196:199]
    v_sub_f32 v225, v225, v121
    v_sub_f32 v226, v226, v121
    v_mfma_f32_16x16x32_bf16 v[196:199], a[224:227], v[228:231], v[196:199]
    v_exp_f32 v225, v225
    v_mfma_f32_16x16x32_bf16 v[196:199], a[228:231], v[236:239], v[196:199]
    ds_read_b128 v[240:243], v9
    v_mul_f32 v220, v192, v220
    v_mfma_f32_16x16x32_bf16 v[196:199], a[232:235], v[204:207], v[196:199]
    v_mul_f32 v221, v192, v221
    v_cvt_pk_bf16_f32 v124, v220, v221
    v_mfma_f32_16x16x32_bf16 v[196:199], a[236:239], v[200:203], v[196:199]
    v_mul_f32 v222, v192, v222
    v_mul_f32 v223, v192, v223
    v_cvt_pk_bf16_f32 v125, v222, v223
    v_mfma_f32_16x16x32_bf16 v[132:135], a[240:243], v[160:163], 0
    ds_write_b64 v4, v[124:125] offset:4096
    v_mfma_f32_16x16x32_bf16 v[132:135], a[244:247], v[184:187], v[132:135]
    v_cvt_pk_bf16_f32 v210, v224, v225
    v_sub_f32 v227, v227, v121
    v_mfma_f32_16x16x32_bf16 v[132:135], a[248:251], v[228:231], v[132:135]
    v_exp_f32 v226, v226
    v_mfma_f32_16x16x32_bf16 v[132:135], a[252:255], v[236:239], v[132:135]
    v_exp_f32 v227, v227
    v_mfma_f32_16x16x32_bf16 v[132:135], v[84:87], v[204:207], v[132:135]
    s_waitcnt lgkmcnt(1)
    v_cvt_pk_bf16_f32 v211, v226, v227
    v_sub_f32 v212, v212, v121
    v_mfma_f32_16x16x32_bf16 v[132:135], v[88:91], v[200:203], v[132:135]
    ds_read_b128 v[192:195], v9 offset:64
    v_exp_f32 v212, v212
    v_sub_f32 v213, v213, v121
    v_exp_f32 v213, v213
    v_sub_f32 v214, v214, v121
    v_cvt_pk_bf16_f32 v36, v212, v213
    v_exp_f32 v214, v214
    v_sub_f32 v215, v215, v121
    v_exp_f32 v215, v215
    v_sub_f32 v232, v232, v121
    v_cvt_pk_bf16_f32 v37, v214, v215
    v_mfma_f32_16x16x32_f16 v[220:223], v[148:151], v[180:183], v[72:75]
    v_exp_f32 v232, v232
    v_mfma_f32_16x16x32_f16 v[148:151], v[116:119], v[180:183], v[76:79]
    v_cvt_pk_bf16_f32 v39, v232, 0
    v_fmac_f32 v120, v130, v130
    v_mfma_f32_16x16x32_f16 v[224:227], v[172:175], v[180:183], v[80:83]
    v_fmac_f32 v120, v131, v131
    v_fmac_f32 v120, v188, v188
    v_mfma_f32_16x16x32_bf16 v[180:183], v[28:31], v[36:39], 0
    s_waitcnt lgkmcnt(0)
    v_fmac_f32 v120, v189, v189
    v_fmac_f32 v120, v190, v190
    v_mfma_f32_16x16x32_bf16 v[180:183], v[28:31], v[208:211], v[180:183]
    v_fmac_f32 v120, v191, v191
    v_fmac_f32 v120, v176, v176
    v_mfma_f32_16x16x32_bf16 v[116:119], v[152:155], v[36:39], 0
    v_fmac_f32 v120, v177, v177
    v_fmac_f32 v120, v178, v178
    v_mfma_f32_16x16x32_bf16 v[116:119], v[164:167], v[208:211], v[116:119]
    v_fmac_f32 v120, v179, v179
    v_fma_f32 v121, v196, v196, s33
    v_mfma_f32_16x16x32_bf16 v[172:175], v[156:159], v[36:39], 0
    v_rcp_f32 v180, v180
    v_mfma_f32_16x16x32_bf16 v[172:175], v[140:143], v[208:211], v[172:175]
    v_fmac_f32 v121, v197, v197
    v_fmac_f32 v121, v198, v198
    v_fmac_f32 v121, v199, v199
    v_mfma_f32_16x16x16_f16 v[220:223], v[122:123], v[136:137], v[220:223]
    v_mul_f32 v116, v180, v116
    v_mul_f32 v117, v180, v117
    v_cvt_pk_bf16_f32 v116, v116, v117
    v_mfma_f32_16x16x16_f16 v[148:151], v[126:127], v[136:137], v[148:151]
    v_mul_f32 v118, v180, v118
    v_mul_f32 v119, v180, v119
    v_cvt_pk_bf16_f32 v117, v118, v119
    v_mul_f32 v172, v180, v172
    v_mfma_f32_16x16x32_bf16 v[124:127], v[168:171], v[36:39], 0
    v_max3_f32 v122, v244, v220, v221
    v_max3_f32 v122, v122, v222, v223
    v_mfma_f32_16x16x32_bf16 v[124:127], v[144:147], v[208:211], v[124:127]
    v_max3_f32 v122, v122, v148, v149
    v_max3_f32 v122, v122, v150, v151
    v_mul_f32 v173, v180, v173
    v_mfma_f32_16x16x16_f16 v[224:227], v[138:139], v[136:137], v[224:227]
    v_cvt_pk_bf16_f32 v118, v172, v173
    v_mul_f32 v174, v180, v174
    v_mul_f32 v175, v180, v175
    v_cvt_pk_bf16_f32 v119, v174, v175
    v_mfma_f32_16x16x32_bf16 v[212:215], v[92:95], v[160:163], 0
    ds_read_b128 v[136:139], v2 offset:12288
    v_mul_f32 v124, v180, v124
    v_mfma_f32_16x16x32_bf16 v[212:215], v[96:99], v[184:187], v[212:215]
    ds_read_b128 v[160:163], v2 offset:13312
    v_max3_f32 v122, v122, v224, v225
    v_mfma_f32_16x16x32_bf16 v[212:215], v[100:103], v[228:231], v[212:215]
    ds_read_b128 v[172:175], v2 offset:14336
    v_max3_f32 v122, v122, v226, v227
    v_mfma_f32_16x16x32_bf16 v[212:215], v[104:107], v[236:239], v[212:215]
    ds_read_b128 v[184:187], v2 offset:15360
    v_mov_b32 v123, v122
    v_mfma_f32_16x16x32_bf16 v[212:215], v[108:111], v[204:207], v[212:215]
    ds_read_b128 v[204:207], v2 offset:16384
    v_mul_f32 v125, v180, v125
    v_mfma_f32_16x16x32_bf16 v[212:215], v[112:115], v[200:203], v[212:215]
    ds_read_b128 v[228:231], v2 offset:17408
    v_cvt_pk_bf16_f32 v124, v124, v125
    v_mfma_f32_16x16x32_bf16 v[236:239], v[240:243], v[28:31], 0
    ds_write_b128 v3, v[116:119] offset:6144
    v_mfma_f32_16x16x32_bf16 v[236:239], v[192:195], v[28:31], v[236:239]
    s_waitcnt lgkmcnt(6)
    v_permlane32_swap_b32 v122, v123
    v_mfma_f32_16x16x32_bf16 v[200:203], a[216:219], v[136:139], 0
    s_waitcnt lgkmcnt(5)
    v_max_f32 v122, v122, v123
    v_mov_b32 v123, v122
    v_mfma_f32_16x16x32_bf16 v[200:203], a[220:223], v[160:163], v[200:203]
    s_waitcnt lgkmcnt(4)
    v_rcp_f32 v236, v236
    v_mfma_f32_16x16x32_bf16 v[200:203], a[224:227], v[172:175], v[200:203]
    s_waitcnt lgkmcnt(3)
    v_permlane16_swap_b32 v122, v123
    v_mfma_f32_16x16x32_bf16 v[200:203], a[228:231], v[184:187], v[200:203]
    s_waitcnt lgkmcnt(2)
    v_max_f32 v122, v122, v123
    v_sub_f32 v220, v220, v122
    v_mfma_f32_16x16x32_bf16 v[200:203], a[232:235], v[204:207], v[200:203]
    s_waitcnt lgkmcnt(1)
    v_exp_f32 v220, v220
    v_mfma_f32_16x16x32_bf16 v[200:203], a[236:239], v[228:231], v[200:203]
    v_sub_f32 v221, v221, v122
    v_sub_f32 v222, v222, v122
    v_mfma_f32_16x16x32_bf16 v[216:219], a[240:243], v[136:139], 0
    v_exp_f32 v221, v221
    v_mfma_f32_16x16x32_bf16 v[216:219], a[244:247], v[160:163], v[216:219]
    v_cvt_pk_bf16_f32 v220, v220, v221
    v_sub_f32 v223, v223, v122
    v_mfma_f32_16x16x32_bf16 v[216:219], a[248:251], v[172:175], v[216:219]
    v_exp_f32 v222, v222
    v_mfma_f32_16x16x32_bf16 v[216:219], a[252:255], v[184:187], v[216:219]
    v_exp_f32 v223, v223
    v_mfma_f32_16x16x32_bf16 v[216:219], v[84:87], v[204:207], v[216:219]
    v_cvt_pk_bf16_f32 v221, v222, v223
    v_sub_f32 v148, v148, v122
    v_mfma_f32_16x16x32_bf16 v[216:219], v[88:91], v[228:231], v[216:219]
    v_exp_f32 v148, v148
    v_mfma_f32_16x16x32_bf16 v[208:211], v[92:95], v[136:139], 0
    v_sub_f32 v149, v149, v122
    v_sub_f32 v150, v150, v122
    v_mfma_f32_16x16x32_bf16 v[208:211], v[96:99], v[160:163], v[208:211]
    v_exp_f32 v149, v149
    v_mfma_f32_16x16x32_bf16 v[208:211], v[100:103], v[172:175], v[208:211]
    v_cvt_pk_bf16_f32 v222, v148, v149
    v_sub_f32 v151, v151, v122
    v_mfma_f32_16x16x32_bf16 v[208:211], v[104:107], v[184:187], v[208:211]
    v_exp_f32 v150, v150
    v_mfma_f32_16x16x32_bf16 v[208:211], v[108:111], v[204:207], v[208:211]
    v_exp_f32 v151, v151
    v_mfma_f32_16x16x32_bf16 v[208:211], v[112:115], v[228:231], v[208:211]
    ds_read_b128 v[232:235], v0 offset:20480
    ds_read_b128 v[248:251], v1 offset:20480
    v_mfma_f32_16x16x32_bf16 v[184:187], v[240:243], v[164:167], 0
    ds_read_b128 v[160:163], v0 offset:20608
    ds_read_b128 v[136:139], v1 offset:20608
    v_mfma_f32_16x16x32_bf16 v[184:187], v[192:195], v[152:155], v[184:187]
    v_cvt_pk_bf16_f32 v223, v150, v151
    v_sub_f32 v224, v224, v122
    v_mfma_f32_16x16x32_bf16 v[148:151], v[240:243], v[140:143], 0
    ds_read_b128 v[116:119], v0 offset:20736
    v_sub_f32 v225, v225, v122
    v_mfma_f32_16x16x32_bf16 v[148:151], v[192:195], v[156:159], v[148:151]
    ds_read_b128 v[172:175], v1 offset:20736
    v_exp_f32 v224, v224
    v_mul_f32 v184, v184, v236
    v_exp_f32 v225, v225
    v_sub_f32 v226, v226, v122
    v_cvt_pk_bf16_f32 v36, v224, v225
    v_exp_f32 v226, v226
    v_sub_f32 v227, v227, v122
    v_mul_f32_dpp v184, v148, v236 quad_perm:[0,1,2,3] row_mask:0x2 bank_mask:0xf
    v_mfma_f32_16x16x32_bf16 v[204:207], v[240:243], v[144:147], 0
    s_waitcnt lgkmcnt(4)
    v_exp_f32 v227, v227
    v_mfma_f32_16x16x32_bf16 v[204:207], v[192:195], v[168:171], v[204:207]
    s_waitcnt lgkmcnt(2)
    v_cvt_pk_bf16_f32 v37, v226, v227
    v_sub_f32 v244, v244, v122
    v_mfma_f32_16x16x32_bf16 v[148:151], a[72:75], v[232:235], 0
    v_exp_f32 v244, v244
    v_mfma_f32_16x16x32_bf16 v[148:151], a[76:79], v[248:251], v[148:151]
    s_waitcnt lgkmcnt(1)
    v_cvt_pk_bf16_f32 v39, v244, 0
    v_mul_f32_dpp v184, v204, v236 quad_perm:[0,1,2,3] row_mask:0x4 bank_mask:0xf
    v_mfma_f32_16x16x32_bf16 v[148:151], a[80:83], v[160:163], v[148:151]
    s_waitcnt lgkmcnt(0)
    v_cvt_pk_bf16_f32 v184, v184, v184
    v_mul_f32 v126, v180, v126
    v_mfma_f32_16x16x32_bf16 v[192:195], v[28:31], v[36:39], 0
    ds_write_b16 v7, v184
    v_mfma_f32_16x16x32_bf16 v[192:195], v[28:31], v[220:223], v[192:195]
    v_mul_f32 v127, v180, v127
    v_cvt_pk_bf16_f32 v125, v126, v127
    v_mfma_f32_16x16x32_bf16 v[180:183], v[152:155], v[36:39], 0
    ds_write_b64 v4, v[124:125] offset:10240
    v_mfma_f32_16x16x32_bf16 v[180:183], v[164:167], v[220:223], v[180:183]
    v_fma_f32 v122, v200, v200, s33
    v_fmac_f32 v122, v201, v201
    v_mfma_f32_16x16x32_bf16 v[124:127], v[156:159], v[36:39], 0
    v_rcp_f32 v192, v192
    v_mfma_f32_16x16x32_bf16 v[124:127], v[140:143], v[220:223], v[124:127]
    v_fmac_f32 v122, v202, v202
    v_fmac_f32 v122, v203, v203
    v_mfma_f32_16x16x32_bf16 v[152:155], v[168:171], v[36:39], 0
    v_mul_f32 v180, v192, v180
    v_mul_f32 v181, v192, v181
    v_mfma_f32_16x16x32_bf16 v[152:155], v[144:147], v[220:223], v[152:155]
    v_cvt_pk_bf16_f32 v144, v180, v181
    v_mul_f32 v182, v192, v182
    v_mfma_f32_16x16x32_bf16 v[148:151], a[84:87], v[136:139], v[148:151]
    v_mul_f32 v183, v192, v183
    v_cvt_pk_bf16_f32 v145, v182, v183
    v_mfma_f32_16x16x32_bf16 v[148:151], a[88:91], v[116:119], v[148:151]
    v_mul_f32 v124, v192, v124
    v_mul_f32 v125, v192, v125
    v_mfma_f32_16x16x32_bf16 v[148:151], a[92:95], v[172:175], v[148:151]
    v_cvt_pk_bf16_f32 v146, v124, v125
    v_mul_f32 v126, v192, v126
    v_mfma_f32_16x16x32_bf16 v[140:143], a[96:99], v[232:235], 0
    v_mul_f32 v127, v192, v127
    v_cvt_pk_bf16_f32 v147, v126, v127
    v_mfma_f32_16x16x32_bf16 v[140:143], a[100:103], v[248:251], v[140:143]
    ds_write_b128 v3, v[144:147] offset:12288
    v_mfma_f32_16x16x32_bf16 v[140:143], a[104:107], v[160:163], v[140:143]
    v_mul_f32 v152, v192, v152
    v_mul_f32 v153, v192, v153
    v_mfma_f32_16x16x32_bf16 v[140:143], a[108:111], v[136:139], v[140:143]
    v_cvt_pk_bf16_f32 v152, v152, v153
    v_mul_f32 v154, v192, v154
    v_mfma_f32_16x16x32_bf16 v[140:143], a[112:115], v[116:119], v[140:143]
    v_mul_f32 v155, v192, v155
    v_cvt_pk_bf16_f32 v153, v154, v155
    v_mfma_f32_16x16x32_bf16 v[140:143], a[116:119], v[172:175], v[140:143]
    ds_write_b64 v4, v[152:153] offset:16384
    v_mfma_f32_16x16x32_bf16 v[144:147], a[120:123], v[232:235], 0
    v_fmac_f32 v122, v216, v216
    v_fmac_f32 v122, v217, v217
    v_mfma_f32_16x16x32_bf16 v[144:147], a[124:127], v[248:251], v[144:147]
    v_fmac_f32 v122, v218, v218
    v_fmac_f32 v122, v219, v219
    v_mfma_f32_16x16x32_bf16 v[144:147], a[128:131], v[160:163], v[144:147]
    v_fmac_f32 v122, v208, v208
    v_fmac_f32 v122, v209, v209
    v_mfma_f32_16x16x32_bf16 v[144:147], a[132:135], v[136:139], v[144:147]
    v_fmac_f32 v122, v210, v210
    v_fmac_f32 v122, v211, v211
    v_mfma_f32_16x16x32_bf16 v[144:147], a[136:139], v[116:119], v[144:147]
    v_cvt_pk_bf16_f32 v123, v122, v122
    v_fmac_f32 v121, v132, v132
    v_mfma_f32_16x16x32_bf16 v[144:147], a[140:143], v[172:175], v[144:147]
    v_fmac_f32 v121, v133, v133
    v_fmac_f32 v121, v134, v134
    v_mfma_f32_16x16x32_bf16 v[152:155], a[0:3], v[232:235], 0
    v_fmac_f32 v121, v135, v135
    v_fmac_f32 v121, v212, v212
    v_mfma_f32_16x16x32_bf16 v[152:155], a[4:7], v[248:251], v[152:155]
    v_fmac_f32 v121, v213, v213
    v_fmac_f32 v121, v214, v214
    v_mfma_f32_16x16x32_bf16 v[152:155], a[8:11], v[160:163], v[152:155]
    v_fmac_f32 v121, v215, v215
    v_cvt_pk_bf16_f32 v122, v120, v121
    v_mfma_f32_16x16x32_bf16 v[152:155], a[12:15], v[136:139], v[152:155]
    ds_write_b64 v4, v[122:123] offset:18432
    v_mfma_f32_16x16x32_bf16 v[152:155], a[16:19], v[116:119], v[152:155]
    v_add_u32 v7, s76, v7
    v_fma_f32 v164, v148, v148, s32
    v_mfma_f32_16x16x32_bf16 v[152:155], a[20:23], v[172:175], v[152:155]
    v_fmac_f32 v164, v149, v149
    v_fmac_f32 v164, v150, v150
    v_mfma_f32_16x16x32_bf16 v[156:159], a[24:27], v[232:235], 0
    v_fmac_f32 v164, v151, v151
    v_fmac_f32 v164, v140, v140
    v_mfma_f32_16x16x32_bf16 v[156:159], a[28:31], v[248:251], v[156:159]
    v_fmac_f32 v164, v141, v141
    v_fmac_f32 v164, v142, v142
    v_mfma_f32_16x16x32_bf16 v[156:159], a[32:35], v[160:163], v[156:159]
    v_fmac_f32 v164, v143, v143
    v_xor_b32 v2, 65536, v2
    v_mfma_f32_16x16x32_bf16 v[156:159], a[36:39], v[136:139], v[156:159]
    v_xor_b32 v3, 65536, v3
    v_xor_b32 v4, 65536, v4
    v_mfma_f32_16x16x32_bf16 v[156:159], a[40:43], v[116:119], v[156:159]
    s_waitcnt lgkmcnt(0)
    s_nop 0
    s_nop 0
    s_nop 0
    s_barrier
    v_mfma_f32_16x16x32_bf16 v[156:159], a[44:47], v[172:175], v[156:159]
    s_cbranch_scc1 L_loop_safe3
L_final_safe:
    v_mfma_f32_16x16x32_bf16 v[120:123], a[48:51], v[232:235], 0
    s_mov_b32 s12, s40
    ds_read_b128 v[124:127], v2 offset:18432
    ds_read_b128 v[168:171], v2 offset:19456
    v_mfma_f32_16x16x32_bf16 v[120:123], a[52:55], v[248:251], v[120:123]
    s_mov_b32 s13, s41
    v_fmac_f32 v164, v144, v144
    v_fmac_f32 v164, v145, v145
    v_mfma_f32_16x16x32_bf16 v[120:123], a[56:59], v[160:163], v[120:123]
    s_mov_b32 s14, s36
    v_fmac_f32 v164, v146, v146
    v_fmac_f32 v164, v147, v147
    v_mfma_f32_16x16x32_bf16 v[120:123], a[60:63], v[136:139], v[120:123]
    s_add_u32 s48, s40, s27
    v_fma_f32 v165, v152, v152, s32
    v_fmac_f32 v165, v153, v153
    v_mfma_f32_16x16x32_bf16 v[120:123], a[64:67], v[116:119], v[120:123]
    s_addc_u32 s49, s41, 0
    v_fmac_f32 v165, v154, v154
    v_fmac_f32 v165, v155, v155
    v_mfma_f32_16x16x32_bf16 v[120:123], a[68:71], v[172:175], v[120:123]
    s_sub_u32 s50, s36, s27
    v_fmac_f32 v165, v156, v156
    v_fmac_f32 v165, v157, v157
    v_mfma_f32_16x16x32_bf16 v[180:183], v[232:235], a[144:147], 0
    s_mov_b32 s51, 0x00020000
    v_fmac_f32 v165, v158, v158
    v_fmac_f32 v165, v159, v159
    v_mfma_f32_16x16x32_bf16 v[180:183], v[248:251], a[148:151], v[180:183]
    s_waitcnt lgkmcnt(0)
    v_fmac_f32 v165, v120, v120
    v_fmac_f32 v165, v121, v121
    v_mfma_f32_16x16x32_bf16 v[184:187], v[32:35], v[124:127], 0
    s_add_u32 s52, s40, s26
    v_fmac_f32 v165, v122, v122
    v_fmac_f32 v165, v123, v123
    v_mfma_f32_16x16x32_bf16 v[184:187], v[32:35], v[168:171], v[184:187]
    s_addc_u32 s53, s41, 0
    v_cvt_pk_bf16_f32 v36, v165, v164
    v_mov_b32 v125, 0x40000000
    v_mfma_f32_16x16x32_bf16 v[180:183], v[160:163], a[152:155], v[180:183]
    s_sub_u32 s54, s36, s26
    v_bfe_u32 v127, v2, 4, 6
    v_lshrrev_b32 v124, 4, v127
    v_mfma_f32_16x16x32_bf16 v[168:171], v[32:35], v[36:39], 0
    s_mov_b32 s55, 0x00020000
    v_mul_f32 v184, 0x3baaaaab, v184
    v_mul_f32 v126, 0x3baaaaab, v185
    v_mfma_f32_16x16x32_bf16 v[180:183], v[136:139], a[156:159], v[180:183]
    s_add_u32 s56, s40, s25
    v_rsq_f32 v184, v184
    v_mfma_f32_16x16x32_bf16 v[180:183], v[116:119], a[160:163], v[180:183]
    s_addc_u32 s57, s41, 0
    v_mul_f32 v128, v184, v128
    v_mul_f32 v129, v184, v129
    v_mfma_f32_16x16x32_bf16 v[180:183], v[172:175], a[164:167], v[180:183]
    s_sub_u32 s58, s36, s25
    v_cvt_pk_bf16_f32 v128, v128, v129
    v_mul_f32 v130, v184, v130
    v_mfma_f32_16x16x32_bf16 v[164:167], v[232:235], a[168:171], 0
    s_mov_b32 s59, 0x00020000
    v_mul_f32 v131, v184, v131
    v_cvt_pk_bf16_f32 v129, v130, v131
    v_mfma_f32_16x16x32_bf16 v[164:167], v[248:251], a[172:175], v[164:167]
    s_and_b32 s6, s2, 7
    v_mul_f32 v188, v184, v188
    v_mul_f32 v189, v184, v189
    v_mfma_f32_16x16x32_bf16 v[164:167], v[160:163], a[176:179], v[164:167]
    s_sub_u32 s6, 0, s6
    v_cvt_pk_bf16_f32 v130, v188, v189
    v_mul_f32 v190, v184, v190
    v_mfma_f32_16x16x32_bf16 v[164:167], v[136:139], a[180:183], v[164:167]
    s_lshl_b32 s3, s16, 6
    v_mul_f32 v191, v184, v191
    v_cvt_pk_bf16_f32 v131, v190, v191
    v_mfma_f32_16x16x32_bf16 v[164:167], v[116:119], a[184:187], v[164:167]
    s_lshl_b32 s4, s16, 5
    ds_read_b128 v[188:191], v0 offset:26624
    buffer_store_dwordx4 v[128:131], v15, s[48:51], 0 offen nt
    v_mul_f32 v176, v184, v176
    v_mul_f32 v177, v184, v177
    v_cvt_pk_bf16_f32 v170, v176, v177
    v_mul_f32 v178, v184, v178
    v_mfma_f32_16x16x32_bf16 v[164:167], v[172:175], a[188:191], v[164:167]
    s_add_u32 s4, s4, 256
    ds_read_b128 v[128:131], v1 offset:26624
    v_mul_f32 v179, v184, v179
    v_mfma_f32_16x16x32_bf16 v[192:195], v[232:235], a[192:195], 0
    s_mul_i32 s5, s16, 9408
    ds_read_b128 v[232:235], v0 offset:26752
    v_cvt_pk_bf16_f32 v171, v178, v179
    v_mfma_f32_16x16x32_bf16 v[192:195], v[248:251], a[196:199], v[192:195]
    s_add_u32 s5, s5, 104448
    ds_read_b128 v[248:251], v1 offset:26752
    v_cvt_pk_bf16_f32 v184, v180, v181
    v_mfma_f32_16x16x32_bf16 v[192:195], v[160:163], a[200:203], v[192:195]
    ds_read_b128 v[176:179], v0 offset:26880
    v_cvt_pk_bf16_f32 v185, v182, v183
    v_mfma_f32_16x16x32_bf16 v[192:195], v[136:139], a[204:207], v[192:195]
    ds_read_b128 v[160:163], v1 offset:26880
    v_cvt_pk_bf16_f32 v136, v164, v165
    v_mfma_f32_16x16x32_bf16 v[192:195], v[116:119], a[208:211], v[192:195]
    s_waitcnt lgkmcnt(5)
    ds_read_b128 v[220:223], v2 offset:0
    ds_read_b128 v[116:119], v2 offset:1024
    v_mfma_f32_16x16x32_bf16 v[192:195], v[172:175], a[212:215], v[192:195]
    ds_read_b128 v[224:227], v2 offset:2048
    ds_read_b128 v[204:207], v2 offset:3072
    v_mfma_f32_16x16x32_bf16 v[180:183], a[72:75], v[188:191], 0
    s_waitcnt lgkmcnt(8)
    v_rsq_f32 v126, v126
    v_mfma_f32_16x16x32_bf16 v[180:183], a[76:79], v[128:131], v[180:183]
    s_waitcnt lgkmcnt(7)
    ds_read_b128 v[172:175], v2 offset:4096
    ds_read_b128 v[228:231], v2 offset:5120
    v_mfma_f32_16x16x32_bf16 v[180:183], a[80:83], v[232:235], v[180:183]
    s_waitcnt lgkmcnt(8)
    v_mul_f32 v196, v126, v196
    v_mul_f32 v197, v126, v197
    v_mfma_f32_16x16x32_bf16 v[180:183], a[84:87], v[248:251], v[180:183]
    s_waitcnt lgkmcnt(7)
    v_cvt_pk_bf16_f32 v236, v196, v197
    v_mul_f32 v198, v126, v198
    v_mfma_f32_16x16x32_bf16 v[180:183], a[88:91], v[176:179], v[180:183]
    s_waitcnt lgkmcnt(6)
    v_mul_f32 v199, v126, v199
    v_cvt_pk_bf16_f32 v237, v198, v199
    v_mfma_f32_16x16x32_bf16 v[180:183], a[92:95], v[160:163], v[180:183]
    s_waitcnt lgkmcnt(4)
    v_mul_f32 v132, v126, v132
    v_mul_f32 v133, v126, v133
    v_mfma_f32_16x16x32_bf16 v[196:199], a[216:219], v[220:223], 0
    s_waitcnt lgkmcnt(2)
    v_cvt_pk_bf16_f32 v238, v132, v133
    v_mul_f32 v134, v126, v134
    v_mfma_f32_16x16x32_bf16 v[196:199], a[220:223], v[116:119], v[196:199]
    v_mul_f32 v135, v126, v135
    v_cvt_pk_bf16_f32 v239, v134, v135
    v_mfma_f32_16x16x32_bf16 v[196:199], a[224:227], v[224:227], v[196:199]
    s_waitcnt lgkmcnt(0)
    buffer_store_dwordx2 v[170:171], v18, s[48:51], 0 offen nt
    v_mul_f32 v212, v126, v212
    v_mul_f32 v213, v126, v213
    v_mfma_f32_16x16x32_bf16 v[196:199], a[228:231], v[204:207], v[196:199]
    v_cvt_pk_bf16_f32 v138, v212, v213
    v_mul_f32 v214, v126, v214
    v_mfma_f32_16x16x32_bf16 v[196:199], a[232:235], v[172:175], v[196:199]
    v_mul_f32 v215, v126, v215
    v_cvt_pk_bf16_f32 v139, v214, v215
    v_mfma_f32_16x16x32_bf16 v[196:199], a[236:239], v[228:231], v[196:199]
    v_rsq_f32 v169, v169
    v_mfma_f32_16x16x32_bf16 v[240:243], a[240:243], v[220:223], 0
    v_rsq_f32 v168, v168
    v_mfma_f32_16x16x32_bf16 v[240:243], a[244:247], v[116:119], v[240:243]
    v_mul_f32 v168, s31, v168
    v_cvt_pk_bf16_f32 v137, v166, v167
    v_mfma_f32_16x16x32_bf16 v[240:243], a[248:251], v[224:227], v[240:243]
    v_cvt_pk_bf16_f32 v212, v192, v193
    v_fma_f32 v126, v196, v196, s33
    v_mfma_f32_16x16x32_bf16 v[240:243], a[252:255], v[204:207], v[240:243]
    v_fmac_f32 v126, v197, v197
    v_fmac_f32 v126, v198, v198
    v_mfma_f32_16x16x32_bf16 v[240:243], v[84:87], v[172:175], v[240:243]
    v_fmac_f32 v126, v199, v199
    v_cvt_pk_bf16_f32 v213, v194, v195
    v_mfma_f32_16x16x32_bf16 v[240:243], v[88:91], v[228:231], v[240:243]
    ds_read_b128 v[164:167], v2 offset:6144
    v_mul_f32 v148, v169, v148
    v_mfma_f32_16x16x32_bf16 v[192:195], v[92:95], v[220:223], 0
    ds_read_b128 v[132:135], v2 offset:7168
    v_mul_f32 v149, v169, v149
    v_mfma_f32_16x16x32_bf16 v[192:195], v[96:99], v[116:119], v[192:195]
    ds_read_b128 v[220:223], v2 offset:8192
    v_cvt_pk_f16_f32 v148, v148, v149
    v_mfma_f32_16x16x32_bf16 v[192:195], v[100:103], v[224:227], v[192:195]
    ds_read_b128 v[224:227], v2 offset:9216
    v_fmac_f32 v126, v240, v240
    v_mfma_f32_16x16x32_bf16 v[192:195], v[104:107], v[204:207], v[192:195]
    ds_read_b128 v[116:119], v2 offset:10240
    v_fmac_f32 v126, v241, v241
    v_mfma_f32_16x16x32_bf16 v[192:195], v[108:111], v[172:175], v[192:195]
    ds_read_b128 v[172:175], v2 offset:11264
    v_fmac_f32 v126, v242, v242
    v_mfma_f32_16x16x32_bf16 v[192:195], v[112:115], v[228:231], v[192:195]
    v_fmac_f32 v126, v243, v243
    v_mul_f32 v150, v169, v150
    v_mfma_f32_16x16x32_bf16 v[204:207], a[96:99], v[188:191], 0
    s_waitcnt lgkmcnt(5)
    buffer_store_dwordx4 v[236:239], v16, s[48:51], 0 offen nt
    v_mul_f32 v151, v169, v151
    v_cvt_pk_f16_f32 v149, v150, v151
    v_mul_f32 v140, v169, v140
    v_fmac_f32 v126, v192, v192
    v_mfma_f32_16x16x32_bf16 v[204:207], a[100:103], v[128:131], v[204:207]
    s_waitcnt lgkmcnt(3)
    v_fmac_f32 v126, v193, v193
    v_fmac_f32 v126, v194, v194
    v_mfma_f32_16x16x32_bf16 v[228:231], a[216:219], v[164:167], 0
    s_waitcnt lgkmcnt(2)
    v_fmac_f32 v126, v195, v195
    v_mul_f32 v141, v169, v141
    v_mfma_f32_16x16x32_bf16 v[228:231], a[220:223], v[132:135], v[228:231]
    s_waitcnt lgkmcnt(1)
    v_cvt_pk_f16_f32 v150, v140, v141
    v_mul_f32 v142, v169, v142
    v_mfma_f32_16x16x32_bf16 v[228:231], a[224:227], v[220:223], v[228:231]
    s_waitcnt lgkmcnt(0)
    v_mul_f32 v143, v169, v143
    v_cvt_pk_f16_f32 v151, v142, v143
    v_mfma_f32_16x16x32_bf16 v[228:231], a[228:231], v[224:227], v[228:231]
    v_mul_f32 v144, v169, v144
    v_mul_f32 v145, v169, v145
    v_mfma_f32_16x16x32_bf16 v[228:231], a[232:235], v[116:119], v[228:231]
    v_cvt_pk_f16_f32 v142, v144, v145
    v_mul_f32 v146, v169, v146
    v_mfma_f32_16x16x32_bf16 v[228:231], a[236:239], v[172:175], v[228:231]
    v_mul_f32 v147, v169, v147
    v_cvt_pk_f16_f32 v143, v146, v147
    v_mfma_f32_16x16x32_bf16 v[144:147], a[240:243], v[164:167], 0
    v_mul_f32 v152, v168, v152
    v_mul_f32 v153, v168, v153
    v_mfma_f32_16x16x32_bf16 v[144:147], a[244:247], v[132:135], v[144:147]
    v_cvt_pk_f16_f32 v152, v152, v153
    v_mul_f32 v154, v168, v154
    v_mfma_f32_16x16x32_bf16 v[144:147], a[248:251], v[220:223], v[144:147]
    v_mul_f32 v155, v168, v155
    v_cvt_pk_f16_f32 v153, v154, v155
    v_mfma_f32_16x16x32_bf16 v[144:147], a[252:255], v[224:227], v[144:147]
    v_mul_f32 v156, v168, v156
    v_mul_f32 v157, v168, v157
    v_mfma_f32_16x16x32_bf16 v[144:147], v[84:87], v[116:119], v[144:147]
    v_cvt_pk_f16_f32 v154, v156, v157
    v_mul_f32 v158, v168, v158
    v_mfma_f32_16x16x32_bf16 v[144:147], v[88:91], v[172:175], v[144:147]
    v_mul_f32 v159, v168, v159
    v_cvt_pk_f16_f32 v155, v158, v159
    v_mfma_f32_16x16x32_bf16 v[156:159], v[92:95], v[164:167], 0
    v_mul_f32 v120, v168, v120
    v_mul_f32 v121, v168, v121
    v_mfma_f32_16x16x32_bf16 v[156:159], v[96:99], v[132:135], v[156:159]
    v_cvt_pk_f16_f32 v140, v120, v121
    v_mul_f32 v122, v168, v122
    v_mfma_f32_16x16x32_bf16 v[156:159], v[100:103], v[220:223], v[156:159]
    buffer_store_dwordx2 v[138:139], v19, s[48:51], 0 offen nt
    v_mul_f32 v123, v168, v123
    v_cvt_pk_f16_f32 v141, v122, v123
    v_mfma_f32_16x16x32_bf16 v[156:159], v[104:107], v[224:227], v[156:159]
    v_fma_f32 v187, v180, v180, s32
    v_fmac_f32 v187, v181, v181
    v_mfma_f32_16x16x32_bf16 v[156:159], v[108:111], v[116:119], v[156:159]
    v_fmac_f32 v187, v182, v182
    v_fmac_f32 v187, v183, v183
    v_mfma_f32_16x16x32_bf16 v[156:159], v[112:115], v[172:175], v[156:159]
    v_fma_f32 v138, v228, v228, s33
    v_fmac_f32 v138, v229, v229
    v_mfma_f32_16x16x32_bf16 v[204:207], a[104:107], v[232:235], v[204:207]
    v_fmac_f32 v138, v230, v230
    v_fmac_f32 v138, v231, v231
    v_mfma_f32_16x16x32_bf16 v[204:207], a[108:111], v[248:251], v[204:207]
    v_fmac_f32 v138, v144, v144
    v_fmac_f32 v138, v145, v145
    v_mfma_f32_16x16x32_bf16 v[204:207], a[112:115], v[176:179], v[204:207]
    v_fmac_f32 v138, v146, v146
    v_fmac_f32 v138, v147, v147
    v_mfma_f32_16x16x32_bf16 v[204:207], a[116:119], v[160:163], v[204:207]
    v_fmac_f32 v138, v156, v156
    v_fmac_f32 v138, v157, v157
    v_mfma_f32_16x16x32_bf16 v[120:123], a[120:123], v[188:191], 0
    v_fmac_f32 v138, v158, v158
    v_fmac_f32 v138, v159, v159
    v_mfma_f32_16x16x32_bf16 v[120:123], a[124:127], v[128:131], v[120:123]
    v_cvt_pk_bf16_f32 v214, v126, v138
    v_cvt_pk_bf16_f32 v215, v138, v138
    v_mfma_f32_16x16x32_bf16 v[120:123], a[128:131], v[232:235], v[120:123]
    v_fmac_f32 v187, v204, v204
    v_fmac_f32 v187, v205, v205
    v_mfma_f32_16x16x32_bf16 v[120:123], a[132:135], v[248:251], v[120:123]
    v_fmac_f32 v187, v206, v206
    v_fmac_f32 v187, v207, v207
    v_mfma_f32_16x16x32_bf16 v[120:123], a[136:139], v[176:179], v[120:123]
    v_and_b32 v116, 15, v127
    v_add_u32 v126, 0, v116
    v_mfma_f32_16x16x32_bf16 v[120:123], a[140:143], v[160:163], v[120:123]
    v_mul_u32_u24 v139, s20, v126
    v_add_u32 v139, s38, v139
    v_mfma_f32_16x16x32_bf16 v[172:175], a[0:3], v[188:191], 0
    v_mul_u32_u24 v138, 911, v139
    v_lshrrev_b32 v138, 16, v138
    v_mfma_f32_16x16x32_bf16 v[172:175], a[4:7], v[128:131], v[172:175]
    v_mul_u32_u24 v138, s22, v138
    v_mad_u32_u24 v138, v126, s21, v138
    v_mfma_f32_16x16x32_bf16 v[172:175], a[8:11], v[232:235], v[172:175]
    v_fmac_f32 v187, v120, v120
    v_fmac_f32 v187, v121, v121
    v_mfma_f32_16x16x32_bf16 v[172:175], a[12:15], v[248:251], v[172:175]
    v_fmac_f32 v187, v122, v122
    v_fmac_f32 v187, v123, v123
    v_mfma_f32_16x16x32_bf16 v[172:175], a[16:19], v[176:179], v[172:175]
    v_bfe_u32 v139, s63, v126, 1
    v_cmp_ne_u32 vcc, 0, v139
    v_mfma_f32_16x16x32_bf16 v[172:175], a[20:23], v[160:163], v[172:175]
    v_add_u32 v126, s7, v138
    v_cndmask_b32 v126, v125, v126, vcc
    v_mfma_f32_16x16x32_bf16 v[132:135], a[24:27], v[188:191], 0
    v_lshl_add_u32 v119, v124, 4, v126
    v_add_u32 v119, s3, v119
    v_mfma_f32_16x16x32_bf16 v[132:135], a[28:31], v[128:131], v[132:135]
    v_lshl_add_u32 v126, v124, 3, v126
    v_add_u32 v126, s4, v126
    v_mfma_f32_16x16x32_bf16 v[132:135], a[32:35], v[232:235], v[132:135]
    v_fma_f32 v138, v172, v172, s32
    v_fmac_f32 v138, v173, v173
    v_mfma_f32_16x16x32_bf16 v[132:135], a[36:39], v[248:251], v[132:135]
    v_fmac_f32 v138, v174, v174
    v_fmac_f32 v138, v175, v175
    v_mfma_f32_16x16x32_bf16 v[132:135], a[40:43], v[176:179], v[132:135]
    v_lshlrev_b32 v117, 9, v124
    v_lshl_add_u32 v117, v116, 4, v117
    v_mfma_f32_16x16x32_bf16 v[132:135], a[44:47], v[160:163], v[132:135]
    v_add_u32 v117, 149696, v117
    v_and_b32 v118, 0xffff, v2
    v_mfma_f32_16x16x32_bf16 v[168:171], a[48:51], v[188:191], 0
    v_add_u32 v118, 38912, v118
    v_and_b32 v164, 0xffff, v4
    v_mfma_f32_16x16x32_bf16 v[168:171], a[52:55], v[128:131], v[168:171]
    v_add_u32 v164, 38912, v164
    v_mul_f32 v165, 0x3baaaaab, v186
    v_mfma_f32_16x16x32_bf16 v[168:171], a[56:59], v[232:235], v[168:171]
    ds_write_b64 v164, v[214:215] offset:0
    v_mfma_f32_16x16x32_bf16 v[168:171], a[60:63], v[248:251], v[168:171]
    v_fmac_f32 v138, v132, v132
    v_fmac_f32 v138, v133, v133
    v_mfma_f32_16x16x32_bf16 v[168:171], a[64:67], v[176:179], v[168:171]
    v_fmac_f32 v138, v134, v134
    v_fmac_f32 v138, v135, v135
    v_mfma_f32_16x16x32_bf16 v[168:171], a[68:71], v[160:163], v[168:171]
    v_rsq_f32 v165, v165
    v_mfma_f32_16x16x32_bf16 v[224:227], v[188:191], a[144:147], 0
    v_mul_f32 v200, v165, v200
    v_mul_f32 v201, v165, v201
    v_mfma_f32_16x16x32_bf16 v[224:227], v[128:131], a[148:151], v[224:227]
    v_cvt_pk_bf16_f32 v200, v200, v201
    v_mul_f32 v202, v165, v202
    v_mfma_f32_16x16x32_bf16 v[224:227], v[232:235], a[152:155], v[224:227]
    v_fmac_f32 v138, v168, v168
    v_fmac_f32 v138, v169, v169
    v_mfma_f32_16x16x32_bf16 v[224:227], v[248:251], a[156:159], v[224:227]
    s_waitcnt lgkmcnt(0)
    v_fmac_f32 v138, v170, v170
    v_fmac_f32 v138, v171, v171
    v_mfma_f32_16x16x32_bf16 v[224:227], v[176:179], a[160:163], v[224:227]
    s_barrier
    ds_read_b128 v[236:239], v118 offset:0
    v_cvt_pk_bf16_f32 v36, v138, v187
    v_mfma_f32_16x16x32_bf16 v[224:227], v[160:163], a[164:167], v[224:227]
    ds_read_b128 v[220:223], v118 offset:1024
    v_mul_f32 v203, v165, v203
    v_cvt_pk_bf16_f32 v201, v202, v203
    v_mul_f32 v216, v165, v216
    v_mul_f32 v217, v165, v217
    v_cvt_pk_bf16_f32 v202, v216, v217
    v_mul_f32 v218, v165, v218
    v_mul_f32 v219, v165, v219
    v_cvt_pk_bf16_f32 v186, v224, v225
    v_cvt_pk_bf16_f32 v187, v226, v227
    v_mfma_f32_16x16x32_bf16 v[224:227], v[32:35], v[36:39], 0
    v_cvt_pk_bf16_f32 v203, v218, v219
    buffer_store_dwordx4 v[200:203], v17, s[48:51], 0 offen nt
    v_mul_f32 v208, v165, v208
    v_mul_f32 v209, v165, v209
    v_cvt_pk_bf16_f32 v166, v208, v209
    v_mul_f32 v210, v165, v210
    v_mfma_f32_16x16x32_bf16 v[216:219], v[188:191], a[168:171], 0
    s_waitcnt lgkmcnt(1)
    v_rsq_f32 v225, v225
    v_mfma_f32_16x16x32_bf16 v[200:203], v[32:35], v[236:239], 0
    s_waitcnt lgkmcnt(0)
    v_rsq_f32 v224, v224
    v_mfma_f32_16x16x32_bf16 v[200:203], v[32:35], v[220:223], v[200:203]
    v_mul_f32 v224, s31, v224
    v_mul_f32 v180, v225, v180
    v_mfma_f32_16x16x32_bf16 v[216:219], v[128:131], a[172:175], v[216:219]
    v_mul_f32 v181, v225, v181
    v_cvt_pk_f16_f32 v180, v180, v181
    v_mfma_f32_16x16x32_bf16 v[216:219], v[232:235], a[176:179], v[216:219]
    v_mul_f32 v182, v225, v182
    v_mul_f32 v183, v225, v183
    v_mfma_f32_16x16x32_bf16 v[216:219], v[248:251], a[180:183], v[216:219]
    v_mul_f32 v167, 0x3baaaaab, v201
    v_mul_f32 v208, 0x3baaaaab, v200
    v_mfma_f32_16x16x32_bf16 v[216:219], v[176:179], a[184:187], v[216:219]
    ds_read_b128 v[220:223], v0 offset:32768
    v_cvt_pk_f16_f32 v181, v182, v183
    v_mfma_f32_16x16x32_bf16 v[216:219], v[160:163], a[188:191], v[216:219]
    ds_read_b128 v[200:203], v1 offset:32768
    v_mul_f32 v204, v225, v204
    v_mfma_f32_16x16x32_bf16 v[236:239], v[188:191], a[192:195], 0
    ds_read_b128 v[188:191], v0 offset:32896
    v_mul_f32 v205, v225, v205
    v_mfma_f32_16x16x32_bf16 v[236:239], v[128:131], a[196:199], v[236:239]
    ds_read_b128 v[128:131], v1 offset:32896
    v_cvt_pk_f16_f32 v182, v204, v205
    v_mfma_f32_16x16x32_bf16 v[236:239], v[232:235], a[200:203], v[236:239]
    ds_read_b128 v[232:235], v0 offset:33024
    v_cvt_pk_bf16_f32 v138, v216, v217
    v_mfma_f32_16x16x32_bf16 v[236:239], v[248:251], a[204:207], v[236:239]
    ds_read_b128 v[248:251], v1 offset:33024
    v_cvt_pk_bf16_f32 v139, v218, v219
    v_mfma_f32_16x16x32_bf16 v[236:239], v[176:179], a[208:211], v[236:239]
    v_rsq_f32 v167, v167
    v_mfma_f32_16x16x32_bf16 v[236:239], v[160:163], a[212:215], v[236:239]
    s_waitcnt lgkmcnt(5)
    v_mul_f32 v228, v167, v228
    v_mul_f32 v229, v167, v229
    v_mfma_f32_16x16x32_bf16 v[176:179], a[72:75], v[220:223], 0
    s_waitcnt lgkmcnt(4)
    v_cvt_pk_bf16_f32 v160, v228, v229
    v_mul_f32 v230, v167, v230
    v_mfma_f32_16x16x32_bf16 v[176:179], a[76:79], v[200:203], v[176:179]
    s_waitcnt lgkmcnt(3)
    v_mul_f32 v231, v167, v231
    v_cvt_pk_bf16_f32 v161, v230, v231
    v_mfma_f32_16x16x32_bf16 v[176:179], a[80:83], v[188:191], v[176:179]
    s_waitcnt lgkmcnt(2)
    v_mul_f32 v144, v167, v144
    v_mul_f32 v145, v167, v145
    v_mfma_f32_16x16x32_bf16 v[176:179], a[84:87], v[128:131], v[176:179]
    s_waitcnt lgkmcnt(1)
    v_cvt_pk_bf16_f32 v162, v144, v145
    v_mul_f32 v146, v167, v146
    v_mfma_f32_16x16x32_bf16 v[176:179], a[88:91], v[232:235], v[176:179]
    s_waitcnt lgkmcnt(0)
    v_mul_f32 v147, v167, v147
    v_cvt_pk_bf16_f32 v163, v146, v147
    v_mfma_f32_16x16x32_bf16 v[176:179], a[92:95], v[248:251], v[176:179]
    buffer_store_dwordx4 v[160:163], v16, s[52:55], 0 offen nt
    v_mul_f32 v156, v167, v156
    v_mul_f32 v157, v167, v157
    v_cvt_pk_bf16_f32 v226, v156, v157
    v_mul_f32 v158, v167, v158
    v_mfma_f32_16x16x32_bf16 v[144:147], a[96:99], v[220:223], 0
    v_mul_f32 v159, v167, v159
    v_cvt_pk_bf16_f32 v227, v158, v159
    v_mfma_f32_16x16x32_bf16 v[144:147], a[100:103], v[200:203], v[144:147]
    v_rsq_f32 v208, v208
    v_mfma_f32_16x16x32_bf16 v[144:147], a[104:107], v[188:191], v[144:147]
    v_mul_f32 v196, v208, v196
    v_mul_f32 v197, v208, v197
    v_mfma_f32_16x16x32_bf16 v[144:147], a[108:111], v[128:131], v[144:147]
    ds_read_b128 v[216:219], v5 offset:0
    ds_read_b128 v[156:159], v5 offset:16
    v_mfma_f32_16x16x32_bf16 v[144:147], a[112:115], v[232:235], v[144:147]
    ds_read_b128 v[160:163], v5 offset:48
    ds_read_b32 v209, v6 offset:192
    v_mfma_f32_16x16x32_bf16 v[144:147], a[116:119], v[248:251], v[144:147]
    v_cvt_pk_bf16_f32 v196, v196, v197
    v_mul_f32 v198, v208, v198
    v_mul_f32 v199, v208, v199
    v_cvt_pk_bf16_f32 v197, v198, v199
    v_mul_f32 v240, v208, v240
    v_mul_f32 v241, v208, v241
    v_cvt_pk_bf16_f32 v198, v240, v241
    v_mfma_f32_16x16x32_bf16 v[228:231], a[120:123], v[220:223], 0
    v_mul_f32 v242, v208, v242
    v_mul_f32 v243, v208, v243
    v_mfma_f32_16x16x32_bf16 v[228:231], a[124:127], v[200:203], v[228:231]
    v_cvt_pk_bf16_f32 v199, v242, v243
    v_mul_f32 v192, v208, v192
    v_mfma_f32_16x16x32_bf16 v[228:231], a[128:131], v[188:191], v[228:231]
    v_mul_f32 v193, v208, v193
    v_cvt_pk_bf16_f32 v204, v192, v193
    v_mfma_f32_16x16x32_bf16 v[228:231], a[132:135], v[128:131], v[228:231]
    s_waitcnt lgkmcnt(2)
    v_mul_f32 v194, v208, v194
    v_mul_f32 v195, v208, v195
    v_mfma_f32_16x16x32_bf16 v[228:231], a[136:139], v[232:235], v[228:231]
    s_waitcnt lgkmcnt(0)
    v_cvt_pk_bf16_f32 v205, v194, v195
    v_cvt_pk_bf16_f32 v214, v236, v237
    v_mfma_f32_16x16x32_bf16 v[228:231], a[140:143], v[248:251], v[228:231]
    v_cvt_pk_bf16_f32 v215, v238, v239
    v_mul_f32 v206, v225, v206
    v_mfma_f32_16x16x32_bf16 v[240:243], a[0:3], v[220:223], 0
    v_mul_f32 v207, v225, v207
    v_cvt_pk_f16_f32 v183, v206, v207
    v_mfma_f32_16x16x32_bf16 v[240:243], a[4:7], v[200:203], v[240:243]
    buffer_store_dwordx2 v[226:227], v19, s[52:55], 0 offen nt
    v_mul_f32 v120, v225, v120
    v_mul_f32 v121, v225, v121
    v_mfma_f32_16x16x32_bf16 v[240:243], a[8:11], v[188:191], v[240:243]
    v_cvt_pk_f16_f32 v194, v120, v121
    v_mul_f32 v122, v225, v122
    v_mfma_f32_16x16x32_bf16 v[240:243], a[12:15], v[128:131], v[240:243]
    v_mul_f32 v123, v225, v123
    v_cvt_pk_f16_f32 v195, v122, v123
    v_mfma_f32_16x16x32_bf16 v[240:243], a[16:19], v[232:235], v[240:243]
    v_mul_f32 v172, v224, v172
    v_mul_f32 v173, v224, v173
    v_mfma_f32_16x16x32_bf16 v[240:243], a[20:23], v[248:251], v[240:243]
    v_cvt_pk_f16_f32 v120, v172, v173
    v_mul_f32 v174, v224, v174
    v_mfma_f32_16x16x32_bf16 v[236:239], a[24:27], v[220:223], 0
    v_mul_f32 v175, v224, v175
    v_cvt_pk_f16_f32 v121, v174, v175
    v_mfma_f32_16x16x32_bf16 v[236:239], a[28:31], v[200:203], v[236:239]
    v_mul_f32 v132, v224, v132
    v_mul_f32 v133, v224, v133
    v_mfma_f32_16x16x32_bf16 v[236:239], a[32:35], v[188:191], v[236:239]
    v_cvt_pk_f16_f32 v122, v132, v133
    v_mul_f32 v134, v224, v134
    v_mfma_f32_16x16x32_bf16 v[236:239], a[36:39], v[128:131], v[236:239]
    v_mul_f32 v135, v224, v135
    v_cvt_pk_f16_f32 v123, v134, v135
    v_mfma_f32_16x16x32_bf16 v[236:239], a[40:43], v[232:235], v[236:239]
    ds_read2_b32 v[206:207], v6 offset0:0 offset1:0
    ds_read2_b32 v[174:175], v6 offset0:16 offset1:16
    v_mfma_f32_16x16x32_bf16 v[236:239], a[44:47], v[248:251], v[236:239]
    ds_read2_b32 v[134:135], v6 offset0:32 offset1:32
    v_mul_f32 v168, v224, v168
    v_mul_f32 v169, v224, v169
    v_cvt_pk_f16_f32 v192, v168, v169
    v_mul_f32 v170, v224, v170
    v_mul_f32 v171, v224, v171
    v_mfma_f32_16x16x32_bf16 v[224:227], a[48:51], v[220:223], 0
    v_cvt_pk_f16_f32 v193, v170, v171
    v_fma_f32 v208, v240, v240, s32
    v_mfma_f32_16x16x32_bf16 v[224:227], a[52:55], v[200:203], v[224:227]
    v_fmac_f32 v208, v241, v241
    v_fmac_f32 v208, v242, v242
    v_mfma_f32_16x16x32_bf16 v[224:227], a[56:59], v[188:191], v[224:227]
    v_fmac_f32 v208, v243, v243
    v_fmac_f32 v208, v236, v236
    v_mfma_f32_16x16x32_bf16 v[224:227], a[60:63], v[128:131], v[224:227]
    v_fmac_f32 v208, v237, v237
    v_fmac_f32 v208, v238, v238
    v_mfma_f32_16x16x32_bf16 v[224:227], a[64:67], v[232:235], v[224:227]
    s_waitcnt lgkmcnt(1)
    buffer_store_dwordx4 v[196:199], v15, s[52:55], 0 offen nt
    v_fmac_f32 v208, v239, v239
    v_fma_f32 v167, v176, v176, s32
    v_fmac_f32 v167, v177, v177
    v_fmac_f32 v167, v178, v178
    v_mfma_f32_16x16x32_bf16 v[224:227], a[68:71], v[248:251], v[224:227]
    v_fmac_f32 v167, v179, v179
    v_fmac_f32 v167, v144, v144
    v_fmac_f32 v167, v145, v145
    v_fmac_f32 v167, v146, v146
    v_fmac_f32 v167, v147, v147
    v_fmac_f32 v167, v228, v228
    v_fmac_f32 v167, v229, v229
    v_fmac_f32 v167, v230, v230
    v_fmac_f32 v208, v224, v224
    v_fmac_f32 v208, v225, v225
    v_fmac_f32 v208, v226, v226
    v_fmac_f32 v208, v227, v227
    v_fmac_f32 v167, v231, v231
    v_cvt_pk_bf16_f32 v36, v208, v167
    v_mfma_f32_16x16x32_f16 v[196:199], v[216:219], v[152:155], v[22:25]
    s_waitcnt lgkmcnt(0)
    v_mul_f32 v211, v165, v211
    v_cvt_pk_bf16_f32 v167, v210, v211
    v_mfma_f32_16x16x32_f16 v[196:199], v[156:159], v[148:151], v[196:199]
    v_add_u32 v172, 16, v116
    v_min_u32 v173, 20, v172
    v_mfma_f32_16x16x32_f16 v[196:199], v[160:163], v[140:143], v[196:199]
    v_add_u32 v132, 12, v172
    v_lshrrev_b32 v132, 5, v132
    v_sub_u32 v165, v172, v173
    v_mad_i32_i24 v165, v132, s6, v165
    v_mul_u32_u24 v133, s20, v173
    v_add3_u32 v133, v133, v165, s38
    v_mul_u32_u24 v132, 911, v133
    v_lshrrev_b32 v132, 16, v132
    v_mul_u32_u24 v132, s22, v132
    v_mad_u32_u24 v132, v173, s21, v132
    v_bfe_u32 v133, s63, v172, 1
    v_cmp_ne_u32 vcc, 0, v133
    v_mul_i32_i24 v165, 2688, v165
    v_add3_u32 v165, v132, v165, s7
    v_mfma_f32_16x16x32_bf16 v[168:171], v[32:35], v[36:39], 0
    v_cndmask_b32 v165, v125, v165, vcc
    v_lshl_add_u32 v208, v124, 4, v165
    v_add_u32 v208, s3, v208
    v_lshl_add_u32 v165, v124, 3, v165
    v_add_u32 v165, s4, v165
    v_mov_b32_dpp v209, v197 quad_perm:[0,1,2,3] row_mask:0x1 bank_mask:0xf
    v_subrev_u32 v132, 0x3d800000, v44
    v_sub_u32 v125, 0x4a000000, v45
    v_rsq_f32 v169, v169
    v_rsq_f32 v168, v168
    v_mul_f32 v176, v169, v176
    v_mul_f32 v168, s31, v168
    v_mul_f32 v177, v169, v177
    buffer_store_dwordx2 v[204:205], v18, s[52:55], 0 offen nt
    v_cvt_pk_f16_f32 v176, v176, v177
    v_mul_f32 v178, v169, v178
    v_mfma_f32_16x16x32_bf16 v[244:247], v[220:223], a[144:147], 0
    v_mul_f32 v179, v169, v179
    v_cvt_pk_f16_f32 v177, v178, v179
    v_mfma_f32_16x16x32_bf16 v[244:247], v[200:203], a[148:151], v[244:247]
    v_mul_f32 v144, v169, v144
    v_mul_f32 v145, v169, v145
    v_mfma_f32_16x16x32_bf16 v[244:247], v[188:191], a[152:155], v[244:247]
    v_cvt_pk_f16_f32 v178, v144, v145
    v_mul_f32 v146, v169, v146
    v_mfma_f32_16x16x32_bf16 v[244:247], v[128:131], a[156:159], v[244:247]
    v_mul_f32 v147, v169, v147
    v_cvt_pk_f16_f32 v179, v146, v147
    v_mfma_f32_16x16x32_bf16 v[244:247], v[232:235], a[160:163], v[244:247]
    v_mul_f32 v228, v169, v228
    v_mul_f32 v229, v169, v229
    v_mfma_f32_16x16x32_bf16 v[244:247], v[248:251], a[164:167], v[244:247]
    v_cvt_pk_f16_f32 v254, v228, v229
    v_mul_f32 v230, v169, v230
    v_mfma_f32_16x16x32_f16 v[144:147], v[216:219], v[120:123], v[24:27]
    v_mul_f32 v231, v169, v231
    v_cvt_pk_f16_f32 v255, v230, v231
    v_mfma_f32_16x16x32_f16 v[144:147], v[156:159], v[180:183], v[144:147]
    v_mul_f32 v240, v168, v240
    v_mul_f32 v241, v168, v241
    v_mfma_f32_16x16x32_f16 v[144:147], v[160:163], v[192:195], v[144:147]
    v_cvt_pk_bf16_f32 v204, v244, v245
    v_cvt_pk_bf16_f32 v205, v246, v247
    v_mfma_f32_16x16x32_f16 v[228:231], v[148:151], v[152:155], v[48:51]
    v_cvt_pk_f16_f32 v240, v240, v241
    v_mul_f32 v242, v168, v242
    v_mul_f32 v243, v168, v243
    v_cvt_pk_f16_f32 v241, v242, v243
    v_mfma_f32_16x16x32_f16 v[244:247], v[180:183], v[152:155], v[52:55]
    v_mul_f32 v236, v168, v236
    v_mul_f32 v237, v168, v237
    v_cvt_pk_f16_f32 v242, v236, v237
    v_mfma_f32_16x16x16_f16 v[228:231], v[142:143], v[140:141], v[228:231]
    v_mul_f32 v238, v168, v238
    v_mul_f32 v239, v168, v239
    v_cvt_pk_f16_f32 v243, v238, v239
    v_mfma_f32_16x16x16_f16 v[244:247], v[194:195], v[140:141], v[244:247]
    v_mul_f32 v224, v168, v224
    v_mul_f32 v225, v168, v225
    v_cvt_pk_f16_f32 v252, v224, v225
    v_mul_f32 v226, v168, v226
    v_mul_f32 v227, v168, v227
    v_mfma_f32_16x16x32_f16 v[168:171], v[216:219], v[240:243], v[26:29]
    v_cvt_pk_f16_f32 v253, v226, v227
    v_mov_b32_dpp v209, v145 quad_perm:[0,1,2,3] row_mask:0x2 bank_mask:0xf
    v_mfma_f32_16x16x32_f16 v[168:171], v[156:159], v[176:179], v[168:171]
    buffer_store_dwordx2 v[166:167], v20, s[48:51], 0 offen nt
    v_max3_f32 v210, v196, v228, v229
    v_max3_f32 v210, v210, v230, v231
    v_mfma_f32_16x16x32_f16 v[168:171], v[160:163], v[252:255], v[168:171]
    v_max3_f32 v210, v210, v244, v245
    v_max3_f32 v210, v210, v246, v247
    v_mfma_f32_16x16x32_f16 v[156:159], v[176:179], v[152:155], v[56:59]
    v_or3_b32 v132, v132, v125, v45
    v_xor_b32 v167, 65536, v2
    v_mfma_f32_16x16x32_bf16 v[152:155], v[220:223], a[168:171], 0
    v_lshl_add_u32 v125, s16, 2, v167
    v_bfe_u32 v166, v116, 1, 2
    v_mfma_f32_16x16x32_bf16 v[152:155], v[200:203], a[172:175], v[152:155]
    ds_write_b32 v125, v132 offset:18432
    v_mov_b32_dpp v209, v169 quad_perm:[0,1,2,3] row_mask:0x4 bank_mask:0xf
    v_mfma_f32_16x16x16_f16 v[156:159], v[254:255], v[140:141], v[156:159]
    v_mov_b32 v211, v209
    v_xor_b32 v166, v166, v124
    v_lshl_add_u32 v166, v116, 2, v166
    v_max_f32_dpp v211, v211, v211 quad_perm:[1,0,3,2] row_mask:0xf bank_mask:0xf
    v_mfma_f32_16x16x32_bf16 v[152:155], v[188:191], a[176:179], v[152:155]
    v_lshl_add_u32 v124, v166, 4, s5
    v_max_f32_dpp v211, v211, v211 quad_perm:[2,3,0,1] row_mask:0xf bank_mask:0xf
    v_mfma_f32_16x16x32_bf16 v[152:155], v[128:131], a[180:183], v[152:155]
    v_max3_f32 v210, v210, v156, v157
    v_max3_f32 v210, v210, v158, v159
    v_mfma_f32_16x16x32_bf16 v[152:155], v[232:235], a[184:187], v[152:155]
    v_mov_b32 v116, v210
    v_max_f32_dpp v211, v211, v211 row_half_mirror row_mask:0xf bank_mask:0xf
    v_mfma_f32_16x16x32_bf16 v[152:155], v[248:251], a[188:191], v[152:155]
    ds_read_b128 v[216:219], v2 offset:12288
    ds_read_b128 v[236:239], v2 offset:13312
    v_mfma_f32_16x16x32_bf16 v[224:227], v[220:223], a[192:195], 0
    ds_read_b128 v[160:163], v2 offset:14336
    v_max_f32_dpp v211, v211, v211 row_mirror row_mask:0xf bank_mask:0xf
    v_mfma_f32_16x16x32_bf16 v[224:227], v[200:203], a[196:199], v[224:227]
    ds_read_b128 v[200:203], v2 offset:15360
    v_mov_b32 v125, v211
    v_mfma_f32_16x16x32_bf16 v[224:227], v[188:191], a[200:203], v[224:227]
    ds_read_b128 v[188:191], v2 offset:16384
    v_cvt_pk_bf16_f32 v172, v152, v153
    v_mfma_f32_16x16x32_bf16 v[224:227], v[128:131], a[204:207], v[224:227]
    ds_read_b128 v[128:131], v2 offset:17408
    v_cvt_pk_bf16_f32 v173, v154, v155
    v_mfma_f32_16x16x32_bf16 v[224:227], v[232:235], a[208:211], v[224:227]
    v_permlane32_swap_b32 v210, v116
    v_mfma_f32_16x16x32_bf16 v[224:227], v[248:251], a[212:215], v[224:227]
    v_max_f32 v210, v210, v116
    s_waitcnt lgkmcnt(5)
    v_mfma_f32_16x16x32_bf16 v[248:251], a[216:219], v[216:219], 0
    s_waitcnt lgkmcnt(4)
    v_mov_b32 v116, v210
    v_lshl_add_u32 v169, v166, 3, s5
    v_mfma_f32_16x16x32_bf16 v[248:251], a[220:223], v[236:239], v[248:251]
    s_waitcnt lgkmcnt(3)
    v_cvt_pk_bf16_f32 v132, v224, v225
    v_cvt_pk_bf16_f32 v133, v226, v227
    v_mfma_f32_16x16x32_bf16 v[248:251], a[224:227], v[160:163], v[248:251]
    s_waitcnt lgkmcnt(2)
    v_permlane16_swap_b32 v210, v116
    v_mfma_f32_16x16x32_bf16 v[248:251], a[228:231], v[200:203], v[248:251]
    s_waitcnt lgkmcnt(1)
    v_max_f32 v210, v210, v116
    v_sub_f32 v228, v228, v210
    v_mfma_f32_16x16x32_bf16 v[248:251], a[232:235], v[188:191], v[248:251]
    s_waitcnt lgkmcnt(0)
    v_exp_f32 v228, v228
    v_mfma_f32_16x16x32_f16 v[152:155], v[148:151], v[120:123], v[60:63]
    v_sub_f32 v229, v229, v210
    v_sub_f32 v230, v230, v210
    v_mfma_f32_16x16x32_bf16 v[248:251], a[236:239], v[128:131], v[248:251]
    v_exp_f32 v229, v229
    v_mfma_f32_16x16x32_bf16 v[232:235], a[240:243], v[216:219], 0
    v_cvt_pk_bf16_f32 v228, v228, v229
    v_exp_f32 v230, v230
    v_mfma_f32_16x16x16_f16 v[152:155], v[142:143], v[192:193], v[152:155]
    v_sub_f32 v231, v231, v210
    v_exp_f32 v231, v231
    v_sub_f32 v244, v244, v210
    v_mfma_f32_16x16x32_bf16 v[232:235], a[244:247], v[236:239], v[232:235]
    v_fma_f32 v116, v248, v248, s33
    v_fmac_f32 v116, v249, v249
    v_mfma_f32_16x16x32_bf16 v[232:235], a[248:251], v[160:163], v[232:235]
    v_fmac_f32 v116, v250, v250
    v_fmac_f32 v116, v251, v251
    v_mfma_f32_16x16x32_bf16 v[232:235], a[252:255], v[200:203], v[232:235]
    v_cvt_pk_bf16_f32 v229, v230, v231
    v_sub_f32 v245, v245, v210
    v_mfma_f32_16x16x32_bf16 v[232:235], v[84:87], v[188:191], v[232:235]
    v_exp_f32 v244, v244
    v_mfma_f32_16x16x32_bf16 v[232:235], v[88:91], v[128:131], v[232:235]
    v_exp_f32 v245, v245
    v_sub_f32 v246, v246, v210
    v_cvt_pk_bf16_f32 v230, v244, v245
    v_mfma_f32_16x16x32_f16 v[220:223], v[180:183], v[120:123], v[64:67]
    v_exp_f32 v246, v246
    v_sub_f32 v247, v247, v210
    v_exp_f32 v247, v247
    v_sub_f32 v156, v156, v210
    v_fmac_f32 v116, v232, v232
    v_fmac_f32 v116, v233, v233
    v_mfma_f32_16x16x16_f16 v[220:223], v[194:195], v[192:193], v[220:223]
    v_fmac_f32 v116, v234, v234
    v_fmac_f32 v116, v235, v235
    v_cvt_pk_bf16_f32 v231, v246, v247
    v_exp_f32 v156, v156
    v_sub_f32 v157, v157, v210
    v_exp_f32 v157, v157
    v_sub_f32 v158, v158, v210
    v_cvt_pk_bf16_f32 v36, v156, v157
    v_exp_f32 v158, v158
    v_sub_f32 v159, v159, v210
    v_exp_f32 v159, v159
    v_sub_f32 v196, v196, v210
    v_mfma_f32_16x16x32_f16 v[224:227], v[176:179], v[120:123], v[68:71]
    ds_read_b128 v[120:123], v117 offset:0
    v_cvt_pk_bf16_f32 v37, v158, v159
    v_exp_f32 v196, v196
    v_permlane32_swap_b32 v211, v125
    v_cvt_pk_bf16_f32 v39, v196, 0
    v_max_f32 v211, v211, v125
    v_mfma_f32_16x16x16_f16 v[224:227], v[254:255], v[192:193], v[224:227]
    v_mov_b32 v125, v211
    v_max3_f32 v170, v144, v152, v153
    v_max3_f32 v170, v170, v154, v155
    v_max3_f32 v170, v170, v220, v221
    v_mfma_f32_16x16x32_bf16 v[196:199], v[28:31], v[36:39], 0
    v_permlane16_swap_b32 v211, v125
    v_mfma_f32_16x16x32_bf16 v[196:199], v[28:31], v[228:231], v[196:199]
    v_max_f32 v211, v211, v125
    v_sub_f32 v209, v209, v211
    v_mfma_f32_16x16x32_bf16 v[156:159], v[204:207], v[36:39], 0
    v_exp_f32 v209, v209
    v_mfma_f32_16x16x32_bf16 v[156:159], v[184:187], v[228:231], v[156:159]
    v_cvt_pk_bf16_f32 v209, v209, v209
    ds_write_b16 v8, v209
    v_max3_f32 v170, v170, v222, v223
    v_rcp_f32 v196, v196
    v_max3_f32 v170, v170, v224, v225
    v_max3_f32 v170, v170, v226, v227
    v_mov_b32 v171, v170
    v_lshl_add_u32 v209, v127, 4, s5
    v_mul_f32 v156, v196, v156
    v_mul_f32 v157, v196, v157
    v_cvt_pk_bf16_f32 v156, v156, v157
    v_mul_f32 v158, v196, v158
    v_mul_f32 v159, v196, v159
    v_cvt_pk_bf16_f32 v157, v158, v159
    v_permlane32_swap_b32 v170, v171
    v_max_f32 v170, v170, v171
    v_mov_b32 v171, v170
    v_lshl_add_u32 v127, v127, 3, s5
    v_lshlrev_b32 v166, 2, v166
    v_permlane16_swap_b32 v170, v171
    v_max_f32 v170, v170, v171
    v_sub_f32 v152, v152, v170
    v_exp_f32 v152, v152
    v_sub_f32 v153, v153, v170
    v_exp_f32 v153, v153
    v_sub_f32 v154, v154, v170
    v_cvt_pk_bf16_f32 v152, v152, v153
    v_mfma_f32_16x16x32_bf16 v[244:247], v[172:175], v[36:39], 0
    s_waitcnt lgkmcnt(0)
    ds_permute_b32 v125, v166, v15
    ds_permute_b32 v171, v166, v18
    v_mfma_f32_16x16x32_bf16 v[244:247], v[136:139], v[228:231], v[244:247]
    ds_permute_b32 v211, v166, v17
    ds_permute_b32 v210, v166, v20
    v_exp_f32 v154, v154
    v_sub_f32 v155, v155, v170
    v_exp_f32 v155, v155
    v_sub_f32 v220, v220, v170
    v_cvt_pk_bf16_f32 v153, v154, v155
    v_exp_f32 v220, v220
    v_mul_f32 v244, v196, v244
    v_mul_f32 v245, v196, v245
    v_cvt_pk_bf16_f32 v158, v244, v245
    v_mul_f32 v246, v196, v246
    v_mul_f32 v247, v196, v247
    v_cvt_pk_bf16_f32 v159, v246, v247
    ds_write_b128 v3, v[156:159] offset:0
    v_mfma_f32_16x16x32_bf16 v[156:159], v[132:135], v[36:39], 0
    s_waitcnt lgkmcnt(2)
    v_sub_f32 v221, v221, v170
    v_sub_f32 v222, v222, v170
    v_mfma_f32_16x16x32_bf16 v[156:159], v[212:215], v[228:231], v[156:159]
    s_waitcnt lgkmcnt(1)
    v_exp_f32 v221, v221
    v_mfma_f32_16x16x32_f16 v[228:231], v[148:151], v[240:243], v[72:75]
    v_cvt_pk_bf16_f32 v154, v220, v221
    v_sub_f32 v223, v223, v170
    v_mfma_f32_16x16x32_bf16 v[148:151], v[92:95], v[216:219], 0
    ds_read_b128 v[244:247], v117 offset:2048
    v_sub_f32 v224, v224, v170
    v_mfma_f32_16x16x32_bf16 v[148:151], v[96:99], v[236:239], v[148:151]
    ds_read_b128 v[216:219], v117 offset:4096
    v_mul_f32 v156, v196, v156
    v_mul_f32 v157, v196, v157
    v_mfma_f32_16x16x16_f16 v[228:231], v[142:143], v[252:253], v[228:231]
    v_cvt_pk_bf16_f32 v192, v156, v157
    v_mul_f32 v158, v196, v158
    v_mul_f32 v159, v196, v159
    v_cvt_pk_bf16_f32 v193, v158, v159
    v_mfma_f32_16x16x32_bf16 v[148:151], v[100:103], v[160:163], v[148:151]
    ds_read_b128 v[156:159], v117 offset:6144
    v_sub_f32 v225, v225, v170
    v_mfma_f32_16x16x32_bf16 v[148:151], v[104:107], v[200:203], v[148:151]
    ds_read_b128 v[200:203], v117 offset:8192
    v_max3_f32 v166, v168, v228, v229
    v_mfma_f32_16x16x32_bf16 v[148:151], v[108:111], v[188:191], v[148:151]
    ds_read_b128 v[188:191], v117 offset:10240
    v_max3_f32 v166, v166, v230, v231
    v_mfma_f32_16x16x32_bf16 v[148:151], v[112:115], v[128:131], v[148:151]
    s_waitcnt lgkmcnt(4)
    ds_write_b64 v4, v[192:193] offset:4096
    v_mfma_f32_16x16x32_bf16 v[128:131], a[216:219], v[120:123], 0
    s_waitcnt lgkmcnt(4)
    v_exp_f32 v222, v222
    v_mfma_f32_16x16x32_bf16 v[128:131], a[220:223], v[244:247], v[128:131]
    v_exp_f32 v223, v223
    v_mfma_f32_16x16x32_bf16 v[128:131], a[224:227], v[216:219], v[128:131]
    v_fmac_f32 v116, v148, v148
    v_fmac_f32 v116, v149, v149
    v_mfma_f32_16x16x32_bf16 v[160:163], a[240:243], v[120:123], 0
    s_waitcnt lgkmcnt(3)
    v_fmac_f32 v116, v150, v150
    v_fmac_f32 v116, v151, v151
    v_mfma_f32_16x16x32_bf16 v[128:131], a[228:231], v[156:159], v[128:131]
    s_waitcnt lgkmcnt(2)
    v_cvt_pk_bf16_f32 v155, v222, v223
    v_sub_f32 v226, v226, v170
    v_mfma_f32_16x16x32_bf16 v[128:131], a[232:235], v[200:203], v[128:131]
    s_waitcnt lgkmcnt(1)
    v_exp_f32 v224, v224
    v_mfma_f32_16x16x32_f16 v[140:143], v[180:183], v[240:243], v[76:79]
    v_exp_f32 v225, v225
    v_mfma_f32_16x16x32_bf16 v[128:131], a[236:239], v[188:191], v[128:131]
    v_cvt_pk_bf16_f32 v36, v224, v225
    v_sub_f32 v227, v227, v170
    v_mfma_f32_16x16x32_bf16 v[160:163], a[244:247], v[244:247], v[160:163]
    v_exp_f32 v226, v226
    v_sub_f32 v144, v144, v170
    v_mfma_f32_16x16x16_f16 v[140:143], v[194:195], v[252:253], v[140:143]
    v_exp_f32 v227, v227
    v_exp_f32 v144, v144
    v_mfma_f32_16x16x32_f16 v[180:183], v[176:179], v[240:243], v[80:83]
    v_fma_f32 v170, v128, v128, s33
    v_fmac_f32 v170, v129, v129
    v_mfma_f32_16x16x32_bf16 v[160:163], a[248:251], v[216:219], v[160:163]
    v_fmac_f32 v170, v130, v130
    v_fmac_f32 v170, v131, v131
    v_mfma_f32_16x16x32_bf16 v[160:163], a[252:255], v[156:159], v[160:163]
    v_max3_f32 v166, v166, v140, v141
    v_max3_f32 v166, v166, v142, v143
    v_cvt_pk_bf16_f32 v37, v226, v227
    v_mfma_f32_16x16x16_f16 v[180:183], v[254:255], v[252:253], v[180:183]
    v_cvt_pk_bf16_f32 v39, v144, 0
    v_mfma_f32_16x16x32_bf16 v[160:163], v[84:87], v[200:203], v[160:163]
    v_mfma_f32_16x16x32_bf16 v[160:163], v[88:91], v[188:191], v[160:163]
    v_mfma_f32_16x16x32_bf16 v[144:147], v[28:31], v[36:39], 0
    v_mfma_f32_16x16x32_bf16 v[144:147], v[28:31], v[152:155], v[144:147]
    v_mfma_f32_16x16x32_bf16 v[240:243], v[204:207], v[36:39], 0
    v_mfma_f32_16x16x32_bf16 v[240:243], v[184:187], v[152:155], v[240:243]
    v_mfma_f32_16x16x32_bf16 v[176:179], v[172:175], v[36:39], 0
    v_max3_f32 v166, v166, v180, v181
    v_max3_f32 v166, v166, v182, v183
    v_mfma_f32_16x16x32_bf16 v[176:179], v[136:139], v[152:155], v[176:179]
    v_fmac_f32 v170, v160, v160
    v_fmac_f32 v170, v161, v161
    v_mfma_f32_16x16x32_bf16 v[192:195], v[132:135], v[36:39], 0
    v_fmac_f32 v170, v162, v162
    v_fmac_f32 v170, v163, v163
    v_mfma_f32_16x16x32_bf16 v[192:195], v[212:215], v[152:155], v[192:195]
    v_rcp_f32 v144, v144
    v_mfma_f32_16x16x32_bf16 v[152:155], v[92:95], v[120:123], 0
    v_mov_b32 v145, v166
    v_mul_f32 v240, v144, v240
    v_mfma_f32_16x16x32_bf16 v[152:155], v[96:99], v[244:247], v[152:155]
    v_permlane32_swap_b32 v166, v145
    v_mfma_f32_16x16x32_bf16 v[152:155], v[100:103], v[216:219], v[152:155]
    v_max_f32 v166, v166, v145
    v_mov_b32 v145, v166
    v_mfma_f32_16x16x32_bf16 v[152:155], v[104:107], v[156:159], v[152:155]
    v_mul_f32 v241, v144, v241
    v_cvt_pk_bf16_f32 v120, v240, v241
    v_mfma_f32_16x16x32_bf16 v[152:155], v[108:111], v[200:203], v[152:155]
    v_permlane16_swap_b32 v166, v145
    v_mfma_f32_16x16x32_bf16 v[152:155], v[112:115], v[188:191], v[152:155]
    v_max_f32 v166, v166, v145
    v_sub_f32 v228, v228, v166
    v_exp_f32 v228, v228
    v_sub_f32 v229, v229, v166
    v_exp_f32 v229, v229
    v_sub_f32 v230, v230, v166
    v_cvt_pk_bf16_f32 v188, v228, v229
    v_exp_f32 v230, v230
    v_fmac_f32 v170, v152, v152
    v_fmac_f32 v170, v153, v153
    v_fmac_f32 v170, v154, v154
    v_fmac_f32 v170, v155, v155
    v_cvt_pk_bf16_f32 v228, v116, v170
    v_cvt_pk_bf16_f32 v229, v170, v170
    ds_write_b64 v164, v[228:229] offset:2048
    v_sub_f32 v231, v231, v166
    v_exp_f32 v231, v231
    v_sub_f32 v140, v140, v166
    v_cvt_pk_bf16_f32 v189, v230, v231
    v_exp_f32 v140, v140
    v_sub_f32 v141, v141, v166
    v_exp_f32 v141, v141
    v_sub_f32 v142, v142, v166
    v_cvt_pk_bf16_f32 v190, v140, v141
    v_exp_f32 v142, v142
    v_sub_f32 v143, v143, v166
    v_exp_f32 v143, v143
    v_sub_f32 v180, v180, v166
    v_cvt_pk_bf16_f32 v191, v142, v143
    v_exp_f32 v180, v180
    v_sub_f32 v181, v181, v166
    s_waitcnt lgkmcnt(0)
    s_barrier
    s_barrier
    ds_read_b128 v[200:203], v118 offset:2048
    ds_read_b128 v[228:231], v118 offset:3072
    ds_read_b128 v[220:223], v167 offset:0
    ds_read_b128 v[216:219], v167 offset:1024
    ds_read_b128 v[224:227], v167 offset:2048
    ds_read_b128 v[236:239], v167 offset:3072
    ds_read_b128 v[140:143], v167 offset:4096
    ds_read_b128 v[156:159], v167 offset:5120
    v_exp_f32 v181, v181
    v_sub_f32 v182, v182, v166
    s_waitcnt lgkmcnt(7)
    v_mfma_f32_16x16x32_bf16 v[196:199], v[32:35], v[200:203], 0
    s_waitcnt lgkmcnt(5)
    v_cvt_pk_bf16_f32 v36, v180, v181
    v_sub_f32 v183, v183, v166
    v_mfma_f32_16x16x32_bf16 v[196:199], v[32:35], v[228:231], v[196:199]
    s_waitcnt lgkmcnt(4)
    v_exp_f32 v182, v182
    v_mfma_f32_16x16x32_bf16 v[228:231], a[216:219], v[220:223], 0
    s_waitcnt lgkmcnt(3)
    v_exp_f32 v183, v183
    v_mfma_f32_16x16x32_bf16 v[228:231], a[220:223], v[216:219], v[228:231]
    s_waitcnt lgkmcnt(2)
    ds_read_b128 v[252:255], v9
    ds_read_b128 v[244:247], v9 offset:64
    v_mfma_f32_16x16x32_bf16 v[228:231], a[224:227], v[224:227], v[228:231]
    s_waitcnt lgkmcnt(3)
    v_mul_f32 v116, 0x3baaaaab, v196
    v_cvt_pk_bf16_f32 v37, v182, v183
    v_mfma_f32_16x16x32_bf16 v[228:231], a[228:231], v[236:239], v[228:231]
    s_waitcnt lgkmcnt(2)
    v_rsq_f32 v116, v116
    v_mfma_f32_16x16x32_bf16 v[228:231], a[232:235], v[140:143], v[228:231]
    v_mul_f32 v248, v116, v248
    v_mul_f32 v249, v116, v249
    v_mfma_f32_16x16x32_bf16 v[228:231], a[236:239], v[156:159], v[228:231]
    v_cvt_pk_bf16_f32 v248, v248, v249
    v_mul_f32 v250, v116, v250
    v_mfma_f32_16x16x32_bf16 v[200:203], a[240:243], v[220:223], 0
    v_mul_f32 v251, v116, v251
    v_cvt_pk_bf16_f32 v249, v250, v251
    v_mfma_f32_16x16x32_bf16 v[200:203], a[244:247], v[216:219], v[200:203]
    v_mul_f32 v232, v116, v232
    v_mul_f32 v233, v116, v233
    v_mfma_f32_16x16x32_bf16 v[200:203], a[248:251], v[224:227], v[200:203]
    s_waitcnt lgkmcnt(0)
    v_cvt_pk_bf16_f32 v250, v232, v233
    v_mul_f32 v234, v116, v234
    v_mfma_f32_16x16x32_bf16 v[200:203], a[252:255], v[236:239], v[200:203]
    v_mul_f32 v235, v116, v235
    v_cvt_pk_bf16_f32 v251, v234, v235
    v_mfma_f32_16x16x32_bf16 v[200:203], v[84:87], v[140:143], v[200:203]
    buffer_store_dwordx4 v[248:251], v17, s[52:55], 0 offen nt
    v_mul_f32 v148, v116, v148
    v_mul_f32 v149, v116, v149
    v_cvt_pk_bf16_f32 v198, v148, v149
    v_mul_f32 v150, v116, v150
    v_mfma_f32_16x16x32_bf16 v[248:251], v[252:255], v[28:31], 0
    v_mul_f32 v151, v116, v151
    v_cvt_pk_bf16_f32 v199, v150, v151
    v_mfma_f32_16x16x32_bf16 v[248:251], v[244:247], v[28:31], v[248:251]
    v_sub_f32 v168, v168, v166
    v_fma_f32 v116, v228, v228, s33
    v_mfma_f32_16x16x32_bf16 v[148:151], v[252:255], v[184:187], 0
    v_exp_f32 v168, v168
    v_mfma_f32_16x16x32_bf16 v[148:151], v[244:247], v[204:207], v[148:151]
    v_cvt_pk_bf16_f32 v39, v168, 0
    v_fmac_f32 v116, v229, v229
    v_mfma_f32_16x16x32_bf16 v[180:183], v[252:255], v[136:139], 0
    v_fmac_f32 v116, v230, v230
    v_fmac_f32 v116, v231, v231
    v_mfma_f32_16x16x32_bf16 v[232:235], v[28:31], v[36:39], 0
    v_mul_f32 v242, v144, v242
    v_mul_f32 v243, v144, v243
    v_mfma_f32_16x16x32_bf16 v[232:235], v[28:31], v[188:191], v[232:235]
    v_cvt_pk_bf16_f32 v121, v242, v243
    v_mul_f32 v176, v144, v176
    v_mfma_f32_16x16x32_bf16 v[240:243], v[204:207], v[36:39], 0
    v_mul_f32 v177, v144, v177
    v_cvt_pk_bf16_f32 v122, v176, v177
    v_mfma_f32_16x16x32_bf16 v[240:243], v[184:187], v[188:191], v[240:243]
    v_mul_f32 v178, v144, v178
    v_mul_f32 v179, v144, v179
    v_mfma_f32_16x16x32_bf16 v[184:187], v[172:175], v[36:39], 0
    v_cvt_pk_bf16_f32 v123, v178, v179
    v_mul_f32 v192, v144, v192
    v_mfma_f32_16x16x32_bf16 v[184:187], v[136:139], v[188:191], v[184:187]
    ds_write_b128 v3, v[120:123] offset:6144
    v_mfma_f32_16x16x32_bf16 v[176:179], v[132:135], v[36:39], 0
    v_mul_f32 v193, v144, v193
    v_cvt_pk_bf16_f32 v192, v192, v193
    v_mfma_f32_16x16x32_bf16 v[176:179], v[212:215], v[188:191], v[176:179]
    v_mul_f32 v194, v144, v194
    v_mul_f32 v195, v144, v195
    v_mfma_f32_16x16x32_bf16 v[180:183], v[244:247], v[172:175], v[180:183]
    v_cvt_pk_bf16_f32 v193, v194, v195
    v_mul_f32 v166, 0x3baaaaab, v197
    v_mfma_f32_16x16x32_bf16 v[136:139], v[252:255], v[212:215], 0
    ds_write_b64 v4, v[192:193] offset:10240
    v_mfma_f32_16x16x32_bf16 v[136:139], v[244:247], v[132:135], v[136:139]
    buffer_store_dwordx2 v[198:199], v20, s[52:55], 0 offen nt
    v_rcp_f32 v232, v232
    v_mfma_f32_16x16x32_bf16 v[200:203], v[88:91], v[156:159], v[200:203]
    v_mul_f32 v240, v232, v240
    v_mul_f32 v241, v232, v241
    v_mfma_f32_16x16x32_bf16 v[188:191], v[92:95], v[220:223], 0
    v_cvt_pk_bf16_f32 v172, v240, v241
    v_mul_f32 v242, v232, v242
    v_mfma_f32_16x16x32_bf16 v[188:191], v[96:99], v[216:219], v[188:191]
    v_mul_f32 v243, v232, v243
    v_cvt_pk_bf16_f32 v173, v242, v243
    v_mfma_f32_16x16x32_bf16 v[188:191], v[100:103], v[224:227], v[188:191]
    v_fmac_f32 v116, v200, v200
    v_fmac_f32 v116, v201, v201
    v_mfma_f32_16x16x32_bf16 v[188:191], v[104:107], v[236:239], v[188:191]
    v_fmac_f32 v116, v202, v202
    v_fmac_f32 v116, v203, v203
    v_mfma_f32_16x16x32_bf16 v[188:191], v[108:111], v[140:143], v[188:191]
    v_mul_f32 v184, v232, v184
    v_mul_f32 v185, v232, v185
    v_mfma_f32_16x16x32_bf16 v[188:191], v[112:115], v[156:159], v[188:191]
    v_cvt_pk_bf16_f32 v174, v184, v185
    v_mul_f32 v186, v232, v186
    v_mul_f32 v187, v232, v187
    v_cvt_pk_bf16_f32 v175, v186, v187
    ds_write_b128 v3, v[172:175] offset:12288
    v_mul_f32 v176, v232, v176
    v_mul_f32 v177, v232, v177
    v_cvt_pk_bf16_f32 v138, v176, v177
    v_fmac_f32 v116, v188, v188
    v_fmac_f32 v116, v189, v189
    v_fmac_f32 v116, v190, v190
    v_fmac_f32 v116, v191, v191
    v_cvt_pk_bf16_f32 v176, v116, v116
    v_cvt_pk_bf16_f32 v177, v116, v116
    ds_write_b64 v164, v[176:177] offset:7616
    v_mul_f32 v178, v232, v178
    v_mul_f32 v179, v232, v179
    v_cvt_pk_bf16_f32 v139, v178, v179
    ds_write_b64 v4, v[138:139] offset:16384
    v_rcp_f32 v248, v248
    v_rsq_f32 v166, v166
    v_mul_f32 v148, v148, v248
    v_mul_f32_dpp v148, v180, v248 quad_perm:[0,1,2,3] row_mask:0x2 bank_mask:0xf
    v_mul_f32_dpp v148, v136, v248 quad_perm:[0,1,2,3] row_mask:0x4 bank_mask:0xf
    v_cvt_pk_bf16_f32 v148, v148, v148
    ds_write_b16 v7, v148
    v_mul_f32 v128, v166, v128
    v_mul_f32 v129, v166, v129
    v_cvt_pk_bf16_f32 v128, v128, v129
    v_mul_f32 v130, v166, v130
    v_mul_f32 v131, v166, v131
    v_cvt_pk_bf16_f32 v129, v130, v131
    v_mul_f32 v160, v166, v160
    v_mul_f32 v161, v166, v161
    v_cvt_pk_bf16_f32 v130, v160, v161
    v_mul_f32 v162, v166, v162
    v_mul_f32 v163, v166, v163
    v_cvt_pk_bf16_f32 v131, v162, v163
    buffer_store_dwordx4 v[128:131], v119, s[12:15], 0 offen nt
    v_mul_f32 v152, v166, v152
    v_mul_f32 v153, v166, v153
    v_cvt_pk_bf16_f32 v152, v152, v153
    v_mul_f32 v154, v166, v154
    v_mul_f32 v155, v166, v155
    v_cvt_pk_bf16_f32 v153, v154, v155
    s_waitcnt lgkmcnt(0)
    s_barrier
    ds_read_b128 v[156:159], v118 offset:7616
    ds_read_b128 v[128:131], v118 offset:8640
    ds_read_b128 v[160:163], v167 offset:6144
    ds_read_b128 v[176:179], v167 offset:7168
    ds_read_b128 v[136:139], v167 offset:8192
    ds_read_b128 v[148:151], v167 offset:9216
    ds_read_b128 v[184:187], v167 offset:10240
    ds_read_b128 v[232:235], v167 offset:11264
    s_waitcnt lgkmcnt(7)
    v_mfma_f32_16x16x32_bf16 v[248:251], v[32:35], v[156:159], 0
    s_waitcnt lgkmcnt(6)
    v_mfma_f32_16x16x32_bf16 v[248:251], v[32:35], v[128:131], v[248:251]
    s_waitcnt lgkmcnt(4)
    v_mfma_f32_16x16x32_bf16 v[128:131], a[216:219], v[160:163], 0
    s_waitcnt lgkmcnt(3)
    v_mfma_f32_16x16x32_bf16 v[128:131], a[220:223], v[176:179], v[128:131]
    s_waitcnt lgkmcnt(2)
    v_mfma_f32_16x16x32_bf16 v[128:131], a[224:227], v[136:139], v[128:131]
    s_waitcnt lgkmcnt(1)
    v_mfma_f32_16x16x32_bf16 v[128:131], a[228:231], v[148:151], v[128:131]
    s_waitcnt lgkmcnt(0)
    v_mul_f32 v166, 0x3baaaaab, v248
    v_mfma_f32_16x16x32_bf16 v[128:131], a[232:235], v[184:187], v[128:131]
    v_rsq_f32 v166, v166
    v_mfma_f32_16x16x32_bf16 v[128:131], a[236:239], v[232:235], v[128:131]
    v_mul_f32 v228, v166, v228
    v_mul_f32 v229, v166, v229
    v_mfma_f32_16x16x32_bf16 v[248:251], a[240:243], v[160:163], 0
    buffer_store_dwordx2 v[152:153], v126, s[12:15], 0 offen nt
    v_cvt_pk_bf16_f32 v156, v228, v229
    v_mul_f32 v230, v166, v230
    v_mfma_f32_16x16x32_bf16 v[248:251], a[244:247], v[176:179], v[248:251]
    v_mul_f32 v231, v166, v231
    v_fma_f32 v126, v128, v128, s33
    v_mfma_f32_16x16x32_bf16 v[248:251], a[248:251], v[136:139], v[248:251]
    v_fmac_f32 v126, v129, v129
    v_fmac_f32 v126, v130, v130
    v_mfma_f32_16x16x32_bf16 v[248:251], a[252:255], v[148:151], v[248:251]
    v_fmac_f32 v126, v131, v131
    v_cvt_pk_bf16_f32 v157, v230, v231
    v_mfma_f32_16x16x32_bf16 v[248:251], v[84:87], v[184:187], v[248:251]
    v_mul_f32 v200, v166, v200
    v_mul_f32 v201, v166, v201
    v_mfma_f32_16x16x32_bf16 v[248:251], v[88:91], v[232:235], v[248:251]
    ds_read_b128 v[228:231], v117 offset:256
    v_cvt_pk_bf16_f32 v158, v200, v201
    v_mfma_f32_16x16x32_bf16 v[180:183], v[92:95], v[160:163], 0
    ds_read_b128 v[152:155], v117 offset:2304
    v_mul_f32 v202, v166, v202
    v_mfma_f32_16x16x32_bf16 v[180:183], v[96:99], v[176:179], v[180:183]
    ds_read_b128 v[216:219], v117 offset:4352
    v_mul_f32 v203, v166, v203
    v_mfma_f32_16x16x32_bf16 v[180:183], v[100:103], v[136:139], v[180:183]
    ds_read_b128 v[160:163], v117 offset:6400
    v_fmac_f32 v126, v248, v248
    v_mfma_f32_16x16x32_bf16 v[180:183], v[104:107], v[148:151], v[180:183]
    ds_read_b128 v[176:179], v117 offset:8448
    v_fmac_f32 v126, v249, v249
    v_mfma_f32_16x16x32_bf16 v[180:183], v[108:111], v[184:187], v[180:183]
    ds_read_b128 v[184:187], v117 offset:10496
    v_fmac_f32 v126, v250, v250
    v_mfma_f32_16x16x32_bf16 v[180:183], v[112:115], v[232:235], v[180:183]
    v_fmac_f32 v126, v251, v251
    s_waitcnt lgkmcnt(5)
    v_mfma_f32_16x16x32_bf16 v[148:151], a[216:219], v[228:231], 0
    v_cvt_pk_bf16_f32 v159, v202, v203
    v_mul_f32 v188, v166, v188
    v_mfma_f32_16x16x32_bf16 v[200:203], a[240:243], v[228:231], 0
    s_waitcnt lgkmcnt(4)
    ds_write_b128 v124, v[156:159] offset:0
    v_mfma_f32_16x16x32_bf16 v[148:151], a[220:223], v[152:155], v[148:151]
    s_waitcnt lgkmcnt(3)
    v_fmac_f32 v126, v180, v180
    v_fmac_f32 v126, v181, v181
    v_mfma_f32_16x16x32_bf16 v[148:151], a[224:227], v[216:219], v[148:151]
    s_waitcnt lgkmcnt(2)
    v_fmac_f32 v126, v182, v182
    v_fmac_f32 v126, v183, v183
    v_mfma_f32_16x16x32_bf16 v[148:151], a[228:231], v[160:163], v[148:151]
    s_waitcnt lgkmcnt(1)
    ds_read_b128 v[232:235], v209 offset:0
    v_cvt_pk_bf16_f32 v116, v126, v126
    v_mfma_f32_16x16x32_bf16 v[148:151], a[232:235], v[176:179], v[148:151]
    v_cvt_pk_bf16_f32 v117, v126, v126
    v_mul_f32 v189, v166, v189
    v_mfma_f32_16x16x32_bf16 v[148:151], a[236:239], v[184:187], v[148:151]
    ds_write_b64 v164, v[116:117] offset:9664
    v_mfma_f32_16x16x32_bf16 v[200:203], a[244:247], v[152:155], v[200:203]
    v_cvt_pk_bf16_f32 v188, v188, v189
    v_mul_f32 v190, v166, v190
    v_mfma_f32_16x16x32_bf16 v[200:203], a[248:251], v[216:219], v[200:203]
    v_mul_f32 v191, v166, v191
    v_cvt_pk_bf16_f32 v189, v190, v191
    v_mfma_f32_16x16x32_bf16 v[200:203], a[252:255], v[160:163], v[200:203]
    ds_write_b64 v169, v[188:189] offset:1024
    v_mfma_f32_16x16x32_bf16 v[200:203], v[84:87], v[176:179], v[200:203]
    s_waitcnt lgkmcnt(2)
    buffer_store_dwordx4 v[232:235], v125, s[56:59], 0 offen nt
    v_fma_f32 v166, v148, v148, s33
    v_fmac_f32 v166, v149, v149
    v_fmac_f32 v166, v150, v150
    v_fmac_f32 v166, v151, v151
    v_mfma_f32_16x16x32_bf16 v[200:203], v[88:91], v[184:187], v[200:203]
    ds_read_b64 v[116:117], v127 offset:1024
    v_mfma_f32_16x16x32_bf16 v[188:191], v[92:95], v[228:231], 0
    s_waitcnt lgkmcnt(2)
    v_mfma_f32_16x16x32_bf16 v[188:191], v[96:99], v[152:155], v[188:191]
    s_barrier
    ds_read_b128 v[232:235], v118 offset:9664
    ds_read_b128 v[136:139], v118 offset:10688
    v_mfma_f32_16x16x32_bf16 v[188:191], v[100:103], v[216:219], v[188:191]
    ds_read_b128 v[152:155], v167 offset:12288
    ds_read_b128 v[156:159], v167 offset:13312
    v_mfma_f32_16x16x32_bf16 v[188:191], v[104:107], v[160:163], v[188:191]
    v_fmac_f32 v166, v200, v200
    v_fmac_f32 v166, v201, v201
    v_mfma_f32_16x16x32_bf16 v[188:191], v[108:111], v[176:179], v[188:191]
    ds_read_b128 v[228:231], v167 offset:14336
    ds_read_b128 v[160:163], v167 offset:15360
    v_mfma_f32_16x16x32_bf16 v[188:191], v[112:115], v[184:187], v[188:191]
    ds_read_b128 v[176:179], v167 offset:16384
    s_waitcnt lgkmcnt(7)
    buffer_store_dwordx2 v[116:117], v171, s[56:59], 0 offen nt
    ds_read_b128 v[184:187], v167 offset:17408
    v_fmac_f32 v166, v202, v202
    v_fmac_f32 v166, v203, v203
    s_nop 0
    s_waitcnt lgkmcnt(7)
    v_mfma_f32_16x16x32_bf16 v[216:219], v[32:35], v[232:235], 0
    s_waitcnt lgkmcnt(6)
    v_fmac_f32 v166, v188, v188
    v_fmac_f32 v166, v189, v189
    v_mfma_f32_16x16x32_bf16 v[216:219], v[32:35], v[136:139], v[216:219]
    s_waitcnt lgkmcnt(4)
    v_fmac_f32 v166, v190, v190
    v_fmac_f32 v166, v191, v191
    v_mfma_f32_16x16x32_bf16 v[232:235], a[216:219], v[152:155], 0
    v_cvt_pk_bf16_f32 v116, v166, v166
    v_cvt_pk_bf16_f32 v117, v166, v166
    v_mfma_f32_16x16x32_bf16 v[232:235], a[220:223], v[156:159], v[232:235]
    s_waitcnt lgkmcnt(2)
    ds_write_b64 v164, v[116:117] offset:17280
    v_mfma_f32_16x16x32_bf16 v[232:235], a[224:227], v[228:231], v[232:235]
    s_waitcnt lgkmcnt(2)
    v_mul_f32 v166, 0x3baaaaab, v216
    v_mfma_f32_16x16x32_bf16 v[232:235], a[228:231], v[160:163], v[232:235]
    s_waitcnt lgkmcnt(1)
    v_rsq_f32 v166, v166
    v_mfma_f32_16x16x32_bf16 v[232:235], a[232:235], v[176:179], v[232:235]
    v_mul_f32 v128, v166, v128
    v_mul_f32 v129, v166, v129
    v_mfma_f32_16x16x32_bf16 v[232:235], a[236:239], v[184:187], v[232:235]
    v_cvt_pk_bf16_f32 v128, v128, v129
    v_mul_f32 v130, v166, v130
    v_mfma_f32_16x16x32_bf16 v[136:139], a[240:243], v[152:155], 0
    v_mul_f32 v131, v166, v131
    v_cvt_pk_bf16_f32 v129, v130, v131
    v_mfma_f32_16x16x32_bf16 v[136:139], a[244:247], v[156:159], v[136:139]
    v_mul_f32 v248, v166, v248
    v_mul_f32 v249, v166, v249
    v_mfma_f32_16x16x32_bf16 v[136:139], a[248:251], v[228:231], v[136:139]
    v_cvt_pk_bf16_f32 v130, v248, v249
    v_mul_f32 v250, v166, v250
    v_mfma_f32_16x16x32_bf16 v[136:139], a[252:255], v[160:163], v[136:139]
    v_mul_f32 v251, v166, v251
    v_cvt_pk_bf16_f32 v131, v250, v251
    v_mfma_f32_16x16x32_bf16 v[136:139], v[84:87], v[176:179], v[136:139]
    buffer_store_dwordx4 v[128:131], v16, s[56:59], 0 offen nt
    v_mul_f32 v180, v166, v180
    v_mul_f32 v181, v166, v181
    v_cvt_pk_bf16_f32 v116, v180, v181
    v_mul_f32 v182, v166, v182
    v_mfma_f32_16x16x32_bf16 v[136:139], v[88:91], v[184:187], v[136:139]
    v_mul_f32 v183, v166, v183
    v_cvt_pk_bf16_f32 v117, v182, v183
    v_mfma_f32_16x16x32_bf16 v[128:131], v[92:95], v[152:155], 0
    v_fma_f32 v166, v232, v232, s33
    v_fmac_f32 v166, v233, v233
    v_mfma_f32_16x16x32_bf16 v[128:131], v[96:99], v[156:159], v[128:131]
    v_fmac_f32 v166, v234, v234
    v_fmac_f32 v166, v235, v235
    v_mfma_f32_16x16x32_bf16 v[128:131], v[100:103], v[228:231], v[128:131]
    v_fmac_f32 v166, v136, v136
    v_fmac_f32 v166, v137, v137
    v_mfma_f32_16x16x32_bf16 v[128:131], v[104:107], v[160:163], v[128:131]
    v_fmac_f32 v166, v138, v138
    v_fmac_f32 v166, v139, v139
    v_mfma_f32_16x16x32_bf16 v[128:131], v[108:111], v[176:179], v[128:131]
    v_mfma_f32_16x16x32_bf16 v[128:131], v[112:115], v[184:187], v[128:131]
    s_nop 0
    s_nop 0
    s_nop 0
    s_nop 0
    s_nop 0
    s_nop 0
    s_nop 0
    s_nop 0
    v_fmac_f32 v166, v128, v128
    v_fmac_f32 v166, v129, v129
    v_fmac_f32 v166, v130, v130
    v_fmac_f32 v166, v131, v131
    v_cvt_pk_bf16_f32 v170, v166, v166
    v_cvt_pk_bf16_f32 v171, v166, v166
    ds_write_b64 v164, v[170:171] offset:15232
    buffer_store_dwordx2 v[116:117], v19, s[56:59], 0 offen nt
    s_waitcnt lgkmcnt(0)
    s_barrier
    ds_read_b128 v[160:163], v118 offset:15232
    ds_read_b128 v[152:155], v118 offset:16256
    ds_read_b128 v[176:179], v118 offset:17280
    ds_read_b128 v[184:187], v118 offset:18304
    ds_read_b128 v[116:119], v167 offset:18432
    s_waitcnt lgkmcnt(4)
    v_mfma_f32_16x16x32_bf16 v[248:251], v[32:35], v[160:163], 0
    s_waitcnt lgkmcnt(3)
    v_mfma_f32_16x16x32_bf16 v[248:251], v[32:35], v[152:155], v[248:251]
    s_waitcnt lgkmcnt(1)
    v_mfma_f32_16x16x32_bf16 v[152:155], v[32:35], v[176:179], 0
    s_waitcnt lgkmcnt(0)
    v_or3_b32 v116, v116, v117, v118
    v_or_b32 v116, v116, v119
    v_mfma_f32_16x16x32_bf16 v[152:155], v[32:35], v[184:187], v[152:155]
    v_cmp_gt_i32 s[46:47], 0, v116
    s_nop 0
    v_mul_f32 v126, 0x3baaaaab, v248
    v_rsq_f32 v126, v126
    s_nop 0
    v_mul_f32 v232, v126, v232
    v_mul_f32 v233, v126, v233
    v_cvt_pk_bf16_f32 v176, v232, v233
    v_mul_f32 v125, 0x3baaaaab, v152
    v_rsq_f32 v125, v125
    v_mul_f32 v234, v126, v234
    v_mul_f32 v148, v125, v148
    v_mul_f32 v149, v125, v149
    v_cvt_pk_bf16_f32 v148, v148, v149
    v_mul_f32 v150, v125, v150
    v_mul_f32 v151, v125, v151
    v_cvt_pk_bf16_f32 v149, v150, v151
    v_mul_f32 v200, v125, v200
    v_mul_f32 v201, v125, v201
    v_cvt_pk_bf16_f32 v150, v200, v201
    v_mul_f32 v202, v125, v202
    v_mul_f32 v203, v125, v203
    v_cvt_pk_bf16_f32 v151, v202, v203
    buffer_store_dwordx4 v[148:151], v208, s[12:15], 0 offen nt
    v_mul_f32 v188, v125, v188
    v_mul_f32 v189, v125, v189
    v_cvt_pk_bf16_f32 v170, v188, v189
    v_mul_f32 v190, v125, v190
    v_mul_f32 v191, v125, v191
    v_cvt_pk_bf16_f32 v171, v190, v191
    v_mul_f32 v235, v126, v235
    v_cvt_pk_bf16_f32 v177, v234, v235
    v_mul_f32 v136, v126, v136
    v_mul_f32 v137, v126, v137
    v_cvt_pk_bf16_f32 v178, v136, v137
    v_mul_f32 v138, v126, v138
    v_mul_f32 v139, v126, v139
    v_cvt_pk_bf16_f32 v179, v138, v139
    ds_write_b128 v124, v[176:179] offset:3072
    v_mul_f32 v128, v126, v128
    v_mul_f32 v129, v126, v129
    v_cvt_pk_bf16_f32 v124, v128, v129
    v_mul_f32 v130, v126, v130
    v_mul_f32 v131, v126, v131
    v_cvt_pk_bf16_f32 v125, v130, v131
    buffer_store_dwordx2 v[170:171], v165, s[12:15], 0 offen nt
    ds_read_b128 v[128:131], v209 offset:3072
    ds_write_b64 v169, v[124:125] offset:4096
    ds_read_b64 v[208:209], v127 offset:4096
    s_waitcnt lgkmcnt(2)
    buffer_store_dwordx4 v[128:131], v211, s[56:59], 0 offen nt
    s_waitcnt lgkmcnt(0)
    buffer_store_dwordx2 v[208:209], v210, s[56:59], 0 offen nt
    s_branch L_end
L_drain:
    ds_read_b128 v[116:119], v2 offset:18432
    ds_read_b128 v[120:123], v2 offset:19456
    ds_read_b128 v[124:127], v2 offset:0
    s_mul_i32 s5, s16, 9408
    s_mov_b32 s12, s40
    ds_read_b128 v[136:139], v2 offset:1024
    s_mov_b32 s13, s41
    s_cmp_ge_u32 s18, 2
    s_cselect_b32 s14, s36, 0
    ds_read_b128 v[140:143], v2 offset:2048
    s_add_u32 s5, s5, 104448
    s_and_b32 s6, s2, 7
    s_sub_u32 s6, 0, s6
    ds_read_b128 v[144:147], v2 offset:3072
    s_lshl_b32 s3, s16, 6
    s_lshl_b32 s4, s16, 5
    s_add_u32 s4, s4, 256
    ds_read_b128 v[148:151], v2 offset:4096
    ds_read_b128 v[152:155], v2 offset:5120
    v_bfe_u32 v156, v2, 4, 6
    v_lshrrev_b32 v157, 4, v156
    v_and_b32 v158, 15, v156
    v_lshlrev_b32 v159, 9, v157
    v_lshl_add_u32 v159, v158, 4, v159
    v_add_u32 v159, 149696, v159
    s_waitcnt lgkmcnt(7)
    v_mfma_f32_16x16x32_bf16 v[160:163], v[32:35], v[116:119], 0
    s_waitcnt lgkmcnt(5)
    v_xor_b32 v116, 65536, v2
    v_bfe_u32 v117, v158, 1, 2
    v_mfma_f32_16x16x32_bf16 v[160:163], v[32:35], v[120:123], v[160:163]
    s_waitcnt lgkmcnt(4)
    v_xor_b32 v117, v117, v157
    v_lshl_add_u32 v117, v158, 2, v117
    v_lshl_add_u32 v118, v117, 4, s5
    v_mfma_f32_16x16x32_bf16 v[120:123], a[216:219], v[124:127], 0
    s_waitcnt lgkmcnt(3)
    v_lshl_add_u32 v119, v117, 3, s5
    v_lshl_add_u32 v164, v156, 4, s5
    v_lshl_add_u32 v165, v156, 3, s5
    v_mfma_f32_16x16x32_bf16 v[120:123], a[220:223], v[136:139], v[120:123]
    s_waitcnt lgkmcnt(2)
    v_lshlrev_b32 v117, 2, v117
    v_mul_f32 v160, 0x3baaaaab, v160
    v_rsq_f32 v160, v160
    v_mfma_f32_16x16x32_bf16 v[120:123], a[224:227], v[140:143], v[120:123]
    s_waitcnt lgkmcnt(0)
    ds_permute_b32 v166, v117, v15
    ds_permute_b32 v167, v117, v18
    v_mul_f32 v128, v160, v128
    v_mfma_f32_16x16x32_bf16 v[120:123], a[228:231], v[144:147], v[120:123]
    ds_permute_b32 v163, v117, v16
    ds_permute_b32 v168, v117, v19
    v_mul_f32 v129, v160, v129
    v_mfma_f32_16x16x32_bf16 v[120:123], a[232:235], v[148:151], v[120:123]
    ds_permute_b32 v169, v117, v17
    ds_permute_b32 v170, v117, v20
    v_cvt_pk_bf16_f32 v128, v128, v129
    v_mfma_f32_16x16x32_bf16 v[120:123], a[236:239], v[152:155], v[120:123]
    v_mul_f32 v130, v160, v130
    v_mul_f32 v131, v160, v131
    v_cvt_pk_bf16_f32 v129, v130, v131
    v_mfma_f32_16x16x32_bf16 v[172:175], a[240:243], v[124:127], 0
    v_mul_f32 v188, v160, v188
    v_mul_f32 v189, v160, v189
    v_cvt_pk_bf16_f32 v130, v188, v189
    v_mfma_f32_16x16x32_bf16 v[172:175], a[244:247], v[136:139], v[172:175]
    v_mul_f32 v190, v160, v190
    v_mul_f32 v191, v160, v191
    v_cvt_pk_bf16_f32 v131, v190, v191
    v_mfma_f32_16x16x32_bf16 v[172:175], a[248:251], v[140:143], v[172:175]
    s_waitcnt lgkmcnt(4)
    ds_read_b128 v[180:183], v2 offset:6144
    v_mul_f32 v176, v160, v176
    v_mul_f32 v177, v160, v177
    v_mfma_f32_16x16x32_bf16 v[172:175], a[252:255], v[144:147], v[172:175]
    s_waitcnt lgkmcnt(3)
    ds_read_b128 v[184:187], v2 offset:7168
    v_cvt_pk_bf16_f32 v176, v176, v177
    v_mul_f32 v178, v160, v178
    v_mfma_f32_16x16x32_bf16 v[172:175], v[84:87], v[148:151], v[172:175]
    s_waitcnt lgkmcnt(2)
    ds_read_b128 v[188:191], v2 offset:8192
    v_mul_f32 v179, v160, v179
    v_cvt_pk_bf16_f32 v177, v178, v179
    v_mfma_f32_16x16x32_bf16 v[172:175], v[88:91], v[152:155], v[172:175]
    ds_read_b128 v[192:195], v2 offset:9216
    v_fma_f32 v117, v120, v120, s33
    v_fmac_f32 v117, v121, v121
    v_mfma_f32_16x16x32_bf16 v[204:207], v[92:95], v[124:127], 0
    ds_read_b128 v[124:127], v2 offset:10240
    v_fmac_f32 v117, v122, v122
    v_fmac_f32 v117, v123, v123
    v_mfma_f32_16x16x32_bf16 v[204:207], v[96:99], v[136:139], v[204:207]
    ds_read_b128 v[136:139], v2 offset:11264
    v_fmac_f32 v117, v172, v172
    v_fmac_f32 v117, v173, v173
    v_mfma_f32_16x16x32_bf16 v[204:207], v[100:103], v[140:143], v[204:207]
    s_waitcnt lgkmcnt(5)
    buffer_store_dwordx4 v[128:131], v15, s[12:15], s27 offen nt
    v_fmac_f32 v117, v174, v174
    v_fmac_f32 v117, v175, v175
    v_mul_f32 v171, 0x3baaaaab, v161
    v_mfma_f32_16x16x32_bf16 v[204:207], v[104:107], v[144:147], v[204:207]
    s_waitcnt lgkmcnt(4)
    v_rsq_f32 v171, v171
    v_subrev_u32 v178, 0x3d800000, v44
    v_mfma_f32_16x16x32_bf16 v[204:207], v[108:111], v[148:151], v[204:207]
    s_waitcnt lgkmcnt(3)
    v_mul_f32 v196, v171, v196
    v_mul_f32 v197, v171, v197
    v_cvt_pk_bf16_f32 v128, v196, v197
    v_mfma_f32_16x16x32_bf16 v[204:207], v[112:115], v[152:155], v[204:207]
    s_waitcnt lgkmcnt(2)
    v_mul_f32 v198, v171, v198
    v_mul_f32 v199, v171, v199
    v_cvt_pk_bf16_f32 v129, v198, v199
    v_mfma_f32_16x16x32_bf16 v[140:143], a[216:219], v[180:183], 0
    s_waitcnt lgkmcnt(1)
    v_mul_f32 v132, v171, v132
    v_mul_f32 v133, v171, v133
    v_fmac_f32 v117, v204, v204
    v_mfma_f32_16x16x32_bf16 v[140:143], a[220:223], v[184:187], v[140:143]
    s_waitcnt lgkmcnt(0)
    v_fmac_f32 v117, v205, v205
    v_fmac_f32 v117, v206, v206
    v_fmac_f32 v117, v207, v207
    v_mfma_f32_16x16x32_bf16 v[140:143], a[224:227], v[188:191], v[140:143]
    v_cvt_pk_bf16_f32 v130, v132, v133
    v_mul_f32 v134, v171, v134
    v_mul_f32 v135, v171, v135
    v_mfma_f32_16x16x32_bf16 v[140:143], a[228:231], v[192:195], v[140:143]
    v_cvt_pk_bf16_f32 v131, v134, v135
    v_mul_f32 v212, v171, v212
    v_mul_f32 v213, v171, v213
    v_mfma_f32_16x16x32_bf16 v[140:143], a[232:235], v[124:127], v[140:143]
    v_cvt_pk_bf16_f32 v160, v212, v213
    v_mul_f32 v214, v171, v214
    v_mul_f32 v215, v171, v215
    v_mfma_f32_16x16x32_bf16 v[140:143], a[236:239], v[136:139], v[140:143]
    v_cvt_pk_bf16_f32 v161, v214, v215
    v_sub_u32 v171, 0x4a000000, v45
    v_or3_b32 v178, v178, v171, v45
    v_mfma_f32_16x16x32_bf16 v[132:135], a[240:243], v[180:183], 0
    v_lshl_add_u32 v171, s16, 2, v116
    v_mul_f32 v162, 0x3baaaaab, v162
    v_rsq_f32 v162, v162
    v_mfma_f32_16x16x32_bf16 v[132:135], a[244:247], v[184:187], v[132:135]
    ds_write_b32 v171, v178 offset:18432
    v_fma_f32 v171, v140, v140, s33
    v_mfma_f32_16x16x32_bf16 v[132:135], a[248:251], v[188:191], v[132:135]
    v_fmac_f32 v171, v141, v141
    v_fmac_f32 v171, v142, v142
    v_fmac_f32 v171, v143, v143
    v_mfma_f32_16x16x32_bf16 v[132:135], a[252:255], v[192:195], v[132:135]
    ds_read_b128 v[144:147], v2 offset:12288
    ds_read_b128 v[148:151], v2 offset:13312
    v_mul_f32 v200, v162, v200
    v_mfma_f32_16x16x32_bf16 v[132:135], v[84:87], v[124:127], v[132:135]
    ds_read_b128 v[152:155], v2 offset:14336
    v_mul_f32 v201, v162, v201
    v_cvt_pk_bf16_f32 v196, v200, v201
    v_mfma_f32_16x16x32_bf16 v[132:135], v[88:91], v[136:139], v[132:135]
    ds_read_b128 v[212:215], v2 offset:15360
    v_mul_f32 v202, v162, v202
    v_mul_f32 v203, v162, v203
    v_mfma_f32_16x16x32_bf16 v[220:223], v[92:95], v[180:183], 0
    ds_read_b128 v[180:183], v2 offset:16384
    v_cvt_pk_bf16_f32 v197, v202, v203
    v_mul_f32 v216, v162, v216
    v_mfma_f32_16x16x32_bf16 v[220:223], v[96:99], v[184:187], v[220:223]
    ds_read_b128 v[184:187], v2 offset:17408
    v_fmac_f32 v171, v132, v132
    v_fmac_f32 v171, v133, v133
    v_mfma_f32_16x16x32_bf16 v[220:223], v[100:103], v[188:191], v[220:223]
    buffer_store_dwordx2 v[176:177], v18, s[12:15], s27 offen nt
    v_fmac_f32 v171, v134, v134
    v_mfma_f32_16x16x32_bf16 v[220:223], v[104:107], v[192:195], v[220:223]
    s_waitcnt lgkmcnt(4)
    v_fmac_f32 v171, v135, v135
    v_mul_f32 v217, v162, v217
    v_cvt_pk_bf16_f32 v198, v216, v217
    v_mfma_f32_16x16x32_bf16 v[220:223], v[108:111], v[124:127], v[220:223]
    s_waitcnt lgkmcnt(3)
    v_mul_f32 v218, v162, v218
    v_mul_f32 v219, v162, v219
    v_cvt_pk_bf16_f32 v199, v218, v219
    v_mfma_f32_16x16x32_bf16 v[220:223], v[112:115], v[136:139], v[220:223]
    s_waitcnt lgkmcnt(2)
    ds_write_b128 v118, v[196:199] offset:3072
    v_mfma_f32_16x16x32_bf16 v[124:127], a[216:219], v[144:147], 0
    s_waitcnt lgkmcnt(2)
    v_mul_f32 v208, v162, v208
    v_mul_f32 v209, v162, v209
    v_cvt_pk_bf16_f32 v208, v208, v209
    v_mfma_f32_16x16x32_bf16 v[124:127], a[220:223], v[148:151], v[124:127]
    s_waitcnt lgkmcnt(1)
    v_fmac_f32 v171, v220, v220
    v_fmac_f32 v171, v221, v221
    v_fmac_f32 v171, v222, v222
    v_mfma_f32_16x16x32_bf16 v[124:127], a[224:227], v[152:155], v[124:127]
    ds_read_b128 v[136:139], v164 offset:3072
    v_fmac_f32 v171, v223, v223
    v_cvt_pk_bf16_f32 v176, v117, v171
    v_mfma_f32_16x16x32_bf16 v[124:127], a[228:231], v[212:215], v[124:127]
    v_cvt_pk_bf16_f32 v177, v171, v171
    v_mul_f32 v210, v162, v210
    v_mul_f32 v211, v162, v211
    v_mfma_f32_16x16x32_bf16 v[124:127], a[232:235], v[180:183], v[124:127]
    ds_write_b64 v4, v[176:177] offset:0
    v_mfma_f32_16x16x32_bf16 v[124:127], a[236:239], v[184:187], v[124:127]
    v_cvt_pk_bf16_f32 v209, v210, v211
    v_mov_b32 v117, 0x40000000
    v_lshrrev_b32 v162, 2, v156
    v_mfma_f32_16x16x32_bf16 v[176:179], a[240:243], v[144:147], 0
    ds_write_b64 v119, v[208:209] offset:4096
    v_mfma_f32_16x16x32_bf16 v[176:179], a[244:247], v[148:151], v[176:179]
    v_lshrrev_b32 v171, 3, v156
    v_xor_b32 v171, v171, v156
    v_fma_f32 v156, v124, v124, s33
    v_mfma_f32_16x16x32_bf16 v[176:179], a[248:251], v[152:155], v[176:179]
    s_waitcnt lgkmcnt(2)
    ds_read_b128 v[188:191], v159 offset:0
    ds_read_b64 v[192:193], v165 offset:4096
    v_fmac_f32 v156, v125, v125
    v_mfma_f32_16x16x32_bf16 v[176:179], a[252:255], v[212:215], v[176:179]
    ds_read_b128 v[196:199], v159 offset:2048
    v_fmac_f32 v156, v126, v126
    v_fmac_f32 v156, v127, v127
    v_mfma_f32_16x16x32_bf16 v[176:179], v[84:87], v[180:183], v[176:179]
    s_waitcnt lgkmcnt(4)
    ds_read_b128 v[200:203], v159 offset:4096
    v_and_b32 v171, 3, v171
    v_add_u32 v162, 0, v162
    v_mfma_f32_16x16x32_bf16 v[176:179], v[88:91], v[184:187], v[176:179]
    s_barrier
    ds_read_b128 v[208:211], v116 offset:0
    ds_read_b128 v[216:219], v116 offset:1024
    v_mul_u32_u24 v194, s20, v162
    v_mfma_f32_16x16x32_bf16 v[224:227], v[92:95], v[144:147], 0
    ds_read_b128 v[144:147], v159 offset:6144
    ds_read_b128 v[228:231], v159 offset:8192
    v_add_u32 v194, s38, v194
    v_mfma_f32_16x16x32_bf16 v[224:227], v[96:99], v[148:151], v[224:227]
    ds_read_b128 v[148:151], v159 offset:10240
    v_fmac_f32 v156, v176, v176
    v_fmac_f32 v156, v177, v177
    v_mfma_f32_16x16x32_bf16 v[224:227], v[100:103], v[152:155], v[224:227]
    s_waitcnt lgkmcnt(7)
    buffer_store_dwordx4 v[128:131], v16, s[12:15], s27 offen nt
    ds_read_b128 v[152:155], v116 offset:18432
    v_fmac_f32 v156, v178, v178
    v_fmac_f32 v156, v179, v179
    v_mfma_f32_16x16x32_bf16 v[224:227], v[104:107], v[212:215], v[224:227]
    s_waitcnt lgkmcnt(7)
    v_mul_u32_u24 v195, 911, v194
    v_lshrrev_b32 v195, 16, v195
    v_mul_u32_u24 v195, s22, v195
    v_mfma_f32_16x16x32_bf16 v[224:227], v[108:111], v[180:183], v[224:227]
    s_waitcnt lgkmcnt(6)
    v_mad_u32_u24 v195, v162, s21, v195
    v_bfe_u32 v194, s63, v162, 1
    v_cmp_ne_u32 vcc, 0, v194
    v_mfma_f32_16x16x32_bf16 v[224:227], v[112:115], v[184:187], v[224:227]
    s_waitcnt lgkmcnt(4)
    v_add_u32 v162, s7, v195
    v_cndmask_b32 v162, v117, v162, vcc
    v_mfma_f32_16x16x32_bf16 v[128:131], v[32:35], v[208:211], 0
    s_waitcnt lgkmcnt(2)
    v_lshl_add_u32 v194, v171, 4, v162
    v_add_u32 v194, s3, v194
    v_mfma_f32_16x16x32_bf16 v[128:131], v[32:35], v[216:219], v[128:131]
    s_waitcnt lgkmcnt(1)
    v_fmac_f32 v156, v224, v224
    v_fmac_f32 v156, v225, v225
    v_fmac_f32 v156, v226, v226
    v_mfma_f32_16x16x32_bf16 v[180:183], a[216:219], v[188:191], 0
    v_fmac_f32 v156, v227, v227
    v_cvt_pk_bf16_f32 v184, v156, v156
    v_cvt_pk_bf16_f32 v185, v156, v156
    v_mfma_f32_16x16x32_bf16 v[180:183], a[220:223], v[196:199], v[180:183]
    s_waitcnt lgkmcnt(0)
    ds_write_b64 v4, v[184:185] offset:2048
    v_mfma_f32_16x16x32_bf16 v[180:183], a[224:227], v[200:203], v[180:183]
    v_lshl_add_u32 v171, v171, 3, v162
    v_add_u32 v171, s4, v171
    v_add_u32 v162, 16, v158
    v_mfma_f32_16x16x32_bf16 v[180:183], a[228:231], v[144:147], v[180:183]
    v_min_u32 v195, 20, v162
    v_add_u32 v130, 12, v162
    v_lshrrev_b32 v130, 5, v130
    v_mfma_f32_16x16x32_bf16 v[180:183], a[232:235], v[228:231], v[180:183]
    v_sub_u32 v131, v162, v195
    v_mad_i32_i24 v131, v130, s6, v131
    v_mul_u32_u24 v156, s20, v195
    v_mfma_f32_16x16x32_bf16 v[180:183], a[236:239], v[148:151], v[180:183]
    v_add3_u32 v156, v156, v131, s38
    v_mul_u32_u24 v130, 911, v156
    v_lshrrev_b32 v130, 16, v130
    v_mfma_f32_16x16x32_bf16 v[184:187], a[240:243], v[188:191], 0
    v_mul_u32_u24 v130, s22, v130
    v_mad_u32_u24 v130, v195, s21, v130
    v_bfe_u32 v156, s63, v162, 1
    v_mfma_f32_16x16x32_bf16 v[184:187], a[244:247], v[196:199], v[184:187]
    buffer_store_dwordx2 v[160:161], v19, s[12:15], s27 offen nt
    v_fma_f32 v195, v180, v180, s33
    v_mfma_f32_16x16x32_bf16 v[184:187], a[248:251], v[200:203], v[184:187]
    ds_read_b128 v[208:211], v159 offset:256
    v_fmac_f32 v195, v181, v181
    v_fmac_f32 v195, v182, v182
    v_mfma_f32_16x16x32_bf16 v[184:187], a[252:255], v[144:147], v[184:187]
    ds_read_b128 v[212:215], v159 offset:2304
    v_fmac_f32 v195, v183, v183
    v_cmp_ne_u32 vcc, 0, v156
    v_mfma_f32_16x16x32_bf16 v[184:187], v[84:87], v[228:231], v[184:187]
    ds_read_b128 v[216:219], v159 offset:4352
    v_mul_i32_i24 v131, 2688, v131
    v_add3_u32 v130, v130, v131, s7
    v_mfma_f32_16x16x32_bf16 v[184:187], v[88:91], v[148:151], v[184:187]
    ds_read_b128 v[232:235], v159 offset:6400
    v_cndmask_b32 v130, v117, v130, vcc
    v_lshl_add_u32 v117, v157, 4, v130
    v_mfma_f32_16x16x32_bf16 v[236:239], v[92:95], v[188:191], 0
    ds_read_b128 v[188:191], v159 offset:8448
    v_add_u32 v117, s3, v117
    v_lshl_add_u32 v160, v157, 3, v130
    v_mfma_f32_16x16x32_bf16 v[236:239], v[96:99], v[196:199], v[236:239]
    ds_read_b128 v[196:199], v159 offset:10496
    v_fmac_f32 v195, v184, v184
    v_fmac_f32 v195, v185, v185
    v_mfma_f32_16x16x32_bf16 v[236:239], v[100:103], v[200:203], v[236:239]
    s_waitcnt lgkmcnt(5)
    v_fmac_f32 v195, v186, v186
    v_fmac_f32 v195, v187, v187
    v_add_u32 v160, s4, v160
    v_mfma_f32_16x16x32_bf16 v[236:239], v[104:107], v[144:147], v[236:239]
    s_waitcnt lgkmcnt(4)
    v_mul_f32 v161, 0x3baaaaab, v128
    v_mul_f32 v162, 0x3baaaaab, v129
    v_rsq_f32 v161, v161
    v_mfma_f32_16x16x32_bf16 v[236:239], v[108:111], v[228:231], v[236:239]
    s_waitcnt lgkmcnt(3)
    v_mul_f32 v120, v161, v120
    v_mul_f32 v121, v161, v121
    v_cvt_pk_bf16_f32 v120, v120, v121
    v_mfma_f32_16x16x32_bf16 v[236:239], v[112:115], v[148:151], v[236:239]
    s_waitcnt lgkmcnt(2)
    v_mul_f32 v122, v161, v122
    v_mul_f32 v123, v161, v123
    v_cvt_pk_bf16_f32 v121, v122, v123
    v_mfma_f32_16x16x32_bf16 v[128:131], a[216:219], v[208:211], 0
    s_waitcnt lgkmcnt(1)
    v_mul_f32 v172, v161, v172
    v_mul_f32 v173, v161, v173
    v_fmac_f32 v195, v236, v236
    v_mfma_f32_16x16x32_bf16 v[128:131], a[220:223], v[212:215], v[128:131]
    s_waitcnt lgkmcnt(0)
    v_fmac_f32 v195, v237, v237
    v_fmac_f32 v195, v238, v238
    v_fmac_f32 v195, v239, v239
    v_mfma_f32_16x16x32_bf16 v[128:131], a[224:227], v[216:219], v[128:131]
    buffer_store_dwordx4 v[136:139], v169, s[12:15], s27 offen nt
    v_cvt_pk_bf16_f32 v144, v195, v195
    v_cvt_pk_bf16_f32 v145, v195, v195
    v_cvt_pk_bf16_f32 v122, v172, v173
    v_mfma_f32_16x16x32_bf16 v[128:131], a[228:231], v[232:235], v[128:131]
    ds_write_b64 v4, v[144:145] offset:4096
    v_mfma_f32_16x16x32_bf16 v[128:131], a[232:235], v[188:191], v[128:131]
    v_mul_f32 v174, v161, v174
    v_mul_f32 v175, v161, v175
    v_cvt_pk_bf16_f32 v123, v174, v175
    v_mfma_f32_16x16x32_bf16 v[128:131], a[236:239], v[196:199], v[128:131]
    ds_write_b128 v118, v[120:123] offset:4608
    v_mfma_f32_16x16x32_bf16 v[120:123], a[240:243], v[208:211], 0
    buffer_store_dwordx2 v[192:193], v170, s[12:15], s27 offen nt
    v_mul_f32 v204, v161, v204
    v_mfma_f32_16x16x32_bf16 v[120:123], a[244:247], v[212:215], v[120:123]
    s_mov_b32 s14, s36
    v_mul_f32 v205, v161, v205
    v_cvt_pk_bf16_f32 v204, v204, v205
    v_fma_f32 v192, v128, v128, s33
    v_mfma_f32_16x16x32_bf16 v[120:123], a[248:251], v[216:219], v[120:123]
    ds_read_b128 v[136:139], v164 offset:4608
    v_fmac_f32 v192, v129, v129
    v_fmac_f32 v192, v130, v130
    v_mfma_f32_16x16x32_bf16 v[120:123], a[252:255], v[232:235], v[120:123]
    s_waitcnt lgkmcnt(2)
    v_fmac_f32 v192, v131, v131
    v_mul_f32 v206, v161, v206
    v_mul_f32 v207, v161, v207
    v_mfma_f32_16x16x32_bf16 v[120:123], v[84:87], v[188:191], v[120:123]
    s_barrier
    ds_read_b128 v[144:147], v116 offset:2048
    ds_read_b128 v[148:151], v116 offset:3072
    v_cvt_pk_bf16_f32 v205, v206, v207
    v_mfma_f32_16x16x32_bf16 v[120:123], v[88:91], v[196:199], v[120:123]
    ds_read_b128 v[156:159], v116 offset:4096
    ds_read_b128 v[172:175], v116 offset:5120
    v_rsq_f32 v162, v162
    v_mfma_f32_16x16x32_bf16 v[200:203], v[92:95], v[208:211], 0
    ds_write_b64 v119, v[204:205] offset:5632
    v_mfma_f32_16x16x32_bf16 v[200:203], v[96:99], v[212:215], v[200:203]
    v_mul_f32 v140, v162, v140
    v_mul_f32 v141, v162, v141
    v_fmac_f32 v192, v120, v120
    v_mfma_f32_16x16x32_bf16 v[200:203], v[100:103], v[216:219], v[200:203]
    s_waitcnt lgkmcnt(5)
    buffer_store_dwordx4 v[136:139], v166, s[12:15], s26 offen nt
    ds_read_b64 v[204:205], v165 offset:5632
    v_fmac_f32 v192, v121, v121
    v_fmac_f32 v192, v122, v122
    v_mfma_f32_16x16x32_bf16 v[200:203], v[104:107], v[232:235], v[200:203]
    v_fmac_f32 v192, v123, v123
    v_cvt_pk_bf16_f32 v136, v140, v141
    v_mul_f32 v142, v162, v142
    v_mfma_f32_16x16x32_bf16 v[200:203], v[108:111], v[188:191], v[200:203]
    s_waitcnt lgkmcnt(4)
    v_mul_f32 v143, v162, v143
    v_cvt_pk_bf16_f32 v137, v142, v143
    v_mfma_f32_16x16x32_bf16 v[140:143], v[32:35], v[144:147], 0
    s_waitcnt lgkmcnt(2)
    v_mul_f32 v132, v162, v132
    v_mul_f32 v133, v162, v133
    v_mfma_f32_16x16x32_bf16 v[140:143], v[32:35], v[148:151], v[140:143]
    v_cvt_pk_bf16_f32 v138, v132, v133
    v_mul_f32 v134, v162, v134
    v_mfma_f32_16x16x32_bf16 v[144:147], v[32:35], v[156:159], 0
    v_mul_f32 v135, v162, v135
    v_cvt_pk_bf16_f32 v139, v134, v135
    v_mfma_f32_16x16x32_bf16 v[144:147], v[32:35], v[172:175], v[144:147]
    ds_write_b128 v118, v[136:139] offset:6144
    v_mfma_f32_16x16x32_bf16 v[200:203], v[112:115], v[196:199], v[200:203]
    s_waitcnt lgkmcnt(1)
    buffer_store_dwordx2 v[204:205], v167, s[12:15], s26 offen nt
    v_mul_f32 v220, v162, v220
    v_mul_f32 v221, v162, v221
    v_cvt_pk_bf16_f32 v166, v220, v221
    ds_read_b128 v[132:135], v164 offset:6144
    v_mul_f32 v222, v162, v222
    v_mul_f32 v223, v162, v223
    v_fmac_f32 v192, v200, v200
    v_fmac_f32 v192, v201, v201
    v_fmac_f32 v192, v202, v202
    v_fmac_f32 v192, v203, v203
    v_cvt_pk_bf16_f32 v220, v192, v192
    v_cvt_pk_bf16_f32 v221, v192, v192
    ds_write_b64 v4, v[220:221] offset:6144
    v_cvt_pk_bf16_f32 v167, v222, v223
    v_mul_f32 v161, 0x3baaaaab, v140
    v_rsq_f32 v161, v161
    ds_write_b64 v119, v[166:167] offset:7168
    v_mul_f32 v124, v161, v124
    v_mul_f32 v125, v161, v125
    v_cvt_pk_bf16_f32 v124, v124, v125
    ds_read_b64 v[166:167], v165 offset:7168
    s_waitcnt lgkmcnt(3)
    buffer_store_dwordx4 v[132:135], v163, s[12:15], s26 offen nt
    v_mul_f32 v126, v161, v126
    v_mul_f32 v127, v161, v127
    v_cvt_pk_bf16_f32 v125, v126, v127
    v_mul_f32 v176, v161, v176
    v_mul_f32 v177, v161, v177
    v_cvt_pk_bf16_f32 v126, v176, v177
    v_mul_f32 v178, v161, v178
    s_waitcnt lgkmcnt(2)
    s_barrier
    ds_read_b128 v[132:135], v116 offset:6144
    ds_read_b128 v[136:139], v116 offset:7168
    v_mul_f32 v179, v161, v179
    v_cvt_pk_bf16_f32 v127, v178, v179
    ds_write_b128 v118, v[124:127] offset:0
    v_mul_f32 v224, v161, v224
    v_mul_f32 v225, v161, v225
    v_cvt_pk_bf16_f32 v162, v224, v225
    v_mul_f32 v226, v161, v226
    s_waitcnt lgkmcnt(3)
    buffer_store_dwordx2 v[166:167], v168, s[12:15], s26 offen nt
    ds_read_b128 v[124:127], v164 offset:0
    v_mul_f32 v227, v161, v227
    v_cvt_pk_bf16_f32 v163, v226, v227
    ds_write_b64 v119, v[162:163] offset:1024
    s_waitcnt lgkmcnt(4)
    v_mfma_f32_16x16x32_bf16 v[140:143], v[32:35], v[132:135], 0
    s_waitcnt lgkmcnt(3)
    v_mul_f32 v116, 0x3baaaaab, v144
    v_or3_b32 v152, v152, v153, v154
    v_mfma_f32_16x16x32_bf16 v[140:143], v[32:35], v[136:139], v[140:143]
    ds_read_b64 v[166:167], v165 offset:1024
    v_rsq_f32 v116, v116
    v_or_b32 v152, v152, v155
    v_mul_f32 v180, v116, v180
    v_mul_f32 v181, v116, v181
    v_cvt_pk_bf16_f32 v132, v180, v181
    v_mul_f32 v182, v116, v182
    v_mul_f32 v183, v116, v183
    v_cvt_pk_bf16_f32 v133, v182, v183
    v_mul_f32 v184, v116, v184
    v_mul_f32 v185, v116, v185
    v_cvt_pk_bf16_f32 v134, v184, v185
    s_waitcnt lgkmcnt(2)
    buffer_store_dwordx4 v[124:127], v169, s[12:15], s26 offen nt
    v_mul_f32 v186, v116, v186
    v_mul_f32 v187, v116, v187
    v_cvt_pk_bf16_f32 v135, v186, v187
    ds_write_b128 v118, v[132:135] offset:1536
    v_mul_f32 v236, v116, v236
    s_waitcnt lgkmcnt(1)
    v_mul_f32 v237, v116, v237
    v_cvt_pk_bf16_f32 v236, v236, v237
    v_mul_f32 v238, v116, v238
    v_mul_f32 v239, v116, v239
    buffer_store_dwordx2 v[166:167], v170, s[12:15], s26 offen nt
    ds_read_b128 v[124:127], v164 offset:1536
    v_cvt_pk_bf16_f32 v237, v238, v239
    ds_write_b64 v119, v[236:237] offset:2560
    v_mul_f32 v153, 0x3baaaaab, v140
    v_rsq_f32 v153, v153
    ds_read_b64 v[154:155], v165 offset:2560
    v_mul_f32 v128, v153, v128
    v_mul_f32 v129, v153, v129
    v_cvt_pk_bf16_f32 v128, v128, v129
    v_mul_f32 v130, v153, v130
    v_mul_f32 v131, v153, v131
    v_cvt_pk_bf16_f32 v129, v130, v131
    v_mul_f32 v120, v153, v120
    v_mul_f32 v121, v153, v121
    v_cvt_pk_bf16_f32 v130, v120, v121
    v_mul_f32 v122, v153, v122
    v_mul_f32 v123, v153, v123
    v_cvt_pk_bf16_f32 v131, v122, v123
    buffer_store_dwordx4 v[128:131], v117, s[12:15], 0 offen nt
    s_waitcnt lgkmcnt(2)
    v_mul_f32 v200, v153, v200
    v_mul_f32 v201, v153, v201
    v_cvt_pk_bf16_f32 v162, v200, v201
    v_mul_f32 v202, v153, v202
    v_mul_f32 v203, v153, v203
    v_cvt_pk_bf16_f32 v163, v202, v203
    v_cmp_gt_i32 s[46:47], 0, v152
    s_waitcnt lgkmcnt(0)
    buffer_store_dwordx4 v[124:127], v194, s[12:15], 0 offen nt
    buffer_store_dwordx2 v[154:155], v171, s[12:15], 0 offen nt
    buffer_store_dwordx2 v[162:163], v160, s[12:15], 0 offen nt
    s_branch L_end
.section .rodata,"a"
.p2align 6
.amdhsa_kernel standalone__window_attn_swin_v2__vision_kernel
  .amdhsa_next_free_vgpr 512
  .amdhsa_next_free_sgpr 102
  .amdhsa_accum_offset 256
  .amdhsa_group_segment_fixed_size 0
  .amdhsa_kernarg_size 96
  .amdhsa_user_sgpr_count 2
  .amdhsa_user_sgpr_kernarg_segment_ptr 1
  .amdhsa_system_sgpr_workgroup_id_x 1
  .amdhsa_float_denorm_mode_32 3
.end_amdhsa_kernel
```

```asm
; @launch grid=(256,1,1) block=(256,1,1) lds=163840
.amdgcn_target "amdgcn-amd-amdhsa--gfx950"
.text
.globl standalone__window_attn_swin_v2__vision_kernel
.p2align 12
.p2align 8
.type standalone__window_attn_swin_v2__vision_kernel,@function
standalone__window_attn_swin_v2__vision_kernel:
    s_mov_b32 s44, 0
L_again:
    s_load_dwordx16 s[76:91], s[0:1], 0
    v_readfirstlane_b32 s16, v0
    s_cmp_ge_u32 s2, 256
    s_cbranch_scc1 L_done
    s_lshr_b32 s16, s16, 6
    s_cbranch_scc1 L_nopf
    s_getpc_b64 s[96:97]
    s_bfe_u32 s3, s2, 0x30003
    s_mul_i32 s3, s3, 44
    v_cmp_gt_u32 vcc, 20, v0
    v_add_u32 v254, s3, v0
    v_mov_b32 v255, 0
    v_cndmask_b32 v254, v254, v0, vcc
    v_lshlrev_b32 v254, 7, v254
    v_lshl_add_u64 v[254:255], s[96:97], 0, v[254:255]
    global_load_dword a255, v[254:255], off offset:992
L_nopf:
    s_max_u32 s3, s2, s44
    s_cmp_ge_u32 s3, 247
    s_cbranch_scc1 L_edge
    v_mov_b32 v254, v0
    v_mov_b32 v255, 0x40000000
    v_and_b32 v114, 63, v0
    s_bfe_u32 s3, s2, 0x50003
    s_lshl_b32 s4, s16, 3
    s_lshr_b32 s98, 0x06143a01, s4
    s_and_b32 s98, s98, 0xff
    s_mul_i32 s3, s3, s98
    s_sub_u32 s98, s98, 1
    s_lshr_b32 s4, 0x0048d800, s4
    s_and_b32 s4, s4, 0xff
    s_lshl_b32 s4, s4, 3
    s_max_u32 s4, s4, 6
    s_sub_u32 s4, s4, s98
    s_sub_u32 s4, s4, 1
    s_min_u32 s3, s3, s4
    v_min_u32 v116, s98, v114
    v_add_lshl_u32 v116, v116, s3, 7
    v_mov_b32 v117, 0
    v_lshrrev_b32 v115, 4, v114
    v_and_b32 v122, 15, v114
    s_mov_b32 s10, 100270464
    s_mov_b32 s11, 0x00020000
    s_mov_b32 s50, 36096
    s_mov_b32 s51, 0x00020000
    s_mul_i32 s3, s16, 96
    v_lshl_add_u32 v123, v114, 4, s3
    v_mul_u32_u24 v124, 171, v114
    v_lshrrev_b32 v124, 10, v124
    v_lshrrev_b32 v125, 1, v124
    v_xor_b32 v125, v125, v124
    v_and_b32 v125, 4, v125
    v_mul_u32_u24 v125, 3, v125
    v_xor_b32 v125, v125, v124
    v_mul_u32_u24 v125, 1152, v125
    v_mul_u32_u24 v130, 96, v124
    v_sub_u32 v125, v125, v130
    v_add_u32 v130, v123, v125
    v_add_u32 v125, 64, v114
    v_mul_u32_u24 v125, 171, v125
    v_lshrrev_b32 v125, 10, v125
    v_lshrrev_b32 v131, 1, v125
    v_xor_b32 v131, v131, v125
    v_and_b32 v131, 4, v131
    v_mul_u32_u24 v131, 3, v131
    v_xor_b32 v131, v131, v125
    v_mul_u32_u24 v131, 1152, v131
    v_mul_u32_u24 v132, 96, v125
    v_sub_u32 v131, v131, v132
    v_add_u32 v132, v123, v131
    v_add_u32 v131, 128, v114
    v_mul_u32_u24 v131, 171, v131
    v_lshrrev_b32 v131, 10, v131
    v_lshrrev_b32 v133, 1, v131
    v_xor_b32 v133, v133, v131
    v_and_b32 v133, 4, v133
    v_mul_u32_u24 v133, 3, v133
    v_xor_b32 v133, v133, v131
    v_mul_u32_u24 v133, 1152, v133
    v_mul_u32_u24 v134, 96, v131
    v_sub_u32 v133, v133, v134
    v_add_u32 v134, v123, v133
    s_mul_i32 s68, s16, 6144
    s_add_u32 s69, s68, 65536
    s_cmp_eq_u32 s16, 3
    s_cselect_b32 s68, 149696, s68
    s_cselect_b32 s69, 155840, s69
    s_waitcnt lgkmcnt(0)
    s_cmp_eq_u32 s16, 2
    s_cselect_b64 s[98:99], s[80:81], s[78:79]
    s_cmp_eq_u32 s16, 3
    s_cselect_b64 s[98:99], s[88:89], s[98:99]
    s_mov_b64 s[8:9], s[76:77]
    v_lshl_add_u64 v[116:117], s[98:99], 0, v[116:117]
    s_cmp_eq_u32 s16, 2
    s_cselect_b64 s[98:99], s[84:85], s[82:83]
    s_cmp_eq_u32 s16, 3
    s_cselect_b64 s[98:99], s[86:87], s[98:99]
    v_writelane_b32 v116, s98, 63
    v_writelane_b32 v117, s99, 63
    s_cmp_eq_u32 s16, 0
    s_cbranch_scc1 L_nowu
    global_load_dword a254, v[116:117], off
L_nowu:
    s_mov_b64 s[48:49], s[78:79]
    s_mov_b64 s[52:53], s[80:81]
    s_mov_b64 s[60:61], s[84:85]
    s_mov_b64 s[64:65], s[86:87]
    s_mov_b64 s[56:57], s[88:89]
    s_mov_b64 s[46:47], s[82:83]
    s_load_dwordx4 s[40:43], s[0:1], 72
    s_add_u32 s48, s48, 384
    s_addc_u32 s49, s49, 0
    s_add_u32 m0, s68, 0
    v_add_u32 v133, s16, v114
    v_and_b32 v133, 3, v133
    v_lshlrev_b32 v133, 1, v133
    s_mov_b32 s54, 12288
    s_mov_b32 s55, 0x00020000
    s_mov_b32 s62, 64
    s_mov_b32 s63, 0x00020000
    s_mov_b32 s66, 128
    s_mov_b32 s67, 0x00020000
    s_mov_b32 s58, 676
    s_mov_b32 s59, 0x00020000
    s_mov_b32 s14, 0
    s_mov_b32 s15, 0x00020000
    v_mov_b32 v123, 0
    v_cmp_lt_u32 s[92:93], 7, v122
    v_mov_b32 v117, 0
    v_mov_b32 v137, 0
    v_mov_b32 v119, 0
    v_lshlrev_b32 v116, 1, v114
    v_mul_u32_u24 v135, 12, v122
    s_mul_i32 s71, s16, 192
    v_add_u32 v135, s71, v135
    v_lshlrev_b32 v120, 5, v115
    s_mul_i32 s72, s16, 9408
    s_add_u32 s72, s72, 104448
    s_mul_i32 s73, s16, 7616
    s_add_u32 s73, s73, 38912
    s_cmp_eq_u32 s16, 3
    s_cselect_b32 s73, 142080, s73
    s_mov_b32 s70, 193536
    s_mov_b32 s36, 100270464
    s_mov_b32 s22, 1180032
    s_mul_i32 s3, s2, 911
    s_lshr_b32 s3, s3, 16
    s_mul_i32 s35, s3, 72
    s_sub_u32 s38, s2, s35
    s_mul_i32 s3, s3, 1373568
    s_mul_i32 s35, s38, 2688
    s_add_u32 s3, s3, s35
    s_add_u32 s25, s3, 589824
    s_add_u32 s7, s3, 1769472
    s_mov_b32 s20, 31
    s_mov_b32 s21, 4204032
    s_mov_b32 s17, 20
    s_cmp_lt_u32 s2, 240
    s_cselect_b32 s45, 28, 24
    s_bfm_b32 s34, s45, 0
    s_and_b32 s4, s2, 7
    s_sub_u32 s4, 0, s4
    s_lshl_b32 s28, s16, 10
    s_add_u32 s28, s28, 20480
    s_mov_b32 s76, 0x3f80
    s_mov_b32 s19, s38
    s_mov_b32 s23, s25
    s_mov_b32 s26, 0
    s_mov_b32 s27, 0
    s_mov_b32 s18, 0
    s_add_u32 s19, s19, s20
    s_add_u32 s23, s23, s21
    s_mul_i32 s79, s16, 64
    s_mul_i32 s80, s16, 32
    s_add_u32 s80, s80, 256
    s_mul_i32 s81, s16, 768
    s_add_u32 s81, s81, 98304
    s_mov_b32 s82, -24
    s_lshr_b32 s83, s16, 1
    s_and_b32 s84, s16, 1
    s_lshl_b32 s84, s84, 3
    s_lshl_b32 s85, s83, 10
    s_add_u32 s85, s85, s84
    s_lshl_b32 s83, s83, 11
    s_add_u32 s83, s83, s84
    s_add_u32 s83, s83, 157888
    s_mul_i32 s86, s16, 2048
    s_add_u32 s86, s86, 149696
    s_mul_i32 s87, s16, 128
    s_add_u32 s87, s87, 61760
    s_mov_b32 s32, 0x2a8cbccc
    s_mov_b32 s33, 0x38fba882
    s_add_u32 s75, s28, 16384
    s_cmp_lt_u32 s16, 2
    s_cselect_b32 s29, s75, 161984
    s_cselect_b32 s30, 65536, 0
    s_xor_b32 s74, s29, s30
    s_mul_i32 s77, s16, 64
    s_mul_i32 s78, s16, 32
    s_add_u32 s78, s78, 192
    s_mov_b32 s71, 1
    s_mov_b32 s27, s26
    s_mov_b32 s26, s25
    buffer_load_dwordx4 v130, s[48:51], 0 offen lds
    v_mul_u32_u24 v136, 2731, v254
    v_bfe_u32 v118, v136, 17, 3
    v_lshrrev_b32 v136, 16, v136
    buffer_load_dwordx4 v132, s[48:51], 0 offen offset:1024 lds
    v_xor_b32 v121, v118, v254
    v_mul_u32_u24 v118, 37, v136
    v_lshrrev_b32 v118, 8, v118
    buffer_load_dwordx4 v134, s[48:51], 0 offen offset:2048 lds
    s_add_u32 m0, s28, 65536
    s_add_u32 s48, s48, 36864
    s_addc_u32 s49, s49, 0
    v_lshlrev_b32 v121, 4, v121
    v_mad_u32_u24 v10, v118, s70, v121
    v_mul_u32_u24 v118, s20, v136
    v_add_u32 v118, s38, v118
    v_mul_u32_u24 v126, 911, v118
    v_lshrrev_b32 v126, 16, v126
    v_mul_u32_u24 v126, s22, v126
    v_mad_u32_u24 v126, v136, s21, v126
    v_bfe_u32 v118, s34, v136, 1
    v_cmp_ne_u32 vcc, 0, v118
    v_add_u32 v118, s7, v126
    v_mul_u32_u24 v136, 384, v136
    v_cndmask_b32 v118, v255, v118, vcc
    v_sub_u32 v136, v121, v136
    v_add_u32 v118, v118, v136
    buffer_load_dwordx4 v118, s[8:11], 0 offen nt lds
    s_add_u32 m0, s28, 69632
    v_add_u32 v136, 256, v254
    v_mul_u32_u24 v118, 2731, v136
    v_bfe_u32 v121, v118, 17, 3
    v_lshrrev_b32 v118, 16, v118
    v_xor_b32 v136, v121, v136
    v_mul_u32_u24 v121, 37, v118
    v_lshrrev_b32 v121, 8, v121
    v_lshlrev_b32 v136, 4, v136
    v_mad_u32_u24 v11, v121, s70, v136
    v_min_u32 v121, 20, v118
    v_add_u32 v126, 12, v118
    v_lshrrev_b32 v126, 5, v126
    v_sub_u32 v127, v118, v121
    v_mad_i32_i24 v127, v126, s4, v127
    v_mul_u32_u24 v128, s20, v121
    v_add3_u32 v128, v128, v127, s38
    v_mul_u32_u24 v126, 911, v128
    v_lshrrev_b32 v126, 16, v126
    v_mul_u32_u24 v126, s22, v126
    v_mad_u32_u24 v126, v121, s21, v126
    v_bfe_u32 v128, s34, v118, 1
    v_cmp_ne_u32 vcc, 0, v128
    v_mul_i32_i24 v127, 2688, v127
    v_add3_u32 v121, v126, v127, s7
    v_cndmask_b32 v121, v255, v121, vcc
    v_mul_u32_u24 v118, 384, v118
    v_sub_u32 v118, v136, v118
    v_add_u32 v121, v121, v118
    buffer_load_dwordx4 v121, s[8:11], 0 offen lds
    s_add_u32 m0, s28, 73728
    v_add_u32 v136, 512, v254
    v_mul_u32_u24 v118, 2731, v136
    v_bfe_u32 v121, v118, 17, 3
    v_lshrrev_b32 v118, 16, v118
    v_xor_b32 v136, v121, v136
    v_mul_u32_u24 v121, 37, v118
    v_lshrrev_b32 v121, 8, v121
    v_lshlrev_b32 v136, 4, v136
    v_mad_u32_u24 v12, v121, s70, v136
    v_min_u32 v121, 20, v118
    v_add_u32 v126, 12, v118
    v_lshrrev_b32 v126, 5, v126
    v_sub_u32 v127, v118, v121
    v_mad_i32_i24 v127, v126, s4, v127
    v_mul_u32_u24 v128, s20, v121
    v_add3_u32 v128, v128, v127, s38
    v_mul_u32_u24 v126, 911, v128
    v_lshrrev_b32 v126, 16, v126
    v_mul_u32_u24 v126, s22, v126
    v_mad_u32_u24 v126, v121, s21, v126
    v_bfe_u32 v128, s34, v118, 1
    v_cmp_ne_u32 vcc, 0, v128
    v_mul_i32_i24 v127, 2688, v127
    v_add3_u32 v121, v126, v127, s7
    v_cndmask_b32 v121, v255, v121, vcc
    v_mul_u32_u24 v118, 384, v118
    v_sub_u32 v118, v136, v118
    v_add_u32 v121, v121, v118
    s_cmp_ge_u32 s19, 72
    s_cselect_b32 s34, 72, 0
    s_cselect_b32 s35, s22, 0
    s_sub_u32 s19, s19, s34
    s_add_u32 s23, s23, s35
    s_mov_b32 s24, s23
    s_add_u32 s19, s19, s20
    s_add_u32 s23, s23, s21
    s_cmp_ge_u32 s19, 72
    s_cselect_b32 s34, 72, 0
    s_cselect_b32 s35, s22, 0
    s_sub_u32 s19, s19, s34
    s_add_u32 s23, s23, s35
    s_add_u32 s34, s18, 2
    s_mov_b32 s18, 1
    s_add_u32 s19, s19, s20
    buffer_load_dwordx4 v121, s[8:11], 0 offen lds
    s_add_u32 m0, s28, 0
    v_lshrrev_b32 v136, 2, v122
    v_and_b32 v121, 1, v136
    buffer_load_dwordx4 v10, s[8:11], s25 offen nt lds
    s_add_u32 m0, s28, 4096
    v_mul_u32_u24 v121, 0x020202, v121
    v_lshl_or_b32 v121, v121, 8, v121
    v_add_u32 v121, 0x05040100, v121
    v_and_b32 v118, 3, v122
    v_lshrrev_b32 v126, 1, v122
    v_xor_b32 v126, v126, v115
    v_mul_u32_u24 v127, 384, v122
    v_lshl_add_u32 v0, v126, 4, v127
    v_xor_b32 v1, 64, v0
    v_and_b32 v126, 2, v115
    v_add_u32 v126, v126, v115
    v_lshl_add_u32 v126, v126, 2, v136
    v_mul_u32_u24 v126, 96, v126
    v_lshl_add_u32 v126, v118, 3, v126
    v_add_u32 v138, s68, v126
    v_add_u32 v139, s69, v126
    v_add_u32 v140, s72, v126
    v_add_u32 v141, s73, v126
    v_mov_b32 v28, 0x3f803f80
    v_mov_b32 v29, 0x3f803f80
    v_mov_b32 v30, 0x3f803f80
    v_mov_b32 v31, 0x3f803f80
    v_mul_u32_u24 v196, 768, v115
    v_add_u32 v196, v135, v196
    v_add_u32 v196, 98304, v196
    v_and_b32 v194, 1, v122
    v_lshlrev_b32 v194, 4, v194
    v_lshlrev_b32 v195, v194, s76
    v_mov_b32 v197, 0x3c003c00
    v_mov_b32 v44, 1.0
    v_lshlrev_b32 v126, 4, v115
    v_lshl_add_u32 v127, v115, 4, s79
    v_lshl_add_u32 v128, v115, 3, s80
    v_add_u32 v129, 0, v122
    v_mul_u32_u24 v142, 37, v129
    v_mul_u32_u24 v143, 384, v129
    v_lshrrev_b32 v142, 8, v142
    v_mad_u32_u24 v143, v142, s70, v143
    v_add_u32 v15, v143, v127
    v_add_u32 v18, v143, v128
    v_add_u32 v143, 16, v122
    v_mul_u32_u24 v144, 37, v143
    v_mul_u32_u24 v145, 384, v143
    v_lshrrev_b32 v144, 8, v144
    v_mad_u32_u24 v145, v144, s70, v145
    v_add_u32 v16, v145, v127
    v_add_u32 v19, v145, v128
    v_add_u32 v145, 32, v122
    v_mul_u32_u24 v146, 37, v145
    v_mul_u32_u24 v147, 384, v145
    v_lshrrev_b32 v146, 8, v146
    v_mad_u32_u24 v147, v146, s70, v147
    v_add_u32 v17, v147, v127
    v_add_u32 v20, v147, v128
    v_mul_u32_u24 v142, 24, v142
    v_lshl_add_u32 v142, v129, 2, v142
    v_add_u32 v22, s81, v142
    v_sub_u32 v23, s81, v142
    v_sub_u32 v127, v22, v126
    v_mul_u32_u24 v128, 24, v144
    v_lshl_add_u32 v128, v143, 2, v128
    v_add_u32 v24, s81, v128
    v_sub_u32 v25, s81, v128
    v_sub_u32 v128, v24, v126
    v_mul_u32_u24 v129, 24, v146
    v_lshl_add_u32 v129, v145, 2, v129
    v_add_u32 v26, s81, v129
    v_sub_u32 v27, s81, v129
    v_sub_u32 v129, v26, v126
    v_mul_u32_u24 v142, 148, v115
    v_add_u32 v143, 0, v142
    v_lshrrev_b32 v143, 8, v143
    v_mad_i32_i24 v46, v143, s82, v127
    v_mad_i32_i24 v58, v143, s82, v128
    v_mad_i32_i24 v70, v143, s82, v129
    v_add_u32 v143, 37, v142
    v_lshrrev_b32 v143, 8, v143
    v_mad_i32_i24 v47, v143, s82, v127
    v_mad_i32_i24 v59, v143, s82, v128
    v_mad_i32_i24 v71, v143, s82, v129
    v_add_u32 v143, 74, v142
    v_lshrrev_b32 v143, 8, v143
    v_mad_i32_i24 v48, v143, s82, v127
    v_mad_i32_i24 v60, v143, s82, v128
    v_mad_i32_i24 v72, v143, s82, v129
    v_add_u32 v143, 111, v142
    v_lshrrev_b32 v143, 8, v143
    v_mad_i32_i24 v49, v143, s82, v127
    v_mad_i32_i24 v61, v143, s82, v128
    v_mad_i32_i24 v73, v143, s82, v129
    v_add_u32 v143, 592, v142
    v_lshrrev_b32 v143, 8, v143
    v_mad_i32_i24 v50, v143, s82, v127
    v_mad_i32_i24 v62, v143, s82, v128
    v_mad_i32_i24 v74, v143, s82, v129
    v_add_u32 v143, 629, v142
    v_lshrrev_b32 v143, 8, v143
    v_mad_i32_i24 v51, v143, s82, v127
    v_mad_i32_i24 v63, v143, s82, v128
    v_mad_i32_i24 v75, v143, s82, v129
    v_add_u32 v143, 666, v142
    v_lshrrev_b32 v143, 8, v143
    v_mad_i32_i24 v52, v143, s82, v127
    v_mad_i32_i24 v64, v143, s82, v128
    v_mad_i32_i24 v76, v143, s82, v129
    v_add_u32 v143, 703, v142
    v_lshrrev_b32 v143, 8, v143
    v_mad_i32_i24 v53, v143, s82, v127
    buffer_load_dwordx4 v11, s[8:11], s25 offen nt lds
    s_add_u32 m0, s68, 3072
    v_mad_i32_i24 v65, v143, s82, v128
    buffer_load_dwordx4 v130, s[48:51], 0 offen lds
    v_mad_i32_i24 v77, v143, s82, v129
    v_add_u32 v143, 1184, v142
    v_lshrrev_b32 v143, 8, v143
    buffer_load_dwordx4 v132, s[48:51], 0 offen offset:1024 lds
    v_mad_i32_i24 v54, v143, s82, v127
    v_mad_i32_i24 v66, v143, s82, v128
    v_mad_i32_i24 v78, v143, s82, v129
    buffer_load_dwordx4 v134, s[48:51], 0 offen offset:2048 lds
    s_add_u32 s48, s48, 36864
    s_addc_u32 s49, s49, 0
    s_add_u32 m0, s69, 0
    v_add_u32 v143, 1221, v142
    v_lshrrev_b32 v143, 8, v143
    v_mad_i32_i24 v55, v143, s82, v127
    v_mad_i32_i24 v67, v143, s82, v128
    v_mad_i32_i24 v79, v143, s82, v129
    v_add_u32 v143, 1258, v142
    v_lshrrev_b32 v143, 8, v143
    v_mad_i32_i24 v56, v143, s82, v127
    v_mad_i32_i24 v68, v143, s82, v128
    v_mad_i32_i24 v80, v143, s82, v129
    v_add_u32 v142, 1295, v142
    v_lshrrev_b32 v142, 8, v142
    s_waitcnt vmcnt(8)
    ds_read_b64_tr_b16 a[72:73], v138 offset:0
    ds_read_b64_tr_b16 a[74:75], v138 offset:768
    ds_read_b64_tr_b16 a[96:97], v138 offset:32
    buffer_load_dwordx4 v130, s[48:51], 0 offen lds
    ds_read_b64_tr_b16 a[98:99], v138 offset:800
    ds_read_b64_tr_b16 a[120:121], v138 offset:64
    ds_read_b64_tr_b16 a[122:123], v138 offset:832
    v_mad_i32_i24 v57, v142, s82, v127
    v_mad_i32_i24 v69, v142, s82, v128
    v_mad_i32_i24 v81, v142, s82, v129
    v_mov_b32 v150, s81
    v_lshlrev_b32 v127, 4, v114
    v_xor_b32 v2, 65536, v127
    v_lshl_add_u32 v3, s16, 10, v127
    v_add_u32 v4, s85, v127
    v_lshl_add_u32 v127, v115, 3, s86
    v_mov_b32 v128, s83
    v_mov_b32 v129, 163264
    v_mul_u32_u24 v151, 80, v115
    v_add3_u32 v152, v151, v194, s72
    v_add_u32 v5, s72, v151
    v_lshl_add_u32 v6, v122, 2, s73
    v_add_u32 v9, s87, v126
    v_lshrrev_b32 v153, 1, v115
    v_mul_u32_u24 v153, 48, v153
    v_lshl_add_u32 v153, v115, 3, v153
    v_lshl_add_u32 v153, v136, 4, v153
    v_lshl_add_u32 v153, v118, 1, v153
    v_add_u32 v8, s87, v153
    v_mov_b32 v37, 0
    v_mov_b32 v38, 0
    v_mov_b32 v39, 0
    v_add_u32 v153, 86016, v0
    v_add_u32 v146, 86016, v1
    v_lshlrev_b32 v194, 4, v122
    v_add_u32 v194, 161984, v194
    v_mul_u32_u24 v147, 336, v122
    v_add3_u32 v147, v147, v151, s72
    v_mul_u32_u24 v151, 272, v122
    v_add3_u32 v151, v151, v126, s73
    v_mul_u32_u24 v154, 1088, v115
    v_add_u32 v154, v154, v6
    v_add_u32 v155, 5376, v147
    v_add_u32 v156, 4352, v151
    v_add_u32 v157, 4352, v154
    v_cmp_gt_u32 s[88:89], 16, v114
    v_mov_b32 v158, 0xf149f2ca
    v_add_u32 v148, 768, v254
    v_mul_u32_u24 v149, 2731, v148
    v_bfe_u32 v159, v149, 17, 3
    v_lshrrev_b32 v149, 16, v149
    v_xor_b32 v148, v159, v148
    v_mul_u32_u24 v159, 37, v149
    v_lshrrev_b32 v159, 8, v159
    v_lshlrev_b32 v148, 4, v148
    v_mad_u32_u24 v13, v159, s70, v148
    v_add_u32 v254, 1024, v254
    v_mul_u32_u24 v148, 2731, v254
    v_bfe_u32 v149, v148, 17, 3
    v_lshrrev_b32 v148, 16, v148
    v_xor_b32 v254, v149, v254
    v_mul_u32_u24 v149, 37, v148
    v_lshrrev_b32 v149, 8, v149
    v_lshlrev_b32 v254, 4, v254
    v_mad_u32_u24 v14, v149, s70, v254
    v_cmp_gt_u32 vcc, 48, v148
    v_mul_u32_u24 v254, 6, v124
    v_sub_u32 v148, v114, v254
    v_cndmask_b32 v14, v255, v14, vcc
    buffer_load_dwordx4 v132, s[48:51], 0 offen offset:1024 lds
    v_cmp_gt_u32 vcc, 2, v118
    v_mul_u32_u24 v254, 384, v124
    v_lshl_add_u32 v254, v148, 4, v254
    v_cndmask_b32 v32, 0, v195, vcc
    v_cndmask_b32 v33, v195, 0, vcc
    v_cndmask_b32 v34, 0, v195, vcc
    v_cndmask_b32 v35, v195, 0, vcc
    v_cmp_eq_u32 vcc, 0, v118
    v_add_u32 v255, s78, v254
    v_add_u32 v254, s77, v254
    v_cndmask_b32 v40, 0, v197, vcc
    v_cmp_eq_u32 vcc, 1, v118
    v_mul_u32_u24 v149, 6, v125
    v_sub_u32 v195, v114, v149
    v_cndmask_b32 v41, 0, v197, vcc
    v_cmp_eq_u32 vcc, 2, v118
    v_mul_u32_u24 v149, 384, v125
    v_lshl_add_u32 v149, v195, 4, v149
    v_cndmask_b32 v42, 0, v197, vcc
    v_cmp_eq_u32 vcc, 3, v118
    v_add_u32 v124, s78, v149
    v_add_u32 v149, s77, v149
    v_cndmask_b32 v43, 0, v197, vcc
    v_cmp_eq_u32 vcc, v115, v136
    v_mul_u32_u24 v125, 6, v131
    v_sub_u32 v114, v114, v125
    v_cndmask_b32 v162, 0, v32, vcc
    v_cndmask_b32 v163, 0, v33, vcc
    v_cmp_gt_i32 vcc, 4, v148
    buffer_load_dwordx4 v134, s[48:51], 0 offen offset:2048 lds
    s_add_u32 s48, s48, 36864
    s_addc_u32 s49, s49, 0
    s_add_u32 m0, s69, 3072
    v_cndmask_b32 v164, v255, v254, vcc
    v_cmp_gt_i32 vcc, -60, v195
    v_mul_u32_u24 v125, 384, v131
    v_lshl_add_u32 v125, v114, 4, v125
    v_cndmask_b32 v165, v124, v149, vcc
    v_add_u32 v124, s78, v125
    v_add_u32 v125, s77, v125
    v_cmp_gt_i32 vcc, -124, v114
    v_mul_u32_u24 v114, 96, v122
    v_add3_u32 v254, v114, v126, s68
    v_cndmask_b32 v255, v124, v125, vcc
    v_cmp_gt_u32 vcc, 2, v115
    v_lshl_add_u32 v131, v115, 3, v114
    v_add3_u32 v131, v131, 64, s68
    v_cndmask_b32 v127, v128, v127, vcc
    v_lshl_add_u32 v127, v136, 9, v127
    v_lshl_add_u32 v127, v118, 1, v127
    v_cmp_gt_u32 vcc, 3, v115
    v_add3_u32 v159, v114, v126, s69
    v_lshl_add_u32 v160, v115, 3, v114
    v_cndmask_b32 v7, v129, v127, vcc
    v_cmp_gt_u32 vcc, 12, v122
    v_add3_u32 v160, v160, 64, s69
    v_add_u32 v118, 16, v122
    v_cndmask_b32 v155, v194, v155, vcc
    v_cndmask_b32 v156, v194, v156, vcc
    v_cmp_gt_u32 vcc, 3, v115
    v_cmp_gt_u32 s[94:95], s45, v118
    v_cndmask_b32 v161, v194, v151, s[88:89]
    v_cndmask_b32 v157, v194, v157, vcc
    v_cndmask_b32 v124, v194, v156, s[88:89]
    s_and_b32 s77, s2, 0xf8
    s_add_u32 s77, s77, 4940
    s_mul_i32 s78, s77, 58255
    s_lshr_b32 s78, s78, 22
    v_add_u32 v5, 336, v5
    buffer_load_dwordx4 v130, s[48:51], 0 offen lds
    buffer_load_dwordx4 v132, s[48:51], 0 offen offset:1024 lds
    buffer_load_dwordx4 v134, s[48:51], 0 offen offset:2048 lds
    s_waitcnt vmcnt(9)
    s_barrier
    ds_read_b128 v[142:145], v153 offset:6144
    ds_read_b128 v[186:189], v146 offset:6144
    ds_read_b128 v[234:237], v153 offset:6272
    s_add_u32 s48, s48, 36864
    s_addc_u32 s49, s49, 0
    ds_read_b128 v[182:185], v146 offset:6272
    s_add_u32 m0, s72, 0
    ds_read_b128 v[206:209], v153 offset:6400
    ds_read_b128 v[190:193], v146 offset:6400
    ds_read_b128 v[166:169], v0 offset:20480
    buffer_load_ushort v122, v116, s[60:63], 0 offen
    s_mov_b64 s[60:61], s[8:9]
    s_sub_u32 s62, s45, s17
    ds_read_b128 v[170:173], v1 offset:20480
    s_sub_u32 s45, s17, 1
    s_waitcnt lgkmcnt(7)
    v_mfma_f32_16x16x32_bf16 v[174:177], a[72:75], v[142:145], 0
    s_bfm_b32 s63, s17, 0
    ds_read_b128 v[178:181], v0 offset:20608
    s_min_u32 s70, s62, 4
    v_mfma_f32_16x16x32_bf16 v[198:201], a[96:99], v[142:145], 0
    s_lshr_b32 s83, s44, 8
    ds_read_b128 v[202:205], v1 offset:20608
    buffer_load_dwordx3 v[210:212], v135, s[56:59], 0 offen
    v_mfma_f32_16x16x32_bf16 v[214:217], a[120:123], v[142:145], 0
    s_cselect_b32 s70, 0, s70
    ds_read_b128 v[142:145], v0 offset:20736
    ds_read_b128 v[218:221], v1 offset:20736
    ds_read_b128 v[222:225], v153 offset:6144
    s_waitcnt lgkmcnt(6)
    v_mfma_f32_16x16x32_bf16 v[226:229], a[72:75], v[166:169], 0
    s_waitcnt lgkmcnt(5)
    ds_read_b128 v[230:233], v153 offset:0
    v_mfma_f32_16x16x32_bf16 v[238:241], a[96:99], v[166:169], 0
    s_waitcnt vmcnt(8)
    buffer_load_dwordx4 v[242:245], v120, s[64:67], 0 offen
    ds_read_b64_tr_b16 a[76:77], v138 offset:3072
    ds_read_b64_tr_b16 a[78:79], v138 offset:3840
    ds_read_b64_tr_b16 a[100:101], v138 offset:3104
    ds_read_b64_tr_b16 a[102:103], v138 offset:3872
    ds_read_b64_tr_b16 a[124:125], v138 offset:3136
    ds_read_b64_tr_b16 a[126:127], v138 offset:3904
    global_load_ushort v133, v133, s[46:47]
    s_waitcnt lgkmcnt(4)
    v_mfma_f32_16x16x32_bf16 v[174:177], a[76:79], v[186:189], v[174:177]
    v_mfma_f32_16x16x32_bf16 v[226:229], a[76:79], v[170:173], v[226:229]
    s_waitcnt lgkmcnt(2)
    v_mfma_f32_16x16x32_bf16 v[198:201], a[100:103], v[186:189], v[198:201]
    s_waitcnt lgkmcnt(0)
    buffer_load_dwordx4 v130, s[48:51], 0 offen lds
    v_mfma_f32_16x16x32_bf16 v[214:217], a[124:127], v[186:189], v[214:217]
    ds_read_b128 v[186:189], v146 offset:6144
    v_mfma_f32_16x16x32_bf16 v[238:241], a[100:103], v[170:173], v[238:241]
    s_waitcnt vmcnt(8)
    ds_read_b64_tr_b16 a[80:81], v139 offset:0
    ds_read_b64_tr_b16 a[82:83], v139 offset:768
    ds_read_b64_tr_b16 a[104:105], v139 offset:32
    ds_read_b64_tr_b16 a[106:107], v139 offset:800
    ds_read_b64_tr_b16 a[128:129], v139 offset:64
    buffer_load_dwordx4 v132, s[48:51], 0 offen offset:1024 lds
    ds_read_b64_tr_b16 a[130:131], v139 offset:832
    s_waitcnt lgkmcnt(4)
    v_mfma_f32_16x16x32_bf16 v[174:177], a[80:83], v[234:237], v[174:177]
    s_waitcnt lgkmcnt(3)
    buffer_load_dwordx4 v134, s[48:51], 0 offen offset:2048 lds
    s_add_u32 s48, s48, 36864
    v_mfma_f32_16x16x32_bf16 v[226:229], a[80:83], v[178:181], v[226:229]
    s_waitcnt lgkmcnt(0)
    s_addc_u32 s49, s49, 0
    s_add_u32 m0, s72, 3072
    v_mfma_f32_16x16x32_bf16 v[198:201], a[104:107], v[234:237], v[198:201]
    s_mov_b32 s72, 2
    v_mfma_f32_16x16x32_bf16 v[214:217], a[128:131], v[234:237], v[214:217]
    ds_read_b128 v[234:237], v153 offset:6272
    v_mfma_f32_16x16x32_bf16 v[238:241], a[104:107], v[178:181], v[238:241]
    buffer_load_dwordx4 v130, s[48:51], 0 offen lds
    s_waitcnt vmcnt(8)
    ds_read_b64_tr_b16 a[84:85], v139 offset:3072
    ds_read_b64_tr_b16 a[86:87], v139 offset:3840
    ds_read_b64_tr_b16 a[108:109], v139 offset:3104
    ds_read_b64_tr_b16 a[110:111], v139 offset:3872
    ds_read_b64_tr_b16 a[132:133], v139 offset:3136
    ds_read_b64_tr_b16 a[134:135], v139 offset:3904
    s_waitcnt vmcnt(6)
    v_bfe_u32 v116, v210, v126, 16
    v_bfe_u32 v136, v211, v126, 16
    v_bfe_u32 v118, v212, v126, 16
    buffer_load_dwordx4 v132, s[48:51], 0 offen offset:1024 lds
    s_waitcnt lgkmcnt(4)
    v_mfma_f32_16x16x32_bf16 v[174:177], a[84:87], v[182:185], v[174:177]
    s_waitcnt vmcnt(6)
    v_cndmask_b32 v242, v242, v243, s[92:93]
    v_cndmask_b32 v244, v244, v245, s[92:93]
    v_mfma_f32_16x16x32_bf16 v[226:229], a[84:87], v[202:205], v[226:229]
    s_waitcnt lgkmcnt(0)
    v_perm_b32 v148, v244, v242, v121
    v_mfma_f32_16x16x16_bf16 v[126:129], v[122:123], v[116:117], 0
    v_mfma_f32_16x16x32_bf16 v[198:201], a[108:111], v[182:185], v[198:201]
    buffer_load_dwordx4 v134, s[48:51], 0 offen offset:2048 lds
    s_waitcnt vmcnt(6)
    v_mfma_f32_16x16x32_bf16 v[214:217], a[132:135], v[182:185], v[214:217]
    s_sub_u32 s48, s48, 184704
    ds_read_b128 v[114:117], v146 offset:6272
    v_lshlrev_b32 v133, 16, v133
    v_mfma_f32_16x16x32_bf16 v[238:241], a[108:111], v[202:205], v[238:241]
    s_subb_u32 s49, s49, 0
    s_add_u32 m0, s73, 0
    v_max_f32 v126, 0, v126
    v_max_f32 v127, 0, v127
    v_max_f32 v128, 0, v128
    v_max_f32 v129, 0, v129
    v_cvt_pk_bf16_f32 v194, v126, v127
    v_cvt_pk_bf16_f32 v195, v128, v129
    v_mfma_f32_16x16x16_bf16 v[126:129], v[122:123], v[136:137], 0
    v_max_f32 v133, 0xc2c80000, v133
    v_min_f32 v133, 0x40930000, v133
    v_mul_f32 v133, 0x3fb8aa3b, v133
    buffer_load_dwordx4 v130, s[48:51], 0 offen lds
    v_exp_f32 v133, v133
    s_nop 0
    v_cvt_pk_bf16_f32 v133, v133, v133
    v_and_b32 v133, 0xffff0000, v133
    v_max_f32 v126, 0, v126
    v_max_f32 v127, 0, v127
    v_max_f32 v128, 0, v128
    v_max_f32 v129, 0, v129
    v_cvt_pk_bf16_f32 v136, v126, v127
    v_cvt_pk_bf16_f32 v137, v128, v129
    v_mfma_f32_16x16x16_bf16 v[126:129], v[122:123], v[118:119], 0
    v_mul_f32 v135, 0x3fb8aa3b, v133
    v_readfirstlane_b32 s37, v133
    v_readfirstlane_b32 s31, v135
    v_mul_f32 v133, 0x3e000000, v133
    v_mfma_f32_16x16x32_bf16 v[242:245], a[120:123], v[166:169], 0
    s_waitcnt lgkmcnt(0)
    ds_read_b128 v[182:185], v146 offset:0
    v_cmp_lt_f32 s[90:91], 4.0, v133
    v_mfma_f32_16x16x32_bf16 v[242:245], a[124:127], v[170:173], v[242:245]
    buffer_load_dwordx4 v[166:169], v120, s[64:67], 0 offen offset:16
    v_max_f32 v126, 0, v126
    v_mfma_f32_16x16x32_bf16 v[242:245], a[128:131], v[178:181], v[242:245]
    buffer_load_dwordx4 v132, s[48:51], 0 offen offset:1024 lds
    ds_read_b128 v[170:173], v153 offset:128
    v_mfma_f32_16x16x32_bf16 v[242:245], a[132:135], v[202:205], v[242:245]
    s_cmp_lg_u64 s[90:91], 0
    ds_read_b128 v[178:181], v146 offset:128
    v_max_f32 v127, 0, v127
    v_max_f32 v128, 0, v128
    v_max_f32 v129, 0, v129
    v_cvt_pk_bf16_f32 v122, v126, v127
    v_cvt_pk_bf16_f32 v123, v128, v129
    v_mfma_f32_16x16x32_bf16 v[126:129], a[72:75], v[230:233], 0
    s_cbranch_scc1 L_slow
    s_waitcnt vmcnt(6)
    ds_read_b64_tr_b16 a[88:89], v140 offset:0
    ds_read_b64_tr_b16 a[90:91], v140 offset:768
    s_waitcnt lgkmcnt(4)
    v_mfma_f32_16x16x32_bf16 v[126:129], a[76:79], v[182:185], v[126:129]
    ds_read_b64_tr_b16 a[112:113], v140 offset:32
    ds_read_b64_tr_b16 a[114:115], v140 offset:800
    ds_read_b64_tr_b16 a[136:137], v140 offset:64
    buffer_load_dwordx4 v134, s[48:51], 0 offen offset:2048 lds
    ds_read_b64_tr_b16 a[138:139], v140 offset:832
    s_add_u32 s48, s48, 36864
    s_waitcnt lgkmcnt(7)
    v_mfma_f32_16x16x32_bf16 v[126:129], a[80:83], v[170:173], v[126:129]
    s_addc_u32 s49, s49, 0
    s_waitcnt lgkmcnt(6)
    s_add_u32 m0, s73, 3072
    v_mfma_f32_16x16x32_bf16 v[126:129], a[84:87], v[178:181], v[126:129]
    s_mov_b32 s73, 3
    s_waitcnt lgkmcnt(4)
    v_mfma_f32_16x16x32_bf16 v[174:177], a[88:91], v[206:209], v[174:177]
    v_mfma_f32_16x16x32_bf16 v[226:229], a[88:91], v[142:145], v[226:229]
    s_waitcnt lgkmcnt(2)
    buffer_load_dwordx4 v130, s[48:51], 0 offen lds
    v_mfma_f32_16x16x32_bf16 v[198:201], a[112:115], v[206:209], v[198:201]
    s_waitcnt lgkmcnt(0)
    v_mfma_f32_16x16x32_bf16 v[214:217], a[136:139], v[206:209], v[214:217]
    ds_read_b128 v[206:209], v153 offset:6400
    v_mfma_f32_16x16x32_bf16 v[238:241], a[112:115], v[142:145], v[238:241]
    v_mfma_f32_16x16x32_bf16 v[242:245], a[136:139], v[142:145], v[242:245]
    ds_read_b128 v[202:205], v153 offset:256
    buffer_load_dwordx4 v132, s[48:51], 0 offen offset:1024 lds
    s_waitcnt vmcnt(6)
    ds_read_b64_tr_b16 a[92:93], v140 offset:3072
    ds_read_b64_tr_b16 a[94:95], v140 offset:3840
    ds_read_b64_tr_b16 a[116:117], v140 offset:3104
    ds_read_b64_tr_b16 a[118:119], v140 offset:3872
    s_waitcnt lgkmcnt(4)
    v_mfma_f32_16x16x32_bf16 v[126:129], a[88:91], v[202:205], v[126:129]
    buffer_load_dwordx4 v134, s[48:51], 0 offen offset:2048 lds
    ds_read_b64_tr_b16 a[140:141], v140 offset:3136
    ds_read_b64_tr_b16 a[142:143], v140 offset:3904
    s_add_u32 s48, s48, 36864
    s_addc_u32 s49, s49, 0
    s_add_u32 m0, s68, 0
    v_mov_b32 v142, 0
    v_mov_b32 v143, 0
    v_mov_b32 v144, 0
    v_mov_b32 v145, 0
    v_mov_b32 v210, v158
    v_mov_b32 v211, v158
    v_mov_b32 v212, v158
    v_mov_b32 v213, v158
    s_waitcnt lgkmcnt(4)
    v_mfma_f32_16x16x32_bf16 v[174:177], a[92:95], v[190:193], v[174:177]
    s_waitcnt lgkmcnt(3)
    v_mfma_f32_16x16x32_bf16 v[226:229], a[92:95], v[218:221], v[226:229]
    s_waitcnt lgkmcnt(2)
    buffer_load_dwordx4 v130, s[48:51], 0 offen lds
    v_mfma_f32_16x16x32_bf16 v[198:201], a[116:119], v[190:193], v[198:201]
    s_waitcnt lgkmcnt(0)
    v_mfma_f32_16x16x32_bf16 v[214:217], a[140:143], v[190:193], v[214:217]
    v_mfma_f32_16x16x32_bf16 v[238:241], a[116:119], v[218:221], v[238:241]
    v_cvt_pk_f16_f32 v118, v174, v175
    v_pk_mul_f16 v175, v118, v118
    v_mfma_f32_16x16x32_bf16 v[242:245], a[140:143], v[218:221], v[242:245]
    s_waitcnt vmcnt(6)
    v_cndmask_b32 v166, v166, v167, s[92:93]
    v_cndmask_b32 v168, v168, v169, s[92:93]
    v_perm_b32 v149, v168, v166, v121
    v_mfma_f32_16x16x32_bf16 v[166:169], a[96:99], v[230:233], 0
    buffer_load_dwordx4 v132, s[48:51], 0 offen offset:1024 lds
    v_cvt_pk_f16_f32 v119, v176, v177
    v_mfma_f32_16x16x32_bf16 v[166:169], a[100:103], v[182:185], v[166:169]
    v_pk_fma_f16 v175, v119, v119, v175
    v_cvt_pk_f16_f32 v120, v198, v199
    v_mfma_f32_16x16x32_bf16 v[166:169], a[104:107], v[170:173], v[166:169]
    v_pk_fma_f16 v175, v120, v120, v175
    v_cvt_pk_f16_f32 v121, v200, v201
    v_pk_fma_f16 v175, v121, v121, v175
    v_mfma_f32_16x16x16_bf16 v[198:201], v[148:149], v[194:195], 0
    v_cvt_pk_f16_f32 v220, v214, v215
    v_pk_fma_f16 v175, v220, v220, v175
    v_cvt_pk_f16_f32 v221, v216, v217
    v_mfma_f32_16x16x16_bf16 v[214:217], v[148:149], v[136:137], 0
    v_pk_fma_f16 v175, v221, v221, v175
    v_cvt_pk_f16_f32 v194, v226, v227
    v_pk_mul_f16 v191, v194, v194
    v_mfma_f32_16x16x16_bf16 v[246:249], v[148:149], v[122:123], 0
    v_cvt_pk_bf16_f32 v198, v198, v198
    v_and_b32 v198, 0xffff0000, v198
    v_mul_f32 v198, 0xbfb8aa3b, v198
    v_cvt_pk_f16_f32 v195, v228, v229
    v_mfma_f32_16x16x32_bf16 v[166:169], a[108:111], v[178:181], v[166:169]
    buffer_load_dwordx4 v134, s[48:51], 0 offen offset:2048 lds
    ds_read_b128 v[226:229], v146 offset:6400
    s_waitcnt vmcnt(6)
    v_mfma_f32_16x16x32_bf16 v[166:169], a[112:115], v[202:205], v[166:169]
    s_add_u32 s48, s48, 36864
    ds_read_b64_tr_b16 a[0:1], v141 offset:0
    ds_read_b64_tr_b16 a[2:3], v141 offset:768
    v_mfma_f32_16x16x32_bf16 v[250:253], a[120:123], v[230:233], 0
    s_addc_u32 s49, s49, 0
    ds_read_b64_tr_b16 a[24:25], v141 offset:32
    ds_read_b64_tr_b16 a[26:27], v141 offset:800
    v_mfma_f32_16x16x32_bf16 v[250:253], a[124:127], v[182:185], v[250:253]
    s_add_u32 m0, s68, 3072
    ds_read_b64_tr_b16 a[48:49], v141 offset:64
    ds_read_b64_tr_b16 a[50:51], v141 offset:832
    v_mfma_f32_16x16x32_bf16 v[250:253], a[128:131], v[170:173], v[250:253]
    ds_read_b128 v[216:219], v146 offset:256
    v_cvt_pk_bf16_f32 v214, v214, v214
    v_mfma_f32_16x16x32_bf16 v[250:253], a[132:135], v[178:181], v[250:253]
    buffer_load_dwordx4 v130, s[48:51], 0 offen lds
    v_and_b32 v214, 0xffff0000, v214
    v_mfma_f32_16x16x32_bf16 v[250:253], a[136:139], v[202:205], v[250:253]
    v_exp_f32 v198, v198
    v_mul_f32 v214, 0xbfb8aa3b, v214
    v_add_f32 v198, 1.0, v198
    v_rcp_f32 v198, v198
    v_exp_f32 v214, v214
    v_cvt_pk_bf16_f32 v198, v198, v198
    v_and_b32 v198, 0xffff0000, v198
    v_add_f32 v198, -0.5, v198
    v_mul_f32 v198, 0x41b8aa3b, v198
    ds_write_b32 v196, v198 offset:0
    s_waitcnt lgkmcnt(1)
    v_mfma_f32_16x16x32_bf16 v[126:129], a[92:95], v[216:219], v[126:129]
    buffer_load_dwordx4 v132, s[48:51], 0 offen offset:1024 lds
    v_add_f32 v214, 1.0, v214
    v_mfma_f32_16x16x32_bf16 v[166:169], a[116:119], v[216:219], v[166:169]
    v_rcp_f32 v214, v214
    v_mfma_f32_16x16x32_bf16 v[250:253], a[140:143], v[216:219], v[250:253]
    v_cvt_pk_bf16_f32 v214, v214, v214
    v_and_b32 v214, 0xffff0000, v214
    v_add_f32 v214, -0.5, v214
    v_mul_f32 v214, 0x41b8aa3b, v214
    s_waitcnt vmcnt(5)
    ds_read_b64_tr_b16 a[4:5], v141 offset:3072
    ds_read_b64_tr_b16 a[6:7], v141 offset:3840
    ds_read_b64_tr_b16 a[28:29], v141 offset:3104
    ds_read_b64_tr_b16 a[30:31], v141 offset:3872
    ds_read_b64_tr_b16 a[52:53], v141 offset:3136
    ds_read_b64_tr_b16 a[54:55], v141 offset:3904
    ds_write_b32 v196, v214 offset:4
    buffer_load_dwordx4 v134, s[48:51], 0 offen offset:2048 lds
    s_add_u32 s48, s48, 36864
    s_addc_u32 s49, s49, 0
    s_add_u32 m0, s69, 0
    v_cvt_pk_bf16_f32 v246, v246, v246
    v_and_b32 v246, 0xffff0000, v246
    v_mul_f32 v246, 0xbfb8aa3b, v246
    v_exp_f32 v246, v246
    ds_write_b128 v147, v[142:145] offset:16
    v_add_f32 v246, 1.0, v246
    v_rcp_f32 v246, v246
    buffer_load_dwordx4 v130, s[48:51], 0 offen lds
    v_cvt_pk_bf16_f32 v246, v246, v246
    v_and_b32 v246, 0xffff0000, v246
    v_add_f32 v246, -0.5, v246
    v_mul_f32 v246, 0x41b8aa3b, v246
    ds_write_b32 v196, v246 offset:8
    v_mfma_f32_16x16x32_bf16 v[198:201], a[0:3], v[230:233], 0
    s_waitcnt lgkmcnt(2)
    v_pk_fma_f16 v191, v195, v195, v191
    v_cvt_pk_f16_f32 v196, v238, v239
    v_mfma_f32_16x16x32_bf16 v[198:201], a[4:7], v[182:185], v[198:201]
    ds_write_b64 v147, v[142:143] offset:56
    v_pk_fma_f16 v191, v196, v196, v191
    buffer_load_dwordx4 v132, s[48:51], 0 offen offset:1024 lds
    ds_write_b64 v147, v[142:143] offset:64
    v_cvt_pk_f16_f32 v197, v240, v241
    v_pk_fma_f16 v191, v197, v197, v191
    v_cvt_pk_f16_f32 v148, v242, v243
    v_mfma_f32_16x16x32_bf16 v[238:241], a[24:27], v[230:233], 0
    ds_write_b128 v155, v[142:145] offset:16
    v_mfma_f32_16x16x32_bf16 v[238:241], a[28:31], v[182:185], v[238:241]
    v_pk_fma_f16 v191, v148, v148, v191
    s_waitcnt vmcnt(5)
    buffer_load_dwordx4 v134, s[48:51], 0 offen offset:2048 lds
    s_add_u32 s48, s48, 36864
    s_addc_u32 s49, s49, 0
    s_add_u32 m0, s69, 3072
    ds_read_b64_tr_b16 a[8:9], v138 offset:0
    ds_read_b64_tr_b16 a[10:11], v138 offset:768
    ds_read_b64_tr_b16 a[32:33], v138 offset:32
    ds_read_b64_tr_b16 a[34:35], v138 offset:800
    ds_read_b64_tr_b16 a[56:57], v138 offset:64
    ds_read_b64_tr_b16 a[58:59], v138 offset:832
    ds_write_b64 v155, v[142:143] offset:56
    v_cvt_pk_f16_f32 v149, v244, v245
    v_pk_fma_f16 v191, v149, v149, v191
    v_cvt_pk_f16_f32 v242, v126, v127
    v_mfma_f32_16x16x32_bf16 v[246:249], a[48:51], v[230:233], 0
    ds_read_b128 v[230:233], v153 offset:6144
    v_pk_mul_f16 v215, v242, v242
    v_mfma_f32_16x16x32_bf16 v[246:249], a[52:55], v[182:185], v[246:249]
    buffer_load_dwordx4 v130, s[48:51], 0 offen lds
    ds_write_b64 v155, v[142:143] offset:64
    v_cvt_pk_f16_f32 v243, v128, v129
    v_pk_fma_f16 v215, v243, v243, v215
    s_waitcnt lgkmcnt(7)
    v_mfma_f32_16x16x32_bf16 v[198:201], a[8:11], v[170:173], v[198:201]
    s_waitcnt lgkmcnt(5)
    ds_read_b128 v[126:129], v146 offset:6144
    v_cvt_pk_f16_f32 v244, v166, v167
    v_mfma_f32_16x16x32_bf16 v[238:241], a[32:35], v[170:173], v[238:241]
    s_waitcnt lgkmcnt(3)
    ds_write_b128 v151, v[210:213] offset:192
    v_mfma_f32_16x16x32_bf16 v[246:249], a[56:59], v[170:173], v[246:249]
    s_waitcnt lgkmcnt(3)
    v_pk_fma_f16 v215, v244, v244, v215
    v_cvt_pk_f16_f32 v245, v168, v169
    v_mfma_f32_16x16x32_bf16 v[182:185], a[0:3], v[230:233], 0
    buffer_load_dwordx4 v132, s[48:51], 0 offen offset:1024 lds
    v_pk_fma_f16 v215, v245, v245, v215
    v_mfma_f32_16x16x32_bf16 v[166:169], a[24:27], v[230:233], 0
    ds_write_b128 v156, v[210:213] offset:192
    v_mfma_f32_16x16x32_bf16 v[170:173], a[48:51], v[230:233], 0
    s_waitcnt lgkmcnt(2)
    v_cvt_pk_f16_f32 v232, v250, v251
    v_pk_fma_f16 v215, v232, v232, v215
    v_mfma_f32_16x16x32_bf16 v[182:185], a[4:7], v[126:129], v[182:185]
    v_cvt_pk_f16_f32 v233, v252, v253
    v_pk_fma_f16 v215, v233, v233, v215
    s_waitcnt vmcnt(5)
    v_mfma_f32_16x16x32_bf16 v[166:169], a[28:31], v[126:129], v[166:169]
    ds_read_b64_tr_b16 a[12:13], v138 offset:3072
    buffer_load_dwordx4 v134, s[48:51], 0 offen offset:2048 lds
    v_mfma_f32_16x16x32_bf16 v[170:173], a[52:55], v[126:129], v[170:173]
    s_sub_u32 s48, s48, 183552
    ds_read_b64_tr_b16 a[14:15], v138 offset:3840
    ds_read_b64_tr_b16 a[36:37], v138 offset:3104
    ds_read_b64_tr_b16 a[38:39], v138 offset:3872
    ds_read_b64_tr_b16 a[60:61], v138 offset:3136
    ds_read_b64_tr_b16 a[62:63], v138 offset:3904
    ds_read_b128 v[126:129], v153 offset:6272
    s_subb_u32 s49, s49, 0
    ds_read_b128 v[210:213], v0 offset:20480
    s_add_u32 m0, s68, 0
    ds_read_b128 v[250:253], v1 offset:20480
    buffer_load_dwordx4 v130, s[48:51], 0 offen lds
    s_waitcnt lgkmcnt(7)
    v_mfma_f32_16x16x32_bf16 v[198:201], a[12:15], v[178:181], v[198:201]
    s_waitcnt lgkmcnt(6)
    s_waitcnt lgkmcnt(5)
    v_mfma_f32_16x16x32_bf16 v[238:241], a[36:39], v[178:181], v[238:241]
    s_waitcnt lgkmcnt(2)
    v_mfma_f32_16x16x32_bf16 v[246:249], a[60:63], v[178:181], v[246:249]
    s_waitcnt lgkmcnt(1)
    ds_read_b128 v[142:145], v146 offset:6272
    v_mfma_f32_16x16x32_bf16 v[182:185], a[8:11], v[126:129], v[182:185]
    s_waitcnt lgkmcnt(1)
    v_mfma_f32_16x16x32_bf16 v[166:169], a[32:35], v[126:129], v[166:169]
    buffer_load_dwordx4 v132, s[48:51], 0 offen offset:1024 lds
    v_mfma_f32_16x16x32_bf16 v[170:173], a[56:59], v[126:129], v[170:173]
    ds_read_b128 v[178:181], v0 offset:20608
    s_waitcnt lgkmcnt(1)
    s_waitcnt vmcnt(5)
    v_mfma_f32_16x16x32_bf16 v[182:185], a[12:15], v[142:145], v[182:185]
    ds_read_b64_tr_b16 a[16:17], v139 offset:0
    ds_read_b64_tr_b16 a[18:19], v139 offset:768
    v_mfma_f32_16x16x32_bf16 v[166:169], a[36:39], v[142:145], v[166:169]
    buffer_load_dwordx4 v134, s[48:51], 0 offen offset:2048 lds
    ds_read_b64_tr_b16 a[40:41], v139 offset:32
    v_mfma_f32_16x16x32_bf16 v[170:173], a[60:63], v[142:145], v[170:173]
    s_add_u32 s48, s48, 36864
    ds_read_b64_tr_b16 a[42:43], v139 offset:800
    ds_read_b64_tr_b16 a[64:65], v139 offset:64
    v_mfma_f32_16x16x32_bf16 v[142:145], a[0:3], v[210:213], 0
    s_addc_u32 s49, s49, 0
    ds_read_b64_tr_b16 a[66:67], v139 offset:832
    s_add_u32 m0, s68, 3072
    v_mfma_f32_16x16x32_bf16 v[142:145], a[4:7], v[250:253], v[142:145]
    s_waitcnt lgkmcnt(6)
    v_mfma_f32_16x16x32_bf16 v[142:145], a[8:11], v[178:181], v[142:145]
    s_waitcnt lgkmcnt(4)
    v_mfma_f32_16x16x32_bf16 v[198:201], a[16:19], v[202:205], v[198:201]
    buffer_load_dwordx4 v130, s[48:51], 0 offen lds
    s_waitcnt lgkmcnt(2)
    v_mfma_f32_16x16x32_bf16 v[238:241], a[40:43], v[202:205], v[238:241]
    s_waitcnt lgkmcnt(1)
    s_waitcnt lgkmcnt(0)
    v_mfma_f32_16x16x32_bf16 v[246:249], a[64:67], v[202:205], v[246:249]
    ds_read_b128 v[126:129], v153 offset:6400
    buffer_load_dwordx4 v132, s[48:51], 0 offen offset:1024 lds
    s_waitcnt lgkmcnt(0)
    v_mfma_f32_16x16x32_bf16 v[182:185], a[16:19], v[126:129], v[182:185]
    v_mfma_f32_16x16x32_bf16 v[166:169], a[40:43], v[126:129], v[166:169]
    s_waitcnt vmcnt(5)
    ds_read_b64_tr_b16 a[20:21], v139 offset:3072
    buffer_load_dwordx4 v134, s[48:51], 0 offen offset:2048 lds
    v_mfma_f32_16x16x32_bf16 v[170:173], a[64:67], v[126:129], v[170:173]
    s_add_u32 s48, s48, 36864
    ds_read_b64_tr_b16 a[22:23], v139 offset:3840
    ds_read_b64_tr_b16 a[44:45], v139 offset:3104
    v_mfma_f32_16x16x32_bf16 v[126:129], a[24:27], v[210:213], 0
    s_addc_u32 s49, s49, 0
    ds_read_b64_tr_b16 a[46:47], v139 offset:3872
    ds_read_b64_tr_b16 a[68:69], v139 offset:3136
    v_mfma_f32_16x16x32_bf16 v[126:129], a[28:31], v[250:253], v[126:129]
    s_add_u32 m0, s69, 0
    ds_read_b64_tr_b16 a[70:71], v139 offset:3904
    v_mfma_f32_16x16x32_bf16 v[126:129], a[32:35], v[178:181], v[126:129]
    buffer_load_dwordx4 v130, s[48:51], 0 offen lds
    s_waitcnt lgkmcnt(4)
    v_mfma_f32_16x16x32_bf16 v[198:201], a[20:23], v[216:219], v[198:201]
    s_waitcnt lgkmcnt(3)
    s_nop 0
    s_nop 0
    s_waitcnt lgkmcnt(2)
    v_mfma_f32_16x16x32_bf16 v[238:241], a[44:47], v[216:219], v[238:241]
    s_waitcnt lgkmcnt(1)
    s_nop 0
    s_waitcnt lgkmcnt(0)
    v_mfma_f32_16x16x32_bf16 v[246:249], a[68:71], v[216:219], v[246:249]
    ds_read_b128 v[202:205], v146 offset:6400
    v_cvt_pk_f16_f32 v198, v198, v199
    buffer_load_dwordx4 v132, s[48:51], 0 offen offset:1024 lds
    v_pk_mul_f16 v214, v198, v198
    v_cvt_pk_f16_f32 v199, v200, v201
    v_pk_fma_f16 v214, v199, v199, v214
    v_cvt_pk_f16_f32 v200, v238, v239
    v_pk_fma_f16 v214, v200, v200, v214
    v_cvt_pk_f16_f32 v201, v240, v241
    v_pk_fma_f16 v214, v201, v201, v214
    v_cvt_pk_f16_f32 v230, v246, v247
    v_mfma_f32_16x16x32_bf16 v[238:241], a[48:51], v[210:213], 0
    ds_read_b128 v[210:213], v1 offset:20608
    v_pk_fma_f16 v214, v230, v230, v214
    v_mfma_f32_16x16x32_bf16 v[238:241], a[52:55], v[250:253], v[238:241]
    ds_read_b128 v[250:253], v0 offset:20736
    v_cvt_pk_f16_f32 v231, v248, v249
    v_mfma_f32_16x16x32_bf16 v[238:241], a[56:59], v[178:181], v[238:241]
    ds_read_b128 v[178:181], v153 offset:0
    s_waitcnt lgkmcnt(3)
    v_mfma_f32_16x16x32_bf16 v[182:185], a[20:23], v[202:205], v[182:185]
    buffer_load_dwordx4 v134, s[48:51], 0 offen offset:2048 lds
    s_waitcnt vmcnt(6)
    v_mfma_f32_16x16x32_bf16 v[166:169], a[44:47], v[202:205], v[166:169]
    s_add_u32 s48, s48, 36864
    ds_read_b64_tr_b16 a[144:145], v138 offset:0
    ds_read_b64_tr_b16 a[146:147], v138 offset:768
    v_mfma_f32_16x16x32_bf16 v[170:173], a[68:71], v[202:205], v[170:173]
    s_addc_u32 s49, s49, 0
    ds_read_b64_tr_b16 a[168:169], v138 offset:32
    ds_read_b64_tr_b16 a[170:171], v138 offset:800
    ds_read_b64_tr_b16 a[192:193], v138 offset:64
    s_waitcnt lgkmcnt(7)
    v_mfma_f32_16x16x32_bf16 v[142:145], a[12:15], v[210:213], v[142:145]
    s_add_u32 m0, s69, 3072
    ds_read_b64_tr_b16 a[194:195], v138 offset:832
    ds_read_b128 v[202:205], v1 offset:20736
    v_mfma_f32_16x16x32_bf16 v[126:129], a[36:39], v[210:213], v[126:129]
    s_waitcnt lgkmcnt(8)
    v_pk_fma_f16 v214, v231, v231, v214
    v_pk_mul_f16 v216, v198, v242
    v_mfma_f32_16x16x32_bf16 v[142:145], a[16:19], v[250:253], v[142:145]
    s_waitcnt lgkmcnt(7)
    buffer_load_dwordx4 v130, s[48:51], 0 offen lds
    v_pk_fma_f16 v216, v199, v243, v216
    v_mfma_f32_16x16x32_bf16 v[126:129], a[40:43], v[250:253], v[126:129]
    v_pk_fma_f16 v216, v200, v244, v216
    v_pk_fma_f16 v216, v201, v245, v216
    v_mfma_f32_16x16x32_bf16 v[238:241], a[60:63], v[210:213], v[238:241]
    s_waitcnt lgkmcnt(5)
    ds_read_b128 v[210:213], v146 offset:0
    v_pk_fma_f16 v216, v230, v232, v216
    v_mfma_f32_16x16x32_bf16 v[238:241], a[64:67], v[250:253], v[238:241]
    s_waitcnt lgkmcnt(3)
    ds_read_b128 v[250:253], v153 offset:128
    v_pk_fma_f16 v216, v231, v233, v216
    v_mov_b32 v217, 0
    v_cvt_pk_f16_f32 v182, v182, v183
    s_waitcnt lgkmcnt(2)
    v_mfma_f32_16x16x32_bf16 v[142:145], a[20:23], v[202:205], v[142:145]
    v_pk_mul_f16 v174, v182, v182
    v_cvt_pk_f16_f32 v183, v184, v185
    v_mfma_f32_16x16x32_bf16 v[126:129], a[44:47], v[202:205], v[126:129]
    buffer_load_dwordx4 v132, s[48:51], 0 offen offset:1024 lds
    v_pk_fma_f16 v174, v183, v183, v174
    v_mfma_f32_16x16x32_bf16 v[238:241], a[68:71], v[202:205], v[238:241]
    ds_read_b128 v[202:205], v146 offset:128
    v_cvt_pk_f16_f32 v184, v166, v167
    v_pk_fma_f16 v174, v184, v184, v174
    v_cvt_pk_f16_f32 v185, v168, v169
    v_pk_fma_f16 v174, v185, v185, v174
    v_cvt_pk_f16_f32 v218, v170, v171
    v_pk_fma_f16 v174, v218, v218, v174
    v_cvt_pk_f16_f32 v219, v172, v173
    v_mfma_f32_16x16x32_f16 v[166:169], v[40:43], v[214:217], 0
    s_waitcnt lgkmcnt(1)
    ds_read_b128 v[170:173], v153 offset:256
    v_pk_fma_f16 v174, v219, v219, v174
    v_pk_mul_f16 v176, v182, v118
    s_waitcnt vmcnt(5)
    ds_read_b64_tr_b16 a[148:149], v138 offset:3072
    ds_read_b64_tr_b16 a[150:151], v138 offset:3840
    buffer_load_dwordx4 v134, s[48:51], 0 offen offset:2048 lds
    ds_read_b64_tr_b16 a[172:173], v138 offset:3104
    ds_read_b64_tr_b16 a[174:175], v138 offset:3872
    ds_read_b64_tr_b16 a[196:197], v138 offset:3136
    ds_read_b64_tr_b16 a[198:199], v138 offset:3904
    s_add_u32 s48, s48, 36864
    s_addc_u32 s49, s49, 0
    s_add_u32 m0, s68, 0
    v_rsq_f32 v166, v166
    v_rsq_f32 v167, v167
    v_mul_f32 v140, s31, v166
    v_cvt_pk_f16_f32 v141, v140, v167
    v_pk_mul_f16 v242, v242, v141 op_sel:[0,1] op_sel_hi:[1,1]
    v_pk_mul_f16 v243, v243, v141 op_sel:[0,1] op_sel_hi:[1,1]
    v_pk_mul_f16 v244, v244, v141 op_sel:[0,1] op_sel_hi:[1,1]
    v_pk_mul_f16 v245, v245, v141 op_sel:[0,1] op_sel_hi:[1,1]
    v_pk_mul_f16 v232, v232, v141 op_sel:[0,1] op_sel_hi:[1,1]
    buffer_load_dwordx4 v130, s[48:51], 0 offen lds
    ds_write_b128 v147, v[242:245]
    v_pk_mul_f16 v233, v233, v141 op_sel:[0,1] op_sel_hi:[1,1]
    v_pk_mul_f16 v198, v198, v141 op_sel:[0,0] op_sel_hi:[1,0]
    v_pk_mul_f16 v199, v199, v141 op_sel:[0,0] op_sel_hi:[1,0]
    v_pk_mul_f16 v200, v200, v141 op_sel:[0,0] op_sel_hi:[1,0]
    v_pk_mul_f16 v201, v201, v141 op_sel:[0,0] op_sel_hi:[1,0]
    v_pk_mul_f16 v230, v230, v141 op_sel:[0,0] op_sel_hi:[1,0]
    v_pk_mul_f16 v231, v231, v141 op_sel:[0,0] op_sel_hi:[1,0]
    v_mfma_f32_16x16x32_bf16 v[242:245], v[222:225], a[144:147], 0
    s_waitcnt lgkmcnt(1)
    ds_write_b64 v147, v[232:233] offset:48
    v_mfma_f32_16x16x32_bf16 v[242:245], v[186:189], a[148:151], v[242:245]
    buffer_load_dwordx4 v132, s[48:51], 0 offen offset:1024 lds
    v_max3_u32 v44, v44, v166, v167
    v_mul_f32 v151, v168, v140
    v_mfma_f32_16x16x32_bf16 v[214:217], v[222:225], a[168:171], 0
    ds_write_b128 v147, v[198:201] offset:32
    v_mfma_f32_16x16x32_bf16 v[214:217], v[186:189], a[172:175], v[214:217]
    v_pk_fma_f16 v176, v183, v119, v176
    v_pk_fma_f16 v176, v184, v120, v176
    v_mfma_f32_16x16x32_bf16 v[198:201], v[222:225], a[192:195], 0
    v_pk_fma_f16 v176, v185, v121, v176
    v_pk_fma_f16 v176, v218, v220, v176
    s_waitcnt vmcnt(5)
    v_mfma_f32_16x16x32_bf16 v[198:201], v[186:189], a[196:199], v[198:201]
    buffer_load_dwordx4 v134, s[48:51], 0 offen offset:2048 lds
    ds_read_b64_tr_b16 a[152:153], v139 offset:0
    v_mfma_f32_16x16x32_bf16 v[186:189], v[178:181], a[144:147], 0
    s_add_u32 s48, s48, 36864
    ds_read_b64_tr_b16 a[154:155], v139 offset:768
    ds_read_b64_tr_b16 a[176:177], v139 offset:32
    v_mfma_f32_16x16x32_bf16 v[186:189], v[210:213], a[148:151], v[186:189]
    s_addc_u32 s49, s49, 0
    ds_read_b64_tr_b16 a[178:179], v139 offset:800
    ds_read_b64_tr_b16 a[200:201], v139 offset:64
    v_mfma_f32_16x16x32_bf16 v[222:225], v[178:181], a[168:171], 0
    s_add_u32 m0, s68, 3072
    ds_read_b64_tr_b16 a[202:203], v139 offset:832
    v_pk_fma_f16 v176, v219, v221, v176
    v_mfma_f32_16x16x32_bf16 v[222:225], v[210:213], a[172:175], v[222:225]
    ds_write_b64 v147, v[230:231] offset:72
    buffer_load_dwordx4 v130, s[48:51], 0 offen lds
    v_mfma_f32_16x16x32_bf16 v[230:233], v[178:181], a[192:195], 0
    v_mov_b32 v177, 0
    v_cvt_pk_f16_f32 v142, v142, v143
    v_mfma_f32_16x16x32_bf16 v[230:233], v[210:213], a[196:199], v[230:233]
    s_waitcnt lgkmcnt(6)
    ds_read_b128 v[178:181], v146 offset:256
    ds_read_b128 v[210:213], v0 offset:20480
    s_waitcnt lgkmcnt(6)
    v_mfma_f32_16x16x32_bf16 v[242:245], v[234:237], a[152:155], v[242:245]
    s_waitcnt lgkmcnt(5)
    v_pk_mul_f16 v190, v142, v142
    v_cvt_pk_f16_f32 v143, v144, v145
    v_mfma_f32_16x16x32_bf16 v[214:217], v[234:237], a[176:179], v[214:217]
    s_waitcnt lgkmcnt(3)
    v_pk_fma_f16 v190, v143, v143, v190
    v_cvt_pk_f16_f32 v144, v126, v127
    v_mfma_f32_16x16x32_bf16 v[198:201], v[234:237], a[200:203], v[198:201]
    ds_read_b128 v[234:237], v1 offset:20480
    buffer_load_dwordx4 v132, s[48:51], 0 offen offset:1024 lds
    v_mfma_f32_16x16x32_bf16 v[186:189], v[250:253], a[152:155], v[186:189]
    v_pk_fma_f16 v190, v144, v144, v190
    v_cvt_pk_f16_f32 v145, v128, v129
    v_mfma_f32_16x16x32_f16 v[126:129], v[40:43], v[174:177], 0
    v_pk_fma_f16 v190, v145, v145, v190
    v_cvt_pk_f16_f32 v146, v238, v239
    v_mfma_f32_16x16x32_bf16 v[222:225], v[250:253], a[176:179], v[222:225]
    s_waitcnt lgkmcnt(1)
    v_pk_fma_f16 v190, v146, v146, v190
    v_cvt_pk_f16_f32 v147, v240, v241
    v_mfma_f32_16x16x32_bf16 v[230:233], v[250:253], a[200:203], v[230:233]
    ds_read_b128 v[238:241], v0 offset:20608
    v_pk_fma_f16 v190, v147, v147, v190
    v_mfma_f32_16x16x32_bf16 v[250:253], v[210:213], a[144:147], 0
    buffer_load_dwordx4 v134, s[48:51], 0 offen offset:2048 lds
    v_mfma_f32_16x16x32_bf16 v[134:137], v[210:213], a[168:171], 0
    s_waitcnt vmcnt(6)
    s_waitcnt lgkmcnt(1)
    ds_read_b64_tr_b16 a[156:157], v139 offset:3072
    v_mfma_f32_16x16x32_bf16 v[250:253], v[234:237], a[148:151], v[250:253]
    s_add_u32 m0, s28, 8192
    ds_read_b64_tr_b16 a[158:159], v139 offset:3840
    ds_read_b64_tr_b16 a[180:181], v139 offset:3104
    v_mfma_f32_16x16x32_bf16 v[134:137], v[234:237], a[172:175], v[134:137]
    ds_read_b64_tr_b16 a[182:183], v139 offset:3872
    ds_read_b64_tr_b16 a[204:205], v139 offset:3136
    ds_read_b64_tr_b16 a[206:207], v139 offset:3904
    v_rsq_f32 v126, v126
    v_rsq_f32 v127, v127
    s_waitcnt lgkmcnt(6)
    v_mfma_f32_16x16x32_bf16 v[250:253], v[238:241], a[152:155], v[250:253]
    buffer_load_dwordx4 v12, s[8:11], s25 offen nt lds
    v_mfma_f32_16x16x32_bf16 v[134:137], v[238:241], a[176:179], v[134:137]
    s_add_u32 m0, s28, 12288
    v_mul_f32 v192, s31, v126
    v_cvt_pk_f16_f32 v193, v192, v127
    v_pk_mul_f16 v118, v118, v193 op_sel:[0,1] op_sel_hi:[1,1]
    v_pk_mul_f16 v119, v119, v193 op_sel:[0,1] op_sel_hi:[1,1]
    v_pk_mul_f16 v120, v120, v193 op_sel:[0,1] op_sel_hi:[1,1]
    s_waitcnt lgkmcnt(4)
    v_mfma_f32_16x16x32_bf16 v[242:245], v[114:117], a[156:159], v[242:245]
    s_waitcnt lgkmcnt(3)
    v_pk_mul_f16 v121, v121, v193 op_sel:[0,1] op_sel_hi:[1,1]
    v_pk_mul_f16 v220, v220, v193 op_sel:[0,1] op_sel_hi:[1,1]
    v_mfma_f32_16x16x32_bf16 v[186:189], v[202:205], a[156:159], v[186:189]
    s_waitcnt lgkmcnt(0)
    ds_write_b128 v155, v[118:121]
    v_mfma_f32_16x16x32_bf16 v[214:217], v[114:117], a[180:183], v[214:217]
    buffer_load_dwordx4 v13, s[8:11], s25 offen nt lds
    v_mfma_f32_16x16x32_bf16 v[198:201], v[114:117], a[204:207], v[198:201]
    s_add_u32 m0, s29, 0
    v_pk_mul_f16 v221, v221, v193 op_sel:[0,1] op_sel_hi:[1,1]
    v_pk_mul_f16 v182, v182, v193 op_sel:[0,0] op_sel_hi:[1,0]
    v_mfma_f32_16x16x32_bf16 v[222:225], v[202:205], a[180:183], v[222:225]
    ds_write_b64 v155, v[220:221] offset:48
    v_mfma_f32_16x16x32_bf16 v[230:233], v[202:205], a[204:207], v[230:233]
    v_pk_mul_f16 v183, v183, v193 op_sel:[0,0] op_sel_hi:[1,0]
    v_pk_mul_f16 v184, v184, v193 op_sel:[0,0] op_sel_hi:[1,0]
    v_mfma_f32_16x16x32_bf16 v[118:121], v[210:213], a[192:195], 0
    ds_read_b128 v[114:117], v1 offset:20608
    v_pk_mul_f16 v185, v185, v193 op_sel:[0,0] op_sel_hi:[1,0]
    v_mfma_f32_16x16x32_bf16 v[118:121], v[234:237], a[196:199], v[118:121]
    s_waitcnt vmcnt(5)
    buffer_load_dwordx4 v14, s[8:11], s25 offen nt lds
    v_mfma_f32_16x16x32_bf16 v[118:121], v[238:241], a[200:203], v[118:121]
    s_add_u32 m0, s69, 0
    ds_read_b64_tr_b16 a[160:161], v138 offset:0
    ds_read_b64_tr_b16 a[162:163], v138 offset:768
    ds_read_b64_tr_b16 a[184:185], v138 offset:32
    ds_read_b64_tr_b16 a[186:187], v138 offset:800
    ds_read_b64_tr_b16 a[208:209], v138 offset:64
    ds_read_b64_tr_b16 a[210:211], v138 offset:832
    ds_write_b128 v155, v[182:185] offset:32
    s_lshr_b32 s10, s17, 1
    s_cselect_b32 s10, s36, 0
    v_pk_mul_f16 v218, v218, v193 op_sel:[0,0] op_sel_hi:[1,0]
    v_pk_mul_f16 v219, v219, v193 op_sel:[0,0] op_sel_hi:[1,0]
    s_waitcnt lgkmcnt(7)
    v_mfma_f32_16x16x32_bf16 v[250:253], v[114:117], a[156:159], v[250:253]
    buffer_load_dwordx4 v164, s[52:55], 0 offen lds
    v_cndmask_b32 v126, 1.0, v126, s[94:95]
    v_mfma_f32_16x16x32_bf16 v[134:137], v[114:117], a[180:183], v[134:137]
    s_mov_b32 s25, s24
    ds_write_b64 v155, v[218:219] offset:72
    v_mfma_f32_16x16x32_bf16 v[118:121], v[114:117], a[204:207], v[118:121]
    s_waitcnt lgkmcnt(4)
    v_cndmask_b32 v127, 1.0, v127, s[94:95]
    v_max3_u32 v44, v44, v126, v127
    v_mfma_f32_16x16x32_bf16 v[242:245], v[206:209], a[160:163], v[242:245]
    s_waitcnt lgkmcnt(1)
    v_mul_f32 v153, v128, v192
    v_mov_b32 v192, 0
    v_mfma_f32_16x16x32_bf16 v[214:217], v[206:209], a[184:187], v[214:217]
    v_mov_b32 v193, 0
    v_xor_b32 v130, 65536, v2
    v_mfma_f32_16x16x32_bf16 v[198:201], v[206:209], a[208:211], v[198:201]
    buffer_load_dwordx4 v165, s[52:55], 0 offen offset:1024 lds
    v_lshrrev_b32 v132, 2, v130
    v_mfma_f32_16x16x32_f16 v[114:117], v[40:43], v[190:193], 0
    v_lshrrev_b32 v133, 8, v130
    v_lshl_add_u32 v122, s16, 2, v130
    v_mfma_f32_16x16x32_bf16 v[186:189], v[170:173], a[160:163], v[186:189]
    v_add_u32 v132, 62784, v132
    v_lshlrev_b32 v133, 4, v133
    v_mfma_f32_16x16x32_bf16 v[222:225], v[170:173], a[184:187], v[222:225]
    v_add_u32 v133, 62784, v133
    v_or_b32 v206, v32, v33
    v_mfma_f32_16x16x32_bf16 v[230:233], v[170:173], a[208:211], v[230:233]
    ds_read_b128 v[234:237], v0 offset:20736
    s_waitcnt vmcnt(5)
    ds_read_b64_tr_b16 a[164:165], v138 offset:3072
    ds_read_b64_tr_b16 a[166:167], v138 offset:3840
    ds_read_b64_tr_b16 a[188:189], v138 offset:3104
    buffer_load_dwordx4 v255, s[52:55], 0 offen offset:2048 lds
    ds_read_b64_tr_b16 a[190:191], v138 offset:3872
    ds_read_b64_tr_b16 a[212:213], v138 offset:3136
    ds_read_b64_tr_b16 a[214:215], v138 offset:3904
    s_add_u32 s52, s52, 12288
    s_addc_u32 s53, s53, 0
    s_add_u32 m0, s69, 3072
    v_rsq_f32 v114, v114
    v_rsq_f32 v115, v115
    v_mul_f32 v116, s31, v114
    v_cvt_pk_f16_f32 v117, v116, v115
    v_pk_mul_f16 v194, v194, v117 op_sel:[0,1] op_sel_hi:[1,1]
    v_pk_mul_f16 v195, v195, v117 op_sel:[0,1] op_sel_hi:[1,1]
    v_pk_mul_f16 v196, v196, v117 op_sel:[0,1] op_sel_hi:[1,1]
    v_pk_mul_f16 v197, v197, v117 op_sel:[0,1] op_sel_hi:[1,1]
    v_pk_mul_f16 v148, v148, v117 op_sel:[0,1] op_sel_hi:[1,1]
    s_waitcnt lgkmcnt(6)
    v_mfma_f32_16x16x32_bf16 v[250:253], v[234:237], a[160:163], v[250:253]
    s_waitcnt lgkmcnt(5)
    buffer_load_dwordx4 v164, s[52:55], 0 offen lds
    v_pk_mul_f16 v149, v149, v117 op_sel:[0,1] op_sel_hi:[1,1]
    v_mfma_f32_16x16x32_bf16 v[134:137], v[234:237], a[184:187], v[134:137]
    s_waitcnt lgkmcnt(2)
    v_pk_mul_f16 v142, v142, v117 op_sel:[0,0] op_sel_hi:[1,0]
    v_pk_mul_f16 v143, v143, v117 op_sel:[0,0] op_sel_hi:[1,0]
    v_mfma_f32_16x16x32_bf16 v[242:245], v[226:229], a[164:167], v[242:245]
    s_waitcnt lgkmcnt(0)
    v_pk_mul_f16 v144, v144, v117 op_sel:[0,0] op_sel_hi:[1,0]
    v_pk_mul_f16 v145, v145, v117 op_sel:[0,0] op_sel_hi:[1,0]
    v_mfma_f32_16x16x32_bf16 v[214:217], v[226:229], a[188:191], v[214:217]
    v_pk_mul_f16 v146, v146, v117 op_sel:[0,0] op_sel_hi:[1,0]
    v_pk_mul_f16 v147, v147, v117 op_sel:[0,0] op_sel_hi:[1,0]
    v_mfma_f32_16x16x32_bf16 v[198:201], v[226:229], a[212:215], v[198:201]
    v_max3_u32 v44, v44, v114, v115
    v_cvt_pk_bf16_f32 v242, v242, v242
    v_mfma_f32_16x16x32_bf16 v[186:189], v[178:181], a[164:167], v[186:189]
    v_cvt_pk_bf16_f32 v243, v243, v243
    v_cvt_pk_bf16_f32 v244, v244, v244
    v_mfma_f32_16x16x32_bf16 v[222:225], v[178:181], a[188:191], v[222:225]
    buffer_load_dwordx4 v165, s[52:55], 0 offen offset:1024 lds
    v_cvt_pk_bf16_f32 v245, v245, v245
    v_mfma_f32_16x16x32_bf16 v[230:233], v[178:181], a[212:215], v[230:233]
    ds_read_b128 v[114:117], v1 offset:20736
    v_cvt_pk_bf16_f32 v214, v214, v214
    v_mfma_f32_16x16x32_bf16 v[118:121], v[234:237], a[208:211], v[118:121]
    ds_write2_b32 v157, v242, v243 offset0:0 offset1:68
    v_cvt_pk_bf16_f32 v215, v215, v215
    v_cvt_pk_bf16_f32 v216, v216, v216
    v_cvt_pk_bf16_f32 v217, v217, v217
    ds_write2_b32 v157, v244, v245 offset0:136 offset1:204
    buffer_load_dwordx4 v255, s[52:55], 0 offen offset:2048 lds
    s_add_u32 s52, s52, 12288
    s_addc_u32 s53, s53, 0
    s_add_u32 m0, s68, 0
    ds_write2_b32 v157, v214, v215 offset0:16 offset1:84
    s_waitcnt lgkmcnt(3)
    v_mfma_f32_16x16x32_bf16 v[250:253], v[114:117], a[164:167], v[250:253]
    v_cvt_pk_bf16_f32 v198, v198, v198
    v_cvt_pk_bf16_f32 v199, v199, v199
    v_mfma_f32_16x16x32_bf16 v[134:137], v[114:117], a[188:191], v[134:137]
    ds_write2_b32 v157, v216, v217 offset0:152 offset1:220
    v_mfma_f32_16x16x32_bf16 v[118:121], v[114:117], a[212:215], v[118:121]
    v_cvt_pk_bf16_f32 v200, v200, v200
    v_cvt_pk_bf16_f32 v201, v201, v201
    ds_write2_b32 v157, v198, v199 offset0:32 offset1:100
    v_cvt_pk_bf16_f32 v186, v186, v186
    v_cvt_pk_bf16_f32 v187, v187, v187
    v_cvt_pk_bf16_f32 v188, v188, v188
    ds_write2_b32 v157, v200, v201 offset0:168 offset1:236
    v_cvt_pk_bf16_f32 v189, v189, v189
    v_cvt_pk_bf16_f32 v222, v222, v222
    v_cvt_pk_bf16_f32 v223, v223, v223
    ds_write2_b32 v154, v186, v187 offset0:0 offset1:68
    v_cvt_pk_bf16_f32 v224, v224, v224
    v_cvt_pk_bf16_f32 v225, v225, v225
    v_cvt_pk_bf16_f32 v230, v230, v230
    ds_write2_b32 v154, v188, v189 offset0:136 offset1:204
    v_cvt_pk_bf16_f32 v231, v231, v231
    v_cvt_pk_bf16_f32 v232, v232, v232
    v_cvt_pk_bf16_f32 v233, v233, v233
    ds_write2_b32 v154, v222, v223 offset0:16 offset1:84
    v_cvt_pk_bf16_f32 v114, v250, v251
    v_cvt_pk_bf16_f32 v115, v252, v253
    v_cvt_pk_bf16_f32 v226, v134, v135
    ds_write2_b32 v154, v224, v225 offset0:152 offset1:220
    v_cvt_pk_bf16_f32 v227, v136, v137
    v_cvt_pk_bf16_f32 v242, v118, v119
    v_cvt_pk_bf16_f32 v243, v120, v121
    ds_write2_b32 v154, v230, v231 offset0:32 offset1:100
    v_and_b32 v206, 0xffff, v206
    v_lshl_or_b32 v206, v206, 16, v206
    v_or_b32 v207, v32, v33
    ds_write2_b32 v154, v232, v233 offset0:168 offset1:236
    v_and_b32 v207, 0xffff, v207
    v_lshl_or_b32 v207, v207, 16, v207
    v_or_b32 v208, v32, v33
    v_lshrrev_b32 v208, 16, v208
    v_lshl_or_b32 v208, v208, 16, v208
    v_or_b32 v209, v32, v33
    v_lshrrev_b32 v209, 16, v209
    v_lshl_or_b32 v209, v209, 16, v209
    v_xor_b32 v2, 65536, v2
    buffer_load_dwordx4 v164, s[52:55], 0 offen lds
    buffer_load_dwordx4 v165, s[52:55], 0 offen offset:1024 lds
    buffer_load_dwordx4 v255, s[52:55], 0 offen offset:2048 lds
    s_waitcnt vmcnt(9)
    s_barrier
    s_barrier
    ds_read_b128 v[118:121], v0 offset:26624
    ds_read_b128 v[186:189], v1 offset:26624
    ds_read_b128 v[234:237], v0 offset:26752
    s_add_u32 s52, s52, 12288
    s_addc_u32 s53, s53, 0
    ds_read_b128 v[182:185], v1 offset:26752
    s_add_u32 m0, s68, 3072
    s_mul_i32 s68, s78, 72
    s_sub_u32 s68, s77, s68
    ds_read_b128 v[238:241], v0 offset:26880
    s_mul_i32 s78, s78, 1373568
    s_mul_i32 s77, s68, 2688
    s_add_u32 s77, s77, s78
    ds_read_b128 v[134:137], v1 offset:26880
    ds_read_b32 v22, v22 offset:0
    buffer_load_dwordx4 v164, s[52:55], 0 offen lds
    ds_read_b32 v23, v23 offset:672
    ds_read_b32 v24, v24 offset:0
    ds_read_b32 v25, v25 offset:672
    s_waitcnt lgkmcnt(8)
    v_mfma_f32_16x16x32_bf16 v[154:157], a[72:75], v[118:121], 0
    s_waitcnt lgkmcnt(7)
    ds_read_b32 v26, v26 offset:0
    ds_read_b32 v27, v27 offset:672
    v_mfma_f32_16x16x32_bf16 v[154:157], a[76:79], v[186:189], v[154:157]
    s_waitcnt lgkmcnt(8)
    ds_read_b32 v46, v46 offset:336
    ds_read_b32 v58, v58 offset:336
    v_mfma_f32_16x16x32_bf16 v[154:157], a[80:83], v[234:237], v[154:157]
    s_waitcnt lgkmcnt(9)
    ds_read_b32 v70, v70 offset:336
    ds_read_b32 v47, v47 offset:332
    v_mfma_f32_16x16x32_bf16 v[154:157], a[84:87], v[182:185], v[154:157]
    s_waitcnt lgkmcnt(10)
    buffer_load_dwordx4 v165, s[52:55], 0 offen offset:1024 lds
    ds_read_b32 v59, v59 offset:332
    v_mfma_f32_16x16x32_bf16 v[154:157], a[88:91], v[238:241], v[154:157]
    s_waitcnt lgkmcnt(9)
    ds_read_b32 v71, v71 offset:332
    ds_read_b32 v48, v48 offset:328
    v_mfma_f32_16x16x32_bf16 v[154:157], a[92:95], v[134:137], v[154:157]
    s_waitcnt lgkmcnt(9)
    s_waitcnt vmcnt(8)
    ds_read_b64 a[216:217], v159 offset:0
    v_mfma_f32_16x16x32_bf16 v[222:225], a[96:99], v[118:121], 0
    s_waitcnt lgkmcnt(9)
    ds_read_b64 a[218:219], v159 offset:1536
    ds_read_b64 a[240:241], v159 offset:8
    v_mfma_f32_16x16x32_bf16 v[222:225], a[100:103], v[186:189], v[222:225]
    s_waitcnt lgkmcnt(9)
    ds_read_b64 a[242:243], v159 offset:1544
    ds_read_b64 v[90:91], v160 offset:0
    v_mfma_f32_16x16x32_bf16 v[222:225], a[104:107], v[234:237], v[222:225]
    s_waitcnt lgkmcnt(9)
    ds_read_b64 v[92:93], v160 offset:1536
    buffer_load_dwordx4 v255, s[52:55], 0 offen offset:2048 lds
    v_mfma_f32_16x16x32_bf16 v[222:225], a[108:111], v[182:185], v[222:225]
    s_add_u32 s52, s52, 12288
    ds_read_b32 v60, v60 offset:328
    ds_read_b32 v72, v72 offset:328
    v_mfma_f32_16x16x32_bf16 v[222:225], a[112:115], v[238:241], v[222:225]
    s_addc_u32 s53, s53, 0
    ds_read_b32 v49, v49 offset:324
    ds_read_b32 v61, v61 offset:324
    v_mfma_f32_16x16x32_bf16 v[222:225], a[116:119], v[134:137], v[222:225]
    s_add_u32 m0, s69, 0
    ds_read_b32 v73, v73 offset:324
    ds_read_b32 v50, v50 offset:272
    v_mfma_f32_16x16x32_bf16 v[178:181], a[120:123], v[118:121], 0
    s_waitcnt lgkmcnt(10)
    ds_read_b32 v62, v62 offset:272
    ds_read_b32 v74, v74 offset:272
    v_mfma_f32_16x16x32_bf16 v[178:181], a[124:127], v[186:189], v[178:181]
    s_waitcnt lgkmcnt(10)
    ds_read_b32 v51, v51 offset:268
    ds_read_b32 v63, v63 offset:268
    v_mfma_f32_16x16x32_bf16 v[178:181], a[128:131], v[234:237], v[178:181]
    s_waitcnt lgkmcnt(10)
    buffer_load_dwordx4 v164, s[52:55], 0 offen lds
    ds_read_b32 v75, v75 offset:268
    v_mfma_f32_16x16x32_bf16 v[178:181], a[132:135], v[182:185], v[178:181]
    s_waitcnt lgkmcnt(10)
    ds_read_b32 v52, v52 offset:264
    ds_read_b32 v64, v64 offset:264
    v_mfma_f32_16x16x32_bf16 v[178:181], a[136:139], v[238:241], v[178:181]
    s_waitcnt lgkmcnt(10)
    ds_read_b32 v76, v76 offset:264
    ds_read_b32 v53, v53 offset:260
    v_mfma_f32_16x16x32_bf16 v[178:181], a[140:143], v[134:137], v[178:181]
    s_waitcnt lgkmcnt(10)
    ds_read_b32 v65, v65 offset:260
    ds_read_b32 v77, v77 offset:260
    v_mfma_f32_16x16x32_bf16 v[138:141], a[0:3], v[118:121], 0
    s_waitcnt vmcnt(7)
    ds_read_b64 a[232:233], v159 offset:3072
    ds_read_b64 a[220:221], v159 offset:4608
    v_mfma_f32_16x16x32_bf16 v[138:141], a[4:7], v[186:189], v[138:141]
    s_waitcnt lgkmcnt(10)
    ds_read_b64 v[82:83], v159 offset:3080
    buffer_load_dwordx4 v165, s[52:55], 0 offen offset:1024 lds
    v_mfma_f32_16x16x32_bf16 v[138:141], a[8:11], v[234:237], v[138:141]
    s_waitcnt lgkmcnt(10)
    ds_read_b64 a[244:245], v159 offset:4616
    ds_read_b64 v[106:107], v160 offset:3072
    v_mfma_f32_16x16x32_bf16 v[138:141], a[12:15], v[182:185], v[138:141]
    s_waitcnt lgkmcnt(10)
    ds_read_b64 v[94:95], v160 offset:4608
    ds_read_b32 v54, v54 offset:208
    v_mfma_f32_16x16x32_bf16 v[138:141], a[16:19], v[238:241], v[138:141]
    s_waitcnt lgkmcnt(10)
    ds_read_b32 v66, v66 offset:208
    ds_read_b32 v78, v78 offset:208
    v_mfma_f32_16x16x32_bf16 v[138:141], a[20:23], v[134:137], v[138:141]
    s_waitcnt lgkmcnt(10)
    ds_read_b32 v55, v55 offset:204
    ds_read_b32 v67, v67 offset:204
    v_mfma_f32_16x16x32_bf16 v[230:233], a[24:27], v[118:121], 0
    s_waitcnt lgkmcnt(10)
    ds_read_b32 v79, v79 offset:204
    ds_read_b32 v56, v56 offset:200
    v_mfma_f32_16x16x32_bf16 v[230:233], a[28:31], v[186:189], v[230:233]
    s_waitcnt lgkmcnt(10)
    buffer_load_dwordx4 v255, s[52:55], 0 offen offset:2048 lds
    ds_read_b32 v68, v68 offset:200
    v_mfma_f32_16x16x32_bf16 v[230:233], a[32:35], v[234:237], v[230:233]
    s_add_u32 s52, s52, 12288
    ds_read_b32 v80, v80 offset:200
    ds_read_b32 v57, v57 offset:196
    v_mfma_f32_16x16x32_bf16 v[230:233], a[36:39], v[182:185], v[230:233]
    s_addc_u32 s53, s53, 0
    ds_read_b32 v69, v69 offset:196
    ds_read_b32 v81, v81 offset:196
    v_mfma_f32_16x16x32_bf16 v[230:233], a[40:43], v[238:241], v[230:233]
    s_add_u32 m0, s69, 3072
    ds_read_b32 v150, v150 offset:336
    v_cndmask_b32 v22, v158, v22, s[88:89]
    v_mfma_f32_16x16x32_bf16 v[230:233], a[44:47], v[134:137], v[230:233]
    s_waitcnt lgkmcnt(9)
    v_cndmask_b32 v24, v158, v24, s[88:89]
    v_mov_b32_dpp v23, v25 quad_perm:[0,1,2,3] row_mask:0x2 bank_mask:0xf
    v_mfma_f32_16x16x32_bf16 v[198:201], a[48:51], v[118:121], 0
    s_add_u32 s69, s77, 589824
    v_cndmask_b32 v26, v158, v26, s[88:89]
    v_mov_b32_dpp v23, v27 quad_perm:[0,1,2,3] row_mask:0x4 bank_mask:0xf
    s_waitcnt vmcnt(6)
    v_mfma_f32_16x16x32_bf16 v[198:201], a[52:55], v[186:189], v[198:201]
    s_waitcnt lgkmcnt(5)
    buffer_load_dwordx4 v164, s[52:55], 0 offen lds
    ds_read_b64 a[222:223], v254 offset:0
    v_mfma_f32_16x16x32_bf16 v[198:201], a[56:59], v[234:237], v[198:201]
    s_waitcnt lgkmcnt(4)
    ds_read_b64 a[234:235], v254 offset:1536
    ds_read_b64 a[246:247], v254 offset:8
    v_mfma_f32_16x16x32_bf16 v[198:201], a[60:63], v[182:185], v[198:201]
    s_waitcnt lgkmcnt(4)
    ds_read_b64 v[84:85], v254 offset:1544
    ds_read_b64 v[96:97], v131 offset:0
    v_mfma_f32_16x16x32_bf16 v[198:201], a[64:67], v[238:241], v[198:201]
    s_waitcnt lgkmcnt(5)
    ds_read_b64 v[108:109], v131 offset:1536
    v_readfirstlane_b32 s39, v150
    v_mfma_f32_16x16x32_bf16 v[198:201], a[68:71], v[134:137], v[198:201]
    s_barrier
    v_fma_f32 v151, v151, v167, s39
    v_fma_f32 v153, v153, v127, s39
    v_mfma_f32_16x16x32_bf16 v[126:129], v[118:121], a[144:147], 0
    ds_write_b32 v161, v151 offset:192
    v_mfma_f32_16x16x32_bf16 v[126:129], v[186:189], a[148:151], v[126:129]
    buffer_load_dwordx4 v165, s[52:55], 0 offen offset:1024 lds
    v_cvt_pk_f16_f32 v154, v154, v155
    v_mfma_f32_16x16x32_bf16 v[126:129], v[234:237], a[152:155], v[126:129]
    s_waitcnt lgkmcnt(5)
    ds_write_b32 v124, v153 offset:192
    v_mfma_f32_16x16x32_bf16 v[126:129], v[182:185], a[156:159], v[126:129]
    s_waitcnt lgkmcnt(4)
    v_pk_mul_f16 v171, v154, v154
    v_cvt_pk_f16_f32 v155, v156, v157
    v_mfma_f32_16x16x32_bf16 v[126:129], v[238:241], a[160:163], v[126:129]
    s_waitcnt lgkmcnt(2)
    v_pk_fma_f16 v171, v155, v155, v171
    v_cvt_pk_f16_f32 v156, v222, v223
    v_mfma_f32_16x16x32_bf16 v[126:129], v[134:137], a[164:167], v[126:129]
    ds_read_b128 v[166:169], v0 offset:32768
    v_pk_fma_f16 v171, v156, v156, v171
    v_mfma_f32_16x16x32_bf16 v[214:217], v[118:121], a[168:171], 0
    ds_read_b128 v[218:221], v1 offset:32768
    buffer_load_dwordx4 v255, s[52:55], 0 offen offset:2048 lds
    v_mfma_f32_16x16x32_bf16 v[214:217], v[186:189], a[172:175], v[214:217]
    s_add_u32 m0, s28, 65536
    s_waitcnt vmcnt(6)
    ds_read_b64 a[224:225], v254 offset:3072
    v_mfma_f32_16x16x32_bf16 v[214:217], v[234:237], a[176:179], v[214:217]
    ds_read_b64 a[226:227], v254 offset:4608
    ds_read_b64 a[248:249], v254 offset:3080
    v_mfma_f32_16x16x32_bf16 v[214:217], v[182:185], a[180:183], v[214:217]
    ds_read_b64 a[250:251], v254 offset:4616
    ds_read_b64 v[98:99], v131 offset:3072
    v_mfma_f32_16x16x32_bf16 v[214:217], v[238:241], a[184:187], v[214:217]
    ds_read_b64 v[100:101], v131 offset:4608
    ds_read_b128 v[202:205], v0 offset:32896
    v_mfma_f32_16x16x32_bf16 v[214:217], v[134:137], a[188:191], v[214:217]
    s_waitcnt lgkmcnt(8)
    ds_read_b128 v[250:253], v1 offset:32896
    ds_read_b128 v[210:213], v0 offset:33024
    v_mfma_f32_16x16x32_bf16 v[190:193], v[118:121], a[192:195], 0
    s_waitcnt lgkmcnt(9)
    buffer_load_dwordx4 v10, s[8:11], s24 offen nt lds
    v_mfma_f32_16x16x32_bf16 v[190:193], v[186:189], a[196:199], v[190:193]
    s_add_u32 m0, s28, 69632
    ds_read_b128 v[118:121], v1 offset:33024
    v_cvt_pk_f16_f32 v157, v224, v225
    v_mfma_f32_16x16x32_bf16 v[190:193], v[234:237], a[200:203], v[190:193]
    s_waitcnt lgkmcnt(8)
    v_pk_fma_f16 v171, v157, v157, v171
    v_cvt_pk_f16_f32 v188, v178, v179
    v_mfma_f32_16x16x32_bf16 v[190:193], v[182:185], a[204:207], v[190:193]
    s_waitcnt lgkmcnt(6)
    v_pk_fma_f16 v171, v188, v188, v171
    v_cvt_pk_f16_f32 v189, v180, v181
    v_mfma_f32_16x16x32_bf16 v[190:193], v[238:241], a[208:211], v[190:193]
    s_waitcnt lgkmcnt(4)
    v_pk_fma_f16 v171, v189, v189, v171
    v_cvt_pk_f16_f32 v234, v138, v139
    v_mfma_f32_16x16x32_bf16 v[190:193], v[134:137], a[212:215], v[190:193]
    s_waitcnt lgkmcnt(2)
    v_pk_mul_f16 v170, v234, v234
    v_cvt_pk_f16_f32 v235, v140, v141
    v_mfma_f32_16x16x32_bf16 v[182:185], a[72:75], v[166:169], 0
    s_waitcnt lgkmcnt(1)
    buffer_load_dwordx4 v11, s[8:11], s24 offen nt lds
    v_mfma_f32_16x16x32_bf16 v[182:185], a[76:79], v[218:221], v[182:185]
    s_add_u32 m0, s28, 73728
    v_pk_fma_f16 v170, v235, v235, v170
    v_cvt_pk_f16_f32 v236, v230, v231
    v_mfma_f32_16x16x32_bf16 v[182:185], a[80:83], v[202:205], v[182:185]
    s_waitcnt lgkmcnt(0)
    s_waitcnt vmcnt(5)
    ds_read_b64 a[236:237], v159 offset:0
    v_mfma_f32_16x16x32_bf16 v[182:185], a[84:87], v[250:253], v[182:185]
    ds_read_b64 a[228:229], v159 offset:1536
    ds_read_b64 v[86:87], v159 offset:8
    v_mfma_f32_16x16x32_bf16 v[182:185], a[88:91], v[210:213], v[182:185]
    ds_read_b64 a[252:253], v159 offset:1544
    ds_read_b64 v[110:111], v160 offset:0
    v_mfma_f32_16x16x32_bf16 v[182:185], a[92:95], v[118:121], v[182:185]
    ds_read_b64 v[102:103], v160 offset:1536
    v_pk_fma_f16 v170, v236, v236, v170
    v_mfma_f32_16x16x32_bf16 v[238:241], a[96:99], v[166:169], 0
    buffer_load_dwordx4 v12, s[8:11], s24 offen nt lds
    v_mfma_f32_16x16x32_bf16 v[238:241], a[100:103], v[218:221], v[238:241]
    s_add_u32 m0, s28, 77824
    v_cvt_pk_f16_f32 v237, v232, v233
    v_pk_fma_f16 v170, v237, v237, v170
    v_mfma_f32_16x16x32_bf16 v[238:241], a[104:107], v[202:205], v[238:241]
    v_cvt_pk_f16_f32 v186, v198, v199
    v_pk_fma_f16 v170, v186, v186, v170
    v_mfma_f32_16x16x32_bf16 v[238:241], a[108:111], v[250:253], v[238:241]
    s_waitcnt lgkmcnt(4)
    v_cvt_pk_f16_f32 v187, v200, v201
    v_pk_fma_f16 v170, v187, v187, v170
    v_mfma_f32_16x16x32_bf16 v[238:241], a[112:115], v[210:213], v[238:241]
    s_waitcnt lgkmcnt(2)
    v_mov_b32 v172, 0
    v_mov_b32 v173, 0
    v_mfma_f32_16x16x32_bf16 v[238:241], a[116:119], v[118:121], v[238:241]
    s_waitcnt lgkmcnt(0)
    v_cvt_pk_bf16_f32 v116, v126, v127
    v_cvt_pk_bf16_f32 v117, v128, v129
    v_mfma_f32_16x16x32_f16 v[126:129], v[40:43], v[170:173], 0
    buffer_load_dwordx4 v13, s[8:11], s24 offen nt lds
    v_mfma_f32_16x16x32_bf16 v[134:137], a[120:123], v[166:169], 0
    s_add_u32 m0, s74, 0
    v_cvt_pk_bf16_f32 v228, v214, v215
    v_cvt_pk_bf16_f32 v229, v216, v217
    v_mfma_f32_16x16x32_bf16 v[134:137], a[124:127], v[218:221], v[134:137]
    v_cvt_pk_bf16_f32 v244, v190, v191
    v_cvt_pk_bf16_f32 v245, v192, v193
    v_mfma_f32_16x16x32_bf16 v[134:137], a[128:131], v[202:205], v[134:137]
    v_rsq_f32 v126, v126
    v_mfma_f32_16x16x32_bf16 v[134:137], a[132:135], v[250:253], v[134:137]
    v_rsq_f32 v127, v127
    v_mfma_f32_16x16x32_bf16 v[134:137], a[136:139], v[210:213], v[134:137]
    v_mul_f32 v128, s31, v126
    v_cvt_pk_f16_f32 v129, v128, v127
    v_mfma_f32_16x16x32_bf16 v[134:137], a[140:143], v[118:121], v[134:137]
    buffer_load_dwordx4 v14, s[8:11], s24 offen nt lds
    v_mfma_f32_16x16x32_bf16 v[222:225], a[0:3], v[166:169], 0
    s_add_u32 s8, s60, s23
    v_pk_mul_f16 v154, v154, v129 op_sel:[0,1] op_sel_hi:[1,1]
    v_pk_mul_f16 v155, v155, v129 op_sel:[0,1] op_sel_hi:[1,1]
    s_waitcnt vmcnt(5)
    v_mfma_f32_16x16x32_bf16 v[222:225], a[4:7], v[218:221], v[222:225]
    s_addc_u32 s9, s61, 0
    ds_read_b64 a[230:231], v159 offset:3072
    ds_read_b64 a[238:239], v159 offset:4608
    v_mfma_f32_16x16x32_bf16 v[222:225], a[8:11], v[202:205], v[222:225]
    s_sub_u32 s10, s36, s23
    ds_read_b64 a[254:255], v159 offset:3080
    ds_read_b64 v[88:89], v159 offset:4616
    v_mfma_f32_16x16x32_bf16 v[222:225], a[12:15], v[250:253], v[222:225]
    s_cmp_lt_u32 s34, s17
    ds_read_b64 v[104:105], v160 offset:3072
    ds_read_b64 v[112:113], v160 offset:4608
    v_mfma_f32_16x16x32_bf16 v[222:225], a[16:19], v[210:213], v[222:225]
    s_cselect_b32 s10, s10, 0
    v_pk_mul_f16 v156, v156, v129 op_sel:[0,1] op_sel_hi:[1,1]
    v_pk_mul_f16 v157, v157, v129 op_sel:[0,1] op_sel_hi:[1,1]
    v_mfma_f32_16x16x32_bf16 v[222:225], a[20:23], v[118:121], v[222:225]
    s_add_u32 m0, s28, 0
    v_pk_mul_f16 v188, v188, v129 op_sel:[0,1] op_sel_hi:[1,1]
    v_pk_mul_f16 v189, v189, v129 op_sel:[0,1] op_sel_hi:[1,1]
    v_mfma_f32_16x16x32_bf16 v[158:161], a[24:27], v[166:169], 0
    s_mov_b32 s24, s23
    v_pk_mul_f16 v234, v234, v129 op_sel:[0,0] op_sel_hi:[1,0]
    v_pk_mul_f16 v235, v235, v129 op_sel:[0,0] op_sel_hi:[1,0]
    v_mfma_f32_16x16x32_bf16 v[158:161], a[28:31], v[218:221], v[158:161]
    s_waitcnt lgkmcnt(5)
    v_pk_mul_f16 v236, v236, v129 op_sel:[0,0] op_sel_hi:[1,0]
    v_pk_mul_f16 v237, v237, v129 op_sel:[0,0] op_sel_hi:[1,0]
    v_mfma_f32_16x16x32_bf16 v[158:161], a[32:35], v[202:205], v[158:161]
    s_waitcnt lgkmcnt(3)
    v_pk_mul_f16 v186, v186, v129 op_sel:[0,0] op_sel_hi:[1,0]
    v_pk_mul_f16 v187, v187, v129 op_sel:[0,0] op_sel_hi:[1,0]
    v_mfma_f32_16x16x32_bf16 v[158:161], a[36:39], v[250:253], v[158:161]
    s_add_u32 s23, s23, s21
    v_max3_u32 v44, v44, v126, v127
    v_cvt_pk_f16_f32 v182, v182, v183
    v_mfma_f32_16x16x32_bf16 v[158:161], a[40:43], v[210:213], v[158:161]
    s_cmp_ge_u32 s19, 72
    v_pk_mul_f16 v127, v182, v182
    v_cvt_pk_f16_f32 v183, v184, v185
    v_mfma_f32_16x16x32_bf16 v[158:161], a[44:47], v[118:121], v[158:161]
    s_cselect_b32 s34, 72, 0
    v_pk_fma_f16 v127, v183, v183, v127
    v_cvt_pk_f16_f32 v184, v238, v239
    v_mfma_f32_16x16x32_bf16 v[178:181], a[48:51], v[166:169], 0
    s_cselect_b32 s35, s22, 0
    v_pk_fma_f16 v127, v184, v184, v127
    v_cvt_pk_f16_f32 v185, v240, v241
    v_mfma_f32_16x16x32_bf16 v[178:181], a[52:55], v[218:221], v[178:181]
    s_sub_u32 s19, s19, s34
    v_pk_fma_f16 v127, v185, v185, v127
    v_cvt_pk_f16_f32 v240, v134, v135
    v_mfma_f32_16x16x32_bf16 v[178:181], a[56:59], v[202:205], v[178:181]
    s_add_u32 s23, s23, s35
    v_pk_fma_f16 v127, v240, v240, v127
    v_cvt_pk_f16_f32 v241, v136, v137
    v_mfma_f32_16x16x32_bf16 v[178:181], a[60:63], v[250:253], v[178:181]
    s_waitcnt lgkmcnt(0)
    v_pk_fma_f16 v127, v241, v241, v127
    v_cvt_pk_f16_f32 v134, v222, v223
    v_mfma_f32_16x16x32_bf16 v[178:181], a[64:67], v[210:213], v[178:181]
    v_pk_mul_f16 v126, v134, v134
    v_cvt_pk_f16_f32 v135, v224, v225
    v_mfma_f32_16x16x32_bf16 v[178:181], a[68:71], v[118:121], v[178:181]
    v_pk_fma_f16 v126, v135, v135, v126
    v_cvt_pk_f16_f32 v136, v158, v159
    v_mfma_f32_16x16x32_bf16 v[222:225], v[166:169], a[144:147], 0
    v_pk_fma_f16 v126, v136, v136, v126
    v_cvt_pk_f16_f32 v137, v160, v161
    v_mfma_f32_16x16x32_bf16 v[222:225], v[218:221], a[148:151], v[222:225]
    v_pk_fma_f16 v126, v137, v137, v126
    v_mov_b32 v128, 0
    v_mfma_f32_16x16x32_bf16 v[222:225], v[202:205], a[152:155], v[222:225]
    ds_read_b128 v[158:161], v152 offset:0
    ds_read_b128 v[138:141], v152 offset:16
    v_mfma_f32_16x16x32_bf16 v[222:225], v[250:253], a[156:159], v[222:225]
    ds_read_b128 v[230:233], v152 offset:48
    ds_read_b32 v131, v6 offset:192
    v_mfma_f32_16x16x32_bf16 v[222:225], v[210:213], a[160:163], v[222:225]
    v_cvt_pk_f16_f32 v238, v178, v179
    v_pk_fma_f16 v126, v238, v238, v126
    v_mfma_f32_16x16x32_bf16 v[222:225], v[118:121], a[164:167], v[222:225]
    v_cvt_pk_f16_f32 v239, v180, v181
    v_pk_fma_f16 v126, v239, v239, v126
    v_mfma_f32_16x16x32_f16 v[150:153], v[194:197], v[142:145], v[46:49]
    v_mov_b32 v129, 0
    v_xor_b32 v0, 65536, v0
    v_mfma_f32_16x16x32_f16 v[178:181], v[154:157], v[142:145], v[50:53]
    v_xor_b32 v1, 65536, v1
    v_mfma_f32_16x16x32_f16 v[198:201], v[40:43], v[126:129], 0
    s_waitcnt lgkmcnt(3)
    v_cvt_pk_bf16_f32 v126, v222, v223
    v_cvt_pk_bf16_f32 v127, v224, v225
    v_mfma_f32_16x16x32_f16 v[222:225], v[158:161], v[142:145], v[22:25]
    s_waitcnt lgkmcnt(1)
    v_mfma_f32_16x16x32_f16 v[222:225], v[138:141], v[194:197], v[222:225]
    s_waitcnt lgkmcnt(0)
    v_mfma_f32_16x16x32_f16 v[222:225], v[230:233], v[146:149], v[222:225]
    v_rsq_f32 v198, v198
    v_mfma_f32_16x16x16_f16 v[150:153], v[148:149], v[146:147], v[150:153]
    v_rsq_f32 v199, v199
    v_mul_f32 v164, s31, v198
    v_mfma_f32_16x16x16_f16 v[178:181], v[188:189], v[146:147], v[178:181]
    v_cvt_pk_f16_f32 v165, v164, v199
    v_pk_mul_f16 v182, v182, v165 op_sel:[0,1] op_sel_hi:[1,1]
    v_pk_mul_f16 v183, v183, v165 op_sel:[0,1] op_sel_hi:[1,1]
    v_pk_mul_f16 v184, v184, v165 op_sel:[0,1] op_sel_hi:[1,1]
    v_mfma_f32_16x16x32_bf16 v[170:173], v[166:169], a[168:171], 0
    v_pk_mul_f16 v185, v185, v165 op_sel:[0,1] op_sel_hi:[1,1]
    v_pk_mul_f16 v240, v240, v165 op_sel:[0,1] op_sel_hi:[1,1]
    v_mfma_f32_16x16x32_bf16 v[170:173], v[218:221], a[172:175], v[170:173]
    v_pk_mul_f16 v241, v241, v165 op_sel:[0,1] op_sel_hi:[1,1]
    v_pk_mul_f16 v134, v134, v165 op_sel:[0,0] op_sel_hi:[1,0]
    v_mfma_f32_16x16x32_f16 v[214:217], v[182:185], v[142:145], v[54:57]
    v_pk_mul_f16 v135, v135, v165 op_sel:[0,0] op_sel_hi:[1,0]
    v_pk_mul_f16 v136, v136, v165 op_sel:[0,0] op_sel_hi:[1,0]
    v_mfma_f32_16x16x32_bf16 v[170:173], v[202:205], a[176:179], v[170:173]
    v_pk_mul_f16 v137, v137, v165 op_sel:[0,0] op_sel_hi:[1,0]
    v_pk_mul_f16 v238, v238, v165 op_sel:[0,0] op_sel_hi:[1,0]
    v_mfma_f32_16x16x32_bf16 v[170:173], v[250:253], a[180:183], v[170:173]
    ds_read2_b32 v[128:129], v6 offset0:0 offset1:0
    ds_read2_b32 v[144:145], v6 offset0:16 offset1:16
    v_pk_mul_f16 v239, v239, v165 op_sel:[0,0] op_sel_hi:[1,0]
    v_mfma_f32_16x16x16_f16 v[214:217], v[240:241], v[146:147], v[214:217]
    v_max3_u32 v44, v44, v198, v199
    v_mov_b32_dpp v131, v223 quad_perm:[0,1,2,3] row_mask:0x1 bank_mask:0xf
    v_exp_f32 v150, v150
    v_mfma_f32_16x16x32_bf16 v[170:173], v[210:213], a[184:187], v[170:173]
    ds_read2_b32 v[200:201], v6 offset0:32 offset1:32
    v_add_u32 v6, 272, v6
    v_mfma_f32_16x16x32_bf16 v[170:173], v[118:121], a[188:191], v[170:173]
    v_exp_f32 v151, v151
    v_mfma_f32_16x16x32_bf16 v[190:193], v[166:169], a[192:195], 0
    v_exp_f32 v152, v152
    v_mfma_f32_16x16x32_bf16 v[190:193], v[218:221], a[196:199], v[190:193]
    v_exp_f32 v153, v153
    v_mfma_f32_16x16x32_f16 v[166:169], v[158:161], v[134:137], v[26:29]
    s_waitcnt lgkmcnt(1)
    v_cvt_pk_bf16_f32 v150, v150, v151
    v_cvt_pk_bf16_f32 v142, v170, v171
    v_mfma_f32_16x16x32_f16 v[166:169], v[138:141], v[182:185], v[166:169]
    v_cvt_pk_bf16_f32 v143, v172, v173
    v_cvt_pk_bf16_f32 v151, v152, v153
    v_mfma_f32_16x16x32_f16 v[166:169], v[230:233], v[238:241], v[166:169]
    s_waitcnt lgkmcnt(0)
    v_exp_f32 v178, v178
    v_mfma_f32_16x16x32_bf16 v[190:193], v[202:205], a[200:203], v[190:193]
    v_exp_f32 v179, v179
    v_mfma_f32_16x16x32_bf16 v[190:193], v[250:253], a[204:207], v[190:193]
    v_exp_f32 v180, v180
    v_mfma_f32_16x16x32_bf16 v[190:193], v[210:213], a[208:211], v[190:193]
    v_exp_f32 v181, v181
    v_mfma_f32_16x16x32_bf16 v[190:193], v[118:121], a[212:215], v[190:193]
    v_cvt_pk_bf16_f32 v152, v178, v179
    v_cvt_pk_bf16_f32 v153, v180, v181
    v_mfma_f32_16x16x32_f16 v[118:121], v[158:161], v[234:237], v[24:27]
    v_exp_f32 v214, v214
    v_mfma_f32_16x16x32_f16 v[118:121], v[138:141], v[154:157], v[118:121]
    v_exp_f32 v215, v215
    v_mfma_f32_16x16x32_f16 v[118:121], v[230:233], v[186:189], v[118:121]
    v_exp_f32 v216, v216
    v_mfma_f32_16x16x32_bf16 v[158:161], v[206:209], a[216:219], 0
    v_cvt_pk_bf16_f32 v198, v190, v191
    v_cvt_pk_bf16_f32 v199, v192, v193
    v_mfma_f32_16x16x32_bf16 v[158:161], v[206:209], a[240:243], v[158:161]
    v_exp_f32 v217, v217
    v_mfma_f32_16x16x32_f16 v[178:181], v[194:197], v[234:237], v[58:61]
    v_cvt_pk_bf16_f32 v36, v214, v215
    v_mov_b32_dpp v131, v119 quad_perm:[0,1,2,3] row_mask:0x2 bank_mask:0xf
    v_mfma_f32_16x16x32_f16 v[138:141], v[154:157], v[234:237], v[62:65]
    v_mov_b32_dpp v131, v167 quad_perm:[0,1,2,3] row_mask:0x4 bank_mask:0xf
    v_cvt_pk_bf16_f32 v37, v216, v217
    v_mfma_f32_16x16x32_f16 v[230:233], v[182:185], v[234:237], v[66:69]
    v_exp_f32 v222, v222
    v_mfma_f32_16x16x16_f16 v[178:181], v[148:149], v[186:187], v[178:181]
    v_cvt_pk_bf16_f32 v39, v222, 0
    v_exp_f32 v166, v166
    v_mfma_f32_16x16x16_f16 v[138:141], v[188:189], v[186:187], v[138:141]
    v_exp_f32 v131, v131
    v_exp_f32 v118, v118
    v_mfma_f32_16x16x32_bf16 v[234:237], v[28:31], v[36:39], 0
    v_cvt_pk_bf16_f32 v131, v131, v131
    v_mfma_f32_16x16x32_bf16 v[234:237], v[28:31], v[150:153], v[234:237]
    ds_write_b16 v8, v131
    v_mfma_f32_16x16x32_bf16 v[222:225], v[126:129], v[36:39], 0
    v_exp_f32 v178, v178
    v_mfma_f32_16x16x32_f16 v[218:221], v[194:197], v[134:137], v[70:73]
    v_exp_f32 v179, v179
    v_mfma_f32_16x16x32_bf16 v[222:225], v[114:117], v[150:153], v[222:225]
    v_exp_f32 v180, v180
    v_mfma_f32_16x16x32_bf16 v[194:197], v[142:145], v[36:39], 0
    v_rcp_f32 v234, v234
    v_mfma_f32_16x16x32_bf16 v[194:197], v[226:229], v[150:153], v[194:197]
    v_cvt_pk_bf16_f32 v146, v178, v179
    v_exp_f32 v181, v181
    v_mfma_f32_16x16x16_f16 v[218:221], v[148:149], v[238:239], v[218:221]
    v_cvt_pk_bf16_f32 v147, v180, v181
    v_mul_f32 v222, v234, v222
    v_mul_f32 v223, v234, v223
    v_cvt_pk_bf16_f32 v222, v222, v223
    v_mfma_f32_16x16x32_bf16 v[178:181], v[198:201], v[36:39], 0
    v_mul_f32 v224, v234, v224
    v_mul_f32 v225, v234, v225
    v_mfma_f32_16x16x32_bf16 v[178:181], v[242:245], v[150:153], v[178:181]
    v_cvt_pk_bf16_f32 v223, v224, v225
    v_mul_f32 v194, v234, v194
    v_mul_f32 v195, v234, v195
    v_mfma_f32_16x16x16_f16 v[230:233], v[240:241], v[186:187], v[230:233]
    v_cvt_pk_bf16_f32 v224, v194, v195
    v_mul_f32 v196, v234, v196
    v_mul_f32 v197, v234, v197
    v_cvt_pk_bf16_f32 v225, v196, v197
    v_mfma_f32_16x16x32_bf16 v[158:161], v[206:209], v[90:93], v[158:161]
    v_mul_f32 v178, v234, v178
    v_mul_f32 v179, v234, v179
    v_mfma_f32_16x16x32_bf16 v[194:197], v[206:209], a[220:223], 0
    v_cvt_pk_bf16_f32 v164, v178, v179
    v_mul_f32 v180, v234, v180
    v_mfma_f32_16x16x32_bf16 v[194:197], v[206:209], a[244:247], v[194:197]
    v_mul_f32 v181, v234, v181
    v_cvt_pk_bf16_f32 v165, v180, v181
    v_mfma_f32_16x16x32_bf16 v[194:197], v[206:209], v[94:97], v[194:197]
    v_mov_b32 v131, v158
    v_mov_b32_dpp v131, v159 quad_perm:[0,1,2,3] row_mask:0x2 bank_mask:0xf
    v_mfma_f32_16x16x32_bf16 v[158:161], v[206:209], a[232:235], 0
    v_exp_f32 v218, v218
    v_mfma_f32_16x16x32_bf16 v[158:161], v[206:209], v[82:85], v[158:161]
    v_exp_f32 v219, v219
    v_mfma_f32_16x16x32_bf16 v[158:161], v[206:209], v[106:109], v[158:161]
    ds_read_b128 v[234:237], v9
    ds_read_b128 v[150:153], v9 offset:64
    v_mfma_f32_16x16x32_bf16 v[178:181], v[206:209], a[224:227], 0
    v_mov_b32 v148, v195
    v_cvt_pk_bf16_f32 v218, v218, v219
    v_mfma_f32_16x16x32_bf16 v[178:181], v[206:209], a[248:251], v[178:181]
    v_exp_f32 v220, v220
    v_mfma_f32_16x16x32_bf16 v[178:181], v[206:209], v[98:101], v[178:181]
    v_mov_b32_dpp v131, v158 quad_perm:[0,1,2,3] row_mask:0x4 bank_mask:0xf
    v_mov_b32_dpp v131, v194 quad_perm:[0,1,2,3] row_mask:0x8 bank_mask:0xf
    v_mfma_f32_16x16x32_bf16 v[194:197], v[206:209], a[228:231], 0
    ds_write_b32 v122, v131 offset:18432
    v_mfma_f32_16x16x32_bf16 v[194:197], v[206:209], a[252:255], v[194:197]
    v_mov_b32_dpp v148, v159 quad_perm:[0,1,2,3] row_mask:0x2 bank_mask:0xf
    v_cvt_pk_bf16_f32 v39, v118, 0
    v_mfma_f32_16x16x32_bf16 v[194:197], v[206:209], v[102:105], v[194:197]
    s_waitcnt lgkmcnt(2)
    v_exp_f32 v221, v221
    v_mfma_f32_16x16x32_bf16 v[118:121], v[234:237], v[28:31], 0
    s_waitcnt lgkmcnt(1)
    v_mov_b32_dpp v148, v178 quad_perm:[0,1,2,3] row_mask:0x4 bank_mask:0xf
    v_mov_b32_dpp v148, v179 quad_perm:[0,1,2,3] row_mask:0x8 bank_mask:0xf
    v_mfma_f32_16x16x32_bf16 v[118:121], v[150:153], v[28:31], v[118:121]
    ds_write_b32 v122, v148 offset:19456
    v_mfma_f32_16x16x32_bf16 v[178:181], v[234:237], v[114:117], 0
    v_exp_f32 v138, v138
    v_mfma_f32_16x16x32_bf16 v[178:181], v[150:153], v[126:129], v[178:181]
    v_exp_f32 v139, v139
    v_mfma_f32_16x16x32_bf16 v[158:161], v[234:237], v[226:229], 0
    v_cvt_pk_bf16_f32 v219, v220, v221
    v_cvt_pk_bf16_f32 v148, v138, v139
    v_mfma_f32_16x16x32_bf16 v[158:161], v[150:153], v[142:145], v[158:161]
    v_rcp_f32 v118, v118
    v_mfma_f32_16x16x32_bf16 v[202:205], v[234:237], v[242:245], 0
    v_exp_f32 v140, v140
    v_mfma_f32_16x16x32_bf16 v[202:205], v[150:153], v[198:201], v[202:205]
    v_exp_f32 v141, v141
    v_mfma_f32_16x16x32_f16 v[234:237], v[154:157], v[134:137], v[74:77]
    v_mul_f32 v178, v178, v118
    v_cvt_pk_bf16_f32 v149, v140, v141
    v_mfma_f32_16x16x32_bf16 v[154:157], v[206:209], a[236:239], 0
    v_exp_f32 v230, v230
    v_mfma_f32_16x16x32_f16 v[150:153], v[182:185], v[134:137], v[78:81]
    v_exp_f32 v231, v231
    v_mul_f32_dpp v178, v158, v118 quad_perm:[0,1,2,3] row_mask:0x2 bank_mask:0xf
    v_mfma_f32_16x16x16_f16 v[234:237], v[188:189], v[238:239], v[234:237]
    v_mul_f32_dpp v178, v202, v118 quad_perm:[0,1,2,3] row_mask:0x4 bank_mask:0xf
    v_cvt_pk_bf16_f32 v178, v178, v178
    v_exp_f32 v232, v232
    v_mfma_f32_16x16x16_f16 v[150:153], v[240:241], v[238:239], v[150:153]
    v_cvt_pk_bf16_f32 v36, v230, v231
    v_exp_f32 v233, v233
    v_mfma_f32_16x16x32_bf16 v[154:157], v[206:209], v[86:89], v[154:157]
    v_cvt_pk_bf16_f32 v37, v232, v233
    v_mfma_f32_16x16x32_bf16 v[154:157], v[206:209], v[110:113], v[154:157]
    v_exp_f32 v234, v234
    v_mfma_f32_16x16x32_bf16 v[134:137], v[28:31], v[36:39], 0
    v_exp_f32 v235, v235
    v_mfma_f32_16x16x32_bf16 v[134:137], v[28:31], v[146:149], v[134:137]
    v_exp_f32 v236, v236
    v_mfma_f32_16x16x32_bf16 v[238:241], v[126:129], v[36:39], 0
    v_exp_f32 v237, v237
    v_mfma_f32_16x16x32_bf16 v[238:241], v[114:117], v[146:149], v[238:241]
    v_mov_b32 v131, v154
    v_mov_b32_dpp v131, v194 quad_perm:[0,1,2,3] row_mask:0x2 bank_mask:0xf
    v_mfma_f32_16x16x32_bf16 v[138:141], v[142:145], v[36:39], 0
    v_mov_b32_dpp v131, v195 quad_perm:[0,1,2,3] row_mask:0x4 bank_mask:0xf
    v_mov_b32_dpp v131, v155 quad_perm:[0,1,2,3] row_mask:0x8 bank_mask:0xf
    v_mfma_f32_16x16x32_bf16 v[138:141], v[226:229], v[146:149], v[138:141]
    ds_write_b32 v122, v131 offset:63552
    v_mfma_f32_16x16x32_bf16 v[194:197], v[198:201], v[36:39], 0
    v_cvt_pk_bf16_f32 v220, v234, v235
    v_cvt_pk_bf16_f32 v221, v236, v237
    v_mfma_f32_16x16x32_bf16 v[194:197], v[242:245], v[146:149], v[194:197]
    v_exp_f32 v150, v150
    v_exp_f32 v151, v151
    v_exp_f32 v152, v152
    v_cvt_pk_bf16_f32 v36, v150, v151
    v_exp_f32 v153, v153
    v_cvt_pk_bf16_f32 v39, v166, 0
    v_cvt_pk_bf16_f32 v37, v152, v153
    v_rcp_f32 v134, v134
    s_nop 0
    v_mfma_f32_16x16x32_bf16 v[154:157], v[28:31], v[36:39], 0
    s_waitcnt lgkmcnt(0)
    v_mul_f32 v238, v134, v238
    v_mul_f32 v239, v134, v239
    v_mfma_f32_16x16x32_bf16 v[154:157], v[28:31], v[218:221], v[154:157]
    s_barrier
    s_waitcnt vmcnt(0)
    ds_read_b128 v[146:149], v130 offset:18432
    v_mfma_f32_16x16x32_bf16 v[150:153], v[126:129], v[36:39], 0
    s_barrier
    ds_read_b128 v[186:189], v0 offset:20480
    ds_read_b128 v[118:121], v1 offset:20480
    v_mfma_f32_16x16x32_bf16 v[150:153], v[114:117], v[218:221], v[150:153]
    ds_read_b128 v[234:237], v0 offset:20608
    buffer_load_dwordx4 v10, s[8:11], 0 offen nt lds
    v_mfma_f32_16x16x32_bf16 v[114:117], v[142:145], v[36:39], 0
    s_add_u32 m0, s28, 4096
    ds_read_b128 v[158:161], v1 offset:20608
    v_cvt_pk_bf16_f32 v230, v238, v239
    v_mfma_f32_16x16x32_bf16 v[114:117], v[226:229], v[218:221], v[114:117]
    ds_read_b128 v[182:185], v0 offset:20736
    v_mul_f32 v240, v134, v240
    v_mfma_f32_16x16x32_bf16 v[122:125], v[198:201], v[36:39], 0
    ds_read_b128 v[206:209], v1 offset:20736
    v_mul_f32 v241, v134, v241
    v_mfma_f32_16x16x32_bf16 v[122:125], v[242:245], v[218:221], v[122:125]
    ds_read_b128 v[142:145], v130 offset:19456
    s_waitcnt lgkmcnt(7)
    ds_read_b128 v[126:129], v130 offset:63552
    s_waitcnt lgkmcnt(7)
    v_mfma_f32_16x16x32_bf16 v[226:229], a[72:75], v[186:189], 0
    s_waitcnt lgkmcnt(6)
    buffer_load_dwordx4 v11, s[8:11], 0 offen nt lds
    v_add_f32 v146, v146, v147
    v_mfma_f32_16x16x32_bf16 v[226:229], a[76:79], v[118:121], v[226:229]
    s_waitcnt lgkmcnt(5)
    ds_write_b128 v3, v[222:225] offset:0
    v_mfma_f32_16x16x32_bf16 v[226:229], a[80:83], v[234:237], v[226:229]
    s_waitcnt lgkmcnt(4)
    v_add_f32 v148, v148, v149
    v_add_f32 v146, v146, v148
    v_mfma_f32_16x16x32_bf16 v[226:229], a[84:87], v[158:161], v[226:229]
    s_add_u32 m0, s28, 8192
    v_mul_f32 v146, 0xbbaaaaab, v146
    v_cvt_pk_bf16_f32 v231, v240, v241
    v_mfma_f32_16x16x32_bf16 v[226:229], a[88:91], v[182:185], v[226:229]
    s_waitcnt lgkmcnt(2)
    ds_write_b32 v132, v146 offset:0
    v_mfma_f32_16x16x32_bf16 v[226:229], a[92:95], v[206:209], v[226:229]
    s_waitcnt lgkmcnt(2)
    buffer_load_dwordx4 v12, s[8:11], 0 offen nt lds
    v_add_f32 v142, v142, v143
    v_mfma_f32_16x16x32_bf16 v[238:241], a[96:99], v[186:189], 0
    s_add_u32 m0, s28, 12288
    ds_read_b128 v[146:149], v133 offset:0
    ds_read_b128 v[222:225], v133 offset:64
    v_mfma_f32_16x16x32_bf16 v[238:241], a[100:103], v[118:121], v[238:241]
    s_xor_b32 s28, s28, 65536
    ds_read_b128 v[198:201], v133 offset:128
    v_add_f32 v144, v144, v145
    v_mfma_f32_16x16x32_bf16 v[238:241], a[104:107], v[234:237], v[238:241]
    ds_write_b64 v4, v[164:165] offset:4096
    v_mfma_f32_16x16x32_bf16 v[238:241], a[108:111], v[158:161], v[238:241]
    v_add_f32 v142, v142, v144
    v_mul_f32 v142, 0xbbaaaaab, v142
    v_mfma_f32_16x16x32_bf16 v[238:241], a[112:115], v[182:185], v[238:241]
    buffer_load_dwordx4 v13, s[8:11], 0 offen nt lds
    v_add_f32 v126, v126, v127
    v_mfma_f32_16x16x32_bf16 v[238:241], a[116:119], v[206:209], v[238:241]
    s_mov_b32 m0, s29
    ds_write_b32 v132, v142 offset:256
    v_mfma_f32_16x16x32_bf16 v[242:245], a[120:123], v[186:189], 0
    s_waitcnt lgkmcnt(3)
    v_add_f32 v128, v128, v129
    v_add_f32 v126, v126, v128
    v_mul_f32 v126, 0xbbaaaaab, v126
    v_mfma_f32_16x16x16_bf16 v[142:145], a[216:217], v[162:163], v[146:149]
    v_rcp_f32 v154, v154
    v_mul_f32 v138, v134, v138
    v_mfma_f32_16x16x16_bf16 v[218:221], a[240:241], v[162:163], v[146:149]
    v_mul_f32 v150, v154, v150
    v_mul_f32 v151, v154, v151
    v_cvt_pk_bf16_f32 v150, v150, v151
    v_mfma_f32_16x16x16_bf16 v[166:169], v[90:91], v[162:163], v[146:149]
    v_mul_f32 v152, v154, v152
    v_cvt_pk_bf16_f32 v142, v142, v143
    v_accvgpr_write_b32 a216, v142
    v_mfma_f32_16x16x16_bf16 v[202:205], a[218:219], v[162:163], v[222:225]
    v_cvt_pk_bf16_f32 v144, v144, v145
    v_accvgpr_write_b32 a217, v144
    v_cvt_pk_bf16_f32 v218, v218, v219
    v_mfma_f32_16x16x16_bf16 v[142:145], a[242:243], v[162:163], v[222:225]
    v_accvgpr_write_b32 a240, v218
    v_cvt_pk_bf16_f32 v220, v220, v221
    v_accvgpr_write_b32 a241, v220
    v_mfma_f32_16x16x16_bf16 v[146:149], v[92:93], v[162:163], v[222:225]
    v_cvt_pk_bf16_f32 v90, v166, v167
    v_cvt_pk_bf16_f32 v91, v168, v169
    v_cvt_pk_bf16_f32 v202, v202, v203
    v_accvgpr_write_b32 a218, v202
    v_mfma_f32_16x16x32_bf16 v[242:245], a[124:127], v[118:121], v[242:245]
    s_waitcnt lgkmcnt(0)
    buffer_load_dwordx4 v14, s[8:11], 0 offen nt lds
    ds_write_b32 v132, v126 offset:512
    v_mfma_f32_16x16x16_bf16 v[126:129], a[232:233], v[162:163], v[198:201]
    v_cvt_pk_bf16_f32 v204, v204, v205
    v_accvgpr_write_b32 a219, v204
    v_cvt_pk_bf16_f32 v142, v142, v143
    v_mfma_f32_16x16x16_bf16 v[222:225], v[82:83], v[162:163], v[198:201]
    v_accvgpr_write_b32 a242, v142
    v_cvt_pk_bf16_f32 v144, v144, v145
    v_accvgpr_write_b32 a243, v144
    v_mfma_f32_16x16x16_bf16 v[218:221], v[106:107], v[162:163], v[198:201]
    v_cvt_pk_bf16_f32 v92, v146, v147
    v_cvt_pk_bf16_f32 v93, v148, v149
    v_cvt_pk_bf16_f32 v126, v126, v127
    v_accvgpr_write_b32 a232, v126
    v_mfma_f32_16x16x32_bf16 v[242:245], a[128:131], v[234:237], v[242:245]
    s_xor_b32 s29, s29, s30
    ds_read_b128 v[146:149], v133 offset:192
    ds_read_b128 v[198:201], v133 offset:256
    v_mfma_f32_16x16x32_bf16 v[242:245], a[132:135], v[158:161], v[242:245]
    ds_write_b16 v7, v178
    v_mfma_f32_16x16x32_bf16 v[242:245], a[136:139], v[182:185], v[242:245]
    v_cvt_pk_bf16_f32 v128, v128, v129
    v_accvgpr_write_b32 a233, v128
    v_mfma_f32_16x16x32_bf16 v[242:245], a[140:143], v[206:209], v[242:245]
    v_cvt_pk_bf16_f32 v82, v222, v223
    v_cvt_pk_bf16_f32 v83, v224, v225
    v_mfma_f32_16x16x32_bf16 v[142:145], a[0:3], v[186:189], 0
    v_cvt_pk_bf16_f32 v106, v218, v219
    v_cvt_pk_bf16_f32 v107, v220, v221
    v_mfma_f32_16x16x32_bf16 v[142:145], a[4:7], v[118:121], v[142:145]
    ds_read_b128 v[126:129], v133 offset:320
    v_mul_f32 v153, v154, v153
    v_mfma_f32_16x16x32_bf16 v[142:145], a[8:11], v[234:237], v[142:145]
    s_waitcnt lgkmcnt(3)
    v_cvt_pk_bf16_f32 v151, v152, v153
    v_mul_f32 v114, v154, v114
    v_mul_f32 v115, v154, v115
    v_mfma_f32_16x16x16_bf16 v[222:225], a[220:221], v[162:163], v[146:149]
    v_cvt_pk_bf16_f32 v152, v114, v115
    v_mul_f32 v116, v154, v116
    v_mul_f32 v117, v154, v117
    v_mfma_f32_16x16x16_bf16 v[178:181], a[244:245], v[162:163], v[146:149]
    v_cvt_pk_bf16_f32 v153, v116, v117
    v_mul_f32 v122, v154, v122
    v_mul_f32 v123, v154, v123
    v_mfma_f32_16x16x16_bf16 v[114:117], v[94:95], v[162:163], v[146:149]
    v_cvt_pk_bf16_f32 v222, v222, v223
    v_accvgpr_write_b32 a220, v222
    v_cvt_pk_bf16_f32 v224, v224, v225
    v_accvgpr_write_b32 a221, v224
    v_mfma_f32_16x16x32_bf16 v[142:145], a[12:15], v[158:161], v[142:145]
    s_waitcnt lgkmcnt(1)
    ds_write_b128 v3, v[150:153] offset:12288
    v_mfma_f32_16x16x16_bf16 v[146:149], a[222:223], v[162:163], v[198:201]
    v_cvt_pk_bf16_f32 v178, v178, v179
    v_accvgpr_write_b32 a244, v178
    v_cvt_pk_bf16_f32 v180, v180, v181
    v_mfma_f32_16x16x16_bf16 v[150:153], a[246:247], v[162:163], v[198:201]
    v_accvgpr_write_b32 a245, v180
    v_cvt_pk_bf16_f32 v94, v114, v115
    v_cvt_pk_bf16_f32 v95, v116, v117
    v_mfma_f32_16x16x16_bf16 v[114:117], v[96:97], v[162:163], v[198:201]
    v_cvt_pk_bf16_f32 v146, v146, v147
    v_accvgpr_write_b32 a222, v146
    v_cvt_pk_bf16_f32 v148, v148, v149
    v_accvgpr_write_b32 a223, v148
    v_mfma_f32_16x16x32_bf16 v[142:145], a[16:19], v[182:185], v[142:145]
    s_waitcnt lgkmcnt(1)
    ds_read_b128 v[146:149], v133 offset:384
    v_cvt_pk_bf16_f32 v150, v150, v151
    v_accvgpr_write_b32 a246, v150
    v_mfma_f32_16x16x16_bf16 v[222:225], a[234:235], v[162:163], v[126:129]
    v_cvt_pk_bf16_f32 v152, v152, v153
    v_accvgpr_write_b32 a247, v152
    v_cvt_pk_bf16_f32 v96, v114, v115
    v_mfma_f32_16x16x16_bf16 v[150:153], v[84:85], v[162:163], v[126:129]
    v_cvt_pk_bf16_f32 v97, v116, v117
    v_cvt_pk_bf16_f32 v164, v122, v123
    v_mul_f32 v124, v154, v124
    v_mfma_f32_16x16x16_bf16 v[114:117], v[108:109], v[162:163], v[126:129]
    v_cvt_pk_bf16_f32 v222, v222, v223
    v_accvgpr_write_b32 a234, v222
    v_cvt_pk_bf16_f32 v224, v224, v225
    v_accvgpr_write_b32 a235, v224
    v_mfma_f32_16x16x32_bf16 v[142:145], a[20:23], v[206:209], v[142:145]
    ds_read_b128 v[222:225], v133 offset:448
    v_cvt_pk_bf16_f32 v84, v150, v151
    v_mfma_f32_16x16x32_bf16 v[126:129], a[24:27], v[186:189], 0
    v_cvt_pk_bf16_f32 v85, v152, v153
    v_cvt_pk_bf16_f32 v108, v114, v115
    v_mfma_f32_16x16x32_bf16 v[126:129], a[28:31], v[118:121], v[126:129]
    s_waitcnt lgkmcnt(1)
    v_cvt_pk_bf16_f32 v109, v116, v117
    v_mul_f32 v125, v154, v125
    v_cvt_pk_bf16_f32 v165, v124, v125
    v_mfma_f32_16x16x16_bf16 v[114:117], a[224:225], v[162:163], v[146:149]
    v_mul_f32 v139, v134, v139
    v_cvt_pk_bf16_f32 v232, v138, v139
    v_mul_f32 v140, v134, v140
    v_mfma_f32_16x16x16_bf16 v[150:153], a[248:249], v[162:163], v[146:149]
    v_mul_f32 v141, v134, v141
    v_cvt_pk_bf16_f32 v233, v140, v141
    v_mul_f32 v194, v134, v194
    v_mfma_f32_16x16x16_bf16 v[154:157], v[98:99], v[162:163], v[146:149]
    v_cvt_pk_bf16_f32 v114, v114, v115
    v_accvgpr_write_b32 a224, v114
    v_cvt_pk_bf16_f32 v116, v116, v117
    v_accvgpr_write_b32 a225, v116
    v_mfma_f32_16x16x32_bf16 v[126:129], a[32:35], v[234:237], v[126:129]
    s_waitcnt lgkmcnt(0)
    ds_read_b128 v[114:117], v133 offset:512
    ds_write_b128 v3, v[230:233] offset:6144
    v_mfma_f32_16x16x16_bf16 v[146:149], a[226:227], v[162:163], v[222:225]
    v_cvt_pk_bf16_f32 v150, v150, v151
    v_accvgpr_write_b32 a248, v150
    v_cvt_pk_bf16_f32 v152, v152, v153
    v_mfma_f32_16x16x16_bf16 v[138:141], a[250:251], v[162:163], v[222:225]
    v_accvgpr_write_b32 a249, v152
    v_cvt_pk_bf16_f32 v98, v154, v155
    v_cvt_pk_bf16_f32 v99, v156, v157
    v_mfma_f32_16x16x16_bf16 v[150:153], v[100:101], v[162:163], v[222:225]
    v_cvt_pk_bf16_f32 v146, v146, v147
    v_accvgpr_write_b32 a226, v146
    v_cvt_pk_bf16_f32 v148, v148, v149
    v_accvgpr_write_b32 a227, v148
    v_mfma_f32_16x16x32_bf16 v[126:129], a[36:39], v[158:161], v[126:129]
    ds_read_b128 v[146:149], v133 offset:576
    v_cvt_pk_bf16_f32 v138, v138, v139
    v_mfma_f32_16x16x32_bf16 v[126:129], a[40:43], v[182:185], v[126:129]
    s_waitcnt lgkmcnt(1)
    ds_write_b64 v4, v[164:165] offset:16384
    v_mfma_f32_16x16x16_bf16 v[154:157], a[236:237], v[162:163], v[114:117]
    v_accvgpr_write_b32 a250, v138
    v_cvt_pk_bf16_f32 v140, v140, v141
    v_accvgpr_write_b32 a251, v140
    v_mfma_f32_16x16x16_bf16 v[222:225], v[86:87], v[162:163], v[114:117]
    v_cvt_pk_bf16_f32 v100, v150, v151
    v_cvt_pk_bf16_f32 v101, v152, v153
    v_mul_f32 v195, v134, v195
    v_mfma_f32_16x16x16_bf16 v[150:153], v[110:111], v[162:163], v[114:117]
    v_cvt_pk_bf16_f32 v154, v154, v155
    v_accvgpr_write_b32 a236, v154
    v_cvt_pk_bf16_f32 v156, v156, v157
    v_accvgpr_write_b32 a237, v156
    v_mfma_f32_16x16x32_bf16 v[126:129], a[44:47], v[206:209], v[126:129]
    ds_read_b128 v[114:117], v133 offset:640
    s_waitcnt lgkmcnt(2)
    v_cvt_pk_bf16_f32 v86, v222, v223
    v_mfma_f32_16x16x16_bf16 v[154:157], a[228:229], v[162:163], v[146:149]
    v_cvt_pk_bf16_f32 v87, v224, v225
    v_cvt_pk_bf16_f32 v110, v150, v151
    v_cvt_pk_bf16_f32 v111, v152, v153
    v_mfma_f32_16x16x16_bf16 v[150:153], a[252:253], v[162:163], v[146:149]
    v_cvt_pk_bf16_f32 v164, v194, v195
    v_mul_f32 v196, v134, v196
    v_mul_f32 v197, v134, v197
    v_mfma_f32_16x16x16_bf16 v[134:137], v[102:103], v[162:163], v[146:149]
    ds_read_b128 v[222:225], v133 offset:704
    v_cvt_pk_bf16_f32 v154, v154, v155
    v_accvgpr_write_b32 a228, v154
    v_cvt_pk_bf16_f32 v156, v156, v157
    v_accvgpr_write_b32 a229, v156
    v_cvt_pk_bf16_f32 v150, v150, v151
    v_accvgpr_write_b32 a252, v150
    v_cvt_pk_bf16_f32 v152, v152, v153
    v_accvgpr_write_b32 a253, v152
    v_cvt_pk_bf16_f32 v102, v134, v135
    s_waitcnt lgkmcnt(1)
    v_mfma_f32_16x16x16_bf16 v[130:133], a[230:231], v[162:163], v[114:117]
    v_cvt_pk_bf16_f32 v103, v136, v137
    v_cvt_pk_bf16_f32 v165, v196, v197
    v_cvt_pk_f16_f32 v194, v226, v227
    v_mfma_f32_16x16x16_bf16 v[146:149], a[254:255], v[162:163], v[114:117]
    v_pk_mul_f16 v191, v194, v194
    v_cvt_pk_f16_f32 v195, v228, v229
    v_pk_fma_f16 v191, v195, v195, v191
    v_mfma_f32_16x16x16_bf16 v[150:153], v[104:105], v[162:163], v[114:117]
    ds_write_b64 v4, v[164:165] offset:10240
    s_waitcnt lgkmcnt(1)
    v_mfma_f32_16x16x16_bf16 v[226:229], a[238:239], v[162:163], v[222:225]
    v_cvt_pk_bf16_f32 v130, v130, v131
    v_accvgpr_write_b32 a230, v130
    v_cvt_pk_bf16_f32 v132, v132, v133
    v_mfma_f32_16x16x16_bf16 v[114:117], v[88:89], v[162:163], v[222:225]
    v_accvgpr_write_b32 a231, v132
    v_cvt_pk_bf16_f32 v146, v146, v147
    v_accvgpr_write_b32 a254, v146
    v_mfma_f32_16x16x16_bf16 v[130:133], v[112:113], v[162:163], v[222:225]
    v_cvt_pk_bf16_f32 v148, v148, v149
    v_accvgpr_write_b32 a255, v148
    v_cvt_pk_bf16_f32 v104, v150, v151
    v_cvt_pk_bf16_f32 v105, v152, v153
    v_cvt_pk_bf16_f32 v226, v226, v227
    v_accvgpr_write_b32 a238, v226
    v_cvt_pk_bf16_f32 v228, v228, v229
    v_accvgpr_write_b32 a239, v228
    v_cvt_pk_bf16_f32 v88, v114, v115
    v_cvt_pk_bf16_f32 v89, v116, v117
    s_waitcnt lgkmcnt(0)
    s_barrier
    v_cvt_pk_bf16_f32 v112, v130, v131
    v_cvt_pk_bf16_f32 v113, v132, v133
    v_cvt_pk_f16_f32 v196, v238, v239
    v_pk_fma_f16 v191, v196, v196, v191
    v_cvt_pk_f16_f32 v197, v240, v241
    v_pk_fma_f16 v191, v197, v197, v191
    v_cvt_pk_f16_f32 v148, v242, v243
    v_pk_fma_f16 v191, v148, v148, v191
    v_cvt_pk_f16_f32 v149, v244, v245
    v_pk_fma_f16 v191, v149, v149, v191
    v_add_u32 v7, 16, v7
    v_xor_b32 v3, 65536, v3
    v_xor_b32 v4, 65536, v4
L_go:
    s_waitcnt lgkmcnt(0)
    s_and_b32 s3, s2, 0xf8
    s_add_u32 s64, s42, s3
    s_addc_u32 s65, s43, 0
    s_mov_b32 s67, 0x00020000
    s_cmp_eq_u32 s16, 1
    s_cbranch_scc1 L_loop_fast1
    s_cmp_eq_u32 s16, 2
    s_cbranch_scc1 L_loop_fast2
    s_cmp_eq_u32 s16, 3
    s_cbranch_scc1 L_loop_fast3
    s_branch L_loop_fast0
.p2align 6
L_loop_fast0:
    v_mfma_f32_16x16x32_bf16 v[130:133], a[48:51], v[186:189], 0
    s_add_u32 s12, s40, s27
    ds_read_b128 v[246:249], v2 offset:18432
    v_cvt_pk_f16_f32 v222, v142, v143
    v_mfma_f32_16x16x32_bf16 v[130:133], a[52:55], v[118:121], v[130:133]
    s_addc_u32 s13, s41, 0
    ds_read_b128 v[210:213], v2 offset:19456
    v_pk_mul_f16 v190, v222, v222
    v_mfma_f32_16x16x32_bf16 v[130:133], a[56:59], v[234:237], v[130:133]
    s_sub_u32 s14, s36, s27
    ds_read_b128 v[238:241], v5 offset:32
    v_cvt_pk_f16_f32 v223, v144, v145
    v_mfma_f32_16x16x32_bf16 v[130:133], a[60:63], v[158:161], v[130:133]
    s_cmp_ge_u32 s18, 2
    ds_read2_b64 v[226:229], v5 offset0:6 offset1:9
    v_pk_fma_f16 v190, v223, v223, v190
    v_mfma_f32_16x16x32_bf16 v[130:133], a[64:67], v[182:185], v[130:133]
    s_cselect_b32 s14, s14, 0
    ds_read_b128 v[142:145], v5
    v_cvt_pk_f16_f32 v224, v126, v127
    v_mfma_f32_16x16x32_bf16 v[130:133], a[68:71], v[206:209], v[130:133]
    s_sub_u32 s82, s72, s71
    ds_read_b32 v254, v6 offset:192
    v_pk_fma_f16 v190, v224, v224, v190
    v_mfma_f32_16x16x32_bf16 v[198:201], v[186:189], a[144:147], 0
    s_mul_i32 s74, s82, 336
    v_cvt_pk_f16_f32 v225, v128, v129
    v_pk_fma_f16 v190, v225, v225, v190
    v_mfma_f32_16x16x32_bf16 v[198:201], v[118:121], a[148:151], v[198:201]
    s_mul_i32 s75, s82, 272
    v_cvt_pk_f16_f32 v146, v130, v131
    v_pk_fma_f16 v190, v146, v146, v190
    v_mfma_f32_16x16x32_bf16 v[198:201], v[234:237], a[152:155], v[198:201]
    s_waitcnt lgkmcnt(5)
    v_cvt_pk_f16_f32 v147, v132, v133
    v_pk_fma_f16 v190, v147, v147, v190
    v_mfma_f32_16x16x32_bf16 v[130:133], v[32:35], v[246:249], 0
    s_waitcnt lgkmcnt(4)
    v_add_u32 v5, s74, v5
    s_mul_i32 s76, s82, 16
    v_mfma_f32_16x16x32_bf16 v[130:133], v[32:35], v[210:213], v[130:133]
    s_waitcnt lgkmcnt(3)
    v_pk_mul_f16 v193, v194, v238
    v_pk_fma_f16 v193, v195, v239, v193
    v_mfma_f32_16x16x32_bf16 v[198:201], v[158:161], a[156:159], v[198:201]
    s_add_u32 s34, s18, 2
    v_pk_fma_f16 v193, v196, v240, v193
    v_pk_fma_f16 v193, v197, v241, v193
    v_mfma_f32_16x16x32_bf16 v[198:201], v[182:185], a[160:163], v[198:201]
    s_waitcnt lgkmcnt(1)
    v_pk_fma_f16 v193, v148, v228, v193
    v_pk_fma_f16 v193, v149, v229, v193
    v_mfma_f32_16x16x32_bf16 v[198:201], v[206:209], a[164:167], v[198:201]
    s_waitcnt lgkmcnt(0)
    v_mov_b32_dpp v254, v23 quad_perm:[0,1,2,3] row_mask:0x7 bank_mask:0xf
    v_pk_mul_f16 v192, v222, v142
    v_mfma_f32_16x16x32_bf16 v[210:213], v[186:189], a[168:171], 0
    s_add_u32 s8, s60, s23
    v_pk_fma_f16 v192, v223, v143, v192
    v_pk_fma_f16 v192, v224, v144, v192
    v_mfma_f32_16x16x32_bf16 v[210:213], v[118:121], a[172:175], v[210:213]
    s_addc_u32 s9, s61, 0
    v_pk_fma_f16 v192, v225, v145, v192
    v_pk_fma_f16 v192, v146, v226, v192
    v_mfma_f32_16x16x32_bf16 v[210:213], v[234:237], a[176:179], v[210:213]
    s_sub_u32 s10, s36, s23
    ds_read_b128 v[246:249], v0 offset:26624
    v_pk_fma_f16 v192, v147, v227, v192
    v_mfma_f32_16x16x32_bf16 v[210:213], v[158:161], a[180:183], v[210:213]
    s_cmp_le_u32 s34, s45
    ds_read_b128 v[174:177], v1 offset:26624
    v_cvt_pk_bf16_f32 v126, v198, v199
    v_mfma_f32_16x16x32_f16 v[214:217], v[40:43], v[190:193], 0
    s_cselect_b32 s10, s10, 0
    v_cvt_pk_bf16_f32 v127, v200, v201
    v_mul_f32 v255, 0x3baaaaab, v130
    v_mfma_f32_16x16x32_bf16 v[210:213], v[182:185], a[184:187], v[210:213]
    s_add_u32 m0, s28, 0
    ds_read_b128 v[198:201], v0 offset:26752
    v_mul_f32 v134, 0x3baaaaab, v131
    v_mfma_f32_16x16x32_bf16 v[210:213], v[206:209], a[188:191], v[210:213]
    s_mov_b32 s27, s26
    ds_read_b128 v[242:245], v1 offset:26752
    v_mul_f32 v132, 0x3baaaaab, v132
    v_mfma_f32_16x16x32_bf16 v[190:193], v[186:189], a[192:195], 0
    s_mov_b32 s26, s25
    ds_read_b128 v[186:189], v0 offset:26880
    s_mov_b32 s25, s24
    v_mfma_f32_16x16x32_bf16 v[190:193], v[118:121], a[196:199], v[190:193]
    s_mov_b32 s24, s23
    ds_read_b128 v[118:121], v1 offset:26880
    v_cvt_pk_bf16_f32 v130, v210, v211
    v_mfma_f32_16x16x32_bf16 v[190:193], v[234:237], a[200:203], v[190:193]
    s_ff1_i32_b32 s80, s100
    v_rsq_f32 v214, v214
    v_mfma_f32_16x16x32_bf16 v[190:193], v[158:161], a[204:207], v[190:193]
    s_waitcnt lgkmcnt(5)
    v_rsq_f32 v215, v215
    v_mfma_f32_16x16x32_bf16 v[190:193], v[182:185], a[208:211], v[190:193]
    s_mov_b32 s71, s72
    v_mul_f32 v128, s31, v214
    v_cvt_pk_f16_f32 v129, v128, v215
    v_mfma_f32_16x16x32_bf16 v[190:193], v[206:209], a[212:215], v[190:193]
    s_mov_b32 s72, s73
    v_cvt_pk_bf16_f32 v131, v212, v213
    v_fma_f32 v216, v216, v128, v22
    v_mfma_f32_16x16x32_bf16 v[210:213], a[72:75], v[246:249], 0
    s_waitcnt lgkmcnt(3)
    v_fmac_f32_dpp v254, v217, v215 quad_perm:[0,1,2,3] row_mask:0x1 bank_mask:0xf
    v_pk_mul_f16 v194, v194, v129 op_sel:[0,1] op_sel_hi:[1,1]
    v_mfma_f32_16x16x32_bf16 v[210:213], a[76:79], v[174:177], v[210:213]
    s_waitcnt lgkmcnt(2)
    v_cvt_pk_bf16_f32 v190, v190, v191
    v_cvt_pk_bf16_f32 v191, v192, v193
    v_mfma_f32_16x16x32_bf16 v[210:213], a[80:83], v[198:201], v[210:213]
    s_waitcnt lgkmcnt(1)
    v_pk_mul_f16 v195, v195, v129 op_sel:[0,1] op_sel_hi:[1,1]
    v_pk_mul_f16 v196, v196, v129 op_sel:[0,1] op_sel_hi:[1,1]
    v_mfma_f32_16x16x32_bf16 v[210:213], a[84:87], v[242:245], v[210:213]
    s_waitcnt lgkmcnt(0)
    v_pk_mul_f16 v197, v197, v129 op_sel:[0,1] op_sel_hi:[1,1]
    v_pk_mul_f16 v148, v148, v129 op_sel:[0,1] op_sel_hi:[1,1]
    v_mfma_f32_16x16x32_bf16 v[210:213], a[88:91], v[186:189], v[210:213]
    v_pk_mul_f16 v149, v149, v129 op_sel:[0,1] op_sel_hi:[1,1]
    v_pk_mul_f16 v222, v222, v129 op_sel:[0,0] op_sel_hi:[1,0]
    v_mfma_f32_16x16x32_bf16 v[210:213], a[92:95], v[118:121], v[210:213]
    v_pk_mul_f16 v223, v223, v129 op_sel:[0,0] op_sel_hi:[1,0]
    v_pk_mul_f16 v224, v224, v129 op_sel:[0,0] op_sel_hi:[1,0]
    v_mfma_f32_16x16x32_bf16 v[206:209], a[96:99], v[246:249], 0
    v_pk_mul_f16 v225, v225, v129 op_sel:[0,0] op_sel_hi:[1,0]
    v_pk_mul_f16 v146, v146, v129 op_sel:[0,0] op_sel_hi:[1,0]
    v_mfma_f32_16x16x32_bf16 v[206:209], a[100:103], v[174:177], v[206:209]
    v_pk_mul_f16 v147, v147, v129 op_sel:[0,0] op_sel_hi:[1,0]
    v_max3_u32 v44, v44, v214, v215
    v_mfma_f32_16x16x32_bf16 v[206:209], a[104:107], v[198:201], v[206:209]
    v_rsq_f32 v255, v255
    v_mfma_f32_16x16x32_bf16 v[206:209], a[108:111], v[242:245], v[206:209]
    v_rsq_f32 v134, v134
    v_mfma_f32_16x16x32_bf16 v[206:209], a[112:115], v[186:189], v[206:209]
    v_rsq_f32 v132, v132
    v_mfma_f32_16x16x32_bf16 v[206:209], a[116:119], v[118:121], v[206:209]
    v_mul_f32 v122, v255, v122
    v_mul_f32 v123, v255, v123
    v_mfma_f32_16x16x32_bf16 v[234:237], a[120:123], v[246:249], 0
    v_cvt_pk_bf16_f32 v122, v122, v123
    v_mul_f32 v124, v255, v124
    v_mfma_f32_16x16x32_bf16 v[234:237], a[124:127], v[174:177], v[234:237]
    v_mul_f32 v125, v255, v125
    v_cvt_pk_bf16_f32 v123, v124, v125
    v_mfma_f32_16x16x32_bf16 v[234:237], a[128:131], v[198:201], v[234:237]
    v_mul_f32 v154, v255, v154
    v_mul_f32 v155, v255, v155
    v_mfma_f32_16x16x32_bf16 v[234:237], a[132:135], v[242:245], v[234:237]
    v_cvt_pk_bf16_f32 v124, v154, v155
    v_mul_f32 v156, v255, v156
    v_mfma_f32_16x16x32_bf16 v[234:237], a[136:139], v[186:189], v[234:237]
    v_mul_f32 v157, v255, v157
    v_cvt_pk_bf16_f32 v125, v156, v157
    v_mfma_f32_16x16x32_bf16 v[234:237], a[140:143], v[118:121], v[234:237]
    buffer_store_dwordx4 v[122:125], v15, s[12:15], 0 offen nt
    v_mul_f32 v202, v255, v202
    v_mul_f32 v203, v255, v203
    v_cvt_pk_bf16_f32 v128, v202, v203
    v_mul_f32 v204, v255, v204
    v_mfma_f32_16x16x32_bf16 v[122:125], a[0:3], v[246:249], 0
    v_mul_f32 v205, v255, v205
    v_cvt_pk_bf16_f32 v129, v204, v205
    v_mfma_f32_16x16x32_bf16 v[122:125], a[4:7], v[174:177], v[122:125]
    v_cvt_pk_f16_f32 v202, v210, v211
    v_pk_mul_f16 v211, v202, v202
    v_mfma_f32_16x16x32_bf16 v[122:125], a[8:11], v[198:201], v[122:125]
    v_cvt_pk_f16_f32 v203, v212, v213
    v_pk_fma_f16 v211, v203, v203, v211
    v_mfma_f32_16x16x32_bf16 v[122:125], a[12:15], v[242:245], v[122:125]
    v_cvt_pk_f16_f32 v204, v206, v207
    v_pk_fma_f16 v211, v204, v204, v211
    v_mfma_f32_16x16x32_bf16 v[122:125], a[16:19], v[186:189], v[122:125]
    v_cvt_pk_f16_f32 v205, v208, v209
    v_pk_fma_f16 v211, v205, v205, v211
    v_mfma_f32_16x16x32_bf16 v[122:125], a[20:23], v[118:121], v[122:125]
    v_cvt_pk_f16_f32 v160, v234, v235
    v_pk_fma_f16 v211, v160, v160, v211
    v_mfma_f32_16x16x32_bf16 v[154:157], a[24:27], v[246:249], 0
    v_cvt_pk_f16_f32 v161, v236, v237
    v_pk_fma_f16 v211, v161, v161, v211
    v_mfma_f32_16x16x32_bf16 v[154:157], a[28:31], v[174:177], v[154:157]
    v_pk_mul_f16 v213, v202, v238
    v_pk_fma_f16 v213, v203, v239, v213
    v_mfma_f32_16x16x32_bf16 v[154:157], a[32:35], v[198:201], v[154:157]
    v_cvt_pk_f16_f32 v122, v122, v123
    v_pk_mul_f16 v210, v122, v122
    v_mfma_f32_16x16x32_bf16 v[154:157], a[36:39], v[242:245], v[154:157]
    v_cvt_pk_f16_f32 v123, v124, v125
    v_pk_fma_f16 v210, v123, v123, v210
    v_mfma_f32_16x16x32_bf16 v[154:157], a[40:43], v[186:189], v[154:157]
    v_pk_mul_f16 v212, v122, v142
    v_pk_fma_f16 v212, v123, v143, v212
    v_mfma_f32_16x16x32_bf16 v[154:157], a[44:47], v[118:121], v[154:157]
    v_pk_fma_f16 v213, v204, v240, v213
    v_pk_fma_f16 v213, v205, v241, v213
    v_mfma_f32_16x16x32_bf16 v[206:209], a[48:51], v[246:249], 0
    v_pk_fma_f16 v213, v160, v228, v213
    v_pk_fma_f16 v213, v161, v229, v213
    v_mfma_f32_16x16x32_bf16 v[206:209], a[52:55], v[174:177], v[206:209]
    v_mul_f32 v150, v132, v150
    v_mul_f32 v151, v132, v151
    v_mfma_f32_16x16x32_bf16 v[206:209], a[56:59], v[198:201], v[206:209]
    v_cvt_pk_f16_f32 v124, v154, v155
    v_pk_fma_f16 v210, v124, v124, v210
    v_mfma_f32_16x16x32_bf16 v[206:209], a[60:63], v[242:245], v[206:209]
    v_cvt_pk_f16_f32 v125, v156, v157
    v_pk_fma_f16 v210, v125, v125, v210
    v_mfma_f32_16x16x32_bf16 v[206:209], a[64:67], v[186:189], v[206:209]
    buffer_store_dwordx2 v[128:129], v18, s[12:15], 0 offen nt
    v_pk_fma_f16 v212, v124, v144, v212
    v_pk_fma_f16 v212, v125, v145, v212
    v_mfma_f32_16x16x32_bf16 v[206:209], a[68:71], v[118:121], v[206:209]
    v_cvt_pk_bf16_f32 v150, v150, v151
    v_mul_f32 v152, v132, v152
    v_mfma_f32_16x16x32_bf16 v[154:157], v[246:249], a[144:147], 0
    v_mul_f32 v153, v132, v153
    v_cvt_pk_bf16_f32 v151, v152, v153
    v_mfma_f32_16x16x32_bf16 v[154:157], v[174:177], a[148:151], v[154:157]
    v_mul_f32 v162, v132, v162
    v_mul_f32 v163, v132, v163
    v_mfma_f32_16x16x32_bf16 v[154:157], v[198:201], a[152:155], v[154:157]
    v_cvt_pk_f16_f32 v158, v206, v207
    v_pk_fma_f16 v210, v158, v158, v210
    v_mfma_f32_16x16x32_bf16 v[154:157], v[242:245], a[156:159], v[154:157]
    v_cvt_pk_f16_f32 v159, v208, v209
    v_pk_fma_f16 v210, v159, v159, v210
    v_mfma_f32_16x16x32_bf16 v[154:157], v[186:189], a[160:163], v[154:157]
    v_pk_fma_f16 v212, v158, v226, v212
    v_pk_fma_f16 v212, v159, v227, v212
    v_mfma_f32_16x16x32_bf16 v[154:157], v[118:121], a[164:167], v[154:157]
    v_cvt_pk_bf16_f32 v152, v162, v163
    v_mul_f32 v164, v132, v164
    v_mfma_f32_16x16x32_f16 v[206:209], v[40:43], v[210:213], 0
    v_mul_f32 v165, v132, v165
    v_cvt_pk_bf16_f32 v153, v164, v165
    v_mfma_f32_16x16x32_bf16 v[210:213], v[246:249], a[168:171], 0
    v_mul_f32 v138, v132, v138
    v_mul_f32 v139, v132, v139
    v_mfma_f32_16x16x32_bf16 v[210:213], v[174:177], a[172:175], v[210:213]
    v_cvt_pk_bf16_f32 v128, v154, v155
    v_cvt_pk_bf16_f32 v129, v156, v157
    v_mfma_f32_16x16x32_bf16 v[210:213], v[198:201], a[176:179], v[210:213]
    ds_read_b128 v[154:157], v0 offset:32768
    v_cvt_pk_bf16_f32 v136, v138, v139
    v_mfma_f32_16x16x32_bf16 v[210:213], v[242:245], a[180:183], v[210:213]
    ds_read_b128 v[162:165], v1 offset:32768
    v_mul_f32 v140, v132, v140
    v_mfma_f32_16x16x32_bf16 v[210:213], v[186:189], a[184:187], v[210:213]
    ds_read_b128 v[218:221], v0 offset:32896
    v_mul_f32 v141, v132, v141
    v_mfma_f32_16x16x32_bf16 v[210:213], v[118:121], a[188:191], v[210:213]
    ds_read_b128 v[234:237], v1 offset:32896
    v_cvt_pk_bf16_f32 v137, v140, v141
    v_mfma_f32_16x16x32_bf16 v[182:185], v[246:249], a[192:195], 0
    ds_read_b128 v[138:141], v0 offset:33024
    v_mul_f32 v114, v134, v114
    v_mfma_f32_16x16x32_bf16 v[182:185], v[174:177], a[196:199], v[182:185]
    ds_read_b128 v[246:249], v1 offset:33024
    v_mul_f32 v115, v134, v115
    v_mfma_f32_16x16x32_bf16 v[182:185], v[198:201], a[200:203], v[182:185]
    buffer_store_dwordx4 v[150:153], v17, s[12:15], 0 offen nt
    v_rsq_f32 v206, v206
    v_rsq_f32 v207, v207
    v_mfma_f32_16x16x32_bf16 v[182:185], v[242:245], a[204:207], v[182:185]
    s_waitcnt lgkmcnt(5)
    v_mul_f32 v214, s31, v206
    v_cvt_pk_f16_f32 v215, v214, v207
    v_mfma_f32_16x16x32_bf16 v[182:185], v[186:189], a[208:211], v[182:185]
    s_waitcnt lgkmcnt(4)
    v_fma_f32 v208, v208, v214, v24
    v_fmac_f32_dpp v254, v209, v207 quad_perm:[0,1,2,3] row_mask:0x2 bank_mask:0xf
    v_mfma_f32_16x16x32_bf16 v[182:185], v[118:121], a[212:215], v[182:185]
    s_waitcnt lgkmcnt(3)
    v_cvt_pk_bf16_f32 v132, v210, v211
    v_cvt_pk_bf16_f32 v133, v212, v213
    v_mfma_f32_16x16x32_bf16 v[210:213], a[72:75], v[154:157], 0
    s_waitcnt lgkmcnt(2)
    v_pk_mul_f16 v202, v202, v215 op_sel:[0,1] op_sel_hi:[1,1]
    v_pk_mul_f16 v203, v203, v215 op_sel:[0,1] op_sel_hi:[1,1]
    v_mfma_f32_16x16x32_bf16 v[210:213], a[76:79], v[162:165], v[210:213]
    s_waitcnt lgkmcnt(1)
    v_cvt_pk_bf16_f32 v192, v182, v183
    v_cvt_pk_bf16_f32 v193, v184, v185
    v_mfma_f32_16x16x32_bf16 v[210:213], a[80:83], v[218:221], v[210:213]
    s_waitcnt lgkmcnt(0)
    v_pk_mul_f16 v204, v204, v215 op_sel:[0,1] op_sel_hi:[1,1]
    v_pk_mul_f16 v205, v205, v215 op_sel:[0,1] op_sel_hi:[1,1]
    v_mfma_f32_16x16x32_bf16 v[210:213], a[84:87], v[234:237], v[210:213]
    v_pk_mul_f16 v160, v160, v215 op_sel:[0,1] op_sel_hi:[1,1]
    v_pk_mul_f16 v161, v161, v215 op_sel:[0,1] op_sel_hi:[1,1]
    v_mfma_f32_16x16x32_bf16 v[210:213], a[88:91], v[138:141], v[210:213]
    v_pk_mul_f16 v122, v122, v215 op_sel:[0,0] op_sel_hi:[1,0]
    v_pk_mul_f16 v123, v123, v215 op_sel:[0,0] op_sel_hi:[1,0]
    v_mfma_f32_16x16x32_bf16 v[210:213], a[92:95], v[246:249], v[210:213]
    v_pk_mul_f16 v124, v124, v215 op_sel:[0,0] op_sel_hi:[1,0]
    v_pk_mul_f16 v125, v125, v215 op_sel:[0,0] op_sel_hi:[1,0]
    v_mfma_f32_16x16x32_bf16 v[118:121], a[96:99], v[154:157], 0
    v_pk_mul_f16 v158, v158, v215 op_sel:[0,0] op_sel_hi:[1,0]
    v_pk_mul_f16 v159, v159, v215 op_sel:[0,0] op_sel_hi:[1,0]
    v_mfma_f32_16x16x32_bf16 v[118:121], a[100:103], v[162:165], v[118:121]
    v_max3_u32 v44, v44, v206, v207
    v_cvt_pk_bf16_f32 v114, v114, v115
    v_mfma_f32_16x16x32_bf16 v[118:121], a[104:107], v[218:221], v[118:121]
    v_cvt_pk_f16_f32 v186, v210, v211
    v_pk_mul_f16 v211, v186, v186
    v_mfma_f32_16x16x32_bf16 v[118:121], a[108:111], v[234:237], v[118:121]
    s_waitcnt vmcnt(3)
    ds_write_b16 v8, v45 offset:512
    v_mfma_f32_16x16x32_bf16 v[118:121], a[112:115], v[138:141], v[118:121]
    v_mov_b32 v45, 1
    v_cvt_pk_f16_f32 v187, v212, v213
    v_mfma_f32_16x16x32_bf16 v[118:121], a[116:119], v[246:249], v[118:121]
    v_pk_fma_f16 v211, v187, v187, v211
    v_pk_mul_f16 v213, v186, v238
    v_mfma_f32_16x16x32_bf16 v[150:153], a[120:123], v[154:157], 0
    v_pk_fma_f16 v213, v187, v239, v213
    v_mul_f32 v116, v134, v116
    v_mfma_f32_16x16x32_bf16 v[150:153], a[124:127], v[162:165], v[150:153]
    buffer_store_dwordx2 v[136:137], v20, s[12:15], 0 offen nt
    v_exp_f32 v208, v208
    v_mfma_f32_16x16x32_bf16 v[150:153], a[128:131], v[218:221], v[150:153]
    v_cvt_pk_f16_f32 v188, v118, v119
    v_pk_fma_f16 v211, v188, v188, v211
    v_mfma_f32_16x16x32_bf16 v[150:153], a[132:135], v[234:237], v[150:153]
    v_cvt_pk_f16_f32 v189, v120, v121
    v_pk_fma_f16 v211, v189, v189, v211
    v_mfma_f32_16x16x32_bf16 v[150:153], a[136:139], v[138:141], v[150:153]
    s_waitcnt lgkmcnt(0)
    v_pk_fma_f16 v213, v188, v240, v213
    v_pk_fma_f16 v213, v189, v241, v213
    v_mfma_f32_16x16x32_bf16 v[150:153], a[140:143], v[246:249], v[150:153]
    s_barrier
    v_mul_f32 v117, v134, v117
    v_mfma_f32_16x16x32_bf16 v[238:241], a[0:3], v[154:157], 0
    v_cvt_pk_bf16_f32 v115, v116, v117
    v_mfma_f32_16x16x32_bf16 v[238:241], a[4:7], v[162:165], v[238:241]
    v_mul_f32 v166, v134, v166
    v_mfma_f32_16x16x32_bf16 v[238:241], a[8:11], v[218:221], v[238:241]
    ds_read_u16 v255, v9 offset:512
    v_mfma_f32_16x16x32_bf16 v[238:241], a[12:15], v[234:237], v[238:241]
    v_cvt_pk_f16_f32 v120, v150, v151
    v_pk_fma_f16 v211, v120, v120, v211
    v_mfma_f32_16x16x32_bf16 v[238:241], a[16:19], v[138:141], v[238:241]
    v_cvt_pk_f16_f32 v121, v152, v153
    v_pk_fma_f16 v211, v121, v121, v211
    v_mfma_f32_16x16x32_bf16 v[238:241], a[20:23], v[246:249], v[238:241]
    v_pk_fma_f16 v213, v120, v228, v213
    v_pk_fma_f16 v213, v121, v229, v213
    v_mfma_f32_16x16x32_bf16 v[150:153], a[24:27], v[154:157], 0
    v_exp_f32 v216, v216
    v_mfma_f32_16x16x32_bf16 v[150:153], a[28:31], v[162:165], v[150:153]
    v_cvt_pk_bf16_f32 v39, v216, 0
    v_mul_f32 v167, v134, v167
    v_mfma_f32_16x16x32_bf16 v[150:153], a[32:35], v[218:221], v[150:153]
    v_cvt_pk_f16_f32 v198, v238, v239
    v_pk_mul_f16 v210, v198, v198
    v_mfma_f32_16x16x32_bf16 v[150:153], a[36:39], v[234:237], v[150:153]
    v_cvt_pk_f16_f32 v199, v240, v241
    v_pk_fma_f16 v210, v199, v199, v210
    v_mfma_f32_16x16x32_bf16 v[150:153], a[40:43], v[138:141], v[150:153]
    s_waitcnt lgkmcnt(0)
    v_readfirstlane_b32 s77, v255
    v_pk_mul_f16 v212, v198, v142
    v_mfma_f32_16x16x32_bf16 v[150:153], a[44:47], v[246:249], v[150:153]
    v_pk_fma_f16 v212, v199, v143, v212
    v_cvt_pk_bf16_f32 v116, v166, v167
    v_mfma_f32_16x16x32_bf16 v[238:241], a[48:51], v[154:157], 0
    buffer_load_dwordx4 v10, s[8:11], 0 offen nt lds
    v_mul_f32 v168, v134, v168
    v_mfma_f32_16x16x32_bf16 v[238:241], a[52:55], v[162:165], v[238:241]
    s_add_u32 m0, s28, 4096
    v_mul_f32 v169, v134, v169
    v_cvt_pk_f16_f32 v200, v150, v151
    v_mfma_f32_16x16x32_bf16 v[238:241], a[56:59], v[218:221], v[238:241]
    v_pk_fma_f16 v210, v200, v200, v210
    v_cvt_pk_f16_f32 v201, v152, v153
    v_mfma_f32_16x16x32_bf16 v[238:241], a[60:63], v[234:237], v[238:241]
    ds_read_b128 v[242:245], v2 offset:0
    v_pk_fma_f16 v210, v201, v201, v210
    v_mfma_f32_16x16x32_bf16 v[238:241], a[64:67], v[138:141], v[238:241]
    ds_read_b128 v[174:177], v2 offset:1024
    v_pk_fma_f16 v212, v200, v144, v212
    v_mfma_f32_16x16x32_bf16 v[238:241], a[68:71], v[246:249], v[238:241]
    ds_read_b128 v[170:173], v2 offset:2048
    buffer_load_dwordx4 v11, s[8:11], 0 offen nt lds
    v_mfma_f32_16x16x32_bf16 v[150:153], v[154:157], a[144:147], 0
    s_add_u32 m0, s28, 8192
    ds_read_b128 v[214:217], v2 offset:3072
    v_pk_fma_f16 v212, v201, v145, v212
    v_mfma_f32_16x16x32_bf16 v[150:153], v[162:165], a[148:151], v[150:153]
    ds_read_b128 v[182:185], v2 offset:4096
    v_cvt_pk_f16_f32 v118, v238, v239
    v_mfma_f32_16x16x32_bf16 v[150:153], v[218:221], a[152:155], v[150:153]
    ds_read_b128 v[178:181], v2 offset:5120
    v_pk_fma_f16 v210, v118, v118, v210
    v_mfma_f32_16x16x32_bf16 v[150:153], v[234:237], a[156:159], v[150:153]
    v_cvt_pk_f16_f32 v119, v240, v241
    v_pk_fma_f16 v210, v119, v119, v210
    v_mfma_f32_16x16x32_bf16 v[150:153], v[138:141], a[160:163], v[150:153]
    buffer_load_dwordx4 v12, s[8:11], 0 offen nt lds
    v_pk_fma_f16 v212, v118, v226, v212
    v_mfma_f32_16x16x32_bf16 v[150:153], v[246:249], a[164:167], v[150:153]
    s_waitcnt lgkmcnt(5)
    v_pk_fma_f16 v212, v119, v227, v212
    v_cvt_pk_bf16_f32 v117, v168, v169
    v_mfma_f32_16x16x32_bf16 v[226:229], v[154:157], a[168:171], 0
    s_add_u32 m0, s28, 12288
    v_mul_f32 v230, v134, v230
    v_mul_f32 v231, v134, v231
    v_mfma_f32_16x16x32_f16 v[166:169], v[40:43], v[210:213], 0
    s_xor_b32 s28, s28, 65536
    v_cvt_pk_bf16_f32 v142, v150, v151
    v_cvt_pk_bf16_f32 v143, v152, v153
    v_mfma_f32_16x16x32_bf16 v[226:229], v[162:165], a[172:175], v[226:229]
    s_waitcnt lgkmcnt(2)
    ds_read2_b32 v[144:145], v6 offset0:0 offset1:0
    v_cvt_pk_bf16_f32 v230, v230, v231
    v_mfma_f32_16x16x32_bf16 v[226:229], v[218:221], a[176:179], v[226:229]
    s_waitcnt lgkmcnt(2)
    buffer_load_dwordx4 v13, s[8:11], 0 offen nt lds
    ds_read2_b32 v[212:213], v6 offset0:16 offset1:16
    v_mfma_f32_16x16x32_bf16 v[226:229], v[234:237], a[180:183], v[226:229]
    s_mov_b32 m0, s29
    ds_read2_b32 v[240:241], v6 offset0:32 offset1:32
    v_mul_f32 v232, v134, v232
    v_mfma_f32_16x16x32_bf16 v[226:229], v[138:141], a[184:187], v[226:229]
    s_xor_b32 s29, s29, s30
    v_rsq_f32 v166, v166
    v_mfma_f32_16x16x32_bf16 v[226:229], v[246:249], a[188:191], v[226:229]
    s_add_u32 s19, s19, s20
    v_rsq_f32 v167, v167
    v_mfma_f32_16x16x32_bf16 v[150:153], v[154:157], a[192:195], 0
    s_add_u32 s23, s23, s21
    v_mul_f32 v136, s31, v166
    v_cvt_pk_f16_f32 v137, v136, v167
    v_mfma_f32_16x16x32_bf16 v[150:153], v[162:165], a[196:199], v[150:153]
    s_waitcnt lgkmcnt(3)
    buffer_load_dwordx4 v14, s[8:11], 0 offen nt lds
    v_fma_f32 v168, v168, v136, v26
    v_mfma_f32_16x16x32_bf16 v[150:153], v[218:221], a[200:203], v[150:153]
    s_cmp_ge_u32 s19, 72
    v_fmac_f32_dpp v254, v169, v167 quad_perm:[0,1,2,3] row_mask:0x4 bank_mask:0xf
    v_cvt_pk_bf16_f32 v210, v226, v227
    v_mfma_f32_16x16x32_bf16 v[150:153], v[234:237], a[204:207], v[150:153]
    s_cselect_b32 s34, 72, 0
    v_cvt_pk_bf16_f32 v211, v228, v229
    v_pk_mul_f16 v186, v186, v137 op_sel:[0,1] op_sel_hi:[1,1]
    v_mfma_f32_16x16x32_bf16 v[150:153], v[138:141], a[208:211], v[150:153]
    s_cselect_b32 s35, s22, 0
    v_pk_mul_f16 v187, v187, v137 op_sel:[0,1] op_sel_hi:[1,1]
    v_pk_mul_f16 v188, v188, v137 op_sel:[0,1] op_sel_hi:[1,1]
    v_mfma_f32_16x16x32_bf16 v[150:153], v[246:249], a[212:215], v[150:153]
    s_sub_u32 s19, s19, s34
    v_pk_mul_f16 v189, v189, v137 op_sel:[0,1] op_sel_hi:[1,1]
    v_pk_mul_f16 v120, v120, v137 op_sel:[0,1] op_sel_hi:[1,1]
    v_mfma_f32_16x16x32_f16 v[154:157], v[194:197], v[222:225], v[46:49]
    s_waitcnt lgkmcnt(0)
    buffer_store_dwordx4 v[114:117], v16, s[12:15], 0 offen nt
    v_pk_mul_f16 v121, v121, v137 op_sel:[0,1] op_sel_hi:[1,1]
    v_pk_mul_f16 v198, v198, v137 op_sel:[0,0] op_sel_hi:[1,0]
    v_cvt_pk_bf16_f32 v238, v150, v151
    v_cvt_pk_bf16_f32 v239, v152, v153
    v_mfma_f32_16x16x32_f16 v[114:117], v[202:205], v[222:225], v[50:53]
    s_add_u32 s23, s23, s35
    v_pk_mul_f16 v199, v199, v137 op_sel:[0,0] op_sel_hi:[1,0]
    v_pk_mul_f16 v200, v200, v137 op_sel:[0,0] op_sel_hi:[1,0]
    v_mfma_f32_16x16x32_f16 v[246:249], v[186:189], v[222:225], v[54:57]
    s_cmp_lg_u32 s83, 0
    v_pk_mul_f16 v201, v201, v137 op_sel:[0,0] op_sel_hi:[1,0]
    v_pk_mul_f16 v118, v118, v137 op_sel:[0,0] op_sel_hi:[1,0]
    v_pk_mul_f16 v119, v119, v137 op_sel:[0,0] op_sel_hi:[1,0]
    v_mfma_f32_16x16x16_f16 v[154:157], v[148:149], v[146:147], v[154:157]
    v_max3_u32 v44, v44, v166, v167
    v_exp_f32 v254, v254
    v_mfma_f32_16x16x16_f16 v[114:117], v[160:161], v[146:147], v[114:117]
    v_cvt_pk_bf16_f32 v254, v254, v254
    v_exp_f32 v168, v168
    v_mfma_f32_16x16x16_f16 v[246:249], v[120:121], v[146:147], v[246:249]
    v_mul_f32 v233, v134, v233
    v_cvt_pk_bf16_f32 v231, v232, v233
    v_exp_f32 v154, v154
    v_mfma_f32_16x16x32_f16 v[162:165], v[194:197], v[122:125], v[58:61]
    s_cselect_b32 s77, s80, s77
    ds_write_b16 v8, v254
    v_mfma_f32_16x16x32_f16 v[138:141], v[202:205], v[122:125], v[62:65]
    s_mul_i32 s78, s77, 2688
    v_exp_f32 v155, v155
    v_mfma_f32_16x16x32_f16 v[234:237], v[186:189], v[122:125], v[66:69]
    s_add_u32 s78, s78, s69
    v_cvt_pk_bf16_f32 v218, v154, v155
    v_exp_f32 v156, v156
    v_mfma_f32_16x16x16_f16 v[162:165], v[148:149], v[158:159], v[162:165]
    v_exp_f32 v157, v157
    v_xor_b32 v0, 65536, v0
    v_mfma_f32_16x16x16_f16 v[138:141], v[160:161], v[158:159], v[138:141]
    v_cvt_pk_bf16_f32 v219, v156, v157
    v_exp_f32 v114, v114
    v_mfma_f32_16x16x16_f16 v[234:237], v[120:121], v[158:159], v[234:237]
    v_exp_f32 v115, v115
    v_exp_f32 v116, v116
    v_mfma_f32_16x16x32_bf16 v[122:125], a[216:219], v[242:245], 0
    s_add_u32 s80, s77, s68
    v_exp_f32 v162, v162
    v_mfma_f32_16x16x32_bf16 v[122:125], a[220:223], v[174:177], v[122:125]
    s_cmp_ge_u32 s80, 72
    v_exp_f32 v163, v163
    v_mfma_f32_16x16x32_f16 v[222:225], v[194:197], v[198:201], v[70:73]
    s_cselect_b32 s80, s22, 0
    v_cvt_pk_bf16_f32 v158, v162, v163
    v_cvt_pk_bf16_f32 v220, v114, v115
    v_mfma_f32_16x16x32_f16 v[134:137], v[202:205], v[198:201], v[74:77]
    s_add_u32 s78, s78, s80
    v_exp_f32 v164, v164
    v_mfma_f32_16x16x32_f16 v[194:197], v[186:189], v[198:201], v[78:81]
    buffer_store_dwordx2 v[230:231], v19, s[12:15], 0 offen nt
    v_exp_f32 v165, v165
    v_mfma_f32_16x16x16_f16 v[222:225], v[148:149], v[118:119], v[222:225]
    v_cvt_pk_bf16_f32 v159, v164, v165
    v_exp_f32 v138, v138
    v_mfma_f32_16x16x16_f16 v[134:137], v[160:161], v[118:119], v[134:137]
    v_exp_f32 v139, v139
    v_xor_b32 v1, 65536, v1
    v_mfma_f32_16x16x16_f16 v[194:197], v[120:121], v[118:119], v[194:197]
    v_cvt_pk_bf16_f32 v160, v138, v139
    v_exp_f32 v140, v140
    v_add_u32 v6, s75, v6
    v_mfma_f32_16x16x32_bf16 v[122:125], a[224:227], v[170:173], v[122:125]
    s_add_u32 s80, s77, 20
    v_exp_f32 v141, v141
    v_mfma_f32_16x16x32_bf16 v[122:125], a[228:231], v[214:217], v[122:125]
    s_add_u32 s34, s18, 3
    v_exp_f32 v234, v234
    v_mfma_f32_16x16x32_bf16 v[122:125], a[232:235], v[182:185], v[122:125]
    s_cmp_lt_u32 s77, s62
    v_exp_f32 v235, v235
    v_mfma_f32_16x16x32_bf16 v[122:125], a[236:239], v[178:181], v[122:125]
    s_cselect_b32 s79, 1, 0
    v_exp_f32 v236, v236
    v_mfma_f32_16x16x32_bf16 v[154:157], a[240:243], v[242:245], 0
    s_cselect_b32 s78, s78, 0
    ds_read_b128 v[150:153], v2 offset:6144
    v_cvt_pk_bf16_f32 v161, v140, v141
    v_mfma_f32_16x16x32_bf16 v[154:157], a[244:247], v[174:177], v[154:157]
    s_cmp_lt_u32 s34, s17
    ds_read_b128 v[162:165], v2 offset:7168
    v_fma_f32 v255, v122, v122, s33
    v_mfma_f32_16x16x32_bf16 v[154:157], a[248:251], v[170:173], v[154:157]
    s_cselect_b32 s23, s23, s78
    ds_read_b128 v[186:189], v2 offset:8192
    v_fmac_f32 v255, v123, v123
    v_mfma_f32_16x16x32_bf16 v[154:157], a[252:255], v[214:217], v[154:157]
    s_cselect_b32 s73, s34, s80
    ds_read_b128 v[138:141], v2 offset:9216
    v_fmac_f32 v255, v124, v124
    v_mfma_f32_16x16x32_bf16 v[154:157], v[82:85], v[182:185], v[154:157]
    s_cselect_b32 s79, 0, s79
    ds_read_b128 v[118:121], v2 offset:10240
    v_fmac_f32 v255, v125, v125
    v_mfma_f32_16x16x32_bf16 v[154:157], v[86:89], v[178:181], v[154:157]
    s_cselect_b32 s81, 0, 1
    ds_read_b128 v[198:201], v2 offset:11264
    s_add_u32 s80, s77, 1
    v_mfma_f32_16x16x32_bf16 v[202:205], v[90:93], v[242:245], 0
    s_mul_i32 s80, s80, s81
    v_exp_f32 v237, v237
    v_mfma_f32_16x16x32_bf16 v[202:205], v[94:97], v[174:177], v[202:205]
    s_cmp_lt_u32 s80, s62
    v_exp_f32 v117, v117
    v_mfma_f32_16x16x32_bf16 v[202:205], v[98:101], v[170:173], v[202:205]
    s_waitcnt lgkmcnt(5)
    v_cvt_pk_bf16_f32 v221, v116, v117
    v_fmac_f32 v255, v154, v154
    v_mfma_f32_16x16x32_bf16 v[202:205], v[102:105], v[214:217], v[202:205]
    s_cselect_b32 s70, s70, 0
    v_exp_f32 v246, v246
    v_mfma_f32_16x16x32_bf16 v[202:205], v[106:109], v[182:185], v[202:205]
    s_cselect_b32 s62, s62, 0
    v_exp_f32 v247, v247
    v_mfma_f32_16x16x32_bf16 v[202:205], v[110:113], v[178:181], v[202:205]
    s_add_u32 s80, s18, 4
    v_cvt_pk_bf16_f32 v36, v246, v247
    v_fmac_f32 v255, v155, v155
    v_mfma_f32_16x16x32_bf16 v[114:117], a[216:219], v[150:153], 0
    s_waitcnt lgkmcnt(1)
    v_exp_f32 v248, v248
    v_mfma_f32_16x16x32_bf16 v[114:117], a[220:223], v[162:165], v[114:117]
    s_cmp_ge_u32 s80, s17
    v_exp_f32 v249, v249
    v_mfma_f32_16x16x32_bf16 v[114:117], a[224:227], v[186:189], v[114:117]
    s_cselect_b32 s66, s70, 0
    v_cvt_pk_bf16_f32 v37, v248, v249
    v_fmac_f32 v255, v156, v156
    v_mfma_f32_16x16x32_bf16 v[114:117], a[228:231], v[138:141], v[114:117]
    s_waitcnt lgkmcnt(0)
    buffer_atomic_add v45, v10, s[64:67], 0 offen sc0 sc1
    v_fmac_f32 v255, v157, v157
    v_mfma_f32_16x16x32_bf16 v[178:181], v[28:31], v[36:39], 0
    s_lshl_b32 s80, s79, s73
    v_exp_f32 v222, v222
    v_mfma_f32_16x16x32_bf16 v[178:181], v[28:31], v[218:221], v[178:181]
    s_or_b32 s63, s63, s80
    v_exp_f32 v223, v223
    v_mfma_f32_16x16x32_bf16 v[146:149], v[142:145], v[36:39], 0
    s_sub_u32 s80, s100, s81
    v_cvt_pk_bf16_f32 v226, v222, v223
    v_fmac_f32 v255, v202, v202
    v_mfma_f32_16x16x32_bf16 v[146:149], v[126:129], v[218:221], v[146:149]
    s_and_b32 s100, s100, s80
    v_exp_f32 v224, v224
    v_mfma_f32_16x16x32_bf16 v[246:249], v[210:213], v[36:39], 0
    s_add_u32 s45, s45, s79
    v_exp_f32 v225, v225
    v_mfma_f32_16x16x32_bf16 v[246:249], v[130:133], v[218:221], v[246:249]
    s_add_u32 s18, s18, 1
    v_cvt_pk_bf16_f32 v227, v224, v225
    v_fmac_f32 v255, v203, v203
    v_mfma_f32_16x16x32_bf16 v[222:225], v[238:241], v[36:39], 0
    s_cmp_lt_u32 s18, s45
    v_cvt_pk_bf16_f32 v36, v234, v235
    v_cvt_pk_bf16_f32 v37, v236, v237
    v_mfma_f32_16x16x32_bf16 v[222:225], v[190:193], v[218:221], v[222:225]
    v_cvt_pk_bf16_f32 v39, v208, 0
    v_fmac_f32 v255, v204, v204
    v_mfma_f32_16x16x32_bf16 v[114:117], a[232:235], v[118:121], v[114:117]
    v_exp_f32 v134, v134
    v_mfma_f32_16x16x32_bf16 v[182:185], v[28:31], v[36:39], 0
    v_exp_f32 v135, v135
    v_mfma_f32_16x16x32_bf16 v[182:185], v[28:31], v[158:161], v[182:185]
    v_cvt_pk_bf16_f32 v228, v134, v135
    v_fmac_f32 v255, v205, v205
    v_mfma_f32_16x16x32_bf16 v[230:233], v[142:145], v[36:39], 0
    v_exp_f32 v136, v136
    v_mfma_f32_16x16x32_bf16 v[230:233], v[126:129], v[158:161], v[230:233]
    v_exp_f32 v137, v137
    v_mfma_f32_16x16x32_bf16 v[170:173], v[210:213], v[36:39], 0
    v_exp_f32 v194, v194
    v_mfma_f32_16x16x32_bf16 v[170:173], v[130:133], v[158:161], v[170:173]
    v_rcp_f32 v182, v182
    v_mfma_f32_16x16x32_bf16 v[174:177], v[238:241], v[36:39], 0
    v_cvt_pk_bf16_f32 v229, v136, v137
    v_cvt_pk_bf16_f32 v39, v168, 0
    v_mfma_f32_16x16x32_bf16 v[174:177], v[190:193], v[158:161], v[174:177]
    v_mul_f32 v230, v182, v230
    v_mul_f32 v231, v182, v231
    v_mfma_f32_16x16x32_bf16 v[114:117], a[236:239], v[198:201], v[114:117]
    v_cvt_pk_bf16_f32 v134, v230, v231
    v_mul_f32 v232, v182, v232
    v_mfma_f32_16x16x32_bf16 v[166:169], a[240:243], v[150:153], 0
    ds_read_b128 v[214:217], v2 offset:12288
    v_mul_f32 v233, v182, v233
    v_mfma_f32_16x16x32_bf16 v[166:169], a[244:247], v[162:165], v[166:169]
    ds_read_b128 v[234:237], v2 offset:13312
    v_cvt_pk_bf16_f32 v135, v232, v233
    v_mfma_f32_16x16x32_bf16 v[166:169], a[248:251], v[186:189], v[166:169]
    ds_read_b128 v[218:221], v2 offset:14336
    v_fma_f32 v254, v114, v114, s33
    v_mfma_f32_16x16x32_bf16 v[166:169], a[252:255], v[138:141], v[166:169]
    ds_read_b128 v[158:161], v2 offset:15360
    v_fmac_f32 v254, v115, v115
    v_mfma_f32_16x16x32_bf16 v[166:169], v[82:85], v[118:121], v[166:169]
    ds_read_b128 v[206:209], v2 offset:16384
    v_fmac_f32 v254, v116, v116
    v_mfma_f32_16x16x32_bf16 v[166:169], v[86:89], v[198:201], v[166:169]
    ds_read_b128 v[242:245], v2 offset:17408
    v_fmac_f32 v254, v117, v117
    v_mfma_f32_16x16x32_bf16 v[230:233], v[90:93], v[150:153], 0
    v_mul_f32 v170, v182, v170
    v_mul_f32 v171, v182, v171
    v_mfma_f32_16x16x32_bf16 v[230:233], v[94:97], v[162:165], v[230:233]
    v_cvt_pk_bf16_f32 v136, v170, v171
    v_mul_f32 v172, v182, v172
    v_mfma_f32_16x16x32_bf16 v[230:233], v[98:101], v[186:189], v[230:233]
    s_waitcnt lgkmcnt(5)
    v_fmac_f32 v254, v166, v166
    v_fmac_f32 v254, v167, v167
    v_mfma_f32_16x16x32_bf16 v[230:233], v[102:105], v[138:141], v[230:233]
    s_waitcnt lgkmcnt(4)
    v_fmac_f32 v254, v168, v168
    v_fmac_f32 v254, v169, v169
    v_mfma_f32_16x16x32_bf16 v[230:233], v[106:109], v[118:121], v[230:233]
    s_waitcnt lgkmcnt(3)
    v_mul_f32 v173, v182, v173
    v_cvt_pk_bf16_f32 v137, v172, v173
    v_mfma_f32_16x16x32_bf16 v[230:233], v[110:113], v[198:201], v[230:233]
    s_waitcnt lgkmcnt(2)
    ds_write_b128 v3, v[134:137] offset:6144
    v_mfma_f32_16x16x32_bf16 v[150:153], a[216:219], v[214:217], 0
    s_waitcnt lgkmcnt(1)
    v_mul_f32 v174, v182, v174
    v_mul_f32 v175, v182, v175
    v_mfma_f32_16x16x32_bf16 v[150:153], a[220:223], v[234:237], v[150:153]
    v_cvt_pk_bf16_f32 v174, v174, v175
    v_fmac_f32 v254, v230, v230
    v_mfma_f32_16x16x32_bf16 v[150:153], a[224:227], v[218:221], v[150:153]
    v_fmac_f32 v254, v231, v231
    v_fmac_f32 v254, v232, v232
    v_mfma_f32_16x16x32_bf16 v[150:153], a[228:231], v[158:161], v[150:153]
    v_fmac_f32 v254, v233, v233
    v_cvt_pk_bf16_f32 v254, v255, v254
    v_mfma_f32_16x16x32_bf16 v[150:153], a[232:235], v[206:209], v[150:153]
    v_mul_f32 v176, v182, v176
    v_mul_f32 v177, v182, v177
    v_mfma_f32_16x16x32_bf16 v[150:153], a[236:239], v[242:245], v[150:153]
    v_cvt_pk_bf16_f32 v175, v176, v177
    v_xor_b32 v2, 65536, v2
    v_mfma_f32_16x16x32_bf16 v[162:165], a[240:243], v[214:217], 0
    ds_write_b64 v4, v[174:175] offset:10240
    v_mfma_f32_16x16x32_bf16 v[162:165], a[244:247], v[234:237], v[162:165]
    v_exp_f32 v195, v195
    v_mfma_f32_16x16x32_bf16 v[162:165], a[248:251], v[218:221], v[162:165]
    v_exp_f32 v196, v196
    v_mfma_f32_16x16x32_bf16 v[162:165], a[252:255], v[158:161], v[162:165]
    v_fma_f32 v255, v150, v150, s33
    v_fmac_f32 v255, v151, v151
    v_mfma_f32_16x16x32_bf16 v[162:165], v[82:85], v[206:209], v[162:165]
    v_fmac_f32 v255, v152, v152
    v_fmac_f32 v255, v153, v153
    v_mfma_f32_16x16x32_bf16 v[162:165], v[86:89], v[242:245], v[162:165]
    v_exp_f32 v197, v197
    v_mfma_f32_16x16x32_bf16 v[138:141], v[90:93], v[214:217], 0
    ds_read_b128 v[186:189], v0 offset:20480
    v_cvt_pk_bf16_f32 v36, v194, v195
    v_mfma_f32_16x16x32_bf16 v[138:141], v[94:97], v[234:237], v[138:141]
    ds_read_b128 v[118:121], v1 offset:20480
    v_cvt_pk_bf16_f32 v37, v196, v197
    v_mfma_f32_16x16x32_bf16 v[138:141], v[98:101], v[218:221], v[138:141]
    ds_read_b128 v[234:237], v0 offset:20608
    v_fmac_f32 v255, v162, v162
    v_mfma_f32_16x16x32_bf16 v[198:201], v[28:31], v[36:39], 0
    ds_read_b128 v[214:217], v9
    v_fmac_f32 v255, v163, v163
    v_mfma_f32_16x16x32_bf16 v[198:201], v[28:31], v[226:229], v[198:201]
    ds_read_b128 v[194:197], v9 offset:64
    v_fmac_f32 v255, v164, v164
    v_mfma_f32_16x16x32_bf16 v[170:173], v[142:145], v[36:39], 0
    v_rcp_f32 v178, v178
    v_mfma_f32_16x16x32_bf16 v[170:173], v[126:129], v[226:229], v[170:173]
    v_fmac_f32 v255, v165, v165
    v_mul_f32 v146, v178, v146
    v_mfma_f32_16x16x32_bf16 v[218:221], v[210:213], v[36:39], 0
    v_rcp_f32 v198, v198
    v_mfma_f32_16x16x32_bf16 v[218:221], v[130:133], v[226:229], v[218:221]
    s_waitcnt lgkmcnt(4)
    v_mul_f32 v147, v178, v147
    v_cvt_pk_bf16_f32 v146, v146, v147
    v_mfma_f32_16x16x32_bf16 v[174:177], v[238:241], v[36:39], 0
    s_waitcnt lgkmcnt(3)
    v_mul_f32 v170, v198, v170
    v_mul_f32 v171, v198, v171
    v_mfma_f32_16x16x32_bf16 v[174:177], v[190:193], v[226:229], v[174:177]
    s_waitcnt lgkmcnt(2)
    v_cvt_pk_bf16_f32 v226, v170, v171
    v_mul_f32 v172, v198, v172
    v_mfma_f32_16x16x32_bf16 v[138:141], v[102:105], v[158:161], v[138:141]
    s_waitcnt lgkmcnt(1)
    ds_read_b128 v[158:161], v1 offset:20608
    v_mul_f32 v173, v198, v173
    v_mfma_f32_16x16x32_bf16 v[138:141], v[106:109], v[206:209], v[138:141]
    s_waitcnt lgkmcnt(1)
    ds_read_b128 v[182:185], v0 offset:20736
    v_cvt_pk_bf16_f32 v227, v172, v173
    v_mfma_f32_16x16x32_bf16 v[138:141], v[110:113], v[242:245], v[138:141]
    ds_read_b128 v[206:209], v1 offset:20736
    v_mul_f32 v218, v198, v218
    v_mfma_f32_16x16x32_bf16 v[242:245], v[214:217], v[28:31], 0
    v_mul_f32 v219, v198, v219
    v_cvt_pk_bf16_f32 v228, v218, v219
    v_mfma_f32_16x16x32_bf16 v[242:245], v[194:197], v[28:31], v[242:245]
    v_mul_f32 v220, v198, v220
    v_mul_f32 v221, v198, v221
    v_mfma_f32_16x16x32_bf16 v[170:173], v[214:217], v[126:129], 0
    v_fmac_f32 v255, v138, v138
    v_fmac_f32 v255, v139, v139
    v_mfma_f32_16x16x32_bf16 v[170:173], v[194:197], v[142:145], v[170:173]
    v_fmac_f32 v255, v140, v140
    v_fmac_f32 v255, v141, v141
    v_mfma_f32_16x16x32_bf16 v[126:129], v[214:217], v[130:133], 0
    v_cvt_pk_bf16_f32 v255, v255, v255
    v_cvt_pk_bf16_f32 v229, v220, v221
    v_mfma_f32_16x16x32_bf16 v[126:129], v[194:197], v[210:213], v[126:129]
    s_waitcnt lgkmcnt(2)
    ds_write_b128 v3, v[226:229] offset:12288
    v_mfma_f32_16x16x32_bf16 v[130:133], v[214:217], v[190:193], 0
    s_waitcnt lgkmcnt(1)
    v_rcp_f32 v242, v242
    v_mfma_f32_16x16x32_bf16 v[130:133], v[194:197], v[238:241], v[130:133]
    v_mul_f32 v170, v170, v242
    v_mul_f32 v174, v198, v174
    v_mfma_f32_16x16x32_bf16 v[190:193], a[72:75], v[186:189], 0
    ds_write_b64 v4, v[254:255] offset:18432
    v_mfma_f32_16x16x32_bf16 v[190:193], a[76:79], v[118:121], v[190:193]
    v_mul_f32_dpp v170, v126, v242 quad_perm:[0,1,2,3] row_mask:0x2 bank_mask:0xf
    v_mul_f32 v175, v198, v175
    v_mfma_f32_16x16x32_bf16 v[190:193], a[80:83], v[234:237], v[190:193]
    v_mul_f32_dpp v170, v130, v242 quad_perm:[0,1,2,3] row_mask:0x4 bank_mask:0xf
    v_cvt_pk_bf16_f32 v170, v170, v170
    v_mfma_f32_16x16x32_bf16 v[190:193], a[84:87], v[158:161], v[190:193]
    ds_write_b16 v7, v170
    v_mfma_f32_16x16x32_bf16 v[190:193], a[88:91], v[182:185], v[190:193]
    v_cvt_pk_bf16_f32 v254, v174, v175
    v_mul_f32 v176, v198, v176
    v_mfma_f32_16x16x32_bf16 v[190:193], a[92:95], v[206:209], v[190:193]
    v_mul_f32 v177, v198, v177
    v_cvt_pk_bf16_f32 v255, v176, v177
    v_mfma_f32_16x16x32_bf16 v[130:133], a[96:99], v[186:189], 0
    ds_write_b64 v4, v[254:255] offset:16384
    v_mfma_f32_16x16x32_bf16 v[130:133], a[100:103], v[118:121], v[130:133]
    v_mul_f32 v148, v178, v148
    v_mul_f32 v149, v178, v149
    v_mfma_f32_16x16x32_bf16 v[130:133], a[104:107], v[234:237], v[130:133]
    v_cvt_pk_bf16_f32 v147, v148, v149
    v_mul_f32 v246, v178, v246
    v_mfma_f32_16x16x32_bf16 v[130:133], a[108:111], v[158:161], v[130:133]
    v_mul_f32 v247, v178, v247
    v_cvt_pk_bf16_f32 v148, v246, v247
    v_mfma_f32_16x16x32_bf16 v[130:133], a[112:115], v[182:185], v[130:133]
    v_mul_f32 v248, v178, v248
    v_mul_f32 v249, v178, v249
    v_mfma_f32_16x16x32_bf16 v[130:133], a[116:119], v[206:209], v[130:133]
    v_cvt_pk_bf16_f32 v149, v248, v249
    v_mul_f32 v222, v178, v222
    v_mfma_f32_16x16x32_bf16 v[126:129], a[120:123], v[186:189], 0
    ds_write_b128 v3, v[146:149] offset:0
    v_mfma_f32_16x16x32_bf16 v[126:129], a[124:127], v[118:121], v[126:129]
    v_mul_f32 v223, v178, v223
    v_cvt_pk_bf16_f32 v254, v222, v223
    v_mfma_f32_16x16x32_bf16 v[126:129], a[128:131], v[234:237], v[126:129]
    v_mul_f32 v224, v178, v224
    v_mul_f32 v225, v178, v225
    v_mfma_f32_16x16x32_bf16 v[126:129], a[132:135], v[158:161], v[126:129]
    v_cvt_pk_bf16_f32 v255, v224, v225
    v_xor_b32 v3, 65536, v3
    v_mfma_f32_16x16x32_bf16 v[126:129], a[136:139], v[182:185], v[126:129]
    ds_write_b64 v4, v[254:255] offset:4096
    v_mfma_f32_16x16x32_bf16 v[126:129], a[140:143], v[206:209], v[126:129]
    v_xor_b32 v4, 65536, v4
    v_cvt_pk_f16_f32 v194, v190, v191
    v_mfma_f32_16x16x32_bf16 v[142:145], a[0:3], v[186:189], 0
    v_pk_mul_f16 v191, v194, v194
    v_cvt_pk_f16_f32 v195, v192, v193
    v_mfma_f32_16x16x32_bf16 v[142:145], a[4:7], v[118:121], v[142:145]
    v_pk_fma_f16 v191, v195, v195, v191
    v_cvt_pk_f16_f32 v196, v130, v131
    v_mfma_f32_16x16x32_bf16 v[142:145], a[8:11], v[234:237], v[142:145]
    v_pk_fma_f16 v191, v196, v196, v191
    v_cvt_pk_f16_f32 v197, v132, v133
    v_mfma_f32_16x16x32_bf16 v[142:145], a[12:15], v[158:161], v[142:145]
    v_pk_fma_f16 v191, v197, v197, v191
    v_cvt_pk_f16_f32 v148, v126, v127
    v_mfma_f32_16x16x32_bf16 v[142:145], a[16:19], v[182:185], v[142:145]
    v_pk_fma_f16 v191, v148, v148, v191
    v_cvt_pk_f16_f32 v149, v128, v129
    v_mfma_f32_16x16x32_bf16 v[142:145], a[20:23], v[206:209], v[142:145]
    s_waitcnt lgkmcnt(0)
    v_pk_fma_f16 v191, v149, v149, v191
    v_add_u32 v7, s76, v7
    v_mfma_f32_16x16x32_bf16 v[126:129], a[24:27], v[186:189], 0
    s_barrier
    v_mfma_f32_16x16x32_bf16 v[126:129], a[28:31], v[118:121], v[126:129]
    s_nop 0
    v_mfma_f32_16x16x32_bf16 v[126:129], a[32:35], v[234:237], v[126:129]
    s_nop 0
    v_mfma_f32_16x16x32_bf16 v[126:129], a[36:39], v[158:161], v[126:129]
    s_nop 0
    v_mfma_f32_16x16x32_bf16 v[126:129], a[40:43], v[182:185], v[126:129]
    v_mfma_f32_16x16x32_bf16 v[126:129], a[44:47], v[206:209], v[126:129]
    s_cbranch_scc1 L_loop_fast0
    s_branch L_final_fast
.p2align 6
L_loop_fast1:
    v_mfma_f32_16x16x32_bf16 v[130:133], a[48:51], v[186:189], 0
    s_add_u32 s12, s40, s27
    ds_read_b128 v[246:249], v2 offset:18432
    v_cvt_pk_f16_f32 v222, v142, v143
    v_mfma_f32_16x16x32_bf16 v[130:133], a[52:55], v[118:121], v[130:133]
    s_addc_u32 s13, s41, 0
    ds_read_b128 v[210:213], v2 offset:19456
    v_pk_mul_f16 v190, v222, v222
    v_mfma_f32_16x16x32_bf16 v[130:133], a[56:59], v[234:237], v[130:133]
    s_sub_u32 s14, s36, s27
    ds_read_b128 v[238:241], v5 offset:32
    v_cvt_pk_f16_f32 v223, v144, v145
    v_mfma_f32_16x16x32_bf16 v[130:133], a[60:63], v[158:161], v[130:133]
    s_cmp_ge_u32 s18, 2
    ds_read2_b64 v[226:229], v5 offset0:6 offset1:9
    v_pk_fma_f16 v190, v223, v223, v190
    v_mfma_f32_16x16x32_bf16 v[130:133], a[64:67], v[182:185], v[130:133]
    s_cselect_b32 s14, s14, 0
    ds_read_b128 v[142:145], v5
    v_cvt_pk_f16_f32 v224, v126, v127
    v_mfma_f32_16x16x32_bf16 v[130:133], a[68:71], v[206:209], v[130:133]
    s_sub_u32 s82, s72, s71
    ds_read_b32 v254, v6 offset:192
    v_pk_fma_f16 v190, v224, v224, v190
    v_mfma_f32_16x16x32_bf16 v[198:201], v[186:189], a[144:147], 0
    s_mul_i32 s74, s82, 336
    v_cvt_pk_f16_f32 v225, v128, v129
    v_pk_fma_f16 v190, v225, v225, v190
    v_mfma_f32_16x16x32_bf16 v[198:201], v[118:121], a[148:151], v[198:201]
    s_mul_i32 s75, s82, 272
    v_cvt_pk_f16_f32 v146, v130, v131
    v_pk_fma_f16 v190, v146, v146, v190
    v_mfma_f32_16x16x32_bf16 v[198:201], v[234:237], a[152:155], v[198:201]
    s_waitcnt lgkmcnt(5)
    v_cvt_pk_f16_f32 v147, v132, v133
    v_pk_fma_f16 v190, v147, v147, v190
    v_mfma_f32_16x16x32_bf16 v[130:133], v[32:35], v[246:249], 0
    s_waitcnt lgkmcnt(4)
    v_add_u32 v5, s74, v5
    s_mul_i32 s76, s82, 16
    v_mfma_f32_16x16x32_bf16 v[130:133], v[32:35], v[210:213], v[130:133]
    s_waitcnt lgkmcnt(3)
    v_pk_mul_f16 v193, v194, v238
    v_pk_fma_f16 v193, v195, v239, v193
    v_mfma_f32_16x16x32_bf16 v[198:201], v[158:161], a[156:159], v[198:201]
    s_add_u32 s34, s18, 2
    v_pk_fma_f16 v193, v196, v240, v193
    v_pk_fma_f16 v193, v197, v241, v193
    v_mfma_f32_16x16x32_bf16 v[198:201], v[182:185], a[160:163], v[198:201]
    s_waitcnt lgkmcnt(1)
    v_pk_fma_f16 v193, v148, v228, v193
    v_pk_fma_f16 v193, v149, v229, v193
    v_mfma_f32_16x16x32_bf16 v[198:201], v[206:209], a[164:167], v[198:201]
    s_waitcnt lgkmcnt(0)
    v_mov_b32_dpp v254, v23 quad_perm:[0,1,2,3] row_mask:0x7 bank_mask:0xf
    v_pk_mul_f16 v192, v222, v142
    v_mfma_f32_16x16x32_bf16 v[210:213], v[186:189], a[168:171], 0
    s_add_u32 s8, s60, s23
    v_pk_fma_f16 v192, v223, v143, v192
    v_pk_fma_f16 v192, v224, v144, v192
    v_mfma_f32_16x16x32_bf16 v[210:213], v[118:121], a[172:175], v[210:213]
    s_addc_u32 s9, s61, 0
    v_pk_fma_f16 v192, v225, v145, v192
    v_pk_fma_f16 v192, v146, v226, v192
    v_mfma_f32_16x16x32_bf16 v[210:213], v[234:237], a[176:179], v[210:213]
    s_sub_u32 s10, s36, s23
    ds_read_b128 v[246:249], v0 offset:26624
    v_pk_fma_f16 v192, v147, v227, v192
    v_mfma_f32_16x16x32_bf16 v[210:213], v[158:161], a[180:183], v[210:213]
    s_cmp_le_u32 s34, s45
    ds_read_b128 v[174:177], v1 offset:26624
    v_cvt_pk_bf16_f32 v126, v198, v199
    v_mfma_f32_16x16x32_f16 v[214:217], v[40:43], v[190:193], 0
    s_cselect_b32 s10, s10, 0
    v_cvt_pk_bf16_f32 v127, v200, v201
    v_mul_f32 v255, 0x3baaaaab, v130
    v_mfma_f32_16x16x32_bf16 v[210:213], v[182:185], a[184:187], v[210:213]
    s_add_u32 m0, s28, 0
    ds_read_b128 v[198:201], v0 offset:26752
    v_mul_f32 v134, 0x3baaaaab, v131
    v_mfma_f32_16x16x32_bf16 v[210:213], v[206:209], a[188:191], v[210:213]
    s_mov_b32 s27, s26
    ds_read_b128 v[242:245], v1 offset:26752
    v_mul_f32 v132, 0x3baaaaab, v132
    v_mfma_f32_16x16x32_bf16 v[190:193], v[186:189], a[192:195], 0
    s_mov_b32 s26, s25
    ds_read_b128 v[186:189], v0 offset:26880
    s_mov_b32 s25, s24
    v_mfma_f32_16x16x32_bf16 v[190:193], v[118:121], a[196:199], v[190:193]
    s_mov_b32 s24, s23
    ds_read_b128 v[118:121], v1 offset:26880
    v_cvt_pk_bf16_f32 v130, v210, v211
    v_mfma_f32_16x16x32_bf16 v[190:193], v[234:237], a[200:203], v[190:193]
    s_ff1_i32_b32 s80, s100
    v_rsq_f32 v214, v214
    v_mfma_f32_16x16x32_bf16 v[190:193], v[158:161], a[204:207], v[190:193]
    s_waitcnt lgkmcnt(5)
    v_rsq_f32 v215, v215
    v_mfma_f32_16x16x32_bf16 v[190:193], v[182:185], a[208:211], v[190:193]
    s_mov_b32 s71, s72
    v_mul_f32 v128, s31, v214
    v_cvt_pk_f16_f32 v129, v128, v215
    v_mfma_f32_16x16x32_bf16 v[190:193], v[206:209], a[212:215], v[190:193]
    s_mov_b32 s72, s73
    v_cvt_pk_bf16_f32 v131, v212, v213
    v_fma_f32 v216, v216, v128, v22
    v_mfma_f32_16x16x32_bf16 v[210:213], a[72:75], v[246:249], 0
    s_waitcnt lgkmcnt(3)
    v_fmac_f32_dpp v254, v217, v215 quad_perm:[0,1,2,3] row_mask:0x1 bank_mask:0xf
    v_pk_mul_f16 v194, v194, v129 op_sel:[0,1] op_sel_hi:[1,1]
    v_mfma_f32_16x16x32_bf16 v[210:213], a[76:79], v[174:177], v[210:213]
    s_waitcnt lgkmcnt(2)
    v_cvt_pk_bf16_f32 v190, v190, v191
    v_cvt_pk_bf16_f32 v191, v192, v193
    v_mfma_f32_16x16x32_bf16 v[210:213], a[80:83], v[198:201], v[210:213]
    s_waitcnt lgkmcnt(1)
    v_pk_mul_f16 v195, v195, v129 op_sel:[0,1] op_sel_hi:[1,1]
    v_pk_mul_f16 v196, v196, v129 op_sel:[0,1] op_sel_hi:[1,1]
    v_mfma_f32_16x16x32_bf16 v[210:213], a[84:87], v[242:245], v[210:213]
    s_waitcnt lgkmcnt(0)
    v_pk_mul_f16 v197, v197, v129 op_sel:[0,1] op_sel_hi:[1,1]
    v_pk_mul_f16 v148, v148, v129 op_sel:[0,1] op_sel_hi:[1,1]
    v_mfma_f32_16x16x32_bf16 v[210:213], a[88:91], v[186:189], v[210:213]
    v_pk_mul_f16 v149, v149, v129 op_sel:[0,1] op_sel_hi:[1,1]
    v_pk_mul_f16 v222, v222, v129 op_sel:[0,0] op_sel_hi:[1,0]
    v_mfma_f32_16x16x32_bf16 v[210:213], a[92:95], v[118:121], v[210:213]
    v_pk_mul_f16 v223, v223, v129 op_sel:[0,0] op_sel_hi:[1,0]
    v_pk_mul_f16 v224, v224, v129 op_sel:[0,0] op_sel_hi:[1,0]
    v_mfma_f32_16x16x32_bf16 v[206:209], a[96:99], v[246:249], 0
    v_pk_mul_f16 v225, v225, v129 op_sel:[0,0] op_sel_hi:[1,0]
    v_pk_mul_f16 v146, v146, v129 op_sel:[0,0] op_sel_hi:[1,0]
    v_mfma_f32_16x16x32_bf16 v[206:209], a[100:103], v[174:177], v[206:209]
    v_pk_mul_f16 v147, v147, v129 op_sel:[0,0] op_sel_hi:[1,0]
    v_max3_u32 v44, v44, v214, v215
    v_mfma_f32_16x16x32_bf16 v[206:209], a[104:107], v[198:201], v[206:209]
    v_rsq_f32 v255, v255
    v_mfma_f32_16x16x32_bf16 v[206:209], a[108:111], v[242:245], v[206:209]
    v_rsq_f32 v134, v134
    v_mfma_f32_16x16x32_bf16 v[206:209], a[112:115], v[186:189], v[206:209]
    v_rsq_f32 v132, v132
    v_mfma_f32_16x16x32_bf16 v[206:209], a[116:119], v[118:121], v[206:209]
    v_mul_f32 v122, v255, v122
    v_mul_f32 v123, v255, v123
    v_mfma_f32_16x16x32_bf16 v[234:237], a[120:123], v[246:249], 0
    v_cvt_pk_bf16_f32 v122, v122, v123
    v_mul_f32 v124, v255, v124
    v_mfma_f32_16x16x32_bf16 v[234:237], a[124:127], v[174:177], v[234:237]
    v_mul_f32 v125, v255, v125
    v_cvt_pk_bf16_f32 v123, v124, v125
    v_mfma_f32_16x16x32_bf16 v[234:237], a[128:131], v[198:201], v[234:237]
    v_mul_f32 v154, v255, v154
    v_mul_f32 v155, v255, v155
    v_mfma_f32_16x16x32_bf16 v[234:237], a[132:135], v[242:245], v[234:237]
    v_cvt_pk_bf16_f32 v124, v154, v155
    v_mul_f32 v156, v255, v156
    v_mfma_f32_16x16x32_bf16 v[234:237], a[136:139], v[186:189], v[234:237]
    v_mul_f32 v157, v255, v157
    v_cvt_pk_bf16_f32 v125, v156, v157
    v_mfma_f32_16x16x32_bf16 v[234:237], a[140:143], v[118:121], v[234:237]
    buffer_store_dwordx4 v[122:125], v15, s[12:15], 0 offen nt
    v_mul_f32 v202, v255, v202
    v_mul_f32 v203, v255, v203
    v_cvt_pk_bf16_f32 v128, v202, v203
    v_mul_f32 v204, v255, v204
    v_mfma_f32_16x16x32_bf16 v[122:125], a[0:3], v[246:249], 0
    v_mul_f32 v205, v255, v205
    v_cvt_pk_bf16_f32 v129, v204, v205
    v_mfma_f32_16x16x32_bf16 v[122:125], a[4:7], v[174:177], v[122:125]
    v_cvt_pk_f16_f32 v202, v210, v211
    v_pk_mul_f16 v211, v202, v202
    v_mfma_f32_16x16x32_bf16 v[122:125], a[8:11], v[198:201], v[122:125]
    v_cvt_pk_f16_f32 v203, v212, v213
    v_pk_fma_f16 v211, v203, v203, v211
    v_mfma_f32_16x16x32_bf16 v[122:125], a[12:15], v[242:245], v[122:125]
    v_cvt_pk_f16_f32 v204, v206, v207
    v_pk_fma_f16 v211, v204, v204, v211
    v_mfma_f32_16x16x32_bf16 v[122:125], a[16:19], v[186:189], v[122:125]
    v_cvt_pk_f16_f32 v205, v208, v209
    v_pk_fma_f16 v211, v205, v205, v211
    v_mfma_f32_16x16x32_bf16 v[122:125], a[20:23], v[118:121], v[122:125]
    v_cvt_pk_f16_f32 v160, v234, v235
    v_pk_fma_f16 v211, v160, v160, v211
    v_mfma_f32_16x16x32_bf16 v[154:157], a[24:27], v[246:249], 0
    v_cvt_pk_f16_f32 v161, v236, v237
    v_pk_fma_f16 v211, v161, v161, v211
    v_mfma_f32_16x16x32_bf16 v[154:157], a[28:31], v[174:177], v[154:157]
    v_pk_mul_f16 v213, v202, v238
    v_pk_fma_f16 v213, v203, v239, v213
    v_mfma_f32_16x16x32_bf16 v[154:157], a[32:35], v[198:201], v[154:157]
    v_cvt_pk_f16_f32 v122, v122, v123
    v_pk_mul_f16 v210, v122, v122
    v_mfma_f32_16x16x32_bf16 v[154:157], a[36:39], v[242:245], v[154:157]
    v_cvt_pk_f16_f32 v123, v124, v125
    v_pk_fma_f16 v210, v123, v123, v210
    v_mfma_f32_16x16x32_bf16 v[154:157], a[40:43], v[186:189], v[154:157]
    v_pk_mul_f16 v212, v122, v142
    v_pk_fma_f16 v212, v123, v143, v212
    v_mfma_f32_16x16x32_bf16 v[154:157], a[44:47], v[118:121], v[154:157]
    v_pk_fma_f16 v213, v204, v240, v213
    v_pk_fma_f16 v213, v205, v241, v213
    v_mfma_f32_16x16x32_bf16 v[206:209], a[48:51], v[246:249], 0
    v_pk_fma_f16 v213, v160, v228, v213
    v_pk_fma_f16 v213, v161, v229, v213
    v_mfma_f32_16x16x32_bf16 v[206:209], a[52:55], v[174:177], v[206:209]
    v_mul_f32 v150, v132, v150
    v_mul_f32 v151, v132, v151
    v_mfma_f32_16x16x32_bf16 v[206:209], a[56:59], v[198:201], v[206:209]
    v_cvt_pk_f16_f32 v124, v154, v155
    v_pk_fma_f16 v210, v124, v124, v210
    v_mfma_f32_16x16x32_bf16 v[206:209], a[60:63], v[242:245], v[206:209]
    v_cvt_pk_f16_f32 v125, v156, v157
    v_pk_fma_f16 v210, v125, v125, v210
    v_mfma_f32_16x16x32_bf16 v[206:209], a[64:67], v[186:189], v[206:209]
    buffer_store_dwordx2 v[128:129], v18, s[12:15], 0 offen nt
    v_pk_fma_f16 v212, v124, v144, v212
    v_pk_fma_f16 v212, v125, v145, v212
    v_mfma_f32_16x16x32_bf16 v[206:209], a[68:71], v[118:121], v[206:209]
    v_cvt_pk_bf16_f32 v150, v150, v151
    v_mul_f32 v152, v132, v152
    v_mfma_f32_16x16x32_bf16 v[154:157], v[246:249], a[144:147], 0
    v_mul_f32 v153, v132, v153
    v_cvt_pk_bf16_f32 v151, v152, v153
    v_mfma_f32_16x16x32_bf16 v[154:157], v[174:177], a[148:151], v[154:157]
    v_mul_f32 v162, v132, v162
    v_mul_f32 v163, v132, v163
    v_mfma_f32_16x16x32_bf16 v[154:157], v[198:201], a[152:155], v[154:157]
    v_cvt_pk_f16_f32 v158, v206, v207
    v_pk_fma_f16 v210, v158, v158, v210
    v_mfma_f32_16x16x32_bf16 v[154:157], v[242:245], a[156:159], v[154:157]
    v_cvt_pk_f16_f32 v159, v208, v209
    v_pk_fma_f16 v210, v159, v159, v210
    v_mfma_f32_16x16x32_bf16 v[154:157], v[186:189], a[160:163], v[154:157]
    v_pk_fma_f16 v212, v158, v226, v212
    v_pk_fma_f16 v212, v159, v227, v212
    v_mfma_f32_16x16x32_bf16 v[154:157], v[118:121], a[164:167], v[154:157]
    v_cvt_pk_bf16_f32 v152, v162, v163
    v_mul_f32 v164, v132, v164
    v_mfma_f32_16x16x32_f16 v[206:209], v[40:43], v[210:213], 0
    v_mul_f32 v165, v132, v165
    v_cvt_pk_bf16_f32 v153, v164, v165
    v_mfma_f32_16x16x32_bf16 v[210:213], v[246:249], a[168:171], 0
    v_mul_f32 v138, v132, v138
    v_mul_f32 v139, v132, v139
    v_mfma_f32_16x16x32_bf16 v[210:213], v[174:177], a[172:175], v[210:213]
    v_cvt_pk_bf16_f32 v128, v154, v155
    v_cvt_pk_bf16_f32 v129, v156, v157
    v_mfma_f32_16x16x32_bf16 v[210:213], v[198:201], a[176:179], v[210:213]
    ds_read_b128 v[154:157], v0 offset:32768
    v_cvt_pk_bf16_f32 v136, v138, v139
    v_mfma_f32_16x16x32_bf16 v[210:213], v[242:245], a[180:183], v[210:213]
    ds_read_b128 v[162:165], v1 offset:32768
    v_mul_f32 v140, v132, v140
    v_mfma_f32_16x16x32_bf16 v[210:213], v[186:189], a[184:187], v[210:213]
    ds_read_b128 v[218:221], v0 offset:32896
    v_mul_f32 v141, v132, v141
    v_mfma_f32_16x16x32_bf16 v[210:213], v[118:121], a[188:191], v[210:213]
    ds_read_b128 v[234:237], v1 offset:32896
    v_cvt_pk_bf16_f32 v137, v140, v141
    v_mfma_f32_16x16x32_bf16 v[182:185], v[246:249], a[192:195], 0
    ds_read_b128 v[138:141], v0 offset:33024
    v_mul_f32 v114, v134, v114
    v_mfma_f32_16x16x32_bf16 v[182:185], v[174:177], a[196:199], v[182:185]
    ds_read_b128 v[246:249], v1 offset:33024
    v_mul_f32 v115, v134, v115
    v_mfma_f32_16x16x32_bf16 v[182:185], v[198:201], a[200:203], v[182:185]
    buffer_store_dwordx4 v[150:153], v17, s[12:15], 0 offen nt
    v_rsq_f32 v206, v206
    v_rsq_f32 v207, v207
    v_mfma_f32_16x16x32_bf16 v[182:185], v[242:245], a[204:207], v[182:185]
    s_waitcnt lgkmcnt(5)
    v_mul_f32 v214, s31, v206
    v_cvt_pk_f16_f32 v215, v214, v207
    v_mfma_f32_16x16x32_bf16 v[182:185], v[186:189], a[208:211], v[182:185]
    s_waitcnt lgkmcnt(4)
    v_fma_f32 v208, v208, v214, v24
    v_fmac_f32_dpp v254, v209, v207 quad_perm:[0,1,2,3] row_mask:0x2 bank_mask:0xf
    v_mfma_f32_16x16x32_bf16 v[182:185], v[118:121], a[212:215], v[182:185]
    s_waitcnt lgkmcnt(3)
    v_cvt_pk_bf16_f32 v132, v210, v211
    v_cvt_pk_bf16_f32 v133, v212, v213
    v_mfma_f32_16x16x32_bf16 v[210:213], a[72:75], v[154:157], 0
    s_waitcnt lgkmcnt(2)
    v_pk_mul_f16 v202, v202, v215 op_sel:[0,1] op_sel_hi:[1,1]
    v_pk_mul_f16 v203, v203, v215 op_sel:[0,1] op_sel_hi:[1,1]
    v_mfma_f32_16x16x32_bf16 v[210:213], a[76:79], v[162:165], v[210:213]
    s_waitcnt lgkmcnt(1)
    v_cvt_pk_bf16_f32 v192, v182, v183
    v_cvt_pk_bf16_f32 v193, v184, v185
    v_mfma_f32_16x16x32_bf16 v[210:213], a[80:83], v[218:221], v[210:213]
    s_waitcnt lgkmcnt(0)
    v_pk_mul_f16 v204, v204, v215 op_sel:[0,1] op_sel_hi:[1,1]
    v_pk_mul_f16 v205, v205, v215 op_sel:[0,1] op_sel_hi:[1,1]
    v_mfma_f32_16x16x32_bf16 v[210:213], a[84:87], v[234:237], v[210:213]
    v_pk_mul_f16 v160, v160, v215 op_sel:[0,1] op_sel_hi:[1,1]
    v_pk_mul_f16 v161, v161, v215 op_sel:[0,1] op_sel_hi:[1,1]
    v_mfma_f32_16x16x32_bf16 v[210:213], a[88:91], v[138:141], v[210:213]
    v_pk_mul_f16 v122, v122, v215 op_sel:[0,0] op_sel_hi:[1,0]
    v_pk_mul_f16 v123, v123, v215 op_sel:[0,0] op_sel_hi:[1,0]
    v_mfma_f32_16x16x32_bf16 v[210:213], a[92:95], v[246:249], v[210:213]
    v_pk_mul_f16 v124, v124, v215 op_sel:[0,0] op_sel_hi:[1,0]
    v_pk_mul_f16 v125, v125, v215 op_sel:[0,0] op_sel_hi:[1,0]
    v_mfma_f32_16x16x32_bf16 v[118:121], a[96:99], v[154:157], 0
    v_pk_mul_f16 v158, v158, v215 op_sel:[0,0] op_sel_hi:[1,0]
    v_pk_mul_f16 v159, v159, v215 op_sel:[0,0] op_sel_hi:[1,0]
    v_mfma_f32_16x16x32_bf16 v[118:121], a[100:103], v[162:165], v[118:121]
    v_max3_u32 v44, v44, v206, v207
    v_cvt_pk_bf16_f32 v114, v114, v115
    v_mfma_f32_16x16x32_bf16 v[118:121], a[104:107], v[218:221], v[118:121]
    v_cvt_pk_f16_f32 v186, v210, v211
    v_pk_mul_f16 v211, v186, v186
    v_mfma_f32_16x16x32_bf16 v[118:121], a[108:111], v[234:237], v[118:121]
    s_waitcnt vmcnt(3)
    ds_write_b16 v8, v45 offset:512
    v_mfma_f32_16x16x32_bf16 v[118:121], a[112:115], v[138:141], v[118:121]
    v_cvt_pk_f16_f32 v187, v212, v213
    v_mfma_f32_16x16x32_bf16 v[118:121], a[116:119], v[246:249], v[118:121]
    v_pk_fma_f16 v211, v187, v187, v211
    v_pk_mul_f16 v213, v186, v238
    v_mfma_f32_16x16x32_bf16 v[150:153], a[120:123], v[154:157], 0
    v_pk_fma_f16 v213, v187, v239, v213
    v_mul_f32 v116, v134, v116
    v_mfma_f32_16x16x32_bf16 v[150:153], a[124:127], v[162:165], v[150:153]
    buffer_store_dwordx2 v[136:137], v20, s[12:15], 0 offen nt
    v_exp_f32 v208, v208
    v_mfma_f32_16x16x32_bf16 v[150:153], a[128:131], v[218:221], v[150:153]
    v_cvt_pk_f16_f32 v188, v118, v119
    v_pk_fma_f16 v211, v188, v188, v211
    v_mfma_f32_16x16x32_bf16 v[150:153], a[132:135], v[234:237], v[150:153]
    v_cvt_pk_f16_f32 v189, v120, v121
    v_pk_fma_f16 v211, v189, v189, v211
    v_mfma_f32_16x16x32_bf16 v[150:153], a[136:139], v[138:141], v[150:153]
    s_waitcnt lgkmcnt(0)
    v_pk_fma_f16 v213, v188, v240, v213
    v_pk_fma_f16 v213, v189, v241, v213
    v_mfma_f32_16x16x32_bf16 v[150:153], a[140:143], v[246:249], v[150:153]
    v_mul_f32 v117, v134, v117
    v_mfma_f32_16x16x32_bf16 v[238:241], a[0:3], v[154:157], 0
    s_barrier
    v_cvt_pk_bf16_f32 v115, v116, v117
    v_mfma_f32_16x16x32_bf16 v[238:241], a[4:7], v[162:165], v[238:241]
    v_mul_f32 v166, v134, v166
    v_mfma_f32_16x16x32_bf16 v[238:241], a[8:11], v[218:221], v[238:241]
    ds_read_u16 v255, v9 offset:384
    v_mfma_f32_16x16x32_bf16 v[238:241], a[12:15], v[234:237], v[238:241]
    v_cvt_pk_f16_f32 v120, v150, v151
    v_pk_fma_f16 v211, v120, v120, v211
    v_mfma_f32_16x16x32_bf16 v[238:241], a[16:19], v[138:141], v[238:241]
    v_cvt_pk_f16_f32 v121, v152, v153
    v_pk_fma_f16 v211, v121, v121, v211
    v_mfma_f32_16x16x32_bf16 v[238:241], a[20:23], v[246:249], v[238:241]
    v_pk_fma_f16 v213, v120, v228, v213
    v_pk_fma_f16 v213, v121, v229, v213
    v_mfma_f32_16x16x32_bf16 v[150:153], a[24:27], v[154:157], 0
    v_exp_f32 v216, v216
    v_mfma_f32_16x16x32_bf16 v[150:153], a[28:31], v[162:165], v[150:153]
    v_cvt_pk_bf16_f32 v39, v216, 0
    v_mul_f32 v167, v134, v167
    v_mfma_f32_16x16x32_bf16 v[150:153], a[32:35], v[218:221], v[150:153]
    v_cvt_pk_f16_f32 v198, v238, v239
    v_pk_mul_f16 v210, v198, v198
    v_mfma_f32_16x16x32_bf16 v[150:153], a[36:39], v[234:237], v[150:153]
    v_cvt_pk_f16_f32 v199, v240, v241
    v_pk_fma_f16 v210, v199, v199, v210
    v_mfma_f32_16x16x32_bf16 v[150:153], a[40:43], v[138:141], v[150:153]
    s_waitcnt lgkmcnt(0)
    v_readfirstlane_b32 s77, v255
    v_pk_mul_f16 v212, v198, v142
    v_mfma_f32_16x16x32_bf16 v[150:153], a[44:47], v[246:249], v[150:153]
    v_pk_fma_f16 v212, v199, v143, v212
    v_cvt_pk_bf16_f32 v116, v166, v167
    v_mfma_f32_16x16x32_bf16 v[238:241], a[48:51], v[154:157], 0
    buffer_load_dwordx4 v10, s[8:11], 0 offen nt lds
    v_mul_f32 v168, v134, v168
    v_mfma_f32_16x16x32_bf16 v[238:241], a[52:55], v[162:165], v[238:241]
    s_add_u32 m0, s28, 4096
    v_mul_f32 v169, v134, v169
    v_cvt_pk_f16_f32 v200, v150, v151
    v_mfma_f32_16x16x32_bf16 v[238:241], a[56:59], v[218:221], v[238:241]
    v_pk_fma_f16 v210, v200, v200, v210
    v_cvt_pk_f16_f32 v201, v152, v153
    v_mfma_f32_16x16x32_bf16 v[238:241], a[60:63], v[234:237], v[238:241]
    ds_read_b128 v[242:245], v2 offset:0
    v_pk_fma_f16 v210, v201, v201, v210
    v_mfma_f32_16x16x32_bf16 v[238:241], a[64:67], v[138:141], v[238:241]
    ds_read_b128 v[174:177], v2 offset:1024
    v_pk_fma_f16 v212, v200, v144, v212
    v_mfma_f32_16x16x32_bf16 v[238:241], a[68:71], v[246:249], v[238:241]
    ds_read_b128 v[170:173], v2 offset:2048
    buffer_load_dwordx4 v11, s[8:11], 0 offen nt lds
    v_mfma_f32_16x16x32_bf16 v[150:153], v[154:157], a[144:147], 0
    s_add_u32 m0, s28, 8192
    ds_read_b128 v[214:217], v2 offset:3072
    v_pk_fma_f16 v212, v201, v145, v212
    v_mfma_f32_16x16x32_bf16 v[150:153], v[162:165], a[148:151], v[150:153]
    ds_read_b128 v[182:185], v2 offset:4096
    v_cvt_pk_f16_f32 v118, v238, v239
    v_mfma_f32_16x16x32_bf16 v[150:153], v[218:221], a[152:155], v[150:153]
    ds_read_b128 v[178:181], v2 offset:5120
    v_pk_fma_f16 v210, v118, v118, v210
    v_mfma_f32_16x16x32_bf16 v[150:153], v[234:237], a[156:159], v[150:153]
    v_cvt_pk_f16_f32 v119, v240, v241
    v_pk_fma_f16 v210, v119, v119, v210
    v_mfma_f32_16x16x32_bf16 v[150:153], v[138:141], a[160:163], v[150:153]
    buffer_load_dwordx4 v12, s[8:11], 0 offen nt lds
    v_pk_fma_f16 v212, v118, v226, v212
    v_mfma_f32_16x16x32_bf16 v[150:153], v[246:249], a[164:167], v[150:153]
    s_waitcnt lgkmcnt(5)
    v_pk_fma_f16 v212, v119, v227, v212
    v_cvt_pk_bf16_f32 v117, v168, v169
    v_mfma_f32_16x16x32_bf16 v[226:229], v[154:157], a[168:171], 0
    s_add_u32 m0, s28, 12288
    v_mul_f32 v230, v134, v230
    v_mul_f32 v231, v134, v231
    v_mfma_f32_16x16x32_f16 v[166:169], v[40:43], v[210:213], 0
    s_xor_b32 s28, s28, 65536
    v_cvt_pk_bf16_f32 v142, v150, v151
    v_cvt_pk_bf16_f32 v143, v152, v153
    v_mfma_f32_16x16x32_bf16 v[226:229], v[162:165], a[172:175], v[226:229]
    s_waitcnt lgkmcnt(2)
    ds_read2_b32 v[144:145], v6 offset0:0 offset1:0
    v_cvt_pk_bf16_f32 v230, v230, v231
    v_mfma_f32_16x16x32_bf16 v[226:229], v[218:221], a[176:179], v[226:229]
    s_waitcnt lgkmcnt(2)
    buffer_load_dwordx4 v13, s[8:11], 0 offen nt lds
    ds_read2_b32 v[212:213], v6 offset0:16 offset1:16
    v_mfma_f32_16x16x32_bf16 v[226:229], v[234:237], a[180:183], v[226:229]
    s_mov_b32 m0, s29
    ds_read2_b32 v[240:241], v6 offset0:32 offset1:32
    v_mul_f32 v232, v134, v232
    v_mfma_f32_16x16x32_bf16 v[226:229], v[138:141], a[184:187], v[226:229]
    s_xor_b32 s29, s29, s30
    v_rsq_f32 v166, v166
    v_mfma_f32_16x16x32_bf16 v[226:229], v[246:249], a[188:191], v[226:229]
    s_add_u32 s19, s19, s20
    v_rsq_f32 v167, v167
    v_mfma_f32_16x16x32_bf16 v[150:153], v[154:157], a[192:195], 0
    s_add_u32 s23, s23, s21
    v_mul_f32 v136, s31, v166
    v_cvt_pk_f16_f32 v137, v136, v167
    v_mfma_f32_16x16x32_bf16 v[150:153], v[162:165], a[196:199], v[150:153]
    s_waitcnt lgkmcnt(3)
    buffer_load_dwordx4 v14, s[8:11], 0 offen nt lds
    v_fma_f32 v168, v168, v136, v26
    v_mfma_f32_16x16x32_bf16 v[150:153], v[218:221], a[200:203], v[150:153]
    s_cmp_ge_u32 s19, 72
    v_fmac_f32_dpp v254, v169, v167 quad_perm:[0,1,2,3] row_mask:0x4 bank_mask:0xf
    v_cvt_pk_bf16_f32 v210, v226, v227
    v_mfma_f32_16x16x32_bf16 v[150:153], v[234:237], a[204:207], v[150:153]
    s_cselect_b32 s34, 72, 0
    v_cvt_pk_bf16_f32 v211, v228, v229
    v_pk_mul_f16 v186, v186, v137 op_sel:[0,1] op_sel_hi:[1,1]
    v_mfma_f32_16x16x32_bf16 v[150:153], v[138:141], a[208:211], v[150:153]
    s_cselect_b32 s35, s22, 0
    v_pk_mul_f16 v187, v187, v137 op_sel:[0,1] op_sel_hi:[1,1]
    v_pk_mul_f16 v188, v188, v137 op_sel:[0,1] op_sel_hi:[1,1]
    v_mfma_f32_16x16x32_bf16 v[150:153], v[246:249], a[212:215], v[150:153]
    s_sub_u32 s19, s19, s34
    v_pk_mul_f16 v189, v189, v137 op_sel:[0,1] op_sel_hi:[1,1]
    v_pk_mul_f16 v120, v120, v137 op_sel:[0,1] op_sel_hi:[1,1]
    v_mfma_f32_16x16x32_f16 v[154:157], v[194:197], v[222:225], v[46:49]
    s_waitcnt lgkmcnt(0)
    buffer_store_dwordx4 v[114:117], v16, s[12:15], 0 offen nt
    v_pk_mul_f16 v121, v121, v137 op_sel:[0,1] op_sel_hi:[1,1]
    v_pk_mul_f16 v198, v198, v137 op_sel:[0,0] op_sel_hi:[1,0]
    v_cvt_pk_bf16_f32 v238, v150, v151
    v_cvt_pk_bf16_f32 v239, v152, v153
    v_mfma_f32_16x16x32_f16 v[114:117], v[202:205], v[222:225], v[50:53]
    s_add_u32 s23, s23, s35
    v_pk_mul_f16 v199, v199, v137 op_sel:[0,0] op_sel_hi:[1,0]
    v_pk_mul_f16 v200, v200, v137 op_sel:[0,0] op_sel_hi:[1,0]
    v_mfma_f32_16x16x32_f16 v[246:249], v[186:189], v[222:225], v[54:57]
    s_cmp_lg_u32 s83, 0
    v_pk_mul_f16 v201, v201, v137 op_sel:[0,0] op_sel_hi:[1,0]
    v_pk_mul_f16 v118, v118, v137 op_sel:[0,0] op_sel_hi:[1,0]
    v_pk_mul_f16 v119, v119, v137 op_sel:[0,0] op_sel_hi:[1,0]
    v_mfma_f32_16x16x16_f16 v[154:157], v[148:149], v[146:147], v[154:157]
    v_max3_u32 v44, v44, v166, v167
    v_exp_f32 v254, v254
    v_mfma_f32_16x16x16_f16 v[114:117], v[160:161], v[146:147], v[114:117]
    v_cvt_pk_bf16_f32 v254, v254, v254
    v_exp_f32 v168, v168
    v_mfma_f32_16x16x16_f16 v[246:249], v[120:121], v[146:147], v[246:249]
    v_mul_f32 v233, v134, v233
    v_cvt_pk_bf16_f32 v231, v232, v233
    v_exp_f32 v154, v154
    v_mfma_f32_16x16x32_f16 v[162:165], v[194:197], v[122:125], v[58:61]
    s_cselect_b32 s77, s80, s77
    ds_write_b16 v8, v254
    v_mfma_f32_16x16x32_f16 v[138:141], v[202:205], v[122:125], v[62:65]
    s_mul_i32 s78, s77, 2688
    v_exp_f32 v155, v155
    v_mfma_f32_16x16x32_f16 v[234:237], v[186:189], v[122:125], v[66:69]
    s_add_u32 s78, s78, s69
    v_cvt_pk_bf16_f32 v218, v154, v155
    v_exp_f32 v156, v156
    v_mfma_f32_16x16x16_f16 v[162:165], v[148:149], v[158:159], v[162:165]
    v_exp_f32 v157, v157
    v_xor_b32 v0, 65536, v0
    v_mfma_f32_16x16x16_f16 v[138:141], v[160:161], v[158:159], v[138:141]
    v_cvt_pk_bf16_f32 v219, v156, v157
    v_exp_f32 v114, v114
    v_mfma_f32_16x16x16_f16 v[234:237], v[120:121], v[158:159], v[234:237]
    v_exp_f32 v115, v115
    v_exp_f32 v116, v116
    v_mfma_f32_16x16x32_bf16 v[122:125], a[216:219], v[242:245], 0
    s_add_u32 s80, s77, s68
    v_exp_f32 v162, v162
    v_mfma_f32_16x16x32_bf16 v[122:125], a[220:223], v[174:177], v[122:125]
    s_cmp_ge_u32 s80, 72
    v_exp_f32 v163, v163
    v_mfma_f32_16x16x32_f16 v[222:225], v[194:197], v[198:201], v[70:73]
    s_cselect_b32 s80, s22, 0
    v_cvt_pk_bf16_f32 v158, v162, v163
    v_cvt_pk_bf16_f32 v220, v114, v115
    v_mfma_f32_16x16x32_f16 v[134:137], v[202:205], v[198:201], v[74:77]
    s_add_u32 s78, s78, s80
    v_exp_f32 v164, v164
    v_mfma_f32_16x16x32_f16 v[194:197], v[186:189], v[198:201], v[78:81]
    buffer_store_dwordx2 v[230:231], v19, s[12:15], 0 offen nt
    v_exp_f32 v165, v165
    v_mfma_f32_16x16x16_f16 v[222:225], v[148:149], v[118:119], v[222:225]
    v_cvt_pk_bf16_f32 v159, v164, v165
    v_exp_f32 v138, v138
    v_mfma_f32_16x16x16_f16 v[134:137], v[160:161], v[118:119], v[134:137]
    v_exp_f32 v139, v139
    v_xor_b32 v1, 65536, v1
    v_mfma_f32_16x16x16_f16 v[194:197], v[120:121], v[118:119], v[194:197]
    v_cvt_pk_bf16_f32 v160, v138, v139
    v_exp_f32 v140, v140
    v_add_u32 v6, s75, v6
    v_mfma_f32_16x16x32_bf16 v[122:125], a[224:227], v[170:173], v[122:125]
    s_add_u32 s80, s77, 20
    v_exp_f32 v141, v141
    v_mfma_f32_16x16x32_bf16 v[122:125], a[228:231], v[214:217], v[122:125]
    s_add_u32 s34, s18, 3
    v_exp_f32 v234, v234
    v_mfma_f32_16x16x32_bf16 v[122:125], a[232:235], v[182:185], v[122:125]
    s_cmp_lt_u32 s77, s62
    v_exp_f32 v235, v235
    v_mfma_f32_16x16x32_bf16 v[122:125], a[236:239], v[178:181], v[122:125]
    s_cselect_b32 s79, 1, 0
    v_exp_f32 v236, v236
    v_mfma_f32_16x16x32_bf16 v[154:157], a[240:243], v[242:245], 0
    s_cselect_b32 s78, s78, 0
    ds_read_b128 v[150:153], v2 offset:6144
    v_cvt_pk_bf16_f32 v161, v140, v141
    v_mfma_f32_16x16x32_bf16 v[154:157], a[244:247], v[174:177], v[154:157]
    s_cmp_lt_u32 s34, s17
    ds_read_b128 v[162:165], v2 offset:7168
    v_fma_f32 v255, v122, v122, s33
    v_mfma_f32_16x16x32_bf16 v[154:157], a[248:251], v[170:173], v[154:157]
    s_cselect_b32 s23, s23, s78
    ds_read_b128 v[186:189], v2 offset:8192
    v_fmac_f32 v255, v123, v123
    v_mfma_f32_16x16x32_bf16 v[154:157], a[252:255], v[214:217], v[154:157]
    s_cselect_b32 s73, s34, s80
    ds_read_b128 v[138:141], v2 offset:9216
    v_fmac_f32 v255, v124, v124
    v_mfma_f32_16x16x32_bf16 v[154:157], v[82:85], v[182:185], v[154:157]
    s_cselect_b32 s79, 0, s79
    ds_read_b128 v[118:121], v2 offset:10240
    v_fmac_f32 v255, v125, v125
    v_mfma_f32_16x16x32_bf16 v[154:157], v[86:89], v[178:181], v[154:157]
    s_cselect_b32 s81, 0, 1
    ds_read_b128 v[198:201], v2 offset:11264
    s_add_u32 s80, s77, 1
    v_mfma_f32_16x16x32_bf16 v[202:205], v[90:93], v[242:245], 0
    s_mul_i32 s80, s80, s81
    v_exp_f32 v237, v237
    v_mfma_f32_16x16x32_bf16 v[202:205], v[94:97], v[174:177], v[202:205]
    s_cmp_lt_u32 s80, s62
    v_exp_f32 v117, v117
    v_mfma_f32_16x16x32_bf16 v[202:205], v[98:101], v[170:173], v[202:205]
    s_waitcnt lgkmcnt(5)
    v_cvt_pk_bf16_f32 v221, v116, v117
    v_fmac_f32 v255, v154, v154
    v_mfma_f32_16x16x32_bf16 v[202:205], v[102:105], v[214:217], v[202:205]
    s_cselect_b32 s70, s70, 0
    v_exp_f32 v246, v246
    v_mfma_f32_16x16x32_bf16 v[202:205], v[106:109], v[182:185], v[202:205]
    s_cselect_b32 s62, s62, 0
    v_exp_f32 v247, v247
    v_mfma_f32_16x16x32_bf16 v[202:205], v[110:113], v[178:181], v[202:205]
    s_add_u32 s80, s18, 4
    v_cvt_pk_bf16_f32 v36, v246, v247
    v_fmac_f32 v255, v155, v155
    v_mfma_f32_16x16x32_bf16 v[114:117], a[216:219], v[150:153], 0
    s_waitcnt lgkmcnt(1)
    v_exp_f32 v248, v248
    v_mfma_f32_16x16x32_bf16 v[114:117], a[220:223], v[162:165], v[114:117]
    s_cmp_ge_u32 s80, s17
    v_exp_f32 v249, v249
    v_mfma_f32_16x16x32_bf16 v[114:117], a[224:227], v[186:189], v[114:117]
    s_cselect_b32 s66, s70, 0
    v_cvt_pk_bf16_f32 v37, v248, v249
    v_fmac_f32 v255, v156, v156
    v_mfma_f32_16x16x32_bf16 v[114:117], a[228:231], v[138:141], v[114:117]
    s_waitcnt lgkmcnt(0)
    v_fmac_f32 v255, v157, v157
    v_mfma_f32_16x16x32_bf16 v[178:181], v[28:31], v[36:39], 0
    s_lshl_b32 s80, s79, s73
    v_exp_f32 v222, v222
    v_mfma_f32_16x16x32_bf16 v[178:181], v[28:31], v[218:221], v[178:181]
    s_or_b32 s63, s63, s80
    v_exp_f32 v223, v223
    v_mfma_f32_16x16x32_bf16 v[146:149], v[142:145], v[36:39], 0
    s_sub_u32 s80, s100, s81
    v_cvt_pk_bf16_f32 v226, v222, v223
    v_fmac_f32 v255, v202, v202
    v_mfma_f32_16x16x32_bf16 v[146:149], v[126:129], v[218:221], v[146:149]
    s_and_b32 s100, s100, s80
    v_exp_f32 v224, v224
    v_mfma_f32_16x16x32_bf16 v[246:249], v[210:213], v[36:39], 0
    s_add_u32 s45, s45, s79
    v_exp_f32 v225, v225
    v_mfma_f32_16x16x32_bf16 v[246:249], v[130:133], v[218:221], v[246:249]
    s_add_u32 s18, s18, 1
    v_cvt_pk_bf16_f32 v227, v224, v225
    v_fmac_f32 v255, v203, v203
    v_mfma_f32_16x16x32_bf16 v[222:225], v[238:241], v[36:39], 0
    s_cmp_lt_u32 s18, s45
    v_cvt_pk_bf16_f32 v36, v234, v235
    v_cvt_pk_bf16_f32 v37, v236, v237
    v_mfma_f32_16x16x32_bf16 v[222:225], v[190:193], v[218:221], v[222:225]
    v_cvt_pk_bf16_f32 v39, v208, 0
    v_fmac_f32 v255, v204, v204
    v_mfma_f32_16x16x32_bf16 v[114:117], a[232:235], v[118:121], v[114:117]
    v_exp_f32 v134, v134
    v_mfma_f32_16x16x32_bf16 v[182:185], v[28:31], v[36:39], 0
    v_exp_f32 v135, v135
    v_mfma_f32_16x16x32_bf16 v[182:185], v[28:31], v[158:161], v[182:185]
    v_cvt_pk_bf16_f32 v228, v134, v135
    v_fmac_f32 v255, v205, v205
    v_mfma_f32_16x16x32_bf16 v[230:233], v[142:145], v[36:39], 0
    v_exp_f32 v136, v136
    v_mfma_f32_16x16x32_bf16 v[230:233], v[126:129], v[158:161], v[230:233]
    v_exp_f32 v137, v137
    v_mfma_f32_16x16x32_bf16 v[170:173], v[210:213], v[36:39], 0
    v_exp_f32 v194, v194
    v_mfma_f32_16x16x32_bf16 v[170:173], v[130:133], v[158:161], v[170:173]
    v_rcp_f32 v182, v182
    v_mfma_f32_16x16x32_bf16 v[174:177], v[238:241], v[36:39], 0
    v_cvt_pk_bf16_f32 v229, v136, v137
    v_cvt_pk_bf16_f32 v39, v168, 0
    v_mfma_f32_16x16x32_bf16 v[174:177], v[190:193], v[158:161], v[174:177]
    v_mul_f32 v230, v182, v230
    v_mul_f32 v231, v182, v231
    v_mfma_f32_16x16x32_bf16 v[114:117], a[236:239], v[198:201], v[114:117]
    v_cvt_pk_bf16_f32 v134, v230, v231
    v_mul_f32 v232, v182, v232
    v_mfma_f32_16x16x32_bf16 v[166:169], a[240:243], v[150:153], 0
    ds_read_b128 v[214:217], v2 offset:12288
    v_mul_f32 v233, v182, v233
    v_mfma_f32_16x16x32_bf16 v[166:169], a[244:247], v[162:165], v[166:169]
    ds_read_b128 v[234:237], v2 offset:13312
    v_cvt_pk_bf16_f32 v135, v232, v233
    v_mfma_f32_16x16x32_bf16 v[166:169], a[248:251], v[186:189], v[166:169]
    ds_read_b128 v[218:221], v2 offset:14336
    v_fma_f32 v254, v114, v114, s33
    v_mfma_f32_16x16x32_bf16 v[166:169], a[252:255], v[138:141], v[166:169]
    ds_read_b128 v[158:161], v2 offset:15360
    v_fmac_f32 v254, v115, v115
    v_mfma_f32_16x16x32_bf16 v[166:169], v[82:85], v[118:121], v[166:169]
    ds_read_b128 v[206:209], v2 offset:16384
    v_fmac_f32 v254, v116, v116
    v_mfma_f32_16x16x32_bf16 v[166:169], v[86:89], v[198:201], v[166:169]
    ds_read_b128 v[242:245], v2 offset:17408
    v_fmac_f32 v254, v117, v117
    v_mfma_f32_16x16x32_bf16 v[230:233], v[90:93], v[150:153], 0
    v_mul_f32 v170, v182, v170
    v_mul_f32 v171, v182, v171
    v_mfma_f32_16x16x32_bf16 v[230:233], v[94:97], v[162:165], v[230:233]
    v_cvt_pk_bf16_f32 v136, v170, v171
    v_mul_f32 v172, v182, v172
    v_mfma_f32_16x16x32_bf16 v[230:233], v[98:101], v[186:189], v[230:233]
    s_waitcnt lgkmcnt(5)
    v_fmac_f32 v254, v166, v166
    v_fmac_f32 v254, v167, v167
    v_mfma_f32_16x16x32_bf16 v[230:233], v[102:105], v[138:141], v[230:233]
    s_waitcnt lgkmcnt(4)
    v_fmac_f32 v254, v168, v168
    v_fmac_f32 v254, v169, v169
    v_mfma_f32_16x16x32_bf16 v[230:233], v[106:109], v[118:121], v[230:233]
    s_waitcnt lgkmcnt(3)
    v_mul_f32 v173, v182, v173
    v_cvt_pk_bf16_f32 v137, v172, v173
    v_mfma_f32_16x16x32_bf16 v[230:233], v[110:113], v[198:201], v[230:233]
    s_waitcnt lgkmcnt(2)
    ds_write_b128 v3, v[134:137] offset:6144
    v_mfma_f32_16x16x32_bf16 v[150:153], a[216:219], v[214:217], 0
    s_waitcnt lgkmcnt(1)
    v_mul_f32 v174, v182, v174
    v_mul_f32 v175, v182, v175
    v_mfma_f32_16x16x32_bf16 v[150:153], a[220:223], v[234:237], v[150:153]
    v_cvt_pk_bf16_f32 v174, v174, v175
    v_fmac_f32 v254, v230, v230
    v_mfma_f32_16x16x32_bf16 v[150:153], a[224:227], v[218:221], v[150:153]
    v_fmac_f32 v254, v231, v231
    v_fmac_f32 v254, v232, v232
    v_mfma_f32_16x16x32_bf16 v[150:153], a[228:231], v[158:161], v[150:153]
    v_fmac_f32 v254, v233, v233
    v_cvt_pk_bf16_f32 v254, v255, v254
    v_mfma_f32_16x16x32_bf16 v[150:153], a[232:235], v[206:209], v[150:153]
    v_mul_f32 v176, v182, v176
    v_mul_f32 v177, v182, v177
    v_mfma_f32_16x16x32_bf16 v[150:153], a[236:239], v[242:245], v[150:153]
    v_cvt_pk_bf16_f32 v175, v176, v177
    v_xor_b32 v2, 65536, v2
    v_mfma_f32_16x16x32_bf16 v[162:165], a[240:243], v[214:217], 0
    ds_write_b64 v4, v[174:175] offset:10240
    v_mfma_f32_16x16x32_bf16 v[162:165], a[244:247], v[234:237], v[162:165]
    v_exp_f32 v195, v195
    v_mfma_f32_16x16x32_bf16 v[162:165], a[248:251], v[218:221], v[162:165]
    v_exp_f32 v196, v196
    v_mfma_f32_16x16x32_bf16 v[162:165], a[252:255], v[158:161], v[162:165]
    v_fma_f32 v255, v150, v150, s33
    v_fmac_f32 v255, v151, v151
    v_mfma_f32_16x16x32_bf16 v[162:165], v[82:85], v[206:209], v[162:165]
    v_fmac_f32 v255, v152, v152
    v_fmac_f32 v255, v153, v153
    v_mfma_f32_16x16x32_bf16 v[162:165], v[86:89], v[242:245], v[162:165]
    v_exp_f32 v197, v197
    v_mfma_f32_16x16x32_bf16 v[138:141], v[90:93], v[214:217], 0
    ds_read_b128 v[186:189], v0 offset:20480
    v_cvt_pk_bf16_f32 v36, v194, v195
    v_mfma_f32_16x16x32_bf16 v[138:141], v[94:97], v[234:237], v[138:141]
    ds_read_b128 v[118:121], v1 offset:20480
    v_cvt_pk_bf16_f32 v37, v196, v197
    v_mfma_f32_16x16x32_bf16 v[138:141], v[98:101], v[218:221], v[138:141]
    ds_read_b128 v[234:237], v0 offset:20608
    v_fmac_f32 v255, v162, v162
    v_mfma_f32_16x16x32_bf16 v[198:201], v[28:31], v[36:39], 0
    ds_read_b128 v[214:217], v9
    v_fmac_f32 v255, v163, v163
    v_mfma_f32_16x16x32_bf16 v[198:201], v[28:31], v[226:229], v[198:201]
    ds_read_b128 v[194:197], v9 offset:64
    v_fmac_f32 v255, v164, v164
    v_mfma_f32_16x16x32_bf16 v[170:173], v[142:145], v[36:39], 0
    v_rcp_f32 v178, v178
    v_mfma_f32_16x16x32_bf16 v[170:173], v[126:129], v[226:229], v[170:173]
    v_fmac_f32 v255, v165, v165
    v_mul_f32 v146, v178, v146
    v_mfma_f32_16x16x32_bf16 v[218:221], v[210:213], v[36:39], 0
    v_rcp_f32 v198, v198
    v_mfma_f32_16x16x32_bf16 v[218:221], v[130:133], v[226:229], v[218:221]
    s_waitcnt lgkmcnt(4)
    v_mul_f32 v147, v178, v147
    v_cvt_pk_bf16_f32 v146, v146, v147
    v_mfma_f32_16x16x32_bf16 v[174:177], v[238:241], v[36:39], 0
    s_waitcnt lgkmcnt(3)
    v_mul_f32 v170, v198, v170
    v_mul_f32 v171, v198, v171
    v_mfma_f32_16x16x32_bf16 v[174:177], v[190:193], v[226:229], v[174:177]
    s_waitcnt lgkmcnt(2)
    v_cvt_pk_bf16_f32 v226, v170, v171
    v_mul_f32 v172, v198, v172
    v_mfma_f32_16x16x32_bf16 v[138:141], v[102:105], v[158:161], v[138:141]
    s_waitcnt lgkmcnt(1)
    ds_read_b128 v[158:161], v1 offset:20608
    v_mul_f32 v173, v198, v173
    v_mfma_f32_16x16x32_bf16 v[138:141], v[106:109], v[206:209], v[138:141]
    s_waitcnt lgkmcnt(1)
    ds_read_b128 v[182:185], v0 offset:20736
    v_cvt_pk_bf16_f32 v227, v172, v173
    v_mfma_f32_16x16x32_bf16 v[138:141], v[110:113], v[242:245], v[138:141]
    ds_read_b128 v[206:209], v1 offset:20736
    v_mul_f32 v218, v198, v218
    v_mfma_f32_16x16x32_bf16 v[242:245], v[214:217], v[28:31], 0
    v_mul_f32 v219, v198, v219
    v_cvt_pk_bf16_f32 v228, v218, v219
    v_mfma_f32_16x16x32_bf16 v[242:245], v[194:197], v[28:31], v[242:245]
    v_mul_f32 v220, v198, v220
    v_mul_f32 v221, v198, v221
    v_mfma_f32_16x16x32_bf16 v[170:173], v[214:217], v[126:129], 0
    v_fmac_f32 v255, v138, v138
    v_fmac_f32 v255, v139, v139
    v_mfma_f32_16x16x32_bf16 v[170:173], v[194:197], v[142:145], v[170:173]
    v_fmac_f32 v255, v140, v140
    v_fmac_f32 v255, v141, v141
    v_mfma_f32_16x16x32_bf16 v[126:129], v[214:217], v[130:133], 0
    v_cvt_pk_bf16_f32 v255, v255, v255
    v_cvt_pk_bf16_f32 v229, v220, v221
    v_mfma_f32_16x16x32_bf16 v[126:129], v[194:197], v[210:213], v[126:129]
    s_waitcnt lgkmcnt(2)
    ds_write_b128 v3, v[226:229] offset:12288
    v_mfma_f32_16x16x32_bf16 v[130:133], v[214:217], v[190:193], 0
    s_waitcnt lgkmcnt(1)
    v_rcp_f32 v242, v242
    v_mfma_f32_16x16x32_bf16 v[130:133], v[194:197], v[238:241], v[130:133]
    v_mul_f32 v170, v170, v242
    v_mul_f32 v174, v198, v174
    v_mfma_f32_16x16x32_bf16 v[190:193], a[72:75], v[186:189], 0
    ds_write_b64 v4, v[254:255] offset:18432
    v_mfma_f32_16x16x32_bf16 v[190:193], a[76:79], v[118:121], v[190:193]
    v_mul_f32_dpp v170, v126, v242 quad_perm:[0,1,2,3] row_mask:0x2 bank_mask:0xf
    v_mul_f32 v175, v198, v175
    v_mfma_f32_16x16x32_bf16 v[190:193], a[80:83], v[234:237], v[190:193]
    v_mul_f32_dpp v170, v130, v242 quad_perm:[0,1,2,3] row_mask:0x4 bank_mask:0xf
    v_cvt_pk_bf16_f32 v170, v170, v170
    v_mfma_f32_16x16x32_bf16 v[190:193], a[84:87], v[158:161], v[190:193]
    ds_write_b16 v7, v170
    v_mfma_f32_16x16x32_bf16 v[190:193], a[88:91], v[182:185], v[190:193]
    v_cvt_pk_bf16_f32 v254, v174, v175
    v_mul_f32 v176, v198, v176
    v_mfma_f32_16x16x32_bf16 v[190:193], a[92:95], v[206:209], v[190:193]
    v_mul_f32 v177, v198, v177
    v_cvt_pk_bf16_f32 v255, v176, v177
    v_mfma_f32_16x16x32_bf16 v[130:133], a[96:99], v[186:189], 0
    ds_write_b64 v4, v[254:255] offset:16384
    v_mfma_f32_16x16x32_bf16 v[130:133], a[100:103], v[118:121], v[130:133]
    v_mul_f32 v148, v178, v148
    v_mul_f32 v149, v178, v149
    v_mfma_f32_16x16x32_bf16 v[130:133], a[104:107], v[234:237], v[130:133]
    v_cvt_pk_bf16_f32 v147, v148, v149
    v_mul_f32 v246, v178, v246
    v_mfma_f32_16x16x32_bf16 v[130:133], a[108:111], v[158:161], v[130:133]
    v_mul_f32 v247, v178, v247
    v_cvt_pk_bf16_f32 v148, v246, v247
    v_mfma_f32_16x16x32_bf16 v[130:133], a[112:115], v[182:185], v[130:133]
    v_mul_f32 v248, v178, v248
    v_mul_f32 v249, v178, v249
    v_mfma_f32_16x16x32_bf16 v[130:133], a[116:119], v[206:209], v[130:133]
    v_cvt_pk_bf16_f32 v149, v248, v249
    v_mul_f32 v222, v178, v222
    v_mfma_f32_16x16x32_bf16 v[126:129], a[120:123], v[186:189], 0
    ds_write_b128 v3, v[146:149] offset:0
    v_mfma_f32_16x16x32_bf16 v[126:129], a[124:127], v[118:121], v[126:129]
    v_mul_f32 v223, v178, v223
    v_cvt_pk_bf16_f32 v254, v222, v223
    v_mfma_f32_16x16x32_bf16 v[126:129], a[128:131], v[234:237], v[126:129]
    v_mul_f32 v224, v178, v224
    v_mul_f32 v225, v178, v225
    v_mfma_f32_16x16x32_bf16 v[126:129], a[132:135], v[158:161], v[126:129]
    v_cvt_pk_bf16_f32 v255, v224, v225
    v_xor_b32 v3, 65536, v3
    v_mfma_f32_16x16x32_bf16 v[126:129], a[136:139], v[182:185], v[126:129]
    ds_write_b64 v4, v[254:255] offset:4096
    v_mfma_f32_16x16x32_bf16 v[126:129], a[140:143], v[206:209], v[126:129]
    v_xor_b32 v4, 65536, v4
    v_cvt_pk_f16_f32 v194, v190, v191
    v_mfma_f32_16x16x32_bf16 v[142:145], a[0:3], v[186:189], 0
    v_pk_mul_f16 v191, v194, v194
    v_cvt_pk_f16_f32 v195, v192, v193
    v_mfma_f32_16x16x32_bf16 v[142:145], a[4:7], v[118:121], v[142:145]
    v_pk_fma_f16 v191, v195, v195, v191
    v_cvt_pk_f16_f32 v196, v130, v131
    v_mfma_f32_16x16x32_bf16 v[142:145], a[8:11], v[234:237], v[142:145]
    v_pk_fma_f16 v191, v196, v196, v191
    v_cvt_pk_f16_f32 v197, v132, v133
    v_mfma_f32_16x16x32_bf16 v[142:145], a[12:15], v[158:161], v[142:145]
    v_pk_fma_f16 v191, v197, v197, v191
    v_cvt_pk_f16_f32 v148, v126, v127
    v_mfma_f32_16x16x32_bf16 v[142:145], a[16:19], v[182:185], v[142:145]
    v_pk_fma_f16 v191, v148, v148, v191
    v_cvt_pk_f16_f32 v149, v128, v129
    v_mfma_f32_16x16x32_bf16 v[142:145], a[20:23], v[206:209], v[142:145]
    s_waitcnt lgkmcnt(0)
    v_pk_fma_f16 v191, v149, v149, v191
    v_add_u32 v7, s76, v7
    v_mfma_f32_16x16x32_bf16 v[126:129], a[24:27], v[186:189], 0
    s_nop 0
    v_mfma_f32_16x16x32_bf16 v[126:129], a[28:31], v[118:121], v[126:129]
    s_barrier
    v_mfma_f32_16x16x32_bf16 v[126:129], a[32:35], v[234:237], v[126:129]
    s_nop 0
    v_mfma_f32_16x16x32_bf16 v[126:129], a[36:39], v[158:161], v[126:129]
    s_nop 0
    v_mfma_f32_16x16x32_bf16 v[126:129], a[40:43], v[182:185], v[126:129]
    v_mfma_f32_16x16x32_bf16 v[126:129], a[44:47], v[206:209], v[126:129]
    s_cbranch_scc1 L_loop_fast1
    s_branch L_final_fast
.p2align 6
L_loop_fast2:
    v_mfma_f32_16x16x32_bf16 v[130:133], a[48:51], v[186:189], 0
    s_add_u32 s12, s40, s27
    ds_read_b128 v[246:249], v2 offset:18432
    v_cvt_pk_f16_f32 v222, v142, v143
    v_mfma_f32_16x16x32_bf16 v[130:133], a[52:55], v[118:121], v[130:133]
    s_addc_u32 s13, s41, 0
    ds_read_b128 v[210:213], v2 offset:19456
    v_pk_mul_f16 v190, v222, v222
    v_mfma_f32_16x16x32_bf16 v[130:133], a[56:59], v[234:237], v[130:133]
    s_sub_u32 s14, s36, s27
    ds_read_b128 v[238:241], v5 offset:32
    v_cvt_pk_f16_f32 v223, v144, v145
    v_mfma_f32_16x16x32_bf16 v[130:133], a[60:63], v[158:161], v[130:133]
    s_cmp_ge_u32 s18, 2
    ds_read2_b64 v[226:229], v5 offset0:6 offset1:9
    v_pk_fma_f16 v190, v223, v223, v190
    v_mfma_f32_16x16x32_bf16 v[130:133], a[64:67], v[182:185], v[130:133]
    s_cselect_b32 s14, s14, 0
    ds_read_b128 v[142:145], v5
    v_cvt_pk_f16_f32 v224, v126, v127
    v_mfma_f32_16x16x32_bf16 v[130:133], a[68:71], v[206:209], v[130:133]
    s_sub_u32 s82, s72, s71
    ds_read_b32 v254, v6 offset:192
    v_pk_fma_f16 v190, v224, v224, v190
    v_mfma_f32_16x16x32_bf16 v[198:201], v[186:189], a[144:147], 0
    s_mul_i32 s74, s82, 336
    v_cvt_pk_f16_f32 v225, v128, v129
    v_pk_fma_f16 v190, v225, v225, v190
    v_mfma_f32_16x16x32_bf16 v[198:201], v[118:121], a[148:151], v[198:201]
    s_mul_i32 s75, s82, 272
    v_cvt_pk_f16_f32 v146, v130, v131
    v_pk_fma_f16 v190, v146, v146, v190
    v_mfma_f32_16x16x32_bf16 v[198:201], v[234:237], a[152:155], v[198:201]
    s_waitcnt lgkmcnt(5)
    v_cvt_pk_f16_f32 v147, v132, v133
    v_pk_fma_f16 v190, v147, v147, v190
    v_mfma_f32_16x16x32_bf16 v[130:133], v[32:35], v[246:249], 0
    s_waitcnt lgkmcnt(4)
    v_add_u32 v5, s74, v5
    s_mul_i32 s76, s82, 16
    v_mfma_f32_16x16x32_bf16 v[130:133], v[32:35], v[210:213], v[130:133]
    s_waitcnt lgkmcnt(3)
    v_pk_mul_f16 v193, v194, v238
    v_pk_fma_f16 v193, v195, v239, v193
    v_mfma_f32_16x16x32_bf16 v[198:201], v[158:161], a[156:159], v[198:201]
    s_add_u32 s34, s18, 2
    v_pk_fma_f16 v193, v196, v240, v193
    v_pk_fma_f16 v193, v197, v241, v193
    v_mfma_f32_16x16x32_bf16 v[198:201], v[182:185], a[160:163], v[198:201]
    s_waitcnt lgkmcnt(1)
    v_pk_fma_f16 v193, v148, v228, v193
    v_pk_fma_f16 v193, v149, v229, v193
    v_mfma_f32_16x16x32_bf16 v[198:201], v[206:209], a[164:167], v[198:201]
    s_waitcnt lgkmcnt(0)
    v_mov_b32_dpp v254, v23 quad_perm:[0,1,2,3] row_mask:0x7 bank_mask:0xf
    v_pk_mul_f16 v192, v222, v142
    v_mfma_f32_16x16x32_bf16 v[210:213], v[186:189], a[168:171], 0
    s_add_u32 s8, s60, s23
    v_pk_fma_f16 v192, v223, v143, v192
    v_pk_fma_f16 v192, v224, v144, v192
    v_mfma_f32_16x16x32_bf16 v[210:213], v[118:121], a[172:175], v[210:213]
    s_addc_u32 s9, s61, 0
    v_pk_fma_f16 v192, v225, v145, v192
    v_pk_fma_f16 v192, v146, v226, v192
    v_mfma_f32_16x16x32_bf16 v[210:213], v[234:237], a[176:179], v[210:213]
    s_sub_u32 s10, s36, s23
    ds_read_b128 v[246:249], v0 offset:26624
    v_pk_fma_f16 v192, v147, v227, v192
    v_mfma_f32_16x16x32_bf16 v[210:213], v[158:161], a[180:183], v[210:213]
    s_cmp_le_u32 s34, s45
    ds_read_b128 v[174:177], v1 offset:26624
    v_cvt_pk_bf16_f32 v126, v198, v199
    v_mfma_f32_16x16x32_f16 v[214:217], v[40:43], v[190:193], 0
    s_cselect_b32 s10, s10, 0
    v_cvt_pk_bf16_f32 v127, v200, v201
    v_mul_f32 v255, 0x3baaaaab, v130
    v_mfma_f32_16x16x32_bf16 v[210:213], v[182:185], a[184:187], v[210:213]
    s_add_u32 m0, s28, 0
    ds_read_b128 v[198:201], v0 offset:26752
    v_mul_f32 v134, 0x3baaaaab, v131
    v_mfma_f32_16x16x32_bf16 v[210:213], v[206:209], a[188:191], v[210:213]
    s_mov_b32 s27, s26
    ds_read_b128 v[242:245], v1 offset:26752
    v_mul_f32 v132, 0x3baaaaab, v132
    v_mfma_f32_16x16x32_bf16 v[190:193], v[186:189], a[192:195], 0
    s_mov_b32 s26, s25
    ds_read_b128 v[186:189], v0 offset:26880
    s_mov_b32 s25, s24
    v_mfma_f32_16x16x32_bf16 v[190:193], v[118:121], a[196:199], v[190:193]
    s_mov_b32 s24, s23
    ds_read_b128 v[118:121], v1 offset:26880
    v_cvt_pk_bf16_f32 v130, v210, v211
    v_mfma_f32_16x16x32_bf16 v[190:193], v[234:237], a[200:203], v[190:193]
    s_ff1_i32_b32 s80, s100
    v_rsq_f32 v214, v214
    v_mfma_f32_16x16x32_bf16 v[190:193], v[158:161], a[204:207], v[190:193]
    s_waitcnt lgkmcnt(5)
    v_rsq_f32 v215, v215
    v_mfma_f32_16x16x32_bf16 v[190:193], v[182:185], a[208:211], v[190:193]
    s_mov_b32 s71, s72
    v_mul_f32 v128, s31, v214
    v_cvt_pk_f16_f32 v129, v128, v215
    v_mfma_f32_16x16x32_bf16 v[190:193], v[206:209], a[212:215], v[190:193]
    s_mov_b32 s72, s73
    v_cvt_pk_bf16_f32 v131, v212, v213
    v_fma_f32 v216, v216, v128, v22
    v_mfma_f32_16x16x32_bf16 v[210:213], a[72:75], v[246:249], 0
    s_waitcnt lgkmcnt(3)
    v_fmac_f32_dpp v254, v217, v215 quad_perm:[0,1,2,3] row_mask:0x1 bank_mask:0xf
    v_pk_mul_f16 v194, v194, v129 op_sel:[0,1] op_sel_hi:[1,1]
    v_mfma_f32_16x16x32_bf16 v[210:213], a[76:79], v[174:177], v[210:213]
    s_waitcnt lgkmcnt(2)
    v_cvt_pk_bf16_f32 v190, v190, v191
    v_cvt_pk_bf16_f32 v191, v192, v193
    v_mfma_f32_16x16x32_bf16 v[210:213], a[80:83], v[198:201], v[210:213]
    s_waitcnt lgkmcnt(1)
    v_pk_mul_f16 v195, v195, v129 op_sel:[0,1] op_sel_hi:[1,1]
    v_pk_mul_f16 v196, v196, v129 op_sel:[0,1] op_sel_hi:[1,1]
    v_mfma_f32_16x16x32_bf16 v[210:213], a[84:87], v[242:245], v[210:213]
    s_waitcnt lgkmcnt(0)
    v_pk_mul_f16 v197, v197, v129 op_sel:[0,1] op_sel_hi:[1,1]
    v_pk_mul_f16 v148, v148, v129 op_sel:[0,1] op_sel_hi:[1,1]
    v_mfma_f32_16x16x32_bf16 v[210:213], a[88:91], v[186:189], v[210:213]
    v_pk_mul_f16 v149, v149, v129 op_sel:[0,1] op_sel_hi:[1,1]
    v_pk_mul_f16 v222, v222, v129 op_sel:[0,0] op_sel_hi:[1,0]
    v_mfma_f32_16x16x32_bf16 v[210:213], a[92:95], v[118:121], v[210:213]
    v_pk_mul_f16 v223, v223, v129 op_sel:[0,0] op_sel_hi:[1,0]
    v_pk_mul_f16 v224, v224, v129 op_sel:[0,0] op_sel_hi:[1,0]
    v_mfma_f32_16x16x32_bf16 v[206:209], a[96:99], v[246:249], 0
    v_pk_mul_f16 v225, v225, v129 op_sel:[0,0] op_sel_hi:[1,0]
    v_pk_mul_f16 v146, v146, v129 op_sel:[0,0] op_sel_hi:[1,0]
    v_mfma_f32_16x16x32_bf16 v[206:209], a[100:103], v[174:177], v[206:209]
    v_pk_mul_f16 v147, v147, v129 op_sel:[0,0] op_sel_hi:[1,0]
    v_max3_u32 v44, v44, v214, v215
    v_mfma_f32_16x16x32_bf16 v[206:209], a[104:107], v[198:201], v[206:209]
    v_rsq_f32 v255, v255
    v_mfma_f32_16x16x32_bf16 v[206:209], a[108:111], v[242:245], v[206:209]
    v_rsq_f32 v134, v134
    v_mfma_f32_16x16x32_bf16 v[206:209], a[112:115], v[186:189], v[206:209]
    v_rsq_f32 v132, v132
    v_mfma_f32_16x16x32_bf16 v[206:209], a[116:119], v[118:121], v[206:209]
    v_mul_f32 v122, v255, v122
    v_mul_f32 v123, v255, v123
    v_mfma_f32_16x16x32_bf16 v[234:237], a[120:123], v[246:249], 0
    v_cvt_pk_bf16_f32 v122, v122, v123
    v_mul_f32 v124, v255, v124
    v_mfma_f32_16x16x32_bf16 v[234:237], a[124:127], v[174:177], v[234:237]
    v_mul_f32 v125, v255, v125
    v_cvt_pk_bf16_f32 v123, v124, v125
    v_mfma_f32_16x16x32_bf16 v[234:237], a[128:131], v[198:201], v[234:237]
    v_mul_f32 v154, v255, v154
    v_mul_f32 v155, v255, v155
    v_mfma_f32_16x16x32_bf16 v[234:237], a[132:135], v[242:245], v[234:237]
    v_cvt_pk_bf16_f32 v124, v154, v155
    v_mul_f32 v156, v255, v156
    v_mfma_f32_16x16x32_bf16 v[234:237], a[136:139], v[186:189], v[234:237]
    v_mul_f32 v157, v255, v157
    v_cvt_pk_bf16_f32 v125, v156, v157
    v_mfma_f32_16x16x32_bf16 v[234:237], a[140:143], v[118:121], v[234:237]
    buffer_store_dwordx4 v[122:125], v15, s[12:15], 0 offen nt
    v_mul_f32 v202, v255, v202
    v_mul_f32 v203, v255, v203
    v_cvt_pk_bf16_f32 v128, v202, v203
    v_mul_f32 v204, v255, v204
    v_mfma_f32_16x16x32_bf16 v[122:125], a[0:3], v[246:249], 0
    v_mul_f32 v205, v255, v205
    v_cvt_pk_bf16_f32 v129, v204, v205
    v_mfma_f32_16x16x32_bf16 v[122:125], a[4:7], v[174:177], v[122:125]
    v_cvt_pk_f16_f32 v202, v210, v211
    v_pk_mul_f16 v211, v202, v202
    v_mfma_f32_16x16x32_bf16 v[122:125], a[8:11], v[198:201], v[122:125]
    v_cvt_pk_f16_f32 v203, v212, v213
    v_pk_fma_f16 v211, v203, v203, v211
    v_mfma_f32_16x16x32_bf16 v[122:125], a[12:15], v[242:245], v[122:125]
    v_cvt_pk_f16_f32 v204, v206, v207
    v_pk_fma_f16 v211, v204, v204, v211
    v_mfma_f32_16x16x32_bf16 v[122:125], a[16:19], v[186:189], v[122:125]
    v_cvt_pk_f16_f32 v205, v208, v209
    v_pk_fma_f16 v211, v205, v205, v211
    v_mfma_f32_16x16x32_bf16 v[122:125], a[20:23], v[118:121], v[122:125]
    v_cvt_pk_f16_f32 v160, v234, v235
    v_pk_fma_f16 v211, v160, v160, v211
    v_mfma_f32_16x16x32_bf16 v[154:157], a[24:27], v[246:249], 0
    v_cvt_pk_f16_f32 v161, v236, v237
    v_pk_fma_f16 v211, v161, v161, v211
    v_mfma_f32_16x16x32_bf16 v[154:157], a[28:31], v[174:177], v[154:157]
    v_pk_mul_f16 v213, v202, v238
    v_pk_fma_f16 v213, v203, v239, v213
    v_mfma_f32_16x16x32_bf16 v[154:157], a[32:35], v[198:201], v[154:157]
    v_cvt_pk_f16_f32 v122, v122, v123
    v_pk_mul_f16 v210, v122, v122
    v_mfma_f32_16x16x32_bf16 v[154:157], a[36:39], v[242:245], v[154:157]
    v_cvt_pk_f16_f32 v123, v124, v125
    v_pk_fma_f16 v210, v123, v123, v210
    v_mfma_f32_16x16x32_bf16 v[154:157], a[40:43], v[186:189], v[154:157]
    v_pk_mul_f16 v212, v122, v142
    v_pk_fma_f16 v212, v123, v143, v212
    v_mfma_f32_16x16x32_bf16 v[154:157], a[44:47], v[118:121], v[154:157]
    v_pk_fma_f16 v213, v204, v240, v213
    v_pk_fma_f16 v213, v205, v241, v213
    v_mfma_f32_16x16x32_bf16 v[206:209], a[48:51], v[246:249], 0
    v_pk_fma_f16 v213, v160, v228, v213
    v_pk_fma_f16 v213, v161, v229, v213
    v_mfma_f32_16x16x32_bf16 v[206:209], a[52:55], v[174:177], v[206:209]
    v_mul_f32 v150, v132, v150
    v_mul_f32 v151, v132, v151
    v_mfma_f32_16x16x32_bf16 v[206:209], a[56:59], v[198:201], v[206:209]
    v_cvt_pk_f16_f32 v124, v154, v155
    v_pk_fma_f16 v210, v124, v124, v210
    v_mfma_f32_16x16x32_bf16 v[206:209], a[60:63], v[242:245], v[206:209]
    v_cvt_pk_f16_f32 v125, v156, v157
    v_pk_fma_f16 v210, v125, v125, v210
    v_mfma_f32_16x16x32_bf16 v[206:209], a[64:67], v[186:189], v[206:209]
    buffer_store_dwordx2 v[128:129], v18, s[12:15], 0 offen nt
    v_pk_fma_f16 v212, v124, v144, v212
    v_pk_fma_f16 v212, v125, v145, v212
    v_mfma_f32_16x16x32_bf16 v[206:209], a[68:71], v[118:121], v[206:209]
    v_cvt_pk_bf16_f32 v150, v150, v151
    v_mul_f32 v152, v132, v152
    v_mfma_f32_16x16x32_bf16 v[154:157], v[246:249], a[144:147], 0
    v_mul_f32 v153, v132, v153
    v_cvt_pk_bf16_f32 v151, v152, v153
    v_mfma_f32_16x16x32_bf16 v[154:157], v[174:177], a[148:151], v[154:157]
    v_mul_f32 v162, v132, v162
    v_mul_f32 v163, v132, v163
    v_mfma_f32_16x16x32_bf16 v[154:157], v[198:201], a[152:155], v[154:157]
    v_cvt_pk_f16_f32 v158, v206, v207
    v_pk_fma_f16 v210, v158, v158, v210
    v_mfma_f32_16x16x32_bf16 v[154:157], v[242:245], a[156:159], v[154:157]
    v_cvt_pk_f16_f32 v159, v208, v209
    v_pk_fma_f16 v210, v159, v159, v210
    v_mfma_f32_16x16x32_bf16 v[154:157], v[186:189], a[160:163], v[154:157]
    v_pk_fma_f16 v212, v158, v226, v212
    v_pk_fma_f16 v212, v159, v227, v212
    v_mfma_f32_16x16x32_bf16 v[154:157], v[118:121], a[164:167], v[154:157]
    v_cvt_pk_bf16_f32 v152, v162, v163
    v_mul_f32 v164, v132, v164
    v_mfma_f32_16x16x32_f16 v[206:209], v[40:43], v[210:213], 0
    v_mul_f32 v165, v132, v165
    v_cvt_pk_bf16_f32 v153, v164, v165
    v_mfma_f32_16x16x32_bf16 v[210:213], v[246:249], a[168:171], 0
    v_mul_f32 v138, v132, v138
    v_mul_f32 v139, v132, v139
    v_mfma_f32_16x16x32_bf16 v[210:213], v[174:177], a[172:175], v[210:213]
    v_cvt_pk_bf16_f32 v128, v154, v155
    v_cvt_pk_bf16_f32 v129, v156, v157
    v_mfma_f32_16x16x32_bf16 v[210:213], v[198:201], a[176:179], v[210:213]
    ds_read_b128 v[154:157], v0 offset:32768
    v_cvt_pk_bf16_f32 v136, v138, v139
    v_mfma_f32_16x16x32_bf16 v[210:213], v[242:245], a[180:183], v[210:213]
    ds_read_b128 v[162:165], v1 offset:32768
    v_mul_f32 v140, v132, v140
    v_mfma_f32_16x16x32_bf16 v[210:213], v[186:189], a[184:187], v[210:213]
    ds_read_b128 v[218:221], v0 offset:32896
    v_mul_f32 v141, v132, v141
    v_mfma_f32_16x16x32_bf16 v[210:213], v[118:121], a[188:191], v[210:213]
    ds_read_b128 v[234:237], v1 offset:32896
    v_cvt_pk_bf16_f32 v137, v140, v141
    v_mfma_f32_16x16x32_bf16 v[182:185], v[246:249], a[192:195], 0
    ds_read_b128 v[138:141], v0 offset:33024
    v_mul_f32 v114, v134, v114
    v_mfma_f32_16x16x32_bf16 v[182:185], v[174:177], a[196:199], v[182:185]
    ds_read_b128 v[246:249], v1 offset:33024
    v_mul_f32 v115, v134, v115
    v_mfma_f32_16x16x32_bf16 v[182:185], v[198:201], a[200:203], v[182:185]
    buffer_store_dwordx4 v[150:153], v17, s[12:15], 0 offen nt
    v_rsq_f32 v206, v206
    v_rsq_f32 v207, v207
    v_mfma_f32_16x16x32_bf16 v[182:185], v[242:245], a[204:207], v[182:185]
    s_waitcnt lgkmcnt(5)
    v_mul_f32 v214, s31, v206
    v_cvt_pk_f16_f32 v215, v214, v207
    v_mfma_f32_16x16x32_bf16 v[182:185], v[186:189], a[208:211], v[182:185]
    s_waitcnt lgkmcnt(4)
    v_fma_f32 v208, v208, v214, v24
    v_fmac_f32_dpp v254, v209, v207 quad_perm:[0,1,2,3] row_mask:0x2 bank_mask:0xf
    v_mfma_f32_16x16x32_bf16 v[182:185], v[118:121], a[212:215], v[182:185]
    s_waitcnt lgkmcnt(3)
    v_cvt_pk_bf16_f32 v132, v210, v211
    v_cvt_pk_bf16_f32 v133, v212, v213
    v_mfma_f32_16x16x32_bf16 v[210:213], a[72:75], v[154:157], 0
    s_waitcnt lgkmcnt(2)
    v_pk_mul_f16 v202, v202, v215 op_sel:[0,1] op_sel_hi:[1,1]
    v_pk_mul_f16 v203, v203, v215 op_sel:[0,1] op_sel_hi:[1,1]
    v_mfma_f32_16x16x32_bf16 v[210:213], a[76:79], v[162:165], v[210:213]
    s_waitcnt lgkmcnt(1)
    v_cvt_pk_bf16_f32 v192, v182, v183
    v_cvt_pk_bf16_f32 v193, v184, v185
    v_mfma_f32_16x16x32_bf16 v[210:213], a[80:83], v[218:221], v[210:213]
    s_waitcnt lgkmcnt(0)
    v_pk_mul_f16 v204, v204, v215 op_sel:[0,1] op_sel_hi:[1,1]
    v_pk_mul_f16 v205, v205, v215 op_sel:[0,1] op_sel_hi:[1,1]
    v_mfma_f32_16x16x32_bf16 v[210:213], a[84:87], v[234:237], v[210:213]
    v_pk_mul_f16 v160, v160, v215 op_sel:[0,1] op_sel_hi:[1,1]
    v_pk_mul_f16 v161, v161, v215 op_sel:[0,1] op_sel_hi:[1,1]
    v_mfma_f32_16x16x32_bf16 v[210:213], a[88:91], v[138:141], v[210:213]
    v_pk_mul_f16 v122, v122, v215 op_sel:[0,0] op_sel_hi:[1,0]
    v_pk_mul_f16 v123, v123, v215 op_sel:[0,0] op_sel_hi:[1,0]
    v_mfma_f32_16x16x32_bf16 v[210:213], a[92:95], v[246:249], v[210:213]
    v_pk_mul_f16 v124, v124, v215 op_sel:[0,0] op_sel_hi:[1,0]
    v_pk_mul_f16 v125, v125, v215 op_sel:[0,0] op_sel_hi:[1,0]
    v_mfma_f32_16x16x32_bf16 v[118:121], a[96:99], v[154:157], 0
    v_pk_mul_f16 v158, v158, v215 op_sel:[0,0] op_sel_hi:[1,0]
    v_pk_mul_f16 v159, v159, v215 op_sel:[0,0] op_sel_hi:[1,0]
    v_mfma_f32_16x16x32_bf16 v[118:121], a[100:103], v[162:165], v[118:121]
    v_max3_u32 v44, v44, v206, v207
    v_cvt_pk_bf16_f32 v114, v114, v115
    v_mfma_f32_16x16x32_bf16 v[118:121], a[104:107], v[218:221], v[118:121]
    v_cvt_pk_f16_f32 v186, v210, v211
    v_pk_mul_f16 v211, v186, v186
    v_mfma_f32_16x16x32_bf16 v[118:121], a[108:111], v[234:237], v[118:121]
    s_waitcnt vmcnt(3)
    ds_write_b16 v8, v45 offset:512
    v_mfma_f32_16x16x32_bf16 v[118:121], a[112:115], v[138:141], v[118:121]
    v_cvt_pk_f16_f32 v187, v212, v213
    v_mfma_f32_16x16x32_bf16 v[118:121], a[116:119], v[246:249], v[118:121]
    v_pk_fma_f16 v211, v187, v187, v211
    v_pk_mul_f16 v213, v186, v238
    v_mfma_f32_16x16x32_bf16 v[150:153], a[120:123], v[154:157], 0
    v_pk_fma_f16 v213, v187, v239, v213
    v_mul_f32 v116, v134, v116
    v_mfma_f32_16x16x32_bf16 v[150:153], a[124:127], v[162:165], v[150:153]
    buffer_store_dwordx2 v[136:137], v20, s[12:15], 0 offen nt
    v_exp_f32 v208, v208
    v_mfma_f32_16x16x32_bf16 v[150:153], a[128:131], v[218:221], v[150:153]
    v_cvt_pk_f16_f32 v188, v118, v119
    v_pk_fma_f16 v211, v188, v188, v211
    v_mfma_f32_16x16x32_bf16 v[150:153], a[132:135], v[234:237], v[150:153]
    v_cvt_pk_f16_f32 v189, v120, v121
    v_pk_fma_f16 v211, v189, v189, v211
    v_mfma_f32_16x16x32_bf16 v[150:153], a[136:139], v[138:141], v[150:153]
    s_waitcnt lgkmcnt(0)
    v_pk_fma_f16 v213, v188, v240, v213
    v_pk_fma_f16 v213, v189, v241, v213
    v_mfma_f32_16x16x32_bf16 v[150:153], a[140:143], v[246:249], v[150:153]
    v_mul_f32 v117, v134, v117
    v_mfma_f32_16x16x32_bf16 v[238:241], a[0:3], v[154:157], 0
    v_cvt_pk_bf16_f32 v115, v116, v117
    v_mfma_f32_16x16x32_bf16 v[238:241], a[4:7], v[162:165], v[238:241]
    s_barrier
    v_mul_f32 v166, v134, v166
    v_mfma_f32_16x16x32_bf16 v[238:241], a[8:11], v[218:221], v[238:241]
    ds_read_u16 v255, v9 offset:256
    v_mfma_f32_16x16x32_bf16 v[238:241], a[12:15], v[234:237], v[238:241]
    v_cvt_pk_f16_f32 v120, v150, v151
    v_pk_fma_f16 v211, v120, v120, v211
    v_mfma_f32_16x16x32_bf16 v[238:241], a[16:19], v[138:141], v[238:241]
    v_cvt_pk_f16_f32 v121, v152, v153
    v_pk_fma_f16 v211, v121, v121, v211
    v_mfma_f32_16x16x32_bf16 v[238:241], a[20:23], v[246:249], v[238:241]
    v_pk_fma_f16 v213, v120, v228, v213
    v_pk_fma_f16 v213, v121, v229, v213
    v_mfma_f32_16x16x32_bf16 v[150:153], a[24:27], v[154:157], 0
    v_exp_f32 v216, v216
    v_mfma_f32_16x16x32_bf16 v[150:153], a[28:31], v[162:165], v[150:153]
    v_cvt_pk_bf16_f32 v39, v216, 0
    v_mul_f32 v167, v134, v167
    v_mfma_f32_16x16x32_bf16 v[150:153], a[32:35], v[218:221], v[150:153]
    v_cvt_pk_f16_f32 v198, v238, v239
    v_pk_mul_f16 v210, v198, v198
    v_mfma_f32_16x16x32_bf16 v[150:153], a[36:39], v[234:237], v[150:153]
    v_cvt_pk_f16_f32 v199, v240, v241
    v_pk_fma_f16 v210, v199, v199, v210
    v_mfma_f32_16x16x32_bf16 v[150:153], a[40:43], v[138:141], v[150:153]
    s_waitcnt lgkmcnt(0)
    v_readfirstlane_b32 s77, v255
    v_pk_mul_f16 v212, v198, v142
    v_mfma_f32_16x16x32_bf16 v[150:153], a[44:47], v[246:249], v[150:153]
    v_pk_fma_f16 v212, v199, v143, v212
    v_cvt_pk_bf16_f32 v116, v166, v167
    v_mfma_f32_16x16x32_bf16 v[238:241], a[48:51], v[154:157], 0
    buffer_load_dwordx4 v10, s[8:11], 0 offen nt lds
    v_mul_f32 v168, v134, v168
    v_mfma_f32_16x16x32_bf16 v[238:241], a[52:55], v[162:165], v[238:241]
    s_add_u32 m0, s28, 4096
    v_mul_f32 v169, v134, v169
    v_cvt_pk_f16_f32 v200, v150, v151
    v_mfma_f32_16x16x32_bf16 v[238:241], a[56:59], v[218:221], v[238:241]
    v_pk_fma_f16 v210, v200, v200, v210
    v_cvt_pk_f16_f32 v201, v152, v153
    v_mfma_f32_16x16x32_bf16 v[238:241], a[60:63], v[234:237], v[238:241]
    ds_read_b128 v[242:245], v2 offset:0
    v_pk_fma_f16 v210, v201, v201, v210
    v_mfma_f32_16x16x32_bf16 v[238:241], a[64:67], v[138:141], v[238:241]
    ds_read_b128 v[174:177], v2 offset:1024
    v_pk_fma_f16 v212, v200, v144, v212
    v_mfma_f32_16x16x32_bf16 v[238:241], a[68:71], v[246:249], v[238:241]
    ds_read_b128 v[170:173], v2 offset:2048
    buffer_load_dwordx4 v11, s[8:11], 0 offen nt lds
    v_mfma_f32_16x16x32_bf16 v[150:153], v[154:157], a[144:147], 0
    s_add_u32 m0, s28, 8192
    ds_read_b128 v[214:217], v2 offset:3072
    v_pk_fma_f16 v212, v201, v145, v212
    v_mfma_f32_16x16x32_bf16 v[150:153], v[162:165], a[148:151], v[150:153]
    ds_read_b128 v[182:185], v2 offset:4096
    v_cvt_pk_f16_f32 v118, v238, v239
    v_mfma_f32_16x16x32_bf16 v[150:153], v[218:221], a[152:155], v[150:153]
    ds_read_b128 v[178:181], v2 offset:5120
    v_pk_fma_f16 v210, v118, v118, v210
    v_mfma_f32_16x16x32_bf16 v[150:153], v[234:237], a[156:159], v[150:153]
    v_cvt_pk_f16_f32 v119, v240, v241
    v_pk_fma_f16 v210, v119, v119, v210
    v_mfma_f32_16x16x32_bf16 v[150:153], v[138:141], a[160:163], v[150:153]
    buffer_load_dwordx4 v12, s[8:11], 0 offen nt lds
    v_pk_fma_f16 v212, v118, v226, v212
    v_mfma_f32_16x16x32_bf16 v[150:153], v[246:249], a[164:167], v[150:153]
    s_waitcnt lgkmcnt(5)
    v_pk_fma_f16 v212, v119, v227, v212
    v_cvt_pk_bf16_f32 v117, v168, v169
    v_mfma_f32_16x16x32_bf16 v[226:229], v[154:157], a[168:171], 0
    s_add_u32 m0, s28, 12288
    v_mul_f32 v230, v134, v230
    v_mul_f32 v231, v134, v231
    v_mfma_f32_16x16x32_f16 v[166:169], v[40:43], v[210:213], 0
    s_xor_b32 s28, s28, 65536
    v_cvt_pk_bf16_f32 v142, v150, v151
    v_cvt_pk_bf16_f32 v143, v152, v153
    v_mfma_f32_16x16x32_bf16 v[226:229], v[162:165], a[172:175], v[226:229]
    s_waitcnt lgkmcnt(2)
    ds_read2_b32 v[144:145], v6 offset0:0 offset1:0
    v_cvt_pk_bf16_f32 v230, v230, v231
    v_mfma_f32_16x16x32_bf16 v[226:229], v[218:221], a[176:179], v[226:229]
    s_waitcnt lgkmcnt(2)
    buffer_load_dwordx4 v13, s[8:11], 0 offen nt lds
    ds_read2_b32 v[212:213], v6 offset0:16 offset1:16
    v_mfma_f32_16x16x32_bf16 v[226:229], v[234:237], a[180:183], v[226:229]
    s_mov_b32 m0, s29
    ds_read2_b32 v[240:241], v6 offset0:32 offset1:32
    v_mul_f32 v232, v134, v232
    v_mfma_f32_16x16x32_bf16 v[226:229], v[138:141], a[184:187], v[226:229]
    s_xor_b32 s29, s29, s30
    v_rsq_f32 v166, v166
    v_mfma_f32_16x16x32_bf16 v[226:229], v[246:249], a[188:191], v[226:229]
    s_add_u32 s19, s19, s20
    v_rsq_f32 v167, v167
    v_mfma_f32_16x16x32_bf16 v[150:153], v[154:157], a[192:195], 0
    s_add_u32 s23, s23, s21
    v_mul_f32 v136, s31, v166
    v_cvt_pk_f16_f32 v137, v136, v167
    v_mfma_f32_16x16x32_bf16 v[150:153], v[162:165], a[196:199], v[150:153]
    s_waitcnt lgkmcnt(3)
    v_fma_f32 v168, v168, v136, v26
    v_mfma_f32_16x16x32_bf16 v[150:153], v[218:221], a[200:203], v[150:153]
    s_cmp_ge_u32 s19, 72
    v_fmac_f32_dpp v254, v169, v167 quad_perm:[0,1,2,3] row_mask:0x4 bank_mask:0xf
    v_cvt_pk_bf16_f32 v210, v226, v227
    v_mfma_f32_16x16x32_bf16 v[150:153], v[234:237], a[204:207], v[150:153]
    s_cselect_b32 s34, 72, 0
    v_cvt_pk_bf16_f32 v211, v228, v229
    v_pk_mul_f16 v186, v186, v137 op_sel:[0,1] op_sel_hi:[1,1]
    v_mfma_f32_16x16x32_bf16 v[150:153], v[138:141], a[208:211], v[150:153]
    s_cselect_b32 s35, s22, 0
    v_pk_mul_f16 v187, v187, v137 op_sel:[0,1] op_sel_hi:[1,1]
    v_pk_mul_f16 v188, v188, v137 op_sel:[0,1] op_sel_hi:[1,1]
    v_mfma_f32_16x16x32_bf16 v[150:153], v[246:249], a[212:215], v[150:153]
    s_sub_u32 s19, s19, s34
    v_pk_mul_f16 v189, v189, v137 op_sel:[0,1] op_sel_hi:[1,1]
    v_pk_mul_f16 v120, v120, v137 op_sel:[0,1] op_sel_hi:[1,1]
    v_mfma_f32_16x16x32_f16 v[154:157], v[194:197], v[222:225], v[46:49]
    s_waitcnt lgkmcnt(0)
    buffer_store_dwordx4 v[114:117], v16, s[12:15], 0 offen nt
    v_pk_mul_f16 v121, v121, v137 op_sel:[0,1] op_sel_hi:[1,1]
    v_pk_mul_f16 v198, v198, v137 op_sel:[0,0] op_sel_hi:[1,0]
    v_cvt_pk_bf16_f32 v238, v150, v151
    v_cvt_pk_bf16_f32 v239, v152, v153
    v_mfma_f32_16x16x32_f16 v[114:117], v[202:205], v[222:225], v[50:53]
    s_add_u32 s23, s23, s35
    v_pk_mul_f16 v199, v199, v137 op_sel:[0,0] op_sel_hi:[1,0]
    v_pk_mul_f16 v200, v200, v137 op_sel:[0,0] op_sel_hi:[1,0]
    v_mfma_f32_16x16x32_f16 v[246:249], v[186:189], v[222:225], v[54:57]
    s_cmp_lg_u32 s83, 0
    v_pk_mul_f16 v201, v201, v137 op_sel:[0,0] op_sel_hi:[1,0]
    v_pk_mul_f16 v118, v118, v137 op_sel:[0,0] op_sel_hi:[1,0]
    v_pk_mul_f16 v119, v119, v137 op_sel:[0,0] op_sel_hi:[1,0]
    v_mfma_f32_16x16x16_f16 v[154:157], v[148:149], v[146:147], v[154:157]
    v_max3_u32 v44, v44, v166, v167
    v_exp_f32 v254, v254
    v_mfma_f32_16x16x16_f16 v[114:117], v[160:161], v[146:147], v[114:117]
    v_cvt_pk_bf16_f32 v254, v254, v254
    v_exp_f32 v168, v168
    v_mfma_f32_16x16x16_f16 v[246:249], v[120:121], v[146:147], v[246:249]
    v_mul_f32 v233, v134, v233
    v_cvt_pk_bf16_f32 v231, v232, v233
    v_exp_f32 v154, v154
    v_mfma_f32_16x16x32_f16 v[162:165], v[194:197], v[122:125], v[58:61]
    s_cselect_b32 s77, s80, s77
    ds_write_b16 v8, v254
    v_mfma_f32_16x16x32_f16 v[138:141], v[202:205], v[122:125], v[62:65]
    s_mul_i32 s78, s77, 2688
    v_exp_f32 v155, v155
    v_mfma_f32_16x16x32_f16 v[234:237], v[186:189], v[122:125], v[66:69]
    s_add_u32 s78, s78, s69
    v_cvt_pk_bf16_f32 v218, v154, v155
    v_exp_f32 v156, v156
    v_mfma_f32_16x16x16_f16 v[162:165], v[148:149], v[158:159], v[162:165]
    v_exp_f32 v157, v157
    v_xor_b32 v0, 65536, v0
    v_mfma_f32_16x16x16_f16 v[138:141], v[160:161], v[158:159], v[138:141]
    v_cvt_pk_bf16_f32 v219, v156, v157
    v_exp_f32 v114, v114
    v_mfma_f32_16x16x16_f16 v[234:237], v[120:121], v[158:159], v[234:237]
    v_exp_f32 v115, v115
    v_exp_f32 v116, v116
    v_mfma_f32_16x16x32_bf16 v[122:125], a[216:219], v[242:245], 0
    s_add_u32 s80, s77, s68
    v_exp_f32 v162, v162
    v_mfma_f32_16x16x32_bf16 v[122:125], a[220:223], v[174:177], v[122:125]
    s_cmp_ge_u32 s80, 72
    v_exp_f32 v163, v163
    v_mfma_f32_16x16x32_f16 v[222:225], v[194:197], v[198:201], v[70:73]
    s_cselect_b32 s80, s22, 0
    v_cvt_pk_bf16_f32 v158, v162, v163
    v_cvt_pk_bf16_f32 v220, v114, v115
    v_mfma_f32_16x16x32_f16 v[134:137], v[202:205], v[198:201], v[74:77]
    s_add_u32 s78, s78, s80
    v_exp_f32 v164, v164
    v_mfma_f32_16x16x32_f16 v[194:197], v[186:189], v[198:201], v[78:81]
    buffer_store_dwordx2 v[230:231], v19, s[12:15], 0 offen nt
    v_exp_f32 v165, v165
    v_mfma_f32_16x16x16_f16 v[222:225], v[148:149], v[118:119], v[222:225]
    v_cvt_pk_bf16_f32 v159, v164, v165
    v_exp_f32 v138, v138
    v_mfma_f32_16x16x16_f16 v[134:137], v[160:161], v[118:119], v[134:137]
    v_exp_f32 v139, v139
    v_xor_b32 v1, 65536, v1
    v_mfma_f32_16x16x16_f16 v[194:197], v[120:121], v[118:119], v[194:197]
    v_cvt_pk_bf16_f32 v160, v138, v139
    v_exp_f32 v140, v140
    v_add_u32 v6, s75, v6
    v_mfma_f32_16x16x32_bf16 v[122:125], a[224:227], v[170:173], v[122:125]
    s_add_u32 s80, s77, 20
    v_exp_f32 v141, v141
    v_mfma_f32_16x16x32_bf16 v[122:125], a[228:231], v[214:217], v[122:125]
    s_add_u32 s34, s18, 3
    v_exp_f32 v234, v234
    v_mfma_f32_16x16x32_bf16 v[122:125], a[232:235], v[182:185], v[122:125]
    s_cmp_lt_u32 s77, s62
    v_exp_f32 v235, v235
    v_mfma_f32_16x16x32_bf16 v[122:125], a[236:239], v[178:181], v[122:125]
    s_cselect_b32 s79, 1, 0
    v_exp_f32 v236, v236
    v_mfma_f32_16x16x32_bf16 v[154:157], a[240:243], v[242:245], 0
    s_cselect_b32 s78, s78, 0
    ds_read_b128 v[150:153], v2 offset:6144
    v_cvt_pk_bf16_f32 v161, v140, v141
    v_mfma_f32_16x16x32_bf16 v[154:157], a[244:247], v[174:177], v[154:157]
    s_cmp_lt_u32 s34, s17
    ds_read_b128 v[162:165], v2 offset:7168
    v_fma_f32 v255, v122, v122, s33
    v_mfma_f32_16x16x32_bf16 v[154:157], a[248:251], v[170:173], v[154:157]
    s_cselect_b32 s23, s23, s78
    ds_read_b128 v[186:189], v2 offset:8192
    v_fmac_f32 v255, v123, v123
    v_mfma_f32_16x16x32_bf16 v[154:157], a[252:255], v[214:217], v[154:157]
    s_cselect_b32 s73, s34, s80
    ds_read_b128 v[138:141], v2 offset:9216
    v_fmac_f32 v255, v124, v124
    v_mfma_f32_16x16x32_bf16 v[154:157], v[82:85], v[182:185], v[154:157]
    s_cselect_b32 s79, 0, s79
    ds_read_b128 v[118:121], v2 offset:10240
    v_fmac_f32 v255, v125, v125
    v_mfma_f32_16x16x32_bf16 v[154:157], v[86:89], v[178:181], v[154:157]
    s_cselect_b32 s81, 0, 1
    ds_read_b128 v[198:201], v2 offset:11264
    s_add_u32 s80, s77, 1
    v_mfma_f32_16x16x32_bf16 v[202:205], v[90:93], v[242:245], 0
    s_mul_i32 s80, s80, s81
    v_exp_f32 v237, v237
    v_mfma_f32_16x16x32_bf16 v[202:205], v[94:97], v[174:177], v[202:205]
    s_cmp_lt_u32 s80, s62
    v_exp_f32 v117, v117
    v_mfma_f32_16x16x32_bf16 v[202:205], v[98:101], v[170:173], v[202:205]
    s_waitcnt lgkmcnt(5)
    v_cvt_pk_bf16_f32 v221, v116, v117
    v_fmac_f32 v255, v154, v154
    v_mfma_f32_16x16x32_bf16 v[202:205], v[102:105], v[214:217], v[202:205]
    s_cselect_b32 s70, s70, 0
    v_exp_f32 v246, v246
    v_mfma_f32_16x16x32_bf16 v[202:205], v[106:109], v[182:185], v[202:205]
    s_cselect_b32 s62, s62, 0
    v_exp_f32 v247, v247
    v_mfma_f32_16x16x32_bf16 v[202:205], v[110:113], v[178:181], v[202:205]
    s_add_u32 s80, s18, 4
    v_cvt_pk_bf16_f32 v36, v246, v247
    v_fmac_f32 v255, v155, v155
    v_mfma_f32_16x16x32_bf16 v[114:117], a[216:219], v[150:153], 0
    s_waitcnt lgkmcnt(1)
    v_exp_f32 v248, v248
    v_mfma_f32_16x16x32_bf16 v[114:117], a[220:223], v[162:165], v[114:117]
    s_cmp_ge_u32 s80, s17
    v_exp_f32 v249, v249
    v_mfma_f32_16x16x32_bf16 v[114:117], a[224:227], v[186:189], v[114:117]
    s_cselect_b32 s66, s70, 0
    v_cvt_pk_bf16_f32 v37, v248, v249
    v_fmac_f32 v255, v156, v156
    v_mfma_f32_16x16x32_bf16 v[114:117], a[228:231], v[138:141], v[114:117]
    s_waitcnt lgkmcnt(0)
    v_fmac_f32 v255, v157, v157
    v_mfma_f32_16x16x32_bf16 v[178:181], v[28:31], v[36:39], 0
    s_lshl_b32 s80, s79, s73
    v_exp_f32 v222, v222
    v_mfma_f32_16x16x32_bf16 v[178:181], v[28:31], v[218:221], v[178:181]
    s_or_b32 s63, s63, s80
    v_exp_f32 v223, v223
    v_mfma_f32_16x16x32_bf16 v[146:149], v[142:145], v[36:39], 0
    s_sub_u32 s80, s100, s81
    v_cvt_pk_bf16_f32 v226, v222, v223
    v_fmac_f32 v255, v202, v202
    v_mfma_f32_16x16x32_bf16 v[146:149], v[126:129], v[218:221], v[146:149]
    s_and_b32 s100, s100, s80
    v_exp_f32 v224, v224
    v_mfma_f32_16x16x32_bf16 v[246:249], v[210:213], v[36:39], 0
    s_add_u32 s45, s45, s79
    v_exp_f32 v225, v225
    v_mfma_f32_16x16x32_bf16 v[246:249], v[130:133], v[218:221], v[246:249]
    s_add_u32 s18, s18, 1
    v_cvt_pk_bf16_f32 v227, v224, v225
    v_fmac_f32 v255, v203, v203
    v_mfma_f32_16x16x32_bf16 v[222:225], v[238:241], v[36:39], 0
    s_cmp_lt_u32 s18, s45
    v_cvt_pk_bf16_f32 v36, v234, v235
    v_cvt_pk_bf16_f32 v37, v236, v237
    v_mfma_f32_16x16x32_bf16 v[222:225], v[190:193], v[218:221], v[222:225]
    v_cvt_pk_bf16_f32 v39, v208, 0
    v_fmac_f32 v255, v204, v204
    v_mfma_f32_16x16x32_bf16 v[114:117], a[232:235], v[118:121], v[114:117]
    v_exp_f32 v134, v134
    v_mfma_f32_16x16x32_bf16 v[182:185], v[28:31], v[36:39], 0
    v_exp_f32 v135, v135
    v_mfma_f32_16x16x32_bf16 v[182:185], v[28:31], v[158:161], v[182:185]
    v_cvt_pk_bf16_f32 v228, v134, v135
    v_fmac_f32 v255, v205, v205
    v_mfma_f32_16x16x32_bf16 v[230:233], v[142:145], v[36:39], 0
    v_exp_f32 v136, v136
    v_mfma_f32_16x16x32_bf16 v[230:233], v[126:129], v[158:161], v[230:233]
    v_exp_f32 v137, v137
    v_mfma_f32_16x16x32_bf16 v[170:173], v[210:213], v[36:39], 0
    v_exp_f32 v194, v194
    v_mfma_f32_16x16x32_bf16 v[170:173], v[130:133], v[158:161], v[170:173]
    v_rcp_f32 v182, v182
    v_mfma_f32_16x16x32_bf16 v[174:177], v[238:241], v[36:39], 0
    v_cvt_pk_bf16_f32 v229, v136, v137
    v_cvt_pk_bf16_f32 v39, v168, 0
    v_mfma_f32_16x16x32_bf16 v[174:177], v[190:193], v[158:161], v[174:177]
    v_mul_f32 v230, v182, v230
    v_mul_f32 v231, v182, v231
    v_mfma_f32_16x16x32_bf16 v[114:117], a[236:239], v[198:201], v[114:117]
    v_cvt_pk_bf16_f32 v134, v230, v231
    v_mul_f32 v232, v182, v232
    v_mfma_f32_16x16x32_bf16 v[166:169], a[240:243], v[150:153], 0
    ds_read_b128 v[214:217], v2 offset:12288
    v_mul_f32 v233, v182, v233
    v_mfma_f32_16x16x32_bf16 v[166:169], a[244:247], v[162:165], v[166:169]
    ds_read_b128 v[234:237], v2 offset:13312
    v_cvt_pk_bf16_f32 v135, v232, v233
    v_mfma_f32_16x16x32_bf16 v[166:169], a[248:251], v[186:189], v[166:169]
    ds_read_b128 v[218:221], v2 offset:14336
    v_fma_f32 v254, v114, v114, s33
    v_mfma_f32_16x16x32_bf16 v[166:169], a[252:255], v[138:141], v[166:169]
    ds_read_b128 v[158:161], v2 offset:15360
    v_fmac_f32 v254, v115, v115
    v_mfma_f32_16x16x32_bf16 v[166:169], v[82:85], v[118:121], v[166:169]
    ds_read_b128 v[206:209], v2 offset:16384
    v_fmac_f32 v254, v116, v116
    v_mfma_f32_16x16x32_bf16 v[166:169], v[86:89], v[198:201], v[166:169]
    ds_read_b128 v[242:245], v2 offset:17408
    v_fmac_f32 v254, v117, v117
    v_mfma_f32_16x16x32_bf16 v[230:233], v[90:93], v[150:153], 0
    v_mul_f32 v170, v182, v170
    v_mul_f32 v171, v182, v171
    v_mfma_f32_16x16x32_bf16 v[230:233], v[94:97], v[162:165], v[230:233]
    v_cvt_pk_bf16_f32 v136, v170, v171
    v_mul_f32 v172, v182, v172
    v_mfma_f32_16x16x32_bf16 v[230:233], v[98:101], v[186:189], v[230:233]
    s_waitcnt lgkmcnt(5)
    v_fmac_f32 v254, v166, v166
    v_fmac_f32 v254, v167, v167
    v_mfma_f32_16x16x32_bf16 v[230:233], v[102:105], v[138:141], v[230:233]
    s_waitcnt lgkmcnt(4)
    v_fmac_f32 v254, v168, v168
    v_fmac_f32 v254, v169, v169
    v_mfma_f32_16x16x32_bf16 v[230:233], v[106:109], v[118:121], v[230:233]
    s_waitcnt lgkmcnt(3)
    v_mul_f32 v173, v182, v173
    v_cvt_pk_bf16_f32 v137, v172, v173
    v_mfma_f32_16x16x32_bf16 v[230:233], v[110:113], v[198:201], v[230:233]
    s_waitcnt lgkmcnt(2)
    ds_write_b128 v3, v[134:137] offset:6144
    v_mfma_f32_16x16x32_bf16 v[150:153], a[216:219], v[214:217], 0
    s_waitcnt lgkmcnt(1)
    v_mul_f32 v174, v182, v174
    v_mul_f32 v175, v182, v175
    v_mfma_f32_16x16x32_bf16 v[150:153], a[220:223], v[234:237], v[150:153]
    v_cvt_pk_bf16_f32 v174, v174, v175
    v_fmac_f32 v254, v230, v230
    v_mfma_f32_16x16x32_bf16 v[150:153], a[224:227], v[218:221], v[150:153]
    v_fmac_f32 v254, v231, v231
    v_fmac_f32 v254, v232, v232
    v_mfma_f32_16x16x32_bf16 v[150:153], a[228:231], v[158:161], v[150:153]
    v_fmac_f32 v254, v233, v233
    v_cvt_pk_bf16_f32 v254, v255, v254
    v_mfma_f32_16x16x32_bf16 v[150:153], a[232:235], v[206:209], v[150:153]
    v_mul_f32 v176, v182, v176
    v_mul_f32 v177, v182, v177
    v_mfma_f32_16x16x32_bf16 v[150:153], a[236:239], v[242:245], v[150:153]
    v_cvt_pk_bf16_f32 v175, v176, v177
    v_xor_b32 v2, 65536, v2
    v_mfma_f32_16x16x32_bf16 v[162:165], a[240:243], v[214:217], 0
    ds_write_b64 v4, v[174:175] offset:10240
    v_mfma_f32_16x16x32_bf16 v[162:165], a[244:247], v[234:237], v[162:165]
    v_exp_f32 v195, v195
    v_mfma_f32_16x16x32_bf16 v[162:165], a[248:251], v[218:221], v[162:165]
    v_exp_f32 v196, v196
    v_mfma_f32_16x16x32_bf16 v[162:165], a[252:255], v[158:161], v[162:165]
    v_fma_f32 v255, v150, v150, s33
    v_fmac_f32 v255, v151, v151
    v_mfma_f32_16x16x32_bf16 v[162:165], v[82:85], v[206:209], v[162:165]
    v_fmac_f32 v255, v152, v152
    v_fmac_f32 v255, v153, v153
    v_mfma_f32_16x16x32_bf16 v[162:165], v[86:89], v[242:245], v[162:165]
    v_exp_f32 v197, v197
    v_mfma_f32_16x16x32_bf16 v[138:141], v[90:93], v[214:217], 0
    ds_read_b128 v[186:189], v0 offset:20480
    v_cvt_pk_bf16_f32 v36, v194, v195
    v_mfma_f32_16x16x32_bf16 v[138:141], v[94:97], v[234:237], v[138:141]
    ds_read_b128 v[118:121], v1 offset:20480
    v_cvt_pk_bf16_f32 v37, v196, v197
    v_mfma_f32_16x16x32_bf16 v[138:141], v[98:101], v[218:221], v[138:141]
    ds_read_b128 v[234:237], v0 offset:20608
    v_fmac_f32 v255, v162, v162
    v_mfma_f32_16x16x32_bf16 v[198:201], v[28:31], v[36:39], 0
    ds_read_b128 v[214:217], v9
    v_fmac_f32 v255, v163, v163
    v_mfma_f32_16x16x32_bf16 v[198:201], v[28:31], v[226:229], v[198:201]
    ds_read_b128 v[194:197], v9 offset:64
    v_fmac_f32 v255, v164, v164
    v_mfma_f32_16x16x32_bf16 v[170:173], v[142:145], v[36:39], 0
    v_rcp_f32 v178, v178
    v_mfma_f32_16x16x32_bf16 v[170:173], v[126:129], v[226:229], v[170:173]
    v_fmac_f32 v255, v165, v165
    v_mul_f32 v146, v178, v146
    v_mfma_f32_16x16x32_bf16 v[218:221], v[210:213], v[36:39], 0
    v_rcp_f32 v198, v198
    v_mfma_f32_16x16x32_bf16 v[218:221], v[130:133], v[226:229], v[218:221]
    s_waitcnt lgkmcnt(4)
    v_mul_f32 v147, v178, v147
    v_cvt_pk_bf16_f32 v146, v146, v147
    v_mfma_f32_16x16x32_bf16 v[174:177], v[238:241], v[36:39], 0
    s_waitcnt lgkmcnt(3)
    v_mul_f32 v170, v198, v170
    v_mul_f32 v171, v198, v171
    v_mfma_f32_16x16x32_bf16 v[174:177], v[190:193], v[226:229], v[174:177]
    s_waitcnt lgkmcnt(2)
    v_cvt_pk_bf16_f32 v226, v170, v171
    v_mul_f32 v172, v198, v172
    v_mfma_f32_16x16x32_bf16 v[138:141], v[102:105], v[158:161], v[138:141]
    s_waitcnt lgkmcnt(1)
    ds_read_b128 v[158:161], v1 offset:20608
    v_mul_f32 v173, v198, v173
    v_mfma_f32_16x16x32_bf16 v[138:141], v[106:109], v[206:209], v[138:141]
    s_waitcnt lgkmcnt(1)
    ds_read_b128 v[182:185], v0 offset:20736
    v_cvt_pk_bf16_f32 v227, v172, v173
    v_mfma_f32_16x16x32_bf16 v[138:141], v[110:113], v[242:245], v[138:141]
    ds_read_b128 v[206:209], v1 offset:20736
    v_mul_f32 v218, v198, v218
    v_mfma_f32_16x16x32_bf16 v[242:245], v[214:217], v[28:31], 0
    v_mul_f32 v219, v198, v219
    v_cvt_pk_bf16_f32 v228, v218, v219
    v_mfma_f32_16x16x32_bf16 v[242:245], v[194:197], v[28:31], v[242:245]
    v_mul_f32 v220, v198, v220
    v_mul_f32 v221, v198, v221
    v_mfma_f32_16x16x32_bf16 v[170:173], v[214:217], v[126:129], 0
    v_fmac_f32 v255, v138, v138
    v_fmac_f32 v255, v139, v139
    v_mfma_f32_16x16x32_bf16 v[170:173], v[194:197], v[142:145], v[170:173]
    v_fmac_f32 v255, v140, v140
    v_fmac_f32 v255, v141, v141
    v_mfma_f32_16x16x32_bf16 v[126:129], v[214:217], v[130:133], 0
    v_cvt_pk_bf16_f32 v255, v255, v255
    v_cvt_pk_bf16_f32 v229, v220, v221
    v_mfma_f32_16x16x32_bf16 v[126:129], v[194:197], v[210:213], v[126:129]
    s_waitcnt lgkmcnt(2)
    ds_write_b128 v3, v[226:229] offset:12288
    v_mfma_f32_16x16x32_bf16 v[130:133], v[214:217], v[190:193], 0
    s_waitcnt lgkmcnt(1)
    v_rcp_f32 v242, v242
    v_mfma_f32_16x16x32_bf16 v[130:133], v[194:197], v[238:241], v[130:133]
    v_mul_f32 v170, v170, v242
    v_mul_f32 v174, v198, v174
    v_mfma_f32_16x16x32_bf16 v[190:193], a[72:75], v[186:189], 0
    ds_write_b64 v4, v[254:255] offset:18432
    v_mfma_f32_16x16x32_bf16 v[190:193], a[76:79], v[118:121], v[190:193]
    v_mul_f32_dpp v170, v126, v242 quad_perm:[0,1,2,3] row_mask:0x2 bank_mask:0xf
    v_mul_f32 v175, v198, v175
    v_mfma_f32_16x16x32_bf16 v[190:193], a[80:83], v[234:237], v[190:193]
    v_mul_f32_dpp v170, v130, v242 quad_perm:[0,1,2,3] row_mask:0x4 bank_mask:0xf
    v_cvt_pk_bf16_f32 v170, v170, v170
    v_mfma_f32_16x16x32_bf16 v[190:193], a[84:87], v[158:161], v[190:193]
    ds_write_b16 v7, v170
    v_mfma_f32_16x16x32_bf16 v[190:193], a[88:91], v[182:185], v[190:193]
    v_cvt_pk_bf16_f32 v254, v174, v175
    v_mul_f32 v176, v198, v176
    v_mfma_f32_16x16x32_bf16 v[190:193], a[92:95], v[206:209], v[190:193]
    v_mul_f32 v177, v198, v177
    v_cvt_pk_bf16_f32 v255, v176, v177
    v_mfma_f32_16x16x32_bf16 v[130:133], a[96:99], v[186:189], 0
    ds_write_b64 v4, v[254:255] offset:16384
    v_mfma_f32_16x16x32_bf16 v[130:133], a[100:103], v[118:121], v[130:133]
    v_mul_f32 v148, v178, v148
    v_mul_f32 v149, v178, v149
    v_mfma_f32_16x16x32_bf16 v[130:133], a[104:107], v[234:237], v[130:133]
    v_cvt_pk_bf16_f32 v147, v148, v149
    v_mul_f32 v246, v178, v246
    v_mfma_f32_16x16x32_bf16 v[130:133], a[108:111], v[158:161], v[130:133]
    v_mul_f32 v247, v178, v247
    v_cvt_pk_bf16_f32 v148, v246, v247
    v_mfma_f32_16x16x32_bf16 v[130:133], a[112:115], v[182:185], v[130:133]
    v_mul_f32 v248, v178, v248
    v_mul_f32 v249, v178, v249
    v_mfma_f32_16x16x32_bf16 v[130:133], a[116:119], v[206:209], v[130:133]
    v_cvt_pk_bf16_f32 v149, v248, v249
    v_mul_f32 v222, v178, v222
    v_mfma_f32_16x16x32_bf16 v[126:129], a[120:123], v[186:189], 0
    ds_write_b128 v3, v[146:149] offset:0
    v_mfma_f32_16x16x32_bf16 v[126:129], a[124:127], v[118:121], v[126:129]
    v_mul_f32 v223, v178, v223
    v_cvt_pk_bf16_f32 v254, v222, v223
    v_mfma_f32_16x16x32_bf16 v[126:129], a[128:131], v[234:237], v[126:129]
    v_mul_f32 v224, v178, v224
    v_mul_f32 v225, v178, v225
    v_mfma_f32_16x16x32_bf16 v[126:129], a[132:135], v[158:161], v[126:129]
    v_cvt_pk_bf16_f32 v255, v224, v225
    v_xor_b32 v3, 65536, v3
    v_mfma_f32_16x16x32_bf16 v[126:129], a[136:139], v[182:185], v[126:129]
    ds_write_b64 v4, v[254:255] offset:4096
    v_mfma_f32_16x16x32_bf16 v[126:129], a[140:143], v[206:209], v[126:129]
    v_xor_b32 v4, 65536, v4
    v_cvt_pk_f16_f32 v194, v190, v191
    v_mfma_f32_16x16x32_bf16 v[142:145], a[0:3], v[186:189], 0
    v_pk_mul_f16 v191, v194, v194
    v_cvt_pk_f16_f32 v195, v192, v193
    v_mfma_f32_16x16x32_bf16 v[142:145], a[4:7], v[118:121], v[142:145]
    v_pk_fma_f16 v191, v195, v195, v191
    v_cvt_pk_f16_f32 v196, v130, v131
    v_mfma_f32_16x16x32_bf16 v[142:145], a[8:11], v[234:237], v[142:145]
    v_pk_fma_f16 v191, v196, v196, v191
    v_cvt_pk_f16_f32 v197, v132, v133
    v_mfma_f32_16x16x32_bf16 v[142:145], a[12:15], v[158:161], v[142:145]
    v_pk_fma_f16 v191, v197, v197, v191
    v_cvt_pk_f16_f32 v148, v126, v127
    v_mfma_f32_16x16x32_bf16 v[142:145], a[16:19], v[182:185], v[142:145]
    v_pk_fma_f16 v191, v148, v148, v191
    v_cvt_pk_f16_f32 v149, v128, v129
    v_mfma_f32_16x16x32_bf16 v[142:145], a[20:23], v[206:209], v[142:145]
    s_waitcnt lgkmcnt(0)
    v_pk_fma_f16 v191, v149, v149, v191
    v_add_u32 v7, s76, v7
    v_mfma_f32_16x16x32_bf16 v[126:129], a[24:27], v[186:189], 0
    s_nop 0
    v_mfma_f32_16x16x32_bf16 v[126:129], a[28:31], v[118:121], v[126:129]
    s_nop 0
    v_mfma_f32_16x16x32_bf16 v[126:129], a[32:35], v[234:237], v[126:129]
    s_barrier
    v_mfma_f32_16x16x32_bf16 v[126:129], a[36:39], v[158:161], v[126:129]
    s_nop 0
    v_mfma_f32_16x16x32_bf16 v[126:129], a[40:43], v[182:185], v[126:129]
    v_mfma_f32_16x16x32_bf16 v[126:129], a[44:47], v[206:209], v[126:129]
    s_cbranch_scc1 L_loop_fast2
    s_branch L_final_fast
.p2align 6
L_loop_fast3:
    v_mfma_f32_16x16x32_bf16 v[130:133], a[48:51], v[186:189], 0
    s_add_u32 s12, s40, s27
    ds_read_b128 v[246:249], v2 offset:18432
    v_cvt_pk_f16_f32 v222, v142, v143
    v_mfma_f32_16x16x32_bf16 v[130:133], a[52:55], v[118:121], v[130:133]
    s_addc_u32 s13, s41, 0
    ds_read_b128 v[210:213], v2 offset:19456
    v_pk_mul_f16 v190, v222, v222
    v_mfma_f32_16x16x32_bf16 v[130:133], a[56:59], v[234:237], v[130:133]
    s_sub_u32 s14, s36, s27
    ds_read_b128 v[238:241], v5 offset:32
    v_cvt_pk_f16_f32 v223, v144, v145
    v_mfma_f32_16x16x32_bf16 v[130:133], a[60:63], v[158:161], v[130:133]
    s_cmp_ge_u32 s18, 2
    ds_read2_b64 v[226:229], v5 offset0:6 offset1:9
    v_pk_fma_f16 v190, v223, v223, v190
    v_mfma_f32_16x16x32_bf16 v[130:133], a[64:67], v[182:185], v[130:133]
    s_cselect_b32 s14, s14, 0
    ds_read_b128 v[142:145], v5
    v_cvt_pk_f16_f32 v224, v126, v127
    v_mfma_f32_16x16x32_bf16 v[130:133], a[68:71], v[206:209], v[130:133]
    s_sub_u32 s82, s72, s71
    ds_read_b32 v254, v6 offset:192
    v_pk_fma_f16 v190, v224, v224, v190
    v_mfma_f32_16x16x32_bf16 v[198:201], v[186:189], a[144:147], 0
    s_mul_i32 s74, s82, 336
    v_cvt_pk_f16_f32 v225, v128, v129
    v_pk_fma_f16 v190, v225, v225, v190
    v_mfma_f32_16x16x32_bf16 v[198:201], v[118:121], a[148:151], v[198:201]
    s_mul_i32 s75, s82, 272
    v_cvt_pk_f16_f32 v146, v130, v131
    v_pk_fma_f16 v190, v146, v146, v190
    v_mfma_f32_16x16x32_bf16 v[198:201], v[234:237], a[152:155], v[198:201]
    s_waitcnt lgkmcnt(5)
    v_cvt_pk_f16_f32 v147, v132, v133
    v_pk_fma_f16 v190, v147, v147, v190
    v_mfma_f32_16x16x32_bf16 v[130:133], v[32:35], v[246:249], 0
    s_waitcnt lgkmcnt(4)
    v_add_u32 v5, s74, v5
    s_mul_i32 s76, s82, 16
    v_mfma_f32_16x16x32_bf16 v[130:133], v[32:35], v[210:213], v[130:133]
    s_waitcnt lgkmcnt(3)
    v_pk_mul_f16 v193, v194, v238
    v_pk_fma_f16 v193, v195, v239, v193
    v_mfma_f32_16x16x32_bf16 v[198:201], v[158:161], a[156:159], v[198:201]
    s_add_u32 s34, s18, 2
    v_pk_fma_f16 v193, v196, v240, v193
    v_pk_fma_f16 v193, v197, v241, v193
    v_mfma_f32_16x16x32_bf16 v[198:201], v[182:185], a[160:163], v[198:201]
    s_waitcnt lgkmcnt(1)
    v_pk_fma_f16 v193, v148, v228, v193
    v_pk_fma_f16 v193, v149, v229, v193
    v_mfma_f32_16x16x32_bf16 v[198:201], v[206:209], a[164:167], v[198:201]
    s_waitcnt lgkmcnt(0)
    v_mov_b32_dpp v254, v23 quad_perm:[0,1,2,3] row_mask:0x7 bank_mask:0xf
    v_pk_mul_f16 v192, v222, v142
    v_mfma_f32_16x16x32_bf16 v[210:213], v[186:189], a[168:171], 0
    s_add_u32 s8, s60, s23
    v_pk_fma_f16 v192, v223, v143, v192
    v_pk_fma_f16 v192, v224, v144, v192
    v_mfma_f32_16x16x32_bf16 v[210:213], v[118:121], a[172:175], v[210:213]
    s_addc_u32 s9, s61, 0
    v_pk_fma_f16 v192, v225, v145, v192
    v_pk_fma_f16 v192, v146, v226, v192
    v_mfma_f32_16x16x32_bf16 v[210:213], v[234:237], a[176:179], v[210:213]
    s_sub_u32 s10, s36, s23
    ds_read_b128 v[246:249], v0 offset:26624
    v_pk_fma_f16 v192, v147, v227, v192
    v_mfma_f32_16x16x32_bf16 v[210:213], v[158:161], a[180:183], v[210:213]
    s_cmp_le_u32 s34, s45
    ds_read_b128 v[174:177], v1 offset:26624
    v_cvt_pk_bf16_f32 v126, v198, v199
    v_mfma_f32_16x16x32_f16 v[214:217], v[40:43], v[190:193], 0
    s_cselect_b32 s10, s10, 0
    v_cvt_pk_bf16_f32 v127, v200, v201
    v_mul_f32 v255, 0x3baaaaab, v130
    v_mfma_f32_16x16x32_bf16 v[210:213], v[182:185], a[184:187], v[210:213]
    s_add_u32 m0, s28, 0
    ds_read_b128 v[198:201], v0 offset:26752
    v_mul_f32 v134, 0x3baaaaab, v131
    v_mfma_f32_16x16x32_bf16 v[210:213], v[206:209], a[188:191], v[210:213]
    s_mov_b32 s27, s26
    ds_read_b128 v[242:245], v1 offset:26752
    v_mul_f32 v132, 0x3baaaaab, v132
    v_mfma_f32_16x16x32_bf16 v[190:193], v[186:189], a[192:195], 0
    s_mov_b32 s26, s25
    ds_read_b128 v[186:189], v0 offset:26880
    s_mov_b32 s25, s24
    v_mfma_f32_16x16x32_bf16 v[190:193], v[118:121], a[196:199], v[190:193]
    s_mov_b32 s24, s23
    ds_read_b128 v[118:121], v1 offset:26880
    v_cvt_pk_bf16_f32 v130, v210, v211
    v_mfma_f32_16x16x32_bf16 v[190:193], v[234:237], a[200:203], v[190:193]
    s_ff1_i32_b32 s80, s100
    v_rsq_f32 v214, v214
    v_mfma_f32_16x16x32_bf16 v[190:193], v[158:161], a[204:207], v[190:193]
    s_waitcnt lgkmcnt(5)
    v_rsq_f32 v215, v215
    v_mfma_f32_16x16x32_bf16 v[190:193], v[182:185], a[208:211], v[190:193]
    s_mov_b32 s71, s72
    v_mul_f32 v128, s31, v214
    v_cvt_pk_f16_f32 v129, v128, v215
    v_mfma_f32_16x16x32_bf16 v[190:193], v[206:209], a[212:215], v[190:193]
    s_mov_b32 s72, s73
    v_cvt_pk_bf16_f32 v131, v212, v213
    v_fma_f32 v216, v216, v128, v22
    v_mfma_f32_16x16x32_bf16 v[210:213], a[72:75], v[246:249], 0
    s_waitcnt lgkmcnt(3)
    v_fmac_f32_dpp v254, v217, v215 quad_perm:[0,1,2,3] row_mask:0x1 bank_mask:0xf
    v_pk_mul_f16 v194, v194, v129 op_sel:[0,1] op_sel_hi:[1,1]
    v_mfma_f32_16x16x32_bf16 v[210:213], a[76:79], v[174:177], v[210:213]
    s_waitcnt lgkmcnt(2)
    v_cvt_pk_bf16_f32 v190, v190, v191
    v_cvt_pk_bf16_f32 v191, v192, v193
    v_mfma_f32_16x16x32_bf16 v[210:213], a[80:83], v[198:201], v[210:213]
    s_waitcnt lgkmcnt(1)
    v_pk_mul_f16 v195, v195, v129 op_sel:[0,1] op_sel_hi:[1,1]
    v_pk_mul_f16 v196, v196, v129 op_sel:[0,1] op_sel_hi:[1,1]
    v_mfma_f32_16x16x32_bf16 v[210:213], a[84:87], v[242:245], v[210:213]
    s_waitcnt lgkmcnt(0)
    v_pk_mul_f16 v197, v197, v129 op_sel:[0,1] op_sel_hi:[1,1]
    v_pk_mul_f16 v148, v148, v129 op_sel:[0,1] op_sel_hi:[1,1]
    v_mfma_f32_16x16x32_bf16 v[210:213], a[88:91], v[186:189], v[210:213]
    v_pk_mul_f16 v149, v149, v129 op_sel:[0,1] op_sel_hi:[1,1]
    v_pk_mul_f16 v222, v222, v129 op_sel:[0,0] op_sel_hi:[1,0]
    v_mfma_f32_16x16x32_bf16 v[210:213], a[92:95], v[118:121], v[210:213]
    v_pk_mul_f16 v223, v223, v129 op_sel:[0,0] op_sel_hi:[1,0]
    v_pk_mul_f16 v224, v224, v129 op_sel:[0,0] op_sel_hi:[1,0]
    v_mfma_f32_16x16x32_bf16 v[206:209], a[96:99], v[246:249], 0
    v_pk_mul_f16 v225, v225, v129 op_sel:[0,0] op_sel_hi:[1,0]
    v_pk_mul_f16 v146, v146, v129 op_sel:[0,0] op_sel_hi:[1,0]
    v_mfma_f32_16x16x32_bf16 v[206:209], a[100:103], v[174:177], v[206:209]
    v_pk_mul_f16 v147, v147, v129 op_sel:[0,0] op_sel_hi:[1,0]
    v_max3_u32 v44, v44, v214, v215
    v_mfma_f32_16x16x32_bf16 v[206:209], a[104:107], v[198:201], v[206:209]
    v_rsq_f32 v255, v255
    v_mfma_f32_16x16x32_bf16 v[206:209], a[108:111], v[242:245], v[206:209]
    v_rsq_f32 v134, v134
    v_mfma_f32_16x16x32_bf16 v[206:209], a[112:115], v[186:189], v[206:209]
    v_rsq_f32 v132, v132
    v_mfma_f32_16x16x32_bf16 v[206:209], a[116:119], v[118:121], v[206:209]
    v_mul_f32 v122, v255, v122
    v_mul_f32 v123, v255, v123
    v_mfma_f32_16x16x32_bf16 v[234:237], a[120:123], v[246:249], 0
    v_cvt_pk_bf16_f32 v122, v122, v123
    v_mul_f32 v124, v255, v124
    v_mfma_f32_16x16x32_bf16 v[234:237], a[124:127], v[174:177], v[234:237]
    v_mul_f32 v125, v255, v125
    v_cvt_pk_bf16_f32 v123, v124, v125
    v_mfma_f32_16x16x32_bf16 v[234:237], a[128:131], v[198:201], v[234:237]
    v_mul_f32 v154, v255, v154
    v_mul_f32 v155, v255, v155
    v_mfma_f32_16x16x32_bf16 v[234:237], a[132:135], v[242:245], v[234:237]
    v_cvt_pk_bf16_f32 v124, v154, v155
    v_mul_f32 v156, v255, v156
    v_mfma_f32_16x16x32_bf16 v[234:237], a[136:139], v[186:189], v[234:237]
    v_mul_f32 v157, v255, v157
    v_cvt_pk_bf16_f32 v125, v156, v157
    v_mfma_f32_16x16x32_bf16 v[234:237], a[140:143], v[118:121], v[234:237]
    buffer_store_dwordx4 v[122:125], v15, s[12:15], 0 offen nt
    v_mul_f32 v202, v255, v202
    v_mul_f32 v203, v255, v203
    v_cvt_pk_bf16_f32 v128, v202, v203
    v_mul_f32 v204, v255, v204
    v_mfma_f32_16x16x32_bf16 v[122:125], a[0:3], v[246:249], 0
    v_mul_f32 v205, v255, v205
    v_cvt_pk_bf16_f32 v129, v204, v205
    v_mfma_f32_16x16x32_bf16 v[122:125], a[4:7], v[174:177], v[122:125]
    v_cvt_pk_f16_f32 v202, v210, v211
    v_pk_mul_f16 v211, v202, v202
    v_mfma_f32_16x16x32_bf16 v[122:125], a[8:11], v[198:201], v[122:125]
    v_cvt_pk_f16_f32 v203, v212, v213
    v_pk_fma_f16 v211, v203, v203, v211
    v_mfma_f32_16x16x32_bf16 v[122:125], a[12:15], v[242:245], v[122:125]
    v_cvt_pk_f16_f32 v204, v206, v207
    v_pk_fma_f16 v211, v204, v204, v211
    v_mfma_f32_16x16x32_bf16 v[122:125], a[16:19], v[186:189], v[122:125]
    v_cvt_pk_f16_f32 v205, v208, v209
    v_pk_fma_f16 v211, v205, v205, v211
    v_mfma_f32_16x16x32_bf16 v[122:125], a[20:23], v[118:121], v[122:125]
    v_cvt_pk_f16_f32 v160, v234, v235
    v_pk_fma_f16 v211, v160, v160, v211
    v_mfma_f32_16x16x32_bf16 v[154:157], a[24:27], v[246:249], 0
    v_cvt_pk_f16_f32 v161, v236, v237
    v_pk_fma_f16 v211, v161, v161, v211
    v_mfma_f32_16x16x32_bf16 v[154:157], a[28:31], v[174:177], v[154:157]
    v_pk_mul_f16 v213, v202, v238
    v_pk_fma_f16 v213, v203, v239, v213
    v_mfma_f32_16x16x32_bf16 v[154:157], a[32:35], v[198:201], v[154:157]
    v_cvt_pk_f16_f32 v122, v122, v123
    v_pk_mul_f16 v210, v122, v122
    v_mfma_f32_16x16x32_bf16 v[154:157], a[36:39], v[242:245], v[154:157]
    v_cvt_pk_f16_f32 v123, v124, v125
    v_pk_fma_f16 v210, v123, v123, v210
    v_mfma_f32_16x16x32_bf16 v[154:157], a[40:43], v[186:189], v[154:157]
    v_pk_mul_f16 v212, v122, v142
    v_pk_fma_f16 v212, v123, v143, v212
    v_mfma_f32_16x16x32_bf16 v[154:157], a[44:47], v[118:121], v[154:157]
    v_pk_fma_f16 v213, v204, v240, v213
    v_pk_fma_f16 v213, v205, v241, v213
    v_mfma_f32_16x16x32_bf16 v[206:209], a[48:51], v[246:249], 0
    v_pk_fma_f16 v213, v160, v228, v213
    v_pk_fma_f16 v213, v161, v229, v213
    v_mfma_f32_16x16x32_bf16 v[206:209], a[52:55], v[174:177], v[206:209]
    v_mul_f32 v150, v132, v150
    v_mul_f32 v151, v132, v151
    v_mfma_f32_16x16x32_bf16 v[206:209], a[56:59], v[198:201], v[206:209]
    v_cvt_pk_f16_f32 v124, v154, v155
    v_pk_fma_f16 v210, v124, v124, v210
    v_mfma_f32_16x16x32_bf16 v[206:209], a[60:63], v[242:245], v[206:209]
    v_cvt_pk_f16_f32 v125, v156, v157
    v_pk_fma_f16 v210, v125, v125, v210
    v_mfma_f32_16x16x32_bf16 v[206:209], a[64:67], v[186:189], v[206:209]
    buffer_store_dwordx2 v[128:129], v18, s[12:15], 0 offen nt
    v_pk_fma_f16 v212, v124, v144, v212
    v_pk_fma_f16 v212, v125, v145, v212
    v_mfma_f32_16x16x32_bf16 v[206:209], a[68:71], v[118:121], v[206:209]
    v_cvt_pk_bf16_f32 v150, v150, v151
    v_mul_f32 v152, v132, v152
    v_mfma_f32_16x16x32_bf16 v[154:157], v[246:249], a[144:147], 0
    v_mul_f32 v153, v132, v153
    v_cvt_pk_bf16_f32 v151, v152, v153
    v_mfma_f32_16x16x32_bf16 v[154:157], v[174:177], a[148:151], v[154:157]
    v_mul_f32 v162, v132, v162
    v_mul_f32 v163, v132, v163
    v_mfma_f32_16x16x32_bf16 v[154:157], v[198:201], a[152:155], v[154:157]
    v_cvt_pk_f16_f32 v158, v206, v207
    v_pk_fma_f16 v210, v158, v158, v210
    v_mfma_f32_16x16x32_bf16 v[154:157], v[242:245], a[156:159], v[154:157]
    v_cvt_pk_f16_f32 v159, v208, v209
    v_pk_fma_f16 v210, v159, v159, v210
    v_mfma_f32_16x16x32_bf16 v[154:157], v[186:189], a[160:163], v[154:157]
    v_pk_fma_f16 v212, v158, v226, v212
    v_pk_fma_f16 v212, v159, v227, v212
    v_mfma_f32_16x16x32_bf16 v[154:157], v[118:121], a[164:167], v[154:157]
    v_cvt_pk_bf16_f32 v152, v162, v163
    v_mul_f32 v164, v132, v164
    v_mfma_f32_16x16x32_f16 v[206:209], v[40:43], v[210:213], 0
    v_mul_f32 v165, v132, v165
    v_cvt_pk_bf16_f32 v153, v164, v165
    v_mfma_f32_16x16x32_bf16 v[210:213], v[246:249], a[168:171], 0
    v_mul_f32 v138, v132, v138
    v_mul_f32 v139, v132, v139
    v_mfma_f32_16x16x32_bf16 v[210:213], v[174:177], a[172:175], v[210:213]
    v_cvt_pk_bf16_f32 v128, v154, v155
    v_cvt_pk_bf16_f32 v129, v156, v157
    v_mfma_f32_16x16x32_bf16 v[210:213], v[198:201], a[176:179], v[210:213]
    ds_read_b128 v[154:157], v0 offset:32768
    v_cvt_pk_bf16_f32 v136, v138, v139
    v_mfma_f32_16x16x32_bf16 v[210:213], v[242:245], a[180:183], v[210:213]
    ds_read_b128 v[162:165], v1 offset:32768
    v_mul_f32 v140, v132, v140
    v_mfma_f32_16x16x32_bf16 v[210:213], v[186:189], a[184:187], v[210:213]
    ds_read_b128 v[218:221], v0 offset:32896
    v_mul_f32 v141, v132, v141
    v_mfma_f32_16x16x32_bf16 v[210:213], v[118:121], a[188:191], v[210:213]
    ds_read_b128 v[234:237], v1 offset:32896
    v_cvt_pk_bf16_f32 v137, v140, v141
    v_mfma_f32_16x16x32_bf16 v[182:185], v[246:249], a[192:195], 0
    ds_read_b128 v[138:141], v0 offset:33024
    v_mul_f32 v114, v134, v114
    v_mfma_f32_16x16x32_bf16 v[182:185], v[174:177], a[196:199], v[182:185]
    ds_read_b128 v[246:249], v1 offset:33024
    v_mul_f32 v115, v134, v115
    v_mfma_f32_16x16x32_bf16 v[182:185], v[198:201], a[200:203], v[182:185]
    buffer_store_dwordx4 v[150:153], v17, s[12:15], 0 offen nt
    v_rsq_f32 v206, v206
    v_rsq_f32 v207, v207
    v_mfma_f32_16x16x32_bf16 v[182:185], v[242:245], a[204:207], v[182:185]
    s_waitcnt lgkmcnt(5)
    v_mul_f32 v214, s31, v206
    v_cvt_pk_f16_f32 v215, v214, v207
    v_mfma_f32_16x16x32_bf16 v[182:185], v[186:189], a[208:211], v[182:185]
    s_waitcnt lgkmcnt(4)
    v_fma_f32 v208, v208, v214, v24
    v_fmac_f32_dpp v254, v209, v207 quad_perm:[0,1,2,3] row_mask:0x2 bank_mask:0xf
    v_mfma_f32_16x16x32_bf16 v[182:185], v[118:121], a[212:215], v[182:185]
    s_waitcnt lgkmcnt(3)
    v_cvt_pk_bf16_f32 v132, v210, v211
    v_cvt_pk_bf16_f32 v133, v212, v213
    v_mfma_f32_16x16x32_bf16 v[210:213], a[72:75], v[154:157], 0
    s_waitcnt lgkmcnt(2)
    v_pk_mul_f16 v202, v202, v215 op_sel:[0,1] op_sel_hi:[1,1]
    v_pk_mul_f16 v203, v203, v215 op_sel:[0,1] op_sel_hi:[1,1]
    v_mfma_f32_16x16x32_bf16 v[210:213], a[76:79], v[162:165], v[210:213]
    s_waitcnt lgkmcnt(1)
    v_cvt_pk_bf16_f32 v192, v182, v183
    v_cvt_pk_bf16_f32 v193, v184, v185
    v_mfma_f32_16x16x32_bf16 v[210:213], a[80:83], v[218:221], v[210:213]
    s_waitcnt lgkmcnt(0)
    v_pk_mul_f16 v204, v204, v215 op_sel:[0,1] op_sel_hi:[1,1]
    v_pk_mul_f16 v205, v205, v215 op_sel:[0,1] op_sel_hi:[1,1]
    v_mfma_f32_16x16x32_bf16 v[210:213], a[84:87], v[234:237], v[210:213]
    v_pk_mul_f16 v160, v160, v215 op_sel:[0,1] op_sel_hi:[1,1]
    v_pk_mul_f16 v161, v161, v215 op_sel:[0,1] op_sel_hi:[1,1]
    v_mfma_f32_16x16x32_bf16 v[210:213], a[88:91], v[138:141], v[210:213]
    v_pk_mul_f16 v122, v122, v215 op_sel:[0,0] op_sel_hi:[1,0]
    v_pk_mul_f16 v123, v123, v215 op_sel:[0,0] op_sel_hi:[1,0]
    v_mfma_f32_16x16x32_bf16 v[210:213], a[92:95], v[246:249], v[210:213]
    v_pk_mul_f16 v124, v124, v215 op_sel:[0,0] op_sel_hi:[1,0]
    v_pk_mul_f16 v125, v125, v215 op_sel:[0,0] op_sel_hi:[1,0]
    v_mfma_f32_16x16x32_bf16 v[118:121], a[96:99], v[154:157], 0
    v_pk_mul_f16 v158, v158, v215 op_sel:[0,0] op_sel_hi:[1,0]
    v_pk_mul_f16 v159, v159, v215 op_sel:[0,0] op_sel_hi:[1,0]
    v_mfma_f32_16x16x32_bf16 v[118:121], a[100:103], v[162:165], v[118:121]
    v_max3_u32 v44, v44, v206, v207
    v_cvt_pk_bf16_f32 v114, v114, v115
    v_mfma_f32_16x16x32_bf16 v[118:121], a[104:107], v[218:221], v[118:121]
    v_cvt_pk_f16_f32 v186, v210, v211
    v_pk_mul_f16 v211, v186, v186
    v_mfma_f32_16x16x32_bf16 v[118:121], a[108:111], v[234:237], v[118:121]
    s_waitcnt vmcnt(3)
    ds_write_b16 v8, v45 offset:512
    v_mfma_f32_16x16x32_bf16 v[118:121], a[112:115], v[138:141], v[118:121]
    v_cvt_pk_f16_f32 v187, v212, v213
    v_mfma_f32_16x16x32_bf16 v[118:121], a[116:119], v[246:249], v[118:121]
    v_pk_fma_f16 v211, v187, v187, v211
    v_pk_mul_f16 v213, v186, v238
    v_mfma_f32_16x16x32_bf16 v[150:153], a[120:123], v[154:157], 0
    v_pk_fma_f16 v213, v187, v239, v213
    v_mul_f32 v116, v134, v116
    v_mfma_f32_16x16x32_bf16 v[150:153], a[124:127], v[162:165], v[150:153]
    buffer_store_dwordx2 v[136:137], v20, s[12:15], 0 offen nt
    v_exp_f32 v208, v208
    v_mfma_f32_16x16x32_bf16 v[150:153], a[128:131], v[218:221], v[150:153]
    v_cvt_pk_f16_f32 v188, v118, v119
    v_pk_fma_f16 v211, v188, v188, v211
    v_mfma_f32_16x16x32_bf16 v[150:153], a[132:135], v[234:237], v[150:153]
    v_cvt_pk_f16_f32 v189, v120, v121
    v_pk_fma_f16 v211, v189, v189, v211
    v_mfma_f32_16x16x32_bf16 v[150:153], a[136:139], v[138:141], v[150:153]
    s_waitcnt lgkmcnt(0)
    v_pk_fma_f16 v213, v188, v240, v213
    v_pk_fma_f16 v213, v189, v241, v213
    v_mfma_f32_16x16x32_bf16 v[150:153], a[140:143], v[246:249], v[150:153]
    v_mul_f32 v117, v134, v117
    v_mfma_f32_16x16x32_bf16 v[238:241], a[0:3], v[154:157], 0
    v_cvt_pk_bf16_f32 v115, v116, v117
    v_mfma_f32_16x16x32_bf16 v[238:241], a[4:7], v[162:165], v[238:241]
    v_mul_f32 v166, v134, v166
    v_mfma_f32_16x16x32_bf16 v[238:241], a[8:11], v[218:221], v[238:241]
    s_barrier
    ds_read_u16 v255, v9 offset:128
    v_mfma_f32_16x16x32_bf16 v[238:241], a[12:15], v[234:237], v[238:241]
    v_cvt_pk_f16_f32 v120, v150, v151
    v_pk_fma_f16 v211, v120, v120, v211
    v_mfma_f32_16x16x32_bf16 v[238:241], a[16:19], v[138:141], v[238:241]
    v_cvt_pk_f16_f32 v121, v152, v153
    v_pk_fma_f16 v211, v121, v121, v211
    v_mfma_f32_16x16x32_bf16 v[238:241], a[20:23], v[246:249], v[238:241]
    v_pk_fma_f16 v213, v120, v228, v213
    v_pk_fma_f16 v213, v121, v229, v213
    v_mfma_f32_16x16x32_bf16 v[150:153], a[24:27], v[154:157], 0
    v_exp_f32 v216, v216
    v_mfma_f32_16x16x32_bf16 v[150:153], a[28:31], v[162:165], v[150:153]
    v_cvt_pk_bf16_f32 v39, v216, 0
    v_mul_f32 v167, v134, v167
    v_mfma_f32_16x16x32_bf16 v[150:153], a[32:35], v[218:221], v[150:153]
    v_cvt_pk_f16_f32 v198, v238, v239
    v_pk_mul_f16 v210, v198, v198
    v_mfma_f32_16x16x32_bf16 v[150:153], a[36:39], v[234:237], v[150:153]
    v_cvt_pk_f16_f32 v199, v240, v241
    v_pk_fma_f16 v210, v199, v199, v210
    v_mfma_f32_16x16x32_bf16 v[150:153], a[40:43], v[138:141], v[150:153]
    s_waitcnt lgkmcnt(0)
    v_readfirstlane_b32 s77, v255
    v_pk_mul_f16 v212, v198, v142
    v_mfma_f32_16x16x32_bf16 v[150:153], a[44:47], v[246:249], v[150:153]
    v_pk_fma_f16 v212, v199, v143, v212
    v_cvt_pk_bf16_f32 v116, v166, v167
    v_mfma_f32_16x16x32_bf16 v[238:241], a[48:51], v[154:157], 0
    buffer_load_dwordx4 v10, s[8:11], 0 offen nt lds
    v_mul_f32 v168, v134, v168
    v_mfma_f32_16x16x32_bf16 v[238:241], a[52:55], v[162:165], v[238:241]
    s_add_u32 m0, s28, 4096
    v_mul_f32 v169, v134, v169
    v_cvt_pk_f16_f32 v200, v150, v151
    v_mfma_f32_16x16x32_bf16 v[238:241], a[56:59], v[218:221], v[238:241]
    v_pk_fma_f16 v210, v200, v200, v210
    v_cvt_pk_f16_f32 v201, v152, v153
    v_mfma_f32_16x16x32_bf16 v[238:241], a[60:63], v[234:237], v[238:241]
    ds_read_b128 v[242:245], v2 offset:0
    v_pk_fma_f16 v210, v201, v201, v210
    v_mfma_f32_16x16x32_bf16 v[238:241], a[64:67], v[138:141], v[238:241]
    ds_read_b128 v[174:177], v2 offset:1024
    v_pk_fma_f16 v212, v200, v144, v212
    v_mfma_f32_16x16x32_bf16 v[238:241], a[68:71], v[246:249], v[238:241]
    ds_read_b128 v[170:173], v2 offset:2048
    buffer_load_dwordx4 v11, s[8:11], 0 offen nt lds
    v_mfma_f32_16x16x32_bf16 v[150:153], v[154:157], a[144:147], 0
    s_add_u32 m0, s28, 8192
    ds_read_b128 v[214:217], v2 offset:3072
    v_pk_fma_f16 v212, v201, v145, v212
    v_mfma_f32_16x16x32_bf16 v[150:153], v[162:165], a[148:151], v[150:153]
    ds_read_b128 v[182:185], v2 offset:4096
    v_cvt_pk_f16_f32 v118, v238, v239
    v_mfma_f32_16x16x32_bf16 v[150:153], v[218:221], a[152:155], v[150:153]
    ds_read_b128 v[178:181], v2 offset:5120
    v_pk_fma_f16 v210, v118, v118, v210
    v_mfma_f32_16x16x32_bf16 v[150:153], v[234:237], a[156:159], v[150:153]
    v_cvt_pk_f16_f32 v119, v240, v241
    v_pk_fma_f16 v210, v119, v119, v210
    v_mfma_f32_16x16x32_bf16 v[150:153], v[138:141], a[160:163], v[150:153]
    buffer_load_dwordx4 v12, s[8:11], 0 offen nt lds
    v_pk_fma_f16 v212, v118, v226, v212
    v_mfma_f32_16x16x32_bf16 v[150:153], v[246:249], a[164:167], v[150:153]
    s_waitcnt lgkmcnt(5)
    v_pk_fma_f16 v212, v119, v227, v212
    v_cvt_pk_bf16_f32 v117, v168, v169
    v_mfma_f32_16x16x32_bf16 v[226:229], v[154:157], a[168:171], 0
    s_add_u32 m0, s28, 12288
    v_mul_f32 v230, v134, v230
    v_mul_f32 v231, v134, v231
    v_mfma_f32_16x16x32_f16 v[166:169], v[40:43], v[210:213], 0
    s_xor_b32 s28, s28, 65536
    v_cvt_pk_bf16_f32 v142, v150, v151
    v_cvt_pk_bf16_f32 v143, v152, v153
    v_mfma_f32_16x16x32_bf16 v[226:229], v[162:165], a[172:175], v[226:229]
    s_waitcnt lgkmcnt(2)
    ds_read2_b32 v[144:145], v6 offset0:0 offset1:0
    v_cvt_pk_bf16_f32 v230, v230, v231
    v_mfma_f32_16x16x32_bf16 v[226:229], v[218:221], a[176:179], v[226:229]
    s_waitcnt lgkmcnt(2)
    buffer_load_dwordx4 v13, s[8:11], 0 offen nt lds
    ds_read2_b32 v[212:213], v6 offset0:16 offset1:16
    v_mfma_f32_16x16x32_bf16 v[226:229], v[234:237], a[180:183], v[226:229]
    s_mov_b32 m0, s29
    ds_read2_b32 v[240:241], v6 offset0:32 offset1:32
    v_mul_f32 v232, v134, v232
    v_mfma_f32_16x16x32_bf16 v[226:229], v[138:141], a[184:187], v[226:229]
    s_xor_b32 s29, s29, s30
    v_rsq_f32 v166, v166
    v_mfma_f32_16x16x32_bf16 v[226:229], v[246:249], a[188:191], v[226:229]
    s_add_u32 s19, s19, s20
    v_rsq_f32 v167, v167
    v_mfma_f32_16x16x32_bf16 v[150:153], v[154:157], a[192:195], 0
    s_add_u32 s23, s23, s21
    v_mul_f32 v136, s31, v166
    v_cvt_pk_f16_f32 v137, v136, v167
    v_mfma_f32_16x16x32_bf16 v[150:153], v[162:165], a[196:199], v[150:153]
    s_waitcnt lgkmcnt(3)
    v_fma_f32 v168, v168, v136, v26
    v_mfma_f32_16x16x32_bf16 v[150:153], v[218:221], a[200:203], v[150:153]
    s_cmp_ge_u32 s19, 72
    v_fmac_f32_dpp v254, v169, v167 quad_perm:[0,1,2,3] row_mask:0x4 bank_mask:0xf
    v_cvt_pk_bf16_f32 v210, v226, v227
    v_mfma_f32_16x16x32_bf16 v[150:153], v[234:237], a[204:207], v[150:153]
    s_cselect_b32 s34, 72, 0
    v_cvt_pk_bf16_f32 v211, v228, v229
    v_pk_mul_f16 v186, v186, v137 op_sel:[0,1] op_sel_hi:[1,1]
    v_mfma_f32_16x16x32_bf16 v[150:153], v[138:141], a[208:211], v[150:153]
    s_cselect_b32 s35, s22, 0
    v_pk_mul_f16 v187, v187, v137 op_sel:[0,1] op_sel_hi:[1,1]
    v_pk_mul_f16 v188, v188, v137 op_sel:[0,1] op_sel_hi:[1,1]
    v_mfma_f32_16x16x32_bf16 v[150:153], v[246:249], a[212:215], v[150:153]
    s_sub_u32 s19, s19, s34
    v_pk_mul_f16 v189, v189, v137 op_sel:[0,1] op_sel_hi:[1,1]
    v_pk_mul_f16 v120, v120, v137 op_sel:[0,1] op_sel_hi:[1,1]
    v_mfma_f32_16x16x32_f16 v[154:157], v[194:197], v[222:225], v[46:49]
    s_waitcnt lgkmcnt(0)
    buffer_store_dwordx4 v[114:117], v16, s[12:15], 0 offen nt
    v_pk_mul_f16 v121, v121, v137 op_sel:[0,1] op_sel_hi:[1,1]
    v_pk_mul_f16 v198, v198, v137 op_sel:[0,0] op_sel_hi:[1,0]
    v_cvt_pk_bf16_f32 v238, v150, v151
    v_cvt_pk_bf16_f32 v239, v152, v153
    v_mfma_f32_16x16x32_f16 v[114:117], v[202:205], v[222:225], v[50:53]
    s_add_u32 s23, s23, s35
    v_pk_mul_f16 v199, v199, v137 op_sel:[0,0] op_sel_hi:[1,0]
    v_pk_mul_f16 v200, v200, v137 op_sel:[0,0] op_sel_hi:[1,0]
    v_mfma_f32_16x16x32_f16 v[246:249], v[186:189], v[222:225], v[54:57]
    s_cmp_lg_u32 s83, 0
    v_pk_mul_f16 v201, v201, v137 op_sel:[0,0] op_sel_hi:[1,0]
    v_pk_mul_f16 v118, v118, v137 op_sel:[0,0] op_sel_hi:[1,0]
    v_pk_mul_f16 v119, v119, v137 op_sel:[0,0] op_sel_hi:[1,0]
    v_mfma_f32_16x16x16_f16 v[154:157], v[148:149], v[146:147], v[154:157]
    v_max3_u32 v44, v44, v166, v167
    v_exp_f32 v254, v254
    v_mfma_f32_16x16x16_f16 v[114:117], v[160:161], v[146:147], v[114:117]
    v_cvt_pk_bf16_f32 v254, v254, v254
    v_exp_f32 v168, v168
    v_mfma_f32_16x16x16_f16 v[246:249], v[120:121], v[146:147], v[246:249]
    v_mul_f32 v233, v134, v233
    v_cvt_pk_bf16_f32 v231, v232, v233
    v_exp_f32 v154, v154
    v_mfma_f32_16x16x32_f16 v[162:165], v[194:197], v[122:125], v[58:61]
    s_cselect_b32 s77, s80, s77
    ds_write_b16 v8, v254
    v_mfma_f32_16x16x32_f16 v[138:141], v[202:205], v[122:125], v[62:65]
    s_mul_i32 s78, s77, 2688
    v_exp_f32 v155, v155
    v_mfma_f32_16x16x32_f16 v[234:237], v[186:189], v[122:125], v[66:69]
    s_add_u32 s78, s78, s69
    v_cvt_pk_bf16_f32 v218, v154, v155
    v_exp_f32 v156, v156
    v_mfma_f32_16x16x16_f16 v[162:165], v[148:149], v[158:159], v[162:165]
    v_exp_f32 v157, v157
    v_xor_b32 v0, 65536, v0
    v_mfma_f32_16x16x16_f16 v[138:141], v[160:161], v[158:159], v[138:141]
    v_cvt_pk_bf16_f32 v219, v156, v157
    v_exp_f32 v114, v114
    v_mfma_f32_16x16x16_f16 v[234:237], v[120:121], v[158:159], v[234:237]
    v_exp_f32 v115, v115
    v_exp_f32 v116, v116
    v_mfma_f32_16x16x32_bf16 v[122:125], a[216:219], v[242:245], 0
    s_add_u32 s80, s77, s68
    v_exp_f32 v162, v162
    v_mfma_f32_16x16x32_bf16 v[122:125], a[220:223], v[174:177], v[122:125]
    s_cmp_ge_u32 s80, 72
    v_exp_f32 v163, v163
    v_mfma_f32_16x16x32_f16 v[222:225], v[194:197], v[198:201], v[70:73]
    s_cselect_b32 s80, s22, 0
    v_cvt_pk_bf16_f32 v158, v162, v163
    v_cvt_pk_bf16_f32 v220, v114, v115
    v_mfma_f32_16x16x32_f16 v[134:137], v[202:205], v[198:201], v[74:77]
    s_add_u32 s78, s78, s80
    v_exp_f32 v164, v164
    v_mfma_f32_16x16x32_f16 v[194:197], v[186:189], v[198:201], v[78:81]
    buffer_store_dwordx2 v[230:231], v19, s[12:15], 0 offen nt
    v_exp_f32 v165, v165
    v_mfma_f32_16x16x16_f16 v[222:225], v[148:149], v[118:119], v[222:225]
    v_cvt_pk_bf16_f32 v159, v164, v165
    v_exp_f32 v138, v138
    v_mfma_f32_16x16x16_f16 v[134:137], v[160:161], v[118:119], v[134:137]
    v_exp_f32 v139, v139
    v_xor_b32 v1, 65536, v1
    v_mfma_f32_16x16x16_f16 v[194:197], v[120:121], v[118:119], v[194:197]
    v_cvt_pk_bf16_f32 v160, v138, v139
    v_exp_f32 v140, v140
    v_add_u32 v6, s75, v6
    v_mfma_f32_16x16x32_bf16 v[122:125], a[224:227], v[170:173], v[122:125]
    s_add_u32 s80, s77, 20
    v_exp_f32 v141, v141
    v_mfma_f32_16x16x32_bf16 v[122:125], a[228:231], v[214:217], v[122:125]
    s_add_u32 s34, s18, 3
    v_exp_f32 v234, v234
    v_mfma_f32_16x16x32_bf16 v[122:125], a[232:235], v[182:185], v[122:125]
    s_cmp_lt_u32 s77, s62
    v_exp_f32 v235, v235
    v_mfma_f32_16x16x32_bf16 v[122:125], a[236:239], v[178:181], v[122:125]
    s_cselect_b32 s79, 1, 0
    v_exp_f32 v236, v236
    v_mfma_f32_16x16x32_bf16 v[154:157], a[240:243], v[242:245], 0
    s_cselect_b32 s78, s78, 0
    ds_read_b128 v[150:153], v2 offset:6144
    v_cvt_pk_bf16_f32 v161, v140, v141
    v_mfma_f32_16x16x32_bf16 v[154:157], a[244:247], v[174:177], v[154:157]
    s_cmp_lt_u32 s34, s17
    ds_read_b128 v[162:165], v2 offset:7168
    v_fma_f32 v255, v122, v122, s33
    v_mfma_f32_16x16x32_bf16 v[154:157], a[248:251], v[170:173], v[154:157]
    s_cselect_b32 s23, s23, s78
    ds_read_b128 v[186:189], v2 offset:8192
    v_fmac_f32 v255, v123, v123
    v_mfma_f32_16x16x32_bf16 v[154:157], a[252:255], v[214:217], v[154:157]
    s_cselect_b32 s73, s34, s80
    ds_read_b128 v[138:141], v2 offset:9216
    v_fmac_f32 v255, v124, v124
    v_mfma_f32_16x16x32_bf16 v[154:157], v[82:85], v[182:185], v[154:157]
    s_cselect_b32 s79, 0, s79
    ds_read_b128 v[118:121], v2 offset:10240
    v_fmac_f32 v255, v125, v125
    v_mfma_f32_16x16x32_bf16 v[154:157], v[86:89], v[178:181], v[154:157]
    s_cselect_b32 s81, 0, 1
    ds_read_b128 v[198:201], v2 offset:11264
    s_add_u32 s80, s77, 1
    v_mfma_f32_16x16x32_bf16 v[202:205], v[90:93], v[242:245], 0
    s_mul_i32 s80, s80, s81
    v_exp_f32 v237, v237
    v_mfma_f32_16x16x32_bf16 v[202:205], v[94:97], v[174:177], v[202:205]
    s_cmp_lt_u32 s80, s62
    v_exp_f32 v117, v117
    v_mfma_f32_16x16x32_bf16 v[202:205], v[98:101], v[170:173], v[202:205]
    s_waitcnt lgkmcnt(5)
    v_cvt_pk_bf16_f32 v221, v116, v117
    v_fmac_f32 v255, v154, v154
    v_mfma_f32_16x16x32_bf16 v[202:205], v[102:105], v[214:217], v[202:205]
    s_cselect_b32 s70, s70, 0
    v_exp_f32 v246, v246
    v_mfma_f32_16x16x32_bf16 v[202:205], v[106:109], v[182:185], v[202:205]
    s_cselect_b32 s62, s62, 0
    v_exp_f32 v247, v247
    v_mfma_f32_16x16x32_bf16 v[202:205], v[110:113], v[178:181], v[202:205]
    s_add_u32 s80, s18, 4
    v_cvt_pk_bf16_f32 v36, v246, v247
    v_fmac_f32 v255, v155, v155
    v_mfma_f32_16x16x32_bf16 v[114:117], a[216:219], v[150:153], 0
    s_waitcnt lgkmcnt(1)
    v_exp_f32 v248, v248
    v_mfma_f32_16x16x32_bf16 v[114:117], a[220:223], v[162:165], v[114:117]
    s_cmp_ge_u32 s80, s17
    v_exp_f32 v249, v249
    v_mfma_f32_16x16x32_bf16 v[114:117], a[224:227], v[186:189], v[114:117]
    s_cselect_b32 s66, s70, 0
    v_cvt_pk_bf16_f32 v37, v248, v249
    v_fmac_f32 v255, v156, v156
    v_mfma_f32_16x16x32_bf16 v[114:117], a[228:231], v[138:141], v[114:117]
    s_waitcnt lgkmcnt(0)
    v_fmac_f32 v255, v157, v157
    v_mfma_f32_16x16x32_bf16 v[178:181], v[28:31], v[36:39], 0
    s_lshl_b32 s80, s79, s73
    v_exp_f32 v222, v222
    v_mfma_f32_16x16x32_bf16 v[178:181], v[28:31], v[218:221], v[178:181]
    s_or_b32 s63, s63, s80
    v_exp_f32 v223, v223
    v_mfma_f32_16x16x32_bf16 v[146:149], v[142:145], v[36:39], 0
    s_sub_u32 s80, s100, s81
    v_cvt_pk_bf16_f32 v226, v222, v223
    v_fmac_f32 v255, v202, v202
    v_mfma_f32_16x16x32_bf16 v[146:149], v[126:129], v[218:221], v[146:149]
    s_and_b32 s100, s100, s80
    v_exp_f32 v224, v224
    v_mfma_f32_16x16x32_bf16 v[246:249], v[210:213], v[36:39], 0
    s_add_u32 s45, s45, s79
    v_exp_f32 v225, v225
    v_mfma_f32_16x16x32_bf16 v[246:249], v[130:133], v[218:221], v[246:249]
    s_add_u32 s18, s18, 1
    v_cvt_pk_bf16_f32 v227, v224, v225
    v_fmac_f32 v255, v203, v203
    v_mfma_f32_16x16x32_bf16 v[222:225], v[238:241], v[36:39], 0
    s_cmp_lt_u32 s18, s45
    v_cvt_pk_bf16_f32 v36, v234, v235
    v_cvt_pk_bf16_f32 v37, v236, v237
    v_mfma_f32_16x16x32_bf16 v[222:225], v[190:193], v[218:221], v[222:225]
    v_cvt_pk_bf16_f32 v39, v208, 0
    v_fmac_f32 v255, v204, v204
    v_mfma_f32_16x16x32_bf16 v[114:117], a[232:235], v[118:121], v[114:117]
    v_exp_f32 v134, v134
    v_mfma_f32_16x16x32_bf16 v[182:185], v[28:31], v[36:39], 0
    v_exp_f32 v135, v135
    v_mfma_f32_16x16x32_bf16 v[182:185], v[28:31], v[158:161], v[182:185]
    v_cvt_pk_bf16_f32 v228, v134, v135
    v_fmac_f32 v255, v205, v205
    v_mfma_f32_16x16x32_bf16 v[230:233], v[142:145], v[36:39], 0
    v_exp_f32 v136, v136
    v_mfma_f32_16x16x32_bf16 v[230:233], v[126:129], v[158:161], v[230:233]
    v_exp_f32 v137, v137
    v_mfma_f32_16x16x32_bf16 v[170:173], v[210:213], v[36:39], 0
    v_exp_f32 v194, v194
    v_mfma_f32_16x16x32_bf16 v[170:173], v[130:133], v[158:161], v[170:173]
    v_rcp_f32 v182, v182
    v_mfma_f32_16x16x32_bf16 v[174:177], v[238:241], v[36:39], 0
    v_cvt_pk_bf16_f32 v229, v136, v137
    v_cvt_pk_bf16_f32 v39, v168, 0
    v_mfma_f32_16x16x32_bf16 v[174:177], v[190:193], v[158:161], v[174:177]
    v_mul_f32 v230, v182, v230
    v_mul_f32 v231, v182, v231
    v_mfma_f32_16x16x32_bf16 v[114:117], a[236:239], v[198:201], v[114:117]
    v_cvt_pk_bf16_f32 v134, v230, v231
    v_mul_f32 v232, v182, v232
    v_mfma_f32_16x16x32_bf16 v[166:169], a[240:243], v[150:153], 0
    ds_read_b128 v[214:217], v2 offset:12288
    v_mul_f32 v233, v182, v233
    v_mfma_f32_16x16x32_bf16 v[166:169], a[244:247], v[162:165], v[166:169]
    ds_read_b128 v[234:237], v2 offset:13312
    v_cvt_pk_bf16_f32 v135, v232, v233
    v_mfma_f32_16x16x32_bf16 v[166:169], a[248:251], v[186:189], v[166:169]
    ds_read_b128 v[218:221], v2 offset:14336
    v_fma_f32 v254, v114, v114, s33
    v_mfma_f32_16x16x32_bf16 v[166:169], a[252:255], v[138:141], v[166:169]
    ds_read_b128 v[158:161], v2 offset:15360
    v_fmac_f32 v254, v115, v115
    v_mfma_f32_16x16x32_bf16 v[166:169], v[82:85], v[118:121], v[166:169]
    ds_read_b128 v[206:209], v2 offset:16384
    v_fmac_f32 v254, v116, v116
    v_mfma_f32_16x16x32_bf16 v[166:169], v[86:89], v[198:201], v[166:169]
    ds_read_b128 v[242:245], v2 offset:17408
    v_fmac_f32 v254, v117, v117
    v_mfma_f32_16x16x32_bf16 v[230:233], v[90:93], v[150:153], 0
    v_mul_f32 v170, v182, v170
    v_mul_f32 v171, v182, v171
    v_mfma_f32_16x16x32_bf16 v[230:233], v[94:97], v[162:165], v[230:233]
    v_cvt_pk_bf16_f32 v136, v170, v171
    v_mul_f32 v172, v182, v172
    v_mfma_f32_16x16x32_bf16 v[230:233], v[98:101], v[186:189], v[230:233]
    s_waitcnt lgkmcnt(5)
    v_fmac_f32 v254, v166, v166
    v_fmac_f32 v254, v167, v167
    v_mfma_f32_16x16x32_bf16 v[230:233], v[102:105], v[138:141], v[230:233]
    s_waitcnt lgkmcnt(4)
    v_fmac_f32 v254, v168, v168
    v_fmac_f32 v254, v169, v169
    v_mfma_f32_16x16x32_bf16 v[230:233], v[106:109], v[118:121], v[230:233]
    s_waitcnt lgkmcnt(3)
    v_mul_f32 v173, v182, v173
    v_cvt_pk_bf16_f32 v137, v172, v173
    v_mfma_f32_16x16x32_bf16 v[230:233], v[110:113], v[198:201], v[230:233]
    s_waitcnt lgkmcnt(2)
    ds_write_b128 v3, v[134:137] offset:6144
    v_mfma_f32_16x16x32_bf16 v[150:153], a[216:219], v[214:217], 0
    s_waitcnt lgkmcnt(1)
    v_mul_f32 v174, v182, v174
    v_mul_f32 v175, v182, v175
    v_mfma_f32_16x16x32_bf16 v[150:153], a[220:223], v[234:237], v[150:153]
    v_cvt_pk_bf16_f32 v174, v174, v175
    v_fmac_f32 v254, v230, v230
    v_mfma_f32_16x16x32_bf16 v[150:153], a[224:227], v[218:221], v[150:153]
    v_fmac_f32 v254, v231, v231
    v_fmac_f32 v254, v232, v232
    v_mfma_f32_16x16x32_bf16 v[150:153], a[228:231], v[158:161], v[150:153]
    v_fmac_f32 v254, v233, v233
    v_cvt_pk_bf16_f32 v254, v255, v254
    v_mfma_f32_16x16x32_bf16 v[150:153], a[232:235], v[206:209], v[150:153]
    v_mul_f32 v176, v182, v176
    v_mul_f32 v177, v182, v177
    v_mfma_f32_16x16x32_bf16 v[150:153], a[236:239], v[242:245], v[150:153]
    v_cvt_pk_bf16_f32 v175, v176, v177
    v_xor_b32 v2, 65536, v2
    v_mfma_f32_16x16x32_bf16 v[162:165], a[240:243], v[214:217], 0
    ds_write_b64 v4, v[174:175] offset:10240
    v_mfma_f32_16x16x32_bf16 v[162:165], a[244:247], v[234:237], v[162:165]
    v_exp_f32 v195, v195
    v_mfma_f32_16x16x32_bf16 v[162:165], a[248:251], v[218:221], v[162:165]
    v_exp_f32 v196, v196
    v_mfma_f32_16x16x32_bf16 v[162:165], a[252:255], v[158:161], v[162:165]
    v_fma_f32 v255, v150, v150, s33
    v_fmac_f32 v255, v151, v151
    v_mfma_f32_16x16x32_bf16 v[162:165], v[82:85], v[206:209], v[162:165]
    v_fmac_f32 v255, v152, v152
    v_fmac_f32 v255, v153, v153
    v_mfma_f32_16x16x32_bf16 v[162:165], v[86:89], v[242:245], v[162:165]
    v_exp_f32 v197, v197
    v_mfma_f32_16x16x32_bf16 v[138:141], v[90:93], v[214:217], 0
    ds_read_b128 v[186:189], v0 offset:20480
    v_cvt_pk_bf16_f32 v36, v194, v195
    v_mfma_f32_16x16x32_bf16 v[138:141], v[94:97], v[234:237], v[138:141]
    ds_read_b128 v[118:121], v1 offset:20480
    v_cvt_pk_bf16_f32 v37, v196, v197
    v_mfma_f32_16x16x32_bf16 v[138:141], v[98:101], v[218:221], v[138:141]
    ds_read_b128 v[234:237], v0 offset:20608
    v_fmac_f32 v255, v162, v162
    v_mfma_f32_16x16x32_bf16 v[198:201], v[28:31], v[36:39], 0
    ds_read_b128 v[214:217], v9
    v_fmac_f32 v255, v163, v163
    v_mfma_f32_16x16x32_bf16 v[198:201], v[28:31], v[226:229], v[198:201]
    ds_read_b128 v[194:197], v9 offset:64
    v_fmac_f32 v255, v164, v164
    v_mfma_f32_16x16x32_bf16 v[170:173], v[142:145], v[36:39], 0
    v_rcp_f32 v178, v178
    v_mfma_f32_16x16x32_bf16 v[170:173], v[126:129], v[226:229], v[170:173]
    v_fmac_f32 v255, v165, v165
    v_mul_f32 v146, v178, v146
    v_mfma_f32_16x16x32_bf16 v[218:221], v[210:213], v[36:39], 0
    v_rcp_f32 v198, v198
    v_mfma_f32_16x16x32_bf16 v[218:221], v[130:133], v[226:229], v[218:221]
    s_waitcnt lgkmcnt(4)
    v_mul_f32 v147, v178, v147
    v_cvt_pk_bf16_f32 v146, v146, v147
    v_mfma_f32_16x16x32_bf16 v[174:177], v[238:241], v[36:39], 0
    s_waitcnt lgkmcnt(3)
    v_mul_f32 v170, v198, v170
    v_mul_f32 v171, v198, v171
    v_mfma_f32_16x16x32_bf16 v[174:177], v[190:193], v[226:229], v[174:177]
    s_waitcnt lgkmcnt(2)
    v_cvt_pk_bf16_f32 v226, v170, v171
    v_mul_f32 v172, v198, v172
    v_mfma_f32_16x16x32_bf16 v[138:141], v[102:105], v[158:161], v[138:141]
    s_waitcnt lgkmcnt(1)
    ds_read_b128 v[158:161], v1 offset:20608
    v_mul_f32 v173, v198, v173
    v_mfma_f32_16x16x32_bf16 v[138:141], v[106:109], v[206:209], v[138:141]
    s_waitcnt lgkmcnt(1)
    ds_read_b128 v[182:185], v0 offset:20736
    v_cvt_pk_bf16_f32 v227, v172, v173
    v_mfma_f32_16x16x32_bf16 v[138:141], v[110:113], v[242:245], v[138:141]
    ds_read_b128 v[206:209], v1 offset:20736
    v_mul_f32 v218, v198, v218
    v_mfma_f32_16x16x32_bf16 v[242:245], v[214:217], v[28:31], 0
    v_mul_f32 v219, v198, v219
    v_cvt_pk_bf16_f32 v228, v218, v219
    v_mfma_f32_16x16x32_bf16 v[242:245], v[194:197], v[28:31], v[242:245]
    v_mul_f32 v220, v198, v220
    v_mul_f32 v221, v198, v221
    v_mfma_f32_16x16x32_bf16 v[170:173], v[214:217], v[126:129], 0
    v_fmac_f32 v255, v138, v138
    v_fmac_f32 v255, v139, v139
    v_mfma_f32_16x16x32_bf16 v[170:173], v[194:197], v[142:145], v[170:173]
    v_fmac_f32 v255, v140, v140
    v_fmac_f32 v255, v141, v141
    v_mfma_f32_16x16x32_bf16 v[126:129], v[214:217], v[130:133], 0
    v_cvt_pk_bf16_f32 v255, v255, v255
    v_cvt_pk_bf16_f32 v229, v220, v221
    v_mfma_f32_16x16x32_bf16 v[126:129], v[194:197], v[210:213], v[126:129]
    s_waitcnt lgkmcnt(2)
    ds_write_b128 v3, v[226:229] offset:12288
    v_mfma_f32_16x16x32_bf16 v[130:133], v[214:217], v[190:193], 0
    s_waitcnt lgkmcnt(1)
    v_rcp_f32 v242, v242
    v_mfma_f32_16x16x32_bf16 v[130:133], v[194:197], v[238:241], v[130:133]
    v_mul_f32 v170, v170, v242
    v_mul_f32 v174, v198, v174
    v_mfma_f32_16x16x32_bf16 v[190:193], a[72:75], v[186:189], 0
    ds_write_b64 v4, v[254:255] offset:18432
    v_mfma_f32_16x16x32_bf16 v[190:193], a[76:79], v[118:121], v[190:193]
    v_mul_f32_dpp v170, v126, v242 quad_perm:[0,1,2,3] row_mask:0x2 bank_mask:0xf
    v_mul_f32 v175, v198, v175
    v_mfma_f32_16x16x32_bf16 v[190:193], a[80:83], v[234:237], v[190:193]
    v_mul_f32_dpp v170, v130, v242 quad_perm:[0,1,2,3] row_mask:0x4 bank_mask:0xf
    v_cvt_pk_bf16_f32 v170, v170, v170
    v_mfma_f32_16x16x32_bf16 v[190:193], a[84:87], v[158:161], v[190:193]
    ds_write_b16 v7, v170
    v_mfma_f32_16x16x32_bf16 v[190:193], a[88:91], v[182:185], v[190:193]
    v_cvt_pk_bf16_f32 v254, v174, v175
    v_mul_f32 v176, v198, v176
    v_mfma_f32_16x16x32_bf16 v[190:193], a[92:95], v[206:209], v[190:193]
    v_mul_f32 v177, v198, v177
    v_cvt_pk_bf16_f32 v255, v176, v177
    v_mfma_f32_16x16x32_bf16 v[130:133], a[96:99], v[186:189], 0
    ds_write_b64 v4, v[254:255] offset:16384
    v_mfma_f32_16x16x32_bf16 v[130:133], a[100:103], v[118:121], v[130:133]
    v_mul_f32 v148, v178, v148
    v_mul_f32 v149, v178, v149
    v_mfma_f32_16x16x32_bf16 v[130:133], a[104:107], v[234:237], v[130:133]
    v_cvt_pk_bf16_f32 v147, v148, v149
    v_mul_f32 v246, v178, v246
    v_mfma_f32_16x16x32_bf16 v[130:133], a[108:111], v[158:161], v[130:133]
    v_mul_f32 v247, v178, v247
    v_cvt_pk_bf16_f32 v148, v246, v247
    v_mfma_f32_16x16x32_bf16 v[130:133], a[112:115], v[182:185], v[130:133]
    v_mul_f32 v248, v178, v248
    v_mul_f32 v249, v178, v249
    v_mfma_f32_16x16x32_bf16 v[130:133], a[116:119], v[206:209], v[130:133]
    v_cvt_pk_bf16_f32 v149, v248, v249
    v_mul_f32 v222, v178, v222
    v_mfma_f32_16x16x32_bf16 v[126:129], a[120:123], v[186:189], 0
    ds_write_b128 v3, v[146:149] offset:0
    v_mfma_f32_16x16x32_bf16 v[126:129], a[124:127], v[118:121], v[126:129]
    v_mul_f32 v223, v178, v223
    v_cvt_pk_bf16_f32 v254, v222, v223
    v_mfma_f32_16x16x32_bf16 v[126:129], a[128:131], v[234:237], v[126:129]
    v_mul_f32 v224, v178, v224
    v_mul_f32 v225, v178, v225
    v_mfma_f32_16x16x32_bf16 v[126:129], a[132:135], v[158:161], v[126:129]
    v_cvt_pk_bf16_f32 v255, v224, v225
    v_xor_b32 v3, 65536, v3
    v_mfma_f32_16x16x32_bf16 v[126:129], a[136:139], v[182:185], v[126:129]
    ds_write_b64 v4, v[254:255] offset:4096
    v_mfma_f32_16x16x32_bf16 v[126:129], a[140:143], v[206:209], v[126:129]
    v_xor_b32 v4, 65536, v4
    v_cvt_pk_f16_f32 v194, v190, v191
    v_mfma_f32_16x16x32_bf16 v[142:145], a[0:3], v[186:189], 0
    v_pk_mul_f16 v191, v194, v194
    v_cvt_pk_f16_f32 v195, v192, v193
    v_mfma_f32_16x16x32_bf16 v[142:145], a[4:7], v[118:121], v[142:145]
    v_pk_fma_f16 v191, v195, v195, v191
    v_cvt_pk_f16_f32 v196, v130, v131
    v_mfma_f32_16x16x32_bf16 v[142:145], a[8:11], v[234:237], v[142:145]
    v_pk_fma_f16 v191, v196, v196, v191
    v_cvt_pk_f16_f32 v197, v132, v133
    v_mfma_f32_16x16x32_bf16 v[142:145], a[12:15], v[158:161], v[142:145]
    v_pk_fma_f16 v191, v197, v197, v191
    v_cvt_pk_f16_f32 v148, v126, v127
    v_mfma_f32_16x16x32_bf16 v[142:145], a[16:19], v[182:185], v[142:145]
    v_pk_fma_f16 v191, v148, v148, v191
    v_cvt_pk_f16_f32 v149, v128, v129
    v_mfma_f32_16x16x32_bf16 v[142:145], a[20:23], v[206:209], v[142:145]
    s_waitcnt lgkmcnt(0)
    v_pk_fma_f16 v191, v149, v149, v191
    v_add_u32 v7, s76, v7
    v_mfma_f32_16x16x32_bf16 v[126:129], a[24:27], v[186:189], 0
    s_nop 0
    v_mfma_f32_16x16x32_bf16 v[126:129], a[28:31], v[118:121], v[126:129]
    s_nop 0
    v_mfma_f32_16x16x32_bf16 v[126:129], a[32:35], v[234:237], v[126:129]
    s_nop 0
    v_mfma_f32_16x16x32_bf16 v[126:129], a[36:39], v[158:161], v[126:129]
    s_barrier
    v_mfma_f32_16x16x32_bf16 v[126:129], a[40:43], v[182:185], v[126:129]
    v_mfma_f32_16x16x32_bf16 v[126:129], a[44:47], v[206:209], v[126:129]
    s_cbranch_scc1 L_loop_fast3
L_final_fast:
    v_mfma_f32_16x16x32_bf16 v[178:181], a[48:51], v[186:189], 0
    s_mov_b32 s12, s40
    ds_read_b128 v[170:173], v2 offset:18432
    ds_read_b128 v[134:137], v2 offset:19456
    v_mfma_f32_16x16x32_bf16 v[178:181], a[52:55], v[118:121], v[178:181]
    s_mov_b32 s13, s41
    ds_read_b128 v[174:177], v5 offset:32
    ds_read2_b64 v[130:133], v5 offset0:6 offset1:9
    v_mfma_f32_16x16x32_bf16 v[178:181], a[56:59], v[234:237], v[178:181]
    s_mov_b32 s14, s36
    v_cvt_pk_f16_f32 v142, v142, v143
    v_pk_mul_f16 v190, v142, v142
    v_mfma_f32_16x16x32_bf16 v[178:181], a[60:63], v[158:161], v[178:181]
    s_add_u32 s48, s40, s27
    ds_read_b128 v[210:213], v5
    ds_read_b32 v254, v6 offset:192
    v_mfma_f32_16x16x32_bf16 v[178:181], a[64:67], v[182:185], v[178:181]
    s_addc_u32 s49, s41, 0
    v_cvt_pk_f16_f32 v143, v144, v145
    v_pk_fma_f16 v190, v143, v143, v190
    v_mfma_f32_16x16x32_bf16 v[178:181], a[68:71], v[206:209], v[178:181]
    s_sub_u32 s50, s36, s27
    v_cvt_pk_f16_f32 v144, v126, v127
    v_pk_fma_f16 v190, v144, v144, v190
    v_mfma_f32_16x16x32_bf16 v[198:201], v[186:189], a[144:147], 0
    s_mov_b32 s51, 0x00020000
    v_cvt_pk_f16_f32 v145, v128, v129
    v_pk_fma_f16 v190, v145, v145, v190
    v_mfma_f32_16x16x32_bf16 v[198:201], v[118:121], a[148:151], v[198:201]
    s_waitcnt lgkmcnt(4)
    v_cvt_pk_f16_f32 v146, v178, v179
    v_pk_fma_f16 v190, v146, v146, v190
    v_mfma_f32_16x16x32_bf16 v[126:129], v[32:35], v[170:173], 0
    s_waitcnt lgkmcnt(2)
    v_cvt_pk_f16_f32 v147, v180, v181
    v_pk_fma_f16 v190, v147, v147, v190
    v_mfma_f32_16x16x32_bf16 v[126:129], v[32:35], v[134:137], v[126:129]
    s_add_u32 s52, s40, s26
    v_pk_mul_f16 v193, v194, v174
    v_pk_fma_f16 v193, v195, v175, v193
    v_mfma_f32_16x16x32_bf16 v[198:201], v[234:237], a[152:155], v[198:201]
    s_waitcnt lgkmcnt(0)
    v_mov_b32_dpp v254, v23 quad_perm:[0,1,2,3] row_mask:0x7 bank_mask:0xf
    v_pk_fma_f16 v193, v196, v176, v193
    v_mfma_f32_16x16x32_bf16 v[198:201], v[158:161], a[156:159], v[198:201]
    s_addc_u32 s53, s41, 0
    v_mul_f32 v192, 0x3baaaaab, v127
    v_mul_f32 v255, 0x3baaaaab, v126
    v_mfma_f32_16x16x32_bf16 v[198:201], v[182:185], a[160:163], v[198:201]
    s_sub_u32 s54, s36, s26
    v_rsq_f32 v192, v192
    v_mfma_f32_16x16x32_bf16 v[198:201], v[206:209], a[164:167], v[198:201]
    s_mov_b32 s55, 0x00020000
    v_mul_f32 v114, v192, v114
    v_mul_f32 v115, v192, v115
    v_mfma_f32_16x16x32_bf16 v[134:137], v[186:189], a[168:171], 0
    s_add_u32 s56, s40, s25
    v_cvt_pk_bf16_f32 v114, v114, v115
    v_mul_f32 v116, v192, v116
    v_mfma_f32_16x16x32_bf16 v[134:137], v[118:121], a[172:175], v[134:137]
    s_addc_u32 s57, s41, 0
    v_mul_f32 v117, v192, v117
    v_cvt_pk_bf16_f32 v115, v116, v117
    v_mfma_f32_16x16x32_bf16 v[134:137], v[234:237], a[176:179], v[134:137]
    s_sub_u32 s58, s36, s25
    v_mul_f32 v166, v192, v166
    v_mul_f32 v167, v192, v167
    v_mfma_f32_16x16x32_bf16 v[134:137], v[158:161], a[180:183], v[134:137]
    s_mov_b32 s59, 0x00020000
    v_cvt_pk_bf16_f32 v116, v166, v167
    v_mul_f32 v168, v192, v168
    v_mfma_f32_16x16x32_bf16 v[134:137], v[182:185], a[184:187], v[134:137]
    s_and_b32 s6, s2, 7
    ds_read_b128 v[170:173], v0 offset:26624
    v_mul_f32 v169, v192, v169
    v_mfma_f32_16x16x32_bf16 v[134:137], v[206:209], a[188:191], v[134:137]
    s_sub_u32 s6, 0, s6
    ds_read_b128 v[178:181], v1 offset:26624
    v_cvt_pk_bf16_f32 v117, v168, v169
    v_mfma_f32_16x16x32_bf16 v[166:169], v[186:189], a[192:195], 0
    s_lshl_b32 s3, s16, 6
    ds_read_b128 v[186:189], v0 offset:26752
    buffer_store_dwordx4 v[114:117], v16, s[48:51], 0 offen nt
    v_mul_f32 v230, v192, v230
    v_mul_f32 v231, v192, v231
    v_cvt_pk_bf16_f32 v126, v230, v231
    v_mul_f32 v232, v192, v232
    v_mfma_f32_16x16x32_bf16 v[166:169], v[118:121], a[196:199], v[166:169]
    s_lshl_b32 s4, s16, 5
    ds_read_b128 v[114:117], v1 offset:26752
    v_mul_f32 v233, v192, v233
    v_mfma_f32_16x16x32_bf16 v[166:169], v[234:237], a[200:203], v[166:169]
    s_add_u32 s4, s4, 256
    ds_read_b128 v[118:121], v0 offset:26880
    v_cvt_pk_bf16_f32 v127, v232, v233
    v_mfma_f32_16x16x32_bf16 v[166:169], v[158:161], a[204:207], v[166:169]
    s_mul_i32 s5, s16, 9408
    ds_read_b128 v[158:161], v1 offset:26880
    v_pk_fma_f16 v193, v197, v177, v193
    v_mfma_f32_16x16x32_bf16 v[166:169], v[182:185], a[208:211], v[166:169]
    s_waitcnt lgkmcnt(5)
    v_rsq_f32 v255, v255
    v_mfma_f32_16x16x32_bf16 v[166:169], v[206:209], a[212:215], v[166:169]
    s_add_u32 s5, s5, 104448
    v_mul_f32 v122, v255, v122
    v_mul_f32 v123, v255, v123
    v_mfma_f32_16x16x32_bf16 v[182:185], a[72:75], v[170:173], 0
    s_waitcnt lgkmcnt(3)
    v_cvt_pk_bf16_f32 v122, v122, v123
    v_mul_f32 v124, v255, v124
    v_mfma_f32_16x16x32_bf16 v[182:185], a[76:79], v[178:181], v[182:185]
    v_mul_f32 v125, v255, v125
    v_cvt_pk_bf16_f32 v123, v124, v125
    v_mfma_f32_16x16x32_bf16 v[182:185], a[80:83], v[186:189], v[182:185]
    s_waitcnt lgkmcnt(2)
    ds_read_b128 v[226:229], v2 offset:0
    ds_read_b128 v[214:217], v2 offset:1024
    v_mfma_f32_16x16x32_bf16 v[182:185], a[84:87], v[114:117], v[182:185]
    s_waitcnt lgkmcnt(3)
    ds_read_b128 v[206:209], v2 offset:2048
    ds_read_b128 v[218:221], v2 offset:3072
    v_mfma_f32_16x16x32_bf16 v[182:185], a[88:91], v[118:121], v[182:185]
    s_waitcnt lgkmcnt(4)
    v_mul_f32 v154, v255, v154
    v_mul_f32 v155, v255, v155
    v_mfma_f32_16x16x32_bf16 v[182:185], a[92:95], v[158:161], v[182:185]
    ds_read_b128 v[230:233], v2 offset:4096
    ds_read_b128 v[234:237], v2 offset:5120
    v_mfma_f32_16x16x32_bf16 v[222:225], a[96:99], v[170:173], 0
    v_cvt_pk_bf16_f32 v124, v154, v155
    v_mul_f32 v156, v255, v156
    v_mfma_f32_16x16x32_bf16 v[222:225], a[100:103], v[178:181], v[222:225]
    v_mul_f32 v157, v255, v157
    v_cvt_pk_bf16_f32 v125, v156, v157
    v_mfma_f32_16x16x32_bf16 v[222:225], a[104:107], v[186:189], v[222:225]
    v_mul_f32 v202, v255, v202
    v_mul_f32 v203, v255, v203
    v_mfma_f32_16x16x32_bf16 v[222:225], a[108:111], v[114:117], v[222:225]
    s_waitcnt lgkmcnt(4)
    v_cvt_pk_bf16_f32 v202, v202, v203
    v_mul_f32 v204, v255, v204
    v_mfma_f32_16x16x32_bf16 v[154:157], a[216:219], v[226:229], 0
    s_waitcnt lgkmcnt(2)
    buffer_store_dwordx2 v[126:127], v19, s[48:51], 0 offen nt
    v_mul_f32 v205, v255, v205
    v_cvt_pk_bf16_f32 v203, v204, v205
    v_mfma_f32_16x16x32_bf16 v[154:157], a[220:223], v[214:217], v[154:157]
    v_pk_fma_f16 v193, v148, v132, v193
    v_pk_fma_f16 v193, v149, v133, v193
    v_mfma_f32_16x16x32_bf16 v[154:157], a[224:227], v[206:209], v[154:157]
    s_waitcnt lgkmcnt(0)
    v_pk_mul_f16 v192, v142, v210
    v_pk_fma_f16 v192, v143, v211, v192
    v_mfma_f32_16x16x32_bf16 v[154:157], a[228:231], v[218:221], v[154:157]
    v_pk_fma_f16 v192, v144, v212, v192
    v_pk_fma_f16 v192, v145, v213, v192
    v_mfma_f32_16x16x32_bf16 v[154:157], a[232:235], v[230:233], v[154:157]
    v_pk_fma_f16 v192, v146, v130, v192
    v_pk_fma_f16 v192, v147, v131, v192
    v_mfma_f32_16x16x32_bf16 v[154:157], a[236:239], v[234:237], v[154:157]
    v_cvt_pk_bf16_f32 v238, v198, v199
    v_cvt_pk_bf16_f32 v239, v200, v201
    v_mfma_f32_16x16x32_f16 v[198:201], v[40:43], v[190:193], 0
    v_cvt_pk_bf16_f32 v190, v134, v135
    v_cvt_pk_bf16_f32 v191, v136, v137
    v_mfma_f32_16x16x32_bf16 v[134:137], a[240:243], v[226:229], 0
    v_cvt_pk_bf16_f32 v126, v166, v167
    v_cvt_pk_bf16_f32 v127, v168, v169
    v_mfma_f32_16x16x32_bf16 v[134:137], a[244:247], v[214:217], v[134:137]
    v_fma_f32 v255, v154, v154, s33
    v_fmac_f32 v255, v155, v155
    v_mfma_f32_16x16x32_bf16 v[134:137], a[248:251], v[206:209], v[134:137]
    v_fmac_f32 v255, v156, v156
    v_fmac_f32 v255, v157, v157
    v_mfma_f32_16x16x32_bf16 v[134:137], a[252:255], v[218:221], v[134:137]
    v_rsq_f32 v198, v198
    v_mfma_f32_16x16x32_bf16 v[134:137], v[82:85], v[230:233], v[134:137]
    v_rsq_f32 v199, v199
    v_mfma_f32_16x16x32_bf16 v[134:137], v[86:89], v[234:237], v[134:137]
    v_mul_f32 v192, s31, v198
    v_cvt_pk_f16_f32 v193, v192, v199
    v_mfma_f32_16x16x32_bf16 v[242:245], v[90:93], v[226:229], 0
    ds_read_b128 v[166:169], v2 offset:6144
    v_fma_f32 v200, v200, v192, v22
    v_mfma_f32_16x16x32_bf16 v[242:245], v[94:97], v[214:217], v[242:245]
    ds_read_b128 v[226:229], v2 offset:7168
    v_fmac_f32_dpp v254, v201, v199 quad_perm:[0,1,2,3] row_mask:0x1 bank_mask:0xf
    v_mfma_f32_16x16x32_bf16 v[242:245], v[98:101], v[206:209], v[242:245]
    ds_read_b128 v[214:217], v2 offset:8192
    v_fmac_f32 v255, v134, v134
    v_mfma_f32_16x16x32_bf16 v[242:245], v[102:105], v[218:221], v[242:245]
    ds_read_b128 v[206:209], v2 offset:9216
    buffer_store_dwordx4 v[122:125], v15, s[48:51], 0 offen nt
    v_fmac_f32 v255, v135, v135
    v_fmac_f32 v255, v136, v136
    v_fmac_f32 v255, v137, v137
    v_pk_mul_f16 v194, v194, v193 op_sel:[0,1] op_sel_hi:[1,1]
    v_mfma_f32_16x16x32_bf16 v[242:245], v[106:109], v[230:233], v[242:245]
    ds_read_b128 v[122:125], v2 offset:10240
    v_pk_mul_f16 v195, v195, v193 op_sel:[0,1] op_sel_hi:[1,1]
    v_mfma_f32_16x16x32_bf16 v[242:245], v[110:113], v[234:237], v[242:245]
    ds_read_b128 v[218:221], v2 offset:11264
    v_pk_mul_f16 v196, v196, v193 op_sel:[0,1] op_sel_hi:[1,1]
    v_mfma_f32_16x16x32_bf16 v[222:225], a[112:115], v[118:121], v[222:225]
    s_waitcnt lgkmcnt(5)
    v_pk_mul_f16 v197, v197, v193 op_sel:[0,1] op_sel_hi:[1,1]
    v_pk_mul_f16 v148, v148, v193 op_sel:[0,1] op_sel_hi:[1,1]
    v_mfma_f32_16x16x32_bf16 v[230:233], a[216:219], v[166:169], 0
    s_waitcnt lgkmcnt(4)
    v_fmac_f32 v255, v242, v242
    v_fmac_f32 v255, v243, v243
    v_mfma_f32_16x16x32_bf16 v[230:233], a[220:223], v[226:229], v[230:233]
    s_waitcnt lgkmcnt(3)
    v_fmac_f32 v255, v244, v244
    v_fmac_f32 v255, v245, v245
    v_mfma_f32_16x16x32_bf16 v[230:233], a[224:227], v[214:217], v[230:233]
    s_waitcnt lgkmcnt(2)
    v_pk_mul_f16 v149, v149, v193 op_sel:[0,1] op_sel_hi:[1,1]
    v_pk_mul_f16 v142, v142, v193 op_sel:[0,0] op_sel_hi:[1,0]
    v_mfma_f32_16x16x32_bf16 v[230:233], a[228:231], v[206:209], v[230:233]
    v_pk_mul_f16 v143, v143, v193 op_sel:[0,0] op_sel_hi:[1,0]
    v_pk_mul_f16 v144, v144, v193 op_sel:[0,0] op_sel_hi:[1,0]
    v_mfma_f32_16x16x32_bf16 v[222:225], a[116:119], v[158:161], v[222:225]
    s_waitcnt lgkmcnt(1)
    v_pk_mul_f16 v145, v145, v193 op_sel:[0,0] op_sel_hi:[1,0]
    v_pk_mul_f16 v146, v146, v193 op_sel:[0,0] op_sel_hi:[1,0]
    v_mfma_f32_16x16x32_bf16 v[230:233], a[232:235], v[122:125], v[230:233]
    s_waitcnt lgkmcnt(0)
    v_pk_mul_f16 v147, v147, v193 op_sel:[0,0] op_sel_hi:[1,0]
    v_max3_u32 v44, v44, v198, v199
    v_mfma_f32_16x16x32_bf16 v[230:233], a[236:239], v[218:221], v[230:233]
    v_mov_b32 v198, 0x40000000
    v_cvt_pk_f16_f32 v246, v182, v183
    v_mfma_f32_16x16x32_bf16 v[234:237], a[240:243], v[166:169], 0
    v_pk_mul_f16 v183, v246, v246
    v_cvt_pk_f16_f32 v247, v184, v185
    v_mfma_f32_16x16x32_bf16 v[234:237], a[244:247], v[226:229], v[234:237]
    v_pk_fma_f16 v183, v247, v247, v183
    v_cvt_pk_f16_f32 v248, v222, v223
    v_mfma_f32_16x16x32_bf16 v[234:237], a[248:251], v[214:217], v[234:237]
    v_pk_fma_f16 v183, v248, v248, v183
    v_cvt_pk_f16_f32 v249, v224, v225
    v_mfma_f32_16x16x32_bf16 v[234:237], a[252:255], v[206:209], v[234:237]
    v_pk_fma_f16 v183, v249, v249, v183
    v_pk_mul_f16 v185, v246, v174
    v_mfma_f32_16x16x32_bf16 v[234:237], v[82:85], v[122:125], v[234:237]
    v_pk_fma_f16 v185, v247, v175, v185
    v_pk_fma_f16 v185, v248, v176, v185
    v_mfma_f32_16x16x32_bf16 v[234:237], v[86:89], v[218:221], v[234:237]
    buffer_store_dwordx2 v[202:203], v18, s[48:51], 0 offen nt
    v_pk_fma_f16 v185, v249, v177, v185
    v_fma_f32 v129, v230, v230, s33
    v_mfma_f32_16x16x32_bf16 v[222:225], v[90:93], v[166:169], 0
    v_fmac_f32 v129, v231, v231
    v_fmac_f32 v129, v232, v232
    v_mfma_f32_16x16x32_bf16 v[222:225], v[94:97], v[226:229], v[222:225]
    v_fmac_f32 v129, v233, v233
    v_fmac_f32 v129, v234, v234
    v_mfma_f32_16x16x32_bf16 v[222:225], v[98:101], v[214:217], v[222:225]
    v_fmac_f32 v129, v235, v235
    v_fmac_f32 v129, v236, v236
    v_mfma_f32_16x16x32_bf16 v[222:225], v[102:105], v[206:209], v[222:225]
    v_fmac_f32 v129, v237, v237
    v_mul_f32 v128, 0x3baaaaab, v128
    v_mfma_f32_16x16x32_bf16 v[222:225], v[106:109], v[122:125], v[222:225]
    v_rsq_f32 v128, v128
    v_mfma_f32_16x16x32_bf16 v[222:225], v[110:113], v[218:221], v[222:225]
    v_mul_f32 v150, v128, v150
    v_mul_f32 v151, v128, v151
    v_mfma_f32_16x16x32_bf16 v[122:125], a[120:123], v[170:173], 0
    v_cvt_pk_bf16_f32 v150, v150, v151
    v_mul_f32 v152, v128, v152
    v_mfma_f32_16x16x32_bf16 v[122:125], a[124:127], v[178:181], v[122:125]
    v_mul_f32 v153, v128, v153
    v_cvt_pk_bf16_f32 v151, v152, v153
    v_mfma_f32_16x16x32_bf16 v[122:125], a[128:131], v[186:189], v[122:125]
    v_fmac_f32 v129, v222, v222
    v_fmac_f32 v129, v223, v223
    v_mfma_f32_16x16x32_bf16 v[122:125], a[132:135], v[114:117], v[122:125]
    v_fmac_f32 v129, v224, v224
    v_fmac_f32 v129, v225, v225
    v_mfma_f32_16x16x32_bf16 v[122:125], a[136:139], v[118:121], v[122:125]
    v_cvt_pk_bf16_f32 v192, v255, v129
    v_cvt_pk_bf16_f32 v193, v129, v129
    v_mfma_f32_16x16x32_bf16 v[122:125], a[140:143], v[158:161], v[122:125]
    v_mul_f32 v162, v128, v162
    v_mul_f32 v163, v128, v163
    v_mfma_f32_16x16x32_bf16 v[166:169], a[0:3], v[170:173], 0
    v_cvt_pk_bf16_f32 v152, v162, v163
    v_mul_f32 v164, v128, v164
    v_mfma_f32_16x16x32_bf16 v[166:169], a[4:7], v[178:181], v[166:169]
    v_mul_f32 v165, v128, v165
    v_cvt_pk_bf16_f32 v153, v164, v165
    v_mfma_f32_16x16x32_bf16 v[166:169], a[8:11], v[186:189], v[166:169]
    v_cvt_pk_f16_f32 v164, v122, v123
    v_pk_fma_f16 v183, v164, v164, v183
    v_mfma_f32_16x16x32_bf16 v[166:169], a[12:15], v[114:117], v[166:169]
    buffer_store_dwordx4 v[150:153], v17, s[48:51], 0 offen nt
    v_cvt_pk_f16_f32 v165, v124, v125
    v_pk_fma_f16 v183, v165, v165, v183
    v_pk_fma_f16 v185, v164, v132, v185
    v_pk_fma_f16 v185, v165, v133, v185
    v_mfma_f32_16x16x32_bf16 v[166:169], a[16:19], v[118:121], v[166:169]
    v_mul_f32 v138, v128, v138
    v_mul_f32 v139, v128, v139
    v_mfma_f32_16x16x32_bf16 v[166:169], a[20:23], v[158:161], v[166:169]
    v_cvt_pk_bf16_f32 v162, v138, v139
    v_mul_f32 v140, v128, v140
    v_mfma_f32_16x16x32_bf16 v[122:125], a[24:27], v[170:173], 0
    v_mul_f32 v141, v128, v141
    v_cvt_pk_bf16_f32 v163, v140, v141
    v_mfma_f32_16x16x32_bf16 v[122:125], a[28:31], v[178:181], v[122:125]
    v_bfe_u32 v201, v2, 4, 6
    v_lshrrev_b32 v255, 4, v201
    v_mfma_f32_16x16x32_bf16 v[122:125], a[32:35], v[186:189], v[122:125]
    v_cvt_pk_f16_f32 v150, v166, v167
    v_pk_mul_f16 v182, v150, v150
    v_mfma_f32_16x16x32_bf16 v[122:125], a[36:39], v[114:117], v[122:125]
    v_cvt_pk_f16_f32 v151, v168, v169
    v_pk_fma_f16 v182, v151, v151, v182
    v_mfma_f32_16x16x32_bf16 v[122:125], a[40:43], v[118:121], v[122:125]
    v_pk_mul_f16 v184, v150, v210
    v_pk_fma_f16 v184, v151, v211, v184
    v_mfma_f32_16x16x32_bf16 v[122:125], a[44:47], v[158:161], v[122:125]
    v_and_b32 v199, 15, v201
    v_add_u32 v128, 0, v199
    v_mfma_f32_16x16x32_bf16 v[138:141], a[48:51], v[170:173], 0
    v_mul_u32_u24 v129, s20, v128
    v_add_u32 v129, s38, v129
    v_mfma_f32_16x16x32_bf16 v[138:141], a[52:55], v[178:181], v[138:141]
    v_mul_u32_u24 v152, 911, v129
    v_lshrrev_b32 v152, 16, v152
    v_mfma_f32_16x16x32_bf16 v[138:141], a[56:59], v[186:189], v[138:141]
    v_mul_u32_u24 v152, s22, v152
    v_mad_u32_u24 v152, v128, s21, v152
    v_mfma_f32_16x16x32_bf16 v[138:141], a[60:63], v[114:117], v[138:141]
    v_bfe_u32 v129, s63, v128, 1
    v_cmp_ne_u32 vcc, 0, v129
    v_mfma_f32_16x16x32_bf16 v[138:141], a[64:67], v[118:121], v[138:141]
    v_add_u32 v128, s7, v152
    v_cndmask_b32 v128, v198, v128, vcc
    v_mfma_f32_16x16x32_bf16 v[138:141], a[68:71], v[158:161], v[138:141]
    v_lshl_add_u32 v167, v255, 4, v128
    v_add_u32 v167, s3, v167
    v_mfma_f32_16x16x32_bf16 v[202:205], v[170:173], a[144:147], 0
    v_lshl_add_u32 v166, v255, 3, v128
    v_add_u32 v166, s4, v166
    v_mfma_f32_16x16x32_bf16 v[202:205], v[178:181], a[148:151], v[202:205]
    buffer_store_dwordx2 v[162:163], v20, s[48:51], 0 offen nt
    v_cvt_pk_f16_f32 v152, v122, v123
    v_pk_fma_f16 v182, v152, v152, v182
    v_mfma_f32_16x16x32_bf16 v[202:205], v[186:189], a[152:155], v[202:205]
    v_cvt_pk_f16_f32 v153, v124, v125
    v_pk_fma_f16 v182, v153, v153, v182
    v_mfma_f32_16x16x32_bf16 v[202:205], v[114:117], a[156:159], v[202:205]
    v_cvt_pk_f16_f32 v162, v138, v139
    v_pk_fma_f16 v182, v162, v162, v182
    v_mfma_f32_16x16x32_bf16 v[202:205], v[118:121], a[160:163], v[202:205]
    v_cvt_pk_f16_f32 v163, v140, v141
    v_pk_fma_f16 v182, v163, v163, v182
    v_mfma_f32_16x16x32_bf16 v[202:205], v[158:161], a[164:167], v[202:205]
    v_pk_fma_f16 v184, v152, v212, v184
    v_pk_fma_f16 v184, v153, v213, v184
    v_mfma_f32_16x16x32_bf16 v[122:125], v[170:173], a[168:171], 0
    v_pk_fma_f16 v184, v162, v130, v184
    v_pk_fma_f16 v184, v163, v131, v184
    v_mfma_f32_16x16x32_bf16 v[122:125], v[178:181], a[172:175], v[122:125]
    v_lshlrev_b32 v206, 9, v255
    v_lshl_add_u32 v206, v199, 4, v206
    v_mfma_f32_16x16x32_f16 v[214:217], v[40:43], v[182:185], 0
    v_cvt_pk_bf16_f32 v240, v202, v203
    v_cvt_pk_bf16_f32 v241, v204, v205
    v_mfma_f32_16x16x32_bf16 v[122:125], v[186:189], a[176:179], v[122:125]
    v_add_u32 v206, 149696, v206
    v_and_b32 v168, 0xffff, v2
    v_mfma_f32_16x16x32_bf16 v[122:125], v[114:117], a[180:183], v[122:125]
    v_add_u32 v168, 38912, v168
    v_and_b32 v169, 0xffff, v4
    v_mfma_f32_16x16x32_bf16 v[122:125], v[118:121], a[184:187], v[122:125]
    ds_read_b128 v[138:141], v0 offset:32768
    v_add_u32 v169, 38912, v169
    v_mfma_f32_16x16x32_bf16 v[122:125], v[158:161], a[188:191], v[122:125]
    ds_read_b128 v[182:185], v1 offset:32768
    v_add_u32 v208, 16, v199
    v_mfma_f32_16x16x32_bf16 v[202:205], v[170:173], a[192:195], 0
    ds_read_b128 v[218:221], v0 offset:32896
    v_min_u32 v207, 20, v208
    v_mfma_f32_16x16x32_bf16 v[202:205], v[178:181], a[196:199], v[202:205]
    ds_write_b64 v169, v[192:193] offset:0
    v_mfma_f32_16x16x32_bf16 v[202:205], v[186:189], a[200:203], v[202:205]
    v_rsq_f32 v214, v214
    v_mfma_f32_16x16x32_bf16 v[202:205], v[114:117], a[204:207], v[202:205]
    ds_read_b128 v[114:117], v1 offset:32896
    ds_read_b128 v[170:173], v0 offset:33024
    v_mfma_f32_16x16x32_bf16 v[202:205], v[118:121], a[208:211], v[202:205]
    ds_read_b128 v[178:181], v1 offset:33024
    v_mul_f32 v186, s31, v214
    v_mfma_f32_16x16x32_bf16 v[202:205], v[158:161], a[212:215], v[202:205]
    s_waitcnt lgkmcnt(6)
    v_rsq_f32 v215, v215
    v_mfma_f32_16x16x32_bf16 v[118:121], a[72:75], v[138:141], 0
    s_waitcnt lgkmcnt(5)
    v_cvt_pk_f16_f32 v187, v186, v215
    v_fma_f32 v216, v216, v186, v24
    v_mfma_f32_16x16x32_bf16 v[118:121], a[76:79], v[182:185], v[118:121]
    s_waitcnt lgkmcnt(4)
    v_fmac_f32_dpp v254, v217, v215 quad_perm:[0,1,2,3] row_mask:0x2 bank_mask:0xf
    v_cvt_pk_bf16_f32 v192, v122, v123
    v_mfma_f32_16x16x32_bf16 v[118:121], a[80:83], v[218:221], v[118:121]
    s_waitcnt lgkmcnt(3)
    v_cvt_pk_bf16_f32 v193, v124, v125
    v_cvt_pk_bf16_f32 v128, v202, v203
    v_mfma_f32_16x16x32_bf16 v[122:125], a[96:99], v[138:141], 0
    s_barrier
    ds_read_b128 v[158:161], v168 offset:0
    v_cvt_pk_bf16_f32 v129, v204, v205
    v_mfma_f32_16x16x32_bf16 v[122:125], a[100:103], v[182:185], v[122:125]
    s_waitcnt lgkmcnt(2)
    v_pk_mul_f16 v246, v246, v187 op_sel:[0,1] op_sel_hi:[1,1]
    v_pk_mul_f16 v247, v247, v187 op_sel:[0,1] op_sel_hi:[1,1]
    v_mfma_f32_16x16x32_bf16 v[118:121], a[84:87], v[114:117], v[118:121]
    s_waitcnt lgkmcnt(1)
    v_pk_mul_f16 v248, v248, v187 op_sel:[0,1] op_sel_hi:[1,1]
    v_pk_mul_f16 v249, v249, v187 op_sel:[0,1] op_sel_hi:[1,1]
    v_mfma_f32_16x16x32_bf16 v[118:121], a[88:91], v[170:173], v[118:121]
    v_pk_mul_f16 v164, v164, v187 op_sel:[0,1] op_sel_hi:[1,1]
    v_pk_mul_f16 v165, v165, v187 op_sel:[0,1] op_sel_hi:[1,1]
    v_mfma_f32_16x16x32_bf16 v[118:121], a[92:95], v[178:181], v[118:121]
    v_pk_mul_f16 v150, v150, v187 op_sel:[0,0] op_sel_hi:[1,0]
    v_pk_mul_f16 v151, v151, v187 op_sel:[0,0] op_sel_hi:[1,0]
    v_mfma_f32_16x16x32_bf16 v[122:125], a[104:107], v[218:221], v[122:125]
    v_pk_mul_f16 v152, v152, v187 op_sel:[0,0] op_sel_hi:[1,0]
    v_pk_mul_f16 v153, v153, v187 op_sel:[0,0] op_sel_hi:[1,0]
    v_mfma_f32_16x16x32_bf16 v[122:125], a[108:111], v[114:117], v[122:125]
    v_pk_mul_f16 v162, v162, v187 op_sel:[0,0] op_sel_hi:[1,0]
    v_pk_mul_f16 v163, v163, v187 op_sel:[0,0] op_sel_hi:[1,0]
    v_mfma_f32_16x16x32_bf16 v[122:125], a[112:115], v[170:173], v[122:125]
    s_waitcnt lgkmcnt(0)
    v_max3_u32 v44, v44, v214, v215
    v_cvt_pk_f16_f32 v118, v118, v119
    v_mfma_f32_16x16x32_bf16 v[202:205], v[32:35], v[158:161], 0
    ds_read_b128 v[158:161], v168 offset:1024
    v_pk_mul_f16 v187, v118, v118
    v_mfma_f32_16x16x32_bf16 v[122:125], a[116:119], v[178:181], v[122:125]
    v_cvt_pk_f16_f32 v119, v120, v121
    v_pk_fma_f16 v187, v119, v119, v187
    v_pk_mul_f16 v189, v118, v174
    v_pk_fma_f16 v189, v119, v175, v189
    v_exp_f32 v200, v200
    v_exp_f32 v216, v216
    v_cvt_pk_bf16_f32 v39, v200, 0
    v_add_u32 v200, 12, v208
    v_cvt_pk_f16_f32 v120, v122, v123
    v_pk_fma_f16 v187, v120, v120, v187
    v_cvt_pk_f16_f32 v121, v124, v125
    v_mfma_f32_16x16x32_bf16 v[122:125], a[120:123], v[138:141], 0
    v_pk_fma_f16 v187, v121, v121, v187
    v_pk_fma_f16 v189, v120, v176, v189
    v_mfma_f32_16x16x32_bf16 v[122:125], a[124:127], v[182:185], v[122:125]
    v_pk_fma_f16 v189, v121, v177, v189
    v_lshrrev_b32 v200, 5, v200
    v_mfma_f32_16x16x32_bf16 v[122:125], a[128:131], v[218:221], v[122:125]
    s_waitcnt lgkmcnt(0)
    v_sub_u32 v214, v208, v207
    v_mad_i32_i24 v214, v200, s6, v214
    v_mfma_f32_16x16x32_bf16 v[202:205], v[32:35], v[158:161], v[202:205]
    v_mul_u32_u24 v209, s20, v207
    v_add3_u32 v209, v209, v214, s38
    v_mfma_f32_16x16x32_bf16 v[122:125], a[132:135], v[114:117], v[122:125]
    v_mul_u32_u24 v200, 911, v209
    v_lshrrev_b32 v200, 16, v200
    v_mfma_f32_16x16x32_bf16 v[122:125], a[136:139], v[170:173], v[122:125]
    v_mul_u32_u24 v200, s22, v200
    v_mad_u32_u24 v200, v207, s21, v200
    v_mfma_f32_16x16x32_bf16 v[122:125], a[140:143], v[178:181], v[122:125]
    v_mul_f32 v186, 0x3baaaaab, v203
    v_mul_f32 v188, 0x3baaaaab, v202
    v_mfma_f32_16x16x32_bf16 v[174:177], a[0:3], v[138:141], 0
    v_rsq_f32 v186, v186
    v_mfma_f32_16x16x32_bf16 v[174:177], a[4:7], v[182:185], v[174:177]
    v_mul_f32 v230, v186, v230
    v_mul_f32 v231, v186, v231
    v_mfma_f32_16x16x32_bf16 v[174:177], a[8:11], v[218:221], v[174:177]
    v_cvt_pk_bf16_f32 v158, v230, v231
    v_mul_f32 v232, v186, v232
    v_mfma_f32_16x16x32_bf16 v[174:177], a[12:15], v[114:117], v[174:177]
    v_mul_f32 v233, v186, v233
    v_cvt_pk_bf16_f32 v159, v232, v233
    v_mfma_f32_16x16x32_bf16 v[174:177], a[16:19], v[170:173], v[174:177]
    v_mul_f32 v234, v186, v234
    v_mul_f32 v235, v186, v235
    v_mfma_f32_16x16x32_bf16 v[174:177], a[20:23], v[178:181], v[174:177]
    v_cvt_pk_bf16_f32 v160, v234, v235
    v_mul_f32 v236, v186, v236
    v_mfma_f32_16x16x32_bf16 v[202:205], a[24:27], v[138:141], 0
    v_mul_f32 v237, v186, v237
    v_cvt_pk_bf16_f32 v161, v236, v237
    v_mfma_f32_16x16x32_bf16 v[202:205], a[28:31], v[182:185], v[202:205]
    buffer_store_dwordx4 v[158:161], v16, s[52:55], 0 offen nt
    v_mul_f32 v222, v186, v222
    v_mul_f32 v223, v186, v223
    v_cvt_pk_bf16_f32 v222, v222, v223
    v_mul_f32 v224, v186, v224
    v_mfma_f32_16x16x32_bf16 v[202:205], a[32:35], v[218:221], v[202:205]
    v_mul_f32 v225, v186, v225
    v_cvt_pk_bf16_f32 v223, v224, v225
    v_mfma_f32_16x16x32_f16 v[158:161], v[194:197], v[142:145], v[46:49]
    v_rsq_f32 v188, v188
    v_mfma_f32_16x16x32_f16 v[226:229], v[246:249], v[142:145], v[50:53]
    v_mul_f32 v154, v188, v154
    v_mul_f32 v155, v188, v155
    v_mfma_f32_16x16x32_bf16 v[202:205], a[36:39], v[114:117], v[202:205]
    v_cvt_pk_bf16_f32 v154, v154, v155
    v_mul_f32 v156, v188, v156
    v_mul_f32 v157, v188, v157
    v_mfma_f32_16x16x16_f16 v[158:161], v[148:149], v[146:147], v[158:161]
    v_cvt_pk_bf16_f32 v155, v156, v157
    v_mul_f32 v134, v188, v134
    v_mul_f32 v135, v188, v135
    v_mfma_f32_16x16x16_f16 v[226:229], v[164:165], v[146:147], v[226:229]
    v_cvt_pk_bf16_f32 v156, v134, v135
    v_mul_f32 v136, v188, v136
    v_mul_f32 v137, v188, v137
    v_cvt_pk_bf16_f32 v157, v136, v137
    v_mfma_f32_16x16x32_bf16 v[202:205], a[40:43], v[170:173], v[202:205]
    v_mul_f32 v242, v188, v242
    v_mul_f32 v243, v188, v243
    v_mfma_f32_16x16x32_bf16 v[202:205], a[44:47], v[178:181], v[202:205]
    v_cvt_pk_bf16_f32 v224, v242, v243
    v_mul_f32 v244, v188, v244
    v_mfma_f32_16x16x32_bf16 v[230:233], a[48:51], v[138:141], 0
    v_mul_f32 v245, v188, v245
    v_cvt_pk_bf16_f32 v225, v244, v245
    v_mfma_f32_16x16x32_bf16 v[230:233], a[52:55], v[182:185], v[230:233]
    v_cvt_pk_f16_f32 v134, v174, v175
    v_pk_mul_f16 v186, v134, v134
    v_mfma_f32_16x16x32_bf16 v[230:233], a[56:59], v[218:221], v[230:233]
    v_cvt_pk_f16_f32 v135, v176, v177
    v_pk_fma_f16 v186, v135, v135, v186
    v_mfma_f32_16x16x32_bf16 v[230:233], a[60:63], v[114:117], v[230:233]
    v_cvt_pk_f16_f32 v136, v202, v203
    v_pk_fma_f16 v186, v136, v136, v186
    v_mfma_f32_16x16x32_bf16 v[230:233], a[64:67], v[170:173], v[230:233]
    v_cvt_pk_f16_f32 v137, v204, v205
    v_pk_fma_f16 v186, v137, v137, v186
    v_mfma_f32_16x16x32_bf16 v[230:233], a[68:71], v[178:181], v[230:233]
    v_pk_mul_f16 v188, v134, v210
    v_pk_fma_f16 v188, v135, v211, v188
    v_mfma_f32_16x16x32_bf16 v[202:205], v[138:141], a[144:147], 0
    buffer_store_dwordx2 v[222:223], v19, s[52:55], 0 offen nt
    v_pk_fma_f16 v188, v136, v212, v188
    v_pk_fma_f16 v188, v137, v213, v188
    v_mfma_f32_16x16x32_bf16 v[202:205], v[182:185], a[148:151], v[202:205]
    v_cvt_pk_f16_f32 v176, v122, v123
    v_cvt_pk_f16_f32 v174, v230, v231
    v_mfma_f32_16x16x32_bf16 v[202:205], v[218:221], a[152:155], v[202:205]
    v_pk_fma_f16 v186, v174, v174, v186
    v_cvt_pk_f16_f32 v175, v232, v233
    v_mfma_f32_16x16x32_bf16 v[202:205], v[114:117], a[156:159], v[202:205]
    v_pk_fma_f16 v186, v175, v175, v186
    v_pk_fma_f16 v188, v174, v130, v188
    v_mfma_f32_16x16x32_bf16 v[202:205], v[170:173], a[160:163], v[202:205]
    v_pk_fma_f16 v188, v175, v131, v188
    v_pk_fma_f16 v187, v176, v176, v187
    v_mfma_f32_16x16x32_bf16 v[202:205], v[178:181], a[164:167], v[202:205]
    v_cvt_pk_f16_f32 v177, v124, v125
    v_pk_fma_f16 v187, v177, v177, v187
    v_mfma_f32_16x16x32_bf16 v[122:125], v[138:141], a[168:171], 0
    v_pk_fma_f16 v189, v176, v132, v189
    v_pk_fma_f16 v189, v177, v133, v189
    v_mfma_f32_16x16x32_bf16 v[122:125], v[182:185], a[172:175], v[122:125]
    v_exp_f32 v158, v158
    v_mfma_f32_16x16x32_f16 v[210:213], v[40:43], v[186:189], 0
    v_cvt_pk_bf16_f32 v230, v202, v203
    v_cvt_pk_bf16_f32 v231, v204, v205
    v_mfma_f32_16x16x32_bf16 v[122:125], v[218:221], a[176:179], v[122:125]
    v_exp_f32 v159, v159
    v_mfma_f32_16x16x32_bf16 v[122:125], v[114:117], a[180:183], v[122:125]
    v_cvt_pk_bf16_f32 v130, v158, v159
    v_bfe_u32 v209, s63, v208, 1
    v_mfma_f32_16x16x32_bf16 v[122:125], v[170:173], a[184:187], v[122:125]
    v_rsq_f32 v210, v210
    v_mfma_f32_16x16x32_bf16 v[122:125], v[178:181], a[188:191], v[122:125]
    ds_read_b128 v[234:237], v2 offset:12288
    ds_read_b128 v[202:205], v2 offset:13312
    v_mfma_f32_16x16x32_bf16 v[186:189], v[138:141], a[192:195], 0
    ds_read_b128 v[138:141], v2 offset:14336
    ds_read_b128 v[242:245], v2 offset:15360
    v_mfma_f32_16x16x32_bf16 v[186:189], v[182:185], a[196:199], v[186:189]
    v_rsq_f32 v211, v211
    v_mfma_f32_16x16x32_bf16 v[186:189], v[218:221], a[200:203], v[186:189]
    ds_read_b128 v[218:221], v2 offset:16384
    ds_read_b128 v[182:185], v2 offset:17408
    v_mfma_f32_16x16x32_bf16 v[186:189], v[114:117], a[204:207], v[186:189]
    buffer_store_dwordx4 v[154:157], v15, s[52:55], 0 offen nt
    v_mul_f32 v158, s31, v210
    v_cvt_pk_f16_f32 v159, v158, v211
    v_fma_f32 v212, v212, v158, v26
    v_fmac_f32_dpp v254, v213, v211 quad_perm:[0,1,2,3] row_mask:0x4 bank_mask:0xf
    v_mfma_f32_16x16x32_bf16 v[186:189], v[170:173], a[208:211], v[186:189]
    v_cvt_pk_bf16_f32 v122, v122, v123
    v_cvt_pk_bf16_f32 v123, v124, v125
    v_mfma_f32_16x16x32_bf16 v[186:189], v[178:181], a[212:215], v[186:189]
    s_waitcnt lgkmcnt(4)
    ds_read2_b32 v[232:233], v6 offset0:0 offset1:0
    ds_read2_b32 v[124:125], v6 offset0:16 offset1:16
    v_mfma_f32_16x16x32_bf16 v[178:181], a[216:219], v[234:237], 0
    s_waitcnt lgkmcnt(4)
    ds_read2_b32 v[116:117], v6 offset0:32 offset1:32
    v_pk_mul_f16 v118, v118, v159 op_sel:[0,1] op_sel_hi:[1,1]
    v_mfma_f32_16x16x32_bf16 v[178:181], a[220:223], v[202:205], v[178:181]
    v_cvt_pk_bf16_f32 v114, v186, v187
    v_cvt_pk_bf16_f32 v115, v188, v189
    v_mfma_f32_16x16x32_bf16 v[178:181], a[224:227], v[138:141], v[178:181]
    s_waitcnt lgkmcnt(3)
    v_exp_f32 v254, v254
    v_mfma_f32_16x16x32_bf16 v[178:181], a[228:231], v[242:245], v[178:181]
    v_cvt_pk_bf16_f32 v254, v254, v254
    v_pk_mul_f16 v119, v119, v159 op_sel:[0,1] op_sel_hi:[1,1]
    v_mfma_f32_16x16x32_bf16 v[178:181], a[232:235], v[218:221], v[178:181]
    ds_write_b16 v8, v254
    v_mfma_f32_16x16x32_bf16 v[178:181], a[236:239], v[182:185], v[178:181]
    v_pk_mul_f16 v120, v120, v159 op_sel:[0,1] op_sel_hi:[1,1]
    v_pk_mul_f16 v121, v121, v159 op_sel:[0,1] op_sel_hi:[1,1]
    v_mfma_f32_16x16x32_bf16 v[170:173], a[240:243], v[234:237], 0
    s_waitcnt lgkmcnt(2)
    v_pk_mul_f16 v176, v176, v159 op_sel:[0,1] op_sel_hi:[1,1]
    v_pk_mul_f16 v177, v177, v159 op_sel:[0,1] op_sel_hi:[1,1]
    v_mfma_f32_16x16x32_f16 v[154:157], v[118:121], v[142:145], v[54:57]
    s_waitcnt lgkmcnt(1)
    v_pk_mul_f16 v134, v134, v159 op_sel:[0,0] op_sel_hi:[1,0]
    v_pk_mul_f16 v135, v135, v159 op_sel:[0,0] op_sel_hi:[1,0]
    v_mfma_f32_16x16x32_bf16 v[170:173], a[244:247], v[202:205], v[170:173]
    v_pk_mul_f16 v136, v136, v159 op_sel:[0,0] op_sel_hi:[1,0]
    v_pk_mul_f16 v137, v137, v159 op_sel:[0,0] op_sel_hi:[1,0]
    v_pk_mul_f16 v174, v174, v159 op_sel:[0,0] op_sel_hi:[1,0]
    v_mfma_f32_16x16x16_f16 v[154:157], v[176:177], v[146:147], v[154:157]
    v_pk_mul_f16 v175, v175, v159 op_sel:[0,0] op_sel_hi:[1,0]
    v_max3_u32 v44, v44, v210, v211
    v_exp_f32 v160, v160
    v_mfma_f32_16x16x32_bf16 v[170:173], a[248:251], v[138:141], v[170:173]
    v_exp_f32 v161, v161
    v_mfma_f32_16x16x32_bf16 v[170:173], a[252:255], v[242:245], v[170:173]
    v_cvt_pk_bf16_f32 v131, v160, v161
    v_sub_u32 v254, 0x40800000, v44
    v_mfma_f32_16x16x32_bf16 v[170:173], v[82:85], v[218:221], v[170:173]
    buffer_store_dwordx2 v[224:225], v18, s[52:55], 0 offen nt
    v_exp_f32 v226, v226
    v_mfma_f32_16x16x32_bf16 v[170:173], v[86:89], v[182:185], v[170:173]
    v_exp_f32 v227, v227
    v_mfma_f32_16x16x32_bf16 v[142:145], v[90:93], v[234:237], 0
    ds_read_b128 v[186:189], v206 offset:0
    v_cvt_pk_bf16_f32 v132, v226, v227
    v_mfma_f32_16x16x32_bf16 v[142:145], v[94:97], v[202:205], v[142:145]
    ds_read_b128 v[222:225], v206 offset:2048
    v_or_b32 v254, v254, v44
    v_mfma_f32_16x16x32_bf16 v[142:145], v[98:101], v[138:141], v[142:145]
    ds_read_b128 v[138:141], v206 offset:4096
    v_fma_f32 v146, v178, v178, s33
    v_mfma_f32_16x16x32_bf16 v[142:145], v[102:105], v[242:245], v[142:145]
    ds_read_b128 v[234:237], v206 offset:6144
    v_fmac_f32 v146, v179, v179
    v_mfma_f32_16x16x32_bf16 v[142:145], v[106:109], v[218:221], v[142:145]
    ds_read_b128 v[202:205], v206 offset:8192
    v_fmac_f32 v146, v180, v180
    v_mfma_f32_16x16x32_bf16 v[142:145], v[110:113], v[182:185], v[142:145]
    ds_read_b128 v[182:185], v206 offset:10240
    v_exp_f32 v228, v228
    v_exp_f32 v229, v229
    v_mfma_f32_16x16x32_f16 v[242:245], v[194:197], v[150:153], v[58:61]
    s_waitcnt lgkmcnt(5)
    v_cvt_pk_bf16_f32 v133, v228, v229
    v_fmac_f32 v146, v181, v181
    v_mfma_f32_16x16x32_bf16 v[158:161], a[216:219], v[186:189], 0
    s_waitcnt lgkmcnt(4)
    v_exp_f32 v154, v154
    v_fmac_f32 v146, v170, v170
    v_mfma_f32_16x16x16_f16 v[242:245], v[148:149], v[162:163], v[242:245]
    v_exp_f32 v155, v155
    v_exp_f32 v156, v156
    v_mfma_f32_16x16x32_bf16 v[158:161], a[220:223], v[222:225], v[158:161]
    s_waitcnt lgkmcnt(2)
    v_cvt_pk_bf16_f32 v36, v154, v155
    v_fmac_f32 v146, v171, v171
    v_mfma_f32_16x16x32_bf16 v[158:161], a[224:227], v[138:141], v[158:161]
    s_waitcnt lgkmcnt(1)
    v_exp_f32 v157, v157
    v_mfma_f32_16x16x32_f16 v[218:221], v[246:249], v[150:153], v[62:65]
    s_waitcnt lgkmcnt(0)
    v_cvt_pk_bf16_f32 v37, v156, v157
    v_fmac_f32 v146, v172, v172
    v_mfma_f32_16x16x32_f16 v[154:157], v[118:121], v[150:153], v[66:69]
    v_exp_f32 v212, v212
    v_mfma_f32_16x16x32_bf16 v[150:153], v[28:31], v[36:39], 0
    v_fmac_f32 v146, v173, v173
    v_fmac_f32 v146, v142, v142
    v_mfma_f32_16x16x32_bf16 v[150:153], v[28:31], v[130:133], v[150:153]
    v_fmac_f32 v146, v143, v143
    v_fmac_f32 v146, v144, v144
    v_fmac_f32 v146, v145, v145
    v_mfma_f32_16x16x16_f16 v[218:221], v[164:165], v[162:163], v[218:221]
    v_exp_f32 v242, v242
    v_cmp_ne_u32 vcc, 0, v209
    v_mul_i32_i24 v214, 2688, v214
    v_mfma_f32_16x16x32_bf16 v[250:253], v[230:233], v[36:39], 0
    v_rcp_f32 v150, v150
    v_mfma_f32_16x16x32_bf16 v[250:253], v[238:241], v[130:133], v[250:253]
    v_exp_f32 v243, v243
    v_add3_u32 v200, v200, v214, s7
    v_mfma_f32_16x16x16_f16 v[154:157], v[176:177], v[162:163], v[154:157]
    v_cvt_pk_bf16_f32 v242, v242, v243
    v_exp_f32 v244, v244
    v_cndmask_b32 v200, v198, v200, vcc
    v_mfma_f32_16x16x32_bf16 v[226:229], v[122:125], v[36:39], 0
    v_exp_f32 v245, v245
    v_mfma_f32_16x16x32_bf16 v[226:229], v[190:193], v[130:133], v[226:229]
    v_mul_f32 v250, v150, v250
    v_mul_f32 v251, v150, v251
    v_mfma_f32_16x16x32_bf16 v[158:161], a[228:231], v[234:237], v[158:161]
    v_cvt_pk_bf16_f32 v250, v250, v251
    v_mul_f32 v252, v150, v252
    v_mfma_f32_16x16x32_bf16 v[158:161], a[232:235], v[202:205], v[158:161]
    v_mul_f32 v253, v150, v253
    v_cvt_pk_bf16_f32 v251, v252, v253
    v_mfma_f32_16x16x32_bf16 v[158:161], a[236:239], v[182:185], v[158:161]
    v_mul_f32 v226, v150, v226
    v_mul_f32 v227, v150, v227
    v_cvt_pk_bf16_f32 v252, v226, v227
    v_mfma_f32_16x16x32_bf16 v[208:211], v[114:117], v[36:39], 0
    v_mul_f32 v228, v150, v228
    v_mul_f32 v229, v150, v229
    v_mfma_f32_16x16x32_bf16 v[208:211], v[126:129], v[130:133], v[208:211]
    v_cvt_pk_bf16_f32 v253, v228, v229
    v_fma_f32 v198, v158, v158, s33
    v_mfma_f32_16x16x32_bf16 v[130:133], a[240:243], v[186:189], 0
    ds_write_b128 v3, v[250:253] offset:0
    v_mfma_f32_16x16x32_bf16 v[130:133], a[244:247], v[222:225], v[130:133]
    v_fmac_f32 v198, v159, v159
    v_fmac_f32 v198, v160, v160
    v_mfma_f32_16x16x32_bf16 v[130:133], a[248:251], v[138:141], v[130:133]
    v_fmac_f32 v198, v161, v161
    v_mul_f32 v208, v150, v208
    v_mfma_f32_16x16x32_bf16 v[130:133], a[252:255], v[234:237], v[130:133]
    v_mul_f32 v209, v150, v209
    v_cvt_pk_bf16_f32 v162, v208, v209
    v_mfma_f32_16x16x32_bf16 v[130:133], v[82:85], v[202:205], v[130:133]
    v_mul_f32 v210, v150, v210
    v_mul_f32 v211, v150, v211
    v_mfma_f32_16x16x32_bf16 v[130:133], v[86:89], v[182:185], v[130:133]
    v_cvt_pk_bf16_f32 v163, v210, v211
    v_cvt_pk_bf16_f32 v243, v244, v245
    v_mfma_f32_16x16x32_bf16 v[150:153], v[90:93], v[186:189], 0
    ds_write_b64 v4, v[162:163] offset:4096
    v_mfma_f32_16x16x32_bf16 v[150:153], v[94:97], v[222:225], v[150:153]
    v_exp_f32 v218, v218
    v_mfma_f32_16x16x32_f16 v[186:189], v[194:197], v[134:137], v[70:73]
    v_exp_f32 v219, v219
    v_mfma_f32_16x16x32_bf16 v[150:153], v[98:101], v[138:141], v[150:153]
    v_fmac_f32 v198, v130, v130
    v_fmac_f32 v198, v131, v131
    v_mfma_f32_16x16x32_bf16 v[150:153], v[102:105], v[234:237], v[150:153]
    v_fmac_f32 v198, v132, v132
    v_fmac_f32 v198, v133, v133
    v_cvt_pk_bf16_f32 v244, v218, v219
    v_mfma_f32_16x16x16_f16 v[186:189], v[148:149], v[174:175], v[186:189]
    v_exp_f32 v220, v220
    v_exp_f32 v221, v221
    v_mfma_f32_16x16x32_bf16 v[150:153], v[106:109], v[202:205], v[150:153]
    v_cvt_pk_bf16_f32 v245, v220, v221
    v_cvt_pk_bf16_f32 v39, v216, 0
    v_mfma_f32_16x16x32_bf16 v[150:153], v[110:113], v[182:185], v[150:153]
    v_exp_f32 v154, v154
    v_mfma_f32_16x16x32_f16 v[182:185], v[246:249], v[134:137], v[74:77]
    v_exp_f32 v186, v186
    v_exp_f32 v187, v187
    v_exp_f32 v188, v188
    v_cvt_pk_bf16_f32 v138, v186, v187
    v_exp_f32 v189, v189
    v_exp_f32 v155, v155
    v_mfma_f32_16x16x16_f16 v[182:185], v[164:165], v[174:175], v[182:185]
    v_fmac_f32 v198, v150, v150
    v_fmac_f32 v198, v151, v151
    v_fmac_f32 v198, v152, v152
    v_fmac_f32 v198, v153, v153
    v_cvt_pk_bf16_f32 v186, v146, v198
    v_cvt_pk_bf16_f32 v187, v198, v198
    ds_write_b64 v169, v[186:187] offset:2048
    v_cvt_pk_bf16_f32 v139, v188, v189
    v_exp_f32 v182, v182
    v_exp_f32 v183, v183
    v_exp_f32 v184, v184
    v_cvt_pk_bf16_f32 v140, v182, v183
    v_exp_f32 v185, v185
    v_cvt_pk_bf16_f32 v36, v154, v155
    v_cvt_pk_bf16_f32 v141, v184, v185
    v_exp_f32 v156, v156
    v_exp_f32 v157, v157
    v_mfma_f32_16x16x32_f16 v[146:149], v[118:121], v[134:137], v[78:81]
    v_cvt_pk_bf16_f32 v37, v156, v157
    v_lshl_add_u32 v198, v255, 4, v200
    v_add_u32 v198, s3, v198
    v_mfma_f32_16x16x32_bf16 v[118:121], v[28:31], v[36:39], 0
    s_waitcnt lgkmcnt(0)
    v_lshl_add_u32 v200, v255, 3, v200
    v_add_u32 v200, s4, v200
    v_mfma_f32_16x16x32_bf16 v[118:121], v[28:31], v[242:245], v[118:121]
    s_barrier
    ds_read_b128 v[162:165], v168 offset:2048
    ds_read_b128 v[194:197], v168 offset:3072
    v_mfma_f32_16x16x32_bf16 v[218:221], v[230:233], v[36:39], 0
    s_barrier
    v_xor_b32 v207, 65536, v2
    v_lshl_add_u32 v208, s16, 2, v207
    v_mfma_f32_16x16x32_bf16 v[218:221], v[238:241], v[242:245], v[218:221]
    ds_read_b128 v[226:229], v207 offset:0
    ds_read_b128 v[134:137], v207 offset:1024
    v_mfma_f32_16x16x32_bf16 v[182:185], v[122:125], v[36:39], 0
    ds_read_b128 v[222:225], v207 offset:2048
    ds_read_b128 v[186:189], v207 offset:3072
    v_mfma_f32_16x16x32_bf16 v[182:185], v[190:193], v[242:245], v[182:185]
    v_rcp_f32 v118, v118
    v_mfma_f32_16x16x32_bf16 v[202:205], v[114:117], v[36:39], 0
    ds_read_b128 v[214:217], v207 offset:4096
    ds_read_b128 v[154:157], v207 offset:5120
    v_mfma_f32_16x16x32_bf16 v[202:205], v[126:129], v[242:245], v[202:205]
    v_cvt_pk_bf16_f32 v39, v212, 0
    v_mul_f32 v218, v118, v218
    v_mul_f32 v219, v118, v219
    v_mfma_f32_16x16x16_f16 v[146:149], v[176:177], v[174:175], v[146:149]
    s_waitcnt lgkmcnt(6)
    ds_write_b32 v208, v254 offset:18432
    v_cvt_pk_bf16_f32 v210, v218, v219
    v_mfma_f32_16x16x32_bf16 v[174:177], v[32:35], v[162:165], 0
    s_waitcnt lgkmcnt(6)
    v_mul_f32 v220, v118, v220
    v_mul_f32 v221, v118, v221
    v_mfma_f32_16x16x32_bf16 v[174:177], v[32:35], v[194:197], v[174:177]
    s_waitcnt lgkmcnt(4)
    v_exp_f32 v146, v146
    v_mfma_f32_16x16x32_bf16 v[162:165], a[216:219], v[226:229], 0
    s_waitcnt lgkmcnt(3)
    v_exp_f32 v147, v147
    v_mfma_f32_16x16x32_bf16 v[162:165], a[220:223], v[134:137], v[162:165]
    s_waitcnt lgkmcnt(2)
    v_cvt_pk_bf16_f32 v36, v146, v147
    v_mul_f32 v254, 0x3baaaaab, v175
    v_mfma_f32_16x16x32_bf16 v[162:165], a[224:227], v[222:225], v[162:165]
    s_waitcnt lgkmcnt(1)
    v_rsq_f32 v254, v254
    v_mfma_f32_16x16x32_bf16 v[162:165], a[228:231], v[186:189], v[162:165]
    v_mul_f32 v158, v254, v158
    v_mul_f32 v159, v254, v159
    v_mfma_f32_16x16x32_bf16 v[162:165], a[232:235], v[214:217], v[162:165]
    v_cvt_pk_bf16_f32 v158, v158, v159
    v_mul_f32 v160, v254, v160
    v_mfma_f32_16x16x32_bf16 v[162:165], a[236:239], v[154:157], v[162:165]
    v_mul_f32 v161, v254, v161
    v_cvt_pk_bf16_f32 v159, v160, v161
    v_mfma_f32_16x16x32_bf16 v[194:197], a[240:243], v[226:229], 0
    v_mul_f32 v130, v254, v130
    v_mul_f32 v131, v254, v131
    v_mfma_f32_16x16x32_bf16 v[194:197], a[244:247], v[134:137], v[194:197]
    v_cvt_pk_bf16_f32 v160, v130, v131
    v_mul_f32 v132, v254, v132
    v_mfma_f32_16x16x32_bf16 v[194:197], a[248:251], v[222:225], v[194:197]
    v_mul_f32 v133, v254, v133
    v_cvt_pk_bf16_f32 v161, v132, v133
    v_mfma_f32_16x16x32_bf16 v[194:197], a[252:255], v[186:189], v[194:197]
    buffer_store_dwordx4 v[158:161], v167, s[12:15], 0 offen nt
    v_mul_f32 v150, v254, v150
    v_mul_f32 v151, v254, v151
    v_cvt_pk_bf16_f32 v208, v150, v151
    v_mul_f32 v152, v254, v152
    v_mfma_f32_16x16x32_bf16 v[194:197], v[82:85], v[214:217], v[194:197]
    v_mul_f32 v153, v254, v153
    v_cvt_pk_bf16_f32 v209, v152, v153
    v_mfma_f32_16x16x32_bf16 v[194:197], v[86:89], v[154:157], v[194:197]
    v_exp_f32 v148, v148
    v_mfma_f32_16x16x32_bf16 v[130:133], v[90:93], v[226:229], 0
    ds_read_b128 v[150:153], v9
    ds_read_b128 v[158:161], v9 offset:64
    v_mfma_f32_16x16x32_bf16 v[130:133], v[94:97], v[134:137], v[130:133]
    v_exp_f32 v149, v149
    v_mfma_f32_16x16x32_bf16 v[130:133], v[98:101], v[222:225], v[130:133]
    v_cvt_pk_bf16_f32 v37, v148, v149
    v_fma_f32 v167, v162, v162, s33
    v_mfma_f32_16x16x32_bf16 v[130:133], v[102:105], v[186:189], v[130:133]
    v_fmac_f32 v167, v163, v163
    v_fmac_f32 v167, v164, v164
    v_mfma_f32_16x16x32_bf16 v[130:133], v[106:109], v[214:217], v[130:133]
    v_fmac_f32 v167, v165, v165
    v_fmac_f32 v167, v194, v194
    v_mfma_f32_16x16x32_bf16 v[130:133], v[110:113], v[154:157], v[130:133]
    v_fmac_f32 v167, v195, v195
    v_fmac_f32 v167, v196, v196
    v_mfma_f32_16x16x32_bf16 v[134:137], v[28:31], v[36:39], 0
    v_fmac_f32 v167, v197, v197
    v_cvt_pk_bf16_f32 v211, v220, v221
    v_mfma_f32_16x16x32_bf16 v[134:137], v[28:31], v[138:141], v[134:137]
    s_waitcnt lgkmcnt(0)
    v_mul_f32 v182, v118, v182
    v_fmac_f32 v167, v130, v130
    v_mfma_f32_16x16x32_bf16 v[154:157], v[230:233], v[36:39], 0
    v_fmac_f32 v167, v131, v131
    v_fmac_f32 v167, v132, v132
    v_mfma_f32_16x16x32_bf16 v[154:157], v[238:241], v[138:141], v[154:157]
    v_fmac_f32 v167, v133, v133
    v_cvt_pk_bf16_f32 v212, v167, v167
    v_mfma_f32_16x16x32_bf16 v[146:149], v[122:125], v[36:39], 0
    v_cvt_pk_bf16_f32 v213, v167, v167
    v_mul_f32 v183, v118, v183
    v_mfma_f32_16x16x32_bf16 v[146:149], v[190:193], v[138:141], v[146:149]
    ds_write_b64 v169, v[212:213] offset:7616
    v_mfma_f32_16x16x32_bf16 v[186:189], v[114:117], v[36:39], 0
    buffer_store_dwordx2 v[208:209], v166, s[12:15], 0 offen nt
    v_cvt_pk_bf16_f32 v212, v182, v183
    v_mul_f32 v184, v118, v184
    v_mfma_f32_16x16x32_bf16 v[186:189], v[126:129], v[138:141], v[186:189]
    v_mul_f32 v185, v118, v185
    v_cvt_pk_bf16_f32 v213, v184, v185
    v_mfma_f32_16x16x32_bf16 v[182:185], v[150:153], v[28:31], 0
    ds_write_b128 v3, v[210:213] offset:6144
    v_mfma_f32_16x16x32_bf16 v[182:185], v[158:161], v[28:31], v[182:185]
    v_mul_f32 v202, v118, v202
    v_mul_f32 v203, v118, v203
    v_mfma_f32_16x16x32_bf16 v[138:141], v[150:153], v[238:241], 0
    v_cvt_pk_bf16_f32 v166, v202, v203
    v_mul_f32 v204, v118, v204
    v_mfma_f32_16x16x32_bf16 v[138:141], v[158:161], v[230:233], v[138:141]
    v_mul_f32 v205, v118, v205
    v_cvt_pk_bf16_f32 v167, v204, v205
    v_mfma_f32_16x16x32_bf16 v[202:205], v[150:153], v[190:193], 0
    ds_write_b64 v4, v[166:167] offset:10240
    v_mfma_f32_16x16x32_bf16 v[202:205], v[158:161], v[122:125], v[202:205]
    v_rcp_f32 v182, v182
    v_mfma_f32_16x16x32_bf16 v[118:121], v[150:153], v[126:129], 0
    v_mul_f32 v254, 0x3baaaaab, v174
    v_mul_f32 v138, v138, v182
    v_mfma_f32_16x16x32_bf16 v[118:121], v[158:161], v[114:117], v[118:121]
    v_rsq_f32 v254, v254
    v_rcp_f32 v134, v134
    v_mul_f32 v178, v254, v178
    v_mul_f32_dpp v138, v202, v182 quad_perm:[0,1,2,3] row_mask:0x2 bank_mask:0xf
    v_mul_f32 v179, v254, v179
    v_cvt_pk_bf16_f32 v114, v178, v179
    v_mul_f32 v180, v254, v180
    v_mul_f32 v181, v254, v181
    v_mul_f32_dpp v138, v118, v182 quad_perm:[0,1,2,3] row_mask:0x4 bank_mask:0xf
    v_cvt_pk_bf16_f32 v138, v138, v138
    ds_write_b16 v7, v138
    v_cvt_pk_bf16_f32 v115, v180, v181
    v_mul_f32 v170, v254, v170
    v_mul_f32 v171, v254, v171
    v_cvt_pk_bf16_f32 v116, v170, v171
    v_mul_f32 v172, v254, v172
    v_mul_f32 v173, v254, v173
    v_cvt_pk_bf16_f32 v117, v172, v173
    buffer_store_dwordx4 v[114:117], v17, s[52:55], 0 offen nt
    v_mul_f32 v142, v254, v142
    v_mul_f32 v143, v254, v143
    v_cvt_pk_bf16_f32 v166, v142, v143
    v_mul_f32 v144, v254, v144
    v_mul_f32 v145, v254, v145
    v_cvt_pk_bf16_f32 v167, v144, v145
    v_mul_f32 v154, v134, v154
    v_mul_f32 v155, v134, v155
    v_cvt_pk_bf16_f32 v114, v154, v155
    v_mul_f32 v156, v134, v156
    v_mul_f32 v157, v134, v157
    v_cvt_pk_bf16_f32 v115, v156, v157
    v_mul_f32 v146, v134, v146
    s_waitcnt lgkmcnt(0)
    s_barrier
    ds_read_b128 v[118:121], v168 offset:7616
    ds_read_b128 v[138:141], v168 offset:8640
    ds_read_b128 v[154:157], v207 offset:6144
    ds_read_b128 v[122:125], v207 offset:7168
    ds_read_b128 v[142:145], v207 offset:8192
    ds_read_b128 v[170:173], v207 offset:9216
    ds_read_b128 v[158:161], v207 offset:10240
    ds_read_b128 v[126:129], v207 offset:11264
    v_mul_f32 v147, v134, v147
    v_cvt_pk_bf16_f32 v116, v146, v147
    v_mul_f32 v148, v134, v148
    s_waitcnt lgkmcnt(7)
    v_mfma_f32_16x16x32_bf16 v[150:153], v[32:35], v[118:121], 0
    s_waitcnt lgkmcnt(5)
    v_mul_f32 v149, v134, v149
    v_cvt_pk_bf16_f32 v117, v148, v149
    v_mfma_f32_16x16x32_bf16 v[150:153], v[32:35], v[138:141], v[150:153]
    s_waitcnt lgkmcnt(4)
    ds_write_b128 v3, v[114:117] offset:12288
    v_mfma_f32_16x16x32_bf16 v[114:117], a[216:219], v[154:157], 0
    s_waitcnt lgkmcnt(3)
    v_mul_f32 v186, v134, v186
    v_mul_f32 v187, v134, v187
    v_mfma_f32_16x16x32_bf16 v[114:117], a[220:223], v[122:125], v[114:117]
    s_waitcnt lgkmcnt(2)
    v_cvt_pk_bf16_f32 v208, v186, v187
    v_mul_f32 v188, v134, v188
    v_mfma_f32_16x16x32_bf16 v[114:117], a[224:227], v[142:145], v[114:117]
    s_waitcnt lgkmcnt(1)
    v_mul_f32 v189, v134, v189
    v_cvt_pk_bf16_f32 v209, v188, v189
    v_mfma_f32_16x16x32_bf16 v[114:117], a[228:231], v[170:173], v[114:117]
    ds_write_b64 v4, v[208:209] offset:16384
    v_mfma_f32_16x16x32_bf16 v[114:117], a[232:235], v[158:161], v[114:117]
    buffer_store_dwordx2 v[166:167], v20, s[52:55], 0 offen nt
    v_mul_f32 v208, 0x3baaaaab, v150
    v_bfe_u32 v254, v199, 1, 2
    v_mfma_f32_16x16x32_bf16 v[114:117], a[236:239], v[126:129], v[114:117]
    v_rsq_f32 v208, v208
    v_mfma_f32_16x16x32_bf16 v[118:121], a[240:243], v[154:157], 0
    v_mul_f32 v162, v208, v162
    v_mul_f32 v163, v208, v163
    v_mfma_f32_16x16x32_bf16 v[118:121], a[244:247], v[122:125], v[118:121]
    v_cvt_pk_bf16_f32 v134, v162, v163
    v_mul_f32 v164, v208, v164
    v_mfma_f32_16x16x32_bf16 v[118:121], a[248:251], v[142:145], v[118:121]
    v_fma_f32 v209, v114, v114, s33
    v_fmac_f32 v209, v115, v115
    v_mfma_f32_16x16x32_bf16 v[118:121], a[252:255], v[170:173], v[118:121]
    v_fmac_f32 v209, v116, v116
    v_fmac_f32 v209, v117, v117
    v_mfma_f32_16x16x32_bf16 v[118:121], v[82:85], v[158:161], v[118:121]
    v_mul_f32 v165, v208, v165
    v_cvt_pk_bf16_f32 v135, v164, v165
    v_mfma_f32_16x16x32_bf16 v[118:121], v[86:89], v[126:129], v[118:121]
    v_mul_f32 v194, v208, v194
    v_mul_f32 v195, v208, v195
    v_mfma_f32_16x16x32_bf16 v[146:149], v[90:93], v[154:157], 0
    ds_read_b128 v[150:153], v206 offset:256
    v_cvt_pk_bf16_f32 v136, v194, v195
    v_mfma_f32_16x16x32_bf16 v[146:149], v[94:97], v[122:125], v[146:149]
    ds_read_b128 v[122:125], v206 offset:2304
    v_mul_f32 v196, v208, v196
    v_mfma_f32_16x16x32_bf16 v[146:149], v[98:101], v[142:145], v[146:149]
    ds_read_b128 v[138:141], v206 offset:4352
    v_fmac_f32 v209, v118, v118
    v_mfma_f32_16x16x32_bf16 v[146:149], v[102:105], v[170:173], v[146:149]
    ds_read_b128 v[142:145], v206 offset:6400
    v_fmac_f32 v209, v119, v119
    v_mfma_f32_16x16x32_bf16 v[146:149], v[106:109], v[158:161], v[146:149]
    ds_read_b128 v[158:161], v206 offset:8448
    v_fmac_f32 v209, v120, v120
    v_mfma_f32_16x16x32_bf16 v[146:149], v[110:113], v[126:129], v[146:149]
    ds_read_b128 v[126:129], v206 offset:10496
    v_fmac_f32 v209, v121, v121
    v_mul_f32 v197, v208, v197
    v_cvt_pk_bf16_f32 v137, v196, v197
    v_mul_f32 v130, v208, v130
    s_waitcnt lgkmcnt(5)
    v_mfma_f32_16x16x32_bf16 v[162:165], a[216:219], v[150:153], 0
    v_mul_f32 v131, v208, v131
    v_fmac_f32 v209, v146, v146
    v_mfma_f32_16x16x32_bf16 v[154:157], a[240:243], v[150:153], 0
    s_waitcnt lgkmcnt(4)
    buffer_store_dwordx4 v[134:137], v15, s[56:59], 0 offen nt
    v_fmac_f32 v209, v147, v147
    v_fmac_f32 v209, v148, v148
    v_fmac_f32 v209, v149, v149
    v_cvt_pk_bf16_f32 v166, v209, v209
    v_mfma_f32_16x16x32_bf16 v[162:165], a[220:223], v[122:125], v[162:165]
    s_waitcnt lgkmcnt(2)
    v_cvt_pk_bf16_f32 v167, v209, v209
    v_cvt_pk_bf16_f32 v130, v130, v131
    v_mfma_f32_16x16x32_bf16 v[162:165], a[224:227], v[138:141], v[162:165]
    s_waitcnt lgkmcnt(1)
    ds_write_b64 v169, v[166:167] offset:9664
    v_mfma_f32_16x16x32_bf16 v[162:165], a[228:231], v[142:145], v[162:165]
    s_waitcnt lgkmcnt(1)
    v_mul_f32 v132, v208, v132
    v_mul_f32 v133, v208, v133
    v_mfma_f32_16x16x32_bf16 v[162:165], a[232:235], v[158:161], v[162:165]
    v_cvt_pk_bf16_f32 v131, v132, v133
    v_xor_b32 v254, v254, v255
    v_mfma_f32_16x16x32_bf16 v[162:165], a[236:239], v[126:129], v[162:165]
    v_lshl_add_u32 v254, v199, 2, v254
    v_lshl_add_u32 v166, v254, 4, s5
    v_mfma_f32_16x16x32_bf16 v[154:157], a[244:247], v[122:125], v[154:157]
    v_lshl_add_u32 v167, v254, 3, s5
    v_lshl_add_u32 v255, v201, 4, s5
    v_mfma_f32_16x16x32_bf16 v[154:157], a[248:251], v[138:141], v[154:157]
    v_lshl_add_u32 v201, v201, 3, s5
    v_lshlrev_b32 v254, 2, v254
    v_mfma_f32_16x16x32_bf16 v[154:157], a[252:255], v[142:145], v[154:157]
    ds_permute_b32 v208, v254, v16
    ds_permute_b32 v199, v254, v19
    v_mfma_f32_16x16x32_bf16 v[154:157], v[82:85], v[158:161], v[154:157]
    s_waitcnt lgkmcnt(2)
    ds_permute_b32 v206, v254, v17
    ds_permute_b32 v209, v254, v20
    v_mfma_f32_16x16x32_bf16 v[154:157], v[86:89], v[126:129], v[154:157]
    s_barrier
    ds_read_b128 v[170:173], v168 offset:9664
    ds_read_b128 v[174:177], v168 offset:10688
    v_mfma_f32_16x16x32_bf16 v[178:181], v[90:93], v[150:153], 0
    ds_read_b128 v[134:137], v207 offset:12288
    v_fma_f32 v254, v162, v162, s33
    v_mfma_f32_16x16x32_bf16 v[178:181], v[94:97], v[122:125], v[178:181]
    ds_read_b128 v[122:125], v207 offset:13312
    v_fmac_f32 v254, v163, v163
    v_mfma_f32_16x16x32_bf16 v[178:181], v[98:101], v[138:141], v[178:181]
    ds_read_b128 v[138:141], v207 offset:14336
    v_fmac_f32 v254, v164, v164
    v_mfma_f32_16x16x32_bf16 v[178:181], v[102:105], v[142:145], v[178:181]
    ds_read_b128 v[150:153], v207 offset:15360
    v_fmac_f32 v254, v165, v165
    v_mfma_f32_16x16x32_bf16 v[178:181], v[106:109], v[158:161], v[178:181]
    s_waitcnt lgkmcnt(8)
    ds_read_b128 v[142:145], v207 offset:16384
    buffer_store_dwordx2 v[130:131], v18, s[56:59], 0 offen nt
    v_fmac_f32 v254, v154, v154
    v_fmac_f32 v254, v155, v155
    v_mfma_f32_16x16x32_bf16 v[178:181], v[110:113], v[126:129], v[178:181]
    s_waitcnt lgkmcnt(6)
    ds_read_b128 v[126:129], v207 offset:17408
    v_fmac_f32 v254, v156, v156
    v_mfma_f32_16x16x32_bf16 v[130:133], v[32:35], v[170:173], 0
    s_waitcnt lgkmcnt(5)
    v_fmac_f32 v254, v157, v157
    v_mfma_f32_16x16x32_bf16 v[130:133], v[32:35], v[174:177], v[130:133]
    s_waitcnt lgkmcnt(4)
    v_fmac_f32 v254, v178, v178
    v_fmac_f32 v254, v179, v179
    v_mfma_f32_16x16x32_bf16 v[158:161], a[216:219], v[134:137], 0
    s_waitcnt lgkmcnt(3)
    v_fmac_f32 v254, v180, v180
    v_fmac_f32 v254, v181, v181
    v_mfma_f32_16x16x32_bf16 v[158:161], a[220:223], v[122:125], v[158:161]
    s_waitcnt lgkmcnt(2)
    v_mul_f32 v130, 0x3baaaaab, v130
    v_cvt_pk_bf16_f32 v132, v254, v254
    v_mfma_f32_16x16x32_bf16 v[158:161], a[224:227], v[138:141], v[158:161]
    s_waitcnt lgkmcnt(1)
    v_rsq_f32 v130, v130
    v_mfma_f32_16x16x32_bf16 v[158:161], a[228:231], v[150:153], v[158:161]
    v_mul_f32 v114, v130, v114
    v_mul_f32 v115, v130, v115
    v_mfma_f32_16x16x32_bf16 v[158:161], a[232:235], v[142:145], v[158:161]
    s_waitcnt lgkmcnt(0)
    v_cvt_pk_bf16_f32 v114, v114, v115
    v_mul_f32 v116, v130, v116
    v_mfma_f32_16x16x32_bf16 v[158:161], a[236:239], v[126:129], v[158:161]
    v_mul_f32 v117, v130, v117
    v_cvt_pk_bf16_f32 v115, v116, v117
    v_mfma_f32_16x16x32_bf16 v[170:173], a[240:243], v[134:137], 0
    v_mul_f32 v118, v130, v118
    v_mul_f32 v119, v130, v119
    v_mfma_f32_16x16x32_bf16 v[170:173], a[244:247], v[122:125], v[170:173]
    v_cvt_pk_bf16_f32 v116, v118, v119
    v_mul_f32 v120, v130, v120
    v_mfma_f32_16x16x32_bf16 v[170:173], a[248:251], v[138:141], v[170:173]
    v_mul_f32 v121, v130, v121
    v_cvt_pk_bf16_f32 v117, v120, v121
    v_mfma_f32_16x16x32_bf16 v[170:173], a[252:255], v[150:153], v[170:173]
    ds_write_b128 v166, v[114:117] offset:1536
    v_mfma_f32_16x16x32_bf16 v[170:173], v[82:85], v[142:145], v[170:173]
    v_mul_f32 v146, v130, v146
    v_mul_f32 v147, v130, v147
    v_mfma_f32_16x16x32_bf16 v[170:173], v[86:89], v[126:129], v[170:173]
    v_cvt_pk_bf16_f32 v146, v146, v147
    v_mul_f32 v148, v130, v148
    v_mfma_f32_16x16x32_bf16 v[114:117], v[90:93], v[134:137], 0
    ds_read_b128 v[134:137], v255 offset:1536
    v_mul_f32 v149, v130, v149
    v_mfma_f32_16x16x32_bf16 v[114:117], v[94:97], v[122:125], v[114:117]
    v_cvt_pk_bf16_f32 v147, v148, v149
    v_cvt_pk_bf16_f32 v133, v254, v254
    v_mfma_f32_16x16x32_bf16 v[114:117], v[98:101], v[138:141], v[114:117]
    ds_write_b64 v169, v[132:133] offset:17280
    v_mfma_f32_16x16x32_bf16 v[114:117], v[102:105], v[150:153], v[114:117]
    v_fma_f32 v254, v158, v158, s33
    v_fmac_f32 v254, v159, v159
    v_mfma_f32_16x16x32_bf16 v[114:117], v[106:109], v[142:145], v[114:117]
    ds_write_b64 v167, v[146:147] offset:2560
    v_mfma_f32_16x16x32_bf16 v[114:117], v[110:113], v[126:129], v[114:117]
    v_fmac_f32 v254, v160, v160
    ds_read_b64 v[118:119], v201 offset:2560
    s_waitcnt lgkmcnt(3)
    buffer_store_dwordx4 v[134:137], v208, s[56:59], 0 offen nt
    v_fmac_f32 v254, v161, v161
    v_fmac_f32 v254, v170, v170
    v_fmac_f32 v254, v171, v171
    v_fmac_f32 v254, v172, v172
    v_fmac_f32 v254, v173, v173
    v_fmac_f32 v254, v114, v114
    v_fmac_f32 v254, v115, v115
    v_fmac_f32 v254, v116, v116
    v_fmac_f32 v254, v117, v117
    v_cvt_pk_bf16_f32 v120, v254, v254
    v_cvt_pk_bf16_f32 v121, v254, v254
    ds_write_b64 v169, v[120:121] offset:15232
    s_waitcnt lgkmcnt(1)
    buffer_store_dwordx2 v[118:119], v199, s[56:59], 0 offen nt
    s_waitcnt lgkmcnt(0)
    s_barrier
    ds_read_b128 v[138:141], v168 offset:15232
    ds_read_b128 v[122:125], v168 offset:16256
    ds_read_b128 v[118:121], v168 offset:17280
    ds_read_b128 v[130:133], v168 offset:18304
    ds_read_b128 v[126:129], v207 offset:18432
    s_waitcnt lgkmcnt(4)
    v_mfma_f32_16x16x32_bf16 v[134:137], v[32:35], v[138:141], 0
    s_waitcnt lgkmcnt(3)
    v_mfma_f32_16x16x32_bf16 v[134:137], v[32:35], v[122:125], v[134:137]
    s_waitcnt lgkmcnt(1)
    v_mfma_f32_16x16x32_bf16 v[122:125], v[32:35], v[118:121], 0
    s_waitcnt lgkmcnt(0)
    v_or3_b32 v126, v126, v127, v128
    v_or_b32 v126, v126, v129
    v_mfma_f32_16x16x32_bf16 v[122:125], v[32:35], v[130:133], v[122:125]
    v_cmp_gt_i32 s[46:47], 0, v126
    s_nop 0
    v_mul_f32 v254, 0x3baaaaab, v134
    v_rsq_f32 v254, v254
    s_nop 0
    v_mul_f32 v158, v254, v158
    v_mul_f32 v159, v254, v159
    v_cvt_pk_bf16_f32 v118, v158, v159
    v_mul_f32 v199, 0x3baaaaab, v122
    v_rsq_f32 v199, v199
    v_mul_f32 v160, v254, v160
    v_mul_f32 v162, v199, v162
    v_mul_f32 v163, v199, v163
    v_cvt_pk_bf16_f32 v122, v162, v163
    v_mul_f32 v164, v199, v164
    v_mul_f32 v165, v199, v165
    v_cvt_pk_bf16_f32 v123, v164, v165
    v_mul_f32 v154, v199, v154
    v_mul_f32 v155, v199, v155
    v_cvt_pk_bf16_f32 v124, v154, v155
    v_mul_f32 v156, v199, v156
    v_mul_f32 v157, v199, v157
    v_cvt_pk_bf16_f32 v125, v156, v157
    buffer_store_dwordx4 v[122:125], v198, s[12:15], 0 offen nt
    v_mul_f32 v178, v199, v178
    v_mul_f32 v179, v199, v179
    v_cvt_pk_bf16_f32 v198, v178, v179
    v_mul_f32 v180, v199, v180
    v_mul_f32 v181, v199, v181
    v_cvt_pk_bf16_f32 v199, v180, v181
    v_mul_f32 v161, v254, v161
    v_cvt_pk_bf16_f32 v119, v160, v161
    v_mul_f32 v170, v254, v170
    v_mul_f32 v171, v254, v171
    v_cvt_pk_bf16_f32 v120, v170, v171
    v_mul_f32 v172, v254, v172
    v_mul_f32 v173, v254, v173
    v_cvt_pk_bf16_f32 v121, v172, v173
    ds_write_b128 v166, v[118:121] offset:3072
    v_mul_f32 v114, v254, v114
    v_mul_f32 v115, v254, v115
    v_cvt_pk_bf16_f32 v168, v114, v115
    v_mul_f32 v116, v254, v116
    v_mul_f32 v117, v254, v117
    v_cvt_pk_bf16_f32 v169, v116, v117
    buffer_store_dwordx2 v[198:199], v200, s[12:15], 0 offen nt
    ds_read_b128 v[114:117], v255 offset:3072
    ds_write_b64 v167, v[168:169] offset:4096
    ds_read_b64 v[254:255], v201 offset:4096
    s_waitcnt lgkmcnt(2)
    buffer_store_dwordx4 v[114:117], v206, s[56:59], 0 offen nt
    s_waitcnt lgkmcnt(0)
    buffer_store_dwordx2 v[254:255], v209, s[56:59], 0 offen nt
L_end:
    s_nop 1
    s_cmp_lg_u64 s[46:47], 0
    s_cbranch_scc1 L_rerun
L_done:
    s_endpgm
L_slow:
    s_mov_b32 s44, 0xff
    s_branch L_redo
L_rerun:
    s_mov_b32 s44, 0x7f000000
    s_lshr_b32 s100, s63, 20
L_redo:
    s_waitcnt vmcnt(0) lgkmcnt(0)
    s_barrier
    v_mbcnt_lo_u32_b32 v0, -1, 0
    v_mbcnt_hi_u32_b32 v0, -1, v0
    v_lshl_add_u32 v0, s16, 6, v0
    s_nop 7
    s_branch L_again
L_edge:
    v_mov_b32 v254, v0
    v_mov_b32 v255, 0x40000000
    s_lshl_b32 s3, s16, 4
    s_load_dwordx4 s[92:95], s[0:1], s3
    v_and_b32 v114, 63, v0
    s_bfe_u32 s3, s2, 0x50003
    s_lshl_b32 s4, s16, 3
    s_lshr_b32 s98, 0x06143a01, s4
    s_and_b32 s98, s98, 0xff
    s_mul_i32 s3, s3, s98
    s_sub_u32 s98, s98, 1
    s_lshr_b32 s4, 0x0048d800, s4
    s_and_b32 s4, s4, 0xff
    s_lshl_b32 s4, s4, 3
    s_max_u32 s4, s4, 6
    s_sub_u32 s4, s4, s98
    s_sub_u32 s4, s4, 1
    s_min_u32 s3, s3, s4
    v_min_u32 v116, s98, v114
    v_add_lshl_u32 v116, v116, s3, 7
    v_mov_b32 v117, 0
    v_lshrrev_b32 v115, 4, v114
    v_and_b32 v122, 15, v114
    s_mov_b32 s10, 100270464
    s_mov_b32 s11, 0x00020000
    s_mov_b32 s50, 36096
    s_mov_b32 s51, 0x00020000
    s_mul_i32 s3, s16, 96
    v_lshl_add_u32 v123, v114, 4, s3
    v_mul_u32_u24 v124, 171, v114
    v_lshrrev_b32 v124, 10, v124
    v_lshrrev_b32 v125, 1, v124
    v_xor_b32 v125, v125, v124
    v_and_b32 v125, 4, v125
    v_mul_u32_u24 v125, 3, v125
    v_xor_b32 v125, v125, v124
    v_mul_u32_u24 v125, 1152, v125
    v_mul_u32_u24 v138, 96, v124
    v_sub_u32 v125, v125, v138
    v_add_u32 v138, v123, v125
    v_add_u32 v125, 64, v114
    v_mul_u32_u24 v125, 171, v125
    v_lshrrev_b32 v125, 10, v125
    v_lshrrev_b32 v139, 1, v125
    v_xor_b32 v139, v139, v125
    v_and_b32 v139, 4, v139
    v_mul_u32_u24 v139, 3, v139
    v_xor_b32 v139, v139, v125
    v_mul_u32_u24 v139, 1152, v139
    v_mul_u32_u24 v140, 96, v125
    v_sub_u32 v139, v139, v140
    v_add_u32 v140, v123, v139
    v_add_u32 v139, 128, v114
    v_mul_u32_u24 v139, 171, v139
    v_lshrrev_b32 v139, 10, v139
    v_lshrrev_b32 v141, 1, v139
    v_xor_b32 v141, v141, v139
    v_and_b32 v141, 4, v141
    v_mul_u32_u24 v141, 3, v141
    v_xor_b32 v141, v141, v139
    v_mul_u32_u24 v141, 1152, v141
    v_mul_u32_u24 v146, 96, v139
    v_sub_u32 v141, v141, v146
    v_add_u32 v146, v123, v141
    s_mul_i32 s68, s16, 6144
    s_add_u32 s69, s68, 65536
    s_cmp_eq_u32 s16, 3
    s_cselect_b32 s68, 149696, s68
    s_cselect_b32 s69, 155840, s69
    s_mov_b32 s70, 193536
    s_mov_b32 s36, 100270464
    s_mov_b32 s22, 1180032
    s_mul_i32 s3, s2, 911
    s_lshr_b32 s3, s3, 16
    s_mul_i32 s35, s3, 72
    s_sub_u32 s38, s2, s35
    s_mul_i32 s3, s3, 1373568
    s_mul_i32 s35, s38, 2688
    s_add_u32 s3, s3, s35
    s_add_u32 s25, s3, 589824
    s_add_u32 s7, s3, 1769472
    s_mov_b32 s20, 31
    s_mov_b32 s21, 4204032
    s_mov_b32 s17, 20
    s_cmp_lt_u32 s2, 240
    s_cselect_b32 s45, 28, 24
    s_mov_b32 s5, 0
    s_mov_b32 s6, 0
    s_cmp_lt_u32 s2, 247
    s_cbranch_scc1 L_inner
    s_mov_b32 s20, 0
    s_mov_b32 s38, 0
    s_sub_u32 s3, s2, 247
    s_and_b32 s3, s3, 3
    s_mul_i32 s3, s3, 7
    s_add_u32 s3, s3, 3
    s_mov_b32 s35, 196224
    s_cmp_lt_u32 s2, 251
    s_cselect_b32 s35, s35, 384
    s_cselect_b32 s6, 1, 0
    s_cselect_b32 s5, 0, 1
    s_mul_i32 s25, s3, s35
    s_mul_i32 s21, s35, 28
    s_cmp_lt_u32 s2, 255
    s_cselect_b32 s17, 18, 1
    s_cselect_b32 s45, 18, 1
    s_cselect_b32 s25, s25, 0
    s_cselect_b32 s6, s6, 1
    s_add_u32 s7, s25, 1179648
L_inner:
    s_mul_i32 s3, s5, 99485568
    s_mul_i32 s35, s5, -784896
    v_mov_b32 v123, s3
    v_mov_b32 v141, s35
    s_add_u32 s7, s7, s35
    s_mul_i32 s3, s6, 194688
    s_mul_i32 s35, s6, -1536
    v_mov_b32 v147, s3
    v_mov_b32 v148, s35
    s_add_u32 s7, s7, s35
    s_bfm_b32 s34, s45, 0
    s_and_b32 s4, s2, 7
    s_sub_u32 s4, 0, s4
    v_mul_u32_u24 v149, 2731, v254
    v_bfe_u32 v150, v149, 17, 3
    v_lshrrev_b32 v149, 16, v149
    v_xor_b32 v151, v150, v254
    v_mul_u32_u24 v150, 37, v149
    v_lshrrev_b32 v150, 8, v150
    v_lshlrev_b32 v151, 4, v151
    v_mad_u32_u24 v10, v150, s70, v151
    v_mul_u32_u24 v150, 37, v149
    v_lshrrev_b32 v150, 8, v150
    v_mul_u32_u24 v152, 7, v150
    v_sub_u32 v152, v149, v152
    v_cmp_gt_u32 vcc, 4, v150
    s_nop 1
    v_cndmask_b32 v150, v141, v123, vcc
    v_cmp_gt_u32 vcc, 4, v152
    s_nop 1
    v_cndmask_b32 v152, v148, v147, vcc
    v_add3_u32 v10, v10, v150, v152
    v_mul_u32_u24 v150, s20, v149
    v_add_u32 v150, s38, v150
    v_mul_u32_u24 v152, 911, v150
    v_lshrrev_b32 v152, 16, v152
    v_mul_u32_u24 v152, s22, v152
    v_mad_u32_u24 v152, v149, s21, v152
    v_bfe_u32 v150, s34, v149, 1
    v_cmp_ne_u32 vcc, 0, v150
    v_add_u32 v150, s7, v152
    s_nop 0
    v_cndmask_b32 v150, v255, v150, vcc
    v_mul_u32_u24 v149, 384, v149
    v_sub_u32 v149, v151, v149
    v_add_u32 v150, v150, v149
    v_add_u32 v149, 256, v254
    v_mul_u32_u24 v151, 2731, v149
    v_bfe_u32 v152, v151, 17, 3
    v_lshrrev_b32 v151, 16, v151
    v_xor_b32 v149, v152, v149
    v_mul_u32_u24 v152, 37, v151
    v_lshrrev_b32 v152, 8, v152
    v_lshlrev_b32 v149, 4, v149
    v_mad_u32_u24 v11, v152, s70, v149
    v_mul_u32_u24 v152, 37, v151
    v_lshrrev_b32 v152, 8, v152
    v_mul_u32_u24 v153, 7, v152
    v_sub_u32 v153, v151, v153
    v_cmp_gt_u32 vcc, 4, v152
    s_nop 1
    v_cndmask_b32 v152, v141, v123, vcc
    v_cmp_gt_u32 vcc, 4, v153
    s_nop 1
    v_cndmask_b32 v153, v148, v147, vcc
    v_add3_u32 v11, v11, v152, v153
    v_min_u32 v152, 20, v151
    v_add_u32 v153, 12, v151
    v_lshrrev_b32 v153, 5, v153
    v_sub_u32 v154, v151, v152
    v_mad_i32_i24 v154, v153, s4, v154
    v_mul_u32_u24 v155, s20, v152
    v_add3_u32 v155, v155, v154, s38
    v_mul_u32_u24 v153, 911, v155
    v_lshrrev_b32 v153, 16, v153
    v_mul_u32_u24 v153, s22, v153
    v_mad_u32_u24 v153, v152, s21, v153
    v_bfe_u32 v155, s34, v151, 1
    v_cmp_ne_u32 vcc, 0, v155
    v_mul_i32_i24 v154, 2688, v154
    v_add3_u32 v152, v153, v154, s7
    v_cndmask_b32 v152, v255, v152, vcc
    v_mul_u32_u24 v151, 384, v151
    v_sub_u32 v151, v149, v151
    v_add_u32 v152, v152, v151
    v_add_u32 v149, 512, v254
    v_mul_u32_u24 v151, 2731, v149
    v_bfe_u32 v153, v151, 17, 3
    v_lshrrev_b32 v151, 16, v151
    v_xor_b32 v149, v153, v149
    v_mul_u32_u24 v153, 37, v151
    v_lshrrev_b32 v153, 8, v153
    v_lshlrev_b32 v149, 4, v149
    v_mad_u32_u24 v12, v153, s70, v149
    v_mul_u32_u24 v153, 37, v151
    v_lshrrev_b32 v153, 8, v153
    v_mul_u32_u24 v154, 7, v153
    v_sub_u32 v154, v151, v154
    v_cmp_gt_u32 vcc, 4, v153
    s_nop 1
    v_cndmask_b32 v153, v141, v123, vcc
    v_cmp_gt_u32 vcc, 4, v154
    s_nop 1
    v_cndmask_b32 v154, v148, v147, vcc
    v_add3_u32 v12, v12, v153, v154
    v_min_u32 v153, 20, v151
    v_add_u32 v154, 12, v151
    v_lshrrev_b32 v154, 5, v154
    v_sub_u32 v155, v151, v153
    v_mad_i32_i24 v155, v154, s4, v155
    v_mul_u32_u24 v156, s20, v153
    v_add3_u32 v156, v156, v155, s38
    v_mul_u32_u24 v154, 911, v156
    v_lshrrev_b32 v154, 16, v154
    v_mul_u32_u24 v154, s22, v154
    v_mad_u32_u24 v154, v153, s21, v154
    v_bfe_u32 v156, s34, v151, 1
    v_cmp_ne_u32 vcc, 0, v156
    v_mul_i32_i24 v155, 2688, v155
    v_add3_u32 v153, v154, v155, s7
    v_cndmask_b32 v153, v255, v153, vcc
    v_mul_u32_u24 v151, 384, v151
    v_sub_u32 v151, v149, v151
    v_add_u32 v153, v153, v151
    s_lshl_b32 s28, s16, 10
    s_add_u32 s28, s28, 20480
    s_waitcnt lgkmcnt(0)
    s_load_dword s101, s[92:93], 0
    s_load_dword s101, s[94:95], 0
    s_cmp_eq_u32 s16, 2
    s_cselect_b64 s[98:99], s[80:81], s[78:79]
    s_cmp_eq_u32 s16, 3
    s_cselect_b64 s[98:99], s[88:89], s[98:99]
    s_mov_b64 s[8:9], s[76:77]
    v_lshl_add_u64 v[116:117], s[98:99], 0, v[116:117]
    s_cmp_eq_u32 s16, 2
    s_cselect_b64 s[98:99], s[84:85], s[82:83]
    s_cmp_eq_u32 s16, 3
    s_cselect_b64 s[98:99], s[86:87], s[98:99]
    v_writelane_b32 v116, s98, 63
    v_writelane_b32 v117, s99, 63
    s_cmp_eq_u32 s16, 0
    s_cbranch_scc1 L_nowue
    global_load_dword a254, v[116:117], off
L_nowue:
    s_add_u32 m0, s28, 65536
    s_nop 0
    buffer_load_dwordx4 v150, s[8:11], 0 offen nt lds
    s_add_u32 m0, s28, 69632
    s_nop 0
    buffer_load_dwordx4 v152, s[8:11], 0 offen lds
    s_add_u32 m0, s28, 73728
    s_nop 0
    buffer_load_dwordx4 v153, s[8:11], 0 offen lds
    s_add_u32 m0, s28, 0
    s_nop 0
    buffer_load_dwordx4 v10, s[8:11], s25 offen nt lds
    s_add_u32 m0, s28, 4096
    s_nop 0
    buffer_load_dwordx4 v11, s[8:11], s25 offen nt lds
    s_mov_b64 s[48:49], s[78:79]
    s_mov_b64 s[52:53], s[80:81]
    s_mov_b64 s[60:61], s[84:85]
    s_mov_b64 s[64:65], s[86:87]
    s_mov_b64 s[56:57], s[88:89]
    s_mov_b64 s[46:47], s[82:83]
    s_load_dwordx4 s[40:43], s[0:1], 72
    s_add_u32 s48, s48, 384
    s_addc_u32 s49, s49, 0
    s_add_u32 m0, s68, 0
    v_add_u32 v149, s16, v114
    v_and_b32 v149, 3, v149
    v_lshlrev_b32 v149, 1, v149
    s_mov_b32 s54, 12288
    s_mov_b32 s55, 0x00020000
    s_mov_b32 s62, 64
    s_mov_b32 s63, 0x00020000
    s_mov_b32 s66, 128
    s_mov_b32 s67, 0x00020000
    s_mov_b32 s58, 676
    s_mov_b32 s59, 0x00020000
    s_mov_b32 s14, 0
    s_mov_b32 s15, 0x00020000
    v_mov_b32 v119, 0
    v_cmp_lt_u32 s[90:91], 7, v122
    v_mov_b32 v117, 0
    v_mov_b32 v121, 0
    v_mov_b32 v127, 0
    v_lshlrev_b32 v116, 1, v114
    v_mul_u32_u24 v120, 12, v122
    s_mul_i32 s71, s16, 192
    v_add_u32 v120, s71, v120
    v_lshlrev_b32 v126, 5, v115
    s_mul_i32 s72, s16, 9408
    s_add_u32 s72, s72, 104448
    s_mul_i32 s73, s16, 7616
    s_add_u32 s73, s73, 38912
    s_cmp_eq_u32 s16, 3
    s_cselect_b32 s73, 142080, s73
    v_lshrrev_b32 v129, 2, v122
    v_and_b32 v128, 1, v129
    v_mul_u32_u24 v128, 0x020202, v128
    v_lshl_or_b32 v128, v128, 8, v128
    v_add_u32 v128, 0x05040100, v128
    v_and_b32 v130, 3, v122
    v_lshrrev_b32 v118, 1, v122
    v_xor_b32 v131, v118, v115
    v_mul_u32_u24 v118, 384, v122
    v_lshl_add_u32 v0, v131, 4, v118
    v_xor_b32 v1, 64, v0
    v_and_b32 v118, 2, v115
    v_add_u32 v118, v118, v115
    v_lshl_add_u32 v118, v118, 2, v129
    v_mul_u32_u24 v118, 96, v118
    v_lshl_add_u32 v118, v130, 3, v118
    v_add_u32 v131, s68, v118
    v_add_u32 v133, s69, v118
    v_add_u32 v132, s72, v118
    v_add_u32 v134, s73, v118
    v_mov_b32 v28, 0x3f803f80
    v_mov_b32 v29, 0x3f803f80
    v_mov_b32 v30, 0x3f803f80
    v_mov_b32 v31, 0x3f803f80
    v_mul_u32_u24 v135, 768, v115
    v_add_u32 v135, v120, v135
    v_add_u32 v135, 98304, v135
    s_mov_b32 s76, 0x3f80
    v_and_b32 v118, 1, v122
    v_lshlrev_b32 v118, 4, v118
    v_lshlrev_b32 v142, v118, s76
    v_mov_b32 v136, 0x3c003c00
    v_mov_b32 v44, 1.0
    v_lshlrev_b32 v137, 4, v115
    s_mov_b32 s19, s38
    s_mov_b32 s23, s25
    s_mov_b32 s26, 0
    s_mov_b32 s27, 0
    s_mov_b32 s18, 0
    s_add_u32 s19, s19, s20
    s_add_u32 s23, s23, s21
    s_cmp_ge_u32 s19, 72
    s_cselect_b32 s34, 72, 0
    s_cselect_b32 s35, s22, 0
    s_sub_u32 s19, s19, s34
    s_add_u32 s23, s23, s35
    s_mov_b32 s24, s23
    s_add_u32 s19, s19, s20
    s_add_u32 s23, s23, s21
    s_cmp_ge_u32 s19, 72
    s_cselect_b32 s34, 72, 0
    s_cselect_b32 s35, s22, 0
    s_sub_u32 s19, s19, s34
    s_add_u32 s23, s23, s35
    s_mul_i32 s79, s16, 64
    v_lshl_add_u32 v143, v115, 4, s79
    s_mul_i32 s80, s16, 32
    s_add_u32 s80, s80, 256
    v_lshl_add_u32 v151, v115, 3, s80
    v_add_u32 v150, 0, v122
    v_mul_u32_u24 v145, 37, v150
    v_mul_u32_u24 v144, 384, v150
    v_lshrrev_b32 v145, 8, v145
    v_mad_u32_u24 v144, v145, s70, v144
    v_add_u32 v15, v144, v143
    v_add_u32 v18, v144, v151
    v_mul_u32_u24 v144, 37, v150
    v_lshrrev_b32 v144, 8, v144
    v_mul_u32_u24 v152, 7, v144
    v_sub_u32 v152, v150, v152
    v_add_u32 v155, 16, v122
    v_mul_u32_u24 v154, 37, v155
    v_mul_u32_u24 v153, 384, v155
    v_lshrrev_b32 v154, 8, v154
    v_mad_u32_u24 v153, v154, s70, v153
    v_add_u32 v16, v153, v143
    v_add_u32 v19, v153, v151
    v_mul_u32_u24 v153, 37, v155
    v_lshrrev_b32 v153, 8, v153
    v_mul_u32_u24 v156, 7, v153
    v_sub_u32 v156, v155, v156
    v_add_u32 v159, 32, v122
    v_mul_u32_u24 v157, 37, v159
    v_mul_u32_u24 v158, 384, v159
    v_lshrrev_b32 v157, 8, v157
    v_mad_u32_u24 v158, v157, s70, v158
    v_add_u32 v17, v158, v143
    v_add_u32 v20, v158, v151
    v_mul_u32_u24 v151, 37, v159
    v_lshrrev_b32 v151, 8, v151
    v_mul_u32_u24 v143, 7, v151
    v_sub_u32 v143, v159, v143
    s_mul_i32 s81, s16, 768
    s_add_u32 s81, s81, 98304
    v_mul_u32_u24 v145, 24, v145
    v_lshl_add_u32 v145, v150, 2, v145
    v_add_u32 v22, s81, v145
    v_sub_u32 v23, s81, v145
    v_sub_u32 v158, v22, v137
    v_mul_u32_u24 v145, 24, v154
    v_lshl_add_u32 v145, v155, 2, v145
    v_add_u32 v24, s81, v145
    v_sub_u32 v25, s81, v145
    v_sub_u32 v154, v24, v137
    v_mul_u32_u24 v145, 24, v157
    v_lshl_add_u32 v145, v159, 2, v145
    v_add_u32 v26, s81, v145
    v_sub_u32 v27, s81, v145
    v_sub_u32 v145, v26, v137
    v_mul_u32_u24 v157, 148, v115
    s_mov_b32 s82, -24
    v_add_u32 v160, 0, v157
    v_lshrrev_b32 v160, 8, v160
    v_mad_i32_i24 v46, v160, s82, v158
    v_mad_i32_i24 v58, v160, s82, v154
    v_mad_i32_i24 v70, v160, s82, v145
    v_add_u32 v160, 37, v157
    v_lshrrev_b32 v160, 8, v160
    v_mad_i32_i24 v47, v160, s82, v158
    v_mad_i32_i24 v59, v160, s82, v154
    v_mad_i32_i24 v71, v160, s82, v145
    v_add_u32 v160, 74, v157
    v_lshrrev_b32 v160, 8, v160
    v_mad_i32_i24 v48, v160, s82, v158
    v_mad_i32_i24 v60, v160, s82, v154
    v_mad_i32_i24 v72, v160, s82, v145
    v_add_u32 v160, 111, v157
    v_lshrrev_b32 v160, 8, v160
    v_mad_i32_i24 v49, v160, s82, v158
    v_mad_i32_i24 v61, v160, s82, v154
    v_mad_i32_i24 v73, v160, s82, v145
    v_add_u32 v160, 592, v157
    v_lshrrev_b32 v160, 8, v160
    v_mad_i32_i24 v50, v160, s82, v158
    v_mad_i32_i24 v62, v160, s82, v154
    v_mad_i32_i24 v74, v160, s82, v145
    v_add_u32 v160, 629, v157
    v_lshrrev_b32 v160, 8, v160
    v_mad_i32_i24 v51, v160, s82, v158
    v_mad_i32_i24 v63, v160, s82, v154
    v_mad_i32_i24 v75, v160, s82, v145
    v_add_u32 v160, 666, v157
    v_lshrrev_b32 v160, 8, v160
    v_mad_i32_i24 v52, v160, s82, v158
    v_mad_i32_i24 v64, v160, s82, v154
    v_mad_i32_i24 v76, v160, s82, v145
    v_add_u32 v160, 703, v157
    v_lshrrev_b32 v160, 8, v160
    v_mad_i32_i24 v53, v160, s82, v158
    v_mad_i32_i24 v65, v160, s82, v154
    v_mad_i32_i24 v77, v160, s82, v145
    v_add_u32 v160, 1184, v157
    v_lshrrev_b32 v160, 8, v160
    v_mad_i32_i24 v54, v160, s82, v158
    v_mad_i32_i24 v66, v160, s82, v154
    v_mad_i32_i24 v78, v160, s82, v145
    v_add_u32 v160, 1221, v157
    v_lshrrev_b32 v160, 8, v160
    v_mad_i32_i24 v55, v160, s82, v158
    v_mad_i32_i24 v67, v160, s82, v154
    v_mad_i32_i24 v79, v160, s82, v145
    v_add_u32 v160, 1258, v157
    v_lshrrev_b32 v160, 8, v160
    v_mad_i32_i24 v56, v160, s82, v158
    v_mad_i32_i24 v68, v160, s82, v154
    v_mad_i32_i24 v80, v160, s82, v145
    v_add_u32 v157, 1295, v157
    v_lshrrev_b32 v157, 8, v157
    v_mad_i32_i24 v57, v157, s82, v158
    v_mad_i32_i24 v69, v157, s82, v154
    v_mad_i32_i24 v81, v157, s82, v145
    v_mov_b32 v154, s81
    v_lshlrev_b32 v145, 4, v114
    v_xor_b32 v2, 65536, v145
    v_lshl_add_u32 v3, s16, 10, v145
    s_lshr_b32 s83, s16, 1
    s_and_b32 s84, s16, 1
    s_lshl_b32 s84, s84, 3
    s_lshl_b32 s85, s83, 10
    s_add_u32 s85, s85, s84
    v_add_u32 v4, s85, v145
    s_lshl_b32 s83, s83, 11
    s_add_u32 s83, s83, s84
    s_add_u32 s83, s83, 157888
    s_mul_i32 s86, s16, 2048
    s_add_u32 s86, s86, 149696
    v_lshl_add_u32 v157, v115, 3, s86
    v_mov_b32 v145, s83
    v_mov_b32 v160, 163264
    v_mul_u32_u24 v158, 80, v115
    v_add3_u32 v5, v158, v118, s72
    s_mul_i32 s87, s16, 128
    s_add_u32 s87, s87, 61760
    s_mov_b32 s32, 0x2a8cbccc
    s_mov_b32 s33, 0x38fba882
    s_add_u32 s75, s28, 16384
    s_cmp_lt_u32 s16, 2
    s_cselect_b32 s29, s75, 161984
    s_cselect_b32 s30, 65536, 0
    s_xor_b32 s74, s29, s30
    s_lshl_b32 s92, s5, 1
    s_or_b32 s92, s92, s6
    s_mul_i32 s77, s16, 64
    s_mul_i32 s78, s16, 32
    s_add_u32 s78, s78, 192
    s_add_u32 s34, s18, 2
    s_mov_b32 s27, s26
    s_mov_b32 s26, s25
    s_add_u32 s19, s19, s20
    s_mov_b32 s18, 1
    s_mov_b32 s71, 1
    buffer_load_dwordx4 v138, s[48:51], 0 offen lds
    v_lshl_add_u32 v6, v122, 2, s73
    v_add_u32 v9, s87, v137
    v_lshrrev_b32 v118, 1, v115
    buffer_load_dwordx4 v140, s[48:51], 0 offen offset:1024 lds
    v_mul_u32_u24 v118, 48, v118
    v_lshl_add_u32 v118, v115, 3, v118
    v_lshl_add_u32 v118, v129, 4, v118
    buffer_load_dwordx4 v146, s[48:51], 0 offen offset:2048 lds
    s_add_u32 s48, s48, 36864
    s_addc_u32 s49, s49, 0
    s_add_u32 m0, s68, 3072
    v_lshl_add_u32 v118, v130, 1, v118
    buffer_load_dwordx4 v138, s[48:51], 0 offen lds
    v_add_u32 v8, s87, v118
    v_mov_b32 v37, 0
    v_mov_b32 v38, 0
    buffer_load_dwordx4 v140, s[48:51], 0 offen offset:1024 lds
    v_mov_b32 v39, 0
    v_add_u32 v162, 86016, v0
    v_add_u32 v163, 86016, v1
    buffer_load_dwordx4 v146, s[48:51], 0 offen offset:2048 lds
    s_add_u32 s48, s48, 36864
    s_addc_u32 s49, s49, 0
    s_add_u32 m0, s69, 0
    buffer_load_ushort v118, v116, s[60:63], 0 offen
    s_mov_b64 s[60:61], s[8:9]
    s_sub_u32 s62, s45, s17
    s_sub_u32 s45, s17, 1
    s_bfm_b32 s63, s17, 0
    buffer_load_dwordx3 v[170:172], v120, s[56:59], 0 offen
    v_lshlrev_b32 v164, 4, v122
    buffer_load_dwordx4 v[186:189], v126, s[64:67], 0 offen
    v_add_u32 v164, 161984, v164
    v_mul_u32_u24 v165, 336, v122
    v_add3_u32 v165, v165, v158, s72
    v_mul_u32_u24 v166, 272, v122
    v_add3_u32 v166, v166, v137, s73
    v_mul_u32_u24 v167, 1088, v115
    buffer_load_dwordx4 v[234:237], v126, s[64:67], 0 offen offset:16
    v_add_u32 v167, v167, v6
    v_add_u32 v168, 5376, v165
    v_add_u32 v169, 4352, v166
    v_add_u32 v175, 4352, v167
    v_cmp_gt_u32 s[88:89], 16, v114
    v_mov_b32 v174, 0xf149f2ca
    v_add_u32 v120, 768, v254
    v_mul_u32_u24 v116, 2731, v120
    v_bfe_u32 v126, v116, 17, 3
    v_lshrrev_b32 v116, 16, v116
    v_xor_b32 v120, v126, v120
    v_mul_u32_u24 v126, 37, v116
    v_lshrrev_b32 v126, 8, v126
    v_lshlrev_b32 v120, 4, v120
    v_mad_u32_u24 v13, v126, s70, v120
    v_mul_u32_u24 v126, 37, v116
    v_lshrrev_b32 v126, 8, v126
    v_mul_u32_u24 v120, 7, v126
    v_sub_u32 v120, v116, v120
    v_cmp_gt_u32 vcc, 4, v126
    v_add_u32 v116, 1024, v254
    v_mul_u32_u24 v173, 2731, v116
    v_cndmask_b32 v126, v141, v123, vcc
    v_cmp_gt_u32 vcc, 4, v120
    v_bfe_u32 v254, v173, 17, 3
    v_lshrrev_b32 v173, 16, v173
    v_cndmask_b32 v120, v148, v147, vcc
    v_add3_u32 v13, v13, v126, v120
    v_xor_b32 v116, v254, v116
    v_mul_u32_u24 v254, 37, v173
    v_lshrrev_b32 v254, 8, v254
    v_lshlrev_b32 v116, 4, v116
    v_mad_u32_u24 v14, v254, s70, v116
    v_mul_u32_u24 v116, 37, v173
    v_lshrrev_b32 v116, 8, v116
    v_mul_u32_u24 v120, 7, v116
    v_sub_u32 v120, v173, v120
    v_cmp_gt_u32 vcc, 4, v116
    v_mov_b32 v254, 0xc31044fe
    v_mul_u32_u24 v176, 37, v150
    v_cndmask_b32 v116, v141, v123, vcc
    v_cmp_gt_u32 vcc, 4, v120
    v_lshrrev_b32 v176, 8, v176
    v_mul_u32_u24 v126, 7, v176
    v_cndmask_b32 v120, v148, v147, vcc
    v_add3_u32 v14, v14, v116, v120
    v_cmp_gt_u32 vcc, 48, v173
    v_sub_u32 v126, v150, v126
    v_lshrrev_b32 v176, 2, v176
    v_cndmask_b32 v14, v255, v14, vcc
    v_cmp_gt_u32 vcc, 2, v130
    v_lshrrev_b32 v126, 2, v126
    v_and_b32 v176, s5, v176
    v_cndmask_b32 v32, 0, v142, vcc
    v_cndmask_b32 v33, v142, 0, vcc
    v_cndmask_b32 v34, 0, v142, vcc
    v_cndmask_b32 v35, v142, 0, vcc
    v_cmp_eq_u32 vcc, 0, v130
    v_and_b32 v126, s6, v126
    v_lshl_or_b32 v176, v176, 1, v126
    v_cndmask_b32 v40, 0, v136, vcc
    v_cmp_eq_u32 vcc, 1, v130
    v_mul_u32_u24 v255, 37, v155
    v_lshrrev_b32 v255, 8, v255
    v_cndmask_b32 v41, 0, v136, vcc
    v_cmp_eq_u32 vcc, 2, v130
    s_min_u32 s70, s62, 4
    s_waitcnt vmcnt(9)
    s_barrier
    global_load_ushort v149, v149, s[46:47]
    v_cndmask_b32 v42, 0, v136, vcc
    v_cmp_eq_u32 vcc, 3, v130
    v_mul_u32_u24 v116, 7, v255
    v_sub_u32 v116, v155, v116
    v_cndmask_b32 v43, 0, v136, vcc
    v_cmp_eq_u32 vcc, v115, v129
    v_lshrrev_b32 v255, 2, v255
    v_lshrrev_b32 v116, 2, v116
    v_cndmask_b32 v178, 0, v32, vcc
    s_lshr_b32 s83, s44, 8
    s_cselect_b32 s70, 0, s70
    buffer_load_dwordx4 v138, s[48:51], 0 offen lds
    v_cndmask_b32 v179, 0, v33, vcc
    v_and_b32 v255, s5, v255
    v_and_b32 v116, s6, v116
    v_lshl_or_b32 v255, v255, 1, v116
    v_mul_u32_u24 v177, 37, v159
    v_lshrrev_b32 v177, 8, v177
    v_mul_u32_u24 v116, 7, v177
    v_sub_u32 v116, v159, v116
    v_lshrrev_b32 v177, 2, v177
    v_lshrrev_b32 v116, 2, v116
    v_and_b32 v177, s5, v177
    v_and_b32 v116, s6, v116
    v_lshl_or_b32 v177, v177, 1, v116
    v_mul_u32_u24 v116, 6, v124
    s_waitcnt vmcnt(9)
    buffer_load_dwordx4 v140, s[48:51], 0 offen offset:1024 lds
    ds_read_b64_tr_b16 a[72:73], v131 offset:0
    ds_read_b64_tr_b16 a[74:75], v131 offset:768
    ds_read_b64_tr_b16 a[96:97], v131 offset:32
    ds_read_b64_tr_b16 a[98:99], v131 offset:800
    ds_read_b64_tr_b16 a[120:121], v131 offset:64
    ds_read_b64_tr_b16 a[122:123], v131 offset:832
    v_sub_u32 v120, v114, v116
    v_mul_u32_u24 v116, 384, v124
    v_lshl_add_u32 v116, v120, 4, v116
    v_add_u32 v124, s78, v116
    v_add_u32 v116, s77, v116
    v_cmp_gt_i32 vcc, 4, v120
    v_mul_u32_u24 v126, 6, v125
    v_sub_u32 v120, v114, v126
    v_cndmask_b32 v180, v124, v116, vcc
    buffer_load_dwordx4 v146, s[48:51], 0 offen offset:2048 lds
    s_add_u32 s48, s48, 36864
    s_addc_u32 s49, s49, 0
    s_add_u32 m0, s69, 3072
    v_mul_u32_u24 v126, 384, v125
    v_lshl_add_u32 v126, v120, 4, v126
    v_add_u32 v136, s78, v126
    v_add_u32 v126, s77, v126
    v_cmp_gt_i32 vcc, -60, v120
    v_mul_u32_u24 v142, 6, v139
    v_sub_u32 v120, v114, v142
    v_cndmask_b32 v181, v136, v126, vcc
    v_mul_u32_u24 v142, 384, v139
    v_lshl_add_u32 v142, v120, 4, v142
    v_add_u32 v126, s78, v142
    v_add_u32 v142, s77, v142
    s_and_b32 s77, s2, 0xf8
    s_add_u32 s77, s77, 4940
    s_mul_i32 s78, s77, 58255
    s_lshr_b32 s78, s78, 22
    buffer_load_dwordx4 v138, s[48:51], 0 offen lds
    v_cmp_gt_i32 vcc, -124, v120
    v_mul_u32_u24 v136, 96, v122
    v_add3_u32 v155, v136, v137, s68
    v_cndmask_b32 v139, v126, v142, vcc
    v_cmp_gt_u32 vcc, 4, v144
    v_lshl_add_u32 v114, v115, 3, v136
    v_add3_u32 v114, v114, 64, s68
    v_cndmask_b32 v144, v141, v123, vcc
    s_waitcnt vmcnt(9)
    ds_read_b64_tr_b16 a[76:77], v131 offset:3072
    ds_read_b64_tr_b16 a[78:79], v131 offset:3840
    s_waitcnt vmcnt(7)
    ds_read_b64_tr_b16 a[100:101], v131 offset:3104
    s_waitcnt vmcnt(6)
    ds_read_b64_tr_b16 a[102:103], v131 offset:3872
    s_waitcnt vmcnt(5)
    buffer_load_dwordx4 v140, s[48:51], 0 offen offset:1024 lds
    ds_read_b64_tr_b16 a[124:125], v131 offset:3136
    ds_read_b64_tr_b16 a[126:127], v131 offset:3904
    v_cndmask_b32 v186, v186, v187, s[90:91]
    v_cndmask_b32 v188, v188, v189, s[90:91]
    v_perm_b32 v124, v188, v186, v128
    v_cndmask_b32 v234, v234, v235, s[90:91]
    v_cndmask_b32 v236, v236, v237, s[90:91]
    v_perm_b32 v125, v236, v234, v128
    v_bfe_u32 v116, v170, v137, 16
    v_bfe_u32 v120, v171, v137, 16
    v_bfe_u32 v126, v172, v137, 16
    v_mfma_f32_16x16x16_bf16 v[170:173], v[118:119], v[116:117], 0
    v_cmp_gt_u32 vcc, 4, v152
    v_add3_u32 v116, v136, v137, s69
    v_lshl_add_u32 v117, v115, 3, v136
    v_mfma_f32_16x16x16_bf16 v[186:189], v[118:119], v[120:121], 0
    v_cndmask_b32 v152, v148, v147, vcc
    v_add3_u32 v15, v15, v144, v152
    v_add3_u32 v18, v18, v144, v152
    v_mfma_f32_16x16x16_bf16 v[234:237], v[118:119], v[126:127], 0
    buffer_load_dwordx4 v146, s[48:51], 0 offen offset:2048 lds
    s_add_u32 s48, s48, 36864
    s_addc_u32 s49, s49, 0
    s_add_u32 m0, s72, 0
    v_max_f32 v170, 0, v170
    v_max_f32 v171, 0, v171
    v_max_f32 v172, 0, v172
    v_max_f32 v173, 0, v173
    v_cvt_pk_bf16_f32 v136, v170, v171
    v_cvt_pk_bf16_f32 v137, v172, v173
    v_max_f32 v186, 0, v186
    v_max_f32 v187, 0, v187
    v_mfma_f32_16x16x16_bf16 v[118:121], v[124:125], v[136:137], 0
    v_max_f32 v188, 0, v188
    s_waitcnt vmcnt(6)
    v_max_f32 v189, 0, v189
    buffer_load_dwordx4 v138, s[48:51], 0 offen lds
    v_cvt_pk_bf16_f32 v136, v186, v187
    v_cvt_pk_bf16_f32 v137, v188, v189
    v_max_f32 v234, 0, v234
    v_max_f32 v235, 0, v235
    v_mfma_f32_16x16x16_bf16 v[170:173], v[124:125], v[136:137], 0
    v_cvt_pk_bf16_f32 v118, v118, v118
    v_and_b32 v118, 0xffff0000, v118
    v_mul_f32 v118, 0xbfb8aa3b, v118
    v_exp_f32 v118, v118
    v_max_f32 v236, 0, v236
    v_add_f32 v118, 1.0, v118
    v_rcp_f32 v118, v118
    v_max_f32 v237, 0, v237
    buffer_load_dwordx4 v140, s[48:51], 0 offen offset:1024 lds
    v_cvt_pk_bf16_f32 v118, v118, v118
    v_and_b32 v118, 0xffff0000, v118
    v_add_f32 v118, -0.5, v118
    v_mul_f32 v118, 0x41b8aa3b, v118
    ds_write_b32 v135, v118 offset:0
    v_cvt_pk_bf16_f32 v170, v170, v170
    v_and_b32 v170, 0xffff0000, v170
    v_mul_f32 v170, 0xbfb8aa3b, v170
    v_exp_f32 v170, v170
    v_cvt_pk_bf16_f32 v136, v234, v235
    v_add_f32 v170, 1.0, v170
    buffer_load_dwordx4 v146, s[48:51], 0 offen offset:2048 lds
    s_add_u32 s48, s48, 36864
    s_addc_u32 s49, s49, 0
    s_add_u32 m0, s72, 3072
    v_rcp_f32 v170, v170
    v_cvt_pk_bf16_f32 v137, v236, v237
    v_cvt_pk_bf16_f32 v170, v170, v170
    v_and_b32 v170, 0xffff0000, v170
    v_mfma_f32_16x16x16_bf16 v[118:121], v[124:125], v[136:137], 0
    v_add_f32 v170, -0.5, v170
    s_waitcnt vmcnt(6)
    s_mov_b32 s72, 2
    ds_read_b64_tr_b16 a[80:81], v133 offset:0
    ds_read_b64_tr_b16 a[82:83], v133 offset:768
    ds_read_b64_tr_b16 a[104:105], v133 offset:32
    ds_read_b64_tr_b16 a[106:107], v133 offset:800
    ds_read_b64_tr_b16 a[128:129], v133 offset:64
    buffer_load_dwordx4 v138, s[48:51], 0 offen lds
    ds_read_b64_tr_b16 a[130:131], v133 offset:832
    v_mul_f32 v170, 0x41b8aa3b, v170
    ds_write_b32 v135, v170 offset:4
    v_cvt_pk_bf16_f32 v118, v118, v118
    v_and_b32 v118, 0xffff0000, v118
    v_mul_f32 v118, 0xbfb8aa3b, v118
    v_exp_f32 v118, v118
    v_lshlrev_b32 v149, 16, v149
    v_add_f32 v118, 1.0, v118
    v_rcp_f32 v118, v118
    buffer_load_dwordx4 v140, s[48:51], 0 offen offset:1024 lds
    v_cvt_pk_bf16_f32 v118, v118, v118
    v_and_b32 v118, 0xffff0000, v118
    v_add_f32 v118, -0.5, v118
    v_mul_f32 v118, 0x41b8aa3b, v118
    ds_write_b32 v135, v118 offset:8
    v_max_f32 v149, 0xc2c80000, v149
    v_min_f32 v149, 0x40930000, v149
    v_mul_f32 v149, 0x3fb8aa3b, v149
    v_exp_f32 v149, v149
    v_cmp_gt_u32 vcc, 4, v153
    v_cvt_pk_bf16_f32 v149, v149, v149
    buffer_load_dwordx4 v146, s[48:51], 0 offen offset:2048 lds
    s_sub_u32 s48, s48, 184704
    s_subb_u32 s49, s49, 0
    s_add_u32 m0, s73, 0
    v_and_b32 v149, 0xffff0000, v149
    v_mul_f32 v124, 0x3fb8aa3b, v149
    v_readfirstlane_b32 s37, v149
    v_readfirstlane_b32 s31, v124
    v_cndmask_b32 v153, v141, v123, vcc
    v_cmp_gt_u32 vcc, 4, v156
    v_add3_u32 v117, v117, 64, s69
    s_nop 0
    v_cndmask_b32 v156, v148, v147, vcc
    v_add3_u32 v16, v16, v153, v156
    v_add3_u32 v19, v19, v153, v156
    v_cmp_gt_u32 vcc, 4, v151
    buffer_load_dwordx4 v138, s[48:51], 0 offen lds
    s_waitcnt vmcnt(7)
    s_waitcnt lgkmcnt(0)
    s_barrier
    ds_read_b64_tr_b16 a[84:85], v133 offset:3072
    ds_read_b64_tr_b16 a[86:87], v133 offset:3840
    ds_read_b64_tr_b16 a[108:109], v133 offset:3104
    ds_read_b64_tr_b16 a[110:111], v133 offset:3872
    ds_read_b64_tr_b16 a[132:133], v133 offset:3136
    ds_read_b64_tr_b16 a[134:135], v133 offset:3904
    ds_read_b32 v22, v22 offset:0
    ds_read_b32 v23, v23 offset:672
    v_cndmask_b32 v151, v141, v123, vcc
    v_cmp_gt_u32 vcc, 4, v143
    ds_read_b32 v24, v24 offset:0
    ds_read_b32 v25, v25 offset:672
    buffer_load_dwordx4 v140, s[48:51], 0 offen offset:1024 lds
    ds_read_b32 v26, v26 offset:0
    ds_read_b32 v27, v27 offset:672
    ds_read_b32 v46, v46 offset:336
    v_cndmask_b32 v143, v148, v147, vcc
    v_add3_u32 v17, v17, v151, v143
    v_add3_u32 v20, v20, v151, v143
    v_cmp_gt_u32 vcc, 2, v115
    ds_read_b32 v58, v58 offset:336
    ds_read_b32 v70, v70 offset:336
    ds_read_b32 v47, v47 offset:332
    ds_read_b32 v59, v59 offset:332
    ds_read_b32 v71, v71 offset:332
    ds_read_b32 v48, v48 offset:328
    buffer_load_dwordx4 v146, s[48:51], 0 offen offset:2048 lds
    ds_read_b32 v60, v60 offset:328
    ds_read_b32 v72, v72 offset:328
    ds_read_b32 v49, v49 offset:324
    s_add_u32 s48, s48, 36864
    ds_read_b32 v61, v61 offset:324
    s_addc_u32 s49, s49, 0
    ds_read_b32 v73, v73 offset:324
    s_add_u32 m0, s73, 3072
    ds_read_b32 v50, v50 offset:272
    v_cndmask_b32 v157, v145, v157, vcc
    v_lshl_add_u32 v157, v129, 9, v157
    v_lshl_add_u32 v157, v130, 1, v157
    v_cmp_gt_u32 vcc, 3, v115
    s_mov_b32 s73, 3
    s_waitcnt vmcnt(6)
    buffer_load_dwordx4 v138, s[48:51], 0 offen lds
    ds_read_b64_tr_b16 a[88:89], v132 offset:0
    ds_read_b64_tr_b16 a[90:91], v132 offset:768
    ds_read_b64_tr_b16 a[112:113], v132 offset:32
    ds_read_b64_tr_b16 a[114:115], v132 offset:800
    ds_read_b64_tr_b16 a[136:137], v132 offset:64
    ds_read_b64_tr_b16 a[138:139], v132 offset:832
    ds_read_b32 v62, v62 offset:272
    ds_read_b32 v74, v74 offset:272
    v_cndmask_b32 v7, v160, v157, vcc
    v_cmp_gt_u32 vcc, 12, v122
    ds_read_b32 v51, v51 offset:268
    ds_read_b32 v63, v63 offset:268
    ds_read_b32 v75, v75 offset:268
    ds_read_b32 v52, v52 offset:264
    buffer_load_dwordx4 v140, s[48:51], 0 offen offset:1024 lds
    ds_read_b32 v64, v64 offset:264
    ds_read_b32 v76, v76 offset:264
    v_cndmask_b32 v168, v164, v168, vcc
    v_cndmask_b32 v169, v164, v169, vcc
    v_cmp_gt_u32 vcc, 3, v115
    ds_read_b32 v53, v53 offset:260
    ds_read_b32 v65, v65 offset:260
    ds_read_b32 v77, v77 offset:260
    ds_read_b32 v54, v54 offset:208
    ds_read_b32 v66, v66 offset:208
    v_cndmask_b32 v175, v164, v175, vcc
    ds_read_b32 v78, v78 offset:208
    ds_read_b32 v55, v55 offset:204
    buffer_load_dwordx4 v146, s[48:51], 0 offen offset:2048 lds
    ds_read_b32 v67, v67 offset:204
    ds_read_b32 v79, v79 offset:204
    s_add_u32 s48, s48, 36864
    ds_read_b32 v56, v56 offset:200
    s_addc_u32 s49, s49, 0
    ds_read_b32 v68, v68 offset:200
    s_add_u32 m0, s68, 0
    ds_read_b32 v80, v80 offset:200
    ds_read_b32 v57, v57 offset:196
    ds_read_b32 v69, v69 offset:196
    ds_read_b32 v81, v81 offset:196
    s_waitcnt vmcnt(6)
    ds_read_b64_tr_b16 a[92:93], v132 offset:3072
    buffer_load_dwordx4 v138, s[48:51], 0 offen lds
    ds_read_b64_tr_b16 a[94:95], v132 offset:3840
    ds_read_b64_tr_b16 a[116:117], v132 offset:3104
    ds_read_b64_tr_b16 a[118:119], v132 offset:3872
    ds_read_b64_tr_b16 a[140:141], v132 offset:3136
    ds_read_b64_tr_b16 a[142:143], v132 offset:3904
    ds_read_b32 v154, v154 offset:336
    v_cmp_ne_u32 vcc, s92, v176
    v_lshl_add_u32 v164, v115, 2, 0
    v_mul_u32_u24 v130, 37, v164
    v_cndmask_b32 v141, 0, v254, vcc
    s_waitcnt lgkmcnt(12)
    buffer_load_dwordx4 v140, s[48:51], 0 offen offset:1024 lds
    v_add_f32 v22, v22, v141
    v_cmp_ne_u32 vcc, s92, v176
    v_lshrrev_b32 v130, 8, v130
    v_mul_u32_u24 v141, 7, v130
    v_cndmask_b32 v132, 0, v254, vcc
    v_add_f32 v23, v23, v132
    v_cmp_ne_u32 vcc, s92, v255
    v_sub_u32 v141, v164, v141
    v_lshrrev_b32 v130, 2, v130
    v_cndmask_b32 v132, 0, v254, vcc
    v_add_f32 v24, v24, v132
    v_cmp_ne_u32 vcc, s92, v255
    v_lshrrev_b32 v141, 2, v141
    v_and_b32 v130, s5, v130
    v_cndmask_b32 v132, 0, v254, vcc
    buffer_load_dwordx4 v146, s[48:51], 0 offen offset:2048 lds
    s_add_u32 s48, s48, 36864
    s_waitcnt lgkmcnt(0)
    s_addc_u32 s49, s49, 0
    s_add_u32 m0, s68, 3072
    v_readfirstlane_b32 s39, v154
    v_add_f32 v25, v25, v132
    v_cmp_ne_u32 vcc, s92, v177
    v_and_b32 v141, s6, v141
    v_lshl_or_b32 v130, v130, 1, v141
    v_cndmask_b32 v132, 0, v254, vcc
    v_add_f32 v26, v26, v132
    v_cmp_ne_u32 vcc, s92, v177
    v_lshl_add_u32 v132, v115, 2, 1
    v_mul_u32_u24 v141, 37, v132
    s_waitcnt vmcnt(6)
    buffer_load_dwordx4 v138, s[48:51], 0 offen lds
    ds_read_b64_tr_b16 a[0:1], v134 offset:0
    ds_read_b64_tr_b16 a[2:3], v134 offset:768
    ds_read_b64_tr_b16 a[24:25], v134 offset:32
    ds_read_b64_tr_b16 a[26:27], v134 offset:800
    ds_read_b64_tr_b16 a[48:49], v134 offset:64
    ds_read_b64_tr_b16 a[50:51], v134 offset:832
    v_cndmask_b32 v164, 0, v254, vcc
    v_add_f32 v27, v27, v164
    v_cmp_ne_u32 vcc, v130, v176
    v_lshrrev_b32 v141, 8, v141
    v_mul_u32_u24 v164, 7, v141
    v_cndmask_b32 v135, 0, v254, vcc
    v_add_f32 v46, v46, v135
    v_cmp_ne_u32 vcc, v130, v255
    v_sub_u32 v164, v132, v164
    buffer_load_dwordx4 v140, s[48:51], 0 offen offset:1024 lds
    v_cndmask_b32 v132, 0, v254, vcc
    v_add_f32 v58, v58, v132
    v_cmp_ne_u32 vcc, v130, v177
    v_lshrrev_b32 v141, 2, v141
    v_lshrrev_b32 v164, 2, v164
    v_cndmask_b32 v130, 0, v254, vcc
    v_add_f32 v70, v70, v130
    v_and_b32 v141, s5, v141
    v_and_b32 v164, s6, v164
    v_lshl_or_b32 v141, v141, 1, v164
    v_cmp_ne_u32 vcc, v141, v176
    v_lshl_add_u32 v164, v115, 2, 2
    v_mul_u32_u24 v130, 37, v164
    v_cndmask_b32 v132, 0, v254, vcc
    v_add_f32 v47, v47, v132
    buffer_load_dwordx4 v146, s[48:51], 0 offen offset:2048 lds
    s_add_u32 s48, s48, 36864
    s_addc_u32 s49, s49, 0
    s_add_u32 m0, s69, 0
    v_cmp_ne_u32 vcc, v141, v255
    v_lshrrev_b32 v130, 8, v130
    v_mul_u32_u24 v132, 7, v130
    v_cndmask_b32 v135, 0, v254, vcc
    v_add_f32 v59, v59, v135
    v_cmp_ne_u32 vcc, v141, v177
    v_sub_u32 v132, v164, v132
    v_lshrrev_b32 v130, 2, v130
    v_cndmask_b32 v141, 0, v254, vcc
    v_add_f32 v71, v71, v141
    v_lshrrev_b32 v132, 2, v132
    v_and_b32 v130, s5, v130
    buffer_load_dwordx4 v138, s[48:51], 0 offen lds
    s_waitcnt vmcnt(7)
    ds_read_b64_tr_b16 a[4:5], v134 offset:3072
    ds_read_b64_tr_b16 a[6:7], v134 offset:3840
    ds_read_b64_tr_b16 a[28:29], v134 offset:3104
    ds_read_b64_tr_b16 a[30:31], v134 offset:3872
    ds_read_b64_tr_b16 a[52:53], v134 offset:3136
    ds_read_b64_tr_b16 a[54:55], v134 offset:3904
    v_and_b32 v132, s6, v132
    v_lshl_or_b32 v130, v130, 1, v132
    v_cmp_ne_u32 vcc, v130, v176
    v_lshl_add_u32 v141, v115, 2, 3
    v_mul_u32_u24 v164, 37, v141
    v_cndmask_b32 v132, 0, v254, vcc
    v_add_f32 v48, v48, v132
    v_cmp_ne_u32 vcc, v130, v255
    buffer_load_dwordx4 v140, s[48:51], 0 offen offset:1024 lds
    v_lshrrev_b32 v164, 8, v164
    v_cndmask_b32 v132, 0, v254, vcc
    v_add_f32 v60, v60, v132
    v_cmp_ne_u32 vcc, v130, v177
    v_mul_u32_u24 v130, 7, v164
    v_sub_u32 v130, v141, v130
    v_cndmask_b32 v141, 0, v254, vcc
    v_add_f32 v72, v72, v141
    v_lshrrev_b32 v164, 2, v164
    v_lshrrev_b32 v130, 2, v130
    v_and_b32 v164, s5, v164
    v_and_b32 v130, s6, v130
    v_lshl_or_b32 v164, v164, 1, v130
    v_cmp_ne_u32 vcc, v164, v176
    v_lshl_add_u32 v141, v115, 2, 16
    buffer_load_dwordx4 v146, s[48:51], 0 offen offset:2048 lds
    s_add_u32 s48, s48, 36864
    s_addc_u32 s49, s49, 0
    s_add_u32 m0, s69, 3072
    v_cndmask_b32 v130, 0, v254, vcc
    v_add_f32 v49, v49, v130
    v_cmp_ne_u32 vcc, v164, v255
    v_mul_u32_u24 v130, 37, v141
    v_lshrrev_b32 v130, 8, v130
    v_cndmask_b32 v132, 0, v254, vcc
    v_add_f32 v61, v61, v132
    v_cmp_ne_u32 vcc, v164, v177
    v_mul_u32_u24 v132, 7, v130
    v_sub_u32 v132, v141, v132
    v_cndmask_b32 v141, 0, v254, vcc
    v_add_f32 v73, v73, v141
    buffer_load_dwordx4 v138, s[48:51], 0 offen lds
    s_waitcnt vmcnt(7)
    ds_read_b64_tr_b16 a[8:9], v131 offset:0
    ds_read_b64_tr_b16 a[10:11], v131 offset:768
    ds_read_b64_tr_b16 a[32:33], v131 offset:32
    ds_read_b64_tr_b16 a[34:35], v131 offset:800
    ds_read_b64_tr_b16 a[56:57], v131 offset:64
    ds_read_b64_tr_b16 a[58:59], v131 offset:832
    v_lshrrev_b32 v130, 2, v130
    v_lshrrev_b32 v132, 2, v132
    v_and_b32 v130, s5, v130
    v_and_b32 v132, s6, v132
    v_lshl_or_b32 v130, v130, 1, v132
    v_cmp_ne_u32 vcc, v130, v176
    v_lshl_add_u32 v141, v115, 2, 17
    v_mul_u32_u24 v164, 37, v141
    buffer_load_dwordx4 v140, s[48:51], 0 offen offset:1024 lds
    v_cndmask_b32 v132, 0, v254, vcc
    v_add_f32 v50, v50, v132
    v_cmp_ne_u32 vcc, v130, v255
    v_lshrrev_b32 v164, 8, v164
    v_mul_u32_u24 v132, 7, v164
    v_cndmask_b32 v147, 0, v254, vcc
    v_add_f32 v62, v62, v147
    v_cmp_ne_u32 vcc, v130, v177
    v_sub_u32 v132, v141, v132
    v_lshrrev_b32 v164, 2, v164
    v_cndmask_b32 v130, 0, v254, vcc
    v_add_f32 v74, v74, v130
    v_lshrrev_b32 v132, 2, v132
    v_and_b32 v164, s5, v164
    v_and_b32 v132, s6, v132
    buffer_load_dwordx4 v146, s[48:51], 0 offen offset:2048 lds
    s_sub_u32 s48, s48, 183552
    s_subb_u32 s49, s49, 0
    s_add_u32 m0, s68, 0
    s_waitcnt lgkmcnt(0)
    v_lshl_or_b32 v164, v164, 1, v132
    v_cmp_ne_u32 vcc, v164, v176
    v_lshl_add_u32 v141, v115, 2, 18
    v_mul_u32_u24 v130, 37, v141
    v_cndmask_b32 v132, 0, v254, vcc
    v_add_f32 v51, v51, v132
    v_cmp_ne_u32 vcc, v164, v255
    v_lshrrev_b32 v130, 8, v130
    v_mul_u32_u24 v132, 7, v130
    v_cndmask_b32 v147, 0, v254, vcc
    v_add_f32 v63, v63, v147
    buffer_load_dwordx4 v138, s[48:51], 0 offen lds
    s_waitcnt vmcnt(7)
    ds_read_b64_tr_b16 a[12:13], v131 offset:3072
    ds_read_b64_tr_b16 a[14:15], v131 offset:3840
    ds_read_b64_tr_b16 a[36:37], v131 offset:3104
    ds_read_b64_tr_b16 a[38:39], v131 offset:3872
    ds_read_b64_tr_b16 a[60:61], v131 offset:3136
    ds_read_b64_tr_b16 a[62:63], v131 offset:3904
    v_cmp_ne_u32 vcc, v164, v177
    v_sub_u32 v132, v141, v132
    v_lshrrev_b32 v130, 2, v130
    v_cndmask_b32 v141, 0, v254, vcc
    v_add_f32 v75, v75, v141
    v_lshrrev_b32 v132, 2, v132
    v_and_b32 v130, s5, v130
    v_and_b32 v132, s6, v132
    buffer_load_dwordx4 v140, s[48:51], 0 offen offset:1024 lds
    v_lshl_or_b32 v130, v130, 1, v132
    v_cmp_ne_u32 vcc, v130, v176
    v_lshl_add_u32 v141, v115, 2, 19
    v_mul_u32_u24 v164, 37, v141
    v_cndmask_b32 v132, 0, v254, vcc
    v_add_f32 v52, v52, v132
    v_cmp_ne_u32 vcc, v130, v255
    v_lshrrev_b32 v164, 8, v164
    v_mul_u32_u24 v132, 7, v164
    v_cndmask_b32 v147, 0, v254, vcc
    v_add_f32 v64, v64, v147
    v_cmp_ne_u32 vcc, v130, v177
    v_sub_u32 v132, v141, v132
    v_lshrrev_b32 v164, 2, v164
    v_cndmask_b32 v130, 0, v254, vcc
    buffer_load_dwordx4 v146, s[48:51], 0 offen offset:2048 lds
    s_add_u32 s48, s48, 36864
    s_addc_u32 s49, s49, 0
    s_add_u32 m0, s68, 3072
    s_waitcnt lgkmcnt(0)
    v_add_f32 v76, v76, v130
    v_lshrrev_b32 v132, 2, v132
    v_and_b32 v164, s5, v164
    v_and_b32 v132, s6, v132
    v_lshl_or_b32 v164, v164, 1, v132
    v_cmp_ne_u32 vcc, v164, v176
    v_lshl_add_u32 v132, v115, 2, 32
    v_mul_u32_u24 v141, 37, v132
    v_cndmask_b32 v130, 0, v254, vcc
    v_add_f32 v53, v53, v130
    v_cmp_ne_u32 vcc, v164, v255
    buffer_load_dwordx4 v138, s[48:51], 0 offen lds
    s_waitcnt vmcnt(7)
    ds_read_b64_tr_b16 a[16:17], v133 offset:0
    ds_read_b64_tr_b16 a[18:19], v133 offset:768
    ds_read_b64_tr_b16 a[40:41], v133 offset:32
    ds_read_b64_tr_b16 a[42:43], v133 offset:800
    ds_read_b64_tr_b16 a[64:65], v133 offset:64
    ds_read_b64_tr_b16 a[66:67], v133 offset:832
    v_cndmask_b32 v130, 0, v254, vcc
    v_add_f32 v65, v65, v130
    v_cmp_ne_u32 vcc, v164, v177
    v_lshrrev_b32 v141, 8, v141
    v_mul_u32_u24 v164, 7, v141
    v_cndmask_b32 v130, 0, v254, vcc
    v_add_f32 v77, v77, v130
    v_sub_u32 v164, v132, v164
    buffer_load_dwordx4 v140, s[48:51], 0 offen offset:1024 lds
    v_lshrrev_b32 v141, 2, v141
    v_lshrrev_b32 v164, 2, v164
    v_and_b32 v141, s5, v141
    v_and_b32 v164, s6, v164
    v_lshl_or_b32 v141, v141, 1, v164
    v_cmp_ne_u32 vcc, v141, v176
    v_lshl_add_u32 v164, v115, 2, 33
    v_mul_u32_u24 v132, 37, v164
    v_cndmask_b32 v130, 0, v254, vcc
    v_add_f32 v54, v54, v130
    v_cmp_ne_u32 vcc, v141, v255
    v_lshrrev_b32 v132, 8, v132
    v_mul_u32_u24 v130, 7, v132
    v_cndmask_b32 v147, 0, v254, vcc
    v_add_f32 v66, v66, v147
    buffer_load_dwordx4 v146, s[48:51], 0 offen offset:2048 lds
    s_add_u32 s48, s48, 36864
    s_addc_u32 s49, s49, 0
    s_add_u32 m0, s69, 0
    s_waitcnt lgkmcnt(0)
    v_cmp_ne_u32 vcc, v141, v177
    v_sub_u32 v130, v164, v130
    v_lshrrev_b32 v132, 2, v132
    v_cndmask_b32 v141, 0, v254, vcc
    v_add_f32 v78, v78, v141
    v_lshrrev_b32 v130, 2, v130
    v_and_b32 v132, s5, v132
    v_and_b32 v130, s6, v130
    v_lshl_or_b32 v132, v132, 1, v130
    v_cmp_ne_u32 vcc, v132, v176
    v_lshl_add_u32 v141, v115, 2, 34
    buffer_load_dwordx4 v138, s[48:51], 0 offen lds
    s_waitcnt vmcnt(7)
    ds_read_b64_tr_b16 a[20:21], v133 offset:3072
    ds_read_b64_tr_b16 a[22:23], v133 offset:3840
    ds_read_b64_tr_b16 a[44:45], v133 offset:3104
    ds_read_b64_tr_b16 a[46:47], v133 offset:3872
    ds_read_b64_tr_b16 a[68:69], v133 offset:3136
    ds_read_b64_tr_b16 a[70:71], v133 offset:3904
    v_cndmask_b32 v130, 0, v254, vcc
    v_add_f32 v55, v55, v130
    v_cmp_ne_u32 vcc, v132, v255
    v_mul_u32_u24 v164, 37, v141
    v_lshrrev_b32 v164, 8, v164
    v_cndmask_b32 v130, 0, v254, vcc
    v_add_f32 v67, v67, v130
    v_cmp_ne_u32 vcc, v132, v177
    buffer_load_dwordx4 v140, s[48:51], 0 offen offset:1024 lds
    v_mul_u32_u24 v132, 7, v164
    v_cndmask_b32 v130, 0, v254, vcc
    v_add_f32 v79, v79, v130
    v_sub_u32 v132, v141, v132
    v_lshrrev_b32 v164, 2, v164
    v_lshrrev_b32 v132, 2, v132
    v_and_b32 v164, s5, v164
    v_and_b32 v132, s6, v132
    v_lshl_or_b32 v164, v164, 1, v132
    v_cmp_ne_u32 vcc, v164, v176
    v_lshl_add_u32 v115, v115, 2, 35
    v_mul_u32_u24 v141, 37, v115
    v_cndmask_b32 v130, 0, v254, vcc
    v_add_f32 v56, v56, v130
    v_cmp_ne_u32 vcc, v164, v255
    buffer_load_dwordx4 v146, s[48:51], 0 offen offset:2048 lds
    s_add_u32 s48, s48, 36864
    s_addc_u32 s49, s49, 0
    s_add_u32 m0, s69, 3072
    s_waitcnt lgkmcnt(0)
    v_cndmask_b32 v130, 0, v254, vcc
    v_add_f32 v68, v68, v130
    v_cmp_ne_u32 vcc, v164, v177
    v_lshrrev_b32 v141, 8, v141
    v_mul_u32_u24 v164, 7, v141
    v_cndmask_b32 v130, 0, v254, vcc
    v_add_f32 v80, v80, v130
    v_sub_u32 v164, v115, v164
    v_lshrrev_b32 v141, 2, v141
    v_lshrrev_b32 v164, 2, v164
    buffer_load_dwordx4 v138, s[48:51], 0 offen lds
    s_waitcnt vmcnt(7)
    ds_read_b64_tr_b16 a[144:145], v131 offset:0
    ds_read_b64_tr_b16 a[146:147], v131 offset:768
    ds_read_b64_tr_b16 a[168:169], v131 offset:32
    ds_read_b64_tr_b16 a[170:171], v131 offset:800
    ds_read_b64_tr_b16 a[192:193], v131 offset:64
    ds_read_b64_tr_b16 a[194:195], v131 offset:832
    v_and_b32 v141, s5, v141
    v_and_b32 v164, s6, v164
    v_lshl_or_b32 v141, v141, 1, v164
    v_cmp_ne_u32 vcc, v141, v176
    v_cndmask_b32 v22, v174, v22, s[88:89]
    v_cndmask_b32 v24, v174, v24, s[88:89]
    v_cndmask_b32 v115, 0, v254, vcc
    v_add_f32 v57, v57, v115
    buffer_load_dwordx4 v140, s[48:51], 0 offen offset:1024 lds
    v_cmp_ne_u32 vcc, v141, v255
    v_mov_b32_dpp v23, v25 quad_perm:[0,1,2,3] row_mask:0x2 bank_mask:0xf
    v_cndmask_b32 v26, v174, v26, s[88:89]
    v_cndmask_b32 v115, 0, v254, vcc
    v_add_f32 v69, v69, v115
    v_cmp_ne_u32 vcc, v141, v177
    v_mov_b32_dpp v23, v27 quad_perm:[0,1,2,3] row_mask:0x4 bank_mask:0xf
    v_mov_b32 v134, 0
    v_cndmask_b32 v115, 0, v254, vcc
    v_add_f32 v81, v81, v115
    ds_read_b128 v[126:129], v162 offset:0
    ds_read_b128 v[234:237], v163 offset:0
    ds_read_b128 v[118:121], v162 offset:128
    buffer_load_dwordx4 v146, s[48:51], 0 offen offset:2048 lds
    ds_read_b128 v[142:145], v163 offset:128
    s_add_u32 s48, s48, 36864
    s_addc_u32 s49, s49, 0
    ds_read_b128 v[170:173], v162 offset:256
    s_add_u32 m0, s68, 0
    s_waitcnt lgkmcnt(5)
    ds_read_b128 v[158:161], v163 offset:256
    v_mov_b32 v135, 0
    v_mov_b32 v136, 0
    v_mov_b32 v137, 0
    ds_write_b128 v165, v[134:137] offset:16
    s_waitcnt vmcnt(6)
    buffer_load_dwordx4 v138, s[48:51], 0 offen lds
    s_waitcnt lgkmcnt(6)
    v_mfma_f32_16x16x32_bf16 v[122:125], a[72:75], v[126:129], 0
    s_waitcnt lgkmcnt(5)
    v_mfma_f32_16x16x32_bf16 v[122:125], a[76:79], v[234:237], v[122:125]
    s_waitcnt lgkmcnt(4)
    ds_read_b64_tr_b16 a[148:149], v131 offset:3072
    ds_read_b64_tr_b16 a[150:151], v131 offset:3840
    v_mfma_f32_16x16x32_bf16 v[122:125], a[80:83], v[118:121], v[122:125]
    s_waitcnt lgkmcnt(4)
    ds_read_b64_tr_b16 a[172:173], v131 offset:3104
    ds_read_b64_tr_b16 a[174:175], v131 offset:3872
    v_mfma_f32_16x16x32_bf16 v[122:125], a[84:87], v[142:145], v[122:125]
    s_waitcnt lgkmcnt(5)
    ds_read_b64_tr_b16 a[196:197], v131 offset:3136
    buffer_load_dwordx4 v140, s[48:51], 0 offen offset:1024 lds
    v_mfma_f32_16x16x32_bf16 v[122:125], a[88:91], v[170:173], v[122:125]
    ds_read_b64_tr_b16 a[198:199], v131 offset:3904
    v_mfma_f32_16x16x32_bf16 v[122:125], a[92:95], v[158:161], v[122:125]
    ds_write_b64 v165, v[134:135] offset:56
    v_mfma_f32_16x16x32_bf16 v[150:153], a[96:99], v[126:129], 0
    v_mfma_f32_16x16x32_bf16 v[150:153], a[100:103], v[234:237], v[150:153]
    ds_write_b64 v165, v[134:135] offset:64
    v_mfma_f32_16x16x32_bf16 v[150:153], a[104:107], v[118:121], v[150:153]
    s_waitcnt lgkmcnt(6)
    buffer_load_dwordx4 v146, s[48:51], 0 offen offset:2048 lds
    s_add_u32 s48, s48, 36864
    v_mfma_f32_16x16x32_bf16 v[150:153], a[108:111], v[142:145], v[150:153]
    s_addc_u32 s49, s49, 0
    ds_read_b128 v[182:185], v162 offset:6144
    v_fma_f32 v115, v122, v122, s32
    v_mfma_f32_16x16x32_bf16 v[150:153], a[112:115], v[170:173], v[150:153]
    s_add_u32 m0, s68, 3072
    ds_read_b128 v[206:209], v163 offset:6144
    v_fmac_f32 v115, v123, v123
    v_mfma_f32_16x16x32_bf16 v[150:153], a[116:119], v[158:161], v[150:153]
    s_waitcnt lgkmcnt(4)
    s_waitcnt vmcnt(6)
    ds_read_b64_tr_b16 a[152:153], v133 offset:0
    v_mfma_f32_16x16x32_bf16 v[190:193], a[120:123], v[126:129], 0
    ds_read_b64_tr_b16 a[154:155], v133 offset:768
    ds_read_b64_tr_b16 a[176:177], v133 offset:32
    v_mfma_f32_16x16x32_bf16 v[190:193], a[124:127], v[234:237], v[190:193]
    buffer_load_dwordx4 v138, s[48:51], 0 offen lds
    ds_read_b64_tr_b16 a[178:179], v133 offset:800
    v_mfma_f32_16x16x32_bf16 v[190:193], a[128:131], v[118:121], v[190:193]
    ds_read_b64_tr_b16 a[200:201], v133 offset:64
    ds_read_b64_tr_b16 a[202:203], v133 offset:832
    v_mfma_f32_16x16x32_bf16 v[190:193], a[132:135], v[142:145], v[190:193]
    ds_read_b128 v[198:201], v162 offset:6272
    ds_read_b128 v[194:197], v163 offset:6272
    v_mfma_f32_16x16x32_bf16 v[190:193], a[136:139], v[170:173], v[190:193]
    ds_read_b128 v[202:205], v162 offset:6400
    ds_read_b128 v[210:213], v163 offset:6400
    v_mfma_f32_16x16x32_bf16 v[190:193], a[140:143], v[158:161], v[190:193]
    s_waitcnt lgkmcnt(11)
    v_fmac_f32 v115, v124, v124
    v_fmac_f32 v115, v125, v125
    v_mfma_f32_16x16x32_bf16 v[214:217], a[72:75], v[182:185], 0
    s_waitcnt lgkmcnt(10)
    buffer_load_dwordx4 v140, s[48:51], 0 offen offset:1024 lds
    v_fmac_f32 v115, v150, v150
    v_mfma_f32_16x16x32_bf16 v[214:217], a[76:79], v[206:209], v[214:217]
    s_waitcnt lgkmcnt(9)
    ds_write_b128 v168, v[134:137] offset:16
    v_mfma_f32_16x16x32_bf16 v[218:221], a[96:99], v[182:185], 0
    s_waitcnt lgkmcnt(7)
    v_fmac_f32 v115, v151, v151
    v_fmac_f32 v115, v152, v152
    v_mfma_f32_16x16x32_bf16 v[218:221], a[100:103], v[206:209], v[218:221]
    s_waitcnt lgkmcnt(5)
    v_fmac_f32 v115, v153, v153
    v_fmac_f32 v115, v190, v190
    v_mfma_f32_16x16x32_bf16 v[222:225], a[120:123], v[182:185], 0
    s_waitcnt lgkmcnt(3)
    buffer_load_dwordx4 v146, s[48:51], 0 offen offset:2048 lds
    v_fmac_f32 v115, v191, v191
    v_mfma_f32_16x16x32_bf16 v[214:217], a[80:83], v[198:201], v[214:217]
    s_add_u32 m0, s28, 8192
    ds_write_b64 v168, v[134:135] offset:56
    s_waitcnt vmcnt(6)
    v_mfma_f32_16x16x32_bf16 v[214:217], a[84:87], v[194:197], v[214:217]
    s_waitcnt lgkmcnt(2)
    v_fmac_f32 v115, v192, v192
    v_fmac_f32 v115, v193, v193
    v_mfma_f32_16x16x32_bf16 v[214:217], a[88:91], v[202:205], v[214:217]
    ds_read_b64_tr_b16 a[156:157], v133 offset:3072
    ds_read_b64_tr_b16 a[158:159], v133 offset:3840
    v_mfma_f32_16x16x32_bf16 v[214:217], a[92:95], v[210:213], v[214:217]
    buffer_load_dwordx4 v12, s[8:11], s25 offen nt lds
    v_mfma_f32_16x16x32_bf16 v[218:221], a[104:107], v[198:201], v[218:221]
    s_add_u32 m0, s28, 12288
    ds_read_b64_tr_b16 a[180:181], v133 offset:3104
    ds_read_b64_tr_b16 a[182:183], v133 offset:3872
    v_mfma_f32_16x16x32_bf16 v[218:221], a[108:111], v[194:197], v[218:221]
    ds_read_b64_tr_b16 a[204:205], v133 offset:3136
    ds_read_b64_tr_b16 a[206:207], v133 offset:3904
    v_mfma_f32_16x16x32_bf16 v[218:221], a[112:115], v[202:205], v[218:221]
    ds_write_b64 v168, v[134:135] offset:64
    v_mfma_f32_16x16x32_bf16 v[218:221], a[116:119], v[210:213], v[218:221]
    v_fma_f32 v164, v214, v214, s32
    v_fmac_f32 v164, v215, v215
    v_mfma_f32_16x16x32_bf16 v[222:225], a[124:127], v[206:209], v[222:225]
    buffer_load_dwordx4 v13, s[8:11], s25 offen nt lds
    v_mfma_f32_16x16x32_bf16 v[222:225], a[128:131], v[198:201], v[222:225]
    s_add_u32 m0, s29, 0
    v_fmac_f32 v164, v216, v216
    v_fmac_f32 v164, v217, v217
    v_mfma_f32_16x16x32_bf16 v[222:225], a[132:135], v[194:197], v[222:225]
    s_waitcnt lgkmcnt(5)
    v_fmac_f32 v164, v218, v218
    v_fmac_f32 v164, v219, v219
    v_mfma_f32_16x16x32_bf16 v[222:225], a[136:139], v[202:205], v[222:225]
    s_waitcnt lgkmcnt(4)
    v_fmac_f32 v164, v220, v220
    v_fmac_f32 v164, v221, v221
    v_mfma_f32_16x16x32_bf16 v[222:225], a[140:143], v[210:213], v[222:225]
    s_waitcnt lgkmcnt(2)
    v_mfma_f32_16x16x32_bf16 v[146:149], a[0:3], v[126:129], 0
    s_waitcnt lgkmcnt(0)
    buffer_load_dwordx4 v14, s[8:11], s25 offen nt lds
    v_mfma_f32_16x16x32_bf16 v[146:149], a[4:7], v[234:237], v[146:149]
    s_add_u32 m0, s69, 0
    s_lshr_b32 s10, s17, 1
    s_cselect_b32 s10, s36, 0
    v_mfma_f32_16x16x32_bf16 v[146:149], a[8:11], v[118:121], v[146:149]
    s_waitcnt vmcnt(6)
    ds_read_b64_tr_b16 a[160:161], v131 offset:0
    ds_read_b64_tr_b16 a[162:163], v131 offset:768
    v_mfma_f32_16x16x32_bf16 v[146:149], a[12:15], v[142:145], v[146:149]
    s_mov_b32 s25, s24
    ds_read_b64_tr_b16 a[184:185], v131 offset:32
    ds_read_b64_tr_b16 a[186:187], v131 offset:800
    v_mfma_f32_16x16x32_bf16 v[146:149], a[16:19], v[170:173], v[146:149]
    ds_read_b64_tr_b16 a[208:209], v131 offset:64
    ds_read_b64_tr_b16 a[210:211], v131 offset:832
    v_mfma_f32_16x16x32_bf16 v[146:149], a[20:23], v[158:161], v[146:149]
    buffer_load_dwordx4 v180, s[52:55], 0 offen lds
    v_fmac_f32 v164, v222, v222
    v_mfma_f32_16x16x32_bf16 v[226:229], a[24:27], v[126:129], 0
    v_fmac_f32 v164, v223, v223
    v_fmac_f32 v164, v224, v224
    v_mfma_f32_16x16x32_bf16 v[226:229], a[28:31], v[234:237], v[226:229]
    v_fmac_f32 v164, v225, v225
    v_xor_b32 v254, 65536, v2
    v_mfma_f32_16x16x32_bf16 v[226:229], a[32:35], v[118:121], v[226:229]
    v_fma_f32 v176, v146, v146, s32
    v_fmac_f32 v176, v147, v147
    v_mfma_f32_16x16x32_bf16 v[226:229], a[36:39], v[142:145], v[226:229]
    v_fmac_f32 v176, v148, v148
    v_fmac_f32 v176, v149, v149
    v_mfma_f32_16x16x32_bf16 v[226:229], a[40:43], v[170:173], v[226:229]
    s_waitcnt lgkmcnt(4)
    buffer_load_dwordx4 v181, s[52:55], 0 offen offset:1024 lds
    v_lshrrev_b32 v154, 2, v254
    v_mfma_f32_16x16x32_bf16 v[226:229], a[44:47], v[158:161], v[226:229]
    s_waitcnt lgkmcnt(2)
    v_lshrrev_b32 v177, 8, v254
    v_lshl_add_u32 v255, s16, 2, v254
    v_mfma_f32_16x16x32_bf16 v[230:233], a[48:51], v[126:129], 0
    s_waitcnt lgkmcnt(0)
    v_add_u32 v154, 62784, v154
    v_lshlrev_b32 v177, 4, v177
    v_mfma_f32_16x16x32_bf16 v[230:233], a[52:55], v[234:237], v[230:233]
    v_fmac_f32 v176, v226, v226
    v_fmac_f32 v176, v227, v227
    v_mfma_f32_16x16x32_bf16 v[230:233], a[56:59], v[118:121], v[230:233]
    v_fmac_f32 v176, v228, v228
    v_fmac_f32 v176, v229, v229
    v_mfma_f32_16x16x32_bf16 v[230:233], a[60:63], v[142:145], v[230:233]
    buffer_load_dwordx4 v139, s[52:55], 0 offen offset:2048 lds
    v_add_u32 v177, 62784, v177
    v_mfma_f32_16x16x32_bf16 v[230:233], a[64:67], v[170:173], v[230:233]
    s_add_u32 s52, s52, 12288
    v_or_b32 v238, v32, v33
    v_and_b32 v238, 0xffff, v238
    s_waitcnt vmcnt(6)
    v_mfma_f32_16x16x32_bf16 v[230:233], a[68:71], v[158:161], v[230:233]
    s_addc_u32 s53, s53, 0
    ds_read_b64_tr_b16 a[164:165], v131 offset:3072
    ds_read_b64_tr_b16 a[166:167], v131 offset:3840
    v_mfma_f32_16x16x32_bf16 v[142:145], a[0:3], v[182:185], 0
    s_add_u32 m0, s69, 3072
    ds_read_b64_tr_b16 a[188:189], v131 offset:3104
    ds_read_b64_tr_b16 a[190:191], v131 offset:3872
    v_mfma_f32_16x16x32_bf16 v[142:145], a[4:7], v[206:209], v[142:145]
    ds_read_b64_tr_b16 a[212:213], v131 offset:3136
    buffer_load_dwordx4 v180, s[52:55], 0 offen lds
    v_mfma_f32_16x16x32_bf16 v[142:145], a[8:11], v[198:201], v[142:145]
    ds_read_b64_tr_b16 a[214:215], v131 offset:3904
    v_fmac_f32 v176, v230, v230
    v_mfma_f32_16x16x32_bf16 v[142:145], a[12:15], v[194:197], v[142:145]
    v_fmac_f32 v176, v231, v231
    v_fmac_f32 v176, v232, v232
    v_mfma_f32_16x16x32_bf16 v[142:145], a[16:19], v[202:205], v[142:145]
    v_fmac_f32 v176, v233, v233
    v_cvt_pk_bf16_f32 v36, v176, v115
    v_mfma_f32_16x16x32_bf16 v[142:145], a[20:23], v[210:213], v[142:145]
    v_lshl_or_b32 v238, v238, 16, v238
    v_or_b32 v239, v32, v33
    v_mfma_f32_16x16x32_bf16 v[242:245], v[32:35], v[36:39], 0
    buffer_load_dwordx4 v181, s[52:55], 0 offen offset:1024 lds
    v_and_b32 v239, 0xffff, v239
    v_mfma_f32_16x16x32_bf16 v[246:249], a[24:27], v[182:185], 0
    s_waitcnt lgkmcnt(4)
    v_lshl_or_b32 v239, v239, 16, v239
    v_or_b32 v240, v32, v33
    v_mfma_f32_16x16x32_bf16 v[246:249], a[28:31], v[206:209], v[246:249]
    s_waitcnt lgkmcnt(2)
    v_rsq_f32 v243, v243
    v_mfma_f32_16x16x32_bf16 v[246:249], a[32:35], v[198:201], v[246:249]
    s_waitcnt lgkmcnt(1)
    v_rsq_f32 v242, v242
    v_mfma_f32_16x16x32_bf16 v[246:249], a[36:39], v[194:197], v[246:249]
    s_waitcnt lgkmcnt(0)
    ds_read_b128 v[186:189], v0 offset:20480
    v_mul_f32 v242, s31, v242
    v_mfma_f32_16x16x32_bf16 v[246:249], a[40:43], v[202:205], v[246:249]
    buffer_load_dwordx4 v139, s[52:55], 0 offen offset:2048 lds
    ds_read_b128 v[118:121], v1 offset:20480
    v_mfma_f32_16x16x32_bf16 v[246:249], a[44:47], v[210:213], v[246:249]
    s_add_u32 s52, s52, 12288
    ds_read_b128 v[234:237], v0 offset:20608
    v_mul_f32 v122, v243, v122
    v_mfma_f32_16x16x32_bf16 v[250:253], a[48:51], v[182:185], 0
    s_addc_u32 s53, s53, 0
    ds_read_b128 v[158:161], v1 offset:20608
    v_mul_f32 v123, v243, v123
    v_mfma_f32_16x16x32_bf16 v[250:253], a[52:55], v[206:209], v[250:253]
    s_add_u32 m0, s68, 0
    ds_read_b128 v[182:185], v0 offset:20736
    v_cvt_pk_f16_f32 v130, v122, v123
    v_mfma_f32_16x16x32_bf16 v[250:253], a[56:59], v[198:201], v[250:253]
    ds_read_b128 v[206:209], v1 offset:20736
    v_mul_f32 v124, v243, v124
    v_mfma_f32_16x16x32_bf16 v[250:253], a[60:63], v[194:197], v[250:253]
    buffer_load_dwordx4 v180, s[52:55], 0 offen lds
    v_mul_f32 v125, v243, v125
    v_mfma_f32_16x16x32_bf16 v[250:253], a[64:67], v[202:205], v[250:253]
    v_cvt_pk_f16_f32 v131, v124, v125
    v_mul_f32 v150, v243, v150
    v_mfma_f32_16x16x32_bf16 v[250:253], a[68:71], v[210:213], v[250:253]
    s_waitcnt lgkmcnt(5)
    v_mul_f32 v151, v243, v151
    v_cvt_pk_f16_f32 v132, v150, v151
    v_mfma_f32_16x16x32_bf16 v[134:137], a[96:99], v[186:189], 0
    s_waitcnt lgkmcnt(4)
    v_mul_f32 v152, v243, v152
    v_mul_f32 v153, v243, v153
    v_mfma_f32_16x16x32_bf16 v[134:137], a[100:103], v[118:121], v[134:137]
    s_waitcnt lgkmcnt(3)
    v_cvt_pk_f16_f32 v133, v152, v153
    v_mul_f32 v190, v243, v190
    v_mfma_f32_16x16x32_bf16 v[134:137], a[104:107], v[234:237], v[134:137]
    s_waitcnt lgkmcnt(2)
    ds_write_b128 v165, v[130:133]
    v_mfma_f32_16x16x32_bf16 v[134:137], a[108:111], v[158:161], v[134:137]
    s_waitcnt lgkmcnt(1)
    v_mul_f32 v191, v243, v191
    v_cvt_pk_f16_f32 v212, v190, v191
    v_mfma_f32_16x16x32_bf16 v[134:137], a[112:115], v[182:185], v[134:137]
    v_mul_f32 v192, v243, v192
    v_mul_f32 v193, v243, v193
    v_mfma_f32_16x16x32_bf16 v[134:137], a[116:119], v[206:209], v[134:137]
    v_cvt_pk_f16_f32 v213, v192, v193
    v_mul_f32 v146, v242, v146
    v_mfma_f32_16x16x32_bf16 v[170:173], a[120:123], v[186:189], 0
    ds_write_b64 v165, v[212:213] offset:48
    v_mfma_f32_16x16x32_bf16 v[170:173], a[124:127], v[118:121], v[170:173]
    v_mul_f32 v147, v242, v147
    v_cvt_pk_f16_f32 v130, v146, v147
    v_mfma_f32_16x16x32_bf16 v[170:173], a[128:131], v[234:237], v[170:173]
    v_mul_f32 v148, v242, v148
    v_mul_f32 v149, v242, v149
    v_mfma_f32_16x16x32_bf16 v[170:173], a[132:135], v[158:161], v[170:173]
    v_cvt_pk_f16_f32 v131, v148, v149
    v_mul_f32 v226, v242, v226
    v_mfma_f32_16x16x32_bf16 v[170:173], a[136:139], v[182:185], v[170:173]
    v_mul_f32 v227, v242, v227
    v_cvt_pk_f16_f32 v132, v226, v227
    v_mfma_f32_16x16x32_bf16 v[170:173], a[140:143], v[206:209], v[170:173]
    v_mul_f32 v228, v242, v228
    v_mul_f32 v229, v242, v229
    v_mfma_f32_16x16x32_bf16 v[126:129], a[24:27], v[186:189], 0
    v_cvt_pk_f16_f32 v133, v228, v229
    v_mul_f32 v230, v242, v230
    v_mfma_f32_16x16x32_bf16 v[126:129], a[28:31], v[118:121], v[126:129]
    ds_write_b128 v165, v[130:133] offset:32
    v_mfma_f32_16x16x32_bf16 v[130:133], a[72:75], v[186:189], 0
    v_mul_f32 v231, v242, v231
    v_cvt_pk_f16_f32 v210, v230, v231
    v_mfma_f32_16x16x32_bf16 v[130:133], a[76:79], v[118:121], v[130:133]
    v_mul_f32 v232, v242, v232
    v_mul_f32 v233, v242, v233
    v_mfma_f32_16x16x32_bf16 v[130:133], a[80:83], v[234:237], v[130:133]
    v_cvt_pk_f16_f32 v211, v232, v233
    v_mul_f32 v146, v146, v122
    v_mfma_f32_16x16x32_bf16 v[130:133], a[84:87], v[158:161], v[130:133]
    ds_write_b64 v165, v[210:211] offset:72
    v_mfma_f32_16x16x32_bf16 v[130:133], a[88:91], v[182:185], v[130:133]
    v_fmac_f32 v146, v147, v123
    v_fmac_f32 v146, v148, v124
    v_mfma_f32_16x16x32_bf16 v[130:133], a[92:95], v[206:209], v[130:133]
    v_fmac_f32 v146, v149, v125
    v_fmac_f32 v146, v226, v150
    v_mfma_f32_16x16x32_bf16 v[126:129], a[32:35], v[234:237], v[126:129]
    v_fmac_f32 v146, v227, v151
    v_fmac_f32 v146, v228, v152
    v_mfma_f32_16x16x32_bf16 v[126:129], a[36:39], v[158:161], v[126:129]
    v_fmac_f32 v146, v229, v153
    v_fmac_f32 v146, v230, v190
    v_mfma_f32_16x16x32_bf16 v[126:129], a[40:43], v[182:185], v[126:129]
    v_fmac_f32 v146, v231, v191
    v_fmac_f32 v146, v232, v192
    v_mfma_f32_16x16x32_bf16 v[126:129], a[44:47], v[206:209], v[126:129]
    v_fmac_f32 v146, v233, v193
    v_mov_b32 v115, v146
    v_mfma_f32_16x16x32_bf16 v[122:125], a[48:51], v[186:189], 0
    v_lshrrev_b32 v240, 16, v240
    v_lshl_or_b32 v240, v240, 16, v240
    v_mfma_f32_16x16x32_bf16 v[122:125], a[52:55], v[118:121], v[122:125]
    v_permlane32_swap_b32 v146, v115
    v_mfma_f32_16x16x32_bf16 v[122:125], a[56:59], v[234:237], v[122:125]
    v_add_f32 v146, v146, v115
    v_mov_b32 v115, v146
    v_mfma_f32_16x16x32_bf16 v[122:125], a[60:63], v[158:161], v[122:125]
    v_or_b32 v241, v32, v33
    v_lshrrev_b32 v241, 16, v241
    v_mfma_f32_16x16x32_bf16 v[122:125], a[64:67], v[182:185], v[122:125]
    v_permlane16_swap_b32 v146, v115
    v_mfma_f32_16x16x32_bf16 v[122:125], a[68:71], v[206:209], v[122:125]
    v_add_f32 v146, v146, v115
    v_add_f32 v146, s39, v146
    v_mfma_f32_16x16x32_bf16 v[150:153], v[186:189], a[144:147], 0
    v_mov_b32 v147, v174
    v_mov_b32 v148, v174
    v_mfma_f32_16x16x32_bf16 v[150:153], v[118:121], a[148:151], v[150:153]
    v_mov_b32 v149, v174
    v_cndmask_b32 v146, v174, v146, s[88:89]
    v_mfma_f32_16x16x32_bf16 v[150:153], v[234:237], a[152:155], v[150:153]
    ds_write_b128 v166, v[146:149] offset:192
    v_mfma_f32_16x16x32_bf16 v[150:153], v[158:161], a[156:159], v[150:153]
    v_lshl_or_b32 v241, v241, 16, v241
    v_fma_f32 v115, v142, v142, s32
    v_mfma_f32_16x16x32_bf16 v[150:153], v[182:185], a[160:163], v[150:153]
    v_fmac_f32 v115, v143, v143
    v_fmac_f32 v115, v144, v144
    v_mfma_f32_16x16x32_bf16 v[150:153], v[206:209], a[164:167], v[150:153]
    v_fmac_f32 v115, v145, v145
    v_fmac_f32 v115, v246, v246
    v_mfma_f32_16x16x32_bf16 v[146:149], v[186:189], a[168:171], 0
    v_fmac_f32 v115, v247, v247
    v_fmac_f32 v115, v248, v248
    v_mfma_f32_16x16x32_bf16 v[146:149], v[118:121], a[172:175], v[146:149]
    v_fmac_f32 v115, v249, v249
    v_fmac_f32 v115, v250, v250
    v_mfma_f32_16x16x32_bf16 v[146:149], v[234:237], a[176:179], v[146:149]
    v_fmac_f32 v115, v251, v251
    v_fmac_f32 v115, v252, v252
    v_mfma_f32_16x16x32_bf16 v[146:149], v[158:161], a[180:183], v[146:149]
    ds_read_b128 v[190:193], v162 offset:0
    v_fmac_f32 v115, v253, v253
    v_mfma_f32_16x16x32_bf16 v[146:149], v[182:185], a[184:187], v[146:149]
    ds_read_b128 v[210:213], v163 offset:0
    v_cvt_pk_bf16_f32 v36, v115, v164
    v_mfma_f32_16x16x32_bf16 v[146:149], v[206:209], a[188:191], v[146:149]
    ds_read_b128 v[202:205], v162 offset:128
    v_fma_f32 v115, v130, v130, s32
    v_fmac_f32 v115, v131, v131
    v_fmac_f32 v115, v132, v132
    v_fmac_f32 v115, v133, v133
    v_fmac_f32 v115, v134, v134
    v_fmac_f32 v115, v135, v135
    v_fmac_f32 v115, v136, v136
    v_fmac_f32 v115, v137, v137
    v_fmac_f32 v115, v170, v170
    v_fmac_f32 v115, v171, v171
    v_fmac_f32 v115, v172, v172
    v_fmac_f32 v115, v173, v173
    v_cvt_pk_bf16_f32 v150, v150, v151
    v_mfma_f32_16x16x32_bf16 v[194:197], v[32:35], v[36:39], 0
    v_cvt_pk_bf16_f32 v151, v152, v153
    v_cvt_pk_bf16_f32 v146, v146, v147
    v_mfma_f32_16x16x32_bf16 v[198:201], v[186:189], a[192:195], 0
    v_cvt_pk_bf16_f32 v147, v148, v149
    v_xor_b32 v2, 65536, v2
    v_mfma_f32_16x16x32_bf16 v[198:201], v[118:121], a[196:199], v[198:201]
    s_waitcnt lgkmcnt(2)
    v_mfma_f32_16x16x32_bf16 v[198:201], v[234:237], a[200:203], v[198:201]
    s_waitcnt lgkmcnt(1)
    v_rsq_f32 v195, v195
    v_mfma_f32_16x16x32_bf16 v[198:201], v[158:161], a[204:207], v[198:201]
    s_waitcnt lgkmcnt(0)
    v_rsq_f32 v194, v194
    v_mfma_f32_16x16x32_bf16 v[198:201], v[182:185], a[208:211], v[198:201]
    v_mul_f32 v194, s31, v194
    v_mul_f32 v214, v195, v214
    v_mfma_f32_16x16x32_bf16 v[198:201], v[206:209], a[212:215], v[198:201]
    v_mul_f32 v215, v195, v215
    v_cvt_pk_f16_f32 v226, v214, v215
    v_mul_f32 v216, v195, v216
    v_mul_f32 v217, v195, v217
    v_cvt_pk_f16_f32 v227, v216, v217
    v_mul_f32 v218, v195, v218
    v_mul_f32 v219, v195, v219
    v_cvt_pk_f16_f32 v228, v218, v219
    v_mul_f32 v220, v195, v220
    v_mul_f32 v221, v195, v221
    v_cvt_pk_f16_f32 v229, v220, v221
    v_mul_f32 v222, v195, v222
    v_mul_f32 v223, v195, v223
    v_cvt_pk_f16_f32 v244, v222, v223
    v_mul_f32 v224, v195, v224
    v_mul_f32 v225, v195, v225
    v_cvt_pk_f16_f32 v245, v224, v225
    v_mul_f32 v142, v194, v142
    v_mul_f32 v143, v194, v143
    v_cvt_pk_f16_f32 v230, v142, v143
    v_mul_f32 v144, v194, v144
    v_mul_f32 v145, v194, v145
    v_cvt_pk_f16_f32 v231, v144, v145
    v_mul_f32 v246, v194, v246
    v_mul_f32 v247, v194, v247
    v_cvt_pk_f16_f32 v232, v246, v247
    v_mul_f32 v248, v194, v248
    v_mul_f32 v249, v194, v249
    v_cvt_pk_f16_f32 v233, v248, v249
    v_mul_f32 v250, v194, v250
    v_mul_f32 v251, v194, v251
    v_cvt_pk_f16_f32 v242, v250, v251
    v_mul_f32 v252, v194, v252
    v_mul_f32 v253, v194, v253
    v_cvt_pk_f16_f32 v243, v252, v253
    v_mul_f32 v214, v142, v214
    v_fmac_f32 v214, v143, v215
    v_fmac_f32 v214, v144, v216
    v_fmac_f32 v214, v145, v217
    v_fmac_f32 v214, v246, v218
    v_fmac_f32 v214, v247, v219
    v_fmac_f32 v214, v248, v220
    v_mfma_f32_16x16x32_bf16 v[194:197], v[190:193], a[144:147], 0
    ds_write_b128 v168, v[226:229]
    v_mfma_f32_16x16x32_bf16 v[142:145], a[0:3], v[186:189], 0
    buffer_load_dwordx4 v181, s[52:55], 0 offen offset:1024 lds
    v_fmac_f32 v214, v249, v221
    v_mfma_f32_16x16x32_bf16 v[142:145], a[4:7], v[118:121], v[142:145]
    v_fmac_f32 v214, v250, v222
    v_fmac_f32 v214, v251, v223
    v_mfma_f32_16x16x32_bf16 v[142:145], a[8:11], v[234:237], v[142:145]
    ds_read_b128 v[118:121], v163 offset:128
    ds_read_b128 v[234:237], v162 offset:256
    v_mfma_f32_16x16x32_bf16 v[142:145], a[12:15], v[158:161], v[142:145]
    ds_read_b128 v[158:161], v163 offset:256
    v_fmac_f32 v214, v252, v224
    v_mfma_f32_16x16x32_bf16 v[142:145], a[16:19], v[182:185], v[142:145]
    ds_write_b64 v168, v[244:245] offset:48
    v_mfma_f32_16x16x32_bf16 v[142:145], a[20:23], v[206:209], v[142:145]
    buffer_load_dwordx4 v139, s[52:55], 0 offen offset:2048 lds
    v_fmac_f32 v214, v253, v225
    v_mfma_f32_16x16x32_bf16 v[194:197], v[210:213], a[148:151], v[194:197]
    s_add_u32 s52, s52, 12288
    ds_write_b128 v168, v[230:233] offset:32
    v_mfma_f32_16x16x32_bf16 v[194:197], v[202:205], a[152:155], v[194:197]
    s_addc_u32 s53, s53, 0
    v_mov_b32 v176, v214
    v_fma_f32 v148, v142, v142, s32
    v_mfma_f32_16x16x32_bf16 v[182:185], v[190:193], a[168:171], 0
    s_add_u32 m0, s68, 3072
    v_permlane32_swap_b32 v214, v176
    v_mfma_f32_16x16x32_bf16 v[182:185], v[210:213], a[172:175], v[182:185]
    s_waitcnt lgkmcnt(3)
    buffer_load_dwordx4 v180, s[52:55], 0 offen lds
    v_add_f32 v214, v214, v176
    v_mfma_f32_16x16x32_bf16 v[194:197], v[118:121], a[156:159], v[194:197]
    s_mul_i32 s68, s78, 72
    ds_write_b64 v168, v[242:243] offset:72
    v_mfma_f32_16x16x32_bf16 v[194:197], v[234:237], a[160:163], v[194:197]
    s_waitcnt lgkmcnt(2)
    v_mov_b32 v176, v214
    v_fmac_f32 v148, v143, v143
    v_mfma_f32_16x16x32_bf16 v[194:197], v[158:161], a[164:167], v[194:197]
    s_sub_u32 s68, s77, s68
    v_permlane16_swap_b32 v214, v176
    v_mfma_f32_16x16x32_bf16 v[182:185], v[202:205], a[176:179], v[182:185]
    s_mul_i32 s78, s78, 1373568
    v_add_f32 v214, v214, v176
    v_add_f32 v214, s39, v214
    v_mfma_f32_16x16x32_bf16 v[182:185], v[118:121], a[180:183], v[182:185]
    buffer_load_dwordx4 v181, s[52:55], 0 offen offset:1024 lds
    ds_read_b128 v[206:209], v162 offset:6144
    v_mfma_f32_16x16x32_bf16 v[182:185], v[234:237], a[184:187], v[182:185]
    s_mul_i32 s77, s68, 2688
    ds_read_b128 v[186:189], v163 offset:6144
    v_mov_b32 v215, v174
    v_mfma_f32_16x16x32_bf16 v[182:185], v[158:161], a[188:191], v[182:185]
    s_add_u32 s77, s77, s78
    ds_read_b128 v[222:225], v162 offset:6272
    v_mov_b32 v216, v174
    v_mfma_f32_16x16x32_bf16 v[218:221], v[190:193], a[192:195], 0
    ds_read_b128 v[246:249], v163 offset:6272
    v_mov_b32 v217, v174
    v_mfma_f32_16x16x32_bf16 v[218:221], v[210:213], a[196:199], v[218:221]
    ds_read_b128 v[190:193], v162 offset:6400
    v_cndmask_b32 v214, v174, v214, s[88:89]
    v_mfma_f32_16x16x32_bf16 v[218:221], v[202:205], a[200:203], v[218:221]
    buffer_load_dwordx4 v139, s[52:55], 0 offen offset:2048 lds
    ds_read_b128 v[210:213], v163 offset:6400
    v_mfma_f32_16x16x32_bf16 v[218:221], v[118:121], a[204:207], v[218:221]
    s_add_u32 s52, s52, 12288
    ds_write_b128 v169, v[214:217] offset:192
    s_waitcnt vmcnt(9)
    v_mfma_f32_16x16x32_bf16 v[218:221], v[234:237], a[208:211], v[218:221]
    s_waitcnt lgkmcnt(6)
    v_fmac_f32 v148, v144, v144
    v_fmac_f32 v148, v145, v145
    v_mfma_f32_16x16x32_bf16 v[218:221], v[158:161], a[212:215], v[218:221]
    s_addc_u32 s53, s53, 0
    v_fmac_f32 v148, v126, v126
    v_fmac_f32 v148, v127, v127
    v_mfma_f32_16x16x32_bf16 v[162:165], v[206:209], a[144:147], 0
    s_waitcnt lgkmcnt(4)
    ds_read_b64 a[216:217], v116 offset:0
    ds_read_b64 a[218:219], v116 offset:1536
    v_mfma_f32_16x16x32_bf16 v[162:165], v[186:189], a[148:151], v[162:165]
    s_add_u32 m0, s69, 0
    ds_read_b64 a[240:241], v116 offset:8
    ds_read_b64 a[242:243], v116 offset:1544
    v_mfma_f32_16x16x32_bf16 v[162:165], v[222:225], a[152:155], v[162:165]
    s_waitcnt lgkmcnt(6)
    ds_read_b64 v[90:91], v117 offset:0
    ds_read_b64 v[92:93], v117 offset:1536
    v_mfma_f32_16x16x32_bf16 v[162:165], v[246:249], a[156:159], v[162:165]
    s_waitcnt lgkmcnt(7)
    v_fmac_f32 v148, v128, v128
    v_fmac_f32 v148, v129, v129
    v_mfma_f32_16x16x32_bf16 v[162:165], v[190:193], a[160:163], v[162:165]
    v_fmac_f32 v148, v122, v122
    v_fmac_f32 v148, v123, v123
    v_mfma_f32_16x16x32_bf16 v[162:165], v[210:213], a[164:167], v[162:165]
    v_fmac_f32 v148, v124, v124
    v_fmac_f32 v148, v125, v125
    v_mfma_f32_16x16x32_bf16 v[118:121], v[206:209], a[168:171], 0
    v_cvt_pk_bf16_f32 v36, v148, v115
    v_cvt_pk_bf16_f32 v214, v198, v199
    v_mfma_f32_16x16x32_bf16 v[118:121], v[186:189], a[172:175], v[118:121]
    v_cvt_pk_bf16_f32 v215, v200, v201
    v_cvt_pk_bf16_f32 v194, v194, v194
    v_mfma_f32_16x16x32_bf16 v[158:161], v[32:35], v[36:39], 0
    s_waitcnt lgkmcnt(4)
    v_cvt_pk_bf16_f32 v195, v195, v195
    v_cvt_pk_bf16_f32 v196, v196, v196
    v_mfma_f32_16x16x32_bf16 v[234:237], v[238:241], a[216:219], 0
    s_waitcnt lgkmcnt(2)
    s_waitcnt vmcnt(6)
    ds_read_b64 a[232:233], v116 offset:3072
    v_mfma_f32_16x16x32_bf16 v[234:237], v[238:241], a[240:243], v[234:237]
    s_waitcnt lgkmcnt(1)
    buffer_load_dwordx4 v180, s[52:55], 0 offen lds
    ds_read_b64 a[220:221], v116 offset:4608
    v_mfma_f32_16x16x32_bf16 v[234:237], v[238:241], v[90:93], v[234:237]
    ds_read_b64 v[82:83], v116 offset:3080
    ds_read_b64 a[244:245], v116 offset:4616
    v_mfma_f32_16x16x32_bf16 v[118:121], v[222:225], a[176:179], v[118:121]
    ds_read_b64 v[106:107], v117 offset:3072
    ds_read_b64 v[94:95], v117 offset:4608
    v_mfma_f32_16x16x32_bf16 v[118:121], v[246:249], a[180:183], v[118:121]
    ds_write2_b32 v167, v194, v195 offset0:0 offset1:68
    v_mfma_f32_16x16x32_bf16 v[118:121], v[190:193], a[184:187], v[118:121]
    v_mov_b32 v115, v234
    v_mov_b32_dpp v115, v235 quad_perm:[0,1,2,3] row_mask:0x2 bank_mask:0xf
    v_mfma_f32_16x16x32_bf16 v[118:121], v[210:213], a[188:191], v[118:121]
    buffer_load_dwordx4 v181, s[52:55], 0 offen offset:1024 lds
    v_cvt_pk_bf16_f32 v197, v197, v197
    v_mfma_f32_16x16x32_bf16 v[234:237], v[206:209], a[192:195], 0
    ds_write2_b32 v167, v196, v197 offset0:136 offset1:204
    v_mfma_f32_16x16x32_bf16 v[234:237], v[186:189], a[196:199], v[234:237]
    s_waitcnt lgkmcnt(6)
    v_rsq_f32 v159, v159
    v_mfma_f32_16x16x32_bf16 v[234:237], v[222:225], a[200:203], v[234:237]
    s_waitcnt lgkmcnt(4)
    v_rsq_f32 v158, v158
    v_mfma_f32_16x16x32_bf16 v[234:237], v[246:249], a[204:207], v[234:237]
    s_waitcnt lgkmcnt(2)
    v_mul_f32 v158, s31, v158
    v_mul_f32 v130, v159, v130
    v_mfma_f32_16x16x32_bf16 v[234:237], v[190:193], a[208:211], v[234:237]
    buffer_load_dwordx4 v139, s[52:55], 0 offen offset:2048 lds
    v_mul_f32 v131, v159, v131
    v_mfma_f32_16x16x32_bf16 v[234:237], v[210:213], a[212:215], v[234:237]
    s_barrier
    s_barrier
    s_waitcnt vmcnt(6)
    ds_read_b64 a[222:223], v155 offset:0
    ds_read_b64 a[234:235], v155 offset:1536
    ds_read_b64 a[246:247], v155 offset:8
    ds_read_b64 v[84:85], v155 offset:1544
    ds_read_b64 v[96:97], v114 offset:0
    ds_read_b64 v[108:109], v114 offset:1536
    ds_read_b128 v[206:209], v0 offset:26624
    s_add_u32 s52, s52, 12288
    s_addc_u32 s53, s53, 0
    ds_read_b128 v[186:189], v1 offset:26624
    s_add_u32 m0, s69, 3072
    s_add_u32 s69, s77, 589824
    buffer_load_dwordx4 v180, s[52:55], 0 offen lds
    ds_read_b128 v[210:213], v0 offset:26752
    ds_read_b128 v[190:193], v1 offset:26752
    ds_read_b128 v[222:225], v0 offset:26880
    ds_read_b128 v[194:197], v1 offset:26880
    v_cvt_pk_f16_f32 v130, v130, v131
    v_mul_f32 v132, v159, v132
    s_waitcnt lgkmcnt(11)
    v_mfma_f32_16x16x32_bf16 v[198:201], v[238:241], a[220:223], 0
    s_waitcnt lgkmcnt(9)
    buffer_load_dwordx4 v181, s[52:55], 0 offen offset:1024 lds
    v_mul_f32 v133, v159, v133
    v_mfma_f32_16x16x32_bf16 v[198:201], v[238:241], a[244:247], v[198:201]
    s_waitcnt lgkmcnt(5)
    v_cvt_pk_f16_f32 v131, v132, v133
    v_mul_f32 v134, v159, v134
    v_mfma_f32_16x16x32_bf16 v[198:201], v[238:241], v[94:97], v[198:201]
    s_waitcnt lgkmcnt(4)
    v_mul_f32 v135, v159, v135
    v_cvt_pk_f16_f32 v132, v134, v135
    v_mfma_f32_16x16x32_bf16 v[202:205], v[238:241], a[232:235], 0
    s_waitcnt lgkmcnt(3)
    v_mul_f32 v136, v159, v136
    v_mul_f32 v137, v159, v137
    v_mfma_f32_16x16x32_bf16 v[202:205], v[238:241], v[82:85], v[202:205]
    s_waitcnt lgkmcnt(2)
    v_mov_b32 v148, v199
    v_cvt_pk_f16_f32 v133, v136, v137
    v_mfma_f32_16x16x32_bf16 v[202:205], v[238:241], v[106:109], v[202:205]
    s_waitcnt vmcnt(5)
    buffer_load_dwordx4 v139, s[52:55], 0 offen offset:2048 lds
    ds_read_b64 a[224:225], v155 offset:3072
    v_mfma_f32_16x16x32_bf16 v[138:141], a[72:75], v[206:209], 0
    s_add_u32 m0, s28, 65536
    ds_read_b64 a[226:227], v155 offset:4608
    ds_read_b64 a[248:249], v155 offset:3080
    v_mfma_f32_16x16x32_bf16 v[138:141], a[76:79], v[186:189], v[138:141]
    s_waitcnt lgkmcnt(3)
    ds_read_b64 a[250:251], v155 offset:4616
    ds_read_b64 v[98:99], v114 offset:3072
    v_mfma_f32_16x16x32_bf16 v[138:141], a[80:83], v[210:213], v[138:141]
    ds_read_b64 v[100:101], v114 offset:4608
    v_mov_b32_dpp v115, v202 quad_perm:[0,1,2,3] row_mask:0x4 bank_mask:0xf
    v_mfma_f32_16x16x32_bf16 v[138:141], a[84:87], v[190:193], v[138:141]
    v_mov_b32_dpp v115, v198 quad_perm:[0,1,2,3] row_mask:0x8 bank_mask:0xf
    v_mov_b32_dpp v148, v203 quad_perm:[0,1,2,3] row_mask:0x2 bank_mask:0xf
    v_mfma_f32_16x16x32_bf16 v[138:141], a[88:91], v[222:225], v[138:141]
    buffer_load_dwordx4 v10, s[8:11], s24 offen nt lds
    v_mfma_f32_16x16x32_bf16 v[138:141], a[92:95], v[194:197], v[138:141]
    s_add_u32 m0, s28, 69632
    ds_write_b32 v255, v115 offset:18432
    v_mfma_f32_16x16x32_bf16 v[134:137], a[96:99], v[206:209], 0
    v_mul_f32 v170, v159, v170
    v_mul_f32 v171, v159, v171
    v_mfma_f32_16x16x32_bf16 v[134:137], a[100:103], v[186:189], v[134:137]
    s_waitcnt lgkmcnt(6)
    v_cvt_pk_f16_f32 v200, v170, v171
    v_mul_f32 v172, v159, v172
    v_mfma_f32_16x16x32_bf16 v[134:137], a[104:107], v[210:213], v[134:137]
    s_waitcnt lgkmcnt(4)
    v_mul_f32 v173, v159, v173
    v_cvt_pk_f16_f32 v201, v172, v173
    v_mfma_f32_16x16x32_bf16 v[170:173], v[238:241], a[224:227], 0
    s_waitcnt lgkmcnt(2)
    buffer_load_dwordx4 v11, s[8:11], s24 offen nt lds
    v_mfma_f32_16x16x32_bf16 v[170:173], v[238:241], a[248:251], v[170:173]
    s_waitcnt lgkmcnt(1)
    v_mul_f32 v142, v158, v142
    v_mul_f32 v143, v158, v143
    v_mfma_f32_16x16x32_bf16 v[170:173], v[238:241], v[98:101], v[170:173]
    s_add_u32 m0, s28, 73728
    v_cvt_pk_f16_f32 v142, v142, v143
    v_mul_f32 v144, v158, v144
    v_mfma_f32_16x16x32_bf16 v[134:137], a[108:111], v[190:193], v[134:137]
    v_mul_f32 v145, v158, v145
    v_cvt_pk_f16_f32 v143, v144, v145
    v_mfma_f32_16x16x32_bf16 v[134:137], a[112:115], v[222:225], v[134:137]
    v_mul_f32 v126, v158, v126
    v_mov_b32_dpp v148, v170 quad_perm:[0,1,2,3] row_mask:0x4 bank_mask:0xf
    v_mfma_f32_16x16x32_bf16 v[134:137], a[116:119], v[194:197], v[134:137]
    buffer_load_dwordx4 v12, s[8:11], s24 offen nt lds
    v_mfma_f32_16x16x32_bf16 v[202:205], a[120:123], v[206:209], 0
    s_add_u32 m0, s28, 77824
    v_mov_b32_dpp v148, v171 quad_perm:[0,1,2,3] row_mask:0x8 bank_mask:0xf
    v_mul_f32 v127, v158, v127
    v_mfma_f32_16x16x32_bf16 v[202:205], a[124:127], v[186:189], v[202:205]
    ds_write_b32 v255, v148 offset:19456
    s_waitcnt vmcnt(6)
    v_mfma_f32_16x16x32_bf16 v[202:205], a[128:131], v[210:213], v[202:205]
    v_cvt_pk_f16_f32 v144, v126, v127
    v_mul_f32 v128, v158, v128
    v_mfma_f32_16x16x32_bf16 v[202:205], a[132:135], v[190:193], v[202:205]
    ds_read_b64 a[236:237], v116 offset:0
    ds_read_b64 a[228:229], v116 offset:1536
    v_mfma_f32_16x16x32_bf16 v[202:205], a[136:139], v[222:225], v[202:205]
    buffer_load_dwordx4 v13, s[8:11], s24 offen nt lds
    v_mfma_f32_16x16x32_bf16 v[202:205], a[140:143], v[194:197], v[202:205]
    s_add_u32 m0, s74, 0
    ds_read_b64 v[86:87], v116 offset:8
    ds_read_b64 a[252:253], v116 offset:1544
    v_mfma_f32_16x16x32_bf16 v[170:173], a[0:3], v[206:209], 0
    ds_read_b64 v[110:111], v117 offset:0
    ds_read_b64 v[102:103], v117 offset:1536
    v_mfma_f32_16x16x32_bf16 v[170:173], a[4:7], v[186:189], v[170:173]
    v_mul_f32 v129, v158, v129
    v_cvt_pk_f16_f32 v145, v128, v129
    v_mfma_f32_16x16x32_bf16 v[170:173], a[8:11], v[210:213], v[170:173]
    v_mul_f32 v122, v158, v122
    v_mul_f32 v123, v158, v123
    v_mfma_f32_16x16x32_bf16 v[170:173], a[12:15], v[190:193], v[170:173]
    buffer_load_dwordx4 v14, s[8:11], s24 offen nt lds
    v_mfma_f32_16x16x32_bf16 v[170:173], a[16:19], v[222:225], v[170:173]
    s_add_u32 s8, s60, s23
    v_cvt_pk_f16_f32 v198, v122, v123
    v_mul_f32 v124, v158, v124
    v_mfma_f32_16x16x32_bf16 v[170:173], a[20:23], v[194:197], v[170:173]
    s_addc_u32 s9, s61, 0
    v_mul_f32 v125, v158, v125
    v_cvt_pk_f16_f32 v199, v124, v125
    v_mfma_f32_16x16x32_bf16 v[122:125], a[24:27], v[206:209], 0
    s_sub_u32 s10, s36, s23
    v_cvt_pk_bf16_f32 v182, v182, v182
    v_cvt_pk_bf16_f32 v183, v183, v183
    v_mfma_f32_16x16x32_bf16 v[122:125], a[28:31], v[186:189], v[122:125]
    s_cmp_lt_u32 s34, s17
    ds_write2_b32 v167, v182, v183 offset0:16 offset1:84
    v_mfma_f32_16x16x32_bf16 v[122:125], a[32:35], v[210:213], v[122:125]
    s_cselect_b32 s10, s10, 0
    v_cvt_pk_bf16_f32 v184, v184, v184
    v_cvt_pk_bf16_f32 v185, v185, v185
    v_mfma_f32_16x16x32_bf16 v[122:125], a[36:39], v[190:193], v[122:125]
    s_waitcnt vmcnt(5)
    ds_read_b64 a[230:231], v116 offset:3072
    ds_read_b64 a[238:239], v116 offset:4608
    v_mfma_f32_16x16x32_bf16 v[122:125], a[40:43], v[222:225], v[122:125]
    s_add_u32 m0, s28, 0
    ds_read_b64 a[254:255], v116 offset:3080
    ds_read_b64 v[88:89], v116 offset:4616
    v_mfma_f32_16x16x32_bf16 v[122:125], a[44:47], v[194:197], v[122:125]
    s_mov_b32 s24, s23
    ds_read_b64 v[104:105], v117 offset:3072
    ds_read_b64 v[112:113], v117 offset:4608
    v_mfma_f32_16x16x32_bf16 v[114:117], a[48:51], v[206:209], 0
    s_add_u32 s23, s23, s21
    ds_write2_b32 v167, v184, v185 offset0:152 offset1:220
    v_mfma_f32_16x16x32_bf16 v[114:117], a[52:55], v[186:189], v[114:117]
    s_cmp_ge_u32 s19, 72
    v_cvt_pk_bf16_f32 v218, v218, v218
    v_cvt_pk_bf16_f32 v219, v219, v219
    v_mfma_f32_16x16x32_bf16 v[114:117], a[56:59], v[210:213], v[114:117]
    s_cselect_b32 s34, 72, 0
    ds_write2_b32 v167, v218, v219 offset0:32 offset1:100
    v_mfma_f32_16x16x32_bf16 v[114:117], a[60:63], v[190:193], v[114:117]
    s_cselect_b32 s35, s22, 0
    v_cvt_pk_bf16_f32 v220, v220, v220
    v_cvt_pk_bf16_f32 v221, v221, v221
    v_mfma_f32_16x16x32_bf16 v[114:117], a[64:67], v[222:225], v[114:117]
    s_waitcnt lgkmcnt(6)
    ds_write2_b32 v167, v220, v221 offset0:168 offset1:236
    v_mfma_f32_16x16x32_bf16 v[166:169], v[238:241], a[228:231], 0
    s_waitcnt lgkmcnt(5)
    v_cvt_pk_bf16_f32 v162, v162, v162
    v_cvt_pk_bf16_f32 v163, v163, v163
    v_mfma_f32_16x16x32_bf16 v[166:169], v[238:241], a[252:255], v[166:169]
    s_waitcnt lgkmcnt(3)
    ds_write2_b32 v175, v162, v163 offset0:0 offset1:68
    v_mfma_f32_16x16x32_bf16 v[166:169], v[238:241], v[102:105], v[166:169]
    s_sub_u32 s19, s19, s34
    v_cvt_pk_bf16_f32 v164, v164, v164
    v_cvt_pk_bf16_f32 v165, v165, v165
    v_mfma_f32_16x16x32_bf16 v[126:129], v[238:241], a[236:239], 0
    s_add_u32 s23, s23, s35
    ds_write2_b32 v175, v164, v165 offset0:136 offset1:204
    v_mfma_f32_16x16x32_bf16 v[126:129], v[238:241], v[86:89], v[126:129]
    v_cvt_pk_bf16_f32 v118, v118, v118
    v_cvt_pk_bf16_f32 v119, v119, v119
    v_mfma_f32_16x16x32_bf16 v[126:129], v[238:241], v[110:113], v[126:129]
    ds_write2_b32 v175, v118, v119 offset0:16 offset1:84
    v_mfma_f32_16x16x32_bf16 v[114:117], a[68:71], v[194:197], v[114:117]
    v_cvt_pk_bf16_f32 v120, v120, v120
    v_cvt_pk_bf16_f32 v121, v121, v121
    v_mfma_f32_16x16x32_bf16 v[162:165], v[206:209], a[144:147], 0
    ds_write2_b32 v175, v120, v121 offset0:152 offset1:220
    v_mfma_f32_16x16x32_bf16 v[162:165], v[186:189], a[148:151], v[162:165]
    v_cvt_pk_bf16_f32 v234, v234, v234
    v_mov_b32 v148, v126
    v_mfma_f32_16x16x32_bf16 v[162:165], v[210:213], a[152:155], v[162:165]
    v_mov_b32_dpp v148, v166 quad_perm:[0,1,2,3] row_mask:0x2 bank_mask:0xf
    v_mov_b32_dpp v148, v167 quad_perm:[0,1,2,3] row_mask:0x4 bank_mask:0xf
    v_mfma_f32_16x16x32_bf16 v[162:165], v[190:193], a[156:159], v[162:165]
    v_mov_b32_dpp v148, v127 quad_perm:[0,1,2,3] row_mask:0x8 bank_mask:0xf
    v_cvt_pk_bf16_f32 v235, v235, v235
    v_mfma_f32_16x16x32_bf16 v[162:165], v[222:225], a[160:163], v[162:165]
    ds_write_b32 v255, v148 offset:63552
    v_mfma_f32_16x16x32_bf16 v[162:165], v[194:197], a[164:167], v[162:165]
    v_cvt_pk_bf16_f32 v236, v236, v236
    v_cvt_pk_bf16_f32 v237, v237, v237
    v_mfma_f32_16x16x32_bf16 v[166:169], v[206:209], a[168:171], 0
    ds_write2_b32 v175, v234, v235 offset0:32 offset1:100
    v_mfma_f32_16x16x32_bf16 v[166:169], v[186:189], a[172:175], v[166:169]
    v_fma_f32 v255, v170, v170, s32
    v_fmac_f32 v255, v171, v171
    v_mfma_f32_16x16x32_bf16 v[166:169], v[210:213], a[176:179], v[166:169]
    ds_write2_b32 v175, v236, v237 offset0:168 offset1:236
    v_mfma_f32_16x16x32_bf16 v[166:169], v[190:193], a[180:183], v[166:169]
    v_cvt_pk_bf16_f32 v152, v162, v163
    v_cvt_pk_bf16_f32 v153, v164, v165
    v_mfma_f32_16x16x32_bf16 v[166:169], v[222:225], a[184:187], v[166:169]
    ds_read_b128 v[162:165], v0 offset:32768
    ds_read_b128 v[118:121], v1 offset:32768
    v_mfma_f32_16x16x32_bf16 v[166:169], v[194:197], a[188:191], v[166:169]
    s_waitcnt lgkmcnt(4)
    ds_read_b128 v[126:129], v0 offset:32896
    v_fmac_f32 v255, v172, v172
    v_mfma_f32_16x16x32_bf16 v[158:161], v[206:209], a[192:195], 0
    s_barrier
    ds_read_b128 v[206:209], v1 offset:32896
    ds_read_b128 v[234:237], v254 offset:18432
    v_mfma_f32_16x16x32_bf16 v[158:161], v[186:189], a[196:199], v[158:161]
    v_fmac_f32 v255, v173, v173
    v_fmac_f32 v255, v122, v122
    v_mfma_f32_16x16x32_bf16 v[158:161], v[210:213], a[200:203], v[158:161]
    ds_read_b128 v[182:185], v0 offset:33024
    ds_read_b128 v[186:189], v1 offset:33024
    v_mfma_f32_16x16x32_bf16 v[158:161], v[190:193], a[204:207], v[158:161]
    v_fmac_f32 v255, v123, v123
    v_fmac_f32 v255, v124, v124
    v_mfma_f32_16x16x32_bf16 v[158:161], v[222:225], a[208:211], v[158:161]
    ds_read_b128 v[190:193], v254 offset:19456
    ds_read_b128 v[222:225], v254 offset:63552
    v_mfma_f32_16x16x32_bf16 v[158:161], v[194:197], a[212:215], v[158:161]
    v_fmac_f32 v255, v125, v125
    v_fmac_f32 v255, v114, v114
    v_mfma_f32_16x16x32_f16 v[218:221], v[130:133], v[142:145], v[46:49]
    s_waitcnt lgkmcnt(7)
    v_fmac_f32 v255, v115, v115
    v_fmac_f32 v255, v116, v116
    v_mfma_f32_16x16x32_bf16 v[210:213], a[72:75], v[162:165], 0
    s_waitcnt lgkmcnt(6)
    v_fmac_f32 v255, v117, v117
    v_fma_f32 v254, v138, v138, s32
    v_mfma_f32_16x16x32_bf16 v[210:213], a[76:79], v[118:121], v[210:213]
    s_waitcnt lgkmcnt(4)
    v_add_f32 v234, v234, v235
    v_add_f32 v236, v236, v237
    v_mfma_f32_16x16x32_bf16 v[210:213], a[80:83], v[126:129], v[210:213]
    v_add_f32 v234, v234, v236
    v_mul_f32 v234, 0xbbaaaaab, v234
    v_mfma_f32_16x16x32_bf16 v[210:213], a[84:87], v[206:209], v[210:213]
    s_waitcnt lgkmcnt(2)
    ds_write_b32 v154, v234 offset:0
    v_mfma_f32_16x16x32_bf16 v[210:213], a[88:91], v[182:185], v[210:213]
    v_fmac_f32 v254, v139, v139
    v_fmac_f32 v254, v140, v140
    v_mfma_f32_16x16x32_bf16 v[210:213], a[92:95], v[186:189], v[210:213]
    s_waitcnt lgkmcnt(1)
    ds_read_b128 v[234:237], v177 offset:0
    ds_read_b128 v[194:197], v177 offset:64
    v_mfma_f32_16x16x32_bf16 v[238:241], a[96:99], v[162:165], 0
    v_add_f32 v190, v190, v191
    v_add_f32 v192, v192, v193
    v_mfma_f32_16x16x32_bf16 v[238:241], a[100:103], v[118:121], v[238:241]
    v_add_f32 v190, v190, v192
    v_mul_f32 v190, 0xbbaaaaab, v190
    v_mfma_f32_16x16x32_bf16 v[238:241], a[104:107], v[126:129], v[238:241]
    ds_write_b32 v154, v190 offset:256
    v_mfma_f32_16x16x32_bf16 v[238:241], a[108:111], v[206:209], v[238:241]
    v_add_f32 v222, v222, v223
    v_add_f32 v224, v224, v225
    v_mfma_f32_16x16x32_bf16 v[238:241], a[112:115], v[182:185], v[238:241]
    ds_read_b128 v[190:193], v5 offset:0
    ds_read_b128 v[246:249], v5 offset:16
    v_mfma_f32_16x16x32_bf16 v[238:241], a[116:119], v[186:189], v[238:241]
    ds_read_b128 v[250:253], v5 offset:48
    ds_read_b32 v180, v6 offset:192
    v_add_f32 v222, v222, v224
    v_mfma_f32_16x16x16_f16 v[218:221], v[200:201], v[198:199], v[218:221]
    v_mul_f32 v222, 0xbbaaaaab, v222
    ds_write_b32 v154, v222 offset:512
    v_fmac_f32 v254, v141, v141
    v_fmac_f32 v254, v134, v134
    v_fmac_f32 v254, v135, v135
    v_fmac_f32 v254, v136, v136
    v_fmac_f32 v254, v137, v137
    v_fmac_f32 v254, v202, v202
    v_fmac_f32 v254, v203, v203
    v_fmac_f32 v254, v204, v204
    v_fmac_f32 v254, v205, v205
    v_cvt_pk_bf16_f32 v36, v255, v254
    v_mfma_f32_16x16x32_bf16 v[154:157], a[120:123], v[162:165], 0
    s_waitcnt lgkmcnt(5)
    v_cvt_pk_bf16_f32 v148, v166, v167
    v_cvt_pk_bf16_f32 v149, v168, v169
    v_mfma_f32_16x16x32_bf16 v[154:157], a[124:127], v[118:121], v[154:157]
    s_waitcnt lgkmcnt(4)
    v_cvt_pk_bf16_f32 v216, v158, v159
    v_cvt_pk_bf16_f32 v217, v160, v161
    v_mfma_f32_16x16x32_bf16 v[166:169], v[32:35], v[36:39], 0
    s_waitcnt lgkmcnt(2)
    v_fma_f32 v181, v210, v210, s32
    v_fmac_f32 v181, v211, v211
    v_mfma_f32_16x16x32_bf16 v[154:157], a[128:131], v[126:129], v[154:157]
    s_waitcnt lgkmcnt(1)
    v_fmac_f32 v181, v212, v212
    v_fmac_f32 v181, v213, v213
    v_mfma_f32_16x16x32_bf16 v[154:157], a[132:135], v[206:209], v[154:157]
    v_rsq_f32 v167, v167
    v_mfma_f32_16x16x32_bf16 v[154:157], a[136:139], v[182:185], v[154:157]
    v_rsq_f32 v166, v166
    v_mfma_f32_16x16x32_bf16 v[154:157], a[140:143], v[186:189], v[154:157]
    v_mul_f32 v166, s31, v166
    v_mul_f32 v138, v167, v138
    v_mul_f32 v139, v167, v139
    v_cvt_pk_f16_f32 v138, v138, v139
    v_mul_f32 v140, v167, v140
    v_mul_f32 v141, v167, v141
    v_cvt_pk_f16_f32 v139, v140, v141
    v_mul_f32 v134, v167, v134
    v_mul_f32 v135, v167, v135
    v_cvt_pk_f16_f32 v140, v134, v135
    v_mfma_f32_16x16x32_bf16 v[158:161], a[0:3], v[162:165], 0
    v_mul_f32 v136, v167, v136
    v_mul_f32 v137, v167, v137
    v_mfma_f32_16x16x32_bf16 v[158:161], a[4:7], v[118:121], v[158:161]
    v_cvt_pk_f16_f32 v141, v136, v137
    v_mul_f32 v202, v167, v202
    v_mfma_f32_16x16x32_bf16 v[158:161], a[8:11], v[126:129], v[158:161]
    v_mul_f32 v203, v167, v203
    v_cvt_pk_f16_f32 v136, v202, v203
    v_mfma_f32_16x16x32_bf16 v[158:161], a[12:15], v[206:209], v[158:161]
    v_mul_f32 v204, v167, v204
    v_mul_f32 v205, v167, v205
    v_mfma_f32_16x16x32_bf16 v[158:161], a[16:19], v[182:185], v[158:161]
    v_cvt_pk_f16_f32 v137, v204, v205
    v_mul_f32 v170, v166, v170
    v_mfma_f32_16x16x32_bf16 v[158:161], a[20:23], v[186:189], v[158:161]
    v_mul_f32 v171, v166, v171
    v_cvt_pk_f16_f32 v170, v170, v171
    v_mfma_f32_16x16x32_bf16 v[222:225], a[24:27], v[162:165], 0
    v_mul_f32 v172, v166, v172
    v_mul_f32 v173, v166, v173
    v_mfma_f32_16x16x32_bf16 v[222:225], a[28:31], v[118:121], v[222:225]
    v_cvt_pk_f16_f32 v171, v172, v173
    v_mul_f32 v122, v166, v122
    v_mfma_f32_16x16x32_bf16 v[222:225], a[32:35], v[126:129], v[222:225]
    v_mul_f32 v123, v166, v123
    v_cvt_pk_f16_f32 v172, v122, v123
    v_mfma_f32_16x16x32_bf16 v[222:225], a[36:39], v[206:209], v[222:225]
    v_mul_f32 v124, v166, v124
    v_mul_f32 v125, v166, v125
    v_mfma_f32_16x16x32_bf16 v[222:225], a[40:43], v[182:185], v[222:225]
    v_cvt_pk_f16_f32 v173, v124, v125
    v_mul_f32 v114, v166, v114
    v_mfma_f32_16x16x32_bf16 v[222:225], a[44:47], v[186:189], v[222:225]
    v_mul_f32 v115, v166, v115
    v_cvt_pk_f16_f32 v134, v114, v115
    v_mfma_f32_16x16x32_bf16 v[122:125], a[48:51], v[162:165], 0
    v_mul_f32 v116, v166, v116
    v_mul_f32 v117, v166, v117
    v_mfma_f32_16x16x32_bf16 v[122:125], a[52:55], v[118:121], v[122:125]
    v_cvt_pk_f16_f32 v135, v116, v117
    v_fma_f32 v254, v158, v158, s32
    v_mfma_f32_16x16x32_bf16 v[122:125], a[56:59], v[126:129], v[122:125]
    v_fmac_f32 v254, v159, v159
    v_fmac_f32 v254, v160, v160
    v_mfma_f32_16x16x32_bf16 v[122:125], a[60:63], v[206:209], v[122:125]
    v_fmac_f32 v254, v161, v161
    v_fmac_f32 v254, v222, v222
    v_mfma_f32_16x16x32_bf16 v[122:125], a[64:67], v[182:185], v[122:125]
    v_fmac_f32 v254, v223, v223
    v_fmac_f32 v254, v224, v224
    v_mfma_f32_16x16x32_bf16 v[122:125], a[68:71], v[186:189], v[122:125]
    v_fmac_f32 v254, v225, v225
    v_fmac_f32 v181, v238, v238
    v_fmac_f32 v181, v239, v239
    v_fmac_f32 v181, v240, v240
    v_fmac_f32 v181, v241, v241
    v_fmac_f32 v181, v154, v154
    v_fmac_f32 v181, v155, v155
    v_fmac_f32 v181, v156, v156
    v_fmac_f32 v254, v122, v122
    v_fmac_f32 v254, v123, v123
    v_fmac_f32 v254, v124, v124
    v_fmac_f32 v254, v125, v125
    v_fmac_f32 v181, v157, v157
    v_cvt_pk_bf16_f32 v36, v254, v181
    v_mfma_f32_16x16x32_bf16 v[114:117], v[162:165], a[144:147], 0
    v_xor_b32 v0, 65536, v0
    v_xor_b32 v1, 65536, v1
    v_mfma_f32_16x16x32_bf16 v[114:117], v[118:121], a[148:151], v[114:117]
    v_add_u32 v5, 336, v5
    v_mfma_f32_16x16x32_bf16 v[114:117], v[126:129], a[152:155], v[114:117]
    v_mfma_f32_16x16x32_bf16 v[114:117], v[206:209], a[156:159], v[114:117]
    v_mfma_f32_16x16x32_bf16 v[114:117], v[182:185], a[160:163], v[114:117]
    v_mfma_f32_16x16x32_bf16 v[114:117], v[186:189], a[164:167], v[114:117]
    s_nop 0
    s_nop 0
    s_nop 0
    s_nop 0
    s_nop 0
    s_nop 0
    s_nop 0
    s_nop 0
    v_cvt_pk_bf16_f32 v166, v114, v115
    v_cvt_pk_bf16_f32 v167, v116, v117
    v_mfma_f32_16x16x32_bf16 v[114:117], v[32:35], v[36:39], 0
    s_nop 0
    s_nop 0
    s_nop 0
    s_nop 0
    s_nop 0
    s_nop 0
    s_nop 0
    s_nop 0
    v_rsq_f32 v115, v115
    v_rsq_f32 v114, v114
    v_mul_f32 v210, v115, v210
    v_mul_f32 v114, s31, v114
    v_mul_f32 v211, v115, v211
    v_cvt_pk_f16_f32 v210, v210, v211
    v_mul_f32 v212, v115, v212
    v_mul_f32 v213, v115, v213
    v_cvt_pk_f16_f32 v211, v212, v213
    v_mul_f32 v238, v115, v238
    v_mul_f32 v239, v115, v239
    v_cvt_pk_f16_f32 v212, v238, v239
    v_mul_f32 v240, v115, v240
    v_mul_f32 v241, v115, v241
    v_cvt_pk_f16_f32 v213, v240, v241
    v_mfma_f32_16x16x32_f16 v[238:241], v[190:193], v[142:145], v[22:25]
    v_mul_f32 v154, v115, v154
    v_mul_f32 v155, v115, v155
    v_mfma_f32_16x16x32_f16 v[238:241], v[246:249], v[130:133], v[238:241]
    v_cvt_pk_f16_f32 v204, v154, v155
    v_mul_f32 v156, v115, v156
    v_mfma_f32_16x16x32_f16 v[238:241], v[250:253], v[198:201], v[238:241]
    v_mul_f32 v157, v115, v157
    v_cvt_pk_f16_f32 v205, v156, v157
    v_mfma_f32_16x16x32_bf16 v[154:157], v[162:165], a[168:171], 0
    v_mul_f32 v158, v114, v158
    v_mul_f32 v159, v114, v159
    v_mfma_f32_16x16x32_bf16 v[154:157], v[118:121], a[172:175], v[154:157]
    v_cvt_pk_f16_f32 v158, v158, v159
    v_mul_f32 v160, v114, v160
    v_mfma_f32_16x16x32_bf16 v[154:157], v[126:129], a[176:179], v[154:157]
    ds_read2_b32 v[168:169], v6 offset0:0 offset1:0
    v_mul_f32 v161, v114, v161
    v_mfma_f32_16x16x32_bf16 v[154:157], v[206:209], a[180:183], v[154:157]
    v_cvt_pk_f16_f32 v159, v160, v161
    v_mul_f32 v222, v114, v222
    v_mfma_f32_16x16x32_bf16 v[154:157], v[182:185], a[184:187], v[154:157]
    v_mul_f32 v223, v114, v223
    v_cvt_pk_f16_f32 v160, v222, v223
    v_mfma_f32_16x16x32_bf16 v[154:157], v[186:189], a[188:191], v[154:157]
    ds_read2_b32 v[228:229], v6 offset0:16 offset1:16
    v_mul_f32 v224, v114, v224
    v_mul_f32 v225, v114, v225
    v_cvt_pk_f16_f32 v161, v224, v225
    v_mul_f32 v122, v114, v122
    v_mul_f32 v123, v114, v123
    v_cvt_pk_f16_f32 v202, v122, v123
    ds_read2_b32 v[116:117], v6 offset0:32 offset1:32
    v_cvt_pk_bf16_f32 v226, v154, v155
    v_cvt_pk_bf16_f32 v227, v156, v157
    v_mul_f32 v124, v114, v124
    v_mul_f32 v125, v114, v125
    v_cvt_pk_f16_f32 v203, v124, v125
    v_mfma_f32_16x16x32_bf16 v[122:125], v[162:165], a[192:195], 0
    s_waitcnt lgkmcnt(2)
    v_mov_b32_dpp v180, v239 quad_perm:[0,1,2,3] row_mask:0x1 bank_mask:0xf
    v_max3_f32 v181, v238, v218, v219
    v_mfma_f32_16x16x32_bf16 v[122:125], v[118:121], a[196:199], v[122:125]
    v_max3_f32 v181, v181, v220, v221
    v_add_u32 v6, 272, v6
    v_mfma_f32_16x16x32_bf16 v[122:125], v[126:129], a[200:203], v[122:125]
    v_mfma_f32_16x16x32_bf16 v[122:125], v[206:209], a[204:207], v[122:125]
    s_waitcnt lgkmcnt(1)
    v_mfma_f32_16x16x32_bf16 v[122:125], v[182:185], a[208:211], v[122:125]
    v_mfma_f32_16x16x32_f16 v[162:165], v[138:141], v[142:145], v[50:53]
    v_mfma_f32_16x16x32_f16 v[118:121], v[210:213], v[142:145], v[54:57]
    s_waitcnt lgkmcnt(0)
    v_mfma_f32_16x16x32_bf16 v[122:125], v[186:189], a[212:215], v[122:125]
    s_waitcnt vmcnt(0)
    v_mfma_f32_16x16x32_f16 v[142:145], v[190:193], v[170:173], v[24:27]
    s_barrier
    buffer_load_dwordx4 v10, s[8:11], 0 offen nt lds
    s_add_u32 m0, s28, 4096
    v_mfma_f32_16x16x16_f16 v[162:165], v[136:137], v[198:199], v[162:165]
    v_mfma_f32_16x16x16_f16 v[118:121], v[204:205], v[198:199], v[118:121]
    v_mfma_f32_16x16x32_f16 v[142:145], v[246:249], v[138:141], v[142:145]
    v_cvt_pk_bf16_f32 v114, v122, v123
    v_cvt_pk_bf16_f32 v115, v124, v125
    v_mfma_f32_16x16x32_f16 v[142:145], v[250:253], v[134:137], v[142:145]
    buffer_load_dwordx4 v11, s[8:11], 0 offen nt lds
    s_add_u32 m0, s28, 8192
    v_mfma_f32_16x16x32_f16 v[122:125], v[190:193], v[158:161], v[26:29]
    v_max3_f32 v181, v181, v162, v163
    v_max3_f32 v181, v181, v164, v165
    v_mfma_f32_16x16x32_f16 v[122:125], v[246:249], v[210:213], v[122:125]
    v_max3_f32 v181, v181, v118, v119
    v_max3_f32 v181, v181, v120, v121
    v_mfma_f32_16x16x32_f16 v[122:125], v[250:253], v[202:205], v[122:125]
    v_mov_b32_dpp v180, v143 quad_perm:[0,1,2,3] row_mask:0x2 bank_mask:0xf
    v_mov_b32 v198, v181
    v_mfma_f32_16x16x16_bf16 v[126:129], a[216:217], v[178:179], v[234:237]
    v_mfma_f32_16x16x16_bf16 v[206:209], a[240:241], v[178:179], v[234:237]
    buffer_load_dwordx4 v12, s[8:11], 0 offen nt lds
    v_permlane32_swap_b32 v181, v198
    v_mfma_f32_16x16x16_bf16 v[154:157], v[90:91], v[178:179], v[234:237]
    v_max_f32 v181, v181, v198
    v_mov_b32 v198, v181
    v_mov_b32_dpp v180, v123 quad_perm:[0,1,2,3] row_mask:0x4 bank_mask:0xf
    v_mfma_f32_16x16x16_bf16 v[186:189], a[218:219], v[178:179], v[194:197]
    v_permlane16_swap_b32 v181, v198
    v_max_f32 v181, v181, v198
    v_mfma_f32_16x16x16_bf16 v[234:237], a[242:243], v[178:179], v[194:197]
    v_sub_f32 v218, v218, v181
    v_exp_f32 v218, v218
    v_mfma_f32_16x16x16_bf16 v[182:185], v[92:93], v[178:179], v[194:197]
    s_add_u32 m0, s28, 12288
    s_xor_b32 s28, s28, 65536
    buffer_load_dwordx4 v13, s[8:11], 0 offen nt lds
    s_mov_b32 m0, s29
    s_xor_b32 s29, s29, s30
    v_sub_f32 v219, v219, v181
    v_exp_f32 v219, v219
    v_sub_f32 v220, v220, v181
    v_cvt_pk_bf16_f32 v190, v218, v219
    v_exp_f32 v220, v220
    v_sub_f32 v221, v221, v181
    v_exp_f32 v221, v221
    v_sub_f32 v162, v162, v181
    v_cvt_pk_bf16_f32 v191, v220, v221
    v_exp_f32 v162, v162
    v_mfma_f32_16x16x32_f16 v[218:221], v[130:133], v[170:173], v[58:61]
    buffer_load_dwordx4 v14, s[8:11], 0 offen nt lds
    v_sub_f32 v163, v163, v181
    v_exp_f32 v163, v163
    v_sub_f32 v164, v164, v181
    v_cvt_pk_bf16_f32 v192, v162, v163
    v_exp_f32 v164, v164
    v_mfma_f32_16x16x16_f16 v[218:221], v[200:201], v[134:135], v[218:221]
    v_sub_f32 v165, v165, v181
    v_exp_f32 v165, v165
    v_sub_f32 v118, v118, v181
    v_mfma_f32_16x16x32_f16 v[222:225], v[138:141], v[170:173], v[62:65]
    v_cvt_pk_bf16_f32 v193, v164, v165
    v_exp_f32 v118, v118
    v_sub_f32 v119, v119, v181
    v_exp_f32 v119, v119
    v_sub_f32 v120, v120, v181
    v_cvt_pk_bf16_f32 v36, v118, v119
    v_mfma_f32_16x16x16_f16 v[222:225], v[136:137], v[134:135], v[222:225]
    v_exp_f32 v120, v120
    v_sub_f32 v121, v121, v181
    v_sub_f32 v238, v238, v181
    v_mfma_f32_16x16x32_f16 v[162:165], v[210:213], v[170:173], v[66:69]
    v_exp_f32 v121, v121
    v_exp_f32 v238, v238
    v_cvt_pk_bf16_f32 v37, v120, v121
    v_cvt_pk_bf16_f32 v39, v238, 0
    v_cvt_pk_bf16_f32 v126, v126, v127
    v_accvgpr_write_b32 a216, v126
    v_mfma_f32_16x16x32_bf16 v[118:121], v[28:31], v[36:39], 0
    v_cvt_pk_bf16_f32 v128, v128, v129
    v_accvgpr_write_b32 a217, v128
    v_mfma_f32_16x16x32_bf16 v[118:121], v[28:31], v[190:193], v[118:121]
    v_cvt_pk_bf16_f32 v206, v206, v207
    v_accvgpr_write_b32 a240, v206
    v_mfma_f32_16x16x32_bf16 v[126:129], v[166:169], v[36:39], 0
    v_cvt_pk_bf16_f32 v208, v208, v209
    v_accvgpr_write_b32 a241, v208
    v_mfma_f32_16x16x32_bf16 v[126:129], v[150:153], v[190:193], v[126:129]
    v_cvt_pk_bf16_f32 v90, v154, v155
    v_cvt_pk_bf16_f32 v91, v156, v157
    v_mfma_f32_16x16x32_bf16 v[206:209], v[226:229], v[36:39], 0
    ds_read_b128 v[170:173], v177 offset:128
    v_cvt_pk_bf16_f32 v186, v186, v187
    v_mfma_f32_16x16x32_bf16 v[206:209], v[146:149], v[190:193], v[206:209]
    v_rcp_f32 v118, v118
    v_mfma_f32_16x16x32_bf16 v[154:157], v[114:117], v[36:39], 0
    v_mul_f32 v126, v118, v126
    v_mul_f32 v127, v118, v127
    v_mfma_f32_16x16x32_bf16 v[154:157], v[214:217], v[190:193], v[154:157]
    v_cvt_pk_bf16_f32 v126, v126, v127
    v_mul_f32 v128, v118, v128
    v_mul_f32 v129, v118, v129
    v_mfma_f32_16x16x16_f16 v[162:165], v[204:205], v[134:135], v[162:165]
    v_cvt_pk_bf16_f32 v127, v128, v129
    v_mul_f32 v206, v118, v206
    v_mul_f32 v207, v118, v207
    v_cvt_pk_bf16_f32 v128, v206, v207
    v_mul_f32 v208, v118, v208
    v_mul_f32 v209, v118, v209
    v_cvt_pk_bf16_f32 v129, v208, v209
    ds_write_b128 v3, v[126:129] offset:0
    s_waitcnt lgkmcnt(1)
    v_mfma_f32_16x16x16_bf16 v[126:129], a[232:233], v[178:179], v[170:173]
    v_mul_f32 v154, v118, v154
    v_mul_f32 v155, v118, v155
    v_cvt_pk_bf16_f32 v134, v154, v155
    v_mfma_f32_16x16x16_bf16 v[206:209], v[82:83], v[178:179], v[170:173]
    v_mul_f32 v156, v118, v156
    v_mul_f32 v157, v118, v157
    v_cvt_pk_bf16_f32 v135, v156, v157
    v_mfma_f32_16x16x16_bf16 v[118:121], v[106:107], v[178:179], v[170:173]
    ds_write_b64 v4, v[134:135] offset:4096
    v_accvgpr_write_b32 a218, v186
    v_cvt_pk_bf16_f32 v188, v188, v189
    v_accvgpr_write_b32 a219, v188
    v_cvt_pk_bf16_f32 v234, v234, v235
    v_accvgpr_write_b32 a242, v234
    v_cvt_pk_bf16_f32 v236, v236, v237
    v_accvgpr_write_b32 a243, v236
    v_cvt_pk_bf16_f32 v92, v182, v183
    v_cvt_pk_bf16_f32 v93, v184, v185
    ds_read_b128 v[234:237], v177 offset:192
    v_cvt_pk_bf16_f32 v126, v126, v127
    v_accvgpr_write_b32 a232, v126
    v_cvt_pk_bf16_f32 v128, v128, v129
    v_accvgpr_write_b32 a233, v128
    v_cvt_pk_bf16_f32 v82, v206, v207
    v_cvt_pk_bf16_f32 v83, v208, v209
    v_cvt_pk_bf16_f32 v106, v118, v119
    v_cvt_pk_bf16_f32 v107, v120, v121
    ds_read_b128 v[118:121], v177 offset:256
    v_mov_b32 v181, v180
    v_max3_f32 v254, v142, v218, v219
    v_max3_f32 v254, v254, v220, v221
    v_max_f32_dpp v181, v181, v181 quad_perm:[1,0,3,2] row_mask:0xf bank_mask:0xf
    v_max3_f32 v254, v254, v222, v223
    v_max3_f32 v254, v254, v224, v225
    v_max_f32_dpp v181, v181, v181 quad_perm:[2,3,0,1] row_mask:0xf bank_mask:0xf
    v_max3_f32 v254, v254, v162, v163
    v_max3_f32 v254, v254, v164, v165
    v_max_f32_dpp v181, v181, v181 row_half_mirror row_mask:0xf bank_mask:0xf
    v_mov_b32 v255, v254
    s_nop 0
    v_max_f32_dpp v181, v181, v181 row_mirror row_mask:0xf bank_mask:0xf
    v_mov_b32 v134, v181
    v_permlane32_swap_b32 v254, v255
    s_waitcnt lgkmcnt(1)
    v_mfma_f32_16x16x16_bf16 v[126:129], a[220:221], v[178:179], v[234:237]
    v_permlane32_swap_b32 v181, v134
    v_max_f32 v181, v181, v134
    v_mfma_f32_16x16x16_bf16 v[170:173], a[244:245], v[178:179], v[234:237]
    v_mov_b32 v134, v181
    v_max_f32 v254, v254, v255
    v_mov_b32 v255, v254
    v_mfma_f32_16x16x16_bf16 v[206:209], v[94:95], v[178:179], v[234:237]
    v_permlane16_swap_b32 v181, v134
    s_waitcnt lgkmcnt(0)
    v_mfma_f32_16x16x16_bf16 v[186:189], a[222:223], v[178:179], v[118:121]
    v_cvt_pk_bf16_f32 v126, v126, v127
    v_accvgpr_write_b32 a220, v126
    v_cvt_pk_bf16_f32 v128, v128, v129
    v_mfma_f32_16x16x16_bf16 v[234:237], a[246:247], v[178:179], v[118:121]
    v_accvgpr_write_b32 a221, v128
    v_cvt_pk_bf16_f32 v170, v170, v171
    v_accvgpr_write_b32 a244, v170
    v_mfma_f32_16x16x16_bf16 v[126:129], v[96:97], v[178:179], v[118:121]
    v_cvt_pk_bf16_f32 v172, v172, v173
    v_accvgpr_write_b32 a245, v172
    v_cvt_pk_bf16_f32 v94, v206, v207
    v_cvt_pk_bf16_f32 v95, v208, v209
    ds_read_b128 v[118:121], v177 offset:320
    v_cvt_pk_bf16_f32 v186, v186, v187
    v_accvgpr_write_b32 a222, v186
    v_cvt_pk_bf16_f32 v188, v188, v189
    v_accvgpr_write_b32 a223, v188
    v_cvt_pk_bf16_f32 v234, v234, v235
    v_accvgpr_write_b32 a246, v234
    v_cvt_pk_bf16_f32 v236, v236, v237
    v_accvgpr_write_b32 a247, v236
    v_cvt_pk_bf16_f32 v96, v126, v127
    v_cvt_pk_bf16_f32 v97, v128, v129
    ds_read_b128 v[234:237], v177 offset:384
    v_max_f32 v181, v181, v134
    v_sub_f32 v180, v180, v181
    v_exp_f32 v180, v180
    v_permlane16_swap_b32 v254, v255
    v_cvt_pk_bf16_f32 v180, v180, v180
    ds_write_b16 v8, v180
    v_max_f32 v254, v254, v255
    ds_read_b128 v[126:129], v9
    s_waitcnt lgkmcnt(3)
    v_mfma_f32_16x16x16_bf16 v[206:209], a[234:235], v[178:179], v[118:121]
    ds_read_b128 v[170:173], v9 offset:64
    v_sub_f32 v218, v218, v254
    v_sub_f32 v219, v219, v254
    v_mfma_f32_16x16x16_bf16 v[186:189], v[84:85], v[178:179], v[118:121]
    v_exp_f32 v218, v218
    v_sub_f32 v220, v220, v254
    v_mfma_f32_16x16x16_bf16 v[154:157], v[108:109], v[178:179], v[118:121]
    v_exp_f32 v219, v219
    s_waitcnt lgkmcnt(3)
    v_mfma_f32_16x16x16_bf16 v[182:185], a[224:225], v[178:179], v[234:237]
    v_cvt_pk_bf16_f32 v206, v206, v207
    v_accvgpr_write_b32 a234, v206
    v_cvt_pk_bf16_f32 v208, v208, v209
    v_mfma_f32_16x16x16_bf16 v[118:121], a[248:249], v[178:179], v[234:237]
    v_accvgpr_write_b32 a235, v208
    v_cvt_pk_bf16_f32 v84, v186, v187
    v_cvt_pk_bf16_f32 v85, v188, v189
    v_mfma_f32_16x16x16_bf16 v[186:189], v[98:99], v[178:179], v[234:237]
    v_cvt_pk_bf16_f32 v108, v154, v155
    v_cvt_pk_bf16_f32 v109, v156, v157
    ds_read_b128 v[206:209], v177 offset:448
    s_waitcnt lgkmcnt(2)
    v_mfma_f32_16x16x32_bf16 v[154:157], v[126:129], v[28:31], 0
    v_cvt_pk_bf16_f32 v182, v182, v183
    v_accvgpr_write_b32 a224, v182
    v_mfma_f32_16x16x32_bf16 v[190:193], v[126:129], v[150:153], 0
    s_waitcnt lgkmcnt(1)
    v_cvt_pk_bf16_f32 v184, v184, v185
    v_accvgpr_write_b32 a225, v184
    v_mfma_f32_16x16x32_bf16 v[154:157], v[170:173], v[28:31], v[154:157]
    v_cvt_pk_bf16_f32 v118, v118, v119
    v_accvgpr_write_b32 a248, v118
    v_mfma_f32_16x16x32_bf16 v[190:193], v[170:173], v[166:169], v[190:193]
    v_cvt_pk_bf16_f32 v120, v120, v121
    v_accvgpr_write_b32 a249, v120
    v_mfma_f32_16x16x32_bf16 v[118:121], v[126:129], v[146:149], 0
    v_cvt_pk_bf16_f32 v98, v186, v187
    v_cvt_pk_bf16_f32 v99, v188, v189
    v_mfma_f32_16x16x32_bf16 v[118:121], v[170:173], v[226:229], v[118:121]
    ds_read_b128 v[234:237], v177 offset:512
    v_cvt_pk_bf16_f32 v218, v218, v219
    v_mfma_f32_16x16x32_bf16 v[194:197], v[126:129], v[214:217], 0
    v_exp_f32 v220, v220
    v_mfma_f32_16x16x32_bf16 v[194:197], v[170:173], v[114:117], v[194:197]
    s_waitcnt lgkmcnt(1)
    v_sub_f32 v221, v221, v254
    v_exp_f32 v221, v221
    v_mfma_f32_16x16x16_bf16 v[126:129], a[226:227], v[178:179], v[206:209]
    v_cvt_pk_bf16_f32 v219, v220, v221
    v_sub_f32 v222, v222, v254
    v_sub_f32 v223, v223, v254
    v_mfma_f32_16x16x16_bf16 v[186:189], a[250:251], v[178:179], v[206:209]
    v_exp_f32 v222, v222
    v_sub_f32 v224, v224, v254
    v_mfma_f32_16x16x16_bf16 v[170:173], v[100:101], v[178:179], v[206:209]
    v_exp_f32 v223, v223
    v_cvt_pk_bf16_f32 v126, v126, v127
    v_accvgpr_write_b32 a226, v126
    v_cvt_pk_bf16_f32 v128, v128, v129
    v_accvgpr_write_b32 a227, v128
    v_cvt_pk_bf16_f32 v186, v186, v187
    v_accvgpr_write_b32 a250, v186
    s_waitcnt lgkmcnt(0)
    v_mfma_f32_16x16x16_bf16 v[126:129], a[236:237], v[178:179], v[234:237]
    v_cvt_pk_bf16_f32 v188, v188, v189
    v_accvgpr_write_b32 a251, v188
    v_cvt_pk_bf16_f32 v100, v170, v171
    v_mfma_f32_16x16x16_bf16 v[206:209], v[86:87], v[178:179], v[234:237]
    v_cvt_pk_bf16_f32 v101, v172, v173
    v_cvt_pk_bf16_f32 v220, v222, v223
    v_sub_f32 v225, v225, v254
    v_mfma_f32_16x16x16_bf16 v[170:173], v[110:111], v[178:179], v[234:237]
    ds_read_b128 v[186:189], v177 offset:576
    v_cvt_pk_bf16_f32 v126, v126, v127
    v_accvgpr_write_b32 a236, v126
    v_cvt_pk_bf16_f32 v128, v128, v129
    v_accvgpr_write_b32 a237, v128
    v_cvt_pk_bf16_f32 v86, v206, v207
    v_cvt_pk_bf16_f32 v87, v208, v209
    v_exp_f32 v224, v224
    v_cvt_pk_bf16_f32 v110, v170, v171
    v_cvt_pk_bf16_f32 v111, v172, v173
    ds_read_b128 v[234:237], v177 offset:640
    v_exp_f32 v225, v225
    v_mfma_f32_16x16x32_f16 v[126:129], v[130:133], v[158:161], v[70:73]
    v_cvt_pk_bf16_f32 v221, v224, v225
    v_sub_f32 v162, v162, v254
    v_exp_f32 v162, v162
    v_sub_f32 v163, v163, v254
    v_exp_f32 v163, v163
    v_sub_f32 v164, v164, v254
    v_mfma_f32_16x16x16_f16 v[126:129], v[200:201], v[202:203], v[126:129]
    v_cvt_pk_bf16_f32 v36, v162, v163
    s_waitcnt lgkmcnt(1)
    v_sub_f32 v165, v165, v254
    v_mfma_f32_16x16x16_bf16 v[130:133], a[228:229], v[178:179], v[186:189]
    v_exp_f32 v164, v164
    v_exp_f32 v165, v165
    v_mfma_f32_16x16x32_f16 v[170:173], v[138:141], v[158:161], v[74:77]
    v_cvt_pk_bf16_f32 v37, v164, v165
    v_max3_f32 v255, v122, v126, v127
    v_mfma_f32_16x16x32_f16 v[162:165], v[210:213], v[158:161], v[78:81]
    v_max3_f32 v255, v255, v128, v129
    v_rcp_f32 v154, v154
    v_mfma_f32_16x16x16_bf16 v[138:141], a[252:253], v[178:179], v[186:189]
    v_cvt_pk_bf16_f32 v130, v130, v131
    v_accvgpr_write_b32 a228, v130
    v_cvt_pk_bf16_f32 v132, v132, v133
    v_mfma_f32_16x16x16_f16 v[170:173], v[136:137], v[202:203], v[170:173]
    v_accvgpr_write_b32 a229, v132
    v_sub_f32 v142, v142, v254
    v_mul_f32 v190, v190, v154
    v_mfma_f32_16x16x16_f16 v[162:165], v[204:205], v[202:203], v[162:165]
    v_cvt_pk_bf16_f32 v138, v138, v139
    v_accvgpr_write_b32 a252, v138
    v_cvt_pk_bf16_f32 v140, v140, v141
    v_mfma_f32_16x16x16_bf16 v[130:133], v[102:103], v[178:179], v[186:189]
    s_waitcnt lgkmcnt(0)
    v_accvgpr_write_b32 a253, v140
    v_max3_f32 v255, v255, v170, v171
    v_mfma_f32_16x16x16_bf16 v[138:141], a[230:231], v[178:179], v[234:237]
    v_max3_f32 v255, v255, v172, v173
    v_max3_f32 v255, v255, v162, v163
    v_max3_f32 v255, v255, v164, v165
    v_mfma_f32_16x16x16_bf16 v[134:137], a[254:255], v[178:179], v[234:237]
    v_cvt_pk_bf16_f32 v102, v130, v131
    v_cvt_pk_bf16_f32 v103, v132, v133
    v_mov_b32 v254, v255
    v_mfma_f32_16x16x16_bf16 v[130:133], v[104:105], v[178:179], v[234:237]
    ds_read_b128 v[206:209], v177 offset:704
    v_cvt_pk_bf16_f32 v138, v138, v139
    v_accvgpr_write_b32 a230, v138
    v_cvt_pk_bf16_f32 v140, v140, v141
    v_accvgpr_write_b32 a231, v140
    v_cvt_pk_bf16_f32 v134, v134, v135
    v_accvgpr_write_b32 a254, v134
    v_cvt_pk_bf16_f32 v136, v136, v137
    v_accvgpr_write_b32 a255, v136
    v_cvt_pk_bf16_f32 v104, v130, v131
    v_cvt_pk_bf16_f32 v105, v132, v133
    v_permlane32_swap_b32 v255, v254
    v_max_f32 v255, v255, v254
    v_mov_b32 v254, v255
    v_exp_f32 v142, v142
    v_mul_f32_dpp v190, v118, v154 quad_perm:[0,1,2,3] row_mask:0x2 bank_mask:0xf
    v_permlane16_swap_b32 v255, v254
    v_max_f32 v255, v255, v254
    v_sub_f32 v126, v126, v255
    v_exp_f32 v126, v126
    v_sub_f32 v127, v127, v255
    v_exp_f32 v127, v127
    v_sub_f32 v128, v128, v255
    s_waitcnt lgkmcnt(0)
    v_mfma_f32_16x16x16_bf16 v[130:133], a[238:239], v[178:179], v[206:209]
    v_cvt_pk_bf16_f32 v174, v126, v127
    v_exp_f32 v128, v128
    v_mfma_f32_16x16x16_bf16 v[134:137], v[88:89], v[178:179], v[206:209]
    v_sub_f32 v129, v129, v255
    v_exp_f32 v129, v129
    v_mfma_f32_16x16x16_bf16 v[138:141], v[112:113], v[178:179], v[206:209]
    ds_read_b128 v[186:189], v0 offset:20480
    ds_read_b128 v[118:121], v1 offset:20480
    ds_read_b128 v[234:237], v0 offset:20608
    ds_read_b128 v[158:161], v1 offset:20608
    ds_read_b128 v[182:185], v0 offset:20736
    ds_read_b128 v[206:209], v1 offset:20736
    v_cvt_pk_bf16_f32 v130, v130, v131
    v_accvgpr_write_b32 a238, v130
    v_cvt_pk_bf16_f32 v132, v132, v133
    v_accvgpr_write_b32 a239, v132
    v_cvt_pk_bf16_f32 v88, v134, v135
    v_cvt_pk_bf16_f32 v89, v136, v137
    v_cvt_pk_bf16_f32 v112, v138, v139
    v_cvt_pk_bf16_f32 v113, v140, v141
    v_cvt_pk_bf16_f32 v175, v128, v129
    v_sub_f32 v170, v170, v255
    v_exp_f32 v170, v170
    v_sub_f32 v171, v171, v255
    v_exp_f32 v171, v171
    s_waitcnt lgkmcnt(4)
    v_mfma_f32_16x16x32_bf16 v[130:133], a[72:75], v[186:189], 0
    s_waitcnt lgkmcnt(3)
    v_cvt_pk_bf16_f32 v176, v170, v171
    v_sub_f32 v172, v172, v255
    v_mfma_f32_16x16x32_bf16 v[130:133], a[76:79], v[118:121], v[130:133]
    s_waitcnt lgkmcnt(2)
    v_exp_f32 v172, v172
    v_mfma_f32_16x16x32_bf16 v[130:133], a[80:83], v[234:237], v[130:133]
    s_waitcnt lgkmcnt(1)
    v_sub_f32 v173, v173, v255
    v_sub_f32 v162, v162, v255
    v_mfma_f32_16x16x32_bf16 v[130:133], a[84:87], v[158:161], v[130:133]
    s_waitcnt lgkmcnt(0)
    v_exp_f32 v173, v173
    v_mfma_f32_16x16x32_bf16 v[130:133], a[88:91], v[182:185], v[130:133]
    v_cvt_pk_bf16_f32 v177, v172, v173
    v_sub_f32 v163, v163, v255
    v_mfma_f32_16x16x32_bf16 v[130:133], a[92:95], v[206:209], v[130:133]
    v_exp_f32 v162, v162
    v_mfma_f32_16x16x32_bf16 v[134:137], a[96:99], v[186:189], 0
    v_exp_f32 v163, v163
    v_mfma_f32_16x16x32_bf16 v[134:137], a[100:103], v[118:121], v[134:137]
    v_sub_f32 v164, v164, v255
    v_sub_f32 v165, v165, v255
    v_mfma_f32_16x16x32_bf16 v[134:137], a[104:107], v[234:237], v[134:137]
    v_exp_f32 v164, v164
    v_mfma_f32_16x16x32_bf16 v[134:137], a[108:111], v[158:161], v[134:137]
    v_exp_f32 v165, v165
    v_mfma_f32_16x16x32_bf16 v[134:137], a[112:115], v[182:185], v[134:137]
    v_sub_f32 v122, v122, v255
    v_cvt_pk_bf16_f32 v39, v142, 0
    v_mfma_f32_16x16x32_bf16 v[134:137], a[116:119], v[206:209], v[134:137]
    v_exp_f32 v122, v122
    v_mfma_f32_16x16x32_bf16 v[138:141], v[28:31], v[36:39], 0
    v_mul_f32_dpp v190, v194, v154 quad_perm:[0,1,2,3] row_mask:0x4 bank_mask:0xf
    v_cvt_pk_bf16_f32 v190, v190, v190
    v_mfma_f32_16x16x32_bf16 v[138:141], v[28:31], v[218:221], v[138:141]
    ds_write_b16 v7, v190
    v_mfma_f32_16x16x32_bf16 v[178:181], v[166:169], v[36:39], 0
    v_add_u32 v7, 16, v7
    v_mfma_f32_16x16x32_bf16 v[178:181], v[150:153], v[218:221], v[178:181]
    v_mfma_f32_16x16x32_bf16 v[142:145], v[226:229], v[36:39], 0
    v_mfma_f32_16x16x32_bf16 v[142:145], v[146:149], v[218:221], v[142:145]
    v_mfma_f32_16x16x32_bf16 v[126:129], v[114:117], v[36:39], 0
    v_cvt_pk_bf16_f32 v36, v162, v163
    v_cvt_pk_bf16_f32 v37, v164, v165
    v_mfma_f32_16x16x32_bf16 v[126:129], v[214:217], v[218:221], v[126:129]
    v_rcp_f32 v138, v138
    v_mfma_f32_16x16x32_bf16 v[170:173], a[120:123], v[186:189], 0
    v_mul_f32 v178, v138, v178
    v_mul_f32 v179, v138, v179
    v_mfma_f32_16x16x32_bf16 v[170:173], a[124:127], v[118:121], v[170:173]
    v_cvt_pk_bf16_f32 v162, v178, v179
    v_mul_f32 v180, v138, v180
    v_mfma_f32_16x16x32_bf16 v[170:173], a[128:131], v[234:237], v[170:173]
    v_mul_f32 v181, v138, v181
    v_cvt_pk_bf16_f32 v163, v180, v181
    v_mfma_f32_16x16x32_bf16 v[170:173], a[132:135], v[158:161], v[170:173]
    v_mul_f32 v142, v138, v142
    v_mul_f32 v143, v138, v143
    v_mfma_f32_16x16x32_bf16 v[170:173], a[136:139], v[182:185], v[170:173]
    v_cvt_pk_bf16_f32 v164, v142, v143
    v_mul_f32 v144, v138, v144
    v_mfma_f32_16x16x32_bf16 v[170:173], a[140:143], v[206:209], v[170:173]
    v_mul_f32 v145, v138, v145
    v_cvt_pk_bf16_f32 v165, v144, v145
    v_mfma_f32_16x16x32_bf16 v[142:145], a[0:3], v[186:189], 0
    ds_write_b128 v3, v[162:165] offset:6144
    v_mfma_f32_16x16x32_bf16 v[142:145], a[4:7], v[118:121], v[142:145]
    v_mul_f32 v126, v138, v126
    v_mul_f32 v127, v138, v127
    v_mfma_f32_16x16x32_bf16 v[142:145], a[8:11], v[234:237], v[142:145]
    v_cvt_pk_bf16_f32 v254, v126, v127
    v_mul_f32 v128, v138, v128
    v_mfma_f32_16x16x32_bf16 v[142:145], a[12:15], v[158:161], v[142:145]
    v_mul_f32 v129, v138, v129
    v_cvt_pk_bf16_f32 v255, v128, v129
    v_mfma_f32_16x16x32_bf16 v[142:145], a[16:19], v[182:185], v[142:145]
    ds_write_b64 v4, v[254:255] offset:10240
    v_mfma_f32_16x16x32_bf16 v[142:145], a[20:23], v[206:209], v[142:145]
    v_cvt_pk_bf16_f32 v39, v122, 0
    v_mfma_f32_16x16x32_bf16 v[126:129], a[24:27], v[186:189], 0
    v_mfma_f32_16x16x32_bf16 v[126:129], a[28:31], v[118:121], v[126:129]
    v_mfma_f32_16x16x32_bf16 v[162:165], v[28:31], v[36:39], 0
    v_mfma_f32_16x16x32_bf16 v[162:165], v[28:31], v[174:177], v[162:165]
    v_mfma_f32_16x16x32_bf16 v[138:141], v[166:169], v[36:39], 0
    v_mfma_f32_16x16x32_bf16 v[138:141], v[150:153], v[174:177], v[138:141]
    v_mfma_f32_16x16x32_bf16 v[178:181], v[226:229], v[36:39], 0
    v_mfma_f32_16x16x32_bf16 v[178:181], v[146:149], v[174:177], v[178:181]
    v_mfma_f32_16x16x32_bf16 v[166:169], v[114:117], v[36:39], 0
    v_mfma_f32_16x16x32_bf16 v[166:169], v[214:217], v[174:177], v[166:169]
    v_mfma_f32_16x16x32_bf16 v[126:129], a[32:35], v[234:237], v[126:129]
    v_mfma_f32_16x16x32_bf16 v[126:129], a[36:39], v[158:161], v[126:129]
    v_rcp_f32 v162, v162
    v_mfma_f32_16x16x32_bf16 v[126:129], a[40:43], v[182:185], v[126:129]
    v_mul_f32 v138, v162, v138
    v_mul_f32 v139, v162, v139
    v_mfma_f32_16x16x32_bf16 v[126:129], a[44:47], v[206:209], v[126:129]
    v_cvt_pk_bf16_f32 v114, v138, v139
    v_mul_f32 v140, v162, v140
    v_mul_f32 v141, v162, v141
    v_cvt_pk_bf16_f32 v115, v140, v141
    v_mul_f32 v178, v162, v178
    v_mul_f32 v179, v162, v179
    v_cvt_pk_bf16_f32 v116, v178, v179
    v_mul_f32 v180, v162, v180
    v_mul_f32 v181, v162, v181
    v_cvt_pk_bf16_f32 v117, v180, v181
    ds_write_b128 v3, v[114:117] offset:12288
    v_mul_f32 v166, v162, v166
    v_mul_f32 v167, v162, v167
    v_cvt_pk_bf16_f32 v254, v166, v167
    v_mul_f32 v168, v162, v168
    v_mul_f32 v169, v162, v169
    v_cvt_pk_bf16_f32 v255, v168, v169
    v_xor_b32 v3, 65536, v3
    ds_write_b64 v4, v[254:255] offset:16384
    v_xor_b32 v4, 65536, v4
    s_waitcnt lgkmcnt(0)
    s_barrier
    s_waitcnt lgkmcnt(0)
    s_cmp_eq_u32 s45, 0
    s_cbranch_scc1 L_drain
    s_max_u32 s3, s37, s44
    s_cmp_gt_u32 s3, 0x42000000
    s_cbranch_scc1 L_safe
    v_cvt_pk_f16_f32 v194, v130, v131
    v_pk_mul_f16 v191, v194, v194
    v_cvt_pk_f16_f32 v195, v132, v133
    v_pk_fma_f16 v191, v195, v195, v191
    v_cvt_pk_f16_f32 v196, v134, v135
    v_pk_fma_f16 v191, v196, v196, v191
    v_cvt_pk_f16_f32 v197, v136, v137
    v_pk_fma_f16 v191, v197, v197, v191
    v_cvt_pk_f16_f32 v148, v170, v171
    v_pk_fma_f16 v191, v148, v148, v191
    v_cvt_pk_f16_f32 v149, v172, v173
    v_pk_fma_f16 v191, v149, v149, v191
    v_and_b32 v146, 16, v2
    v_sub_u32 v5, v5, v146
    s_nop 7
    s_branch L_go
L_safe:
    v_fma_f32 v174, v130, v130, s32
    v_fmac_f32 v174, v131, v131
    v_fmac_f32 v174, v132, v132
    v_fmac_f32 v174, v133, v133
    s_nop 7
    s_and_b32 s3, s2, 0xf8
    s_add_u32 s64, s42, s3
    s_addc_u32 s65, s43, 0
    s_mov_b32 s67, 0x00020000
    s_cmp_eq_u32 s16, 1
    s_cbranch_scc1 L_loop_safe1
    s_cmp_eq_u32 s16, 2
    s_cbranch_scc1 L_loop_safe2
    s_cmp_eq_u32 s16, 3
    s_cbranch_scc1 L_loop_safe3
    s_branch L_loop_safe0
.p2align 6
L_loop_safe0:
    v_mfma_f32_16x16x32_bf16 v[190:193], a[48:51], v[186:189], 0
    s_add_u32 s12, s40, s27
    ds_read_b128 v[146:149], v2 offset:18432
    ds_read_b128 v[178:181], v2 offset:19456
    v_mfma_f32_16x16x32_bf16 v[190:193], a[52:55], v[118:121], v[190:193]
    s_addc_u32 s13, s41, 0
    v_fmac_f32 v174, v134, v134
    v_fmac_f32 v174, v135, v135
    v_mfma_f32_16x16x32_bf16 v[190:193], a[56:59], v[234:237], v[190:193]
    s_sub_u32 s14, s36, s27
    v_fmac_f32 v174, v136, v136
    v_fmac_f32 v174, v137, v137
    v_mfma_f32_16x16x32_bf16 v[190:193], a[60:63], v[158:161], v[190:193]
    s_cmp_ge_u32 s18, 2
    v_fmac_f32 v174, v170, v170
    v_fmac_f32 v174, v171, v171
    v_mfma_f32_16x16x32_bf16 v[190:193], a[64:67], v[182:185], v[190:193]
    s_cselect_b32 s14, s14, 0
    v_fmac_f32 v174, v172, v172
    v_fmac_f32 v174, v173, v173
    v_mfma_f32_16x16x32_bf16 v[190:193], a[68:71], v[206:209], v[190:193]
    s_sub_u32 s82, s72, s71
    v_fma_f32 v254, v142, v142, s32
    v_fmac_f32 v254, v143, v143
    v_mfma_f32_16x16x32_bf16 v[194:197], v[186:189], a[144:147], 0
    s_mul_i32 s74, s82, 336
    v_fmac_f32 v254, v144, v144
    v_fmac_f32 v254, v145, v145
    v_mfma_f32_16x16x32_bf16 v[194:197], v[118:121], a[148:151], v[194:197]
    s_mul_i32 s75, s82, 272
    v_fmac_f32 v254, v126, v126
    v_fmac_f32 v254, v127, v127
    v_mfma_f32_16x16x32_bf16 v[194:197], v[234:237], a[152:155], v[194:197]
    s_waitcnt lgkmcnt(0)
    v_fmac_f32 v254, v128, v128
    v_fmac_f32 v254, v129, v129
    v_mfma_f32_16x16x32_bf16 v[198:201], v[32:35], v[146:149], 0
    s_mul_i32 s76, s82, 16
    v_fmac_f32 v254, v190, v190
    v_fmac_f32 v254, v191, v191
    v_mfma_f32_16x16x32_bf16 v[198:201], v[32:35], v[178:181], v[198:201]
    s_add_u32 s34, s18, 2
    v_fmac_f32 v254, v192, v192
    v_fmac_f32 v254, v193, v193
    v_mfma_f32_16x16x32_bf16 v[194:197], v[158:161], a[156:159], v[194:197]
    s_add_u32 s8, s60, s23
    v_cvt_pk_bf16_f32 v36, v254, v174
    s_addc_u32 s9, s61, 0
    v_mfma_f32_16x16x32_bf16 v[194:197], v[182:185], a[160:163], v[194:197]
    s_sub_u32 s10, s36, s23
    v_mul_f32 v254, 0x3baaaaab, v198
    v_mul_f32 v255, 0x3baaaaab, v199
    v_mfma_f32_16x16x32_bf16 v[210:213], v[32:35], v[36:39], 0
    s_cmp_le_u32 s34, s45
    v_rsq_f32 v254, v254
    v_mfma_f32_16x16x32_bf16 v[194:197], v[206:209], a[164:167], v[194:197]
    s_cselect_b32 s10, s10, 0
    ds_read_b128 v[214:217], v0 offset:26624
    v_mul_f32 v148, 0x3baaaaab, v200
    v_mfma_f32_16x16x32_bf16 v[174:177], v[186:189], a[168:171], 0
    s_add_u32 m0, s28, 0
    ds_read_b128 v[198:201], v1 offset:26624
    v_mul_f32 v122, v254, v122
    v_mfma_f32_16x16x32_bf16 v[174:177], v[118:121], a[172:175], v[174:177]
    s_mov_b32 s27, s26
    ds_read_b128 v[218:221], v0 offset:26752
    v_cvt_pk_bf16_f32 v146, v194, v195
    v_mfma_f32_16x16x32_bf16 v[174:177], v[234:237], a[176:179], v[174:177]
    s_mov_b32 s26, s25
    ds_read_b128 v[222:225], v1 offset:26752
    v_cvt_pk_bf16_f32 v147, v196, v197
    v_mfma_f32_16x16x32_bf16 v[174:177], v[158:161], a[180:183], v[174:177]
    s_mov_b32 s25, s24
    v_rsq_f32 v211, v211
    v_mfma_f32_16x16x32_bf16 v[174:177], v[182:185], a[184:187], v[174:177]
    s_mov_b32 s24, s23
    v_rsq_f32 v210, v210
    v_mfma_f32_16x16x32_bf16 v[174:177], v[206:209], a[188:191], v[174:177]
    s_ff1_i32_b32 s80, s100
    v_mul_f32 v210, s31, v210
    v_mul_f32 v130, v211, v130
    v_mul_f32 v131, v211, v131
    v_cvt_pk_f16_f32 v178, v130, v131
    v_mfma_f32_16x16x32_bf16 v[194:197], v[186:189], a[192:195], 0
    s_waitcnt lgkmcnt(3)
    ds_read_b128 v[186:189], v0 offset:26880
    v_cvt_pk_bf16_f32 v174, v174, v175
    v_mfma_f32_16x16x32_bf16 v[194:197], v[118:121], a[196:199], v[194:197]
    s_mov_b32 s71, s72
    ds_read_b128 v[226:229], v1 offset:26880
    v_cvt_pk_bf16_f32 v175, v176, v177
    v_mfma_f32_16x16x32_bf16 v[194:197], v[234:237], a[200:203], v[194:197]
    s_mov_b32 s72, s73
    v_mul_f32 v132, v211, v132
    v_mul_f32 v133, v211, v133
    v_mfma_f32_16x16x32_bf16 v[194:197], v[158:161], a[204:207], v[194:197]
    s_waitcnt lgkmcnt(2)
    v_cvt_pk_f16_f32 v179, v132, v133
    v_mul_f32 v134, v211, v134
    v_mfma_f32_16x16x32_bf16 v[194:197], v[182:185], a[208:211], v[194:197]
    v_mul_f32 v135, v211, v135
    v_cvt_pk_f16_f32 v180, v134, v135
    v_mfma_f32_16x16x32_bf16 v[194:197], v[206:209], a[212:215], v[194:197]
    v_mul_f32 v136, v211, v136
    v_mul_f32 v137, v211, v137
    v_mfma_f32_16x16x32_bf16 v[130:133], a[72:75], v[214:217], 0
    v_cvt_pk_f16_f32 v181, v136, v137
    v_mul_f32 v170, v211, v170
    v_mfma_f32_16x16x32_bf16 v[130:133], a[76:79], v[198:201], v[130:133]
    v_mul_f32 v171, v211, v171
    v_cvt_pk_f16_f32 v120, v170, v171
    v_mfma_f32_16x16x32_bf16 v[130:133], a[80:83], v[218:221], v[130:133]
    s_waitcnt lgkmcnt(1)
    v_cvt_pk_bf16_f32 v134, v194, v195
    v_cvt_pk_bf16_f32 v135, v196, v197
    v_mfma_f32_16x16x32_bf16 v[130:133], a[84:87], v[222:225], v[130:133]
    s_waitcnt lgkmcnt(0)
    v_mul_f32 v172, v211, v172
    v_mul_f32 v173, v211, v173
    v_mfma_f32_16x16x32_bf16 v[130:133], a[88:91], v[186:189], v[130:133]
    v_cvt_pk_f16_f32 v121, v172, v173
    v_mul_f32 v142, v210, v142
    v_mfma_f32_16x16x32_bf16 v[130:133], a[92:95], v[226:229], v[130:133]
    v_mul_f32 v143, v210, v143
    v_cvt_pk_f16_f32 v194, v142, v143
    v_mfma_f32_16x16x32_bf16 v[158:161], a[96:99], v[214:217], 0
    v_mul_f32 v144, v210, v144
    v_mul_f32 v145, v210, v145
    v_mfma_f32_16x16x32_bf16 v[158:161], a[100:103], v[198:201], v[158:161]
    v_cvt_pk_f16_f32 v195, v144, v145
    v_mul_f32 v126, v210, v126
    v_mfma_f32_16x16x32_bf16 v[158:161], a[104:107], v[218:221], v[158:161]
    v_mul_f32 v127, v210, v127
    v_cvt_pk_f16_f32 v196, v126, v127
    v_mfma_f32_16x16x32_bf16 v[158:161], a[108:111], v[222:225], v[158:161]
    v_mul_f32 v128, v210, v128
    v_mul_f32 v129, v210, v129
    v_mfma_f32_16x16x32_bf16 v[158:161], a[112:115], v[186:189], v[158:161]
    v_cvt_pk_f16_f32 v197, v128, v129
    v_mul_f32 v190, v210, v190
    v_mfma_f32_16x16x32_bf16 v[158:161], a[116:119], v[226:229], v[158:161]
    v_mul_f32 v191, v210, v191
    v_cvt_pk_f16_f32 v118, v190, v191
    v_mfma_f32_16x16x32_bf16 v[142:145], a[120:123], v[214:217], 0
    v_mul_f32 v192, v210, v192
    v_mul_f32 v193, v210, v193
    v_mfma_f32_16x16x32_bf16 v[142:145], a[124:127], v[198:201], v[142:145]
    v_cvt_pk_f16_f32 v119, v192, v193
    v_fma_f32 v149, v130, v130, s32
    v_mfma_f32_16x16x32_bf16 v[142:145], a[128:131], v[218:221], v[142:145]
    v_fmac_f32 v149, v131, v131
    v_fmac_f32 v149, v132, v132
    v_mfma_f32_16x16x32_bf16 v[142:145], a[132:135], v[222:225], v[142:145]
    v_fmac_f32 v149, v133, v133
    v_fmac_f32 v149, v158, v158
    v_mfma_f32_16x16x32_bf16 v[142:145], a[136:139], v[186:189], v[142:145]
    v_fmac_f32 v149, v159, v159
    v_fmac_f32 v149, v160, v160
    v_mfma_f32_16x16x32_bf16 v[142:145], a[140:143], v[226:229], v[142:145]
    v_fmac_f32 v149, v161, v161
    v_mul_f32 v123, v254, v123
    v_mfma_f32_16x16x32_bf16 v[170:173], a[0:3], v[214:217], 0
    v_rsq_f32 v255, v255
    v_mfma_f32_16x16x32_bf16 v[170:173], a[4:7], v[198:201], v[170:173]
    v_rsq_f32 v148, v148
    v_mfma_f32_16x16x32_bf16 v[170:173], a[8:11], v[218:221], v[170:173]
    v_mul_f32 v150, v148, v150
    v_fmac_f32 v149, v142, v142
    v_mfma_f32_16x16x32_bf16 v[170:173], a[12:15], v[222:225], v[170:173]
    v_fmac_f32 v149, v143, v143
    v_fmac_f32 v149, v144, v144
    v_mfma_f32_16x16x32_bf16 v[170:173], a[16:19], v[186:189], v[170:173]
    v_fmac_f32 v149, v145, v145
    v_mul_f32 v151, v148, v151
    v_mfma_f32_16x16x32_bf16 v[170:173], a[20:23], v[226:229], v[170:173]
    v_cvt_pk_bf16_f32 v126, v150, v151
    v_mul_f32 v152, v148, v152
    v_mfma_f32_16x16x32_bf16 v[182:185], a[24:27], v[214:217], 0
    v_mul_f32 v153, v148, v153
    v_cvt_pk_bf16_f32 v127, v152, v153
    v_mfma_f32_16x16x32_bf16 v[182:185], a[28:31], v[198:201], v[182:185]
    v_mul_f32 v162, v148, v162
    v_mul_f32 v163, v148, v163
    v_mfma_f32_16x16x32_bf16 v[182:185], a[32:35], v[218:221], v[182:185]
    v_fma_f32 v136, v170, v170, s32
    v_fmac_f32 v136, v171, v171
    v_mfma_f32_16x16x32_bf16 v[182:185], a[36:39], v[222:225], v[182:185]
    v_fmac_f32 v136, v172, v172
    v_fmac_f32 v136, v173, v173
    v_mfma_f32_16x16x32_bf16 v[182:185], a[40:43], v[186:189], v[182:185]
    v_cvt_pk_bf16_f32 v128, v162, v163
    v_mul_f32 v164, v148, v164
    v_mfma_f32_16x16x32_bf16 v[182:185], a[44:47], v[226:229], v[182:185]
    v_mul_f32 v165, v148, v165
    v_cvt_pk_bf16_f32 v129, v164, v165
    v_mfma_f32_16x16x32_bf16 v[162:165], a[48:51], v[214:217], 0
    buffer_store_dwordx4 v[126:129], v17, s[12:15], 0 offen nt
    v_mul_f32 v138, v148, v138
    v_mul_f32 v139, v148, v139
    v_cvt_pk_bf16_f32 v176, v138, v139
    v_mul_f32 v140, v148, v140
    v_mfma_f32_16x16x32_bf16 v[162:165], a[52:55], v[198:201], v[162:165]
    v_fmac_f32 v136, v182, v182
    v_fmac_f32 v136, v183, v183
    v_mfma_f32_16x16x32_bf16 v[162:165], a[56:59], v[218:221], v[162:165]
    v_fmac_f32 v136, v184, v184
    v_fmac_f32 v136, v185, v185
    v_mfma_f32_16x16x32_bf16 v[162:165], a[60:63], v[222:225], v[162:165]
    v_mul_f32 v141, v148, v141
    v_cvt_pk_bf16_f32 v177, v140, v141
    v_mfma_f32_16x16x32_bf16 v[162:165], a[64:67], v[186:189], v[162:165]
    v_cvt_pk_bf16_f32 v190, v122, v123
    v_mul_f32 v124, v254, v124
    v_mfma_f32_16x16x32_bf16 v[162:165], a[68:71], v[226:229], v[162:165]
    v_mul_f32 v125, v254, v125
    v_cvt_pk_bf16_f32 v191, v124, v125
    v_mfma_f32_16x16x32_bf16 v[122:125], v[214:217], a[144:147], 0
    v_mul_f32 v154, v254, v154
    v_mul_f32 v155, v254, v155
    v_mfma_f32_16x16x32_bf16 v[122:125], v[198:201], a[148:151], v[122:125]
    v_cvt_pk_bf16_f32 v192, v154, v155
    v_mul_f32 v156, v254, v156
    v_mfma_f32_16x16x32_bf16 v[122:125], v[218:221], a[152:155], v[122:125]
    v_fmac_f32 v136, v162, v162
    v_fmac_f32 v136, v163, v163
    v_mfma_f32_16x16x32_bf16 v[122:125], v[222:225], a[156:159], v[122:125]
    v_fmac_f32 v136, v164, v164
    v_fmac_f32 v136, v165, v165
    v_mfma_f32_16x16x32_bf16 v[122:125], v[186:189], a[160:163], v[122:125]
    v_cvt_pk_bf16_f32 v36, v136, v149
    v_mul_f32 v157, v254, v157
    v_mfma_f32_16x16x32_bf16 v[122:125], v[226:229], a[164:167], v[122:125]
    ds_read_b128 v[206:209], v0 offset:32768
    v_cvt_pk_bf16_f32 v193, v156, v157
    v_mfma_f32_16x16x32_bf16 v[154:157], v[32:35], v[36:39], 0
    v_mul_f32 v202, v254, v202
    v_mul_f32 v203, v254, v203
    v_mfma_f32_16x16x32_bf16 v[126:129], v[214:217], a[168:171], 0
    ds_read_b128 v[210:213], v1 offset:32768
    v_cvt_pk_bf16_f32 v234, v202, v203
    v_mfma_f32_16x16x32_bf16 v[126:129], v[198:201], a[172:175], v[126:129]
    ds_read_b128 v[238:241], v0 offset:32896
    v_cvt_pk_bf16_f32 v148, v122, v123
    v_mfma_f32_16x16x32_bf16 v[126:129], v[218:221], a[176:179], v[126:129]
    ds_read_b128 v[242:245], v1 offset:32896
    v_cvt_pk_bf16_f32 v149, v124, v125
    v_mfma_f32_16x16x32_bf16 v[126:129], v[222:225], a[180:183], v[126:129]
    v_rsq_f32 v155, v155
    v_mfma_f32_16x16x32_bf16 v[126:129], v[186:189], a[184:187], v[126:129]
    buffer_store_dwordx2 v[176:177], v20, s[12:15], 0 offen nt
    v_rsq_f32 v154, v154
    v_mfma_f32_16x16x32_bf16 v[126:129], v[226:229], a[188:191], v[126:129]
    s_waitcnt lgkmcnt(3)
    v_mul_f32 v154, s31, v154
    v_mul_f32 v130, v155, v130
    v_mul_f32 v131, v155, v131
    v_cvt_pk_f16_f32 v138, v130, v131
    v_mfma_f32_16x16x32_bf16 v[122:125], v[214:217], a[192:195], 0
    ds_read_b128 v[214:217], v0 offset:33024
    v_mul_f32 v132, v155, v132
    v_mfma_f32_16x16x32_bf16 v[122:125], v[198:201], a[196:199], v[122:125]
    s_waitcnt lgkmcnt(3)
    ds_read_b128 v[198:201], v1 offset:33024
    v_cvt_pk_bf16_f32 v176, v126, v127
    v_mfma_f32_16x16x32_bf16 v[122:125], v[218:221], a[200:203], v[122:125]
    s_waitcnt lgkmcnt(3)
    v_cvt_pk_bf16_f32 v177, v128, v129
    v_mul_f32 v133, v155, v133
    v_mfma_f32_16x16x32_bf16 v[122:125], v[222:225], a[204:207], v[122:125]
    s_waitcnt vmcnt(2)
    ds_write_b16 v8, v45 offset:512
    v_mfma_f32_16x16x32_bf16 v[122:125], v[186:189], a[208:211], v[122:125]
    s_waitcnt lgkmcnt(3)
    v_mov_b32 v45, 1
    v_cvt_pk_f16_f32 v139, v132, v133
    v_mfma_f32_16x16x32_bf16 v[122:125], v[226:229], a[212:215], v[122:125]
    v_mul_f32 v158, v155, v158
    v_mul_f32 v159, v155, v159
    v_mfma_f32_16x16x32_bf16 v[130:133], a[72:75], v[206:209], 0
    v_cvt_pk_f16_f32 v140, v158, v159
    v_mul_f32 v160, v155, v160
    v_mfma_f32_16x16x32_bf16 v[130:133], a[76:79], v[210:213], v[130:133]
    v_mul_f32 v161, v155, v161
    v_cvt_pk_f16_f32 v141, v160, v161
    v_mfma_f32_16x16x32_bf16 v[130:133], a[80:83], v[238:241], v[130:133]
    s_waitcnt lgkmcnt(2)
    v_cvt_pk_bf16_f32 v136, v122, v123
    v_cvt_pk_bf16_f32 v137, v124, v125
    v_mfma_f32_16x16x32_bf16 v[130:133], a[84:87], v[242:245], v[130:133]
    s_waitcnt lgkmcnt(1)
    v_mul_f32 v142, v155, v142
    v_mul_f32 v143, v155, v143
    v_mfma_f32_16x16x32_bf16 v[130:133], a[88:91], v[214:217], v[130:133]
    v_cvt_pk_f16_f32 v128, v142, v143
    v_mul_f32 v144, v155, v144
    v_mfma_f32_16x16x32_bf16 v[130:133], a[92:95], v[198:201], v[130:133]
    s_waitcnt lgkmcnt(0)
    v_mul_f32 v145, v155, v145
    v_cvt_pk_f16_f32 v129, v144, v145
    v_mfma_f32_16x16x32_bf16 v[218:221], a[96:99], v[206:209], 0
    s_barrier
    v_mul_f32 v170, v154, v170
    v_mul_f32 v171, v154, v171
    v_mfma_f32_16x16x32_bf16 v[218:221], a[100:103], v[210:213], v[218:221]
    v_cvt_pk_f16_f32 v150, v170, v171
    v_mul_f32 v172, v154, v172
    v_mfma_f32_16x16x32_bf16 v[218:221], a[104:107], v[238:241], v[218:221]
    v_mul_f32 v173, v154, v173
    v_cvt_pk_f16_f32 v151, v172, v173
    v_mfma_f32_16x16x32_bf16 v[218:221], a[108:111], v[242:245], v[218:221]
    buffer_load_dwordx4 v10, s[8:11], 0 offen nt lds
    ds_read_u16 v202, v9 offset:512
    v_mfma_f32_16x16x32_bf16 v[218:221], a[112:115], v[214:217], v[218:221]
    s_add_u32 m0, s28, 4096
    v_mul_f32 v182, v154, v182
    v_mul_f32 v183, v154, v183
    v_mfma_f32_16x16x32_bf16 v[218:221], a[116:119], v[198:201], v[218:221]
    v_cvt_pk_f16_f32 v152, v182, v183
    v_mul_f32 v184, v154, v184
    v_mfma_f32_16x16x32_bf16 v[226:229], a[120:123], v[206:209], 0
    v_mul_f32 v185, v154, v185
    v_cvt_pk_f16_f32 v153, v184, v185
    v_mfma_f32_16x16x32_bf16 v[226:229], a[124:127], v[210:213], v[226:229]
    v_mul_f32 v162, v154, v162
    v_mul_f32 v163, v154, v163
    v_mfma_f32_16x16x32_bf16 v[226:229], a[128:131], v[238:241], v[226:229]
    buffer_load_dwordx4 v11, s[8:11], 0 offen nt lds
    v_cvt_pk_f16_f32 v126, v162, v163
    v_mfma_f32_16x16x32_bf16 v[226:229], a[132:135], v[242:245], v[226:229]
    s_add_u32 m0, s28, 8192
    v_mul_f32 v164, v154, v164
    v_mul_f32 v165, v154, v165
    v_mfma_f32_16x16x32_bf16 v[226:229], a[136:139], v[214:217], v[226:229]
    v_cvt_pk_f16_f32 v127, v164, v165
    v_mul_f32 v204, v254, v204
    v_mfma_f32_16x16x32_bf16 v[226:229], a[140:143], v[198:201], v[226:229]
    s_waitcnt lgkmcnt(0)
    v_readfirstlane_b32 s77, v202
    v_mul_f32 v205, v254, v205
    v_mfma_f32_16x16x32_bf16 v[162:165], a[0:3], v[206:209], 0
    v_cvt_pk_bf16_f32 v235, v204, v205
    v_fma_f32 v236, v130, v130, s32
    v_mfma_f32_16x16x32_bf16 v[162:165], a[4:7], v[210:213], v[162:165]
    buffer_load_dwordx4 v12, s[8:11], 0 offen nt lds
    v_fmac_f32 v236, v131, v131
    v_mfma_f32_16x16x32_bf16 v[162:165], a[8:11], v[238:241], v[162:165]
    s_add_u32 m0, s28, 12288
    v_fmac_f32 v236, v132, v132
    v_fmac_f32 v236, v133, v133
    v_mfma_f32_16x16x32_bf16 v[162:165], a[12:15], v[242:245], v[162:165]
    s_xor_b32 s28, s28, 65536
    v_fmac_f32 v236, v218, v218
    v_fmac_f32 v236, v219, v219
    v_mfma_f32_16x16x32_bf16 v[162:165], a[16:19], v[214:217], v[162:165]
    v_fmac_f32 v236, v220, v220
    v_fmac_f32 v236, v221, v221
    v_mfma_f32_16x16x32_bf16 v[162:165], a[20:23], v[198:201], v[162:165]
    v_fmac_f32 v236, v226, v226
    v_fmac_f32 v236, v227, v227
    v_mfma_f32_16x16x32_bf16 v[246:249], a[24:27], v[206:209], 0
    buffer_load_dwordx4 v13, s[8:11], 0 offen nt lds
    v_fmac_f32 v236, v228, v228
    v_mfma_f32_16x16x32_bf16 v[246:249], a[28:31], v[210:213], v[246:249]
    s_mov_b32 m0, s29
    v_fmac_f32 v236, v229, v229
    v_fma_f32 v237, v162, v162, s32
    v_mfma_f32_16x16x32_bf16 v[246:249], a[32:35], v[238:241], v[246:249]
    s_xor_b32 s29, s29, s30
    v_fmac_f32 v237, v163, v163
    v_fmac_f32 v237, v164, v164
    v_mfma_f32_16x16x32_bf16 v[246:249], a[36:39], v[242:245], v[246:249]
    s_add_u32 s19, s19, s20
    v_fmac_f32 v237, v165, v165
    v_mul_f32 v114, v255, v114
    v_mfma_f32_16x16x32_bf16 v[246:249], a[40:43], v[214:217], v[246:249]
    s_add_u32 s23, s23, s21
    v_mul_f32 v115, v255, v115
    v_cvt_pk_bf16_f32 v114, v114, v115
    v_mfma_f32_16x16x32_bf16 v[246:249], a[44:47], v[198:201], v[246:249]
    buffer_load_dwordx4 v14, s[8:11], 0 offen nt lds
    v_mul_f32 v116, v255, v116
    v_mfma_f32_16x16x32_bf16 v[122:125], a[48:51], v[206:209], 0
    s_cmp_ge_u32 s19, 72
    v_mul_f32 v117, v255, v117
    v_cvt_pk_bf16_f32 v115, v116, v117
    v_mfma_f32_16x16x32_bf16 v[122:125], a[52:55], v[210:213], v[122:125]
    s_cselect_b32 s34, 72, 0
    v_fmac_f32 v237, v246, v246
    v_fmac_f32 v237, v247, v247
    v_mfma_f32_16x16x32_bf16 v[122:125], a[56:59], v[238:241], v[122:125]
    s_cselect_b32 s35, s22, 0
    v_fmac_f32 v237, v248, v248
    v_fmac_f32 v237, v249, v249
    v_mfma_f32_16x16x32_bf16 v[122:125], a[60:63], v[242:245], v[122:125]
    s_sub_u32 s19, s19, s34
    v_mul_f32 v166, v255, v166
    v_mul_f32 v167, v255, v167
    v_mfma_f32_16x16x32_bf16 v[122:125], a[64:67], v[214:217], v[122:125]
    buffer_store_dwordx4 v[190:193], v15, s[12:15], 0 offen nt
    v_cvt_pk_bf16_f32 v116, v166, v167
    v_mul_f32 v168, v255, v168
    v_mul_f32 v169, v255, v169
    v_cvt_pk_bf16_f32 v117, v168, v169
    v_mfma_f32_16x16x32_bf16 v[122:125], a[68:71], v[198:201], v[122:125]
    s_add_u32 s23, s23, s35
    v_mul_f32 v230, v255, v230
    v_mul_f32 v231, v255, v231
    v_mfma_f32_16x16x32_bf16 v[154:157], v[206:209], a[144:147], 0
    s_cmp_lg_u32 s83, 0
    v_cvt_pk_bf16_f32 v254, v230, v231
    v_mul_f32 v232, v255, v232
    v_mfma_f32_16x16x32_bf16 v[154:157], v[210:213], a[148:151], v[154:157]
    s_cselect_b32 s77, s80, s77
    v_fmac_f32 v237, v122, v122
    v_fmac_f32 v237, v123, v123
    v_mfma_f32_16x16x32_bf16 v[154:157], v[238:241], a[152:155], v[154:157]
    s_mul_i32 s78, s77, 2688
    v_fmac_f32 v237, v124, v124
    v_fmac_f32 v237, v125, v125
    v_mfma_f32_16x16x32_bf16 v[154:157], v[242:245], a[156:159], v[154:157]
    s_add_u32 s78, s78, s69
    ds_read2_b32 v[144:145], v6 offset0:0 offset1:0
    ds_read2_b32 v[172:173], v6 offset0:16 offset1:16
    v_mfma_f32_16x16x32_bf16 v[154:157], v[214:217], a[160:163], v[154:157]
    s_add_u32 s80, s77, s68
    ds_read2_b32 v[192:193], v6 offset0:32 offset1:32
    v_cvt_pk_bf16_f32 v36, v237, v236
    v_mfma_f32_16x16x32_bf16 v[154:157], v[198:201], a[164:167], v[154:157]
    s_cmp_ge_u32 s80, 72
    v_mul_f32 v233, v255, v233
    v_cvt_pk_bf16_f32 v255, v232, v233
    v_mfma_f32_16x16x32_bf16 v[230:233], v[32:35], v[36:39], 0
    s_cselect_b32 s80, s22, 0
    v_xor_b32 v0, 65536, v0
    v_xor_b32 v1, 65536, v1
    v_mfma_f32_16x16x32_bf16 v[166:169], v[206:209], a[168:171], 0
    s_add_u32 s78, s78, s80
    v_cvt_pk_bf16_f32 v142, v154, v155
    v_cvt_pk_bf16_f32 v143, v156, v157
    v_mfma_f32_16x16x32_bf16 v[166:169], v[210:213], a[172:175], v[166:169]
    s_add_u32 s80, s77, 20
    v_rsq_f32 v231, v231
    v_mfma_f32_16x16x32_bf16 v[166:169], v[238:241], a[176:179], v[166:169]
    s_add_u32 s34, s18, 3
    v_rsq_f32 v230, v230
    v_mfma_f32_16x16x32_bf16 v[166:169], v[242:245], a[180:183], v[166:169]
    s_cmp_lt_u32 s77, s62
    v_mul_f32 v230, s31, v230
    v_mul_f32 v130, v231, v130
    v_mfma_f32_16x16x32_bf16 v[166:169], v[214:217], a[184:187], v[166:169]
    s_cselect_b32 s79, 1, 0
    v_mul_f32 v131, v231, v131
    v_cvt_pk_f16_f32 v158, v130, v131
    v_mfma_f32_16x16x32_bf16 v[166:169], v[198:201], a[188:191], v[166:169]
    s_cselect_b32 s78, s78, 0
    v_mul_f32 v132, v231, v132
    v_mul_f32 v133, v231, v133
    v_mfma_f32_16x16x32_bf16 v[250:253], v[206:209], a[192:195], 0
    s_cmp_lt_u32 s34, s17
    v_cvt_pk_f16_f32 v159, v132, v133
    v_mul_f32 v218, v231, v218
    v_mfma_f32_16x16x32_bf16 v[250:253], v[210:213], a[196:199], v[250:253]
    s_cselect_b32 s23, s23, s78
    v_cvt_pk_bf16_f32 v170, v166, v167
    v_cvt_pk_bf16_f32 v171, v168, v169
    v_mfma_f32_16x16x32_bf16 v[250:253], v[238:241], a[200:203], v[250:253]
    s_cselect_b32 s73, s34, s80
    ds_read_b128 v[222:225], v5 offset:0
    ds_read_b128 v[202:205], v5 offset:16
    v_mfma_f32_16x16x32_bf16 v[250:253], v[242:245], a[204:207], v[250:253]
    s_cselect_b32 s79, 0, s79
    ds_read_b128 v[154:157], v5 offset:48
    ds_read_b32 v232, v6 offset:192
    v_mfma_f32_16x16x32_bf16 v[250:253], v[214:217], a[208:211], v[250:253]
    s_waitcnt lgkmcnt(4)
    buffer_store_dwordx2 v[234:235], v18, s[12:15], 0 offen nt
    v_mul_f32 v219, v231, v219
    v_cvt_pk_f16_f32 v160, v218, v219
    v_mfma_f32_16x16x32_f16 v[186:189], v[178:181], v[194:197], v[46:49]
    s_cselect_b32 s81, 0, 1
    v_mul_f32 v220, v231, v220
    v_mul_f32 v221, v231, v221
    v_mfma_f32_16x16x32_f16 v[182:185], v[138:141], v[194:197], v[50:53]
    s_add_u32 s80, s77, 1
    v_cvt_pk_f16_f32 v161, v220, v221
    v_mul_f32 v226, v231, v226
    v_mul_f32 v227, v231, v227
    v_mfma_f32_16x16x32_f16 v[166:169], v[158:161], v[194:197], v[54:57]
    s_mul_i32 s80, s80, s81
    v_cvt_pk_f16_f32 v132, v226, v227
    v_mul_f32 v228, v231, v228
    v_mul_f32 v229, v231, v229
    v_mfma_f32_16x16x16_f16 v[186:189], v[120:121], v[118:119], v[186:189]
    v_cvt_pk_f16_f32 v133, v228, v229
    v_mul_f32 v162, v230, v162
    v_mul_f32 v163, v230, v163
    v_mfma_f32_16x16x16_f16 v[182:185], v[128:129], v[118:119], v[182:185]
    v_cvt_pk_f16_f32 v162, v162, v163
    v_mul_f32 v164, v230, v164
    v_mul_f32 v165, v230, v165
    v_mfma_f32_16x16x16_f16 v[166:169], v[132:133], v[118:119], v[166:169]
    v_cvt_pk_f16_f32 v163, v164, v165
    v_mul_f32 v246, v230, v246
    v_mul_f32 v247, v230, v247
    v_cvt_pk_f16_f32 v164, v246, v247
    v_mfma_f32_16x16x32_bf16 v[250:253], v[198:201], a[212:215], v[250:253]
    s_waitcnt lgkmcnt(0)
    ds_read_b128 v[214:217], v2 offset:0
    ds_read_b128 v[206:209], v2 offset:1024
    v_mfma_f32_16x16x32_f16 v[226:229], v[222:225], v[194:197], v[22:25]
    s_cmp_lt_u32 s80, s62
    ds_read_b128 v[210:213], v2 offset:2048
    ds_read_b128 v[194:197], v2 offset:3072
    v_mfma_f32_16x16x32_f16 v[226:229], v[202:205], v[178:181], v[226:229]
    s_cselect_b32 s70, s70, 0
    v_cvt_pk_bf16_f32 v190, v250, v251
    v_cvt_pk_bf16_f32 v191, v252, v253
    v_mfma_f32_16x16x32_f16 v[226:229], v[154:157], v[118:121], v[226:229]
    s_cselect_b32 s62, s62, 0
    ds_read_b128 v[198:201], v2 offset:4096
    v_mul_f32 v248, v230, v248
    v_mul_f32 v249, v230, v249
    v_cvt_pk_f16_f32 v165, v248, v249
    v_mfma_f32_16x16x32_f16 v[218:221], v[222:225], v[150:153], v[24:27]
    s_add_u32 s80, s18, 4
    v_mul_f32 v122, v230, v122
    v_mul_f32 v123, v230, v123
    v_mfma_f32_16x16x32_f16 v[218:221], v[202:205], v[138:141], v[218:221]
    s_cmp_ge_u32 s80, s17
    v_cvt_pk_f16_f32 v130, v122, v123
    v_mul_f32 v124, v230, v124
    v_mfma_f32_16x16x32_f16 v[218:221], v[154:157], v[126:129], v[218:221]
    s_cselect_b32 s66, s70, 0
    v_mul_f32 v125, v230, v125
    v_cvt_pk_f16_f32 v131, v124, v125
    v_mfma_f32_16x16x32_f16 v[238:241], v[222:225], v[162:165], v[26:29]
    s_waitcnt lgkmcnt(3)
    ds_read_b128 v[222:225], v2 offset:5120
    v_mov_b32_dpp v232, v227 quad_perm:[0,1,2,3] row_mask:0x1 bank_mask:0xf
    v_mfma_f32_16x16x32_f16 v[238:241], v[202:205], v[158:161], v[238:241]
    s_lshl_b32 s80, s79, s73
    v_mov_b32_dpp v232, v219 quad_perm:[0,1,2,3] row_mask:0x2 bank_mask:0xf
    v_max3_f32 v118, v226, v186, v187
    v_mfma_f32_16x16x32_f16 v[238:241], v[154:157], v[130:133], v[238:241]
    s_waitcnt lgkmcnt(2)
    buffer_atomic_add v45, v10, s[64:67], 0 offen sc0 sc1
    buffer_store_dwordx4 v[114:117], v16, s[12:15], 0 offen nt
    v_max3_f32 v118, v118, v188, v189
    v_max3_f32 v118, v118, v182, v183
    v_max3_f32 v118, v118, v184, v185
    v_max3_f32 v118, v118, v166, v167
    v_mfma_f32_16x16x32_bf16 v[122:125], a[216:219], v[214:217], 0
    s_or_b32 s63, s63, s80
    v_max3_f32 v118, v118, v168, v169
    v_mov_b32 v119, v118
    v_mfma_f32_16x16x32_bf16 v[122:125], a[220:223], v[206:209], v[122:125]
    s_sub_u32 s80, s100, s81
    v_permlane32_swap_b32 v118, v119
    v_mfma_f32_16x16x32_bf16 v[122:125], a[224:227], v[210:213], v[122:125]
    s_and_b32 s100, s100, s80
    v_max_f32 v118, v118, v119
    v_mov_b32 v119, v118
    v_mfma_f32_16x16x32_bf16 v[122:125], a[228:231], v[194:197], v[122:125]
    s_waitcnt lgkmcnt(1)
    v_permlane16_swap_b32 v118, v119
    v_mfma_f32_16x16x32_bf16 v[122:125], a[232:235], v[198:201], v[122:125]
    s_waitcnt lgkmcnt(0)
    v_max_f32 v118, v118, v119
    v_sub_f32 v186, v186, v118
    v_mfma_f32_16x16x32_bf16 v[122:125], a[236:239], v[222:225], v[122:125]
    s_add_u32 s45, s45, s79
    v_exp_f32 v186, v186
    v_mfma_f32_16x16x32_bf16 v[154:157], a[240:243], v[214:217], 0
    s_add_u32 s18, s18, 1
    v_sub_f32 v187, v187, v118
    v_sub_f32 v188, v188, v118
    v_mfma_f32_16x16x32_bf16 v[154:157], a[244:247], v[206:209], v[154:157]
    s_cmp_lt_u32 s18, s45
    v_exp_f32 v187, v187
    v_mfma_f32_16x16x32_bf16 v[154:157], a[248:251], v[210:213], v[154:157]
    v_cvt_pk_bf16_f32 v186, v186, v187
    v_sub_f32 v189, v189, v118
    v_mfma_f32_16x16x32_bf16 v[154:157], a[252:255], v[194:197], v[154:157]
    v_exp_f32 v188, v188
    v_mfma_f32_16x16x32_bf16 v[154:157], v[82:85], v[198:201], v[154:157]
    v_exp_f32 v189, v189
    v_mfma_f32_16x16x32_bf16 v[154:157], v[86:89], v[222:225], v[154:157]
    v_cvt_pk_bf16_f32 v187, v188, v189
    v_sub_f32 v182, v182, v118
    v_mfma_f32_16x16x32_bf16 v[202:205], v[90:93], v[214:217], 0
    ds_read_b128 v[214:217], v2 offset:6144
    v_sub_f32 v183, v183, v118
    v_mfma_f32_16x16x32_bf16 v[202:205], v[94:97], v[206:209], v[202:205]
    ds_read_b128 v[206:209], v2 offset:7168
    v_sub_f32 v184, v184, v118
    v_mfma_f32_16x16x32_bf16 v[202:205], v[98:101], v[210:213], v[202:205]
    ds_read_b128 v[210:213], v2 offset:8192
    v_sub_f32 v185, v185, v118
    v_mfma_f32_16x16x32_bf16 v[202:205], v[102:105], v[194:197], v[202:205]
    ds_read_b128 v[194:197], v2 offset:9216
    buffer_store_dwordx2 v[254:255], v19, s[12:15], 0 offen nt
    v_exp_f32 v182, v182
    v_mfma_f32_16x16x32_f16 v[234:237], v[178:181], v[150:153], v[58:61]
    v_exp_f32 v183, v183
    v_mfma_f32_16x16x32_bf16 v[202:205], v[106:109], v[198:201], v[202:205]
    ds_read_b128 v[198:201], v2 offset:10240
    v_cvt_pk_bf16_f32 v188, v182, v183
    v_mfma_f32_16x16x32_bf16 v[202:205], v[110:113], v[222:225], v[202:205]
    ds_read_b128 v[222:225], v2 offset:11264
    v_exp_f32 v184, v184
    v_mfma_f32_16x16x16_f16 v[234:237], v[120:121], v[126:127], v[234:237]
    v_exp_f32 v185, v185
    v_sub_f32 v166, v166, v118
    v_cvt_pk_bf16_f32 v189, v184, v185
    v_mfma_f32_16x16x32_f16 v[182:185], v[138:141], v[150:153], v[62:65]
    s_waitcnt lgkmcnt(4)
    v_exp_f32 v166, v166
    v_sub_f32 v167, v167, v118
    v_exp_f32 v167, v167
    v_sub_f32 v168, v168, v118
    v_cvt_pk_bf16_f32 v36, v166, v167
    v_mfma_f32_16x16x16_f16 v[182:185], v[128:129], v[126:127], v[182:185]
    v_exp_f32 v168, v168
    v_sub_f32 v169, v169, v118
    v_sub_f32 v226, v226, v118
    v_mfma_f32_16x16x32_f16 v[242:245], v[158:161], v[150:153], v[66:69]
    s_waitcnt lgkmcnt(2)
    v_exp_f32 v169, v169
    v_mfma_f32_16x16x32_bf16 v[114:117], a[216:219], v[214:217], 0
    s_waitcnt lgkmcnt(1)
    v_cvt_pk_bf16_f32 v37, v168, v169
    v_mov_b32_dpp v232, v239 quad_perm:[0,1,2,3] row_mask:0x4 bank_mask:0xf
    v_mov_b32 v118, v232
    v_mfma_f32_16x16x16_f16 v[242:245], v[132:133], v[126:127], v[242:245]
    v_exp_f32 v226, v226
    v_max_f32_dpp v118, v118, v118 quad_perm:[1,0,3,2] row_mask:0xf bank_mask:0xf
    v_cvt_pk_bf16_f32 v39, v226, 0
    v_mfma_f32_16x16x32_bf16 v[114:117], a[220:223], v[206:209], v[114:117]
    s_waitcnt lgkmcnt(0)
    v_max_f32_dpp v118, v118, v118 quad_perm:[2,3,0,1] row_mask:0xf bank_mask:0xf
    v_max3_f32 v126, v218, v234, v235
    v_mfma_f32_16x16x32_bf16 v[150:153], v[28:31], v[36:39], 0
    v_max_f32_dpp v118, v118, v118 row_half_mirror row_mask:0xf bank_mask:0xf
    v_max3_f32 v126, v126, v236, v237
    v_mfma_f32_16x16x32_bf16 v[150:153], v[28:31], v[186:189], v[150:153]
    v_max_f32_dpp v118, v118, v118 row_mirror row_mask:0xf bank_mask:0xf
    v_mov_b32 v119, v118
    v_mfma_f32_16x16x32_bf16 v[114:117], a[224:227], v[210:213], v[114:117]
    v_max3_f32 v126, v126, v182, v183
    v_max3_f32 v126, v126, v184, v185
    v_mfma_f32_16x16x32_bf16 v[114:117], a[228:231], v[194:197], v[114:117]
    v_permlane32_swap_b32 v118, v119
    v_mfma_f32_16x16x32_bf16 v[114:117], a[232:235], v[198:201], v[114:117]
    v_rcp_f32 v150, v150
    v_mfma_f32_16x16x32_bf16 v[114:117], a[236:239], v[222:225], v[114:117]
    v_max_f32 v118, v118, v119
    v_mov_b32 v119, v118
    v_max3_f32 v126, v126, v242, v243
    v_max3_f32 v126, v126, v244, v245
    v_permlane16_swap_b32 v118, v119
    v_max_f32 v118, v118, v119
    v_mfma_f32_16x16x32_bf16 v[166:169], v[142:145], v[36:39], 0
    v_sub_f32 v232, v232, v118
    v_mov_b32 v127, v126
    v_mfma_f32_16x16x32_bf16 v[166:169], v[146:149], v[186:189], v[166:169]
    v_exp_f32 v232, v232
    v_permlane32_swap_b32 v126, v127
    v_cvt_pk_bf16_f32 v232, v232, v232
    v_max_f32 v126, v126, v127
    v_mov_b32 v127, v126
    v_fma_f32 v254, v122, v122, s33
    v_fmac_f32 v254, v123, v123
    v_permlane16_swap_b32 v126, v127
    v_mul_f32 v166, v150, v166
    v_mul_f32 v167, v150, v167
    v_cvt_pk_bf16_f32 v166, v166, v167
    v_mul_f32 v168, v150, v168
    v_mul_f32 v169, v150, v169
    v_cvt_pk_bf16_f32 v167, v168, v169
    v_max_f32 v126, v126, v127
    v_sub_f32 v234, v234, v126
    v_exp_f32 v234, v234
    v_sub_f32 v235, v235, v126
    v_exp_f32 v235, v235
    v_sub_f32 v236, v236, v126
    v_cvt_pk_bf16_f32 v226, v234, v235
    v_exp_f32 v236, v236
    v_sub_f32 v237, v237, v126
    v_exp_f32 v237, v237
    v_sub_f32 v182, v182, v126
    v_cvt_pk_bf16_f32 v227, v236, v237
    v_mfma_f32_16x16x32_bf16 v[234:237], v[170:173], v[36:39], 0
    ds_write_b16 v8, v232
    v_mfma_f32_16x16x32_bf16 v[234:237], v[174:177], v[186:189], v[234:237]
    v_exp_f32 v182, v182
    v_sub_f32 v183, v183, v126
    v_exp_f32 v183, v183
    v_sub_f32 v184, v184, v126
    v_cvt_pk_bf16_f32 v228, v182, v183
    v_exp_f32 v184, v184
    v_sub_f32 v185, v185, v126
    v_exp_f32 v185, v185
    v_mul_f32 v234, v150, v234
    v_mul_f32 v235, v150, v235
    v_cvt_pk_bf16_f32 v168, v234, v235
    v_mul_f32 v236, v150, v236
    v_mul_f32 v237, v150, v237
    v_cvt_pk_bf16_f32 v169, v236, v237
    v_mfma_f32_16x16x32_bf16 v[230:233], v[190:193], v[36:39], 0
    ds_write_b128 v3, v[166:169] offset:0
    v_mfma_f32_16x16x32_bf16 v[230:233], v[134:137], v[186:189], v[230:233]
    v_cvt_pk_bf16_f32 v229, v184, v185
    v_sub_f32 v242, v242, v126
    v_mfma_f32_16x16x32_f16 v[182:185], v[178:181], v[162:165], v[70:73]
    v_exp_f32 v242, v242
    v_mfma_f32_16x16x32_bf16 v[166:169], a[240:243], v[214:217], 0
    ds_read_b128 v[178:181], v9
    v_sub_f32 v243, v243, v126
    v_mfma_f32_16x16x32_bf16 v[166:169], a[244:247], v[206:209], v[166:169]
    v_mul_f32 v230, v150, v230
    v_mul_f32 v231, v150, v231
    v_cvt_pk_bf16_f32 v220, v230, v231
    v_mfma_f32_16x16x16_f16 v[182:185], v[120:121], v[130:131], v[182:185]
    v_mul_f32 v232, v150, v232
    v_mul_f32 v233, v150, v233
    v_cvt_pk_bf16_f32 v221, v232, v233
    v_sub_f32 v244, v244, v126
    v_mfma_f32_16x16x32_bf16 v[166:169], a[248:251], v[210:213], v[166:169]
    ds_read_b128 v[118:121], v9 offset:64
    v_sub_f32 v245, v245, v126
    v_mfma_f32_16x16x32_bf16 v[166:169], a[252:255], v[194:197], v[166:169]
    ds_write_b64 v4, v[220:221] offset:4096
    v_mfma_f32_16x16x32_bf16 v[166:169], v[82:85], v[198:201], v[166:169]
    v_max3_f32 v255, v238, v182, v183
    v_max3_f32 v255, v255, v184, v185
    v_mfma_f32_16x16x32_bf16 v[166:169], v[86:89], v[222:225], v[166:169]
    v_exp_f32 v243, v243
    v_exp_f32 v244, v244
    v_cvt_pk_bf16_f32 v36, v242, v243
    v_mfma_f32_16x16x32_f16 v[186:189], v[138:141], v[162:165], v[74:77]
    s_waitcnt lgkmcnt(2)
    v_exp_f32 v245, v245
    v_mfma_f32_16x16x32_f16 v[246:249], v[158:161], v[162:165], v[78:81]
    v_cvt_pk_bf16_f32 v37, v244, v245
    v_sub_f32 v218, v218, v126
    v_mfma_f32_16x16x32_bf16 v[242:245], v[178:181], v[28:31], 0
    v_exp_f32 v218, v218
    v_fmac_f32 v254, v124, v124
    v_mfma_f32_16x16x16_f16 v[186:189], v[128:129], v[130:131], v[186:189]
    v_cvt_pk_bf16_f32 v39, v218, 0
    v_fmac_f32 v254, v125, v125
    v_fmac_f32 v254, v154, v154
    v_mfma_f32_16x16x16_f16 v[246:249], v[132:133], v[130:131], v[246:249]
    v_fmac_f32 v254, v155, v155
    v_fmac_f32 v254, v156, v156
    v_fmac_f32 v254, v157, v157
    v_fmac_f32 v254, v202, v202
    v_mfma_f32_16x16x32_bf16 v[126:129], v[28:31], v[36:39], 0
    s_waitcnt lgkmcnt(0)
    v_max3_f32 v255, v255, v186, v187
    v_max3_f32 v255, v255, v188, v189
    v_mfma_f32_16x16x32_bf16 v[126:129], v[28:31], v[226:229], v[126:129]
    v_max3_f32 v255, v255, v246, v247
    v_max3_f32 v255, v255, v248, v249
    v_mfma_f32_16x16x32_bf16 v[130:133], v[142:145], v[36:39], 0
    v_mov_b32 v239, v255
    v_fmac_f32 v254, v203, v203
    v_mfma_f32_16x16x32_bf16 v[130:133], v[146:149], v[226:229], v[130:133]
    v_permlane32_swap_b32 v255, v239
    v_mfma_f32_16x16x32_bf16 v[138:141], v[170:173], v[36:39], 0
    v_rcp_f32 v126, v126
    v_mfma_f32_16x16x32_bf16 v[138:141], v[174:177], v[226:229], v[138:141]
    v_max_f32 v255, v255, v239
    v_mov_b32 v239, v255
    v_mfma_f32_16x16x32_bf16 v[150:153], v[190:193], v[36:39], 0
    v_fmac_f32 v254, v204, v204
    v_mul_f32 v130, v126, v130
    v_mfma_f32_16x16x32_bf16 v[150:153], v[134:137], v[226:229], v[150:153]
    v_mul_f32 v131, v126, v131
    v_cvt_pk_bf16_f32 v130, v130, v131
    v_mfma_f32_16x16x32_bf16 v[242:245], v[118:121], v[28:31], v[242:245]
    v_mul_f32 v132, v126, v132
    v_mul_f32 v133, v126, v133
    v_mfma_f32_16x16x32_bf16 v[218:221], v[178:181], v[146:149], 0
    v_cvt_pk_bf16_f32 v131, v132, v133
    v_mul_f32 v138, v126, v138
    v_mfma_f32_16x16x32_bf16 v[218:221], v[118:121], v[142:145], v[218:221]
    v_mul_f32 v139, v126, v139
    v_cvt_pk_bf16_f32 v132, v138, v139
    v_mfma_f32_16x16x32_bf16 v[226:229], v[178:181], v[174:177], 0
    v_mul_f32 v140, v126, v140
    v_mul_f32 v141, v126, v141
    v_mfma_f32_16x16x32_bf16 v[226:229], v[118:121], v[170:173], v[226:229]
    v_cvt_pk_bf16_f32 v133, v140, v141
    v_mul_f32 v150, v126, v150
    v_mfma_f32_16x16x32_bf16 v[250:253], v[178:181], v[134:137], 0
    ds_write_b128 v3, v[130:133] offset:6144
    v_mfma_f32_16x16x32_bf16 v[250:253], v[118:121], v[190:193], v[250:253]
    v_mul_f32 v151, v126, v151
    v_cvt_pk_bf16_f32 v240, v150, v151
    v_mfma_f32_16x16x32_bf16 v[230:233], v[90:93], v[214:217], 0
    v_mul_f32 v152, v126, v152
    v_mul_f32 v153, v126, v153
    v_mfma_f32_16x16x32_bf16 v[230:233], v[94:97], v[206:209], v[230:233]
    ds_read_b128 v[118:121], v2 offset:12288
    ds_read_b128 v[126:129], v2 offset:13312
    v_mfma_f32_16x16x32_bf16 v[230:233], v[98:101], v[210:213], v[230:233]
    ds_read_b128 v[130:133], v2 offset:14336
    v_cvt_pk_bf16_f32 v241, v152, v153
    v_mfma_f32_16x16x32_bf16 v[230:233], v[102:105], v[194:197], v[230:233]
    ds_read_b128 v[158:161], v2 offset:15360
    v_fmac_f32 v254, v205, v205
    v_mfma_f32_16x16x32_bf16 v[230:233], v[106:109], v[198:201], v[230:233]
    ds_read_b128 v[178:181], v2 offset:16384
    v_fma_f32 v219, v114, v114, s33
    v_mfma_f32_16x16x32_bf16 v[230:233], v[110:113], v[222:225], v[230:233]
    ds_read_b128 v[194:197], v2 offset:17408
    ds_write_b64 v4, v[240:241] offset:10240
    v_permlane16_swap_b32 v255, v239
    v_max_f32 v255, v255, v239
    v_sub_f32 v182, v182, v255
    v_exp_f32 v182, v182
    v_sub_f32 v183, v183, v255
    v_exp_f32 v183, v183
    s_waitcnt lgkmcnt(5)
    v_mfma_f32_16x16x32_bf16 v[150:153], a[216:219], v[118:121], 0
    v_cvt_pk_bf16_f32 v198, v182, v183
    v_sub_f32 v184, v184, v255
    v_mfma_f32_16x16x32_bf16 v[150:153], a[220:223], v[126:129], v[150:153]
    s_waitcnt lgkmcnt(4)
    v_exp_f32 v184, v184
    v_mfma_f32_16x16x32_bf16 v[150:153], a[224:227], v[130:133], v[150:153]
    s_waitcnt lgkmcnt(3)
    v_sub_f32 v185, v185, v255
    v_sub_f32 v186, v186, v255
    v_mfma_f32_16x16x32_bf16 v[150:153], a[228:231], v[158:161], v[150:153]
    s_waitcnt lgkmcnt(2)
    v_exp_f32 v185, v185
    v_mfma_f32_16x16x32_bf16 v[150:153], a[232:235], v[178:181], v[150:153]
    s_waitcnt lgkmcnt(0)
    v_cvt_pk_bf16_f32 v199, v184, v185
    v_sub_f32 v187, v187, v255
    v_mfma_f32_16x16x32_bf16 v[150:153], a[236:239], v[194:197], v[150:153]
    v_exp_f32 v186, v186
    v_mfma_f32_16x16x32_bf16 v[162:165], a[240:243], v[118:121], 0
    v_exp_f32 v187, v187
    v_mfma_f32_16x16x32_bf16 v[162:165], a[244:247], v[126:129], v[162:165]
    v_cvt_pk_bf16_f32 v200, v186, v187
    v_sub_f32 v188, v188, v255
    v_mfma_f32_16x16x32_bf16 v[162:165], a[248:251], v[130:133], v[162:165]
    v_exp_f32 v188, v188
    v_mfma_f32_16x16x32_bf16 v[162:165], a[252:255], v[158:161], v[162:165]
    v_sub_f32 v189, v189, v255
    v_sub_f32 v246, v246, v255
    v_mfma_f32_16x16x32_bf16 v[162:165], v[82:85], v[178:181], v[162:165]
    v_exp_f32 v189, v189
    v_mfma_f32_16x16x32_bf16 v[162:165], v[86:89], v[194:197], v[162:165]
    v_cvt_pk_bf16_f32 v201, v188, v189
    v_sub_f32 v247, v247, v255
    v_mfma_f32_16x16x32_bf16 v[138:141], v[90:93], v[118:121], 0
    v_exp_f32 v246, v246
    v_mfma_f32_16x16x32_bf16 v[138:141], v[94:97], v[126:129], v[138:141]
    v_exp_f32 v247, v247
    v_mfma_f32_16x16x32_bf16 v[138:141], v[98:101], v[130:133], v[138:141]
    v_cvt_pk_bf16_f32 v36, v246, v247
    v_sub_f32 v248, v248, v255
    v_mfma_f32_16x16x32_bf16 v[138:141], v[102:105], v[158:161], v[138:141]
    v_exp_f32 v248, v248
    v_mfma_f32_16x16x32_bf16 v[138:141], v[106:109], v[178:181], v[138:141]
    v_sub_f32 v249, v249, v255
    v_sub_f32 v238, v238, v255
    v_mfma_f32_16x16x32_bf16 v[138:141], v[110:113], v[194:197], v[138:141]
    ds_read_b128 v[186:189], v0 offset:20480
    ds_read_b128 v[118:121], v1 offset:20480
    ds_read_b128 v[234:237], v0 offset:20608
    v_exp_f32 v249, v249
    v_exp_f32 v238, v238
    v_cvt_pk_bf16_f32 v37, v248, v249
    v_cvt_pk_bf16_f32 v39, v238, 0
    v_fma_f32 v255, v150, v150, s33
    v_fmac_f32 v255, v151, v151
    v_mfma_f32_16x16x32_bf16 v[126:129], v[28:31], v[36:39], 0
    ds_read_b128 v[158:161], v1 offset:20608
    ds_read_b128 v[182:185], v0 offset:20736
    v_mfma_f32_16x16x32_bf16 v[126:129], v[28:31], v[198:201], v[126:129]
    ds_read_b128 v[206:209], v1 offset:20736
    v_fmac_f32 v255, v152, v152
    v_mfma_f32_16x16x32_bf16 v[178:181], v[142:145], v[36:39], 0
    v_fmac_f32 v255, v153, v153
    v_fmac_f32 v255, v162, v162
    v_mfma_f32_16x16x32_bf16 v[178:181], v[146:149], v[198:201], v[178:181]
    v_fmac_f32 v255, v163, v163
    v_fmac_f32 v255, v164, v164
    v_mfma_f32_16x16x32_bf16 v[142:145], v[170:173], v[36:39], 0
    s_waitcnt lgkmcnt(5)
    v_rcp_f32 v126, v126
    v_mfma_f32_16x16x32_bf16 v[142:145], v[174:177], v[198:201], v[142:145]
    s_waitcnt lgkmcnt(3)
    v_fmac_f32 v255, v165, v165
    v_mul_f32 v178, v126, v178
    v_mfma_f32_16x16x32_bf16 v[146:149], v[190:193], v[36:39], 0
    v_mul_f32 v179, v126, v179
    v_cvt_pk_bf16_f32 v170, v178, v179
    v_mfma_f32_16x16x32_bf16 v[146:149], v[134:137], v[198:201], v[146:149]
    v_mul_f32 v180, v126, v180
    v_mul_f32 v181, v126, v181
    v_mfma_f32_16x16x32_bf16 v[130:133], a[72:75], v[186:189], 0
    s_waitcnt lgkmcnt(1)
    v_cvt_pk_bf16_f32 v171, v180, v181
    v_mul_f32 v142, v126, v142
    v_mfma_f32_16x16x32_bf16 v[130:133], a[76:79], v[118:121], v[130:133]
    s_waitcnt lgkmcnt(0)
    v_mul_f32 v143, v126, v143
    v_cvt_pk_bf16_f32 v172, v142, v143
    v_mfma_f32_16x16x32_bf16 v[130:133], a[80:83], v[234:237], v[130:133]
    v_mul_f32 v144, v126, v144
    v_mul_f32 v145, v126, v145
    v_mfma_f32_16x16x32_bf16 v[130:133], a[84:87], v[158:161], v[130:133]
    v_cvt_pk_bf16_f32 v173, v144, v145
    v_mul_f32 v146, v126, v146
    v_mfma_f32_16x16x32_bf16 v[130:133], a[88:91], v[182:185], v[130:133]
    ds_write_b128 v3, v[170:173] offset:12288
    v_mfma_f32_16x16x32_bf16 v[130:133], a[92:95], v[206:209], v[130:133]
    v_mul_f32 v147, v126, v147
    v_cvt_pk_bf16_f32 v220, v146, v147
    v_mfma_f32_16x16x32_bf16 v[134:137], a[96:99], v[186:189], 0
    v_mul_f32 v148, v126, v148
    v_mul_f32 v149, v126, v149
    v_mfma_f32_16x16x32_bf16 v[134:137], a[100:103], v[118:121], v[134:137]
    v_cvt_pk_bf16_f32 v221, v148, v149
    v_fmac_f32 v255, v138, v138
    v_mfma_f32_16x16x32_bf16 v[134:137], a[104:107], v[234:237], v[134:137]
    ds_write_b64 v4, v[220:221] offset:16384
    v_mfma_f32_16x16x32_bf16 v[134:137], a[108:111], v[158:161], v[134:137]
    v_fmac_f32 v255, v139, v139
    v_fmac_f32 v255, v140, v140
    v_mfma_f32_16x16x32_bf16 v[134:137], a[112:115], v[182:185], v[134:137]
    v_fmac_f32 v255, v141, v141
    v_cvt_pk_bf16_f32 v255, v255, v255
    v_mfma_f32_16x16x32_bf16 v[134:137], a[116:119], v[206:209], v[134:137]
    v_rcp_f32 v242, v242
    v_mfma_f32_16x16x32_bf16 v[170:173], a[120:123], v[186:189], 0
    v_mul_f32 v218, v218, v242
    v_mul_f32_dpp v218, v226, v242 quad_perm:[0,1,2,3] row_mask:0x2 bank_mask:0xf
    v_mfma_f32_16x16x32_bf16 v[170:173], a[124:127], v[118:121], v[170:173]
    v_mul_f32_dpp v218, v250, v242 quad_perm:[0,1,2,3] row_mask:0x4 bank_mask:0xf
    v_cvt_pk_bf16_f32 v218, v218, v218
    v_mfma_f32_16x16x32_bf16 v[170:173], a[128:131], v[234:237], v[170:173]
    ds_write_b16 v7, v218
    v_mfma_f32_16x16x32_bf16 v[170:173], a[132:135], v[158:161], v[170:173]
    v_fmac_f32 v219, v115, v115
    v_fmac_f32 v219, v116, v116
    v_mfma_f32_16x16x32_bf16 v[170:173], a[136:139], v[182:185], v[170:173]
    v_fmac_f32 v219, v117, v117
    v_fmac_f32 v219, v166, v166
    v_mfma_f32_16x16x32_bf16 v[170:173], a[140:143], v[206:209], v[170:173]
    v_fmac_f32 v219, v167, v167
    v_fmac_f32 v219, v168, v168
    v_mfma_f32_16x16x32_bf16 v[142:145], a[0:3], v[186:189], 0
    v_fmac_f32 v219, v169, v169
    v_fmac_f32 v219, v230, v230
    v_mfma_f32_16x16x32_bf16 v[142:145], a[4:7], v[118:121], v[142:145]
    v_fmac_f32 v219, v231, v231
    v_fmac_f32 v219, v232, v232
    v_mfma_f32_16x16x32_bf16 v[142:145], a[8:11], v[234:237], v[142:145]
    v_fmac_f32 v219, v233, v233
    v_cvt_pk_bf16_f32 v254, v254, v219
    v_mfma_f32_16x16x32_bf16 v[142:145], a[12:15], v[158:161], v[142:145]
    ds_write_b64 v4, v[254:255] offset:18432
    v_mfma_f32_16x16x32_bf16 v[142:145], a[16:19], v[182:185], v[142:145]
    v_fma_f32 v174, v130, v130, s32
    v_fmac_f32 v174, v131, v131
    v_mfma_f32_16x16x32_bf16 v[142:145], a[20:23], v[206:209], v[142:145]
    v_fmac_f32 v174, v132, v132
    v_fmac_f32 v174, v133, v133
    v_mfma_f32_16x16x32_bf16 v[126:129], a[24:27], v[186:189], 0
    v_xor_b32 v2, 65536, v2
    v_xor_b32 v3, 65536, v3
    v_mfma_f32_16x16x32_bf16 v[126:129], a[28:31], v[118:121], v[126:129]
    v_xor_b32 v4, 65536, v4
    v_add_u32 v5, s74, v5
    v_mfma_f32_16x16x32_bf16 v[126:129], a[32:35], v[234:237], v[126:129]
    v_add_u32 v6, s75, v6
    v_add_u32 v7, s76, v7
    v_mfma_f32_16x16x32_bf16 v[126:129], a[36:39], v[158:161], v[126:129]
    v_mfma_f32_16x16x32_bf16 v[126:129], a[40:43], v[182:185], v[126:129]
    s_waitcnt lgkmcnt(0)
    s_barrier
    s_nop 0
    s_nop 0
    s_nop 0
    v_mfma_f32_16x16x32_bf16 v[126:129], a[44:47], v[206:209], v[126:129]
    s_cbranch_scc1 L_loop_safe0
    s_branch L_final_safe
.p2align 6
L_loop_safe1:
    v_mfma_f32_16x16x32_bf16 v[190:193], a[48:51], v[186:189], 0
    s_add_u32 s12, s40, s27
    ds_read_b128 v[146:149], v2 offset:18432
    ds_read_b128 v[178:181], v2 offset:19456
    v_mfma_f32_16x16x32_bf16 v[190:193], a[52:55], v[118:121], v[190:193]
    s_addc_u32 s13, s41, 0
    v_fmac_f32 v174, v134, v134
    v_fmac_f32 v174, v135, v135
    v_mfma_f32_16x16x32_bf16 v[190:193], a[56:59], v[234:237], v[190:193]
    s_sub_u32 s14, s36, s27
    v_fmac_f32 v174, v136, v136
    v_fmac_f32 v174, v137, v137
    v_mfma_f32_16x16x32_bf16 v[190:193], a[60:63], v[158:161], v[190:193]
    s_cmp_ge_u32 s18, 2
    v_fmac_f32 v174, v170, v170
    v_fmac_f32 v174, v171, v171
    v_mfma_f32_16x16x32_bf16 v[190:193], a[64:67], v[182:185], v[190:193]
    s_cselect_b32 s14, s14, 0
    v_fmac_f32 v174, v172, v172
    v_fmac_f32 v174, v173, v173
    v_mfma_f32_16x16x32_bf16 v[190:193], a[68:71], v[206:209], v[190:193]
    s_sub_u32 s82, s72, s71
    v_fma_f32 v254, v142, v142, s32
    v_fmac_f32 v254, v143, v143
    v_mfma_f32_16x16x32_bf16 v[194:197], v[186:189], a[144:147], 0
    s_mul_i32 s74, s82, 336
    v_fmac_f32 v254, v144, v144
    v_fmac_f32 v254, v145, v145
    v_mfma_f32_16x16x32_bf16 v[194:197], v[118:121], a[148:151], v[194:197]
    s_mul_i32 s75, s82, 272
    v_fmac_f32 v254, v126, v126
    v_fmac_f32 v254, v127, v127
    v_mfma_f32_16x16x32_bf16 v[194:197], v[234:237], a[152:155], v[194:197]
    s_waitcnt lgkmcnt(0)
    v_fmac_f32 v254, v128, v128
    v_fmac_f32 v254, v129, v129
    v_mfma_f32_16x16x32_bf16 v[198:201], v[32:35], v[146:149], 0
    s_mul_i32 s76, s82, 16
    v_fmac_f32 v254, v190, v190
    v_fmac_f32 v254, v191, v191
    v_mfma_f32_16x16x32_bf16 v[198:201], v[32:35], v[178:181], v[198:201]
    s_add_u32 s34, s18, 2
    v_fmac_f32 v254, v192, v192
    v_fmac_f32 v254, v193, v193
    v_mfma_f32_16x16x32_bf16 v[194:197], v[158:161], a[156:159], v[194:197]
    s_add_u32 s8, s60, s23
    v_cvt_pk_bf16_f32 v36, v254, v174
    s_addc_u32 s9, s61, 0
    v_mfma_f32_16x16x32_bf16 v[194:197], v[182:185], a[160:163], v[194:197]
    s_sub_u32 s10, s36, s23
    v_mul_f32 v254, 0x3baaaaab, v198
    v_mul_f32 v255, 0x3baaaaab, v199
    v_mfma_f32_16x16x32_bf16 v[210:213], v[32:35], v[36:39], 0
    s_cmp_le_u32 s34, s45
    v_rsq_f32 v254, v254
    v_mfma_f32_16x16x32_bf16 v[194:197], v[206:209], a[164:167], v[194:197]
    s_cselect_b32 s10, s10, 0
    ds_read_b128 v[214:217], v0 offset:26624
    v_mul_f32 v148, 0x3baaaaab, v200
    v_mfma_f32_16x16x32_bf16 v[174:177], v[186:189], a[168:171], 0
    s_add_u32 m0, s28, 0
    ds_read_b128 v[198:201], v1 offset:26624
    v_mul_f32 v122, v254, v122
    v_mfma_f32_16x16x32_bf16 v[174:177], v[118:121], a[172:175], v[174:177]
    s_mov_b32 s27, s26
    ds_read_b128 v[218:221], v0 offset:26752
    v_cvt_pk_bf16_f32 v146, v194, v195
    v_mfma_f32_16x16x32_bf16 v[174:177], v[234:237], a[176:179], v[174:177]
    s_mov_b32 s26, s25
    ds_read_b128 v[222:225], v1 offset:26752
    v_cvt_pk_bf16_f32 v147, v196, v197
    v_mfma_f32_16x16x32_bf16 v[174:177], v[158:161], a[180:183], v[174:177]
    s_mov_b32 s25, s24
    v_rsq_f32 v211, v211
    v_mfma_f32_16x16x32_bf16 v[174:177], v[182:185], a[184:187], v[174:177]
    s_mov_b32 s24, s23
    v_rsq_f32 v210, v210
    v_mfma_f32_16x16x32_bf16 v[174:177], v[206:209], a[188:191], v[174:177]
    s_ff1_i32_b32 s80, s100
    v_mul_f32 v210, s31, v210
    v_mul_f32 v130, v211, v130
    v_mul_f32 v131, v211, v131
    v_cvt_pk_f16_f32 v178, v130, v131
    v_mfma_f32_16x16x32_bf16 v[194:197], v[186:189], a[192:195], 0
    s_waitcnt lgkmcnt(3)
    ds_read_b128 v[186:189], v0 offset:26880
    v_cvt_pk_bf16_f32 v174, v174, v175
    v_mfma_f32_16x16x32_bf16 v[194:197], v[118:121], a[196:199], v[194:197]
    s_mov_b32 s71, s72
    ds_read_b128 v[226:229], v1 offset:26880
    v_cvt_pk_bf16_f32 v175, v176, v177
    v_mfma_f32_16x16x32_bf16 v[194:197], v[234:237], a[200:203], v[194:197]
    s_mov_b32 s72, s73
    v_mul_f32 v132, v211, v132
    v_mul_f32 v133, v211, v133
    v_mfma_f32_16x16x32_bf16 v[194:197], v[158:161], a[204:207], v[194:197]
    s_waitcnt lgkmcnt(2)
    v_cvt_pk_f16_f32 v179, v132, v133
    v_mul_f32 v134, v211, v134
    v_mfma_f32_16x16x32_bf16 v[194:197], v[182:185], a[208:211], v[194:197]
    v_mul_f32 v135, v211, v135
    v_cvt_pk_f16_f32 v180, v134, v135
    v_mfma_f32_16x16x32_bf16 v[194:197], v[206:209], a[212:215], v[194:197]
    v_mul_f32 v136, v211, v136
    v_mul_f32 v137, v211, v137
    v_mfma_f32_16x16x32_bf16 v[130:133], a[72:75], v[214:217], 0
    v_cvt_pk_f16_f32 v181, v136, v137
    v_mul_f32 v170, v211, v170
    v_mfma_f32_16x16x32_bf16 v[130:133], a[76:79], v[198:201], v[130:133]
    v_mul_f32 v171, v211, v171
    v_cvt_pk_f16_f32 v120, v170, v171
    v_mfma_f32_16x16x32_bf16 v[130:133], a[80:83], v[218:221], v[130:133]
    s_waitcnt lgkmcnt(1)
    v_cvt_pk_bf16_f32 v134, v194, v195
    v_cvt_pk_bf16_f32 v135, v196, v197
    v_mfma_f32_16x16x32_bf16 v[130:133], a[84:87], v[222:225], v[130:133]
    s_waitcnt lgkmcnt(0)
    v_mul_f32 v172, v211, v172
    v_mul_f32 v173, v211, v173
    v_mfma_f32_16x16x32_bf16 v[130:133], a[88:91], v[186:189], v[130:133]
    v_cvt_pk_f16_f32 v121, v172, v173
    v_mul_f32 v142, v210, v142
    v_mfma_f32_16x16x32_bf16 v[130:133], a[92:95], v[226:229], v[130:133]
    v_mul_f32 v143, v210, v143
    v_cvt_pk_f16_f32 v194, v142, v143
    v_mfma_f32_16x16x32_bf16 v[158:161], a[96:99], v[214:217], 0
    v_mul_f32 v144, v210, v144
    v_mul_f32 v145, v210, v145
    v_mfma_f32_16x16x32_bf16 v[158:161], a[100:103], v[198:201], v[158:161]
    v_cvt_pk_f16_f32 v195, v144, v145
    v_mul_f32 v126, v210, v126
    v_mfma_f32_16x16x32_bf16 v[158:161], a[104:107], v[218:221], v[158:161]
    v_mul_f32 v127, v210, v127
    v_cvt_pk_f16_f32 v196, v126, v127
    v_mfma_f32_16x16x32_bf16 v[158:161], a[108:111], v[222:225], v[158:161]
    v_mul_f32 v128, v210, v128
    v_mul_f32 v129, v210, v129
    v_mfma_f32_16x16x32_bf16 v[158:161], a[112:115], v[186:189], v[158:161]
    v_cvt_pk_f16_f32 v197, v128, v129
    v_mul_f32 v190, v210, v190
    v_mfma_f32_16x16x32_bf16 v[158:161], a[116:119], v[226:229], v[158:161]
    v_mul_f32 v191, v210, v191
    v_cvt_pk_f16_f32 v118, v190, v191
    v_mfma_f32_16x16x32_bf16 v[142:145], a[120:123], v[214:217], 0
    v_mul_f32 v192, v210, v192
    v_mul_f32 v193, v210, v193
    v_mfma_f32_16x16x32_bf16 v[142:145], a[124:127], v[198:201], v[142:145]
    v_cvt_pk_f16_f32 v119, v192, v193
    v_fma_f32 v149, v130, v130, s32
    v_mfma_f32_16x16x32_bf16 v[142:145], a[128:131], v[218:221], v[142:145]
    v_fmac_f32 v149, v131, v131
    v_fmac_f32 v149, v132, v132
    v_mfma_f32_16x16x32_bf16 v[142:145], a[132:135], v[222:225], v[142:145]
    v_fmac_f32 v149, v133, v133
    v_fmac_f32 v149, v158, v158
    v_mfma_f32_16x16x32_bf16 v[142:145], a[136:139], v[186:189], v[142:145]
    v_fmac_f32 v149, v159, v159
    v_fmac_f32 v149, v160, v160
    v_mfma_f32_16x16x32_bf16 v[142:145], a[140:143], v[226:229], v[142:145]
    v_fmac_f32 v149, v161, v161
    v_mul_f32 v123, v254, v123
    v_mfma_f32_16x16x32_bf16 v[170:173], a[0:3], v[214:217], 0
    v_rsq_f32 v255, v255
    v_mfma_f32_16x16x32_bf16 v[170:173], a[4:7], v[198:201], v[170:173]
    v_rsq_f32 v148, v148
    v_mfma_f32_16x16x32_bf16 v[170:173], a[8:11], v[218:221], v[170:173]
    v_mul_f32 v150, v148, v150
    v_fmac_f32 v149, v142, v142
    v_mfma_f32_16x16x32_bf16 v[170:173], a[12:15], v[222:225], v[170:173]
    v_fmac_f32 v149, v143, v143
    v_fmac_f32 v149, v144, v144
    v_mfma_f32_16x16x32_bf16 v[170:173], a[16:19], v[186:189], v[170:173]
    v_fmac_f32 v149, v145, v145
    v_mul_f32 v151, v148, v151
    v_mfma_f32_16x16x32_bf16 v[170:173], a[20:23], v[226:229], v[170:173]
    v_cvt_pk_bf16_f32 v126, v150, v151
    v_mul_f32 v152, v148, v152
    v_mfma_f32_16x16x32_bf16 v[182:185], a[24:27], v[214:217], 0
    v_mul_f32 v153, v148, v153
    v_cvt_pk_bf16_f32 v127, v152, v153
    v_mfma_f32_16x16x32_bf16 v[182:185], a[28:31], v[198:201], v[182:185]
    v_mul_f32 v162, v148, v162
    v_mul_f32 v163, v148, v163
    v_mfma_f32_16x16x32_bf16 v[182:185], a[32:35], v[218:221], v[182:185]
    v_fma_f32 v136, v170, v170, s32
    v_fmac_f32 v136, v171, v171
    v_mfma_f32_16x16x32_bf16 v[182:185], a[36:39], v[222:225], v[182:185]
    v_fmac_f32 v136, v172, v172
    v_fmac_f32 v136, v173, v173
    v_mfma_f32_16x16x32_bf16 v[182:185], a[40:43], v[186:189], v[182:185]
    v_cvt_pk_bf16_f32 v128, v162, v163
    v_mul_f32 v164, v148, v164
    v_mfma_f32_16x16x32_bf16 v[182:185], a[44:47], v[226:229], v[182:185]
    v_mul_f32 v165, v148, v165
    v_cvt_pk_bf16_f32 v129, v164, v165
    v_mfma_f32_16x16x32_bf16 v[162:165], a[48:51], v[214:217], 0
    buffer_store_dwordx4 v[126:129], v17, s[12:15], 0 offen nt
    v_mul_f32 v138, v148, v138
    v_mul_f32 v139, v148, v139
    v_cvt_pk_bf16_f32 v176, v138, v139
    v_mul_f32 v140, v148, v140
    v_mfma_f32_16x16x32_bf16 v[162:165], a[52:55], v[198:201], v[162:165]
    v_fmac_f32 v136, v182, v182
    v_fmac_f32 v136, v183, v183
    v_mfma_f32_16x16x32_bf16 v[162:165], a[56:59], v[218:221], v[162:165]
    v_fmac_f32 v136, v184, v184
    v_fmac_f32 v136, v185, v185
    v_mfma_f32_16x16x32_bf16 v[162:165], a[60:63], v[222:225], v[162:165]
    v_mul_f32 v141, v148, v141
    v_cvt_pk_bf16_f32 v177, v140, v141
    v_mfma_f32_16x16x32_bf16 v[162:165], a[64:67], v[186:189], v[162:165]
    v_cvt_pk_bf16_f32 v190, v122, v123
    v_mul_f32 v124, v254, v124
    v_mfma_f32_16x16x32_bf16 v[162:165], a[68:71], v[226:229], v[162:165]
    v_mul_f32 v125, v254, v125
    v_cvt_pk_bf16_f32 v191, v124, v125
    v_mfma_f32_16x16x32_bf16 v[122:125], v[214:217], a[144:147], 0
    v_mul_f32 v154, v254, v154
    v_mul_f32 v155, v254, v155
    v_mfma_f32_16x16x32_bf16 v[122:125], v[198:201], a[148:151], v[122:125]
    v_cvt_pk_bf16_f32 v192, v154, v155
    v_mul_f32 v156, v254, v156
    v_mfma_f32_16x16x32_bf16 v[122:125], v[218:221], a[152:155], v[122:125]
    v_fmac_f32 v136, v162, v162
    v_fmac_f32 v136, v163, v163
    v_mfma_f32_16x16x32_bf16 v[122:125], v[222:225], a[156:159], v[122:125]
    v_fmac_f32 v136, v164, v164
    v_fmac_f32 v136, v165, v165
    v_mfma_f32_16x16x32_bf16 v[122:125], v[186:189], a[160:163], v[122:125]
    v_cvt_pk_bf16_f32 v36, v136, v149
    v_mul_f32 v157, v254, v157
    v_mfma_f32_16x16x32_bf16 v[122:125], v[226:229], a[164:167], v[122:125]
    ds_read_b128 v[206:209], v0 offset:32768
    v_cvt_pk_bf16_f32 v193, v156, v157
    v_mfma_f32_16x16x32_bf16 v[154:157], v[32:35], v[36:39], 0
    v_mul_f32 v202, v254, v202
    v_mul_f32 v203, v254, v203
    v_mfma_f32_16x16x32_bf16 v[126:129], v[214:217], a[168:171], 0
    ds_read_b128 v[210:213], v1 offset:32768
    v_cvt_pk_bf16_f32 v234, v202, v203
    v_mfma_f32_16x16x32_bf16 v[126:129], v[198:201], a[172:175], v[126:129]
    ds_read_b128 v[238:241], v0 offset:32896
    v_cvt_pk_bf16_f32 v148, v122, v123
    v_mfma_f32_16x16x32_bf16 v[126:129], v[218:221], a[176:179], v[126:129]
    ds_read_b128 v[242:245], v1 offset:32896
    v_cvt_pk_bf16_f32 v149, v124, v125
    v_mfma_f32_16x16x32_bf16 v[126:129], v[222:225], a[180:183], v[126:129]
    v_rsq_f32 v155, v155
    v_mfma_f32_16x16x32_bf16 v[126:129], v[186:189], a[184:187], v[126:129]
    buffer_store_dwordx2 v[176:177], v20, s[12:15], 0 offen nt
    v_rsq_f32 v154, v154
    v_mfma_f32_16x16x32_bf16 v[126:129], v[226:229], a[188:191], v[126:129]
    s_waitcnt lgkmcnt(3)
    v_mul_f32 v154, s31, v154
    v_mul_f32 v130, v155, v130
    v_mul_f32 v131, v155, v131
    v_cvt_pk_f16_f32 v138, v130, v131
    v_mfma_f32_16x16x32_bf16 v[122:125], v[214:217], a[192:195], 0
    ds_read_b128 v[214:217], v0 offset:33024
    v_mul_f32 v132, v155, v132
    v_mfma_f32_16x16x32_bf16 v[122:125], v[198:201], a[196:199], v[122:125]
    s_waitcnt lgkmcnt(3)
    ds_read_b128 v[198:201], v1 offset:33024
    v_cvt_pk_bf16_f32 v176, v126, v127
    v_mfma_f32_16x16x32_bf16 v[122:125], v[218:221], a[200:203], v[122:125]
    s_waitcnt lgkmcnt(3)
    v_cvt_pk_bf16_f32 v177, v128, v129
    v_mul_f32 v133, v155, v133
    v_mfma_f32_16x16x32_bf16 v[122:125], v[222:225], a[204:207], v[122:125]
    s_waitcnt vmcnt(2)
    ds_write_b16 v8, v45 offset:512
    v_mfma_f32_16x16x32_bf16 v[122:125], v[186:189], a[208:211], v[122:125]
    s_waitcnt lgkmcnt(3)
    v_cvt_pk_f16_f32 v139, v132, v133
    v_mfma_f32_16x16x32_bf16 v[122:125], v[226:229], a[212:215], v[122:125]
    v_mul_f32 v158, v155, v158
    v_mul_f32 v159, v155, v159
    v_mfma_f32_16x16x32_bf16 v[130:133], a[72:75], v[206:209], 0
    v_cvt_pk_f16_f32 v140, v158, v159
    v_mul_f32 v160, v155, v160
    v_mfma_f32_16x16x32_bf16 v[130:133], a[76:79], v[210:213], v[130:133]
    v_mul_f32 v161, v155, v161
    v_cvt_pk_f16_f32 v141, v160, v161
    v_mfma_f32_16x16x32_bf16 v[130:133], a[80:83], v[238:241], v[130:133]
    s_waitcnt lgkmcnt(2)
    v_cvt_pk_bf16_f32 v136, v122, v123
    v_cvt_pk_bf16_f32 v137, v124, v125
    v_mfma_f32_16x16x32_bf16 v[130:133], a[84:87], v[242:245], v[130:133]
    s_waitcnt lgkmcnt(1)
    v_mul_f32 v142, v155, v142
    v_mul_f32 v143, v155, v143
    v_mfma_f32_16x16x32_bf16 v[130:133], a[88:91], v[214:217], v[130:133]
    v_cvt_pk_f16_f32 v128, v142, v143
    v_mul_f32 v144, v155, v144
    v_mfma_f32_16x16x32_bf16 v[130:133], a[92:95], v[198:201], v[130:133]
    s_waitcnt lgkmcnt(0)
    v_mul_f32 v145, v155, v145
    v_cvt_pk_f16_f32 v129, v144, v145
    v_mfma_f32_16x16x32_bf16 v[218:221], a[96:99], v[206:209], 0
    v_mul_f32 v170, v154, v170
    v_mul_f32 v171, v154, v171
    v_mfma_f32_16x16x32_bf16 v[218:221], a[100:103], v[210:213], v[218:221]
    s_barrier
    v_cvt_pk_f16_f32 v150, v170, v171
    v_mul_f32 v172, v154, v172
    v_mfma_f32_16x16x32_bf16 v[218:221], a[104:107], v[238:241], v[218:221]
    v_mul_f32 v173, v154, v173
    v_cvt_pk_f16_f32 v151, v172, v173
    v_mfma_f32_16x16x32_bf16 v[218:221], a[108:111], v[242:245], v[218:221]
    buffer_load_dwordx4 v10, s[8:11], 0 offen nt lds
    ds_read_u16 v202, v9 offset:384
    v_mfma_f32_16x16x32_bf16 v[218:221], a[112:115], v[214:217], v[218:221]
    s_add_u32 m0, s28, 4096
    v_mul_f32 v182, v154, v182
    v_mul_f32 v183, v154, v183
    v_mfma_f32_16x16x32_bf16 v[218:221], a[116:119], v[198:201], v[218:221]
    v_cvt_pk_f16_f32 v152, v182, v183
    v_mul_f32 v184, v154, v184
    v_mfma_f32_16x16x32_bf16 v[226:229], a[120:123], v[206:209], 0
    v_mul_f32 v185, v154, v185
    v_cvt_pk_f16_f32 v153, v184, v185
    v_mfma_f32_16x16x32_bf16 v[226:229], a[124:127], v[210:213], v[226:229]
    v_mul_f32 v162, v154, v162
    v_mul_f32 v163, v154, v163
    v_mfma_f32_16x16x32_bf16 v[226:229], a[128:131], v[238:241], v[226:229]
    buffer_load_dwordx4 v11, s[8:11], 0 offen nt lds
    v_cvt_pk_f16_f32 v126, v162, v163
    v_mfma_f32_16x16x32_bf16 v[226:229], a[132:135], v[242:245], v[226:229]
    s_add_u32 m0, s28, 8192
    v_mul_f32 v164, v154, v164
    v_mul_f32 v165, v154, v165
    v_mfma_f32_16x16x32_bf16 v[226:229], a[136:139], v[214:217], v[226:229]
    v_cvt_pk_f16_f32 v127, v164, v165
    v_mul_f32 v204, v254, v204
    v_mfma_f32_16x16x32_bf16 v[226:229], a[140:143], v[198:201], v[226:229]
    s_waitcnt lgkmcnt(0)
    v_readfirstlane_b32 s77, v202
    v_mul_f32 v205, v254, v205
    v_mfma_f32_16x16x32_bf16 v[162:165], a[0:3], v[206:209], 0
    v_cvt_pk_bf16_f32 v235, v204, v205
    v_fma_f32 v236, v130, v130, s32
    v_mfma_f32_16x16x32_bf16 v[162:165], a[4:7], v[210:213], v[162:165]
    buffer_load_dwordx4 v12, s[8:11], 0 offen nt lds
    v_fmac_f32 v236, v131, v131
    v_mfma_f32_16x16x32_bf16 v[162:165], a[8:11], v[238:241], v[162:165]
    s_add_u32 m0, s28, 12288
    v_fmac_f32 v236, v132, v132
    v_fmac_f32 v236, v133, v133
    v_mfma_f32_16x16x32_bf16 v[162:165], a[12:15], v[242:245], v[162:165]
    s_xor_b32 s28, s28, 65536
    v_fmac_f32 v236, v218, v218
    v_fmac_f32 v236, v219, v219
    v_mfma_f32_16x16x32_bf16 v[162:165], a[16:19], v[214:217], v[162:165]
    v_fmac_f32 v236, v220, v220
    v_fmac_f32 v236, v221, v221
    v_mfma_f32_16x16x32_bf16 v[162:165], a[20:23], v[198:201], v[162:165]
    v_fmac_f32 v236, v226, v226
    v_fmac_f32 v236, v227, v227
    v_mfma_f32_16x16x32_bf16 v[246:249], a[24:27], v[206:209], 0
    buffer_load_dwordx4 v13, s[8:11], 0 offen nt lds
    v_fmac_f32 v236, v228, v228
    v_mfma_f32_16x16x32_bf16 v[246:249], a[28:31], v[210:213], v[246:249]
    s_mov_b32 m0, s29
    v_fmac_f32 v236, v229, v229
    v_fma_f32 v237, v162, v162, s32
    v_mfma_f32_16x16x32_bf16 v[246:249], a[32:35], v[238:241], v[246:249]
    s_xor_b32 s29, s29, s30
    v_fmac_f32 v237, v163, v163
    v_fmac_f32 v237, v164, v164
    v_mfma_f32_16x16x32_bf16 v[246:249], a[36:39], v[242:245], v[246:249]
    s_add_u32 s19, s19, s20
    v_fmac_f32 v237, v165, v165
    v_mul_f32 v114, v255, v114
    v_mfma_f32_16x16x32_bf16 v[246:249], a[40:43], v[214:217], v[246:249]
    s_add_u32 s23, s23, s21
    v_mul_f32 v115, v255, v115
    v_cvt_pk_bf16_f32 v114, v114, v115
    v_mfma_f32_16x16x32_bf16 v[246:249], a[44:47], v[198:201], v[246:249]
    buffer_load_dwordx4 v14, s[8:11], 0 offen nt lds
    v_mul_f32 v116, v255, v116
    v_mfma_f32_16x16x32_bf16 v[122:125], a[48:51], v[206:209], 0
    s_cmp_ge_u32 s19, 72
    v_mul_f32 v117, v255, v117
    v_cvt_pk_bf16_f32 v115, v116, v117
    v_mfma_f32_16x16x32_bf16 v[122:125], a[52:55], v[210:213], v[122:125]
    s_cselect_b32 s34, 72, 0
    v_fmac_f32 v237, v246, v246
    v_fmac_f32 v237, v247, v247
    v_mfma_f32_16x16x32_bf16 v[122:125], a[56:59], v[238:241], v[122:125]
    s_cselect_b32 s35, s22, 0
    v_fmac_f32 v237, v248, v248
    v_fmac_f32 v237, v249, v249
    v_mfma_f32_16x16x32_bf16 v[122:125], a[60:63], v[242:245], v[122:125]
    s_sub_u32 s19, s19, s34
    v_mul_f32 v166, v255, v166
    v_mul_f32 v167, v255, v167
    v_mfma_f32_16x16x32_bf16 v[122:125], a[64:67], v[214:217], v[122:125]
    buffer_store_dwordx4 v[190:193], v15, s[12:15], 0 offen nt
    v_cvt_pk_bf16_f32 v116, v166, v167
    v_mul_f32 v168, v255, v168
    v_mul_f32 v169, v255, v169
    v_cvt_pk_bf16_f32 v117, v168, v169
    v_mfma_f32_16x16x32_bf16 v[122:125], a[68:71], v[198:201], v[122:125]
    s_add_u32 s23, s23, s35
    v_mul_f32 v230, v255, v230
    v_mul_f32 v231, v255, v231
    v_mfma_f32_16x16x32_bf16 v[154:157], v[206:209], a[144:147], 0
    s_cmp_lg_u32 s83, 0
    v_cvt_pk_bf16_f32 v254, v230, v231
    v_mul_f32 v232, v255, v232
    v_mfma_f32_16x16x32_bf16 v[154:157], v[210:213], a[148:151], v[154:157]
    s_cselect_b32 s77, s80, s77
    v_fmac_f32 v237, v122, v122
    v_fmac_f32 v237, v123, v123
    v_mfma_f32_16x16x32_bf16 v[154:157], v[238:241], a[152:155], v[154:157]
    s_mul_i32 s78, s77, 2688
    v_fmac_f32 v237, v124, v124
    v_fmac_f32 v237, v125, v125
    v_mfma_f32_16x16x32_bf16 v[154:157], v[242:245], a[156:159], v[154:157]
    s_add_u32 s78, s78, s69
    ds_read2_b32 v[144:145], v6 offset0:0 offset1:0
    ds_read2_b32 v[172:173], v6 offset0:16 offset1:16
    v_mfma_f32_16x16x32_bf16 v[154:157], v[214:217], a[160:163], v[154:157]
    s_add_u32 s80, s77, s68
    ds_read2_b32 v[192:193], v6 offset0:32 offset1:32
    v_cvt_pk_bf16_f32 v36, v237, v236
    v_mfma_f32_16x16x32_bf16 v[154:157], v[198:201], a[164:167], v[154:157]
    s_cmp_ge_u32 s80, 72
    v_mul_f32 v233, v255, v233
    v_cvt_pk_bf16_f32 v255, v232, v233
    v_mfma_f32_16x16x32_bf16 v[230:233], v[32:35], v[36:39], 0
    s_cselect_b32 s80, s22, 0
    v_xor_b32 v0, 65536, v0
    v_xor_b32 v1, 65536, v1
    v_mfma_f32_16x16x32_bf16 v[166:169], v[206:209], a[168:171], 0
    s_add_u32 s78, s78, s80
    v_cvt_pk_bf16_f32 v142, v154, v155
    v_cvt_pk_bf16_f32 v143, v156, v157
    v_mfma_f32_16x16x32_bf16 v[166:169], v[210:213], a[172:175], v[166:169]
    s_add_u32 s80, s77, 20
    v_rsq_f32 v231, v231
    v_mfma_f32_16x16x32_bf16 v[166:169], v[238:241], a[176:179], v[166:169]
    s_add_u32 s34, s18, 3
    v_rsq_f32 v230, v230
    v_mfma_f32_16x16x32_bf16 v[166:169], v[242:245], a[180:183], v[166:169]
    s_cmp_lt_u32 s77, s62
    v_mul_f32 v230, s31, v230
    v_mul_f32 v130, v231, v130
    v_mfma_f32_16x16x32_bf16 v[166:169], v[214:217], a[184:187], v[166:169]
    s_cselect_b32 s79, 1, 0
    v_mul_f32 v131, v231, v131
    v_cvt_pk_f16_f32 v158, v130, v131
    v_mfma_f32_16x16x32_bf16 v[166:169], v[198:201], a[188:191], v[166:169]
    s_cselect_b32 s78, s78, 0
    v_mul_f32 v132, v231, v132
    v_mul_f32 v133, v231, v133
    v_mfma_f32_16x16x32_bf16 v[250:253], v[206:209], a[192:195], 0
    s_cmp_lt_u32 s34, s17
    v_cvt_pk_f16_f32 v159, v132, v133
    v_mul_f32 v218, v231, v218
    v_mfma_f32_16x16x32_bf16 v[250:253], v[210:213], a[196:199], v[250:253]
    s_cselect_b32 s23, s23, s78
    v_cvt_pk_bf16_f32 v170, v166, v167
    v_cvt_pk_bf16_f32 v171, v168, v169
    v_mfma_f32_16x16x32_bf16 v[250:253], v[238:241], a[200:203], v[250:253]
    s_cselect_b32 s73, s34, s80
    ds_read_b128 v[222:225], v5 offset:0
    ds_read_b128 v[202:205], v5 offset:16
    v_mfma_f32_16x16x32_bf16 v[250:253], v[242:245], a[204:207], v[250:253]
    s_cselect_b32 s79, 0, s79
    ds_read_b128 v[154:157], v5 offset:48
    ds_read_b32 v232, v6 offset:192
    v_mfma_f32_16x16x32_bf16 v[250:253], v[214:217], a[208:211], v[250:253]
    s_waitcnt lgkmcnt(4)
    buffer_store_dwordx2 v[234:235], v18, s[12:15], 0 offen nt
    v_mul_f32 v219, v231, v219
    v_cvt_pk_f16_f32 v160, v218, v219
    v_mfma_f32_16x16x32_f16 v[186:189], v[178:181], v[194:197], v[46:49]
    s_cselect_b32 s81, 0, 1
    v_mul_f32 v220, v231, v220
    v_mul_f32 v221, v231, v221
    v_mfma_f32_16x16x32_f16 v[182:185], v[138:141], v[194:197], v[50:53]
    s_add_u32 s80, s77, 1
    v_cvt_pk_f16_f32 v161, v220, v221
    v_mul_f32 v226, v231, v226
    v_mul_f32 v227, v231, v227
    v_mfma_f32_16x16x32_f16 v[166:169], v[158:161], v[194:197], v[54:57]
    s_mul_i32 s80, s80, s81
    v_cvt_pk_f16_f32 v132, v226, v227
    v_mul_f32 v228, v231, v228
    v_mul_f32 v229, v231, v229
    v_mfma_f32_16x16x16_f16 v[186:189], v[120:121], v[118:119], v[186:189]
    v_cvt_pk_f16_f32 v133, v228, v229
    v_mul_f32 v162, v230, v162
    v_mul_f32 v163, v230, v163
    v_mfma_f32_16x16x16_f16 v[182:185], v[128:129], v[118:119], v[182:185]
    v_cvt_pk_f16_f32 v162, v162, v163
    v_mul_f32 v164, v230, v164
    v_mul_f32 v165, v230, v165
    v_mfma_f32_16x16x16_f16 v[166:169], v[132:133], v[118:119], v[166:169]
    v_cvt_pk_f16_f32 v163, v164, v165
    v_mul_f32 v246, v230, v246
    v_mul_f32 v247, v230, v247
    v_cvt_pk_f16_f32 v164, v246, v247
    v_mfma_f32_16x16x32_bf16 v[250:253], v[198:201], a[212:215], v[250:253]
    s_waitcnt lgkmcnt(0)
    ds_read_b128 v[214:217], v2 offset:0
    ds_read_b128 v[206:209], v2 offset:1024
    v_mfma_f32_16x16x32_f16 v[226:229], v[222:225], v[194:197], v[22:25]
    s_cmp_lt_u32 s80, s62
    ds_read_b128 v[210:213], v2 offset:2048
    ds_read_b128 v[194:197], v2 offset:3072
    v_mfma_f32_16x16x32_f16 v[226:229], v[202:205], v[178:181], v[226:229]
    s_cselect_b32 s70, s70, 0
    v_cvt_pk_bf16_f32 v190, v250, v251
    v_cvt_pk_bf16_f32 v191, v252, v253
    v_mfma_f32_16x16x32_f16 v[226:229], v[154:157], v[118:121], v[226:229]
    s_cselect_b32 s62, s62, 0
    ds_read_b128 v[198:201], v2 offset:4096
    v_mul_f32 v248, v230, v248
    v_mul_f32 v249, v230, v249
    v_cvt_pk_f16_f32 v165, v248, v249
    v_mfma_f32_16x16x32_f16 v[218:221], v[222:225], v[150:153], v[24:27]
    s_add_u32 s80, s18, 4
    v_mul_f32 v122, v230, v122
    v_mul_f32 v123, v230, v123
    v_mfma_f32_16x16x32_f16 v[218:221], v[202:205], v[138:141], v[218:221]
    s_cmp_ge_u32 s80, s17
    v_cvt_pk_f16_f32 v130, v122, v123
    v_mul_f32 v124, v230, v124
    v_mfma_f32_16x16x32_f16 v[218:221], v[154:157], v[126:129], v[218:221]
    s_cselect_b32 s66, s70, 0
    v_mul_f32 v125, v230, v125
    v_cvt_pk_f16_f32 v131, v124, v125
    v_mfma_f32_16x16x32_f16 v[238:241], v[222:225], v[162:165], v[26:29]
    s_waitcnt lgkmcnt(3)
    ds_read_b128 v[222:225], v2 offset:5120
    v_mov_b32_dpp v232, v227 quad_perm:[0,1,2,3] row_mask:0x1 bank_mask:0xf
    v_mfma_f32_16x16x32_f16 v[238:241], v[202:205], v[158:161], v[238:241]
    s_lshl_b32 s80, s79, s73
    v_mov_b32_dpp v232, v219 quad_perm:[0,1,2,3] row_mask:0x2 bank_mask:0xf
    v_max3_f32 v118, v226, v186, v187
    v_mfma_f32_16x16x32_f16 v[238:241], v[154:157], v[130:133], v[238:241]
    s_waitcnt lgkmcnt(2)
    buffer_store_dwordx4 v[114:117], v16, s[12:15], 0 offen nt
    v_max3_f32 v118, v118, v188, v189
    v_max3_f32 v118, v118, v182, v183
    v_max3_f32 v118, v118, v184, v185
    v_max3_f32 v118, v118, v166, v167
    v_mfma_f32_16x16x32_bf16 v[122:125], a[216:219], v[214:217], 0
    s_or_b32 s63, s63, s80
    v_max3_f32 v118, v118, v168, v169
    v_mov_b32 v119, v118
    v_mfma_f32_16x16x32_bf16 v[122:125], a[220:223], v[206:209], v[122:125]
    s_sub_u32 s80, s100, s81
    v_permlane32_swap_b32 v118, v119
    v_mfma_f32_16x16x32_bf16 v[122:125], a[224:227], v[210:213], v[122:125]
    s_and_b32 s100, s100, s80
    v_max_f32 v118, v118, v119
    v_mov_b32 v119, v118
    v_mfma_f32_16x16x32_bf16 v[122:125], a[228:231], v[194:197], v[122:125]
    s_waitcnt lgkmcnt(1)
    v_permlane16_swap_b32 v118, v119
    v_mfma_f32_16x16x32_bf16 v[122:125], a[232:235], v[198:201], v[122:125]
    s_waitcnt lgkmcnt(0)
    v_max_f32 v118, v118, v119
    v_sub_f32 v186, v186, v118
    v_mfma_f32_16x16x32_bf16 v[122:125], a[236:239], v[222:225], v[122:125]
    s_add_u32 s45, s45, s79
    v_exp_f32 v186, v186
    v_mfma_f32_16x16x32_bf16 v[154:157], a[240:243], v[214:217], 0
    s_add_u32 s18, s18, 1
    v_sub_f32 v187, v187, v118
    v_sub_f32 v188, v188, v118
    v_mfma_f32_16x16x32_bf16 v[154:157], a[244:247], v[206:209], v[154:157]
    s_cmp_lt_u32 s18, s45
    v_exp_f32 v187, v187
    v_mfma_f32_16x16x32_bf16 v[154:157], a[248:251], v[210:213], v[154:157]
    v_cvt_pk_bf16_f32 v186, v186, v187
    v_sub_f32 v189, v189, v118
    v_mfma_f32_16x16x32_bf16 v[154:157], a[252:255], v[194:197], v[154:157]
    v_exp_f32 v188, v188
    v_mfma_f32_16x16x32_bf16 v[154:157], v[82:85], v[198:201], v[154:157]
    v_exp_f32 v189, v189
    v_mfma_f32_16x16x32_bf16 v[154:157], v[86:89], v[222:225], v[154:157]
    v_cvt_pk_bf16_f32 v187, v188, v189
    v_sub_f32 v182, v182, v118
    v_mfma_f32_16x16x32_bf16 v[202:205], v[90:93], v[214:217], 0
    ds_read_b128 v[214:217], v2 offset:6144
    v_sub_f32 v183, v183, v118
    v_mfma_f32_16x16x32_bf16 v[202:205], v[94:97], v[206:209], v[202:205]
    ds_read_b128 v[206:209], v2 offset:7168
    v_sub_f32 v184, v184, v118
    v_mfma_f32_16x16x32_bf16 v[202:205], v[98:101], v[210:213], v[202:205]
    ds_read_b128 v[210:213], v2 offset:8192
    v_sub_f32 v185, v185, v118
    v_mfma_f32_16x16x32_bf16 v[202:205], v[102:105], v[194:197], v[202:205]
    ds_read_b128 v[194:197], v2 offset:9216
    buffer_store_dwordx2 v[254:255], v19, s[12:15], 0 offen nt
    v_exp_f32 v182, v182
    v_mfma_f32_16x16x32_f16 v[234:237], v[178:181], v[150:153], v[58:61]
    v_exp_f32 v183, v183
    v_mfma_f32_16x16x32_bf16 v[202:205], v[106:109], v[198:201], v[202:205]
    ds_read_b128 v[198:201], v2 offset:10240
    v_cvt_pk_bf16_f32 v188, v182, v183
    v_mfma_f32_16x16x32_bf16 v[202:205], v[110:113], v[222:225], v[202:205]
    ds_read_b128 v[222:225], v2 offset:11264
    v_exp_f32 v184, v184
    v_mfma_f32_16x16x16_f16 v[234:237], v[120:121], v[126:127], v[234:237]
    v_exp_f32 v185, v185
    v_sub_f32 v166, v166, v118
    v_cvt_pk_bf16_f32 v189, v184, v185
    v_mfma_f32_16x16x32_f16 v[182:185], v[138:141], v[150:153], v[62:65]
    s_waitcnt lgkmcnt(4)
    v_exp_f32 v166, v166
    v_sub_f32 v167, v167, v118
    v_exp_f32 v167, v167
    v_sub_f32 v168, v168, v118
    v_cvt_pk_bf16_f32 v36, v166, v167
    v_mfma_f32_16x16x16_f16 v[182:185], v[128:129], v[126:127], v[182:185]
    v_exp_f32 v168, v168
    v_sub_f32 v169, v169, v118
    v_sub_f32 v226, v226, v118
    v_mfma_f32_16x16x32_f16 v[242:245], v[158:161], v[150:153], v[66:69]
    s_waitcnt lgkmcnt(2)
    v_exp_f32 v169, v169
    v_mfma_f32_16x16x32_bf16 v[114:117], a[216:219], v[214:217], 0
    s_waitcnt lgkmcnt(1)
    v_cvt_pk_bf16_f32 v37, v168, v169
    v_mov_b32_dpp v232, v239 quad_perm:[0,1,2,3] row_mask:0x4 bank_mask:0xf
    v_mov_b32 v118, v232
    v_mfma_f32_16x16x16_f16 v[242:245], v[132:133], v[126:127], v[242:245]
    v_exp_f32 v226, v226
    v_max_f32_dpp v118, v118, v118 quad_perm:[1,0,3,2] row_mask:0xf bank_mask:0xf
    v_cvt_pk_bf16_f32 v39, v226, 0
    v_mfma_f32_16x16x32_bf16 v[114:117], a[220:223], v[206:209], v[114:117]
    s_waitcnt lgkmcnt(0)
    v_max_f32_dpp v118, v118, v118 quad_perm:[2,3,0,1] row_mask:0xf bank_mask:0xf
    v_max3_f32 v126, v218, v234, v235
    v_mfma_f32_16x16x32_bf16 v[150:153], v[28:31], v[36:39], 0
    v_max_f32_dpp v118, v118, v118 row_half_mirror row_mask:0xf bank_mask:0xf
    v_max3_f32 v126, v126, v236, v237
    v_mfma_f32_16x16x32_bf16 v[150:153], v[28:31], v[186:189], v[150:153]
    v_max_f32_dpp v118, v118, v118 row_mirror row_mask:0xf bank_mask:0xf
    v_mov_b32 v119, v118
    v_mfma_f32_16x16x32_bf16 v[114:117], a[224:227], v[210:213], v[114:117]
    v_max3_f32 v126, v126, v182, v183
    v_max3_f32 v126, v126, v184, v185
    v_mfma_f32_16x16x32_bf16 v[114:117], a[228:231], v[194:197], v[114:117]
    v_permlane32_swap_b32 v118, v119
    v_mfma_f32_16x16x32_bf16 v[114:117], a[232:235], v[198:201], v[114:117]
    v_rcp_f32 v150, v150
    v_mfma_f32_16x16x32_bf16 v[114:117], a[236:239], v[222:225], v[114:117]
    v_max_f32 v118, v118, v119
    v_mov_b32 v119, v118
    v_max3_f32 v126, v126, v242, v243
    v_max3_f32 v126, v126, v244, v245
    v_permlane16_swap_b32 v118, v119
    v_max_f32 v118, v118, v119
    v_mfma_f32_16x16x32_bf16 v[166:169], v[142:145], v[36:39], 0
    v_sub_f32 v232, v232, v118
    v_mov_b32 v127, v126
    v_mfma_f32_16x16x32_bf16 v[166:169], v[146:149], v[186:189], v[166:169]
    v_exp_f32 v232, v232
    v_permlane32_swap_b32 v126, v127
    v_cvt_pk_bf16_f32 v232, v232, v232
    v_max_f32 v126, v126, v127
    v_mov_b32 v127, v126
    v_fma_f32 v254, v122, v122, s33
    v_fmac_f32 v254, v123, v123
    v_permlane16_swap_b32 v126, v127
    v_mul_f32 v166, v150, v166
    v_mul_f32 v167, v150, v167
    v_cvt_pk_bf16_f32 v166, v166, v167
    v_mul_f32 v168, v150, v168
    v_mul_f32 v169, v150, v169
    v_cvt_pk_bf16_f32 v167, v168, v169
    v_max_f32 v126, v126, v127
    v_sub_f32 v234, v234, v126
    v_exp_f32 v234, v234
    v_sub_f32 v235, v235, v126
    v_exp_f32 v235, v235
    v_sub_f32 v236, v236, v126
    v_cvt_pk_bf16_f32 v226, v234, v235
    v_exp_f32 v236, v236
    v_sub_f32 v237, v237, v126
    v_exp_f32 v237, v237
    v_sub_f32 v182, v182, v126
    v_cvt_pk_bf16_f32 v227, v236, v237
    v_mfma_f32_16x16x32_bf16 v[234:237], v[170:173], v[36:39], 0
    ds_write_b16 v8, v232
    v_mfma_f32_16x16x32_bf16 v[234:237], v[174:177], v[186:189], v[234:237]
    v_exp_f32 v182, v182
    v_sub_f32 v183, v183, v126
    v_exp_f32 v183, v183
    v_sub_f32 v184, v184, v126
    v_cvt_pk_bf16_f32 v228, v182, v183
    v_exp_f32 v184, v184
    v_sub_f32 v185, v185, v126
    v_exp_f32 v185, v185
    v_mul_f32 v234, v150, v234
    v_mul_f32 v235, v150, v235
    v_cvt_pk_bf16_f32 v168, v234, v235
    v_mul_f32 v236, v150, v236
    v_mul_f32 v237, v150, v237
    v_cvt_pk_bf16_f32 v169, v236, v237
    v_mfma_f32_16x16x32_bf16 v[230:233], v[190:193], v[36:39], 0
    ds_write_b128 v3, v[166:169] offset:0
    v_mfma_f32_16x16x32_bf16 v[230:233], v[134:137], v[186:189], v[230:233]
    v_cvt_pk_bf16_f32 v229, v184, v185
    v_sub_f32 v242, v242, v126
    v_mfma_f32_16x16x32_f16 v[182:185], v[178:181], v[162:165], v[70:73]
    v_exp_f32 v242, v242
    v_mfma_f32_16x16x32_bf16 v[166:169], a[240:243], v[214:217], 0
    ds_read_b128 v[178:181], v9
    v_sub_f32 v243, v243, v126
    v_mfma_f32_16x16x32_bf16 v[166:169], a[244:247], v[206:209], v[166:169]
    v_mul_f32 v230, v150, v230
    v_mul_f32 v231, v150, v231
    v_cvt_pk_bf16_f32 v220, v230, v231
    v_mfma_f32_16x16x16_f16 v[182:185], v[120:121], v[130:131], v[182:185]
    v_mul_f32 v232, v150, v232
    v_mul_f32 v233, v150, v233
    v_cvt_pk_bf16_f32 v221, v232, v233
    v_sub_f32 v244, v244, v126
    v_mfma_f32_16x16x32_bf16 v[166:169], a[248:251], v[210:213], v[166:169]
    ds_read_b128 v[118:121], v9 offset:64
    v_sub_f32 v245, v245, v126
    v_mfma_f32_16x16x32_bf16 v[166:169], a[252:255], v[194:197], v[166:169]
    ds_write_b64 v4, v[220:221] offset:4096
    v_mfma_f32_16x16x32_bf16 v[166:169], v[82:85], v[198:201], v[166:169]
    v_max3_f32 v255, v238, v182, v183
    v_max3_f32 v255, v255, v184, v185
    v_mfma_f32_16x16x32_bf16 v[166:169], v[86:89], v[222:225], v[166:169]
    v_exp_f32 v243, v243
    v_exp_f32 v244, v244
    v_cvt_pk_bf16_f32 v36, v242, v243
    v_mfma_f32_16x16x32_f16 v[186:189], v[138:141], v[162:165], v[74:77]
    s_waitcnt lgkmcnt(2)
    v_exp_f32 v245, v245
    v_mfma_f32_16x16x32_f16 v[246:249], v[158:161], v[162:165], v[78:81]
    v_cvt_pk_bf16_f32 v37, v244, v245
    v_sub_f32 v218, v218, v126
    v_mfma_f32_16x16x32_bf16 v[242:245], v[178:181], v[28:31], 0
    v_exp_f32 v218, v218
    v_fmac_f32 v254, v124, v124
    v_mfma_f32_16x16x16_f16 v[186:189], v[128:129], v[130:131], v[186:189]
    v_cvt_pk_bf16_f32 v39, v218, 0
    v_fmac_f32 v254, v125, v125
    v_fmac_f32 v254, v154, v154
    v_mfma_f32_16x16x16_f16 v[246:249], v[132:133], v[130:131], v[246:249]
    v_fmac_f32 v254, v155, v155
    v_fmac_f32 v254, v156, v156
    v_fmac_f32 v254, v157, v157
    v_fmac_f32 v254, v202, v202
    v_mfma_f32_16x16x32_bf16 v[126:129], v[28:31], v[36:39], 0
    s_waitcnt lgkmcnt(0)
    v_max3_f32 v255, v255, v186, v187
    v_max3_f32 v255, v255, v188, v189
    v_mfma_f32_16x16x32_bf16 v[126:129], v[28:31], v[226:229], v[126:129]
    v_max3_f32 v255, v255, v246, v247
    v_max3_f32 v255, v255, v248, v249
    v_mfma_f32_16x16x32_bf16 v[130:133], v[142:145], v[36:39], 0
    v_mov_b32 v239, v255
    v_fmac_f32 v254, v203, v203
    v_mfma_f32_16x16x32_bf16 v[130:133], v[146:149], v[226:229], v[130:133]
    v_permlane32_swap_b32 v255, v239
    v_mfma_f32_16x16x32_bf16 v[138:141], v[170:173], v[36:39], 0
    v_rcp_f32 v126, v126
    v_mfma_f32_16x16x32_bf16 v[138:141], v[174:177], v[226:229], v[138:141]
    v_max_f32 v255, v255, v239
    v_mov_b32 v239, v255
    v_mfma_f32_16x16x32_bf16 v[150:153], v[190:193], v[36:39], 0
    v_fmac_f32 v254, v204, v204
    v_mul_f32 v130, v126, v130
    v_mfma_f32_16x16x32_bf16 v[150:153], v[134:137], v[226:229], v[150:153]
    v_mul_f32 v131, v126, v131
    v_cvt_pk_bf16_f32 v130, v130, v131
    v_mfma_f32_16x16x32_bf16 v[242:245], v[118:121], v[28:31], v[242:245]
    v_mul_f32 v132, v126, v132
    v_mul_f32 v133, v126, v133
    v_mfma_f32_16x16x32_bf16 v[218:221], v[178:181], v[146:149], 0
    v_cvt_pk_bf16_f32 v131, v132, v133
    v_mul_f32 v138, v126, v138
    v_mfma_f32_16x16x32_bf16 v[218:221], v[118:121], v[142:145], v[218:221]
    v_mul_f32 v139, v126, v139
    v_cvt_pk_bf16_f32 v132, v138, v139
    v_mfma_f32_16x16x32_bf16 v[226:229], v[178:181], v[174:177], 0
    v_mul_f32 v140, v126, v140
    v_mul_f32 v141, v126, v141
    v_mfma_f32_16x16x32_bf16 v[226:229], v[118:121], v[170:173], v[226:229]
    v_cvt_pk_bf16_f32 v133, v140, v141
    v_mul_f32 v150, v126, v150
    v_mfma_f32_16x16x32_bf16 v[250:253], v[178:181], v[134:137], 0
    ds_write_b128 v3, v[130:133] offset:6144
    v_mfma_f32_16x16x32_bf16 v[250:253], v[118:121], v[190:193], v[250:253]
    v_mul_f32 v151, v126, v151
    v_cvt_pk_bf16_f32 v240, v150, v151
    v_mfma_f32_16x16x32_bf16 v[230:233], v[90:93], v[214:217], 0
    v_mul_f32 v152, v126, v152
    v_mul_f32 v153, v126, v153
    v_mfma_f32_16x16x32_bf16 v[230:233], v[94:97], v[206:209], v[230:233]
    ds_read_b128 v[118:121], v2 offset:12288
    ds_read_b128 v[126:129], v2 offset:13312
    v_mfma_f32_16x16x32_bf16 v[230:233], v[98:101], v[210:213], v[230:233]
    ds_read_b128 v[130:133], v2 offset:14336
    v_cvt_pk_bf16_f32 v241, v152, v153
    v_mfma_f32_16x16x32_bf16 v[230:233], v[102:105], v[194:197], v[230:233]
    ds_read_b128 v[158:161], v2 offset:15360
    v_fmac_f32 v254, v205, v205
    v_mfma_f32_16x16x32_bf16 v[230:233], v[106:109], v[198:201], v[230:233]
    ds_read_b128 v[178:181], v2 offset:16384
    v_fma_f32 v219, v114, v114, s33
    v_mfma_f32_16x16x32_bf16 v[230:233], v[110:113], v[222:225], v[230:233]
    ds_read_b128 v[194:197], v2 offset:17408
    ds_write_b64 v4, v[240:241] offset:10240
    v_permlane16_swap_b32 v255, v239
    v_max_f32 v255, v255, v239
    v_sub_f32 v182, v182, v255
    v_exp_f32 v182, v182
    v_sub_f32 v183, v183, v255
    v_exp_f32 v183, v183
    s_waitcnt lgkmcnt(5)
    v_mfma_f32_16x16x32_bf16 v[150:153], a[216:219], v[118:121], 0
    v_cvt_pk_bf16_f32 v198, v182, v183
    v_sub_f32 v184, v184, v255
    v_mfma_f32_16x16x32_bf16 v[150:153], a[220:223], v[126:129], v[150:153]
    s_waitcnt lgkmcnt(4)
    v_exp_f32 v184, v184
    v_mfma_f32_16x16x32_bf16 v[150:153], a[224:227], v[130:133], v[150:153]
    s_waitcnt lgkmcnt(3)
    v_sub_f32 v185, v185, v255
    v_sub_f32 v186, v186, v255
    v_mfma_f32_16x16x32_bf16 v[150:153], a[228:231], v[158:161], v[150:153]
    s_waitcnt lgkmcnt(2)
    v_exp_f32 v185, v185
    v_mfma_f32_16x16x32_bf16 v[150:153], a[232:235], v[178:181], v[150:153]
    s_waitcnt lgkmcnt(0)
    v_cvt_pk_bf16_f32 v199, v184, v185
    v_sub_f32 v187, v187, v255
    v_mfma_f32_16x16x32_bf16 v[150:153], a[236:239], v[194:197], v[150:153]
    v_exp_f32 v186, v186
    v_mfma_f32_16x16x32_bf16 v[162:165], a[240:243], v[118:121], 0
    v_exp_f32 v187, v187
    v_mfma_f32_16x16x32_bf16 v[162:165], a[244:247], v[126:129], v[162:165]
    v_cvt_pk_bf16_f32 v200, v186, v187
    v_sub_f32 v188, v188, v255
    v_mfma_f32_16x16x32_bf16 v[162:165], a[248:251], v[130:133], v[162:165]
    v_exp_f32 v188, v188
    v_mfma_f32_16x16x32_bf16 v[162:165], a[252:255], v[158:161], v[162:165]
    v_sub_f32 v189, v189, v255
    v_sub_f32 v246, v246, v255
    v_mfma_f32_16x16x32_bf16 v[162:165], v[82:85], v[178:181], v[162:165]
    v_exp_f32 v189, v189
    v_mfma_f32_16x16x32_bf16 v[162:165], v[86:89], v[194:197], v[162:165]
    v_cvt_pk_bf16_f32 v201, v188, v189
    v_sub_f32 v247, v247, v255
    v_mfma_f32_16x16x32_bf16 v[138:141], v[90:93], v[118:121], 0
    v_exp_f32 v246, v246
    v_mfma_f32_16x16x32_bf16 v[138:141], v[94:97], v[126:129], v[138:141]
    v_exp_f32 v247, v247
    v_mfma_f32_16x16x32_bf16 v[138:141], v[98:101], v[130:133], v[138:141]
    v_cvt_pk_bf16_f32 v36, v246, v247
    v_sub_f32 v248, v248, v255
    v_mfma_f32_16x16x32_bf16 v[138:141], v[102:105], v[158:161], v[138:141]
    v_exp_f32 v248, v248
    v_mfma_f32_16x16x32_bf16 v[138:141], v[106:109], v[178:181], v[138:141]
    v_sub_f32 v249, v249, v255
    v_sub_f32 v238, v238, v255
    v_mfma_f32_16x16x32_bf16 v[138:141], v[110:113], v[194:197], v[138:141]
    ds_read_b128 v[186:189], v0 offset:20480
    ds_read_b128 v[118:121], v1 offset:20480
    ds_read_b128 v[234:237], v0 offset:20608
    v_exp_f32 v249, v249
    v_exp_f32 v238, v238
    v_cvt_pk_bf16_f32 v37, v248, v249
    v_cvt_pk_bf16_f32 v39, v238, 0
    v_fma_f32 v255, v150, v150, s33
    v_fmac_f32 v255, v151, v151
    v_mfma_f32_16x16x32_bf16 v[126:129], v[28:31], v[36:39], 0
    ds_read_b128 v[158:161], v1 offset:20608
    ds_read_b128 v[182:185], v0 offset:20736
    v_mfma_f32_16x16x32_bf16 v[126:129], v[28:31], v[198:201], v[126:129]
    ds_read_b128 v[206:209], v1 offset:20736
    v_fmac_f32 v255, v152, v152
    v_mfma_f32_16x16x32_bf16 v[178:181], v[142:145], v[36:39], 0
    v_fmac_f32 v255, v153, v153
    v_fmac_f32 v255, v162, v162
    v_mfma_f32_16x16x32_bf16 v[178:181], v[146:149], v[198:201], v[178:181]
    v_fmac_f32 v255, v163, v163
    v_fmac_f32 v255, v164, v164
    v_mfma_f32_16x16x32_bf16 v[142:145], v[170:173], v[36:39], 0
    s_waitcnt lgkmcnt(5)
    v_rcp_f32 v126, v126
    v_mfma_f32_16x16x32_bf16 v[142:145], v[174:177], v[198:201], v[142:145]
    s_waitcnt lgkmcnt(3)
    v_fmac_f32 v255, v165, v165
    v_mul_f32 v178, v126, v178
    v_mfma_f32_16x16x32_bf16 v[146:149], v[190:193], v[36:39], 0
    v_mul_f32 v179, v126, v179
    v_cvt_pk_bf16_f32 v170, v178, v179
    v_mfma_f32_16x16x32_bf16 v[146:149], v[134:137], v[198:201], v[146:149]
    v_mul_f32 v180, v126, v180
    v_mul_f32 v181, v126, v181
    v_mfma_f32_16x16x32_bf16 v[130:133], a[72:75], v[186:189], 0
    s_waitcnt lgkmcnt(1)
    v_cvt_pk_bf16_f32 v171, v180, v181
    v_mul_f32 v142, v126, v142
    v_mfma_f32_16x16x32_bf16 v[130:133], a[76:79], v[118:121], v[130:133]
    s_waitcnt lgkmcnt(0)
    v_mul_f32 v143, v126, v143
    v_cvt_pk_bf16_f32 v172, v142, v143
    v_mfma_f32_16x16x32_bf16 v[130:133], a[80:83], v[234:237], v[130:133]
    v_mul_f32 v144, v126, v144
    v_mul_f32 v145, v126, v145
    v_mfma_f32_16x16x32_bf16 v[130:133], a[84:87], v[158:161], v[130:133]
    v_cvt_pk_bf16_f32 v173, v144, v145
    v_mul_f32 v146, v126, v146
    v_mfma_f32_16x16x32_bf16 v[130:133], a[88:91], v[182:185], v[130:133]
    ds_write_b128 v3, v[170:173] offset:12288
    v_mfma_f32_16x16x32_bf16 v[130:133], a[92:95], v[206:209], v[130:133]
    v_mul_f32 v147, v126, v147
    v_cvt_pk_bf16_f32 v220, v146, v147
    v_mfma_f32_16x16x32_bf16 v[134:137], a[96:99], v[186:189], 0
    v_mul_f32 v148, v126, v148
    v_mul_f32 v149, v126, v149
    v_mfma_f32_16x16x32_bf16 v[134:137], a[100:103], v[118:121], v[134:137]
    v_cvt_pk_bf16_f32 v221, v148, v149
    v_fmac_f32 v255, v138, v138
    v_mfma_f32_16x16x32_bf16 v[134:137], a[104:107], v[234:237], v[134:137]
    ds_write_b64 v4, v[220:221] offset:16384
    v_mfma_f32_16x16x32_bf16 v[134:137], a[108:111], v[158:161], v[134:137]
    v_fmac_f32 v255, v139, v139
    v_fmac_f32 v255, v140, v140
    v_mfma_f32_16x16x32_bf16 v[134:137], a[112:115], v[182:185], v[134:137]
    v_fmac_f32 v255, v141, v141
    v_cvt_pk_bf16_f32 v255, v255, v255
    v_mfma_f32_16x16x32_bf16 v[134:137], a[116:119], v[206:209], v[134:137]
    v_rcp_f32 v242, v242
    v_mfma_f32_16x16x32_bf16 v[170:173], a[120:123], v[186:189], 0
    v_mul_f32 v218, v218, v242
    v_mul_f32_dpp v218, v226, v242 quad_perm:[0,1,2,3] row_mask:0x2 bank_mask:0xf
    v_mfma_f32_16x16x32_bf16 v[170:173], a[124:127], v[118:121], v[170:173]
    v_mul_f32_dpp v218, v250, v242 quad_perm:[0,1,2,3] row_mask:0x4 bank_mask:0xf
    v_cvt_pk_bf16_f32 v218, v218, v218
    v_mfma_f32_16x16x32_bf16 v[170:173], a[128:131], v[234:237], v[170:173]
    ds_write_b16 v7, v218
    v_mfma_f32_16x16x32_bf16 v[170:173], a[132:135], v[158:161], v[170:173]
    v_fmac_f32 v219, v115, v115
    v_fmac_f32 v219, v116, v116
    v_mfma_f32_16x16x32_bf16 v[170:173], a[136:139], v[182:185], v[170:173]
    v_fmac_f32 v219, v117, v117
    v_fmac_f32 v219, v166, v166
    v_mfma_f32_16x16x32_bf16 v[170:173], a[140:143], v[206:209], v[170:173]
    v_fmac_f32 v219, v167, v167
    v_fmac_f32 v219, v168, v168
    v_mfma_f32_16x16x32_bf16 v[142:145], a[0:3], v[186:189], 0
    v_fmac_f32 v219, v169, v169
    v_fmac_f32 v219, v230, v230
    v_mfma_f32_16x16x32_bf16 v[142:145], a[4:7], v[118:121], v[142:145]
    v_fmac_f32 v219, v231, v231
    v_fmac_f32 v219, v232, v232
    v_mfma_f32_16x16x32_bf16 v[142:145], a[8:11], v[234:237], v[142:145]
    v_fmac_f32 v219, v233, v233
    v_cvt_pk_bf16_f32 v254, v254, v219
    v_mfma_f32_16x16x32_bf16 v[142:145], a[12:15], v[158:161], v[142:145]
    ds_write_b64 v4, v[254:255] offset:18432
    v_mfma_f32_16x16x32_bf16 v[142:145], a[16:19], v[182:185], v[142:145]
    v_fma_f32 v174, v130, v130, s32
    v_fmac_f32 v174, v131, v131
    v_mfma_f32_16x16x32_bf16 v[142:145], a[20:23], v[206:209], v[142:145]
    v_fmac_f32 v174, v132, v132
    v_fmac_f32 v174, v133, v133
    v_mfma_f32_16x16x32_bf16 v[126:129], a[24:27], v[186:189], 0
    v_xor_b32 v2, 65536, v2
    v_xor_b32 v3, 65536, v3
    v_mfma_f32_16x16x32_bf16 v[126:129], a[28:31], v[118:121], v[126:129]
    v_xor_b32 v4, 65536, v4
    v_add_u32 v5, s74, v5
    v_mfma_f32_16x16x32_bf16 v[126:129], a[32:35], v[234:237], v[126:129]
    v_add_u32 v6, s75, v6
    v_add_u32 v7, s76, v7
    v_mfma_f32_16x16x32_bf16 v[126:129], a[36:39], v[158:161], v[126:129]
    v_mfma_f32_16x16x32_bf16 v[126:129], a[40:43], v[182:185], v[126:129]
    s_waitcnt lgkmcnt(0)
    s_nop 0
    s_barrier
    s_nop 0
    s_nop 0
    v_mfma_f32_16x16x32_bf16 v[126:129], a[44:47], v[206:209], v[126:129]
    s_cbranch_scc1 L_loop_safe1
    s_branch L_final_safe
.p2align 6
L_loop_safe2:
    v_mfma_f32_16x16x32_bf16 v[190:193], a[48:51], v[186:189], 0
    s_add_u32 s12, s40, s27
    ds_read_b128 v[146:149], v2 offset:18432
    ds_read_b128 v[178:181], v2 offset:19456
    v_mfma_f32_16x16x32_bf16 v[190:193], a[52:55], v[118:121], v[190:193]
    s_addc_u32 s13, s41, 0
    v_fmac_f32 v174, v134, v134
    v_fmac_f32 v174, v135, v135
    v_mfma_f32_16x16x32_bf16 v[190:193], a[56:59], v[234:237], v[190:193]
    s_sub_u32 s14, s36, s27
    v_fmac_f32 v174, v136, v136
    v_fmac_f32 v174, v137, v137
    v_mfma_f32_16x16x32_bf16 v[190:193], a[60:63], v[158:161], v[190:193]
    s_cmp_ge_u32 s18, 2
    v_fmac_f32 v174, v170, v170
    v_fmac_f32 v174, v171, v171
    v_mfma_f32_16x16x32_bf16 v[190:193], a[64:67], v[182:185], v[190:193]
    s_cselect_b32 s14, s14, 0
    v_fmac_f32 v174, v172, v172
    v_fmac_f32 v174, v173, v173
    v_mfma_f32_16x16x32_bf16 v[190:193], a[68:71], v[206:209], v[190:193]
    s_sub_u32 s82, s72, s71
    v_fma_f32 v254, v142, v142, s32
    v_fmac_f32 v254, v143, v143
    v_mfma_f32_16x16x32_bf16 v[194:197], v[186:189], a[144:147], 0
    s_mul_i32 s74, s82, 336
    v_fmac_f32 v254, v144, v144
    v_fmac_f32 v254, v145, v145
    v_mfma_f32_16x16x32_bf16 v[194:197], v[118:121], a[148:151], v[194:197]
    s_mul_i32 s75, s82, 272
    v_fmac_f32 v254, v126, v126
    v_fmac_f32 v254, v127, v127
    v_mfma_f32_16x16x32_bf16 v[194:197], v[234:237], a[152:155], v[194:197]
    s_waitcnt lgkmcnt(0)
    v_fmac_f32 v254, v128, v128
    v_fmac_f32 v254, v129, v129
    v_mfma_f32_16x16x32_bf16 v[198:201], v[32:35], v[146:149], 0
    s_mul_i32 s76, s82, 16
    v_fmac_f32 v254, v190, v190
    v_fmac_f32 v254, v191, v191
    v_mfma_f32_16x16x32_bf16 v[198:201], v[32:35], v[178:181], v[198:201]
    s_add_u32 s34, s18, 2
    v_fmac_f32 v254, v192, v192
    v_fmac_f32 v254, v193, v193
    v_mfma_f32_16x16x32_bf16 v[194:197], v[158:161], a[156:159], v[194:197]
    s_add_u32 s8, s60, s23
    v_cvt_pk_bf16_f32 v36, v254, v174
    s_addc_u32 s9, s61, 0
    v_mfma_f32_16x16x32_bf16 v[194:197], v[182:185], a[160:163], v[194:197]
    s_sub_u32 s10, s36, s23
    v_mul_f32 v254, 0x3baaaaab, v198
    v_mul_f32 v255, 0x3baaaaab, v199
    v_mfma_f32_16x16x32_bf16 v[210:213], v[32:35], v[36:39], 0
    s_cmp_le_u32 s34, s45
    v_rsq_f32 v254, v254
    v_mfma_f32_16x16x32_bf16 v[194:197], v[206:209], a[164:167], v[194:197]
    s_cselect_b32 s10, s10, 0
    ds_read_b128 v[214:217], v0 offset:26624
    v_mul_f32 v148, 0x3baaaaab, v200
    v_mfma_f32_16x16x32_bf16 v[174:177], v[186:189], a[168:171], 0
    s_add_u32 m0, s28, 0
    ds_read_b128 v[198:201], v1 offset:26624
    v_mul_f32 v122, v254, v122
    v_mfma_f32_16x16x32_bf16 v[174:177], v[118:121], a[172:175], v[174:177]
    s_mov_b32 s27, s26
    ds_read_b128 v[218:221], v0 offset:26752
    v_cvt_pk_bf16_f32 v146, v194, v195
    v_mfma_f32_16x16x32_bf16 v[174:177], v[234:237], a[176:179], v[174:177]
    s_mov_b32 s26, s25
    ds_read_b128 v[222:225], v1 offset:26752
    v_cvt_pk_bf16_f32 v147, v196, v197
    v_mfma_f32_16x16x32_bf16 v[174:177], v[158:161], a[180:183], v[174:177]
    s_mov_b32 s25, s24
    v_rsq_f32 v211, v211
    v_mfma_f32_16x16x32_bf16 v[174:177], v[182:185], a[184:187], v[174:177]
    s_mov_b32 s24, s23
    v_rsq_f32 v210, v210
    v_mfma_f32_16x16x32_bf16 v[174:177], v[206:209], a[188:191], v[174:177]
    s_ff1_i32_b32 s80, s100
    v_mul_f32 v210, s31, v210
    v_mul_f32 v130, v211, v130
    v_mul_f32 v131, v211, v131
    v_cvt_pk_f16_f32 v178, v130, v131
    v_mfma_f32_16x16x32_bf16 v[194:197], v[186:189], a[192:195], 0
    s_waitcnt lgkmcnt(3)
    ds_read_b128 v[186:189], v0 offset:26880
    v_cvt_pk_bf16_f32 v174, v174, v175
    v_mfma_f32_16x16x32_bf16 v[194:197], v[118:121], a[196:199], v[194:197]
    s_mov_b32 s71, s72
    ds_read_b128 v[226:229], v1 offset:26880
    v_cvt_pk_bf16_f32 v175, v176, v177
    v_mfma_f32_16x16x32_bf16 v[194:197], v[234:237], a[200:203], v[194:197]
    s_mov_b32 s72, s73
    v_mul_f32 v132, v211, v132
    v_mul_f32 v133, v211, v133
    v_mfma_f32_16x16x32_bf16 v[194:197], v[158:161], a[204:207], v[194:197]
    s_waitcnt lgkmcnt(2)
    v_cvt_pk_f16_f32 v179, v132, v133
    v_mul_f32 v134, v211, v134
    v_mfma_f32_16x16x32_bf16 v[194:197], v[182:185], a[208:211], v[194:197]
    v_mul_f32 v135, v211, v135
    v_cvt_pk_f16_f32 v180, v134, v135
    v_mfma_f32_16x16x32_bf16 v[194:197], v[206:209], a[212:215], v[194:197]
    v_mul_f32 v136, v211, v136
    v_mul_f32 v137, v211, v137
    v_mfma_f32_16x16x32_bf16 v[130:133], a[72:75], v[214:217], 0
    v_cvt_pk_f16_f32 v181, v136, v137
    v_mul_f32 v170, v211, v170
    v_mfma_f32_16x16x32_bf16 v[130:133], a[76:79], v[198:201], v[130:133]
    v_mul_f32 v171, v211, v171
    v_cvt_pk_f16_f32 v120, v170, v171
    v_mfma_f32_16x16x32_bf16 v[130:133], a[80:83], v[218:221], v[130:133]
    s_waitcnt lgkmcnt(1)
    v_cvt_pk_bf16_f32 v134, v194, v195
    v_cvt_pk_bf16_f32 v135, v196, v197
    v_mfma_f32_16x16x32_bf16 v[130:133], a[84:87], v[222:225], v[130:133]
    s_waitcnt lgkmcnt(0)
    v_mul_f32 v172, v211, v172
    v_mul_f32 v173, v211, v173
    v_mfma_f32_16x16x32_bf16 v[130:133], a[88:91], v[186:189], v[130:133]
    v_cvt_pk_f16_f32 v121, v172, v173
    v_mul_f32 v142, v210, v142
    v_mfma_f32_16x16x32_bf16 v[130:133], a[92:95], v[226:229], v[130:133]
    v_mul_f32 v143, v210, v143
    v_cvt_pk_f16_f32 v194, v142, v143
    v_mfma_f32_16x16x32_bf16 v[158:161], a[96:99], v[214:217], 0
    v_mul_f32 v144, v210, v144
    v_mul_f32 v145, v210, v145
    v_mfma_f32_16x16x32_bf16 v[158:161], a[100:103], v[198:201], v[158:161]
    v_cvt_pk_f16_f32 v195, v144, v145
    v_mul_f32 v126, v210, v126
    v_mfma_f32_16x16x32_bf16 v[158:161], a[104:107], v[218:221], v[158:161]
    v_mul_f32 v127, v210, v127
    v_cvt_pk_f16_f32 v196, v126, v127
    v_mfma_f32_16x16x32_bf16 v[158:161], a[108:111], v[222:225], v[158:161]
    v_mul_f32 v128, v210, v128
    v_mul_f32 v129, v210, v129
    v_mfma_f32_16x16x32_bf16 v[158:161], a[112:115], v[186:189], v[158:161]
    v_cvt_pk_f16_f32 v197, v128, v129
    v_mul_f32 v190, v210, v190
    v_mfma_f32_16x16x32_bf16 v[158:161], a[116:119], v[226:229], v[158:161]
    v_mul_f32 v191, v210, v191
    v_cvt_pk_f16_f32 v118, v190, v191
    v_mfma_f32_16x16x32_bf16 v[142:145], a[120:123], v[214:217], 0
    v_mul_f32 v192, v210, v192
    v_mul_f32 v193, v210, v193
    v_mfma_f32_16x16x32_bf16 v[142:145], a[124:127], v[198:201], v[142:145]
    v_cvt_pk_f16_f32 v119, v192, v193
    v_fma_f32 v149, v130, v130, s32
    v_mfma_f32_16x16x32_bf16 v[142:145], a[128:131], v[218:221], v[142:145]
    v_fmac_f32 v149, v131, v131
    v_fmac_f32 v149, v132, v132
    v_mfma_f32_16x16x32_bf16 v[142:145], a[132:135], v[222:225], v[142:145]
    v_fmac_f32 v149, v133, v133
    v_fmac_f32 v149, v158, v158
    v_mfma_f32_16x16x32_bf16 v[142:145], a[136:139], v[186:189], v[142:145]
    v_fmac_f32 v149, v159, v159
    v_fmac_f32 v149, v160, v160
    v_mfma_f32_16x16x32_bf16 v[142:145], a[140:143], v[226:229], v[142:145]
    v_fmac_f32 v149, v161, v161
    v_mul_f32 v123, v254, v123
    v_mfma_f32_16x16x32_bf16 v[170:173], a[0:3], v[214:217], 0
    v_rsq_f32 v255, v255
    v_mfma_f32_16x16x32_bf16 v[170:173], a[4:7], v[198:201], v[170:173]
    v_rsq_f32 v148, v148
    v_mfma_f32_16x16x32_bf16 v[170:173], a[8:11], v[218:221], v[170:173]
    v_mul_f32 v150, v148, v150
    v_fmac_f32 v149, v142, v142
    v_mfma_f32_16x16x32_bf16 v[170:173], a[12:15], v[222:225], v[170:173]
    v_fmac_f32 v149, v143, v143
    v_fmac_f32 v149, v144, v144
    v_mfma_f32_16x16x32_bf16 v[170:173], a[16:19], v[186:189], v[170:173]
    v_fmac_f32 v149, v145, v145
    v_mul_f32 v151, v148, v151
    v_mfma_f32_16x16x32_bf16 v[170:173], a[20:23], v[226:229], v[170:173]
    v_cvt_pk_bf16_f32 v126, v150, v151
    v_mul_f32 v152, v148, v152
    v_mfma_f32_16x16x32_bf16 v[182:185], a[24:27], v[214:217], 0
    v_mul_f32 v153, v148, v153
    v_cvt_pk_bf16_f32 v127, v152, v153
    v_mfma_f32_16x16x32_bf16 v[182:185], a[28:31], v[198:201], v[182:185]
    v_mul_f32 v162, v148, v162
    v_mul_f32 v163, v148, v163
    v_mfma_f32_16x16x32_bf16 v[182:185], a[32:35], v[218:221], v[182:185]
    v_fma_f32 v136, v170, v170, s32
    v_fmac_f32 v136, v171, v171
    v_mfma_f32_16x16x32_bf16 v[182:185], a[36:39], v[222:225], v[182:185]
    v_fmac_f32 v136, v172, v172
    v_fmac_f32 v136, v173, v173
    v_mfma_f32_16x16x32_bf16 v[182:185], a[40:43], v[186:189], v[182:185]
    v_cvt_pk_bf16_f32 v128, v162, v163
    v_mul_f32 v164, v148, v164
    v_mfma_f32_16x16x32_bf16 v[182:185], a[44:47], v[226:229], v[182:185]
    v_mul_f32 v165, v148, v165
    v_cvt_pk_bf16_f32 v129, v164, v165
    v_mfma_f32_16x16x32_bf16 v[162:165], a[48:51], v[214:217], 0
    buffer_store_dwordx4 v[126:129], v17, s[12:15], 0 offen nt
    v_mul_f32 v138, v148, v138
    v_mul_f32 v139, v148, v139
    v_cvt_pk_bf16_f32 v176, v138, v139
    v_mul_f32 v140, v148, v140
    v_mfma_f32_16x16x32_bf16 v[162:165], a[52:55], v[198:201], v[162:165]
    v_fmac_f32 v136, v182, v182
    v_fmac_f32 v136, v183, v183
    v_mfma_f32_16x16x32_bf16 v[162:165], a[56:59], v[218:221], v[162:165]
    v_fmac_f32 v136, v184, v184
    v_fmac_f32 v136, v185, v185
    v_mfma_f32_16x16x32_bf16 v[162:165], a[60:63], v[222:225], v[162:165]
    v_mul_f32 v141, v148, v141
    v_cvt_pk_bf16_f32 v177, v140, v141
    v_mfma_f32_16x16x32_bf16 v[162:165], a[64:67], v[186:189], v[162:165]
    v_cvt_pk_bf16_f32 v190, v122, v123
    v_mul_f32 v124, v254, v124
    v_mfma_f32_16x16x32_bf16 v[162:165], a[68:71], v[226:229], v[162:165]
    v_mul_f32 v125, v254, v125
    v_cvt_pk_bf16_f32 v191, v124, v125
    v_mfma_f32_16x16x32_bf16 v[122:125], v[214:217], a[144:147], 0
    v_mul_f32 v154, v254, v154
    v_mul_f32 v155, v254, v155
    v_mfma_f32_16x16x32_bf16 v[122:125], v[198:201], a[148:151], v[122:125]
    v_cvt_pk_bf16_f32 v192, v154, v155
    v_mul_f32 v156, v254, v156
    v_mfma_f32_16x16x32_bf16 v[122:125], v[218:221], a[152:155], v[122:125]
    v_fmac_f32 v136, v162, v162
    v_fmac_f32 v136, v163, v163
    v_mfma_f32_16x16x32_bf16 v[122:125], v[222:225], a[156:159], v[122:125]
    v_fmac_f32 v136, v164, v164
    v_fmac_f32 v136, v165, v165
    v_mfma_f32_16x16x32_bf16 v[122:125], v[186:189], a[160:163], v[122:125]
    v_cvt_pk_bf16_f32 v36, v136, v149
    v_mul_f32 v157, v254, v157
    v_mfma_f32_16x16x32_bf16 v[122:125], v[226:229], a[164:167], v[122:125]
    ds_read_b128 v[206:209], v0 offset:32768
    v_cvt_pk_bf16_f32 v193, v156, v157
    v_mfma_f32_16x16x32_bf16 v[154:157], v[32:35], v[36:39], 0
    v_mul_f32 v202, v254, v202
    v_mul_f32 v203, v254, v203
    v_mfma_f32_16x16x32_bf16 v[126:129], v[214:217], a[168:171], 0
    ds_read_b128 v[210:213], v1 offset:32768
    v_cvt_pk_bf16_f32 v234, v202, v203
    v_mfma_f32_16x16x32_bf16 v[126:129], v[198:201], a[172:175], v[126:129]
    ds_read_b128 v[238:241], v0 offset:32896
    v_cvt_pk_bf16_f32 v148, v122, v123
    v_mfma_f32_16x16x32_bf16 v[126:129], v[218:221], a[176:179], v[126:129]
    ds_read_b128 v[242:245], v1 offset:32896
    v_cvt_pk_bf16_f32 v149, v124, v125
    v_mfma_f32_16x16x32_bf16 v[126:129], v[222:225], a[180:183], v[126:129]
    v_rsq_f32 v155, v155
    v_mfma_f32_16x16x32_bf16 v[126:129], v[186:189], a[184:187], v[126:129]
    buffer_store_dwordx2 v[176:177], v20, s[12:15], 0 offen nt
    v_rsq_f32 v154, v154
    v_mfma_f32_16x16x32_bf16 v[126:129], v[226:229], a[188:191], v[126:129]
    s_waitcnt lgkmcnt(3)
    v_mul_f32 v154, s31, v154
    v_mul_f32 v130, v155, v130
    v_mul_f32 v131, v155, v131
    v_cvt_pk_f16_f32 v138, v130, v131
    v_mfma_f32_16x16x32_bf16 v[122:125], v[214:217], a[192:195], 0
    ds_read_b128 v[214:217], v0 offset:33024
    v_mul_f32 v132, v155, v132
    v_mfma_f32_16x16x32_bf16 v[122:125], v[198:201], a[196:199], v[122:125]
    s_waitcnt lgkmcnt(3)
    ds_read_b128 v[198:201], v1 offset:33024
    v_cvt_pk_bf16_f32 v176, v126, v127
    v_mfma_f32_16x16x32_bf16 v[122:125], v[218:221], a[200:203], v[122:125]
    s_waitcnt lgkmcnt(3)
    v_cvt_pk_bf16_f32 v177, v128, v129
    v_mul_f32 v133, v155, v133
    v_mfma_f32_16x16x32_bf16 v[122:125], v[222:225], a[204:207], v[122:125]
    s_waitcnt vmcnt(2)
    ds_write_b16 v8, v45 offset:512
    v_mfma_f32_16x16x32_bf16 v[122:125], v[186:189], a[208:211], v[122:125]
    s_waitcnt lgkmcnt(3)
    v_cvt_pk_f16_f32 v139, v132, v133
    v_mfma_f32_16x16x32_bf16 v[122:125], v[226:229], a[212:215], v[122:125]
    v_mul_f32 v158, v155, v158
    v_mul_f32 v159, v155, v159
    v_mfma_f32_16x16x32_bf16 v[130:133], a[72:75], v[206:209], 0
    v_cvt_pk_f16_f32 v140, v158, v159
    v_mul_f32 v160, v155, v160
    v_mfma_f32_16x16x32_bf16 v[130:133], a[76:79], v[210:213], v[130:133]
    v_mul_f32 v161, v155, v161
    v_cvt_pk_f16_f32 v141, v160, v161
    v_mfma_f32_16x16x32_bf16 v[130:133], a[80:83], v[238:241], v[130:133]
    s_waitcnt lgkmcnt(2)
    v_cvt_pk_bf16_f32 v136, v122, v123
    v_cvt_pk_bf16_f32 v137, v124, v125
    v_mfma_f32_16x16x32_bf16 v[130:133], a[84:87], v[242:245], v[130:133]
    s_waitcnt lgkmcnt(1)
    v_mul_f32 v142, v155, v142
    v_mul_f32 v143, v155, v143
    v_mfma_f32_16x16x32_bf16 v[130:133], a[88:91], v[214:217], v[130:133]
    v_cvt_pk_f16_f32 v128, v142, v143
    v_mul_f32 v144, v155, v144
    v_mfma_f32_16x16x32_bf16 v[130:133], a[92:95], v[198:201], v[130:133]
    s_waitcnt lgkmcnt(0)
    v_mul_f32 v145, v155, v145
    v_cvt_pk_f16_f32 v129, v144, v145
    v_mfma_f32_16x16x32_bf16 v[218:221], a[96:99], v[206:209], 0
    v_mul_f32 v170, v154, v170
    v_mul_f32 v171, v154, v171
    v_mfma_f32_16x16x32_bf16 v[218:221], a[100:103], v[210:213], v[218:221]
    v_cvt_pk_f16_f32 v150, v170, v171
    v_mul_f32 v172, v154, v172
    v_mfma_f32_16x16x32_bf16 v[218:221], a[104:107], v[238:241], v[218:221]
    s_barrier
    v_mul_f32 v173, v154, v173
    v_cvt_pk_f16_f32 v151, v172, v173
    v_mfma_f32_16x16x32_bf16 v[218:221], a[108:111], v[242:245], v[218:221]
    buffer_load_dwordx4 v10, s[8:11], 0 offen nt lds
    ds_read_u16 v202, v9 offset:256
    v_mfma_f32_16x16x32_bf16 v[218:221], a[112:115], v[214:217], v[218:221]
    s_add_u32 m0, s28, 4096
    v_mul_f32 v182, v154, v182
    v_mul_f32 v183, v154, v183
    v_mfma_f32_16x16x32_bf16 v[218:221], a[116:119], v[198:201], v[218:221]
    v_cvt_pk_f16_f32 v152, v182, v183
    v_mul_f32 v184, v154, v184
    v_mfma_f32_16x16x32_bf16 v[226:229], a[120:123], v[206:209], 0
    v_mul_f32 v185, v154, v185
    v_cvt_pk_f16_f32 v153, v184, v185
    v_mfma_f32_16x16x32_bf16 v[226:229], a[124:127], v[210:213], v[226:229]
    v_mul_f32 v162, v154, v162
    v_mul_f32 v163, v154, v163
    v_mfma_f32_16x16x32_bf16 v[226:229], a[128:131], v[238:241], v[226:229]
    buffer_load_dwordx4 v11, s[8:11], 0 offen nt lds
    v_cvt_pk_f16_f32 v126, v162, v163
    v_mfma_f32_16x16x32_bf16 v[226:229], a[132:135], v[242:245], v[226:229]
    s_add_u32 m0, s28, 8192
    v_mul_f32 v164, v154, v164
    v_mul_f32 v165, v154, v165
    v_mfma_f32_16x16x32_bf16 v[226:229], a[136:139], v[214:217], v[226:229]
    v_cvt_pk_f16_f32 v127, v164, v165
    v_mul_f32 v204, v254, v204
    v_mfma_f32_16x16x32_bf16 v[226:229], a[140:143], v[198:201], v[226:229]
    s_waitcnt lgkmcnt(0)
    v_readfirstlane_b32 s77, v202
    v_mul_f32 v205, v254, v205
    v_mfma_f32_16x16x32_bf16 v[162:165], a[0:3], v[206:209], 0
    v_cvt_pk_bf16_f32 v235, v204, v205
    v_fma_f32 v236, v130, v130, s32
    v_mfma_f32_16x16x32_bf16 v[162:165], a[4:7], v[210:213], v[162:165]
    buffer_load_dwordx4 v12, s[8:11], 0 offen nt lds
    v_fmac_f32 v236, v131, v131
    v_mfma_f32_16x16x32_bf16 v[162:165], a[8:11], v[238:241], v[162:165]
    s_add_u32 m0, s28, 12288
    v_fmac_f32 v236, v132, v132
    v_fmac_f32 v236, v133, v133
    v_mfma_f32_16x16x32_bf16 v[162:165], a[12:15], v[242:245], v[162:165]
    s_xor_b32 s28, s28, 65536
    v_fmac_f32 v236, v218, v218
    v_fmac_f32 v236, v219, v219
    v_mfma_f32_16x16x32_bf16 v[162:165], a[16:19], v[214:217], v[162:165]
    v_fmac_f32 v236, v220, v220
    v_fmac_f32 v236, v221, v221
    v_mfma_f32_16x16x32_bf16 v[162:165], a[20:23], v[198:201], v[162:165]
    v_fmac_f32 v236, v226, v226
    v_fmac_f32 v236, v227, v227
    v_mfma_f32_16x16x32_bf16 v[246:249], a[24:27], v[206:209], 0
    buffer_load_dwordx4 v13, s[8:11], 0 offen nt lds
    v_fmac_f32 v236, v228, v228
    v_mfma_f32_16x16x32_bf16 v[246:249], a[28:31], v[210:213], v[246:249]
    s_mov_b32 m0, s29
    v_fmac_f32 v236, v229, v229
    v_fma_f32 v237, v162, v162, s32
    v_mfma_f32_16x16x32_bf16 v[246:249], a[32:35], v[238:241], v[246:249]
    s_xor_b32 s29, s29, s30
    v_fmac_f32 v237, v163, v163
    v_fmac_f32 v237, v164, v164
    v_mfma_f32_16x16x32_bf16 v[246:249], a[36:39], v[242:245], v[246:249]
    s_add_u32 s19, s19, s20
    v_fmac_f32 v237, v165, v165
    v_mul_f32 v114, v255, v114
    v_mfma_f32_16x16x32_bf16 v[246:249], a[40:43], v[214:217], v[246:249]
    s_add_u32 s23, s23, s21
    v_mul_f32 v115, v255, v115
    v_cvt_pk_bf16_f32 v114, v114, v115
    v_mfma_f32_16x16x32_bf16 v[246:249], a[44:47], v[198:201], v[246:249]
    v_mul_f32 v116, v255, v116
    v_mfma_f32_16x16x32_bf16 v[122:125], a[48:51], v[206:209], 0
    s_cmp_ge_u32 s19, 72
    v_mul_f32 v117, v255, v117
    v_cvt_pk_bf16_f32 v115, v116, v117
    v_mfma_f32_16x16x32_bf16 v[122:125], a[52:55], v[210:213], v[122:125]
    s_cselect_b32 s34, 72, 0
    s_nop 0
    v_fmac_f32 v237, v246, v246
    v_fmac_f32 v237, v247, v247
    v_mfma_f32_16x16x32_bf16 v[122:125], a[56:59], v[238:241], v[122:125]
    s_cselect_b32 s35, s22, 0
    v_fmac_f32 v237, v248, v248
    v_fmac_f32 v237, v249, v249
    v_mfma_f32_16x16x32_bf16 v[122:125], a[60:63], v[242:245], v[122:125]
    s_sub_u32 s19, s19, s34
    v_mul_f32 v166, v255, v166
    v_mul_f32 v167, v255, v167
    v_mfma_f32_16x16x32_bf16 v[122:125], a[64:67], v[214:217], v[122:125]
    buffer_store_dwordx4 v[190:193], v15, s[12:15], 0 offen nt
    v_cvt_pk_bf16_f32 v116, v166, v167
    v_mul_f32 v168, v255, v168
    v_mul_f32 v169, v255, v169
    v_cvt_pk_bf16_f32 v117, v168, v169
    v_mfma_f32_16x16x32_bf16 v[122:125], a[68:71], v[198:201], v[122:125]
    s_add_u32 s23, s23, s35
    v_mul_f32 v230, v255, v230
    v_mul_f32 v231, v255, v231
    v_mfma_f32_16x16x32_bf16 v[154:157], v[206:209], a[144:147], 0
    s_cmp_lg_u32 s83, 0
    v_cvt_pk_bf16_f32 v254, v230, v231
    v_mul_f32 v232, v255, v232
    v_mfma_f32_16x16x32_bf16 v[154:157], v[210:213], a[148:151], v[154:157]
    s_cselect_b32 s77, s80, s77
    v_fmac_f32 v237, v122, v122
    v_fmac_f32 v237, v123, v123
    v_mfma_f32_16x16x32_bf16 v[154:157], v[238:241], a[152:155], v[154:157]
    s_mul_i32 s78, s77, 2688
    v_fmac_f32 v237, v124, v124
    v_fmac_f32 v237, v125, v125
    v_mfma_f32_16x16x32_bf16 v[154:157], v[242:245], a[156:159], v[154:157]
    s_add_u32 s78, s78, s69
    ds_read2_b32 v[144:145], v6 offset0:0 offset1:0
    ds_read2_b32 v[172:173], v6 offset0:16 offset1:16
    v_mfma_f32_16x16x32_bf16 v[154:157], v[214:217], a[160:163], v[154:157]
    s_add_u32 s80, s77, s68
    ds_read2_b32 v[192:193], v6 offset0:32 offset1:32
    v_cvt_pk_bf16_f32 v36, v237, v236
    v_mfma_f32_16x16x32_bf16 v[154:157], v[198:201], a[164:167], v[154:157]
    s_cmp_ge_u32 s80, 72
    v_mul_f32 v233, v255, v233
    v_cvt_pk_bf16_f32 v255, v232, v233
    v_mfma_f32_16x16x32_bf16 v[230:233], v[32:35], v[36:39], 0
    s_cselect_b32 s80, s22, 0
    v_xor_b32 v0, 65536, v0
    v_xor_b32 v1, 65536, v1
    v_mfma_f32_16x16x32_bf16 v[166:169], v[206:209], a[168:171], 0
    s_add_u32 s78, s78, s80
    v_cvt_pk_bf16_f32 v142, v154, v155
    v_cvt_pk_bf16_f32 v143, v156, v157
    v_mfma_f32_16x16x32_bf16 v[166:169], v[210:213], a[172:175], v[166:169]
    s_add_u32 s80, s77, 20
    v_rsq_f32 v231, v231
    v_mfma_f32_16x16x32_bf16 v[166:169], v[238:241], a[176:179], v[166:169]
    s_add_u32 s34, s18, 3
    v_rsq_f32 v230, v230
    v_mfma_f32_16x16x32_bf16 v[166:169], v[242:245], a[180:183], v[166:169]
    s_cmp_lt_u32 s77, s62
    v_mul_f32 v230, s31, v230
    v_mul_f32 v130, v231, v130
    v_mfma_f32_16x16x32_bf16 v[166:169], v[214:217], a[184:187], v[166:169]
    s_cselect_b32 s79, 1, 0
    v_mul_f32 v131, v231, v131
    v_cvt_pk_f16_f32 v158, v130, v131
    v_mfma_f32_16x16x32_bf16 v[166:169], v[198:201], a[188:191], v[166:169]
    s_cselect_b32 s78, s78, 0
    v_mul_f32 v132, v231, v132
    v_mul_f32 v133, v231, v133
    v_mfma_f32_16x16x32_bf16 v[250:253], v[206:209], a[192:195], 0
    s_cmp_lt_u32 s34, s17
    v_cvt_pk_f16_f32 v159, v132, v133
    v_mul_f32 v218, v231, v218
    v_mfma_f32_16x16x32_bf16 v[250:253], v[210:213], a[196:199], v[250:253]
    s_cselect_b32 s23, s23, s78
    v_cvt_pk_bf16_f32 v170, v166, v167
    v_cvt_pk_bf16_f32 v171, v168, v169
    v_mfma_f32_16x16x32_bf16 v[250:253], v[238:241], a[200:203], v[250:253]
    s_cselect_b32 s73, s34, s80
    ds_read_b128 v[222:225], v5 offset:0
    ds_read_b128 v[202:205], v5 offset:16
    v_mfma_f32_16x16x32_bf16 v[250:253], v[242:245], a[204:207], v[250:253]
    s_cselect_b32 s79, 0, s79
    ds_read_b128 v[154:157], v5 offset:48
    ds_read_b32 v232, v6 offset:192
    v_mfma_f32_16x16x32_bf16 v[250:253], v[214:217], a[208:211], v[250:253]
    s_waitcnt lgkmcnt(4)
    buffer_store_dwordx2 v[234:235], v18, s[12:15], 0 offen nt
    v_mul_f32 v219, v231, v219
    v_cvt_pk_f16_f32 v160, v218, v219
    v_mfma_f32_16x16x32_f16 v[186:189], v[178:181], v[194:197], v[46:49]
    s_cselect_b32 s81, 0, 1
    v_mul_f32 v220, v231, v220
    v_mul_f32 v221, v231, v221
    v_mfma_f32_16x16x32_f16 v[182:185], v[138:141], v[194:197], v[50:53]
    s_add_u32 s80, s77, 1
    v_cvt_pk_f16_f32 v161, v220, v221
    v_mul_f32 v226, v231, v226
    v_mul_f32 v227, v231, v227
    v_mfma_f32_16x16x32_f16 v[166:169], v[158:161], v[194:197], v[54:57]
    s_mul_i32 s80, s80, s81
    v_cvt_pk_f16_f32 v132, v226, v227
    v_mul_f32 v228, v231, v228
    v_mul_f32 v229, v231, v229
    v_mfma_f32_16x16x16_f16 v[186:189], v[120:121], v[118:119], v[186:189]
    v_cvt_pk_f16_f32 v133, v228, v229
    v_mul_f32 v162, v230, v162
    v_mul_f32 v163, v230, v163
    v_mfma_f32_16x16x16_f16 v[182:185], v[128:129], v[118:119], v[182:185]
    v_cvt_pk_f16_f32 v162, v162, v163
    v_mul_f32 v164, v230, v164
    v_mul_f32 v165, v230, v165
    v_mfma_f32_16x16x16_f16 v[166:169], v[132:133], v[118:119], v[166:169]
    v_cvt_pk_f16_f32 v163, v164, v165
    v_mul_f32 v246, v230, v246
    v_mul_f32 v247, v230, v247
    v_cvt_pk_f16_f32 v164, v246, v247
    v_mfma_f32_16x16x32_bf16 v[250:253], v[198:201], a[212:215], v[250:253]
    s_waitcnt lgkmcnt(0)
    ds_read_b128 v[214:217], v2 offset:0
    ds_read_b128 v[206:209], v2 offset:1024
    v_mfma_f32_16x16x32_f16 v[226:229], v[222:225], v[194:197], v[22:25]
    s_cmp_lt_u32 s80, s62
    ds_read_b128 v[210:213], v2 offset:2048
    ds_read_b128 v[194:197], v2 offset:3072
    v_mfma_f32_16x16x32_f16 v[226:229], v[202:205], v[178:181], v[226:229]
    s_cselect_b32 s70, s70, 0
    v_cvt_pk_bf16_f32 v190, v250, v251
    v_cvt_pk_bf16_f32 v191, v252, v253
    v_mfma_f32_16x16x32_f16 v[226:229], v[154:157], v[118:121], v[226:229]
    s_cselect_b32 s62, s62, 0
    ds_read_b128 v[198:201], v2 offset:4096
    v_mul_f32 v248, v230, v248
    v_mul_f32 v249, v230, v249
    v_cvt_pk_f16_f32 v165, v248, v249
    v_mfma_f32_16x16x32_f16 v[218:221], v[222:225], v[150:153], v[24:27]
    s_add_u32 s80, s18, 4
    v_mul_f32 v122, v230, v122
    v_mul_f32 v123, v230, v123
    v_mfma_f32_16x16x32_f16 v[218:221], v[202:205], v[138:141], v[218:221]
    s_cmp_ge_u32 s80, s17
    v_cvt_pk_f16_f32 v130, v122, v123
    v_mul_f32 v124, v230, v124
    v_mfma_f32_16x16x32_f16 v[218:221], v[154:157], v[126:129], v[218:221]
    s_cselect_b32 s66, s70, 0
    v_mul_f32 v125, v230, v125
    v_cvt_pk_f16_f32 v131, v124, v125
    v_mfma_f32_16x16x32_f16 v[238:241], v[222:225], v[162:165], v[26:29]
    s_waitcnt lgkmcnt(3)
    ds_read_b128 v[222:225], v2 offset:5120
    v_mov_b32_dpp v232, v227 quad_perm:[0,1,2,3] row_mask:0x1 bank_mask:0xf
    v_mfma_f32_16x16x32_f16 v[238:241], v[202:205], v[158:161], v[238:241]
    s_lshl_b32 s80, s79, s73
    v_mov_b32_dpp v232, v219 quad_perm:[0,1,2,3] row_mask:0x2 bank_mask:0xf
    v_max3_f32 v118, v226, v186, v187
    v_mfma_f32_16x16x32_f16 v[238:241], v[154:157], v[130:133], v[238:241]
    s_waitcnt lgkmcnt(2)
    buffer_store_dwordx4 v[114:117], v16, s[12:15], 0 offen nt
    v_max3_f32 v118, v118, v188, v189
    v_max3_f32 v118, v118, v182, v183
    v_max3_f32 v118, v118, v184, v185
    v_max3_f32 v118, v118, v166, v167
    v_mfma_f32_16x16x32_bf16 v[122:125], a[216:219], v[214:217], 0
    s_or_b32 s63, s63, s80
    v_max3_f32 v118, v118, v168, v169
    v_mov_b32 v119, v118
    v_mfma_f32_16x16x32_bf16 v[122:125], a[220:223], v[206:209], v[122:125]
    s_sub_u32 s80, s100, s81
    v_permlane32_swap_b32 v118, v119
    v_mfma_f32_16x16x32_bf16 v[122:125], a[224:227], v[210:213], v[122:125]
    s_and_b32 s100, s100, s80
    v_max_f32 v118, v118, v119
    v_mov_b32 v119, v118
    v_mfma_f32_16x16x32_bf16 v[122:125], a[228:231], v[194:197], v[122:125]
    s_waitcnt lgkmcnt(1)
    v_permlane16_swap_b32 v118, v119
    v_mfma_f32_16x16x32_bf16 v[122:125], a[232:235], v[198:201], v[122:125]
    s_waitcnt lgkmcnt(0)
    v_max_f32 v118, v118, v119
    v_sub_f32 v186, v186, v118
    v_mfma_f32_16x16x32_bf16 v[122:125], a[236:239], v[222:225], v[122:125]
    s_add_u32 s45, s45, s79
    v_exp_f32 v186, v186
    v_mfma_f32_16x16x32_bf16 v[154:157], a[240:243], v[214:217], 0
    s_add_u32 s18, s18, 1
    v_sub_f32 v187, v187, v118
    v_sub_f32 v188, v188, v118
    v_mfma_f32_16x16x32_bf16 v[154:157], a[244:247], v[206:209], v[154:157]
    s_cmp_lt_u32 s18, s45
    v_exp_f32 v187, v187
    v_mfma_f32_16x16x32_bf16 v[154:157], a[248:251], v[210:213], v[154:157]
    v_cvt_pk_bf16_f32 v186, v186, v187
    v_sub_f32 v189, v189, v118
    v_mfma_f32_16x16x32_bf16 v[154:157], a[252:255], v[194:197], v[154:157]
    v_exp_f32 v188, v188
    v_mfma_f32_16x16x32_bf16 v[154:157], v[82:85], v[198:201], v[154:157]
    v_exp_f32 v189, v189
    v_mfma_f32_16x16x32_bf16 v[154:157], v[86:89], v[222:225], v[154:157]
    v_cvt_pk_bf16_f32 v187, v188, v189
    v_sub_f32 v182, v182, v118
    v_mfma_f32_16x16x32_bf16 v[202:205], v[90:93], v[214:217], 0
    ds_read_b128 v[214:217], v2 offset:6144
    v_sub_f32 v183, v183, v118
    v_mfma_f32_16x16x32_bf16 v[202:205], v[94:97], v[206:209], v[202:205]
    ds_read_b128 v[206:209], v2 offset:7168
    v_sub_f32 v184, v184, v118
    v_mfma_f32_16x16x32_bf16 v[202:205], v[98:101], v[210:213], v[202:205]
    ds_read_b128 v[210:213], v2 offset:8192
    v_sub_f32 v185, v185, v118
    v_mfma_f32_16x16x32_bf16 v[202:205], v[102:105], v[194:197], v[202:205]
    ds_read_b128 v[194:197], v2 offset:9216
    buffer_store_dwordx2 v[254:255], v19, s[12:15], 0 offen nt
    v_exp_f32 v182, v182
    v_mfma_f32_16x16x32_f16 v[234:237], v[178:181], v[150:153], v[58:61]
    v_exp_f32 v183, v183
    v_mfma_f32_16x16x32_bf16 v[202:205], v[106:109], v[198:201], v[202:205]
    ds_read_b128 v[198:201], v2 offset:10240
    v_cvt_pk_bf16_f32 v188, v182, v183
    v_mfma_f32_16x16x32_bf16 v[202:205], v[110:113], v[222:225], v[202:205]
    ds_read_b128 v[222:225], v2 offset:11264
    v_exp_f32 v184, v184
    v_mfma_f32_16x16x16_f16 v[234:237], v[120:121], v[126:127], v[234:237]
    v_exp_f32 v185, v185
    v_sub_f32 v166, v166, v118
    v_cvt_pk_bf16_f32 v189, v184, v185
    v_mfma_f32_16x16x32_f16 v[182:185], v[138:141], v[150:153], v[62:65]
    s_waitcnt lgkmcnt(4)
    v_exp_f32 v166, v166
    v_sub_f32 v167, v167, v118
    v_exp_f32 v167, v167
    v_sub_f32 v168, v168, v118
    v_cvt_pk_bf16_f32 v36, v166, v167
    v_mfma_f32_16x16x16_f16 v[182:185], v[128:129], v[126:127], v[182:185]
    v_exp_f32 v168, v168
    v_sub_f32 v169, v169, v118
    v_sub_f32 v226, v226, v118
    v_mfma_f32_16x16x32_f16 v[242:245], v[158:161], v[150:153], v[66:69]
    s_waitcnt lgkmcnt(2)
    v_exp_f32 v169, v169
    v_mfma_f32_16x16x32_bf16 v[114:117], a[216:219], v[214:217], 0
    s_waitcnt lgkmcnt(1)
    v_cvt_pk_bf16_f32 v37, v168, v169
    v_mov_b32_dpp v232, v239 quad_perm:[0,1,2,3] row_mask:0x4 bank_mask:0xf
    v_mov_b32 v118, v232
    v_mfma_f32_16x16x16_f16 v[242:245], v[132:133], v[126:127], v[242:245]
    v_exp_f32 v226, v226
    v_max_f32_dpp v118, v118, v118 quad_perm:[1,0,3,2] row_mask:0xf bank_mask:0xf
    v_cvt_pk_bf16_f32 v39, v226, 0
    v_mfma_f32_16x16x32_bf16 v[114:117], a[220:223], v[206:209], v[114:117]
    s_waitcnt lgkmcnt(0)
    v_max_f32_dpp v118, v118, v118 quad_perm:[2,3,0,1] row_mask:0xf bank_mask:0xf
    v_max3_f32 v126, v218, v234, v235
    v_mfma_f32_16x16x32_bf16 v[150:153], v[28:31], v[36:39], 0
    v_max_f32_dpp v118, v118, v118 row_half_mirror row_mask:0xf bank_mask:0xf
    v_max3_f32 v126, v126, v236, v237
    v_mfma_f32_16x16x32_bf16 v[150:153], v[28:31], v[186:189], v[150:153]
    v_max_f32_dpp v118, v118, v118 row_mirror row_mask:0xf bank_mask:0xf
    v_mov_b32 v119, v118
    v_mfma_f32_16x16x32_bf16 v[114:117], a[224:227], v[210:213], v[114:117]
    v_max3_f32 v126, v126, v182, v183
    v_max3_f32 v126, v126, v184, v185
    v_mfma_f32_16x16x32_bf16 v[114:117], a[228:231], v[194:197], v[114:117]
    v_permlane32_swap_b32 v118, v119
    v_mfma_f32_16x16x32_bf16 v[114:117], a[232:235], v[198:201], v[114:117]
    v_rcp_f32 v150, v150
    v_mfma_f32_16x16x32_bf16 v[114:117], a[236:239], v[222:225], v[114:117]
    v_max_f32 v118, v118, v119
    v_mov_b32 v119, v118
    v_max3_f32 v126, v126, v242, v243
    v_max3_f32 v126, v126, v244, v245
    v_permlane16_swap_b32 v118, v119
    v_max_f32 v118, v118, v119
    v_mfma_f32_16x16x32_bf16 v[166:169], v[142:145], v[36:39], 0
    v_sub_f32 v232, v232, v118
    v_mov_b32 v127, v126
    v_mfma_f32_16x16x32_bf16 v[166:169], v[146:149], v[186:189], v[166:169]
    v_exp_f32 v232, v232
    v_permlane32_swap_b32 v126, v127
    v_cvt_pk_bf16_f32 v232, v232, v232
    v_max_f32 v126, v126, v127
    v_mov_b32 v127, v126
    v_fma_f32 v254, v122, v122, s33
    v_fmac_f32 v254, v123, v123
    v_permlane16_swap_b32 v126, v127
    v_mul_f32 v166, v150, v166
    v_mul_f32 v167, v150, v167
    v_cvt_pk_bf16_f32 v166, v166, v167
    v_mul_f32 v168, v150, v168
    v_mul_f32 v169, v150, v169
    v_cvt_pk_bf16_f32 v167, v168, v169
    v_max_f32 v126, v126, v127
    v_sub_f32 v234, v234, v126
    v_exp_f32 v234, v234
    v_sub_f32 v235, v235, v126
    v_exp_f32 v235, v235
    v_sub_f32 v236, v236, v126
    v_cvt_pk_bf16_f32 v226, v234, v235
    v_exp_f32 v236, v236
    v_sub_f32 v237, v237, v126
    v_exp_f32 v237, v237
    v_sub_f32 v182, v182, v126
    v_cvt_pk_bf16_f32 v227, v236, v237
    v_mfma_f32_16x16x32_bf16 v[234:237], v[170:173], v[36:39], 0
    ds_write_b16 v8, v232
    v_mfma_f32_16x16x32_bf16 v[234:237], v[174:177], v[186:189], v[234:237]
    v_exp_f32 v182, v182
    v_sub_f32 v183, v183, v126
    v_exp_f32 v183, v183
    v_sub_f32 v184, v184, v126
    v_cvt_pk_bf16_f32 v228, v182, v183
    v_exp_f32 v184, v184
    v_sub_f32 v185, v185, v126
    v_exp_f32 v185, v185
    v_mul_f32 v234, v150, v234
    v_mul_f32 v235, v150, v235
    v_cvt_pk_bf16_f32 v168, v234, v235
    v_mul_f32 v236, v150, v236
    v_mul_f32 v237, v150, v237
    v_cvt_pk_bf16_f32 v169, v236, v237
    v_mfma_f32_16x16x32_bf16 v[230:233], v[190:193], v[36:39], 0
    ds_write_b128 v3, v[166:169] offset:0
    v_mfma_f32_16x16x32_bf16 v[230:233], v[134:137], v[186:189], v[230:233]
    v_cvt_pk_bf16_f32 v229, v184, v185
    v_sub_f32 v242, v242, v126
    v_mfma_f32_16x16x32_f16 v[182:185], v[178:181], v[162:165], v[70:73]
    v_exp_f32 v242, v242
    v_mfma_f32_16x16x32_bf16 v[166:169], a[240:243], v[214:217], 0
    ds_read_b128 v[178:181], v9
    v_sub_f32 v243, v243, v126
    v_mfma_f32_16x16x32_bf16 v[166:169], a[244:247], v[206:209], v[166:169]
    v_mul_f32 v230, v150, v230
    v_mul_f32 v231, v150, v231
    v_cvt_pk_bf16_f32 v220, v230, v231
    v_mfma_f32_16x16x16_f16 v[182:185], v[120:121], v[130:131], v[182:185]
    v_mul_f32 v232, v150, v232
    v_mul_f32 v233, v150, v233
    v_cvt_pk_bf16_f32 v221, v232, v233
    v_sub_f32 v244, v244, v126
    v_mfma_f32_16x16x32_bf16 v[166:169], a[248:251], v[210:213], v[166:169]
    ds_read_b128 v[118:121], v9 offset:64
    v_sub_f32 v245, v245, v126
    v_mfma_f32_16x16x32_bf16 v[166:169], a[252:255], v[194:197], v[166:169]
    ds_write_b64 v4, v[220:221] offset:4096
    v_mfma_f32_16x16x32_bf16 v[166:169], v[82:85], v[198:201], v[166:169]
    v_max3_f32 v255, v238, v182, v183
    v_max3_f32 v255, v255, v184, v185
    v_mfma_f32_16x16x32_bf16 v[166:169], v[86:89], v[222:225], v[166:169]
    v_exp_f32 v243, v243
    v_exp_f32 v244, v244
    v_cvt_pk_bf16_f32 v36, v242, v243
    v_mfma_f32_16x16x32_f16 v[186:189], v[138:141], v[162:165], v[74:77]
    s_waitcnt lgkmcnt(2)
    v_exp_f32 v245, v245
    v_mfma_f32_16x16x32_f16 v[246:249], v[158:161], v[162:165], v[78:81]
    v_cvt_pk_bf16_f32 v37, v244, v245
    v_sub_f32 v218, v218, v126
    v_mfma_f32_16x16x32_bf16 v[242:245], v[178:181], v[28:31], 0
    v_exp_f32 v218, v218
    v_fmac_f32 v254, v124, v124
    v_mfma_f32_16x16x16_f16 v[186:189], v[128:129], v[130:131], v[186:189]
    v_cvt_pk_bf16_f32 v39, v218, 0
    v_fmac_f32 v254, v125, v125
    v_fmac_f32 v254, v154, v154
    v_mfma_f32_16x16x16_f16 v[246:249], v[132:133], v[130:131], v[246:249]
    v_fmac_f32 v254, v155, v155
    v_fmac_f32 v254, v156, v156
    v_fmac_f32 v254, v157, v157
    v_fmac_f32 v254, v202, v202
    v_mfma_f32_16x16x32_bf16 v[126:129], v[28:31], v[36:39], 0
    s_waitcnt lgkmcnt(0)
    v_max3_f32 v255, v255, v186, v187
    v_max3_f32 v255, v255, v188, v189
    v_mfma_f32_16x16x32_bf16 v[126:129], v[28:31], v[226:229], v[126:129]
    v_max3_f32 v255, v255, v246, v247
    v_max3_f32 v255, v255, v248, v249
    v_mfma_f32_16x16x32_bf16 v[130:133], v[142:145], v[36:39], 0
    v_mov_b32 v239, v255
    v_fmac_f32 v254, v203, v203
    v_mfma_f32_16x16x32_bf16 v[130:133], v[146:149], v[226:229], v[130:133]
    v_permlane32_swap_b32 v255, v239
    v_mfma_f32_16x16x32_bf16 v[138:141], v[170:173], v[36:39], 0
    v_rcp_f32 v126, v126
    v_mfma_f32_16x16x32_bf16 v[138:141], v[174:177], v[226:229], v[138:141]
    v_max_f32 v255, v255, v239
    v_mov_b32 v239, v255
    v_mfma_f32_16x16x32_bf16 v[150:153], v[190:193], v[36:39], 0
    v_fmac_f32 v254, v204, v204
    v_mul_f32 v130, v126, v130
    v_mfma_f32_16x16x32_bf16 v[150:153], v[134:137], v[226:229], v[150:153]
    v_mul_f32 v131, v126, v131
    v_cvt_pk_bf16_f32 v130, v130, v131
    v_mfma_f32_16x16x32_bf16 v[242:245], v[118:121], v[28:31], v[242:245]
    v_mul_f32 v132, v126, v132
    v_mul_f32 v133, v126, v133
    v_mfma_f32_16x16x32_bf16 v[218:221], v[178:181], v[146:149], 0
    v_cvt_pk_bf16_f32 v131, v132, v133
    v_mul_f32 v138, v126, v138
    v_mfma_f32_16x16x32_bf16 v[218:221], v[118:121], v[142:145], v[218:221]
    v_mul_f32 v139, v126, v139
    v_cvt_pk_bf16_f32 v132, v138, v139
    v_mfma_f32_16x16x32_bf16 v[226:229], v[178:181], v[174:177], 0
    v_mul_f32 v140, v126, v140
    v_mul_f32 v141, v126, v141
    v_mfma_f32_16x16x32_bf16 v[226:229], v[118:121], v[170:173], v[226:229]
    v_cvt_pk_bf16_f32 v133, v140, v141
    v_mul_f32 v150, v126, v150
    v_mfma_f32_16x16x32_bf16 v[250:253], v[178:181], v[134:137], 0
    ds_write_b128 v3, v[130:133] offset:6144
    v_mfma_f32_16x16x32_bf16 v[250:253], v[118:121], v[190:193], v[250:253]
    v_mul_f32 v151, v126, v151
    v_cvt_pk_bf16_f32 v240, v150, v151
    v_mfma_f32_16x16x32_bf16 v[230:233], v[90:93], v[214:217], 0
    v_mul_f32 v152, v126, v152
    v_mul_f32 v153, v126, v153
    v_mfma_f32_16x16x32_bf16 v[230:233], v[94:97], v[206:209], v[230:233]
    ds_read_b128 v[118:121], v2 offset:12288
    ds_read_b128 v[126:129], v2 offset:13312
    v_mfma_f32_16x16x32_bf16 v[230:233], v[98:101], v[210:213], v[230:233]
    ds_read_b128 v[130:133], v2 offset:14336
    v_cvt_pk_bf16_f32 v241, v152, v153
    v_mfma_f32_16x16x32_bf16 v[230:233], v[102:105], v[194:197], v[230:233]
    ds_read_b128 v[158:161], v2 offset:15360
    v_fmac_f32 v254, v205, v205
    v_mfma_f32_16x16x32_bf16 v[230:233], v[106:109], v[198:201], v[230:233]
    ds_read_b128 v[178:181], v2 offset:16384
    v_fma_f32 v219, v114, v114, s33
    v_mfma_f32_16x16x32_bf16 v[230:233], v[110:113], v[222:225], v[230:233]
    ds_read_b128 v[194:197], v2 offset:17408
    ds_write_b64 v4, v[240:241] offset:10240
    v_permlane16_swap_b32 v255, v239
    v_max_f32 v255, v255, v239
    v_sub_f32 v182, v182, v255
    v_exp_f32 v182, v182
    v_sub_f32 v183, v183, v255
    v_exp_f32 v183, v183
    s_waitcnt lgkmcnt(5)
    v_mfma_f32_16x16x32_bf16 v[150:153], a[216:219], v[118:121], 0
    v_cvt_pk_bf16_f32 v198, v182, v183
    v_sub_f32 v184, v184, v255
    v_mfma_f32_16x16x32_bf16 v[150:153], a[220:223], v[126:129], v[150:153]
    s_waitcnt lgkmcnt(4)
    v_exp_f32 v184, v184
    v_mfma_f32_16x16x32_bf16 v[150:153], a[224:227], v[130:133], v[150:153]
    s_waitcnt lgkmcnt(3)
    v_sub_f32 v185, v185, v255
    v_sub_f32 v186, v186, v255
    v_mfma_f32_16x16x32_bf16 v[150:153], a[228:231], v[158:161], v[150:153]
    s_waitcnt lgkmcnt(2)
    v_exp_f32 v185, v185
    v_mfma_f32_16x16x32_bf16 v[150:153], a[232:235], v[178:181], v[150:153]
    s_waitcnt lgkmcnt(0)
    v_cvt_pk_bf16_f32 v199, v184, v185
    v_sub_f32 v187, v187, v255
    v_mfma_f32_16x16x32_bf16 v[150:153], a[236:239], v[194:197], v[150:153]
    v_exp_f32 v186, v186
    v_mfma_f32_16x16x32_bf16 v[162:165], a[240:243], v[118:121], 0
    v_exp_f32 v187, v187
    v_mfma_f32_16x16x32_bf16 v[162:165], a[244:247], v[126:129], v[162:165]
    v_cvt_pk_bf16_f32 v200, v186, v187
    v_sub_f32 v188, v188, v255
    v_mfma_f32_16x16x32_bf16 v[162:165], a[248:251], v[130:133], v[162:165]
    v_exp_f32 v188, v188
    v_mfma_f32_16x16x32_bf16 v[162:165], a[252:255], v[158:161], v[162:165]
    v_sub_f32 v189, v189, v255
    v_sub_f32 v246, v246, v255
    v_mfma_f32_16x16x32_bf16 v[162:165], v[82:85], v[178:181], v[162:165]
    v_exp_f32 v189, v189
    v_mfma_f32_16x16x32_bf16 v[162:165], v[86:89], v[194:197], v[162:165]
    v_cvt_pk_bf16_f32 v201, v188, v189
    v_sub_f32 v247, v247, v255
    v_mfma_f32_16x16x32_bf16 v[138:141], v[90:93], v[118:121], 0
    v_exp_f32 v246, v246
    v_mfma_f32_16x16x32_bf16 v[138:141], v[94:97], v[126:129], v[138:141]
    v_exp_f32 v247, v247
    v_mfma_f32_16x16x32_bf16 v[138:141], v[98:101], v[130:133], v[138:141]
    v_cvt_pk_bf16_f32 v36, v246, v247
    v_sub_f32 v248, v248, v255
    v_mfma_f32_16x16x32_bf16 v[138:141], v[102:105], v[158:161], v[138:141]
    v_exp_f32 v248, v248
    v_mfma_f32_16x16x32_bf16 v[138:141], v[106:109], v[178:181], v[138:141]
    v_sub_f32 v249, v249, v255
    v_sub_f32 v238, v238, v255
    v_mfma_f32_16x16x32_bf16 v[138:141], v[110:113], v[194:197], v[138:141]
    ds_read_b128 v[186:189], v0 offset:20480
    ds_read_b128 v[118:121], v1 offset:20480
    ds_read_b128 v[234:237], v0 offset:20608
    v_exp_f32 v249, v249
    v_exp_f32 v238, v238
    v_cvt_pk_bf16_f32 v37, v248, v249
    v_cvt_pk_bf16_f32 v39, v238, 0
    v_fma_f32 v255, v150, v150, s33
    v_fmac_f32 v255, v151, v151
    v_mfma_f32_16x16x32_bf16 v[126:129], v[28:31], v[36:39], 0
    ds_read_b128 v[158:161], v1 offset:20608
    ds_read_b128 v[182:185], v0 offset:20736
    v_mfma_f32_16x16x32_bf16 v[126:129], v[28:31], v[198:201], v[126:129]
    ds_read_b128 v[206:209], v1 offset:20736
    v_fmac_f32 v255, v152, v152
    v_mfma_f32_16x16x32_bf16 v[178:181], v[142:145], v[36:39], 0
    v_fmac_f32 v255, v153, v153
    v_fmac_f32 v255, v162, v162
    v_mfma_f32_16x16x32_bf16 v[178:181], v[146:149], v[198:201], v[178:181]
    v_fmac_f32 v255, v163, v163
    v_fmac_f32 v255, v164, v164
    v_mfma_f32_16x16x32_bf16 v[142:145], v[170:173], v[36:39], 0
    s_waitcnt lgkmcnt(5)
    v_rcp_f32 v126, v126
    v_mfma_f32_16x16x32_bf16 v[142:145], v[174:177], v[198:201], v[142:145]
    s_waitcnt lgkmcnt(3)
    v_fmac_f32 v255, v165, v165
    v_mul_f32 v178, v126, v178
    v_mfma_f32_16x16x32_bf16 v[146:149], v[190:193], v[36:39], 0
    v_mul_f32 v179, v126, v179
    v_cvt_pk_bf16_f32 v170, v178, v179
    v_mfma_f32_16x16x32_bf16 v[146:149], v[134:137], v[198:201], v[146:149]
    v_mul_f32 v180, v126, v180
    v_mul_f32 v181, v126, v181
    v_mfma_f32_16x16x32_bf16 v[130:133], a[72:75], v[186:189], 0
    s_waitcnt lgkmcnt(1)
    v_cvt_pk_bf16_f32 v171, v180, v181
    v_mul_f32 v142, v126, v142
    v_mfma_f32_16x16x32_bf16 v[130:133], a[76:79], v[118:121], v[130:133]
    s_waitcnt lgkmcnt(0)
    v_mul_f32 v143, v126, v143
    v_cvt_pk_bf16_f32 v172, v142, v143
    v_mfma_f32_16x16x32_bf16 v[130:133], a[80:83], v[234:237], v[130:133]
    v_mul_f32 v144, v126, v144
    v_mul_f32 v145, v126, v145
    v_mfma_f32_16x16x32_bf16 v[130:133], a[84:87], v[158:161], v[130:133]
    v_cvt_pk_bf16_f32 v173, v144, v145
    v_mul_f32 v146, v126, v146
    v_mfma_f32_16x16x32_bf16 v[130:133], a[88:91], v[182:185], v[130:133]
    ds_write_b128 v3, v[170:173] offset:12288
    v_mfma_f32_16x16x32_bf16 v[130:133], a[92:95], v[206:209], v[130:133]
    v_mul_f32 v147, v126, v147
    v_cvt_pk_bf16_f32 v220, v146, v147
    v_mfma_f32_16x16x32_bf16 v[134:137], a[96:99], v[186:189], 0
    v_mul_f32 v148, v126, v148
    v_mul_f32 v149, v126, v149
    v_mfma_f32_16x16x32_bf16 v[134:137], a[100:103], v[118:121], v[134:137]
    v_cvt_pk_bf16_f32 v221, v148, v149
    v_fmac_f32 v255, v138, v138
    v_mfma_f32_16x16x32_bf16 v[134:137], a[104:107], v[234:237], v[134:137]
    ds_write_b64 v4, v[220:221] offset:16384
    v_mfma_f32_16x16x32_bf16 v[134:137], a[108:111], v[158:161], v[134:137]
    v_fmac_f32 v255, v139, v139
    v_fmac_f32 v255, v140, v140
    v_mfma_f32_16x16x32_bf16 v[134:137], a[112:115], v[182:185], v[134:137]
    v_fmac_f32 v255, v141, v141
    v_cvt_pk_bf16_f32 v255, v255, v255
    v_mfma_f32_16x16x32_bf16 v[134:137], a[116:119], v[206:209], v[134:137]
    v_rcp_f32 v242, v242
    v_mfma_f32_16x16x32_bf16 v[170:173], a[120:123], v[186:189], 0
    v_mul_f32 v218, v218, v242
    v_mul_f32_dpp v218, v226, v242 quad_perm:[0,1,2,3] row_mask:0x2 bank_mask:0xf
    v_mfma_f32_16x16x32_bf16 v[170:173], a[124:127], v[118:121], v[170:173]
    v_mul_f32_dpp v218, v250, v242 quad_perm:[0,1,2,3] row_mask:0x4 bank_mask:0xf
    v_cvt_pk_bf16_f32 v218, v218, v218
    v_mfma_f32_16x16x32_bf16 v[170:173], a[128:131], v[234:237], v[170:173]
    ds_write_b16 v7, v218
    v_mfma_f32_16x16x32_bf16 v[170:173], a[132:135], v[158:161], v[170:173]
    v_fmac_f32 v219, v115, v115
    v_fmac_f32 v219, v116, v116
    v_mfma_f32_16x16x32_bf16 v[170:173], a[136:139], v[182:185], v[170:173]
    v_fmac_f32 v219, v117, v117
    v_fmac_f32 v219, v166, v166
    v_mfma_f32_16x16x32_bf16 v[170:173], a[140:143], v[206:209], v[170:173]
    v_fmac_f32 v219, v167, v167
    v_fmac_f32 v219, v168, v168
    v_mfma_f32_16x16x32_bf16 v[142:145], a[0:3], v[186:189], 0
    v_fmac_f32 v219, v169, v169
    v_fmac_f32 v219, v230, v230
    v_mfma_f32_16x16x32_bf16 v[142:145], a[4:7], v[118:121], v[142:145]
    v_fmac_f32 v219, v231, v231
    v_fmac_f32 v219, v232, v232
    v_mfma_f32_16x16x32_bf16 v[142:145], a[8:11], v[234:237], v[142:145]
    v_fmac_f32 v219, v233, v233
    v_cvt_pk_bf16_f32 v254, v254, v219
    v_mfma_f32_16x16x32_bf16 v[142:145], a[12:15], v[158:161], v[142:145]
    ds_write_b64 v4, v[254:255] offset:18432
    v_mfma_f32_16x16x32_bf16 v[142:145], a[16:19], v[182:185], v[142:145]
    v_fma_f32 v174, v130, v130, s32
    v_fmac_f32 v174, v131, v131
    v_mfma_f32_16x16x32_bf16 v[142:145], a[20:23], v[206:209], v[142:145]
    v_fmac_f32 v174, v132, v132
    v_fmac_f32 v174, v133, v133
    v_mfma_f32_16x16x32_bf16 v[126:129], a[24:27], v[186:189], 0
    v_xor_b32 v2, 65536, v2
    v_xor_b32 v3, 65536, v3
    v_mfma_f32_16x16x32_bf16 v[126:129], a[28:31], v[118:121], v[126:129]
    v_xor_b32 v4, 65536, v4
    v_add_u32 v5, s74, v5
    v_mfma_f32_16x16x32_bf16 v[126:129], a[32:35], v[234:237], v[126:129]
    v_add_u32 v6, s75, v6
    v_add_u32 v7, s76, v7
    v_mfma_f32_16x16x32_bf16 v[126:129], a[36:39], v[158:161], v[126:129]
    v_mfma_f32_16x16x32_bf16 v[126:129], a[40:43], v[182:185], v[126:129]
    s_waitcnt lgkmcnt(0)
    s_nop 0
    s_nop 0
    s_barrier
    s_nop 0
    v_mfma_f32_16x16x32_bf16 v[126:129], a[44:47], v[206:209], v[126:129]
    s_cbranch_scc1 L_loop_safe2
    s_branch L_final_safe
.p2align 6
L_loop_safe3:
    v_mfma_f32_16x16x32_bf16 v[190:193], a[48:51], v[186:189], 0
    s_add_u32 s12, s40, s27
    ds_read_b128 v[146:149], v2 offset:18432
    ds_read_b128 v[178:181], v2 offset:19456
    v_mfma_f32_16x16x32_bf16 v[190:193], a[52:55], v[118:121], v[190:193]
    s_addc_u32 s13, s41, 0
    v_fmac_f32 v174, v134, v134
    v_fmac_f32 v174, v135, v135
    v_mfma_f32_16x16x32_bf16 v[190:193], a[56:59], v[234:237], v[190:193]
    s_sub_u32 s14, s36, s27
    v_fmac_f32 v174, v136, v136
    v_fmac_f32 v174, v137, v137
    v_mfma_f32_16x16x32_bf16 v[190:193], a[60:63], v[158:161], v[190:193]
    s_cmp_ge_u32 s18, 2
    v_fmac_f32 v174, v170, v170
    v_fmac_f32 v174, v171, v171
    v_mfma_f32_16x16x32_bf16 v[190:193], a[64:67], v[182:185], v[190:193]
    s_cselect_b32 s14, s14, 0
    v_fmac_f32 v174, v172, v172
    v_fmac_f32 v174, v173, v173
    v_mfma_f32_16x16x32_bf16 v[190:193], a[68:71], v[206:209], v[190:193]
    s_sub_u32 s82, s72, s71
    v_fma_f32 v254, v142, v142, s32
    v_fmac_f32 v254, v143, v143
    v_mfma_f32_16x16x32_bf16 v[194:197], v[186:189], a[144:147], 0
    s_mul_i32 s74, s82, 336
    v_fmac_f32 v254, v144, v144
    v_fmac_f32 v254, v145, v145
    v_mfma_f32_16x16x32_bf16 v[194:197], v[118:121], a[148:151], v[194:197]
    s_mul_i32 s75, s82, 272
    v_fmac_f32 v254, v126, v126
    v_fmac_f32 v254, v127, v127
    v_mfma_f32_16x16x32_bf16 v[194:197], v[234:237], a[152:155], v[194:197]
    s_waitcnt lgkmcnt(0)
    v_fmac_f32 v254, v128, v128
    v_fmac_f32 v254, v129, v129
    v_mfma_f32_16x16x32_bf16 v[198:201], v[32:35], v[146:149], 0
    s_mul_i32 s76, s82, 16
    v_fmac_f32 v254, v190, v190
    v_fmac_f32 v254, v191, v191
    v_mfma_f32_16x16x32_bf16 v[198:201], v[32:35], v[178:181], v[198:201]
    s_add_u32 s34, s18, 2
    v_fmac_f32 v254, v192, v192
    v_fmac_f32 v254, v193, v193
    v_mfma_f32_16x16x32_bf16 v[194:197], v[158:161], a[156:159], v[194:197]
    s_add_u32 s8, s60, s23
    v_cvt_pk_bf16_f32 v36, v254, v174
    s_addc_u32 s9, s61, 0
    v_mfma_f32_16x16x32_bf16 v[194:197], v[182:185], a[160:163], v[194:197]
    s_sub_u32 s10, s36, s23
    v_mul_f32 v254, 0x3baaaaab, v198
    v_mul_f32 v255, 0x3baaaaab, v199
    v_mfma_f32_16x16x32_bf16 v[210:213], v[32:35], v[36:39], 0
    s_cmp_le_u32 s34, s45
    v_rsq_f32 v254, v254
    v_mfma_f32_16x16x32_bf16 v[194:197], v[206:209], a[164:167], v[194:197]
    s_cselect_b32 s10, s10, 0
    ds_read_b128 v[214:217], v0 offset:26624
    v_mul_f32 v148, 0x3baaaaab, v200
    v_mfma_f32_16x16x32_bf16 v[174:177], v[186:189], a[168:171], 0
    s_add_u32 m0, s28, 0
    ds_read_b128 v[198:201], v1 offset:26624
    v_mul_f32 v122, v254, v122
    v_mfma_f32_16x16x32_bf16 v[174:177], v[118:121], a[172:175], v[174:177]
    s_mov_b32 s27, s26
    ds_read_b128 v[218:221], v0 offset:26752
    v_cvt_pk_bf16_f32 v146, v194, v195
    v_mfma_f32_16x16x32_bf16 v[174:177], v[234:237], a[176:179], v[174:177]
    s_mov_b32 s26, s25
    ds_read_b128 v[222:225], v1 offset:26752
    v_cvt_pk_bf16_f32 v147, v196, v197
    v_mfma_f32_16x16x32_bf16 v[174:177], v[158:161], a[180:183], v[174:177]
    s_mov_b32 s25, s24
    v_rsq_f32 v211, v211
    v_mfma_f32_16x16x32_bf16 v[174:177], v[182:185], a[184:187], v[174:177]
    s_mov_b32 s24, s23
    v_rsq_f32 v210, v210
    v_mfma_f32_16x16x32_bf16 v[174:177], v[206:209], a[188:191], v[174:177]
    s_ff1_i32_b32 s80, s100
    v_mul_f32 v210, s31, v210
    v_mul_f32 v130, v211, v130
    v_mul_f32 v131, v211, v131
    v_cvt_pk_f16_f32 v178, v130, v131
    v_mfma_f32_16x16x32_bf16 v[194:197], v[186:189], a[192:195], 0
    s_waitcnt lgkmcnt(3)
    ds_read_b128 v[186:189], v0 offset:26880
    v_cvt_pk_bf16_f32 v174, v174, v175
    v_mfma_f32_16x16x32_bf16 v[194:197], v[118:121], a[196:199], v[194:197]
    s_mov_b32 s71, s72
    ds_read_b128 v[226:229], v1 offset:26880
    v_cvt_pk_bf16_f32 v175, v176, v177
    v_mfma_f32_16x16x32_bf16 v[194:197], v[234:237], a[200:203], v[194:197]
    s_mov_b32 s72, s73
    v_mul_f32 v132, v211, v132
    v_mul_f32 v133, v211, v133
    v_mfma_f32_16x16x32_bf16 v[194:197], v[158:161], a[204:207], v[194:197]
    s_waitcnt lgkmcnt(2)
    v_cvt_pk_f16_f32 v179, v132, v133
    v_mul_f32 v134, v211, v134
    v_mfma_f32_16x16x32_bf16 v[194:197], v[182:185], a[208:211], v[194:197]
    v_mul_f32 v135, v211, v135
    v_cvt_pk_f16_f32 v180, v134, v135
    v_mfma_f32_16x16x32_bf16 v[194:197], v[206:209], a[212:215], v[194:197]
    v_mul_f32 v136, v211, v136
    v_mul_f32 v137, v211, v137
    v_mfma_f32_16x16x32_bf16 v[130:133], a[72:75], v[214:217], 0
    v_cvt_pk_f16_f32 v181, v136, v137
    v_mul_f32 v170, v211, v170
    v_mfma_f32_16x16x32_bf16 v[130:133], a[76:79], v[198:201], v[130:133]
    v_mul_f32 v171, v211, v171
    v_cvt_pk_f16_f32 v120, v170, v171
    v_mfma_f32_16x16x32_bf16 v[130:133], a[80:83], v[218:221], v[130:133]
    s_waitcnt lgkmcnt(1)
    v_cvt_pk_bf16_f32 v134, v194, v195
    v_cvt_pk_bf16_f32 v135, v196, v197
    v_mfma_f32_16x16x32_bf16 v[130:133], a[84:87], v[222:225], v[130:133]
    s_waitcnt lgkmcnt(0)
    v_mul_f32 v172, v211, v172
    v_mul_f32 v173, v211, v173
    v_mfma_f32_16x16x32_bf16 v[130:133], a[88:91], v[186:189], v[130:133]
    v_cvt_pk_f16_f32 v121, v172, v173
    v_mul_f32 v142, v210, v142
    v_mfma_f32_16x16x32_bf16 v[130:133], a[92:95], v[226:229], v[130:133]
    v_mul_f32 v143, v210, v143
    v_cvt_pk_f16_f32 v194, v142, v143
    v_mfma_f32_16x16x32_bf16 v[158:161], a[96:99], v[214:217], 0
    v_mul_f32 v144, v210, v144
    v_mul_f32 v145, v210, v145
    v_mfma_f32_16x16x32_bf16 v[158:161], a[100:103], v[198:201], v[158:161]
    v_cvt_pk_f16_f32 v195, v144, v145
    v_mul_f32 v126, v210, v126
    v_mfma_f32_16x16x32_bf16 v[158:161], a[104:107], v[218:221], v[158:161]
    v_mul_f32 v127, v210, v127
    v_cvt_pk_f16_f32 v196, v126, v127
    v_mfma_f32_16x16x32_bf16 v[158:161], a[108:111], v[222:225], v[158:161]
    v_mul_f32 v128, v210, v128
    v_mul_f32 v129, v210, v129
    v_mfma_f32_16x16x32_bf16 v[158:161], a[112:115], v[186:189], v[158:161]
    v_cvt_pk_f16_f32 v197, v128, v129
    v_mul_f32 v190, v210, v190
    v_mfma_f32_16x16x32_bf16 v[158:161], a[116:119], v[226:229], v[158:161]
    v_mul_f32 v191, v210, v191
    v_cvt_pk_f16_f32 v118, v190, v191
    v_mfma_f32_16x16x32_bf16 v[142:145], a[120:123], v[214:217], 0
    v_mul_f32 v192, v210, v192
    v_mul_f32 v193, v210, v193
    v_mfma_f32_16x16x32_bf16 v[142:145], a[124:127], v[198:201], v[142:145]
    v_cvt_pk_f16_f32 v119, v192, v193
    v_fma_f32 v149, v130, v130, s32
    v_mfma_f32_16x16x32_bf16 v[142:145], a[128:131], v[218:221], v[142:145]
    v_fmac_f32 v149, v131, v131
    v_fmac_f32 v149, v132, v132
    v_mfma_f32_16x16x32_bf16 v[142:145], a[132:135], v[222:225], v[142:145]
    v_fmac_f32 v149, v133, v133
    v_fmac_f32 v149, v158, v158
    v_mfma_f32_16x16x32_bf16 v[142:145], a[136:139], v[186:189], v[142:145]
    v_fmac_f32 v149, v159, v159
    v_fmac_f32 v149, v160, v160
    v_mfma_f32_16x16x32_bf16 v[142:145], a[140:143], v[226:229], v[142:145]
    v_fmac_f32 v149, v161, v161
    v_mul_f32 v123, v254, v123
    v_mfma_f32_16x16x32_bf16 v[170:173], a[0:3], v[214:217], 0
    v_rsq_f32 v255, v255
    v_mfma_f32_16x16x32_bf16 v[170:173], a[4:7], v[198:201], v[170:173]
    v_rsq_f32 v148, v148
    v_mfma_f32_16x16x32_bf16 v[170:173], a[8:11], v[218:221], v[170:173]
    v_mul_f32 v150, v148, v150
    v_fmac_f32 v149, v142, v142
    v_mfma_f32_16x16x32_bf16 v[170:173], a[12:15], v[222:225], v[170:173]
    v_fmac_f32 v149, v143, v143
    v_fmac_f32 v149, v144, v144
    v_mfma_f32_16x16x32_bf16 v[170:173], a[16:19], v[186:189], v[170:173]
    v_fmac_f32 v149, v145, v145
    v_mul_f32 v151, v148, v151
    v_mfma_f32_16x16x32_bf16 v[170:173], a[20:23], v[226:229], v[170:173]
    v_cvt_pk_bf16_f32 v126, v150, v151
    v_mul_f32 v152, v148, v152
    v_mfma_f32_16x16x32_bf16 v[182:185], a[24:27], v[214:217], 0
    v_mul_f32 v153, v148, v153
    v_cvt_pk_bf16_f32 v127, v152, v153
    v_mfma_f32_16x16x32_bf16 v[182:185], a[28:31], v[198:201], v[182:185]
    v_mul_f32 v162, v148, v162
    v_mul_f32 v163, v148, v163
    v_mfma_f32_16x16x32_bf16 v[182:185], a[32:35], v[218:221], v[182:185]
    v_fma_f32 v136, v170, v170, s32
    v_fmac_f32 v136, v171, v171
    v_mfma_f32_16x16x32_bf16 v[182:185], a[36:39], v[222:225], v[182:185]
    v_fmac_f32 v136, v172, v172
    v_fmac_f32 v136, v173, v173
    v_mfma_f32_16x16x32_bf16 v[182:185], a[40:43], v[186:189], v[182:185]
    v_cvt_pk_bf16_f32 v128, v162, v163
    v_mul_f32 v164, v148, v164
    v_mfma_f32_16x16x32_bf16 v[182:185], a[44:47], v[226:229], v[182:185]
    v_mul_f32 v165, v148, v165
    v_cvt_pk_bf16_f32 v129, v164, v165
    v_mfma_f32_16x16x32_bf16 v[162:165], a[48:51], v[214:217], 0
    buffer_store_dwordx4 v[126:129], v17, s[12:15], 0 offen nt
    v_mul_f32 v138, v148, v138
    v_mul_f32 v139, v148, v139
    v_cvt_pk_bf16_f32 v176, v138, v139
    v_mul_f32 v140, v148, v140
    v_mfma_f32_16x16x32_bf16 v[162:165], a[52:55], v[198:201], v[162:165]
    v_fmac_f32 v136, v182, v182
    v_fmac_f32 v136, v183, v183
    v_mfma_f32_16x16x32_bf16 v[162:165], a[56:59], v[218:221], v[162:165]
    v_fmac_f32 v136, v184, v184
    v_fmac_f32 v136, v185, v185
    v_mfma_f32_16x16x32_bf16 v[162:165], a[60:63], v[222:225], v[162:165]
    v_mul_f32 v141, v148, v141
    v_cvt_pk_bf16_f32 v177, v140, v141
    v_mfma_f32_16x16x32_bf16 v[162:165], a[64:67], v[186:189], v[162:165]
    v_cvt_pk_bf16_f32 v190, v122, v123
    v_mul_f32 v124, v254, v124
    v_mfma_f32_16x16x32_bf16 v[162:165], a[68:71], v[226:229], v[162:165]
    v_mul_f32 v125, v254, v125
    v_cvt_pk_bf16_f32 v191, v124, v125
    v_mfma_f32_16x16x32_bf16 v[122:125], v[214:217], a[144:147], 0
    v_mul_f32 v154, v254, v154
    v_mul_f32 v155, v254, v155
    v_mfma_f32_16x16x32_bf16 v[122:125], v[198:201], a[148:151], v[122:125]
    v_cvt_pk_bf16_f32 v192, v154, v155
    v_mul_f32 v156, v254, v156
    v_mfma_f32_16x16x32_bf16 v[122:125], v[218:221], a[152:155], v[122:125]
    v_fmac_f32 v136, v162, v162
    v_fmac_f32 v136, v163, v163
    v_mfma_f32_16x16x32_bf16 v[122:125], v[222:225], a[156:159], v[122:125]
    v_fmac_f32 v136, v164, v164
    v_fmac_f32 v136, v165, v165
    v_mfma_f32_16x16x32_bf16 v[122:125], v[186:189], a[160:163], v[122:125]
    v_cvt_pk_bf16_f32 v36, v136, v149
    v_mul_f32 v157, v254, v157
    v_mfma_f32_16x16x32_bf16 v[122:125], v[226:229], a[164:167], v[122:125]
    ds_read_b128 v[206:209], v0 offset:32768
    v_cvt_pk_bf16_f32 v193, v156, v157
    v_mfma_f32_16x16x32_bf16 v[154:157], v[32:35], v[36:39], 0
    v_mul_f32 v202, v254, v202
    v_mul_f32 v203, v254, v203
    v_mfma_f32_16x16x32_bf16 v[126:129], v[214:217], a[168:171], 0
    ds_read_b128 v[210:213], v1 offset:32768
    v_cvt_pk_bf16_f32 v234, v202, v203
    v_mfma_f32_16x16x32_bf16 v[126:129], v[198:201], a[172:175], v[126:129]
    ds_read_b128 v[238:241], v0 offset:32896
    v_cvt_pk_bf16_f32 v148, v122, v123
    v_mfma_f32_16x16x32_bf16 v[126:129], v[218:221], a[176:179], v[126:129]
    ds_read_b128 v[242:245], v1 offset:32896
    v_cvt_pk_bf16_f32 v149, v124, v125
    v_mfma_f32_16x16x32_bf16 v[126:129], v[222:225], a[180:183], v[126:129]
    v_rsq_f32 v155, v155
    v_mfma_f32_16x16x32_bf16 v[126:129], v[186:189], a[184:187], v[126:129]
    buffer_store_dwordx2 v[176:177], v20, s[12:15], 0 offen nt
    v_rsq_f32 v154, v154
    v_mfma_f32_16x16x32_bf16 v[126:129], v[226:229], a[188:191], v[126:129]
    s_waitcnt lgkmcnt(3)
    v_mul_f32 v154, s31, v154
    v_mul_f32 v130, v155, v130
    v_mul_f32 v131, v155, v131
    v_cvt_pk_f16_f32 v138, v130, v131
    v_mfma_f32_16x16x32_bf16 v[122:125], v[214:217], a[192:195], 0
    ds_read_b128 v[214:217], v0 offset:33024
    v_mul_f32 v132, v155, v132
    v_mfma_f32_16x16x32_bf16 v[122:125], v[198:201], a[196:199], v[122:125]
    s_waitcnt lgkmcnt(3)
    ds_read_b128 v[198:201], v1 offset:33024
    v_cvt_pk_bf16_f32 v176, v126, v127
    v_mfma_f32_16x16x32_bf16 v[122:125], v[218:221], a[200:203], v[122:125]
    s_waitcnt lgkmcnt(3)
    v_cvt_pk_bf16_f32 v177, v128, v129
    v_mul_f32 v133, v155, v133
    v_mfma_f32_16x16x32_bf16 v[122:125], v[222:225], a[204:207], v[122:125]
    s_waitcnt vmcnt(2)
    ds_write_b16 v8, v45 offset:512
    v_mfma_f32_16x16x32_bf16 v[122:125], v[186:189], a[208:211], v[122:125]
    s_waitcnt lgkmcnt(3)
    v_cvt_pk_f16_f32 v139, v132, v133
    v_mfma_f32_16x16x32_bf16 v[122:125], v[226:229], a[212:215], v[122:125]
    v_mul_f32 v158, v155, v158
    v_mul_f32 v159, v155, v159
    v_mfma_f32_16x16x32_bf16 v[130:133], a[72:75], v[206:209], 0
    v_cvt_pk_f16_f32 v140, v158, v159
    v_mul_f32 v160, v155, v160
    v_mfma_f32_16x16x32_bf16 v[130:133], a[76:79], v[210:213], v[130:133]
    v_mul_f32 v161, v155, v161
    v_cvt_pk_f16_f32 v141, v160, v161
    v_mfma_f32_16x16x32_bf16 v[130:133], a[80:83], v[238:241], v[130:133]
    s_waitcnt lgkmcnt(2)
    v_cvt_pk_bf16_f32 v136, v122, v123
    v_cvt_pk_bf16_f32 v137, v124, v125
    v_mfma_f32_16x16x32_bf16 v[130:133], a[84:87], v[242:245], v[130:133]
    s_waitcnt lgkmcnt(1)
    v_mul_f32 v142, v155, v142
    v_mul_f32 v143, v155, v143
    v_mfma_f32_16x16x32_bf16 v[130:133], a[88:91], v[214:217], v[130:133]
    v_cvt_pk_f16_f32 v128, v142, v143
    v_mul_f32 v144, v155, v144
    v_mfma_f32_16x16x32_bf16 v[130:133], a[92:95], v[198:201], v[130:133]
    s_waitcnt lgkmcnt(0)
    v_mul_f32 v145, v155, v145
    v_cvt_pk_f16_f32 v129, v144, v145
    v_mfma_f32_16x16x32_bf16 v[218:221], a[96:99], v[206:209], 0
    v_mul_f32 v170, v154, v170
    v_mul_f32 v171, v154, v171
    v_mfma_f32_16x16x32_bf16 v[218:221], a[100:103], v[210:213], v[218:221]
    v_cvt_pk_f16_f32 v150, v170, v171
    v_mul_f32 v172, v154, v172
    v_mfma_f32_16x16x32_bf16 v[218:221], a[104:107], v[238:241], v[218:221]
    v_mul_f32 v173, v154, v173
    v_cvt_pk_f16_f32 v151, v172, v173
    v_mfma_f32_16x16x32_bf16 v[218:221], a[108:111], v[242:245], v[218:221]
    s_barrier
    buffer_load_dwordx4 v10, s[8:11], 0 offen nt lds
    ds_read_u16 v202, v9 offset:128
    v_mfma_f32_16x16x32_bf16 v[218:221], a[112:115], v[214:217], v[218:221]
    s_add_u32 m0, s28, 4096
    v_mul_f32 v182, v154, v182
    v_mul_f32 v183, v154, v183
    v_mfma_f32_16x16x32_bf16 v[218:221], a[116:119], v[198:201], v[218:221]
    v_cvt_pk_f16_f32 v152, v182, v183
    v_mul_f32 v184, v154, v184
    v_mfma_f32_16x16x32_bf16 v[226:229], a[120:123], v[206:209], 0
    v_mul_f32 v185, v154, v185
    v_cvt_pk_f16_f32 v153, v184, v185
    v_mfma_f32_16x16x32_bf16 v[226:229], a[124:127], v[210:213], v[226:229]
    v_mul_f32 v162, v154, v162
    v_mul_f32 v163, v154, v163
    v_mfma_f32_16x16x32_bf16 v[226:229], a[128:131], v[238:241], v[226:229]
    buffer_load_dwordx4 v11, s[8:11], 0 offen nt lds
    v_cvt_pk_f16_f32 v126, v162, v163
    v_mfma_f32_16x16x32_bf16 v[226:229], a[132:135], v[242:245], v[226:229]
    s_add_u32 m0, s28, 8192
    v_mul_f32 v164, v154, v164
    v_mul_f32 v165, v154, v165
    v_mfma_f32_16x16x32_bf16 v[226:229], a[136:139], v[214:217], v[226:229]
    v_cvt_pk_f16_f32 v127, v164, v165
    v_mul_f32 v204, v254, v204
    v_mfma_f32_16x16x32_bf16 v[226:229], a[140:143], v[198:201], v[226:229]
    s_waitcnt lgkmcnt(0)
    v_readfirstlane_b32 s77, v202
    v_mul_f32 v205, v254, v205
    v_mfma_f32_16x16x32_bf16 v[162:165], a[0:3], v[206:209], 0
    v_cvt_pk_bf16_f32 v235, v204, v205
    v_fma_f32 v236, v130, v130, s32
    v_mfma_f32_16x16x32_bf16 v[162:165], a[4:7], v[210:213], v[162:165]
    buffer_load_dwordx4 v12, s[8:11], 0 offen nt lds
    v_fmac_f32 v236, v131, v131
    v_mfma_f32_16x16x32_bf16 v[162:165], a[8:11], v[238:241], v[162:165]
    s_add_u32 m0, s28, 12288
    v_fmac_f32 v236, v132, v132
    v_fmac_f32 v236, v133, v133
    v_mfma_f32_16x16x32_bf16 v[162:165], a[12:15], v[242:245], v[162:165]
    s_xor_b32 s28, s28, 65536
    v_fmac_f32 v236, v218, v218
    v_fmac_f32 v236, v219, v219
    v_mfma_f32_16x16x32_bf16 v[162:165], a[16:19], v[214:217], v[162:165]
    v_fmac_f32 v236, v220, v220
    v_fmac_f32 v236, v221, v221
    v_mfma_f32_16x16x32_bf16 v[162:165], a[20:23], v[198:201], v[162:165]
    v_fmac_f32 v236, v226, v226
    v_fmac_f32 v236, v227, v227
    v_mfma_f32_16x16x32_bf16 v[246:249], a[24:27], v[206:209], 0
    buffer_load_dwordx4 v13, s[8:11], 0 offen nt lds
    v_fmac_f32 v236, v228, v228
    v_mfma_f32_16x16x32_bf16 v[246:249], a[28:31], v[210:213], v[246:249]
    s_mov_b32 m0, s29
    v_fmac_f32 v236, v229, v229
    v_fma_f32 v237, v162, v162, s32
    v_mfma_f32_16x16x32_bf16 v[246:249], a[32:35], v[238:241], v[246:249]
    s_xor_b32 s29, s29, s30
    v_fmac_f32 v237, v163, v163
    v_fmac_f32 v237, v164, v164
    v_mfma_f32_16x16x32_bf16 v[246:249], a[36:39], v[242:245], v[246:249]
    s_add_u32 s19, s19, s20
    v_fmac_f32 v237, v165, v165
    v_mul_f32 v114, v255, v114
    v_mfma_f32_16x16x32_bf16 v[246:249], a[40:43], v[214:217], v[246:249]
    s_add_u32 s23, s23, s21
    v_mul_f32 v115, v255, v115
    v_cvt_pk_bf16_f32 v114, v114, v115
    v_mfma_f32_16x16x32_bf16 v[246:249], a[44:47], v[198:201], v[246:249]
    v_mul_f32 v116, v255, v116
    v_mfma_f32_16x16x32_bf16 v[122:125], a[48:51], v[206:209], 0
    s_cmp_ge_u32 s19, 72
    v_mul_f32 v117, v255, v117
    v_cvt_pk_bf16_f32 v115, v116, v117
    v_mfma_f32_16x16x32_bf16 v[122:125], a[52:55], v[210:213], v[122:125]
    s_cselect_b32 s34, 72, 0
    s_nop 0
    v_fmac_f32 v237, v246, v246
    v_fmac_f32 v237, v247, v247
    v_mfma_f32_16x16x32_bf16 v[122:125], a[56:59], v[238:241], v[122:125]
    s_cselect_b32 s35, s22, 0
    v_fmac_f32 v237, v248, v248
    v_fmac_f32 v237, v249, v249
    v_mfma_f32_16x16x32_bf16 v[122:125], a[60:63], v[242:245], v[122:125]
    s_sub_u32 s19, s19, s34
    v_mul_f32 v166, v255, v166
    v_mul_f32 v167, v255, v167
    v_mfma_f32_16x16x32_bf16 v[122:125], a[64:67], v[214:217], v[122:125]
    buffer_store_dwordx4 v[190:193], v15, s[12:15], 0 offen nt
    v_cvt_pk_bf16_f32 v116, v166, v167
    v_mul_f32 v168, v255, v168
    v_mul_f32 v169, v255, v169
    v_cvt_pk_bf16_f32 v117, v168, v169
    v_mfma_f32_16x16x32_bf16 v[122:125], a[68:71], v[198:201], v[122:125]
    s_add_u32 s23, s23, s35
    v_mul_f32 v230, v255, v230
    v_mul_f32 v231, v255, v231
    v_mfma_f32_16x16x32_bf16 v[154:157], v[206:209], a[144:147], 0
    s_cmp_lg_u32 s83, 0
    v_cvt_pk_bf16_f32 v254, v230, v231
    v_mul_f32 v232, v255, v232
    v_mfma_f32_16x16x32_bf16 v[154:157], v[210:213], a[148:151], v[154:157]
    s_cselect_b32 s77, s80, s77
    v_fmac_f32 v237, v122, v122
    v_fmac_f32 v237, v123, v123
    v_mfma_f32_16x16x32_bf16 v[154:157], v[238:241], a[152:155], v[154:157]
    s_mul_i32 s78, s77, 2688
    v_fmac_f32 v237, v124, v124
    v_fmac_f32 v237, v125, v125
    v_mfma_f32_16x16x32_bf16 v[154:157], v[242:245], a[156:159], v[154:157]
    s_add_u32 s78, s78, s69
    ds_read2_b32 v[144:145], v6 offset0:0 offset1:0
    ds_read2_b32 v[172:173], v6 offset0:16 offset1:16
    v_mfma_f32_16x16x32_bf16 v[154:157], v[214:217], a[160:163], v[154:157]
    s_add_u32 s80, s77, s68
    ds_read2_b32 v[192:193], v6 offset0:32 offset1:32
    v_cvt_pk_bf16_f32 v36, v237, v236
    v_mfma_f32_16x16x32_bf16 v[154:157], v[198:201], a[164:167], v[154:157]
    s_cmp_ge_u32 s80, 72
    v_mul_f32 v233, v255, v233
    v_cvt_pk_bf16_f32 v255, v232, v233
    v_mfma_f32_16x16x32_bf16 v[230:233], v[32:35], v[36:39], 0
    s_cselect_b32 s80, s22, 0
    v_xor_b32 v0, 65536, v0
    v_xor_b32 v1, 65536, v1
    v_mfma_f32_16x16x32_bf16 v[166:169], v[206:209], a[168:171], 0
    s_add_u32 s78, s78, s80
    v_cvt_pk_bf16_f32 v142, v154, v155
    v_cvt_pk_bf16_f32 v143, v156, v157
    v_mfma_f32_16x16x32_bf16 v[166:169], v[210:213], a[172:175], v[166:169]
    s_add_u32 s80, s77, 20
    v_rsq_f32 v231, v231
    v_mfma_f32_16x16x32_bf16 v[166:169], v[238:241], a[176:179], v[166:169]
    s_add_u32 s34, s18, 3
    v_rsq_f32 v230, v230
    v_mfma_f32_16x16x32_bf16 v[166:169], v[242:245], a[180:183], v[166:169]
    s_cmp_lt_u32 s77, s62
    v_mul_f32 v230, s31, v230
    v_mul_f32 v130, v231, v130
    v_mfma_f32_16x16x32_bf16 v[166:169], v[214:217], a[184:187], v[166:169]
    s_cselect_b32 s79, 1, 0
    v_mul_f32 v131, v231, v131
    v_cvt_pk_f16_f32 v158, v130, v131
    v_mfma_f32_16x16x32_bf16 v[166:169], v[198:201], a[188:191], v[166:169]
    s_cselect_b32 s78, s78, 0
    v_mul_f32 v132, v231, v132
    v_mul_f32 v133, v231, v133
    v_mfma_f32_16x16x32_bf16 v[250:253], v[206:209], a[192:195], 0
    s_cmp_lt_u32 s34, s17
    v_cvt_pk_f16_f32 v159, v132, v133
    v_mul_f32 v218, v231, v218
    v_mfma_f32_16x16x32_bf16 v[250:253], v[210:213], a[196:199], v[250:253]
    s_cselect_b32 s23, s23, s78
    v_cvt_pk_bf16_f32 v170, v166, v167
    v_cvt_pk_bf16_f32 v171, v168, v169
    v_mfma_f32_16x16x32_bf16 v[250:253], v[238:241], a[200:203], v[250:253]
    s_cselect_b32 s73, s34, s80
    ds_read_b128 v[222:225], v5 offset:0
    ds_read_b128 v[202:205], v5 offset:16
    v_mfma_f32_16x16x32_bf16 v[250:253], v[242:245], a[204:207], v[250:253]
    s_cselect_b32 s79, 0, s79
    ds_read_b128 v[154:157], v5 offset:48
    ds_read_b32 v232, v6 offset:192
    v_mfma_f32_16x16x32_bf16 v[250:253], v[214:217], a[208:211], v[250:253]
    s_waitcnt lgkmcnt(4)
    buffer_store_dwordx2 v[234:235], v18, s[12:15], 0 offen nt
    v_mul_f32 v219, v231, v219
    v_cvt_pk_f16_f32 v160, v218, v219
    v_mfma_f32_16x16x32_f16 v[186:189], v[178:181], v[194:197], v[46:49]
    s_cselect_b32 s81, 0, 1
    v_mul_f32 v220, v231, v220
    v_mul_f32 v221, v231, v221
    v_mfma_f32_16x16x32_f16 v[182:185], v[138:141], v[194:197], v[50:53]
    s_add_u32 s80, s77, 1
    v_cvt_pk_f16_f32 v161, v220, v221
    v_mul_f32 v226, v231, v226
    v_mul_f32 v227, v231, v227
    v_mfma_f32_16x16x32_f16 v[166:169], v[158:161], v[194:197], v[54:57]
    s_mul_i32 s80, s80, s81
    v_cvt_pk_f16_f32 v132, v226, v227
    v_mul_f32 v228, v231, v228
    v_mul_f32 v229, v231, v229
    v_mfma_f32_16x16x16_f16 v[186:189], v[120:121], v[118:119], v[186:189]
    v_cvt_pk_f16_f32 v133, v228, v229
    v_mul_f32 v162, v230, v162
    v_mul_f32 v163, v230, v163
    v_mfma_f32_16x16x16_f16 v[182:185], v[128:129], v[118:119], v[182:185]
    v_cvt_pk_f16_f32 v162, v162, v163
    v_mul_f32 v164, v230, v164
    v_mul_f32 v165, v230, v165
    v_mfma_f32_16x16x16_f16 v[166:169], v[132:133], v[118:119], v[166:169]
    v_cvt_pk_f16_f32 v163, v164, v165
    v_mul_f32 v246, v230, v246
    v_mul_f32 v247, v230, v247
    v_cvt_pk_f16_f32 v164, v246, v247
    v_mfma_f32_16x16x32_bf16 v[250:253], v[198:201], a[212:215], v[250:253]
    s_waitcnt lgkmcnt(0)
    ds_read_b128 v[214:217], v2 offset:0
    ds_read_b128 v[206:209], v2 offset:1024
    v_mfma_f32_16x16x32_f16 v[226:229], v[222:225], v[194:197], v[22:25]
    s_cmp_lt_u32 s80, s62
    ds_read_b128 v[210:213], v2 offset:2048
    ds_read_b128 v[194:197], v2 offset:3072
    v_mfma_f32_16x16x32_f16 v[226:229], v[202:205], v[178:181], v[226:229]
    s_cselect_b32 s70, s70, 0
    v_cvt_pk_bf16_f32 v190, v250, v251
    v_cvt_pk_bf16_f32 v191, v252, v253
    v_mfma_f32_16x16x32_f16 v[226:229], v[154:157], v[118:121], v[226:229]
    s_cselect_b32 s62, s62, 0
    ds_read_b128 v[198:201], v2 offset:4096
    v_mul_f32 v248, v230, v248
    v_mul_f32 v249, v230, v249
    v_cvt_pk_f16_f32 v165, v248, v249
    v_mfma_f32_16x16x32_f16 v[218:221], v[222:225], v[150:153], v[24:27]
    s_add_u32 s80, s18, 4
    v_mul_f32 v122, v230, v122
    v_mul_f32 v123, v230, v123
    v_mfma_f32_16x16x32_f16 v[218:221], v[202:205], v[138:141], v[218:221]
    s_cmp_ge_u32 s80, s17
    v_cvt_pk_f16_f32 v130, v122, v123
    v_mul_f32 v124, v230, v124
    v_mfma_f32_16x16x32_f16 v[218:221], v[154:157], v[126:129], v[218:221]
    s_cselect_b32 s66, s70, 0
    v_mul_f32 v125, v230, v125
    v_cvt_pk_f16_f32 v131, v124, v125
    v_mfma_f32_16x16x32_f16 v[238:241], v[222:225], v[162:165], v[26:29]
    s_waitcnt lgkmcnt(3)
    ds_read_b128 v[222:225], v2 offset:5120
    v_mov_b32_dpp v232, v227 quad_perm:[0,1,2,3] row_mask:0x1 bank_mask:0xf
    v_mfma_f32_16x16x32_f16 v[238:241], v[202:205], v[158:161], v[238:241]
    s_lshl_b32 s80, s79, s73
    v_mov_b32_dpp v232, v219 quad_perm:[0,1,2,3] row_mask:0x2 bank_mask:0xf
    v_max3_f32 v118, v226, v186, v187
    v_mfma_f32_16x16x32_f16 v[238:241], v[154:157], v[130:133], v[238:241]
    s_waitcnt lgkmcnt(2)
    buffer_store_dwordx4 v[114:117], v16, s[12:15], 0 offen nt
    v_max3_f32 v118, v118, v188, v189
    v_max3_f32 v118, v118, v182, v183
    v_max3_f32 v118, v118, v184, v185
    v_max3_f32 v118, v118, v166, v167
    v_mfma_f32_16x16x32_bf16 v[122:125], a[216:219], v[214:217], 0
    s_or_b32 s63, s63, s80
    v_max3_f32 v118, v118, v168, v169
    v_mov_b32 v119, v118
    v_mfma_f32_16x16x32_bf16 v[122:125], a[220:223], v[206:209], v[122:125]
    s_sub_u32 s80, s100, s81
    v_permlane32_swap_b32 v118, v119
    v_mfma_f32_16x16x32_bf16 v[122:125], a[224:227], v[210:213], v[122:125]
    s_and_b32 s100, s100, s80
    v_max_f32 v118, v118, v119
    v_mov_b32 v119, v118
    v_mfma_f32_16x16x32_bf16 v[122:125], a[228:231], v[194:197], v[122:125]
    s_waitcnt lgkmcnt(1)
    v_permlane16_swap_b32 v118, v119
    v_mfma_f32_16x16x32_bf16 v[122:125], a[232:235], v[198:201], v[122:125]
    s_waitcnt lgkmcnt(0)
    v_max_f32 v118, v118, v119
    v_sub_f32 v186, v186, v118
    v_mfma_f32_16x16x32_bf16 v[122:125], a[236:239], v[222:225], v[122:125]
    s_add_u32 s45, s45, s79
    v_exp_f32 v186, v186
    v_mfma_f32_16x16x32_bf16 v[154:157], a[240:243], v[214:217], 0
    s_add_u32 s18, s18, 1
    v_sub_f32 v187, v187, v118
    v_sub_f32 v188, v188, v118
    v_mfma_f32_16x16x32_bf16 v[154:157], a[244:247], v[206:209], v[154:157]
    s_cmp_lt_u32 s18, s45
    v_exp_f32 v187, v187
    v_mfma_f32_16x16x32_bf16 v[154:157], a[248:251], v[210:213], v[154:157]
    v_cvt_pk_bf16_f32 v186, v186, v187
    v_sub_f32 v189, v189, v118
    v_mfma_f32_16x16x32_bf16 v[154:157], a[252:255], v[194:197], v[154:157]
    v_exp_f32 v188, v188
    v_mfma_f32_16x16x32_bf16 v[154:157], v[82:85], v[198:201], v[154:157]
    v_exp_f32 v189, v189
    v_mfma_f32_16x16x32_bf16 v[154:157], v[86:89], v[222:225], v[154:157]
    v_cvt_pk_bf16_f32 v187, v188, v189
    v_sub_f32 v182, v182, v118
    v_mfma_f32_16x16x32_bf16 v[202:205], v[90:93], v[214:217], 0
    ds_read_b128 v[214:217], v2 offset:6144
    v_sub_f32 v183, v183, v118
    v_mfma_f32_16x16x32_bf16 v[202:205], v[94:97], v[206:209], v[202:205]
    ds_read_b128 v[206:209], v2 offset:7168
    v_sub_f32 v184, v184, v118
    v_mfma_f32_16x16x32_bf16 v[202:205], v[98:101], v[210:213], v[202:205]
    ds_read_b128 v[210:213], v2 offset:8192
    v_sub_f32 v185, v185, v118
    v_mfma_f32_16x16x32_bf16 v[202:205], v[102:105], v[194:197], v[202:205]
    ds_read_b128 v[194:197], v2 offset:9216
    buffer_store_dwordx2 v[254:255], v19, s[12:15], 0 offen nt
    v_exp_f32 v182, v182
    v_mfma_f32_16x16x32_f16 v[234:237], v[178:181], v[150:153], v[58:61]
    v_exp_f32 v183, v183
    v_mfma_f32_16x16x32_bf16 v[202:205], v[106:109], v[198:201], v[202:205]
    ds_read_b128 v[198:201], v2 offset:10240
    v_cvt_pk_bf16_f32 v188, v182, v183
    v_mfma_f32_16x16x32_bf16 v[202:205], v[110:113], v[222:225], v[202:205]
    ds_read_b128 v[222:225], v2 offset:11264
    v_exp_f32 v184, v184
    v_mfma_f32_16x16x16_f16 v[234:237], v[120:121], v[126:127], v[234:237]
    v_exp_f32 v185, v185
    v_sub_f32 v166, v166, v118
    v_cvt_pk_bf16_f32 v189, v184, v185
    v_mfma_f32_16x16x32_f16 v[182:185], v[138:141], v[150:153], v[62:65]
    s_waitcnt lgkmcnt(4)
    v_exp_f32 v166, v166
    v_sub_f32 v167, v167, v118
    v_exp_f32 v167, v167
    v_sub_f32 v168, v168, v118
    v_cvt_pk_bf16_f32 v36, v166, v167
    v_mfma_f32_16x16x16_f16 v[182:185], v[128:129], v[126:127], v[182:185]
    v_exp_f32 v168, v168
    v_sub_f32 v169, v169, v118
    v_sub_f32 v226, v226, v118
    v_mfma_f32_16x16x32_f16 v[242:245], v[158:161], v[150:153], v[66:69]
    s_waitcnt lgkmcnt(2)
    v_exp_f32 v169, v169
    v_mfma_f32_16x16x32_bf16 v[114:117], a[216:219], v[214:217], 0
    s_waitcnt lgkmcnt(1)
    v_cvt_pk_bf16_f32 v37, v168, v169
    v_mov_b32_dpp v232, v239 quad_perm:[0,1,2,3] row_mask:0x4 bank_mask:0xf
    v_mov_b32 v118, v232
    v_mfma_f32_16x16x16_f16 v[242:245], v[132:133], v[126:127], v[242:245]
    v_exp_f32 v226, v226
    v_max_f32_dpp v118, v118, v118 quad_perm:[1,0,3,2] row_mask:0xf bank_mask:0xf
    v_cvt_pk_bf16_f32 v39, v226, 0
    v_mfma_f32_16x16x32_bf16 v[114:117], a[220:223], v[206:209], v[114:117]
    s_waitcnt lgkmcnt(0)
    v_max_f32_dpp v118, v118, v118 quad_perm:[2,3,0,1] row_mask:0xf bank_mask:0xf
    v_max3_f32 v126, v218, v234, v235
    v_mfma_f32_16x16x32_bf16 v[150:153], v[28:31], v[36:39], 0
    v_max_f32_dpp v118, v118, v118 row_half_mirror row_mask:0xf bank_mask:0xf
    v_max3_f32 v126, v126, v236, v237
    v_mfma_f32_16x16x32_bf16 v[150:153], v[28:31], v[186:189], v[150:153]
    v_max_f32_dpp v118, v118, v118 row_mirror row_mask:0xf bank_mask:0xf
    v_mov_b32 v119, v118
    v_mfma_f32_16x16x32_bf16 v[114:117], a[224:227], v[210:213], v[114:117]
    v_max3_f32 v126, v126, v182, v183
    v_max3_f32 v126, v126, v184, v185
    v_mfma_f32_16x16x32_bf16 v[114:117], a[228:231], v[194:197], v[114:117]
    v_permlane32_swap_b32 v118, v119
    v_mfma_f32_16x16x32_bf16 v[114:117], a[232:235], v[198:201], v[114:117]
    v_rcp_f32 v150, v150
    v_mfma_f32_16x16x32_bf16 v[114:117], a[236:239], v[222:225], v[114:117]
    v_max_f32 v118, v118, v119
    v_mov_b32 v119, v118
    v_max3_f32 v126, v126, v242, v243
    v_max3_f32 v126, v126, v244, v245
    v_permlane16_swap_b32 v118, v119
    v_max_f32 v118, v118, v119
    v_mfma_f32_16x16x32_bf16 v[166:169], v[142:145], v[36:39], 0
    v_sub_f32 v232, v232, v118
    v_mov_b32 v127, v126
    v_mfma_f32_16x16x32_bf16 v[166:169], v[146:149], v[186:189], v[166:169]
    v_exp_f32 v232, v232
    v_permlane32_swap_b32 v126, v127
    v_cvt_pk_bf16_f32 v232, v232, v232
    v_max_f32 v126, v126, v127
    v_mov_b32 v127, v126
    v_fma_f32 v254, v122, v122, s33
    v_fmac_f32 v254, v123, v123
    v_permlane16_swap_b32 v126, v127
    v_mul_f32 v166, v150, v166
    v_mul_f32 v167, v150, v167
    v_cvt_pk_bf16_f32 v166, v166, v167
    v_mul_f32 v168, v150, v168
    v_mul_f32 v169, v150, v169
    v_cvt_pk_bf16_f32 v167, v168, v169
    v_max_f32 v126, v126, v127
    v_sub_f32 v234, v234, v126
    v_exp_f32 v234, v234
    v_sub_f32 v235, v235, v126
    v_exp_f32 v235, v235
    v_sub_f32 v236, v236, v126
    v_cvt_pk_bf16_f32 v226, v234, v235
    v_exp_f32 v236, v236
    v_sub_f32 v237, v237, v126
    v_exp_f32 v237, v237
    v_sub_f32 v182, v182, v126
    v_cvt_pk_bf16_f32 v227, v236, v237
    v_mfma_f32_16x16x32_bf16 v[234:237], v[170:173], v[36:39], 0
    ds_write_b16 v8, v232
    v_mfma_f32_16x16x32_bf16 v[234:237], v[174:177], v[186:189], v[234:237]
    v_exp_f32 v182, v182
    v_sub_f32 v183, v183, v126
    v_exp_f32 v183, v183
    v_sub_f32 v184, v184, v126
    v_cvt_pk_bf16_f32 v228, v182, v183
    v_exp_f32 v184, v184
    v_sub_f32 v185, v185, v126
    v_exp_f32 v185, v185
    v_mul_f32 v234, v150, v234
    v_mul_f32 v235, v150, v235
    v_cvt_pk_bf16_f32 v168, v234, v235
    v_mul_f32 v236, v150, v236
    v_mul_f32 v237, v150, v237
    v_cvt_pk_bf16_f32 v169, v236, v237
    v_mfma_f32_16x16x32_bf16 v[230:233], v[190:193], v[36:39], 0
    ds_write_b128 v3, v[166:169] offset:0
    v_mfma_f32_16x16x32_bf16 v[230:233], v[134:137], v[186:189], v[230:233]
    v_cvt_pk_bf16_f32 v229, v184, v185
    v_sub_f32 v242, v242, v126
    v_mfma_f32_16x16x32_f16 v[182:185], v[178:181], v[162:165], v[70:73]
    v_exp_f32 v242, v242
    v_mfma_f32_16x16x32_bf16 v[166:169], a[240:243], v[214:217], 0
    ds_read_b128 v[178:181], v9
    v_sub_f32 v243, v243, v126
    v_mfma_f32_16x16x32_bf16 v[166:169], a[244:247], v[206:209], v[166:169]
    v_mul_f32 v230, v150, v230
    v_mul_f32 v231, v150, v231
    v_cvt_pk_bf16_f32 v220, v230, v231
    v_mfma_f32_16x16x16_f16 v[182:185], v[120:121], v[130:131], v[182:185]
    v_mul_f32 v232, v150, v232
    v_mul_f32 v233, v150, v233
    v_cvt_pk_bf16_f32 v221, v232, v233
    v_sub_f32 v244, v244, v126
    v_mfma_f32_16x16x32_bf16 v[166:169], a[248:251], v[210:213], v[166:169]
    ds_read_b128 v[118:121], v9 offset:64
    v_sub_f32 v245, v245, v126
    v_mfma_f32_16x16x32_bf16 v[166:169], a[252:255], v[194:197], v[166:169]
    ds_write_b64 v4, v[220:221] offset:4096
    v_mfma_f32_16x16x32_bf16 v[166:169], v[82:85], v[198:201], v[166:169]
    v_max3_f32 v255, v238, v182, v183
    v_max3_f32 v255, v255, v184, v185
    v_mfma_f32_16x16x32_bf16 v[166:169], v[86:89], v[222:225], v[166:169]
    v_exp_f32 v243, v243
    v_exp_f32 v244, v244
    v_cvt_pk_bf16_f32 v36, v242, v243
    v_mfma_f32_16x16x32_f16 v[186:189], v[138:141], v[162:165], v[74:77]
    s_waitcnt lgkmcnt(2)
    v_exp_f32 v245, v245
    v_mfma_f32_16x16x32_f16 v[246:249], v[158:161], v[162:165], v[78:81]
    v_cvt_pk_bf16_f32 v37, v244, v245
    v_sub_f32 v218, v218, v126
    v_mfma_f32_16x16x32_bf16 v[242:245], v[178:181], v[28:31], 0
    v_exp_f32 v218, v218
    v_fmac_f32 v254, v124, v124
    v_mfma_f32_16x16x16_f16 v[186:189], v[128:129], v[130:131], v[186:189]
    v_cvt_pk_bf16_f32 v39, v218, 0
    v_fmac_f32 v254, v125, v125
    v_fmac_f32 v254, v154, v154
    v_mfma_f32_16x16x16_f16 v[246:249], v[132:133], v[130:131], v[246:249]
    v_fmac_f32 v254, v155, v155
    v_fmac_f32 v254, v156, v156
    v_fmac_f32 v254, v157, v157
    v_fmac_f32 v254, v202, v202
    v_mfma_f32_16x16x32_bf16 v[126:129], v[28:31], v[36:39], 0
    s_waitcnt lgkmcnt(0)
    v_max3_f32 v255, v255, v186, v187
    v_max3_f32 v255, v255, v188, v189
    v_mfma_f32_16x16x32_bf16 v[126:129], v[28:31], v[226:229], v[126:129]
    v_max3_f32 v255, v255, v246, v247
    v_max3_f32 v255, v255, v248, v249
    v_mfma_f32_16x16x32_bf16 v[130:133], v[142:145], v[36:39], 0
    v_mov_b32 v239, v255
    v_fmac_f32 v254, v203, v203
    v_mfma_f32_16x16x32_bf16 v[130:133], v[146:149], v[226:229], v[130:133]
    v_permlane32_swap_b32 v255, v239
    v_mfma_f32_16x16x32_bf16 v[138:141], v[170:173], v[36:39], 0
    v_rcp_f32 v126, v126
    v_mfma_f32_16x16x32_bf16 v[138:141], v[174:177], v[226:229], v[138:141]
    v_max_f32 v255, v255, v239
    v_mov_b32 v239, v255
    v_mfma_f32_16x16x32_bf16 v[150:153], v[190:193], v[36:39], 0
    v_fmac_f32 v254, v204, v204
    v_mul_f32 v130, v126, v130
    v_mfma_f32_16x16x32_bf16 v[150:153], v[134:137], v[226:229], v[150:153]
    v_mul_f32 v131, v126, v131
    v_cvt_pk_bf16_f32 v130, v130, v131
    v_mfma_f32_16x16x32_bf16 v[242:245], v[118:121], v[28:31], v[242:245]
    v_mul_f32 v132, v126, v132
    v_mul_f32 v133, v126, v133
    v_mfma_f32_16x16x32_bf16 v[218:221], v[178:181], v[146:149], 0
    v_cvt_pk_bf16_f32 v131, v132, v133
    v_mul_f32 v138, v126, v138
    v_mfma_f32_16x16x32_bf16 v[218:221], v[118:121], v[142:145], v[218:221]
    v_mul_f32 v139, v126, v139
    v_cvt_pk_bf16_f32 v132, v138, v139
    v_mfma_f32_16x16x32_bf16 v[226:229], v[178:181], v[174:177], 0
    v_mul_f32 v140, v126, v140
    v_mul_f32 v141, v126, v141
    v_mfma_f32_16x16x32_bf16 v[226:229], v[118:121], v[170:173], v[226:229]
    v_cvt_pk_bf16_f32 v133, v140, v141
    v_mul_f32 v150, v126, v150
    v_mfma_f32_16x16x32_bf16 v[250:253], v[178:181], v[134:137], 0
    ds_write_b128 v3, v[130:133] offset:6144
    v_mfma_f32_16x16x32_bf16 v[250:253], v[118:121], v[190:193], v[250:253]
    v_mul_f32 v151, v126, v151
    v_cvt_pk_bf16_f32 v240, v150, v151
    v_mfma_f32_16x16x32_bf16 v[230:233], v[90:93], v[214:217], 0
    v_mul_f32 v152, v126, v152
    v_mul_f32 v153, v126, v153
    v_mfma_f32_16x16x32_bf16 v[230:233], v[94:97], v[206:209], v[230:233]
    ds_read_b128 v[118:121], v2 offset:12288
    ds_read_b128 v[126:129], v2 offset:13312
    v_mfma_f32_16x16x32_bf16 v[230:233], v[98:101], v[210:213], v[230:233]
    ds_read_b128 v[130:133], v2 offset:14336
    v_cvt_pk_bf16_f32 v241, v152, v153
    v_mfma_f32_16x16x32_bf16 v[230:233], v[102:105], v[194:197], v[230:233]
    ds_read_b128 v[158:161], v2 offset:15360
    v_fmac_f32 v254, v205, v205
    v_mfma_f32_16x16x32_bf16 v[230:233], v[106:109], v[198:201], v[230:233]
    ds_read_b128 v[178:181], v2 offset:16384
    v_fma_f32 v219, v114, v114, s33
    v_mfma_f32_16x16x32_bf16 v[230:233], v[110:113], v[222:225], v[230:233]
    ds_read_b128 v[194:197], v2 offset:17408
    ds_write_b64 v4, v[240:241] offset:10240
    v_permlane16_swap_b32 v255, v239
    v_max_f32 v255, v255, v239
    v_sub_f32 v182, v182, v255
    v_exp_f32 v182, v182
    v_sub_f32 v183, v183, v255
    v_exp_f32 v183, v183
    s_waitcnt lgkmcnt(5)
    v_mfma_f32_16x16x32_bf16 v[150:153], a[216:219], v[118:121], 0
    v_cvt_pk_bf16_f32 v198, v182, v183
    v_sub_f32 v184, v184, v255
    v_mfma_f32_16x16x32_bf16 v[150:153], a[220:223], v[126:129], v[150:153]
    s_waitcnt lgkmcnt(4)
    v_exp_f32 v184, v184
    v_mfma_f32_16x16x32_bf16 v[150:153], a[224:227], v[130:133], v[150:153]
    s_waitcnt lgkmcnt(3)
    v_sub_f32 v185, v185, v255
    v_sub_f32 v186, v186, v255
    v_mfma_f32_16x16x32_bf16 v[150:153], a[228:231], v[158:161], v[150:153]
    s_waitcnt lgkmcnt(2)
    v_exp_f32 v185, v185
    v_mfma_f32_16x16x32_bf16 v[150:153], a[232:235], v[178:181], v[150:153]
    s_waitcnt lgkmcnt(0)
    v_cvt_pk_bf16_f32 v199, v184, v185
    v_sub_f32 v187, v187, v255
    v_mfma_f32_16x16x32_bf16 v[150:153], a[236:239], v[194:197], v[150:153]
    v_exp_f32 v186, v186
    v_mfma_f32_16x16x32_bf16 v[162:165], a[240:243], v[118:121], 0
    v_exp_f32 v187, v187
    v_mfma_f32_16x16x32_bf16 v[162:165], a[244:247], v[126:129], v[162:165]
    v_cvt_pk_bf16_f32 v200, v186, v187
    v_sub_f32 v188, v188, v255
    v_mfma_f32_16x16x32_bf16 v[162:165], a[248:251], v[130:133], v[162:165]
    v_exp_f32 v188, v188
    v_mfma_f32_16x16x32_bf16 v[162:165], a[252:255], v[158:161], v[162:165]
    v_sub_f32 v189, v189, v255
    v_sub_f32 v246, v246, v255
    v_mfma_f32_16x16x32_bf16 v[162:165], v[82:85], v[178:181], v[162:165]
    v_exp_f32 v189, v189
    v_mfma_f32_16x16x32_bf16 v[162:165], v[86:89], v[194:197], v[162:165]
    v_cvt_pk_bf16_f32 v201, v188, v189
    v_sub_f32 v247, v247, v255
    v_mfma_f32_16x16x32_bf16 v[138:141], v[90:93], v[118:121], 0
    v_exp_f32 v246, v246
    v_mfma_f32_16x16x32_bf16 v[138:141], v[94:97], v[126:129], v[138:141]
    v_exp_f32 v247, v247
    v_mfma_f32_16x16x32_bf16 v[138:141], v[98:101], v[130:133], v[138:141]
    v_cvt_pk_bf16_f32 v36, v246, v247
    v_sub_f32 v248, v248, v255
    v_mfma_f32_16x16x32_bf16 v[138:141], v[102:105], v[158:161], v[138:141]
    v_exp_f32 v248, v248
    v_mfma_f32_16x16x32_bf16 v[138:141], v[106:109], v[178:181], v[138:141]
    v_sub_f32 v249, v249, v255
    v_sub_f32 v238, v238, v255
    v_mfma_f32_16x16x32_bf16 v[138:141], v[110:113], v[194:197], v[138:141]
    ds_read_b128 v[186:189], v0 offset:20480
    ds_read_b128 v[118:121], v1 offset:20480
    ds_read_b128 v[234:237], v0 offset:20608
    v_exp_f32 v249, v249
    v_exp_f32 v238, v238
    v_cvt_pk_bf16_f32 v37, v248, v249
    v_cvt_pk_bf16_f32 v39, v238, 0
    v_fma_f32 v255, v150, v150, s33
    v_fmac_f32 v255, v151, v151
    v_mfma_f32_16x16x32_bf16 v[126:129], v[28:31], v[36:39], 0
    ds_read_b128 v[158:161], v1 offset:20608
    ds_read_b128 v[182:185], v0 offset:20736
    v_mfma_f32_16x16x32_bf16 v[126:129], v[28:31], v[198:201], v[126:129]
    ds_read_b128 v[206:209], v1 offset:20736
    v_fmac_f32 v255, v152, v152
    v_mfma_f32_16x16x32_bf16 v[178:181], v[142:145], v[36:39], 0
    v_fmac_f32 v255, v153, v153
    v_fmac_f32 v255, v162, v162
    v_mfma_f32_16x16x32_bf16 v[178:181], v[146:149], v[198:201], v[178:181]
    v_fmac_f32 v255, v163, v163
    v_fmac_f32 v255, v164, v164
    v_mfma_f32_16x16x32_bf16 v[142:145], v[170:173], v[36:39], 0
    s_waitcnt lgkmcnt(5)
    v_rcp_f32 v126, v126
    v_mfma_f32_16x16x32_bf16 v[142:145], v[174:177], v[198:201], v[142:145]
    s_waitcnt lgkmcnt(3)
    v_fmac_f32 v255, v165, v165
    v_mul_f32 v178, v126, v178
    v_mfma_f32_16x16x32_bf16 v[146:149], v[190:193], v[36:39], 0
    v_mul_f32 v179, v126, v179
    v_cvt_pk_bf16_f32 v170, v178, v179
    v_mfma_f32_16x16x32_bf16 v[146:149], v[134:137], v[198:201], v[146:149]
    v_mul_f32 v180, v126, v180
    v_mul_f32 v181, v126, v181
    v_mfma_f32_16x16x32_bf16 v[130:133], a[72:75], v[186:189], 0
    s_waitcnt lgkmcnt(1)
    v_cvt_pk_bf16_f32 v171, v180, v181
    v_mul_f32 v142, v126, v142
    v_mfma_f32_16x16x32_bf16 v[130:133], a[76:79], v[118:121], v[130:133]
    s_waitcnt lgkmcnt(0)
    v_mul_f32 v143, v126, v143
    v_cvt_pk_bf16_f32 v172, v142, v143
    v_mfma_f32_16x16x32_bf16 v[130:133], a[80:83], v[234:237], v[130:133]
    v_mul_f32 v144, v126, v144
    v_mul_f32 v145, v126, v145
    v_mfma_f32_16x16x32_bf16 v[130:133], a[84:87], v[158:161], v[130:133]
    v_cvt_pk_bf16_f32 v173, v144, v145
    v_mul_f32 v146, v126, v146
    v_mfma_f32_16x16x32_bf16 v[130:133], a[88:91], v[182:185], v[130:133]
    ds_write_b128 v3, v[170:173] offset:12288
    v_mfma_f32_16x16x32_bf16 v[130:133], a[92:95], v[206:209], v[130:133]
    v_mul_f32 v147, v126, v147
    v_cvt_pk_bf16_f32 v220, v146, v147
    v_mfma_f32_16x16x32_bf16 v[134:137], a[96:99], v[186:189], 0
    v_mul_f32 v148, v126, v148
    v_mul_f32 v149, v126, v149
    v_mfma_f32_16x16x32_bf16 v[134:137], a[100:103], v[118:121], v[134:137]
    v_cvt_pk_bf16_f32 v221, v148, v149
    v_fmac_f32 v255, v138, v138
    v_mfma_f32_16x16x32_bf16 v[134:137], a[104:107], v[234:237], v[134:137]
    ds_write_b64 v4, v[220:221] offset:16384
    v_mfma_f32_16x16x32_bf16 v[134:137], a[108:111], v[158:161], v[134:137]
    v_fmac_f32 v255, v139, v139
    v_fmac_f32 v255, v140, v140
    v_mfma_f32_16x16x32_bf16 v[134:137], a[112:115], v[182:185], v[134:137]
    v_fmac_f32 v255, v141, v141
    v_cvt_pk_bf16_f32 v255, v255, v255
    v_mfma_f32_16x16x32_bf16 v[134:137], a[116:119], v[206:209], v[134:137]
    v_rcp_f32 v242, v242
    v_mfma_f32_16x16x32_bf16 v[170:173], a[120:123], v[186:189], 0
    v_mul_f32 v218, v218, v242
    v_mul_f32_dpp v218, v226, v242 quad_perm:[0,1,2,3] row_mask:0x2 bank_mask:0xf
    v_mfma_f32_16x16x32_bf16 v[170:173], a[124:127], v[118:121], v[170:173]
    v_mul_f32_dpp v218, v250, v242 quad_perm:[0,1,2,3] row_mask:0x4 bank_mask:0xf
    v_cvt_pk_bf16_f32 v218, v218, v218
    v_mfma_f32_16x16x32_bf16 v[170:173], a[128:131], v[234:237], v[170:173]
    ds_write_b16 v7, v218
    v_mfma_f32_16x16x32_bf16 v[170:173], a[132:135], v[158:161], v[170:173]
    v_fmac_f32 v219, v115, v115
    v_fmac_f32 v219, v116, v116
    v_mfma_f32_16x16x32_bf16 v[170:173], a[136:139], v[182:185], v[170:173]
    v_fmac_f32 v219, v117, v117
    v_fmac_f32 v219, v166, v166
    v_mfma_f32_16x16x32_bf16 v[170:173], a[140:143], v[206:209], v[170:173]
    v_fmac_f32 v219, v167, v167
    v_fmac_f32 v219, v168, v168
    v_mfma_f32_16x16x32_bf16 v[142:145], a[0:3], v[186:189], 0
    v_fmac_f32 v219, v169, v169
    v_fmac_f32 v219, v230, v230
    v_mfma_f32_16x16x32_bf16 v[142:145], a[4:7], v[118:121], v[142:145]
    v_fmac_f32 v219, v231, v231
    v_fmac_f32 v219, v232, v232
    v_mfma_f32_16x16x32_bf16 v[142:145], a[8:11], v[234:237], v[142:145]
    v_fmac_f32 v219, v233, v233
    v_cvt_pk_bf16_f32 v254, v254, v219
    v_mfma_f32_16x16x32_bf16 v[142:145], a[12:15], v[158:161], v[142:145]
    ds_write_b64 v4, v[254:255] offset:18432
    v_mfma_f32_16x16x32_bf16 v[142:145], a[16:19], v[182:185], v[142:145]
    v_fma_f32 v174, v130, v130, s32
    v_fmac_f32 v174, v131, v131
    v_mfma_f32_16x16x32_bf16 v[142:145], a[20:23], v[206:209], v[142:145]
    v_fmac_f32 v174, v132, v132
    v_fmac_f32 v174, v133, v133
    v_mfma_f32_16x16x32_bf16 v[126:129], a[24:27], v[186:189], 0
    v_xor_b32 v2, 65536, v2
    v_xor_b32 v3, 65536, v3
    v_mfma_f32_16x16x32_bf16 v[126:129], a[28:31], v[118:121], v[126:129]
    v_xor_b32 v4, 65536, v4
    v_add_u32 v5, s74, v5
    v_mfma_f32_16x16x32_bf16 v[126:129], a[32:35], v[234:237], v[126:129]
    v_add_u32 v6, s75, v6
    v_add_u32 v7, s76, v7
    v_mfma_f32_16x16x32_bf16 v[126:129], a[36:39], v[158:161], v[126:129]
    v_mfma_f32_16x16x32_bf16 v[126:129], a[40:43], v[182:185], v[126:129]
    s_waitcnt lgkmcnt(0)
    s_nop 0
    s_nop 0
    s_nop 0
    s_barrier
    v_mfma_f32_16x16x32_bf16 v[126:129], a[44:47], v[206:209], v[126:129]
    s_cbranch_scc1 L_loop_safe3
L_final_safe:
    v_mfma_f32_16x16x32_bf16 v[146:149], a[48:51], v[186:189], 0
    s_mov_b32 s12, s40
    ds_read_b128 v[178:181], v2 offset:18432
    ds_read_b128 v[190:193], v2 offset:19456
    v_mfma_f32_16x16x32_bf16 v[146:149], a[52:55], v[118:121], v[146:149]
    s_mov_b32 s13, s41
    v_fmac_f32 v174, v134, v134
    v_fmac_f32 v174, v135, v135
    v_mfma_f32_16x16x32_bf16 v[146:149], a[56:59], v[234:237], v[146:149]
    s_mov_b32 s14, s36
    v_fmac_f32 v174, v136, v136
    v_fmac_f32 v174, v137, v137
    v_mfma_f32_16x16x32_bf16 v[146:149], a[60:63], v[158:161], v[146:149]
    s_add_u32 s48, s40, s27
    v_fmac_f32 v174, v170, v170
    v_fmac_f32 v174, v171, v171
    v_mfma_f32_16x16x32_bf16 v[146:149], a[64:67], v[182:185], v[146:149]
    s_addc_u32 s49, s41, 0
    v_fmac_f32 v174, v172, v172
    v_fmac_f32 v174, v173, v173
    v_mfma_f32_16x16x32_bf16 v[146:149], a[68:71], v[206:209], v[146:149]
    s_sub_u32 s50, s36, s27
    v_fma_f32 v254, v142, v142, s32
    v_fmac_f32 v254, v143, v143
    v_mfma_f32_16x16x32_bf16 v[194:197], v[186:189], a[144:147], 0
    s_mov_b32 s51, 0x00020000
    v_fmac_f32 v254, v144, v144
    v_fmac_f32 v254, v145, v145
    v_mfma_f32_16x16x32_bf16 v[194:197], v[118:121], a[148:151], v[194:197]
    s_waitcnt lgkmcnt(0)
    v_fmac_f32 v254, v126, v126
    v_fmac_f32 v254, v127, v127
    v_mfma_f32_16x16x32_bf16 v[198:201], v[32:35], v[178:181], 0
    s_add_u32 s52, s40, s26
    v_fmac_f32 v254, v128, v128
    v_fmac_f32 v254, v129, v129
    v_mfma_f32_16x16x32_bf16 v[198:201], v[32:35], v[190:193], v[198:201]
    s_addc_u32 s53, s41, 0
    v_fmac_f32 v254, v146, v146
    v_fmac_f32 v254, v147, v147
    v_mfma_f32_16x16x32_bf16 v[194:197], v[234:237], a[152:155], v[194:197]
    s_sub_u32 s54, s36, s26
    v_fmac_f32 v254, v148, v148
    v_fmac_f32 v254, v149, v149
    v_mfma_f32_16x16x32_bf16 v[194:197], v[158:161], a[156:159], v[194:197]
    s_mov_b32 s55, 0x00020000
    v_mul_f32 v199, 0x3baaaaab, v199
    v_mul_f32 v255, 0x3baaaaab, v198
    v_mfma_f32_16x16x32_bf16 v[194:197], v[182:185], a[160:163], v[194:197]
    s_add_u32 s56, s40, s25
    v_rsq_f32 v199, v199
    v_mfma_f32_16x16x32_bf16 v[194:197], v[206:209], a[164:167], v[194:197]
    s_addc_u32 s57, s41, 0
    v_mul_f32 v114, v199, v114
    v_mul_f32 v115, v199, v115
    v_mfma_f32_16x16x32_bf16 v[190:193], v[186:189], a[168:171], 0
    s_sub_u32 s58, s36, s25
    v_cvt_pk_bf16_f32 v178, v114, v115
    v_mul_f32 v116, v199, v116
    v_mfma_f32_16x16x32_bf16 v[190:193], v[118:121], a[172:175], v[190:193]
    s_mov_b32 s59, 0x00020000
    v_mul_f32 v117, v199, v117
    v_cvt_pk_bf16_f32 v179, v116, v117
    v_mfma_f32_16x16x32_bf16 v[190:193], v[234:237], a[176:179], v[190:193]
    s_and_b32 s6, s2, 7
    v_mul_f32 v166, v199, v166
    v_mul_f32 v167, v199, v167
    v_mfma_f32_16x16x32_bf16 v[190:193], v[158:161], a[180:183], v[190:193]
    s_sub_u32 s6, 0, s6
    v_cvt_pk_bf16_f32 v180, v166, v167
    v_mul_f32 v168, v199, v168
    v_mfma_f32_16x16x32_bf16 v[190:193], v[182:185], a[184:187], v[190:193]
    s_lshl_b32 s3, s16, 6
    ds_read_b128 v[114:117], v0 offset:26624
    v_mul_f32 v169, v199, v169
    v_mfma_f32_16x16x32_bf16 v[190:193], v[206:209], a[188:191], v[190:193]
    s_lshl_b32 s4, s16, 5
    ds_read_b128 v[210:213], v1 offset:26624
    v_cvt_pk_bf16_f32 v181, v168, v169
    v_mfma_f32_16x16x32_bf16 v[166:169], v[186:189], a[192:195], 0
    s_add_u32 s4, s4, 256
    ds_read_b128 v[186:189], v0 offset:26752
    buffer_store_dwordx4 v[178:181], v16, s[48:51], 0 offen nt
    v_mul_f32 v230, v199, v230
    v_mul_f32 v231, v199, v231
    v_cvt_pk_bf16_f32 v198, v230, v231
    v_mul_f32 v232, v199, v232
    v_mfma_f32_16x16x32_bf16 v[166:169], v[118:121], a[196:199], v[166:169]
    s_mul_i32 s5, s16, 9408
    ds_read_b128 v[118:121], v1 offset:26752
    v_mul_f32 v233, v199, v233
    v_mfma_f32_16x16x32_bf16 v[166:169], v[234:237], a[200:203], v[166:169]
    s_add_u32 s5, s5, 104448
    ds_read_b128 v[234:237], v0 offset:26880
    v_cvt_pk_bf16_f32 v199, v232, v233
    v_mfma_f32_16x16x32_bf16 v[166:169], v[158:161], a[204:207], v[166:169]
    ds_read_b128 v[158:161], v1 offset:26880
    v_cvt_pk_bf16_f32 v36, v254, v174
    v_mfma_f32_16x16x32_bf16 v[166:169], v[182:185], a[208:211], v[166:169]
    s_waitcnt lgkmcnt(5)
    v_rsq_f32 v255, v255
    v_mfma_f32_16x16x32_bf16 v[182:185], v[32:35], v[36:39], 0
    s_waitcnt lgkmcnt(4)
    v_mul_f32 v122, v255, v122
    v_mul_f32 v123, v255, v123
    v_mfma_f32_16x16x32_bf16 v[166:169], v[206:209], a[212:215], v[166:169]
    s_waitcnt lgkmcnt(3)
    v_cvt_pk_bf16_f32 v122, v122, v123
    v_mul_f32 v124, v255, v124
    v_mfma_f32_16x16x32_bf16 v[206:209], a[72:75], v[114:117], 0
    v_mul_f32 v125, v255, v125
    v_cvt_pk_bf16_f32 v123, v124, v125
    v_mfma_f32_16x16x32_bf16 v[206:209], a[76:79], v[210:213], v[206:209]
    s_waitcnt lgkmcnt(2)
    v_mul_f32 v154, v255, v154
    v_mul_f32 v155, v255, v155
    v_mfma_f32_16x16x32_bf16 v[206:209], a[80:83], v[186:189], v[206:209]
    s_waitcnt lgkmcnt(1)
    ds_read_b128 v[214:217], v2 offset:0
    ds_read_b128 v[230:233], v2 offset:1024
    v_mfma_f32_16x16x32_bf16 v[206:209], a[84:87], v[118:121], v[206:209]
    s_waitcnt lgkmcnt(2)
    ds_read_b128 v[222:225], v2 offset:2048
    ds_read_b128 v[174:177], v2 offset:3072
    v_mfma_f32_16x16x32_bf16 v[206:209], a[88:91], v[234:237], v[206:209]
    v_cvt_pk_bf16_f32 v124, v154, v155
    v_mul_f32 v156, v255, v156
    v_mfma_f32_16x16x32_bf16 v[206:209], a[92:95], v[158:161], v[206:209]
    ds_read_b128 v[178:181], v2 offset:4096
    ds_read_b128 v[226:229], v2 offset:5120
    v_mfma_f32_16x16x32_bf16 v[218:221], a[96:99], v[114:117], 0
    v_mul_f32 v157, v255, v157
    v_cvt_pk_bf16_f32 v125, v156, v157
    v_mfma_f32_16x16x32_bf16 v[218:221], a[100:103], v[210:213], v[218:221]
    v_mul_f32 v202, v255, v202
    v_mul_f32 v203, v255, v203
    v_mfma_f32_16x16x32_bf16 v[218:221], a[104:107], v[186:189], v[218:221]
    v_cvt_pk_bf16_f32 v254, v202, v203
    v_mul_f32 v204, v255, v204
    v_mfma_f32_16x16x32_bf16 v[218:221], a[108:111], v[118:121], v[218:221]
    s_waitcnt lgkmcnt(4)
    buffer_store_dwordx2 v[198:199], v19, s[48:51], 0 offen nt
    v_mul_f32 v205, v255, v205
    v_cvt_pk_bf16_f32 v255, v204, v205
    v_mfma_f32_16x16x32_bf16 v[202:205], a[216:219], v[214:217], 0
    s_waitcnt lgkmcnt(2)
    v_rsq_f32 v183, v183
    v_mfma_f32_16x16x32_bf16 v[202:205], a[220:223], v[230:233], v[202:205]
    v_rsq_f32 v182, v182
    v_mfma_f32_16x16x32_bf16 v[202:205], a[224:227], v[222:225], v[202:205]
    s_waitcnt lgkmcnt(0)
    v_mul_f32 v182, s31, v182
    v_cvt_pk_bf16_f32 v194, v194, v195
    v_mfma_f32_16x16x32_bf16 v[202:205], a[228:231], v[174:177], v[202:205]
    v_cvt_pk_bf16_f32 v195, v196, v197
    v_cvt_pk_bf16_f32 v190, v190, v191
    v_mfma_f32_16x16x32_bf16 v[202:205], a[232:235], v[178:181], v[202:205]
    v_cvt_pk_bf16_f32 v191, v192, v193
    v_cvt_pk_bf16_f32 v166, v166, v167
    v_mfma_f32_16x16x32_bf16 v[202:205], a[236:239], v[226:229], v[202:205]
    v_cvt_pk_bf16_f32 v167, v168, v169
    v_mul_f32 v130, v183, v130
    v_mfma_f32_16x16x32_bf16 v[154:157], a[240:243], v[214:217], 0
    v_mul_f32 v131, v183, v131
    v_cvt_pk_f16_f32 v130, v130, v131
    v_mfma_f32_16x16x32_bf16 v[154:157], a[244:247], v[230:233], v[154:157]
    v_mul_f32 v132, v183, v132
    v_mul_f32 v133, v183, v133
    v_mfma_f32_16x16x32_bf16 v[154:157], a[248:251], v[222:225], v[154:157]
    v_fma_f32 v168, v202, v202, s33
    v_fmac_f32 v168, v203, v203
    v_mfma_f32_16x16x32_bf16 v[154:157], a[252:255], v[174:177], v[154:157]
    v_fmac_f32 v168, v204, v204
    v_fmac_f32 v168, v205, v205
    v_mfma_f32_16x16x32_bf16 v[154:157], v[82:85], v[178:181], v[154:157]
    v_cvt_pk_f16_f32 v131, v132, v133
    v_mul_f32 v134, v183, v134
    v_mfma_f32_16x16x32_bf16 v[154:157], v[86:89], v[226:229], v[154:157]
    v_mul_f32 v135, v183, v135
    v_cvt_pk_f16_f32 v132, v134, v135
    v_mfma_f32_16x16x32_bf16 v[238:241], v[90:93], v[214:217], 0
    ds_read_b128 v[214:217], v2 offset:6144
    v_mul_f32 v136, v183, v136
    v_mfma_f32_16x16x32_bf16 v[238:241], v[94:97], v[230:233], v[238:241]
    ds_read_b128 v[230:233], v2 offset:7168
    v_mul_f32 v137, v183, v137
    v_mfma_f32_16x16x32_bf16 v[238:241], v[98:101], v[222:225], v[238:241]
    ds_read_b128 v[222:225], v2 offset:8192
    v_fmac_f32 v168, v154, v154
    v_mfma_f32_16x16x32_bf16 v[238:241], v[102:105], v[174:177], v[238:241]
    ds_read_b128 v[174:177], v2 offset:9216
    buffer_store_dwordx4 v[122:125], v15, s[48:51], 0 offen nt
    v_fmac_f32 v168, v155, v155
    v_fmac_f32 v168, v156, v156
    v_fmac_f32 v168, v157, v157
    v_cvt_pk_f16_f32 v133, v136, v137
    v_mfma_f32_16x16x32_bf16 v[238:241], v[106:109], v[178:181], v[238:241]
    ds_read_b128 v[178:181], v2 offset:10240
    v_mul_f32 v170, v183, v170
    v_mfma_f32_16x16x32_bf16 v[238:241], v[110:113], v[226:229], v[238:241]
    ds_read_b128 v[134:137], v2 offset:11264
    v_mul_f32 v171, v183, v171
    v_mfma_f32_16x16x32_bf16 v[218:221], a[112:115], v[234:237], v[218:221]
    s_waitcnt lgkmcnt(5)
    v_cvt_pk_f16_f32 v124, v170, v171
    v_mul_f32 v172, v183, v172
    v_mfma_f32_16x16x32_bf16 v[226:229], a[216:219], v[214:217], 0
    s_waitcnt lgkmcnt(4)
    v_fmac_f32 v168, v238, v238
    v_fmac_f32 v168, v239, v239
    v_mfma_f32_16x16x32_bf16 v[226:229], a[220:223], v[230:233], v[226:229]
    s_waitcnt lgkmcnt(3)
    v_fmac_f32 v168, v240, v240
    v_fmac_f32 v168, v241, v241
    v_mfma_f32_16x16x32_bf16 v[226:229], a[224:227], v[222:225], v[226:229]
    s_waitcnt lgkmcnt(2)
    v_mul_f32 v173, v183, v173
    v_cvt_pk_f16_f32 v125, v172, v173
    v_mfma_f32_16x16x32_bf16 v[226:229], a[228:231], v[174:177], v[226:229]
    v_mul_f32 v142, v182, v142
    v_mul_f32 v143, v182, v143
    v_mfma_f32_16x16x32_bf16 v[170:173], a[240:243], v[214:217], 0
    s_waitcnt lgkmcnt(1)
    v_cvt_pk_f16_f32 v142, v142, v143
    v_mul_f32 v144, v182, v144
    v_mfma_f32_16x16x32_bf16 v[226:229], a[232:235], v[178:181], v[226:229]
    s_waitcnt lgkmcnt(0)
    v_mul_f32 v145, v182, v145
    v_cvt_pk_f16_f32 v143, v144, v145
    v_mfma_f32_16x16x32_bf16 v[226:229], a[236:239], v[134:137], v[226:229]
    v_mul_f32 v126, v182, v126
    v_mul_f32 v127, v182, v127
    v_mfma_f32_16x16x32_bf16 v[170:173], a[244:247], v[230:233], v[170:173]
    v_cvt_pk_f16_f32 v144, v126, v127
    v_mul_f32 v128, v182, v128
    v_mfma_f32_16x16x32_bf16 v[170:173], a[248:251], v[222:225], v[170:173]
    v_mul_f32 v129, v182, v129
    v_cvt_pk_f16_f32 v145, v128, v129
    v_mfma_f32_16x16x32_bf16 v[170:173], a[252:255], v[174:177], v[170:173]
    v_mul_f32 v146, v182, v146
    v_mul_f32 v147, v182, v147
    v_mfma_f32_16x16x32_bf16 v[170:173], v[82:85], v[178:181], v[170:173]
    v_cvt_pk_f16_f32 v122, v146, v147
    v_mul_f32 v148, v182, v148
    v_mfma_f32_16x16x32_bf16 v[170:173], v[86:89], v[134:137], v[170:173]
    v_mul_f32 v149, v182, v149
    v_cvt_pk_f16_f32 v123, v148, v149
    v_mfma_f32_16x16x32_bf16 v[146:149], v[90:93], v[214:217], 0
    buffer_store_dwordx2 v[254:255], v18, s[48:51], 0 offen nt
    v_mov_b32 v198, 0x40000000
    v_fma_f32 v169, v206, v206, s32
    v_mfma_f32_16x16x32_bf16 v[146:149], v[94:97], v[230:233], v[146:149]
    v_fmac_f32 v169, v207, v207
    v_fmac_f32 v169, v208, v208
    v_mfma_f32_16x16x32_bf16 v[146:149], v[98:101], v[222:225], v[146:149]
    v_fmac_f32 v169, v209, v209
    v_fma_f32 v192, v226, v226, s33
    v_mfma_f32_16x16x32_bf16 v[146:149], v[102:105], v[174:177], v[146:149]
    v_fmac_f32 v192, v227, v227
    v_fmac_f32 v192, v228, v228
    v_mfma_f32_16x16x32_bf16 v[146:149], v[106:109], v[178:181], v[146:149]
    v_fmac_f32 v192, v229, v229
    v_fmac_f32 v192, v170, v170
    v_mfma_f32_16x16x32_bf16 v[146:149], v[110:113], v[134:137], v[146:149]
    v_fmac_f32 v192, v171, v171
    v_fmac_f32 v192, v172, v172
    v_mfma_f32_16x16x32_bf16 v[218:221], a[116:119], v[158:161], v[218:221]
    v_fmac_f32 v192, v173, v173
    v_mul_f32 v193, 0x3baaaaab, v200
    v_mfma_f32_16x16x32_bf16 v[126:129], a[120:123], v[114:117], 0
    v_rsq_f32 v193, v193
    v_mfma_f32_16x16x32_bf16 v[126:129], a[124:127], v[210:213], v[126:129]
    v_fmac_f32 v192, v146, v146
    v_fmac_f32 v192, v147, v147
    v_mfma_f32_16x16x32_bf16 v[126:129], a[128:131], v[186:189], v[126:129]
    v_fmac_f32 v169, v218, v218
    v_fmac_f32 v169, v219, v219
    v_mfma_f32_16x16x32_bf16 v[126:129], a[132:135], v[118:121], v[126:129]
    v_fmac_f32 v169, v220, v220
    v_fmac_f32 v169, v221, v221
    v_mfma_f32_16x16x32_bf16 v[126:129], a[136:139], v[234:237], v[126:129]
    v_fmac_f32 v192, v148, v148
    v_fmac_f32 v192, v149, v149
    v_mfma_f32_16x16x32_bf16 v[126:129], a[140:143], v[158:161], v[126:129]
    v_cvt_pk_bf16_f32 v254, v168, v192
    v_cvt_pk_bf16_f32 v255, v192, v192
    v_mfma_f32_16x16x32_bf16 v[134:137], a[0:3], v[114:117], 0
    v_mul_f32 v150, v193, v150
    v_mul_f32 v151, v193, v151
    v_mfma_f32_16x16x32_bf16 v[134:137], a[4:7], v[210:213], v[134:137]
    v_cvt_pk_bf16_f32 v150, v150, v151
    v_mul_f32 v152, v193, v152
    v_mfma_f32_16x16x32_bf16 v[134:137], a[8:11], v[186:189], v[134:137]
    v_fmac_f32 v169, v126, v126
    v_fmac_f32 v169, v127, v127
    v_mfma_f32_16x16x32_bf16 v[134:137], a[12:15], v[118:121], v[134:137]
    v_fmac_f32 v169, v128, v128
    v_fmac_f32 v169, v129, v129
    v_mfma_f32_16x16x32_bf16 v[134:137], a[16:19], v[234:237], v[134:137]
    v_mul_f32 v153, v193, v153
    v_cvt_pk_bf16_f32 v151, v152, v153
    v_mfma_f32_16x16x32_bf16 v[134:137], a[20:23], v[158:161], v[134:137]
    v_mul_f32 v162, v193, v162
    v_mul_f32 v163, v193, v163
    v_mfma_f32_16x16x32_bf16 v[230:233], a[24:27], v[114:117], 0
    v_cvt_pk_bf16_f32 v152, v162, v163
    v_mul_f32 v164, v193, v164
    v_mfma_f32_16x16x32_bf16 v[230:233], a[28:31], v[210:213], v[230:233]
    v_mul_f32 v165, v193, v165
    v_cvt_pk_bf16_f32 v153, v164, v165
    v_mfma_f32_16x16x32_bf16 v[230:233], a[32:35], v[186:189], v[230:233]
    buffer_store_dwordx4 v[150:153], v17, s[48:51], 0 offen nt
    v_fma_f32 v168, v134, v134, s32
    v_fmac_f32 v168, v135, v135
    v_fmac_f32 v168, v136, v136
    v_fmac_f32 v168, v137, v137
    v_mfma_f32_16x16x32_bf16 v[230:233], a[36:39], v[118:121], v[230:233]
    v_mul_f32 v138, v193, v138
    v_mul_f32 v139, v193, v139
    v_mfma_f32_16x16x32_bf16 v[230:233], a[40:43], v[234:237], v[230:233]
    v_cvt_pk_bf16_f32 v196, v138, v139
    v_mul_f32 v140, v193, v140
    v_mfma_f32_16x16x32_bf16 v[230:233], a[44:47], v[158:161], v[230:233]
    v_mul_f32 v141, v193, v141
    v_cvt_pk_bf16_f32 v197, v140, v141
    v_mfma_f32_16x16x32_bf16 v[138:141], a[48:51], v[114:117], 0
    v_bfe_u32 v201, v2, 4, 6
    v_lshrrev_b32 v199, 4, v201
    v_mfma_f32_16x16x32_bf16 v[138:141], a[52:55], v[210:213], v[138:141]
    v_and_b32 v150, 15, v201
    v_add_u32 v192, 0, v150
    v_mfma_f32_16x16x32_bf16 v[138:141], a[56:59], v[186:189], v[138:141]
    v_mul_u32_u24 v200, s20, v192
    v_add_u32 v200, s38, v200
    v_mfma_f32_16x16x32_bf16 v[138:141], a[60:63], v[118:121], v[138:141]
    v_mul_u32_u24 v193, 911, v200
    v_lshrrev_b32 v193, 16, v193
    v_mfma_f32_16x16x32_bf16 v[138:141], a[64:67], v[234:237], v[138:141]
    v_mul_u32_u24 v193, s22, v193
    v_mad_u32_u24 v193, v192, s21, v193
    v_mfma_f32_16x16x32_bf16 v[138:141], a[68:71], v[158:161], v[138:141]
    v_bfe_u32 v200, s63, v192, 1
    v_cmp_ne_u32 vcc, 0, v200
    v_mfma_f32_16x16x32_bf16 v[162:165], v[114:117], a[144:147], 0
    v_add_u32 v200, s7, v193
    v_cndmask_b32 v200, v198, v200, vcc
    v_mfma_f32_16x16x32_bf16 v[162:165], v[210:213], a[148:151], v[162:165]
    v_lshl_add_u32 v151, v199, 4, v200
    v_add_u32 v151, s3, v151
    v_mfma_f32_16x16x32_bf16 v[162:165], v[186:189], a[152:155], v[162:165]
    v_lshl_add_u32 v200, v199, 3, v200
    v_add_u32 v200, s4, v200
    v_mfma_f32_16x16x32_bf16 v[162:165], v[118:121], a[156:159], v[162:165]
    v_fmac_f32 v168, v230, v230
    v_fmac_f32 v168, v231, v231
    v_mfma_f32_16x16x32_bf16 v[162:165], v[234:237], a[160:163], v[162:165]
    v_fmac_f32 v168, v232, v232
    v_fmac_f32 v168, v233, v233
    v_mfma_f32_16x16x32_bf16 v[162:165], v[158:161], a[164:167], v[162:165]
    v_fmac_f32 v168, v138, v138
    v_fmac_f32 v168, v139, v139
    v_mfma_f32_16x16x32_bf16 v[178:181], v[114:117], a[168:171], 0
    buffer_store_dwordx2 v[196:197], v20, s[48:51], 0 offen nt
    v_fmac_f32 v168, v140, v140
    v_fmac_f32 v168, v141, v141
    v_mfma_f32_16x16x32_bf16 v[178:181], v[210:213], a[172:175], v[178:181]
    v_cvt_pk_bf16_f32 v36, v168, v169
    v_cvt_pk_bf16_f32 v196, v162, v163
    v_mfma_f32_16x16x32_bf16 v[178:181], v[186:189], a[176:179], v[178:181]
    v_cvt_pk_bf16_f32 v197, v164, v165
    v_lshlrev_b32 v152, 9, v199
    v_mfma_f32_16x16x32_bf16 v[182:185], v[32:35], v[36:39], 0
    v_lshl_add_u32 v152, v150, 4, v152
    v_add_u32 v152, 149696, v152
    v_mfma_f32_16x16x32_bf16 v[178:181], v[118:121], a[180:183], v[178:181]
    v_and_b32 v153, 0xffff, v2
    v_add_u32 v153, 38912, v153
    v_mfma_f32_16x16x32_bf16 v[178:181], v[234:237], a[184:187], v[178:181]
    ds_read_b128 v[174:177], v0 offset:32768
    v_and_b32 v214, 0xffff, v4
    v_mfma_f32_16x16x32_bf16 v[178:181], v[158:161], a[188:191], v[178:181]
    ds_read_b128 v[162:165], v1 offset:32768
    v_add_u32 v214, 38912, v214
    v_mfma_f32_16x16x32_bf16 v[222:225], v[114:117], a[192:195], 0
    ds_read_b128 v[114:117], v0 offset:32896
    v_sub_u32 v215, 0x40800000, v44
    v_mfma_f32_16x16x32_bf16 v[222:225], v[210:213], a[196:199], v[222:225]
    ds_read_b128 v[210:213], v1 offset:32896
    v_or_b32 v215, v215, v44
    v_mfma_f32_16x16x32_bf16 v[222:225], v[186:189], a[200:203], v[222:225]
    ds_read_b128 v[186:189], v0 offset:33024
    v_cvt_pk_bf16_f32 v192, v178, v179
    v_mfma_f32_16x16x32_bf16 v[222:225], v[118:121], a[204:207], v[222:225]
    ds_read_b128 v[118:121], v1 offset:33024
    v_cvt_pk_bf16_f32 v193, v180, v181
    v_mfma_f32_16x16x32_bf16 v[222:225], v[234:237], a[208:211], v[222:225]
    ds_write_b64 v214, v[254:255] offset:0
    v_mfma_f32_16x16x32_bf16 v[222:225], v[158:161], a[212:215], v[222:225]
    s_waitcnt lgkmcnt(6)
    v_rsq_f32 v183, v183
    v_mfma_f32_16x16x32_bf16 v[158:161], a[72:75], v[174:177], 0
    s_waitcnt lgkmcnt(5)
    v_rsq_f32 v182, v182
    v_mfma_f32_16x16x32_bf16 v[158:161], a[76:79], v[162:165], v[158:161]
    s_waitcnt lgkmcnt(4)
    v_mul_f32 v182, s31, v182
    v_cvt_pk_bf16_f32 v168, v222, v223
    v_mfma_f32_16x16x32_bf16 v[158:161], a[80:83], v[114:117], v[158:161]
    s_waitcnt lgkmcnt(3)
    v_cvt_pk_bf16_f32 v169, v224, v225
    v_mul_f32 v206, v183, v206
    v_mfma_f32_16x16x32_bf16 v[158:161], a[84:87], v[210:213], v[158:161]
    s_waitcnt lgkmcnt(2)
    v_mul_f32 v207, v183, v207
    v_cvt_pk_f16_f32 v178, v206, v207
    v_mfma_f32_16x16x32_bf16 v[158:161], a[88:91], v[186:189], v[158:161]
    s_waitcnt lgkmcnt(1)
    v_mul_f32 v208, v183, v208
    v_mul_f32 v209, v183, v209
    v_mfma_f32_16x16x32_bf16 v[158:161], a[92:95], v[118:121], v[158:161]
    s_waitcnt lgkmcnt(0)
    v_cvt_pk_f16_f32 v179, v208, v209
    v_mul_f32 v218, v183, v218
    v_mfma_f32_16x16x32_bf16 v[206:209], a[96:99], v[174:177], 0
    s_barrier
    ds_read_b128 v[222:225], v153 offset:0
    ds_read_b128 v[234:237], v153 offset:1024
    v_mfma_f32_16x16x32_bf16 v[206:209], a[100:103], v[162:165], v[206:209]
    v_mul_f32 v219, v183, v219
    v_cvt_pk_f16_f32 v180, v218, v219
    v_mfma_f32_16x16x32_bf16 v[206:209], a[104:107], v[114:117], v[206:209]
    v_mul_f32 v220, v183, v220
    v_mul_f32 v221, v183, v221
    v_mfma_f32_16x16x32_bf16 v[206:209], a[108:111], v[210:213], v[206:209]
    v_cvt_pk_f16_f32 v181, v220, v221
    v_mul_f32 v126, v183, v126
    v_mfma_f32_16x16x32_bf16 v[206:209], a[112:115], v[186:189], v[206:209]
    v_mul_f32 v127, v183, v127
    v_cvt_pk_f16_f32 v220, v126, v127
    v_mfma_f32_16x16x32_bf16 v[206:209], a[116:119], v[118:121], v[206:209]
    v_mul_f32 v128, v183, v128
    v_mul_f32 v129, v183, v129
    v_mfma_f32_16x16x32_bf16 v[242:245], a[120:123], v[174:177], 0
    v_cvt_pk_f16_f32 v221, v128, v129
    v_mul_f32 v134, v182, v134
    v_mfma_f32_16x16x32_bf16 v[242:245], a[124:127], v[162:165], v[242:245]
    s_waitcnt lgkmcnt(0)
    v_mul_f32 v135, v182, v135
    v_cvt_pk_f16_f32 v134, v134, v135
    v_mfma_f32_16x16x32_bf16 v[126:129], v[32:35], v[222:225], 0
    v_mul_f32 v136, v182, v136
    v_mul_f32 v137, v182, v137
    v_mfma_f32_16x16x32_bf16 v[126:129], v[32:35], v[234:237], v[126:129]
    v_cvt_pk_f16_f32 v135, v136, v137
    v_mul_f32 v230, v182, v230
    v_mfma_f32_16x16x32_bf16 v[242:245], a[128:131], v[114:117], v[242:245]
    v_mul_f32 v231, v182, v231
    v_cvt_pk_f16_f32 v136, v230, v231
    v_mfma_f32_16x16x32_bf16 v[242:245], a[132:135], v[210:213], v[242:245]
    v_mul_f32 v232, v182, v232
    v_mul_f32 v233, v182, v233
    v_mfma_f32_16x16x32_bf16 v[242:245], a[136:139], v[186:189], v[242:245]
    v_mul_f32 v137, 0x3baaaaab, v127
    v_mul_f32 v216, 0x3baaaaab, v126
    v_mfma_f32_16x16x32_bf16 v[242:245], a[140:143], v[118:121], v[242:245]
    v_rsq_f32 v137, v137
    v_mfma_f32_16x16x32_bf16 v[234:237], a[0:3], v[174:177], 0
    v_mul_f32 v226, v137, v226
    v_mul_f32 v227, v137, v227
    v_mfma_f32_16x16x32_bf16 v[234:237], a[4:7], v[162:165], v[234:237]
    v_cvt_pk_bf16_f32 v126, v226, v227
    v_mul_f32 v228, v137, v228
    v_mfma_f32_16x16x32_bf16 v[234:237], a[8:11], v[114:117], v[234:237]
    v_mul_f32 v229, v137, v229
    v_cvt_pk_bf16_f32 v127, v228, v229
    v_mfma_f32_16x16x32_bf16 v[234:237], a[12:15], v[210:213], v[234:237]
    v_mul_f32 v170, v137, v170
    v_mul_f32 v171, v137, v171
    v_mfma_f32_16x16x32_bf16 v[234:237], a[16:19], v[186:189], v[234:237]
    v_cvt_pk_bf16_f32 v128, v170, v171
    v_mul_f32 v172, v137, v172
    v_mfma_f32_16x16x32_bf16 v[234:237], a[20:23], v[118:121], v[234:237]
    v_mul_f32 v173, v137, v173
    v_cvt_pk_bf16_f32 v129, v172, v173
    v_mfma_f32_16x16x32_bf16 v[170:173], a[24:27], v[174:177], 0
    buffer_store_dwordx4 v[126:129], v16, s[52:55], 0 offen nt
    v_mul_f32 v146, v137, v146
    v_mul_f32 v147, v137, v147
    v_cvt_pk_bf16_f32 v254, v146, v147
    v_mul_f32 v148, v137, v148
    v_mfma_f32_16x16x32_bf16 v[170:173], a[28:31], v[162:165], v[170:173]
    v_mul_f32 v149, v137, v149
    v_cvt_pk_bf16_f32 v255, v148, v149
    v_mfma_f32_16x16x32_bf16 v[170:173], a[32:35], v[114:117], v[170:173]
    v_rsq_f32 v216, v216
    v_mfma_f32_16x16x32_f16 v[146:149], v[130:133], v[142:145], v[46:49]
    v_mul_f32 v202, v216, v202
    v_mul_f32 v203, v216, v203
    v_mfma_f32_16x16x32_f16 v[126:129], v[178:181], v[142:145], v[50:53]
    v_cvt_pk_bf16_f32 v202, v202, v203
    v_mul_f32 v204, v216, v204
    v_mfma_f32_16x16x32_bf16 v[170:173], a[36:39], v[210:213], v[170:173]
    v_mul_f32 v205, v216, v205
    v_cvt_pk_bf16_f32 v203, v204, v205
    v_mul_f32 v154, v216, v154
    v_mfma_f32_16x16x16_f16 v[146:149], v[124:125], v[122:123], v[146:149]
    v_mul_f32 v155, v216, v155
    v_cvt_pk_bf16_f32 v204, v154, v155
    v_mul_f32 v156, v216, v156
    v_mfma_f32_16x16x16_f16 v[126:129], v[220:221], v[122:123], v[126:129]
    v_mul_f32 v157, v216, v157
    v_cvt_pk_bf16_f32 v205, v156, v157
    v_mul_f32 v238, v216, v238
    v_mul_f32 v239, v216, v239
    v_mfma_f32_16x16x32_bf16 v[170:173], a[40:43], v[186:189], v[170:173]
    v_cvt_pk_bf16_f32 v184, v238, v239
    v_mul_f32 v240, v216, v240
    v_mfma_f32_16x16x32_bf16 v[170:173], a[44:47], v[118:121], v[170:173]
    v_mul_f32 v241, v216, v241
    v_cvt_pk_bf16_f32 v185, v240, v241
    v_mfma_f32_16x16x32_bf16 v[154:157], a[48:51], v[174:177], 0
    v_cvt_pk_f16_f32 v137, v232, v233
    v_mul_f32 v138, v182, v138
    v_mfma_f32_16x16x32_bf16 v[154:157], a[52:55], v[162:165], v[154:157]
    v_mul_f32 v139, v182, v139
    v_cvt_pk_f16_f32 v218, v138, v139
    v_mfma_f32_16x16x32_bf16 v[154:157], a[56:59], v[114:117], v[154:157]
    v_mul_f32 v140, v182, v140
    v_mul_f32 v141, v182, v141
    v_mfma_f32_16x16x32_bf16 v[154:157], a[60:63], v[210:213], v[154:157]
    v_cvt_pk_f16_f32 v219, v140, v141
    v_fma_f32 v183, v234, v234, s32
    v_mfma_f32_16x16x32_bf16 v[154:157], a[64:67], v[186:189], v[154:157]
    v_fmac_f32 v183, v235, v235
    v_fmac_f32 v183, v236, v236
    v_mfma_f32_16x16x32_bf16 v[154:157], a[68:71], v[118:121], v[154:157]
    buffer_store_dwordx2 v[254:255], v19, s[52:55], 0 offen nt
    v_fmac_f32 v183, v237, v237
    v_fmac_f32 v183, v170, v170
    v_mfma_f32_16x16x32_bf16 v[138:141], v[174:177], a[144:147], 0
    v_fmac_f32 v183, v171, v171
    v_fmac_f32 v183, v172, v172
    v_mfma_f32_16x16x32_bf16 v[138:141], v[162:165], a[148:151], v[138:141]
    v_fmac_f32 v183, v173, v173
    v_fmac_f32 v183, v154, v154
    v_mfma_f32_16x16x32_bf16 v[138:141], v[114:117], a[152:155], v[138:141]
    v_fmac_f32 v183, v155, v155
    v_fmac_f32 v183, v156, v156
    v_mfma_f32_16x16x32_bf16 v[138:141], v[210:213], a[156:159], v[138:141]
    v_fmac_f32 v183, v157, v157
    v_fma_f32 v182, v158, v158, s32
    v_mfma_f32_16x16x32_bf16 v[138:141], v[186:189], a[160:163], v[138:141]
    v_fmac_f32 v182, v159, v159
    v_fmac_f32 v182, v160, v160
    v_mfma_f32_16x16x32_bf16 v[138:141], v[118:121], a[164:167], v[138:141]
    v_fmac_f32 v182, v161, v161
    v_fmac_f32 v182, v206, v206
    v_mfma_f32_16x16x32_bf16 v[230:233], v[174:177], a[168:171], 0
    v_fmac_f32 v182, v207, v207
    v_fmac_f32 v182, v208, v208
    v_mfma_f32_16x16x32_bf16 v[230:233], v[162:165], a[172:175], v[230:233]
    ds_read_b128 v[226:229], v5 offset:0
    ds_read_b128 v[238:241], v5 offset:16
    v_mfma_f32_16x16x32_bf16 v[230:233], v[114:117], a[176:179], v[230:233]
    ds_read_b32 v254, v6 offset:192
    v_cvt_pk_bf16_f32 v138, v138, v139
    v_mfma_f32_16x16x32_bf16 v[230:233], v[210:213], a[180:183], v[230:233]
    v_cvt_pk_bf16_f32 v139, v140, v141
    v_fmac_f32 v182, v209, v209
    v_mfma_f32_16x16x32_bf16 v[230:233], v[186:189], a[184:187], v[230:233]
    v_fmac_f32 v182, v242, v242
    v_fmac_f32 v182, v243, v243
    v_mfma_f32_16x16x32_bf16 v[230:233], v[118:121], a[188:191], v[230:233]
    v_fmac_f32 v182, v244, v244
    v_fmac_f32 v182, v245, v245
    v_cvt_pk_bf16_f32 v36, v183, v182
    v_add_u32 v182, 16, v150
    v_min_u32 v183, 20, v182
    v_add_u32 v141, 12, v182
    v_lshrrev_b32 v141, 5, v141
    v_sub_u32 v140, v182, v183
    v_cvt_pk_bf16_f32 v230, v230, v231
    v_cvt_pk_bf16_f32 v231, v232, v233
    v_mad_i32_i24 v140, v141, s6, v140
    v_mul_u32_u24 v255, s20, v183
    v_add3_u32 v255, v255, v140, s38
    buffer_store_dwordx4 v[202:205], v15, s[52:55], 0 offen nt
    ds_read_b128 v[222:225], v2 offset:12288
    v_mul_u32_u24 v141, 911, v255
    v_lshrrev_b32 v141, 16, v141
    v_mul_u32_u24 v141, s22, v141
    v_mad_u32_u24 v141, v183, s21, v141
    v_bfe_u32 v255, s63, v182, 1
    v_cmp_ne_u32 vcc, 0, v255
    v_mul_i32_i24 v140, 2688, v140
    v_add3_u32 v255, v141, v140, s7
    v_mfma_f32_16x16x32_bf16 v[202:205], v[32:35], v[36:39], 0
    v_cndmask_b32 v255, v198, v255, vcc
    v_lshl_add_u32 v217, v199, 4, v255
    v_add_u32 v217, s3, v217
    v_lshl_add_u32 v216, v199, 3, v255
    v_add_u32 v216, s4, v216
    v_xor_b32 v255, 65536, v2
    v_lshl_add_u32 v198, s16, 2, v255
    ds_write_b32 v198, v215 offset:18432
    v_rsq_f32 v203, v203
    v_rsq_f32 v202, v202
    v_mul_f32 v158, v203, v158
    v_mul_f32 v202, s31, v202
    v_mul_f32 v159, v203, v159
    v_cvt_pk_f16_f32 v246, v158, v159
    v_mul_f32 v160, v203, v160
    v_mul_f32 v161, v203, v161
    v_cvt_pk_f16_f32 v247, v160, v161
    v_mfma_f32_16x16x32_bf16 v[250:253], v[174:177], a[192:195], 0
    s_waitcnt lgkmcnt(1)
    ds_read_b128 v[174:177], v2 offset:13312
    v_mul_f32 v206, v203, v206
    v_mfma_f32_16x16x32_bf16 v[250:253], v[162:165], a[196:199], v[250:253]
    ds_read_b128 v[158:161], v2 offset:14336
    v_mul_f32 v207, v203, v207
    v_mfma_f32_16x16x32_bf16 v[250:253], v[114:117], a[200:203], v[250:253]
    ds_read_b128 v[162:165], v2 offset:15360
    v_cvt_pk_f16_f32 v248, v206, v207
    v_mfma_f32_16x16x32_bf16 v[250:253], v[210:213], a[204:207], v[250:253]
    ds_read_b128 v[114:117], v2 offset:16384
    v_mul_f32 v208, v203, v208
    v_mfma_f32_16x16x32_bf16 v[250:253], v[186:189], a[208:211], v[250:253]
    ds_read_b128 v[210:213], v2 offset:17408
    v_mul_f32 v209, v203, v209
    v_mfma_f32_16x16x32_bf16 v[250:253], v[118:121], a[212:215], v[250:253]
    ds_read_b128 v[118:121], v5 offset:48
    v_cvt_pk_f16_f32 v249, v208, v209
    ds_read2_b32 v[140:141], v6 offset0:0 offset1:0
    v_mul_f32 v242, v203, v242
    buffer_store_dwordx2 v[184:185], v18, s[52:55], 0 offen nt
    ds_read2_b32 v[232:233], v6 offset0:16 offset1:16
    v_mul_f32 v243, v203, v243
    v_cvt_pk_f16_f32 v208, v242, v243
    v_cvt_pk_bf16_f32 v186, v250, v251
    ds_read2_b32 v[188:189], v6 offset0:32 offset1:32
    v_cvt_pk_bf16_f32 v187, v252, v253
    v_mul_f32 v244, v203, v244
    v_mul_f32 v245, v203, v245
    v_cvt_pk_f16_f32 v209, v244, v245
    v_mul_f32 v234, v202, v234
    v_mul_f32 v235, v202, v235
    v_cvt_pk_f16_f32 v242, v234, v235
    v_mfma_f32_16x16x32_f16 v[182:185], v[226:229], v[142:145], v[22:25]
    s_waitcnt lgkmcnt(4)
    v_mul_f32 v236, v202, v236
    v_mul_f32 v237, v202, v237
    v_mfma_f32_16x16x32_f16 v[182:185], v[238:241], v[130:133], v[182:185]
    s_waitcnt lgkmcnt(3)
    v_cvt_pk_f16_f32 v243, v236, v237
    v_mul_f32 v170, v202, v170
    v_mfma_f32_16x16x32_f16 v[182:185], v[118:121], v[122:125], v[182:185]
    v_mul_f32 v171, v202, v171
    v_cvt_pk_f16_f32 v244, v170, v171
    v_mfma_f32_16x16x32_f16 v[234:237], v[226:229], v[134:137], v[24:27]
    s_waitcnt lgkmcnt(1)
    v_mul_f32 v172, v202, v172
    v_mul_f32 v173, v202, v173
    v_mfma_f32_16x16x32_f16 v[234:237], v[238:241], v[178:181], v[234:237]
    s_waitcnt lgkmcnt(0)
    v_mov_b32_dpp v254, v183 quad_perm:[0,1,2,3] row_mask:0x1 bank_mask:0xf
    v_cvt_pk_f16_f32 v245, v172, v173
    v_mfma_f32_16x16x32_f16 v[234:237], v[118:121], v[218:221], v[234:237]
    v_mul_f32 v154, v202, v154
    v_mul_f32 v155, v202, v155
    v_mfma_f32_16x16x32_f16 v[170:173], v[246:249], v[142:145], v[54:57]
    v_cvt_pk_f16_f32 v206, v154, v155
    v_mul_f32 v156, v202, v156
    v_mfma_f32_16x16x32_f16 v[142:145], v[226:229], v[242:245], v[26:29]
    v_mul_f32 v157, v202, v157
    v_cvt_pk_f16_f32 v207, v156, v157
    v_mfma_f32_16x16x32_f16 v[142:145], v[238:241], v[246:249], v[142:145]
    v_mov_b32_dpp v254, v235 quad_perm:[0,1,2,3] row_mask:0x2 bank_mask:0xf
    v_max3_f32 v198, v182, v146, v147
    v_max3_f32 v198, v198, v148, v149
    v_mfma_f32_16x16x16_f16 v[170:173], v[208:209], v[122:123], v[170:173]
    v_max3_f32 v198, v198, v126, v127
    v_max3_f32 v198, v198, v128, v129
    v_bfe_u32 v215, v150, 1, 2
    v_xor_b32 v215, v215, v199
    v_mfma_f32_16x16x32_f16 v[142:145], v[118:121], v[206:209], v[142:145]
    v_lshl_add_u32 v215, v150, 2, v215
    v_lshl_add_u32 v199, v215, 4, s5
    v_mfma_f32_16x16x32_bf16 v[118:121], a[216:219], v[222:225], 0
    v_max3_f32 v198, v198, v170, v171
    v_max3_f32 v198, v198, v172, v173
    v_mfma_f32_16x16x32_bf16 v[118:121], a[220:223], v[174:177], v[118:121]
    v_mov_b32 v150, v198
    v_lshl_add_u32 v123, v215, 3, s5
    v_mfma_f32_16x16x32_bf16 v[118:121], a[224:227], v[158:161], v[118:121]
    v_permlane32_swap_b32 v198, v150
    v_mfma_f32_16x16x32_bf16 v[118:121], a[228:231], v[162:165], v[118:121]
    v_max_f32 v198, v198, v150
    v_mov_b32 v150, v198
    v_mfma_f32_16x16x32_bf16 v[118:121], a[232:235], v[114:117], v[118:121]
    v_mov_b32_dpp v254, v143 quad_perm:[0,1,2,3] row_mask:0x4 bank_mask:0xf
    v_mov_b32 v122, v254
    v_mfma_f32_16x16x32_bf16 v[118:121], a[236:239], v[210:213], v[118:121]
    v_permlane16_swap_b32 v198, v150
    v_mfma_f32_16x16x32_bf16 v[154:157], a[240:243], v[222:225], 0
    v_max_f32_dpp v122, v122, v122 quad_perm:[1,0,3,2] row_mask:0xf bank_mask:0xf
    v_max_f32 v198, v198, v150
    v_mfma_f32_16x16x32_bf16 v[154:157], a[244:247], v[174:177], v[154:157]
    v_max_f32_dpp v122, v122, v122 quad_perm:[2,3,0,1] row_mask:0xf bank_mask:0xf
    v_sub_f32 v146, v146, v198
    v_mfma_f32_16x16x32_bf16 v[154:157], a[248:251], v[158:161], v[154:157]
    v_max_f32_dpp v122, v122, v122 row_half_mirror row_mask:0xf bank_mask:0xf
    v_sub_f32 v147, v147, v198
    v_mfma_f32_16x16x32_bf16 v[154:157], a[252:255], v[162:165], v[154:157]
    v_max_f32_dpp v122, v122, v122 row_mirror row_mask:0xf bank_mask:0xf
    v_mov_b32 v150, v122
    v_mfma_f32_16x16x32_bf16 v[154:157], v[82:85], v[114:117], v[154:157]
    v_exp_f32 v146, v146
    v_mfma_f32_16x16x32_bf16 v[154:157], v[86:89], v[210:213], v[154:157]
    v_permlane32_swap_b32 v122, v150
    v_mfma_f32_16x16x32_bf16 v[202:205], v[90:93], v[222:225], 0
    ds_read_b128 v[238:241], v152 offset:0
    v_max_f32 v122, v122, v150
    v_mfma_f32_16x16x32_bf16 v[202:205], v[94:97], v[174:177], v[202:205]
    ds_read_b128 v[226:229], v152 offset:2048
    v_mov_b32 v150, v122
    v_mfma_f32_16x16x32_bf16 v[202:205], v[98:101], v[158:161], v[202:205]
    ds_read_b128 v[174:177], v152 offset:4096
    v_sub_f32 v148, v148, v198
    v_mfma_f32_16x16x32_bf16 v[202:205], v[102:105], v[162:165], v[202:205]
    ds_read_b128 v[222:225], v152 offset:6144
    v_sub_f32 v149, v149, v198
    v_mfma_f32_16x16x32_bf16 v[202:205], v[106:109], v[114:117], v[202:205]
    ds_read_b128 v[162:165], v152 offset:8192
    v_sub_f32 v126, v126, v198
    v_mfma_f32_16x16x32_bf16 v[202:205], v[110:113], v[210:213], v[202:205]
    ds_read_b128 v[158:161], v152 offset:10240
    v_permlane16_swap_b32 v122, v150
    v_max_f32 v122, v122, v150
    v_sub_f32 v254, v254, v122
    s_waitcnt lgkmcnt(5)
    v_mfma_f32_16x16x32_bf16 v[114:117], a[216:219], v[238:241], 0
    v_exp_f32 v254, v254
    s_waitcnt lgkmcnt(4)
    v_mfma_f32_16x16x32_bf16 v[114:117], a[220:223], v[226:229], v[114:117]
    v_cvt_pk_bf16_f32 v254, v254, v254
    s_waitcnt lgkmcnt(3)
    v_mfma_f32_16x16x32_bf16 v[114:117], a[224:227], v[174:177], v[114:117]
    ds_write_b16 v8, v254
    v_mfma_f32_16x16x32_bf16 v[210:213], a[240:243], v[238:241], 0
    s_waitcnt lgkmcnt(3)
    v_exp_f32 v147, v147
    v_mfma_f32_16x16x32_bf16 v[114:117], a[228:231], v[222:225], v[114:117]
    s_waitcnt lgkmcnt(2)
    v_cvt_pk_bf16_f32 v146, v146, v147
    v_sub_f32 v127, v127, v198
    v_mfma_f32_16x16x32_bf16 v[114:117], a[232:235], v[162:165], v[114:117]
    s_waitcnt lgkmcnt(1)
    v_exp_f32 v148, v148
    v_mfma_f32_16x16x32_bf16 v[114:117], a[236:239], v[158:161], v[114:117]
    v_exp_f32 v149, v149
    v_mfma_f32_16x16x32_bf16 v[210:213], a[244:247], v[226:229], v[210:213]
    v_cvt_pk_bf16_f32 v147, v148, v149
    v_sub_f32 v128, v128, v198
    v_mfma_f32_16x16x32_bf16 v[210:213], a[248:251], v[174:177], v[210:213]
    v_exp_f32 v126, v126
    v_mfma_f32_16x16x32_bf16 v[210:213], a[252:255], v[222:225], v[210:213]
    v_exp_f32 v127, v127
    v_mfma_f32_16x16x32_bf16 v[210:213], v[82:85], v[162:165], v[210:213]
    v_fma_f32 v150, v114, v114, s33
    v_fmac_f32 v150, v115, v115
    v_mfma_f32_16x16x32_bf16 v[210:213], v[86:89], v[158:161], v[210:213]
    v_fmac_f32 v150, v116, v116
    v_fmac_f32 v150, v117, v117
    v_cvt_pk_bf16_f32 v148, v126, v127
    v_exp_f32 v128, v128
    v_sub_f32 v129, v129, v198
    v_exp_f32 v129, v129
    v_sub_f32 v170, v170, v198
    v_cvt_pk_bf16_f32 v149, v128, v129
    v_fmac_f32 v150, v210, v210
    v_fmac_f32 v150, v211, v211
    v_fmac_f32 v150, v212, v212
    v_fmac_f32 v150, v213, v213
    v_exp_f32 v170, v170
    v_sub_f32 v171, v171, v198
    v_exp_f32 v171, v171
    v_sub_f32 v172, v172, v198
    v_cvt_pk_bf16_f32 v36, v170, v171
    v_mfma_f32_16x16x32_f16 v[126:129], v[130:133], v[134:137], v[58:61]
    v_exp_f32 v172, v172
    v_sub_f32 v173, v173, v198
    v_exp_f32 v173, v173
    v_sub_f32 v182, v182, v198
    v_cvt_pk_bf16_f32 v37, v172, v173
    v_mfma_f32_16x16x32_f16 v[170:173], v[178:181], v[134:137], v[62:65]
    v_exp_f32 v182, v182
    v_fma_f32 v254, v118, v118, s33
    v_mfma_f32_16x16x16_f16 v[126:129], v[124:125], v[218:219], v[126:129]
    v_cvt_pk_bf16_f32 v39, v182, 0
    v_fmac_f32 v254, v119, v119
    v_fmac_f32 v254, v120, v120
    v_mfma_f32_16x16x16_f16 v[170:173], v[220:221], v[218:219], v[170:173]
    v_fmac_f32 v254, v121, v121
    v_fmac_f32 v254, v154, v154
    v_fmac_f32 v254, v155, v155
    v_fmac_f32 v254, v156, v156
    v_fmac_f32 v254, v157, v157
    v_fmac_f32 v254, v202, v202
    v_fmac_f32 v254, v203, v203
    v_fmac_f32 v254, v204, v204
    v_fmac_f32 v254, v205, v205
    v_max3_f32 v144, v234, v126, v127
    v_max3_f32 v144, v144, v128, v129
    v_max3_f32 v144, v144, v170, v171
    v_max3_f32 v144, v144, v172, v173
    v_lshl_add_u32 v145, v201, 4, s5
    v_lshl_add_u32 v122, v201, 3, s5
    v_lshlrev_b32 v215, 2, v215
    ds_permute_b32 v198, v215, v16
    ds_permute_b32 v235, v215, v19
    ds_permute_b32 v143, v215, v17
    ds_permute_b32 v201, v215, v20
    v_mfma_f32_16x16x32_f16 v[182:185], v[246:249], v[134:137], v[66:69]
    s_nop 0
    s_nop 0
    s_nop 0
    s_nop 0
    s_nop 0
    s_nop 0
    v_mfma_f32_16x16x16_f16 v[182:185], v[208:209], v[218:219], v[182:185]
    s_nop 0
    s_nop 0
    s_nop 0
    s_nop 0
    s_nop 0
    s_nop 0
    s_nop 0
    s_nop 0
    v_max3_f32 v144, v144, v182, v183
    v_max3_f32 v144, v144, v184, v185
    v_mov_b32 v215, v144
    s_nop 0
    s_nop 0
    v_permlane32_swap_b32 v144, v215
    v_max_f32 v144, v144, v215
    v_mov_b32 v215, v144
    s_nop 0
    s_nop 0
    v_permlane16_swap_b32 v144, v215
    v_max_f32 v144, v144, v215
    v_sub_f32 v126, v126, v144
    v_exp_f32 v126, v126
    v_sub_f32 v127, v127, v144
    v_exp_f32 v127, v127
    v_sub_f32 v128, v128, v144
    v_cvt_pk_bf16_f32 v126, v126, v127
    v_exp_f32 v128, v128
    v_sub_f32 v129, v129, v144
    v_exp_f32 v129, v129
    v_sub_f32 v170, v170, v144
    v_cvt_pk_bf16_f32 v127, v128, v129
    v_exp_f32 v170, v170
    v_sub_f32 v171, v171, v144
    v_exp_f32 v171, v171
    v_sub_f32 v172, v172, v144
    v_cvt_pk_bf16_f32 v128, v170, v171
    v_exp_f32 v172, v172
    v_sub_f32 v173, v173, v144
    v_exp_f32 v173, v173
    v_sub_f32 v182, v182, v144
    v_cvt_pk_bf16_f32 v129, v172, v173
    v_exp_f32 v182, v182
    v_sub_f32 v183, v183, v144
    v_exp_f32 v183, v183
    v_sub_f32 v184, v184, v144
    v_exp_f32 v184, v184
    v_sub_f32 v185, v185, v144
    v_exp_f32 v185, v185
    v_sub_f32 v234, v234, v144
    v_exp_f32 v234, v234
    v_mfma_f32_16x16x32_bf16 v[134:137], v[28:31], v[36:39], 0
    s_waitcnt lgkmcnt(0)
    v_mfma_f32_16x16x32_bf16 v[134:137], v[28:31], v[146:149], v[134:137]
    s_nop 0
    s_nop 0
    s_nop 0
    s_nop 0
    s_nop 0
    s_nop 0
    s_nop 0
    s_nop 0
    v_rcp_f32 v134, v134
    v_mfma_f32_16x16x32_bf16 v[170:173], v[138:141], v[36:39], 0
    v_mfma_f32_16x16x32_bf16 v[170:173], v[194:197], v[146:149], v[170:173]
    s_nop 0
    s_nop 0
    s_nop 0
    s_nop 0
    s_nop 0
    s_nop 0
    s_nop 0
    s_nop 0
    v_mul_f32 v170, v134, v170
    v_mul_f32 v171, v134, v171
    v_cvt_pk_bf16_f32 v170, v170, v171
    v_mul_f32 v172, v134, v172
    v_mul_f32 v173, v134, v173
    v_cvt_pk_bf16_f32 v171, v172, v173
    v_mfma_f32_16x16x32_bf16 v[250:253], v[230:233], v[36:39], 0
    v_mfma_f32_16x16x32_bf16 v[250:253], v[190:193], v[146:149], v[250:253]
    s_nop 0
    s_nop 0
    s_nop 0
    s_nop 0
    s_nop 0
    s_nop 0
    s_nop 0
    s_nop 0
    v_mul_f32 v250, v134, v250
    v_mul_f32 v251, v134, v251
    v_cvt_pk_bf16_f32 v172, v250, v251
    v_mul_f32 v252, v134, v252
    v_mul_f32 v253, v134, v253
    v_cvt_pk_bf16_f32 v173, v252, v253
    ds_write_b128 v3, v[170:173] offset:0
    v_mfma_f32_16x16x32_bf16 v[170:173], v[186:189], v[36:39], 0
    v_cvt_pk_bf16_f32 v36, v182, v183
    v_cvt_pk_bf16_f32 v37, v184, v185
    v_mfma_f32_16x16x32_bf16 v[170:173], v[166:169], v[146:149], v[170:173]
    v_cvt_pk_bf16_f32 v39, v234, 0
    v_mfma_f32_16x16x32_f16 v[146:149], v[130:133], v[242:245], v[70:73]
    v_mfma_f32_16x16x32_f16 v[182:185], v[178:181], v[242:245], v[74:77]
    v_mfma_f32_16x16x32_bf16 v[250:253], v[28:31], v[36:39], 0
    v_mfma_f32_16x16x32_bf16 v[250:253], v[28:31], v[126:129], v[250:253]
    v_mfma_f32_16x16x32_bf16 v[178:181], v[138:141], v[36:39], 0
    v_mfma_f32_16x16x32_bf16 v[178:181], v[194:197], v[126:129], v[178:181]
    s_nop 0
    v_mul_f32 v170, v134, v170
    v_mul_f32 v171, v134, v171
    v_cvt_pk_bf16_f32 v170, v170, v171
    v_mfma_f32_16x16x16_f16 v[146:149], v[124:125], v[206:207], v[146:149]
    v_mul_f32 v172, v134, v172
    v_rcp_f32 v250, v250
    v_mul_f32 v173, v134, v173
    v_mfma_f32_16x16x32_bf16 v[130:133], v[230:233], v[36:39], 0
    v_mul_f32 v178, v250, v178
    v_mul_f32 v179, v250, v179
    v_mfma_f32_16x16x32_bf16 v[130:133], v[190:193], v[126:129], v[130:133]
    v_cvt_pk_bf16_f32 v178, v178, v179
    v_max3_f32 v144, v142, v146, v147
    v_max3_f32 v144, v144, v148, v149
    v_mfma_f32_16x16x16_f16 v[182:185], v[220:221], v[206:207], v[182:185]
    v_mul_f32 v180, v250, v180
    v_mul_f32 v181, v250, v181
    v_cvt_pk_bf16_f32 v179, v180, v181
    v_cvt_pk_bf16_f32 v171, v172, v173
    v_mfma_f32_16x16x32_bf16 v[134:137], v[186:189], v[36:39], 0
    ds_write_b64 v4, v[170:171] offset:4096
    v_mfma_f32_16x16x32_bf16 v[134:137], v[166:169], v[126:129], v[134:137]
    v_mul_f32 v130, v250, v130
    v_max3_f32 v144, v144, v182, v183
    v_mfma_f32_16x16x32_f16 v[126:129], v[246:249], v[242:245], v[78:81]
    v_max3_f32 v144, v144, v184, v185
    v_mul_f32 v131, v250, v131
    v_mfma_f32_16x16x32_bf16 v[170:173], v[90:93], v[238:241], 0
    v_cvt_pk_bf16_f32 v180, v130, v131
    v_mul_f32 v132, v250, v132
    v_mfma_f32_16x16x32_bf16 v[170:173], v[94:97], v[226:229], v[170:173]
    v_mul_f32 v133, v250, v133
    v_cvt_pk_bf16_f32 v181, v132, v133
    v_mul_f32 v134, v250, v134
    v_mfma_f32_16x16x16_f16 v[126:129], v[208:209], v[206:207], v[126:129]
    v_mul_f32 v135, v250, v135
    v_cvt_pk_bf16_f32 v124, v134, v135
    v_mul_f32 v136, v250, v136
    v_mul_f32 v137, v250, v137
    v_mfma_f32_16x16x32_bf16 v[170:173], v[98:101], v[174:177], v[170:173]
    ds_write_b128 v3, v[178:181] offset:6144
    v_mfma_f32_16x16x32_bf16 v[170:173], v[102:105], v[222:225], v[170:173]
    v_cvt_pk_bf16_f32 v125, v136, v137
    v_max3_f32 v144, v144, v126, v127
    v_mfma_f32_16x16x32_bf16 v[170:173], v[106:109], v[162:165], v[170:173]
    v_max3_f32 v144, v144, v128, v129
    v_mov_b32 v215, v144
    v_mfma_f32_16x16x32_bf16 v[170:173], v[110:113], v[158:161], v[170:173]
    ds_write_b64 v4, v[124:125] offset:10240
    v_permlane32_swap_b32 v144, v215
    v_max_f32 v144, v144, v215
    v_mov_b32 v215, v144
    s_nop 0
    s_nop 0
    v_permlane16_swap_b32 v144, v215
    v_max_f32 v144, v144, v215
    v_fmac_f32 v150, v170, v170
    v_fmac_f32 v150, v171, v171
    v_fmac_f32 v150, v172, v172
    v_fmac_f32 v150, v173, v173
    v_cvt_pk_bf16_f32 v124, v254, v150
    v_cvt_pk_bf16_f32 v125, v150, v150
    ds_write_b64 v214, v[124:125] offset:2048
    v_sub_f32 v146, v146, v144
    v_exp_f32 v146, v146
    v_sub_f32 v147, v147, v144
    v_exp_f32 v147, v147
    v_sub_f32 v148, v148, v144
    v_cvt_pk_bf16_f32 v146, v146, v147
    v_exp_f32 v148, v148
    v_sub_f32 v149, v149, v144
    v_exp_f32 v149, v149
    v_sub_f32 v182, v182, v144
    v_cvt_pk_bf16_f32 v147, v148, v149
    v_exp_f32 v182, v182
    v_sub_f32 v183, v183, v144
    v_exp_f32 v183, v183
    v_sub_f32 v184, v184, v144
    v_cvt_pk_bf16_f32 v148, v182, v183
    s_waitcnt lgkmcnt(0)
    s_barrier
    s_barrier
    ds_read_b128 v[158:161], v153 offset:2048
    ds_read_b128 v[134:137], v153 offset:3072
    ds_read_b128 v[174:177], v255 offset:0
    ds_read_b128 v[206:209], v255 offset:1024
    ds_read_b128 v[218:221], v255 offset:2048
    ds_read_b128 v[238:241], v255 offset:3072
    ds_read_b128 v[162:165], v255 offset:4096
    ds_read_b128 v[130:133], v255 offset:5120
    v_exp_f32 v184, v184
    v_sub_f32 v185, v185, v144
    s_waitcnt lgkmcnt(7)
    v_mfma_f32_16x16x32_bf16 v[178:181], v[32:35], v[158:161], 0
    s_waitcnt lgkmcnt(5)
    v_exp_f32 v185, v185
    v_mfma_f32_16x16x32_bf16 v[178:181], v[32:35], v[134:137], v[178:181]
    s_waitcnt lgkmcnt(4)
    v_cvt_pk_bf16_f32 v149, v184, v185
    v_sub_f32 v126, v126, v144
    v_mfma_f32_16x16x32_bf16 v[158:161], a[216:219], v[174:177], 0
    s_waitcnt lgkmcnt(3)
    v_exp_f32 v126, v126
    v_mfma_f32_16x16x32_bf16 v[158:161], a[220:223], v[206:209], v[158:161]
    s_waitcnt lgkmcnt(2)
    v_mul_f32 v215, 0x3baaaaab, v179
    v_sub_f32 v127, v127, v144
    v_mfma_f32_16x16x32_bf16 v[158:161], a[224:227], v[218:221], v[158:161]
    s_waitcnt lgkmcnt(1)
    v_rsq_f32 v215, v215
    v_mfma_f32_16x16x32_bf16 v[158:161], a[228:231], v[238:241], v[158:161]
    s_waitcnt lgkmcnt(0)
    v_mul_f32 v114, v215, v114
    v_mul_f32 v115, v215, v115
    v_mfma_f32_16x16x32_bf16 v[158:161], a[232:235], v[162:165], v[158:161]
    v_cvt_pk_bf16_f32 v134, v114, v115
    v_mul_f32 v116, v215, v116
    v_mfma_f32_16x16x32_bf16 v[158:161], a[236:239], v[130:133], v[158:161]
    v_mul_f32 v117, v215, v117
    v_cvt_pk_bf16_f32 v135, v116, v117
    v_mfma_f32_16x16x32_bf16 v[114:117], a[240:243], v[174:177], 0
    v_mul_f32 v210, v215, v210
    v_mul_f32 v211, v215, v211
    v_mfma_f32_16x16x32_bf16 v[114:117], a[244:247], v[206:209], v[114:117]
    v_cvt_pk_bf16_f32 v136, v210, v211
    v_mul_f32 v212, v215, v212
    v_mfma_f32_16x16x32_bf16 v[114:117], a[248:251], v[218:221], v[114:117]
    v_mul_f32 v213, v215, v213
    v_cvt_pk_bf16_f32 v137, v212, v213
    v_mfma_f32_16x16x32_bf16 v[114:117], a[252:255], v[238:241], v[114:117]
    buffer_store_dwordx4 v[134:137], v151, s[12:15], 0 offen nt
    v_mul_f32 v170, v215, v170
    v_mul_f32 v171, v215, v171
    v_cvt_pk_bf16_f32 v124, v170, v171
    v_mul_f32 v172, v215, v172
    v_mfma_f32_16x16x32_bf16 v[114:117], v[82:85], v[162:165], v[114:117]
    v_mul_f32 v173, v215, v173
    v_cvt_pk_bf16_f32 v125, v172, v173
    v_mfma_f32_16x16x32_bf16 v[114:117], v[86:89], v[130:133], v[114:117]
    v_exp_f32 v127, v127
    v_mfma_f32_16x16x32_bf16 v[170:173], v[90:93], v[174:177], 0
    v_cvt_pk_bf16_f32 v36, v126, v127
    v_sub_f32 v128, v128, v144
    v_mfma_f32_16x16x32_bf16 v[170:173], v[94:97], v[206:209], v[170:173]
    v_exp_f32 v128, v128
    v_mfma_f32_16x16x32_bf16 v[170:173], v[98:101], v[218:221], v[170:173]
    ds_read_b128 v[206:209], v9
    ds_read_b128 v[210:213], v9 offset:64
    v_mfma_f32_16x16x32_bf16 v[170:173], v[102:105], v[238:241], v[170:173]
    v_sub_f32 v129, v129, v144
    v_sub_f32 v142, v142, v144
    v_mfma_f32_16x16x32_bf16 v[170:173], v[106:109], v[162:165], v[170:173]
    v_exp_f32 v129, v129
    v_mfma_f32_16x16x32_bf16 v[170:173], v[110:113], v[130:133], v[170:173]
    v_cvt_pk_bf16_f32 v37, v128, v129
    v_exp_f32 v142, v142
    v_fma_f32 v215, v158, v158, s33
    v_cvt_pk_bf16_f32 v39, v142, 0
    v_fmac_f32 v215, v159, v159
    v_fmac_f32 v215, v160, v160
    v_mfma_f32_16x16x32_bf16 v[130:133], v[28:31], v[36:39], 0
    v_fmac_f32 v215, v161, v161
    v_fmac_f32 v215, v114, v114
    v_mfma_f32_16x16x32_bf16 v[130:133], v[28:31], v[146:149], v[130:133]
    v_fmac_f32 v215, v115, v115
    v_fmac_f32 v215, v116, v116
    v_mfma_f32_16x16x32_bf16 v[162:165], v[138:141], v[36:39], 0
    s_waitcnt lgkmcnt(0)
    v_fmac_f32 v215, v117, v117
    v_fmac_f32 v215, v170, v170
    v_mfma_f32_16x16x32_bf16 v[162:165], v[194:197], v[146:149], v[162:165]
    v_fmac_f32 v215, v171, v171
    v_fmac_f32 v215, v172, v172
    v_mfma_f32_16x16x32_bf16 v[126:129], v[230:233], v[36:39], 0
    v_fmac_f32 v215, v173, v173
    v_cvt_pk_bf16_f32 v150, v215, v215
    v_mfma_f32_16x16x32_bf16 v[126:129], v[190:193], v[146:149], v[126:129]
    buffer_store_dwordx2 v[124:125], v200, s[12:15], 0 offen nt
    v_cvt_pk_bf16_f32 v151, v215, v215
    v_mul_f32 v200, 0x3baaaaab, v178
    v_mfma_f32_16x16x32_bf16 v[174:177], v[186:189], v[36:39], 0
    ds_write_b64 v214, v[150:151] offset:7616
    v_mfma_f32_16x16x32_bf16 v[174:177], v[166:169], v[146:149], v[174:177]
    v_rsq_f32 v200, v200
    v_mfma_f32_16x16x32_bf16 v[146:149], v[206:209], v[28:31], 0
    v_mul_f32 v118, v200, v118
    v_mul_f32 v119, v200, v119
    v_mfma_f32_16x16x32_bf16 v[146:149], v[210:213], v[28:31], v[146:149]
    v_cvt_pk_bf16_f32 v178, v118, v119
    v_mul_f32 v120, v200, v120
    v_mfma_f32_16x16x32_bf16 v[134:137], v[206:209], v[194:197], 0
    v_mul_f32 v121, v200, v121
    v_cvt_pk_bf16_f32 v179, v120, v121
    v_mfma_f32_16x16x32_bf16 v[134:137], v[210:213], v[138:141], v[134:137]
    v_mul_f32 v154, v200, v154
    v_mul_f32 v155, v200, v155
    v_mfma_f32_16x16x32_bf16 v[118:121], v[206:209], v[190:193], 0
    v_rcp_f32 v146, v146
    v_mfma_f32_16x16x32_bf16 v[118:121], v[210:213], v[230:233], v[118:121]
    v_cvt_pk_bf16_f32 v180, v154, v155
    v_mul_f32 v156, v200, v156
    v_mfma_f32_16x16x32_bf16 v[138:141], v[206:209], v[166:169], 0
    v_mul_f32 v134, v134, v146
    v_mul_f32 v157, v200, v157
    v_mfma_f32_16x16x32_bf16 v[138:141], v[210:213], v[186:189], v[138:141]
    v_cvt_pk_bf16_f32 v181, v156, v157
    v_mul_f32 v202, v200, v202
    v_mul_f32_dpp v134, v118, v146 quad_perm:[0,1,2,3] row_mask:0x2 bank_mask:0xf
    v_mul_f32 v203, v200, v203
    v_cvt_pk_bf16_f32 v124, v202, v203
    v_mul_f32 v204, v200, v204
    v_mul_f32 v205, v200, v205
    v_cvt_pk_bf16_f32 v125, v204, v205
    v_mul_f32_dpp v134, v138, v146 quad_perm:[0,1,2,3] row_mask:0x4 bank_mask:0xf
    v_cvt_pk_bf16_f32 v134, v134, v134
    ds_write_b16 v7, v134
    v_rcp_f32 v130, v130
    s_nop 0
    v_mul_f32 v162, v130, v162
    v_mul_f32 v163, v130, v163
    v_cvt_pk_bf16_f32 v118, v162, v163
    buffer_store_dwordx4 v[178:181], v17, s[52:55], 0 offen nt
    v_mul_f32 v164, v130, v164
    v_mul_f32 v165, v130, v165
    v_cvt_pk_bf16_f32 v119, v164, v165
    v_mul_f32 v126, v130, v126
    v_mul_f32 v127, v130, v127
    v_cvt_pk_bf16_f32 v120, v126, v127
    v_mul_f32 v128, v130, v128
    v_mul_f32 v129, v130, v129
    v_cvt_pk_bf16_f32 v121, v128, v129
    ds_write_b128 v3, v[118:121] offset:12288
    s_waitcnt lgkmcnt(1)
    s_barrier
    v_mul_f32 v174, v130, v174
    v_mul_f32 v175, v130, v175
    v_cvt_pk_bf16_f32 v150, v174, v175
    v_mul_f32 v176, v130, v176
    v_mul_f32 v177, v130, v177
    ds_read_b128 v[126:129], v153 offset:7616
    ds_read_b128 v[118:121], v153 offset:8640
    ds_read_b128 v[146:149], v255 offset:6144
    ds_read_b128 v[186:189], v255 offset:7168
    ds_read_b128 v[206:209], v255 offset:8192
    ds_read_b128 v[166:169], v255 offset:9216
    ds_read_b128 v[162:165], v255 offset:10240
    ds_read_b128 v[154:157], v255 offset:11264
    v_cvt_pk_bf16_f32 v151, v176, v177
    ds_write_b64 v4, v[150:151] offset:16384
    s_waitcnt lgkmcnt(6)
    v_mfma_f32_16x16x32_bf16 v[138:141], v[32:35], v[126:129], 0
    s_waitcnt lgkmcnt(5)
    v_mfma_f32_16x16x32_bf16 v[138:141], v[32:35], v[118:121], v[138:141]
    s_waitcnt lgkmcnt(4)
    v_mfma_f32_16x16x32_bf16 v[118:121], a[216:219], v[146:149], 0
    s_waitcnt lgkmcnt(3)
    buffer_store_dwordx2 v[124:125], v20, s[52:55], 0 offen nt
    v_mfma_f32_16x16x32_bf16 v[118:121], a[220:223], v[186:189], v[118:121]
    s_waitcnt lgkmcnt(2)
    v_mfma_f32_16x16x32_bf16 v[118:121], a[224:227], v[206:209], v[118:121]
    s_waitcnt lgkmcnt(1)
    v_mul_f32 v200, 0x3baaaaab, v138
    v_mfma_f32_16x16x32_bf16 v[118:121], a[228:231], v[166:169], v[118:121]
    v_rsq_f32 v200, v200
    v_mfma_f32_16x16x32_bf16 v[118:121], a[232:235], v[162:165], v[118:121]
    v_mul_f32 v158, v200, v158
    v_mul_f32 v159, v200, v159
    v_mfma_f32_16x16x32_bf16 v[118:121], a[236:239], v[154:157], v[118:121]
    v_cvt_pk_bf16_f32 v158, v158, v159
    v_mul_f32 v160, v200, v160
    v_mfma_f32_16x16x32_bf16 v[138:141], a[240:243], v[146:149], 0
    v_mul_f32 v161, v200, v161
    v_cvt_pk_bf16_f32 v159, v160, v161
    v_mfma_f32_16x16x32_bf16 v[138:141], a[244:247], v[186:189], v[138:141]
    v_mul_f32 v114, v200, v114
    v_mul_f32 v115, v200, v115
    v_mfma_f32_16x16x32_bf16 v[138:141], a[248:251], v[206:209], v[138:141]
    v_fma_f32 v215, v118, v118, s33
    v_fmac_f32 v215, v119, v119
    v_mfma_f32_16x16x32_bf16 v[138:141], a[252:255], v[166:169], v[138:141]
    v_fmac_f32 v215, v120, v120
    v_fmac_f32 v215, v121, v121
    v_mfma_f32_16x16x32_bf16 v[138:141], v[82:85], v[162:165], v[138:141]
    v_cvt_pk_bf16_f32 v160, v114, v115
    v_mul_f32 v116, v200, v116
    v_mfma_f32_16x16x32_bf16 v[138:141], v[86:89], v[154:157], v[138:141]
    v_mul_f32 v117, v200, v117
    v_cvt_pk_bf16_f32 v161, v116, v117
    v_mfma_f32_16x16x32_bf16 v[126:129], v[90:93], v[146:149], 0
    ds_read_b128 v[146:149], v152 offset:256
    v_mul_f32 v170, v200, v170
    v_mfma_f32_16x16x32_bf16 v[126:129], v[94:97], v[186:189], v[126:129]
    ds_read_b128 v[114:117], v152 offset:2304
    v_mul_f32 v171, v200, v171
    v_mfma_f32_16x16x32_bf16 v[126:129], v[98:101], v[206:209], v[126:129]
    ds_read_b128 v[206:209], v152 offset:4352
    v_fmac_f32 v215, v138, v138
    v_mfma_f32_16x16x32_bf16 v[126:129], v[102:105], v[166:169], v[126:129]
    ds_read_b128 v[166:169], v152 offset:6400
    v_fmac_f32 v215, v139, v139
    v_mfma_f32_16x16x32_bf16 v[126:129], v[106:109], v[162:165], v[126:129]
    ds_read_b128 v[186:189], v152 offset:8448
    buffer_store_dwordx4 v[158:161], v15, s[56:59], 0 offen nt
    v_fmac_f32 v215, v140, v140
    v_fmac_f32 v215, v141, v141
    v_cvt_pk_bf16_f32 v124, v170, v171
    v_mul_f32 v172, v200, v172
    v_mfma_f32_16x16x32_bf16 v[126:129], v[110:113], v[154:157], v[126:129]
    ds_read_b128 v[154:157], v152 offset:10496
    s_waitcnt lgkmcnt(5)
    v_mfma_f32_16x16x32_bf16 v[158:161], a[216:219], v[146:149], 0
    v_mul_f32 v173, v200, v173
    v_cvt_pk_bf16_f32 v125, v172, v173
    v_mfma_f32_16x16x32_bf16 v[170:173], a[240:243], v[146:149], 0
    s_waitcnt lgkmcnt(4)
    v_mfma_f32_16x16x32_bf16 v[158:161], a[220:223], v[114:117], v[158:161]
    s_waitcnt lgkmcnt(3)
    v_fmac_f32 v215, v126, v126
    v_fmac_f32 v215, v127, v127
    v_mfma_f32_16x16x32_bf16 v[158:161], a[224:227], v[206:209], v[158:161]
    s_waitcnt lgkmcnt(2)
    v_fmac_f32 v215, v128, v128
    v_fmac_f32 v215, v129, v129
    v_mfma_f32_16x16x32_bf16 v[158:161], a[228:231], v[166:169], v[158:161]
    s_waitcnt lgkmcnt(1)
    v_cvt_pk_bf16_f32 v150, v215, v215
    v_cvt_pk_bf16_f32 v151, v215, v215
    v_mfma_f32_16x16x32_bf16 v[158:161], a[232:235], v[186:189], v[158:161]
    ds_write_b64 v214, v[150:151] offset:9664
    v_mfma_f32_16x16x32_bf16 v[170:173], a[244:247], v[114:117], v[170:173]
    s_waitcnt lgkmcnt(1)
    v_mfma_f32_16x16x32_bf16 v[158:161], a[236:239], v[154:157], v[158:161]
    v_mfma_f32_16x16x32_bf16 v[170:173], a[248:251], v[206:209], v[170:173]
    v_mfma_f32_16x16x32_bf16 v[170:173], a[252:255], v[166:169], v[170:173]
    v_mfma_f32_16x16x32_bf16 v[170:173], v[82:85], v[186:189], v[170:173]
    v_mfma_f32_16x16x32_bf16 v[170:173], v[86:89], v[154:157], v[170:173]
    v_mfma_f32_16x16x32_bf16 v[162:165], v[90:93], v[146:149], 0
    s_waitcnt lgkmcnt(0)
    v_mfma_f32_16x16x32_bf16 v[162:165], v[94:97], v[114:117], v[162:165]
    s_barrier
    ds_read_b128 v[146:149], v153 offset:9664
    ds_read_b128 v[202:205], v153 offset:10688
    v_mfma_f32_16x16x32_bf16 v[162:165], v[98:101], v[206:209], v[162:165]
    ds_read_b128 v[114:117], v255 offset:12288
    ds_read_b128 v[206:209], v255 offset:13312
    v_mfma_f32_16x16x32_bf16 v[162:165], v[102:105], v[166:169], v[162:165]
    buffer_store_dwordx2 v[124:125], v18, s[56:59], 0 offen nt
    ds_read_b128 v[130:133], v255 offset:14336
    v_fma_f32 v200, v158, v158, s33
    v_mfma_f32_16x16x32_bf16 v[162:165], v[106:109], v[186:189], v[162:165]
    ds_read_b128 v[186:189], v255 offset:15360
    v_fmac_f32 v200, v159, v159
    v_mfma_f32_16x16x32_bf16 v[162:165], v[110:113], v[154:157], v[162:165]
    ds_read_b128 v[166:169], v255 offset:16384
    ds_read_b128 v[154:157], v255 offset:17408
    v_fmac_f32 v200, v160, v160
    v_fmac_f32 v200, v161, v161
    v_fmac_f32 v200, v170, v170
    s_waitcnt lgkmcnt(7)
    v_mfma_f32_16x16x32_bf16 v[210:213], v[32:35], v[146:149], 0
    s_waitcnt lgkmcnt(6)
    v_fmac_f32 v200, v171, v171
    v_fmac_f32 v200, v172, v172
    v_mfma_f32_16x16x32_bf16 v[210:213], v[32:35], v[202:205], v[210:213]
    s_waitcnt lgkmcnt(4)
    v_fmac_f32 v200, v173, v173
    v_fmac_f32 v200, v162, v162
    v_mfma_f32_16x16x32_bf16 v[146:149], a[216:219], v[114:117], 0
    s_waitcnt lgkmcnt(3)
    v_fmac_f32 v200, v163, v163
    v_fmac_f32 v200, v164, v164
    v_mfma_f32_16x16x32_bf16 v[146:149], a[220:223], v[206:209], v[146:149]
    s_waitcnt lgkmcnt(2)
    v_mul_f32 v215, 0x3baaaaab, v210
    v_fmac_f32 v200, v165, v165
    v_mfma_f32_16x16x32_bf16 v[146:149], a[224:227], v[130:133], v[146:149]
    s_waitcnt lgkmcnt(1)
    v_rsq_f32 v215, v215
    v_mfma_f32_16x16x32_bf16 v[146:149], a[228:231], v[186:189], v[146:149]
    s_waitcnt lgkmcnt(0)
    v_mul_f32 v118, v215, v118
    v_mul_f32 v119, v215, v119
    v_mfma_f32_16x16x32_bf16 v[146:149], a[232:235], v[166:169], v[146:149]
    v_cvt_pk_bf16_f32 v202, v118, v119
    v_mul_f32 v120, v215, v120
    v_mfma_f32_16x16x32_bf16 v[146:149], a[236:239], v[154:157], v[146:149]
    v_mul_f32 v121, v215, v121
    v_cvt_pk_bf16_f32 v203, v120, v121
    v_mfma_f32_16x16x32_bf16 v[118:121], a[240:243], v[114:117], 0
    v_mul_f32 v138, v215, v138
    v_mul_f32 v139, v215, v139
    v_mfma_f32_16x16x32_bf16 v[118:121], a[244:247], v[206:209], v[118:121]
    v_cvt_pk_bf16_f32 v204, v138, v139
    v_mul_f32 v140, v215, v140
    v_mfma_f32_16x16x32_bf16 v[118:121], a[248:251], v[130:133], v[118:121]
    v_mul_f32 v141, v215, v141
    v_cvt_pk_bf16_f32 v205, v140, v141
    v_mfma_f32_16x16x32_bf16 v[118:121], a[252:255], v[186:189], v[118:121]
    ds_write_b128 v199, v[202:205] offset:1536
    v_mfma_f32_16x16x32_bf16 v[118:121], v[82:85], v[166:169], v[118:121]
    v_mul_f32 v126, v215, v126
    v_mul_f32 v127, v215, v127
    v_mfma_f32_16x16x32_bf16 v[118:121], v[86:89], v[154:157], v[118:121]
    v_cvt_pk_bf16_f32 v124, v126, v127
    v_mul_f32 v128, v215, v128
    v_mfma_f32_16x16x32_bf16 v[138:141], v[90:93], v[114:117], 0
    ds_read_b128 v[114:117], v145 offset:1536
    v_mul_f32 v129, v215, v129
    v_mfma_f32_16x16x32_bf16 v[138:141], v[94:97], v[206:209], v[138:141]
    v_cvt_pk_bf16_f32 v125, v128, v129
    v_cvt_pk_bf16_f32 v150, v200, v200
    v_mfma_f32_16x16x32_bf16 v[138:141], v[98:101], v[130:133], v[138:141]
    ds_write_b64 v123, v[124:125] offset:2560
    v_mfma_f32_16x16x32_bf16 v[138:141], v[102:105], v[186:189], v[138:141]
    v_cvt_pk_bf16_f32 v151, v200, v200
    v_fma_f32 v215, v146, v146, s33
    v_mfma_f32_16x16x32_bf16 v[138:141], v[106:109], v[166:169], v[138:141]
    ds_write_b64 v214, v[150:151] offset:17280
    v_mfma_f32_16x16x32_bf16 v[138:141], v[110:113], v[154:157], v[138:141]
    v_fmac_f32 v215, v147, v147
    ds_read_b64 v[124:125], v122 offset:2560
    s_waitcnt lgkmcnt(3)
    buffer_store_dwordx4 v[114:117], v198, s[56:59], 0 offen nt
    v_fmac_f32 v215, v148, v148
    v_fmac_f32 v215, v149, v149
    v_fmac_f32 v215, v118, v118
    v_fmac_f32 v215, v119, v119
    v_fmac_f32 v215, v120, v120
    v_fmac_f32 v215, v121, v121
    v_fmac_f32 v215, v138, v138
    v_fmac_f32 v215, v139, v139
    v_fmac_f32 v215, v140, v140
    v_fmac_f32 v215, v141, v141
    v_cvt_pk_bf16_f32 v150, v215, v215
    v_cvt_pk_bf16_f32 v151, v215, v215
    ds_write_b64 v214, v[150:151] offset:15232
    s_waitcnt lgkmcnt(1)
    buffer_store_dwordx2 v[124:125], v235, s[56:59], 0 offen nt
    s_waitcnt lgkmcnt(0)
    s_barrier
    ds_read_b128 v[166:169], v153 offset:15232
    ds_read_b128 v[186:189], v153 offset:16256
    ds_read_b128 v[114:117], v153 offset:17280
    ds_read_b128 v[206:209], v153 offset:18304
    ds_read_b128 v[126:129], v255 offset:18432
    s_waitcnt lgkmcnt(4)
    v_mfma_f32_16x16x32_bf16 v[154:157], v[32:35], v[166:169], 0
    s_waitcnt lgkmcnt(3)
    v_mfma_f32_16x16x32_bf16 v[154:157], v[32:35], v[186:189], v[154:157]
    s_waitcnt lgkmcnt(1)
    v_mfma_f32_16x16x32_bf16 v[186:189], v[32:35], v[114:117], 0
    s_waitcnt lgkmcnt(0)
    v_or3_b32 v126, v126, v127, v128
    v_or_b32 v126, v126, v129
    v_mfma_f32_16x16x32_bf16 v[186:189], v[32:35], v[206:209], v[186:189]
    v_cmp_gt_i32 s[46:47], 0, v126
    s_nop 0
    v_mul_f32 v125, 0x3baaaaab, v154
    v_rsq_f32 v125, v125
    s_nop 0
    v_mul_f32 v146, v125, v146
    v_mul_f32 v147, v125, v147
    v_cvt_pk_bf16_f32 v146, v146, v147
    v_mul_f32 v124, 0x3baaaaab, v186
    v_rsq_f32 v124, v124
    v_mul_f32 v148, v125, v148
    v_mul_f32 v158, v124, v158
    v_mul_f32 v159, v124, v159
    v_cvt_pk_bf16_f32 v158, v158, v159
    v_mul_f32 v160, v124, v160
    v_mul_f32 v161, v124, v161
    v_cvt_pk_bf16_f32 v159, v160, v161
    v_mul_f32 v170, v124, v170
    v_mul_f32 v171, v124, v171
    v_cvt_pk_bf16_f32 v160, v170, v171
    v_mul_f32 v172, v124, v172
    v_mul_f32 v173, v124, v173
    v_cvt_pk_bf16_f32 v161, v172, v173
    buffer_store_dwordx4 v[158:161], v217, s[12:15], 0 offen nt
    v_mul_f32 v162, v124, v162
    v_mul_f32 v163, v124, v163
    v_cvt_pk_bf16_f32 v254, v162, v163
    v_mul_f32 v164, v124, v164
    v_mul_f32 v165, v124, v165
    v_cvt_pk_bf16_f32 v255, v164, v165
    v_mul_f32 v149, v125, v149
    v_cvt_pk_bf16_f32 v147, v148, v149
    v_mul_f32 v118, v125, v118
    v_mul_f32 v119, v125, v119
    v_cvt_pk_bf16_f32 v148, v118, v119
    v_mul_f32 v120, v125, v120
    v_mul_f32 v121, v125, v121
    v_cvt_pk_bf16_f32 v149, v120, v121
    ds_write_b128 v199, v[146:149] offset:3072
    v_mul_f32 v138, v125, v138
    v_mul_f32 v139, v125, v139
    v_cvt_pk_bf16_f32 v124, v138, v139
    v_mul_f32 v140, v125, v140
    v_mul_f32 v141, v125, v141
    v_cvt_pk_bf16_f32 v125, v140, v141
    buffer_store_dwordx2 v[254:255], v216, s[12:15], 0 offen nt
    ds_read_b128 v[118:121], v145 offset:3072
    ds_write_b64 v123, v[124:125] offset:4096
    ds_read_b64 v[198:199], v122 offset:4096
    s_waitcnt lgkmcnt(2)
    buffer_store_dwordx4 v[118:121], v143, s[56:59], 0 offen nt
    s_waitcnt lgkmcnt(0)
    buffer_store_dwordx2 v[198:199], v201, s[56:59], 0 offen nt
    s_branch L_end
L_drain:
    ds_read_b128 v[118:121], v2 offset:18432
    ds_read_b128 v[126:129], v2 offset:19456
    ds_read_b128 v[130:133], v2 offset:0
    s_mul_i32 s5, s16, 9408
    s_mov_b32 s12, s40
    ds_read_b128 v[134:137], v2 offset:1024
    s_mov_b32 s13, s41
    s_cmp_ge_u32 s18, 2
    s_cselect_b32 s14, s36, 0
    ds_read_b128 v[142:145], v2 offset:2048
    s_add_u32 s5, s5, 104448
    s_and_b32 s6, s2, 7
    s_sub_u32 s6, 0, s6
    ds_read_b128 v[146:149], v2 offset:3072
    s_lshl_b32 s3, s16, 6
    s_lshl_b32 s4, s16, 5
    s_add_u32 s4, s4, 256
    ds_read_b128 v[158:161], v2 offset:4096
    ds_read_b128 v[170:173], v2 offset:5120
    v_bfe_u32 v254, v2, 4, 6
    v_lshrrev_b32 v255, 4, v254
    v_and_b32 v174, 15, v254
    v_lshlrev_b32 v175, 9, v255
    v_lshl_add_u32 v175, v174, 4, v175
    v_add_u32 v175, 149696, v175
    s_waitcnt lgkmcnt(7)
    v_mfma_f32_16x16x32_bf16 v[178:181], v[32:35], v[118:121], 0
    s_waitcnt lgkmcnt(5)
    v_xor_b32 v176, 65536, v2
    v_bfe_u32 v177, v174, 1, 2
    v_mfma_f32_16x16x32_bf16 v[178:181], v[32:35], v[126:129], v[178:181]
    s_waitcnt lgkmcnt(4)
    v_xor_b32 v177, v177, v255
    v_lshl_add_u32 v177, v174, 2, v177
    v_lshl_add_u32 v118, v177, 4, s5
    v_mfma_f32_16x16x32_bf16 v[126:129], a[216:219], v[130:133], 0
    s_waitcnt lgkmcnt(3)
    v_lshl_add_u32 v119, v177, 3, s5
    v_lshl_add_u32 v120, v254, 4, s5
    v_lshl_add_u32 v121, v254, 3, s5
    v_mfma_f32_16x16x32_bf16 v[126:129], a[220:223], v[134:137], v[126:129]
    s_waitcnt lgkmcnt(2)
    v_lshlrev_b32 v177, 2, v177
    v_mul_f32 v178, 0x3baaaaab, v178
    v_rsq_f32 v178, v178
    v_mfma_f32_16x16x32_bf16 v[126:129], a[224:227], v[142:145], v[126:129]
    s_waitcnt lgkmcnt(0)
    ds_permute_b32 v181, v177, v15
    ds_permute_b32 v182, v177, v18
    v_mul_f32 v122, v178, v122
    v_mfma_f32_16x16x32_bf16 v[126:129], a[228:231], v[146:149], v[126:129]
    ds_permute_b32 v183, v177, v16
    ds_permute_b32 v184, v177, v19
    v_mul_f32 v123, v178, v123
    v_mfma_f32_16x16x32_bf16 v[126:129], a[232:235], v[158:161], v[126:129]
    ds_permute_b32 v185, v177, v17
    ds_permute_b32 v186, v177, v20
    v_cvt_pk_bf16_f32 v122, v122, v123
    v_mfma_f32_16x16x32_bf16 v[126:129], a[236:239], v[170:173], v[126:129]
    v_mul_f32 v124, v178, v124
    v_mul_f32 v125, v178, v125
    v_cvt_pk_bf16_f32 v123, v124, v125
    v_mfma_f32_16x16x32_bf16 v[190:193], a[240:243], v[130:133], 0
    v_mul_f32 v154, v178, v154
    v_mul_f32 v155, v178, v155
    v_cvt_pk_bf16_f32 v124, v154, v155
    v_mfma_f32_16x16x32_bf16 v[190:193], a[244:247], v[134:137], v[190:193]
    v_mul_f32 v156, v178, v156
    v_mul_f32 v157, v178, v157
    v_cvt_pk_bf16_f32 v125, v156, v157
    v_mfma_f32_16x16x32_bf16 v[190:193], a[248:251], v[142:145], v[190:193]
    s_waitcnt lgkmcnt(4)
    ds_read_b128 v[154:157], v2 offset:6144
    v_mul_f32 v202, v178, v202
    v_mul_f32 v203, v178, v203
    v_mfma_f32_16x16x32_bf16 v[190:193], a[252:255], v[146:149], v[190:193]
    s_waitcnt lgkmcnt(3)
    ds_read_b128 v[194:197], v2 offset:7168
    v_cvt_pk_bf16_f32 v188, v202, v203
    v_mul_f32 v204, v178, v204
    v_mfma_f32_16x16x32_bf16 v[190:193], v[82:85], v[158:161], v[190:193]
    s_waitcnt lgkmcnt(2)
    ds_read_b128 v[198:201], v2 offset:8192
    v_mul_f32 v205, v178, v205
    v_cvt_pk_bf16_f32 v189, v204, v205
    v_mfma_f32_16x16x32_bf16 v[190:193], v[86:89], v[170:173], v[190:193]
    ds_read_b128 v[202:205], v2 offset:9216
    v_fma_f32 v177, v126, v126, s33
    v_fmac_f32 v177, v127, v127
    v_mfma_f32_16x16x32_bf16 v[206:209], v[90:93], v[130:133], 0
    ds_read_b128 v[130:133], v2 offset:10240
    v_fmac_f32 v177, v128, v128
    v_fmac_f32 v177, v129, v129
    v_mfma_f32_16x16x32_bf16 v[206:209], v[94:97], v[134:137], v[206:209]
    ds_read_b128 v[134:137], v2 offset:11264
    v_fmac_f32 v177, v190, v190
    v_fmac_f32 v177, v191, v191
    v_mfma_f32_16x16x32_bf16 v[206:209], v[98:101], v[142:145], v[206:209]
    s_waitcnt lgkmcnt(5)
    buffer_store_dwordx4 v[122:125], v15, s[12:15], s27 offen nt
    v_fmac_f32 v177, v192, v192
    v_fmac_f32 v177, v193, v193
    v_mul_f32 v187, 0x3baaaaab, v179
    v_mfma_f32_16x16x32_bf16 v[206:209], v[102:105], v[146:149], v[206:209]
    s_waitcnt lgkmcnt(4)
    v_rsq_f32 v187, v187
    v_sub_u32 v178, 0x40800000, v44
    v_mfma_f32_16x16x32_bf16 v[206:209], v[106:109], v[158:161], v[206:209]
    s_waitcnt lgkmcnt(3)
    v_mul_f32 v114, v187, v114
    v_mul_f32 v115, v187, v115
    v_cvt_pk_bf16_f32 v114, v114, v115
    v_mfma_f32_16x16x32_bf16 v[206:209], v[110:113], v[170:173], v[206:209]
    s_waitcnt lgkmcnt(2)
    v_mul_f32 v116, v187, v116
    v_mul_f32 v117, v187, v117
    v_cvt_pk_bf16_f32 v115, v116, v117
    v_mfma_f32_16x16x32_bf16 v[122:125], a[216:219], v[154:157], 0
    s_waitcnt lgkmcnt(1)
    v_mul_f32 v166, v187, v166
    v_mul_f32 v167, v187, v167
    v_fmac_f32 v177, v206, v206
    v_mfma_f32_16x16x32_bf16 v[122:125], a[220:223], v[194:197], v[122:125]
    s_waitcnt lgkmcnt(0)
    v_fmac_f32 v177, v207, v207
    v_fmac_f32 v177, v208, v208
    v_fmac_f32 v177, v209, v209
    v_mfma_f32_16x16x32_bf16 v[122:125], a[224:227], v[198:201], v[122:125]
    v_cvt_pk_bf16_f32 v116, v166, v167
    v_mul_f32 v168, v187, v168
    v_mul_f32 v169, v187, v169
    v_mfma_f32_16x16x32_bf16 v[122:125], a[228:231], v[202:205], v[122:125]
    v_cvt_pk_bf16_f32 v117, v168, v169
    v_mul_f32 v230, v187, v230
    v_mul_f32 v231, v187, v231
    v_mfma_f32_16x16x32_bf16 v[122:125], a[232:235], v[130:133], v[122:125]
    v_cvt_pk_bf16_f32 v230, v230, v231
    v_mul_f32 v232, v187, v232
    v_mul_f32 v233, v187, v233
    v_mfma_f32_16x16x32_bf16 v[122:125], a[236:239], v[134:137], v[122:125]
    v_cvt_pk_bf16_f32 v231, v232, v233
    v_or_b32 v178, v178, v44
    v_lshl_add_u32 v179, s16, 2, v176
    v_mfma_f32_16x16x32_bf16 v[142:145], a[240:243], v[154:157], 0
    ds_write_b32 v179, v178 offset:18432
    v_mul_f32 v187, 0x3baaaaab, v180
    v_mfma_f32_16x16x32_bf16 v[142:145], a[244:247], v[194:197], v[142:145]
    v_rsq_f32 v187, v187
    v_fma_f32 v232, v122, v122, s33
    v_mfma_f32_16x16x32_bf16 v[142:145], a[248:251], v[198:201], v[142:145]
    ds_read_b128 v[146:149], v2 offset:12288
    v_fmac_f32 v232, v123, v123
    v_fmac_f32 v232, v124, v124
    v_mfma_f32_16x16x32_bf16 v[142:145], a[252:255], v[202:205], v[142:145]
    ds_read_b128 v[158:161], v2 offset:13312
    v_fmac_f32 v232, v125, v125
    v_mul_f32 v150, v187, v150
    v_mfma_f32_16x16x32_bf16 v[142:145], v[82:85], v[130:133], v[142:145]
    ds_read_b128 v[166:169], v2 offset:14336
    v_mul_f32 v151, v187, v151
    v_cvt_pk_bf16_f32 v150, v150, v151
    v_mfma_f32_16x16x32_bf16 v[142:145], v[86:89], v[134:137], v[142:145]
    ds_read_b128 v[170:173], v2 offset:15360
    v_mul_f32 v152, v187, v152
    v_mul_f32 v153, v187, v153
    v_mfma_f32_16x16x32_bf16 v[210:213], v[90:93], v[154:157], 0
    ds_read_b128 v[154:157], v2 offset:16384
    v_cvt_pk_bf16_f32 v151, v152, v153
    v_mul_f32 v162, v187, v162
    v_mfma_f32_16x16x32_bf16 v[210:213], v[94:97], v[194:197], v[210:213]
    ds_read_b128 v[194:197], v2 offset:17408
    v_fmac_f32 v232, v142, v142
    v_fmac_f32 v232, v143, v143
    v_mfma_f32_16x16x32_bf16 v[210:213], v[98:101], v[198:201], v[210:213]
    s_waitcnt lgkmcnt(5)
    buffer_store_dwordx2 v[188:189], v18, s[12:15], s27 offen nt
    v_fmac_f32 v232, v144, v144
    v_mfma_f32_16x16x32_bf16 v[210:213], v[102:105], v[202:205], v[210:213]
    s_waitcnt lgkmcnt(4)
    v_fmac_f32 v232, v145, v145
    v_mul_f32 v163, v187, v163
    v_cvt_pk_bf16_f32 v152, v162, v163
    v_mfma_f32_16x16x32_bf16 v[210:213], v[106:109], v[130:133], v[210:213]
    s_waitcnt lgkmcnt(3)
    v_mul_f32 v164, v187, v164
    v_mul_f32 v165, v187, v165
    v_cvt_pk_bf16_f32 v153, v164, v165
    v_mfma_f32_16x16x32_bf16 v[210:213], v[110:113], v[134:137], v[210:213]
    s_waitcnt lgkmcnt(2)
    ds_write_b128 v118, v[150:153] offset:3072
    v_mfma_f32_16x16x32_bf16 v[130:133], a[216:219], v[146:149], 0
    s_waitcnt lgkmcnt(2)
    v_mul_f32 v138, v187, v138
    v_mul_f32 v139, v187, v139
    v_cvt_pk_bf16_f32 v138, v138, v139
    v_mfma_f32_16x16x32_bf16 v[130:133], a[220:223], v[158:161], v[130:133]
    s_waitcnt lgkmcnt(1)
    v_fmac_f32 v232, v210, v210
    v_fmac_f32 v232, v211, v211
    v_fmac_f32 v232, v212, v212
    v_mfma_f32_16x16x32_bf16 v[130:133], a[224:227], v[166:169], v[130:133]
    ds_read_b128 v[134:137], v120 offset:3072
    v_fmac_f32 v232, v213, v213
    v_cvt_pk_bf16_f32 v188, v177, v232
    v_mfma_f32_16x16x32_bf16 v[130:133], a[228:231], v[170:173], v[130:133]
    v_cvt_pk_bf16_f32 v189, v232, v232
    v_mul_f32 v140, v187, v140
    v_mul_f32 v141, v187, v141
    v_mfma_f32_16x16x32_bf16 v[130:133], a[232:235], v[154:157], v[130:133]
    ds_write_b64 v4, v[188:189] offset:0
    v_mfma_f32_16x16x32_bf16 v[130:133], a[236:239], v[194:197], v[130:133]
    v_cvt_pk_bf16_f32 v139, v140, v141
    v_mov_b32 v177, 0x40000000
    v_lshrrev_b32 v232, 2, v254
    v_mfma_f32_16x16x32_bf16 v[150:153], a[240:243], v[146:149], 0
    ds_write_b64 v119, v[138:139] offset:4096
    v_mfma_f32_16x16x32_bf16 v[150:153], a[244:247], v[158:161], v[150:153]
    v_lshrrev_b32 v233, 3, v254
    v_xor_b32 v233, v233, v254
    v_fma_f32 v254, v130, v130, s33
    v_mfma_f32_16x16x32_bf16 v[150:153], a[248:251], v[166:169], v[150:153]
    s_waitcnt lgkmcnt(2)
    ds_read_b128 v[138:141], v175 offset:0
    ds_read_b64 v[178:179], v121 offset:4096
    v_fmac_f32 v254, v131, v131
    v_mfma_f32_16x16x32_bf16 v[150:153], a[252:255], v[170:173], v[150:153]
    ds_read_b128 v[162:165], v175 offset:2048
    v_fmac_f32 v254, v132, v132
    v_fmac_f32 v254, v133, v133
    v_mfma_f32_16x16x32_bf16 v[150:153], v[82:85], v[154:157], v[150:153]
    s_waitcnt lgkmcnt(4)
    ds_read_b128 v[198:201], v175 offset:4096
    v_and_b32 v233, 3, v233
    v_add_u32 v180, 0, v232
    v_mfma_f32_16x16x32_bf16 v[150:153], v[86:89], v[194:197], v[150:153]
    s_barrier
    ds_read_b128 v[202:205], v176 offset:0
    ds_read_b128 v[214:217], v176 offset:1024
    v_mul_u32_u24 v232, s20, v180
    v_mfma_f32_16x16x32_bf16 v[218:221], v[90:93], v[146:149], 0
    ds_read_b128 v[146:149], v175 offset:6144
    ds_read_b128 v[222:225], v175 offset:8192
    v_add_u32 v232, s38, v232
    v_mfma_f32_16x16x32_bf16 v[218:221], v[94:97], v[158:161], v[218:221]
    ds_read_b128 v[158:161], v175 offset:10240
    v_fmac_f32 v254, v150, v150
    v_fmac_f32 v254, v151, v151
    v_mfma_f32_16x16x32_bf16 v[218:221], v[98:101], v[166:169], v[218:221]
    s_waitcnt lgkmcnt(7)
    buffer_store_dwordx4 v[114:117], v16, s[12:15], s27 offen nt
    ds_read_b128 v[166:169], v176 offset:18432
    v_fmac_f32 v254, v152, v152
    v_fmac_f32 v254, v153, v153
    v_mfma_f32_16x16x32_bf16 v[218:221], v[102:105], v[170:173], v[218:221]
    s_waitcnt lgkmcnt(7)
    v_mul_u32_u24 v187, 911, v232
    v_lshrrev_b32 v187, 16, v187
    v_mul_u32_u24 v187, s22, v187
    v_mfma_f32_16x16x32_bf16 v[218:221], v[106:109], v[154:157], v[218:221]
    s_waitcnt lgkmcnt(6)
    v_mad_u32_u24 v187, v180, s21, v187
    v_bfe_u32 v232, s63, v180, 1
    v_cmp_ne_u32 vcc, 0, v232
    v_mfma_f32_16x16x32_bf16 v[218:221], v[110:113], v[194:197], v[218:221]
    s_waitcnt lgkmcnt(4)
    v_add_u32 v180, s7, v187
    v_cndmask_b32 v180, v177, v180, vcc
    v_mfma_f32_16x16x32_bf16 v[114:117], v[32:35], v[202:205], 0
    s_waitcnt lgkmcnt(2)
    v_lshl_add_u32 v187, v233, 4, v180
    v_add_u32 v187, s3, v187
    v_mfma_f32_16x16x32_bf16 v[114:117], v[32:35], v[214:217], v[114:117]
    s_waitcnt lgkmcnt(1)
    v_fmac_f32 v254, v218, v218
    v_fmac_f32 v254, v219, v219
    v_fmac_f32 v254, v220, v220
    v_mfma_f32_16x16x32_bf16 v[154:157], a[216:219], v[138:141], 0
    v_fmac_f32 v254, v221, v221
    v_cvt_pk_bf16_f32 v188, v254, v254
    v_cvt_pk_bf16_f32 v189, v254, v254
    v_mfma_f32_16x16x32_bf16 v[154:157], a[220:223], v[162:165], v[154:157]
    s_waitcnt lgkmcnt(0)
    ds_write_b64 v4, v[188:189] offset:2048
    v_mfma_f32_16x16x32_bf16 v[154:157], a[224:227], v[198:201], v[154:157]
    v_lshl_add_u32 v254, v233, 3, v180
    v_add_u32 v254, s4, v254
    v_add_u32 v174, 16, v174
    v_mfma_f32_16x16x32_bf16 v[154:157], a[228:231], v[146:149], v[154:157]
    v_min_u32 v180, 20, v174
    v_add_u32 v116, 12, v174
    v_lshrrev_b32 v116, 5, v116
    v_mfma_f32_16x16x32_bf16 v[154:157], a[232:235], v[222:225], v[154:157]
    v_sub_u32 v117, v174, v180
    v_mad_i32_i24 v117, v116, s6, v117
    v_mul_u32_u24 v188, s20, v180
    v_mfma_f32_16x16x32_bf16 v[154:157], a[236:239], v[158:161], v[154:157]
    v_add3_u32 v188, v188, v117, s38
    v_mul_u32_u24 v116, 911, v188
    v_lshrrev_b32 v116, 16, v116
    v_mfma_f32_16x16x32_bf16 v[170:173], a[240:243], v[138:141], 0
    v_mul_u32_u24 v116, s22, v116
    v_mad_u32_u24 v116, v180, s21, v116
    v_bfe_u32 v188, s63, v174, 1
    v_mfma_f32_16x16x32_bf16 v[170:173], a[244:247], v[162:165], v[170:173]
    buffer_store_dwordx2 v[230:231], v19, s[12:15], s27 offen nt
    v_fma_f32 v180, v154, v154, s33
    v_mfma_f32_16x16x32_bf16 v[170:173], a[248:251], v[198:201], v[170:173]
    ds_read_b128 v[194:197], v175 offset:256
    v_fmac_f32 v180, v155, v155
    v_fmac_f32 v180, v156, v156
    v_mfma_f32_16x16x32_bf16 v[170:173], a[252:255], v[146:149], v[170:173]
    ds_read_b128 v[202:205], v175 offset:2304
    v_fmac_f32 v180, v157, v157
    v_cmp_ne_u32 vcc, 0, v188
    v_mfma_f32_16x16x32_bf16 v[170:173], v[82:85], v[222:225], v[170:173]
    ds_read_b128 v[214:217], v175 offset:4352
    v_mul_i32_i24 v117, 2688, v117
    v_add3_u32 v174, v116, v117, s7
    v_mfma_f32_16x16x32_bf16 v[170:173], v[86:89], v[158:161], v[170:173]
    ds_read_b128 v[226:229], v175 offset:6400
    v_cndmask_b32 v174, v177, v174, vcc
    v_lshl_add_u32 v188, v255, 4, v174
    v_mfma_f32_16x16x32_bf16 v[230:233], v[90:93], v[138:141], 0
    ds_read_b128 v[138:141], v175 offset:8448
    v_add_u32 v188, s3, v188
    v_lshl_add_u32 v255, v255, 3, v174
    v_mfma_f32_16x16x32_bf16 v[230:233], v[94:97], v[162:165], v[230:233]
    ds_read_b128 v[162:165], v175 offset:10496
    v_fmac_f32 v180, v170, v170
    v_fmac_f32 v180, v171, v171
    v_mfma_f32_16x16x32_bf16 v[230:233], v[98:101], v[198:201], v[230:233]
    s_waitcnt lgkmcnt(5)
    v_fmac_f32 v180, v172, v172
    v_fmac_f32 v180, v173, v173
    v_add_u32 v255, s4, v255
    v_mfma_f32_16x16x32_bf16 v[230:233], v[102:105], v[146:149], v[230:233]
    s_waitcnt lgkmcnt(4)
    v_mul_f32 v189, 0x3baaaaab, v114
    v_mul_f32 v174, 0x3baaaaab, v115
    v_rsq_f32 v189, v189
    v_mfma_f32_16x16x32_bf16 v[230:233], v[106:109], v[222:225], v[230:233]
    s_waitcnt lgkmcnt(3)
    v_mul_f32 v126, v189, v126
    v_mul_f32 v127, v189, v127
    v_cvt_pk_bf16_f32 v114, v126, v127
    v_mfma_f32_16x16x32_bf16 v[230:233], v[110:113], v[158:161], v[230:233]
    s_waitcnt lgkmcnt(2)
    v_mul_f32 v128, v189, v128
    v_mul_f32 v129, v189, v129
    v_cvt_pk_bf16_f32 v115, v128, v129
    v_mfma_f32_16x16x32_bf16 v[126:129], a[216:219], v[194:197], 0
    s_waitcnt lgkmcnt(1)
    v_mul_f32 v190, v189, v190
    v_mul_f32 v191, v189, v191
    v_fmac_f32 v180, v230, v230
    v_mfma_f32_16x16x32_bf16 v[126:129], a[220:223], v[202:205], v[126:129]
    s_waitcnt lgkmcnt(0)
    v_fmac_f32 v180, v231, v231
    v_fmac_f32 v180, v232, v232
    v_fmac_f32 v180, v233, v233
    v_mfma_f32_16x16x32_bf16 v[126:129], a[224:227], v[214:217], v[126:129]
    buffer_store_dwordx4 v[134:137], v185, s[12:15], s27 offen nt
    v_cvt_pk_bf16_f32 v146, v180, v180
    v_cvt_pk_bf16_f32 v147, v180, v180
    v_cvt_pk_bf16_f32 v116, v190, v191
    v_mfma_f32_16x16x32_bf16 v[126:129], a[228:231], v[226:229], v[126:129]
    ds_write_b64 v4, v[146:147] offset:4096
    v_mfma_f32_16x16x32_bf16 v[126:129], a[232:235], v[138:141], v[126:129]
    v_mul_f32 v192, v189, v192
    v_mul_f32 v193, v189, v193
    v_cvt_pk_bf16_f32 v117, v192, v193
    v_mfma_f32_16x16x32_bf16 v[126:129], a[236:239], v[162:165], v[126:129]
    ds_write_b128 v118, v[114:117] offset:4608
    v_mfma_f32_16x16x32_bf16 v[114:117], a[240:243], v[194:197], 0
    buffer_store_dwordx2 v[178:179], v186, s[12:15], s27 offen nt
    v_mul_f32 v206, v189, v206
    v_mfma_f32_16x16x32_bf16 v[114:117], a[244:247], v[202:205], v[114:117]
    s_mov_b32 s14, s36
    v_mul_f32 v207, v189, v207
    v_cvt_pk_bf16_f32 v206, v206, v207
    v_fma_f32 v175, v126, v126, s33
    v_mfma_f32_16x16x32_bf16 v[114:117], a[248:251], v[214:217], v[114:117]
    ds_read_b128 v[134:137], v120 offset:4608
    v_fmac_f32 v175, v127, v127
    v_fmac_f32 v175, v128, v128
    v_mfma_f32_16x16x32_bf16 v[114:117], a[252:255], v[226:229], v[114:117]
    s_waitcnt lgkmcnt(2)
    v_fmac_f32 v175, v129, v129
    v_mul_f32 v208, v189, v208
    v_mul_f32 v209, v189, v209
    v_mfma_f32_16x16x32_bf16 v[114:117], v[82:85], v[138:141], v[114:117]
    s_barrier
    ds_read_b128 v[146:149], v176 offset:2048
    ds_read_b128 v[158:161], v176 offset:3072
    v_cvt_pk_bf16_f32 v207, v208, v209
    v_mfma_f32_16x16x32_bf16 v[114:117], v[86:89], v[162:165], v[114:117]
    ds_read_b128 v[190:193], v176 offset:4096
    ds_read_b128 v[198:201], v176 offset:5120
    v_rsq_f32 v174, v174
    v_mfma_f32_16x16x32_bf16 v[222:225], v[90:93], v[194:197], 0
    ds_write_b64 v119, v[206:207] offset:5632
    v_mfma_f32_16x16x32_bf16 v[222:225], v[94:97], v[202:205], v[222:225]
    v_mul_f32 v122, v174, v122
    v_mul_f32 v123, v174, v123
    v_fmac_f32 v175, v114, v114
    v_mfma_f32_16x16x32_bf16 v[222:225], v[98:101], v[214:217], v[222:225]
    s_waitcnt lgkmcnt(5)
    buffer_store_dwordx4 v[134:137], v181, s[12:15], s26 offen nt
    ds_read_b64 v[178:179], v121 offset:5632
    v_fmac_f32 v175, v115, v115
    v_fmac_f32 v175, v116, v116
    v_mfma_f32_16x16x32_bf16 v[222:225], v[102:105], v[226:229], v[222:225]
    v_fmac_f32 v175, v117, v117
    v_cvt_pk_bf16_f32 v122, v122, v123
    v_mul_f32 v124, v174, v124
    v_mfma_f32_16x16x32_bf16 v[222:225], v[106:109], v[138:141], v[222:225]
    s_waitcnt lgkmcnt(4)
    v_mul_f32 v125, v174, v125
    v_cvt_pk_bf16_f32 v123, v124, v125
    v_mfma_f32_16x16x32_bf16 v[134:137], v[32:35], v[146:149], 0
    s_waitcnt lgkmcnt(2)
    v_mul_f32 v142, v174, v142
    v_mul_f32 v143, v174, v143
    v_mfma_f32_16x16x32_bf16 v[134:137], v[32:35], v[158:161], v[134:137]
    v_cvt_pk_bf16_f32 v124, v142, v143
    v_mul_f32 v144, v174, v144
    v_mfma_f32_16x16x32_bf16 v[138:141], v[32:35], v[190:193], 0
    v_mul_f32 v145, v174, v145
    v_cvt_pk_bf16_f32 v125, v144, v145
    v_mfma_f32_16x16x32_bf16 v[138:141], v[32:35], v[198:201], v[138:141]
    ds_write_b128 v118, v[122:125] offset:6144
    v_mfma_f32_16x16x32_bf16 v[222:225], v[110:113], v[162:165], v[222:225]
    s_waitcnt lgkmcnt(1)
    buffer_store_dwordx2 v[178:179], v182, s[12:15], s26 offen nt
    v_mul_f32 v210, v174, v210
    v_mul_f32 v211, v174, v211
    v_cvt_pk_bf16_f32 v210, v210, v211
    ds_read_b128 v[122:125], v120 offset:6144
    v_mul_f32 v212, v174, v212
    v_mul_f32 v213, v174, v213
    v_fmac_f32 v175, v222, v222
    v_fmac_f32 v175, v223, v223
    v_fmac_f32 v175, v224, v224
    v_fmac_f32 v175, v225, v225
    v_cvt_pk_bf16_f32 v174, v175, v175
    v_cvt_pk_bf16_f32 v175, v175, v175
    ds_write_b64 v4, v[174:175] offset:6144
    v_cvt_pk_bf16_f32 v211, v212, v213
    v_mul_f32 v189, 0x3baaaaab, v134
    v_rsq_f32 v189, v189
    ds_write_b64 v119, v[210:211] offset:7168
    v_mul_f32 v130, v189, v130
    v_mul_f32 v131, v189, v131
    v_cvt_pk_bf16_f32 v130, v130, v131
    ds_read_b64 v[140:141], v121 offset:7168
    s_waitcnt lgkmcnt(3)
    buffer_store_dwordx4 v[122:125], v183, s[12:15], s26 offen nt
    v_mul_f32 v132, v189, v132
    v_mul_f32 v133, v189, v133
    v_cvt_pk_bf16_f32 v131, v132, v133
    v_mul_f32 v150, v189, v150
    v_mul_f32 v151, v189, v151
    v_cvt_pk_bf16_f32 v132, v150, v151
    v_mul_f32 v152, v189, v152
    s_waitcnt lgkmcnt(2)
    s_barrier
    ds_read_b128 v[122:125], v176 offset:6144
    ds_read_b128 v[134:137], v176 offset:7168
    v_mul_f32 v153, v189, v153
    v_cvt_pk_bf16_f32 v133, v152, v153
    ds_write_b128 v118, v[130:133] offset:0
    v_mul_f32 v218, v189, v218
    v_mul_f32 v219, v189, v219
    v_cvt_pk_bf16_f32 v218, v218, v219
    v_mul_f32 v220, v189, v220
    s_waitcnt lgkmcnt(3)
    buffer_store_dwordx2 v[140:141], v184, s[12:15], s26 offen nt
    ds_read_b128 v[130:133], v120 offset:0
    v_mul_f32 v221, v189, v221
    v_cvt_pk_bf16_f32 v219, v220, v221
    ds_write_b64 v119, v[218:219] offset:1024
    s_waitcnt lgkmcnt(4)
    v_mfma_f32_16x16x32_bf16 v[142:145], v[32:35], v[122:125], 0
    s_waitcnt lgkmcnt(3)
    v_mul_f32 v189, 0x3baaaaab, v138
    v_or3_b32 v166, v166, v167, v168
    v_mfma_f32_16x16x32_bf16 v[142:145], v[32:35], v[134:137], v[142:145]
    ds_read_b64 v[182:183], v121 offset:1024
    v_rsq_f32 v189, v189
    v_or_b32 v166, v166, v169
    v_mul_f32 v154, v189, v154
    v_mul_f32 v155, v189, v155
    v_cvt_pk_bf16_f32 v122, v154, v155
    v_mul_f32 v156, v189, v156
    v_mul_f32 v157, v189, v157
    v_cvt_pk_bf16_f32 v123, v156, v157
    v_mul_f32 v170, v189, v170
    v_mul_f32 v171, v189, v171
    v_cvt_pk_bf16_f32 v124, v170, v171
    s_waitcnt lgkmcnt(2)
    buffer_store_dwordx4 v[130:133], v185, s[12:15], s26 offen nt
    v_mul_f32 v172, v189, v172
    v_mul_f32 v173, v189, v173
    v_cvt_pk_bf16_f32 v125, v172, v173
    ds_write_b128 v118, v[122:125] offset:1536
    v_mul_f32 v230, v189, v230
    s_waitcnt lgkmcnt(1)
    v_mul_f32 v231, v189, v231
    v_cvt_pk_bf16_f32 v184, v230, v231
    v_mul_f32 v232, v189, v232
    v_mul_f32 v233, v189, v233
    buffer_store_dwordx2 v[182:183], v186, s[12:15], s26 offen nt
    ds_read_b128 v[122:125], v120 offset:1536
    v_cvt_pk_bf16_f32 v185, v232, v233
    ds_write_b64 v119, v[184:185] offset:2560
    v_mul_f32 v186, 0x3baaaaab, v142
    v_rsq_f32 v186, v186
    ds_read_b64 v[168:169], v121 offset:2560
    v_mul_f32 v126, v186, v126
    v_mul_f32 v127, v186, v127
    v_cvt_pk_bf16_f32 v118, v126, v127
    v_mul_f32 v128, v186, v128
    v_mul_f32 v129, v186, v129
    v_cvt_pk_bf16_f32 v119, v128, v129
    v_mul_f32 v114, v186, v114
    v_mul_f32 v115, v186, v115
    v_cvt_pk_bf16_f32 v120, v114, v115
    v_mul_f32 v116, v186, v116
    v_mul_f32 v117, v186, v117
    v_cvt_pk_bf16_f32 v121, v116, v117
    buffer_store_dwordx4 v[118:121], v188, s[12:15], 0 offen nt
    s_waitcnt lgkmcnt(2)
    v_mul_f32 v222, v186, v222
    v_mul_f32 v223, v186, v223
    v_cvt_pk_bf16_f32 v188, v222, v223
    v_mul_f32 v224, v186, v224
    v_mul_f32 v225, v186, v225
    v_cvt_pk_bf16_f32 v189, v224, v225
    v_cmp_gt_i32 s[46:47], 0, v166
    s_waitcnt lgkmcnt(0)
    buffer_store_dwordx4 v[122:125], v187, s[12:15], 0 offen nt
    buffer_store_dwordx2 v[168:169], v254, s[12:15], 0 offen nt
    buffer_store_dwordx2 v[188:189], v255, s[12:15], 0 offen nt
    s_branch L_end
.section .rodata,"a"
.p2align 6
.amdhsa_kernel standalone__window_attn_swin_v2__vision_kernel
  .amdhsa_next_free_vgpr 512
  .amdhsa_next_free_sgpr 102
  .amdhsa_accum_offset 256
  .amdhsa_group_segment_fixed_size 0
  .amdhsa_kernarg_size 96
  .amdhsa_user_sgpr_count 2
  .amdhsa_user_sgpr_kernarg_segment_ptr 1
  .amdhsa_system_sgpr_workgroup_id_x 1
  .amdhsa_float_denorm_mode_32 3
.end_amdhsa_kernel
```

```asm
; @launch grid=(256,1,1) block=(256,1,1) lds=163840
.amdgcn_target "amdgcn-amd-amdhsa--gfx950"
.text
.globl standalone__window_attn_swin_v2__vision_kernel
.p2align 12
.p2align 8
.type standalone__window_attn_swin_v2__vision_kernel,@function
standalone__window_attn_swin_v2__vision_kernel:
    s_mov_b32 s44, 0
L_again:
    s_load_dwordx16 s[76:91], s[0:1], 0
    v_readfirstlane_b32 s16, v0
    s_cmp_ge_u32 s2, 256
    s_cbranch_scc1 L_done
    s_lshr_b32 s16, s16, 6
    s_cbranch_scc1 L_nopf
    s_getpc_b64 s[96:97]
    s_bfe_u32 s3, s2, 0x30003
    s_mul_i32 s3, s3, 44
    v_cmp_gt_u32 vcc, 20, v0
    v_add_u32 v254, s3, v0
    v_mov_b32 v255, 0
    v_cndmask_b32 v254, v254, v0, vcc
    v_lshlrev_b32 v254, 7, v254
    v_lshl_add_u64 v[254:255], s[96:97], 0, v[254:255]
    global_load_dword a255, v[254:255], off offset:992
L_nopf:
    s_max_u32 s3, s2, s44
    s_cmp_ge_u32 s3, 247
    s_cbranch_scc1 L_edge
    v_mov_b32 v254, v0
    v_mov_b32 v255, 0x40000000
    v_and_b32 v114, 63, v0
    s_bfe_u32 s3, s2, 0x50003
    s_lshl_b32 s4, s16, 3
    s_lshr_b32 s98, 0x06143a01, s4
    s_and_b32 s98, s98, 0xff
    s_mul_i32 s3, s3, s98
    s_sub_u32 s98, s98, 1
    s_lshr_b32 s4, 0x0048d800, s4
    s_and_b32 s4, s4, 0xff
    s_lshl_b32 s4, s4, 3
    s_max_u32 s4, s4, 6
    s_sub_u32 s4, s4, s98
    s_sub_u32 s4, s4, 1
    s_min_u32 s3, s3, s4
    v_min_u32 v116, s98, v114
    v_add_lshl_u32 v116, v116, s3, 7
    v_mov_b32 v117, 0
    v_lshrrev_b32 v115, 4, v114
    v_and_b32 v122, 15, v114
    s_mov_b32 s10, 100270464
    s_mov_b32 s11, 0x00020000
    s_mov_b32 s50, 36096
    s_mov_b32 s51, 0x00020000
    s_mul_i32 s3, s16, 96
    v_lshl_add_u32 v123, v114, 4, s3
    v_mul_u32_u24 v124, 171, v114
    v_lshrrev_b32 v124, 10, v124
    v_lshrrev_b32 v125, 1, v124
    v_xor_b32 v125, v125, v124
    v_and_b32 v125, 4, v125
    v_mul_u32_u24 v125, 3, v125
    v_xor_b32 v125, v125, v124
    v_mul_u32_u24 v125, 1152, v125
    v_mul_u32_u24 v130, 96, v124
    v_sub_u32 v125, v125, v130
    v_add_u32 v130, v123, v125
    v_add_u32 v125, 64, v114
    v_mul_u32_u24 v125, 171, v125
    v_lshrrev_b32 v125, 10, v125
    v_lshrrev_b32 v131, 1, v125
    v_xor_b32 v131, v131, v125
    v_and_b32 v131, 4, v131
    v_mul_u32_u24 v131, 3, v131
    v_xor_b32 v131, v131, v125
    v_mul_u32_u24 v131, 1152, v131
    v_mul_u32_u24 v132, 96, v125
    v_sub_u32 v131, v131, v132
    v_add_u32 v132, v123, v131
    v_add_u32 v131, 128, v114
    v_mul_u32_u24 v131, 171, v131
    v_lshrrev_b32 v131, 10, v131
    v_lshrrev_b32 v133, 1, v131
    v_xor_b32 v133, v133, v131
    v_and_b32 v133, 4, v133
    v_mul_u32_u24 v133, 3, v133
    v_xor_b32 v133, v133, v131
    v_mul_u32_u24 v133, 1152, v133
    v_mul_u32_u24 v134, 96, v131
    v_sub_u32 v133, v133, v134
    v_add_u32 v134, v123, v133
    s_mul_i32 s68, s16, 6144
    s_add_u32 s69, s68, 65536
    s_cmp_eq_u32 s16, 3
    s_cselect_b32 s68, 149696, s68
    s_cselect_b32 s69, 155840, s69
    s_waitcnt lgkmcnt(0)
    s_cmp_eq_u32 s16, 2
    s_cselect_b64 s[98:99], s[80:81], s[78:79]
    s_cmp_eq_u32 s16, 3
    s_cselect_b64 s[98:99], s[88:89], s[98:99]
    s_mov_b64 s[8:9], s[76:77]
    v_lshl_add_u64 v[116:117], s[98:99], 0, v[116:117]
    s_cmp_eq_u32 s16, 2
    s_cselect_b64 s[98:99], s[84:85], s[82:83]
    s_cmp_eq_u32 s16, 3
    s_cselect_b64 s[98:99], s[86:87], s[98:99]
    v_writelane_b32 v116, s98, 63
    v_writelane_b32 v117, s99, 63
    s_cmp_eq_u32 s16, 0
    s_cbranch_scc1 L_nowu
    global_load_dword a254, v[116:117], off
L_nowu:
    s_mov_b64 s[48:49], s[78:79]
    s_mov_b64 s[52:53], s[80:81]
    s_mov_b64 s[60:61], s[84:85]
    s_mov_b64 s[64:65], s[86:87]
    s_mov_b64 s[56:57], s[88:89]
    s_mov_b64 s[46:47], s[82:83]
    s_load_dwordx4 s[40:43], s[0:1], 72
    s_add_u32 s48, s48, 384
    s_addc_u32 s49, s49, 0
    s_add_u32 m0, s68, 0
    v_add_u32 v133, s16, v114
    v_and_b32 v133, 3, v133
    v_lshlrev_b32 v133, 1, v133
    s_mov_b32 s54, 12288
    s_mov_b32 s55, 0x00020000
    s_mov_b32 s62, 64
    s_mov_b32 s63, 0x00020000
    s_mov_b32 s66, 128
    s_mov_b32 s67, 0x00020000
    s_mov_b32 s58, 676
    s_mov_b32 s59, 0x00020000
    s_mov_b32 s14, 0
    s_mov_b32 s15, 0x00020000
    v_mov_b32 v123, 0
    v_cmp_lt_u32 s[92:93], 7, v122
    v_mov_b32 v137, 0
    v_mov_b32 v117, 0
    v_mov_b32 v119, 0
    v_lshlrev_b32 v116, 1, v114
    v_mul_u32_u24 v135, 12, v122
    s_mul_i32 s71, s16, 192
    v_add_u32 v135, s71, v135
    v_lshlrev_b32 v120, 5, v115
    s_mul_i32 s72, s16, 9408
    s_add_u32 s72, s72, 104448
    s_mul_i32 s73, s16, 7616
    s_add_u32 s73, s73, 38912
    s_cmp_eq_u32 s16, 3
    s_cselect_b32 s73, 142080, s73
    s_mov_b32 s70, 193536
    s_mov_b32 s36, 100270464
    s_mov_b32 s22, 1180032
    s_mul_i32 s3, s2, 911
    s_lshr_b32 s3, s3, 16
    s_mul_i32 s35, s3, 72
    s_sub_u32 s38, s2, s35
    s_mul_i32 s3, s3, 1373568
    s_mul_i32 s35, s38, 2688
    s_add_u32 s3, s3, s35
    s_add_u32 s25, s3, 589824
    s_add_u32 s7, s3, 1769472
    s_mov_b32 s20, 31
    s_mov_b32 s21, 4204032
    s_mov_b32 s17, 20
    s_cmp_lt_u32 s2, 240
    s_cselect_b32 s45, 28, 24
    s_bfm_b32 s34, s45, 0
    s_and_b32 s4, s2, 7
    s_sub_u32 s4, 0, s4
    s_lshl_b32 s28, s16, 10
    s_add_u32 s28, s28, 20480
    s_mov_b32 s76, 0x3f80
    s_mov_b32 s19, s38
    s_mov_b32 s23, s25
    s_mov_b32 s26, 0
    s_mov_b32 s27, 0
    s_mov_b32 s18, 0
    s_add_u32 s19, s19, s20
    s_add_u32 s23, s23, s21
    s_mul_i32 s79, s16, 64
    s_mul_i32 s80, s16, 32
    s_add_u32 s80, s80, 256
    s_mul_i32 s81, s16, 768
    s_add_u32 s81, s81, 98304
    s_mov_b32 s82, -24
    s_lshr_b32 s83, s16, 1
    s_and_b32 s84, s16, 1
    s_lshl_b32 s84, s84, 3
    s_lshl_b32 s85, s83, 10
    s_add_u32 s85, s85, s84
    s_lshl_b32 s83, s83, 11
    s_add_u32 s83, s83, s84
    s_add_u32 s83, s83, 157888
    s_mul_i32 s86, s16, 2048
    s_add_u32 s86, s86, 149696
    s_mul_i32 s87, s16, 128
    s_add_u32 s87, s87, 61760
    s_mov_b32 s32, 0x2a8cbccc
    s_mov_b32 s33, 0x38fba882
    s_add_u32 s75, s28, 16384
    s_cmp_lt_u32 s16, 2
    s_cselect_b32 s29, s75, 161984
    s_cselect_b32 s30, 65536, 0
    s_xor_b32 s74, s29, s30
    s_mul_i32 s77, s16, 64
    s_mul_i32 s78, s16, 32
    s_add_u32 s78, s78, 192
    s_mov_b32 s71, 1
    s_mov_b32 s27, s26
    s_mov_b32 s26, s25
    buffer_load_dwordx4 v130, s[48:51], 0 offen lds
    v_mul_u32_u24 v118, 2731, v254
    v_bfe_u32 v136, v118, 17, 3
    v_lshrrev_b32 v118, 16, v118
    buffer_load_dwordx4 v132, s[48:51], 0 offen offset:1024 lds
    v_xor_b32 v121, v136, v254
    v_mul_u32_u24 v136, 37, v118
    v_lshrrev_b32 v136, 8, v136
    buffer_load_dwordx4 v134, s[48:51], 0 offen offset:2048 lds
    s_add_u32 m0, s28, 65536
    s_add_u32 s48, s48, 36864
    s_addc_u32 s49, s49, 0
    v_lshlrev_b32 v121, 4, v121
    v_mad_u32_u24 v10, v136, s70, v121
    v_mul_u32_u24 v136, s20, v118
    v_add_u32 v136, s38, v136
    v_mul_u32_u24 v126, 911, v136
    v_lshrrev_b32 v126, 16, v126
    v_mul_u32_u24 v126, s22, v126
    v_mad_u32_u24 v126, v118, s21, v126
    v_bfe_u32 v136, s34, v118, 1
    v_cmp_ne_u32 vcc, 0, v136
    v_add_u32 v136, s7, v126
    v_mul_u32_u24 v118, 384, v118
    v_cndmask_b32 v136, v255, v136, vcc
    v_sub_u32 v118, v121, v118
    v_add_u32 v136, v136, v118
    buffer_load_dwordx4 v136, s[8:11], 0 offen nt lds
    s_add_u32 m0, s28, 69632
    v_add_u32 v136, 256, v254
    v_mul_u32_u24 v118, 2731, v136
    v_bfe_u32 v121, v118, 17, 3
    v_lshrrev_b32 v118, 16, v118
    v_xor_b32 v136, v121, v136
    v_mul_u32_u24 v121, 37, v118
    v_lshrrev_b32 v121, 8, v121
    v_lshlrev_b32 v136, 4, v136
    v_mad_u32_u24 v11, v121, s70, v136
    v_min_u32 v127, 20, v118
    v_add_u32 v126, 12, v118
    v_lshrrev_b32 v126, 5, v126
    v_sub_u32 v121, v118, v127
    v_mad_i32_i24 v121, v126, s4, v121
    v_mul_u32_u24 v128, s20, v127
    v_add3_u32 v128, v128, v121, s38
    v_mul_u32_u24 v126, 911, v128
    v_lshrrev_b32 v126, 16, v126
    v_mul_u32_u24 v126, s22, v126
    v_mad_u32_u24 v126, v127, s21, v126
    v_bfe_u32 v128, s34, v118, 1
    v_cmp_ne_u32 vcc, 0, v128
    v_mul_i32_i24 v121, 2688, v121
    v_add3_u32 v121, v126, v121, s7
    v_cndmask_b32 v121, v255, v121, vcc
    v_mul_u32_u24 v118, 384, v118
    v_sub_u32 v118, v136, v118
    v_add_u32 v121, v121, v118
    buffer_load_dwordx4 v121, s[8:11], 0 offen lds
    s_add_u32 m0, s28, 73728
    v_add_u32 v118, 512, v254
    v_mul_u32_u24 v121, 2731, v118
    v_bfe_u32 v136, v121, 17, 3
    v_lshrrev_b32 v121, 16, v121
    v_xor_b32 v118, v136, v118
    v_mul_u32_u24 v136, 37, v121
    v_lshrrev_b32 v136, 8, v136
    v_lshlrev_b32 v118, 4, v118
    v_mad_u32_u24 v12, v136, s70, v118
    v_min_u32 v127, 20, v121
    v_add_u32 v136, 12, v121
    v_lshrrev_b32 v136, 5, v136
    v_sub_u32 v126, v121, v127
    v_mad_i32_i24 v126, v136, s4, v126
    v_mul_u32_u24 v128, s20, v127
    v_add3_u32 v128, v128, v126, s38
    v_mul_u32_u24 v136, 911, v128
    v_lshrrev_b32 v136, 16, v136
    v_mul_u32_u24 v136, s22, v136
    v_mad_u32_u24 v136, v127, s21, v136
    v_bfe_u32 v128, s34, v121, 1
    v_cmp_ne_u32 vcc, 0, v128
    v_mul_i32_i24 v126, 2688, v126
    v_add3_u32 v136, v136, v126, s7
    v_cndmask_b32 v136, v255, v136, vcc
    v_mul_u32_u24 v121, 384, v121
    v_sub_u32 v121, v118, v121
    v_add_u32 v136, v136, v121
    s_cmp_ge_u32 s19, 72
    s_cselect_b32 s34, 72, 0
    s_cselect_b32 s35, s22, 0
    s_sub_u32 s19, s19, s34
    s_add_u32 s23, s23, s35
    s_mov_b32 s24, s23
    s_add_u32 s19, s19, s20
    s_add_u32 s23, s23, s21
    s_cmp_ge_u32 s19, 72
    s_cselect_b32 s34, 72, 0
    s_cselect_b32 s35, s22, 0
    s_sub_u32 s19, s19, s34
    s_add_u32 s23, s23, s35
    s_add_u32 s34, s18, 2
    s_mov_b32 s18, 1
    s_add_u32 s19, s19, s20
    buffer_load_dwordx4 v136, s[8:11], 0 offen lds
    s_add_u32 m0, s68, 3072
    v_lshrrev_b32 v136, 2, v122
    v_and_b32 v121, 1, v136
    v_mul_u32_u24 v121, 0x020202, v121
    v_lshl_or_b32 v121, v121, 8, v121
    v_add_u32 v121, 0x05040100, v121
    v_and_b32 v127, 3, v122
    v_lshrrev_b32 v118, 1, v122
    v_xor_b32 v118, v118, v115
    v_mul_u32_u24 v126, 384, v122
    v_lshl_add_u32 v0, v118, 4, v126
    v_xor_b32 v1, 64, v0
    v_and_b32 v118, 2, v115
    v_add_u32 v118, v118, v115
    v_lshl_add_u32 v118, v118, 2, v136
    v_mul_u32_u24 v118, 96, v118
    v_lshl_add_u32 v118, v127, 3, v118
    v_add_u32 v138, s68, v118
    buffer_load_dwordx4 v130, s[48:51], 0 offen lds
    v_add_u32 v193, s69, v118
    v_add_u32 v139, s72, v118
    v_add_u32 v140, s73, v118
    v_mov_b32 v28, 0x3f803f80
    v_mov_b32 v29, 0x3f803f80
    v_mov_b32 v30, 0x3f803f80
    v_mov_b32 v31, 0x3f803f80
    v_mul_u32_u24 v141, 768, v115
    v_add_u32 v141, v135, v141
    v_add_u32 v141, 98304, v141
    v_and_b32 v118, 1, v122
    v_lshlrev_b32 v118, 4, v118
    v_lshlrev_b32 v128, v118, s76
    v_mov_b32 v126, 0x3c003c00
    v_mov_b32 v44, 1.0
    v_lshlrev_b32 v190, 4, v115
    v_lshl_add_u32 v129, v115, 4, s79
    v_lshl_add_u32 v191, v115, 3, s80
    buffer_load_dwordx4 v132, s[48:51], 0 offen offset:1024 lds
    v_add_u32 v143, 0, v122
    v_mul_u32_u24 v192, 37, v143
    v_mul_u32_u24 v142, 384, v143
    v_lshrrev_b32 v192, 8, v192
    v_mad_u32_u24 v142, v192, s70, v142
    v_add_u32 v15, v142, v129
    v_add_u32 v18, v142, v191
    v_add_u32 v144, 16, v122
    v_mul_u32_u24 v142, 37, v144
    v_mul_u32_u24 v145, 384, v144
    v_lshrrev_b32 v142, 8, v142
    v_mad_u32_u24 v145, v142, s70, v145
    v_add_u32 v16, v145, v129
    v_add_u32 v19, v145, v191
    v_add_u32 v145, 32, v122
    v_mul_u32_u24 v147, 37, v145
    v_mul_u32_u24 v146, 384, v145
    v_lshrrev_b32 v147, 8, v147
    v_mad_u32_u24 v146, v147, s70, v146
    v_add_u32 v17, v146, v129
    v_add_u32 v20, v146, v191
    v_mul_u32_u24 v129, 24, v192
    v_lshl_add_u32 v129, v143, 2, v129
    v_add_u32 v22, s81, v129
    v_sub_u32 v23, s81, v129
    v_sub_u32 v129, v22, v190
    v_mul_u32_u24 v191, 24, v142
    v_lshl_add_u32 v191, v144, 2, v191
    v_add_u32 v24, s81, v191
    v_sub_u32 v25, s81, v191
    v_sub_u32 v191, v24, v190
    v_mul_u32_u24 v192, 24, v147
    v_lshl_add_u32 v192, v145, 2, v192
    v_add_u32 v26, s81, v192
    v_sub_u32 v27, s81, v192
    v_sub_u32 v192, v26, v190
    v_mul_u32_u24 v143, 148, v115
    v_add_u32 v142, 0, v143
    v_lshrrev_b32 v142, 8, v142
    v_mad_i32_i24 v46, v142, s82, v129
    v_mad_i32_i24 v58, v142, s82, v191
    v_mad_i32_i24 v70, v142, s82, v192
    v_add_u32 v142, 37, v143
    v_lshrrev_b32 v142, 8, v142
    v_mad_i32_i24 v47, v142, s82, v129
    v_mad_i32_i24 v59, v142, s82, v191
    v_mad_i32_i24 v71, v142, s82, v192
    v_add_u32 v142, 74, v143
    v_lshrrev_b32 v142, 8, v142
    v_mad_i32_i24 v48, v142, s82, v129
    v_mad_i32_i24 v60, v142, s82, v191
    v_mad_i32_i24 v72, v142, s82, v192
    v_add_u32 v142, 111, v143
    v_lshrrev_b32 v142, 8, v142
    v_mad_i32_i24 v49, v142, s82, v129
    v_mad_i32_i24 v61, v142, s82, v191
    v_mad_i32_i24 v73, v142, s82, v192
    v_add_u32 v142, 592, v143
    v_lshrrev_b32 v142, 8, v142
    v_mad_i32_i24 v50, v142, s82, v129
    v_mad_i32_i24 v62, v142, s82, v191
    v_mad_i32_i24 v74, v142, s82, v192
    v_add_u32 v142, 629, v143
    v_lshrrev_b32 v142, 8, v142
    v_mad_i32_i24 v51, v142, s82, v129
    v_mad_i32_i24 v63, v142, s82, v191
    v_mad_i32_i24 v75, v142, s82, v192
    v_add_u32 v142, 666, v143
    v_lshrrev_b32 v142, 8, v142
    v_mad_i32_i24 v52, v142, s82, v129
    v_mad_i32_i24 v64, v142, s82, v191
    v_mad_i32_i24 v76, v142, s82, v192
    v_add_u32 v142, 703, v143
    v_lshrrev_b32 v142, 8, v142
    buffer_load_dwordx4 v134, s[48:51], 0 offen offset:2048 lds
    s_add_u32 s48, s48, 36864
    s_addc_u32 s49, s49, 0
    s_add_u32 m0, s69, 0
    v_mad_i32_i24 v53, v142, s82, v129
    v_mad_i32_i24 v65, v142, s82, v191
    v_mad_i32_i24 v77, v142, s82, v192
    v_add_u32 v142, 1184, v143
    v_lshrrev_b32 v142, 8, v142
    v_mad_i32_i24 v54, v142, s82, v129
    v_mad_i32_i24 v66, v142, s82, v191
    v_mad_i32_i24 v78, v142, s82, v192
    v_add_u32 v142, 1221, v143
    v_lshrrev_b32 v142, 8, v142
    v_mad_i32_i24 v55, v142, s82, v129
    v_mad_i32_i24 v67, v142, s82, v191
    v_mad_i32_i24 v79, v142, s82, v192
    v_add_u32 v142, 1258, v143
    v_lshrrev_b32 v142, 8, v142
    buffer_load_dwordx4 v130, s[48:51], 0 offen lds
    v_mad_i32_i24 v56, v142, s82, v129
    v_mad_i32_i24 v68, v142, s82, v191
    v_mad_i32_i24 v80, v142, s82, v192
    v_add_u32 v142, 1295, v143
    v_lshrrev_b32 v142, 8, v142
    v_mad_i32_i24 v57, v142, s82, v129
    v_mad_i32_i24 v69, v142, s82, v191
    v_mad_i32_i24 v81, v142, s82, v192
    v_mov_b32 v191, s81
    v_lshlrev_b32 v129, 4, v114
    v_xor_b32 v2, 65536, v129
    v_lshl_add_u32 v3, s16, 10, v129
    v_add_u32 v4, s85, v129
    s_waitcnt vmcnt(7)
    ds_read_b64_tr_b16 a[72:73], v138 offset:0
    ds_read_b64_tr_b16 a[74:75], v138 offset:768
    ds_read_b64_tr_b16 a[96:97], v138 offset:32
    ds_read_b64_tr_b16 a[98:99], v138 offset:800
    ds_read_b64_tr_b16 a[120:121], v138 offset:64
    buffer_load_dwordx4 v132, s[48:51], 0 offen offset:1024 lds
    ds_read_b64_tr_b16 a[122:123], v138 offset:832
    v_lshl_add_u32 v143, v115, 3, s86
    v_mov_b32 v192, s83
    v_mov_b32 v129, 163264
    v_mul_u32_u24 v142, 80, v115
    v_add3_u32 v150, v142, v118, s72
    v_add_u32 v5, s72, v142
    v_lshl_add_u32 v6, v122, 2, s73
    v_add_u32 v9, s87, v190
    v_lshrrev_b32 v118, 1, v115
    v_mul_u32_u24 v118, 48, v118
    v_lshl_add_u32 v118, v115, 3, v118
    v_lshl_add_u32 v118, v136, 4, v118
    v_lshl_add_u32 v118, v127, 1, v118
    v_add_u32 v8, s87, v118
    v_mov_b32 v37, 0
    v_mov_b32 v38, 0
    v_mov_b32 v39, 0
    buffer_load_dwordx4 v134, s[48:51], 0 offen offset:2048 lds
    s_add_u32 s48, s48, 36864
    s_addc_u32 s49, s49, 0
    s_add_u32 m0, s69, 3072
    v_add_u32 v152, 86016, v0
    v_add_u32 v151, 86016, v1
    v_lshlrev_b32 v118, 4, v122
    v_add_u32 v118, 161984, v118
    v_mul_u32_u24 v144, 336, v122
    v_add3_u32 v144, v144, v142, s72
    v_mul_u32_u24 v153, 272, v122
    v_add3_u32 v153, v153, v190, s73
    v_mul_u32_u24 v154, 1088, v115
    v_add_u32 v154, v154, v6
    v_add_u32 v145, 5376, v144
    v_add_u32 v142, 4352, v153
    v_add_u32 v155, 4352, v154
    v_cmp_gt_u32 s[88:89], 16, v114
    v_mov_b32 v156, 0xf149f2ca
    v_add_u32 v157, 768, v254
    v_mul_u32_u24 v147, 2731, v157
    v_bfe_u32 v146, v147, 17, 3
    v_lshrrev_b32 v147, 16, v147
    v_xor_b32 v157, v146, v157
    v_mul_u32_u24 v146, 37, v147
    v_lshrrev_b32 v146, 8, v146
    v_lshlrev_b32 v157, 4, v157
    v_mad_u32_u24 v13, v146, s70, v157
    v_add_u32 v254, 1024, v254
    v_mul_u32_u24 v157, 2731, v254
    v_bfe_u32 v146, v157, 17, 3
    v_lshrrev_b32 v157, 16, v157
    v_xor_b32 v254, v146, v254
    v_mul_u32_u24 v146, 37, v157
    v_lshrrev_b32 v146, 8, v146
    v_lshlrev_b32 v254, 4, v254
    v_mad_u32_u24 v14, v146, s70, v254
    v_cmp_gt_u32 vcc, 48, v157
    v_mul_u32_u24 v157, 6, v124
    v_sub_u32 v254, v114, v157
    v_cndmask_b32 v14, v255, v14, vcc
    v_cmp_gt_u32 vcc, 2, v127
    v_mul_u32_u24 v157, 384, v124
    v_lshl_add_u32 v157, v254, 4, v157
    v_cndmask_b32 v32, 0, v128, vcc
    v_cndmask_b32 v33, v128, 0, vcc
    v_cndmask_b32 v34, 0, v128, vcc
    v_cndmask_b32 v35, v128, 0, vcc
    v_cmp_eq_u32 vcc, 0, v127
    v_add_u32 v255, s78, v157
    v_add_u32 v157, s77, v157
    v_cndmask_b32 v40, 0, v126, vcc
    v_cmp_eq_u32 vcc, 1, v127
    v_mul_u32_u24 v124, 6, v125
    v_sub_u32 v128, v114, v124
    v_cndmask_b32 v41, 0, v126, vcc
    v_cmp_eq_u32 vcc, 2, v127
    v_mul_u32_u24 v124, 384, v125
    v_lshl_add_u32 v124, v128, 4, v124
    v_cndmask_b32 v42, 0, v126, vcc
    v_cmp_eq_u32 vcc, 3, v127
    v_add_u32 v125, s78, v124
    v_add_u32 v124, s77, v124
    v_cndmask_b32 v43, 0, v126, vcc
    v_cmp_eq_u32 vcc, v115, v136
    v_mul_u32_u24 v126, 6, v131
    v_sub_u32 v114, v114, v126
    v_cndmask_b32 v162, 0, v32, vcc
    v_cndmask_b32 v163, 0, v33, vcc
    v_cmp_gt_i32 vcc, 4, v254
    v_mul_u32_u24 v126, 384, v131
    v_lshl_add_u32 v126, v114, 4, v126
    v_cndmask_b32 v157, v255, v157, vcc
    v_cmp_gt_i32 vcc, -60, v128
    v_add_u32 v128, s78, v126
    v_add_u32 v126, s77, v126
    v_cndmask_b32 v164, v125, v124, vcc
    v_cmp_gt_i32 vcc, -124, v114
    v_mul_u32_u24 v114, 96, v122
    v_add3_u32 v165, v114, v190, s68
    v_cndmask_b32 v254, v128, v126, vcc
    v_cmp_gt_u32 vcc, 2, v115
    v_lshl_add_u32 v255, v115, 3, v114
    v_add3_u32 v255, v255, 64, s68
    v_cndmask_b32 v143, v192, v143, vcc
    v_lshl_add_u32 v143, v136, 9, v143
    v_lshl_add_u32 v143, v127, 1, v143
    v_cmp_gt_u32 vcc, 3, v115
    v_add3_u32 v124, v114, v190, s69
    v_lshl_add_u32 v131, v115, 3, v114
    v_cndmask_b32 v7, v129, v143, vcc
    v_cmp_gt_u32 vcc, 12, v122
    v_add3_u32 v131, v131, 64, s69
    v_add_u32 v136, 16, v122
    v_cndmask_b32 v145, v118, v145, vcc
    v_cndmask_b32 v142, v118, v142, vcc
    v_cmp_gt_u32 vcc, 3, v115
    v_cmp_gt_u32 s[94:95], s45, v136
    v_cndmask_b32 v143, v118, v153, s[88:89]
    v_cndmask_b32 v155, v118, v155, vcc
    v_cndmask_b32 v192, v118, v142, s[88:89]
    v_add_u32 v5, 336, v5
    s_and_b32 s77, s2, 0xf8
    s_add_u32 s77, s77, 4940
    s_mul_i32 s78, s77, 58255
    s_lshr_b32 s78, s78, 22
    buffer_load_dwordx4 v130, s[48:51], 0 offen lds
    buffer_load_dwordx4 v132, s[48:51], 0 offen offset:1024 lds
    buffer_load_dwordx4 v134, s[48:51], 0 offen offset:2048 lds
    s_waitcnt vmcnt(9)
    s_barrier
    ds_read_b128 v[194:197], v152 offset:6144
    ds_read_b128 v[146:149], v151 offset:6144
    ds_read_b128 v[186:189], v152 offset:6272
    s_add_u32 s48, s48, 36864
    s_addc_u32 s49, s49, 0
    ds_read_b128 v[126:129], v151 offset:6272
    s_add_u32 m0, s72, 0
    ds_read_b128 v[234:237], v152 offset:6400
    ds_read_b128 v[158:161], v151 offset:6400
    ds_read_b128 v[206:209], v152 offset:0
    buffer_load_ushort v122, v116, s[60:63], 0 offen
    s_mov_b64 s[60:61], s[8:9]
    s_sub_u32 s62, s45, s17
    ds_read_b128 v[182:185], v151 offset:0
    s_sub_u32 s45, s17, 1
    s_waitcnt lgkmcnt(7)
    v_mfma_f32_16x16x32_bf16 v[166:169], a[72:75], v[194:197], 0
    s_bfm_b32 s63, s17, 0
    ds_read_b128 v[170:173], v152 offset:128
    s_min_u32 s70, s62, 4
    v_mfma_f32_16x16x32_bf16 v[178:181], a[96:99], v[194:197], 0
    s_lshr_b32 s83, s44, 8
    ds_read_b128 v[174:177], v151 offset:128
    s_cselect_b32 s70, 0, s70
    v_mfma_f32_16x16x32_bf16 v[202:205], a[120:123], v[194:197], 0
    s_waitcnt lgkmcnt(5)
    buffer_load_dwordx3 v[194:196], v135, s[56:59], 0 offen
    ds_read_b128 v[198:201], v152 offset:256
    ds_read_b128 v[210:213], v151 offset:256
    ds_read_b128 v[218:221], v152 offset:6144
    s_waitcnt lgkmcnt(6)
    v_mfma_f32_16x16x32_bf16 v[222:225], a[72:75], v[206:209], 0
    s_waitcnt lgkmcnt(5)
    ds_read_b128 v[214:217], v151 offset:6144
    v_mfma_f32_16x16x32_bf16 v[226:229], a[96:99], v[206:209], 0
    global_load_ushort v133, v133, s[46:47]
    s_waitcnt vmcnt(9)
    ds_read_b64_tr_b16 a[76:77], v138 offset:3072
    ds_read_b64_tr_b16 a[78:79], v138 offset:3840
    ds_read_b64_tr_b16 a[100:101], v138 offset:3104
    ds_read_b64_tr_b16 a[102:103], v138 offset:3872
    ds_read_b64_tr_b16 a[124:125], v138 offset:3136
    ds_read_b64_tr_b16 a[126:127], v138 offset:3904
    buffer_load_dwordx4 v130, s[48:51], 0 offen lds
    s_waitcnt lgkmcnt(4)
    v_mfma_f32_16x16x32_bf16 v[166:169], a[76:79], v[146:149], v[166:169]
    s_waitcnt lgkmcnt(3)
    v_mfma_f32_16x16x32_bf16 v[222:225], a[76:79], v[182:185], v[222:225]
    s_waitcnt lgkmcnt(1)
    v_mfma_f32_16x16x32_bf16 v[178:181], a[100:103], v[146:149], v[178:181]
    s_waitcnt lgkmcnt(0)
    v_mfma_f32_16x16x32_bf16 v[202:205], a[124:127], v[146:149], v[202:205]
    buffer_load_dwordx4 v[146:149], v120, s[64:67], 0 offen
    v_mfma_f32_16x16x32_bf16 v[226:229], a[100:103], v[182:185], v[226:229]
    buffer_load_dwordx4 v132, s[48:51], 0 offen offset:1024 lds
    s_waitcnt vmcnt(9)
    ds_read_b64_tr_b16 a[80:81], v193 offset:0
    ds_read_b64_tr_b16 a[82:83], v193 offset:768
    ds_read_b64_tr_b16 a[104:105], v193 offset:32
    ds_read_b64_tr_b16 a[106:107], v193 offset:800
    ds_read_b64_tr_b16 a[128:129], v193 offset:64
    ds_read_b64_tr_b16 a[130:131], v193 offset:832
    buffer_load_dwordx4 v134, s[48:51], 0 offen offset:2048 lds
    s_add_u32 s48, s48, 36864
    s_addc_u32 s49, s49, 0
    s_add_u32 m0, s72, 3072
    s_mov_b32 s72, 2
    s_waitcnt lgkmcnt(4)
    v_mfma_f32_16x16x32_bf16 v[166:169], a[80:83], v[186:189], v[166:169]
    s_waitcnt lgkmcnt(3)
    v_mfma_f32_16x16x32_bf16 v[222:225], a[80:83], v[170:173], v[222:225]
    s_waitcnt lgkmcnt(0)
    v_mfma_f32_16x16x32_bf16 v[178:181], a[104:107], v[186:189], v[178:181]
    v_mfma_f32_16x16x32_bf16 v[202:205], a[128:131], v[186:189], v[202:205]
    ds_read_b128 v[186:189], v152 offset:6272
    buffer_load_dwordx4 v130, s[48:51], 0 offen lds
    v_mfma_f32_16x16x32_bf16 v[226:229], a[104:107], v[170:173], v[226:229]
    s_waitcnt vmcnt(8)
    ds_read_b64_tr_b16 a[84:85], v193 offset:3072
    ds_read_b64_tr_b16 a[86:87], v193 offset:3840
    ds_read_b64_tr_b16 a[108:109], v193 offset:3104
    ds_read_b64_tr_b16 a[110:111], v193 offset:3872
    ds_read_b64_tr_b16 a[132:133], v193 offset:3136
    ds_read_b64_tr_b16 a[134:135], v193 offset:3904
    s_waitcnt vmcnt(6)
    v_bfe_u32 v136, v194, v190, 16
    buffer_load_dwordx4 v132, s[48:51], 0 offen offset:1024 lds
    v_bfe_u32 v116, v195, v190, 16
    v_bfe_u32 v118, v196, v190, 16
    s_waitcnt vmcnt(6)
    v_lshlrev_b32 v133, 16, v133
    v_max_f32 v133, 0xc2c80000, v133
    s_waitcnt lgkmcnt(4)
    v_mfma_f32_16x16x32_bf16 v[166:169], a[84:87], v[126:129], v[166:169]
    s_waitcnt lgkmcnt(2)
    v_min_f32 v133, 0x40930000, v133
    v_mul_f32 v133, 0x3fb8aa3b, v133
    v_mfma_f32_16x16x32_bf16 v[178:181], a[108:111], v[126:129], v[178:181]
    s_waitcnt lgkmcnt(0)
    buffer_load_dwordx4 v134, s[48:51], 0 offen offset:2048 lds
    s_sub_u32 s48, s48, 184704
    v_mfma_f32_16x16x32_bf16 v[202:205], a[132:135], v[126:129], v[202:205]
    s_subb_u32 s49, s49, 0
    ds_read_b128 v[194:197], v151 offset:6272
    s_add_u32 m0, s73, 0
    v_mfma_f32_16x16x32_bf16 v[222:225], a[84:87], v[174:177], v[222:225]
    v_exp_f32 v133, v133
    v_mfma_f32_16x16x32_bf16 v[226:229], a[108:111], v[174:177], v[226:229]
    v_cvt_pk_bf16_f32 v133, v133, v133
    v_and_b32 v133, 0xffff0000, v133
    v_mul_f32 v125, 0x3fb8aa3b, v133
    v_readfirstlane_b32 s37, v133
    v_readfirstlane_b32 s31, v125
    v_mul_f32 v125, 0x3e000000, v133
    v_cmp_lt_f32 s[90:91], 4.0, v125
    v_mfma_f32_16x16x16_bf16 v[126:129], v[122:123], v[136:137], 0
    buffer_load_dwordx4 v130, s[48:51], 0 offen lds
    s_cmp_lg_u64 s[90:91], 0
    s_cbranch_scc1 L_slow
    s_nop 0
    s_nop 0
    s_nop 0
    s_nop 0
    s_nop 0
    v_max_f32 v126, 0, v126
    s_waitcnt vmcnt(6)
    v_cndmask_b32 v146, v146, v147, s[92:93]
    v_cndmask_b32 v148, v148, v149, s[92:93]
    v_mfma_f32_16x16x16_bf16 v[230:233], v[122:123], v[116:117], 0
    v_perm_b32 v136, v148, v146, v121
    v_max_f32 v127, 0, v127
    v_max_f32 v128, 0, v128
    v_max_f32 v129, 0, v129
    v_cvt_pk_bf16_f32 v126, v126, v127
    v_mfma_f32_16x16x16_bf16 v[238:241], v[122:123], v[118:119], 0
    v_cvt_pk_bf16_f32 v127, v128, v129
    v_mfma_f32_16x16x32_bf16 v[146:149], a[120:123], v[206:209], 0
    s_waitcnt lgkmcnt(0)
    buffer_load_dwordx4 v[114:117], v120, s[64:67], 0 offen offset:16
    v_max_f32 v230, 0, v230
    v_mfma_f32_16x16x32_bf16 v[146:149], a[124:127], v[182:185], v[146:149]
    buffer_load_dwordx4 v132, s[48:51], 0 offen offset:1024 lds
    ds_read_b128 v[182:185], v152 offset:6400
    v_mfma_f32_16x16x32_bf16 v[146:149], a[128:131], v[170:173], v[146:149]
    ds_read_b128 v[206:209], v151 offset:6400
    v_max_f32 v231, 0, v231
    v_mfma_f32_16x16x32_bf16 v[146:149], a[132:135], v[174:177], v[146:149]
    ds_read_b128 v[170:173], v152 offset:0
    v_max_f32 v232, 0, v232
    v_max_f32 v233, 0, v233
    v_cvt_pk_bf16_f32 v128, v230, v231
    v_cvt_pk_bf16_f32 v129, v232, v233
    v_max_f32 v238, 0, v238
    s_waitcnt vmcnt(6)
    ds_read_b64_tr_b16 a[88:89], v139 offset:0
    ds_read_b64_tr_b16 a[90:91], v139 offset:768
    ds_read_b64_tr_b16 a[112:113], v139 offset:32
    ds_read_b64_tr_b16 a[114:115], v139 offset:800
    ds_read_b64_tr_b16 a[136:137], v139 offset:64
    buffer_load_dwordx4 v134, s[48:51], 0 offen offset:2048 lds
    ds_read_b64_tr_b16 a[138:139], v139 offset:832
    ds_read_b128 v[174:177], v151 offset:128
    s_add_u32 s48, s48, 36864
    s_addc_u32 s49, s49, 0
    s_add_u32 m0, s73, 3072
    v_max_f32 v239, 0, v239
    v_max_f32 v240, 0, v240
    v_max_f32 v241, 0, v241
    v_cvt_pk_bf16_f32 v122, v238, v239
    v_cvt_pk_bf16_f32 v123, v240, v241
    s_mov_b32 s73, 3
    s_waitcnt lgkmcnt(5)
    v_mfma_f32_16x16x32_bf16 v[166:169], a[88:91], v[234:237], v[166:169]
    s_waitcnt lgkmcnt(4)
    buffer_load_dwordx4 v130, s[48:51], 0 offen lds
    v_mfma_f32_16x16x32_bf16 v[222:225], a[88:91], v[198:201], v[222:225]
    s_waitcnt lgkmcnt(1)
    v_mfma_f32_16x16x32_bf16 v[178:181], a[112:115], v[234:237], v[178:181]
    s_waitcnt lgkmcnt(0)
    v_mfma_f32_16x16x32_bf16 v[202:205], a[136:139], v[234:237], v[202:205]
    ds_read_b128 v[238:241], v151 offset:0
    v_mfma_f32_16x16x32_bf16 v[226:229], a[112:115], v[198:201], v[226:229]
    v_mfma_f32_16x16x32_bf16 v[146:149], a[136:139], v[198:201], v[146:149]
    ds_read_b128 v[234:237], v152 offset:256
    buffer_load_dwordx4 v132, s[48:51], 0 offen offset:1024 lds
    s_waitcnt vmcnt(6)
    ds_read_b64_tr_b16 a[92:93], v139 offset:3072
    ds_read_b64_tr_b16 a[94:95], v139 offset:3840
    ds_read_b64_tr_b16 a[116:117], v139 offset:3104
    ds_read_b64_tr_b16 a[118:119], v139 offset:3872
    ds_read_b64_tr_b16 a[140:141], v139 offset:3136
    ds_read_b64_tr_b16 a[142:143], v139 offset:3904
    v_mov_b32 v198, 0
    buffer_load_dwordx4 v134, s[48:51], 0 offen offset:2048 lds
    s_add_u32 s48, s48, 36864
    s_addc_u32 s49, s49, 0
    s_add_u32 m0, s68, 0
    v_mov_b32 v199, 0
    v_mov_b32 v200, 0
    v_mov_b32 v201, 0
    v_mov_b32 v230, v156
    v_mov_b32 v231, v156
    v_mov_b32 v232, v156
    v_mov_b32 v233, v156
    s_waitcnt lgkmcnt(4)
    v_mfma_f32_16x16x32_bf16 v[166:169], a[92:95], v[158:161], v[166:169]
    s_waitcnt lgkmcnt(3)
    v_mfma_f32_16x16x32_bf16 v[222:225], a[92:95], v[210:213], v[222:225]
    s_waitcnt lgkmcnt(0)
    buffer_load_dwordx4 v130, s[48:51], 0 offen lds
    v_mfma_f32_16x16x32_bf16 v[178:181], a[116:119], v[158:161], v[178:181]
    v_mfma_f32_16x16x32_bf16 v[202:205], a[140:143], v[158:161], v[202:205]
    v_mfma_f32_16x16x32_bf16 v[226:229], a[116:119], v[210:213], v[226:229]
    v_mfma_f32_16x16x32_bf16 v[146:149], a[140:143], v[210:213], v[146:149]
    v_cvt_pk_f16_f32 v118, v166, v167
    ds_read_b128 v[158:161], v152 offset:128
    s_waitcnt vmcnt(6)
    buffer_load_dwordx4 v132, s[48:51], 0 offen offset:1024 lds
    v_cndmask_b32 v114, v114, v115, s[92:93]
    v_cndmask_b32 v116, v116, v117, s[92:93]
    v_perm_b32 v137, v116, v114, v121
    ds_read_b128 v[114:117], v151 offset:256
    v_pk_mul_f16 v167, v118, v118
    v_cvt_pk_f16_f32 v119, v168, v169
    v_pk_fma_f16 v167, v119, v119, v167
    v_cvt_pk_f16_f32 v120, v178, v179
    v_pk_fma_f16 v167, v120, v120, v167
    v_cvt_pk_f16_f32 v121, v180, v181
    v_pk_fma_f16 v167, v121, v121, v167
    v_cvt_pk_f16_f32 v212, v202, v203
    v_pk_fma_f16 v167, v212, v212, v167
    v_cvt_pk_f16_f32 v213, v204, v205
    v_mfma_f32_16x16x16_bf16 v[178:181], v[136:137], v[126:127], 0
    v_pk_fma_f16 v167, v213, v213, v167
    v_cvt_pk_f16_f32 v126, v222, v223
    v_pk_mul_f16 v223, v126, v126
    v_mfma_f32_16x16x16_bf16 v[202:205], v[136:137], v[128:129], 0
    v_cvt_pk_f16_f32 v127, v224, v225
    v_pk_fma_f16 v223, v127, v127, v223
    v_cvt_pk_f16_f32 v128, v226, v227
    v_mfma_f32_16x16x16_bf16 v[242:245], v[136:137], v[122:123], 0
    buffer_load_dwordx4 v134, s[48:51], 0 offen offset:2048 lds
    s_add_u32 s48, s48, 36864
    s_addc_u32 s49, s49, 0
    s_add_u32 m0, s68, 3072
    s_waitcnt vmcnt(6)
    ds_read_b64_tr_b16 a[0:1], v140 offset:0
    ds_read_b64_tr_b16 a[2:3], v140 offset:768
    ds_read_b64_tr_b16 a[24:25], v140 offset:32
    ds_read_b64_tr_b16 a[26:27], v140 offset:800
    ds_read_b64_tr_b16 a[48:49], v140 offset:64
    ds_read_b64_tr_b16 a[50:51], v140 offset:832
    v_cvt_pk_bf16_f32 v178, v178, v178
    v_and_b32 v178, 0xffff0000, v178
    v_mul_f32 v178, 0xbfb8aa3b, v178
    v_exp_f32 v178, v178
    v_cvt_pk_bf16_f32 v202, v202, v202
    v_add_f32 v178, 1.0, v178
    v_rcp_f32 v178, v178
    buffer_load_dwordx4 v130, s[48:51], 0 offen lds
    v_cvt_pk_bf16_f32 v178, v178, v178
    v_and_b32 v178, 0xffff0000, v178
    v_add_f32 v178, -0.5, v178
    v_mul_f32 v178, 0x41b8aa3b, v178
    ds_write_b32 v141, v178 offset:0
    s_waitcnt lgkmcnt(3)
    v_mfma_f32_16x16x32_bf16 v[178:181], a[0:3], v[218:221], 0
    s_waitcnt lgkmcnt(1)
    v_and_b32 v202, 0xffff0000, v202
    v_mul_f32 v202, 0xbfb8aa3b, v202
    v_mfma_f32_16x16x32_bf16 v[250:253], a[24:27], v[218:221], 0
    v_exp_f32 v202, v202
    v_mfma_f32_16x16x32_bf16 v[246:249], a[48:51], v[218:221], 0
    v_add_f32 v202, 1.0, v202
    v_cvt_pk_bf16_f32 v242, v242, v242
    v_mfma_f32_16x16x32_bf16 v[218:221], a[0:3], v[170:173], 0
    buffer_load_dwordx4 v132, s[48:51], 0 offen offset:1024 lds
    v_rcp_f32 v202, v202
    v_and_b32 v242, 0xffff0000, v242
    v_cvt_pk_bf16_f32 v202, v202, v202
    v_and_b32 v202, 0xffff0000, v202
    v_add_f32 v202, -0.5, v202
    v_mul_f32 v202, 0x41b8aa3b, v202
    ds_write_b32 v141, v202 offset:4
    s_waitcnt vmcnt(5)
    v_mul_f32 v242, 0xbfb8aa3b, v242
    v_exp_f32 v242, v242
    ds_read_b64_tr_b16 a[4:5], v140 offset:3072
    ds_read_b64_tr_b16 a[6:7], v140 offset:3840
    ds_read_b64_tr_b16 a[28:29], v140 offset:3104
    buffer_load_dwordx4 v134, s[48:51], 0 offen offset:2048 lds
    ds_read_b64_tr_b16 a[30:31], v140 offset:3872
    ds_read_b64_tr_b16 a[52:53], v140 offset:3136
    ds_read_b64_tr_b16 a[54:55], v140 offset:3904
    ds_write_b128 v144, v[198:201] offset:16
    s_add_u32 s48, s48, 36864
    s_addc_u32 s49, s49, 0
    s_add_u32 m0, s69, 0
    v_add_f32 v242, 1.0, v242
    v_rcp_f32 v242, v242
    v_pk_fma_f16 v223, v128, v128, v223
    v_cvt_pk_bf16_f32 v242, v242, v242
    v_and_b32 v242, 0xffff0000, v242
    v_add_f32 v242, -0.5, v242
    buffer_load_dwordx4 v130, s[48:51], 0 offen lds
    s_waitcnt lgkmcnt(4)
    v_mfma_f32_16x16x32_bf16 v[178:181], a[4:7], v[214:217], v[178:181]
    s_waitcnt lgkmcnt(3)
    ds_write_b64 v144, v[198:199] offset:56
    v_mfma_f32_16x16x32_bf16 v[250:253], a[28:31], v[214:217], v[250:253]
    s_waitcnt lgkmcnt(1)
    v_mul_f32 v242, 0x41b8aa3b, v242
    v_cvt_pk_f16_f32 v129, v228, v229
    v_mfma_f32_16x16x32_bf16 v[246:249], a[52:55], v[214:217], v[246:249]
    ds_write_b32 v141, v242 offset:8
    v_mfma_f32_16x16x32_bf16 v[218:221], a[4:7], v[238:241], v[218:221]
    v_pk_fma_f16 v223, v129, v129, v223
    v_cvt_pk_f16_f32 v204, v146, v147
    v_mfma_f32_16x16x32_bf16 v[214:217], a[24:27], v[170:173], 0
    buffer_load_dwordx4 v132, s[48:51], 0 offen offset:1024 lds
    v_pk_fma_f16 v223, v204, v204, v223
    v_mfma_f32_16x16x32_bf16 v[214:217], a[28:31], v[238:241], v[214:217]
    ds_write_b64 v144, v[198:199] offset:64
    v_mfma_f32_16x16x32_bf16 v[226:229], a[48:51], v[170:173], 0
    v_cvt_pk_f16_f32 v205, v148, v149
    v_pk_fma_f16 v223, v205, v205, v223
    v_mfma_f32_16x16x32_bf16 v[226:229], a[52:55], v[238:241], v[226:229]
    ds_write_b128 v145, v[198:201] offset:16
    s_waitcnt vmcnt(5)
    s_waitcnt lgkmcnt(2)
    s_barrier
    buffer_load_dwordx4 v134, s[48:51], 0 offen offset:2048 lds
    s_add_u32 s48, s48, 36864
    s_addc_u32 s49, s49, 0
    s_add_u32 m0, s69, 3072
    ds_read_b64_tr_b16 a[8:9], v138 offset:0
    ds_read_b64_tr_b16 a[10:11], v138 offset:768
    ds_read_b64_tr_b16 a[32:33], v138 offset:32
    ds_read_b64_tr_b16 a[34:35], v138 offset:800
    ds_read_b64_tr_b16 a[56:57], v138 offset:64
    ds_read_b64_tr_b16 a[58:59], v138 offset:832
    ds_read_b32 v22, v22 offset:0
    ds_read_b32 v23, v23 offset:672
    ds_read_b32 v24, v24 offset:0
    ds_read_b32 v25, v25 offset:672
    ds_read_b32 v26, v26 offset:0
    buffer_load_dwordx4 v130, s[48:51], 0 offen lds
    ds_read_b32 v27, v27 offset:672
    ds_read_b32 v46, v46 offset:336
    ds_read_b32 v58, v58 offset:336
    ds_read_b32 v70, v70 offset:336
    ds_read_b32 v47, v47 offset:332
    s_waitcnt lgkmcnt(14)
    v_mfma_f32_16x16x32_bf16 v[178:181], a[8:11], v[186:189], v[178:181]
    s_waitcnt lgkmcnt(12)
    ds_read_b32 v59, v59 offset:332
    ds_read_b32 v71, v71 offset:332
    v_mfma_f32_16x16x32_bf16 v[250:253], a[32:35], v[186:189], v[250:253]
    s_waitcnt lgkmcnt(10)
    ds_read_b32 v48, v48 offset:328
    ds_read_b32 v60, v60 offset:328
    v_mfma_f32_16x16x32_bf16 v[246:249], a[56:59], v[186:189], v[246:249]
    s_waitcnt lgkmcnt(10)
    buffer_load_dwordx4 v132, s[48:51], 0 offen offset:1024 lds
    ds_read_b32 v72, v72 offset:328
    v_mfma_f32_16x16x32_bf16 v[218:221], a[8:11], v[158:161], v[218:221]
    s_waitcnt lgkmcnt(9)
    ds_read_b32 v49, v49 offset:324
    ds_read_b32 v61, v61 offset:324
    v_mfma_f32_16x16x32_bf16 v[214:217], a[32:35], v[158:161], v[214:217]
    s_waitcnt lgkmcnt(9)
    ds_read_b32 v73, v73 offset:324
    ds_read_b32 v50, v50 offset:272
    v_mfma_f32_16x16x32_bf16 v[226:229], a[56:59], v[158:161], v[226:229]
    s_waitcnt lgkmcnt(9)
    ds_read_b32 v62, v62 offset:272
    ds_read_b32 v74, v74 offset:272
    ds_read_b32 v51, v51 offset:268
    ds_read_b32 v63, v63 offset:268
    ds_read_b32 v75, v75 offset:268
    ds_read_b32 v52, v52 offset:264
    buffer_load_dwordx4 v134, s[48:51], 0 offen offset:2048 lds
    s_waitcnt vmcnt(6)
    ds_read_b64_tr_b16 a[12:13], v138 offset:3072
    ds_read_b64_tr_b16 a[14:15], v138 offset:3840
    ds_read_b64_tr_b16 a[36:37], v138 offset:3104
    s_add_u32 m0, s28, 0
    ds_read_b64_tr_b16 a[38:39], v138 offset:3872
    s_sub_u32 s48, s48, 183552
    ds_read_b64_tr_b16 a[60:61], v138 offset:3136
    s_subb_u32 s49, s49, 0
    ds_read_b64_tr_b16 a[62:63], v138 offset:3904
    ds_read_b32 v64, v64 offset:264
    ds_read_b32 v76, v76 offset:264
    ds_read_b32 v53, v53 offset:260
    ds_read_b32 v65, v65 offset:260
    buffer_load_dwordx4 v10, s[8:11], s25 offen nt lds
    ds_read_b32 v77, v77 offset:260
    ds_read_b32 v54, v54 offset:208
    ds_read_b32 v66, v66 offset:208
    s_add_u32 m0, s28, 4096
    s_waitcnt lgkmcnt(11)
    v_mfma_f32_16x16x32_bf16 v[178:181], a[12:15], v[194:197], v[178:181]
    s_waitcnt lgkmcnt(10)
    ds_read_b32 v78, v78 offset:208
    ds_read_b32 v55, v55 offset:204
    v_mfma_f32_16x16x32_bf16 v[218:221], a[12:15], v[174:177], v[218:221]
    s_waitcnt lgkmcnt(10)
    ds_read_b32 v67, v67 offset:204
    ds_read_b32 v79, v79 offset:204
    v_mfma_f32_16x16x32_bf16 v[250:253], a[36:39], v[194:197], v[250:253]
    s_waitcnt lgkmcnt(9)
    ds_read_b32 v56, v56 offset:200
    ds_read_b32 v68, v68 offset:200
    v_mfma_f32_16x16x32_bf16 v[246:249], a[60:63], v[194:197], v[246:249]
    s_waitcnt lgkmcnt(9)
    buffer_load_dwordx4 v11, s[8:11], s25 offen nt lds
    v_mfma_f32_16x16x32_bf16 v[214:217], a[36:39], v[174:177], v[214:217]
    s_add_u32 m0, s28, 8192
    ds_read_b32 v80, v80 offset:200
    ds_read_b32 v57, v57 offset:196
    v_mfma_f32_16x16x32_bf16 v[226:229], a[60:63], v[174:177], v[226:229]
    s_waitcnt lgkmcnt(8)
    ds_read_b32 v69, v69 offset:196
    ds_read_b32 v81, v81 offset:196
    ds_read_b32 v191, v191 offset:336
    ds_write_b64 v145, v[198:199] offset:56
    v_cndmask_b32 v22, v156, v22, s[88:89]
    v_cndmask_b32 v24, v156, v24, s[88:89]
    v_mov_b32_dpp v23, v25 quad_perm:[0,1,2,3] row_mask:0x2 bank_mask:0xf
    v_cndmask_b32 v26, v156, v26, s[88:89]
    v_mov_b32_dpp v23, v27 quad_perm:[0,1,2,3] row_mask:0x4 bank_mask:0xf
    buffer_load_dwordx4 v12, s[8:11], s25 offen nt lds
    s_waitcnt vmcnt(6)
    ds_read_b64_tr_b16 a[16:17], v193 offset:0
    ds_read_b64_tr_b16 a[18:19], v193 offset:768
    ds_read_b64_tr_b16 a[40:41], v193 offset:32
    ds_read_b64_tr_b16 a[42:43], v193 offset:800
    ds_read_b64_tr_b16 a[64:65], v193 offset:64
    ds_read_b64_tr_b16 a[66:67], v193 offset:832
    ds_write_b64 v145, v[198:199] offset:64
    s_waitcnt lgkmcnt(8)
    s_add_u32 m0, s28, 12288
    v_readfirstlane_b32 s39, v191
    ds_write_b128 v153, v[230:233] offset:192
    buffer_load_dwordx4 v13, s[8:11], s25 offen nt lds
    s_add_u32 m0, s29, 0
    s_nop 0
    s_waitcnt lgkmcnt(6)
    v_mfma_f32_16x16x32_bf16 v[178:181], a[16:19], v[182:185], v[178:181]
    s_waitcnt lgkmcnt(5)
    v_mfma_f32_16x16x32_bf16 v[218:221], a[16:19], v[234:237], v[218:221]
    s_waitcnt lgkmcnt(1)
    ds_write_b128 v142, v[230:233] offset:192
    v_mfma_f32_16x16x32_bf16 v[250:253], a[40:43], v[182:185], v[250:253]
    v_mfma_f32_16x16x32_bf16 v[246:249], a[64:67], v[182:185], v[246:249]
    buffer_load_dwordx4 v14, s[8:11], s25 offen nt lds
    v_mfma_f32_16x16x32_bf16 v[214:217], a[40:43], v[234:237], v[214:217]
    s_add_u32 m0, s68, 0
    s_lshr_b32 s10, s17, 1
    s_cselect_b32 s10, s36, 0
    v_mfma_f32_16x16x32_bf16 v[226:229], a[64:67], v[234:237], v[226:229]
    s_mov_b32 s25, s24
    s_waitcnt vmcnt(5)
    ds_read_b64_tr_b16 a[20:21], v193 offset:3072
    ds_read_b64_tr_b16 a[22:23], v193 offset:3840
    buffer_load_dwordx4 v130, s[48:51], 0 offen lds
    ds_read_b64_tr_b16 a[44:45], v193 offset:3104
    ds_read_b64_tr_b16 a[46:47], v193 offset:3872
    ds_read_b64_tr_b16 a[68:69], v193 offset:3136
    ds_read_b64_tr_b16 a[70:71], v193 offset:3904
    buffer_load_dwordx4 v132, s[48:51], 0 offen offset:1024 lds
    s_waitcnt lgkmcnt(4)
    v_mfma_f32_16x16x32_bf16 v[178:181], a[20:23], v[206:209], v[178:181]
    v_mfma_f32_16x16x32_bf16 v[218:221], a[20:23], v[114:117], v[218:221]
    s_waitcnt lgkmcnt(0)
    v_mfma_f32_16x16x32_bf16 v[250:253], a[44:47], v[206:209], v[250:253]
    v_mfma_f32_16x16x32_bf16 v[246:249], a[68:71], v[206:209], v[246:249]
    v_mov_b32 v169, 0
    v_mfma_f32_16x16x32_bf16 v[214:217], a[44:47], v[114:117], v[214:217]
    v_mfma_f32_16x16x32_bf16 v[226:229], a[68:71], v[114:117], v[226:229]
    buffer_load_dwordx4 v134, s[48:51], 0 offen offset:2048 lds
    s_add_u32 s48, s48, 36864
    s_addc_u32 s49, s49, 0
    s_add_u32 m0, s68, 3072
    v_cvt_pk_f16_f32 v194, v178, v179
    v_pk_mul_f16 v166, v194, v194
    v_cvt_pk_f16_f32 v195, v180, v181
    v_pk_fma_f16 v166, v195, v195, v166
    v_cvt_pk_f16_f32 v196, v250, v251
    v_pk_fma_f16 v166, v196, v196, v166
    v_cvt_pk_f16_f32 v197, v252, v253
    v_pk_fma_f16 v166, v197, v197, v166
    v_cvt_pk_f16_f32 v210, v246, v247
    v_pk_fma_f16 v166, v210, v210, v166
    v_cvt_pk_f16_f32 v211, v248, v249
    v_pk_fma_f16 v166, v211, v211, v166
    v_pk_mul_f16 v168, v194, v118
    v_pk_fma_f16 v168, v195, v119, v168
    v_pk_fma_f16 v168, v196, v120, v168
    buffer_load_dwordx4 v130, s[48:51], 0 offen lds
    v_pk_fma_f16 v168, v197, v121, v168
    v_pk_fma_f16 v168, v210, v212, v168
    v_pk_fma_f16 v168, v211, v213, v168
    v_cvt_pk_f16_f32 v146, v218, v219
    v_pk_mul_f16 v222, v146, v146
    v_mfma_f32_16x16x32_f16 v[114:117], v[40:43], v[166:169], 0
    v_cvt_pk_f16_f32 v147, v220, v221
    v_pk_fma_f16 v222, v147, v147, v222
    v_cvt_pk_f16_f32 v148, v214, v215
    v_pk_fma_f16 v222, v148, v148, v222
    v_cvt_pk_f16_f32 v149, v216, v217
    v_pk_fma_f16 v222, v149, v149, v222
    v_cvt_pk_f16_f32 v202, v226, v227
    v_pk_fma_f16 v222, v202, v202, v222
    v_rsq_f32 v114, v114
    v_rsq_f32 v115, v115
    v_mul_f32 v190, s31, v114
    v_cvt_pk_f16_f32 v191, v190, v115
    v_pk_mul_f16 v118, v118, v191 op_sel:[0,1] op_sel_hi:[1,1]
    v_pk_mul_f16 v119, v119, v191 op_sel:[0,1] op_sel_hi:[1,1]
    v_pk_mul_f16 v120, v120, v191 op_sel:[0,1] op_sel_hi:[1,1]
    v_pk_mul_f16 v121, v121, v191 op_sel:[0,1] op_sel_hi:[1,1]
    v_pk_mul_f16 v212, v212, v191 op_sel:[0,1] op_sel_hi:[1,1]
    v_pk_mul_f16 v213, v213, v191 op_sel:[0,1] op_sel_hi:[1,1]
    v_pk_mul_f16 v194, v194, v191 op_sel:[0,0] op_sel_hi:[1,0]
    v_pk_mul_f16 v195, v195, v191 op_sel:[0,0] op_sel_hi:[1,0]
    v_pk_mul_f16 v196, v196, v191 op_sel:[0,0] op_sel_hi:[1,0]
    v_pk_mul_f16 v197, v197, v191 op_sel:[0,0] op_sel_hi:[1,0]
    v_pk_mul_f16 v210, v210, v191 op_sel:[0,0] op_sel_hi:[1,0]
    v_pk_mul_f16 v211, v211, v191 op_sel:[0,0] op_sel_hi:[1,0]
    v_cndmask_b32 v114, 1.0, v114, s[94:95]
    v_cndmask_b32 v115, 1.0, v115, s[94:95]
    v_max3_u32 v44, v44, v114, v115
    v_mul_f32 v133, v116, v190
    v_fma_f32 v133, v133, v115, s39
    ds_write_b32 v192, v133 offset:192
    v_cvt_pk_f16_f32 v203, v228, v229
    v_pk_fma_f16 v222, v203, v203, v222
    v_pk_mul_f16 v224, v146, v126
    v_pk_fma_f16 v224, v147, v127, v224
    ds_write_b128 v145, v[118:121]
    v_pk_fma_f16 v224, v148, v128, v224
    v_pk_fma_f16 v224, v149, v129, v224
    v_pk_fma_f16 v224, v202, v204, v224
    v_pk_fma_f16 v224, v203, v205, v224
    v_mov_b32 v225, 0
    s_nop 0
    s_nop 0
    v_mfma_f32_16x16x32_f16 v[118:121], v[40:43], v[222:225], 0
    ds_write_b64 v145, v[212:213] offset:48
    s_nop 0
    s_nop 0
    s_nop 0
    ds_write_b128 v145, v[194:197] offset:32
    s_nop 0
    s_nop 0
    s_nop 0
    v_rsq_f32 v118, v118
    v_rsq_f32 v119, v119
    ds_write_b64 v145, v[210:211] offset:72
    v_mul_f32 v122, s31, v118
    v_cvt_pk_f16_f32 v123, v122, v119
    v_pk_mul_f16 v126, v126, v123 op_sel:[0,1] op_sel_hi:[1,1]
    v_pk_mul_f16 v127, v127, v123 op_sel:[0,1] op_sel_hi:[1,1]
    v_pk_mul_f16 v128, v128, v123 op_sel:[0,1] op_sel_hi:[1,1]
    v_pk_mul_f16 v129, v129, v123 op_sel:[0,1] op_sel_hi:[1,1]
    v_pk_mul_f16 v204, v204, v123 op_sel:[0,1] op_sel_hi:[1,1]
    v_pk_mul_f16 v205, v205, v123 op_sel:[0,1] op_sel_hi:[1,1]
    v_pk_mul_f16 v146, v146, v123 op_sel:[0,0] op_sel_hi:[1,0]
    v_pk_mul_f16 v147, v147, v123 op_sel:[0,0] op_sel_hi:[1,0]
    v_pk_mul_f16 v148, v148, v123 op_sel:[0,0] op_sel_hi:[1,0]
    v_pk_mul_f16 v149, v149, v123 op_sel:[0,0] op_sel_hi:[1,0]
    v_pk_mul_f16 v202, v202, v123 op_sel:[0,0] op_sel_hi:[1,0]
    v_pk_mul_f16 v203, v203, v123 op_sel:[0,0] op_sel_hi:[1,0]
    v_max3_u32 v44, v44, v118, v119
    v_mul_f32 v133, v120, v122
    v_fma_f32 v133, v133, v119, s39
    ds_write_b32 v143, v133 offset:192
    buffer_load_dwordx4 v132, s[48:51], 0 offen offset:1024 lds
    ds_write_b128 v144, v[126:129]
    buffer_load_dwordx4 v134, s[48:51], 0 offen offset:2048 lds
    ds_write_b64 v144, v[204:205] offset:48
    s_add_u32 s48, s48, 36864
    s_addc_u32 s49, s49, 0
    s_add_u32 m0, s69, 0
    ds_write_b128 v144, v[146:149] offset:32
    buffer_load_dwordx4 v130, s[48:51], 0 offen lds
    ds_write_b64 v144, v[202:203] offset:72
    buffer_load_dwordx4 v132, s[48:51], 0 offen offset:1024 lds
    buffer_load_dwordx4 v134, s[48:51], 0 offen offset:2048 lds
    s_waitcnt vmcnt(9)
    s_barrier
    ds_read_b128 v[206:209], v0 offset:20480
    ds_read_b128 v[118:121], v1 offset:20480
    ds_read_b128 v[114:117], v0 offset:20608
    s_add_u32 s48, s48, 36864
    s_addc_u32 s49, s49, 0
    ds_read_b128 v[182:185], v1 offset:20608
    s_add_u32 m0, s69, 3072
    ds_read_b128 v[234:237], v0 offset:20736
    ds_read_b128 v[186:189], v1 offset:20736
    buffer_load_dwordx4 v130, s[48:51], 0 offen lds
    s_waitcnt lgkmcnt(5)
    v_mfma_f32_16x16x32_bf16 v[194:197], a[72:75], v[206:209], 0
    s_waitcnt lgkmcnt(4)
    v_mfma_f32_16x16x32_bf16 v[194:197], a[76:79], v[118:121], v[194:197]
    s_waitcnt lgkmcnt(2)
    v_mfma_f32_16x16x32_bf16 v[194:197], a[80:83], v[114:117], v[194:197]
    s_waitcnt lgkmcnt(1)
    v_mfma_f32_16x16x32_bf16 v[194:197], a[84:87], v[182:185], v[194:197]
    s_waitcnt lgkmcnt(0)
    v_mfma_f32_16x16x32_bf16 v[194:197], a[88:91], v[234:237], v[194:197]
    buffer_load_dwordx4 v132, s[48:51], 0 offen offset:1024 lds
    v_mfma_f32_16x16x32_bf16 v[194:197], a[92:95], v[186:189], v[194:197]
    v_mfma_f32_16x16x32_bf16 v[146:149], a[96:99], v[206:209], 0
    v_mfma_f32_16x16x32_bf16 v[146:149], a[100:103], v[118:121], v[146:149]
    s_waitcnt vmcnt(8)
    ds_read_b64_tr_b16 a[144:145], v138 offset:0
    ds_read_b64_tr_b16 a[146:147], v138 offset:768
    v_mfma_f32_16x16x32_bf16 v[146:149], a[104:107], v[114:117], v[146:149]
    ds_read_b64_tr_b16 a[168:169], v138 offset:32
    ds_read_b64_tr_b16 a[170:171], v138 offset:800
    v_mfma_f32_16x16x32_bf16 v[146:149], a[108:111], v[182:185], v[146:149]
    ds_read_b64_tr_b16 a[192:193], v138 offset:64
    buffer_load_dwordx4 v134, s[48:51], 0 offen offset:2048 lds
    v_mfma_f32_16x16x32_bf16 v[146:149], a[112:115], v[234:237], v[146:149]
    s_add_u32 s48, s48, 36864
    ds_read_b64_tr_b16 a[194:195], v138 offset:832
    v_cvt_pk_f16_f32 v194, v194, v195
    v_mfma_f32_16x16x32_bf16 v[146:149], a[116:119], v[186:189], v[146:149]
    s_addc_u32 s49, s49, 0
    v_pk_mul_f16 v191, v194, v194
    v_cvt_pk_f16_f32 v195, v196, v197
    v_mfma_f32_16x16x32_bf16 v[218:221], a[120:123], v[206:209], 0
    s_add_u32 m0, s68, 0
    v_pk_fma_f16 v191, v195, v195, v191
    v_mfma_f32_16x16x32_bf16 v[218:221], a[124:127], v[118:121], v[218:221]
    s_waitcnt lgkmcnt(5)
    v_cvt_pk_f16_f32 v196, v146, v147
    v_pk_fma_f16 v191, v196, v196, v191
    v_mfma_f32_16x16x32_bf16 v[218:221], a[128:131], v[114:117], v[218:221]
    s_waitcnt lgkmcnt(3)
    v_cvt_pk_f16_f32 v197, v148, v149
    v_pk_fma_f16 v191, v197, v197, v191
    v_mfma_f32_16x16x32_bf16 v[218:221], a[132:135], v[182:185], v[218:221]
    s_waitcnt lgkmcnt(1)
    v_mfma_f32_16x16x32_bf16 v[218:221], a[136:139], v[234:237], v[218:221]
    s_waitcnt lgkmcnt(0)
    buffer_load_dwordx4 v130, s[48:51], 0 offen lds
    ds_read_b128 v[158:161], v0 offset:26624
    v_mfma_f32_16x16x32_bf16 v[218:221], a[140:143], v[186:189], v[218:221]
    ds_read_b128 v[214:217], v1 offset:26624
    v_mfma_f32_16x16x32_bf16 v[142:145], a[0:3], v[206:209], 0
    ds_read_b128 v[226:229], v0 offset:26752
    v_mfma_f32_16x16x32_bf16 v[142:145], a[4:7], v[118:121], v[142:145]
    ds_read_b128 v[178:181], v1 offset:26752
    s_waitcnt vmcnt(7)
    v_mfma_f32_16x16x32_bf16 v[142:145], a[8:11], v[114:117], v[142:145]
    ds_read_b64_tr_b16 a[148:149], v138 offset:3072
    ds_read_b64_tr_b16 a[150:151], v138 offset:3840
    v_mfma_f32_16x16x32_bf16 v[142:145], a[12:15], v[182:185], v[142:145]
    ds_read_b64_tr_b16 a[172:173], v138 offset:3104
    buffer_load_dwordx4 v132, s[48:51], 0 offen offset:1024 lds
    v_mfma_f32_16x16x32_bf16 v[142:145], a[16:19], v[234:237], v[142:145]
    ds_read_b64_tr_b16 a[174:175], v138 offset:3872
    ds_read_b64_tr_b16 a[196:197], v138 offset:3136
    v_mfma_f32_16x16x32_bf16 v[142:145], a[20:23], v[186:189], v[142:145]
    s_waitcnt lgkmcnt(7)
    ds_read_b64_tr_b16 a[198:199], v138 offset:3904
    ds_read_b128 v[202:205], v0 offset:26880
    v_mfma_f32_16x16x32_bf16 v[126:129], a[24:27], v[206:209], 0
    s_waitcnt lgkmcnt(8)
    ds_read_b128 v[174:177], v1 offset:26880
    v_cvt_pk_f16_f32 v148, v218, v219
    v_mfma_f32_16x16x32_bf16 v[126:129], a[28:31], v[118:121], v[126:129]
    s_waitcnt lgkmcnt(8)
    v_pk_fma_f16 v191, v148, v148, v191
    v_cvt_pk_f16_f32 v149, v220, v221
    v_mfma_f32_16x16x32_bf16 v[126:129], a[32:35], v[114:117], v[126:129]
    s_waitcnt lgkmcnt(7)
    v_pk_fma_f16 v191, v149, v149, v191
    v_cvt_pk_f16_f32 v142, v142, v143
    v_mfma_f32_16x16x32_bf16 v[126:129], a[36:39], v[182:185], v[126:129]
    s_waitcnt lgkmcnt(5)
    buffer_load_dwordx4 v134, s[48:51], 0 offen offset:2048 lds
    v_pk_mul_f16 v190, v142, v142
    v_mfma_f32_16x16x32_bf16 v[126:129], a[40:43], v[234:237], v[126:129]
    s_add_u32 s48, s48, 36864
    v_cvt_pk_f16_f32 v143, v144, v145
    v_pk_fma_f16 v190, v143, v143, v190
    v_mfma_f32_16x16x32_bf16 v[126:129], a[44:47], v[186:189], v[126:129]
    s_addc_u32 s49, s49, 0
    s_add_u32 m0, s68, 3072
    v_mfma_f32_16x16x32_bf16 v[218:221], a[48:51], v[206:209], 0
    s_waitcnt lgkmcnt(0)
    v_mfma_f32_16x16x32_bf16 v[218:221], a[52:55], v[118:121], v[218:221]
    v_mfma_f32_16x16x32_bf16 v[218:221], a[56:59], v[114:117], v[218:221]
    v_mfma_f32_16x16x32_bf16 v[218:221], a[60:63], v[182:185], v[218:221]
    s_waitcnt vmcnt(6)
    buffer_load_dwordx4 v130, s[48:51], 0 offen lds
    ds_read_b64_tr_b16 a[152:153], v193 offset:0
    v_mfma_f32_16x16x32_bf16 v[218:221], a[64:67], v[234:237], v[218:221]
    ds_read_b64_tr_b16 a[154:155], v193 offset:768
    ds_read_b64_tr_b16 a[176:177], v193 offset:32
    v_mfma_f32_16x16x32_bf16 v[218:221], a[68:71], v[186:189], v[218:221]
    ds_read_b64_tr_b16 a[178:179], v193 offset:800
    ds_read_b64_tr_b16 a[200:201], v193 offset:64
    v_mfma_f32_16x16x32_bf16 v[118:121], a[72:75], v[158:161], 0
    ds_read_b64_tr_b16 a[202:203], v193 offset:832
    ds_read_b128 v[206:209], v0 offset:32768
    v_mfma_f32_16x16x32_bf16 v[118:121], a[76:79], v[214:217], v[118:121]
    ds_read_b128 v[234:237], v1 offset:32768
    ds_read_b128 v[114:117], v0 offset:32896
    v_mfma_f32_16x16x32_bf16 v[118:121], a[80:83], v[226:229], v[118:121]
    ds_read_b128 v[182:185], v1 offset:32896
    buffer_load_dwordx4 v132, s[48:51], 0 offen offset:1024 lds
    v_mfma_f32_16x16x32_bf16 v[118:121], a[84:87], v[178:181], v[118:121]
    ds_read_b128 v[210:213], v0 offset:33024
    v_cvt_pk_f16_f32 v144, v126, v127
    v_mfma_f32_16x16x32_bf16 v[118:121], a[88:91], v[202:205], v[118:121]
    s_waitcnt lgkmcnt(9)
    ds_read_b128 v[186:189], v1 offset:33024
    v_pk_fma_f16 v190, v144, v144, v190
    v_mfma_f32_16x16x32_bf16 v[118:121], a[92:95], v[174:177], v[118:121]
    s_waitcnt lgkmcnt(8)
    v_cvt_pk_f16_f32 v145, v128, v129
    v_pk_fma_f16 v190, v145, v145, v190
    v_mfma_f32_16x16x32_bf16 v[126:129], a[96:99], v[158:161], 0
    s_waitcnt lgkmcnt(6)
    v_cvt_pk_f16_f32 v146, v218, v219
    v_pk_fma_f16 v190, v146, v146, v190
    v_mfma_f32_16x16x32_bf16 v[126:129], a[100:103], v[214:217], v[126:129]
    s_waitcnt lgkmcnt(4)
    v_cvt_pk_f16_f32 v147, v220, v221
    v_pk_fma_f16 v190, v147, v147, v190
    v_mfma_f32_16x16x32_bf16 v[126:129], a[104:107], v[226:229], v[126:129]
    s_waitcnt lgkmcnt(2)
    buffer_load_dwordx4 v134, s[48:51], 0 offen offset:2048 lds
    v_mov_b32 v192, 0
    v_mfma_f32_16x16x32_bf16 v[126:129], a[108:111], v[178:181], v[126:129]
    s_add_u32 m0, s69, 0
    s_waitcnt vmcnt(6)
    ds_read_b64_tr_b16 a[156:157], v193 offset:3072
    v_mfma_f32_16x16x32_bf16 v[126:129], a[112:115], v[202:205], v[126:129]
    s_waitcnt lgkmcnt(1)
    ds_read_b64_tr_b16 a[158:159], v193 offset:3840
    ds_read_b64_tr_b16 a[180:181], v193 offset:3104
    v_mfma_f32_16x16x32_bf16 v[126:129], a[116:119], v[174:177], v[126:129]
    ds_read_b64_tr_b16 a[182:183], v193 offset:3872
    ds_read_b64_tr_b16 a[204:205], v193 offset:3136
    v_mfma_f32_16x16x32_bf16 v[134:137], a[120:123], v[158:161], 0
    ds_read_b64_tr_b16 a[206:207], v193 offset:3904
    v_mov_b32 v193, 0
    v_mfma_f32_16x16x32_bf16 v[134:137], a[124:127], v[214:217], v[134:137]
    v_cvt_pk_f16_f32 v218, v118, v119
    v_pk_mul_f16 v119, v218, v218
    v_mfma_f32_16x16x32_f16 v[158:161], v[40:43], v[190:193], 0
    buffer_load_dwordx4 v157, s[52:55], 0 offen lds
    v_cvt_pk_f16_f32 v219, v120, v121
    v_mfma_f32_16x16x32_bf16 v[134:137], a[128:131], v[226:229], v[134:137]
    v_pk_fma_f16 v119, v219, v219, v119
    v_cvt_pk_f16_f32 v220, v126, v127
    v_mfma_f32_16x16x32_bf16 v[134:137], a[132:135], v[178:181], v[134:137]
    s_waitcnt lgkmcnt(4)
    v_pk_fma_f16 v119, v220, v220, v119
    v_cvt_pk_f16_f32 v221, v128, v129
    v_mfma_f32_16x16x32_bf16 v[134:137], a[136:139], v[202:205], v[134:137]
    s_waitcnt lgkmcnt(2)
    ds_read_b128 v[126:129], v152 offset:6144
    v_pk_fma_f16 v119, v221, v221, v119
    v_mfma_f32_16x16x32_bf16 v[134:137], a[140:143], v[174:177], v[134:137]
    s_waitcnt lgkmcnt(1)
    ds_read_b128 v[190:193], v151 offset:6144
    v_mfma_f32_16x16x32_bf16 v[214:217], a[72:75], v[206:209], 0
    ds_read_b128 v[178:181], v152 offset:6272
    buffer_load_dwordx4 v164, s[52:55], 0 offen offset:1024 lds
    v_mfma_f32_16x16x32_bf16 v[214:217], a[76:79], v[234:237], v[214:217]
    ds_read_b128 v[202:205], v151 offset:6272
    v_mfma_f32_16x16x32_bf16 v[214:217], a[80:83], v[114:117], v[214:217]
    ds_read_b128 v[226:229], v152 offset:6400
    v_cvt_pk_f16_f32 v160, v134, v135
    v_mfma_f32_16x16x32_bf16 v[214:217], a[84:87], v[182:185], v[214:217]
    ds_read_b128 v[174:177], v151 offset:6400
    s_waitcnt vmcnt(5)
    v_mfma_f32_16x16x32_bf16 v[214:217], a[88:91], v[210:213], v[214:217]
    s_waitcnt lgkmcnt(5)
    ds_read_b64_tr_b16 a[160:161], v138 offset:0
    ds_read_b64_tr_b16 a[162:163], v138 offset:768
    v_mfma_f32_16x16x32_bf16 v[214:217], a[92:95], v[186:189], v[214:217]
    s_waitcnt lgkmcnt(6)
    ds_read_b64_tr_b16 a[184:185], v138 offset:32
    ds_read_b64_tr_b16 a[186:187], v138 offset:800
    v_mfma_f32_16x16x32_bf16 v[198:201], a[96:99], v[206:209], 0
    s_waitcnt lgkmcnt(7)
    buffer_load_dwordx4 v254, s[52:55], 0 offen offset:2048 lds
    ds_read_b64_tr_b16 a[208:209], v138 offset:64
    v_mfma_f32_16x16x32_bf16 v[198:201], a[100:103], v[234:237], v[198:201]
    s_add_u32 s52, s52, 12288
    ds_read_b64_tr_b16 a[210:211], v138 offset:832
    v_pk_fma_f16 v119, v160, v160, v119
    v_mfma_f32_16x16x32_bf16 v[198:201], a[104:107], v[114:117], v[198:201]
    s_addc_u32 s53, s53, 0
    v_rsq_f32 v158, v158
    v_mfma_f32_16x16x32_bf16 v[198:201], a[108:111], v[182:185], v[198:201]
    s_add_u32 m0, s69, 3072
    v_rsq_f32 v159, v159
    v_mfma_f32_16x16x32_bf16 v[198:201], a[112:115], v[210:213], v[198:201]
    s_waitcnt lgkmcnt(5)
    v_mul_f32 v134, s31, v158
    v_cvt_pk_f16_f32 v135, v134, v159
    v_mfma_f32_16x16x32_bf16 v[198:201], a[116:119], v[186:189], v[198:201]
    s_waitcnt lgkmcnt(3)
    v_pk_mul_f16 v194, v194, v135 op_sel:[0,1] op_sel_hi:[1,1]
    v_pk_mul_f16 v195, v195, v135 op_sel:[0,1] op_sel_hi:[1,1]
    v_mfma_f32_16x16x32_bf16 v[170:173], a[120:123], v[206:209], 0
    s_waitcnt lgkmcnt(2)
    buffer_load_dwordx4 v157, s[52:55], 0 offen lds
    v_pk_mul_f16 v196, v196, v135 op_sel:[0,1] op_sel_hi:[1,1]
    v_mfma_f32_16x16x32_bf16 v[170:173], a[124:127], v[234:237], v[170:173]
    s_waitcnt lgkmcnt(0)
    v_pk_mul_f16 v197, v197, v135 op_sel:[0,1] op_sel_hi:[1,1]
    v_pk_mul_f16 v148, v148, v135 op_sel:[0,1] op_sel_hi:[1,1]
    v_mfma_f32_16x16x32_bf16 v[170:173], a[128:131], v[114:117], v[170:173]
    v_pk_mul_f16 v149, v149, v135 op_sel:[0,1] op_sel_hi:[1,1]
    v_pk_mul_f16 v142, v142, v135 op_sel:[0,0] op_sel_hi:[1,0]
    v_mfma_f32_16x16x32_bf16 v[170:173], a[132:135], v[182:185], v[170:173]
    v_pk_mul_f16 v143, v143, v135 op_sel:[0,0] op_sel_hi:[1,0]
    v_pk_mul_f16 v144, v144, v135 op_sel:[0,0] op_sel_hi:[1,0]
    v_mfma_f32_16x16x32_bf16 v[170:173], a[136:139], v[210:213], v[170:173]
    ds_read_b128 v[234:237], v0 offset:26624
    v_pk_mul_f16 v145, v145, v135 op_sel:[0,0] op_sel_hi:[1,0]
    v_mfma_f32_16x16x32_bf16 v[170:173], a[140:143], v[186:189], v[170:173]
    ds_read_b128 v[114:117], v1 offset:26624
    buffer_load_dwordx4 v164, s[52:55], 0 offen offset:1024 lds
    v_mfma_f32_16x16x32_bf16 v[206:209], v[126:129], a[144:147], 0
    ds_read_b128 v[182:185], v0 offset:26752
    v_pk_mul_f16 v146, v146, v135 op_sel:[0,0] op_sel_hi:[1,0]
    v_mfma_f32_16x16x32_bf16 v[206:209], v[190:193], a[148:151], v[206:209]
    ds_read_b128 v[186:189], v1 offset:26752
    v_pk_mul_f16 v147, v147, v135 op_sel:[0,0] op_sel_hi:[1,0]
    v_mfma_f32_16x16x32_bf16 v[206:209], v[178:181], a[152:155], v[206:209]
    ds_read_b128 v[210:213], v0 offset:26880
    s_waitcnt vmcnt(5)
    v_mfma_f32_16x16x32_bf16 v[206:209], v[202:205], a[156:159], v[206:209]
    ds_read_b64_tr_b16 a[164:165], v138 offset:3072
    ds_read_b64_tr_b16 a[166:167], v138 offset:3840
    v_mfma_f32_16x16x32_bf16 v[206:209], v[226:229], a[160:163], v[206:209]
    s_waitcnt lgkmcnt(6)
    ds_read_b64_tr_b16 a[188:189], v138 offset:3104
    ds_read_b64_tr_b16 a[190:191], v138 offset:3872
    v_mfma_f32_16x16x32_bf16 v[222:225], v[126:129], a[168:171], 0
    s_waitcnt lgkmcnt(7)
    buffer_load_dwordx4 v254, s[52:55], 0 offen offset:2048 lds
    ds_read_b64_tr_b16 a[212:213], v138 offset:3136
    v_mfma_f32_16x16x32_bf16 v[222:225], v[190:193], a[172:175], v[222:225]
    s_add_u32 s52, s52, 12288
    ds_read_b64_tr_b16 a[214:215], v138 offset:3904
    ds_read_b128 v[138:141], v1 offset:26880
    v_mfma_f32_16x16x32_bf16 v[222:225], v[178:181], a[176:179], v[222:225]
    s_addc_u32 s53, s53, 0
    v_max3_u32 v44, v44, v158, v159
    v_cvt_pk_f16_f32 v161, v136, v137
    v_mfma_f32_16x16x32_bf16 v[222:225], v[202:205], a[180:183], v[222:225]
    s_add_u32 m0, s68, 0
    v_pk_fma_f16 v119, v161, v161, v119
    v_cvt_pk_f16_f32 v134, v214, v215
    v_mfma_f32_16x16x32_bf16 v[222:225], v[226:229], a[184:187], v[222:225]
    s_waitcnt lgkmcnt(6)
    v_pk_mul_f16 v123, v134, v134
    v_cvt_pk_f16_f32 v135, v216, v217
    v_mfma_f32_16x16x32_bf16 v[214:217], v[126:129], a[192:195], 0
    s_waitcnt lgkmcnt(4)
    v_pk_fma_f16 v123, v135, v135, v123
    v_cvt_pk_f16_f32 v136, v198, v199
    v_mfma_f32_16x16x32_bf16 v[206:209], v[174:177], a[164:167], v[206:209]
    s_waitcnt lgkmcnt(3)
    buffer_load_dwordx4 v157, s[52:55], 0 offen lds
    v_pk_fma_f16 v123, v136, v136, v123
    v_mfma_f32_16x16x32_bf16 v[222:225], v[174:177], a[188:191], v[222:225]
    s_waitcnt lgkmcnt(1)
    v_cvt_pk_f16_f32 v137, v200, v201
    v_pk_fma_f16 v123, v137, v137, v123
    v_mfma_f32_16x16x32_bf16 v[214:217], v[190:193], a[196:199], v[214:217]
    s_waitcnt lgkmcnt(0)
    v_cvt_pk_f16_f32 v132, v170, v171
    v_pk_fma_f16 v123, v132, v132, v123
    v_mfma_f32_16x16x32_bf16 v[214:217], v[178:181], a[200:203], v[214:217]
    v_cvt_pk_f16_f32 v133, v172, v173
    v_pk_fma_f16 v123, v133, v133, v123
    v_mfma_f32_16x16x32_bf16 v[214:217], v[202:205], a[204:207], v[214:217]
    v_cvt_pk_bf16_f32 v206, v206, v206
    v_cvt_pk_bf16_f32 v207, v207, v207
    v_mfma_f32_16x16x32_bf16 v[214:217], v[226:229], a[208:211], v[214:217]
    ds_write2_b32 v155, v206, v207 offset0:0 offset1:68
    v_mfma_f32_16x16x32_bf16 v[214:217], v[174:177], a[212:215], v[214:217]
    buffer_load_dwordx4 v164, s[52:55], 0 offen offset:1024 lds
    v_cvt_pk_bf16_f32 v208, v208, v208
    v_mfma_f32_16x16x32_bf16 v[126:129], v[234:237], a[144:147], 0
    v_cvt_pk_bf16_f32 v209, v209, v209
    v_cvt_pk_bf16_f32 v222, v222, v222
    v_mfma_f32_16x16x32_bf16 v[126:129], v[114:117], a[148:151], v[126:129]
    ds_write2_b32 v155, v208, v209 offset0:136 offset1:204
    s_waitcnt vmcnt(5)
    v_mfma_f32_16x16x32_bf16 v[126:129], v[182:185], a[152:155], v[126:129]
    v_cvt_pk_bf16_f32 v223, v223, v223
    v_cvt_pk_bf16_f32 v224, v224, v224
    v_mfma_f32_16x16x32_bf16 v[126:129], v[186:189], a[156:159], v[126:129]
    ds_read_b64 a[216:217], v124 offset:0
    ds_read_b64 a[218:219], v124 offset:1536
    v_mfma_f32_16x16x32_bf16 v[126:129], v[210:213], a[160:163], v[126:129]
    buffer_load_dwordx4 v254, s[52:55], 0 offen offset:2048 lds
    ds_read_b64 a[240:241], v124 offset:8
    v_mfma_f32_16x16x32_bf16 v[126:129], v[138:141], a[164:167], v[126:129]
    s_add_u32 s52, s52, 12288
    ds_read_b64 a[242:243], v124 offset:1544
    ds_read_b64 v[90:91], v131 offset:0
    v_mfma_f32_16x16x32_bf16 v[206:209], v[234:237], a[168:171], 0
    s_addc_u32 s53, s53, 0
    ds_read_b64 v[92:93], v131 offset:1536
    ds_read_b128 v[190:193], v152 offset:0
    v_mfma_f32_16x16x32_bf16 v[206:209], v[114:117], a[172:175], v[206:209]
    s_add_u32 m0, s68, 3072
    ds_read_b128 v[178:181], v151 offset:0
    ds_read_b128 v[226:229], v152 offset:128
    v_mfma_f32_16x16x32_bf16 v[206:209], v[182:185], a[176:179], v[206:209]
    s_mul_i32 s68, s78, 72
    ds_read_b128 v[202:205], v151 offset:128
    v_cvt_pk_bf16_f32 v225, v225, v225
    v_mfma_f32_16x16x32_bf16 v[206:209], v[186:189], a[180:183], v[206:209]
    s_sub_u32 s68, s77, s68
    ds_read_b128 v[174:177], v152 offset:256
    buffer_load_dwordx4 v157, s[52:55], 0 offen lds
    v_mfma_f32_16x16x32_bf16 v[206:209], v[210:213], a[184:187], v[206:209]
    s_mul_i32 s78, s78, 1373568
    ds_read_b128 v[198:201], v151 offset:256
    v_cvt_pk_bf16_f32 v214, v214, v214
    v_mfma_f32_16x16x32_bf16 v[206:209], v[138:141], a[188:191], v[206:209]
    s_mul_i32 s77, s68, 2688
    ds_write2_b32 v155, v222, v223 offset0:16 offset1:84
    v_mfma_f32_16x16x32_bf16 v[170:173], v[234:237], a[192:195], 0
    s_waitcnt lgkmcnt(6)
    v_cvt_pk_bf16_f32 v215, v215, v215
    v_cvt_pk_bf16_f32 v216, v216, v216
    v_mfma_f32_16x16x32_bf16 v[170:173], v[114:117], a[196:199], v[170:173]
    s_add_u32 s77, s77, s78
    ds_write2_b32 v155, v224, v225 offset0:152 offset1:220
    v_mfma_f32_16x16x32_bf16 v[170:173], v[182:185], a[200:203], v[170:173]
    s_waitcnt lgkmcnt(4)
    buffer_load_dwordx4 v164, s[52:55], 0 offen offset:1024 lds
    v_cvt_pk_bf16_f32 v217, v217, v217
    v_mfma_f32_16x16x32_bf16 v[170:173], v[186:189], a[204:207], v[170:173]
    s_waitcnt lgkmcnt(3)
    ds_write2_b32 v155, v214, v215 offset0:32 offset1:100
    v_mfma_f32_16x16x32_bf16 v[170:173], v[210:213], a[208:211], v[170:173]
    s_waitcnt lgkmcnt(3)
    v_cvt_pk_bf16_f32 v116, v126, v127
    v_cvt_pk_bf16_f32 v117, v128, v129
    v_mfma_f32_16x16x32_bf16 v[170:173], v[138:141], a[212:215], v[170:173]
    s_waitcnt vmcnt(5)
    ds_read_b64 a[232:233], v124 offset:3072
    ds_read_b64 a[220:221], v124 offset:4608
    v_mfma_f32_16x16x32_bf16 v[234:237], v[190:193], a[144:147], 0
    s_barrier
    ds_read_b64 v[82:83], v124 offset:3080
    ds_read_b64 a[244:245], v124 offset:4616
    v_mfma_f32_16x16x32_bf16 v[234:237], v[178:181], a[148:151], v[234:237]
    buffer_load_dwordx4 v254, s[52:55], 0 offen offset:2048 lds
    ds_read_b64 v[106:107], v131 offset:3072
    v_mfma_f32_16x16x32_bf16 v[234:237], v[226:229], a[152:155], v[234:237]
    s_add_u32 s52, s52, 12288
    ds_read_b64 v[94:95], v131 offset:4608
    v_cvt_pk_bf16_f32 v128, v206, v207
    v_mfma_f32_16x16x32_bf16 v[234:237], v[202:205], a[156:159], v[234:237]
    s_addc_u32 s53, s53, 0
    ds_write2_b32 v155, v216, v217 offset0:168 offset1:236
    v_mfma_f32_16x16x32_bf16 v[234:237], v[174:177], a[160:163], v[234:237]
    s_add_u32 m0, s69, 0
    v_cvt_pk_bf16_f32 v129, v208, v209
    v_cvt_pk_bf16_f32 v152, v170, v171
    v_mfma_f32_16x16x32_bf16 v[234:237], v[198:201], a[164:167], v[234:237]
    s_waitcnt lgkmcnt(5)
    ds_read_b128 v[206:209], v0 offset:26624
    v_cvt_pk_bf16_f32 v153, v172, v173
    v_mfma_f32_16x16x32_bf16 v[182:185], v[190:193], a[168:171], 0
    s_waitcnt lgkmcnt(4)
    buffer_load_dwordx4 v157, s[52:55], 0 offen lds
    ds_read_b128 v[186:189], v1 offset:26624
    v_mfma_f32_16x16x32_bf16 v[182:185], v[178:181], a[172:175], v[182:185]
    s_waitcnt lgkmcnt(4)
    ds_read_b128 v[138:141], v0 offset:26752
    v_cvt_pk_bf16_f32 v234, v234, v234
    v_mfma_f32_16x16x32_bf16 v[182:185], v[226:229], a[176:179], v[182:185]
    s_waitcnt lgkmcnt(4)
    ds_read_b128 v[210:213], v1 offset:26752
    v_cvt_pk_bf16_f32 v235, v235, v235
    v_mfma_f32_16x16x32_bf16 v[182:185], v[202:205], a[180:183], v[182:185]
    ds_read_b128 v[214:217], v0 offset:26880
    v_cvt_pk_bf16_f32 v236, v236, v236
    v_mfma_f32_16x16x32_bf16 v[182:185], v[174:177], a[184:187], v[182:185]
    ds_read_b128 v[170:173], v1 offset:26880
    v_cvt_pk_bf16_f32 v237, v237, v237
    v_mfma_f32_16x16x32_bf16 v[182:185], v[198:201], a[188:191], v[182:185]
    s_waitcnt lgkmcnt(5)
    ds_write2_b32 v154, v234, v235 offset0:0 offset1:68
    v_mfma_f32_16x16x32_bf16 v[222:225], v[190:193], a[192:195], 0
    s_waitcnt lgkmcnt(5)
    buffer_load_dwordx4 v164, s[52:55], 0 offen offset:1024 lds
    v_xor_b32 v155, 65536, v2
    v_mfma_f32_16x16x32_bf16 v[222:225], v[178:181], a[196:199], v[222:225]
    s_waitcnt lgkmcnt(4)
    ds_write2_b32 v154, v236, v237 offset0:136 offset1:204
    v_mfma_f32_16x16x32_bf16 v[222:225], v[226:229], a[200:203], v[222:225]
    s_waitcnt lgkmcnt(4)
    v_cvt_pk_bf16_f32 v182, v182, v182
    v_cvt_pk_bf16_f32 v183, v183, v183
    v_mfma_f32_16x16x32_bf16 v[222:225], v[202:205], a[204:207], v[222:225]
    s_waitcnt lgkmcnt(3)
    ds_write2_b32 v154, v182, v183 offset0:16 offset1:84
    s_waitcnt vmcnt(5)
    v_mfma_f32_16x16x32_bf16 v[222:225], v[174:177], a[208:211], v[222:225]
    s_waitcnt lgkmcnt(2)
    v_cvt_pk_bf16_f32 v184, v184, v184
    v_cvt_pk_bf16_f32 v185, v185, v185
    v_mfma_f32_16x16x32_bf16 v[222:225], v[198:201], a[212:215], v[222:225]
    buffer_load_dwordx4 v254, s[52:55], 0 offen offset:2048 lds
    ds_read_b64 a[222:223], v165 offset:0
    v_mfma_f32_16x16x32_bf16 v[234:237], a[0:3], v[206:209], 0
    s_add_u32 s52, s52, 12288
    ds_read_b64 a[234:235], v165 offset:1536
    ds_read_b64 a[246:247], v165 offset:8
    v_mfma_f32_16x16x32_bf16 v[234:237], a[4:7], v[186:189], v[234:237]
    s_addc_u32 s53, s53, 0
    ds_read_b64 v[84:85], v165 offset:1544
    ds_read_b64 v[96:97], v255 offset:0
    v_mfma_f32_16x16x32_bf16 v[234:237], a[8:11], v[138:141], v[234:237]
    s_add_u32 m0, s69, 3072
    ds_read_b64 v[108:109], v255 offset:1536
    v_cvt_pk_bf16_f32 v222, v222, v222
    v_mfma_f32_16x16x32_bf16 v[234:237], a[12:15], v[210:213], v[234:237]
    s_add_u32 s69, s77, 589824
    ds_write2_b32 v154, v184, v185 offset0:152 offset1:220
    v_mfma_f32_16x16x32_bf16 v[234:237], a[16:19], v[214:217], v[234:237]
    buffer_load_dwordx4 v157, s[52:55], 0 offen lds
    v_cvt_pk_bf16_f32 v223, v223, v223
    v_mfma_f32_16x16x32_bf16 v[234:237], a[20:23], v[170:173], v[234:237]
    s_waitcnt lgkmcnt(6)
    ds_read_b128 v[182:185], v0 offset:20480
    v_cvt_pk_bf16_f32 v224, v224, v224
    v_mfma_f32_16x16x32_bf16 v[190:193], a[24:27], v[206:209], 0
    s_waitcnt lgkmcnt(5)
    ds_read_b128 v[226:229], v1 offset:20480
    v_cvt_pk_bf16_f32 v225, v225, v225
    v_mfma_f32_16x16x32_bf16 v[190:193], a[28:31], v[186:189], v[190:193]
    s_waitcnt lgkmcnt(4)
    ds_read_b128 v[202:205], v0 offset:20608
    v_cvt_pk_f16_f32 v234, v234, v235
    v_mfma_f32_16x16x32_bf16 v[190:193], a[32:35], v[138:141], v[190:193]
    s_waitcnt lgkmcnt(4)
    ds_read_b128 v[178:181], v1 offset:20608
    v_pk_mul_f16 v118, v234, v234
    v_mfma_f32_16x16x32_bf16 v[190:193], a[36:39], v[210:213], v[190:193]
    ds_read_b128 v[198:201], v0 offset:20736
    buffer_load_dwordx4 v164, s[52:55], 0 offen offset:1024 lds
    v_mfma_f32_16x16x32_bf16 v[190:193], a[40:43], v[214:217], v[190:193]
    ds_read_b128 v[174:177], v1 offset:20736
    v_cvt_pk_f16_f32 v235, v236, v237
    v_mfma_f32_16x16x32_bf16 v[190:193], a[44:47], v[170:173], v[190:193]
    s_waitcnt lgkmcnt(5)
    ds_write2_b32 v154, v222, v223 offset0:32 offset1:100
    v_mfma_f32_16x16x32_bf16 v[166:169], a[48:51], v[206:209], 0
    s_waitcnt lgkmcnt(5)
    v_pk_fma_f16 v118, v235, v235, v118
    v_lshrrev_b32 v164, 2, v155
    s_waitcnt vmcnt(5)
    v_mfma_f32_16x16x32_bf16 v[166:169], a[52:55], v[186:189], v[166:169]
    s_waitcnt lgkmcnt(4)
    ds_read_b64 a[224:225], v165 offset:3072
    ds_read_b64 a[226:227], v165 offset:4608
    v_mfma_f32_16x16x32_bf16 v[166:169], a[56:59], v[138:141], v[166:169]
    s_waitcnt lgkmcnt(5)
    buffer_load_dwordx4 v254, s[52:55], 0 offen offset:2048 lds
    ds_read_b64 a[248:249], v165 offset:3080
    v_mfma_f32_16x16x32_bf16 v[166:169], a[60:63], v[210:213], v[166:169]
    s_add_u32 m0, s28, 65536
    ds_read_b64 a[250:251], v165 offset:4616
    ds_read_b64 v[98:99], v255 offset:3072
    v_mfma_f32_16x16x32_bf16 v[166:169], a[64:67], v[214:217], v[166:169]
    s_waitcnt lgkmcnt(6)
    ds_read_b64 v[100:101], v255 offset:4608
    v_cvt_pk_f16_f32 v236, v190, v191
    v_mfma_f32_16x16x32_bf16 v[166:169], a[68:71], v[170:173], v[166:169]
    ds_write2_b32 v154, v224, v225 offset0:168 offset1:236
    v_mfma_f32_16x16x32_bf16 v[206:209], v[182:185], a[144:147], 0
    v_pk_fma_f16 v118, v236, v236, v118
    v_cvt_pk_f16_f32 v237, v192, v193
    v_mfma_f32_16x16x32_bf16 v[206:209], v[226:229], a[148:151], v[206:209]
    s_waitcnt lgkmcnt(5)
    buffer_load_dwordx4 v10, s[8:11], s24 offen nt lds
    v_mfma_f32_16x16x32_bf16 v[206:209], v[202:205], a[152:155], v[206:209]
    s_add_u32 m0, s28, 69632
    v_pk_fma_f16 v118, v237, v237, v118
    v_cvt_pk_f16_f32 v158, v166, v167
    v_mfma_f32_16x16x32_bf16 v[206:209], v[178:181], a[156:159], v[206:209]
    s_waitcnt lgkmcnt(2)
    v_pk_fma_f16 v118, v158, v158, v118
    v_cvt_pk_f16_f32 v159, v168, v169
    v_mfma_f32_16x16x32_bf16 v[206:209], v[198:201], a[160:163], v[206:209]
    s_waitcnt lgkmcnt(1)
    v_pk_fma_f16 v118, v159, v159, v118
    v_mov_b32 v120, 0
    v_mfma_f32_16x16x32_bf16 v[206:209], v[174:177], a[164:167], v[206:209]
    ds_read_b128 v[138:141], v0 offset:32768
    v_mov_b32 v121, 0
    v_mfma_f32_16x16x32_bf16 v[186:189], v[182:185], a[168:171], 0
    ds_read_b128 v[190:193], v1 offset:32768
    v_lshrrev_b32 v165, 8, v155
    v_mfma_f32_16x16x32_f16 v[214:217], v[40:43], v[118:121], 0
    buffer_load_dwordx4 v11, s[8:11], s24 offen nt lds
    v_mfma_f32_16x16x32_bf16 v[186:189], v[226:229], a[172:175], v[186:189]
    s_add_u32 m0, s28, 73728
    ds_read_b128 v[118:121], v0 offset:32896
    v_cvt_pk_bf16_f32 v114, v206, v207
    v_mfma_f32_16x16x32_bf16 v[186:189], v[202:205], a[176:179], v[186:189]
    ds_read_b128 v[210:213], v1 offset:32896
    v_cvt_pk_bf16_f32 v115, v208, v209
    v_mfma_f32_16x16x32_bf16 v[186:189], v[178:181], a[180:183], v[186:189]
    ds_read_b128 v[206:209], v0 offset:33024
    v_xor_b32 v0, 65536, v0
    v_mfma_f32_16x16x32_bf16 v[186:189], v[198:201], a[184:187], v[186:189]
    s_waitcnt lgkmcnt(4)
    ds_read_b128 v[222:225], v1 offset:33024
    s_waitcnt vmcnt(5)
    v_mfma_f32_16x16x32_bf16 v[186:189], v[174:177], a[188:191], v[186:189]
    s_waitcnt lgkmcnt(4)
    ds_read_b64 a[236:237], v124 offset:0
    ds_read_b64 a[228:229], v124 offset:1536
    v_mfma_f32_16x16x32_bf16 v[170:173], v[182:185], a[192:195], 0
    buffer_load_dwordx4 v12, s[8:11], s24 offen nt lds
    v_mfma_f32_16x16x32_bf16 v[170:173], v[226:229], a[196:199], v[170:173]
    s_add_u32 m0, s28, 77824
    ds_read_b64 v[86:87], v124 offset:8
    ds_read_b64 a[252:253], v124 offset:1544
    v_mfma_f32_16x16x32_bf16 v[170:173], v[202:205], a[200:203], v[170:173]
    s_waitcnt lgkmcnt(6)
    ds_read_b64 v[110:111], v131 offset:0
    ds_read_b64 v[102:103], v131 offset:1536
    v_mfma_f32_16x16x32_bf16 v[170:173], v[178:181], a[204:207], v[170:173]
    s_waitcnt lgkmcnt(7)
    ds_read_b128 v[226:229], v150 offset:0
    ds_read_b128 v[182:185], v150 offset:16
    v_mfma_f32_16x16x32_bf16 v[170:173], v[198:201], a[208:211], v[170:173]
    s_waitcnt lgkmcnt(8)
    ds_read_b128 v[178:181], v150 offset:48
    ds_read_b32 v254, v6 offset:192
    v_mfma_f32_16x16x32_bf16 v[170:173], v[174:177], a[212:215], v[170:173]
    s_waitcnt lgkmcnt(9)
    v_rsq_f32 v214, v214
    v_mfma_f32_16x16x32_bf16 v[174:177], a[0:3], v[138:141], 0
    s_waitcnt lgkmcnt(8)
    buffer_load_dwordx4 v13, s[8:11], s24 offen nt lds
    v_mfma_f32_16x16x32_bf16 v[174:177], a[4:7], v[190:193], v[174:177]
    s_add_u32 m0, s74, 0
    v_rsq_f32 v215, v215
    v_mfma_f32_16x16x32_bf16 v[174:177], a[8:11], v[118:121], v[174:177]
    s_waitcnt lgkmcnt(5)
    v_mul_f32 v126, s31, v214
    v_cvt_pk_f16_f32 v127, v126, v215
    v_mfma_f32_16x16x32_bf16 v[174:177], a[12:15], v[210:213], v[174:177]
    s_waitcnt lgkmcnt(3)
    v_pk_mul_f16 v218, v218, v127 op_sel:[0,1] op_sel_hi:[1,1]
    v_pk_mul_f16 v219, v219, v127 op_sel:[0,1] op_sel_hi:[1,1]
    v_mfma_f32_16x16x32_bf16 v[174:177], a[16:19], v[206:209], v[174:177]
    s_waitcnt lgkmcnt(1)
    v_pk_mul_f16 v220, v220, v127 op_sel:[0,1] op_sel_hi:[1,1]
    v_pk_mul_f16 v221, v221, v127 op_sel:[0,1] op_sel_hi:[1,1]
    v_mfma_f32_16x16x32_bf16 v[174:177], a[20:23], v[222:225], v[174:177]
    s_waitcnt lgkmcnt(0)
    v_pk_mul_f16 v160, v160, v127 op_sel:[0,1] op_sel_hi:[1,1]
    v_pk_mul_f16 v161, v161, v127 op_sel:[0,1] op_sel_hi:[1,1]
    v_mfma_f32_16x16x32_bf16 v[202:205], a[24:27], v[138:141], 0
    buffer_load_dwordx4 v14, s[8:11], s24 offen nt lds
    v_mfma_f32_16x16x32_bf16 v[202:205], a[28:31], v[190:193], v[202:205]
    s_add_u32 s8, s60, s23
    v_pk_mul_f16 v234, v234, v127 op_sel:[0,0] op_sel_hi:[1,0]
    v_pk_mul_f16 v235, v235, v127 op_sel:[0,0] op_sel_hi:[1,0]
    v_mfma_f32_16x16x32_bf16 v[202:205], a[32:35], v[118:121], v[202:205]
    s_addc_u32 s9, s61, 0
    s_waitcnt vmcnt(5)
    ds_read_b64 a[230:231], v124 offset:3072
    v_mfma_f32_16x16x32_bf16 v[202:205], a[36:39], v[210:213], v[202:205]
    s_sub_u32 s10, s36, s23
    ds_read_b64 a[238:239], v124 offset:4608
    ds_read_b64 a[254:255], v124 offset:3080
    v_mfma_f32_16x16x32_bf16 v[202:205], a[40:43], v[206:209], v[202:205]
    s_cmp_lt_u32 s34, s17
    ds_read_b64 v[88:89], v124 offset:4616
    ds_read_b64 v[104:105], v131 offset:3072
    v_mfma_f32_16x16x32_bf16 v[202:205], a[44:47], v[222:225], v[202:205]
    s_cselect_b32 s10, s10, 0
    ds_read_b64 v[112:113], v131 offset:4608
    v_pk_mul_f16 v236, v236, v127 op_sel:[0,0] op_sel_hi:[1,0]
    v_mfma_f32_16x16x32_bf16 v[198:201], a[48:51], v[138:141], 0
    s_add_u32 m0, s28, 0
    v_pk_mul_f16 v237, v237, v127 op_sel:[0,0] op_sel_hi:[1,0]
    v_pk_mul_f16 v158, v158, v127 op_sel:[0,0] op_sel_hi:[1,0]
    v_mfma_f32_16x16x32_bf16 v[198:201], a[52:55], v[190:193], v[198:201]
    s_mov_b32 s24, s23
    v_pk_mul_f16 v159, v159, v127 op_sel:[0,0] op_sel_hi:[1,0]
    v_max3_u32 v44, v44, v214, v215
    v_mfma_f32_16x16x32_bf16 v[198:201], a[56:59], v[118:121], v[198:201]
    s_add_u32 s23, s23, s21
    v_cvt_pk_bf16_f32 v126, v186, v187
    v_cvt_pk_bf16_f32 v127, v188, v189
    v_mfma_f32_16x16x32_bf16 v[198:201], a[60:63], v[210:213], v[198:201]
    s_cmp_ge_u32 s19, 72
    v_cvt_pk_bf16_f32 v150, v170, v171
    v_cvt_pk_bf16_f32 v151, v172, v173
    v_mfma_f32_16x16x32_bf16 v[198:201], a[64:67], v[206:209], v[198:201]
    s_cselect_b32 s34, 72, 0
    v_cvt_pk_f16_f32 v186, v174, v175
    v_pk_mul_f16 v122, v186, v186
    v_mfma_f32_16x16x32_bf16 v[198:201], a[68:71], v[222:225], v[198:201]
    s_cselect_b32 s35, s22, 0
    v_cvt_pk_f16_f32 v187, v176, v177
    v_pk_fma_f16 v122, v187, v187, v122
    v_mfma_f32_16x16x32_bf16 v[214:217], v[138:141], a[144:147], 0
    s_sub_u32 s19, s19, s34
    v_cvt_pk_f16_f32 v188, v202, v203
    v_pk_fma_f16 v122, v188, v188, v122
    v_mfma_f32_16x16x32_bf16 v[214:217], v[190:193], a[148:151], v[214:217]
    s_add_u32 s23, s23, s35
    v_cvt_pk_f16_f32 v189, v204, v205
    v_pk_fma_f16 v122, v189, v189, v122
    v_mfma_f32_16x16x32_bf16 v[214:217], v[118:121], a[152:155], v[214:217]
    s_waitcnt lgkmcnt(0)
    v_cvt_pk_f16_f32 v130, v198, v199
    v_pk_fma_f16 v122, v130, v130, v122
    v_mfma_f32_16x16x32_bf16 v[214:217], v[210:213], a[156:159], v[214:217]
    v_cvt_pk_f16_f32 v131, v200, v201
    v_pk_fma_f16 v122, v131, v131, v122
    v_mfma_f32_16x16x32_f16 v[174:177], v[226:229], v[142:145], v[22:25]
    v_mov_b32 v124, 0
    v_mov_b32 v125, 0
    v_mfma_f32_16x16x32_f16 v[174:177], v[182:185], v[194:197], v[174:177]
    v_xor_b32 v1, 65536, v1
    v_lshl_add_u32 v255, s16, 2, v155
    v_mfma_f32_16x16x32_f16 v[202:205], v[40:43], v[122:125], 0
    v_add_u32 v164, 62784, v164
    v_lshlrev_b32 v165, 4, v165
    v_mfma_f32_16x16x32_f16 v[174:177], v[178:181], v[146:149], v[174:177]
    v_add_u32 v165, 62784, v165
    v_or_b32 v122, v32, v33
    v_mfma_f32_16x16x32_bf16 v[214:217], v[206:209], a[160:163], v[214:217]
    v_and_b32 v122, 0xffff, v122
    v_lshl_or_b32 v122, v122, 16, v122
    v_mfma_f32_16x16x32_bf16 v[214:217], v[222:225], a[164:167], v[214:217]
    v_rsq_f32 v202, v202
    v_mfma_f32_16x16x32_bf16 v[198:201], v[138:141], a[168:171], 0
    v_rsq_f32 v203, v203
    v_mfma_f32_16x16x32_bf16 v[198:201], v[190:193], a[172:175], v[198:201]
    v_mul_f32 v176, s31, v202
    v_cvt_pk_f16_f32 v177, v176, v203
    v_mfma_f32_16x16x32_f16 v[170:173], v[194:197], v[142:145], v[46:49]
    v_pk_mul_f16 v134, v134, v177 op_sel:[0,1] op_sel_hi:[1,1]
    v_pk_mul_f16 v135, v135, v177 op_sel:[0,1] op_sel_hi:[1,1]
    v_mfma_f32_16x16x32_f16 v[166:169], v[218:221], v[142:145], v[50:53]
    v_pk_mul_f16 v136, v136, v177 op_sel:[0,1] op_sel_hi:[1,1]
    v_pk_mul_f16 v137, v137, v177 op_sel:[0,1] op_sel_hi:[1,1]
    v_mfma_f32_16x16x32_bf16 v[198:201], v[118:121], a[176:179], v[198:201]
    v_pk_mul_f16 v132, v132, v177 op_sel:[0,1] op_sel_hi:[1,1]
    v_pk_mul_f16 v133, v133, v177 op_sel:[0,1] op_sel_hi:[1,1]
    v_pk_mul_f16 v186, v186, v177 op_sel:[0,0] op_sel_hi:[1,0]
    v_mfma_f32_16x16x16_f16 v[170:173], v[148:149], v[146:147], v[170:173]
    v_pk_mul_f16 v187, v187, v177 op_sel:[0,0] op_sel_hi:[1,0]
    v_pk_mul_f16 v188, v188, v177 op_sel:[0,0] op_sel_hi:[1,0]
    v_pk_mul_f16 v189, v189, v177 op_sel:[0,0] op_sel_hi:[1,0]
    v_mfma_f32_16x16x16_f16 v[166:169], v[160:161], v[146:147], v[166:169]
    v_pk_mul_f16 v130, v130, v177 op_sel:[0,0] op_sel_hi:[1,0]
    v_pk_mul_f16 v131, v131, v177 op_sel:[0,0] op_sel_hi:[1,0]
    v_max3_u32 v44, v44, v202, v203
    v_mov_b32_dpp v254, v175 quad_perm:[0,1,2,3] row_mask:0x1 bank_mask:0xf
    v_mfma_f32_16x16x32_f16 v[202:205], v[134:137], v[142:145], v[54:57]
    v_cvt_pk_bf16_f32 v214, v214, v215
    v_cvt_pk_bf16_f32 v215, v216, v217
    v_mfma_f32_16x16x32_f16 v[142:145], v[226:229], v[234:237], v[24:27]
    v_exp_f32 v170, v170
    v_mfma_f32_16x16x32_f16 v[142:145], v[182:185], v[218:221], v[142:145]
    v_exp_f32 v171, v171
    v_or_b32 v123, v32, v33
    v_mfma_f32_16x16x16_f16 v[202:205], v[132:133], v[146:147], v[202:205]
    v_cvt_pk_bf16_f32 v170, v170, v171
    v_exp_f32 v172, v172
    v_and_b32 v123, 0xffff, v123
    v_mfma_f32_16x16x32_f16 v[142:145], v[178:181], v[158:161], v[142:145]
    v_exp_f32 v173, v173
    v_mfma_f32_16x16x32_bf16 v[198:201], v[210:213], a[180:183], v[198:201]
    v_cvt_pk_bf16_f32 v171, v172, v173
    v_lshl_or_b32 v123, v123, 16, v123
    v_mfma_f32_16x16x32_bf16 v[198:201], v[206:209], a[184:187], v[198:201]
    v_exp_f32 v166, v166
    v_mfma_f32_16x16x32_bf16 v[198:201], v[222:225], a[188:191], v[198:201]
    v_exp_f32 v167, v167
    v_mfma_f32_16x16x32_bf16 v[230:233], v[138:141], a[192:195], 0
    v_mov_b32_dpp v254, v143 quad_perm:[0,1,2,3] row_mask:0x2 bank_mask:0xf
    v_cvt_pk_bf16_f32 v172, v166, v167
    v_mfma_f32_16x16x32_bf16 v[230:233], v[190:193], a[196:199], v[230:233]
    ds_read2_b32 v[216:217], v6 offset0:0 offset1:0
    ds_read2_b32 v[192:193], v6 offset0:16 offset1:16
    v_mfma_f32_16x16x32_bf16 v[230:233], v[118:121], a[200:203], v[230:233]
    ds_read2_b32 v[140:141], v6 offset0:32 offset1:32
    v_add_u32 v6, 272, v6
    v_mfma_f32_16x16x32_f16 v[118:121], v[226:229], v[186:189], v[26:29]
    v_cvt_pk_bf16_f32 v190, v198, v199
    v_cvt_pk_bf16_f32 v191, v200, v201
    v_mfma_f32_16x16x32_f16 v[118:121], v[182:185], v[134:137], v[118:121]
    v_exp_f32 v168, v168
    v_mfma_f32_16x16x32_f16 v[118:121], v[178:181], v[130:133], v[118:121]
    v_exp_f32 v169, v169
    v_mfma_f32_16x16x32_bf16 v[230:233], v[210:213], a[204:207], v[230:233]
    v_cvt_pk_bf16_f32 v173, v168, v169
    v_or_b32 v124, v32, v33
    v_mfma_f32_16x16x32_bf16 v[230:233], v[206:209], a[208:211], v[230:233]
    s_waitcnt lgkmcnt(2)
    v_exp_f32 v202, v202
    v_mfma_f32_16x16x32_bf16 v[230:233], v[222:225], a[212:215], v[230:233]
    s_waitcnt lgkmcnt(0)
    v_mov_b32_dpp v254, v119 quad_perm:[0,1,2,3] row_mask:0x4 bank_mask:0xf
    v_lshrrev_b32 v124, 16, v124
    v_mfma_f32_16x16x32_f16 v[206:209], v[194:197], v[234:237], v[58:61]
    v_exp_f32 v254, v254
    v_exp_f32 v203, v203
    v_cvt_pk_bf16_f32 v254, v254, v254
    ds_write_b16 v8, v254
    v_cvt_pk_bf16_f32 v138, v230, v231
    v_cvt_pk_bf16_f32 v139, v232, v233
    v_mfma_f32_16x16x16_f16 v[206:209], v[148:149], v[158:159], v[206:209]
    v_cvt_pk_bf16_f32 v36, v202, v203
    v_exp_f32 v204, v204
    v_lshl_or_b32 v124, v124, 16, v124
    v_mfma_f32_16x16x32_f16 v[182:185], v[218:221], v[234:237], v[62:65]
    v_exp_f32 v205, v205
    v_mfma_f32_16x16x32_f16 v[226:229], v[134:137], v[234:237], v[66:69]
    v_cvt_pk_bf16_f32 v37, v204, v205
    v_exp_f32 v174, v174
    v_exp_f32 v118, v118
    v_cvt_pk_bf16_f32 v39, v174, 0
    v_mfma_f32_16x16x16_f16 v[182:185], v[160:161], v[158:159], v[182:185]
    v_exp_f32 v206, v206
    v_exp_f32 v207, v207
    v_mfma_f32_16x16x32_f16 v[234:237], v[194:197], v[186:189], v[70:73]
    v_cvt_pk_bf16_f32 v206, v206, v207
    v_or_b32 v125, v32, v33
    v_mfma_f32_16x16x32_bf16 v[194:197], v[28:31], v[36:39], 0
    v_exp_f32 v208, v208
    v_mfma_f32_16x16x32_bf16 v[194:197], v[28:31], v[170:173], v[194:197]
    v_exp_f32 v209, v209
    v_lshrrev_b32 v125, 16, v125
    v_mfma_f32_16x16x16_f16 v[234:237], v[148:149], v[130:131], v[234:237]
    v_cvt_pk_bf16_f32 v207, v208, v209
    v_exp_f32 v182, v182
    v_lshl_or_b32 v125, v125, 16, v125
    v_mfma_f32_16x16x32_f16 v[146:149], v[218:221], v[186:189], v[74:77]
    v_exp_f32 v183, v183
    v_mfma_f32_16x16x32_bf16 v[218:221], v[214:217], v[36:39], 0
    v_rcp_f32 v194, v194
    v_mfma_f32_16x16x32_bf16 v[218:221], v[114:117], v[170:173], v[218:221]
    v_exp_f32 v234, v234
    v_mfma_f32_16x16x32_bf16 v[178:181], v[190:193], v[36:39], 0
    v_exp_f32 v235, v235
    v_cvt_pk_bf16_f32 v208, v182, v183
    v_mfma_f32_16x16x16_f16 v[146:149], v[160:161], v[130:131], v[146:149]
    v_cvt_pk_bf16_f32 v202, v234, v235
    v_exp_f32 v236, v236
    v_xor_b32 v2, 65536, v2
    v_mfma_f32_16x16x32_bf16 v[178:181], v[126:129], v[170:173], v[178:181]
    v_mul_f32 v218, v194, v218
    v_mul_f32 v219, v194, v219
    v_mfma_f32_16x16x32_bf16 v[174:177], v[138:141], v[36:39], 0
    v_cvt_pk_bf16_f32 v218, v218, v219
    v_mul_f32 v220, v194, v220
    v_mfma_f32_16x16x32_bf16 v[174:177], v[150:153], v[170:173], v[174:177]
    v_mul_f32 v221, v194, v221
    v_exp_f32 v237, v237
    v_mfma_f32_16x16x16_f16 v[226:229], v[132:133], v[158:159], v[226:229]
    v_cvt_pk_bf16_f32 v219, v220, v221
    v_mul_f32 v178, v194, v178
    v_mul_f32 v179, v194, v179
    v_cvt_pk_bf16_f32 v220, v178, v179
    v_mfma_f32_16x16x32_bf16 v[158:161], v[122:125], a[216:219], 0
    v_mul_f32 v180, v194, v180
    v_mul_f32 v181, v194, v181
    v_mfma_f32_16x16x32_bf16 v[158:161], v[122:125], a[240:243], v[158:161]
    v_cvt_pk_bf16_f32 v221, v180, v181
    v_mul_f32 v174, v194, v174
    v_mfma_f32_16x16x32_bf16 v[158:161], v[122:125], v[90:93], v[158:161]
    v_mul_f32 v175, v194, v175
    v_cvt_pk_bf16_f32 v182, v174, v175
    v_mfma_f32_16x16x32_bf16 v[178:181], v[122:125], a[220:223], 0
    v_mul_f32 v176, v194, v176
    v_mul_f32 v177, v194, v177
    v_mfma_f32_16x16x32_bf16 v[178:181], v[122:125], a[244:247], v[178:181]
    v_cvt_pk_bf16_f32 v183, v176, v177
    v_cvt_pk_bf16_f32 v203, v236, v237
    v_mfma_f32_16x16x32_bf16 v[178:181], v[122:125], v[94:97], v[178:181]
    v_exp_f32 v146, v146
    v_mfma_f32_16x16x32_bf16 v[194:197], v[122:125], a[232:235], 0
    v_exp_f32 v147, v147
    v_mfma_f32_16x16x32_bf16 v[194:197], v[122:125], v[82:85], v[194:197]
    v_mov_b32 v209, v158
    v_mov_b32_dpp v209, v159 quad_perm:[0,1,2,3] row_mask:0x2 bank_mask:0xf
    v_mfma_f32_16x16x32_bf16 v[194:197], v[122:125], v[106:109], v[194:197]
    v_exp_f32 v148, v148
    v_mfma_f32_16x16x32_bf16 v[234:237], v[122:125], a[224:227], 0
    v_mov_b32 v254, v179
    v_cvt_pk_bf16_f32 v204, v146, v147
    v_mfma_f32_16x16x32_bf16 v[234:237], v[122:125], a[248:251], v[234:237]
    v_exp_f32 v149, v149
    v_mfma_f32_16x16x32_bf16 v[234:237], v[122:125], v[98:101], v[234:237]
    v_exp_f32 v184, v184
    v_mfma_f32_16x16x32_bf16 v[158:161], v[122:125], a[228:231], 0
    v_mov_b32_dpp v209, v194 quad_perm:[0,1,2,3] row_mask:0x4 bank_mask:0xf
    v_mov_b32_dpp v209, v178 quad_perm:[0,1,2,3] row_mask:0x8 bank_mask:0xf
    v_mfma_f32_16x16x32_bf16 v[158:161], v[122:125], a[252:255], v[158:161]
    ds_write_b32 v255, v209 offset:18432
    v_mfma_f32_16x16x32_bf16 v[158:161], v[122:125], v[102:105], v[158:161]
    v_mov_b32_dpp v254, v195 quad_perm:[0,1,2,3] row_mask:0x2 bank_mask:0xf
    v_mov_b32_dpp v254, v234 quad_perm:[0,1,2,3] row_mask:0x4 bank_mask:0xf
    v_mfma_f32_16x16x32_bf16 v[194:197], v[122:125], a[236:239], 0
    v_mov_b32_dpp v254, v235 quad_perm:[0,1,2,3] row_mask:0x8 bank_mask:0xf
    v_cvt_pk_bf16_f32 v205, v148, v149
    v_mfma_f32_16x16x32_bf16 v[194:197], v[122:125], v[86:89], v[194:197]
    ds_write_b32 v255, v254 offset:19456
    v_mfma_f32_16x16x32_bf16 v[194:197], v[122:125], v[110:113], v[194:197]
    v_exp_f32 v185, v185
    v_exp_f32 v226, v226
    v_mfma_f32_16x16x32_f16 v[234:237], v[134:137], v[186:189], v[78:81]
    v_cvt_pk_bf16_f32 v209, v184, v185
    v_exp_f32 v227, v227
    v_exp_f32 v228, v228
    v_cvt_pk_bf16_f32 v36, v226, v227
    v_exp_f32 v229, v229
    v_mov_b32 v254, v194
    v_mfma_f32_16x16x16_f16 v[234:237], v[132:133], v[130:131], v[234:237]
    v_mov_b32_dpp v254, v158 quad_perm:[0,1,2,3] row_mask:0x2 bank_mask:0xf
    v_mov_b32_dpp v254, v159 quad_perm:[0,1,2,3] row_mask:0x4 bank_mask:0xf
    v_mov_b32_dpp v254, v195 quad_perm:[0,1,2,3] row_mask:0x8 bank_mask:0xf
    v_cvt_pk_bf16_f32 v37, v228, v229
    v_exp_f32 v142, v142
    ds_write_b32 v255, v254 offset:63552
    v_cvt_pk_bf16_f32 v39, v142, 0
    s_nop 0
    v_exp_f32 v234, v234
    v_mfma_f32_16x16x32_bf16 v[130:133], v[28:31], v[36:39], 0
    v_exp_f32 v235, v235
    v_mfma_f32_16x16x32_bf16 v[130:133], v[28:31], v[206:209], v[130:133]
    v_exp_f32 v236, v236
    v_mfma_f32_16x16x32_bf16 v[134:137], v[214:217], v[36:39], 0
    v_exp_f32 v237, v237
    v_mfma_f32_16x16x32_bf16 v[134:137], v[114:117], v[206:209], v[134:137]
    ds_read_b128 v[194:197], v9
    ds_read_b128 v[142:145], v9 offset:64
    v_mfma_f32_16x16x32_bf16 v[226:229], v[190:193], v[36:39], 0
    s_waitcnt lgkmcnt(2)
    v_rcp_f32 v130, v130
    v_mfma_f32_16x16x32_bf16 v[226:229], v[126:129], v[206:209], v[226:229]
    s_barrier
    ds_read_b128 v[146:149], v155 offset:18432
    ds_read_b128 v[122:125], v155 offset:19456
    v_mfma_f32_16x16x32_bf16 v[174:177], v[138:141], v[36:39], 0
    ds_read_b128 v[178:181], v155 offset:63552
    v_cvt_pk_bf16_f32 v36, v234, v235
    v_mfma_f32_16x16x32_bf16 v[174:177], v[150:153], v[206:209], v[174:177]
    ds_write_b128 v3, v[218:221] offset:0
    v_cvt_pk_bf16_f32 v37, v236, v237
    v_cvt_pk_bf16_f32 v39, v118, 0
    s_waitcnt lgkmcnt(5)
    v_mfma_f32_16x16x32_bf16 v[218:221], v[194:197], v[28:31], 0
    s_waitcnt lgkmcnt(4)
    v_mul_f32 v134, v130, v134
    v_mul_f32 v135, v130, v135
    v_mfma_f32_16x16x32_bf16 v[218:221], v[142:145], v[28:31], v[218:221]
    ds_write_b64 v4, v[182:183] offset:4096
    v_mfma_f32_16x16x32_bf16 v[154:157], v[194:197], v[114:117], 0
    s_waitcnt lgkmcnt(3)
    v_add_f32 v146, v146, v147
    v_add_f32 v148, v148, v149
    s_waitcnt vmcnt(0)
    v_mfma_f32_16x16x32_bf16 v[154:157], v[142:145], v[214:217], v[154:157]
    s_barrier
    ds_read_b128 v[186:189], v0 offset:20480
    ds_read_b128 v[118:121], v1 offset:20480
    v_mfma_f32_16x16x32_bf16 v[210:213], v[194:197], v[126:129], 0
    s_waitcnt lgkmcnt(3)
    ds_read_b128 v[234:237], v0 offset:20608
    ds_read_b128 v[158:161], v1 offset:20608
    v_mfma_f32_16x16x32_bf16 v[210:213], v[142:145], v[190:193], v[210:213]
    buffer_load_dwordx4 v10, s[8:11], 0 offen nt lds
    ds_read_b128 v[182:185], v0 offset:20736
    v_mfma_f32_16x16x32_bf16 v[198:201], v[194:197], v[150:153], 0
    s_add_u32 m0, s28, 4096
    v_add_f32 v146, v146, v148
    v_mul_f32 v146, 0xbbaaaaab, v146
    v_mfma_f32_16x16x32_bf16 v[198:201], v[142:145], v[138:141], v[198:201]
    ds_read_b128 v[206:209], v1 offset:20736
    v_add_f32 v122, v122, v123
    v_mfma_f32_16x16x32_bf16 v[170:173], v[28:31], v[36:39], 0
    ds_write_b32 v164, v146 offset:0
    v_mfma_f32_16x16x32_bf16 v[170:173], v[28:31], v[202:205], v[170:173]
    s_waitcnt lgkmcnt(6)
    v_add_f32 v124, v124, v125
    v_add_f32 v122, v122, v124
    v_mfma_f32_16x16x32_bf16 v[142:145], v[214:217], v[36:39], 0
    s_waitcnt lgkmcnt(4)
    ds_read_b128 v[146:149], v165 offset:0
    buffer_load_dwordx4 v11, s[8:11], 0 offen nt lds
    v_mfma_f32_16x16x32_bf16 v[142:145], v[114:117], v[202:205], v[142:145]
    s_add_u32 m0, s28, 8192
    ds_read_b128 v[214:217], v165 offset:64
    ds_read_b128 v[114:117], v165 offset:128
    v_mfma_f32_16x16x32_bf16 v[222:225], v[190:193], v[36:39], 0
    s_waitcnt lgkmcnt(5)
    ds_read_b128 v[190:193], v165 offset:192
    v_mul_f32 v122, 0xbbaaaaab, v122
    v_mfma_f32_16x16x32_bf16 v[222:225], v[126:129], v[202:205], v[222:225]
    s_waitcnt lgkmcnt(5)
    ds_write_b32 v164, v122 offset:256
    v_mfma_f32_16x16x32_bf16 v[126:129], v[138:141], v[36:39], 0
    v_add_f32 v178, v178, v179
    v_add_f32 v180, v180, v181
    v_mfma_f32_16x16x32_bf16 v[126:129], v[150:153], v[202:205], v[126:129]
    ds_read_b128 v[150:153], v165 offset:256
    v_add_f32 v178, v178, v180
    v_mfma_f32_16x16x32_bf16 v[194:197], a[72:75], v[186:189], 0
    s_waitcnt lgkmcnt(5)
    buffer_load_dwordx4 v12, s[8:11], 0 offen nt lds
    v_mul_f32 v178, 0xbbaaaaab, v178
    v_cvt_pk_bf16_f32 v134, v134, v135
    v_mfma_f32_16x16x16_bf16 v[122:125], a[216:217], v[162:163], v[146:149]
    v_rcp_f32 v218, v218
    v_mul_f32 v136, v130, v136
    v_mfma_f32_16x16x16_bf16 v[138:141], a[240:241], v[162:163], v[146:149]
    v_mul_f32 v154, v154, v218
    v_mul_f32_dpp v154, v210, v218 quad_perm:[0,1,2,3] row_mask:0x2 bank_mask:0xf
    v_mul_f32_dpp v154, v198, v218 quad_perm:[0,1,2,3] row_mask:0x4 bank_mask:0xf
    v_mfma_f32_16x16x16_bf16 v[218:221], v[90:91], v[162:163], v[146:149]
    v_cvt_pk_bf16_f32 v154, v154, v154
    v_cvt_pk_bf16_f32 v122, v122, v123
    v_accvgpr_write_b32 a216, v122
    v_cvt_pk_bf16_f32 v124, v124, v125
    v_mfma_f32_16x16x32_bf16 v[194:197], a[76:79], v[118:121], v[194:197]
    s_waitcnt lgkmcnt(1)
    ds_write_b32 v164, v178 offset:512
    v_accvgpr_write_b32 a217, v124
    v_mfma_f32_16x16x16_bf16 v[146:149], a[218:219], v[162:163], v[214:217]
    v_cvt_pk_bf16_f32 v138, v138, v139
    v_accvgpr_write_b32 a240, v138
    v_cvt_pk_bf16_f32 v140, v140, v141
    v_mfma_f32_16x16x16_bf16 v[122:125], a[242:243], v[162:163], v[214:217]
    v_accvgpr_write_b32 a241, v140
    v_cvt_pk_bf16_f32 v90, v218, v219
    v_cvt_pk_bf16_f32 v91, v220, v221
    v_mfma_f32_16x16x16_bf16 v[218:221], v[92:93], v[162:163], v[214:217]
    v_cvt_pk_bf16_f32 v146, v146, v147
    v_accvgpr_write_b32 a218, v146
    v_cvt_pk_bf16_f32 v148, v148, v149
    v_mfma_f32_16x16x16_bf16 v[138:141], a[232:233], v[162:163], v[114:117]
    v_accvgpr_write_b32 a219, v148
    v_cvt_pk_bf16_f32 v122, v122, v123
    v_accvgpr_write_b32 a242, v122
    v_mfma_f32_16x16x16_bf16 v[146:149], v[82:83], v[162:163], v[114:117]
    v_cvt_pk_bf16_f32 v124, v124, v125
    v_accvgpr_write_b32 a243, v124
    v_cvt_pk_bf16_f32 v92, v218, v219
    v_mfma_f32_16x16x16_bf16 v[214:217], v[106:107], v[162:163], v[114:117]
    v_cvt_pk_bf16_f32 v93, v220, v221
    v_cvt_pk_bf16_f32 v138, v138, v139
    v_accvgpr_write_b32 a232, v138
    v_mfma_f32_16x16x16_bf16 v[218:221], a[220:221], v[162:163], v[190:193]
    v_cvt_pk_bf16_f32 v140, v140, v141
    v_accvgpr_write_b32 a233, v140
    v_cvt_pk_bf16_f32 v82, v146, v147
    v_mfma_f32_16x16x16_bf16 v[114:117], a[244:245], v[162:163], v[190:193]
    v_cvt_pk_bf16_f32 v83, v148, v149
    v_cvt_pk_bf16_f32 v106, v214, v215
    v_cvt_pk_bf16_f32 v107, v216, v217
    v_mfma_f32_16x16x16_bf16 v[146:149], v[94:95], v[162:163], v[190:193]
    v_cvt_pk_bf16_f32 v218, v218, v219
    v_accvgpr_write_b32 a220, v218
    v_cvt_pk_bf16_f32 v220, v220, v221
    v_accvgpr_write_b32 a221, v220
    v_mfma_f32_16x16x32_bf16 v[194:197], a[80:83], v[234:237], v[194:197]
    s_waitcnt lgkmcnt(0)
    ds_read_b128 v[190:193], v165 offset:320
    ds_read_b128 v[218:221], v165 offset:384
    ds_read_b128 v[138:141], v165 offset:448
    v_mfma_f32_16x16x16_bf16 v[214:217], a[222:223], v[162:163], v[150:153]
    v_cvt_pk_bf16_f32 v114, v114, v115
    v_accvgpr_write_b32 a244, v114
    v_cvt_pk_bf16_f32 v116, v116, v117
    v_mfma_f32_16x16x16_bf16 v[122:125], a[246:247], v[162:163], v[150:153]
    v_accvgpr_write_b32 a245, v116
    v_cvt_pk_bf16_f32 v94, v146, v147
    v_cvt_pk_bf16_f32 v95, v148, v149
    v_mfma_f32_16x16x16_bf16 v[114:117], v[96:97], v[162:163], v[150:153]
    v_cvt_pk_bf16_f32 v214, v214, v215
    v_accvgpr_write_b32 a222, v214
    v_cvt_pk_bf16_f32 v216, v216, v217
    v_accvgpr_write_b32 a223, v216
    v_mfma_f32_16x16x32_bf16 v[194:197], a[84:87], v[158:161], v[194:197]
    s_add_u32 m0, s28, 12288
    ds_read_b128 v[150:153], v165 offset:512
    buffer_load_dwordx4 v13, s[8:11], 0 offen nt lds
    v_mfma_f32_16x16x32_bf16 v[194:197], a[88:91], v[182:185], v[194:197]
    s_mov_b32 m0, s29
    ds_write_b16 v7, v154
    v_mfma_f32_16x16x32_bf16 v[194:197], a[92:95], v[206:209], v[194:197]
    s_waitcnt lgkmcnt(2)
    v_add_u32 v7, 16, v7
    v_cvt_pk_bf16_f32 v122, v122, v123
    v_accvgpr_write_b32 a246, v122
    v_mfma_f32_16x16x16_bf16 v[146:149], a[234:235], v[162:163], v[190:193]
    v_cvt_pk_bf16_f32 v124, v124, v125
    v_accvgpr_write_b32 a247, v124
    v_cvt_pk_bf16_f32 v96, v114, v115
    v_mfma_f32_16x16x16_bf16 v[214:217], v[84:85], v[162:163], v[190:193]
    v_cvt_pk_bf16_f32 v97, v116, v117
    v_rcp_f32 v170, v170
    v_mfma_f32_16x16x16_bf16 v[114:117], v[108:109], v[162:163], v[190:193]
    v_mul_f32 v142, v170, v142
    v_cvt_pk_bf16_f32 v146, v146, v147
    v_accvgpr_write_b32 a234, v146
    v_mfma_f32_16x16x16_bf16 v[122:125], a[224:225], v[162:163], v[218:221]
    v_cvt_pk_bf16_f32 v148, v148, v149
    v_accvgpr_write_b32 a235, v148
    v_cvt_pk_bf16_f32 v84, v214, v215
    v_mfma_f32_16x16x16_bf16 v[190:193], a[248:249], v[162:163], v[218:221]
    v_cvt_pk_bf16_f32 v85, v216, v217
    v_cvt_pk_bf16_f32 v108, v114, v115
    v_cvt_pk_bf16_f32 v109, v116, v117
    v_mfma_f32_16x16x16_bf16 v[114:117], v[98:99], v[162:163], v[218:221]
    v_cvt_pk_bf16_f32 v122, v122, v123
    v_accvgpr_write_b32 a224, v122
    v_cvt_pk_bf16_f32 v124, v124, v125
    v_mfma_f32_16x16x16_bf16 v[214:217], a[226:227], v[162:163], v[138:141]
    v_accvgpr_write_b32 a225, v124
    v_cvt_pk_bf16_f32 v190, v190, v191
    v_accvgpr_write_b32 a248, v190
    v_mfma_f32_16x16x16_bf16 v[218:221], a[250:251], v[162:163], v[138:141]
    v_cvt_pk_bf16_f32 v192, v192, v193
    v_accvgpr_write_b32 a249, v192
    v_cvt_pk_bf16_f32 v98, v114, v115
    v_mfma_f32_16x16x16_bf16 v[190:193], v[100:101], v[162:163], v[138:141]
    v_cvt_pk_bf16_f32 v99, v116, v117
    v_cvt_pk_bf16_f32 v214, v214, v215
    v_accvgpr_write_b32 a226, v214
    v_cvt_pk_bf16_f32 v216, v216, v217
    v_mfma_f32_16x16x32_bf16 v[146:149], a[96:99], v[186:189], 0
    s_waitcnt lgkmcnt(0)
    buffer_load_dwordx4 v14, s[8:11], 0 offen nt lds
    ds_read_b128 v[114:117], v165 offset:576
    ds_read_b128 v[122:125], v165 offset:640
    v_mfma_f32_16x16x16_bf16 v[138:141], a[236:237], v[162:163], v[150:153]
    ds_read_b128 v[154:157], v165 offset:704
    v_accvgpr_write_b32 a227, v216
    v_cvt_pk_bf16_f32 v218, v218, v219
    v_mfma_f32_16x16x16_bf16 v[214:217], v[86:87], v[162:163], v[150:153]
    v_accvgpr_write_b32 a250, v218
    v_cvt_pk_bf16_f32 v220, v220, v221
    v_accvgpr_write_b32 a251, v220
    v_mfma_f32_16x16x16_bf16 v[218:221], v[110:111], v[162:163], v[150:153]
    v_cvt_pk_bf16_f32 v100, v190, v191
    v_cvt_pk_bf16_f32 v101, v192, v193
    v_cvt_pk_bf16_f32 v138, v138, v139
    v_accvgpr_write_b32 a236, v138
    v_mfma_f32_16x16x32_bf16 v[146:149], a[100:103], v[118:121], v[146:149]
    s_xor_b32 s28, s28, 65536
    v_cvt_pk_bf16_f32 v140, v140, v141
    v_accvgpr_write_b32 a237, v140
    v_mfma_f32_16x16x32_bf16 v[146:149], a[104:107], v[234:237], v[146:149]
    s_xor_b32 s29, s29, s30
    v_cvt_pk_bf16_f32 v86, v214, v215
    v_cvt_pk_bf16_f32 v87, v216, v217
    v_mfma_f32_16x16x32_bf16 v[146:149], a[108:111], v[158:161], v[146:149]
    s_waitcnt lgkmcnt(1)
    v_cvt_pk_bf16_f32 v110, v218, v219
    v_cvt_pk_bf16_f32 v111, v220, v221
    v_mul_f32 v143, v170, v143
    v_mfma_f32_16x16x16_bf16 v[150:153], a[228:229], v[162:163], v[114:117]
    v_cvt_pk_bf16_f32 v142, v142, v143
    v_mul_f32 v144, v170, v144
    v_mul_f32 v145, v170, v145
    v_mfma_f32_16x16x16_bf16 v[190:193], a[252:253], v[162:163], v[114:117]
    v_cvt_pk_bf16_f32 v143, v144, v145
    v_mul_f32 v222, v170, v222
    v_mul_f32 v223, v170, v223
    v_mfma_f32_16x16x16_bf16 v[218:221], v[102:103], v[162:163], v[114:117]
    v_cvt_pk_bf16_f32 v150, v150, v151
    v_accvgpr_write_b32 a228, v150
    v_cvt_pk_bf16_f32 v152, v152, v153
    v_mfma_f32_16x16x16_bf16 v[138:141], a[230:231], v[162:163], v[122:125]
    v_accvgpr_write_b32 a229, v152
    v_cvt_pk_bf16_f32 v190, v190, v191
    v_accvgpr_write_b32 a252, v190
    v_mfma_f32_16x16x16_bf16 v[114:117], a[254:255], v[162:163], v[122:125]
    v_cvt_pk_bf16_f32 v192, v192, v193
    v_accvgpr_write_b32 a253, v192
    v_cvt_pk_bf16_f32 v102, v218, v219
    v_mfma_f32_16x16x16_bf16 v[150:153], v[104:105], v[162:163], v[122:125]
    v_cvt_pk_bf16_f32 v103, v220, v221
    v_cvt_pk_bf16_f32 v138, v138, v139
    v_accvgpr_write_b32 a230, v138
    v_cvt_pk_bf16_f32 v140, v140, v141
    v_mfma_f32_16x16x32_bf16 v[146:149], a[112:115], v[182:185], v[146:149]
    s_waitcnt lgkmcnt(0)
    v_accvgpr_write_b32 a231, v140
    v_cvt_pk_bf16_f32 v114, v114, v115
    v_accvgpr_write_b32 a254, v114
    v_mfma_f32_16x16x16_bf16 v[190:193], a[238:239], v[162:163], v[154:157]
    v_cvt_pk_bf16_f32 v116, v116, v117
    v_accvgpr_write_b32 a255, v116
    v_cvt_pk_bf16_f32 v104, v150, v151
    v_mfma_f32_16x16x16_bf16 v[114:117], v[88:89], v[162:163], v[154:157]
    v_cvt_pk_bf16_f32 v105, v152, v153
    v_cvt_pk_bf16_f32 v144, v222, v223
    v_mul_f32 v224, v170, v224
    v_mfma_f32_16x16x16_bf16 v[150:153], v[112:113], v[162:163], v[154:157]
    v_cvt_pk_bf16_f32 v190, v190, v191
    v_accvgpr_write_b32 a238, v190
    v_cvt_pk_bf16_f32 v192, v192, v193
    v_accvgpr_write_b32 a239, v192
    v_mfma_f32_16x16x32_bf16 v[146:149], a[116:119], v[206:209], v[146:149]
    v_cvt_pk_bf16_f32 v88, v114, v115
    v_cvt_pk_bf16_f32 v89, v116, v117
    v_mfma_f32_16x16x32_bf16 v[218:221], a[120:123], v[186:189], 0
    v_cvt_pk_bf16_f32 v112, v150, v151
    v_cvt_pk_bf16_f32 v113, v152, v153
    v_mfma_f32_16x16x32_bf16 v[218:221], a[124:127], v[118:121], v[218:221]
    v_mul_f32 v225, v170, v225
    v_cvt_pk_bf16_f32 v145, v224, v225
    v_mfma_f32_16x16x32_bf16 v[218:221], a[128:131], v[234:237], v[218:221]
    ds_write_b128 v3, v[142:145] offset:12288
    v_mfma_f32_16x16x32_bf16 v[218:221], a[132:135], v[158:161], v[218:221]
    v_mul_f32 v126, v170, v126
    v_mul_f32 v127, v170, v127
    v_mfma_f32_16x16x32_bf16 v[218:221], a[136:139], v[182:185], v[218:221]
    v_cvt_pk_bf16_f32 v254, v126, v127
    v_mul_f32 v128, v170, v128
    v_mfma_f32_16x16x32_bf16 v[218:221], a[140:143], v[206:209], v[218:221]
    v_mul_f32 v129, v170, v129
    v_cvt_pk_bf16_f32 v255, v128, v129
    v_mfma_f32_16x16x32_bf16 v[142:145], a[0:3], v[186:189], 0
    ds_write_b64 v4, v[254:255] offset:16384
    v_mfma_f32_16x16x32_bf16 v[142:145], a[4:7], v[118:121], v[142:145]
    v_mul_f32 v137, v130, v137
    v_cvt_pk_bf16_f32 v135, v136, v137
    v_mfma_f32_16x16x32_bf16 v[142:145], a[8:11], v[234:237], v[142:145]
    v_mul_f32 v226, v130, v226
    v_mul_f32 v227, v130, v227
    v_mfma_f32_16x16x32_bf16 v[142:145], a[12:15], v[158:161], v[142:145]
    v_cvt_pk_bf16_f32 v136, v226, v227
    v_mul_f32 v228, v130, v228
    v_mfma_f32_16x16x32_bf16 v[142:145], a[16:19], v[182:185], v[142:145]
    v_mul_f32 v229, v130, v229
    v_cvt_pk_bf16_f32 v137, v228, v229
    v_mfma_f32_16x16x32_bf16 v[142:145], a[20:23], v[206:209], v[142:145]
    ds_write_b128 v3, v[134:137] offset:6144
    v_mfma_f32_16x16x32_bf16 v[126:129], a[24:27], v[186:189], 0
    v_mul_f32 v174, v130, v174
    v_mul_f32 v175, v130, v175
    v_mfma_f32_16x16x32_bf16 v[126:129], a[28:31], v[118:121], v[126:129]
    v_cvt_pk_bf16_f32 v254, v174, v175
    v_mul_f32 v176, v130, v176
    v_mfma_f32_16x16x32_bf16 v[126:129], a[32:35], v[234:237], v[126:129]
    v_mul_f32 v177, v130, v177
    v_cvt_pk_bf16_f32 v255, v176, v177
    v_mfma_f32_16x16x32_bf16 v[126:129], a[36:39], v[158:161], v[126:129]
    ds_write_b64 v4, v[254:255] offset:10240
    v_mfma_f32_16x16x32_bf16 v[126:129], a[40:43], v[182:185], v[126:129]
    v_cvt_pk_f16_f32 v194, v194, v195
    v_pk_mul_f16 v191, v194, v194
    v_mfma_f32_16x16x32_bf16 v[126:129], a[44:47], v[206:209], v[126:129]
    v_cvt_pk_f16_f32 v195, v196, v197
    v_pk_fma_f16 v191, v195, v195, v191
    v_cvt_pk_f16_f32 v196, v146, v147
    v_pk_fma_f16 v191, v196, v196, v191
    v_cvt_pk_f16_f32 v197, v148, v149
    v_pk_fma_f16 v191, v197, v197, v191
    v_cvt_pk_f16_f32 v148, v218, v219
    v_pk_fma_f16 v191, v148, v148, v191
    v_cvt_pk_f16_f32 v149, v220, v221
    v_pk_fma_f16 v191, v149, v149, v191
    v_xor_b32 v3, 65536, v3
    v_xor_b32 v4, 65536, v4
    s_waitcnt lgkmcnt(0)
    s_barrier
L_go:
    s_waitcnt lgkmcnt(0)
    s_and_b32 s3, s2, 0xf8
    s_add_u32 s64, s42, s3
    s_addc_u32 s65, s43, 0
    s_mov_b32 s67, 0x00020000
    s_cmp_eq_u32 s16, 1
    s_cbranch_scc1 L_loop_fast1
    s_cmp_eq_u32 s16, 2
    s_cbranch_scc1 L_loop_fast2
    s_cmp_eq_u32 s16, 3
    s_cbranch_scc1 L_loop_fast3
    s_branch L_loop_fast0
.p2align 6
L_loop_fast0:
    v_mfma_f32_16x16x32_bf16 v[130:133], a[48:51], v[186:189], 0
    s_add_u32 s12, s40, s27
    ds_read_b128 v[246:249], v2 offset:18432
    v_cvt_pk_f16_f32 v222, v142, v143
    v_mfma_f32_16x16x32_bf16 v[130:133], a[52:55], v[118:121], v[130:133]
    s_addc_u32 s13, s41, 0
    ds_read_b128 v[210:213], v2 offset:19456
    v_pk_mul_f16 v190, v222, v222
    v_mfma_f32_16x16x32_bf16 v[130:133], a[56:59], v[234:237], v[130:133]
    s_sub_u32 s14, s36, s27
    ds_read_b128 v[238:241], v5 offset:32
    v_cvt_pk_f16_f32 v223, v144, v145
    v_mfma_f32_16x16x32_bf16 v[130:133], a[60:63], v[158:161], v[130:133]
    s_cmp_ge_u32 s18, 2
    ds_read2_b64 v[226:229], v5 offset0:6 offset1:9
    v_pk_fma_f16 v190, v223, v223, v190
    v_mfma_f32_16x16x32_bf16 v[130:133], a[64:67], v[182:185], v[130:133]
    s_cselect_b32 s14, s14, 0
    ds_read_b128 v[142:145], v5
    v_cvt_pk_f16_f32 v224, v126, v127
    v_mfma_f32_16x16x32_bf16 v[130:133], a[68:71], v[206:209], v[130:133]
    s_sub_u32 s82, s72, s71
    ds_read_b32 v254, v6 offset:192
    v_pk_fma_f16 v190, v224, v224, v190
    v_mfma_f32_16x16x32_bf16 v[198:201], v[186:189], a[144:147], 0
    s_mul_i32 s74, s82, 336
    v_cvt_pk_f16_f32 v225, v128, v129
    v_pk_fma_f16 v190, v225, v225, v190
    v_mfma_f32_16x16x32_bf16 v[198:201], v[118:121], a[148:151], v[198:201]
    s_mul_i32 s75, s82, 272
    v_cvt_pk_f16_f32 v146, v130, v131
    v_pk_fma_f16 v190, v146, v146, v190
    v_mfma_f32_16x16x32_bf16 v[198:201], v[234:237], a[152:155], v[198:201]
    s_waitcnt lgkmcnt(5)
    v_cvt_pk_f16_f32 v147, v132, v133
    v_pk_fma_f16 v190, v147, v147, v190
    v_mfma_f32_16x16x32_bf16 v[130:133], v[32:35], v[246:249], 0
    s_waitcnt lgkmcnt(4)
    v_add_u32 v5, s74, v5
    s_mul_i32 s76, s82, 16
    v_mfma_f32_16x16x32_bf16 v[130:133], v[32:35], v[210:213], v[130:133]
    s_waitcnt lgkmcnt(3)
    v_pk_mul_f16 v193, v194, v238
    v_pk_fma_f16 v193, v195, v239, v193
    v_mfma_f32_16x16x32_bf16 v[198:201], v[158:161], a[156:159], v[198:201]
    s_add_u32 s34, s18, 2
    v_pk_fma_f16 v193, v196, v240, v193
    v_pk_fma_f16 v193, v197, v241, v193
    v_mfma_f32_16x16x32_bf16 v[198:201], v[182:185], a[160:163], v[198:201]
    s_waitcnt lgkmcnt(1)
    v_pk_fma_f16 v193, v148, v228, v193
    v_pk_fma_f16 v193, v149, v229, v193
    v_mfma_f32_16x16x32_bf16 v[198:201], v[206:209], a[164:167], v[198:201]
    s_waitcnt lgkmcnt(0)
    v_mov_b32_dpp v254, v23 quad_perm:[0,1,2,3] row_mask:0x7 bank_mask:0xf
    v_pk_mul_f16 v192, v222, v142
    v_mfma_f32_16x16x32_bf16 v[210:213], v[186:189], a[168:171], 0
    s_add_u32 s8, s60, s23
    v_pk_fma_f16 v192, v223, v143, v192
    v_pk_fma_f16 v192, v224, v144, v192
    v_mfma_f32_16x16x32_bf16 v[210:213], v[118:121], a[172:175], v[210:213]
    s_addc_u32 s9, s61, 0
    v_pk_fma_f16 v192, v225, v145, v192
    v_pk_fma_f16 v192, v146, v226, v192
    v_mfma_f32_16x16x32_bf16 v[210:213], v[234:237], a[176:179], v[210:213]
    s_sub_u32 s10, s36, s23
    ds_read_b128 v[246:249], v0 offset:26624
    v_pk_fma_f16 v192, v147, v227, v192
    v_mfma_f32_16x16x32_bf16 v[210:213], v[158:161], a[180:183], v[210:213]
    s_cmp_le_u32 s34, s45
    ds_read_b128 v[174:177], v1 offset:26624
    v_cvt_pk_bf16_f32 v126, v198, v199
    v_mfma_f32_16x16x32_f16 v[214:217], v[40:43], v[190:193], 0
    s_cselect_b32 s10, s10, 0
    v_cvt_pk_bf16_f32 v127, v200, v201
    v_mul_f32 v255, 0x3baaaaab, v130
    v_mfma_f32_16x16x32_bf16 v[210:213], v[182:185], a[184:187], v[210:213]
    s_add_u32 m0, s28, 0
    ds_read_b128 v[198:201], v0 offset:26752
    v_mul_f32 v134, 0x3baaaaab, v131
    v_mfma_f32_16x16x32_bf16 v[210:213], v[206:209], a[188:191], v[210:213]
    s_mov_b32 s27, s26
    ds_read_b128 v[242:245], v1 offset:26752
    v_mul_f32 v132, 0x3baaaaab, v132
    v_mfma_f32_16x16x32_bf16 v[190:193], v[186:189], a[192:195], 0
    s_mov_b32 s26, s25
    ds_read_b128 v[186:189], v0 offset:26880
    s_mov_b32 s25, s24
    v_mfma_f32_16x16x32_bf16 v[190:193], v[118:121], a[196:199], v[190:193]
    s_mov_b32 s24, s23
    ds_read_b128 v[118:121], v1 offset:26880
    v_cvt_pk_bf16_f32 v130, v210, v211
    v_mfma_f32_16x16x32_bf16 v[190:193], v[234:237], a[200:203], v[190:193]
    s_ff1_i32_b32 s80, s100
    v_rsq_f32 v214, v214
    v_mfma_f32_16x16x32_bf16 v[190:193], v[158:161], a[204:207], v[190:193]
    s_waitcnt lgkmcnt(5)
    v_rsq_f32 v215, v215
    v_mfma_f32_16x16x32_bf16 v[190:193], v[182:185], a[208:211], v[190:193]
    s_mov_b32 s71, s72
    v_mul_f32 v128, s31, v214
    v_cvt_pk_f16_f32 v129, v128, v215
    v_mfma_f32_16x16x32_bf16 v[190:193], v[206:209], a[212:215], v[190:193]
    s_mov_b32 s72, s73
    v_cvt_pk_bf16_f32 v131, v212, v213
    v_fma_f32 v216, v216, v128, v22
    v_mfma_f32_16x16x32_bf16 v[210:213], a[72:75], v[246:249], 0
    s_waitcnt lgkmcnt(3)
    v_fmac_f32_dpp v254, v217, v215 quad_perm:[0,1,2,3] row_mask:0x1 bank_mask:0xf
    v_pk_mul_f16 v194, v194, v129 op_sel:[0,1] op_sel_hi:[1,1]
    v_mfma_f32_16x16x32_bf16 v[210:213], a[76:79], v[174:177], v[210:213]
    s_waitcnt lgkmcnt(2)
    v_cvt_pk_bf16_f32 v190, v190, v191
    v_cvt_pk_bf16_f32 v191, v192, v193
    v_mfma_f32_16x16x32_bf16 v[210:213], a[80:83], v[198:201], v[210:213]
    s_waitcnt lgkmcnt(1)
    v_pk_mul_f16 v195, v195, v129 op_sel:[0,1] op_sel_hi:[1,1]
    v_pk_mul_f16 v196, v196, v129 op_sel:[0,1] op_sel_hi:[1,1]
    v_mfma_f32_16x16x32_bf16 v[210:213], a[84:87], v[242:245], v[210:213]
    s_waitcnt lgkmcnt(0)
    v_pk_mul_f16 v197, v197, v129 op_sel:[0,1] op_sel_hi:[1,1]
    v_pk_mul_f16 v148, v148, v129 op_sel:[0,1] op_sel_hi:[1,1]
    v_mfma_f32_16x16x32_bf16 v[210:213], a[88:91], v[186:189], v[210:213]
    v_pk_mul_f16 v149, v149, v129 op_sel:[0,1] op_sel_hi:[1,1]
    v_pk_mul_f16 v222, v222, v129 op_sel:[0,0] op_sel_hi:[1,0]
    v_mfma_f32_16x16x32_bf16 v[210:213], a[92:95], v[118:121], v[210:213]
    v_pk_mul_f16 v223, v223, v129 op_sel:[0,0] op_sel_hi:[1,0]
    v_pk_mul_f16 v224, v224, v129 op_sel:[0,0] op_sel_hi:[1,0]
    v_mfma_f32_16x16x32_bf16 v[206:209], a[96:99], v[246:249], 0
    v_pk_mul_f16 v225, v225, v129 op_sel:[0,0] op_sel_hi:[1,0]
    v_pk_mul_f16 v146, v146, v129 op_sel:[0,0] op_sel_hi:[1,0]
    v_mfma_f32_16x16x32_bf16 v[206:209], a[100:103], v[174:177], v[206:209]
    v_pk_mul_f16 v147, v147, v129 op_sel:[0,0] op_sel_hi:[1,0]
    v_max3_u32 v44, v44, v214, v215
    v_mfma_f32_16x16x32_bf16 v[206:209], a[104:107], v[198:201], v[206:209]
    v_rsq_f32 v255, v255
    v_mfma_f32_16x16x32_bf16 v[206:209], a[108:111], v[242:245], v[206:209]
    v_rsq_f32 v134, v134
    v_mfma_f32_16x16x32_bf16 v[206:209], a[112:115], v[186:189], v[206:209]
    v_rsq_f32 v132, v132
    v_mfma_f32_16x16x32_bf16 v[206:209], a[116:119], v[118:121], v[206:209]
    v_mul_f32 v122, v255, v122
    v_mul_f32 v123, v255, v123
    v_mfma_f32_16x16x32_bf16 v[234:237], a[120:123], v[246:249], 0
    v_cvt_pk_bf16_f32 v122, v122, v123
    v_mul_f32 v124, v255, v124
    v_mfma_f32_16x16x32_bf16 v[234:237], a[124:127], v[174:177], v[234:237]
    v_mul_f32 v125, v255, v125
    v_cvt_pk_bf16_f32 v123, v124, v125
    v_mfma_f32_16x16x32_bf16 v[234:237], a[128:131], v[198:201], v[234:237]
    v_mul_f32 v154, v255, v154
    v_mul_f32 v155, v255, v155
    v_mfma_f32_16x16x32_bf16 v[234:237], a[132:135], v[242:245], v[234:237]
    v_cvt_pk_bf16_f32 v124, v154, v155
    v_mul_f32 v156, v255, v156
    v_mfma_f32_16x16x32_bf16 v[234:237], a[136:139], v[186:189], v[234:237]
    v_mul_f32 v157, v255, v157
    v_cvt_pk_bf16_f32 v125, v156, v157
    v_mfma_f32_16x16x32_bf16 v[234:237], a[140:143], v[118:121], v[234:237]
    buffer_store_dwordx4 v[122:125], v15, s[12:15], 0 offen nt
    v_mul_f32 v202, v255, v202
    v_mul_f32 v203, v255, v203
    v_cvt_pk_bf16_f32 v128, v202, v203
    v_mul_f32 v204, v255, v204
    v_mfma_f32_16x16x32_bf16 v[122:125], a[0:3], v[246:249], 0
    v_mul_f32 v205, v255, v205
    v_cvt_pk_bf16_f32 v129, v204, v205
    v_mfma_f32_16x16x32_bf16 v[122:125], a[4:7], v[174:177], v[122:125]
    v_cvt_pk_f16_f32 v202, v210, v211
    v_pk_mul_f16 v211, v202, v202
    v_mfma_f32_16x16x32_bf16 v[122:125], a[8:11], v[198:201], v[122:125]
    v_cvt_pk_f16_f32 v203, v212, v213
    v_pk_fma_f16 v211, v203, v203, v211
    v_mfma_f32_16x16x32_bf16 v[122:125], a[12:15], v[242:245], v[122:125]
    v_cvt_pk_f16_f32 v204, v206, v207
    v_pk_fma_f16 v211, v204, v204, v211
    v_mfma_f32_16x16x32_bf16 v[122:125], a[16:19], v[186:189], v[122:125]
    v_cvt_pk_f16_f32 v205, v208, v209
    v_pk_fma_f16 v211, v205, v205, v211
    v_mfma_f32_16x16x32_bf16 v[122:125], a[20:23], v[118:121], v[122:125]
    v_cvt_pk_f16_f32 v160, v234, v235
    v_pk_fma_f16 v211, v160, v160, v211
    v_mfma_f32_16x16x32_bf16 v[154:157], a[24:27], v[246:249], 0
    v_cvt_pk_f16_f32 v161, v236, v237
    v_pk_fma_f16 v211, v161, v161, v211
    v_mfma_f32_16x16x32_bf16 v[154:157], a[28:31], v[174:177], v[154:157]
    v_pk_mul_f16 v213, v202, v238
    v_pk_fma_f16 v213, v203, v239, v213
    v_mfma_f32_16x16x32_bf16 v[154:157], a[32:35], v[198:201], v[154:157]
    v_cvt_pk_f16_f32 v122, v122, v123
    v_pk_mul_f16 v210, v122, v122
    v_mfma_f32_16x16x32_bf16 v[154:157], a[36:39], v[242:245], v[154:157]
    v_cvt_pk_f16_f32 v123, v124, v125
    v_pk_fma_f16 v210, v123, v123, v210
    v_mfma_f32_16x16x32_bf16 v[154:157], a[40:43], v[186:189], v[154:157]
    v_pk_mul_f16 v212, v122, v142
    v_pk_fma_f16 v212, v123, v143, v212
    v_mfma_f32_16x16x32_bf16 v[154:157], a[44:47], v[118:121], v[154:157]
    v_pk_fma_f16 v213, v204, v240, v213
    v_pk_fma_f16 v213, v205, v241, v213
    v_mfma_f32_16x16x32_bf16 v[206:209], a[48:51], v[246:249], 0
    v_pk_fma_f16 v213, v160, v228, v213
    v_pk_fma_f16 v213, v161, v229, v213
    v_mfma_f32_16x16x32_bf16 v[206:209], a[52:55], v[174:177], v[206:209]
    v_mul_f32 v150, v132, v150
    v_mul_f32 v151, v132, v151
    v_mfma_f32_16x16x32_bf16 v[206:209], a[56:59], v[198:201], v[206:209]
    v_cvt_pk_f16_f32 v124, v154, v155
    v_pk_fma_f16 v210, v124, v124, v210
    v_mfma_f32_16x16x32_bf16 v[206:209], a[60:63], v[242:245], v[206:209]
    v_cvt_pk_f16_f32 v125, v156, v157
    v_pk_fma_f16 v210, v125, v125, v210
    v_mfma_f32_16x16x32_bf16 v[206:209], a[64:67], v[186:189], v[206:209]
    buffer_store_dwordx2 v[128:129], v18, s[12:15], 0 offen nt
    v_pk_fma_f16 v212, v124, v144, v212
    v_pk_fma_f16 v212, v125, v145, v212
    v_mfma_f32_16x16x32_bf16 v[206:209], a[68:71], v[118:121], v[206:209]
    v_cvt_pk_bf16_f32 v150, v150, v151
    v_mul_f32 v152, v132, v152
    v_mfma_f32_16x16x32_bf16 v[154:157], v[246:249], a[144:147], 0
    v_mul_f32 v153, v132, v153
    v_cvt_pk_bf16_f32 v151, v152, v153
    v_mfma_f32_16x16x32_bf16 v[154:157], v[174:177], a[148:151], v[154:157]
    v_mul_f32 v162, v132, v162
    v_mul_f32 v163, v132, v163
    v_mfma_f32_16x16x32_bf16 v[154:157], v[198:201], a[152:155], v[154:157]
    v_cvt_pk_f16_f32 v158, v206, v207
    v_pk_fma_f16 v210, v158, v158, v210
    v_mfma_f32_16x16x32_bf16 v[154:157], v[242:245], a[156:159], v[154:157]
    v_cvt_pk_f16_f32 v159, v208, v209
    v_pk_fma_f16 v210, v159, v159, v210
    v_mfma_f32_16x16x32_bf16 v[154:157], v[186:189], a[160:163], v[154:157]
    v_pk_fma_f16 v212, v158, v226, v212
    v_pk_fma_f16 v212, v159, v227, v212
    v_mfma_f32_16x16x32_bf16 v[154:157], v[118:121], a[164:167], v[154:157]
    v_cvt_pk_bf16_f32 v152, v162, v163
    v_mul_f32 v164, v132, v164
    v_mfma_f32_16x16x32_f16 v[206:209], v[40:43], v[210:213], 0
    v_mul_f32 v165, v132, v165
    v_cvt_pk_bf16_f32 v153, v164, v165
    v_mfma_f32_16x16x32_bf16 v[210:213], v[246:249], a[168:171], 0
    v_mul_f32 v138, v132, v138
    v_mul_f32 v139, v132, v139
    v_mfma_f32_16x16x32_bf16 v[210:213], v[174:177], a[172:175], v[210:213]
    v_cvt_pk_bf16_f32 v128, v154, v155
    v_cvt_pk_bf16_f32 v129, v156, v157
    v_mfma_f32_16x16x32_bf16 v[210:213], v[198:201], a[176:179], v[210:213]
    ds_read_b128 v[154:157], v0 offset:32768
    v_cvt_pk_bf16_f32 v136, v138, v139
    v_mfma_f32_16x16x32_bf16 v[210:213], v[242:245], a[180:183], v[210:213]
    ds_read_b128 v[162:165], v1 offset:32768
    v_mul_f32 v140, v132, v140
    v_mfma_f32_16x16x32_bf16 v[210:213], v[186:189], a[184:187], v[210:213]
    ds_read_b128 v[218:221], v0 offset:32896
    v_mul_f32 v141, v132, v141
    v_mfma_f32_16x16x32_bf16 v[210:213], v[118:121], a[188:191], v[210:213]
    ds_read_b128 v[234:237], v1 offset:32896
    v_cvt_pk_bf16_f32 v137, v140, v141
    v_mfma_f32_16x16x32_bf16 v[182:185], v[246:249], a[192:195], 0
    ds_read_b128 v[138:141], v0 offset:33024
    v_mul_f32 v114, v134, v114
    v_mfma_f32_16x16x32_bf16 v[182:185], v[174:177], a[196:199], v[182:185]
    ds_read_b128 v[246:249], v1 offset:33024
    v_mul_f32 v115, v134, v115
    v_mfma_f32_16x16x32_bf16 v[182:185], v[198:201], a[200:203], v[182:185]
    buffer_store_dwordx4 v[150:153], v17, s[12:15], 0 offen nt
    v_rsq_f32 v206, v206
    v_rsq_f32 v207, v207
    v_mfma_f32_16x16x32_bf16 v[182:185], v[242:245], a[204:207], v[182:185]
    s_waitcnt lgkmcnt(5)
    v_mul_f32 v214, s31, v206
    v_cvt_pk_f16_f32 v215, v214, v207
    v_mfma_f32_16x16x32_bf16 v[182:185], v[186:189], a[208:211], v[182:185]
    s_waitcnt lgkmcnt(4)
    v_fma_f32 v208, v208, v214, v24
    v_fmac_f32_dpp v254, v209, v207 quad_perm:[0,1,2,3] row_mask:0x2 bank_mask:0xf
    v_mfma_f32_16x16x32_bf16 v[182:185], v[118:121], a[212:215], v[182:185]
    s_waitcnt lgkmcnt(3)
    v_cvt_pk_bf16_f32 v132, v210, v211
    v_cvt_pk_bf16_f32 v133, v212, v213
    v_mfma_f32_16x16x32_bf16 v[210:213], a[72:75], v[154:157], 0
    s_waitcnt lgkmcnt(2)
    v_pk_mul_f16 v202, v202, v215 op_sel:[0,1] op_sel_hi:[1,1]
    v_pk_mul_f16 v203, v203, v215 op_sel:[0,1] op_sel_hi:[1,1]
    v_mfma_f32_16x16x32_bf16 v[210:213], a[76:79], v[162:165], v[210:213]
    s_waitcnt lgkmcnt(1)
    v_cvt_pk_bf16_f32 v192, v182, v183
    v_cvt_pk_bf16_f32 v193, v184, v185
    v_mfma_f32_16x16x32_bf16 v[210:213], a[80:83], v[218:221], v[210:213]
    s_waitcnt lgkmcnt(0)
    v_pk_mul_f16 v204, v204, v215 op_sel:[0,1] op_sel_hi:[1,1]
    v_pk_mul_f16 v205, v205, v215 op_sel:[0,1] op_sel_hi:[1,1]
    v_mfma_f32_16x16x32_bf16 v[210:213], a[84:87], v[234:237], v[210:213]
    v_pk_mul_f16 v160, v160, v215 op_sel:[0,1] op_sel_hi:[1,1]
    v_pk_mul_f16 v161, v161, v215 op_sel:[0,1] op_sel_hi:[1,1]
    v_mfma_f32_16x16x32_bf16 v[210:213], a[88:91], v[138:141], v[210:213]
    v_pk_mul_f16 v122, v122, v215 op_sel:[0,0] op_sel_hi:[1,0]
    v_pk_mul_f16 v123, v123, v215 op_sel:[0,0] op_sel_hi:[1,0]
    v_mfma_f32_16x16x32_bf16 v[210:213], a[92:95], v[246:249], v[210:213]
    v_pk_mul_f16 v124, v124, v215 op_sel:[0,0] op_sel_hi:[1,0]
    v_pk_mul_f16 v125, v125, v215 op_sel:[0,0] op_sel_hi:[1,0]
    v_mfma_f32_16x16x32_bf16 v[118:121], a[96:99], v[154:157], 0
    v_pk_mul_f16 v158, v158, v215 op_sel:[0,0] op_sel_hi:[1,0]
    v_pk_mul_f16 v159, v159, v215 op_sel:[0,0] op_sel_hi:[1,0]
    v_mfma_f32_16x16x32_bf16 v[118:121], a[100:103], v[162:165], v[118:121]
    v_max3_u32 v44, v44, v206, v207
    v_cvt_pk_bf16_f32 v114, v114, v115
    v_mfma_f32_16x16x32_bf16 v[118:121], a[104:107], v[218:221], v[118:121]
    v_cvt_pk_f16_f32 v186, v210, v211
    v_pk_mul_f16 v211, v186, v186
    v_mfma_f32_16x16x32_bf16 v[118:121], a[108:111], v[234:237], v[118:121]
    s_waitcnt vmcnt(3)
    ds_write_b16 v8, v45 offset:512
    v_mfma_f32_16x16x32_bf16 v[118:121], a[112:115], v[138:141], v[118:121]
    v_mov_b32 v45, 1
    v_cvt_pk_f16_f32 v187, v212, v213
    v_mfma_f32_16x16x32_bf16 v[118:121], a[116:119], v[246:249], v[118:121]
    v_pk_fma_f16 v211, v187, v187, v211
    v_pk_mul_f16 v213, v186, v238
    v_mfma_f32_16x16x32_bf16 v[150:153], a[120:123], v[154:157], 0
    v_pk_fma_f16 v213, v187, v239, v213
    v_mul_f32 v116, v134, v116
    v_mfma_f32_16x16x32_bf16 v[150:153], a[124:127], v[162:165], v[150:153]
    buffer_store_dwordx2 v[136:137], v20, s[12:15], 0 offen nt
    v_exp_f32 v208, v208
    v_mfma_f32_16x16x32_bf16 v[150:153], a[128:131], v[218:221], v[150:153]
    v_cvt_pk_f16_f32 v188, v118, v119
    v_pk_fma_f16 v211, v188, v188, v211
    v_mfma_f32_16x16x32_bf16 v[150:153], a[132:135], v[234:237], v[150:153]
    v_cvt_pk_f16_f32 v189, v120, v121
    v_pk_fma_f16 v211, v189, v189, v211
    v_mfma_f32_16x16x32_bf16 v[150:153], a[136:139], v[138:141], v[150:153]
    s_waitcnt lgkmcnt(0)
    v_pk_fma_f16 v213, v188, v240, v213
    v_pk_fma_f16 v213, v189, v241, v213
    v_mfma_f32_16x16x32_bf16 v[150:153], a[140:143], v[246:249], v[150:153]
    s_barrier
    v_mul_f32 v117, v134, v117
    v_mfma_f32_16x16x32_bf16 v[238:241], a[0:3], v[154:157], 0
    v_cvt_pk_bf16_f32 v115, v116, v117
    v_mfma_f32_16x16x32_bf16 v[238:241], a[4:7], v[162:165], v[238:241]
    v_mul_f32 v166, v134, v166
    v_mfma_f32_16x16x32_bf16 v[238:241], a[8:11], v[218:221], v[238:241]
    ds_read_u16 v255, v9 offset:512
    v_mfma_f32_16x16x32_bf16 v[238:241], a[12:15], v[234:237], v[238:241]
    v_cvt_pk_f16_f32 v120, v150, v151
    v_pk_fma_f16 v211, v120, v120, v211
    v_mfma_f32_16x16x32_bf16 v[238:241], a[16:19], v[138:141], v[238:241]
    v_cvt_pk_f16_f32 v121, v152, v153
    v_pk_fma_f16 v211, v121, v121, v211
    v_mfma_f32_16x16x32_bf16 v[238:241], a[20:23], v[246:249], v[238:241]
    v_pk_fma_f16 v213, v120, v228, v213
    v_pk_fma_f16 v213, v121, v229, v213
    v_mfma_f32_16x16x32_bf16 v[150:153], a[24:27], v[154:157], 0
    v_exp_f32 v216, v216
    v_mfma_f32_16x16x32_bf16 v[150:153], a[28:31], v[162:165], v[150:153]
    v_cvt_pk_bf16_f32 v39, v216, 0
    v_mul_f32 v167, v134, v167
    v_mfma_f32_16x16x32_bf16 v[150:153], a[32:35], v[218:221], v[150:153]
    v_cvt_pk_f16_f32 v198, v238, v239
    v_pk_mul_f16 v210, v198, v198
    v_mfma_f32_16x16x32_bf16 v[150:153], a[36:39], v[234:237], v[150:153]
    v_cvt_pk_f16_f32 v199, v240, v241
    v_pk_fma_f16 v210, v199, v199, v210
    v_mfma_f32_16x16x32_bf16 v[150:153], a[40:43], v[138:141], v[150:153]
    s_waitcnt lgkmcnt(0)
    v_readfirstlane_b32 s77, v255
    v_pk_mul_f16 v212, v198, v142
    v_mfma_f32_16x16x32_bf16 v[150:153], a[44:47], v[246:249], v[150:153]
    v_pk_fma_f16 v212, v199, v143, v212
    v_cvt_pk_bf16_f32 v116, v166, v167
    v_mfma_f32_16x16x32_bf16 v[238:241], a[48:51], v[154:157], 0
    buffer_load_dwordx4 v10, s[8:11], 0 offen nt lds
    v_mul_f32 v168, v134, v168
    v_mfma_f32_16x16x32_bf16 v[238:241], a[52:55], v[162:165], v[238:241]
    s_add_u32 m0, s28, 4096
    v_mul_f32 v169, v134, v169
    v_cvt_pk_f16_f32 v200, v150, v151
    v_mfma_f32_16x16x32_bf16 v[238:241], a[56:59], v[218:221], v[238:241]
    v_pk_fma_f16 v210, v200, v200, v210
    v_cvt_pk_f16_f32 v201, v152, v153
    v_mfma_f32_16x16x32_bf16 v[238:241], a[60:63], v[234:237], v[238:241]
    ds_read_b128 v[242:245], v2 offset:0
    v_pk_fma_f16 v210, v201, v201, v210
    v_mfma_f32_16x16x32_bf16 v[238:241], a[64:67], v[138:141], v[238:241]
    ds_read_b128 v[174:177], v2 offset:1024
    v_pk_fma_f16 v212, v200, v144, v212
    v_mfma_f32_16x16x32_bf16 v[238:241], a[68:71], v[246:249], v[238:241]
    ds_read_b128 v[170:173], v2 offset:2048
    buffer_load_dwordx4 v11, s[8:11], 0 offen nt lds
    v_mfma_f32_16x16x32_bf16 v[150:153], v[154:157], a[144:147], 0
    s_add_u32 m0, s28, 8192
    ds_read_b128 v[214:217], v2 offset:3072
    v_pk_fma_f16 v212, v201, v145, v212
    v_mfma_f32_16x16x32_bf16 v[150:153], v[162:165], a[148:151], v[150:153]
    ds_read_b128 v[182:185], v2 offset:4096
    v_cvt_pk_f16_f32 v118, v238, v239
    v_mfma_f32_16x16x32_bf16 v[150:153], v[218:221], a[152:155], v[150:153]
    ds_read_b128 v[178:181], v2 offset:5120
    v_pk_fma_f16 v210, v118, v118, v210
    v_mfma_f32_16x16x32_bf16 v[150:153], v[234:237], a[156:159], v[150:153]
    v_cvt_pk_f16_f32 v119, v240, v241
    v_pk_fma_f16 v210, v119, v119, v210
    v_mfma_f32_16x16x32_bf16 v[150:153], v[138:141], a[160:163], v[150:153]
    buffer_load_dwordx4 v12, s[8:11], 0 offen nt lds
    v_pk_fma_f16 v212, v118, v226, v212
    v_mfma_f32_16x16x32_bf16 v[150:153], v[246:249], a[164:167], v[150:153]
    s_waitcnt lgkmcnt(5)
    v_pk_fma_f16 v212, v119, v227, v212
    v_cvt_pk_bf16_f32 v117, v168, v169
    v_mfma_f32_16x16x32_bf16 v[226:229], v[154:157], a[168:171], 0
    s_add_u32 m0, s28, 12288
    v_mul_f32 v230, v134, v230
    v_mul_f32 v231, v134, v231
    v_mfma_f32_16x16x32_f16 v[166:169], v[40:43], v[210:213], 0
    s_xor_b32 s28, s28, 65536
    v_cvt_pk_bf16_f32 v142, v150, v151
    v_cvt_pk_bf16_f32 v143, v152, v153
    v_mfma_f32_16x16x32_bf16 v[226:229], v[162:165], a[172:175], v[226:229]
    s_waitcnt lgkmcnt(2)
    ds_read2_b32 v[144:145], v6 offset0:0 offset1:0
    v_cvt_pk_bf16_f32 v230, v230, v231
    v_mfma_f32_16x16x32_bf16 v[226:229], v[218:221], a[176:179], v[226:229]
    s_waitcnt lgkmcnt(2)
    buffer_load_dwordx4 v13, s[8:11], 0 offen nt lds
    ds_read2_b32 v[212:213], v6 offset0:16 offset1:16
    v_mfma_f32_16x16x32_bf16 v[226:229], v[234:237], a[180:183], v[226:229]
    s_mov_b32 m0, s29
    ds_read2_b32 v[240:241], v6 offset0:32 offset1:32
    v_mul_f32 v232, v134, v232
    v_mfma_f32_16x16x32_bf16 v[226:229], v[138:141], a[184:187], v[226:229]
    s_xor_b32 s29, s29, s30
    v_rsq_f32 v166, v166
    v_mfma_f32_16x16x32_bf16 v[226:229], v[246:249], a[188:191], v[226:229]
    s_add_u32 s19, s19, s20
    v_rsq_f32 v167, v167
    v_mfma_f32_16x16x32_bf16 v[150:153], v[154:157], a[192:195], 0
    s_add_u32 s23, s23, s21
    v_mul_f32 v136, s31, v166
    v_cvt_pk_f16_f32 v137, v136, v167
    v_mfma_f32_16x16x32_bf16 v[150:153], v[162:165], a[196:199], v[150:153]
    s_waitcnt lgkmcnt(3)
    buffer_load_dwordx4 v14, s[8:11], 0 offen nt lds
    v_fma_f32 v168, v168, v136, v26
    v_mfma_f32_16x16x32_bf16 v[150:153], v[218:221], a[200:203], v[150:153]
    s_cmp_ge_u32 s19, 72
    v_fmac_f32_dpp v254, v169, v167 quad_perm:[0,1,2,3] row_mask:0x4 bank_mask:0xf
    v_cvt_pk_bf16_f32 v210, v226, v227
    v_mfma_f32_16x16x32_bf16 v[150:153], v[234:237], a[204:207], v[150:153]
    s_cselect_b32 s34, 72, 0
    v_cvt_pk_bf16_f32 v211, v228, v229
    v_pk_mul_f16 v186, v186, v137 op_sel:[0,1] op_sel_hi:[1,1]
    v_mfma_f32_16x16x32_bf16 v[150:153], v[138:141], a[208:211], v[150:153]
    s_cselect_b32 s35, s22, 0
    v_pk_mul_f16 v187, v187, v137 op_sel:[0,1] op_sel_hi:[1,1]
    v_pk_mul_f16 v188, v188, v137 op_sel:[0,1] op_sel_hi:[1,1]
    v_mfma_f32_16x16x32_bf16 v[150:153], v[246:249], a[212:215], v[150:153]
    s_sub_u32 s19, s19, s34
    v_pk_mul_f16 v189, v189, v137 op_sel:[0,1] op_sel_hi:[1,1]
    v_pk_mul_f16 v120, v120, v137 op_sel:[0,1] op_sel_hi:[1,1]
    v_mfma_f32_16x16x32_f16 v[154:157], v[194:197], v[222:225], v[46:49]
    s_waitcnt lgkmcnt(0)
    buffer_store_dwordx4 v[114:117], v16, s[12:15], 0 offen nt
    v_pk_mul_f16 v121, v121, v137 op_sel:[0,1] op_sel_hi:[1,1]
    v_pk_mul_f16 v198, v198, v137 op_sel:[0,0] op_sel_hi:[1,0]
    v_cvt_pk_bf16_f32 v238, v150, v151
    v_cvt_pk_bf16_f32 v239, v152, v153
    v_mfma_f32_16x16x32_f16 v[114:117], v[202:205], v[222:225], v[50:53]
    s_add_u32 s23, s23, s35
    v_pk_mul_f16 v199, v199, v137 op_sel:[0,0] op_sel_hi:[1,0]
    v_pk_mul_f16 v200, v200, v137 op_sel:[0,0] op_sel_hi:[1,0]
    v_mfma_f32_16x16x32_f16 v[246:249], v[186:189], v[222:225], v[54:57]
    s_cmp_lg_u32 s83, 0
    v_pk_mul_f16 v201, v201, v137 op_sel:[0,0] op_sel_hi:[1,0]
    v_pk_mul_f16 v118, v118, v137 op_sel:[0,0] op_sel_hi:[1,0]
    v_pk_mul_f16 v119, v119, v137 op_sel:[0,0] op_sel_hi:[1,0]
    v_mfma_f32_16x16x16_f16 v[154:157], v[148:149], v[146:147], v[154:157]
    v_max3_u32 v44, v44, v166, v167
    v_exp_f32 v254, v254
    v_mfma_f32_16x16x16_f16 v[114:117], v[160:161], v[146:147], v[114:117]
    v_cvt_pk_bf16_f32 v254, v254, v254
    v_exp_f32 v168, v168
    v_mfma_f32_16x16x16_f16 v[246:249], v[120:121], v[146:147], v[246:249]
    v_mul_f32 v233, v134, v233
    v_cvt_pk_bf16_f32 v231, v232, v233
    v_exp_f32 v154, v154
    v_mfma_f32_16x16x32_f16 v[162:165], v[194:197], v[122:125], v[58:61]
    s_cselect_b32 s77, s80, s77
    ds_write_b16 v8, v254
    v_mfma_f32_16x16x32_f16 v[138:141], v[202:205], v[122:125], v[62:65]
    s_mul_i32 s78, s77, 2688
    v_exp_f32 v155, v155
    v_mfma_f32_16x16x32_f16 v[234:237], v[186:189], v[122:125], v[66:69]
    s_add_u32 s78, s78, s69
    v_cvt_pk_bf16_f32 v218, v154, v155
    v_exp_f32 v156, v156
    v_mfma_f32_16x16x16_f16 v[162:165], v[148:149], v[158:159], v[162:165]
    v_exp_f32 v157, v157
    v_xor_b32 v0, 65536, v0
    v_mfma_f32_16x16x16_f16 v[138:141], v[160:161], v[158:159], v[138:141]
    v_cvt_pk_bf16_f32 v219, v156, v157
    v_exp_f32 v114, v114
    v_mfma_f32_16x16x16_f16 v[234:237], v[120:121], v[158:159], v[234:237]
    v_exp_f32 v115, v115
    v_exp_f32 v116, v116
    v_mfma_f32_16x16x32_bf16 v[122:125], a[216:219], v[242:245], 0
    s_add_u32 s80, s77, s68
    v_exp_f32 v162, v162
    v_mfma_f32_16x16x32_bf16 v[122:125], a[220:223], v[174:177], v[122:125]
    s_cmp_ge_u32 s80, 72
    v_exp_f32 v163, v163
    v_mfma_f32_16x16x32_f16 v[222:225], v[194:197], v[198:201], v[70:73]
    s_cselect_b32 s80, s22, 0
    v_cvt_pk_bf16_f32 v158, v162, v163
    v_cvt_pk_bf16_f32 v220, v114, v115
    v_mfma_f32_16x16x32_f16 v[134:137], v[202:205], v[198:201], v[74:77]
    s_add_u32 s78, s78, s80
    v_exp_f32 v164, v164
    v_mfma_f32_16x16x32_f16 v[194:197], v[186:189], v[198:201], v[78:81]
    buffer_store_dwordx2 v[230:231], v19, s[12:15], 0 offen nt
    v_exp_f32 v165, v165
    v_mfma_f32_16x16x16_f16 v[222:225], v[148:149], v[118:119], v[222:225]
    v_cvt_pk_bf16_f32 v159, v164, v165
    v_exp_f32 v138, v138
    v_mfma_f32_16x16x16_f16 v[134:137], v[160:161], v[118:119], v[134:137]
    v_exp_f32 v139, v139
    v_xor_b32 v1, 65536, v1
    v_mfma_f32_16x16x16_f16 v[194:197], v[120:121], v[118:119], v[194:197]
    v_cvt_pk_bf16_f32 v160, v138, v139
    v_exp_f32 v140, v140
    v_add_u32 v6, s75, v6
    v_mfma_f32_16x16x32_bf16 v[122:125], a[224:227], v[170:173], v[122:125]
    s_add_u32 s80, s77, 20
    v_exp_f32 v141, v141
    v_mfma_f32_16x16x32_bf16 v[122:125], a[228:231], v[214:217], v[122:125]
    s_add_u32 s34, s18, 3
    v_exp_f32 v234, v234
    v_mfma_f32_16x16x32_bf16 v[122:125], a[232:235], v[182:185], v[122:125]
    s_cmp_lt_u32 s77, s62
    v_exp_f32 v235, v235
    v_mfma_f32_16x16x32_bf16 v[122:125], a[236:239], v[178:181], v[122:125]
    s_cselect_b32 s79, 1, 0
    v_exp_f32 v236, v236
    v_mfma_f32_16x16x32_bf16 v[154:157], a[240:243], v[242:245], 0
    s_cselect_b32 s78, s78, 0
    ds_read_b128 v[150:153], v2 offset:6144
    v_cvt_pk_bf16_f32 v161, v140, v141
    v_mfma_f32_16x16x32_bf16 v[154:157], a[244:247], v[174:177], v[154:157]
    s_cmp_lt_u32 s34, s17
    ds_read_b128 v[162:165], v2 offset:7168
    v_fma_f32 v255, v122, v122, s33
    v_mfma_f32_16x16x32_bf16 v[154:157], a[248:251], v[170:173], v[154:157]
    s_cselect_b32 s23, s23, s78
    ds_read_b128 v[186:189], v2 offset:8192
    v_fmac_f32 v255, v123, v123
    v_mfma_f32_16x16x32_bf16 v[154:157], a[252:255], v[214:217], v[154:157]
    s_cselect_b32 s73, s34, s80
    ds_read_b128 v[138:141], v2 offset:9216
    v_fmac_f32 v255, v124, v124
    v_mfma_f32_16x16x32_bf16 v[154:157], v[82:85], v[182:185], v[154:157]
    s_cselect_b32 s79, 0, s79
    ds_read_b128 v[118:121], v2 offset:10240
    v_fmac_f32 v255, v125, v125
    v_mfma_f32_16x16x32_bf16 v[154:157], v[86:89], v[178:181], v[154:157]
    s_cselect_b32 s81, 0, 1
    ds_read_b128 v[198:201], v2 offset:11264
    s_add_u32 s80, s77, 1
    v_mfma_f32_16x16x32_bf16 v[202:205], v[90:93], v[242:245], 0
    s_mul_i32 s80, s80, s81
    v_exp_f32 v237, v237
    v_mfma_f32_16x16x32_bf16 v[202:205], v[94:97], v[174:177], v[202:205]
    s_cmp_lt_u32 s80, s62
    v_exp_f32 v117, v117
    v_mfma_f32_16x16x32_bf16 v[202:205], v[98:101], v[170:173], v[202:205]
    s_waitcnt lgkmcnt(5)
    v_cvt_pk_bf16_f32 v221, v116, v117
    v_fmac_f32 v255, v154, v154
    v_mfma_f32_16x16x32_bf16 v[202:205], v[102:105], v[214:217], v[202:205]
    s_cselect_b32 s70, s70, 0
    v_exp_f32 v246, v246
    v_mfma_f32_16x16x32_bf16 v[202:205], v[106:109], v[182:185], v[202:205]
    s_cselect_b32 s62, s62, 0
    v_exp_f32 v247, v247
    v_mfma_f32_16x16x32_bf16 v[202:205], v[110:113], v[178:181], v[202:205]
    s_add_u32 s80, s18, 4
    v_cvt_pk_bf16_f32 v36, v246, v247
    v_fmac_f32 v255, v155, v155
    v_mfma_f32_16x16x32_bf16 v[114:117], a[216:219], v[150:153], 0
    s_waitcnt lgkmcnt(1)
    v_exp_f32 v248, v248
    v_mfma_f32_16x16x32_bf16 v[114:117], a[220:223], v[162:165], v[114:117]
    s_cmp_ge_u32 s80, s17
    v_exp_f32 v249, v249
    v_mfma_f32_16x16x32_bf16 v[114:117], a[224:227], v[186:189], v[114:117]
    s_cselect_b32 s66, s70, 0
    v_cvt_pk_bf16_f32 v37, v248, v249
    v_fmac_f32 v255, v156, v156
    v_mfma_f32_16x16x32_bf16 v[114:117], a[228:231], v[138:141], v[114:117]
    s_waitcnt lgkmcnt(0)
    buffer_atomic_add v45, v10, s[64:67], 0 offen sc0 sc1
    v_fmac_f32 v255, v157, v157
    v_mfma_f32_16x16x32_bf16 v[178:181], v[28:31], v[36:39], 0
    s_lshl_b32 s80, s79, s73
    v_exp_f32 v222, v222
    v_mfma_f32_16x16x32_bf16 v[178:181], v[28:31], v[218:221], v[178:181]
    s_or_b32 s63, s63, s80
    v_exp_f32 v223, v223
    v_mfma_f32_16x16x32_bf16 v[146:149], v[142:145], v[36:39], 0
    s_sub_u32 s80, s100, s81
    v_cvt_pk_bf16_f32 v226, v222, v223
    v_fmac_f32 v255, v202, v202
    v_mfma_f32_16x16x32_bf16 v[146:149], v[126:129], v[218:221], v[146:149]
    s_and_b32 s100, s100, s80
    v_exp_f32 v224, v224
    v_mfma_f32_16x16x32_bf16 v[246:249], v[210:213], v[36:39], 0
    s_add_u32 s45, s45, s79
    v_exp_f32 v225, v225
    v_mfma_f32_16x16x32_bf16 v[246:249], v[130:133], v[218:221], v[246:249]
    s_add_u32 s18, s18, 1
    v_cvt_pk_bf16_f32 v227, v224, v225
    v_fmac_f32 v255, v203, v203
    v_mfma_f32_16x16x32_bf16 v[222:225], v[238:241], v[36:39], 0
    s_cmp_lt_u32 s18, s45
    v_cvt_pk_bf16_f32 v36, v234, v235
    v_cvt_pk_bf16_f32 v37, v236, v237
    v_mfma_f32_16x16x32_bf16 v[222:225], v[190:193], v[218:221], v[222:225]
    v_cvt_pk_bf16_f32 v39, v208, 0
    v_fmac_f32 v255, v204, v204
    v_mfma_f32_16x16x32_bf16 v[114:117], a[232:235], v[118:121], v[114:117]
    v_exp_f32 v134, v134
    v_mfma_f32_16x16x32_bf16 v[182:185], v[28:31], v[36:39], 0
    v_exp_f32 v135, v135
    v_mfma_f32_16x16x32_bf16 v[182:185], v[28:31], v[158:161], v[182:185]
    v_cvt_pk_bf16_f32 v228, v134, v135
    v_fmac_f32 v255, v205, v205
    v_mfma_f32_16x16x32_bf16 v[230:233], v[142:145], v[36:39], 0
    v_exp_f32 v136, v136
    v_mfma_f32_16x16x32_bf16 v[230:233], v[126:129], v[158:161], v[230:233]
    v_exp_f32 v137, v137
    v_mfma_f32_16x16x32_bf16 v[170:173], v[210:213], v[36:39], 0
    v_exp_f32 v194, v194
    v_mfma_f32_16x16x32_bf16 v[170:173], v[130:133], v[158:161], v[170:173]
    v_rcp_f32 v182, v182
    v_mfma_f32_16x16x32_bf16 v[174:177], v[238:241], v[36:39], 0
    v_cvt_pk_bf16_f32 v229, v136, v137
    v_cvt_pk_bf16_f32 v39, v168, 0
    v_mfma_f32_16x16x32_bf16 v[174:177], v[190:193], v[158:161], v[174:177]
    v_mul_f32 v230, v182, v230
    v_mul_f32 v231, v182, v231
    v_mfma_f32_16x16x32_bf16 v[114:117], a[236:239], v[198:201], v[114:117]
    v_cvt_pk_bf16_f32 v134, v230, v231
    v_mul_f32 v232, v182, v232
    v_mfma_f32_16x16x32_bf16 v[166:169], a[240:243], v[150:153], 0
    ds_read_b128 v[214:217], v2 offset:12288
    v_mul_f32 v233, v182, v233
    v_mfma_f32_16x16x32_bf16 v[166:169], a[244:247], v[162:165], v[166:169]
    ds_read_b128 v[234:237], v2 offset:13312
    v_cvt_pk_bf16_f32 v135, v232, v233
    v_mfma_f32_16x16x32_bf16 v[166:169], a[248:251], v[186:189], v[166:169]
    ds_read_b128 v[218:221], v2 offset:14336
    v_fma_f32 v254, v114, v114, s33
    v_mfma_f32_16x16x32_bf16 v[166:169], a[252:255], v[138:141], v[166:169]
    ds_read_b128 v[158:161], v2 offset:15360
    v_fmac_f32 v254, v115, v115
    v_mfma_f32_16x16x32_bf16 v[166:169], v[82:85], v[118:121], v[166:169]
    ds_read_b128 v[206:209], v2 offset:16384
    v_fmac_f32 v254, v116, v116
    v_mfma_f32_16x16x32_bf16 v[166:169], v[86:89], v[198:201], v[166:169]
    ds_read_b128 v[242:245], v2 offset:17408
    v_fmac_f32 v254, v117, v117
    v_mfma_f32_16x16x32_bf16 v[230:233], v[90:93], v[150:153], 0
    v_mul_f32 v170, v182, v170
    v_mul_f32 v171, v182, v171
    v_mfma_f32_16x16x32_bf16 v[230:233], v[94:97], v[162:165], v[230:233]
    v_cvt_pk_bf16_f32 v136, v170, v171
    v_mul_f32 v172, v182, v172
    v_mfma_f32_16x16x32_bf16 v[230:233], v[98:101], v[186:189], v[230:233]
    s_waitcnt lgkmcnt(5)
    v_fmac_f32 v254, v166, v166
    v_fmac_f32 v254, v167, v167
    v_mfma_f32_16x16x32_bf16 v[230:233], v[102:105], v[138:141], v[230:233]
    s_waitcnt lgkmcnt(4)
    v_fmac_f32 v254, v168, v168
    v_fmac_f32 v254, v169, v169
    v_mfma_f32_16x16x32_bf16 v[230:233], v[106:109], v[118:121], v[230:233]
    s_waitcnt lgkmcnt(3)
    v_mul_f32 v173, v182, v173
    v_cvt_pk_bf16_f32 v137, v172, v173
    v_mfma_f32_16x16x32_bf16 v[230:233], v[110:113], v[198:201], v[230:233]
    s_waitcnt lgkmcnt(2)
    ds_write_b128 v3, v[134:137] offset:6144
    v_mfma_f32_16x16x32_bf16 v[150:153], a[216:219], v[214:217], 0
    s_waitcnt lgkmcnt(1)
    v_mul_f32 v174, v182, v174
    v_mul_f32 v175, v182, v175
    v_mfma_f32_16x16x32_bf16 v[150:153], a[220:223], v[234:237], v[150:153]
    v_cvt_pk_bf16_f32 v174, v174, v175
    v_fmac_f32 v254, v230, v230
    v_mfma_f32_16x16x32_bf16 v[150:153], a[224:227], v[218:221], v[150:153]
    v_fmac_f32 v254, v231, v231
    v_fmac_f32 v254, v232, v232
    v_mfma_f32_16x16x32_bf16 v[150:153], a[228:231], v[158:161], v[150:153]
    v_fmac_f32 v254, v233, v233
    v_cvt_pk_bf16_f32 v254, v255, v254
    v_mfma_f32_16x16x32_bf16 v[150:153], a[232:235], v[206:209], v[150:153]
    v_mul_f32 v176, v182, v176
    v_mul_f32 v177, v182, v177
    v_mfma_f32_16x16x32_bf16 v[150:153], a[236:239], v[242:245], v[150:153]
    v_cvt_pk_bf16_f32 v175, v176, v177
    v_xor_b32 v2, 65536, v2
    v_mfma_f32_16x16x32_bf16 v[162:165], a[240:243], v[214:217], 0
    ds_write_b64 v4, v[174:175] offset:10240
    v_mfma_f32_16x16x32_bf16 v[162:165], a[244:247], v[234:237], v[162:165]
    v_exp_f32 v195, v195
    v_mfma_f32_16x16x32_bf16 v[162:165], a[248:251], v[218:221], v[162:165]
    v_exp_f32 v196, v196
    v_mfma_f32_16x16x32_bf16 v[162:165], a[252:255], v[158:161], v[162:165]
    v_fma_f32 v255, v150, v150, s33
    v_fmac_f32 v255, v151, v151
    v_mfma_f32_16x16x32_bf16 v[162:165], v[82:85], v[206:209], v[162:165]
    v_fmac_f32 v255, v152, v152
    v_fmac_f32 v255, v153, v153
    v_mfma_f32_16x16x32_bf16 v[162:165], v[86:89], v[242:245], v[162:165]
    v_exp_f32 v197, v197
    v_mfma_f32_16x16x32_bf16 v[138:141], v[90:93], v[214:217], 0
    ds_read_b128 v[186:189], v0 offset:20480
    v_cvt_pk_bf16_f32 v36, v194, v195
    v_mfma_f32_16x16x32_bf16 v[138:141], v[94:97], v[234:237], v[138:141]
    ds_read_b128 v[118:121], v1 offset:20480
    v_cvt_pk_bf16_f32 v37, v196, v197
    v_mfma_f32_16x16x32_bf16 v[138:141], v[98:101], v[218:221], v[138:141]
    ds_read_b128 v[234:237], v0 offset:20608
    v_fmac_f32 v255, v162, v162
    v_mfma_f32_16x16x32_bf16 v[198:201], v[28:31], v[36:39], 0
    ds_read_b128 v[214:217], v9
    v_fmac_f32 v255, v163, v163
    v_mfma_f32_16x16x32_bf16 v[198:201], v[28:31], v[226:229], v[198:201]
    ds_read_b128 v[194:197], v9 offset:64
    v_fmac_f32 v255, v164, v164
    v_mfma_f32_16x16x32_bf16 v[170:173], v[142:145], v[36:39], 0
    v_rcp_f32 v178, v178
    v_mfma_f32_16x16x32_bf16 v[170:173], v[126:129], v[226:229], v[170:173]
    v_fmac_f32 v255, v165, v165
    v_mul_f32 v146, v178, v146
    v_mfma_f32_16x16x32_bf16 v[218:221], v[210:213], v[36:39], 0
    v_rcp_f32 v198, v198
    v_mfma_f32_16x16x32_bf16 v[218:221], v[130:133], v[226:229], v[218:221]
    s_waitcnt lgkmcnt(4)
    v_mul_f32 v147, v178, v147
    v_cvt_pk_bf16_f32 v146, v146, v147
    v_mfma_f32_16x16x32_bf16 v[174:177], v[238:241], v[36:39], 0
    s_waitcnt lgkmcnt(3)
    v_mul_f32 v170, v198, v170
    v_mul_f32 v171, v198, v171
    v_mfma_f32_16x16x32_bf16 v[174:177], v[190:193], v[226:229], v[174:177]
    s_waitcnt lgkmcnt(2)
    v_cvt_pk_bf16_f32 v226, v170, v171
    v_mul_f32 v172, v198, v172
    v_mfma_f32_16x16x32_bf16 v[138:141], v[102:105], v[158:161], v[138:141]
    s_waitcnt lgkmcnt(1)
    ds_read_b128 v[158:161], v1 offset:20608
    v_mul_f32 v173, v198, v173
    v_mfma_f32_16x16x32_bf16 v[138:141], v[106:109], v[206:209], v[138:141]
    s_waitcnt lgkmcnt(1)
    ds_read_b128 v[182:185], v0 offset:20736
    v_cvt_pk_bf16_f32 v227, v172, v173
    v_mfma_f32_16x16x32_bf16 v[138:141], v[110:113], v[242:245], v[138:141]
    ds_read_b128 v[206:209], v1 offset:20736
    v_mul_f32 v218, v198, v218
    v_mfma_f32_16x16x32_bf16 v[242:245], v[214:217], v[28:31], 0
    v_mul_f32 v219, v198, v219
    v_cvt_pk_bf16_f32 v228, v218, v219
    v_mfma_f32_16x16x32_bf16 v[242:245], v[194:197], v[28:31], v[242:245]
    v_mul_f32 v220, v198, v220
    v_mul_f32 v221, v198, v221
    v_mfma_f32_16x16x32_bf16 v[170:173], v[214:217], v[126:129], 0
    v_fmac_f32 v255, v138, v138
    v_fmac_f32 v255, v139, v139
    v_mfma_f32_16x16x32_bf16 v[170:173], v[194:197], v[142:145], v[170:173]
    v_fmac_f32 v255, v140, v140
    v_fmac_f32 v255, v141, v141
    v_mfma_f32_16x16x32_bf16 v[126:129], v[214:217], v[130:133], 0
    v_cvt_pk_bf16_f32 v255, v255, v255
    v_cvt_pk_bf16_f32 v229, v220, v221
    v_mfma_f32_16x16x32_bf16 v[126:129], v[194:197], v[210:213], v[126:129]
    s_waitcnt lgkmcnt(2)
    ds_write_b128 v3, v[226:229] offset:12288
    v_mfma_f32_16x16x32_bf16 v[130:133], v[214:217], v[190:193], 0
    s_waitcnt lgkmcnt(1)
    v_rcp_f32 v242, v242
    v_mfma_f32_16x16x32_bf16 v[130:133], v[194:197], v[238:241], v[130:133]
    v_mul_f32 v170, v170, v242
    v_mul_f32 v174, v198, v174
    v_mfma_f32_16x16x32_bf16 v[190:193], a[72:75], v[186:189], 0
    ds_write_b64 v4, v[254:255] offset:18432
    v_mfma_f32_16x16x32_bf16 v[190:193], a[76:79], v[118:121], v[190:193]
    v_mul_f32_dpp v170, v126, v242 quad_perm:[0,1,2,3] row_mask:0x2 bank_mask:0xf
    v_mul_f32 v175, v198, v175
    v_mfma_f32_16x16x32_bf16 v[190:193], a[80:83], v[234:237], v[190:193]
    v_mul_f32_dpp v170, v130, v242 quad_perm:[0,1,2,3] row_mask:0x4 bank_mask:0xf
    v_cvt_pk_bf16_f32 v170, v170, v170
    v_mfma_f32_16x16x32_bf16 v[190:193], a[84:87], v[158:161], v[190:193]
    ds_write_b16 v7, v170
    v_mfma_f32_16x16x32_bf16 v[190:193], a[88:91], v[182:185], v[190:193]
    v_cvt_pk_bf16_f32 v254, v174, v175
    v_mul_f32 v176, v198, v176
    v_mfma_f32_16x16x32_bf16 v[190:193], a[92:95], v[206:209], v[190:193]
    v_mul_f32 v177, v198, v177
    v_cvt_pk_bf16_f32 v255, v176, v177
    v_mfma_f32_16x16x32_bf16 v[130:133], a[96:99], v[186:189], 0
    ds_write_b64 v4, v[254:255] offset:16384
    v_mfma_f32_16x16x32_bf16 v[130:133], a[100:103], v[118:121], v[130:133]
    v_mul_f32 v148, v178, v148
    v_mul_f32 v149, v178, v149
    v_mfma_f32_16x16x32_bf16 v[130:133], a[104:107], v[234:237], v[130:133]
    v_cvt_pk_bf16_f32 v147, v148, v149
    v_mul_f32 v246, v178, v246
    v_mfma_f32_16x16x32_bf16 v[130:133], a[108:111], v[158:161], v[130:133]
    v_mul_f32 v247, v178, v247
    v_cvt_pk_bf16_f32 v148, v246, v247
    v_mfma_f32_16x16x32_bf16 v[130:133], a[112:115], v[182:185], v[130:133]
    v_mul_f32 v248, v178, v248
    v_mul_f32 v249, v178, v249
    v_mfma_f32_16x16x32_bf16 v[130:133], a[116:119], v[206:209], v[130:133]
    v_cvt_pk_bf16_f32 v149, v248, v249
    v_mul_f32 v222, v178, v222
    v_mfma_f32_16x16x32_bf16 v[126:129], a[120:123], v[186:189], 0
    ds_write_b128 v3, v[146:149] offset:0
    v_mfma_f32_16x16x32_bf16 v[126:129], a[124:127], v[118:121], v[126:129]
    v_mul_f32 v223, v178, v223
    v_cvt_pk_bf16_f32 v254, v222, v223
    v_mfma_f32_16x16x32_bf16 v[126:129], a[128:131], v[234:237], v[126:129]
    v_mul_f32 v224, v178, v224
    v_mul_f32 v225, v178, v225
    v_mfma_f32_16x16x32_bf16 v[126:129], a[132:135], v[158:161], v[126:129]
    v_cvt_pk_bf16_f32 v255, v224, v225
    v_xor_b32 v3, 65536, v3
    v_mfma_f32_16x16x32_bf16 v[126:129], a[136:139], v[182:185], v[126:129]
    ds_write_b64 v4, v[254:255] offset:4096
    v_mfma_f32_16x16x32_bf16 v[126:129], a[140:143], v[206:209], v[126:129]
    v_xor_b32 v4, 65536, v4
    v_cvt_pk_f16_f32 v194, v190, v191
    v_mfma_f32_16x16x32_bf16 v[142:145], a[0:3], v[186:189], 0
    v_pk_mul_f16 v191, v194, v194
    v_cvt_pk_f16_f32 v195, v192, v193
    v_mfma_f32_16x16x32_bf16 v[142:145], a[4:7], v[118:121], v[142:145]
    v_pk_fma_f16 v191, v195, v195, v191
    v_cvt_pk_f16_f32 v196, v130, v131
    v_mfma_f32_16x16x32_bf16 v[142:145], a[8:11], v[234:237], v[142:145]
    v_pk_fma_f16 v191, v196, v196, v191
    v_cvt_pk_f16_f32 v197, v132, v133
    v_mfma_f32_16x16x32_bf16 v[142:145], a[12:15], v[158:161], v[142:145]
    v_pk_fma_f16 v191, v197, v197, v191
    v_cvt_pk_f16_f32 v148, v126, v127
    v_mfma_f32_16x16x32_bf16 v[142:145], a[16:19], v[182:185], v[142:145]
    v_pk_fma_f16 v191, v148, v148, v191
    v_cvt_pk_f16_f32 v149, v128, v129
    v_mfma_f32_16x16x32_bf16 v[142:145], a[20:23], v[206:209], v[142:145]
    s_waitcnt lgkmcnt(0)
    v_pk_fma_f16 v191, v149, v149, v191
    v_add_u32 v7, s76, v7
    v_mfma_f32_16x16x32_bf16 v[126:129], a[24:27], v[186:189], 0
    s_barrier
    v_mfma_f32_16x16x32_bf16 v[126:129], a[28:31], v[118:121], v[126:129]
    s_nop 0
    v_mfma_f32_16x16x32_bf16 v[126:129], a[32:35], v[234:237], v[126:129]
    s_nop 0
    v_mfma_f32_16x16x32_bf16 v[126:129], a[36:39], v[158:161], v[126:129]
    s_nop 0
    v_mfma_f32_16x16x32_bf16 v[126:129], a[40:43], v[182:185], v[126:129]
    v_mfma_f32_16x16x32_bf16 v[126:129], a[44:47], v[206:209], v[126:129]
    s_cbranch_scc1 L_loop_fast0
    s_branch L_final_fast
.p2align 6
L_loop_fast1:
    v_mfma_f32_16x16x32_bf16 v[130:133], a[48:51], v[186:189], 0
    s_add_u32 s12, s40, s27
    ds_read_b128 v[246:249], v2 offset:18432
    v_cvt_pk_f16_f32 v222, v142, v143
    v_mfma_f32_16x16x32_bf16 v[130:133], a[52:55], v[118:121], v[130:133]
    s_addc_u32 s13, s41, 0
    ds_read_b128 v[210:213], v2 offset:19456
    v_pk_mul_f16 v190, v222, v222
    v_mfma_f32_16x16x32_bf16 v[130:133], a[56:59], v[234:237], v[130:133]
    s_sub_u32 s14, s36, s27
    ds_read_b128 v[238:241], v5 offset:32
    v_cvt_pk_f16_f32 v223, v144, v145
    v_mfma_f32_16x16x32_bf16 v[130:133], a[60:63], v[158:161], v[130:133]
    s_cmp_ge_u32 s18, 2
    ds_read2_b64 v[226:229], v5 offset0:6 offset1:9
    v_pk_fma_f16 v190, v223, v223, v190
    v_mfma_f32_16x16x32_bf16 v[130:133], a[64:67], v[182:185], v[130:133]
    s_cselect_b32 s14, s14, 0
    ds_read_b128 v[142:145], v5
    v_cvt_pk_f16_f32 v224, v126, v127
    v_mfma_f32_16x16x32_bf16 v[130:133], a[68:71], v[206:209], v[130:133]
    s_sub_u32 s82, s72, s71
    ds_read_b32 v254, v6 offset:192
    v_pk_fma_f16 v190, v224, v224, v190
    v_mfma_f32_16x16x32_bf16 v[198:201], v[186:189], a[144:147], 0
    s_mul_i32 s74, s82, 336
    v_cvt_pk_f16_f32 v225, v128, v129
    v_pk_fma_f16 v190, v225, v225, v190
    v_mfma_f32_16x16x32_bf16 v[198:201], v[118:121], a[148:151], v[198:201]
    s_mul_i32 s75, s82, 272
    v_cvt_pk_f16_f32 v146, v130, v131
    v_pk_fma_f16 v190, v146, v146, v190
    v_mfma_f32_16x16x32_bf16 v[198:201], v[234:237], a[152:155], v[198:201]
    s_waitcnt lgkmcnt(5)
    v_cvt_pk_f16_f32 v147, v132, v133
    v_pk_fma_f16 v190, v147, v147, v190
    v_mfma_f32_16x16x32_bf16 v[130:133], v[32:35], v[246:249], 0
    s_waitcnt lgkmcnt(4)
    v_add_u32 v5, s74, v5
    s_mul_i32 s76, s82, 16
    v_mfma_f32_16x16x32_bf16 v[130:133], v[32:35], v[210:213], v[130:133]
    s_waitcnt lgkmcnt(3)
    v_pk_mul_f16 v193, v194, v238
    v_pk_fma_f16 v193, v195, v239, v193
    v_mfma_f32_16x16x32_bf16 v[198:201], v[158:161], a[156:159], v[198:201]
    s_add_u32 s34, s18, 2
    v_pk_fma_f16 v193, v196, v240, v193
    v_pk_fma_f16 v193, v197, v241, v193
    v_mfma_f32_16x16x32_bf16 v[198:201], v[182:185], a[160:163], v[198:201]
    s_waitcnt lgkmcnt(1)
    v_pk_fma_f16 v193, v148, v228, v193
    v_pk_fma_f16 v193, v149, v229, v193
    v_mfma_f32_16x16x32_bf16 v[198:201], v[206:209], a[164:167], v[198:201]
    s_waitcnt lgkmcnt(0)
    v_mov_b32_dpp v254, v23 quad_perm:[0,1,2,3] row_mask:0x7 bank_mask:0xf
    v_pk_mul_f16 v192, v222, v142
    v_mfma_f32_16x16x32_bf16 v[210:213], v[186:189], a[168:171], 0
    s_add_u32 s8, s60, s23
    v_pk_fma_f16 v192, v223, v143, v192
    v_pk_fma_f16 v192, v224, v144, v192
    v_mfma_f32_16x16x32_bf16 v[210:213], v[118:121], a[172:175], v[210:213]
    s_addc_u32 s9, s61, 0
    v_pk_fma_f16 v192, v225, v145, v192
    v_pk_fma_f16 v192, v146, v226, v192
    v_mfma_f32_16x16x32_bf16 v[210:213], v[234:237], a[176:179], v[210:213]
    s_sub_u32 s10, s36, s23
    ds_read_b128 v[246:249], v0 offset:26624
    v_pk_fma_f16 v192, v147, v227, v192
    v_mfma_f32_16x16x32_bf16 v[210:213], v[158:161], a[180:183], v[210:213]
    s_cmp_le_u32 s34, s45
    ds_read_b128 v[174:177], v1 offset:26624
    v_cvt_pk_bf16_f32 v126, v198, v199
    v_mfma_f32_16x16x32_f16 v[214:217], v[40:43], v[190:193], 0
    s_cselect_b32 s10, s10, 0
    v_cvt_pk_bf16_f32 v127, v200, v201
    v_mul_f32 v255, 0x3baaaaab, v130
    v_mfma_f32_16x16x32_bf16 v[210:213], v[182:185], a[184:187], v[210:213]
    s_add_u32 m0, s28, 0
    ds_read_b128 v[198:201], v0 offset:26752
    v_mul_f32 v134, 0x3baaaaab, v131
    v_mfma_f32_16x16x32_bf16 v[210:213], v[206:209], a[188:191], v[210:213]
    s_mov_b32 s27, s26
    ds_read_b128 v[242:245], v1 offset:26752
    v_mul_f32 v132, 0x3baaaaab, v132
    v_mfma_f32_16x16x32_bf16 v[190:193], v[186:189], a[192:195], 0
    s_mov_b32 s26, s25
    ds_read_b128 v[186:189], v0 offset:26880
    s_mov_b32 s25, s24
    v_mfma_f32_16x16x32_bf16 v[190:193], v[118:121], a[196:199], v[190:193]
    s_mov_b32 s24, s23
    ds_read_b128 v[118:121], v1 offset:26880
    v_cvt_pk_bf16_f32 v130, v210, v211
    v_mfma_f32_16x16x32_bf16 v[190:193], v[234:237], a[200:203], v[190:193]
    s_ff1_i32_b32 s80, s100
    v_rsq_f32 v214, v214
    v_mfma_f32_16x16x32_bf16 v[190:193], v[158:161], a[204:207], v[190:193]
    s_waitcnt lgkmcnt(5)
    v_rsq_f32 v215, v215
    v_mfma_f32_16x16x32_bf16 v[190:193], v[182:185], a[208:211], v[190:193]
    s_mov_b32 s71, s72
    v_mul_f32 v128, s31, v214
    v_cvt_pk_f16_f32 v129, v128, v215
    v_mfma_f32_16x16x32_bf16 v[190:193], v[206:209], a[212:215], v[190:193]
    s_mov_b32 s72, s73
    v_cvt_pk_bf16_f32 v131, v212, v213
    v_fma_f32 v216, v216, v128, v22
    v_mfma_f32_16x16x32_bf16 v[210:213], a[72:75], v[246:249], 0
    s_waitcnt lgkmcnt(3)
    v_fmac_f32_dpp v254, v217, v215 quad_perm:[0,1,2,3] row_mask:0x1 bank_mask:0xf
    v_pk_mul_f16 v194, v194, v129 op_sel:[0,1] op_sel_hi:[1,1]
    v_mfma_f32_16x16x32_bf16 v[210:213], a[76:79], v[174:177], v[210:213]
    s_waitcnt lgkmcnt(2)
    v_cvt_pk_bf16_f32 v190, v190, v191
    v_cvt_pk_bf16_f32 v191, v192, v193
    v_mfma_f32_16x16x32_bf16 v[210:213], a[80:83], v[198:201], v[210:213]
    s_waitcnt lgkmcnt(1)
    v_pk_mul_f16 v195, v195, v129 op_sel:[0,1] op_sel_hi:[1,1]
    v_pk_mul_f16 v196, v196, v129 op_sel:[0,1] op_sel_hi:[1,1]
    v_mfma_f32_16x16x32_bf16 v[210:213], a[84:87], v[242:245], v[210:213]
    s_waitcnt lgkmcnt(0)
    v_pk_mul_f16 v197, v197, v129 op_sel:[0,1] op_sel_hi:[1,1]
    v_pk_mul_f16 v148, v148, v129 op_sel:[0,1] op_sel_hi:[1,1]
    v_mfma_f32_16x16x32_bf16 v[210:213], a[88:91], v[186:189], v[210:213]
    v_pk_mul_f16 v149, v149, v129 op_sel:[0,1] op_sel_hi:[1,1]
    v_pk_mul_f16 v222, v222, v129 op_sel:[0,0] op_sel_hi:[1,0]
    v_mfma_f32_16x16x32_bf16 v[210:213], a[92:95], v[118:121], v[210:213]
    v_pk_mul_f16 v223, v223, v129 op_sel:[0,0] op_sel_hi:[1,0]
    v_pk_mul_f16 v224, v224, v129 op_sel:[0,0] op_sel_hi:[1,0]
    v_mfma_f32_16x16x32_bf16 v[206:209], a[96:99], v[246:249], 0
    v_pk_mul_f16 v225, v225, v129 op_sel:[0,0] op_sel_hi:[1,0]
    v_pk_mul_f16 v146, v146, v129 op_sel:[0,0] op_sel_hi:[1,0]
    v_mfma_f32_16x16x32_bf16 v[206:209], a[100:103], v[174:177], v[206:209]
    v_pk_mul_f16 v147, v147, v129 op_sel:[0,0] op_sel_hi:[1,0]
    v_max3_u32 v44, v44, v214, v215
    v_mfma_f32_16x16x32_bf16 v[206:209], a[104:107], v[198:201], v[206:209]
    v_rsq_f32 v255, v255
    v_mfma_f32_16x16x32_bf16 v[206:209], a[108:111], v[242:245], v[206:209]
    v_rsq_f32 v134, v134
    v_mfma_f32_16x16x32_bf16 v[206:209], a[112:115], v[186:189], v[206:209]
    v_rsq_f32 v132, v132
    v_mfma_f32_16x16x32_bf16 v[206:209], a[116:119], v[118:121], v[206:209]
    v_mul_f32 v122, v255, v122
    v_mul_f32 v123, v255, v123
    v_mfma_f32_16x16x32_bf16 v[234:237], a[120:123], v[246:249], 0
    v_cvt_pk_bf16_f32 v122, v122, v123
    v_mul_f32 v124, v255, v124
    v_mfma_f32_16x16x32_bf16 v[234:237], a[124:127], v[174:177], v[234:237]
    v_mul_f32 v125, v255, v125
    v_cvt_pk_bf16_f32 v123, v124, v125
    v_mfma_f32_16x16x32_bf16 v[234:237], a[128:131], v[198:201], v[234:237]
    v_mul_f32 v154, v255, v154
    v_mul_f32 v155, v255, v155
    v_mfma_f32_16x16x32_bf16 v[234:237], a[132:135], v[242:245], v[234:237]
    v_cvt_pk_bf16_f32 v124, v154, v155
    v_mul_f32 v156, v255, v156
    v_mfma_f32_16x16x32_bf16 v[234:237], a[136:139], v[186:189], v[234:237]
    v_mul_f32 v157, v255, v157
    v_cvt_pk_bf16_f32 v125, v156, v157
    v_mfma_f32_16x16x32_bf16 v[234:237], a[140:143], v[118:121], v[234:237]
    buffer_store_dwordx4 v[122:125], v15, s[12:15], 0 offen nt
    v_mul_f32 v202, v255, v202
    v_mul_f32 v203, v255, v203
    v_cvt_pk_bf16_f32 v128, v202, v203
    v_mul_f32 v204, v255, v204
    v_mfma_f32_16x16x32_bf16 v[122:125], a[0:3], v[246:249], 0
    v_mul_f32 v205, v255, v205
    v_cvt_pk_bf16_f32 v129, v204, v205
    v_mfma_f32_16x16x32_bf16 v[122:125], a[4:7], v[174:177], v[122:125]
    v_cvt_pk_f16_f32 v202, v210, v211
    v_pk_mul_f16 v211, v202, v202
    v_mfma_f32_16x16x32_bf16 v[122:125], a[8:11], v[198:201], v[122:125]
    v_cvt_pk_f16_f32 v203, v212, v213
    v_pk_fma_f16 v211, v203, v203, v211
    v_mfma_f32_16x16x32_bf16 v[122:125], a[12:15], v[242:245], v[122:125]
    v_cvt_pk_f16_f32 v204, v206, v207
    v_pk_fma_f16 v211, v204, v204, v211
    v_mfma_f32_16x16x32_bf16 v[122:125], a[16:19], v[186:189], v[122:125]
    v_cvt_pk_f16_f32 v205, v208, v209
    v_pk_fma_f16 v211, v205, v205, v211
    v_mfma_f32_16x16x32_bf16 v[122:125], a[20:23], v[118:121], v[122:125]
    v_cvt_pk_f16_f32 v160, v234, v235
    v_pk_fma_f16 v211, v160, v160, v211
    v_mfma_f32_16x16x32_bf16 v[154:157], a[24:27], v[246:249], 0
    v_cvt_pk_f16_f32 v161, v236, v237
    v_pk_fma_f16 v211, v161, v161, v211
    v_mfma_f32_16x16x32_bf16 v[154:157], a[28:31], v[174:177], v[154:157]
    v_pk_mul_f16 v213, v202, v238
    v_pk_fma_f16 v213, v203, v239, v213
    v_mfma_f32_16x16x32_bf16 v[154:157], a[32:35], v[198:201], v[154:157]
    v_cvt_pk_f16_f32 v122, v122, v123
    v_pk_mul_f16 v210, v122, v122
    v_mfma_f32_16x16x32_bf16 v[154:157], a[36:39], v[242:245], v[154:157]
    v_cvt_pk_f16_f32 v123, v124, v125
    v_pk_fma_f16 v210, v123, v123, v210
    v_mfma_f32_16x16x32_bf16 v[154:157], a[40:43], v[186:189], v[154:157]
    v_pk_mul_f16 v212, v122, v142
    v_pk_fma_f16 v212, v123, v143, v212
    v_mfma_f32_16x16x32_bf16 v[154:157], a[44:47], v[118:121], v[154:157]
    v_pk_fma_f16 v213, v204, v240, v213
    v_pk_fma_f16 v213, v205, v241, v213
    v_mfma_f32_16x16x32_bf16 v[206:209], a[48:51], v[246:249], 0
    v_pk_fma_f16 v213, v160, v228, v213
    v_pk_fma_f16 v213, v161, v229, v213
    v_mfma_f32_16x16x32_bf16 v[206:209], a[52:55], v[174:177], v[206:209]
    v_mul_f32 v150, v132, v150
    v_mul_f32 v151, v132, v151
    v_mfma_f32_16x16x32_bf16 v[206:209], a[56:59], v[198:201], v[206:209]
    v_cvt_pk_f16_f32 v124, v154, v155
    v_pk_fma_f16 v210, v124, v124, v210
    v_mfma_f32_16x16x32_bf16 v[206:209], a[60:63], v[242:245], v[206:209]
    v_cvt_pk_f16_f32 v125, v156, v157
    v_pk_fma_f16 v210, v125, v125, v210
    v_mfma_f32_16x16x32_bf16 v[206:209], a[64:67], v[186:189], v[206:209]
    buffer_store_dwordx2 v[128:129], v18, s[12:15], 0 offen nt
    v_pk_fma_f16 v212, v124, v144, v212
    v_pk_fma_f16 v212, v125, v145, v212
    v_mfma_f32_16x16x32_bf16 v[206:209], a[68:71], v[118:121], v[206:209]
    v_cvt_pk_bf16_f32 v150, v150, v151
    v_mul_f32 v152, v132, v152
    v_mfma_f32_16x16x32_bf16 v[154:157], v[246:249], a[144:147], 0
    v_mul_f32 v153, v132, v153
    v_cvt_pk_bf16_f32 v151, v152, v153
    v_mfma_f32_16x16x32_bf16 v[154:157], v[174:177], a[148:151], v[154:157]
    v_mul_f32 v162, v132, v162
    v_mul_f32 v163, v132, v163
    v_mfma_f32_16x16x32_bf16 v[154:157], v[198:201], a[152:155], v[154:157]
    v_cvt_pk_f16_f32 v158, v206, v207
    v_pk_fma_f16 v210, v158, v158, v210
    v_mfma_f32_16x16x32_bf16 v[154:157], v[242:245], a[156:159], v[154:157]
    v_cvt_pk_f16_f32 v159, v208, v209
    v_pk_fma_f16 v210, v159, v159, v210
    v_mfma_f32_16x16x32_bf16 v[154:157], v[186:189], a[160:163], v[154:157]
    v_pk_fma_f16 v212, v158, v226, v212
    v_pk_fma_f16 v212, v159, v227, v212
    v_mfma_f32_16x16x32_bf16 v[154:157], v[118:121], a[164:167], v[154:157]
    v_cvt_pk_bf16_f32 v152, v162, v163
    v_mul_f32 v164, v132, v164
    v_mfma_f32_16x16x32_f16 v[206:209], v[40:43], v[210:213], 0
    v_mul_f32 v165, v132, v165
    v_cvt_pk_bf16_f32 v153, v164, v165
    v_mfma_f32_16x16x32_bf16 v[210:213], v[246:249], a[168:171], 0
    v_mul_f32 v138, v132, v138
    v_mul_f32 v139, v132, v139
    v_mfma_f32_16x16x32_bf16 v[210:213], v[174:177], a[172:175], v[210:213]
    v_cvt_pk_bf16_f32 v128, v154, v155
    v_cvt_pk_bf16_f32 v129, v156, v157
    v_mfma_f32_16x16x32_bf16 v[210:213], v[198:201], a[176:179], v[210:213]
    ds_read_b128 v[154:157], v0 offset:32768
    v_cvt_pk_bf16_f32 v136, v138, v139
    v_mfma_f32_16x16x32_bf16 v[210:213], v[242:245], a[180:183], v[210:213]
    ds_read_b128 v[162:165], v1 offset:32768
    v_mul_f32 v140, v132, v140
    v_mfma_f32_16x16x32_bf16 v[210:213], v[186:189], a[184:187], v[210:213]
    ds_read_b128 v[218:221], v0 offset:32896
    v_mul_f32 v141, v132, v141
    v_mfma_f32_16x16x32_bf16 v[210:213], v[118:121], a[188:191], v[210:213]
    ds_read_b128 v[234:237], v1 offset:32896
    v_cvt_pk_bf16_f32 v137, v140, v141
    v_mfma_f32_16x16x32_bf16 v[182:185], v[246:249], a[192:195], 0
    ds_read_b128 v[138:141], v0 offset:33024
    v_mul_f32 v114, v134, v114
    v_mfma_f32_16x16x32_bf16 v[182:185], v[174:177], a[196:199], v[182:185]
    ds_read_b128 v[246:249], v1 offset:33024
    v_mul_f32 v115, v134, v115
    v_mfma_f32_16x16x32_bf16 v[182:185], v[198:201], a[200:203], v[182:185]
    buffer_store_dwordx4 v[150:153], v17, s[12:15], 0 offen nt
    v_rsq_f32 v206, v206
    v_rsq_f32 v207, v207
    v_mfma_f32_16x16x32_bf16 v[182:185], v[242:245], a[204:207], v[182:185]
    s_waitcnt lgkmcnt(5)
    v_mul_f32 v214, s31, v206
    v_cvt_pk_f16_f32 v215, v214, v207
    v_mfma_f32_16x16x32_bf16 v[182:185], v[186:189], a[208:211], v[182:185]
    s_waitcnt lgkmcnt(4)
    v_fma_f32 v208, v208, v214, v24
    v_fmac_f32_dpp v254, v209, v207 quad_perm:[0,1,2,3] row_mask:0x2 bank_mask:0xf
    v_mfma_f32_16x16x32_bf16 v[182:185], v[118:121], a[212:215], v[182:185]
    s_waitcnt lgkmcnt(3)
    v_cvt_pk_bf16_f32 v132, v210, v211
    v_cvt_pk_bf16_f32 v133, v212, v213
    v_mfma_f32_16x16x32_bf16 v[210:213], a[72:75], v[154:157], 0
    s_waitcnt lgkmcnt(2)
    v_pk_mul_f16 v202, v202, v215 op_sel:[0,1] op_sel_hi:[1,1]
    v_pk_mul_f16 v203, v203, v215 op_sel:[0,1] op_sel_hi:[1,1]
    v_mfma_f32_16x16x32_bf16 v[210:213], a[76:79], v[162:165], v[210:213]
    s_waitcnt lgkmcnt(1)
    v_cvt_pk_bf16_f32 v192, v182, v183
    v_cvt_pk_bf16_f32 v193, v184, v185
    v_mfma_f32_16x16x32_bf16 v[210:213], a[80:83], v[218:221], v[210:213]
    s_waitcnt lgkmcnt(0)
    v_pk_mul_f16 v204, v204, v215 op_sel:[0,1] op_sel_hi:[1,1]
    v_pk_mul_f16 v205, v205, v215 op_sel:[0,1] op_sel_hi:[1,1]
    v_mfma_f32_16x16x32_bf16 v[210:213], a[84:87], v[234:237], v[210:213]
    v_pk_mul_f16 v160, v160, v215 op_sel:[0,1] op_sel_hi:[1,1]
    v_pk_mul_f16 v161, v161, v215 op_sel:[0,1] op_sel_hi:[1,1]
    v_mfma_f32_16x16x32_bf16 v[210:213], a[88:91], v[138:141], v[210:213]
    v_pk_mul_f16 v122, v122, v215 op_sel:[0,0] op_sel_hi:[1,0]
    v_pk_mul_f16 v123, v123, v215 op_sel:[0,0] op_sel_hi:[1,0]
    v_mfma_f32_16x16x32_bf16 v[210:213], a[92:95], v[246:249], v[210:213]
    v_pk_mul_f16 v124, v124, v215 op_sel:[0,0] op_sel_hi:[1,0]
    v_pk_mul_f16 v125, v125, v215 op_sel:[0,0] op_sel_hi:[1,0]
    v_mfma_f32_16x16x32_bf16 v[118:121], a[96:99], v[154:157], 0
    v_pk_mul_f16 v158, v158, v215 op_sel:[0,0] op_sel_hi:[1,0]
    v_pk_mul_f16 v159, v159, v215 op_sel:[0,0] op_sel_hi:[1,0]
    v_mfma_f32_16x16x32_bf16 v[118:121], a[100:103], v[162:165], v[118:121]
    v_max3_u32 v44, v44, v206, v207
    v_cvt_pk_bf16_f32 v114, v114, v115
    v_mfma_f32_16x16x32_bf16 v[118:121], a[104:107], v[218:221], v[118:121]
    v_cvt_pk_f16_f32 v186, v210, v211
    v_pk_mul_f16 v211, v186, v186
    v_mfma_f32_16x16x32_bf16 v[118:121], a[108:111], v[234:237], v[118:121]
    s_waitcnt vmcnt(3)
    ds_write_b16 v8, v45 offset:512
    v_mfma_f32_16x16x32_bf16 v[118:121], a[112:115], v[138:141], v[118:121]
    v_cvt_pk_f16_f32 v187, v212, v213
    v_mfma_f32_16x16x32_bf16 v[118:121], a[116:119], v[246:249], v[118:121]
    v_pk_fma_f16 v211, v187, v187, v211
    v_pk_mul_f16 v213, v186, v238
    v_mfma_f32_16x16x32_bf16 v[150:153], a[120:123], v[154:157], 0
    v_pk_fma_f16 v213, v187, v239, v213
    v_mul_f32 v116, v134, v116
    v_mfma_f32_16x16x32_bf16 v[150:153], a[124:127], v[162:165], v[150:153]
    buffer_store_dwordx2 v[136:137], v20, s[12:15], 0 offen nt
    v_exp_f32 v208, v208
    v_mfma_f32_16x16x32_bf16 v[150:153], a[128:131], v[218:221], v[150:153]
    v_cvt_pk_f16_f32 v188, v118, v119
    v_pk_fma_f16 v211, v188, v188, v211
    v_mfma_f32_16x16x32_bf16 v[150:153], a[132:135], v[234:237], v[150:153]
    v_cvt_pk_f16_f32 v189, v120, v121
    v_pk_fma_f16 v211, v189, v189, v211
    v_mfma_f32_16x16x32_bf16 v[150:153], a[136:139], v[138:141], v[150:153]
    s_waitcnt lgkmcnt(0)
    v_pk_fma_f16 v213, v188, v240, v213
    v_pk_fma_f16 v213, v189, v241, v213
    v_mfma_f32_16x16x32_bf16 v[150:153], a[140:143], v[246:249], v[150:153]
    v_mul_f32 v117, v134, v117
    v_mfma_f32_16x16x32_bf16 v[238:241], a[0:3], v[154:157], 0
    s_barrier
    v_cvt_pk_bf16_f32 v115, v116, v117
    v_mfma_f32_16x16x32_bf16 v[238:241], a[4:7], v[162:165], v[238:241]
    v_mul_f32 v166, v134, v166
    v_mfma_f32_16x16x32_bf16 v[238:241], a[8:11], v[218:221], v[238:241]
    ds_read_u16 v255, v9 offset:384
    v_mfma_f32_16x16x32_bf16 v[238:241], a[12:15], v[234:237], v[238:241]
    v_cvt_pk_f16_f32 v120, v150, v151
    v_pk_fma_f16 v211, v120, v120, v211
    v_mfma_f32_16x16x32_bf16 v[238:241], a[16:19], v[138:141], v[238:241]
    v_cvt_pk_f16_f32 v121, v152, v153
    v_pk_fma_f16 v211, v121, v121, v211
    v_mfma_f32_16x16x32_bf16 v[238:241], a[20:23], v[246:249], v[238:241]
    v_pk_fma_f16 v213, v120, v228, v213
    v_pk_fma_f16 v213, v121, v229, v213
    v_mfma_f32_16x16x32_bf16 v[150:153], a[24:27], v[154:157], 0
    v_exp_f32 v216, v216
    v_mfma_f32_16x16x32_bf16 v[150:153], a[28:31], v[162:165], v[150:153]
    v_cvt_pk_bf16_f32 v39, v216, 0
    v_mul_f32 v167, v134, v167
    v_mfma_f32_16x16x32_bf16 v[150:153], a[32:35], v[218:221], v[150:153]
    v_cvt_pk_f16_f32 v198, v238, v239
    v_pk_mul_f16 v210, v198, v198
    v_mfma_f32_16x16x32_bf16 v[150:153], a[36:39], v[234:237], v[150:153]
    v_cvt_pk_f16_f32 v199, v240, v241
    v_pk_fma_f16 v210, v199, v199, v210
    v_mfma_f32_16x16x32_bf16 v[150:153], a[40:43], v[138:141], v[150:153]
    s_waitcnt lgkmcnt(0)
    v_readfirstlane_b32 s77, v255
    v_pk_mul_f16 v212, v198, v142
    v_mfma_f32_16x16x32_bf16 v[150:153], a[44:47], v[246:249], v[150:153]
    v_pk_fma_f16 v212, v199, v143, v212
    v_cvt_pk_bf16_f32 v116, v166, v167
    v_mfma_f32_16x16x32_bf16 v[238:241], a[48:51], v[154:157], 0
    buffer_load_dwordx4 v10, s[8:11], 0 offen nt lds
    v_mul_f32 v168, v134, v168
    v_mfma_f32_16x16x32_bf16 v[238:241], a[52:55], v[162:165], v[238:241]
    s_add_u32 m0, s28, 4096
    v_mul_f32 v169, v134, v169
    v_cvt_pk_f16_f32 v200, v150, v151
    v_mfma_f32_16x16x32_bf16 v[238:241], a[56:59], v[218:221], v[238:241]
    v_pk_fma_f16 v210, v200, v200, v210
    v_cvt_pk_f16_f32 v201, v152, v153
    v_mfma_f32_16x16x32_bf16 v[238:241], a[60:63], v[234:237], v[238:241]
    ds_read_b128 v[242:245], v2 offset:0
    v_pk_fma_f16 v210, v201, v201, v210
    v_mfma_f32_16x16x32_bf16 v[238:241], a[64:67], v[138:141], v[238:241]
    ds_read_b128 v[174:177], v2 offset:1024
    v_pk_fma_f16 v212, v200, v144, v212
    v_mfma_f32_16x16x32_bf16 v[238:241], a[68:71], v[246:249], v[238:241]
    ds_read_b128 v[170:173], v2 offset:2048
    buffer_load_dwordx4 v11, s[8:11], 0 offen nt lds
    v_mfma_f32_16x16x32_bf16 v[150:153], v[154:157], a[144:147], 0
    s_add_u32 m0, s28, 8192
    ds_read_b128 v[214:217], v2 offset:3072
    v_pk_fma_f16 v212, v201, v145, v212
    v_mfma_f32_16x16x32_bf16 v[150:153], v[162:165], a[148:151], v[150:153]
    ds_read_b128 v[182:185], v2 offset:4096
    v_cvt_pk_f16_f32 v118, v238, v239
    v_mfma_f32_16x16x32_bf16 v[150:153], v[218:221], a[152:155], v[150:153]
    ds_read_b128 v[178:181], v2 offset:5120
    v_pk_fma_f16 v210, v118, v118, v210
    v_mfma_f32_16x16x32_bf16 v[150:153], v[234:237], a[156:159], v[150:153]
    v_cvt_pk_f16_f32 v119, v240, v241
    v_pk_fma_f16 v210, v119, v119, v210
    v_mfma_f32_16x16x32_bf16 v[150:153], v[138:141], a[160:163], v[150:153]
    buffer_load_dwordx4 v12, s[8:11], 0 offen nt lds
    v_pk_fma_f16 v212, v118, v226, v212
    v_mfma_f32_16x16x32_bf16 v[150:153], v[246:249], a[164:167], v[150:153]
    s_waitcnt lgkmcnt(5)
    v_pk_fma_f16 v212, v119, v227, v212
    v_cvt_pk_bf16_f32 v117, v168, v169
    v_mfma_f32_16x16x32_bf16 v[226:229], v[154:157], a[168:171], 0
    s_add_u32 m0, s28, 12288
    v_mul_f32 v230, v134, v230
    v_mul_f32 v231, v134, v231
    v_mfma_f32_16x16x32_f16 v[166:169], v[40:43], v[210:213], 0
    s_xor_b32 s28, s28, 65536
    v_cvt_pk_bf16_f32 v142, v150, v151
    v_cvt_pk_bf16_f32 v143, v152, v153
    v_mfma_f32_16x16x32_bf16 v[226:229], v[162:165], a[172:175], v[226:229]
    s_waitcnt lgkmcnt(2)
    ds_read2_b32 v[144:145], v6 offset0:0 offset1:0
    v_cvt_pk_bf16_f32 v230, v230, v231
    v_mfma_f32_16x16x32_bf16 v[226:229], v[218:221], a[176:179], v[226:229]
    s_waitcnt lgkmcnt(2)
    buffer_load_dwordx4 v13, s[8:11], 0 offen nt lds
    ds_read2_b32 v[212:213], v6 offset0:16 offset1:16
    v_mfma_f32_16x16x32_bf16 v[226:229], v[234:237], a[180:183], v[226:229]
    s_mov_b32 m0, s29
    ds_read2_b32 v[240:241], v6 offset0:32 offset1:32
    v_mul_f32 v232, v134, v232
    v_mfma_f32_16x16x32_bf16 v[226:229], v[138:141], a[184:187], v[226:229]
    s_xor_b32 s29, s29, s30
    v_rsq_f32 v166, v166
    v_mfma_f32_16x16x32_bf16 v[226:229], v[246:249], a[188:191], v[226:229]
    s_add_u32 s19, s19, s20
    v_rsq_f32 v167, v167
    v_mfma_f32_16x16x32_bf16 v[150:153], v[154:157], a[192:195], 0
    s_add_u32 s23, s23, s21
    v_mul_f32 v136, s31, v166
    v_cvt_pk_f16_f32 v137, v136, v167
    v_mfma_f32_16x16x32_bf16 v[150:153], v[162:165], a[196:199], v[150:153]
    s_waitcnt lgkmcnt(3)
    buffer_load_dwordx4 v14, s[8:11], 0 offen nt lds
    v_fma_f32 v168, v168, v136, v26
    v_mfma_f32_16x16x32_bf16 v[150:153], v[218:221], a[200:203], v[150:153]
    s_cmp_ge_u32 s19, 72
    v_fmac_f32_dpp v254, v169, v167 quad_perm:[0,1,2,3] row_mask:0x4 bank_mask:0xf
    v_cvt_pk_bf16_f32 v210, v226, v227
    v_mfma_f32_16x16x32_bf16 v[150:153], v[234:237], a[204:207], v[150:153]
    s_cselect_b32 s34, 72, 0
    v_cvt_pk_bf16_f32 v211, v228, v229
    v_pk_mul_f16 v186, v186, v137 op_sel:[0,1] op_sel_hi:[1,1]
    v_mfma_f32_16x16x32_bf16 v[150:153], v[138:141], a[208:211], v[150:153]
    s_cselect_b32 s35, s22, 0
    v_pk_mul_f16 v187, v187, v137 op_sel:[0,1] op_sel_hi:[1,1]
    v_pk_mul_f16 v188, v188, v137 op_sel:[0,1] op_sel_hi:[1,1]
    v_mfma_f32_16x16x32_bf16 v[150:153], v[246:249], a[212:215], v[150:153]
    s_sub_u32 s19, s19, s34
    v_pk_mul_f16 v189, v189, v137 op_sel:[0,1] op_sel_hi:[1,1]
    v_pk_mul_f16 v120, v120, v137 op_sel:[0,1] op_sel_hi:[1,1]
    v_mfma_f32_16x16x32_f16 v[154:157], v[194:197], v[222:225], v[46:49]
    s_waitcnt lgkmcnt(0)
    buffer_store_dwordx4 v[114:117], v16, s[12:15], 0 offen nt
    v_pk_mul_f16 v121, v121, v137 op_sel:[0,1] op_sel_hi:[1,1]
    v_pk_mul_f16 v198, v198, v137 op_sel:[0,0] op_sel_hi:[1,0]
    v_cvt_pk_bf16_f32 v238, v150, v151
    v_cvt_pk_bf16_f32 v239, v152, v153
    v_mfma_f32_16x16x32_f16 v[114:117], v[202:205], v[222:225], v[50:53]
    s_add_u32 s23, s23, s35
    v_pk_mul_f16 v199, v199, v137 op_sel:[0,0] op_sel_hi:[1,0]
    v_pk_mul_f16 v200, v200, v137 op_sel:[0,0] op_sel_hi:[1,0]
    v_mfma_f32_16x16x32_f16 v[246:249], v[186:189], v[222:225], v[54:57]
    s_cmp_lg_u32 s83, 0
    v_pk_mul_f16 v201, v201, v137 op_sel:[0,0] op_sel_hi:[1,0]
    v_pk_mul_f16 v118, v118, v137 op_sel:[0,0] op_sel_hi:[1,0]
    v_pk_mul_f16 v119, v119, v137 op_sel:[0,0] op_sel_hi:[1,0]
    v_mfma_f32_16x16x16_f16 v[154:157], v[148:149], v[146:147], v[154:157]
    v_max3_u32 v44, v44, v166, v167
    v_exp_f32 v254, v254
    v_mfma_f32_16x16x16_f16 v[114:117], v[160:161], v[146:147], v[114:117]
    v_cvt_pk_bf16_f32 v254, v254, v254
    v_exp_f32 v168, v168
    v_mfma_f32_16x16x16_f16 v[246:249], v[120:121], v[146:147], v[246:249]
    v_mul_f32 v233, v134, v233
    v_cvt_pk_bf16_f32 v231, v232, v233
    v_exp_f32 v154, v154
    v_mfma_f32_16x16x32_f16 v[162:165], v[194:197], v[122:125], v[58:61]
    s_cselect_b32 s77, s80, s77
    ds_write_b16 v8, v254
    v_mfma_f32_16x16x32_f16 v[138:141], v[202:205], v[122:125], v[62:65]
    s_mul_i32 s78, s77, 2688
    v_exp_f32 v155, v155
    v_mfma_f32_16x16x32_f16 v[234:237], v[186:189], v[122:125], v[66:69]
    s_add_u32 s78, s78, s69
    v_cvt_pk_bf16_f32 v218, v154, v155
    v_exp_f32 v156, v156
    v_mfma_f32_16x16x16_f16 v[162:165], v[148:149], v[158:159], v[162:165]
    v_exp_f32 v157, v157
    v_xor_b32 v0, 65536, v0
    v_mfma_f32_16x16x16_f16 v[138:141], v[160:161], v[158:159], v[138:141]
    v_cvt_pk_bf16_f32 v219, v156, v157
    v_exp_f32 v114, v114
    v_mfma_f32_16x16x16_f16 v[234:237], v[120:121], v[158:159], v[234:237]
    v_exp_f32 v115, v115
    v_exp_f32 v116, v116
    v_mfma_f32_16x16x32_bf16 v[122:125], a[216:219], v[242:245], 0
    s_add_u32 s80, s77, s68
    v_exp_f32 v162, v162
    v_mfma_f32_16x16x32_bf16 v[122:125], a[220:223], v[174:177], v[122:125]
    s_cmp_ge_u32 s80, 72
    v_exp_f32 v163, v163
    v_mfma_f32_16x16x32_f16 v[222:225], v[194:197], v[198:201], v[70:73]
    s_cselect_b32 s80, s22, 0
    v_cvt_pk_bf16_f32 v158, v162, v163
    v_cvt_pk_bf16_f32 v220, v114, v115
    v_mfma_f32_16x16x32_f16 v[134:137], v[202:205], v[198:201], v[74:77]
    s_add_u32 s78, s78, s80
    v_exp_f32 v164, v164
    v_mfma_f32_16x16x32_f16 v[194:197], v[186:189], v[198:201], v[78:81]
    buffer_store_dwordx2 v[230:231], v19, s[12:15], 0 offen nt
    v_exp_f32 v165, v165
    v_mfma_f32_16x16x16_f16 v[222:225], v[148:149], v[118:119], v[222:225]
    v_cvt_pk_bf16_f32 v159, v164, v165
    v_exp_f32 v138, v138
    v_mfma_f32_16x16x16_f16 v[134:137], v[160:161], v[118:119], v[134:137]
    v_exp_f32 v139, v139
    v_xor_b32 v1, 65536, v1
    v_mfma_f32_16x16x16_f16 v[194:197], v[120:121], v[118:119], v[194:197]
    v_cvt_pk_bf16_f32 v160, v138, v139
    v_exp_f32 v140, v140
    v_add_u32 v6, s75, v6
    v_mfma_f32_16x16x32_bf16 v[122:125], a[224:227], v[170:173], v[122:125]
    s_add_u32 s80, s77, 20
    v_exp_f32 v141, v141
    v_mfma_f32_16x16x32_bf16 v[122:125], a[228:231], v[214:217], v[122:125]
    s_add_u32 s34, s18, 3
    v_exp_f32 v234, v234
    v_mfma_f32_16x16x32_bf16 v[122:125], a[232:235], v[182:185], v[122:125]
    s_cmp_lt_u32 s77, s62
    v_exp_f32 v235, v235
    v_mfma_f32_16x16x32_bf16 v[122:125], a[236:239], v[178:181], v[122:125]
    s_cselect_b32 s79, 1, 0
    v_exp_f32 v236, v236
    v_mfma_f32_16x16x32_bf16 v[154:157], a[240:243], v[242:245], 0
    s_cselect_b32 s78, s78, 0
    ds_read_b128 v[150:153], v2 offset:6144
    v_cvt_pk_bf16_f32 v161, v140, v141
    v_mfma_f32_16x16x32_bf16 v[154:157], a[244:247], v[174:177], v[154:157]
    s_cmp_lt_u32 s34, s17
    ds_read_b128 v[162:165], v2 offset:7168
    v_fma_f32 v255, v122, v122, s33
    v_mfma_f32_16x16x32_bf16 v[154:157], a[248:251], v[170:173], v[154:157]
    s_cselect_b32 s23, s23, s78
    ds_read_b128 v[186:189], v2 offset:8192
    v_fmac_f32 v255, v123, v123
    v_mfma_f32_16x16x32_bf16 v[154:157], a[252:255], v[214:217], v[154:157]
    s_cselect_b32 s73, s34, s80
    ds_read_b128 v[138:141], v2 offset:9216
    v_fmac_f32 v255, v124, v124
    v_mfma_f32_16x16x32_bf16 v[154:157], v[82:85], v[182:185], v[154:157]
    s_cselect_b32 s79, 0, s79
    ds_read_b128 v[118:121], v2 offset:10240
    v_fmac_f32 v255, v125, v125
    v_mfma_f32_16x16x32_bf16 v[154:157], v[86:89], v[178:181], v[154:157]
    s_cselect_b32 s81, 0, 1
    ds_read_b128 v[198:201], v2 offset:11264
    s_add_u32 s80, s77, 1
    v_mfma_f32_16x16x32_bf16 v[202:205], v[90:93], v[242:245], 0
    s_mul_i32 s80, s80, s81
    v_exp_f32 v237, v237
    v_mfma_f32_16x16x32_bf16 v[202:205], v[94:97], v[174:177], v[202:205]
    s_cmp_lt_u32 s80, s62
    v_exp_f32 v117, v117
    v_mfma_f32_16x16x32_bf16 v[202:205], v[98:101], v[170:173], v[202:205]
    s_waitcnt lgkmcnt(5)
    v_cvt_pk_bf16_f32 v221, v116, v117
    v_fmac_f32 v255, v154, v154
    v_mfma_f32_16x16x32_bf16 v[202:205], v[102:105], v[214:217], v[202:205]
    s_cselect_b32 s70, s70, 0
    v_exp_f32 v246, v246
    v_mfma_f32_16x16x32_bf16 v[202:205], v[106:109], v[182:185], v[202:205]
    s_cselect_b32 s62, s62, 0
    v_exp_f32 v247, v247
    v_mfma_f32_16x16x32_bf16 v[202:205], v[110:113], v[178:181], v[202:205]
    s_add_u32 s80, s18, 4
    v_cvt_pk_bf16_f32 v36, v246, v247
    v_fmac_f32 v255, v155, v155
    v_mfma_f32_16x16x32_bf16 v[114:117], a[216:219], v[150:153], 0
    s_waitcnt lgkmcnt(1)
    v_exp_f32 v248, v248
    v_mfma_f32_16x16x32_bf16 v[114:117], a[220:223], v[162:165], v[114:117]
    s_cmp_ge_u32 s80, s17
    v_exp_f32 v249, v249
    v_mfma_f32_16x16x32_bf16 v[114:117], a[224:227], v[186:189], v[114:117]
    s_cselect_b32 s66, s70, 0
    v_cvt_pk_bf16_f32 v37, v248, v249
    v_fmac_f32 v255, v156, v156
    v_mfma_f32_16x16x32_bf16 v[114:117], a[228:231], v[138:141], v[114:117]
    s_waitcnt lgkmcnt(0)
    v_fmac_f32 v255, v157, v157
    v_mfma_f32_16x16x32_bf16 v[178:181], v[28:31], v[36:39], 0
    s_lshl_b32 s80, s79, s73
    v_exp_f32 v222, v222
    v_mfma_f32_16x16x32_bf16 v[178:181], v[28:31], v[218:221], v[178:181]
    s_or_b32 s63, s63, s80
    v_exp_f32 v223, v223
    v_mfma_f32_16x16x32_bf16 v[146:149], v[142:145], v[36:39], 0
    s_sub_u32 s80, s100, s81
    v_cvt_pk_bf16_f32 v226, v222, v223
    v_fmac_f32 v255, v202, v202
    v_mfma_f32_16x16x32_bf16 v[146:149], v[126:129], v[218:221], v[146:149]
    s_and_b32 s100, s100, s80
    v_exp_f32 v224, v224
    v_mfma_f32_16x16x32_bf16 v[246:249], v[210:213], v[36:39], 0
    s_add_u32 s45, s45, s79
    v_exp_f32 v225, v225
    v_mfma_f32_16x16x32_bf16 v[246:249], v[130:133], v[218:221], v[246:249]
    s_add_u32 s18, s18, 1
    v_cvt_pk_bf16_f32 v227, v224, v225
    v_fmac_f32 v255, v203, v203
    v_mfma_f32_16x16x32_bf16 v[222:225], v[238:241], v[36:39], 0
    s_cmp_lt_u32 s18, s45
    v_cvt_pk_bf16_f32 v36, v234, v235
    v_cvt_pk_bf16_f32 v37, v236, v237
    v_mfma_f32_16x16x32_bf16 v[222:225], v[190:193], v[218:221], v[222:225]
    v_cvt_pk_bf16_f32 v39, v208, 0
    v_fmac_f32 v255, v204, v204
    v_mfma_f32_16x16x32_bf16 v[114:117], a[232:235], v[118:121], v[114:117]
    v_exp_f32 v134, v134
    v_mfma_f32_16x16x32_bf16 v[182:185], v[28:31], v[36:39], 0
    v_exp_f32 v135, v135
    v_mfma_f32_16x16x32_bf16 v[182:185], v[28:31], v[158:161], v[182:185]
    v_cvt_pk_bf16_f32 v228, v134, v135
    v_fmac_f32 v255, v205, v205
    v_mfma_f32_16x16x32_bf16 v[230:233], v[142:145], v[36:39], 0
    v_exp_f32 v136, v136
    v_mfma_f32_16x16x32_bf16 v[230:233], v[126:129], v[158:161], v[230:233]
    v_exp_f32 v137, v137
    v_mfma_f32_16x16x32_bf16 v[170:173], v[210:213], v[36:39], 0
    v_exp_f32 v194, v194
    v_mfma_f32_16x16x32_bf16 v[170:173], v[130:133], v[158:161], v[170:173]
    v_rcp_f32 v182, v182
    v_mfma_f32_16x16x32_bf16 v[174:177], v[238:241], v[36:39], 0
    v_cvt_pk_bf16_f32 v229, v136, v137
    v_cvt_pk_bf16_f32 v39, v168, 0
    v_mfma_f32_16x16x32_bf16 v[174:177], v[190:193], v[158:161], v[174:177]
    v_mul_f32 v230, v182, v230
    v_mul_f32 v231, v182, v231
    v_mfma_f32_16x16x32_bf16 v[114:117], a[236:239], v[198:201], v[114:117]
    v_cvt_pk_bf16_f32 v134, v230, v231
    v_mul_f32 v232, v182, v232
    v_mfma_f32_16x16x32_bf16 v[166:169], a[240:243], v[150:153], 0
    ds_read_b128 v[214:217], v2 offset:12288
    v_mul_f32 v233, v182, v233
    v_mfma_f32_16x16x32_bf16 v[166:169], a[244:247], v[162:165], v[166:169]
    ds_read_b128 v[234:237], v2 offset:13312
    v_cvt_pk_bf16_f32 v135, v232, v233
    v_mfma_f32_16x16x32_bf16 v[166:169], a[248:251], v[186:189], v[166:169]
    ds_read_b128 v[218:221], v2 offset:14336
    v_fma_f32 v254, v114, v114, s33
    v_mfma_f32_16x16x32_bf16 v[166:169], a[252:255], v[138:141], v[166:169]
    ds_read_b128 v[158:161], v2 offset:15360
    v_fmac_f32 v254, v115, v115
    v_mfma_f32_16x16x32_bf16 v[166:169], v[82:85], v[118:121], v[166:169]
    ds_read_b128 v[206:209], v2 offset:16384
    v_fmac_f32 v254, v116, v116
    v_mfma_f32_16x16x32_bf16 v[166:169], v[86:89], v[198:201], v[166:169]
    ds_read_b128 v[242:245], v2 offset:17408
    v_fmac_f32 v254, v117, v117
    v_mfma_f32_16x16x32_bf16 v[230:233], v[90:93], v[150:153], 0
    v_mul_f32 v170, v182, v170
    v_mul_f32 v171, v182, v171
    v_mfma_f32_16x16x32_bf16 v[230:233], v[94:97], v[162:165], v[230:233]
    v_cvt_pk_bf16_f32 v136, v170, v171
    v_mul_f32 v172, v182, v172
    v_mfma_f32_16x16x32_bf16 v[230:233], v[98:101], v[186:189], v[230:233]
    s_waitcnt lgkmcnt(5)
    v_fmac_f32 v254, v166, v166
    v_fmac_f32 v254, v167, v167
    v_mfma_f32_16x16x32_bf16 v[230:233], v[102:105], v[138:141], v[230:233]
    s_waitcnt lgkmcnt(4)
    v_fmac_f32 v254, v168, v168
    v_fmac_f32 v254, v169, v169
    v_mfma_f32_16x16x32_bf16 v[230:233], v[106:109], v[118:121], v[230:233]
    s_waitcnt lgkmcnt(3)
    v_mul_f32 v173, v182, v173
    v_cvt_pk_bf16_f32 v137, v172, v173
    v_mfma_f32_16x16x32_bf16 v[230:233], v[110:113], v[198:201], v[230:233]
    s_waitcnt lgkmcnt(2)
    ds_write_b128 v3, v[134:137] offset:6144
    v_mfma_f32_16x16x32_bf16 v[150:153], a[216:219], v[214:217], 0
    s_waitcnt lgkmcnt(1)
    v_mul_f32 v174, v182, v174
    v_mul_f32 v175, v182, v175
    v_mfma_f32_16x16x32_bf16 v[150:153], a[220:223], v[234:237], v[150:153]
    v_cvt_pk_bf16_f32 v174, v174, v175
    v_fmac_f32 v254, v230, v230
    v_mfma_f32_16x16x32_bf16 v[150:153], a[224:227], v[218:221], v[150:153]
    v_fmac_f32 v254, v231, v231
    v_fmac_f32 v254, v232, v232
    v_mfma_f32_16x16x32_bf16 v[150:153], a[228:231], v[158:161], v[150:153]
    v_fmac_f32 v254, v233, v233
    v_cvt_pk_bf16_f32 v254, v255, v254
    v_mfma_f32_16x16x32_bf16 v[150:153], a[232:235], v[206:209], v[150:153]
    v_mul_f32 v176, v182, v176
    v_mul_f32 v177, v182, v177
    v_mfma_f32_16x16x32_bf16 v[150:153], a[236:239], v[242:245], v[150:153]
    v_cvt_pk_bf16_f32 v175, v176, v177
    v_xor_b32 v2, 65536, v2
    v_mfma_f32_16x16x32_bf16 v[162:165], a[240:243], v[214:217], 0
    ds_write_b64 v4, v[174:175] offset:10240
    v_mfma_f32_16x16x32_bf16 v[162:165], a[244:247], v[234:237], v[162:165]
    v_exp_f32 v195, v195
    v_mfma_f32_16x16x32_bf16 v[162:165], a[248:251], v[218:221], v[162:165]
    v_exp_f32 v196, v196
    v_mfma_f32_16x16x32_bf16 v[162:165], a[252:255], v[158:161], v[162:165]
    v_fma_f32 v255, v150, v150, s33
    v_fmac_f32 v255, v151, v151
    v_mfma_f32_16x16x32_bf16 v[162:165], v[82:85], v[206:209], v[162:165]
    v_fmac_f32 v255, v152, v152
    v_fmac_f32 v255, v153, v153
    v_mfma_f32_16x16x32_bf16 v[162:165], v[86:89], v[242:245], v[162:165]
    v_exp_f32 v197, v197
    v_mfma_f32_16x16x32_bf16 v[138:141], v[90:93], v[214:217], 0
    ds_read_b128 v[186:189], v0 offset:20480
    v_cvt_pk_bf16_f32 v36, v194, v195
    v_mfma_f32_16x16x32_bf16 v[138:141], v[94:97], v[234:237], v[138:141]
    ds_read_b128 v[118:121], v1 offset:20480
    v_cvt_pk_bf16_f32 v37, v196, v197
    v_mfma_f32_16x16x32_bf16 v[138:141], v[98:101], v[218:221], v[138:141]
    ds_read_b128 v[234:237], v0 offset:20608
    v_fmac_f32 v255, v162, v162
    v_mfma_f32_16x16x32_bf16 v[198:201], v[28:31], v[36:39], 0
    ds_read_b128 v[214:217], v9
    v_fmac_f32 v255, v163, v163
    v_mfma_f32_16x16x32_bf16 v[198:201], v[28:31], v[226:229], v[198:201]
    ds_read_b128 v[194:197], v9 offset:64
    v_fmac_f32 v255, v164, v164
    v_mfma_f32_16x16x32_bf16 v[170:173], v[142:145], v[36:39], 0
    v_rcp_f32 v178, v178
    v_mfma_f32_16x16x32_bf16 v[170:173], v[126:129], v[226:229], v[170:173]
    v_fmac_f32 v255, v165, v165
    v_mul_f32 v146, v178, v146
    v_mfma_f32_16x16x32_bf16 v[218:221], v[210:213], v[36:39], 0
    v_rcp_f32 v198, v198
    v_mfma_f32_16x16x32_bf16 v[218:221], v[130:133], v[226:229], v[218:221]
    s_waitcnt lgkmcnt(4)
    v_mul_f32 v147, v178, v147
    v_cvt_pk_bf16_f32 v146, v146, v147
    v_mfma_f32_16x16x32_bf16 v[174:177], v[238:241], v[36:39], 0
    s_waitcnt lgkmcnt(3)
    v_mul_f32 v170, v198, v170
    v_mul_f32 v171, v198, v171
    v_mfma_f32_16x16x32_bf16 v[174:177], v[190:193], v[226:229], v[174:177]
    s_waitcnt lgkmcnt(2)
    v_cvt_pk_bf16_f32 v226, v170, v171
    v_mul_f32 v172, v198, v172
    v_mfma_f32_16x16x32_bf16 v[138:141], v[102:105], v[158:161], v[138:141]
    s_waitcnt lgkmcnt(1)
    ds_read_b128 v[158:161], v1 offset:20608
    v_mul_f32 v173, v198, v173
    v_mfma_f32_16x16x32_bf16 v[138:141], v[106:109], v[206:209], v[138:141]
    s_waitcnt lgkmcnt(1)
    ds_read_b128 v[182:185], v0 offset:20736
    v_cvt_pk_bf16_f32 v227, v172, v173
    v_mfma_f32_16x16x32_bf16 v[138:141], v[110:113], v[242:245], v[138:141]
    ds_read_b128 v[206:209], v1 offset:20736
    v_mul_f32 v218, v198, v218
    v_mfma_f32_16x16x32_bf16 v[242:245], v[214:217], v[28:31], 0
    v_mul_f32 v219, v198, v219
    v_cvt_pk_bf16_f32 v228, v218, v219
    v_mfma_f32_16x16x32_bf16 v[242:245], v[194:197], v[28:31], v[242:245]
    v_mul_f32 v220, v198, v220
    v_mul_f32 v221, v198, v221
    v_mfma_f32_16x16x32_bf16 v[170:173], v[214:217], v[126:129], 0
    v_fmac_f32 v255, v138, v138
    v_fmac_f32 v255, v139, v139
    v_mfma_f32_16x16x32_bf16 v[170:173], v[194:197], v[142:145], v[170:173]
    v_fmac_f32 v255, v140, v140
    v_fmac_f32 v255, v141, v141
    v_mfma_f32_16x16x32_bf16 v[126:129], v[214:217], v[130:133], 0
    v_cvt_pk_bf16_f32 v255, v255, v255
    v_cvt_pk_bf16_f32 v229, v220, v221
    v_mfma_f32_16x16x32_bf16 v[126:129], v[194:197], v[210:213], v[126:129]
    s_waitcnt lgkmcnt(2)
    ds_write_b128 v3, v[226:229] offset:12288
    v_mfma_f32_16x16x32_bf16 v[130:133], v[214:217], v[190:193], 0
    s_waitcnt lgkmcnt(1)
    v_rcp_f32 v242, v242
    v_mfma_f32_16x16x32_bf16 v[130:133], v[194:197], v[238:241], v[130:133]
    v_mul_f32 v170, v170, v242
    v_mul_f32 v174, v198, v174
    v_mfma_f32_16x16x32_bf16 v[190:193], a[72:75], v[186:189], 0
    ds_write_b64 v4, v[254:255] offset:18432
    v_mfma_f32_16x16x32_bf16 v[190:193], a[76:79], v[118:121], v[190:193]
    v_mul_f32_dpp v170, v126, v242 quad_perm:[0,1,2,3] row_mask:0x2 bank_mask:0xf
    v_mul_f32 v175, v198, v175
    v_mfma_f32_16x16x32_bf16 v[190:193], a[80:83], v[234:237], v[190:193]
    v_mul_f32_dpp v170, v130, v242 quad_perm:[0,1,2,3] row_mask:0x4 bank_mask:0xf
    v_cvt_pk_bf16_f32 v170, v170, v170
    v_mfma_f32_16x16x32_bf16 v[190:193], a[84:87], v[158:161], v[190:193]
    ds_write_b16 v7, v170
    v_mfma_f32_16x16x32_bf16 v[190:193], a[88:91], v[182:185], v[190:193]
    v_cvt_pk_bf16_f32 v254, v174, v175
    v_mul_f32 v176, v198, v176
    v_mfma_f32_16x16x32_bf16 v[190:193], a[92:95], v[206:209], v[190:193]
    v_mul_f32 v177, v198, v177
    v_cvt_pk_bf16_f32 v255, v176, v177
    v_mfma_f32_16x16x32_bf16 v[130:133], a[96:99], v[186:189], 0
    ds_write_b64 v4, v[254:255] offset:16384
    v_mfma_f32_16x16x32_bf16 v[130:133], a[100:103], v[118:121], v[130:133]
    v_mul_f32 v148, v178, v148
    v_mul_f32 v149, v178, v149
    v_mfma_f32_16x16x32_bf16 v[130:133], a[104:107], v[234:237], v[130:133]
    v_cvt_pk_bf16_f32 v147, v148, v149
    v_mul_f32 v246, v178, v246
    v_mfma_f32_16x16x32_bf16 v[130:133], a[108:111], v[158:161], v[130:133]
    v_mul_f32 v247, v178, v247
    v_cvt_pk_bf16_f32 v148, v246, v247
    v_mfma_f32_16x16x32_bf16 v[130:133], a[112:115], v[182:185], v[130:133]
    v_mul_f32 v248, v178, v248
    v_mul_f32 v249, v178, v249
    v_mfma_f32_16x16x32_bf16 v[130:133], a[116:119], v[206:209], v[130:133]
    v_cvt_pk_bf16_f32 v149, v248, v249
    v_mul_f32 v222, v178, v222
    v_mfma_f32_16x16x32_bf16 v[126:129], a[120:123], v[186:189], 0
    ds_write_b128 v3, v[146:149] offset:0
    v_mfma_f32_16x16x32_bf16 v[126:129], a[124:127], v[118:121], v[126:129]
    v_mul_f32 v223, v178, v223
    v_cvt_pk_bf16_f32 v254, v222, v223
    v_mfma_f32_16x16x32_bf16 v[126:129], a[128:131], v[234:237], v[126:129]
    v_mul_f32 v224, v178, v224
    v_mul_f32 v225, v178, v225
    v_mfma_f32_16x16x32_bf16 v[126:129], a[132:135], v[158:161], v[126:129]
    v_cvt_pk_bf16_f32 v255, v224, v225
    v_xor_b32 v3, 65536, v3
    v_mfma_f32_16x16x32_bf16 v[126:129], a[136:139], v[182:185], v[126:129]
    ds_write_b64 v4, v[254:255] offset:4096
    v_mfma_f32_16x16x32_bf16 v[126:129], a[140:143], v[206:209], v[126:129]
    v_xor_b32 v4, 65536, v4
    v_cvt_pk_f16_f32 v194, v190, v191
    v_mfma_f32_16x16x32_bf16 v[142:145], a[0:3], v[186:189], 0
    v_pk_mul_f16 v191, v194, v194
    v_cvt_pk_f16_f32 v195, v192, v193
    v_mfma_f32_16x16x32_bf16 v[142:145], a[4:7], v[118:121], v[142:145]
    v_pk_fma_f16 v191, v195, v195, v191
    v_cvt_pk_f16_f32 v196, v130, v131
    v_mfma_f32_16x16x32_bf16 v[142:145], a[8:11], v[234:237], v[142:145]
    v_pk_fma_f16 v191, v196, v196, v191
    v_cvt_pk_f16_f32 v197, v132, v133
    v_mfma_f32_16x16x32_bf16 v[142:145], a[12:15], v[158:161], v[142:145]
    v_pk_fma_f16 v191, v197, v197, v191
    v_cvt_pk_f16_f32 v148, v126, v127
    v_mfma_f32_16x16x32_bf16 v[142:145], a[16:19], v[182:185], v[142:145]
    v_pk_fma_f16 v191, v148, v148, v191
    v_cvt_pk_f16_f32 v149, v128, v129
    v_mfma_f32_16x16x32_bf16 v[142:145], a[20:23], v[206:209], v[142:145]
    s_waitcnt lgkmcnt(0)
    v_pk_fma_f16 v191, v149, v149, v191
    v_add_u32 v7, s76, v7
    v_mfma_f32_16x16x32_bf16 v[126:129], a[24:27], v[186:189], 0
    s_nop 0
    v_mfma_f32_16x16x32_bf16 v[126:129], a[28:31], v[118:121], v[126:129]
    s_barrier
    v_mfma_f32_16x16x32_bf16 v[126:129], a[32:35], v[234:237], v[126:129]
    s_nop 0
    v_mfma_f32_16x16x32_bf16 v[126:129], a[36:39], v[158:161], v[126:129]
    s_nop 0
    v_mfma_f32_16x16x32_bf16 v[126:129], a[40:43], v[182:185], v[126:129]
    v_mfma_f32_16x16x32_bf16 v[126:129], a[44:47], v[206:209], v[126:129]
    s_cbranch_scc1 L_loop_fast1
    s_branch L_final_fast
.p2align 6
L_loop_fast2:
    v_mfma_f32_16x16x32_bf16 v[130:133], a[48:51], v[186:189], 0
    s_add_u32 s12, s40, s27
    ds_read_b128 v[246:249], v2 offset:18432
    v_cvt_pk_f16_f32 v222, v142, v143
    v_mfma_f32_16x16x32_bf16 v[130:133], a[52:55], v[118:121], v[130:133]
    s_addc_u32 s13, s41, 0
    ds_read_b128 v[210:213], v2 offset:19456
    v_pk_mul_f16 v190, v222, v222
    v_mfma_f32_16x16x32_bf16 v[130:133], a[56:59], v[234:237], v[130:133]
    s_sub_u32 s14, s36, s27
    ds_read_b128 v[238:241], v5 offset:32
    v_cvt_pk_f16_f32 v223, v144, v145
    v_mfma_f32_16x16x32_bf16 v[130:133], a[60:63], v[158:161], v[130:133]
    s_cmp_ge_u32 s18, 2
    ds_read2_b64 v[226:229], v5 offset0:6 offset1:9
    v_pk_fma_f16 v190, v223, v223, v190
    v_mfma_f32_16x16x32_bf16 v[130:133], a[64:67], v[182:185], v[130:133]
    s_cselect_b32 s14, s14, 0
    ds_read_b128 v[142:145], v5
    v_cvt_pk_f16_f32 v224, v126, v127
    v_mfma_f32_16x16x32_bf16 v[130:133], a[68:71], v[206:209], v[130:133]
    s_sub_u32 s82, s72, s71
    ds_read_b32 v254, v6 offset:192
    v_pk_fma_f16 v190, v224, v224, v190
    v_mfma_f32_16x16x32_bf16 v[198:201], v[186:189], a[144:147], 0
    s_mul_i32 s74, s82, 336
    v_cvt_pk_f16_f32 v225, v128, v129
    v_pk_fma_f16 v190, v225, v225, v190
    v_mfma_f32_16x16x32_bf16 v[198:201], v[118:121], a[148:151], v[198:201]
    s_mul_i32 s75, s82, 272
    v_cvt_pk_f16_f32 v146, v130, v131
    v_pk_fma_f16 v190, v146, v146, v190
    v_mfma_f32_16x16x32_bf16 v[198:201], v[234:237], a[152:155], v[198:201]
    s_waitcnt lgkmcnt(5)
    v_cvt_pk_f16_f32 v147, v132, v133
    v_pk_fma_f16 v190, v147, v147, v190
    v_mfma_f32_16x16x32_bf16 v[130:133], v[32:35], v[246:249], 0
    s_waitcnt lgkmcnt(4)
    v_add_u32 v5, s74, v5
    s_mul_i32 s76, s82, 16
    v_mfma_f32_16x16x32_bf16 v[130:133], v[32:35], v[210:213], v[130:133]
    s_waitcnt lgkmcnt(3)
    v_pk_mul_f16 v193, v194, v238
    v_pk_fma_f16 v193, v195, v239, v193
    v_mfma_f32_16x16x32_bf16 v[198:201], v[158:161], a[156:159], v[198:201]
    s_add_u32 s34, s18, 2
    v_pk_fma_f16 v193, v196, v240, v193
    v_pk_fma_f16 v193, v197, v241, v193
    v_mfma_f32_16x16x32_bf16 v[198:201], v[182:185], a[160:163], v[198:201]
    s_waitcnt lgkmcnt(1)
    v_pk_fma_f16 v193, v148, v228, v193
    v_pk_fma_f16 v193, v149, v229, v193
    v_mfma_f32_16x16x32_bf16 v[198:201], v[206:209], a[164:167], v[198:201]
    s_waitcnt lgkmcnt(0)
    v_mov_b32_dpp v254, v23 quad_perm:[0,1,2,3] row_mask:0x7 bank_mask:0xf
    v_pk_mul_f16 v192, v222, v142
    v_mfma_f32_16x16x32_bf16 v[210:213], v[186:189], a[168:171], 0
    s_add_u32 s8, s60, s23
    v_pk_fma_f16 v192, v223, v143, v192
    v_pk_fma_f16 v192, v224, v144, v192
    v_mfma_f32_16x16x32_bf16 v[210:213], v[118:121], a[172:175], v[210:213]
    s_addc_u32 s9, s61, 0
    v_pk_fma_f16 v192, v225, v145, v192
    v_pk_fma_f16 v192, v146, v226, v192
    v_mfma_f32_16x16x32_bf16 v[210:213], v[234:237], a[176:179], v[210:213]
    s_sub_u32 s10, s36, s23
    ds_read_b128 v[246:249], v0 offset:26624
    v_pk_fma_f16 v192, v147, v227, v192
    v_mfma_f32_16x16x32_bf16 v[210:213], v[158:161], a[180:183], v[210:213]
    s_cmp_le_u32 s34, s45
    ds_read_b128 v[174:177], v1 offset:26624
    v_cvt_pk_bf16_f32 v126, v198, v199
    v_mfma_f32_16x16x32_f16 v[214:217], v[40:43], v[190:193], 0
    s_cselect_b32 s10, s10, 0
    v_cvt_pk_bf16_f32 v127, v200, v201
    v_mul_f32 v255, 0x3baaaaab, v130
    v_mfma_f32_16x16x32_bf16 v[210:213], v[182:185], a[184:187], v[210:213]
    s_add_u32 m0, s28, 0
    ds_read_b128 v[198:201], v0 offset:26752
    v_mul_f32 v134, 0x3baaaaab, v131
    v_mfma_f32_16x16x32_bf16 v[210:213], v[206:209], a[188:191], v[210:213]
    s_mov_b32 s27, s26
    ds_read_b128 v[242:245], v1 offset:26752
    v_mul_f32 v132, 0x3baaaaab, v132
    v_mfma_f32_16x16x32_bf16 v[190:193], v[186:189], a[192:195], 0
    s_mov_b32 s26, s25
    ds_read_b128 v[186:189], v0 offset:26880
    s_mov_b32 s25, s24
    v_mfma_f32_16x16x32_bf16 v[190:193], v[118:121], a[196:199], v[190:193]
    s_mov_b32 s24, s23
    ds_read_b128 v[118:121], v1 offset:26880
    v_cvt_pk_bf16_f32 v130, v210, v211
    v_mfma_f32_16x16x32_bf16 v[190:193], v[234:237], a[200:203], v[190:193]
    s_ff1_i32_b32 s80, s100
    v_rsq_f32 v214, v214
    v_mfma_f32_16x16x32_bf16 v[190:193], v[158:161], a[204:207], v[190:193]
    s_waitcnt lgkmcnt(5)
    v_rsq_f32 v215, v215
    v_mfma_f32_16x16x32_bf16 v[190:193], v[182:185], a[208:211], v[190:193]
    s_mov_b32 s71, s72
    v_mul_f32 v128, s31, v214
    v_cvt_pk_f16_f32 v129, v128, v215
    v_mfma_f32_16x16x32_bf16 v[190:193], v[206:209], a[212:215], v[190:193]
    s_mov_b32 s72, s73
    v_cvt_pk_bf16_f32 v131, v212, v213
    v_fma_f32 v216, v216, v128, v22
    v_mfma_f32_16x16x32_bf16 v[210:213], a[72:75], v[246:249], 0
    s_waitcnt lgkmcnt(3)
    v_fmac_f32_dpp v254, v217, v215 quad_perm:[0,1,2,3] row_mask:0x1 bank_mask:0xf
    v_pk_mul_f16 v194, v194, v129 op_sel:[0,1] op_sel_hi:[1,1]
    v_mfma_f32_16x16x32_bf16 v[210:213], a[76:79], v[174:177], v[210:213]
    s_waitcnt lgkmcnt(2)
    v_cvt_pk_bf16_f32 v190, v190, v191
    v_cvt_pk_bf16_f32 v191, v192, v193
    v_mfma_f32_16x16x32_bf16 v[210:213], a[80:83], v[198:201], v[210:213]
    s_waitcnt lgkmcnt(1)
    v_pk_mul_f16 v195, v195, v129 op_sel:[0,1] op_sel_hi:[1,1]
    v_pk_mul_f16 v196, v196, v129 op_sel:[0,1] op_sel_hi:[1,1]
    v_mfma_f32_16x16x32_bf16 v[210:213], a[84:87], v[242:245], v[210:213]
    s_waitcnt lgkmcnt(0)
    v_pk_mul_f16 v197, v197, v129 op_sel:[0,1] op_sel_hi:[1,1]
    v_pk_mul_f16 v148, v148, v129 op_sel:[0,1] op_sel_hi:[1,1]
    v_mfma_f32_16x16x32_bf16 v[210:213], a[88:91], v[186:189], v[210:213]
    v_pk_mul_f16 v149, v149, v129 op_sel:[0,1] op_sel_hi:[1,1]
    v_pk_mul_f16 v222, v222, v129 op_sel:[0,0] op_sel_hi:[1,0]
    v_mfma_f32_16x16x32_bf16 v[210:213], a[92:95], v[118:121], v[210:213]
    v_pk_mul_f16 v223, v223, v129 op_sel:[0,0] op_sel_hi:[1,0]
    v_pk_mul_f16 v224, v224, v129 op_sel:[0,0] op_sel_hi:[1,0]
    v_mfma_f32_16x16x32_bf16 v[206:209], a[96:99], v[246:249], 0
    v_pk_mul_f16 v225, v225, v129 op_sel:[0,0] op_sel_hi:[1,0]
    v_pk_mul_f16 v146, v146, v129 op_sel:[0,0] op_sel_hi:[1,0]
    v_mfma_f32_16x16x32_bf16 v[206:209], a[100:103], v[174:177], v[206:209]
    v_pk_mul_f16 v147, v147, v129 op_sel:[0,0] op_sel_hi:[1,0]
    v_max3_u32 v44, v44, v214, v215
    v_mfma_f32_16x16x32_bf16 v[206:209], a[104:107], v[198:201], v[206:209]
    v_rsq_f32 v255, v255
    v_mfma_f32_16x16x32_bf16 v[206:209], a[108:111], v[242:245], v[206:209]
    v_rsq_f32 v134, v134
    v_mfma_f32_16x16x32_bf16 v[206:209], a[112:115], v[186:189], v[206:209]
    v_rsq_f32 v132, v132
    v_mfma_f32_16x16x32_bf16 v[206:209], a[116:119], v[118:121], v[206:209]
    v_mul_f32 v122, v255, v122
    v_mul_f32 v123, v255, v123
    v_mfma_f32_16x16x32_bf16 v[234:237], a[120:123], v[246:249], 0
    v_cvt_pk_bf16_f32 v122, v122, v123
    v_mul_f32 v124, v255, v124
    v_mfma_f32_16x16x32_bf16 v[234:237], a[124:127], v[174:177], v[234:237]
    v_mul_f32 v125, v255, v125
    v_cvt_pk_bf16_f32 v123, v124, v125
    v_mfma_f32_16x16x32_bf16 v[234:237], a[128:131], v[198:201], v[234:237]
    v_mul_f32 v154, v255, v154
    v_mul_f32 v155, v255, v155
    v_mfma_f32_16x16x32_bf16 v[234:237], a[132:135], v[242:245], v[234:237]
    v_cvt_pk_bf16_f32 v124, v154, v155
    v_mul_f32 v156, v255, v156
    v_mfma_f32_16x16x32_bf16 v[234:237], a[136:139], v[186:189], v[234:237]
    v_mul_f32 v157, v255, v157
    v_cvt_pk_bf16_f32 v125, v156, v157
    v_mfma_f32_16x16x32_bf16 v[234:237], a[140:143], v[118:121], v[234:237]
    buffer_store_dwordx4 v[122:125], v15, s[12:15], 0 offen nt
    v_mul_f32 v202, v255, v202
    v_mul_f32 v203, v255, v203
    v_cvt_pk_bf16_f32 v128, v202, v203
    v_mul_f32 v204, v255, v204
    v_mfma_f32_16x16x32_bf16 v[122:125], a[0:3], v[246:249], 0
    v_mul_f32 v205, v255, v205
    v_cvt_pk_bf16_f32 v129, v204, v205
    v_mfma_f32_16x16x32_bf16 v[122:125], a[4:7], v[174:177], v[122:125]
    v_cvt_pk_f16_f32 v202, v210, v211
    v_pk_mul_f16 v211, v202, v202
    v_mfma_f32_16x16x32_bf16 v[122:125], a[8:11], v[198:201], v[122:125]
    v_cvt_pk_f16_f32 v203, v212, v213
    v_pk_fma_f16 v211, v203, v203, v211
    v_mfma_f32_16x16x32_bf16 v[122:125], a[12:15], v[242:245], v[122:125]
    v_cvt_pk_f16_f32 v204, v206, v207
    v_pk_fma_f16 v211, v204, v204, v211
    v_mfma_f32_16x16x32_bf16 v[122:125], a[16:19], v[186:189], v[122:125]
    v_cvt_pk_f16_f32 v205, v208, v209
    v_pk_fma_f16 v211, v205, v205, v211
    v_mfma_f32_16x16x32_bf16 v[122:125], a[20:23], v[118:121], v[122:125]
    v_cvt_pk_f16_f32 v160, v234, v235
    v_pk_fma_f16 v211, v160, v160, v211
    v_mfma_f32_16x16x32_bf16 v[154:157], a[24:27], v[246:249], 0
    v_cvt_pk_f16_f32 v161, v236, v237
    v_pk_fma_f16 v211, v161, v161, v211
    v_mfma_f32_16x16x32_bf16 v[154:157], a[28:31], v[174:177], v[154:157]
    v_pk_mul_f16 v213, v202, v238
    v_pk_fma_f16 v213, v203, v239, v213
    v_mfma_f32_16x16x32_bf16 v[154:157], a[32:35], v[198:201], v[154:157]
    v_cvt_pk_f16_f32 v122, v122, v123
    v_pk_mul_f16 v210, v122, v122
    v_mfma_f32_16x16x32_bf16 v[154:157], a[36:39], v[242:245], v[154:157]
    v_cvt_pk_f16_f32 v123, v124, v125
    v_pk_fma_f16 v210, v123, v123, v210
    v_mfma_f32_16x16x32_bf16 v[154:157], a[40:43], v[186:189], v[154:157]
    v_pk_mul_f16 v212, v122, v142
    v_pk_fma_f16 v212, v123, v143, v212
    v_mfma_f32_16x16x32_bf16 v[154:157], a[44:47], v[118:121], v[154:157]
    v_pk_fma_f16 v213, v204, v240, v213
    v_pk_fma_f16 v213, v205, v241, v213
    v_mfma_f32_16x16x32_bf16 v[206:209], a[48:51], v[246:249], 0
    v_pk_fma_f16 v213, v160, v228, v213
    v_pk_fma_f16 v213, v161, v229, v213
    v_mfma_f32_16x16x32_bf16 v[206:209], a[52:55], v[174:177], v[206:209]
    v_mul_f32 v150, v132, v150
    v_mul_f32 v151, v132, v151
    v_mfma_f32_16x16x32_bf16 v[206:209], a[56:59], v[198:201], v[206:209]
    v_cvt_pk_f16_f32 v124, v154, v155
    v_pk_fma_f16 v210, v124, v124, v210
    v_mfma_f32_16x16x32_bf16 v[206:209], a[60:63], v[242:245], v[206:209]
    v_cvt_pk_f16_f32 v125, v156, v157
    v_pk_fma_f16 v210, v125, v125, v210
    v_mfma_f32_16x16x32_bf16 v[206:209], a[64:67], v[186:189], v[206:209]
    buffer_store_dwordx2 v[128:129], v18, s[12:15], 0 offen nt
    v_pk_fma_f16 v212, v124, v144, v212
    v_pk_fma_f16 v212, v125, v145, v212
    v_mfma_f32_16x16x32_bf16 v[206:209], a[68:71], v[118:121], v[206:209]
    v_cvt_pk_bf16_f32 v150, v150, v151
    v_mul_f32 v152, v132, v152
    v_mfma_f32_16x16x32_bf16 v[154:157], v[246:249], a[144:147], 0
    v_mul_f32 v153, v132, v153
    v_cvt_pk_bf16_f32 v151, v152, v153
    v_mfma_f32_16x16x32_bf16 v[154:157], v[174:177], a[148:151], v[154:157]
    v_mul_f32 v162, v132, v162
    v_mul_f32 v163, v132, v163
    v_mfma_f32_16x16x32_bf16 v[154:157], v[198:201], a[152:155], v[154:157]
    v_cvt_pk_f16_f32 v158, v206, v207
    v_pk_fma_f16 v210, v158, v158, v210
    v_mfma_f32_16x16x32_bf16 v[154:157], v[242:245], a[156:159], v[154:157]
    v_cvt_pk_f16_f32 v159, v208, v209
    v_pk_fma_f16 v210, v159, v159, v210
    v_mfma_f32_16x16x32_bf16 v[154:157], v[186:189], a[160:163], v[154:157]
    v_pk_fma_f16 v212, v158, v226, v212
    v_pk_fma_f16 v212, v159, v227, v212
    v_mfma_f32_16x16x32_bf16 v[154:157], v[118:121], a[164:167], v[154:157]
    v_cvt_pk_bf16_f32 v152, v162, v163
    v_mul_f32 v164, v132, v164
    v_mfma_f32_16x16x32_f16 v[206:209], v[40:43], v[210:213], 0
    v_mul_f32 v165, v132, v165
    v_cvt_pk_bf16_f32 v153, v164, v165
    v_mfma_f32_16x16x32_bf16 v[210:213], v[246:249], a[168:171], 0
    v_mul_f32 v138, v132, v138
    v_mul_f32 v139, v132, v139
    v_mfma_f32_16x16x32_bf16 v[210:213], v[174:177], a[172:175], v[210:213]
    v_cvt_pk_bf16_f32 v128, v154, v155
    v_cvt_pk_bf16_f32 v129, v156, v157
    v_mfma_f32_16x16x32_bf16 v[210:213], v[198:201], a[176:179], v[210:213]
    ds_read_b128 v[154:157], v0 offset:32768
    v_cvt_pk_bf16_f32 v136, v138, v139
    v_mfma_f32_16x16x32_bf16 v[210:213], v[242:245], a[180:183], v[210:213]
    ds_read_b128 v[162:165], v1 offset:32768
    v_mul_f32 v140, v132, v140
    v_mfma_f32_16x16x32_bf16 v[210:213], v[186:189], a[184:187], v[210:213]
    ds_read_b128 v[218:221], v0 offset:32896
    v_mul_f32 v141, v132, v141
    v_mfma_f32_16x16x32_bf16 v[210:213], v[118:121], a[188:191], v[210:213]
    ds_read_b128 v[234:237], v1 offset:32896
    v_cvt_pk_bf16_f32 v137, v140, v141
    v_mfma_f32_16x16x32_bf16 v[182:185], v[246:249], a[192:195], 0
    ds_read_b128 v[138:141], v0 offset:33024
    v_mul_f32 v114, v134, v114
    v_mfma_f32_16x16x32_bf16 v[182:185], v[174:177], a[196:199], v[182:185]
    ds_read_b128 v[246:249], v1 offset:33024
    v_mul_f32 v115, v134, v115
    v_mfma_f32_16x16x32_bf16 v[182:185], v[198:201], a[200:203], v[182:185]
    buffer_store_dwordx4 v[150:153], v17, s[12:15], 0 offen nt
    v_rsq_f32 v206, v206
    v_rsq_f32 v207, v207
    v_mfma_f32_16x16x32_bf16 v[182:185], v[242:245], a[204:207], v[182:185]
    s_waitcnt lgkmcnt(5)
    v_mul_f32 v214, s31, v206
    v_cvt_pk_f16_f32 v215, v214, v207
    v_mfma_f32_16x16x32_bf16 v[182:185], v[186:189], a[208:211], v[182:185]
    s_waitcnt lgkmcnt(4)
    v_fma_f32 v208, v208, v214, v24
    v_fmac_f32_dpp v254, v209, v207 quad_perm:[0,1,2,3] row_mask:0x2 bank_mask:0xf
    v_mfma_f32_16x16x32_bf16 v[182:185], v[118:121], a[212:215], v[182:185]
    s_waitcnt lgkmcnt(3)
    v_cvt_pk_bf16_f32 v132, v210, v211
    v_cvt_pk_bf16_f32 v133, v212, v213
    v_mfma_f32_16x16x32_bf16 v[210:213], a[72:75], v[154:157], 0
    s_waitcnt lgkmcnt(2)
    v_pk_mul_f16 v202, v202, v215 op_sel:[0,1] op_sel_hi:[1,1]
    v_pk_mul_f16 v203, v203, v215 op_sel:[0,1] op_sel_hi:[1,1]
    v_mfma_f32_16x16x32_bf16 v[210:213], a[76:79], v[162:165], v[210:213]
    s_waitcnt lgkmcnt(1)
    v_cvt_pk_bf16_f32 v192, v182, v183
    v_cvt_pk_bf16_f32 v193, v184, v185
    v_mfma_f32_16x16x32_bf16 v[210:213], a[80:83], v[218:221], v[210:213]
    s_waitcnt lgkmcnt(0)
    v_pk_mul_f16 v204, v204, v215 op_sel:[0,1] op_sel_hi:[1,1]
    v_pk_mul_f16 v205, v205, v215 op_sel:[0,1] op_sel_hi:[1,1]
    v_mfma_f32_16x16x32_bf16 v[210:213], a[84:87], v[234:237], v[210:213]
    v_pk_mul_f16 v160, v160, v215 op_sel:[0,1] op_sel_hi:[1,1]
    v_pk_mul_f16 v161, v161, v215 op_sel:[0,1] op_sel_hi:[1,1]
    v_mfma_f32_16x16x32_bf16 v[210:213], a[88:91], v[138:141], v[210:213]
    v_pk_mul_f16 v122, v122, v215 op_sel:[0,0] op_sel_hi:[1,0]
    v_pk_mul_f16 v123, v123, v215 op_sel:[0,0] op_sel_hi:[1,0]
    v_mfma_f32_16x16x32_bf16 v[210:213], a[92:95], v[246:249], v[210:213]
    v_pk_mul_f16 v124, v124, v215 op_sel:[0,0] op_sel_hi:[1,0]
    v_pk_mul_f16 v125, v125, v215 op_sel:[0,0] op_sel_hi:[1,0]
    v_mfma_f32_16x16x32_bf16 v[118:121], a[96:99], v[154:157], 0
    v_pk_mul_f16 v158, v158, v215 op_sel:[0,0] op_sel_hi:[1,0]
    v_pk_mul_f16 v159, v159, v215 op_sel:[0,0] op_sel_hi:[1,0]
    v_mfma_f32_16x16x32_bf16 v[118:121], a[100:103], v[162:165], v[118:121]
    v_max3_u32 v44, v44, v206, v207
    v_cvt_pk_bf16_f32 v114, v114, v115
    v_mfma_f32_16x16x32_bf16 v[118:121], a[104:107], v[218:221], v[118:121]
    v_cvt_pk_f16_f32 v186, v210, v211
    v_pk_mul_f16 v211, v186, v186
    v_mfma_f32_16x16x32_bf16 v[118:121], a[108:111], v[234:237], v[118:121]
    s_waitcnt vmcnt(3)
    ds_write_b16 v8, v45 offset:512
    v_mfma_f32_16x16x32_bf16 v[118:121], a[112:115], v[138:141], v[118:121]
    v_cvt_pk_f16_f32 v187, v212, v213
    v_mfma_f32_16x16x32_bf16 v[118:121], a[116:119], v[246:249], v[118:121]
    v_pk_fma_f16 v211, v187, v187, v211
    v_pk_mul_f16 v213, v186, v238
    v_mfma_f32_16x16x32_bf16 v[150:153], a[120:123], v[154:157], 0
    v_pk_fma_f16 v213, v187, v239, v213
    v_mul_f32 v116, v134, v116
    v_mfma_f32_16x16x32_bf16 v[150:153], a[124:127], v[162:165], v[150:153]
    buffer_store_dwordx2 v[136:137], v20, s[12:15], 0 offen nt
    v_exp_f32 v208, v208
    v_mfma_f32_16x16x32_bf16 v[150:153], a[128:131], v[218:221], v[150:153]
    v_cvt_pk_f16_f32 v188, v118, v119
    v_pk_fma_f16 v211, v188, v188, v211
    v_mfma_f32_16x16x32_bf16 v[150:153], a[132:135], v[234:237], v[150:153]
    v_cvt_pk_f16_f32 v189, v120, v121
    v_pk_fma_f16 v211, v189, v189, v211
    v_mfma_f32_16x16x32_bf16 v[150:153], a[136:139], v[138:141], v[150:153]
    s_waitcnt lgkmcnt(0)
    v_pk_fma_f16 v213, v188, v240, v213
    v_pk_fma_f16 v213, v189, v241, v213
    v_mfma_f32_16x16x32_bf16 v[150:153], a[140:143], v[246:249], v[150:153]
    v_mul_f32 v117, v134, v117
    v_mfma_f32_16x16x32_bf16 v[238:241], a[0:3], v[154:157], 0
    v_cvt_pk_bf16_f32 v115, v116, v117
    v_mfma_f32_16x16x32_bf16 v[238:241], a[4:7], v[162:165], v[238:241]
    s_barrier
    v_mul_f32 v166, v134, v166
    v_mfma_f32_16x16x32_bf16 v[238:241], a[8:11], v[218:221], v[238:241]
    ds_read_u16 v255, v9 offset:256
    v_mfma_f32_16x16x32_bf16 v[238:241], a[12:15], v[234:237], v[238:241]
    v_cvt_pk_f16_f32 v120, v150, v151
    v_pk_fma_f16 v211, v120, v120, v211
    v_mfma_f32_16x16x32_bf16 v[238:241], a[16:19], v[138:141], v[238:241]
    v_cvt_pk_f16_f32 v121, v152, v153
    v_pk_fma_f16 v211, v121, v121, v211
    v_mfma_f32_16x16x32_bf16 v[238:241], a[20:23], v[246:249], v[238:241]
    v_pk_fma_f16 v213, v120, v228, v213
    v_pk_fma_f16 v213, v121, v229, v213
    v_mfma_f32_16x16x32_bf16 v[150:153], a[24:27], v[154:157], 0
    v_exp_f32 v216, v216
    v_mfma_f32_16x16x32_bf16 v[150:153], a[28:31], v[162:165], v[150:153]
    v_cvt_pk_bf16_f32 v39, v216, 0
    v_mul_f32 v167, v134, v167
    v_mfma_f32_16x16x32_bf16 v[150:153], a[32:35], v[218:221], v[150:153]
    v_cvt_pk_f16_f32 v198, v238, v239
    v_pk_mul_f16 v210, v198, v198
    v_mfma_f32_16x16x32_bf16 v[150:153], a[36:39], v[234:237], v[150:153]
    v_cvt_pk_f16_f32 v199, v240, v241
    v_pk_fma_f16 v210, v199, v199, v210
    v_mfma_f32_16x16x32_bf16 v[150:153], a[40:43], v[138:141], v[150:153]
    s_waitcnt lgkmcnt(0)
    v_readfirstlane_b32 s77, v255
    v_pk_mul_f16 v212, v198, v142
    v_mfma_f32_16x16x32_bf16 v[150:153], a[44:47], v[246:249], v[150:153]
    v_pk_fma_f16 v212, v199, v143, v212
    v_cvt_pk_bf16_f32 v116, v166, v167
    v_mfma_f32_16x16x32_bf16 v[238:241], a[48:51], v[154:157], 0
    buffer_load_dwordx4 v10, s[8:11], 0 offen nt lds
    v_mul_f32 v168, v134, v168
    v_mfma_f32_16x16x32_bf16 v[238:241], a[52:55], v[162:165], v[238:241]
    s_add_u32 m0, s28, 4096
    v_mul_f32 v169, v134, v169
    v_cvt_pk_f16_f32 v200, v150, v151
    v_mfma_f32_16x16x32_bf16 v[238:241], a[56:59], v[218:221], v[238:241]
    v_pk_fma_f16 v210, v200, v200, v210
    v_cvt_pk_f16_f32 v201, v152, v153
    v_mfma_f32_16x16x32_bf16 v[238:241], a[60:63], v[234:237], v[238:241]
    ds_read_b128 v[242:245], v2 offset:0
    v_pk_fma_f16 v210, v201, v201, v210
    v_mfma_f32_16x16x32_bf16 v[238:241], a[64:67], v[138:141], v[238:241]
    ds_read_b128 v[174:177], v2 offset:1024
    v_pk_fma_f16 v212, v200, v144, v212
    v_mfma_f32_16x16x32_bf16 v[238:241], a[68:71], v[246:249], v[238:241]
    ds_read_b128 v[170:173], v2 offset:2048
    buffer_load_dwordx4 v11, s[8:11], 0 offen nt lds
    v_mfma_f32_16x16x32_bf16 v[150:153], v[154:157], a[144:147], 0
    s_add_u32 m0, s28, 8192
    ds_read_b128 v[214:217], v2 offset:3072
    v_pk_fma_f16 v212, v201, v145, v212
    v_mfma_f32_16x16x32_bf16 v[150:153], v[162:165], a[148:151], v[150:153]
    ds_read_b128 v[182:185], v2 offset:4096
    v_cvt_pk_f16_f32 v118, v238, v239
    v_mfma_f32_16x16x32_bf16 v[150:153], v[218:221], a[152:155], v[150:153]
    ds_read_b128 v[178:181], v2 offset:5120
    v_pk_fma_f16 v210, v118, v118, v210
    v_mfma_f32_16x16x32_bf16 v[150:153], v[234:237], a[156:159], v[150:153]
    v_cvt_pk_f16_f32 v119, v240, v241
    v_pk_fma_f16 v210, v119, v119, v210
    v_mfma_f32_16x16x32_bf16 v[150:153], v[138:141], a[160:163], v[150:153]
    buffer_load_dwordx4 v12, s[8:11], 0 offen nt lds
    v_pk_fma_f16 v212, v118, v226, v212
    v_mfma_f32_16x16x32_bf16 v[150:153], v[246:249], a[164:167], v[150:153]
    s_waitcnt lgkmcnt(5)
    v_pk_fma_f16 v212, v119, v227, v212
    v_cvt_pk_bf16_f32 v117, v168, v169
    v_mfma_f32_16x16x32_bf16 v[226:229], v[154:157], a[168:171], 0
    s_add_u32 m0, s28, 12288
    v_mul_f32 v230, v134, v230
    v_mul_f32 v231, v134, v231
    v_mfma_f32_16x16x32_f16 v[166:169], v[40:43], v[210:213], 0
    s_xor_b32 s28, s28, 65536
    v_cvt_pk_bf16_f32 v142, v150, v151
    v_cvt_pk_bf16_f32 v143, v152, v153
    v_mfma_f32_16x16x32_bf16 v[226:229], v[162:165], a[172:175], v[226:229]
    s_waitcnt lgkmcnt(2)
    ds_read2_b32 v[144:145], v6 offset0:0 offset1:0
    v_cvt_pk_bf16_f32 v230, v230, v231
    v_mfma_f32_16x16x32_bf16 v[226:229], v[218:221], a[176:179], v[226:229]
    s_waitcnt lgkmcnt(2)
    buffer_load_dwordx4 v13, s[8:11], 0 offen nt lds
    ds_read2_b32 v[212:213], v6 offset0:16 offset1:16
    v_mfma_f32_16x16x32_bf16 v[226:229], v[234:237], a[180:183], v[226:229]
    s_mov_b32 m0, s29
    ds_read2_b32 v[240:241], v6 offset0:32 offset1:32
    v_mul_f32 v232, v134, v232
    v_mfma_f32_16x16x32_bf16 v[226:229], v[138:141], a[184:187], v[226:229]
    s_xor_b32 s29, s29, s30
    v_rsq_f32 v166, v166
    v_mfma_f32_16x16x32_bf16 v[226:229], v[246:249], a[188:191], v[226:229]
    s_add_u32 s19, s19, s20
    v_rsq_f32 v167, v167
    v_mfma_f32_16x16x32_bf16 v[150:153], v[154:157], a[192:195], 0
    s_add_u32 s23, s23, s21
    v_mul_f32 v136, s31, v166
    v_cvt_pk_f16_f32 v137, v136, v167
    v_mfma_f32_16x16x32_bf16 v[150:153], v[162:165], a[196:199], v[150:153]
    s_waitcnt lgkmcnt(3)
    v_fma_f32 v168, v168, v136, v26
    v_mfma_f32_16x16x32_bf16 v[150:153], v[218:221], a[200:203], v[150:153]
    s_cmp_ge_u32 s19, 72
    v_fmac_f32_dpp v254, v169, v167 quad_perm:[0,1,2,3] row_mask:0x4 bank_mask:0xf
    v_cvt_pk_bf16_f32 v210, v226, v227
    v_mfma_f32_16x16x32_bf16 v[150:153], v[234:237], a[204:207], v[150:153]
    s_cselect_b32 s34, 72, 0
    v_cvt_pk_bf16_f32 v211, v228, v229
    v_pk_mul_f16 v186, v186, v137 op_sel:[0,1] op_sel_hi:[1,1]
    v_mfma_f32_16x16x32_bf16 v[150:153], v[138:141], a[208:211], v[150:153]
    s_cselect_b32 s35, s22, 0
    v_pk_mul_f16 v187, v187, v137 op_sel:[0,1] op_sel_hi:[1,1]
    v_pk_mul_f16 v188, v188, v137 op_sel:[0,1] op_sel_hi:[1,1]
    v_mfma_f32_16x16x32_bf16 v[150:153], v[246:249], a[212:215], v[150:153]
    s_sub_u32 s19, s19, s34
    v_pk_mul_f16 v189, v189, v137 op_sel:[0,1] op_sel_hi:[1,1]
    v_pk_mul_f16 v120, v120, v137 op_sel:[0,1] op_sel_hi:[1,1]
    v_mfma_f32_16x16x32_f16 v[154:157], v[194:197], v[222:225], v[46:49]
    s_waitcnt lgkmcnt(0)
    buffer_store_dwordx4 v[114:117], v16, s[12:15], 0 offen nt
    v_pk_mul_f16 v121, v121, v137 op_sel:[0,1] op_sel_hi:[1,1]
    v_pk_mul_f16 v198, v198, v137 op_sel:[0,0] op_sel_hi:[1,0]
    v_cvt_pk_bf16_f32 v238, v150, v151
    v_cvt_pk_bf16_f32 v239, v152, v153
    v_mfma_f32_16x16x32_f16 v[114:117], v[202:205], v[222:225], v[50:53]
    s_add_u32 s23, s23, s35
    v_pk_mul_f16 v199, v199, v137 op_sel:[0,0] op_sel_hi:[1,0]
    v_pk_mul_f16 v200, v200, v137 op_sel:[0,0] op_sel_hi:[1,0]
    v_mfma_f32_16x16x32_f16 v[246:249], v[186:189], v[222:225], v[54:57]
    s_cmp_lg_u32 s83, 0
    v_pk_mul_f16 v201, v201, v137 op_sel:[0,0] op_sel_hi:[1,0]
    v_pk_mul_f16 v118, v118, v137 op_sel:[0,0] op_sel_hi:[1,0]
    v_pk_mul_f16 v119, v119, v137 op_sel:[0,0] op_sel_hi:[1,0]
    v_mfma_f32_16x16x16_f16 v[154:157], v[148:149], v[146:147], v[154:157]
    v_max3_u32 v44, v44, v166, v167
    v_exp_f32 v254, v254
    v_mfma_f32_16x16x16_f16 v[114:117], v[160:161], v[146:147], v[114:117]
    v_cvt_pk_bf16_f32 v254, v254, v254
    v_exp_f32 v168, v168
    v_mfma_f32_16x16x16_f16 v[246:249], v[120:121], v[146:147], v[246:249]
    v_mul_f32 v233, v134, v233
    v_cvt_pk_bf16_f32 v231, v232, v233
    v_exp_f32 v154, v154
    v_mfma_f32_16x16x32_f16 v[162:165], v[194:197], v[122:125], v[58:61]
    s_cselect_b32 s77, s80, s77
    ds_write_b16 v8, v254
    v_mfma_f32_16x16x32_f16 v[138:141], v[202:205], v[122:125], v[62:65]
    s_mul_i32 s78, s77, 2688
    v_exp_f32 v155, v155
    v_mfma_f32_16x16x32_f16 v[234:237], v[186:189], v[122:125], v[66:69]
    s_add_u32 s78, s78, s69
    v_cvt_pk_bf16_f32 v218, v154, v155
    v_exp_f32 v156, v156
    v_mfma_f32_16x16x16_f16 v[162:165], v[148:149], v[158:159], v[162:165]
    v_exp_f32 v157, v157
    v_xor_b32 v0, 65536, v0
    v_mfma_f32_16x16x16_f16 v[138:141], v[160:161], v[158:159], v[138:141]
    v_cvt_pk_bf16_f32 v219, v156, v157
    v_exp_f32 v114, v114
    v_mfma_f32_16x16x16_f16 v[234:237], v[120:121], v[158:159], v[234:237]
    v_exp_f32 v115, v115
    v_exp_f32 v116, v116
    v_mfma_f32_16x16x32_bf16 v[122:125], a[216:219], v[242:245], 0
    s_add_u32 s80, s77, s68
    v_exp_f32 v162, v162
    v_mfma_f32_16x16x32_bf16 v[122:125], a[220:223], v[174:177], v[122:125]
    s_cmp_ge_u32 s80, 72
    v_exp_f32 v163, v163
    v_mfma_f32_16x16x32_f16 v[222:225], v[194:197], v[198:201], v[70:73]
    s_cselect_b32 s80, s22, 0
    v_cvt_pk_bf16_f32 v158, v162, v163
    v_cvt_pk_bf16_f32 v220, v114, v115
    v_mfma_f32_16x16x32_f16 v[134:137], v[202:205], v[198:201], v[74:77]
    s_add_u32 s78, s78, s80
    v_exp_f32 v164, v164
    v_mfma_f32_16x16x32_f16 v[194:197], v[186:189], v[198:201], v[78:81]
    buffer_store_dwordx2 v[230:231], v19, s[12:15], 0 offen nt
    v_exp_f32 v165, v165
    v_mfma_f32_16x16x16_f16 v[222:225], v[148:149], v[118:119], v[222:225]
    v_cvt_pk_bf16_f32 v159, v164, v165
    v_exp_f32 v138, v138
    v_mfma_f32_16x16x16_f16 v[134:137], v[160:161], v[118:119], v[134:137]
    v_exp_f32 v139, v139
    v_xor_b32 v1, 65536, v1
    v_mfma_f32_16x16x16_f16 v[194:197], v[120:121], v[118:119], v[194:197]
    v_cvt_pk_bf16_f32 v160, v138, v139
    v_exp_f32 v140, v140
    v_add_u32 v6, s75, v6
    v_mfma_f32_16x16x32_bf16 v[122:125], a[224:227], v[170:173], v[122:125]
    s_add_u32 s80, s77, 20
    v_exp_f32 v141, v141
    v_mfma_f32_16x16x32_bf16 v[122:125], a[228:231], v[214:217], v[122:125]
    s_add_u32 s34, s18, 3
    v_exp_f32 v234, v234
    v_mfma_f32_16x16x32_bf16 v[122:125], a[232:235], v[182:185], v[122:125]
    s_cmp_lt_u32 s77, s62
    v_exp_f32 v235, v235
    v_mfma_f32_16x16x32_bf16 v[122:125], a[236:239], v[178:181], v[122:125]
    s_cselect_b32 s79, 1, 0
    v_exp_f32 v236, v236
    v_mfma_f32_16x16x32_bf16 v[154:157], a[240:243], v[242:245], 0
    s_cselect_b32 s78, s78, 0
    ds_read_b128 v[150:153], v2 offset:6144
    v_cvt_pk_bf16_f32 v161, v140, v141
    v_mfma_f32_16x16x32_bf16 v[154:157], a[244:247], v[174:177], v[154:157]
    s_cmp_lt_u32 s34, s17
    ds_read_b128 v[162:165], v2 offset:7168
    v_fma_f32 v255, v122, v122, s33
    v_mfma_f32_16x16x32_bf16 v[154:157], a[248:251], v[170:173], v[154:157]
    s_cselect_b32 s23, s23, s78
    ds_read_b128 v[186:189], v2 offset:8192
    v_fmac_f32 v255, v123, v123
    v_mfma_f32_16x16x32_bf16 v[154:157], a[252:255], v[214:217], v[154:157]
    s_cselect_b32 s73, s34, s80
    ds_read_b128 v[138:141], v2 offset:9216
    v_fmac_f32 v255, v124, v124
    v_mfma_f32_16x16x32_bf16 v[154:157], v[82:85], v[182:185], v[154:157]
    s_cselect_b32 s79, 0, s79
    ds_read_b128 v[118:121], v2 offset:10240
    v_fmac_f32 v255, v125, v125
    v_mfma_f32_16x16x32_bf16 v[154:157], v[86:89], v[178:181], v[154:157]
    s_cselect_b32 s81, 0, 1
    ds_read_b128 v[198:201], v2 offset:11264
    s_add_u32 s80, s77, 1
    v_mfma_f32_16x16x32_bf16 v[202:205], v[90:93], v[242:245], 0
    s_mul_i32 s80, s80, s81
    v_exp_f32 v237, v237
    v_mfma_f32_16x16x32_bf16 v[202:205], v[94:97], v[174:177], v[202:205]
    s_cmp_lt_u32 s80, s62
    v_exp_f32 v117, v117
    v_mfma_f32_16x16x32_bf16 v[202:205], v[98:101], v[170:173], v[202:205]
    s_waitcnt lgkmcnt(5)
    v_cvt_pk_bf16_f32 v221, v116, v117
    v_fmac_f32 v255, v154, v154
    v_mfma_f32_16x16x32_bf16 v[202:205], v[102:105], v[214:217], v[202:205]
    s_cselect_b32 s70, s70, 0
    v_exp_f32 v246, v246
    v_mfma_f32_16x16x32_bf16 v[202:205], v[106:109], v[182:185], v[202:205]
    s_cselect_b32 s62, s62, 0
    v_exp_f32 v247, v247
    v_mfma_f32_16x16x32_bf16 v[202:205], v[110:113], v[178:181], v[202:205]
    s_add_u32 s80, s18, 4
    v_cvt_pk_bf16_f32 v36, v246, v247
    v_fmac_f32 v255, v155, v155
    v_mfma_f32_16x16x32_bf16 v[114:117], a[216:219], v[150:153], 0
    s_waitcnt lgkmcnt(1)
    v_exp_f32 v248, v248
    v_mfma_f32_16x16x32_bf16 v[114:117], a[220:223], v[162:165], v[114:117]
    s_cmp_ge_u32 s80, s17
    v_exp_f32 v249, v249
    v_mfma_f32_16x16x32_bf16 v[114:117], a[224:227], v[186:189], v[114:117]
    s_cselect_b32 s66, s70, 0
    v_cvt_pk_bf16_f32 v37, v248, v249
    v_fmac_f32 v255, v156, v156
    v_mfma_f32_16x16x32_bf16 v[114:117], a[228:231], v[138:141], v[114:117]
    s_waitcnt lgkmcnt(0)
    v_fmac_f32 v255, v157, v157
    v_mfma_f32_16x16x32_bf16 v[178:181], v[28:31], v[36:39], 0
    s_lshl_b32 s80, s79, s73
    v_exp_f32 v222, v222
    v_mfma_f32_16x16x32_bf16 v[178:181], v[28:31], v[218:221], v[178:181]
    s_or_b32 s63, s63, s80
    v_exp_f32 v223, v223
    v_mfma_f32_16x16x32_bf16 v[146:149], v[142:145], v[36:39], 0
    s_sub_u32 s80, s100, s81
    v_cvt_pk_bf16_f32 v226, v222, v223
    v_fmac_f32 v255, v202, v202
    v_mfma_f32_16x16x32_bf16 v[146:149], v[126:129], v[218:221], v[146:149]
    s_and_b32 s100, s100, s80
    v_exp_f32 v224, v224
    v_mfma_f32_16x16x32_bf16 v[246:249], v[210:213], v[36:39], 0
    s_add_u32 s45, s45, s79
    v_exp_f32 v225, v225
    v_mfma_f32_16x16x32_bf16 v[246:249], v[130:133], v[218:221], v[246:249]
    s_add_u32 s18, s18, 1
    v_cvt_pk_bf16_f32 v227, v224, v225
    v_fmac_f32 v255, v203, v203
    v_mfma_f32_16x16x32_bf16 v[222:225], v[238:241], v[36:39], 0
    s_cmp_lt_u32 s18, s45
    v_cvt_pk_bf16_f32 v36, v234, v235
    v_cvt_pk_bf16_f32 v37, v236, v237
    v_mfma_f32_16x16x32_bf16 v[222:225], v[190:193], v[218:221], v[222:225]
    v_cvt_pk_bf16_f32 v39, v208, 0
    v_fmac_f32 v255, v204, v204
    v_mfma_f32_16x16x32_bf16 v[114:117], a[232:235], v[118:121], v[114:117]
    v_exp_f32 v134, v134
    v_mfma_f32_16x16x32_bf16 v[182:185], v[28:31], v[36:39], 0
    v_exp_f32 v135, v135
    v_mfma_f32_16x16x32_bf16 v[182:185], v[28:31], v[158:161], v[182:185]
    v_cvt_pk_bf16_f32 v228, v134, v135
    v_fmac_f32 v255, v205, v205
    v_mfma_f32_16x16x32_bf16 v[230:233], v[142:145], v[36:39], 0
    v_exp_f32 v136, v136
    v_mfma_f32_16x16x32_bf16 v[230:233], v[126:129], v[158:161], v[230:233]
    v_exp_f32 v137, v137
    v_mfma_f32_16x16x32_bf16 v[170:173], v[210:213], v[36:39], 0
    v_exp_f32 v194, v194
    v_mfma_f32_16x16x32_bf16 v[170:173], v[130:133], v[158:161], v[170:173]
    v_rcp_f32 v182, v182
    v_mfma_f32_16x16x32_bf16 v[174:177], v[238:241], v[36:39], 0
    v_cvt_pk_bf16_f32 v229, v136, v137
    v_cvt_pk_bf16_f32 v39, v168, 0
    v_mfma_f32_16x16x32_bf16 v[174:177], v[190:193], v[158:161], v[174:177]
    v_mul_f32 v230, v182, v230
    v_mul_f32 v231, v182, v231
    v_mfma_f32_16x16x32_bf16 v[114:117], a[236:239], v[198:201], v[114:117]
    v_cvt_pk_bf16_f32 v134, v230, v231
    v_mul_f32 v232, v182, v232
    v_mfma_f32_16x16x32_bf16 v[166:169], a[240:243], v[150:153], 0
    ds_read_b128 v[214:217], v2 offset:12288
    v_mul_f32 v233, v182, v233
    v_mfma_f32_16x16x32_bf16 v[166:169], a[244:247], v[162:165], v[166:169]
    ds_read_b128 v[234:237], v2 offset:13312
    v_cvt_pk_bf16_f32 v135, v232, v233
    v_mfma_f32_16x16x32_bf16 v[166:169], a[248:251], v[186:189], v[166:169]
    ds_read_b128 v[218:221], v2 offset:14336
    v_fma_f32 v254, v114, v114, s33
    v_mfma_f32_16x16x32_bf16 v[166:169], a[252:255], v[138:141], v[166:169]
    ds_read_b128 v[158:161], v2 offset:15360
    v_fmac_f32 v254, v115, v115
    v_mfma_f32_16x16x32_bf16 v[166:169], v[82:85], v[118:121], v[166:169]
    ds_read_b128 v[206:209], v2 offset:16384
    v_fmac_f32 v254, v116, v116
    v_mfma_f32_16x16x32_bf16 v[166:169], v[86:89], v[198:201], v[166:169]
    ds_read_b128 v[242:245], v2 offset:17408
    v_fmac_f32 v254, v117, v117
    v_mfma_f32_16x16x32_bf16 v[230:233], v[90:93], v[150:153], 0
    v_mul_f32 v170, v182, v170
    v_mul_f32 v171, v182, v171
    v_mfma_f32_16x16x32_bf16 v[230:233], v[94:97], v[162:165], v[230:233]
    v_cvt_pk_bf16_f32 v136, v170, v171
    v_mul_f32 v172, v182, v172
    v_mfma_f32_16x16x32_bf16 v[230:233], v[98:101], v[186:189], v[230:233]
    s_waitcnt lgkmcnt(5)
    v_fmac_f32 v254, v166, v166
    v_fmac_f32 v254, v167, v167
    v_mfma_f32_16x16x32_bf16 v[230:233], v[102:105], v[138:141], v[230:233]
    s_waitcnt lgkmcnt(4)
    v_fmac_f32 v254, v168, v168
    v_fmac_f32 v254, v169, v169
    v_mfma_f32_16x16x32_bf16 v[230:233], v[106:109], v[118:121], v[230:233]
    s_waitcnt lgkmcnt(3)
    v_mul_f32 v173, v182, v173
    v_cvt_pk_bf16_f32 v137, v172, v173
    v_mfma_f32_16x16x32_bf16 v[230:233], v[110:113], v[198:201], v[230:233]
    s_waitcnt lgkmcnt(2)
    ds_write_b128 v3, v[134:137] offset:6144
    v_mfma_f32_16x16x32_bf16 v[150:153], a[216:219], v[214:217], 0
    s_waitcnt lgkmcnt(1)
    v_mul_f32 v174, v182, v174
    v_mul_f32 v175, v182, v175
    v_mfma_f32_16x16x32_bf16 v[150:153], a[220:223], v[234:237], v[150:153]
    v_cvt_pk_bf16_f32 v174, v174, v175
    v_fmac_f32 v254, v230, v230
    v_mfma_f32_16x16x32_bf16 v[150:153], a[224:227], v[218:221], v[150:153]
    v_fmac_f32 v254, v231, v231
    v_fmac_f32 v254, v232, v232
    v_mfma_f32_16x16x32_bf16 v[150:153], a[228:231], v[158:161], v[150:153]
    v_fmac_f32 v254, v233, v233
    v_cvt_pk_bf16_f32 v254, v255, v254
    v_mfma_f32_16x16x32_bf16 v[150:153], a[232:235], v[206:209], v[150:153]
    v_mul_f32 v176, v182, v176
    v_mul_f32 v177, v182, v177
    v_mfma_f32_16x16x32_bf16 v[150:153], a[236:239], v[242:245], v[150:153]
    v_cvt_pk_bf16_f32 v175, v176, v177
    v_xor_b32 v2, 65536, v2
    v_mfma_f32_16x16x32_bf16 v[162:165], a[240:243], v[214:217], 0
    ds_write_b64 v4, v[174:175] offset:10240
    v_mfma_f32_16x16x32_bf16 v[162:165], a[244:247], v[234:237], v[162:165]
    v_exp_f32 v195, v195
    v_mfma_f32_16x16x32_bf16 v[162:165], a[248:251], v[218:221], v[162:165]
    v_exp_f32 v196, v196
    v_mfma_f32_16x16x32_bf16 v[162:165], a[252:255], v[158:161], v[162:165]
    v_fma_f32 v255, v150, v150, s33
    v_fmac_f32 v255, v151, v151
    v_mfma_f32_16x16x32_bf16 v[162:165], v[82:85], v[206:209], v[162:165]
    v_fmac_f32 v255, v152, v152
    v_fmac_f32 v255, v153, v153
    v_mfma_f32_16x16x32_bf16 v[162:165], v[86:89], v[242:245], v[162:165]
    v_exp_f32 v197, v197
    v_mfma_f32_16x16x32_bf16 v[138:141], v[90:93], v[214:217], 0
    ds_read_b128 v[186:189], v0 offset:20480
    v_cvt_pk_bf16_f32 v36, v194, v195
    v_mfma_f32_16x16x32_bf16 v[138:141], v[94:97], v[234:237], v[138:141]
    ds_read_b128 v[118:121], v1 offset:20480
    v_cvt_pk_bf16_f32 v37, v196, v197
    v_mfma_f32_16x16x32_bf16 v[138:141], v[98:101], v[218:221], v[138:141]
    ds_read_b128 v[234:237], v0 offset:20608
    v_fmac_f32 v255, v162, v162
    v_mfma_f32_16x16x32_bf16 v[198:201], v[28:31], v[36:39], 0
    ds_read_b128 v[214:217], v9
    v_fmac_f32 v255, v163, v163
    v_mfma_f32_16x16x32_bf16 v[198:201], v[28:31], v[226:229], v[198:201]
    ds_read_b128 v[194:197], v9 offset:64
    v_fmac_f32 v255, v164, v164
    v_mfma_f32_16x16x32_bf16 v[170:173], v[142:145], v[36:39], 0
    v_rcp_f32 v178, v178
    v_mfma_f32_16x16x32_bf16 v[170:173], v[126:129], v[226:229], v[170:173]
    v_fmac_f32 v255, v165, v165
    v_mul_f32 v146, v178, v146
    v_mfma_f32_16x16x32_bf16 v[218:221], v[210:213], v[36:39], 0
    v_rcp_f32 v198, v198
    v_mfma_f32_16x16x32_bf16 v[218:221], v[130:133], v[226:229], v[218:221]
    s_waitcnt lgkmcnt(4)
    v_mul_f32 v147, v178, v147
    v_cvt_pk_bf16_f32 v146, v146, v147
    v_mfma_f32_16x16x32_bf16 v[174:177], v[238:241], v[36:39], 0
    s_waitcnt lgkmcnt(3)
    v_mul_f32 v170, v198, v170
    v_mul_f32 v171, v198, v171
    v_mfma_f32_16x16x32_bf16 v[174:177], v[190:193], v[226:229], v[174:177]
    s_waitcnt lgkmcnt(2)
    v_cvt_pk_bf16_f32 v226, v170, v171
    v_mul_f32 v172, v198, v172
    v_mfma_f32_16x16x32_bf16 v[138:141], v[102:105], v[158:161], v[138:141]
    s_waitcnt lgkmcnt(1)
    ds_read_b128 v[158:161], v1 offset:20608
    v_mul_f32 v173, v198, v173
    v_mfma_f32_16x16x32_bf16 v[138:141], v[106:109], v[206:209], v[138:141]
    s_waitcnt lgkmcnt(1)
    ds_read_b128 v[182:185], v0 offset:20736
    v_cvt_pk_bf16_f32 v227, v172, v173
    v_mfma_f32_16x16x32_bf16 v[138:141], v[110:113], v[242:245], v[138:141]
    ds_read_b128 v[206:209], v1 offset:20736
    v_mul_f32 v218, v198, v218
    v_mfma_f32_16x16x32_bf16 v[242:245], v[214:217], v[28:31], 0
    v_mul_f32 v219, v198, v219
    v_cvt_pk_bf16_f32 v228, v218, v219
    v_mfma_f32_16x16x32_bf16 v[242:245], v[194:197], v[28:31], v[242:245]
    v_mul_f32 v220, v198, v220
    v_mul_f32 v221, v198, v221
    v_mfma_f32_16x16x32_bf16 v[170:173], v[214:217], v[126:129], 0
    v_fmac_f32 v255, v138, v138
    v_fmac_f32 v255, v139, v139
    v_mfma_f32_16x16x32_bf16 v[170:173], v[194:197], v[142:145], v[170:173]
    v_fmac_f32 v255, v140, v140
    v_fmac_f32 v255, v141, v141
    v_mfma_f32_16x16x32_bf16 v[126:129], v[214:217], v[130:133], 0
    v_cvt_pk_bf16_f32 v255, v255, v255
    v_cvt_pk_bf16_f32 v229, v220, v221
    v_mfma_f32_16x16x32_bf16 v[126:129], v[194:197], v[210:213], v[126:129]
    s_waitcnt lgkmcnt(2)
    ds_write_b128 v3, v[226:229] offset:12288
    v_mfma_f32_16x16x32_bf16 v[130:133], v[214:217], v[190:193], 0
    s_waitcnt lgkmcnt(1)
    v_rcp_f32 v242, v242
    v_mfma_f32_16x16x32_bf16 v[130:133], v[194:197], v[238:241], v[130:133]
    v_mul_f32 v170, v170, v242
    v_mul_f32 v174, v198, v174
    v_mfma_f32_16x16x32_bf16 v[190:193], a[72:75], v[186:189], 0
    ds_write_b64 v4, v[254:255] offset:18432
    v_mfma_f32_16x16x32_bf16 v[190:193], a[76:79], v[118:121], v[190:193]
    v_mul_f32_dpp v170, v126, v242 quad_perm:[0,1,2,3] row_mask:0x2 bank_mask:0xf
    v_mul_f32 v175, v198, v175
    v_mfma_f32_16x16x32_bf16 v[190:193], a[80:83], v[234:237], v[190:193]
    v_mul_f32_dpp v170, v130, v242 quad_perm:[0,1,2,3] row_mask:0x4 bank_mask:0xf
    v_cvt_pk_bf16_f32 v170, v170, v170
    v_mfma_f32_16x16x32_bf16 v[190:193], a[84:87], v[158:161], v[190:193]
    ds_write_b16 v7, v170
    v_mfma_f32_16x16x32_bf16 v[190:193], a[88:91], v[182:185], v[190:193]
    v_cvt_pk_bf16_f32 v254, v174, v175
    v_mul_f32 v176, v198, v176
    v_mfma_f32_16x16x32_bf16 v[190:193], a[92:95], v[206:209], v[190:193]
    v_mul_f32 v177, v198, v177
    v_cvt_pk_bf16_f32 v255, v176, v177
    v_mfma_f32_16x16x32_bf16 v[130:133], a[96:99], v[186:189], 0
    ds_write_b64 v4, v[254:255] offset:16384
    v_mfma_f32_16x16x32_bf16 v[130:133], a[100:103], v[118:121], v[130:133]
    v_mul_f32 v148, v178, v148
    v_mul_f32 v149, v178, v149
    v_mfma_f32_16x16x32_bf16 v[130:133], a[104:107], v[234:237], v[130:133]
    v_cvt_pk_bf16_f32 v147, v148, v149
    v_mul_f32 v246, v178, v246
    v_mfma_f32_16x16x32_bf16 v[130:133], a[108:111], v[158:161], v[130:133]
    v_mul_f32 v247, v178, v247
    v_cvt_pk_bf16_f32 v148, v246, v247
    v_mfma_f32_16x16x32_bf16 v[130:133], a[112:115], v[182:185], v[130:133]
    v_mul_f32 v248, v178, v248
    v_mul_f32 v249, v178, v249
    v_mfma_f32_16x16x32_bf16 v[130:133], a[116:119], v[206:209], v[130:133]
    v_cvt_pk_bf16_f32 v149, v248, v249
    v_mul_f32 v222, v178, v222
    v_mfma_f32_16x16x32_bf16 v[126:129], a[120:123], v[186:189], 0
    ds_write_b128 v3, v[146:149] offset:0
    v_mfma_f32_16x16x32_bf16 v[126:129], a[124:127], v[118:121], v[126:129]
    v_mul_f32 v223, v178, v223
    v_cvt_pk_bf16_f32 v254, v222, v223
    v_mfma_f32_16x16x32_bf16 v[126:129], a[128:131], v[234:237], v[126:129]
    v_mul_f32 v224, v178, v224
    v_mul_f32 v225, v178, v225
    v_mfma_f32_16x16x32_bf16 v[126:129], a[132:135], v[158:161], v[126:129]
    v_cvt_pk_bf16_f32 v255, v224, v225
    v_xor_b32 v3, 65536, v3
    v_mfma_f32_16x16x32_bf16 v[126:129], a[136:139], v[182:185], v[126:129]
    ds_write_b64 v4, v[254:255] offset:4096
    v_mfma_f32_16x16x32_bf16 v[126:129], a[140:143], v[206:209], v[126:129]
    v_xor_b32 v4, 65536, v4
    v_cvt_pk_f16_f32 v194, v190, v191
    v_mfma_f32_16x16x32_bf16 v[142:145], a[0:3], v[186:189], 0
    v_pk_mul_f16 v191, v194, v194
    v_cvt_pk_f16_f32 v195, v192, v193
    v_mfma_f32_16x16x32_bf16 v[142:145], a[4:7], v[118:121], v[142:145]
    v_pk_fma_f16 v191, v195, v195, v191
    v_cvt_pk_f16_f32 v196, v130, v131
    v_mfma_f32_16x16x32_bf16 v[142:145], a[8:11], v[234:237], v[142:145]
    v_pk_fma_f16 v191, v196, v196, v191
    v_cvt_pk_f16_f32 v197, v132, v133
    v_mfma_f32_16x16x32_bf16 v[142:145], a[12:15], v[158:161], v[142:145]
    v_pk_fma_f16 v191, v197, v197, v191
    v_cvt_pk_f16_f32 v148, v126, v127
    v_mfma_f32_16x16x32_bf16 v[142:145], a[16:19], v[182:185], v[142:145]
    v_pk_fma_f16 v191, v148, v148, v191
    v_cvt_pk_f16_f32 v149, v128, v129
    v_mfma_f32_16x16x32_bf16 v[142:145], a[20:23], v[206:209], v[142:145]
    s_waitcnt lgkmcnt(0)
    v_pk_fma_f16 v191, v149, v149, v191
    v_add_u32 v7, s76, v7
    v_mfma_f32_16x16x32_bf16 v[126:129], a[24:27], v[186:189], 0
    s_nop 0
    v_mfma_f32_16x16x32_bf16 v[126:129], a[28:31], v[118:121], v[126:129]
    s_nop 0
    v_mfma_f32_16x16x32_bf16 v[126:129], a[32:35], v[234:237], v[126:129]
    s_barrier
    v_mfma_f32_16x16x32_bf16 v[126:129], a[36:39], v[158:161], v[126:129]
    s_nop 0
    v_mfma_f32_16x16x32_bf16 v[126:129], a[40:43], v[182:185], v[126:129]
    v_mfma_f32_16x16x32_bf16 v[126:129], a[44:47], v[206:209], v[126:129]
    s_cbranch_scc1 L_loop_fast2
    s_branch L_final_fast
.p2align 6
L_loop_fast3:
    v_mfma_f32_16x16x32_bf16 v[130:133], a[48:51], v[186:189], 0
    s_add_u32 s12, s40, s27
    ds_read_b128 v[246:249], v2 offset:18432
    v_cvt_pk_f16_f32 v222, v142, v143
    v_mfma_f32_16x16x32_bf16 v[130:133], a[52:55], v[118:121], v[130:133]
    s_addc_u32 s13, s41, 0
    ds_read_b128 v[210:213], v2 offset:19456
    v_pk_mul_f16 v190, v222, v222
    v_mfma_f32_16x16x32_bf16 v[130:133], a[56:59], v[234:237], v[130:133]
    s_sub_u32 s14, s36, s27
    ds_read_b128 v[238:241], v5 offset:32
    v_cvt_pk_f16_f32 v223, v144, v145
    v_mfma_f32_16x16x32_bf16 v[130:133], a[60:63], v[158:161], v[130:133]
    s_cmp_ge_u32 s18, 2
    ds_read2_b64 v[226:229], v5 offset0:6 offset1:9
    v_pk_fma_f16 v190, v223, v223, v190
    v_mfma_f32_16x16x32_bf16 v[130:133], a[64:67], v[182:185], v[130:133]
    s_cselect_b32 s14, s14, 0
    ds_read_b128 v[142:145], v5
    v_cvt_pk_f16_f32 v224, v126, v127
    v_mfma_f32_16x16x32_bf16 v[130:133], a[68:71], v[206:209], v[130:133]
    s_sub_u32 s82, s72, s71
    ds_read_b32 v254, v6 offset:192
    v_pk_fma_f16 v190, v224, v224, v190
    v_mfma_f32_16x16x32_bf16 v[198:201], v[186:189], a[144:147], 0
    s_mul_i32 s74, s82, 336
    v_cvt_pk_f16_f32 v225, v128, v129
    v_pk_fma_f16 v190, v225, v225, v190
    v_mfma_f32_16x16x32_bf16 v[198:201], v[118:121], a[148:151], v[198:201]
    s_mul_i32 s75, s82, 272
    v_cvt_pk_f16_f32 v146, v130, v131
    v_pk_fma_f16 v190, v146, v146, v190
    v_mfma_f32_16x16x32_bf16 v[198:201], v[234:237], a[152:155], v[198:201]
    s_waitcnt lgkmcnt(5)
    v_cvt_pk_f16_f32 v147, v132, v133
    v_pk_fma_f16 v190, v147, v147, v190
    v_mfma_f32_16x16x32_bf16 v[130:133], v[32:35], v[246:249], 0
    s_waitcnt lgkmcnt(4)
    v_add_u32 v5, s74, v5
    s_mul_i32 s76, s82, 16
    v_mfma_f32_16x16x32_bf16 v[130:133], v[32:35], v[210:213], v[130:133]
    s_waitcnt lgkmcnt(3)
    v_pk_mul_f16 v193, v194, v238
    v_pk_fma_f16 v193, v195, v239, v193
    v_mfma_f32_16x16x32_bf16 v[198:201], v[158:161], a[156:159], v[198:201]
    s_add_u32 s34, s18, 2
    v_pk_fma_f16 v193, v196, v240, v193
    v_pk_fma_f16 v193, v197, v241, v193
    v_mfma_f32_16x16x32_bf16 v[198:201], v[182:185], a[160:163], v[198:201]
    s_waitcnt lgkmcnt(1)
    v_pk_fma_f16 v193, v148, v228, v193
    v_pk_fma_f16 v193, v149, v229, v193
    v_mfma_f32_16x16x32_bf16 v[198:201], v[206:209], a[164:167], v[198:201]
    s_waitcnt lgkmcnt(0)
    v_mov_b32_dpp v254, v23 quad_perm:[0,1,2,3] row_mask:0x7 bank_mask:0xf
    v_pk_mul_f16 v192, v222, v142
    v_mfma_f32_16x16x32_bf16 v[210:213], v[186:189], a[168:171], 0
    s_add_u32 s8, s60, s23
    v_pk_fma_f16 v192, v223, v143, v192
    v_pk_fma_f16 v192, v224, v144, v192
    v_mfma_f32_16x16x32_bf16 v[210:213], v[118:121], a[172:175], v[210:213]
    s_addc_u32 s9, s61, 0
    v_pk_fma_f16 v192, v225, v145, v192
    v_pk_fma_f16 v192, v146, v226, v192
    v_mfma_f32_16x16x32_bf16 v[210:213], v[234:237], a[176:179], v[210:213]
    s_sub_u32 s10, s36, s23
    ds_read_b128 v[246:249], v0 offset:26624
    v_pk_fma_f16 v192, v147, v227, v192
    v_mfma_f32_16x16x32_bf16 v[210:213], v[158:161], a[180:183], v[210:213]
    s_cmp_le_u32 s34, s45
    ds_read_b128 v[174:177], v1 offset:26624
    v_cvt_pk_bf16_f32 v126, v198, v199
    v_mfma_f32_16x16x32_f16 v[214:217], v[40:43], v[190:193], 0
    s_cselect_b32 s10, s10, 0
    v_cvt_pk_bf16_f32 v127, v200, v201
    v_mul_f32 v255, 0x3baaaaab, v130
    v_mfma_f32_16x16x32_bf16 v[210:213], v[182:185], a[184:187], v[210:213]
    s_add_u32 m0, s28, 0
    ds_read_b128 v[198:201], v0 offset:26752
    v_mul_f32 v134, 0x3baaaaab, v131
    v_mfma_f32_16x16x32_bf16 v[210:213], v[206:209], a[188:191], v[210:213]
    s_mov_b32 s27, s26
    ds_read_b128 v[242:245], v1 offset:26752
    v_mul_f32 v132, 0x3baaaaab, v132
    v_mfma_f32_16x16x32_bf16 v[190:193], v[186:189], a[192:195], 0
    s_mov_b32 s26, s25
    ds_read_b128 v[186:189], v0 offset:26880
    s_mov_b32 s25, s24
    v_mfma_f32_16x16x32_bf16 v[190:193], v[118:121], a[196:199], v[190:193]
    s_mov_b32 s24, s23
    ds_read_b128 v[118:121], v1 offset:26880
    v_cvt_pk_bf16_f32 v130, v210, v211
    v_mfma_f32_16x16x32_bf16 v[190:193], v[234:237], a[200:203], v[190:193]
    s_ff1_i32_b32 s80, s100
    v_rsq_f32 v214, v214
    v_mfma_f32_16x16x32_bf16 v[190:193], v[158:161], a[204:207], v[190:193]
    s_waitcnt lgkmcnt(5)
    v_rsq_f32 v215, v215
    v_mfma_f32_16x16x32_bf16 v[190:193], v[182:185], a[208:211], v[190:193]
    s_mov_b32 s71, s72
    v_mul_f32 v128, s31, v214
    v_cvt_pk_f16_f32 v129, v128, v215
    v_mfma_f32_16x16x32_bf16 v[190:193], v[206:209], a[212:215], v[190:193]
    s_mov_b32 s72, s73
    v_cvt_pk_bf16_f32 v131, v212, v213
    v_fma_f32 v216, v216, v128, v22
    v_mfma_f32_16x16x32_bf16 v[210:213], a[72:75], v[246:249], 0
    s_waitcnt lgkmcnt(3)
    v_fmac_f32_dpp v254, v217, v215 quad_perm:[0,1,2,3] row_mask:0x1 bank_mask:0xf
    v_pk_mul_f16 v194, v194, v129 op_sel:[0,1] op_sel_hi:[1,1]
    v_mfma_f32_16x16x32_bf16 v[210:213], a[76:79], v[174:177], v[210:213]
    s_waitcnt lgkmcnt(2)
    v_cvt_pk_bf16_f32 v190, v190, v191
    v_cvt_pk_bf16_f32 v191, v192, v193
    v_mfma_f32_16x16x32_bf16 v[210:213], a[80:83], v[198:201], v[210:213]
    s_waitcnt lgkmcnt(1)
    v_pk_mul_f16 v195, v195, v129 op_sel:[0,1] op_sel_hi:[1,1]
    v_pk_mul_f16 v196, v196, v129 op_sel:[0,1] op_sel_hi:[1,1]
    v_mfma_f32_16x16x32_bf16 v[210:213], a[84:87], v[242:245], v[210:213]
    s_waitcnt lgkmcnt(0)
    v_pk_mul_f16 v197, v197, v129 op_sel:[0,1] op_sel_hi:[1,1]
    v_pk_mul_f16 v148, v148, v129 op_sel:[0,1] op_sel_hi:[1,1]
    v_mfma_f32_16x16x32_bf16 v[210:213], a[88:91], v[186:189], v[210:213]
    v_pk_mul_f16 v149, v149, v129 op_sel:[0,1] op_sel_hi:[1,1]
    v_pk_mul_f16 v222, v222, v129 op_sel:[0,0] op_sel_hi:[1,0]
    v_mfma_f32_16x16x32_bf16 v[210:213], a[92:95], v[118:121], v[210:213]
    v_pk_mul_f16 v223, v223, v129 op_sel:[0,0] op_sel_hi:[1,0]
    v_pk_mul_f16 v224, v224, v129 op_sel:[0,0] op_sel_hi:[1,0]
    v_mfma_f32_16x16x32_bf16 v[206:209], a[96:99], v[246:249], 0
    v_pk_mul_f16 v225, v225, v129 op_sel:[0,0] op_sel_hi:[1,0]
    v_pk_mul_f16 v146, v146, v129 op_sel:[0,0] op_sel_hi:[1,0]
    v_mfma_f32_16x16x32_bf16 v[206:209], a[100:103], v[174:177], v[206:209]
    v_pk_mul_f16 v147, v147, v129 op_sel:[0,0] op_sel_hi:[1,0]
    v_max3_u32 v44, v44, v214, v215
    v_mfma_f32_16x16x32_bf16 v[206:209], a[104:107], v[198:201], v[206:209]
    v_rsq_f32 v255, v255
    v_mfma_f32_16x16x32_bf16 v[206:209], a[108:111], v[242:245], v[206:209]
    v_rsq_f32 v134, v134
    v_mfma_f32_16x16x32_bf16 v[206:209], a[112:115], v[186:189], v[206:209]
    v_rsq_f32 v132, v132
    v_mfma_f32_16x16x32_bf16 v[206:209], a[116:119], v[118:121], v[206:209]
    v_mul_f32 v122, v255, v122
    v_mul_f32 v123, v255, v123
    v_mfma_f32_16x16x32_bf16 v[234:237], a[120:123], v[246:249], 0
    v_cvt_pk_bf16_f32 v122, v122, v123
    v_mul_f32 v124, v255, v124
    v_mfma_f32_16x16x32_bf16 v[234:237], a[124:127], v[174:177], v[234:237]
    v_mul_f32 v125, v255, v125
    v_cvt_pk_bf16_f32 v123, v124, v125
    v_mfma_f32_16x16x32_bf16 v[234:237], a[128:131], v[198:201], v[234:237]
    v_mul_f32 v154, v255, v154
    v_mul_f32 v155, v255, v155
    v_mfma_f32_16x16x32_bf16 v[234:237], a[132:135], v[242:245], v[234:237]
    v_cvt_pk_bf16_f32 v124, v154, v155
    v_mul_f32 v156, v255, v156
    v_mfma_f32_16x16x32_bf16 v[234:237], a[136:139], v[186:189], v[234:237]
    v_mul_f32 v157, v255, v157
    v_cvt_pk_bf16_f32 v125, v156, v157
    v_mfma_f32_16x16x32_bf16 v[234:237], a[140:143], v[118:121], v[234:237]
    buffer_store_dwordx4 v[122:125], v15, s[12:15], 0 offen nt
    v_mul_f32 v202, v255, v202
    v_mul_f32 v203, v255, v203
    v_cvt_pk_bf16_f32 v128, v202, v203
    v_mul_f32 v204, v255, v204
    v_mfma_f32_16x16x32_bf16 v[122:125], a[0:3], v[246:249], 0
    v_mul_f32 v205, v255, v205
    v_cvt_pk_bf16_f32 v129, v204, v205
    v_mfma_f32_16x16x32_bf16 v[122:125], a[4:7], v[174:177], v[122:125]
    v_cvt_pk_f16_f32 v202, v210, v211
    v_pk_mul_f16 v211, v202, v202
    v_mfma_f32_16x16x32_bf16 v[122:125], a[8:11], v[198:201], v[122:125]
    v_cvt_pk_f16_f32 v203, v212, v213
    v_pk_fma_f16 v211, v203, v203, v211
    v_mfma_f32_16x16x32_bf16 v[122:125], a[12:15], v[242:245], v[122:125]
    v_cvt_pk_f16_f32 v204, v206, v207
    v_pk_fma_f16 v211, v204, v204, v211
    v_mfma_f32_16x16x32_bf16 v[122:125], a[16:19], v[186:189], v[122:125]
    v_cvt_pk_f16_f32 v205, v208, v209
    v_pk_fma_f16 v211, v205, v205, v211
    v_mfma_f32_16x16x32_bf16 v[122:125], a[20:23], v[118:121], v[122:125]
    v_cvt_pk_f16_f32 v160, v234, v235
    v_pk_fma_f16 v211, v160, v160, v211
    v_mfma_f32_16x16x32_bf16 v[154:157], a[24:27], v[246:249], 0
    v_cvt_pk_f16_f32 v161, v236, v237
    v_pk_fma_f16 v211, v161, v161, v211
    v_mfma_f32_16x16x32_bf16 v[154:157], a[28:31], v[174:177], v[154:157]
    v_pk_mul_f16 v213, v202, v238
    v_pk_fma_f16 v213, v203, v239, v213
    v_mfma_f32_16x16x32_bf16 v[154:157], a[32:35], v[198:201], v[154:157]
    v_cvt_pk_f16_f32 v122, v122, v123
    v_pk_mul_f16 v210, v122, v122
    v_mfma_f32_16x16x32_bf16 v[154:157], a[36:39], v[242:245], v[154:157]
    v_cvt_pk_f16_f32 v123, v124, v125
    v_pk_fma_f16 v210, v123, v123, v210
    v_mfma_f32_16x16x32_bf16 v[154:157], a[40:43], v[186:189], v[154:157]
    v_pk_mul_f16 v212, v122, v142
    v_pk_fma_f16 v212, v123, v143, v212
    v_mfma_f32_16x16x32_bf16 v[154:157], a[44:47], v[118:121], v[154:157]
    v_pk_fma_f16 v213, v204, v240, v213
    v_pk_fma_f16 v213, v205, v241, v213
    v_mfma_f32_16x16x32_bf16 v[206:209], a[48:51], v[246:249], 0
    v_pk_fma_f16 v213, v160, v228, v213
    v_pk_fma_f16 v213, v161, v229, v213
    v_mfma_f32_16x16x32_bf16 v[206:209], a[52:55], v[174:177], v[206:209]
    v_mul_f32 v150, v132, v150
    v_mul_f32 v151, v132, v151
    v_mfma_f32_16x16x32_bf16 v[206:209], a[56:59], v[198:201], v[206:209]
    v_cvt_pk_f16_f32 v124, v154, v155
    v_pk_fma_f16 v210, v124, v124, v210
    v_mfma_f32_16x16x32_bf16 v[206:209], a[60:63], v[242:245], v[206:209]
    v_cvt_pk_f16_f32 v125, v156, v157
    v_pk_fma_f16 v210, v125, v125, v210
    v_mfma_f32_16x16x32_bf16 v[206:209], a[64:67], v[186:189], v[206:209]
    buffer_store_dwordx2 v[128:129], v18, s[12:15], 0 offen nt
    v_pk_fma_f16 v212, v124, v144, v212
    v_pk_fma_f16 v212, v125, v145, v212
    v_mfma_f32_16x16x32_bf16 v[206:209], a[68:71], v[118:121], v[206:209]
    v_cvt_pk_bf16_f32 v150, v150, v151
    v_mul_f32 v152, v132, v152
    v_mfma_f32_16x16x32_bf16 v[154:157], v[246:249], a[144:147], 0
    v_mul_f32 v153, v132, v153
    v_cvt_pk_bf16_f32 v151, v152, v153
    v_mfma_f32_16x16x32_bf16 v[154:157], v[174:177], a[148:151], v[154:157]
    v_mul_f32 v162, v132, v162
    v_mul_f32 v163, v132, v163
    v_mfma_f32_16x16x32_bf16 v[154:157], v[198:201], a[152:155], v[154:157]
    v_cvt_pk_f16_f32 v158, v206, v207
    v_pk_fma_f16 v210, v158, v158, v210
    v_mfma_f32_16x16x32_bf16 v[154:157], v[242:245], a[156:159], v[154:157]
    v_cvt_pk_f16_f32 v159, v208, v209
    v_pk_fma_f16 v210, v159, v159, v210
    v_mfma_f32_16x16x32_bf16 v[154:157], v[186:189], a[160:163], v[154:157]
    v_pk_fma_f16 v212, v158, v226, v212
    v_pk_fma_f16 v212, v159, v227, v212
    v_mfma_f32_16x16x32_bf16 v[154:157], v[118:121], a[164:167], v[154:157]
    v_cvt_pk_bf16_f32 v152, v162, v163
    v_mul_f32 v164, v132, v164
    v_mfma_f32_16x16x32_f16 v[206:209], v[40:43], v[210:213], 0
    v_mul_f32 v165, v132, v165
    v_cvt_pk_bf16_f32 v153, v164, v165
    v_mfma_f32_16x16x32_bf16 v[210:213], v[246:249], a[168:171], 0
    v_mul_f32 v138, v132, v138
    v_mul_f32 v139, v132, v139
    v_mfma_f32_16x16x32_bf16 v[210:213], v[174:177], a[172:175], v[210:213]
    v_cvt_pk_bf16_f32 v128, v154, v155
    v_cvt_pk_bf16_f32 v129, v156, v157
    v_mfma_f32_16x16x32_bf16 v[210:213], v[198:201], a[176:179], v[210:213]
    ds_read_b128 v[154:157], v0 offset:32768
    v_cvt_pk_bf16_f32 v136, v138, v139
    v_mfma_f32_16x16x32_bf16 v[210:213], v[242:245], a[180:183], v[210:213]
    ds_read_b128 v[162:165], v1 offset:32768
    v_mul_f32 v140, v132, v140
    v_mfma_f32_16x16x32_bf16 v[210:213], v[186:189], a[184:187], v[210:213]
    ds_read_b128 v[218:221], v0 offset:32896
    v_mul_f32 v141, v132, v141
    v_mfma_f32_16x16x32_bf16 v[210:213], v[118:121], a[188:191], v[210:213]
    ds_read_b128 v[234:237], v1 offset:32896
    v_cvt_pk_bf16_f32 v137, v140, v141
    v_mfma_f32_16x16x32_bf16 v[182:185], v[246:249], a[192:195], 0
    ds_read_b128 v[138:141], v0 offset:33024
    v_mul_f32 v114, v134, v114
    v_mfma_f32_16x16x32_bf16 v[182:185], v[174:177], a[196:199], v[182:185]
    ds_read_b128 v[246:249], v1 offset:33024
    v_mul_f32 v115, v134, v115
    v_mfma_f32_16x16x32_bf16 v[182:185], v[198:201], a[200:203], v[182:185]
    buffer_store_dwordx4 v[150:153], v17, s[12:15], 0 offen nt
    v_rsq_f32 v206, v206
    v_rsq_f32 v207, v207
    v_mfma_f32_16x16x32_bf16 v[182:185], v[242:245], a[204:207], v[182:185]
    s_waitcnt lgkmcnt(5)
    v_mul_f32 v214, s31, v206
    v_cvt_pk_f16_f32 v215, v214, v207
    v_mfma_f32_16x16x32_bf16 v[182:185], v[186:189], a[208:211], v[182:185]
    s_waitcnt lgkmcnt(4)
    v_fma_f32 v208, v208, v214, v24
    v_fmac_f32_dpp v254, v209, v207 quad_perm:[0,1,2,3] row_mask:0x2 bank_mask:0xf
    v_mfma_f32_16x16x32_bf16 v[182:185], v[118:121], a[212:215], v[182:185]
    s_waitcnt lgkmcnt(3)
    v_cvt_pk_bf16_f32 v132, v210, v211
    v_cvt_pk_bf16_f32 v133, v212, v213
    v_mfma_f32_16x16x32_bf16 v[210:213], a[72:75], v[154:157], 0
    s_waitcnt lgkmcnt(2)
    v_pk_mul_f16 v202, v202, v215 op_sel:[0,1] op_sel_hi:[1,1]
    v_pk_mul_f16 v203, v203, v215 op_sel:[0,1] op_sel_hi:[1,1]
    v_mfma_f32_16x16x32_bf16 v[210:213], a[76:79], v[162:165], v[210:213]
    s_waitcnt lgkmcnt(1)
    v_cvt_pk_bf16_f32 v192, v182, v183
    v_cvt_pk_bf16_f32 v193, v184, v185
    v_mfma_f32_16x16x32_bf16 v[210:213], a[80:83], v[218:221], v[210:213]
    s_waitcnt lgkmcnt(0)
    v_pk_mul_f16 v204, v204, v215 op_sel:[0,1] op_sel_hi:[1,1]
    v_pk_mul_f16 v205, v205, v215 op_sel:[0,1] op_sel_hi:[1,1]
    v_mfma_f32_16x16x32_bf16 v[210:213], a[84:87], v[234:237], v[210:213]
    v_pk_mul_f16 v160, v160, v215 op_sel:[0,1] op_sel_hi:[1,1]
    v_pk_mul_f16 v161, v161, v215 op_sel:[0,1] op_sel_hi:[1,1]
    v_mfma_f32_16x16x32_bf16 v[210:213], a[88:91], v[138:141], v[210:213]
    v_pk_mul_f16 v122, v122, v215 op_sel:[0,0] op_sel_hi:[1,0]
    v_pk_mul_f16 v123, v123, v215 op_sel:[0,0] op_sel_hi:[1,0]
    v_mfma_f32_16x16x32_bf16 v[210:213], a[92:95], v[246:249], v[210:213]
    v_pk_mul_f16 v124, v124, v215 op_sel:[0,0] op_sel_hi:[1,0]
    v_pk_mul_f16 v125, v125, v215 op_sel:[0,0] op_sel_hi:[1,0]
    v_mfma_f32_16x16x32_bf16 v[118:121], a[96:99], v[154:157], 0
    v_pk_mul_f16 v158, v158, v215 op_sel:[0,0] op_sel_hi:[1,0]
    v_pk_mul_f16 v159, v159, v215 op_sel:[0,0] op_sel_hi:[1,0]
    v_mfma_f32_16x16x32_bf16 v[118:121], a[100:103], v[162:165], v[118:121]
    v_max3_u32 v44, v44, v206, v207
    v_cvt_pk_bf16_f32 v114, v114, v115
    v_mfma_f32_16x16x32_bf16 v[118:121], a[104:107], v[218:221], v[118:121]
    v_cvt_pk_f16_f32 v186, v210, v211
    v_pk_mul_f16 v211, v186, v186
    v_mfma_f32_16x16x32_bf16 v[118:121], a[108:111], v[234:237], v[118:121]
    s_waitcnt vmcnt(3)
    ds_write_b16 v8, v45 offset:512
    v_mfma_f32_16x16x32_bf16 v[118:121], a[112:115], v[138:141], v[118:121]
    v_cvt_pk_f16_f32 v187, v212, v213
    v_mfma_f32_16x16x32_bf16 v[118:121], a[116:119], v[246:249], v[118:121]
    v_pk_fma_f16 v211, v187, v187, v211
    v_pk_mul_f16 v213, v186, v238
    v_mfma_f32_16x16x32_bf16 v[150:153], a[120:123], v[154:157], 0
    v_pk_fma_f16 v213, v187, v239, v213
    v_mul_f32 v116, v134, v116
    v_mfma_f32_16x16x32_bf16 v[150:153], a[124:127], v[162:165], v[150:153]
    buffer_store_dwordx2 v[136:137], v20, s[12:15], 0 offen nt
    v_exp_f32 v208, v208
    v_mfma_f32_16x16x32_bf16 v[150:153], a[128:131], v[218:221], v[150:153]
    v_cvt_pk_f16_f32 v188, v118, v119
    v_pk_fma_f16 v211, v188, v188, v211
    v_mfma_f32_16x16x32_bf16 v[150:153], a[132:135], v[234:237], v[150:153]
    v_cvt_pk_f16_f32 v189, v120, v121
    v_pk_fma_f16 v211, v189, v189, v211
    v_mfma_f32_16x16x32_bf16 v[150:153], a[136:139], v[138:141], v[150:153]
    s_waitcnt lgkmcnt(0)
    v_pk_fma_f16 v213, v188, v240, v213
    v_pk_fma_f16 v213, v189, v241, v213
    v_mfma_f32_16x16x32_bf16 v[150:153], a[140:143], v[246:249], v[150:153]
    v_mul_f32 v117, v134, v117
    v_mfma_f32_16x16x32_bf16 v[238:241], a[0:3], v[154:157], 0
    v_cvt_pk_bf16_f32 v115, v116, v117
    v_mfma_f32_16x16x32_bf16 v[238:241], a[4:7], v[162:165], v[238:241]
    v_mul_f32 v166, v134, v166
    v_mfma_f32_16x16x32_bf16 v[238:241], a[8:11], v[218:221], v[238:241]
    s_barrier
    ds_read_u16 v255, v9 offset:128
    v_mfma_f32_16x16x32_bf16 v[238:241], a[12:15], v[234:237], v[238:241]
    v_cvt_pk_f16_f32 v120, v150, v151
    v_pk_fma_f16 v211, v120, v120, v211
    v_mfma_f32_16x16x32_bf16 v[238:241], a[16:19], v[138:141], v[238:241]
    v_cvt_pk_f16_f32 v121, v152, v153
    v_pk_fma_f16 v211, v121, v121, v211
    v_mfma_f32_16x16x32_bf16 v[238:241], a[20:23], v[246:249], v[238:241]
    v_pk_fma_f16 v213, v120, v228, v213
    v_pk_fma_f16 v213, v121, v229, v213
    v_mfma_f32_16x16x32_bf16 v[150:153], a[24:27], v[154:157], 0
    v_exp_f32 v216, v216
    v_mfma_f32_16x16x32_bf16 v[150:153], a[28:31], v[162:165], v[150:153]
    v_cvt_pk_bf16_f32 v39, v216, 0
    v_mul_f32 v167, v134, v167
    v_mfma_f32_16x16x32_bf16 v[150:153], a[32:35], v[218:221], v[150:153]
    v_cvt_pk_f16_f32 v198, v238, v239
    v_pk_mul_f16 v210, v198, v198
    v_mfma_f32_16x16x32_bf16 v[150:153], a[36:39], v[234:237], v[150:153]
    v_cvt_pk_f16_f32 v199, v240, v241
    v_pk_fma_f16 v210, v199, v199, v210
    v_mfma_f32_16x16x32_bf16 v[150:153], a[40:43], v[138:141], v[150:153]
    s_waitcnt lgkmcnt(0)
    v_readfirstlane_b32 s77, v255
    v_pk_mul_f16 v212, v198, v142
    v_mfma_f32_16x16x32_bf16 v[150:153], a[44:47], v[246:249], v[150:153]
    v_pk_fma_f16 v212, v199, v143, v212
    v_cvt_pk_bf16_f32 v116, v166, v167
    v_mfma_f32_16x16x32_bf16 v[238:241], a[48:51], v[154:157], 0
    buffer_load_dwordx4 v10, s[8:11], 0 offen nt lds
    v_mul_f32 v168, v134, v168
    v_mfma_f32_16x16x32_bf16 v[238:241], a[52:55], v[162:165], v[238:241]
    s_add_u32 m0, s28, 4096
    v_mul_f32 v169, v134, v169
    v_cvt_pk_f16_f32 v200, v150, v151
    v_mfma_f32_16x16x32_bf16 v[238:241], a[56:59], v[218:221], v[238:241]
    v_pk_fma_f16 v210, v200, v200, v210
    v_cvt_pk_f16_f32 v201, v152, v153
    v_mfma_f32_16x16x32_bf16 v[238:241], a[60:63], v[234:237], v[238:241]
    ds_read_b128 v[242:245], v2 offset:0
    v_pk_fma_f16 v210, v201, v201, v210
    v_mfma_f32_16x16x32_bf16 v[238:241], a[64:67], v[138:141], v[238:241]
    ds_read_b128 v[174:177], v2 offset:1024
    v_pk_fma_f16 v212, v200, v144, v212
    v_mfma_f32_16x16x32_bf16 v[238:241], a[68:71], v[246:249], v[238:241]
    ds_read_b128 v[170:173], v2 offset:2048
    buffer_load_dwordx4 v11, s[8:11], 0 offen nt lds
    v_mfma_f32_16x16x32_bf16 v[150:153], v[154:157], a[144:147], 0
    s_add_u32 m0, s28, 8192
    ds_read_b128 v[214:217], v2 offset:3072
    v_pk_fma_f16 v212, v201, v145, v212
    v_mfma_f32_16x16x32_bf16 v[150:153], v[162:165], a[148:151], v[150:153]
    ds_read_b128 v[182:185], v2 offset:4096
    v_cvt_pk_f16_f32 v118, v238, v239
    v_mfma_f32_16x16x32_bf16 v[150:153], v[218:221], a[152:155], v[150:153]
    ds_read_b128 v[178:181], v2 offset:5120
    v_pk_fma_f16 v210, v118, v118, v210
    v_mfma_f32_16x16x32_bf16 v[150:153], v[234:237], a[156:159], v[150:153]
    v_cvt_pk_f16_f32 v119, v240, v241
    v_pk_fma_f16 v210, v119, v119, v210
    v_mfma_f32_16x16x32_bf16 v[150:153], v[138:141], a[160:163], v[150:153]
    buffer_load_dwordx4 v12, s[8:11], 0 offen nt lds
    v_pk_fma_f16 v212, v118, v226, v212
    v_mfma_f32_16x16x32_bf16 v[150:153], v[246:249], a[164:167], v[150:153]
    s_waitcnt lgkmcnt(5)
    v_pk_fma_f16 v212, v119, v227, v212
    v_cvt_pk_bf16_f32 v117, v168, v169
    v_mfma_f32_16x16x32_bf16 v[226:229], v[154:157], a[168:171], 0
    s_add_u32 m0, s28, 12288
    v_mul_f32 v230, v134, v230
    v_mul_f32 v231, v134, v231
    v_mfma_f32_16x16x32_f16 v[166:169], v[40:43], v[210:213], 0
    s_xor_b32 s28, s28, 65536
    v_cvt_pk_bf16_f32 v142, v150, v151
    v_cvt_pk_bf16_f32 v143, v152, v153
    v_mfma_f32_16x16x32_bf16 v[226:229], v[162:165], a[172:175], v[226:229]
    s_waitcnt lgkmcnt(2)
    ds_read2_b32 v[144:145], v6 offset0:0 offset1:0
    v_cvt_pk_bf16_f32 v230, v230, v231
    v_mfma_f32_16x16x32_bf16 v[226:229], v[218:221], a[176:179], v[226:229]
    s_waitcnt lgkmcnt(2)
    buffer_load_dwordx4 v13, s[8:11], 0 offen nt lds
    ds_read2_b32 v[212:213], v6 offset0:16 offset1:16
    v_mfma_f32_16x16x32_bf16 v[226:229], v[234:237], a[180:183], v[226:229]
    s_mov_b32 m0, s29
    ds_read2_b32 v[240:241], v6 offset0:32 offset1:32
    v_mul_f32 v232, v134, v232
    v_mfma_f32_16x16x32_bf16 v[226:229], v[138:141], a[184:187], v[226:229]
    s_xor_b32 s29, s29, s30
    v_rsq_f32 v166, v166
    v_mfma_f32_16x16x32_bf16 v[226:229], v[246:249], a[188:191], v[226:229]
    s_add_u32 s19, s19, s20
    v_rsq_f32 v167, v167
    v_mfma_f32_16x16x32_bf16 v[150:153], v[154:157], a[192:195], 0
    s_add_u32 s23, s23, s21
    v_mul_f32 v136, s31, v166
    v_cvt_pk_f16_f32 v137, v136, v167
    v_mfma_f32_16x16x32_bf16 v[150:153], v[162:165], a[196:199], v[150:153]
    s_waitcnt lgkmcnt(3)
    v_fma_f32 v168, v168, v136, v26
    v_mfma_f32_16x16x32_bf16 v[150:153], v[218:221], a[200:203], v[150:153]
    s_cmp_ge_u32 s19, 72
    v_fmac_f32_dpp v254, v169, v167 quad_perm:[0,1,2,3] row_mask:0x4 bank_mask:0xf
    v_cvt_pk_bf16_f32 v210, v226, v227
    v_mfma_f32_16x16x32_bf16 v[150:153], v[234:237], a[204:207], v[150:153]
    s_cselect_b32 s34, 72, 0
    v_cvt_pk_bf16_f32 v211, v228, v229
    v_pk_mul_f16 v186, v186, v137 op_sel:[0,1] op_sel_hi:[1,1]
    v_mfma_f32_16x16x32_bf16 v[150:153], v[138:141], a[208:211], v[150:153]
    s_cselect_b32 s35, s22, 0
    v_pk_mul_f16 v187, v187, v137 op_sel:[0,1] op_sel_hi:[1,1]
    v_pk_mul_f16 v188, v188, v137 op_sel:[0,1] op_sel_hi:[1,1]
    v_mfma_f32_16x16x32_bf16 v[150:153], v[246:249], a[212:215], v[150:153]
    s_sub_u32 s19, s19, s34
    v_pk_mul_f16 v189, v189, v137 op_sel:[0,1] op_sel_hi:[1,1]
    v_pk_mul_f16 v120, v120, v137 op_sel:[0,1] op_sel_hi:[1,1]
    v_mfma_f32_16x16x32_f16 v[154:157], v[194:197], v[222:225], v[46:49]
    s_waitcnt lgkmcnt(0)
    buffer_store_dwordx4 v[114:117], v16, s[12:15], 0 offen nt
    v_pk_mul_f16 v121, v121, v137 op_sel:[0,1] op_sel_hi:[1,1]
    v_pk_mul_f16 v198, v198, v137 op_sel:[0,0] op_sel_hi:[1,0]
    v_cvt_pk_bf16_f32 v238, v150, v151
    v_cvt_pk_bf16_f32 v239, v152, v153
    v_mfma_f32_16x16x32_f16 v[114:117], v[202:205], v[222:225], v[50:53]
    s_add_u32 s23, s23, s35
    v_pk_mul_f16 v199, v199, v137 op_sel:[0,0] op_sel_hi:[1,0]
    v_pk_mul_f16 v200, v200, v137 op_sel:[0,0] op_sel_hi:[1,0]
    v_mfma_f32_16x16x32_f16 v[246:249], v[186:189], v[222:225], v[54:57]
    s_cmp_lg_u32 s83, 0
    v_pk_mul_f16 v201, v201, v137 op_sel:[0,0] op_sel_hi:[1,0]
    v_pk_mul_f16 v118, v118, v137 op_sel:[0,0] op_sel_hi:[1,0]
    v_pk_mul_f16 v119, v119, v137 op_sel:[0,0] op_sel_hi:[1,0]
    v_mfma_f32_16x16x16_f16 v[154:157], v[148:149], v[146:147], v[154:157]
    v_max3_u32 v44, v44, v166, v167
    v_exp_f32 v254, v254
    v_mfma_f32_16x16x16_f16 v[114:117], v[160:161], v[146:147], v[114:117]
    v_cvt_pk_bf16_f32 v254, v254, v254
    v_exp_f32 v168, v168
    v_mfma_f32_16x16x16_f16 v[246:249], v[120:121], v[146:147], v[246:249]
    v_mul_f32 v233, v134, v233
    v_cvt_pk_bf16_f32 v231, v232, v233
    v_exp_f32 v154, v154
    v_mfma_f32_16x16x32_f16 v[162:165], v[194:197], v[122:125], v[58:61]
    s_cselect_b32 s77, s80, s77
    ds_write_b16 v8, v254
    v_mfma_f32_16x16x32_f16 v[138:141], v[202:205], v[122:125], v[62:65]
    s_mul_i32 s78, s77, 2688
    v_exp_f32 v155, v155
    v_mfma_f32_16x16x32_f16 v[234:237], v[186:189], v[122:125], v[66:69]
    s_add_u32 s78, s78, s69
    v_cvt_pk_bf16_f32 v218, v154, v155
    v_exp_f32 v156, v156
    v_mfma_f32_16x16x16_f16 v[162:165], v[148:149], v[158:159], v[162:165]
    v_exp_f32 v157, v157
    v_xor_b32 v0, 65536, v0
    v_mfma_f32_16x16x16_f16 v[138:141], v[160:161], v[158:159], v[138:141]
    v_cvt_pk_bf16_f32 v219, v156, v157
    v_exp_f32 v114, v114
    v_mfma_f32_16x16x16_f16 v[234:237], v[120:121], v[158:159], v[234:237]
    v_exp_f32 v115, v115
    v_exp_f32 v116, v116
    v_mfma_f32_16x16x32_bf16 v[122:125], a[216:219], v[242:245], 0
    s_add_u32 s80, s77, s68
    v_exp_f32 v162, v162
    v_mfma_f32_16x16x32_bf16 v[122:125], a[220:223], v[174:177], v[122:125]
    s_cmp_ge_u32 s80, 72
    v_exp_f32 v163, v163
    v_mfma_f32_16x16x32_f16 v[222:225], v[194:197], v[198:201], v[70:73]
    s_cselect_b32 s80, s22, 0
    v_cvt_pk_bf16_f32 v158, v162, v163
    v_cvt_pk_bf16_f32 v220, v114, v115
    v_mfma_f32_16x16x32_f16 v[134:137], v[202:205], v[198:201], v[74:77]
    s_add_u32 s78, s78, s80
    v_exp_f32 v164, v164
    v_mfma_f32_16x16x32_f16 v[194:197], v[186:189], v[198:201], v[78:81]
    buffer_store_dwordx2 v[230:231], v19, s[12:15], 0 offen nt
    v_exp_f32 v165, v165
    v_mfma_f32_16x16x16_f16 v[222:225], v[148:149], v[118:119], v[222:225]
    v_cvt_pk_bf16_f32 v159, v164, v165
    v_exp_f32 v138, v138
    v_mfma_f32_16x16x16_f16 v[134:137], v[160:161], v[118:119], v[134:137]
    v_exp_f32 v139, v139
    v_xor_b32 v1, 65536, v1
    v_mfma_f32_16x16x16_f16 v[194:197], v[120:121], v[118:119], v[194:197]
    v_cvt_pk_bf16_f32 v160, v138, v139
    v_exp_f32 v140, v140
    v_add_u32 v6, s75, v6
    v_mfma_f32_16x16x32_bf16 v[122:125], a[224:227], v[170:173], v[122:125]
    s_add_u32 s80, s77, 20
    v_exp_f32 v141, v141
    v_mfma_f32_16x16x32_bf16 v[122:125], a[228:231], v[214:217], v[122:125]
    s_add_u32 s34, s18, 3
    v_exp_f32 v234, v234
    v_mfma_f32_16x16x32_bf16 v[122:125], a[232:235], v[182:185], v[122:125]
    s_cmp_lt_u32 s77, s62
    v_exp_f32 v235, v235
    v_mfma_f32_16x16x32_bf16 v[122:125], a[236:239], v[178:181], v[122:125]
    s_cselect_b32 s79, 1, 0
    v_exp_f32 v236, v236
    v_mfma_f32_16x16x32_bf16 v[154:157], a[240:243], v[242:245], 0
    s_cselect_b32 s78, s78, 0
    ds_read_b128 v[150:153], v2 offset:6144
    v_cvt_pk_bf16_f32 v161, v140, v141
    v_mfma_f32_16x16x32_bf16 v[154:157], a[244:247], v[174:177], v[154:157]
    s_cmp_lt_u32 s34, s17
    ds_read_b128 v[162:165], v2 offset:7168
    v_fma_f32 v255, v122, v122, s33
    v_mfma_f32_16x16x32_bf16 v[154:157], a[248:251], v[170:173], v[154:157]
    s_cselect_b32 s23, s23, s78
    ds_read_b128 v[186:189], v2 offset:8192
    v_fmac_f32 v255, v123, v123
    v_mfma_f32_16x16x32_bf16 v[154:157], a[252:255], v[214:217], v[154:157]
    s_cselect_b32 s73, s34, s80
    ds_read_b128 v[138:141], v2 offset:9216
    v_fmac_f32 v255, v124, v124
    v_mfma_f32_16x16x32_bf16 v[154:157], v[82:85], v[182:185], v[154:157]
    s_cselect_b32 s79, 0, s79
    ds_read_b128 v[118:121], v2 offset:10240
    v_fmac_f32 v255, v125, v125
    v_mfma_f32_16x16x32_bf16 v[154:157], v[86:89], v[178:181], v[154:157]
    s_cselect_b32 s81, 0, 1
    ds_read_b128 v[198:201], v2 offset:11264
    s_add_u32 s80, s77, 1
    v_mfma_f32_16x16x32_bf16 v[202:205], v[90:93], v[242:245], 0
    s_mul_i32 s80, s80, s81
    v_exp_f32 v237, v237
    v_mfma_f32_16x16x32_bf16 v[202:205], v[94:97], v[174:177], v[202:205]
    s_cmp_lt_u32 s80, s62
    v_exp_f32 v117, v117
    v_mfma_f32_16x16x32_bf16 v[202:205], v[98:101], v[170:173], v[202:205]
    s_waitcnt lgkmcnt(5)
    v_cvt_pk_bf16_f32 v221, v116, v117
    v_fmac_f32 v255, v154, v154
    v_mfma_f32_16x16x32_bf16 v[202:205], v[102:105], v[214:217], v[202:205]
    s_cselect_b32 s70, s70, 0
    v_exp_f32 v246, v246
    v_mfma_f32_16x16x32_bf16 v[202:205], v[106:109], v[182:185], v[202:205]
    s_cselect_b32 s62, s62, 0
    v_exp_f32 v247, v247
    v_mfma_f32_16x16x32_bf16 v[202:205], v[110:113], v[178:181], v[202:205]
    s_add_u32 s80, s18, 4
    v_cvt_pk_bf16_f32 v36, v246, v247
    v_fmac_f32 v255, v155, v155
    v_mfma_f32_16x16x32_bf16 v[114:117], a[216:219], v[150:153], 0
    s_waitcnt lgkmcnt(1)
    v_exp_f32 v248, v248
    v_mfma_f32_16x16x32_bf16 v[114:117], a[220:223], v[162:165], v[114:117]
    s_cmp_ge_u32 s80, s17
    v_exp_f32 v249, v249
    v_mfma_f32_16x16x32_bf16 v[114:117], a[224:227], v[186:189], v[114:117]
    s_cselect_b32 s66, s70, 0
    v_cvt_pk_bf16_f32 v37, v248, v249
    v_fmac_f32 v255, v156, v156
    v_mfma_f32_16x16x32_bf16 v[114:117], a[228:231], v[138:141], v[114:117]
    s_waitcnt lgkmcnt(0)
    v_fmac_f32 v255, v157, v157
    v_mfma_f32_16x16x32_bf16 v[178:181], v[28:31], v[36:39], 0
    s_lshl_b32 s80, s79, s73
    v_exp_f32 v222, v222
    v_mfma_f32_16x16x32_bf16 v[178:181], v[28:31], v[218:221], v[178:181]
    s_or_b32 s63, s63, s80
    v_exp_f32 v223, v223
    v_mfma_f32_16x16x32_bf16 v[146:149], v[142:145], v[36:39], 0
    s_sub_u32 s80, s100, s81
    v_cvt_pk_bf16_f32 v226, v222, v223
    v_fmac_f32 v255, v202, v202
    v_mfma_f32_16x16x32_bf16 v[146:149], v[126:129], v[218:221], v[146:149]
    s_and_b32 s100, s100, s80
    v_exp_f32 v224, v224
    v_mfma_f32_16x16x32_bf16 v[246:249], v[210:213], v[36:39], 0
    s_add_u32 s45, s45, s79
    v_exp_f32 v225, v225
    v_mfma_f32_16x16x32_bf16 v[246:249], v[130:133], v[218:221], v[246:249]
    s_add_u32 s18, s18, 1
    v_cvt_pk_bf16_f32 v227, v224, v225
    v_fmac_f32 v255, v203, v203
    v_mfma_f32_16x16x32_bf16 v[222:225], v[238:241], v[36:39], 0
    s_cmp_lt_u32 s18, s45
    v_cvt_pk_bf16_f32 v36, v234, v235
    v_cvt_pk_bf16_f32 v37, v236, v237
    v_mfma_f32_16x16x32_bf16 v[222:225], v[190:193], v[218:221], v[222:225]
    v_cvt_pk_bf16_f32 v39, v208, 0
    v_fmac_f32 v255, v204, v204
    v_mfma_f32_16x16x32_bf16 v[114:117], a[232:235], v[118:121], v[114:117]
    v_exp_f32 v134, v134
    v_mfma_f32_16x16x32_bf16 v[182:185], v[28:31], v[36:39], 0
    v_exp_f32 v135, v135
    v_mfma_f32_16x16x32_bf16 v[182:185], v[28:31], v[158:161], v[182:185]
    v_cvt_pk_bf16_f32 v228, v134, v135
    v_fmac_f32 v255, v205, v205
    v_mfma_f32_16x16x32_bf16 v[230:233], v[142:145], v[36:39], 0
    v_exp_f32 v136, v136
    v_mfma_f32_16x16x32_bf16 v[230:233], v[126:129], v[158:161], v[230:233]
    v_exp_f32 v137, v137
    v_mfma_f32_16x16x32_bf16 v[170:173], v[210:213], v[36:39], 0
    v_exp_f32 v194, v194
    v_mfma_f32_16x16x32_bf16 v[170:173], v[130:133], v[158:161], v[170:173]
    v_rcp_f32 v182, v182
    v_mfma_f32_16x16x32_bf16 v[174:177], v[238:241], v[36:39], 0
    v_cvt_pk_bf16_f32 v229, v136, v137
    v_cvt_pk_bf16_f32 v39, v168, 0
    v_mfma_f32_16x16x32_bf16 v[174:177], v[190:193], v[158:161], v[174:177]
    v_mul_f32 v230, v182, v230
    v_mul_f32 v231, v182, v231
    v_mfma_f32_16x16x32_bf16 v[114:117], a[236:239], v[198:201], v[114:117]
    v_cvt_pk_bf16_f32 v134, v230, v231
    v_mul_f32 v232, v182, v232
    v_mfma_f32_16x16x32_bf16 v[166:169], a[240:243], v[150:153], 0
    ds_read_b128 v[214:217], v2 offset:12288
    v_mul_f32 v233, v182, v233
    v_mfma_f32_16x16x32_bf16 v[166:169], a[244:247], v[162:165], v[166:169]
    ds_read_b128 v[234:237], v2 offset:13312
    v_cvt_pk_bf16_f32 v135, v232, v233
    v_mfma_f32_16x16x32_bf16 v[166:169], a[248:251], v[186:189], v[166:169]
    ds_read_b128 v[218:221], v2 offset:14336
    v_fma_f32 v254, v114, v114, s33
    v_mfma_f32_16x16x32_bf16 v[166:169], a[252:255], v[138:141], v[166:169]
    ds_read_b128 v[158:161], v2 offset:15360
    v_fmac_f32 v254, v115, v115
    v_mfma_f32_16x16x32_bf16 v[166:169], v[82:85], v[118:121], v[166:169]
    ds_read_b128 v[206:209], v2 offset:16384
    v_fmac_f32 v254, v116, v116
    v_mfma_f32_16x16x32_bf16 v[166:169], v[86:89], v[198:201], v[166:169]
    ds_read_b128 v[242:245], v2 offset:17408
    v_fmac_f32 v254, v117, v117
    v_mfma_f32_16x16x32_bf16 v[230:233], v[90:93], v[150:153], 0
    v_mul_f32 v170, v182, v170
    v_mul_f32 v171, v182, v171
    v_mfma_f32_16x16x32_bf16 v[230:233], v[94:97], v[162:165], v[230:233]
    v_cvt_pk_bf16_f32 v136, v170, v171
    v_mul_f32 v172, v182, v172
    v_mfma_f32_16x16x32_bf16 v[230:233], v[98:101], v[186:189], v[230:233]
    s_waitcnt lgkmcnt(5)
    v_fmac_f32 v254, v166, v166
    v_fmac_f32 v254, v167, v167
    v_mfma_f32_16x16x32_bf16 v[230:233], v[102:105], v[138:141], v[230:233]
    s_waitcnt lgkmcnt(4)
    v_fmac_f32 v254, v168, v168
    v_fmac_f32 v254, v169, v169
    v_mfma_f32_16x16x32_bf16 v[230:233], v[106:109], v[118:121], v[230:233]
    s_waitcnt lgkmcnt(3)
    v_mul_f32 v173, v182, v173
    v_cvt_pk_bf16_f32 v137, v172, v173
    v_mfma_f32_16x16x32_bf16 v[230:233], v[110:113], v[198:201], v[230:233]
    s_waitcnt lgkmcnt(2)
    ds_write_b128 v3, v[134:137] offset:6144
    v_mfma_f32_16x16x32_bf16 v[150:153], a[216:219], v[214:217], 0
    s_waitcnt lgkmcnt(1)
    v_mul_f32 v174, v182, v174
    v_mul_f32 v175, v182, v175
    v_mfma_f32_16x16x32_bf16 v[150:153], a[220:223], v[234:237], v[150:153]
    v_cvt_pk_bf16_f32 v174, v174, v175
    v_fmac_f32 v254, v230, v230
    v_mfma_f32_16x16x32_bf16 v[150:153], a[224:227], v[218:221], v[150:153]
    v_fmac_f32 v254, v231, v231
    v_fmac_f32 v254, v232, v232
    v_mfma_f32_16x16x32_bf16 v[150:153], a[228:231], v[158:161], v[150:153]
    v_fmac_f32 v254, v233, v233
    v_cvt_pk_bf16_f32 v254, v255, v254
    v_mfma_f32_16x16x32_bf16 v[150:153], a[232:235], v[206:209], v[150:153]
    v_mul_f32 v176, v182, v176
    v_mul_f32 v177, v182, v177
    v_mfma_f32_16x16x32_bf16 v[150:153], a[236:239], v[242:245], v[150:153]
    v_cvt_pk_bf16_f32 v175, v176, v177
    v_xor_b32 v2, 65536, v2
    v_mfma_f32_16x16x32_bf16 v[162:165], a[240:243], v[214:217], 0
    ds_write_b64 v4, v[174:175] offset:10240
    v_mfma_f32_16x16x32_bf16 v[162:165], a[244:247], v[234:237], v[162:165]
    v_exp_f32 v195, v195
    v_mfma_f32_16x16x32_bf16 v[162:165], a[248:251], v[218:221], v[162:165]
    v_exp_f32 v196, v196
    v_mfma_f32_16x16x32_bf16 v[162:165], a[252:255], v[158:161], v[162:165]
    v_fma_f32 v255, v150, v150, s33
    v_fmac_f32 v255, v151, v151
    v_mfma_f32_16x16x32_bf16 v[162:165], v[82:85], v[206:209], v[162:165]
    v_fmac_f32 v255, v152, v152
    v_fmac_f32 v255, v153, v153
    v_mfma_f32_16x16x32_bf16 v[162:165], v[86:89], v[242:245], v[162:165]
    v_exp_f32 v197, v197
    v_mfma_f32_16x16x32_bf16 v[138:141], v[90:93], v[214:217], 0
    ds_read_b128 v[186:189], v0 offset:20480
    v_cvt_pk_bf16_f32 v36, v194, v195
    v_mfma_f32_16x16x32_bf16 v[138:141], v[94:97], v[234:237], v[138:141]
    ds_read_b128 v[118:121], v1 offset:20480
    v_cvt_pk_bf16_f32 v37, v196, v197
    v_mfma_f32_16x16x32_bf16 v[138:141], v[98:101], v[218:221], v[138:141]
    ds_read_b128 v[234:237], v0 offset:20608
    v_fmac_f32 v255, v162, v162
    v_mfma_f32_16x16x32_bf16 v[198:201], v[28:31], v[36:39], 0
    ds_read_b128 v[214:217], v9
    v_fmac_f32 v255, v163, v163
    v_mfma_f32_16x16x32_bf16 v[198:201], v[28:31], v[226:229], v[198:201]
    ds_read_b128 v[194:197], v9 offset:64
    v_fmac_f32 v255, v164, v164
    v_mfma_f32_16x16x32_bf16 v[170:173], v[142:145], v[36:39], 0
    v_rcp_f32 v178, v178
    v_mfma_f32_16x16x32_bf16 v[170:173], v[126:129], v[226:229], v[170:173]
    v_fmac_f32 v255, v165, v165
    v_mul_f32 v146, v178, v146
    v_mfma_f32_16x16x32_bf16 v[218:221], v[210:213], v[36:39], 0
    v_rcp_f32 v198, v198
    v_mfma_f32_16x16x32_bf16 v[218:221], v[130:133], v[226:229], v[218:221]
    s_waitcnt lgkmcnt(4)
    v_mul_f32 v147, v178, v147
    v_cvt_pk_bf16_f32 v146, v146, v147
    v_mfma_f32_16x16x32_bf16 v[174:177], v[238:241], v[36:39], 0
    s_waitcnt lgkmcnt(3)
    v_mul_f32 v170, v198, v170
    v_mul_f32 v171, v198, v171
    v_mfma_f32_16x16x32_bf16 v[174:177], v[190:193], v[226:229], v[174:177]
    s_waitcnt lgkmcnt(2)
    v_cvt_pk_bf16_f32 v226, v170, v171
    v_mul_f32 v172, v198, v172
    v_mfma_f32_16x16x32_bf16 v[138:141], v[102:105], v[158:161], v[138:141]
    s_waitcnt lgkmcnt(1)
    ds_read_b128 v[158:161], v1 offset:20608
    v_mul_f32 v173, v198, v173
    v_mfma_f32_16x16x32_bf16 v[138:141], v[106:109], v[206:209], v[138:141]
    s_waitcnt lgkmcnt(1)
    ds_read_b128 v[182:185], v0 offset:20736
    v_cvt_pk_bf16_f32 v227, v172, v173
    v_mfma_f32_16x16x32_bf16 v[138:141], v[110:113], v[242:245], v[138:141]
    ds_read_b128 v[206:209], v1 offset:20736
    v_mul_f32 v218, v198, v218
    v_mfma_f32_16x16x32_bf16 v[242:245], v[214:217], v[28:31], 0
    v_mul_f32 v219, v198, v219
    v_cvt_pk_bf16_f32 v228, v218, v219
    v_mfma_f32_16x16x32_bf16 v[242:245], v[194:197], v[28:31], v[242:245]
    v_mul_f32 v220, v198, v220
    v_mul_f32 v221, v198, v221
    v_mfma_f32_16x16x32_bf16 v[170:173], v[214:217], v[126:129], 0
    v_fmac_f32 v255, v138, v138
    v_fmac_f32 v255, v139, v139
    v_mfma_f32_16x16x32_bf16 v[170:173], v[194:197], v[142:145], v[170:173]
    v_fmac_f32 v255, v140, v140
    v_fmac_f32 v255, v141, v141
    v_mfma_f32_16x16x32_bf16 v[126:129], v[214:217], v[130:133], 0
    v_cvt_pk_bf16_f32 v255, v255, v255
    v_cvt_pk_bf16_f32 v229, v220, v221
    v_mfma_f32_16x16x32_bf16 v[126:129], v[194:197], v[210:213], v[126:129]
    s_waitcnt lgkmcnt(2)
    ds_write_b128 v3, v[226:229] offset:12288
    v_mfma_f32_16x16x32_bf16 v[130:133], v[214:217], v[190:193], 0
    s_waitcnt lgkmcnt(1)
    v_rcp_f32 v242, v242
    v_mfma_f32_16x16x32_bf16 v[130:133], v[194:197], v[238:241], v[130:133]
    v_mul_f32 v170, v170, v242
    v_mul_f32 v174, v198, v174
    v_mfma_f32_16x16x32_bf16 v[190:193], a[72:75], v[186:189], 0
    ds_write_b64 v4, v[254:255] offset:18432
    v_mfma_f32_16x16x32_bf16 v[190:193], a[76:79], v[118:121], v[190:193]
    v_mul_f32_dpp v170, v126, v242 quad_perm:[0,1,2,3] row_mask:0x2 bank_mask:0xf
    v_mul_f32 v175, v198, v175
    v_mfma_f32_16x16x32_bf16 v[190:193], a[80:83], v[234:237], v[190:193]
    v_mul_f32_dpp v170, v130, v242 quad_perm:[0,1,2,3] row_mask:0x4 bank_mask:0xf
    v_cvt_pk_bf16_f32 v170, v170, v170
    v_mfma_f32_16x16x32_bf16 v[190:193], a[84:87], v[158:161], v[190:193]
    ds_write_b16 v7, v170
    v_mfma_f32_16x16x32_bf16 v[190:193], a[88:91], v[182:185], v[190:193]
    v_cvt_pk_bf16_f32 v254, v174, v175
    v_mul_f32 v176, v198, v176
    v_mfma_f32_16x16x32_bf16 v[190:193], a[92:95], v[206:209], v[190:193]
    v_mul_f32 v177, v198, v177
    v_cvt_pk_bf16_f32 v255, v176, v177
    v_mfma_f32_16x16x32_bf16 v[130:133], a[96:99], v[186:189], 0
    ds_write_b64 v4, v[254:255] offset:16384
    v_mfma_f32_16x16x32_bf16 v[130:133], a[100:103], v[118:121], v[130:133]
    v_mul_f32 v148, v178, v148
    v_mul_f32 v149, v178, v149
    v_mfma_f32_16x16x32_bf16 v[130:133], a[104:107], v[234:237], v[130:133]
    v_cvt_pk_bf16_f32 v147, v148, v149
    v_mul_f32 v246, v178, v246
    v_mfma_f32_16x16x32_bf16 v[130:133], a[108:111], v[158:161], v[130:133]
    v_mul_f32 v247, v178, v247
    v_cvt_pk_bf16_f32 v148, v246, v247
    v_mfma_f32_16x16x32_bf16 v[130:133], a[112:115], v[182:185], v[130:133]
    v_mul_f32 v248, v178, v248
    v_mul_f32 v249, v178, v249
    v_mfma_f32_16x16x32_bf16 v[130:133], a[116:119], v[206:209], v[130:133]
    v_cvt_pk_bf16_f32 v149, v248, v249
    v_mul_f32 v222, v178, v222
    v_mfma_f32_16x16x32_bf16 v[126:129], a[120:123], v[186:189], 0
    ds_write_b128 v3, v[146:149] offset:0
    v_mfma_f32_16x16x32_bf16 v[126:129], a[124:127], v[118:121], v[126:129]
    v_mul_f32 v223, v178, v223
    v_cvt_pk_bf16_f32 v254, v222, v223
    v_mfma_f32_16x16x32_bf16 v[126:129], a[128:131], v[234:237], v[126:129]
    v_mul_f32 v224, v178, v224
    v_mul_f32 v225, v178, v225
    v_mfma_f32_16x16x32_bf16 v[126:129], a[132:135], v[158:161], v[126:129]
    v_cvt_pk_bf16_f32 v255, v224, v225
    v_xor_b32 v3, 65536, v3
    v_mfma_f32_16x16x32_bf16 v[126:129], a[136:139], v[182:185], v[126:129]
    ds_write_b64 v4, v[254:255] offset:4096
    v_mfma_f32_16x16x32_bf16 v[126:129], a[140:143], v[206:209], v[126:129]
    v_xor_b32 v4, 65536, v4
    v_cvt_pk_f16_f32 v194, v190, v191
    v_mfma_f32_16x16x32_bf16 v[142:145], a[0:3], v[186:189], 0
    v_pk_mul_f16 v191, v194, v194
    v_cvt_pk_f16_f32 v195, v192, v193
    v_mfma_f32_16x16x32_bf16 v[142:145], a[4:7], v[118:121], v[142:145]
    v_pk_fma_f16 v191, v195, v195, v191
    v_cvt_pk_f16_f32 v196, v130, v131
    v_mfma_f32_16x16x32_bf16 v[142:145], a[8:11], v[234:237], v[142:145]
    v_pk_fma_f16 v191, v196, v196, v191
    v_cvt_pk_f16_f32 v197, v132, v133
    v_mfma_f32_16x16x32_bf16 v[142:145], a[12:15], v[158:161], v[142:145]
    v_pk_fma_f16 v191, v197, v197, v191
    v_cvt_pk_f16_f32 v148, v126, v127
    v_mfma_f32_16x16x32_bf16 v[142:145], a[16:19], v[182:185], v[142:145]
    v_pk_fma_f16 v191, v148, v148, v191
    v_cvt_pk_f16_f32 v149, v128, v129
    v_mfma_f32_16x16x32_bf16 v[142:145], a[20:23], v[206:209], v[142:145]
    s_waitcnt lgkmcnt(0)
    v_pk_fma_f16 v191, v149, v149, v191
    v_add_u32 v7, s76, v7
    v_mfma_f32_16x16x32_bf16 v[126:129], a[24:27], v[186:189], 0
    s_nop 0
    v_mfma_f32_16x16x32_bf16 v[126:129], a[28:31], v[118:121], v[126:129]
    s_nop 0
    v_mfma_f32_16x16x32_bf16 v[126:129], a[32:35], v[234:237], v[126:129]
    s_nop 0
    v_mfma_f32_16x16x32_bf16 v[126:129], a[36:39], v[158:161], v[126:129]
    s_barrier
    v_mfma_f32_16x16x32_bf16 v[126:129], a[40:43], v[182:185], v[126:129]
    v_mfma_f32_16x16x32_bf16 v[126:129], a[44:47], v[206:209], v[126:129]
    s_cbranch_scc1 L_loop_fast3
L_final_fast:
    v_mfma_f32_16x16x32_bf16 v[178:181], a[48:51], v[186:189], 0
    s_mov_b32 s12, s40
    ds_read_b128 v[170:173], v2 offset:18432
    ds_read_b128 v[134:137], v2 offset:19456
    v_mfma_f32_16x16x32_bf16 v[178:181], a[52:55], v[118:121], v[178:181]
    s_mov_b32 s13, s41
    ds_read_b128 v[174:177], v5 offset:32
    ds_read2_b64 v[130:133], v5 offset0:6 offset1:9
    v_mfma_f32_16x16x32_bf16 v[178:181], a[56:59], v[234:237], v[178:181]
    s_mov_b32 s14, s36
    v_cvt_pk_f16_f32 v142, v142, v143
    v_pk_mul_f16 v190, v142, v142
    v_mfma_f32_16x16x32_bf16 v[178:181], a[60:63], v[158:161], v[178:181]
    s_add_u32 s48, s40, s27
    ds_read_b128 v[210:213], v5
    ds_read_b32 v254, v6 offset:192
    v_mfma_f32_16x16x32_bf16 v[178:181], a[64:67], v[182:185], v[178:181]
    s_addc_u32 s49, s41, 0
    v_cvt_pk_f16_f32 v143, v144, v145
    v_pk_fma_f16 v190, v143, v143, v190
    v_mfma_f32_16x16x32_bf16 v[178:181], a[68:71], v[206:209], v[178:181]
    s_sub_u32 s50, s36, s27
    v_cvt_pk_f16_f32 v144, v126, v127
    v_pk_fma_f16 v190, v144, v144, v190
    v_mfma_f32_16x16x32_bf16 v[198:201], v[186:189], a[144:147], 0
    s_mov_b32 s51, 0x00020000
    v_cvt_pk_f16_f32 v145, v128, v129
    v_pk_fma_f16 v190, v145, v145, v190
    v_mfma_f32_16x16x32_bf16 v[198:201], v[118:121], a[148:151], v[198:201]
    s_waitcnt lgkmcnt(4)
    v_cvt_pk_f16_f32 v146, v178, v179
    v_pk_fma_f16 v190, v146, v146, v190
    v_mfma_f32_16x16x32_bf16 v[126:129], v[32:35], v[170:173], 0
    s_waitcnt lgkmcnt(2)
    v_cvt_pk_f16_f32 v147, v180, v181
    v_pk_fma_f16 v190, v147, v147, v190
    v_mfma_f32_16x16x32_bf16 v[126:129], v[32:35], v[134:137], v[126:129]
    s_add_u32 s52, s40, s26
    v_pk_mul_f16 v193, v194, v174
    v_pk_fma_f16 v193, v195, v175, v193
    v_mfma_f32_16x16x32_bf16 v[198:201], v[234:237], a[152:155], v[198:201]
    s_waitcnt lgkmcnt(0)
    v_mov_b32_dpp v254, v23 quad_perm:[0,1,2,3] row_mask:0x7 bank_mask:0xf
    v_pk_fma_f16 v193, v196, v176, v193
    v_mfma_f32_16x16x32_bf16 v[198:201], v[158:161], a[156:159], v[198:201]
    s_addc_u32 s53, s41, 0
    v_mul_f32 v192, 0x3baaaaab, v127
    v_mul_f32 v255, 0x3baaaaab, v126
    v_mfma_f32_16x16x32_bf16 v[198:201], v[182:185], a[160:163], v[198:201]
    s_sub_u32 s54, s36, s26
    v_rsq_f32 v192, v192
    v_mfma_f32_16x16x32_bf16 v[198:201], v[206:209], a[164:167], v[198:201]
    s_mov_b32 s55, 0x00020000
    v_mul_f32 v114, v192, v114
    v_mul_f32 v115, v192, v115
    v_mfma_f32_16x16x32_bf16 v[134:137], v[186:189], a[168:171], 0
    s_add_u32 s56, s40, s25
    v_cvt_pk_bf16_f32 v114, v114, v115
    v_mul_f32 v116, v192, v116
    v_mfma_f32_16x16x32_bf16 v[134:137], v[118:121], a[172:175], v[134:137]
    s_addc_u32 s57, s41, 0
    v_mul_f32 v117, v192, v117
    v_cvt_pk_bf16_f32 v115, v116, v117
    v_mfma_f32_16x16x32_bf16 v[134:137], v[234:237], a[176:179], v[134:137]
    s_sub_u32 s58, s36, s25
    v_mul_f32 v166, v192, v166
    v_mul_f32 v167, v192, v167
    v_mfma_f32_16x16x32_bf16 v[134:137], v[158:161], a[180:183], v[134:137]
    s_mov_b32 s59, 0x00020000
    v_cvt_pk_bf16_f32 v116, v166, v167
    v_mul_f32 v168, v192, v168
    v_mfma_f32_16x16x32_bf16 v[134:137], v[182:185], a[184:187], v[134:137]
    s_and_b32 s6, s2, 7
    ds_read_b128 v[170:173], v0 offset:26624
    v_mul_f32 v169, v192, v169
    v_mfma_f32_16x16x32_bf16 v[134:137], v[206:209], a[188:191], v[134:137]
    s_sub_u32 s6, 0, s6
    ds_read_b128 v[178:181], v1 offset:26624
    v_cvt_pk_bf16_f32 v117, v168, v169
    v_mfma_f32_16x16x32_bf16 v[166:169], v[186:189], a[192:195], 0
    s_lshl_b32 s3, s16, 6
    ds_read_b128 v[186:189], v0 offset:26752
    buffer_store_dwordx4 v[114:117], v16, s[48:51], 0 offen nt
    v_mul_f32 v230, v192, v230
    v_mul_f32 v231, v192, v231
    v_cvt_pk_bf16_f32 v126, v230, v231
    v_mul_f32 v232, v192, v232
    v_mfma_f32_16x16x32_bf16 v[166:169], v[118:121], a[196:199], v[166:169]
    s_lshl_b32 s4, s16, 5
    ds_read_b128 v[114:117], v1 offset:26752
    v_mul_f32 v233, v192, v233
    v_mfma_f32_16x16x32_bf16 v[166:169], v[234:237], a[200:203], v[166:169]
    s_add_u32 s4, s4, 256
    ds_read_b128 v[118:121], v0 offset:26880
    v_cvt_pk_bf16_f32 v127, v232, v233
    v_mfma_f32_16x16x32_bf16 v[166:169], v[158:161], a[204:207], v[166:169]
    s_mul_i32 s5, s16, 9408
    ds_read_b128 v[158:161], v1 offset:26880
    v_pk_fma_f16 v193, v197, v177, v193
    v_mfma_f32_16x16x32_bf16 v[166:169], v[182:185], a[208:211], v[166:169]
    s_waitcnt lgkmcnt(5)
    v_rsq_f32 v255, v255
    v_mfma_f32_16x16x32_bf16 v[166:169], v[206:209], a[212:215], v[166:169]
    s_add_u32 s5, s5, 104448
    v_mul_f32 v122, v255, v122
    v_mul_f32 v123, v255, v123
    v_mfma_f32_16x16x32_bf16 v[182:185], a[72:75], v[170:173], 0
    s_waitcnt lgkmcnt(3)
    v_cvt_pk_bf16_f32 v122, v122, v123
    v_mul_f32 v124, v255, v124
    v_mfma_f32_16x16x32_bf16 v[182:185], a[76:79], v[178:181], v[182:185]
    v_mul_f32 v125, v255, v125
    v_cvt_pk_bf16_f32 v123, v124, v125
    v_mfma_f32_16x16x32_bf16 v[182:185], a[80:83], v[186:189], v[182:185]
    s_waitcnt lgkmcnt(2)
    ds_read_b128 v[226:229], v2 offset:0
    ds_read_b128 v[214:217], v2 offset:1024
    v_mfma_f32_16x16x32_bf16 v[182:185], a[84:87], v[114:117], v[182:185]
    s_waitcnt lgkmcnt(3)
    ds_read_b128 v[206:209], v2 offset:2048
    ds_read_b128 v[218:221], v2 offset:3072
    v_mfma_f32_16x16x32_bf16 v[182:185], a[88:91], v[118:121], v[182:185]
    s_waitcnt lgkmcnt(4)
    v_mul_f32 v154, v255, v154
    v_mul_f32 v155, v255, v155
    v_mfma_f32_16x16x32_bf16 v[182:185], a[92:95], v[158:161], v[182:185]
    ds_read_b128 v[230:233], v2 offset:4096
    ds_read_b128 v[234:237], v2 offset:5120
    v_mfma_f32_16x16x32_bf16 v[222:225], a[96:99], v[170:173], 0
    v_cvt_pk_bf16_f32 v124, v154, v155
    v_mul_f32 v156, v255, v156
    v_mfma_f32_16x16x32_bf16 v[222:225], a[100:103], v[178:181], v[222:225]
    v_mul_f32 v157, v255, v157
    v_cvt_pk_bf16_f32 v125, v156, v157
    v_mfma_f32_16x16x32_bf16 v[222:225], a[104:107], v[186:189], v[222:225]
    v_mul_f32 v202, v255, v202
    v_mul_f32 v203, v255, v203
    v_mfma_f32_16x16x32_bf16 v[222:225], a[108:111], v[114:117], v[222:225]
    s_waitcnt lgkmcnt(4)
    v_cvt_pk_bf16_f32 v202, v202, v203
    v_mul_f32 v204, v255, v204
    v_mfma_f32_16x16x32_bf16 v[154:157], a[216:219], v[226:229], 0
    s_waitcnt lgkmcnt(2)
    buffer_store_dwordx2 v[126:127], v19, s[48:51], 0 offen nt
    v_mul_f32 v205, v255, v205
    v_cvt_pk_bf16_f32 v203, v204, v205
    v_mfma_f32_16x16x32_bf16 v[154:157], a[220:223], v[214:217], v[154:157]
    v_pk_fma_f16 v193, v148, v132, v193
    v_pk_fma_f16 v193, v149, v133, v193
    v_mfma_f32_16x16x32_bf16 v[154:157], a[224:227], v[206:209], v[154:157]
    s_waitcnt lgkmcnt(0)
    v_pk_mul_f16 v192, v142, v210
    v_pk_fma_f16 v192, v143, v211, v192
    v_mfma_f32_16x16x32_bf16 v[154:157], a[228:231], v[218:221], v[154:157]
    v_pk_fma_f16 v192, v144, v212, v192
    v_pk_fma_f16 v192, v145, v213, v192
    v_mfma_f32_16x16x32_bf16 v[154:157], a[232:235], v[230:233], v[154:157]
    v_pk_fma_f16 v192, v146, v130, v192
    v_pk_fma_f16 v192, v147, v131, v192
    v_mfma_f32_16x16x32_bf16 v[154:157], a[236:239], v[234:237], v[154:157]
    v_cvt_pk_bf16_f32 v238, v198, v199
    v_cvt_pk_bf16_f32 v239, v200, v201
    v_mfma_f32_16x16x32_f16 v[198:201], v[40:43], v[190:193], 0
    v_cvt_pk_bf16_f32 v190, v134, v135
    v_cvt_pk_bf16_f32 v191, v136, v137
    v_mfma_f32_16x16x32_bf16 v[134:137], a[240:243], v[226:229], 0
    v_cvt_pk_bf16_f32 v126, v166, v167
    v_cvt_pk_bf16_f32 v127, v168, v169
    v_mfma_f32_16x16x32_bf16 v[134:137], a[244:247], v[214:217], v[134:137]
    v_fma_f32 v255, v154, v154, s33
    v_fmac_f32 v255, v155, v155
    v_mfma_f32_16x16x32_bf16 v[134:137], a[248:251], v[206:209], v[134:137]
    v_fmac_f32 v255, v156, v156
    v_fmac_f32 v255, v157, v157
    v_mfma_f32_16x16x32_bf16 v[134:137], a[252:255], v[218:221], v[134:137]
    v_rsq_f32 v198, v198
    v_mfma_f32_16x16x32_bf16 v[134:137], v[82:85], v[230:233], v[134:137]
    v_rsq_f32 v199, v199
    v_mfma_f32_16x16x32_bf16 v[134:137], v[86:89], v[234:237], v[134:137]
    v_mul_f32 v192, s31, v198
    v_cvt_pk_f16_f32 v193, v192, v199
    v_mfma_f32_16x16x32_bf16 v[242:245], v[90:93], v[226:229], 0
    ds_read_b128 v[166:169], v2 offset:6144
    v_fma_f32 v200, v200, v192, v22
    v_mfma_f32_16x16x32_bf16 v[242:245], v[94:97], v[214:217], v[242:245]
    ds_read_b128 v[226:229], v2 offset:7168
    v_fmac_f32_dpp v254, v201, v199 quad_perm:[0,1,2,3] row_mask:0x1 bank_mask:0xf
    v_mfma_f32_16x16x32_bf16 v[242:245], v[98:101], v[206:209], v[242:245]
    ds_read_b128 v[214:217], v2 offset:8192
    v_fmac_f32 v255, v134, v134
    v_mfma_f32_16x16x32_bf16 v[242:245], v[102:105], v[218:221], v[242:245]
    ds_read_b128 v[206:209], v2 offset:9216
    buffer_store_dwordx4 v[122:125], v15, s[48:51], 0 offen nt
    v_fmac_f32 v255, v135, v135
    v_fmac_f32 v255, v136, v136
    v_fmac_f32 v255, v137, v137
    v_pk_mul_f16 v194, v194, v193 op_sel:[0,1] op_sel_hi:[1,1]
    v_mfma_f32_16x16x32_bf16 v[242:245], v[106:109], v[230:233], v[242:245]
    ds_read_b128 v[122:125], v2 offset:10240
    v_pk_mul_f16 v195, v195, v193 op_sel:[0,1] op_sel_hi:[1,1]
    v_mfma_f32_16x16x32_bf16 v[242:245], v[110:113], v[234:237], v[242:245]
    ds_read_b128 v[218:221], v2 offset:11264
    v_pk_mul_f16 v196, v196, v193 op_sel:[0,1] op_sel_hi:[1,1]
    v_mfma_f32_16x16x32_bf16 v[222:225], a[112:115], v[118:121], v[222:225]
    s_waitcnt lgkmcnt(5)
    v_pk_mul_f16 v197, v197, v193 op_sel:[0,1] op_sel_hi:[1,1]
    v_pk_mul_f16 v148, v148, v193 op_sel:[0,1] op_sel_hi:[1,1]
    v_mfma_f32_16x16x32_bf16 v[230:233], a[216:219], v[166:169], 0
    s_waitcnt lgkmcnt(4)
    v_fmac_f32 v255, v242, v242
    v_fmac_f32 v255, v243, v243
    v_mfma_f32_16x16x32_bf16 v[230:233], a[220:223], v[226:229], v[230:233]
    s_waitcnt lgkmcnt(3)
    v_fmac_f32 v255, v244, v244
    v_fmac_f32 v255, v245, v245
    v_mfma_f32_16x16x32_bf16 v[230:233], a[224:227], v[214:217], v[230:233]
    s_waitcnt lgkmcnt(2)
    v_pk_mul_f16 v149, v149, v193 op_sel:[0,1] op_sel_hi:[1,1]
    v_pk_mul_f16 v142, v142, v193 op_sel:[0,0] op_sel_hi:[1,0]
    v_mfma_f32_16x16x32_bf16 v[230:233], a[228:231], v[206:209], v[230:233]
    v_pk_mul_f16 v143, v143, v193 op_sel:[0,0] op_sel_hi:[1,0]
    v_pk_mul_f16 v144, v144, v193 op_sel:[0,0] op_sel_hi:[1,0]
    v_mfma_f32_16x16x32_bf16 v[222:225], a[116:119], v[158:161], v[222:225]
    s_waitcnt lgkmcnt(1)
    v_pk_mul_f16 v145, v145, v193 op_sel:[0,0] op_sel_hi:[1,0]
    v_pk_mul_f16 v146, v146, v193 op_sel:[0,0] op_sel_hi:[1,0]
    v_mfma_f32_16x16x32_bf16 v[230:233], a[232:235], v[122:125], v[230:233]
    s_waitcnt lgkmcnt(0)
    v_pk_mul_f16 v147, v147, v193 op_sel:[0,0] op_sel_hi:[1,0]
    v_max3_u32 v44, v44, v198, v199
    v_mfma_f32_16x16x32_bf16 v[230:233], a[236:239], v[218:221], v[230:233]
    v_mov_b32 v198, 0x40000000
    v_cvt_pk_f16_f32 v246, v182, v183
    v_mfma_f32_16x16x32_bf16 v[234:237], a[240:243], v[166:169], 0
    v_pk_mul_f16 v183, v246, v246
    v_cvt_pk_f16_f32 v247, v184, v185
    v_mfma_f32_16x16x32_bf16 v[234:237], a[244:247], v[226:229], v[234:237]
    v_pk_fma_f16 v183, v247, v247, v183
    v_cvt_pk_f16_f32 v248, v222, v223
    v_mfma_f32_16x16x32_bf16 v[234:237], a[248:251], v[214:217], v[234:237]
    v_pk_fma_f16 v183, v248, v248, v183
    v_cvt_pk_f16_f32 v249, v224, v225
    v_mfma_f32_16x16x32_bf16 v[234:237], a[252:255], v[206:209], v[234:237]
    v_pk_fma_f16 v183, v249, v249, v183
    v_pk_mul_f16 v185, v246, v174
    v_mfma_f32_16x16x32_bf16 v[234:237], v[82:85], v[122:125], v[234:237]
    v_pk_fma_f16 v185, v247, v175, v185
    v_pk_fma_f16 v185, v248, v176, v185
    v_mfma_f32_16x16x32_bf16 v[234:237], v[86:89], v[218:221], v[234:237]
    buffer_store_dwordx2 v[202:203], v18, s[48:51], 0 offen nt
    v_pk_fma_f16 v185, v249, v177, v185
    v_fma_f32 v129, v230, v230, s33
    v_mfma_f32_16x16x32_bf16 v[222:225], v[90:93], v[166:169], 0
    v_fmac_f32 v129, v231, v231
    v_fmac_f32 v129, v232, v232
    v_mfma_f32_16x16x32_bf16 v[222:225], v[94:97], v[226:229], v[222:225]
    v_fmac_f32 v129, v233, v233
    v_fmac_f32 v129, v234, v234
    v_mfma_f32_16x16x32_bf16 v[222:225], v[98:101], v[214:217], v[222:225]
    v_fmac_f32 v129, v235, v235
    v_fmac_f32 v129, v236, v236
    v_mfma_f32_16x16x32_bf16 v[222:225], v[102:105], v[206:209], v[222:225]
    v_fmac_f32 v129, v237, v237
    v_mul_f32 v128, 0x3baaaaab, v128
    v_mfma_f32_16x16x32_bf16 v[222:225], v[106:109], v[122:125], v[222:225]
    v_rsq_f32 v128, v128
    v_mfma_f32_16x16x32_bf16 v[222:225], v[110:113], v[218:221], v[222:225]
    v_mul_f32 v150, v128, v150
    v_mul_f32 v151, v128, v151
    v_mfma_f32_16x16x32_bf16 v[122:125], a[120:123], v[170:173], 0
    v_cvt_pk_bf16_f32 v150, v150, v151
    v_mul_f32 v152, v128, v152
    v_mfma_f32_16x16x32_bf16 v[122:125], a[124:127], v[178:181], v[122:125]
    v_mul_f32 v153, v128, v153
    v_cvt_pk_bf16_f32 v151, v152, v153
    v_mfma_f32_16x16x32_bf16 v[122:125], a[128:131], v[186:189], v[122:125]
    v_fmac_f32 v129, v222, v222
    v_fmac_f32 v129, v223, v223
    v_mfma_f32_16x16x32_bf16 v[122:125], a[132:135], v[114:117], v[122:125]
    v_fmac_f32 v129, v224, v224
    v_fmac_f32 v129, v225, v225
    v_mfma_f32_16x16x32_bf16 v[122:125], a[136:139], v[118:121], v[122:125]
    v_cvt_pk_bf16_f32 v192, v255, v129
    v_cvt_pk_bf16_f32 v193, v129, v129
    v_mfma_f32_16x16x32_bf16 v[122:125], a[140:143], v[158:161], v[122:125]
    v_mul_f32 v162, v128, v162
    v_mul_f32 v163, v128, v163
    v_mfma_f32_16x16x32_bf16 v[166:169], a[0:3], v[170:173], 0
    v_cvt_pk_bf16_f32 v152, v162, v163
    v_mul_f32 v164, v128, v164
    v_mfma_f32_16x16x32_bf16 v[166:169], a[4:7], v[178:181], v[166:169]
    v_mul_f32 v165, v128, v165
    v_cvt_pk_bf16_f32 v153, v164, v165
    v_mfma_f32_16x16x32_bf16 v[166:169], a[8:11], v[186:189], v[166:169]
    v_cvt_pk_f16_f32 v164, v122, v123
    v_pk_fma_f16 v183, v164, v164, v183
    v_mfma_f32_16x16x32_bf16 v[166:169], a[12:15], v[114:117], v[166:169]
    buffer_store_dwordx4 v[150:153], v17, s[48:51], 0 offen nt
    v_cvt_pk_f16_f32 v165, v124, v125
    v_pk_fma_f16 v183, v165, v165, v183
    v_pk_fma_f16 v185, v164, v132, v185
    v_pk_fma_f16 v185, v165, v133, v185
    v_mfma_f32_16x16x32_bf16 v[166:169], a[16:19], v[118:121], v[166:169]
    v_mul_f32 v138, v128, v138
    v_mul_f32 v139, v128, v139
    v_mfma_f32_16x16x32_bf16 v[166:169], a[20:23], v[158:161], v[166:169]
    v_cvt_pk_bf16_f32 v162, v138, v139
    v_mul_f32 v140, v128, v140
    v_mfma_f32_16x16x32_bf16 v[122:125], a[24:27], v[170:173], 0
    v_mul_f32 v141, v128, v141
    v_cvt_pk_bf16_f32 v163, v140, v141
    v_mfma_f32_16x16x32_bf16 v[122:125], a[28:31], v[178:181], v[122:125]
    v_bfe_u32 v201, v2, 4, 6
    v_lshrrev_b32 v255, 4, v201
    v_mfma_f32_16x16x32_bf16 v[122:125], a[32:35], v[186:189], v[122:125]
    v_cvt_pk_f16_f32 v150, v166, v167
    v_pk_mul_f16 v182, v150, v150
    v_mfma_f32_16x16x32_bf16 v[122:125], a[36:39], v[114:117], v[122:125]
    v_cvt_pk_f16_f32 v151, v168, v169
    v_pk_fma_f16 v182, v151, v151, v182
    v_mfma_f32_16x16x32_bf16 v[122:125], a[40:43], v[118:121], v[122:125]
    v_pk_mul_f16 v184, v150, v210
    v_pk_fma_f16 v184, v151, v211, v184
    v_mfma_f32_16x16x32_bf16 v[122:125], a[44:47], v[158:161], v[122:125]
    v_and_b32 v199, 15, v201
    v_add_u32 v128, 0, v199
    v_mfma_f32_16x16x32_bf16 v[138:141], a[48:51], v[170:173], 0
    v_mul_u32_u24 v129, s20, v128
    v_add_u32 v129, s38, v129
    v_mfma_f32_16x16x32_bf16 v[138:141], a[52:55], v[178:181], v[138:141]
    v_mul_u32_u24 v152, 911, v129
    v_lshrrev_b32 v152, 16, v152
    v_mfma_f32_16x16x32_bf16 v[138:141], a[56:59], v[186:189], v[138:141]
    v_mul_u32_u24 v152, s22, v152
    v_mad_u32_u24 v152, v128, s21, v152
    v_mfma_f32_16x16x32_bf16 v[138:141], a[60:63], v[114:117], v[138:141]
    v_bfe_u32 v129, s63, v128, 1
    v_cmp_ne_u32 vcc, 0, v129
    v_mfma_f32_16x16x32_bf16 v[138:141], a[64:67], v[118:121], v[138:141]
    v_add_u32 v128, s7, v152
    v_cndmask_b32 v128, v198, v128, vcc
    v_mfma_f32_16x16x32_bf16 v[138:141], a[68:71], v[158:161], v[138:141]
    v_lshl_add_u32 v167, v255, 4, v128
    v_add_u32 v167, s3, v167
    v_mfma_f32_16x16x32_bf16 v[202:205], v[170:173], a[144:147], 0
    v_lshl_add_u32 v166, v255, 3, v128
    v_add_u32 v166, s4, v166
    v_mfma_f32_16x16x32_bf16 v[202:205], v[178:181], a[148:151], v[202:205]
    buffer_store_dwordx2 v[162:163], v20, s[48:51], 0 offen nt
    v_cvt_pk_f16_f32 v152, v122, v123
    v_pk_fma_f16 v182, v152, v152, v182
    v_mfma_f32_16x16x32_bf16 v[202:205], v[186:189], a[152:155], v[202:205]
    v_cvt_pk_f16_f32 v153, v124, v125
    v_pk_fma_f16 v182, v153, v153, v182
    v_mfma_f32_16x16x32_bf16 v[202:205], v[114:117], a[156:159], v[202:205]
    v_cvt_pk_f16_f32 v162, v138, v139
    v_pk_fma_f16 v182, v162, v162, v182
    v_mfma_f32_16x16x32_bf16 v[202:205], v[118:121], a[160:163], v[202:205]
    v_cvt_pk_f16_f32 v163, v140, v141
    v_pk_fma_f16 v182, v163, v163, v182
    v_mfma_f32_16x16x32_bf16 v[202:205], v[158:161], a[164:167], v[202:205]
    v_pk_fma_f16 v184, v152, v212, v184
    v_pk_fma_f16 v184, v153, v213, v184
    v_mfma_f32_16x16x32_bf16 v[122:125], v[170:173], a[168:171], 0
    v_pk_fma_f16 v184, v162, v130, v184
    v_pk_fma_f16 v184, v163, v131, v184
    v_mfma_f32_16x16x32_bf16 v[122:125], v[178:181], a[172:175], v[122:125]
    v_lshlrev_b32 v206, 9, v255
    v_lshl_add_u32 v206, v199, 4, v206
    v_mfma_f32_16x16x32_f16 v[214:217], v[40:43], v[182:185], 0
    v_cvt_pk_bf16_f32 v240, v202, v203
    v_cvt_pk_bf16_f32 v241, v204, v205
    v_mfma_f32_16x16x32_bf16 v[122:125], v[186:189], a[176:179], v[122:125]
    v_add_u32 v206, 149696, v206
    v_and_b32 v168, 0xffff, v2
    v_mfma_f32_16x16x32_bf16 v[122:125], v[114:117], a[180:183], v[122:125]
    v_add_u32 v168, 38912, v168
    v_and_b32 v169, 0xffff, v4
    v_mfma_f32_16x16x32_bf16 v[122:125], v[118:121], a[184:187], v[122:125]
    ds_read_b128 v[138:141], v0 offset:32768
    v_add_u32 v169, 38912, v169
    v_mfma_f32_16x16x32_bf16 v[122:125], v[158:161], a[188:191], v[122:125]
    ds_read_b128 v[182:185], v1 offset:32768
    v_add_u32 v208, 16, v199
    v_mfma_f32_16x16x32_bf16 v[202:205], v[170:173], a[192:195], 0
    ds_read_b128 v[218:221], v0 offset:32896
    v_min_u32 v207, 20, v208
    v_mfma_f32_16x16x32_bf16 v[202:205], v[178:181], a[196:199], v[202:205]
    ds_write_b64 v169, v[192:193] offset:0
    v_mfma_f32_16x16x32_bf16 v[202:205], v[186:189], a[200:203], v[202:205]
    v_rsq_f32 v214, v214
    v_mfma_f32_16x16x32_bf16 v[202:205], v[114:117], a[204:207], v[202:205]
    ds_read_b128 v[114:117], v1 offset:32896
    ds_read_b128 v[170:173], v0 offset:33024
    v_mfma_f32_16x16x32_bf16 v[202:205], v[118:121], a[208:211], v[202:205]
    ds_read_b128 v[178:181], v1 offset:33024
    v_mul_f32 v186, s31, v214
    v_mfma_f32_16x16x32_bf16 v[202:205], v[158:161], a[212:215], v[202:205]
    s_waitcnt lgkmcnt(6)
    v_rsq_f32 v215, v215
    v_mfma_f32_16x16x32_bf16 v[118:121], a[72:75], v[138:141], 0
    s_waitcnt lgkmcnt(5)
    v_cvt_pk_f16_f32 v187, v186, v215
    v_fma_f32 v216, v216, v186, v24
    v_mfma_f32_16x16x32_bf16 v[118:121], a[76:79], v[182:185], v[118:121]
    s_waitcnt lgkmcnt(4)
    v_fmac_f32_dpp v254, v217, v215 quad_perm:[0,1,2,3] row_mask:0x2 bank_mask:0xf
    v_cvt_pk_bf16_f32 v192, v122, v123
    v_mfma_f32_16x16x32_bf16 v[118:121], a[80:83], v[218:221], v[118:121]
    s_waitcnt lgkmcnt(3)
    v_cvt_pk_bf16_f32 v193, v124, v125
    v_cvt_pk_bf16_f32 v128, v202, v203
    v_mfma_f32_16x16x32_bf16 v[122:125], a[96:99], v[138:141], 0
    s_barrier
    ds_read_b128 v[158:161], v168 offset:0
    v_cvt_pk_bf16_f32 v129, v204, v205
    v_mfma_f32_16x16x32_bf16 v[122:125], a[100:103], v[182:185], v[122:125]
    s_waitcnt lgkmcnt(2)
    v_pk_mul_f16 v246, v246, v187 op_sel:[0,1] op_sel_hi:[1,1]
    v_pk_mul_f16 v247, v247, v187 op_sel:[0,1] op_sel_hi:[1,1]
    v_mfma_f32_16x16x32_bf16 v[118:121], a[84:87], v[114:117], v[118:121]
    s_waitcnt lgkmcnt(1)
    v_pk_mul_f16 v248, v248, v187 op_sel:[0,1] op_sel_hi:[1,1]
    v_pk_mul_f16 v249, v249, v187 op_sel:[0,1] op_sel_hi:[1,1]
    v_mfma_f32_16x16x32_bf16 v[118:121], a[88:91], v[170:173], v[118:121]
    v_pk_mul_f16 v164, v164, v187 op_sel:[0,1] op_sel_hi:[1,1]
    v_pk_mul_f16 v165, v165, v187 op_sel:[0,1] op_sel_hi:[1,1]
    v_mfma_f32_16x16x32_bf16 v[118:121], a[92:95], v[178:181], v[118:121]
    v_pk_mul_f16 v150, v150, v187 op_sel:[0,0] op_sel_hi:[1,0]
    v_pk_mul_f16 v151, v151, v187 op_sel:[0,0] op_sel_hi:[1,0]
    v_mfma_f32_16x16x32_bf16 v[122:125], a[104:107], v[218:221], v[122:125]
    v_pk_mul_f16 v152, v152, v187 op_sel:[0,0] op_sel_hi:[1,0]
    v_pk_mul_f16 v153, v153, v187 op_sel:[0,0] op_sel_hi:[1,0]
    v_mfma_f32_16x16x32_bf16 v[122:125], a[108:111], v[114:117], v[122:125]
    v_pk_mul_f16 v162, v162, v187 op_sel:[0,0] op_sel_hi:[1,0]
    v_pk_mul_f16 v163, v163, v187 op_sel:[0,0] op_sel_hi:[1,0]
    v_mfma_f32_16x16x32_bf16 v[122:125], a[112:115], v[170:173], v[122:125]
    s_waitcnt lgkmcnt(0)
    v_max3_u32 v44, v44, v214, v215
    v_cvt_pk_f16_f32 v118, v118, v119
    v_mfma_f32_16x16x32_bf16 v[202:205], v[32:35], v[158:161], 0
    ds_read_b128 v[158:161], v168 offset:1024
    v_pk_mul_f16 v187, v118, v118
    v_mfma_f32_16x16x32_bf16 v[122:125], a[116:119], v[178:181], v[122:125]
    v_cvt_pk_f16_f32 v119, v120, v121
    v_pk_fma_f16 v187, v119, v119, v187
    v_pk_mul_f16 v189, v118, v174
    v_pk_fma_f16 v189, v119, v175, v189
    v_exp_f32 v200, v200
    v_exp_f32 v216, v216
    v_cvt_pk_bf16_f32 v39, v200, 0
    v_add_u32 v200, 12, v208
    v_cvt_pk_f16_f32 v120, v122, v123
    v_pk_fma_f16 v187, v120, v120, v187
    v_cvt_pk_f16_f32 v121, v124, v125
    v_mfma_f32_16x16x32_bf16 v[122:125], a[120:123], v[138:141], 0
    v_pk_fma_f16 v187, v121, v121, v187
    v_pk_fma_f16 v189, v120, v176, v189
    v_mfma_f32_16x16x32_bf16 v[122:125], a[124:127], v[182:185], v[122:125]
    v_pk_fma_f16 v189, v121, v177, v189
    v_lshrrev_b32 v200, 5, v200
    v_mfma_f32_16x16x32_bf16 v[122:125], a[128:131], v[218:221], v[122:125]
    s_waitcnt lgkmcnt(0)
    v_sub_u32 v214, v208, v207
    v_mad_i32_i24 v214, v200, s6, v214
    v_mfma_f32_16x16x32_bf16 v[202:205], v[32:35], v[158:161], v[202:205]
    v_mul_u32_u24 v209, s20, v207
    v_add3_u32 v209, v209, v214, s38
    v_mfma_f32_16x16x32_bf16 v[122:125], a[132:135], v[114:117], v[122:125]
    v_mul_u32_u24 v200, 911, v209
    v_lshrrev_b32 v200, 16, v200
    v_mfma_f32_16x16x32_bf16 v[122:125], a[136:139], v[170:173], v[122:125]
    v_mul_u32_u24 v200, s22, v200
    v_mad_u32_u24 v200, v207, s21, v200
    v_mfma_f32_16x16x32_bf16 v[122:125], a[140:143], v[178:181], v[122:125]
    v_mul_f32 v186, 0x3baaaaab, v203
    v_mul_f32 v188, 0x3baaaaab, v202
    v_mfma_f32_16x16x32_bf16 v[174:177], a[0:3], v[138:141], 0
    v_rsq_f32 v186, v186
    v_mfma_f32_16x16x32_bf16 v[174:177], a[4:7], v[182:185], v[174:177]
    v_mul_f32 v230, v186, v230
    v_mul_f32 v231, v186, v231
    v_mfma_f32_16x16x32_bf16 v[174:177], a[8:11], v[218:221], v[174:177]
    v_cvt_pk_bf16_f32 v158, v230, v231
    v_mul_f32 v232, v186, v232
    v_mfma_f32_16x16x32_bf16 v[174:177], a[12:15], v[114:117], v[174:177]
    v_mul_f32 v233, v186, v233
    v_cvt_pk_bf16_f32 v159, v232, v233
    v_mfma_f32_16x16x32_bf16 v[174:177], a[16:19], v[170:173], v[174:177]
    v_mul_f32 v234, v186, v234
    v_mul_f32 v235, v186, v235
    v_mfma_f32_16x16x32_bf16 v[174:177], a[20:23], v[178:181], v[174:177]
    v_cvt_pk_bf16_f32 v160, v234, v235
    v_mul_f32 v236, v186, v236
    v_mfma_f32_16x16x32_bf16 v[202:205], a[24:27], v[138:141], 0
    v_mul_f32 v237, v186, v237
    v_cvt_pk_bf16_f32 v161, v236, v237
    v_mfma_f32_16x16x32_bf16 v[202:205], a[28:31], v[182:185], v[202:205]
    buffer_store_dwordx4 v[158:161], v16, s[52:55], 0 offen nt
    v_mul_f32 v222, v186, v222
    v_mul_f32 v223, v186, v223
    v_cvt_pk_bf16_f32 v222, v222, v223
    v_mul_f32 v224, v186, v224
    v_mfma_f32_16x16x32_bf16 v[202:205], a[32:35], v[218:221], v[202:205]
    v_mul_f32 v225, v186, v225
    v_cvt_pk_bf16_f32 v223, v224, v225
    v_mfma_f32_16x16x32_f16 v[158:161], v[194:197], v[142:145], v[46:49]
    v_rsq_f32 v188, v188
    v_mfma_f32_16x16x32_f16 v[226:229], v[246:249], v[142:145], v[50:53]
    v_mul_f32 v154, v188, v154
    v_mul_f32 v155, v188, v155
    v_mfma_f32_16x16x32_bf16 v[202:205], a[36:39], v[114:117], v[202:205]
    v_cvt_pk_bf16_f32 v154, v154, v155
    v_mul_f32 v156, v188, v156
    v_mul_f32 v157, v188, v157
    v_mfma_f32_16x16x16_f16 v[158:161], v[148:149], v[146:147], v[158:161]
    v_cvt_pk_bf16_f32 v155, v156, v157
    v_mul_f32 v134, v188, v134
    v_mul_f32 v135, v188, v135
    v_mfma_f32_16x16x16_f16 v[226:229], v[164:165], v[146:147], v[226:229]
    v_cvt_pk_bf16_f32 v156, v134, v135
    v_mul_f32 v136, v188, v136
    v_mul_f32 v137, v188, v137
    v_cvt_pk_bf16_f32 v157, v136, v137
    v_mfma_f32_16x16x32_bf16 v[202:205], a[40:43], v[170:173], v[202:205]
    v_mul_f32 v242, v188, v242
    v_mul_f32 v243, v188, v243
    v_mfma_f32_16x16x32_bf16 v[202:205], a[44:47], v[178:181], v[202:205]
    v_cvt_pk_bf16_f32 v224, v242, v243
    v_mul_f32 v244, v188, v244
    v_mfma_f32_16x16x32_bf16 v[230:233], a[48:51], v[138:141], 0
    v_mul_f32 v245, v188, v245
    v_cvt_pk_bf16_f32 v225, v244, v245
    v_mfma_f32_16x16x32_bf16 v[230:233], a[52:55], v[182:185], v[230:233]
    v_cvt_pk_f16_f32 v134, v174, v175
    v_pk_mul_f16 v186, v134, v134
    v_mfma_f32_16x16x32_bf16 v[230:233], a[56:59], v[218:221], v[230:233]
    v_cvt_pk_f16_f32 v135, v176, v177
    v_pk_fma_f16 v186, v135, v135, v186
    v_mfma_f32_16x16x32_bf16 v[230:233], a[60:63], v[114:117], v[230:233]
    v_cvt_pk_f16_f32 v136, v202, v203
    v_pk_fma_f16 v186, v136, v136, v186
    v_mfma_f32_16x16x32_bf16 v[230:233], a[64:67], v[170:173], v[230:233]
    v_cvt_pk_f16_f32 v137, v204, v205
    v_pk_fma_f16 v186, v137, v137, v186
    v_mfma_f32_16x16x32_bf16 v[230:233], a[68:71], v[178:181], v[230:233]
    v_pk_mul_f16 v188, v134, v210
    v_pk_fma_f16 v188, v135, v211, v188
    v_mfma_f32_16x16x32_bf16 v[202:205], v[138:141], a[144:147], 0
    buffer_store_dwordx2 v[222:223], v19, s[52:55], 0 offen nt
    v_pk_fma_f16 v188, v136, v212, v188
    v_pk_fma_f16 v188, v137, v213, v188
    v_mfma_f32_16x16x32_bf16 v[202:205], v[182:185], a[148:151], v[202:205]
    v_cvt_pk_f16_f32 v176, v122, v123
    v_cvt_pk_f16_f32 v174, v230, v231
    v_mfma_f32_16x16x32_bf16 v[202:205], v[218:221], a[152:155], v[202:205]
    v_pk_fma_f16 v186, v174, v174, v186
    v_cvt_pk_f16_f32 v175, v232, v233
    v_mfma_f32_16x16x32_bf16 v[202:205], v[114:117], a[156:159], v[202:205]
    v_pk_fma_f16 v186, v175, v175, v186
    v_pk_fma_f16 v188, v174, v130, v188
    v_mfma_f32_16x16x32_bf16 v[202:205], v[170:173], a[160:163], v[202:205]
    v_pk_fma_f16 v188, v175, v131, v188
    v_pk_fma_f16 v187, v176, v176, v187
    v_mfma_f32_16x16x32_bf16 v[202:205], v[178:181], a[164:167], v[202:205]
    v_cvt_pk_f16_f32 v177, v124, v125
    v_pk_fma_f16 v187, v177, v177, v187
    v_mfma_f32_16x16x32_bf16 v[122:125], v[138:141], a[168:171], 0
    v_pk_fma_f16 v189, v176, v132, v189
    v_pk_fma_f16 v189, v177, v133, v189
    v_mfma_f32_16x16x32_bf16 v[122:125], v[182:185], a[172:175], v[122:125]
    v_exp_f32 v158, v158
    v_mfma_f32_16x16x32_f16 v[210:213], v[40:43], v[186:189], 0
    v_cvt_pk_bf16_f32 v230, v202, v203
    v_cvt_pk_bf16_f32 v231, v204, v205
    v_mfma_f32_16x16x32_bf16 v[122:125], v[218:221], a[176:179], v[122:125]
    v_exp_f32 v159, v159
    v_mfma_f32_16x16x32_bf16 v[122:125], v[114:117], a[180:183], v[122:125]
    v_cvt_pk_bf16_f32 v130, v158, v159
    v_bfe_u32 v209, s63, v208, 1
    v_mfma_f32_16x16x32_bf16 v[122:125], v[170:173], a[184:187], v[122:125]
    v_rsq_f32 v210, v210
    v_mfma_f32_16x16x32_bf16 v[122:125], v[178:181], a[188:191], v[122:125]
    ds_read_b128 v[234:237], v2 offset:12288
    ds_read_b128 v[202:205], v2 offset:13312
    v_mfma_f32_16x16x32_bf16 v[186:189], v[138:141], a[192:195], 0
    ds_read_b128 v[138:141], v2 offset:14336
    ds_read_b128 v[242:245], v2 offset:15360
    v_mfma_f32_16x16x32_bf16 v[186:189], v[182:185], a[196:199], v[186:189]
    v_rsq_f32 v211, v211
    v_mfma_f32_16x16x32_bf16 v[186:189], v[218:221], a[200:203], v[186:189]
    ds_read_b128 v[218:221], v2 offset:16384
    ds_read_b128 v[182:185], v2 offset:17408
    v_mfma_f32_16x16x32_bf16 v[186:189], v[114:117], a[204:207], v[186:189]
    buffer_store_dwordx4 v[154:157], v15, s[52:55], 0 offen nt
    v_mul_f32 v158, s31, v210
    v_cvt_pk_f16_f32 v159, v158, v211
    v_fma_f32 v212, v212, v158, v26
    v_fmac_f32_dpp v254, v213, v211 quad_perm:[0,1,2,3] row_mask:0x4 bank_mask:0xf
    v_mfma_f32_16x16x32_bf16 v[186:189], v[170:173], a[208:211], v[186:189]
    v_cvt_pk_bf16_f32 v122, v122, v123
    v_cvt_pk_bf16_f32 v123, v124, v125
    v_mfma_f32_16x16x32_bf16 v[186:189], v[178:181], a[212:215], v[186:189]
    s_waitcnt lgkmcnt(4)
    ds_read2_b32 v[232:233], v6 offset0:0 offset1:0
    ds_read2_b32 v[124:125], v6 offset0:16 offset1:16
    v_mfma_f32_16x16x32_bf16 v[178:181], a[216:219], v[234:237], 0
    s_waitcnt lgkmcnt(4)
    ds_read2_b32 v[116:117], v6 offset0:32 offset1:32
    v_pk_mul_f16 v118, v118, v159 op_sel:[0,1] op_sel_hi:[1,1]
    v_mfma_f32_16x16x32_bf16 v[178:181], a[220:223], v[202:205], v[178:181]
    v_cvt_pk_bf16_f32 v114, v186, v187
    v_cvt_pk_bf16_f32 v115, v188, v189
    v_mfma_f32_16x16x32_bf16 v[178:181], a[224:227], v[138:141], v[178:181]
    s_waitcnt lgkmcnt(3)
    v_exp_f32 v254, v254
    v_mfma_f32_16x16x32_bf16 v[178:181], a[228:231], v[242:245], v[178:181]
    v_cvt_pk_bf16_f32 v254, v254, v254
    v_pk_mul_f16 v119, v119, v159 op_sel:[0,1] op_sel_hi:[1,1]
    v_mfma_f32_16x16x32_bf16 v[178:181], a[232:235], v[218:221], v[178:181]
    ds_write_b16 v8, v254
    v_mfma_f32_16x16x32_bf16 v[178:181], a[236:239], v[182:185], v[178:181]
    v_pk_mul_f16 v120, v120, v159 op_sel:[0,1] op_sel_hi:[1,1]
    v_pk_mul_f16 v121, v121, v159 op_sel:[0,1] op_sel_hi:[1,1]
    v_mfma_f32_16x16x32_bf16 v[170:173], a[240:243], v[234:237], 0
    s_waitcnt lgkmcnt(2)
    v_pk_mul_f16 v176, v176, v159 op_sel:[0,1] op_sel_hi:[1,1]
    v_pk_mul_f16 v177, v177, v159 op_sel:[0,1] op_sel_hi:[1,1]
    v_mfma_f32_16x16x32_f16 v[154:157], v[118:121], v[142:145], v[54:57]
    s_waitcnt lgkmcnt(1)
    v_pk_mul_f16 v134, v134, v159 op_sel:[0,0] op_sel_hi:[1,0]
    v_pk_mul_f16 v135, v135, v159 op_sel:[0,0] op_sel_hi:[1,0]
    v_mfma_f32_16x16x32_bf16 v[170:173], a[244:247], v[202:205], v[170:173]
    v_pk_mul_f16 v136, v136, v159 op_sel:[0,0] op_sel_hi:[1,0]
    v_pk_mul_f16 v137, v137, v159 op_sel:[0,0] op_sel_hi:[1,0]
    v_pk_mul_f16 v174, v174, v159 op_sel:[0,0] op_sel_hi:[1,0]
    v_mfma_f32_16x16x16_f16 v[154:157], v[176:177], v[146:147], v[154:157]
    v_pk_mul_f16 v175, v175, v159 op_sel:[0,0] op_sel_hi:[1,0]
    v_max3_u32 v44, v44, v210, v211
    v_exp_f32 v160, v160
    v_mfma_f32_16x16x32_bf16 v[170:173], a[248:251], v[138:141], v[170:173]
    v_exp_f32 v161, v161
    v_mfma_f32_16x16x32_bf16 v[170:173], a[252:255], v[242:245], v[170:173]
    v_cvt_pk_bf16_f32 v131, v160, v161
    v_sub_u32 v254, 0x40800000, v44
    v_mfma_f32_16x16x32_bf16 v[170:173], v[82:85], v[218:221], v[170:173]
    buffer_store_dwordx2 v[224:225], v18, s[52:55], 0 offen nt
    v_exp_f32 v226, v226
    v_mfma_f32_16x16x32_bf16 v[170:173], v[86:89], v[182:185], v[170:173]
    v_exp_f32 v227, v227
    v_mfma_f32_16x16x32_bf16 v[142:145], v[90:93], v[234:237], 0
    ds_read_b128 v[186:189], v206 offset:0
    v_cvt_pk_bf16_f32 v132, v226, v227
    v_mfma_f32_16x16x32_bf16 v[142:145], v[94:97], v[202:205], v[142:145]
    ds_read_b128 v[222:225], v206 offset:2048
    v_or_b32 v254, v254, v44
    v_mfma_f32_16x16x32_bf16 v[142:145], v[98:101], v[138:141], v[142:145]
    ds_read_b128 v[138:141], v206 offset:4096
    v_fma_f32 v146, v178, v178, s33
    v_mfma_f32_16x16x32_bf16 v[142:145], v[102:105], v[242:245], v[142:145]
    ds_read_b128 v[234:237], v206 offset:6144
    v_fmac_f32 v146, v179, v179
    v_mfma_f32_16x16x32_bf16 v[142:145], v[106:109], v[218:221], v[142:145]
    ds_read_b128 v[202:205], v206 offset:8192
    v_fmac_f32 v146, v180, v180
    v_mfma_f32_16x16x32_bf16 v[142:145], v[110:113], v[182:185], v[142:145]
    ds_read_b128 v[182:185], v206 offset:10240
    v_exp_f32 v228, v228
    v_exp_f32 v229, v229
    v_mfma_f32_16x16x32_f16 v[242:245], v[194:197], v[150:153], v[58:61]
    s_waitcnt lgkmcnt(5)
    v_cvt_pk_bf16_f32 v133, v228, v229
    v_fmac_f32 v146, v181, v181
    v_mfma_f32_16x16x32_bf16 v[158:161], a[216:219], v[186:189], 0
    s_waitcnt lgkmcnt(4)
    v_exp_f32 v154, v154
    v_fmac_f32 v146, v170, v170
    v_mfma_f32_16x16x16_f16 v[242:245], v[148:149], v[162:163], v[242:245]
    v_exp_f32 v155, v155
    v_exp_f32 v156, v156
    v_mfma_f32_16x16x32_bf16 v[158:161], a[220:223], v[222:225], v[158:161]
    s_waitcnt lgkmcnt(2)
    v_cvt_pk_bf16_f32 v36, v154, v155
    v_fmac_f32 v146, v171, v171
    v_mfma_f32_16x16x32_bf16 v[158:161], a[224:227], v[138:141], v[158:161]
    s_waitcnt lgkmcnt(1)
    v_exp_f32 v157, v157
    v_mfma_f32_16x16x32_f16 v[218:221], v[246:249], v[150:153], v[62:65]
    s_waitcnt lgkmcnt(0)
    v_cvt_pk_bf16_f32 v37, v156, v157
    v_fmac_f32 v146, v172, v172
    v_mfma_f32_16x16x32_f16 v[154:157], v[118:121], v[150:153], v[66:69]
    v_exp_f32 v212, v212
    v_mfma_f32_16x16x32_bf16 v[150:153], v[28:31], v[36:39], 0
    v_fmac_f32 v146, v173, v173
    v_fmac_f32 v146, v142, v142
    v_mfma_f32_16x16x32_bf16 v[150:153], v[28:31], v[130:133], v[150:153]
    v_fmac_f32 v146, v143, v143
    v_fmac_f32 v146, v144, v144
    v_fmac_f32 v146, v145, v145
    v_mfma_f32_16x16x16_f16 v[218:221], v[164:165], v[162:163], v[218:221]
    v_exp_f32 v242, v242
    v_cmp_ne_u32 vcc, 0, v209
    v_mul_i32_i24 v214, 2688, v214
    v_mfma_f32_16x16x32_bf16 v[250:253], v[230:233], v[36:39], 0
    v_rcp_f32 v150, v150
    v_mfma_f32_16x16x32_bf16 v[250:253], v[238:241], v[130:133], v[250:253]
    v_exp_f32 v243, v243
    v_add3_u32 v200, v200, v214, s7
    v_mfma_f32_16x16x16_f16 v[154:157], v[176:177], v[162:163], v[154:157]
    v_cvt_pk_bf16_f32 v242, v242, v243
    v_exp_f32 v244, v244
    v_cndmask_b32 v200, v198, v200, vcc
    v_mfma_f32_16x16x32_bf16 v[226:229], v[122:125], v[36:39], 0
    v_exp_f32 v245, v245
    v_mfma_f32_16x16x32_bf16 v[226:229], v[190:193], v[130:133], v[226:229]
    v_mul_f32 v250, v150, v250
    v_mul_f32 v251, v150, v251
    v_mfma_f32_16x16x32_bf16 v[158:161], a[228:231], v[234:237], v[158:161]
    v_cvt_pk_bf16_f32 v250, v250, v251
    v_mul_f32 v252, v150, v252
    v_mfma_f32_16x16x32_bf16 v[158:161], a[232:235], v[202:205], v[158:161]
    v_mul_f32 v253, v150, v253
    v_cvt_pk_bf16_f32 v251, v252, v253
    v_mfma_f32_16x16x32_bf16 v[158:161], a[236:239], v[182:185], v[158:161]
    v_mul_f32 v226, v150, v226
    v_mul_f32 v227, v150, v227
    v_cvt_pk_bf16_f32 v252, v226, v227
    v_mfma_f32_16x16x32_bf16 v[208:211], v[114:117], v[36:39], 0
    v_mul_f32 v228, v150, v228
    v_mul_f32 v229, v150, v229
    v_mfma_f32_16x16x32_bf16 v[208:211], v[126:129], v[130:133], v[208:211]
    v_cvt_pk_bf16_f32 v253, v228, v229
    v_fma_f32 v198, v158, v158, s33
    v_mfma_f32_16x16x32_bf16 v[130:133], a[240:243], v[186:189], 0
    ds_write_b128 v3, v[250:253] offset:0
    v_mfma_f32_16x16x32_bf16 v[130:133], a[244:247], v[222:225], v[130:133]
    v_fmac_f32 v198, v159, v159
    v_fmac_f32 v198, v160, v160
    v_mfma_f32_16x16x32_bf16 v[130:133], a[248:251], v[138:141], v[130:133]
    v_fmac_f32 v198, v161, v161
    v_mul_f32 v208, v150, v208
    v_mfma_f32_16x16x32_bf16 v[130:133], a[252:255], v[234:237], v[130:133]
    v_mul_f32 v209, v150, v209
    v_cvt_pk_bf16_f32 v162, v208, v209
    v_mfma_f32_16x16x32_bf16 v[130:133], v[82:85], v[202:205], v[130:133]
    v_mul_f32 v210, v150, v210
    v_mul_f32 v211, v150, v211
    v_mfma_f32_16x16x32_bf16 v[130:133], v[86:89], v[182:185], v[130:133]
    v_cvt_pk_bf16_f32 v163, v210, v211
    v_cvt_pk_bf16_f32 v243, v244, v245
    v_mfma_f32_16x16x32_bf16 v[150:153], v[90:93], v[186:189], 0
    ds_write_b64 v4, v[162:163] offset:4096
    v_mfma_f32_16x16x32_bf16 v[150:153], v[94:97], v[222:225], v[150:153]
    v_exp_f32 v218, v218
    v_mfma_f32_16x16x32_f16 v[186:189], v[194:197], v[134:137], v[70:73]
    v_exp_f32 v219, v219
    v_mfma_f32_16x16x32_bf16 v[150:153], v[98:101], v[138:141], v[150:153]
    v_fmac_f32 v198, v130, v130
    v_fmac_f32 v198, v131, v131
    v_mfma_f32_16x16x32_bf16 v[150:153], v[102:105], v[234:237], v[150:153]
    v_fmac_f32 v198, v132, v132
    v_fmac_f32 v198, v133, v133
    v_cvt_pk_bf16_f32 v244, v218, v219
    v_mfma_f32_16x16x16_f16 v[186:189], v[148:149], v[174:175], v[186:189]
    v_exp_f32 v220, v220
    v_exp_f32 v221, v221
    v_mfma_f32_16x16x32_bf16 v[150:153], v[106:109], v[202:205], v[150:153]
    v_cvt_pk_bf16_f32 v245, v220, v221
    v_cvt_pk_bf16_f32 v39, v216, 0
    v_mfma_f32_16x16x32_bf16 v[150:153], v[110:113], v[182:185], v[150:153]
    v_exp_f32 v154, v154
    v_mfma_f32_16x16x32_f16 v[182:185], v[246:249], v[134:137], v[74:77]
    v_exp_f32 v186, v186
    v_exp_f32 v187, v187
    v_exp_f32 v188, v188
    v_cvt_pk_bf16_f32 v138, v186, v187
    v_exp_f32 v189, v189
    v_exp_f32 v155, v155
    v_mfma_f32_16x16x16_f16 v[182:185], v[164:165], v[174:175], v[182:185]
    v_fmac_f32 v198, v150, v150
    v_fmac_f32 v198, v151, v151
    v_fmac_f32 v198, v152, v152
    v_fmac_f32 v198, v153, v153
    v_cvt_pk_bf16_f32 v186, v146, v198
    v_cvt_pk_bf16_f32 v187, v198, v198
    ds_write_b64 v169, v[186:187] offset:2048
    v_cvt_pk_bf16_f32 v139, v188, v189
    v_exp_f32 v182, v182
    v_exp_f32 v183, v183
    v_exp_f32 v184, v184
    v_cvt_pk_bf16_f32 v140, v182, v183
    v_exp_f32 v185, v185
    v_cvt_pk_bf16_f32 v36, v154, v155
    v_cvt_pk_bf16_f32 v141, v184, v185
    v_exp_f32 v156, v156
    v_exp_f32 v157, v157
    v_mfma_f32_16x16x32_f16 v[146:149], v[118:121], v[134:137], v[78:81]
    v_cvt_pk_bf16_f32 v37, v156, v157
    v_lshl_add_u32 v198, v255, 4, v200
    v_add_u32 v198, s3, v198
    v_mfma_f32_16x16x32_bf16 v[118:121], v[28:31], v[36:39], 0
    s_waitcnt lgkmcnt(0)
    v_lshl_add_u32 v200, v255, 3, v200
    v_add_u32 v200, s4, v200
    v_mfma_f32_16x16x32_bf16 v[118:121], v[28:31], v[242:245], v[118:121]
    s_barrier
    ds_read_b128 v[162:165], v168 offset:2048
    ds_read_b128 v[194:197], v168 offset:3072
    v_mfma_f32_16x16x32_bf16 v[218:221], v[230:233], v[36:39], 0
    s_barrier
    v_xor_b32 v207, 65536, v2
    v_lshl_add_u32 v208, s16, 2, v207
    v_mfma_f32_16x16x32_bf16 v[218:221], v[238:241], v[242:245], v[218:221]
    ds_read_b128 v[226:229], v207 offset:0
    ds_read_b128 v[134:137], v207 offset:1024
    v_mfma_f32_16x16x32_bf16 v[182:185], v[122:125], v[36:39], 0
    ds_read_b128 v[222:225], v207 offset:2048
    ds_read_b128 v[186:189], v207 offset:3072
    v_mfma_f32_16x16x32_bf16 v[182:185], v[190:193], v[242:245], v[182:185]
    v_rcp_f32 v118, v118
    v_mfma_f32_16x16x32_bf16 v[202:205], v[114:117], v[36:39], 0
    ds_read_b128 v[214:217], v207 offset:4096
    ds_read_b128 v[154:157], v207 offset:5120
    v_mfma_f32_16x16x32_bf16 v[202:205], v[126:129], v[242:245], v[202:205]
    v_cvt_pk_bf16_f32 v39, v212, 0
    v_mul_f32 v218, v118, v218
    v_mul_f32 v219, v118, v219
    v_mfma_f32_16x16x16_f16 v[146:149], v[176:177], v[174:175], v[146:149]
    s_waitcnt lgkmcnt(6)
    ds_write_b32 v208, v254 offset:18432
    v_cvt_pk_bf16_f32 v210, v218, v219
    v_mfma_f32_16x16x32_bf16 v[174:177], v[32:35], v[162:165], 0
    s_waitcnt lgkmcnt(6)
    v_mul_f32 v220, v118, v220
    v_mul_f32 v221, v118, v221
    v_mfma_f32_16x16x32_bf16 v[174:177], v[32:35], v[194:197], v[174:177]
    s_waitcnt lgkmcnt(4)
    v_exp_f32 v146, v146
    v_mfma_f32_16x16x32_bf16 v[162:165], a[216:219], v[226:229], 0
    s_waitcnt lgkmcnt(3)
    v_exp_f32 v147, v147
    v_mfma_f32_16x16x32_bf16 v[162:165], a[220:223], v[134:137], v[162:165]
    s_waitcnt lgkmcnt(2)
    v_cvt_pk_bf16_f32 v36, v146, v147
    v_mul_f32 v254, 0x3baaaaab, v175
    v_mfma_f32_16x16x32_bf16 v[162:165], a[224:227], v[222:225], v[162:165]
    s_waitcnt lgkmcnt(1)
    v_rsq_f32 v254, v254
    v_mfma_f32_16x16x32_bf16 v[162:165], a[228:231], v[186:189], v[162:165]
    v_mul_f32 v158, v254, v158
    v_mul_f32 v159, v254, v159
    v_mfma_f32_16x16x32_bf16 v[162:165], a[232:235], v[214:217], v[162:165]
    v_cvt_pk_bf16_f32 v158, v158, v159
    v_mul_f32 v160, v254, v160
    v_mfma_f32_16x16x32_bf16 v[162:165], a[236:239], v[154:157], v[162:165]
    v_mul_f32 v161, v254, v161
    v_cvt_pk_bf16_f32 v159, v160, v161
    v_mfma_f32_16x16x32_bf16 v[194:197], a[240:243], v[226:229], 0
    v_mul_f32 v130, v254, v130
    v_mul_f32 v131, v254, v131
    v_mfma_f32_16x16x32_bf16 v[194:197], a[244:247], v[134:137], v[194:197]
    v_cvt_pk_bf16_f32 v160, v130, v131
    v_mul_f32 v132, v254, v132
    v_mfma_f32_16x16x32_bf16 v[194:197], a[248:251], v[222:225], v[194:197]
    v_mul_f32 v133, v254, v133
    v_cvt_pk_bf16_f32 v161, v132, v133
    v_mfma_f32_16x16x32_bf16 v[194:197], a[252:255], v[186:189], v[194:197]
    buffer_store_dwordx4 v[158:161], v167, s[12:15], 0 offen nt
    v_mul_f32 v150, v254, v150
    v_mul_f32 v151, v254, v151
    v_cvt_pk_bf16_f32 v208, v150, v151
    v_mul_f32 v152, v254, v152
    v_mfma_f32_16x16x32_bf16 v[194:197], v[82:85], v[214:217], v[194:197]
    v_mul_f32 v153, v254, v153
    v_cvt_pk_bf16_f32 v209, v152, v153
    v_mfma_f32_16x16x32_bf16 v[194:197], v[86:89], v[154:157], v[194:197]
    v_exp_f32 v148, v148
    v_mfma_f32_16x16x32_bf16 v[130:133], v[90:93], v[226:229], 0
    ds_read_b128 v[150:153], v9
    ds_read_b128 v[158:161], v9 offset:64
    v_mfma_f32_16x16x32_bf16 v[130:133], v[94:97], v[134:137], v[130:133]
    v_exp_f32 v149, v149
    v_mfma_f32_16x16x32_bf16 v[130:133], v[98:101], v[222:225], v[130:133]
    v_cvt_pk_bf16_f32 v37, v148, v149
    v_fma_f32 v167, v162, v162, s33
    v_mfma_f32_16x16x32_bf16 v[130:133], v[102:105], v[186:189], v[130:133]
    v_fmac_f32 v167, v163, v163
    v_fmac_f32 v167, v164, v164
    v_mfma_f32_16x16x32_bf16 v[130:133], v[106:109], v[214:217], v[130:133]
    v_fmac_f32 v167, v165, v165
    v_fmac_f32 v167, v194, v194
    v_mfma_f32_16x16x32_bf16 v[130:133], v[110:113], v[154:157], v[130:133]
    v_fmac_f32 v167, v195, v195
    v_fmac_f32 v167, v196, v196
    v_mfma_f32_16x16x32_bf16 v[134:137], v[28:31], v[36:39], 0
    v_fmac_f32 v167, v197, v197
    v_cvt_pk_bf16_f32 v211, v220, v221
    v_mfma_f32_16x16x32_bf16 v[134:137], v[28:31], v[138:141], v[134:137]
    s_waitcnt lgkmcnt(0)
    v_mul_f32 v182, v118, v182
    v_fmac_f32 v167, v130, v130
    v_mfma_f32_16x16x32_bf16 v[154:157], v[230:233], v[36:39], 0
    v_fmac_f32 v167, v131, v131
    v_fmac_f32 v167, v132, v132
    v_mfma_f32_16x16x32_bf16 v[154:157], v[238:241], v[138:141], v[154:157]
    v_fmac_f32 v167, v133, v133
    v_cvt_pk_bf16_f32 v212, v167, v167
    v_mfma_f32_16x16x32_bf16 v[146:149], v[122:125], v[36:39], 0
    v_cvt_pk_bf16_f32 v213, v167, v167
    v_mul_f32 v183, v118, v183
    v_mfma_f32_16x16x32_bf16 v[146:149], v[190:193], v[138:141], v[146:149]
    ds_write_b64 v169, v[212:213] offset:7616
    v_mfma_f32_16x16x32_bf16 v[186:189], v[114:117], v[36:39], 0
    buffer_store_dwordx2 v[208:209], v166, s[12:15], 0 offen nt
    v_cvt_pk_bf16_f32 v212, v182, v183
    v_mul_f32 v184, v118, v184
    v_mfma_f32_16x16x32_bf16 v[186:189], v[126:129], v[138:141], v[186:189]
    v_mul_f32 v185, v118, v185
    v_cvt_pk_bf16_f32 v213, v184, v185
    v_mfma_f32_16x16x32_bf16 v[182:185], v[150:153], v[28:31], 0
    ds_write_b128 v3, v[210:213] offset:6144
    v_mfma_f32_16x16x32_bf16 v[182:185], v[158:161], v[28:31], v[182:185]
    v_mul_f32 v202, v118, v202
    v_mul_f32 v203, v118, v203
    v_mfma_f32_16x16x32_bf16 v[138:141], v[150:153], v[238:241], 0
    v_cvt_pk_bf16_f32 v166, v202, v203
    v_mul_f32 v204, v118, v204
    v_mfma_f32_16x16x32_bf16 v[138:141], v[158:161], v[230:233], v[138:141]
    v_mul_f32 v205, v118, v205
    v_cvt_pk_bf16_f32 v167, v204, v205
    v_mfma_f32_16x16x32_bf16 v[202:205], v[150:153], v[190:193], 0
    ds_write_b64 v4, v[166:167] offset:10240
    v_mfma_f32_16x16x32_bf16 v[202:205], v[158:161], v[122:125], v[202:205]
    v_rcp_f32 v182, v182
    v_mfma_f32_16x16x32_bf16 v[118:121], v[150:153], v[126:129], 0
    v_mul_f32 v254, 0x3baaaaab, v174
    v_mul_f32 v138, v138, v182
    v_mfma_f32_16x16x32_bf16 v[118:121], v[158:161], v[114:117], v[118:121]
    v_rsq_f32 v254, v254
    v_rcp_f32 v134, v134
    v_mul_f32 v178, v254, v178
    v_mul_f32_dpp v138, v202, v182 quad_perm:[0,1,2,3] row_mask:0x2 bank_mask:0xf
    v_mul_f32 v179, v254, v179
    v_cvt_pk_bf16_f32 v114, v178, v179
    v_mul_f32 v180, v254, v180
    v_mul_f32 v181, v254, v181
    v_mul_f32_dpp v138, v118, v182 quad_perm:[0,1,2,3] row_mask:0x4 bank_mask:0xf
    v_cvt_pk_bf16_f32 v138, v138, v138
    ds_write_b16 v7, v138
    v_cvt_pk_bf16_f32 v115, v180, v181
    v_mul_f32 v170, v254, v170
    v_mul_f32 v171, v254, v171
    v_cvt_pk_bf16_f32 v116, v170, v171
    v_mul_f32 v172, v254, v172
    v_mul_f32 v173, v254, v173
    v_cvt_pk_bf16_f32 v117, v172, v173
    buffer_store_dwordx4 v[114:117], v17, s[52:55], 0 offen nt
    v_mul_f32 v142, v254, v142
    v_mul_f32 v143, v254, v143
    v_cvt_pk_bf16_f32 v166, v142, v143
    v_mul_f32 v144, v254, v144
    v_mul_f32 v145, v254, v145
    v_cvt_pk_bf16_f32 v167, v144, v145
    v_mul_f32 v154, v134, v154
    v_mul_f32 v155, v134, v155
    v_cvt_pk_bf16_f32 v114, v154, v155
    v_mul_f32 v156, v134, v156
    v_mul_f32 v157, v134, v157
    v_cvt_pk_bf16_f32 v115, v156, v157
    v_mul_f32 v146, v134, v146
    s_waitcnt lgkmcnt(0)
    s_barrier
    ds_read_b128 v[118:121], v168 offset:7616
    ds_read_b128 v[138:141], v168 offset:8640
    ds_read_b128 v[154:157], v207 offset:6144
    ds_read_b128 v[122:125], v207 offset:7168
    ds_read_b128 v[142:145], v207 offset:8192
    ds_read_b128 v[170:173], v207 offset:9216
    ds_read_b128 v[158:161], v207 offset:10240
    ds_read_b128 v[126:129], v207 offset:11264
    v_mul_f32 v147, v134, v147
    v_cvt_pk_bf16_f32 v116, v146, v147
    v_mul_f32 v148, v134, v148
    s_waitcnt lgkmcnt(7)
    v_mfma_f32_16x16x32_bf16 v[150:153], v[32:35], v[118:121], 0
    s_waitcnt lgkmcnt(5)
    v_mul_f32 v149, v134, v149
    v_cvt_pk_bf16_f32 v117, v148, v149
    v_mfma_f32_16x16x32_bf16 v[150:153], v[32:35], v[138:141], v[150:153]
    s_waitcnt lgkmcnt(4)
    ds_write_b128 v3, v[114:117] offset:12288
    v_mfma_f32_16x16x32_bf16 v[114:117], a[216:219], v[154:157], 0
    s_waitcnt lgkmcnt(3)
    v_mul_f32 v186, v134, v186
    v_mul_f32 v187, v134, v187
    v_mfma_f32_16x16x32_bf16 v[114:117], a[220:223], v[122:125], v[114:117]
    s_waitcnt lgkmcnt(2)
    v_cvt_pk_bf16_f32 v208, v186, v187
    v_mul_f32 v188, v134, v188
    v_mfma_f32_16x16x32_bf16 v[114:117], a[224:227], v[142:145], v[114:117]
    s_waitcnt lgkmcnt(1)
    v_mul_f32 v189, v134, v189
    v_cvt_pk_bf16_f32 v209, v188, v189
    v_mfma_f32_16x16x32_bf16 v[114:117], a[228:231], v[170:173], v[114:117]
    ds_write_b64 v4, v[208:209] offset:16384
    v_mfma_f32_16x16x32_bf16 v[114:117], a[232:235], v[158:161], v[114:117]
    buffer_store_dwordx2 v[166:167], v20, s[52:55], 0 offen nt
    v_mul_f32 v208, 0x3baaaaab, v150
    v_bfe_u32 v254, v199, 1, 2
    v_mfma_f32_16x16x32_bf16 v[114:117], a[236:239], v[126:129], v[114:117]
    v_rsq_f32 v208, v208
    v_mfma_f32_16x16x32_bf16 v[118:121], a[240:243], v[154:157], 0
    v_mul_f32 v162, v208, v162
    v_mul_f32 v163, v208, v163
    v_mfma_f32_16x16x32_bf16 v[118:121], a[244:247], v[122:125], v[118:121]
    v_cvt_pk_bf16_f32 v134, v162, v163
    v_mul_f32 v164, v208, v164
    v_mfma_f32_16x16x32_bf16 v[118:121], a[248:251], v[142:145], v[118:121]
    v_fma_f32 v209, v114, v114, s33
    v_fmac_f32 v209, v115, v115
    v_mfma_f32_16x16x32_bf16 v[118:121], a[252:255], v[170:173], v[118:121]
    v_fmac_f32 v209, v116, v116
    v_fmac_f32 v209, v117, v117
    v_mfma_f32_16x16x32_bf16 v[118:121], v[82:85], v[158:161], v[118:121]
    v_mul_f32 v165, v208, v165
    v_cvt_pk_bf16_f32 v135, v164, v165
    v_mfma_f32_16x16x32_bf16 v[118:121], v[86:89], v[126:129], v[118:121]
    v_mul_f32 v194, v208, v194
    v_mul_f32 v195, v208, v195
    v_mfma_f32_16x16x32_bf16 v[146:149], v[90:93], v[154:157], 0
    ds_read_b128 v[150:153], v206 offset:256
    v_cvt_pk_bf16_f32 v136, v194, v195
    v_mfma_f32_16x16x32_bf16 v[146:149], v[94:97], v[122:125], v[146:149]
    ds_read_b128 v[122:125], v206 offset:2304
    v_mul_f32 v196, v208, v196
    v_mfma_f32_16x16x32_bf16 v[146:149], v[98:101], v[142:145], v[146:149]
    ds_read_b128 v[138:141], v206 offset:4352
    v_fmac_f32 v209, v118, v118
    v_mfma_f32_16x16x32_bf16 v[146:149], v[102:105], v[170:173], v[146:149]
    ds_read_b128 v[142:145], v206 offset:6400
    v_fmac_f32 v209, v119, v119
    v_mfma_f32_16x16x32_bf16 v[146:149], v[106:109], v[158:161], v[146:149]
    ds_read_b128 v[158:161], v206 offset:8448
    v_fmac_f32 v209, v120, v120
    v_mfma_f32_16x16x32_bf16 v[146:149], v[110:113], v[126:129], v[146:149]
    ds_read_b128 v[126:129], v206 offset:10496
    v_fmac_f32 v209, v121, v121
    v_mul_f32 v197, v208, v197
    v_cvt_pk_bf16_f32 v137, v196, v197
    v_mul_f32 v130, v208, v130
    s_waitcnt lgkmcnt(5)
    v_mfma_f32_16x16x32_bf16 v[162:165], a[216:219], v[150:153], 0
    v_mul_f32 v131, v208, v131
    v_fmac_f32 v209, v146, v146
    v_mfma_f32_16x16x32_bf16 v[154:157], a[240:243], v[150:153], 0
    s_waitcnt lgkmcnt(4)
    buffer_store_dwordx4 v[134:137], v15, s[56:59], 0 offen nt
    v_fmac_f32 v209, v147, v147
    v_fmac_f32 v209, v148, v148
    v_fmac_f32 v209, v149, v149
    v_cvt_pk_bf16_f32 v166, v209, v209
    v_mfma_f32_16x16x32_bf16 v[162:165], a[220:223], v[122:125], v[162:165]
    s_waitcnt lgkmcnt(2)
    v_cvt_pk_bf16_f32 v167, v209, v209
    v_cvt_pk_bf16_f32 v130, v130, v131
    v_mfma_f32_16x16x32_bf16 v[162:165], a[224:227], v[138:141], v[162:165]
    s_waitcnt lgkmcnt(1)
    ds_write_b64 v169, v[166:167] offset:9664
    v_mfma_f32_16x16x32_bf16 v[162:165], a[228:231], v[142:145], v[162:165]
    s_waitcnt lgkmcnt(1)
    v_mul_f32 v132, v208, v132
    v_mul_f32 v133, v208, v133
    v_mfma_f32_16x16x32_bf16 v[162:165], a[232:235], v[158:161], v[162:165]
    v_cvt_pk_bf16_f32 v131, v132, v133
    v_xor_b32 v254, v254, v255
    v_mfma_f32_16x16x32_bf16 v[162:165], a[236:239], v[126:129], v[162:165]
    v_lshl_add_u32 v254, v199, 2, v254
    v_lshl_add_u32 v166, v254, 4, s5
    v_mfma_f32_16x16x32_bf16 v[154:157], a[244:247], v[122:125], v[154:157]
    v_lshl_add_u32 v167, v254, 3, s5
    v_lshl_add_u32 v255, v201, 4, s5
    v_mfma_f32_16x16x32_bf16 v[154:157], a[248:251], v[138:141], v[154:157]
    v_lshl_add_u32 v201, v201, 3, s5
    v_lshlrev_b32 v254, 2, v254
    v_mfma_f32_16x16x32_bf16 v[154:157], a[252:255], v[142:145], v[154:157]
    ds_permute_b32 v208, v254, v16
    ds_permute_b32 v199, v254, v19
    v_mfma_f32_16x16x32_bf16 v[154:157], v[82:85], v[158:161], v[154:157]
    s_waitcnt lgkmcnt(2)
    ds_permute_b32 v206, v254, v17
    ds_permute_b32 v209, v254, v20
    v_mfma_f32_16x16x32_bf16 v[154:157], v[86:89], v[126:129], v[154:157]
    s_barrier
    ds_read_b128 v[170:173], v168 offset:9664
    ds_read_b128 v[174:177], v168 offset:10688
    v_mfma_f32_16x16x32_bf16 v[178:181], v[90:93], v[150:153], 0
    ds_read_b128 v[134:137], v207 offset:12288
    v_fma_f32 v254, v162, v162, s33
    v_mfma_f32_16x16x32_bf16 v[178:181], v[94:97], v[122:125], v[178:181]
    ds_read_b128 v[122:125], v207 offset:13312
    v_fmac_f32 v254, v163, v163
    v_mfma_f32_16x16x32_bf16 v[178:181], v[98:101], v[138:141], v[178:181]
    ds_read_b128 v[138:141], v207 offset:14336
    v_fmac_f32 v254, v164, v164
    v_mfma_f32_16x16x32_bf16 v[178:181], v[102:105], v[142:145], v[178:181]
    ds_read_b128 v[150:153], v207 offset:15360
    v_fmac_f32 v254, v165, v165
    v_mfma_f32_16x16x32_bf16 v[178:181], v[106:109], v[158:161], v[178:181]
    s_waitcnt lgkmcnt(8)
    ds_read_b128 v[142:145], v207 offset:16384
    buffer_store_dwordx2 v[130:131], v18, s[56:59], 0 offen nt
    v_fmac_f32 v254, v154, v154
    v_fmac_f32 v254, v155, v155
    v_mfma_f32_16x16x32_bf16 v[178:181], v[110:113], v[126:129], v[178:181]
    s_waitcnt lgkmcnt(6)
    ds_read_b128 v[126:129], v207 offset:17408
    v_fmac_f32 v254, v156, v156
    v_mfma_f32_16x16x32_bf16 v[130:133], v[32:35], v[170:173], 0
    s_waitcnt lgkmcnt(5)
    v_fmac_f32 v254, v157, v157
    v_mfma_f32_16x16x32_bf16 v[130:133], v[32:35], v[174:177], v[130:133]
    s_waitcnt lgkmcnt(4)
    v_fmac_f32 v254, v178, v178
    v_fmac_f32 v254, v179, v179
    v_mfma_f32_16x16x32_bf16 v[158:161], a[216:219], v[134:137], 0
    s_waitcnt lgkmcnt(3)
    v_fmac_f32 v254, v180, v180
    v_fmac_f32 v254, v181, v181
    v_mfma_f32_16x16x32_bf16 v[158:161], a[220:223], v[122:125], v[158:161]
    s_waitcnt lgkmcnt(2)
    v_cvt_pk_bf16_f32 v132, v254, v254
    v_cvt_pk_bf16_f32 v133, v254, v254
    v_mfma_f32_16x16x32_bf16 v[158:161], a[224:227], v[138:141], v[158:161]
    s_waitcnt lgkmcnt(1)
    ds_write_b64 v169, v[132:133] offset:17280
    v_mfma_f32_16x16x32_bf16 v[158:161], a[228:231], v[150:153], v[158:161]
    v_mul_f32 v254, 0x3baaaaab, v130
    v_mfma_f32_16x16x32_bf16 v[158:161], a[232:235], v[142:145], v[158:161]
    s_waitcnt lgkmcnt(1)
    v_rsq_f32 v254, v254
    v_mfma_f32_16x16x32_bf16 v[158:161], a[236:239], v[126:129], v[158:161]
    v_mul_f32 v114, v254, v114
    v_mul_f32 v115, v254, v115
    v_mfma_f32_16x16x32_bf16 v[130:133], a[240:243], v[134:137], 0
    v_cvt_pk_bf16_f32 v174, v114, v115
    v_mul_f32 v116, v254, v116
    v_mfma_f32_16x16x32_bf16 v[130:133], a[244:247], v[122:125], v[130:133]
    v_mul_f32 v117, v254, v117
    v_cvt_pk_bf16_f32 v175, v116, v117
    v_mfma_f32_16x16x32_bf16 v[130:133], a[248:251], v[138:141], v[130:133]
    v_fma_f32 v114, v158, v158, s33
    v_fmac_f32 v114, v159, v159
    v_mfma_f32_16x16x32_bf16 v[130:133], a[252:255], v[150:153], v[130:133]
    v_fmac_f32 v114, v160, v160
    v_fmac_f32 v114, v161, v161
    v_mfma_f32_16x16x32_bf16 v[130:133], v[82:85], v[142:145], v[130:133]
    v_mul_f32 v118, v254, v118
    v_mul_f32 v119, v254, v119
    v_mfma_f32_16x16x32_bf16 v[130:133], v[86:89], v[126:129], v[130:133]
    v_cvt_pk_bf16_f32 v176, v118, v119
    v_mul_f32 v120, v254, v120
    v_mfma_f32_16x16x32_bf16 v[170:173], v[90:93], v[134:137], 0
    v_mul_f32 v121, v254, v121
    v_cvt_pk_bf16_f32 v177, v120, v121
    v_mfma_f32_16x16x32_bf16 v[170:173], v[94:97], v[122:125], v[170:173]
    ds_write_b128 v166, v[174:177] offset:1536
    v_mfma_f32_16x16x32_bf16 v[170:173], v[98:101], v[138:141], v[170:173]
    v_fmac_f32 v114, v130, v130
    v_fmac_f32 v114, v131, v131
    v_mfma_f32_16x16x32_bf16 v[170:173], v[102:105], v[150:153], v[170:173]
    v_fmac_f32 v114, v132, v132
    v_fmac_f32 v114, v133, v133
    v_mfma_f32_16x16x32_bf16 v[170:173], v[106:109], v[142:145], v[170:173]
    ds_read_b128 v[118:121], v255 offset:1536
    v_mul_f32 v146, v254, v146
    v_mfma_f32_16x16x32_bf16 v[170:173], v[110:113], v[126:129], v[170:173]
    v_mul_f32 v147, v254, v147
    v_cvt_pk_bf16_f32 v146, v146, v147
    v_mul_f32 v148, v254, v148
    v_mul_f32 v149, v254, v149
    v_cvt_pk_bf16_f32 v147, v148, v149
    ds_write_b64 v167, v[146:147] offset:2560
    s_nop 0
    s_nop 0
    v_fmac_f32 v114, v170, v170
    v_fmac_f32 v114, v171, v171
    v_fmac_f32 v114, v172, v172
    v_fmac_f32 v114, v173, v173
    v_cvt_pk_bf16_f32 v116, v114, v114
    v_cvt_pk_bf16_f32 v117, v114, v114
    ds_write_b64 v169, v[116:117] offset:15232
    s_waitcnt lgkmcnt(2)
    buffer_store_dwordx4 v[118:121], v208, s[56:59], 0 offen nt
    ds_read_b64 v[114:115], v201 offset:2560
    s_waitcnt lgkmcnt(1)
    s_barrier
    ds_read_b128 v[142:145], v168 offset:15232
    ds_read_b128 v[122:125], v168 offset:16256
    ds_read_b128 v[118:121], v168 offset:17280
    ds_read_b128 v[134:137], v168 offset:18304
    ds_read_b128 v[126:129], v207 offset:18432
    s_waitcnt lgkmcnt(5)
    buffer_store_dwordx2 v[114:115], v199, s[56:59], 0 offen nt
    s_waitcnt lgkmcnt(4)
    v_mfma_f32_16x16x32_bf16 v[138:141], v[32:35], v[142:145], 0
    s_waitcnt lgkmcnt(3)
    v_mfma_f32_16x16x32_bf16 v[138:141], v[32:35], v[122:125], v[138:141]
    s_waitcnt lgkmcnt(1)
    v_mfma_f32_16x16x32_bf16 v[114:117], v[32:35], v[118:121], 0
    s_waitcnt lgkmcnt(0)
    v_or3_b32 v126, v126, v127, v128
    v_or_b32 v126, v126, v129
    v_mfma_f32_16x16x32_bf16 v[114:117], v[32:35], v[134:137], v[114:117]
    v_cmp_gt_i32 s[46:47], 0, v126
    s_nop 0
    v_mul_f32 v254, 0x3baaaaab, v138
    v_rsq_f32 v254, v254
    s_nop 0
    v_mul_f32 v158, v254, v158
    v_mul_f32 v159, v254, v159
    v_cvt_pk_bf16_f32 v118, v158, v159
    v_mul_f32 v199, 0x3baaaaab, v114
    v_rsq_f32 v199, v199
    v_mul_f32 v160, v254, v160
    v_mul_f32 v162, v199, v162
    v_mul_f32 v163, v199, v163
    v_cvt_pk_bf16_f32 v114, v162, v163
    v_mul_f32 v164, v199, v164
    v_mul_f32 v165, v199, v165
    v_cvt_pk_bf16_f32 v115, v164, v165
    v_mul_f32 v154, v199, v154
    v_mul_f32 v155, v199, v155
    v_cvt_pk_bf16_f32 v116, v154, v155
    v_mul_f32 v156, v199, v156
    v_mul_f32 v157, v199, v157
    v_cvt_pk_bf16_f32 v117, v156, v157
    buffer_store_dwordx4 v[114:117], v198, s[12:15], 0 offen nt
    v_mul_f32 v178, v199, v178
    v_mul_f32 v179, v199, v179
    v_cvt_pk_bf16_f32 v198, v178, v179
    v_mul_f32 v180, v199, v180
    v_mul_f32 v181, v199, v181
    v_cvt_pk_bf16_f32 v199, v180, v181
    v_mul_f32 v161, v254, v161
    v_cvt_pk_bf16_f32 v119, v160, v161
    v_mul_f32 v130, v254, v130
    v_mul_f32 v131, v254, v131
    v_cvt_pk_bf16_f32 v120, v130, v131
    v_mul_f32 v132, v254, v132
    v_mul_f32 v133, v254, v133
    v_cvt_pk_bf16_f32 v121, v132, v133
    ds_write_b128 v166, v[118:121] offset:3072
    v_mul_f32 v170, v254, v170
    v_mul_f32 v171, v254, v171
    v_cvt_pk_bf16_f32 v168, v170, v171
    v_mul_f32 v172, v254, v172
    v_mul_f32 v173, v254, v173
    v_cvt_pk_bf16_f32 v169, v172, v173
    buffer_store_dwordx2 v[198:199], v200, s[12:15], 0 offen nt
    ds_read_b128 v[114:117], v255 offset:3072
    ds_write_b64 v167, v[168:169] offset:4096
    ds_read_b64 v[254:255], v201 offset:4096
    s_waitcnt lgkmcnt(2)
    buffer_store_dwordx4 v[114:117], v206, s[56:59], 0 offen nt
    s_waitcnt lgkmcnt(0)
    buffer_store_dwordx2 v[254:255], v209, s[56:59], 0 offen nt
L_end:
    s_nop 1
    s_cmp_lg_u64 s[46:47], 0
    s_cbranch_scc1 L_rerun
L_done:
    s_endpgm
L_slow:
    s_mov_b32 s44, 0xff
    s_branch L_redo
L_rerun:
    s_mov_b32 s44, 0x7f000000
    s_lshr_b32 s100, s63, 20
L_redo:
    s_waitcnt vmcnt(0) lgkmcnt(0)
    s_barrier
    v_mbcnt_lo_u32_b32 v0, -1, 0
    v_mbcnt_hi_u32_b32 v0, -1, v0
    v_lshl_add_u32 v0, s16, 6, v0
    s_nop 7
    s_branch L_again
L_edge:
    v_mov_b32 v254, v0
    v_mov_b32 v255, 0x40000000
    s_lshl_b32 s3, s16, 4
    s_load_dwordx4 s[92:95], s[0:1], s3
    v_and_b32 v114, 63, v0
    s_bfe_u32 s3, s2, 0x50003
    s_lshl_b32 s4, s16, 3
    s_lshr_b32 s98, 0x06143a01, s4
    s_and_b32 s98, s98, 0xff
    s_mul_i32 s3, s3, s98
    s_sub_u32 s98, s98, 1
    s_lshr_b32 s4, 0x0048d800, s4
    s_and_b32 s4, s4, 0xff
    s_lshl_b32 s4, s4, 3
    s_max_u32 s4, s4, 6
    s_sub_u32 s4, s4, s98
    s_sub_u32 s4, s4, 1
    s_min_u32 s3, s3, s4
    v_min_u32 v116, s98, v114
    v_add_lshl_u32 v116, v116, s3, 7
    v_mov_b32 v117, 0
    v_lshrrev_b32 v115, 4, v114
    v_and_b32 v122, 15, v114
    s_mov_b32 s10, 100270464
    s_mov_b32 s11, 0x00020000
    s_mov_b32 s50, 36096
    s_mov_b32 s51, 0x00020000
    s_mul_i32 s3, s16, 96
    v_lshl_add_u32 v123, v114, 4, s3
    v_mul_u32_u24 v124, 171, v114
    v_lshrrev_b32 v124, 10, v124
    v_lshrrev_b32 v125, 1, v124
    v_xor_b32 v125, v125, v124
    v_and_b32 v125, 4, v125
    v_mul_u32_u24 v125, 3, v125
    v_xor_b32 v125, v125, v124
    v_mul_u32_u24 v125, 1152, v125
    v_mul_u32_u24 v138, 96, v124
    v_sub_u32 v125, v125, v138
    v_add_u32 v138, v123, v125
    v_add_u32 v125, 64, v114
    v_mul_u32_u24 v125, 171, v125
    v_lshrrev_b32 v125, 10, v125
    v_lshrrev_b32 v139, 1, v125
    v_xor_b32 v139, v139, v125
    v_and_b32 v139, 4, v139
    v_mul_u32_u24 v139, 3, v139
    v_xor_b32 v139, v139, v125
    v_mul_u32_u24 v139, 1152, v139
    v_mul_u32_u24 v140, 96, v125
    v_sub_u32 v139, v139, v140
    v_add_u32 v140, v123, v139
    v_add_u32 v139, 128, v114
    v_mul_u32_u24 v139, 171, v139
    v_lshrrev_b32 v139, 10, v139
    v_lshrrev_b32 v141, 1, v139
    v_xor_b32 v141, v141, v139
    v_and_b32 v141, 4, v141
    v_mul_u32_u24 v141, 3, v141
    v_xor_b32 v141, v141, v139
    v_mul_u32_u24 v141, 1152, v141
    v_mul_u32_u24 v146, 96, v139
    v_sub_u32 v141, v141, v146
    v_add_u32 v146, v123, v141
    s_mul_i32 s68, s16, 6144
    s_add_u32 s69, s68, 65536
    s_cmp_eq_u32 s16, 3
    s_cselect_b32 s68, 149696, s68
    s_cselect_b32 s69, 155840, s69
    s_mov_b32 s70, 193536
    s_mov_b32 s36, 100270464
    s_mov_b32 s22, 1180032
    s_mul_i32 s3, s2, 911
    s_lshr_b32 s3, s3, 16
    s_mul_i32 s35, s3, 72
    s_sub_u32 s38, s2, s35
    s_mul_i32 s3, s3, 1373568
    s_mul_i32 s35, s38, 2688
    s_add_u32 s3, s3, s35
    s_add_u32 s25, s3, 589824
    s_add_u32 s7, s3, 1769472
    s_mov_b32 s20, 31
    s_mov_b32 s21, 4204032
    s_mov_b32 s17, 20
    s_cmp_lt_u32 s2, 240
    s_cselect_b32 s45, 28, 24
    s_mov_b32 s5, 0
    s_mov_b32 s6, 0
    s_cmp_lt_u32 s2, 247
    s_cbranch_scc1 L_inner
    s_mov_b32 s20, 0
    s_mov_b32 s38, 0
    s_sub_u32 s3, s2, 247
    s_and_b32 s3, s3, 3
    s_mul_i32 s3, s3, 7
    s_add_u32 s3, s3, 3
    s_mov_b32 s35, 196224
    s_cmp_lt_u32 s2, 251
    s_cselect_b32 s35, s35, 384
    s_cselect_b32 s6, 1, 0
    s_cselect_b32 s5, 0, 1
    s_mul_i32 s25, s3, s35
    s_mul_i32 s21, s35, 28
    s_cmp_lt_u32 s2, 255
    s_cselect_b32 s17, 18, 1
    s_cselect_b32 s45, 18, 1
    s_cselect_b32 s25, s25, 0
    s_cselect_b32 s6, s6, 1
    s_add_u32 s7, s25, 1179648
L_inner:
    s_mul_i32 s3, s5, 99485568
    s_mul_i32 s35, s5, -784896
    v_mov_b32 v123, s3
    v_mov_b32 v141, s35
    s_add_u32 s7, s7, s35
    s_mul_i32 s3, s6, 194688
    s_mul_i32 s35, s6, -1536
    v_mov_b32 v147, s3
    v_mov_b32 v148, s35
    s_add_u32 s7, s7, s35
    s_bfm_b32 s34, s45, 0
    s_and_b32 s4, s2, 7
    s_sub_u32 s4, 0, s4
    v_mul_u32_u24 v149, 2731, v254
    v_bfe_u32 v150, v149, 17, 3
    v_lshrrev_b32 v149, 16, v149
    v_xor_b32 v151, v150, v254
    v_mul_u32_u24 v150, 37, v149
    v_lshrrev_b32 v150, 8, v150
    v_lshlrev_b32 v151, 4, v151
    v_mad_u32_u24 v10, v150, s70, v151
    v_mul_u32_u24 v150, 37, v149
    v_lshrrev_b32 v150, 8, v150
    v_mul_u32_u24 v152, 7, v150
    v_sub_u32 v152, v149, v152
    v_cmp_gt_u32 vcc, 4, v150
    s_nop 1
    v_cndmask_b32 v150, v141, v123, vcc
    v_cmp_gt_u32 vcc, 4, v152
    s_nop 1
    v_cndmask_b32 v152, v148, v147, vcc
    v_add3_u32 v10, v10, v150, v152
    v_mul_u32_u24 v150, s20, v149
    v_add_u32 v150, s38, v150
    v_mul_u32_u24 v152, 911, v150
    v_lshrrev_b32 v152, 16, v152
    v_mul_u32_u24 v152, s22, v152
    v_mad_u32_u24 v152, v149, s21, v152
    v_bfe_u32 v150, s34, v149, 1
    v_cmp_ne_u32 vcc, 0, v150
    v_add_u32 v150, s7, v152
    s_nop 0
    v_cndmask_b32 v150, v255, v150, vcc
    v_mul_u32_u24 v149, 384, v149
    v_sub_u32 v149, v151, v149
    v_add_u32 v150, v150, v149
    v_add_u32 v149, 256, v254
    v_mul_u32_u24 v151, 2731, v149
    v_bfe_u32 v152, v151, 17, 3
    v_lshrrev_b32 v151, 16, v151
    v_xor_b32 v149, v152, v149
    v_mul_u32_u24 v152, 37, v151
    v_lshrrev_b32 v152, 8, v152
    v_lshlrev_b32 v149, 4, v149
    v_mad_u32_u24 v11, v152, s70, v149
    v_mul_u32_u24 v152, 37, v151
    v_lshrrev_b32 v152, 8, v152
    v_mul_u32_u24 v153, 7, v152
    v_sub_u32 v153, v151, v153
    v_cmp_gt_u32 vcc, 4, v152
    s_nop 1
    v_cndmask_b32 v152, v141, v123, vcc
    v_cmp_gt_u32 vcc, 4, v153
    s_nop 1
    v_cndmask_b32 v153, v148, v147, vcc
    v_add3_u32 v11, v11, v152, v153
    v_min_u32 v152, 20, v151
    v_add_u32 v153, 12, v151
    v_lshrrev_b32 v153, 5, v153
    v_sub_u32 v154, v151, v152
    v_mad_i32_i24 v154, v153, s4, v154
    v_mul_u32_u24 v155, s20, v152
    v_add3_u32 v155, v155, v154, s38
    v_mul_u32_u24 v153, 911, v155
    v_lshrrev_b32 v153, 16, v153
    v_mul_u32_u24 v153, s22, v153
    v_mad_u32_u24 v153, v152, s21, v153
    v_bfe_u32 v155, s34, v151, 1
    v_cmp_ne_u32 vcc, 0, v155
    v_mul_i32_i24 v154, 2688, v154
    v_add3_u32 v152, v153, v154, s7
    v_cndmask_b32 v152, v255, v152, vcc
    v_mul_u32_u24 v151, 384, v151
    v_sub_u32 v151, v149, v151
    v_add_u32 v152, v152, v151
    v_add_u32 v149, 512, v254
    v_mul_u32_u24 v151, 2731, v149
    v_bfe_u32 v153, v151, 17, 3
    v_lshrrev_b32 v151, 16, v151
    v_xor_b32 v149, v153, v149
    v_mul_u32_u24 v153, 37, v151
    v_lshrrev_b32 v153, 8, v153
    v_lshlrev_b32 v149, 4, v149
    v_mad_u32_u24 v12, v153, s70, v149
    v_mul_u32_u24 v153, 37, v151
    v_lshrrev_b32 v153, 8, v153
    v_mul_u32_u24 v154, 7, v153
    v_sub_u32 v154, v151, v154
    v_cmp_gt_u32 vcc, 4, v153
    s_nop 1
    v_cndmask_b32 v153, v141, v123, vcc
    v_cmp_gt_u32 vcc, 4, v154
    s_nop 1
    v_cndmask_b32 v154, v148, v147, vcc
    v_add3_u32 v12, v12, v153, v154
    v_min_u32 v153, 20, v151
    v_add_u32 v154, 12, v151
    v_lshrrev_b32 v154, 5, v154
    v_sub_u32 v155, v151, v153
    v_mad_i32_i24 v155, v154, s4, v155
    v_mul_u32_u24 v156, s20, v153
    v_add3_u32 v156, v156, v155, s38
    v_mul_u32_u24 v154, 911, v156
    v_lshrrev_b32 v154, 16, v154
    v_mul_u32_u24 v154, s22, v154
    v_mad_u32_u24 v154, v153, s21, v154
    v_bfe_u32 v156, s34, v151, 1
    v_cmp_ne_u32 vcc, 0, v156
    v_mul_i32_i24 v155, 2688, v155
    v_add3_u32 v153, v154, v155, s7
    v_cndmask_b32 v153, v255, v153, vcc
    v_mul_u32_u24 v151, 384, v151
    v_sub_u32 v151, v149, v151
    v_add_u32 v153, v153, v151
    s_lshl_b32 s28, s16, 10
    s_add_u32 s28, s28, 20480
    s_waitcnt lgkmcnt(0)
    s_load_dword s101, s[92:93], 0
    s_load_dword s101, s[94:95], 0
    s_cmp_eq_u32 s16, 2
    s_cselect_b64 s[98:99], s[80:81], s[78:79]
    s_cmp_eq_u32 s16, 3
    s_cselect_b64 s[98:99], s[88:89], s[98:99]
    s_mov_b64 s[8:9], s[76:77]
    v_lshl_add_u64 v[116:117], s[98:99], 0, v[116:117]
    s_cmp_eq_u32 s16, 2
    s_cselect_b64 s[98:99], s[84:85], s[82:83]
    s_cmp_eq_u32 s16, 3
    s_cselect_b64 s[98:99], s[86:87], s[98:99]
    v_writelane_b32 v116, s98, 63
    v_writelane_b32 v117, s99, 63
    s_cmp_eq_u32 s16, 0
    s_cbranch_scc1 L_nowue
    global_load_dword a254, v[116:117], off
L_nowue:
    s_add_u32 m0, s28, 65536
    s_nop 0
    buffer_load_dwordx4 v150, s[8:11], 0 offen nt lds
    s_add_u32 m0, s28, 69632
    s_nop 0
    buffer_load_dwordx4 v152, s[8:11], 0 offen lds
    s_add_u32 m0, s28, 73728
    s_nop 0
    buffer_load_dwordx4 v153, s[8:11], 0 offen lds
    s_add_u32 m0, s28, 0
    s_nop 0
    buffer_load_dwordx4 v10, s[8:11], s25 offen nt lds
    s_add_u32 m0, s28, 4096
    s_nop 0
    buffer_load_dwordx4 v11, s[8:11], s25 offen nt lds
    s_mov_b64 s[48:49], s[78:79]
    s_mov_b64 s[52:53], s[80:81]
    s_mov_b64 s[60:61], s[84:85]
    s_mov_b64 s[64:65], s[86:87]
    s_mov_b64 s[56:57], s[88:89]
    s_mov_b64 s[46:47], s[82:83]
    s_load_dwordx4 s[40:43], s[0:1], 72
    s_add_u32 s48, s48, 384
    s_addc_u32 s49, s49, 0
    s_add_u32 m0, s68, 0
    v_add_u32 v149, s16, v114
    v_and_b32 v149, 3, v149
    v_lshlrev_b32 v149, 1, v149
    s_mov_b32 s54, 12288
    s_mov_b32 s55, 0x00020000
    s_mov_b32 s62, 64
    s_mov_b32 s63, 0x00020000
    s_mov_b32 s66, 128
    s_mov_b32 s67, 0x00020000
    s_mov_b32 s58, 676
    s_mov_b32 s59, 0x00020000
    s_mov_b32 s14, 0
    s_mov_b32 s15, 0x00020000
    v_mov_b32 v119, 0
    v_cmp_lt_u32 s[90:91], 7, v122
    v_mov_b32 v117, 0
    v_mov_b32 v121, 0
    v_mov_b32 v127, 0
    v_lshlrev_b32 v116, 1, v114
    v_mul_u32_u24 v120, 12, v122
    s_mul_i32 s71, s16, 192
    v_add_u32 v120, s71, v120
    v_lshlrev_b32 v126, 5, v115
    s_mul_i32 s72, s16, 9408
    s_add_u32 s72, s72, 104448
    s_mul_i32 s73, s16, 7616
    s_add_u32 s73, s73, 38912
    s_cmp_eq_u32 s16, 3
    s_cselect_b32 s73, 142080, s73
    v_lshrrev_b32 v129, 2, v122
    v_and_b32 v128, 1, v129
    v_mul_u32_u24 v128, 0x020202, v128
    v_lshl_or_b32 v128, v128, 8, v128
    v_add_u32 v128, 0x05040100, v128
    v_and_b32 v130, 3, v122
    v_lshrrev_b32 v118, 1, v122
    v_xor_b32 v131, v118, v115
    v_mul_u32_u24 v118, 384, v122
    v_lshl_add_u32 v0, v131, 4, v118
    v_xor_b32 v1, 64, v0
    v_and_b32 v118, 2, v115
    v_add_u32 v118, v118, v115
    v_lshl_add_u32 v118, v118, 2, v129
    v_mul_u32_u24 v118, 96, v118
    v_lshl_add_u32 v118, v130, 3, v118
    v_add_u32 v131, s68, v118
    v_add_u32 v133, s69, v118
    v_add_u32 v132, s72, v118
    v_add_u32 v134, s73, v118
    v_mov_b32 v28, 0x3f803f80
    v_mov_b32 v29, 0x3f803f80
    v_mov_b32 v30, 0x3f803f80
    v_mov_b32 v31, 0x3f803f80
    v_mul_u32_u24 v135, 768, v115
    v_add_u32 v135, v120, v135
    v_add_u32 v135, 98304, v135
    s_mov_b32 s76, 0x3f80
    v_and_b32 v118, 1, v122
    v_lshlrev_b32 v118, 4, v118
    v_lshlrev_b32 v142, v118, s76
    v_mov_b32 v136, 0x3c003c00
    v_mov_b32 v44, 1.0
    v_lshlrev_b32 v137, 4, v115
    s_mov_b32 s19, s38
    s_mov_b32 s23, s25
    s_mov_b32 s26, 0
    s_mov_b32 s27, 0
    s_mov_b32 s18, 0
    s_add_u32 s19, s19, s20
    s_add_u32 s23, s23, s21
    s_cmp_ge_u32 s19, 72
    s_cselect_b32 s34, 72, 0
    s_cselect_b32 s35, s22, 0
    s_sub_u32 s19, s19, s34
    s_add_u32 s23, s23, s35
    s_mov_b32 s24, s23
    s_add_u32 s19, s19, s20
    s_add_u32 s23, s23, s21
    s_cmp_ge_u32 s19, 72
    s_cselect_b32 s34, 72, 0
    s_cselect_b32 s35, s22, 0
    s_sub_u32 s19, s19, s34
    s_add_u32 s23, s23, s35
    s_mul_i32 s79, s16, 64
    v_lshl_add_u32 v143, v115, 4, s79
    s_mul_i32 s80, s16, 32
    s_add_u32 s80, s80, 256
    v_lshl_add_u32 v151, v115, 3, s80
    v_add_u32 v150, 0, v122
    v_mul_u32_u24 v145, 37, v150
    v_mul_u32_u24 v144, 384, v150
    v_lshrrev_b32 v145, 8, v145
    v_mad_u32_u24 v144, v145, s70, v144
    v_add_u32 v15, v144, v143
    v_add_u32 v18, v144, v151
    v_mul_u32_u24 v144, 37, v150
    v_lshrrev_b32 v144, 8, v144
    v_mul_u32_u24 v152, 7, v144
    v_sub_u32 v152, v150, v152
    v_add_u32 v155, 16, v122
    v_mul_u32_u24 v154, 37, v155
    v_mul_u32_u24 v153, 384, v155
    v_lshrrev_b32 v154, 8, v154
    v_mad_u32_u24 v153, v154, s70, v153
    v_add_u32 v16, v153, v143
    v_add_u32 v19, v153, v151
    v_mul_u32_u24 v153, 37, v155
    v_lshrrev_b32 v153, 8, v153
    v_mul_u32_u24 v156, 7, v153
    v_sub_u32 v156, v155, v156
    v_add_u32 v159, 32, v122
    v_mul_u32_u24 v157, 37, v159
    v_mul_u32_u24 v158, 384, v159
    v_lshrrev_b32 v157, 8, v157
    v_mad_u32_u24 v158, v157, s70, v158
    v_add_u32 v17, v158, v143
    v_add_u32 v20, v158, v151
    v_mul_u32_u24 v151, 37, v159
    v_lshrrev_b32 v151, 8, v151
    v_mul_u32_u24 v143, 7, v151
    v_sub_u32 v143, v159, v143
    s_mul_i32 s81, s16, 768
    s_add_u32 s81, s81, 98304
    v_mul_u32_u24 v145, 24, v145
    v_lshl_add_u32 v145, v150, 2, v145
    v_add_u32 v22, s81, v145
    v_sub_u32 v23, s81, v145
    v_sub_u32 v158, v22, v137
    v_mul_u32_u24 v145, 24, v154
    v_lshl_add_u32 v145, v155, 2, v145
    v_add_u32 v24, s81, v145
    v_sub_u32 v25, s81, v145
    v_sub_u32 v154, v24, v137
    v_mul_u32_u24 v145, 24, v157
    v_lshl_add_u32 v145, v159, 2, v145
    v_add_u32 v26, s81, v145
    v_sub_u32 v27, s81, v145
    v_sub_u32 v145, v26, v137
    v_mul_u32_u24 v157, 148, v115
    s_mov_b32 s82, -24
    v_add_u32 v160, 0, v157
    v_lshrrev_b32 v160, 8, v160
    v_mad_i32_i24 v46, v160, s82, v158
    v_mad_i32_i24 v58, v160, s82, v154
    v_mad_i32_i24 v70, v160, s82, v145
    v_add_u32 v160, 37, v157
    v_lshrrev_b32 v160, 8, v160
    v_mad_i32_i24 v47, v160, s82, v158
    v_mad_i32_i24 v59, v160, s82, v154
    v_mad_i32_i24 v71, v160, s82, v145
    v_add_u32 v160, 74, v157
    v_lshrrev_b32 v160, 8, v160
    v_mad_i32_i24 v48, v160, s82, v158
    v_mad_i32_i24 v60, v160, s82, v154
    v_mad_i32_i24 v72, v160, s82, v145
    v_add_u32 v160, 111, v157
    v_lshrrev_b32 v160, 8, v160
    v_mad_i32_i24 v49, v160, s82, v158
    v_mad_i32_i24 v61, v160, s82, v154
    v_mad_i32_i24 v73, v160, s82, v145
    v_add_u32 v160, 592, v157
    v_lshrrev_b32 v160, 8, v160
    v_mad_i32_i24 v50, v160, s82, v158
    v_mad_i32_i24 v62, v160, s82, v154
    v_mad_i32_i24 v74, v160, s82, v145
    v_add_u32 v160, 629, v157
    v_lshrrev_b32 v160, 8, v160
    v_mad_i32_i24 v51, v160, s82, v158
    v_mad_i32_i24 v63, v160, s82, v154
    v_mad_i32_i24 v75, v160, s82, v145
    v_add_u32 v160, 666, v157
    v_lshrrev_b32 v160, 8, v160
    v_mad_i32_i24 v52, v160, s82, v158
    v_mad_i32_i24 v64, v160, s82, v154
    v_mad_i32_i24 v76, v160, s82, v145
    v_add_u32 v160, 703, v157
    v_lshrrev_b32 v160, 8, v160
    v_mad_i32_i24 v53, v160, s82, v158
    v_mad_i32_i24 v65, v160, s82, v154
    v_mad_i32_i24 v77, v160, s82, v145
    v_add_u32 v160, 1184, v157
    v_lshrrev_b32 v160, 8, v160
    v_mad_i32_i24 v54, v160, s82, v158
    v_mad_i32_i24 v66, v160, s82, v154
    v_mad_i32_i24 v78, v160, s82, v145
    v_add_u32 v160, 1221, v157
    v_lshrrev_b32 v160, 8, v160
    v_mad_i32_i24 v55, v160, s82, v158
    v_mad_i32_i24 v67, v160, s82, v154
    v_mad_i32_i24 v79, v160, s82, v145
    v_add_u32 v160, 1258, v157
    v_lshrrev_b32 v160, 8, v160
    v_mad_i32_i24 v56, v160, s82, v158
    v_mad_i32_i24 v68, v160, s82, v154
    v_mad_i32_i24 v80, v160, s82, v145
    v_add_u32 v157, 1295, v157
    v_lshrrev_b32 v157, 8, v157
    v_mad_i32_i24 v57, v157, s82, v158
    v_mad_i32_i24 v69, v157, s82, v154
    v_mad_i32_i24 v81, v157, s82, v145
    v_mov_b32 v154, s81
    v_lshlrev_b32 v145, 4, v114
    v_xor_b32 v2, 65536, v145
    v_lshl_add_u32 v3, s16, 10, v145
    s_lshr_b32 s83, s16, 1
    s_and_b32 s84, s16, 1
    s_lshl_b32 s84, s84, 3
    s_lshl_b32 s85, s83, 10
    s_add_u32 s85, s85, s84
    v_add_u32 v4, s85, v145
    s_lshl_b32 s83, s83, 11
    s_add_u32 s83, s83, s84
    s_add_u32 s83, s83, 157888
    s_mul_i32 s86, s16, 2048
    s_add_u32 s86, s86, 149696
    v_lshl_add_u32 v157, v115, 3, s86
    v_mov_b32 v145, s83
    v_mov_b32 v160, 163264
    v_mul_u32_u24 v158, 80, v115
    v_add3_u32 v5, v158, v118, s72
    s_mul_i32 s87, s16, 128
    s_add_u32 s87, s87, 61760
    s_mov_b32 s32, 0x2a8cbccc
    s_mov_b32 s33, 0x38fba882
    s_add_u32 s75, s28, 16384
    s_cmp_lt_u32 s16, 2
    s_cselect_b32 s29, s75, 161984
    s_cselect_b32 s30, 65536, 0
    s_xor_b32 s74, s29, s30
    s_lshl_b32 s92, s5, 1
    s_or_b32 s92, s92, s6
    s_mul_i32 s77, s16, 64
    s_mul_i32 s78, s16, 32
    s_add_u32 s78, s78, 192
    s_add_u32 s34, s18, 2
    s_mov_b32 s27, s26
    s_mov_b32 s26, s25
    s_add_u32 s19, s19, s20
    s_mov_b32 s18, 1
    s_mov_b32 s71, 1
    buffer_load_dwordx4 v138, s[48:51], 0 offen lds
    v_lshl_add_u32 v6, v122, 2, s73
    v_add_u32 v9, s87, v137
    v_lshrrev_b32 v118, 1, v115
    buffer_load_dwordx4 v140, s[48:51], 0 offen offset:1024 lds
    v_mul_u32_u24 v118, 48, v118
    v_lshl_add_u32 v118, v115, 3, v118
    v_lshl_add_u32 v118, v129, 4, v118
    buffer_load_dwordx4 v146, s[48:51], 0 offen offset:2048 lds
    s_add_u32 s48, s48, 36864
    s_addc_u32 s49, s49, 0
    s_add_u32 m0, s68, 3072
    v_lshl_add_u32 v118, v130, 1, v118
    buffer_load_dwordx4 v138, s[48:51], 0 offen lds
    v_add_u32 v8, s87, v118
    v_mov_b32 v37, 0
    v_mov_b32 v38, 0
    buffer_load_dwordx4 v140, s[48:51], 0 offen offset:1024 lds
    v_mov_b32 v39, 0
    v_add_u32 v162, 86016, v0
    v_add_u32 v163, 86016, v1
    buffer_load_dwordx4 v146, s[48:51], 0 offen offset:2048 lds
    s_add_u32 s48, s48, 36864
    s_addc_u32 s49, s49, 0
    s_add_u32 m0, s69, 0
    buffer_load_ushort v118, v116, s[60:63], 0 offen
    s_mov_b64 s[60:61], s[8:9]
    s_sub_u32 s62, s45, s17
    s_sub_u32 s45, s17, 1
    s_bfm_b32 s63, s17, 0
    buffer_load_dwordx3 v[170:172], v120, s[56:59], 0 offen
    v_lshlrev_b32 v164, 4, v122
    buffer_load_dwordx4 v[186:189], v126, s[64:67], 0 offen
    v_add_u32 v164, 161984, v164
    v_mul_u32_u24 v165, 336, v122
    v_add3_u32 v165, v165, v158, s72
    v_mul_u32_u24 v166, 272, v122
    v_add3_u32 v166, v166, v137, s73
    v_mul_u32_u24 v167, 1088, v115
    buffer_load_dwordx4 v[234:237], v126, s[64:67], 0 offen offset:16
    v_add_u32 v167, v167, v6
    v_add_u32 v168, 5376, v165
    v_add_u32 v169, 4352, v166
    v_add_u32 v175, 4352, v167
    v_cmp_gt_u32 s[88:89], 16, v114
    v_mov_b32 v174, 0xf149f2ca
    v_add_u32 v120, 768, v254
    v_mul_u32_u24 v116, 2731, v120
    v_bfe_u32 v126, v116, 17, 3
    v_lshrrev_b32 v116, 16, v116
    v_xor_b32 v120, v126, v120
    v_mul_u32_u24 v126, 37, v116
    v_lshrrev_b32 v126, 8, v126
    v_lshlrev_b32 v120, 4, v120
    v_mad_u32_u24 v13, v126, s70, v120
    v_mul_u32_u24 v126, 37, v116
    v_lshrrev_b32 v126, 8, v126
    v_mul_u32_u24 v120, 7, v126
    v_sub_u32 v120, v116, v120
    v_cmp_gt_u32 vcc, 4, v126
    v_add_u32 v116, 1024, v254
    v_mul_u32_u24 v173, 2731, v116
    v_cndmask_b32 v126, v141, v123, vcc
    v_cmp_gt_u32 vcc, 4, v120
    v_bfe_u32 v254, v173, 17, 3
    v_lshrrev_b32 v173, 16, v173
    v_cndmask_b32 v120, v148, v147, vcc
    v_add3_u32 v13, v13, v126, v120
    v_xor_b32 v116, v254, v116
    v_mul_u32_u24 v254, 37, v173
    v_lshrrev_b32 v254, 8, v254
    v_lshlrev_b32 v116, 4, v116
    v_mad_u32_u24 v14, v254, s70, v116
    v_mul_u32_u24 v116, 37, v173
    v_lshrrev_b32 v116, 8, v116
    v_mul_u32_u24 v120, 7, v116
    v_sub_u32 v120, v173, v120
    v_cmp_gt_u32 vcc, 4, v116
    v_mov_b32 v254, 0xc31044fe
    v_mul_u32_u24 v176, 37, v150
    v_cndmask_b32 v116, v141, v123, vcc
    v_cmp_gt_u32 vcc, 4, v120
    v_lshrrev_b32 v176, 8, v176
    v_mul_u32_u24 v126, 7, v176
    v_cndmask_b32 v120, v148, v147, vcc
    v_add3_u32 v14, v14, v116, v120
    v_cmp_gt_u32 vcc, 48, v173
    v_sub_u32 v126, v150, v126
    v_lshrrev_b32 v176, 2, v176
    v_cndmask_b32 v14, v255, v14, vcc
    v_cmp_gt_u32 vcc, 2, v130
    v_lshrrev_b32 v126, 2, v126
    v_and_b32 v176, s5, v176
    v_cndmask_b32 v32, 0, v142, vcc
    v_cndmask_b32 v33, v142, 0, vcc
    v_cndmask_b32 v34, 0, v142, vcc
    v_cndmask_b32 v35, v142, 0, vcc
    v_cmp_eq_u32 vcc, 0, v130
    v_and_b32 v126, s6, v126
    v_lshl_or_b32 v176, v176, 1, v126
    v_cndmask_b32 v40, 0, v136, vcc
    v_cmp_eq_u32 vcc, 1, v130
    v_mul_u32_u24 v255, 37, v155
    v_lshrrev_b32 v255, 8, v255
    v_cndmask_b32 v41, 0, v136, vcc
    v_cmp_eq_u32 vcc, 2, v130
    s_min_u32 s70, s62, 4
    s_waitcnt vmcnt(9)
    s_barrier
    global_load_ushort v149, v149, s[46:47]
    v_cndmask_b32 v42, 0, v136, vcc
    v_cmp_eq_u32 vcc, 3, v130
    v_mul_u32_u24 v116, 7, v255
    v_sub_u32 v116, v155, v116
    v_cndmask_b32 v43, 0, v136, vcc
    v_cmp_eq_u32 vcc, v115, v129
    v_lshrrev_b32 v255, 2, v255
    v_lshrrev_b32 v116, 2, v116
    v_cndmask_b32 v178, 0, v32, vcc
    s_lshr_b32 s83, s44, 8
    s_cselect_b32 s70, 0, s70
    buffer_load_dwordx4 v138, s[48:51], 0 offen lds
    v_cndmask_b32 v179, 0, v33, vcc
    v_and_b32 v255, s5, v255
    v_and_b32 v116, s6, v116
    v_lshl_or_b32 v255, v255, 1, v116
    v_mul_u32_u24 v177, 37, v159
    v_lshrrev_b32 v177, 8, v177
    v_mul_u32_u24 v116, 7, v177
    v_sub_u32 v116, v159, v116
    v_lshrrev_b32 v177, 2, v177
    v_lshrrev_b32 v116, 2, v116
    v_and_b32 v177, s5, v177
    v_and_b32 v116, s6, v116
    v_lshl_or_b32 v177, v177, 1, v116
    v_mul_u32_u24 v116, 6, v124
    s_waitcnt vmcnt(9)
    buffer_load_dwordx4 v140, s[48:51], 0 offen offset:1024 lds
    ds_read_b64_tr_b16 a[72:73], v131 offset:0
    ds_read_b64_tr_b16 a[74:75], v131 offset:768
    ds_read_b64_tr_b16 a[96:97], v131 offset:32
    ds_read_b64_tr_b16 a[98:99], v131 offset:800
    ds_read_b64_tr_b16 a[120:121], v131 offset:64
    ds_read_b64_tr_b16 a[122:123], v131 offset:832
    v_sub_u32 v120, v114, v116
    v_mul_u32_u24 v116, 384, v124
    v_lshl_add_u32 v116, v120, 4, v116
    v_add_u32 v124, s78, v116
    v_add_u32 v116, s77, v116
    v_cmp_gt_i32 vcc, 4, v120
    v_mul_u32_u24 v126, 6, v125
    v_sub_u32 v120, v114, v126
    v_cndmask_b32 v180, v124, v116, vcc
    buffer_load_dwordx4 v146, s[48:51], 0 offen offset:2048 lds
    s_add_u32 s48, s48, 36864
    s_addc_u32 s49, s49, 0
    s_add_u32 m0, s69, 3072
    v_mul_u32_u24 v126, 384, v125
    v_lshl_add_u32 v126, v120, 4, v126
    v_add_u32 v136, s78, v126
    v_add_u32 v126, s77, v126
    v_cmp_gt_i32 vcc, -60, v120
    v_mul_u32_u24 v142, 6, v139
    v_sub_u32 v120, v114, v142
    v_cndmask_b32 v181, v136, v126, vcc
    v_mul_u32_u24 v142, 384, v139
    v_lshl_add_u32 v142, v120, 4, v142
    v_add_u32 v126, s78, v142
    v_add_u32 v142, s77, v142
    s_and_b32 s77, s2, 0xf8
    s_add_u32 s77, s77, 4940
    s_mul_i32 s78, s77, 58255
    s_lshr_b32 s78, s78, 22
    buffer_load_dwordx4 v138, s[48:51], 0 offen lds
    v_cmp_gt_i32 vcc, -124, v120
    v_mul_u32_u24 v136, 96, v122
    v_add3_u32 v155, v136, v137, s68
    v_cndmask_b32 v139, v126, v142, vcc
    v_cmp_gt_u32 vcc, 4, v144
    v_lshl_add_u32 v114, v115, 3, v136
    v_add3_u32 v114, v114, 64, s68
    v_cndmask_b32 v144, v141, v123, vcc
    s_waitcnt vmcnt(9)
    ds_read_b64_tr_b16 a[76:77], v131 offset:3072
    ds_read_b64_tr_b16 a[78:79], v131 offset:3840
    s_waitcnt vmcnt(7)
    ds_read_b64_tr_b16 a[100:101], v131 offset:3104
    s_waitcnt vmcnt(6)
    ds_read_b64_tr_b16 a[102:103], v131 offset:3872
    s_waitcnt vmcnt(5)
    buffer_load_dwordx4 v140, s[48:51], 0 offen offset:1024 lds
    ds_read_b64_tr_b16 a[124:125], v131 offset:3136
    ds_read_b64_tr_b16 a[126:127], v131 offset:3904
    v_cndmask_b32 v186, v186, v187, s[90:91]
    v_cndmask_b32 v188, v188, v189, s[90:91]
    v_perm_b32 v124, v188, v186, v128
    v_cndmask_b32 v234, v234, v235, s[90:91]
    v_cndmask_b32 v236, v236, v237, s[90:91]
    v_perm_b32 v125, v236, v234, v128
    v_bfe_u32 v116, v170, v137, 16
    v_bfe_u32 v120, v171, v137, 16
    v_bfe_u32 v126, v172, v137, 16
    v_mfma_f32_16x16x16_bf16 v[170:173], v[118:119], v[116:117], 0
    v_cmp_gt_u32 vcc, 4, v152
    v_add3_u32 v116, v136, v137, s69
    v_lshl_add_u32 v117, v115, 3, v136
    v_mfma_f32_16x16x16_bf16 v[186:189], v[118:119], v[120:121], 0
    v_cndmask_b32 v152, v148, v147, vcc
    v_add3_u32 v15, v15, v144, v152
    v_add3_u32 v18, v18, v144, v152
    v_mfma_f32_16x16x16_bf16 v[234:237], v[118:119], v[126:127], 0
    buffer_load_dwordx4 v146, s[48:51], 0 offen offset:2048 lds
    s_add_u32 s48, s48, 36864
    s_addc_u32 s49, s49, 0
    s_add_u32 m0, s72, 0
    v_max_f32 v170, 0, v170
    v_max_f32 v171, 0, v171
    v_max_f32 v172, 0, v172
    v_max_f32 v173, 0, v173
    v_cvt_pk_bf16_f32 v136, v170, v171
    v_cvt_pk_bf16_f32 v137, v172, v173
    v_max_f32 v186, 0, v186
    v_max_f32 v187, 0, v187
    v_mfma_f32_16x16x16_bf16 v[118:121], v[124:125], v[136:137], 0
    v_max_f32 v188, 0, v188
    s_waitcnt vmcnt(6)
    v_max_f32 v189, 0, v189
    buffer_load_dwordx4 v138, s[48:51], 0 offen lds
    v_cvt_pk_bf16_f32 v136, v186, v187
    v_cvt_pk_bf16_f32 v137, v188, v189
    v_max_f32 v234, 0, v234
    v_max_f32 v235, 0, v235
    v_mfma_f32_16x16x16_bf16 v[170:173], v[124:125], v[136:137], 0
    v_cvt_pk_bf16_f32 v118, v118, v118
    v_and_b32 v118, 0xffff0000, v118
    v_mul_f32 v118, 0xbfb8aa3b, v118
    v_exp_f32 v118, v118
    v_max_f32 v236, 0, v236
    v_add_f32 v118, 1.0, v118
    v_rcp_f32 v118, v118
    v_max_f32 v237, 0, v237
    buffer_load_dwordx4 v140, s[48:51], 0 offen offset:1024 lds
    v_cvt_pk_bf16_f32 v118, v118, v118
    v_and_b32 v118, 0xffff0000, v118
    v_add_f32 v118, -0.5, v118
    v_mul_f32 v118, 0x41b8aa3b, v118
    ds_write_b32 v135, v118 offset:0
    v_cvt_pk_bf16_f32 v170, v170, v170
    v_and_b32 v170, 0xffff0000, v170
    v_mul_f32 v170, 0xbfb8aa3b, v170
    v_exp_f32 v170, v170
    v_cvt_pk_bf16_f32 v136, v234, v235
    v_add_f32 v170, 1.0, v170
    buffer_load_dwordx4 v146, s[48:51], 0 offen offset:2048 lds
    s_add_u32 s48, s48, 36864
    s_addc_u32 s49, s49, 0
    s_add_u32 m0, s72, 3072
    v_rcp_f32 v170, v170
    v_cvt_pk_bf16_f32 v137, v236, v237
    v_cvt_pk_bf16_f32 v170, v170, v170
    v_and_b32 v170, 0xffff0000, v170
    v_mfma_f32_16x16x16_bf16 v[118:121], v[124:125], v[136:137], 0
    v_add_f32 v170, -0.5, v170
    s_waitcnt vmcnt(6)
    s_mov_b32 s72, 2
    ds_read_b64_tr_b16 a[80:81], v133 offset:0
    ds_read_b64_tr_b16 a[82:83], v133 offset:768
    ds_read_b64_tr_b16 a[104:105], v133 offset:32
    ds_read_b64_tr_b16 a[106:107], v133 offset:800
    ds_read_b64_tr_b16 a[128:129], v133 offset:64
    buffer_load_dwordx4 v138, s[48:51], 0 offen lds
    ds_read_b64_tr_b16 a[130:131], v133 offset:832
    v_mul_f32 v170, 0x41b8aa3b, v170
    ds_write_b32 v135, v170 offset:4
    v_cvt_pk_bf16_f32 v118, v118, v118
    v_and_b32 v118, 0xffff0000, v118
    v_mul_f32 v118, 0xbfb8aa3b, v118
    v_exp_f32 v118, v118
    v_lshlrev_b32 v149, 16, v149
    v_add_f32 v118, 1.0, v118
    v_rcp_f32 v118, v118
    buffer_load_dwordx4 v140, s[48:51], 0 offen offset:1024 lds
    v_cvt_pk_bf16_f32 v118, v118, v118
    v_and_b32 v118, 0xffff0000, v118
    v_add_f32 v118, -0.5, v118
    v_mul_f32 v118, 0x41b8aa3b, v118
    ds_write_b32 v135, v118 offset:8
    v_max_f32 v149, 0xc2c80000, v149
    v_min_f32 v149, 0x40930000, v149
    v_mul_f32 v149, 0x3fb8aa3b, v149
    v_exp_f32 v149, v149
    v_cmp_gt_u32 vcc, 4, v153
    v_cvt_pk_bf16_f32 v149, v149, v149
    buffer_load_dwordx4 v146, s[48:51], 0 offen offset:2048 lds
    s_sub_u32 s48, s48, 184704
    s_subb_u32 s49, s49, 0
    s_add_u32 m0, s73, 0
    v_and_b32 v149, 0xffff0000, v149
    v_mul_f32 v124, 0x3fb8aa3b, v149
    v_readfirstlane_b32 s37, v149
    v_readfirstlane_b32 s31, v124
    v_cndmask_b32 v153, v141, v123, vcc
    v_cmp_gt_u32 vcc, 4, v156
    v_add3_u32 v117, v117, 64, s69
    s_nop 0
    v_cndmask_b32 v156, v148, v147, vcc
    v_add3_u32 v16, v16, v153, v156
    v_add3_u32 v19, v19, v153, v156
    v_cmp_gt_u32 vcc, 4, v151
    buffer_load_dwordx4 v138, s[48:51], 0 offen lds
    s_waitcnt vmcnt(7)
    s_waitcnt lgkmcnt(0)
    s_barrier
    ds_read_b64_tr_b16 a[84:85], v133 offset:3072
    ds_read_b64_tr_b16 a[86:87], v133 offset:3840
    ds_read_b64_tr_b16 a[108:109], v133 offset:3104
    ds_read_b64_tr_b16 a[110:111], v133 offset:3872
    ds_read_b64_tr_b16 a[132:133], v133 offset:3136
    ds_read_b64_tr_b16 a[134:135], v133 offset:3904
    ds_read_b32 v22, v22 offset:0
    ds_read_b32 v23, v23 offset:672
    v_cndmask_b32 v151, v141, v123, vcc
    v_cmp_gt_u32 vcc, 4, v143
    ds_read_b32 v24, v24 offset:0
    ds_read_b32 v25, v25 offset:672
    buffer_load_dwordx4 v140, s[48:51], 0 offen offset:1024 lds
    ds_read_b32 v26, v26 offset:0
    ds_read_b32 v27, v27 offset:672
    ds_read_b32 v46, v46 offset:336
    v_cndmask_b32 v143, v148, v147, vcc
    v_add3_u32 v17, v17, v151, v143
    v_add3_u32 v20, v20, v151, v143
    v_cmp_gt_u32 vcc, 2, v115
    ds_read_b32 v58, v58 offset:336
    ds_read_b32 v70, v70 offset:336
    ds_read_b32 v47, v47 offset:332
    ds_read_b32 v59, v59 offset:332
    ds_read_b32 v71, v71 offset:332
    ds_read_b32 v48, v48 offset:328
    buffer_load_dwordx4 v146, s[48:51], 0 offen offset:2048 lds
    ds_read_b32 v60, v60 offset:328
    ds_read_b32 v72, v72 offset:328
    ds_read_b32 v49, v49 offset:324
    s_add_u32 s48, s48, 36864
    ds_read_b32 v61, v61 offset:324
    s_addc_u32 s49, s49, 0
    ds_read_b32 v73, v73 offset:324
    s_add_u32 m0, s73, 3072
    ds_read_b32 v50, v50 offset:272
    v_cndmask_b32 v157, v145, v157, vcc
    v_lshl_add_u32 v157, v129, 9, v157
    v_lshl_add_u32 v157, v130, 1, v157
    v_cmp_gt_u32 vcc, 3, v115
    s_mov_b32 s73, 3
    s_waitcnt vmcnt(6)
    buffer_load_dwordx4 v138, s[48:51], 0 offen lds
    ds_read_b64_tr_b16 a[88:89], v132 offset:0
    ds_read_b64_tr_b16 a[90:91], v132 offset:768
    ds_read_b64_tr_b16 a[112:113], v132 offset:32
    ds_read_b64_tr_b16 a[114:115], v132 offset:800
    ds_read_b64_tr_b16 a[136:137], v132 offset:64
    ds_read_b64_tr_b16 a[138:139], v132 offset:832
    ds_read_b32 v62, v62 offset:272
    ds_read_b32 v74, v74 offset:272
    v_cndmask_b32 v7, v160, v157, vcc
    v_cmp_gt_u32 vcc, 12, v122
    ds_read_b32 v51, v51 offset:268
    ds_read_b32 v63, v63 offset:268
    ds_read_b32 v75, v75 offset:268
    ds_read_b32 v52, v52 offset:264
    buffer_load_dwordx4 v140, s[48:51], 0 offen offset:1024 lds
    ds_read_b32 v64, v64 offset:264
    ds_read_b32 v76, v76 offset:264
    v_cndmask_b32 v168, v164, v168, vcc
    v_cndmask_b32 v169, v164, v169, vcc
    v_cmp_gt_u32 vcc, 3, v115
    ds_read_b32 v53, v53 offset:260
    ds_read_b32 v65, v65 offset:260
    ds_read_b32 v77, v77 offset:260
    ds_read_b32 v54, v54 offset:208
    ds_read_b32 v66, v66 offset:208
    v_cndmask_b32 v175, v164, v175, vcc
    ds_read_b32 v78, v78 offset:208
    ds_read_b32 v55, v55 offset:204
    buffer_load_dwordx4 v146, s[48:51], 0 offen offset:2048 lds
    ds_read_b32 v67, v67 offset:204
    ds_read_b32 v79, v79 offset:204
    s_add_u32 s48, s48, 36864
    ds_read_b32 v56, v56 offset:200
    s_addc_u32 s49, s49, 0
    ds_read_b32 v68, v68 offset:200
    s_add_u32 m0, s68, 0
    ds_read_b32 v80, v80 offset:200
    ds_read_b32 v57, v57 offset:196
    ds_read_b32 v69, v69 offset:196
    ds_read_b32 v81, v81 offset:196
    s_waitcnt vmcnt(6)
    ds_read_b64_tr_b16 a[92:93], v132 offset:3072
    buffer_load_dwordx4 v138, s[48:51], 0 offen lds
    ds_read_b64_tr_b16 a[94:95], v132 offset:3840
    ds_read_b64_tr_b16 a[116:117], v132 offset:3104
    ds_read_b64_tr_b16 a[118:119], v132 offset:3872
    ds_read_b64_tr_b16 a[140:141], v132 offset:3136
    ds_read_b64_tr_b16 a[142:143], v132 offset:3904
    ds_read_b32 v154, v154 offset:336
    v_cmp_ne_u32 vcc, s92, v176
    v_lshl_add_u32 v164, v115, 2, 0
    v_mul_u32_u24 v130, 37, v164
    v_cndmask_b32 v141, 0, v254, vcc
    s_waitcnt lgkmcnt(12)
    buffer_load_dwordx4 v140, s[48:51], 0 offen offset:1024 lds
    v_add_f32 v22, v22, v141
    v_cmp_ne_u32 vcc, s92, v176
    v_lshrrev_b32 v130, 8, v130
    v_mul_u32_u24 v141, 7, v130
    v_cndmask_b32 v132, 0, v254, vcc
    v_add_f32 v23, v23, v132
    v_cmp_ne_u32 vcc, s92, v255
    v_sub_u32 v141, v164, v141
    v_lshrrev_b32 v130, 2, v130
    v_cndmask_b32 v132, 0, v254, vcc
    v_add_f32 v24, v24, v132
    v_cmp_ne_u32 vcc, s92, v255
    v_lshrrev_b32 v141, 2, v141
    v_and_b32 v130, s5, v130
    v_cndmask_b32 v132, 0, v254, vcc
    buffer_load_dwordx4 v146, s[48:51], 0 offen offset:2048 lds
    s_add_u32 s48, s48, 36864
    s_waitcnt lgkmcnt(0)
    s_addc_u32 s49, s49, 0
    s_add_u32 m0, s68, 3072
    v_readfirstlane_b32 s39, v154
    v_add_f32 v25, v25, v132
    v_cmp_ne_u32 vcc, s92, v177
    v_and_b32 v141, s6, v141
    v_lshl_or_b32 v130, v130, 1, v141
    v_cndmask_b32 v132, 0, v254, vcc
    v_add_f32 v26, v26, v132
    v_cmp_ne_u32 vcc, s92, v177
    v_lshl_add_u32 v132, v115, 2, 1
    v_mul_u32_u24 v141, 37, v132
    s_waitcnt vmcnt(6)
    buffer_load_dwordx4 v138, s[48:51], 0 offen lds
    ds_read_b64_tr_b16 a[0:1], v134 offset:0
    ds_read_b64_tr_b16 a[2:3], v134 offset:768
    ds_read_b64_tr_b16 a[24:25], v134 offset:32
    ds_read_b64_tr_b16 a[26:27], v134 offset:800
    ds_read_b64_tr_b16 a[48:49], v134 offset:64
    ds_read_b64_tr_b16 a[50:51], v134 offset:832
    v_cndmask_b32 v164, 0, v254, vcc
    v_add_f32 v27, v27, v164
    v_cmp_ne_u32 vcc, v130, v176
    v_lshrrev_b32 v141, 8, v141
    v_mul_u32_u24 v164, 7, v141
    v_cndmask_b32 v135, 0, v254, vcc
    v_add_f32 v46, v46, v135
    v_cmp_ne_u32 vcc, v130, v255
    v_sub_u32 v164, v132, v164
    buffer_load_dwordx4 v140, s[48:51], 0 offen offset:1024 lds
    v_cndmask_b32 v132, 0, v254, vcc
    v_add_f32 v58, v58, v132
    v_cmp_ne_u32 vcc, v130, v177
    v_lshrrev_b32 v141, 2, v141
    v_lshrrev_b32 v164, 2, v164
    v_cndmask_b32 v130, 0, v254, vcc
    v_add_f32 v70, v70, v130
    v_and_b32 v141, s5, v141
    v_and_b32 v164, s6, v164
    v_lshl_or_b32 v141, v141, 1, v164
    v_cmp_ne_u32 vcc, v141, v176
    v_lshl_add_u32 v164, v115, 2, 2
    v_mul_u32_u24 v130, 37, v164
    v_cndmask_b32 v132, 0, v254, vcc
    v_add_f32 v47, v47, v132
    buffer_load_dwordx4 v146, s[48:51], 0 offen offset:2048 lds
    s_add_u32 s48, s48, 36864
    s_addc_u32 s49, s49, 0
    s_add_u32 m0, s69, 0
    v_cmp_ne_u32 vcc, v141, v255
    v_lshrrev_b32 v130, 8, v130
    v_mul_u32_u24 v132, 7, v130
    v_cndmask_b32 v135, 0, v254, vcc
    v_add_f32 v59, v59, v135
    v_cmp_ne_u32 vcc, v141, v177
    v_sub_u32 v132, v164, v132
    v_lshrrev_b32 v130, 2, v130
    v_cndmask_b32 v141, 0, v254, vcc
    v_add_f32 v71, v71, v141
    v_lshrrev_b32 v132, 2, v132
    v_and_b32 v130, s5, v130
    buffer_load_dwordx4 v138, s[48:51], 0 offen lds
    s_waitcnt vmcnt(7)
    ds_read_b64_tr_b16 a[4:5], v134 offset:3072
    ds_read_b64_tr_b16 a[6:7], v134 offset:3840
    ds_read_b64_tr_b16 a[28:29], v134 offset:3104
    ds_read_b64_tr_b16 a[30:31], v134 offset:3872
    ds_read_b64_tr_b16 a[52:53], v134 offset:3136
    ds_read_b64_tr_b16 a[54:55], v134 offset:3904
    v_and_b32 v132, s6, v132
    v_lshl_or_b32 v130, v130, 1, v132
    v_cmp_ne_u32 vcc, v130, v176
    v_lshl_add_u32 v141, v115, 2, 3
    v_mul_u32_u24 v164, 37, v141
    v_cndmask_b32 v132, 0, v254, vcc
    v_add_f32 v48, v48, v132
    v_cmp_ne_u32 vcc, v130, v255
    buffer_load_dwordx4 v140, s[48:51], 0 offen offset:1024 lds
    v_lshrrev_b32 v164, 8, v164
    v_cndmask_b32 v132, 0, v254, vcc
    v_add_f32 v60, v60, v132
    v_cmp_ne_u32 vcc, v130, v177
    v_mul_u32_u24 v130, 7, v164
    v_sub_u32 v130, v141, v130
    v_cndmask_b32 v141, 0, v254, vcc
    v_add_f32 v72, v72, v141
    v_lshrrev_b32 v164, 2, v164
    v_lshrrev_b32 v130, 2, v130
    v_and_b32 v164, s5, v164
    v_and_b32 v130, s6, v130
    v_lshl_or_b32 v164, v164, 1, v130
    v_cmp_ne_u32 vcc, v164, v176
    v_lshl_add_u32 v141, v115, 2, 16
    buffer_load_dwordx4 v146, s[48:51], 0 offen offset:2048 lds
    s_add_u32 s48, s48, 36864
    s_addc_u32 s49, s49, 0
    s_add_u32 m0, s69, 3072
    v_cndmask_b32 v130, 0, v254, vcc
    v_add_f32 v49, v49, v130
    v_cmp_ne_u32 vcc, v164, v255
    v_mul_u32_u24 v130, 37, v141
    v_lshrrev_b32 v130, 8, v130
    v_cndmask_b32 v132, 0, v254, vcc
    v_add_f32 v61, v61, v132
    v_cmp_ne_u32 vcc, v164, v177
    v_mul_u32_u24 v132, 7, v130
    v_sub_u32 v132, v141, v132
    v_cndmask_b32 v141, 0, v254, vcc
    v_add_f32 v73, v73, v141
    buffer_load_dwordx4 v138, s[48:51], 0 offen lds
    s_waitcnt vmcnt(7)
    ds_read_b64_tr_b16 a[8:9], v131 offset:0
    ds_read_b64_tr_b16 a[10:11], v131 offset:768
    ds_read_b64_tr_b16 a[32:33], v131 offset:32
    ds_read_b64_tr_b16 a[34:35], v131 offset:800
    ds_read_b64_tr_b16 a[56:57], v131 offset:64
    ds_read_b64_tr_b16 a[58:59], v131 offset:832
    v_lshrrev_b32 v130, 2, v130
    v_lshrrev_b32 v132, 2, v132
    v_and_b32 v130, s5, v130
    v_and_b32 v132, s6, v132
    v_lshl_or_b32 v130, v130, 1, v132
    v_cmp_ne_u32 vcc, v130, v176
    v_lshl_add_u32 v141, v115, 2, 17
    v_mul_u32_u24 v164, 37, v141
    buffer_load_dwordx4 v140, s[48:51], 0 offen offset:1024 lds
    v_cndmask_b32 v132, 0, v254, vcc
    v_add_f32 v50, v50, v132
    v_cmp_ne_u32 vcc, v130, v255
    v_lshrrev_b32 v164, 8, v164
    v_mul_u32_u24 v132, 7, v164
    v_cndmask_b32 v147, 0, v254, vcc
    v_add_f32 v62, v62, v147
    v_cmp_ne_u32 vcc, v130, v177
    v_sub_u32 v132, v141, v132
    v_lshrrev_b32 v164, 2, v164
    v_cndmask_b32 v130, 0, v254, vcc
    v_add_f32 v74, v74, v130
    v_lshrrev_b32 v132, 2, v132
    v_and_b32 v164, s5, v164
    v_and_b32 v132, s6, v132
    buffer_load_dwordx4 v146, s[48:51], 0 offen offset:2048 lds
    s_sub_u32 s48, s48, 183552
    s_subb_u32 s49, s49, 0
    s_add_u32 m0, s68, 0
    s_waitcnt lgkmcnt(0)
    v_lshl_or_b32 v164, v164, 1, v132
    v_cmp_ne_u32 vcc, v164, v176
    v_lshl_add_u32 v141, v115, 2, 18
    v_mul_u32_u24 v130, 37, v141
    v_cndmask_b32 v132, 0, v254, vcc
    v_add_f32 v51, v51, v132
    v_cmp_ne_u32 vcc, v164, v255
    v_lshrrev_b32 v130, 8, v130
    v_mul_u32_u24 v132, 7, v130
    v_cndmask_b32 v147, 0, v254, vcc
    v_add_f32 v63, v63, v147
    buffer_load_dwordx4 v138, s[48:51], 0 offen lds
    s_waitcnt vmcnt(7)
    ds_read_b64_tr_b16 a[12:13], v131 offset:3072
    ds_read_b64_tr_b16 a[14:15], v131 offset:3840
    ds_read_b64_tr_b16 a[36:37], v131 offset:3104
    ds_read_b64_tr_b16 a[38:39], v131 offset:3872
    ds_read_b64_tr_b16 a[60:61], v131 offset:3136
    ds_read_b64_tr_b16 a[62:63], v131 offset:3904
    v_cmp_ne_u32 vcc, v164, v177
    v_sub_u32 v132, v141, v132
    v_lshrrev_b32 v130, 2, v130
    v_cndmask_b32 v141, 0, v254, vcc
    v_add_f32 v75, v75, v141
    v_lshrrev_b32 v132, 2, v132
    v_and_b32 v130, s5, v130
    v_and_b32 v132, s6, v132
    buffer_load_dwordx4 v140, s[48:51], 0 offen offset:1024 lds
    v_lshl_or_b32 v130, v130, 1, v132
    v_cmp_ne_u32 vcc, v130, v176
    v_lshl_add_u32 v141, v115, 2, 19
    v_mul_u32_u24 v164, 37, v141
    v_cndmask_b32 v132, 0, v254, vcc
    v_add_f32 v52, v52, v132
    v_cmp_ne_u32 vcc, v130, v255
    v_lshrrev_b32 v164, 8, v164
    v_mul_u32_u24 v132, 7, v164
    v_cndmask_b32 v147, 0, v254, vcc
    v_add_f32 v64, v64, v147
    v_cmp_ne_u32 vcc, v130, v177
    v_sub_u32 v132, v141, v132
    v_lshrrev_b32 v164, 2, v164
    v_cndmask_b32 v130, 0, v254, vcc
    buffer_load_dwordx4 v146, s[48:51], 0 offen offset:2048 lds
    s_add_u32 s48, s48, 36864
    s_addc_u32 s49, s49, 0
    s_add_u32 m0, s68, 3072
    s_waitcnt lgkmcnt(0)
    v_add_f32 v76, v76, v130
    v_lshrrev_b32 v132, 2, v132
    v_and_b32 v164, s5, v164
    v_and_b32 v132, s6, v132
    v_lshl_or_b32 v164, v164, 1, v132
    v_cmp_ne_u32 vcc, v164, v176
    v_lshl_add_u32 v132, v115, 2, 32
    v_mul_u32_u24 v141, 37, v132
    v_cndmask_b32 v130, 0, v254, vcc
    v_add_f32 v53, v53, v130
    v_cmp_ne_u32 vcc, v164, v255
    buffer_load_dwordx4 v138, s[48:51], 0 offen lds
    s_waitcnt vmcnt(7)
    ds_read_b64_tr_b16 a[16:17], v133 offset:0
    ds_read_b64_tr_b16 a[18:19], v133 offset:768
    ds_read_b64_tr_b16 a[40:41], v133 offset:32
    ds_read_b64_tr_b16 a[42:43], v133 offset:800
    ds_read_b64_tr_b16 a[64:65], v133 offset:64
    ds_read_b64_tr_b16 a[66:67], v133 offset:832
    v_cndmask_b32 v130, 0, v254, vcc
    v_add_f32 v65, v65, v130
    v_cmp_ne_u32 vcc, v164, v177
    v_lshrrev_b32 v141, 8, v141
    v_mul_u32_u24 v164, 7, v141
    v_cndmask_b32 v130, 0, v254, vcc
    v_add_f32 v77, v77, v130
    v_sub_u32 v164, v132, v164
    buffer_load_dwordx4 v140, s[48:51], 0 offen offset:1024 lds
    v_lshrrev_b32 v141, 2, v141
    v_lshrrev_b32 v164, 2, v164
    v_and_b32 v141, s5, v141
    v_and_b32 v164, s6, v164
    v_lshl_or_b32 v141, v141, 1, v164
    v_cmp_ne_u32 vcc, v141, v176
    v_lshl_add_u32 v164, v115, 2, 33
    v_mul_u32_u24 v132, 37, v164
    v_cndmask_b32 v130, 0, v254, vcc
    v_add_f32 v54, v54, v130
    v_cmp_ne_u32 vcc, v141, v255
    v_lshrrev_b32 v132, 8, v132
    v_mul_u32_u24 v130, 7, v132
    v_cndmask_b32 v147, 0, v254, vcc
    v_add_f32 v66, v66, v147
    buffer_load_dwordx4 v146, s[48:51], 0 offen offset:2048 lds
    s_add_u32 s48, s48, 36864
    s_addc_u32 s49, s49, 0
    s_add_u32 m0, s69, 0
    s_waitcnt lgkmcnt(0)
    v_cmp_ne_u32 vcc, v141, v177
    v_sub_u32 v130, v164, v130
    v_lshrrev_b32 v132, 2, v132
    v_cndmask_b32 v141, 0, v254, vcc
    v_add_f32 v78, v78, v141
    v_lshrrev_b32 v130, 2, v130
    v_and_b32 v132, s5, v132
    v_and_b32 v130, s6, v130
    v_lshl_or_b32 v132, v132, 1, v130
    v_cmp_ne_u32 vcc, v132, v176
    v_lshl_add_u32 v141, v115, 2, 34
    buffer_load_dwordx4 v138, s[48:51], 0 offen lds
    s_waitcnt vmcnt(7)
    ds_read_b64_tr_b16 a[20:21], v133 offset:3072
    ds_read_b64_tr_b16 a[22:23], v133 offset:3840
    ds_read_b64_tr_b16 a[44:45], v133 offset:3104
    ds_read_b64_tr_b16 a[46:47], v133 offset:3872
    ds_read_b64_tr_b16 a[68:69], v133 offset:3136
    ds_read_b64_tr_b16 a[70:71], v133 offset:3904
    v_cndmask_b32 v130, 0, v254, vcc
    v_add_f32 v55, v55, v130
    v_cmp_ne_u32 vcc, v132, v255
    v_mul_u32_u24 v164, 37, v141
    v_lshrrev_b32 v164, 8, v164
    v_cndmask_b32 v130, 0, v254, vcc
    v_add_f32 v67, v67, v130
    v_cmp_ne_u32 vcc, v132, v177
    buffer_load_dwordx4 v140, s[48:51], 0 offen offset:1024 lds
    v_mul_u32_u24 v132, 7, v164
    v_cndmask_b32 v130, 0, v254, vcc
    v_add_f32 v79, v79, v130
    v_sub_u32 v132, v141, v132
    v_lshrrev_b32 v164, 2, v164
    v_lshrrev_b32 v132, 2, v132
    v_and_b32 v164, s5, v164
    v_and_b32 v132, s6, v132
    v_lshl_or_b32 v164, v164, 1, v132
    v_cmp_ne_u32 vcc, v164, v176
    v_lshl_add_u32 v115, v115, 2, 35
    v_mul_u32_u24 v141, 37, v115
    v_cndmask_b32 v130, 0, v254, vcc
    v_add_f32 v56, v56, v130
    v_cmp_ne_u32 vcc, v164, v255
    buffer_load_dwordx4 v146, s[48:51], 0 offen offset:2048 lds
    s_add_u32 s48, s48, 36864
    s_addc_u32 s49, s49, 0
    s_add_u32 m0, s69, 3072
    s_waitcnt lgkmcnt(0)
    v_cndmask_b32 v130, 0, v254, vcc
    v_add_f32 v68, v68, v130
    v_cmp_ne_u32 vcc, v164, v177
    v_lshrrev_b32 v141, 8, v141
    v_mul_u32_u24 v164, 7, v141
    v_cndmask_b32 v130, 0, v254, vcc
    v_add_f32 v80, v80, v130
    v_sub_u32 v164, v115, v164
    v_lshrrev_b32 v141, 2, v141
    v_lshrrev_b32 v164, 2, v164
    buffer_load_dwordx4 v138, s[48:51], 0 offen lds
    s_waitcnt vmcnt(7)
    ds_read_b64_tr_b16 a[144:145], v131 offset:0
    ds_read_b64_tr_b16 a[146:147], v131 offset:768
    ds_read_b64_tr_b16 a[168:169], v131 offset:32
    ds_read_b64_tr_b16 a[170:171], v131 offset:800
    ds_read_b64_tr_b16 a[192:193], v131 offset:64
    ds_read_b64_tr_b16 a[194:195], v131 offset:832
    v_and_b32 v141, s5, v141
    v_and_b32 v164, s6, v164
    v_lshl_or_b32 v141, v141, 1, v164
    v_cmp_ne_u32 vcc, v141, v176
    v_cndmask_b32 v22, v174, v22, s[88:89]
    v_cndmask_b32 v24, v174, v24, s[88:89]
    v_cndmask_b32 v115, 0, v254, vcc
    v_add_f32 v57, v57, v115
    buffer_load_dwordx4 v140, s[48:51], 0 offen offset:1024 lds
    v_cmp_ne_u32 vcc, v141, v255
    v_mov_b32_dpp v23, v25 quad_perm:[0,1,2,3] row_mask:0x2 bank_mask:0xf
    v_cndmask_b32 v26, v174, v26, s[88:89]
    v_cndmask_b32 v115, 0, v254, vcc
    v_add_f32 v69, v69, v115
    v_cmp_ne_u32 vcc, v141, v177
    v_mov_b32_dpp v23, v27 quad_perm:[0,1,2,3] row_mask:0x4 bank_mask:0xf
    v_mov_b32 v134, 0
    v_cndmask_b32 v115, 0, v254, vcc
    v_add_f32 v81, v81, v115
    ds_read_b128 v[126:129], v162 offset:0
    ds_read_b128 v[234:237], v163 offset:0
    ds_read_b128 v[118:121], v162 offset:128
    buffer_load_dwordx4 v146, s[48:51], 0 offen offset:2048 lds
    ds_read_b128 v[142:145], v163 offset:128
    s_add_u32 s48, s48, 36864
    s_addc_u32 s49, s49, 0
    ds_read_b128 v[170:173], v162 offset:256
    s_add_u32 m0, s68, 0
    s_waitcnt lgkmcnt(5)
    ds_read_b128 v[158:161], v163 offset:256
    v_mov_b32 v135, 0
    v_mov_b32 v136, 0
    v_mov_b32 v137, 0
    ds_write_b128 v165, v[134:137] offset:16
    s_waitcnt vmcnt(6)
    buffer_load_dwordx4 v138, s[48:51], 0 offen lds
    s_waitcnt lgkmcnt(6)
    v_mfma_f32_16x16x32_bf16 v[122:125], a[72:75], v[126:129], 0
    s_waitcnt lgkmcnt(5)
    v_mfma_f32_16x16x32_bf16 v[122:125], a[76:79], v[234:237], v[122:125]
    s_waitcnt lgkmcnt(4)
    ds_read_b64_tr_b16 a[148:149], v131 offset:3072
    ds_read_b64_tr_b16 a[150:151], v131 offset:3840
    v_mfma_f32_16x16x32_bf16 v[122:125], a[80:83], v[118:121], v[122:125]
    s_waitcnt lgkmcnt(4)
    ds_read_b64_tr_b16 a[172:173], v131 offset:3104
    ds_read_b64_tr_b16 a[174:175], v131 offset:3872
    v_mfma_f32_16x16x32_bf16 v[122:125], a[84:87], v[142:145], v[122:125]
    s_waitcnt lgkmcnt(5)
    ds_read_b64_tr_b16 a[196:197], v131 offset:3136
    buffer_load_dwordx4 v140, s[48:51], 0 offen offset:1024 lds
    v_mfma_f32_16x16x32_bf16 v[122:125], a[88:91], v[170:173], v[122:125]
    ds_read_b64_tr_b16 a[198:199], v131 offset:3904
    v_mfma_f32_16x16x32_bf16 v[122:125], a[92:95], v[158:161], v[122:125]
    ds_write_b64 v165, v[134:135] offset:56
    v_mfma_f32_16x16x32_bf16 v[150:153], a[96:99], v[126:129], 0
    v_mfma_f32_16x16x32_bf16 v[150:153], a[100:103], v[234:237], v[150:153]
    ds_write_b64 v165, v[134:135] offset:64
    v_mfma_f32_16x16x32_bf16 v[150:153], a[104:107], v[118:121], v[150:153]
    s_waitcnt lgkmcnt(6)
    buffer_load_dwordx4 v146, s[48:51], 0 offen offset:2048 lds
    s_add_u32 s48, s48, 36864
    v_mfma_f32_16x16x32_bf16 v[150:153], a[108:111], v[142:145], v[150:153]
    s_addc_u32 s49, s49, 0
    ds_read_b128 v[182:185], v162 offset:6144
    v_fma_f32 v115, v122, v122, s32
    v_mfma_f32_16x16x32_bf16 v[150:153], a[112:115], v[170:173], v[150:153]
    s_add_u32 m0, s68, 3072
    ds_read_b128 v[206:209], v163 offset:6144
    v_fmac_f32 v115, v123, v123
    v_mfma_f32_16x16x32_bf16 v[150:153], a[116:119], v[158:161], v[150:153]
    s_waitcnt lgkmcnt(4)
    s_waitcnt vmcnt(6)
    ds_read_b64_tr_b16 a[152:153], v133 offset:0
    v_mfma_f32_16x16x32_bf16 v[190:193], a[120:123], v[126:129], 0
    ds_read_b64_tr_b16 a[154:155], v133 offset:768
    ds_read_b64_tr_b16 a[176:177], v133 offset:32
    v_mfma_f32_16x16x32_bf16 v[190:193], a[124:127], v[234:237], v[190:193]
    buffer_load_dwordx4 v138, s[48:51], 0 offen lds
    ds_read_b64_tr_b16 a[178:179], v133 offset:800
    v_mfma_f32_16x16x32_bf16 v[190:193], a[128:131], v[118:121], v[190:193]
    ds_read_b64_tr_b16 a[200:201], v133 offset:64
    ds_read_b64_tr_b16 a[202:203], v133 offset:832
    v_mfma_f32_16x16x32_bf16 v[190:193], a[132:135], v[142:145], v[190:193]
    ds_read_b128 v[198:201], v162 offset:6272
    ds_read_b128 v[194:197], v163 offset:6272
    v_mfma_f32_16x16x32_bf16 v[190:193], a[136:139], v[170:173], v[190:193]
    ds_read_b128 v[202:205], v162 offset:6400
    ds_read_b128 v[210:213], v163 offset:6400
    v_mfma_f32_16x16x32_bf16 v[190:193], a[140:143], v[158:161], v[190:193]
    s_waitcnt lgkmcnt(11)
    v_fmac_f32 v115, v124, v124
    v_fmac_f32 v115, v125, v125
    v_mfma_f32_16x16x32_bf16 v[214:217], a[72:75], v[182:185], 0
    s_waitcnt lgkmcnt(10)
    buffer_load_dwordx4 v140, s[48:51], 0 offen offset:1024 lds
    v_fmac_f32 v115, v150, v150
    v_mfma_f32_16x16x32_bf16 v[214:217], a[76:79], v[206:209], v[214:217]
    s_waitcnt lgkmcnt(9)
    ds_write_b128 v168, v[134:137] offset:16
    v_mfma_f32_16x16x32_bf16 v[218:221], a[96:99], v[182:185], 0
    s_waitcnt lgkmcnt(7)
    v_fmac_f32 v115, v151, v151
    v_fmac_f32 v115, v152, v152
    v_mfma_f32_16x16x32_bf16 v[218:221], a[100:103], v[206:209], v[218:221]
    s_waitcnt lgkmcnt(5)
    v_fmac_f32 v115, v153, v153
    v_fmac_f32 v115, v190, v190
    v_mfma_f32_16x16x32_bf16 v[222:225], a[120:123], v[182:185], 0
    s_waitcnt lgkmcnt(3)
    buffer_load_dwordx4 v146, s[48:51], 0 offen offset:2048 lds
    v_fmac_f32 v115, v191, v191
    v_mfma_f32_16x16x32_bf16 v[214:217], a[80:83], v[198:201], v[214:217]
    s_add_u32 m0, s28, 8192
    ds_write_b64 v168, v[134:135] offset:56
    s_waitcnt vmcnt(6)
    v_mfma_f32_16x16x32_bf16 v[214:217], a[84:87], v[194:197], v[214:217]
    s_waitcnt lgkmcnt(2)
    v_fmac_f32 v115, v192, v192
    v_fmac_f32 v115, v193, v193
    v_mfma_f32_16x16x32_bf16 v[214:217], a[88:91], v[202:205], v[214:217]
    ds_read_b64_tr_b16 a[156:157], v133 offset:3072
    ds_read_b64_tr_b16 a[158:159], v133 offset:3840
    v_mfma_f32_16x16x32_bf16 v[214:217], a[92:95], v[210:213], v[214:217]
    buffer_load_dwordx4 v12, s[8:11], s25 offen nt lds
    v_mfma_f32_16x16x32_bf16 v[218:221], a[104:107], v[198:201], v[218:221]
    s_add_u32 m0, s28, 12288
    ds_read_b64_tr_b16 a[180:181], v133 offset:3104
    ds_read_b64_tr_b16 a[182:183], v133 offset:3872
    v_mfma_f32_16x16x32_bf16 v[218:221], a[108:111], v[194:197], v[218:221]
    ds_read_b64_tr_b16 a[204:205], v133 offset:3136
    ds_read_b64_tr_b16 a[206:207], v133 offset:3904
    v_mfma_f32_16x16x32_bf16 v[218:221], a[112:115], v[202:205], v[218:221]
    ds_write_b64 v168, v[134:135] offset:64
    v_mfma_f32_16x16x32_bf16 v[218:221], a[116:119], v[210:213], v[218:221]
    v_fma_f32 v164, v214, v214, s32
    v_fmac_f32 v164, v215, v215
    v_mfma_f32_16x16x32_bf16 v[222:225], a[124:127], v[206:209], v[222:225]
    buffer_load_dwordx4 v13, s[8:11], s25 offen nt lds
    v_mfma_f32_16x16x32_bf16 v[222:225], a[128:131], v[198:201], v[222:225]
    s_add_u32 m0, s29, 0
    v_fmac_f32 v164, v216, v216
    v_fmac_f32 v164, v217, v217
    v_mfma_f32_16x16x32_bf16 v[222:225], a[132:135], v[194:197], v[222:225]
    s_waitcnt lgkmcnt(5)
    v_fmac_f32 v164, v218, v218
    v_fmac_f32 v164, v219, v219
    v_mfma_f32_16x16x32_bf16 v[222:225], a[136:139], v[202:205], v[222:225]
    s_waitcnt lgkmcnt(4)
    v_fmac_f32 v164, v220, v220
    v_fmac_f32 v164, v221, v221
    v_mfma_f32_16x16x32_bf16 v[222:225], a[140:143], v[210:213], v[222:225]
    s_waitcnt lgkmcnt(2)
    v_mfma_f32_16x16x32_bf16 v[146:149], a[0:3], v[126:129], 0
    s_waitcnt lgkmcnt(0)
    buffer_load_dwordx4 v14, s[8:11], s25 offen nt lds
    v_mfma_f32_16x16x32_bf16 v[146:149], a[4:7], v[234:237], v[146:149]
    s_add_u32 m0, s69, 0
    s_lshr_b32 s10, s17, 1
    s_cselect_b32 s10, s36, 0
    v_mfma_f32_16x16x32_bf16 v[146:149], a[8:11], v[118:121], v[146:149]
    s_waitcnt vmcnt(6)
    ds_read_b64_tr_b16 a[160:161], v131 offset:0
    ds_read_b64_tr_b16 a[162:163], v131 offset:768
    v_mfma_f32_16x16x32_bf16 v[146:149], a[12:15], v[142:145], v[146:149]
    s_mov_b32 s25, s24
    ds_read_b64_tr_b16 a[184:185], v131 offset:32
    ds_read_b64_tr_b16 a[186:187], v131 offset:800
    v_mfma_f32_16x16x32_bf16 v[146:149], a[16:19], v[170:173], v[146:149]
    ds_read_b64_tr_b16 a[208:209], v131 offset:64
    ds_read_b64_tr_b16 a[210:211], v131 offset:832
    v_mfma_f32_16x16x32_bf16 v[146:149], a[20:23], v[158:161], v[146:149]
    buffer_load_dwordx4 v180, s[52:55], 0 offen lds
    v_fmac_f32 v164, v222, v222
    v_mfma_f32_16x16x32_bf16 v[226:229], a[24:27], v[126:129], 0
    v_fmac_f32 v164, v223, v223
    v_fmac_f32 v164, v224, v224
    v_mfma_f32_16x16x32_bf16 v[226:229], a[28:31], v[234:237], v[226:229]
    v_fmac_f32 v164, v225, v225
    v_xor_b32 v254, 65536, v2
    v_mfma_f32_16x16x32_bf16 v[226:229], a[32:35], v[118:121], v[226:229]
    v_fma_f32 v176, v146, v146, s32
    v_fmac_f32 v176, v147, v147
    v_mfma_f32_16x16x32_bf16 v[226:229], a[36:39], v[142:145], v[226:229]
    v_fmac_f32 v176, v148, v148
    v_fmac_f32 v176, v149, v149
    v_mfma_f32_16x16x32_bf16 v[226:229], a[40:43], v[170:173], v[226:229]
    s_waitcnt lgkmcnt(4)
    buffer_load_dwordx4 v181, s[52:55], 0 offen offset:1024 lds
    v_lshrrev_b32 v154, 2, v254
    v_mfma_f32_16x16x32_bf16 v[226:229], a[44:47], v[158:161], v[226:229]
    s_waitcnt lgkmcnt(2)
    v_lshrrev_b32 v177, 8, v254
    v_lshl_add_u32 v255, s16, 2, v254
    v_mfma_f32_16x16x32_bf16 v[230:233], a[48:51], v[126:129], 0
    s_waitcnt lgkmcnt(0)
    v_add_u32 v154, 62784, v154
    v_lshlrev_b32 v177, 4, v177
    v_mfma_f32_16x16x32_bf16 v[230:233], a[52:55], v[234:237], v[230:233]
    v_fmac_f32 v176, v226, v226
    v_fmac_f32 v176, v227, v227
    v_mfma_f32_16x16x32_bf16 v[230:233], a[56:59], v[118:121], v[230:233]
    v_fmac_f32 v176, v228, v228
    v_fmac_f32 v176, v229, v229
    v_mfma_f32_16x16x32_bf16 v[230:233], a[60:63], v[142:145], v[230:233]
    buffer_load_dwordx4 v139, s[52:55], 0 offen offset:2048 lds
    v_add_u32 v177, 62784, v177
    v_mfma_f32_16x16x32_bf16 v[230:233], a[64:67], v[170:173], v[230:233]
    s_add_u32 s52, s52, 12288
    v_or_b32 v238, v32, v33
    v_and_b32 v238, 0xffff, v238
    s_waitcnt vmcnt(6)
    v_mfma_f32_16x16x32_bf16 v[230:233], a[68:71], v[158:161], v[230:233]
    s_addc_u32 s53, s53, 0
    ds_read_b64_tr_b16 a[164:165], v131 offset:3072
    ds_read_b64_tr_b16 a[166:167], v131 offset:3840
    v_mfma_f32_16x16x32_bf16 v[142:145], a[0:3], v[182:185], 0
    s_add_u32 m0, s69, 3072
    ds_read_b64_tr_b16 a[188:189], v131 offset:3104
    ds_read_b64_tr_b16 a[190:191], v131 offset:3872
    v_mfma_f32_16x16x32_bf16 v[142:145], a[4:7], v[206:209], v[142:145]
    ds_read_b64_tr_b16 a[212:213], v131 offset:3136
    buffer_load_dwordx4 v180, s[52:55], 0 offen lds
    v_mfma_f32_16x16x32_bf16 v[142:145], a[8:11], v[198:201], v[142:145]
    ds_read_b64_tr_b16 a[214:215], v131 offset:3904
    v_fmac_f32 v176, v230, v230
    v_mfma_f32_16x16x32_bf16 v[142:145], a[12:15], v[194:197], v[142:145]
    v_fmac_f32 v176, v231, v231
    v_fmac_f32 v176, v232, v232
    v_mfma_f32_16x16x32_bf16 v[142:145], a[16:19], v[202:205], v[142:145]
    v_fmac_f32 v176, v233, v233
    v_cvt_pk_bf16_f32 v36, v176, v115
    v_mfma_f32_16x16x32_bf16 v[142:145], a[20:23], v[210:213], v[142:145]
    v_lshl_or_b32 v238, v238, 16, v238
    v_or_b32 v239, v32, v33
    v_mfma_f32_16x16x32_bf16 v[242:245], v[32:35], v[36:39], 0
    buffer_load_dwordx4 v181, s[52:55], 0 offen offset:1024 lds
    v_and_b32 v239, 0xffff, v239
    v_mfma_f32_16x16x32_bf16 v[246:249], a[24:27], v[182:185], 0
    s_waitcnt lgkmcnt(4)
    v_lshl_or_b32 v239, v239, 16, v239
    v_or_b32 v240, v32, v33
    v_mfma_f32_16x16x32_bf16 v[246:249], a[28:31], v[206:209], v[246:249]
    s_waitcnt lgkmcnt(2)
    v_rsq_f32 v243, v243
    v_mfma_f32_16x16x32_bf16 v[246:249], a[32:35], v[198:201], v[246:249]
    s_waitcnt lgkmcnt(1)
    v_rsq_f32 v242, v242
    v_mfma_f32_16x16x32_bf16 v[246:249], a[36:39], v[194:197], v[246:249]
    s_waitcnt lgkmcnt(0)
    ds_read_b128 v[186:189], v0 offset:20480
    v_mul_f32 v242, s31, v242
    v_mfma_f32_16x16x32_bf16 v[246:249], a[40:43], v[202:205], v[246:249]
    buffer_load_dwordx4 v139, s[52:55], 0 offen offset:2048 lds
    ds_read_b128 v[118:121], v1 offset:20480
    v_mfma_f32_16x16x32_bf16 v[246:249], a[44:47], v[210:213], v[246:249]
    s_add_u32 s52, s52, 12288
    ds_read_b128 v[234:237], v0 offset:20608
    v_mul_f32 v122, v243, v122
    v_mfma_f32_16x16x32_bf16 v[250:253], a[48:51], v[182:185], 0
    s_addc_u32 s53, s53, 0
    ds_read_b128 v[158:161], v1 offset:20608
    v_mul_f32 v123, v243, v123
    v_mfma_f32_16x16x32_bf16 v[250:253], a[52:55], v[206:209], v[250:253]
    s_add_u32 m0, s68, 0
    ds_read_b128 v[182:185], v0 offset:20736
    v_cvt_pk_f16_f32 v130, v122, v123
    v_mfma_f32_16x16x32_bf16 v[250:253], a[56:59], v[198:201], v[250:253]
    ds_read_b128 v[206:209], v1 offset:20736
    v_mul_f32 v124, v243, v124
    v_mfma_f32_16x16x32_bf16 v[250:253], a[60:63], v[194:197], v[250:253]
    buffer_load_dwordx4 v180, s[52:55], 0 offen lds
    v_mul_f32 v125, v243, v125
    v_mfma_f32_16x16x32_bf16 v[250:253], a[64:67], v[202:205], v[250:253]
    v_cvt_pk_f16_f32 v131, v124, v125
    v_mul_f32 v150, v243, v150
    v_mfma_f32_16x16x32_bf16 v[250:253], a[68:71], v[210:213], v[250:253]
    s_waitcnt lgkmcnt(5)
    v_mul_f32 v151, v243, v151
    v_cvt_pk_f16_f32 v132, v150, v151
    v_mfma_f32_16x16x32_bf16 v[134:137], a[96:99], v[186:189], 0
    s_waitcnt lgkmcnt(4)
    v_mul_f32 v152, v243, v152
    v_mul_f32 v153, v243, v153
    v_mfma_f32_16x16x32_bf16 v[134:137], a[100:103], v[118:121], v[134:137]
    s_waitcnt lgkmcnt(3)
    v_cvt_pk_f16_f32 v133, v152, v153
    v_mul_f32 v190, v243, v190
    v_mfma_f32_16x16x32_bf16 v[134:137], a[104:107], v[234:237], v[134:137]
    s_waitcnt lgkmcnt(2)
    ds_write_b128 v165, v[130:133]
    v_mfma_f32_16x16x32_bf16 v[134:137], a[108:111], v[158:161], v[134:137]
    s_waitcnt lgkmcnt(1)
    v_mul_f32 v191, v243, v191
    v_cvt_pk_f16_f32 v212, v190, v191
    v_mfma_f32_16x16x32_bf16 v[134:137], a[112:115], v[182:185], v[134:137]
    v_mul_f32 v192, v243, v192
    v_mul_f32 v193, v243, v193
    v_mfma_f32_16x16x32_bf16 v[134:137], a[116:119], v[206:209], v[134:137]
    v_cvt_pk_f16_f32 v213, v192, v193
    v_mul_f32 v146, v242, v146
    v_mfma_f32_16x16x32_bf16 v[170:173], a[120:123], v[186:189], 0
    ds_write_b64 v165, v[212:213] offset:48
    v_mfma_f32_16x16x32_bf16 v[170:173], a[124:127], v[118:121], v[170:173]
    v_mul_f32 v147, v242, v147
    v_cvt_pk_f16_f32 v130, v146, v147
    v_mfma_f32_16x16x32_bf16 v[170:173], a[128:131], v[234:237], v[170:173]
    v_mul_f32 v148, v242, v148
    v_mul_f32 v149, v242, v149
    v_mfma_f32_16x16x32_bf16 v[170:173], a[132:135], v[158:161], v[170:173]
    v_cvt_pk_f16_f32 v131, v148, v149
    v_mul_f32 v226, v242, v226
    v_mfma_f32_16x16x32_bf16 v[170:173], a[136:139], v[182:185], v[170:173]
    v_mul_f32 v227, v242, v227
    v_cvt_pk_f16_f32 v132, v226, v227
    v_mfma_f32_16x16x32_bf16 v[170:173], a[140:143], v[206:209], v[170:173]
    v_mul_f32 v228, v242, v228
    v_mul_f32 v229, v242, v229
    v_mfma_f32_16x16x32_bf16 v[126:129], a[24:27], v[186:189], 0
    v_cvt_pk_f16_f32 v133, v228, v229
    v_mul_f32 v230, v242, v230
    v_mfma_f32_16x16x32_bf16 v[126:129], a[28:31], v[118:121], v[126:129]
    ds_write_b128 v165, v[130:133] offset:32
    v_mfma_f32_16x16x32_bf16 v[130:133], a[72:75], v[186:189], 0
    v_mul_f32 v231, v242, v231
    v_cvt_pk_f16_f32 v210, v230, v231
    v_mfma_f32_16x16x32_bf16 v[130:133], a[76:79], v[118:121], v[130:133]
    v_mul_f32 v232, v242, v232
    v_mul_f32 v233, v242, v233
    v_mfma_f32_16x16x32_bf16 v[130:133], a[80:83], v[234:237], v[130:133]
    v_cvt_pk_f16_f32 v211, v232, v233
    v_mul_f32 v146, v146, v122
    v_mfma_f32_16x16x32_bf16 v[130:133], a[84:87], v[158:161], v[130:133]
    ds_write_b64 v165, v[210:211] offset:72
    v_mfma_f32_16x16x32_bf16 v[130:133], a[88:91], v[182:185], v[130:133]
    v_fmac_f32 v146, v147, v123
    v_fmac_f32 v146, v148, v124
    v_mfma_f32_16x16x32_bf16 v[130:133], a[92:95], v[206:209], v[130:133]
    v_fmac_f32 v146, v149, v125
    v_fmac_f32 v146, v226, v150
    v_mfma_f32_16x16x32_bf16 v[126:129], a[32:35], v[234:237], v[126:129]
    v_fmac_f32 v146, v227, v151
    v_fmac_f32 v146, v228, v152
    v_mfma_f32_16x16x32_bf16 v[126:129], a[36:39], v[158:161], v[126:129]
    v_fmac_f32 v146, v229, v153
    v_fmac_f32 v146, v230, v190
    v_mfma_f32_16x16x32_bf16 v[126:129], a[40:43], v[182:185], v[126:129]
    v_fmac_f32 v146, v231, v191
    v_fmac_f32 v146, v232, v192
    v_mfma_f32_16x16x32_bf16 v[126:129], a[44:47], v[206:209], v[126:129]
    v_fmac_f32 v146, v233, v193
    v_mov_b32 v115, v146
    v_mfma_f32_16x16x32_bf16 v[122:125], a[48:51], v[186:189], 0
    v_lshrrev_b32 v240, 16, v240
    v_lshl_or_b32 v240, v240, 16, v240
    v_mfma_f32_16x16x32_bf16 v[122:125], a[52:55], v[118:121], v[122:125]
    v_permlane32_swap_b32 v146, v115
    v_mfma_f32_16x16x32_bf16 v[122:125], a[56:59], v[234:237], v[122:125]
    v_add_f32 v146, v146, v115
    v_mov_b32 v115, v146
    v_mfma_f32_16x16x32_bf16 v[122:125], a[60:63], v[158:161], v[122:125]
    v_or_b32 v241, v32, v33
    v_lshrrev_b32 v241, 16, v241
    v_mfma_f32_16x16x32_bf16 v[122:125], a[64:67], v[182:185], v[122:125]
    v_permlane16_swap_b32 v146, v115
    v_mfma_f32_16x16x32_bf16 v[122:125], a[68:71], v[206:209], v[122:125]
    v_add_f32 v146, v146, v115
    v_add_f32 v146, s39, v146
    v_mfma_f32_16x16x32_bf16 v[150:153], v[186:189], a[144:147], 0
    v_mov_b32 v147, v174
    v_mov_b32 v148, v174
    v_mfma_f32_16x16x32_bf16 v[150:153], v[118:121], a[148:151], v[150:153]
    v_mov_b32 v149, v174
    v_cndmask_b32 v146, v174, v146, s[88:89]
    v_mfma_f32_16x16x32_bf16 v[150:153], v[234:237], a[152:155], v[150:153]
    ds_write_b128 v166, v[146:149] offset:192
    v_mfma_f32_16x16x32_bf16 v[150:153], v[158:161], a[156:159], v[150:153]
    v_lshl_or_b32 v241, v241, 16, v241
    v_fma_f32 v115, v142, v142, s32
    v_mfma_f32_16x16x32_bf16 v[150:153], v[182:185], a[160:163], v[150:153]
    v_fmac_f32 v115, v143, v143
    v_fmac_f32 v115, v144, v144
    v_mfma_f32_16x16x32_bf16 v[150:153], v[206:209], a[164:167], v[150:153]
    v_fmac_f32 v115, v145, v145
    v_fmac_f32 v115, v246, v246
    v_mfma_f32_16x16x32_bf16 v[146:149], v[186:189], a[168:171], 0
    v_fmac_f32 v115, v247, v247
    v_fmac_f32 v115, v248, v248
    v_mfma_f32_16x16x32_bf16 v[146:149], v[118:121], a[172:175], v[146:149]
    v_fmac_f32 v115, v249, v249
    v_fmac_f32 v115, v250, v250
    v_mfma_f32_16x16x32_bf16 v[146:149], v[234:237], a[176:179], v[146:149]
    v_fmac_f32 v115, v251, v251
    v_fmac_f32 v115, v252, v252
    v_mfma_f32_16x16x32_bf16 v[146:149], v[158:161], a[180:183], v[146:149]
    ds_read_b128 v[190:193], v162 offset:0
    v_fmac_f32 v115, v253, v253
    v_mfma_f32_16x16x32_bf16 v[146:149], v[182:185], a[184:187], v[146:149]
    ds_read_b128 v[210:213], v163 offset:0
    v_cvt_pk_bf16_f32 v36, v115, v164
    v_mfma_f32_16x16x32_bf16 v[146:149], v[206:209], a[188:191], v[146:149]
    ds_read_b128 v[202:205], v162 offset:128
    v_fma_f32 v115, v130, v130, s32
    v_fmac_f32 v115, v131, v131
    v_fmac_f32 v115, v132, v132
    v_fmac_f32 v115, v133, v133
    v_fmac_f32 v115, v134, v134
    v_fmac_f32 v115, v135, v135
    v_fmac_f32 v115, v136, v136
    v_fmac_f32 v115, v137, v137
    v_fmac_f32 v115, v170, v170
    v_fmac_f32 v115, v171, v171
    v_fmac_f32 v115, v172, v172
    v_fmac_f32 v115, v173, v173
    v_cvt_pk_bf16_f32 v150, v150, v151
    v_mfma_f32_16x16x32_bf16 v[194:197], v[32:35], v[36:39], 0
    v_cvt_pk_bf16_f32 v151, v152, v153
    v_cvt_pk_bf16_f32 v146, v146, v147
    v_mfma_f32_16x16x32_bf16 v[198:201], v[186:189], a[192:195], 0
    v_cvt_pk_bf16_f32 v147, v148, v149
    v_xor_b32 v2, 65536, v2
    v_mfma_f32_16x16x32_bf16 v[198:201], v[118:121], a[196:199], v[198:201]
    s_waitcnt lgkmcnt(2)
    v_mfma_f32_16x16x32_bf16 v[198:201], v[234:237], a[200:203], v[198:201]
    s_waitcnt lgkmcnt(1)
    v_rsq_f32 v195, v195
    v_mfma_f32_16x16x32_bf16 v[198:201], v[158:161], a[204:207], v[198:201]
    s_waitcnt lgkmcnt(0)
    v_rsq_f32 v194, v194
    v_mfma_f32_16x16x32_bf16 v[198:201], v[182:185], a[208:211], v[198:201]
    v_mul_f32 v194, s31, v194
    v_mul_f32 v214, v195, v214
    v_mfma_f32_16x16x32_bf16 v[198:201], v[206:209], a[212:215], v[198:201]
    v_mul_f32 v215, v195, v215
    v_cvt_pk_f16_f32 v226, v214, v215
    v_mul_f32 v216, v195, v216
    v_mul_f32 v217, v195, v217
    v_cvt_pk_f16_f32 v227, v216, v217
    v_mul_f32 v218, v195, v218
    v_mul_f32 v219, v195, v219
    v_cvt_pk_f16_f32 v228, v218, v219
    v_mul_f32 v220, v195, v220
    v_mul_f32 v221, v195, v221
    v_cvt_pk_f16_f32 v229, v220, v221
    v_mul_f32 v222, v195, v222
    v_mul_f32 v223, v195, v223
    v_cvt_pk_f16_f32 v244, v222, v223
    v_mul_f32 v224, v195, v224
    v_mul_f32 v225, v195, v225
    v_cvt_pk_f16_f32 v245, v224, v225
    v_mul_f32 v142, v194, v142
    v_mul_f32 v143, v194, v143
    v_cvt_pk_f16_f32 v230, v142, v143
    v_mul_f32 v144, v194, v144
    v_mul_f32 v145, v194, v145
    v_cvt_pk_f16_f32 v231, v144, v145
    v_mul_f32 v246, v194, v246
    v_mul_f32 v247, v194, v247
    v_cvt_pk_f16_f32 v232, v246, v247
    v_mul_f32 v248, v194, v248
    v_mul_f32 v249, v194, v249
    v_cvt_pk_f16_f32 v233, v248, v249
    v_mul_f32 v250, v194, v250
    v_mul_f32 v251, v194, v251
    v_cvt_pk_f16_f32 v242, v250, v251
    v_mul_f32 v252, v194, v252
    v_mul_f32 v253, v194, v253
    v_cvt_pk_f16_f32 v243, v252, v253
    v_mul_f32 v214, v142, v214
    v_fmac_f32 v214, v143, v215
    v_fmac_f32 v214, v144, v216
    v_fmac_f32 v214, v145, v217
    v_fmac_f32 v214, v246, v218
    v_fmac_f32 v214, v247, v219
    v_fmac_f32 v214, v248, v220
    v_mfma_f32_16x16x32_bf16 v[194:197], v[190:193], a[144:147], 0
    ds_write_b128 v168, v[226:229]
    v_mfma_f32_16x16x32_bf16 v[142:145], a[0:3], v[186:189], 0
    buffer_load_dwordx4 v181, s[52:55], 0 offen offset:1024 lds
    v_fmac_f32 v214, v249, v221
    v_mfma_f32_16x16x32_bf16 v[142:145], a[4:7], v[118:121], v[142:145]
    v_fmac_f32 v214, v250, v222
    v_fmac_f32 v214, v251, v223
    v_mfma_f32_16x16x32_bf16 v[142:145], a[8:11], v[234:237], v[142:145]
    ds_read_b128 v[118:121], v163 offset:128
    ds_read_b128 v[234:237], v162 offset:256
    v_mfma_f32_16x16x32_bf16 v[142:145], a[12:15], v[158:161], v[142:145]
    ds_read_b128 v[158:161], v163 offset:256
    v_fmac_f32 v214, v252, v224
    v_mfma_f32_16x16x32_bf16 v[142:145], a[16:19], v[182:185], v[142:145]
    ds_write_b64 v168, v[244:245] offset:48
    v_mfma_f32_16x16x32_bf16 v[142:145], a[20:23], v[206:209], v[142:145]
    buffer_load_dwordx4 v139, s[52:55], 0 offen offset:2048 lds
    v_fmac_f32 v214, v253, v225
    v_mfma_f32_16x16x32_bf16 v[194:197], v[210:213], a[148:151], v[194:197]
    s_add_u32 s52, s52, 12288
    ds_write_b128 v168, v[230:233] offset:32
    v_mfma_f32_16x16x32_bf16 v[194:197], v[202:205], a[152:155], v[194:197]
    s_addc_u32 s53, s53, 0
    v_mov_b32 v176, v214
    v_fma_f32 v148, v142, v142, s32
    v_mfma_f32_16x16x32_bf16 v[182:185], v[190:193], a[168:171], 0
    s_add_u32 m0, s68, 3072
    v_permlane32_swap_b32 v214, v176
    v_mfma_f32_16x16x32_bf16 v[182:185], v[210:213], a[172:175], v[182:185]
    s_waitcnt lgkmcnt(3)
    buffer_load_dwordx4 v180, s[52:55], 0 offen lds
    v_add_f32 v214, v214, v176
    v_mfma_f32_16x16x32_bf16 v[194:197], v[118:121], a[156:159], v[194:197]
    s_mul_i32 s68, s78, 72
    ds_write_b64 v168, v[242:243] offset:72
    v_mfma_f32_16x16x32_bf16 v[194:197], v[234:237], a[160:163], v[194:197]
    s_waitcnt lgkmcnt(2)
    v_mov_b32 v176, v214
    v_fmac_f32 v148, v143, v143
    v_mfma_f32_16x16x32_bf16 v[194:197], v[158:161], a[164:167], v[194:197]
    s_sub_u32 s68, s77, s68
    v_permlane16_swap_b32 v214, v176
    v_mfma_f32_16x16x32_bf16 v[182:185], v[202:205], a[176:179], v[182:185]
    s_mul_i32 s78, s78, 1373568
    v_add_f32 v214, v214, v176
    v_add_f32 v214, s39, v214
    v_mfma_f32_16x16x32_bf16 v[182:185], v[118:121], a[180:183], v[182:185]
    buffer_load_dwordx4 v181, s[52:55], 0 offen offset:1024 lds
    ds_read_b128 v[206:209], v162 offset:6144
    v_mfma_f32_16x16x32_bf16 v[182:185], v[234:237], a[184:187], v[182:185]
    s_mul_i32 s77, s68, 2688
    ds_read_b128 v[186:189], v163 offset:6144
    v_mov_b32 v215, v174
    v_mfma_f32_16x16x32_bf16 v[182:185], v[158:161], a[188:191], v[182:185]
    s_add_u32 s77, s77, s78
    ds_read_b128 v[222:225], v162 offset:6272
    v_mov_b32 v216, v174
    v_mfma_f32_16x16x32_bf16 v[218:221], v[190:193], a[192:195], 0
    ds_read_b128 v[246:249], v163 offset:6272
    v_mov_b32 v217, v174
    v_mfma_f32_16x16x32_bf16 v[218:221], v[210:213], a[196:199], v[218:221]
    ds_read_b128 v[190:193], v162 offset:6400
    v_cndmask_b32 v214, v174, v214, s[88:89]
    v_mfma_f32_16x16x32_bf16 v[218:221], v[202:205], a[200:203], v[218:221]
    buffer_load_dwordx4 v139, s[52:55], 0 offen offset:2048 lds
    ds_read_b128 v[210:213], v163 offset:6400
    v_mfma_f32_16x16x32_bf16 v[218:221], v[118:121], a[204:207], v[218:221]
    s_add_u32 s52, s52, 12288
    ds_write_b128 v169, v[214:217] offset:192
    s_waitcnt vmcnt(9)
    v_mfma_f32_16x16x32_bf16 v[218:221], v[234:237], a[208:211], v[218:221]
    s_waitcnt lgkmcnt(6)
    v_fmac_f32 v148, v144, v144
    v_fmac_f32 v148, v145, v145
    v_mfma_f32_16x16x32_bf16 v[218:221], v[158:161], a[212:215], v[218:221]
    s_addc_u32 s53, s53, 0
    v_fmac_f32 v148, v126, v126
    v_fmac_f32 v148, v127, v127
    v_mfma_f32_16x16x32_bf16 v[162:165], v[206:209], a[144:147], 0
    s_waitcnt lgkmcnt(4)
    ds_read_b64 a[216:217], v116 offset:0
    ds_read_b64 a[218:219], v116 offset:1536
    v_mfma_f32_16x16x32_bf16 v[162:165], v[186:189], a[148:151], v[162:165]
    s_add_u32 m0, s69, 0
    ds_read_b64 a[240:241], v116 offset:8
    ds_read_b64 a[242:243], v116 offset:1544
    v_mfma_f32_16x16x32_bf16 v[162:165], v[222:225], a[152:155], v[162:165]
    s_waitcnt lgkmcnt(6)
    ds_read_b64 v[90:91], v117 offset:0
    ds_read_b64 v[92:93], v117 offset:1536
    v_mfma_f32_16x16x32_bf16 v[162:165], v[246:249], a[156:159], v[162:165]
    s_waitcnt lgkmcnt(7)
    v_fmac_f32 v148, v128, v128
    v_fmac_f32 v148, v129, v129
    v_mfma_f32_16x16x32_bf16 v[162:165], v[190:193], a[160:163], v[162:165]
    v_fmac_f32 v148, v122, v122
    v_fmac_f32 v148, v123, v123
    v_mfma_f32_16x16x32_bf16 v[162:165], v[210:213], a[164:167], v[162:165]
    v_fmac_f32 v148, v124, v124
    v_fmac_f32 v148, v125, v125
    v_mfma_f32_16x16x32_bf16 v[118:121], v[206:209], a[168:171], 0
    v_cvt_pk_bf16_f32 v36, v148, v115
    v_cvt_pk_bf16_f32 v214, v198, v199
    v_mfma_f32_16x16x32_bf16 v[118:121], v[186:189], a[172:175], v[118:121]
    v_cvt_pk_bf16_f32 v215, v200, v201
    v_cvt_pk_bf16_f32 v194, v194, v194
    v_mfma_f32_16x16x32_bf16 v[158:161], v[32:35], v[36:39], 0
    s_waitcnt lgkmcnt(4)
    v_cvt_pk_bf16_f32 v195, v195, v195
    v_cvt_pk_bf16_f32 v196, v196, v196
    v_mfma_f32_16x16x32_bf16 v[234:237], v[238:241], a[216:219], 0
    s_waitcnt lgkmcnt(2)
    s_waitcnt vmcnt(6)
    ds_read_b64 a[232:233], v116 offset:3072
    v_mfma_f32_16x16x32_bf16 v[234:237], v[238:241], a[240:243], v[234:237]
    s_waitcnt lgkmcnt(1)
    buffer_load_dwordx4 v180, s[52:55], 0 offen lds
    ds_read_b64 a[220:221], v116 offset:4608
    v_mfma_f32_16x16x32_bf16 v[234:237], v[238:241], v[90:93], v[234:237]
    ds_read_b64 v[82:83], v116 offset:3080
    ds_read_b64 a[244:245], v116 offset:4616
    v_mfma_f32_16x16x32_bf16 v[118:121], v[222:225], a[176:179], v[118:121]
    ds_read_b64 v[106:107], v117 offset:3072
    ds_read_b64 v[94:95], v117 offset:4608
    v_mfma_f32_16x16x32_bf16 v[118:121], v[246:249], a[180:183], v[118:121]
    ds_write2_b32 v167, v194, v195 offset0:0 offset1:68
    v_mfma_f32_16x16x32_bf16 v[118:121], v[190:193], a[184:187], v[118:121]
    v_mov_b32 v115, v234
    v_mov_b32_dpp v115, v235 quad_perm:[0,1,2,3] row_mask:0x2 bank_mask:0xf
    v_mfma_f32_16x16x32_bf16 v[118:121], v[210:213], a[188:191], v[118:121]
    buffer_load_dwordx4 v181, s[52:55], 0 offen offset:1024 lds
    v_cvt_pk_bf16_f32 v197, v197, v197
    v_mfma_f32_16x16x32_bf16 v[234:237], v[206:209], a[192:195], 0
    ds_write2_b32 v167, v196, v197 offset0:136 offset1:204
    v_mfma_f32_16x16x32_bf16 v[234:237], v[186:189], a[196:199], v[234:237]
    s_waitcnt lgkmcnt(6)
    v_rsq_f32 v159, v159
    v_mfma_f32_16x16x32_bf16 v[234:237], v[222:225], a[200:203], v[234:237]
    s_waitcnt lgkmcnt(4)
    v_rsq_f32 v158, v158
    v_mfma_f32_16x16x32_bf16 v[234:237], v[246:249], a[204:207], v[234:237]
    s_waitcnt lgkmcnt(2)
    v_mul_f32 v158, s31, v158
    v_mul_f32 v130, v159, v130
    v_mfma_f32_16x16x32_bf16 v[234:237], v[190:193], a[208:211], v[234:237]
    buffer_load_dwordx4 v139, s[52:55], 0 offen offset:2048 lds
    v_mul_f32 v131, v159, v131
    v_mfma_f32_16x16x32_bf16 v[234:237], v[210:213], a[212:215], v[234:237]
    s_barrier
    s_barrier
    s_waitcnt vmcnt(6)
    ds_read_b64 a[222:223], v155 offset:0
    ds_read_b64 a[234:235], v155 offset:1536
    ds_read_b64 a[246:247], v155 offset:8
    ds_read_b64 v[84:85], v155 offset:1544
    ds_read_b64 v[96:97], v114 offset:0
    ds_read_b64 v[108:109], v114 offset:1536
    ds_read_b128 v[206:209], v0 offset:26624
    s_add_u32 s52, s52, 12288
    s_addc_u32 s53, s53, 0
    ds_read_b128 v[186:189], v1 offset:26624
    s_add_u32 m0, s69, 3072
    s_add_u32 s69, s77, 589824
    buffer_load_dwordx4 v180, s[52:55], 0 offen lds
    ds_read_b128 v[210:213], v0 offset:26752
    ds_read_b128 v[190:193], v1 offset:26752
    ds_read_b128 v[222:225], v0 offset:26880
    ds_read_b128 v[194:197], v1 offset:26880
    v_cvt_pk_f16_f32 v130, v130, v131
    v_mul_f32 v132, v159, v132
    s_waitcnt lgkmcnt(11)
    v_mfma_f32_16x16x32_bf16 v[198:201], v[238:241], a[220:223], 0
    s_waitcnt lgkmcnt(9)
    buffer_load_dwordx4 v181, s[52:55], 0 offen offset:1024 lds
    v_mul_f32 v133, v159, v133
    v_mfma_f32_16x16x32_bf16 v[198:201], v[238:241], a[244:247], v[198:201]
    s_waitcnt lgkmcnt(5)
    v_cvt_pk_f16_f32 v131, v132, v133
    v_mul_f32 v134, v159, v134
    v_mfma_f32_16x16x32_bf16 v[198:201], v[238:241], v[94:97], v[198:201]
    s_waitcnt lgkmcnt(4)
    v_mul_f32 v135, v159, v135
    v_cvt_pk_f16_f32 v132, v134, v135
    v_mfma_f32_16x16x32_bf16 v[202:205], v[238:241], a[232:235], 0
    s_waitcnt lgkmcnt(3)
    v_mul_f32 v136, v159, v136
    v_mul_f32 v137, v159, v137
    v_mfma_f32_16x16x32_bf16 v[202:205], v[238:241], v[82:85], v[202:205]
    s_waitcnt lgkmcnt(2)
    v_mov_b32 v148, v199
    v_cvt_pk_f16_f32 v133, v136, v137
    v_mfma_f32_16x16x32_bf16 v[202:205], v[238:241], v[106:109], v[202:205]
    s_waitcnt vmcnt(5)
    buffer_load_dwordx4 v139, s[52:55], 0 offen offset:2048 lds
    ds_read_b64 a[224:225], v155 offset:3072
    v_mfma_f32_16x16x32_bf16 v[138:141], a[72:75], v[206:209], 0
    s_add_u32 m0, s28, 65536
    ds_read_b64 a[226:227], v155 offset:4608
    ds_read_b64 a[248:249], v155 offset:3080
    v_mfma_f32_16x16x32_bf16 v[138:141], a[76:79], v[186:189], v[138:141]
    s_waitcnt lgkmcnt(3)
    ds_read_b64 a[250:251], v155 offset:4616
    ds_read_b64 v[98:99], v114 offset:3072
    v_mfma_f32_16x16x32_bf16 v[138:141], a[80:83], v[210:213], v[138:141]
    ds_read_b64 v[100:101], v114 offset:4608
    v_mov_b32_dpp v115, v202 quad_perm:[0,1,2,3] row_mask:0x4 bank_mask:0xf
    v_mfma_f32_16x16x32_bf16 v[138:141], a[84:87], v[190:193], v[138:141]
    v_mov_b32_dpp v115, v198 quad_perm:[0,1,2,3] row_mask:0x8 bank_mask:0xf
    v_mov_b32_dpp v148, v203 quad_perm:[0,1,2,3] row_mask:0x2 bank_mask:0xf
    v_mfma_f32_16x16x32_bf16 v[138:141], a[88:91], v[222:225], v[138:141]
    buffer_load_dwordx4 v10, s[8:11], s24 offen nt lds
    v_mfma_f32_16x16x32_bf16 v[138:141], a[92:95], v[194:197], v[138:141]
    s_add_u32 m0, s28, 69632
    ds_write_b32 v255, v115 offset:18432
    v_mfma_f32_16x16x32_bf16 v[134:137], a[96:99], v[206:209], 0
    v_mul_f32 v170, v159, v170
    v_mul_f32 v171, v159, v171
    v_mfma_f32_16x16x32_bf16 v[134:137], a[100:103], v[186:189], v[134:137]
    s_waitcnt lgkmcnt(6)
    v_cvt_pk_f16_f32 v200, v170, v171
    v_mul_f32 v172, v159, v172
    v_mfma_f32_16x16x32_bf16 v[134:137], a[104:107], v[210:213], v[134:137]
    s_waitcnt lgkmcnt(4)
    v_mul_f32 v173, v159, v173
    v_cvt_pk_f16_f32 v201, v172, v173
    v_mfma_f32_16x16x32_bf16 v[170:173], v[238:241], a[224:227], 0
    s_waitcnt lgkmcnt(2)
    buffer_load_dwordx4 v11, s[8:11], s24 offen nt lds
    v_mfma_f32_16x16x32_bf16 v[170:173], v[238:241], a[248:251], v[170:173]
    s_waitcnt lgkmcnt(1)
    v_mul_f32 v142, v158, v142
    v_mul_f32 v143, v158, v143
    v_mfma_f32_16x16x32_bf16 v[170:173], v[238:241], v[98:101], v[170:173]
    s_add_u32 m0, s28, 73728
    v_cvt_pk_f16_f32 v142, v142, v143
    v_mul_f32 v144, v158, v144
    v_mfma_f32_16x16x32_bf16 v[134:137], a[108:111], v[190:193], v[134:137]
    v_mul_f32 v145, v158, v145
    v_cvt_pk_f16_f32 v143, v144, v145
    v_mfma_f32_16x16x32_bf16 v[134:137], a[112:115], v[222:225], v[134:137]
    v_mul_f32 v126, v158, v126
    v_mov_b32_dpp v148, v170 quad_perm:[0,1,2,3] row_mask:0x4 bank_mask:0xf
    v_mfma_f32_16x16x32_bf16 v[134:137], a[116:119], v[194:197], v[134:137]
    buffer_load_dwordx4 v12, s[8:11], s24 offen nt lds
    v_mfma_f32_16x16x32_bf16 v[202:205], a[120:123], v[206:209], 0
    s_add_u32 m0, s28, 77824
    v_mov_b32_dpp v148, v171 quad_perm:[0,1,2,3] row_mask:0x8 bank_mask:0xf
    v_mul_f32 v127, v158, v127
    v_mfma_f32_16x16x32_bf16 v[202:205], a[124:127], v[186:189], v[202:205]
    ds_write_b32 v255, v148 offset:19456
    s_waitcnt vmcnt(6)
    v_mfma_f32_16x16x32_bf16 v[202:205], a[128:131], v[210:213], v[202:205]
    v_cvt_pk_f16_f32 v144, v126, v127
    v_mul_f32 v128, v158, v128
    v_mfma_f32_16x16x32_bf16 v[202:205], a[132:135], v[190:193], v[202:205]
    ds_read_b64 a[236:237], v116 offset:0
    ds_read_b64 a[228:229], v116 offset:1536
    v_mfma_f32_16x16x32_bf16 v[202:205], a[136:139], v[222:225], v[202:205]
    buffer_load_dwordx4 v13, s[8:11], s24 offen nt lds
    v_mfma_f32_16x16x32_bf16 v[202:205], a[140:143], v[194:197], v[202:205]
    s_add_u32 m0, s74, 0
    ds_read_b64 v[86:87], v116 offset:8
    ds_read_b64 a[252:253], v116 offset:1544
    v_mfma_f32_16x16x32_bf16 v[170:173], a[0:3], v[206:209], 0
    ds_read_b64 v[110:111], v117 offset:0
    ds_read_b64 v[102:103], v117 offset:1536
    v_mfma_f32_16x16x32_bf16 v[170:173], a[4:7], v[186:189], v[170:173]
    v_mul_f32 v129, v158, v129
    v_cvt_pk_f16_f32 v145, v128, v129
    v_mfma_f32_16x16x32_bf16 v[170:173], a[8:11], v[210:213], v[170:173]
    v_mul_f32 v122, v158, v122
    v_mul_f32 v123, v158, v123
    v_mfma_f32_16x16x32_bf16 v[170:173], a[12:15], v[190:193], v[170:173]
    buffer_load_dwordx4 v14, s[8:11], s24 offen nt lds
    v_mfma_f32_16x16x32_bf16 v[170:173], a[16:19], v[222:225], v[170:173]
    s_add_u32 s8, s60, s23
    v_cvt_pk_f16_f32 v198, v122, v123
    v_mul_f32 v124, v158, v124
    v_mfma_f32_16x16x32_bf16 v[170:173], a[20:23], v[194:197], v[170:173]
    s_addc_u32 s9, s61, 0
    v_mul_f32 v125, v158, v125
    v_cvt_pk_f16_f32 v199, v124, v125
    v_mfma_f32_16x16x32_bf16 v[122:125], a[24:27], v[206:209], 0
    s_sub_u32 s10, s36, s23
    v_cvt_pk_bf16_f32 v182, v182, v182
    v_cvt_pk_bf16_f32 v183, v183, v183
    v_mfma_f32_16x16x32_bf16 v[122:125], a[28:31], v[186:189], v[122:125]
    s_cmp_lt_u32 s34, s17
    ds_write2_b32 v167, v182, v183 offset0:16 offset1:84
    v_mfma_f32_16x16x32_bf16 v[122:125], a[32:35], v[210:213], v[122:125]
    s_cselect_b32 s10, s10, 0
    v_cvt_pk_bf16_f32 v184, v184, v184
    v_cvt_pk_bf16_f32 v185, v185, v185
    v_mfma_f32_16x16x32_bf16 v[122:125], a[36:39], v[190:193], v[122:125]
    s_waitcnt vmcnt(5)
    ds_read_b64 a[230:231], v116 offset:3072
    ds_read_b64 a[238:239], v116 offset:4608
    v_mfma_f32_16x16x32_bf16 v[122:125], a[40:43], v[222:225], v[122:125]
    s_add_u32 m0, s28, 0
    ds_read_b64 a[254:255], v116 offset:3080
    ds_read_b64 v[88:89], v116 offset:4616
    v_mfma_f32_16x16x32_bf16 v[122:125], a[44:47], v[194:197], v[122:125]
    s_mov_b32 s24, s23
    ds_read_b64 v[104:105], v117 offset:3072
    ds_read_b64 v[112:113], v117 offset:4608
    v_mfma_f32_16x16x32_bf16 v[114:117], a[48:51], v[206:209], 0
    s_add_u32 s23, s23, s21
    ds_write2_b32 v167, v184, v185 offset0:152 offset1:220
    v_mfma_f32_16x16x32_bf16 v[114:117], a[52:55], v[186:189], v[114:117]
    s_cmp_ge_u32 s19, 72
    v_cvt_pk_bf16_f32 v218, v218, v218
    v_cvt_pk_bf16_f32 v219, v219, v219
    v_mfma_f32_16x16x32_bf16 v[114:117], a[56:59], v[210:213], v[114:117]
    s_cselect_b32 s34, 72, 0
    ds_write2_b32 v167, v218, v219 offset0:32 offset1:100
    v_mfma_f32_16x16x32_bf16 v[114:117], a[60:63], v[190:193], v[114:117]
    s_cselect_b32 s35, s22, 0
    v_cvt_pk_bf16_f32 v220, v220, v220
    v_cvt_pk_bf16_f32 v221, v221, v221
    v_mfma_f32_16x16x32_bf16 v[114:117], a[64:67], v[222:225], v[114:117]
    s_waitcnt lgkmcnt(6)
    ds_write2_b32 v167, v220, v221 offset0:168 offset1:236
    v_mfma_f32_16x16x32_bf16 v[166:169], v[238:241], a[228:231], 0
    s_waitcnt lgkmcnt(5)
    v_cvt_pk_bf16_f32 v162, v162, v162
    v_cvt_pk_bf16_f32 v163, v163, v163
    v_mfma_f32_16x16x32_bf16 v[166:169], v[238:241], a[252:255], v[166:169]
    s_waitcnt lgkmcnt(3)
    ds_write2_b32 v175, v162, v163 offset0:0 offset1:68
    v_mfma_f32_16x16x32_bf16 v[166:169], v[238:241], v[102:105], v[166:169]
    s_sub_u32 s19, s19, s34
    v_cvt_pk_bf16_f32 v164, v164, v164
    v_cvt_pk_bf16_f32 v165, v165, v165
    v_mfma_f32_16x16x32_bf16 v[126:129], v[238:241], a[236:239], 0
    s_add_u32 s23, s23, s35
    ds_write2_b32 v175, v164, v165 offset0:136 offset1:204
    v_mfma_f32_16x16x32_bf16 v[126:129], v[238:241], v[86:89], v[126:129]
    v_cvt_pk_bf16_f32 v118, v118, v118
    v_cvt_pk_bf16_f32 v119, v119, v119
    v_mfma_f32_16x16x32_bf16 v[126:129], v[238:241], v[110:113], v[126:129]
    ds_write2_b32 v175, v118, v119 offset0:16 offset1:84
    v_mfma_f32_16x16x32_bf16 v[114:117], a[68:71], v[194:197], v[114:117]
    v_cvt_pk_bf16_f32 v120, v120, v120
    v_cvt_pk_bf16_f32 v121, v121, v121
    v_mfma_f32_16x16x32_bf16 v[162:165], v[206:209], a[144:147], 0
    ds_write2_b32 v175, v120, v121 offset0:152 offset1:220
    v_mfma_f32_16x16x32_bf16 v[162:165], v[186:189], a[148:151], v[162:165]
    v_cvt_pk_bf16_f32 v234, v234, v234
    v_mov_b32 v148, v126
    v_mfma_f32_16x16x32_bf16 v[162:165], v[210:213], a[152:155], v[162:165]
    v_mov_b32_dpp v148, v166 quad_perm:[0,1,2,3] row_mask:0x2 bank_mask:0xf
    v_mov_b32_dpp v148, v167 quad_perm:[0,1,2,3] row_mask:0x4 bank_mask:0xf
    v_mfma_f32_16x16x32_bf16 v[162:165], v[190:193], a[156:159], v[162:165]
    v_mov_b32_dpp v148, v127 quad_perm:[0,1,2,3] row_mask:0x8 bank_mask:0xf
    v_cvt_pk_bf16_f32 v235, v235, v235
    v_mfma_f32_16x16x32_bf16 v[162:165], v[222:225], a[160:163], v[162:165]
    ds_write_b32 v255, v148 offset:63552
    v_mfma_f32_16x16x32_bf16 v[162:165], v[194:197], a[164:167], v[162:165]
    v_cvt_pk_bf16_f32 v236, v236, v236
    v_cvt_pk_bf16_f32 v237, v237, v237
    v_mfma_f32_16x16x32_bf16 v[166:169], v[206:209], a[168:171], 0
    ds_write2_b32 v175, v234, v235 offset0:32 offset1:100
    v_mfma_f32_16x16x32_bf16 v[166:169], v[186:189], a[172:175], v[166:169]
    v_fma_f32 v255, v170, v170, s32
    v_fmac_f32 v255, v171, v171
    v_mfma_f32_16x16x32_bf16 v[166:169], v[210:213], a[176:179], v[166:169]
    ds_write2_b32 v175, v236, v237 offset0:168 offset1:236
    v_mfma_f32_16x16x32_bf16 v[166:169], v[190:193], a[180:183], v[166:169]
    v_cvt_pk_bf16_f32 v152, v162, v163
    v_cvt_pk_bf16_f32 v153, v164, v165
    v_mfma_f32_16x16x32_bf16 v[166:169], v[222:225], a[184:187], v[166:169]
    ds_read_b128 v[162:165], v0 offset:32768
    ds_read_b128 v[118:121], v1 offset:32768
    v_mfma_f32_16x16x32_bf16 v[166:169], v[194:197], a[188:191], v[166:169]
    s_waitcnt lgkmcnt(4)
    ds_read_b128 v[126:129], v0 offset:32896
    v_fmac_f32 v255, v172, v172
    v_mfma_f32_16x16x32_bf16 v[158:161], v[206:209], a[192:195], 0
    s_barrier
    ds_read_b128 v[206:209], v1 offset:32896
    ds_read_b128 v[234:237], v254 offset:18432
    v_mfma_f32_16x16x32_bf16 v[158:161], v[186:189], a[196:199], v[158:161]
    v_fmac_f32 v255, v173, v173
    v_fmac_f32 v255, v122, v122
    v_mfma_f32_16x16x32_bf16 v[158:161], v[210:213], a[200:203], v[158:161]
    ds_read_b128 v[182:185], v0 offset:33024
    ds_read_b128 v[186:189], v1 offset:33024
    v_mfma_f32_16x16x32_bf16 v[158:161], v[190:193], a[204:207], v[158:161]
    v_fmac_f32 v255, v123, v123
    v_fmac_f32 v255, v124, v124
    v_mfma_f32_16x16x32_bf16 v[158:161], v[222:225], a[208:211], v[158:161]
    ds_read_b128 v[190:193], v254 offset:19456
    ds_read_b128 v[222:225], v254 offset:63552
    v_mfma_f32_16x16x32_bf16 v[158:161], v[194:197], a[212:215], v[158:161]
    v_fmac_f32 v255, v125, v125
    v_fmac_f32 v255, v114, v114
    v_mfma_f32_16x16x32_f16 v[218:221], v[130:133], v[142:145], v[46:49]
    s_waitcnt lgkmcnt(7)
    v_fmac_f32 v255, v115, v115
    v_fmac_f32 v255, v116, v116
    v_mfma_f32_16x16x32_bf16 v[210:213], a[72:75], v[162:165], 0
    s_waitcnt lgkmcnt(6)
    v_fmac_f32 v255, v117, v117
    v_fma_f32 v254, v138, v138, s32
    v_mfma_f32_16x16x32_bf16 v[210:213], a[76:79], v[118:121], v[210:213]
    s_waitcnt lgkmcnt(4)
    v_add_f32 v234, v234, v235
    v_add_f32 v236, v236, v237
    v_mfma_f32_16x16x32_bf16 v[210:213], a[80:83], v[126:129], v[210:213]
    v_add_f32 v234, v234, v236
    v_mul_f32 v234, 0xbbaaaaab, v234
    v_mfma_f32_16x16x32_bf16 v[210:213], a[84:87], v[206:209], v[210:213]
    s_waitcnt lgkmcnt(2)
    ds_write_b32 v154, v234 offset:0
    v_mfma_f32_16x16x32_bf16 v[210:213], a[88:91], v[182:185], v[210:213]
    v_fmac_f32 v254, v139, v139
    v_fmac_f32 v254, v140, v140
    v_mfma_f32_16x16x32_bf16 v[210:213], a[92:95], v[186:189], v[210:213]
    s_waitcnt lgkmcnt(1)
    ds_read_b128 v[234:237], v177 offset:0
    ds_read_b128 v[194:197], v177 offset:64
    v_mfma_f32_16x16x32_bf16 v[238:241], a[96:99], v[162:165], 0
    v_add_f32 v190, v190, v191
    v_add_f32 v192, v192, v193
    v_mfma_f32_16x16x32_bf16 v[238:241], a[100:103], v[118:121], v[238:241]
    v_add_f32 v190, v190, v192
    v_mul_f32 v190, 0xbbaaaaab, v190
    v_mfma_f32_16x16x32_bf16 v[238:241], a[104:107], v[126:129], v[238:241]
    ds_write_b32 v154, v190 offset:256
    v_mfma_f32_16x16x32_bf16 v[238:241], a[108:111], v[206:209], v[238:241]
    v_add_f32 v222, v222, v223
    v_add_f32 v224, v224, v225
    v_mfma_f32_16x16x32_bf16 v[238:241], a[112:115], v[182:185], v[238:241]
    ds_read_b128 v[190:193], v5 offset:0
    ds_read_b128 v[246:249], v5 offset:16
    v_mfma_f32_16x16x32_bf16 v[238:241], a[116:119], v[186:189], v[238:241]
    ds_read_b128 v[250:253], v5 offset:48
    ds_read_b32 v180, v6 offset:192
    v_add_f32 v222, v222, v224
    v_mfma_f32_16x16x16_f16 v[218:221], v[200:201], v[198:199], v[218:221]
    v_mul_f32 v222, 0xbbaaaaab, v222
    ds_write_b32 v154, v222 offset:512
    v_fmac_f32 v254, v141, v141
    v_fmac_f32 v254, v134, v134
    v_fmac_f32 v254, v135, v135
    v_fmac_f32 v254, v136, v136
    v_fmac_f32 v254, v137, v137
    v_fmac_f32 v254, v202, v202
    v_fmac_f32 v254, v203, v203
    v_fmac_f32 v254, v204, v204
    v_fmac_f32 v254, v205, v205
    v_cvt_pk_bf16_f32 v36, v255, v254
    v_mfma_f32_16x16x32_bf16 v[154:157], a[120:123], v[162:165], 0
    s_waitcnt lgkmcnt(5)
    v_cvt_pk_bf16_f32 v148, v166, v167
    v_cvt_pk_bf16_f32 v149, v168, v169
    v_mfma_f32_16x16x32_bf16 v[154:157], a[124:127], v[118:121], v[154:157]
    s_waitcnt lgkmcnt(4)
    v_cvt_pk_bf16_f32 v216, v158, v159
    v_cvt_pk_bf16_f32 v217, v160, v161
    v_mfma_f32_16x16x32_bf16 v[166:169], v[32:35], v[36:39], 0
    s_waitcnt lgkmcnt(2)
    v_fma_f32 v181, v210, v210, s32
    v_fmac_f32 v181, v211, v211
    v_mfma_f32_16x16x32_bf16 v[154:157], a[128:131], v[126:129], v[154:157]
    s_waitcnt lgkmcnt(1)
    v_fmac_f32 v181, v212, v212
    v_fmac_f32 v181, v213, v213
    v_mfma_f32_16x16x32_bf16 v[154:157], a[132:135], v[206:209], v[154:157]
    v_rsq_f32 v167, v167
    v_mfma_f32_16x16x32_bf16 v[154:157], a[136:139], v[182:185], v[154:157]
    v_rsq_f32 v166, v166
    v_mfma_f32_16x16x32_bf16 v[154:157], a[140:143], v[186:189], v[154:157]
    v_mul_f32 v166, s31, v166
    v_mul_f32 v138, v167, v138
    v_mul_f32 v139, v167, v139
    v_cvt_pk_f16_f32 v138, v138, v139
    v_mul_f32 v140, v167, v140
    v_mul_f32 v141, v167, v141
    v_cvt_pk_f16_f32 v139, v140, v141
    v_mul_f32 v134, v167, v134
    v_mul_f32 v135, v167, v135
    v_cvt_pk_f16_f32 v140, v134, v135
    v_mfma_f32_16x16x32_bf16 v[158:161], a[0:3], v[162:165], 0
    v_mul_f32 v136, v167, v136
    v_mul_f32 v137, v167, v137
    v_mfma_f32_16x16x32_bf16 v[158:161], a[4:7], v[118:121], v[158:161]
    v_cvt_pk_f16_f32 v141, v136, v137
    v_mul_f32 v202, v167, v202
    v_mfma_f32_16x16x32_bf16 v[158:161], a[8:11], v[126:129], v[158:161]
    v_mul_f32 v203, v167, v203
    v_cvt_pk_f16_f32 v136, v202, v203
    v_mfma_f32_16x16x32_bf16 v[158:161], a[12:15], v[206:209], v[158:161]
    v_mul_f32 v204, v167, v204
    v_mul_f32 v205, v167, v205
    v_mfma_f32_16x16x32_bf16 v[158:161], a[16:19], v[182:185], v[158:161]
    v_cvt_pk_f16_f32 v137, v204, v205
    v_mul_f32 v170, v166, v170
    v_mfma_f32_16x16x32_bf16 v[158:161], a[20:23], v[186:189], v[158:161]
    v_mul_f32 v171, v166, v171
    v_cvt_pk_f16_f32 v170, v170, v171
    v_mfma_f32_16x16x32_bf16 v[222:225], a[24:27], v[162:165], 0
    v_mul_f32 v172, v166, v172
    v_mul_f32 v173, v166, v173
    v_mfma_f32_16x16x32_bf16 v[222:225], a[28:31], v[118:121], v[222:225]
    v_cvt_pk_f16_f32 v171, v172, v173
    v_mul_f32 v122, v166, v122
    v_mfma_f32_16x16x32_bf16 v[222:225], a[32:35], v[126:129], v[222:225]
    v_mul_f32 v123, v166, v123
    v_cvt_pk_f16_f32 v172, v122, v123
    v_mfma_f32_16x16x32_bf16 v[222:225], a[36:39], v[206:209], v[222:225]
    v_mul_f32 v124, v166, v124
    v_mul_f32 v125, v166, v125
    v_mfma_f32_16x16x32_bf16 v[222:225], a[40:43], v[182:185], v[222:225]
    v_cvt_pk_f16_f32 v173, v124, v125
    v_mul_f32 v114, v166, v114
    v_mfma_f32_16x16x32_bf16 v[222:225], a[44:47], v[186:189], v[222:225]
    v_mul_f32 v115, v166, v115
    v_cvt_pk_f16_f32 v134, v114, v115
    v_mfma_f32_16x16x32_bf16 v[122:125], a[48:51], v[162:165], 0
    v_mul_f32 v116, v166, v116
    v_mul_f32 v117, v166, v117
    v_mfma_f32_16x16x32_bf16 v[122:125], a[52:55], v[118:121], v[122:125]
    v_cvt_pk_f16_f32 v135, v116, v117
    v_fma_f32 v254, v158, v158, s32
    v_mfma_f32_16x16x32_bf16 v[122:125], a[56:59], v[126:129], v[122:125]
    v_fmac_f32 v254, v159, v159
    v_fmac_f32 v254, v160, v160
    v_mfma_f32_16x16x32_bf16 v[122:125], a[60:63], v[206:209], v[122:125]
    v_fmac_f32 v254, v161, v161
    v_fmac_f32 v254, v222, v222
    v_mfma_f32_16x16x32_bf16 v[122:125], a[64:67], v[182:185], v[122:125]
    v_fmac_f32 v254, v223, v223
    v_fmac_f32 v254, v224, v224
    v_mfma_f32_16x16x32_bf16 v[122:125], a[68:71], v[186:189], v[122:125]
    v_fmac_f32 v254, v225, v225
    v_fmac_f32 v181, v238, v238
    v_fmac_f32 v181, v239, v239
    v_fmac_f32 v181, v240, v240
    v_fmac_f32 v181, v241, v241
    v_fmac_f32 v181, v154, v154
    v_fmac_f32 v181, v155, v155
    v_fmac_f32 v181, v156, v156
    v_fmac_f32 v254, v122, v122
    v_fmac_f32 v254, v123, v123
    v_fmac_f32 v254, v124, v124
    v_fmac_f32 v254, v125, v125
    v_fmac_f32 v181, v157, v157
    v_cvt_pk_bf16_f32 v36, v254, v181
    v_mfma_f32_16x16x32_bf16 v[114:117], v[162:165], a[144:147], 0
    v_xor_b32 v0, 65536, v0
    v_xor_b32 v1, 65536, v1
    v_mfma_f32_16x16x32_bf16 v[114:117], v[118:121], a[148:151], v[114:117]
    v_add_u32 v5, 336, v5
    v_mfma_f32_16x16x32_bf16 v[114:117], v[126:129], a[152:155], v[114:117]
    v_mfma_f32_16x16x32_bf16 v[114:117], v[206:209], a[156:159], v[114:117]
    v_mfma_f32_16x16x32_bf16 v[114:117], v[182:185], a[160:163], v[114:117]
    v_mfma_f32_16x16x32_bf16 v[114:117], v[186:189], a[164:167], v[114:117]
    s_nop 0
    s_nop 0
    s_nop 0
    s_nop 0
    s_nop 0
    s_nop 0
    s_nop 0
    s_nop 0
    v_cvt_pk_bf16_f32 v166, v114, v115
    v_cvt_pk_bf16_f32 v167, v116, v117
    v_mfma_f32_16x16x32_bf16 v[114:117], v[32:35], v[36:39], 0
    s_nop 0
    s_nop 0
    s_nop 0
    s_nop 0
    s_nop 0
    s_nop 0
    s_nop 0
    s_nop 0
    v_rsq_f32 v115, v115
    v_rsq_f32 v114, v114
    v_mul_f32 v210, v115, v210
    v_mul_f32 v114, s31, v114
    v_mul_f32 v211, v115, v211
    v_cvt_pk_f16_f32 v210, v210, v211
    v_mul_f32 v212, v115, v212
    v_mul_f32 v213, v115, v213
    v_cvt_pk_f16_f32 v211, v212, v213
    v_mul_f32 v238, v115, v238
    v_mul_f32 v239, v115, v239
    v_cvt_pk_f16_f32 v212, v238, v239
    v_mul_f32 v240, v115, v240
    v_mul_f32 v241, v115, v241
    v_cvt_pk_f16_f32 v213, v240, v241
    v_mfma_f32_16x16x32_f16 v[238:241], v[190:193], v[142:145], v[22:25]
    v_mul_f32 v154, v115, v154
    v_mul_f32 v155, v115, v155
    v_mfma_f32_16x16x32_f16 v[238:241], v[246:249], v[130:133], v[238:241]
    v_cvt_pk_f16_f32 v204, v154, v155
    v_mul_f32 v156, v115, v156
    v_mfma_f32_16x16x32_f16 v[238:241], v[250:253], v[198:201], v[238:241]
    v_mul_f32 v157, v115, v157
    v_cvt_pk_f16_f32 v205, v156, v157
    v_mfma_f32_16x16x32_bf16 v[154:157], v[162:165], a[168:171], 0
    v_mul_f32 v158, v114, v158
    v_mul_f32 v159, v114, v159
    v_mfma_f32_16x16x32_bf16 v[154:157], v[118:121], a[172:175], v[154:157]
    v_cvt_pk_f16_f32 v158, v158, v159
    v_mul_f32 v160, v114, v160
    v_mfma_f32_16x16x32_bf16 v[154:157], v[126:129], a[176:179], v[154:157]
    ds_read2_b32 v[168:169], v6 offset0:0 offset1:0
    v_mul_f32 v161, v114, v161
    v_mfma_f32_16x16x32_bf16 v[154:157], v[206:209], a[180:183], v[154:157]
    v_cvt_pk_f16_f32 v159, v160, v161
    v_mul_f32 v222, v114, v222
    v_mfma_f32_16x16x32_bf16 v[154:157], v[182:185], a[184:187], v[154:157]
    v_mul_f32 v223, v114, v223
    v_cvt_pk_f16_f32 v160, v222, v223
    v_mfma_f32_16x16x32_bf16 v[154:157], v[186:189], a[188:191], v[154:157]
    ds_read2_b32 v[228:229], v6 offset0:16 offset1:16
    v_mul_f32 v224, v114, v224
    v_mul_f32 v225, v114, v225
    v_cvt_pk_f16_f32 v161, v224, v225
    v_mul_f32 v122, v114, v122
    v_mul_f32 v123, v114, v123
    v_cvt_pk_f16_f32 v202, v122, v123
    ds_read2_b32 v[116:117], v6 offset0:32 offset1:32
    v_cvt_pk_bf16_f32 v226, v154, v155
    v_cvt_pk_bf16_f32 v227, v156, v157
    v_mul_f32 v124, v114, v124
    v_mul_f32 v125, v114, v125
    v_cvt_pk_f16_f32 v203, v124, v125
    v_mfma_f32_16x16x32_bf16 v[122:125], v[162:165], a[192:195], 0
    s_waitcnt lgkmcnt(2)
    v_mov_b32_dpp v180, v239 quad_perm:[0,1,2,3] row_mask:0x1 bank_mask:0xf
    v_max3_f32 v181, v238, v218, v219
    v_mfma_f32_16x16x32_bf16 v[122:125], v[118:121], a[196:199], v[122:125]
    v_max3_f32 v181, v181, v220, v221
    v_add_u32 v6, 272, v6
    v_mfma_f32_16x16x32_bf16 v[122:125], v[126:129], a[200:203], v[122:125]
    v_mfma_f32_16x16x32_bf16 v[122:125], v[206:209], a[204:207], v[122:125]
    s_waitcnt lgkmcnt(1)
    v_mfma_f32_16x16x32_bf16 v[122:125], v[182:185], a[208:211], v[122:125]
    v_mfma_f32_16x16x32_f16 v[162:165], v[138:141], v[142:145], v[50:53]
    v_mfma_f32_16x16x32_f16 v[118:121], v[210:213], v[142:145], v[54:57]
    s_waitcnt lgkmcnt(0)
    v_mfma_f32_16x16x32_bf16 v[122:125], v[186:189], a[212:215], v[122:125]
    s_waitcnt vmcnt(0)
    v_mfma_f32_16x16x32_f16 v[142:145], v[190:193], v[170:173], v[24:27]
    s_barrier
    buffer_load_dwordx4 v10, s[8:11], 0 offen nt lds
    s_add_u32 m0, s28, 4096
    v_mfma_f32_16x16x16_f16 v[162:165], v[136:137], v[198:199], v[162:165]
    v_mfma_f32_16x16x16_f16 v[118:121], v[204:205], v[198:199], v[118:121]
    v_mfma_f32_16x16x32_f16 v[142:145], v[246:249], v[138:141], v[142:145]
    v_cvt_pk_bf16_f32 v114, v122, v123
    v_cvt_pk_bf16_f32 v115, v124, v125
    v_mfma_f32_16x16x32_f16 v[142:145], v[250:253], v[134:137], v[142:145]
    buffer_load_dwordx4 v11, s[8:11], 0 offen nt lds
    s_add_u32 m0, s28, 8192
    v_mfma_f32_16x16x32_f16 v[122:125], v[190:193], v[158:161], v[26:29]
    v_max3_f32 v181, v181, v162, v163
    v_max3_f32 v181, v181, v164, v165
    v_mfma_f32_16x16x32_f16 v[122:125], v[246:249], v[210:213], v[122:125]
    v_max3_f32 v181, v181, v118, v119
    v_max3_f32 v181, v181, v120, v121
    v_mfma_f32_16x16x32_f16 v[122:125], v[250:253], v[202:205], v[122:125]
    v_mov_b32_dpp v180, v143 quad_perm:[0,1,2,3] row_mask:0x2 bank_mask:0xf
    v_mov_b32 v198, v181
    v_mfma_f32_16x16x16_bf16 v[126:129], a[216:217], v[178:179], v[234:237]
    v_mfma_f32_16x16x16_bf16 v[206:209], a[240:241], v[178:179], v[234:237]
    buffer_load_dwordx4 v12, s[8:11], 0 offen nt lds
    v_permlane32_swap_b32 v181, v198
    v_mfma_f32_16x16x16_bf16 v[154:157], v[90:91], v[178:179], v[234:237]
    v_max_f32 v181, v181, v198
    v_mov_b32 v198, v181
    v_mov_b32_dpp v180, v123 quad_perm:[0,1,2,3] row_mask:0x4 bank_mask:0xf
    v_mfma_f32_16x16x16_bf16 v[186:189], a[218:219], v[178:179], v[194:197]
    v_permlane16_swap_b32 v181, v198
    v_max_f32 v181, v181, v198
    v_mfma_f32_16x16x16_bf16 v[234:237], a[242:243], v[178:179], v[194:197]
    v_sub_f32 v218, v218, v181
    v_exp_f32 v218, v218
    v_mfma_f32_16x16x16_bf16 v[182:185], v[92:93], v[178:179], v[194:197]
    s_add_u32 m0, s28, 12288
    s_xor_b32 s28, s28, 65536
    buffer_load_dwordx4 v13, s[8:11], 0 offen nt lds
    s_mov_b32 m0, s29
    s_xor_b32 s29, s29, s30
    v_sub_f32 v219, v219, v181
    v_exp_f32 v219, v219
    v_sub_f32 v220, v220, v181
    v_cvt_pk_bf16_f32 v190, v218, v219
    v_exp_f32 v220, v220
    v_sub_f32 v221, v221, v181
    v_exp_f32 v221, v221
    v_sub_f32 v162, v162, v181
    v_cvt_pk_bf16_f32 v191, v220, v221
    v_exp_f32 v162, v162
    v_mfma_f32_16x16x32_f16 v[218:221], v[130:133], v[170:173], v[58:61]
    buffer_load_dwordx4 v14, s[8:11], 0 offen nt lds
    v_sub_f32 v163, v163, v181
    v_exp_f32 v163, v163
    v_sub_f32 v164, v164, v181
    v_cvt_pk_bf16_f32 v192, v162, v163
    v_exp_f32 v164, v164
    v_mfma_f32_16x16x16_f16 v[218:221], v[200:201], v[134:135], v[218:221]
    v_sub_f32 v165, v165, v181
    v_exp_f32 v165, v165
    v_sub_f32 v118, v118, v181
    v_mfma_f32_16x16x32_f16 v[222:225], v[138:141], v[170:173], v[62:65]
    v_cvt_pk_bf16_f32 v193, v164, v165
    v_exp_f32 v118, v118
    v_sub_f32 v119, v119, v181
    v_exp_f32 v119, v119
    v_sub_f32 v120, v120, v181
    v_cvt_pk_bf16_f32 v36, v118, v119
    v_mfma_f32_16x16x16_f16 v[222:225], v[136:137], v[134:135], v[222:225]
    v_exp_f32 v120, v120
    v_sub_f32 v121, v121, v181
    v_sub_f32 v238, v238, v181
    v_mfma_f32_16x16x32_f16 v[162:165], v[210:213], v[170:173], v[66:69]
    v_exp_f32 v121, v121
    v_exp_f32 v238, v238
    v_cvt_pk_bf16_f32 v37, v120, v121
    v_cvt_pk_bf16_f32 v39, v238, 0
    v_cvt_pk_bf16_f32 v126, v126, v127
    v_accvgpr_write_b32 a216, v126
    v_mfma_f32_16x16x32_bf16 v[118:121], v[28:31], v[36:39], 0
    v_cvt_pk_bf16_f32 v128, v128, v129
    v_accvgpr_write_b32 a217, v128
    v_mfma_f32_16x16x32_bf16 v[118:121], v[28:31], v[190:193], v[118:121]
    v_cvt_pk_bf16_f32 v206, v206, v207
    v_accvgpr_write_b32 a240, v206
    v_mfma_f32_16x16x32_bf16 v[126:129], v[166:169], v[36:39], 0
    v_cvt_pk_bf16_f32 v208, v208, v209
    v_accvgpr_write_b32 a241, v208
    v_mfma_f32_16x16x32_bf16 v[126:129], v[150:153], v[190:193], v[126:129]
    v_cvt_pk_bf16_f32 v90, v154, v155
    v_cvt_pk_bf16_f32 v91, v156, v157
    v_mfma_f32_16x16x32_bf16 v[206:209], v[226:229], v[36:39], 0
    ds_read_b128 v[170:173], v177 offset:128
    v_cvt_pk_bf16_f32 v186, v186, v187
    v_mfma_f32_16x16x32_bf16 v[206:209], v[146:149], v[190:193], v[206:209]
    v_rcp_f32 v118, v118
    v_mfma_f32_16x16x32_bf16 v[154:157], v[114:117], v[36:39], 0
    v_mul_f32 v126, v118, v126
    v_mul_f32 v127, v118, v127
    v_mfma_f32_16x16x32_bf16 v[154:157], v[214:217], v[190:193], v[154:157]
    v_cvt_pk_bf16_f32 v126, v126, v127
    v_mul_f32 v128, v118, v128
    v_mul_f32 v129, v118, v129
    v_mfma_f32_16x16x16_f16 v[162:165], v[204:205], v[134:135], v[162:165]
    v_cvt_pk_bf16_f32 v127, v128, v129
    v_mul_f32 v206, v118, v206
    v_mul_f32 v207, v118, v207
    v_cvt_pk_bf16_f32 v128, v206, v207
    v_mul_f32 v208, v118, v208
    v_mul_f32 v209, v118, v209
    v_cvt_pk_bf16_f32 v129, v208, v209
    ds_write_b128 v3, v[126:129] offset:0
    s_waitcnt lgkmcnt(1)
    v_mfma_f32_16x16x16_bf16 v[126:129], a[232:233], v[178:179], v[170:173]
    v_mul_f32 v154, v118, v154
    v_mul_f32 v155, v118, v155
    v_cvt_pk_bf16_f32 v134, v154, v155
    v_mfma_f32_16x16x16_bf16 v[206:209], v[82:83], v[178:179], v[170:173]
    v_mul_f32 v156, v118, v156
    v_mul_f32 v157, v118, v157
    v_cvt_pk_bf16_f32 v135, v156, v157
    v_mfma_f32_16x16x16_bf16 v[118:121], v[106:107], v[178:179], v[170:173]
    ds_write_b64 v4, v[134:135] offset:4096
    v_accvgpr_write_b32 a218, v186
    v_cvt_pk_bf16_f32 v188, v188, v189
    v_accvgpr_write_b32 a219, v188
    v_cvt_pk_bf16_f32 v234, v234, v235
    v_accvgpr_write_b32 a242, v234
    v_cvt_pk_bf16_f32 v236, v236, v237
    v_accvgpr_write_b32 a243, v236
    v_cvt_pk_bf16_f32 v92, v182, v183
    v_cvt_pk_bf16_f32 v93, v184, v185
    ds_read_b128 v[234:237], v177 offset:192
    v_cvt_pk_bf16_f32 v126, v126, v127
    v_accvgpr_write_b32 a232, v126
    v_cvt_pk_bf16_f32 v128, v128, v129
    v_accvgpr_write_b32 a233, v128
    v_cvt_pk_bf16_f32 v82, v206, v207
    v_cvt_pk_bf16_f32 v83, v208, v209
    v_cvt_pk_bf16_f32 v106, v118, v119
    v_cvt_pk_bf16_f32 v107, v120, v121
    ds_read_b128 v[118:121], v177 offset:256
    v_mov_b32 v181, v180
    v_max3_f32 v254, v142, v218, v219
    v_max3_f32 v254, v254, v220, v221
    v_max_f32_dpp v181, v181, v181 quad_perm:[1,0,3,2] row_mask:0xf bank_mask:0xf
    v_max3_f32 v254, v254, v222, v223
    v_max3_f32 v254, v254, v224, v225
    v_max_f32_dpp v181, v181, v181 quad_perm:[2,3,0,1] row_mask:0xf bank_mask:0xf
    v_max3_f32 v254, v254, v162, v163
    v_max3_f32 v254, v254, v164, v165
    v_max_f32_dpp v181, v181, v181 row_half_mirror row_mask:0xf bank_mask:0xf
    v_mov_b32 v255, v254
    s_nop 0
    v_max_f32_dpp v181, v181, v181 row_mirror row_mask:0xf bank_mask:0xf
    v_mov_b32 v134, v181
    v_permlane32_swap_b32 v254, v255
    s_waitcnt lgkmcnt(1)
    v_mfma_f32_16x16x16_bf16 v[126:129], a[220:221], v[178:179], v[234:237]
    v_permlane32_swap_b32 v181, v134
    v_max_f32 v181, v181, v134
    v_mfma_f32_16x16x16_bf16 v[170:173], a[244:245], v[178:179], v[234:237]
    v_mov_b32 v134, v181
    v_max_f32 v254, v254, v255
    v_mov_b32 v255, v254
    v_mfma_f32_16x16x16_bf16 v[206:209], v[94:95], v[178:179], v[234:237]
    v_permlane16_swap_b32 v181, v134
    s_waitcnt lgkmcnt(0)
    v_mfma_f32_16x16x16_bf16 v[186:189], a[222:223], v[178:179], v[118:121]
    v_cvt_pk_bf16_f32 v126, v126, v127
    v_accvgpr_write_b32 a220, v126
    v_cvt_pk_bf16_f32 v128, v128, v129
    v_mfma_f32_16x16x16_bf16 v[234:237], a[246:247], v[178:179], v[118:121]
    v_accvgpr_write_b32 a221, v128
    v_cvt_pk_bf16_f32 v170, v170, v171
    v_accvgpr_write_b32 a244, v170
    v_mfma_f32_16x16x16_bf16 v[126:129], v[96:97], v[178:179], v[118:121]
    v_cvt_pk_bf16_f32 v172, v172, v173
    v_accvgpr_write_b32 a245, v172
    v_cvt_pk_bf16_f32 v94, v206, v207
    v_cvt_pk_bf16_f32 v95, v208, v209
    ds_read_b128 v[118:121], v177 offset:320
    v_cvt_pk_bf16_f32 v186, v186, v187
    v_accvgpr_write_b32 a222, v186
    v_cvt_pk_bf16_f32 v188, v188, v189
    v_accvgpr_write_b32 a223, v188
    v_cvt_pk_bf16_f32 v234, v234, v235
    v_accvgpr_write_b32 a246, v234
    v_cvt_pk_bf16_f32 v236, v236, v237
    v_accvgpr_write_b32 a247, v236
    v_cvt_pk_bf16_f32 v96, v126, v127
    v_cvt_pk_bf16_f32 v97, v128, v129
    ds_read_b128 v[234:237], v177 offset:384
    v_max_f32 v181, v181, v134
    v_sub_f32 v180, v180, v181
    v_exp_f32 v180, v180
    v_permlane16_swap_b32 v254, v255
    v_cvt_pk_bf16_f32 v180, v180, v180
    ds_write_b16 v8, v180
    v_max_f32 v254, v254, v255
    ds_read_b128 v[126:129], v9
    s_waitcnt lgkmcnt(3)
    v_mfma_f32_16x16x16_bf16 v[206:209], a[234:235], v[178:179], v[118:121]
    ds_read_b128 v[170:173], v9 offset:64
    v_sub_f32 v218, v218, v254
    v_sub_f32 v219, v219, v254
    v_mfma_f32_16x16x16_bf16 v[186:189], v[84:85], v[178:179], v[118:121]
    v_exp_f32 v218, v218
    v_sub_f32 v220, v220, v254
    v_mfma_f32_16x16x16_bf16 v[154:157], v[108:109], v[178:179], v[118:121]
    v_exp_f32 v219, v219
    s_waitcnt lgkmcnt(3)
    v_mfma_f32_16x16x16_bf16 v[182:185], a[224:225], v[178:179], v[234:237]
    v_cvt_pk_bf16_f32 v206, v206, v207
    v_accvgpr_write_b32 a234, v206
    v_cvt_pk_bf16_f32 v208, v208, v209
    v_mfma_f32_16x16x16_bf16 v[118:121], a[248:249], v[178:179], v[234:237]
    v_accvgpr_write_b32 a235, v208
    v_cvt_pk_bf16_f32 v84, v186, v187
    v_cvt_pk_bf16_f32 v85, v188, v189
    v_mfma_f32_16x16x16_bf16 v[186:189], v[98:99], v[178:179], v[234:237]
    v_cvt_pk_bf16_f32 v108, v154, v155
    v_cvt_pk_bf16_f32 v109, v156, v157
    ds_read_b128 v[206:209], v177 offset:448
    s_waitcnt lgkmcnt(2)
    v_mfma_f32_16x16x32_bf16 v[154:157], v[126:129], v[28:31], 0
    v_cvt_pk_bf16_f32 v182, v182, v183
    v_accvgpr_write_b32 a224, v182
    v_mfma_f32_16x16x32_bf16 v[190:193], v[126:129], v[150:153], 0
    s_waitcnt lgkmcnt(1)
    v_cvt_pk_bf16_f32 v184, v184, v185
    v_accvgpr_write_b32 a225, v184
    v_mfma_f32_16x16x32_bf16 v[154:157], v[170:173], v[28:31], v[154:157]
    v_cvt_pk_bf16_f32 v118, v118, v119
    v_accvgpr_write_b32 a248, v118
    v_mfma_f32_16x16x32_bf16 v[190:193], v[170:173], v[166:169], v[190:193]
    v_cvt_pk_bf16_f32 v120, v120, v121
    v_accvgpr_write_b32 a249, v120
    v_mfma_f32_16x16x32_bf16 v[118:121], v[126:129], v[146:149], 0
    v_cvt_pk_bf16_f32 v98, v186, v187
    v_cvt_pk_bf16_f32 v99, v188, v189
    v_mfma_f32_16x16x32_bf16 v[118:121], v[170:173], v[226:229], v[118:121]
    ds_read_b128 v[234:237], v177 offset:512
    v_cvt_pk_bf16_f32 v218, v218, v219
    v_mfma_f32_16x16x32_bf16 v[194:197], v[126:129], v[214:217], 0
    v_exp_f32 v220, v220
    v_mfma_f32_16x16x32_bf16 v[194:197], v[170:173], v[114:117], v[194:197]
    s_waitcnt lgkmcnt(1)
    v_sub_f32 v221, v221, v254
    v_exp_f32 v221, v221
    v_mfma_f32_16x16x16_bf16 v[126:129], a[226:227], v[178:179], v[206:209]
    v_cvt_pk_bf16_f32 v219, v220, v221
    v_sub_f32 v222, v222, v254
    v_sub_f32 v223, v223, v254
    v_mfma_f32_16x16x16_bf16 v[186:189], a[250:251], v[178:179], v[206:209]
    v_exp_f32 v222, v222
    v_sub_f32 v224, v224, v254
    v_mfma_f32_16x16x16_bf16 v[170:173], v[100:101], v[178:179], v[206:209]
    v_exp_f32 v223, v223
    v_cvt_pk_bf16_f32 v126, v126, v127
    v_accvgpr_write_b32 a226, v126
    v_cvt_pk_bf16_f32 v128, v128, v129
    v_accvgpr_write_b32 a227, v128
    v_cvt_pk_bf16_f32 v186, v186, v187
    v_accvgpr_write_b32 a250, v186
    s_waitcnt lgkmcnt(0)
    v_mfma_f32_16x16x16_bf16 v[126:129], a[236:237], v[178:179], v[234:237]
    v_cvt_pk_bf16_f32 v188, v188, v189
    v_accvgpr_write_b32 a251, v188
    v_cvt_pk_bf16_f32 v100, v170, v171
    v_mfma_f32_16x16x16_bf16 v[206:209], v[86:87], v[178:179], v[234:237]
    v_cvt_pk_bf16_f32 v101, v172, v173
    v_cvt_pk_bf16_f32 v220, v222, v223
    v_sub_f32 v225, v225, v254
    v_mfma_f32_16x16x16_bf16 v[170:173], v[110:111], v[178:179], v[234:237]
    ds_read_b128 v[186:189], v177 offset:576
    v_cvt_pk_bf16_f32 v126, v126, v127
    v_accvgpr_write_b32 a236, v126
    v_cvt_pk_bf16_f32 v128, v128, v129
    v_accvgpr_write_b32 a237, v128
    v_cvt_pk_bf16_f32 v86, v206, v207
    v_cvt_pk_bf16_f32 v87, v208, v209
    v_exp_f32 v224, v224
    v_cvt_pk_bf16_f32 v110, v170, v171
    v_cvt_pk_bf16_f32 v111, v172, v173
    ds_read_b128 v[234:237], v177 offset:640
    v_exp_f32 v225, v225
    v_mfma_f32_16x16x32_f16 v[126:129], v[130:133], v[158:161], v[70:73]
    v_cvt_pk_bf16_f32 v221, v224, v225
    v_sub_f32 v162, v162, v254
    v_exp_f32 v162, v162
    v_sub_f32 v163, v163, v254
    v_exp_f32 v163, v163
    v_sub_f32 v164, v164, v254
    v_mfma_f32_16x16x16_f16 v[126:129], v[200:201], v[202:203], v[126:129]
    v_cvt_pk_bf16_f32 v36, v162, v163
    s_waitcnt lgkmcnt(1)
    v_sub_f32 v165, v165, v254
    v_mfma_f32_16x16x16_bf16 v[130:133], a[228:229], v[178:179], v[186:189]
    v_exp_f32 v164, v164
    v_exp_f32 v165, v165
    v_mfma_f32_16x16x32_f16 v[170:173], v[138:141], v[158:161], v[74:77]
    v_cvt_pk_bf16_f32 v37, v164, v165
    v_max3_f32 v255, v122, v126, v127
    v_mfma_f32_16x16x32_f16 v[162:165], v[210:213], v[158:161], v[78:81]
    v_max3_f32 v255, v255, v128, v129
    v_rcp_f32 v154, v154
    v_mfma_f32_16x16x16_bf16 v[138:141], a[252:253], v[178:179], v[186:189]
    v_cvt_pk_bf16_f32 v130, v130, v131
    v_accvgpr_write_b32 a228, v130
    v_cvt_pk_bf16_f32 v132, v132, v133
    v_mfma_f32_16x16x16_f16 v[170:173], v[136:137], v[202:203], v[170:173]
    v_accvgpr_write_b32 a229, v132
    v_sub_f32 v142, v142, v254
    v_mul_f32 v190, v190, v154
    v_mfma_f32_16x16x16_f16 v[162:165], v[204:205], v[202:203], v[162:165]
    v_cvt_pk_bf16_f32 v138, v138, v139
    v_accvgpr_write_b32 a252, v138
    v_cvt_pk_bf16_f32 v140, v140, v141
    v_mfma_f32_16x16x16_bf16 v[130:133], v[102:103], v[178:179], v[186:189]
    s_waitcnt lgkmcnt(0)
    v_accvgpr_write_b32 a253, v140
    v_max3_f32 v255, v255, v170, v171
    v_mfma_f32_16x16x16_bf16 v[138:141], a[230:231], v[178:179], v[234:237]
    v_max3_f32 v255, v255, v172, v173
    v_max3_f32 v255, v255, v162, v163
    v_max3_f32 v255, v255, v164, v165
    v_mfma_f32_16x16x16_bf16 v[134:137], a[254:255], v[178:179], v[234:237]
    v_cvt_pk_bf16_f32 v102, v130, v131
    v_cvt_pk_bf16_f32 v103, v132, v133
    v_mov_b32 v254, v255
    v_mfma_f32_16x16x16_bf16 v[130:133], v[104:105], v[178:179], v[234:237]
    ds_read_b128 v[206:209], v177 offset:704
    v_cvt_pk_bf16_f32 v138, v138, v139
    v_accvgpr_write_b32 a230, v138
    v_cvt_pk_bf16_f32 v140, v140, v141
    v_accvgpr_write_b32 a231, v140
    v_cvt_pk_bf16_f32 v134, v134, v135
    v_accvgpr_write_b32 a254, v134
    v_cvt_pk_bf16_f32 v136, v136, v137
    v_accvgpr_write_b32 a255, v136
    v_cvt_pk_bf16_f32 v104, v130, v131
    v_cvt_pk_bf16_f32 v105, v132, v133
    v_permlane32_swap_b32 v255, v254
    v_max_f32 v255, v255, v254
    v_mov_b32 v254, v255
    v_exp_f32 v142, v142
    v_mul_f32_dpp v190, v118, v154 quad_perm:[0,1,2,3] row_mask:0x2 bank_mask:0xf
    v_permlane16_swap_b32 v255, v254
    v_max_f32 v255, v255, v254
    v_sub_f32 v126, v126, v255
    v_exp_f32 v126, v126
    v_sub_f32 v127, v127, v255
    v_exp_f32 v127, v127
    v_sub_f32 v128, v128, v255
    s_waitcnt lgkmcnt(0)
    v_mfma_f32_16x16x16_bf16 v[130:133], a[238:239], v[178:179], v[206:209]
    v_cvt_pk_bf16_f32 v174, v126, v127
    v_exp_f32 v128, v128
    v_mfma_f32_16x16x16_bf16 v[134:137], v[88:89], v[178:179], v[206:209]
    v_sub_f32 v129, v129, v255
    v_exp_f32 v129, v129
    v_mfma_f32_16x16x16_bf16 v[138:141], v[112:113], v[178:179], v[206:209]
    ds_read_b128 v[186:189], v0 offset:20480
    ds_read_b128 v[118:121], v1 offset:20480
    ds_read_b128 v[234:237], v0 offset:20608
    ds_read_b128 v[158:161], v1 offset:20608
    ds_read_b128 v[182:185], v0 offset:20736
    ds_read_b128 v[206:209], v1 offset:20736
    v_cvt_pk_bf16_f32 v130, v130, v131
    v_accvgpr_write_b32 a238, v130
    v_cvt_pk_bf16_f32 v132, v132, v133
    v_accvgpr_write_b32 a239, v132
    v_cvt_pk_bf16_f32 v88, v134, v135
    v_cvt_pk_bf16_f32 v89, v136, v137
    v_cvt_pk_bf16_f32 v112, v138, v139
    v_cvt_pk_bf16_f32 v113, v140, v141
    v_cvt_pk_bf16_f32 v175, v128, v129
    v_sub_f32 v170, v170, v255
    v_exp_f32 v170, v170
    v_sub_f32 v171, v171, v255
    v_exp_f32 v171, v171
    s_waitcnt lgkmcnt(4)
    v_mfma_f32_16x16x32_bf16 v[130:133], a[72:75], v[186:189], 0
    s_waitcnt lgkmcnt(3)
    v_cvt_pk_bf16_f32 v176, v170, v171
    v_sub_f32 v172, v172, v255
    v_mfma_f32_16x16x32_bf16 v[130:133], a[76:79], v[118:121], v[130:133]
    s_waitcnt lgkmcnt(2)
    v_exp_f32 v172, v172
    v_mfma_f32_16x16x32_bf16 v[130:133], a[80:83], v[234:237], v[130:133]
    s_waitcnt lgkmcnt(1)
    v_sub_f32 v173, v173, v255
    v_sub_f32 v162, v162, v255
    v_mfma_f32_16x16x32_bf16 v[130:133], a[84:87], v[158:161], v[130:133]
    s_waitcnt lgkmcnt(0)
    v_exp_f32 v173, v173
    v_mfma_f32_16x16x32_bf16 v[130:133], a[88:91], v[182:185], v[130:133]
    v_cvt_pk_bf16_f32 v177, v172, v173
    v_sub_f32 v163, v163, v255
    v_mfma_f32_16x16x32_bf16 v[130:133], a[92:95], v[206:209], v[130:133]
    v_exp_f32 v162, v162
    v_mfma_f32_16x16x32_bf16 v[134:137], a[96:99], v[186:189], 0
    v_exp_f32 v163, v163
    v_mfma_f32_16x16x32_bf16 v[134:137], a[100:103], v[118:121], v[134:137]
    v_sub_f32 v164, v164, v255
    v_sub_f32 v165, v165, v255
    v_mfma_f32_16x16x32_bf16 v[134:137], a[104:107], v[234:237], v[134:137]
    v_exp_f32 v164, v164
    v_mfma_f32_16x16x32_bf16 v[134:137], a[108:111], v[158:161], v[134:137]
    v_exp_f32 v165, v165
    v_mfma_f32_16x16x32_bf16 v[134:137], a[112:115], v[182:185], v[134:137]
    v_sub_f32 v122, v122, v255
    v_cvt_pk_bf16_f32 v39, v142, 0
    v_mfma_f32_16x16x32_bf16 v[134:137], a[116:119], v[206:209], v[134:137]
    v_exp_f32 v122, v122
    v_mfma_f32_16x16x32_bf16 v[138:141], v[28:31], v[36:39], 0
    v_mul_f32_dpp v190, v194, v154 quad_perm:[0,1,2,3] row_mask:0x4 bank_mask:0xf
    v_cvt_pk_bf16_f32 v190, v190, v190
    v_mfma_f32_16x16x32_bf16 v[138:141], v[28:31], v[218:221], v[138:141]
    ds_write_b16 v7, v190
    v_mfma_f32_16x16x32_bf16 v[178:181], v[166:169], v[36:39], 0
    v_add_u32 v7, 16, v7
    v_mfma_f32_16x16x32_bf16 v[178:181], v[150:153], v[218:221], v[178:181]
    v_mfma_f32_16x16x32_bf16 v[142:145], v[226:229], v[36:39], 0
    v_mfma_f32_16x16x32_bf16 v[142:145], v[146:149], v[218:221], v[142:145]
    v_mfma_f32_16x16x32_bf16 v[126:129], v[114:117], v[36:39], 0
    v_cvt_pk_bf16_f32 v36, v162, v163
    v_cvt_pk_bf16_f32 v37, v164, v165
    v_mfma_f32_16x16x32_bf16 v[126:129], v[214:217], v[218:221], v[126:129]
    v_rcp_f32 v138, v138
    v_mfma_f32_16x16x32_bf16 v[170:173], a[120:123], v[186:189], 0
    v_mul_f32 v178, v138, v178
    v_mul_f32 v179, v138, v179
    v_mfma_f32_16x16x32_bf16 v[170:173], a[124:127], v[118:121], v[170:173]
    v_cvt_pk_bf16_f32 v162, v178, v179
    v_mul_f32 v180, v138, v180
    v_mfma_f32_16x16x32_bf16 v[170:173], a[128:131], v[234:237], v[170:173]
    v_mul_f32 v181, v138, v181
    v_cvt_pk_bf16_f32 v163, v180, v181
    v_mfma_f32_16x16x32_bf16 v[170:173], a[132:135], v[158:161], v[170:173]
    v_mul_f32 v142, v138, v142
    v_mul_f32 v143, v138, v143
    v_mfma_f32_16x16x32_bf16 v[170:173], a[136:139], v[182:185], v[170:173]
    v_cvt_pk_bf16_f32 v164, v142, v143
    v_mul_f32 v144, v138, v144
    v_mfma_f32_16x16x32_bf16 v[170:173], a[140:143], v[206:209], v[170:173]
    v_mul_f32 v145, v138, v145
    v_cvt_pk_bf16_f32 v165, v144, v145
    v_mfma_f32_16x16x32_bf16 v[142:145], a[0:3], v[186:189], 0
    ds_write_b128 v3, v[162:165] offset:6144
    v_mfma_f32_16x16x32_bf16 v[142:145], a[4:7], v[118:121], v[142:145]
    v_mul_f32 v126, v138, v126
    v_mul_f32 v127, v138, v127
    v_mfma_f32_16x16x32_bf16 v[142:145], a[8:11], v[234:237], v[142:145]
    v_cvt_pk_bf16_f32 v254, v126, v127
    v_mul_f32 v128, v138, v128
    v_mfma_f32_16x16x32_bf16 v[142:145], a[12:15], v[158:161], v[142:145]
    v_mul_f32 v129, v138, v129
    v_cvt_pk_bf16_f32 v255, v128, v129
    v_mfma_f32_16x16x32_bf16 v[142:145], a[16:19], v[182:185], v[142:145]
    ds_write_b64 v4, v[254:255] offset:10240
    v_mfma_f32_16x16x32_bf16 v[142:145], a[20:23], v[206:209], v[142:145]
    v_cvt_pk_bf16_f32 v39, v122, 0
    v_mfma_f32_16x16x32_bf16 v[126:129], a[24:27], v[186:189], 0
    v_mfma_f32_16x16x32_bf16 v[126:129], a[28:31], v[118:121], v[126:129]
    v_mfma_f32_16x16x32_bf16 v[162:165], v[28:31], v[36:39], 0
    v_mfma_f32_16x16x32_bf16 v[162:165], v[28:31], v[174:177], v[162:165]
    v_mfma_f32_16x16x32_bf16 v[138:141], v[166:169], v[36:39], 0
    v_mfma_f32_16x16x32_bf16 v[138:141], v[150:153], v[174:177], v[138:141]
    v_mfma_f32_16x16x32_bf16 v[178:181], v[226:229], v[36:39], 0
    v_mfma_f32_16x16x32_bf16 v[178:181], v[146:149], v[174:177], v[178:181]
    v_mfma_f32_16x16x32_bf16 v[166:169], v[114:117], v[36:39], 0
    v_mfma_f32_16x16x32_bf16 v[166:169], v[214:217], v[174:177], v[166:169]
    v_mfma_f32_16x16x32_bf16 v[126:129], a[32:35], v[234:237], v[126:129]
    v_mfma_f32_16x16x32_bf16 v[126:129], a[36:39], v[158:161], v[126:129]
    v_rcp_f32 v162, v162
    v_mfma_f32_16x16x32_bf16 v[126:129], a[40:43], v[182:185], v[126:129]
    v_mul_f32 v138, v162, v138
    v_mul_f32 v139, v162, v139
    v_mfma_f32_16x16x32_bf16 v[126:129], a[44:47], v[206:209], v[126:129]
    v_cvt_pk_bf16_f32 v114, v138, v139
    v_mul_f32 v140, v162, v140
    v_mul_f32 v141, v162, v141
    v_cvt_pk_bf16_f32 v115, v140, v141
    v_mul_f32 v178, v162, v178
    v_mul_f32 v179, v162, v179
    v_cvt_pk_bf16_f32 v116, v178, v179
    v_mul_f32 v180, v162, v180
    v_mul_f32 v181, v162, v181
    v_cvt_pk_bf16_f32 v117, v180, v181
    ds_write_b128 v3, v[114:117] offset:12288
    v_mul_f32 v166, v162, v166
    v_mul_f32 v167, v162, v167
    v_cvt_pk_bf16_f32 v254, v166, v167
    v_mul_f32 v168, v162, v168
    v_mul_f32 v169, v162, v169
    v_cvt_pk_bf16_f32 v255, v168, v169
    v_xor_b32 v3, 65536, v3
    ds_write_b64 v4, v[254:255] offset:16384
    v_xor_b32 v4, 65536, v4
    s_waitcnt lgkmcnt(0)
    s_barrier
    s_waitcnt lgkmcnt(0)
    s_cmp_eq_u32 s45, 0
    s_cbranch_scc1 L_drain
    s_max_u32 s3, s37, s44
    s_cmp_gt_u32 s3, 0x42000000
    s_cbranch_scc1 L_safe
    v_cvt_pk_f16_f32 v194, v130, v131
    v_pk_mul_f16 v191, v194, v194
    v_cvt_pk_f16_f32 v195, v132, v133
    v_pk_fma_f16 v191, v195, v195, v191
    v_cvt_pk_f16_f32 v196, v134, v135
    v_pk_fma_f16 v191, v196, v196, v191
    v_cvt_pk_f16_f32 v197, v136, v137
    v_pk_fma_f16 v191, v197, v197, v191
    v_cvt_pk_f16_f32 v148, v170, v171
    v_pk_fma_f16 v191, v148, v148, v191
    v_cvt_pk_f16_f32 v149, v172, v173
    v_pk_fma_f16 v191, v149, v149, v191
    v_and_b32 v146, 16, v2
    v_sub_u32 v5, v5, v146
    s_nop 7
    s_branch L_go
L_safe:
    v_fma_f32 v174, v130, v130, s32
    v_fmac_f32 v174, v131, v131
    v_fmac_f32 v174, v132, v132
    v_fmac_f32 v174, v133, v133
    s_nop 7
    s_and_b32 s3, s2, 0xf8
    s_add_u32 s64, s42, s3
    s_addc_u32 s65, s43, 0
    s_mov_b32 s67, 0x00020000
    s_cmp_eq_u32 s16, 1
    s_cbranch_scc1 L_loop_safe1
    s_cmp_eq_u32 s16, 2
    s_cbranch_scc1 L_loop_safe2
    s_cmp_eq_u32 s16, 3
    s_cbranch_scc1 L_loop_safe3
    s_branch L_loop_safe0
.p2align 6
L_loop_safe0:
    v_mfma_f32_16x16x32_bf16 v[190:193], a[48:51], v[186:189], 0
    s_add_u32 s12, s40, s27
    ds_read_b128 v[146:149], v2 offset:18432
    ds_read_b128 v[178:181], v2 offset:19456
    v_mfma_f32_16x16x32_bf16 v[190:193], a[52:55], v[118:121], v[190:193]
    s_addc_u32 s13, s41, 0
    v_fmac_f32 v174, v134, v134
    v_fmac_f32 v174, v135, v135
    v_mfma_f32_16x16x32_bf16 v[190:193], a[56:59], v[234:237], v[190:193]
    s_sub_u32 s14, s36, s27
    v_fmac_f32 v174, v136, v136
    v_fmac_f32 v174, v137, v137
    v_mfma_f32_16x16x32_bf16 v[190:193], a[60:63], v[158:161], v[190:193]
    s_cmp_ge_u32 s18, 2
    v_fmac_f32 v174, v170, v170
    v_fmac_f32 v174, v171, v171
    v_mfma_f32_16x16x32_bf16 v[190:193], a[64:67], v[182:185], v[190:193]
    s_cselect_b32 s14, s14, 0
    v_fmac_f32 v174, v172, v172
    v_fmac_f32 v174, v173, v173
    v_mfma_f32_16x16x32_bf16 v[190:193], a[68:71], v[206:209], v[190:193]
    s_sub_u32 s82, s72, s71
    v_fma_f32 v254, v142, v142, s32
    v_fmac_f32 v254, v143, v143
    v_mfma_f32_16x16x32_bf16 v[194:197], v[186:189], a[144:147], 0
    s_mul_i32 s74, s82, 336
    v_fmac_f32 v254, v144, v144
    v_fmac_f32 v254, v145, v145
    v_mfma_f32_16x16x32_bf16 v[194:197], v[118:121], a[148:151], v[194:197]
    s_mul_i32 s75, s82, 272
    v_fmac_f32 v254, v126, v126
    v_fmac_f32 v254, v127, v127
    v_mfma_f32_16x16x32_bf16 v[194:197], v[234:237], a[152:155], v[194:197]
    s_waitcnt lgkmcnt(0)
    v_fmac_f32 v254, v128, v128
    v_fmac_f32 v254, v129, v129
    v_mfma_f32_16x16x32_bf16 v[198:201], v[32:35], v[146:149], 0
    s_mul_i32 s76, s82, 16
    v_fmac_f32 v254, v190, v190
    v_fmac_f32 v254, v191, v191
    v_mfma_f32_16x16x32_bf16 v[198:201], v[32:35], v[178:181], v[198:201]
    s_add_u32 s34, s18, 2
    v_fmac_f32 v254, v192, v192
    v_fmac_f32 v254, v193, v193
    v_mfma_f32_16x16x32_bf16 v[194:197], v[158:161], a[156:159], v[194:197]
    s_add_u32 s8, s60, s23
    v_cvt_pk_bf16_f32 v36, v254, v174
    s_addc_u32 s9, s61, 0
    v_mfma_f32_16x16x32_bf16 v[194:197], v[182:185], a[160:163], v[194:197]
    s_sub_u32 s10, s36, s23
    v_mul_f32 v254, 0x3baaaaab, v198
    v_mul_f32 v255, 0x3baaaaab, v199
    v_mfma_f32_16x16x32_bf16 v[210:213], v[32:35], v[36:39], 0
    s_cmp_le_u32 s34, s45
    v_rsq_f32 v254, v254
    v_mfma_f32_16x16x32_bf16 v[194:197], v[206:209], a[164:167], v[194:197]
    s_cselect_b32 s10, s10, 0
    ds_read_b128 v[214:217], v0 offset:26624
    v_mul_f32 v148, 0x3baaaaab, v200
    v_mfma_f32_16x16x32_bf16 v[174:177], v[186:189], a[168:171], 0
    s_add_u32 m0, s28, 0
    ds_read_b128 v[198:201], v1 offset:26624
    v_mul_f32 v122, v254, v122
    v_mfma_f32_16x16x32_bf16 v[174:177], v[118:121], a[172:175], v[174:177]
    s_mov_b32 s27, s26
    ds_read_b128 v[218:221], v0 offset:26752
    v_cvt_pk_bf16_f32 v146, v194, v195
    v_mfma_f32_16x16x32_bf16 v[174:177], v[234:237], a[176:179], v[174:177]
    s_mov_b32 s26, s25
    ds_read_b128 v[222:225], v1 offset:26752
    v_cvt_pk_bf16_f32 v147, v196, v197
    v_mfma_f32_16x16x32_bf16 v[174:177], v[158:161], a[180:183], v[174:177]
    s_mov_b32 s25, s24
    v_rsq_f32 v211, v211
    v_mfma_f32_16x16x32_bf16 v[174:177], v[182:185], a[184:187], v[174:177]
    s_mov_b32 s24, s23
    v_rsq_f32 v210, v210
    v_mfma_f32_16x16x32_bf16 v[174:177], v[206:209], a[188:191], v[174:177]
    s_ff1_i32_b32 s80, s100
    v_mul_f32 v210, s31, v210
    v_mul_f32 v130, v211, v130
    v_mul_f32 v131, v211, v131
    v_cvt_pk_f16_f32 v178, v130, v131
    v_mfma_f32_16x16x32_bf16 v[194:197], v[186:189], a[192:195], 0
    s_waitcnt lgkmcnt(3)
    ds_read_b128 v[186:189], v0 offset:26880
    v_cvt_pk_bf16_f32 v174, v174, v175
    v_mfma_f32_16x16x32_bf16 v[194:197], v[118:121], a[196:199], v[194:197]
    s_mov_b32 s71, s72
    ds_read_b128 v[226:229], v1 offset:26880
    v_cvt_pk_bf16_f32 v175, v176, v177
    v_mfma_f32_16x16x32_bf16 v[194:197], v[234:237], a[200:203], v[194:197]
    s_mov_b32 s72, s73
    v_mul_f32 v132, v211, v132
    v_mul_f32 v133, v211, v133
    v_mfma_f32_16x16x32_bf16 v[194:197], v[158:161], a[204:207], v[194:197]
    s_waitcnt lgkmcnt(2)
    v_cvt_pk_f16_f32 v179, v132, v133
    v_mul_f32 v134, v211, v134
    v_mfma_f32_16x16x32_bf16 v[194:197], v[182:185], a[208:211], v[194:197]
    v_mul_f32 v135, v211, v135
    v_cvt_pk_f16_f32 v180, v134, v135
    v_mfma_f32_16x16x32_bf16 v[194:197], v[206:209], a[212:215], v[194:197]
    v_mul_f32 v136, v211, v136
    v_mul_f32 v137, v211, v137
    v_mfma_f32_16x16x32_bf16 v[130:133], a[72:75], v[214:217], 0
    v_cvt_pk_f16_f32 v181, v136, v137
    v_mul_f32 v170, v211, v170
    v_mfma_f32_16x16x32_bf16 v[130:133], a[76:79], v[198:201], v[130:133]
    v_mul_f32 v171, v211, v171
    v_cvt_pk_f16_f32 v120, v170, v171
    v_mfma_f32_16x16x32_bf16 v[130:133], a[80:83], v[218:221], v[130:133]
    s_waitcnt lgkmcnt(1)
    v_cvt_pk_bf16_f32 v134, v194, v195
    v_cvt_pk_bf16_f32 v135, v196, v197
    v_mfma_f32_16x16x32_bf16 v[130:133], a[84:87], v[222:225], v[130:133]
    s_waitcnt lgkmcnt(0)
    v_mul_f32 v172, v211, v172
    v_mul_f32 v173, v211, v173
    v_mfma_f32_16x16x32_bf16 v[130:133], a[88:91], v[186:189], v[130:133]
    v_cvt_pk_f16_f32 v121, v172, v173
    v_mul_f32 v142, v210, v142
    v_mfma_f32_16x16x32_bf16 v[130:133], a[92:95], v[226:229], v[130:133]
    v_mul_f32 v143, v210, v143
    v_cvt_pk_f16_f32 v194, v142, v143
    v_mfma_f32_16x16x32_bf16 v[158:161], a[96:99], v[214:217], 0
    v_mul_f32 v144, v210, v144
    v_mul_f32 v145, v210, v145
    v_mfma_f32_16x16x32_bf16 v[158:161], a[100:103], v[198:201], v[158:161]
    v_cvt_pk_f16_f32 v195, v144, v145
    v_mul_f32 v126, v210, v126
    v_mfma_f32_16x16x32_bf16 v[158:161], a[104:107], v[218:221], v[158:161]
    v_mul_f32 v127, v210, v127
    v_cvt_pk_f16_f32 v196, v126, v127
    v_mfma_f32_16x16x32_bf16 v[158:161], a[108:111], v[222:225], v[158:161]
    v_mul_f32 v128, v210, v128
    v_mul_f32 v129, v210, v129
    v_mfma_f32_16x16x32_bf16 v[158:161], a[112:115], v[186:189], v[158:161]
    v_cvt_pk_f16_f32 v197, v128, v129
    v_mul_f32 v190, v210, v190
    v_mfma_f32_16x16x32_bf16 v[158:161], a[116:119], v[226:229], v[158:161]
    v_mul_f32 v191, v210, v191
    v_cvt_pk_f16_f32 v118, v190, v191
    v_mfma_f32_16x16x32_bf16 v[142:145], a[120:123], v[214:217], 0
    v_mul_f32 v192, v210, v192
    v_mul_f32 v193, v210, v193
    v_mfma_f32_16x16x32_bf16 v[142:145], a[124:127], v[198:201], v[142:145]
    v_cvt_pk_f16_f32 v119, v192, v193
    v_fma_f32 v149, v130, v130, s32
    v_mfma_f32_16x16x32_bf16 v[142:145], a[128:131], v[218:221], v[142:145]
    v_fmac_f32 v149, v131, v131
    v_fmac_f32 v149, v132, v132
    v_mfma_f32_16x16x32_bf16 v[142:145], a[132:135], v[222:225], v[142:145]
    v_fmac_f32 v149, v133, v133
    v_fmac_f32 v149, v158, v158
    v_mfma_f32_16x16x32_bf16 v[142:145], a[136:139], v[186:189], v[142:145]
    v_fmac_f32 v149, v159, v159
    v_fmac_f32 v149, v160, v160
    v_mfma_f32_16x16x32_bf16 v[142:145], a[140:143], v[226:229], v[142:145]
    v_fmac_f32 v149, v161, v161
    v_mul_f32 v123, v254, v123
    v_mfma_f32_16x16x32_bf16 v[170:173], a[0:3], v[214:217], 0
    v_rsq_f32 v255, v255
    v_mfma_f32_16x16x32_bf16 v[170:173], a[4:7], v[198:201], v[170:173]
    v_rsq_f32 v148, v148
    v_mfma_f32_16x16x32_bf16 v[170:173], a[8:11], v[218:221], v[170:173]
    v_mul_f32 v150, v148, v150
    v_fmac_f32 v149, v142, v142
    v_mfma_f32_16x16x32_bf16 v[170:173], a[12:15], v[222:225], v[170:173]
    v_fmac_f32 v149, v143, v143
    v_fmac_f32 v149, v144, v144
    v_mfma_f32_16x16x32_bf16 v[170:173], a[16:19], v[186:189], v[170:173]
    v_fmac_f32 v149, v145, v145
    v_mul_f32 v151, v148, v151
    v_mfma_f32_16x16x32_bf16 v[170:173], a[20:23], v[226:229], v[170:173]
    v_cvt_pk_bf16_f32 v126, v150, v151
    v_mul_f32 v152, v148, v152
    v_mfma_f32_16x16x32_bf16 v[182:185], a[24:27], v[214:217], 0
    v_mul_f32 v153, v148, v153
    v_cvt_pk_bf16_f32 v127, v152, v153
    v_mfma_f32_16x16x32_bf16 v[182:185], a[28:31], v[198:201], v[182:185]
    v_mul_f32 v162, v148, v162
    v_mul_f32 v163, v148, v163
    v_mfma_f32_16x16x32_bf16 v[182:185], a[32:35], v[218:221], v[182:185]
    v_fma_f32 v136, v170, v170, s32
    v_fmac_f32 v136, v171, v171
    v_mfma_f32_16x16x32_bf16 v[182:185], a[36:39], v[222:225], v[182:185]
    v_fmac_f32 v136, v172, v172
    v_fmac_f32 v136, v173, v173
    v_mfma_f32_16x16x32_bf16 v[182:185], a[40:43], v[186:189], v[182:185]
    v_cvt_pk_bf16_f32 v128, v162, v163
    v_mul_f32 v164, v148, v164
    v_mfma_f32_16x16x32_bf16 v[182:185], a[44:47], v[226:229], v[182:185]
    v_mul_f32 v165, v148, v165
    v_cvt_pk_bf16_f32 v129, v164, v165
    v_mfma_f32_16x16x32_bf16 v[162:165], a[48:51], v[214:217], 0
    buffer_store_dwordx4 v[126:129], v17, s[12:15], 0 offen nt
    v_mul_f32 v138, v148, v138
    v_mul_f32 v139, v148, v139
    v_cvt_pk_bf16_f32 v176, v138, v139
    v_mul_f32 v140, v148, v140
    v_mfma_f32_16x16x32_bf16 v[162:165], a[52:55], v[198:201], v[162:165]
    v_fmac_f32 v136, v182, v182
    v_fmac_f32 v136, v183, v183
    v_mfma_f32_16x16x32_bf16 v[162:165], a[56:59], v[218:221], v[162:165]
    v_fmac_f32 v136, v184, v184
    v_fmac_f32 v136, v185, v185
    v_mfma_f32_16x16x32_bf16 v[162:165], a[60:63], v[222:225], v[162:165]
    v_mul_f32 v141, v148, v141
    v_cvt_pk_bf16_f32 v177, v140, v141
    v_mfma_f32_16x16x32_bf16 v[162:165], a[64:67], v[186:189], v[162:165]
    v_cvt_pk_bf16_f32 v190, v122, v123
    v_mul_f32 v124, v254, v124
    v_mfma_f32_16x16x32_bf16 v[162:165], a[68:71], v[226:229], v[162:165]
    v_mul_f32 v125, v254, v125
    v_cvt_pk_bf16_f32 v191, v124, v125
    v_mfma_f32_16x16x32_bf16 v[122:125], v[214:217], a[144:147], 0
    v_mul_f32 v154, v254, v154
    v_mul_f32 v155, v254, v155
    v_mfma_f32_16x16x32_bf16 v[122:125], v[198:201], a[148:151], v[122:125]
    v_cvt_pk_bf16_f32 v192, v154, v155
    v_mul_f32 v156, v254, v156
    v_mfma_f32_16x16x32_bf16 v[122:125], v[218:221], a[152:155], v[122:125]
    v_fmac_f32 v136, v162, v162
    v_fmac_f32 v136, v163, v163
    v_mfma_f32_16x16x32_bf16 v[122:125], v[222:225], a[156:159], v[122:125]
    v_fmac_f32 v136, v164, v164
    v_fmac_f32 v136, v165, v165
    v_mfma_f32_16x16x32_bf16 v[122:125], v[186:189], a[160:163], v[122:125]
    v_cvt_pk_bf16_f32 v36, v136, v149
    v_mul_f32 v157, v254, v157
    v_mfma_f32_16x16x32_bf16 v[122:125], v[226:229], a[164:167], v[122:125]
    ds_read_b128 v[206:209], v0 offset:32768
    v_cvt_pk_bf16_f32 v193, v156, v157
    v_mfma_f32_16x16x32_bf16 v[154:157], v[32:35], v[36:39], 0
    v_mul_f32 v202, v254, v202
    v_mul_f32 v203, v254, v203
    v_mfma_f32_16x16x32_bf16 v[126:129], v[214:217], a[168:171], 0
    ds_read_b128 v[210:213], v1 offset:32768
    v_cvt_pk_bf16_f32 v234, v202, v203
    v_mfma_f32_16x16x32_bf16 v[126:129], v[198:201], a[172:175], v[126:129]
    ds_read_b128 v[238:241], v0 offset:32896
    v_cvt_pk_bf16_f32 v148, v122, v123
    v_mfma_f32_16x16x32_bf16 v[126:129], v[218:221], a[176:179], v[126:129]
    ds_read_b128 v[242:245], v1 offset:32896
    v_cvt_pk_bf16_f32 v149, v124, v125
    v_mfma_f32_16x16x32_bf16 v[126:129], v[222:225], a[180:183], v[126:129]
    v_rsq_f32 v155, v155
    v_mfma_f32_16x16x32_bf16 v[126:129], v[186:189], a[184:187], v[126:129]
    buffer_store_dwordx2 v[176:177], v20, s[12:15], 0 offen nt
    v_rsq_f32 v154, v154
    v_mfma_f32_16x16x32_bf16 v[126:129], v[226:229], a[188:191], v[126:129]
    s_waitcnt lgkmcnt(3)
    v_mul_f32 v154, s31, v154
    v_mul_f32 v130, v155, v130
    v_mul_f32 v131, v155, v131
    v_cvt_pk_f16_f32 v138, v130, v131
    v_mfma_f32_16x16x32_bf16 v[122:125], v[214:217], a[192:195], 0
    ds_read_b128 v[214:217], v0 offset:33024
    v_mul_f32 v132, v155, v132
    v_mfma_f32_16x16x32_bf16 v[122:125], v[198:201], a[196:199], v[122:125]
    s_waitcnt lgkmcnt(3)
    ds_read_b128 v[198:201], v1 offset:33024
    v_cvt_pk_bf16_f32 v176, v126, v127
    v_mfma_f32_16x16x32_bf16 v[122:125], v[218:221], a[200:203], v[122:125]
    s_waitcnt lgkmcnt(3)
    v_cvt_pk_bf16_f32 v177, v128, v129
    v_mul_f32 v133, v155, v133
    v_mfma_f32_16x16x32_bf16 v[122:125], v[222:225], a[204:207], v[122:125]
    s_waitcnt vmcnt(2)
    ds_write_b16 v8, v45 offset:512
    v_mfma_f32_16x16x32_bf16 v[122:125], v[186:189], a[208:211], v[122:125]
    s_waitcnt lgkmcnt(3)
    v_mov_b32 v45, 1
    v_cvt_pk_f16_f32 v139, v132, v133
    v_mfma_f32_16x16x32_bf16 v[122:125], v[226:229], a[212:215], v[122:125]
    v_mul_f32 v158, v155, v158
    v_mul_f32 v159, v155, v159
    v_mfma_f32_16x16x32_bf16 v[130:133], a[72:75], v[206:209], 0
    v_cvt_pk_f16_f32 v140, v158, v159
    v_mul_f32 v160, v155, v160
    v_mfma_f32_16x16x32_bf16 v[130:133], a[76:79], v[210:213], v[130:133]
    v_mul_f32 v161, v155, v161
    v_cvt_pk_f16_f32 v141, v160, v161
    v_mfma_f32_16x16x32_bf16 v[130:133], a[80:83], v[238:241], v[130:133]
    s_waitcnt lgkmcnt(2)
    v_cvt_pk_bf16_f32 v136, v122, v123
    v_cvt_pk_bf16_f32 v137, v124, v125
    v_mfma_f32_16x16x32_bf16 v[130:133], a[84:87], v[242:245], v[130:133]
    s_waitcnt lgkmcnt(1)
    v_mul_f32 v142, v155, v142
    v_mul_f32 v143, v155, v143
    v_mfma_f32_16x16x32_bf16 v[130:133], a[88:91], v[214:217], v[130:133]
    v_cvt_pk_f16_f32 v128, v142, v143
    v_mul_f32 v144, v155, v144
    v_mfma_f32_16x16x32_bf16 v[130:133], a[92:95], v[198:201], v[130:133]
    s_waitcnt lgkmcnt(0)
    v_mul_f32 v145, v155, v145
    v_cvt_pk_f16_f32 v129, v144, v145
    v_mfma_f32_16x16x32_bf16 v[218:221], a[96:99], v[206:209], 0
    s_barrier
    v_mul_f32 v170, v154, v170
    v_mul_f32 v171, v154, v171
    v_mfma_f32_16x16x32_bf16 v[218:221], a[100:103], v[210:213], v[218:221]
    v_cvt_pk_f16_f32 v150, v170, v171
    v_mul_f32 v172, v154, v172
    v_mfma_f32_16x16x32_bf16 v[218:221], a[104:107], v[238:241], v[218:221]
    v_mul_f32 v173, v154, v173
    v_cvt_pk_f16_f32 v151, v172, v173
    v_mfma_f32_16x16x32_bf16 v[218:221], a[108:111], v[242:245], v[218:221]
    buffer_load_dwordx4 v10, s[8:11], 0 offen nt lds
    ds_read_u16 v202, v9 offset:512
    v_mfma_f32_16x16x32_bf16 v[218:221], a[112:115], v[214:217], v[218:221]
    s_add_u32 m0, s28, 4096
    v_mul_f32 v182, v154, v182
    v_mul_f32 v183, v154, v183
    v_mfma_f32_16x16x32_bf16 v[218:221], a[116:119], v[198:201], v[218:221]
    v_cvt_pk_f16_f32 v152, v182, v183
    v_mul_f32 v184, v154, v184
    v_mfma_f32_16x16x32_bf16 v[226:229], a[120:123], v[206:209], 0
    v_mul_f32 v185, v154, v185
    v_cvt_pk_f16_f32 v153, v184, v185
    v_mfma_f32_16x16x32_bf16 v[226:229], a[124:127], v[210:213], v[226:229]
    v_mul_f32 v162, v154, v162
    v_mul_f32 v163, v154, v163
    v_mfma_f32_16x16x32_bf16 v[226:229], a[128:131], v[238:241], v[226:229]
    buffer_load_dwordx4 v11, s[8:11], 0 offen nt lds
    v_cvt_pk_f16_f32 v126, v162, v163
    v_mfma_f32_16x16x32_bf16 v[226:229], a[132:135], v[242:245], v[226:229]
    s_add_u32 m0, s28, 8192
    v_mul_f32 v164, v154, v164
    v_mul_f32 v165, v154, v165
    v_mfma_f32_16x16x32_bf16 v[226:229], a[136:139], v[214:217], v[226:229]
    v_cvt_pk_f16_f32 v127, v164, v165
    v_mul_f32 v204, v254, v204
    v_mfma_f32_16x16x32_bf16 v[226:229], a[140:143], v[198:201], v[226:229]
    s_waitcnt lgkmcnt(0)
    v_readfirstlane_b32 s77, v202
    v_mul_f32 v205, v254, v205
    v_mfma_f32_16x16x32_bf16 v[162:165], a[0:3], v[206:209], 0
    v_cvt_pk_bf16_f32 v235, v204, v205
    v_fma_f32 v236, v130, v130, s32
    v_mfma_f32_16x16x32_bf16 v[162:165], a[4:7], v[210:213], v[162:165]
    buffer_load_dwordx4 v12, s[8:11], 0 offen nt lds
    v_fmac_f32 v236, v131, v131
    v_mfma_f32_16x16x32_bf16 v[162:165], a[8:11], v[238:241], v[162:165]
    s_add_u32 m0, s28, 12288
    v_fmac_f32 v236, v132, v132
    v_fmac_f32 v236, v133, v133
    v_mfma_f32_16x16x32_bf16 v[162:165], a[12:15], v[242:245], v[162:165]
    s_xor_b32 s28, s28, 65536
    v_fmac_f32 v236, v218, v218
    v_fmac_f32 v236, v219, v219
    v_mfma_f32_16x16x32_bf16 v[162:165], a[16:19], v[214:217], v[162:165]
    v_fmac_f32 v236, v220, v220
    v_fmac_f32 v236, v221, v221
    v_mfma_f32_16x16x32_bf16 v[162:165], a[20:23], v[198:201], v[162:165]
    v_fmac_f32 v236, v226, v226
    v_fmac_f32 v236, v227, v227
    v_mfma_f32_16x16x32_bf16 v[246:249], a[24:27], v[206:209], 0
    buffer_load_dwordx4 v13, s[8:11], 0 offen nt lds
    v_fmac_f32 v236, v228, v228
    v_mfma_f32_16x16x32_bf16 v[246:249], a[28:31], v[210:213], v[246:249]
    s_mov_b32 m0, s29
    v_fmac_f32 v236, v229, v229
    v_fma_f32 v237, v162, v162, s32
    v_mfma_f32_16x16x32_bf16 v[246:249], a[32:35], v[238:241], v[246:249]
    s_xor_b32 s29, s29, s30
    v_fmac_f32 v237, v163, v163
    v_fmac_f32 v237, v164, v164
    v_mfma_f32_16x16x32_bf16 v[246:249], a[36:39], v[242:245], v[246:249]
    s_add_u32 s19, s19, s20
    v_fmac_f32 v237, v165, v165
    v_mul_f32 v114, v255, v114
    v_mfma_f32_16x16x32_bf16 v[246:249], a[40:43], v[214:217], v[246:249]
    s_add_u32 s23, s23, s21
    v_mul_f32 v115, v255, v115
    v_cvt_pk_bf16_f32 v114, v114, v115
    v_mfma_f32_16x16x32_bf16 v[246:249], a[44:47], v[198:201], v[246:249]
    buffer_load_dwordx4 v14, s[8:11], 0 offen nt lds
    v_mul_f32 v116, v255, v116
    v_mfma_f32_16x16x32_bf16 v[122:125], a[48:51], v[206:209], 0
    s_cmp_ge_u32 s19, 72
    v_mul_f32 v117, v255, v117
    v_cvt_pk_bf16_f32 v115, v116, v117
    v_mfma_f32_16x16x32_bf16 v[122:125], a[52:55], v[210:213], v[122:125]
    s_cselect_b32 s34, 72, 0
    v_fmac_f32 v237, v246, v246
    v_fmac_f32 v237, v247, v247
    v_mfma_f32_16x16x32_bf16 v[122:125], a[56:59], v[238:241], v[122:125]
    s_cselect_b32 s35, s22, 0
    v_fmac_f32 v237, v248, v248
    v_fmac_f32 v237, v249, v249
    v_mfma_f32_16x16x32_bf16 v[122:125], a[60:63], v[242:245], v[122:125]
    s_sub_u32 s19, s19, s34
    v_mul_f32 v166, v255, v166
    v_mul_f32 v167, v255, v167
    v_mfma_f32_16x16x32_bf16 v[122:125], a[64:67], v[214:217], v[122:125]
    buffer_store_dwordx4 v[190:193], v15, s[12:15], 0 offen nt
    v_cvt_pk_bf16_f32 v116, v166, v167
    v_mul_f32 v168, v255, v168
    v_mul_f32 v169, v255, v169
    v_cvt_pk_bf16_f32 v117, v168, v169
    v_mfma_f32_16x16x32_bf16 v[122:125], a[68:71], v[198:201], v[122:125]
    s_add_u32 s23, s23, s35
    v_mul_f32 v230, v255, v230
    v_mul_f32 v231, v255, v231
    v_mfma_f32_16x16x32_bf16 v[154:157], v[206:209], a[144:147], 0
    s_cmp_lg_u32 s83, 0
    v_cvt_pk_bf16_f32 v254, v230, v231
    v_mul_f32 v232, v255, v232
    v_mfma_f32_16x16x32_bf16 v[154:157], v[210:213], a[148:151], v[154:157]
    s_cselect_b32 s77, s80, s77
    v_fmac_f32 v237, v122, v122
    v_fmac_f32 v237, v123, v123
    v_mfma_f32_16x16x32_bf16 v[154:157], v[238:241], a[152:155], v[154:157]
    s_mul_i32 s78, s77, 2688
    v_fmac_f32 v237, v124, v124
    v_fmac_f32 v237, v125, v125
    v_mfma_f32_16x16x32_bf16 v[154:157], v[242:245], a[156:159], v[154:157]
    s_add_u32 s78, s78, s69
    ds_read2_b32 v[144:145], v6 offset0:0 offset1:0
    ds_read2_b32 v[172:173], v6 offset0:16 offset1:16
    v_mfma_f32_16x16x32_bf16 v[154:157], v[214:217], a[160:163], v[154:157]
    s_add_u32 s80, s77, s68
    ds_read2_b32 v[192:193], v6 offset0:32 offset1:32
    v_cvt_pk_bf16_f32 v36, v237, v236
    v_mfma_f32_16x16x32_bf16 v[154:157], v[198:201], a[164:167], v[154:157]
    s_cmp_ge_u32 s80, 72
    v_mul_f32 v233, v255, v233
    v_cvt_pk_bf16_f32 v255, v232, v233
    v_mfma_f32_16x16x32_bf16 v[230:233], v[32:35], v[36:39], 0
    s_cselect_b32 s80, s22, 0
    v_xor_b32 v0, 65536, v0
    v_xor_b32 v1, 65536, v1
    v_mfma_f32_16x16x32_bf16 v[166:169], v[206:209], a[168:171], 0
    s_add_u32 s78, s78, s80
    v_cvt_pk_bf16_f32 v142, v154, v155
    v_cvt_pk_bf16_f32 v143, v156, v157
    v_mfma_f32_16x16x32_bf16 v[166:169], v[210:213], a[172:175], v[166:169]
    s_add_u32 s80, s77, 20
    v_rsq_f32 v231, v231
    v_mfma_f32_16x16x32_bf16 v[166:169], v[238:241], a[176:179], v[166:169]
    s_add_u32 s34, s18, 3
    v_rsq_f32 v230, v230
    v_mfma_f32_16x16x32_bf16 v[166:169], v[242:245], a[180:183], v[166:169]
    s_cmp_lt_u32 s77, s62
    v_mul_f32 v230, s31, v230
    v_mul_f32 v130, v231, v130
    v_mfma_f32_16x16x32_bf16 v[166:169], v[214:217], a[184:187], v[166:169]
    s_cselect_b32 s79, 1, 0
    v_mul_f32 v131, v231, v131
    v_cvt_pk_f16_f32 v158, v130, v131
    v_mfma_f32_16x16x32_bf16 v[166:169], v[198:201], a[188:191], v[166:169]
    s_cselect_b32 s78, s78, 0
    v_mul_f32 v132, v231, v132
    v_mul_f32 v133, v231, v133
    v_mfma_f32_16x16x32_bf16 v[250:253], v[206:209], a[192:195], 0
    s_cmp_lt_u32 s34, s17
    v_cvt_pk_f16_f32 v159, v132, v133
    v_mul_f32 v218, v231, v218
    v_mfma_f32_16x16x32_bf16 v[250:253], v[210:213], a[196:199], v[250:253]
    s_cselect_b32 s23, s23, s78
    v_cvt_pk_bf16_f32 v170, v166, v167
    v_cvt_pk_bf16_f32 v171, v168, v169
    v_mfma_f32_16x16x32_bf16 v[250:253], v[238:241], a[200:203], v[250:253]
    s_cselect_b32 s73, s34, s80
    ds_read_b128 v[222:225], v5 offset:0
    ds_read_b128 v[202:205], v5 offset:16
    v_mfma_f32_16x16x32_bf16 v[250:253], v[242:245], a[204:207], v[250:253]
    s_cselect_b32 s79, 0, s79
    ds_read_b128 v[154:157], v5 offset:48
    ds_read_b32 v232, v6 offset:192
    v_mfma_f32_16x16x32_bf16 v[250:253], v[214:217], a[208:211], v[250:253]
    s_waitcnt lgkmcnt(4)
    buffer_store_dwordx2 v[234:235], v18, s[12:15], 0 offen nt
    v_mul_f32 v219, v231, v219
    v_cvt_pk_f16_f32 v160, v218, v219
    v_mfma_f32_16x16x32_f16 v[186:189], v[178:181], v[194:197], v[46:49]
    s_cselect_b32 s81, 0, 1
    v_mul_f32 v220, v231, v220
    v_mul_f32 v221, v231, v221
    v_mfma_f32_16x16x32_f16 v[182:185], v[138:141], v[194:197], v[50:53]
    s_add_u32 s80, s77, 1
    v_cvt_pk_f16_f32 v161, v220, v221
    v_mul_f32 v226, v231, v226
    v_mul_f32 v227, v231, v227
    v_mfma_f32_16x16x32_f16 v[166:169], v[158:161], v[194:197], v[54:57]
    s_mul_i32 s80, s80, s81
    v_cvt_pk_f16_f32 v132, v226, v227
    v_mul_f32 v228, v231, v228
    v_mul_f32 v229, v231, v229
    v_mfma_f32_16x16x16_f16 v[186:189], v[120:121], v[118:119], v[186:189]
    v_cvt_pk_f16_f32 v133, v228, v229
    v_mul_f32 v162, v230, v162
    v_mul_f32 v163, v230, v163
    v_mfma_f32_16x16x16_f16 v[182:185], v[128:129], v[118:119], v[182:185]
    v_cvt_pk_f16_f32 v162, v162, v163
    v_mul_f32 v164, v230, v164
    v_mul_f32 v165, v230, v165
    v_mfma_f32_16x16x16_f16 v[166:169], v[132:133], v[118:119], v[166:169]
    v_cvt_pk_f16_f32 v163, v164, v165
    v_mul_f32 v246, v230, v246
    v_mul_f32 v247, v230, v247
    v_cvt_pk_f16_f32 v164, v246, v247
    v_mfma_f32_16x16x32_bf16 v[250:253], v[198:201], a[212:215], v[250:253]
    s_waitcnt lgkmcnt(0)
    ds_read_b128 v[214:217], v2 offset:0
    ds_read_b128 v[206:209], v2 offset:1024
    v_mfma_f32_16x16x32_f16 v[226:229], v[222:225], v[194:197], v[22:25]
    s_cmp_lt_u32 s80, s62
    ds_read_b128 v[210:213], v2 offset:2048
    ds_read_b128 v[194:197], v2 offset:3072
    v_mfma_f32_16x16x32_f16 v[226:229], v[202:205], v[178:181], v[226:229]
    s_cselect_b32 s70, s70, 0
    v_cvt_pk_bf16_f32 v190, v250, v251
    v_cvt_pk_bf16_f32 v191, v252, v253
    v_mfma_f32_16x16x32_f16 v[226:229], v[154:157], v[118:121], v[226:229]
    s_cselect_b32 s62, s62, 0
    ds_read_b128 v[198:201], v2 offset:4096
    v_mul_f32 v248, v230, v248
    v_mul_f32 v249, v230, v249
    v_cvt_pk_f16_f32 v165, v248, v249
    v_mfma_f32_16x16x32_f16 v[218:221], v[222:225], v[150:153], v[24:27]
    s_add_u32 s80, s18, 4
    v_mul_f32 v122, v230, v122
    v_mul_f32 v123, v230, v123
    v_mfma_f32_16x16x32_f16 v[218:221], v[202:205], v[138:141], v[218:221]
    s_cmp_ge_u32 s80, s17
    v_cvt_pk_f16_f32 v130, v122, v123
    v_mul_f32 v124, v230, v124
    v_mfma_f32_16x16x32_f16 v[218:221], v[154:157], v[126:129], v[218:221]
    s_cselect_b32 s66, s70, 0
    v_mul_f32 v125, v230, v125
    v_cvt_pk_f16_f32 v131, v124, v125
    v_mfma_f32_16x16x32_f16 v[238:241], v[222:225], v[162:165], v[26:29]
    s_waitcnt lgkmcnt(3)
    ds_read_b128 v[222:225], v2 offset:5120
    v_mov_b32_dpp v232, v227 quad_perm:[0,1,2,3] row_mask:0x1 bank_mask:0xf
    v_mfma_f32_16x16x32_f16 v[238:241], v[202:205], v[158:161], v[238:241]
    s_lshl_b32 s80, s79, s73
    v_mov_b32_dpp v232, v219 quad_perm:[0,1,2,3] row_mask:0x2 bank_mask:0xf
    v_max3_f32 v118, v226, v186, v187
    v_mfma_f32_16x16x32_f16 v[238:241], v[154:157], v[130:133], v[238:241]
    s_waitcnt lgkmcnt(2)
    buffer_atomic_add v45, v10, s[64:67], 0 offen sc0 sc1
    buffer_store_dwordx4 v[114:117], v16, s[12:15], 0 offen nt
    v_max3_f32 v118, v118, v188, v189
    v_max3_f32 v118, v118, v182, v183
    v_max3_f32 v118, v118, v184, v185
    v_max3_f32 v118, v118, v166, v167
    v_mfma_f32_16x16x32_bf16 v[122:125], a[216:219], v[214:217], 0
    s_or_b32 s63, s63, s80
    v_max3_f32 v118, v118, v168, v169
    v_mov_b32 v119, v118
    v_mfma_f32_16x16x32_bf16 v[122:125], a[220:223], v[206:209], v[122:125]
    s_sub_u32 s80, s100, s81
    v_permlane32_swap_b32 v118, v119
    v_mfma_f32_16x16x32_bf16 v[122:125], a[224:227], v[210:213], v[122:125]
    s_and_b32 s100, s100, s80
    v_max_f32 v118, v118, v119
    v_mov_b32 v119, v118
    v_mfma_f32_16x16x32_bf16 v[122:125], a[228:231], v[194:197], v[122:125]
    s_waitcnt lgkmcnt(1)
    v_permlane16_swap_b32 v118, v119
    v_mfma_f32_16x16x32_bf16 v[122:125], a[232:235], v[198:201], v[122:125]
    s_waitcnt lgkmcnt(0)
    v_max_f32 v118, v118, v119
    v_sub_f32 v186, v186, v118
    v_mfma_f32_16x16x32_bf16 v[122:125], a[236:239], v[222:225], v[122:125]
    s_add_u32 s45, s45, s79
    v_exp_f32 v186, v186
    v_mfma_f32_16x16x32_bf16 v[154:157], a[240:243], v[214:217], 0
    s_add_u32 s18, s18, 1
    v_sub_f32 v187, v187, v118
    v_sub_f32 v188, v188, v118
    v_mfma_f32_16x16x32_bf16 v[154:157], a[244:247], v[206:209], v[154:157]
    s_cmp_lt_u32 s18, s45
    v_exp_f32 v187, v187
    v_mfma_f32_16x16x32_bf16 v[154:157], a[248:251], v[210:213], v[154:157]
    v_cvt_pk_bf16_f32 v186, v186, v187
    v_sub_f32 v189, v189, v118
    v_mfma_f32_16x16x32_bf16 v[154:157], a[252:255], v[194:197], v[154:157]
    v_exp_f32 v188, v188
    v_mfma_f32_16x16x32_bf16 v[154:157], v[82:85], v[198:201], v[154:157]
    v_exp_f32 v189, v189
    v_mfma_f32_16x16x32_bf16 v[154:157], v[86:89], v[222:225], v[154:157]
    v_cvt_pk_bf16_f32 v187, v188, v189
    v_sub_f32 v182, v182, v118
    v_mfma_f32_16x16x32_bf16 v[202:205], v[90:93], v[214:217], 0
    ds_read_b128 v[214:217], v2 offset:6144
    v_sub_f32 v183, v183, v118
    v_mfma_f32_16x16x32_bf16 v[202:205], v[94:97], v[206:209], v[202:205]
    ds_read_b128 v[206:209], v2 offset:7168
    v_sub_f32 v184, v184, v118
    v_mfma_f32_16x16x32_bf16 v[202:205], v[98:101], v[210:213], v[202:205]
    ds_read_b128 v[210:213], v2 offset:8192
    v_sub_f32 v185, v185, v118
    v_mfma_f32_16x16x32_bf16 v[202:205], v[102:105], v[194:197], v[202:205]
    ds_read_b128 v[194:197], v2 offset:9216
    buffer_store_dwordx2 v[254:255], v19, s[12:15], 0 offen nt
    v_exp_f32 v182, v182
    v_mfma_f32_16x16x32_f16 v[234:237], v[178:181], v[150:153], v[58:61]
    v_exp_f32 v183, v183
    v_mfma_f32_16x16x32_bf16 v[202:205], v[106:109], v[198:201], v[202:205]
    ds_read_b128 v[198:201], v2 offset:10240
    v_cvt_pk_bf16_f32 v188, v182, v183
    v_mfma_f32_16x16x32_bf16 v[202:205], v[110:113], v[222:225], v[202:205]
    ds_read_b128 v[222:225], v2 offset:11264
    v_exp_f32 v184, v184
    v_mfma_f32_16x16x16_f16 v[234:237], v[120:121], v[126:127], v[234:237]
    v_exp_f32 v185, v185
    v_sub_f32 v166, v166, v118
    v_cvt_pk_bf16_f32 v189, v184, v185
    v_mfma_f32_16x16x32_f16 v[182:185], v[138:141], v[150:153], v[62:65]
    s_waitcnt lgkmcnt(4)
    v_exp_f32 v166, v166
    v_sub_f32 v167, v167, v118
    v_exp_f32 v167, v167
    v_sub_f32 v168, v168, v118
    v_cvt_pk_bf16_f32 v36, v166, v167
    v_mfma_f32_16x16x16_f16 v[182:185], v[128:129], v[126:127], v[182:185]
    v_exp_f32 v168, v168
    v_sub_f32 v169, v169, v118
    v_sub_f32 v226, v226, v118
    v_mfma_f32_16x16x32_f16 v[242:245], v[158:161], v[150:153], v[66:69]
    s_waitcnt lgkmcnt(2)
    v_exp_f32 v169, v169
    v_mfma_f32_16x16x32_bf16 v[114:117], a[216:219], v[214:217], 0
    s_waitcnt lgkmcnt(1)
    v_cvt_pk_bf16_f32 v37, v168, v169
    v_mov_b32_dpp v232, v239 quad_perm:[0,1,2,3] row_mask:0x4 bank_mask:0xf
    v_mov_b32 v118, v232
    v_mfma_f32_16x16x16_f16 v[242:245], v[132:133], v[126:127], v[242:245]
    v_exp_f32 v226, v226
    v_max_f32_dpp v118, v118, v118 quad_perm:[1,0,3,2] row_mask:0xf bank_mask:0xf
    v_cvt_pk_bf16_f32 v39, v226, 0
    v_mfma_f32_16x16x32_bf16 v[114:117], a[220:223], v[206:209], v[114:117]
    s_waitcnt lgkmcnt(0)
    v_max_f32_dpp v118, v118, v118 quad_perm:[2,3,0,1] row_mask:0xf bank_mask:0xf
    v_max3_f32 v126, v218, v234, v235
    v_mfma_f32_16x16x32_bf16 v[150:153], v[28:31], v[36:39], 0
    v_max_f32_dpp v118, v118, v118 row_half_mirror row_mask:0xf bank_mask:0xf
    v_max3_f32 v126, v126, v236, v237
    v_mfma_f32_16x16x32_bf16 v[150:153], v[28:31], v[186:189], v[150:153]
    v_max_f32_dpp v118, v118, v118 row_mirror row_mask:0xf bank_mask:0xf
    v_mov_b32 v119, v118
    v_mfma_f32_16x16x32_bf16 v[114:117], a[224:227], v[210:213], v[114:117]
    v_max3_f32 v126, v126, v182, v183
    v_max3_f32 v126, v126, v184, v185
    v_mfma_f32_16x16x32_bf16 v[114:117], a[228:231], v[194:197], v[114:117]
    v_permlane32_swap_b32 v118, v119
    v_mfma_f32_16x16x32_bf16 v[114:117], a[232:235], v[198:201], v[114:117]
    v_rcp_f32 v150, v150
    v_mfma_f32_16x16x32_bf16 v[114:117], a[236:239], v[222:225], v[114:117]
    v_max_f32 v118, v118, v119
    v_mov_b32 v119, v118
    v_max3_f32 v126, v126, v242, v243
    v_max3_f32 v126, v126, v244, v245
    v_permlane16_swap_b32 v118, v119
    v_max_f32 v118, v118, v119
    v_mfma_f32_16x16x32_bf16 v[166:169], v[142:145], v[36:39], 0
    v_sub_f32 v232, v232, v118
    v_mov_b32 v127, v126
    v_mfma_f32_16x16x32_bf16 v[166:169], v[146:149], v[186:189], v[166:169]
    v_exp_f32 v232, v232
    v_permlane32_swap_b32 v126, v127
    v_cvt_pk_bf16_f32 v232, v232, v232
    v_max_f32 v126, v126, v127
    v_mov_b32 v127, v126
    v_fma_f32 v254, v122, v122, s33
    v_fmac_f32 v254, v123, v123
    v_permlane16_swap_b32 v126, v127
    v_mul_f32 v166, v150, v166
    v_mul_f32 v167, v150, v167
    v_cvt_pk_bf16_f32 v166, v166, v167
    v_mul_f32 v168, v150, v168
    v_mul_f32 v169, v150, v169
    v_cvt_pk_bf16_f32 v167, v168, v169
    v_max_f32 v126, v126, v127
    v_sub_f32 v234, v234, v126
    v_exp_f32 v234, v234
    v_sub_f32 v235, v235, v126
    v_exp_f32 v235, v235
    v_sub_f32 v236, v236, v126
    v_cvt_pk_bf16_f32 v226, v234, v235
    v_exp_f32 v236, v236
    v_sub_f32 v237, v237, v126
    v_exp_f32 v237, v237
    v_sub_f32 v182, v182, v126
    v_cvt_pk_bf16_f32 v227, v236, v237
    v_mfma_f32_16x16x32_bf16 v[234:237], v[170:173], v[36:39], 0
    ds_write_b16 v8, v232
    v_mfma_f32_16x16x32_bf16 v[234:237], v[174:177], v[186:189], v[234:237]
    v_exp_f32 v182, v182
    v_sub_f32 v183, v183, v126
    v_exp_f32 v183, v183
    v_sub_f32 v184, v184, v126
    v_cvt_pk_bf16_f32 v228, v182, v183
    v_exp_f32 v184, v184
    v_sub_f32 v185, v185, v126
    v_exp_f32 v185, v185
    v_mul_f32 v234, v150, v234
    v_mul_f32 v235, v150, v235
    v_cvt_pk_bf16_f32 v168, v234, v235
    v_mul_f32 v236, v150, v236
    v_mul_f32 v237, v150, v237
    v_cvt_pk_bf16_f32 v169, v236, v237
    v_mfma_f32_16x16x32_bf16 v[230:233], v[190:193], v[36:39], 0
    ds_write_b128 v3, v[166:169] offset:0
    v_mfma_f32_16x16x32_bf16 v[230:233], v[134:137], v[186:189], v[230:233]
    v_cvt_pk_bf16_f32 v229, v184, v185
    v_sub_f32 v242, v242, v126
    v_mfma_f32_16x16x32_f16 v[182:185], v[178:181], v[162:165], v[70:73]
    v_exp_f32 v242, v242
    v_mfma_f32_16x16x32_bf16 v[166:169], a[240:243], v[214:217], 0
    ds_read_b128 v[178:181], v9
    v_sub_f32 v243, v243, v126
    v_mfma_f32_16x16x32_bf16 v[166:169], a[244:247], v[206:209], v[166:169]
    v_mul_f32 v230, v150, v230
    v_mul_f32 v231, v150, v231
    v_cvt_pk_bf16_f32 v220, v230, v231
    v_mfma_f32_16x16x16_f16 v[182:185], v[120:121], v[130:131], v[182:185]
    v_mul_f32 v232, v150, v232
    v_mul_f32 v233, v150, v233
    v_cvt_pk_bf16_f32 v221, v232, v233
    v_sub_f32 v244, v244, v126
    v_mfma_f32_16x16x32_bf16 v[166:169], a[248:251], v[210:213], v[166:169]
    ds_read_b128 v[118:121], v9 offset:64
    v_sub_f32 v245, v245, v126
    v_mfma_f32_16x16x32_bf16 v[166:169], a[252:255], v[194:197], v[166:169]
    ds_write_b64 v4, v[220:221] offset:4096
    v_mfma_f32_16x16x32_bf16 v[166:169], v[82:85], v[198:201], v[166:169]
    v_max3_f32 v255, v238, v182, v183
    v_max3_f32 v255, v255, v184, v185
    v_mfma_f32_16x16x32_bf16 v[166:169], v[86:89], v[222:225], v[166:169]
    v_exp_f32 v243, v243
    v_exp_f32 v244, v244
    v_cvt_pk_bf16_f32 v36, v242, v243
    v_mfma_f32_16x16x32_f16 v[186:189], v[138:141], v[162:165], v[74:77]
    s_waitcnt lgkmcnt(2)
    v_exp_f32 v245, v245
    v_mfma_f32_16x16x32_f16 v[246:249], v[158:161], v[162:165], v[78:81]
    v_cvt_pk_bf16_f32 v37, v244, v245
    v_sub_f32 v218, v218, v126
    v_mfma_f32_16x16x32_bf16 v[242:245], v[178:181], v[28:31], 0
    v_exp_f32 v218, v218
    v_fmac_f32 v254, v124, v124
    v_mfma_f32_16x16x16_f16 v[186:189], v[128:129], v[130:131], v[186:189]
    v_cvt_pk_bf16_f32 v39, v218, 0
    v_fmac_f32 v254, v125, v125
    v_fmac_f32 v254, v154, v154
    v_mfma_f32_16x16x16_f16 v[246:249], v[132:133], v[130:131], v[246:249]
    v_fmac_f32 v254, v155, v155
    v_fmac_f32 v254, v156, v156
    v_fmac_f32 v254, v157, v157
    v_fmac_f32 v254, v202, v202
    v_mfma_f32_16x16x32_bf16 v[126:129], v[28:31], v[36:39], 0
    s_waitcnt lgkmcnt(0)
    v_max3_f32 v255, v255, v186, v187
    v_max3_f32 v255, v255, v188, v189
    v_mfma_f32_16x16x32_bf16 v[126:129], v[28:31], v[226:229], v[126:129]
    v_max3_f32 v255, v255, v246, v247
    v_max3_f32 v255, v255, v248, v249
    v_mfma_f32_16x16x32_bf16 v[130:133], v[142:145], v[36:39], 0
    v_mov_b32 v239, v255
    v_fmac_f32 v254, v203, v203
    v_mfma_f32_16x16x32_bf16 v[130:133], v[146:149], v[226:229], v[130:133]
    v_permlane32_swap_b32 v255, v239
    v_mfma_f32_16x16x32_bf16 v[138:141], v[170:173], v[36:39], 0
    v_rcp_f32 v126, v126
    v_mfma_f32_16x16x32_bf16 v[138:141], v[174:177], v[226:229], v[138:141]
    v_max_f32 v255, v255, v239
    v_mov_b32 v239, v255
    v_mfma_f32_16x16x32_bf16 v[150:153], v[190:193], v[36:39], 0
    v_fmac_f32 v254, v204, v204
    v_mul_f32 v130, v126, v130
    v_mfma_f32_16x16x32_bf16 v[150:153], v[134:137], v[226:229], v[150:153]
    v_mul_f32 v131, v126, v131
    v_cvt_pk_bf16_f32 v130, v130, v131
    v_mfma_f32_16x16x32_bf16 v[242:245], v[118:121], v[28:31], v[242:245]
    v_mul_f32 v132, v126, v132
    v_mul_f32 v133, v126, v133
    v_mfma_f32_16x16x32_bf16 v[218:221], v[178:181], v[146:149], 0
    v_cvt_pk_bf16_f32 v131, v132, v133
    v_mul_f32 v138, v126, v138
    v_mfma_f32_16x16x32_bf16 v[218:221], v[118:121], v[142:145], v[218:221]
    v_mul_f32 v139, v126, v139
    v_cvt_pk_bf16_f32 v132, v138, v139
    v_mfma_f32_16x16x32_bf16 v[226:229], v[178:181], v[174:177], 0
    v_mul_f32 v140, v126, v140
    v_mul_f32 v141, v126, v141
    v_mfma_f32_16x16x32_bf16 v[226:229], v[118:121], v[170:173], v[226:229]
    v_cvt_pk_bf16_f32 v133, v140, v141
    v_mul_f32 v150, v126, v150
    v_mfma_f32_16x16x32_bf16 v[250:253], v[178:181], v[134:137], 0
    ds_write_b128 v3, v[130:133] offset:6144
    v_mfma_f32_16x16x32_bf16 v[250:253], v[118:121], v[190:193], v[250:253]
    v_mul_f32 v151, v126, v151
    v_cvt_pk_bf16_f32 v240, v150, v151
    v_mfma_f32_16x16x32_bf16 v[230:233], v[90:93], v[214:217], 0
    v_mul_f32 v152, v126, v152
    v_mul_f32 v153, v126, v153
    v_mfma_f32_16x16x32_bf16 v[230:233], v[94:97], v[206:209], v[230:233]
    ds_read_b128 v[118:121], v2 offset:12288
    ds_read_b128 v[126:129], v2 offset:13312
    v_mfma_f32_16x16x32_bf16 v[230:233], v[98:101], v[210:213], v[230:233]
    ds_read_b128 v[130:133], v2 offset:14336
    v_cvt_pk_bf16_f32 v241, v152, v153
    v_mfma_f32_16x16x32_bf16 v[230:233], v[102:105], v[194:197], v[230:233]
    ds_read_b128 v[158:161], v2 offset:15360
    v_fmac_f32 v254, v205, v205
    v_mfma_f32_16x16x32_bf16 v[230:233], v[106:109], v[198:201], v[230:233]
    ds_read_b128 v[178:181], v2 offset:16384
    v_fma_f32 v219, v114, v114, s33
    v_mfma_f32_16x16x32_bf16 v[230:233], v[110:113], v[222:225], v[230:233]
    ds_read_b128 v[194:197], v2 offset:17408
    ds_write_b64 v4, v[240:241] offset:10240
    v_permlane16_swap_b32 v255, v239
    v_max_f32 v255, v255, v239
    v_sub_f32 v182, v182, v255
    v_exp_f32 v182, v182
    v_sub_f32 v183, v183, v255
    v_exp_f32 v183, v183
    s_waitcnt lgkmcnt(5)
    v_mfma_f32_16x16x32_bf16 v[150:153], a[216:219], v[118:121], 0
    v_cvt_pk_bf16_f32 v198, v182, v183
    v_sub_f32 v184, v184, v255
    v_mfma_f32_16x16x32_bf16 v[150:153], a[220:223], v[126:129], v[150:153]
    s_waitcnt lgkmcnt(4)
    v_exp_f32 v184, v184
    v_mfma_f32_16x16x32_bf16 v[150:153], a[224:227], v[130:133], v[150:153]
    s_waitcnt lgkmcnt(3)
    v_sub_f32 v185, v185, v255
    v_sub_f32 v186, v186, v255
    v_mfma_f32_16x16x32_bf16 v[150:153], a[228:231], v[158:161], v[150:153]
    s_waitcnt lgkmcnt(2)
    v_exp_f32 v185, v185
    v_mfma_f32_16x16x32_bf16 v[150:153], a[232:235], v[178:181], v[150:153]
    s_waitcnt lgkmcnt(0)
    v_cvt_pk_bf16_f32 v199, v184, v185
    v_sub_f32 v187, v187, v255
    v_mfma_f32_16x16x32_bf16 v[150:153], a[236:239], v[194:197], v[150:153]
    v_exp_f32 v186, v186
    v_mfma_f32_16x16x32_bf16 v[162:165], a[240:243], v[118:121], 0
    v_exp_f32 v187, v187
    v_mfma_f32_16x16x32_bf16 v[162:165], a[244:247], v[126:129], v[162:165]
    v_cvt_pk_bf16_f32 v200, v186, v187
    v_sub_f32 v188, v188, v255
    v_mfma_f32_16x16x32_bf16 v[162:165], a[248:251], v[130:133], v[162:165]
    v_exp_f32 v188, v188
    v_mfma_f32_16x16x32_bf16 v[162:165], a[252:255], v[158:161], v[162:165]
    v_sub_f32 v189, v189, v255
    v_sub_f32 v246, v246, v255
    v_mfma_f32_16x16x32_bf16 v[162:165], v[82:85], v[178:181], v[162:165]
    v_exp_f32 v189, v189
    v_mfma_f32_16x16x32_bf16 v[162:165], v[86:89], v[194:197], v[162:165]
    v_cvt_pk_bf16_f32 v201, v188, v189
    v_sub_f32 v247, v247, v255
    v_mfma_f32_16x16x32_bf16 v[138:141], v[90:93], v[118:121], 0
    v_exp_f32 v246, v246
    v_mfma_f32_16x16x32_bf16 v[138:141], v[94:97], v[126:129], v[138:141]
    v_exp_f32 v247, v247
    v_mfma_f32_16x16x32_bf16 v[138:141], v[98:101], v[130:133], v[138:141]
    v_cvt_pk_bf16_f32 v36, v246, v247
    v_sub_f32 v248, v248, v255
    v_mfma_f32_16x16x32_bf16 v[138:141], v[102:105], v[158:161], v[138:141]
    v_exp_f32 v248, v248
    v_mfma_f32_16x16x32_bf16 v[138:141], v[106:109], v[178:181], v[138:141]
    v_sub_f32 v249, v249, v255
    v_sub_f32 v238, v238, v255
    v_mfma_f32_16x16x32_bf16 v[138:141], v[110:113], v[194:197], v[138:141]
    ds_read_b128 v[186:189], v0 offset:20480
    ds_read_b128 v[118:121], v1 offset:20480
    ds_read_b128 v[234:237], v0 offset:20608
    v_exp_f32 v249, v249
    v_exp_f32 v238, v238
    v_cvt_pk_bf16_f32 v37, v248, v249
    v_cvt_pk_bf16_f32 v39, v238, 0
    v_fma_f32 v255, v150, v150, s33
    v_fmac_f32 v255, v151, v151
    v_mfma_f32_16x16x32_bf16 v[126:129], v[28:31], v[36:39], 0
    ds_read_b128 v[158:161], v1 offset:20608
    ds_read_b128 v[182:185], v0 offset:20736
    v_mfma_f32_16x16x32_bf16 v[126:129], v[28:31], v[198:201], v[126:129]
    ds_read_b128 v[206:209], v1 offset:20736
    v_fmac_f32 v255, v152, v152
    v_mfma_f32_16x16x32_bf16 v[178:181], v[142:145], v[36:39], 0
    v_fmac_f32 v255, v153, v153
    v_fmac_f32 v255, v162, v162
    v_mfma_f32_16x16x32_bf16 v[178:181], v[146:149], v[198:201], v[178:181]
    v_fmac_f32 v255, v163, v163
    v_fmac_f32 v255, v164, v164
    v_mfma_f32_16x16x32_bf16 v[142:145], v[170:173], v[36:39], 0
    s_waitcnt lgkmcnt(5)
    v_rcp_f32 v126, v126
    v_mfma_f32_16x16x32_bf16 v[142:145], v[174:177], v[198:201], v[142:145]
    s_waitcnt lgkmcnt(3)
    v_fmac_f32 v255, v165, v165
    v_mul_f32 v178, v126, v178
    v_mfma_f32_16x16x32_bf16 v[146:149], v[190:193], v[36:39], 0
    v_mul_f32 v179, v126, v179
    v_cvt_pk_bf16_f32 v170, v178, v179
    v_mfma_f32_16x16x32_bf16 v[146:149], v[134:137], v[198:201], v[146:149]
    v_mul_f32 v180, v126, v180
    v_mul_f32 v181, v126, v181
    v_mfma_f32_16x16x32_bf16 v[130:133], a[72:75], v[186:189], 0
    s_waitcnt lgkmcnt(1)
    v_cvt_pk_bf16_f32 v171, v180, v181
    v_mul_f32 v142, v126, v142
    v_mfma_f32_16x16x32_bf16 v[130:133], a[76:79], v[118:121], v[130:133]
    s_waitcnt lgkmcnt(0)
    v_mul_f32 v143, v126, v143
    v_cvt_pk_bf16_f32 v172, v142, v143
    v_mfma_f32_16x16x32_bf16 v[130:133], a[80:83], v[234:237], v[130:133]
    v_mul_f32 v144, v126, v144
    v_mul_f32 v145, v126, v145
    v_mfma_f32_16x16x32_bf16 v[130:133], a[84:87], v[158:161], v[130:133]
    v_cvt_pk_bf16_f32 v173, v144, v145
    v_mul_f32 v146, v126, v146
    v_mfma_f32_16x16x32_bf16 v[130:133], a[88:91], v[182:185], v[130:133]
    ds_write_b128 v3, v[170:173] offset:12288
    v_mfma_f32_16x16x32_bf16 v[130:133], a[92:95], v[206:209], v[130:133]
    v_mul_f32 v147, v126, v147
    v_cvt_pk_bf16_f32 v220, v146, v147
    v_mfma_f32_16x16x32_bf16 v[134:137], a[96:99], v[186:189], 0
    v_mul_f32 v148, v126, v148
    v_mul_f32 v149, v126, v149
    v_mfma_f32_16x16x32_bf16 v[134:137], a[100:103], v[118:121], v[134:137]
    v_cvt_pk_bf16_f32 v221, v148, v149
    v_fmac_f32 v255, v138, v138
    v_mfma_f32_16x16x32_bf16 v[134:137], a[104:107], v[234:237], v[134:137]
    ds_write_b64 v4, v[220:221] offset:16384
    v_mfma_f32_16x16x32_bf16 v[134:137], a[108:111], v[158:161], v[134:137]
    v_fmac_f32 v255, v139, v139
    v_fmac_f32 v255, v140, v140
    v_mfma_f32_16x16x32_bf16 v[134:137], a[112:115], v[182:185], v[134:137]
    v_fmac_f32 v255, v141, v141
    v_cvt_pk_bf16_f32 v255, v255, v255
    v_mfma_f32_16x16x32_bf16 v[134:137], a[116:119], v[206:209], v[134:137]
    v_rcp_f32 v242, v242
    v_mfma_f32_16x16x32_bf16 v[170:173], a[120:123], v[186:189], 0
    v_mul_f32 v218, v218, v242
    v_mul_f32_dpp v218, v226, v242 quad_perm:[0,1,2,3] row_mask:0x2 bank_mask:0xf
    v_mfma_f32_16x16x32_bf16 v[170:173], a[124:127], v[118:121], v[170:173]
    v_mul_f32_dpp v218, v250, v242 quad_perm:[0,1,2,3] row_mask:0x4 bank_mask:0xf
    v_cvt_pk_bf16_f32 v218, v218, v218
    v_mfma_f32_16x16x32_bf16 v[170:173], a[128:131], v[234:237], v[170:173]
    ds_write_b16 v7, v218
    v_mfma_f32_16x16x32_bf16 v[170:173], a[132:135], v[158:161], v[170:173]
    v_fmac_f32 v219, v115, v115
    v_fmac_f32 v219, v116, v116
    v_mfma_f32_16x16x32_bf16 v[170:173], a[136:139], v[182:185], v[170:173]
    v_fmac_f32 v219, v117, v117
    v_fmac_f32 v219, v166, v166
    v_mfma_f32_16x16x32_bf16 v[170:173], a[140:143], v[206:209], v[170:173]
    v_fmac_f32 v219, v167, v167
    v_fmac_f32 v219, v168, v168
    v_mfma_f32_16x16x32_bf16 v[142:145], a[0:3], v[186:189], 0
    v_fmac_f32 v219, v169, v169
    v_fmac_f32 v219, v230, v230
    v_mfma_f32_16x16x32_bf16 v[142:145], a[4:7], v[118:121], v[142:145]
    v_fmac_f32 v219, v231, v231
    v_fmac_f32 v219, v232, v232
    v_mfma_f32_16x16x32_bf16 v[142:145], a[8:11], v[234:237], v[142:145]
    v_fmac_f32 v219, v233, v233
    v_cvt_pk_bf16_f32 v254, v254, v219
    v_mfma_f32_16x16x32_bf16 v[142:145], a[12:15], v[158:161], v[142:145]
    ds_write_b64 v4, v[254:255] offset:18432
    v_mfma_f32_16x16x32_bf16 v[142:145], a[16:19], v[182:185], v[142:145]
    v_fma_f32 v174, v130, v130, s32
    v_fmac_f32 v174, v131, v131
    v_mfma_f32_16x16x32_bf16 v[142:145], a[20:23], v[206:209], v[142:145]
    v_fmac_f32 v174, v132, v132
    v_fmac_f32 v174, v133, v133
    v_mfma_f32_16x16x32_bf16 v[126:129], a[24:27], v[186:189], 0
    v_xor_b32 v2, 65536, v2
    v_xor_b32 v3, 65536, v3
    v_mfma_f32_16x16x32_bf16 v[126:129], a[28:31], v[118:121], v[126:129]
    v_xor_b32 v4, 65536, v4
    v_add_u32 v5, s74, v5
    v_mfma_f32_16x16x32_bf16 v[126:129], a[32:35], v[234:237], v[126:129]
    v_add_u32 v6, s75, v6
    v_add_u32 v7, s76, v7
    v_mfma_f32_16x16x32_bf16 v[126:129], a[36:39], v[158:161], v[126:129]
    v_mfma_f32_16x16x32_bf16 v[126:129], a[40:43], v[182:185], v[126:129]
    s_waitcnt lgkmcnt(0)
    s_barrier
    s_nop 0
    s_nop 0
    s_nop 0
    v_mfma_f32_16x16x32_bf16 v[126:129], a[44:47], v[206:209], v[126:129]
    s_cbranch_scc1 L_loop_safe0
    s_branch L_final_safe
.p2align 6
L_loop_safe1:
    v_mfma_f32_16x16x32_bf16 v[190:193], a[48:51], v[186:189], 0
    s_add_u32 s12, s40, s27
    ds_read_b128 v[146:149], v2 offset:18432
    ds_read_b128 v[178:181], v2 offset:19456
    v_mfma_f32_16x16x32_bf16 v[190:193], a[52:55], v[118:121], v[190:193]
    s_addc_u32 s13, s41, 0
    v_fmac_f32 v174, v134, v134
    v_fmac_f32 v174, v135, v135
    v_mfma_f32_16x16x32_bf16 v[190:193], a[56:59], v[234:237], v[190:193]
    s_sub_u32 s14, s36, s27
    v_fmac_f32 v174, v136, v136
    v_fmac_f32 v174, v137, v137
    v_mfma_f32_16x16x32_bf16 v[190:193], a[60:63], v[158:161], v[190:193]
    s_cmp_ge_u32 s18, 2
    v_fmac_f32 v174, v170, v170
    v_fmac_f32 v174, v171, v171
    v_mfma_f32_16x16x32_bf16 v[190:193], a[64:67], v[182:185], v[190:193]
    s_cselect_b32 s14, s14, 0
    v_fmac_f32 v174, v172, v172
    v_fmac_f32 v174, v173, v173
    v_mfma_f32_16x16x32_bf16 v[190:193], a[68:71], v[206:209], v[190:193]
    s_sub_u32 s82, s72, s71
    v_fma_f32 v254, v142, v142, s32
    v_fmac_f32 v254, v143, v143
    v_mfma_f32_16x16x32_bf16 v[194:197], v[186:189], a[144:147], 0
    s_mul_i32 s74, s82, 336
    v_fmac_f32 v254, v144, v144
    v_fmac_f32 v254, v145, v145
    v_mfma_f32_16x16x32_bf16 v[194:197], v[118:121], a[148:151], v[194:197]
    s_mul_i32 s75, s82, 272
    v_fmac_f32 v254, v126, v126
    v_fmac_f32 v254, v127, v127
    v_mfma_f32_16x16x32_bf16 v[194:197], v[234:237], a[152:155], v[194:197]
    s_waitcnt lgkmcnt(0)
    v_fmac_f32 v254, v128, v128
    v_fmac_f32 v254, v129, v129
    v_mfma_f32_16x16x32_bf16 v[198:201], v[32:35], v[146:149], 0
    s_mul_i32 s76, s82, 16
    v_fmac_f32 v254, v190, v190
    v_fmac_f32 v254, v191, v191
    v_mfma_f32_16x16x32_bf16 v[198:201], v[32:35], v[178:181], v[198:201]
    s_add_u32 s34, s18, 2
    v_fmac_f32 v254, v192, v192
    v_fmac_f32 v254, v193, v193
    v_mfma_f32_16x16x32_bf16 v[194:197], v[158:161], a[156:159], v[194:197]
    s_add_u32 s8, s60, s23
    v_cvt_pk_bf16_f32 v36, v254, v174
    s_addc_u32 s9, s61, 0
    v_mfma_f32_16x16x32_bf16 v[194:197], v[182:185], a[160:163], v[194:197]
    s_sub_u32 s10, s36, s23
    v_mul_f32 v254, 0x3baaaaab, v198
    v_mul_f32 v255, 0x3baaaaab, v199
    v_mfma_f32_16x16x32_bf16 v[210:213], v[32:35], v[36:39], 0
    s_cmp_le_u32 s34, s45
    v_rsq_f32 v254, v254
    v_mfma_f32_16x16x32_bf16 v[194:197], v[206:209], a[164:167], v[194:197]
    s_cselect_b32 s10, s10, 0
    ds_read_b128 v[214:217], v0 offset:26624
    v_mul_f32 v148, 0x3baaaaab, v200
    v_mfma_f32_16x16x32_bf16 v[174:177], v[186:189], a[168:171], 0
    s_add_u32 m0, s28, 0
    ds_read_b128 v[198:201], v1 offset:26624
    v_mul_f32 v122, v254, v122
    v_mfma_f32_16x16x32_bf16 v[174:177], v[118:121], a[172:175], v[174:177]
    s_mov_b32 s27, s26
    ds_read_b128 v[218:221], v0 offset:26752
    v_cvt_pk_bf16_f32 v146, v194, v195
    v_mfma_f32_16x16x32_bf16 v[174:177], v[234:237], a[176:179], v[174:177]
    s_mov_b32 s26, s25
    ds_read_b128 v[222:225], v1 offset:26752
    v_cvt_pk_bf16_f32 v147, v196, v197
    v_mfma_f32_16x16x32_bf16 v[174:177], v[158:161], a[180:183], v[174:177]
    s_mov_b32 s25, s24
    v_rsq_f32 v211, v211
    v_mfma_f32_16x16x32_bf16 v[174:177], v[182:185], a[184:187], v[174:177]
    s_mov_b32 s24, s23
    v_rsq_f32 v210, v210
    v_mfma_f32_16x16x32_bf16 v[174:177], v[206:209], a[188:191], v[174:177]
    s_ff1_i32_b32 s80, s100
    v_mul_f32 v210, s31, v210
    v_mul_f32 v130, v211, v130
    v_mul_f32 v131, v211, v131
    v_cvt_pk_f16_f32 v178, v130, v131
    v_mfma_f32_16x16x32_bf16 v[194:197], v[186:189], a[192:195], 0
    s_waitcnt lgkmcnt(3)
    ds_read_b128 v[186:189], v0 offset:26880
    v_cvt_pk_bf16_f32 v174, v174, v175
    v_mfma_f32_16x16x32_bf16 v[194:197], v[118:121], a[196:199], v[194:197]
    s_mov_b32 s71, s72
    ds_read_b128 v[226:229], v1 offset:26880
    v_cvt_pk_bf16_f32 v175, v176, v177
    v_mfma_f32_16x16x32_bf16 v[194:197], v[234:237], a[200:203], v[194:197]
    s_mov_b32 s72, s73
    v_mul_f32 v132, v211, v132
    v_mul_f32 v133, v211, v133
    v_mfma_f32_16x16x32_bf16 v[194:197], v[158:161], a[204:207], v[194:197]
    s_waitcnt lgkmcnt(2)
    v_cvt_pk_f16_f32 v179, v132, v133
    v_mul_f32 v134, v211, v134
    v_mfma_f32_16x16x32_bf16 v[194:197], v[182:185], a[208:211], v[194:197]
    v_mul_f32 v135, v211, v135
    v_cvt_pk_f16_f32 v180, v134, v135
    v_mfma_f32_16x16x32_bf16 v[194:197], v[206:209], a[212:215], v[194:197]
    v_mul_f32 v136, v211, v136
    v_mul_f32 v137, v211, v137
    v_mfma_f32_16x16x32_bf16 v[130:133], a[72:75], v[214:217], 0
    v_cvt_pk_f16_f32 v181, v136, v137
    v_mul_f32 v170, v211, v170
    v_mfma_f32_16x16x32_bf16 v[130:133], a[76:79], v[198:201], v[130:133]
    v_mul_f32 v171, v211, v171
    v_cvt_pk_f16_f32 v120, v170, v171
    v_mfma_f32_16x16x32_bf16 v[130:133], a[80:83], v[218:221], v[130:133]
    s_waitcnt lgkmcnt(1)
    v_cvt_pk_bf16_f32 v134, v194, v195
    v_cvt_pk_bf16_f32 v135, v196, v197
    v_mfma_f32_16x16x32_bf16 v[130:133], a[84:87], v[222:225], v[130:133]
    s_waitcnt lgkmcnt(0)
    v_mul_f32 v172, v211, v172
    v_mul_f32 v173, v211, v173
    v_mfma_f32_16x16x32_bf16 v[130:133], a[88:91], v[186:189], v[130:133]
    v_cvt_pk_f16_f32 v121, v172, v173
    v_mul_f32 v142, v210, v142
    v_mfma_f32_16x16x32_bf16 v[130:133], a[92:95], v[226:229], v[130:133]
    v_mul_f32 v143, v210, v143
    v_cvt_pk_f16_f32 v194, v142, v143
    v_mfma_f32_16x16x32_bf16 v[158:161], a[96:99], v[214:217], 0
    v_mul_f32 v144, v210, v144
    v_mul_f32 v145, v210, v145
    v_mfma_f32_16x16x32_bf16 v[158:161], a[100:103], v[198:201], v[158:161]
    v_cvt_pk_f16_f32 v195, v144, v145
    v_mul_f32 v126, v210, v126
    v_mfma_f32_16x16x32_bf16 v[158:161], a[104:107], v[218:221], v[158:161]
    v_mul_f32 v127, v210, v127
    v_cvt_pk_f16_f32 v196, v126, v127
    v_mfma_f32_16x16x32_bf16 v[158:161], a[108:111], v[222:225], v[158:161]
    v_mul_f32 v128, v210, v128
    v_mul_f32 v129, v210, v129
    v_mfma_f32_16x16x32_bf16 v[158:161], a[112:115], v[186:189], v[158:161]
    v_cvt_pk_f16_f32 v197, v128, v129
    v_mul_f32 v190, v210, v190
    v_mfma_f32_16x16x32_bf16 v[158:161], a[116:119], v[226:229], v[158:161]
    v_mul_f32 v191, v210, v191
    v_cvt_pk_f16_f32 v118, v190, v191
    v_mfma_f32_16x16x32_bf16 v[142:145], a[120:123], v[214:217], 0
    v_mul_f32 v192, v210, v192
    v_mul_f32 v193, v210, v193
    v_mfma_f32_16x16x32_bf16 v[142:145], a[124:127], v[198:201], v[142:145]
    v_cvt_pk_f16_f32 v119, v192, v193
    v_fma_f32 v149, v130, v130, s32
    v_mfma_f32_16x16x32_bf16 v[142:145], a[128:131], v[218:221], v[142:145]
    v_fmac_f32 v149, v131, v131
    v_fmac_f32 v149, v132, v132
    v_mfma_f32_16x16x32_bf16 v[142:145], a[132:135], v[222:225], v[142:145]
    v_fmac_f32 v149, v133, v133
    v_fmac_f32 v149, v158, v158
    v_mfma_f32_16x16x32_bf16 v[142:145], a[136:139], v[186:189], v[142:145]
    v_fmac_f32 v149, v159, v159
    v_fmac_f32 v149, v160, v160
    v_mfma_f32_16x16x32_bf16 v[142:145], a[140:143], v[226:229], v[142:145]
    v_fmac_f32 v149, v161, v161
    v_mul_f32 v123, v254, v123
    v_mfma_f32_16x16x32_bf16 v[170:173], a[0:3], v[214:217], 0
    v_rsq_f32 v255, v255
    v_mfma_f32_16x16x32_bf16 v[170:173], a[4:7], v[198:201], v[170:173]
    v_rsq_f32 v148, v148
    v_mfma_f32_16x16x32_bf16 v[170:173], a[8:11], v[218:221], v[170:173]
    v_mul_f32 v150, v148, v150
    v_fmac_f32 v149, v142, v142
    v_mfma_f32_16x16x32_bf16 v[170:173], a[12:15], v[222:225], v[170:173]
    v_fmac_f32 v149, v143, v143
    v_fmac_f32 v149, v144, v144
    v_mfma_f32_16x16x32_bf16 v[170:173], a[16:19], v[186:189], v[170:173]
    v_fmac_f32 v149, v145, v145
    v_mul_f32 v151, v148, v151
    v_mfma_f32_16x16x32_bf16 v[170:173], a[20:23], v[226:229], v[170:173]
    v_cvt_pk_bf16_f32 v126, v150, v151
    v_mul_f32 v152, v148, v152
    v_mfma_f32_16x16x32_bf16 v[182:185], a[24:27], v[214:217], 0
    v_mul_f32 v153, v148, v153
    v_cvt_pk_bf16_f32 v127, v152, v153
    v_mfma_f32_16x16x32_bf16 v[182:185], a[28:31], v[198:201], v[182:185]
    v_mul_f32 v162, v148, v162
    v_mul_f32 v163, v148, v163
    v_mfma_f32_16x16x32_bf16 v[182:185], a[32:35], v[218:221], v[182:185]
    v_fma_f32 v136, v170, v170, s32
    v_fmac_f32 v136, v171, v171
    v_mfma_f32_16x16x32_bf16 v[182:185], a[36:39], v[222:225], v[182:185]
    v_fmac_f32 v136, v172, v172
    v_fmac_f32 v136, v173, v173
    v_mfma_f32_16x16x32_bf16 v[182:185], a[40:43], v[186:189], v[182:185]
    v_cvt_pk_bf16_f32 v128, v162, v163
    v_mul_f32 v164, v148, v164
    v_mfma_f32_16x16x32_bf16 v[182:185], a[44:47], v[226:229], v[182:185]
    v_mul_f32 v165, v148, v165
    v_cvt_pk_bf16_f32 v129, v164, v165
    v_mfma_f32_16x16x32_bf16 v[162:165], a[48:51], v[214:217], 0
    buffer_store_dwordx4 v[126:129], v17, s[12:15], 0 offen nt
    v_mul_f32 v138, v148, v138
    v_mul_f32 v139, v148, v139
    v_cvt_pk_bf16_f32 v176, v138, v139
    v_mul_f32 v140, v148, v140
    v_mfma_f32_16x16x32_bf16 v[162:165], a[52:55], v[198:201], v[162:165]
    v_fmac_f32 v136, v182, v182
    v_fmac_f32 v136, v183, v183
    v_mfma_f32_16x16x32_bf16 v[162:165], a[56:59], v[218:221], v[162:165]
    v_fmac_f32 v136, v184, v184
    v_fmac_f32 v136, v185, v185
    v_mfma_f32_16x16x32_bf16 v[162:165], a[60:63], v[222:225], v[162:165]
    v_mul_f32 v141, v148, v141
    v_cvt_pk_bf16_f32 v177, v140, v141
    v_mfma_f32_16x16x32_bf16 v[162:165], a[64:67], v[186:189], v[162:165]
    v_cvt_pk_bf16_f32 v190, v122, v123
    v_mul_f32 v124, v254, v124
    v_mfma_f32_16x16x32_bf16 v[162:165], a[68:71], v[226:229], v[162:165]
    v_mul_f32 v125, v254, v125
    v_cvt_pk_bf16_f32 v191, v124, v125
    v_mfma_f32_16x16x32_bf16 v[122:125], v[214:217], a[144:147], 0
    v_mul_f32 v154, v254, v154
    v_mul_f32 v155, v254, v155
    v_mfma_f32_16x16x32_bf16 v[122:125], v[198:201], a[148:151], v[122:125]
    v_cvt_pk_bf16_f32 v192, v154, v155
    v_mul_f32 v156, v254, v156
    v_mfma_f32_16x16x32_bf16 v[122:125], v[218:221], a[152:155], v[122:125]
    v_fmac_f32 v136, v162, v162
    v_fmac_f32 v136, v163, v163
    v_mfma_f32_16x16x32_bf16 v[122:125], v[222:225], a[156:159], v[122:125]
    v_fmac_f32 v136, v164, v164
    v_fmac_f32 v136, v165, v165
    v_mfma_f32_16x16x32_bf16 v[122:125], v[186:189], a[160:163], v[122:125]
    v_cvt_pk_bf16_f32 v36, v136, v149
    v_mul_f32 v157, v254, v157
    v_mfma_f32_16x16x32_bf16 v[122:125], v[226:229], a[164:167], v[122:125]
    ds_read_b128 v[206:209], v0 offset:32768
    v_cvt_pk_bf16_f32 v193, v156, v157
    v_mfma_f32_16x16x32_bf16 v[154:157], v[32:35], v[36:39], 0
    v_mul_f32 v202, v254, v202
    v_mul_f32 v203, v254, v203
    v_mfma_f32_16x16x32_bf16 v[126:129], v[214:217], a[168:171], 0
    ds_read_b128 v[210:213], v1 offset:32768
    v_cvt_pk_bf16_f32 v234, v202, v203
    v_mfma_f32_16x16x32_bf16 v[126:129], v[198:201], a[172:175], v[126:129]
    ds_read_b128 v[238:241], v0 offset:32896
    v_cvt_pk_bf16_f32 v148, v122, v123
    v_mfma_f32_16x16x32_bf16 v[126:129], v[218:221], a[176:179], v[126:129]
    ds_read_b128 v[242:245], v1 offset:32896
    v_cvt_pk_bf16_f32 v149, v124, v125
    v_mfma_f32_16x16x32_bf16 v[126:129], v[222:225], a[180:183], v[126:129]
    v_rsq_f32 v155, v155
    v_mfma_f32_16x16x32_bf16 v[126:129], v[186:189], a[184:187], v[126:129]
    buffer_store_dwordx2 v[176:177], v20, s[12:15], 0 offen nt
    v_rsq_f32 v154, v154
    v_mfma_f32_16x16x32_bf16 v[126:129], v[226:229], a[188:191], v[126:129]
    s_waitcnt lgkmcnt(3)
    v_mul_f32 v154, s31, v154
    v_mul_f32 v130, v155, v130
    v_mul_f32 v131, v155, v131
    v_cvt_pk_f16_f32 v138, v130, v131
    v_mfma_f32_16x16x32_bf16 v[122:125], v[214:217], a[192:195], 0
    ds_read_b128 v[214:217], v0 offset:33024
    v_mul_f32 v132, v155, v132
    v_mfma_f32_16x16x32_bf16 v[122:125], v[198:201], a[196:199], v[122:125]
    s_waitcnt lgkmcnt(3)
    ds_read_b128 v[198:201], v1 offset:33024
    v_cvt_pk_bf16_f32 v176, v126, v127
    v_mfma_f32_16x16x32_bf16 v[122:125], v[218:221], a[200:203], v[122:125]
    s_waitcnt lgkmcnt(3)
    v_cvt_pk_bf16_f32 v177, v128, v129
    v_mul_f32 v133, v155, v133
    v_mfma_f32_16x16x32_bf16 v[122:125], v[222:225], a[204:207], v[122:125]
    s_waitcnt vmcnt(2)
    ds_write_b16 v8, v45 offset:512
    v_mfma_f32_16x16x32_bf16 v[122:125], v[186:189], a[208:211], v[122:125]
    s_waitcnt lgkmcnt(3)
    v_cvt_pk_f16_f32 v139, v132, v133
    v_mfma_f32_16x16x32_bf16 v[122:125], v[226:229], a[212:215], v[122:125]
    v_mul_f32 v158, v155, v158
    v_mul_f32 v159, v155, v159
    v_mfma_f32_16x16x32_bf16 v[130:133], a[72:75], v[206:209], 0
    v_cvt_pk_f16_f32 v140, v158, v159
    v_mul_f32 v160, v155, v160
    v_mfma_f32_16x16x32_bf16 v[130:133], a[76:79], v[210:213], v[130:133]
    v_mul_f32 v161, v155, v161
    v_cvt_pk_f16_f32 v141, v160, v161
    v_mfma_f32_16x16x32_bf16 v[130:133], a[80:83], v[238:241], v[130:133]
    s_waitcnt lgkmcnt(2)
    v_cvt_pk_bf16_f32 v136, v122, v123
    v_cvt_pk_bf16_f32 v137, v124, v125
    v_mfma_f32_16x16x32_bf16 v[130:133], a[84:87], v[242:245], v[130:133]
    s_waitcnt lgkmcnt(1)
    v_mul_f32 v142, v155, v142
    v_mul_f32 v143, v155, v143
    v_mfma_f32_16x16x32_bf16 v[130:133], a[88:91], v[214:217], v[130:133]
    v_cvt_pk_f16_f32 v128, v142, v143
    v_mul_f32 v144, v155, v144
    v_mfma_f32_16x16x32_bf16 v[130:133], a[92:95], v[198:201], v[130:133]
    s_waitcnt lgkmcnt(0)
    v_mul_f32 v145, v155, v145
    v_cvt_pk_f16_f32 v129, v144, v145
    v_mfma_f32_16x16x32_bf16 v[218:221], a[96:99], v[206:209], 0
    v_mul_f32 v170, v154, v170
    v_mul_f32 v171, v154, v171
    v_mfma_f32_16x16x32_bf16 v[218:221], a[100:103], v[210:213], v[218:221]
    s_barrier
    v_cvt_pk_f16_f32 v150, v170, v171
    v_mul_f32 v172, v154, v172
    v_mfma_f32_16x16x32_bf16 v[218:221], a[104:107], v[238:241], v[218:221]
    v_mul_f32 v173, v154, v173
    v_cvt_pk_f16_f32 v151, v172, v173
    v_mfma_f32_16x16x32_bf16 v[218:221], a[108:111], v[242:245], v[218:221]
    buffer_load_dwordx4 v10, s[8:11], 0 offen nt lds
    ds_read_u16 v202, v9 offset:384
    v_mfma_f32_16x16x32_bf16 v[218:221], a[112:115], v[214:217], v[218:221]
    s_add_u32 m0, s28, 4096
    v_mul_f32 v182, v154, v182
    v_mul_f32 v183, v154, v183
    v_mfma_f32_16x16x32_bf16 v[218:221], a[116:119], v[198:201], v[218:221]
    v_cvt_pk_f16_f32 v152, v182, v183
    v_mul_f32 v184, v154, v184
    v_mfma_f32_16x16x32_bf16 v[226:229], a[120:123], v[206:209], 0
    v_mul_f32 v185, v154, v185
    v_cvt_pk_f16_f32 v153, v184, v185
    v_mfma_f32_16x16x32_bf16 v[226:229], a[124:127], v[210:213], v[226:229]
    v_mul_f32 v162, v154, v162
    v_mul_f32 v163, v154, v163
    v_mfma_f32_16x16x32_bf16 v[226:229], a[128:131], v[238:241], v[226:229]
    buffer_load_dwordx4 v11, s[8:11], 0 offen nt lds
    v_cvt_pk_f16_f32 v126, v162, v163
    v_mfma_f32_16x16x32_bf16 v[226:229], a[132:135], v[242:245], v[226:229]
    s_add_u32 m0, s28, 8192
    v_mul_f32 v164, v154, v164
    v_mul_f32 v165, v154, v165
    v_mfma_f32_16x16x32_bf16 v[226:229], a[136:139], v[214:217], v[226:229]
    v_cvt_pk_f16_f32 v127, v164, v165
    v_mul_f32 v204, v254, v204
    v_mfma_f32_16x16x32_bf16 v[226:229], a[140:143], v[198:201], v[226:229]
    s_waitcnt lgkmcnt(0)
    v_readfirstlane_b32 s77, v202
    v_mul_f32 v205, v254, v205
    v_mfma_f32_16x16x32_bf16 v[162:165], a[0:3], v[206:209], 0
    v_cvt_pk_bf16_f32 v235, v204, v205
    v_fma_f32 v236, v130, v130, s32
    v_mfma_f32_16x16x32_bf16 v[162:165], a[4:7], v[210:213], v[162:165]
    buffer_load_dwordx4 v12, s[8:11], 0 offen nt lds
    v_fmac_f32 v236, v131, v131
    v_mfma_f32_16x16x32_bf16 v[162:165], a[8:11], v[238:241], v[162:165]
    s_add_u32 m0, s28, 12288
    v_fmac_f32 v236, v132, v132
    v_fmac_f32 v236, v133, v133
    v_mfma_f32_16x16x32_bf16 v[162:165], a[12:15], v[242:245], v[162:165]
    s_xor_b32 s28, s28, 65536
    v_fmac_f32 v236, v218, v218
    v_fmac_f32 v236, v219, v219
    v_mfma_f32_16x16x32_bf16 v[162:165], a[16:19], v[214:217], v[162:165]
    v_fmac_f32 v236, v220, v220
    v_fmac_f32 v236, v221, v221
    v_mfma_f32_16x16x32_bf16 v[162:165], a[20:23], v[198:201], v[162:165]
    v_fmac_f32 v236, v226, v226
    v_fmac_f32 v236, v227, v227
    v_mfma_f32_16x16x32_bf16 v[246:249], a[24:27], v[206:209], 0
    buffer_load_dwordx4 v13, s[8:11], 0 offen nt lds
    v_fmac_f32 v236, v228, v228
    v_mfma_f32_16x16x32_bf16 v[246:249], a[28:31], v[210:213], v[246:249]
    s_mov_b32 m0, s29
    v_fmac_f32 v236, v229, v229
    v_fma_f32 v237, v162, v162, s32
    v_mfma_f32_16x16x32_bf16 v[246:249], a[32:35], v[238:241], v[246:249]
    s_xor_b32 s29, s29, s30
    v_fmac_f32 v237, v163, v163
    v_fmac_f32 v237, v164, v164
    v_mfma_f32_16x16x32_bf16 v[246:249], a[36:39], v[242:245], v[246:249]
    s_add_u32 s19, s19, s20
    v_fmac_f32 v237, v165, v165
    v_mul_f32 v114, v255, v114
    v_mfma_f32_16x16x32_bf16 v[246:249], a[40:43], v[214:217], v[246:249]
    s_add_u32 s23, s23, s21
    v_mul_f32 v115, v255, v115
    v_cvt_pk_bf16_f32 v114, v114, v115
    v_mfma_f32_16x16x32_bf16 v[246:249], a[44:47], v[198:201], v[246:249]
    buffer_load_dwordx4 v14, s[8:11], 0 offen nt lds
    v_mul_f32 v116, v255, v116
    v_mfma_f32_16x16x32_bf16 v[122:125], a[48:51], v[206:209], 0
    s_cmp_ge_u32 s19, 72
    v_mul_f32 v117, v255, v117
    v_cvt_pk_bf16_f32 v115, v116, v117
    v_mfma_f32_16x16x32_bf16 v[122:125], a[52:55], v[210:213], v[122:125]
    s_cselect_b32 s34, 72, 0
    v_fmac_f32 v237, v246, v246
    v_fmac_f32 v237, v247, v247
    v_mfma_f32_16x16x32_bf16 v[122:125], a[56:59], v[238:241], v[122:125]
    s_cselect_b32 s35, s22, 0
    v_fmac_f32 v237, v248, v248
    v_fmac_f32 v237, v249, v249
    v_mfma_f32_16x16x32_bf16 v[122:125], a[60:63], v[242:245], v[122:125]
    s_sub_u32 s19, s19, s34
    v_mul_f32 v166, v255, v166
    v_mul_f32 v167, v255, v167
    v_mfma_f32_16x16x32_bf16 v[122:125], a[64:67], v[214:217], v[122:125]
    buffer_store_dwordx4 v[190:193], v15, s[12:15], 0 offen nt
    v_cvt_pk_bf16_f32 v116, v166, v167
    v_mul_f32 v168, v255, v168
    v_mul_f32 v169, v255, v169
    v_cvt_pk_bf16_f32 v117, v168, v169
    v_mfma_f32_16x16x32_bf16 v[122:125], a[68:71], v[198:201], v[122:125]
    s_add_u32 s23, s23, s35
    v_mul_f32 v230, v255, v230
    v_mul_f32 v231, v255, v231
    v_mfma_f32_16x16x32_bf16 v[154:157], v[206:209], a[144:147], 0
    s_cmp_lg_u32 s83, 0
    v_cvt_pk_bf16_f32 v254, v230, v231
    v_mul_f32 v232, v255, v232
    v_mfma_f32_16x16x32_bf16 v[154:157], v[210:213], a[148:151], v[154:157]
    s_cselect_b32 s77, s80, s77
    v_fmac_f32 v237, v122, v122
    v_fmac_f32 v237, v123, v123
    v_mfma_f32_16x16x32_bf16 v[154:157], v[238:241], a[152:155], v[154:157]
    s_mul_i32 s78, s77, 2688
    v_fmac_f32 v237, v124, v124
    v_fmac_f32 v237, v125, v125
    v_mfma_f32_16x16x32_bf16 v[154:157], v[242:245], a[156:159], v[154:157]
    s_add_u32 s78, s78, s69
    ds_read2_b32 v[144:145], v6 offset0:0 offset1:0
    ds_read2_b32 v[172:173], v6 offset0:16 offset1:16
    v_mfma_f32_16x16x32_bf16 v[154:157], v[214:217], a[160:163], v[154:157]
    s_add_u32 s80, s77, s68
    ds_read2_b32 v[192:193], v6 offset0:32 offset1:32
    v_cvt_pk_bf16_f32 v36, v237, v236
    v_mfma_f32_16x16x32_bf16 v[154:157], v[198:201], a[164:167], v[154:157]
    s_cmp_ge_u32 s80, 72
    v_mul_f32 v233, v255, v233
    v_cvt_pk_bf16_f32 v255, v232, v233
    v_mfma_f32_16x16x32_bf16 v[230:233], v[32:35], v[36:39], 0
    s_cselect_b32 s80, s22, 0
    v_xor_b32 v0, 65536, v0
    v_xor_b32 v1, 65536, v1
    v_mfma_f32_16x16x32_bf16 v[166:169], v[206:209], a[168:171], 0
    s_add_u32 s78, s78, s80
    v_cvt_pk_bf16_f32 v142, v154, v155
    v_cvt_pk_bf16_f32 v143, v156, v157
    v_mfma_f32_16x16x32_bf16 v[166:169], v[210:213], a[172:175], v[166:169]
    s_add_u32 s80, s77, 20
    v_rsq_f32 v231, v231
    v_mfma_f32_16x16x32_bf16 v[166:169], v[238:241], a[176:179], v[166:169]
    s_add_u32 s34, s18, 3
    v_rsq_f32 v230, v230
    v_mfma_f32_16x16x32_bf16 v[166:169], v[242:245], a[180:183], v[166:169]
    s_cmp_lt_u32 s77, s62
    v_mul_f32 v230, s31, v230
    v_mul_f32 v130, v231, v130
    v_mfma_f32_16x16x32_bf16 v[166:169], v[214:217], a[184:187], v[166:169]
    s_cselect_b32 s79, 1, 0
    v_mul_f32 v131, v231, v131
    v_cvt_pk_f16_f32 v158, v130, v131
    v_mfma_f32_16x16x32_bf16 v[166:169], v[198:201], a[188:191], v[166:169]
    s_cselect_b32 s78, s78, 0
    v_mul_f32 v132, v231, v132
    v_mul_f32 v133, v231, v133
    v_mfma_f32_16x16x32_bf16 v[250:253], v[206:209], a[192:195], 0
    s_cmp_lt_u32 s34, s17
    v_cvt_pk_f16_f32 v159, v132, v133
    v_mul_f32 v218, v231, v218
    v_mfma_f32_16x16x32_bf16 v[250:253], v[210:213], a[196:199], v[250:253]
    s_cselect_b32 s23, s23, s78
    v_cvt_pk_bf16_f32 v170, v166, v167
    v_cvt_pk_bf16_f32 v171, v168, v169
    v_mfma_f32_16x16x32_bf16 v[250:253], v[238:241], a[200:203], v[250:253]
    s_cselect_b32 s73, s34, s80
    ds_read_b128 v[222:225], v5 offset:0
    ds_read_b128 v[202:205], v5 offset:16
    v_mfma_f32_16x16x32_bf16 v[250:253], v[242:245], a[204:207], v[250:253]
    s_cselect_b32 s79, 0, s79
    ds_read_b128 v[154:157], v5 offset:48
    ds_read_b32 v232, v6 offset:192
    v_mfma_f32_16x16x32_bf16 v[250:253], v[214:217], a[208:211], v[250:253]
    s_waitcnt lgkmcnt(4)
    buffer_store_dwordx2 v[234:235], v18, s[12:15], 0 offen nt
    v_mul_f32 v219, v231, v219
    v_cvt_pk_f16_f32 v160, v218, v219
    v_mfma_f32_16x16x32_f16 v[186:189], v[178:181], v[194:197], v[46:49]
    s_cselect_b32 s81, 0, 1
    v_mul_f32 v220, v231, v220
    v_mul_f32 v221, v231, v221
    v_mfma_f32_16x16x32_f16 v[182:185], v[138:141], v[194:197], v[50:53]
    s_add_u32 s80, s77, 1
    v_cvt_pk_f16_f32 v161, v220, v221
    v_mul_f32 v226, v231, v226
    v_mul_f32 v227, v231, v227
    v_mfma_f32_16x16x32_f16 v[166:169], v[158:161], v[194:197], v[54:57]
    s_mul_i32 s80, s80, s81
    v_cvt_pk_f16_f32 v132, v226, v227
    v_mul_f32 v228, v231, v228
    v_mul_f32 v229, v231, v229
    v_mfma_f32_16x16x16_f16 v[186:189], v[120:121], v[118:119], v[186:189]
    v_cvt_pk_f16_f32 v133, v228, v229
    v_mul_f32 v162, v230, v162
    v_mul_f32 v163, v230, v163
    v_mfma_f32_16x16x16_f16 v[182:185], v[128:129], v[118:119], v[182:185]
    v_cvt_pk_f16_f32 v162, v162, v163
    v_mul_f32 v164, v230, v164
    v_mul_f32 v165, v230, v165
    v_mfma_f32_16x16x16_f16 v[166:169], v[132:133], v[118:119], v[166:169]
    v_cvt_pk_f16_f32 v163, v164, v165
    v_mul_f32 v246, v230, v246
    v_mul_f32 v247, v230, v247
    v_cvt_pk_f16_f32 v164, v246, v247
    v_mfma_f32_16x16x32_bf16 v[250:253], v[198:201], a[212:215], v[250:253]
    s_waitcnt lgkmcnt(0)
    ds_read_b128 v[214:217], v2 offset:0
    ds_read_b128 v[206:209], v2 offset:1024
    v_mfma_f32_16x16x32_f16 v[226:229], v[222:225], v[194:197], v[22:25]
    s_cmp_lt_u32 s80, s62
    ds_read_b128 v[210:213], v2 offset:2048
    ds_read_b128 v[194:197], v2 offset:3072
    v_mfma_f32_16x16x32_f16 v[226:229], v[202:205], v[178:181], v[226:229]
    s_cselect_b32 s70, s70, 0
    v_cvt_pk_bf16_f32 v190, v250, v251
    v_cvt_pk_bf16_f32 v191, v252, v253
    v_mfma_f32_16x16x32_f16 v[226:229], v[154:157], v[118:121], v[226:229]
    s_cselect_b32 s62, s62, 0
    ds_read_b128 v[198:201], v2 offset:4096
    v_mul_f32 v248, v230, v248
    v_mul_f32 v249, v230, v249
    v_cvt_pk_f16_f32 v165, v248, v249
    v_mfma_f32_16x16x32_f16 v[218:221], v[222:225], v[150:153], v[24:27]
    s_add_u32 s80, s18, 4
    v_mul_f32 v122, v230, v122
    v_mul_f32 v123, v230, v123
    v_mfma_f32_16x16x32_f16 v[218:221], v[202:205], v[138:141], v[218:221]
    s_cmp_ge_u32 s80, s17
    v_cvt_pk_f16_f32 v130, v122, v123
    v_mul_f32 v124, v230, v124
    v_mfma_f32_16x16x32_f16 v[218:221], v[154:157], v[126:129], v[218:221]
    s_cselect_b32 s66, s70, 0
    v_mul_f32 v125, v230, v125
    v_cvt_pk_f16_f32 v131, v124, v125
    v_mfma_f32_16x16x32_f16 v[238:241], v[222:225], v[162:165], v[26:29]
    s_waitcnt lgkmcnt(3)
    ds_read_b128 v[222:225], v2 offset:5120
    v_mov_b32_dpp v232, v227 quad_perm:[0,1,2,3] row_mask:0x1 bank_mask:0xf
    v_mfma_f32_16x16x32_f16 v[238:241], v[202:205], v[158:161], v[238:241]
    s_lshl_b32 s80, s79, s73
    v_mov_b32_dpp v232, v219 quad_perm:[0,1,2,3] row_mask:0x2 bank_mask:0xf
    v_max3_f32 v118, v226, v186, v187
    v_mfma_f32_16x16x32_f16 v[238:241], v[154:157], v[130:133], v[238:241]
    s_waitcnt lgkmcnt(2)
    buffer_store_dwordx4 v[114:117], v16, s[12:15], 0 offen nt
    v_max3_f32 v118, v118, v188, v189
    v_max3_f32 v118, v118, v182, v183
    v_max3_f32 v118, v118, v184, v185
    v_max3_f32 v118, v118, v166, v167
    v_mfma_f32_16x16x32_bf16 v[122:125], a[216:219], v[214:217], 0
    s_or_b32 s63, s63, s80
    v_max3_f32 v118, v118, v168, v169
    v_mov_b32 v119, v118
    v_mfma_f32_16x16x32_bf16 v[122:125], a[220:223], v[206:209], v[122:125]
    s_sub_u32 s80, s100, s81
    v_permlane32_swap_b32 v118, v119
    v_mfma_f32_16x16x32_bf16 v[122:125], a[224:227], v[210:213], v[122:125]
    s_and_b32 s100, s100, s80
    v_max_f32 v118, v118, v119
    v_mov_b32 v119, v118
    v_mfma_f32_16x16x32_bf16 v[122:125], a[228:231], v[194:197], v[122:125]
    s_waitcnt lgkmcnt(1)
    v_permlane16_swap_b32 v118, v119
    v_mfma_f32_16x16x32_bf16 v[122:125], a[232:235], v[198:201], v[122:125]
    s_waitcnt lgkmcnt(0)
    v_max_f32 v118, v118, v119
    v_sub_f32 v186, v186, v118
    v_mfma_f32_16x16x32_bf16 v[122:125], a[236:239], v[222:225], v[122:125]
    s_add_u32 s45, s45, s79
    v_exp_f32 v186, v186
    v_mfma_f32_16x16x32_bf16 v[154:157], a[240:243], v[214:217], 0
    s_add_u32 s18, s18, 1
    v_sub_f32 v187, v187, v118
    v_sub_f32 v188, v188, v118
    v_mfma_f32_16x16x32_bf16 v[154:157], a[244:247], v[206:209], v[154:157]
    s_cmp_lt_u32 s18, s45
    v_exp_f32 v187, v187
    v_mfma_f32_16x16x32_bf16 v[154:157], a[248:251], v[210:213], v[154:157]
    v_cvt_pk_bf16_f32 v186, v186, v187
    v_sub_f32 v189, v189, v118
    v_mfma_f32_16x16x32_bf16 v[154:157], a[252:255], v[194:197], v[154:157]
    v_exp_f32 v188, v188
    v_mfma_f32_16x16x32_bf16 v[154:157], v[82:85], v[198:201], v[154:157]
    v_exp_f32 v189, v189
    v_mfma_f32_16x16x32_bf16 v[154:157], v[86:89], v[222:225], v[154:157]
    v_cvt_pk_bf16_f32 v187, v188, v189
    v_sub_f32 v182, v182, v118
    v_mfma_f32_16x16x32_bf16 v[202:205], v[90:93], v[214:217], 0
    ds_read_b128 v[214:217], v2 offset:6144
    v_sub_f32 v183, v183, v118
    v_mfma_f32_16x16x32_bf16 v[202:205], v[94:97], v[206:209], v[202:205]
    ds_read_b128 v[206:209], v2 offset:7168
    v_sub_f32 v184, v184, v118
    v_mfma_f32_16x16x32_bf16 v[202:205], v[98:101], v[210:213], v[202:205]
    ds_read_b128 v[210:213], v2 offset:8192
    v_sub_f32 v185, v185, v118
    v_mfma_f32_16x16x32_bf16 v[202:205], v[102:105], v[194:197], v[202:205]
    ds_read_b128 v[194:197], v2 offset:9216
    buffer_store_dwordx2 v[254:255], v19, s[12:15], 0 offen nt
    v_exp_f32 v182, v182
    v_mfma_f32_16x16x32_f16 v[234:237], v[178:181], v[150:153], v[58:61]
    v_exp_f32 v183, v183
    v_mfma_f32_16x16x32_bf16 v[202:205], v[106:109], v[198:201], v[202:205]
    ds_read_b128 v[198:201], v2 offset:10240
    v_cvt_pk_bf16_f32 v188, v182, v183
    v_mfma_f32_16x16x32_bf16 v[202:205], v[110:113], v[222:225], v[202:205]
    ds_read_b128 v[222:225], v2 offset:11264
    v_exp_f32 v184, v184
    v_mfma_f32_16x16x16_f16 v[234:237], v[120:121], v[126:127], v[234:237]
    v_exp_f32 v185, v185
    v_sub_f32 v166, v166, v118
    v_cvt_pk_bf16_f32 v189, v184, v185
    v_mfma_f32_16x16x32_f16 v[182:185], v[138:141], v[150:153], v[62:65]
    s_waitcnt lgkmcnt(4)
    v_exp_f32 v166, v166
    v_sub_f32 v167, v167, v118
    v_exp_f32 v167, v167
    v_sub_f32 v168, v168, v118
    v_cvt_pk_bf16_f32 v36, v166, v167
    v_mfma_f32_16x16x16_f16 v[182:185], v[128:129], v[126:127], v[182:185]
    v_exp_f32 v168, v168
    v_sub_f32 v169, v169, v118
    v_sub_f32 v226, v226, v118
    v_mfma_f32_16x16x32_f16 v[242:245], v[158:161], v[150:153], v[66:69]
    s_waitcnt lgkmcnt(2)
    v_exp_f32 v169, v169
    v_mfma_f32_16x16x32_bf16 v[114:117], a[216:219], v[214:217], 0
    s_waitcnt lgkmcnt(1)
    v_cvt_pk_bf16_f32 v37, v168, v169
    v_mov_b32_dpp v232, v239 quad_perm:[0,1,2,3] row_mask:0x4 bank_mask:0xf
    v_mov_b32 v118, v232
    v_mfma_f32_16x16x16_f16 v[242:245], v[132:133], v[126:127], v[242:245]
    v_exp_f32 v226, v226
    v_max_f32_dpp v118, v118, v118 quad_perm:[1,0,3,2] row_mask:0xf bank_mask:0xf
    v_cvt_pk_bf16_f32 v39, v226, 0
    v_mfma_f32_16x16x32_bf16 v[114:117], a[220:223], v[206:209], v[114:117]
    s_waitcnt lgkmcnt(0)
    v_max_f32_dpp v118, v118, v118 quad_perm:[2,3,0,1] row_mask:0xf bank_mask:0xf
    v_max3_f32 v126, v218, v234, v235
    v_mfma_f32_16x16x32_bf16 v[150:153], v[28:31], v[36:39], 0
    v_max_f32_dpp v118, v118, v118 row_half_mirror row_mask:0xf bank_mask:0xf
    v_max3_f32 v126, v126, v236, v237
    v_mfma_f32_16x16x32_bf16 v[150:153], v[28:31], v[186:189], v[150:153]
    v_max_f32_dpp v118, v118, v118 row_mirror row_mask:0xf bank_mask:0xf
    v_mov_b32 v119, v118
    v_mfma_f32_16x16x32_bf16 v[114:117], a[224:227], v[210:213], v[114:117]
    v_max3_f32 v126, v126, v182, v183
    v_max3_f32 v126, v126, v184, v185
    v_mfma_f32_16x16x32_bf16 v[114:117], a[228:231], v[194:197], v[114:117]
    v_permlane32_swap_b32 v118, v119
    v_mfma_f32_16x16x32_bf16 v[114:117], a[232:235], v[198:201], v[114:117]
    v_rcp_f32 v150, v150
    v_mfma_f32_16x16x32_bf16 v[114:117], a[236:239], v[222:225], v[114:117]
    v_max_f32 v118, v118, v119
    v_mov_b32 v119, v118
    v_max3_f32 v126, v126, v242, v243
    v_max3_f32 v126, v126, v244, v245
    v_permlane16_swap_b32 v118, v119
    v_max_f32 v118, v118, v119
    v_mfma_f32_16x16x32_bf16 v[166:169], v[142:145], v[36:39], 0
    v_sub_f32 v232, v232, v118
    v_mov_b32 v127, v126
    v_mfma_f32_16x16x32_bf16 v[166:169], v[146:149], v[186:189], v[166:169]
    v_exp_f32 v232, v232
    v_permlane32_swap_b32 v126, v127
    v_cvt_pk_bf16_f32 v232, v232, v232
    v_max_f32 v126, v126, v127
    v_mov_b32 v127, v126
    v_fma_f32 v254, v122, v122, s33
    v_fmac_f32 v254, v123, v123
    v_permlane16_swap_b32 v126, v127
    v_mul_f32 v166, v150, v166
    v_mul_f32 v167, v150, v167
    v_cvt_pk_bf16_f32 v166, v166, v167
    v_mul_f32 v168, v150, v168
    v_mul_f32 v169, v150, v169
    v_cvt_pk_bf16_f32 v167, v168, v169
    v_max_f32 v126, v126, v127
    v_sub_f32 v234, v234, v126
    v_exp_f32 v234, v234
    v_sub_f32 v235, v235, v126
    v_exp_f32 v235, v235
    v_sub_f32 v236, v236, v126
    v_cvt_pk_bf16_f32 v226, v234, v235
    v_exp_f32 v236, v236
    v_sub_f32 v237, v237, v126
    v_exp_f32 v237, v237
    v_sub_f32 v182, v182, v126
    v_cvt_pk_bf16_f32 v227, v236, v237
    v_mfma_f32_16x16x32_bf16 v[234:237], v[170:173], v[36:39], 0
    ds_write_b16 v8, v232
    v_mfma_f32_16x16x32_bf16 v[234:237], v[174:177], v[186:189], v[234:237]
    v_exp_f32 v182, v182
    v_sub_f32 v183, v183, v126
    v_exp_f32 v183, v183
    v_sub_f32 v184, v184, v126
    v_cvt_pk_bf16_f32 v228, v182, v183
    v_exp_f32 v184, v184
    v_sub_f32 v185, v185, v126
    v_exp_f32 v185, v185
    v_mul_f32 v234, v150, v234
    v_mul_f32 v235, v150, v235
    v_cvt_pk_bf16_f32 v168, v234, v235
    v_mul_f32 v236, v150, v236
    v_mul_f32 v237, v150, v237
    v_cvt_pk_bf16_f32 v169, v236, v237
    v_mfma_f32_16x16x32_bf16 v[230:233], v[190:193], v[36:39], 0
    ds_write_b128 v3, v[166:169] offset:0
    v_mfma_f32_16x16x32_bf16 v[230:233], v[134:137], v[186:189], v[230:233]
    v_cvt_pk_bf16_f32 v229, v184, v185
    v_sub_f32 v242, v242, v126
    v_mfma_f32_16x16x32_f16 v[182:185], v[178:181], v[162:165], v[70:73]
    v_exp_f32 v242, v242
    v_mfma_f32_16x16x32_bf16 v[166:169], a[240:243], v[214:217], 0
    ds_read_b128 v[178:181], v9
    v_sub_f32 v243, v243, v126
    v_mfma_f32_16x16x32_bf16 v[166:169], a[244:247], v[206:209], v[166:169]
    v_mul_f32 v230, v150, v230
    v_mul_f32 v231, v150, v231
    v_cvt_pk_bf16_f32 v220, v230, v231
    v_mfma_f32_16x16x16_f16 v[182:185], v[120:121], v[130:131], v[182:185]
    v_mul_f32 v232, v150, v232
    v_mul_f32 v233, v150, v233
    v_cvt_pk_bf16_f32 v221, v232, v233
    v_sub_f32 v244, v244, v126
    v_mfma_f32_16x16x32_bf16 v[166:169], a[248:251], v[210:213], v[166:169]
    ds_read_b128 v[118:121], v9 offset:64
    v_sub_f32 v245, v245, v126
    v_mfma_f32_16x16x32_bf16 v[166:169], a[252:255], v[194:197], v[166:169]
    ds_write_b64 v4, v[220:221] offset:4096
    v_mfma_f32_16x16x32_bf16 v[166:169], v[82:85], v[198:201], v[166:169]
    v_max3_f32 v255, v238, v182, v183
    v_max3_f32 v255, v255, v184, v185
    v_mfma_f32_16x16x32_bf16 v[166:169], v[86:89], v[222:225], v[166:169]
    v_exp_f32 v243, v243
    v_exp_f32 v244, v244
    v_cvt_pk_bf16_f32 v36, v242, v243
    v_mfma_f32_16x16x32_f16 v[186:189], v[138:141], v[162:165], v[74:77]
    s_waitcnt lgkmcnt(2)
    v_exp_f32 v245, v245
    v_mfma_f32_16x16x32_f16 v[246:249], v[158:161], v[162:165], v[78:81]
    v_cvt_pk_bf16_f32 v37, v244, v245
    v_sub_f32 v218, v218, v126
    v_mfma_f32_16x16x32_bf16 v[242:245], v[178:181], v[28:31], 0
    v_exp_f32 v218, v218
    v_fmac_f32 v254, v124, v124
    v_mfma_f32_16x16x16_f16 v[186:189], v[128:129], v[130:131], v[186:189]
    v_cvt_pk_bf16_f32 v39, v218, 0
    v_fmac_f32 v254, v125, v125
    v_fmac_f32 v254, v154, v154
    v_mfma_f32_16x16x16_f16 v[246:249], v[132:133], v[130:131], v[246:249]
    v_fmac_f32 v254, v155, v155
    v_fmac_f32 v254, v156, v156
    v_fmac_f32 v254, v157, v157
    v_fmac_f32 v254, v202, v202
    v_mfma_f32_16x16x32_bf16 v[126:129], v[28:31], v[36:39], 0
    s_waitcnt lgkmcnt(0)
    v_max3_f32 v255, v255, v186, v187
    v_max3_f32 v255, v255, v188, v189
    v_mfma_f32_16x16x32_bf16 v[126:129], v[28:31], v[226:229], v[126:129]
    v_max3_f32 v255, v255, v246, v247
    v_max3_f32 v255, v255, v248, v249
    v_mfma_f32_16x16x32_bf16 v[130:133], v[142:145], v[36:39], 0
    v_mov_b32 v239, v255
    v_fmac_f32 v254, v203, v203
    v_mfma_f32_16x16x32_bf16 v[130:133], v[146:149], v[226:229], v[130:133]
    v_permlane32_swap_b32 v255, v239
    v_mfma_f32_16x16x32_bf16 v[138:141], v[170:173], v[36:39], 0
    v_rcp_f32 v126, v126
    v_mfma_f32_16x16x32_bf16 v[138:141], v[174:177], v[226:229], v[138:141]
    v_max_f32 v255, v255, v239
    v_mov_b32 v239, v255
    v_mfma_f32_16x16x32_bf16 v[150:153], v[190:193], v[36:39], 0
    v_fmac_f32 v254, v204, v204
    v_mul_f32 v130, v126, v130
    v_mfma_f32_16x16x32_bf16 v[150:153], v[134:137], v[226:229], v[150:153]
    v_mul_f32 v131, v126, v131
    v_cvt_pk_bf16_f32 v130, v130, v131
    v_mfma_f32_16x16x32_bf16 v[242:245], v[118:121], v[28:31], v[242:245]
    v_mul_f32 v132, v126, v132
    v_mul_f32 v133, v126, v133
    v_mfma_f32_16x16x32_bf16 v[218:221], v[178:181], v[146:149], 0
    v_cvt_pk_bf16_f32 v131, v132, v133
    v_mul_f32 v138, v126, v138
    v_mfma_f32_16x16x32_bf16 v[218:221], v[118:121], v[142:145], v[218:221]
    v_mul_f32 v139, v126, v139
    v_cvt_pk_bf16_f32 v132, v138, v139
    v_mfma_f32_16x16x32_bf16 v[226:229], v[178:181], v[174:177], 0
    v_mul_f32 v140, v126, v140
    v_mul_f32 v141, v126, v141
    v_mfma_f32_16x16x32_bf16 v[226:229], v[118:121], v[170:173], v[226:229]
    v_cvt_pk_bf16_f32 v133, v140, v141
    v_mul_f32 v150, v126, v150
    v_mfma_f32_16x16x32_bf16 v[250:253], v[178:181], v[134:137], 0
    ds_write_b128 v3, v[130:133] offset:6144
    v_mfma_f32_16x16x32_bf16 v[250:253], v[118:121], v[190:193], v[250:253]
    v_mul_f32 v151, v126, v151
    v_cvt_pk_bf16_f32 v240, v150, v151
    v_mfma_f32_16x16x32_bf16 v[230:233], v[90:93], v[214:217], 0
    v_mul_f32 v152, v126, v152
    v_mul_f32 v153, v126, v153
    v_mfma_f32_16x16x32_bf16 v[230:233], v[94:97], v[206:209], v[230:233]
    ds_read_b128 v[118:121], v2 offset:12288
    ds_read_b128 v[126:129], v2 offset:13312
    v_mfma_f32_16x16x32_bf16 v[230:233], v[98:101], v[210:213], v[230:233]
    ds_read_b128 v[130:133], v2 offset:14336
    v_cvt_pk_bf16_f32 v241, v152, v153
    v_mfma_f32_16x16x32_bf16 v[230:233], v[102:105], v[194:197], v[230:233]
    ds_read_b128 v[158:161], v2 offset:15360
    v_fmac_f32 v254, v205, v205
    v_mfma_f32_16x16x32_bf16 v[230:233], v[106:109], v[198:201], v[230:233]
    ds_read_b128 v[178:181], v2 offset:16384
    v_fma_f32 v219, v114, v114, s33
    v_mfma_f32_16x16x32_bf16 v[230:233], v[110:113], v[222:225], v[230:233]
    ds_read_b128 v[194:197], v2 offset:17408
    ds_write_b64 v4, v[240:241] offset:10240
    v_permlane16_swap_b32 v255, v239
    v_max_f32 v255, v255, v239
    v_sub_f32 v182, v182, v255
    v_exp_f32 v182, v182
    v_sub_f32 v183, v183, v255
    v_exp_f32 v183, v183
    s_waitcnt lgkmcnt(5)
    v_mfma_f32_16x16x32_bf16 v[150:153], a[216:219], v[118:121], 0
    v_cvt_pk_bf16_f32 v198, v182, v183
    v_sub_f32 v184, v184, v255
    v_mfma_f32_16x16x32_bf16 v[150:153], a[220:223], v[126:129], v[150:153]
    s_waitcnt lgkmcnt(4)
    v_exp_f32 v184, v184
    v_mfma_f32_16x16x32_bf16 v[150:153], a[224:227], v[130:133], v[150:153]
    s_waitcnt lgkmcnt(3)
    v_sub_f32 v185, v185, v255
    v_sub_f32 v186, v186, v255
    v_mfma_f32_16x16x32_bf16 v[150:153], a[228:231], v[158:161], v[150:153]
    s_waitcnt lgkmcnt(2)
    v_exp_f32 v185, v185
    v_mfma_f32_16x16x32_bf16 v[150:153], a[232:235], v[178:181], v[150:153]
    s_waitcnt lgkmcnt(0)
    v_cvt_pk_bf16_f32 v199, v184, v185
    v_sub_f32 v187, v187, v255
    v_mfma_f32_16x16x32_bf16 v[150:153], a[236:239], v[194:197], v[150:153]
    v_exp_f32 v186, v186
    v_mfma_f32_16x16x32_bf16 v[162:165], a[240:243], v[118:121], 0
    v_exp_f32 v187, v187
    v_mfma_f32_16x16x32_bf16 v[162:165], a[244:247], v[126:129], v[162:165]
    v_cvt_pk_bf16_f32 v200, v186, v187
    v_sub_f32 v188, v188, v255
    v_mfma_f32_16x16x32_bf16 v[162:165], a[248:251], v[130:133], v[162:165]
    v_exp_f32 v188, v188
    v_mfma_f32_16x16x32_bf16 v[162:165], a[252:255], v[158:161], v[162:165]
    v_sub_f32 v189, v189, v255
    v_sub_f32 v246, v246, v255
    v_mfma_f32_16x16x32_bf16 v[162:165], v[82:85], v[178:181], v[162:165]
    v_exp_f32 v189, v189
    v_mfma_f32_16x16x32_bf16 v[162:165], v[86:89], v[194:197], v[162:165]
    v_cvt_pk_bf16_f32 v201, v188, v189
    v_sub_f32 v247, v247, v255
    v_mfma_f32_16x16x32_bf16 v[138:141], v[90:93], v[118:121], 0
    v_exp_f32 v246, v246
    v_mfma_f32_16x16x32_bf16 v[138:141], v[94:97], v[126:129], v[138:141]
    v_exp_f32 v247, v247
    v_mfma_f32_16x16x32_bf16 v[138:141], v[98:101], v[130:133], v[138:141]
    v_cvt_pk_bf16_f32 v36, v246, v247
    v_sub_f32 v248, v248, v255
    v_mfma_f32_16x16x32_bf16 v[138:141], v[102:105], v[158:161], v[138:141]
    v_exp_f32 v248, v248
    v_mfma_f32_16x16x32_bf16 v[138:141], v[106:109], v[178:181], v[138:141]
    v_sub_f32 v249, v249, v255
    v_sub_f32 v238, v238, v255
    v_mfma_f32_16x16x32_bf16 v[138:141], v[110:113], v[194:197], v[138:141]
    ds_read_b128 v[186:189], v0 offset:20480
    ds_read_b128 v[118:121], v1 offset:20480
    ds_read_b128 v[234:237], v0 offset:20608
    v_exp_f32 v249, v249
    v_exp_f32 v238, v238
    v_cvt_pk_bf16_f32 v37, v248, v249
    v_cvt_pk_bf16_f32 v39, v238, 0
    v_fma_f32 v255, v150, v150, s33
    v_fmac_f32 v255, v151, v151
    v_mfma_f32_16x16x32_bf16 v[126:129], v[28:31], v[36:39], 0
    ds_read_b128 v[158:161], v1 offset:20608
    ds_read_b128 v[182:185], v0 offset:20736
    v_mfma_f32_16x16x32_bf16 v[126:129], v[28:31], v[198:201], v[126:129]
    ds_read_b128 v[206:209], v1 offset:20736
    v_fmac_f32 v255, v152, v152
    v_mfma_f32_16x16x32_bf16 v[178:181], v[142:145], v[36:39], 0
    v_fmac_f32 v255, v153, v153
    v_fmac_f32 v255, v162, v162
    v_mfma_f32_16x16x32_bf16 v[178:181], v[146:149], v[198:201], v[178:181]
    v_fmac_f32 v255, v163, v163
    v_fmac_f32 v255, v164, v164
    v_mfma_f32_16x16x32_bf16 v[142:145], v[170:173], v[36:39], 0
    s_waitcnt lgkmcnt(5)
    v_rcp_f32 v126, v126
    v_mfma_f32_16x16x32_bf16 v[142:145], v[174:177], v[198:201], v[142:145]
    s_waitcnt lgkmcnt(3)
    v_fmac_f32 v255, v165, v165
    v_mul_f32 v178, v126, v178
    v_mfma_f32_16x16x32_bf16 v[146:149], v[190:193], v[36:39], 0
    v_mul_f32 v179, v126, v179
    v_cvt_pk_bf16_f32 v170, v178, v179
    v_mfma_f32_16x16x32_bf16 v[146:149], v[134:137], v[198:201], v[146:149]
    v_mul_f32 v180, v126, v180
    v_mul_f32 v181, v126, v181
    v_mfma_f32_16x16x32_bf16 v[130:133], a[72:75], v[186:189], 0
    s_waitcnt lgkmcnt(1)
    v_cvt_pk_bf16_f32 v171, v180, v181
    v_mul_f32 v142, v126, v142
    v_mfma_f32_16x16x32_bf16 v[130:133], a[76:79], v[118:121], v[130:133]
    s_waitcnt lgkmcnt(0)
    v_mul_f32 v143, v126, v143
    v_cvt_pk_bf16_f32 v172, v142, v143
    v_mfma_f32_16x16x32_bf16 v[130:133], a[80:83], v[234:237], v[130:133]
    v_mul_f32 v144, v126, v144
    v_mul_f32 v145, v126, v145
    v_mfma_f32_16x16x32_bf16 v[130:133], a[84:87], v[158:161], v[130:133]
    v_cvt_pk_bf16_f32 v173, v144, v145
    v_mul_f32 v146, v126, v146
    v_mfma_f32_16x16x32_bf16 v[130:133], a[88:91], v[182:185], v[130:133]
    ds_write_b128 v3, v[170:173] offset:12288
    v_mfma_f32_16x16x32_bf16 v[130:133], a[92:95], v[206:209], v[130:133]
    v_mul_f32 v147, v126, v147
    v_cvt_pk_bf16_f32 v220, v146, v147
    v_mfma_f32_16x16x32_bf16 v[134:137], a[96:99], v[186:189], 0
    v_mul_f32 v148, v126, v148
    v_mul_f32 v149, v126, v149
    v_mfma_f32_16x16x32_bf16 v[134:137], a[100:103], v[118:121], v[134:137]
    v_cvt_pk_bf16_f32 v221, v148, v149
    v_fmac_f32 v255, v138, v138
    v_mfma_f32_16x16x32_bf16 v[134:137], a[104:107], v[234:237], v[134:137]
    ds_write_b64 v4, v[220:221] offset:16384
    v_mfma_f32_16x16x32_bf16 v[134:137], a[108:111], v[158:161], v[134:137]
    v_fmac_f32 v255, v139, v139
    v_fmac_f32 v255, v140, v140
    v_mfma_f32_16x16x32_bf16 v[134:137], a[112:115], v[182:185], v[134:137]
    v_fmac_f32 v255, v141, v141
    v_cvt_pk_bf16_f32 v255, v255, v255
    v_mfma_f32_16x16x32_bf16 v[134:137], a[116:119], v[206:209], v[134:137]
    v_rcp_f32 v242, v242
    v_mfma_f32_16x16x32_bf16 v[170:173], a[120:123], v[186:189], 0
    v_mul_f32 v218, v218, v242
    v_mul_f32_dpp v218, v226, v242 quad_perm:[0,1,2,3] row_mask:0x2 bank_mask:0xf
    v_mfma_f32_16x16x32_bf16 v[170:173], a[124:127], v[118:121], v[170:173]
    v_mul_f32_dpp v218, v250, v242 quad_perm:[0,1,2,3] row_mask:0x4 bank_mask:0xf
    v_cvt_pk_bf16_f32 v218, v218, v218
    v_mfma_f32_16x16x32_bf16 v[170:173], a[128:131], v[234:237], v[170:173]
    ds_write_b16 v7, v218
    v_mfma_f32_16x16x32_bf16 v[170:173], a[132:135], v[158:161], v[170:173]
    v_fmac_f32 v219, v115, v115
    v_fmac_f32 v219, v116, v116
    v_mfma_f32_16x16x32_bf16 v[170:173], a[136:139], v[182:185], v[170:173]
    v_fmac_f32 v219, v117, v117
    v_fmac_f32 v219, v166, v166
    v_mfma_f32_16x16x32_bf16 v[170:173], a[140:143], v[206:209], v[170:173]
    v_fmac_f32 v219, v167, v167
    v_fmac_f32 v219, v168, v168
    v_mfma_f32_16x16x32_bf16 v[142:145], a[0:3], v[186:189], 0
    v_fmac_f32 v219, v169, v169
    v_fmac_f32 v219, v230, v230
    v_mfma_f32_16x16x32_bf16 v[142:145], a[4:7], v[118:121], v[142:145]
    v_fmac_f32 v219, v231, v231
    v_fmac_f32 v219, v232, v232
    v_mfma_f32_16x16x32_bf16 v[142:145], a[8:11], v[234:237], v[142:145]
    v_fmac_f32 v219, v233, v233
    v_cvt_pk_bf16_f32 v254, v254, v219
    v_mfma_f32_16x16x32_bf16 v[142:145], a[12:15], v[158:161], v[142:145]
    ds_write_b64 v4, v[254:255] offset:18432
    v_mfma_f32_16x16x32_bf16 v[142:145], a[16:19], v[182:185], v[142:145]
    v_fma_f32 v174, v130, v130, s32
    v_fmac_f32 v174, v131, v131
    v_mfma_f32_16x16x32_bf16 v[142:145], a[20:23], v[206:209], v[142:145]
    v_fmac_f32 v174, v132, v132
    v_fmac_f32 v174, v133, v133
    v_mfma_f32_16x16x32_bf16 v[126:129], a[24:27], v[186:189], 0
    v_xor_b32 v2, 65536, v2
    v_xor_b32 v3, 65536, v3
    v_mfma_f32_16x16x32_bf16 v[126:129], a[28:31], v[118:121], v[126:129]
    v_xor_b32 v4, 65536, v4
    v_add_u32 v5, s74, v5
    v_mfma_f32_16x16x32_bf16 v[126:129], a[32:35], v[234:237], v[126:129]
    v_add_u32 v6, s75, v6
    v_add_u32 v7, s76, v7
    v_mfma_f32_16x16x32_bf16 v[126:129], a[36:39], v[158:161], v[126:129]
    v_mfma_f32_16x16x32_bf16 v[126:129], a[40:43], v[182:185], v[126:129]
    s_waitcnt lgkmcnt(0)
    s_nop 0
    s_barrier
    s_nop 0
    s_nop 0
    v_mfma_f32_16x16x32_bf16 v[126:129], a[44:47], v[206:209], v[126:129]
    s_cbranch_scc1 L_loop_safe1
    s_branch L_final_safe
.p2align 6
L_loop_safe2:
    v_mfma_f32_16x16x32_bf16 v[190:193], a[48:51], v[186:189], 0
    s_add_u32 s12, s40, s27
    ds_read_b128 v[146:149], v2 offset:18432
    ds_read_b128 v[178:181], v2 offset:19456
    v_mfma_f32_16x16x32_bf16 v[190:193], a[52:55], v[118:121], v[190:193]
    s_addc_u32 s13, s41, 0
    v_fmac_f32 v174, v134, v134
    v_fmac_f32 v174, v135, v135
    v_mfma_f32_16x16x32_bf16 v[190:193], a[56:59], v[234:237], v[190:193]
    s_sub_u32 s14, s36, s27
    v_fmac_f32 v174, v136, v136
    v_fmac_f32 v174, v137, v137
    v_mfma_f32_16x16x32_bf16 v[190:193], a[60:63], v[158:161], v[190:193]
    s_cmp_ge_u32 s18, 2
    v_fmac_f32 v174, v170, v170
    v_fmac_f32 v174, v171, v171
    v_mfma_f32_16x16x32_bf16 v[190:193], a[64:67], v[182:185], v[190:193]
    s_cselect_b32 s14, s14, 0
    v_fmac_f32 v174, v172, v172
    v_fmac_f32 v174, v173, v173
    v_mfma_f32_16x16x32_bf16 v[190:193], a[68:71], v[206:209], v[190:193]
    s_sub_u32 s82, s72, s71
    v_fma_f32 v254, v142, v142, s32
    v_fmac_f32 v254, v143, v143
    v_mfma_f32_16x16x32_bf16 v[194:197], v[186:189], a[144:147], 0
    s_mul_i32 s74, s82, 336
    v_fmac_f32 v254, v144, v144
    v_fmac_f32 v254, v145, v145
    v_mfma_f32_16x16x32_bf16 v[194:197], v[118:121], a[148:151], v[194:197]
    s_mul_i32 s75, s82, 272
    v_fmac_f32 v254, v126, v126
    v_fmac_f32 v254, v127, v127
    v_mfma_f32_16x16x32_bf16 v[194:197], v[234:237], a[152:155], v[194:197]
    s_waitcnt lgkmcnt(0)
    v_fmac_f32 v254, v128, v128
    v_fmac_f32 v254, v129, v129
    v_mfma_f32_16x16x32_bf16 v[198:201], v[32:35], v[146:149], 0
    s_mul_i32 s76, s82, 16
    v_fmac_f32 v254, v190, v190
    v_fmac_f32 v254, v191, v191
    v_mfma_f32_16x16x32_bf16 v[198:201], v[32:35], v[178:181], v[198:201]
    s_add_u32 s34, s18, 2
    v_fmac_f32 v254, v192, v192
    v_fmac_f32 v254, v193, v193
    v_mfma_f32_16x16x32_bf16 v[194:197], v[158:161], a[156:159], v[194:197]
    s_add_u32 s8, s60, s23
    v_cvt_pk_bf16_f32 v36, v254, v174
    s_addc_u32 s9, s61, 0
    v_mfma_f32_16x16x32_bf16 v[194:197], v[182:185], a[160:163], v[194:197]
    s_sub_u32 s10, s36, s23
    v_mul_f32 v254, 0x3baaaaab, v198
    v_mul_f32 v255, 0x3baaaaab, v199
    v_mfma_f32_16x16x32_bf16 v[210:213], v[32:35], v[36:39], 0
    s_cmp_le_u32 s34, s45
    v_rsq_f32 v254, v254
    v_mfma_f32_16x16x32_bf16 v[194:197], v[206:209], a[164:167], v[194:197]
    s_cselect_b32 s10, s10, 0
    ds_read_b128 v[214:217], v0 offset:26624
    v_mul_f32 v148, 0x3baaaaab, v200
    v_mfma_f32_16x16x32_bf16 v[174:177], v[186:189], a[168:171], 0
    s_add_u32 m0, s28, 0
    ds_read_b128 v[198:201], v1 offset:26624
    v_mul_f32 v122, v254, v122
    v_mfma_f32_16x16x32_bf16 v[174:177], v[118:121], a[172:175], v[174:177]
    s_mov_b32 s27, s26
    ds_read_b128 v[218:221], v0 offset:26752
    v_cvt_pk_bf16_f32 v146, v194, v195
    v_mfma_f32_16x16x32_bf16 v[174:177], v[234:237], a[176:179], v[174:177]
    s_mov_b32 s26, s25
    ds_read_b128 v[222:225], v1 offset:26752
    v_cvt_pk_bf16_f32 v147, v196, v197
    v_mfma_f32_16x16x32_bf16 v[174:177], v[158:161], a[180:183], v[174:177]
    s_mov_b32 s25, s24
    v_rsq_f32 v211, v211
    v_mfma_f32_16x16x32_bf16 v[174:177], v[182:185], a[184:187], v[174:177]
    s_mov_b32 s24, s23
    v_rsq_f32 v210, v210
    v_mfma_f32_16x16x32_bf16 v[174:177], v[206:209], a[188:191], v[174:177]
    s_ff1_i32_b32 s80, s100
    v_mul_f32 v210, s31, v210
    v_mul_f32 v130, v211, v130
    v_mul_f32 v131, v211, v131
    v_cvt_pk_f16_f32 v178, v130, v131
    v_mfma_f32_16x16x32_bf16 v[194:197], v[186:189], a[192:195], 0
    s_waitcnt lgkmcnt(3)
    ds_read_b128 v[186:189], v0 offset:26880
    v_cvt_pk_bf16_f32 v174, v174, v175
    v_mfma_f32_16x16x32_bf16 v[194:197], v[118:121], a[196:199], v[194:197]
    s_mov_b32 s71, s72
    ds_read_b128 v[226:229], v1 offset:26880
    v_cvt_pk_bf16_f32 v175, v176, v177
    v_mfma_f32_16x16x32_bf16 v[194:197], v[234:237], a[200:203], v[194:197]
    s_mov_b32 s72, s73
    v_mul_f32 v132, v211, v132
    v_mul_f32 v133, v211, v133
    v_mfma_f32_16x16x32_bf16 v[194:197], v[158:161], a[204:207], v[194:197]
    s_waitcnt lgkmcnt(2)
    v_cvt_pk_f16_f32 v179, v132, v133
    v_mul_f32 v134, v211, v134
    v_mfma_f32_16x16x32_bf16 v[194:197], v[182:185], a[208:211], v[194:197]
    v_mul_f32 v135, v211, v135
    v_cvt_pk_f16_f32 v180, v134, v135
    v_mfma_f32_16x16x32_bf16 v[194:197], v[206:209], a[212:215], v[194:197]
    v_mul_f32 v136, v211, v136
    v_mul_f32 v137, v211, v137
    v_mfma_f32_16x16x32_bf16 v[130:133], a[72:75], v[214:217], 0
    v_cvt_pk_f16_f32 v181, v136, v137
    v_mul_f32 v170, v211, v170
    v_mfma_f32_16x16x32_bf16 v[130:133], a[76:79], v[198:201], v[130:133]
    v_mul_f32 v171, v211, v171
    v_cvt_pk_f16_f32 v120, v170, v171
    v_mfma_f32_16x16x32_bf16 v[130:133], a[80:83], v[218:221], v[130:133]
    s_waitcnt lgkmcnt(1)
    v_cvt_pk_bf16_f32 v134, v194, v195
    v_cvt_pk_bf16_f32 v135, v196, v197
    v_mfma_f32_16x16x32_bf16 v[130:133], a[84:87], v[222:225], v[130:133]
    s_waitcnt lgkmcnt(0)
    v_mul_f32 v172, v211, v172
    v_mul_f32 v173, v211, v173
    v_mfma_f32_16x16x32_bf16 v[130:133], a[88:91], v[186:189], v[130:133]
    v_cvt_pk_f16_f32 v121, v172, v173
    v_mul_f32 v142, v210, v142
    v_mfma_f32_16x16x32_bf16 v[130:133], a[92:95], v[226:229], v[130:133]
    v_mul_f32 v143, v210, v143
    v_cvt_pk_f16_f32 v194, v142, v143
    v_mfma_f32_16x16x32_bf16 v[158:161], a[96:99], v[214:217], 0
    v_mul_f32 v144, v210, v144
    v_mul_f32 v145, v210, v145
    v_mfma_f32_16x16x32_bf16 v[158:161], a[100:103], v[198:201], v[158:161]
    v_cvt_pk_f16_f32 v195, v144, v145
    v_mul_f32 v126, v210, v126
    v_mfma_f32_16x16x32_bf16 v[158:161], a[104:107], v[218:221], v[158:161]
    v_mul_f32 v127, v210, v127
    v_cvt_pk_f16_f32 v196, v126, v127
    v_mfma_f32_16x16x32_bf16 v[158:161], a[108:111], v[222:225], v[158:161]
    v_mul_f32 v128, v210, v128
    v_mul_f32 v129, v210, v129
    v_mfma_f32_16x16x32_bf16 v[158:161], a[112:115], v[186:189], v[158:161]
    v_cvt_pk_f16_f32 v197, v128, v129
    v_mul_f32 v190, v210, v190
    v_mfma_f32_16x16x32_bf16 v[158:161], a[116:119], v[226:229], v[158:161]
    v_mul_f32 v191, v210, v191
    v_cvt_pk_f16_f32 v118, v190, v191
    v_mfma_f32_16x16x32_bf16 v[142:145], a[120:123], v[214:217], 0
    v_mul_f32 v192, v210, v192
    v_mul_f32 v193, v210, v193
    v_mfma_f32_16x16x32_bf16 v[142:145], a[124:127], v[198:201], v[142:145]
    v_cvt_pk_f16_f32 v119, v192, v193
    v_fma_f32 v149, v130, v130, s32
    v_mfma_f32_16x16x32_bf16 v[142:145], a[128:131], v[218:221], v[142:145]
    v_fmac_f32 v149, v131, v131
    v_fmac_f32 v149, v132, v132
    v_mfma_f32_16x16x32_bf16 v[142:145], a[132:135], v[222:225], v[142:145]
    v_fmac_f32 v149, v133, v133
    v_fmac_f32 v149, v158, v158
    v_mfma_f32_16x16x32_bf16 v[142:145], a[136:139], v[186:189], v[142:145]
    v_fmac_f32 v149, v159, v159
    v_fmac_f32 v149, v160, v160
    v_mfma_f32_16x16x32_bf16 v[142:145], a[140:143], v[226:229], v[142:145]
    v_fmac_f32 v149, v161, v161
    v_mul_f32 v123, v254, v123
    v_mfma_f32_16x16x32_bf16 v[170:173], a[0:3], v[214:217], 0
    v_rsq_f32 v255, v255
    v_mfma_f32_16x16x32_bf16 v[170:173], a[4:7], v[198:201], v[170:173]
    v_rsq_f32 v148, v148
    v_mfma_f32_16x16x32_bf16 v[170:173], a[8:11], v[218:221], v[170:173]
    v_mul_f32 v150, v148, v150
    v_fmac_f32 v149, v142, v142
    v_mfma_f32_16x16x32_bf16 v[170:173], a[12:15], v[222:225], v[170:173]
    v_fmac_f32 v149, v143, v143
    v_fmac_f32 v149, v144, v144
    v_mfma_f32_16x16x32_bf16 v[170:173], a[16:19], v[186:189], v[170:173]
    v_fmac_f32 v149, v145, v145
    v_mul_f32 v151, v148, v151
    v_mfma_f32_16x16x32_bf16 v[170:173], a[20:23], v[226:229], v[170:173]
    v_cvt_pk_bf16_f32 v126, v150, v151
    v_mul_f32 v152, v148, v152
    v_mfma_f32_16x16x32_bf16 v[182:185], a[24:27], v[214:217], 0
    v_mul_f32 v153, v148, v153
    v_cvt_pk_bf16_f32 v127, v152, v153
    v_mfma_f32_16x16x32_bf16 v[182:185], a[28:31], v[198:201], v[182:185]
    v_mul_f32 v162, v148, v162
    v_mul_f32 v163, v148, v163
    v_mfma_f32_16x16x32_bf16 v[182:185], a[32:35], v[218:221], v[182:185]
    v_fma_f32 v136, v170, v170, s32
    v_fmac_f32 v136, v171, v171
    v_mfma_f32_16x16x32_bf16 v[182:185], a[36:39], v[222:225], v[182:185]
    v_fmac_f32 v136, v172, v172
    v_fmac_f32 v136, v173, v173
    v_mfma_f32_16x16x32_bf16 v[182:185], a[40:43], v[186:189], v[182:185]
    v_cvt_pk_bf16_f32 v128, v162, v163
    v_mul_f32 v164, v148, v164
    v_mfma_f32_16x16x32_bf16 v[182:185], a[44:47], v[226:229], v[182:185]
    v_mul_f32 v165, v148, v165
    v_cvt_pk_bf16_f32 v129, v164, v165
    v_mfma_f32_16x16x32_bf16 v[162:165], a[48:51], v[214:217], 0
    buffer_store_dwordx4 v[126:129], v17, s[12:15], 0 offen nt
    v_mul_f32 v138, v148, v138
    v_mul_f32 v139, v148, v139
    v_cvt_pk_bf16_f32 v176, v138, v139
    v_mul_f32 v140, v148, v140
    v_mfma_f32_16x16x32_bf16 v[162:165], a[52:55], v[198:201], v[162:165]
    v_fmac_f32 v136, v182, v182
    v_fmac_f32 v136, v183, v183
    v_mfma_f32_16x16x32_bf16 v[162:165], a[56:59], v[218:221], v[162:165]
    v_fmac_f32 v136, v184, v184
    v_fmac_f32 v136, v185, v185
    v_mfma_f32_16x16x32_bf16 v[162:165], a[60:63], v[222:225], v[162:165]
    v_mul_f32 v141, v148, v141
    v_cvt_pk_bf16_f32 v177, v140, v141
    v_mfma_f32_16x16x32_bf16 v[162:165], a[64:67], v[186:189], v[162:165]
    v_cvt_pk_bf16_f32 v190, v122, v123
    v_mul_f32 v124, v254, v124
    v_mfma_f32_16x16x32_bf16 v[162:165], a[68:71], v[226:229], v[162:165]
    v_mul_f32 v125, v254, v125
    v_cvt_pk_bf16_f32 v191, v124, v125
    v_mfma_f32_16x16x32_bf16 v[122:125], v[214:217], a[144:147], 0
    v_mul_f32 v154, v254, v154
    v_mul_f32 v155, v254, v155
    v_mfma_f32_16x16x32_bf16 v[122:125], v[198:201], a[148:151], v[122:125]
    v_cvt_pk_bf16_f32 v192, v154, v155
    v_mul_f32 v156, v254, v156
    v_mfma_f32_16x16x32_bf16 v[122:125], v[218:221], a[152:155], v[122:125]
    v_fmac_f32 v136, v162, v162
    v_fmac_f32 v136, v163, v163
    v_mfma_f32_16x16x32_bf16 v[122:125], v[222:225], a[156:159], v[122:125]
    v_fmac_f32 v136, v164, v164
    v_fmac_f32 v136, v165, v165
    v_mfma_f32_16x16x32_bf16 v[122:125], v[186:189], a[160:163], v[122:125]
    v_cvt_pk_bf16_f32 v36, v136, v149
    v_mul_f32 v157, v254, v157
    v_mfma_f32_16x16x32_bf16 v[122:125], v[226:229], a[164:167], v[122:125]
    ds_read_b128 v[206:209], v0 offset:32768
    v_cvt_pk_bf16_f32 v193, v156, v157
    v_mfma_f32_16x16x32_bf16 v[154:157], v[32:35], v[36:39], 0
    v_mul_f32 v202, v254, v202
    v_mul_f32 v203, v254, v203
    v_mfma_f32_16x16x32_bf16 v[126:129], v[214:217], a[168:171], 0
    ds_read_b128 v[210:213], v1 offset:32768
    v_cvt_pk_bf16_f32 v234, v202, v203
    v_mfma_f32_16x16x32_bf16 v[126:129], v[198:201], a[172:175], v[126:129]
    ds_read_b128 v[238:241], v0 offset:32896
    v_cvt_pk_bf16_f32 v148, v122, v123
    v_mfma_f32_16x16x32_bf16 v[126:129], v[218:221], a[176:179], v[126:129]
    ds_read_b128 v[242:245], v1 offset:32896
    v_cvt_pk_bf16_f32 v149, v124, v125
    v_mfma_f32_16x16x32_bf16 v[126:129], v[222:225], a[180:183], v[126:129]
    v_rsq_f32 v155, v155
    v_mfma_f32_16x16x32_bf16 v[126:129], v[186:189], a[184:187], v[126:129]
    buffer_store_dwordx2 v[176:177], v20, s[12:15], 0 offen nt
    v_rsq_f32 v154, v154
    v_mfma_f32_16x16x32_bf16 v[126:129], v[226:229], a[188:191], v[126:129]
    s_waitcnt lgkmcnt(3)
    v_mul_f32 v154, s31, v154
    v_mul_f32 v130, v155, v130
    v_mul_f32 v131, v155, v131
    v_cvt_pk_f16_f32 v138, v130, v131
    v_mfma_f32_16x16x32_bf16 v[122:125], v[214:217], a[192:195], 0
    ds_read_b128 v[214:217], v0 offset:33024
    v_mul_f32 v132, v155, v132
    v_mfma_f32_16x16x32_bf16 v[122:125], v[198:201], a[196:199], v[122:125]
    s_waitcnt lgkmcnt(3)
    ds_read_b128 v[198:201], v1 offset:33024
    v_cvt_pk_bf16_f32 v176, v126, v127
    v_mfma_f32_16x16x32_bf16 v[122:125], v[218:221], a[200:203], v[122:125]
    s_waitcnt lgkmcnt(3)
    v_cvt_pk_bf16_f32 v177, v128, v129
    v_mul_f32 v133, v155, v133
    v_mfma_f32_16x16x32_bf16 v[122:125], v[222:225], a[204:207], v[122:125]
    s_waitcnt vmcnt(2)
    ds_write_b16 v8, v45 offset:512
    v_mfma_f32_16x16x32_bf16 v[122:125], v[186:189], a[208:211], v[122:125]
    s_waitcnt lgkmcnt(3)
    v_cvt_pk_f16_f32 v139, v132, v133
    v_mfma_f32_16x16x32_bf16 v[122:125], v[226:229], a[212:215], v[122:125]
    v_mul_f32 v158, v155, v158
    v_mul_f32 v159, v155, v159
    v_mfma_f32_16x16x32_bf16 v[130:133], a[72:75], v[206:209], 0
    v_cvt_pk_f16_f32 v140, v158, v159
    v_mul_f32 v160, v155, v160
    v_mfma_f32_16x16x32_bf16 v[130:133], a[76:79], v[210:213], v[130:133]
    v_mul_f32 v161, v155, v161
    v_cvt_pk_f16_f32 v141, v160, v161
    v_mfma_f32_16x16x32_bf16 v[130:133], a[80:83], v[238:241], v[130:133]
    s_waitcnt lgkmcnt(2)
    v_cvt_pk_bf16_f32 v136, v122, v123
    v_cvt_pk_bf16_f32 v137, v124, v125
    v_mfma_f32_16x16x32_bf16 v[130:133], a[84:87], v[242:245], v[130:133]
    s_waitcnt lgkmcnt(1)
    v_mul_f32 v142, v155, v142
    v_mul_f32 v143, v155, v143
    v_mfma_f32_16x16x32_bf16 v[130:133], a[88:91], v[214:217], v[130:133]
    v_cvt_pk_f16_f32 v128, v142, v143
    v_mul_f32 v144, v155, v144
    v_mfma_f32_16x16x32_bf16 v[130:133], a[92:95], v[198:201], v[130:133]
    s_waitcnt lgkmcnt(0)
    v_mul_f32 v145, v155, v145
    v_cvt_pk_f16_f32 v129, v144, v145
    v_mfma_f32_16x16x32_bf16 v[218:221], a[96:99], v[206:209], 0
    v_mul_f32 v170, v154, v170
    v_mul_f32 v171, v154, v171
    v_mfma_f32_16x16x32_bf16 v[218:221], a[100:103], v[210:213], v[218:221]
    v_cvt_pk_f16_f32 v150, v170, v171
    v_mul_f32 v172, v154, v172
    v_mfma_f32_16x16x32_bf16 v[218:221], a[104:107], v[238:241], v[218:221]
    s_barrier
    v_mul_f32 v173, v154, v173
    v_cvt_pk_f16_f32 v151, v172, v173
    v_mfma_f32_16x16x32_bf16 v[218:221], a[108:111], v[242:245], v[218:221]
    buffer_load_dwordx4 v10, s[8:11], 0 offen nt lds
    ds_read_u16 v202, v9 offset:256
    v_mfma_f32_16x16x32_bf16 v[218:221], a[112:115], v[214:217], v[218:221]
    s_add_u32 m0, s28, 4096
    v_mul_f32 v182, v154, v182
    v_mul_f32 v183, v154, v183
    v_mfma_f32_16x16x32_bf16 v[218:221], a[116:119], v[198:201], v[218:221]
    v_cvt_pk_f16_f32 v152, v182, v183
    v_mul_f32 v184, v154, v184
    v_mfma_f32_16x16x32_bf16 v[226:229], a[120:123], v[206:209], 0
    v_mul_f32 v185, v154, v185
    v_cvt_pk_f16_f32 v153, v184, v185
    v_mfma_f32_16x16x32_bf16 v[226:229], a[124:127], v[210:213], v[226:229]
    v_mul_f32 v162, v154, v162
    v_mul_f32 v163, v154, v163
    v_mfma_f32_16x16x32_bf16 v[226:229], a[128:131], v[238:241], v[226:229]
    buffer_load_dwordx4 v11, s[8:11], 0 offen nt lds
    v_cvt_pk_f16_f32 v126, v162, v163
    v_mfma_f32_16x16x32_bf16 v[226:229], a[132:135], v[242:245], v[226:229]
    s_add_u32 m0, s28, 8192
    v_mul_f32 v164, v154, v164
    v_mul_f32 v165, v154, v165
    v_mfma_f32_16x16x32_bf16 v[226:229], a[136:139], v[214:217], v[226:229]
    v_cvt_pk_f16_f32 v127, v164, v165
    v_mul_f32 v204, v254, v204
    v_mfma_f32_16x16x32_bf16 v[226:229], a[140:143], v[198:201], v[226:229]
    s_waitcnt lgkmcnt(0)
    v_readfirstlane_b32 s77, v202
    v_mul_f32 v205, v254, v205
    v_mfma_f32_16x16x32_bf16 v[162:165], a[0:3], v[206:209], 0
    v_cvt_pk_bf16_f32 v235, v204, v205
    v_fma_f32 v236, v130, v130, s32
    v_mfma_f32_16x16x32_bf16 v[162:165], a[4:7], v[210:213], v[162:165]
    buffer_load_dwordx4 v12, s[8:11], 0 offen nt lds
    v_fmac_f32 v236, v131, v131
    v_mfma_f32_16x16x32_bf16 v[162:165], a[8:11], v[238:241], v[162:165]
    s_add_u32 m0, s28, 12288
    v_fmac_f32 v236, v132, v132
    v_fmac_f32 v236, v133, v133
    v_mfma_f32_16x16x32_bf16 v[162:165], a[12:15], v[242:245], v[162:165]
    s_xor_b32 s28, s28, 65536
    v_fmac_f32 v236, v218, v218
    v_fmac_f32 v236, v219, v219
    v_mfma_f32_16x16x32_bf16 v[162:165], a[16:19], v[214:217], v[162:165]
    v_fmac_f32 v236, v220, v220
    v_fmac_f32 v236, v221, v221
    v_mfma_f32_16x16x32_bf16 v[162:165], a[20:23], v[198:201], v[162:165]
    v_fmac_f32 v236, v226, v226
    v_fmac_f32 v236, v227, v227
    v_mfma_f32_16x16x32_bf16 v[246:249], a[24:27], v[206:209], 0
    buffer_load_dwordx4 v13, s[8:11], 0 offen nt lds
    v_fmac_f32 v236, v228, v228
    v_mfma_f32_16x16x32_bf16 v[246:249], a[28:31], v[210:213], v[246:249]
    s_mov_b32 m0, s29
    v_fmac_f32 v236, v229, v229
    v_fma_f32 v237, v162, v162, s32
    v_mfma_f32_16x16x32_bf16 v[246:249], a[32:35], v[238:241], v[246:249]
    s_xor_b32 s29, s29, s30
    v_fmac_f32 v237, v163, v163
    v_fmac_f32 v237, v164, v164
    v_mfma_f32_16x16x32_bf16 v[246:249], a[36:39], v[242:245], v[246:249]
    s_add_u32 s19, s19, s20
    v_fmac_f32 v237, v165, v165
    v_mul_f32 v114, v255, v114
    v_mfma_f32_16x16x32_bf16 v[246:249], a[40:43], v[214:217], v[246:249]
    s_add_u32 s23, s23, s21
    v_mul_f32 v115, v255, v115
    v_cvt_pk_bf16_f32 v114, v114, v115
    v_mfma_f32_16x16x32_bf16 v[246:249], a[44:47], v[198:201], v[246:249]
    v_mul_f32 v116, v255, v116
    v_mfma_f32_16x16x32_bf16 v[122:125], a[48:51], v[206:209], 0
    s_cmp_ge_u32 s19, 72
    v_mul_f32 v117, v255, v117
    v_cvt_pk_bf16_f32 v115, v116, v117
    v_mfma_f32_16x16x32_bf16 v[122:125], a[52:55], v[210:213], v[122:125]
    s_cselect_b32 s34, 72, 0
    s_nop 0
    v_fmac_f32 v237, v246, v246
    v_fmac_f32 v237, v247, v247
    v_mfma_f32_16x16x32_bf16 v[122:125], a[56:59], v[238:241], v[122:125]
    s_cselect_b32 s35, s22, 0
    v_fmac_f32 v237, v248, v248
    v_fmac_f32 v237, v249, v249
    v_mfma_f32_16x16x32_bf16 v[122:125], a[60:63], v[242:245], v[122:125]
    s_sub_u32 s19, s19, s34
    v_mul_f32 v166, v255, v166
    v_mul_f32 v167, v255, v167
    v_mfma_f32_16x16x32_bf16 v[122:125], a[64:67], v[214:217], v[122:125]
    buffer_store_dwordx4 v[190:193], v15, s[12:15], 0 offen nt
    v_cvt_pk_bf16_f32 v116, v166, v167
    v_mul_f32 v168, v255, v168
    v_mul_f32 v169, v255, v169
    v_cvt_pk_bf16_f32 v117, v168, v169
    v_mfma_f32_16x16x32_bf16 v[122:125], a[68:71], v[198:201], v[122:125]
    s_add_u32 s23, s23, s35
    v_mul_f32 v230, v255, v230
    v_mul_f32 v231, v255, v231
    v_mfma_f32_16x16x32_bf16 v[154:157], v[206:209], a[144:147], 0
    s_cmp_lg_u32 s83, 0
    v_cvt_pk_bf16_f32 v254, v230, v231
    v_mul_f32 v232, v255, v232
    v_mfma_f32_16x16x32_bf16 v[154:157], v[210:213], a[148:151], v[154:157]
    s_cselect_b32 s77, s80, s77
    v_fmac_f32 v237, v122, v122
    v_fmac_f32 v237, v123, v123
    v_mfma_f32_16x16x32_bf16 v[154:157], v[238:241], a[152:155], v[154:157]
    s_mul_i32 s78, s77, 2688
    v_fmac_f32 v237, v124, v124
    v_fmac_f32 v237, v125, v125
    v_mfma_f32_16x16x32_bf16 v[154:157], v[242:245], a[156:159], v[154:157]
    s_add_u32 s78, s78, s69
    ds_read2_b32 v[144:145], v6 offset0:0 offset1:0
    ds_read2_b32 v[172:173], v6 offset0:16 offset1:16
    v_mfma_f32_16x16x32_bf16 v[154:157], v[214:217], a[160:163], v[154:157]
    s_add_u32 s80, s77, s68
    ds_read2_b32 v[192:193], v6 offset0:32 offset1:32
    v_cvt_pk_bf16_f32 v36, v237, v236
    v_mfma_f32_16x16x32_bf16 v[154:157], v[198:201], a[164:167], v[154:157]
    s_cmp_ge_u32 s80, 72
    v_mul_f32 v233, v255, v233
    v_cvt_pk_bf16_f32 v255, v232, v233
    v_mfma_f32_16x16x32_bf16 v[230:233], v[32:35], v[36:39], 0
    s_cselect_b32 s80, s22, 0
    v_xor_b32 v0, 65536, v0
    v_xor_b32 v1, 65536, v1
    v_mfma_f32_16x16x32_bf16 v[166:169], v[206:209], a[168:171], 0
    s_add_u32 s78, s78, s80
    v_cvt_pk_bf16_f32 v142, v154, v155
    v_cvt_pk_bf16_f32 v143, v156, v157
    v_mfma_f32_16x16x32_bf16 v[166:169], v[210:213], a[172:175], v[166:169]
    s_add_u32 s80, s77, 20
    v_rsq_f32 v231, v231
    v_mfma_f32_16x16x32_bf16 v[166:169], v[238:241], a[176:179], v[166:169]
    s_add_u32 s34, s18, 3
    v_rsq_f32 v230, v230
    v_mfma_f32_16x16x32_bf16 v[166:169], v[242:245], a[180:183], v[166:169]
    s_cmp_lt_u32 s77, s62
    v_mul_f32 v230, s31, v230
    v_mul_f32 v130, v231, v130
    v_mfma_f32_16x16x32_bf16 v[166:169], v[214:217], a[184:187], v[166:169]
    s_cselect_b32 s79, 1, 0
    v_mul_f32 v131, v231, v131
    v_cvt_pk_f16_f32 v158, v130, v131
    v_mfma_f32_16x16x32_bf16 v[166:169], v[198:201], a[188:191], v[166:169]
    s_cselect_b32 s78, s78, 0
    v_mul_f32 v132, v231, v132
    v_mul_f32 v133, v231, v133
    v_mfma_f32_16x16x32_bf16 v[250:253], v[206:209], a[192:195], 0
    s_cmp_lt_u32 s34, s17
    v_cvt_pk_f16_f32 v159, v132, v133
    v_mul_f32 v218, v231, v218
    v_mfma_f32_16x16x32_bf16 v[250:253], v[210:213], a[196:199], v[250:253]
    s_cselect_b32 s23, s23, s78
    v_cvt_pk_bf16_f32 v170, v166, v167
    v_cvt_pk_bf16_f32 v171, v168, v169
    v_mfma_f32_16x16x32_bf16 v[250:253], v[238:241], a[200:203], v[250:253]
    s_cselect_b32 s73, s34, s80
    ds_read_b128 v[222:225], v5 offset:0
    ds_read_b128 v[202:205], v5 offset:16
    v_mfma_f32_16x16x32_bf16 v[250:253], v[242:245], a[204:207], v[250:253]
    s_cselect_b32 s79, 0, s79
    ds_read_b128 v[154:157], v5 offset:48
    ds_read_b32 v232, v6 offset:192
    v_mfma_f32_16x16x32_bf16 v[250:253], v[214:217], a[208:211], v[250:253]
    s_waitcnt lgkmcnt(4)
    buffer_store_dwordx2 v[234:235], v18, s[12:15], 0 offen nt
    v_mul_f32 v219, v231, v219
    v_cvt_pk_f16_f32 v160, v218, v219
    v_mfma_f32_16x16x32_f16 v[186:189], v[178:181], v[194:197], v[46:49]
    s_cselect_b32 s81, 0, 1
    v_mul_f32 v220, v231, v220
    v_mul_f32 v221, v231, v221
    v_mfma_f32_16x16x32_f16 v[182:185], v[138:141], v[194:197], v[50:53]
    s_add_u32 s80, s77, 1
    v_cvt_pk_f16_f32 v161, v220, v221
    v_mul_f32 v226, v231, v226
    v_mul_f32 v227, v231, v227
    v_mfma_f32_16x16x32_f16 v[166:169], v[158:161], v[194:197], v[54:57]
    s_mul_i32 s80, s80, s81
    v_cvt_pk_f16_f32 v132, v226, v227
    v_mul_f32 v228, v231, v228
    v_mul_f32 v229, v231, v229
    v_mfma_f32_16x16x16_f16 v[186:189], v[120:121], v[118:119], v[186:189]
    v_cvt_pk_f16_f32 v133, v228, v229
    v_mul_f32 v162, v230, v162
    v_mul_f32 v163, v230, v163
    v_mfma_f32_16x16x16_f16 v[182:185], v[128:129], v[118:119], v[182:185]
    v_cvt_pk_f16_f32 v162, v162, v163
    v_mul_f32 v164, v230, v164
    v_mul_f32 v165, v230, v165
    v_mfma_f32_16x16x16_f16 v[166:169], v[132:133], v[118:119], v[166:169]
    v_cvt_pk_f16_f32 v163, v164, v165
    v_mul_f32 v246, v230, v246
    v_mul_f32 v247, v230, v247
    v_cvt_pk_f16_f32 v164, v246, v247
    v_mfma_f32_16x16x32_bf16 v[250:253], v[198:201], a[212:215], v[250:253]
    s_waitcnt lgkmcnt(0)
    ds_read_b128 v[214:217], v2 offset:0
    ds_read_b128 v[206:209], v2 offset:1024
    v_mfma_f32_16x16x32_f16 v[226:229], v[222:225], v[194:197], v[22:25]
    s_cmp_lt_u32 s80, s62
    ds_read_b128 v[210:213], v2 offset:2048
    ds_read_b128 v[194:197], v2 offset:3072
    v_mfma_f32_16x16x32_f16 v[226:229], v[202:205], v[178:181], v[226:229]
    s_cselect_b32 s70, s70, 0
    v_cvt_pk_bf16_f32 v190, v250, v251
    v_cvt_pk_bf16_f32 v191, v252, v253
    v_mfma_f32_16x16x32_f16 v[226:229], v[154:157], v[118:121], v[226:229]
    s_cselect_b32 s62, s62, 0
    ds_read_b128 v[198:201], v2 offset:4096
    v_mul_f32 v248, v230, v248
    v_mul_f32 v249, v230, v249
    v_cvt_pk_f16_f32 v165, v248, v249
    v_mfma_f32_16x16x32_f16 v[218:221], v[222:225], v[150:153], v[24:27]
    s_add_u32 s80, s18, 4
    v_mul_f32 v122, v230, v122
    v_mul_f32 v123, v230, v123
    v_mfma_f32_16x16x32_f16 v[218:221], v[202:205], v[138:141], v[218:221]
    s_cmp_ge_u32 s80, s17
    v_cvt_pk_f16_f32 v130, v122, v123
    v_mul_f32 v124, v230, v124
    v_mfma_f32_16x16x32_f16 v[218:221], v[154:157], v[126:129], v[218:221]
    s_cselect_b32 s66, s70, 0
    v_mul_f32 v125, v230, v125
    v_cvt_pk_f16_f32 v131, v124, v125
    v_mfma_f32_16x16x32_f16 v[238:241], v[222:225], v[162:165], v[26:29]
    s_waitcnt lgkmcnt(3)
    ds_read_b128 v[222:225], v2 offset:5120
    v_mov_b32_dpp v232, v227 quad_perm:[0,1,2,3] row_mask:0x1 bank_mask:0xf
    v_mfma_f32_16x16x32_f16 v[238:241], v[202:205], v[158:161], v[238:241]
    s_lshl_b32 s80, s79, s73
    v_mov_b32_dpp v232, v219 quad_perm:[0,1,2,3] row_mask:0x2 bank_mask:0xf
    v_max3_f32 v118, v226, v186, v187
    v_mfma_f32_16x16x32_f16 v[238:241], v[154:157], v[130:133], v[238:241]
    s_waitcnt lgkmcnt(2)
    buffer_store_dwordx4 v[114:117], v16, s[12:15], 0 offen nt
    v_max3_f32 v118, v118, v188, v189
    v_max3_f32 v118, v118, v182, v183
    v_max3_f32 v118, v118, v184, v185
    v_max3_f32 v118, v118, v166, v167
    v_mfma_f32_16x16x32_bf16 v[122:125], a[216:219], v[214:217], 0
    s_or_b32 s63, s63, s80
    v_max3_f32 v118, v118, v168, v169
    v_mov_b32 v119, v118
    v_mfma_f32_16x16x32_bf16 v[122:125], a[220:223], v[206:209], v[122:125]
    s_sub_u32 s80, s100, s81
    v_permlane32_swap_b32 v118, v119
    v_mfma_f32_16x16x32_bf16 v[122:125], a[224:227], v[210:213], v[122:125]
    s_and_b32 s100, s100, s80
    v_max_f32 v118, v118, v119
    v_mov_b32 v119, v118
    v_mfma_f32_16x16x32_bf16 v[122:125], a[228:231], v[194:197], v[122:125]
    s_waitcnt lgkmcnt(1)
    v_permlane16_swap_b32 v118, v119
    v_mfma_f32_16x16x32_bf16 v[122:125], a[232:235], v[198:201], v[122:125]
    s_waitcnt lgkmcnt(0)
    v_max_f32 v118, v118, v119
    v_sub_f32 v186, v186, v118
    v_mfma_f32_16x16x32_bf16 v[122:125], a[236:239], v[222:225], v[122:125]
    s_add_u32 s45, s45, s79
    v_exp_f32 v186, v186
    v_mfma_f32_16x16x32_bf16 v[154:157], a[240:243], v[214:217], 0
    s_add_u32 s18, s18, 1
    v_sub_f32 v187, v187, v118
    v_sub_f32 v188, v188, v118
    v_mfma_f32_16x16x32_bf16 v[154:157], a[244:247], v[206:209], v[154:157]
    s_cmp_lt_u32 s18, s45
    v_exp_f32 v187, v187
    v_mfma_f32_16x16x32_bf16 v[154:157], a[248:251], v[210:213], v[154:157]
    v_cvt_pk_bf16_f32 v186, v186, v187
    v_sub_f32 v189, v189, v118
    v_mfma_f32_16x16x32_bf16 v[154:157], a[252:255], v[194:197], v[154:157]
    v_exp_f32 v188, v188
    v_mfma_f32_16x16x32_bf16 v[154:157], v[82:85], v[198:201], v[154:157]
    v_exp_f32 v189, v189
    v_mfma_f32_16x16x32_bf16 v[154:157], v[86:89], v[222:225], v[154:157]
    v_cvt_pk_bf16_f32 v187, v188, v189
    v_sub_f32 v182, v182, v118
    v_mfma_f32_16x16x32_bf16 v[202:205], v[90:93], v[214:217], 0
    ds_read_b128 v[214:217], v2 offset:6144
    v_sub_f32 v183, v183, v118
    v_mfma_f32_16x16x32_bf16 v[202:205], v[94:97], v[206:209], v[202:205]
    ds_read_b128 v[206:209], v2 offset:7168
    v_sub_f32 v184, v184, v118
    v_mfma_f32_16x16x32_bf16 v[202:205], v[98:101], v[210:213], v[202:205]
    ds_read_b128 v[210:213], v2 offset:8192
    v_sub_f32 v185, v185, v118
    v_mfma_f32_16x16x32_bf16 v[202:205], v[102:105], v[194:197], v[202:205]
    ds_read_b128 v[194:197], v2 offset:9216
    buffer_store_dwordx2 v[254:255], v19, s[12:15], 0 offen nt
    v_exp_f32 v182, v182
    v_mfma_f32_16x16x32_f16 v[234:237], v[178:181], v[150:153], v[58:61]
    v_exp_f32 v183, v183
    v_mfma_f32_16x16x32_bf16 v[202:205], v[106:109], v[198:201], v[202:205]
    ds_read_b128 v[198:201], v2 offset:10240
    v_cvt_pk_bf16_f32 v188, v182, v183
    v_mfma_f32_16x16x32_bf16 v[202:205], v[110:113], v[222:225], v[202:205]
    ds_read_b128 v[222:225], v2 offset:11264
    v_exp_f32 v184, v184
    v_mfma_f32_16x16x16_f16 v[234:237], v[120:121], v[126:127], v[234:237]
    v_exp_f32 v185, v185
    v_sub_f32 v166, v166, v118
    v_cvt_pk_bf16_f32 v189, v184, v185
    v_mfma_f32_16x16x32_f16 v[182:185], v[138:141], v[150:153], v[62:65]
    s_waitcnt lgkmcnt(4)
    v_exp_f32 v166, v166
    v_sub_f32 v167, v167, v118
    v_exp_f32 v167, v167
    v_sub_f32 v168, v168, v118
    v_cvt_pk_bf16_f32 v36, v166, v167
    v_mfma_f32_16x16x16_f16 v[182:185], v[128:129], v[126:127], v[182:185]
    v_exp_f32 v168, v168
    v_sub_f32 v169, v169, v118
    v_sub_f32 v226, v226, v118
    v_mfma_f32_16x16x32_f16 v[242:245], v[158:161], v[150:153], v[66:69]
    s_waitcnt lgkmcnt(2)
    v_exp_f32 v169, v169
    v_mfma_f32_16x16x32_bf16 v[114:117], a[216:219], v[214:217], 0
    s_waitcnt lgkmcnt(1)
    v_cvt_pk_bf16_f32 v37, v168, v169
    v_mov_b32_dpp v232, v239 quad_perm:[0,1,2,3] row_mask:0x4 bank_mask:0xf
    v_mov_b32 v118, v232
    v_mfma_f32_16x16x16_f16 v[242:245], v[132:133], v[126:127], v[242:245]
    v_exp_f32 v226, v226
    v_max_f32_dpp v118, v118, v118 quad_perm:[1,0,3,2] row_mask:0xf bank_mask:0xf
    v_cvt_pk_bf16_f32 v39, v226, 0
    v_mfma_f32_16x16x32_bf16 v[114:117], a[220:223], v[206:209], v[114:117]
    s_waitcnt lgkmcnt(0)
    v_max_f32_dpp v118, v118, v118 quad_perm:[2,3,0,1] row_mask:0xf bank_mask:0xf
    v_max3_f32 v126, v218, v234, v235
    v_mfma_f32_16x16x32_bf16 v[150:153], v[28:31], v[36:39], 0
    v_max_f32_dpp v118, v118, v118 row_half_mirror row_mask:0xf bank_mask:0xf
    v_max3_f32 v126, v126, v236, v237
    v_mfma_f32_16x16x32_bf16 v[150:153], v[28:31], v[186:189], v[150:153]
    v_max_f32_dpp v118, v118, v118 row_mirror row_mask:0xf bank_mask:0xf
    v_mov_b32 v119, v118
    v_mfma_f32_16x16x32_bf16 v[114:117], a[224:227], v[210:213], v[114:117]
    v_max3_f32 v126, v126, v182, v183
    v_max3_f32 v126, v126, v184, v185
    v_mfma_f32_16x16x32_bf16 v[114:117], a[228:231], v[194:197], v[114:117]
    v_permlane32_swap_b32 v118, v119
    v_mfma_f32_16x16x32_bf16 v[114:117], a[232:235], v[198:201], v[114:117]
    v_rcp_f32 v150, v150
    v_mfma_f32_16x16x32_bf16 v[114:117], a[236:239], v[222:225], v[114:117]
    v_max_f32 v118, v118, v119
    v_mov_b32 v119, v118
    v_max3_f32 v126, v126, v242, v243
    v_max3_f32 v126, v126, v244, v245
    v_permlane16_swap_b32 v118, v119
    v_max_f32 v118, v118, v119
    v_mfma_f32_16x16x32_bf16 v[166:169], v[142:145], v[36:39], 0
    v_sub_f32 v232, v232, v118
    v_mov_b32 v127, v126
    v_mfma_f32_16x16x32_bf16 v[166:169], v[146:149], v[186:189], v[166:169]
    v_exp_f32 v232, v232
    v_permlane32_swap_b32 v126, v127
    v_cvt_pk_bf16_f32 v232, v232, v232
    v_max_f32 v126, v126, v127
    v_mov_b32 v127, v126
    v_fma_f32 v254, v122, v122, s33
    v_fmac_f32 v254, v123, v123
    v_permlane16_swap_b32 v126, v127
    v_mul_f32 v166, v150, v166
    v_mul_f32 v167, v150, v167
    v_cvt_pk_bf16_f32 v166, v166, v167
    v_mul_f32 v168, v150, v168
    v_mul_f32 v169, v150, v169
    v_cvt_pk_bf16_f32 v167, v168, v169
    v_max_f32 v126, v126, v127
    v_sub_f32 v234, v234, v126
    v_exp_f32 v234, v234
    v_sub_f32 v235, v235, v126
    v_exp_f32 v235, v235
    v_sub_f32 v236, v236, v126
    v_cvt_pk_bf16_f32 v226, v234, v235
    v_exp_f32 v236, v236
    v_sub_f32 v237, v237, v126
    v_exp_f32 v237, v237
    v_sub_f32 v182, v182, v126
    v_cvt_pk_bf16_f32 v227, v236, v237
    v_mfma_f32_16x16x32_bf16 v[234:237], v[170:173], v[36:39], 0
    ds_write_b16 v8, v232
    v_mfma_f32_16x16x32_bf16 v[234:237], v[174:177], v[186:189], v[234:237]
    v_exp_f32 v182, v182
    v_sub_f32 v183, v183, v126
    v_exp_f32 v183, v183
    v_sub_f32 v184, v184, v126
    v_cvt_pk_bf16_f32 v228, v182, v183
    v_exp_f32 v184, v184
    v_sub_f32 v185, v185, v126
    v_exp_f32 v185, v185
    v_mul_f32 v234, v150, v234
    v_mul_f32 v235, v150, v235
    v_cvt_pk_bf16_f32 v168, v234, v235
    v_mul_f32 v236, v150, v236
    v_mul_f32 v237, v150, v237
    v_cvt_pk_bf16_f32 v169, v236, v237
    v_mfma_f32_16x16x32_bf16 v[230:233], v[190:193], v[36:39], 0
    ds_write_b128 v3, v[166:169] offset:0
    v_mfma_f32_16x16x32_bf16 v[230:233], v[134:137], v[186:189], v[230:233]
    v_cvt_pk_bf16_f32 v229, v184, v185
    v_sub_f32 v242, v242, v126
    v_mfma_f32_16x16x32_f16 v[182:185], v[178:181], v[162:165], v[70:73]
    v_exp_f32 v242, v242
    v_mfma_f32_16x16x32_bf16 v[166:169], a[240:243], v[214:217], 0
    ds_read_b128 v[178:181], v9
    v_sub_f32 v243, v243, v126
    v_mfma_f32_16x16x32_bf16 v[166:169], a[244:247], v[206:209], v[166:169]
    v_mul_f32 v230, v150, v230
    v_mul_f32 v231, v150, v231
    v_cvt_pk_bf16_f32 v220, v230, v231
    v_mfma_f32_16x16x16_f16 v[182:185], v[120:121], v[130:131], v[182:185]
    v_mul_f32 v232, v150, v232
    v_mul_f32 v233, v150, v233
    v_cvt_pk_bf16_f32 v221, v232, v233
    v_sub_f32 v244, v244, v126
    v_mfma_f32_16x16x32_bf16 v[166:169], a[248:251], v[210:213], v[166:169]
    ds_read_b128 v[118:121], v9 offset:64
    v_sub_f32 v245, v245, v126
    v_mfma_f32_16x16x32_bf16 v[166:169], a[252:255], v[194:197], v[166:169]
    ds_write_b64 v4, v[220:221] offset:4096
    v_mfma_f32_16x16x32_bf16 v[166:169], v[82:85], v[198:201], v[166:169]
    v_max3_f32 v255, v238, v182, v183
    v_max3_f32 v255, v255, v184, v185
    v_mfma_f32_16x16x32_bf16 v[166:169], v[86:89], v[222:225], v[166:169]
    v_exp_f32 v243, v243
    v_exp_f32 v244, v244
    v_cvt_pk_bf16_f32 v36, v242, v243
    v_mfma_f32_16x16x32_f16 v[186:189], v[138:141], v[162:165], v[74:77]
    s_waitcnt lgkmcnt(2)
    v_exp_f32 v245, v245
    v_mfma_f32_16x16x32_f16 v[246:249], v[158:161], v[162:165], v[78:81]
    v_cvt_pk_bf16_f32 v37, v244, v245
    v_sub_f32 v218, v218, v126
    v_mfma_f32_16x16x32_bf16 v[242:245], v[178:181], v[28:31], 0
    v_exp_f32 v218, v218
    v_fmac_f32 v254, v124, v124
    v_mfma_f32_16x16x16_f16 v[186:189], v[128:129], v[130:131], v[186:189]
    v_cvt_pk_bf16_f32 v39, v218, 0
    v_fmac_f32 v254, v125, v125
    v_fmac_f32 v254, v154, v154
    v_mfma_f32_16x16x16_f16 v[246:249], v[132:133], v[130:131], v[246:249]
    v_fmac_f32 v254, v155, v155
    v_fmac_f32 v254, v156, v156
    v_fmac_f32 v254, v157, v157
    v_fmac_f32 v254, v202, v202
    v_mfma_f32_16x16x32_bf16 v[126:129], v[28:31], v[36:39], 0
    s_waitcnt lgkmcnt(0)
    v_max3_f32 v255, v255, v186, v187
    v_max3_f32 v255, v255, v188, v189
    v_mfma_f32_16x16x32_bf16 v[126:129], v[28:31], v[226:229], v[126:129]
    v_max3_f32 v255, v255, v246, v247
    v_max3_f32 v255, v255, v248, v249
    v_mfma_f32_16x16x32_bf16 v[130:133], v[142:145], v[36:39], 0
    v_mov_b32 v239, v255
    v_fmac_f32 v254, v203, v203
    v_mfma_f32_16x16x32_bf16 v[130:133], v[146:149], v[226:229], v[130:133]
    v_permlane32_swap_b32 v255, v239
    v_mfma_f32_16x16x32_bf16 v[138:141], v[170:173], v[36:39], 0
    v_rcp_f32 v126, v126
    v_mfma_f32_16x16x32_bf16 v[138:141], v[174:177], v[226:229], v[138:141]
    v_max_f32 v255, v255, v239
    v_mov_b32 v239, v255
    v_mfma_f32_16x16x32_bf16 v[150:153], v[190:193], v[36:39], 0
    v_fmac_f32 v254, v204, v204
    v_mul_f32 v130, v126, v130
    v_mfma_f32_16x16x32_bf16 v[150:153], v[134:137], v[226:229], v[150:153]
    v_mul_f32 v131, v126, v131
    v_cvt_pk_bf16_f32 v130, v130, v131
    v_mfma_f32_16x16x32_bf16 v[242:245], v[118:121], v[28:31], v[242:245]
    v_mul_f32 v132, v126, v132
    v_mul_f32 v133, v126, v133
    v_mfma_f32_16x16x32_bf16 v[218:221], v[178:181], v[146:149], 0
    v_cvt_pk_bf16_f32 v131, v132, v133
    v_mul_f32 v138, v126, v138
    v_mfma_f32_16x16x32_bf16 v[218:221], v[118:121], v[142:145], v[218:221]
    v_mul_f32 v139, v126, v139
    v_cvt_pk_bf16_f32 v132, v138, v139
    v_mfma_f32_16x16x32_bf16 v[226:229], v[178:181], v[174:177], 0
    v_mul_f32 v140, v126, v140
    v_mul_f32 v141, v126, v141
    v_mfma_f32_16x16x32_bf16 v[226:229], v[118:121], v[170:173], v[226:229]
    v_cvt_pk_bf16_f32 v133, v140, v141
    v_mul_f32 v150, v126, v150
    v_mfma_f32_16x16x32_bf16 v[250:253], v[178:181], v[134:137], 0
    ds_write_b128 v3, v[130:133] offset:6144
    v_mfma_f32_16x16x32_bf16 v[250:253], v[118:121], v[190:193], v[250:253]
    v_mul_f32 v151, v126, v151
    v_cvt_pk_bf16_f32 v240, v150, v151
    v_mfma_f32_16x16x32_bf16 v[230:233], v[90:93], v[214:217], 0
    v_mul_f32 v152, v126, v152
    v_mul_f32 v153, v126, v153
    v_mfma_f32_16x16x32_bf16 v[230:233], v[94:97], v[206:209], v[230:233]
    ds_read_b128 v[118:121], v2 offset:12288
    ds_read_b128 v[126:129], v2 offset:13312
    v_mfma_f32_16x16x32_bf16 v[230:233], v[98:101], v[210:213], v[230:233]
    ds_read_b128 v[130:133], v2 offset:14336
    v_cvt_pk_bf16_f32 v241, v152, v153
    v_mfma_f32_16x16x32_bf16 v[230:233], v[102:105], v[194:197], v[230:233]
    ds_read_b128 v[158:161], v2 offset:15360
    v_fmac_f32 v254, v205, v205
    v_mfma_f32_16x16x32_bf16 v[230:233], v[106:109], v[198:201], v[230:233]
    ds_read_b128 v[178:181], v2 offset:16384
    v_fma_f32 v219, v114, v114, s33
    v_mfma_f32_16x16x32_bf16 v[230:233], v[110:113], v[222:225], v[230:233]
    ds_read_b128 v[194:197], v2 offset:17408
    ds_write_b64 v4, v[240:241] offset:10240
    v_permlane16_swap_b32 v255, v239
    v_max_f32 v255, v255, v239
    v_sub_f32 v182, v182, v255
    v_exp_f32 v182, v182
    v_sub_f32 v183, v183, v255
    v_exp_f32 v183, v183
    s_waitcnt lgkmcnt(5)
    v_mfma_f32_16x16x32_bf16 v[150:153], a[216:219], v[118:121], 0
    v_cvt_pk_bf16_f32 v198, v182, v183
    v_sub_f32 v184, v184, v255
    v_mfma_f32_16x16x32_bf16 v[150:153], a[220:223], v[126:129], v[150:153]
    s_waitcnt lgkmcnt(4)
    v_exp_f32 v184, v184
    v_mfma_f32_16x16x32_bf16 v[150:153], a[224:227], v[130:133], v[150:153]
    s_waitcnt lgkmcnt(3)
    v_sub_f32 v185, v185, v255
    v_sub_f32 v186, v186, v255
    v_mfma_f32_16x16x32_bf16 v[150:153], a[228:231], v[158:161], v[150:153]
    s_waitcnt lgkmcnt(2)
    v_exp_f32 v185, v185
    v_mfma_f32_16x16x32_bf16 v[150:153], a[232:235], v[178:181], v[150:153]
    s_waitcnt lgkmcnt(0)
    v_cvt_pk_bf16_f32 v199, v184, v185
    v_sub_f32 v187, v187, v255
    v_mfma_f32_16x16x32_bf16 v[150:153], a[236:239], v[194:197], v[150:153]
    v_exp_f32 v186, v186
    v_mfma_f32_16x16x32_bf16 v[162:165], a[240:243], v[118:121], 0
    v_exp_f32 v187, v187
    v_mfma_f32_16x16x32_bf16 v[162:165], a[244:247], v[126:129], v[162:165]
    v_cvt_pk_bf16_f32 v200, v186, v187
    v_sub_f32 v188, v188, v255
    v_mfma_f32_16x16x32_bf16 v[162:165], a[248:251], v[130:133], v[162:165]
    v_exp_f32 v188, v188
    v_mfma_f32_16x16x32_bf16 v[162:165], a[252:255], v[158:161], v[162:165]
    v_sub_f32 v189, v189, v255
    v_sub_f32 v246, v246, v255
    v_mfma_f32_16x16x32_bf16 v[162:165], v[82:85], v[178:181], v[162:165]
    v_exp_f32 v189, v189
    v_mfma_f32_16x16x32_bf16 v[162:165], v[86:89], v[194:197], v[162:165]
    v_cvt_pk_bf16_f32 v201, v188, v189
    v_sub_f32 v247, v247, v255
    v_mfma_f32_16x16x32_bf16 v[138:141], v[90:93], v[118:121], 0
    v_exp_f32 v246, v246
    v_mfma_f32_16x16x32_bf16 v[138:141], v[94:97], v[126:129], v[138:141]
    v_exp_f32 v247, v247
    v_mfma_f32_16x16x32_bf16 v[138:141], v[98:101], v[130:133], v[138:141]
    v_cvt_pk_bf16_f32 v36, v246, v247
    v_sub_f32 v248, v248, v255
    v_mfma_f32_16x16x32_bf16 v[138:141], v[102:105], v[158:161], v[138:141]
    v_exp_f32 v248, v248
    v_mfma_f32_16x16x32_bf16 v[138:141], v[106:109], v[178:181], v[138:141]
    v_sub_f32 v249, v249, v255
    v_sub_f32 v238, v238, v255
    v_mfma_f32_16x16x32_bf16 v[138:141], v[110:113], v[194:197], v[138:141]
    ds_read_b128 v[186:189], v0 offset:20480
    ds_read_b128 v[118:121], v1 offset:20480
    ds_read_b128 v[234:237], v0 offset:20608
    v_exp_f32 v249, v249
    v_exp_f32 v238, v238
    v_cvt_pk_bf16_f32 v37, v248, v249
    v_cvt_pk_bf16_f32 v39, v238, 0
    v_fma_f32 v255, v150, v150, s33
    v_fmac_f32 v255, v151, v151
    v_mfma_f32_16x16x32_bf16 v[126:129], v[28:31], v[36:39], 0
    ds_read_b128 v[158:161], v1 offset:20608
    ds_read_b128 v[182:185], v0 offset:20736
    v_mfma_f32_16x16x32_bf16 v[126:129], v[28:31], v[198:201], v[126:129]
    ds_read_b128 v[206:209], v1 offset:20736
    v_fmac_f32 v255, v152, v152
    v_mfma_f32_16x16x32_bf16 v[178:181], v[142:145], v[36:39], 0
    v_fmac_f32 v255, v153, v153
    v_fmac_f32 v255, v162, v162
    v_mfma_f32_16x16x32_bf16 v[178:181], v[146:149], v[198:201], v[178:181]
    v_fmac_f32 v255, v163, v163
    v_fmac_f32 v255, v164, v164
    v_mfma_f32_16x16x32_bf16 v[142:145], v[170:173], v[36:39], 0
    s_waitcnt lgkmcnt(5)
    v_rcp_f32 v126, v126
    v_mfma_f32_16x16x32_bf16 v[142:145], v[174:177], v[198:201], v[142:145]
    s_waitcnt lgkmcnt(3)
    v_fmac_f32 v255, v165, v165
    v_mul_f32 v178, v126, v178
    v_mfma_f32_16x16x32_bf16 v[146:149], v[190:193], v[36:39], 0
    v_mul_f32 v179, v126, v179
    v_cvt_pk_bf16_f32 v170, v178, v179
    v_mfma_f32_16x16x32_bf16 v[146:149], v[134:137], v[198:201], v[146:149]
    v_mul_f32 v180, v126, v180
    v_mul_f32 v181, v126, v181
    v_mfma_f32_16x16x32_bf16 v[130:133], a[72:75], v[186:189], 0
    s_waitcnt lgkmcnt(1)
    v_cvt_pk_bf16_f32 v171, v180, v181
    v_mul_f32 v142, v126, v142
    v_mfma_f32_16x16x32_bf16 v[130:133], a[76:79], v[118:121], v[130:133]
    s_waitcnt lgkmcnt(0)
    v_mul_f32 v143, v126, v143
    v_cvt_pk_bf16_f32 v172, v142, v143
    v_mfma_f32_16x16x32_bf16 v[130:133], a[80:83], v[234:237], v[130:133]
    v_mul_f32 v144, v126, v144
    v_mul_f32 v145, v126, v145
    v_mfma_f32_16x16x32_bf16 v[130:133], a[84:87], v[158:161], v[130:133]
    v_cvt_pk_bf16_f32 v173, v144, v145
    v_mul_f32 v146, v126, v146
    v_mfma_f32_16x16x32_bf16 v[130:133], a[88:91], v[182:185], v[130:133]
    ds_write_b128 v3, v[170:173] offset:12288
    v_mfma_f32_16x16x32_bf16 v[130:133], a[92:95], v[206:209], v[130:133]
    v_mul_f32 v147, v126, v147
    v_cvt_pk_bf16_f32 v220, v146, v147
    v_mfma_f32_16x16x32_bf16 v[134:137], a[96:99], v[186:189], 0
    v_mul_f32 v148, v126, v148
    v_mul_f32 v149, v126, v149
    v_mfma_f32_16x16x32_bf16 v[134:137], a[100:103], v[118:121], v[134:137]
    v_cvt_pk_bf16_f32 v221, v148, v149
    v_fmac_f32 v255, v138, v138
    v_mfma_f32_16x16x32_bf16 v[134:137], a[104:107], v[234:237], v[134:137]
    ds_write_b64 v4, v[220:221] offset:16384
    v_mfma_f32_16x16x32_bf16 v[134:137], a[108:111], v[158:161], v[134:137]
    v_fmac_f32 v255, v139, v139
    v_fmac_f32 v255, v140, v140
    v_mfma_f32_16x16x32_bf16 v[134:137], a[112:115], v[182:185], v[134:137]
    v_fmac_f32 v255, v141, v141
    v_cvt_pk_bf16_f32 v255, v255, v255
    v_mfma_f32_16x16x32_bf16 v[134:137], a[116:119], v[206:209], v[134:137]
    v_rcp_f32 v242, v242
    v_mfma_f32_16x16x32_bf16 v[170:173], a[120:123], v[186:189], 0
    v_mul_f32 v218, v218, v242
    v_mul_f32_dpp v218, v226, v242 quad_perm:[0,1,2,3] row_mask:0x2 bank_mask:0xf
    v_mfma_f32_16x16x32_bf16 v[170:173], a[124:127], v[118:121], v[170:173]
    v_mul_f32_dpp v218, v250, v242 quad_perm:[0,1,2,3] row_mask:0x4 bank_mask:0xf
    v_cvt_pk_bf16_f32 v218, v218, v218
    v_mfma_f32_16x16x32_bf16 v[170:173], a[128:131], v[234:237], v[170:173]
    ds_write_b16 v7, v218
    v_mfma_f32_16x16x32_bf16 v[170:173], a[132:135], v[158:161], v[170:173]
    v_fmac_f32 v219, v115, v115
    v_fmac_f32 v219, v116, v116
    v_mfma_f32_16x16x32_bf16 v[170:173], a[136:139], v[182:185], v[170:173]
    v_fmac_f32 v219, v117, v117
    v_fmac_f32 v219, v166, v166
    v_mfma_f32_16x16x32_bf16 v[170:173], a[140:143], v[206:209], v[170:173]
    v_fmac_f32 v219, v167, v167
    v_fmac_f32 v219, v168, v168
    v_mfma_f32_16x16x32_bf16 v[142:145], a[0:3], v[186:189], 0
    v_fmac_f32 v219, v169, v169
    v_fmac_f32 v219, v230, v230
    v_mfma_f32_16x16x32_bf16 v[142:145], a[4:7], v[118:121], v[142:145]
    v_fmac_f32 v219, v231, v231
    v_fmac_f32 v219, v232, v232
    v_mfma_f32_16x16x32_bf16 v[142:145], a[8:11], v[234:237], v[142:145]
    v_fmac_f32 v219, v233, v233
    v_cvt_pk_bf16_f32 v254, v254, v219
    v_mfma_f32_16x16x32_bf16 v[142:145], a[12:15], v[158:161], v[142:145]
    ds_write_b64 v4, v[254:255] offset:18432
    v_mfma_f32_16x16x32_bf16 v[142:145], a[16:19], v[182:185], v[142:145]
    v_fma_f32 v174, v130, v130, s32
    v_fmac_f32 v174, v131, v131
    v_mfma_f32_16x16x32_bf16 v[142:145], a[20:23], v[206:209], v[142:145]
    v_fmac_f32 v174, v132, v132
    v_fmac_f32 v174, v133, v133
    v_mfma_f32_16x16x32_bf16 v[126:129], a[24:27], v[186:189], 0
    v_xor_b32 v2, 65536, v2
    v_xor_b32 v3, 65536, v3
    v_mfma_f32_16x16x32_bf16 v[126:129], a[28:31], v[118:121], v[126:129]
    v_xor_b32 v4, 65536, v4
    v_add_u32 v5, s74, v5
    v_mfma_f32_16x16x32_bf16 v[126:129], a[32:35], v[234:237], v[126:129]
    v_add_u32 v6, s75, v6
    v_add_u32 v7, s76, v7
    v_mfma_f32_16x16x32_bf16 v[126:129], a[36:39], v[158:161], v[126:129]
    v_mfma_f32_16x16x32_bf16 v[126:129], a[40:43], v[182:185], v[126:129]
    s_waitcnt lgkmcnt(0)
    s_nop 0
    s_nop 0
    s_barrier
    s_nop 0
    v_mfma_f32_16x16x32_bf16 v[126:129], a[44:47], v[206:209], v[126:129]
    s_cbranch_scc1 L_loop_safe2
    s_branch L_final_safe
.p2align 6
L_loop_safe3:
    v_mfma_f32_16x16x32_bf16 v[190:193], a[48:51], v[186:189], 0
    s_add_u32 s12, s40, s27
    ds_read_b128 v[146:149], v2 offset:18432
    ds_read_b128 v[178:181], v2 offset:19456
    v_mfma_f32_16x16x32_bf16 v[190:193], a[52:55], v[118:121], v[190:193]
    s_addc_u32 s13, s41, 0
    v_fmac_f32 v174, v134, v134
    v_fmac_f32 v174, v135, v135
    v_mfma_f32_16x16x32_bf16 v[190:193], a[56:59], v[234:237], v[190:193]
    s_sub_u32 s14, s36, s27
    v_fmac_f32 v174, v136, v136
    v_fmac_f32 v174, v137, v137
    v_mfma_f32_16x16x32_bf16 v[190:193], a[60:63], v[158:161], v[190:193]
    s_cmp_ge_u32 s18, 2
    v_fmac_f32 v174, v170, v170
    v_fmac_f32 v174, v171, v171
    v_mfma_f32_16x16x32_bf16 v[190:193], a[64:67], v[182:185], v[190:193]
    s_cselect_b32 s14, s14, 0
    v_fmac_f32 v174, v172, v172
    v_fmac_f32 v174, v173, v173
    v_mfma_f32_16x16x32_bf16 v[190:193], a[68:71], v[206:209], v[190:193]
    s_sub_u32 s82, s72, s71
    v_fma_f32 v254, v142, v142, s32
    v_fmac_f32 v254, v143, v143
    v_mfma_f32_16x16x32_bf16 v[194:197], v[186:189], a[144:147], 0
    s_mul_i32 s74, s82, 336
    v_fmac_f32 v254, v144, v144
    v_fmac_f32 v254, v145, v145
    v_mfma_f32_16x16x32_bf16 v[194:197], v[118:121], a[148:151], v[194:197]
    s_mul_i32 s75, s82, 272
    v_fmac_f32 v254, v126, v126
    v_fmac_f32 v254, v127, v127
    v_mfma_f32_16x16x32_bf16 v[194:197], v[234:237], a[152:155], v[194:197]
    s_waitcnt lgkmcnt(0)
    v_fmac_f32 v254, v128, v128
    v_fmac_f32 v254, v129, v129
    v_mfma_f32_16x16x32_bf16 v[198:201], v[32:35], v[146:149], 0
    s_mul_i32 s76, s82, 16
    v_fmac_f32 v254, v190, v190
    v_fmac_f32 v254, v191, v191
    v_mfma_f32_16x16x32_bf16 v[198:201], v[32:35], v[178:181], v[198:201]
    s_add_u32 s34, s18, 2
    v_fmac_f32 v254, v192, v192
    v_fmac_f32 v254, v193, v193
    v_mfma_f32_16x16x32_bf16 v[194:197], v[158:161], a[156:159], v[194:197]
    s_add_u32 s8, s60, s23
    v_cvt_pk_bf16_f32 v36, v254, v174
    s_addc_u32 s9, s61, 0
    v_mfma_f32_16x16x32_bf16 v[194:197], v[182:185], a[160:163], v[194:197]
    s_sub_u32 s10, s36, s23
    v_mul_f32 v254, 0x3baaaaab, v198
    v_mul_f32 v255, 0x3baaaaab, v199
    v_mfma_f32_16x16x32_bf16 v[210:213], v[32:35], v[36:39], 0
    s_cmp_le_u32 s34, s45
    v_rsq_f32 v254, v254
    v_mfma_f32_16x16x32_bf16 v[194:197], v[206:209], a[164:167], v[194:197]
    s_cselect_b32 s10, s10, 0
    ds_read_b128 v[214:217], v0 offset:26624
    v_mul_f32 v148, 0x3baaaaab, v200
    v_mfma_f32_16x16x32_bf16 v[174:177], v[186:189], a[168:171], 0
    s_add_u32 m0, s28, 0
    ds_read_b128 v[198:201], v1 offset:26624
    v_mul_f32 v122, v254, v122
    v_mfma_f32_16x16x32_bf16 v[174:177], v[118:121], a[172:175], v[174:177]
    s_mov_b32 s27, s26
    ds_read_b128 v[218:221], v0 offset:26752
    v_cvt_pk_bf16_f32 v146, v194, v195
    v_mfma_f32_16x16x32_bf16 v[174:177], v[234:237], a[176:179], v[174:177]
    s_mov_b32 s26, s25
    ds_read_b128 v[222:225], v1 offset:26752
    v_cvt_pk_bf16_f32 v147, v196, v197
    v_mfma_f32_16x16x32_bf16 v[174:177], v[158:161], a[180:183], v[174:177]
    s_mov_b32 s25, s24
    v_rsq_f32 v211, v211
    v_mfma_f32_16x16x32_bf16 v[174:177], v[182:185], a[184:187], v[174:177]
    s_mov_b32 s24, s23
    v_rsq_f32 v210, v210
    v_mfma_f32_16x16x32_bf16 v[174:177], v[206:209], a[188:191], v[174:177]
    s_ff1_i32_b32 s80, s100
    v_mul_f32 v210, s31, v210
    v_mul_f32 v130, v211, v130
    v_mul_f32 v131, v211, v131
    v_cvt_pk_f16_f32 v178, v130, v131
    v_mfma_f32_16x16x32_bf16 v[194:197], v[186:189], a[192:195], 0
    s_waitcnt lgkmcnt(3)
    ds_read_b128 v[186:189], v0 offset:26880
    v_cvt_pk_bf16_f32 v174, v174, v175
    v_mfma_f32_16x16x32_bf16 v[194:197], v[118:121], a[196:199], v[194:197]
    s_mov_b32 s71, s72
    ds_read_b128 v[226:229], v1 offset:26880
    v_cvt_pk_bf16_f32 v175, v176, v177
    v_mfma_f32_16x16x32_bf16 v[194:197], v[234:237], a[200:203], v[194:197]
    s_mov_b32 s72, s73
    v_mul_f32 v132, v211, v132
    v_mul_f32 v133, v211, v133
    v_mfma_f32_16x16x32_bf16 v[194:197], v[158:161], a[204:207], v[194:197]
    s_waitcnt lgkmcnt(2)
    v_cvt_pk_f16_f32 v179, v132, v133
    v_mul_f32 v134, v211, v134
    v_mfma_f32_16x16x32_bf16 v[194:197], v[182:185], a[208:211], v[194:197]
    v_mul_f32 v135, v211, v135
    v_cvt_pk_f16_f32 v180, v134, v135
    v_mfma_f32_16x16x32_bf16 v[194:197], v[206:209], a[212:215], v[194:197]
    v_mul_f32 v136, v211, v136
    v_mul_f32 v137, v211, v137
    v_mfma_f32_16x16x32_bf16 v[130:133], a[72:75], v[214:217], 0
    v_cvt_pk_f16_f32 v181, v136, v137
    v_mul_f32 v170, v211, v170
    v_mfma_f32_16x16x32_bf16 v[130:133], a[76:79], v[198:201], v[130:133]
    v_mul_f32 v171, v211, v171
    v_cvt_pk_f16_f32 v120, v170, v171
    v_mfma_f32_16x16x32_bf16 v[130:133], a[80:83], v[218:221], v[130:133]
    s_waitcnt lgkmcnt(1)
    v_cvt_pk_bf16_f32 v134, v194, v195
    v_cvt_pk_bf16_f32 v135, v196, v197
    v_mfma_f32_16x16x32_bf16 v[130:133], a[84:87], v[222:225], v[130:133]
    s_waitcnt lgkmcnt(0)
    v_mul_f32 v172, v211, v172
    v_mul_f32 v173, v211, v173
    v_mfma_f32_16x16x32_bf16 v[130:133], a[88:91], v[186:189], v[130:133]
    v_cvt_pk_f16_f32 v121, v172, v173
    v_mul_f32 v142, v210, v142
    v_mfma_f32_16x16x32_bf16 v[130:133], a[92:95], v[226:229], v[130:133]
    v_mul_f32 v143, v210, v143
    v_cvt_pk_f16_f32 v194, v142, v143
    v_mfma_f32_16x16x32_bf16 v[158:161], a[96:99], v[214:217], 0
    v_mul_f32 v144, v210, v144
    v_mul_f32 v145, v210, v145
    v_mfma_f32_16x16x32_bf16 v[158:161], a[100:103], v[198:201], v[158:161]
    v_cvt_pk_f16_f32 v195, v144, v145
    v_mul_f32 v126, v210, v126
    v_mfma_f32_16x16x32_bf16 v[158:161], a[104:107], v[218:221], v[158:161]
    v_mul_f32 v127, v210, v127
    v_cvt_pk_f16_f32 v196, v126, v127
    v_mfma_f32_16x16x32_bf16 v[158:161], a[108:111], v[222:225], v[158:161]
    v_mul_f32 v128, v210, v128
    v_mul_f32 v129, v210, v129
    v_mfma_f32_16x16x32_bf16 v[158:161], a[112:115], v[186:189], v[158:161]
    v_cvt_pk_f16_f32 v197, v128, v129
    v_mul_f32 v190, v210, v190
    v_mfma_f32_16x16x32_bf16 v[158:161], a[116:119], v[226:229], v[158:161]
    v_mul_f32 v191, v210, v191
    v_cvt_pk_f16_f32 v118, v190, v191
    v_mfma_f32_16x16x32_bf16 v[142:145], a[120:123], v[214:217], 0
    v_mul_f32 v192, v210, v192
    v_mul_f32 v193, v210, v193
    v_mfma_f32_16x16x32_bf16 v[142:145], a[124:127], v[198:201], v[142:145]
    v_cvt_pk_f16_f32 v119, v192, v193
    v_fma_f32 v149, v130, v130, s32
    v_mfma_f32_16x16x32_bf16 v[142:145], a[128:131], v[218:221], v[142:145]
    v_fmac_f32 v149, v131, v131
    v_fmac_f32 v149, v132, v132
    v_mfma_f32_16x16x32_bf16 v[142:145], a[132:135], v[222:225], v[142:145]
    v_fmac_f32 v149, v133, v133
    v_fmac_f32 v149, v158, v158
    v_mfma_f32_16x16x32_bf16 v[142:145], a[136:139], v[186:189], v[142:145]
    v_fmac_f32 v149, v159, v159
    v_fmac_f32 v149, v160, v160
    v_mfma_f32_16x16x32_bf16 v[142:145], a[140:143], v[226:229], v[142:145]
    v_fmac_f32 v149, v161, v161
    v_mul_f32 v123, v254, v123
    v_mfma_f32_16x16x32_bf16 v[170:173], a[0:3], v[214:217], 0
    v_rsq_f32 v255, v255
    v_mfma_f32_16x16x32_bf16 v[170:173], a[4:7], v[198:201], v[170:173]
    v_rsq_f32 v148, v148
    v_mfma_f32_16x16x32_bf16 v[170:173], a[8:11], v[218:221], v[170:173]
    v_mul_f32 v150, v148, v150
    v_fmac_f32 v149, v142, v142
    v_mfma_f32_16x16x32_bf16 v[170:173], a[12:15], v[222:225], v[170:173]
    v_fmac_f32 v149, v143, v143
    v_fmac_f32 v149, v144, v144
    v_mfma_f32_16x16x32_bf16 v[170:173], a[16:19], v[186:189], v[170:173]
    v_fmac_f32 v149, v145, v145
    v_mul_f32 v151, v148, v151
    v_mfma_f32_16x16x32_bf16 v[170:173], a[20:23], v[226:229], v[170:173]
    v_cvt_pk_bf16_f32 v126, v150, v151
    v_mul_f32 v152, v148, v152
    v_mfma_f32_16x16x32_bf16 v[182:185], a[24:27], v[214:217], 0
    v_mul_f32 v153, v148, v153
    v_cvt_pk_bf16_f32 v127, v152, v153
    v_mfma_f32_16x16x32_bf16 v[182:185], a[28:31], v[198:201], v[182:185]
    v_mul_f32 v162, v148, v162
    v_mul_f32 v163, v148, v163
    v_mfma_f32_16x16x32_bf16 v[182:185], a[32:35], v[218:221], v[182:185]
    v_fma_f32 v136, v170, v170, s32
    v_fmac_f32 v136, v171, v171
    v_mfma_f32_16x16x32_bf16 v[182:185], a[36:39], v[222:225], v[182:185]
    v_fmac_f32 v136, v172, v172
    v_fmac_f32 v136, v173, v173
    v_mfma_f32_16x16x32_bf16 v[182:185], a[40:43], v[186:189], v[182:185]
    v_cvt_pk_bf16_f32 v128, v162, v163
    v_mul_f32 v164, v148, v164
    v_mfma_f32_16x16x32_bf16 v[182:185], a[44:47], v[226:229], v[182:185]
    v_mul_f32 v165, v148, v165
    v_cvt_pk_bf16_f32 v129, v164, v165
    v_mfma_f32_16x16x32_bf16 v[162:165], a[48:51], v[214:217], 0
    buffer_store_dwordx4 v[126:129], v17, s[12:15], 0 offen nt
    v_mul_f32 v138, v148, v138
    v_mul_f32 v139, v148, v139
    v_cvt_pk_bf16_f32 v176, v138, v139
    v_mul_f32 v140, v148, v140
    v_mfma_f32_16x16x32_bf16 v[162:165], a[52:55], v[198:201], v[162:165]
    v_fmac_f32 v136, v182, v182
    v_fmac_f32 v136, v183, v183
    v_mfma_f32_16x16x32_bf16 v[162:165], a[56:59], v[218:221], v[162:165]
    v_fmac_f32 v136, v184, v184
    v_fmac_f32 v136, v185, v185
    v_mfma_f32_16x16x32_bf16 v[162:165], a[60:63], v[222:225], v[162:165]
    v_mul_f32 v141, v148, v141
    v_cvt_pk_bf16_f32 v177, v140, v141
    v_mfma_f32_16x16x32_bf16 v[162:165], a[64:67], v[186:189], v[162:165]
    v_cvt_pk_bf16_f32 v190, v122, v123
    v_mul_f32 v124, v254, v124
    v_mfma_f32_16x16x32_bf16 v[162:165], a[68:71], v[226:229], v[162:165]
    v_mul_f32 v125, v254, v125
    v_cvt_pk_bf16_f32 v191, v124, v125
    v_mfma_f32_16x16x32_bf16 v[122:125], v[214:217], a[144:147], 0
    v_mul_f32 v154, v254, v154
    v_mul_f32 v155, v254, v155
    v_mfma_f32_16x16x32_bf16 v[122:125], v[198:201], a[148:151], v[122:125]
    v_cvt_pk_bf16_f32 v192, v154, v155
    v_mul_f32 v156, v254, v156
    v_mfma_f32_16x16x32_bf16 v[122:125], v[218:221], a[152:155], v[122:125]
    v_fmac_f32 v136, v162, v162
    v_fmac_f32 v136, v163, v163
    v_mfma_f32_16x16x32_bf16 v[122:125], v[222:225], a[156:159], v[122:125]
    v_fmac_f32 v136, v164, v164
    v_fmac_f32 v136, v165, v165
    v_mfma_f32_16x16x32_bf16 v[122:125], v[186:189], a[160:163], v[122:125]
    v_cvt_pk_bf16_f32 v36, v136, v149
    v_mul_f32 v157, v254, v157
    v_mfma_f32_16x16x32_bf16 v[122:125], v[226:229], a[164:167], v[122:125]
    ds_read_b128 v[206:209], v0 offset:32768
    v_cvt_pk_bf16_f32 v193, v156, v157
    v_mfma_f32_16x16x32_bf16 v[154:157], v[32:35], v[36:39], 0
    v_mul_f32 v202, v254, v202
    v_mul_f32 v203, v254, v203
    v_mfma_f32_16x16x32_bf16 v[126:129], v[214:217], a[168:171], 0
    ds_read_b128 v[210:213], v1 offset:32768
    v_cvt_pk_bf16_f32 v234, v202, v203
    v_mfma_f32_16x16x32_bf16 v[126:129], v[198:201], a[172:175], v[126:129]
    ds_read_b128 v[238:241], v0 offset:32896
    v_cvt_pk_bf16_f32 v148, v122, v123
    v_mfma_f32_16x16x32_bf16 v[126:129], v[218:221], a[176:179], v[126:129]
    ds_read_b128 v[242:245], v1 offset:32896
    v_cvt_pk_bf16_f32 v149, v124, v125
    v_mfma_f32_16x16x32_bf16 v[126:129], v[222:225], a[180:183], v[126:129]
    v_rsq_f32 v155, v155
    v_mfma_f32_16x16x32_bf16 v[126:129], v[186:189], a[184:187], v[126:129]
    buffer_store_dwordx2 v[176:177], v20, s[12:15], 0 offen nt
    v_rsq_f32 v154, v154
    v_mfma_f32_16x16x32_bf16 v[126:129], v[226:229], a[188:191], v[126:129]
    s_waitcnt lgkmcnt(3)
    v_mul_f32 v154, s31, v154
    v_mul_f32 v130, v155, v130
    v_mul_f32 v131, v155, v131
    v_cvt_pk_f16_f32 v138, v130, v131
    v_mfma_f32_16x16x32_bf16 v[122:125], v[214:217], a[192:195], 0
    ds_read_b128 v[214:217], v0 offset:33024
    v_mul_f32 v132, v155, v132
    v_mfma_f32_16x16x32_bf16 v[122:125], v[198:201], a[196:199], v[122:125]
    s_waitcnt lgkmcnt(3)
    ds_read_b128 v[198:201], v1 offset:33024
    v_cvt_pk_bf16_f32 v176, v126, v127
    v_mfma_f32_16x16x32_bf16 v[122:125], v[218:221], a[200:203], v[122:125]
    s_waitcnt lgkmcnt(3)
    v_cvt_pk_bf16_f32 v177, v128, v129
    v_mul_f32 v133, v155, v133
    v_mfma_f32_16x16x32_bf16 v[122:125], v[222:225], a[204:207], v[122:125]
    s_waitcnt vmcnt(2)
    ds_write_b16 v8, v45 offset:512
    v_mfma_f32_16x16x32_bf16 v[122:125], v[186:189], a[208:211], v[122:125]
    s_waitcnt lgkmcnt(3)
    v_cvt_pk_f16_f32 v139, v132, v133
    v_mfma_f32_16x16x32_bf16 v[122:125], v[226:229], a[212:215], v[122:125]
    v_mul_f32 v158, v155, v158
    v_mul_f32 v159, v155, v159
    v_mfma_f32_16x16x32_bf16 v[130:133], a[72:75], v[206:209], 0
    v_cvt_pk_f16_f32 v140, v158, v159
    v_mul_f32 v160, v155, v160
    v_mfma_f32_16x16x32_bf16 v[130:133], a[76:79], v[210:213], v[130:133]
    v_mul_f32 v161, v155, v161
    v_cvt_pk_f16_f32 v141, v160, v161
    v_mfma_f32_16x16x32_bf16 v[130:133], a[80:83], v[238:241], v[130:133]
    s_waitcnt lgkmcnt(2)
    v_cvt_pk_bf16_f32 v136, v122, v123
    v_cvt_pk_bf16_f32 v137, v124, v125
    v_mfma_f32_16x16x32_bf16 v[130:133], a[84:87], v[242:245], v[130:133]
    s_waitcnt lgkmcnt(1)
    v_mul_f32 v142, v155, v142
    v_mul_f32 v143, v155, v143
    v_mfma_f32_16x16x32_bf16 v[130:133], a[88:91], v[214:217], v[130:133]
    v_cvt_pk_f16_f32 v128, v142, v143
    v_mul_f32 v144, v155, v144
    v_mfma_f32_16x16x32_bf16 v[130:133], a[92:95], v[198:201], v[130:133]
    s_waitcnt lgkmcnt(0)
    v_mul_f32 v145, v155, v145
    v_cvt_pk_f16_f32 v129, v144, v145
    v_mfma_f32_16x16x32_bf16 v[218:221], a[96:99], v[206:209], 0
    v_mul_f32 v170, v154, v170
    v_mul_f32 v171, v154, v171
    v_mfma_f32_16x16x32_bf16 v[218:221], a[100:103], v[210:213], v[218:221]
    v_cvt_pk_f16_f32 v150, v170, v171
    v_mul_f32 v172, v154, v172
    v_mfma_f32_16x16x32_bf16 v[218:221], a[104:107], v[238:241], v[218:221]
    v_mul_f32 v173, v154, v173
    v_cvt_pk_f16_f32 v151, v172, v173
    v_mfma_f32_16x16x32_bf16 v[218:221], a[108:111], v[242:245], v[218:221]
    s_barrier
    buffer_load_dwordx4 v10, s[8:11], 0 offen nt lds
    ds_read_u16 v202, v9 offset:128
    v_mfma_f32_16x16x32_bf16 v[218:221], a[112:115], v[214:217], v[218:221]
    s_add_u32 m0, s28, 4096
    v_mul_f32 v182, v154, v182
    v_mul_f32 v183, v154, v183
    v_mfma_f32_16x16x32_bf16 v[218:221], a[116:119], v[198:201], v[218:221]
    v_cvt_pk_f16_f32 v152, v182, v183
    v_mul_f32 v184, v154, v184
    v_mfma_f32_16x16x32_bf16 v[226:229], a[120:123], v[206:209], 0
    v_mul_f32 v185, v154, v185
    v_cvt_pk_f16_f32 v153, v184, v185
    v_mfma_f32_16x16x32_bf16 v[226:229], a[124:127], v[210:213], v[226:229]
    v_mul_f32 v162, v154, v162
    v_mul_f32 v163, v154, v163
    v_mfma_f32_16x16x32_bf16 v[226:229], a[128:131], v[238:241], v[226:229]
    buffer_load_dwordx4 v11, s[8:11], 0 offen nt lds
    v_cvt_pk_f16_f32 v126, v162, v163
    v_mfma_f32_16x16x32_bf16 v[226:229], a[132:135], v[242:245], v[226:229]
    s_add_u32 m0, s28, 8192
    v_mul_f32 v164, v154, v164
    v_mul_f32 v165, v154, v165
    v_mfma_f32_16x16x32_bf16 v[226:229], a[136:139], v[214:217], v[226:229]
    v_cvt_pk_f16_f32 v127, v164, v165
    v_mul_f32 v204, v254, v204
    v_mfma_f32_16x16x32_bf16 v[226:229], a[140:143], v[198:201], v[226:229]
    s_waitcnt lgkmcnt(0)
    v_readfirstlane_b32 s77, v202
    v_mul_f32 v205, v254, v205
    v_mfma_f32_16x16x32_bf16 v[162:165], a[0:3], v[206:209], 0
    v_cvt_pk_bf16_f32 v235, v204, v205
    v_fma_f32 v236, v130, v130, s32
    v_mfma_f32_16x16x32_bf16 v[162:165], a[4:7], v[210:213], v[162:165]
    buffer_load_dwordx4 v12, s[8:11], 0 offen nt lds
    v_fmac_f32 v236, v131, v131
    v_mfma_f32_16x16x32_bf16 v[162:165], a[8:11], v[238:241], v[162:165]
    s_add_u32 m0, s28, 12288
    v_fmac_f32 v236, v132, v132
    v_fmac_f32 v236, v133, v133
    v_mfma_f32_16x16x32_bf16 v[162:165], a[12:15], v[242:245], v[162:165]
    s_xor_b32 s28, s28, 65536
    v_fmac_f32 v236, v218, v218
    v_fmac_f32 v236, v219, v219
    v_mfma_f32_16x16x32_bf16 v[162:165], a[16:19], v[214:217], v[162:165]
    v_fmac_f32 v236, v220, v220
    v_fmac_f32 v236, v221, v221
    v_mfma_f32_16x16x32_bf16 v[162:165], a[20:23], v[198:201], v[162:165]
    v_fmac_f32 v236, v226, v226
    v_fmac_f32 v236, v227, v227
    v_mfma_f32_16x16x32_bf16 v[246:249], a[24:27], v[206:209], 0
    buffer_load_dwordx4 v13, s[8:11], 0 offen nt lds
    v_fmac_f32 v236, v228, v228
    v_mfma_f32_16x16x32_bf16 v[246:249], a[28:31], v[210:213], v[246:249]
    s_mov_b32 m0, s29
    v_fmac_f32 v236, v229, v229
    v_fma_f32 v237, v162, v162, s32
    v_mfma_f32_16x16x32_bf16 v[246:249], a[32:35], v[238:241], v[246:249]
    s_xor_b32 s29, s29, s30
    v_fmac_f32 v237, v163, v163
    v_fmac_f32 v237, v164, v164
    v_mfma_f32_16x16x32_bf16 v[246:249], a[36:39], v[242:245], v[246:249]
    s_add_u32 s19, s19, s20
    v_fmac_f32 v237, v165, v165
    v_mul_f32 v114, v255, v114
    v_mfma_f32_16x16x32_bf16 v[246:249], a[40:43], v[214:217], v[246:249]
    s_add_u32 s23, s23, s21
    v_mul_f32 v115, v255, v115
    v_cvt_pk_bf16_f32 v114, v114, v115
    v_mfma_f32_16x16x32_bf16 v[246:249], a[44:47], v[198:201], v[246:249]
    v_mul_f32 v116, v255, v116
    v_mfma_f32_16x16x32_bf16 v[122:125], a[48:51], v[206:209], 0
    s_cmp_ge_u32 s19, 72
    v_mul_f32 v117, v255, v117
    v_cvt_pk_bf16_f32 v115, v116, v117
    v_mfma_f32_16x16x32_bf16 v[122:125], a[52:55], v[210:213], v[122:125]
    s_cselect_b32 s34, 72, 0
    s_nop 0
    v_fmac_f32 v237, v246, v246
    v_fmac_f32 v237, v247, v247
    v_mfma_f32_16x16x32_bf16 v[122:125], a[56:59], v[238:241], v[122:125]
    s_cselect_b32 s35, s22, 0
    v_fmac_f32 v237, v248, v248
    v_fmac_f32 v237, v249, v249
    v_mfma_f32_16x16x32_bf16 v[122:125], a[60:63], v[242:245], v[122:125]
    s_sub_u32 s19, s19, s34
    v_mul_f32 v166, v255, v166
    v_mul_f32 v167, v255, v167
    v_mfma_f32_16x16x32_bf16 v[122:125], a[64:67], v[214:217], v[122:125]
    buffer_store_dwordx4 v[190:193], v15, s[12:15], 0 offen nt
    v_cvt_pk_bf16_f32 v116, v166, v167
    v_mul_f32 v168, v255, v168
    v_mul_f32 v169, v255, v169
    v_cvt_pk_bf16_f32 v117, v168, v169
    v_mfma_f32_16x16x32_bf16 v[122:125], a[68:71], v[198:201], v[122:125]
    s_add_u32 s23, s23, s35
    v_mul_f32 v230, v255, v230
    v_mul_f32 v231, v255, v231
    v_mfma_f32_16x16x32_bf16 v[154:157], v[206:209], a[144:147], 0
    s_cmp_lg_u32 s83, 0
    v_cvt_pk_bf16_f32 v254, v230, v231
    v_mul_f32 v232, v255, v232
    v_mfma_f32_16x16x32_bf16 v[154:157], v[210:213], a[148:151], v[154:157]
    s_cselect_b32 s77, s80, s77
    v_fmac_f32 v237, v122, v122
    v_fmac_f32 v237, v123, v123
    v_mfma_f32_16x16x32_bf16 v[154:157], v[238:241], a[152:155], v[154:157]
    s_mul_i32 s78, s77, 2688
    v_fmac_f32 v237, v124, v124
    v_fmac_f32 v237, v125, v125
    v_mfma_f32_16x16x32_bf16 v[154:157], v[242:245], a[156:159], v[154:157]
    s_add_u32 s78, s78, s69
    ds_read2_b32 v[144:145], v6 offset0:0 offset1:0
    ds_read2_b32 v[172:173], v6 offset0:16 offset1:16
    v_mfma_f32_16x16x32_bf16 v[154:157], v[214:217], a[160:163], v[154:157]
    s_add_u32 s80, s77, s68
    ds_read2_b32 v[192:193], v6 offset0:32 offset1:32
    v_cvt_pk_bf16_f32 v36, v237, v236
    v_mfma_f32_16x16x32_bf16 v[154:157], v[198:201], a[164:167], v[154:157]
    s_cmp_ge_u32 s80, 72
    v_mul_f32 v233, v255, v233
    v_cvt_pk_bf16_f32 v255, v232, v233
    v_mfma_f32_16x16x32_bf16 v[230:233], v[32:35], v[36:39], 0
    s_cselect_b32 s80, s22, 0
    v_xor_b32 v0, 65536, v0
    v_xor_b32 v1, 65536, v1
    v_mfma_f32_16x16x32_bf16 v[166:169], v[206:209], a[168:171], 0
    s_add_u32 s78, s78, s80
    v_cvt_pk_bf16_f32 v142, v154, v155
    v_cvt_pk_bf16_f32 v143, v156, v157
    v_mfma_f32_16x16x32_bf16 v[166:169], v[210:213], a[172:175], v[166:169]
    s_add_u32 s80, s77, 20
    v_rsq_f32 v231, v231
    v_mfma_f32_16x16x32_bf16 v[166:169], v[238:241], a[176:179], v[166:169]
    s_add_u32 s34, s18, 3
    v_rsq_f32 v230, v230
    v_mfma_f32_16x16x32_bf16 v[166:169], v[242:245], a[180:183], v[166:169]
    s_cmp_lt_u32 s77, s62
    v_mul_f32 v230, s31, v230
    v_mul_f32 v130, v231, v130
    v_mfma_f32_16x16x32_bf16 v[166:169], v[214:217], a[184:187], v[166:169]
    s_cselect_b32 s79, 1, 0
    v_mul_f32 v131, v231, v131
    v_cvt_pk_f16_f32 v158, v130, v131
    v_mfma_f32_16x16x32_bf16 v[166:169], v[198:201], a[188:191], v[166:169]
    s_cselect_b32 s78, s78, 0
    v_mul_f32 v132, v231, v132
    v_mul_f32 v133, v231, v133
    v_mfma_f32_16x16x32_bf16 v[250:253], v[206:209], a[192:195], 0
    s_cmp_lt_u32 s34, s17
    v_cvt_pk_f16_f32 v159, v132, v133
    v_mul_f32 v218, v231, v218
    v_mfma_f32_16x16x32_bf16 v[250:253], v[210:213], a[196:199], v[250:253]
    s_cselect_b32 s23, s23, s78
    v_cvt_pk_bf16_f32 v170, v166, v167
    v_cvt_pk_bf16_f32 v171, v168, v169
    v_mfma_f32_16x16x32_bf16 v[250:253], v[238:241], a[200:203], v[250:253]
    s_cselect_b32 s73, s34, s80
    ds_read_b128 v[222:225], v5 offset:0
    ds_read_b128 v[202:205], v5 offset:16
    v_mfma_f32_16x16x32_bf16 v[250:253], v[242:245], a[204:207], v[250:253]
    s_cselect_b32 s79, 0, s79
    ds_read_b128 v[154:157], v5 offset:48
    ds_read_b32 v232, v6 offset:192
    v_mfma_f32_16x16x32_bf16 v[250:253], v[214:217], a[208:211], v[250:253]
    s_waitcnt lgkmcnt(4)
    buffer_store_dwordx2 v[234:235], v18, s[12:15], 0 offen nt
    v_mul_f32 v219, v231, v219
    v_cvt_pk_f16_f32 v160, v218, v219
    v_mfma_f32_16x16x32_f16 v[186:189], v[178:181], v[194:197], v[46:49]
    s_cselect_b32 s81, 0, 1
    v_mul_f32 v220, v231, v220
    v_mul_f32 v221, v231, v221
    v_mfma_f32_16x16x32_f16 v[182:185], v[138:141], v[194:197], v[50:53]
    s_add_u32 s80, s77, 1
    v_cvt_pk_f16_f32 v161, v220, v221
    v_mul_f32 v226, v231, v226
    v_mul_f32 v227, v231, v227
    v_mfma_f32_16x16x32_f16 v[166:169], v[158:161], v[194:197], v[54:57]
    s_mul_i32 s80, s80, s81
    v_cvt_pk_f16_f32 v132, v226, v227
    v_mul_f32 v228, v231, v228
    v_mul_f32 v229, v231, v229
    v_mfma_f32_16x16x16_f16 v[186:189], v[120:121], v[118:119], v[186:189]
    v_cvt_pk_f16_f32 v133, v228, v229
    v_mul_f32 v162, v230, v162
    v_mul_f32 v163, v230, v163
    v_mfma_f32_16x16x16_f16 v[182:185], v[128:129], v[118:119], v[182:185]
    v_cvt_pk_f16_f32 v162, v162, v163
    v_mul_f32 v164, v230, v164
    v_mul_f32 v165, v230, v165
    v_mfma_f32_16x16x16_f16 v[166:169], v[132:133], v[118:119], v[166:169]
    v_cvt_pk_f16_f32 v163, v164, v165
    v_mul_f32 v246, v230, v246
    v_mul_f32 v247, v230, v247
    v_cvt_pk_f16_f32 v164, v246, v247
    v_mfma_f32_16x16x32_bf16 v[250:253], v[198:201], a[212:215], v[250:253]
    s_waitcnt lgkmcnt(0)
    ds_read_b128 v[214:217], v2 offset:0
    ds_read_b128 v[206:209], v2 offset:1024
    v_mfma_f32_16x16x32_f16 v[226:229], v[222:225], v[194:197], v[22:25]
    s_cmp_lt_u32 s80, s62
    ds_read_b128 v[210:213], v2 offset:2048
    ds_read_b128 v[194:197], v2 offset:3072
    v_mfma_f32_16x16x32_f16 v[226:229], v[202:205], v[178:181], v[226:229]
    s_cselect_b32 s70, s70, 0
    v_cvt_pk_bf16_f32 v190, v250, v251
    v_cvt_pk_bf16_f32 v191, v252, v253
    v_mfma_f32_16x16x32_f16 v[226:229], v[154:157], v[118:121], v[226:229]
    s_cselect_b32 s62, s62, 0
    ds_read_b128 v[198:201], v2 offset:4096
    v_mul_f32 v248, v230, v248
    v_mul_f32 v249, v230, v249
    v_cvt_pk_f16_f32 v165, v248, v249
    v_mfma_f32_16x16x32_f16 v[218:221], v[222:225], v[150:153], v[24:27]
    s_add_u32 s80, s18, 4
    v_mul_f32 v122, v230, v122
    v_mul_f32 v123, v230, v123
    v_mfma_f32_16x16x32_f16 v[218:221], v[202:205], v[138:141], v[218:221]
    s_cmp_ge_u32 s80, s17
    v_cvt_pk_f16_f32 v130, v122, v123
    v_mul_f32 v124, v230, v124
    v_mfma_f32_16x16x32_f16 v[218:221], v[154:157], v[126:129], v[218:221]
    s_cselect_b32 s66, s70, 0
    v_mul_f32 v125, v230, v125
    v_cvt_pk_f16_f32 v131, v124, v125
    v_mfma_f32_16x16x32_f16 v[238:241], v[222:225], v[162:165], v[26:29]
    s_waitcnt lgkmcnt(3)
    ds_read_b128 v[222:225], v2 offset:5120
    v_mov_b32_dpp v232, v227 quad_perm:[0,1,2,3] row_mask:0x1 bank_mask:0xf
    v_mfma_f32_16x16x32_f16 v[238:241], v[202:205], v[158:161], v[238:241]
    s_lshl_b32 s80, s79, s73
    v_mov_b32_dpp v232, v219 quad_perm:[0,1,2,3] row_mask:0x2 bank_mask:0xf
    v_max3_f32 v118, v226, v186, v187
    v_mfma_f32_16x16x32_f16 v[238:241], v[154:157], v[130:133], v[238:241]
    s_waitcnt lgkmcnt(2)
    buffer_store_dwordx4 v[114:117], v16, s[12:15], 0 offen nt
    v_max3_f32 v118, v118, v188, v189
    v_max3_f32 v118, v118, v182, v183
    v_max3_f32 v118, v118, v184, v185
    v_max3_f32 v118, v118, v166, v167
    v_mfma_f32_16x16x32_bf16 v[122:125], a[216:219], v[214:217], 0
    s_or_b32 s63, s63, s80
    v_max3_f32 v118, v118, v168, v169
    v_mov_b32 v119, v118
    v_mfma_f32_16x16x32_bf16 v[122:125], a[220:223], v[206:209], v[122:125]
    s_sub_u32 s80, s100, s81
    v_permlane32_swap_b32 v118, v119
    v_mfma_f32_16x16x32_bf16 v[122:125], a[224:227], v[210:213], v[122:125]
    s_and_b32 s100, s100, s80
    v_max_f32 v118, v118, v119
    v_mov_b32 v119, v118
    v_mfma_f32_16x16x32_bf16 v[122:125], a[228:231], v[194:197], v[122:125]
    s_waitcnt lgkmcnt(1)
    v_permlane16_swap_b32 v118, v119
    v_mfma_f32_16x16x32_bf16 v[122:125], a[232:235], v[198:201], v[122:125]
    s_waitcnt lgkmcnt(0)
    v_max_f32 v118, v118, v119
    v_sub_f32 v186, v186, v118
    v_mfma_f32_16x16x32_bf16 v[122:125], a[236:239], v[222:225], v[122:125]
    s_add_u32 s45, s45, s79
    v_exp_f32 v186, v186
    v_mfma_f32_16x16x32_bf16 v[154:157], a[240:243], v[214:217], 0
    s_add_u32 s18, s18, 1
    v_sub_f32 v187, v187, v118
    v_sub_f32 v188, v188, v118
    v_mfma_f32_16x16x32_bf16 v[154:157], a[244:247], v[206:209], v[154:157]
    s_cmp_lt_u32 s18, s45
    v_exp_f32 v187, v187
    v_mfma_f32_16x16x32_bf16 v[154:157], a[248:251], v[210:213], v[154:157]
    v_cvt_pk_bf16_f32 v186, v186, v187
    v_sub_f32 v189, v189, v118
    v_mfma_f32_16x16x32_bf16 v[154:157], a[252:255], v[194:197], v[154:157]
    v_exp_f32 v188, v188
    v_mfma_f32_16x16x32_bf16 v[154:157], v[82:85], v[198:201], v[154:157]
    v_exp_f32 v189, v189
    v_mfma_f32_16x16x32_bf16 v[154:157], v[86:89], v[222:225], v[154:157]
    v_cvt_pk_bf16_f32 v187, v188, v189
    v_sub_f32 v182, v182, v118
    v_mfma_f32_16x16x32_bf16 v[202:205], v[90:93], v[214:217], 0
    ds_read_b128 v[214:217], v2 offset:6144
    v_sub_f32 v183, v183, v118
    v_mfma_f32_16x16x32_bf16 v[202:205], v[94:97], v[206:209], v[202:205]
    ds_read_b128 v[206:209], v2 offset:7168
    v_sub_f32 v184, v184, v118
    v_mfma_f32_16x16x32_bf16 v[202:205], v[98:101], v[210:213], v[202:205]
    ds_read_b128 v[210:213], v2 offset:8192
    v_sub_f32 v185, v185, v118
    v_mfma_f32_16x16x32_bf16 v[202:205], v[102:105], v[194:197], v[202:205]
    ds_read_b128 v[194:197], v2 offset:9216
    buffer_store_dwordx2 v[254:255], v19, s[12:15], 0 offen nt
    v_exp_f32 v182, v182
    v_mfma_f32_16x16x32_f16 v[234:237], v[178:181], v[150:153], v[58:61]
    v_exp_f32 v183, v183
    v_mfma_f32_16x16x32_bf16 v[202:205], v[106:109], v[198:201], v[202:205]
    ds_read_b128 v[198:201], v2 offset:10240
    v_cvt_pk_bf16_f32 v188, v182, v183
    v_mfma_f32_16x16x32_bf16 v[202:205], v[110:113], v[222:225], v[202:205]
    ds_read_b128 v[222:225], v2 offset:11264
    v_exp_f32 v184, v184
    v_mfma_f32_16x16x16_f16 v[234:237], v[120:121], v[126:127], v[234:237]
    v_exp_f32 v185, v185
    v_sub_f32 v166, v166, v118
    v_cvt_pk_bf16_f32 v189, v184, v185
    v_mfma_f32_16x16x32_f16 v[182:185], v[138:141], v[150:153], v[62:65]
    s_waitcnt lgkmcnt(4)
    v_exp_f32 v166, v166
    v_sub_f32 v167, v167, v118
    v_exp_f32 v167, v167
    v_sub_f32 v168, v168, v118
    v_cvt_pk_bf16_f32 v36, v166, v167
    v_mfma_f32_16x16x16_f16 v[182:185], v[128:129], v[126:127], v[182:185]
    v_exp_f32 v168, v168
    v_sub_f32 v169, v169, v118
    v_sub_f32 v226, v226, v118
    v_mfma_f32_16x16x32_f16 v[242:245], v[158:161], v[150:153], v[66:69]
    s_waitcnt lgkmcnt(2)
    v_exp_f32 v169, v169
    v_mfma_f32_16x16x32_bf16 v[114:117], a[216:219], v[214:217], 0
    s_waitcnt lgkmcnt(1)
    v_cvt_pk_bf16_f32 v37, v168, v169
    v_mov_b32_dpp v232, v239 quad_perm:[0,1,2,3] row_mask:0x4 bank_mask:0xf
    v_mov_b32 v118, v232
    v_mfma_f32_16x16x16_f16 v[242:245], v[132:133], v[126:127], v[242:245]
    v_exp_f32 v226, v226
    v_max_f32_dpp v118, v118, v118 quad_perm:[1,0,3,2] row_mask:0xf bank_mask:0xf
    v_cvt_pk_bf16_f32 v39, v226, 0
    v_mfma_f32_16x16x32_bf16 v[114:117], a[220:223], v[206:209], v[114:117]
    s_waitcnt lgkmcnt(0)
    v_max_f32_dpp v118, v118, v118 quad_perm:[2,3,0,1] row_mask:0xf bank_mask:0xf
    v_max3_f32 v126, v218, v234, v235
    v_mfma_f32_16x16x32_bf16 v[150:153], v[28:31], v[36:39], 0
    v_max_f32_dpp v118, v118, v118 row_half_mirror row_mask:0xf bank_mask:0xf
    v_max3_f32 v126, v126, v236, v237
    v_mfma_f32_16x16x32_bf16 v[150:153], v[28:31], v[186:189], v[150:153]
    v_max_f32_dpp v118, v118, v118 row_mirror row_mask:0xf bank_mask:0xf
    v_mov_b32 v119, v118
    v_mfma_f32_16x16x32_bf16 v[114:117], a[224:227], v[210:213], v[114:117]
    v_max3_f32 v126, v126, v182, v183
    v_max3_f32 v126, v126, v184, v185
    v_mfma_f32_16x16x32_bf16 v[114:117], a[228:231], v[194:197], v[114:117]
    v_permlane32_swap_b32 v118, v119
    v_mfma_f32_16x16x32_bf16 v[114:117], a[232:235], v[198:201], v[114:117]
    v_rcp_f32 v150, v150
    v_mfma_f32_16x16x32_bf16 v[114:117], a[236:239], v[222:225], v[114:117]
    v_max_f32 v118, v118, v119
    v_mov_b32 v119, v118
    v_max3_f32 v126, v126, v242, v243
    v_max3_f32 v126, v126, v244, v245
    v_permlane16_swap_b32 v118, v119
    v_max_f32 v118, v118, v119
    v_mfma_f32_16x16x32_bf16 v[166:169], v[142:145], v[36:39], 0
    v_sub_f32 v232, v232, v118
    v_mov_b32 v127, v126
    v_mfma_f32_16x16x32_bf16 v[166:169], v[146:149], v[186:189], v[166:169]
    v_exp_f32 v232, v232
    v_permlane32_swap_b32 v126, v127
    v_cvt_pk_bf16_f32 v232, v232, v232
    v_max_f32 v126, v126, v127
    v_mov_b32 v127, v126
    v_fma_f32 v254, v122, v122, s33
    v_fmac_f32 v254, v123, v123
    v_permlane16_swap_b32 v126, v127
    v_mul_f32 v166, v150, v166
    v_mul_f32 v167, v150, v167
    v_cvt_pk_bf16_f32 v166, v166, v167
    v_mul_f32 v168, v150, v168
    v_mul_f32 v169, v150, v169
    v_cvt_pk_bf16_f32 v167, v168, v169
    v_max_f32 v126, v126, v127
    v_sub_f32 v234, v234, v126
    v_exp_f32 v234, v234
    v_sub_f32 v235, v235, v126
    v_exp_f32 v235, v235
    v_sub_f32 v236, v236, v126
    v_cvt_pk_bf16_f32 v226, v234, v235
    v_exp_f32 v236, v236
    v_sub_f32 v237, v237, v126
    v_exp_f32 v237, v237
    v_sub_f32 v182, v182, v126
    v_cvt_pk_bf16_f32 v227, v236, v237
    v_mfma_f32_16x16x32_bf16 v[234:237], v[170:173], v[36:39], 0
    ds_write_b16 v8, v232
    v_mfma_f32_16x16x32_bf16 v[234:237], v[174:177], v[186:189], v[234:237]
    v_exp_f32 v182, v182
    v_sub_f32 v183, v183, v126
    v_exp_f32 v183, v183
    v_sub_f32 v184, v184, v126
    v_cvt_pk_bf16_f32 v228, v182, v183
    v_exp_f32 v184, v184
    v_sub_f32 v185, v185, v126
    v_exp_f32 v185, v185
    v_mul_f32 v234, v150, v234
    v_mul_f32 v235, v150, v235
    v_cvt_pk_bf16_f32 v168, v234, v235
    v_mul_f32 v236, v150, v236
    v_mul_f32 v237, v150, v237
    v_cvt_pk_bf16_f32 v169, v236, v237
    v_mfma_f32_16x16x32_bf16 v[230:233], v[190:193], v[36:39], 0
    ds_write_b128 v3, v[166:169] offset:0
    v_mfma_f32_16x16x32_bf16 v[230:233], v[134:137], v[186:189], v[230:233]
    v_cvt_pk_bf16_f32 v229, v184, v185
    v_sub_f32 v242, v242, v126
    v_mfma_f32_16x16x32_f16 v[182:185], v[178:181], v[162:165], v[70:73]
    v_exp_f32 v242, v242
    v_mfma_f32_16x16x32_bf16 v[166:169], a[240:243], v[214:217], 0
    ds_read_b128 v[178:181], v9
    v_sub_f32 v243, v243, v126
    v_mfma_f32_16x16x32_bf16 v[166:169], a[244:247], v[206:209], v[166:169]
    v_mul_f32 v230, v150, v230
    v_mul_f32 v231, v150, v231
    v_cvt_pk_bf16_f32 v220, v230, v231
    v_mfma_f32_16x16x16_f16 v[182:185], v[120:121], v[130:131], v[182:185]
    v_mul_f32 v232, v150, v232
    v_mul_f32 v233, v150, v233
    v_cvt_pk_bf16_f32 v221, v232, v233
    v_sub_f32 v244, v244, v126
    v_mfma_f32_16x16x32_bf16 v[166:169], a[248:251], v[210:213], v[166:169]
    ds_read_b128 v[118:121], v9 offset:64
    v_sub_f32 v245, v245, v126
    v_mfma_f32_16x16x32_bf16 v[166:169], a[252:255], v[194:197], v[166:169]
    ds_write_b64 v4, v[220:221] offset:4096
    v_mfma_f32_16x16x32_bf16 v[166:169], v[82:85], v[198:201], v[166:169]
    v_max3_f32 v255, v238, v182, v183
    v_max3_f32 v255, v255, v184, v185
    v_mfma_f32_16x16x32_bf16 v[166:169], v[86:89], v[222:225], v[166:169]
    v_exp_f32 v243, v243
    v_exp_f32 v244, v244
    v_cvt_pk_bf16_f32 v36, v242, v243
    v_mfma_f32_16x16x32_f16 v[186:189], v[138:141], v[162:165], v[74:77]
    s_waitcnt lgkmcnt(2)
    v_exp_f32 v245, v245
    v_mfma_f32_16x16x32_f16 v[246:249], v[158:161], v[162:165], v[78:81]
    v_cvt_pk_bf16_f32 v37, v244, v245
    v_sub_f32 v218, v218, v126
    v_mfma_f32_16x16x32_bf16 v[242:245], v[178:181], v[28:31], 0
    v_exp_f32 v218, v218
    v_fmac_f32 v254, v124, v124
    v_mfma_f32_16x16x16_f16 v[186:189], v[128:129], v[130:131], v[186:189]
    v_cvt_pk_bf16_f32 v39, v218, 0
    v_fmac_f32 v254, v125, v125
    v_fmac_f32 v254, v154, v154
    v_mfma_f32_16x16x16_f16 v[246:249], v[132:133], v[130:131], v[246:249]
    v_fmac_f32 v254, v155, v155
    v_fmac_f32 v254, v156, v156
    v_fmac_f32 v254, v157, v157
    v_fmac_f32 v254, v202, v202
    v_mfma_f32_16x16x32_bf16 v[126:129], v[28:31], v[36:39], 0
    s_waitcnt lgkmcnt(0)
    v_max3_f32 v255, v255, v186, v187
    v_max3_f32 v255, v255, v188, v189
    v_mfma_f32_16x16x32_bf16 v[126:129], v[28:31], v[226:229], v[126:129]
    v_max3_f32 v255, v255, v246, v247
    v_max3_f32 v255, v255, v248, v249
    v_mfma_f32_16x16x32_bf16 v[130:133], v[142:145], v[36:39], 0
    v_mov_b32 v239, v255
    v_fmac_f32 v254, v203, v203
    v_mfma_f32_16x16x32_bf16 v[130:133], v[146:149], v[226:229], v[130:133]
    v_permlane32_swap_b32 v255, v239
    v_mfma_f32_16x16x32_bf16 v[138:141], v[170:173], v[36:39], 0
    v_rcp_f32 v126, v126
    v_mfma_f32_16x16x32_bf16 v[138:141], v[174:177], v[226:229], v[138:141]
    v_max_f32 v255, v255, v239
    v_mov_b32 v239, v255
    v_mfma_f32_16x16x32_bf16 v[150:153], v[190:193], v[36:39], 0
    v_fmac_f32 v254, v204, v204
    v_mul_f32 v130, v126, v130
    v_mfma_f32_16x16x32_bf16 v[150:153], v[134:137], v[226:229], v[150:153]
    v_mul_f32 v131, v126, v131
    v_cvt_pk_bf16_f32 v130, v130, v131
    v_mfma_f32_16x16x32_bf16 v[242:245], v[118:121], v[28:31], v[242:245]
    v_mul_f32 v132, v126, v132
    v_mul_f32 v133, v126, v133
    v_mfma_f32_16x16x32_bf16 v[218:221], v[178:181], v[146:149], 0
    v_cvt_pk_bf16_f32 v131, v132, v133
    v_mul_f32 v138, v126, v138
    v_mfma_f32_16x16x32_bf16 v[218:221], v[118:121], v[142:145], v[218:221]
    v_mul_f32 v139, v126, v139
    v_cvt_pk_bf16_f32 v132, v138, v139
    v_mfma_f32_16x16x32_bf16 v[226:229], v[178:181], v[174:177], 0
    v_mul_f32 v140, v126, v140
    v_mul_f32 v141, v126, v141
    v_mfma_f32_16x16x32_bf16 v[226:229], v[118:121], v[170:173], v[226:229]
    v_cvt_pk_bf16_f32 v133, v140, v141
    v_mul_f32 v150, v126, v150
    v_mfma_f32_16x16x32_bf16 v[250:253], v[178:181], v[134:137], 0
    ds_write_b128 v3, v[130:133] offset:6144
    v_mfma_f32_16x16x32_bf16 v[250:253], v[118:121], v[190:193], v[250:253]
    v_mul_f32 v151, v126, v151
    v_cvt_pk_bf16_f32 v240, v150, v151
    v_mfma_f32_16x16x32_bf16 v[230:233], v[90:93], v[214:217], 0
    v_mul_f32 v152, v126, v152
    v_mul_f32 v153, v126, v153
    v_mfma_f32_16x16x32_bf16 v[230:233], v[94:97], v[206:209], v[230:233]
    ds_read_b128 v[118:121], v2 offset:12288
    ds_read_b128 v[126:129], v2 offset:13312
    v_mfma_f32_16x16x32_bf16 v[230:233], v[98:101], v[210:213], v[230:233]
    ds_read_b128 v[130:133], v2 offset:14336
    v_cvt_pk_bf16_f32 v241, v152, v153
    v_mfma_f32_16x16x32_bf16 v[230:233], v[102:105], v[194:197], v[230:233]
    ds_read_b128 v[158:161], v2 offset:15360
    v_fmac_f32 v254, v205, v205
    v_mfma_f32_16x16x32_bf16 v[230:233], v[106:109], v[198:201], v[230:233]
    ds_read_b128 v[178:181], v2 offset:16384
    v_fma_f32 v219, v114, v114, s33
    v_mfma_f32_16x16x32_bf16 v[230:233], v[110:113], v[222:225], v[230:233]
    ds_read_b128 v[194:197], v2 offset:17408
    ds_write_b64 v4, v[240:241] offset:10240
    v_permlane16_swap_b32 v255, v239
    v_max_f32 v255, v255, v239
    v_sub_f32 v182, v182, v255
    v_exp_f32 v182, v182
    v_sub_f32 v183, v183, v255
    v_exp_f32 v183, v183
    s_waitcnt lgkmcnt(5)
    v_mfma_f32_16x16x32_bf16 v[150:153], a[216:219], v[118:121], 0
    v_cvt_pk_bf16_f32 v198, v182, v183
    v_sub_f32 v184, v184, v255
    v_mfma_f32_16x16x32_bf16 v[150:153], a[220:223], v[126:129], v[150:153]
    s_waitcnt lgkmcnt(4)
    v_exp_f32 v184, v184
    v_mfma_f32_16x16x32_bf16 v[150:153], a[224:227], v[130:133], v[150:153]
    s_waitcnt lgkmcnt(3)
    v_sub_f32 v185, v185, v255
    v_sub_f32 v186, v186, v255
    v_mfma_f32_16x16x32_bf16 v[150:153], a[228:231], v[158:161], v[150:153]
    s_waitcnt lgkmcnt(2)
    v_exp_f32 v185, v185
    v_mfma_f32_16x16x32_bf16 v[150:153], a[232:235], v[178:181], v[150:153]
    s_waitcnt lgkmcnt(0)
    v_cvt_pk_bf16_f32 v199, v184, v185
    v_sub_f32 v187, v187, v255
    v_mfma_f32_16x16x32_bf16 v[150:153], a[236:239], v[194:197], v[150:153]
    v_exp_f32 v186, v186
    v_mfma_f32_16x16x32_bf16 v[162:165], a[240:243], v[118:121], 0
    v_exp_f32 v187, v187
    v_mfma_f32_16x16x32_bf16 v[162:165], a[244:247], v[126:129], v[162:165]
    v_cvt_pk_bf16_f32 v200, v186, v187
    v_sub_f32 v188, v188, v255
    v_mfma_f32_16x16x32_bf16 v[162:165], a[248:251], v[130:133], v[162:165]
    v_exp_f32 v188, v188
    v_mfma_f32_16x16x32_bf16 v[162:165], a[252:255], v[158:161], v[162:165]
    v_sub_f32 v189, v189, v255
    v_sub_f32 v246, v246, v255
    v_mfma_f32_16x16x32_bf16 v[162:165], v[82:85], v[178:181], v[162:165]
    v_exp_f32 v189, v189
    v_mfma_f32_16x16x32_bf16 v[162:165], v[86:89], v[194:197], v[162:165]
    v_cvt_pk_bf16_f32 v201, v188, v189
    v_sub_f32 v247, v247, v255
    v_mfma_f32_16x16x32_bf16 v[138:141], v[90:93], v[118:121], 0
    v_exp_f32 v246, v246
    v_mfma_f32_16x16x32_bf16 v[138:141], v[94:97], v[126:129], v[138:141]
    v_exp_f32 v247, v247
    v_mfma_f32_16x16x32_bf16 v[138:141], v[98:101], v[130:133], v[138:141]
    v_cvt_pk_bf16_f32 v36, v246, v247
    v_sub_f32 v248, v248, v255
    v_mfma_f32_16x16x32_bf16 v[138:141], v[102:105], v[158:161], v[138:141]
    v_exp_f32 v248, v248
    v_mfma_f32_16x16x32_bf16 v[138:141], v[106:109], v[178:181], v[138:141]
    v_sub_f32 v249, v249, v255
    v_sub_f32 v238, v238, v255
    v_mfma_f32_16x16x32_bf16 v[138:141], v[110:113], v[194:197], v[138:141]
    ds_read_b128 v[186:189], v0 offset:20480
    ds_read_b128 v[118:121], v1 offset:20480
    ds_read_b128 v[234:237], v0 offset:20608
    v_exp_f32 v249, v249
    v_exp_f32 v238, v238
    v_cvt_pk_bf16_f32 v37, v248, v249
    v_cvt_pk_bf16_f32 v39, v238, 0
    v_fma_f32 v255, v150, v150, s33
    v_fmac_f32 v255, v151, v151
    v_mfma_f32_16x16x32_bf16 v[126:129], v[28:31], v[36:39], 0
    ds_read_b128 v[158:161], v1 offset:20608
    ds_read_b128 v[182:185], v0 offset:20736
    v_mfma_f32_16x16x32_bf16 v[126:129], v[28:31], v[198:201], v[126:129]
    ds_read_b128 v[206:209], v1 offset:20736
    v_fmac_f32 v255, v152, v152
    v_mfma_f32_16x16x32_bf16 v[178:181], v[142:145], v[36:39], 0
    v_fmac_f32 v255, v153, v153
    v_fmac_f32 v255, v162, v162
    v_mfma_f32_16x16x32_bf16 v[178:181], v[146:149], v[198:201], v[178:181]
    v_fmac_f32 v255, v163, v163
    v_fmac_f32 v255, v164, v164
    v_mfma_f32_16x16x32_bf16 v[142:145], v[170:173], v[36:39], 0
    s_waitcnt lgkmcnt(5)
    v_rcp_f32 v126, v126
    v_mfma_f32_16x16x32_bf16 v[142:145], v[174:177], v[198:201], v[142:145]
    s_waitcnt lgkmcnt(3)
    v_fmac_f32 v255, v165, v165
    v_mul_f32 v178, v126, v178
    v_mfma_f32_16x16x32_bf16 v[146:149], v[190:193], v[36:39], 0
    v_mul_f32 v179, v126, v179
    v_cvt_pk_bf16_f32 v170, v178, v179
    v_mfma_f32_16x16x32_bf16 v[146:149], v[134:137], v[198:201], v[146:149]
    v_mul_f32 v180, v126, v180
    v_mul_f32 v181, v126, v181
    v_mfma_f32_16x16x32_bf16 v[130:133], a[72:75], v[186:189], 0
    s_waitcnt lgkmcnt(1)
    v_cvt_pk_bf16_f32 v171, v180, v181
    v_mul_f32 v142, v126, v142
    v_mfma_f32_16x16x32_bf16 v[130:133], a[76:79], v[118:121], v[130:133]
    s_waitcnt lgkmcnt(0)
    v_mul_f32 v143, v126, v143
    v_cvt_pk_bf16_f32 v172, v142, v143
    v_mfma_f32_16x16x32_bf16 v[130:133], a[80:83], v[234:237], v[130:133]
    v_mul_f32 v144, v126, v144
    v_mul_f32 v145, v126, v145
    v_mfma_f32_16x16x32_bf16 v[130:133], a[84:87], v[158:161], v[130:133]
    v_cvt_pk_bf16_f32 v173, v144, v145
    v_mul_f32 v146, v126, v146
    v_mfma_f32_16x16x32_bf16 v[130:133], a[88:91], v[182:185], v[130:133]
    ds_write_b128 v3, v[170:173] offset:12288
    v_mfma_f32_16x16x32_bf16 v[130:133], a[92:95], v[206:209], v[130:133]
    v_mul_f32 v147, v126, v147
    v_cvt_pk_bf16_f32 v220, v146, v147
    v_mfma_f32_16x16x32_bf16 v[134:137], a[96:99], v[186:189], 0
    v_mul_f32 v148, v126, v148
    v_mul_f32 v149, v126, v149
    v_mfma_f32_16x16x32_bf16 v[134:137], a[100:103], v[118:121], v[134:137]
    v_cvt_pk_bf16_f32 v221, v148, v149
    v_fmac_f32 v255, v138, v138
    v_mfma_f32_16x16x32_bf16 v[134:137], a[104:107], v[234:237], v[134:137]
    ds_write_b64 v4, v[220:221] offset:16384
    v_mfma_f32_16x16x32_bf16 v[134:137], a[108:111], v[158:161], v[134:137]
    v_fmac_f32 v255, v139, v139
    v_fmac_f32 v255, v140, v140
    v_mfma_f32_16x16x32_bf16 v[134:137], a[112:115], v[182:185], v[134:137]
    v_fmac_f32 v255, v141, v141
    v_cvt_pk_bf16_f32 v255, v255, v255
    v_mfma_f32_16x16x32_bf16 v[134:137], a[116:119], v[206:209], v[134:137]
    v_rcp_f32 v242, v242
    v_mfma_f32_16x16x32_bf16 v[170:173], a[120:123], v[186:189], 0
    v_mul_f32 v218, v218, v242
    v_mul_f32_dpp v218, v226, v242 quad_perm:[0,1,2,3] row_mask:0x2 bank_mask:0xf
    v_mfma_f32_16x16x32_bf16 v[170:173], a[124:127], v[118:121], v[170:173]
    v_mul_f32_dpp v218, v250, v242 quad_perm:[0,1,2,3] row_mask:0x4 bank_mask:0xf
    v_cvt_pk_bf16_f32 v218, v218, v218
    v_mfma_f32_16x16x32_bf16 v[170:173], a[128:131], v[234:237], v[170:173]
    ds_write_b16 v7, v218
    v_mfma_f32_16x16x32_bf16 v[170:173], a[132:135], v[158:161], v[170:173]
    v_fmac_f32 v219, v115, v115
    v_fmac_f32 v219, v116, v116
    v_mfma_f32_16x16x32_bf16 v[170:173], a[136:139], v[182:185], v[170:173]
    v_fmac_f32 v219, v117, v117
    v_fmac_f32 v219, v166, v166
    v_mfma_f32_16x16x32_bf16 v[170:173], a[140:143], v[206:209], v[170:173]
    v_fmac_f32 v219, v167, v167
    v_fmac_f32 v219, v168, v168
    v_mfma_f32_16x16x32_bf16 v[142:145], a[0:3], v[186:189], 0
    v_fmac_f32 v219, v169, v169
    v_fmac_f32 v219, v230, v230
    v_mfma_f32_16x16x32_bf16 v[142:145], a[4:7], v[118:121], v[142:145]
    v_fmac_f32 v219, v231, v231
    v_fmac_f32 v219, v232, v232
    v_mfma_f32_16x16x32_bf16 v[142:145], a[8:11], v[234:237], v[142:145]
    v_fmac_f32 v219, v233, v233
    v_cvt_pk_bf16_f32 v254, v254, v219
    v_mfma_f32_16x16x32_bf16 v[142:145], a[12:15], v[158:161], v[142:145]
    ds_write_b64 v4, v[254:255] offset:18432
    v_mfma_f32_16x16x32_bf16 v[142:145], a[16:19], v[182:185], v[142:145]
    v_fma_f32 v174, v130, v130, s32
    v_fmac_f32 v174, v131, v131
    v_mfma_f32_16x16x32_bf16 v[142:145], a[20:23], v[206:209], v[142:145]
    v_fmac_f32 v174, v132, v132
    v_fmac_f32 v174, v133, v133
    v_mfma_f32_16x16x32_bf16 v[126:129], a[24:27], v[186:189], 0
    v_xor_b32 v2, 65536, v2
    v_xor_b32 v3, 65536, v3
    v_mfma_f32_16x16x32_bf16 v[126:129], a[28:31], v[118:121], v[126:129]
    v_xor_b32 v4, 65536, v4
    v_add_u32 v5, s74, v5
    v_mfma_f32_16x16x32_bf16 v[126:129], a[32:35], v[234:237], v[126:129]
    v_add_u32 v6, s75, v6
    v_add_u32 v7, s76, v7
    v_mfma_f32_16x16x32_bf16 v[126:129], a[36:39], v[158:161], v[126:129]
    v_mfma_f32_16x16x32_bf16 v[126:129], a[40:43], v[182:185], v[126:129]
    s_waitcnt lgkmcnt(0)
    s_nop 0
    s_nop 0
    s_nop 0
    s_barrier
    v_mfma_f32_16x16x32_bf16 v[126:129], a[44:47], v[206:209], v[126:129]
    s_cbranch_scc1 L_loop_safe3
L_final_safe:
    v_mfma_f32_16x16x32_bf16 v[146:149], a[48:51], v[186:189], 0
    s_mov_b32 s12, s40
    ds_read_b128 v[178:181], v2 offset:18432
    ds_read_b128 v[190:193], v2 offset:19456
    v_mfma_f32_16x16x32_bf16 v[146:149], a[52:55], v[118:121], v[146:149]
    s_mov_b32 s13, s41
    v_fmac_f32 v174, v134, v134
    v_fmac_f32 v174, v135, v135
    v_mfma_f32_16x16x32_bf16 v[146:149], a[56:59], v[234:237], v[146:149]
    s_mov_b32 s14, s36
    v_fmac_f32 v174, v136, v136
    v_fmac_f32 v174, v137, v137
    v_mfma_f32_16x16x32_bf16 v[146:149], a[60:63], v[158:161], v[146:149]
    s_add_u32 s48, s40, s27
    v_fmac_f32 v174, v170, v170
    v_fmac_f32 v174, v171, v171
    v_mfma_f32_16x16x32_bf16 v[146:149], a[64:67], v[182:185], v[146:149]
    s_addc_u32 s49, s41, 0
    v_fmac_f32 v174, v172, v172
    v_fmac_f32 v174, v173, v173
    v_mfma_f32_16x16x32_bf16 v[146:149], a[68:71], v[206:209], v[146:149]
    s_sub_u32 s50, s36, s27
    v_fma_f32 v254, v142, v142, s32
    v_fmac_f32 v254, v143, v143
    v_mfma_f32_16x16x32_bf16 v[194:197], v[186:189], a[144:147], 0
    s_mov_b32 s51, 0x00020000
    v_fmac_f32 v254, v144, v144
    v_fmac_f32 v254, v145, v145
    v_mfma_f32_16x16x32_bf16 v[194:197], v[118:121], a[148:151], v[194:197]
    s_waitcnt lgkmcnt(0)
    v_fmac_f32 v254, v126, v126
    v_fmac_f32 v254, v127, v127
    v_mfma_f32_16x16x32_bf16 v[198:201], v[32:35], v[178:181], 0
    s_add_u32 s52, s40, s26
    v_fmac_f32 v254, v128, v128
    v_fmac_f32 v254, v129, v129
    v_mfma_f32_16x16x32_bf16 v[198:201], v[32:35], v[190:193], v[198:201]
    s_addc_u32 s53, s41, 0
    v_fmac_f32 v254, v146, v146
    v_fmac_f32 v254, v147, v147
    v_mfma_f32_16x16x32_bf16 v[194:197], v[234:237], a[152:155], v[194:197]
    s_sub_u32 s54, s36, s26
    v_fmac_f32 v254, v148, v148
    v_fmac_f32 v254, v149, v149
    v_mfma_f32_16x16x32_bf16 v[194:197], v[158:161], a[156:159], v[194:197]
    s_mov_b32 s55, 0x00020000
    v_mul_f32 v199, 0x3baaaaab, v199
    v_mul_f32 v255, 0x3baaaaab, v198
    v_mfma_f32_16x16x32_bf16 v[194:197], v[182:185], a[160:163], v[194:197]
    s_add_u32 s56, s40, s25
    v_rsq_f32 v199, v199
    v_mfma_f32_16x16x32_bf16 v[194:197], v[206:209], a[164:167], v[194:197]
    s_addc_u32 s57, s41, 0
    v_mul_f32 v114, v199, v114
    v_mul_f32 v115, v199, v115
    v_mfma_f32_16x16x32_bf16 v[190:193], v[186:189], a[168:171], 0
    s_sub_u32 s58, s36, s25
    v_cvt_pk_bf16_f32 v178, v114, v115
    v_mul_f32 v116, v199, v116
    v_mfma_f32_16x16x32_bf16 v[190:193], v[118:121], a[172:175], v[190:193]
    s_mov_b32 s59, 0x00020000
    v_mul_f32 v117, v199, v117
    v_cvt_pk_bf16_f32 v179, v116, v117
    v_mfma_f32_16x16x32_bf16 v[190:193], v[234:237], a[176:179], v[190:193]
    s_and_b32 s6, s2, 7
    v_mul_f32 v166, v199, v166
    v_mul_f32 v167, v199, v167
    v_mfma_f32_16x16x32_bf16 v[190:193], v[158:161], a[180:183], v[190:193]
    s_sub_u32 s6, 0, s6
    v_cvt_pk_bf16_f32 v180, v166, v167
    v_mul_f32 v168, v199, v168
    v_mfma_f32_16x16x32_bf16 v[190:193], v[182:185], a[184:187], v[190:193]
    s_lshl_b32 s3, s16, 6
    ds_read_b128 v[114:117], v0 offset:26624
    v_mul_f32 v169, v199, v169
    v_mfma_f32_16x16x32_bf16 v[190:193], v[206:209], a[188:191], v[190:193]
    s_lshl_b32 s4, s16, 5
    ds_read_b128 v[210:213], v1 offset:26624
    v_cvt_pk_bf16_f32 v181, v168, v169
    v_mfma_f32_16x16x32_bf16 v[166:169], v[186:189], a[192:195], 0
    s_add_u32 s4, s4, 256
    ds_read_b128 v[186:189], v0 offset:26752
    buffer_store_dwordx4 v[178:181], v16, s[48:51], 0 offen nt
    v_mul_f32 v230, v199, v230
    v_mul_f32 v231, v199, v231
    v_cvt_pk_bf16_f32 v198, v230, v231
    v_mul_f32 v232, v199, v232
    v_mfma_f32_16x16x32_bf16 v[166:169], v[118:121], a[196:199], v[166:169]
    s_mul_i32 s5, s16, 9408
    ds_read_b128 v[118:121], v1 offset:26752
    v_mul_f32 v233, v199, v233
    v_mfma_f32_16x16x32_bf16 v[166:169], v[234:237], a[200:203], v[166:169]
    s_add_u32 s5, s5, 104448
    ds_read_b128 v[234:237], v0 offset:26880
    v_cvt_pk_bf16_f32 v199, v232, v233
    v_mfma_f32_16x16x32_bf16 v[166:169], v[158:161], a[204:207], v[166:169]
    ds_read_b128 v[158:161], v1 offset:26880
    v_cvt_pk_bf16_f32 v36, v254, v174
    v_mfma_f32_16x16x32_bf16 v[166:169], v[182:185], a[208:211], v[166:169]
    s_waitcnt lgkmcnt(5)
    v_rsq_f32 v255, v255
    v_mfma_f32_16x16x32_bf16 v[182:185], v[32:35], v[36:39], 0
    s_waitcnt lgkmcnt(4)
    v_mul_f32 v122, v255, v122
    v_mul_f32 v123, v255, v123
    v_mfma_f32_16x16x32_bf16 v[166:169], v[206:209], a[212:215], v[166:169]
    s_waitcnt lgkmcnt(3)
    v_cvt_pk_bf16_f32 v122, v122, v123
    v_mul_f32 v124, v255, v124
    v_mfma_f32_16x16x32_bf16 v[206:209], a[72:75], v[114:117], 0
    v_mul_f32 v125, v255, v125
    v_cvt_pk_bf16_f32 v123, v124, v125
    v_mfma_f32_16x16x32_bf16 v[206:209], a[76:79], v[210:213], v[206:209]
    s_waitcnt lgkmcnt(2)
    v_mul_f32 v154, v255, v154
    v_mul_f32 v155, v255, v155
    v_mfma_f32_16x16x32_bf16 v[206:209], a[80:83], v[186:189], v[206:209]
    s_waitcnt lgkmcnt(1)
    ds_read_b128 v[214:217], v2 offset:0
    ds_read_b128 v[230:233], v2 offset:1024
    v_mfma_f32_16x16x32_bf16 v[206:209], a[84:87], v[118:121], v[206:209]
    s_waitcnt lgkmcnt(2)
    ds_read_b128 v[222:225], v2 offset:2048
    ds_read_b128 v[174:177], v2 offset:3072
    v_mfma_f32_16x16x32_bf16 v[206:209], a[88:91], v[234:237], v[206:209]
    v_cvt_pk_bf16_f32 v124, v154, v155
    v_mul_f32 v156, v255, v156
    v_mfma_f32_16x16x32_bf16 v[206:209], a[92:95], v[158:161], v[206:209]
    ds_read_b128 v[178:181], v2 offset:4096
    ds_read_b128 v[226:229], v2 offset:5120
    v_mfma_f32_16x16x32_bf16 v[218:221], a[96:99], v[114:117], 0
    v_mul_f32 v157, v255, v157
    v_cvt_pk_bf16_f32 v125, v156, v157
    v_mfma_f32_16x16x32_bf16 v[218:221], a[100:103], v[210:213], v[218:221]
    v_mul_f32 v202, v255, v202
    v_mul_f32 v203, v255, v203
    v_mfma_f32_16x16x32_bf16 v[218:221], a[104:107], v[186:189], v[218:221]
    v_cvt_pk_bf16_f32 v254, v202, v203
    v_mul_f32 v204, v255, v204
    v_mfma_f32_16x16x32_bf16 v[218:221], a[108:111], v[118:121], v[218:221]
    s_waitcnt lgkmcnt(4)
    buffer_store_dwordx2 v[198:199], v19, s[48:51], 0 offen nt
    v_mul_f32 v205, v255, v205
    v_cvt_pk_bf16_f32 v255, v204, v205
    v_mfma_f32_16x16x32_bf16 v[202:205], a[216:219], v[214:217], 0
    s_waitcnt lgkmcnt(2)
    v_rsq_f32 v183, v183
    v_mfma_f32_16x16x32_bf16 v[202:205], a[220:223], v[230:233], v[202:205]
    v_rsq_f32 v182, v182
    v_mfma_f32_16x16x32_bf16 v[202:205], a[224:227], v[222:225], v[202:205]
    s_waitcnt lgkmcnt(0)
    v_mul_f32 v182, s31, v182
    v_cvt_pk_bf16_f32 v194, v194, v195
    v_mfma_f32_16x16x32_bf16 v[202:205], a[228:231], v[174:177], v[202:205]
    v_cvt_pk_bf16_f32 v195, v196, v197
    v_cvt_pk_bf16_f32 v190, v190, v191
    v_mfma_f32_16x16x32_bf16 v[202:205], a[232:235], v[178:181], v[202:205]
    v_cvt_pk_bf16_f32 v191, v192, v193
    v_cvt_pk_bf16_f32 v166, v166, v167
    v_mfma_f32_16x16x32_bf16 v[202:205], a[236:239], v[226:229], v[202:205]
    v_cvt_pk_bf16_f32 v167, v168, v169
    v_mul_f32 v130, v183, v130
    v_mfma_f32_16x16x32_bf16 v[154:157], a[240:243], v[214:217], 0
    v_mul_f32 v131, v183, v131
    v_cvt_pk_f16_f32 v130, v130, v131
    v_mfma_f32_16x16x32_bf16 v[154:157], a[244:247], v[230:233], v[154:157]
    v_mul_f32 v132, v183, v132
    v_mul_f32 v133, v183, v133
    v_mfma_f32_16x16x32_bf16 v[154:157], a[248:251], v[222:225], v[154:157]
    v_fma_f32 v168, v202, v202, s33
    v_fmac_f32 v168, v203, v203
    v_mfma_f32_16x16x32_bf16 v[154:157], a[252:255], v[174:177], v[154:157]
    v_fmac_f32 v168, v204, v204
    v_fmac_f32 v168, v205, v205
    v_mfma_f32_16x16x32_bf16 v[154:157], v[82:85], v[178:181], v[154:157]
    v_cvt_pk_f16_f32 v131, v132, v133
    v_mul_f32 v134, v183, v134
    v_mfma_f32_16x16x32_bf16 v[154:157], v[86:89], v[226:229], v[154:157]
    v_mul_f32 v135, v183, v135
    v_cvt_pk_f16_f32 v132, v134, v135
    v_mfma_f32_16x16x32_bf16 v[238:241], v[90:93], v[214:217], 0
    ds_read_b128 v[214:217], v2 offset:6144
    v_mul_f32 v136, v183, v136
    v_mfma_f32_16x16x32_bf16 v[238:241], v[94:97], v[230:233], v[238:241]
    ds_read_b128 v[230:233], v2 offset:7168
    v_mul_f32 v137, v183, v137
    v_mfma_f32_16x16x32_bf16 v[238:241], v[98:101], v[222:225], v[238:241]
    ds_read_b128 v[222:225], v2 offset:8192
    v_fmac_f32 v168, v154, v154
    v_mfma_f32_16x16x32_bf16 v[238:241], v[102:105], v[174:177], v[238:241]
    ds_read_b128 v[174:177], v2 offset:9216
    buffer_store_dwordx4 v[122:125], v15, s[48:51], 0 offen nt
    v_fmac_f32 v168, v155, v155
    v_fmac_f32 v168, v156, v156
    v_fmac_f32 v168, v157, v157
    v_cvt_pk_f16_f32 v133, v136, v137
    v_mfma_f32_16x16x32_bf16 v[238:241], v[106:109], v[178:181], v[238:241]
    ds_read_b128 v[178:181], v2 offset:10240
    v_mul_f32 v170, v183, v170
    v_mfma_f32_16x16x32_bf16 v[238:241], v[110:113], v[226:229], v[238:241]
    ds_read_b128 v[134:137], v2 offset:11264
    v_mul_f32 v171, v183, v171
    v_mfma_f32_16x16x32_bf16 v[218:221], a[112:115], v[234:237], v[218:221]
    s_waitcnt lgkmcnt(5)
    v_cvt_pk_f16_f32 v124, v170, v171
    v_mul_f32 v172, v183, v172
    v_mfma_f32_16x16x32_bf16 v[226:229], a[216:219], v[214:217], 0
    s_waitcnt lgkmcnt(4)
    v_fmac_f32 v168, v238, v238
    v_fmac_f32 v168, v239, v239
    v_mfma_f32_16x16x32_bf16 v[226:229], a[220:223], v[230:233], v[226:229]
    s_waitcnt lgkmcnt(3)
    v_fmac_f32 v168, v240, v240
    v_fmac_f32 v168, v241, v241
    v_mfma_f32_16x16x32_bf16 v[226:229], a[224:227], v[222:225], v[226:229]
    s_waitcnt lgkmcnt(2)
    v_mul_f32 v173, v183, v173
    v_cvt_pk_f16_f32 v125, v172, v173
    v_mfma_f32_16x16x32_bf16 v[226:229], a[228:231], v[174:177], v[226:229]
    v_mul_f32 v142, v182, v142
    v_mul_f32 v143, v182, v143
    v_mfma_f32_16x16x32_bf16 v[170:173], a[240:243], v[214:217], 0
    s_waitcnt lgkmcnt(1)
    v_cvt_pk_f16_f32 v142, v142, v143
    v_mul_f32 v144, v182, v144
    v_mfma_f32_16x16x32_bf16 v[226:229], a[232:235], v[178:181], v[226:229]
    s_waitcnt lgkmcnt(0)
    v_mul_f32 v145, v182, v145
    v_cvt_pk_f16_f32 v143, v144, v145
    v_mfma_f32_16x16x32_bf16 v[226:229], a[236:239], v[134:137], v[226:229]
    v_mul_f32 v126, v182, v126
    v_mul_f32 v127, v182, v127
    v_mfma_f32_16x16x32_bf16 v[170:173], a[244:247], v[230:233], v[170:173]
    v_cvt_pk_f16_f32 v144, v126, v127
    v_mul_f32 v128, v182, v128
    v_mfma_f32_16x16x32_bf16 v[170:173], a[248:251], v[222:225], v[170:173]
    v_mul_f32 v129, v182, v129
    v_cvt_pk_f16_f32 v145, v128, v129
    v_mfma_f32_16x16x32_bf16 v[170:173], a[252:255], v[174:177], v[170:173]
    v_mul_f32 v146, v182, v146
    v_mul_f32 v147, v182, v147
    v_mfma_f32_16x16x32_bf16 v[170:173], v[82:85], v[178:181], v[170:173]
    v_cvt_pk_f16_f32 v122, v146, v147
    v_mul_f32 v148, v182, v148
    v_mfma_f32_16x16x32_bf16 v[170:173], v[86:89], v[134:137], v[170:173]
    v_mul_f32 v149, v182, v149
    v_cvt_pk_f16_f32 v123, v148, v149
    v_mfma_f32_16x16x32_bf16 v[146:149], v[90:93], v[214:217], 0
    buffer_store_dwordx2 v[254:255], v18, s[48:51], 0 offen nt
    v_mov_b32 v198, 0x40000000
    v_fma_f32 v169, v206, v206, s32
    v_mfma_f32_16x16x32_bf16 v[146:149], v[94:97], v[230:233], v[146:149]
    v_fmac_f32 v169, v207, v207
    v_fmac_f32 v169, v208, v208
    v_mfma_f32_16x16x32_bf16 v[146:149], v[98:101], v[222:225], v[146:149]
    v_fmac_f32 v169, v209, v209
    v_fma_f32 v192, v226, v226, s33
    v_mfma_f32_16x16x32_bf16 v[146:149], v[102:105], v[174:177], v[146:149]
    v_fmac_f32 v192, v227, v227
    v_fmac_f32 v192, v228, v228
    v_mfma_f32_16x16x32_bf16 v[146:149], v[106:109], v[178:181], v[146:149]
    v_fmac_f32 v192, v229, v229
    v_fmac_f32 v192, v170, v170
    v_mfma_f32_16x16x32_bf16 v[146:149], v[110:113], v[134:137], v[146:149]
    v_fmac_f32 v192, v171, v171
    v_fmac_f32 v192, v172, v172
    v_mfma_f32_16x16x32_bf16 v[218:221], a[116:119], v[158:161], v[218:221]
    v_fmac_f32 v192, v173, v173
    v_mul_f32 v193, 0x3baaaaab, v200
    v_mfma_f32_16x16x32_bf16 v[126:129], a[120:123], v[114:117], 0
    v_rsq_f32 v193, v193
    v_mfma_f32_16x16x32_bf16 v[126:129], a[124:127], v[210:213], v[126:129]
    v_fmac_f32 v192, v146, v146
    v_fmac_f32 v192, v147, v147
    v_mfma_f32_16x16x32_bf16 v[126:129], a[128:131], v[186:189], v[126:129]
    v_fmac_f32 v169, v218, v218
    v_fmac_f32 v169, v219, v219
    v_mfma_f32_16x16x32_bf16 v[126:129], a[132:135], v[118:121], v[126:129]
    v_fmac_f32 v169, v220, v220
    v_fmac_f32 v169, v221, v221
    v_mfma_f32_16x16x32_bf16 v[126:129], a[136:139], v[234:237], v[126:129]
    v_fmac_f32 v192, v148, v148
    v_fmac_f32 v192, v149, v149
    v_mfma_f32_16x16x32_bf16 v[126:129], a[140:143], v[158:161], v[126:129]
    v_cvt_pk_bf16_f32 v254, v168, v192
    v_cvt_pk_bf16_f32 v255, v192, v192
    v_mfma_f32_16x16x32_bf16 v[134:137], a[0:3], v[114:117], 0
    v_mul_f32 v150, v193, v150
    v_mul_f32 v151, v193, v151
    v_mfma_f32_16x16x32_bf16 v[134:137], a[4:7], v[210:213], v[134:137]
    v_cvt_pk_bf16_f32 v150, v150, v151
    v_mul_f32 v152, v193, v152
    v_mfma_f32_16x16x32_bf16 v[134:137], a[8:11], v[186:189], v[134:137]
    v_fmac_f32 v169, v126, v126
    v_fmac_f32 v169, v127, v127
    v_mfma_f32_16x16x32_bf16 v[134:137], a[12:15], v[118:121], v[134:137]
    v_fmac_f32 v169, v128, v128
    v_fmac_f32 v169, v129, v129
    v_mfma_f32_16x16x32_bf16 v[134:137], a[16:19], v[234:237], v[134:137]
    v_mul_f32 v153, v193, v153
    v_cvt_pk_bf16_f32 v151, v152, v153
    v_mfma_f32_16x16x32_bf16 v[134:137], a[20:23], v[158:161], v[134:137]
    v_mul_f32 v162, v193, v162
    v_mul_f32 v163, v193, v163
    v_mfma_f32_16x16x32_bf16 v[230:233], a[24:27], v[114:117], 0
    v_cvt_pk_bf16_f32 v152, v162, v163
    v_mul_f32 v164, v193, v164
    v_mfma_f32_16x16x32_bf16 v[230:233], a[28:31], v[210:213], v[230:233]
    v_mul_f32 v165, v193, v165
    v_cvt_pk_bf16_f32 v153, v164, v165
    v_mfma_f32_16x16x32_bf16 v[230:233], a[32:35], v[186:189], v[230:233]
    buffer_store_dwordx4 v[150:153], v17, s[48:51], 0 offen nt
    v_fma_f32 v168, v134, v134, s32
    v_fmac_f32 v168, v135, v135
    v_fmac_f32 v168, v136, v136
    v_fmac_f32 v168, v137, v137
    v_mfma_f32_16x16x32_bf16 v[230:233], a[36:39], v[118:121], v[230:233]
    v_mul_f32 v138, v193, v138
    v_mul_f32 v139, v193, v139
    v_mfma_f32_16x16x32_bf16 v[230:233], a[40:43], v[234:237], v[230:233]
    v_cvt_pk_bf16_f32 v196, v138, v139
    v_mul_f32 v140, v193, v140
    v_mfma_f32_16x16x32_bf16 v[230:233], a[44:47], v[158:161], v[230:233]
    v_mul_f32 v141, v193, v141
    v_cvt_pk_bf16_f32 v197, v140, v141
    v_mfma_f32_16x16x32_bf16 v[138:141], a[48:51], v[114:117], 0
    v_bfe_u32 v201, v2, 4, 6
    v_lshrrev_b32 v199, 4, v201
    v_mfma_f32_16x16x32_bf16 v[138:141], a[52:55], v[210:213], v[138:141]
    v_and_b32 v150, 15, v201
    v_add_u32 v192, 0, v150
    v_mfma_f32_16x16x32_bf16 v[138:141], a[56:59], v[186:189], v[138:141]
    v_mul_u32_u24 v200, s20, v192
    v_add_u32 v200, s38, v200
    v_mfma_f32_16x16x32_bf16 v[138:141], a[60:63], v[118:121], v[138:141]
    v_mul_u32_u24 v193, 911, v200
    v_lshrrev_b32 v193, 16, v193
    v_mfma_f32_16x16x32_bf16 v[138:141], a[64:67], v[234:237], v[138:141]
    v_mul_u32_u24 v193, s22, v193
    v_mad_u32_u24 v193, v192, s21, v193
    v_mfma_f32_16x16x32_bf16 v[138:141], a[68:71], v[158:161], v[138:141]
    v_bfe_u32 v200, s63, v192, 1
    v_cmp_ne_u32 vcc, 0, v200
    v_mfma_f32_16x16x32_bf16 v[162:165], v[114:117], a[144:147], 0
    v_add_u32 v200, s7, v193
    v_cndmask_b32 v200, v198, v200, vcc
    v_mfma_f32_16x16x32_bf16 v[162:165], v[210:213], a[148:151], v[162:165]
    v_lshl_add_u32 v151, v199, 4, v200
    v_add_u32 v151, s3, v151
    v_mfma_f32_16x16x32_bf16 v[162:165], v[186:189], a[152:155], v[162:165]
    v_lshl_add_u32 v200, v199, 3, v200
    v_add_u32 v200, s4, v200
    v_mfma_f32_16x16x32_bf16 v[162:165], v[118:121], a[156:159], v[162:165]
    v_fmac_f32 v168, v230, v230
    v_fmac_f32 v168, v231, v231
    v_mfma_f32_16x16x32_bf16 v[162:165], v[234:237], a[160:163], v[162:165]
    v_fmac_f32 v168, v232, v232
    v_fmac_f32 v168, v233, v233
    v_mfma_f32_16x16x32_bf16 v[162:165], v[158:161], a[164:167], v[162:165]
    v_fmac_f32 v168, v138, v138
    v_fmac_f32 v168, v139, v139
    v_mfma_f32_16x16x32_bf16 v[178:181], v[114:117], a[168:171], 0
    buffer_store_dwordx2 v[196:197], v20, s[48:51], 0 offen nt
    v_fmac_f32 v168, v140, v140
    v_fmac_f32 v168, v141, v141
    v_mfma_f32_16x16x32_bf16 v[178:181], v[210:213], a[172:175], v[178:181]
    v_cvt_pk_bf16_f32 v36, v168, v169
    v_cvt_pk_bf16_f32 v196, v162, v163
    v_mfma_f32_16x16x32_bf16 v[178:181], v[186:189], a[176:179], v[178:181]
    v_cvt_pk_bf16_f32 v197, v164, v165
    v_lshlrev_b32 v152, 9, v199
    v_mfma_f32_16x16x32_bf16 v[182:185], v[32:35], v[36:39], 0
    v_lshl_add_u32 v152, v150, 4, v152
    v_add_u32 v152, 149696, v152
    v_mfma_f32_16x16x32_bf16 v[178:181], v[118:121], a[180:183], v[178:181]
    v_and_b32 v153, 0xffff, v2
    v_add_u32 v153, 38912, v153
    v_mfma_f32_16x16x32_bf16 v[178:181], v[234:237], a[184:187], v[178:181]
    ds_read_b128 v[174:177], v0 offset:32768
    v_and_b32 v214, 0xffff, v4
    v_mfma_f32_16x16x32_bf16 v[178:181], v[158:161], a[188:191], v[178:181]
    ds_read_b128 v[162:165], v1 offset:32768
    v_add_u32 v214, 38912, v214
    v_mfma_f32_16x16x32_bf16 v[222:225], v[114:117], a[192:195], 0
    ds_read_b128 v[114:117], v0 offset:32896
    v_sub_u32 v215, 0x40800000, v44
    v_mfma_f32_16x16x32_bf16 v[222:225], v[210:213], a[196:199], v[222:225]
    ds_read_b128 v[210:213], v1 offset:32896
    v_or_b32 v215, v215, v44
    v_mfma_f32_16x16x32_bf16 v[222:225], v[186:189], a[200:203], v[222:225]
    ds_read_b128 v[186:189], v0 offset:33024
    v_cvt_pk_bf16_f32 v192, v178, v179
    v_mfma_f32_16x16x32_bf16 v[222:225], v[118:121], a[204:207], v[222:225]
    ds_read_b128 v[118:121], v1 offset:33024
    v_cvt_pk_bf16_f32 v193, v180, v181
    v_mfma_f32_16x16x32_bf16 v[222:225], v[234:237], a[208:211], v[222:225]
    ds_write_b64 v214, v[254:255] offset:0
    v_mfma_f32_16x16x32_bf16 v[222:225], v[158:161], a[212:215], v[222:225]
    s_waitcnt lgkmcnt(6)
    v_rsq_f32 v183, v183
    v_mfma_f32_16x16x32_bf16 v[158:161], a[72:75], v[174:177], 0
    s_waitcnt lgkmcnt(5)
    v_rsq_f32 v182, v182
    v_mfma_f32_16x16x32_bf16 v[158:161], a[76:79], v[162:165], v[158:161]
    s_waitcnt lgkmcnt(4)
    v_mul_f32 v182, s31, v182
    v_cvt_pk_bf16_f32 v168, v222, v223
    v_mfma_f32_16x16x32_bf16 v[158:161], a[80:83], v[114:117], v[158:161]
    s_waitcnt lgkmcnt(3)
    v_cvt_pk_bf16_f32 v169, v224, v225
    v_mul_f32 v206, v183, v206
    v_mfma_f32_16x16x32_bf16 v[158:161], a[84:87], v[210:213], v[158:161]
    s_waitcnt lgkmcnt(2)
    v_mul_f32 v207, v183, v207
    v_cvt_pk_f16_f32 v178, v206, v207
    v_mfma_f32_16x16x32_bf16 v[158:161], a[88:91], v[186:189], v[158:161]
    s_waitcnt lgkmcnt(1)
    v_mul_f32 v208, v183, v208
    v_mul_f32 v209, v183, v209
    v_mfma_f32_16x16x32_bf16 v[158:161], a[92:95], v[118:121], v[158:161]
    s_waitcnt lgkmcnt(0)
    v_cvt_pk_f16_f32 v179, v208, v209
    v_mul_f32 v218, v183, v218
    v_mfma_f32_16x16x32_bf16 v[206:209], a[96:99], v[174:177], 0
    s_barrier
    ds_read_b128 v[222:225], v153 offset:0
    ds_read_b128 v[234:237], v153 offset:1024
    v_mfma_f32_16x16x32_bf16 v[206:209], a[100:103], v[162:165], v[206:209]
    v_mul_f32 v219, v183, v219
    v_cvt_pk_f16_f32 v180, v218, v219
    v_mfma_f32_16x16x32_bf16 v[206:209], a[104:107], v[114:117], v[206:209]
    v_mul_f32 v220, v183, v220
    v_mul_f32 v221, v183, v221
    v_mfma_f32_16x16x32_bf16 v[206:209], a[108:111], v[210:213], v[206:209]
    v_cvt_pk_f16_f32 v181, v220, v221
    v_mul_f32 v126, v183, v126
    v_mfma_f32_16x16x32_bf16 v[206:209], a[112:115], v[186:189], v[206:209]
    v_mul_f32 v127, v183, v127
    v_cvt_pk_f16_f32 v220, v126, v127
    v_mfma_f32_16x16x32_bf16 v[206:209], a[116:119], v[118:121], v[206:209]
    v_mul_f32 v128, v183, v128
    v_mul_f32 v129, v183, v129
    v_mfma_f32_16x16x32_bf16 v[242:245], a[120:123], v[174:177], 0
    v_cvt_pk_f16_f32 v221, v128, v129
    v_mul_f32 v134, v182, v134
    v_mfma_f32_16x16x32_bf16 v[242:245], a[124:127], v[162:165], v[242:245]
    s_waitcnt lgkmcnt(0)
    v_mul_f32 v135, v182, v135
    v_cvt_pk_f16_f32 v134, v134, v135
    v_mfma_f32_16x16x32_bf16 v[126:129], v[32:35], v[222:225], 0
    v_mul_f32 v136, v182, v136
    v_mul_f32 v137, v182, v137
    v_mfma_f32_16x16x32_bf16 v[126:129], v[32:35], v[234:237], v[126:129]
    v_cvt_pk_f16_f32 v135, v136, v137
    v_mul_f32 v230, v182, v230
    v_mfma_f32_16x16x32_bf16 v[242:245], a[128:131], v[114:117], v[242:245]
    v_mul_f32 v231, v182, v231
    v_cvt_pk_f16_f32 v136, v230, v231
    v_mfma_f32_16x16x32_bf16 v[242:245], a[132:135], v[210:213], v[242:245]
    v_mul_f32 v232, v182, v232
    v_mul_f32 v233, v182, v233
    v_mfma_f32_16x16x32_bf16 v[242:245], a[136:139], v[186:189], v[242:245]
    v_mul_f32 v137, 0x3baaaaab, v127
    v_mul_f32 v216, 0x3baaaaab, v126
    v_mfma_f32_16x16x32_bf16 v[242:245], a[140:143], v[118:121], v[242:245]
    v_rsq_f32 v137, v137
    v_mfma_f32_16x16x32_bf16 v[234:237], a[0:3], v[174:177], 0
    v_mul_f32 v226, v137, v226
    v_mul_f32 v227, v137, v227
    v_mfma_f32_16x16x32_bf16 v[234:237], a[4:7], v[162:165], v[234:237]
    v_cvt_pk_bf16_f32 v126, v226, v227
    v_mul_f32 v228, v137, v228
    v_mfma_f32_16x16x32_bf16 v[234:237], a[8:11], v[114:117], v[234:237]
    v_mul_f32 v229, v137, v229
    v_cvt_pk_bf16_f32 v127, v228, v229
    v_mfma_f32_16x16x32_bf16 v[234:237], a[12:15], v[210:213], v[234:237]
    v_mul_f32 v170, v137, v170
    v_mul_f32 v171, v137, v171
    v_mfma_f32_16x16x32_bf16 v[234:237], a[16:19], v[186:189], v[234:237]
    v_cvt_pk_bf16_f32 v128, v170, v171
    v_mul_f32 v172, v137, v172
    v_mfma_f32_16x16x32_bf16 v[234:237], a[20:23], v[118:121], v[234:237]
    v_mul_f32 v173, v137, v173
    v_cvt_pk_bf16_f32 v129, v172, v173
    v_mfma_f32_16x16x32_bf16 v[170:173], a[24:27], v[174:177], 0
    buffer_store_dwordx4 v[126:129], v16, s[52:55], 0 offen nt
    v_mul_f32 v146, v137, v146
    v_mul_f32 v147, v137, v147
    v_cvt_pk_bf16_f32 v254, v146, v147
    v_mul_f32 v148, v137, v148
    v_mfma_f32_16x16x32_bf16 v[170:173], a[28:31], v[162:165], v[170:173]
    v_mul_f32 v149, v137, v149
    v_cvt_pk_bf16_f32 v255, v148, v149
    v_mfma_f32_16x16x32_bf16 v[170:173], a[32:35], v[114:117], v[170:173]
    v_rsq_f32 v216, v216
    v_mfma_f32_16x16x32_f16 v[146:149], v[130:133], v[142:145], v[46:49]
    v_mul_f32 v202, v216, v202
    v_mul_f32 v203, v216, v203
    v_mfma_f32_16x16x32_f16 v[126:129], v[178:181], v[142:145], v[50:53]
    v_cvt_pk_bf16_f32 v202, v202, v203
    v_mul_f32 v204, v216, v204
    v_mfma_f32_16x16x32_bf16 v[170:173], a[36:39], v[210:213], v[170:173]
    v_mul_f32 v205, v216, v205
    v_cvt_pk_bf16_f32 v203, v204, v205
    v_mul_f32 v154, v216, v154
    v_mfma_f32_16x16x16_f16 v[146:149], v[124:125], v[122:123], v[146:149]
    v_mul_f32 v155, v216, v155
    v_cvt_pk_bf16_f32 v204, v154, v155
    v_mul_f32 v156, v216, v156
    v_mfma_f32_16x16x16_f16 v[126:129], v[220:221], v[122:123], v[126:129]
    v_mul_f32 v157, v216, v157
    v_cvt_pk_bf16_f32 v205, v156, v157
    v_mul_f32 v238, v216, v238
    v_mul_f32 v239, v216, v239
    v_mfma_f32_16x16x32_bf16 v[170:173], a[40:43], v[186:189], v[170:173]
    v_cvt_pk_bf16_f32 v184, v238, v239
    v_mul_f32 v240, v216, v240
    v_mfma_f32_16x16x32_bf16 v[170:173], a[44:47], v[118:121], v[170:173]
    v_mul_f32 v241, v216, v241
    v_cvt_pk_bf16_f32 v185, v240, v241
    v_mfma_f32_16x16x32_bf16 v[154:157], a[48:51], v[174:177], 0
    v_cvt_pk_f16_f32 v137, v232, v233
    v_mul_f32 v138, v182, v138
    v_mfma_f32_16x16x32_bf16 v[154:157], a[52:55], v[162:165], v[154:157]
    v_mul_f32 v139, v182, v139
    v_cvt_pk_f16_f32 v218, v138, v139
    v_mfma_f32_16x16x32_bf16 v[154:157], a[56:59], v[114:117], v[154:157]
    v_mul_f32 v140, v182, v140
    v_mul_f32 v141, v182, v141
    v_mfma_f32_16x16x32_bf16 v[154:157], a[60:63], v[210:213], v[154:157]
    v_cvt_pk_f16_f32 v219, v140, v141
    v_fma_f32 v183, v234, v234, s32
    v_mfma_f32_16x16x32_bf16 v[154:157], a[64:67], v[186:189], v[154:157]
    v_fmac_f32 v183, v235, v235
    v_fmac_f32 v183, v236, v236
    v_mfma_f32_16x16x32_bf16 v[154:157], a[68:71], v[118:121], v[154:157]
    buffer_store_dwordx2 v[254:255], v19, s[52:55], 0 offen nt
    v_fmac_f32 v183, v237, v237
    v_fmac_f32 v183, v170, v170
    v_mfma_f32_16x16x32_bf16 v[138:141], v[174:177], a[144:147], 0
    v_fmac_f32 v183, v171, v171
    v_fmac_f32 v183, v172, v172
    v_mfma_f32_16x16x32_bf16 v[138:141], v[162:165], a[148:151], v[138:141]
    v_fmac_f32 v183, v173, v173
    v_fmac_f32 v183, v154, v154
    v_mfma_f32_16x16x32_bf16 v[138:141], v[114:117], a[152:155], v[138:141]
    v_fmac_f32 v183, v155, v155
    v_fmac_f32 v183, v156, v156
    v_mfma_f32_16x16x32_bf16 v[138:141], v[210:213], a[156:159], v[138:141]
    v_fmac_f32 v183, v157, v157
    v_fma_f32 v182, v158, v158, s32
    v_mfma_f32_16x16x32_bf16 v[138:141], v[186:189], a[160:163], v[138:141]
    v_fmac_f32 v182, v159, v159
    v_fmac_f32 v182, v160, v160
    v_mfma_f32_16x16x32_bf16 v[138:141], v[118:121], a[164:167], v[138:141]
    v_fmac_f32 v182, v161, v161
    v_fmac_f32 v182, v206, v206
    v_mfma_f32_16x16x32_bf16 v[230:233], v[174:177], a[168:171], 0
    v_fmac_f32 v182, v207, v207
    v_fmac_f32 v182, v208, v208
    v_mfma_f32_16x16x32_bf16 v[230:233], v[162:165], a[172:175], v[230:233]
    ds_read_b128 v[226:229], v5 offset:0
    ds_read_b128 v[238:241], v5 offset:16
    v_mfma_f32_16x16x32_bf16 v[230:233], v[114:117], a[176:179], v[230:233]
    ds_read_b32 v254, v6 offset:192
    v_cvt_pk_bf16_f32 v138, v138, v139
    v_mfma_f32_16x16x32_bf16 v[230:233], v[210:213], a[180:183], v[230:233]
    v_cvt_pk_bf16_f32 v139, v140, v141
    v_fmac_f32 v182, v209, v209
    v_mfma_f32_16x16x32_bf16 v[230:233], v[186:189], a[184:187], v[230:233]
    v_fmac_f32 v182, v242, v242
    v_fmac_f32 v182, v243, v243
    v_mfma_f32_16x16x32_bf16 v[230:233], v[118:121], a[188:191], v[230:233]
    v_fmac_f32 v182, v244, v244
    v_fmac_f32 v182, v245, v245
    v_cvt_pk_bf16_f32 v36, v183, v182
    v_add_u32 v182, 16, v150
    v_min_u32 v183, 20, v182
    v_add_u32 v141, 12, v182
    v_lshrrev_b32 v141, 5, v141
    v_sub_u32 v140, v182, v183
    v_cvt_pk_bf16_f32 v230, v230, v231
    v_cvt_pk_bf16_f32 v231, v232, v233
    v_mad_i32_i24 v140, v141, s6, v140
    v_mul_u32_u24 v255, s20, v183
    v_add3_u32 v255, v255, v140, s38
    buffer_store_dwordx4 v[202:205], v15, s[52:55], 0 offen nt
    ds_read_b128 v[222:225], v2 offset:12288
    v_mul_u32_u24 v141, 911, v255
    v_lshrrev_b32 v141, 16, v141
    v_mul_u32_u24 v141, s22, v141
    v_mad_u32_u24 v141, v183, s21, v141
    v_bfe_u32 v255, s63, v182, 1
    v_cmp_ne_u32 vcc, 0, v255
    v_mul_i32_i24 v140, 2688, v140
    v_add3_u32 v255, v141, v140, s7
    v_mfma_f32_16x16x32_bf16 v[202:205], v[32:35], v[36:39], 0
    v_cndmask_b32 v255, v198, v255, vcc
    v_lshl_add_u32 v217, v199, 4, v255
    v_add_u32 v217, s3, v217
    v_lshl_add_u32 v216, v199, 3, v255
    v_add_u32 v216, s4, v216
    v_xor_b32 v255, 65536, v2
    v_lshl_add_u32 v198, s16, 2, v255
    ds_write_b32 v198, v215 offset:18432
    v_rsq_f32 v203, v203
    v_rsq_f32 v202, v202
    v_mul_f32 v158, v203, v158
    v_mul_f32 v202, s31, v202
    v_mul_f32 v159, v203, v159
    v_cvt_pk_f16_f32 v246, v158, v159
    v_mul_f32 v160, v203, v160
    v_mul_f32 v161, v203, v161
    v_cvt_pk_f16_f32 v247, v160, v161
    v_mfma_f32_16x16x32_bf16 v[250:253], v[174:177], a[192:195], 0
    s_waitcnt lgkmcnt(1)
    ds_read_b128 v[174:177], v2 offset:13312
    v_mul_f32 v206, v203, v206
    v_mfma_f32_16x16x32_bf16 v[250:253], v[162:165], a[196:199], v[250:253]
    ds_read_b128 v[158:161], v2 offset:14336
    v_mul_f32 v207, v203, v207
    v_mfma_f32_16x16x32_bf16 v[250:253], v[114:117], a[200:203], v[250:253]
    ds_read_b128 v[162:165], v2 offset:15360
    v_cvt_pk_f16_f32 v248, v206, v207
    v_mfma_f32_16x16x32_bf16 v[250:253], v[210:213], a[204:207], v[250:253]
    ds_read_b128 v[114:117], v2 offset:16384
    v_mul_f32 v208, v203, v208
    v_mfma_f32_16x16x32_bf16 v[250:253], v[186:189], a[208:211], v[250:253]
    ds_read_b128 v[210:213], v2 offset:17408
    v_mul_f32 v209, v203, v209
    v_mfma_f32_16x16x32_bf16 v[250:253], v[118:121], a[212:215], v[250:253]
    ds_read_b128 v[118:121], v5 offset:48
    v_cvt_pk_f16_f32 v249, v208, v209
    ds_read2_b32 v[140:141], v6 offset0:0 offset1:0
    v_mul_f32 v242, v203, v242
    buffer_store_dwordx2 v[184:185], v18, s[52:55], 0 offen nt
    ds_read2_b32 v[232:233], v6 offset0:16 offset1:16
    v_mul_f32 v243, v203, v243
    v_cvt_pk_f16_f32 v208, v242, v243
    v_cvt_pk_bf16_f32 v186, v250, v251
    ds_read2_b32 v[188:189], v6 offset0:32 offset1:32
    v_cvt_pk_bf16_f32 v187, v252, v253
    v_mul_f32 v244, v203, v244
    v_mul_f32 v245, v203, v245
    v_cvt_pk_f16_f32 v209, v244, v245
    v_mul_f32 v234, v202, v234
    v_mul_f32 v235, v202, v235
    v_cvt_pk_f16_f32 v242, v234, v235
    v_mfma_f32_16x16x32_f16 v[182:185], v[226:229], v[142:145], v[22:25]
    s_waitcnt lgkmcnt(4)
    v_mul_f32 v236, v202, v236
    v_mul_f32 v237, v202, v237
    v_mfma_f32_16x16x32_f16 v[182:185], v[238:241], v[130:133], v[182:185]
    s_waitcnt lgkmcnt(3)
    v_cvt_pk_f16_f32 v243, v236, v237
    v_mul_f32 v170, v202, v170
    v_mfma_f32_16x16x32_f16 v[182:185], v[118:121], v[122:125], v[182:185]
    v_mul_f32 v171, v202, v171
    v_cvt_pk_f16_f32 v244, v170, v171
    v_mfma_f32_16x16x32_f16 v[234:237], v[226:229], v[134:137], v[24:27]
    s_waitcnt lgkmcnt(1)
    v_mul_f32 v172, v202, v172
    v_mul_f32 v173, v202, v173
    v_mfma_f32_16x16x32_f16 v[234:237], v[238:241], v[178:181], v[234:237]
    s_waitcnt lgkmcnt(0)
    v_mov_b32_dpp v254, v183 quad_perm:[0,1,2,3] row_mask:0x1 bank_mask:0xf
    v_cvt_pk_f16_f32 v245, v172, v173
    v_mfma_f32_16x16x32_f16 v[234:237], v[118:121], v[218:221], v[234:237]
    v_mul_f32 v154, v202, v154
    v_mul_f32 v155, v202, v155
    v_mfma_f32_16x16x32_f16 v[170:173], v[246:249], v[142:145], v[54:57]
    v_cvt_pk_f16_f32 v206, v154, v155
    v_mul_f32 v156, v202, v156
    v_mfma_f32_16x16x32_f16 v[142:145], v[226:229], v[242:245], v[26:29]
    v_mul_f32 v157, v202, v157
    v_cvt_pk_f16_f32 v207, v156, v157
    v_mfma_f32_16x16x32_f16 v[142:145], v[238:241], v[246:249], v[142:145]
    v_mov_b32_dpp v254, v235 quad_perm:[0,1,2,3] row_mask:0x2 bank_mask:0xf
    v_max3_f32 v198, v182, v146, v147
    v_max3_f32 v198, v198, v148, v149
    v_mfma_f32_16x16x16_f16 v[170:173], v[208:209], v[122:123], v[170:173]
    v_max3_f32 v198, v198, v126, v127
    v_max3_f32 v198, v198, v128, v129
    v_bfe_u32 v215, v150, 1, 2
    v_xor_b32 v215, v215, v199
    v_mfma_f32_16x16x32_f16 v[142:145], v[118:121], v[206:209], v[142:145]
    v_lshl_add_u32 v215, v150, 2, v215
    v_lshl_add_u32 v199, v215, 4, s5
    v_mfma_f32_16x16x32_bf16 v[118:121], a[216:219], v[222:225], 0
    v_max3_f32 v198, v198, v170, v171
    v_max3_f32 v198, v198, v172, v173
    v_mfma_f32_16x16x32_bf16 v[118:121], a[220:223], v[174:177], v[118:121]
    v_mov_b32 v150, v198
    v_lshl_add_u32 v123, v215, 3, s5
    v_mfma_f32_16x16x32_bf16 v[118:121], a[224:227], v[158:161], v[118:121]
    v_permlane32_swap_b32 v198, v150
    v_mfma_f32_16x16x32_bf16 v[118:121], a[228:231], v[162:165], v[118:121]
    v_max_f32 v198, v198, v150
    v_mov_b32 v150, v198
    v_mfma_f32_16x16x32_bf16 v[118:121], a[232:235], v[114:117], v[118:121]
    v_mov_b32_dpp v254, v143 quad_perm:[0,1,2,3] row_mask:0x4 bank_mask:0xf
    v_mov_b32 v122, v254
    v_mfma_f32_16x16x32_bf16 v[118:121], a[236:239], v[210:213], v[118:121]
    v_permlane16_swap_b32 v198, v150
    v_mfma_f32_16x16x32_bf16 v[154:157], a[240:243], v[222:225], 0
    v_max_f32_dpp v122, v122, v122 quad_perm:[1,0,3,2] row_mask:0xf bank_mask:0xf
    v_max_f32 v198, v198, v150
    v_mfma_f32_16x16x32_bf16 v[154:157], a[244:247], v[174:177], v[154:157]
    v_max_f32_dpp v122, v122, v122 quad_perm:[2,3,0,1] row_mask:0xf bank_mask:0xf
    v_sub_f32 v146, v146, v198
    v_mfma_f32_16x16x32_bf16 v[154:157], a[248:251], v[158:161], v[154:157]
    v_max_f32_dpp v122, v122, v122 row_half_mirror row_mask:0xf bank_mask:0xf
    v_sub_f32 v147, v147, v198
    v_mfma_f32_16x16x32_bf16 v[154:157], a[252:255], v[162:165], v[154:157]
    v_max_f32_dpp v122, v122, v122 row_mirror row_mask:0xf bank_mask:0xf
    v_mov_b32 v150, v122
    v_mfma_f32_16x16x32_bf16 v[154:157], v[82:85], v[114:117], v[154:157]
    v_exp_f32 v146, v146
    v_mfma_f32_16x16x32_bf16 v[154:157], v[86:89], v[210:213], v[154:157]
    v_permlane32_swap_b32 v122, v150
    v_mfma_f32_16x16x32_bf16 v[202:205], v[90:93], v[222:225], 0
    ds_read_b128 v[238:241], v152 offset:0
    v_max_f32 v122, v122, v150
    v_mfma_f32_16x16x32_bf16 v[202:205], v[94:97], v[174:177], v[202:205]
    ds_read_b128 v[226:229], v152 offset:2048
    v_mov_b32 v150, v122
    v_mfma_f32_16x16x32_bf16 v[202:205], v[98:101], v[158:161], v[202:205]
    ds_read_b128 v[174:177], v152 offset:4096
    v_sub_f32 v148, v148, v198
    v_mfma_f32_16x16x32_bf16 v[202:205], v[102:105], v[162:165], v[202:205]
    ds_read_b128 v[222:225], v152 offset:6144
    v_sub_f32 v149, v149, v198
    v_mfma_f32_16x16x32_bf16 v[202:205], v[106:109], v[114:117], v[202:205]
    ds_read_b128 v[162:165], v152 offset:8192
    v_sub_f32 v126, v126, v198
    v_mfma_f32_16x16x32_bf16 v[202:205], v[110:113], v[210:213], v[202:205]
    ds_read_b128 v[158:161], v152 offset:10240
    v_permlane16_swap_b32 v122, v150
    v_max_f32 v122, v122, v150
    v_sub_f32 v254, v254, v122
    s_waitcnt lgkmcnt(5)
    v_mfma_f32_16x16x32_bf16 v[114:117], a[216:219], v[238:241], 0
    v_exp_f32 v254, v254
    s_waitcnt lgkmcnt(4)
    v_mfma_f32_16x16x32_bf16 v[114:117], a[220:223], v[226:229], v[114:117]
    v_cvt_pk_bf16_f32 v254, v254, v254
    s_waitcnt lgkmcnt(3)
    v_mfma_f32_16x16x32_bf16 v[114:117], a[224:227], v[174:177], v[114:117]
    ds_write_b16 v8, v254
    v_mfma_f32_16x16x32_bf16 v[210:213], a[240:243], v[238:241], 0
    s_waitcnt lgkmcnt(3)
    v_exp_f32 v147, v147
    v_mfma_f32_16x16x32_bf16 v[114:117], a[228:231], v[222:225], v[114:117]
    s_waitcnt lgkmcnt(2)
    v_cvt_pk_bf16_f32 v146, v146, v147
    v_sub_f32 v127, v127, v198
    v_mfma_f32_16x16x32_bf16 v[114:117], a[232:235], v[162:165], v[114:117]
    s_waitcnt lgkmcnt(1)
    v_exp_f32 v148, v148
    v_mfma_f32_16x16x32_bf16 v[114:117], a[236:239], v[158:161], v[114:117]
    v_exp_f32 v149, v149
    v_mfma_f32_16x16x32_bf16 v[210:213], a[244:247], v[226:229], v[210:213]
    v_cvt_pk_bf16_f32 v147, v148, v149
    v_sub_f32 v128, v128, v198
    v_mfma_f32_16x16x32_bf16 v[210:213], a[248:251], v[174:177], v[210:213]
    v_exp_f32 v126, v126
    v_mfma_f32_16x16x32_bf16 v[210:213], a[252:255], v[222:225], v[210:213]
    v_exp_f32 v127, v127
    v_mfma_f32_16x16x32_bf16 v[210:213], v[82:85], v[162:165], v[210:213]
    v_fma_f32 v150, v114, v114, s33
    v_fmac_f32 v150, v115, v115
    v_mfma_f32_16x16x32_bf16 v[210:213], v[86:89], v[158:161], v[210:213]
    v_fmac_f32 v150, v116, v116
    v_fmac_f32 v150, v117, v117
    v_cvt_pk_bf16_f32 v148, v126, v127
    v_exp_f32 v128, v128
    v_sub_f32 v129, v129, v198
    v_exp_f32 v129, v129
    v_sub_f32 v170, v170, v198
    v_cvt_pk_bf16_f32 v149, v128, v129
    v_fmac_f32 v150, v210, v210
    v_fmac_f32 v150, v211, v211
    v_fmac_f32 v150, v212, v212
    v_fmac_f32 v150, v213, v213
    v_exp_f32 v170, v170
    v_sub_f32 v171, v171, v198
    v_exp_f32 v171, v171
    v_sub_f32 v172, v172, v198
    v_cvt_pk_bf16_f32 v36, v170, v171
    v_mfma_f32_16x16x32_f16 v[126:129], v[130:133], v[134:137], v[58:61]
    v_exp_f32 v172, v172
    v_sub_f32 v173, v173, v198
    v_exp_f32 v173, v173
    v_sub_f32 v182, v182, v198
    v_cvt_pk_bf16_f32 v37, v172, v173
    v_mfma_f32_16x16x32_f16 v[170:173], v[178:181], v[134:137], v[62:65]
    v_exp_f32 v182, v182
    v_fma_f32 v254, v118, v118, s33
    v_mfma_f32_16x16x16_f16 v[126:129], v[124:125], v[218:219], v[126:129]
    v_cvt_pk_bf16_f32 v39, v182, 0
    v_fmac_f32 v254, v119, v119
    v_fmac_f32 v254, v120, v120
    v_mfma_f32_16x16x16_f16 v[170:173], v[220:221], v[218:219], v[170:173]
    v_fmac_f32 v254, v121, v121
    v_fmac_f32 v254, v154, v154
    v_fmac_f32 v254, v155, v155
    v_fmac_f32 v254, v156, v156
    v_fmac_f32 v254, v157, v157
    v_fmac_f32 v254, v202, v202
    v_fmac_f32 v254, v203, v203
    v_fmac_f32 v254, v204, v204
    v_fmac_f32 v254, v205, v205
    v_max3_f32 v144, v234, v126, v127
    v_max3_f32 v144, v144, v128, v129
    v_max3_f32 v144, v144, v170, v171
    v_max3_f32 v144, v144, v172, v173
    v_lshl_add_u32 v145, v201, 4, s5
    v_lshl_add_u32 v122, v201, 3, s5
    v_lshlrev_b32 v215, 2, v215
    ds_permute_b32 v198, v215, v16
    ds_permute_b32 v235, v215, v19
    ds_permute_b32 v143, v215, v17
    ds_permute_b32 v201, v215, v20
    v_mfma_f32_16x16x32_f16 v[182:185], v[246:249], v[134:137], v[66:69]
    s_nop 0
    s_nop 0
    s_nop 0
    s_nop 0
    s_nop 0
    s_nop 0
    v_mfma_f32_16x16x16_f16 v[182:185], v[208:209], v[218:219], v[182:185]
    s_nop 0
    s_nop 0
    s_nop 0
    s_nop 0
    s_nop 0
    s_nop 0
    s_nop 0
    s_nop 0
    v_max3_f32 v144, v144, v182, v183
    v_max3_f32 v144, v144, v184, v185
    v_mov_b32 v215, v144
    s_nop 0
    s_nop 0
    v_permlane32_swap_b32 v144, v215
    v_max_f32 v144, v144, v215
    v_mov_b32 v215, v144
    s_nop 0
    s_nop 0
    v_permlane16_swap_b32 v144, v215
    v_max_f32 v144, v144, v215
    v_sub_f32 v126, v126, v144
    v_exp_f32 v126, v126
    v_sub_f32 v127, v127, v144
    v_exp_f32 v127, v127
    v_sub_f32 v128, v128, v144
    v_cvt_pk_bf16_f32 v126, v126, v127
    v_exp_f32 v128, v128
    v_sub_f32 v129, v129, v144
    v_exp_f32 v129, v129
    v_sub_f32 v170, v170, v144
    v_cvt_pk_bf16_f32 v127, v128, v129
    v_exp_f32 v170, v170
    v_sub_f32 v171, v171, v144
    v_exp_f32 v171, v171
    v_sub_f32 v172, v172, v144
    v_cvt_pk_bf16_f32 v128, v170, v171
    v_exp_f32 v172, v172
    v_sub_f32 v173, v173, v144
    v_exp_f32 v173, v173
    v_sub_f32 v182, v182, v144
    v_cvt_pk_bf16_f32 v129, v172, v173
    v_exp_f32 v182, v182
    v_sub_f32 v183, v183, v144
    v_exp_f32 v183, v183
    v_sub_f32 v184, v184, v144
    v_exp_f32 v184, v184
    v_sub_f32 v185, v185, v144
    v_exp_f32 v185, v185
    v_sub_f32 v234, v234, v144
    v_exp_f32 v234, v234
    v_mfma_f32_16x16x32_bf16 v[134:137], v[28:31], v[36:39], 0
    s_waitcnt lgkmcnt(0)
    v_mfma_f32_16x16x32_bf16 v[134:137], v[28:31], v[146:149], v[134:137]
    s_nop 0
    s_nop 0
    s_nop 0
    s_nop 0
    s_nop 0
    s_nop 0
    s_nop 0
    s_nop 0
    v_rcp_f32 v134, v134
    v_mfma_f32_16x16x32_bf16 v[170:173], v[138:141], v[36:39], 0
    v_mfma_f32_16x16x32_bf16 v[170:173], v[194:197], v[146:149], v[170:173]
    s_nop 0
    s_nop 0
    s_nop 0
    s_nop 0
    s_nop 0
    s_nop 0
    s_nop 0
    s_nop 0
    v_mul_f32 v170, v134, v170
    v_mul_f32 v171, v134, v171
    v_cvt_pk_bf16_f32 v170, v170, v171
    v_mul_f32 v172, v134, v172
    v_mul_f32 v173, v134, v173
    v_cvt_pk_bf16_f32 v171, v172, v173
    v_mfma_f32_16x16x32_bf16 v[250:253], v[230:233], v[36:39], 0
    v_mfma_f32_16x16x32_bf16 v[250:253], v[190:193], v[146:149], v[250:253]
    s_nop 0
    s_nop 0
    s_nop 0
    s_nop 0
    s_nop 0
    s_nop 0
    s_nop 0
    s_nop 0
    v_mul_f32 v250, v134, v250
    v_mul_f32 v251, v134, v251
    v_cvt_pk_bf16_f32 v172, v250, v251
    v_mul_f32 v252, v134, v252
    v_mul_f32 v253, v134, v253
    v_cvt_pk_bf16_f32 v173, v252, v253
    ds_write_b128 v3, v[170:173] offset:0
    v_mfma_f32_16x16x32_bf16 v[170:173], v[186:189], v[36:39], 0
    v_cvt_pk_bf16_f32 v36, v182, v183
    v_cvt_pk_bf16_f32 v37, v184, v185
    v_mfma_f32_16x16x32_bf16 v[170:173], v[166:169], v[146:149], v[170:173]
    v_cvt_pk_bf16_f32 v39, v234, 0
    v_mfma_f32_16x16x32_f16 v[146:149], v[130:133], v[242:245], v[70:73]
    v_mfma_f32_16x16x32_f16 v[182:185], v[178:181], v[242:245], v[74:77]
    v_mfma_f32_16x16x32_bf16 v[250:253], v[28:31], v[36:39], 0
    v_mfma_f32_16x16x32_bf16 v[250:253], v[28:31], v[126:129], v[250:253]
    v_mfma_f32_16x16x32_bf16 v[178:181], v[138:141], v[36:39], 0
    v_mfma_f32_16x16x32_bf16 v[178:181], v[194:197], v[126:129], v[178:181]
    s_nop 0
    v_mul_f32 v170, v134, v170
    v_mul_f32 v171, v134, v171
    v_cvt_pk_bf16_f32 v170, v170, v171
    v_mfma_f32_16x16x16_f16 v[146:149], v[124:125], v[206:207], v[146:149]
    v_mul_f32 v172, v134, v172
    v_rcp_f32 v250, v250
    v_mul_f32 v173, v134, v173
    v_mfma_f32_16x16x32_bf16 v[130:133], v[230:233], v[36:39], 0
    v_mul_f32 v178, v250, v178
    v_mul_f32 v179, v250, v179
    v_mfma_f32_16x16x32_bf16 v[130:133], v[190:193], v[126:129], v[130:133]
    v_cvt_pk_bf16_f32 v178, v178, v179
    v_max3_f32 v144, v142, v146, v147
    v_max3_f32 v144, v144, v148, v149
    v_mfma_f32_16x16x16_f16 v[182:185], v[220:221], v[206:207], v[182:185]
    v_mul_f32 v180, v250, v180
    v_mul_f32 v181, v250, v181
    v_cvt_pk_bf16_f32 v179, v180, v181
    v_cvt_pk_bf16_f32 v171, v172, v173
    v_mfma_f32_16x16x32_bf16 v[134:137], v[186:189], v[36:39], 0
    ds_write_b64 v4, v[170:171] offset:4096
    v_mfma_f32_16x16x32_bf16 v[134:137], v[166:169], v[126:129], v[134:137]
    v_mul_f32 v130, v250, v130
    v_max3_f32 v144, v144, v182, v183
    v_mfma_f32_16x16x32_f16 v[126:129], v[246:249], v[242:245], v[78:81]
    v_max3_f32 v144, v144, v184, v185
    v_mul_f32 v131, v250, v131
    v_mfma_f32_16x16x32_bf16 v[170:173], v[90:93], v[238:241], 0
    v_cvt_pk_bf16_f32 v180, v130, v131
    v_mul_f32 v132, v250, v132
    v_mfma_f32_16x16x32_bf16 v[170:173], v[94:97], v[226:229], v[170:173]
    v_mul_f32 v133, v250, v133
    v_cvt_pk_bf16_f32 v181, v132, v133
    v_mul_f32 v134, v250, v134
    v_mfma_f32_16x16x16_f16 v[126:129], v[208:209], v[206:207], v[126:129]
    v_mul_f32 v135, v250, v135
    v_cvt_pk_bf16_f32 v124, v134, v135
    v_mul_f32 v136, v250, v136
    v_mul_f32 v137, v250, v137
    v_mfma_f32_16x16x32_bf16 v[170:173], v[98:101], v[174:177], v[170:173]
    ds_write_b128 v3, v[178:181] offset:6144
    v_mfma_f32_16x16x32_bf16 v[170:173], v[102:105], v[222:225], v[170:173]
    v_cvt_pk_bf16_f32 v125, v136, v137
    v_max3_f32 v144, v144, v126, v127
    v_mfma_f32_16x16x32_bf16 v[170:173], v[106:109], v[162:165], v[170:173]
    v_max3_f32 v144, v144, v128, v129
    v_mov_b32 v215, v144
    v_mfma_f32_16x16x32_bf16 v[170:173], v[110:113], v[158:161], v[170:173]
    ds_write_b64 v4, v[124:125] offset:10240
    v_permlane32_swap_b32 v144, v215
    v_max_f32 v144, v144, v215
    v_mov_b32 v215, v144
    s_nop 0
    s_nop 0
    v_permlane16_swap_b32 v144, v215
    v_max_f32 v144, v144, v215
    v_fmac_f32 v150, v170, v170
    v_fmac_f32 v150, v171, v171
    v_fmac_f32 v150, v172, v172
    v_fmac_f32 v150, v173, v173
    v_cvt_pk_bf16_f32 v124, v254, v150
    v_cvt_pk_bf16_f32 v125, v150, v150
    ds_write_b64 v214, v[124:125] offset:2048
    v_sub_f32 v146, v146, v144
    v_exp_f32 v146, v146
    v_sub_f32 v147, v147, v144
    v_exp_f32 v147, v147
    v_sub_f32 v148, v148, v144
    v_cvt_pk_bf16_f32 v146, v146, v147
    v_exp_f32 v148, v148
    v_sub_f32 v149, v149, v144
    v_exp_f32 v149, v149
    v_sub_f32 v182, v182, v144
    v_cvt_pk_bf16_f32 v147, v148, v149
    v_exp_f32 v182, v182
    v_sub_f32 v183, v183, v144
    v_exp_f32 v183, v183
    v_sub_f32 v184, v184, v144
    v_cvt_pk_bf16_f32 v148, v182, v183
    s_waitcnt lgkmcnt(0)
    s_barrier
    s_barrier
    ds_read_b128 v[158:161], v153 offset:2048
    ds_read_b128 v[134:137], v153 offset:3072
    ds_read_b128 v[174:177], v255 offset:0
    ds_read_b128 v[206:209], v255 offset:1024
    ds_read_b128 v[218:221], v255 offset:2048
    ds_read_b128 v[238:241], v255 offset:3072
    ds_read_b128 v[162:165], v255 offset:4096
    ds_read_b128 v[130:133], v255 offset:5120
    v_exp_f32 v184, v184
    v_sub_f32 v185, v185, v144
    s_waitcnt lgkmcnt(7)
    v_mfma_f32_16x16x32_bf16 v[178:181], v[32:35], v[158:161], 0
    s_waitcnt lgkmcnt(5)
    v_exp_f32 v185, v185
    v_mfma_f32_16x16x32_bf16 v[178:181], v[32:35], v[134:137], v[178:181]
    s_waitcnt lgkmcnt(4)
    v_cvt_pk_bf16_f32 v149, v184, v185
    v_sub_f32 v126, v126, v144
    v_mfma_f32_16x16x32_bf16 v[158:161], a[216:219], v[174:177], 0
    s_waitcnt lgkmcnt(3)
    v_exp_f32 v126, v126
    v_mfma_f32_16x16x32_bf16 v[158:161], a[220:223], v[206:209], v[158:161]
    s_waitcnt lgkmcnt(2)
    v_mul_f32 v215, 0x3baaaaab, v179
    v_sub_f32 v127, v127, v144
    v_mfma_f32_16x16x32_bf16 v[158:161], a[224:227], v[218:221], v[158:161]
    s_waitcnt lgkmcnt(1)
    v_rsq_f32 v215, v215
    v_mfma_f32_16x16x32_bf16 v[158:161], a[228:231], v[238:241], v[158:161]
    s_waitcnt lgkmcnt(0)
    v_mul_f32 v114, v215, v114
    v_mul_f32 v115, v215, v115
    v_mfma_f32_16x16x32_bf16 v[158:161], a[232:235], v[162:165], v[158:161]
    v_cvt_pk_bf16_f32 v134, v114, v115
    v_mul_f32 v116, v215, v116
    v_mfma_f32_16x16x32_bf16 v[158:161], a[236:239], v[130:133], v[158:161]
    v_mul_f32 v117, v215, v117
    v_cvt_pk_bf16_f32 v135, v116, v117
    v_mfma_f32_16x16x32_bf16 v[114:117], a[240:243], v[174:177], 0
    v_mul_f32 v210, v215, v210
    v_mul_f32 v211, v215, v211
    v_mfma_f32_16x16x32_bf16 v[114:117], a[244:247], v[206:209], v[114:117]
    v_cvt_pk_bf16_f32 v136, v210, v211
    v_mul_f32 v212, v215, v212
    v_mfma_f32_16x16x32_bf16 v[114:117], a[248:251], v[218:221], v[114:117]
    v_mul_f32 v213, v215, v213
    v_cvt_pk_bf16_f32 v137, v212, v213
    v_mfma_f32_16x16x32_bf16 v[114:117], a[252:255], v[238:241], v[114:117]
    buffer_store_dwordx4 v[134:137], v151, s[12:15], 0 offen nt
    v_mul_f32 v170, v215, v170
    v_mul_f32 v171, v215, v171
    v_cvt_pk_bf16_f32 v124, v170, v171
    v_mul_f32 v172, v215, v172
    v_mfma_f32_16x16x32_bf16 v[114:117], v[82:85], v[162:165], v[114:117]
    v_mul_f32 v173, v215, v173
    v_cvt_pk_bf16_f32 v125, v172, v173
    v_mfma_f32_16x16x32_bf16 v[114:117], v[86:89], v[130:133], v[114:117]
    v_exp_f32 v127, v127
    v_mfma_f32_16x16x32_bf16 v[170:173], v[90:93], v[174:177], 0
    v_cvt_pk_bf16_f32 v36, v126, v127
    v_sub_f32 v128, v128, v144
    v_mfma_f32_16x16x32_bf16 v[170:173], v[94:97], v[206:209], v[170:173]
    v_exp_f32 v128, v128
    v_mfma_f32_16x16x32_bf16 v[170:173], v[98:101], v[218:221], v[170:173]
    ds_read_b128 v[206:209], v9
    ds_read_b128 v[210:213], v9 offset:64
    v_mfma_f32_16x16x32_bf16 v[170:173], v[102:105], v[238:241], v[170:173]
    v_sub_f32 v129, v129, v144
    v_sub_f32 v142, v142, v144
    v_mfma_f32_16x16x32_bf16 v[170:173], v[106:109], v[162:165], v[170:173]
    v_exp_f32 v129, v129
    v_mfma_f32_16x16x32_bf16 v[170:173], v[110:113], v[130:133], v[170:173]
    v_cvt_pk_bf16_f32 v37, v128, v129
    v_exp_f32 v142, v142
    v_fma_f32 v215, v158, v158, s33
    v_cvt_pk_bf16_f32 v39, v142, 0
    v_fmac_f32 v215, v159, v159
    v_fmac_f32 v215, v160, v160
    v_mfma_f32_16x16x32_bf16 v[130:133], v[28:31], v[36:39], 0
    v_fmac_f32 v215, v161, v161
    v_fmac_f32 v215, v114, v114
    v_mfma_f32_16x16x32_bf16 v[130:133], v[28:31], v[146:149], v[130:133]
    v_fmac_f32 v215, v115, v115
    v_fmac_f32 v215, v116, v116
    v_mfma_f32_16x16x32_bf16 v[162:165], v[138:141], v[36:39], 0
    s_waitcnt lgkmcnt(0)
    v_fmac_f32 v215, v117, v117
    v_fmac_f32 v215, v170, v170
    v_mfma_f32_16x16x32_bf16 v[162:165], v[194:197], v[146:149], v[162:165]
    v_fmac_f32 v215, v171, v171
    v_fmac_f32 v215, v172, v172
    v_mfma_f32_16x16x32_bf16 v[126:129], v[230:233], v[36:39], 0
    v_fmac_f32 v215, v173, v173
    v_cvt_pk_bf16_f32 v150, v215, v215
    v_mfma_f32_16x16x32_bf16 v[126:129], v[190:193], v[146:149], v[126:129]
    buffer_store_dwordx2 v[124:125], v200, s[12:15], 0 offen nt
    v_cvt_pk_bf16_f32 v151, v215, v215
    v_mul_f32 v200, 0x3baaaaab, v178
    v_mfma_f32_16x16x32_bf16 v[174:177], v[186:189], v[36:39], 0
    ds_write_b64 v214, v[150:151] offset:7616
    v_mfma_f32_16x16x32_bf16 v[174:177], v[166:169], v[146:149], v[174:177]
    v_rsq_f32 v200, v200
    v_mfma_f32_16x16x32_bf16 v[146:149], v[206:209], v[28:31], 0
    v_mul_f32 v118, v200, v118
    v_mul_f32 v119, v200, v119
    v_mfma_f32_16x16x32_bf16 v[146:149], v[210:213], v[28:31], v[146:149]
    v_cvt_pk_bf16_f32 v178, v118, v119
    v_mul_f32 v120, v200, v120
    v_mfma_f32_16x16x32_bf16 v[134:137], v[206:209], v[194:197], 0
    v_mul_f32 v121, v200, v121
    v_cvt_pk_bf16_f32 v179, v120, v121
    v_mfma_f32_16x16x32_bf16 v[134:137], v[210:213], v[138:141], v[134:137]
    v_mul_f32 v154, v200, v154
    v_mul_f32 v155, v200, v155
    v_mfma_f32_16x16x32_bf16 v[118:121], v[206:209], v[190:193], 0
    v_rcp_f32 v146, v146
    v_mfma_f32_16x16x32_bf16 v[118:121], v[210:213], v[230:233], v[118:121]
    v_cvt_pk_bf16_f32 v180, v154, v155
    v_mul_f32 v156, v200, v156
    v_mfma_f32_16x16x32_bf16 v[138:141], v[206:209], v[166:169], 0
    v_mul_f32 v134, v134, v146
    v_mul_f32 v157, v200, v157
    v_mfma_f32_16x16x32_bf16 v[138:141], v[210:213], v[186:189], v[138:141]
    v_cvt_pk_bf16_f32 v181, v156, v157
    v_mul_f32 v202, v200, v202
    v_mul_f32_dpp v134, v118, v146 quad_perm:[0,1,2,3] row_mask:0x2 bank_mask:0xf
    v_mul_f32 v203, v200, v203
    v_cvt_pk_bf16_f32 v124, v202, v203
    v_mul_f32 v204, v200, v204
    v_mul_f32 v205, v200, v205
    v_cvt_pk_bf16_f32 v125, v204, v205
    v_mul_f32_dpp v134, v138, v146 quad_perm:[0,1,2,3] row_mask:0x4 bank_mask:0xf
    v_cvt_pk_bf16_f32 v134, v134, v134
    ds_write_b16 v7, v134
    v_rcp_f32 v130, v130
    s_nop 0
    v_mul_f32 v162, v130, v162
    v_mul_f32 v163, v130, v163
    v_cvt_pk_bf16_f32 v118, v162, v163
    buffer_store_dwordx4 v[178:181], v17, s[52:55], 0 offen nt
    v_mul_f32 v164, v130, v164
    v_mul_f32 v165, v130, v165
    v_cvt_pk_bf16_f32 v119, v164, v165
    v_mul_f32 v126, v130, v126
    v_mul_f32 v127, v130, v127
    v_cvt_pk_bf16_f32 v120, v126, v127
    v_mul_f32 v128, v130, v128
    v_mul_f32 v129, v130, v129
    v_cvt_pk_bf16_f32 v121, v128, v129
    ds_write_b128 v3, v[118:121] offset:12288
    s_waitcnt lgkmcnt(1)
    s_barrier
    v_mul_f32 v174, v130, v174
    v_mul_f32 v175, v130, v175
    v_cvt_pk_bf16_f32 v150, v174, v175
    v_mul_f32 v176, v130, v176
    v_mul_f32 v177, v130, v177
    ds_read_b128 v[126:129], v153 offset:7616
    ds_read_b128 v[118:121], v153 offset:8640
    ds_read_b128 v[146:149], v255 offset:6144
    ds_read_b128 v[186:189], v255 offset:7168
    ds_read_b128 v[206:209], v255 offset:8192
    ds_read_b128 v[166:169], v255 offset:9216
    ds_read_b128 v[162:165], v255 offset:10240
    ds_read_b128 v[154:157], v255 offset:11264
    v_cvt_pk_bf16_f32 v151, v176, v177
    ds_write_b64 v4, v[150:151] offset:16384
    s_waitcnt lgkmcnt(6)
    v_mfma_f32_16x16x32_bf16 v[138:141], v[32:35], v[126:129], 0
    s_waitcnt lgkmcnt(5)
    v_mfma_f32_16x16x32_bf16 v[138:141], v[32:35], v[118:121], v[138:141]
    s_waitcnt lgkmcnt(4)
    v_mfma_f32_16x16x32_bf16 v[118:121], a[216:219], v[146:149], 0
    s_waitcnt lgkmcnt(3)
    buffer_store_dwordx2 v[124:125], v20, s[52:55], 0 offen nt
    v_mfma_f32_16x16x32_bf16 v[118:121], a[220:223], v[186:189], v[118:121]
    s_waitcnt lgkmcnt(2)
    v_mfma_f32_16x16x32_bf16 v[118:121], a[224:227], v[206:209], v[118:121]
    s_waitcnt lgkmcnt(1)
    v_mul_f32 v200, 0x3baaaaab, v138
    v_mfma_f32_16x16x32_bf16 v[118:121], a[228:231], v[166:169], v[118:121]
    v_rsq_f32 v200, v200
    v_mfma_f32_16x16x32_bf16 v[118:121], a[232:235], v[162:165], v[118:121]
    v_mul_f32 v158, v200, v158
    v_mul_f32 v159, v200, v159
    v_mfma_f32_16x16x32_bf16 v[118:121], a[236:239], v[154:157], v[118:121]
    v_cvt_pk_bf16_f32 v158, v158, v159
    v_mul_f32 v160, v200, v160
    v_mfma_f32_16x16x32_bf16 v[138:141], a[240:243], v[146:149], 0
    v_mul_f32 v161, v200, v161
    v_cvt_pk_bf16_f32 v159, v160, v161
    v_mfma_f32_16x16x32_bf16 v[138:141], a[244:247], v[186:189], v[138:141]
    v_mul_f32 v114, v200, v114
    v_mul_f32 v115, v200, v115
    v_mfma_f32_16x16x32_bf16 v[138:141], a[248:251], v[206:209], v[138:141]
    v_fma_f32 v215, v118, v118, s33
    v_fmac_f32 v215, v119, v119
    v_mfma_f32_16x16x32_bf16 v[138:141], a[252:255], v[166:169], v[138:141]
    v_fmac_f32 v215, v120, v120
    v_fmac_f32 v215, v121, v121
    v_mfma_f32_16x16x32_bf16 v[138:141], v[82:85], v[162:165], v[138:141]
    v_cvt_pk_bf16_f32 v160, v114, v115
    v_mul_f32 v116, v200, v116
    v_mfma_f32_16x16x32_bf16 v[138:141], v[86:89], v[154:157], v[138:141]
    v_mul_f32 v117, v200, v117
    v_cvt_pk_bf16_f32 v161, v116, v117
    v_mfma_f32_16x16x32_bf16 v[126:129], v[90:93], v[146:149], 0
    ds_read_b128 v[146:149], v152 offset:256
    v_mul_f32 v170, v200, v170
    v_mfma_f32_16x16x32_bf16 v[126:129], v[94:97], v[186:189], v[126:129]
    ds_read_b128 v[114:117], v152 offset:2304
    v_mul_f32 v171, v200, v171
    v_mfma_f32_16x16x32_bf16 v[126:129], v[98:101], v[206:209], v[126:129]
    ds_read_b128 v[206:209], v152 offset:4352
    v_fmac_f32 v215, v138, v138
    v_mfma_f32_16x16x32_bf16 v[126:129], v[102:105], v[166:169], v[126:129]
    ds_read_b128 v[166:169], v152 offset:6400
    v_fmac_f32 v215, v139, v139
    v_mfma_f32_16x16x32_bf16 v[126:129], v[106:109], v[162:165], v[126:129]
    ds_read_b128 v[186:189], v152 offset:8448
    buffer_store_dwordx4 v[158:161], v15, s[56:59], 0 offen nt
    v_fmac_f32 v215, v140, v140
    v_fmac_f32 v215, v141, v141
    v_cvt_pk_bf16_f32 v124, v170, v171
    v_mul_f32 v172, v200, v172
    v_mfma_f32_16x16x32_bf16 v[126:129], v[110:113], v[154:157], v[126:129]
    ds_read_b128 v[154:157], v152 offset:10496
    s_waitcnt lgkmcnt(5)
    v_mfma_f32_16x16x32_bf16 v[158:161], a[216:219], v[146:149], 0
    v_mul_f32 v173, v200, v173
    v_cvt_pk_bf16_f32 v125, v172, v173
    v_mfma_f32_16x16x32_bf16 v[170:173], a[240:243], v[146:149], 0
    s_waitcnt lgkmcnt(4)
    v_mfma_f32_16x16x32_bf16 v[158:161], a[220:223], v[114:117], v[158:161]
    s_waitcnt lgkmcnt(3)
    v_fmac_f32 v215, v126, v126
    v_fmac_f32 v215, v127, v127
    v_mfma_f32_16x16x32_bf16 v[158:161], a[224:227], v[206:209], v[158:161]
    s_waitcnt lgkmcnt(2)
    v_fmac_f32 v215, v128, v128
    v_fmac_f32 v215, v129, v129
    v_mfma_f32_16x16x32_bf16 v[158:161], a[228:231], v[166:169], v[158:161]
    s_waitcnt lgkmcnt(1)
    v_cvt_pk_bf16_f32 v150, v215, v215
    v_cvt_pk_bf16_f32 v151, v215, v215
    v_mfma_f32_16x16x32_bf16 v[158:161], a[232:235], v[186:189], v[158:161]
    ds_write_b64 v214, v[150:151] offset:9664
    v_mfma_f32_16x16x32_bf16 v[170:173], a[244:247], v[114:117], v[170:173]
    s_waitcnt lgkmcnt(1)
    v_mfma_f32_16x16x32_bf16 v[158:161], a[236:239], v[154:157], v[158:161]
    v_mfma_f32_16x16x32_bf16 v[170:173], a[248:251], v[206:209], v[170:173]
    v_mfma_f32_16x16x32_bf16 v[170:173], a[252:255], v[166:169], v[170:173]
    v_mfma_f32_16x16x32_bf16 v[170:173], v[82:85], v[186:189], v[170:173]
    v_mfma_f32_16x16x32_bf16 v[170:173], v[86:89], v[154:157], v[170:173]
    v_mfma_f32_16x16x32_bf16 v[162:165], v[90:93], v[146:149], 0
    s_waitcnt lgkmcnt(0)
    v_mfma_f32_16x16x32_bf16 v[162:165], v[94:97], v[114:117], v[162:165]
    s_barrier
    ds_read_b128 v[146:149], v153 offset:9664
    ds_read_b128 v[202:205], v153 offset:10688
    v_mfma_f32_16x16x32_bf16 v[162:165], v[98:101], v[206:209], v[162:165]
    ds_read_b128 v[114:117], v255 offset:12288
    ds_read_b128 v[206:209], v255 offset:13312
    v_mfma_f32_16x16x32_bf16 v[162:165], v[102:105], v[166:169], v[162:165]
    buffer_store_dwordx2 v[124:125], v18, s[56:59], 0 offen nt
    ds_read_b128 v[130:133], v255 offset:14336
    v_fma_f32 v200, v158, v158, s33
    v_mfma_f32_16x16x32_bf16 v[162:165], v[106:109], v[186:189], v[162:165]
    ds_read_b128 v[186:189], v255 offset:15360
    v_fmac_f32 v200, v159, v159
    v_mfma_f32_16x16x32_bf16 v[162:165], v[110:113], v[154:157], v[162:165]
    ds_read_b128 v[166:169], v255 offset:16384
    ds_read_b128 v[154:157], v255 offset:17408
    v_fmac_f32 v200, v160, v160
    v_fmac_f32 v200, v161, v161
    v_fmac_f32 v200, v170, v170
    s_waitcnt lgkmcnt(7)
    v_mfma_f32_16x16x32_bf16 v[210:213], v[32:35], v[146:149], 0
    s_waitcnt lgkmcnt(6)
    v_fmac_f32 v200, v171, v171
    v_fmac_f32 v200, v172, v172
    v_mfma_f32_16x16x32_bf16 v[210:213], v[32:35], v[202:205], v[210:213]
    s_waitcnt lgkmcnt(4)
    v_fmac_f32 v200, v173, v173
    v_fmac_f32 v200, v162, v162
    v_mfma_f32_16x16x32_bf16 v[146:149], a[216:219], v[114:117], 0
    s_waitcnt lgkmcnt(3)
    v_fmac_f32 v200, v163, v163
    v_fmac_f32 v200, v164, v164
    v_mfma_f32_16x16x32_bf16 v[146:149], a[220:223], v[206:209], v[146:149]
    s_waitcnt lgkmcnt(2)
    v_fmac_f32 v200, v165, v165
    v_cvt_pk_bf16_f32 v124, v200, v200
    v_mfma_f32_16x16x32_bf16 v[146:149], a[224:227], v[130:133], v[146:149]
    s_waitcnt lgkmcnt(1)
    v_cvt_pk_bf16_f32 v125, v200, v200
    v_mul_f32 v215, 0x3baaaaab, v210
    v_mfma_f32_16x16x32_bf16 v[146:149], a[228:231], v[186:189], v[146:149]
    s_waitcnt lgkmcnt(0)
    ds_write_b64 v214, v[124:125] offset:17280
    v_mfma_f32_16x16x32_bf16 v[146:149], a[232:235], v[166:169], v[146:149]
    v_rsq_f32 v215, v215
    v_mfma_f32_16x16x32_bf16 v[146:149], a[236:239], v[154:157], v[146:149]
    v_mul_f32 v118, v215, v118
    v_mul_f32 v119, v215, v119
    v_mfma_f32_16x16x32_bf16 v[202:205], a[240:243], v[114:117], 0
    v_cvt_pk_bf16_f32 v118, v118, v119
    v_mul_f32 v120, v215, v120
    v_mfma_f32_16x16x32_bf16 v[202:205], a[244:247], v[206:209], v[202:205]
    v_mul_f32 v121, v215, v121
    v_cvt_pk_bf16_f32 v119, v120, v121
    v_mfma_f32_16x16x32_bf16 v[202:205], a[248:251], v[130:133], v[202:205]
    v_fma_f32 v200, v146, v146, s33
    v_fmac_f32 v200, v147, v147
    v_mfma_f32_16x16x32_bf16 v[202:205], a[252:255], v[186:189], v[202:205]
    v_fmac_f32 v200, v148, v148
    v_fmac_f32 v200, v149, v149
    v_mfma_f32_16x16x32_bf16 v[202:205], v[82:85], v[166:169], v[202:205]
    v_mul_f32 v138, v215, v138
    v_mul_f32 v139, v215, v139
    v_mfma_f32_16x16x32_bf16 v[202:205], v[86:89], v[154:157], v[202:205]
    v_cvt_pk_bf16_f32 v120, v138, v139
    v_mul_f32 v140, v215, v140
    v_mfma_f32_16x16x32_bf16 v[210:213], v[90:93], v[114:117], 0
    v_mul_f32 v141, v215, v141
    v_cvt_pk_bf16_f32 v121, v140, v141
    v_mfma_f32_16x16x32_bf16 v[210:213], v[94:97], v[206:209], v[210:213]
    ds_write_b128 v199, v[118:121] offset:1536
    v_mfma_f32_16x16x32_bf16 v[210:213], v[98:101], v[130:133], v[210:213]
    v_fmac_f32 v200, v202, v202
    v_fmac_f32 v200, v203, v203
    v_mfma_f32_16x16x32_bf16 v[210:213], v[102:105], v[186:189], v[210:213]
    v_fmac_f32 v200, v204, v204
    v_fmac_f32 v200, v205, v205
    v_mfma_f32_16x16x32_bf16 v[210:213], v[106:109], v[166:169], v[210:213]
    ds_read_b128 v[114:117], v145 offset:1536
    v_mul_f32 v126, v215, v126
    v_mfma_f32_16x16x32_bf16 v[210:213], v[110:113], v[154:157], v[210:213]
    v_mul_f32 v127, v215, v127
    v_cvt_pk_bf16_f32 v124, v126, v127
    v_mul_f32 v128, v215, v128
    v_mul_f32 v129, v215, v129
    v_cvt_pk_bf16_f32 v125, v128, v129
    ds_write_b64 v123, v[124:125] offset:2560
    s_nop 0
    s_nop 0
    v_fmac_f32 v200, v210, v210
    v_fmac_f32 v200, v211, v211
    v_fmac_f32 v200, v212, v212
    v_fmac_f32 v200, v213, v213
    v_cvt_pk_bf16_f32 v124, v200, v200
    v_cvt_pk_bf16_f32 v125, v200, v200
    ds_write_b64 v214, v[124:125] offset:15232
    s_waitcnt lgkmcnt(2)
    buffer_store_dwordx4 v[114:117], v198, s[56:59], 0 offen nt
    ds_read_b64 v[124:125], v122 offset:2560
    s_waitcnt lgkmcnt(1)
    s_barrier
    ds_read_b128 v[186:189], v153 offset:15232
    ds_read_b128 v[118:121], v153 offset:16256
    ds_read_b128 v[114:117], v153 offset:17280
    ds_read_b128 v[166:169], v153 offset:18304
    ds_read_b128 v[154:157], v255 offset:18432
    s_waitcnt lgkmcnt(5)
    buffer_store_dwordx2 v[124:125], v235, s[56:59], 0 offen nt
    s_waitcnt lgkmcnt(4)
    v_mfma_f32_16x16x32_bf16 v[138:141], v[32:35], v[186:189], 0
    s_waitcnt lgkmcnt(3)
    v_mfma_f32_16x16x32_bf16 v[138:141], v[32:35], v[118:121], v[138:141]
    s_waitcnt lgkmcnt(1)
    v_mfma_f32_16x16x32_bf16 v[118:121], v[32:35], v[114:117], 0
    s_waitcnt lgkmcnt(0)
    v_or3_b32 v154, v154, v155, v156
    v_or_b32 v154, v154, v157
    v_mfma_f32_16x16x32_bf16 v[118:121], v[32:35], v[166:169], v[118:121]
    v_cmp_gt_i32 s[46:47], 0, v154
    s_nop 0
    v_mul_f32 v125, 0x3baaaaab, v138
    v_rsq_f32 v125, v125
    s_nop 0
    v_mul_f32 v146, v125, v146
    v_mul_f32 v147, v125, v147
    v_cvt_pk_bf16_f32 v146, v146, v147
    v_mul_f32 v124, 0x3baaaaab, v118
    v_rsq_f32 v124, v124
    v_mul_f32 v148, v125, v148
    v_mul_f32 v158, v124, v158
    v_mul_f32 v159, v124, v159
    v_cvt_pk_bf16_f32 v114, v158, v159
    v_mul_f32 v160, v124, v160
    v_mul_f32 v161, v124, v161
    v_cvt_pk_bf16_f32 v115, v160, v161
    v_mul_f32 v170, v124, v170
    v_mul_f32 v171, v124, v171
    v_cvt_pk_bf16_f32 v116, v170, v171
    v_mul_f32 v172, v124, v172
    v_mul_f32 v173, v124, v173
    v_cvt_pk_bf16_f32 v117, v172, v173
    buffer_store_dwordx4 v[114:117], v217, s[12:15], 0 offen nt
    v_mul_f32 v162, v124, v162
    v_mul_f32 v163, v124, v163
    v_cvt_pk_bf16_f32 v254, v162, v163
    v_mul_f32 v164, v124, v164
    v_mul_f32 v165, v124, v165
    v_cvt_pk_bf16_f32 v255, v164, v165
    v_mul_f32 v149, v125, v149
    v_cvt_pk_bf16_f32 v147, v148, v149
    v_mul_f32 v202, v125, v202
    v_mul_f32 v203, v125, v203
    v_cvt_pk_bf16_f32 v148, v202, v203
    v_mul_f32 v204, v125, v204
    v_mul_f32 v205, v125, v205
    v_cvt_pk_bf16_f32 v149, v204, v205
    ds_write_b128 v199, v[146:149] offset:3072
    v_mul_f32 v210, v125, v210
    v_mul_f32 v211, v125, v211
    v_cvt_pk_bf16_f32 v124, v210, v211
    v_mul_f32 v212, v125, v212
    v_mul_f32 v213, v125, v213
    v_cvt_pk_bf16_f32 v125, v212, v213
    buffer_store_dwordx2 v[254:255], v216, s[12:15], 0 offen nt
    ds_read_b128 v[114:117], v145 offset:3072
    ds_write_b64 v123, v[124:125] offset:4096
    ds_read_b64 v[198:199], v122 offset:4096
    s_waitcnt lgkmcnt(2)
    buffer_store_dwordx4 v[114:117], v143, s[56:59], 0 offen nt
    s_waitcnt lgkmcnt(0)
    buffer_store_dwordx2 v[198:199], v201, s[56:59], 0 offen nt
    s_branch L_end
L_drain:
    ds_read_b128 v[118:121], v2 offset:18432
    ds_read_b128 v[126:129], v2 offset:19456
    ds_read_b128 v[130:133], v2 offset:0
    s_mul_i32 s5, s16, 9408
    s_mov_b32 s12, s40
    ds_read_b128 v[134:137], v2 offset:1024
    s_mov_b32 s13, s41
    s_cmp_ge_u32 s18, 2
    s_cselect_b32 s14, s36, 0
    ds_read_b128 v[142:145], v2 offset:2048
    s_add_u32 s5, s5, 104448
    s_and_b32 s6, s2, 7
    s_sub_u32 s6, 0, s6
    ds_read_b128 v[146:149], v2 offset:3072
    s_lshl_b32 s3, s16, 6
    s_lshl_b32 s4, s16, 5
    s_add_u32 s4, s4, 256
    ds_read_b128 v[158:161], v2 offset:4096
    ds_read_b128 v[170:173], v2 offset:5120
    v_bfe_u32 v254, v2, 4, 6
    v_lshrrev_b32 v255, 4, v254
    v_and_b32 v174, 15, v254
    v_lshlrev_b32 v175, 9, v255
    v_lshl_add_u32 v175, v174, 4, v175
    v_add_u32 v175, 149696, v175
    s_waitcnt lgkmcnt(7)
    v_mfma_f32_16x16x32_bf16 v[178:181], v[32:35], v[118:121], 0
    s_waitcnt lgkmcnt(5)
    v_xor_b32 v176, 65536, v2
    v_bfe_u32 v177, v174, 1, 2
    v_mfma_f32_16x16x32_bf16 v[178:181], v[32:35], v[126:129], v[178:181]
    s_waitcnt lgkmcnt(4)
    v_xor_b32 v177, v177, v255
    v_lshl_add_u32 v177, v174, 2, v177
    v_lshl_add_u32 v118, v177, 4, s5
    v_mfma_f32_16x16x32_bf16 v[126:129], a[216:219], v[130:133], 0
    s_waitcnt lgkmcnt(3)
    v_lshl_add_u32 v119, v177, 3, s5
    v_lshl_add_u32 v120, v254, 4, s5
    v_lshl_add_u32 v121, v254, 3, s5
    v_mfma_f32_16x16x32_bf16 v[126:129], a[220:223], v[134:137], v[126:129]
    s_waitcnt lgkmcnt(2)
    v_lshlrev_b32 v177, 2, v177
    v_mul_f32 v178, 0x3baaaaab, v178
    v_rsq_f32 v178, v178
    v_mfma_f32_16x16x32_bf16 v[126:129], a[224:227], v[142:145], v[126:129]
    s_waitcnt lgkmcnt(0)
    ds_permute_b32 v181, v177, v15
    ds_permute_b32 v182, v177, v18
    v_mul_f32 v122, v178, v122
    v_mfma_f32_16x16x32_bf16 v[126:129], a[228:231], v[146:149], v[126:129]
    ds_permute_b32 v183, v177, v16
    ds_permute_b32 v184, v177, v19
    v_mul_f32 v123, v178, v123
    v_mfma_f32_16x16x32_bf16 v[126:129], a[232:235], v[158:161], v[126:129]
    ds_permute_b32 v185, v177, v17
    ds_permute_b32 v186, v177, v20
    v_cvt_pk_bf16_f32 v122, v122, v123
    v_mfma_f32_16x16x32_bf16 v[126:129], a[236:239], v[170:173], v[126:129]
    v_mul_f32 v124, v178, v124
    v_mul_f32 v125, v178, v125
    v_cvt_pk_bf16_f32 v123, v124, v125
    v_mfma_f32_16x16x32_bf16 v[190:193], a[240:243], v[130:133], 0
    v_mul_f32 v154, v178, v154
    v_mul_f32 v155, v178, v155
    v_cvt_pk_bf16_f32 v124, v154, v155
    v_mfma_f32_16x16x32_bf16 v[190:193], a[244:247], v[134:137], v[190:193]
    v_mul_f32 v156, v178, v156
    v_mul_f32 v157, v178, v157
    v_cvt_pk_bf16_f32 v125, v156, v157
    v_mfma_f32_16x16x32_bf16 v[190:193], a[248:251], v[142:145], v[190:193]
    s_waitcnt lgkmcnt(4)
    ds_read_b128 v[154:157], v2 offset:6144
    v_mul_f32 v202, v178, v202
    v_mul_f32 v203, v178, v203
    v_mfma_f32_16x16x32_bf16 v[190:193], a[252:255], v[146:149], v[190:193]
    s_waitcnt lgkmcnt(3)
    ds_read_b128 v[194:197], v2 offset:7168
    v_cvt_pk_bf16_f32 v188, v202, v203
    v_mul_f32 v204, v178, v204
    v_mfma_f32_16x16x32_bf16 v[190:193], v[82:85], v[158:161], v[190:193]
    s_waitcnt lgkmcnt(2)
    ds_read_b128 v[198:201], v2 offset:8192
    v_mul_f32 v205, v178, v205
    v_cvt_pk_bf16_f32 v189, v204, v205
    v_mfma_f32_16x16x32_bf16 v[190:193], v[86:89], v[170:173], v[190:193]
    ds_read_b128 v[202:205], v2 offset:9216
    v_fma_f32 v177, v126, v126, s33
    v_fmac_f32 v177, v127, v127
    v_mfma_f32_16x16x32_bf16 v[206:209], v[90:93], v[130:133], 0
    ds_read_b128 v[130:133], v2 offset:10240
    v_fmac_f32 v177, v128, v128
    v_fmac_f32 v177, v129, v129
    v_mfma_f32_16x16x32_bf16 v[206:209], v[94:97], v[134:137], v[206:209]
    ds_read_b128 v[134:137], v2 offset:11264
    v_fmac_f32 v177, v190, v190
    v_fmac_f32 v177, v191, v191
    v_mfma_f32_16x16x32_bf16 v[206:209], v[98:101], v[142:145], v[206:209]
    s_waitcnt lgkmcnt(5)
    buffer_store_dwordx4 v[122:125], v15, s[12:15], s27 offen nt
    v_fmac_f32 v177, v192, v192
    v_fmac_f32 v177, v193, v193
    v_mul_f32 v187, 0x3baaaaab, v179
    v_mfma_f32_16x16x32_bf16 v[206:209], v[102:105], v[146:149], v[206:209]
    s_waitcnt lgkmcnt(4)
    v_rsq_f32 v187, v187
    v_sub_u32 v178, 0x40800000, v44
    v_mfma_f32_16x16x32_bf16 v[206:209], v[106:109], v[158:161], v[206:209]
    s_waitcnt lgkmcnt(3)
    v_mul_f32 v114, v187, v114
    v_mul_f32 v115, v187, v115
    v_cvt_pk_bf16_f32 v114, v114, v115
    v_mfma_f32_16x16x32_bf16 v[206:209], v[110:113], v[170:173], v[206:209]
    s_waitcnt lgkmcnt(2)
    v_mul_f32 v116, v187, v116
    v_mul_f32 v117, v187, v117
    v_cvt_pk_bf16_f32 v115, v116, v117
    v_mfma_f32_16x16x32_bf16 v[122:125], a[216:219], v[154:157], 0
    s_waitcnt lgkmcnt(1)
    v_mul_f32 v166, v187, v166
    v_mul_f32 v167, v187, v167
    v_fmac_f32 v177, v206, v206
    v_mfma_f32_16x16x32_bf16 v[122:125], a[220:223], v[194:197], v[122:125]
    s_waitcnt lgkmcnt(0)
    v_fmac_f32 v177, v207, v207
    v_fmac_f32 v177, v208, v208
    v_fmac_f32 v177, v209, v209
    v_mfma_f32_16x16x32_bf16 v[122:125], a[224:227], v[198:201], v[122:125]
    v_cvt_pk_bf16_f32 v116, v166, v167
    v_mul_f32 v168, v187, v168
    v_mul_f32 v169, v187, v169
    v_mfma_f32_16x16x32_bf16 v[122:125], a[228:231], v[202:205], v[122:125]
    v_cvt_pk_bf16_f32 v117, v168, v169
    v_mul_f32 v230, v187, v230
    v_mul_f32 v231, v187, v231
    v_mfma_f32_16x16x32_bf16 v[122:125], a[232:235], v[130:133], v[122:125]
    v_cvt_pk_bf16_f32 v230, v230, v231
    v_mul_f32 v232, v187, v232
    v_mul_f32 v233, v187, v233
    v_mfma_f32_16x16x32_bf16 v[122:125], a[236:239], v[134:137], v[122:125]
    v_cvt_pk_bf16_f32 v231, v232, v233
    v_or_b32 v178, v178, v44
    v_lshl_add_u32 v179, s16, 2, v176
    v_mfma_f32_16x16x32_bf16 v[142:145], a[240:243], v[154:157], 0
    ds_write_b32 v179, v178 offset:18432
    v_mul_f32 v187, 0x3baaaaab, v180
    v_mfma_f32_16x16x32_bf16 v[142:145], a[244:247], v[194:197], v[142:145]
    v_rsq_f32 v187, v187
    v_fma_f32 v232, v122, v122, s33
    v_mfma_f32_16x16x32_bf16 v[142:145], a[248:251], v[198:201], v[142:145]
    ds_read_b128 v[146:149], v2 offset:12288
    v_fmac_f32 v232, v123, v123
    v_fmac_f32 v232, v124, v124
    v_mfma_f32_16x16x32_bf16 v[142:145], a[252:255], v[202:205], v[142:145]
    ds_read_b128 v[158:161], v2 offset:13312
    v_fmac_f32 v232, v125, v125
    v_mul_f32 v150, v187, v150
    v_mfma_f32_16x16x32_bf16 v[142:145], v[82:85], v[130:133], v[142:145]
    ds_read_b128 v[166:169], v2 offset:14336
    v_mul_f32 v151, v187, v151
    v_cvt_pk_bf16_f32 v150, v150, v151
    v_mfma_f32_16x16x32_bf16 v[142:145], v[86:89], v[134:137], v[142:145]
    ds_read_b128 v[170:173], v2 offset:15360
    v_mul_f32 v152, v187, v152
    v_mul_f32 v153, v187, v153
    v_mfma_f32_16x16x32_bf16 v[210:213], v[90:93], v[154:157], 0
    ds_read_b128 v[154:157], v2 offset:16384
    v_cvt_pk_bf16_f32 v151, v152, v153
    v_mul_f32 v162, v187, v162
    v_mfma_f32_16x16x32_bf16 v[210:213], v[94:97], v[194:197], v[210:213]
    ds_read_b128 v[194:197], v2 offset:17408
    v_fmac_f32 v232, v142, v142
    v_fmac_f32 v232, v143, v143
    v_mfma_f32_16x16x32_bf16 v[210:213], v[98:101], v[198:201], v[210:213]
    s_waitcnt lgkmcnt(5)
    buffer_store_dwordx2 v[188:189], v18, s[12:15], s27 offen nt
    v_fmac_f32 v232, v144, v144
    v_mfma_f32_16x16x32_bf16 v[210:213], v[102:105], v[202:205], v[210:213]
    s_waitcnt lgkmcnt(4)
    v_fmac_f32 v232, v145, v145
    v_mul_f32 v163, v187, v163
    v_cvt_pk_bf16_f32 v152, v162, v163
    v_mfma_f32_16x16x32_bf16 v[210:213], v[106:109], v[130:133], v[210:213]
    s_waitcnt lgkmcnt(3)
    v_mul_f32 v164, v187, v164
    v_mul_f32 v165, v187, v165
    v_cvt_pk_bf16_f32 v153, v164, v165
    v_mfma_f32_16x16x32_bf16 v[210:213], v[110:113], v[134:137], v[210:213]
    s_waitcnt lgkmcnt(2)
    ds_write_b128 v118, v[150:153] offset:3072
    v_mfma_f32_16x16x32_bf16 v[130:133], a[216:219], v[146:149], 0
    s_waitcnt lgkmcnt(2)
    v_mul_f32 v138, v187, v138
    v_mul_f32 v139, v187, v139
    v_cvt_pk_bf16_f32 v138, v138, v139
    v_mfma_f32_16x16x32_bf16 v[130:133], a[220:223], v[158:161], v[130:133]
    s_waitcnt lgkmcnt(1)
    v_fmac_f32 v232, v210, v210
    v_fmac_f32 v232, v211, v211
    v_fmac_f32 v232, v212, v212
    v_mfma_f32_16x16x32_bf16 v[130:133], a[224:227], v[166:169], v[130:133]
    ds_read_b128 v[134:137], v120 offset:3072
    v_fmac_f32 v232, v213, v213
    v_cvt_pk_bf16_f32 v188, v177, v232
    v_mfma_f32_16x16x32_bf16 v[130:133], a[228:231], v[170:173], v[130:133]
    v_cvt_pk_bf16_f32 v189, v232, v232
    v_mul_f32 v140, v187, v140
    v_mul_f32 v141, v187, v141
    v_mfma_f32_16x16x32_bf16 v[130:133], a[232:235], v[154:157], v[130:133]
    ds_write_b64 v4, v[188:189] offset:0
    v_mfma_f32_16x16x32_bf16 v[130:133], a[236:239], v[194:197], v[130:133]
    v_cvt_pk_bf16_f32 v139, v140, v141
    v_mov_b32 v177, 0x40000000
    v_lshrrev_b32 v232, 2, v254
    v_mfma_f32_16x16x32_bf16 v[150:153], a[240:243], v[146:149], 0
    ds_write_b64 v119, v[138:139] offset:4096
    v_mfma_f32_16x16x32_bf16 v[150:153], a[244:247], v[158:161], v[150:153]
    v_lshrrev_b32 v233, 3, v254
    v_xor_b32 v233, v233, v254
    v_fma_f32 v254, v130, v130, s33
    v_mfma_f32_16x16x32_bf16 v[150:153], a[248:251], v[166:169], v[150:153]
    s_waitcnt lgkmcnt(2)
    ds_read_b128 v[138:141], v175 offset:0
    ds_read_b64 v[178:179], v121 offset:4096
    v_fmac_f32 v254, v131, v131
    v_mfma_f32_16x16x32_bf16 v[150:153], a[252:255], v[170:173], v[150:153]
    ds_read_b128 v[162:165], v175 offset:2048
    v_fmac_f32 v254, v132, v132
    v_fmac_f32 v254, v133, v133
    v_mfma_f32_16x16x32_bf16 v[150:153], v[82:85], v[154:157], v[150:153]
    s_waitcnt lgkmcnt(4)
    ds_read_b128 v[198:201], v175 offset:4096
    v_and_b32 v233, 3, v233
    v_add_u32 v180, 0, v232
    v_mfma_f32_16x16x32_bf16 v[150:153], v[86:89], v[194:197], v[150:153]
    s_barrier
    ds_read_b128 v[202:205], v176 offset:0
    ds_read_b128 v[214:217], v176 offset:1024
    v_mul_u32_u24 v232, s20, v180
    v_mfma_f32_16x16x32_bf16 v[218:221], v[90:93], v[146:149], 0
    ds_read_b128 v[146:149], v175 offset:6144
    ds_read_b128 v[222:225], v175 offset:8192
    v_add_u32 v232, s38, v232
    v_mfma_f32_16x16x32_bf16 v[218:221], v[94:97], v[158:161], v[218:221]
    ds_read_b128 v[158:161], v175 offset:10240
    v_fmac_f32 v254, v150, v150
    v_fmac_f32 v254, v151, v151
    v_mfma_f32_16x16x32_bf16 v[218:221], v[98:101], v[166:169], v[218:221]
    s_waitcnt lgkmcnt(7)
    buffer_store_dwordx4 v[114:117], v16, s[12:15], s27 offen nt
    ds_read_b128 v[166:169], v176 offset:18432
    v_fmac_f32 v254, v152, v152
    v_fmac_f32 v254, v153, v153
    v_mfma_f32_16x16x32_bf16 v[218:221], v[102:105], v[170:173], v[218:221]
    s_waitcnt lgkmcnt(7)
    v_mul_u32_u24 v187, 911, v232
    v_lshrrev_b32 v187, 16, v187
    v_mul_u32_u24 v187, s22, v187
    v_mfma_f32_16x16x32_bf16 v[218:221], v[106:109], v[154:157], v[218:221]
    s_waitcnt lgkmcnt(6)
    v_mad_u32_u24 v187, v180, s21, v187
    v_bfe_u32 v232, s63, v180, 1
    v_cmp_ne_u32 vcc, 0, v232
    v_mfma_f32_16x16x32_bf16 v[218:221], v[110:113], v[194:197], v[218:221]
    s_waitcnt lgkmcnt(4)
    v_add_u32 v180, s7, v187
    v_cndmask_b32 v180, v177, v180, vcc
    v_mfma_f32_16x16x32_bf16 v[114:117], v[32:35], v[202:205], 0
    s_waitcnt lgkmcnt(2)
    v_lshl_add_u32 v187, v233, 4, v180
    v_add_u32 v187, s3, v187
    v_mfma_f32_16x16x32_bf16 v[114:117], v[32:35], v[214:217], v[114:117]
    s_waitcnt lgkmcnt(1)
    v_fmac_f32 v254, v218, v218
    v_fmac_f32 v254, v219, v219
    v_fmac_f32 v254, v220, v220
    v_mfma_f32_16x16x32_bf16 v[154:157], a[216:219], v[138:141], 0
    v_fmac_f32 v254, v221, v221
    v_cvt_pk_bf16_f32 v188, v254, v254
    v_cvt_pk_bf16_f32 v189, v254, v254
    v_mfma_f32_16x16x32_bf16 v[154:157], a[220:223], v[162:165], v[154:157]
    s_waitcnt lgkmcnt(0)
    ds_write_b64 v4, v[188:189] offset:2048
    v_mfma_f32_16x16x32_bf16 v[154:157], a[224:227], v[198:201], v[154:157]
    v_lshl_add_u32 v254, v233, 3, v180
    v_add_u32 v254, s4, v254
    v_add_u32 v174, 16, v174
    v_mfma_f32_16x16x32_bf16 v[154:157], a[228:231], v[146:149], v[154:157]
    v_min_u32 v180, 20, v174
    v_add_u32 v116, 12, v174
    v_lshrrev_b32 v116, 5, v116
    v_mfma_f32_16x16x32_bf16 v[154:157], a[232:235], v[222:225], v[154:157]
    v_sub_u32 v117, v174, v180
    v_mad_i32_i24 v117, v116, s6, v117
    v_mul_u32_u24 v188, s20, v180
    v_mfma_f32_16x16x32_bf16 v[154:157], a[236:239], v[158:161], v[154:157]
    v_add3_u32 v188, v188, v117, s38
    v_mul_u32_u24 v116, 911, v188
    v_lshrrev_b32 v116, 16, v116
    v_mfma_f32_16x16x32_bf16 v[170:173], a[240:243], v[138:141], 0
    v_mul_u32_u24 v116, s22, v116
    v_mad_u32_u24 v116, v180, s21, v116
    v_bfe_u32 v188, s63, v174, 1
    v_mfma_f32_16x16x32_bf16 v[170:173], a[244:247], v[162:165], v[170:173]
    buffer_store_dwordx2 v[230:231], v19, s[12:15], s27 offen nt
    v_fma_f32 v180, v154, v154, s33
    v_mfma_f32_16x16x32_bf16 v[170:173], a[248:251], v[198:201], v[170:173]
    ds_read_b128 v[194:197], v175 offset:256
    v_fmac_f32 v180, v155, v155
    v_fmac_f32 v180, v156, v156
    v_mfma_f32_16x16x32_bf16 v[170:173], a[252:255], v[146:149], v[170:173]
    ds_read_b128 v[202:205], v175 offset:2304
    v_fmac_f32 v180, v157, v157
    v_cmp_ne_u32 vcc, 0, v188
    v_mfma_f32_16x16x32_bf16 v[170:173], v[82:85], v[222:225], v[170:173]
    ds_read_b128 v[214:217], v175 offset:4352
    v_mul_i32_i24 v117, 2688, v117
    v_add3_u32 v174, v116, v117, s7
    v_mfma_f32_16x16x32_bf16 v[170:173], v[86:89], v[158:161], v[170:173]
    ds_read_b128 v[226:229], v175 offset:6400
    v_cndmask_b32 v174, v177, v174, vcc
    v_lshl_add_u32 v188, v255, 4, v174
    v_mfma_f32_16x16x32_bf16 v[230:233], v[90:93], v[138:141], 0
    ds_read_b128 v[138:141], v175 offset:8448
    v_add_u32 v188, s3, v188
    v_lshl_add_u32 v255, v255, 3, v174
    v_mfma_f32_16x16x32_bf16 v[230:233], v[94:97], v[162:165], v[230:233]
    ds_read_b128 v[162:165], v175 offset:10496
    v_fmac_f32 v180, v170, v170
    v_fmac_f32 v180, v171, v171
    v_mfma_f32_16x16x32_bf16 v[230:233], v[98:101], v[198:201], v[230:233]
    s_waitcnt lgkmcnt(5)
    v_fmac_f32 v180, v172, v172
    v_fmac_f32 v180, v173, v173
    v_add_u32 v255, s4, v255
    v_mfma_f32_16x16x32_bf16 v[230:233], v[102:105], v[146:149], v[230:233]
    s_waitcnt lgkmcnt(4)
    v_mul_f32 v189, 0x3baaaaab, v114
    v_mul_f32 v174, 0x3baaaaab, v115
    v_rsq_f32 v189, v189
    v_mfma_f32_16x16x32_bf16 v[230:233], v[106:109], v[222:225], v[230:233]
    s_waitcnt lgkmcnt(3)
    v_mul_f32 v126, v189, v126
    v_mul_f32 v127, v189, v127
    v_cvt_pk_bf16_f32 v114, v126, v127
    v_mfma_f32_16x16x32_bf16 v[230:233], v[110:113], v[158:161], v[230:233]
    s_waitcnt lgkmcnt(2)
    v_mul_f32 v128, v189, v128
    v_mul_f32 v129, v189, v129
    v_cvt_pk_bf16_f32 v115, v128, v129
    v_mfma_f32_16x16x32_bf16 v[126:129], a[216:219], v[194:197], 0
    s_waitcnt lgkmcnt(1)
    v_mul_f32 v190, v189, v190
    v_mul_f32 v191, v189, v191
    v_fmac_f32 v180, v230, v230
    v_mfma_f32_16x16x32_bf16 v[126:129], a[220:223], v[202:205], v[126:129]
    s_waitcnt lgkmcnt(0)
    v_fmac_f32 v180, v231, v231
    v_fmac_f32 v180, v232, v232
    v_fmac_f32 v180, v233, v233
    v_mfma_f32_16x16x32_bf16 v[126:129], a[224:227], v[214:217], v[126:129]
    buffer_store_dwordx4 v[134:137], v185, s[12:15], s27 offen nt
    v_cvt_pk_bf16_f32 v146, v180, v180
    v_cvt_pk_bf16_f32 v147, v180, v180
    v_cvt_pk_bf16_f32 v116, v190, v191
    v_mfma_f32_16x16x32_bf16 v[126:129], a[228:231], v[226:229], v[126:129]
    ds_write_b64 v4, v[146:147] offset:4096
    v_mfma_f32_16x16x32_bf16 v[126:129], a[232:235], v[138:141], v[126:129]
    v_mul_f32 v192, v189, v192
    v_mul_f32 v193, v189, v193
    v_cvt_pk_bf16_f32 v117, v192, v193
    v_mfma_f32_16x16x32_bf16 v[126:129], a[236:239], v[162:165], v[126:129]
    ds_write_b128 v118, v[114:117] offset:4608
    v_mfma_f32_16x16x32_bf16 v[114:117], a[240:243], v[194:197], 0
    buffer_store_dwordx2 v[178:179], v186, s[12:15], s27 offen nt
    v_mul_f32 v206, v189, v206
    v_mfma_f32_16x16x32_bf16 v[114:117], a[244:247], v[202:205], v[114:117]
    s_mov_b32 s14, s36
    v_mul_f32 v207, v189, v207
    v_cvt_pk_bf16_f32 v206, v206, v207
    v_fma_f32 v175, v126, v126, s33
    v_mfma_f32_16x16x32_bf16 v[114:117], a[248:251], v[214:217], v[114:117]
    ds_read_b128 v[134:137], v120 offset:4608
    v_fmac_f32 v175, v127, v127
    v_fmac_f32 v175, v128, v128
    v_mfma_f32_16x16x32_bf16 v[114:117], a[252:255], v[226:229], v[114:117]
    s_waitcnt lgkmcnt(2)
    v_fmac_f32 v175, v129, v129
    v_mul_f32 v208, v189, v208
    v_mul_f32 v209, v189, v209
    v_mfma_f32_16x16x32_bf16 v[114:117], v[82:85], v[138:141], v[114:117]
    s_barrier
    ds_read_b128 v[146:149], v176 offset:2048
    ds_read_b128 v[158:161], v176 offset:3072
    v_cvt_pk_bf16_f32 v207, v208, v209
    v_mfma_f32_16x16x32_bf16 v[114:117], v[86:89], v[162:165], v[114:117]
    ds_read_b128 v[190:193], v176 offset:4096
    ds_read_b128 v[198:201], v176 offset:5120
    v_rsq_f32 v174, v174
    v_mfma_f32_16x16x32_bf16 v[222:225], v[90:93], v[194:197], 0
    ds_write_b64 v119, v[206:207] offset:5632
    v_mfma_f32_16x16x32_bf16 v[222:225], v[94:97], v[202:205], v[222:225]
    v_mul_f32 v122, v174, v122
    v_mul_f32 v123, v174, v123
    v_fmac_f32 v175, v114, v114
    v_mfma_f32_16x16x32_bf16 v[222:225], v[98:101], v[214:217], v[222:225]
    s_waitcnt lgkmcnt(5)
    buffer_store_dwordx4 v[134:137], v181, s[12:15], s26 offen nt
    ds_read_b64 v[178:179], v121 offset:5632
    v_fmac_f32 v175, v115, v115
    v_fmac_f32 v175, v116, v116
    v_mfma_f32_16x16x32_bf16 v[222:225], v[102:105], v[226:229], v[222:225]
    v_fmac_f32 v175, v117, v117
    v_cvt_pk_bf16_f32 v122, v122, v123
    v_mul_f32 v124, v174, v124
    v_mfma_f32_16x16x32_bf16 v[222:225], v[106:109], v[138:141], v[222:225]
    s_waitcnt lgkmcnt(4)
    v_mul_f32 v125, v174, v125
    v_cvt_pk_bf16_f32 v123, v124, v125
    v_mfma_f32_16x16x32_bf16 v[134:137], v[32:35], v[146:149], 0
    s_waitcnt lgkmcnt(2)
    v_mul_f32 v142, v174, v142
    v_mul_f32 v143, v174, v143
    v_mfma_f32_16x16x32_bf16 v[134:137], v[32:35], v[158:161], v[134:137]
    v_cvt_pk_bf16_f32 v124, v142, v143
    v_mul_f32 v144, v174, v144
    v_mfma_f32_16x16x32_bf16 v[138:141], v[32:35], v[190:193], 0
    v_mul_f32 v145, v174, v145
    v_cvt_pk_bf16_f32 v125, v144, v145
    v_mfma_f32_16x16x32_bf16 v[138:141], v[32:35], v[198:201], v[138:141]
    ds_write_b128 v118, v[122:125] offset:6144
    v_mfma_f32_16x16x32_bf16 v[222:225], v[110:113], v[162:165], v[222:225]
    s_waitcnt lgkmcnt(1)
    buffer_store_dwordx2 v[178:179], v182, s[12:15], s26 offen nt
    v_mul_f32 v210, v174, v210
    v_mul_f32 v211, v174, v211
    v_cvt_pk_bf16_f32 v210, v210, v211
    ds_read_b128 v[122:125], v120 offset:6144
    v_mul_f32 v212, v174, v212
    v_mul_f32 v213, v174, v213
    v_fmac_f32 v175, v222, v222
    v_fmac_f32 v175, v223, v223
    v_fmac_f32 v175, v224, v224
    v_fmac_f32 v175, v225, v225
    v_cvt_pk_bf16_f32 v174, v175, v175
    v_cvt_pk_bf16_f32 v175, v175, v175
    ds_write_b64 v4, v[174:175] offset:6144
    v_cvt_pk_bf16_f32 v211, v212, v213
    v_mul_f32 v189, 0x3baaaaab, v134
    v_rsq_f32 v189, v189
    ds_write_b64 v119, v[210:211] offset:7168
    v_mul_f32 v130, v189, v130
    v_mul_f32 v131, v189, v131
    v_cvt_pk_bf16_f32 v130, v130, v131
    ds_read_b64 v[140:141], v121 offset:7168
    s_waitcnt lgkmcnt(3)
    buffer_store_dwordx4 v[122:125], v183, s[12:15], s26 offen nt
    v_mul_f32 v132, v189, v132
    v_mul_f32 v133, v189, v133
    v_cvt_pk_bf16_f32 v131, v132, v133
    v_mul_f32 v150, v189, v150
    v_mul_f32 v151, v189, v151
    v_cvt_pk_bf16_f32 v132, v150, v151
    v_mul_f32 v152, v189, v152
    s_waitcnt lgkmcnt(2)
    s_barrier
    ds_read_b128 v[122:125], v176 offset:6144
    ds_read_b128 v[134:137], v176 offset:7168
    v_mul_f32 v153, v189, v153
    v_cvt_pk_bf16_f32 v133, v152, v153
    ds_write_b128 v118, v[130:133] offset:0
    v_mul_f32 v218, v189, v218
    v_mul_f32 v219, v189, v219
    v_cvt_pk_bf16_f32 v218, v218, v219
    v_mul_f32 v220, v189, v220
    s_waitcnt lgkmcnt(3)
    buffer_store_dwordx2 v[140:141], v184, s[12:15], s26 offen nt
    ds_read_b128 v[130:133], v120 offset:0
    v_mul_f32 v221, v189, v221
    v_cvt_pk_bf16_f32 v219, v220, v221
    ds_write_b64 v119, v[218:219] offset:1024
    s_waitcnt lgkmcnt(4)
    v_mfma_f32_16x16x32_bf16 v[142:145], v[32:35], v[122:125], 0
    s_waitcnt lgkmcnt(3)
    v_mul_f32 v189, 0x3baaaaab, v138
    v_or3_b32 v166, v166, v167, v168
    v_mfma_f32_16x16x32_bf16 v[142:145], v[32:35], v[134:137], v[142:145]
    ds_read_b64 v[182:183], v121 offset:1024
    v_rsq_f32 v189, v189
    v_or_b32 v166, v166, v169
    v_mul_f32 v154, v189, v154
    v_mul_f32 v155, v189, v155
    v_cvt_pk_bf16_f32 v122, v154, v155
    v_mul_f32 v156, v189, v156
    v_mul_f32 v157, v189, v157
    v_cvt_pk_bf16_f32 v123, v156, v157
    v_mul_f32 v170, v189, v170
    v_mul_f32 v171, v189, v171
    v_cvt_pk_bf16_f32 v124, v170, v171
    s_waitcnt lgkmcnt(2)
    buffer_store_dwordx4 v[130:133], v185, s[12:15], s26 offen nt
    v_mul_f32 v172, v189, v172
    v_mul_f32 v173, v189, v173
    v_cvt_pk_bf16_f32 v125, v172, v173
    ds_write_b128 v118, v[122:125] offset:1536
    v_mul_f32 v230, v189, v230
    s_waitcnt lgkmcnt(1)
    v_mul_f32 v231, v189, v231
    v_cvt_pk_bf16_f32 v184, v230, v231
    v_mul_f32 v232, v189, v232
    v_mul_f32 v233, v189, v233
    buffer_store_dwordx2 v[182:183], v186, s[12:15], s26 offen nt
    ds_read_b128 v[122:125], v120 offset:1536
    v_cvt_pk_bf16_f32 v185, v232, v233
    ds_write_b64 v119, v[184:185] offset:2560
    v_mul_f32 v186, 0x3baaaaab, v142
    v_rsq_f32 v186, v186
    ds_read_b64 v[168:169], v121 offset:2560
    v_mul_f32 v126, v186, v126
    v_mul_f32 v127, v186, v127
    v_cvt_pk_bf16_f32 v118, v126, v127
    v_mul_f32 v128, v186, v128
    v_mul_f32 v129, v186, v129
    v_cvt_pk_bf16_f32 v119, v128, v129
    v_mul_f32 v114, v186, v114
    v_mul_f32 v115, v186, v115
    v_cvt_pk_bf16_f32 v120, v114, v115
    v_mul_f32 v116, v186, v116
    v_mul_f32 v117, v186, v117
    v_cvt_pk_bf16_f32 v121, v116, v117
    buffer_store_dwordx4 v[118:121], v188, s[12:15], 0 offen nt
    s_waitcnt lgkmcnt(2)
    v_mul_f32 v222, v186, v222
    v_mul_f32 v223, v186, v223
    v_cvt_pk_bf16_f32 v188, v222, v223
    v_mul_f32 v224, v186, v224
    v_mul_f32 v225, v186, v225
    v_cvt_pk_bf16_f32 v189, v224, v225
    v_cmp_gt_i32 s[46:47], 0, v166
    s_waitcnt lgkmcnt(0)
    buffer_store_dwordx4 v[122:125], v187, s[12:15], 0 offen nt
    buffer_store_dwordx2 v[168:169], v254, s[12:15], 0 offen nt
    buffer_store_dwordx2 v[188:189], v255, s[12:15], 0 offen nt
    s_branch L_end
.section .rodata,"a"
.p2align 6
.amdhsa_kernel standalone__window_attn_swin_v2__vision_kernel
  .amdhsa_next_free_vgpr 512
  .amdhsa_next_free_sgpr 102
  .amdhsa_accum_offset 256
  .amdhsa_group_segment_fixed_size 0
  .amdhsa_kernarg_size 96
  .amdhsa_user_sgpr_count 2
  .amdhsa_user_sgpr_kernarg_segment_ptr 1
  .amdhsa_system_sgpr_workgroup_id_x 1
  .amdhsa_float_denorm_mode_32 3
.end_amdhsa_kernel
```

```asm
; @launch grid=(256,1,1) block=(256,1,1) lds=163840
.amdgcn_target "amdgcn-amd-amdhsa--gfx950"
.text
.globl standalone__window_attn_swin_v2__vision_kernel
.p2align 12
.p2align 8
.type standalone__window_attn_swin_v2__vision_kernel,@function
standalone__window_attn_swin_v2__vision_kernel:
    s_mov_b32 s44, 0
L_again:
    s_load_dwordx16 s[76:91], s[0:1], 0
    v_readfirstlane_b32 s16, v0
    s_cmp_ge_u32 s2, 256
    s_cbranch_scc1 L_done
    s_lshr_b32 s16, s16, 6
    s_cbranch_scc1 L_nopf
    s_getpc_b64 s[96:97]
    s_bfe_u32 s3, s2, 0x30003
    s_mul_i32 s3, s3, 44
    v_cmp_gt_u32 vcc, 20, v0
    v_add_u32 v114, s3, v0
    v_mov_b32 v115, 0
    v_cndmask_b32 v114, v114, v0, vcc
    v_lshlrev_b32 v114, 7, v114
    v_lshl_add_u64 v[114:115], s[96:97], 0, v[114:115]
    global_load_dword a255, v[114:115], off offset:992
L_nopf:
    s_max_u32 s3, s2, s44
    s_cmp_ge_u32 s3, 247
    s_cbranch_scc1 L_edge
    v_mov_b32 v114, v0
    v_mov_b32 v115, 0x40000000
    v_and_b32 v254, 63, v0
    s_bfe_u32 s3, s2, 0x50003
    s_lshl_b32 s4, s16, 3
    s_lshr_b32 s98, 0x06143a01, s4
    s_and_b32 s98, s98, 0xff
    s_mul_i32 s3, s3, s98
    s_sub_u32 s98, s98, 1
    s_lshr_b32 s4, 0x0048d800, s4
    s_and_b32 s4, s4, 0xff
    s_lshl_b32 s4, s4, 3
    s_max_u32 s4, s4, 6
    s_sub_u32 s4, s4, s98
    s_sub_u32 s4, s4, 1
    s_min_u32 s3, s3, s4
    v_min_u32 v126, s98, v254
    v_add_lshl_u32 v126, v126, s3, 7
    v_mov_b32 v127, 0
    v_lshrrev_b32 v255, 4, v254
    v_and_b32 v128, 15, v254
    s_mov_b32 s10, 100270464
    s_mov_b32 s11, 0x00020000
    s_mov_b32 s50, 36096
    s_mov_b32 s51, 0x00020000
    s_mul_i32 s3, s16, 96
    v_lshl_add_u32 v129, v254, 4, s3
    v_mul_u32_u24 v130, 171, v254
    v_lshrrev_b32 v130, 10, v130
    v_lshrrev_b32 v131, 1, v130
    v_xor_b32 v131, v131, v130
    v_and_b32 v131, 4, v131
    v_mul_u32_u24 v131, 3, v131
    v_xor_b32 v131, v131, v130
    v_mul_u32_u24 v131, 1152, v131
    v_mul_u32_u24 v132, 96, v130
    v_sub_u32 v131, v131, v132
    v_add_u32 v132, v129, v131
    v_add_u32 v131, 64, v254
    v_mul_u32_u24 v131, 171, v131
    v_lshrrev_b32 v131, 10, v131
    v_lshrrev_b32 v133, 1, v131
    v_xor_b32 v133, v133, v131
    v_and_b32 v133, 4, v133
    v_mul_u32_u24 v133, 3, v133
    v_xor_b32 v133, v133, v131
    v_mul_u32_u24 v133, 1152, v133
    v_mul_u32_u24 v150, 96, v131
    v_sub_u32 v133, v133, v150
    v_add_u32 v150, v129, v133
    v_add_u32 v133, 128, v254
    v_mul_u32_u24 v133, 171, v133
    v_lshrrev_b32 v133, 10, v133
    v_lshrrev_b32 v151, 1, v133
    v_xor_b32 v151, v151, v133
    v_and_b32 v151, 4, v151
    v_mul_u32_u24 v151, 3, v151
    v_xor_b32 v151, v151, v133
    v_mul_u32_u24 v151, 1152, v151
    v_mul_u32_u24 v152, 96, v133
    v_sub_u32 v151, v151, v152
    v_add_u32 v152, v129, v151
    s_mul_i32 s68, s16, 6144
    s_add_u32 s69, s68, 65536
    s_cmp_eq_u32 s16, 3
    s_cselect_b32 s68, 149696, s68
    s_cselect_b32 s69, 155840, s69
    s_waitcnt lgkmcnt(0)
    s_cmp_eq_u32 s16, 2
    s_cselect_b64 s[98:99], s[80:81], s[78:79]
    s_cmp_eq_u32 s16, 3
    s_cselect_b64 s[98:99], s[88:89], s[98:99]
    s_mov_b64 s[8:9], s[76:77]
    v_lshl_add_u64 v[126:127], s[98:99], 0, v[126:127]
    s_cmp_eq_u32 s16, 2
    s_cselect_b64 s[98:99], s[84:85], s[82:83]
    s_cmp_eq_u32 s16, 3
    s_cselect_b64 s[98:99], s[86:87], s[98:99]
    v_writelane_b32 v126, s98, 63
    v_writelane_b32 v127, s99, 63
    s_cmp_eq_u32 s16, 0
    s_cbranch_scc1 L_nowu
    global_load_dword a254, v[126:127], off
L_nowu:
    s_mov_b64 s[48:49], s[78:79]
    s_mov_b64 s[52:53], s[80:81]
    s_mov_b64 s[60:61], s[84:85]
    s_mov_b64 s[64:65], s[86:87]
    s_mov_b64 s[56:57], s[88:89]
    s_mov_b64 s[46:47], s[82:83]
    s_load_dwordx4 s[40:43], s[0:1], 72
    s_add_u32 s48, s48, 384
    s_addc_u32 s49, s49, 0
    s_add_u32 m0, s68, 0
    v_lshlrev_b32 v151, 1, v255
    s_mov_b32 s54, 12288
    s_mov_b32 s55, 0x00020000
    s_mov_b32 s62, 64
    s_mov_b32 s63, 0x00020000
    s_mov_b32 s66, 128
    s_mov_b32 s67, 0x00020000
    s_mov_b32 s58, 676
    s_mov_b32 s59, 0x00020000
    s_mov_b32 s14, 0
    s_mov_b32 s15, 0x00020000
    s_mul_i32 s90, s16, 16
    v_mov_b32 v117, 0
    v_cmp_lt_u32 s[92:93], 7, v128
    v_mov_b32 v127, 0
    v_mov_b32 v129, 0
    v_mov_b32 v119, 0
    v_lshlrev_b32 v153, 1, v254
    v_mul_u32_u24 v126, 12, v128
    s_mul_i32 s71, s16, 192
    v_add_u32 v126, s71, v126
    v_lshlrev_b32 v120, 5, v255
    s_mul_i32 s72, s16, 9408
    s_add_u32 s72, s72, 104448
    s_mul_i32 s73, s16, 7616
    s_add_u32 s73, s73, 38912
    s_cmp_eq_u32 s16, 3
    s_cselect_b32 s73, 142080, s73
    s_mov_b32 s70, 193536
    s_mov_b32 s36, 100270464
    s_mov_b32 s22, 1180032
    s_mul_i32 s3, s2, 911
    s_lshr_b32 s3, s3, 16
    s_mul_i32 s35, s3, 72
    s_sub_u32 s38, s2, s35
    s_mul_i32 s3, s3, 1373568
    s_mul_i32 s35, s38, 2688
    s_add_u32 s3, s3, s35
    s_add_u32 s25, s3, 589824
    s_add_u32 s7, s3, 1769472
    s_mov_b32 s20, 31
    s_mov_b32 s21, 4204032
    s_mov_b32 s17, 20
    s_cmp_lt_u32 s2, 240
    s_cselect_b32 s45, 28, 24
    s_bfm_b32 s34, s45, 0
    s_and_b32 s4, s2, 7
    s_sub_u32 s4, 0, s4
    s_lshl_b32 s28, s16, 10
    s_add_u32 s28, s28, 20480
    s_mov_b32 s76, 0x3f80
    s_mov_b32 s19, s38
    s_mov_b32 s23, s25
    s_mov_b32 s26, 0
    s_mov_b32 s27, 0
    s_mov_b32 s18, 0
    s_add_u32 s19, s19, s20
    s_add_u32 s23, s23, s21
    s_mul_i32 s79, s16, 64
    s_mul_i32 s80, s16, 32
    s_add_u32 s80, s80, 256
    s_mul_i32 s81, s16, 768
    s_add_u32 s81, s81, 98304
    s_mov_b32 s82, -24
    s_lshr_b32 s83, s16, 1
    s_and_b32 s84, s16, 1
    s_lshl_b32 s84, s84, 3
    s_lshl_b32 s85, s83, 10
    s_add_u32 s85, s85, s84
    s_lshl_b32 s83, s83, 11
    s_add_u32 s83, s83, s84
    s_add_u32 s83, s83, 157888
    s_mul_i32 s86, s16, 2048
    s_add_u32 s86, s86, 149696
    s_mul_i32 s87, s16, 128
    s_add_u32 s87, s87, 61760
    s_mov_b32 s32, 0x2a8cbccc
    s_mov_b32 s33, 0x38fba882
    s_add_u32 s75, s28, 16384
    s_cmp_lt_u32 s16, 2
    s_cselect_b32 s29, s75, 161984
    s_cselect_b32 s30, 65536, 0
    s_xor_b32 s74, s29, s30
    s_mul_i32 s77, s16, 64
    s_mul_i32 s78, s16, 32
    s_add_u32 s78, s78, 192
    s_mov_b32 s71, 1
    s_mov_b32 s27, s26
    s_mov_b32 s26, s25
    buffer_load_dwordx4 v132, s[48:51], 0 offen lds
    v_mul_u32_u24 v116, 2731, v114
    v_bfe_u32 v118, v116, 17, 3
    v_lshrrev_b32 v116, 16, v116
    buffer_load_dwordx4 v150, s[48:51], 0 offen offset:1024 lds
    v_xor_b32 v121, v118, v114
    v_mul_u32_u24 v118, 37, v116
    v_lshrrev_b32 v118, 8, v118
    buffer_load_dwordx4 v152, s[48:51], 0 offen offset:2048 lds
    s_add_u32 m0, s28, 65536
    s_add_u32 s48, s48, 36864
    s_addc_u32 s49, s49, 0
    v_lshlrev_b32 v121, 4, v121
    v_mad_u32_u24 v10, v118, s70, v121
    v_mul_u32_u24 v118, s20, v116
    v_add_u32 v118, s38, v118
    v_mul_u32_u24 v122, 911, v118
    v_lshrrev_b32 v122, 16, v122
    v_mul_u32_u24 v122, s22, v122
    v_mad_u32_u24 v122, v116, s21, v122
    v_bfe_u32 v118, s34, v116, 1
    v_cmp_ne_u32 vcc, 0, v118
    v_add_u32 v118, s7, v122
    v_mul_u32_u24 v116, 384, v116
    v_cndmask_b32 v118, v115, v118, vcc
    v_sub_u32 v116, v121, v116
    v_add_u32 v118, v118, v116
    buffer_load_dwordx4 v118, s[8:11], 0 offen nt lds
    s_add_u32 m0, s28, 69632
    v_add_u32 v116, 256, v114
    v_mul_u32_u24 v118, 2731, v116
    v_bfe_u32 v121, v118, 17, 3
    v_lshrrev_b32 v118, 16, v118
    v_xor_b32 v116, v121, v116
    v_mul_u32_u24 v121, 37, v118
    v_lshrrev_b32 v121, 8, v121
    v_lshlrev_b32 v116, 4, v116
    v_mad_u32_u24 v11, v121, s70, v116
    v_min_u32 v121, 20, v118
    v_add_u32 v122, 12, v118
    v_lshrrev_b32 v122, 5, v122
    v_sub_u32 v123, v118, v121
    v_mad_i32_i24 v123, v122, s4, v123
    v_mul_u32_u24 v124, s20, v121
    v_add3_u32 v124, v124, v123, s38
    v_mul_u32_u24 v122, 911, v124
    v_lshrrev_b32 v122, 16, v122
    v_mul_u32_u24 v122, s22, v122
    v_mad_u32_u24 v122, v121, s21, v122
    v_bfe_u32 v124, s34, v118, 1
    v_cmp_ne_u32 vcc, 0, v124
    v_mul_i32_i24 v123, 2688, v123
    v_add3_u32 v121, v122, v123, s7
    v_cndmask_b32 v121, v115, v121, vcc
    v_mul_u32_u24 v118, 384, v118
    v_sub_u32 v118, v116, v118
    v_add_u32 v121, v121, v118
    buffer_load_dwordx4 v121, s[8:11], 0 offen lds
    s_add_u32 m0, s28, 73728
    v_add_u32 v116, 512, v114
    v_mul_u32_u24 v118, 2731, v116
    v_bfe_u32 v121, v118, 17, 3
    v_lshrrev_b32 v118, 16, v118
    v_xor_b32 v116, v121, v116
    v_mul_u32_u24 v121, 37, v118
    v_lshrrev_b32 v121, 8, v121
    v_lshlrev_b32 v116, 4, v116
    v_mad_u32_u24 v12, v121, s70, v116
    v_min_u32 v121, 20, v118
    v_add_u32 v122, 12, v118
    v_lshrrev_b32 v122, 5, v122
    v_sub_u32 v123, v118, v121
    v_mad_i32_i24 v123, v122, s4, v123
    v_mul_u32_u24 v124, s20, v121
    v_add3_u32 v124, v124, v123, s38
    v_mul_u32_u24 v122, 911, v124
    v_lshrrev_b32 v122, 16, v122
    v_mul_u32_u24 v122, s22, v122
    v_mad_u32_u24 v122, v121, s21, v122
    v_bfe_u32 v124, s34, v118, 1
    v_cmp_ne_u32 vcc, 0, v124
    v_mul_i32_i24 v123, 2688, v123
    v_add3_u32 v121, v122, v123, s7
    v_cndmask_b32 v121, v115, v121, vcc
    v_mul_u32_u24 v118, 384, v118
    v_sub_u32 v118, v116, v118
    v_add_u32 v121, v121, v118
    s_cmp_ge_u32 s19, 72
    s_cselect_b32 s34, 72, 0
    s_cselect_b32 s35, s22, 0
    s_sub_u32 s19, s19, s34
    s_add_u32 s23, s23, s35
    s_mov_b32 s24, s23
    s_add_u32 s19, s19, s20
    s_add_u32 s23, s23, s21
    s_cmp_ge_u32 s19, 72
    s_cselect_b32 s34, 72, 0
    s_cselect_b32 s35, s22, 0
    s_sub_u32 s19, s19, s34
    s_add_u32 s23, s23, s35
    s_add_u32 s34, s18, 2
    s_mov_b32 s18, 1
    s_add_u32 s19, s19, s20
    buffer_load_dwordx4 v121, s[8:11], 0 offen lds
    s_add_u32 m0, s68, 3072
    v_lshrrev_b32 v116, 2, v128
    v_and_b32 v121, 1, v116
    v_mul_u32_u24 v121, 0x020202, v121
    v_lshl_or_b32 v121, v121, 8, v121
    v_add_u32 v121, 0x05040100, v121
    v_and_b32 v118, 3, v128
    v_lshrrev_b32 v122, 1, v128
    v_xor_b32 v122, v122, v255
    v_mul_u32_u24 v123, 384, v128
    v_lshl_add_u32 v0, v122, 4, v123
    v_xor_b32 v1, 64, v0
    v_and_b32 v122, 2, v255
    v_add_u32 v122, v122, v255
    v_lshl_add_u32 v122, v122, 2, v116
    v_mul_u32_u24 v122, 96, v122
    v_lshl_add_u32 v122, v118, 3, v122
    v_add_u32 v123, s68, v122
    buffer_load_dwordx4 v132, s[48:51], 0 offen lds
    v_add_u32 v124, s69, v122
    v_add_u32 v125, s72, v122
    v_add_u32 v122, s73, v122
    v_mov_b32 v28, 0x3f803f80
    v_mov_b32 v29, 0x3f803f80
    v_mov_b32 v30, 0x3f803f80
    v_mov_b32 v31, 0x3f803f80
    v_mul_u32_u24 v134, 768, v255
    v_add_u32 v134, v126, v134
    v_add_u32 v134, 98304, v134
    v_and_b32 v135, 1, v128
    v_lshlrev_b32 v135, 4, v135
    v_lshlrev_b32 v136, v135, s76
    v_mov_b32 v137, 0x3c003c00
    v_mov_b32 v44, 1.0
    v_lshlrev_b32 v138, 4, v255
    v_lshl_add_u32 v139, v255, 4, s79
    v_lshl_add_u32 v140, v255, 3, s80
    buffer_load_dwordx4 v150, s[48:51], 0 offen offset:1024 lds
    v_add_u32 v141, 0, v128
    v_mul_u32_u24 v142, 37, v141
    v_mul_u32_u24 v143, 384, v141
    v_lshrrev_b32 v142, 8, v142
    v_mad_u32_u24 v143, v142, s70, v143
    v_add_u32 v15, v143, v139
    v_add_u32 v18, v143, v140
    v_add_u32 v143, 16, v128
    v_mul_u32_u24 v144, 37, v143
    v_mul_u32_u24 v145, 384, v143
    v_lshrrev_b32 v144, 8, v144
    v_mad_u32_u24 v145, v144, s70, v145
    v_add_u32 v16, v145, v139
    v_add_u32 v19, v145, v140
    v_add_u32 v145, 32, v128
    v_mul_u32_u24 v146, 37, v145
    v_mul_u32_u24 v147, 384, v145
    v_lshrrev_b32 v146, 8, v146
    v_mad_u32_u24 v147, v146, s70, v147
    v_add_u32 v17, v147, v139
    v_add_u32 v20, v147, v140
    v_mul_u32_u24 v142, 24, v142
    v_lshl_add_u32 v142, v141, 2, v142
    v_add_u32 v22, s81, v142
    v_sub_u32 v23, s81, v142
    v_sub_u32 v139, v22, v138
    v_mul_u32_u24 v140, 24, v144
    v_lshl_add_u32 v140, v143, 2, v140
    v_add_u32 v24, s81, v140
    v_sub_u32 v25, s81, v140
    v_sub_u32 v140, v24, v138
    v_mul_u32_u24 v141, 24, v146
    v_lshl_add_u32 v141, v145, 2, v141
    v_add_u32 v26, s81, v141
    v_sub_u32 v27, s81, v141
    v_sub_u32 v141, v26, v138
    v_mul_u32_u24 v142, 148, v255
    v_add_u32 v143, 0, v142
    v_lshrrev_b32 v143, 8, v143
    v_mad_i32_i24 v46, v143, s82, v139
    v_mad_i32_i24 v58, v143, s82, v140
    v_mad_i32_i24 v70, v143, s82, v141
    v_add_u32 v143, 37, v142
    v_lshrrev_b32 v143, 8, v143
    v_mad_i32_i24 v47, v143, s82, v139
    v_mad_i32_i24 v59, v143, s82, v140
    v_mad_i32_i24 v71, v143, s82, v141
    v_add_u32 v143, 74, v142
    v_lshrrev_b32 v143, 8, v143
    v_mad_i32_i24 v48, v143, s82, v139
    v_mad_i32_i24 v60, v143, s82, v140
    buffer_load_dwordx4 v152, s[48:51], 0 offen offset:2048 lds
    s_add_u32 s48, s48, 36864
    s_addc_u32 s49, s49, 0
    s_add_u32 m0, s69, 0
    v_mad_i32_i24 v72, v143, s82, v141
    v_add_u32 v143, 111, v142
    v_lshrrev_b32 v143, 8, v143
    v_mad_i32_i24 v49, v143, s82, v139
    v_mad_i32_i24 v61, v143, s82, v140
    v_mad_i32_i24 v73, v143, s82, v141
    v_add_u32 v143, 592, v142
    v_lshrrev_b32 v143, 8, v143
    v_mad_i32_i24 v50, v143, s82, v139
    v_mad_i32_i24 v62, v143, s82, v140
    v_mad_i32_i24 v74, v143, s82, v141
    v_add_u32 v143, 629, v142
    v_lshrrev_b32 v143, 8, v143
    v_mad_i32_i24 v51, v143, s82, v139
    v_mad_i32_i24 v63, v143, s82, v140
    buffer_load_dwordx4 v132, s[48:51], 0 offen lds
    v_mad_i32_i24 v75, v143, s82, v141
    v_add_u32 v143, 666, v142
    v_lshrrev_b32 v143, 8, v143
    v_mad_i32_i24 v52, v143, s82, v139
    v_mad_i32_i24 v64, v143, s82, v140
    v_mad_i32_i24 v76, v143, s82, v141
    v_add_u32 v143, 703, v142
    v_lshrrev_b32 v143, 8, v143
    v_mad_i32_i24 v53, v143, s82, v139
    v_mad_i32_i24 v65, v143, s82, v140
    v_mad_i32_i24 v77, v143, s82, v141
    v_add_u32 v143, 1184, v142
    v_lshrrev_b32 v143, 8, v143
    s_waitcnt vmcnt(7)
    ds_read_b64_tr_b16 a[72:73], v123 offset:0
    ds_read_b64_tr_b16 a[74:75], v123 offset:768
    ds_read_b64_tr_b16 a[96:97], v123 offset:32
    ds_read_b64_tr_b16 a[98:99], v123 offset:800
    ds_read_b64_tr_b16 a[120:121], v123 offset:64
    buffer_load_dwordx4 v150, s[48:51], 0 offen offset:1024 lds
    ds_read_b64_tr_b16 a[122:123], v123 offset:832
    v_mad_i32_i24 v54, v143, s82, v139
    v_mad_i32_i24 v66, v143, s82, v140
    v_mad_i32_i24 v78, v143, s82, v141
    v_add_u32 v143, 1221, v142
    v_lshrrev_b32 v143, 8, v143
    v_mad_i32_i24 v55, v143, s82, v139
    v_mad_i32_i24 v67, v143, s82, v140
    v_mad_i32_i24 v79, v143, s82, v141
    v_add_u32 v143, 1258, v142
    v_lshrrev_b32 v143, 8, v143
    v_mad_i32_i24 v56, v143, s82, v139
    v_mad_i32_i24 v68, v143, s82, v140
    v_mad_i32_i24 v80, v143, s82, v141
    v_add_u32 v142, 1295, v142
    v_lshrrev_b32 v142, 8, v142
    v_mad_i32_i24 v57, v142, s82, v139
    v_mad_i32_i24 v69, v142, s82, v140
    buffer_load_dwordx4 v152, s[48:51], 0 offen offset:2048 lds
    s_add_u32 s48, s48, 36864
    s_addc_u32 s49, s49, 0
    s_add_u32 m0, s69, 3072
    v_mad_i32_i24 v81, v142, s82, v141
    v_mov_b32 v139, s81
    v_lshlrev_b32 v140, 4, v254
    v_xor_b32 v2, 65536, v140
    v_lshl_add_u32 v3, s16, 10, v140
    v_add_u32 v4, s85, v140
    v_lshl_add_u32 v140, v255, 3, s86
    v_mov_b32 v141, s83
    v_mov_b32 v142, 163264
    v_mul_u32_u24 v143, 80, v255
    v_add3_u32 v154, v143, v135, s72
    v_add_u32 v5, s72, v143
    v_lshl_add_u32 v6, v128, 2, s73
    v_add_u32 v9, s87, v138
    v_lshrrev_b32 v135, 1, v255
    v_mul_u32_u24 v135, 48, v135
    v_lshl_add_u32 v135, v255, 3, v135
    v_lshl_add_u32 v135, v116, 4, v135
    v_lshl_add_u32 v135, v118, 1, v135
    v_add_u32 v8, s87, v135
    v_mov_b32 v37, 0
    v_mov_b32 v38, 0
    v_mov_b32 v39, 0
    v_add_u32 v155, 86016, v0
    v_add_u32 v156, 86016, v1
    v_lshlrev_b32 v157, 4, v128
    v_add_u32 v157, 161984, v157
    v_mul_u32_u24 v135, 336, v128
    v_add3_u32 v135, v135, v143, s72
    v_mul_u32_u24 v143, 272, v128
    v_add3_u32 v143, v143, v138, s73
    v_mul_u32_u24 v158, 1088, v255
    v_add_u32 v158, v158, v6
    v_add_u32 v159, 5376, v135
    v_add_u32 v160, 4352, v143
    v_add_u32 v161, 4352, v158
    v_cmp_gt_u32 s[88:89], 16, v254
    v_mov_b32 v144, 0xf149f2ca
    v_add_u32 v145, 768, v114
    v_mul_u32_u24 v146, 2731, v145
    v_bfe_u32 v147, v146, 17, 3
    v_lshrrev_b32 v146, 16, v146
    v_xor_b32 v145, v147, v145
    v_mul_u32_u24 v147, 37, v146
    v_lshrrev_b32 v147, 8, v147
    v_lshlrev_b32 v145, 4, v145
    v_mad_u32_u24 v13, v147, s70, v145
    v_add_u32 v114, 1024, v114
    v_mul_u32_u24 v145, 2731, v114
    v_bfe_u32 v146, v145, 17, 3
    v_lshrrev_b32 v145, 16, v145
    v_xor_b32 v114, v146, v114
    v_mul_u32_u24 v146, 37, v145
    v_lshrrev_b32 v146, 8, v146
    v_lshlrev_b32 v114, 4, v114
    v_mad_u32_u24 v14, v146, s70, v114
    v_cmp_gt_u32 vcc, 48, v145
    v_mul_u32_u24 v145, 6, v130
    v_sub_u32 v114, v254, v145
    v_cndmask_b32 v14, v115, v14, vcc
    v_cmp_gt_u32 vcc, 2, v118
    v_mul_u32_u24 v145, 384, v130
    v_lshl_add_u32 v145, v114, 4, v145
    v_cndmask_b32 v32, 0, v136, vcc
    v_cndmask_b32 v33, v136, 0, vcc
    v_cndmask_b32 v34, 0, v136, vcc
    v_cndmask_b32 v35, v136, 0, vcc
    v_cmp_eq_u32 vcc, 0, v118
    v_add_u32 v115, s78, v145
    v_add_u32 v145, s77, v145
    v_cndmask_b32 v40, 0, v137, vcc
    v_cmp_eq_u32 vcc, 1, v118
    v_mul_u32_u24 v136, 6, v131
    v_sub_u32 v130, v254, v136
    v_cndmask_b32 v41, 0, v137, vcc
    v_cmp_eq_u32 vcc, 2, v118
    v_mul_u32_u24 v136, 384, v131
    v_lshl_add_u32 v136, v130, 4, v136
    v_cndmask_b32 v42, 0, v137, vcc
    v_cmp_eq_u32 vcc, 3, v118
    v_add_u32 v131, s78, v136
    v_add_u32 v136, s77, v136
    v_cndmask_b32 v43, 0, v137, vcc
    v_cmp_eq_u32 vcc, v255, v116
    v_mul_u32_u24 v137, 6, v133
    v_sub_u32 v254, v254, v137
    v_cndmask_b32 v162, 0, v32, vcc
    v_cndmask_b32 v163, 0, v33, vcc
    v_cmp_gt_i32 vcc, 4, v114
    v_mul_u32_u24 v137, 384, v133
    v_lshl_add_u32 v137, v254, 4, v137
    v_cndmask_b32 v164, v115, v145, vcc
    v_cmp_gt_i32 vcc, -60, v130
    v_add_u32 v145, s78, v137
    v_add_u32 v137, s77, v137
    v_cndmask_b32 v165, v131, v136, vcc
    v_cmp_gt_i32 vcc, -124, v254
    v_mul_u32_u24 v254, 96, v128
    v_add3_u32 v130, v254, v138, s68
    v_cndmask_b32 v131, v145, v137, vcc
    v_cmp_gt_u32 vcc, 2, v255
    v_lshl_add_u32 v133, v255, 3, v254
    v_add3_u32 v133, v133, 64, s68
    v_cndmask_b32 v140, v141, v140, vcc
    v_lshl_add_u32 v140, v116, 9, v140
    v_lshl_add_u32 v140, v118, 1, v140
    v_cmp_gt_u32 vcc, 3, v255
    v_add3_u32 v114, v254, v138, s69
    v_lshl_add_u32 v254, v255, 3, v254
    v_cndmask_b32 v7, v142, v140, vcc
    v_cmp_gt_u32 vcc, 12, v128
    v_add3_u32 v254, v254, 64, s69
    v_add_u32 v118, 16, v128
    v_cndmask_b32 v159, v157, v159, vcc
    v_cndmask_b32 v160, v157, v160, vcc
    v_cmp_gt_u32 vcc, 3, v255
    v_cmp_gt_u32 s[94:95], s45, v118
    v_cndmask_b32 v255, v157, v143, s[88:89]
    v_cndmask_b32 v161, v157, v161, vcc
    v_cndmask_b32 v157, v157, v160, s[88:89]
    v_add_u32 v5, 336, v5
    s_bfm_b32 s70, s17, 0
    s_and_b32 s77, s2, 0xf8
    s_add_u32 s77, s77, 4940
    s_mul_i32 s78, s77, 58255
    s_lshr_b32 s78, s78, 22
    buffer_load_dwordx4 v132, s[48:51], 0 offen lds
    buffer_load_dwordx4 v150, s[48:51], 0 offen offset:1024 lds
    buffer_load_dwordx4 v152, s[48:51], 0 offen offset:2048 lds
    s_waitcnt vmcnt(9)
    s_barrier
    ds_read_b128 v[146:149], v155 offset:6144
    ds_read_b128 v[166:169], v156 offset:6144
    ds_read_b128 v[170:173], v155 offset:6272
    s_add_u32 s48, s48, 36864
    s_addc_u32 s49, s49, 0
    ds_read_b128 v[174:177], v156 offset:6272
    s_add_u32 m0, s72, 0
    ds_read_b128 v[178:181], v155 offset:6400
    ds_read_b128 v[182:185], v156 offset:6400
    ds_read_b128 v[186:189], v155 offset:0
    buffer_load_ushort v116, v153, s[60:63], 0 offen
    s_mov_b64 s[60:61], s[8:9]
    s_sub_u32 s62, s45, s17
    ds_read_b128 v[190:193], v156 offset:0
    s_sub_u32 s45, s17, 1
    ds_read_b128 v[194:197], v155 offset:128
    ds_read_b128 v[198:201], v156 offset:128
    s_waitcnt lgkmcnt(7)
    v_mfma_f32_16x16x32_bf16 v[202:205], a[72:75], v[146:149], 0
    buffer_load_dwordx3 v[206:208], v126, s[56:59], 0 offen
    ds_read_b128 v[210:213], v155 offset:256
    v_mfma_f32_16x16x32_bf16 v[214:217], a[96:99], v[146:149], 0
    s_waitcnt lgkmcnt(7)
    ds_read_b128 v[218:221], v156 offset:256
    v_mfma_f32_16x16x32_bf16 v[222:225], a[120:123], v[146:149], 0
    s_waitcnt lgkmcnt(7)
    ds_read_b128 v[146:149], v156 offset:6400
    s_waitcnt lgkmcnt(6)
    v_mfma_f32_16x16x32_bf16 v[226:229], a[72:75], v[186:189], 0
    v_mfma_f32_16x16x32_bf16 v[230:233], a[96:99], v[186:189], 0
    s_waitcnt vmcnt(8)
    buffer_load_dwordx4 v[234:237], v120, s[64:67], 0 offen
    ds_read_b64_tr_b16 a[76:77], v123 offset:3072
    ds_read_b64_tr_b16 a[78:79], v123 offset:3840
    ds_read_b64_tr_b16 a[100:101], v123 offset:3104
    ds_read_b64_tr_b16 a[102:103], v123 offset:3872
    ds_read_b64_tr_b16 a[124:125], v123 offset:3136
    ds_read_b64_tr_b16 a[126:127], v123 offset:3904
    global_load_ushort v151, v151, s[46:47]
    s_waitcnt lgkmcnt(4)
    v_mfma_f32_16x16x32_bf16 v[202:205], a[76:79], v[166:169], v[202:205]
    s_waitcnt lgkmcnt(3)
    v_mfma_f32_16x16x32_bf16 v[226:229], a[76:79], v[190:193], v[226:229]
    s_waitcnt lgkmcnt(0)
    buffer_load_dwordx4 v132, s[48:51], 0 offen lds
    v_mfma_f32_16x16x32_bf16 v[214:217], a[100:103], v[166:169], v[214:217]
    v_mfma_f32_16x16x32_bf16 v[222:225], a[124:127], v[166:169], v[222:225]
    ds_read_b128 v[166:169], v155 offset:6144
    v_mfma_f32_16x16x32_bf16 v[230:233], a[100:103], v[190:193], v[230:233]
    s_waitcnt vmcnt(8)
    ds_read_b64_tr_b16 a[80:81], v124 offset:0
    ds_read_b64_tr_b16 a[82:83], v124 offset:768
    ds_read_b64_tr_b16 a[104:105], v124 offset:32
    ds_read_b64_tr_b16 a[106:107], v124 offset:800
    ds_read_b64_tr_b16 a[128:129], v124 offset:64
    ds_read_b64_tr_b16 a[130:131], v124 offset:832
    buffer_load_dwordx4 v150, s[48:51], 0 offen offset:1024 lds
    buffer_load_dwordx4 v152, s[48:51], 0 offen offset:2048 lds
    s_add_u32 s48, s48, 36864
    s_waitcnt lgkmcnt(4)
    v_mfma_f32_16x16x32_bf16 v[202:205], a[80:83], v[170:173], v[202:205]
    s_waitcnt lgkmcnt(2)
    s_addc_u32 s49, s49, 0
    s_add_u32 m0, s72, 3072
    v_mfma_f32_16x16x32_bf16 v[214:217], a[104:107], v[170:173], v[214:217]
    s_waitcnt lgkmcnt(0)
    s_mov_b32 s72, 2
    v_mfma_f32_16x16x32_bf16 v[222:225], a[128:131], v[170:173], v[222:225]
    ds_read_b128 v[170:173], v156 offset:6144
    v_mfma_f32_16x16x32_bf16 v[226:229], a[80:83], v[194:197], v[226:229]
    v_mfma_f32_16x16x32_bf16 v[230:233], a[104:107], v[194:197], v[230:233]
    buffer_load_dwordx4 v132, s[48:51], 0 offen lds
    s_waitcnt vmcnt(8)
    ds_read_b64_tr_b16 a[84:85], v124 offset:3072
    ds_read_b64_tr_b16 a[86:87], v124 offset:3840
    ds_read_b64_tr_b16 a[108:109], v124 offset:3104
    ds_read_b64_tr_b16 a[110:111], v124 offset:3872
    ds_read_b64_tr_b16 a[132:133], v124 offset:3136
    ds_read_b64_tr_b16 a[134:135], v124 offset:3904
    s_waitcnt vmcnt(6)
    v_bfe_u32 v126, v206, v138, 16
    v_bfe_u32 v128, v207, v138, 16
    v_bfe_u32 v118, v208, v138, 16
    buffer_load_dwordx4 v150, s[48:51], 0 offen offset:1024 lds
    s_waitcnt vmcnt(6)
    v_cndmask_b32 v234, v234, v235, s[92:93]
    v_mfma_f32_16x16x16_bf16 v[206:209], v[116:117], v[126:127], 0
    v_cndmask_b32 v236, v236, v237, s[92:93]
    v_perm_b32 v136, v236, v234, v121
    v_mfma_f32_16x16x16_bf16 v[234:237], v[116:117], v[128:129], 0
    s_waitcnt lgkmcnt(4)
    v_mfma_f32_16x16x32_bf16 v[202:205], a[84:87], v[174:177], v[202:205]
    s_waitcnt lgkmcnt(0)
    v_mfma_f32_16x16x32_bf16 v[214:217], a[108:111], v[174:177], v[214:217]
    buffer_load_dwordx4 v152, s[48:51], 0 offen offset:2048 lds
    s_waitcnt vmcnt(6)
    v_mfma_f32_16x16x32_bf16 v[222:225], a[132:135], v[174:177], v[222:225]
    s_sub_u32 s48, s48, 184704
    ds_read_b128 v[126:129], v155 offset:6272
    v_lshlrev_b32 v151, 16, v151
    v_mfma_f32_16x16x32_bf16 v[226:229], a[84:87], v[198:201], v[226:229]
    s_subb_u32 s49, s49, 0
    v_max_f32 v151, 0xc2c80000, v151
    v_min_f32 v151, 0x40930000, v151
    v_mfma_f32_16x16x32_bf16 v[230:233], a[108:111], v[198:201], v[230:233]
    s_add_u32 m0, s73, 0
    v_mul_f32 v151, 0x3fb8aa3b, v151
    v_exp_f32 v151, v151
    v_max_f32 v206, 0, v206
    v_cvt_pk_bf16_f32 v151, v151, v151
    v_and_b32 v151, 0xffff0000, v151
    v_mul_f32 v151, 0x3fb8aa3b, v151
    buffer_load_dwordx4 v132, s[48:51], 0 offen lds
    v_mul_f32 v153, 0xbea8f5c3, v151
    v_add_f32 v153, 0xc138aa3b, v153
    v_readlane_b32 s31, v151, s90
    v_max_f32 v207, 0, v207
    v_max_f32 v208, 0, v208
    v_max_f32 v209, 0, v209
    v_cvt_pk_bf16_f32 v140, v206, v207
    v_cvt_pk_bf16_f32 v141, v208, v209
    v_mfma_f32_16x16x16_bf16 v[174:177], v[116:117], v[118:119], 0
    v_max_f32 v234, 0, v234
    v_max_f32 v235, 0, v235
    v_max_f32 v236, 0, v236
    v_max_f32 v237, 0, v237
    v_mfma_f32_16x16x32_bf16 v[206:209], a[120:123], v[186:189], 0
    s_waitcnt lgkmcnt(0)
    ds_read_b128 v[186:189], v155 offset:0
    v_cvt_pk_bf16_f32 v118, v234, v235
    v_mfma_f32_16x16x32_bf16 v[206:209], a[124:127], v[190:193], v[206:209]
    ds_read_b128 v[190:193], v156 offset:0
    buffer_load_dwordx4 v150, s[48:51], 0 offen offset:1024 lds
    v_mfma_f32_16x16x32_bf16 v[206:209], a[128:131], v[194:197], v[206:209]
    ds_read_b128 v[194:197], v155 offset:128
    v_cvt_pk_bf16_f32 v119, v236, v237
    v_mfma_f32_16x16x32_bf16 v[206:209], a[132:135], v[198:201], v[206:209]
    ds_read_b128 v[198:201], v156 offset:256
    v_max_f32 v174, 0, v174
    v_max_f32 v175, 0, v175
    v_max_f32 v176, 0, v176
    v_max_f32 v177, 0, v177
    v_cvt_pk_bf16_f32 v116, v174, v175
    v_cvt_pk_bf16_f32 v117, v176, v177
    s_waitcnt vmcnt(5)
    ds_read_b64_tr_b16 a[88:89], v125 offset:0
    ds_read_b64_tr_b16 a[90:91], v125 offset:768
    buffer_load_dwordx4 v[174:177], v120, s[64:67], 0 offen offset:16
    ds_read_b64_tr_b16 a[112:113], v125 offset:32
    ds_read_b64_tr_b16 a[114:115], v125 offset:800
    ds_read_b64_tr_b16 a[136:137], v125 offset:64
    buffer_load_dwordx4 v152, s[48:51], 0 offen offset:2048 lds
    ds_read_b64_tr_b16 a[138:139], v125 offset:832
    s_add_u32 s48, s48, 36864
    s_addc_u32 s49, s49, 0
    s_add_u32 m0, s73, 3072
    s_mov_b32 s73, 3
    buffer_load_dwordx4 v132, s[48:51], 0 offen lds
    s_waitcnt lgkmcnt(4)
    v_mfma_f32_16x16x32_bf16 v[202:205], a[88:91], v[178:181], v[202:205]
    v_mfma_f32_16x16x32_bf16 v[226:229], a[88:91], v[210:213], v[226:229]
    s_waitcnt lgkmcnt(1)
    v_mfma_f32_16x16x32_bf16 v[214:217], a[112:115], v[178:181], v[214:217]
    s_waitcnt lgkmcnt(0)
    v_mfma_f32_16x16x32_bf16 v[222:225], a[136:139], v[178:181], v[222:225]
    ds_read_b128 v[178:181], v156 offset:6272
    v_mfma_f32_16x16x32_bf16 v[230:233], a[112:115], v[210:213], v[230:233]
    v_mfma_f32_16x16x32_bf16 v[206:209], a[136:139], v[210:213], v[206:209]
    buffer_load_dwordx4 v150, s[48:51], 0 offen offset:1024 lds
    ds_read_b128 v[210:213], v156 offset:128
    s_waitcnt vmcnt(6)
    ds_read_b64_tr_b16 a[92:93], v125 offset:3072
    ds_read_b64_tr_b16 a[94:95], v125 offset:3840
    ds_read_b64_tr_b16 a[116:117], v125 offset:3104
    ds_read_b64_tr_b16 a[118:119], v125 offset:3872
    ds_read_b64_tr_b16 a[140:141], v125 offset:3136
    ds_read_b64_tr_b16 a[142:143], v125 offset:3904
    buffer_load_dwordx4 v152, s[48:51], 0 offen offset:2048 lds
    s_add_u32 s48, s48, 36864
    s_addc_u32 s49, s49, 0
    s_add_u32 m0, s68, 0
    v_mov_b32 v234, 0
    v_mov_b32 v235, 0
    v_mov_b32 v236, 0
    v_mov_b32 v237, 0
    v_mov_b32 v238, v144
    v_mov_b32 v239, v144
    v_mov_b32 v240, v144
    v_mov_b32 v241, v144
    buffer_load_dwordx4 v132, s[48:51], 0 offen lds
    s_waitcnt lgkmcnt(4)
    v_mfma_f32_16x16x32_bf16 v[202:205], a[92:95], v[182:185], v[202:205]
    s_waitcnt lgkmcnt(3)
    v_mfma_f32_16x16x32_bf16 v[226:229], a[92:95], v[218:221], v[226:229]
    s_waitcnt lgkmcnt(0)
    v_mfma_f32_16x16x32_bf16 v[214:217], a[116:119], v[182:185], v[214:217]
    v_mfma_f32_16x16x32_bf16 v[222:225], a[140:143], v[182:185], v[222:225]
    v_mfma_f32_16x16x32_bf16 v[230:233], a[116:119], v[218:221], v[230:233]
    v_mfma_f32_16x16x32_bf16 v[206:209], a[140:143], v[218:221], v[206:209]
    buffer_load_dwordx4 v150, s[48:51], 0 offen offset:1024 lds
    v_cvt_pk_f16_f32 v182, v202, v203
    v_pk_mul_f16 v203, v182, v182
    v_cvt_pk_f16_f32 v183, v204, v205
    v_pk_fma_f16 v203, v183, v183, v203
    v_cvt_pk_f16_f32 v184, v214, v215
    ds_read_b128 v[218:221], v155 offset:6400
    v_pk_fma_f16 v203, v184, v184, v203
    v_cvt_pk_f16_f32 v185, v216, v217
    v_pk_fma_f16 v203, v185, v185, v203
    v_cvt_pk_f16_f32 v120, v222, v223
    s_waitcnt vmcnt(6)
    v_cndmask_b32 v174, v174, v175, s[92:93]
    v_cndmask_b32 v176, v176, v177, s[92:93]
    v_perm_b32 v137, v176, v174, v121
    ds_read_b128 v[174:177], v155 offset:256
    buffer_load_dwordx4 v152, s[48:51], 0 offen offset:2048 lds
    s_add_u32 s48, s48, 36864
    s_addc_u32 s49, s49, 0
    s_add_u32 m0, s68, 3072
    v_pk_fma_f16 v203, v120, v120, v203
    v_cvt_pk_f16_f32 v121, v224, v225
    v_pk_fma_f16 v203, v121, v121, v203
    v_cvt_pk_f16_f32 v214, v226, v227
    v_mfma_f32_16x16x16_bf16 v[222:225], v[136:137], v[140:141], 0
    v_pk_mul_f16 v227, v214, v214
    s_waitcnt vmcnt(6)
    v_cvt_pk_f16_f32 v215, v228, v229
    v_mfma_f32_16x16x16_bf16 v[242:245], v[136:137], v[118:119], 0
    v_pk_fma_f16 v227, v215, v215, v227
    v_cvt_pk_f16_f32 v216, v230, v231
    v_pk_fma_f16 v227, v216, v216, v227
    v_mfma_f32_16x16x16_bf16 v[246:249], v[136:137], v[116:117], 0
    ds_read_b64_tr_b16 a[0:1], v122 offset:0
    ds_read_b64_tr_b16 a[2:3], v122 offset:768
    ds_read_b64_tr_b16 a[24:25], v122 offset:32
    buffer_load_dwordx4 v132, s[48:51], 0 offen lds
    ds_read_b64_tr_b16 a[26:27], v122 offset:800
    ds_read_b64_tr_b16 a[48:49], v122 offset:64
    ds_read_b64_tr_b16 a[50:51], v122 offset:832
    v_cvt_pk_bf16_f32 v222, v222, v222
    v_and_b32 v222, 0xffff0000, v222
    v_mul_f32 v222, 0xbfb8aa3b, v222
    v_exp_f32 v222, v222
    v_cvt_pk_bf16_f32 v242, v242, v242
    v_add_f32 v222, 1.0, v222
    v_rcp_f32 v222, v222
    v_and_b32 v242, 0xffff0000, v242
    v_cvt_pk_bf16_f32 v222, v222, v222
    v_and_b32 v222, 0xffff0000, v222
    v_fmamk_f32 v222, v222, 0x41b8aa3b, v153
    ds_write_b32 v134, v222 offset:0
    buffer_load_dwordx4 v150, s[48:51], 0 offen offset:1024 lds
    v_mul_f32 v242, 0xbfb8aa3b, v242
    v_exp_f32 v242, v242
    v_cvt_pk_bf16_f32 v246, v246, v246
    s_waitcnt lgkmcnt(5)
    v_mfma_f32_16x16x32_bf16 v[222:225], a[0:3], v[166:169], 0
    s_waitcnt lgkmcnt(4)
    v_add_f32 v242, 1.0, v242
    v_and_b32 v246, 0xffff0000, v246
    v_mfma_f32_16x16x32_bf16 v[250:253], a[0:3], v[186:189], 0
    v_rcp_f32 v242, v242
    v_mul_f32 v246, 0xbfb8aa3b, v246
    v_cvt_pk_bf16_f32 v242, v242, v242
    v_and_b32 v242, 0xffff0000, v242
    v_fmamk_f32 v242, v242, 0x41b8aa3b, v153
    ds_write_b32 v134, v242 offset:4
    s_waitcnt vmcnt(5)
    s_waitcnt lgkmcnt(2)
    v_mfma_f32_16x16x32_bf16 v[242:245], a[24:27], v[166:169], 0
    buffer_load_dwordx4 v152, s[48:51], 0 offen offset:2048 lds
    s_add_u32 s48, s48, 36864
    ds_read_b64_tr_b16 a[4:5], v122 offset:3072
    ds_read_b64_tr_b16 a[6:7], v122 offset:3840
    ds_read_b64_tr_b16 a[28:29], v122 offset:3104
    ds_read_b64_tr_b16 a[30:31], v122 offset:3872
    ds_read_b64_tr_b16 a[52:53], v122 offset:3136
    ds_read_b64_tr_b16 a[54:55], v122 offset:3904
    ds_write_b128 v135, v[234:237] offset:16
    s_addc_u32 s49, s49, 0
    s_add_u32 m0, s69, 0
    v_exp_f32 v246, v246
    v_cvt_pk_f16_f32 v217, v232, v233
    v_add_f32 v246, 1.0, v246
    buffer_load_dwordx4 v132, s[48:51], 0 offen lds
    ds_write_b64 v135, v[234:235] offset:56
    v_rcp_f32 v246, v246
    v_pk_fma_f16 v227, v217, v217, v227
    v_cvt_pk_bf16_f32 v246, v246, v246
    v_and_b32 v246, 0xffff0000, v246
    v_fmamk_f32 v246, v246, 0x41b8aa3b, v153
    s_waitcnt lgkmcnt(6)
    v_mfma_f32_16x16x32_bf16 v[222:225], a[4:7], v[170:173], v[222:225]
    s_waitcnt lgkmcnt(4)
    ds_write_b32 v134, v246 offset:8
    v_mfma_f32_16x16x32_bf16 v[242:245], a[28:31], v[170:173], v[242:245]
    s_waitcnt lgkmcnt(2)
    v_cvt_pk_f16_f32 v140, v206, v207
    v_pk_fma_f16 v227, v140, v140, v227
    v_mfma_f32_16x16x32_bf16 v[230:233], a[48:51], v[166:169], 0
    buffer_load_dwordx4 v150, s[48:51], 0 offen offset:1024 lds
    v_cvt_pk_f16_f32 v141, v208, v209
    v_mfma_f32_16x16x32_bf16 v[230:233], a[52:55], v[170:173], v[230:233]
    ds_write_b64 v135, v[234:235] offset:64
    v_mfma_f32_16x16x32_bf16 v[250:253], a[4:7], v[190:193], v[250:253]
    v_pk_fma_f16 v227, v141, v141, v227
    v_mfma_f32_16x16x32_bf16 v[166:169], a[24:27], v[186:189], 0
    ds_write_b128 v159, v[234:237] offset:16
    s_waitcnt vmcnt(5)
    v_mfma_f32_16x16x32_bf16 v[166:169], a[28:31], v[190:193], v[166:169]
    s_waitcnt lgkmcnt(2)
    buffer_load_dwordx4 v152, s[48:51], 0 offen offset:2048 lds
    s_add_u32 s48, s48, 36864
    v_mfma_f32_16x16x32_bf16 v[170:173], a[48:51], v[186:189], 0
    s_barrier
    s_addc_u32 s49, s49, 0
    s_add_u32 m0, s69, 3072
    v_mfma_f32_16x16x32_bf16 v[170:173], a[52:55], v[190:193], v[170:173]
    ds_read_b64_tr_b16 a[8:9], v123 offset:0
    ds_read_b64_tr_b16 a[10:11], v123 offset:768
    ds_read_b64_tr_b16 a[32:33], v123 offset:32
    ds_read_b64_tr_b16 a[34:35], v123 offset:800
    ds_read_b64_tr_b16 a[56:57], v123 offset:64
    ds_read_b64_tr_b16 a[58:59], v123 offset:832
    ds_read_b32 v22, v22 offset:0
    ds_read_b32 v23, v23 offset:672
    ds_read_b32 v24, v24 offset:0
    ds_read_b32 v25, v25 offset:672
    buffer_load_dwordx4 v132, s[48:51], 0 offen lds
    ds_read_b32 v26, v26 offset:0
    ds_read_b32 v27, v27 offset:672
    ds_read_b32 v46, v46 offset:336
    ds_read_b32 v58, v58 offset:336
    ds_read_b32 v70, v70 offset:336
    ds_read_b32 v47, v47 offset:332
    ds_read_b32 v59, v59 offset:332
    ds_read_b32 v71, v71 offset:332
    ds_read_b32 v48, v48 offset:328
    s_waitcnt lgkmcnt(15)
    v_mfma_f32_16x16x32_bf16 v[222:225], a[8:11], v[126:129], v[222:225]
    s_waitcnt lgkmcnt(14)
    buffer_load_dwordx4 v150, s[48:51], 0 offen offset:1024 lds
    ds_read_b32 v60, v60 offset:328
    v_mfma_f32_16x16x32_bf16 v[242:245], a[32:35], v[126:129], v[242:245]
    s_waitcnt lgkmcnt(12)
    ds_read_b32 v72, v72 offset:328
    ds_read_b32 v49, v49 offset:324
    v_mfma_f32_16x16x32_bf16 v[230:233], a[56:59], v[126:129], v[230:233]
    s_waitcnt lgkmcnt(12)
    ds_read_b32 v61, v61 offset:324
    ds_read_b32 v73, v73 offset:324
    v_mfma_f32_16x16x32_bf16 v[250:253], a[8:11], v[194:197], v[250:253]
    s_waitcnt lgkmcnt(12)
    ds_read_b32 v50, v50 offset:272
    ds_read_b32 v62, v62 offset:272
    v_mfma_f32_16x16x32_bf16 v[166:169], a[32:35], v[194:197], v[166:169]
    s_waitcnt lgkmcnt(12)
    ds_read_b32 v74, v74 offset:272
    ds_read_b32 v51, v51 offset:268
    v_mfma_f32_16x16x32_bf16 v[170:173], a[56:59], v[194:197], v[170:173]
    s_waitcnt lgkmcnt(12)
    ds_read_b32 v63, v63 offset:268
    s_waitcnt vmcnt(5)
    buffer_load_dwordx4 v152, s[48:51], 0 offen offset:2048 lds
    ds_read_b64_tr_b16 a[12:13], v123 offset:3072
    ds_read_b64_tr_b16 a[14:15], v123 offset:3840
    ds_read_b64_tr_b16 a[36:37], v123 offset:3104
    ds_read_b64_tr_b16 a[38:39], v123 offset:3872
    ds_read_b64_tr_b16 a[60:61], v123 offset:3136
    ds_read_b64_tr_b16 a[62:63], v123 offset:3904
    s_add_u32 m0, s28, 0
    ds_read_b32 v75, v75 offset:268
    s_sub_u32 s48, s48, 183552
    ds_read_b32 v52, v52 offset:264
    s_subb_u32 s49, s49, 0
    ds_read_b32 v64, v64 offset:264
    ds_read_b32 v76, v76 offset:264
    ds_read_b32 v53, v53 offset:260
    ds_read_b32 v65, v65 offset:260
    buffer_load_dwordx4 v10, s[8:11], s25 offen nt lds
    ds_read_b32 v77, v77 offset:260
    ds_read_b32 v54, v54 offset:208
    ds_read_b32 v66, v66 offset:208
    s_add_u32 m0, s28, 4096
    ds_read_b32 v78, v78 offset:208
    ds_read_b32 v55, v55 offset:204
    ds_read_b32 v67, v67 offset:204
    s_waitcnt lgkmcnt(15)
    v_mfma_f32_16x16x32_bf16 v[222:225], a[12:15], v[178:181], v[222:225]
    s_waitcnt lgkmcnt(13)
    ds_read_b32 v79, v79 offset:204
    ds_read_b32 v56, v56 offset:200
    v_mfma_f32_16x16x32_bf16 v[242:245], a[36:39], v[178:181], v[242:245]
    s_waitcnt lgkmcnt(13)
    ds_read_b32 v68, v68 offset:200
    ds_read_b32 v80, v80 offset:200
    v_mfma_f32_16x16x32_bf16 v[230:233], a[60:63], v[178:181], v[230:233]
    s_waitcnt lgkmcnt(13)
    buffer_load_dwordx4 v11, s[8:11], s25 offen nt lds
    v_mfma_f32_16x16x32_bf16 v[250:253], a[12:15], v[210:213], v[250:253]
    s_add_u32 m0, s28, 8192
    ds_read_b32 v57, v57 offset:196
    ds_read_b32 v69, v69 offset:196
    v_mfma_f32_16x16x32_bf16 v[166:169], a[36:39], v[210:213], v[166:169]
    s_waitcnt lgkmcnt(12)
    ds_read_b32 v81, v81 offset:196
    ds_read_b32 v139, v139 offset:336
    v_mfma_f32_16x16x32_bf16 v[170:173], a[60:63], v[210:213], v[170:173]
    s_waitcnt lgkmcnt(11)
    ds_write_b64 v159, v[234:235] offset:56
    v_cndmask_b32 v22, v144, v22, s[88:89]
    v_cndmask_b32 v24, v144, v24, s[88:89]
    v_mov_b32_dpp v23, v25 quad_perm:[0,1,2,3] row_mask:0x2 bank_mask:0xf
    v_cndmask_b32 v26, v144, v26, s[88:89]
    buffer_load_dwordx4 v12, s[8:11], s25 offen nt lds
    s_waitcnt vmcnt(6)
    ds_read_b64_tr_b16 a[16:17], v124 offset:0
    ds_read_b64_tr_b16 a[18:19], v124 offset:768
    ds_read_b64_tr_b16 a[40:41], v124 offset:32
    ds_read_b64_tr_b16 a[42:43], v124 offset:800
    ds_read_b64_tr_b16 a[64:65], v124 offset:64
    ds_read_b64_tr_b16 a[66:67], v124 offset:832
    ds_write_b64 v159, v[234:235] offset:64
    s_add_u32 m0, s28, 12288
    v_mov_b32_dpp v23, v27 quad_perm:[0,1,2,3] row_mask:0x4 bank_mask:0xf
    s_waitcnt lgkmcnt(8)
    v_readfirstlane_b32 s39, v139
    ds_write_b128 v143, v[238:241] offset:192
    buffer_load_dwordx4 v13, s[8:11], s25 offen nt lds
    s_add_u32 m0, s29, 0
    s_nop 0
    s_waitcnt lgkmcnt(6)
    v_mfma_f32_16x16x32_bf16 v[222:225], a[16:19], v[218:221], v[222:225]
    s_waitcnt lgkmcnt(5)
    ds_write_b128 v160, v[238:241] offset:192
    v_mfma_f32_16x16x32_bf16 v[250:253], a[16:19], v[174:177], v[250:253]
    s_waitcnt lgkmcnt(2)
    v_mfma_f32_16x16x32_bf16 v[242:245], a[40:43], v[218:221], v[242:245]
    buffer_load_dwordx4 v14, s[8:11], s25 offen nt lds
    v_mfma_f32_16x16x32_bf16 v[230:233], a[64:67], v[218:221], v[230:233]
    s_add_u32 m0, s68, 0
    s_lshr_b32 s10, s17, 1
    s_cselect_b32 s10, s36, 0
    v_mfma_f32_16x16x32_bf16 v[166:169], a[40:43], v[174:177], v[166:169]
    s_mov_b32 s25, s24
    v_mfma_f32_16x16x32_bf16 v[170:173], a[64:67], v[174:177], v[170:173]
    s_waitcnt vmcnt(5)
    ds_read_b64_tr_b16 a[20:21], v124 offset:3072
    ds_read_b64_tr_b16 a[22:23], v124 offset:3840
    ds_read_b64_tr_b16 a[44:45], v124 offset:3104
    buffer_load_dwordx4 v132, s[48:51], 0 offen lds
    ds_read_b64_tr_b16 a[46:47], v124 offset:3872
    ds_read_b64_tr_b16 a[68:69], v124 offset:3136
    ds_read_b64_tr_b16 a[70:71], v124 offset:3904
    buffer_load_dwordx4 v150, s[48:51], 0 offen offset:1024 lds
    s_waitcnt lgkmcnt(4)
    v_mfma_f32_16x16x32_bf16 v[222:225], a[20:23], v[146:149], v[222:225]
    s_waitcnt lgkmcnt(3)
    v_mfma_f32_16x16x32_bf16 v[250:253], a[20:23], v[198:201], v[250:253]
    s_waitcnt lgkmcnt(0)
    v_mfma_f32_16x16x32_bf16 v[242:245], a[44:47], v[146:149], v[242:245]
    v_mfma_f32_16x16x32_bf16 v[230:233], a[68:71], v[146:149], v[230:233]
    v_mov_b32 v205, 0
    v_mfma_f32_16x16x32_bf16 v[166:169], a[44:47], v[198:201], v[166:169]
    buffer_load_dwordx4 v152, s[48:51], 0 offen offset:2048 lds
    v_cvt_pk_f16_f32 v126, v222, v223
    v_mfma_f32_16x16x32_bf16 v[170:173], a[68:71], v[198:201], v[170:173]
    s_add_u32 s48, s48, 36864
    s_addc_u32 s49, s49, 0
    s_add_u32 m0, s68, 3072
    v_pk_mul_f16 v202, v126, v126
    v_cvt_pk_f16_f32 v127, v224, v225
    v_pk_fma_f16 v202, v127, v127, v202
    v_cvt_pk_f16_f32 v128, v242, v243
    v_pk_fma_f16 v202, v128, v128, v202
    v_cvt_pk_f16_f32 v129, v244, v245
    v_pk_fma_f16 v202, v129, v129, v202
    v_cvt_pk_f16_f32 v118, v230, v231
    v_pk_fma_f16 v202, v118, v118, v202
    v_cvt_pk_f16_f32 v119, v232, v233
    v_pk_fma_f16 v202, v119, v119, v202
    v_pk_mul_f16 v204, v126, v182
    v_pk_fma_f16 v204, v127, v183, v204
    buffer_load_dwordx4 v132, s[48:51], 0 offen lds
    v_pk_fma_f16 v204, v128, v184, v204
    v_pk_fma_f16 v204, v129, v185, v204
    v_pk_fma_f16 v204, v118, v120, v204
    v_pk_fma_f16 v204, v119, v121, v204
    v_cvt_pk_f16_f32 v142, v250, v251
    v_pk_mul_f16 v226, v142, v142
    v_mfma_f32_16x16x32_f16 v[146:149], v[40:43], v[202:205], 0
    v_cvt_pk_f16_f32 v143, v252, v253
    v_pk_fma_f16 v226, v143, v143, v226
    v_cvt_pk_f16_f32 v144, v166, v167
    v_pk_fma_f16 v226, v144, v144, v226
    v_cvt_pk_f16_f32 v145, v168, v169
    v_pk_fma_f16 v226, v145, v145, v226
    v_cvt_pk_f16_f32 v138, v170, v171
    v_pk_fma_f16 v226, v138, v138, v226
    v_rsq_f32 v146, v146
    v_rsq_f32 v147, v147
    v_mul_f32 v170, s31, v146
    v_cvt_pk_f16_f32 v171, v170, v147
    v_pk_mul_f16 v182, v182, v171 op_sel:[0,1] op_sel_hi:[1,1]
    v_pk_mul_f16 v183, v183, v171 op_sel:[0,1] op_sel_hi:[1,1]
    v_pk_mul_f16 v184, v184, v171 op_sel:[0,1] op_sel_hi:[1,1]
    v_pk_mul_f16 v185, v185, v171 op_sel:[0,1] op_sel_hi:[1,1]
    v_pk_mul_f16 v120, v120, v171 op_sel:[0,1] op_sel_hi:[1,1]
    v_pk_mul_f16 v121, v121, v171 op_sel:[0,1] op_sel_hi:[1,1]
    v_pk_mul_f16 v126, v126, v171 op_sel:[0,0] op_sel_hi:[1,0]
    v_pk_mul_f16 v127, v127, v171 op_sel:[0,0] op_sel_hi:[1,0]
    v_pk_mul_f16 v128, v128, v171 op_sel:[0,0] op_sel_hi:[1,0]
    v_pk_mul_f16 v129, v129, v171 op_sel:[0,0] op_sel_hi:[1,0]
    v_pk_mul_f16 v118, v118, v171 op_sel:[0,0] op_sel_hi:[1,0]
    v_pk_mul_f16 v119, v119, v171 op_sel:[0,0] op_sel_hi:[1,0]
    v_cndmask_b32 v146, 1.0, v146, s[94:95]
    v_cndmask_b32 v147, 1.0, v147, s[94:95]
    v_max3_u32 v44, v44, v146, v147
    v_mul_f32 v139, v148, v170
    v_fma_f32 v139, v139, v147, s39
    ds_write_b32 v157, v139 offset:192
    v_cvt_pk_f16_f32 v139, v172, v173
    v_pk_fma_f16 v226, v139, v139, v226
    v_pk_mul_f16 v228, v142, v214
    v_pk_fma_f16 v228, v143, v215, v228
    ds_write_b128 v159, v[182:185]
    v_pk_fma_f16 v228, v144, v216, v228
    v_pk_fma_f16 v228, v145, v217, v228
    v_pk_fma_f16 v228, v138, v140, v228
    v_pk_fma_f16 v228, v139, v141, v228
    v_mov_b32 v229, 0
    s_nop 0
    s_nop 0
    v_mfma_f32_16x16x32_f16 v[146:149], v[40:43], v[226:229], 0
    ds_write_b64 v159, v[120:121] offset:48
    s_nop 0
    s_nop 0
    s_nop 0
    ds_write_b128 v159, v[126:129] offset:32
    s_nop 0
    s_nop 0
    s_nop 0
    v_rsq_f32 v146, v146
    v_rsq_f32 v147, v147
    ds_write_b64 v159, v[118:119] offset:72
    v_mul_f32 v116, s31, v146
    v_cvt_pk_f16_f32 v117, v116, v147
    v_pk_mul_f16 v214, v214, v117 op_sel:[0,1] op_sel_hi:[1,1]
    v_pk_mul_f16 v215, v215, v117 op_sel:[0,1] op_sel_hi:[1,1]
    v_pk_mul_f16 v216, v216, v117 op_sel:[0,1] op_sel_hi:[1,1]
    v_pk_mul_f16 v217, v217, v117 op_sel:[0,1] op_sel_hi:[1,1]
    v_pk_mul_f16 v140, v140, v117 op_sel:[0,1] op_sel_hi:[1,1]
    v_pk_mul_f16 v141, v141, v117 op_sel:[0,1] op_sel_hi:[1,1]
    v_pk_mul_f16 v142, v142, v117 op_sel:[0,0] op_sel_hi:[1,0]
    v_pk_mul_f16 v143, v143, v117 op_sel:[0,0] op_sel_hi:[1,0]
    v_pk_mul_f16 v144, v144, v117 op_sel:[0,0] op_sel_hi:[1,0]
    v_pk_mul_f16 v145, v145, v117 op_sel:[0,0] op_sel_hi:[1,0]
    v_pk_mul_f16 v138, v138, v117 op_sel:[0,0] op_sel_hi:[1,0]
    v_pk_mul_f16 v139, v139, v117 op_sel:[0,0] op_sel_hi:[1,0]
    v_max3_u32 v44, v44, v146, v147
    v_mul_f32 v157, v148, v116
    v_fma_f32 v157, v157, v147, s39
    ds_write_b32 v255, v157 offset:192
    buffer_load_dwordx4 v150, s[48:51], 0 offen offset:1024 lds
    ds_write_b128 v135, v[214:217]
    buffer_load_dwordx4 v152, s[48:51], 0 offen offset:2048 lds
    ds_write_b64 v135, v[140:141] offset:48
    s_add_u32 s48, s48, 36864
    s_addc_u32 s49, s49, 0
    s_add_u32 m0, s69, 0
    ds_write_b128 v135, v[142:145] offset:32
    buffer_load_dwordx4 v132, s[48:51], 0 offen lds
    ds_write_b64 v135, v[138:139] offset:72
    buffer_load_dwordx4 v150, s[48:51], 0 offen offset:1024 lds
    buffer_load_dwordx4 v152, s[48:51], 0 offen offset:2048 lds
    s_waitcnt vmcnt(9)
    s_barrier
    ds_read_b128 v[126:129], v0 offset:20480
    ds_read_b128 v[170:173], v1 offset:20480
    ds_read_b128 v[174:177], v0 offset:20608
    s_add_u32 s48, s48, 36864
    s_addc_u32 s49, s49, 0
    ds_read_b128 v[178:181], v1 offset:20608
    s_add_u32 m0, s69, 3072
    ds_read_b128 v[182:185], v0 offset:20736
    ds_read_b128 v[186:189], v1 offset:20736
    buffer_load_dwordx4 v132, s[48:51], 0 offen lds
    s_waitcnt lgkmcnt(5)
    v_mfma_f32_16x16x32_bf16 v[118:121], a[72:75], v[126:129], 0
    s_waitcnt lgkmcnt(4)
    v_mfma_f32_16x16x32_bf16 v[118:121], a[76:79], v[170:173], v[118:121]
    s_waitcnt lgkmcnt(2)
    v_mfma_f32_16x16x32_bf16 v[118:121], a[80:83], v[174:177], v[118:121]
    s_waitcnt lgkmcnt(1)
    v_mfma_f32_16x16x32_bf16 v[118:121], a[84:87], v[178:181], v[118:121]
    s_waitcnt lgkmcnt(0)
    buffer_load_dwordx4 v150, s[48:51], 0 offen offset:1024 lds
    v_mfma_f32_16x16x32_bf16 v[118:121], a[88:91], v[182:185], v[118:121]
    v_mfma_f32_16x16x32_bf16 v[118:121], a[92:95], v[186:189], v[118:121]
    v_mfma_f32_16x16x32_bf16 v[190:193], a[96:99], v[126:129], 0
    s_waitcnt vmcnt(8)
    ds_read_b64_tr_b16 a[144:145], v123 offset:0
    ds_read_b64_tr_b16 a[146:147], v123 offset:768
    v_mfma_f32_16x16x32_bf16 v[190:193], a[100:103], v[170:173], v[190:193]
    ds_read_b64_tr_b16 a[168:169], v123 offset:32
    ds_read_b64_tr_b16 a[170:171], v123 offset:800
    v_mfma_f32_16x16x32_bf16 v[190:193], a[104:107], v[174:177], v[190:193]
    ds_read_b64_tr_b16 a[192:193], v123 offset:64
    buffer_load_dwordx4 v152, s[48:51], 0 offen offset:2048 lds
    v_mfma_f32_16x16x32_bf16 v[190:193], a[108:111], v[178:181], v[190:193]
    s_add_u32 s48, s48, 36864
    ds_read_b64_tr_b16 a[194:195], v123 offset:832
    v_cvt_pk_f16_f32 v146, v118, v119
    v_mfma_f32_16x16x32_bf16 v[190:193], a[112:115], v[182:185], v[190:193]
    s_addc_u32 s49, s49, 0
    v_pk_mul_f16 v143, v146, v146
    v_cvt_pk_f16_f32 v147, v120, v121
    v_mfma_f32_16x16x32_bf16 v[190:193], a[116:119], v[186:189], v[190:193]
    s_add_u32 m0, s68, 0
    v_pk_fma_f16 v143, v147, v147, v143
    v_mfma_f32_16x16x32_bf16 v[198:201], a[120:123], v[126:129], 0
    v_mfma_f32_16x16x32_bf16 v[198:201], a[124:127], v[170:173], v[198:201]
    v_mfma_f32_16x16x32_bf16 v[198:201], a[128:131], v[174:177], v[198:201]
    s_waitcnt lgkmcnt(4)
    v_mfma_f32_16x16x32_bf16 v[198:201], a[132:135], v[178:181], v[198:201]
    s_waitcnt lgkmcnt(2)
    v_cvt_pk_f16_f32 v148, v190, v191
    v_pk_fma_f16 v143, v148, v148, v143
    v_mfma_f32_16x16x32_bf16 v[198:201], a[136:139], v[182:185], v[198:201]
    s_waitcnt lgkmcnt(1)
    ds_read_b128 v[194:197], v0 offset:26624
    v_cvt_pk_f16_f32 v149, v192, v193
    v_mfma_f32_16x16x32_bf16 v[198:201], a[140:143], v[186:189], v[198:201]
    s_waitcnt lgkmcnt(1)
    buffer_load_dwordx4 v132, s[48:51], 0 offen lds
    ds_read_b128 v[190:193], v1 offset:26624
    v_mfma_f32_16x16x32_bf16 v[138:141], a[0:3], v[126:129], 0
    ds_read_b128 v[202:205], v0 offset:26752
    s_waitcnt vmcnt(7)
    v_mfma_f32_16x16x32_bf16 v[138:141], a[4:7], v[170:173], v[138:141]
    ds_read_b64_tr_b16 a[148:149], v123 offset:3072
    ds_read_b64_tr_b16 a[150:151], v123 offset:3840
    v_mfma_f32_16x16x32_bf16 v[138:141], a[8:11], v[174:177], v[138:141]
    ds_read_b64_tr_b16 a[172:173], v123 offset:3104
    ds_read_b64_tr_b16 a[174:175], v123 offset:3872
    v_mfma_f32_16x16x32_bf16 v[138:141], a[12:15], v[178:181], v[138:141]
    ds_read_b64_tr_b16 a[196:197], v123 offset:3136
    ds_read_b64_tr_b16 a[198:199], v123 offset:3904
    v_mfma_f32_16x16x32_bf16 v[138:141], a[16:19], v[182:185], v[138:141]
    ds_read_b128 v[206:209], v1 offset:26752
    buffer_load_dwordx4 v150, s[48:51], 0 offen offset:1024 lds
    v_mfma_f32_16x16x32_bf16 v[138:141], a[20:23], v[186:189], v[138:141]
    ds_read_b128 v[210:213], v0 offset:26880
    ds_read_b128 v[214:217], v1 offset:26880
    v_mfma_f32_16x16x32_bf16 v[166:169], a[24:27], v[126:129], 0
    s_waitcnt lgkmcnt(11)
    v_pk_fma_f16 v143, v149, v149, v143
    v_cvt_pk_f16_f32 v120, v198, v199
    v_mfma_f32_16x16x32_bf16 v[166:169], a[28:31], v[170:173], v[166:169]
    s_waitcnt lgkmcnt(10)
    v_pk_fma_f16 v143, v120, v120, v143
    v_cvt_pk_f16_f32 v121, v200, v201
    v_mfma_f32_16x16x32_bf16 v[166:169], a[32:35], v[174:177], v[166:169]
    s_waitcnt lgkmcnt(9)
    v_pk_fma_f16 v143, v121, v121, v143
    v_cvt_pk_f16_f32 v138, v138, v139
    v_mfma_f32_16x16x32_bf16 v[166:169], a[36:39], v[178:181], v[166:169]
    s_waitcnt lgkmcnt(7)
    v_pk_mul_f16 v142, v138, v138
    v_cvt_pk_f16_f32 v139, v140, v141
    v_mfma_f32_16x16x32_bf16 v[166:169], a[40:43], v[182:185], v[166:169]
    s_waitcnt lgkmcnt(5)
    buffer_load_dwordx4 v152, s[48:51], 0 offen offset:2048 lds
    v_pk_fma_f16 v142, v139, v139, v142
    v_mfma_f32_16x16x32_bf16 v[166:169], a[44:47], v[186:189], v[166:169]
    s_add_u32 s48, s48, 36864
    s_addc_u32 s49, s49, 0
    s_add_u32 m0, s68, 3072
    v_mfma_f32_16x16x32_bf16 v[134:137], a[48:51], v[126:129], 0
    s_waitcnt lgkmcnt(2)
    v_mfma_f32_16x16x32_bf16 v[134:137], a[52:55], v[170:173], v[134:137]
    s_waitcnt vmcnt(6)
    ds_read_b64_tr_b16 a[152:153], v124 offset:0
    ds_read_b64_tr_b16 a[154:155], v124 offset:768
    v_mfma_f32_16x16x32_bf16 v[134:137], a[56:59], v[174:177], v[134:137]
    s_waitcnt lgkmcnt(2)
    ds_read_b64_tr_b16 a[176:177], v124 offset:32
    ds_read_b64_tr_b16 a[178:179], v124 offset:800
    v_mfma_f32_16x16x32_bf16 v[134:137], a[60:63], v[178:181], v[134:137]
    ds_read_b64_tr_b16 a[200:201], v124 offset:64
    buffer_load_dwordx4 v132, s[48:51], 0 offen lds
    v_mfma_f32_16x16x32_bf16 v[134:137], a[64:67], v[182:185], v[134:137]
    ds_read_b64_tr_b16 a[202:203], v124 offset:832
    ds_read_b128 v[126:129], v0 offset:32768
    v_mfma_f32_16x16x32_bf16 v[134:137], a[68:71], v[186:189], v[134:137]
    ds_read_b128 v[170:173], v1 offset:32768
    v_cvt_pk_f16_f32 v140, v166, v167
    v_mfma_f32_16x16x32_bf16 v[174:177], a[72:75], v[194:197], 0
    ds_read_b128 v[178:181], v0 offset:32896
    v_pk_fma_f16 v142, v140, v140, v142
    v_mfma_f32_16x16x32_bf16 v[174:177], a[76:79], v[190:193], v[174:177]
    ds_read_b128 v[182:185], v1 offset:32896
    v_cvt_pk_f16_f32 v141, v168, v169
    v_mfma_f32_16x16x32_bf16 v[174:177], a[80:83], v[202:205], v[174:177]
    ds_read_b128 v[166:169], v0 offset:33024
    v_pk_fma_f16 v142, v141, v141, v142
    v_mfma_f32_16x16x32_bf16 v[174:177], a[84:87], v[206:209], v[174:177]
    s_waitcnt lgkmcnt(9)
    buffer_load_dwordx4 v150, s[48:51], 0 offen offset:1024 lds
    ds_read_b128 v[186:189], v1 offset:33024
    v_mfma_f32_16x16x32_bf16 v[174:177], a[88:91], v[210:213], v[174:177]
    s_waitcnt lgkmcnt(8)
    v_cvt_pk_f16_f32 v118, v134, v135
    v_pk_fma_f16 v142, v118, v118, v142
    v_mfma_f32_16x16x32_bf16 v[174:177], a[92:95], v[214:217], v[174:177]
    s_waitcnt lgkmcnt(7)
    v_cvt_pk_f16_f32 v119, v136, v137
    v_pk_fma_f16 v142, v119, v119, v142
    v_mfma_f32_16x16x32_bf16 v[134:137], a[96:99], v[194:197], 0
    s_waitcnt lgkmcnt(5)
    v_mov_b32 v144, 0
    v_mov_b32 v145, 0
    v_mfma_f32_16x16x32_bf16 v[134:137], a[100:103], v[190:193], v[134:137]
    s_waitcnt lgkmcnt(4)
    v_cvt_pk_f16_f32 v150, v174, v175
    v_pk_mul_f16 v175, v150, v150
    v_mfma_f32_16x16x32_f16 v[198:201], v[40:43], v[142:145], 0
    s_waitcnt vmcnt(5)
    ds_read_b64_tr_b16 a[156:157], v124 offset:3072
    buffer_load_dwordx4 v152, s[48:51], 0 offen offset:2048 lds
    v_mfma_f32_16x16x32_bf16 v[134:137], a[104:107], v[202:205], v[134:137]
    s_add_u32 m0, s69, 0
    ds_read_b64_tr_b16 a[158:159], v124 offset:3840
    ds_read_b64_tr_b16 a[180:181], v124 offset:3104
    v_mfma_f32_16x16x32_bf16 v[134:137], a[108:111], v[206:209], v[134:137]
    s_waitcnt lgkmcnt(4)
    ds_read_b64_tr_b16 a[182:183], v124 offset:3872
    ds_read_b64_tr_b16 a[204:205], v124 offset:3136
    v_mfma_f32_16x16x32_bf16 v[134:137], a[112:115], v[210:213], v[134:137]
    s_waitcnt lgkmcnt(5)
    ds_read_b64_tr_b16 a[206:207], v124 offset:3904
    v_cvt_pk_f16_f32 v151, v176, v177
    v_mfma_f32_16x16x32_bf16 v[134:137], a[116:119], v[214:217], v[134:137]
    v_rsq_f32 v198, v198
    v_mfma_f32_16x16x32_bf16 v[142:145], a[120:123], v[194:197], 0
    v_rsq_f32 v199, v199
    v_mfma_f32_16x16x32_bf16 v[142:145], a[124:127], v[190:193], v[142:145]
    buffer_load_dwordx4 v164, s[52:55], 0 offen lds
    v_mul_f32 v152, s31, v198
    v_mfma_f32_16x16x32_bf16 v[142:145], a[128:131], v[202:205], v[142:145]
    v_cvt_pk_f16_f32 v153, v152, v199
    v_pk_mul_f16 v146, v146, v153 op_sel:[0,1] op_sel_hi:[1,1]
    v_mfma_f32_16x16x32_bf16 v[142:145], a[132:135], v[206:209], v[142:145]
    s_waitcnt lgkmcnt(5)
    v_pk_mul_f16 v147, v147, v153 op_sel:[0,1] op_sel_hi:[1,1]
    v_pk_mul_f16 v148, v148, v153 op_sel:[0,1] op_sel_hi:[1,1]
    v_mfma_f32_16x16x32_bf16 v[142:145], a[136:139], v[210:213], v[142:145]
    s_waitcnt lgkmcnt(3)
    ds_read_b128 v[190:193], v155 offset:6144
    v_pk_mul_f16 v149, v149, v153 op_sel:[0,1] op_sel_hi:[1,1]
    v_mfma_f32_16x16x32_bf16 v[142:145], a[140:143], v[214:217], v[142:145]
    s_waitcnt lgkmcnt(2)
    ds_read_b128 v[194:197], v156 offset:6144
    v_pk_mul_f16 v120, v120, v153 op_sel:[0,1] op_sel_hi:[1,1]
    v_mfma_f32_16x16x32_bf16 v[202:205], a[72:75], v[126:129], 0
    s_waitcnt lgkmcnt(2)
    ds_read_b128 v[206:209], v155 offset:6272
    buffer_load_dwordx4 v165, s[52:55], 0 offen offset:1024 lds
    v_mfma_f32_16x16x32_bf16 v[202:205], a[76:79], v[170:173], v[202:205]
    ds_read_b128 v[210:213], v156 offset:6272
    v_pk_mul_f16 v121, v121, v153 op_sel:[0,1] op_sel_hi:[1,1]
    v_mfma_f32_16x16x32_bf16 v[202:205], a[80:83], v[178:181], v[202:205]
    ds_read_b128 v[214:217], v155 offset:6400
    v_pk_mul_f16 v138, v138, v153 op_sel:[0,0] op_sel_hi:[1,0]
    v_mfma_f32_16x16x32_bf16 v[202:205], a[84:87], v[182:185], v[202:205]
    ds_read_b128 v[218:221], v156 offset:6400
    v_pk_mul_f16 v139, v139, v153 op_sel:[0,0] op_sel_hi:[1,0]
    v_mfma_f32_16x16x32_bf16 v[202:205], a[88:91], v[166:169], v[202:205]
    v_pk_mul_f16 v140, v140, v153 op_sel:[0,0] op_sel_hi:[1,0]
    s_waitcnt vmcnt(5)
    v_mfma_f32_16x16x32_bf16 v[202:205], a[92:95], v[186:189], v[202:205]
    ds_read_b64_tr_b16 a[160:161], v123 offset:0
    ds_read_b64_tr_b16 a[162:163], v123 offset:768
    v_mfma_f32_16x16x32_bf16 v[222:225], a[96:99], v[126:129], 0
    s_waitcnt lgkmcnt(7)
    buffer_load_dwordx4 v131, s[52:55], 0 offen offset:2048 lds
    ds_read_b64_tr_b16 a[184:185], v123 offset:32
    v_mfma_f32_16x16x32_bf16 v[222:225], a[100:103], v[170:173], v[222:225]
    s_add_u32 s52, s52, 12288
    ds_read_b64_tr_b16 a[186:187], v123 offset:800
    ds_read_b64_tr_b16 a[208:209], v123 offset:64
    v_mfma_f32_16x16x32_bf16 v[222:225], a[104:107], v[178:181], v[222:225]
    s_addc_u32 s53, s53, 0
    ds_read_b64_tr_b16 a[210:211], v123 offset:832
    v_pk_mul_f16 v141, v141, v153 op_sel:[0,0] op_sel_hi:[1,0]
    v_mfma_f32_16x16x32_bf16 v[222:225], a[108:111], v[182:185], v[222:225]
    s_add_u32 m0, s69, 3072
    v_pk_mul_f16 v118, v118, v153 op_sel:[0,0] op_sel_hi:[1,0]
    v_pk_mul_f16 v119, v119, v153 op_sel:[0,0] op_sel_hi:[1,0]
    v_mfma_f32_16x16x32_bf16 v[222:225], a[112:115], v[166:169], v[222:225]
    s_waitcnt lgkmcnt(7)
    v_max3_u32 v44, v44, v198, v199
    v_pk_fma_f16 v175, v151, v151, v175
    v_mfma_f32_16x16x32_bf16 v[222:225], a[116:119], v[186:189], v[222:225]
    s_waitcnt lgkmcnt(6)
    v_cvt_pk_f16_f32 v152, v134, v135
    v_pk_fma_f16 v175, v152, v152, v175
    v_mfma_f32_16x16x32_bf16 v[198:201], a[120:123], v[126:129], 0
    buffer_load_dwordx4 v164, s[52:55], 0 offen lds
    v_cvt_pk_f16_f32 v153, v136, v137
    v_mfma_f32_16x16x32_bf16 v[198:201], a[124:127], v[170:173], v[198:201]
    s_waitcnt lgkmcnt(4)
    v_pk_fma_f16 v175, v153, v153, v175
    v_cvt_pk_f16_f32 v124, v142, v143
    v_mfma_f32_16x16x32_bf16 v[198:201], a[128:131], v[178:181], v[198:201]
    s_waitcnt lgkmcnt(3)
    v_pk_fma_f16 v175, v124, v124, v175
    v_cvt_pk_f16_f32 v125, v144, v145
    v_mfma_f32_16x16x32_bf16 v[198:201], a[132:135], v[182:185], v[198:201]
    s_waitcnt lgkmcnt(1)
    v_pk_fma_f16 v175, v125, v125, v175
    v_cvt_pk_f16_f32 v126, v202, v203
    v_mfma_f32_16x16x32_bf16 v[198:201], a[136:139], v[166:169], v[198:201]
    s_waitcnt lgkmcnt(0)
    ds_read_b128 v[134:137], v0 offset:26624
    v_pk_mul_f16 v115, v126, v126
    v_mfma_f32_16x16x32_bf16 v[198:201], a[140:143], v[186:189], v[198:201]
    ds_read_b128 v[142:145], v1 offset:26624
    buffer_load_dwordx4 v165, s[52:55], 0 offen offset:1024 lds
    v_mfma_f32_16x16x32_bf16 v[166:169], v[190:193], a[144:147], 0
    ds_read_b128 v[170:173], v0 offset:26752
    v_cvt_pk_f16_f32 v127, v204, v205
    v_mfma_f32_16x16x32_bf16 v[166:169], v[194:197], a[148:151], v[166:169]
    ds_read_b128 v[178:181], v1 offset:26752
    v_pk_fma_f16 v115, v127, v127, v115
    v_mfma_f32_16x16x32_bf16 v[166:169], v[206:209], a[152:155], v[166:169]
    ds_read_b128 v[182:185], v0 offset:26880
    v_cvt_pk_f16_f32 v128, v222, v223
    s_waitcnt vmcnt(5)
    v_mfma_f32_16x16x32_bf16 v[166:169], v[210:213], a[156:159], v[166:169]
    ds_read_b64_tr_b16 a[164:165], v123 offset:3072
    ds_read_b64_tr_b16 a[166:167], v123 offset:3840
    v_mfma_f32_16x16x32_bf16 v[166:169], v[214:217], a[160:163], v[166:169]
    ds_read_b64_tr_b16 a[188:189], v123 offset:3104
    buffer_load_dwordx4 v131, s[52:55], 0 offen offset:2048 lds
    v_mfma_f32_16x16x32_bf16 v[186:189], v[190:193], a[168:171], 0
    s_waitcnt lgkmcnt(7)
    ds_read_b64_tr_b16 a[190:191], v123 offset:3872
    ds_read_b64_tr_b16 a[212:213], v123 offset:3136
    v_mfma_f32_16x16x32_bf16 v[186:189], v[194:197], a[172:175], v[186:189]
    s_add_u32 s52, s52, 12288
    ds_read_b64_tr_b16 a[214:215], v123 offset:3904
    ds_read_b128 v[202:205], v1 offset:26880
    v_mfma_f32_16x16x32_bf16 v[186:189], v[206:209], a[176:179], v[186:189]
    s_addc_u32 s53, s53, 0
    v_pk_fma_f16 v115, v128, v128, v115
    v_cvt_pk_f16_f32 v129, v224, v225
    v_mfma_f32_16x16x32_bf16 v[186:189], v[210:213], a[180:183], v[186:189]
    s_add_u32 m0, s68, 0
    v_pk_fma_f16 v115, v129, v129, v115
    v_cvt_pk_f16_f32 v224, v198, v199
    v_mfma_f32_16x16x32_bf16 v[186:189], v[214:217], a[184:187], v[186:189]
    s_waitcnt lgkmcnt(7)
    v_pk_fma_f16 v115, v224, v224, v115
    v_cvt_pk_f16_f32 v225, v200, v201
    v_mfma_f32_16x16x32_bf16 v[198:201], v[190:193], a[192:195], 0
    buffer_load_dwordx4 v164, s[52:55], 0 offen lds
    v_pk_fma_f16 v115, v225, v225, v115
    v_mfma_f32_16x16x32_bf16 v[198:201], v[194:197], a[196:199], v[198:201]
    s_waitcnt lgkmcnt(5)
    v_xor_b32 v255, 65536, v2
    v_lshrrev_b32 v132, 2, v255
    v_mfma_f32_16x16x32_bf16 v[166:169], v[218:221], a[164:167], v[166:169]
    s_waitcnt lgkmcnt(4)
    v_lshrrev_b32 v157, 8, v255
    v_lshl_add_u32 v159, s16, 2, v255
    v_mfma_f32_16x16x32_bf16 v[198:201], v[206:209], a[200:203], v[198:201]
    s_waitcnt lgkmcnt(2)
    v_add_u32 v132, 62784, v132
    v_lshlrev_b32 v157, 4, v157
    v_mfma_f32_16x16x32_bf16 v[186:189], v[218:221], a[188:191], v[186:189]
    s_waitcnt lgkmcnt(0)
    v_cvt_pk_bf16_f32 v166, v166, v166
    v_cvt_pk_bf16_f32 v167, v167, v167
    v_mfma_f32_16x16x32_bf16 v[198:201], v[210:213], a[204:207], v[198:201]
    ds_write2_b32 v161, v166, v167 offset0:0 offset1:68
    v_mfma_f32_16x16x32_bf16 v[198:201], v[214:217], a[208:211], v[198:201]
    buffer_load_dwordx4 v165, s[52:55], 0 offen offset:1024 lds
    v_cvt_pk_bf16_f32 v168, v168, v168
    v_mfma_f32_16x16x32_bf16 v[198:201], v[218:221], a[212:215], v[198:201]
    v_cvt_pk_bf16_f32 v169, v169, v169
    v_cvt_pk_bf16_f32 v186, v186, v186
    v_mfma_f32_16x16x32_bf16 v[190:193], v[134:137], a[144:147], 0
    ds_write2_b32 v161, v168, v169 offset0:136 offset1:204
    s_waitcnt vmcnt(5)
    v_mfma_f32_16x16x32_bf16 v[190:193], v[142:145], a[148:151], v[190:193]
    v_cvt_pk_bf16_f32 v187, v187, v187
    v_cvt_pk_bf16_f32 v188, v188, v188
    v_mfma_f32_16x16x32_bf16 v[190:193], v[170:173], a[152:155], v[190:193]
    ds_read_b64 a[216:217], v114 offset:0
    ds_read_b64 a[218:219], v114 offset:1536
    v_mfma_f32_16x16x32_bf16 v[190:193], v[178:181], a[156:159], v[190:193]
    buffer_load_dwordx4 v131, s[52:55], 0 offen offset:2048 lds
    ds_read_b64 a[240:241], v114 offset:8
    v_mfma_f32_16x16x32_bf16 v[190:193], v[182:185], a[160:163], v[190:193]
    s_add_u32 s52, s52, 12288
    ds_read_b64 a[242:243], v114 offset:1544
    ds_read_b64 v[90:91], v254 offset:0
    v_mfma_f32_16x16x32_bf16 v[190:193], v[202:205], a[164:167], v[190:193]
    s_addc_u32 s53, s53, 0
    ds_read_b64 v[92:93], v254 offset:1536
    ds_read_b128 v[166:169], v155 offset:0
    v_mfma_f32_16x16x32_bf16 v[194:197], v[134:137], a[168:171], 0
    s_add_u32 m0, s68, 3072
    ds_read_b128 v[206:209], v156 offset:0
    v_cvt_pk_bf16_f32 v189, v189, v189
    v_mfma_f32_16x16x32_bf16 v[194:197], v[142:145], a[172:175], v[194:197]
    s_mul_i32 s68, s78, 72
    ds_read_b128 v[210:213], v155 offset:128
    v_cvt_pk_bf16_f32 v198, v198, v198
    v_mfma_f32_16x16x32_bf16 v[194:197], v[170:173], a[176:179], v[194:197]
    s_sub_u32 s68, s77, s68
    ds_read_b128 v[214:217], v156 offset:128
    buffer_load_dwordx4 v164, s[52:55], 0 offen lds
    v_mfma_f32_16x16x32_bf16 v[194:197], v[178:181], a[180:183], v[194:197]
    s_mul_i32 s78, s78, 1373568
    ds_read_b128 v[218:221], v155 offset:256
    v_cvt_pk_bf16_f32 v199, v199, v199
    v_mfma_f32_16x16x32_bf16 v[194:197], v[182:185], a[184:187], v[194:197]
    s_mul_i32 s77, s68, 2688
    ds_read_b128 v[226:229], v156 offset:256
    v_cvt_pk_bf16_f32 v200, v200, v200
    v_mfma_f32_16x16x32_bf16 v[194:197], v[202:205], a[188:191], v[194:197]
    s_add_u32 s77, s77, s78
    ds_write2_b32 v161, v186, v187 offset0:16 offset1:84
    v_mfma_f32_16x16x32_bf16 v[230:233], v[134:137], a[192:195], 0
    s_waitcnt lgkmcnt(7)
    v_cvt_pk_bf16_f32 v201, v201, v201
    v_cvt_pk_bf16_f32 v136, v190, v191
    v_mfma_f32_16x16x32_bf16 v[230:233], v[142:145], a[196:199], v[230:233]
    s_waitcnt lgkmcnt(5)
    ds_write2_b32 v161, v188, v189 offset0:152 offset1:220
    v_mfma_f32_16x16x32_bf16 v[230:233], v[170:173], a[200:203], v[230:233]
    s_waitcnt lgkmcnt(5)
    buffer_load_dwordx4 v165, s[52:55], 0 offen offset:1024 lds
    v_cvt_pk_bf16_f32 v137, v192, v193
    v_mfma_f32_16x16x32_bf16 v[230:233], v[178:181], a[204:207], v[230:233]
    s_waitcnt lgkmcnt(4)
    ds_write2_b32 v161, v198, v199 offset0:32 offset1:100
    v_mfma_f32_16x16x32_bf16 v[230:233], v[182:185], a[208:211], v[230:233]
    s_waitcnt lgkmcnt(4)
    s_waitcnt vmcnt(5)
    v_cvt_pk_bf16_f32 v144, v194, v195
    v_mfma_f32_16x16x32_bf16 v[230:233], v[202:205], a[212:215], v[230:233]
    s_waitcnt lgkmcnt(3)
    ds_read_b64 a[232:233], v114 offset:3072
    ds_read_b64 a[220:221], v114 offset:4608
    v_mfma_f32_16x16x32_bf16 v[170:173], v[166:169], a[144:147], 0
    s_barrier
    ds_read_b64 v[82:83], v114 offset:3080
    ds_read_b64 a[244:245], v114 offset:4616
    v_mfma_f32_16x16x32_bf16 v[170:173], v[206:209], a[148:151], v[170:173]
    buffer_load_dwordx4 v131, s[52:55], 0 offen offset:2048 lds
    ds_read_b64 v[106:107], v254 offset:3072
    v_mfma_f32_16x16x32_bf16 v[170:173], v[210:213], a[152:155], v[170:173]
    s_add_u32 s52, s52, 12288
    ds_read_b64 v[94:95], v254 offset:4608
    v_cvt_pk_bf16_f32 v145, v196, v197
    v_mfma_f32_16x16x32_bf16 v[170:173], v[214:217], a[156:159], v[170:173]
    s_addc_u32 s53, s53, 0
    ds_write2_b32 v161, v200, v201 offset0:168 offset1:236
    v_mfma_f32_16x16x32_bf16 v[170:173], v[218:221], a[160:163], v[170:173]
    s_add_u32 m0, s69, 0
    v_cvt_pk_bf16_f32 v180, v230, v231
    v_cvt_pk_bf16_f32 v181, v232, v233
    v_mfma_f32_16x16x32_bf16 v[170:173], v[226:229], a[164:167], v[170:173]
    ds_read_b128 v[182:185], v0 offset:26624
    v_add_u32 v157, 62784, v157
    v_mfma_f32_16x16x32_bf16 v[186:189], v[166:169], a[168:171], 0
    s_waitcnt lgkmcnt(7)
    buffer_load_dwordx4 v164, s[52:55], 0 offen lds
    ds_read_b128 v[190:193], v1 offset:26624
    v_mfma_f32_16x16x32_bf16 v[186:189], v[206:209], a[172:175], v[186:189]
    s_waitcnt lgkmcnt(6)
    ds_read_b128 v[194:197], v0 offset:26752
    v_cvt_pk_bf16_f32 v170, v170, v170
    v_mfma_f32_16x16x32_bf16 v[186:189], v[210:213], a[176:179], v[186:189]
    s_waitcnt lgkmcnt(6)
    ds_read_b128 v[198:201], v1 offset:26752
    v_cvt_pk_bf16_f32 v171, v171, v171
    v_mfma_f32_16x16x32_bf16 v[186:189], v[214:217], a[180:183], v[186:189]
    s_waitcnt lgkmcnt(5)
    ds_read_b128 v[202:205], v0 offset:26880
    v_cvt_pk_bf16_f32 v172, v172, v172
    v_mfma_f32_16x16x32_bf16 v[186:189], v[218:221], a[184:187], v[186:189]
    ds_read_b128 v[230:233], v1 offset:26880
    v_cvt_pk_bf16_f32 v173, v173, v173
    v_mfma_f32_16x16x32_bf16 v[186:189], v[226:229], a[188:191], v[186:189]
    ds_write2_b32 v158, v170, v171 offset0:0 offset1:68
    v_mfma_f32_16x16x32_bf16 v[234:237], v[166:169], a[192:195], 0
    s_waitcnt lgkmcnt(6)
    buffer_load_dwordx4 v165, s[52:55], 0 offen offset:1024 lds
    v_or_b32 v166, v32, v33
    v_mfma_f32_16x16x32_bf16 v[234:237], v[206:209], a[196:199], v[234:237]
    ds_write2_b32 v158, v172, v173 offset0:136 offset1:204
    v_mfma_f32_16x16x32_bf16 v[234:237], v[210:213], a[200:203], v[234:237]
    s_waitcnt lgkmcnt(5)
    v_cvt_pk_bf16_f32 v186, v186, v186
    v_cvt_pk_bf16_f32 v187, v187, v187
    v_mfma_f32_16x16x32_bf16 v[234:237], v[214:217], a[204:207], v[234:237]
    s_waitcnt vmcnt(5)
    ds_read_b64 a[222:223], v130 offset:0
    ds_read_b64 a[234:235], v130 offset:1536
    v_mfma_f32_16x16x32_bf16 v[234:237], v[218:221], a[208:211], v[234:237]
    s_waitcnt lgkmcnt(5)
    ds_read_b64 a[246:247], v130 offset:8
    ds_read_b64 v[84:85], v130 offset:1544
    v_mfma_f32_16x16x32_bf16 v[234:237], v[226:229], a[212:215], v[234:237]
    s_waitcnt lgkmcnt(6)
    buffer_load_dwordx4 v131, s[52:55], 0 offen offset:2048 lds
    ds_read_b64 v[96:97], v133 offset:0
    v_mfma_f32_16x16x32_bf16 v[170:173], a[0:3], v[182:185], 0
    s_add_u32 s52, s52, 12288
    ds_read_b64 v[108:109], v133 offset:1536
    v_cvt_pk_bf16_f32 v188, v188, v188
    v_mfma_f32_16x16x32_bf16 v[170:173], a[4:7], v[190:193], v[170:173]
    s_addc_u32 s53, s53, 0
    ds_write2_b32 v158, v186, v187 offset0:16 offset1:84
    v_mfma_f32_16x16x32_bf16 v[170:173], a[8:11], v[194:197], v[170:173]
    s_add_u32 m0, s69, 3072
    v_cvt_pk_bf16_f32 v189, v189, v189
    v_cvt_pk_bf16_f32 v234, v234, v234
    v_mfma_f32_16x16x32_bf16 v[170:173], a[12:15], v[198:201], v[170:173]
    s_add_u32 s69, s77, 589824
    ds_write2_b32 v158, v188, v189 offset0:152 offset1:220
    v_mfma_f32_16x16x32_bf16 v[170:173], a[16:19], v[202:205], v[170:173]
    s_waitcnt lgkmcnt(6)
    buffer_load_dwordx4 v164, s[52:55], 0 offen lds
    v_cvt_pk_bf16_f32 v235, v235, v235
    v_mfma_f32_16x16x32_bf16 v[170:173], a[20:23], v[230:233], v[170:173]
    s_waitcnt lgkmcnt(4)
    ds_read_b128 v[186:189], v0 offset:20480
    v_cvt_pk_bf16_f32 v236, v236, v236
    v_mfma_f32_16x16x32_bf16 v[206:209], a[24:27], v[182:185], 0
    s_waitcnt lgkmcnt(4)
    ds_read_b128 v[210:213], v1 offset:20480
    v_cvt_pk_bf16_f32 v237, v237, v237
    v_mfma_f32_16x16x32_bf16 v[206:209], a[28:31], v[190:193], v[206:209]
    s_waitcnt lgkmcnt(4)
    ds_read_b128 v[214:217], v0 offset:20608
    v_cvt_pk_f16_f32 v170, v170, v171
    v_mfma_f32_16x16x32_bf16 v[206:209], a[32:35], v[194:197], v[206:209]
    ds_read_b128 v[218:221], v1 offset:20608
    v_pk_mul_f16 v174, v170, v170
    v_mfma_f32_16x16x32_bf16 v[206:209], a[36:39], v[198:201], v[206:209]
    ds_read_b128 v[226:229], v0 offset:20736
    buffer_load_dwordx4 v165, s[52:55], 0 offen offset:1024 lds
    v_mfma_f32_16x16x32_bf16 v[206:209], a[40:43], v[202:205], v[206:209]
    ds_read_b128 v[238:241], v1 offset:20736
    v_cvt_pk_f16_f32 v171, v172, v173
    v_mfma_f32_16x16x32_bf16 v[206:209], a[44:47], v[230:233], v[206:209]
    ds_write2_b32 v158, v234, v235 offset0:32 offset1:100
    v_mfma_f32_16x16x32_bf16 v[242:245], a[48:51], v[182:185], 0
    s_waitcnt lgkmcnt(6)
    v_pk_fma_f16 v174, v171, v171, v174
    v_and_b32 v166, 0xffff, v166
    v_mfma_f32_16x16x32_bf16 v[242:245], a[52:55], v[190:193], v[242:245]
    s_waitcnt vmcnt(5)
    ds_read_b64 a[224:225], v130 offset:3072
    ds_read_b64 a[226:227], v130 offset:4608
    v_mfma_f32_16x16x32_bf16 v[242:245], a[56:59], v[194:197], v[242:245]
    s_waitcnt lgkmcnt(6)
    ds_read_b64 a[248:249], v130 offset:3080
    buffer_load_dwordx4 v131, s[52:55], 0 offen offset:2048 lds
    v_mfma_f32_16x16x32_bf16 v[242:245], a[60:63], v[198:201], v[242:245]
    s_add_u32 m0, s28, 65536
    ds_read_b64 a[250:251], v130 offset:4616
    ds_read_b64 v[98:99], v133 offset:3072
    v_mfma_f32_16x16x32_bf16 v[242:245], a[64:67], v[202:205], v[242:245]
    s_waitcnt lgkmcnt(7)
    ds_read_b64 v[100:101], v133 offset:4608
    v_cvt_pk_f16_f32 v172, v206, v207
    v_mfma_f32_16x16x32_bf16 v[242:245], a[68:71], v[230:233], v[242:245]
    s_waitcnt lgkmcnt(7)
    ds_write2_b32 v158, v236, v237 offset0:168 offset1:236
    v_mfma_f32_16x16x32_bf16 v[182:185], v[186:189], a[144:147], 0
    v_pk_fma_f16 v174, v172, v172, v174
    v_cvt_pk_f16_f32 v173, v208, v209
    v_mfma_f32_16x16x32_bf16 v[182:185], v[210:213], a[148:151], v[182:185]
    v_pk_fma_f16 v174, v173, v173, v174
    v_mov_b32 v176, 0
    v_mfma_f32_16x16x32_bf16 v[182:185], v[214:217], a[152:155], v[182:185]
    s_waitcnt lgkmcnt(6)
    buffer_load_dwordx4 v10, s[8:11], s24 offen nt lds
    v_mfma_f32_16x16x32_bf16 v[182:185], v[218:221], a[156:159], v[182:185]
    s_add_u32 m0, s28, 69632
    v_cvt_pk_f16_f32 v122, v242, v243
    v_pk_fma_f16 v174, v122, v122, v174
    v_mfma_f32_16x16x32_bf16 v[182:185], v[226:229], a[160:163], v[182:185]
    s_waitcnt lgkmcnt(3)
    v_cvt_pk_f16_f32 v123, v244, v245
    v_pk_fma_f16 v174, v123, v123, v174
    v_mfma_f32_16x16x32_bf16 v[182:185], v[238:241], a[164:167], v[182:185]
    s_waitcnt lgkmcnt(1)
    ds_read_b128 v[190:193], v0 offset:32768
    v_mov_b32 v177, 0
    v_mfma_f32_16x16x32_bf16 v[194:197], v[186:189], a[168:171], 0
    ds_read_b128 v[198:201], v1 offset:32768
    v_lshl_or_b32 v166, v166, 16, v166
    v_mfma_f32_16x16x32_f16 v[202:205], v[40:43], v[174:177], 0
    v_or_b32 v167, v32, v33
    v_cvt_pk_bf16_f32 v134, v182, v183
    v_mfma_f32_16x16x32_bf16 v[194:197], v[210:213], a[172:175], v[194:197]
    buffer_load_dwordx4 v11, s[8:11], s24 offen nt lds
    v_mfma_f32_16x16x32_bf16 v[194:197], v[214:217], a[176:179], v[194:197]
    s_add_u32 m0, s28, 73728
    ds_read_b128 v[174:177], v0 offset:32896
    ds_read_b128 v[206:209], v1 offset:32896
    v_mfma_f32_16x16x32_bf16 v[194:197], v[218:221], a[180:183], v[194:197]
    ds_read_b128 v[230:233], v0 offset:33024
    v_cvt_pk_bf16_f32 v135, v184, v185
    v_mfma_f32_16x16x32_bf16 v[194:197], v[226:229], a[184:187], v[194:197]
    ds_read_b128 v[182:185], v1 offset:33024
    s_waitcnt vmcnt(5)
    v_mfma_f32_16x16x32_bf16 v[194:197], v[238:241], a[188:191], v[194:197]
    ds_read_b64 a[236:237], v114 offset:0
    ds_read_b64 a[228:229], v114 offset:1536
    v_mfma_f32_16x16x32_bf16 v[234:237], v[186:189], a[192:195], 0
    s_waitcnt lgkmcnt(7)
    ds_read_b64 v[86:87], v114 offset:8
    ds_read_b64 a[252:253], v114 offset:1544
    v_mfma_f32_16x16x32_bf16 v[234:237], v[210:213], a[196:199], v[234:237]
    s_waitcnt lgkmcnt(8)
    buffer_load_dwordx4 v12, s[8:11], s24 offen nt lds
    v_mfma_f32_16x16x32_bf16 v[234:237], v[214:217], a[200:203], v[234:237]
    s_add_u32 m0, s28, 77824
    ds_read_b64 v[110:111], v254 offset:0
    ds_read_b64 v[102:103], v254 offset:1536
    v_mfma_f32_16x16x32_bf16 v[234:237], v[218:221], a[204:207], v[234:237]
    ds_read_b128 v[186:189], v154 offset:0
    ds_read_b128 v[210:213], v154 offset:16
    v_mfma_f32_16x16x32_bf16 v[234:237], v[226:229], a[208:211], v[234:237]
    s_waitcnt lgkmcnt(10)
    ds_read_b128 v[214:217], v154 offset:48
    ds_read_b32 v164, v6 offset:192
    v_mfma_f32_16x16x32_bf16 v[234:237], v[238:241], a[212:215], v[234:237]
    s_waitcnt lgkmcnt(11)
    v_rsq_f32 v202, v202
    v_mfma_f32_16x16x32_bf16 v[218:221], a[0:3], v[190:193], 0
    s_waitcnt lgkmcnt(10)
    v_rsq_f32 v203, v203
    v_mfma_f32_16x16x32_bf16 v[218:221], a[4:7], v[198:201], v[218:221]
    s_waitcnt lgkmcnt(8)
    buffer_load_dwordx4 v13, s[8:11], s24 offen nt lds
    v_mfma_f32_16x16x32_bf16 v[218:221], a[8:11], v[174:177], v[218:221]
    s_add_u32 m0, s74, 0
    v_mul_f32 v142, s31, v202
    v_cvt_pk_f16_f32 v143, v142, v203
    v_mfma_f32_16x16x32_bf16 v[218:221], a[12:15], v[206:209], v[218:221]
    s_waitcnt lgkmcnt(6)
    v_pk_mul_f16 v150, v150, v143 op_sel:[0,1] op_sel_hi:[1,1]
    v_pk_mul_f16 v151, v151, v143 op_sel:[0,1] op_sel_hi:[1,1]
    v_mfma_f32_16x16x32_bf16 v[218:221], a[16:19], v[230:233], v[218:221]
    s_waitcnt lgkmcnt(4)
    v_pk_mul_f16 v152, v152, v143 op_sel:[0,1] op_sel_hi:[1,1]
    v_pk_mul_f16 v153, v153, v143 op_sel:[0,1] op_sel_hi:[1,1]
    v_mfma_f32_16x16x32_bf16 v[218:221], a[20:23], v[182:185], v[218:221]
    s_waitcnt lgkmcnt(2)
    v_pk_mul_f16 v124, v124, v143 op_sel:[0,1] op_sel_hi:[1,1]
    v_pk_mul_f16 v125, v125, v143 op_sel:[0,1] op_sel_hi:[1,1]
    v_mfma_f32_16x16x32_bf16 v[226:229], a[24:27], v[190:193], 0
    s_waitcnt lgkmcnt(0)
    v_pk_mul_f16 v170, v170, v143 op_sel:[0,0] op_sel_hi:[1,0]
    v_pk_mul_f16 v171, v171, v143 op_sel:[0,0] op_sel_hi:[1,0]
    v_mfma_f32_16x16x32_bf16 v[226:229], a[28:31], v[198:201], v[226:229]
    buffer_load_dwordx4 v14, s[8:11], s24 offen nt lds
    v_mfma_f32_16x16x32_bf16 v[226:229], a[32:35], v[174:177], v[226:229]
    s_add_u32 s8, s60, s23
    v_pk_mul_f16 v172, v172, v143 op_sel:[0,0] op_sel_hi:[1,0]
    s_waitcnt vmcnt(5)
    v_mfma_f32_16x16x32_bf16 v[226:229], a[36:39], v[206:209], v[226:229]
    s_addc_u32 s9, s61, 0
    ds_read_b64 a[230:231], v114 offset:3072
    ds_read_b64 a[238:239], v114 offset:4608
    v_mfma_f32_16x16x32_bf16 v[226:229], a[40:43], v[230:233], v[226:229]
    s_sub_u32 s10, s36, s23
    ds_read_b64 a[254:255], v114 offset:3080
    ds_read_b64 v[88:89], v114 offset:4616
    v_mfma_f32_16x16x32_bf16 v[226:229], a[44:47], v[182:185], v[226:229]
    s_cmp_lt_u32 s34, s17
    ds_read_b64 v[104:105], v254 offset:3072
    ds_read_b64 v[112:113], v254 offset:4608
    v_mfma_f32_16x16x32_bf16 v[238:241], a[48:51], v[190:193], 0
    s_cselect_b32 s10, s10, 0
    v_pk_mul_f16 v173, v173, v143 op_sel:[0,0] op_sel_hi:[1,0]
    v_pk_mul_f16 v122, v122, v143 op_sel:[0,0] op_sel_hi:[1,0]
    v_mfma_f32_16x16x32_bf16 v[238:241], a[52:55], v[198:201], v[238:241]
    s_add_u32 m0, s28, 0
    v_pk_mul_f16 v123, v123, v143 op_sel:[0,0] op_sel_hi:[1,0]
    v_max3_u32 v44, v44, v202, v203
    v_mfma_f32_16x16x32_bf16 v[238:241], a[56:59], v[174:177], v[238:241]
    s_mov_b32 s24, s23
    v_cvt_pk_bf16_f32 v142, v194, v195
    v_cvt_pk_bf16_f32 v143, v196, v197
    v_mfma_f32_16x16x32_bf16 v[238:241], a[60:63], v[206:209], v[238:241]
    s_add_u32 s23, s23, s21
    v_cvt_pk_bf16_f32 v178, v234, v235
    v_cvt_pk_bf16_f32 v179, v236, v237
    v_mfma_f32_16x16x32_bf16 v[238:241], a[64:67], v[230:233], v[238:241]
    s_cmp_ge_u32 s19, 72
    v_cvt_pk_f16_f32 v194, v218, v219
    v_pk_mul_f16 v114, v194, v194
    v_mfma_f32_16x16x32_bf16 v[238:241], a[68:71], v[182:185], v[238:241]
    s_cselect_b32 s34, 72, 0
    v_cvt_pk_f16_f32 v195, v220, v221
    v_pk_fma_f16 v114, v195, v195, v114
    v_mfma_f32_16x16x32_bf16 v[202:205], v[190:193], a[144:147], 0
    s_cselect_b32 s35, s22, 0
    v_cvt_pk_f16_f32 v196, v226, v227
    v_pk_fma_f16 v114, v196, v196, v114
    v_mfma_f32_16x16x32_bf16 v[202:205], v[198:201], a[148:151], v[202:205]
    s_sub_u32 s19, s19, s34
    v_cvt_pk_f16_f32 v197, v228, v229
    v_pk_fma_f16 v114, v197, v197, v114
    v_mfma_f32_16x16x32_bf16 v[202:205], v[174:177], a[152:155], v[202:205]
    s_add_u32 s23, s23, s35
    v_cvt_pk_f16_f32 v222, v238, v239
    v_pk_fma_f16 v114, v222, v222, v114
    v_mfma_f32_16x16x32_bf16 v[202:205], v[206:209], a[156:159], v[202:205]
    s_waitcnt lgkmcnt(0)
    v_cvt_pk_f16_f32 v223, v240, v241
    v_pk_fma_f16 v114, v223, v223, v114
    v_mfma_f32_16x16x32_f16 v[218:221], v[186:189], v[138:141], v[22:25]
    v_mov_b32 v116, 0
    v_mov_b32 v117, 0
    v_mfma_f32_16x16x32_f16 v[218:221], v[210:213], v[146:149], v[218:221]
    v_xor_b32 v0, 65536, v0
    v_xor_b32 v1, 65536, v1
    v_mfma_f32_16x16x32_f16 v[226:229], v[40:43], v[114:117], 0
    v_and_b32 v167, 0xffff, v167
    v_lshl_or_b32 v167, v167, 16, v167
    v_mfma_f32_16x16x32_f16 v[218:221], v[214:217], v[118:121], v[218:221]
    v_or_b32 v168, v32, v33
    v_lshrrev_b32 v168, 16, v168
    v_mfma_f32_16x16x32_bf16 v[202:205], v[230:233], a[160:163], v[202:205]
    v_lshl_or_b32 v168, v168, 16, v168
    v_or_b32 v169, v32, v33
    v_mfma_f32_16x16x32_bf16 v[202:205], v[182:185], a[164:167], v[202:205]
    v_rsq_f32 v226, v226
    v_mfma_f32_16x16x32_bf16 v[114:117], v[190:193], a[168:171], 0
    v_rsq_f32 v227, v227
    v_mfma_f32_16x16x32_bf16 v[114:117], v[198:201], a[172:175], v[114:117]
    v_mul_f32 v220, s31, v226
    v_cvt_pk_f16_f32 v221, v220, v227
    v_mfma_f32_16x16x32_f16 v[234:237], v[146:149], v[138:141], v[46:49]
    v_pk_mul_f16 v126, v126, v221 op_sel:[0,1] op_sel_hi:[1,1]
    v_pk_mul_f16 v127, v127, v221 op_sel:[0,1] op_sel_hi:[1,1]
    v_mfma_f32_16x16x32_f16 v[238:241], v[150:153], v[138:141], v[50:53]
    v_pk_mul_f16 v128, v128, v221 op_sel:[0,1] op_sel_hi:[1,1]
    v_pk_mul_f16 v129, v129, v221 op_sel:[0,1] op_sel_hi:[1,1]
    v_mfma_f32_16x16x32_bf16 v[114:117], v[174:177], a[176:179], v[114:117]
    v_pk_mul_f16 v224, v224, v221 op_sel:[0,1] op_sel_hi:[1,1]
    v_pk_mul_f16 v225, v225, v221 op_sel:[0,1] op_sel_hi:[1,1]
    v_pk_mul_f16 v194, v194, v221 op_sel:[0,0] op_sel_hi:[1,0]
    v_mfma_f32_16x16x16_f16 v[234:237], v[120:121], v[118:119], v[234:237]
    v_pk_mul_f16 v195, v195, v221 op_sel:[0,0] op_sel_hi:[1,0]
    v_pk_mul_f16 v196, v196, v221 op_sel:[0,0] op_sel_hi:[1,0]
    v_pk_mul_f16 v197, v197, v221 op_sel:[0,0] op_sel_hi:[1,0]
    v_mfma_f32_16x16x16_f16 v[238:241], v[124:125], v[118:119], v[238:241]
    v_pk_mul_f16 v222, v222, v221 op_sel:[0,0] op_sel_hi:[1,0]
    v_pk_mul_f16 v223, v223, v221 op_sel:[0,0] op_sel_hi:[1,0]
    v_max3_u32 v44, v44, v226, v227
    v_mov_b32_dpp v164, v219 quad_perm:[0,1,2,3] row_mask:0x1 bank_mask:0xf
    v_mfma_f32_16x16x32_f16 v[226:229], v[126:129], v[138:141], v[54:57]
    v_cvt_pk_bf16_f32 v138, v202, v203
    v_cvt_pk_bf16_f32 v139, v204, v205
    v_mfma_f32_16x16x32_f16 v[202:205], v[186:189], v[170:173], v[24:27]
    v_exp_f32 v234, v234
    v_mfma_f32_16x16x32_f16 v[202:205], v[210:213], v[150:153], v[202:205]
    v_exp_f32 v235, v235
    v_mov_b32 v25, 0
    v_mfma_f32_16x16x16_f16 v[226:229], v[224:225], v[118:119], v[226:229]
    v_cvt_pk_bf16_f32 v234, v234, v235
    v_exp_f32 v236, v236
    v_lshrrev_b32 v169, 16, v169
    v_mfma_f32_16x16x32_f16 v[202:205], v[214:217], v[122:125], v[202:205]
    v_exp_f32 v237, v237
    v_mfma_f32_16x16x32_bf16 v[114:117], v[206:209], a[180:183], v[114:117]
    v_cvt_pk_bf16_f32 v235, v236, v237
    v_lshl_or_b32 v169, v169, 16, v169
    v_mfma_f32_16x16x32_bf16 v[114:117], v[230:233], a[184:187], v[114:117]
    v_exp_f32 v238, v238
    v_mfma_f32_16x16x32_bf16 v[114:117], v[182:185], a[188:191], v[114:117]
    v_exp_f32 v239, v239
    v_mfma_f32_16x16x32_bf16 v[242:245], v[190:193], a[192:195], 0
    v_mov_b32_dpp v164, v203 quad_perm:[0,1,2,3] row_mask:0x2 bank_mask:0xf
    v_cvt_pk_bf16_f32 v236, v238, v239
    v_mfma_f32_16x16x32_bf16 v[242:245], v[198:201], a[196:199], v[242:245]
    ds_read2_b32 v[140:141], v6 offset0:0 offset1:0
    ds_read2_b32 v[192:193], v6 offset0:16 offset1:16
    v_mfma_f32_16x16x32_bf16 v[242:245], v[174:177], a[200:203], v[242:245]
    ds_read2_b32 v[176:177], v6 offset0:32 offset1:32
    v_add_u32 v6, 272, v6
    v_mfma_f32_16x16x32_f16 v[198:201], v[186:189], v[194:197], v[26:29]
    v_exp_f32 v202, v202
    v_mfma_f32_16x16x32_f16 v[198:201], v[210:213], v[126:129], v[198:201]
    v_cvt_pk_bf16_f32 v190, v114, v115
    v_cvt_pk_bf16_f32 v191, v116, v117
    v_mfma_f32_16x16x32_f16 v[198:201], v[214:217], v[222:225], v[198:201]
    v_exp_f32 v240, v240
    v_mfma_f32_16x16x32_bf16 v[242:245], v[206:209], a[204:207], v[242:245]
    v_exp_f32 v241, v241
    v_mfma_f32_16x16x32_bf16 v[242:245], v[230:233], a[208:211], v[242:245]
    v_cvt_pk_bf16_f32 v237, v240, v241
    v_xor_b32 v2, 65536, v2
    v_mfma_f32_16x16x32_bf16 v[242:245], v[182:185], a[212:215], v[242:245]
    v_exp_f32 v226, v226
    v_mfma_f32_16x16x32_f16 v[114:117], v[146:149], v[170:173], v[58:61]
    s_waitcnt lgkmcnt(1)
    v_exp_f32 v227, v227
    v_mfma_f32_16x16x32_f16 v[182:185], v[150:153], v[170:173], v[62:65]
    s_waitcnt lgkmcnt(0)
    v_mov_b32_dpp v164, v199 quad_perm:[0,1,2,3] row_mask:0x4 bank_mask:0xf
    v_cvt_pk_bf16_f32 v36, v226, v227
    v_mfma_f32_16x16x32_f16 v[186:189], v[126:129], v[170:173], v[66:69]
    v_exp_f32 v164, v164
    v_cvt_pk_bf16_f32 v174, v242, v243
    v_mfma_f32_16x16x16_f16 v[114:117], v[120:121], v[122:123], v[114:117]
    v_cvt_pk_bf16_f32 v164, v164, v164
    v_exp_f32 v228, v228
    v_mfma_f32_16x16x16_f16 v[182:185], v[124:125], v[122:123], v[182:185]
    v_cvt_pk_bf16_f32 v175, v244, v245
    v_exp_f32 v229, v229
    v_mfma_f32_16x16x16_f16 v[186:189], v[224:225], v[122:123], v[186:189]
    v_cvt_pk_bf16_f32 v37, v228, v229
    v_exp_f32 v218, v218
    v_mfma_f32_16x16x32_bf16 v[170:173], v[166:169], a[216:219], 0
    ds_write_b16 v8, v164
    v_mfma_f32_16x16x32_bf16 v[170:173], v[166:169], a[240:243], v[170:173]
    v_exp_f32 v114, v114
    v_mfma_f32_16x16x32_f16 v[206:209], v[146:149], v[194:197], v[70:73]
    v_exp_f32 v115, v115
    v_mfma_f32_16x16x32_f16 v[146:149], v[150:153], v[194:197], v[74:77]
    v_cvt_pk_bf16_f32 v114, v114, v115
    v_cvt_pk_bf16_f32 v39, v218, 0
    v_mfma_f32_16x16x32_bf16 v[170:173], v[166:169], v[90:93], v[170:173]
    v_exp_f32 v116, v116
    v_mfma_f32_16x16x32_bf16 v[150:153], v[28:31], v[36:39], 0
    v_exp_f32 v117, v117
    v_mfma_f32_16x16x32_bf16 v[150:153], v[28:31], v[234:237], v[150:153]
    v_exp_f32 v182, v182
    v_mfma_f32_16x16x32_bf16 v[210:213], v[138:141], v[36:39], 0
    v_exp_f32 v183, v183
    v_mfma_f32_16x16x32_bf16 v[210:213], v[134:137], v[234:237], v[210:213]
    v_mov_b32 v254, v170
    v_mov_b32_dpp v254, v171 quad_perm:[0,1,2,3] row_mask:0x2 bank_mask:0xf
    v_mfma_f32_16x16x32_bf16 v[170:173], v[190:193], v[36:39], 0
    v_cvt_pk_bf16_f32 v115, v116, v117
    v_cvt_pk_bf16_f32 v116, v182, v183
    v_mfma_f32_16x16x32_bf16 v[170:173], v[142:145], v[234:237], v[170:173]
    v_exp_f32 v184, v184
    v_mfma_f32_16x16x32_bf16 v[214:217], v[174:177], v[36:39], 0
    v_exp_f32 v185, v185
    v_mfma_f32_16x16x32_bf16 v[214:217], v[178:181], v[234:237], v[214:217]
    v_cvt_pk_bf16_f32 v117, v184, v185
    v_cvt_pk_bf16_f32 v39, v202, 0
    v_mfma_f32_16x16x32_f16 v[182:185], v[126:129], v[194:197], v[78:81]
    v_exp_f32 v186, v186
    v_mfma_f32_16x16x16_f16 v[206:209], v[120:121], v[222:223], v[206:209]
    v_exp_f32 v187, v187
    v_mfma_f32_16x16x16_f16 v[146:149], v[124:125], v[222:223], v[146:149]
    v_cvt_pk_bf16_f32 v36, v186, v187
    v_exp_f32 v188, v188
    v_mfma_f32_16x16x16_f16 v[182:185], v[224:225], v[222:223], v[182:185]
    v_exp_f32 v189, v189
    v_rcp_f32 v150, v150
    v_mfma_f32_16x16x32_bf16 v[118:121], v[166:169], a[220:223], 0
    v_cvt_pk_bf16_f32 v37, v188, v189
    v_max3_u32 v25, v25, v150, v151
    v_mfma_f32_16x16x32_bf16 v[118:121], v[166:169], a[244:247], v[118:121]
    v_mul_f32 v210, v150, v210
    v_mul_f32 v211, v150, v211
    v_mfma_f32_16x16x32_bf16 v[126:129], v[28:31], v[36:39], 0
    v_cvt_pk_bf16_f32 v210, v210, v211
    v_mul_f32 v212, v150, v212
    v_mfma_f32_16x16x32_bf16 v[126:129], v[28:31], v[114:117], v[126:129]
    v_mul_f32 v213, v150, v213
    v_cvt_pk_bf16_f32 v211, v212, v213
    v_mfma_f32_16x16x32_bf16 v[122:125], v[138:141], v[36:39], 0
    v_mul_f32 v170, v150, v170
    v_mul_f32 v171, v150, v171
    v_mfma_f32_16x16x32_bf16 v[122:125], v[134:137], v[114:117], v[122:125]
    v_cvt_pk_bf16_f32 v212, v170, v171
    v_mul_f32 v172, v150, v172
    v_mfma_f32_16x16x32_bf16 v[218:221], v[190:193], v[36:39], 0
    v_mul_f32 v173, v150, v173
    v_cvt_pk_bf16_f32 v213, v172, v173
    v_mfma_f32_16x16x32_bf16 v[218:221], v[142:145], v[114:117], v[218:221]
    v_mul_f32 v214, v150, v214
    v_mul_f32 v215, v150, v215
    v_mfma_f32_16x16x32_bf16 v[170:173], v[174:177], v[36:39], 0
    v_cvt_pk_bf16_f32 v164, v214, v215
    v_mul_f32 v216, v150, v216
    v_mfma_f32_16x16x32_bf16 v[170:173], v[178:181], v[114:117], v[170:173]
    v_mul_f32 v217, v150, v217
    v_cvt_pk_bf16_f32 v165, v216, v217
    v_mfma_f32_16x16x32_bf16 v[118:121], v[166:169], v[94:97], v[118:121]
    v_exp_f32 v206, v206
    v_mfma_f32_16x16x32_bf16 v[114:117], v[166:169], a[232:235], 0
    v_exp_f32 v207, v207
    v_mfma_f32_16x16x32_bf16 v[114:117], v[166:169], v[82:85], v[114:117]
    v_exp_f32 v208, v208
    v_mfma_f32_16x16x32_bf16 v[114:117], v[166:169], v[106:109], v[114:117]
    v_exp_f32 v209, v209
    v_mfma_f32_16x16x32_bf16 v[150:153], v[166:169], a[224:227], 0
    v_mov_b32 v128, v119
    v_cvt_pk_bf16_f32 v206, v206, v207
    v_mfma_f32_16x16x32_bf16 v[150:153], v[166:169], a[248:251], v[150:153]
    v_exp_f32 v146, v146
    v_mfma_f32_16x16x32_bf16 v[150:153], v[166:169], v[98:101], v[150:153]
    v_exp_f32 v147, v147
    v_mfma_f32_16x16x32_bf16 v[186:189], v[166:169], a[228:231], 0
    v_mov_b32_dpp v254, v114 quad_perm:[0,1,2,3] row_mask:0x4 bank_mask:0xf
    v_mov_b32_dpp v254, v118 quad_perm:[0,1,2,3] row_mask:0x8 bank_mask:0xf
    v_mfma_f32_16x16x32_bf16 v[186:189], v[166:169], a[252:255], v[186:189]
    ds_write_b32 v159, v254 offset:18432
    v_mfma_f32_16x16x32_bf16 v[186:189], v[166:169], v[102:105], v[186:189]
    v_mov_b32_dpp v128, v115 quad_perm:[0,1,2,3] row_mask:0x2 bank_mask:0xf
    v_mov_b32_dpp v128, v150 quad_perm:[0,1,2,3] row_mask:0x4 bank_mask:0xf
    v_mfma_f32_16x16x32_bf16 v[114:117], v[166:169], a[236:239], 0
    v_mov_b32_dpp v128, v151 quad_perm:[0,1,2,3] row_mask:0x8 bank_mask:0xf
    v_cvt_pk_bf16_f32 v207, v208, v209
    v_mfma_f32_16x16x32_bf16 v[114:117], v[166:169], v[86:89], v[114:117]
    ds_write_b32 v159, v128 offset:19456
    v_mfma_f32_16x16x32_bf16 v[114:117], v[166:169], v[110:113], v[114:117]
    v_cvt_pk_bf16_f32 v208, v146, v147
    v_exp_f32 v148, v148
    v_exp_f32 v149, v149
    v_exp_f32 v182, v182
    v_cvt_pk_bf16_f32 v209, v148, v149
    v_exp_f32 v183, v183
    v_exp_f32 v184, v184
    v_cvt_pk_bf16_f32 v36, v182, v183
    v_mov_b32 v254, v114
    v_mov_b32_dpp v254, v186 quad_perm:[0,1,2,3] row_mask:0x2 bank_mask:0xf
    v_mov_b32_dpp v254, v187 quad_perm:[0,1,2,3] row_mask:0x4 bank_mask:0xf
    v_mov_b32_dpp v254, v115 quad_perm:[0,1,2,3] row_mask:0x8 bank_mask:0xf
    v_exp_f32 v185, v185
    ds_read_b128 v[114:117], v9
    ds_read_b128 v[118:121], v9 offset:64
    ds_write_b32 v159, v254 offset:63552
    v_cvt_pk_bf16_f32 v37, v184, v185
    v_exp_f32 v198, v198
    v_rcp_f32 v126, v126
    v_cvt_pk_bf16_f32 v39, v198, 0
    v_max3_u32 v25, v25, v126, v127
    v_mul_f32 v122, v126, v122
    v_mfma_f32_16x16x32_bf16 v[146:149], v[28:31], v[36:39], 0
    v_mul_f32 v123, v126, v123
    v_cvt_pk_bf16_f32 v150, v122, v123
    v_mfma_f32_16x16x32_bf16 v[146:149], v[28:31], v[206:209], v[146:149]
    v_mul_f32 v124, v126, v124
    v_mul_f32 v125, v126, v125
    v_mfma_f32_16x16x32_bf16 v[158:161], v[138:141], v[36:39], 0
    v_cvt_pk_bf16_f32 v151, v124, v125
    v_mul_f32 v218, v126, v218
    v_mfma_f32_16x16x32_bf16 v[158:161], v[134:137], v[206:209], v[158:161]
    v_mul_f32 v219, v126, v219
    v_cvt_pk_bf16_f32 v152, v218, v219
    v_mfma_f32_16x16x32_bf16 v[166:169], v[190:193], v[36:39], 0
    s_waitcnt lgkmcnt(1)
    v_rcp_f32 v146, v146
    v_mfma_f32_16x16x32_bf16 v[182:185], v[114:117], v[28:31], 0
    s_waitcnt lgkmcnt(0)
    v_max3_u32 v25, v25, v146, v147
    v_mul_f32 v158, v146, v158
    v_mfma_f32_16x16x32_bf16 v[182:185], v[118:121], v[28:31], v[182:185]
    s_barrier
    ds_read_b128 v[198:201], v255 offset:18432
    ds_read_b128 v[214:217], v255 offset:19456
    v_mfma_f32_16x16x32_bf16 v[222:225], v[114:117], v[134:137], 0
    s_waitcnt vmcnt(0)
    ds_read_b128 v[134:137], v255 offset:63552
    v_mul_f32 v159, v146, v159
    v_mfma_f32_16x16x32_bf16 v[222:225], v[118:121], v[138:141], v[222:225]
    s_barrier
    ds_read_b128 v[186:189], v0 offset:20480
    ds_read_b128 v[194:197], v1 offset:20480
    v_mfma_f32_16x16x32_bf16 v[138:141], v[114:117], v[142:145], 0
    buffer_load_dwordx4 v10, s[8:11], 0 offen nt lds
    ds_read_b128 v[122:125], v0 offset:20608
    v_mfma_f32_16x16x32_bf16 v[138:141], v[118:121], v[190:193], v[138:141]
    s_add_u32 m0, s28, 4096
    v_rcp_f32 v182, v182
    v_mfma_f32_16x16x32_bf16 v[226:229], v[114:117], v[178:181], 0
    ds_read_b128 v[202:205], v1 offset:20608
    ds_read_b128 v[230:233], v0 offset:20736
    v_mfma_f32_16x16x32_bf16 v[226:229], v[118:121], v[174:177], v[226:229]
    v_max3_u32 v25, v25, v182, v183
    v_mul_f32 v222, v222, v182
    v_mfma_f32_16x16x32_bf16 v[166:169], v[142:145], v[206:209], v[166:169]
    ds_read_b128 v[238:241], v1 offset:20736
    v_mul_f32_dpp v222, v138, v182 quad_perm:[0,1,2,3] row_mask:0x2 bank_mask:0xf
    v_mfma_f32_16x16x32_bf16 v[114:117], v[174:177], v[36:39], 0
    s_waitcnt lgkmcnt(7)
    ds_write_b128 v3, v[210:213] offset:0
    v_mfma_f32_16x16x32_bf16 v[114:117], v[178:181], v[206:209], v[114:117]
    s_waitcnt lgkmcnt(5)
    buffer_load_dwordx4 v11, s[8:11], 0 offen nt lds
    v_add_f32 v198, v198, v199
    v_mfma_f32_16x16x32_bf16 v[118:121], a[72:75], v[186:189], 0
    s_add_u32 m0, s28, 8192
    v_add_f32 v200, v200, v201
    v_add_f32 v198, v198, v200
    v_mfma_f32_16x16x32_bf16 v[118:121], a[76:79], v[194:197], v[118:121]
    s_waitcnt lgkmcnt(4)
    ds_write_b64 v4, v[164:165] offset:4096
    v_mfma_f32_16x16x32_bf16 v[118:121], a[80:83], v[122:125], v[118:121]
    s_waitcnt lgkmcnt(3)
    v_mul_f32 v198, 0xbbaaaaab, v198
    v_add_f32 v214, v214, v215
    v_mfma_f32_16x16x32_bf16 v[118:121], a[84:87], v[202:205], v[118:121]
    ds_write_b32 v132, v198 offset:0
    v_mfma_f32_16x16x32_bf16 v[118:121], a[88:91], v[230:233], v[118:121]
    s_waitcnt lgkmcnt(3)
    buffer_load_dwordx4 v12, s[8:11], 0 offen nt lds
    v_add_f32 v216, v216, v217
    v_mfma_f32_16x16x32_bf16 v[118:121], a[92:95], v[238:241], v[118:121]
    s_add_u32 m0, s28, 12288
    ds_read_b128 v[138:141], v157 offset:0
    ds_read_b128 v[142:145], v157 offset:64
    v_mfma_f32_16x16x32_bf16 v[190:193], a[96:99], v[186:189], 0
    s_xor_b32 s28, s28, 65536
    ds_read_b128 v[174:177], v157 offset:128
    ds_read_b128 v[178:181], v157 offset:192
    v_mfma_f32_16x16x32_bf16 v[190:193], a[100:103], v[194:197], v[190:193]
    v_add_f32 v214, v214, v216
    v_mul_f32 v214, 0xbbaaaaab, v214
    v_mfma_f32_16x16x32_bf16 v[190:193], a[104:107], v[122:125], v[190:193]
    ds_write_b32 v132, v214 offset:256
    v_mfma_f32_16x16x32_bf16 v[190:193], a[108:111], v[202:205], v[190:193]
    v_add_f32 v134, v134, v135
    v_add_f32 v136, v136, v137
    v_mfma_f32_16x16x32_bf16 v[190:193], a[112:115], v[230:233], v[190:193]
    buffer_load_dwordx4 v13, s[8:11], 0 offen nt lds
    ds_read_b128 v[206:209], v157 offset:256
    v_mfma_f32_16x16x32_bf16 v[190:193], a[116:119], v[238:241], v[190:193]
    s_mov_b32 m0, s29
    v_add_f32 v134, v134, v136
    v_mul_f32 v134, 0xbbaaaaab, v134
    v_mfma_f32_16x16x32_bf16 v[198:201], a[120:123], v[186:189], 0
    s_xor_b32 s29, s29, s30
    ds_write_b32 v132, v134 offset:512
    v_mfma_f32_16x16x32_bf16 v[198:201], a[124:127], v[194:197], v[198:201]
    s_waitcnt lgkmcnt(5)
    v_mul_f32_dpp v222, v226, v182 quad_perm:[0,1,2,3] row_mask:0x4 bank_mask:0xf
    v_cvt_pk_bf16_f32 v222, v222, v222
    v_cvt_pk_bf16_f32 v130, v158, v159
    v_mfma_f32_16x16x16_bf16 v[134:137], a[216:217], v[162:163], v[138:141]
    v_mul_f32 v160, v146, v160
    v_mul_f32 v161, v146, v161
    v_cvt_pk_bf16_f32 v131, v160, v161
    v_mfma_f32_16x16x16_bf16 v[158:161], a[240:241], v[162:163], v[138:141]
    v_mul_f32 v166, v146, v166
    v_mul_f32 v167, v146, v167
    v_cvt_pk_bf16_f32 v132, v166, v167
    v_mfma_f32_16x16x16_bf16 v[182:185], v[90:91], v[162:163], v[138:141]
    v_cvt_pk_bf16_f32 v134, v134, v135
    v_accvgpr_write_b32 a216, v134
    v_cvt_pk_bf16_f32 v136, v136, v137
    v_mfma_f32_16x16x16_bf16 v[210:213], a[218:219], v[162:163], v[142:145]
    v_accvgpr_write_b32 a217, v136
    v_cvt_pk_bf16_f32 v158, v158, v159
    v_accvgpr_write_b32 a240, v158
    v_mfma_f32_16x16x16_bf16 v[134:137], a[242:243], v[162:163], v[142:145]
    v_cvt_pk_bf16_f32 v160, v160, v161
    v_accvgpr_write_b32 a241, v160
    v_cvt_pk_bf16_f32 v90, v182, v183
    v_mfma_f32_16x16x16_bf16 v[138:141], v[92:93], v[162:163], v[142:145]
    v_cvt_pk_bf16_f32 v91, v184, v185
    v_cvt_pk_bf16_f32 v210, v210, v211
    v_accvgpr_write_b32 a218, v210
    v_cvt_pk_bf16_f32 v212, v212, v213
    v_mfma_f32_16x16x32_bf16 v[198:201], a[128:131], v[122:125], v[198:201]
    s_waitcnt lgkmcnt(0)
    buffer_load_dwordx4 v14, s[8:11], 0 offen nt lds
    ds_read_b128 v[142:145], v157 offset:320
    v_accvgpr_write_b32 a219, v212
    v_mfma_f32_16x16x16_bf16 v[158:161], a[232:233], v[162:163], v[174:177]
    v_cvt_pk_bf16_f32 v134, v134, v135
    v_accvgpr_write_b32 a242, v134
    v_cvt_pk_bf16_f32 v136, v136, v137
    v_mfma_f32_16x16x16_bf16 v[182:185], v[82:83], v[162:163], v[174:177]
    v_accvgpr_write_b32 a243, v136
    v_cvt_pk_bf16_f32 v92, v138, v139
    v_cvt_pk_bf16_f32 v93, v140, v141
    v_mfma_f32_16x16x16_bf16 v[134:137], v[106:107], v[162:163], v[174:177]
    v_cvt_pk_bf16_f32 v158, v158, v159
    v_accvgpr_write_b32 a232, v158
    v_cvt_pk_bf16_f32 v160, v160, v161
    v_mfma_f32_16x16x16_bf16 v[138:141], a[220:221], v[162:163], v[178:181]
    v_accvgpr_write_b32 a233, v160
    v_cvt_pk_bf16_f32 v82, v182, v183
    v_cvt_pk_bf16_f32 v83, v184, v185
    v_mfma_f32_16x16x16_bf16 v[158:161], a[244:245], v[162:163], v[178:181]
    v_cvt_pk_bf16_f32 v106, v134, v135
    v_cvt_pk_bf16_f32 v107, v136, v137
    v_mul_f32 v168, v146, v168
    v_mfma_f32_16x16x16_bf16 v[134:137], v[94:95], v[162:163], v[178:181]
    v_cvt_pk_bf16_f32 v138, v138, v139
    v_accvgpr_write_b32 a220, v138
    v_cvt_pk_bf16_f32 v140, v140, v141
    v_mfma_f32_16x16x16_bf16 v[174:177], a[222:223], v[162:163], v[206:209]
    v_accvgpr_write_b32 a221, v140
    v_cvt_pk_bf16_f32 v158, v158, v159
    v_accvgpr_write_b32 a244, v158
    v_mfma_f32_16x16x16_bf16 v[138:141], a[246:247], v[162:163], v[206:209]
    v_cvt_pk_bf16_f32 v160, v160, v161
    v_accvgpr_write_b32 a245, v160
    v_cvt_pk_bf16_f32 v94, v134, v135
    v_mfma_f32_16x16x16_bf16 v[158:161], v[96:97], v[162:163], v[206:209]
    v_cvt_pk_bf16_f32 v95, v136, v137
    v_cvt_pk_bf16_f32 v174, v174, v175
    v_accvgpr_write_b32 a222, v174
    v_cvt_pk_bf16_f32 v176, v176, v177
    v_mfma_f32_16x16x32_bf16 v[198:201], a[132:135], v[202:205], v[198:201]
    s_waitcnt lgkmcnt(0)
    ds_read_b128 v[134:137], v157 offset:384
    ds_read_b128 v[178:181], v157 offset:448
    ds_read_b128 v[182:185], v157 offset:512
    v_mfma_f32_16x16x16_bf16 v[206:209], a[234:235], v[162:163], v[142:145]
    v_accvgpr_write_b32 a223, v176
    v_cvt_pk_bf16_f32 v138, v138, v139
    v_accvgpr_write_b32 a246, v138
    v_mfma_f32_16x16x16_bf16 v[174:177], v[84:85], v[162:163], v[142:145]
    v_cvt_pk_bf16_f32 v140, v140, v141
    v_accvgpr_write_b32 a247, v140
    v_cvt_pk_bf16_f32 v96, v158, v159
    v_mfma_f32_16x16x16_bf16 v[210:213], v[108:109], v[162:163], v[142:145]
    v_cvt_pk_bf16_f32 v97, v160, v161
    v_cvt_pk_bf16_f32 v206, v206, v207
    v_accvgpr_write_b32 a234, v206
    v_cvt_pk_bf16_f32 v208, v208, v209
    v_mfma_f32_16x16x32_bf16 v[198:201], a[136:139], v[230:233], v[198:201]
    ds_read_b128 v[142:145], v157 offset:576
    v_accvgpr_write_b32 a235, v208
    v_mfma_f32_16x16x32_bf16 v[198:201], a[140:143], v[238:241], v[198:201]
    ds_write_b16 v7, v222
    v_mfma_f32_16x16x32_bf16 v[138:141], a[0:3], v[186:189], 0
    v_add_u32 v7, 16, v7
    v_cvt_pk_bf16_f32 v84, v174, v175
    v_mfma_f32_16x16x32_bf16 v[138:141], a[4:7], v[194:197], v[138:141]
    s_waitcnt lgkmcnt(3)
    v_cvt_pk_bf16_f32 v85, v176, v177
    v_cvt_pk_bf16_f32 v108, v210, v211
    v_cvt_pk_bf16_f32 v109, v212, v213
    v_mfma_f32_16x16x16_bf16 v[158:161], a[224:225], v[162:163], v[134:137]
    v_mul_f32 v169, v146, v169
    v_cvt_pk_bf16_f32 v133, v168, v169
    v_mul_f32 v114, v146, v114
    v_mfma_f32_16x16x16_bf16 v[166:169], a[248:249], v[162:163], v[134:137]
    v_mul_f32 v115, v146, v115
    v_cvt_pk_bf16_f32 v218, v114, v115
    v_mul_f32 v116, v146, v116
    v_mfma_f32_16x16x16_bf16 v[174:177], v[98:99], v[162:163], v[134:137]
    v_cvt_pk_bf16_f32 v158, v158, v159
    v_accvgpr_write_b32 a224, v158
    v_cvt_pk_bf16_f32 v160, v160, v161
    v_mfma_f32_16x16x16_bf16 v[206:209], a[226:227], v[162:163], v[178:181]
    v_accvgpr_write_b32 a225, v160
    v_cvt_pk_bf16_f32 v166, v166, v167
    v_accvgpr_write_b32 a248, v166
    v_mfma_f32_16x16x16_bf16 v[134:137], a[250:251], v[162:163], v[178:181]
    v_cvt_pk_bf16_f32 v168, v168, v169
    v_accvgpr_write_b32 a249, v168
    v_cvt_pk_bf16_f32 v98, v174, v175
    v_mfma_f32_16x16x16_bf16 v[158:161], v[100:101], v[162:163], v[178:181]
    v_cvt_pk_bf16_f32 v99, v176, v177
    v_cvt_pk_bf16_f32 v206, v206, v207
    v_accvgpr_write_b32 a226, v206
    v_cvt_pk_bf16_f32 v208, v208, v209
    v_mfma_f32_16x16x32_bf16 v[138:141], a[8:11], v[122:125], v[138:141]
    s_waitcnt lgkmcnt(0)
    ds_read_b128 v[166:169], v157 offset:640
    ds_read_b128 v[174:177], v157 offset:704
    v_accvgpr_write_b32 a227, v208
    v_mfma_f32_16x16x16_bf16 v[154:157], a[236:237], v[162:163], v[182:185]
    v_cvt_pk_bf16_f32 v134, v134, v135
    v_accvgpr_write_b32 a250, v134
    v_cvt_pk_bf16_f32 v136, v136, v137
    v_mfma_f32_16x16x16_bf16 v[178:181], v[86:87], v[162:163], v[182:185]
    v_accvgpr_write_b32 a251, v136
    v_cvt_pk_bf16_f32 v100, v158, v159
    v_cvt_pk_bf16_f32 v101, v160, v161
    v_mfma_f32_16x16x16_bf16 v[134:137], v[110:111], v[162:163], v[182:185]
    v_cvt_pk_bf16_f32 v154, v154, v155
    v_accvgpr_write_b32 a236, v154
    v_cvt_pk_bf16_f32 v156, v156, v157
    v_mfma_f32_16x16x16_bf16 v[158:161], a[228:229], v[162:163], v[142:145]
    v_accvgpr_write_b32 a237, v156
    v_cvt_pk_bf16_f32 v86, v178, v179
    v_cvt_pk_bf16_f32 v87, v180, v181
    v_mfma_f32_16x16x16_bf16 v[154:157], a[252:253], v[162:163], v[142:145]
    v_cvt_pk_bf16_f32 v110, v134, v135
    v_cvt_pk_bf16_f32 v111, v136, v137
    v_mul_f32 v117, v146, v117
    v_mfma_f32_16x16x16_bf16 v[134:137], v[102:103], v[162:163], v[142:145]
    v_cvt_pk_bf16_f32 v158, v158, v159
    v_accvgpr_write_b32 a228, v158
    v_cvt_pk_bf16_f32 v160, v160, v161
    v_accvgpr_write_b32 a229, v160
    v_mfma_f32_16x16x32_bf16 v[138:141], a[12:15], v[202:205], v[138:141]
    s_waitcnt lgkmcnt(0)
    ds_write_b128 v3, v[130:133] offset:12288
    v_mfma_f32_16x16x16_bf16 v[130:133], a[230:231], v[162:163], v[166:169]
    v_cvt_pk_bf16_f32 v154, v154, v155
    v_accvgpr_write_b32 a252, v154
    v_cvt_pk_bf16_f32 v156, v156, v157
    v_mfma_f32_16x16x16_bf16 v[142:145], a[254:255], v[162:163], v[166:169]
    v_accvgpr_write_b32 a253, v156
    v_cvt_pk_bf16_f32 v102, v134, v135
    v_cvt_pk_bf16_f32 v103, v136, v137
    v_mfma_f32_16x16x16_bf16 v[134:137], v[104:105], v[162:163], v[166:169]
    v_cvt_pk_bf16_f32 v130, v130, v131
    v_accvgpr_write_b32 a230, v130
    v_cvt_pk_bf16_f32 v132, v132, v133
    v_mfma_f32_16x16x16_bf16 v[146:149], a[238:239], v[162:163], v[174:177]
    v_accvgpr_write_b32 a231, v132
    v_cvt_pk_bf16_f32 v142, v142, v143
    v_accvgpr_write_b32 a254, v142
    v_mfma_f32_16x16x16_bf16 v[130:133], v[88:89], v[162:163], v[174:177]
    v_cvt_pk_bf16_f32 v144, v144, v145
    v_accvgpr_write_b32 a255, v144
    v_cvt_pk_bf16_f32 v104, v134, v135
    v_mfma_f32_16x16x16_bf16 v[142:145], v[112:113], v[162:163], v[174:177]
    v_cvt_pk_bf16_f32 v105, v136, v137
    v_cvt_pk_bf16_f32 v146, v146, v147
    v_accvgpr_write_b32 a238, v146
    v_cvt_pk_bf16_f32 v148, v148, v149
    v_mfma_f32_16x16x32_bf16 v[138:141], a[16:19], v[230:233], v[138:141]
    v_accvgpr_write_b32 a239, v148
    v_cvt_pk_bf16_f32 v88, v130, v131
    v_mfma_f32_16x16x32_bf16 v[138:141], a[20:23], v[238:241], v[138:141]
    v_cvt_pk_bf16_f32 v89, v132, v133
    v_cvt_pk_bf16_f32 v112, v142, v143
    v_mfma_f32_16x16x32_bf16 v[166:169], a[24:27], v[186:189], 0
    v_cvt_pk_bf16_f32 v113, v144, v145
    v_cvt_pk_bf16_f32 v219, v116, v117
    v_mfma_f32_16x16x32_bf16 v[166:169], a[28:31], v[194:197], v[166:169]
    ds_write_b64 v4, v[218:219] offset:16384
    v_mfma_f32_16x16x32_bf16 v[166:169], a[32:35], v[122:125], v[166:169]
    v_mul_f32 v220, v126, v220
    v_mul_f32 v221, v126, v221
    v_mfma_f32_16x16x32_bf16 v[166:169], a[36:39], v[202:205], v[166:169]
    v_cvt_pk_bf16_f32 v153, v220, v221
    v_mul_f32 v170, v126, v170
    v_mfma_f32_16x16x32_bf16 v[166:169], a[40:43], v[230:233], v[166:169]
    ds_write_b128 v3, v[150:153] offset:6144
    v_mfma_f32_16x16x32_bf16 v[166:169], a[44:47], v[238:241], v[166:169]
    v_mul_f32 v171, v126, v171
    v_cvt_pk_bf16_f32 v254, v170, v171
    v_mfma_f32_16x16x32_bf16 v[134:137], a[48:51], v[186:189], 0
    v_mul_f32 v172, v126, v172
    v_mul_f32 v173, v126, v173
    v_mfma_f32_16x16x32_bf16 v[134:137], a[52:55], v[194:197], v[134:137]
    v_cvt_pk_bf16_f32 v255, v172, v173
    ds_write_b64 v4, v[254:255] offset:10240
    v_cvt_pk_f16_f32 v146, v118, v119
    v_pk_mul_f16 v143, v146, v146
    v_cvt_pk_f16_f32 v147, v120, v121
    v_pk_fma_f16 v143, v147, v147, v143
    v_cvt_pk_f16_f32 v148, v190, v191
    v_pk_fma_f16 v143, v148, v148, v143
    v_cvt_pk_f16_f32 v149, v192, v193
    v_pk_fma_f16 v143, v149, v149, v143
    v_cvt_pk_f16_f32 v120, v198, v199
    v_pk_fma_f16 v143, v120, v120, v143
    v_cvt_pk_f16_f32 v121, v200, v201
    v_pk_fma_f16 v143, v121, v121, v143
    v_xor_b32 v3, 65536, v3
    v_xor_b32 v4, 65536, v4
    s_waitcnt lgkmcnt(0)
    s_barrier
L_go:
    s_waitcnt lgkmcnt(0)
    s_and_b32 s3, s2, 0xf8
    s_add_u32 s64, s42, s3
    s_addc_u32 s65, s43, 0
    s_mov_b32 s67, 0x00020000
    s_cmp_eq_u32 s16, 1
    s_cbranch_scc1 L_loop_fast1
    s_cmp_eq_u32 s16, 2
    s_cbranch_scc1 L_loop_fast2
    s_cmp_eq_u32 s16, 3
    s_cbranch_scc1 L_loop_fast3
    s_branch L_loop_fast0
.p2align 6
L_loop_fast0:
    v_mfma_f32_16x16x32_bf16 v[134:137], a[56:59], v[122:125], v[134:137]
    s_add_u32 s12, s40, s27
    ds_read_b128 v[190:193], v2 offset:18432
    v_cvt_pk_f16_f32 v150, v138, v139
    v_mfma_f32_16x16x32_bf16 v[134:137], a[60:63], v[202:205], v[134:137]
    s_addc_u32 s13, s41, 0
    ds_read_b128 v[210:213], v2 offset:19456
    v_pk_mul_f16 v142, v150, v150
    v_mfma_f32_16x16x32_bf16 v[134:137], a[64:67], v[230:233], v[134:137]
    s_sub_u32 s14, s36, s27
    ds_read_b128 v[174:177], v5 offset:32
    v_cvt_pk_f16_f32 v151, v140, v141
    v_mfma_f32_16x16x32_bf16 v[134:137], a[68:71], v[238:241], v[134:137]
    s_cmp_ge_u32 s18, 2
    ds_read2_b64 v[162:165], v5 offset0:6 offset1:9
    v_pk_fma_f16 v142, v151, v151, v142
    v_mfma_f32_16x16x32_bf16 v[138:141], v[186:189], a[144:147], 0
    s_cselect_b32 s14, s14, 0
    ds_read_b128 v[170:173], v5
    v_cvt_pk_f16_f32 v152, v166, v167
    v_mfma_f32_16x16x32_bf16 v[138:141], v[194:197], a[148:151], v[138:141]
    s_sub_u32 s82, s72, s71
    ds_read_b32 v254, v6 offset:192
    v_pk_fma_f16 v142, v152, v152, v142
    v_mfma_f32_16x16x32_bf16 v[138:141], v[122:125], a[152:155], v[138:141]
    s_mul_i32 s74, s82, 336
    v_cvt_pk_f16_f32 v153, v168, v169
    v_pk_fma_f16 v142, v153, v153, v142
    v_mfma_f32_16x16x32_bf16 v[138:141], v[202:205], a[156:159], v[138:141]
    s_mul_i32 s75, s82, 272
    v_cvt_pk_f16_f32 v118, v134, v135
    v_pk_fma_f16 v142, v118, v118, v142
    v_mfma_f32_16x16x32_bf16 v[138:141], v[230:233], a[160:163], v[138:141]
    s_waitcnt lgkmcnt(5)
    ds_read_b128 v[182:185], v0 offset:26624
    v_cvt_pk_f16_f32 v119, v136, v137
    v_mfma_f32_16x16x32_bf16 v[166:169], v[32:35], v[190:193], 0
    s_waitcnt lgkmcnt(5)
    v_pk_fma_f16 v142, v119, v119, v142
    v_add_u32 v5, s74, v5
    v_mfma_f32_16x16x32_bf16 v[166:169], v[32:35], v[210:213], v[166:169]
    s_waitcnt lgkmcnt(4)
    v_pk_mul_f16 v145, v146, v174
    v_pk_fma_f16 v145, v147, v175, v145
    v_mfma_f32_16x16x32_bf16 v[138:141], v[238:241], a[164:167], v[138:141]
    s_mul_i32 s76, s82, 16
    ds_read_b128 v[210:213], v1 offset:26624
    v_pk_fma_f16 v145, v148, v176, v145
    v_mfma_f32_16x16x32_bf16 v[214:217], v[186:189], a[168:171], 0
    s_waitcnt lgkmcnt(3)
    ds_read_b128 v[218:221], v0 offset:26752
    v_pk_fma_f16 v145, v149, v177, v145
    v_mfma_f32_16x16x32_bf16 v[214:217], v[194:197], a[172:175], v[214:217]
    s_waitcnt lgkmcnt(3)
    ds_read_b128 v[222:225], v1 offset:26752
    v_mov_b32_dpp v254, v23 quad_perm:[0,1,2,3] row_mask:0x7 bank_mask:0xf
    v_mfma_f32_16x16x32_bf16 v[214:217], v[122:125], a[176:179], v[214:217]
    s_add_u32 s34, s18, 2
    ds_read_b128 v[226:229], v0 offset:26880
    v_pk_fma_f16 v145, v120, v164, v145
    v_mfma_f32_16x16x32_bf16 v[214:217], v[202:205], a[180:183], v[214:217]
    s_add_u32 s8, s60, s23
    ds_read_b128 v[190:193], v1 offset:26880
    v_pk_fma_f16 v145, v121, v165, v145
    v_mfma_f32_16x16x32_bf16 v[214:217], v[230:233], a[184:187], v[214:217]
    s_waitcnt lgkmcnt(5)
    v_pk_mul_f16 v144, v150, v170
    v_pk_fma_f16 v144, v151, v171, v144
    v_mfma_f32_16x16x32_bf16 v[214:217], v[238:241], a[188:191], v[214:217]
    s_addc_u32 s9, s61, 0
    v_pk_fma_f16 v144, v152, v172, v144
    v_pk_fma_f16 v144, v153, v173, v144
    v_mfma_f32_16x16x32_bf16 v[246:249], v[186:189], a[192:195], 0
    s_sub_u32 s10, s36, s23
    v_pk_fma_f16 v144, v118, v162, v144
    v_pk_fma_f16 v144, v119, v163, v144
    v_mfma_f32_16x16x32_bf16 v[246:249], v[194:197], a[196:199], v[246:249]
    s_cmp_le_u32 s34, s45
    v_cvt_pk_bf16_f32 v134, v138, v139
    v_cvt_pk_bf16_f32 v135, v140, v141
    v_mfma_f32_16x16x32_f16 v[234:237], v[40:43], v[142:145], 0
    s_cselect_b32 s10, s10, 0
    v_cvt_pk_bf16_f32 v138, v214, v215
    v_cvt_pk_bf16_f32 v139, v216, v217
    v_mfma_f32_16x16x32_bf16 v[246:249], v[122:125], a[200:203], v[246:249]
    s_add_u32 m0, s28, 0
    v_mul_f32 v136, 0x3baaaaab, v166
    v_mul_f32 v255, 0x3baaaaab, v167
    v_mfma_f32_16x16x32_bf16 v[246:249], v[202:205], a[204:207], v[246:249]
    s_mov_b32 s27, s26
    v_rsq_f32 v234, v234
    v_mfma_f32_16x16x32_bf16 v[246:249], v[230:233], a[208:211], v[246:249]
    s_mov_b32 s26, s25
    v_rsq_f32 v235, v235
    v_mfma_f32_16x16x32_bf16 v[246:249], v[238:241], a[212:215], v[246:249]
    s_mov_b32 s25, s24
    v_mul_f32 v140, s31, v234
    v_cvt_pk_f16_f32 v141, v140, v235
    v_mfma_f32_16x16x32_bf16 v[122:125], a[72:75], v[182:185], 0
    s_waitcnt lgkmcnt(0)
    v_fma_f32 v236, v236, v140, v22
    v_fmac_f32_dpp v254, v237, v235 quad_perm:[0,1,2,3] row_mask:0x1 bank_mask:0xf
    v_mfma_f32_16x16x32_bf16 v[122:125], a[76:79], v[210:213], v[122:125]
    s_mov_b32 s24, s23
    v_cvt_pk_bf16_f32 v142, v246, v247
    v_cvt_pk_bf16_f32 v143, v248, v249
    v_mfma_f32_16x16x32_bf16 v[122:125], a[80:83], v[218:221], v[122:125]
    s_mov_b32 s71, s72
    v_pk_mul_f16 v146, v146, v141 op_sel:[0,1] op_sel_hi:[1,1]
    v_pk_mul_f16 v147, v147, v141 op_sel:[0,1] op_sel_hi:[1,1]
    v_mfma_f32_16x16x32_bf16 v[122:125], a[84:87], v[222:225], v[122:125]
    s_mov_b32 s72, s73
    v_pk_mul_f16 v148, v148, v141 op_sel:[0,1] op_sel_hi:[1,1]
    v_pk_mul_f16 v149, v149, v141 op_sel:[0,1] op_sel_hi:[1,1]
    v_mfma_f32_16x16x32_bf16 v[122:125], a[88:91], v[226:229], v[122:125]
    v_pk_mul_f16 v120, v120, v141 op_sel:[0,1] op_sel_hi:[1,1]
    v_pk_mul_f16 v121, v121, v141 op_sel:[0,1] op_sel_hi:[1,1]
    v_mfma_f32_16x16x32_bf16 v[122:125], a[92:95], v[190:193], v[122:125]
    v_pk_mul_f16 v150, v150, v141 op_sel:[0,0] op_sel_hi:[1,0]
    v_pk_mul_f16 v151, v151, v141 op_sel:[0,0] op_sel_hi:[1,0]
    v_mfma_f32_16x16x32_bf16 v[186:189], a[96:99], v[182:185], 0
    v_pk_mul_f16 v152, v152, v141 op_sel:[0,0] op_sel_hi:[1,0]
    v_pk_mul_f16 v153, v153, v141 op_sel:[0,0] op_sel_hi:[1,0]
    v_mfma_f32_16x16x32_bf16 v[186:189], a[100:103], v[210:213], v[186:189]
    v_pk_mul_f16 v118, v118, v141 op_sel:[0,0] op_sel_hi:[1,0]
    v_pk_mul_f16 v119, v119, v141 op_sel:[0,0] op_sel_hi:[1,0]
    v_mfma_f32_16x16x32_bf16 v[186:189], a[104:107], v[218:221], v[186:189]
    v_max3_u32 v44, v44, v234, v235
    v_mul_f32 v144, 0x3baaaaab, v168
    v_mfma_f32_16x16x32_bf16 v[186:189], a[108:111], v[222:225], v[186:189]
    v_rsq_f32 v136, v136
    v_mfma_f32_16x16x32_bf16 v[186:189], a[112:115], v[226:229], v[186:189]
    v_rsq_f32 v255, v255
    v_mfma_f32_16x16x32_bf16 v[186:189], a[116:119], v[190:193], v[186:189]
    v_rsq_f32 v144, v144
    v_mfma_f32_16x16x32_bf16 v[194:197], a[120:123], v[182:185], 0
    v_mul_f32 v178, v136, v178
    v_mul_f32 v179, v136, v179
    v_mfma_f32_16x16x32_bf16 v[194:197], a[124:127], v[210:213], v[194:197]
    v_cvt_pk_bf16_f32 v166, v178, v179
    v_mul_f32 v180, v136, v180
    v_mfma_f32_16x16x32_bf16 v[194:197], a[128:131], v[218:221], v[194:197]
    v_mul_f32 v181, v136, v181
    v_cvt_pk_bf16_f32 v167, v180, v181
    v_mfma_f32_16x16x32_bf16 v[194:197], a[132:135], v[222:225], v[194:197]
    v_mul_f32 v198, v136, v198
    v_mul_f32 v199, v136, v199
    v_mfma_f32_16x16x32_bf16 v[194:197], a[136:139], v[226:229], v[194:197]
    v_cvt_pk_bf16_f32 v168, v198, v199
    v_mul_f32 v200, v136, v200
    v_mfma_f32_16x16x32_bf16 v[194:197], a[140:143], v[190:193], v[194:197]
    v_mul_f32 v201, v136, v201
    v_cvt_pk_bf16_f32 v169, v200, v201
    v_mfma_f32_16x16x32_bf16 v[178:181], a[0:3], v[182:185], 0
    buffer_store_dwordx4 v[166:169], v15, s[12:15], 0 offen nt
    v_mul_f32 v206, v136, v206
    v_mul_f32 v207, v136, v207
    v_cvt_pk_bf16_f32 v140, v206, v207
    v_mul_f32 v208, v136, v208
    v_mfma_f32_16x16x32_bf16 v[178:181], a[4:7], v[210:213], v[178:181]
    v_mul_f32 v209, v136, v209
    v_cvt_pk_bf16_f32 v141, v208, v209
    v_mfma_f32_16x16x32_bf16 v[178:181], a[8:11], v[218:221], v[178:181]
    v_cvt_pk_f16_f32 v166, v122, v123
    v_pk_mul_f16 v199, v166, v166
    v_mfma_f32_16x16x32_bf16 v[178:181], a[12:15], v[222:225], v[178:181]
    v_cvt_pk_f16_f32 v167, v124, v125
    v_pk_fma_f16 v199, v167, v167, v199
    v_mfma_f32_16x16x32_bf16 v[178:181], a[16:19], v[226:229], v[178:181]
    v_cvt_pk_f16_f32 v168, v186, v187
    v_pk_fma_f16 v199, v168, v168, v199
    v_mfma_f32_16x16x32_bf16 v[178:181], a[20:23], v[190:193], v[178:181]
    v_cvt_pk_f16_f32 v169, v188, v189
    v_pk_fma_f16 v199, v169, v169, v199
    v_mfma_f32_16x16x32_bf16 v[186:189], a[24:27], v[182:185], 0
    v_cvt_pk_f16_f32 v124, v194, v195
    v_pk_fma_f16 v199, v124, v124, v199
    v_mfma_f32_16x16x32_bf16 v[186:189], a[28:31], v[210:213], v[186:189]
    v_cvt_pk_f16_f32 v125, v196, v197
    v_pk_fma_f16 v199, v125, v125, v199
    v_mfma_f32_16x16x32_bf16 v[186:189], a[32:35], v[218:221], v[186:189]
    v_cvt_pk_f16_f32 v178, v178, v179
    v_pk_mul_f16 v198, v178, v178
    v_mfma_f32_16x16x32_bf16 v[186:189], a[36:39], v[222:225], v[186:189]
    v_cvt_pk_f16_f32 v179, v180, v181
    v_pk_fma_f16 v198, v179, v179, v198
    v_mfma_f32_16x16x32_bf16 v[186:189], a[40:43], v[226:229], v[186:189]
    v_pk_mul_f16 v200, v178, v170
    v_pk_fma_f16 v200, v179, v171, v200
    v_mfma_f32_16x16x32_bf16 v[186:189], a[44:47], v[190:193], v[186:189]
    v_pk_mul_f16 v201, v166, v174
    v_pk_fma_f16 v201, v167, v175, v201
    v_mfma_f32_16x16x32_bf16 v[194:197], a[48:51], v[182:185], 0
    v_pk_fma_f16 v201, v168, v176, v201
    v_pk_fma_f16 v201, v169, v177, v201
    v_mfma_f32_16x16x32_bf16 v[194:197], a[52:55], v[210:213], v[194:197]
    v_pk_fma_f16 v201, v124, v164, v201
    v_pk_fma_f16 v201, v125, v165, v201
    v_mfma_f32_16x16x32_bf16 v[194:197], a[56:59], v[218:221], v[194:197]
    v_cvt_pk_f16_f32 v180, v186, v187
    v_pk_fma_f16 v198, v180, v180, v198
    v_mfma_f32_16x16x32_bf16 v[194:197], a[60:63], v[222:225], v[194:197]
    v_cvt_pk_f16_f32 v181, v188, v189
    v_pk_fma_f16 v198, v181, v181, v198
    v_mfma_f32_16x16x32_bf16 v[194:197], a[64:67], v[226:229], v[194:197]
    v_pk_fma_f16 v200, v180, v172, v200
    v_pk_fma_f16 v200, v181, v173, v200
    v_mfma_f32_16x16x32_bf16 v[194:197], a[68:71], v[190:193], v[194:197]
    buffer_store_dwordx2 v[140:141], v18, s[12:15], 0 offen nt
    v_mul_f32 v242, v144, v242
    v_mul_f32 v243, v144, v243
    v_mfma_f32_16x16x32_bf16 v[186:189], v[182:185], a[144:147], 0
    v_cvt_pk_bf16_f32 v238, v242, v243
    v_mul_f32 v244, v144, v244
    v_mfma_f32_16x16x32_bf16 v[186:189], v[210:213], a[148:151], v[186:189]
    v_mul_f32 v245, v144, v245
    v_cvt_pk_f16_f32 v122, v194, v195
    v_mfma_f32_16x16x32_bf16 v[186:189], v[218:221], a[152:155], v[186:189]
    v_pk_fma_f16 v198, v122, v122, v198
    v_cvt_pk_f16_f32 v123, v196, v197
    v_mfma_f32_16x16x32_bf16 v[186:189], v[222:225], a[156:159], v[186:189]
    v_pk_fma_f16 v198, v123, v123, v198
    v_pk_fma_f16 v200, v122, v162, v200
    v_mfma_f32_16x16x32_bf16 v[186:189], v[226:229], a[160:163], v[186:189]
    ds_read_b128 v[202:205], v0 offset:32768
    v_pk_fma_f16 v200, v123, v163, v200
    v_mfma_f32_16x16x32_bf16 v[186:189], v[190:193], a[164:167], v[186:189]
    ds_read_b128 v[194:197], v1 offset:32768
    v_cvt_pk_bf16_f32 v239, v244, v245
    v_mfma_f32_16x16x32_f16 v[230:233], v[40:43], v[198:201], 0
    v_mul_f32 v158, v144, v158
    v_mul_f32 v159, v144, v159
    v_mfma_f32_16x16x32_bf16 v[246:249], v[182:185], a[168:171], 0
    ds_read_b128 v[214:217], v0 offset:32896
    v_cvt_pk_bf16_f32 v240, v158, v159
    v_mfma_f32_16x16x32_bf16 v[246:249], v[210:213], a[172:175], v[246:249]
    ds_read_b128 v[206:209], v1 offset:32896
    v_cvt_pk_bf16_f32 v136, v186, v187
    v_mfma_f32_16x16x32_bf16 v[246:249], v[218:221], a[176:179], v[246:249]
    ds_read_b128 v[198:201], v0 offset:33024
    v_cvt_pk_bf16_f32 v137, v188, v189
    v_mfma_f32_16x16x32_bf16 v[246:249], v[222:225], a[180:183], v[246:249]
    ds_read_b128 v[186:189], v1 offset:33024
    v_mul_f32 v160, v144, v160
    v_mfma_f32_16x16x32_bf16 v[246:249], v[226:229], a[184:187], v[246:249]
    v_rsq_f32 v230, v230
    v_mfma_f32_16x16x32_bf16 v[246:249], v[190:193], a[188:191], v[246:249]
    s_waitcnt lgkmcnt(5)
    v_rsq_f32 v231, v231
    v_mfma_f32_16x16x32_bf16 v[242:245], v[182:185], a[192:195], 0
    s_waitcnt lgkmcnt(4)
    v_mul_f32 v234, s31, v230
    v_cvt_pk_f16_f32 v235, v234, v231
    v_mfma_f32_16x16x32_bf16 v[242:245], v[210:213], a[196:199], v[242:245]
    v_fma_f32 v232, v232, v234, v24
    v_fmac_f32_dpp v254, v233, v231 quad_perm:[0,1,2,3] row_mask:0x2 bank_mask:0xf
    v_mfma_f32_16x16x32_bf16 v[242:245], v[218:221], a[200:203], v[242:245]
    s_waitcnt lgkmcnt(3)
    v_cvt_pk_bf16_f32 v140, v246, v247
    v_cvt_pk_bf16_f32 v141, v248, v249
    v_mfma_f32_16x16x32_bf16 v[242:245], v[222:225], a[204:207], v[242:245]
    s_waitcnt lgkmcnt(2)
    v_mul_f32 v161, v144, v161
    v_cvt_pk_bf16_f32 v241, v160, v161
    v_mfma_f32_16x16x32_bf16 v[242:245], v[226:229], a[208:211], v[242:245]
    s_waitcnt lgkmcnt(1)
    buffer_store_dwordx4 v[238:241], v17, s[12:15], 0 offen nt
    v_mul_f32 v154, v144, v154
    v_mul_f32 v155, v144, v155
    v_cvt_pk_bf16_f32 v154, v154, v155
    v_mul_f32 v156, v144, v156
    v_mfma_f32_16x16x32_bf16 v[242:245], v[190:193], a[212:215], v[242:245]
    s_waitcnt lgkmcnt(0)
    v_mul_f32 v157, v144, v157
    v_cvt_pk_bf16_f32 v155, v156, v157
    v_mfma_f32_16x16x32_bf16 v[158:161], a[72:75], v[202:205], 0
    v_pk_mul_f16 v166, v166, v235 op_sel:[0,1] op_sel_hi:[1,1]
    v_pk_mul_f16 v167, v167, v235 op_sel:[0,1] op_sel_hi:[1,1]
    v_mfma_f32_16x16x32_bf16 v[158:161], a[76:79], v[194:197], v[158:161]
    v_pk_mul_f16 v168, v168, v235 op_sel:[0,1] op_sel_hi:[1,1]
    v_cvt_pk_bf16_f32 v144, v242, v243
    v_mfma_f32_16x16x32_bf16 v[158:161], a[80:83], v[214:217], v[158:161]
    v_cvt_pk_bf16_f32 v145, v244, v245
    v_pk_mul_f16 v169, v169, v235 op_sel:[0,1] op_sel_hi:[1,1]
    v_mfma_f32_16x16x32_bf16 v[158:161], a[84:87], v[206:209], v[158:161]
    v_pk_mul_f16 v124, v124, v235 op_sel:[0,1] op_sel_hi:[1,1]
    v_pk_mul_f16 v125, v125, v235 op_sel:[0,1] op_sel_hi:[1,1]
    v_mfma_f32_16x16x32_bf16 v[158:161], a[88:91], v[198:201], v[158:161]
    v_pk_mul_f16 v178, v178, v235 op_sel:[0,0] op_sel_hi:[1,0]
    v_pk_mul_f16 v179, v179, v235 op_sel:[0,0] op_sel_hi:[1,0]
    v_mfma_f32_16x16x32_bf16 v[158:161], a[92:95], v[186:189], v[158:161]
    v_pk_mul_f16 v180, v180, v235 op_sel:[0,0] op_sel_hi:[1,0]
    v_pk_mul_f16 v181, v181, v235 op_sel:[0,0] op_sel_hi:[1,0]
    v_mfma_f32_16x16x32_bf16 v[182:185], a[96:99], v[202:205], 0
    v_pk_mul_f16 v122, v122, v235 op_sel:[0,0] op_sel_hi:[1,0]
    v_pk_mul_f16 v123, v123, v235 op_sel:[0,0] op_sel_hi:[1,0]
    v_mfma_f32_16x16x32_bf16 v[182:185], a[100:103], v[194:197], v[182:185]
    v_max3_u32 v44, v44, v230, v231
    v_mul_f32 v130, v255, v130
    v_mfma_f32_16x16x32_bf16 v[182:185], a[104:107], v[214:217], v[182:185]
    v_cvt_pk_f16_f32 v158, v158, v159
    v_pk_mul_f16 v191, v158, v158
    v_mfma_f32_16x16x32_bf16 v[182:185], a[108:111], v[206:209], v[182:185]
    v_cvt_pk_f16_f32 v159, v160, v161
    v_pk_fma_f16 v191, v159, v159, v191
    v_mfma_f32_16x16x32_bf16 v[182:185], a[112:115], v[198:201], v[182:185]
    v_pk_mul_f16 v193, v158, v174
    v_pk_fma_f16 v193, v159, v175, v193
    v_mfma_f32_16x16x32_bf16 v[182:185], a[116:119], v[186:189], v[182:185]
    v_exp_f32 v232, v232
    v_mfma_f32_16x16x32_bf16 v[210:213], a[120:123], v[202:205], 0
    v_exp_f32 v236, v236
    v_mfma_f32_16x16x32_bf16 v[210:213], a[124:127], v[194:197], v[210:213]
    v_cvt_pk_bf16_f32 v39, v236, 0
    v_mul_f32 v131, v255, v131
    v_mfma_f32_16x16x32_bf16 v[210:213], a[128:131], v[214:217], v[210:213]
    s_waitcnt vmcnt(3)
    ds_write_b16 v8, v45 offset:512
    v_mfma_f32_16x16x32_bf16 v[210:213], a[132:135], v[206:209], v[210:213]
    buffer_store_dwordx2 v[154:155], v20, s[12:15], 0 offen nt
    v_mov_b32 v45, 1
    v_cvt_pk_f16_f32 v160, v182, v183
    v_mfma_f32_16x16x32_bf16 v[210:213], a[136:139], v[198:201], v[210:213]
    v_pk_fma_f16 v191, v160, v160, v191
    v_cvt_pk_f16_f32 v161, v184, v185
    v_mfma_f32_16x16x32_bf16 v[210:213], a[140:143], v[186:189], v[210:213]
    v_pk_fma_f16 v191, v161, v161, v191
    v_pk_fma_f16 v193, v160, v176, v193
    v_mfma_f32_16x16x32_bf16 v[154:157], a[0:3], v[202:205], 0
    v_pk_fma_f16 v193, v161, v177, v193
    v_cvt_pk_bf16_f32 v130, v130, v131
    v_mfma_f32_16x16x32_bf16 v[154:157], a[4:7], v[194:197], v[154:157]
    v_mul_f32 v132, v255, v132
    v_mul_f32 v133, v255, v133
    v_mfma_f32_16x16x32_bf16 v[154:157], a[8:11], v[214:217], v[154:157]
    v_cvt_pk_f16_f32 v176, v210, v211
    v_pk_fma_f16 v191, v176, v176, v191
    v_mfma_f32_16x16x32_bf16 v[154:157], a[12:15], v[206:209], v[154:157]
    s_waitcnt lgkmcnt(0)
    v_cvt_pk_f16_f32 v177, v212, v213
    v_pk_fma_f16 v191, v177, v177, v191
    v_mfma_f32_16x16x32_bf16 v[154:157], a[16:19], v[198:201], v[154:157]
    s_barrier
    v_pk_fma_f16 v193, v176, v164, v193
    v_mfma_f32_16x16x32_bf16 v[154:157], a[20:23], v[186:189], v[154:157]
    v_pk_fma_f16 v193, v177, v165, v193
    v_mfma_f32_16x16x32_bf16 v[182:185], a[24:27], v[202:205], 0
    v_cvt_pk_bf16_f32 v131, v132, v133
    v_mfma_f32_16x16x32_bf16 v[182:185], a[28:31], v[194:197], v[182:185]
    ds_read2_b32 v[164:165], v6 offset0:0 offset1:0
    v_mfma_f32_16x16x32_bf16 v[182:185], a[32:35], v[214:217], v[182:185]
    ds_read2_b32 v[212:213], v6 offset0:16 offset1:16
    s_nop 0
    v_cvt_pk_f16_f32 v154, v154, v155
    v_mfma_f32_16x16x32_bf16 v[182:185], a[36:39], v[206:209], v[182:185]
    ds_read2_b32 v[220:221], v6 offset0:32 offset1:32
    v_pk_mul_f16 v190, v154, v154
    v_mfma_f32_16x16x32_bf16 v[182:185], a[40:43], v[198:201], v[182:185]
    ds_read_u16 v133, v9 offset:512
    v_cvt_pk_f16_f32 v155, v156, v157
    v_mfma_f32_16x16x32_bf16 v[182:185], a[44:47], v[186:189], v[182:185]
    v_pk_fma_f16 v190, v155, v155, v190
    v_pk_mul_f16 v192, v154, v170
    v_mfma_f32_16x16x32_bf16 v[222:225], a[48:51], v[202:205], 0
    v_pk_fma_f16 v192, v155, v171, v192
    v_mul_f32 v126, v255, v126
    v_mfma_f32_16x16x32_bf16 v[222:225], a[52:55], v[194:197], v[222:225]
    v_mul_f32 v127, v255, v127
    v_cvt_pk_bf16_f32 v132, v126, v127
    v_mfma_f32_16x16x32_bf16 v[222:225], a[56:59], v[214:217], v[222:225]
    buffer_load_dwordx4 v10, s[8:11], 0 offen nt lds
    v_cvt_pk_f16_f32 v156, v182, v183
    v_mfma_f32_16x16x32_bf16 v[222:225], a[60:63], v[206:209], v[222:225]
    s_add_u32 m0, s28, 4096
    v_pk_fma_f16 v190, v156, v156, v190
    v_cvt_pk_f16_f32 v157, v184, v185
    v_mfma_f32_16x16x32_bf16 v[222:225], a[64:67], v[198:201], v[222:225]
    s_waitcnt lgkmcnt(2)
    v_pk_fma_f16 v190, v157, v157, v190
    v_pk_fma_f16 v192, v156, v172, v192
    v_mfma_f32_16x16x32_bf16 v[222:225], a[68:71], v[186:189], v[222:225]
    s_waitcnt lgkmcnt(1)
    ds_read_b128 v[182:185], v2 offset:0
    v_pk_fma_f16 v192, v157, v173, v192
    v_mfma_f32_16x16x32_bf16 v[170:173], v[202:205], a[144:147], 0
    s_waitcnt lgkmcnt(1)
    ds_read_b128 v[226:229], v2 offset:1024
    v_readfirstlane_b32 s77, v133
    v_mfma_f32_16x16x32_bf16 v[170:173], v[194:197], a[148:151], v[170:173]
    ds_read_b128 v[234:237], v2 offset:2048
    buffer_load_dwordx4 v11, s[8:11], 0 offen nt lds
    v_mfma_f32_16x16x32_bf16 v[170:173], v[214:217], a[152:155], v[170:173]
    s_add_u32 m0, s28, 8192
    ds_read_b128 v[238:241], v2 offset:3072
    v_cvt_pk_f16_f32 v174, v222, v223
    v_mfma_f32_16x16x32_bf16 v[170:173], v[206:209], a[156:159], v[170:173]
    s_mul_i32 s78, s77, 2688
    ds_read_b128 v[242:245], v2 offset:4096
    v_pk_fma_f16 v190, v174, v174, v190
    v_mfma_f32_16x16x32_bf16 v[170:173], v[198:201], a[160:163], v[170:173]
    ds_read_b128 v[246:249], v2 offset:5120
    v_cvt_pk_f16_f32 v175, v224, v225
    v_mfma_f32_16x16x32_bf16 v[170:173], v[186:189], a[164:167], v[170:173]
    v_pk_fma_f16 v190, v175, v175, v190
    v_pk_fma_f16 v192, v174, v162, v192
    v_mfma_f32_16x16x32_bf16 v[222:225], v[202:205], a[168:171], 0
    buffer_load_dwordx4 v12, s[8:11], 0 offen nt lds
    v_pk_fma_f16 v192, v175, v163, v192
    v_mfma_f32_16x16x32_bf16 v[222:225], v[194:197], a[172:175], v[222:225]
    s_waitcnt lgkmcnt(5)
    v_mul_f32 v128, v255, v128
    v_cvt_pk_bf16_f32 v162, v170, v171
    v_mfma_f32_16x16x32_f16 v[250:253], v[40:43], v[190:193], 0
    s_add_u32 m0, s28, 12288
    v_cvt_pk_bf16_f32 v163, v172, v173
    v_mul_f32 v129, v255, v129
    v_mfma_f32_16x16x32_bf16 v[222:225], v[214:217], a[176:179], v[222:225]
    s_xor_b32 s28, s28, 65536
    v_cvt_pk_bf16_f32 v133, v128, v129
    v_mul_f32 v114, v255, v114
    v_mfma_f32_16x16x32_bf16 v[222:225], v[206:209], a[180:183], v[222:225]
    s_waitcnt lgkmcnt(2)
    v_rsq_f32 v250, v250
    v_mfma_f32_16x16x32_bf16 v[222:225], v[198:201], a[184:187], v[222:225]
    s_waitcnt lgkmcnt(1)
    buffer_load_dwordx4 v13, s[8:11], 0 offen nt lds
    v_mul_f32 v230, s31, v250
    v_mfma_f32_16x16x32_bf16 v[222:225], v[186:189], a[188:191], v[222:225]
    s_mov_b32 m0, s29
    v_rsq_f32 v251, v251
    v_mfma_f32_16x16x32_bf16 v[126:129], v[202:205], a[192:195], 0
    s_xor_b32 s29, s29, s30
    v_cvt_pk_f16_f32 v231, v230, v251
    v_fma_f32 v252, v252, v230, v26
    v_mfma_f32_16x16x32_bf16 v[126:129], v[194:197], a[196:199], v[126:129]
    s_add_u32 s19, s19, s20
    v_fmac_f32_dpp v254, v253, v251 quad_perm:[0,1,2,3] row_mask:0x4 bank_mask:0xf
    v_cvt_pk_bf16_f32 v210, v222, v223
    v_mfma_f32_16x16x32_bf16 v[126:129], v[214:217], a[200:203], v[126:129]
    s_add_u32 s23, s23, s21
    v_cvt_pk_bf16_f32 v211, v224, v225
    v_pk_mul_f16 v158, v158, v231 op_sel:[0,1] op_sel_hi:[1,1]
    v_mfma_f32_16x16x32_bf16 v[126:129], v[206:209], a[204:207], v[126:129]
    s_waitcnt lgkmcnt(0)
    buffer_load_dwordx4 v14, s[8:11], 0 offen nt lds
    v_pk_mul_f16 v159, v159, v231 op_sel:[0,1] op_sel_hi:[1,1]
    v_mfma_f32_16x16x32_bf16 v[126:129], v[198:201], a[208:211], v[126:129]
    s_cmp_ge_u32 s19, 72
    v_pk_mul_f16 v160, v160, v231 op_sel:[0,1] op_sel_hi:[1,1]
    v_pk_mul_f16 v161, v161, v231 op_sel:[0,1] op_sel_hi:[1,1]
    v_mfma_f32_16x16x32_bf16 v[126:129], v[186:189], a[212:215], v[126:129]
    s_cselect_b32 s34, 72, 0
    v_pk_mul_f16 v176, v176, v231 op_sel:[0,1] op_sel_hi:[1,1]
    v_pk_mul_f16 v177, v177, v231 op_sel:[0,1] op_sel_hi:[1,1]
    v_mfma_f32_16x16x32_f16 v[170:173], v[146:149], v[150:153], v[46:49]
    s_cselect_b32 s35, s22, 0
    v_pk_mul_f16 v154, v154, v231 op_sel:[0,0] op_sel_hi:[1,0]
    v_pk_mul_f16 v155, v155, v231 op_sel:[0,0] op_sel_hi:[1,0]
    v_mfma_f32_16x16x32_f16 v[186:189], v[166:169], v[150:153], v[50:53]
    s_sub_u32 s19, s19, s34
    v_cvt_pk_bf16_f32 v218, v126, v127
    v_cvt_pk_bf16_f32 v219, v128, v129
    v_mfma_f32_16x16x32_f16 v[126:129], v[158:161], v[150:153], v[54:57]
    buffer_store_dwordx4 v[130:133], v16, s[12:15], 0 offen nt
    v_pk_mul_f16 v156, v156, v231 op_sel:[0,0] op_sel_hi:[1,0]
    v_pk_mul_f16 v157, v157, v231 op_sel:[0,0] op_sel_hi:[1,0]
    v_pk_mul_f16 v174, v174, v231 op_sel:[0,0] op_sel_hi:[1,0]
    v_pk_mul_f16 v175, v175, v231 op_sel:[0,0] op_sel_hi:[1,0]
    v_mfma_f32_16x16x16_f16 v[170:173], v[120:121], v[118:119], v[170:173]
    v_max3_u32 v44, v44, v250, v251
    v_exp_f32 v254, v254
    v_mfma_f32_16x16x16_f16 v[186:189], v[124:125], v[118:119], v[186:189]
    v_cvt_pk_bf16_f32 v254, v254, v254
    v_exp_f32 v252, v252
    v_mfma_f32_16x16x16_f16 v[126:129], v[176:177], v[118:119], v[126:129]
    v_mul_f32 v115, v255, v115
    v_cvt_pk_bf16_f32 v118, v114, v115
    v_exp_f32 v170, v170
    v_mfma_f32_16x16x32_f16 v[130:133], v[146:149], v[178:181], v[58:61]
    s_add_u32 s23, s23, s35
    ds_write_b16 v8, v254
    v_mfma_f32_16x16x32_f16 v[150:153], v[166:169], v[178:181], v[62:65]
    s_add_u32 s78, s78, s69
    v_exp_f32 v171, v171
    v_mfma_f32_16x16x32_f16 v[190:193], v[158:161], v[178:181], v[66:69]
    s_add_u32 s80, s77, s68
    v_cvt_pk_bf16_f32 v170, v170, v171
    v_exp_f32 v172, v172
    v_mfma_f32_16x16x16_f16 v[130:133], v[120:121], v[122:123], v[130:133]
    v_exp_f32 v173, v173
    v_mul_f32 v116, v255, v116
    v_mfma_f32_16x16x16_f16 v[150:153], v[124:125], v[122:123], v[150:153]
    v_cvt_pk_bf16_f32 v171, v172, v173
    v_exp_f32 v186, v186
    v_mfma_f32_16x16x16_f16 v[190:193], v[176:177], v[122:123], v[190:193]
    v_exp_f32 v187, v187
    v_exp_f32 v188, v188
    v_mfma_f32_16x16x32_bf16 v[178:181], a[216:219], v[182:185], 0
    s_cmp_ge_u32 s80, 72
    v_exp_f32 v130, v130
    v_mfma_f32_16x16x32_bf16 v[178:181], a[220:223], v[226:229], v[178:181]
    s_cselect_b32 s80, s22, 0
    v_exp_f32 v131, v131
    v_mfma_f32_16x16x32_bf16 v[178:181], a[224:227], v[234:237], v[178:181]
    s_add_u32 s78, s78, s80
    v_cvt_pk_bf16_f32 v194, v130, v131
    v_cvt_pk_bf16_f32 v172, v186, v187
    v_mfma_f32_16x16x32_bf16 v[178:181], a[228:231], v[238:241], v[178:181]
    s_add_u32 s80, s77, 20
    v_exp_f32 v132, v132
    v_mfma_f32_16x16x32_bf16 v[178:181], a[232:235], v[242:245], v[178:181]
    s_add_u32 s34, s18, 3
    v_exp_f32 v133, v133
    v_mfma_f32_16x16x32_bf16 v[178:181], a[236:239], v[246:249], v[178:181]
    s_cmp_lt_u32 s77, s62
    v_cvt_pk_bf16_f32 v195, v132, v133
    v_mul_f32 v117, v255, v117
    v_mfma_f32_16x16x32_bf16 v[198:201], a[240:243], v[182:185], 0
    s_cselect_b32 s79, 1, 0
    v_exp_f32 v150, v150
    v_mfma_f32_16x16x32_f16 v[202:205], v[146:149], v[154:157], v[70:73]
    s_cselect_b32 s78, s78, 0
    v_exp_f32 v151, v151
    v_mfma_f32_16x16x32_f16 v[146:149], v[166:169], v[154:157], v[74:77]
    s_cmp_lt_u32 s34, s17
    v_cvt_pk_bf16_f32 v196, v150, v151
    v_cvt_pk_bf16_f32 v119, v116, v117
    v_mfma_f32_16x16x32_f16 v[166:169], v[158:161], v[154:157], v[78:81]
    buffer_store_dwordx2 v[118:119], v19, s[12:15], 0 offen nt
    v_exp_f32 v152, v152
    v_mfma_f32_16x16x16_f16 v[202:205], v[120:121], v[174:175], v[202:205]
    v_exp_f32 v153, v153
    v_fma_f32 v254, v178, v178, s33
    v_mfma_f32_16x16x16_f16 v[146:149], v[124:125], v[174:175], v[146:149]
    v_cvt_pk_bf16_f32 v197, v152, v153
    v_exp_f32 v190, v190
    v_mfma_f32_16x16x16_f16 v[166:169], v[176:177], v[174:175], v[166:169]
    v_exp_f32 v191, v191
    v_exp_f32 v192, v192
    v_mfma_f32_16x16x32_bf16 v[198:201], a[244:247], v[226:229], v[198:201]
    s_cselect_b32 s23, s23, s78
    v_exp_f32 v193, v193
    v_mfma_f32_16x16x32_bf16 v[198:201], a[248:251], v[234:237], v[198:201]
    s_cselect_b32 s73, s34, s80
    ds_read_b128 v[118:121], v2 offset:6144
    v_fmac_f32 v254, v179, v179
    v_mfma_f32_16x16x32_bf16 v[198:201], a[252:255], v[238:241], v[198:201]
    s_cselect_b32 s79, 0, s79
    ds_read_b128 v[122:125], v2 offset:7168
    v_fmac_f32 v254, v180, v180
    v_mfma_f32_16x16x32_bf16 v[198:201], v[82:85], v[242:245], v[198:201]
    s_cselect_b32 s81, 0, 1
    ds_read_b128 v[150:153], v2 offset:8192
    v_fmac_f32 v254, v181, v181
    v_mfma_f32_16x16x32_bf16 v[198:201], v[86:89], v[246:249], v[198:201]
    s_add_u32 s80, s77, 1
    ds_read_b128 v[154:157], v2 offset:9216
    v_xor_b32 v0, 65536, v0
    v_mfma_f32_16x16x32_bf16 v[206:209], v[90:93], v[182:185], 0
    s_mul_i32 s80, s80, s81
    ds_read_b128 v[158:161], v2 offset:10240
    v_xor_b32 v1, 65536, v1
    v_mfma_f32_16x16x32_bf16 v[206:209], v[94:97], v[226:229], v[206:209]
    s_cmp_lt_u32 s80, s62
    ds_read_b128 v[174:177], v2 offset:11264
    v_fmac_f32 v254, v198, v198
    v_mfma_f32_16x16x32_bf16 v[206:209], v[98:101], v[234:237], v[206:209]
    s_cselect_b32 s62, s62, 0
    v_exp_f32 v189, v189
    v_mfma_f32_16x16x32_bf16 v[206:209], v[102:105], v[238:241], v[206:209]
    s_add_u32 s80, s18, 4
    v_cvt_pk_bf16_f32 v173, v188, v189
    v_fmac_f32 v254, v199, v199
    v_mfma_f32_16x16x32_bf16 v[206:209], v[106:109], v[242:245], v[206:209]
    s_waitcnt lgkmcnt(5)
    v_exp_f32 v126, v126
    v_mfma_f32_16x16x32_bf16 v[206:209], v[110:113], v[246:249], v[206:209]
    s_cmp_ge_u32 s80, s17
    v_exp_f32 v127, v127
    v_mfma_f32_16x16x32_bf16 v[130:133], a[216:219], v[118:121], 0
    s_waitcnt lgkmcnt(3)
    v_cvt_pk_bf16_f32 v36, v126, v127
    v_fmac_f32 v254, v200, v200
    v_mfma_f32_16x16x32_bf16 v[130:133], a[220:223], v[122:125], v[130:133]
    s_cselect_b32 s66, s62, 0
    v_exp_f32 v128, v128
    v_mfma_f32_16x16x32_bf16 v[130:133], a[224:227], v[150:153], v[130:133]
    s_waitcnt lgkmcnt(1)
    buffer_atomic_add v45, v10, s[64:67], 0 offen sc0 sc1
    v_fmac_f32 v254, v201, v201
    v_mfma_f32_16x16x32_bf16 v[130:133], a[228:231], v[154:157], v[130:133]
    s_lshl_b32 s80, s79, s73
    v_exp_f32 v129, v129
    v_mfma_f32_16x16x32_bf16 v[130:133], a[232:235], v[158:161], v[130:133]
    s_waitcnt lgkmcnt(0)
    v_cvt_pk_bf16_f32 v37, v128, v129
    v_fmac_f32 v254, v206, v206
    v_mfma_f32_16x16x32_bf16 v[130:133], a[236:239], v[174:177], v[130:133]
    s_or_b32 s70, s70, s80
    v_exp_f32 v202, v202
    v_mfma_f32_16x16x32_bf16 v[182:185], v[28:31], v[36:39], 0
    s_add_u32 s45, s45, s79
    v_exp_f32 v203, v203
    v_mfma_f32_16x16x32_bf16 v[182:185], v[28:31], v[170:173], v[182:185]
    s_add_u32 s18, s18, 1
    v_cvt_pk_bf16_f32 v186, v202, v203
    v_fma_f32 v255, v130, v130, s33
    v_mfma_f32_16x16x32_bf16 v[214:217], v[162:165], v[36:39], 0
    s_cmp_lt_u32 s18, s45
    v_fmac_f32 v255, v131, v131
    v_fmac_f32 v255, v132, v132
    v_mfma_f32_16x16x32_bf16 v[214:217], v[134:137], v[170:173], v[214:217]
    v_fmac_f32 v255, v133, v133
    v_fmac_f32 v254, v207, v207
    v_mfma_f32_16x16x32_bf16 v[222:225], v[210:213], v[36:39], 0
    v_exp_f32 v204, v204
    v_mfma_f32_16x16x32_bf16 v[222:225], v[138:141], v[170:173], v[222:225]
    v_exp_f32 v205, v205
    v_mfma_f32_16x16x32_bf16 v[226:229], v[218:221], v[36:39], 0
    v_cvt_pk_bf16_f32 v36, v190, v191
    v_cvt_pk_bf16_f32 v37, v192, v193
    v_mfma_f32_16x16x32_bf16 v[226:229], v[142:145], v[170:173], v[226:229]
    v_cvt_pk_bf16_f32 v39, v232, 0
    v_cvt_pk_bf16_f32 v187, v204, v205
    v_mfma_f32_16x16x32_bf16 v[126:129], a[240:243], v[118:121], 0
    v_exp_f32 v146, v146
    v_mfma_f32_16x16x32_bf16 v[170:173], v[28:31], v[36:39], 0
    v_exp_f32 v147, v147
    v_mfma_f32_16x16x32_bf16 v[170:173], v[28:31], v[194:197], v[170:173]
    v_cvt_pk_bf16_f32 v188, v146, v147
    v_fmac_f32 v254, v208, v208
    v_mfma_f32_16x16x32_bf16 v[114:117], v[162:165], v[36:39], 0
    v_exp_f32 v148, v148
    v_mfma_f32_16x16x32_bf16 v[114:117], v[134:137], v[194:197], v[114:117]
    v_exp_f32 v149, v149
    v_mfma_f32_16x16x32_bf16 v[190:193], v[210:213], v[36:39], 0
    v_cvt_pk_bf16_f32 v189, v148, v149
    v_fmac_f32 v254, v209, v209
    v_mfma_f32_16x16x32_bf16 v[190:193], v[138:141], v[194:197], v[190:193]
    v_rcp_f32 v170, v170
    v_mfma_f32_16x16x32_bf16 v[146:149], v[218:221], v[36:39], 0
    v_exp_f32 v166, v166
    v_mfma_f32_16x16x32_bf16 v[146:149], v[142:145], v[194:197], v[146:149]
    v_mul_f32 v114, v170, v114
    v_mul_f32 v115, v170, v115
    v_mfma_f32_16x16x32_bf16 v[126:129], a[244:247], v[122:125], v[126:129]
    v_cvt_pk_bf16_f32 v194, v114, v115
    v_mul_f32 v116, v170, v116
    v_mfma_f32_16x16x32_bf16 v[126:129], a[248:251], v[150:153], v[126:129]
    ds_read_b128 v[202:205], v2 offset:12288
    v_mul_f32 v117, v170, v117
    v_mfma_f32_16x16x32_bf16 v[126:129], a[252:255], v[154:157], v[126:129]
    ds_read_b128 v[230:233], v2 offset:13312
    v_cvt_pk_bf16_f32 v195, v116, v117
    v_mfma_f32_16x16x32_bf16 v[126:129], v[82:85], v[158:161], v[126:129]
    ds_read_b128 v[234:237], v2 offset:14336
    v_mul_f32 v190, v170, v190
    v_mfma_f32_16x16x32_bf16 v[126:129], v[86:89], v[174:177], v[126:129]
    ds_read_b128 v[238:241], v2 offset:15360
    v_mul_f32 v191, v170, v191
    v_mfma_f32_16x16x32_bf16 v[114:117], v[90:93], v[118:121], 0
    ds_read_b128 v[118:121], v2 offset:16384
    v_cvt_pk_bf16_f32 v196, v190, v191
    v_mfma_f32_16x16x32_bf16 v[114:117], v[94:97], v[122:125], v[114:117]
    ds_read_b128 v[122:125], v2 offset:17408
    v_mul_f32 v192, v170, v192
    v_mfma_f32_16x16x32_bf16 v[114:117], v[98:101], v[150:153], v[114:117]
    v_fmac_f32 v255, v126, v126
    v_fmac_f32 v255, v127, v127
    v_mfma_f32_16x16x32_bf16 v[114:117], v[102:105], v[154:157], v[114:117]
    v_fmac_f32 v255, v128, v128
    v_fmac_f32 v255, v129, v129
    v_mfma_f32_16x16x32_bf16 v[114:117], v[106:109], v[158:161], v[114:117]
    s_waitcnt lgkmcnt(5)
    v_mul_f32 v193, v170, v193
    v_cvt_pk_bf16_f32 v197, v192, v193
    v_mfma_f32_16x16x32_bf16 v[114:117], v[110:113], v[174:177], v[114:117]
    s_waitcnt lgkmcnt(4)
    ds_write_b128 v3, v[194:197] offset:6144
    v_mfma_f32_16x16x32_bf16 v[242:245], a[216:219], v[202:205], 0
    s_waitcnt lgkmcnt(3)
    v_mul_f32 v146, v170, v146
    v_mul_f32 v147, v170, v147
    v_mfma_f32_16x16x32_bf16 v[242:245], a[220:223], v[230:233], v[242:245]
    s_waitcnt lgkmcnt(2)
    v_fmac_f32 v255, v114, v114
    v_fmac_f32 v255, v115, v115
    v_mfma_f32_16x16x32_bf16 v[242:245], a[224:227], v[234:237], v[242:245]
    s_waitcnt lgkmcnt(1)
    v_fmac_f32 v255, v116, v116
    v_fmac_f32 v255, v117, v117
    v_mfma_f32_16x16x32_bf16 v[242:245], a[228:231], v[238:241], v[242:245]
    v_cvt_pk_bf16_f32 v254, v254, v255
    v_cvt_pk_bf16_f32 v172, v146, v147
    v_mfma_f32_16x16x32_bf16 v[242:245], a[232:235], v[118:121], v[242:245]
    v_mul_f32 v148, v170, v148
    v_mul_f32 v149, v170, v149
    v_mfma_f32_16x16x32_bf16 v[242:245], a[236:239], v[122:125], v[242:245]
    v_cvt_pk_bf16_f32 v173, v148, v149
    v_cvt_pk_bf16_f32 v39, v252, 0
    v_mfma_f32_16x16x32_bf16 v[158:161], a[240:243], v[202:205], 0
    ds_write_b64 v4, v[172:173] offset:10240
    v_mfma_f32_16x16x32_bf16 v[158:161], a[244:247], v[230:233], v[158:161]
    v_exp_f32 v167, v167
    v_mfma_f32_16x16x32_bf16 v[158:161], a[248:251], v[234:237], v[158:161]
    v_cvt_pk_bf16_f32 v36, v166, v167
    v_fma_f32 v255, v242, v242, s33
    v_mfma_f32_16x16x32_bf16 v[158:161], a[252:255], v[238:241], v[158:161]
    v_fmac_f32 v255, v243, v243
    v_fmac_f32 v255, v244, v244
    v_mfma_f32_16x16x32_bf16 v[158:161], v[82:85], v[118:121], v[158:161]
    v_fmac_f32 v255, v245, v245
    v_xor_b32 v2, 65536, v2
    v_mfma_f32_16x16x32_bf16 v[158:161], v[86:89], v[122:125], v[158:161]
    v_exp_f32 v168, v168
    v_mfma_f32_16x16x32_bf16 v[154:157], v[90:93], v[202:205], 0
    v_exp_f32 v169, v169
    v_mfma_f32_16x16x32_bf16 v[154:157], v[94:97], v[230:233], v[154:157]
    ds_read_b128 v[146:149], v9
    v_cvt_pk_bf16_f32 v37, v168, v169
    v_mfma_f32_16x16x32_bf16 v[154:157], v[98:101], v[234:237], v[154:157]
    ds_read_b128 v[150:153], v9 offset:64
    v_fmac_f32 v255, v158, v158
    v_mfma_f32_16x16x32_bf16 v[166:169], v[28:31], v[36:39], 0
    v_fmac_f32 v255, v159, v159
    v_fmac_f32 v255, v160, v160
    v_mfma_f32_16x16x32_bf16 v[166:169], v[28:31], v[186:189], v[166:169]
    v_fmac_f32 v255, v161, v161
    v_add_u32 v6, s75, v6
    v_mfma_f32_16x16x32_bf16 v[174:177], v[162:165], v[36:39], 0
    v_rcp_f32 v182, v182
    v_mfma_f32_16x16x32_bf16 v[174:177], v[134:137], v[186:189], v[174:177]
    v_max3_u32 v25, v25, v182, v183
    v_max3_u32 v25, v25, v170, v171
    v_mfma_f32_16x16x32_bf16 v[170:173], v[210:213], v[36:39], 0
    v_rcp_f32 v166, v166
    v_mfma_f32_16x16x32_bf16 v[170:173], v[138:141], v[186:189], v[170:173]
    v_max3_u32 v25, v25, v166, v167
    v_mul_f32 v214, v182, v214
    v_mfma_f32_16x16x32_bf16 v[190:193], v[218:221], v[36:39], 0
    s_waitcnt lgkmcnt(1)
    v_mul_f32 v174, v166, v174
    v_mul_f32 v175, v166, v175
    v_mfma_f32_16x16x32_bf16 v[190:193], v[142:145], v[186:189], v[190:193]
    s_waitcnt lgkmcnt(0)
    v_cvt_pk_bf16_f32 v174, v174, v175
    v_mul_f32 v176, v166, v176
    v_mfma_f32_16x16x32_bf16 v[154:157], v[102:105], v[238:241], v[154:157]
    ds_read_b128 v[186:189], v0 offset:20480
    v_mul_f32 v177, v166, v177
    v_mfma_f32_16x16x32_bf16 v[154:157], v[106:109], v[118:121], v[154:157]
    ds_read_b128 v[194:197], v1 offset:20480
    v_cvt_pk_bf16_f32 v175, v176, v177
    v_mfma_f32_16x16x32_bf16 v[154:157], v[110:113], v[122:125], v[154:157]
    ds_read_b128 v[122:125], v0 offset:20608
    v_mul_f32 v170, v166, v170
    v_mfma_f32_16x16x32_bf16 v[118:121], v[146:149], v[28:31], 0
    ds_read_b128 v[202:205], v1 offset:20608
    v_mul_f32 v171, v166, v171
    v_mfma_f32_16x16x32_bf16 v[118:121], v[150:153], v[28:31], v[118:121]
    ds_read_b128 v[230:233], v0 offset:20736
    v_cvt_pk_bf16_f32 v176, v170, v171
    v_mfma_f32_16x16x32_bf16 v[234:237], v[146:149], v[134:137], 0
    ds_read_b128 v[238:241], v1 offset:20736
    v_fmac_f32 v255, v154, v154
    v_mfma_f32_16x16x32_bf16 v[234:237], v[150:153], v[162:165], v[234:237]
    v_fmac_f32 v255, v155, v155
    v_fmac_f32 v255, v156, v156
    v_mfma_f32_16x16x32_bf16 v[134:137], v[146:149], v[138:141], 0
    v_fmac_f32 v255, v157, v157
    v_cvt_pk_bf16_f32 v255, v255, v255
    v_mfma_f32_16x16x32_bf16 v[134:137], v[150:153], v[210:213], v[134:137]
    s_waitcnt lgkmcnt(5)
    ds_write_b64 v4, v[254:255] offset:18432
    v_mfma_f32_16x16x32_bf16 v[138:141], v[146:149], v[142:145], 0
    s_waitcnt lgkmcnt(4)
    v_mul_f32 v172, v166, v172
    v_mul_f32 v173, v166, v173
    v_mfma_f32_16x16x32_bf16 v[138:141], v[150:153], v[218:221], v[138:141]
    s_waitcnt lgkmcnt(3)
    v_cvt_pk_bf16_f32 v177, v172, v173
    v_mul_f32 v190, v166, v190
    v_mfma_f32_16x16x32_bf16 v[142:145], a[72:75], v[186:189], 0
    s_waitcnt lgkmcnt(2)
    ds_write_b128 v3, v[174:177] offset:12288
    v_mfma_f32_16x16x32_bf16 v[142:145], a[76:79], v[194:197], v[142:145]
    s_waitcnt lgkmcnt(2)
    v_mul_f32 v191, v166, v191
    v_cvt_pk_bf16_f32 v120, v190, v191
    v_mfma_f32_16x16x32_bf16 v[142:145], a[80:83], v[122:125], v[142:145]
    v_mul_f32 v192, v166, v192
    v_mul_f32 v193, v166, v193
    v_mfma_f32_16x16x32_bf16 v[142:145], a[84:87], v[202:205], v[142:145]
    v_cvt_pk_bf16_f32 v121, v192, v193
    v_mul_f32 v215, v182, v215
    v_mfma_f32_16x16x32_bf16 v[142:145], a[88:91], v[230:233], v[142:145]
    ds_write_b64 v4, v[120:121] offset:16384
    v_mfma_f32_16x16x32_bf16 v[142:145], a[92:95], v[238:241], v[142:145]
    v_rcp_f32 v118, v118
    v_mfma_f32_16x16x32_bf16 v[150:153], a[96:99], v[186:189], 0
    v_max3_u32 v25, v25, v118, v119
    v_mul_f32 v234, v234, v118
    v_mfma_f32_16x16x32_bf16 v[150:153], a[100:103], v[194:197], v[150:153]
    v_mul_f32_dpp v234, v134, v118 quad_perm:[0,1,2,3] row_mask:0x2 bank_mask:0xf
    v_mul_f32_dpp v234, v138, v118 quad_perm:[0,1,2,3] row_mask:0x4 bank_mask:0xf
    v_mfma_f32_16x16x32_bf16 v[150:153], a[104:107], v[122:125], v[150:153]
    v_cvt_pk_bf16_f32 v234, v234, v234
    v_cvt_pk_bf16_f32 v118, v214, v215
    v_mfma_f32_16x16x32_bf16 v[150:153], a[108:111], v[202:205], v[150:153]
    ds_write_b16 v7, v234
    v_mfma_f32_16x16x32_bf16 v[150:153], a[112:115], v[230:233], v[150:153]
    v_mul_f32 v216, v182, v216
    v_mul_f32 v217, v182, v217
    v_mfma_f32_16x16x32_bf16 v[150:153], a[116:119], v[238:241], v[150:153]
    v_cvt_pk_bf16_f32 v119, v216, v217
    v_mul_f32 v222, v182, v222
    v_mfma_f32_16x16x32_bf16 v[134:137], a[120:123], v[186:189], 0
    v_mul_f32 v223, v182, v223
    v_cvt_pk_bf16_f32 v120, v222, v223
    v_mfma_f32_16x16x32_bf16 v[134:137], a[124:127], v[194:197], v[134:137]
    v_mul_f32 v224, v182, v224
    v_mul_f32 v225, v182, v225
    v_mfma_f32_16x16x32_bf16 v[134:137], a[128:131], v[122:125], v[134:137]
    v_cvt_pk_bf16_f32 v121, v224, v225
    v_mul_f32 v226, v182, v226
    v_mfma_f32_16x16x32_bf16 v[134:137], a[132:135], v[202:205], v[134:137]
    ds_write_b128 v3, v[118:121] offset:0
    v_mfma_f32_16x16x32_bf16 v[134:137], a[136:139], v[230:233], v[134:137]
    v_mul_f32 v227, v182, v227
    v_cvt_pk_bf16_f32 v254, v226, v227
    v_mfma_f32_16x16x32_bf16 v[134:137], a[140:143], v[238:241], v[134:137]
    v_mul_f32 v228, v182, v228
    v_mul_f32 v229, v182, v229
    v_mfma_f32_16x16x32_bf16 v[138:141], a[0:3], v[186:189], 0
    v_cvt_pk_bf16_f32 v255, v228, v229
    v_xor_b32 v3, 65536, v3
    v_mfma_f32_16x16x32_bf16 v[138:141], a[4:7], v[194:197], v[138:141]
    ds_write_b64 v4, v[254:255] offset:4096
    v_mfma_f32_16x16x32_bf16 v[138:141], a[8:11], v[122:125], v[138:141]
    v_xor_b32 v4, 65536, v4
    v_add_u32 v7, s76, v7
    v_mfma_f32_16x16x32_bf16 v[138:141], a[12:15], v[202:205], v[138:141]
    v_cvt_pk_f16_f32 v146, v142, v143
    v_pk_mul_f16 v143, v146, v146
    v_mfma_f32_16x16x32_bf16 v[138:141], a[16:19], v[230:233], v[138:141]
    v_cvt_pk_f16_f32 v147, v144, v145
    v_pk_fma_f16 v143, v147, v147, v143
    v_mfma_f32_16x16x32_bf16 v[138:141], a[20:23], v[238:241], v[138:141]
    v_cvt_pk_f16_f32 v148, v150, v151
    v_pk_fma_f16 v143, v148, v148, v143
    v_mfma_f32_16x16x32_bf16 v[166:169], a[24:27], v[186:189], 0
    v_cvt_pk_f16_f32 v149, v152, v153
    v_pk_fma_f16 v143, v149, v149, v143
    v_mfma_f32_16x16x32_bf16 v[166:169], a[28:31], v[194:197], v[166:169]
    v_cvt_pk_f16_f32 v120, v134, v135
    v_pk_fma_f16 v143, v120, v120, v143
    v_mfma_f32_16x16x32_bf16 v[166:169], a[32:35], v[122:125], v[166:169]
    s_waitcnt lgkmcnt(0)
    v_cvt_pk_f16_f32 v121, v136, v137
    v_pk_fma_f16 v143, v121, v121, v143
    v_mfma_f32_16x16x32_bf16 v[166:169], a[36:39], v[202:205], v[166:169]
    s_barrier
    v_mfma_f32_16x16x32_bf16 v[166:169], a[40:43], v[230:233], v[166:169]
    s_nop 0
    v_mfma_f32_16x16x32_bf16 v[166:169], a[44:47], v[238:241], v[166:169]
    s_nop 0
    v_mfma_f32_16x16x32_bf16 v[134:137], a[48:51], v[186:189], 0
    s_nop 0
    v_mfma_f32_16x16x32_bf16 v[134:137], a[52:55], v[194:197], v[134:137]
    s_cbranch_scc1 L_loop_fast0
    s_branch L_final_fast
.p2align 6
L_loop_fast1:
    v_mfma_f32_16x16x32_bf16 v[134:137], a[56:59], v[122:125], v[134:137]
    s_add_u32 s12, s40, s27
    ds_read_b128 v[190:193], v2 offset:18432
    v_cvt_pk_f16_f32 v150, v138, v139
    v_mfma_f32_16x16x32_bf16 v[134:137], a[60:63], v[202:205], v[134:137]
    s_addc_u32 s13, s41, 0
    ds_read_b128 v[210:213], v2 offset:19456
    v_pk_mul_f16 v142, v150, v150
    v_mfma_f32_16x16x32_bf16 v[134:137], a[64:67], v[230:233], v[134:137]
    s_sub_u32 s14, s36, s27
    ds_read_b128 v[174:177], v5 offset:32
    v_cvt_pk_f16_f32 v151, v140, v141
    v_mfma_f32_16x16x32_bf16 v[134:137], a[68:71], v[238:241], v[134:137]
    s_cmp_ge_u32 s18, 2
    ds_read2_b64 v[162:165], v5 offset0:6 offset1:9
    v_pk_fma_f16 v142, v151, v151, v142
    v_mfma_f32_16x16x32_bf16 v[138:141], v[186:189], a[144:147], 0
    s_cselect_b32 s14, s14, 0
    ds_read_b128 v[170:173], v5
    v_cvt_pk_f16_f32 v152, v166, v167
    v_mfma_f32_16x16x32_bf16 v[138:141], v[194:197], a[148:151], v[138:141]
    s_sub_u32 s82, s72, s71
    ds_read_b32 v254, v6 offset:192
    v_pk_fma_f16 v142, v152, v152, v142
    v_mfma_f32_16x16x32_bf16 v[138:141], v[122:125], a[152:155], v[138:141]
    s_mul_i32 s74, s82, 336
    v_cvt_pk_f16_f32 v153, v168, v169
    v_pk_fma_f16 v142, v153, v153, v142
    v_mfma_f32_16x16x32_bf16 v[138:141], v[202:205], a[156:159], v[138:141]
    s_mul_i32 s75, s82, 272
    v_cvt_pk_f16_f32 v118, v134, v135
    v_pk_fma_f16 v142, v118, v118, v142
    v_mfma_f32_16x16x32_bf16 v[138:141], v[230:233], a[160:163], v[138:141]
    s_waitcnt lgkmcnt(5)
    ds_read_b128 v[182:185], v0 offset:26624
    v_cvt_pk_f16_f32 v119, v136, v137
    v_mfma_f32_16x16x32_bf16 v[166:169], v[32:35], v[190:193], 0
    s_waitcnt lgkmcnt(5)
    v_pk_fma_f16 v142, v119, v119, v142
    v_add_u32 v5, s74, v5
    v_mfma_f32_16x16x32_bf16 v[166:169], v[32:35], v[210:213], v[166:169]
    s_waitcnt lgkmcnt(4)
    v_pk_mul_f16 v145, v146, v174
    v_pk_fma_f16 v145, v147, v175, v145
    v_mfma_f32_16x16x32_bf16 v[138:141], v[238:241], a[164:167], v[138:141]
    s_mul_i32 s76, s82, 16
    ds_read_b128 v[210:213], v1 offset:26624
    v_pk_fma_f16 v145, v148, v176, v145
    v_mfma_f32_16x16x32_bf16 v[214:217], v[186:189], a[168:171], 0
    s_waitcnt lgkmcnt(3)
    ds_read_b128 v[218:221], v0 offset:26752
    v_pk_fma_f16 v145, v149, v177, v145
    v_mfma_f32_16x16x32_bf16 v[214:217], v[194:197], a[172:175], v[214:217]
    s_waitcnt lgkmcnt(3)
    ds_read_b128 v[222:225], v1 offset:26752
    v_mov_b32_dpp v254, v23 quad_perm:[0,1,2,3] row_mask:0x7 bank_mask:0xf
    v_mfma_f32_16x16x32_bf16 v[214:217], v[122:125], a[176:179], v[214:217]
    s_add_u32 s34, s18, 2
    ds_read_b128 v[226:229], v0 offset:26880
    v_pk_fma_f16 v145, v120, v164, v145
    v_mfma_f32_16x16x32_bf16 v[214:217], v[202:205], a[180:183], v[214:217]
    s_add_u32 s8, s60, s23
    ds_read_b128 v[190:193], v1 offset:26880
    v_pk_fma_f16 v145, v121, v165, v145
    v_mfma_f32_16x16x32_bf16 v[214:217], v[230:233], a[184:187], v[214:217]
    s_waitcnt lgkmcnt(5)
    v_pk_mul_f16 v144, v150, v170
    v_pk_fma_f16 v144, v151, v171, v144
    v_mfma_f32_16x16x32_bf16 v[214:217], v[238:241], a[188:191], v[214:217]
    s_addc_u32 s9, s61, 0
    v_pk_fma_f16 v144, v152, v172, v144
    v_pk_fma_f16 v144, v153, v173, v144
    v_mfma_f32_16x16x32_bf16 v[246:249], v[186:189], a[192:195], 0
    s_sub_u32 s10, s36, s23
    v_pk_fma_f16 v144, v118, v162, v144
    v_pk_fma_f16 v144, v119, v163, v144
    v_mfma_f32_16x16x32_bf16 v[246:249], v[194:197], a[196:199], v[246:249]
    s_cmp_le_u32 s34, s45
    v_cvt_pk_bf16_f32 v134, v138, v139
    v_cvt_pk_bf16_f32 v135, v140, v141
    v_mfma_f32_16x16x32_f16 v[234:237], v[40:43], v[142:145], 0
    s_cselect_b32 s10, s10, 0
    v_cvt_pk_bf16_f32 v138, v214, v215
    v_cvt_pk_bf16_f32 v139, v216, v217
    v_mfma_f32_16x16x32_bf16 v[246:249], v[122:125], a[200:203], v[246:249]
    s_add_u32 m0, s28, 0
    v_mul_f32 v136, 0x3baaaaab, v166
    v_mul_f32 v255, 0x3baaaaab, v167
    v_mfma_f32_16x16x32_bf16 v[246:249], v[202:205], a[204:207], v[246:249]
    s_mov_b32 s27, s26
    v_rsq_f32 v234, v234
    v_mfma_f32_16x16x32_bf16 v[246:249], v[230:233], a[208:211], v[246:249]
    s_mov_b32 s26, s25
    v_rsq_f32 v235, v235
    v_mfma_f32_16x16x32_bf16 v[246:249], v[238:241], a[212:215], v[246:249]
    s_mov_b32 s25, s24
    v_mul_f32 v140, s31, v234
    v_cvt_pk_f16_f32 v141, v140, v235
    v_mfma_f32_16x16x32_bf16 v[122:125], a[72:75], v[182:185], 0
    s_waitcnt lgkmcnt(0)
    v_fma_f32 v236, v236, v140, v22
    v_fmac_f32_dpp v254, v237, v235 quad_perm:[0,1,2,3] row_mask:0x1 bank_mask:0xf
    v_mfma_f32_16x16x32_bf16 v[122:125], a[76:79], v[210:213], v[122:125]
    s_mov_b32 s24, s23
    v_cvt_pk_bf16_f32 v142, v246, v247
    v_cvt_pk_bf16_f32 v143, v248, v249
    v_mfma_f32_16x16x32_bf16 v[122:125], a[80:83], v[218:221], v[122:125]
    s_mov_b32 s71, s72
    v_pk_mul_f16 v146, v146, v141 op_sel:[0,1] op_sel_hi:[1,1]
    v_pk_mul_f16 v147, v147, v141 op_sel:[0,1] op_sel_hi:[1,1]
    v_mfma_f32_16x16x32_bf16 v[122:125], a[84:87], v[222:225], v[122:125]
    s_mov_b32 s72, s73
    v_pk_mul_f16 v148, v148, v141 op_sel:[0,1] op_sel_hi:[1,1]
    v_pk_mul_f16 v149, v149, v141 op_sel:[0,1] op_sel_hi:[1,1]
    v_mfma_f32_16x16x32_bf16 v[122:125], a[88:91], v[226:229], v[122:125]
    v_pk_mul_f16 v120, v120, v141 op_sel:[0,1] op_sel_hi:[1,1]
    v_pk_mul_f16 v121, v121, v141 op_sel:[0,1] op_sel_hi:[1,1]
    v_mfma_f32_16x16x32_bf16 v[122:125], a[92:95], v[190:193], v[122:125]
    v_pk_mul_f16 v150, v150, v141 op_sel:[0,0] op_sel_hi:[1,0]
    v_pk_mul_f16 v151, v151, v141 op_sel:[0,0] op_sel_hi:[1,0]
    v_mfma_f32_16x16x32_bf16 v[186:189], a[96:99], v[182:185], 0
    v_pk_mul_f16 v152, v152, v141 op_sel:[0,0] op_sel_hi:[1,0]
    v_pk_mul_f16 v153, v153, v141 op_sel:[0,0] op_sel_hi:[1,0]
    v_mfma_f32_16x16x32_bf16 v[186:189], a[100:103], v[210:213], v[186:189]
    v_pk_mul_f16 v118, v118, v141 op_sel:[0,0] op_sel_hi:[1,0]
    v_pk_mul_f16 v119, v119, v141 op_sel:[0,0] op_sel_hi:[1,0]
    v_mfma_f32_16x16x32_bf16 v[186:189], a[104:107], v[218:221], v[186:189]
    v_max3_u32 v44, v44, v234, v235
    v_mul_f32 v144, 0x3baaaaab, v168
    v_mfma_f32_16x16x32_bf16 v[186:189], a[108:111], v[222:225], v[186:189]
    v_rsq_f32 v136, v136
    v_mfma_f32_16x16x32_bf16 v[186:189], a[112:115], v[226:229], v[186:189]
    v_rsq_f32 v255, v255
    v_mfma_f32_16x16x32_bf16 v[186:189], a[116:119], v[190:193], v[186:189]
    v_rsq_f32 v144, v144
    v_mfma_f32_16x16x32_bf16 v[194:197], a[120:123], v[182:185], 0
    v_mul_f32 v178, v136, v178
    v_mul_f32 v179, v136, v179
    v_mfma_f32_16x16x32_bf16 v[194:197], a[124:127], v[210:213], v[194:197]
    v_cvt_pk_bf16_f32 v166, v178, v179
    v_mul_f32 v180, v136, v180
    v_mfma_f32_16x16x32_bf16 v[194:197], a[128:131], v[218:221], v[194:197]
    v_mul_f32 v181, v136, v181
    v_cvt_pk_bf16_f32 v167, v180, v181
    v_mfma_f32_16x16x32_bf16 v[194:197], a[132:135], v[222:225], v[194:197]
    v_mul_f32 v198, v136, v198
    v_mul_f32 v199, v136, v199
    v_mfma_f32_16x16x32_bf16 v[194:197], a[136:139], v[226:229], v[194:197]
    v_cvt_pk_bf16_f32 v168, v198, v199
    v_mul_f32 v200, v136, v200
    v_mfma_f32_16x16x32_bf16 v[194:197], a[140:143], v[190:193], v[194:197]
    v_mul_f32 v201, v136, v201
    v_cvt_pk_bf16_f32 v169, v200, v201
    v_mfma_f32_16x16x32_bf16 v[178:181], a[0:3], v[182:185], 0
    buffer_store_dwordx4 v[166:169], v15, s[12:15], 0 offen nt
    v_mul_f32 v206, v136, v206
    v_mul_f32 v207, v136, v207
    v_cvt_pk_bf16_f32 v140, v206, v207
    v_mul_f32 v208, v136, v208
    v_mfma_f32_16x16x32_bf16 v[178:181], a[4:7], v[210:213], v[178:181]
    v_mul_f32 v209, v136, v209
    v_cvt_pk_bf16_f32 v141, v208, v209
    v_mfma_f32_16x16x32_bf16 v[178:181], a[8:11], v[218:221], v[178:181]
    v_cvt_pk_f16_f32 v166, v122, v123
    v_pk_mul_f16 v199, v166, v166
    v_mfma_f32_16x16x32_bf16 v[178:181], a[12:15], v[222:225], v[178:181]
    v_cvt_pk_f16_f32 v167, v124, v125
    v_pk_fma_f16 v199, v167, v167, v199
    v_mfma_f32_16x16x32_bf16 v[178:181], a[16:19], v[226:229], v[178:181]
    v_cvt_pk_f16_f32 v168, v186, v187
    v_pk_fma_f16 v199, v168, v168, v199
    v_mfma_f32_16x16x32_bf16 v[178:181], a[20:23], v[190:193], v[178:181]
    v_cvt_pk_f16_f32 v169, v188, v189
    v_pk_fma_f16 v199, v169, v169, v199
    v_mfma_f32_16x16x32_bf16 v[186:189], a[24:27], v[182:185], 0
    v_cvt_pk_f16_f32 v124, v194, v195
    v_pk_fma_f16 v199, v124, v124, v199
    v_mfma_f32_16x16x32_bf16 v[186:189], a[28:31], v[210:213], v[186:189]
    v_cvt_pk_f16_f32 v125, v196, v197
    v_pk_fma_f16 v199, v125, v125, v199
    v_mfma_f32_16x16x32_bf16 v[186:189], a[32:35], v[218:221], v[186:189]
    v_cvt_pk_f16_f32 v178, v178, v179
    v_pk_mul_f16 v198, v178, v178
    v_mfma_f32_16x16x32_bf16 v[186:189], a[36:39], v[222:225], v[186:189]
    v_cvt_pk_f16_f32 v179, v180, v181
    v_pk_fma_f16 v198, v179, v179, v198
    v_mfma_f32_16x16x32_bf16 v[186:189], a[40:43], v[226:229], v[186:189]
    v_pk_mul_f16 v200, v178, v170
    v_pk_fma_f16 v200, v179, v171, v200
    v_mfma_f32_16x16x32_bf16 v[186:189], a[44:47], v[190:193], v[186:189]
    v_pk_mul_f16 v201, v166, v174
    v_pk_fma_f16 v201, v167, v175, v201
    v_mfma_f32_16x16x32_bf16 v[194:197], a[48:51], v[182:185], 0
    v_pk_fma_f16 v201, v168, v176, v201
    v_pk_fma_f16 v201, v169, v177, v201
    v_mfma_f32_16x16x32_bf16 v[194:197], a[52:55], v[210:213], v[194:197]
    v_pk_fma_f16 v201, v124, v164, v201
    v_pk_fma_f16 v201, v125, v165, v201
    v_mfma_f32_16x16x32_bf16 v[194:197], a[56:59], v[218:221], v[194:197]
    v_cvt_pk_f16_f32 v180, v186, v187
    v_pk_fma_f16 v198, v180, v180, v198
    v_mfma_f32_16x16x32_bf16 v[194:197], a[60:63], v[222:225], v[194:197]
    v_cvt_pk_f16_f32 v181, v188, v189
    v_pk_fma_f16 v198, v181, v181, v198
    v_mfma_f32_16x16x32_bf16 v[194:197], a[64:67], v[226:229], v[194:197]
    v_pk_fma_f16 v200, v180, v172, v200
    v_pk_fma_f16 v200, v181, v173, v200
    v_mfma_f32_16x16x32_bf16 v[194:197], a[68:71], v[190:193], v[194:197]
    buffer_store_dwordx2 v[140:141], v18, s[12:15], 0 offen nt
    v_mul_f32 v242, v144, v242
    v_mul_f32 v243, v144, v243
    v_mfma_f32_16x16x32_bf16 v[186:189], v[182:185], a[144:147], 0
    v_cvt_pk_bf16_f32 v238, v242, v243
    v_mul_f32 v244, v144, v244
    v_mfma_f32_16x16x32_bf16 v[186:189], v[210:213], a[148:151], v[186:189]
    v_mul_f32 v245, v144, v245
    v_cvt_pk_f16_f32 v122, v194, v195
    v_mfma_f32_16x16x32_bf16 v[186:189], v[218:221], a[152:155], v[186:189]
    v_pk_fma_f16 v198, v122, v122, v198
    v_cvt_pk_f16_f32 v123, v196, v197
    v_mfma_f32_16x16x32_bf16 v[186:189], v[222:225], a[156:159], v[186:189]
    v_pk_fma_f16 v198, v123, v123, v198
    v_pk_fma_f16 v200, v122, v162, v200
    v_mfma_f32_16x16x32_bf16 v[186:189], v[226:229], a[160:163], v[186:189]
    ds_read_b128 v[202:205], v0 offset:32768
    v_pk_fma_f16 v200, v123, v163, v200
    v_mfma_f32_16x16x32_bf16 v[186:189], v[190:193], a[164:167], v[186:189]
    ds_read_b128 v[194:197], v1 offset:32768
    v_cvt_pk_bf16_f32 v239, v244, v245
    v_mfma_f32_16x16x32_f16 v[230:233], v[40:43], v[198:201], 0
    v_mul_f32 v158, v144, v158
    v_mul_f32 v159, v144, v159
    v_mfma_f32_16x16x32_bf16 v[246:249], v[182:185], a[168:171], 0
    ds_read_b128 v[214:217], v0 offset:32896
    v_cvt_pk_bf16_f32 v240, v158, v159
    v_mfma_f32_16x16x32_bf16 v[246:249], v[210:213], a[172:175], v[246:249]
    ds_read_b128 v[206:209], v1 offset:32896
    v_cvt_pk_bf16_f32 v136, v186, v187
    v_mfma_f32_16x16x32_bf16 v[246:249], v[218:221], a[176:179], v[246:249]
    ds_read_b128 v[198:201], v0 offset:33024
    v_cvt_pk_bf16_f32 v137, v188, v189
    v_mfma_f32_16x16x32_bf16 v[246:249], v[222:225], a[180:183], v[246:249]
    ds_read_b128 v[186:189], v1 offset:33024
    v_mul_f32 v160, v144, v160
    v_mfma_f32_16x16x32_bf16 v[246:249], v[226:229], a[184:187], v[246:249]
    v_rsq_f32 v230, v230
    v_mfma_f32_16x16x32_bf16 v[246:249], v[190:193], a[188:191], v[246:249]
    s_waitcnt lgkmcnt(5)
    v_rsq_f32 v231, v231
    v_mfma_f32_16x16x32_bf16 v[242:245], v[182:185], a[192:195], 0
    s_waitcnt lgkmcnt(4)
    v_mul_f32 v234, s31, v230
    v_cvt_pk_f16_f32 v235, v234, v231
    v_mfma_f32_16x16x32_bf16 v[242:245], v[210:213], a[196:199], v[242:245]
    v_fma_f32 v232, v232, v234, v24
    v_fmac_f32_dpp v254, v233, v231 quad_perm:[0,1,2,3] row_mask:0x2 bank_mask:0xf
    v_mfma_f32_16x16x32_bf16 v[242:245], v[218:221], a[200:203], v[242:245]
    s_waitcnt lgkmcnt(3)
    v_cvt_pk_bf16_f32 v140, v246, v247
    v_cvt_pk_bf16_f32 v141, v248, v249
    v_mfma_f32_16x16x32_bf16 v[242:245], v[222:225], a[204:207], v[242:245]
    s_waitcnt lgkmcnt(2)
    v_mul_f32 v161, v144, v161
    v_cvt_pk_bf16_f32 v241, v160, v161
    v_mfma_f32_16x16x32_bf16 v[242:245], v[226:229], a[208:211], v[242:245]
    s_waitcnt lgkmcnt(1)
    buffer_store_dwordx4 v[238:241], v17, s[12:15], 0 offen nt
    v_mul_f32 v154, v144, v154
    v_mul_f32 v155, v144, v155
    v_cvt_pk_bf16_f32 v154, v154, v155
    v_mul_f32 v156, v144, v156
    v_mfma_f32_16x16x32_bf16 v[242:245], v[190:193], a[212:215], v[242:245]
    s_waitcnt lgkmcnt(0)
    v_mul_f32 v157, v144, v157
    v_cvt_pk_bf16_f32 v155, v156, v157
    v_mfma_f32_16x16x32_bf16 v[158:161], a[72:75], v[202:205], 0
    v_pk_mul_f16 v166, v166, v235 op_sel:[0,1] op_sel_hi:[1,1]
    v_pk_mul_f16 v167, v167, v235 op_sel:[0,1] op_sel_hi:[1,1]
    v_mfma_f32_16x16x32_bf16 v[158:161], a[76:79], v[194:197], v[158:161]
    v_pk_mul_f16 v168, v168, v235 op_sel:[0,1] op_sel_hi:[1,1]
    v_cvt_pk_bf16_f32 v144, v242, v243
    v_mfma_f32_16x16x32_bf16 v[158:161], a[80:83], v[214:217], v[158:161]
    v_cvt_pk_bf16_f32 v145, v244, v245
    v_pk_mul_f16 v169, v169, v235 op_sel:[0,1] op_sel_hi:[1,1]
    v_mfma_f32_16x16x32_bf16 v[158:161], a[84:87], v[206:209], v[158:161]
    v_pk_mul_f16 v124, v124, v235 op_sel:[0,1] op_sel_hi:[1,1]
    v_pk_mul_f16 v125, v125, v235 op_sel:[0,1] op_sel_hi:[1,1]
    v_mfma_f32_16x16x32_bf16 v[158:161], a[88:91], v[198:201], v[158:161]
    v_pk_mul_f16 v178, v178, v235 op_sel:[0,0] op_sel_hi:[1,0]
    v_pk_mul_f16 v179, v179, v235 op_sel:[0,0] op_sel_hi:[1,0]
    v_mfma_f32_16x16x32_bf16 v[158:161], a[92:95], v[186:189], v[158:161]
    v_pk_mul_f16 v180, v180, v235 op_sel:[0,0] op_sel_hi:[1,0]
    v_pk_mul_f16 v181, v181, v235 op_sel:[0,0] op_sel_hi:[1,0]
    v_mfma_f32_16x16x32_bf16 v[182:185], a[96:99], v[202:205], 0
    v_pk_mul_f16 v122, v122, v235 op_sel:[0,0] op_sel_hi:[1,0]
    v_pk_mul_f16 v123, v123, v235 op_sel:[0,0] op_sel_hi:[1,0]
    v_mfma_f32_16x16x32_bf16 v[182:185], a[100:103], v[194:197], v[182:185]
    v_max3_u32 v44, v44, v230, v231
    v_mul_f32 v130, v255, v130
    v_mfma_f32_16x16x32_bf16 v[182:185], a[104:107], v[214:217], v[182:185]
    v_cvt_pk_f16_f32 v158, v158, v159
    v_pk_mul_f16 v191, v158, v158
    v_mfma_f32_16x16x32_bf16 v[182:185], a[108:111], v[206:209], v[182:185]
    v_cvt_pk_f16_f32 v159, v160, v161
    v_pk_fma_f16 v191, v159, v159, v191
    v_mfma_f32_16x16x32_bf16 v[182:185], a[112:115], v[198:201], v[182:185]
    v_pk_mul_f16 v193, v158, v174
    v_pk_fma_f16 v193, v159, v175, v193
    v_mfma_f32_16x16x32_bf16 v[182:185], a[116:119], v[186:189], v[182:185]
    v_exp_f32 v232, v232
    v_mfma_f32_16x16x32_bf16 v[210:213], a[120:123], v[202:205], 0
    v_exp_f32 v236, v236
    v_mfma_f32_16x16x32_bf16 v[210:213], a[124:127], v[194:197], v[210:213]
    v_cvt_pk_bf16_f32 v39, v236, 0
    v_mul_f32 v131, v255, v131
    v_mfma_f32_16x16x32_bf16 v[210:213], a[128:131], v[214:217], v[210:213]
    s_waitcnt vmcnt(3)
    ds_write_b16 v8, v45 offset:512
    v_mfma_f32_16x16x32_bf16 v[210:213], a[132:135], v[206:209], v[210:213]
    buffer_store_dwordx2 v[154:155], v20, s[12:15], 0 offen nt
    v_cvt_pk_f16_f32 v160, v182, v183
    v_mfma_f32_16x16x32_bf16 v[210:213], a[136:139], v[198:201], v[210:213]
    v_pk_fma_f16 v191, v160, v160, v191
    v_cvt_pk_f16_f32 v161, v184, v185
    v_mfma_f32_16x16x32_bf16 v[210:213], a[140:143], v[186:189], v[210:213]
    v_pk_fma_f16 v191, v161, v161, v191
    v_pk_fma_f16 v193, v160, v176, v193
    v_mfma_f32_16x16x32_bf16 v[154:157], a[0:3], v[202:205], 0
    v_pk_fma_f16 v193, v161, v177, v193
    v_cvt_pk_bf16_f32 v130, v130, v131
    v_mfma_f32_16x16x32_bf16 v[154:157], a[4:7], v[194:197], v[154:157]
    v_mul_f32 v132, v255, v132
    v_mul_f32 v133, v255, v133
    v_mfma_f32_16x16x32_bf16 v[154:157], a[8:11], v[214:217], v[154:157]
    v_cvt_pk_f16_f32 v176, v210, v211
    v_pk_fma_f16 v191, v176, v176, v191
    v_mfma_f32_16x16x32_bf16 v[154:157], a[12:15], v[206:209], v[154:157]
    s_waitcnt lgkmcnt(0)
    v_cvt_pk_f16_f32 v177, v212, v213
    v_pk_fma_f16 v191, v177, v177, v191
    v_mfma_f32_16x16x32_bf16 v[154:157], a[16:19], v[198:201], v[154:157]
    v_pk_fma_f16 v193, v176, v164, v193
    v_mfma_f32_16x16x32_bf16 v[154:157], a[20:23], v[186:189], v[154:157]
    s_barrier
    v_pk_fma_f16 v193, v177, v165, v193
    v_mfma_f32_16x16x32_bf16 v[182:185], a[24:27], v[202:205], 0
    v_cvt_pk_bf16_f32 v131, v132, v133
    v_mfma_f32_16x16x32_bf16 v[182:185], a[28:31], v[194:197], v[182:185]
    ds_read2_b32 v[164:165], v6 offset0:0 offset1:0
    v_mfma_f32_16x16x32_bf16 v[182:185], a[32:35], v[214:217], v[182:185]
    ds_read2_b32 v[212:213], v6 offset0:16 offset1:16
    v_cvt_pk_f16_f32 v154, v154, v155
    v_mfma_f32_16x16x32_bf16 v[182:185], a[36:39], v[206:209], v[182:185]
    ds_read2_b32 v[220:221], v6 offset0:32 offset1:32
    v_pk_mul_f16 v190, v154, v154
    v_mfma_f32_16x16x32_bf16 v[182:185], a[40:43], v[198:201], v[182:185]
    ds_read_u16 v133, v9 offset:384
    v_cvt_pk_f16_f32 v155, v156, v157
    v_mfma_f32_16x16x32_bf16 v[182:185], a[44:47], v[186:189], v[182:185]
    v_pk_fma_f16 v190, v155, v155, v190
    v_pk_mul_f16 v192, v154, v170
    v_mfma_f32_16x16x32_bf16 v[222:225], a[48:51], v[202:205], 0
    v_pk_fma_f16 v192, v155, v171, v192
    v_mul_f32 v126, v255, v126
    v_mfma_f32_16x16x32_bf16 v[222:225], a[52:55], v[194:197], v[222:225]
    v_mul_f32 v127, v255, v127
    v_cvt_pk_bf16_f32 v132, v126, v127
    v_mfma_f32_16x16x32_bf16 v[222:225], a[56:59], v[214:217], v[222:225]
    buffer_load_dwordx4 v10, s[8:11], 0 offen nt lds
    v_cvt_pk_f16_f32 v156, v182, v183
    v_mfma_f32_16x16x32_bf16 v[222:225], a[60:63], v[206:209], v[222:225]
    s_add_u32 m0, s28, 4096
    v_pk_fma_f16 v190, v156, v156, v190
    v_cvt_pk_f16_f32 v157, v184, v185
    v_mfma_f32_16x16x32_bf16 v[222:225], a[64:67], v[198:201], v[222:225]
    s_waitcnt lgkmcnt(2)
    v_pk_fma_f16 v190, v157, v157, v190
    v_pk_fma_f16 v192, v156, v172, v192
    v_mfma_f32_16x16x32_bf16 v[222:225], a[68:71], v[186:189], v[222:225]
    s_waitcnt lgkmcnt(1)
    ds_read_b128 v[182:185], v2 offset:0
    v_pk_fma_f16 v192, v157, v173, v192
    v_mfma_f32_16x16x32_bf16 v[170:173], v[202:205], a[144:147], 0
    s_waitcnt lgkmcnt(1)
    ds_read_b128 v[226:229], v2 offset:1024
    v_readfirstlane_b32 s77, v133
    v_mfma_f32_16x16x32_bf16 v[170:173], v[194:197], a[148:151], v[170:173]
    ds_read_b128 v[234:237], v2 offset:2048
    buffer_load_dwordx4 v11, s[8:11], 0 offen nt lds
    v_mfma_f32_16x16x32_bf16 v[170:173], v[214:217], a[152:155], v[170:173]
    s_add_u32 m0, s28, 8192
    ds_read_b128 v[238:241], v2 offset:3072
    v_cvt_pk_f16_f32 v174, v222, v223
    v_mfma_f32_16x16x32_bf16 v[170:173], v[206:209], a[156:159], v[170:173]
    s_mul_i32 s78, s77, 2688
    ds_read_b128 v[242:245], v2 offset:4096
    v_pk_fma_f16 v190, v174, v174, v190
    v_mfma_f32_16x16x32_bf16 v[170:173], v[198:201], a[160:163], v[170:173]
    ds_read_b128 v[246:249], v2 offset:5120
    v_cvt_pk_f16_f32 v175, v224, v225
    v_mfma_f32_16x16x32_bf16 v[170:173], v[186:189], a[164:167], v[170:173]
    v_pk_fma_f16 v190, v175, v175, v190
    v_pk_fma_f16 v192, v174, v162, v192
    v_mfma_f32_16x16x32_bf16 v[222:225], v[202:205], a[168:171], 0
    buffer_load_dwordx4 v12, s[8:11], 0 offen nt lds
    v_pk_fma_f16 v192, v175, v163, v192
    v_mfma_f32_16x16x32_bf16 v[222:225], v[194:197], a[172:175], v[222:225]
    s_waitcnt lgkmcnt(5)
    v_mul_f32 v128, v255, v128
    v_cvt_pk_bf16_f32 v162, v170, v171
    v_mfma_f32_16x16x32_f16 v[250:253], v[40:43], v[190:193], 0
    s_add_u32 m0, s28, 12288
    v_cvt_pk_bf16_f32 v163, v172, v173
    v_mul_f32 v129, v255, v129
    v_mfma_f32_16x16x32_bf16 v[222:225], v[214:217], a[176:179], v[222:225]
    s_xor_b32 s28, s28, 65536
    v_cvt_pk_bf16_f32 v133, v128, v129
    v_mul_f32 v114, v255, v114
    v_mfma_f32_16x16x32_bf16 v[222:225], v[206:209], a[180:183], v[222:225]
    s_waitcnt lgkmcnt(2)
    v_rsq_f32 v250, v250
    v_mfma_f32_16x16x32_bf16 v[222:225], v[198:201], a[184:187], v[222:225]
    s_waitcnt lgkmcnt(1)
    buffer_load_dwordx4 v13, s[8:11], 0 offen nt lds
    v_mul_f32 v230, s31, v250
    v_mfma_f32_16x16x32_bf16 v[222:225], v[186:189], a[188:191], v[222:225]
    s_mov_b32 m0, s29
    v_rsq_f32 v251, v251
    v_mfma_f32_16x16x32_bf16 v[126:129], v[202:205], a[192:195], 0
    s_xor_b32 s29, s29, s30
    v_cvt_pk_f16_f32 v231, v230, v251
    v_fma_f32 v252, v252, v230, v26
    v_mfma_f32_16x16x32_bf16 v[126:129], v[194:197], a[196:199], v[126:129]
    s_add_u32 s19, s19, s20
    v_fmac_f32_dpp v254, v253, v251 quad_perm:[0,1,2,3] row_mask:0x4 bank_mask:0xf
    v_cvt_pk_bf16_f32 v210, v222, v223
    v_mfma_f32_16x16x32_bf16 v[126:129], v[214:217], a[200:203], v[126:129]
    s_add_u32 s23, s23, s21
    v_cvt_pk_bf16_f32 v211, v224, v225
    v_pk_mul_f16 v158, v158, v231 op_sel:[0,1] op_sel_hi:[1,1]
    v_mfma_f32_16x16x32_bf16 v[126:129], v[206:209], a[204:207], v[126:129]
    s_waitcnt lgkmcnt(0)
    buffer_load_dwordx4 v14, s[8:11], 0 offen nt lds
    v_pk_mul_f16 v159, v159, v231 op_sel:[0,1] op_sel_hi:[1,1]
    v_mfma_f32_16x16x32_bf16 v[126:129], v[198:201], a[208:211], v[126:129]
    s_cmp_ge_u32 s19, 72
    v_pk_mul_f16 v160, v160, v231 op_sel:[0,1] op_sel_hi:[1,1]
    v_pk_mul_f16 v161, v161, v231 op_sel:[0,1] op_sel_hi:[1,1]
    v_mfma_f32_16x16x32_bf16 v[126:129], v[186:189], a[212:215], v[126:129]
    s_cselect_b32 s34, 72, 0
    v_pk_mul_f16 v176, v176, v231 op_sel:[0,1] op_sel_hi:[1,1]
    v_pk_mul_f16 v177, v177, v231 op_sel:[0,1] op_sel_hi:[1,1]
    v_mfma_f32_16x16x32_f16 v[170:173], v[146:149], v[150:153], v[46:49]
    s_cselect_b32 s35, s22, 0
    v_pk_mul_f16 v154, v154, v231 op_sel:[0,0] op_sel_hi:[1,0]
    v_pk_mul_f16 v155, v155, v231 op_sel:[0,0] op_sel_hi:[1,0]
    v_mfma_f32_16x16x32_f16 v[186:189], v[166:169], v[150:153], v[50:53]
    s_sub_u32 s19, s19, s34
    v_cvt_pk_bf16_f32 v218, v126, v127
    v_cvt_pk_bf16_f32 v219, v128, v129
    v_mfma_f32_16x16x32_f16 v[126:129], v[158:161], v[150:153], v[54:57]
    buffer_store_dwordx4 v[130:133], v16, s[12:15], 0 offen nt
    v_pk_mul_f16 v156, v156, v231 op_sel:[0,0] op_sel_hi:[1,0]
    v_pk_mul_f16 v157, v157, v231 op_sel:[0,0] op_sel_hi:[1,0]
    v_pk_mul_f16 v174, v174, v231 op_sel:[0,0] op_sel_hi:[1,0]
    v_pk_mul_f16 v175, v175, v231 op_sel:[0,0] op_sel_hi:[1,0]
    v_mfma_f32_16x16x16_f16 v[170:173], v[120:121], v[118:119], v[170:173]
    v_max3_u32 v44, v44, v250, v251
    v_exp_f32 v254, v254
    v_mfma_f32_16x16x16_f16 v[186:189], v[124:125], v[118:119], v[186:189]
    v_cvt_pk_bf16_f32 v254, v254, v254
    v_exp_f32 v252, v252
    v_mfma_f32_16x16x16_f16 v[126:129], v[176:177], v[118:119], v[126:129]
    v_mul_f32 v115, v255, v115
    v_cvt_pk_bf16_f32 v118, v114, v115
    v_exp_f32 v170, v170
    v_mfma_f32_16x16x32_f16 v[130:133], v[146:149], v[178:181], v[58:61]
    s_add_u32 s23, s23, s35
    ds_write_b16 v8, v254
    v_mfma_f32_16x16x32_f16 v[150:153], v[166:169], v[178:181], v[62:65]
    s_add_u32 s78, s78, s69
    v_exp_f32 v171, v171
    v_mfma_f32_16x16x32_f16 v[190:193], v[158:161], v[178:181], v[66:69]
    s_add_u32 s80, s77, s68
    v_cvt_pk_bf16_f32 v170, v170, v171
    v_exp_f32 v172, v172
    v_mfma_f32_16x16x16_f16 v[130:133], v[120:121], v[122:123], v[130:133]
    v_exp_f32 v173, v173
    v_mul_f32 v116, v255, v116
    v_mfma_f32_16x16x16_f16 v[150:153], v[124:125], v[122:123], v[150:153]
    v_cvt_pk_bf16_f32 v171, v172, v173
    v_exp_f32 v186, v186
    v_mfma_f32_16x16x16_f16 v[190:193], v[176:177], v[122:123], v[190:193]
    v_exp_f32 v187, v187
    v_exp_f32 v188, v188
    v_mfma_f32_16x16x32_bf16 v[178:181], a[216:219], v[182:185], 0
    s_cmp_ge_u32 s80, 72
    v_exp_f32 v130, v130
    v_mfma_f32_16x16x32_bf16 v[178:181], a[220:223], v[226:229], v[178:181]
    s_cselect_b32 s80, s22, 0
    v_exp_f32 v131, v131
    v_mfma_f32_16x16x32_bf16 v[178:181], a[224:227], v[234:237], v[178:181]
    s_add_u32 s78, s78, s80
    v_cvt_pk_bf16_f32 v194, v130, v131
    v_cvt_pk_bf16_f32 v172, v186, v187
    v_mfma_f32_16x16x32_bf16 v[178:181], a[228:231], v[238:241], v[178:181]
    s_add_u32 s80, s77, 20
    v_exp_f32 v132, v132
    v_mfma_f32_16x16x32_bf16 v[178:181], a[232:235], v[242:245], v[178:181]
    s_add_u32 s34, s18, 3
    v_exp_f32 v133, v133
    v_mfma_f32_16x16x32_bf16 v[178:181], a[236:239], v[246:249], v[178:181]
    s_cmp_lt_u32 s77, s62
    v_cvt_pk_bf16_f32 v195, v132, v133
    v_mul_f32 v117, v255, v117
    v_mfma_f32_16x16x32_bf16 v[198:201], a[240:243], v[182:185], 0
    s_cselect_b32 s79, 1, 0
    v_exp_f32 v150, v150
    v_mfma_f32_16x16x32_f16 v[202:205], v[146:149], v[154:157], v[70:73]
    s_cselect_b32 s78, s78, 0
    v_exp_f32 v151, v151
    v_mfma_f32_16x16x32_f16 v[146:149], v[166:169], v[154:157], v[74:77]
    s_cmp_lt_u32 s34, s17
    v_cvt_pk_bf16_f32 v196, v150, v151
    v_cvt_pk_bf16_f32 v119, v116, v117
    v_mfma_f32_16x16x32_f16 v[166:169], v[158:161], v[154:157], v[78:81]
    buffer_store_dwordx2 v[118:119], v19, s[12:15], 0 offen nt
    v_exp_f32 v152, v152
    v_mfma_f32_16x16x16_f16 v[202:205], v[120:121], v[174:175], v[202:205]
    v_exp_f32 v153, v153
    v_fma_f32 v254, v178, v178, s33
    v_mfma_f32_16x16x16_f16 v[146:149], v[124:125], v[174:175], v[146:149]
    v_cvt_pk_bf16_f32 v197, v152, v153
    v_exp_f32 v190, v190
    v_mfma_f32_16x16x16_f16 v[166:169], v[176:177], v[174:175], v[166:169]
    v_exp_f32 v191, v191
    v_exp_f32 v192, v192
    v_mfma_f32_16x16x32_bf16 v[198:201], a[244:247], v[226:229], v[198:201]
    s_cselect_b32 s23, s23, s78
    v_exp_f32 v193, v193
    v_mfma_f32_16x16x32_bf16 v[198:201], a[248:251], v[234:237], v[198:201]
    s_cselect_b32 s73, s34, s80
    ds_read_b128 v[118:121], v2 offset:6144
    v_fmac_f32 v254, v179, v179
    v_mfma_f32_16x16x32_bf16 v[198:201], a[252:255], v[238:241], v[198:201]
    s_cselect_b32 s79, 0, s79
    ds_read_b128 v[122:125], v2 offset:7168
    v_fmac_f32 v254, v180, v180
    v_mfma_f32_16x16x32_bf16 v[198:201], v[82:85], v[242:245], v[198:201]
    s_cselect_b32 s81, 0, 1
    ds_read_b128 v[150:153], v2 offset:8192
    v_fmac_f32 v254, v181, v181
    v_mfma_f32_16x16x32_bf16 v[198:201], v[86:89], v[246:249], v[198:201]
    s_add_u32 s80, s77, 1
    ds_read_b128 v[154:157], v2 offset:9216
    v_xor_b32 v0, 65536, v0
    v_mfma_f32_16x16x32_bf16 v[206:209], v[90:93], v[182:185], 0
    s_mul_i32 s80, s80, s81
    ds_read_b128 v[158:161], v2 offset:10240
    v_xor_b32 v1, 65536, v1
    v_mfma_f32_16x16x32_bf16 v[206:209], v[94:97], v[226:229], v[206:209]
    s_cmp_lt_u32 s80, s62
    ds_read_b128 v[174:177], v2 offset:11264
    v_fmac_f32 v254, v198, v198
    v_mfma_f32_16x16x32_bf16 v[206:209], v[98:101], v[234:237], v[206:209]
    s_cselect_b32 s62, s62, 0
    v_exp_f32 v189, v189
    v_mfma_f32_16x16x32_bf16 v[206:209], v[102:105], v[238:241], v[206:209]
    s_add_u32 s80, s18, 4
    v_cvt_pk_bf16_f32 v173, v188, v189
    v_fmac_f32 v254, v199, v199
    v_mfma_f32_16x16x32_bf16 v[206:209], v[106:109], v[242:245], v[206:209]
    s_waitcnt lgkmcnt(5)
    v_exp_f32 v126, v126
    v_mfma_f32_16x16x32_bf16 v[206:209], v[110:113], v[246:249], v[206:209]
    s_cmp_ge_u32 s80, s17
    v_exp_f32 v127, v127
    v_mfma_f32_16x16x32_bf16 v[130:133], a[216:219], v[118:121], 0
    s_waitcnt lgkmcnt(3)
    v_cvt_pk_bf16_f32 v36, v126, v127
    v_fmac_f32 v254, v200, v200
    v_mfma_f32_16x16x32_bf16 v[130:133], a[220:223], v[122:125], v[130:133]
    s_cselect_b32 s66, s62, 0
    v_exp_f32 v128, v128
    v_mfma_f32_16x16x32_bf16 v[130:133], a[224:227], v[150:153], v[130:133]
    s_waitcnt lgkmcnt(1)
    v_fmac_f32 v254, v201, v201
    v_mfma_f32_16x16x32_bf16 v[130:133], a[228:231], v[154:157], v[130:133]
    s_lshl_b32 s80, s79, s73
    v_exp_f32 v129, v129
    v_mfma_f32_16x16x32_bf16 v[130:133], a[232:235], v[158:161], v[130:133]
    s_waitcnt lgkmcnt(0)
    v_cvt_pk_bf16_f32 v37, v128, v129
    v_fmac_f32 v254, v206, v206
    v_mfma_f32_16x16x32_bf16 v[130:133], a[236:239], v[174:177], v[130:133]
    s_or_b32 s70, s70, s80
    v_exp_f32 v202, v202
    v_mfma_f32_16x16x32_bf16 v[182:185], v[28:31], v[36:39], 0
    s_add_u32 s45, s45, s79
    v_exp_f32 v203, v203
    v_mfma_f32_16x16x32_bf16 v[182:185], v[28:31], v[170:173], v[182:185]
    s_add_u32 s18, s18, 1
    v_cvt_pk_bf16_f32 v186, v202, v203
    v_fma_f32 v255, v130, v130, s33
    v_mfma_f32_16x16x32_bf16 v[214:217], v[162:165], v[36:39], 0
    s_cmp_lt_u32 s18, s45
    v_fmac_f32 v255, v131, v131
    v_fmac_f32 v255, v132, v132
    v_mfma_f32_16x16x32_bf16 v[214:217], v[134:137], v[170:173], v[214:217]
    v_fmac_f32 v255, v133, v133
    v_fmac_f32 v254, v207, v207
    v_mfma_f32_16x16x32_bf16 v[222:225], v[210:213], v[36:39], 0
    v_exp_f32 v204, v204
    v_mfma_f32_16x16x32_bf16 v[222:225], v[138:141], v[170:173], v[222:225]
    v_exp_f32 v205, v205
    v_mfma_f32_16x16x32_bf16 v[226:229], v[218:221], v[36:39], 0
    v_cvt_pk_bf16_f32 v36, v190, v191
    v_cvt_pk_bf16_f32 v37, v192, v193
    v_mfma_f32_16x16x32_bf16 v[226:229], v[142:145], v[170:173], v[226:229]
    v_cvt_pk_bf16_f32 v39, v232, 0
    v_cvt_pk_bf16_f32 v187, v204, v205
    v_mfma_f32_16x16x32_bf16 v[126:129], a[240:243], v[118:121], 0
    v_exp_f32 v146, v146
    v_mfma_f32_16x16x32_bf16 v[170:173], v[28:31], v[36:39], 0
    v_exp_f32 v147, v147
    v_mfma_f32_16x16x32_bf16 v[170:173], v[28:31], v[194:197], v[170:173]
    v_cvt_pk_bf16_f32 v188, v146, v147
    v_fmac_f32 v254, v208, v208
    v_mfma_f32_16x16x32_bf16 v[114:117], v[162:165], v[36:39], 0
    v_exp_f32 v148, v148
    v_mfma_f32_16x16x32_bf16 v[114:117], v[134:137], v[194:197], v[114:117]
    v_exp_f32 v149, v149
    v_mfma_f32_16x16x32_bf16 v[190:193], v[210:213], v[36:39], 0
    v_cvt_pk_bf16_f32 v189, v148, v149
    v_fmac_f32 v254, v209, v209
    v_mfma_f32_16x16x32_bf16 v[190:193], v[138:141], v[194:197], v[190:193]
    v_rcp_f32 v170, v170
    v_mfma_f32_16x16x32_bf16 v[146:149], v[218:221], v[36:39], 0
    v_exp_f32 v166, v166
    v_mfma_f32_16x16x32_bf16 v[146:149], v[142:145], v[194:197], v[146:149]
    v_mul_f32 v114, v170, v114
    v_mul_f32 v115, v170, v115
    v_mfma_f32_16x16x32_bf16 v[126:129], a[244:247], v[122:125], v[126:129]
    v_cvt_pk_bf16_f32 v194, v114, v115
    v_mul_f32 v116, v170, v116
    v_mfma_f32_16x16x32_bf16 v[126:129], a[248:251], v[150:153], v[126:129]
    ds_read_b128 v[202:205], v2 offset:12288
    v_mul_f32 v117, v170, v117
    v_mfma_f32_16x16x32_bf16 v[126:129], a[252:255], v[154:157], v[126:129]
    ds_read_b128 v[230:233], v2 offset:13312
    v_cvt_pk_bf16_f32 v195, v116, v117
    v_mfma_f32_16x16x32_bf16 v[126:129], v[82:85], v[158:161], v[126:129]
    ds_read_b128 v[234:237], v2 offset:14336
    v_mul_f32 v190, v170, v190
    v_mfma_f32_16x16x32_bf16 v[126:129], v[86:89], v[174:177], v[126:129]
    ds_read_b128 v[238:241], v2 offset:15360
    v_mul_f32 v191, v170, v191
    v_mfma_f32_16x16x32_bf16 v[114:117], v[90:93], v[118:121], 0
    ds_read_b128 v[118:121], v2 offset:16384
    v_cvt_pk_bf16_f32 v196, v190, v191
    v_mfma_f32_16x16x32_bf16 v[114:117], v[94:97], v[122:125], v[114:117]
    ds_read_b128 v[122:125], v2 offset:17408
    v_mul_f32 v192, v170, v192
    v_mfma_f32_16x16x32_bf16 v[114:117], v[98:101], v[150:153], v[114:117]
    v_fmac_f32 v255, v126, v126
    v_fmac_f32 v255, v127, v127
    v_mfma_f32_16x16x32_bf16 v[114:117], v[102:105], v[154:157], v[114:117]
    v_fmac_f32 v255, v128, v128
    v_fmac_f32 v255, v129, v129
    v_mfma_f32_16x16x32_bf16 v[114:117], v[106:109], v[158:161], v[114:117]
    s_waitcnt lgkmcnt(5)
    v_mul_f32 v193, v170, v193
    v_cvt_pk_bf16_f32 v197, v192, v193
    v_mfma_f32_16x16x32_bf16 v[114:117], v[110:113], v[174:177], v[114:117]
    s_waitcnt lgkmcnt(4)
    ds_write_b128 v3, v[194:197] offset:6144
    v_mfma_f32_16x16x32_bf16 v[242:245], a[216:219], v[202:205], 0
    s_waitcnt lgkmcnt(3)
    v_mul_f32 v146, v170, v146
    v_mul_f32 v147, v170, v147
    v_mfma_f32_16x16x32_bf16 v[242:245], a[220:223], v[230:233], v[242:245]
    s_waitcnt lgkmcnt(2)
    v_fmac_f32 v255, v114, v114
    v_fmac_f32 v255, v115, v115
    v_mfma_f32_16x16x32_bf16 v[242:245], a[224:227], v[234:237], v[242:245]
    s_waitcnt lgkmcnt(1)
    v_fmac_f32 v255, v116, v116
    v_fmac_f32 v255, v117, v117
    v_mfma_f32_16x16x32_bf16 v[242:245], a[228:231], v[238:241], v[242:245]
    v_cvt_pk_bf16_f32 v254, v254, v255
    v_cvt_pk_bf16_f32 v172, v146, v147
    v_mfma_f32_16x16x32_bf16 v[242:245], a[232:235], v[118:121], v[242:245]
    v_mul_f32 v148, v170, v148
    v_mul_f32 v149, v170, v149
    v_mfma_f32_16x16x32_bf16 v[242:245], a[236:239], v[122:125], v[242:245]
    v_cvt_pk_bf16_f32 v173, v148, v149
    v_cvt_pk_bf16_f32 v39, v252, 0
    v_mfma_f32_16x16x32_bf16 v[158:161], a[240:243], v[202:205], 0
    ds_write_b64 v4, v[172:173] offset:10240
    v_mfma_f32_16x16x32_bf16 v[158:161], a[244:247], v[230:233], v[158:161]
    v_exp_f32 v167, v167
    v_mfma_f32_16x16x32_bf16 v[158:161], a[248:251], v[234:237], v[158:161]
    v_cvt_pk_bf16_f32 v36, v166, v167
    v_fma_f32 v255, v242, v242, s33
    v_mfma_f32_16x16x32_bf16 v[158:161], a[252:255], v[238:241], v[158:161]
    v_fmac_f32 v255, v243, v243
    v_fmac_f32 v255, v244, v244
    v_mfma_f32_16x16x32_bf16 v[158:161], v[82:85], v[118:121], v[158:161]
    v_fmac_f32 v255, v245, v245
    v_xor_b32 v2, 65536, v2
    v_mfma_f32_16x16x32_bf16 v[158:161], v[86:89], v[122:125], v[158:161]
    v_exp_f32 v168, v168
    v_mfma_f32_16x16x32_bf16 v[154:157], v[90:93], v[202:205], 0
    v_exp_f32 v169, v169
    v_mfma_f32_16x16x32_bf16 v[154:157], v[94:97], v[230:233], v[154:157]
    ds_read_b128 v[146:149], v9
    v_cvt_pk_bf16_f32 v37, v168, v169
    v_mfma_f32_16x16x32_bf16 v[154:157], v[98:101], v[234:237], v[154:157]
    ds_read_b128 v[150:153], v9 offset:64
    v_fmac_f32 v255, v158, v158
    v_mfma_f32_16x16x32_bf16 v[166:169], v[28:31], v[36:39], 0
    v_fmac_f32 v255, v159, v159
    v_fmac_f32 v255, v160, v160
    v_mfma_f32_16x16x32_bf16 v[166:169], v[28:31], v[186:189], v[166:169]
    v_fmac_f32 v255, v161, v161
    v_add_u32 v6, s75, v6
    v_mfma_f32_16x16x32_bf16 v[174:177], v[162:165], v[36:39], 0
    v_rcp_f32 v182, v182
    v_mfma_f32_16x16x32_bf16 v[174:177], v[134:137], v[186:189], v[174:177]
    v_max3_u32 v25, v25, v182, v183
    v_max3_u32 v25, v25, v170, v171
    v_mfma_f32_16x16x32_bf16 v[170:173], v[210:213], v[36:39], 0
    v_rcp_f32 v166, v166
    v_mfma_f32_16x16x32_bf16 v[170:173], v[138:141], v[186:189], v[170:173]
    v_max3_u32 v25, v25, v166, v167
    v_mul_f32 v214, v182, v214
    v_mfma_f32_16x16x32_bf16 v[190:193], v[218:221], v[36:39], 0
    s_waitcnt lgkmcnt(1)
    v_mul_f32 v174, v166, v174
    v_mul_f32 v175, v166, v175
    v_mfma_f32_16x16x32_bf16 v[190:193], v[142:145], v[186:189], v[190:193]
    s_waitcnt lgkmcnt(0)
    v_cvt_pk_bf16_f32 v174, v174, v175
    v_mul_f32 v176, v166, v176
    v_mfma_f32_16x16x32_bf16 v[154:157], v[102:105], v[238:241], v[154:157]
    ds_read_b128 v[186:189], v0 offset:20480
    v_mul_f32 v177, v166, v177
    v_mfma_f32_16x16x32_bf16 v[154:157], v[106:109], v[118:121], v[154:157]
    ds_read_b128 v[194:197], v1 offset:20480
    v_cvt_pk_bf16_f32 v175, v176, v177
    v_mfma_f32_16x16x32_bf16 v[154:157], v[110:113], v[122:125], v[154:157]
    ds_read_b128 v[122:125], v0 offset:20608
    v_mul_f32 v170, v166, v170
    v_mfma_f32_16x16x32_bf16 v[118:121], v[146:149], v[28:31], 0
    ds_read_b128 v[202:205], v1 offset:20608
    v_mul_f32 v171, v166, v171
    v_mfma_f32_16x16x32_bf16 v[118:121], v[150:153], v[28:31], v[118:121]
    ds_read_b128 v[230:233], v0 offset:20736
    v_cvt_pk_bf16_f32 v176, v170, v171
    v_mfma_f32_16x16x32_bf16 v[234:237], v[146:149], v[134:137], 0
    ds_read_b128 v[238:241], v1 offset:20736
    v_fmac_f32 v255, v154, v154
    v_mfma_f32_16x16x32_bf16 v[234:237], v[150:153], v[162:165], v[234:237]
    v_fmac_f32 v255, v155, v155
    v_fmac_f32 v255, v156, v156
    v_mfma_f32_16x16x32_bf16 v[134:137], v[146:149], v[138:141], 0
    v_fmac_f32 v255, v157, v157
    v_cvt_pk_bf16_f32 v255, v255, v255
    v_mfma_f32_16x16x32_bf16 v[134:137], v[150:153], v[210:213], v[134:137]
    s_waitcnt lgkmcnt(5)
    ds_write_b64 v4, v[254:255] offset:18432
    v_mfma_f32_16x16x32_bf16 v[138:141], v[146:149], v[142:145], 0
    s_waitcnt lgkmcnt(4)
    v_mul_f32 v172, v166, v172
    v_mul_f32 v173, v166, v173
    v_mfma_f32_16x16x32_bf16 v[138:141], v[150:153], v[218:221], v[138:141]
    s_waitcnt lgkmcnt(3)
    v_cvt_pk_bf16_f32 v177, v172, v173
    v_mul_f32 v190, v166, v190
    v_mfma_f32_16x16x32_bf16 v[142:145], a[72:75], v[186:189], 0
    s_waitcnt lgkmcnt(2)
    ds_write_b128 v3, v[174:177] offset:12288
    v_mfma_f32_16x16x32_bf16 v[142:145], a[76:79], v[194:197], v[142:145]
    s_waitcnt lgkmcnt(2)
    v_mul_f32 v191, v166, v191
    v_cvt_pk_bf16_f32 v120, v190, v191
    v_mfma_f32_16x16x32_bf16 v[142:145], a[80:83], v[122:125], v[142:145]
    v_mul_f32 v192, v166, v192
    v_mul_f32 v193, v166, v193
    v_mfma_f32_16x16x32_bf16 v[142:145], a[84:87], v[202:205], v[142:145]
    v_cvt_pk_bf16_f32 v121, v192, v193
    v_mul_f32 v215, v182, v215
    v_mfma_f32_16x16x32_bf16 v[142:145], a[88:91], v[230:233], v[142:145]
    ds_write_b64 v4, v[120:121] offset:16384
    v_mfma_f32_16x16x32_bf16 v[142:145], a[92:95], v[238:241], v[142:145]
    v_rcp_f32 v118, v118
    v_mfma_f32_16x16x32_bf16 v[150:153], a[96:99], v[186:189], 0
    v_max3_u32 v25, v25, v118, v119
    v_mul_f32 v234, v234, v118
    v_mfma_f32_16x16x32_bf16 v[150:153], a[100:103], v[194:197], v[150:153]
    v_mul_f32_dpp v234, v134, v118 quad_perm:[0,1,2,3] row_mask:0x2 bank_mask:0xf
    v_mul_f32_dpp v234, v138, v118 quad_perm:[0,1,2,3] row_mask:0x4 bank_mask:0xf
    v_mfma_f32_16x16x32_bf16 v[150:153], a[104:107], v[122:125], v[150:153]
    v_cvt_pk_bf16_f32 v234, v234, v234
    v_cvt_pk_bf16_f32 v118, v214, v215
    v_mfma_f32_16x16x32_bf16 v[150:153], a[108:111], v[202:205], v[150:153]
    ds_write_b16 v7, v234
    v_mfma_f32_16x16x32_bf16 v[150:153], a[112:115], v[230:233], v[150:153]
    v_mul_f32 v216, v182, v216
    v_mul_f32 v217, v182, v217
    v_mfma_f32_16x16x32_bf16 v[150:153], a[116:119], v[238:241], v[150:153]
    v_cvt_pk_bf16_f32 v119, v216, v217
    v_mul_f32 v222, v182, v222
    v_mfma_f32_16x16x32_bf16 v[134:137], a[120:123], v[186:189], 0
    v_mul_f32 v223, v182, v223
    v_cvt_pk_bf16_f32 v120, v222, v223
    v_mfma_f32_16x16x32_bf16 v[134:137], a[124:127], v[194:197], v[134:137]
    v_mul_f32 v224, v182, v224
    v_mul_f32 v225, v182, v225
    v_mfma_f32_16x16x32_bf16 v[134:137], a[128:131], v[122:125], v[134:137]
    v_cvt_pk_bf16_f32 v121, v224, v225
    v_mul_f32 v226, v182, v226
    v_mfma_f32_16x16x32_bf16 v[134:137], a[132:135], v[202:205], v[134:137]
    ds_write_b128 v3, v[118:121] offset:0
    v_mfma_f32_16x16x32_bf16 v[134:137], a[136:139], v[230:233], v[134:137]
    v_mul_f32 v227, v182, v227
    v_cvt_pk_bf16_f32 v254, v226, v227
    v_mfma_f32_16x16x32_bf16 v[134:137], a[140:143], v[238:241], v[134:137]
    v_mul_f32 v228, v182, v228
    v_mul_f32 v229, v182, v229
    v_mfma_f32_16x16x32_bf16 v[138:141], a[0:3], v[186:189], 0
    v_cvt_pk_bf16_f32 v255, v228, v229
    v_xor_b32 v3, 65536, v3
    v_mfma_f32_16x16x32_bf16 v[138:141], a[4:7], v[194:197], v[138:141]
    ds_write_b64 v4, v[254:255] offset:4096
    v_mfma_f32_16x16x32_bf16 v[138:141], a[8:11], v[122:125], v[138:141]
    v_xor_b32 v4, 65536, v4
    v_add_u32 v7, s76, v7
    v_mfma_f32_16x16x32_bf16 v[138:141], a[12:15], v[202:205], v[138:141]
    v_cvt_pk_f16_f32 v146, v142, v143
    v_pk_mul_f16 v143, v146, v146
    v_mfma_f32_16x16x32_bf16 v[138:141], a[16:19], v[230:233], v[138:141]
    v_cvt_pk_f16_f32 v147, v144, v145
    v_pk_fma_f16 v143, v147, v147, v143
    v_mfma_f32_16x16x32_bf16 v[138:141], a[20:23], v[238:241], v[138:141]
    v_cvt_pk_f16_f32 v148, v150, v151
    v_pk_fma_f16 v143, v148, v148, v143
    v_mfma_f32_16x16x32_bf16 v[166:169], a[24:27], v[186:189], 0
    v_cvt_pk_f16_f32 v149, v152, v153
    v_pk_fma_f16 v143, v149, v149, v143
    v_mfma_f32_16x16x32_bf16 v[166:169], a[28:31], v[194:197], v[166:169]
    v_cvt_pk_f16_f32 v120, v134, v135
    v_pk_fma_f16 v143, v120, v120, v143
    v_mfma_f32_16x16x32_bf16 v[166:169], a[32:35], v[122:125], v[166:169]
    s_waitcnt lgkmcnt(0)
    v_cvt_pk_f16_f32 v121, v136, v137
    v_pk_fma_f16 v143, v121, v121, v143
    v_mfma_f32_16x16x32_bf16 v[166:169], a[36:39], v[202:205], v[166:169]
    s_nop 0
    v_mfma_f32_16x16x32_bf16 v[166:169], a[40:43], v[230:233], v[166:169]
    s_barrier
    v_mfma_f32_16x16x32_bf16 v[166:169], a[44:47], v[238:241], v[166:169]
    s_nop 0
    v_mfma_f32_16x16x32_bf16 v[134:137], a[48:51], v[186:189], 0
    s_nop 0
    v_mfma_f32_16x16x32_bf16 v[134:137], a[52:55], v[194:197], v[134:137]
    s_cbranch_scc1 L_loop_fast1
    s_branch L_final_fast
.p2align 6
L_loop_fast2:
    v_mfma_f32_16x16x32_bf16 v[134:137], a[56:59], v[122:125], v[134:137]
    s_add_u32 s12, s40, s27
    ds_read_b128 v[190:193], v2 offset:18432
    v_cvt_pk_f16_f32 v150, v138, v139
    v_mfma_f32_16x16x32_bf16 v[134:137], a[60:63], v[202:205], v[134:137]
    s_addc_u32 s13, s41, 0
    ds_read_b128 v[210:213], v2 offset:19456
    v_pk_mul_f16 v142, v150, v150
    v_mfma_f32_16x16x32_bf16 v[134:137], a[64:67], v[230:233], v[134:137]
    s_sub_u32 s14, s36, s27
    ds_read_b128 v[174:177], v5 offset:32
    v_cvt_pk_f16_f32 v151, v140, v141
    v_mfma_f32_16x16x32_bf16 v[134:137], a[68:71], v[238:241], v[134:137]
    s_cmp_ge_u32 s18, 2
    ds_read2_b64 v[162:165], v5 offset0:6 offset1:9
    v_pk_fma_f16 v142, v151, v151, v142
    v_mfma_f32_16x16x32_bf16 v[138:141], v[186:189], a[144:147], 0
    s_cselect_b32 s14, s14, 0
    ds_read_b128 v[170:173], v5
    v_cvt_pk_f16_f32 v152, v166, v167
    v_mfma_f32_16x16x32_bf16 v[138:141], v[194:197], a[148:151], v[138:141]
    s_sub_u32 s82, s72, s71
    ds_read_b32 v254, v6 offset:192
    v_pk_fma_f16 v142, v152, v152, v142
    v_mfma_f32_16x16x32_bf16 v[138:141], v[122:125], a[152:155], v[138:141]
    s_mul_i32 s74, s82, 336
    v_cvt_pk_f16_f32 v153, v168, v169
    v_pk_fma_f16 v142, v153, v153, v142
    v_mfma_f32_16x16x32_bf16 v[138:141], v[202:205], a[156:159], v[138:141]
    s_mul_i32 s75, s82, 272
    v_cvt_pk_f16_f32 v118, v134, v135
    v_pk_fma_f16 v142, v118, v118, v142
    v_mfma_f32_16x16x32_bf16 v[138:141], v[230:233], a[160:163], v[138:141]
    s_waitcnt lgkmcnt(5)
    ds_read_b128 v[182:185], v0 offset:26624
    v_cvt_pk_f16_f32 v119, v136, v137
    v_mfma_f32_16x16x32_bf16 v[166:169], v[32:35], v[190:193], 0
    s_waitcnt lgkmcnt(5)
    v_pk_fma_f16 v142, v119, v119, v142
    v_add_u32 v5, s74, v5
    v_mfma_f32_16x16x32_bf16 v[166:169], v[32:35], v[210:213], v[166:169]
    s_waitcnt lgkmcnt(4)
    v_pk_mul_f16 v145, v146, v174
    v_pk_fma_f16 v145, v147, v175, v145
    v_mfma_f32_16x16x32_bf16 v[138:141], v[238:241], a[164:167], v[138:141]
    s_mul_i32 s76, s82, 16
    ds_read_b128 v[210:213], v1 offset:26624
    v_pk_fma_f16 v145, v148, v176, v145
    v_mfma_f32_16x16x32_bf16 v[214:217], v[186:189], a[168:171], 0
    s_waitcnt lgkmcnt(3)
    ds_read_b128 v[218:221], v0 offset:26752
    v_pk_fma_f16 v145, v149, v177, v145
    v_mfma_f32_16x16x32_bf16 v[214:217], v[194:197], a[172:175], v[214:217]
    s_waitcnt lgkmcnt(3)
    ds_read_b128 v[222:225], v1 offset:26752
    v_mov_b32_dpp v254, v23 quad_perm:[0,1,2,3] row_mask:0x7 bank_mask:0xf
    v_mfma_f32_16x16x32_bf16 v[214:217], v[122:125], a[176:179], v[214:217]
    s_add_u32 s34, s18, 2
    ds_read_b128 v[226:229], v0 offset:26880
    v_pk_fma_f16 v145, v120, v164, v145
    v_mfma_f32_16x16x32_bf16 v[214:217], v[202:205], a[180:183], v[214:217]
    s_add_u32 s8, s60, s23
    ds_read_b128 v[190:193], v1 offset:26880
    v_pk_fma_f16 v145, v121, v165, v145
    v_mfma_f32_16x16x32_bf16 v[214:217], v[230:233], a[184:187], v[214:217]
    s_waitcnt lgkmcnt(5)
    v_pk_mul_f16 v144, v150, v170
    v_pk_fma_f16 v144, v151, v171, v144
    v_mfma_f32_16x16x32_bf16 v[214:217], v[238:241], a[188:191], v[214:217]
    s_addc_u32 s9, s61, 0
    v_pk_fma_f16 v144, v152, v172, v144
    v_pk_fma_f16 v144, v153, v173, v144
    v_mfma_f32_16x16x32_bf16 v[246:249], v[186:189], a[192:195], 0
    s_sub_u32 s10, s36, s23
    v_pk_fma_f16 v144, v118, v162, v144
    v_pk_fma_f16 v144, v119, v163, v144
    v_mfma_f32_16x16x32_bf16 v[246:249], v[194:197], a[196:199], v[246:249]
    s_cmp_le_u32 s34, s45
    v_cvt_pk_bf16_f32 v134, v138, v139
    v_cvt_pk_bf16_f32 v135, v140, v141
    v_mfma_f32_16x16x32_f16 v[234:237], v[40:43], v[142:145], 0
    s_cselect_b32 s10, s10, 0
    v_cvt_pk_bf16_f32 v138, v214, v215
    v_cvt_pk_bf16_f32 v139, v216, v217
    v_mfma_f32_16x16x32_bf16 v[246:249], v[122:125], a[200:203], v[246:249]
    s_add_u32 m0, s28, 0
    v_mul_f32 v136, 0x3baaaaab, v166
    v_mul_f32 v255, 0x3baaaaab, v167
    v_mfma_f32_16x16x32_bf16 v[246:249], v[202:205], a[204:207], v[246:249]
    s_mov_b32 s27, s26
    v_rsq_f32 v234, v234
    v_mfma_f32_16x16x32_bf16 v[246:249], v[230:233], a[208:211], v[246:249]
    s_mov_b32 s26, s25
    v_rsq_f32 v235, v235
    v_mfma_f32_16x16x32_bf16 v[246:249], v[238:241], a[212:215], v[246:249]
    s_mov_b32 s25, s24
    v_mul_f32 v140, s31, v234
    v_cvt_pk_f16_f32 v141, v140, v235
    v_mfma_f32_16x16x32_bf16 v[122:125], a[72:75], v[182:185], 0
    s_waitcnt lgkmcnt(0)
    v_fma_f32 v236, v236, v140, v22
    v_fmac_f32_dpp v254, v237, v235 quad_perm:[0,1,2,3] row_mask:0x1 bank_mask:0xf
    v_mfma_f32_16x16x32_bf16 v[122:125], a[76:79], v[210:213], v[122:125]
    s_mov_b32 s24, s23
    v_cvt_pk_bf16_f32 v142, v246, v247
    v_cvt_pk_bf16_f32 v143, v248, v249
    v_mfma_f32_16x16x32_bf16 v[122:125], a[80:83], v[218:221], v[122:125]
    s_mov_b32 s71, s72
    v_pk_mul_f16 v146, v146, v141 op_sel:[0,1] op_sel_hi:[1,1]
    v_pk_mul_f16 v147, v147, v141 op_sel:[0,1] op_sel_hi:[1,1]
    v_mfma_f32_16x16x32_bf16 v[122:125], a[84:87], v[222:225], v[122:125]
    s_mov_b32 s72, s73
    v_pk_mul_f16 v148, v148, v141 op_sel:[0,1] op_sel_hi:[1,1]
    v_pk_mul_f16 v149, v149, v141 op_sel:[0,1] op_sel_hi:[1,1]
    v_mfma_f32_16x16x32_bf16 v[122:125], a[88:91], v[226:229], v[122:125]
    v_pk_mul_f16 v120, v120, v141 op_sel:[0,1] op_sel_hi:[1,1]
    v_pk_mul_f16 v121, v121, v141 op_sel:[0,1] op_sel_hi:[1,1]
    v_mfma_f32_16x16x32_bf16 v[122:125], a[92:95], v[190:193], v[122:125]
    v_pk_mul_f16 v150, v150, v141 op_sel:[0,0] op_sel_hi:[1,0]
    v_pk_mul_f16 v151, v151, v141 op_sel:[0,0] op_sel_hi:[1,0]
    v_mfma_f32_16x16x32_bf16 v[186:189], a[96:99], v[182:185], 0
    v_pk_mul_f16 v152, v152, v141 op_sel:[0,0] op_sel_hi:[1,0]
    v_pk_mul_f16 v153, v153, v141 op_sel:[0,0] op_sel_hi:[1,0]
    v_mfma_f32_16x16x32_bf16 v[186:189], a[100:103], v[210:213], v[186:189]
    v_pk_mul_f16 v118, v118, v141 op_sel:[0,0] op_sel_hi:[1,0]
    v_pk_mul_f16 v119, v119, v141 op_sel:[0,0] op_sel_hi:[1,0]
    v_mfma_f32_16x16x32_bf16 v[186:189], a[104:107], v[218:221], v[186:189]
    v_max3_u32 v44, v44, v234, v235
    v_mul_f32 v144, 0x3baaaaab, v168
    v_mfma_f32_16x16x32_bf16 v[186:189], a[108:111], v[222:225], v[186:189]
    v_rsq_f32 v136, v136
    v_mfma_f32_16x16x32_bf16 v[186:189], a[112:115], v[226:229], v[186:189]
    v_rsq_f32 v255, v255
    v_mfma_f32_16x16x32_bf16 v[186:189], a[116:119], v[190:193], v[186:189]
    v_rsq_f32 v144, v144
    v_mfma_f32_16x16x32_bf16 v[194:197], a[120:123], v[182:185], 0
    v_mul_f32 v178, v136, v178
    v_mul_f32 v179, v136, v179
    v_mfma_f32_16x16x32_bf16 v[194:197], a[124:127], v[210:213], v[194:197]
    v_cvt_pk_bf16_f32 v166, v178, v179
    v_mul_f32 v180, v136, v180
    v_mfma_f32_16x16x32_bf16 v[194:197], a[128:131], v[218:221], v[194:197]
    v_mul_f32 v181, v136, v181
    v_cvt_pk_bf16_f32 v167, v180, v181
    v_mfma_f32_16x16x32_bf16 v[194:197], a[132:135], v[222:225], v[194:197]
    v_mul_f32 v198, v136, v198
    v_mul_f32 v199, v136, v199
    v_mfma_f32_16x16x32_bf16 v[194:197], a[136:139], v[226:229], v[194:197]
    v_cvt_pk_bf16_f32 v168, v198, v199
    v_mul_f32 v200, v136, v200
    v_mfma_f32_16x16x32_bf16 v[194:197], a[140:143], v[190:193], v[194:197]
    v_mul_f32 v201, v136, v201
    v_cvt_pk_bf16_f32 v169, v200, v201
    v_mfma_f32_16x16x32_bf16 v[178:181], a[0:3], v[182:185], 0
    buffer_store_dwordx4 v[166:169], v15, s[12:15], 0 offen nt
    v_mul_f32 v206, v136, v206
    v_mul_f32 v207, v136, v207
    v_cvt_pk_bf16_f32 v140, v206, v207
    v_mul_f32 v208, v136, v208
    v_mfma_f32_16x16x32_bf16 v[178:181], a[4:7], v[210:213], v[178:181]
    v_mul_f32 v209, v136, v209
    v_cvt_pk_bf16_f32 v141, v208, v209
    v_mfma_f32_16x16x32_bf16 v[178:181], a[8:11], v[218:221], v[178:181]
    v_cvt_pk_f16_f32 v166, v122, v123
    v_pk_mul_f16 v199, v166, v166
    v_mfma_f32_16x16x32_bf16 v[178:181], a[12:15], v[222:225], v[178:181]
    v_cvt_pk_f16_f32 v167, v124, v125
    v_pk_fma_f16 v199, v167, v167, v199
    v_mfma_f32_16x16x32_bf16 v[178:181], a[16:19], v[226:229], v[178:181]
    v_cvt_pk_f16_f32 v168, v186, v187
    v_pk_fma_f16 v199, v168, v168, v199
    v_mfma_f32_16x16x32_bf16 v[178:181], a[20:23], v[190:193], v[178:181]
    v_cvt_pk_f16_f32 v169, v188, v189
    v_pk_fma_f16 v199, v169, v169, v199
    v_mfma_f32_16x16x32_bf16 v[186:189], a[24:27], v[182:185], 0
    v_cvt_pk_f16_f32 v124, v194, v195
    v_pk_fma_f16 v199, v124, v124, v199
    v_mfma_f32_16x16x32_bf16 v[186:189], a[28:31], v[210:213], v[186:189]
    v_cvt_pk_f16_f32 v125, v196, v197
    v_pk_fma_f16 v199, v125, v125, v199
    v_mfma_f32_16x16x32_bf16 v[186:189], a[32:35], v[218:221], v[186:189]
    v_cvt_pk_f16_f32 v178, v178, v179
    v_pk_mul_f16 v198, v178, v178
    v_mfma_f32_16x16x32_bf16 v[186:189], a[36:39], v[222:225], v[186:189]
    v_cvt_pk_f16_f32 v179, v180, v181
    v_pk_fma_f16 v198, v179, v179, v198
    v_mfma_f32_16x16x32_bf16 v[186:189], a[40:43], v[226:229], v[186:189]
    v_pk_mul_f16 v200, v178, v170
    v_pk_fma_f16 v200, v179, v171, v200
    v_mfma_f32_16x16x32_bf16 v[186:189], a[44:47], v[190:193], v[186:189]
    v_pk_mul_f16 v201, v166, v174
    v_pk_fma_f16 v201, v167, v175, v201
    v_mfma_f32_16x16x32_bf16 v[194:197], a[48:51], v[182:185], 0
    v_pk_fma_f16 v201, v168, v176, v201
    v_pk_fma_f16 v201, v169, v177, v201
    v_mfma_f32_16x16x32_bf16 v[194:197], a[52:55], v[210:213], v[194:197]
    v_pk_fma_f16 v201, v124, v164, v201
    v_pk_fma_f16 v201, v125, v165, v201
    v_mfma_f32_16x16x32_bf16 v[194:197], a[56:59], v[218:221], v[194:197]
    v_cvt_pk_f16_f32 v180, v186, v187
    v_pk_fma_f16 v198, v180, v180, v198
    v_mfma_f32_16x16x32_bf16 v[194:197], a[60:63], v[222:225], v[194:197]
    v_cvt_pk_f16_f32 v181, v188, v189
    v_pk_fma_f16 v198, v181, v181, v198
    v_mfma_f32_16x16x32_bf16 v[194:197], a[64:67], v[226:229], v[194:197]
    v_pk_fma_f16 v200, v180, v172, v200
    v_pk_fma_f16 v200, v181, v173, v200
    v_mfma_f32_16x16x32_bf16 v[194:197], a[68:71], v[190:193], v[194:197]
    buffer_store_dwordx2 v[140:141], v18, s[12:15], 0 offen nt
    v_mul_f32 v242, v144, v242
    v_mul_f32 v243, v144, v243
    v_mfma_f32_16x16x32_bf16 v[186:189], v[182:185], a[144:147], 0
    v_cvt_pk_bf16_f32 v238, v242, v243
    v_mul_f32 v244, v144, v244
    v_mfma_f32_16x16x32_bf16 v[186:189], v[210:213], a[148:151], v[186:189]
    v_mul_f32 v245, v144, v245
    v_cvt_pk_f16_f32 v122, v194, v195
    v_mfma_f32_16x16x32_bf16 v[186:189], v[218:221], a[152:155], v[186:189]
    v_pk_fma_f16 v198, v122, v122, v198
    v_cvt_pk_f16_f32 v123, v196, v197
    v_mfma_f32_16x16x32_bf16 v[186:189], v[222:225], a[156:159], v[186:189]
    v_pk_fma_f16 v198, v123, v123, v198
    v_pk_fma_f16 v200, v122, v162, v200
    v_mfma_f32_16x16x32_bf16 v[186:189], v[226:229], a[160:163], v[186:189]
    ds_read_b128 v[202:205], v0 offset:32768
    v_pk_fma_f16 v200, v123, v163, v200
    v_mfma_f32_16x16x32_bf16 v[186:189], v[190:193], a[164:167], v[186:189]
    ds_read_b128 v[194:197], v1 offset:32768
    v_cvt_pk_bf16_f32 v239, v244, v245
    v_mfma_f32_16x16x32_f16 v[230:233], v[40:43], v[198:201], 0
    v_mul_f32 v158, v144, v158
    v_mul_f32 v159, v144, v159
    v_mfma_f32_16x16x32_bf16 v[246:249], v[182:185], a[168:171], 0
    ds_read_b128 v[214:217], v0 offset:32896
    v_cvt_pk_bf16_f32 v240, v158, v159
    v_mfma_f32_16x16x32_bf16 v[246:249], v[210:213], a[172:175], v[246:249]
    ds_read_b128 v[206:209], v1 offset:32896
    v_cvt_pk_bf16_f32 v136, v186, v187
    v_mfma_f32_16x16x32_bf16 v[246:249], v[218:221], a[176:179], v[246:249]
    ds_read_b128 v[198:201], v0 offset:33024
    v_cvt_pk_bf16_f32 v137, v188, v189
    v_mfma_f32_16x16x32_bf16 v[246:249], v[222:225], a[180:183], v[246:249]
    ds_read_b128 v[186:189], v1 offset:33024
    v_mul_f32 v160, v144, v160
    v_mfma_f32_16x16x32_bf16 v[246:249], v[226:229], a[184:187], v[246:249]
    v_rsq_f32 v230, v230
    v_mfma_f32_16x16x32_bf16 v[246:249], v[190:193], a[188:191], v[246:249]
    s_waitcnt lgkmcnt(5)
    v_rsq_f32 v231, v231
    v_mfma_f32_16x16x32_bf16 v[242:245], v[182:185], a[192:195], 0
    s_waitcnt lgkmcnt(4)
    v_mul_f32 v234, s31, v230
    v_cvt_pk_f16_f32 v235, v234, v231
    v_mfma_f32_16x16x32_bf16 v[242:245], v[210:213], a[196:199], v[242:245]
    v_fma_f32 v232, v232, v234, v24
    v_fmac_f32_dpp v254, v233, v231 quad_perm:[0,1,2,3] row_mask:0x2 bank_mask:0xf
    v_mfma_f32_16x16x32_bf16 v[242:245], v[218:221], a[200:203], v[242:245]
    s_waitcnt lgkmcnt(3)
    v_cvt_pk_bf16_f32 v140, v246, v247
    v_cvt_pk_bf16_f32 v141, v248, v249
    v_mfma_f32_16x16x32_bf16 v[242:245], v[222:225], a[204:207], v[242:245]
    s_waitcnt lgkmcnt(2)
    v_mul_f32 v161, v144, v161
    v_cvt_pk_bf16_f32 v241, v160, v161
    v_mfma_f32_16x16x32_bf16 v[242:245], v[226:229], a[208:211], v[242:245]
    s_waitcnt lgkmcnt(1)
    buffer_store_dwordx4 v[238:241], v17, s[12:15], 0 offen nt
    v_mul_f32 v154, v144, v154
    v_mul_f32 v155, v144, v155
    v_cvt_pk_bf16_f32 v154, v154, v155
    v_mul_f32 v156, v144, v156
    v_mfma_f32_16x16x32_bf16 v[242:245], v[190:193], a[212:215], v[242:245]
    s_waitcnt lgkmcnt(0)
    v_mul_f32 v157, v144, v157
    v_cvt_pk_bf16_f32 v155, v156, v157
    v_mfma_f32_16x16x32_bf16 v[158:161], a[72:75], v[202:205], 0
    v_pk_mul_f16 v166, v166, v235 op_sel:[0,1] op_sel_hi:[1,1]
    v_pk_mul_f16 v167, v167, v235 op_sel:[0,1] op_sel_hi:[1,1]
    v_mfma_f32_16x16x32_bf16 v[158:161], a[76:79], v[194:197], v[158:161]
    v_pk_mul_f16 v168, v168, v235 op_sel:[0,1] op_sel_hi:[1,1]
    v_cvt_pk_bf16_f32 v144, v242, v243
    v_mfma_f32_16x16x32_bf16 v[158:161], a[80:83], v[214:217], v[158:161]
    v_cvt_pk_bf16_f32 v145, v244, v245
    v_pk_mul_f16 v169, v169, v235 op_sel:[0,1] op_sel_hi:[1,1]
    v_mfma_f32_16x16x32_bf16 v[158:161], a[84:87], v[206:209], v[158:161]
    v_pk_mul_f16 v124, v124, v235 op_sel:[0,1] op_sel_hi:[1,1]
    v_pk_mul_f16 v125, v125, v235 op_sel:[0,1] op_sel_hi:[1,1]
    v_mfma_f32_16x16x32_bf16 v[158:161], a[88:91], v[198:201], v[158:161]
    v_pk_mul_f16 v178, v178, v235 op_sel:[0,0] op_sel_hi:[1,0]
    v_pk_mul_f16 v179, v179, v235 op_sel:[0,0] op_sel_hi:[1,0]
    v_mfma_f32_16x16x32_bf16 v[158:161], a[92:95], v[186:189], v[158:161]
    v_pk_mul_f16 v180, v180, v235 op_sel:[0,0] op_sel_hi:[1,0]
    v_pk_mul_f16 v181, v181, v235 op_sel:[0,0] op_sel_hi:[1,0]
    v_mfma_f32_16x16x32_bf16 v[182:185], a[96:99], v[202:205], 0
    v_pk_mul_f16 v122, v122, v235 op_sel:[0,0] op_sel_hi:[1,0]
    v_pk_mul_f16 v123, v123, v235 op_sel:[0,0] op_sel_hi:[1,0]
    v_mfma_f32_16x16x32_bf16 v[182:185], a[100:103], v[194:197], v[182:185]
    v_max3_u32 v44, v44, v230, v231
    v_mul_f32 v130, v255, v130
    v_mfma_f32_16x16x32_bf16 v[182:185], a[104:107], v[214:217], v[182:185]
    v_cvt_pk_f16_f32 v158, v158, v159
    v_pk_mul_f16 v191, v158, v158
    v_mfma_f32_16x16x32_bf16 v[182:185], a[108:111], v[206:209], v[182:185]
    v_cvt_pk_f16_f32 v159, v160, v161
    v_pk_fma_f16 v191, v159, v159, v191
    v_mfma_f32_16x16x32_bf16 v[182:185], a[112:115], v[198:201], v[182:185]
    v_pk_mul_f16 v193, v158, v174
    v_pk_fma_f16 v193, v159, v175, v193
    v_mfma_f32_16x16x32_bf16 v[182:185], a[116:119], v[186:189], v[182:185]
    v_exp_f32 v232, v232
    v_mfma_f32_16x16x32_bf16 v[210:213], a[120:123], v[202:205], 0
    v_exp_f32 v236, v236
    v_mfma_f32_16x16x32_bf16 v[210:213], a[124:127], v[194:197], v[210:213]
    v_cvt_pk_bf16_f32 v39, v236, 0
    v_mul_f32 v131, v255, v131
    v_mfma_f32_16x16x32_bf16 v[210:213], a[128:131], v[214:217], v[210:213]
    s_waitcnt vmcnt(3)
    ds_write_b16 v8, v45 offset:512
    v_mfma_f32_16x16x32_bf16 v[210:213], a[132:135], v[206:209], v[210:213]
    buffer_store_dwordx2 v[154:155], v20, s[12:15], 0 offen nt
    v_cvt_pk_f16_f32 v160, v182, v183
    v_mfma_f32_16x16x32_bf16 v[210:213], a[136:139], v[198:201], v[210:213]
    v_pk_fma_f16 v191, v160, v160, v191
    v_cvt_pk_f16_f32 v161, v184, v185
    v_mfma_f32_16x16x32_bf16 v[210:213], a[140:143], v[186:189], v[210:213]
    v_pk_fma_f16 v191, v161, v161, v191
    v_pk_fma_f16 v193, v160, v176, v193
    v_mfma_f32_16x16x32_bf16 v[154:157], a[0:3], v[202:205], 0
    v_pk_fma_f16 v193, v161, v177, v193
    v_cvt_pk_bf16_f32 v130, v130, v131
    v_mfma_f32_16x16x32_bf16 v[154:157], a[4:7], v[194:197], v[154:157]
    v_mul_f32 v132, v255, v132
    v_mul_f32 v133, v255, v133
    v_mfma_f32_16x16x32_bf16 v[154:157], a[8:11], v[214:217], v[154:157]
    v_cvt_pk_f16_f32 v176, v210, v211
    v_pk_fma_f16 v191, v176, v176, v191
    v_mfma_f32_16x16x32_bf16 v[154:157], a[12:15], v[206:209], v[154:157]
    s_waitcnt lgkmcnt(0)
    v_cvt_pk_f16_f32 v177, v212, v213
    v_pk_fma_f16 v191, v177, v177, v191
    v_mfma_f32_16x16x32_bf16 v[154:157], a[16:19], v[198:201], v[154:157]
    v_pk_fma_f16 v193, v176, v164, v193
    v_mfma_f32_16x16x32_bf16 v[154:157], a[20:23], v[186:189], v[154:157]
    v_pk_fma_f16 v193, v177, v165, v193
    v_mfma_f32_16x16x32_bf16 v[182:185], a[24:27], v[202:205], 0
    s_barrier
    v_cvt_pk_bf16_f32 v131, v132, v133
    v_mfma_f32_16x16x32_bf16 v[182:185], a[28:31], v[194:197], v[182:185]
    ds_read2_b32 v[164:165], v6 offset0:0 offset1:0
    v_mfma_f32_16x16x32_bf16 v[182:185], a[32:35], v[214:217], v[182:185]
    ds_read2_b32 v[212:213], v6 offset0:16 offset1:16
    v_cvt_pk_f16_f32 v154, v154, v155
    v_mfma_f32_16x16x32_bf16 v[182:185], a[36:39], v[206:209], v[182:185]
    ds_read2_b32 v[220:221], v6 offset0:32 offset1:32
    v_pk_mul_f16 v190, v154, v154
    v_mfma_f32_16x16x32_bf16 v[182:185], a[40:43], v[198:201], v[182:185]
    ds_read_u16 v133, v9 offset:256
    v_cvt_pk_f16_f32 v155, v156, v157
    v_mfma_f32_16x16x32_bf16 v[182:185], a[44:47], v[186:189], v[182:185]
    v_pk_fma_f16 v190, v155, v155, v190
    v_pk_mul_f16 v192, v154, v170
    v_mfma_f32_16x16x32_bf16 v[222:225], a[48:51], v[202:205], 0
    v_pk_fma_f16 v192, v155, v171, v192
    v_mul_f32 v126, v255, v126
    v_mfma_f32_16x16x32_bf16 v[222:225], a[52:55], v[194:197], v[222:225]
    v_mul_f32 v127, v255, v127
    v_cvt_pk_bf16_f32 v132, v126, v127
    v_mfma_f32_16x16x32_bf16 v[222:225], a[56:59], v[214:217], v[222:225]
    buffer_load_dwordx4 v10, s[8:11], 0 offen nt lds
    v_cvt_pk_f16_f32 v156, v182, v183
    v_mfma_f32_16x16x32_bf16 v[222:225], a[60:63], v[206:209], v[222:225]
    s_add_u32 m0, s28, 4096
    v_pk_fma_f16 v190, v156, v156, v190
    v_cvt_pk_f16_f32 v157, v184, v185
    v_mfma_f32_16x16x32_bf16 v[222:225], a[64:67], v[198:201], v[222:225]
    s_waitcnt lgkmcnt(2)
    v_pk_fma_f16 v190, v157, v157, v190
    v_pk_fma_f16 v192, v156, v172, v192
    v_mfma_f32_16x16x32_bf16 v[222:225], a[68:71], v[186:189], v[222:225]
    s_waitcnt lgkmcnt(1)
    ds_read_b128 v[182:185], v2 offset:0
    v_pk_fma_f16 v192, v157, v173, v192
    v_mfma_f32_16x16x32_bf16 v[170:173], v[202:205], a[144:147], 0
    s_waitcnt lgkmcnt(1)
    ds_read_b128 v[226:229], v2 offset:1024
    v_readfirstlane_b32 s77, v133
    v_mfma_f32_16x16x32_bf16 v[170:173], v[194:197], a[148:151], v[170:173]
    ds_read_b128 v[234:237], v2 offset:2048
    buffer_load_dwordx4 v11, s[8:11], 0 offen nt lds
    v_mfma_f32_16x16x32_bf16 v[170:173], v[214:217], a[152:155], v[170:173]
    s_add_u32 m0, s28, 8192
    ds_read_b128 v[238:241], v2 offset:3072
    v_cvt_pk_f16_f32 v174, v222, v223
    v_mfma_f32_16x16x32_bf16 v[170:173], v[206:209], a[156:159], v[170:173]
    s_mul_i32 s78, s77, 2688
    ds_read_b128 v[242:245], v2 offset:4096
    v_pk_fma_f16 v190, v174, v174, v190
    v_mfma_f32_16x16x32_bf16 v[170:173], v[198:201], a[160:163], v[170:173]
    ds_read_b128 v[246:249], v2 offset:5120
    v_cvt_pk_f16_f32 v175, v224, v225
    v_mfma_f32_16x16x32_bf16 v[170:173], v[186:189], a[164:167], v[170:173]
    v_pk_fma_f16 v190, v175, v175, v190
    v_pk_fma_f16 v192, v174, v162, v192
    v_mfma_f32_16x16x32_bf16 v[222:225], v[202:205], a[168:171], 0
    buffer_load_dwordx4 v12, s[8:11], 0 offen nt lds
    v_pk_fma_f16 v192, v175, v163, v192
    v_mfma_f32_16x16x32_bf16 v[222:225], v[194:197], a[172:175], v[222:225]
    s_waitcnt lgkmcnt(5)
    v_mul_f32 v128, v255, v128
    v_cvt_pk_bf16_f32 v162, v170, v171
    v_mfma_f32_16x16x32_f16 v[250:253], v[40:43], v[190:193], 0
    s_add_u32 m0, s28, 12288
    v_cvt_pk_bf16_f32 v163, v172, v173
    v_mul_f32 v129, v255, v129
    v_mfma_f32_16x16x32_bf16 v[222:225], v[214:217], a[176:179], v[222:225]
    s_xor_b32 s28, s28, 65536
    v_cvt_pk_bf16_f32 v133, v128, v129
    v_mul_f32 v114, v255, v114
    v_mfma_f32_16x16x32_bf16 v[222:225], v[206:209], a[180:183], v[222:225]
    s_waitcnt lgkmcnt(2)
    v_rsq_f32 v250, v250
    v_mfma_f32_16x16x32_bf16 v[222:225], v[198:201], a[184:187], v[222:225]
    s_waitcnt lgkmcnt(1)
    buffer_load_dwordx4 v13, s[8:11], 0 offen nt lds
    v_mul_f32 v230, s31, v250
    v_mfma_f32_16x16x32_bf16 v[222:225], v[186:189], a[188:191], v[222:225]
    s_mov_b32 m0, s29
    v_rsq_f32 v251, v251
    v_mfma_f32_16x16x32_bf16 v[126:129], v[202:205], a[192:195], 0
    s_xor_b32 s29, s29, s30
    v_cvt_pk_f16_f32 v231, v230, v251
    v_fma_f32 v252, v252, v230, v26
    v_mfma_f32_16x16x32_bf16 v[126:129], v[194:197], a[196:199], v[126:129]
    s_add_u32 s19, s19, s20
    v_fmac_f32_dpp v254, v253, v251 quad_perm:[0,1,2,3] row_mask:0x4 bank_mask:0xf
    v_cvt_pk_bf16_f32 v210, v222, v223
    v_mfma_f32_16x16x32_bf16 v[126:129], v[214:217], a[200:203], v[126:129]
    s_add_u32 s23, s23, s21
    v_cvt_pk_bf16_f32 v211, v224, v225
    v_pk_mul_f16 v158, v158, v231 op_sel:[0,1] op_sel_hi:[1,1]
    v_mfma_f32_16x16x32_bf16 v[126:129], v[206:209], a[204:207], v[126:129]
    s_waitcnt lgkmcnt(0)
    v_pk_mul_f16 v159, v159, v231 op_sel:[0,1] op_sel_hi:[1,1]
    v_mfma_f32_16x16x32_bf16 v[126:129], v[198:201], a[208:211], v[126:129]
    s_cmp_ge_u32 s19, 72
    v_pk_mul_f16 v160, v160, v231 op_sel:[0,1] op_sel_hi:[1,1]
    v_pk_mul_f16 v161, v161, v231 op_sel:[0,1] op_sel_hi:[1,1]
    v_mfma_f32_16x16x32_bf16 v[126:129], v[186:189], a[212:215], v[126:129]
    s_cselect_b32 s34, 72, 0
    v_pk_mul_f16 v176, v176, v231 op_sel:[0,1] op_sel_hi:[1,1]
    v_pk_mul_f16 v177, v177, v231 op_sel:[0,1] op_sel_hi:[1,1]
    v_mfma_f32_16x16x32_f16 v[170:173], v[146:149], v[150:153], v[46:49]
    s_cselect_b32 s35, s22, 0
    v_pk_mul_f16 v154, v154, v231 op_sel:[0,0] op_sel_hi:[1,0]
    v_pk_mul_f16 v155, v155, v231 op_sel:[0,0] op_sel_hi:[1,0]
    v_mfma_f32_16x16x32_f16 v[186:189], v[166:169], v[150:153], v[50:53]
    s_sub_u32 s19, s19, s34
    v_cvt_pk_bf16_f32 v218, v126, v127
    v_cvt_pk_bf16_f32 v219, v128, v129
    v_mfma_f32_16x16x32_f16 v[126:129], v[158:161], v[150:153], v[54:57]
    buffer_store_dwordx4 v[130:133], v16, s[12:15], 0 offen nt
    v_pk_mul_f16 v156, v156, v231 op_sel:[0,0] op_sel_hi:[1,0]
    v_pk_mul_f16 v157, v157, v231 op_sel:[0,0] op_sel_hi:[1,0]
    v_pk_mul_f16 v174, v174, v231 op_sel:[0,0] op_sel_hi:[1,0]
    v_pk_mul_f16 v175, v175, v231 op_sel:[0,0] op_sel_hi:[1,0]
    v_mfma_f32_16x16x16_f16 v[170:173], v[120:121], v[118:119], v[170:173]
    v_max3_u32 v44, v44, v250, v251
    v_exp_f32 v254, v254
    v_mfma_f32_16x16x16_f16 v[186:189], v[124:125], v[118:119], v[186:189]
    v_cvt_pk_bf16_f32 v254, v254, v254
    v_exp_f32 v252, v252
    v_mfma_f32_16x16x16_f16 v[126:129], v[176:177], v[118:119], v[126:129]
    v_mul_f32 v115, v255, v115
    v_cvt_pk_bf16_f32 v118, v114, v115
    v_exp_f32 v170, v170
    v_mfma_f32_16x16x32_f16 v[130:133], v[146:149], v[178:181], v[58:61]
    s_add_u32 s23, s23, s35
    ds_write_b16 v8, v254
    v_mfma_f32_16x16x32_f16 v[150:153], v[166:169], v[178:181], v[62:65]
    s_add_u32 s78, s78, s69
    v_exp_f32 v171, v171
    v_mfma_f32_16x16x32_f16 v[190:193], v[158:161], v[178:181], v[66:69]
    s_add_u32 s80, s77, s68
    v_cvt_pk_bf16_f32 v170, v170, v171
    v_exp_f32 v172, v172
    v_mfma_f32_16x16x16_f16 v[130:133], v[120:121], v[122:123], v[130:133]
    v_exp_f32 v173, v173
    v_mul_f32 v116, v255, v116
    v_mfma_f32_16x16x16_f16 v[150:153], v[124:125], v[122:123], v[150:153]
    v_cvt_pk_bf16_f32 v171, v172, v173
    v_exp_f32 v186, v186
    v_mfma_f32_16x16x16_f16 v[190:193], v[176:177], v[122:123], v[190:193]
    v_exp_f32 v187, v187
    v_exp_f32 v188, v188
    v_mfma_f32_16x16x32_bf16 v[178:181], a[216:219], v[182:185], 0
    s_cmp_ge_u32 s80, 72
    v_exp_f32 v130, v130
    v_mfma_f32_16x16x32_bf16 v[178:181], a[220:223], v[226:229], v[178:181]
    s_cselect_b32 s80, s22, 0
    v_exp_f32 v131, v131
    v_mfma_f32_16x16x32_bf16 v[178:181], a[224:227], v[234:237], v[178:181]
    s_add_u32 s78, s78, s80
    v_cvt_pk_bf16_f32 v194, v130, v131
    v_cvt_pk_bf16_f32 v172, v186, v187
    v_mfma_f32_16x16x32_bf16 v[178:181], a[228:231], v[238:241], v[178:181]
    s_add_u32 s80, s77, 20
    v_exp_f32 v132, v132
    v_mfma_f32_16x16x32_bf16 v[178:181], a[232:235], v[242:245], v[178:181]
    s_add_u32 s34, s18, 3
    v_exp_f32 v133, v133
    v_mfma_f32_16x16x32_bf16 v[178:181], a[236:239], v[246:249], v[178:181]
    s_cmp_lt_u32 s77, s62
    v_cvt_pk_bf16_f32 v195, v132, v133
    v_mul_f32 v117, v255, v117
    v_mfma_f32_16x16x32_bf16 v[198:201], a[240:243], v[182:185], 0
    s_cselect_b32 s79, 1, 0
    v_exp_f32 v150, v150
    v_mfma_f32_16x16x32_f16 v[202:205], v[146:149], v[154:157], v[70:73]
    s_cselect_b32 s78, s78, 0
    v_exp_f32 v151, v151
    v_mfma_f32_16x16x32_f16 v[146:149], v[166:169], v[154:157], v[74:77]
    s_cmp_lt_u32 s34, s17
    v_cvt_pk_bf16_f32 v196, v150, v151
    v_cvt_pk_bf16_f32 v119, v116, v117
    v_mfma_f32_16x16x32_f16 v[166:169], v[158:161], v[154:157], v[78:81]
    buffer_store_dwordx2 v[118:119], v19, s[12:15], 0 offen nt
    v_exp_f32 v152, v152
    v_mfma_f32_16x16x16_f16 v[202:205], v[120:121], v[174:175], v[202:205]
    v_exp_f32 v153, v153
    v_fma_f32 v254, v178, v178, s33
    v_mfma_f32_16x16x16_f16 v[146:149], v[124:125], v[174:175], v[146:149]
    v_cvt_pk_bf16_f32 v197, v152, v153
    v_exp_f32 v190, v190
    v_mfma_f32_16x16x16_f16 v[166:169], v[176:177], v[174:175], v[166:169]
    v_exp_f32 v191, v191
    v_exp_f32 v192, v192
    v_mfma_f32_16x16x32_bf16 v[198:201], a[244:247], v[226:229], v[198:201]
    s_cselect_b32 s23, s23, s78
    v_exp_f32 v193, v193
    v_mfma_f32_16x16x32_bf16 v[198:201], a[248:251], v[234:237], v[198:201]
    s_cselect_b32 s73, s34, s80
    ds_read_b128 v[118:121], v2 offset:6144
    v_fmac_f32 v254, v179, v179
    v_mfma_f32_16x16x32_bf16 v[198:201], a[252:255], v[238:241], v[198:201]
    s_cselect_b32 s79, 0, s79
    ds_read_b128 v[122:125], v2 offset:7168
    v_fmac_f32 v254, v180, v180
    v_mfma_f32_16x16x32_bf16 v[198:201], v[82:85], v[242:245], v[198:201]
    s_cselect_b32 s81, 0, 1
    ds_read_b128 v[150:153], v2 offset:8192
    v_fmac_f32 v254, v181, v181
    v_mfma_f32_16x16x32_bf16 v[198:201], v[86:89], v[246:249], v[198:201]
    s_add_u32 s80, s77, 1
    ds_read_b128 v[154:157], v2 offset:9216
    v_xor_b32 v0, 65536, v0
    v_mfma_f32_16x16x32_bf16 v[206:209], v[90:93], v[182:185], 0
    s_mul_i32 s80, s80, s81
    ds_read_b128 v[158:161], v2 offset:10240
    v_xor_b32 v1, 65536, v1
    v_mfma_f32_16x16x32_bf16 v[206:209], v[94:97], v[226:229], v[206:209]
    s_cmp_lt_u32 s80, s62
    ds_read_b128 v[174:177], v2 offset:11264
    v_fmac_f32 v254, v198, v198
    v_mfma_f32_16x16x32_bf16 v[206:209], v[98:101], v[234:237], v[206:209]
    s_cselect_b32 s62, s62, 0
    v_exp_f32 v189, v189
    v_mfma_f32_16x16x32_bf16 v[206:209], v[102:105], v[238:241], v[206:209]
    s_add_u32 s80, s18, 4
    v_cvt_pk_bf16_f32 v173, v188, v189
    v_fmac_f32 v254, v199, v199
    v_mfma_f32_16x16x32_bf16 v[206:209], v[106:109], v[242:245], v[206:209]
    s_waitcnt lgkmcnt(5)
    v_exp_f32 v126, v126
    v_mfma_f32_16x16x32_bf16 v[206:209], v[110:113], v[246:249], v[206:209]
    s_cmp_ge_u32 s80, s17
    v_exp_f32 v127, v127
    v_mfma_f32_16x16x32_bf16 v[130:133], a[216:219], v[118:121], 0
    s_waitcnt lgkmcnt(3)
    v_cvt_pk_bf16_f32 v36, v126, v127
    v_fmac_f32 v254, v200, v200
    v_mfma_f32_16x16x32_bf16 v[130:133], a[220:223], v[122:125], v[130:133]
    s_cselect_b32 s66, s62, 0
    v_exp_f32 v128, v128
    v_mfma_f32_16x16x32_bf16 v[130:133], a[224:227], v[150:153], v[130:133]
    s_waitcnt lgkmcnt(1)
    v_fmac_f32 v254, v201, v201
    v_mfma_f32_16x16x32_bf16 v[130:133], a[228:231], v[154:157], v[130:133]
    s_lshl_b32 s80, s79, s73
    v_exp_f32 v129, v129
    v_mfma_f32_16x16x32_bf16 v[130:133], a[232:235], v[158:161], v[130:133]
    s_waitcnt lgkmcnt(0)
    v_cvt_pk_bf16_f32 v37, v128, v129
    v_fmac_f32 v254, v206, v206
    v_mfma_f32_16x16x32_bf16 v[130:133], a[236:239], v[174:177], v[130:133]
    s_or_b32 s70, s70, s80
    v_exp_f32 v202, v202
    v_mfma_f32_16x16x32_bf16 v[182:185], v[28:31], v[36:39], 0
    s_add_u32 s45, s45, s79
    v_exp_f32 v203, v203
    v_mfma_f32_16x16x32_bf16 v[182:185], v[28:31], v[170:173], v[182:185]
    s_add_u32 s18, s18, 1
    v_cvt_pk_bf16_f32 v186, v202, v203
    v_fma_f32 v255, v130, v130, s33
    v_mfma_f32_16x16x32_bf16 v[214:217], v[162:165], v[36:39], 0
    s_cmp_lt_u32 s18, s45
    v_fmac_f32 v255, v131, v131
    v_fmac_f32 v255, v132, v132
    v_mfma_f32_16x16x32_bf16 v[214:217], v[134:137], v[170:173], v[214:217]
    v_fmac_f32 v255, v133, v133
    v_fmac_f32 v254, v207, v207
    v_mfma_f32_16x16x32_bf16 v[222:225], v[210:213], v[36:39], 0
    v_exp_f32 v204, v204
    v_mfma_f32_16x16x32_bf16 v[222:225], v[138:141], v[170:173], v[222:225]
    v_exp_f32 v205, v205
    v_mfma_f32_16x16x32_bf16 v[226:229], v[218:221], v[36:39], 0
    v_cvt_pk_bf16_f32 v36, v190, v191
    v_cvt_pk_bf16_f32 v37, v192, v193
    v_mfma_f32_16x16x32_bf16 v[226:229], v[142:145], v[170:173], v[226:229]
    v_cvt_pk_bf16_f32 v39, v232, 0
    v_cvt_pk_bf16_f32 v187, v204, v205
    v_mfma_f32_16x16x32_bf16 v[126:129], a[240:243], v[118:121], 0
    v_exp_f32 v146, v146
    v_mfma_f32_16x16x32_bf16 v[170:173], v[28:31], v[36:39], 0
    v_exp_f32 v147, v147
    v_mfma_f32_16x16x32_bf16 v[170:173], v[28:31], v[194:197], v[170:173]
    v_cvt_pk_bf16_f32 v188, v146, v147
    v_fmac_f32 v254, v208, v208
    v_mfma_f32_16x16x32_bf16 v[114:117], v[162:165], v[36:39], 0
    v_exp_f32 v148, v148
    v_mfma_f32_16x16x32_bf16 v[114:117], v[134:137], v[194:197], v[114:117]
    v_exp_f32 v149, v149
    v_mfma_f32_16x16x32_bf16 v[190:193], v[210:213], v[36:39], 0
    v_cvt_pk_bf16_f32 v189, v148, v149
    v_fmac_f32 v254, v209, v209
    v_mfma_f32_16x16x32_bf16 v[190:193], v[138:141], v[194:197], v[190:193]
    v_rcp_f32 v170, v170
    v_mfma_f32_16x16x32_bf16 v[146:149], v[218:221], v[36:39], 0
    v_exp_f32 v166, v166
    v_mfma_f32_16x16x32_bf16 v[146:149], v[142:145], v[194:197], v[146:149]
    v_mul_f32 v114, v170, v114
    v_mul_f32 v115, v170, v115
    v_mfma_f32_16x16x32_bf16 v[126:129], a[244:247], v[122:125], v[126:129]
    v_cvt_pk_bf16_f32 v194, v114, v115
    v_mul_f32 v116, v170, v116
    v_mfma_f32_16x16x32_bf16 v[126:129], a[248:251], v[150:153], v[126:129]
    ds_read_b128 v[202:205], v2 offset:12288
    v_mul_f32 v117, v170, v117
    v_mfma_f32_16x16x32_bf16 v[126:129], a[252:255], v[154:157], v[126:129]
    ds_read_b128 v[230:233], v2 offset:13312
    v_cvt_pk_bf16_f32 v195, v116, v117
    v_mfma_f32_16x16x32_bf16 v[126:129], v[82:85], v[158:161], v[126:129]
    ds_read_b128 v[234:237], v2 offset:14336
    v_mul_f32 v190, v170, v190
    v_mfma_f32_16x16x32_bf16 v[126:129], v[86:89], v[174:177], v[126:129]
    ds_read_b128 v[238:241], v2 offset:15360
    v_mul_f32 v191, v170, v191
    v_mfma_f32_16x16x32_bf16 v[114:117], v[90:93], v[118:121], 0
    ds_read_b128 v[118:121], v2 offset:16384
    v_cvt_pk_bf16_f32 v196, v190, v191
    v_mfma_f32_16x16x32_bf16 v[114:117], v[94:97], v[122:125], v[114:117]
    ds_read_b128 v[122:125], v2 offset:17408
    v_mul_f32 v192, v170, v192
    v_mfma_f32_16x16x32_bf16 v[114:117], v[98:101], v[150:153], v[114:117]
    v_fmac_f32 v255, v126, v126
    v_fmac_f32 v255, v127, v127
    v_mfma_f32_16x16x32_bf16 v[114:117], v[102:105], v[154:157], v[114:117]
    v_fmac_f32 v255, v128, v128
    v_fmac_f32 v255, v129, v129
    v_mfma_f32_16x16x32_bf16 v[114:117], v[106:109], v[158:161], v[114:117]
    s_waitcnt lgkmcnt(5)
    v_mul_f32 v193, v170, v193
    v_cvt_pk_bf16_f32 v197, v192, v193
    v_mfma_f32_16x16x32_bf16 v[114:117], v[110:113], v[174:177], v[114:117]
    s_waitcnt lgkmcnt(4)
    ds_write_b128 v3, v[194:197] offset:6144
    v_mfma_f32_16x16x32_bf16 v[242:245], a[216:219], v[202:205], 0
    s_waitcnt lgkmcnt(3)
    v_mul_f32 v146, v170, v146
    v_mul_f32 v147, v170, v147
    v_mfma_f32_16x16x32_bf16 v[242:245], a[220:223], v[230:233], v[242:245]
    s_waitcnt lgkmcnt(2)
    v_fmac_f32 v255, v114, v114
    v_fmac_f32 v255, v115, v115
    v_mfma_f32_16x16x32_bf16 v[242:245], a[224:227], v[234:237], v[242:245]
    s_waitcnt lgkmcnt(1)
    v_fmac_f32 v255, v116, v116
    v_fmac_f32 v255, v117, v117
    v_mfma_f32_16x16x32_bf16 v[242:245], a[228:231], v[238:241], v[242:245]
    v_cvt_pk_bf16_f32 v254, v254, v255
    v_cvt_pk_bf16_f32 v172, v146, v147
    v_mfma_f32_16x16x32_bf16 v[242:245], a[232:235], v[118:121], v[242:245]
    v_mul_f32 v148, v170, v148
    v_mul_f32 v149, v170, v149
    v_mfma_f32_16x16x32_bf16 v[242:245], a[236:239], v[122:125], v[242:245]
    v_cvt_pk_bf16_f32 v173, v148, v149
    v_cvt_pk_bf16_f32 v39, v252, 0
    v_mfma_f32_16x16x32_bf16 v[158:161], a[240:243], v[202:205], 0
    ds_write_b64 v4, v[172:173] offset:10240
    v_mfma_f32_16x16x32_bf16 v[158:161], a[244:247], v[230:233], v[158:161]
    v_exp_f32 v167, v167
    v_mfma_f32_16x16x32_bf16 v[158:161], a[248:251], v[234:237], v[158:161]
    v_cvt_pk_bf16_f32 v36, v166, v167
    v_fma_f32 v255, v242, v242, s33
    v_mfma_f32_16x16x32_bf16 v[158:161], a[252:255], v[238:241], v[158:161]
    v_fmac_f32 v255, v243, v243
    v_fmac_f32 v255, v244, v244
    v_mfma_f32_16x16x32_bf16 v[158:161], v[82:85], v[118:121], v[158:161]
    v_fmac_f32 v255, v245, v245
    v_xor_b32 v2, 65536, v2
    v_mfma_f32_16x16x32_bf16 v[158:161], v[86:89], v[122:125], v[158:161]
    v_exp_f32 v168, v168
    v_mfma_f32_16x16x32_bf16 v[154:157], v[90:93], v[202:205], 0
    v_exp_f32 v169, v169
    v_mfma_f32_16x16x32_bf16 v[154:157], v[94:97], v[230:233], v[154:157]
    ds_read_b128 v[146:149], v9
    v_cvt_pk_bf16_f32 v37, v168, v169
    v_mfma_f32_16x16x32_bf16 v[154:157], v[98:101], v[234:237], v[154:157]
    ds_read_b128 v[150:153], v9 offset:64
    v_fmac_f32 v255, v158, v158
    v_mfma_f32_16x16x32_bf16 v[166:169], v[28:31], v[36:39], 0
    v_fmac_f32 v255, v159, v159
    v_fmac_f32 v255, v160, v160
    v_mfma_f32_16x16x32_bf16 v[166:169], v[28:31], v[186:189], v[166:169]
    v_fmac_f32 v255, v161, v161
    v_add_u32 v6, s75, v6
    v_mfma_f32_16x16x32_bf16 v[174:177], v[162:165], v[36:39], 0
    v_rcp_f32 v182, v182
    v_mfma_f32_16x16x32_bf16 v[174:177], v[134:137], v[186:189], v[174:177]
    v_max3_u32 v25, v25, v182, v183
    v_max3_u32 v25, v25, v170, v171
    v_mfma_f32_16x16x32_bf16 v[170:173], v[210:213], v[36:39], 0
    v_rcp_f32 v166, v166
    v_mfma_f32_16x16x32_bf16 v[170:173], v[138:141], v[186:189], v[170:173]
    v_max3_u32 v25, v25, v166, v167
    v_mul_f32 v214, v182, v214
    v_mfma_f32_16x16x32_bf16 v[190:193], v[218:221], v[36:39], 0
    s_waitcnt lgkmcnt(1)
    v_mul_f32 v174, v166, v174
    v_mul_f32 v175, v166, v175
    v_mfma_f32_16x16x32_bf16 v[190:193], v[142:145], v[186:189], v[190:193]
    s_waitcnt lgkmcnt(0)
    v_cvt_pk_bf16_f32 v174, v174, v175
    v_mul_f32 v176, v166, v176
    v_mfma_f32_16x16x32_bf16 v[154:157], v[102:105], v[238:241], v[154:157]
    ds_read_b128 v[186:189], v0 offset:20480
    v_mul_f32 v177, v166, v177
    v_mfma_f32_16x16x32_bf16 v[154:157], v[106:109], v[118:121], v[154:157]
    ds_read_b128 v[194:197], v1 offset:20480
    v_cvt_pk_bf16_f32 v175, v176, v177
    v_mfma_f32_16x16x32_bf16 v[154:157], v[110:113], v[122:125], v[154:157]
    ds_read_b128 v[122:125], v0 offset:20608
    v_mul_f32 v170, v166, v170
    v_mfma_f32_16x16x32_bf16 v[118:121], v[146:149], v[28:31], 0
    ds_read_b128 v[202:205], v1 offset:20608
    v_mul_f32 v171, v166, v171
    v_mfma_f32_16x16x32_bf16 v[118:121], v[150:153], v[28:31], v[118:121]
    ds_read_b128 v[230:233], v0 offset:20736
    v_cvt_pk_bf16_f32 v176, v170, v171
    v_mfma_f32_16x16x32_bf16 v[234:237], v[146:149], v[134:137], 0
    ds_read_b128 v[238:241], v1 offset:20736
    v_fmac_f32 v255, v154, v154
    v_mfma_f32_16x16x32_bf16 v[234:237], v[150:153], v[162:165], v[234:237]
    v_fmac_f32 v255, v155, v155
    v_fmac_f32 v255, v156, v156
    v_mfma_f32_16x16x32_bf16 v[134:137], v[146:149], v[138:141], 0
    v_fmac_f32 v255, v157, v157
    v_cvt_pk_bf16_f32 v255, v255, v255
    v_mfma_f32_16x16x32_bf16 v[134:137], v[150:153], v[210:213], v[134:137]
    s_waitcnt lgkmcnt(5)
    ds_write_b64 v4, v[254:255] offset:18432
    v_mfma_f32_16x16x32_bf16 v[138:141], v[146:149], v[142:145], 0
    s_waitcnt lgkmcnt(4)
    v_mul_f32 v172, v166, v172
    v_mul_f32 v173, v166, v173
    v_mfma_f32_16x16x32_bf16 v[138:141], v[150:153], v[218:221], v[138:141]
    s_waitcnt lgkmcnt(3)
    v_cvt_pk_bf16_f32 v177, v172, v173
    v_mul_f32 v190, v166, v190
    v_mfma_f32_16x16x32_bf16 v[142:145], a[72:75], v[186:189], 0
    s_waitcnt lgkmcnt(2)
    ds_write_b128 v3, v[174:177] offset:12288
    v_mfma_f32_16x16x32_bf16 v[142:145], a[76:79], v[194:197], v[142:145]
    s_waitcnt lgkmcnt(2)
    v_mul_f32 v191, v166, v191
    v_cvt_pk_bf16_f32 v120, v190, v191
    v_mfma_f32_16x16x32_bf16 v[142:145], a[80:83], v[122:125], v[142:145]
    v_mul_f32 v192, v166, v192
    v_mul_f32 v193, v166, v193
    v_mfma_f32_16x16x32_bf16 v[142:145], a[84:87], v[202:205], v[142:145]
    v_cvt_pk_bf16_f32 v121, v192, v193
    v_mul_f32 v215, v182, v215
    v_mfma_f32_16x16x32_bf16 v[142:145], a[88:91], v[230:233], v[142:145]
    ds_write_b64 v4, v[120:121] offset:16384
    v_mfma_f32_16x16x32_bf16 v[142:145], a[92:95], v[238:241], v[142:145]
    v_rcp_f32 v118, v118
    v_mfma_f32_16x16x32_bf16 v[150:153], a[96:99], v[186:189], 0
    v_max3_u32 v25, v25, v118, v119
    v_mul_f32 v234, v234, v118
    v_mfma_f32_16x16x32_bf16 v[150:153], a[100:103], v[194:197], v[150:153]
    v_mul_f32_dpp v234, v134, v118 quad_perm:[0,1,2,3] row_mask:0x2 bank_mask:0xf
    v_mul_f32_dpp v234, v138, v118 quad_perm:[0,1,2,3] row_mask:0x4 bank_mask:0xf
    v_mfma_f32_16x16x32_bf16 v[150:153], a[104:107], v[122:125], v[150:153]
    v_cvt_pk_bf16_f32 v234, v234, v234
    v_cvt_pk_bf16_f32 v118, v214, v215
    v_mfma_f32_16x16x32_bf16 v[150:153], a[108:111], v[202:205], v[150:153]
    ds_write_b16 v7, v234
    v_mfma_f32_16x16x32_bf16 v[150:153], a[112:115], v[230:233], v[150:153]
    v_mul_f32 v216, v182, v216
    v_mul_f32 v217, v182, v217
    v_mfma_f32_16x16x32_bf16 v[150:153], a[116:119], v[238:241], v[150:153]
    v_cvt_pk_bf16_f32 v119, v216, v217
    v_mul_f32 v222, v182, v222
    v_mfma_f32_16x16x32_bf16 v[134:137], a[120:123], v[186:189], 0
    v_mul_f32 v223, v182, v223
    v_cvt_pk_bf16_f32 v120, v222, v223
    v_mfma_f32_16x16x32_bf16 v[134:137], a[124:127], v[194:197], v[134:137]
    v_mul_f32 v224, v182, v224
    v_mul_f32 v225, v182, v225
    v_mfma_f32_16x16x32_bf16 v[134:137], a[128:131], v[122:125], v[134:137]
    v_cvt_pk_bf16_f32 v121, v224, v225
    v_mul_f32 v226, v182, v226
    v_mfma_f32_16x16x32_bf16 v[134:137], a[132:135], v[202:205], v[134:137]
    ds_write_b128 v3, v[118:121] offset:0
    v_mfma_f32_16x16x32_bf16 v[134:137], a[136:139], v[230:233], v[134:137]
    v_mul_f32 v227, v182, v227
    v_cvt_pk_bf16_f32 v254, v226, v227
    v_mfma_f32_16x16x32_bf16 v[134:137], a[140:143], v[238:241], v[134:137]
    v_mul_f32 v228, v182, v228
    v_mul_f32 v229, v182, v229
    v_mfma_f32_16x16x32_bf16 v[138:141], a[0:3], v[186:189], 0
    v_cvt_pk_bf16_f32 v255, v228, v229
    v_xor_b32 v3, 65536, v3
    v_mfma_f32_16x16x32_bf16 v[138:141], a[4:7], v[194:197], v[138:141]
    ds_write_b64 v4, v[254:255] offset:4096
    v_mfma_f32_16x16x32_bf16 v[138:141], a[8:11], v[122:125], v[138:141]
    v_xor_b32 v4, 65536, v4
    v_add_u32 v7, s76, v7
    v_mfma_f32_16x16x32_bf16 v[138:141], a[12:15], v[202:205], v[138:141]
    v_cvt_pk_f16_f32 v146, v142, v143
    v_pk_mul_f16 v143, v146, v146
    v_mfma_f32_16x16x32_bf16 v[138:141], a[16:19], v[230:233], v[138:141]
    v_cvt_pk_f16_f32 v147, v144, v145
    v_pk_fma_f16 v143, v147, v147, v143
    v_mfma_f32_16x16x32_bf16 v[138:141], a[20:23], v[238:241], v[138:141]
    v_cvt_pk_f16_f32 v148, v150, v151
    v_pk_fma_f16 v143, v148, v148, v143
    v_mfma_f32_16x16x32_bf16 v[166:169], a[24:27], v[186:189], 0
    v_cvt_pk_f16_f32 v149, v152, v153
    v_pk_fma_f16 v143, v149, v149, v143
    v_mfma_f32_16x16x32_bf16 v[166:169], a[28:31], v[194:197], v[166:169]
    v_cvt_pk_f16_f32 v120, v134, v135
    v_pk_fma_f16 v143, v120, v120, v143
    v_mfma_f32_16x16x32_bf16 v[166:169], a[32:35], v[122:125], v[166:169]
    s_waitcnt lgkmcnt(0)
    v_cvt_pk_f16_f32 v121, v136, v137
    v_pk_fma_f16 v143, v121, v121, v143
    v_mfma_f32_16x16x32_bf16 v[166:169], a[36:39], v[202:205], v[166:169]
    s_nop 0
    v_mfma_f32_16x16x32_bf16 v[166:169], a[40:43], v[230:233], v[166:169]
    s_nop 0
    v_mfma_f32_16x16x32_bf16 v[166:169], a[44:47], v[238:241], v[166:169]
    s_barrier
    v_mfma_f32_16x16x32_bf16 v[134:137], a[48:51], v[186:189], 0
    s_nop 0
    v_mfma_f32_16x16x32_bf16 v[134:137], a[52:55], v[194:197], v[134:137]
    s_cbranch_scc1 L_loop_fast2
    s_branch L_final_fast
.p2align 6
L_loop_fast3:
    v_mfma_f32_16x16x32_bf16 v[134:137], a[56:59], v[122:125], v[134:137]
    s_add_u32 s12, s40, s27
    ds_read_b128 v[190:193], v2 offset:18432
    v_cvt_pk_f16_f32 v150, v138, v139
    v_mfma_f32_16x16x32_bf16 v[134:137], a[60:63], v[202:205], v[134:137]
    s_addc_u32 s13, s41, 0
    ds_read_b128 v[210:213], v2 offset:19456
    v_pk_mul_f16 v142, v150, v150
    v_mfma_f32_16x16x32_bf16 v[134:137], a[64:67], v[230:233], v[134:137]
    s_sub_u32 s14, s36, s27
    ds_read_b128 v[174:177], v5 offset:32
    v_cvt_pk_f16_f32 v151, v140, v141
    v_mfma_f32_16x16x32_bf16 v[134:137], a[68:71], v[238:241], v[134:137]
    s_cmp_ge_u32 s18, 2
    ds_read2_b64 v[162:165], v5 offset0:6 offset1:9
    v_pk_fma_f16 v142, v151, v151, v142
    v_mfma_f32_16x16x32_bf16 v[138:141], v[186:189], a[144:147], 0
    s_cselect_b32 s14, s14, 0
    ds_read_b128 v[170:173], v5
    v_cvt_pk_f16_f32 v152, v166, v167
    v_mfma_f32_16x16x32_bf16 v[138:141], v[194:197], a[148:151], v[138:141]
    s_sub_u32 s82, s72, s71
    ds_read_b32 v254, v6 offset:192
    v_pk_fma_f16 v142, v152, v152, v142
    v_mfma_f32_16x16x32_bf16 v[138:141], v[122:125], a[152:155], v[138:141]
    s_mul_i32 s74, s82, 336
    v_cvt_pk_f16_f32 v153, v168, v169
    v_pk_fma_f16 v142, v153, v153, v142
    v_mfma_f32_16x16x32_bf16 v[138:141], v[202:205], a[156:159], v[138:141]
    s_mul_i32 s75, s82, 272
    v_cvt_pk_f16_f32 v118, v134, v135
    v_pk_fma_f16 v142, v118, v118, v142
    v_mfma_f32_16x16x32_bf16 v[138:141], v[230:233], a[160:163], v[138:141]
    s_waitcnt lgkmcnt(5)
    ds_read_b128 v[182:185], v0 offset:26624
    v_cvt_pk_f16_f32 v119, v136, v137
    v_mfma_f32_16x16x32_bf16 v[166:169], v[32:35], v[190:193], 0
    s_waitcnt lgkmcnt(5)
    v_pk_fma_f16 v142, v119, v119, v142
    v_add_u32 v5, s74, v5
    v_mfma_f32_16x16x32_bf16 v[166:169], v[32:35], v[210:213], v[166:169]
    s_waitcnt lgkmcnt(4)
    v_pk_mul_f16 v145, v146, v174
    v_pk_fma_f16 v145, v147, v175, v145
    v_mfma_f32_16x16x32_bf16 v[138:141], v[238:241], a[164:167], v[138:141]
    s_mul_i32 s76, s82, 16
    ds_read_b128 v[210:213], v1 offset:26624
    v_pk_fma_f16 v145, v148, v176, v145
    v_mfma_f32_16x16x32_bf16 v[214:217], v[186:189], a[168:171], 0
    s_waitcnt lgkmcnt(3)
    ds_read_b128 v[218:221], v0 offset:26752
    v_pk_fma_f16 v145, v149, v177, v145
    v_mfma_f32_16x16x32_bf16 v[214:217], v[194:197], a[172:175], v[214:217]
    s_waitcnt lgkmcnt(3)
    ds_read_b128 v[222:225], v1 offset:26752
    v_mov_b32_dpp v254, v23 quad_perm:[0,1,2,3] row_mask:0x7 bank_mask:0xf
    v_mfma_f32_16x16x32_bf16 v[214:217], v[122:125], a[176:179], v[214:217]
    s_add_u32 s34, s18, 2
    ds_read_b128 v[226:229], v0 offset:26880
    v_pk_fma_f16 v145, v120, v164, v145
    v_mfma_f32_16x16x32_bf16 v[214:217], v[202:205], a[180:183], v[214:217]
    s_add_u32 s8, s60, s23
    ds_read_b128 v[190:193], v1 offset:26880
    v_pk_fma_f16 v145, v121, v165, v145
    v_mfma_f32_16x16x32_bf16 v[214:217], v[230:233], a[184:187], v[214:217]
    s_waitcnt lgkmcnt(5)
    v_pk_mul_f16 v144, v150, v170
    v_pk_fma_f16 v144, v151, v171, v144
    v_mfma_f32_16x16x32_bf16 v[214:217], v[238:241], a[188:191], v[214:217]
    s_addc_u32 s9, s61, 0
    v_pk_fma_f16 v144, v152, v172, v144
    v_pk_fma_f16 v144, v153, v173, v144
    v_mfma_f32_16x16x32_bf16 v[246:249], v[186:189], a[192:195], 0
    s_sub_u32 s10, s36, s23
    v_pk_fma_f16 v144, v118, v162, v144
    v_pk_fma_f16 v144, v119, v163, v144
    v_mfma_f32_16x16x32_bf16 v[246:249], v[194:197], a[196:199], v[246:249]
    s_cmp_le_u32 s34, s45
    v_cvt_pk_bf16_f32 v134, v138, v139
    v_cvt_pk_bf16_f32 v135, v140, v141
    v_mfma_f32_16x16x32_f16 v[234:237], v[40:43], v[142:145], 0
    s_cselect_b32 s10, s10, 0
    v_cvt_pk_bf16_f32 v138, v214, v215
    v_cvt_pk_bf16_f32 v139, v216, v217
    v_mfma_f32_16x16x32_bf16 v[246:249], v[122:125], a[200:203], v[246:249]
    s_add_u32 m0, s28, 0
    v_mul_f32 v136, 0x3baaaaab, v166
    v_mul_f32 v255, 0x3baaaaab, v167
    v_mfma_f32_16x16x32_bf16 v[246:249], v[202:205], a[204:207], v[246:249]
    s_mov_b32 s27, s26
    v_rsq_f32 v234, v234
    v_mfma_f32_16x16x32_bf16 v[246:249], v[230:233], a[208:211], v[246:249]
    s_mov_b32 s26, s25
    v_rsq_f32 v235, v235
    v_mfma_f32_16x16x32_bf16 v[246:249], v[238:241], a[212:215], v[246:249]
    s_mov_b32 s25, s24
    v_mul_f32 v140, s31, v234
    v_cvt_pk_f16_f32 v141, v140, v235
    v_mfma_f32_16x16x32_bf16 v[122:125], a[72:75], v[182:185], 0
    s_waitcnt lgkmcnt(0)
    v_fma_f32 v236, v236, v140, v22
    v_fmac_f32_dpp v254, v237, v235 quad_perm:[0,1,2,3] row_mask:0x1 bank_mask:0xf
    v_mfma_f32_16x16x32_bf16 v[122:125], a[76:79], v[210:213], v[122:125]
    s_mov_b32 s24, s23
    v_cvt_pk_bf16_f32 v142, v246, v247
    v_cvt_pk_bf16_f32 v143, v248, v249
    v_mfma_f32_16x16x32_bf16 v[122:125], a[80:83], v[218:221], v[122:125]
    s_mov_b32 s71, s72
    v_pk_mul_f16 v146, v146, v141 op_sel:[0,1] op_sel_hi:[1,1]
    v_pk_mul_f16 v147, v147, v141 op_sel:[0,1] op_sel_hi:[1,1]
    v_mfma_f32_16x16x32_bf16 v[122:125], a[84:87], v[222:225], v[122:125]
    s_mov_b32 s72, s73
    v_pk_mul_f16 v148, v148, v141 op_sel:[0,1] op_sel_hi:[1,1]
    v_pk_mul_f16 v149, v149, v141 op_sel:[0,1] op_sel_hi:[1,1]
    v_mfma_f32_16x16x32_bf16 v[122:125], a[88:91], v[226:229], v[122:125]
    v_pk_mul_f16 v120, v120, v141 op_sel:[0,1] op_sel_hi:[1,1]
    v_pk_mul_f16 v121, v121, v141 op_sel:[0,1] op_sel_hi:[1,1]
    v_mfma_f32_16x16x32_bf16 v[122:125], a[92:95], v[190:193], v[122:125]
    v_pk_mul_f16 v150, v150, v141 op_sel:[0,0] op_sel_hi:[1,0]
    v_pk_mul_f16 v151, v151, v141 op_sel:[0,0] op_sel_hi:[1,0]
    v_mfma_f32_16x16x32_bf16 v[186:189], a[96:99], v[182:185], 0
    v_pk_mul_f16 v152, v152, v141 op_sel:[0,0] op_sel_hi:[1,0]
    v_pk_mul_f16 v153, v153, v141 op_sel:[0,0] op_sel_hi:[1,0]
    v_mfma_f32_16x16x32_bf16 v[186:189], a[100:103], v[210:213], v[186:189]
    v_pk_mul_f16 v118, v118, v141 op_sel:[0,0] op_sel_hi:[1,0]
    v_pk_mul_f16 v119, v119, v141 op_sel:[0,0] op_sel_hi:[1,0]
    v_mfma_f32_16x16x32_bf16 v[186:189], a[104:107], v[218:221], v[186:189]
    v_max3_u32 v44, v44, v234, v235
    v_mul_f32 v144, 0x3baaaaab, v168
    v_mfma_f32_16x16x32_bf16 v[186:189], a[108:111], v[222:225], v[186:189]
    v_rsq_f32 v136, v136
    v_mfma_f32_16x16x32_bf16 v[186:189], a[112:115], v[226:229], v[186:189]
    v_rsq_f32 v255, v255
    v_mfma_f32_16x16x32_bf16 v[186:189], a[116:119], v[190:193], v[186:189]
    v_rsq_f32 v144, v144
    v_mfma_f32_16x16x32_bf16 v[194:197], a[120:123], v[182:185], 0
    v_mul_f32 v178, v136, v178
    v_mul_f32 v179, v136, v179
    v_mfma_f32_16x16x32_bf16 v[194:197], a[124:127], v[210:213], v[194:197]
    v_cvt_pk_bf16_f32 v166, v178, v179
    v_mul_f32 v180, v136, v180
    v_mfma_f32_16x16x32_bf16 v[194:197], a[128:131], v[218:221], v[194:197]
    v_mul_f32 v181, v136, v181
    v_cvt_pk_bf16_f32 v167, v180, v181
    v_mfma_f32_16x16x32_bf16 v[194:197], a[132:135], v[222:225], v[194:197]
    v_mul_f32 v198, v136, v198
    v_mul_f32 v199, v136, v199
    v_mfma_f32_16x16x32_bf16 v[194:197], a[136:139], v[226:229], v[194:197]
    v_cvt_pk_bf16_f32 v168, v198, v199
    v_mul_f32 v200, v136, v200
    v_mfma_f32_16x16x32_bf16 v[194:197], a[140:143], v[190:193], v[194:197]
    v_mul_f32 v201, v136, v201
    v_cvt_pk_bf16_f32 v169, v200, v201
    v_mfma_f32_16x16x32_bf16 v[178:181], a[0:3], v[182:185], 0
    buffer_store_dwordx4 v[166:169], v15, s[12:15], 0 offen nt
    v_mul_f32 v206, v136, v206
    v_mul_f32 v207, v136, v207
    v_cvt_pk_bf16_f32 v140, v206, v207
    v_mul_f32 v208, v136, v208
    v_mfma_f32_16x16x32_bf16 v[178:181], a[4:7], v[210:213], v[178:181]
    v_mul_f32 v209, v136, v209
    v_cvt_pk_bf16_f32 v141, v208, v209
    v_mfma_f32_16x16x32_bf16 v[178:181], a[8:11], v[218:221], v[178:181]
    v_cvt_pk_f16_f32 v166, v122, v123
    v_pk_mul_f16 v199, v166, v166
    v_mfma_f32_16x16x32_bf16 v[178:181], a[12:15], v[222:225], v[178:181]
    v_cvt_pk_f16_f32 v167, v124, v125
    v_pk_fma_f16 v199, v167, v167, v199
    v_mfma_f32_16x16x32_bf16 v[178:181], a[16:19], v[226:229], v[178:181]
    v_cvt_pk_f16_f32 v168, v186, v187
    v_pk_fma_f16 v199, v168, v168, v199
    v_mfma_f32_16x16x32_bf16 v[178:181], a[20:23], v[190:193], v[178:181]
    v_cvt_pk_f16_f32 v169, v188, v189
    v_pk_fma_f16 v199, v169, v169, v199
    v_mfma_f32_16x16x32_bf16 v[186:189], a[24:27], v[182:185], 0
    v_cvt_pk_f16_f32 v124, v194, v195
    v_pk_fma_f16 v199, v124, v124, v199
    v_mfma_f32_16x16x32_bf16 v[186:189], a[28:31], v[210:213], v[186:189]
    v_cvt_pk_f16_f32 v125, v196, v197
    v_pk_fma_f16 v199, v125, v125, v199
    v_mfma_f32_16x16x32_bf16 v[186:189], a[32:35], v[218:221], v[186:189]
    v_cvt_pk_f16_f32 v178, v178, v179
    v_pk_mul_f16 v198, v178, v178
    v_mfma_f32_16x16x32_bf16 v[186:189], a[36:39], v[222:225], v[186:189]
    v_cvt_pk_f16_f32 v179, v180, v181
    v_pk_fma_f16 v198, v179, v179, v198
    v_mfma_f32_16x16x32_bf16 v[186:189], a[40:43], v[226:229], v[186:189]
    v_pk_mul_f16 v200, v178, v170
    v_pk_fma_f16 v200, v179, v171, v200
    v_mfma_f32_16x16x32_bf16 v[186:189], a[44:47], v[190:193], v[186:189]
    v_pk_mul_f16 v201, v166, v174
    v_pk_fma_f16 v201, v167, v175, v201
    v_mfma_f32_16x16x32_bf16 v[194:197], a[48:51], v[182:185], 0
    v_pk_fma_f16 v201, v168, v176, v201
    v_pk_fma_f16 v201, v169, v177, v201
    v_mfma_f32_16x16x32_bf16 v[194:197], a[52:55], v[210:213], v[194:197]
    v_pk_fma_f16 v201, v124, v164, v201
    v_pk_fma_f16 v201, v125, v165, v201
    v_mfma_f32_16x16x32_bf16 v[194:197], a[56:59], v[218:221], v[194:197]
    v_cvt_pk_f16_f32 v180, v186, v187
    v_pk_fma_f16 v198, v180, v180, v198
    v_mfma_f32_16x16x32_bf16 v[194:197], a[60:63], v[222:225], v[194:197]
    v_cvt_pk_f16_f32 v181, v188, v189
    v_pk_fma_f16 v198, v181, v181, v198
    v_mfma_f32_16x16x32_bf16 v[194:197], a[64:67], v[226:229], v[194:197]
    v_pk_fma_f16 v200, v180, v172, v200
    v_pk_fma_f16 v200, v181, v173, v200
    v_mfma_f32_16x16x32_bf16 v[194:197], a[68:71], v[190:193], v[194:197]
    buffer_store_dwordx2 v[140:141], v18, s[12:15], 0 offen nt
    v_mul_f32 v242, v144, v242
    v_mul_f32 v243, v144, v243
    v_mfma_f32_16x16x32_bf16 v[186:189], v[182:185], a[144:147], 0
    v_cvt_pk_bf16_f32 v238, v242, v243
    v_mul_f32 v244, v144, v244
    v_mfma_f32_16x16x32_bf16 v[186:189], v[210:213], a[148:151], v[186:189]
    v_mul_f32 v245, v144, v245
    v_cvt_pk_f16_f32 v122, v194, v195
    v_mfma_f32_16x16x32_bf16 v[186:189], v[218:221], a[152:155], v[186:189]
    v_pk_fma_f16 v198, v122, v122, v198
    v_cvt_pk_f16_f32 v123, v196, v197
    v_mfma_f32_16x16x32_bf16 v[186:189], v[222:225], a[156:159], v[186:189]
    v_pk_fma_f16 v198, v123, v123, v198
    v_pk_fma_f16 v200, v122, v162, v200
    v_mfma_f32_16x16x32_bf16 v[186:189], v[226:229], a[160:163], v[186:189]
    ds_read_b128 v[202:205], v0 offset:32768
    v_pk_fma_f16 v200, v123, v163, v200
    v_mfma_f32_16x16x32_bf16 v[186:189], v[190:193], a[164:167], v[186:189]
    ds_read_b128 v[194:197], v1 offset:32768
    v_cvt_pk_bf16_f32 v239, v244, v245
    v_mfma_f32_16x16x32_f16 v[230:233], v[40:43], v[198:201], 0
    v_mul_f32 v158, v144, v158
    v_mul_f32 v159, v144, v159
    v_mfma_f32_16x16x32_bf16 v[246:249], v[182:185], a[168:171], 0
    ds_read_b128 v[214:217], v0 offset:32896
    v_cvt_pk_bf16_f32 v240, v158, v159
    v_mfma_f32_16x16x32_bf16 v[246:249], v[210:213], a[172:175], v[246:249]
    ds_read_b128 v[206:209], v1 offset:32896
    v_cvt_pk_bf16_f32 v136, v186, v187
    v_mfma_f32_16x16x32_bf16 v[246:249], v[218:221], a[176:179], v[246:249]
    ds_read_b128 v[198:201], v0 offset:33024
    v_cvt_pk_bf16_f32 v137, v188, v189
    v_mfma_f32_16x16x32_bf16 v[246:249], v[222:225], a[180:183], v[246:249]
    ds_read_b128 v[186:189], v1 offset:33024
    v_mul_f32 v160, v144, v160
    v_mfma_f32_16x16x32_bf16 v[246:249], v[226:229], a[184:187], v[246:249]
    v_rsq_f32 v230, v230
    v_mfma_f32_16x16x32_bf16 v[246:249], v[190:193], a[188:191], v[246:249]
    s_waitcnt lgkmcnt(5)
    v_rsq_f32 v231, v231
    v_mfma_f32_16x16x32_bf16 v[242:245], v[182:185], a[192:195], 0
    s_waitcnt lgkmcnt(4)
    v_mul_f32 v234, s31, v230
    v_cvt_pk_f16_f32 v235, v234, v231
    v_mfma_f32_16x16x32_bf16 v[242:245], v[210:213], a[196:199], v[242:245]
    v_fma_f32 v232, v232, v234, v24
    v_fmac_f32_dpp v254, v233, v231 quad_perm:[0,1,2,3] row_mask:0x2 bank_mask:0xf
    v_mfma_f32_16x16x32_bf16 v[242:245], v[218:221], a[200:203], v[242:245]
    s_waitcnt lgkmcnt(3)
    v_cvt_pk_bf16_f32 v140, v246, v247
    v_cvt_pk_bf16_f32 v141, v248, v249
    v_mfma_f32_16x16x32_bf16 v[242:245], v[222:225], a[204:207], v[242:245]
    s_waitcnt lgkmcnt(2)
    v_mul_f32 v161, v144, v161
    v_cvt_pk_bf16_f32 v241, v160, v161
    v_mfma_f32_16x16x32_bf16 v[242:245], v[226:229], a[208:211], v[242:245]
    s_waitcnt lgkmcnt(1)
    buffer_store_dwordx4 v[238:241], v17, s[12:15], 0 offen nt
    v_mul_f32 v154, v144, v154
    v_mul_f32 v155, v144, v155
    v_cvt_pk_bf16_f32 v154, v154, v155
    v_mul_f32 v156, v144, v156
    v_mfma_f32_16x16x32_bf16 v[242:245], v[190:193], a[212:215], v[242:245]
    s_waitcnt lgkmcnt(0)
    v_mul_f32 v157, v144, v157
    v_cvt_pk_bf16_f32 v155, v156, v157
    v_mfma_f32_16x16x32_bf16 v[158:161], a[72:75], v[202:205], 0
    v_pk_mul_f16 v166, v166, v235 op_sel:[0,1] op_sel_hi:[1,1]
    v_pk_mul_f16 v167, v167, v235 op_sel:[0,1] op_sel_hi:[1,1]
    v_mfma_f32_16x16x32_bf16 v[158:161], a[76:79], v[194:197], v[158:161]
    v_pk_mul_f16 v168, v168, v235 op_sel:[0,1] op_sel_hi:[1,1]
    v_cvt_pk_bf16_f32 v144, v242, v243
    v_mfma_f32_16x16x32_bf16 v[158:161], a[80:83], v[214:217], v[158:161]
    v_cvt_pk_bf16_f32 v145, v244, v245
    v_pk_mul_f16 v169, v169, v235 op_sel:[0,1] op_sel_hi:[1,1]
    v_mfma_f32_16x16x32_bf16 v[158:161], a[84:87], v[206:209], v[158:161]
    v_pk_mul_f16 v124, v124, v235 op_sel:[0,1] op_sel_hi:[1,1]
    v_pk_mul_f16 v125, v125, v235 op_sel:[0,1] op_sel_hi:[1,1]
    v_mfma_f32_16x16x32_bf16 v[158:161], a[88:91], v[198:201], v[158:161]
    v_pk_mul_f16 v178, v178, v235 op_sel:[0,0] op_sel_hi:[1,0]
    v_pk_mul_f16 v179, v179, v235 op_sel:[0,0] op_sel_hi:[1,0]
    v_mfma_f32_16x16x32_bf16 v[158:161], a[92:95], v[186:189], v[158:161]
    v_pk_mul_f16 v180, v180, v235 op_sel:[0,0] op_sel_hi:[1,0]
    v_pk_mul_f16 v181, v181, v235 op_sel:[0,0] op_sel_hi:[1,0]
    v_mfma_f32_16x16x32_bf16 v[182:185], a[96:99], v[202:205], 0
    v_pk_mul_f16 v122, v122, v235 op_sel:[0,0] op_sel_hi:[1,0]
    v_pk_mul_f16 v123, v123, v235 op_sel:[0,0] op_sel_hi:[1,0]
    v_mfma_f32_16x16x32_bf16 v[182:185], a[100:103], v[194:197], v[182:185]
    v_max3_u32 v44, v44, v230, v231
    v_mul_f32 v130, v255, v130
    v_mfma_f32_16x16x32_bf16 v[182:185], a[104:107], v[214:217], v[182:185]
    v_cvt_pk_f16_f32 v158, v158, v159
    v_pk_mul_f16 v191, v158, v158
    v_mfma_f32_16x16x32_bf16 v[182:185], a[108:111], v[206:209], v[182:185]
    v_cvt_pk_f16_f32 v159, v160, v161
    v_pk_fma_f16 v191, v159, v159, v191
    v_mfma_f32_16x16x32_bf16 v[182:185], a[112:115], v[198:201], v[182:185]
    v_pk_mul_f16 v193, v158, v174
    v_pk_fma_f16 v193, v159, v175, v193
    v_mfma_f32_16x16x32_bf16 v[182:185], a[116:119], v[186:189], v[182:185]
    v_exp_f32 v232, v232
    v_mfma_f32_16x16x32_bf16 v[210:213], a[120:123], v[202:205], 0
    v_exp_f32 v236, v236
    v_mfma_f32_16x16x32_bf16 v[210:213], a[124:127], v[194:197], v[210:213]
    v_cvt_pk_bf16_f32 v39, v236, 0
    v_mul_f32 v131, v255, v131
    v_mfma_f32_16x16x32_bf16 v[210:213], a[128:131], v[214:217], v[210:213]
    s_waitcnt vmcnt(3)
    ds_write_b16 v8, v45 offset:512
    v_mfma_f32_16x16x32_bf16 v[210:213], a[132:135], v[206:209], v[210:213]
    buffer_store_dwordx2 v[154:155], v20, s[12:15], 0 offen nt
    v_cvt_pk_f16_f32 v160, v182, v183
    v_mfma_f32_16x16x32_bf16 v[210:213], a[136:139], v[198:201], v[210:213]
    v_pk_fma_f16 v191, v160, v160, v191
    v_cvt_pk_f16_f32 v161, v184, v185
    v_mfma_f32_16x16x32_bf16 v[210:213], a[140:143], v[186:189], v[210:213]
    v_pk_fma_f16 v191, v161, v161, v191
    v_pk_fma_f16 v193, v160, v176, v193
    v_mfma_f32_16x16x32_bf16 v[154:157], a[0:3], v[202:205], 0
    v_pk_fma_f16 v193, v161, v177, v193
    v_cvt_pk_bf16_f32 v130, v130, v131
    v_mfma_f32_16x16x32_bf16 v[154:157], a[4:7], v[194:197], v[154:157]
    v_mul_f32 v132, v255, v132
    v_mul_f32 v133, v255, v133
    v_mfma_f32_16x16x32_bf16 v[154:157], a[8:11], v[214:217], v[154:157]
    v_cvt_pk_f16_f32 v176, v210, v211
    v_pk_fma_f16 v191, v176, v176, v191
    v_mfma_f32_16x16x32_bf16 v[154:157], a[12:15], v[206:209], v[154:157]
    s_waitcnt lgkmcnt(0)
    v_cvt_pk_f16_f32 v177, v212, v213
    v_pk_fma_f16 v191, v177, v177, v191
    v_mfma_f32_16x16x32_bf16 v[154:157], a[16:19], v[198:201], v[154:157]
    v_pk_fma_f16 v193, v176, v164, v193
    v_mfma_f32_16x16x32_bf16 v[154:157], a[20:23], v[186:189], v[154:157]
    v_pk_fma_f16 v193, v177, v165, v193
    v_mfma_f32_16x16x32_bf16 v[182:185], a[24:27], v[202:205], 0
    v_cvt_pk_bf16_f32 v131, v132, v133
    v_mfma_f32_16x16x32_bf16 v[182:185], a[28:31], v[194:197], v[182:185]
    s_barrier
    ds_read2_b32 v[164:165], v6 offset0:0 offset1:0
    v_mfma_f32_16x16x32_bf16 v[182:185], a[32:35], v[214:217], v[182:185]
    ds_read2_b32 v[212:213], v6 offset0:16 offset1:16
    v_cvt_pk_f16_f32 v154, v154, v155
    v_mfma_f32_16x16x32_bf16 v[182:185], a[36:39], v[206:209], v[182:185]
    ds_read2_b32 v[220:221], v6 offset0:32 offset1:32
    v_pk_mul_f16 v190, v154, v154
    v_mfma_f32_16x16x32_bf16 v[182:185], a[40:43], v[198:201], v[182:185]
    ds_read_u16 v133, v9 offset:128
    v_cvt_pk_f16_f32 v155, v156, v157
    v_mfma_f32_16x16x32_bf16 v[182:185], a[44:47], v[186:189], v[182:185]
    v_pk_fma_f16 v190, v155, v155, v190
    v_pk_mul_f16 v192, v154, v170
    v_mfma_f32_16x16x32_bf16 v[222:225], a[48:51], v[202:205], 0
    v_pk_fma_f16 v192, v155, v171, v192
    v_mul_f32 v126, v255, v126
    v_mfma_f32_16x16x32_bf16 v[222:225], a[52:55], v[194:197], v[222:225]
    v_mul_f32 v127, v255, v127
    v_cvt_pk_bf16_f32 v132, v126, v127
    v_mfma_f32_16x16x32_bf16 v[222:225], a[56:59], v[214:217], v[222:225]
    buffer_load_dwordx4 v10, s[8:11], 0 offen nt lds
    v_cvt_pk_f16_f32 v156, v182, v183
    v_mfma_f32_16x16x32_bf16 v[222:225], a[60:63], v[206:209], v[222:225]
    s_add_u32 m0, s28, 4096
    v_pk_fma_f16 v190, v156, v156, v190
    v_cvt_pk_f16_f32 v157, v184, v185
    v_mfma_f32_16x16x32_bf16 v[222:225], a[64:67], v[198:201], v[222:225]
    s_waitcnt lgkmcnt(2)
    v_pk_fma_f16 v190, v157, v157, v190
    v_pk_fma_f16 v192, v156, v172, v192
    v_mfma_f32_16x16x32_bf16 v[222:225], a[68:71], v[186:189], v[222:225]
    s_waitcnt lgkmcnt(1)
    ds_read_b128 v[182:185], v2 offset:0
    v_pk_fma_f16 v192, v157, v173, v192
    v_mfma_f32_16x16x32_bf16 v[170:173], v[202:205], a[144:147], 0
    s_waitcnt lgkmcnt(1)
    ds_read_b128 v[226:229], v2 offset:1024
    v_readfirstlane_b32 s77, v133
    v_mfma_f32_16x16x32_bf16 v[170:173], v[194:197], a[148:151], v[170:173]
    ds_read_b128 v[234:237], v2 offset:2048
    buffer_load_dwordx4 v11, s[8:11], 0 offen nt lds
    v_mfma_f32_16x16x32_bf16 v[170:173], v[214:217], a[152:155], v[170:173]
    s_add_u32 m0, s28, 8192
    ds_read_b128 v[238:241], v2 offset:3072
    v_cvt_pk_f16_f32 v174, v222, v223
    v_mfma_f32_16x16x32_bf16 v[170:173], v[206:209], a[156:159], v[170:173]
    s_mul_i32 s78, s77, 2688
    ds_read_b128 v[242:245], v2 offset:4096
    v_pk_fma_f16 v190, v174, v174, v190
    v_mfma_f32_16x16x32_bf16 v[170:173], v[198:201], a[160:163], v[170:173]
    ds_read_b128 v[246:249], v2 offset:5120
    v_cvt_pk_f16_f32 v175, v224, v225
    v_mfma_f32_16x16x32_bf16 v[170:173], v[186:189], a[164:167], v[170:173]
    v_pk_fma_f16 v190, v175, v175, v190
    v_pk_fma_f16 v192, v174, v162, v192
    v_mfma_f32_16x16x32_bf16 v[222:225], v[202:205], a[168:171], 0
    buffer_load_dwordx4 v12, s[8:11], 0 offen nt lds
    v_pk_fma_f16 v192, v175, v163, v192
    v_mfma_f32_16x16x32_bf16 v[222:225], v[194:197], a[172:175], v[222:225]
    s_waitcnt lgkmcnt(5)
    v_mul_f32 v128, v255, v128
    v_cvt_pk_bf16_f32 v162, v170, v171
    v_mfma_f32_16x16x32_f16 v[250:253], v[40:43], v[190:193], 0
    s_add_u32 m0, s28, 12288
    v_cvt_pk_bf16_f32 v163, v172, v173
    v_mul_f32 v129, v255, v129
    v_mfma_f32_16x16x32_bf16 v[222:225], v[214:217], a[176:179], v[222:225]
    s_xor_b32 s28, s28, 65536
    v_cvt_pk_bf16_f32 v133, v128, v129
    v_mul_f32 v114, v255, v114
    v_mfma_f32_16x16x32_bf16 v[222:225], v[206:209], a[180:183], v[222:225]
    s_waitcnt lgkmcnt(2)
    v_rsq_f32 v250, v250
    v_mfma_f32_16x16x32_bf16 v[222:225], v[198:201], a[184:187], v[222:225]
    s_waitcnt lgkmcnt(1)
    buffer_load_dwordx4 v13, s[8:11], 0 offen nt lds
    v_mul_f32 v230, s31, v250
    v_mfma_f32_16x16x32_bf16 v[222:225], v[186:189], a[188:191], v[222:225]
    s_mov_b32 m0, s29
    v_rsq_f32 v251, v251
    v_mfma_f32_16x16x32_bf16 v[126:129], v[202:205], a[192:195], 0
    s_xor_b32 s29, s29, s30
    v_cvt_pk_f16_f32 v231, v230, v251
    v_fma_f32 v252, v252, v230, v26
    v_mfma_f32_16x16x32_bf16 v[126:129], v[194:197], a[196:199], v[126:129]
    s_add_u32 s19, s19, s20
    v_fmac_f32_dpp v254, v253, v251 quad_perm:[0,1,2,3] row_mask:0x4 bank_mask:0xf
    v_cvt_pk_bf16_f32 v210, v222, v223
    v_mfma_f32_16x16x32_bf16 v[126:129], v[214:217], a[200:203], v[126:129]
    s_add_u32 s23, s23, s21
    v_cvt_pk_bf16_f32 v211, v224, v225
    v_pk_mul_f16 v158, v158, v231 op_sel:[0,1] op_sel_hi:[1,1]
    v_mfma_f32_16x16x32_bf16 v[126:129], v[206:209], a[204:207], v[126:129]
    s_waitcnt lgkmcnt(0)
    v_pk_mul_f16 v159, v159, v231 op_sel:[0,1] op_sel_hi:[1,1]
    v_mfma_f32_16x16x32_bf16 v[126:129], v[198:201], a[208:211], v[126:129]
    s_cmp_ge_u32 s19, 72
    v_pk_mul_f16 v160, v160, v231 op_sel:[0,1] op_sel_hi:[1,1]
    v_pk_mul_f16 v161, v161, v231 op_sel:[0,1] op_sel_hi:[1,1]
    v_mfma_f32_16x16x32_bf16 v[126:129], v[186:189], a[212:215], v[126:129]
    s_cselect_b32 s34, 72, 0
    v_pk_mul_f16 v176, v176, v231 op_sel:[0,1] op_sel_hi:[1,1]
    v_pk_mul_f16 v177, v177, v231 op_sel:[0,1] op_sel_hi:[1,1]
    v_mfma_f32_16x16x32_f16 v[170:173], v[146:149], v[150:153], v[46:49]
    s_cselect_b32 s35, s22, 0
    v_pk_mul_f16 v154, v154, v231 op_sel:[0,0] op_sel_hi:[1,0]
    v_pk_mul_f16 v155, v155, v231 op_sel:[0,0] op_sel_hi:[1,0]
    v_mfma_f32_16x16x32_f16 v[186:189], v[166:169], v[150:153], v[50:53]
    s_sub_u32 s19, s19, s34
    v_cvt_pk_bf16_f32 v218, v126, v127
    v_cvt_pk_bf16_f32 v219, v128, v129
    v_mfma_f32_16x16x32_f16 v[126:129], v[158:161], v[150:153], v[54:57]
    buffer_store_dwordx4 v[130:133], v16, s[12:15], 0 offen nt
    v_pk_mul_f16 v156, v156, v231 op_sel:[0,0] op_sel_hi:[1,0]
    v_pk_mul_f16 v157, v157, v231 op_sel:[0,0] op_sel_hi:[1,0]
    v_pk_mul_f16 v174, v174, v231 op_sel:[0,0] op_sel_hi:[1,0]
    v_pk_mul_f16 v175, v175, v231 op_sel:[0,0] op_sel_hi:[1,0]
    v_mfma_f32_16x16x16_f16 v[170:173], v[120:121], v[118:119], v[170:173]
    v_max3_u32 v44, v44, v250, v251
    v_exp_f32 v254, v254
    v_mfma_f32_16x16x16_f16 v[186:189], v[124:125], v[118:119], v[186:189]
    v_cvt_pk_bf16_f32 v254, v254, v254
    v_exp_f32 v252, v252
    v_mfma_f32_16x16x16_f16 v[126:129], v[176:177], v[118:119], v[126:129]
    v_mul_f32 v115, v255, v115
    v_cvt_pk_bf16_f32 v118, v114, v115
    v_exp_f32 v170, v170
    v_mfma_f32_16x16x32_f16 v[130:133], v[146:149], v[178:181], v[58:61]
    s_add_u32 s23, s23, s35
    ds_write_b16 v8, v254
    v_mfma_f32_16x16x32_f16 v[150:153], v[166:169], v[178:181], v[62:65]
    s_add_u32 s78, s78, s69
    v_exp_f32 v171, v171
    v_mfma_f32_16x16x32_f16 v[190:193], v[158:161], v[178:181], v[66:69]
    s_add_u32 s80, s77, s68
    v_cvt_pk_bf16_f32 v170, v170, v171
    v_exp_f32 v172, v172
    v_mfma_f32_16x16x16_f16 v[130:133], v[120:121], v[122:123], v[130:133]
    v_exp_f32 v173, v173
    v_mul_f32 v116, v255, v116
    v_mfma_f32_16x16x16_f16 v[150:153], v[124:125], v[122:123], v[150:153]
    v_cvt_pk_bf16_f32 v171, v172, v173
    v_exp_f32 v186, v186
    v_mfma_f32_16x16x16_f16 v[190:193], v[176:177], v[122:123], v[190:193]
    v_exp_f32 v187, v187
    v_exp_f32 v188, v188
    v_mfma_f32_16x16x32_bf16 v[178:181], a[216:219], v[182:185], 0
    s_cmp_ge_u32 s80, 72
    v_exp_f32 v130, v130
    v_mfma_f32_16x16x32_bf16 v[178:181], a[220:223], v[226:229], v[178:181]
    s_cselect_b32 s80, s22, 0
    v_exp_f32 v131, v131
    v_mfma_f32_16x16x32_bf16 v[178:181], a[224:227], v[234:237], v[178:181]
    s_add_u32 s78, s78, s80
    v_cvt_pk_bf16_f32 v194, v130, v131
    v_cvt_pk_bf16_f32 v172, v186, v187
    v_mfma_f32_16x16x32_bf16 v[178:181], a[228:231], v[238:241], v[178:181]
    s_add_u32 s80, s77, 20
    v_exp_f32 v132, v132
    v_mfma_f32_16x16x32_bf16 v[178:181], a[232:235], v[242:245], v[178:181]
    s_add_u32 s34, s18, 3
    v_exp_f32 v133, v133
    v_mfma_f32_16x16x32_bf16 v[178:181], a[236:239], v[246:249], v[178:181]
    s_cmp_lt_u32 s77, s62
    v_cvt_pk_bf16_f32 v195, v132, v133
    v_mul_f32 v117, v255, v117
    v_mfma_f32_16x16x32_bf16 v[198:201], a[240:243], v[182:185], 0
    s_cselect_b32 s79, 1, 0
    v_exp_f32 v150, v150
    v_mfma_f32_16x16x32_f16 v[202:205], v[146:149], v[154:157], v[70:73]
    s_cselect_b32 s78, s78, 0
    v_exp_f32 v151, v151
    v_mfma_f32_16x16x32_f16 v[146:149], v[166:169], v[154:157], v[74:77]
    s_cmp_lt_u32 s34, s17
    v_cvt_pk_bf16_f32 v196, v150, v151
    v_cvt_pk_bf16_f32 v119, v116, v117
    v_mfma_f32_16x16x32_f16 v[166:169], v[158:161], v[154:157], v[78:81]
    buffer_store_dwordx2 v[118:119], v19, s[12:15], 0 offen nt
    v_exp_f32 v152, v152
    v_mfma_f32_16x16x16_f16 v[202:205], v[120:121], v[174:175], v[202:205]
    v_exp_f32 v153, v153
    v_fma_f32 v254, v178, v178, s33
    v_mfma_f32_16x16x16_f16 v[146:149], v[124:125], v[174:175], v[146:149]
    v_cvt_pk_bf16_f32 v197, v152, v153
    v_exp_f32 v190, v190
    v_mfma_f32_16x16x16_f16 v[166:169], v[176:177], v[174:175], v[166:169]
    v_exp_f32 v191, v191
    v_exp_f32 v192, v192
    v_mfma_f32_16x16x32_bf16 v[198:201], a[244:247], v[226:229], v[198:201]
    s_cselect_b32 s23, s23, s78
    v_exp_f32 v193, v193
    v_mfma_f32_16x16x32_bf16 v[198:201], a[248:251], v[234:237], v[198:201]
    s_cselect_b32 s73, s34, s80
    ds_read_b128 v[118:121], v2 offset:6144
    v_fmac_f32 v254, v179, v179
    v_mfma_f32_16x16x32_bf16 v[198:201], a[252:255], v[238:241], v[198:201]
    s_cselect_b32 s79, 0, s79
    ds_read_b128 v[122:125], v2 offset:7168
    v_fmac_f32 v254, v180, v180
    v_mfma_f32_16x16x32_bf16 v[198:201], v[82:85], v[242:245], v[198:201]
    s_cselect_b32 s81, 0, 1
    ds_read_b128 v[150:153], v2 offset:8192
    v_fmac_f32 v254, v181, v181
    v_mfma_f32_16x16x32_bf16 v[198:201], v[86:89], v[246:249], v[198:201]
    s_add_u32 s80, s77, 1
    ds_read_b128 v[154:157], v2 offset:9216
    v_xor_b32 v0, 65536, v0
    v_mfma_f32_16x16x32_bf16 v[206:209], v[90:93], v[182:185], 0
    s_mul_i32 s80, s80, s81
    ds_read_b128 v[158:161], v2 offset:10240
    v_xor_b32 v1, 65536, v1
    v_mfma_f32_16x16x32_bf16 v[206:209], v[94:97], v[226:229], v[206:209]
    s_cmp_lt_u32 s80, s62
    ds_read_b128 v[174:177], v2 offset:11264
    v_fmac_f32 v254, v198, v198
    v_mfma_f32_16x16x32_bf16 v[206:209], v[98:101], v[234:237], v[206:209]
    s_cselect_b32 s62, s62, 0
    v_exp_f32 v189, v189
    v_mfma_f32_16x16x32_bf16 v[206:209], v[102:105], v[238:241], v[206:209]
    s_add_u32 s80, s18, 4
    v_cvt_pk_bf16_f32 v173, v188, v189
    v_fmac_f32 v254, v199, v199
    v_mfma_f32_16x16x32_bf16 v[206:209], v[106:109], v[242:245], v[206:209]
    s_waitcnt lgkmcnt(5)
    v_exp_f32 v126, v126
    v_mfma_f32_16x16x32_bf16 v[206:209], v[110:113], v[246:249], v[206:209]
    s_cmp_ge_u32 s80, s17
    v_exp_f32 v127, v127
    v_mfma_f32_16x16x32_bf16 v[130:133], a[216:219], v[118:121], 0
    s_waitcnt lgkmcnt(3)
    v_cvt_pk_bf16_f32 v36, v126, v127
    v_fmac_f32 v254, v200, v200
    v_mfma_f32_16x16x32_bf16 v[130:133], a[220:223], v[122:125], v[130:133]
    s_cselect_b32 s66, s62, 0
    v_exp_f32 v128, v128
    v_mfma_f32_16x16x32_bf16 v[130:133], a[224:227], v[150:153], v[130:133]
    s_waitcnt lgkmcnt(1)
    v_fmac_f32 v254, v201, v201
    v_mfma_f32_16x16x32_bf16 v[130:133], a[228:231], v[154:157], v[130:133]
    s_lshl_b32 s80, s79, s73
    v_exp_f32 v129, v129
    v_mfma_f32_16x16x32_bf16 v[130:133], a[232:235], v[158:161], v[130:133]
    s_waitcnt lgkmcnt(0)
    v_cvt_pk_bf16_f32 v37, v128, v129
    v_fmac_f32 v254, v206, v206
    v_mfma_f32_16x16x32_bf16 v[130:133], a[236:239], v[174:177], v[130:133]
    s_or_b32 s70, s70, s80
    v_exp_f32 v202, v202
    v_mfma_f32_16x16x32_bf16 v[182:185], v[28:31], v[36:39], 0
    s_add_u32 s45, s45, s79
    v_exp_f32 v203, v203
    v_mfma_f32_16x16x32_bf16 v[182:185], v[28:31], v[170:173], v[182:185]
    s_add_u32 s18, s18, 1
    v_cvt_pk_bf16_f32 v186, v202, v203
    v_fma_f32 v255, v130, v130, s33
    v_mfma_f32_16x16x32_bf16 v[214:217], v[162:165], v[36:39], 0
    s_cmp_lt_u32 s18, s45
    v_fmac_f32 v255, v131, v131
    v_fmac_f32 v255, v132, v132
    v_mfma_f32_16x16x32_bf16 v[214:217], v[134:137], v[170:173], v[214:217]
    v_fmac_f32 v255, v133, v133
    v_fmac_f32 v254, v207, v207
    v_mfma_f32_16x16x32_bf16 v[222:225], v[210:213], v[36:39], 0
    v_exp_f32 v204, v204
    v_mfma_f32_16x16x32_bf16 v[222:225], v[138:141], v[170:173], v[222:225]
    v_exp_f32 v205, v205
    v_mfma_f32_16x16x32_bf16 v[226:229], v[218:221], v[36:39], 0
    v_cvt_pk_bf16_f32 v36, v190, v191
    v_cvt_pk_bf16_f32 v37, v192, v193
    v_mfma_f32_16x16x32_bf16 v[226:229], v[142:145], v[170:173], v[226:229]
    v_cvt_pk_bf16_f32 v39, v232, 0
    v_cvt_pk_bf16_f32 v187, v204, v205
    v_mfma_f32_16x16x32_bf16 v[126:129], a[240:243], v[118:121], 0
    v_exp_f32 v146, v146
    v_mfma_f32_16x16x32_bf16 v[170:173], v[28:31], v[36:39], 0
    v_exp_f32 v147, v147
    v_mfma_f32_16x16x32_bf16 v[170:173], v[28:31], v[194:197], v[170:173]
    v_cvt_pk_bf16_f32 v188, v146, v147
    v_fmac_f32 v254, v208, v208
    v_mfma_f32_16x16x32_bf16 v[114:117], v[162:165], v[36:39], 0
    v_exp_f32 v148, v148
    v_mfma_f32_16x16x32_bf16 v[114:117], v[134:137], v[194:197], v[114:117]
    v_exp_f32 v149, v149
    v_mfma_f32_16x16x32_bf16 v[190:193], v[210:213], v[36:39], 0
    v_cvt_pk_bf16_f32 v189, v148, v149
    v_fmac_f32 v254, v209, v209
    v_mfma_f32_16x16x32_bf16 v[190:193], v[138:141], v[194:197], v[190:193]
    v_rcp_f32 v170, v170
    v_mfma_f32_16x16x32_bf16 v[146:149], v[218:221], v[36:39], 0
    v_exp_f32 v166, v166
    v_mfma_f32_16x16x32_bf16 v[146:149], v[142:145], v[194:197], v[146:149]
    v_mul_f32 v114, v170, v114
    v_mul_f32 v115, v170, v115
    v_mfma_f32_16x16x32_bf16 v[126:129], a[244:247], v[122:125], v[126:129]
    v_cvt_pk_bf16_f32 v194, v114, v115
    v_mul_f32 v116, v170, v116
    v_mfma_f32_16x16x32_bf16 v[126:129], a[248:251], v[150:153], v[126:129]
    ds_read_b128 v[202:205], v2 offset:12288
    v_mul_f32 v117, v170, v117
    v_mfma_f32_16x16x32_bf16 v[126:129], a[252:255], v[154:157], v[126:129]
    ds_read_b128 v[230:233], v2 offset:13312
    v_cvt_pk_bf16_f32 v195, v116, v117
    v_mfma_f32_16x16x32_bf16 v[126:129], v[82:85], v[158:161], v[126:129]
    ds_read_b128 v[234:237], v2 offset:14336
    v_mul_f32 v190, v170, v190
    v_mfma_f32_16x16x32_bf16 v[126:129], v[86:89], v[174:177], v[126:129]
    ds_read_b128 v[238:241], v2 offset:15360
    v_mul_f32 v191, v170, v191
    v_mfma_f32_16x16x32_bf16 v[114:117], v[90:93], v[118:121], 0
    ds_read_b128 v[118:121], v2 offset:16384
    v_cvt_pk_bf16_f32 v196, v190, v191
    v_mfma_f32_16x16x32_bf16 v[114:117], v[94:97], v[122:125], v[114:117]
    ds_read_b128 v[122:125], v2 offset:17408
    v_mul_f32 v192, v170, v192
    v_mfma_f32_16x16x32_bf16 v[114:117], v[98:101], v[150:153], v[114:117]
    v_fmac_f32 v255, v126, v126
    v_fmac_f32 v255, v127, v127
    v_mfma_f32_16x16x32_bf16 v[114:117], v[102:105], v[154:157], v[114:117]
    v_fmac_f32 v255, v128, v128
    v_fmac_f32 v255, v129, v129
    v_mfma_f32_16x16x32_bf16 v[114:117], v[106:109], v[158:161], v[114:117]
    s_waitcnt lgkmcnt(5)
    v_mul_f32 v193, v170, v193
    v_cvt_pk_bf16_f32 v197, v192, v193
    v_mfma_f32_16x16x32_bf16 v[114:117], v[110:113], v[174:177], v[114:117]
    s_waitcnt lgkmcnt(4)
    ds_write_b128 v3, v[194:197] offset:6144
    v_mfma_f32_16x16x32_bf16 v[242:245], a[216:219], v[202:205], 0
    s_waitcnt lgkmcnt(3)
    v_mul_f32 v146, v170, v146
    v_mul_f32 v147, v170, v147
    v_mfma_f32_16x16x32_bf16 v[242:245], a[220:223], v[230:233], v[242:245]
    s_waitcnt lgkmcnt(2)
    v_fmac_f32 v255, v114, v114
    v_fmac_f32 v255, v115, v115
    v_mfma_f32_16x16x32_bf16 v[242:245], a[224:227], v[234:237], v[242:245]
    s_waitcnt lgkmcnt(1)
    v_fmac_f32 v255, v116, v116
    v_fmac_f32 v255, v117, v117
    v_mfma_f32_16x16x32_bf16 v[242:245], a[228:231], v[238:241], v[242:245]
    v_cvt_pk_bf16_f32 v254, v254, v255
    v_cvt_pk_bf16_f32 v172, v146, v147
    v_mfma_f32_16x16x32_bf16 v[242:245], a[232:235], v[118:121], v[242:245]
    v_mul_f32 v148, v170, v148
    v_mul_f32 v149, v170, v149
    v_mfma_f32_16x16x32_bf16 v[242:245], a[236:239], v[122:125], v[242:245]
    v_cvt_pk_bf16_f32 v173, v148, v149
    v_cvt_pk_bf16_f32 v39, v252, 0
    v_mfma_f32_16x16x32_bf16 v[158:161], a[240:243], v[202:205], 0
    ds_write_b64 v4, v[172:173] offset:10240
    v_mfma_f32_16x16x32_bf16 v[158:161], a[244:247], v[230:233], v[158:161]
    v_exp_f32 v167, v167
    v_mfma_f32_16x16x32_bf16 v[158:161], a[248:251], v[234:237], v[158:161]
    v_cvt_pk_bf16_f32 v36, v166, v167
    v_fma_f32 v255, v242, v242, s33
    v_mfma_f32_16x16x32_bf16 v[158:161], a[252:255], v[238:241], v[158:161]
    v_fmac_f32 v255, v243, v243
    v_fmac_f32 v255, v244, v244
    v_mfma_f32_16x16x32_bf16 v[158:161], v[82:85], v[118:121], v[158:161]
    v_fmac_f32 v255, v245, v245
    v_xor_b32 v2, 65536, v2
    v_mfma_f32_16x16x32_bf16 v[158:161], v[86:89], v[122:125], v[158:161]
    v_exp_f32 v168, v168
    v_mfma_f32_16x16x32_bf16 v[154:157], v[90:93], v[202:205], 0
    v_exp_f32 v169, v169
    v_mfma_f32_16x16x32_bf16 v[154:157], v[94:97], v[230:233], v[154:157]
    ds_read_b128 v[146:149], v9
    v_cvt_pk_bf16_f32 v37, v168, v169
    v_mfma_f32_16x16x32_bf16 v[154:157], v[98:101], v[234:237], v[154:157]
    ds_read_b128 v[150:153], v9 offset:64
    v_fmac_f32 v255, v158, v158
    v_mfma_f32_16x16x32_bf16 v[166:169], v[28:31], v[36:39], 0
    v_fmac_f32 v255, v159, v159
    v_fmac_f32 v255, v160, v160
    v_mfma_f32_16x16x32_bf16 v[166:169], v[28:31], v[186:189], v[166:169]
    v_fmac_f32 v255, v161, v161
    v_add_u32 v6, s75, v6
    v_mfma_f32_16x16x32_bf16 v[174:177], v[162:165], v[36:39], 0
    v_rcp_f32 v182, v182
    v_mfma_f32_16x16x32_bf16 v[174:177], v[134:137], v[186:189], v[174:177]
    v_max3_u32 v25, v25, v182, v183
    v_max3_u32 v25, v25, v170, v171
    v_mfma_f32_16x16x32_bf16 v[170:173], v[210:213], v[36:39], 0
    v_rcp_f32 v166, v166
    v_mfma_f32_16x16x32_bf16 v[170:173], v[138:141], v[186:189], v[170:173]
    v_max3_u32 v25, v25, v166, v167
    v_mul_f32 v214, v182, v214
    v_mfma_f32_16x16x32_bf16 v[190:193], v[218:221], v[36:39], 0
    s_waitcnt lgkmcnt(1)
    v_mul_f32 v174, v166, v174
    v_mul_f32 v175, v166, v175
    v_mfma_f32_16x16x32_bf16 v[190:193], v[142:145], v[186:189], v[190:193]
    s_waitcnt lgkmcnt(0)
    v_cvt_pk_bf16_f32 v174, v174, v175
    v_mul_f32 v176, v166, v176
    v_mfma_f32_16x16x32_bf16 v[154:157], v[102:105], v[238:241], v[154:157]
    ds_read_b128 v[186:189], v0 offset:20480
    v_mul_f32 v177, v166, v177
    v_mfma_f32_16x16x32_bf16 v[154:157], v[106:109], v[118:121], v[154:157]
    ds_read_b128 v[194:197], v1 offset:20480
    v_cvt_pk_bf16_f32 v175, v176, v177
    v_mfma_f32_16x16x32_bf16 v[154:157], v[110:113], v[122:125], v[154:157]
    ds_read_b128 v[122:125], v0 offset:20608
    v_mul_f32 v170, v166, v170
    v_mfma_f32_16x16x32_bf16 v[118:121], v[146:149], v[28:31], 0
    ds_read_b128 v[202:205], v1 offset:20608
    v_mul_f32 v171, v166, v171
    v_mfma_f32_16x16x32_bf16 v[118:121], v[150:153], v[28:31], v[118:121]
    ds_read_b128 v[230:233], v0 offset:20736
    v_cvt_pk_bf16_f32 v176, v170, v171
    v_mfma_f32_16x16x32_bf16 v[234:237], v[146:149], v[134:137], 0
    ds_read_b128 v[238:241], v1 offset:20736
    v_fmac_f32 v255, v154, v154
    v_mfma_f32_16x16x32_bf16 v[234:237], v[150:153], v[162:165], v[234:237]
    v_fmac_f32 v255, v155, v155
    v_fmac_f32 v255, v156, v156
    v_mfma_f32_16x16x32_bf16 v[134:137], v[146:149], v[138:141], 0
    v_fmac_f32 v255, v157, v157
    v_cvt_pk_bf16_f32 v255, v255, v255
    v_mfma_f32_16x16x32_bf16 v[134:137], v[150:153], v[210:213], v[134:137]
    s_waitcnt lgkmcnt(5)
    ds_write_b64 v4, v[254:255] offset:18432
    v_mfma_f32_16x16x32_bf16 v[138:141], v[146:149], v[142:145], 0
    s_waitcnt lgkmcnt(4)
    v_mul_f32 v172, v166, v172
    v_mul_f32 v173, v166, v173
    v_mfma_f32_16x16x32_bf16 v[138:141], v[150:153], v[218:221], v[138:141]
    s_waitcnt lgkmcnt(3)
    v_cvt_pk_bf16_f32 v177, v172, v173
    v_mul_f32 v190, v166, v190
    v_mfma_f32_16x16x32_bf16 v[142:145], a[72:75], v[186:189], 0
    s_waitcnt lgkmcnt(2)
    ds_write_b128 v3, v[174:177] offset:12288
    v_mfma_f32_16x16x32_bf16 v[142:145], a[76:79], v[194:197], v[142:145]
    s_waitcnt lgkmcnt(2)
    v_mul_f32 v191, v166, v191
    v_cvt_pk_bf16_f32 v120, v190, v191
    v_mfma_f32_16x16x32_bf16 v[142:145], a[80:83], v[122:125], v[142:145]
    v_mul_f32 v192, v166, v192
    v_mul_f32 v193, v166, v193
    v_mfma_f32_16x16x32_bf16 v[142:145], a[84:87], v[202:205], v[142:145]
    v_cvt_pk_bf16_f32 v121, v192, v193
    v_mul_f32 v215, v182, v215
    v_mfma_f32_16x16x32_bf16 v[142:145], a[88:91], v[230:233], v[142:145]
    ds_write_b64 v4, v[120:121] offset:16384
    v_mfma_f32_16x16x32_bf16 v[142:145], a[92:95], v[238:241], v[142:145]
    v_rcp_f32 v118, v118
    v_mfma_f32_16x16x32_bf16 v[150:153], a[96:99], v[186:189], 0
    v_max3_u32 v25, v25, v118, v119
    v_mul_f32 v234, v234, v118
    v_mfma_f32_16x16x32_bf16 v[150:153], a[100:103], v[194:197], v[150:153]
    v_mul_f32_dpp v234, v134, v118 quad_perm:[0,1,2,3] row_mask:0x2 bank_mask:0xf
    v_mul_f32_dpp v234, v138, v118 quad_perm:[0,1,2,3] row_mask:0x4 bank_mask:0xf
    v_mfma_f32_16x16x32_bf16 v[150:153], a[104:107], v[122:125], v[150:153]
    v_cvt_pk_bf16_f32 v234, v234, v234
    v_cvt_pk_bf16_f32 v118, v214, v215
    v_mfma_f32_16x16x32_bf16 v[150:153], a[108:111], v[202:205], v[150:153]
    ds_write_b16 v7, v234
    v_mfma_f32_16x16x32_bf16 v[150:153], a[112:115], v[230:233], v[150:153]
    v_mul_f32 v216, v182, v216
    v_mul_f32 v217, v182, v217
    v_mfma_f32_16x16x32_bf16 v[150:153], a[116:119], v[238:241], v[150:153]
    v_cvt_pk_bf16_f32 v119, v216, v217
    v_mul_f32 v222, v182, v222
    v_mfma_f32_16x16x32_bf16 v[134:137], a[120:123], v[186:189], 0
    v_mul_f32 v223, v182, v223
    v_cvt_pk_bf16_f32 v120, v222, v223
    v_mfma_f32_16x16x32_bf16 v[134:137], a[124:127], v[194:197], v[134:137]
    v_mul_f32 v224, v182, v224
    v_mul_f32 v225, v182, v225
    v_mfma_f32_16x16x32_bf16 v[134:137], a[128:131], v[122:125], v[134:137]
    v_cvt_pk_bf16_f32 v121, v224, v225
    v_mul_f32 v226, v182, v226
    v_mfma_f32_16x16x32_bf16 v[134:137], a[132:135], v[202:205], v[134:137]
    ds_write_b128 v3, v[118:121] offset:0
    v_mfma_f32_16x16x32_bf16 v[134:137], a[136:139], v[230:233], v[134:137]
    v_mul_f32 v227, v182, v227
    v_cvt_pk_bf16_f32 v254, v226, v227
    v_mfma_f32_16x16x32_bf16 v[134:137], a[140:143], v[238:241], v[134:137]
    v_mul_f32 v228, v182, v228
    v_mul_f32 v229, v182, v229
    v_mfma_f32_16x16x32_bf16 v[138:141], a[0:3], v[186:189], 0
    v_cvt_pk_bf16_f32 v255, v228, v229
    v_xor_b32 v3, 65536, v3
    v_mfma_f32_16x16x32_bf16 v[138:141], a[4:7], v[194:197], v[138:141]
    ds_write_b64 v4, v[254:255] offset:4096
    v_mfma_f32_16x16x32_bf16 v[138:141], a[8:11], v[122:125], v[138:141]
    v_xor_b32 v4, 65536, v4
    v_add_u32 v7, s76, v7
    v_mfma_f32_16x16x32_bf16 v[138:141], a[12:15], v[202:205], v[138:141]
    v_cvt_pk_f16_f32 v146, v142, v143
    v_pk_mul_f16 v143, v146, v146
    v_mfma_f32_16x16x32_bf16 v[138:141], a[16:19], v[230:233], v[138:141]
    v_cvt_pk_f16_f32 v147, v144, v145
    v_pk_fma_f16 v143, v147, v147, v143
    v_mfma_f32_16x16x32_bf16 v[138:141], a[20:23], v[238:241], v[138:141]
    v_cvt_pk_f16_f32 v148, v150, v151
    v_pk_fma_f16 v143, v148, v148, v143
    v_mfma_f32_16x16x32_bf16 v[166:169], a[24:27], v[186:189], 0
    v_cvt_pk_f16_f32 v149, v152, v153
    v_pk_fma_f16 v143, v149, v149, v143
    v_mfma_f32_16x16x32_bf16 v[166:169], a[28:31], v[194:197], v[166:169]
    v_cvt_pk_f16_f32 v120, v134, v135
    v_pk_fma_f16 v143, v120, v120, v143
    v_mfma_f32_16x16x32_bf16 v[166:169], a[32:35], v[122:125], v[166:169]
    s_waitcnt lgkmcnt(0)
    v_cvt_pk_f16_f32 v121, v136, v137
    v_pk_fma_f16 v143, v121, v121, v143
    v_mfma_f32_16x16x32_bf16 v[166:169], a[36:39], v[202:205], v[166:169]
    s_nop 0
    v_mfma_f32_16x16x32_bf16 v[166:169], a[40:43], v[230:233], v[166:169]
    s_nop 0
    v_mfma_f32_16x16x32_bf16 v[166:169], a[44:47], v[238:241], v[166:169]
    s_nop 0
    v_mfma_f32_16x16x32_bf16 v[134:137], a[48:51], v[186:189], 0
    s_barrier
    v_mfma_f32_16x16x32_bf16 v[134:137], a[52:55], v[194:197], v[134:137]
    s_cbranch_scc1 L_loop_fast3
L_final_fast:
    v_mfma_f32_16x16x32_bf16 v[134:137], a[56:59], v[122:125], v[134:137]
    s_mov_b32 s12, s40
    ds_read_b128 v[170:173], v2 offset:18432
    ds_read_b128 v[150:153], v2 offset:19456
    v_mfma_f32_16x16x32_bf16 v[134:137], a[60:63], v[202:205], v[134:137]
    s_mov_b32 s13, s41
    ds_read_b128 v[174:177], v5 offset:32
    ds_read2_b64 v[162:165], v5 offset0:6 offset1:9
    v_mfma_f32_16x16x32_bf16 v[134:137], a[64:67], v[230:233], v[134:137]
    s_mov_b32 s14, s36
    v_cvt_pk_f16_f32 v138, v138, v139
    v_pk_mul_f16 v142, v138, v138
    v_mfma_f32_16x16x32_bf16 v[134:137], a[68:71], v[238:241], v[134:137]
    s_add_u32 s48, s40, s27
    ds_read_b128 v[182:185], v5
    ds_read_b32 v254, v6 offset:192
    v_mfma_f32_16x16x32_bf16 v[190:193], v[186:189], a[144:147], 0
    s_addc_u32 s49, s41, 0
    v_cvt_pk_f16_f32 v139, v140, v141
    v_pk_fma_f16 v142, v139, v139, v142
    v_mfma_f32_16x16x32_bf16 v[190:193], v[194:197], a[148:151], v[190:193]
    s_sub_u32 s50, s36, s27
    v_cvt_pk_f16_f32 v140, v166, v167
    v_pk_fma_f16 v142, v140, v140, v142
    v_mfma_f32_16x16x32_bf16 v[190:193], v[122:125], a[152:155], v[190:193]
    s_mov_b32 s51, 0x00020000
    v_cvt_pk_f16_f32 v141, v168, v169
    v_pk_fma_f16 v142, v141, v141, v142
    v_mfma_f32_16x16x32_bf16 v[190:193], v[202:205], a[156:159], v[190:193]
    s_waitcnt lgkmcnt(4)
    v_cvt_pk_f16_f32 v118, v134, v135
    v_pk_fma_f16 v142, v118, v118, v142
    v_mfma_f32_16x16x32_bf16 v[166:169], v[32:35], v[170:173], 0
    s_waitcnt lgkmcnt(2)
    v_cvt_pk_f16_f32 v119, v136, v137
    v_pk_fma_f16 v142, v119, v119, v142
    v_mfma_f32_16x16x32_bf16 v[166:169], v[32:35], v[150:153], v[166:169]
    s_add_u32 s52, s40, s26
    v_pk_mul_f16 v145, v146, v174
    v_pk_fma_f16 v145, v147, v175, v145
    v_mfma_f32_16x16x32_bf16 v[190:193], v[230:233], a[160:163], v[190:193]
    s_waitcnt lgkmcnt(0)
    v_mov_b32_dpp v254, v23 quad_perm:[0,1,2,3] row_mask:0x7 bank_mask:0xf
    v_pk_fma_f16 v145, v148, v176, v145
    v_mfma_f32_16x16x32_bf16 v[190:193], v[238:241], a[164:167], v[190:193]
    s_addc_u32 s53, s41, 0
    v_mul_f32 v144, 0x3baaaaab, v167
    v_mul_f32 v255, 0x3baaaaab, v166
    v_mfma_f32_16x16x32_bf16 v[134:137], v[186:189], a[168:171], 0
    s_sub_u32 s54, s36, s26
    v_rsq_f32 v144, v144
    v_mfma_f32_16x16x32_bf16 v[134:137], v[194:197], a[172:175], v[134:137]
    s_mov_b32 s55, 0x00020000
    v_mul_f32 v130, v144, v130
    v_mul_f32 v131, v144, v131
    v_mfma_f32_16x16x32_bf16 v[134:137], v[122:125], a[176:179], v[134:137]
    s_add_u32 s56, s40, s25
    v_cvt_pk_bf16_f32 v130, v130, v131
    v_mul_f32 v132, v144, v132
    v_mfma_f32_16x16x32_bf16 v[134:137], v[202:205], a[180:183], v[134:137]
    s_addc_u32 s57, s41, 0
    v_mul_f32 v133, v144, v133
    v_cvt_pk_bf16_f32 v131, v132, v133
    v_mfma_f32_16x16x32_bf16 v[134:137], v[230:233], a[184:187], v[134:137]
    s_sub_u32 s58, s36, s25
    ds_read_b128 v[210:213], v0 offset:26624
    v_mul_f32 v126, v144, v126
    v_mfma_f32_16x16x32_bf16 v[134:137], v[238:241], a[188:191], v[134:137]
    s_mov_b32 s59, 0x00020000
    ds_read_b128 v[214:217], v1 offset:26624
    v_mul_f32 v127, v144, v127
    v_mfma_f32_16x16x32_bf16 v[218:221], v[186:189], a[192:195], 0
    s_and_b32 s6, s2, 7
    ds_read_b128 v[170:173], v0 offset:26752
    v_cvt_pk_bf16_f32 v132, v126, v127
    v_mfma_f32_16x16x32_bf16 v[218:221], v[194:197], a[196:199], v[218:221]
    s_sub_u32 s6, 0, s6
    ds_read_b128 v[150:153], v1 offset:26752
    v_mul_f32 v128, v144, v128
    v_mfma_f32_16x16x32_bf16 v[218:221], v[122:125], a[200:203], v[218:221]
    s_lshl_b32 s3, s16, 6
    ds_read_b128 v[186:189], v0 offset:26880
    v_mul_f32 v129, v144, v129
    v_mfma_f32_16x16x32_bf16 v[218:221], v[202:205], a[204:207], v[218:221]
    s_lshl_b32 s4, s16, 5
    ds_read_b128 v[122:125], v1 offset:26880
    v_cvt_pk_bf16_f32 v133, v128, v129
    v_mfma_f32_16x16x32_bf16 v[218:221], v[230:233], a[208:211], v[218:221]
    buffer_store_dwordx4 v[130:133], v16, s[48:51], 0 offen nt
    v_mul_f32 v114, v144, v114
    v_mul_f32 v115, v144, v115
    v_cvt_pk_bf16_f32 v166, v114, v115
    v_mul_f32 v116, v144, v116
    v_mfma_f32_16x16x32_bf16 v[218:221], v[238:241], a[212:215], v[218:221]
    s_waitcnt lgkmcnt(4)
    v_mul_f32 v117, v144, v117
    v_cvt_pk_bf16_f32 v167, v116, v117
    v_mfma_f32_16x16x32_bf16 v[130:133], a[72:75], v[210:213], 0
    s_add_u32 s4, s4, 256
    ds_read_b128 v[194:197], v2 offset:0
    ds_read_b128 v[222:225], v2 offset:1024
    v_mfma_f32_16x16x32_bf16 v[130:133], a[76:79], v[214:217], v[130:133]
    s_waitcnt lgkmcnt(4)
    ds_read_b128 v[202:205], v2 offset:2048
    ds_read_b128 v[114:117], v2 offset:3072
    v_mfma_f32_16x16x32_bf16 v[130:133], a[80:83], v[170:173], v[130:133]
    s_mul_i32 s5, s16, 9408
    v_rsq_f32 v255, v255
    v_mfma_f32_16x16x32_bf16 v[130:133], a[84:87], v[150:153], v[130:133]
    s_waitcnt lgkmcnt(4)
    ds_read_b128 v[226:229], v2 offset:4096
    ds_read_b128 v[126:129], v2 offset:5120
    v_mfma_f32_16x16x32_bf16 v[130:133], a[88:91], v[186:189], v[130:133]
    s_add_u32 s5, s5, 104448
    v_mul_f32 v178, v255, v178
    v_mul_f32 v179, v255, v179
    v_mfma_f32_16x16x32_bf16 v[130:133], a[92:95], v[122:125], v[130:133]
    v_cvt_pk_bf16_f32 v230, v178, v179
    v_mul_f32 v180, v255, v180
    v_mfma_f32_16x16x32_bf16 v[234:237], a[96:99], v[210:213], 0
    v_mul_f32 v181, v255, v181
    v_cvt_pk_bf16_f32 v231, v180, v181
    v_mfma_f32_16x16x32_bf16 v[234:237], a[100:103], v[214:217], v[234:237]
    s_waitcnt lgkmcnt(4)
    v_mul_f32 v198, v255, v198
    v_mul_f32 v199, v255, v199
    v_mfma_f32_16x16x32_bf16 v[178:181], a[216:219], v[194:197], 0
    s_waitcnt lgkmcnt(2)
    v_cvt_pk_bf16_f32 v232, v198, v199
    v_mul_f32 v200, v255, v200
    v_mfma_f32_16x16x32_bf16 v[178:181], a[220:223], v[222:225], v[178:181]
    v_mul_f32 v201, v255, v201
    v_cvt_pk_bf16_f32 v233, v200, v201
    v_mfma_f32_16x16x32_bf16 v[178:181], a[224:227], v[202:205], v[178:181]
    s_waitcnt lgkmcnt(0)
    v_mul_f32 v206, v255, v206
    v_mul_f32 v207, v255, v207
    v_mfma_f32_16x16x32_bf16 v[178:181], a[228:231], v[114:117], v[178:181]
    v_cvt_pk_bf16_f32 v206, v206, v207
    v_mul_f32 v208, v255, v208
    v_mfma_f32_16x16x32_bf16 v[178:181], a[232:235], v[226:229], v[178:181]
    v_mul_f32 v209, v255, v209
    v_cvt_pk_bf16_f32 v207, v208, v209
    v_mfma_f32_16x16x32_bf16 v[178:181], a[236:239], v[126:129], v[178:181]
    v_pk_fma_f16 v145, v149, v177, v145
    v_pk_fma_f16 v145, v120, v164, v145
    v_mfma_f32_16x16x32_bf16 v[198:201], a[240:243], v[194:197], 0
    buffer_store_dwordx2 v[166:167], v19, s[48:51], 0 offen nt
    v_pk_fma_f16 v145, v121, v165, v145
    v_pk_mul_f16 v144, v138, v182
    v_mfma_f32_16x16x32_bf16 v[198:201], a[244:247], v[222:225], v[198:201]
    v_pk_fma_f16 v144, v139, v183, v144
    v_fma_f32 v255, v178, v178, s33
    v_mfma_f32_16x16x32_bf16 v[198:201], a[248:251], v[202:205], v[198:201]
    v_fmac_f32 v255, v179, v179
    v_fmac_f32 v255, v180, v180
    v_mfma_f32_16x16x32_bf16 v[198:201], a[252:255], v[114:117], v[198:201]
    v_fmac_f32 v255, v181, v181
    v_pk_fma_f16 v144, v140, v184, v144
    v_mfma_f32_16x16x32_bf16 v[198:201], v[82:85], v[226:229], v[198:201]
    v_pk_fma_f16 v144, v141, v185, v144
    v_pk_fma_f16 v144, v118, v162, v144
    v_mfma_f32_16x16x32_bf16 v[198:201], v[86:89], v[126:129], v[198:201]
    v_pk_fma_f16 v144, v119, v163, v144
    v_cvt_pk_bf16_f32 v166, v190, v191
    v_mfma_f32_16x16x32_bf16 v[234:237], a[104:107], v[170:173], v[234:237]
    v_cvt_pk_bf16_f32 v167, v192, v193
    v_cvt_pk_bf16_f32 v134, v134, v135
    v_mfma_f32_16x16x32_f16 v[238:241], v[40:43], v[142:145], 0
    v_cvt_pk_bf16_f32 v135, v136, v137
    v_cvt_pk_bf16_f32 v218, v218, v219
    v_mfma_f32_16x16x32_bf16 v[190:193], v[90:93], v[194:197], 0
    ds_read_b128 v[194:197], v2 offset:6144
    v_fmac_f32 v255, v198, v198
    v_mfma_f32_16x16x32_bf16 v[190:193], v[94:97], v[222:225], v[190:193]
    ds_read_b128 v[142:145], v2 offset:7168
    v_fmac_f32 v255, v199, v199
    v_mfma_f32_16x16x32_bf16 v[190:193], v[98:101], v[202:205], v[190:193]
    ds_read_b128 v[202:205], v2 offset:8192
    v_fmac_f32 v255, v200, v200
    v_mfma_f32_16x16x32_bf16 v[190:193], v[102:105], v[114:117], v[190:193]
    ds_read_b128 v[114:117], v2 offset:9216
    v_fmac_f32 v255, v201, v201
    v_mfma_f32_16x16x32_bf16 v[190:193], v[106:109], v[226:229], v[190:193]
    ds_read_b128 v[222:225], v2 offset:10240
    v_cvt_pk_bf16_f32 v219, v220, v221
    v_mfma_f32_16x16x32_bf16 v[190:193], v[110:113], v[126:129], v[190:193]
    ds_read_b128 v[226:229], v2 offset:11264
    v_cvt_pk_f16_f32 v126, v130, v131
    v_mfma_f32_16x16x32_bf16 v[234:237], a[108:111], v[150:153], v[234:237]
    v_rsq_f32 v238, v238
    v_mfma_f32_16x16x32_bf16 v[234:237], a[112:115], v[186:189], v[234:237]
    s_waitcnt lgkmcnt(5)
    v_rsq_f32 v239, v239
    v_mfma_f32_16x16x32_bf16 v[246:249], a[216:219], v[194:197], 0
    s_waitcnt lgkmcnt(4)
    buffer_store_dwordx4 v[230:233], v15, s[48:51], 0 offen nt
    v_fmac_f32 v255, v190, v190
    v_fmac_f32 v255, v191, v191
    v_fmac_f32 v255, v192, v192
    v_fmac_f32 v255, v193, v193
    v_mfma_f32_16x16x32_bf16 v[246:249], a[220:223], v[142:145], v[246:249]
    s_waitcnt lgkmcnt(2)
    v_mul_f32 v130, s31, v238
    v_cvt_pk_f16_f32 v131, v130, v239
    v_mfma_f32_16x16x32_bf16 v[246:249], a[224:227], v[202:205], v[246:249]
    s_waitcnt lgkmcnt(1)
    v_fma_f32 v240, v240, v130, v22
    v_fmac_f32_dpp v254, v241, v239 quad_perm:[0,1,2,3] row_mask:0x1 bank_mask:0xf
    v_mfma_f32_16x16x32_bf16 v[246:249], a[228:231], v[114:117], v[246:249]
    s_waitcnt lgkmcnt(0)
    v_pk_mul_f16 v146, v146, v131 op_sel:[0,1] op_sel_hi:[1,1]
    v_pk_mul_f16 v147, v147, v131 op_sel:[0,1] op_sel_hi:[1,1]
    v_mfma_f32_16x16x32_bf16 v[246:249], a[232:235], v[222:225], v[246:249]
    v_pk_mul_f16 v148, v148, v131 op_sel:[0,1] op_sel_hi:[1,1]
    v_pk_mul_f16 v149, v149, v131 op_sel:[0,1] op_sel_hi:[1,1]
    v_mfma_f32_16x16x32_bf16 v[246:249], a[236:239], v[226:229], v[246:249]
    v_pk_mul_f16 v120, v120, v131 op_sel:[0,1] op_sel_hi:[1,1]
    v_pk_mul_f16 v121, v121, v131 op_sel:[0,1] op_sel_hi:[1,1]
    v_mfma_f32_16x16x32_bf16 v[230:233], a[240:243], v[194:197], 0
    v_pk_mul_f16 v138, v138, v131 op_sel:[0,0] op_sel_hi:[1,0]
    v_pk_mul_f16 v139, v139, v131 op_sel:[0,0] op_sel_hi:[1,0]
    v_mfma_f32_16x16x32_bf16 v[230:233], a[244:247], v[142:145], v[230:233]
    v_pk_mul_f16 v140, v140, v131 op_sel:[0,0] op_sel_hi:[1,0]
    v_pk_mul_f16 v141, v141, v131 op_sel:[0,0] op_sel_hi:[1,0]
    v_mfma_f32_16x16x32_bf16 v[230:233], a[248:251], v[202:205], v[230:233]
    v_pk_mul_f16 v118, v118, v131 op_sel:[0,0] op_sel_hi:[1,0]
    v_pk_mul_f16 v119, v119, v131 op_sel:[0,0] op_sel_hi:[1,0]
    v_mfma_f32_16x16x32_bf16 v[230:233], a[252:255], v[114:117], v[230:233]
    v_max3_u32 v44, v44, v238, v239
    v_pk_mul_f16 v131, v126, v126
    v_mfma_f32_16x16x32_bf16 v[230:233], v[82:85], v[222:225], v[230:233]
    v_cvt_pk_f16_f32 v127, v132, v133
    v_pk_fma_f16 v131, v127, v127, v131
    v_mfma_f32_16x16x32_bf16 v[230:233], v[86:89], v[226:229], v[230:233]
    v_pk_mul_f16 v133, v126, v174
    v_pk_fma_f16 v133, v127, v175, v133
    v_mfma_f32_16x16x32_bf16 v[234:237], a[116:119], v[122:125], v[234:237]
    v_fma_f32 v137, v246, v246, s33
    v_fmac_f32 v137, v247, v247
    v_fmac_f32 v137, v248, v248
    v_fmac_f32 v137, v249, v249
    v_mul_f32 v136, 0x3baaaaab, v168
    v_fmac_f32 v137, v230, v230
    v_fmac_f32 v137, v231, v231
    v_fmac_f32 v137, v232, v232
    v_cvt_pk_f16_f32 v128, v234, v235
    v_pk_fma_f16 v131, v128, v128, v131
    v_cvt_pk_f16_f32 v129, v236, v237
    buffer_store_dwordx2 v[206:207], v18, s[48:51], 0 offen nt
    v_pk_fma_f16 v131, v129, v129, v131
    v_pk_fma_f16 v133, v128, v176, v133
    v_mfma_f32_16x16x32_bf16 v[234:237], v[90:93], v[194:197], 0
    v_pk_fma_f16 v133, v129, v177, v133
    v_fmac_f32 v137, v233, v233
    v_mfma_f32_16x16x32_bf16 v[234:237], v[94:97], v[142:145], v[234:237]
    v_rsq_f32 v136, v136
    v_mfma_f32_16x16x32_bf16 v[234:237], v[98:101], v[202:205], v[234:237]
    v_mul_f32 v242, v136, v242
    v_mul_f32 v243, v136, v243
    v_mfma_f32_16x16x32_bf16 v[234:237], v[102:105], v[114:117], v[234:237]
    v_cvt_pk_bf16_f32 v114, v242, v243
    v_mul_f32 v244, v136, v244
    v_mfma_f32_16x16x32_bf16 v[234:237], v[106:109], v[222:225], v[234:237]
    v_mul_f32 v245, v136, v245
    v_cvt_pk_bf16_f32 v115, v244, v245
    v_mfma_f32_16x16x32_bf16 v[234:237], v[110:113], v[226:229], v[234:237]
    v_mul_f32 v158, v136, v158
    v_mul_f32 v159, v136, v159
    v_mfma_f32_16x16x32_bf16 v[194:197], a[120:123], v[210:213], 0
    v_cvt_pk_bf16_f32 v116, v158, v159
    v_mul_f32 v160, v136, v160
    v_mfma_f32_16x16x32_bf16 v[194:197], a[124:127], v[214:217], v[194:197]
    v_mul_f32 v161, v136, v161
    v_cvt_pk_bf16_f32 v117, v160, v161
    v_mfma_f32_16x16x32_bf16 v[194:197], a[128:131], v[170:173], v[194:197]
    v_fmac_f32 v137, v234, v234
    v_fmac_f32 v137, v235, v235
    v_mfma_f32_16x16x32_bf16 v[194:197], a[132:135], v[150:153], v[194:197]
    v_fmac_f32 v137, v236, v236
    v_fmac_f32 v137, v237, v237
    v_mfma_f32_16x16x32_bf16 v[194:197], a[136:139], v[186:189], v[194:197]
    v_cvt_pk_bf16_f32 v168, v255, v137
    v_cvt_pk_bf16_f32 v169, v137, v137
    v_mfma_f32_16x16x32_bf16 v[194:197], a[140:143], v[122:125], v[194:197]
    v_mul_f32 v154, v136, v154
    v_mul_f32 v155, v136, v155
    v_mfma_f32_16x16x32_bf16 v[142:145], a[0:3], v[210:213], 0
    v_cvt_pk_bf16_f32 v220, v154, v155
    v_mul_f32 v156, v136, v156
    v_mfma_f32_16x16x32_bf16 v[142:145], a[4:7], v[214:217], v[142:145]
    v_mul_f32 v157, v136, v157
    v_cvt_pk_bf16_f32 v221, v156, v157
    v_mfma_f32_16x16x32_bf16 v[142:145], a[8:11], v[170:173], v[142:145]
    v_cvt_pk_f16_f32 v156, v194, v195
    v_pk_fma_f16 v131, v156, v156, v131
    v_mfma_f32_16x16x32_bf16 v[142:145], a[12:15], v[150:153], v[142:145]
    buffer_store_dwordx4 v[114:117], v17, s[48:51], 0 offen nt
    v_cvt_pk_f16_f32 v157, v196, v197
    v_pk_fma_f16 v131, v157, v157, v131
    v_pk_fma_f16 v133, v156, v164, v133
    v_pk_fma_f16 v133, v157, v165, v133
    v_mfma_f32_16x16x32_bf16 v[142:145], a[16:19], v[186:189], v[142:145]
    v_mov_b32 v238, 0x40000000
    v_bfe_u32 v239, v2, 4, 6
    v_mfma_f32_16x16x32_bf16 v[142:145], a[20:23], v[122:125], v[142:145]
    v_lshrrev_b32 v255, 4, v239
    v_and_b32 v241, 15, v239
    v_mfma_f32_16x16x32_bf16 v[114:117], a[24:27], v[210:213], 0
    v_add_u32 v136, 0, v241
    v_mul_u32_u24 v137, s20, v136
    v_mfma_f32_16x16x32_bf16 v[114:117], a[28:31], v[214:217], v[114:117]
    v_add_u32 v137, s38, v137
    v_mul_u32_u24 v154, 911, v137
    v_mfma_f32_16x16x32_bf16 v[114:117], a[32:35], v[170:173], v[114:117]
    v_cvt_pk_f16_f32 v142, v142, v143
    v_pk_mul_f16 v130, v142, v142
    v_mfma_f32_16x16x32_bf16 v[114:117], a[36:39], v[150:153], v[114:117]
    v_cvt_pk_f16_f32 v143, v144, v145
    v_pk_fma_f16 v130, v143, v143, v130
    v_mfma_f32_16x16x32_bf16 v[114:117], a[40:43], v[186:189], v[114:117]
    v_pk_mul_f16 v132, v142, v182
    v_pk_fma_f16 v132, v143, v183, v132
    v_mfma_f32_16x16x32_bf16 v[114:117], a[44:47], v[122:125], v[114:117]
    v_lshrrev_b32 v154, 16, v154
    v_mul_u32_u24 v154, s22, v154
    v_mfma_f32_16x16x32_bf16 v[158:161], a[48:51], v[210:213], 0
    v_mad_u32_u24 v154, v136, s21, v154
    v_bfe_u32 v137, s70, v136, 1
    v_mfma_f32_16x16x32_bf16 v[158:161], a[52:55], v[214:217], v[158:161]
    v_cmp_ne_u32 vcc, 0, v137
    v_add_u32 v136, s7, v154
    v_mfma_f32_16x16x32_bf16 v[158:161], a[56:59], v[170:173], v[158:161]
    v_cvt_pk_f16_f32 v144, v114, v115
    v_pk_fma_f16 v130, v144, v144, v130
    v_mfma_f32_16x16x32_bf16 v[158:161], a[60:63], v[150:153], v[158:161]
    v_cvt_pk_f16_f32 v145, v116, v117
    v_pk_fma_f16 v130, v145, v145, v130
    v_mfma_f32_16x16x32_bf16 v[158:161], a[64:67], v[186:189], v[158:161]
    v_pk_fma_f16 v132, v144, v184, v132
    v_pk_fma_f16 v132, v145, v185, v132
    v_mfma_f32_16x16x32_bf16 v[158:161], a[68:71], v[122:125], v[158:161]
    v_cndmask_b32 v136, v238, v136, vcc
    v_lshl_add_u32 v114, v255, 4, v136
    v_mfma_f32_16x16x32_bf16 v[194:197], v[210:213], a[144:147], 0
    v_add_u32 v114, s3, v114
    v_lshl_add_u32 v115, v255, 3, v136
    v_mfma_f32_16x16x32_bf16 v[194:197], v[214:217], a[148:151], v[194:197]
    buffer_store_dwordx2 v[220:221], v20, s[48:51], 0 offen nt
    v_add_u32 v115, s4, v115
    v_cvt_pk_f16_f32 v154, v158, v159
    v_mfma_f32_16x16x32_bf16 v[194:197], v[170:173], a[152:155], v[194:197]
    v_pk_fma_f16 v130, v154, v154, v130
    v_cvt_pk_f16_f32 v155, v160, v161
    v_mfma_f32_16x16x32_bf16 v[194:197], v[150:153], a[156:159], v[194:197]
    v_pk_fma_f16 v130, v155, v155, v130
    v_pk_fma_f16 v132, v154, v162, v132
    v_mfma_f32_16x16x32_bf16 v[194:197], v[186:189], a[160:163], v[194:197]
    v_pk_fma_f16 v132, v155, v163, v132
    v_lshlrev_b32 v116, 9, v255
    v_mfma_f32_16x16x32_bf16 v[194:197], v[122:125], a[164:167], v[194:197]
    v_lshl_add_u32 v116, v241, 4, v116
    v_add_u32 v116, 149696, v116
    v_mfma_f32_16x16x32_f16 v[158:161], v[40:43], v[130:133], 0
    v_and_b32 v206, 0xffff, v2
    v_add_u32 v206, 38912, v206
    v_mfma_f32_16x16x32_bf16 v[130:133], v[210:213], a[168:171], 0
    v_and_b32 v117, 0xffff, v4
    v_add_u32 v117, 38912, v117
    v_mfma_f32_16x16x32_bf16 v[130:133], v[214:217], a[172:175], v[130:133]
    ds_write_b64 v117, v[168:169] offset:0
    v_mfma_f32_16x16x32_bf16 v[130:133], v[170:173], a[176:179], v[130:133]
    v_cvt_pk_bf16_f32 v168, v194, v195
    v_cvt_pk_bf16_f32 v169, v196, v197
    v_mfma_f32_16x16x32_bf16 v[130:133], v[150:153], a[180:183], v[130:133]
    v_rsq_f32 v158, v158
    v_mfma_f32_16x16x32_bf16 v[130:133], v[186:189], a[184:187], v[130:133]
    ds_read_b128 v[222:225], v0 offset:32768
    v_mul_f32 v194, s31, v158
    v_mfma_f32_16x16x32_bf16 v[130:133], v[122:125], a[188:191], v[130:133]
    ds_read_b128 v[242:245], v1 offset:32768
    v_fma_f32 v160, v160, v194, v24
    v_mfma_f32_16x16x32_bf16 v[226:229], v[210:213], a[192:195], 0
    ds_read_b128 v[210:213], v0 offset:32896
    v_add_u32 v208, 16, v241
    v_mfma_f32_16x16x32_bf16 v[226:229], v[214:217], a[196:199], v[226:229]
    ds_read_b128 v[202:205], v1 offset:32896
    v_min_u32 v207, 20, v208
    v_mfma_f32_16x16x32_bf16 v[226:229], v[170:173], a[200:203], v[226:229]
    s_waitcnt lgkmcnt(4)
    ds_read_b128 v[170:173], v0 offset:33024
    v_cvt_pk_bf16_f32 v136, v130, v131
    v_mfma_f32_16x16x32_bf16 v[226:229], v[150:153], a[204:207], v[226:229]
    s_barrier
    ds_read_b128 v[150:153], v206 offset:0
    v_cvt_pk_bf16_f32 v137, v132, v133
    v_mfma_f32_16x16x32_bf16 v[226:229], v[186:189], a[208:211], v[226:229]
    ds_read_b128 v[130:133], v206 offset:1024
    v_add_u32 v209, 12, v208
    v_mfma_f32_16x16x32_bf16 v[226:229], v[122:125], a[212:215], v[226:229]
    s_waitcnt lgkmcnt(6)
    ds_read_b128 v[186:189], v1 offset:33024
    v_rsq_f32 v159, v159
    v_exp_f32 v240, v240
    v_cvt_pk_f16_f32 v195, v194, v159
    v_fmac_f32_dpp v254, v161, v159 quad_perm:[0,1,2,3] row_mask:0x2 bank_mask:0xf
    v_pk_mul_f16 v126, v126, v195 op_sel:[0,1] op_sel_hi:[1,1]
    v_pk_mul_f16 v127, v127, v195 op_sel:[0,1] op_sel_hi:[1,1]
    v_cvt_pk_bf16_f32 v220, v226, v227
    v_cvt_pk_bf16_f32 v221, v228, v229
    v_mfma_f32_16x16x32_bf16 v[122:125], a[72:75], v[222:225], 0
    s_waitcnt lgkmcnt(4)
    v_pk_mul_f16 v128, v128, v195 op_sel:[0,1] op_sel_hi:[1,1]
    v_pk_mul_f16 v129, v129, v195 op_sel:[0,1] op_sel_hi:[1,1]
    v_mfma_f32_16x16x32_bf16 v[122:125], a[76:79], v[242:245], v[122:125]
    s_waitcnt lgkmcnt(3)
    v_pk_mul_f16 v156, v156, v195 op_sel:[0,1] op_sel_hi:[1,1]
    v_pk_mul_f16 v157, v157, v195 op_sel:[0,1] op_sel_hi:[1,1]
    v_mfma_f32_16x16x32_bf16 v[122:125], a[80:83], v[210:213], v[122:125]
    s_waitcnt lgkmcnt(2)
    v_pk_mul_f16 v142, v142, v195 op_sel:[0,0] op_sel_hi:[1,0]
    v_pk_mul_f16 v143, v143, v195 op_sel:[0,0] op_sel_hi:[1,0]
    v_mfma_f32_16x16x32_bf16 v[122:125], a[84:87], v[202:205], v[122:125]
    s_waitcnt lgkmcnt(1)
    v_pk_mul_f16 v144, v144, v195 op_sel:[0,0] op_sel_hi:[1,0]
    v_pk_mul_f16 v145, v145, v195 op_sel:[0,0] op_sel_hi:[1,0]
    v_mfma_f32_16x16x32_bf16 v[122:125], a[88:91], v[170:173], v[122:125]
    s_waitcnt lgkmcnt(0)
    v_pk_mul_f16 v154, v154, v195 op_sel:[0,0] op_sel_hi:[1,0]
    v_pk_mul_f16 v155, v155, v195 op_sel:[0,0] op_sel_hi:[1,0]
    v_mfma_f32_16x16x32_bf16 v[122:125], a[92:95], v[186:189], v[122:125]
    v_max3_u32 v44, v44, v158, v159
    v_cvt_pk_bf16_f32 v39, v240, 0
    v_mfma_f32_16x16x32_bf16 v[194:197], v[32:35], v[150:153], 0
    v_exp_f32 v160, v160
    v_mfma_f32_16x16x32_bf16 v[194:197], v[32:35], v[130:133], v[194:197]
    v_lshrrev_b32 v209, 5, v209
    v_sub_u32 v240, v208, v207
    v_mfma_f32_16x16x32_bf16 v[130:133], a[96:99], v[222:225], 0
    v_cvt_pk_f16_f32 v150, v122, v123
    v_pk_mul_f16 v123, v150, v150
    v_mfma_f32_16x16x32_bf16 v[130:133], a[100:103], v[242:245], v[130:133]
    v_cvt_pk_f16_f32 v151, v124, v125
    v_pk_fma_f16 v123, v151, v151, v123
    v_mfma_f32_16x16x32_bf16 v[130:133], a[104:107], v[210:213], v[130:133]
    v_mul_f32 v152, 0x3baaaaab, v195
    v_mul_f32 v153, 0x3baaaaab, v194
    v_mfma_f32_16x16x32_bf16 v[130:133], a[108:111], v[202:205], v[130:133]
    v_rsq_f32 v152, v152
    v_mfma_f32_16x16x32_bf16 v[130:133], a[112:115], v[170:173], v[130:133]
    v_mul_f32 v246, v152, v246
    v_mul_f32 v247, v152, v247
    v_mfma_f32_16x16x32_bf16 v[130:133], a[116:119], v[186:189], v[130:133]
    v_cvt_pk_bf16_f32 v194, v246, v247
    v_mul_f32 v248, v152, v248
    v_mfma_f32_16x16x32_bf16 v[214:217], a[120:123], v[222:225], 0
    v_mul_f32 v249, v152, v249
    v_cvt_pk_bf16_f32 v195, v248, v249
    v_mfma_f32_16x16x32_bf16 v[214:217], a[124:127], v[242:245], v[214:217]
    v_mul_f32 v230, v152, v230
    v_mul_f32 v231, v152, v231
    v_mfma_f32_16x16x32_bf16 v[214:217], a[128:131], v[210:213], v[214:217]
    v_cvt_pk_bf16_f32 v196, v230, v231
    v_mul_f32 v232, v152, v232
    v_mfma_f32_16x16x32_bf16 v[214:217], a[132:135], v[202:205], v[214:217]
    v_mul_f32 v233, v152, v233
    v_cvt_pk_bf16_f32 v197, v232, v233
    v_mfma_f32_16x16x32_bf16 v[214:217], a[136:139], v[170:173], v[214:217]
    buffer_store_dwordx4 v[194:197], v16, s[52:55], 0 offen nt
    v_mul_f32 v234, v152, v234
    v_mul_f32 v235, v152, v235
    v_cvt_pk_bf16_f32 v158, v234, v235
    v_mul_f32 v236, v152, v236
    v_mfma_f32_16x16x32_bf16 v[214:217], a[140:143], v[186:189], v[214:217]
    v_mul_f32 v237, v152, v237
    v_cvt_pk_bf16_f32 v159, v236, v237
    v_mfma_f32_16x16x32_bf16 v[194:197], a[0:3], v[222:225], 0
    v_rsq_f32 v153, v153
    v_mfma_f32_16x16x32_bf16 v[194:197], a[4:7], v[242:245], v[194:197]
    v_mul_f32 v178, v153, v178
    v_mul_f32 v179, v153, v179
    v_mfma_f32_16x16x32_bf16 v[194:197], a[8:11], v[210:213], v[194:197]
    v_cvt_pk_bf16_f32 v178, v178, v179
    v_mul_f32 v180, v153, v180
    v_mfma_f32_16x16x32_bf16 v[194:197], a[12:15], v[202:205], v[194:197]
    v_mul_f32 v181, v153, v181
    v_cvt_pk_bf16_f32 v179, v180, v181
    v_mfma_f32_16x16x32_bf16 v[194:197], a[16:19], v[170:173], v[194:197]
    v_mul_f32 v198, v153, v198
    v_mul_f32 v199, v153, v199
    v_mfma_f32_16x16x32_bf16 v[194:197], a[20:23], v[186:189], v[194:197]
    v_cvt_pk_bf16_f32 v180, v198, v199
    v_mul_f32 v200, v153, v200
    v_mfma_f32_16x16x32_bf16 v[226:229], a[24:27], v[222:225], 0
    v_mul_f32 v201, v153, v201
    v_cvt_pk_bf16_f32 v181, v200, v201
    v_mfma_f32_16x16x32_bf16 v[226:229], a[28:31], v[242:245], v[226:229]
    v_mul_f32 v190, v153, v190
    v_mul_f32 v191, v153, v191
    v_mfma_f32_16x16x32_bf16 v[226:229], a[32:35], v[210:213], v[226:229]
    v_cvt_pk_bf16_f32 v190, v190, v191
    v_mul_f32 v192, v153, v192
    v_mfma_f32_16x16x32_bf16 v[226:229], a[36:39], v[202:205], v[226:229]
    v_mul_f32 v193, v153, v193
    v_cvt_pk_bf16_f32 v191, v192, v193
    v_mfma_f32_16x16x32_bf16 v[226:229], a[40:43], v[170:173], v[226:229]
    v_cvt_pk_f16_f32 v194, v194, v195
    v_pk_mul_f16 v122, v194, v194
    v_mfma_f32_16x16x32_bf16 v[226:229], a[44:47], v[186:189], v[226:229]
    v_cvt_pk_f16_f32 v195, v196, v197
    v_pk_fma_f16 v122, v195, v195, v122
    v_mfma_f32_16x16x32_bf16 v[198:201], a[48:51], v[222:225], 0
    v_pk_mul_f16 v124, v194, v182
    v_pk_fma_f16 v124, v195, v183, v124
    v_mfma_f32_16x16x32_bf16 v[198:201], a[52:55], v[242:245], v[198:201]
    v_cvt_pk_f16_f32 v152, v130, v131
    v_pk_fma_f16 v123, v152, v152, v123
    v_mfma_f32_16x16x32_bf16 v[198:201], a[56:59], v[210:213], v[198:201]
    buffer_store_dwordx2 v[158:159], v19, s[52:55], 0 offen nt
    v_cvt_pk_f16_f32 v196, v226, v227
    v_pk_fma_f16 v122, v196, v196, v122
    v_mfma_f32_16x16x32_bf16 v[198:201], a[60:63], v[202:205], v[198:201]
    v_cvt_pk_f16_f32 v197, v228, v229
    v_pk_fma_f16 v122, v197, v197, v122
    v_mfma_f32_16x16x32_bf16 v[198:201], a[64:67], v[170:173], v[198:201]
    v_pk_fma_f16 v124, v196, v184, v124
    v_pk_fma_f16 v124, v197, v185, v124
    v_mfma_f32_16x16x32_bf16 v[198:201], a[68:71], v[186:189], v[198:201]
    v_cvt_pk_f16_f32 v153, v132, v133
    v_pk_fma_f16 v123, v153, v153, v123
    v_mfma_f32_16x16x32_bf16 v[130:133], v[222:225], a[144:147], 0
    v_cvt_pk_f16_f32 v184, v214, v215
    v_pk_fma_f16 v123, v184, v184, v123
    v_mfma_f32_16x16x32_bf16 v[130:133], v[242:245], a[148:151], v[130:133]
    v_cvt_pk_f16_f32 v185, v216, v217
    v_pk_fma_f16 v123, v185, v185, v123
    v_mfma_f32_16x16x32_f16 v[226:229], v[146:149], v[138:141], v[46:49]
    v_cvt_pk_f16_f32 v182, v198, v199
    v_pk_fma_f16 v122, v182, v182, v122
    v_mfma_f32_16x16x32_f16 v[214:217], v[126:129], v[138:141], v[50:53]
    v_cvt_pk_f16_f32 v183, v200, v201
    v_pk_fma_f16 v122, v183, v183, v122
    v_mfma_f32_16x16x32_bf16 v[130:133], v[210:213], a[152:155], v[130:133]
    v_pk_fma_f16 v124, v182, v162, v124
    v_pk_fma_f16 v124, v183, v163, v124
    v_pk_mul_f16 v125, v150, v174
    v_mfma_f32_16x16x16_f16 v[226:229], v[120:121], v[118:119], v[226:229]
    v_pk_fma_f16 v125, v151, v175, v125
    v_pk_fma_f16 v125, v152, v176, v125
    v_pk_fma_f16 v125, v153, v177, v125
    v_mfma_f32_16x16x16_f16 v[214:217], v[156:157], v[118:119], v[214:217]
    v_pk_fma_f16 v125, v184, v164, v125
    v_pk_fma_f16 v125, v185, v165, v125
    v_mad_i32_i24 v240, v209, s6, v240
    v_mul_u32_u24 v192, s20, v207
    v_mfma_f32_16x16x32_f16 v[162:165], v[40:43], v[122:125], 0
    v_exp_f32 v226, v226
    v_mfma_f32_16x16x32_bf16 v[130:133], v[202:205], a[156:159], v[130:133]
    v_exp_f32 v227, v227
    v_mfma_f32_16x16x32_bf16 v[130:133], v[170:173], a[160:163], v[130:133]
    v_cvt_pk_bf16_f32 v122, v226, v227
    v_add3_u32 v192, v192, v240, s38
    v_mfma_f32_16x16x32_bf16 v[130:133], v[186:189], a[164:167], v[130:133]
    v_exp_f32 v228, v228
    v_mfma_f32_16x16x32_bf16 v[174:177], v[222:225], a[168:171], 0
    v_rsq_f32 v162, v162
    v_mfma_f32_16x16x32_bf16 v[174:177], v[242:245], a[172:175], v[174:177]
    buffer_store_dwordx4 v[178:181], v15, s[52:55], 0 offen nt
    v_rsq_f32 v163, v163
    v_mul_f32 v226, s31, v162
    v_cvt_pk_f16_f32 v227, v226, v163
    v_mfma_f32_16x16x32_bf16 v[174:177], v[210:213], a[176:179], v[174:177]
    v_cvt_pk_bf16_f32 v234, v130, v131
    v_cvt_pk_bf16_f32 v235, v132, v133
    v_mfma_f32_16x16x32_bf16 v[174:177], v[202:205], a[180:183], v[174:177]
    ds_read_b128 v[230:233], v2 offset:12288
    ds_read_b128 v[198:201], v2 offset:13312
    v_mfma_f32_16x16x32_bf16 v[174:177], v[170:173], a[184:187], v[174:177]
    ds_read_b128 v[130:133], v2 offset:14336
    ds_read_b128 v[178:181], v2 offset:15360
    v_mfma_f32_16x16x32_bf16 v[174:177], v[186:189], a[188:191], v[174:177]
    v_fma_f32 v164, v164, v226, v26
    v_fmac_f32_dpp v254, v165, v163 quad_perm:[0,1,2,3] row_mask:0x4 bank_mask:0xf
    v_mfma_f32_16x16x32_bf16 v[246:249], v[222:225], a[192:195], 0
    ds_read_b128 v[250:253], v2 offset:16384
    v_pk_mul_f16 v150, v150, v227 op_sel:[0,1] op_sel_hi:[1,1]
    v_mfma_f32_16x16x32_bf16 v[246:249], v[242:245], a[196:199], v[246:249]
    ds_read_b128 v[222:225], v2 offset:17408
    v_pk_mul_f16 v151, v151, v227 op_sel:[0,1] op_sel_hi:[1,1]
    v_mfma_f32_16x16x32_bf16 v[246:249], v[210:213], a[200:203], v[246:249]
    v_cvt_pk_bf16_f32 v174, v174, v175
    v_cvt_pk_bf16_f32 v175, v176, v177
    v_mfma_f32_16x16x32_bf16 v[246:249], v[202:205], a[204:207], v[246:249]
    v_exp_f32 v254, v254
    v_mfma_f32_16x16x32_bf16 v[246:249], v[170:173], a[208:211], v[246:249]
    s_waitcnt lgkmcnt(4)
    v_cvt_pk_bf16_f32 v254, v254, v254
    v_pk_mul_f16 v152, v152, v227 op_sel:[0,1] op_sel_hi:[1,1]
    v_mfma_f32_16x16x32_bf16 v[246:249], v[186:189], a[212:215], v[246:249]
    s_waitcnt lgkmcnt(2)
    ds_read2_b32 v[236:237], v6 offset0:0 offset1:0
    ds_read2_b32 v[176:177], v6 offset0:16 offset1:16
    v_mfma_f32_16x16x32_bf16 v[186:189], a[216:219], v[230:233], 0
    ds_read2_b32 v[172:173], v6 offset0:32 offset1:32
    v_pk_mul_f16 v153, v153, v227 op_sel:[0,1] op_sel_hi:[1,1]
    v_mfma_f32_16x16x32_bf16 v[186:189], a[220:223], v[198:201], v[186:189]
    s_waitcnt lgkmcnt(4)
    ds_write_b16 v8, v254
    v_mfma_f32_16x16x32_f16 v[202:205], v[150:153], v[138:141], v[54:57]
    s_waitcnt lgkmcnt(4)
    v_cvt_pk_bf16_f32 v170, v246, v247
    v_cvt_pk_bf16_f32 v171, v248, v249
    v_mfma_f32_16x16x32_bf16 v[186:189], a[224:227], v[130:133], v[186:189]
    v_pk_mul_f16 v184, v184, v227 op_sel:[0,1] op_sel_hi:[1,1]
    v_pk_mul_f16 v185, v185, v227 op_sel:[0,1] op_sel_hi:[1,1]
    v_mfma_f32_16x16x32_bf16 v[186:189], a[228:231], v[178:181], v[186:189]
    v_pk_mul_f16 v194, v194, v227 op_sel:[0,0] op_sel_hi:[1,0]
    v_pk_mul_f16 v195, v195, v227 op_sel:[0,0] op_sel_hi:[1,0]
    v_pk_mul_f16 v196, v196, v227 op_sel:[0,0] op_sel_hi:[1,0]
    v_mfma_f32_16x16x16_f16 v[202:205], v[184:185], v[118:119], v[202:205]
    v_pk_mul_f16 v197, v197, v227 op_sel:[0,0] op_sel_hi:[1,0]
    v_pk_mul_f16 v182, v182, v227 op_sel:[0,0] op_sel_hi:[1,0]
    v_pk_mul_f16 v183, v183, v227 op_sel:[0,0] op_sel_hi:[1,0]
    v_max3_u32 v44, v44, v162, v163
    v_mfma_f32_16x16x32_bf16 v[186:189], a[232:235], v[250:253], v[186:189]
    s_waitcnt lgkmcnt(1)
    buffer_store_dwordx2 v[190:191], v18, s[52:55], 0 offen nt
    v_exp_f32 v229, v229
    v_mfma_f32_16x16x32_bf16 v[186:189], a[236:239], v[222:225], v[186:189]
    v_cvt_pk_bf16_f32 v123, v228, v229
    v_sub_u32 v254, 0x40800000, v44
    v_mfma_f32_16x16x32_bf16 v[210:213], a[240:243], v[230:233], 0
    v_exp_f32 v214, v214
    v_mfma_f32_16x16x32_bf16 v[210:213], a[244:247], v[198:201], v[210:213]
    v_exp_f32 v215, v215
    v_mfma_f32_16x16x32_bf16 v[210:213], a[248:251], v[130:133], v[210:213]
    v_cvt_pk_bf16_f32 v124, v214, v215
    v_or_b32 v254, v254, v44
    v_mfma_f32_16x16x32_bf16 v[210:213], a[252:255], v[178:181], v[210:213]
    v_exp_f32 v216, v216
    v_mfma_f32_16x16x32_bf16 v[210:213], v[82:85], v[250:253], v[210:213]
    v_exp_f32 v217, v217
    v_mfma_f32_16x16x32_f16 v[226:229], v[146:149], v[142:145], v[58:61]
    v_cvt_pk_bf16_f32 v125, v216, v217
    v_fma_f32 v118, v186, v186, s33
    v_mfma_f32_16x16x32_bf16 v[210:213], v[86:89], v[222:225], v[210:213]
    v_exp_f32 v202, v202
    v_mfma_f32_16x16x32_bf16 v[242:245], v[90:93], v[230:233], 0
    ds_read_b128 v[138:141], v116 offset:0
    v_exp_f32 v203, v203
    v_mfma_f32_16x16x32_f16 v[214:217], v[126:129], v[142:145], v[62:65]
    v_cvt_pk_bf16_f32 v36, v202, v203
    v_exp_f32 v204, v204
    v_mfma_f32_16x16x16_f16 v[226:229], v[120:121], v[154:155], v[226:229]
    v_exp_f32 v205, v205
    v_fmac_f32 v118, v187, v187
    v_cvt_pk_bf16_f32 v37, v204, v205
    v_mfma_f32_16x16x32_f16 v[246:249], v[150:153], v[142:145], v[66:69]
    v_fmac_f32 v118, v188, v188
    v_fmac_f32 v118, v189, v189
    v_mfma_f32_16x16x32_bf16 v[142:145], v[28:31], v[36:39], 0
    v_fmac_f32 v118, v210, v210
    v_fmac_f32 v118, v211, v211
    v_mfma_f32_16x16x32_bf16 v[142:145], v[28:31], v[122:125], v[142:145]
    v_fmac_f32 v118, v212, v212
    v_fmac_f32 v118, v213, v213
    v_mfma_f32_16x16x32_bf16 v[202:205], v[234:237], v[36:39], 0
    s_waitcnt lgkmcnt(0)
    v_exp_f32 v164, v164
    v_mfma_f32_16x16x32_bf16 v[202:205], v[166:169], v[122:125], v[202:205]
    v_exp_f32 v226, v226
    v_mul_u32_u24 v209, 911, v192
    v_mfma_f32_16x16x16_f16 v[214:217], v[156:157], v[154:155], v[214:217]
    v_rcp_f32 v142, v142
    v_lshrrev_b32 v209, 16, v209
    v_mfma_f32_16x16x16_f16 v[246:249], v[184:185], v[154:155], v[246:249]
    v_max3_u32 v25, v25, v142, v143
    v_exp_f32 v227, v227
    v_mul_f32 v202, v142, v202
    v_mfma_f32_16x16x32_bf16 v[230:233], v[174:177], v[36:39], 0
    v_mul_f32 v203, v142, v203
    v_cvt_pk_bf16_f32 v190, v202, v203
    v_mfma_f32_16x16x32_bf16 v[230:233], v[134:137], v[122:125], v[230:233]
    v_mul_f32 v204, v142, v204
    v_mul_f32 v205, v142, v205
    v_mfma_f32_16x16x32_bf16 v[242:245], v[94:97], v[198:201], v[242:245]
    ds_read_b128 v[198:201], v116 offset:2048
    v_cvt_pk_bf16_f32 v191, v204, v205
    v_mfma_f32_16x16x32_bf16 v[242:245], v[98:101], v[130:133], v[242:245]
    ds_read_b128 v[202:205], v116 offset:4096
    v_cvt_pk_bf16_f32 v158, v226, v227
    v_mfma_f32_16x16x32_bf16 v[242:245], v[102:105], v[178:181], v[242:245]
    ds_read_b128 v[130:133], v116 offset:6144
    v_mul_f32 v230, v142, v230
    v_mfma_f32_16x16x32_bf16 v[242:245], v[106:109], v[250:253], v[242:245]
    ds_read_b128 v[250:253], v116 offset:8192
    v_mul_f32 v231, v142, v231
    v_mfma_f32_16x16x32_bf16 v[242:245], v[110:113], v[222:225], v[242:245]
    ds_read_b128 v[178:181], v116 offset:10240
    v_cvt_pk_bf16_f32 v192, v230, v231
    v_mfma_f32_16x16x32_bf16 v[222:225], v[170:173], v[36:39], 0
    v_mul_f32 v232, v142, v232
    v_mul_f32 v233, v142, v233
    v_mfma_f32_16x16x32_bf16 v[222:225], v[218:221], v[122:125], v[222:225]
    v_cvt_pk_bf16_f32 v193, v232, v233
    v_cvt_pk_bf16_f32 v39, v160, 0
    v_mfma_f32_16x16x32_bf16 v[122:125], a[216:219], v[138:141], 0
    s_waitcnt lgkmcnt(4)
    ds_write_b128 v3, v[190:193] offset:0
    v_mfma_f32_16x16x32_bf16 v[122:125], a[220:223], v[198:201], v[122:125]
    s_waitcnt lgkmcnt(3)
    v_fmac_f32 v118, v242, v242
    v_fmac_f32 v118, v243, v243
    v_mfma_f32_16x16x32_bf16 v[122:125], a[224:227], v[202:205], v[122:125]
    s_waitcnt lgkmcnt(2)
    v_fmac_f32 v118, v244, v244
    v_fmac_f32 v118, v245, v245
    v_mfma_f32_16x16x32_bf16 v[122:125], a[228:231], v[130:133], v[122:125]
    s_waitcnt lgkmcnt(1)
    v_mul_f32 v222, v142, v222
    v_mul_f32 v223, v142, v223
    v_mfma_f32_16x16x32_bf16 v[122:125], a[232:235], v[250:253], v[122:125]
    v_cvt_pk_bf16_f32 v154, v222, v223
    v_mul_f32 v224, v142, v224
    v_mfma_f32_16x16x32_bf16 v[122:125], a[236:239], v[178:181], v[122:125]
    v_mul_f32 v225, v142, v225
    v_cvt_pk_bf16_f32 v155, v224, v225
    v_mfma_f32_16x16x32_bf16 v[142:145], a[240:243], v[138:141], 0
    ds_write_b64 v4, v[154:155] offset:4096
    v_mfma_f32_16x16x32_bf16 v[142:145], a[244:247], v[198:201], v[142:145]
    v_exp_f32 v228, v228
    v_mfma_f32_16x16x32_bf16 v[142:145], a[248:251], v[202:205], v[142:145]
    v_exp_f32 v229, v229
    v_mfma_f32_16x16x32_bf16 v[142:145], a[252:255], v[130:133], v[142:145]
    v_fma_f32 v119, v122, v122, s33
    v_fmac_f32 v119, v123, v123
    v_mfma_f32_16x16x32_bf16 v[142:145], v[82:85], v[250:253], v[142:145]
    v_fmac_f32 v119, v124, v124
    v_fmac_f32 v119, v125, v125
    v_mfma_f32_16x16x32_bf16 v[142:145], v[86:89], v[178:181], v[142:145]
    v_cvt_pk_bf16_f32 v159, v228, v229
    v_mul_u32_u24 v209, s22, v209
    v_mfma_f32_16x16x32_bf16 v[222:225], v[90:93], v[138:141], 0
    v_exp_f32 v214, v214
    v_mfma_f32_16x16x32_f16 v[138:141], v[146:149], v[194:197], v[70:73]
    v_exp_f32 v215, v215
    v_mfma_f32_16x16x32_bf16 v[222:225], v[94:97], v[198:201], v[222:225]
    v_cvt_pk_bf16_f32 v160, v214, v215
    v_fmac_f32 v119, v142, v142
    v_mfma_f32_16x16x32_bf16 v[222:225], v[98:101], v[202:205], v[222:225]
    v_fmac_f32 v119, v143, v143
    v_fmac_f32 v119, v144, v144
    v_fmac_f32 v119, v145, v145
    v_mfma_f32_16x16x16_f16 v[138:141], v[120:121], v[182:183], v[138:141]
    v_exp_f32 v216, v216
    v_exp_f32 v217, v217
    v_mfma_f32_16x16x32_f16 v[146:149], v[126:129], v[194:197], v[74:77]
    v_cvt_pk_bf16_f32 v161, v216, v217
    v_mad_u32_u24 v209, v207, s21, v209
    v_mfma_f32_16x16x32_bf16 v[222:225], v[102:105], v[130:133], v[222:225]
    v_exp_f32 v246, v246
    v_mfma_f32_16x16x32_f16 v[198:201], v[150:153], v[194:197], v[78:81]
    v_exp_f32 v138, v138
    v_bfe_u32 v192, s70, v208, 1
    v_mfma_f32_16x16x16_f16 v[146:149], v[156:157], v[182:183], v[146:149]
    v_exp_f32 v139, v139
    v_exp_f32 v140, v140
    v_mfma_f32_16x16x32_bf16 v[222:225], v[106:109], v[250:253], v[222:225]
    v_cvt_pk_bf16_f32 v126, v138, v139
    v_exp_f32 v141, v141
    v_mfma_f32_16x16x16_f16 v[198:201], v[184:185], v[182:183], v[198:201]
    v_cvt_pk_bf16_f32 v127, v140, v141
    v_exp_f32 v247, v247
    v_cmp_ne_u32 vcc, 0, v192
    v_mfma_f32_16x16x32_bf16 v[222:225], v[110:113], v[178:181], v[222:225]
    v_exp_f32 v146, v146
    v_exp_f32 v147, v147
    v_exp_f32 v148, v148
    v_cvt_pk_bf16_f32 v128, v146, v147
    v_exp_f32 v149, v149
    v_exp_f32 v198, v198
    ds_read_b128 v[138:141], v9
    ds_read_b128 v[130:133], v9 offset:64
    v_fmac_f32 v119, v222, v222
    v_fmac_f32 v119, v223, v223
    v_fmac_f32 v119, v224, v224
    v_fmac_f32 v119, v225, v225
    v_cvt_pk_bf16_f32 v146, v118, v119
    v_cvt_pk_bf16_f32 v147, v119, v119
    ds_write_b64 v117, v[146:147] offset:2048
    v_cvt_pk_bf16_f32 v129, v148, v149
    v_exp_f32 v199, v199
    v_exp_f32 v200, v200
    v_exp_f32 v201, v201
    v_cvt_pk_bf16_f32 v36, v246, v247
    v_exp_f32 v248, v248
    v_exp_f32 v249, v249
    s_waitcnt lgkmcnt(2)
    v_mfma_f32_16x16x32_bf16 v[146:149], v[138:141], v[28:31], 0
    s_waitcnt lgkmcnt(1)
    v_cvt_pk_bf16_f32 v37, v248, v249
    v_mul_i32_i24 v240, 2688, v240
    v_mfma_f32_16x16x32_bf16 v[146:149], v[130:133], v[28:31], v[146:149]
    v_add3_u32 v240, v209, v240, s7
    v_cndmask_b32 v240, v238, v240, vcc
    v_mfma_f32_16x16x32_bf16 v[154:157], v[28:31], v[36:39], 0
    s_waitcnt lgkmcnt(0)
    v_lshl_add_u32 v207, v255, 4, v240
    v_add_u32 v207, s3, v207
    v_mfma_f32_16x16x32_bf16 v[154:157], v[28:31], v[158:161], v[154:157]
    s_barrier
    ds_read_b128 v[118:121], v206 offset:2048
    ds_read_b128 v[150:153], v206 offset:3072
    v_mfma_f32_16x16x32_bf16 v[178:181], v[234:237], v[36:39], 0
    s_barrier
    v_rcp_f32 v146, v146
    v_mfma_f32_16x16x32_bf16 v[178:181], v[166:169], v[158:161], v[178:181]
    v_lshl_add_u32 v240, v255, 3, v240
    v_add_u32 v240, s4, v240
    v_mfma_f32_16x16x32_bf16 v[190:193], v[174:177], v[36:39], 0
    v_rcp_f32 v154, v154
    v_mfma_f32_16x16x32_bf16 v[190:193], v[134:137], v[158:161], v[190:193]
    v_max3_u32 v25, v25, v154, v155
    v_xor_b32 v238, 65536, v2
    v_mfma_f32_16x16x32_bf16 v[214:217], v[170:173], v[36:39], 0
    ds_read_b128 v[202:205], v238 offset:0
    ds_read_b128 v[226:229], v238 offset:1024
    v_mfma_f32_16x16x32_bf16 v[214:217], v[218:221], v[158:161], v[214:217]
    ds_read_b128 v[158:161], v238 offset:2048
    ds_read_b128 v[182:185], v238 offset:3072
    v_mfma_f32_16x16x32_bf16 v[194:197], v[138:141], v[166:169], 0
    s_waitcnt lgkmcnt(4)
    v_cvt_pk_bf16_f32 v36, v198, v199
    v_cvt_pk_bf16_f32 v37, v200, v201
    v_mfma_f32_16x16x32_bf16 v[198:201], v[32:35], v[118:121], 0
    ds_read_b128 v[118:121], v238 offset:4096
    ds_read_b128 v[230:233], v238 offset:5120
    v_mfma_f32_16x16x32_bf16 v[198:201], v[32:35], v[150:153], v[198:201]
    v_cvt_pk_bf16_f32 v39, v164, 0
    v_mul_f32 v178, v154, v178
    v_mfma_f32_16x16x32_bf16 v[194:197], v[130:133], v[234:237], v[194:197]
    v_mul_f32 v179, v154, v179
    v_cvt_pk_bf16_f32 v162, v178, v179
    v_mfma_f32_16x16x32_bf16 v[150:153], v[138:141], v[134:137], 0
    v_mul_f32 v180, v154, v180
    v_mul_f32 v181, v154, v181
    v_mfma_f32_16x16x32_bf16 v[150:153], v[130:133], v[174:177], v[150:153]
    s_waitcnt lgkmcnt(4)
    v_cvt_pk_bf16_f32 v163, v180, v181
    v_mul_f32 v190, v154, v190
    v_mfma_f32_16x16x32_bf16 v[178:181], a[216:219], v[202:205], 0
    s_waitcnt lgkmcnt(2)
    v_mul_f32 v191, v154, v191
    v_cvt_pk_bf16_f32 v164, v190, v191
    v_mfma_f32_16x16x32_bf16 v[178:181], a[220:223], v[226:229], v[178:181]
    v_mul_f32 v192, v154, v192
    v_mul_f32 v193, v154, v193
    v_mfma_f32_16x16x32_bf16 v[178:181], a[224:227], v[158:161], v[178:181]
    s_waitcnt lgkmcnt(0)
    v_cvt_pk_bf16_f32 v165, v192, v193
    v_mul_f32 v214, v154, v214
    v_mfma_f32_16x16x32_bf16 v[178:181], a[228:231], v[182:185], v[178:181]
    ds_write_b128 v3, v[162:165] offset:6144
    v_mfma_f32_16x16x32_bf16 v[178:181], a[232:235], v[118:121], v[178:181]
    v_mul_f32 v215, v154, v215
    v_cvt_pk_bf16_f32 v148, v214, v215
    v_mfma_f32_16x16x32_bf16 v[178:181], a[236:239], v[230:233], v[178:181]
    v_mul_f32 v216, v154, v216
    v_mul_f32 v217, v154, v217
    v_mfma_f32_16x16x32_bf16 v[154:157], a[240:243], v[202:205], 0
    v_cvt_pk_bf16_f32 v149, v216, v217
    v_mul_f32 v208, 0x3baaaaab, v199
    v_mfma_f32_16x16x32_bf16 v[154:157], a[244:247], v[226:229], v[154:157]
    ds_write_b64 v4, v[148:149] offset:10240
    v_mfma_f32_16x16x32_bf16 v[154:157], a[248:251], v[158:161], v[154:157]
    v_fma_f32 v148, v178, v178, s33
    v_fmac_f32 v148, v179, v179
    v_mfma_f32_16x16x32_bf16 v[154:157], a[252:255], v[182:185], v[154:157]
    v_fmac_f32 v148, v180, v180
    v_fmac_f32 v148, v181, v181
    v_mfma_f32_16x16x32_bf16 v[154:157], v[82:85], v[118:121], v[154:157]
    v_rsq_f32 v208, v208
    v_mfma_f32_16x16x32_bf16 v[154:157], v[86:89], v[230:233], v[154:157]
    v_mul_f32 v122, v208, v122
    v_mul_f32 v123, v208, v123
    v_mfma_f32_16x16x32_bf16 v[162:165], v[90:93], v[202:205], 0
    v_cvt_pk_bf16_f32 v122, v122, v123
    v_mul_f32 v124, v208, v124
    v_mfma_f32_16x16x32_bf16 v[162:165], v[94:97], v[226:229], v[162:165]
    v_mul_f32 v125, v208, v125
    v_cvt_pk_bf16_f32 v123, v124, v125
    v_mfma_f32_16x16x32_bf16 v[162:165], v[98:101], v[158:161], v[162:165]
    v_fmac_f32 v148, v154, v154
    v_fmac_f32 v148, v155, v155
    v_mfma_f32_16x16x32_bf16 v[162:165], v[102:105], v[182:185], v[162:165]
    v_fmac_f32 v148, v156, v156
    v_fmac_f32 v148, v157, v157
    v_mfma_f32_16x16x32_bf16 v[162:165], v[106:109], v[118:121], v[162:165]
    v_mul_f32 v142, v208, v142
    v_mul_f32 v143, v208, v143
    v_mfma_f32_16x16x32_bf16 v[162:165], v[110:113], v[230:233], v[162:165]
    v_cvt_pk_bf16_f32 v124, v142, v143
    v_mul_f32 v144, v208, v144
    v_mfma_f32_16x16x32_bf16 v[118:121], v[138:141], v[218:221], 0
    v_mul_f32 v145, v208, v145
    v_cvt_pk_bf16_f32 v125, v144, v145
    v_mfma_f32_16x16x32_bf16 v[118:121], v[130:133], v[170:173], v[118:121]
    buffer_store_dwordx4 v[122:125], v114, s[12:15], 0 offen nt
    v_mul_f32 v222, v208, v222
    v_fmac_f32 v148, v162, v162
    v_fmac_f32 v148, v163, v163
    v_fmac_f32 v148, v164, v164
    v_mfma_f32_16x16x32_bf16 v[138:141], v[28:31], v[36:39], 0
    v_fmac_f32 v148, v165, v165
    v_cvt_pk_bf16_f32 v152, v148, v148
    v_mfma_f32_16x16x32_bf16 v[138:141], v[28:31], v[126:129], v[138:141]
    v_cvt_pk_bf16_f32 v153, v148, v148
    v_mul_f32 v223, v208, v223
    v_mfma_f32_16x16x32_bf16 v[142:145], v[234:237], v[36:39], 0
    ds_write_b64 v117, v[152:153] offset:7616
    v_mfma_f32_16x16x32_bf16 v[142:145], v[166:169], v[126:129], v[142:145]
    v_cvt_pk_bf16_f32 v148, v222, v223
    v_mul_f32 v224, v208, v224
    v_mfma_f32_16x16x32_bf16 v[130:133], v[174:177], v[36:39], 0
    v_mul_f32 v225, v208, v225
    v_cvt_pk_bf16_f32 v149, v224, v225
    v_mfma_f32_16x16x32_bf16 v[130:133], v[134:137], v[126:129], v[130:133]
    v_mul_f32 v194, v194, v146
    v_mul_f32_dpp v194, v150, v146 quad_perm:[0,1,2,3] row_mask:0x2 bank_mask:0xf
    v_mfma_f32_16x16x32_bf16 v[122:125], v[170:173], v[36:39], 0
    v_mul_f32_dpp v194, v118, v146 quad_perm:[0,1,2,3] row_mask:0x4 bank_mask:0xf
    v_cvt_pk_bf16_f32 v194, v194, v194
    v_mfma_f32_16x16x32_bf16 v[122:125], v[218:221], v[126:129], v[122:125]
    ds_write_b16 v7, v194
    v_mul_f32 v114, 0x3baaaaab, v198
    v_rsq_f32 v114, v114
    v_rcp_f32 v138, v138
    v_mul_f32 v186, v114, v186
    v_mul_f32 v187, v114, v187
    v_cvt_pk_bf16_f32 v118, v186, v187
    v_mul_f32 v188, v114, v188
    v_mul_f32 v189, v114, v189
    v_cvt_pk_bf16_f32 v119, v188, v189
    v_mul_f32 v210, v114, v210
    v_mul_f32 v211, v114, v211
    v_cvt_pk_bf16_f32 v120, v210, v211
    v_mul_f32 v212, v114, v212
    v_mul_f32 v213, v114, v213
    v_cvt_pk_bf16_f32 v121, v212, v213
    v_mul_f32 v242, v114, v242
    v_mul_f32 v243, v114, v243
    v_cvt_pk_bf16_f32 v208, v242, v243
    v_mul_f32 v244, v114, v244
    v_mul_f32 v245, v114, v245
    v_cvt_pk_bf16_f32 v209, v244, v245
    s_waitcnt lgkmcnt(0)
    s_barrier
    ds_read_b128 v[150:153], v206 offset:7616
    ds_read_b128 v[126:129], v206 offset:8640
    ds_read_b128 v[166:169], v238 offset:6144
    buffer_store_dwordx2 v[148:149], v115, s[12:15], 0 offen nt
    ds_read_b128 v[170:173], v238 offset:7168
    ds_read_b128 v[134:137], v238 offset:8192
    ds_read_b128 v[158:161], v238 offset:9216
    ds_read_b128 v[174:177], v238 offset:10240
    ds_read_b128 v[182:185], v238 offset:11264
    v_max3_u32 v25, v25, v138, v139
    v_max3_u32 v25, v25, v146, v147
    v_sub_u32 v114, 0x67800000, v25
    s_waitcnt lgkmcnt(7)
    v_mfma_f32_16x16x32_bf16 v[146:149], v[32:35], v[150:153], 0
    s_waitcnt lgkmcnt(5)
    v_or3_b32 v254, v254, v114, v25
    v_lshl_add_u32 v114, s16, 2, v238
    v_mfma_f32_16x16x32_bf16 v[146:149], v[32:35], v[126:129], v[146:149]
    s_waitcnt lgkmcnt(4)
    ds_write_b32 v114, v254 offset:18432
    v_mfma_f32_16x16x32_bf16 v[126:129], a[216:219], v[166:169], 0
    s_waitcnt lgkmcnt(4)
    v_mul_f32 v142, v138, v142
    v_mul_f32 v143, v138, v143
    v_mfma_f32_16x16x32_bf16 v[126:129], a[220:223], v[170:173], v[126:129]
    s_waitcnt lgkmcnt(3)
    v_cvt_pk_bf16_f32 v142, v142, v143
    v_mul_f32 v144, v138, v144
    v_mfma_f32_16x16x32_bf16 v[126:129], a[224:227], v[134:137], v[126:129]
    s_waitcnt lgkmcnt(2)
    v_mul_f32 v145, v138, v145
    v_cvt_pk_bf16_f32 v143, v144, v145
    v_mfma_f32_16x16x32_bf16 v[126:129], a[228:231], v[158:161], v[126:129]
    s_waitcnt lgkmcnt(1)
    v_mul_f32 v130, v138, v130
    v_mul_f32 v131, v138, v131
    v_mfma_f32_16x16x32_bf16 v[126:129], a[232:235], v[174:177], v[126:129]
    v_cvt_pk_bf16_f32 v144, v130, v131
    v_mul_f32 v132, v138, v132
    v_mfma_f32_16x16x32_bf16 v[126:129], a[236:239], v[182:185], v[126:129]
    v_mul_f32 v133, v138, v133
    v_cvt_pk_bf16_f32 v145, v132, v133
    v_mfma_f32_16x16x32_bf16 v[130:133], a[240:243], v[166:169], 0
    ds_write_b128 v3, v[142:145] offset:12288
    v_mfma_f32_16x16x32_bf16 v[130:133], a[244:247], v[170:173], v[130:133]
    buffer_store_dwordx4 v[118:121], v17, s[52:55], 0 offen nt
    v_mul_f32 v122, v138, v122
    v_mul_f32 v123, v138, v123
    v_fma_f32 v254, v126, v126, s33
    v_fmac_f32 v254, v127, v127
    v_mfma_f32_16x16x32_bf16 v[130:133], a[248:251], v[134:137], v[130:133]
    v_fmac_f32 v254, v128, v128
    v_fmac_f32 v254, v129, v129
    v_mfma_f32_16x16x32_bf16 v[130:133], a[252:255], v[158:161], v[130:133]
    v_cvt_pk_bf16_f32 v114, v122, v123
    v_mul_f32 v124, v138, v124
    v_mfma_f32_16x16x32_bf16 v[130:133], v[82:85], v[174:177], v[130:133]
    v_mul_f32 v125, v138, v125
    v_cvt_pk_bf16_f32 v115, v124, v125
    v_mfma_f32_16x16x32_bf16 v[130:133], v[86:89], v[182:185], v[130:133]
    ds_write_b64 v4, v[114:115] offset:16384
    v_mfma_f32_16x16x32_bf16 v[118:121], v[90:93], v[166:169], 0
    v_mul_f32 v115, 0x3baaaaab, v146
    v_bfe_u32 v114, v241, 1, 2
    v_mfma_f32_16x16x32_bf16 v[118:121], v[94:97], v[170:173], v[118:121]
    ds_read_b128 v[138:141], v116 offset:256
    ds_read_b128 v[146:149], v116 offset:2304
    v_mfma_f32_16x16x32_bf16 v[118:121], v[98:101], v[134:137], v[118:121]
    ds_read_b128 v[122:125], v116 offset:4352
    v_fmac_f32 v254, v130, v130
    v_mfma_f32_16x16x32_bf16 v[118:121], v[102:105], v[158:161], v[118:121]
    ds_read_b128 v[134:137], v116 offset:6400
    v_fmac_f32 v254, v131, v131
    v_mfma_f32_16x16x32_bf16 v[118:121], v[106:109], v[174:177], v[118:121]
    ds_read_b128 v[142:145], v116 offset:8448
    v_fmac_f32 v254, v132, v132
    v_mfma_f32_16x16x32_bf16 v[118:121], v[110:113], v[182:185], v[118:121]
    ds_read_b128 v[158:161], v116 offset:10496
    v_fmac_f32 v254, v133, v133
    v_rsq_f32 v115, v115
    v_xor_b32 v114, v114, v255
    v_mul_f32 v178, v115, v178
    v_mul_f32 v179, v115, v179
    v_cvt_pk_bf16_f32 v166, v178, v179
    v_mul_f32 v180, v115, v180
    s_waitcnt lgkmcnt(5)
    v_mfma_f32_16x16x32_bf16 v[150:153], a[216:219], v[138:141], 0
    s_waitcnt lgkmcnt(4)
    v_fmac_f32 v254, v118, v118
    v_fmac_f32 v254, v119, v119
    v_mfma_f32_16x16x32_bf16 v[150:153], a[220:223], v[146:149], v[150:153]
    s_waitcnt lgkmcnt(3)
    v_fmac_f32 v254, v120, v120
    v_fmac_f32 v254, v121, v121
    v_mfma_f32_16x16x32_bf16 v[150:153], a[224:227], v[122:125], v[150:153]
    s_waitcnt lgkmcnt(2)
    buffer_store_dwordx2 v[208:209], v20, s[52:55], 0 offen nt
    v_cvt_pk_bf16_f32 v178, v254, v254
    v_cvt_pk_bf16_f32 v179, v254, v254
    v_mfma_f32_16x16x32_bf16 v[150:153], a[228:231], v[134:137], v[150:153]
    s_waitcnt lgkmcnt(1)
    ds_write_b64 v117, v[178:179] offset:9664
    v_mfma_f32_16x16x32_bf16 v[150:153], a[232:235], v[142:145], v[150:153]
    s_waitcnt lgkmcnt(1)
    v_mul_f32 v181, v115, v181
    v_cvt_pk_bf16_f32 v167, v180, v181
    v_mfma_f32_16x16x32_bf16 v[150:153], a[236:239], v[158:161], v[150:153]
    v_mul_f32 v154, v115, v154
    v_mul_f32 v155, v115, v155
    v_mfma_f32_16x16x32_bf16 v[170:173], a[240:243], v[138:141], 0
    v_cvt_pk_bf16_f32 v168, v154, v155
    v_mul_f32 v156, v115, v156
    v_mfma_f32_16x16x32_bf16 v[170:173], a[244:247], v[146:149], v[170:173]
    v_mul_f32 v157, v115, v157
    v_cvt_pk_bf16_f32 v169, v156, v157
    v_mfma_f32_16x16x32_bf16 v[170:173], a[248:251], v[122:125], v[170:173]
    v_fma_f32 v116, v150, v150, s33
    v_fmac_f32 v116, v151, v151
    v_mfma_f32_16x16x32_bf16 v[170:173], a[252:255], v[134:137], v[170:173]
    v_fmac_f32 v116, v152, v152
    v_fmac_f32 v116, v153, v153
    v_mfma_f32_16x16x32_bf16 v[170:173], v[82:85], v[142:145], v[170:173]
    s_waitcnt lgkmcnt(0)
    v_mul_f32 v162, v115, v162
    v_mul_f32 v163, v115, v163
    v_mfma_f32_16x16x32_bf16 v[170:173], v[86:89], v[158:161], v[170:173]
    s_barrier
    ds_read_b128 v[154:157], v206 offset:9664
    ds_read_b128 v[174:177], v206 offset:10688
    v_mfma_f32_16x16x32_bf16 v[178:181], v[90:93], v[138:141], 0
    ds_read_b128 v[138:141], v238 offset:12288
    v_cvt_pk_bf16_f32 v208, v162, v163
    v_mfma_f32_16x16x32_bf16 v[178:181], v[94:97], v[146:149], v[178:181]
    ds_read_b128 v[182:185], v238 offset:13312
    v_fmac_f32 v116, v170, v170
    v_mfma_f32_16x16x32_bf16 v[178:181], v[98:101], v[122:125], v[178:181]
    ds_read_b128 v[146:149], v238 offset:14336
    v_fmac_f32 v116, v171, v171
    v_mfma_f32_16x16x32_bf16 v[178:181], v[102:105], v[134:137], v[178:181]
    ds_read_b128 v[134:137], v238 offset:15360
    v_fmac_f32 v116, v172, v172
    v_mfma_f32_16x16x32_bf16 v[178:181], v[106:109], v[142:145], v[178:181]
    ds_read_b128 v[122:125], v238 offset:16384
    v_fmac_f32 v116, v173, v173
    v_mfma_f32_16x16x32_bf16 v[178:181], v[110:113], v[158:161], v[178:181]
    ds_read_b128 v[158:161], v238 offset:17408
    s_waitcnt lgkmcnt(7)
    v_mfma_f32_16x16x32_bf16 v[142:145], v[32:35], v[154:157], 0
    s_waitcnt lgkmcnt(6)
    buffer_store_dwordx4 v[166:169], v15, s[56:59], 0 offen nt
    v_mul_f32 v164, v115, v164
    v_mul_f32 v165, v115, v165
    v_cvt_pk_bf16_f32 v209, v164, v165
    v_fmac_f32 v116, v178, v178
    v_mfma_f32_16x16x32_bf16 v[142:145], v[32:35], v[174:177], v[142:145]
    s_waitcnt lgkmcnt(4)
    v_fmac_f32 v116, v179, v179
    v_fmac_f32 v116, v180, v180
    v_mfma_f32_16x16x32_bf16 v[154:157], a[216:219], v[138:141], 0
    s_waitcnt lgkmcnt(3)
    v_fmac_f32 v116, v181, v181
    v_cvt_pk_bf16_f32 v254, v116, v116
    v_mfma_f32_16x16x32_bf16 v[154:157], a[220:223], v[182:185], v[154:157]
    s_waitcnt lgkmcnt(2)
    v_cvt_pk_bf16_f32 v255, v116, v116
    v_lshl_add_u32 v114, v241, 2, v114
    v_mfma_f32_16x16x32_bf16 v[154:157], a[224:227], v[146:149], v[154:157]
    s_waitcnt lgkmcnt(1)
    ds_write_b64 v117, v[254:255] offset:17280
    v_mfma_f32_16x16x32_bf16 v[154:157], a[228:231], v[134:137], v[154:157]
    s_waitcnt lgkmcnt(1)
    v_lshl_add_u32 v255, v114, 4, s5
    v_lshl_add_u32 v115, v114, 3, s5
    v_mfma_f32_16x16x32_bf16 v[154:157], a[232:235], v[122:125], v[154:157]
    v_lshl_add_u32 v254, v239, 4, s5
    v_lshl_add_u32 v241, v239, 3, s5
    v_mfma_f32_16x16x32_bf16 v[154:157], a[236:239], v[158:161], v[154:157]
    v_lshlrev_b32 v114, 2, v114
    v_mul_f32 v142, 0x3baaaaab, v142
    v_mfma_f32_16x16x32_bf16 v[166:169], a[240:243], v[138:141], 0
    ds_permute_b32 v143, v114, v16
    ds_permute_b32 v144, v114, v19
    v_mfma_f32_16x16x32_bf16 v[166:169], a[244:247], v[182:185], v[166:169]
    ds_permute_b32 v116, v114, v17
    ds_permute_b32 v239, v114, v20
    v_mfma_f32_16x16x32_bf16 v[166:169], a[248:251], v[146:149], v[166:169]
    v_rsq_f32 v142, v142
    v_mfma_f32_16x16x32_bf16 v[166:169], a[252:255], v[134:137], v[166:169]
    v_fma_f32 v114, v154, v154, s33
    v_fmac_f32 v114, v155, v155
    v_mfma_f32_16x16x32_bf16 v[166:169], v[82:85], v[122:125], v[166:169]
    v_fmac_f32 v114, v156, v156
    v_fmac_f32 v114, v157, v157
    v_mfma_f32_16x16x32_bf16 v[166:169], v[86:89], v[158:161], v[166:169]
    v_mul_f32 v126, v142, v126
    v_mul_f32 v127, v142, v127
    v_mfma_f32_16x16x32_bf16 v[162:165], v[90:93], v[138:141], 0
    v_cvt_pk_bf16_f32 v126, v126, v127
    v_mul_f32 v128, v142, v128
    v_mfma_f32_16x16x32_bf16 v[162:165], v[94:97], v[182:185], v[162:165]
    s_waitcnt lgkmcnt(2)
    buffer_store_dwordx2 v[208:209], v18, s[56:59], 0 offen nt
    v_fmac_f32 v114, v166, v166
    v_fmac_f32 v114, v167, v167
    v_mfma_f32_16x16x32_bf16 v[162:165], v[98:101], v[146:149], v[162:165]
    s_waitcnt lgkmcnt(0)
    v_fmac_f32 v114, v168, v168
    v_fmac_f32 v114, v169, v169
    v_mfma_f32_16x16x32_bf16 v[162:165], v[102:105], v[134:137], v[162:165]
    v_mul_f32 v129, v142, v129
    v_cvt_pk_bf16_f32 v127, v128, v129
    v_mfma_f32_16x16x32_bf16 v[162:165], v[106:109], v[122:125], v[162:165]
    v_mul_f32 v130, v142, v130
    v_mul_f32 v131, v142, v131
    v_mfma_f32_16x16x32_bf16 v[162:165], v[110:113], v[158:161], v[162:165]
    v_cvt_pk_bf16_f32 v128, v130, v131
    v_mul_f32 v132, v142, v132
    v_mul_f32 v133, v142, v133
    v_cvt_pk_bf16_f32 v129, v132, v133
    ds_write_b128 v255, v[126:129] offset:1536
    v_mul_f32 v118, v142, v118
    v_mul_f32 v119, v142, v119
    v_cvt_pk_bf16_f32 v208, v118, v119
    v_fmac_f32 v114, v162, v162
    v_fmac_f32 v114, v163, v163
    v_fmac_f32 v114, v164, v164
    v_fmac_f32 v114, v165, v165
    v_cvt_pk_bf16_f32 v118, v114, v114
    v_cvt_pk_bf16_f32 v119, v114, v114
    ds_write_b64 v117, v[118:119] offset:15232
    v_mul_f32 v120, v142, v120
    v_mul_f32 v121, v142, v121
    v_cvt_pk_bf16_f32 v209, v120, v121
    ds_read_b128 v[126:129], v254 offset:1536
    ds_write_b64 v115, v[208:209] offset:2560
    ds_read_b64 v[208:209], v241 offset:2560
    s_waitcnt lgkmcnt(3)
    s_barrier
    ds_read_b128 v[130:133], v206 offset:15232
    ds_read_b128 v[146:149], v206 offset:16256
    ds_read_b128 v[138:141], v206 offset:17280
    ds_read_b128 v[118:121], v206 offset:18304
    ds_read_b128 v[134:137], v238 offset:18432
    s_waitcnt lgkmcnt(6)
    buffer_store_dwordx4 v[126:129], v143, s[56:59], 0 offen nt
    s_waitcnt lgkmcnt(5)
    s_waitcnt lgkmcnt(4)
    v_mfma_f32_16x16x32_bf16 v[122:125], v[32:35], v[130:133], 0
    s_waitcnt lgkmcnt(3)
    v_mfma_f32_16x16x32_bf16 v[122:125], v[32:35], v[146:149], v[122:125]
    s_waitcnt lgkmcnt(1)
    v_mfma_f32_16x16x32_bf16 v[126:129], v[32:35], v[138:141], 0
    s_waitcnt lgkmcnt(0)
    buffer_store_dwordx2 v[208:209], v144, s[56:59], 0 offen nt
    v_or3_b32 v134, v134, v135, v136
    v_or_b32 v134, v134, v137
    v_mfma_f32_16x16x32_bf16 v[126:129], v[32:35], v[118:121], v[126:129]
    v_cmp_gt_i32 s[46:47], 0, v134
    v_mul_f32 v238, 0x3baaaaab, v122
    v_rsq_f32 v238, v238
    s_nop 0
    v_mul_f32 v154, v238, v154
    v_mul_f32 v155, v238, v155
    v_cvt_pk_bf16_f32 v122, v154, v155
    v_mul_f32 v156, v238, v156
    v_mul_f32 v114, 0x3baaaaab, v126
    v_rsq_f32 v114, v114
    v_mul_f32 v157, v238, v157
    v_mul_f32 v150, v114, v150
    v_mul_f32 v151, v114, v151
    v_cvt_pk_bf16_f32 v118, v150, v151
    v_mul_f32 v152, v114, v152
    v_mul_f32 v153, v114, v153
    v_cvt_pk_bf16_f32 v119, v152, v153
    v_mul_f32 v170, v114, v170
    v_mul_f32 v171, v114, v171
    v_cvt_pk_bf16_f32 v120, v170, v171
    v_mul_f32 v172, v114, v172
    v_mul_f32 v173, v114, v173
    v_cvt_pk_bf16_f32 v121, v172, v173
    buffer_store_dwordx4 v[118:121], v207, s[12:15], 0 offen nt
    v_mul_f32 v178, v114, v178
    v_mul_f32 v179, v114, v179
    v_cvt_pk_bf16_f32 v154, v178, v179
    v_mul_f32 v180, v114, v180
    v_mul_f32 v181, v114, v181
    v_cvt_pk_bf16_f32 v155, v180, v181
    v_cvt_pk_bf16_f32 v123, v156, v157
    v_mul_f32 v166, v238, v166
    v_mul_f32 v167, v238, v167
    v_cvt_pk_bf16_f32 v124, v166, v167
    v_mul_f32 v168, v238, v168
    v_mul_f32 v169, v238, v169
    v_cvt_pk_bf16_f32 v125, v168, v169
    ds_write_b128 v255, v[122:125] offset:3072
    v_mul_f32 v162, v238, v162
    v_mul_f32 v163, v238, v163
    v_cvt_pk_bf16_f32 v156, v162, v163
    v_mul_f32 v164, v238, v164
    v_mul_f32 v165, v238, v165
    v_cvt_pk_bf16_f32 v157, v164, v165
    buffer_store_dwordx2 v[154:155], v240, s[12:15], 0 offen nt
    ds_read_b128 v[118:121], v254 offset:3072
    ds_write_b64 v115, v[156:157] offset:4096
    ds_read_b64 v[254:255], v241 offset:4096
    s_waitcnt lgkmcnt(2)
    buffer_store_dwordx4 v[118:121], v116, s[56:59], 0 offen nt
    s_waitcnt lgkmcnt(0)
    buffer_store_dwordx2 v[254:255], v239, s[56:59], 0 offen nt
L_end:
    s_nop 1
    s_cmp_lg_u64 s[46:47], 0
    s_cbranch_scc1 L_rerun
L_done:
    s_endpgm
L_rerun:
    s_mov_b32 s44, 0x7f000000
    s_lshr_b32 s100, s70, 20
    s_waitcnt vmcnt(0) lgkmcnt(0)
    s_barrier
    v_mbcnt_lo_u32_b32 v0, -1, 0
    v_mbcnt_hi_u32_b32 v0, -1, v0
    v_lshl_add_u32 v0, s16, 6, v0
    s_nop 7
    s_branch L_again
L_edge:
    v_mov_b32 v254, v0
    v_mov_b32 v255, 0x40000000
    s_lshl_b32 s3, s16, 4
    s_load_dwordx4 s[92:95], s[0:1], s3
    v_and_b32 v114, 63, v0
    s_bfe_u32 s3, s2, 0x50003
    s_lshl_b32 s4, s16, 3
    s_lshr_b32 s98, 0x06143a01, s4
    s_and_b32 s98, s98, 0xff
    s_mul_i32 s3, s3, s98
    s_sub_u32 s98, s98, 1
    s_lshr_b32 s4, 0x0048d800, s4
    s_and_b32 s4, s4, 0xff
    s_lshl_b32 s4, s4, 3
    s_max_u32 s4, s4, 6
    s_sub_u32 s4, s4, s98
    s_sub_u32 s4, s4, 1
    s_min_u32 s3, s3, s4
    v_min_u32 v116, s98, v114
    v_add_lshl_u32 v116, v116, s3, 7
    v_mov_b32 v117, 0
    v_lshrrev_b32 v115, 4, v114
    v_and_b32 v118, 15, v114
    s_mov_b32 s10, 100270464
    s_mov_b32 s11, 0x00020000
    s_mov_b32 s50, 36096
    s_mov_b32 s51, 0x00020000
    s_mul_i32 s3, s16, 96
    v_lshl_add_u32 v119, v114, 4, s3
    v_mul_u32_u24 v120, 171, v114
    v_lshrrev_b32 v120, 10, v120
    v_lshrrev_b32 v121, 1, v120
    v_xor_b32 v121, v121, v120
    v_and_b32 v121, 4, v121
    v_mul_u32_u24 v121, 3, v121
    v_xor_b32 v121, v121, v120
    v_mul_u32_u24 v121, 1152, v121
    v_mul_u32_u24 v126, 96, v120
    v_sub_u32 v121, v121, v126
    v_add_u32 v126, v119, v121
    v_add_u32 v121, 64, v114
    v_mul_u32_u24 v121, 171, v121
    v_lshrrev_b32 v121, 10, v121
    v_lshrrev_b32 v127, 1, v121
    v_xor_b32 v127, v127, v121
    v_and_b32 v127, 4, v127
    v_mul_u32_u24 v127, 3, v127
    v_xor_b32 v127, v127, v121
    v_mul_u32_u24 v127, 1152, v127
    v_mul_u32_u24 v128, 96, v121
    v_sub_u32 v127, v127, v128
    v_add_u32 v128, v119, v127
    v_add_u32 v127, 128, v114
    v_mul_u32_u24 v127, 171, v127
    v_lshrrev_b32 v127, 10, v127
    v_lshrrev_b32 v129, 1, v127
    v_xor_b32 v129, v129, v127
    v_and_b32 v129, 4, v129
    v_mul_u32_u24 v129, 3, v129
    v_xor_b32 v129, v129, v127
    v_mul_u32_u24 v129, 1152, v129
    v_mul_u32_u24 v130, 96, v127
    v_sub_u32 v129, v129, v130
    v_add_u32 v130, v119, v129
    s_mul_i32 s68, s16, 6144
    s_add_u32 s69, s68, 65536
    s_cmp_eq_u32 s16, 3
    s_cselect_b32 s68, 149696, s68
    s_cselect_b32 s69, 155840, s69
    s_mov_b32 s70, 193536
    s_mov_b32 s36, 100270464
    s_mov_b32 s22, 1180032
    s_mul_i32 s3, s2, 911
    s_lshr_b32 s3, s3, 16
    s_mul_i32 s35, s3, 72
    s_sub_u32 s38, s2, s35
    s_mul_i32 s3, s3, 1373568
    s_mul_i32 s35, s38, 2688
    s_add_u32 s3, s3, s35
    s_add_u32 s25, s3, 589824
    s_add_u32 s7, s3, 1769472
    s_mov_b32 s20, 31
    s_mov_b32 s21, 4204032
    s_mov_b32 s17, 20
    s_cmp_lt_u32 s2, 240
    s_cselect_b32 s45, 28, 24
    s_mov_b32 s5, 0
    s_mov_b32 s6, 0
    s_cmp_lt_u32 s2, 247
    s_cbranch_scc1 L_inner
    s_mov_b32 s20, 0
    s_mov_b32 s38, 0
    s_sub_u32 s3, s2, 247
    s_and_b32 s3, s3, 3
    s_mul_i32 s3, s3, 7
    s_add_u32 s3, s3, 3
    s_mov_b32 s35, 196224
    s_cmp_lt_u32 s2, 251
    s_cselect_b32 s35, s35, 384
    s_cselect_b32 s6, 1, 0
    s_cselect_b32 s5, 0, 1
    s_mul_i32 s25, s3, s35
    s_mul_i32 s21, s35, 28
    s_cmp_lt_u32 s2, 255
    s_cselect_b32 s17, 18, 1
    s_cselect_b32 s45, 18, 1
    s_cselect_b32 s25, s25, 0
    s_cselect_b32 s6, s6, 1
    s_add_u32 s7, s25, 1179648
L_inner:
    s_mul_i32 s3, s5, 99485568
    s_mul_i32 s35, s5, -784896
    v_mov_b32 v119, s3
    v_mov_b32 v129, s35
    s_add_u32 s7, s7, s35
    s_mul_i32 s3, s6, 194688
    s_mul_i32 s35, s6, -1536
    v_mov_b32 v131, s3
    v_mov_b32 v132, s35
    s_add_u32 s7, s7, s35
    s_bfm_b32 s34, s45, 0
    s_and_b32 s4, s2, 7
    s_sub_u32 s4, 0, s4
    v_mul_u32_u24 v133, 2731, v254
    v_bfe_u32 v142, v133, 17, 3
    v_lshrrev_b32 v133, 16, v133
    v_xor_b32 v143, v142, v254
    v_mul_u32_u24 v142, 37, v133
    v_lshrrev_b32 v142, 8, v142
    v_lshlrev_b32 v143, 4, v143
    v_mad_u32_u24 v10, v142, s70, v143
    v_mul_u32_u24 v142, 37, v133
    v_lshrrev_b32 v142, 8, v142
    v_mul_u32_u24 v144, 7, v142
    v_sub_u32 v144, v133, v144
    v_cmp_gt_u32 vcc, 4, v142
    s_nop 1
    v_cndmask_b32 v142, v129, v119, vcc
    v_cmp_gt_u32 vcc, 4, v144
    s_nop 1
    v_cndmask_b32 v144, v132, v131, vcc
    v_add3_u32 v10, v10, v142, v144
    v_mul_u32_u24 v142, s20, v133
    v_add_u32 v142, s38, v142
    v_mul_u32_u24 v144, 911, v142
    v_lshrrev_b32 v144, 16, v144
    v_mul_u32_u24 v144, s22, v144
    v_mad_u32_u24 v144, v133, s21, v144
    v_bfe_u32 v142, s34, v133, 1
    v_cmp_ne_u32 vcc, 0, v142
    v_add_u32 v142, s7, v144
    s_nop 0
    v_cndmask_b32 v142, v255, v142, vcc
    v_mul_u32_u24 v133, 384, v133
    v_sub_u32 v133, v143, v133
    v_add_u32 v142, v142, v133
    v_add_u32 v133, 256, v254
    v_mul_u32_u24 v143, 2731, v133
    v_bfe_u32 v144, v143, 17, 3
    v_lshrrev_b32 v143, 16, v143
    v_xor_b32 v133, v144, v133
    v_mul_u32_u24 v144, 37, v143
    v_lshrrev_b32 v144, 8, v144
    v_lshlrev_b32 v133, 4, v133
    v_mad_u32_u24 v11, v144, s70, v133
    v_mul_u32_u24 v144, 37, v143
    v_lshrrev_b32 v144, 8, v144
    v_mul_u32_u24 v145, 7, v144
    v_sub_u32 v145, v143, v145
    v_cmp_gt_u32 vcc, 4, v144
    s_nop 1
    v_cndmask_b32 v144, v129, v119, vcc
    v_cmp_gt_u32 vcc, 4, v145
    s_nop 1
    v_cndmask_b32 v145, v132, v131, vcc
    v_add3_u32 v11, v11, v144, v145
    v_min_u32 v144, 20, v143
    v_add_u32 v145, 12, v143
    v_lshrrev_b32 v145, 5, v145
    v_sub_u32 v146, v143, v144
    v_mad_i32_i24 v146, v145, s4, v146
    v_mul_u32_u24 v147, s20, v144
    v_add3_u32 v147, v147, v146, s38
    v_mul_u32_u24 v145, 911, v147
    v_lshrrev_b32 v145, 16, v145
    v_mul_u32_u24 v145, s22, v145
    v_mad_u32_u24 v145, v144, s21, v145
    v_bfe_u32 v147, s34, v143, 1
    v_cmp_ne_u32 vcc, 0, v147
    v_mul_i32_i24 v146, 2688, v146
    v_add3_u32 v144, v145, v146, s7
    v_cndmask_b32 v144, v255, v144, vcc
    v_mul_u32_u24 v143, 384, v143
    v_sub_u32 v143, v133, v143
    v_add_u32 v144, v144, v143
    v_add_u32 v133, 512, v254
    v_mul_u32_u24 v143, 2731, v133
    v_bfe_u32 v145, v143, 17, 3
    v_lshrrev_b32 v143, 16, v143
    v_xor_b32 v133, v145, v133
    v_mul_u32_u24 v145, 37, v143
    v_lshrrev_b32 v145, 8, v145
    v_lshlrev_b32 v133, 4, v133
    v_mad_u32_u24 v12, v145, s70, v133
    v_mul_u32_u24 v145, 37, v143
    v_lshrrev_b32 v145, 8, v145
    v_mul_u32_u24 v146, 7, v145
    v_sub_u32 v146, v143, v146
    v_cmp_gt_u32 vcc, 4, v145
    s_nop 1
    v_cndmask_b32 v145, v129, v119, vcc
    v_cmp_gt_u32 vcc, 4, v146
    s_nop 1
    v_cndmask_b32 v146, v132, v131, vcc
    v_add3_u32 v12, v12, v145, v146
    v_min_u32 v145, 20, v143
    v_add_u32 v146, 12, v143
    v_lshrrev_b32 v146, 5, v146
    v_sub_u32 v147, v143, v145
    v_mad_i32_i24 v147, v146, s4, v147
    v_mul_u32_u24 v148, s20, v145
    v_add3_u32 v148, v148, v147, s38
    v_mul_u32_u24 v146, 911, v148
    v_lshrrev_b32 v146, 16, v146
    v_mul_u32_u24 v146, s22, v146
    v_mad_u32_u24 v146, v145, s21, v146
    v_bfe_u32 v148, s34, v143, 1
    v_cmp_ne_u32 vcc, 0, v148
    v_mul_i32_i24 v147, 2688, v147
    v_add3_u32 v145, v146, v147, s7
    v_cndmask_b32 v145, v255, v145, vcc
    v_mul_u32_u24 v143, 384, v143
    v_sub_u32 v143, v133, v143
    v_add_u32 v145, v145, v143
    s_lshl_b32 s28, s16, 10
    s_add_u32 s28, s28, 20480
    s_waitcnt lgkmcnt(0)
    s_load_dword s101, s[92:93], 0
    s_load_dword s101, s[94:95], 0
    s_cmp_eq_u32 s16, 2
    s_cselect_b64 s[98:99], s[80:81], s[78:79]
    s_cmp_eq_u32 s16, 3
    s_cselect_b64 s[98:99], s[88:89], s[98:99]
    s_mov_b64 s[8:9], s[76:77]
    v_lshl_add_u64 v[116:117], s[98:99], 0, v[116:117]
    s_cmp_eq_u32 s16, 2
    s_cselect_b64 s[98:99], s[84:85], s[82:83]
    s_cmp_eq_u32 s16, 3
    s_cselect_b64 s[98:99], s[86:87], s[98:99]
    v_writelane_b32 v116, s98, 63
    v_writelane_b32 v117, s99, 63
    s_cmp_eq_u32 s16, 0
    s_cbranch_scc1 L_nowue
    global_load_dword a254, v[116:117], off
L_nowue:
    s_add_u32 m0, s28, 65536
    s_nop 0
    buffer_load_dwordx4 v142, s[8:11], 0 offen nt lds
    s_add_u32 m0, s28, 69632
    s_nop 0
    buffer_load_dwordx4 v144, s[8:11], 0 offen lds
    s_add_u32 m0, s28, 73728
    s_nop 0
    buffer_load_dwordx4 v145, s[8:11], 0 offen lds
    s_add_u32 m0, s28, 0
    s_nop 0
    buffer_load_dwordx4 v10, s[8:11], s25 offen nt lds
    s_add_u32 m0, s28, 4096
    s_nop 0
    buffer_load_dwordx4 v11, s[8:11], s25 offen nt lds
    s_mov_b64 s[48:49], s[78:79]
    s_mov_b64 s[52:53], s[80:81]
    s_mov_b64 s[60:61], s[84:85]
    s_mov_b64 s[64:65], s[86:87]
    s_mov_b64 s[56:57], s[88:89]
    s_mov_b64 s[46:47], s[82:83]
    s_load_dwordx4 s[40:43], s[0:1], 72
    s_add_u32 s48, s48, 384
    s_addc_u32 s49, s49, 0
    s_add_u32 m0, s68, 0
    v_lshlrev_b32 v133, 1, v115
    s_mov_b32 s54, 12288
    s_mov_b32 s55, 0x00020000
    s_mov_b32 s62, 64
    s_mov_b32 s63, 0x00020000
    s_mov_b32 s66, 128
    s_mov_b32 s67, 0x00020000
    s_mov_b32 s58, 676
    s_mov_b32 s59, 0x00020000
    s_mov_b32 s14, 0
    s_mov_b32 s15, 0x00020000
    s_mul_i32 s90, s16, 16
    v_mov_b32 v117, 0
    v_cmp_lt_u32 s[92:93], 7, v118
    v_mov_b32 v135, 0
    v_mov_b32 v125, 0
    v_mov_b32 v123, 0
    v_lshlrev_b32 v122, 1, v114
    v_mul_u32_u24 v124, 12, v118
    s_mul_i32 s71, s16, 192
    v_add_u32 v124, s71, v124
    v_lshlrev_b32 v134, 5, v115
    s_mul_i32 s72, s16, 9408
    s_add_u32 s72, s72, 104448
    s_mul_i32 s73, s16, 7616
    s_add_u32 s73, s73, 38912
    s_cmp_eq_u32 s16, 3
    s_cselect_b32 s73, 142080, s73
    v_lshrrev_b32 v136, 2, v118
    v_and_b32 v137, 1, v136
    v_mul_u32_u24 v137, 0x020202, v137
    v_lshl_or_b32 v137, v137, 8, v137
    v_add_u32 v137, 0x05040100, v137
    v_and_b32 v138, 3, v118
    v_lshrrev_b32 v116, 1, v118
    v_xor_b32 v116, v116, v115
    v_mul_u32_u24 v139, 384, v118
    v_lshl_add_u32 v0, v116, 4, v139
    v_xor_b32 v1, 64, v0
    v_and_b32 v116, 2, v115
    v_add_u32 v116, v116, v115
    v_lshl_add_u32 v116, v116, 2, v136
    v_mul_u32_u24 v116, 96, v116
    v_lshl_add_u32 v116, v138, 3, v116
    v_add_u32 v141, s68, v116
    v_add_u32 v139, s69, v116
    v_add_u32 v140, s72, v116
    v_add_u32 v142, s73, v116
    v_mov_b32 v28, 0x3f803f80
    v_mov_b32 v29, 0x3f803f80
    v_mov_b32 v30, 0x3f803f80
    v_mov_b32 v31, 0x3f803f80
    v_mul_u32_u24 v143, 768, v115
    v_add_u32 v143, v124, v143
    v_add_u32 v143, 98304, v143
    s_mov_b32 s76, 0x3f80
    v_and_b32 v116, 1, v118
    v_lshlrev_b32 v116, 4, v116
    v_lshlrev_b32 v144, v116, s76
    v_mov_b32 v145, 0x3c003c00
    v_mov_b32 v44, 1.0
    v_lshlrev_b32 v146, 4, v115
    s_mov_b32 s19, s38
    s_mov_b32 s23, s25
    s_mov_b32 s26, 0
    s_mov_b32 s27, 0
    s_mov_b32 s18, 0
    s_add_u32 s19, s19, s20
    s_add_u32 s23, s23, s21
    s_cmp_ge_u32 s19, 72
    s_cselect_b32 s34, 72, 0
    s_cselect_b32 s35, s22, 0
    s_sub_u32 s19, s19, s34
    s_add_u32 s23, s23, s35
    s_mov_b32 s24, s23
    s_add_u32 s19, s19, s20
    s_add_u32 s23, s23, s21
    s_cmp_ge_u32 s19, 72
    s_cselect_b32 s34, 72, 0
    s_cselect_b32 s35, s22, 0
    s_sub_u32 s19, s19, s34
    s_add_u32 s23, s23, s35
    s_mul_i32 s79, s16, 64
    v_lshl_add_u32 v147, v115, 4, s79
    s_mul_i32 s80, s16, 32
    s_add_u32 s80, s80, 256
    v_lshl_add_u32 v149, v115, 3, s80
    v_add_u32 v151, 0, v118
    v_mul_u32_u24 v148, 37, v151
    v_mul_u32_u24 v150, 384, v151
    v_lshrrev_b32 v148, 8, v148
    v_mad_u32_u24 v150, v148, s70, v150
    v_add_u32 v15, v150, v147
    v_add_u32 v18, v150, v149
    v_mul_u32_u24 v150, 37, v151
    v_lshrrev_b32 v150, 8, v150
    v_mul_u32_u24 v153, 7, v150
    v_sub_u32 v153, v151, v153
    v_add_u32 v152, 16, v118
    v_mul_u32_u24 v155, 37, v152
    v_mul_u32_u24 v154, 384, v152
    v_lshrrev_b32 v155, 8, v155
    v_mad_u32_u24 v154, v155, s70, v154
    v_add_u32 v16, v154, v147
    v_add_u32 v19, v154, v149
    v_mul_u32_u24 v154, 37, v152
    v_lshrrev_b32 v154, 8, v154
    v_mul_u32_u24 v157, 7, v154
    v_sub_u32 v157, v152, v157
    v_add_u32 v159, 32, v118
    v_mul_u32_u24 v158, 37, v159
    v_mul_u32_u24 v156, 384, v159
    v_lshrrev_b32 v158, 8, v158
    v_mad_u32_u24 v156, v158, s70, v156
    v_add_u32 v17, v156, v147
    v_add_u32 v20, v156, v149
    v_mul_u32_u24 v156, 37, v159
    v_lshrrev_b32 v156, 8, v156
    v_mul_u32_u24 v147, 7, v156
    v_sub_u32 v147, v159, v147
    s_mul_i32 s81, s16, 768
    s_add_u32 s81, s81, 98304
    v_mul_u32_u24 v148, 24, v148
    v_lshl_add_u32 v148, v151, 2, v148
    v_add_u32 v22, s81, v148
    v_sub_u32 v23, s81, v148
    v_sub_u32 v148, v22, v146
    v_mul_u32_u24 v155, 24, v155
    v_lshl_add_u32 v155, v152, 2, v155
    v_add_u32 v24, s81, v155
    v_sub_u32 v25, s81, v155
    v_sub_u32 v149, v24, v146
    v_mul_u32_u24 v155, 24, v158
    v_lshl_add_u32 v155, v159, 2, v155
    v_add_u32 v26, s81, v155
    v_sub_u32 v27, s81, v155
    v_sub_u32 v155, v26, v146
    v_mul_u32_u24 v158, 148, v115
    s_mov_b32 s82, -24
    v_add_u32 v160, 0, v158
    v_lshrrev_b32 v160, 8, v160
    v_mad_i32_i24 v46, v160, s82, v148
    v_mad_i32_i24 v58, v160, s82, v149
    v_mad_i32_i24 v70, v160, s82, v155
    v_add_u32 v160, 37, v158
    v_lshrrev_b32 v160, 8, v160
    v_mad_i32_i24 v47, v160, s82, v148
    v_mad_i32_i24 v59, v160, s82, v149
    v_mad_i32_i24 v71, v160, s82, v155
    v_add_u32 v160, 74, v158
    v_lshrrev_b32 v160, 8, v160
    v_mad_i32_i24 v48, v160, s82, v148
    v_mad_i32_i24 v60, v160, s82, v149
    v_mad_i32_i24 v72, v160, s82, v155
    v_add_u32 v160, 111, v158
    v_lshrrev_b32 v160, 8, v160
    v_mad_i32_i24 v49, v160, s82, v148
    v_mad_i32_i24 v61, v160, s82, v149
    v_mad_i32_i24 v73, v160, s82, v155
    v_add_u32 v160, 592, v158
    v_lshrrev_b32 v160, 8, v160
    v_mad_i32_i24 v50, v160, s82, v148
    v_mad_i32_i24 v62, v160, s82, v149
    v_mad_i32_i24 v74, v160, s82, v155
    v_add_u32 v160, 629, v158
    v_lshrrev_b32 v160, 8, v160
    v_mad_i32_i24 v51, v160, s82, v148
    v_mad_i32_i24 v63, v160, s82, v149
    v_mad_i32_i24 v75, v160, s82, v155
    v_add_u32 v160, 666, v158
    v_lshrrev_b32 v160, 8, v160
    v_mad_i32_i24 v52, v160, s82, v148
    v_mad_i32_i24 v64, v160, s82, v149
    v_mad_i32_i24 v76, v160, s82, v155
    v_add_u32 v160, 703, v158
    v_lshrrev_b32 v160, 8, v160
    v_mad_i32_i24 v53, v160, s82, v148
    v_mad_i32_i24 v65, v160, s82, v149
    v_mad_i32_i24 v77, v160, s82, v155
    v_add_u32 v160, 1184, v158
    v_lshrrev_b32 v160, 8, v160
    v_mad_i32_i24 v54, v160, s82, v148
    v_mad_i32_i24 v66, v160, s82, v149
    v_mad_i32_i24 v78, v160, s82, v155
    v_add_u32 v160, 1221, v158
    v_lshrrev_b32 v160, 8, v160
    v_mad_i32_i24 v55, v160, s82, v148
    v_mad_i32_i24 v67, v160, s82, v149
    v_mad_i32_i24 v79, v160, s82, v155
    v_add_u32 v160, 1258, v158
    v_lshrrev_b32 v160, 8, v160
    v_mad_i32_i24 v56, v160, s82, v148
    v_mad_i32_i24 v68, v160, s82, v149
    v_mad_i32_i24 v80, v160, s82, v155
    v_add_u32 v158, 1295, v158
    v_lshrrev_b32 v158, 8, v158
    v_mad_i32_i24 v57, v158, s82, v148
    v_mad_i32_i24 v69, v158, s82, v149
    v_mad_i32_i24 v81, v158, s82, v155
    v_mov_b32 v155, s81
    v_lshlrev_b32 v148, 4, v114
    v_xor_b32 v2, 65536, v148
    v_lshl_add_u32 v3, s16, 10, v148
    s_lshr_b32 s83, s16, 1
    s_and_b32 s84, s16, 1
    s_lshl_b32 s84, s84, 3
    s_lshl_b32 s85, s83, 10
    s_add_u32 s85, s85, s84
    v_add_u32 v4, s85, v148
    s_lshl_b32 s83, s83, 11
    s_add_u32 s83, s83, s84
    s_add_u32 s83, s83, 157888
    s_mul_i32 s86, s16, 2048
    s_add_u32 s86, s86, 149696
    v_lshl_add_u32 v160, v115, 3, s86
    v_mov_b32 v148, s83
    v_mov_b32 v149, 163264
    v_mul_u32_u24 v158, 80, v115
    v_add3_u32 v5, v158, v116, s72
    v_lshl_add_u32 v6, v118, 2, s73
    s_mul_i32 s87, s16, 128
    s_add_u32 s87, s87, 61760
    s_mov_b32 s32, 0x2a8cbccc
    s_mov_b32 s33, 0x38fba882
    s_add_u32 s75, s28, 16384
    s_cmp_lt_u32 s16, 2
    s_cselect_b32 s29, s75, 161984
    s_cselect_b32 s30, 65536, 0
    s_xor_b32 s74, s29, s30
    s_lshl_b32 s94, s5, 1
    s_or_b32 s94, s94, s6
    s_mul_i32 s77, s16, 64
    s_mul_i32 s78, s16, 32
    s_add_u32 s78, s78, 192
    s_add_u32 s34, s18, 2
    s_mov_b32 s27, s26
    s_mov_b32 s26, s25
    s_add_u32 s19, s19, s20
    s_mov_b32 s18, 1
    s_mov_b32 s71, 1
    buffer_load_dwordx4 v126, s[48:51], 0 offen lds
    v_add_u32 v9, s87, v146
    v_lshrrev_b32 v116, 1, v115
    v_mul_u32_u24 v116, 48, v116
    buffer_load_dwordx4 v128, s[48:51], 0 offen offset:1024 lds
    v_lshl_add_u32 v116, v115, 3, v116
    v_lshl_add_u32 v116, v136, 4, v116
    v_lshl_add_u32 v116, v138, 1, v116
    buffer_load_dwordx4 v130, s[48:51], 0 offen offset:2048 lds
    s_add_u32 s48, s48, 36864
    s_addc_u32 s49, s49, 0
    s_add_u32 m0, s68, 3072
    v_add_u32 v8, s87, v116
    buffer_load_dwordx4 v126, s[48:51], 0 offen lds
    v_mov_b32 v37, 0
    v_mov_b32 v38, 0
    v_mov_b32 v39, 0
    buffer_load_dwordx4 v128, s[48:51], 0 offen offset:1024 lds
    v_add_u32 v161, 86016, v0
    v_add_u32 v174, 86016, v1
    v_lshlrev_b32 v162, 4, v118
    buffer_load_dwordx4 v130, s[48:51], 0 offen offset:2048 lds
    s_add_u32 s48, s48, 36864
    s_addc_u32 s49, s49, 0
    s_add_u32 m0, s69, 0
    buffer_load_ushort v116, v122, s[60:63], 0 offen
    s_mov_b64 s[60:61], s[8:9]
    s_sub_u32 s62, s45, s17
    s_sub_u32 s45, s17, 1
    buffer_load_dwordx3 v[166:168], v124, s[56:59], 0 offen
    v_add_u32 v162, 161984, v162
    buffer_load_dwordx4 v[170:173], v134, s[64:67], 0 offen
    v_mul_u32_u24 v175, 336, v118
    v_add3_u32 v175, v175, v158, s72
    v_mul_u32_u24 v158, 272, v118
    v_add3_u32 v158, v158, v146, s73
    v_mul_u32_u24 v177, 1088, v115
    v_add_u32 v177, v177, v6
    v_add_u32 v176, 5376, v175
    buffer_load_dwordx4 v[186:189], v134, s[64:67], 0 offen offset:16
    v_add_u32 v179, 4352, v158
    v_add_u32 v178, 4352, v177
    v_cmp_gt_u32 s[88:89], 16, v114
    v_mov_b32 v180, 0xf149f2ca
    v_add_u32 v134, 768, v254
    v_mul_u32_u24 v169, 2731, v134
    v_bfe_u32 v181, v169, 17, 3
    v_lshrrev_b32 v169, 16, v169
    v_xor_b32 v134, v181, v134
    v_mul_u32_u24 v181, 37, v169
    v_lshrrev_b32 v181, 8, v181
    v_lshlrev_b32 v134, 4, v134
    v_mad_u32_u24 v13, v181, s70, v134
    v_mul_u32_u24 v181, 37, v169
    v_lshrrev_b32 v181, 8, v181
    v_mul_u32_u24 v134, 7, v181
    v_sub_u32 v134, v169, v134
    v_cmp_gt_u32 vcc, 4, v181
    v_add_u32 v169, 1024, v254
    v_mul_u32_u24 v254, 2731, v169
    v_cndmask_b32 v181, v129, v119, vcc
    v_cmp_gt_u32 vcc, 4, v134
    v_bfe_u32 v122, v254, 17, 3
    v_lshrrev_b32 v254, 16, v254
    v_cndmask_b32 v134, v132, v131, vcc
    v_add3_u32 v13, v13, v181, v134
    v_xor_b32 v169, v122, v169
    v_mul_u32_u24 v122, 37, v254
    v_lshrrev_b32 v122, 8, v122
    v_lshlrev_b32 v169, 4, v169
    v_mad_u32_u24 v14, v122, s70, v169
    v_mul_u32_u24 v169, 37, v254
    v_lshrrev_b32 v169, 8, v169
    v_mul_u32_u24 v134, 7, v169
    v_sub_u32 v134, v254, v134
    v_cmp_gt_u32 vcc, 4, v169
    v_mov_b32 v163, 0xc31044fe
    v_mul_u32_u24 v181, 37, v151
    v_cndmask_b32 v169, v129, v119, vcc
    v_cmp_gt_u32 vcc, 4, v134
    v_lshrrev_b32 v181, 8, v181
    v_mul_u32_u24 v122, 7, v181
    v_cndmask_b32 v134, v132, v131, vcc
    v_add3_u32 v14, v14, v169, v134
    v_cmp_gt_u32 vcc, 48, v254
    v_sub_u32 v122, v151, v122
    v_lshrrev_b32 v181, 2, v181
    v_cndmask_b32 v14, v255, v14, vcc
    v_cmp_gt_u32 vcc, 2, v138
    v_lshrrev_b32 v122, 2, v122
    v_and_b32 v181, s5, v181
    v_cndmask_b32 v32, 0, v144, vcc
    v_cndmask_b32 v33, v144, 0, vcc
    v_cndmask_b32 v34, 0, v144, vcc
    v_cndmask_b32 v35, v144, 0, vcc
    v_cmp_eq_u32 vcc, 0, v138
    v_and_b32 v122, s6, v122
    v_lshl_or_b32 v181, v181, 1, v122
    v_cndmask_b32 v40, 0, v145, vcc
    v_cmp_eq_u32 vcc, 1, v138
    v_mul_u32_u24 v254, 37, v152
    v_lshrrev_b32 v254, 8, v254
    v_cndmask_b32 v41, 0, v145, vcc
    v_cmp_eq_u32 vcc, 2, v138
    v_mul_u32_u24 v134, 7, v254
    v_sub_u32 v134, v152, v134
    s_bfm_b32 s70, s17, 0
    s_waitcnt vmcnt(9)
    s_barrier
    global_load_ushort v133, v133, s[46:47]
    v_cndmask_b32 v42, 0, v145, vcc
    v_cmp_eq_u32 vcc, 3, v138
    v_lshrrev_b32 v254, 2, v254
    v_lshrrev_b32 v134, 2, v134
    v_cndmask_b32 v43, 0, v145, vcc
    v_cmp_eq_u32 vcc, v115, v136
    v_and_b32 v254, s5, v254
    v_and_b32 v134, s6, v134
    v_cndmask_b32 v144, 0, v32, vcc
    v_cndmask_b32 v145, 0, v33, vcc
    v_lshl_or_b32 v254, v254, 1, v134
    buffer_load_dwordx4 v126, s[48:51], 0 offen lds
    v_mul_u32_u24 v255, 37, v159
    v_lshrrev_b32 v255, 8, v255
    v_mul_u32_u24 v134, 7, v255
    v_sub_u32 v134, v159, v134
    v_lshrrev_b32 v255, 2, v255
    v_lshrrev_b32 v134, 2, v134
    v_and_b32 v255, s5, v255
    v_and_b32 v134, s6, v134
    v_lshl_or_b32 v255, v255, 1, v134
    v_mul_u32_u24 v134, 6, v120
    v_sub_u32 v159, v114, v134
    v_mul_u32_u24 v134, 384, v120
    v_lshl_add_u32 v134, v159, 4, v134
    v_add_u32 v120, s78, v134
    v_add_u32 v134, s77, v134
    buffer_load_dwordx4 v128, s[48:51], 0 offen offset:1024 lds
    s_waitcnt vmcnt(10)
    ds_read_b64_tr_b16 a[72:73], v141 offset:0
    ds_read_b64_tr_b16 a[74:75], v141 offset:768
    ds_read_b64_tr_b16 a[96:97], v141 offset:32
    ds_read_b64_tr_b16 a[98:99], v141 offset:800
    ds_read_b64_tr_b16 a[120:121], v141 offset:64
    ds_read_b64_tr_b16 a[122:123], v141 offset:832
    v_cmp_gt_i32 vcc, 4, v159
    v_mul_u32_u24 v159, 6, v121
    v_sub_u32 v169, v114, v159
    v_cndmask_b32 v120, v120, v134, vcc
    v_mul_u32_u24 v159, 384, v121
    v_lshl_add_u32 v159, v169, 4, v159
    v_add_u32 v134, s78, v159
    v_add_u32 v159, s77, v159
    buffer_load_dwordx4 v130, s[48:51], 0 offen offset:2048 lds
    s_add_u32 s48, s48, 36864
    s_addc_u32 s49, s49, 0
    s_add_u32 m0, s69, 3072
    v_cmp_gt_i32 vcc, -60, v169
    v_mul_u32_u24 v121, 6, v127
    v_sub_u32 v114, v114, v121
    v_cndmask_b32 v159, v134, v159, vcc
    v_mul_u32_u24 v121, 384, v127
    v_lshl_add_u32 v121, v114, 4, v121
    v_add_u32 v127, s78, v121
    v_add_u32 v121, s77, v121
    v_cmp_gt_i32 vcc, -124, v114
    v_mul_u32_u24 v114, 96, v118
    v_add3_u32 v182, v114, v146, s68
    v_cndmask_b32 v121, v127, v121, vcc
    s_and_b32 s77, s2, 0xf8
    s_add_u32 s77, s77, 4940
    s_mul_i32 s78, s77, 58255
    s_lshr_b32 s78, s78, 22
    buffer_load_dwordx4 v126, s[48:51], 0 offen lds
    v_cmp_gt_u32 vcc, 4, v150
    v_lshl_add_u32 v127, v115, 3, v114
    v_add3_u32 v127, v127, 64, s68
    v_cndmask_b32 v150, v129, v119, vcc
    v_cmp_gt_u32 vcc, 4, v153
    v_add3_u32 v183, v114, v146, s69
    v_lshl_add_u32 v184, v115, 3, v114
    v_cndmask_b32 v153, v132, v131, vcc
    v_add3_u32 v15, v15, v150, v153
    s_waitcnt vmcnt(9)
    ds_read_b64_tr_b16 a[76:77], v141 offset:3072
    ds_read_b64_tr_b16 a[78:79], v141 offset:3840
    s_waitcnt vmcnt(7)
    ds_read_b64_tr_b16 a[100:101], v141 offset:3104
    s_waitcnt vmcnt(6)
    ds_read_b64_tr_b16 a[102:103], v141 offset:3872
    s_waitcnt vmcnt(5)
    buffer_load_dwordx4 v128, s[48:51], 0 offen offset:1024 lds
    ds_read_b64_tr_b16 a[124:125], v141 offset:3136
    ds_read_b64_tr_b16 a[126:127], v141 offset:3904
    v_cndmask_b32 v170, v170, v171, s[92:93]
    v_cndmask_b32 v172, v172, v173, s[92:93]
    v_perm_b32 v164, v172, v170, v137
    v_cndmask_b32 v186, v186, v187, s[92:93]
    v_cndmask_b32 v188, v188, v189, s[92:93]
    v_perm_b32 v165, v188, v186, v137
    v_bfe_u32 v134, v166, v146, 16
    v_bfe_u32 v124, v167, v146, 16
    v_bfe_u32 v122, v168, v146, 16
    v_mfma_f32_16x16x16_bf16 v[170:173], v[116:117], v[134:135], 0
    v_add3_u32 v18, v18, v150, v153
    v_cmp_gt_u32 vcc, 4, v154
    v_add3_u32 v184, v184, 64, s69
    v_mfma_f32_16x16x16_bf16 v[150:153], v[116:117], v[124:125], 0
    v_cndmask_b32 v154, v129, v119, vcc
    v_cmp_gt_u32 vcc, 4, v157
    v_mfma_f32_16x16x16_bf16 v[166:169], v[116:117], v[122:123], 0
    buffer_load_dwordx4 v130, s[48:51], 0 offen offset:2048 lds
    s_add_u32 s48, s48, 36864
    s_addc_u32 s49, s49, 0
    s_add_u32 m0, s72, 0
    v_max_f32 v170, 0, v170
    v_max_f32 v171, 0, v171
    v_max_f32 v172, 0, v172
    v_max_f32 v173, 0, v173
    v_cvt_pk_bf16_f32 v116, v170, v171
    v_cvt_pk_bf16_f32 v117, v172, v173
    v_max_f32 v150, 0, v150
    v_max_f32 v151, 0, v151
    s_waitcnt vmcnt(6)
    v_mfma_f32_16x16x16_bf16 v[122:125], v[164:165], v[116:117], 0
    v_lshlrev_b32 v133, 16, v133
    buffer_load_dwordx4 v126, s[48:51], 0 offen lds
    v_max_f32 v133, 0xc2c80000, v133
    v_min_f32 v133, 0x40930000, v133
    v_mul_f32 v133, 0x3fb8aa3b, v133
    v_exp_f32 v133, v133
    v_max_f32 v152, 0, v152
    v_cvt_pk_bf16_f32 v133, v133, v133
    v_and_b32 v133, 0xffff0000, v133
    v_mul_f32 v133, 0x3fb8aa3b, v133
    v_mul_f32 v146, 0xbea8f5c3, v133
    v_add_f32 v146, 0xc138aa3b, v146
    v_readlane_b32 s31, v133, s90
    v_cvt_pk_bf16_f32 v122, v122, v122
    v_and_b32 v122, 0xffff0000, v122
    v_mul_f32 v122, 0xbfb8aa3b, v122
    buffer_load_dwordx4 v128, s[48:51], 0 offen offset:1024 lds
    v_exp_f32 v122, v122
    v_max_f32 v153, 0, v153
    v_add_f32 v122, 1.0, v122
    v_rcp_f32 v122, v122
    v_cvt_pk_bf16_f32 v150, v150, v151
    v_cvt_pk_bf16_f32 v122, v122, v122
    v_and_b32 v122, 0xffff0000, v122
    v_fmamk_f32 v122, v122, 0x41b8aa3b, v146
    ds_write_b32 v143, v122 offset:0
    v_cvt_pk_bf16_f32 v151, v152, v153
    buffer_load_dwordx4 v130, s[48:51], 0 offen offset:2048 lds
    s_add_u32 s48, s48, 36864
    v_mfma_f32_16x16x16_bf16 v[122:125], v[164:165], v[150:151], 0
    s_addc_u32 s49, s49, 0
    s_add_u32 m0, s72, 3072
    v_max_f32 v166, 0, v166
    v_max_f32 v167, 0, v167
    v_max_f32 v168, 0, v168
    v_max_f32 v169, 0, v169
    v_cvt_pk_bf16_f32 v166, v166, v167
    s_waitcnt vmcnt(6)
    s_mov_b32 s72, 2
    ds_read_b64_tr_b16 a[80:81], v139 offset:0
    ds_read_b64_tr_b16 a[82:83], v139 offset:768
    ds_read_b64_tr_b16 a[104:105], v139 offset:32
    ds_read_b64_tr_b16 a[106:107], v139 offset:800
    ds_read_b64_tr_b16 a[128:129], v139 offset:64
    ds_read_b64_tr_b16 a[130:131], v139 offset:832
    buffer_load_dwordx4 v126, s[48:51], 0 offen lds
    v_cvt_pk_bf16_f32 v122, v122, v122
    v_and_b32 v122, 0xffff0000, v122
    v_mul_f32 v122, 0xbfb8aa3b, v122
    v_exp_f32 v122, v122
    v_cvt_pk_bf16_f32 v167, v168, v169
    v_add_f32 v122, 1.0, v122
    v_rcp_f32 v122, v122
    v_mfma_f32_16x16x16_bf16 v[150:153], v[164:165], v[166:167], 0
    v_cvt_pk_bf16_f32 v122, v122, v122
    v_and_b32 v122, 0xffff0000, v122
    v_fmamk_f32 v122, v122, 0x41b8aa3b, v146
    ds_write_b32 v143, v122 offset:4
    buffer_load_dwordx4 v128, s[48:51], 0 offen offset:1024 lds
    v_cndmask_b32 v157, v132, v131, vcc
    v_add3_u32 v16, v16, v154, v157
    v_add3_u32 v19, v19, v154, v157
    v_cvt_pk_bf16_f32 v150, v150, v150
    v_and_b32 v150, 0xffff0000, v150
    v_mul_f32 v150, 0xbfb8aa3b, v150
    v_exp_f32 v150, v150
    v_cmp_gt_u32 vcc, 4, v156
    v_add_f32 v150, 1.0, v150
    v_rcp_f32 v150, v150
    v_cndmask_b32 v156, v129, v119, vcc
    v_cvt_pk_bf16_f32 v150, v150, v150
    v_and_b32 v150, 0xffff0000, v150
    buffer_load_dwordx4 v130, s[48:51], 0 offen offset:2048 lds
    s_sub_u32 s48, s48, 184704
    s_subb_u32 s49, s49, 0
    s_add_u32 m0, s73, 0
    v_fmamk_f32 v150, v150, 0x41b8aa3b, v146
    ds_write_b32 v143, v150 offset:8
    v_cmp_gt_u32 vcc, 4, v147
    s_nop 0
    s_nop 0
    v_cndmask_b32 v147, v132, v131, vcc
    v_add3_u32 v17, v17, v156, v147
    v_add3_u32 v20, v20, v156, v147
    v_cmp_gt_u32 vcc, 2, v115
    buffer_load_dwordx4 v126, s[48:51], 0 offen lds
    s_waitcnt vmcnt(7)
    ds_read_b64_tr_b16 a[84:85], v139 offset:3072
    ds_read_b64_tr_b16 a[86:87], v139 offset:3840
    ds_read_b64_tr_b16 a[108:109], v139 offset:3104
    ds_read_b64_tr_b16 a[110:111], v139 offset:3872
    ds_read_b64_tr_b16 a[132:133], v139 offset:3136
    ds_read_b64_tr_b16 a[134:135], v139 offset:3904
    v_cndmask_b32 v160, v148, v160, vcc
    v_lshl_add_u32 v160, v136, 9, v160
    v_lshl_add_u32 v160, v138, 1, v160
    v_cmp_gt_u32 vcc, 3, v115
    s_nop 0
    s_nop 0
    v_cndmask_b32 v7, v149, v160, vcc
    v_cmp_gt_u32 vcc, 12, v118
    buffer_load_dwordx4 v128, s[48:51], 0 offen offset:1024 lds
    s_waitcnt lgkmcnt(6)
    s_barrier
    ds_read_b32 v22, v22 offset:0
    ds_read_b32 v23, v23 offset:672
    ds_read_b32 v24, v24 offset:0
    ds_read_b32 v25, v25 offset:672
    ds_read_b32 v26, v26 offset:0
    ds_read_b32 v27, v27 offset:672
    ds_read_b32 v46, v46 offset:336
    ds_read_b32 v58, v58 offset:336
    v_cndmask_b32 v176, v162, v176, vcc
    v_cndmask_b32 v179, v162, v179, vcc
    v_cmp_gt_u32 vcc, 3, v115
    ds_read_b32 v70, v70 offset:336
    ds_read_b32 v47, v47 offset:332
    buffer_load_dwordx4 v130, s[48:51], 0 offen offset:2048 lds
    ds_read_b32 v59, v59 offset:332
    ds_read_b32 v71, v71 offset:332
    ds_read_b32 v48, v48 offset:328
    ds_read_b32 v60, v60 offset:328
    s_add_u32 s48, s48, 36864
    ds_read_b32 v72, v72 offset:328
    s_addc_u32 s49, s49, 0
    ds_read_b32 v49, v49 offset:324
    s_add_u32 m0, s73, 3072
    ds_read_b32 v61, v61 offset:324
    v_cndmask_b32 v178, v162, v178, vcc
    s_mov_b32 s73, 3
    ds_read_b32 v73, v73 offset:324
    ds_read_b32 v50, v50 offset:272
    ds_read_b32 v62, v62 offset:272
    s_waitcnt vmcnt(6)
    buffer_load_dwordx4 v126, s[48:51], 0 offen lds
    ds_read_b64_tr_b16 a[88:89], v140 offset:0
    ds_read_b64_tr_b16 a[90:91], v140 offset:768
    ds_read_b64_tr_b16 a[112:113], v140 offset:32
    ds_read_b64_tr_b16 a[114:115], v140 offset:800
    ds_read_b64_tr_b16 a[136:137], v140 offset:64
    ds_read_b64_tr_b16 a[138:139], v140 offset:832
    ds_read_b32 v74, v74 offset:272
    ds_read_b32 v51, v51 offset:268
    ds_read_b32 v63, v63 offset:268
    buffer_load_dwordx4 v128, s[48:51], 0 offen offset:1024 lds
    ds_read_b32 v75, v75 offset:268
    ds_read_b32 v52, v52 offset:264
    ds_read_b32 v64, v64 offset:264
    ds_read_b32 v76, v76 offset:264
    ds_read_b32 v53, v53 offset:260
    ds_read_b32 v65, v65 offset:260
    ds_read_b32 v77, v77 offset:260
    ds_read_b32 v54, v54 offset:208
    ds_read_b32 v66, v66 offset:208
    buffer_load_dwordx4 v130, s[48:51], 0 offen offset:2048 lds
    ds_read_b32 v78, v78 offset:208
    ds_read_b32 v55, v55 offset:204
    s_add_u32 s48, s48, 36864
    ds_read_b32 v67, v67 offset:204
    s_addc_u32 s49, s49, 0
    ds_read_b32 v79, v79 offset:204
    s_add_u32 m0, s68, 0
    ds_read_b32 v56, v56 offset:200
    ds_read_b32 v68, v68 offset:200
    ds_read_b32 v80, v80 offset:200
    ds_read_b32 v57, v57 offset:196
    ds_read_b32 v69, v69 offset:196
    s_waitcnt vmcnt(6)
    buffer_load_dwordx4 v126, s[48:51], 0 offen lds
    ds_read_b64_tr_b16 a[92:93], v140 offset:3072
    ds_read_b64_tr_b16 a[94:95], v140 offset:3840
    ds_read_b64_tr_b16 a[116:117], v140 offset:3104
    ds_read_b64_tr_b16 a[118:119], v140 offset:3872
    ds_read_b64_tr_b16 a[140:141], v140 offset:3136
    ds_read_b64_tr_b16 a[142:143], v140 offset:3904
    ds_read_b32 v81, v81 offset:196
    ds_read_b32 v155, v155 offset:336
    v_cmp_ne_u32 vcc, s94, v181
    buffer_load_dwordx4 v128, s[48:51], 0 offen offset:1024 lds
    v_lshl_add_u32 v143, v115, 2, 0
    v_cndmask_b32 v129, 0, v163, vcc
    s_waitcnt lgkmcnt(11)
    v_add_f32 v22, v22, v129
    v_cmp_ne_u32 vcc, s94, v181
    v_mul_u32_u24 v129, 37, v143
    v_lshrrev_b32 v129, 8, v129
    v_cndmask_b32 v160, 0, v163, vcc
    v_add_f32 v23, v23, v160
    v_cmp_ne_u32 vcc, s94, v254
    v_mul_u32_u24 v160, 7, v129
    v_sub_u32 v160, v143, v160
    v_cndmask_b32 v143, 0, v163, vcc
    v_add_f32 v24, v24, v143
    v_cmp_ne_u32 vcc, s94, v254
    buffer_load_dwordx4 v130, s[48:51], 0 offen offset:2048 lds
    s_add_u32 s48, s48, 36864
    s_addc_u32 s49, s49, 0
    s_add_u32 m0, s68, 3072
    v_cndmask_b32 v143, 0, v163, vcc
    s_waitcnt lgkmcnt(0)
    v_readfirstlane_b32 s39, v155
    v_add_f32 v25, v25, v143
    v_cmp_ne_u32 vcc, s94, v255
    v_lshrrev_b32 v129, 2, v129
    v_lshrrev_b32 v160, 2, v160
    v_cndmask_b32 v143, 0, v163, vcc
    v_add_f32 v26, v26, v143
    v_cmp_ne_u32 vcc, s94, v255
    v_and_b32 v129, s5, v129
    buffer_load_dwordx4 v126, s[48:51], 0 offen lds
    s_waitcnt vmcnt(7)
    ds_read_b64_tr_b16 a[0:1], v142 offset:0
    ds_read_b64_tr_b16 a[2:3], v142 offset:768
    ds_read_b64_tr_b16 a[24:25], v142 offset:32
    ds_read_b64_tr_b16 a[26:27], v142 offset:800
    ds_read_b64_tr_b16 a[48:49], v142 offset:64
    ds_read_b64_tr_b16 a[50:51], v142 offset:832
    v_cndmask_b32 v143, 0, v163, vcc
    v_add_f32 v27, v27, v143
    v_and_b32 v160, s6, v160
    v_lshl_or_b32 v129, v129, 1, v160
    v_cmp_ne_u32 vcc, v129, v181
    v_lshl_add_u32 v185, v115, 2, 1
    v_mul_u32_u24 v160, 37, v185
    v_cndmask_b32 v143, 0, v163, vcc
    buffer_load_dwordx4 v128, s[48:51], 0 offen offset:1024 lds
    v_add_f32 v46, v46, v143
    v_cmp_ne_u32 vcc, v129, v254
    v_lshrrev_b32 v160, 8, v160
    v_mul_u32_u24 v118, 7, v160
    v_cndmask_b32 v143, 0, v163, vcc
    v_add_f32 v58, v58, v143
    v_cmp_ne_u32 vcc, v129, v255
    v_sub_u32 v118, v185, v118
    v_lshrrev_b32 v160, 2, v160
    v_cndmask_b32 v119, 0, v163, vcc
    v_add_f32 v70, v70, v119
    v_lshrrev_b32 v118, 2, v118
    v_and_b32 v160, s5, v160
    v_and_b32 v118, s6, v118
    v_lshl_or_b32 v160, v160, 1, v118
    buffer_load_dwordx4 v130, s[48:51], 0 offen offset:2048 lds
    s_add_u32 s48, s48, 36864
    s_addc_u32 s49, s49, 0
    s_add_u32 m0, s69, 0
    v_cmp_ne_u32 vcc, v160, v181
    v_lshl_add_u32 v129, v115, 2, 2
    v_mul_u32_u24 v185, 37, v129
    v_cndmask_b32 v143, 0, v163, vcc
    v_add_f32 v47, v47, v143
    v_cmp_ne_u32 vcc, v160, v254
    v_lshrrev_b32 v185, 8, v185
    v_mul_u32_u24 v143, 7, v185
    v_cndmask_b32 v118, 0, v163, vcc
    v_add_f32 v59, v59, v118
    v_cmp_ne_u32 vcc, v160, v255
    v_sub_u32 v143, v129, v143
    buffer_load_dwordx4 v126, s[48:51], 0 offen lds
    s_waitcnt vmcnt(7)
    ds_read_b64_tr_b16 a[4:5], v142 offset:3072
    ds_read_b64_tr_b16 a[6:7], v142 offset:3840
    ds_read_b64_tr_b16 a[28:29], v142 offset:3104
    ds_read_b64_tr_b16 a[30:31], v142 offset:3872
    ds_read_b64_tr_b16 a[52:53], v142 offset:3136
    ds_read_b64_tr_b16 a[54:55], v142 offset:3904
    v_cndmask_b32 v129, 0, v163, vcc
    v_add_f32 v71, v71, v129
    v_lshrrev_b32 v185, 2, v185
    v_lshrrev_b32 v143, 2, v143
    v_and_b32 v185, s5, v185
    v_and_b32 v143, s6, v143
    v_lshl_or_b32 v185, v185, 1, v143
    v_cmp_ne_u32 vcc, v185, v181
    buffer_load_dwordx4 v128, s[48:51], 0 offen offset:1024 lds
    v_lshl_add_u32 v129, v115, 2, 3
    v_cndmask_b32 v160, 0, v163, vcc
    v_add_f32 v48, v48, v160
    v_cmp_ne_u32 vcc, v185, v254
    v_mul_u32_u24 v160, 37, v129
    v_lshrrev_b32 v160, 8, v160
    v_cndmask_b32 v118, 0, v163, vcc
    v_add_f32 v60, v60, v118
    v_cmp_ne_u32 vcc, v185, v255
    v_mul_u32_u24 v185, 7, v160
    v_sub_u32 v185, v129, v185
    v_cndmask_b32 v129, 0, v163, vcc
    v_add_f32 v72, v72, v129
    v_lshrrev_b32 v160, 2, v160
    v_lshrrev_b32 v185, 2, v185
    buffer_load_dwordx4 v130, s[48:51], 0 offen offset:2048 lds
    s_add_u32 s48, s48, 36864
    s_addc_u32 s49, s49, 0
    s_add_u32 m0, s69, 3072
    v_and_b32 v160, s5, v160
    v_and_b32 v185, s6, v185
    v_lshl_or_b32 v160, v160, 1, v185
    v_cmp_ne_u32 vcc, v160, v181
    v_lshl_add_u32 v185, v115, 2, 16
    v_mul_u32_u24 v129, 37, v185
    v_cndmask_b32 v118, 0, v163, vcc
    v_add_f32 v49, v49, v118
    v_cmp_ne_u32 vcc, v160, v254
    v_lshrrev_b32 v129, 8, v129
    v_mul_u32_u24 v118, 7, v129
    v_cndmask_b32 v119, 0, v163, vcc
    buffer_load_dwordx4 v126, s[48:51], 0 offen lds
    s_waitcnt vmcnt(7)
    ds_read_b64_tr_b16 a[8:9], v141 offset:0
    ds_read_b64_tr_b16 a[10:11], v141 offset:768
    ds_read_b64_tr_b16 a[32:33], v141 offset:32
    ds_read_b64_tr_b16 a[34:35], v141 offset:800
    ds_read_b64_tr_b16 a[56:57], v141 offset:64
    ds_read_b64_tr_b16 a[58:59], v141 offset:832
    v_add_f32 v61, v61, v119
    v_cmp_ne_u32 vcc, v160, v255
    v_sub_u32 v118, v185, v118
    v_lshrrev_b32 v129, 2, v129
    v_cndmask_b32 v119, 0, v163, vcc
    v_add_f32 v73, v73, v119
    v_lshrrev_b32 v118, 2, v118
    v_and_b32 v129, s5, v129
    buffer_load_dwordx4 v128, s[48:51], 0 offen offset:1024 lds
    v_and_b32 v118, s6, v118
    v_lshl_or_b32 v129, v129, 1, v118
    v_cmp_ne_u32 vcc, v129, v181
    v_lshl_add_u32 v160, v115, 2, 17
    v_mul_u32_u24 v118, 37, v160
    v_cndmask_b32 v185, 0, v163, vcc
    v_add_f32 v50, v50, v185
    v_cmp_ne_u32 vcc, v129, v254
    v_lshrrev_b32 v118, 8, v118
    v_mul_u32_u24 v185, 7, v118
    v_cndmask_b32 v119, 0, v163, vcc
    v_add_f32 v62, v62, v119
    v_cmp_ne_u32 vcc, v129, v255
    v_sub_u32 v185, v160, v185
    v_lshrrev_b32 v118, 2, v118
    buffer_load_dwordx4 v130, s[48:51], 0 offen offset:2048 lds
    s_sub_u32 s48, s48, 183552
    s_subb_u32 s49, s49, 0
    s_add_u32 m0, s68, 0
    s_waitcnt lgkmcnt(0)
    v_cndmask_b32 v119, 0, v163, vcc
    v_add_f32 v74, v74, v119
    v_lshrrev_b32 v185, 2, v185
    v_and_b32 v118, s5, v118
    v_and_b32 v185, s6, v185
    v_lshl_or_b32 v118, v118, 1, v185
    v_cmp_ne_u32 vcc, v118, v181
    v_lshl_add_u32 v129, v115, 2, 18
    v_mul_u32_u24 v160, 37, v129
    v_cndmask_b32 v119, 0, v163, vcc
    v_add_f32 v51, v51, v119
    buffer_load_dwordx4 v126, s[48:51], 0 offen lds
    s_waitcnt vmcnt(7)
    ds_read_b64_tr_b16 a[12:13], v141 offset:3072
    ds_read_b64_tr_b16 a[14:15], v141 offset:3840
    ds_read_b64_tr_b16 a[36:37], v141 offset:3104
    ds_read_b64_tr_b16 a[38:39], v141 offset:3872
    ds_read_b64_tr_b16 a[60:61], v141 offset:3136
    ds_read_b64_tr_b16 a[62:63], v141 offset:3904
    v_cmp_ne_u32 vcc, v118, v254
    v_lshrrev_b32 v160, 8, v160
    v_mul_u32_u24 v185, 7, v160
    v_cndmask_b32 v119, 0, v163, vcc
    v_add_f32 v63, v63, v119
    v_cmp_ne_u32 vcc, v118, v255
    v_sub_u32 v185, v129, v185
    v_lshrrev_b32 v160, 2, v160
    buffer_load_dwordx4 v128, s[48:51], 0 offen offset:1024 lds
    v_cndmask_b32 v129, 0, v163, vcc
    v_add_f32 v75, v75, v129
    v_lshrrev_b32 v185, 2, v185
    v_and_b32 v160, s5, v160
    v_and_b32 v185, s6, v185
    v_lshl_or_b32 v160, v160, 1, v185
    v_cmp_ne_u32 vcc, v160, v181
    v_lshl_add_u32 v129, v115, 2, 19
    v_mul_u32_u24 v118, 37, v129
    v_cndmask_b32 v185, 0, v163, vcc
    v_add_f32 v52, v52, v185
    v_cmp_ne_u32 vcc, v160, v254
    v_lshrrev_b32 v118, 8, v118
    v_mul_u32_u24 v185, 7, v118
    v_cndmask_b32 v119, 0, v163, vcc
    buffer_load_dwordx4 v130, s[48:51], 0 offen offset:2048 lds
    s_add_u32 s48, s48, 36864
    s_addc_u32 s49, s49, 0
    s_add_u32 m0, s68, 3072
    s_waitcnt lgkmcnt(0)
    v_add_f32 v64, v64, v119
    v_cmp_ne_u32 vcc, v160, v255
    v_sub_u32 v185, v129, v185
    v_lshrrev_b32 v118, 2, v118
    v_cndmask_b32 v119, 0, v163, vcc
    v_add_f32 v76, v76, v119
    v_lshrrev_b32 v185, 2, v185
    v_and_b32 v118, s5, v118
    v_and_b32 v185, s6, v185
    v_lshl_or_b32 v118, v118, 1, v185
    v_cmp_ne_u32 vcc, v118, v181
    buffer_load_dwordx4 v126, s[48:51], 0 offen lds
    s_waitcnt vmcnt(7)
    ds_read_b64_tr_b16 a[16:17], v139 offset:0
    ds_read_b64_tr_b16 a[18:19], v139 offset:768
    ds_read_b64_tr_b16 a[40:41], v139 offset:32
    ds_read_b64_tr_b16 a[42:43], v139 offset:800
    ds_read_b64_tr_b16 a[64:65], v139 offset:64
    ds_read_b64_tr_b16 a[66:67], v139 offset:832
    v_cndmask_b32 v119, 0, v163, vcc
    v_add_f32 v53, v53, v119
    v_cmp_ne_u32 vcc, v118, v254
    v_lshl_add_u32 v160, v115, 2, 32
    v_mul_u32_u24 v129, 37, v160
    v_cndmask_b32 v119, 0, v163, vcc
    v_add_f32 v65, v65, v119
    v_cmp_ne_u32 vcc, v118, v255
    buffer_load_dwordx4 v128, s[48:51], 0 offen offset:1024 lds
    v_lshrrev_b32 v129, 8, v129
    v_cndmask_b32 v185, 0, v163, vcc
    v_add_f32 v77, v77, v185
    v_mul_u32_u24 v185, 7, v129
    v_sub_u32 v185, v160, v185
    v_lshrrev_b32 v129, 2, v129
    v_lshrrev_b32 v185, 2, v185
    v_and_b32 v129, s5, v129
    v_and_b32 v185, s6, v185
    v_lshl_or_b32 v129, v129, 1, v185
    v_cmp_ne_u32 vcc, v129, v181
    v_lshl_add_u32 v118, v115, 2, 33
    v_mul_u32_u24 v185, 37, v118
    v_cndmask_b32 v160, 0, v163, vcc
    v_add_f32 v54, v54, v160
    buffer_load_dwordx4 v130, s[48:51], 0 offen offset:2048 lds
    s_add_u32 s48, s48, 36864
    s_addc_u32 s49, s49, 0
    s_add_u32 m0, s69, 0
    s_waitcnt lgkmcnt(0)
    v_cmp_ne_u32 vcc, v129, v254
    v_lshrrev_b32 v185, 8, v185
    v_mul_u32_u24 v160, 7, v185
    v_cndmask_b32 v119, 0, v163, vcc
    v_add_f32 v66, v66, v119
    v_cmp_ne_u32 vcc, v129, v255
    v_sub_u32 v160, v118, v160
    v_lshrrev_b32 v185, 2, v185
    v_cndmask_b32 v129, 0, v163, vcc
    v_add_f32 v78, v78, v129
    v_lshrrev_b32 v160, 2, v160
    buffer_load_dwordx4 v126, s[48:51], 0 offen lds
    s_waitcnt vmcnt(7)
    ds_read_b64_tr_b16 a[20:21], v139 offset:3072
    ds_read_b64_tr_b16 a[22:23], v139 offset:3840
    ds_read_b64_tr_b16 a[44:45], v139 offset:3104
    ds_read_b64_tr_b16 a[46:47], v139 offset:3872
    ds_read_b64_tr_b16 a[68:69], v139 offset:3136
    ds_read_b64_tr_b16 a[70:71], v139 offset:3904
    v_and_b32 v185, s5, v185
    v_and_b32 v160, s6, v160
    v_lshl_or_b32 v185, v185, 1, v160
    v_cmp_ne_u32 vcc, v185, v181
    v_lshl_add_u32 v129, v115, 2, 34
    v_mul_u32_u24 v160, 37, v129
    v_cndmask_b32 v118, 0, v163, vcc
    v_add_f32 v55, v55, v118
    buffer_load_dwordx4 v128, s[48:51], 0 offen offset:1024 lds
    v_cmp_ne_u32 vcc, v185, v254
    v_lshrrev_b32 v160, 8, v160
    v_mul_u32_u24 v119, 7, v160
    v_cndmask_b32 v118, 0, v163, vcc
    v_add_f32 v67, v67, v118
    v_cmp_ne_u32 vcc, v185, v255
    v_sub_u32 v119, v129, v119
    v_lshrrev_b32 v160, 2, v160
    v_cndmask_b32 v129, 0, v163, vcc
    v_add_f32 v79, v79, v129
    v_lshrrev_b32 v119, 2, v119
    v_and_b32 v160, s5, v160
    v_and_b32 v119, s6, v119
    v_lshl_or_b32 v160, v160, 1, v119
    v_cmp_ne_u32 vcc, v160, v181
    buffer_load_dwordx4 v130, s[48:51], 0 offen offset:2048 lds
    s_add_u32 s48, s48, 36864
    s_addc_u32 s49, s49, 0
    s_add_u32 m0, s69, 3072
    s_waitcnt lgkmcnt(0)
    v_cndmask_b32 v129, 0, v163, vcc
    v_add_f32 v56, v56, v129
    v_cmp_ne_u32 vcc, v160, v254
    v_lshl_add_u32 v129, v115, 2, 35
    v_mul_u32_u24 v118, 37, v129
    v_cndmask_b32 v185, 0, v163, vcc
    v_add_f32 v68, v68, v185
    v_cmp_ne_u32 vcc, v160, v255
    v_lshrrev_b32 v118, 8, v118
    v_mul_u32_u24 v119, 7, v118
    buffer_load_dwordx4 v126, s[48:51], 0 offen lds
    s_waitcnt vmcnt(7)
    ds_read_b64_tr_b16 a[144:145], v141 offset:0
    ds_read_b64_tr_b16 a[146:147], v141 offset:768
    ds_read_b64_tr_b16 a[168:169], v141 offset:32
    ds_read_b64_tr_b16 a[170:171], v141 offset:800
    ds_read_b64_tr_b16 a[192:193], v141 offset:64
    ds_read_b64_tr_b16 a[194:195], v141 offset:832
    v_cndmask_b32 v160, 0, v163, vcc
    v_add_f32 v80, v80, v160
    v_sub_u32 v119, v129, v119
    v_lshrrev_b32 v118, 2, v118
    v_lshrrev_b32 v119, 2, v119
    v_and_b32 v118, s5, v118
    v_and_b32 v119, s6, v119
    v_lshl_or_b32 v118, v118, 1, v119
    buffer_load_dwordx4 v128, s[48:51], 0 offen offset:1024 lds
    v_cmp_ne_u32 vcc, v118, v181
    v_cndmask_b32 v22, v180, v22, s[88:89]
    v_cndmask_b32 v24, v180, v24, s[88:89]
    v_cndmask_b32 v119, 0, v163, vcc
    v_add_f32 v57, v57, v119
    v_cmp_ne_u32 vcc, v118, v254
    v_mov_b32_dpp v23, v25 quad_perm:[0,1,2,3] row_mask:0x2 bank_mask:0xf
    v_cndmask_b32 v26, v180, v26, s[88:89]
    v_cndmask_b32 v119, 0, v163, vcc
    v_add_f32 v69, v69, v119
    v_cmp_ne_u32 vcc, v118, v255
    v_mov_b32_dpp v23, v27 quad_perm:[0,1,2,3] row_mask:0x4 bank_mask:0xf
    v_mov_b32 v134, 0
    v_cndmask_b32 v129, 0, v163, vcc
    v_add_f32 v81, v81, v129
    buffer_load_dwordx4 v130, s[48:51], 0 offen offset:2048 lds
    ds_read_b128 v[150:153], v161 offset:0
    ds_read_b128 v[122:125], v174 offset:0
    ds_read_b128 v[170:173], v161 offset:128
    s_add_u32 s48, s48, 36864
    s_addc_u32 s49, s49, 0
    ds_read_b128 v[162:165], v174 offset:128
    s_add_u32 m0, s68, 0
    s_waitcnt lgkmcnt(4)
    ds_read_b128 v[166:169], v161 offset:256
    ds_read_b128 v[114:117], v174 offset:256
    v_mov_b32 v135, 0
    buffer_load_dwordx4 v126, s[48:51], 0 offen lds
    s_waitcnt vmcnt(7)
    ds_read_b64_tr_b16 a[148:149], v141 offset:3072
    ds_read_b64_tr_b16 a[150:151], v141 offset:3840
    ds_read_b64_tr_b16 a[172:173], v141 offset:3104
    ds_read_b64_tr_b16 a[174:175], v141 offset:3872
    ds_read_b64_tr_b16 a[196:197], v141 offset:3136
    ds_read_b64_tr_b16 a[198:199], v141 offset:3904
    s_waitcnt lgkmcnt(11)
    v_mfma_f32_16x16x32_bf16 v[146:149], a[72:75], v[150:153], 0
    s_waitcnt lgkmcnt(9)
    ds_write_b64 v175, v[134:135] offset:56
    v_mfma_f32_16x16x32_bf16 v[146:149], a[76:79], v[122:125], v[146:149]
    s_waitcnt lgkmcnt(9)
    buffer_load_dwordx4 v128, s[48:51], 0 offen offset:1024 lds
    v_mov_b32 v136, 0
    v_mfma_f32_16x16x32_bf16 v[146:149], a[80:83], v[170:173], v[146:149]
    s_waitcnt lgkmcnt(8)
    ds_write_b64 v175, v[134:135] offset:64
    v_mfma_f32_16x16x32_bf16 v[146:149], a[84:87], v[162:165], v[146:149]
    s_waitcnt lgkmcnt(8)
    v_mov_b32 v137, 0
    v_mfma_f32_16x16x32_bf16 v[146:149], a[88:91], v[166:169], v[146:149]
    s_waitcnt lgkmcnt(6)
    ds_write_b128 v175, v[134:137] offset:16
    v_mfma_f32_16x16x32_bf16 v[146:149], a[92:95], v[114:117], v[146:149]
    s_waitcnt lgkmcnt(3)
    buffer_load_dwordx4 v130, s[48:51], 0 offen offset:2048 lds
    s_add_u32 s48, s48, 36864
    v_mfma_f32_16x16x32_bf16 v[154:157], a[96:99], v[150:153], 0
    s_addc_u32 s49, s49, 0
    s_add_u32 m0, s68, 3072
    v_mfma_f32_16x16x32_bf16 v[154:157], a[100:103], v[122:125], v[154:157]
    ds_write_b128 v176, v[134:137] offset:16
    v_mfma_f32_16x16x32_bf16 v[154:157], a[104:107], v[170:173], v[154:157]
    s_waitcnt vmcnt(6)
    v_fma_f32 v160, v146, v146, s32
    v_fmac_f32 v160, v147, v147
    v_mfma_f32_16x16x32_bf16 v[154:157], a[108:111], v[162:165], v[154:157]
    buffer_load_dwordx4 v126, s[48:51], 0 offen lds
    v_fmac_f32 v160, v148, v148
    v_mfma_f32_16x16x32_bf16 v[154:157], a[112:115], v[166:169], v[154:157]
    ds_read_b64_tr_b16 a[152:153], v139 offset:0
    ds_read_b64_tr_b16 a[154:155], v139 offset:768
    v_mfma_f32_16x16x32_bf16 v[154:157], a[116:119], v[114:117], v[154:157]
    ds_read_b64_tr_b16 a[176:177], v139 offset:32
    ds_read_b64_tr_b16 a[178:179], v139 offset:800
    v_mfma_f32_16x16x32_bf16 v[190:193], a[120:123], v[150:153], 0
    ds_read_b64_tr_b16 a[200:201], v139 offset:64
    ds_read_b64_tr_b16 a[202:203], v139 offset:832
    v_mfma_f32_16x16x32_bf16 v[190:193], a[124:127], v[122:125], v[190:193]
    ds_read_b128 v[202:205], v161 offset:6144
    ds_read_b128 v[230:233], v174 offset:6144
    v_mfma_f32_16x16x32_bf16 v[190:193], a[128:131], v[170:173], v[190:193]
    buffer_load_dwordx4 v128, s[48:51], 0 offen offset:1024 lds
    ds_read_b128 v[238:241], v161 offset:6272
    v_mfma_f32_16x16x32_bf16 v[190:193], a[132:135], v[162:165], v[190:193]
    ds_read_b128 v[206:209], v174 offset:6272
    ds_read_b128 v[198:201], v161 offset:6400
    v_mfma_f32_16x16x32_bf16 v[190:193], a[136:139], v[166:169], v[190:193]
    v_fmac_f32 v160, v149, v149
    v_fmac_f32 v160, v154, v154
    v_mfma_f32_16x16x32_bf16 v[190:193], a[140:143], v[114:117], v[190:193]
    ds_read_b128 v[210:213], v174 offset:6400
    v_fmac_f32 v160, v155, v155
    v_mfma_f32_16x16x32_bf16 v[214:217], a[0:3], v[150:153], 0
    s_waitcnt lgkmcnt(10)
    ds_write_b64 v176, v[134:135] offset:56
    v_mfma_f32_16x16x32_bf16 v[214:217], a[4:7], v[122:125], v[214:217]
    s_waitcnt lgkmcnt(8)
    buffer_load_dwordx4 v130, s[48:51], 0 offen offset:2048 lds
    v_fmac_f32 v160, v156, v156
    v_mfma_f32_16x16x32_bf16 v[214:217], a[8:11], v[170:173], v[214:217]
    s_waitcnt lgkmcnt(6)
    ds_write_b64 v176, v[134:135] offset:64
    v_mfma_f32_16x16x32_bf16 v[130:133], a[72:75], v[202:205], 0
    s_waitcnt vmcnt(6)
    v_fmac_f32 v160, v157, v157
    v_fmac_f32 v160, v190, v190
    v_mfma_f32_16x16x32_bf16 v[218:221], a[96:99], v[202:205], 0
    s_waitcnt lgkmcnt(3)
    ds_read_b64_tr_b16 a[156:157], v139 offset:3072
    ds_read_b64_tr_b16 a[158:159], v139 offset:3840
    v_mfma_f32_16x16x32_bf16 v[130:133], a[76:79], v[230:233], v[130:133]
    s_add_u32 m0, s28, 8192
    ds_read_b64_tr_b16 a[180:181], v139 offset:3104
    ds_read_b64_tr_b16 a[182:183], v139 offset:3872
    v_mfma_f32_16x16x32_bf16 v[130:133], a[80:83], v[238:241], v[130:133]
    s_waitcnt lgkmcnt(6)
    buffer_load_dwordx4 v12, s[8:11], s25 offen nt lds
    v_mfma_f32_16x16x32_bf16 v[130:133], a[84:87], v[206:209], v[130:133]
    s_add_u32 m0, s28, 12288
    ds_read_b64_tr_b16 a[204:205], v139 offset:3136
    ds_read_b64_tr_b16 a[206:207], v139 offset:3904
    v_mfma_f32_16x16x32_bf16 v[130:133], a[88:91], v[198:201], v[130:133]
    v_fmac_f32 v160, v191, v191
    v_fmac_f32 v160, v192, v192
    v_mfma_f32_16x16x32_bf16 v[130:133], a[92:95], v[210:213], v[130:133]
    v_fmac_f32 v160, v193, v193
    v_mfma_f32_16x16x32_bf16 v[218:221], a[100:103], v[230:233], v[218:221]
    v_mfma_f32_16x16x32_bf16 v[218:221], a[104:107], v[238:241], v[218:221]
    buffer_load_dwordx4 v13, s[8:11], s25 offen nt lds
    v_mfma_f32_16x16x32_bf16 v[218:221], a[108:111], v[206:209], v[218:221]
    s_add_u32 m0, s29, 0
    v_mfma_f32_16x16x32_bf16 v[218:221], a[112:115], v[198:201], v[218:221]
    s_waitcnt lgkmcnt(2)
    v_fma_f32 v181, v130, v130, s32
    v_fmac_f32 v181, v131, v131
    v_mfma_f32_16x16x32_bf16 v[218:221], a[116:119], v[210:213], v[218:221]
    v_fmac_f32 v181, v132, v132
    v_fmac_f32 v181, v133, v133
    v_mfma_f32_16x16x32_bf16 v[222:225], a[120:123], v[202:205], 0
    s_waitcnt lgkmcnt(0)
    v_mfma_f32_16x16x32_bf16 v[222:225], a[124:127], v[230:233], v[222:225]
    buffer_load_dwordx4 v14, s[8:11], s25 offen nt lds
    v_mfma_f32_16x16x32_bf16 v[222:225], a[128:131], v[238:241], v[222:225]
    s_add_u32 m0, s69, 0
    s_waitcnt vmcnt(6)
    ds_read_b64_tr_b16 a[160:161], v141 offset:0
    v_mfma_f32_16x16x32_bf16 v[222:225], a[132:135], v[206:209], v[222:225]
    s_lshr_b32 s10, s17, 1
    ds_read_b64_tr_b16 a[162:163], v141 offset:768
    ds_read_b64_tr_b16 a[184:185], v141 offset:32
    v_mfma_f32_16x16x32_bf16 v[222:225], a[136:139], v[198:201], v[222:225]
    s_cselect_b32 s10, s36, 0
    ds_read_b64_tr_b16 a[186:187], v141 offset:800
    ds_read_b64_tr_b16 a[208:209], v141 offset:64
    v_mfma_f32_16x16x32_bf16 v[222:225], a[140:143], v[210:213], v[222:225]
    s_mov_b32 s25, s24
    ds_read_b64_tr_b16 a[210:211], v141 offset:832
    v_fmac_f32 v181, v218, v218
    v_mfma_f32_16x16x32_bf16 v[214:217], a[12:15], v[162:165], v[214:217]
    buffer_load_dwordx4 v120, s[52:55], 0 offen lds
    v_fmac_f32 v181, v219, v219
    v_mfma_f32_16x16x32_bf16 v[214:217], a[16:19], v[166:169], v[214:217]
    v_fmac_f32 v181, v220, v220
    v_fmac_f32 v181, v221, v221
    v_mfma_f32_16x16x32_bf16 v[214:217], a[20:23], v[114:117], v[214:217]
    v_fmac_f32 v181, v222, v222
    v_fmac_f32 v181, v223, v223
    v_mfma_f32_16x16x32_bf16 v[134:137], a[24:27], v[150:153], 0
    v_fmac_f32 v181, v224, v224
    v_fmac_f32 v181, v225, v225
    v_mfma_f32_16x16x32_bf16 v[134:137], a[28:31], v[122:125], v[134:137]
    s_waitcnt lgkmcnt(5)
    v_xor_b32 v185, 65536, v2
    v_fma_f32 v118, v214, v214, s32
    v_mfma_f32_16x16x32_bf16 v[134:137], a[32:35], v[170:173], v[134:137]
    s_waitcnt lgkmcnt(3)
    buffer_load_dwordx4 v159, s[52:55], 0 offen offset:1024 lds
    v_fmac_f32 v118, v215, v215
    v_mfma_f32_16x16x32_bf16 v[134:137], a[36:39], v[162:165], v[134:137]
    s_waitcnt lgkmcnt(1)
    v_fmac_f32 v118, v216, v216
    v_fmac_f32 v118, v217, v217
    v_mfma_f32_16x16x32_bf16 v[134:137], a[40:43], v[166:169], v[134:137]
    s_waitcnt lgkmcnt(0)
    v_lshrrev_b32 v142, 2, v185
    v_lshrrev_b32 v143, 8, v185
    v_mfma_f32_16x16x32_bf16 v[134:137], a[44:47], v[114:117], v[134:137]
    v_lshl_add_u32 v254, s16, 2, v185
    v_add_u32 v142, 62784, v142
    v_mfma_f32_16x16x32_bf16 v[226:229], a[48:51], v[150:153], 0
    v_lshlrev_b32 v143, 4, v143
    v_add_u32 v143, 62784, v143
    v_mfma_f32_16x16x32_bf16 v[226:229], a[52:55], v[122:125], v[226:229]
    buffer_load_dwordx4 v121, s[52:55], 0 offen offset:2048 lds
    v_or_b32 v234, v32, v33
    v_mfma_f32_16x16x32_bf16 v[226:229], a[56:59], v[170:173], v[226:229]
    s_add_u32 s52, s52, 12288
    s_waitcnt vmcnt(6)
    ds_read_b64_tr_b16 a[164:165], v141 offset:3072
    v_mfma_f32_16x16x32_bf16 v[226:229], a[60:63], v[162:165], v[226:229]
    s_addc_u32 s53, s53, 0
    ds_read_b64_tr_b16 a[166:167], v141 offset:3840
    ds_read_b64_tr_b16 a[188:189], v141 offset:3104
    v_mfma_f32_16x16x32_bf16 v[226:229], a[64:67], v[166:169], v[226:229]
    s_add_u32 m0, s69, 3072
    ds_read_b64_tr_b16 a[190:191], v141 offset:3872
    ds_read_b64_tr_b16 a[212:213], v141 offset:3136
    v_mfma_f32_16x16x32_bf16 v[226:229], a[68:71], v[114:117], v[226:229]
    ds_read_b64_tr_b16 a[214:215], v141 offset:3904
    v_fmac_f32 v118, v134, v134
    v_mfma_f32_16x16x32_bf16 v[138:141], a[0:3], v[202:205], 0
    buffer_load_dwordx4 v120, s[52:55], 0 offen lds
    v_fmac_f32 v118, v135, v135
    v_mfma_f32_16x16x32_bf16 v[138:141], a[4:7], v[230:233], v[138:141]
    v_fmac_f32 v118, v136, v136
    v_fmac_f32 v118, v137, v137
    v_mfma_f32_16x16x32_bf16 v[138:141], a[8:11], v[238:241], v[138:141]
    v_fmac_f32 v118, v226, v226
    v_fmac_f32 v118, v227, v227
    v_mfma_f32_16x16x32_bf16 v[138:141], a[12:15], v[206:209], v[138:141]
    v_fmac_f32 v118, v228, v228
    v_fmac_f32 v118, v229, v229
    v_mfma_f32_16x16x32_bf16 v[138:141], a[16:19], v[198:201], v[138:141]
    s_waitcnt lgkmcnt(5)
    v_cvt_pk_bf16_f32 v36, v118, v160
    v_and_b32 v234, 0xffff, v234
    v_mfma_f32_16x16x32_bf16 v[138:141], a[20:23], v[210:213], v[138:141]
    s_waitcnt lgkmcnt(3)
    buffer_load_dwordx4 v159, s[52:55], 0 offen offset:1024 lds
    v_lshl_or_b32 v234, v234, 16, v234
    v_mfma_f32_16x16x32_bf16 v[242:245], v[32:35], v[36:39], 0
    s_waitcnt lgkmcnt(1)
    v_or_b32 v235, v32, v33
    v_and_b32 v235, 0xffff, v235
    v_mfma_f32_16x16x32_bf16 v[114:117], a[24:27], v[202:205], 0
    s_waitcnt lgkmcnt(0)
    v_lshl_or_b32 v235, v235, 16, v235
    v_or_b32 v236, v32, v33
    v_mfma_f32_16x16x32_bf16 v[114:117], a[28:31], v[230:233], v[114:117]
    v_rsq_f32 v243, v243
    v_mfma_f32_16x16x32_bf16 v[114:117], a[32:35], v[238:241], v[114:117]
    v_rsq_f32 v242, v242
    v_mfma_f32_16x16x32_bf16 v[114:117], a[36:39], v[206:209], v[114:117]
    buffer_load_dwordx4 v121, s[52:55], 0 offen offset:2048 lds
    ds_read_b128 v[186:189], v0 offset:20480
    v_mfma_f32_16x16x32_bf16 v[114:117], a[40:43], v[198:201], v[114:117]
    s_add_u32 s52, s52, 12288
    ds_read_b128 v[194:197], v1 offset:20480
    v_mul_f32 v242, s31, v242
    v_mfma_f32_16x16x32_bf16 v[114:117], a[44:47], v[210:213], v[114:117]
    s_addc_u32 s53, s53, 0
    ds_read_b128 v[122:125], v0 offset:20608
    v_mul_f32 v146, v243, v146
    v_mfma_f32_16x16x32_bf16 v[246:249], a[48:51], v[202:205], 0
    s_add_u32 m0, s68, 0
    ds_read_b128 v[202:205], v1 offset:20608
    v_mul_f32 v147, v243, v147
    v_mfma_f32_16x16x32_bf16 v[246:249], a[52:55], v[230:233], v[246:249]
    ds_read_b128 v[230:233], v0 offset:20736
    v_cvt_pk_f16_f32 v150, v146, v147
    v_mfma_f32_16x16x32_bf16 v[246:249], a[56:59], v[238:241], v[246:249]
    buffer_load_dwordx4 v120, s[52:55], 0 offen lds
    ds_read_b128 v[238:241], v1 offset:20736
    v_mfma_f32_16x16x32_bf16 v[246:249], a[60:63], v[206:209], v[246:249]
    v_mul_f32 v148, v243, v148
    v_mul_f32 v149, v243, v149
    v_mfma_f32_16x16x32_bf16 v[246:249], a[64:67], v[198:201], v[246:249]
    v_cvt_pk_f16_f32 v151, v148, v149
    v_mul_f32 v154, v243, v154
    v_mfma_f32_16x16x32_bf16 v[246:249], a[68:71], v[210:213], v[246:249]
    s_waitcnt lgkmcnt(5)
    v_mul_f32 v155, v243, v155
    v_cvt_pk_f16_f32 v152, v154, v155
    v_mfma_f32_16x16x32_bf16 v[162:165], a[96:99], v[186:189], 0
    s_waitcnt lgkmcnt(4)
    v_mul_f32 v156, v243, v156
    v_mul_f32 v157, v243, v157
    v_mfma_f32_16x16x32_bf16 v[162:165], a[100:103], v[194:197], v[162:165]
    s_waitcnt lgkmcnt(3)
    v_cvt_pk_f16_f32 v153, v156, v157
    v_mul_f32 v190, v243, v190
    v_mfma_f32_16x16x32_bf16 v[162:165], a[104:107], v[122:125], v[162:165]
    s_waitcnt lgkmcnt(2)
    ds_write_b128 v175, v[150:153]
    v_mfma_f32_16x16x32_bf16 v[162:165], a[108:111], v[202:205], v[162:165]
    s_waitcnt lgkmcnt(1)
    v_mul_f32 v191, v243, v191
    v_cvt_pk_f16_f32 v208, v190, v191
    v_mfma_f32_16x16x32_bf16 v[162:165], a[112:115], v[230:233], v[162:165]
    v_mul_f32 v192, v243, v192
    v_mul_f32 v193, v243, v193
    v_mfma_f32_16x16x32_bf16 v[162:165], a[116:119], v[238:241], v[162:165]
    v_cvt_pk_f16_f32 v209, v192, v193
    v_mul_f32 v214, v242, v214
    v_mfma_f32_16x16x32_bf16 v[170:173], a[120:123], v[186:189], 0
    ds_write_b64 v175, v[208:209] offset:48
    v_mfma_f32_16x16x32_bf16 v[170:173], a[124:127], v[194:197], v[170:173]
    v_mul_f32 v215, v242, v215
    v_cvt_pk_f16_f32 v150, v214, v215
    v_mfma_f32_16x16x32_bf16 v[170:173], a[128:131], v[122:125], v[170:173]
    v_mul_f32 v216, v242, v216
    v_mul_f32 v217, v242, v217
    v_mfma_f32_16x16x32_bf16 v[170:173], a[132:135], v[202:205], v[170:173]
    v_cvt_pk_f16_f32 v151, v216, v217
    v_mul_f32 v134, v242, v134
    v_mfma_f32_16x16x32_bf16 v[170:173], a[136:139], v[230:233], v[170:173]
    v_mul_f32 v135, v242, v135
    v_cvt_pk_f16_f32 v152, v134, v135
    v_mfma_f32_16x16x32_bf16 v[170:173], a[140:143], v[238:241], v[170:173]
    v_mul_f32 v136, v242, v136
    v_mul_f32 v137, v242, v137
    v_mfma_f32_16x16x32_bf16 v[166:169], a[24:27], v[186:189], 0
    v_cvt_pk_f16_f32 v153, v136, v137
    v_mul_f32 v226, v242, v226
    v_mfma_f32_16x16x32_bf16 v[166:169], a[28:31], v[194:197], v[166:169]
    ds_write_b128 v175, v[150:153] offset:32
    v_mfma_f32_16x16x32_bf16 v[150:153], a[72:75], v[186:189], 0
    v_mul_f32 v227, v242, v227
    v_cvt_pk_f16_f32 v206, v226, v227
    v_mfma_f32_16x16x32_bf16 v[150:153], a[76:79], v[194:197], v[150:153]
    v_mul_f32 v228, v242, v228
    v_mul_f32 v229, v242, v229
    v_mfma_f32_16x16x32_bf16 v[150:153], a[80:83], v[122:125], v[150:153]
    v_cvt_pk_f16_f32 v207, v228, v229
    v_mul_f32 v146, v214, v146
    v_mfma_f32_16x16x32_bf16 v[150:153], a[84:87], v[202:205], v[150:153]
    ds_write_b64 v175, v[206:207] offset:72
    v_mfma_f32_16x16x32_bf16 v[150:153], a[88:91], v[230:233], v[150:153]
    v_fmac_f32 v146, v215, v147
    v_fmac_f32 v146, v216, v148
    v_mfma_f32_16x16x32_bf16 v[150:153], a[92:95], v[238:241], v[150:153]
    v_fmac_f32 v146, v217, v149
    v_fmac_f32 v146, v134, v154
    v_mfma_f32_16x16x32_bf16 v[166:169], a[32:35], v[122:125], v[166:169]
    v_fmac_f32 v146, v135, v155
    v_fmac_f32 v146, v136, v156
    v_mfma_f32_16x16x32_bf16 v[166:169], a[36:39], v[202:205], v[166:169]
    v_fmac_f32 v146, v137, v157
    v_fmac_f32 v146, v226, v190
    v_mfma_f32_16x16x32_bf16 v[166:169], a[40:43], v[230:233], v[166:169]
    v_fmac_f32 v146, v227, v191
    v_fmac_f32 v146, v228, v192
    v_mfma_f32_16x16x32_bf16 v[166:169], a[44:47], v[238:241], v[166:169]
    v_fmac_f32 v146, v229, v193
    v_mov_b32 v160, v146
    v_mfma_f32_16x16x32_bf16 v[134:137], a[48:51], v[186:189], 0
    v_lshrrev_b32 v236, 16, v236
    v_lshl_or_b32 v236, v236, 16, v236
    v_mfma_f32_16x16x32_bf16 v[134:137], a[52:55], v[194:197], v[134:137]
    v_permlane32_swap_b32 v146, v160
    v_mfma_f32_16x16x32_bf16 v[134:137], a[56:59], v[122:125], v[134:137]
    v_add_f32 v146, v146, v160
    v_mov_b32 v160, v146
    v_mfma_f32_16x16x32_bf16 v[134:137], a[60:63], v[202:205], v[134:137]
    v_or_b32 v237, v32, v33
    v_lshrrev_b32 v237, 16, v237
    v_mfma_f32_16x16x32_bf16 v[134:137], a[64:67], v[230:233], v[134:137]
    v_permlane16_swap_b32 v146, v160
    v_mfma_f32_16x16x32_bf16 v[134:137], a[68:71], v[238:241], v[134:137]
    v_add_f32 v146, v146, v160
    v_add_f32 v146, s39, v146
    v_mfma_f32_16x16x32_bf16 v[154:157], v[186:189], a[144:147], 0
    v_mov_b32 v147, v180
    v_mov_b32 v148, v180
    v_mfma_f32_16x16x32_bf16 v[154:157], v[194:197], a[148:151], v[154:157]
    v_mov_b32 v149, v180
    v_cndmask_b32 v146, v180, v146, s[88:89]
    v_mfma_f32_16x16x32_bf16 v[154:157], v[122:125], a[152:155], v[154:157]
    ds_write_b128 v158, v[146:149] offset:192
    v_mfma_f32_16x16x32_bf16 v[154:157], v[202:205], a[156:159], v[154:157]
    v_lshl_or_b32 v237, v237, 16, v237
    v_fma_f32 v175, v138, v138, s32
    v_mfma_f32_16x16x32_bf16 v[154:157], v[230:233], a[160:163], v[154:157]
    v_fmac_f32 v175, v139, v139
    v_fmac_f32 v175, v140, v140
    v_mfma_f32_16x16x32_bf16 v[154:157], v[238:241], a[164:167], v[154:157]
    v_fmac_f32 v175, v141, v141
    v_fmac_f32 v175, v114, v114
    v_mfma_f32_16x16x32_bf16 v[146:149], v[186:189], a[168:171], 0
    v_fmac_f32 v175, v115, v115
    v_fmac_f32 v175, v116, v116
    v_mfma_f32_16x16x32_bf16 v[146:149], v[194:197], a[172:175], v[146:149]
    v_fmac_f32 v175, v117, v117
    v_fmac_f32 v175, v246, v246
    v_mfma_f32_16x16x32_bf16 v[146:149], v[122:125], a[176:179], v[146:149]
    v_fmac_f32 v175, v247, v247
    v_fmac_f32 v175, v248, v248
    v_mfma_f32_16x16x32_bf16 v[146:149], v[202:205], a[180:183], v[146:149]
    ds_read_b128 v[190:193], v161 offset:0
    v_fmac_f32 v175, v249, v249
    v_mfma_f32_16x16x32_bf16 v[146:149], v[230:233], a[184:187], v[146:149]
    ds_read_b128 v[206:209], v174 offset:0
    v_cvt_pk_bf16_f32 v36, v175, v181
    v_mfma_f32_16x16x32_bf16 v[146:149], v[238:241], a[188:191], v[146:149]
    ds_read_b128 v[214:217], v161 offset:128
    v_fma_f32 v255, v150, v150, s32
    v_fmac_f32 v255, v151, v151
    v_fmac_f32 v255, v152, v152
    v_fmac_f32 v255, v153, v153
    v_fmac_f32 v255, v162, v162
    v_fmac_f32 v255, v163, v163
    v_fmac_f32 v255, v164, v164
    v_fmac_f32 v255, v165, v165
    v_fmac_f32 v255, v170, v170
    v_fmac_f32 v255, v171, v171
    v_fmac_f32 v255, v172, v172
    v_fmac_f32 v255, v173, v173
    v_cvt_pk_bf16_f32 v118, v154, v155
    v_mfma_f32_16x16x32_bf16 v[198:201], v[32:35], v[36:39], 0
    v_cvt_pk_bf16_f32 v119, v156, v157
    v_cvt_pk_bf16_f32 v146, v146, v147
    v_mfma_f32_16x16x32_bf16 v[154:157], v[186:189], a[192:195], 0
    v_cvt_pk_bf16_f32 v147, v148, v149
    v_xor_b32 v2, 65536, v2
    v_mfma_f32_16x16x32_bf16 v[154:157], v[194:197], a[196:199], v[154:157]
    s_waitcnt lgkmcnt(2)
    v_mfma_f32_16x16x32_bf16 v[154:157], v[122:125], a[200:203], v[154:157]
    s_waitcnt lgkmcnt(1)
    v_rsq_f32 v199, v199
    v_mfma_f32_16x16x32_bf16 v[154:157], v[202:205], a[204:207], v[154:157]
    s_waitcnt lgkmcnt(0)
    v_rsq_f32 v198, v198
    v_mfma_f32_16x16x32_bf16 v[154:157], v[230:233], a[208:211], v[154:157]
    v_mul_f32 v198, s31, v198
    v_mul_f32 v130, v199, v130
    v_mfma_f32_16x16x32_bf16 v[154:157], v[238:241], a[212:215], v[154:157]
    v_mul_f32 v131, v199, v131
    v_cvt_pk_f16_f32 v210, v130, v131
    v_mul_f32 v132, v199, v132
    v_mul_f32 v133, v199, v133
    v_cvt_pk_f16_f32 v211, v132, v133
    v_mul_f32 v218, v199, v218
    v_mul_f32 v219, v199, v219
    v_cvt_pk_f16_f32 v212, v218, v219
    v_mul_f32 v220, v199, v220
    v_mul_f32 v221, v199, v221
    v_cvt_pk_f16_f32 v213, v220, v221
    v_mul_f32 v222, v199, v222
    v_mul_f32 v223, v199, v223
    v_cvt_pk_f16_f32 v228, v222, v223
    v_mul_f32 v224, v199, v224
    v_mul_f32 v225, v199, v225
    v_cvt_pk_f16_f32 v229, v224, v225
    v_mul_f32 v138, v198, v138
    v_mul_f32 v139, v198, v139
    v_cvt_pk_f16_f32 v242, v138, v139
    v_mul_f32 v140, v198, v140
    v_mul_f32 v141, v198, v141
    v_cvt_pk_f16_f32 v243, v140, v141
    v_mul_f32 v114, v198, v114
    v_mul_f32 v115, v198, v115
    v_cvt_pk_f16_f32 v244, v114, v115
    v_mul_f32 v116, v198, v116
    v_mul_f32 v117, v198, v117
    v_cvt_pk_f16_f32 v245, v116, v117
    v_mul_f32 v246, v198, v246
    v_mul_f32 v247, v198, v247
    v_cvt_pk_f16_f32 v226, v246, v247
    v_mul_f32 v248, v198, v248
    v_mul_f32 v249, v198, v249
    v_cvt_pk_f16_f32 v227, v248, v249
    v_mul_f32 v130, v138, v130
    v_fmac_f32 v130, v139, v131
    buffer_load_dwordx4 v159, s[52:55], 0 offen offset:1024 lds
    ds_write_b128 v176, v[210:213]
    v_fmac_f32 v130, v140, v132
    v_fmac_f32 v130, v141, v133
    v_fmac_f32 v130, v114, v218
    v_mfma_f32_16x16x32_bf16 v[138:141], a[0:3], v[186:189], 0
    v_fmac_f32 v130, v115, v219
    v_fmac_f32 v130, v116, v220
    v_mfma_f32_16x16x32_bf16 v[138:141], a[4:7], v[194:197], v[138:141]
    ds_read_b128 v[194:197], v174 offset:128
    ds_read_b128 v[186:189], v161 offset:256
    v_mfma_f32_16x16x32_bf16 v[138:141], a[8:11], v[122:125], v[138:141]
    ds_read_b128 v[122:125], v174 offset:256
    buffer_load_dwordx4 v121, s[52:55], 0 offen offset:2048 lds
    v_mfma_f32_16x16x32_bf16 v[138:141], a[12:15], v[202:205], v[138:141]
    s_add_u32 s52, s52, 12288
    ds_write_b64 v176, v[228:229] offset:48
    v_mfma_f32_16x16x32_bf16 v[138:141], a[16:19], v[230:233], v[138:141]
    s_addc_u32 s53, s53, 0
    v_fmac_f32 v130, v117, v221
    v_fmac_f32 v130, v246, v222
    v_mfma_f32_16x16x32_bf16 v[138:141], a[20:23], v[238:241], v[138:141]
    s_add_u32 m0, s68, 3072
    ds_write_b128 v176, v[242:245] offset:32
    v_mfma_f32_16x16x32_bf16 v[114:117], v[190:193], a[144:147], 0
    s_mul_i32 s68, s78, 72
    v_fmac_f32 v130, v247, v223
    v_fmac_f32 v130, v248, v224
    v_mfma_f32_16x16x32_bf16 v[114:117], v[206:209], a[148:151], v[114:117]
    buffer_load_dwordx4 v120, s[52:55], 0 offen lds
    v_fmac_f32 v130, v249, v225
    v_mfma_f32_16x16x32_bf16 v[114:117], v[214:217], a[152:155], v[114:117]
    s_waitcnt lgkmcnt(3)
    ds_write_b64 v176, v[226:227] offset:72
    v_mfma_f32_16x16x32_bf16 v[114:117], v[194:197], a[156:159], v[114:117]
    s_sub_u32 s68, s77, s68
    v_mov_b32 v148, v130
    v_fma_f32 v181, v138, v138, s32
    v_mfma_f32_16x16x32_bf16 v[114:117], v[186:189], a[160:163], v[114:117]
    s_waitcnt lgkmcnt(2)
    v_permlane32_swap_b32 v130, v148
    v_mfma_f32_16x16x32_bf16 v[114:117], v[122:125], a[164:167], v[114:117]
    s_mul_i32 s78, s78, 1373568
    v_add_f32 v130, v130, v148
    v_mov_b32 v148, v130
    v_mfma_f32_16x16x32_bf16 v[230:233], v[190:193], a[168:171], 0
    buffer_load_dwordx4 v159, s[52:55], 0 offen offset:1024 lds
    v_fmac_f32 v181, v139, v139
    v_mfma_f32_16x16x32_bf16 v[230:233], v[206:209], a[172:175], v[230:233]
    s_mul_i32 s77, s68, 2688
    v_permlane16_swap_b32 v130, v148
    v_mfma_f32_16x16x32_bf16 v[230:233], v[214:217], a[176:179], v[230:233]
    s_add_u32 s77, s77, s78
    v_add_f32 v130, v130, v148
    v_add_f32 v130, s39, v130
    v_mfma_f32_16x16x32_bf16 v[230:233], v[194:197], a[180:183], v[230:233]
    ds_read_b128 v[238:241], v161 offset:6144
    v_mov_b32 v131, v180
    v_mfma_f32_16x16x32_bf16 v[230:233], v[186:189], a[184:187], v[230:233]
    ds_read_b128 v[202:205], v174 offset:6144
    v_mov_b32 v132, v180
    v_mfma_f32_16x16x32_bf16 v[230:233], v[122:125], a[188:191], v[230:233]
    buffer_load_dwordx4 v121, s[52:55], 0 offen offset:2048 lds
    ds_read_b128 v[218:221], v161 offset:6272
    v_mfma_f32_16x16x32_bf16 v[222:225], v[190:193], a[192:195], 0
    s_add_u32 s52, s52, 12288
    ds_read_b128 v[190:193], v174 offset:6272
    v_mov_b32 v133, v180
    v_mfma_f32_16x16x32_bf16 v[222:225], v[206:209], a[196:199], v[222:225]
    s_waitcnt vmcnt(9)
    ds_read_b64 a[216:217], v183 offset:0
    ds_read_b64 a[218:219], v183 offset:1536
    v_mfma_f32_16x16x32_bf16 v[222:225], v[214:217], a[200:203], v[222:225]
    s_addc_u32 s53, s53, 0
    ds_read_b64 a[240:241], v183 offset:8
    ds_read_b64 a[242:243], v183 offset:1544
    v_mfma_f32_16x16x32_bf16 v[222:225], v[194:197], a[204:207], v[222:225]
    s_add_u32 m0, s69, 0
    ds_read_b64 v[90:91], v184 offset:0
    ds_read_b64 v[92:93], v184 offset:1536
    v_mfma_f32_16x16x32_bf16 v[222:225], v[186:189], a[208:211], v[222:225]
    ds_read_b128 v[194:197], v161 offset:6400
    ds_read_b128 v[186:189], v174 offset:6400
    v_mfma_f32_16x16x32_bf16 v[222:225], v[122:125], a[212:215], v[222:225]
    s_waitcnt lgkmcnt(11)
    v_cndmask_b32 v130, v180, v130, s[88:89]
    v_fmac_f32 v181, v140, v140
    v_mfma_f32_16x16x32_bf16 v[122:125], v[238:241], a[144:147], 0
    s_waitcnt lgkmcnt(10)
    ds_write_b128 v179, v[130:133] offset:192
    v_mfma_f32_16x16x32_bf16 v[122:125], v[202:205], a[148:151], v[122:125]
    s_waitcnt lgkmcnt(9)
    v_fmac_f32 v181, v141, v141
    v_fmac_f32 v181, v166, v166
    v_mfma_f32_16x16x32_bf16 v[122:125], v[218:221], a[152:155], v[122:125]
    s_waitcnt lgkmcnt(7)
    v_fmac_f32 v181, v167, v167
    v_fmac_f32 v181, v168, v168
    v_mfma_f32_16x16x32_bf16 v[130:133], v[234:237], a[216:219], 0
    s_waitcnt lgkmcnt(5)
    v_fmac_f32 v181, v169, v169
    v_fmac_f32 v181, v134, v134
    v_mfma_f32_16x16x32_bf16 v[130:133], v[234:237], a[240:243], v[130:133]
    s_waitcnt lgkmcnt(3)
    buffer_load_dwordx4 v120, s[52:55], 0 offen lds
    v_fmac_f32 v181, v135, v135
    v_mfma_f32_16x16x32_bf16 v[130:133], v[234:237], v[90:93], v[130:133]
    s_waitcnt lgkmcnt(1)
    v_fmac_f32 v181, v136, v136
    v_fmac_f32 v181, v137, v137
    v_mfma_f32_16x16x32_bf16 v[122:125], v[190:193], a[156:159], v[122:125]
    v_cvt_pk_bf16_f32 v36, v181, v255
    v_cvt_pk_bf16_f32 v174, v154, v155
    v_mfma_f32_16x16x32_bf16 v[122:125], v[194:197], a[160:163], v[122:125]
    s_waitcnt vmcnt(7)
    ds_read_b64 a[232:233], v183 offset:3072
    ds_read_b64 a[220:221], v183 offset:4608
    v_mfma_f32_16x16x32_bf16 v[214:217], v[32:35], v[36:39], 0
    ds_read_b64 v[82:83], v183 offset:3080
    ds_read_b64 a[244:245], v183 offset:4616
    v_mfma_f32_16x16x32_bf16 v[122:125], v[186:189], a[164:167], v[122:125]
    buffer_load_dwordx4 v159, s[52:55], 0 offen offset:1024 lds
    ds_read_b64 v[106:107], v184 offset:3072
    v_mfma_f32_16x16x32_bf16 v[206:209], v[238:241], a[168:171], 0
    ds_read_b64 v[94:95], v184 offset:4608
    v_mov_b32 v255, v130
    v_mfma_f32_16x16x32_bf16 v[206:209], v[202:205], a[172:175], v[206:209]
    v_mov_b32_dpp v255, v131 quad_perm:[0,1,2,3] row_mask:0x2 bank_mask:0xf
    v_cvt_pk_bf16_f32 v175, v156, v157
    v_mfma_f32_16x16x32_bf16 v[206:209], v[218:221], a[176:179], v[206:209]
    v_rsq_f32 v215, v215
    v_mfma_f32_16x16x32_bf16 v[206:209], v[190:193], a[180:183], v[206:209]
    v_rsq_f32 v214, v214
    v_mfma_f32_16x16x32_bf16 v[206:209], v[194:197], a[184:187], v[206:209]
    buffer_load_dwordx4 v121, s[52:55], 0 offen offset:2048 lds
    v_mul_f32 v214, s31, v214
    v_mfma_f32_16x16x32_bf16 v[206:209], v[186:189], a[188:191], v[206:209]
    s_add_u32 s52, s52, 12288
    v_mul_f32 v150, v215, v150
    v_mul_f32 v151, v215, v151
    v_mfma_f32_16x16x32_bf16 v[130:133], v[238:241], a[192:195], 0
    s_addc_u32 s53, s53, 0
    v_cvt_pk_f16_f32 v154, v150, v151
    v_mul_f32 v152, v215, v152
    v_mfma_f32_16x16x32_bf16 v[130:133], v[202:205], a[196:199], v[130:133]
    s_add_u32 m0, s69, 3072
    v_mul_f32 v153, v215, v153
    v_cvt_pk_f16_f32 v155, v152, v153
    v_mfma_f32_16x16x32_bf16 v[130:133], v[218:221], a[200:203], v[130:133]
    s_waitcnt lgkmcnt(0)
    v_mul_f32 v162, v215, v162
    v_mul_f32 v163, v215, v163
    v_mfma_f32_16x16x32_bf16 v[130:133], v[190:193], a[204:207], v[130:133]
    buffer_load_dwordx4 v120, s[52:55], 0 offen lds
    v_cvt_pk_f16_f32 v156, v162, v163
    s_waitcnt vmcnt(7)
    v_mfma_f32_16x16x32_bf16 v[130:133], v[194:197], a[208:211], v[130:133]
    s_add_u32 s69, s77, 589824
    ds_read_b64 a[222:223], v182 offset:0
    ds_read_b64 a[234:235], v182 offset:1536
    v_mfma_f32_16x16x32_bf16 v[130:133], v[186:189], a[212:215], v[130:133]
    s_barrier
    s_barrier
    ds_read_b64 a[246:247], v182 offset:8
    ds_read_b64 v[84:85], v182 offset:1544
    ds_read_b64 v[96:97], v127 offset:0
    ds_read_b64 v[108:109], v127 offset:1536
    ds_read_b128 v[150:153], v0 offset:26624
    ds_read_b128 v[186:189], v1 offset:26624
    buffer_load_dwordx4 v159, s[52:55], 0 offen offset:1024 lds
    ds_read_b128 v[238:241], v0 offset:26752
    ds_read_b128 v[202:205], v1 offset:26752
    ds_read_b128 v[158:161], v0 offset:26880
    ds_read_b128 v[190:193], v1 offset:26880
    v_mul_f32 v164, v215, v164
    s_waitcnt lgkmcnt(11)
    v_mfma_f32_16x16x32_bf16 v[194:197], v[234:237], a[220:223], 0
    s_waitcnt lgkmcnt(10)
    buffer_load_dwordx4 v121, s[52:55], 0 offen offset:2048 lds
    v_mul_f32 v165, v215, v165
    v_mfma_f32_16x16x32_bf16 v[218:221], v[234:237], a[232:235], 0
    s_waitcnt lgkmcnt(8)
    v_cvt_pk_f16_f32 v157, v164, v165
    v_mul_f32 v170, v215, v170
    v_mfma_f32_16x16x32_bf16 v[194:197], v[234:237], a[244:247], v[194:197]
    s_waitcnt lgkmcnt(4)
    v_mul_f32 v171, v215, v171
    v_cvt_pk_f16_f32 v128, v170, v171
    v_mfma_f32_16x16x32_bf16 v[194:197], v[234:237], v[94:97], v[194:197]
    s_add_u32 m0, s28, 65536
    v_mul_f32 v172, v215, v172
    v_mul_f32 v173, v215, v173
    v_mfma_f32_16x16x32_bf16 v[218:221], v[234:237], v[82:85], v[218:221]
    s_waitcnt lgkmcnt(2)
    v_cvt_pk_f16_f32 v129, v172, v173
    s_waitcnt vmcnt(6)
    v_mfma_f32_16x16x32_bf16 v[218:221], v[234:237], v[106:109], v[218:221]
    s_waitcnt lgkmcnt(1)
    buffer_load_dwordx4 v10, s[8:11], s24 offen nt lds
    v_mfma_f32_16x16x32_bf16 v[162:165], a[72:75], v[150:153], 0
    s_add_u32 m0, s28, 69632
    ds_read_b64 a[224:225], v182 offset:3072
    ds_read_b64 a[226:227], v182 offset:4608
    v_mfma_f32_16x16x32_bf16 v[162:165], a[76:79], v[186:189], v[162:165]
    s_waitcnt lgkmcnt(2)
    ds_read_b64 a[248:249], v182 offset:3080
    ds_read_b64 a[250:251], v182 offset:4616
    v_mfma_f32_16x16x32_bf16 v[162:165], a[80:83], v[238:241], v[162:165]
    ds_read_b64 v[98:99], v127 offset:3072
    ds_read_b64 v[100:101], v127 offset:4608
    v_mfma_f32_16x16x32_bf16 v[162:165], a[84:87], v[202:205], v[162:165]
    v_mov_b32_dpp v255, v218 quad_perm:[0,1,2,3] row_mask:0x4 bank_mask:0xf
    v_mov_b32_dpp v255, v194 quad_perm:[0,1,2,3] row_mask:0x8 bank_mask:0xf
    v_mfma_f32_16x16x32_bf16 v[162:165], a[88:91], v[158:161], v[162:165]
    buffer_load_dwordx4 v11, s[8:11], s24 offen nt lds
    v_mfma_f32_16x16x32_bf16 v[162:165], a[92:95], v[190:193], v[162:165]
    s_add_u32 m0, s28, 73728
    ds_write_b32 v254, v255 offset:18432
    v_mfma_f32_16x16x32_bf16 v[170:173], a[96:99], v[150:153], 0
    v_mov_b32 v176, v195
    v_mov_b32_dpp v176, v219 quad_perm:[0,1,2,3] row_mask:0x2 bank_mask:0xf
    v_mfma_f32_16x16x32_bf16 v[170:173], a[100:103], v[186:189], v[170:173]
    v_mul_f32 v138, v214, v138
    v_mul_f32 v139, v214, v139
    v_mfma_f32_16x16x32_bf16 v[170:173], a[104:107], v[238:241], v[170:173]
    s_waitcnt lgkmcnt(5)
    v_cvt_pk_f16_f32 v138, v138, v139
    v_mul_f32 v140, v214, v140
    v_mfma_f32_16x16x32_bf16 v[194:197], v[234:237], a[224:227], 0
    s_waitcnt lgkmcnt(3)
    buffer_load_dwordx4 v12, s[8:11], s24 offen nt lds
    v_mfma_f32_16x16x32_bf16 v[194:197], v[234:237], a[248:251], v[194:197]
    s_waitcnt lgkmcnt(1)
    v_mul_f32 v141, v214, v141
    v_cvt_pk_f16_f32 v139, v140, v141
    v_mfma_f32_16x16x32_bf16 v[194:197], v[234:237], v[98:101], v[194:197]
    s_add_u32 m0, s28, 77824
    v_mul_f32 v166, v214, v166
    s_waitcnt vmcnt(6)
    v_mfma_f32_16x16x32_bf16 v[170:173], a[108:111], v[202:205], v[170:173]
    ds_read_b64 a[236:237], v183 offset:0
    ds_read_b64 a[228:229], v183 offset:1536
    v_mfma_f32_16x16x32_bf16 v[170:173], a[112:115], v[158:161], v[170:173]
    ds_read_b64 v[86:87], v183 offset:8
    ds_read_b64 a[252:253], v183 offset:1544
    v_mfma_f32_16x16x32_bf16 v[170:173], a[116:119], v[190:193], v[170:173]
    buffer_load_dwordx4 v13, s[8:11], s24 offen nt lds
    v_mfma_f32_16x16x32_bf16 v[218:221], a[120:123], v[150:153], 0
    s_add_u32 m0, s74, 0
    ds_read_b64 v[110:111], v184 offset:0
    ds_read_b64 v[102:103], v184 offset:1536
    v_mfma_f32_16x16x32_bf16 v[218:221], a[124:127], v[186:189], v[218:221]
    v_mov_b32_dpp v176, v194 quad_perm:[0,1,2,3] row_mask:0x4 bank_mask:0xf
    v_mov_b32_dpp v176, v195 quad_perm:[0,1,2,3] row_mask:0x8 bank_mask:0xf
    v_mfma_f32_16x16x32_bf16 v[218:221], a[128:131], v[238:241], v[218:221]
    ds_write_b32 v254, v176 offset:19456
    v_mfma_f32_16x16x32_bf16 v[218:221], a[132:135], v[202:205], v[218:221]
    v_mul_f32 v167, v214, v167
    v_cvt_pk_f16_f32 v140, v166, v167
    v_mfma_f32_16x16x32_bf16 v[218:221], a[136:139], v[158:161], v[218:221]
    buffer_load_dwordx4 v14, s[8:11], s24 offen nt lds
    v_mfma_f32_16x16x32_bf16 v[218:221], a[140:143], v[190:193], v[218:221]
    s_add_u32 s8, s60, s23
    v_mul_f32 v168, v214, v168
    v_mul_f32 v169, v214, v169
    v_mfma_f32_16x16x32_bf16 v[194:197], a[0:3], v[150:153], 0
    s_addc_u32 s9, s61, 0
    v_cvt_pk_f16_f32 v141, v168, v169
    v_mul_f32 v134, v214, v134
    v_mfma_f32_16x16x32_bf16 v[194:197], a[4:7], v[186:189], v[194:197]
    s_sub_u32 s10, s36, s23
    v_mul_f32 v135, v214, v135
    v_cvt_pk_f16_f32 v126, v134, v135
    v_mfma_f32_16x16x32_bf16 v[194:197], a[8:11], v[238:241], v[194:197]
    s_cmp_lt_u32 s34, s17
    v_mul_f32 v136, v214, v136
    v_mul_f32 v137, v214, v137
    v_mfma_f32_16x16x32_bf16 v[194:197], a[12:15], v[202:205], v[194:197]
    s_cselect_b32 s10, s10, 0
    v_cvt_pk_f16_f32 v127, v136, v137
    v_cvt_pk_bf16_f32 v114, v114, v114
    v_mfma_f32_16x16x32_bf16 v[194:197], a[16:19], v[158:161], v[194:197]
    s_add_u32 m0, s28, 0
    v_cvt_pk_bf16_f32 v115, v115, v115
    s_waitcnt vmcnt(5)
    v_mfma_f32_16x16x32_bf16 v[194:197], a[20:23], v[190:193], v[194:197]
    s_mov_b32 s24, s23
    ds_read_b64 a[230:231], v183 offset:3072
    ds_read_b64 a[238:239], v183 offset:4608
    v_mfma_f32_16x16x32_bf16 v[134:137], a[24:27], v[150:153], 0
    s_add_u32 s23, s23, s21
    ds_read_b64 a[254:255], v183 offset:3080
    ds_read_b64 v[88:89], v183 offset:4616
    v_mfma_f32_16x16x32_bf16 v[134:137], a[28:31], v[186:189], v[134:137]
    s_cmp_ge_u32 s19, 72
    ds_read_b64 v[104:105], v184 offset:3072
    ds_read_b64 v[112:113], v184 offset:4608
    v_mfma_f32_16x16x32_bf16 v[134:137], a[32:35], v[238:241], v[134:137]
    s_cselect_b32 s34, 72, 0
    ds_write2_b32 v177, v114, v115 offset0:0 offset1:68
    v_mfma_f32_16x16x32_bf16 v[134:137], a[36:39], v[202:205], v[134:137]
    s_cselect_b32 s35, s22, 0
    v_cvt_pk_bf16_f32 v116, v116, v116
    v_cvt_pk_bf16_f32 v117, v117, v117
    v_mfma_f32_16x16x32_bf16 v[134:137], a[40:43], v[158:161], v[134:137]
    s_sub_u32 s19, s19, s34
    ds_write2_b32 v177, v116, v117 offset0:136 offset1:204
    v_mfma_f32_16x16x32_bf16 v[134:137], a[44:47], v[190:193], v[134:137]
    s_add_u32 s23, s23, s35
    v_cvt_pk_bf16_f32 v230, v230, v230
    v_cvt_pk_bf16_f32 v231, v231, v231
    v_mfma_f32_16x16x32_bf16 v[114:117], a[48:51], v[150:153], 0
    s_waitcnt lgkmcnt(6)
    ds_write2_b32 v177, v230, v231 offset0:16 offset1:84
    v_mfma_f32_16x16x32_bf16 v[166:169], v[234:237], a[228:231], 0
    s_waitcnt lgkmcnt(5)
    v_cvt_pk_bf16_f32 v232, v232, v232
    v_cvt_pk_bf16_f32 v233, v233, v233
    v_mfma_f32_16x16x32_bf16 v[166:169], v[234:237], a[252:255], v[166:169]
    s_waitcnt lgkmcnt(3)
    ds_write2_b32 v177, v232, v233 offset0:152 offset1:220
    v_mfma_f32_16x16x32_bf16 v[166:169], v[234:237], v[102:105], v[166:169]
    v_cvt_pk_bf16_f32 v222, v222, v222
    v_cvt_pk_bf16_f32 v223, v223, v223
    v_mfma_f32_16x16x32_bf16 v[230:233], v[234:237], a[236:239], 0
    ds_write2_b32 v177, v222, v223 offset0:32 offset1:100
    v_mfma_f32_16x16x32_bf16 v[230:233], v[234:237], v[86:89], v[230:233]
    v_cvt_pk_bf16_f32 v224, v224, v224
    v_cvt_pk_bf16_f32 v225, v225, v225
    v_mfma_f32_16x16x32_bf16 v[230:233], v[234:237], v[110:113], v[230:233]
    ds_write2_b32 v177, v224, v225 offset0:168 offset1:236
    v_mfma_f32_16x16x32_bf16 v[114:117], a[52:55], v[186:189], v[114:117]
    v_cvt_pk_bf16_f32 v122, v122, v122
    v_cvt_pk_bf16_f32 v123, v123, v123
    v_mfma_f32_16x16x32_bf16 v[114:117], a[56:59], v[238:241], v[114:117]
    ds_write2_b32 v178, v122, v123 offset0:0 offset1:68
    v_mfma_f32_16x16x32_bf16 v[114:117], a[60:63], v[202:205], v[114:117]
    v_cvt_pk_bf16_f32 v124, v124, v124
    v_mov_b32 v255, v230
    v_mfma_f32_16x16x32_bf16 v[114:117], a[64:67], v[158:161], v[114:117]
    v_mov_b32_dpp v255, v166 quad_perm:[0,1,2,3] row_mask:0x2 bank_mask:0xf
    v_mov_b32_dpp v255, v167 quad_perm:[0,1,2,3] row_mask:0x4 bank_mask:0xf
    v_mfma_f32_16x16x32_bf16 v[114:117], a[68:71], v[190:193], v[114:117]
    v_mov_b32_dpp v255, v231 quad_perm:[0,1,2,3] row_mask:0x8 bank_mask:0xf
    v_cvt_pk_bf16_f32 v125, v125, v125
    v_mfma_f32_16x16x32_bf16 v[166:169], v[150:153], a[144:147], 0
    ds_write_b32 v254, v255 offset:63552
    v_mfma_f32_16x16x32_bf16 v[166:169], v[186:189], a[148:151], v[166:169]
    v_cvt_pk_bf16_f32 v206, v206, v206
    v_cvt_pk_bf16_f32 v207, v207, v207
    v_mfma_f32_16x16x32_bf16 v[166:169], v[238:241], a[152:155], v[166:169]
    ds_write2_b32 v178, v124, v125 offset0:136 offset1:204
    v_mfma_f32_16x16x32_bf16 v[166:169], v[202:205], a[156:159], v[166:169]
    v_cvt_pk_bf16_f32 v208, v208, v208
    v_cvt_pk_bf16_f32 v209, v209, v209
    v_mfma_f32_16x16x32_bf16 v[166:169], v[158:161], a[160:163], v[166:169]
    ds_write2_b32 v178, v206, v207 offset0:16 offset1:84
    v_mfma_f32_16x16x32_bf16 v[166:169], v[190:193], a[164:167], v[166:169]
    v_cvt_pk_bf16_f32 v130, v130, v130
    v_cvt_pk_bf16_f32 v131, v131, v131
    v_mfma_f32_16x16x32_bf16 v[122:125], v[150:153], a[168:171], 0
    ds_write2_b32 v178, v208, v209 offset0:152 offset1:220
    v_mfma_f32_16x16x32_bf16 v[122:125], v[186:189], a[172:175], v[122:125]
    s_waitcnt lgkmcnt(3)
    v_cvt_pk_bf16_f32 v132, v132, v132
    v_cvt_pk_bf16_f32 v133, v133, v133
    v_mfma_f32_16x16x32_bf16 v[122:125], v[238:241], a[176:179], v[122:125]
    s_barrier
    ds_read_b128 v[230:233], v185 offset:18432
    ds_read_b128 v[222:225], v185 offset:19456
    v_mfma_f32_16x16x32_bf16 v[122:125], v[202:205], a[180:183], v[122:125]
    ds_read_b128 v[206:209], v0 offset:32768
    ds_read_b128 v[234:237], v185 offset:63552
    v_mfma_f32_16x16x32_bf16 v[122:125], v[158:161], a[184:187], v[122:125]
    v_cvt_pk_bf16_f32 v120, v166, v167
    v_cvt_pk_bf16_f32 v121, v168, v169
    v_mfma_f32_16x16x32_bf16 v[122:125], v[190:193], a[188:191], v[122:125]
    ds_read_b128 v[182:185], v1 offset:32768
    ds_read_b128 v[166:169], v0 offset:32896
    v_mfma_f32_16x16x32_bf16 v[214:217], v[150:153], a[192:195], 0
    v_fma_f32 v148, v194, v194, s32
    v_fmac_f32 v148, v195, v195
    v_mfma_f32_16x16x32_bf16 v[214:217], v[186:189], a[196:199], v[214:217]
    ds_read_b128 v[186:189], v1 offset:32896
    ds_read_b128 v[150:153], v0 offset:33024
    v_mfma_f32_16x16x32_bf16 v[214:217], v[238:241], a[200:203], v[214:217]
    v_fmac_f32 v148, v196, v196
    v_fmac_f32 v148, v197, v197
    v_mfma_f32_16x16x32_bf16 v[214:217], v[202:205], a[204:207], v[214:217]
    ds_read_b128 v[202:205], v1 offset:33024
    v_fmac_f32 v148, v134, v134
    v_mfma_f32_16x16x32_bf16 v[214:217], v[158:161], a[208:211], v[214:217]
    s_waitcnt lgkmcnt(7)
    ds_write2_b32 v178, v130, v131 offset0:32 offset1:100
    v_mfma_f32_16x16x32_bf16 v[214:217], v[190:193], a[212:215], v[214:217]
    s_waitcnt lgkmcnt(6)
    v_add_f32 v230, v230, v231
    v_add_f32 v232, v232, v233
    v_mfma_f32_16x16x32_bf16 v[158:161], a[72:75], v[206:209], 0
    s_waitcnt lgkmcnt(5)
    ds_write2_b32 v178, v132, v133 offset0:168 offset1:236
    v_mfma_f32_16x16x32_bf16 v[158:161], a[76:79], v[182:185], v[158:161]
    s_waitcnt lgkmcnt(5)
    v_add_f32 v230, v230, v232
    v_mul_f32 v230, 0xbbaaaaab, v230
    v_mfma_f32_16x16x32_bf16 v[158:161], a[80:83], v[166:169], v[158:161]
    s_waitcnt lgkmcnt(3)
    ds_write_b32 v142, v230 offset:0
    v_mfma_f32_16x16x32_bf16 v[158:161], a[84:87], v[186:189], v[158:161]
    v_add_f32 v222, v222, v223
    v_add_f32 v224, v224, v225
    v_mfma_f32_16x16x32_bf16 v[158:161], a[88:91], v[150:153], v[158:161]
    s_waitcnt lgkmcnt(3)
    ds_read_b128 v[178:181], v143 offset:0
    ds_read_b128 v[130:133], v143 offset:64
    v_mfma_f32_16x16x32_bf16 v[158:161], a[92:95], v[202:205], v[158:161]
    v_add_f32 v222, v222, v224
    v_mul_f32 v222, 0xbbaaaaab, v222
    v_mfma_f32_16x16x32_bf16 v[230:233], a[96:99], v[206:209], 0
    ds_write_b32 v142, v222 offset:256
    v_mfma_f32_16x16x32_bf16 v[230:233], a[100:103], v[182:185], v[230:233]
    v_add_f32 v234, v234, v235
    v_add_f32 v236, v236, v237
    v_mfma_f32_16x16x32_bf16 v[230:233], a[104:107], v[166:169], v[230:233]
    v_add_f32 v234, v234, v236
    v_mul_f32 v234, 0xbbaaaaab, v234
    v_mfma_f32_16x16x32_bf16 v[230:233], a[108:111], v[186:189], v[230:233]
    ds_write_b32 v142, v234 offset:512
    v_mfma_f32_16x16x32_bf16 v[230:233], a[112:115], v[150:153], v[230:233]
    v_fmac_f32 v148, v135, v135
    v_fmac_f32 v148, v136, v136
    v_mfma_f32_16x16x32_bf16 v[230:233], a[116:119], v[202:205], v[230:233]
    v_fmac_f32 v148, v137, v137
    v_fmac_f32 v148, v114, v114
    v_mfma_f32_16x16x32_bf16 v[238:241], a[120:123], v[206:209], 0
    s_waitcnt lgkmcnt(2)
    v_fmac_f32 v148, v115, v115
    v_fmac_f32 v148, v116, v116
    v_mfma_f32_16x16x32_bf16 v[238:241], a[124:127], v[182:185], v[238:241]
    v_fmac_f32 v148, v117, v117
    v_fma_f32 v142, v162, v162, s32
    v_mfma_f32_16x16x32_bf16 v[238:241], a[128:131], v[166:169], v[238:241]
    v_fmac_f32 v142, v163, v163
    v_fmac_f32 v142, v164, v164
    v_mfma_f32_16x16x32_bf16 v[238:241], a[132:135], v[186:189], v[238:241]
    v_fmac_f32 v142, v165, v165
    v_fmac_f32 v142, v170, v170
    v_mfma_f32_16x16x32_bf16 v[238:241], a[136:139], v[150:153], v[238:241]
    v_fmac_f32 v142, v171, v171
    v_fmac_f32 v142, v172, v172
    v_mfma_f32_16x16x32_bf16 v[238:241], a[140:143], v[202:205], v[238:241]
    v_fmac_f32 v142, v173, v173
    v_fmac_f32 v142, v218, v218
    v_mfma_f32_16x16x32_bf16 v[190:193], a[0:3], v[206:209], 0
    v_fmac_f32 v142, v219, v219
    v_fmac_f32 v142, v220, v220
    v_mfma_f32_16x16x32_bf16 v[190:193], a[4:7], v[182:185], v[190:193]
    v_fmac_f32 v142, v221, v221
    v_cvt_pk_bf16_f32 v36, v148, v142
    v_mfma_f32_16x16x32_bf16 v[190:193], a[8:11], v[166:169], v[190:193]
    v_cvt_pk_bf16_f32 v148, v122, v123
    v_cvt_pk_bf16_f32 v149, v124, v125
    v_mfma_f32_16x16x32_bf16 v[122:125], v[32:35], v[36:39], 0
    v_cvt_pk_bf16_f32 v176, v214, v215
    v_cvt_pk_bf16_f32 v177, v216, v217
    v_mfma_f32_16x16x32_bf16 v[190:193], a[12:15], v[186:189], v[190:193]
    v_fma_f32 v142, v158, v158, s32
    v_fmac_f32 v142, v159, v159
    v_mfma_f32_16x16x32_bf16 v[190:193], a[16:19], v[150:153], v[190:193]
    v_fmac_f32 v142, v160, v160
    v_fmac_f32 v142, v161, v161
    v_mfma_f32_16x16x32_bf16 v[190:193], a[20:23], v[202:205], v[190:193]
    v_rsq_f32 v123, v123
    v_mfma_f32_16x16x32_bf16 v[222:225], a[24:27], v[206:209], 0
    v_rsq_f32 v122, v122
    v_mfma_f32_16x16x32_bf16 v[222:225], a[28:31], v[182:185], v[222:225]
    ds_read2_b32 v[216:217], v6 offset0:0 offset1:0
    ds_read2_b32 v[236:237], v6 offset0:16 offset1:16
    v_mfma_f32_16x16x32_bf16 v[222:225], a[32:35], v[166:169], v[222:225]
    ds_read2_b32 v[248:249], v6 offset0:32 offset1:32
    v_mul_f32 v122, s31, v122
    v_mfma_f32_16x16x32_bf16 v[222:225], a[36:39], v[186:189], v[222:225]
    v_mul_f32 v162, v123, v162
    v_mul_f32 v163, v123, v163
    v_mfma_f32_16x16x32_bf16 v[222:225], a[40:43], v[150:153], v[222:225]
    v_cvt_pk_f16_f32 v210, v162, v163
    v_mul_f32 v164, v123, v164
    v_mfma_f32_16x16x32_bf16 v[222:225], a[44:47], v[202:205], v[222:225]
    v_mul_f32 v165, v123, v165
    v_cvt_pk_f16_f32 v211, v164, v165
    v_mfma_f32_16x16x32_bf16 v[162:165], a[48:51], v[206:209], 0
    v_mul_f32 v170, v123, v170
    v_mul_f32 v171, v123, v171
    v_mfma_f32_16x16x32_bf16 v[162:165], a[52:55], v[182:185], v[162:165]
    v_cvt_pk_f16_f32 v212, v170, v171
    v_mul_f32 v172, v123, v172
    v_mfma_f32_16x16x32_bf16 v[162:165], a[56:59], v[166:169], v[162:165]
    v_mul_f32 v173, v123, v173
    v_cvt_pk_f16_f32 v213, v172, v173
    v_mfma_f32_16x16x32_bf16 v[162:165], a[60:63], v[186:189], v[162:165]
    s_waitcnt lgkmcnt(1)
    v_mul_f32 v218, v123, v218
    v_mul_f32 v219, v123, v219
    v_mfma_f32_16x16x32_bf16 v[162:165], a[64:67], v[150:153], v[162:165]
    s_waitcnt lgkmcnt(0)
    v_cvt_pk_f16_f32 v172, v218, v219
    v_mul_f32 v220, v123, v220
    v_mfma_f32_16x16x32_bf16 v[162:165], a[68:71], v[202:205], v[162:165]
    v_mul_f32 v221, v123, v221
    v_cvt_pk_f16_f32 v173, v220, v221
    v_mfma_f32_16x16x32_bf16 v[218:221], v[206:209], a[144:147], 0
    v_mul_f32 v194, v122, v194
    v_mul_f32 v195, v122, v195
    v_mfma_f32_16x16x32_bf16 v[218:221], v[182:185], a[148:151], v[218:221]
    v_cvt_pk_f16_f32 v194, v194, v195
    v_mul_f32 v196, v122, v196
    v_mfma_f32_16x16x32_bf16 v[218:221], v[166:169], a[152:155], v[218:221]
    v_mul_f32 v197, v122, v197
    v_cvt_pk_f16_f32 v195, v196, v197
    v_mfma_f32_16x16x32_bf16 v[218:221], v[186:189], a[156:159], v[218:221]
    v_mul_f32 v134, v122, v134
    v_mul_f32 v135, v122, v135
    v_mfma_f32_16x16x32_bf16 v[218:221], v[150:153], a[160:163], v[218:221]
    v_cvt_pk_f16_f32 v196, v134, v135
    v_mul_f32 v136, v122, v136
    v_mfma_f32_16x16x32_bf16 v[218:221], v[202:205], a[164:167], v[218:221]
    v_mul_f32 v137, v122, v137
    v_cvt_pk_f16_f32 v197, v136, v137
    v_mfma_f32_16x16x32_bf16 v[134:137], v[206:209], a[168:171], 0
    v_mul_f32 v114, v122, v114
    v_mul_f32 v115, v122, v115
    v_mfma_f32_16x16x32_bf16 v[134:137], v[182:185], a[172:175], v[134:137]
    ds_read_b32 v254, v6 offset:192
    v_cvt_pk_f16_f32 v170, v114, v115
    v_mfma_f32_16x16x32_bf16 v[134:137], v[166:169], a[176:179], v[134:137]
    v_mul_f32 v116, v122, v116
    v_mul_f32 v117, v122, v117
    v_mfma_f32_16x16x32_bf16 v[134:137], v[186:189], a[180:183], v[134:137]
    ds_read_b128 v[122:125], v5 offset:0
    v_cvt_pk_f16_f32 v171, v116, v117
    v_mfma_f32_16x16x32_bf16 v[134:137], v[150:153], a[184:187], v[134:137]
    v_cvt_pk_bf16_f32 v214, v218, v219
    v_cvt_pk_bf16_f32 v215, v220, v221
    v_mfma_f32_16x16x32_bf16 v[134:137], v[202:205], a[188:191], v[134:137]
    v_fma_f32 v255, v190, v190, s32
    v_fmac_f32 v255, v191, v191
    v_fmac_f32 v255, v192, v192
    v_fmac_f32 v255, v193, v193
    v_fmac_f32 v255, v222, v222
    v_fmac_f32 v255, v223, v223
    v_fmac_f32 v255, v224, v224
    v_fmac_f32 v255, v225, v225
    v_fmac_f32 v255, v162, v162
    v_fmac_f32 v255, v163, v163
    v_fmac_f32 v255, v164, v164
    v_fmac_f32 v255, v165, v165
    v_fmac_f32 v142, v230, v230
    v_fmac_f32 v142, v231, v231
    v_fmac_f32 v142, v232, v232
    v_fmac_f32 v142, v233, v233
    v_fmac_f32 v142, v238, v238
    v_fmac_f32 v142, v239, v239
    v_fmac_f32 v142, v240, v240
    v_fmac_f32 v142, v241, v241
    v_cvt_pk_bf16_f32 v36, v255, v142
    v_mfma_f32_16x16x32_bf16 v[218:221], v[206:209], a[192:195], 0
    s_waitcnt lgkmcnt(0)
    ds_read_b128 v[114:117], v5 offset:16
    v_cvt_pk_bf16_f32 v234, v134, v135
    v_mfma_f32_16x16x32_bf16 v[218:221], v[182:185], a[196:199], v[218:221]
    ds_read_b128 v[182:185], v5 offset:48
    v_cvt_pk_bf16_f32 v235, v136, v137
    v_mfma_f32_16x16x32_bf16 v[218:221], v[166:169], a[200:203], v[218:221]
    v_xor_b32 v0, 65536, v0
    v_xor_b32 v1, 65536, v1
    v_mfma_f32_16x16x32_bf16 v[134:137], v[32:35], v[36:39], 0
    v_add_u32 v5, 336, v5
    v_add_u32 v6, 272, v6
    v_mfma_f32_16x16x32_f16 v[206:209], v[122:125], v[138:141], v[22:25]
    v_mfma_f32_16x16x32_bf16 v[218:221], v[186:189], a[204:207], v[218:221]
    v_mfma_f32_16x16x32_bf16 v[218:221], v[150:153], a[208:211], v[218:221]
    v_mfma_f32_16x16x32_f16 v[150:153], v[154:157], v[138:141], v[46:49]
    v_mfma_f32_16x16x32_f16 v[166:169], v[210:213], v[138:141], v[50:53]
    s_waitcnt lgkmcnt(1)
    v_rsq_f32 v135, v135
    v_mfma_f32_16x16x32_f16 v[206:209], v[114:117], v[154:157], v[206:209]
    s_waitcnt lgkmcnt(0)
    v_rsq_f32 v134, v134
    v_mfma_f32_16x16x32_f16 v[206:209], v[182:185], v[126:129], v[206:209]
    v_mul_f32 v134, s31, v134
    v_mul_f32 v158, v135, v158
    v_mul_f32 v159, v135, v159
    v_mfma_f32_16x16x16_f16 v[150:153], v[128:129], v[126:127], v[150:153]
    v_cvt_pk_f16_f32 v158, v158, v159
    v_mul_f32 v160, v135, v160
    v_mul_f32 v161, v135, v161
    v_mfma_f32_16x16x16_f16 v[166:169], v[172:173], v[126:127], v[166:169]
    v_cvt_pk_f16_f32 v159, v160, v161
    v_mul_f32 v230, v135, v230
    v_mul_f32 v231, v135, v231
    v_cvt_pk_f16_f32 v160, v230, v231
    v_mfma_f32_16x16x32_bf16 v[218:221], v[202:205], a[212:215], v[218:221]
    s_waitcnt vmcnt(0)
    v_mul_f32 v232, v135, v232
    v_mul_f32 v233, v135, v233
    v_mfma_f32_16x16x32_f16 v[186:189], v[122:125], v[194:197], v[24:27]
    s_barrier
    buffer_load_dwordx4 v10, s[8:11], 0 offen nt lds
    v_cvt_pk_f16_f32 v161, v232, v233
    v_mfma_f32_16x16x32_f16 v[186:189], v[114:117], v[210:213], v[186:189]
    s_add_u32 m0, s28, 4096
    v_cvt_pk_bf16_f32 v246, v218, v219
    v_cvt_pk_bf16_f32 v247, v220, v221
    v_mfma_f32_16x16x32_f16 v[202:205], v[158:161], v[138:141], v[54:57]
    v_mul_f32 v238, v135, v238
    v_mul_f32 v239, v135, v239
    v_mfma_f32_16x16x32_f16 v[186:189], v[182:185], v[170:173], v[186:189]
    v_cvt_pk_f16_f32 v140, v238, v239
    v_mul_f32 v240, v135, v240
    v_mul_f32 v241, v135, v241
    v_mfma_f32_16x16x16_bf16 v[230:233], a[216:217], v[144:145], v[178:181]
    v_cvt_pk_f16_f32 v141, v240, v241
    v_mul_f32 v190, v134, v190
    v_mul_f32 v191, v134, v191
    v_mfma_f32_16x16x16_f16 v[202:205], v[140:141], v[126:127], v[202:205]
    v_cvt_pk_f16_f32 v238, v190, v191
    v_mul_f32 v192, v134, v192
    v_mul_f32 v193, v134, v193
    v_mfma_f32_16x16x16_bf16 v[218:221], a[240:241], v[144:145], v[178:181]
    v_cvt_pk_f16_f32 v239, v192, v193
    v_mul_f32 v222, v134, v222
    v_mul_f32 v223, v134, v223
    v_mfma_f32_16x16x16_bf16 v[190:193], v[90:91], v[144:145], v[178:181]
    v_cvt_pk_f16_f32 v240, v222, v223
    v_mul_f32 v224, v134, v224
    v_mul_f32 v225, v134, v225
    v_mfma_f32_16x16x16_bf16 v[198:201], a[218:219], v[144:145], v[130:133]
    v_cvt_pk_f16_f32 v241, v224, v225
    v_mul_f32 v162, v134, v162
    v_mul_f32 v163, v134, v163
    v_cvt_pk_f16_f32 v138, v162, v163
    v_mfma_f32_16x16x32_f16 v[178:181], v[122:125], v[238:241], v[26:29]
    buffer_load_dwordx4 v11, s[8:11], 0 offen nt lds
    v_mul_f32 v164, v134, v164
    v_mfma_f32_16x16x32_f16 v[178:181], v[114:117], v[158:161], v[178:181]
    s_add_u32 m0, s28, 8192
    v_mul_f32 v165, v134, v165
    v_cvt_pk_f16_f32 v139, v164, v165
    v_mov_b32_dpp v254, v207 quad_perm:[0,1,2,3] row_mask:0x1 bank_mask:0xf
    v_mfma_f32_16x16x16_bf16 v[114:117], a[242:243], v[144:145], v[130:133]
    v_mov_b32_dpp v254, v187 quad_perm:[0,1,2,3] row_mask:0x2 bank_mask:0xf
    v_max3_f32 v142, v206, v150, v151
    v_max3_f32 v142, v142, v152, v153
    v_max3_f32 v142, v142, v166, v167
    v_mfma_f32_16x16x32_f16 v[178:181], v[182:185], v[138:141], v[178:181]
    v_max3_f32 v142, v142, v168, v169
    v_max3_f32 v142, v142, v202, v203
    v_max3_f32 v142, v142, v204, v205
    v_mfma_f32_16x16x16_bf16 v[182:185], v[92:93], v[144:145], v[130:133]
    buffer_load_dwordx4 v12, s[8:11], 0 offen nt lds
    s_add_u32 m0, s28, 12288
    s_xor_b32 s28, s28, 65536
    v_mov_b32 v255, v142
    v_mov_b32_dpp v254, v179 quad_perm:[0,1,2,3] row_mask:0x4 bank_mask:0xf
    v_cvt_pk_bf16_f32 v230, v230, v231
    v_permlane32_swap_b32 v142, v255
    v_max_f32 v142, v142, v255
    v_mov_b32 v255, v142
    v_accvgpr_write_b32 a216, v230
    v_cvt_pk_bf16_f32 v232, v232, v233
    v_permlane16_swap_b32 v142, v255
    v_max_f32 v142, v142, v255
    v_sub_f32 v150, v150, v142
    buffer_load_dwordx4 v13, s[8:11], 0 offen nt lds
    s_mov_b32 m0, s29
    s_xor_b32 s29, s29, s30
    v_exp_f32 v150, v150
    v_sub_f32 v151, v151, v142
    v_exp_f32 v151, v151
    v_sub_f32 v152, v152, v142
    v_cvt_pk_bf16_f32 v130, v150, v151
    v_exp_f32 v152, v152
    v_sub_f32 v153, v153, v142
    v_exp_f32 v153, v153
    v_sub_f32 v166, v166, v142
    buffer_load_dwordx4 v14, s[8:11], 0 offen nt lds
    v_cvt_pk_bf16_f32 v131, v152, v153
    v_exp_f32 v166, v166
    v_mfma_f32_16x16x32_f16 v[122:125], v[154:157], v[194:197], v[58:61]
    v_sub_f32 v167, v167, v142
    v_exp_f32 v167, v167
    v_sub_f32 v168, v168, v142
    v_cvt_pk_bf16_f32 v132, v166, v167
    v_exp_f32 v168, v168
    v_sub_f32 v169, v169, v142
    v_mfma_f32_16x16x16_f16 v[122:125], v[128:129], v[170:171], v[122:125]
    v_exp_f32 v169, v169
    v_sub_f32 v202, v202, v142
    v_cvt_pk_bf16_f32 v133, v168, v169
    v_mfma_f32_16x16x32_f16 v[150:153], v[210:213], v[194:197], v[62:65]
    v_exp_f32 v202, v202
    v_sub_f32 v203, v203, v142
    v_exp_f32 v203, v203
    v_sub_f32 v204, v204, v142
    v_cvt_pk_bf16_f32 v36, v202, v203
    v_exp_f32 v204, v204
    v_mfma_f32_16x16x32_f16 v[134:137], v[158:161], v[194:197], v[66:69]
    v_sub_f32 v205, v205, v142
    v_exp_f32 v205, v205
    v_mfma_f32_16x16x16_f16 v[150:153], v[172:173], v[170:171], v[150:153]
    v_cvt_pk_bf16_f32 v37, v204, v205
    v_sub_f32 v206, v206, v142
    v_exp_f32 v206, v206
    v_mfma_f32_16x16x16_f16 v[134:137], v[140:141], v[170:171], v[134:137]
    v_cvt_pk_bf16_f32 v39, v206, 0
    v_accvgpr_write_b32 a217, v232
    v_cvt_pk_bf16_f32 v218, v218, v219
    v_accvgpr_write_b32 a240, v218
    v_mfma_f32_16x16x32_bf16 v[162:165], v[28:31], v[36:39], 0
    v_cvt_pk_bf16_f32 v220, v220, v221
    v_accvgpr_write_b32 a241, v220
    v_mfma_f32_16x16x32_bf16 v[162:165], v[28:31], v[130:133], v[162:165]
    v_cvt_pk_bf16_f32 v90, v190, v191
    v_cvt_pk_bf16_f32 v91, v192, v193
    v_mfma_f32_16x16x32_bf16 v[202:205], v[214:217], v[36:39], 0
    ds_read_b128 v[166:169], v143 offset:128
    v_cvt_pk_bf16_f32 v198, v198, v199
    v_mfma_f32_16x16x32_bf16 v[202:205], v[118:121], v[130:133], v[202:205]
    v_accvgpr_write_b32 a218, v198
    v_cvt_pk_bf16_f32 v200, v200, v201
    v_mfma_f32_16x16x32_bf16 v[190:193], v[234:237], v[36:39], 0
    v_rcp_f32 v162, v162
    v_mfma_f32_16x16x32_bf16 v[190:193], v[146:149], v[130:133], v[190:193]
    v_accvgpr_write_b32 a219, v200
    v_cvt_pk_bf16_f32 v114, v114, v115
    v_mfma_f32_16x16x32_bf16 v[230:233], v[246:249], v[36:39], 0
    v_mul_f32 v202, v162, v202
    v_mul_f32 v203, v162, v203
    v_mfma_f32_16x16x32_bf16 v[230:233], v[174:177], v[130:133], v[230:233]
    v_cvt_pk_bf16_f32 v130, v202, v203
    v_mul_f32 v204, v162, v204
    v_mul_f32 v205, v162, v205
    v_cvt_pk_bf16_f32 v131, v204, v205
    v_mul_f32 v190, v162, v190
    v_mul_f32 v191, v162, v191
    v_cvt_pk_bf16_f32 v132, v190, v191
    v_mul_f32 v192, v162, v192
    s_waitcnt lgkmcnt(0)
    v_mfma_f32_16x16x16_bf16 v[202:205], a[232:233], v[144:145], v[166:169]
    v_mul_f32 v193, v162, v193
    v_cvt_pk_bf16_f32 v133, v192, v193
    v_mul_f32 v230, v162, v230
    v_mfma_f32_16x16x16_bf16 v[190:193], v[82:83], v[144:145], v[166:169]
    v_mul_f32 v231, v162, v231
    v_cvt_pk_bf16_f32 v126, v230, v231
    v_mul_f32 v232, v162, v232
    v_mfma_f32_16x16x16_bf16 v[194:197], v[106:107], v[144:145], v[166:169]
    ds_write_b128 v3, v[130:133] offset:0
    v_mul_f32 v233, v162, v233
    v_cvt_pk_bf16_f32 v127, v232, v233
    v_accvgpr_write_b32 a242, v114
    v_cvt_pk_bf16_f32 v116, v116, v117
    v_accvgpr_write_b32 a243, v116
    v_cvt_pk_bf16_f32 v92, v182, v183
    v_cvt_pk_bf16_f32 v93, v184, v185
    ds_read_b128 v[130:133], v143 offset:192
    ds_write_b64 v4, v[126:127] offset:4096
    v_cvt_pk_bf16_f32 v202, v202, v203
    v_accvgpr_write_b32 a232, v202
    v_cvt_pk_bf16_f32 v204, v204, v205
    v_accvgpr_write_b32 a233, v204
    v_cvt_pk_bf16_f32 v82, v190, v191
    v_cvt_pk_bf16_f32 v83, v192, v193
    v_cvt_pk_bf16_f32 v106, v194, v195
    v_cvt_pk_bf16_f32 v107, v196, v197
    ds_read_b128 v[114:117], v143 offset:256
    v_mov_b32 v142, v254
    v_max3_f32 v255, v186, v122, v123
    v_max3_f32 v255, v255, v124, v125
    v_max_f32_dpp v142, v142, v142 quad_perm:[1,0,3,2] row_mask:0xf bank_mask:0xf
    v_max3_f32 v255, v255, v150, v151
    v_max3_f32 v255, v255, v152, v153
    v_max_f32_dpp v142, v142, v142 quad_perm:[2,3,0,1] row_mask:0xf bank_mask:0xf
    v_max3_f32 v255, v255, v134, v135
    v_max3_f32 v255, v255, v136, v137
    v_max_f32_dpp v142, v142, v142 row_half_mirror row_mask:0xf bank_mask:0xf
    v_mov_b32 v126, v255
    s_nop 0
    v_max_f32_dpp v142, v142, v142 row_mirror row_mask:0xf bank_mask:0xf
    s_waitcnt lgkmcnt(2)
    v_mfma_f32_16x16x16_bf16 v[182:185], a[220:221], v[144:145], v[130:133]
    v_mov_b32 v127, v142
    v_permlane32_swap_b32 v255, v126
    v_mfma_f32_16x16x16_bf16 v[166:169], a[244:245], v[144:145], v[130:133]
    v_permlane32_swap_b32 v142, v127
    v_max_f32 v142, v142, v127
    v_mfma_f32_16x16x16_bf16 v[162:165], v[94:95], v[144:145], v[130:133]
    v_mov_b32 v127, v142
    v_max_f32 v255, v255, v126
    v_cvt_pk_bf16_f32 v182, v182, v183
    v_accvgpr_write_b32 a220, v182
    s_waitcnt lgkmcnt(0)
    v_mfma_f32_16x16x16_bf16 v[130:133], a[222:223], v[144:145], v[114:117]
    v_cvt_pk_bf16_f32 v184, v184, v185
    v_accvgpr_write_b32 a221, v184
    v_cvt_pk_bf16_f32 v166, v166, v167
    v_mfma_f32_16x16x16_bf16 v[182:185], a[246:247], v[144:145], v[114:117]
    v_accvgpr_write_b32 a244, v166
    v_cvt_pk_bf16_f32 v168, v168, v169
    v_accvgpr_write_b32 a245, v168
    v_mfma_f32_16x16x16_bf16 v[166:169], v[96:97], v[144:145], v[114:117]
    v_cvt_pk_bf16_f32 v94, v162, v163
    v_cvt_pk_bf16_f32 v95, v164, v165
    ds_read_b128 v[162:165], v143 offset:320
    v_cvt_pk_bf16_f32 v130, v130, v131
    v_accvgpr_write_b32 a222, v130
    v_cvt_pk_bf16_f32 v132, v132, v133
    v_accvgpr_write_b32 a223, v132
    v_cvt_pk_bf16_f32 v182, v182, v183
    v_accvgpr_write_b32 a246, v182
    v_cvt_pk_bf16_f32 v184, v184, v185
    v_accvgpr_write_b32 a247, v184
    v_cvt_pk_bf16_f32 v96, v166, v167
    v_cvt_pk_bf16_f32 v97, v168, v169
    ds_read_b128 v[130:133], v143 offset:384
    v_permlane16_swap_b32 v142, v127
    v_max_f32 v142, v142, v127
    v_sub_f32 v254, v254, v142
    v_exp_f32 v254, v254
    v_mov_b32 v126, v255
    v_cvt_pk_bf16_f32 v254, v254, v254
    ds_write_b16 v8, v254
    v_permlane16_swap_b32 v255, v126
    s_waitcnt lgkmcnt(2)
    v_mfma_f32_16x16x16_bf16 v[114:117], a[234:235], v[144:145], v[162:165]
    ds_read_b128 v[182:185], v9
    ds_read_b128 v[166:169], v9 offset:64
    v_max_f32 v255, v255, v126
    v_mfma_f32_16x16x16_bf16 v[202:205], v[84:85], v[144:145], v[162:165]
    v_sub_f32 v122, v122, v255
    v_exp_f32 v122, v122
    v_mfma_f32_16x16x16_bf16 v[230:233], v[108:109], v[144:145], v[162:165]
    v_sub_f32 v123, v123, v255
    v_cvt_pk_bf16_f32 v114, v114, v115
    v_accvgpr_write_b32 a234, v114
    s_waitcnt lgkmcnt(3)
    v_mfma_f32_16x16x16_bf16 v[162:165], a[224:225], v[144:145], v[130:133]
    v_cvt_pk_bf16_f32 v116, v116, v117
    v_accvgpr_write_b32 a235, v116
    v_cvt_pk_bf16_f32 v84, v202, v203
    v_mfma_f32_16x16x16_bf16 v[114:117], a[248:249], v[144:145], v[130:133]
    v_cvt_pk_bf16_f32 v85, v204, v205
    v_cvt_pk_bf16_f32 v108, v230, v231
    v_cvt_pk_bf16_f32 v109, v232, v233
    v_mfma_f32_16x16x16_bf16 v[230:233], v[98:99], v[144:145], v[130:133]
    ds_read_b128 v[202:205], v143 offset:448
    v_cvt_pk_bf16_f32 v162, v162, v163
    v_accvgpr_write_b32 a224, v162
    v_cvt_pk_bf16_f32 v164, v164, v165
    v_accvgpr_write_b32 a225, v164
    v_cvt_pk_bf16_f32 v114, v114, v115
    s_waitcnt lgkmcnt(2)
    v_mfma_f32_16x16x32_bf16 v[130:133], v[182:185], v[28:31], 0
    s_waitcnt lgkmcnt(1)
    v_accvgpr_write_b32 a248, v114
    v_cvt_pk_bf16_f32 v116, v116, v117
    v_mfma_f32_16x16x32_bf16 v[130:133], v[166:169], v[28:31], v[130:133]
    v_accvgpr_write_b32 a249, v116
    v_cvt_pk_bf16_f32 v98, v230, v231
    v_mfma_f32_16x16x32_bf16 v[114:117], v[182:185], v[118:121], 0
    v_cvt_pk_bf16_f32 v99, v232, v233
    v_sub_f32 v124, v124, v255
    v_mfma_f32_16x16x32_bf16 v[114:117], v[166:169], v[214:217], v[114:117]
    ds_read_b128 v[162:165], v143 offset:512
    v_sub_f32 v125, v125, v255
    v_mfma_f32_16x16x32_bf16 v[230:233], v[182:185], v[146:149], 0
    v_exp_f32 v123, v123
    v_mfma_f32_16x16x32_bf16 v[230:233], v[166:169], v[234:237], v[230:233]
    s_waitcnt lgkmcnt(1)
    v_cvt_pk_bf16_f32 v122, v122, v123
    v_sub_f32 v150, v150, v255
    v_mfma_f32_16x16x32_bf16 v[190:193], v[182:185], v[174:177], 0
    v_exp_f32 v124, v124
    v_mfma_f32_16x16x32_bf16 v[190:193], v[166:169], v[246:249], v[190:193]
    v_exp_f32 v125, v125
    v_sub_f32 v151, v151, v255
    v_mfma_f32_16x16x16_bf16 v[182:185], a[226:227], v[144:145], v[202:205]
    v_cvt_pk_bf16_f32 v123, v124, v125
    v_exp_f32 v150, v150
    v_mfma_f32_16x16x16_bf16 v[166:169], a[250:251], v[144:145], v[202:205]
    v_exp_f32 v151, v151
    v_sub_f32 v152, v152, v255
    v_mfma_f32_16x16x16_bf16 v[194:197], v[100:101], v[144:145], v[202:205]
    s_waitcnt lgkmcnt(0)
    v_cvt_pk_bf16_f32 v124, v150, v151
    v_cvt_pk_bf16_f32 v182, v182, v183
    v_mfma_f32_16x16x16_bf16 v[218:221], a[236:237], v[144:145], v[162:165]
    v_accvgpr_write_b32 a226, v182
    v_cvt_pk_bf16_f32 v184, v184, v185
    v_accvgpr_write_b32 a227, v184
    v_mfma_f32_16x16x16_bf16 v[182:185], v[86:87], v[144:145], v[162:165]
    v_cvt_pk_bf16_f32 v166, v166, v167
    v_accvgpr_write_b32 a250, v166
    v_cvt_pk_bf16_f32 v168, v168, v169
    v_mfma_f32_16x16x16_bf16 v[202:205], v[110:111], v[144:145], v[162:165]
    v_accvgpr_write_b32 a251, v168
    v_cvt_pk_bf16_f32 v100, v194, v195
    v_cvt_pk_bf16_f32 v101, v196, v197
    ds_read_b128 v[166:169], v143 offset:576
    v_cvt_pk_bf16_f32 v218, v218, v219
    v_accvgpr_write_b32 a236, v218
    v_cvt_pk_bf16_f32 v220, v220, v221
    v_accvgpr_write_b32 a237, v220
    v_cvt_pk_bf16_f32 v86, v182, v183
    v_cvt_pk_bf16_f32 v87, v184, v185
    v_cvt_pk_bf16_f32 v110, v202, v203
    v_cvt_pk_bf16_f32 v111, v204, v205
    ds_read_b128 v[182:185], v143 offset:640
    v_exp_f32 v152, v152
    v_sub_f32 v153, v153, v255
    v_exp_f32 v153, v153
    v_mfma_f32_16x16x32_f16 v[162:165], v[154:157], v[238:241], v[70:73]
    v_cvt_pk_bf16_f32 v125, v152, v153
    v_sub_f32 v134, v134, v255
    v_exp_f32 v134, v134
    v_sub_f32 v135, v135, v255
    v_exp_f32 v135, v135
    v_sub_f32 v136, v136, v255
    v_mfma_f32_16x16x16_f16 v[162:165], v[128:129], v[138:139], v[162:165]
    s_waitcnt lgkmcnt(1)
    v_cvt_pk_bf16_f32 v36, v134, v135
    v_sub_f32 v137, v137, v255
    v_mfma_f32_16x16x16_bf16 v[154:157], a[228:229], v[144:145], v[166:169]
    v_exp_f32 v136, v136
    v_exp_f32 v137, v137
    v_mfma_f32_16x16x32_f16 v[126:129], v[210:213], v[238:241], v[74:77]
    v_cvt_pk_bf16_f32 v37, v136, v137
    v_max3_f32 v254, v178, v162, v163
    v_mfma_f32_16x16x32_f16 v[134:137], v[158:161], v[238:241], v[78:81]
    s_waitcnt lgkmcnt(0)
    v_max3_f32 v254, v254, v164, v165
    v_cvt_pk_bf16_f32 v154, v154, v155
    v_accvgpr_write_b32 a228, v154
    v_mfma_f32_16x16x16_f16 v[126:129], v[172:173], v[138:139], v[126:129]
    v_cvt_pk_bf16_f32 v156, v156, v157
    v_accvgpr_write_b32 a229, v156
    v_sub_f32 v186, v186, v255
    v_mfma_f32_16x16x16_f16 v[134:137], v[140:141], v[138:139], v[134:137]
    v_exp_f32 v186, v186
    v_mfma_f32_16x16x16_bf16 v[138:141], a[252:253], v[144:145], v[166:169]
    v_cvt_pk_bf16_f32 v39, v186, 0
    v_rcp_f32 v130, v130
    v_mfma_f32_16x16x16_bf16 v[158:161], v[102:103], v[144:145], v[166:169]
    v_max3_f32 v254, v254, v126, v127
    v_max3_f32 v254, v254, v128, v129
    v_mul_f32 v114, v114, v130
    v_max3_f32 v254, v254, v134, v135
    v_mfma_f32_16x16x32_bf16 v[154:157], v[28:31], v[36:39], 0
    v_cvt_pk_bf16_f32 v138, v138, v139
    v_accvgpr_write_b32 a252, v138
    v_mfma_f32_16x16x32_bf16 v[154:157], v[28:31], v[122:125], v[154:157]
    v_cvt_pk_bf16_f32 v140, v140, v141
    v_accvgpr_write_b32 a253, v140
    v_mfma_f32_16x16x32_bf16 v[150:153], v[214:217], v[36:39], 0
    v_cvt_pk_bf16_f32 v102, v158, v159
    v_cvt_pk_bf16_f32 v103, v160, v161
    v_mfma_f32_16x16x32_bf16 v[150:153], v[118:121], v[122:125], v[150:153]
    ds_read_b128 v[138:141], v143 offset:704
    v_max3_f32 v254, v254, v136, v137
    v_mfma_f32_16x16x32_bf16 v[158:161], v[234:237], v[36:39], 0
    v_rcp_f32 v154, v154
    v_mfma_f32_16x16x32_bf16 v[158:161], v[146:149], v[122:125], v[158:161]
    v_mov_b32 v255, v254
    v_mul_f32_dpp v114, v230, v130 quad_perm:[0,1,2,3] row_mask:0x2 bank_mask:0xf
    v_mfma_f32_16x16x32_bf16 v[170:173], v[246:249], v[36:39], 0
    v_mul_f32 v150, v154, v150
    v_mul_f32 v151, v154, v151
    v_mfma_f32_16x16x32_bf16 v[170:173], v[174:177], v[122:125], v[170:173]
    v_cvt_pk_bf16_f32 v122, v150, v151
    v_mul_f32 v152, v154, v152
    v_mul_f32 v153, v154, v153
    v_mfma_f32_16x16x16_bf16 v[166:169], a[230:231], v[144:145], v[182:185]
    v_cvt_pk_bf16_f32 v123, v152, v153
    v_mul_f32 v158, v154, v158
    v_mul_f32 v159, v154, v159
    v_mfma_f32_16x16x16_bf16 v[238:241], a[254:255], v[144:145], v[182:185]
    v_cvt_pk_bf16_f32 v124, v158, v159
    v_mul_f32 v160, v154, v160
    v_mul_f32 v161, v154, v161
    v_mfma_f32_16x16x16_bf16 v[150:153], v[104:105], v[144:145], v[182:185]
    s_waitcnt lgkmcnt(0)
    v_cvt_pk_bf16_f32 v125, v160, v161
    v_mul_f32 v170, v154, v170
    v_mfma_f32_16x16x16_bf16 v[158:161], a[238:239], v[144:145], v[138:141]
    v_mul_f32 v171, v154, v171
    v_cvt_pk_bf16_f32 v116, v170, v171
    v_mul_f32 v172, v154, v172
    v_mfma_f32_16x16x16_bf16 v[182:185], v[88:89], v[144:145], v[138:141]
    v_mul_f32 v173, v154, v173
    v_cvt_pk_bf16_f32 v117, v172, v173
    v_cvt_pk_bf16_f32 v166, v166, v167
    v_mfma_f32_16x16x16_bf16 v[154:157], v[112:113], v[144:145], v[138:141]
    ds_write_b128 v3, v[122:125] offset:6144
    v_accvgpr_write_b32 a230, v166
    v_cvt_pk_bf16_f32 v168, v168, v169
    v_accvgpr_write_b32 a231, v168
    v_cvt_pk_bf16_f32 v238, v238, v239
    v_accvgpr_write_b32 a254, v238
    v_cvt_pk_bf16_f32 v240, v240, v241
    v_accvgpr_write_b32 a255, v240
    ds_write_b64 v4, v[116:117] offset:10240
    v_cvt_pk_bf16_f32 v104, v150, v151
    v_cvt_pk_bf16_f32 v105, v152, v153
    v_cvt_pk_bf16_f32 v158, v158, v159
    v_accvgpr_write_b32 a238, v158
    v_cvt_pk_bf16_f32 v160, v160, v161
    v_accvgpr_write_b32 a239, v160
    v_cvt_pk_bf16_f32 v88, v182, v183
    v_cvt_pk_bf16_f32 v89, v184, v185
    v_cvt_pk_bf16_f32 v112, v154, v155
    v_cvt_pk_bf16_f32 v113, v156, v157
    v_permlane32_swap_b32 v254, v255
    v_max_f32 v254, v254, v255
    v_mov_b32 v255, v254
    v_mul_f32_dpp v114, v190, v130 quad_perm:[0,1,2,3] row_mask:0x4 bank_mask:0xf
    v_cvt_pk_bf16_f32 v114, v114, v114
    ds_write_b16 v7, v114
    v_permlane16_swap_b32 v254, v255
    v_max_f32 v254, v254, v255
    v_sub_f32 v162, v162, v254
    v_exp_f32 v162, v162
    v_sub_f32 v163, v163, v254
    v_exp_f32 v163, v163
    v_sub_f32 v164, v164, v254
    v_cvt_pk_bf16_f32 v138, v162, v163
    v_exp_f32 v164, v164
    ds_read_b128 v[186:189], v0 offset:20480
    ds_read_b128 v[194:197], v1 offset:20480
    ds_read_b128 v[122:125], v0 offset:20608
    ds_read_b128 v[202:205], v1 offset:20608
    ds_read_b128 v[230:233], v0 offset:20736
    ds_read_b128 v[238:241], v1 offset:20736
    v_sub_f32 v165, v165, v254
    v_exp_f32 v165, v165
    v_sub_f32 v126, v126, v254
    v_cvt_pk_bf16_f32 v139, v164, v165
    v_exp_f32 v126, v126
    v_sub_f32 v127, v127, v254
    v_exp_f32 v127, v127
    v_sub_f32 v128, v128, v254
    v_cvt_pk_bf16_f32 v140, v126, v127
    v_exp_f32 v128, v128
    s_waitcnt lgkmcnt(5)
    v_mfma_f32_16x16x32_bf16 v[150:153], a[72:75], v[186:189], 0
    s_waitcnt lgkmcnt(3)
    v_sub_f32 v129, v129, v254
    v_sub_f32 v134, v134, v254
    v_mfma_f32_16x16x32_bf16 v[150:153], a[76:79], v[194:197], v[150:153]
    s_waitcnt lgkmcnt(2)
    v_exp_f32 v129, v129
    v_mfma_f32_16x16x32_bf16 v[150:153], a[80:83], v[122:125], v[150:153]
    s_waitcnt lgkmcnt(1)
    v_cvt_pk_bf16_f32 v141, v128, v129
    v_sub_f32 v135, v135, v254
    v_mfma_f32_16x16x32_bf16 v[150:153], a[84:87], v[202:205], v[150:153]
    s_waitcnt lgkmcnt(0)
    v_exp_f32 v134, v134
    v_mfma_f32_16x16x32_bf16 v[150:153], a[88:91], v[230:233], v[150:153]
    v_exp_f32 v135, v135
    v_mfma_f32_16x16x32_bf16 v[150:153], a[92:95], v[238:241], v[150:153]
    v_cvt_pk_bf16_f32 v36, v134, v135
    v_sub_f32 v136, v136, v254
    v_mfma_f32_16x16x32_bf16 v[162:165], a[96:99], v[186:189], 0
    v_exp_f32 v136, v136
    v_mfma_f32_16x16x32_bf16 v[162:165], a[100:103], v[194:197], v[162:165]
    v_sub_f32 v137, v137, v254
    v_sub_f32 v178, v178, v254
    v_mfma_f32_16x16x32_bf16 v[162:165], a[104:107], v[122:125], v[162:165]
    v_exp_f32 v137, v137
    v_mfma_f32_16x16x32_bf16 v[162:165], a[108:111], v[202:205], v[162:165]
    v_cvt_pk_bf16_f32 v37, v136, v137
    v_add_u32 v7, 16, v7
    v_mfma_f32_16x16x32_bf16 v[162:165], a[112:115], v[230:233], v[162:165]
    v_exp_f32 v178, v178
    v_mfma_f32_16x16x32_bf16 v[162:165], a[116:119], v[238:241], v[162:165]
    v_cvt_pk_bf16_f32 v39, v178, 0
    v_mfma_f32_16x16x32_bf16 v[170:173], a[120:123], v[186:189], 0
    v_mfma_f32_16x16x32_bf16 v[170:173], a[124:127], v[194:197], v[170:173]
    v_mfma_f32_16x16x32_bf16 v[142:145], v[28:31], v[36:39], 0
    v_mfma_f32_16x16x32_bf16 v[142:145], v[28:31], v[138:141], v[142:145]
    v_mfma_f32_16x16x32_bf16 v[158:161], v[214:217], v[36:39], 0
    v_mfma_f32_16x16x32_bf16 v[158:161], v[118:121], v[138:141], v[158:161]
    v_mfma_f32_16x16x32_bf16 v[118:121], v[234:237], v[36:39], 0
    v_mfma_f32_16x16x32_bf16 v[118:121], v[146:149], v[138:141], v[118:121]
    v_mfma_f32_16x16x32_bf16 v[126:129], v[246:249], v[36:39], 0
    v_mfma_f32_16x16x32_bf16 v[126:129], v[174:177], v[138:141], v[126:129]
    v_mfma_f32_16x16x32_bf16 v[170:173], a[128:131], v[122:125], v[170:173]
    v_mfma_f32_16x16x32_bf16 v[170:173], a[132:135], v[202:205], v[170:173]
    v_rcp_f32 v142, v142
    v_mfma_f32_16x16x32_bf16 v[170:173], a[136:139], v[230:233], v[170:173]
    v_mul_f32 v158, v142, v158
    v_mul_f32 v159, v142, v159
    v_mfma_f32_16x16x32_bf16 v[170:173], a[140:143], v[238:241], v[170:173]
    v_cvt_pk_bf16_f32 v174, v158, v159
    v_mul_f32 v160, v142, v160
    v_mfma_f32_16x16x32_bf16 v[138:141], a[0:3], v[186:189], 0
    v_mul_f32 v161, v142, v161
    v_cvt_pk_bf16_f32 v175, v160, v161
    v_mfma_f32_16x16x32_bf16 v[138:141], a[4:7], v[194:197], v[138:141]
    v_mul_f32 v118, v142, v118
    v_mul_f32 v119, v142, v119
    v_mfma_f32_16x16x32_bf16 v[138:141], a[8:11], v[122:125], v[138:141]
    v_cvt_pk_bf16_f32 v176, v118, v119
    v_mul_f32 v120, v142, v120
    v_mfma_f32_16x16x32_bf16 v[138:141], a[12:15], v[202:205], v[138:141]
    v_mul_f32 v121, v142, v121
    v_cvt_pk_bf16_f32 v177, v120, v121
    v_mfma_f32_16x16x32_bf16 v[138:141], a[16:19], v[230:233], v[138:141]
    ds_write_b128 v3, v[174:177] offset:12288
    v_mfma_f32_16x16x32_bf16 v[138:141], a[20:23], v[238:241], v[138:141]
    v_mul_f32 v126, v142, v126
    v_mul_f32 v127, v142, v127
    v_mfma_f32_16x16x32_bf16 v[166:169], a[24:27], v[186:189], 0
    v_cvt_pk_bf16_f32 v254, v126, v127
    v_mul_f32 v128, v142, v128
    v_mfma_f32_16x16x32_bf16 v[166:169], a[28:31], v[194:197], v[166:169]
    v_mul_f32 v129, v142, v129
    v_cvt_pk_bf16_f32 v255, v128, v129
    v_mfma_f32_16x16x32_bf16 v[166:169], a[32:35], v[122:125], v[166:169]
    ds_write_b64 v4, v[254:255] offset:16384
    v_mfma_f32_16x16x32_bf16 v[166:169], a[36:39], v[202:205], v[166:169]
    v_xor_b32 v3, 65536, v3
    v_xor_b32 v4, 65536, v4
    v_mfma_f32_16x16x32_bf16 v[166:169], a[40:43], v[230:233], v[166:169]
    v_mfma_f32_16x16x32_bf16 v[166:169], a[44:47], v[238:241], v[166:169]
    v_mfma_f32_16x16x32_bf16 v[134:137], a[48:51], v[186:189], 0
    v_mfma_f32_16x16x32_bf16 v[134:137], a[52:55], v[194:197], v[134:137]
    s_waitcnt lgkmcnt(0)
    s_barrier
    s_waitcnt lgkmcnt(0)
    s_cmp_eq_u32 s45, 0
    s_cbranch_scc1 L_drain
    s_nop 0
    s_lshr_b32 s3, s44, 8
    s_cbranch_scc1 L_safe
    v_cvt_pk_f16_f32 v146, v150, v151
    v_pk_mul_f16 v143, v146, v146
    v_cvt_pk_f16_f32 v147, v152, v153
    v_pk_fma_f16 v143, v147, v147, v143
    v_cvt_pk_f16_f32 v148, v162, v163
    v_pk_fma_f16 v143, v148, v148, v143
    v_cvt_pk_f16_f32 v149, v164, v165
    v_pk_fma_f16 v143, v149, v149, v143
    v_cvt_pk_f16_f32 v120, v170, v171
    v_pk_fma_f16 v143, v120, v120, v143
    v_cvt_pk_f16_f32 v121, v172, v173
    v_pk_fma_f16 v143, v121, v121, v143
    v_and_b32 v118, 16, v2
    v_sub_u32 v5, v5, v118
    v_mov_b32 v25, 0
    s_nop 7
    s_branch L_go
L_safe:
    v_fma_f32 v174, v150, v150, s32
    v_fmac_f32 v174, v151, v151
    v_fmac_f32 v174, v152, v152
    v_fmac_f32 v174, v153, v153
    s_nop 7
L_LOOP:
    v_mfma_f32_16x16x32_bf16 v[134:137], a[56:59], v[122:125], v[134:137]
    s_add_u32 s12, s40, s27
    ds_read_b128 v[118:121], v2 offset:18432
    ds_read_b128 v[142:145], v2 offset:19456
    v_mfma_f32_16x16x32_bf16 v[134:137], a[60:63], v[202:205], v[134:137]
    s_addc_u32 s13, s41, 0
    v_fmac_f32 v174, v162, v162
    v_fmac_f32 v174, v163, v163
    v_mfma_f32_16x16x32_bf16 v[134:137], a[64:67], v[230:233], v[134:137]
    s_sub_u32 s14, s36, s27
    v_fmac_f32 v174, v164, v164
    v_fmac_f32 v174, v165, v165
    v_mfma_f32_16x16x32_bf16 v[134:137], a[68:71], v[238:241], v[134:137]
    s_cmp_ge_u32 s18, 2
    v_fmac_f32 v174, v170, v170
    v_fmac_f32 v174, v171, v171
    v_mfma_f32_16x16x32_bf16 v[146:149], v[186:189], a[144:147], 0
    s_cselect_b32 s14, s14, 0
    v_fmac_f32 v174, v172, v172
    v_fmac_f32 v174, v173, v173
    v_mfma_f32_16x16x32_bf16 v[146:149], v[194:197], a[148:151], v[146:149]
    s_sub_u32 s82, s72, s71
    v_fma_f32 v254, v138, v138, s32
    v_fmac_f32 v254, v139, v139
    v_mfma_f32_16x16x32_bf16 v[146:149], v[122:125], a[152:155], v[146:149]
    s_mul_i32 s74, s82, 336
    v_fmac_f32 v254, v140, v140
    v_fmac_f32 v254, v141, v141
    v_mfma_f32_16x16x32_bf16 v[146:149], v[202:205], a[156:159], v[146:149]
    s_mul_i32 s75, s82, 272
    v_fmac_f32 v254, v166, v166
    v_fmac_f32 v254, v167, v167
    v_mfma_f32_16x16x32_bf16 v[146:149], v[230:233], a[160:163], v[146:149]
    s_waitcnt lgkmcnt(0)
    v_fmac_f32 v254, v168, v168
    v_fmac_f32 v254, v169, v169
    v_mfma_f32_16x16x32_bf16 v[182:185], v[32:35], v[118:121], 0
    s_mul_i32 s76, s82, 16
    v_fmac_f32 v254, v134, v134
    v_fmac_f32 v254, v135, v135
    v_mfma_f32_16x16x32_bf16 v[182:185], v[32:35], v[142:145], v[182:185]
    s_add_u32 s34, s18, 2
    v_fmac_f32 v254, v136, v136
    v_fmac_f32 v254, v137, v137
    v_mfma_f32_16x16x32_bf16 v[146:149], v[238:241], a[164:167], v[146:149]
    s_add_u32 s8, s60, s23
    ds_read_b128 v[190:193], v0 offset:26624
    v_cvt_pk_bf16_f32 v36, v254, v174
    v_mfma_f32_16x16x32_bf16 v[118:121], v[186:189], a[168:171], 0
    s_addc_u32 s9, s61, 0
    ds_read_b128 v[210:213], v1 offset:26624
    v_mul_f32 v254, 0x3baaaaab, v182
    v_mfma_f32_16x16x32_bf16 v[214:217], v[32:35], v[36:39], 0
    s_sub_u32 s10, s36, s23
    v_cvt_pk_bf16_f32 v142, v146, v147
    v_cvt_pk_bf16_f32 v143, v148, v149
    v_mfma_f32_16x16x32_bf16 v[118:121], v[194:197], a[172:175], v[118:121]
    s_cmp_le_u32 s34, s45
    ds_read_b128 v[218:221], v0 offset:26752
    v_mul_f32 v255, 0x3baaaaab, v183
    v_mfma_f32_16x16x32_bf16 v[118:121], v[122:125], a[176:179], v[118:121]
    s_cselect_b32 s10, s10, 0
    ds_read_b128 v[222:225], v1 offset:26752
    v_mul_f32 v144, 0x3baaaaab, v184
    v_mfma_f32_16x16x32_bf16 v[118:121], v[202:205], a[180:183], v[118:121]
    s_add_u32 m0, s28, 0
    v_rsq_f32 v215, v215
    v_mfma_f32_16x16x32_bf16 v[118:121], v[230:233], a[184:187], v[118:121]
    s_mov_b32 s27, s26
    v_rsq_f32 v214, v214
    v_mfma_f32_16x16x32_bf16 v[118:121], v[238:241], a[188:191], v[118:121]
    s_mov_b32 s26, s25
    v_mul_f32 v214, s31, v214
    v_mul_f32 v150, v215, v150
    v_mul_f32 v151, v215, v151
    v_cvt_pk_f16_f32 v174, v150, v151
    v_mfma_f32_16x16x32_bf16 v[182:185], v[186:189], a[192:195], 0
    s_waitcnt lgkmcnt(2)
    ds_read_b128 v[186:189], v0 offset:26880
    v_cvt_pk_bf16_f32 v146, v118, v119
    v_mfma_f32_16x16x32_bf16 v[182:185], v[194:197], a[196:199], v[182:185]
    s_mov_b32 s25, s24
    ds_read_b128 v[194:197], v1 offset:26880
    v_cvt_pk_bf16_f32 v147, v120, v121
    v_mfma_f32_16x16x32_bf16 v[182:185], v[122:125], a[200:203], v[182:185]
    s_mov_b32 s24, s23
    v_mul_f32 v152, v215, v152
    v_mul_f32 v153, v215, v153
    v_mfma_f32_16x16x32_bf16 v[182:185], v[202:205], a[204:207], v[182:185]
    s_ff1_i32_b32 s77, s100
    v_cvt_pk_f16_f32 v175, v152, v153
    v_mul_f32 v162, v215, v162
    v_mfma_f32_16x16x32_bf16 v[182:185], v[230:233], a[208:211], v[182:185]
    s_mul_i32 s78, s77, 2688
    v_mul_f32 v163, v215, v163
    v_cvt_pk_f16_f32 v176, v162, v163
    v_mfma_f32_16x16x32_bf16 v[182:185], v[238:241], a[212:215], v[182:185]
    s_mov_b32 s71, s72
    v_mul_f32 v164, v215, v164
    v_mul_f32 v165, v215, v165
    v_mfma_f32_16x16x32_bf16 v[122:125], a[72:75], v[190:193], 0
    s_mov_b32 s72, s73
    v_cvt_pk_f16_f32 v177, v164, v165
    v_mul_f32 v170, v215, v170
    v_mfma_f32_16x16x32_bf16 v[122:125], a[76:79], v[210:213], v[122:125]
    s_waitcnt lgkmcnt(2)
    v_cvt_pk_bf16_f32 v150, v182, v183
    v_cvt_pk_bf16_f32 v151, v184, v185
    v_mfma_f32_16x16x32_bf16 v[122:125], a[80:83], v[218:221], v[122:125]
    s_waitcnt lgkmcnt(1)
    v_mul_f32 v171, v215, v171
    v_cvt_pk_f16_f32 v120, v170, v171
    v_mfma_f32_16x16x32_bf16 v[122:125], a[84:87], v[222:225], v[122:125]
    s_waitcnt lgkmcnt(0)
    v_mul_f32 v172, v215, v172
    v_mul_f32 v173, v215, v173
    v_mfma_f32_16x16x32_bf16 v[122:125], a[88:91], v[186:189], v[122:125]
    v_cvt_pk_f16_f32 v121, v172, v173
    v_mul_f32 v138, v214, v138
    v_mfma_f32_16x16x32_bf16 v[122:125], a[92:95], v[194:197], v[122:125]
    v_mul_f32 v139, v214, v139
    v_cvt_pk_f16_f32 v202, v138, v139
    v_mfma_f32_16x16x32_bf16 v[162:165], a[96:99], v[190:193], 0
    v_mul_f32 v140, v214, v140
    v_mul_f32 v141, v214, v141
    v_mfma_f32_16x16x32_bf16 v[162:165], a[100:103], v[210:213], v[162:165]
    v_cvt_pk_f16_f32 v203, v140, v141
    v_mul_f32 v166, v214, v166
    v_mfma_f32_16x16x32_bf16 v[162:165], a[104:107], v[218:221], v[162:165]
    v_mul_f32 v167, v214, v167
    v_cvt_pk_f16_f32 v204, v166, v167
    v_mfma_f32_16x16x32_bf16 v[162:165], a[108:111], v[222:225], v[162:165]
    v_mul_f32 v168, v214, v168
    v_mul_f32 v169, v214, v169
    v_mfma_f32_16x16x32_bf16 v[162:165], a[112:115], v[186:189], v[162:165]
    v_cvt_pk_f16_f32 v205, v168, v169
    v_mul_f32 v134, v214, v134
    v_mfma_f32_16x16x32_bf16 v[162:165], a[116:119], v[194:197], v[162:165]
    v_mul_f32 v135, v214, v135
    v_cvt_pk_f16_f32 v118, v134, v135
    v_mfma_f32_16x16x32_bf16 v[166:169], a[120:123], v[190:193], 0
    v_mul_f32 v136, v214, v136
    v_mul_f32 v137, v214, v137
    v_mfma_f32_16x16x32_bf16 v[166:169], a[124:127], v[210:213], v[166:169]
    v_cvt_pk_f16_f32 v119, v136, v137
    v_fma_f32 v145, v122, v122, s32
    v_mfma_f32_16x16x32_bf16 v[166:169], a[128:131], v[218:221], v[166:169]
    v_rsq_f32 v254, v254
    v_mfma_f32_16x16x32_bf16 v[166:169], a[132:135], v[222:225], v[166:169]
    v_fmac_f32 v145, v123, v123
    v_fmac_f32 v145, v124, v124
    v_mfma_f32_16x16x32_bf16 v[166:169], a[136:139], v[186:189], v[166:169]
    v_fmac_f32 v145, v125, v125
    v_fmac_f32 v145, v162, v162
    v_mfma_f32_16x16x32_bf16 v[166:169], a[140:143], v[194:197], v[166:169]
    v_fmac_f32 v145, v163, v163
    v_fmac_f32 v145, v164, v164
    v_mfma_f32_16x16x32_bf16 v[134:137], a[0:3], v[190:193], 0
    v_fmac_f32 v145, v165, v165
    v_mul_f32 v178, v254, v178
    v_mfma_f32_16x16x32_bf16 v[134:137], a[4:7], v[210:213], v[134:137]
    v_rsq_f32 v255, v255
    v_mfma_f32_16x16x32_bf16 v[134:137], a[8:11], v[218:221], v[134:137]
    v_fmac_f32 v145, v166, v166
    v_fmac_f32 v145, v167, v167
    v_mfma_f32_16x16x32_bf16 v[134:137], a[12:15], v[222:225], v[134:137]
    v_fmac_f32 v145, v168, v168
    v_fmac_f32 v145, v169, v169
    v_mfma_f32_16x16x32_bf16 v[134:137], a[16:19], v[186:189], v[134:137]
    v_rsq_f32 v144, v144
    v_mfma_f32_16x16x32_bf16 v[134:137], a[20:23], v[194:197], v[134:137]
    v_mul_f32 v242, v144, v242
    v_mul_f32 v243, v144, v243
    v_mfma_f32_16x16x32_bf16 v[170:173], a[24:27], v[190:193], 0
    v_cvt_pk_bf16_f32 v138, v242, v243
    v_mul_f32 v244, v144, v244
    v_mfma_f32_16x16x32_bf16 v[170:173], a[28:31], v[210:213], v[170:173]
    v_mul_f32 v245, v144, v245
    v_cvt_pk_bf16_f32 v139, v244, v245
    v_mfma_f32_16x16x32_bf16 v[170:173], a[32:35], v[218:221], v[170:173]
    v_fma_f32 v148, v134, v134, s32
    v_fmac_f32 v148, v135, v135
    v_mfma_f32_16x16x32_bf16 v[170:173], a[36:39], v[222:225], v[170:173]
    v_fmac_f32 v148, v136, v136
    v_fmac_f32 v148, v137, v137
    v_mfma_f32_16x16x32_bf16 v[170:173], a[40:43], v[186:189], v[170:173]
    v_mul_f32 v158, v144, v158
    v_mul_f32 v159, v144, v159
    v_mfma_f32_16x16x32_bf16 v[170:173], a[44:47], v[194:197], v[170:173]
    v_cvt_pk_bf16_f32 v140, v158, v159
    v_mul_f32 v160, v144, v160
    v_mfma_f32_16x16x32_bf16 v[182:185], a[48:51], v[190:193], 0
    v_mul_f32 v161, v144, v161
    v_cvt_pk_bf16_f32 v141, v160, v161
    v_mfma_f32_16x16x32_bf16 v[182:185], a[52:55], v[210:213], v[182:185]
    buffer_store_dwordx4 v[138:141], v17, s[12:15], 0 offen nt
    v_mul_f32 v154, v144, v154
    v_fmac_f32 v148, v170, v170
    v_fmac_f32 v148, v171, v171
    v_fmac_f32 v148, v172, v172
    v_mfma_f32_16x16x32_bf16 v[182:185], a[56:59], v[218:221], v[182:185]
    v_fmac_f32 v148, v173, v173
    v_mul_f32 v155, v144, v155
    v_mfma_f32_16x16x32_bf16 v[182:185], a[60:63], v[222:225], v[182:185]
    v_cvt_pk_bf16_f32 v152, v154, v155
    v_mul_f32 v156, v144, v156
    v_mfma_f32_16x16x32_bf16 v[182:185], a[64:67], v[186:189], v[182:185]
    v_mul_f32 v157, v144, v157
    v_cvt_pk_bf16_f32 v153, v156, v157
    v_mfma_f32_16x16x32_bf16 v[182:185], a[68:71], v[194:197], v[182:185]
    v_mul_f32 v179, v254, v179
    v_cvt_pk_bf16_f32 v158, v178, v179
    v_mfma_f32_16x16x32_bf16 v[138:141], v[190:193], a[144:147], 0
    v_mul_f32 v180, v254, v180
    v_mul_f32 v181, v254, v181
    v_mfma_f32_16x16x32_bf16 v[138:141], v[210:213], a[148:151], v[138:141]
    v_cvt_pk_bf16_f32 v159, v180, v181
    v_mul_f32 v198, v254, v198
    v_mfma_f32_16x16x32_bf16 v[138:141], v[218:221], a[152:155], v[138:141]
    v_fmac_f32 v148, v182, v182
    v_fmac_f32 v148, v183, v183
    v_mfma_f32_16x16x32_bf16 v[138:141], v[222:225], a[156:159], v[138:141]
    v_fmac_f32 v148, v184, v184
    v_fmac_f32 v148, v185, v185
    v_mfma_f32_16x16x32_bf16 v[138:141], v[186:189], a[160:163], v[138:141]
    v_cvt_pk_bf16_f32 v36, v148, v145
    v_mul_f32 v199, v254, v199
    v_mfma_f32_16x16x32_bf16 v[138:141], v[194:197], a[164:167], v[138:141]
    ds_read_b128 v[214:217], v0 offset:32768
    v_cvt_pk_bf16_f32 v160, v198, v199
    v_mfma_f32_16x16x32_bf16 v[178:181], v[32:35], v[36:39], 0
    v_mul_f32 v200, v254, v200
    v_mul_f32 v201, v254, v201
    v_mfma_f32_16x16x32_bf16 v[154:157], v[190:193], a[168:171], 0
    ds_read_b128 v[226:229], v1 offset:32768
    v_cvt_pk_bf16_f32 v161, v200, v201
    v_mfma_f32_16x16x32_bf16 v[154:157], v[210:213], a[172:175], v[154:157]
    ds_read_b128 v[198:201], v0 offset:32896
    v_cvt_pk_bf16_f32 v144, v138, v139
    v_mfma_f32_16x16x32_bf16 v[154:157], v[218:221], a[176:179], v[154:157]
    v_cvt_pk_bf16_f32 v145, v140, v141
    v_mul_f32 v206, v254, v206
    v_mfma_f32_16x16x32_bf16 v[154:157], v[222:225], a[180:183], v[154:157]
    ds_read_b128 v[230:233], v1 offset:32896
    v_mul_f32 v207, v254, v207
    v_mfma_f32_16x16x32_bf16 v[154:157], v[186:189], a[184:187], v[154:157]
    v_rsq_f32 v179, v179
    v_mfma_f32_16x16x32_bf16 v[154:157], v[194:197], a[188:191], v[154:157]
    buffer_store_dwordx2 v[152:153], v20, s[12:15], 0 offen nt
    v_rsq_f32 v178, v178
    v_mul_f32 v122, v179, v122
    v_mul_f32 v178, s31, v178
    v_mul_f32 v123, v179, v123
    v_cvt_pk_f16_f32 v138, v122, v123
    v_mul_f32 v124, v179, v124
    v_mul_f32 v125, v179, v125
    v_cvt_pk_bf16_f32 v148, v154, v155
    v_mfma_f32_16x16x32_bf16 v[234:237], v[190:193], a[192:195], 0
    s_waitcnt lgkmcnt(2)
    ds_read_b128 v[190:193], v0 offset:33024
    v_cvt_pk_bf16_f32 v149, v156, v157
    v_mfma_f32_16x16x32_bf16 v[234:237], v[210:213], a[196:199], v[234:237]
    s_waitcnt lgkmcnt(2)
    ds_read_b128 v[210:213], v1 offset:33024
    v_cvt_pk_f16_f32 v139, v124, v125
    v_mfma_f32_16x16x32_bf16 v[234:237], v[218:221], a[200:203], v[234:237]
    v_mul_f32 v162, v179, v162
    v_mul_f32 v163, v179, v163
    v_mfma_f32_16x16x32_bf16 v[234:237], v[222:225], a[204:207], v[234:237]
    s_waitcnt vmcnt(2)
    v_cvt_pk_f16_f32 v140, v162, v163
    v_mul_f32 v164, v179, v164
    v_mfma_f32_16x16x32_bf16 v[234:237], v[186:189], a[208:211], v[234:237]
    s_waitcnt lgkmcnt(2)
    v_mul_f32 v165, v179, v165
    v_cvt_pk_f16_f32 v141, v164, v165
    v_mfma_f32_16x16x32_bf16 v[234:237], v[194:197], a[212:215], v[234:237]
    v_mul_f32 v166, v179, v166
    v_mul_f32 v167, v179, v167
    v_mfma_f32_16x16x32_bf16 v[186:189], a[72:75], v[214:217], 0
    v_cvt_pk_f16_f32 v124, v166, v167
    v_mul_f32 v168, v179, v168
    v_mfma_f32_16x16x32_bf16 v[186:189], a[76:79], v[226:229], v[186:189]
    v_mul_f32 v169, v179, v169
    v_cvt_pk_f16_f32 v125, v168, v169
    v_mfma_f32_16x16x32_bf16 v[186:189], a[80:83], v[198:201], v[186:189]
    s_waitcnt lgkmcnt(1)
    v_cvt_pk_bf16_f32 v152, v234, v235
    v_cvt_pk_bf16_f32 v153, v236, v237
    v_mfma_f32_16x16x32_bf16 v[186:189], a[84:87], v[230:233], v[186:189]
    s_waitcnt lgkmcnt(0)
    v_mul_f32 v134, v178, v134
    v_mul_f32 v135, v178, v135
    v_mfma_f32_16x16x32_bf16 v[186:189], a[88:91], v[190:193], v[186:189]
    s_barrier
    v_cvt_pk_f16_f32 v154, v134, v135
    v_mul_f32 v136, v178, v136
    v_mfma_f32_16x16x32_bf16 v[186:189], a[92:95], v[210:213], v[186:189]
    v_mul_f32 v137, v178, v137
    v_cvt_pk_f16_f32 v155, v136, v137
    v_mfma_f32_16x16x32_bf16 v[134:137], a[96:99], v[214:217], 0
    v_mul_f32 v170, v178, v170
    v_mul_f32 v171, v178, v171
    v_mfma_f32_16x16x32_bf16 v[134:137], a[100:103], v[226:229], v[134:137]
    v_cvt_pk_f16_f32 v156, v170, v171
    v_mul_f32 v172, v178, v172
    v_mfma_f32_16x16x32_bf16 v[134:137], a[104:107], v[198:201], v[134:137]
    buffer_load_dwordx4 v10, s[8:11], 0 offen nt lds
    v_mul_f32 v173, v178, v173
    v_mfma_f32_16x16x32_bf16 v[134:137], a[108:111], v[230:233], v[134:137]
    s_add_u32 m0, s28, 4096
    v_cvt_pk_f16_f32 v157, v172, v173
    v_mul_f32 v182, v178, v182
    v_mfma_f32_16x16x32_bf16 v[134:137], a[112:115], v[190:193], v[134:137]
    v_mul_f32 v183, v178, v183
    v_cvt_pk_f16_f32 v122, v182, v183
    v_mfma_f32_16x16x32_bf16 v[134:137], a[116:119], v[210:213], v[134:137]
    v_mul_f32 v184, v178, v184
    v_mul_f32 v185, v178, v185
    v_mfma_f32_16x16x32_bf16 v[218:221], a[120:123], v[214:217], 0
    v_cvt_pk_f16_f32 v123, v184, v185
    v_cvt_pk_bf16_f32 v170, v206, v207
    v_mfma_f32_16x16x32_bf16 v[218:221], a[124:127], v[226:229], v[218:221]
    buffer_load_dwordx4 v11, s[8:11], 0 offen nt lds
    v_mul_f32 v208, v254, v208
    v_mfma_f32_16x16x32_bf16 v[218:221], a[128:131], v[198:201], v[218:221]
    s_add_u32 m0, s28, 8192
    v_mul_f32 v209, v254, v209
    v_cvt_pk_bf16_f32 v171, v208, v209
    v_mfma_f32_16x16x32_bf16 v[218:221], a[132:135], v[230:233], v[218:221]
    v_fma_f32 v162, v186, v186, s32
    v_fmac_f32 v162, v187, v187
    v_mfma_f32_16x16x32_bf16 v[218:221], a[136:139], v[190:193], v[218:221]
    v_fmac_f32 v162, v188, v188
    v_fmac_f32 v162, v189, v189
    v_mfma_f32_16x16x32_bf16 v[218:221], a[140:143], v[210:213], v[218:221]
    v_fmac_f32 v162, v134, v134
    v_fmac_f32 v162, v135, v135
    v_mfma_f32_16x16x32_bf16 v[222:225], a[0:3], v[214:217], 0
    buffer_load_dwordx4 v12, s[8:11], 0 offen nt lds
    v_fmac_f32 v162, v136, v136
    v_mfma_f32_16x16x32_bf16 v[222:225], a[4:7], v[226:229], v[222:225]
    s_add_u32 m0, s28, 12288
    v_fmac_f32 v162, v137, v137
    v_fmac_f32 v162, v218, v218
    v_mfma_f32_16x16x32_bf16 v[222:225], a[8:11], v[198:201], v[222:225]
    s_xor_b32 s28, s28, 65536
    v_fmac_f32 v162, v219, v219
    v_fmac_f32 v162, v220, v220
    v_mfma_f32_16x16x32_bf16 v[222:225], a[12:15], v[230:233], v[222:225]
    v_fmac_f32 v162, v221, v221
    v_mul_f32 v130, v255, v130
    v_mfma_f32_16x16x32_bf16 v[222:225], a[16:19], v[190:193], v[222:225]
    v_mul_f32 v131, v255, v131
    v_cvt_pk_bf16_f32 v130, v130, v131
    v_mfma_f32_16x16x32_bf16 v[222:225], a[20:23], v[210:213], v[222:225]
    buffer_load_dwordx4 v13, s[8:11], 0 offen nt lds
    v_mul_f32 v132, v255, v132
    v_mfma_f32_16x16x32_bf16 v[238:241], a[24:27], v[214:217], 0
    s_mov_b32 m0, s29
    v_mul_f32 v133, v255, v133
    v_cvt_pk_bf16_f32 v131, v132, v133
    v_mfma_f32_16x16x32_bf16 v[238:241], a[28:31], v[226:229], v[238:241]
    s_xor_b32 s29, s29, s30
    v_fma_f32 v163, v222, v222, s32
    v_fmac_f32 v163, v223, v223
    v_mfma_f32_16x16x32_bf16 v[238:241], a[32:35], v[198:201], v[238:241]
    s_add_u32 s19, s19, s20
    v_fmac_f32 v163, v224, v224
    v_fmac_f32 v163, v225, v225
    v_mfma_f32_16x16x32_bf16 v[238:241], a[36:39], v[230:233], v[238:241]
    s_add_u32 s23, s23, s21
    v_mul_f32 v126, v255, v126
    v_mul_f32 v127, v255, v127
    v_mfma_f32_16x16x32_bf16 v[238:241], a[40:43], v[190:193], v[238:241]
    buffer_load_dwordx4 v14, s[8:11], 0 offen nt lds
    v_cvt_pk_bf16_f32 v132, v126, v127
    v_mfma_f32_16x16x32_bf16 v[238:241], a[44:47], v[210:213], v[238:241]
    s_cmp_ge_u32 s19, 72
    v_mul_f32 v128, v255, v128
    v_mul_f32 v129, v255, v129
    v_mfma_f32_16x16x32_bf16 v[178:181], a[48:51], v[214:217], 0
    s_cselect_b32 s34, 72, 0
    v_cvt_pk_bf16_f32 v133, v128, v129
    v_mul_f32 v114, v255, v114
    v_mfma_f32_16x16x32_bf16 v[178:181], a[52:55], v[226:229], v[178:181]
    s_cselect_b32 s35, s22, 0
    v_fmac_f32 v163, v238, v238
    v_fmac_f32 v163, v239, v239
    v_mfma_f32_16x16x32_bf16 v[178:181], a[56:59], v[198:201], v[178:181]
    s_sub_u32 s19, s19, s34
    v_fmac_f32 v163, v240, v240
    v_fmac_f32 v163, v241, v241
    v_mfma_f32_16x16x32_bf16 v[178:181], a[60:63], v[230:233], v[178:181]
    buffer_store_dwordx4 v[158:161], v15, s[12:15], 0 offen nt
    v_mul_f32 v115, v255, v115
    v_cvt_pk_bf16_f32 v254, v114, v115
    v_mul_f32 v116, v255, v116
    v_mul_f32 v117, v255, v117
    v_mfma_f32_16x16x32_bf16 v[178:181], a[64:67], v[190:193], v[178:181]
    s_add_u32 s23, s23, s35
    v_cvt_pk_bf16_f32 v255, v116, v117
    v_xor_b32 v0, 65536, v0
    v_mfma_f32_16x16x32_bf16 v[178:181], a[68:71], v[210:213], v[178:181]
    s_add_u32 s78, s78, s69
    v_xor_b32 v1, 65536, v1
    s_add_u32 s80, s77, s68
    v_mfma_f32_16x16x32_bf16 v[114:117], v[214:217], a[144:147], 0
    s_cmp_ge_u32 s80, 72
    s_cselect_b32 s80, s22, 0
    s_add_u32 s78, s78, s80
    v_mfma_f32_16x16x32_bf16 v[114:117], v[226:229], a[148:151], v[114:117]
    s_add_u32 s80, s77, 20
    v_fmac_f32 v163, v178, v178
    v_fmac_f32 v163, v179, v179
    v_mfma_f32_16x16x32_bf16 v[114:117], v[198:201], a[152:155], v[114:117]
    s_add_u32 s34, s18, 3
    v_fmac_f32 v163, v180, v180
    v_fmac_f32 v163, v181, v181
    v_mfma_f32_16x16x32_bf16 v[114:117], v[230:233], a[156:159], v[114:117]
    s_cmp_lt_u32 s77, s62
    ds_read2_b32 v[164:165], v6 offset0:0 offset1:0
    ds_read2_b32 v[168:169], v6 offset0:16 offset1:16
    v_mfma_f32_16x16x32_bf16 v[114:117], v[190:193], a[160:163], v[114:117]
    s_cselect_b32 s79, 1, 0
    ds_read2_b32 v[172:173], v6 offset0:32 offset1:32
    v_cvt_pk_bf16_f32 v36, v163, v162
    v_mfma_f32_16x16x32_bf16 v[114:117], v[210:213], a[164:167], v[114:117]
    s_cselect_b32 s78, s78, 0
    s_cmp_lt_u32 s34, s17
    s_cselect_b32 s23, s23, s78
    v_mfma_f32_16x16x32_bf16 v[234:237], v[32:35], v[36:39], 0
    s_cselect_b32 s73, s34, s80
    s_cselect_b32 s79, 0, s79
    s_cselect_b32 s81, 0, 1
    v_mfma_f32_16x16x32_bf16 v[126:129], v[214:217], a[168:171], 0
    s_sub_u32 s80, s100, s81
    v_cvt_pk_bf16_f32 v162, v114, v115
    v_cvt_pk_bf16_f32 v163, v116, v117
    v_mfma_f32_16x16x32_bf16 v[126:129], v[226:229], a[172:175], v[126:129]
    s_and_b32 s100, s100, s80
    v_rsq_f32 v235, v235
    v_mfma_f32_16x16x32_bf16 v[126:129], v[198:201], a[176:179], v[126:129]
    s_lshl_b32 s80, s79, s73
    v_rsq_f32 v234, v234
    v_mfma_f32_16x16x32_bf16 v[126:129], v[230:233], a[180:183], v[126:129]
    s_or_b32 s70, s70, s80
    v_mul_f32 v234, s31, v234
    v_mul_f32 v186, v235, v186
    v_mfma_f32_16x16x32_bf16 v[126:129], v[190:193], a[184:187], v[126:129]
    s_add_u32 s45, s45, s79
    v_mul_f32 v187, v235, v187
    v_cvt_pk_f16_f32 v114, v186, v187
    v_mfma_f32_16x16x32_bf16 v[126:129], v[210:213], a[188:191], v[126:129]
    s_add_u32 s18, s18, 1
    v_mul_f32 v188, v235, v188
    v_mul_f32 v189, v235, v189
    v_mfma_f32_16x16x32_bf16 v[158:161], v[214:217], a[192:195], 0
    s_cmp_lt_u32 s18, s45
    v_cvt_pk_f16_f32 v115, v188, v189
    v_mul_f32 v134, v235, v134
    v_mfma_f32_16x16x32_bf16 v[158:161], v[226:229], a[196:199], v[158:161]
    s_waitcnt lgkmcnt(0)
    buffer_store_dwordx2 v[170:171], v18, s[12:15], 0 offen nt
    v_cvt_pk_bf16_f32 v166, v126, v127
    v_cvt_pk_bf16_f32 v167, v128, v129
    v_mfma_f32_16x16x32_bf16 v[158:161], v[198:201], a[200:203], v[158:161]
    ds_read_b128 v[226:229], v5 offset:0
    ds_read_b128 v[206:209], v5 offset:16
    v_mfma_f32_16x16x32_bf16 v[158:161], v[230:233], a[204:207], v[158:161]
    ds_read_b128 v[198:201], v5 offset:48
    ds_read_b32 v236, v6 offset:192
    v_mfma_f32_16x16x32_bf16 v[158:161], v[190:193], a[208:211], v[158:161]
    v_mul_f32 v135, v235, v135
    v_cvt_pk_f16_f32 v116, v134, v135
    v_mfma_f32_16x16x32_f16 v[186:189], v[174:177], v[202:205], v[46:49]
    v_mul_f32 v136, v235, v136
    v_mul_f32 v137, v235, v137
    v_mfma_f32_16x16x32_f16 v[182:185], v[138:141], v[202:205], v[50:53]
    v_cvt_pk_f16_f32 v117, v136, v137
    v_mul_f32 v218, v235, v218
    v_mfma_f32_16x16x32_bf16 v[158:161], v[210:213], a[212:215], v[158:161]
    ds_read_b128 v[194:197], v2 offset:0
    ds_read_b128 v[190:193], v2 offset:1024
    v_mfma_f32_16x16x32_f16 v[126:129], v[114:117], v[202:205], v[54:57]
    v_mul_f32 v219, v235, v219
    v_cvt_pk_f16_f32 v136, v218, v219
    v_mul_f32 v220, v235, v220
    v_mfma_f32_16x16x16_f16 v[186:189], v[120:121], v[118:119], v[186:189]
    v_mul_f32 v221, v235, v221
    v_cvt_pk_bf16_f32 v170, v158, v159
    v_cvt_pk_bf16_f32 v171, v160, v161
    v_mfma_f32_16x16x16_f16 v[182:185], v[124:125], v[118:119], v[182:185]
    v_cvt_pk_f16_f32 v137, v220, v221
    v_mul_f32 v222, v234, v222
    v_mul_f32 v223, v234, v223
    v_mfma_f32_16x16x16_f16 v[126:129], v[136:137], v[118:119], v[126:129]
    v_cvt_pk_f16_f32 v158, v222, v223
    v_mul_f32 v224, v234, v224
    v_mul_f32 v225, v234, v225
    s_waitcnt lgkmcnt(2)
    v_mfma_f32_16x16x32_f16 v[230:233], v[226:229], v[202:205], v[22:25]
    ds_read_b128 v[210:213], v2 offset:2048
    ds_read_b128 v[202:205], v2 offset:3072
    v_mfma_f32_16x16x32_f16 v[230:233], v[206:209], v[174:177], v[230:233]
    v_cvt_pk_f16_f32 v159, v224, v225
    v_mul_f32 v238, v234, v238
    v_mfma_f32_16x16x32_f16 v[230:233], v[198:201], v[118:121], v[230:233]
    s_waitcnt lgkmcnt(2)
    ds_read_b128 v[214:217], v2 offset:4096
    v_mul_f32 v239, v234, v239
    v_cvt_pk_f16_f32 v160, v238, v239
    v_mul_f32 v240, v234, v240
    v_mul_f32 v241, v234, v241
    v_cvt_pk_f16_f32 v161, v240, v241
    v_mfma_f32_16x16x32_f16 v[218:221], v[226:229], v[154:157], v[24:27]
    v_mul_f32 v178, v234, v178
    v_mul_f32 v179, v234, v179
    v_mfma_f32_16x16x32_f16 v[218:221], v[206:209], v[138:141], v[218:221]
    v_cvt_pk_f16_f32 v134, v178, v179
    v_mul_f32 v180, v234, v180
    v_mfma_f32_16x16x32_f16 v[218:221], v[198:201], v[122:125], v[218:221]
    buffer_store_dwordx4 v[130:133], v16, s[12:15], 0 offen nt
    ds_read_b128 v[222:225], v2 offset:5120
    v_mul_f32 v181, v234, v181
    v_cvt_pk_f16_f32 v135, v180, v181
    v_mov_b32_dpp v236, v231 quad_perm:[0,1,2,3] row_mask:0x1 bank_mask:0xf
    v_mfma_f32_16x16x32_f16 v[238:241], v[226:229], v[158:161], v[26:29]
    s_waitcnt lgkmcnt(2)
    v_max3_f32 v118, v230, v186, v187
    v_mov_b32_dpp v236, v219 quad_perm:[0,1,2,3] row_mask:0x2 bank_mask:0xf
    v_mfma_f32_16x16x32_f16 v[238:241], v[206:209], v[114:117], v[238:241]
    v_max3_f32 v118, v118, v188, v189
    v_max3_f32 v118, v118, v182, v183
    v_mfma_f32_16x16x32_f16 v[238:241], v[198:201], v[134:137], v[238:241]
    s_waitcnt lgkmcnt(1)
    v_max3_f32 v118, v118, v184, v185
    v_max3_f32 v118, v118, v126, v127
    v_mfma_f32_16x16x32_bf16 v[178:181], a[216:219], v[194:197], 0
    v_max3_f32 v118, v118, v128, v129
    v_mov_b32 v119, v118
    v_mfma_f32_16x16x32_bf16 v[178:181], a[220:223], v[190:193], v[178:181]
    v_add_u32 v5, s74, v5
    v_mov_b32_dpp v236, v239 quad_perm:[0,1,2,3] row_mask:0x4 bank_mask:0xf
    v_mfma_f32_16x16x32_bf16 v[178:181], a[224:227], v[210:213], v[178:181]
    v_permlane32_swap_b32 v118, v119
    v_mfma_f32_16x16x32_bf16 v[178:181], a[228:231], v[202:205], v[178:181]
    s_waitcnt lgkmcnt(0)
    v_max_f32 v118, v118, v119
    v_mov_b32 v119, v118
    v_mfma_f32_16x16x32_bf16 v[178:181], a[232:235], v[214:217], v[178:181]
    v_mov_b32 v219, v236
    v_add_u32 v6, s75, v6
    v_mfma_f32_16x16x32_bf16 v[178:181], a[236:239], v[222:225], v[178:181]
    v_permlane16_swap_b32 v118, v119
    v_mfma_f32_16x16x32_bf16 v[198:201], a[240:243], v[194:197], 0
    v_max_f32 v118, v118, v119
    v_sub_f32 v186, v186, v118
    v_mfma_f32_16x16x32_bf16 v[198:201], a[244:247], v[190:193], v[198:201]
    v_exp_f32 v186, v186
    v_mfma_f32_16x16x32_bf16 v[198:201], a[248:251], v[210:213], v[198:201]
    v_sub_f32 v187, v187, v118
    v_sub_f32 v188, v188, v118
    v_mfma_f32_16x16x32_bf16 v[198:201], a[252:255], v[202:205], v[198:201]
    v_exp_f32 v187, v187
    v_mfma_f32_16x16x32_bf16 v[198:201], v[82:85], v[214:217], v[198:201]
    v_cvt_pk_bf16_f32 v186, v186, v187
    v_sub_f32 v189, v189, v118
    v_mfma_f32_16x16x32_bf16 v[198:201], v[86:89], v[222:225], v[198:201]
    v_exp_f32 v188, v188
    v_mfma_f32_16x16x32_bf16 v[206:209], v[90:93], v[194:197], 0
    ds_read_b128 v[194:197], v2 offset:6144
    buffer_store_dwordx2 v[254:255], v19, s[12:15], 0 offen nt
    v_exp_f32 v189, v189
    v_mfma_f32_16x16x32_bf16 v[206:209], v[94:97], v[190:193], v[206:209]
    ds_read_b128 v[190:193], v2 offset:7168
    v_cvt_pk_bf16_f32 v187, v188, v189
    v_mfma_f32_16x16x32_bf16 v[206:209], v[98:101], v[210:213], v[206:209]
    ds_read_b128 v[210:213], v2 offset:8192
    v_sub_f32 v182, v182, v118
    v_mfma_f32_16x16x32_bf16 v[206:209], v[102:105], v[202:205], v[206:209]
    ds_read_b128 v[202:205], v2 offset:9216
    v_sub_f32 v183, v183, v118
    v_mfma_f32_16x16x32_bf16 v[206:209], v[106:109], v[214:217], v[206:209]
    ds_read_b128 v[214:217], v2 offset:10240
    v_sub_f32 v184, v184, v118
    v_mfma_f32_16x16x32_bf16 v[206:209], v[110:113], v[222:225], v[206:209]
    ds_read_b128 v[222:225], v2 offset:11264
    v_exp_f32 v182, v182
    v_mfma_f32_16x16x32_f16 v[226:229], v[174:177], v[154:157], v[58:61]
    v_exp_f32 v183, v183
    s_waitcnt lgkmcnt(5)
    v_mfma_f32_16x16x32_bf16 v[130:133], a[216:219], v[194:197], 0
    v_cvt_pk_bf16_f32 v188, v182, v183
    v_exp_f32 v184, v184
    s_waitcnt lgkmcnt(4)
    v_mfma_f32_16x16x16_f16 v[226:229], v[120:121], v[122:123], v[226:229]
    v_sub_f32 v185, v185, v118
    v_exp_f32 v185, v185
    v_sub_f32 v126, v126, v118
    v_mfma_f32_16x16x32_bf16 v[130:133], a[220:223], v[190:193], v[130:133]
    s_waitcnt lgkmcnt(2)
    v_cvt_pk_bf16_f32 v189, v184, v185
    v_sub_f32 v127, v127, v118
    v_mfma_f32_16x16x32_bf16 v[130:133], a[224:227], v[210:213], v[130:133]
    s_waitcnt lgkmcnt(1)
    v_exp_f32 v126, v126
    v_mfma_f32_16x16x32_bf16 v[130:133], a[228:231], v[202:205], v[130:133]
    s_waitcnt lgkmcnt(0)
    v_exp_f32 v127, v127
    v_mfma_f32_16x16x32_bf16 v[130:133], a[232:235], v[214:217], v[130:133]
    v_cvt_pk_bf16_f32 v36, v126, v127
    v_sub_f32 v128, v128, v118
    v_mfma_f32_16x16x32_f16 v[182:185], v[138:141], v[154:157], v[62:65]
    v_exp_f32 v128, v128
    v_mfma_f32_16x16x32_bf16 v[130:133], a[236:239], v[222:225], v[130:133]
    v_sub_f32 v129, v129, v118
    v_exp_f32 v129, v129
    v_sub_f32 v230, v230, v118
    v_cvt_pk_bf16_f32 v37, v128, v129
    v_mfma_f32_16x16x16_f16 v[182:185], v[124:125], v[122:123], v[182:185]
    v_exp_f32 v230, v230
    v_max_f32_dpp v219, v219, v219 quad_perm:[1,0,3,2] row_mask:0xf bank_mask:0xf
    v_cvt_pk_bf16_f32 v39, v230, 0
    v_mfma_f32_16x16x32_f16 v[230:233], v[114:117], v[154:157], v[66:69]
    v_max_f32_dpp v219, v219, v219 quad_perm:[2,3,0,1] row_mask:0xf bank_mask:0xf
    v_max3_f32 v254, v218, v226, v227
    v_max3_f32 v254, v254, v228, v229
    v_max_f32_dpp v219, v219, v219 row_half_mirror row_mask:0xf bank_mask:0xf
    v_max3_f32 v254, v254, v182, v183
    v_max3_f32 v254, v254, v184, v185
    v_mfma_f32_16x16x16_f16 v[230:233], v[136:137], v[122:123], v[230:233]
    v_max_f32_dpp v219, v219, v219 row_mirror row_mask:0xf bank_mask:0xf
    v_mov_b32 v255, v219
    v_fma_f32 v118, v178, v178, s33
    v_fmac_f32 v118, v179, v179
    v_permlane32_swap_b32 v219, v255
    v_max_f32 v219, v219, v255
    v_mfma_f32_16x16x32_bf16 v[154:157], v[28:31], v[36:39], 0
    v_mov_b32 v255, v219
    v_max3_f32 v254, v254, v230, v231
    v_mfma_f32_16x16x32_bf16 v[154:157], v[28:31], v[186:189], v[154:157]
    v_permlane16_swap_b32 v219, v255
    v_max_f32 v219, v219, v255
    v_sub_f32 v236, v236, v219
    v_mfma_f32_16x16x32_bf16 v[126:129], v[162:165], v[36:39], 0
    v_exp_f32 v236, v236
    v_mfma_f32_16x16x32_bf16 v[126:129], v[142:145], v[186:189], v[126:129]
    v_cvt_pk_bf16_f32 v236, v236, v236
    v_max3_f32 v254, v254, v232, v233
    v_rcp_f32 v154, v154
    v_mov_b32 v119, v254
    v_fmac_f32 v118, v180, v180
    v_fmac_f32 v118, v181, v181
    v_permlane32_swap_b32 v254, v119
    v_max_f32 v254, v254, v119
    v_mul_f32 v126, v154, v126
    v_mul_f32 v127, v154, v127
    v_cvt_pk_bf16_f32 v126, v126, v127
    v_mul_f32 v128, v154, v128
    v_mul_f32 v129, v154, v129
    v_cvt_pk_bf16_f32 v127, v128, v129
    v_mov_b32 v119, v254
    v_fmac_f32 v118, v198, v198
    v_fmac_f32 v118, v199, v199
    v_permlane16_swap_b32 v254, v119
    v_max_f32 v254, v254, v119
    v_sub_f32 v226, v226, v254
    v_exp_f32 v226, v226
    v_sub_f32 v227, v227, v254
    v_exp_f32 v227, v227
    v_sub_f32 v228, v228, v254
    v_cvt_pk_bf16_f32 v226, v226, v227
    v_exp_f32 v228, v228
    v_sub_f32 v229, v229, v254
    v_exp_f32 v229, v229
    v_sub_f32 v182, v182, v254
    v_cvt_pk_bf16_f32 v227, v228, v229
    v_mfma_f32_16x16x32_bf16 v[242:245], v[166:169], v[36:39], 0
    ds_write_b16 v8, v236
    v_mfma_f32_16x16x32_bf16 v[242:245], v[146:149], v[186:189], v[242:245]
    v_exp_f32 v182, v182
    v_sub_f32 v183, v183, v254
    v_exp_f32 v183, v183
    v_sub_f32 v184, v184, v254
    v_cvt_pk_bf16_f32 v228, v182, v183
    v_exp_f32 v184, v184
    v_sub_f32 v185, v185, v254
    v_exp_f32 v185, v185
    v_mul_f32 v242, v154, v242
    v_mul_f32 v243, v154, v243
    v_cvt_pk_bf16_f32 v128, v242, v243
    v_mul_f32 v244, v154, v244
    v_mul_f32 v245, v154, v245
    v_cvt_pk_bf16_f32 v129, v244, v245
    v_mfma_f32_16x16x32_bf16 v[234:237], v[170:173], v[36:39], 0
    ds_write_b128 v3, v[126:129] offset:0
    v_mfma_f32_16x16x32_bf16 v[234:237], v[150:153], v[186:189], v[234:237]
    v_cvt_pk_bf16_f32 v229, v184, v185
    v_sub_f32 v230, v230, v254
    v_mfma_f32_16x16x32_f16 v[182:185], v[174:177], v[158:161], v[70:73]
    v_exp_f32 v230, v230
    v_mfma_f32_16x16x32_bf16 v[126:129], a[240:243], v[194:197], 0
    ds_read_b128 v[174:177], v9
    v_sub_f32 v231, v231, v254
    v_mfma_f32_16x16x32_bf16 v[126:129], a[244:247], v[190:193], v[126:129]
    v_mul_f32 v234, v154, v234
    v_mul_f32 v235, v154, v235
    v_cvt_pk_bf16_f32 v122, v234, v235
    v_mfma_f32_16x16x16_f16 v[182:185], v[120:121], v[134:135], v[182:185]
    v_mul_f32 v236, v154, v236
    v_mul_f32 v237, v154, v237
    v_cvt_pk_bf16_f32 v123, v236, v237
    v_sub_f32 v232, v232, v254
    v_mfma_f32_16x16x32_bf16 v[126:129], a[248:251], v[210:213], v[126:129]
    ds_read_b128 v[154:157], v9 offset:64
    v_sub_f32 v233, v233, v254
    v_mfma_f32_16x16x32_bf16 v[126:129], a[252:255], v[202:205], v[126:129]
    ds_write_b64 v4, v[122:123] offset:4096
    v_mfma_f32_16x16x32_bf16 v[126:129], v[82:85], v[214:217], v[126:129]
    v_max3_f32 v255, v238, v182, v183
    v_max3_f32 v255, v255, v184, v185
    v_mfma_f32_16x16x32_bf16 v[126:129], v[86:89], v[222:225], v[126:129]
    v_exp_f32 v231, v231
    v_exp_f32 v232, v232
    v_cvt_pk_bf16_f32 v36, v230, v231
    v_mfma_f32_16x16x32_f16 v[186:189], v[138:141], v[158:161], v[74:77]
    s_waitcnt lgkmcnt(2)
    v_exp_f32 v233, v233
    v_mfma_f32_16x16x32_f16 v[138:141], v[114:117], v[158:161], v[78:81]
    v_cvt_pk_bf16_f32 v37, v232, v233
    v_sub_f32 v218, v218, v254
    v_mfma_f32_16x16x32_bf16 v[234:237], v[174:177], v[28:31], 0
    v_exp_f32 v218, v218
    v_fmac_f32 v118, v200, v200
    v_mfma_f32_16x16x16_f16 v[186:189], v[124:125], v[134:135], v[186:189]
    v_cvt_pk_bf16_f32 v39, v218, 0
    v_fmac_f32 v118, v201, v201
    v_fmac_f32 v118, v206, v206
    v_mfma_f32_16x16x16_f16 v[138:141], v[136:137], v[134:135], v[138:141]
    v_fmac_f32 v118, v207, v207
    v_fmac_f32 v118, v208, v208
    v_fmac_f32 v118, v209, v209
    v_fma_f32 v254, v130, v130, s33
    v_mfma_f32_16x16x32_bf16 v[122:125], v[28:31], v[36:39], 0
    s_waitcnt lgkmcnt(0)
    v_max3_f32 v255, v255, v186, v187
    v_max3_f32 v255, v255, v188, v189
    v_mfma_f32_16x16x32_bf16 v[122:125], v[28:31], v[226:229], v[122:125]
    v_max3_f32 v255, v255, v138, v139
    v_max3_f32 v255, v255, v140, v141
    v_mfma_f32_16x16x32_bf16 v[114:117], v[162:165], v[36:39], 0
    v_mov_b32 v119, v255
    v_fmac_f32 v254, v131, v131
    v_mfma_f32_16x16x32_bf16 v[114:117], v[142:145], v[226:229], v[114:117]
    v_permlane32_swap_b32 v255, v119
    v_mfma_f32_16x16x32_bf16 v[134:137], v[166:169], v[36:39], 0
    v_rcp_f32 v122, v122
    v_mfma_f32_16x16x32_bf16 v[134:137], v[146:149], v[226:229], v[134:137]
    v_max_f32 v255, v255, v119
    v_mov_b32 v119, v255
    v_mfma_f32_16x16x32_bf16 v[158:161], v[170:173], v[36:39], 0
    v_fmac_f32 v254, v132, v132
    v_mul_f32 v114, v122, v114
    v_mfma_f32_16x16x32_bf16 v[158:161], v[150:153], v[226:229], v[158:161]
    v_mul_f32 v115, v122, v115
    v_cvt_pk_bf16_f32 v114, v114, v115
    v_mfma_f32_16x16x32_bf16 v[234:237], v[154:157], v[28:31], v[234:237]
    v_mul_f32 v116, v122, v116
    v_mul_f32 v117, v122, v117
    v_mfma_f32_16x16x32_bf16 v[218:221], v[174:177], v[142:145], 0
    v_cvt_pk_bf16_f32 v115, v116, v117
    v_mul_f32 v134, v122, v134
    v_mfma_f32_16x16x32_bf16 v[218:221], v[154:157], v[162:165], v[218:221]
    v_mul_f32 v135, v122, v135
    v_cvt_pk_bf16_f32 v116, v134, v135
    v_mfma_f32_16x16x32_bf16 v[226:229], v[174:177], v[146:149], 0
    v_mul_f32 v136, v122, v136
    v_mul_f32 v137, v122, v137
    v_mfma_f32_16x16x32_bf16 v[226:229], v[154:157], v[166:169], v[226:229]
    v_cvt_pk_bf16_f32 v117, v136, v137
    v_mul_f32 v158, v122, v158
    v_mfma_f32_16x16x32_bf16 v[134:137], v[174:177], v[150:153], 0
    ds_write_b128 v3, v[114:117] offset:6144
    v_mfma_f32_16x16x32_bf16 v[134:137], v[154:157], v[170:173], v[134:137]
    v_mul_f32 v159, v122, v159
    v_cvt_pk_bf16_f32 v120, v158, v159
    v_mfma_f32_16x16x32_bf16 v[114:117], v[90:93], v[194:197], 0
    v_mul_f32 v160, v122, v160
    v_mul_f32 v161, v122, v161
    v_mfma_f32_16x16x32_bf16 v[114:117], v[94:97], v[190:193], v[114:117]
    ds_read_b128 v[122:125], v2 offset:12288
    ds_read_b128 v[174:177], v2 offset:13312
    v_mfma_f32_16x16x32_bf16 v[114:117], v[98:101], v[210:213], v[114:117]
    ds_read_b128 v[190:193], v2 offset:14336
    v_cvt_pk_bf16_f32 v121, v160, v161
    v_mfma_f32_16x16x32_bf16 v[114:117], v[102:105], v[202:205], v[114:117]
    ds_read_b128 v[194:197], v2 offset:15360
    v_fmac_f32 v254, v133, v133
    v_mfma_f32_16x16x32_bf16 v[114:117], v[106:109], v[214:217], v[114:117]
    ds_read_b128 v[202:205], v2 offset:16384
    v_fmac_f32 v254, v126, v126
    v_mfma_f32_16x16x32_bf16 v[114:117], v[110:113], v[222:225], v[114:117]
    ds_read_b128 v[210:213], v2 offset:17408
    ds_write_b64 v4, v[120:121] offset:10240
    v_permlane16_swap_b32 v255, v119
    v_max_f32 v255, v255, v119
    v_sub_f32 v182, v182, v255
    v_exp_f32 v182, v182
    v_sub_f32 v183, v183, v255
    v_exp_f32 v183, v183
    s_waitcnt lgkmcnt(5)
    v_mfma_f32_16x16x32_bf16 v[242:245], a[216:219], v[122:125], 0
    v_cvt_pk_bf16_f32 v182, v182, v183
    v_sub_f32 v184, v184, v255
    v_mfma_f32_16x16x32_bf16 v[242:245], a[220:223], v[174:177], v[242:245]
    s_waitcnt lgkmcnt(4)
    v_exp_f32 v184, v184
    v_mfma_f32_16x16x32_bf16 v[242:245], a[224:227], v[190:193], v[242:245]
    s_waitcnt lgkmcnt(3)
    v_sub_f32 v185, v185, v255
    v_sub_f32 v186, v186, v255
    v_mfma_f32_16x16x32_bf16 v[242:245], a[228:231], v[194:197], v[242:245]
    s_waitcnt lgkmcnt(2)
    v_exp_f32 v185, v185
    v_mfma_f32_16x16x32_bf16 v[242:245], a[232:235], v[202:205], v[242:245]
    s_waitcnt lgkmcnt(0)
    v_cvt_pk_bf16_f32 v183, v184, v185
    v_sub_f32 v187, v187, v255
    v_mfma_f32_16x16x32_bf16 v[242:245], a[236:239], v[210:213], v[242:245]
    v_exp_f32 v186, v186
    v_mfma_f32_16x16x32_bf16 v[158:161], a[240:243], v[122:125], 0
    v_exp_f32 v187, v187
    v_mfma_f32_16x16x32_bf16 v[158:161], a[244:247], v[174:177], v[158:161]
    v_cvt_pk_bf16_f32 v184, v186, v187
    v_sub_f32 v188, v188, v255
    v_mfma_f32_16x16x32_bf16 v[158:161], a[248:251], v[190:193], v[158:161]
    v_exp_f32 v188, v188
    v_mfma_f32_16x16x32_bf16 v[158:161], a[252:255], v[194:197], v[158:161]
    v_sub_f32 v189, v189, v255
    v_sub_f32 v138, v138, v255
    v_mfma_f32_16x16x32_bf16 v[158:161], v[82:85], v[202:205], v[158:161]
    v_exp_f32 v189, v189
    v_mfma_f32_16x16x32_bf16 v[158:161], v[86:89], v[210:213], v[158:161]
    v_cvt_pk_bf16_f32 v185, v188, v189
    v_sub_f32 v139, v139, v255
    v_mfma_f32_16x16x32_bf16 v[154:157], v[90:93], v[122:125], 0
    v_exp_f32 v138, v138
    v_mfma_f32_16x16x32_bf16 v[154:157], v[94:97], v[174:177], v[154:157]
    v_exp_f32 v139, v139
    v_mfma_f32_16x16x32_bf16 v[154:157], v[98:101], v[190:193], v[154:157]
    v_cvt_pk_bf16_f32 v36, v138, v139
    v_sub_f32 v140, v140, v255
    v_mfma_f32_16x16x32_bf16 v[154:157], v[102:105], v[194:197], v[154:157]
    v_exp_f32 v140, v140
    v_mfma_f32_16x16x32_bf16 v[154:157], v[106:109], v[202:205], v[154:157]
    v_sub_f32 v141, v141, v255
    v_sub_f32 v238, v238, v255
    v_mfma_f32_16x16x32_bf16 v[154:157], v[110:113], v[210:213], v[154:157]
    ds_read_b128 v[186:189], v0 offset:20480
    ds_read_b128 v[194:197], v1 offset:20480
    ds_read_b128 v[122:125], v0 offset:20608
    v_exp_f32 v141, v141
    v_exp_f32 v238, v238
    v_cvt_pk_bf16_f32 v37, v140, v141
    v_cvt_pk_bf16_f32 v39, v238, 0
    v_fma_f32 v255, v242, v242, s33
    v_fmac_f32 v255, v243, v243
    v_mfma_f32_16x16x32_bf16 v[138:141], v[28:31], v[36:39], 0
    ds_read_b128 v[202:205], v1 offset:20608
    ds_read_b128 v[230:233], v0 offset:20736
    v_mfma_f32_16x16x32_bf16 v[138:141], v[28:31], v[182:185], v[138:141]
    ds_read_b128 v[238:241], v1 offset:20736
    v_fmac_f32 v255, v244, v244
    v_mfma_f32_16x16x32_bf16 v[174:177], v[162:165], v[36:39], 0
    v_fmac_f32 v255, v245, v245
    v_fmac_f32 v255, v158, v158
    v_mfma_f32_16x16x32_bf16 v[174:177], v[142:145], v[182:185], v[174:177]
    v_fmac_f32 v255, v159, v159
    v_fmac_f32 v255, v160, v160
    v_mfma_f32_16x16x32_bf16 v[142:145], v[166:169], v[36:39], 0
    s_waitcnt lgkmcnt(5)
    v_rcp_f32 v138, v138
    v_mfma_f32_16x16x32_bf16 v[142:145], v[146:149], v[182:185], v[142:145]
    s_waitcnt lgkmcnt(3)
    v_fmac_f32 v255, v161, v161
    v_mul_f32 v174, v138, v174
    v_mfma_f32_16x16x32_bf16 v[146:149], v[170:173], v[36:39], 0
    v_mul_f32 v175, v138, v175
    v_cvt_pk_bf16_f32 v162, v174, v175
    v_mfma_f32_16x16x32_bf16 v[146:149], v[150:153], v[182:185], v[146:149]
    v_mul_f32 v176, v138, v176
    v_mul_f32 v177, v138, v177
    v_mfma_f32_16x16x32_bf16 v[150:153], a[72:75], v[186:189], 0
    s_waitcnt lgkmcnt(1)
    v_cvt_pk_bf16_f32 v163, v176, v177
    v_mul_f32 v142, v138, v142
    v_mfma_f32_16x16x32_bf16 v[150:153], a[76:79], v[194:197], v[150:153]
    s_waitcnt lgkmcnt(0)
    v_mul_f32 v143, v138, v143
    v_cvt_pk_bf16_f32 v164, v142, v143
    v_mfma_f32_16x16x32_bf16 v[150:153], a[80:83], v[122:125], v[150:153]
    v_mul_f32 v144, v138, v144
    v_mul_f32 v145, v138, v145
    v_mfma_f32_16x16x32_bf16 v[150:153], a[84:87], v[202:205], v[150:153]
    v_cvt_pk_bf16_f32 v165, v144, v145
    v_mul_f32 v146, v138, v146
    v_mfma_f32_16x16x32_bf16 v[150:153], a[88:91], v[230:233], v[150:153]
    ds_write_b128 v3, v[162:165] offset:12288
    v_mfma_f32_16x16x32_bf16 v[150:153], a[92:95], v[238:241], v[150:153]
    v_mul_f32 v147, v138, v147
    v_cvt_pk_bf16_f32 v146, v146, v147
    v_mfma_f32_16x16x32_bf16 v[162:165], a[96:99], v[186:189], 0
    v_mul_f32 v148, v138, v148
    v_mul_f32 v149, v138, v149
    v_mfma_f32_16x16x32_bf16 v[162:165], a[100:103], v[194:197], v[162:165]
    v_cvt_pk_bf16_f32 v147, v148, v149
    v_fmac_f32 v255, v154, v154
    v_mfma_f32_16x16x32_bf16 v[162:165], a[104:107], v[122:125], v[162:165]
    ds_write_b64 v4, v[146:147] offset:16384
    v_mfma_f32_16x16x32_bf16 v[162:165], a[108:111], v[202:205], v[162:165]
    v_fmac_f32 v255, v155, v155
    v_fmac_f32 v255, v156, v156
    v_mfma_f32_16x16x32_bf16 v[162:165], a[112:115], v[230:233], v[162:165]
    v_fmac_f32 v255, v157, v157
    v_cvt_pk_bf16_f32 v255, v255, v255
    v_mfma_f32_16x16x32_bf16 v[162:165], a[116:119], v[238:241], v[162:165]
    v_rcp_f32 v234, v234
    v_mfma_f32_16x16x32_bf16 v[170:173], a[120:123], v[186:189], 0
    v_mul_f32 v218, v218, v234
    v_mul_f32_dpp v218, v226, v234 quad_perm:[0,1,2,3] row_mask:0x2 bank_mask:0xf
    v_mfma_f32_16x16x32_bf16 v[170:173], a[124:127], v[194:197], v[170:173]
    v_mul_f32_dpp v218, v134, v234 quad_perm:[0,1,2,3] row_mask:0x4 bank_mask:0xf
    v_cvt_pk_bf16_f32 v218, v218, v218
    v_mfma_f32_16x16x32_bf16 v[170:173], a[128:131], v[122:125], v[170:173]
    ds_write_b16 v7, v218
    v_mfma_f32_16x16x32_bf16 v[170:173], a[132:135], v[202:205], v[170:173]
    v_fmac_f32 v254, v127, v127
    v_fmac_f32 v254, v128, v128
    v_mfma_f32_16x16x32_bf16 v[170:173], a[136:139], v[230:233], v[170:173]
    v_fmac_f32 v254, v129, v129
    v_fmac_f32 v254, v114, v114
    v_mfma_f32_16x16x32_bf16 v[170:173], a[140:143], v[238:241], v[170:173]
    v_fmac_f32 v254, v115, v115
    v_fmac_f32 v254, v116, v116
    v_mfma_f32_16x16x32_bf16 v[138:141], a[0:3], v[186:189], 0
    v_fmac_f32 v254, v117, v117
    v_cvt_pk_bf16_f32 v254, v118, v254
    v_mfma_f32_16x16x32_bf16 v[138:141], a[4:7], v[194:197], v[138:141]
    ds_write_b64 v4, v[254:255] offset:18432
    v_mfma_f32_16x16x32_bf16 v[138:141], a[8:11], v[122:125], v[138:141]
    v_fma_f32 v174, v150, v150, s32
    v_fmac_f32 v174, v151, v151
    v_mfma_f32_16x16x32_bf16 v[138:141], a[12:15], v[202:205], v[138:141]
    v_fmac_f32 v174, v152, v152
    v_fmac_f32 v174, v153, v153
    v_mfma_f32_16x16x32_bf16 v[138:141], a[16:19], v[230:233], v[138:141]
    v_xor_b32 v2, 65536, v2
    v_xor_b32 v3, 65536, v3
    v_mfma_f32_16x16x32_bf16 v[138:141], a[20:23], v[238:241], v[138:141]
    v_xor_b32 v4, 65536, v4
    v_add_u32 v7, s76, v7
    v_mfma_f32_16x16x32_bf16 v[166:169], a[24:27], v[186:189], 0
    v_mfma_f32_16x16x32_bf16 v[166:169], a[28:31], v[194:197], v[166:169]
    v_mfma_f32_16x16x32_bf16 v[166:169], a[32:35], v[122:125], v[166:169]
    s_waitcnt lgkmcnt(0)
    v_mfma_f32_16x16x32_bf16 v[166:169], a[36:39], v[202:205], v[166:169]
    s_barrier
    v_mfma_f32_16x16x32_bf16 v[166:169], a[40:43], v[230:233], v[166:169]
    v_mfma_f32_16x16x32_bf16 v[166:169], a[44:47], v[238:241], v[166:169]
    v_mfma_f32_16x16x32_bf16 v[134:137], a[48:51], v[186:189], 0
    v_mfma_f32_16x16x32_bf16 v[134:137], a[52:55], v[194:197], v[134:137]
    s_cbranch_scc1 L_LOOP
    v_mfma_f32_16x16x32_bf16 v[134:137], a[56:59], v[122:125], v[134:137]
    s_mov_b32 s12, s40
    ds_read_b128 v[118:121], v2 offset:18432
    ds_read_b128 v[142:145], v2 offset:19456
    v_mfma_f32_16x16x32_bf16 v[134:137], a[60:63], v[202:205], v[134:137]
    s_mov_b32 s13, s41
    v_fmac_f32 v174, v162, v162
    v_fmac_f32 v174, v163, v163
    v_mfma_f32_16x16x32_bf16 v[134:137], a[64:67], v[230:233], v[134:137]
    s_mov_b32 s14, s36
    v_fmac_f32 v174, v164, v164
    v_fmac_f32 v174, v165, v165
    v_mfma_f32_16x16x32_bf16 v[134:137], a[68:71], v[238:241], v[134:137]
    s_add_u32 s48, s40, s27
    v_fmac_f32 v174, v170, v170
    v_fmac_f32 v174, v171, v171
    v_mfma_f32_16x16x32_bf16 v[146:149], v[186:189], a[144:147], 0
    s_addc_u32 s49, s41, 0
    v_fmac_f32 v174, v172, v172
    v_fmac_f32 v174, v173, v173
    v_mfma_f32_16x16x32_bf16 v[146:149], v[194:197], a[148:151], v[146:149]
    s_sub_u32 s50, s36, s27
    v_fma_f32 v254, v138, v138, s32
    v_fmac_f32 v254, v139, v139
    v_mfma_f32_16x16x32_bf16 v[146:149], v[122:125], a[152:155], v[146:149]
    s_mov_b32 s51, 0x00020000
    v_fmac_f32 v254, v140, v140
    v_fmac_f32 v254, v141, v141
    v_mfma_f32_16x16x32_bf16 v[146:149], v[202:205], a[156:159], v[146:149]
    s_waitcnt lgkmcnt(0)
    v_fmac_f32 v254, v166, v166
    v_fmac_f32 v254, v167, v167
    v_mfma_f32_16x16x32_bf16 v[182:185], v[32:35], v[118:121], 0
    s_add_u32 s52, s40, s26
    v_fmac_f32 v254, v168, v168
    v_fmac_f32 v254, v169, v169
    v_mfma_f32_16x16x32_bf16 v[182:185], v[32:35], v[142:145], v[182:185]
    s_addc_u32 s53, s41, 0
    v_fmac_f32 v254, v134, v134
    v_fmac_f32 v254, v135, v135
    v_mfma_f32_16x16x32_bf16 v[146:149], v[230:233], a[160:163], v[146:149]
    s_sub_u32 s54, s36, s26
    v_fmac_f32 v254, v136, v136
    v_fmac_f32 v254, v137, v137
    v_mfma_f32_16x16x32_bf16 v[146:149], v[238:241], a[164:167], v[146:149]
    s_mov_b32 s55, 0x00020000
    v_mul_f32 v255, 0x3baaaaab, v183
    v_mul_f32 v175, 0x3baaaaab, v182
    v_mfma_f32_16x16x32_bf16 v[118:121], v[186:189], a[168:171], 0
    s_add_u32 s56, s40, s25
    v_rsq_f32 v255, v255
    v_mfma_f32_16x16x32_bf16 v[118:121], v[194:197], a[172:175], v[118:121]
    s_addc_u32 s57, s41, 0
    v_mul_f32 v130, v255, v130
    v_mul_f32 v131, v255, v131
    v_mfma_f32_16x16x32_bf16 v[118:121], v[122:125], a[176:179], v[118:121]
    s_sub_u32 s58, s36, s25
    v_cvt_pk_bf16_f32 v130, v130, v131
    v_mul_f32 v132, v255, v132
    v_mfma_f32_16x16x32_bf16 v[118:121], v[202:205], a[180:183], v[118:121]
    s_mov_b32 s59, 0x00020000
    v_mul_f32 v133, v255, v133
    v_cvt_pk_bf16_f32 v131, v132, v133
    v_mfma_f32_16x16x32_bf16 v[118:121], v[230:233], a[184:187], v[118:121]
    s_and_b32 s6, s2, 7
    ds_read_b128 v[142:145], v0 offset:26624
    v_mul_f32 v126, v255, v126
    v_mfma_f32_16x16x32_bf16 v[118:121], v[238:241], a[188:191], v[118:121]
    s_sub_u32 s6, 0, s6
    ds_read_b128 v[190:193], v1 offset:26624
    v_mul_f32 v127, v255, v127
    v_mfma_f32_16x16x32_bf16 v[210:213], v[186:189], a[192:195], 0
    s_lshl_b32 s3, s16, 6
    ds_read_b128 v[186:189], v0 offset:26752
    v_cvt_pk_bf16_f32 v132, v126, v127
    v_mfma_f32_16x16x32_bf16 v[210:213], v[194:197], a[196:199], v[210:213]
    s_lshl_b32 s4, s16, 5
    ds_read_b128 v[194:197], v1 offset:26752
    v_mul_f32 v128, v255, v128
    v_mfma_f32_16x16x32_bf16 v[210:213], v[122:125], a[200:203], v[210:213]
    s_add_u32 s4, s4, 256
    ds_read_b128 v[122:125], v0 offset:26880
    v_mul_f32 v129, v255, v129
    v_mfma_f32_16x16x32_bf16 v[210:213], v[202:205], a[204:207], v[210:213]
    s_mul_i32 s5, s16, 9408
    ds_read_b128 v[202:205], v1 offset:26880
    v_cvt_pk_bf16_f32 v133, v128, v129
    v_mfma_f32_16x16x32_bf16 v[210:213], v[230:233], a[208:211], v[210:213]
    buffer_store_dwordx4 v[130:133], v16, s[48:51], 0 offen nt
    v_mul_f32 v114, v255, v114
    v_mul_f32 v115, v255, v115
    v_cvt_pk_bf16_f32 v176, v114, v115
    v_mul_f32 v116, v255, v116
    v_mfma_f32_16x16x32_bf16 v[210:213], v[238:241], a[212:215], v[210:213]
    s_waitcnt lgkmcnt(4)
    v_mul_f32 v117, v255, v117
    v_cvt_pk_bf16_f32 v177, v116, v117
    v_mfma_f32_16x16x32_bf16 v[114:117], a[72:75], v[142:145], 0
    s_add_u32 s5, s5, 104448
    ds_read_b128 v[126:129], v2 offset:0
    ds_read_b128 v[130:133], v2 offset:1024
    v_mfma_f32_16x16x32_bf16 v[114:117], a[76:79], v[190:193], v[114:117]
    s_waitcnt lgkmcnt(4)
    ds_read_b128 v[214:217], v2 offset:2048
    ds_read_b128 v[218:221], v2 offset:3072
    v_mfma_f32_16x16x32_bf16 v[114:117], a[80:83], v[186:189], v[114:117]
    s_waitcnt lgkmcnt(5)
    v_rsq_f32 v175, v175
    v_mfma_f32_16x16x32_bf16 v[114:117], a[84:87], v[194:197], v[114:117]
    s_waitcnt lgkmcnt(4)
    ds_read_b128 v[222:225], v2 offset:4096
    v_mul_f32 v178, v175, v178
    v_mfma_f32_16x16x32_bf16 v[114:117], a[88:91], v[122:125], v[114:117]
    v_mul_f32 v179, v175, v179
    v_cvt_pk_bf16_f32 v178, v178, v179
    v_mfma_f32_16x16x32_bf16 v[114:117], a[92:95], v[202:205], v[114:117]
    ds_read_b128 v[226:229], v2 offset:5120
    v_mul_f32 v180, v175, v180
    v_mul_f32 v181, v175, v181
    v_cvt_pk_bf16_f32 v179, v180, v181
    v_mul_f32 v198, v175, v198
    v_mul_f32 v199, v175, v199
    v_cvt_pk_bf16_f32 v180, v198, v199
    v_mul_f32 v200, v175, v200
    v_mul_f32 v201, v175, v201
    v_cvt_pk_bf16_f32 v181, v200, v201
    v_mul_f32 v206, v175, v206
    v_mul_f32 v207, v175, v207
    v_cvt_pk_bf16_f32 v182, v206, v207
    v_mfma_f32_16x16x32_bf16 v[198:201], a[96:99], v[142:145], 0
    s_waitcnt lgkmcnt(2)
    v_mul_f32 v208, v175, v208
    v_mul_f32 v209, v175, v209
    v_mfma_f32_16x16x32_bf16 v[198:201], a[100:103], v[190:193], v[198:201]
    s_waitcnt lgkmcnt(1)
    v_cvt_pk_bf16_f32 v183, v208, v209
    v_cvt_pk_bf16_f32 v36, v254, v174
    v_mfma_f32_16x16x32_bf16 v[206:209], a[216:219], v[126:129], 0
    v_cvt_pk_bf16_f32 v146, v146, v147
    v_cvt_pk_bf16_f32 v147, v148, v149
    v_mfma_f32_16x16x32_bf16 v[206:209], a[220:223], v[130:133], v[206:209]
    s_waitcnt lgkmcnt(0)
    v_cvt_pk_bf16_f32 v118, v118, v119
    v_cvt_pk_bf16_f32 v119, v120, v121
    v_mfma_f32_16x16x32_bf16 v[230:233], v[32:35], v[36:39], 0
    v_cvt_pk_bf16_f32 v174, v210, v211
    v_cvt_pk_bf16_f32 v175, v212, v213
    v_mfma_f32_16x16x32_bf16 v[206:209], a[224:227], v[214:217], v[206:209]
    buffer_store_dwordx2 v[176:177], v19, s[48:51], 0 offen nt
    v_fma_f32 v120, v114, v114, s32
    v_fmac_f32 v120, v115, v115
    v_mfma_f32_16x16x32_bf16 v[206:209], a[228:231], v[218:221], v[206:209]
    v_fmac_f32 v120, v116, v116
    v_fmac_f32 v120, v117, v117
    v_mfma_f32_16x16x32_bf16 v[206:209], a[232:235], v[222:225], v[206:209]
    v_rsq_f32 v231, v231
    v_mfma_f32_16x16x32_bf16 v[206:209], a[236:239], v[226:229], v[206:209]
    v_rsq_f32 v230, v230
    v_mfma_f32_16x16x32_bf16 v[210:213], a[240:243], v[126:129], 0
    v_mul_f32 v230, s31, v230
    v_mul_f32 v150, v231, v150
    v_mfma_f32_16x16x32_bf16 v[210:213], a[244:247], v[130:133], v[210:213]
    v_mul_f32 v151, v231, v151
    v_cvt_pk_f16_f32 v150, v150, v151
    v_mfma_f32_16x16x32_bf16 v[210:213], a[248:251], v[214:217], v[210:213]
    v_fma_f32 v121, v206, v206, s33
    v_fmac_f32 v121, v207, v207
    v_mfma_f32_16x16x32_bf16 v[210:213], a[252:255], v[218:221], v[210:213]
    v_fmac_f32 v121, v208, v208
    v_fmac_f32 v121, v209, v209
    v_mfma_f32_16x16x32_bf16 v[210:213], v[82:85], v[222:225], v[210:213]
    v_mul_f32 v152, v231, v152
    v_mul_f32 v153, v231, v153
    v_mfma_f32_16x16x32_bf16 v[210:213], v[86:89], v[226:229], v[210:213]
    v_cvt_pk_f16_f32 v151, v152, v153
    v_mul_f32 v162, v231, v162
    v_mfma_f32_16x16x32_bf16 v[198:201], a[104:107], v[186:189], v[198:201]
    v_mul_f32 v163, v231, v163
    v_cvt_pk_f16_f32 v152, v162, v163
    v_mfma_f32_16x16x32_bf16 v[198:201], a[108:111], v[194:197], v[198:201]
    v_mul_f32 v164, v231, v164
    v_mul_f32 v165, v231, v165
    v_mfma_f32_16x16x32_bf16 v[198:201], a[112:115], v[122:125], v[198:201]
    v_fmac_f32 v121, v210, v210
    v_fmac_f32 v121, v211, v211
    v_mfma_f32_16x16x32_bf16 v[198:201], a[116:119], v[202:205], v[198:201]
    v_fmac_f32 v121, v212, v212
    v_fmac_f32 v121, v213, v213
    v_cvt_pk_f16_f32 v153, v164, v165
    v_mfma_f32_16x16x32_bf16 v[162:165], v[90:93], v[126:129], 0
    ds_read_b128 v[126:129], v2 offset:6144
    v_mul_f32 v170, v231, v170
    v_mfma_f32_16x16x32_bf16 v[162:165], v[94:97], v[130:133], v[162:165]
    ds_read_b128 v[130:133], v2 offset:7168
    v_mul_f32 v171, v231, v171
    v_mfma_f32_16x16x32_bf16 v[162:165], v[98:101], v[214:217], v[162:165]
    ds_read_b128 v[214:217], v2 offset:8192
    buffer_store_dwordx4 v[178:181], v15, s[48:51], 0 offen nt
    v_cvt_pk_f16_f32 v236, v170, v171
    v_mul_f32 v172, v231, v172
    v_mul_f32 v173, v231, v173
    v_cvt_pk_f16_f32 v237, v172, v173
    v_mfma_f32_16x16x32_bf16 v[162:165], v[102:105], v[218:221], v[162:165]
    ds_read_b128 v[170:173], v2 offset:9216
    v_mul_f32 v138, v230, v138
    v_mfma_f32_16x16x32_bf16 v[162:165], v[106:109], v[222:225], v[162:165]
    ds_read_b128 v[178:181], v2 offset:10240
    v_mul_f32 v139, v230, v139
    v_mfma_f32_16x16x32_bf16 v[162:165], v[110:113], v[226:229], v[162:165]
    ds_read_b128 v[218:221], v2 offset:11264
    v_cvt_pk_f16_f32 v138, v138, v139
    v_mfma_f32_16x16x32_bf16 v[222:225], a[120:123], v[142:145], 0
    s_waitcnt lgkmcnt(5)
    v_mul_f32 v140, v230, v140
    v_mul_f32 v141, v230, v141
    v_mfma_f32_16x16x32_bf16 v[226:229], a[216:219], v[126:129], 0
    s_waitcnt lgkmcnt(4)
    v_fmac_f32 v121, v162, v162
    v_fmac_f32 v121, v163, v163
    v_mfma_f32_16x16x32_bf16 v[226:229], a[220:223], v[130:133], v[226:229]
    s_waitcnt lgkmcnt(3)
    v_fmac_f32 v121, v164, v164
    v_fmac_f32 v121, v165, v165
    v_mfma_f32_16x16x32_bf16 v[226:229], a[224:227], v[214:217], v[226:229]
    v_cvt_pk_f16_f32 v139, v140, v141
    v_mul_f32 v166, v230, v166
    v_mfma_f32_16x16x32_bf16 v[222:225], a[124:127], v[190:193], v[222:225]
    s_waitcnt lgkmcnt(2)
    v_mul_f32 v167, v230, v167
    v_cvt_pk_f16_f32 v140, v166, v167
    v_mfma_f32_16x16x32_bf16 v[226:229], a[228:231], v[170:173], v[226:229]
    s_waitcnt lgkmcnt(1)
    v_mul_f32 v168, v230, v168
    v_mul_f32 v169, v230, v169
    v_mfma_f32_16x16x32_bf16 v[226:229], a[232:235], v[178:181], v[226:229]
    s_waitcnt lgkmcnt(0)
    v_cvt_pk_f16_f32 v141, v168, v169
    v_mul_f32 v134, v230, v134
    v_mfma_f32_16x16x32_bf16 v[226:229], a[236:239], v[218:221], v[226:229]
    v_mul_f32 v135, v230, v135
    v_cvt_pk_f16_f32 v234, v134, v135
    v_mfma_f32_16x16x32_bf16 v[166:169], a[240:243], v[126:129], 0
    v_mul_f32 v136, v230, v136
    v_mul_f32 v137, v230, v137
    v_mfma_f32_16x16x32_bf16 v[166:169], a[244:247], v[130:133], v[166:169]
    v_cvt_pk_f16_f32 v235, v136, v137
    v_fmac_f32 v120, v198, v198
    v_mfma_f32_16x16x32_bf16 v[166:169], a[248:251], v[214:217], v[166:169]
    v_fmac_f32 v120, v199, v199
    v_fmac_f32 v120, v200, v200
    v_mfma_f32_16x16x32_bf16 v[166:169], a[252:255], v[170:173], v[166:169]
    v_fmac_f32 v120, v201, v201
    v_fma_f32 v148, v226, v226, s33
    v_mfma_f32_16x16x32_bf16 v[166:169], v[82:85], v[178:181], v[166:169]
    buffer_store_dwordx2 v[182:183], v18, s[48:51], 0 offen nt
    v_fmac_f32 v148, v227, v227
    v_fmac_f32 v148, v228, v228
    v_mfma_f32_16x16x32_bf16 v[166:169], v[86:89], v[218:221], v[166:169]
    v_fmac_f32 v148, v229, v229
    v_mul_f32 v149, 0x3baaaaab, v184
    v_mfma_f32_16x16x32_bf16 v[222:225], a[128:131], v[186:189], v[222:225]
    v_rsq_f32 v149, v149
    v_mfma_f32_16x16x32_bf16 v[222:225], a[132:135], v[194:197], v[222:225]
    v_mul_f32 v242, v149, v242
    v_mul_f32 v243, v149, v243
    v_mfma_f32_16x16x32_bf16 v[222:225], a[136:139], v[122:125], v[222:225]
    v_fmac_f32 v148, v166, v166
    v_fmac_f32 v148, v167, v167
    v_mfma_f32_16x16x32_bf16 v[222:225], a[140:143], v[202:205], v[222:225]
    v_fmac_f32 v148, v168, v168
    v_fmac_f32 v148, v169, v169
    v_cvt_pk_bf16_f32 v134, v242, v243
    v_mfma_f32_16x16x32_bf16 v[182:185], v[90:93], v[126:129], 0
    v_mul_f32 v244, v149, v244
    v_mul_f32 v245, v149, v245
    v_mfma_f32_16x16x32_bf16 v[182:185], v[94:97], v[130:133], v[182:185]
    v_cvt_pk_bf16_f32 v135, v244, v245
    v_fmac_f32 v120, v222, v222
    v_mfma_f32_16x16x32_bf16 v[182:185], v[98:101], v[214:217], v[182:185]
    v_fmac_f32 v120, v223, v223
    v_fmac_f32 v120, v224, v224
    v_mfma_f32_16x16x32_bf16 v[182:185], v[102:105], v[170:173], v[182:185]
    v_fmac_f32 v120, v225, v225
    v_mul_f32 v158, v149, v158
    v_mfma_f32_16x16x32_bf16 v[182:185], v[106:109], v[178:181], v[182:185]
    v_mul_f32 v159, v149, v159
    v_cvt_pk_bf16_f32 v136, v158, v159
    v_mfma_f32_16x16x32_bf16 v[182:185], v[110:113], v[218:221], v[182:185]
    v_mul_f32 v160, v149, v160
    v_mul_f32 v161, v149, v161
    v_mfma_f32_16x16x32_bf16 v[126:129], a[0:3], v[142:145], 0
    v_cvt_pk_bf16_f32 v137, v160, v161
    v_mul_f32 v154, v149, v154
    v_mfma_f32_16x16x32_bf16 v[126:129], a[4:7], v[190:193], v[126:129]
    v_mul_f32 v155, v149, v155
    v_cvt_pk_bf16_f32 v176, v154, v155
    v_mfma_f32_16x16x32_bf16 v[126:129], a[8:11], v[186:189], v[126:129]
    v_fmac_f32 v148, v182, v182
    v_fmac_f32 v148, v183, v183
    v_mfma_f32_16x16x32_bf16 v[126:129], a[12:15], v[194:197], v[126:129]
    v_fmac_f32 v148, v184, v184
    v_fmac_f32 v148, v185, v185
    v_mfma_f32_16x16x32_bf16 v[126:129], a[16:19], v[122:125], v[126:129]
    buffer_store_dwordx4 v[134:137], v17, s[48:51], 0 offen nt
    v_cvt_pk_bf16_f32 v254, v121, v148
    v_cvt_pk_bf16_f32 v255, v148, v148
    v_mul_f32 v156, v149, v156
    v_mul_f32 v157, v149, v157
    v_mfma_f32_16x16x32_bf16 v[126:129], a[20:23], v[202:205], v[126:129]
    v_cvt_pk_bf16_f32 v177, v156, v157
    v_mov_b32 v130, 0x40000000
    v_mfma_f32_16x16x32_bf16 v[134:137], a[24:27], v[142:145], 0
    v_bfe_u32 v131, v2, 4, 6
    v_lshrrev_b32 v132, 4, v131
    v_mfma_f32_16x16x32_bf16 v[134:137], a[28:31], v[190:193], v[134:137]
    v_and_b32 v133, 15, v131
    v_add_u32 v121, 0, v133
    v_mfma_f32_16x16x32_bf16 v[134:137], a[32:35], v[186:189], v[134:137]
    v_fma_f32 v148, v126, v126, s32
    v_fmac_f32 v148, v127, v127
    v_mfma_f32_16x16x32_bf16 v[134:137], a[36:39], v[194:197], v[134:137]
    v_fmac_f32 v148, v128, v128
    v_fmac_f32 v148, v129, v129
    v_mfma_f32_16x16x32_bf16 v[134:137], a[40:43], v[122:125], v[134:137]
    v_mul_u32_u24 v149, s20, v121
    v_add_u32 v149, s38, v149
    v_mfma_f32_16x16x32_bf16 v[134:137], a[44:47], v[202:205], v[134:137]
    v_mul_u32_u24 v154, 911, v149
    v_lshrrev_b32 v154, 16, v154
    v_mfma_f32_16x16x32_bf16 v[158:161], a[48:51], v[142:145], 0
    v_mul_u32_u24 v154, s22, v154
    v_mad_u32_u24 v154, v121, s21, v154
    v_mfma_f32_16x16x32_bf16 v[158:161], a[52:55], v[190:193], v[158:161]
    v_bfe_u32 v149, s70, v121, 1
    v_cmp_ne_u32 vcc, 0, v149
    v_mfma_f32_16x16x32_bf16 v[158:161], a[56:59], v[186:189], v[158:161]
    v_fmac_f32 v148, v134, v134
    v_fmac_f32 v148, v135, v135
    v_mfma_f32_16x16x32_bf16 v[158:161], a[60:63], v[194:197], v[158:161]
    v_fmac_f32 v148, v136, v136
    v_fmac_f32 v148, v137, v137
    v_mfma_f32_16x16x32_bf16 v[158:161], a[64:67], v[122:125], v[158:161]
    v_add_u32 v121, s7, v154
    v_cndmask_b32 v121, v130, v121, vcc
    v_mfma_f32_16x16x32_bf16 v[158:161], a[68:71], v[202:205], v[158:161]
    v_lshl_add_u32 v154, v132, 4, v121
    v_add_u32 v154, s3, v154
    v_mfma_f32_16x16x32_bf16 v[170:173], v[142:145], a[144:147], 0
    v_lshl_add_u32 v155, v132, 3, v121
    v_add_u32 v155, s4, v155
    v_mfma_f32_16x16x32_bf16 v[170:173], v[190:193], a[148:151], v[170:173]
    v_lshlrev_b32 v156, 9, v132
    v_lshl_add_u32 v156, v133, 4, v156
    v_mfma_f32_16x16x32_bf16 v[170:173], v[186:189], a[152:155], v[170:173]
    buffer_store_dwordx2 v[176:177], v20, s[48:51], 0 offen nt
    v_fmac_f32 v148, v158, v158
    v_fmac_f32 v148, v159, v159
    v_mfma_f32_16x16x32_bf16 v[170:173], v[194:197], a[156:159], v[170:173]
    v_fmac_f32 v148, v160, v160
    v_fmac_f32 v148, v161, v161
    v_mfma_f32_16x16x32_bf16 v[170:173], v[122:125], a[160:163], v[170:173]
    v_cvt_pk_bf16_f32 v36, v148, v120
    v_add_u32 v156, 149696, v156
    v_mfma_f32_16x16x32_bf16 v[170:173], v[202:205], a[164:167], v[170:173]
    v_and_b32 v157, 0xffff, v2
    v_add_u32 v157, 38912, v157
    v_mfma_f32_16x16x32_bf16 v[178:181], v[32:35], v[36:39], 0
    v_and_b32 v214, 0xffff, v4
    v_add_u32 v214, 38912, v214
    v_mfma_f32_16x16x32_bf16 v[218:221], v[142:145], a[168:171], 0
    ds_write_b64 v214, v[254:255] offset:0
    v_mfma_f32_16x16x32_bf16 v[218:221], v[190:193], a[172:175], v[218:221]
    v_cvt_pk_bf16_f32 v148, v170, v171
    v_cvt_pk_bf16_f32 v149, v172, v173
    v_mfma_f32_16x16x32_bf16 v[218:221], v[186:189], a[176:179], v[218:221]
    v_rsq_f32 v179, v179
    v_mfma_f32_16x16x32_bf16 v[218:221], v[194:197], a[180:183], v[218:221]
    v_rsq_f32 v178, v178
    v_mfma_f32_16x16x32_bf16 v[218:221], v[122:125], a[184:187], v[218:221]
    ds_read_b128 v[170:173], v0 offset:32768
    v_mul_f32 v178, s31, v178
    v_mfma_f32_16x16x32_bf16 v[218:221], v[202:205], a[188:191], v[218:221]
    ds_read_b128 v[230:233], v1 offset:32768
    v_mul_f32 v114, v179, v114
    v_mul_f32 v115, v179, v115
    v_cvt_pk_f16_f32 v114, v114, v115
    s_waitcnt lgkmcnt(2)
    s_barrier
    v_mul_f32 v116, v179, v116
    v_mul_f32 v117, v179, v117
    v_cvt_pk_bf16_f32 v120, v218, v219
    v_mfma_f32_16x16x32_bf16 v[238:241], v[142:145], a[192:195], 0
    ds_read_b128 v[142:145], v157 offset:0
    v_cvt_pk_bf16_f32 v121, v220, v221
    v_mfma_f32_16x16x32_bf16 v[238:241], v[190:193], a[196:199], v[238:241]
    ds_read_b128 v[190:193], v157 offset:1024
    v_cvt_pk_f16_f32 v115, v116, v117
    v_mfma_f32_16x16x32_bf16 v[238:241], v[186:189], a[200:203], v[238:241]
    ds_read_b128 v[186:189], v0 offset:32896
    v_mul_f32 v198, v179, v198
    v_mfma_f32_16x16x32_bf16 v[238:241], v[194:197], a[204:207], v[238:241]
    s_waitcnt lgkmcnt(4)
    ds_read_b128 v[194:197], v1 offset:32896
    v_mul_f32 v199, v179, v199
    v_mfma_f32_16x16x32_bf16 v[238:241], v[122:125], a[208:211], v[238:241]
    s_waitcnt lgkmcnt(4)
    ds_read_b128 v[122:125], v0 offset:33024
    v_cvt_pk_f16_f32 v116, v198, v199
    v_mfma_f32_16x16x32_bf16 v[238:241], v[202:205], a[212:215], v[238:241]
    ds_read_b128 v[202:205], v1 offset:33024
    v_mul_f32 v200, v179, v200
    v_mul_f32 v201, v179, v201
    v_cvt_pk_f16_f32 v117, v200, v201
    v_mfma_f32_16x16x32_bf16 v[198:201], a[72:75], v[170:173], 0
    s_waitcnt lgkmcnt(5)
    v_mul_f32 v222, v179, v222
    v_mul_f32 v223, v179, v223
    v_mfma_f32_16x16x32_bf16 v[198:201], a[76:79], v[230:233], v[198:201]
    v_cvt_pk_bf16_f32 v176, v238, v239
    v_cvt_pk_bf16_f32 v177, v240, v241
    v_cvt_pk_f16_f32 v220, v222, v223
    s_waitcnt lgkmcnt(3)
    v_mfma_f32_16x16x32_bf16 v[198:201], a[80:83], v[186:189], v[198:201]
    v_mul_f32 v224, v179, v224
    s_waitcnt lgkmcnt(2)
    v_mfma_f32_16x16x32_bf16 v[198:201], a[84:87], v[194:197], v[198:201]
    v_mul_f32 v225, v179, v225
    v_cvt_pk_f16_f32 v221, v224, v225
    v_mfma_f32_16x16x32_bf16 v[222:225], v[32:35], v[142:145], 0
    s_waitcnt lgkmcnt(1)
    v_mul_f32 v126, v178, v126
    v_mul_f32 v127, v178, v127
    v_mfma_f32_16x16x32_bf16 v[222:225], v[32:35], v[190:193], v[222:225]
    s_waitcnt lgkmcnt(0)
    v_cvt_pk_f16_f32 v126, v126, v127
    v_mul_f32 v128, v178, v128
    v_mfma_f32_16x16x32_bf16 v[198:201], a[88:91], v[122:125], v[198:201]
    v_mul_f32 v129, v178, v129
    v_cvt_pk_f16_f32 v127, v128, v129
    v_mfma_f32_16x16x32_bf16 v[198:201], a[92:95], v[202:205], v[198:201]
    v_mul_f32 v134, v178, v134
    v_mul_f32 v128, 0x3baaaaab, v223
    v_mfma_f32_16x16x32_bf16 v[142:145], a[96:99], v[170:173], 0
    v_rsq_f32 v128, v128
    v_mfma_f32_16x16x32_bf16 v[142:145], a[100:103], v[230:233], v[142:145]
    v_mul_f32 v226, v128, v226
    v_mul_f32 v227, v128, v227
    v_mfma_f32_16x16x32_bf16 v[142:145], a[104:107], v[186:189], v[142:145]
    v_cvt_pk_bf16_f32 v190, v226, v227
    v_mul_f32 v228, v128, v228
    v_mfma_f32_16x16x32_bf16 v[142:145], a[108:111], v[194:197], v[142:145]
    ds_read_b128 v[238:241], v5 offset:0
    ds_read_b128 v[242:245], v5 offset:16
    v_mfma_f32_16x16x32_bf16 v[142:145], a[112:115], v[122:125], v[142:145]
    ds_read_b32 v254, v6 offset:192
    v_mul_f32 v229, v128, v229
    v_mfma_f32_16x16x32_bf16 v[142:145], a[116:119], v[202:205], v[142:145]
    v_cvt_pk_bf16_f32 v191, v228, v229
    v_mul_f32 v166, v128, v166
    v_mul_f32 v167, v128, v167
    v_cvt_pk_bf16_f32 v192, v166, v167
    v_mul_f32 v168, v128, v168
    v_mul_f32 v169, v128, v169
    v_cvt_pk_bf16_f32 v193, v168, v169
    v_mfma_f32_16x16x32_bf16 v[166:169], a[120:123], v[170:173], 0
    buffer_store_dwordx4 v[190:193], v16, s[52:55], 0 offen nt
    ds_read_b128 v[226:229], v5 offset:48
    v_mul_f32 v182, v128, v182
    v_mul_f32 v183, v128, v183
    v_cvt_pk_bf16_f32 v180, v182, v183
    v_mfma_f32_16x16x32_bf16 v[166:169], a[124:127], v[230:233], v[166:169]
    v_mul_f32 v184, v128, v184
    v_mul_f32 v185, v128, v185
    v_mfma_f32_16x16x32_bf16 v[166:169], a[128:131], v[186:189], v[166:169]
    s_waitcnt lgkmcnt(2)
    v_cvt_pk_bf16_f32 v181, v184, v185
    v_mul_f32 v179, 0x3baaaaab, v222
    v_mfma_f32_16x16x32_bf16 v[166:169], a[132:135], v[194:197], v[166:169]
    s_waitcnt lgkmcnt(1)
    v_rsq_f32 v179, v179
    v_mfma_f32_16x16x32_bf16 v[166:169], a[136:139], v[122:125], v[166:169]
    v_mul_f32 v206, v179, v206
    v_mul_f32 v207, v179, v207
    v_mfma_f32_16x16x32_bf16 v[166:169], a[140:143], v[202:205], v[166:169]
    v_cvt_pk_bf16_f32 v182, v206, v207
    v_mul_f32 v208, v179, v208
    v_mfma_f32_16x16x32_f16 v[190:193], v[238:241], v[138:141], v[22:25]
    s_waitcnt lgkmcnt(0)
    v_mul_f32 v209, v179, v209
    v_cvt_pk_bf16_f32 v183, v208, v209
    v_mfma_f32_16x16x32_f16 v[190:193], v[242:245], v[150:153], v[190:193]
    v_mul_f32 v210, v179, v210
    v_mul_f32 v211, v179, v211
    v_mfma_f32_16x16x32_f16 v[190:193], v[226:229], v[234:237], v[190:193]
    v_cvt_pk_bf16_f32 v184, v210, v211
    v_mul_f32 v212, v179, v212
    v_mfma_f32_16x16x32_bf16 v[206:209], a[0:3], v[170:173], 0
    v_mul_f32 v213, v179, v213
    v_cvt_pk_bf16_f32 v185, v212, v213
    v_mfma_f32_16x16x32_bf16 v[206:209], a[4:7], v[230:233], v[206:209]
    v_mul_f32 v162, v179, v162
    v_mul_f32 v163, v179, v163
    v_mfma_f32_16x16x32_bf16 v[206:209], a[8:11], v[186:189], v[206:209]
    v_cvt_pk_bf16_f32 v192, v162, v163
    v_mul_f32 v164, v179, v164
    v_mfma_f32_16x16x32_bf16 v[206:209], a[12:15], v[194:197], v[206:209]
    v_mul_f32 v165, v179, v165
    v_cvt_pk_bf16_f32 v193, v164, v165
    v_mfma_f32_16x16x32_bf16 v[206:209], a[16:19], v[122:125], v[206:209]
    v_mul_f32 v135, v178, v135
    v_cvt_pk_f16_f32 v128, v134, v135
    v_mfma_f32_16x16x32_bf16 v[206:209], a[20:23], v[202:205], v[206:209]
    v_mul_f32 v136, v178, v136
    v_mul_f32 v137, v178, v137
    v_mfma_f32_16x16x32_bf16 v[162:165], a[24:27], v[170:173], 0
    v_cvt_pk_f16_f32 v129, v136, v137
    v_mul_f32 v158, v178, v158
    v_mfma_f32_16x16x32_bf16 v[162:165], a[28:31], v[230:233], v[162:165]
    buffer_store_dwordx2 v[180:181], v19, s[52:55], 0 offen nt
    v_mul_f32 v159, v178, v159
    v_cvt_pk_f16_f32 v218, v158, v159
    v_mfma_f32_16x16x32_bf16 v[162:165], a[32:35], v[186:189], v[162:165]
    v_mul_f32 v160, v178, v160
    v_mul_f32 v161, v178, v161
    v_mfma_f32_16x16x32_bf16 v[162:165], a[36:39], v[194:197], v[162:165]
    v_cvt_pk_f16_f32 v219, v160, v161
    v_mov_b32_dpp v254, v191 quad_perm:[0,1,2,3] row_mask:0x1 bank_mask:0xf
    v_mfma_f32_16x16x32_bf16 v[162:165], a[40:43], v[122:125], v[162:165]
    v_fma_f32 v191, v206, v206, s32
    v_fmac_f32 v191, v207, v207
    v_mfma_f32_16x16x32_bf16 v[162:165], a[44:47], v[202:205], v[162:165]
    v_fmac_f32 v191, v208, v208
    v_fmac_f32 v191, v209, v209
    v_mfma_f32_16x16x32_bf16 v[134:137], a[48:51], v[170:173], 0
    v_fma_f32 v255, v198, v198, s32
    v_fmac_f32 v255, v199, v199
    v_mfma_f32_16x16x32_bf16 v[134:137], a[52:55], v[230:233], v[134:137]
    v_fmac_f32 v255, v200, v200
    v_fmac_f32 v255, v201, v201
    v_mfma_f32_16x16x32_bf16 v[134:137], a[56:59], v[186:189], v[134:137]
    v_fmac_f32 v191, v162, v162
    v_fmac_f32 v191, v163, v163
    v_mfma_f32_16x16x32_bf16 v[134:137], a[60:63], v[194:197], v[134:137]
    v_fmac_f32 v191, v164, v164
    v_fmac_f32 v191, v165, v165
    v_mfma_f32_16x16x32_bf16 v[134:137], a[64:67], v[122:125], v[134:137]
    v_fmac_f32 v255, v142, v142
    v_fmac_f32 v255, v143, v143
    v_mfma_f32_16x16x32_bf16 v[134:137], a[68:71], v[202:205], v[134:137]
    v_fmac_f32 v255, v144, v144
    v_fmac_f32 v255, v145, v145
    v_fmac_f32 v255, v166, v166
    v_fmac_f32 v255, v167, v167
    v_fmac_f32 v255, v168, v168
    v_fmac_f32 v255, v169, v169
    v_sub_u32 v215, 0x40800000, v44
    v_or_b32 v215, v215, v44
    v_fmac_f32 v191, v134, v134
    v_fmac_f32 v191, v135, v135
    v_fmac_f32 v191, v136, v136
    v_fmac_f32 v191, v137, v137
    v_cvt_pk_bf16_f32 v36, v191, v255
    v_add_u32 v191, 16, v133
    v_min_u32 v255, 20, v191
    v_add_u32 v216, 12, v191
    v_lshrrev_b32 v216, 5, v216
    v_sub_u32 v217, v191, v255
    v_mad_i32_i24 v217, v216, s6, v217
    v_mul_u32_u24 v158, s20, v255
    v_add3_u32 v158, v158, v217, s38
    buffer_store_dwordx4 v[182:185], v15, s[52:55], 0 offen nt
    v_mul_u32_u24 v216, 911, v158
    v_lshrrev_b32 v216, 16, v216
    v_mul_u32_u24 v216, s22, v216
    v_mad_u32_u24 v216, v255, s21, v216
    v_mfma_f32_16x16x32_bf16 v[178:181], v[32:35], v[36:39], 0
    v_bfe_u32 v158, s70, v191, 1
    v_cmp_ne_u32 vcc, 0, v158
    v_mul_i32_i24 v217, 2688, v217
    v_add3_u32 v255, v216, v217, s7
    v_mfma_f32_16x16x32_bf16 v[158:161], v[170:173], a[144:147], 0
    v_cndmask_b32 v255, v130, v255, vcc
    v_lshl_add_u32 v216, v132, 4, v255
    v_mfma_f32_16x16x32_bf16 v[158:161], v[230:233], a[148:151], v[158:161]
    v_rsq_f32 v179, v179
    v_mfma_f32_16x16x32_bf16 v[158:161], v[186:189], a[152:155], v[158:161]
    v_rsq_f32 v178, v178
    v_mfma_f32_16x16x32_bf16 v[158:161], v[194:197], a[156:159], v[158:161]
    v_mul_f32 v178, s31, v178
    v_mul_f32 v198, v179, v198
    v_mfma_f32_16x16x32_bf16 v[158:161], v[122:125], a[160:163], v[158:161]
    v_mul_f32 v199, v179, v199
    v_cvt_pk_f16_f32 v182, v198, v199
    v_mfma_f32_16x16x32_bf16 v[158:161], v[202:205], a[164:167], v[158:161]
    v_mul_f32 v200, v179, v200
    v_mul_f32 v201, v179, v201
    v_cvt_pk_f16_f32 v183, v200, v201
    v_mul_f32 v142, v179, v142
    v_mul_f32 v143, v179, v143
    v_cvt_pk_f16_f32 v184, v142, v143
    v_mul_f32 v144, v179, v144
    v_mul_f32 v145, v179, v145
    v_cvt_pk_bf16_f32 v142, v158, v159
    v_mfma_f32_16x16x32_f16 v[198:201], v[150:153], v[138:141], v[46:49]
    v_cvt_pk_bf16_f32 v143, v160, v161
    v_cvt_pk_f16_f32 v185, v144, v145
    v_mul_f32 v166, v179, v166
    v_mul_f32 v167, v179, v167
    v_cvt_pk_f16_f32 v160, v166, v167
    v_mul_f32 v168, v179, v168
    v_mfma_f32_16x16x16_f16 v[198:201], v[236:237], v[234:235], v[198:201]
    v_mul_f32 v169, v179, v169
    v_cvt_pk_f16_f32 v161, v168, v169
    v_mul_f32 v206, v178, v206
    v_mul_f32 v207, v178, v207
    v_mfma_f32_16x16x32_f16 v[166:169], v[114:117], v[138:141], v[50:53]
    v_cvt_pk_f16_f32 v206, v206, v207
    v_mul_f32 v208, v178, v208
    v_mul_f32 v209, v178, v209
    v_cvt_pk_f16_f32 v207, v208, v209
    v_mul_f32 v162, v178, v162
    buffer_store_dwordx2 v[192:193], v18, s[52:55], 0 offen nt
    v_mul_f32 v163, v178, v163
    v_cvt_pk_f16_f32 v208, v162, v163
    v_mfma_f32_16x16x32_f16 v[210:213], v[182:185], v[138:141], v[54:57]
    v_mul_f32 v164, v178, v164
    v_mul_f32 v165, v178, v165
    v_cvt_pk_f16_f32 v209, v164, v165
    v_mfma_f32_16x16x16_f16 v[166:169], v[220:221], v[234:235], v[166:169]
    v_mul_f32 v134, v178, v134
    v_mul_f32 v135, v178, v135
    v_cvt_pk_f16_f32 v158, v134, v135
    v_mul_f32 v136, v178, v136
    v_mfma_f32_16x16x32_f16 v[138:141], v[238:241], v[206:209], v[26:29]
    v_mul_f32 v137, v178, v137
    v_cvt_pk_f16_f32 v159, v136, v137
    v_mfma_f32_16x16x32_f16 v[138:141], v[242:245], v[182:185], v[138:141]
    v_max3_f32 v217, v190, v198, v199
    v_max3_f32 v217, v217, v200, v201
    v_mfma_f32_16x16x32_f16 v[138:141], v[226:229], v[158:161], v[138:141]
    v_max3_f32 v217, v217, v166, v167
    v_max3_f32 v217, v217, v168, v169
    v_add_u32 v216, s3, v216
    v_mfma_f32_16x16x16_f16 v[210:213], v[160:161], v[234:235], v[210:213]
    v_lshl_add_u32 v255, v132, 3, v255
    v_add_u32 v255, s4, v255
    v_xor_b32 v234, 65536, v2
    v_lshl_add_u32 v130, s16, 2, v234
    v_mfma_f32_16x16x32_bf16 v[134:137], v[170:173], a[168:171], 0
    ds_write_b32 v130, v215 offset:18432
    v_mfma_f32_16x16x32_bf16 v[134:137], v[230:233], a[172:175], v[134:137]
    v_bfe_u32 v235, v133, 1, 2
    v_max3_f32 v217, v217, v210, v211
    v_mfma_f32_16x16x32_bf16 v[134:137], v[186:189], a[176:179], v[134:137]
    v_max3_f32 v217, v217, v212, v213
    v_mov_b32 v215, v217
    v_mfma_f32_16x16x32_bf16 v[134:137], v[194:197], a[180:183], v[134:137]
    v_xor_b32 v235, v235, v132
    v_lshl_add_u32 v235, v133, 2, v235
    v_mfma_f32_16x16x32_bf16 v[134:137], v[122:125], a[184:187], v[134:137]
    ds_read_b128 v[162:165], v2 offset:12288
    v_lshl_add_u32 v140, v235, 4, s5
    v_mfma_f32_16x16x32_bf16 v[134:137], v[202:205], a[188:191], v[134:137]
    v_permlane32_swap_b32 v217, v215
    v_max_f32 v217, v217, v215
    v_mov_b32 v215, v217
    v_lshl_add_u32 v141, v235, 3, s5
    v_lshl_add_u32 v191, v131, 4, s5
    v_permlane16_swap_b32 v217, v215
    v_max_f32 v217, v217, v215
    v_sub_f32 v198, v198, v217
    v_cvt_pk_bf16_f32 v134, v134, v135
    v_cvt_pk_bf16_f32 v135, v136, v137
    v_exp_f32 v198, v198
    v_sub_f32 v199, v199, v217
    v_exp_f32 v199, v199
    v_sub_f32 v200, v200, v217
    v_cvt_pk_bf16_f32 v178, v198, v199
    v_exp_f32 v200, v200
    v_sub_f32 v201, v201, v217
    v_exp_f32 v201, v201
    v_sub_f32 v166, v166, v217
    v_cvt_pk_bf16_f32 v179, v200, v201
    v_exp_f32 v166, v166
    v_sub_f32 v167, v167, v217
    v_exp_f32 v167, v167
    v_sub_f32 v168, v168, v217
    v_cvt_pk_bf16_f32 v180, v166, v167
    v_mfma_f32_16x16x32_bf16 v[198:201], v[170:173], a[192:195], 0
    s_waitcnt lgkmcnt(0)
    ds_read_b128 v[170:173], v2 offset:13312
    v_sub_f32 v169, v169, v217
    v_mfma_f32_16x16x32_bf16 v[198:201], v[230:233], a[196:199], v[198:201]
    ds_read_b128 v[222:225], v2 offset:14336
    v_sub_f32 v210, v210, v217
    v_mfma_f32_16x16x32_bf16 v[198:201], v[186:189], a[200:203], v[198:201]
    ds_read_b128 v[186:189], v2 offset:15360
    v_sub_f32 v211, v211, v217
    v_mfma_f32_16x16x32_bf16 v[198:201], v[194:197], a[204:207], v[198:201]
    ds_read_b128 v[194:197], v2 offset:16384
    v_sub_f32 v212, v212, v217
    v_mfma_f32_16x16x32_bf16 v[198:201], v[122:125], a[208:211], v[198:201]
    ds_read_b128 v[122:125], v2 offset:17408
    v_sub_f32 v213, v213, v217
    v_mfma_f32_16x16x32_bf16 v[198:201], v[202:205], a[212:215], v[198:201]
    ds_read2_b32 v[144:145], v6 offset0:0 offset1:0
    ds_read2_b32 v[136:137], v6 offset0:16 offset1:16
    v_exp_f32 v168, v168
    v_exp_f32 v169, v169
    v_exp_f32 v210, v210
    v_cvt_pk_bf16_f32 v181, v168, v169
    v_exp_f32 v211, v211
    v_exp_f32 v212, v212
    v_cvt_pk_bf16_f32 v166, v198, v199
    ds_read2_b32 v[168:169], v6 offset0:32 offset1:32
    v_cvt_pk_bf16_f32 v167, v200, v201
    v_cvt_pk_bf16_f32 v36, v210, v211
    v_exp_f32 v213, v213
    v_sub_f32 v190, v190, v217
    v_mfma_f32_16x16x32_f16 v[198:201], v[150:153], v[126:129], v[58:61]
    v_cvt_pk_bf16_f32 v37, v212, v213
    v_exp_f32 v190, v190
    v_lshl_add_u32 v215, v131, 3, s5
    v_cvt_pk_bf16_f32 v39, v190, 0
    v_lshlrev_b32 v235, 2, v235
    ds_permute_b32 v217, v235, v16
    v_mfma_f32_16x16x16_f16 v[198:201], v[236:237], v[218:219], v[198:201]
    ds_permute_b32 v190, v235, v19
    ds_permute_b32 v192, v235, v17
    ds_permute_b32 v193, v235, v20
    v_mfma_f32_16x16x32_f16 v[130:133], v[238:241], v[126:129], v[24:27]
    s_waitcnt lgkmcnt(5)
    v_mfma_f32_16x16x32_f16 v[130:133], v[242:245], v[114:117], v[130:133]
    s_waitcnt lgkmcnt(4)
    v_mfma_f32_16x16x32_bf16 v[202:205], v[28:31], v[36:39], 0
    v_mfma_f32_16x16x32_bf16 v[202:205], v[28:31], v[178:181], v[202:205]
    v_mfma_f32_16x16x32_f16 v[130:133], v[226:229], v[218:221], v[130:133]
    v_mfma_f32_16x16x32_bf16 v[210:213], v[142:145], v[36:39], 0
    s_waitcnt lgkmcnt(2)
    v_mfma_f32_16x16x32_bf16 v[210:213], v[146:149], v[178:181], v[210:213]
    s_waitcnt lgkmcnt(0)
    v_mfma_f32_16x16x32_bf16 v[226:229], v[134:137], v[36:39], 0
    v_mfma_f32_16x16x32_bf16 v[226:229], v[118:121], v[178:181], v[226:229]
    s_nop 0
    v_rcp_f32 v202, v202
    v_mov_b32_dpp v254, v131 quad_perm:[0,1,2,3] row_mask:0x2 bank_mask:0xf
    v_mov_b32_dpp v254, v139 quad_perm:[0,1,2,3] row_mask:0x4 bank_mask:0xf
    v_mov_b32 v139, v254
    v_mul_f32 v210, v202, v210
    v_mul_f32 v211, v202, v211
    v_max_f32_dpp v139, v139, v139 quad_perm:[1,0,3,2] row_mask:0xf bank_mask:0xf
    v_cvt_pk_bf16_f32 v210, v210, v211
    v_mul_f32 v212, v202, v212
    v_max_f32_dpp v139, v139, v139 quad_perm:[2,3,0,1] row_mask:0xf bank_mask:0xf
    v_mul_f32 v213, v202, v213
    v_cvt_pk_bf16_f32 v211, v212, v213
    v_mfma_f32_16x16x32_bf16 v[230:233], v[166:169], v[36:39], 0
    v_max_f32_dpp v139, v139, v139 row_half_mirror row_mask:0xf bank_mask:0xf
    v_mul_f32 v226, v202, v226
    v_mfma_f32_16x16x32_bf16 v[230:233], v[174:177], v[178:181], v[230:233]
    v_max_f32_dpp v139, v139, v139 row_mirror row_mask:0xf bank_mask:0xf
    v_mov_b32 v235, v139
    v_mul_f32 v227, v202, v227
    v_cvt_pk_bf16_f32 v212, v226, v227
    v_mfma_f32_16x16x32_f16 v[178:181], v[114:117], v[126:129], v[62:65]
    v_permlane32_swap_b32 v139, v235
    v_max_f32 v139, v139, v235
    v_mov_b32 v235, v139
    v_mul_f32 v228, v202, v228
    v_mul_f32 v229, v202, v229
    v_permlane16_swap_b32 v139, v235
    v_mfma_f32_16x16x16_f16 v[178:181], v[220:221], v[218:219], v[178:181]
    v_max_f32 v139, v139, v235
    v_sub_f32 v254, v254, v139
    v_exp_f32 v254, v254
    v_cvt_pk_bf16_f32 v213, v228, v229
    ds_write_b128 v3, v[210:213] offset:0
    v_mfma_f32_16x16x32_f16 v[210:213], v[182:185], v[126:129], v[66:69]
    v_cvt_pk_bf16_f32 v254, v254, v254
    v_mul_f32 v230, v202, v230
    v_mfma_f32_16x16x32_bf16 v[126:129], a[216:219], v[162:165], 0
    v_mul_f32 v231, v202, v231
    v_cvt_pk_bf16_f32 v230, v230, v231
    v_mfma_f32_16x16x32_bf16 v[126:129], a[220:223], v[170:173], v[126:129]
    ds_write_b16 v8, v254
    v_mul_f32 v232, v202, v232
    v_mfma_f32_16x16x16_f16 v[210:213], v[160:161], v[218:219], v[210:213]
    v_mul_f32 v233, v202, v233
    v_cvt_pk_bf16_f32 v231, v232, v233
    v_max3_f32 v139, v130, v198, v199
    v_max3_f32 v139, v139, v200, v201
    v_mfma_f32_16x16x32_bf16 v[126:129], a[224:227], v[222:225], v[126:129]
    ds_write_b64 v4, v[230:231] offset:4096
    v_mfma_f32_16x16x32_bf16 v[126:129], a[228:231], v[186:189], v[126:129]
    v_max3_f32 v139, v139, v178, v179
    v_max3_f32 v139, v139, v180, v181
    v_mfma_f32_16x16x32_bf16 v[126:129], a[232:235], v[194:197], v[126:129]
    v_max3_f32 v139, v139, v210, v211
    v_max3_f32 v139, v139, v212, v213
    v_mfma_f32_16x16x32_bf16 v[126:129], a[236:239], v[122:125], v[126:129]
    v_mov_b32 v235, v139
    v_mfma_f32_16x16x32_bf16 v[202:205], a[240:243], v[162:165], 0
    v_mfma_f32_16x16x32_bf16 v[202:205], a[244:247], v[170:173], v[202:205]
    v_permlane32_swap_b32 v139, v235
    v_mfma_f32_16x16x32_bf16 v[202:205], a[248:251], v[222:225], v[202:205]
    v_max_f32 v139, v139, v235
    v_mov_b32 v235, v139
    v_mfma_f32_16x16x32_bf16 v[202:205], a[252:255], v[186:189], v[202:205]
    v_fma_f32 v254, v126, v126, s33
    v_fmac_f32 v254, v127, v127
    v_mfma_f32_16x16x32_bf16 v[202:205], v[82:85], v[194:197], v[202:205]
    v_permlane16_swap_b32 v139, v235
    v_mfma_f32_16x16x32_bf16 v[202:205], v[86:89], v[122:125], v[202:205]
    v_fmac_f32 v254, v128, v128
    v_fmac_f32 v254, v129, v129
    v_mfma_f32_16x16x32_bf16 v[226:229], v[90:93], v[162:165], 0
    ds_read_b128 v[162:165], v156 offset:0
    v_max_f32 v139, v139, v235
    v_mfma_f32_16x16x32_bf16 v[226:229], v[94:97], v[170:173], v[226:229]
    ds_read_b128 v[170:173], v156 offset:2048
    v_sub_f32 v198, v198, v139
    v_mfma_f32_16x16x32_bf16 v[226:229], v[98:101], v[222:225], v[226:229]
    ds_read_b128 v[222:225], v156 offset:4096
    v_fmac_f32 v254, v202, v202
    v_mfma_f32_16x16x32_bf16 v[226:229], v[102:105], v[186:189], v[226:229]
    ds_read_b128 v[186:189], v156 offset:6144
    v_fmac_f32 v254, v203, v203
    v_mfma_f32_16x16x32_bf16 v[226:229], v[106:109], v[194:197], v[226:229]
    ds_read_b128 v[194:197], v156 offset:8192
    v_fmac_f32 v254, v204, v204
    v_mfma_f32_16x16x32_bf16 v[226:229], v[110:113], v[122:125], v[226:229]
    ds_read_b128 v[122:125], v156 offset:10240
    v_fmac_f32 v254, v205, v205
    v_exp_f32 v198, v198
    v_sub_f32 v199, v199, v139
    v_exp_f32 v199, v199
    v_sub_f32 v200, v200, v139
    v_cvt_pk_bf16_f32 v198, v198, v199
    v_exp_f32 v200, v200
    v_fmac_f32 v254, v226, v226
    v_fmac_f32 v254, v227, v227
    v_fmac_f32 v254, v228, v228
    v_fmac_f32 v254, v229, v229
    v_sub_f32 v201, v201, v139
    v_exp_f32 v201, v201
    v_sub_f32 v178, v178, v139
    v_cvt_pk_bf16_f32 v199, v200, v201
    v_exp_f32 v178, v178
    v_sub_f32 v179, v179, v139
    v_exp_f32 v179, v179
    v_sub_f32 v180, v180, v139
    v_cvt_pk_bf16_f32 v200, v178, v179
    v_mfma_f32_16x16x32_f16 v[230:233], v[150:153], v[206:209], v[70:73]
    s_waitcnt lgkmcnt(0)
    v_exp_f32 v180, v180
    v_mfma_f32_16x16x32_f16 v[150:153], v[114:117], v[206:209], v[74:77]
    v_sub_f32 v181, v181, v139
    v_sub_f32 v210, v210, v139
    v_mfma_f32_16x16x32_bf16 v[114:117], a[216:219], v[162:165], 0
    v_exp_f32 v181, v181
    v_sub_f32 v211, v211, v139
    v_mfma_f32_16x16x16_f16 v[230:233], v[236:237], v[158:159], v[230:233]
    v_cvt_pk_bf16_f32 v201, v180, v181
    v_exp_f32 v210, v210
    v_mfma_f32_16x16x16_f16 v[150:153], v[220:221], v[158:159], v[150:153]
    v_exp_f32 v211, v211
    v_sub_f32 v212, v212, v139
    v_cvt_pk_bf16_f32 v36, v210, v211
    v_mfma_f32_16x16x32_f16 v[178:181], v[182:185], v[206:209], v[78:81]
    v_exp_f32 v212, v212
    v_mfma_f32_16x16x32_bf16 v[114:117], a[220:223], v[170:173], v[114:117]
    v_max3_f32 v235, v138, v230, v231
    v_max3_f32 v235, v235, v232, v233
    v_mfma_f32_16x16x32_bf16 v[114:117], a[224:227], v[222:225], v[114:117]
    v_max3_f32 v235, v235, v150, v151
    v_max3_f32 v235, v235, v152, v153
    v_sub_f32 v213, v213, v139
    v_mfma_f32_16x16x16_f16 v[178:181], v[160:161], v[158:159], v[178:181]
    v_exp_f32 v213, v213
    v_sub_f32 v130, v130, v139
    v_cvt_pk_bf16_f32 v37, v212, v213
    v_mfma_f32_16x16x32_bf16 v[114:117], a[228:231], v[186:189], v[114:117]
    v_exp_f32 v130, v130
    v_mfma_f32_16x16x32_bf16 v[114:117], a[232:235], v[194:197], v[114:117]
    v_cvt_pk_bf16_f32 v39, v130, 0
    v_mfma_f32_16x16x32_bf16 v[114:117], a[236:239], v[122:125], v[114:117]
    v_max3_f32 v235, v235, v178, v179
    v_max3_f32 v235, v235, v180, v181
    v_mfma_f32_16x16x32_bf16 v[130:133], v[28:31], v[36:39], 0
    v_mov_b32 v139, v235
    v_mfma_f32_16x16x32_bf16 v[130:133], v[28:31], v[198:201], v[130:133]
    v_mfma_f32_16x16x32_bf16 v[158:161], v[142:145], v[36:39], 0
    v_permlane32_swap_b32 v235, v139
    v_mfma_f32_16x16x32_bf16 v[158:161], v[146:149], v[198:201], v[158:161]
    v_fma_f32 v236, v114, v114, s33
    v_fmac_f32 v236, v115, v115
    v_mfma_f32_16x16x32_bf16 v[182:185], v[134:137], v[36:39], 0
    v_fmac_f32 v236, v116, v116
    v_fmac_f32 v236, v117, v117
    v_mfma_f32_16x16x32_bf16 v[182:185], v[118:121], v[198:201], v[182:185]
    v_max_f32 v235, v235, v139
    v_mov_b32 v139, v235
    v_mfma_f32_16x16x32_bf16 v[206:209], v[166:169], v[36:39], 0
    v_rcp_f32 v130, v130
    v_mfma_f32_16x16x32_bf16 v[206:209], v[174:177], v[198:201], v[206:209]
    v_permlane16_swap_b32 v235, v139
    v_mfma_f32_16x16x32_bf16 v[198:201], a[240:243], v[162:165], 0
    v_max_f32 v235, v235, v139
    v_sub_f32 v230, v230, v235
    v_mfma_f32_16x16x32_bf16 v[198:201], a[244:247], v[170:173], v[198:201]
    v_exp_f32 v230, v230
    v_mfma_f32_16x16x32_bf16 v[198:201], a[248:251], v[222:225], v[198:201]
    v_sub_f32 v231, v231, v235
    v_sub_f32 v232, v232, v235
    v_mfma_f32_16x16x32_bf16 v[198:201], a[252:255], v[186:189], v[198:201]
    v_exp_f32 v231, v231
    v_mfma_f32_16x16x32_bf16 v[198:201], v[82:85], v[194:197], v[198:201]
    v_cvt_pk_bf16_f32 v210, v230, v231
    v_sub_f32 v233, v233, v235
    v_mfma_f32_16x16x32_bf16 v[198:201], v[86:89], v[122:125], v[198:201]
    v_exp_f32 v232, v232
    v_mfma_f32_16x16x32_bf16 v[218:221], v[90:93], v[162:165], 0
    v_exp_f32 v233, v233
    v_mfma_f32_16x16x32_bf16 v[218:221], v[94:97], v[170:173], v[218:221]
    v_cvt_pk_bf16_f32 v211, v232, v233
    v_sub_f32 v150, v150, v235
    v_mfma_f32_16x16x32_bf16 v[218:221], v[98:101], v[222:225], v[218:221]
    v_exp_f32 v150, v150
    v_mfma_f32_16x16x32_bf16 v[218:221], v[102:105], v[186:189], v[218:221]
    v_fmac_f32 v236, v198, v198
    v_fmac_f32 v236, v199, v199
    v_mfma_f32_16x16x32_bf16 v[218:221], v[106:109], v[194:197], v[218:221]
    v_fmac_f32 v236, v200, v200
    v_fmac_f32 v236, v201, v201
    v_mfma_f32_16x16x32_bf16 v[218:221], v[110:113], v[122:125], v[218:221]
    v_sub_f32 v151, v151, v235
    v_exp_f32 v151, v151
    v_sub_f32 v152, v152, v235
    v_cvt_pk_bf16_f32 v212, v150, v151
    v_exp_f32 v152, v152
    v_sub_f32 v153, v153, v235
    v_exp_f32 v153, v153
    v_sub_f32 v178, v178, v235
    v_fmac_f32 v236, v218, v218
    v_fmac_f32 v236, v219, v219
    v_fmac_f32 v236, v220, v220
    v_fmac_f32 v236, v221, v221
    v_cvt_pk_bf16_f32 v150, v254, v236
    v_cvt_pk_bf16_f32 v151, v236, v236
    ds_write_b64 v214, v[150:151] offset:2048
    v_cvt_pk_bf16_f32 v213, v152, v153
    v_exp_f32 v178, v178
    ds_read_b128 v[122:125], v9
    ds_read_b128 v[150:153], v9 offset:64
    v_sub_f32 v179, v179, v235
    v_exp_f32 v179, v179
    v_sub_f32 v180, v180, v235
    v_cvt_pk_bf16_f32 v36, v178, v179
    v_exp_f32 v180, v180
    v_sub_f32 v181, v181, v235
    v_exp_f32 v181, v181
    v_sub_f32 v138, v138, v235
    v_cvt_pk_bf16_f32 v37, v180, v181
    v_exp_f32 v138, v138
    v_mul_f32 v158, v130, v158
    s_waitcnt lgkmcnt(2)
    s_barrier
    s_barrier
    ds_read_b128 v[162:165], v157 offset:2048
    ds_read_b128 v[170:173], v157 offset:3072
    ds_read_b128 v[178:181], v234 offset:0
    ds_read_b128 v[186:189], v234 offset:1024
    s_waitcnt lgkmcnt(4)
    v_mfma_f32_16x16x32_bf16 v[194:197], v[122:125], v[28:31], 0
    ds_read_b128 v[222:225], v234 offset:2048
    v_cvt_pk_bf16_f32 v39, v138, 0
    v_mfma_f32_16x16x32_bf16 v[194:197], v[150:153], v[28:31], v[194:197]
    ds_read_b128 v[230:233], v234 offset:3072
    v_mul_f32 v159, v130, v159
    v_cvt_pk_bf16_f32 v158, v158, v159
    v_mfma_f32_16x16x32_bf16 v[238:241], v[122:125], v[146:149], 0
    v_mul_f32 v160, v130, v160
    v_mul_f32 v161, v130, v161
    v_mfma_f32_16x16x32_bf16 v[238:241], v[150:153], v[142:145], v[238:241]
    v_cvt_pk_bf16_f32 v159, v160, v161
    v_mul_f32 v182, v130, v182
    v_mfma_f32_16x16x32_bf16 v[242:245], v[122:125], v[118:121], 0
    s_waitcnt lgkmcnt(5)
    v_mul_f32 v183, v130, v183
    v_cvt_pk_bf16_f32 v160, v182, v183
    v_mfma_f32_16x16x32_bf16 v[242:245], v[150:153], v[134:137], v[242:245]
    s_waitcnt lgkmcnt(3)
    ds_read_b128 v[246:249], v234 offset:4096
    v_mul_f32 v184, v130, v184
    v_mul_f32 v185, v130, v185
    v_cvt_pk_bf16_f32 v161, v184, v185
    ds_write_b128 v3, v[158:161] offset:6144
    v_mfma_f32_16x16x32_bf16 v[158:161], v[32:35], v[162:165], 0
    s_waitcnt lgkmcnt(2)
    v_mul_f32 v206, v130, v206
    v_mul_f32 v207, v130, v207
    v_mfma_f32_16x16x32_bf16 v[158:161], v[32:35], v[170:173], v[158:161]
    v_cvt_pk_bf16_f32 v138, v206, v207
    v_mul_f32 v208, v130, v208
    v_mfma_f32_16x16x32_bf16 v[162:165], a[216:219], v[178:181], 0
    ds_read_b128 v[170:173], v234 offset:5120
    v_mul_f32 v209, v130, v209
    v_mfma_f32_16x16x32_bf16 v[162:165], a[220:223], v[186:189], v[162:165]
    v_rcp_f32 v194, v194
    v_mfma_f32_16x16x32_bf16 v[162:165], a[224:227], v[222:225], v[162:165]
    s_waitcnt lgkmcnt(2)
    v_cvt_pk_bf16_f32 v139, v208, v209
    v_mul_f32 v254, 0x3baaaaab, v159
    v_mfma_f32_16x16x32_bf16 v[162:165], a[228:231], v[230:233], v[162:165]
    ds_write_b64 v4, v[138:139] offset:10240
    v_mfma_f32_16x16x32_bf16 v[162:165], a[232:235], v[246:249], v[162:165]
    v_rsq_f32 v254, v254
    v_mfma_f32_16x16x32_bf16 v[130:133], a[240:243], v[178:181], 0
    v_mul_f32 v114, v254, v114
    v_mul_f32 v115, v254, v115
    v_mfma_f32_16x16x32_bf16 v[130:133], a[244:247], v[186:189], v[130:133]
    v_cvt_pk_bf16_f32 v114, v114, v115
    v_mul_f32 v116, v254, v116
    v_mfma_f32_16x16x32_bf16 v[130:133], a[248:251], v[222:225], v[130:133]
    s_waitcnt lgkmcnt(1)
    v_mul_f32 v117, v254, v117
    v_cvt_pk_bf16_f32 v115, v116, v117
    v_mfma_f32_16x16x32_bf16 v[162:165], a[236:239], v[170:173], v[162:165]
    v_mul_f32 v198, v254, v198
    v_mul_f32 v199, v254, v199
    v_mfma_f32_16x16x32_bf16 v[130:133], a[252:255], v[230:233], v[130:133]
    v_cvt_pk_bf16_f32 v116, v198, v199
    v_mul_f32 v200, v254, v200
    v_mfma_f32_16x16x32_bf16 v[130:133], v[82:85], v[246:249], v[130:133]
    v_mul_f32 v201, v254, v201
    v_cvt_pk_bf16_f32 v117, v200, v201
    v_mfma_f32_16x16x32_bf16 v[130:133], v[86:89], v[170:173], v[130:133]
    buffer_store_dwordx4 v[114:117], v154, s[12:15], 0 offen nt
    v_fma_f32 v154, v162, v162, s33
    v_fmac_f32 v154, v163, v163
    v_fmac_f32 v154, v164, v164
    v_fmac_f32 v154, v165, v165
    v_mfma_f32_16x16x32_bf16 v[114:117], v[90:93], v[178:181], 0
    v_mul_f32 v218, v254, v218
    v_mul_f32 v219, v254, v219
    v_mfma_f32_16x16x32_bf16 v[114:117], v[94:97], v[186:189], v[114:117]
    v_fmac_f32 v154, v130, v130
    v_fmac_f32 v154, v131, v131
    v_mfma_f32_16x16x32_bf16 v[114:117], v[98:101], v[222:225], v[114:117]
    v_fmac_f32 v154, v132, v132
    v_fmac_f32 v154, v133, v133
    v_mfma_f32_16x16x32_bf16 v[114:117], v[102:105], v[230:233], v[114:117]
    v_cvt_pk_bf16_f32 v138, v218, v219
    v_mul_f32 v220, v254, v220
    v_mfma_f32_16x16x32_bf16 v[114:117], v[106:109], v[246:249], v[114:117]
    v_mul_f32 v221, v254, v221
    v_cvt_pk_bf16_f32 v139, v220, v221
    v_mfma_f32_16x16x32_bf16 v[114:117], v[110:113], v[170:173], v[114:117]
    v_mul_f32 v238, v238, v194
    v_mul_f32_dpp v238, v242, v194 quad_perm:[0,1,2,3] row_mask:0x2 bank_mask:0xf
    v_mfma_f32_16x16x32_bf16 v[170:173], v[122:125], v[174:177], 0
    v_mul_f32 v254, 0x3baaaaab, v158
    v_mfma_f32_16x16x32_bf16 v[170:173], v[150:153], v[166:169], v[170:173]
    v_rsq_f32 v254, v254
    v_mfma_f32_16x16x32_bf16 v[122:125], v[28:31], v[36:39], 0
    v_mul_f32 v126, v254, v126
    v_fmac_f32 v154, v114, v114
    v_mfma_f32_16x16x32_bf16 v[122:125], v[28:31], v[210:213], v[122:125]
    v_fmac_f32 v154, v115, v115
    v_fmac_f32 v154, v116, v116
    v_mfma_f32_16x16x32_bf16 v[150:153], v[142:145], v[36:39], 0
    v_fmac_f32 v154, v117, v117
    v_cvt_pk_bf16_f32 v236, v154, v154
    v_mfma_f32_16x16x32_bf16 v[150:153], v[146:149], v[210:213], v[150:153]
    v_cvt_pk_bf16_f32 v237, v154, v154
    v_mul_f32_dpp v238, v170, v194 quad_perm:[0,1,2,3] row_mask:0x4 bank_mask:0xf
    v_mfma_f32_16x16x32_bf16 v[142:145], v[134:137], v[36:39], 0
    ds_write_b64 v214, v[236:237] offset:7616
    v_mfma_f32_16x16x32_bf16 v[142:145], v[118:121], v[210:213], v[142:145]
    v_cvt_pk_bf16_f32 v238, v238, v238
    v_mul_f32 v127, v254, v127
    v_mfma_f32_16x16x32_bf16 v[118:121], v[166:169], v[36:39], 0
    ds_write_b16 v7, v238
    v_mfma_f32_16x16x32_bf16 v[118:121], v[174:177], v[210:213], v[118:121]
    buffer_store_dwordx2 v[138:139], v155, s[12:15], 0 offen nt
    v_cvt_pk_bf16_f32 v126, v126, v127
    v_mul_f32 v128, v254, v128
    v_mul_f32 v129, v254, v129
    v_cvt_pk_bf16_f32 v127, v128, v129
    v_mul_f32 v202, v254, v202
    v_mul_f32 v203, v254, v203
    v_cvt_pk_bf16_f32 v128, v202, v203
    v_mul_f32 v204, v254, v204
    v_mul_f32 v205, v254, v205
    v_cvt_pk_bf16_f32 v129, v204, v205
    v_mul_f32 v226, v254, v226
    v_mul_f32 v227, v254, v227
    v_cvt_pk_bf16_f32 v138, v226, v227
    v_mul_f32 v228, v254, v228
    v_mul_f32 v229, v254, v229
    v_cvt_pk_bf16_f32 v139, v228, v229
    v_rcp_f32 v122, v122
    s_nop 0
    v_mul_f32 v150, v122, v150
    s_waitcnt lgkmcnt(0)
    s_barrier
    ds_read_b128 v[134:137], v157 offset:7616
    ds_read_b128 v[146:149], v157 offset:8640
    ds_read_b128 v[158:161], v234 offset:6144
    ds_read_b128 v[166:169], v234 offset:7168
    ds_read_b128 v[170:173], v234 offset:8192
    ds_read_b128 v[174:177], v234 offset:9216
    ds_read_b128 v[178:181], v234 offset:10240
    ds_read_b128 v[182:185], v234 offset:11264
    v_mul_f32 v151, v122, v151
    v_cvt_pk_bf16_f32 v150, v150, v151
    v_mul_f32 v152, v122, v152
    s_waitcnt lgkmcnt(7)
    v_mfma_f32_16x16x32_bf16 v[186:189], v[32:35], v[134:137], 0
    s_waitcnt lgkmcnt(5)
    v_mul_f32 v153, v122, v153
    v_cvt_pk_bf16_f32 v151, v152, v153
    v_mfma_f32_16x16x32_bf16 v[186:189], v[32:35], v[146:149], v[186:189]
    s_waitcnt lgkmcnt(4)
    v_mul_f32 v142, v122, v142
    v_mul_f32 v143, v122, v143
    v_mfma_f32_16x16x32_bf16 v[134:137], a[216:219], v[158:161], 0
    s_waitcnt lgkmcnt(3)
    v_cvt_pk_bf16_f32 v152, v142, v143
    v_mul_f32 v144, v122, v144
    v_mfma_f32_16x16x32_bf16 v[134:137], a[220:223], v[166:169], v[134:137]
    s_waitcnt lgkmcnt(2)
    v_mul_f32 v145, v122, v145
    v_cvt_pk_bf16_f32 v153, v144, v145
    v_mfma_f32_16x16x32_bf16 v[134:137], a[224:227], v[170:173], v[134:137]
    s_waitcnt lgkmcnt(1)
    ds_write_b128 v3, v[150:153] offset:12288
    v_mfma_f32_16x16x32_bf16 v[134:137], a[228:231], v[174:177], v[134:137]
    s_waitcnt lgkmcnt(1)
    buffer_store_dwordx4 v[126:129], v17, s[52:55], 0 offen nt
    v_mul_f32 v118, v122, v118
    v_mul_f32 v119, v122, v119
    v_cvt_pk_bf16_f32 v154, v118, v119
    v_mul_f32 v120, v122, v120
    v_mfma_f32_16x16x32_bf16 v[134:137], a[232:235], v[178:181], v[134:137]
    v_mul_f32 v121, v122, v121
    v_cvt_pk_bf16_f32 v155, v120, v121
    v_mfma_f32_16x16x32_bf16 v[134:137], a[236:239], v[182:185], v[134:137]
    ds_write_b64 v4, v[154:155] offset:16384
    v_mfma_f32_16x16x32_bf16 v[118:121], a[240:243], v[158:161], 0
    v_mul_f32 v254, 0x3baaaaab, v186
    v_mfma_f32_16x16x32_bf16 v[118:121], a[244:247], v[166:169], v[118:121]
    v_rsq_f32 v254, v254
    v_mfma_f32_16x16x32_bf16 v[118:121], a[248:251], v[170:173], v[118:121]
    v_mul_f32 v162, v254, v162
    v_mul_f32 v163, v254, v163
    v_mfma_f32_16x16x32_bf16 v[118:121], a[252:255], v[174:177], v[118:121]
    v_fma_f32 v154, v134, v134, s33
    v_fmac_f32 v154, v135, v135
    v_mfma_f32_16x16x32_bf16 v[118:121], v[82:85], v[178:181], v[118:121]
    v_fmac_f32 v154, v136, v136
    v_fmac_f32 v154, v137, v137
    v_mfma_f32_16x16x32_bf16 v[118:121], v[86:89], v[182:185], v[118:121]
    v_cvt_pk_bf16_f32 v122, v162, v163
    v_mul_f32 v164, v254, v164
    v_mfma_f32_16x16x32_bf16 v[126:129], v[90:93], v[158:161], 0
    ds_read_b128 v[142:145], v156 offset:256
    v_mul_f32 v165, v254, v165
    v_mfma_f32_16x16x32_bf16 v[126:129], v[94:97], v[166:169], v[126:129]
    ds_read_b128 v[146:149], v156 offset:2304
    v_cvt_pk_bf16_f32 v123, v164, v165
    v_mfma_f32_16x16x32_bf16 v[126:129], v[98:101], v[170:173], v[126:129]
    ds_read_b128 v[150:153], v156 offset:4352
    v_fmac_f32 v154, v118, v118
    v_mfma_f32_16x16x32_bf16 v[126:129], v[102:105], v[174:177], v[126:129]
    ds_read_b128 v[158:161], v156 offset:6400
    v_fmac_f32 v154, v119, v119
    v_mfma_f32_16x16x32_bf16 v[126:129], v[106:109], v[178:181], v[126:129]
    ds_read_b128 v[162:165], v156 offset:8448
    v_fmac_f32 v154, v120, v120
    v_mfma_f32_16x16x32_bf16 v[126:129], v[110:113], v[182:185], v[126:129]
    ds_read_b128 v[166:169], v156 offset:10496
    v_fmac_f32 v154, v121, v121
    buffer_store_dwordx2 v[138:139], v20, s[52:55], 0 offen nt
    s_waitcnt lgkmcnt(5)
    v_mul_f32 v130, v254, v130
    v_mfma_f32_16x16x32_bf16 v[170:173], a[216:219], v[142:145], 0
    v_mul_f32 v131, v254, v131
    v_cvt_pk_bf16_f32 v124, v130, v131
    v_mfma_f32_16x16x32_bf16 v[174:177], a[240:243], v[142:145], 0
    s_waitcnt lgkmcnt(4)
    v_fmac_f32 v154, v126, v126
    v_fmac_f32 v154, v127, v127
    v_mfma_f32_16x16x32_bf16 v[170:173], a[220:223], v[146:149], v[170:173]
    s_waitcnt lgkmcnt(3)
    v_fmac_f32 v154, v128, v128
    v_fmac_f32 v154, v129, v129
    v_mfma_f32_16x16x32_bf16 v[170:173], a[224:227], v[150:153], v[170:173]
    s_waitcnt lgkmcnt(2)
    v_cvt_pk_bf16_f32 v130, v154, v154
    v_cvt_pk_bf16_f32 v131, v154, v154
    v_mfma_f32_16x16x32_bf16 v[170:173], a[228:231], v[158:161], v[170:173]
    s_waitcnt lgkmcnt(1)
    ds_write_b64 v214, v[130:131] offset:9664
    v_mfma_f32_16x16x32_bf16 v[170:173], a[232:235], v[162:165], v[170:173]
    s_waitcnt lgkmcnt(1)
    v_mul_f32 v132, v254, v132
    v_mul_f32 v133, v254, v133
    v_mfma_f32_16x16x32_bf16 v[170:173], a[236:239], v[166:169], v[170:173]
    v_cvt_pk_bf16_f32 v125, v132, v133
    v_mul_f32 v114, v254, v114
    v_mfma_f32_16x16x32_bf16 v[174:177], a[244:247], v[146:149], v[174:177]
    v_mul_f32 v115, v254, v115
    v_cvt_pk_bf16_f32 v138, v114, v115
    v_mfma_f32_16x16x32_bf16 v[174:177], a[248:251], v[150:153], v[174:177]
    v_mul_f32 v116, v254, v116
    v_mul_f32 v117, v254, v117
    v_mfma_f32_16x16x32_bf16 v[174:177], a[252:255], v[158:161], v[174:177]
    v_fma_f32 v254, v170, v170, s33
    v_fmac_f32 v254, v171, v171
    v_mfma_f32_16x16x32_bf16 v[174:177], v[82:85], v[162:165], v[174:177]
    v_fmac_f32 v254, v172, v172
    v_fmac_f32 v254, v173, v173
    v_mfma_f32_16x16x32_bf16 v[174:177], v[86:89], v[166:169], v[174:177]
    s_waitcnt lgkmcnt(0)
    v_cvt_pk_bf16_f32 v139, v116, v117
    v_mfma_f32_16x16x32_bf16 v[114:117], v[90:93], v[142:145], 0
    s_barrier
    ds_read_b128 v[130:133], v157 offset:9664
    ds_read_b128 v[142:145], v157 offset:10688
    v_mfma_f32_16x16x32_bf16 v[114:117], v[94:97], v[146:149], v[114:117]
    ds_read_b128 v[146:149], v234 offset:12288
    ds_read_b128 v[178:181], v234 offset:13312
    v_mfma_f32_16x16x32_bf16 v[114:117], v[98:101], v[150:153], v[114:117]
    v_fmac_f32 v254, v174, v174
    v_fmac_f32 v254, v175, v175
    v_mfma_f32_16x16x32_bf16 v[114:117], v[102:105], v[158:161], v[114:117]
    ds_read_b128 v[150:153], v234 offset:14336
    ds_read_b128 v[158:161], v234 offset:15360
    v_mfma_f32_16x16x32_bf16 v[114:117], v[106:109], v[162:165], v[114:117]
    buffer_store_dwordx4 v[122:125], v15, s[56:59], 0 offen nt
    ds_read_b128 v[162:165], v234 offset:16384
    v_fmac_f32 v254, v176, v176
    v_fmac_f32 v254, v177, v177
    v_mfma_f32_16x16x32_bf16 v[114:117], v[110:113], v[166:169], v[114:117]
    ds_read_b128 v[122:125], v234 offset:17408
    s_nop 0
    s_waitcnt lgkmcnt(7)
    v_mfma_f32_16x16x32_bf16 v[166:169], v[32:35], v[130:133], 0
    s_waitcnt lgkmcnt(6)
    v_mfma_f32_16x16x32_bf16 v[166:169], v[32:35], v[142:145], v[166:169]
    s_waitcnt lgkmcnt(4)
    v_mfma_f32_16x16x32_bf16 v[130:133], a[216:219], v[146:149], 0
    v_fmac_f32 v254, v114, v114
    v_fmac_f32 v254, v115, v115
    v_mfma_f32_16x16x32_bf16 v[130:133], a[220:223], v[178:181], v[130:133]
    s_waitcnt lgkmcnt(2)
    v_fmac_f32 v254, v116, v116
    v_fmac_f32 v254, v117, v117
    v_mfma_f32_16x16x32_bf16 v[130:133], a[224:227], v[150:153], v[130:133]
    s_waitcnt lgkmcnt(1)
    v_cvt_pk_bf16_f32 v154, v254, v254
    v_cvt_pk_bf16_f32 v155, v254, v254
    v_mfma_f32_16x16x32_bf16 v[130:133], a[228:231], v[158:161], v[130:133]
    ds_write_b64 v214, v[154:155] offset:17280
    v_mfma_f32_16x16x32_bf16 v[130:133], a[232:235], v[162:165], v[130:133]
    s_waitcnt lgkmcnt(1)
    v_mul_f32 v254, 0x3baaaaab, v166
    v_mfma_f32_16x16x32_bf16 v[130:133], a[236:239], v[122:125], v[130:133]
    v_rsq_f32 v254, v254
    v_mfma_f32_16x16x32_bf16 v[142:145], a[240:243], v[146:149], 0
    v_mul_f32 v134, v254, v134
    v_mul_f32 v135, v254, v135
    v_mfma_f32_16x16x32_bf16 v[142:145], a[244:247], v[178:181], v[142:145]
    v_cvt_pk_bf16_f32 v134, v134, v135
    v_mul_f32 v136, v254, v136
    v_mfma_f32_16x16x32_bf16 v[142:145], a[248:251], v[150:153], v[142:145]
    v_fma_f32 v154, v130, v130, s33
    v_fmac_f32 v154, v131, v131
    v_mfma_f32_16x16x32_bf16 v[142:145], a[252:255], v[158:161], v[142:145]
    v_fmac_f32 v154, v132, v132
    v_fmac_f32 v154, v133, v133
    v_mfma_f32_16x16x32_bf16 v[142:145], v[82:85], v[162:165], v[142:145]
    v_mul_f32 v137, v254, v137
    v_cvt_pk_bf16_f32 v135, v136, v137
    v_mfma_f32_16x16x32_bf16 v[142:145], v[86:89], v[122:125], v[142:145]
    buffer_store_dwordx2 v[138:139], v18, s[56:59], 0 offen nt
    v_mul_f32 v118, v254, v118
    v_mul_f32 v119, v254, v119
    v_mfma_f32_16x16x32_bf16 v[166:169], v[90:93], v[146:149], 0
    v_cvt_pk_bf16_f32 v136, v118, v119
    v_mul_f32 v120, v254, v120
    v_mfma_f32_16x16x32_bf16 v[166:169], v[94:97], v[178:181], v[166:169]
    v_mul_f32 v121, v254, v121
    v_fmac_f32 v154, v142, v142
    v_mfma_f32_16x16x32_bf16 v[166:169], v[98:101], v[150:153], v[166:169]
    v_fmac_f32 v154, v143, v143
    v_fmac_f32 v154, v144, v144
    v_mfma_f32_16x16x32_bf16 v[166:169], v[102:105], v[158:161], v[166:169]
    v_fmac_f32 v154, v145, v145
    v_cvt_pk_bf16_f32 v137, v120, v121
    v_mfma_f32_16x16x32_bf16 v[166:169], v[106:109], v[162:165], v[166:169]
    ds_write_b128 v140, v[134:137] offset:1536
    v_mfma_f32_16x16x32_bf16 v[166:169], v[110:113], v[122:125], v[166:169]
    v_mul_f32 v126, v254, v126
    v_mul_f32 v127, v254, v127
    v_cvt_pk_bf16_f32 v138, v126, v127
    v_mul_f32 v128, v254, v128
    v_mul_f32 v129, v254, v129
    ds_read_b128 v[118:121], v191 offset:1536
    v_cvt_pk_bf16_f32 v139, v128, v129
    ds_write_b64 v141, v[138:139] offset:2560
    v_fmac_f32 v154, v166, v166
    v_fmac_f32 v154, v167, v167
    v_fmac_f32 v154, v168, v168
    v_fmac_f32 v154, v169, v169
    v_cvt_pk_bf16_f32 v138, v154, v154
    v_cvt_pk_bf16_f32 v139, v154, v154
    ds_write_b64 v214, v[138:139] offset:15232
    ds_read_b64 v[138:139], v215 offset:2560
    s_waitcnt lgkmcnt(3)
    buffer_store_dwordx4 v[118:121], v217, s[56:59], 0 offen nt
    s_waitcnt lgkmcnt(1)
    s_barrier
    ds_read_b128 v[122:125], v157 offset:15232
    ds_read_b128 v[118:121], v157 offset:16256
    ds_read_b128 v[126:129], v157 offset:17280
    ds_read_b128 v[134:137], v157 offset:18304
    ds_read_b128 v[146:149], v234 offset:18432
    s_waitcnt lgkmcnt(5)
    buffer_store_dwordx2 v[138:139], v190, s[56:59], 0 offen nt
    s_waitcnt lgkmcnt(4)
    v_mfma_f32_16x16x32_bf16 v[150:153], v[32:35], v[122:125], 0
    s_waitcnt lgkmcnt(3)
    v_mfma_f32_16x16x32_bf16 v[150:153], v[32:35], v[118:121], v[150:153]
    s_waitcnt lgkmcnt(1)
    v_mfma_f32_16x16x32_bf16 v[118:121], v[32:35], v[126:129], 0
    s_waitcnt lgkmcnt(0)
    v_or3_b32 v146, v146, v147, v148
    v_or_b32 v146, v146, v149
    v_mfma_f32_16x16x32_bf16 v[118:121], v[32:35], v[134:137], v[118:121]
    v_cmp_gt_i32 s[46:47], 0, v146
    s_nop 0
    v_mul_f32 v190, 0x3baaaaab, v150
    v_rsq_f32 v190, v190
    s_nop 0
    v_mul_f32 v130, v190, v130
    v_mul_f32 v131, v190, v131
    v_cvt_pk_bf16_f32 v122, v130, v131
    v_mul_f32 v254, 0x3baaaaab, v118
    v_rsq_f32 v254, v254
    v_mul_f32 v132, v190, v132
    v_mul_f32 v170, v254, v170
    v_mul_f32 v171, v254, v171
    v_cvt_pk_bf16_f32 v118, v170, v171
    v_mul_f32 v172, v254, v172
    v_mul_f32 v173, v254, v173
    v_cvt_pk_bf16_f32 v119, v172, v173
    v_mul_f32 v174, v254, v174
    v_mul_f32 v175, v254, v175
    v_cvt_pk_bf16_f32 v120, v174, v175
    v_mul_f32 v176, v254, v176
    v_mul_f32 v177, v254, v177
    v_cvt_pk_bf16_f32 v121, v176, v177
    buffer_store_dwordx4 v[118:121], v216, s[12:15], 0 offen nt
    v_mul_f32 v114, v254, v114
    v_mul_f32 v115, v254, v115
    v_cvt_pk_bf16_f32 v138, v114, v115
    v_mul_f32 v116, v254, v116
    v_mul_f32 v117, v254, v117
    v_cvt_pk_bf16_f32 v139, v116, v117
    v_mul_f32 v133, v190, v133
    v_cvt_pk_bf16_f32 v123, v132, v133
    v_mul_f32 v142, v190, v142
    v_mul_f32 v143, v190, v143
    v_cvt_pk_bf16_f32 v124, v142, v143
    v_mul_f32 v144, v190, v144
    v_mul_f32 v145, v190, v145
    v_cvt_pk_bf16_f32 v125, v144, v145
    ds_write_b128 v140, v[122:125] offset:3072
    v_mul_f32 v166, v190, v166
    v_mul_f32 v167, v190, v167
    v_cvt_pk_bf16_f32 v166, v166, v167
    v_mul_f32 v168, v190, v168
    v_mul_f32 v169, v190, v169
    v_cvt_pk_bf16_f32 v167, v168, v169
    buffer_store_dwordx2 v[138:139], v255, s[12:15], 0 offen nt
    ds_read_b128 v[114:117], v191 offset:3072
    ds_write_b64 v141, v[166:167] offset:4096
    ds_read_b64 v[254:255], v215 offset:4096
    s_waitcnt lgkmcnt(2)
    buffer_store_dwordx4 v[114:117], v192, s[56:59], 0 offen nt
    s_waitcnt lgkmcnt(0)
    buffer_store_dwordx2 v[254:255], v193, s[56:59], 0 offen nt
    s_branch L_end
L_drain:
    ds_read_b128 v[118:121], v2 offset:18432
    ds_read_b128 v[122:125], v2 offset:19456
    s_nop 3
    ds_read_b128 v[134:137], v2 offset:0
    s_mul_i32 s5, s16, 9408
    s_mov_b32 s12, s40
    ds_read_b128 v[138:141], v2 offset:1024
    s_mov_b32 s13, s41
    s_cmp_ge_u32 s18, 2
    s_cselect_b32 s14, s36, 0
    ds_read_b128 v[142:145], v2 offset:2048
    s_add_u32 s5, s5, 104448
    s_and_b32 s6, s2, 7
    s_sub_u32 s6, 0, s6
    ds_read_b128 v[146:149], v2 offset:3072
    s_lshl_b32 s3, s16, 6
    s_lshl_b32 s4, s16, 5
    s_add_u32 s4, s4, 256
    ds_read_b128 v[150:153], v2 offset:4096
    ds_read_b128 v[162:165], v2 offset:5120
    v_bfe_u32 v254, v2, 4, 6
    v_lshrrev_b32 v255, 4, v254
    v_and_b32 v166, 15, v254
    v_lshlrev_b32 v167, 9, v255
    v_lshl_add_u32 v167, v166, 4, v167
    v_add_u32 v167, 149696, v167
    s_waitcnt lgkmcnt(7)
    v_mfma_f32_16x16x32_bf16 v[170:173], v[32:35], v[118:121], 0
    s_waitcnt lgkmcnt(5)
    v_xor_b32 v168, 65536, v2
    v_bfe_u32 v169, v166, 1, 2
    v_mfma_f32_16x16x32_bf16 v[170:173], v[32:35], v[122:125], v[170:173]
    s_waitcnt lgkmcnt(4)
    v_xor_b32 v169, v169, v255
    v_lshl_add_u32 v169, v166, 2, v169
    v_lshl_add_u32 v118, v169, 4, s5
    v_mfma_f32_16x16x32_bf16 v[122:125], a[216:219], v[134:137], 0
    s_waitcnt lgkmcnt(3)
    v_lshl_add_u32 v119, v169, 3, s5
    v_lshl_add_u32 v120, v254, 4, s5
    v_lshl_add_u32 v121, v254, 3, s5
    v_mfma_f32_16x16x32_bf16 v[122:125], a[220:223], v[138:141], v[122:125]
    s_waitcnt lgkmcnt(2)
    v_lshlrev_b32 v169, 2, v169
    v_mul_f32 v170, 0x3baaaaab, v170
    v_rsq_f32 v170, v170
    v_mfma_f32_16x16x32_bf16 v[122:125], a[224:227], v[142:145], v[122:125]
    s_waitcnt lgkmcnt(0)
    ds_permute_b32 v173, v169, v15
    ds_permute_b32 v174, v169, v18
    v_mul_f32 v178, v170, v178
    v_mfma_f32_16x16x32_bf16 v[122:125], a[228:231], v[146:149], v[122:125]
    ds_permute_b32 v175, v169, v16
    ds_permute_b32 v176, v169, v19
    v_mul_f32 v179, v170, v179
    v_mfma_f32_16x16x32_bf16 v[122:125], a[232:235], v[150:153], v[122:125]
    ds_permute_b32 v177, v169, v17
    ds_permute_b32 v182, v169, v20
    v_cvt_pk_bf16_f32 v178, v178, v179
    v_mfma_f32_16x16x32_bf16 v[122:125], a[236:239], v[162:165], v[122:125]
    v_mul_f32 v180, v170, v180
    v_mul_f32 v181, v170, v181
    v_cvt_pk_bf16_f32 v179, v180, v181
    v_mfma_f32_16x16x32_bf16 v[186:189], a[240:243], v[134:137], 0
    v_mul_f32 v198, v170, v198
    v_mul_f32 v199, v170, v199
    v_cvt_pk_bf16_f32 v180, v198, v199
    v_mfma_f32_16x16x32_bf16 v[186:189], a[244:247], v[138:141], v[186:189]
    v_mul_f32 v200, v170, v200
    v_mul_f32 v201, v170, v201
    v_cvt_pk_bf16_f32 v181, v200, v201
    v_mfma_f32_16x16x32_bf16 v[186:189], a[248:251], v[142:145], v[186:189]
    s_waitcnt lgkmcnt(4)
    ds_read_b128 v[190:193], v2 offset:6144
    v_mul_f32 v206, v170, v206
    v_mul_f32 v207, v170, v207
    v_mfma_f32_16x16x32_bf16 v[186:189], a[252:255], v[146:149], v[186:189]
    s_waitcnt lgkmcnt(3)
    ds_read_b128 v[194:197], v2 offset:7168
    v_cvt_pk_bf16_f32 v184, v206, v207
    v_mul_f32 v208, v170, v208
    v_mfma_f32_16x16x32_bf16 v[186:189], v[82:85], v[150:153], v[186:189]
    s_waitcnt lgkmcnt(2)
    ds_read_b128 v[198:201], v2 offset:8192
    v_mul_f32 v209, v170, v209
    v_cvt_pk_bf16_f32 v185, v208, v209
    v_mfma_f32_16x16x32_bf16 v[186:189], v[86:89], v[162:165], v[186:189]
    ds_read_b128 v[202:205], v2 offset:9216
    v_fma_f32 v169, v122, v122, s33
    v_fmac_f32 v169, v123, v123
    v_mfma_f32_16x16x32_bf16 v[206:209], v[90:93], v[134:137], 0
    ds_read_b128 v[134:137], v2 offset:10240
    v_fmac_f32 v169, v124, v124
    v_fmac_f32 v169, v125, v125
    v_mfma_f32_16x16x32_bf16 v[206:209], v[94:97], v[138:141], v[206:209]
    ds_read_b128 v[138:141], v2 offset:11264
    v_fmac_f32 v169, v186, v186
    v_fmac_f32 v169, v187, v187
    v_mfma_f32_16x16x32_bf16 v[206:209], v[98:101], v[142:145], v[206:209]
    s_waitcnt lgkmcnt(5)
    buffer_store_dwordx4 v[178:181], v15, s[12:15], s27 offen nt
    v_fmac_f32 v169, v188, v188
    v_fmac_f32 v169, v189, v189
    v_mul_f32 v183, 0x3baaaaab, v171
    v_mfma_f32_16x16x32_bf16 v[206:209], v[102:105], v[146:149], v[206:209]
    s_waitcnt lgkmcnt(4)
    v_rsq_f32 v183, v183
    v_sub_u32 v170, 0x40800000, v44
    v_mfma_f32_16x16x32_bf16 v[206:209], v[106:109], v[150:153], v[206:209]
    s_waitcnt lgkmcnt(3)
    v_mul_f32 v130, v183, v130
    v_mul_f32 v131, v183, v131
    v_cvt_pk_bf16_f32 v130, v130, v131
    v_mfma_f32_16x16x32_bf16 v[206:209], v[110:113], v[162:165], v[206:209]
    s_waitcnt lgkmcnt(2)
    v_mul_f32 v132, v183, v132
    v_mul_f32 v133, v183, v133
    v_cvt_pk_bf16_f32 v131, v132, v133
    v_mfma_f32_16x16x32_bf16 v[142:145], a[216:219], v[190:193], 0
    s_waitcnt lgkmcnt(1)
    v_mul_f32 v126, v183, v126
    v_mul_f32 v127, v183, v127
    v_fmac_f32 v169, v206, v206
    v_mfma_f32_16x16x32_bf16 v[142:145], a[220:223], v[194:197], v[142:145]
    s_waitcnt lgkmcnt(0)
    v_fmac_f32 v169, v207, v207
    v_fmac_f32 v169, v208, v208
    v_fmac_f32 v169, v209, v209
    v_mfma_f32_16x16x32_bf16 v[142:145], a[224:227], v[198:201], v[142:145]
    v_cvt_pk_bf16_f32 v132, v126, v127
    v_mul_f32 v128, v183, v128
    v_mul_f32 v129, v183, v129
    v_mfma_f32_16x16x32_bf16 v[142:145], a[228:231], v[202:205], v[142:145]
    v_cvt_pk_bf16_f32 v133, v128, v129
    v_mul_f32 v114, v183, v114
    v_mul_f32 v115, v183, v115
    v_mfma_f32_16x16x32_bf16 v[142:145], a[232:235], v[134:137], v[142:145]
    v_cvt_pk_bf16_f32 v114, v114, v115
    v_mul_f32 v116, v183, v116
    v_mul_f32 v117, v183, v117
    v_mfma_f32_16x16x32_bf16 v[142:145], a[236:239], v[138:141], v[142:145]
    v_cvt_pk_bf16_f32 v115, v116, v117
    v_or_b32 v170, v170, v44
    v_lshl_add_u32 v171, s16, 2, v168
    v_mfma_f32_16x16x32_bf16 v[126:129], a[240:243], v[190:193], 0
    ds_write_b32 v171, v170 offset:18432
    v_mul_f32 v183, 0x3baaaaab, v172
    v_mfma_f32_16x16x32_bf16 v[126:129], a[244:247], v[194:197], v[126:129]
    v_rsq_f32 v183, v183
    v_fma_f32 v116, v142, v142, s33
    v_mfma_f32_16x16x32_bf16 v[126:129], a[248:251], v[198:201], v[126:129]
    ds_read_b128 v[146:149], v2 offset:12288
    v_fmac_f32 v116, v143, v143
    v_fmac_f32 v116, v144, v144
    v_mfma_f32_16x16x32_bf16 v[126:129], a[252:255], v[202:205], v[126:129]
    ds_read_b128 v[150:153], v2 offset:13312
    v_fmac_f32 v116, v145, v145
    v_mul_f32 v242, v183, v242
    v_mfma_f32_16x16x32_bf16 v[126:129], v[82:85], v[134:137], v[126:129]
    ds_read_b128 v[162:165], v2 offset:14336
    v_mul_f32 v243, v183, v243
    v_cvt_pk_bf16_f32 v178, v242, v243
    v_mfma_f32_16x16x32_bf16 v[126:129], v[86:89], v[138:141], v[126:129]
    ds_read_b128 v[210:213], v2 offset:15360
    v_mul_f32 v244, v183, v244
    v_mul_f32 v245, v183, v245
    v_mfma_f32_16x16x32_bf16 v[214:217], v[90:93], v[190:193], 0
    ds_read_b128 v[190:193], v2 offset:16384
    v_cvt_pk_bf16_f32 v179, v244, v245
    v_mul_f32 v158, v183, v158
    v_mfma_f32_16x16x32_bf16 v[214:217], v[94:97], v[194:197], v[214:217]
    ds_read_b128 v[194:197], v2 offset:17408
    v_fmac_f32 v116, v126, v126
    v_fmac_f32 v116, v127, v127
    v_mfma_f32_16x16x32_bf16 v[214:217], v[98:101], v[198:201], v[214:217]
    s_waitcnt lgkmcnt(5)
    buffer_store_dwordx2 v[184:185], v18, s[12:15], s27 offen nt
    v_fmac_f32 v116, v128, v128
    v_mfma_f32_16x16x32_bf16 v[214:217], v[102:105], v[202:205], v[214:217]
    s_waitcnt lgkmcnt(4)
    v_fmac_f32 v116, v129, v129
    v_mul_f32 v159, v183, v159
    v_cvt_pk_bf16_f32 v180, v158, v159
    v_mfma_f32_16x16x32_bf16 v[214:217], v[106:109], v[134:137], v[214:217]
    s_waitcnt lgkmcnt(3)
    v_mul_f32 v160, v183, v160
    v_mul_f32 v161, v183, v161
    v_cvt_pk_bf16_f32 v181, v160, v161
    v_mfma_f32_16x16x32_bf16 v[214:217], v[110:113], v[138:141], v[214:217]
    s_waitcnt lgkmcnt(2)
    ds_write_b128 v118, v[178:181] offset:3072
    v_mfma_f32_16x16x32_bf16 v[134:137], a[216:219], v[146:149], 0
    s_waitcnt lgkmcnt(2)
    v_mul_f32 v154, v183, v154
    v_mul_f32 v155, v183, v155
    v_cvt_pk_bf16_f32 v154, v154, v155
    v_mfma_f32_16x16x32_bf16 v[134:137], a[220:223], v[150:153], v[134:137]
    s_waitcnt lgkmcnt(1)
    v_fmac_f32 v116, v214, v214
    v_fmac_f32 v116, v215, v215
    v_fmac_f32 v116, v216, v216
    v_mfma_f32_16x16x32_bf16 v[134:137], a[224:227], v[162:165], v[134:137]
    ds_read_b128 v[138:141], v120 offset:3072
    v_fmac_f32 v116, v217, v217
    v_cvt_pk_bf16_f32 v184, v169, v116
    v_mfma_f32_16x16x32_bf16 v[134:137], a[228:231], v[210:213], v[134:137]
    v_cvt_pk_bf16_f32 v185, v116, v116
    v_mul_f32 v156, v183, v156
    v_mul_f32 v157, v183, v157
    v_mfma_f32_16x16x32_bf16 v[134:137], a[232:235], v[190:193], v[134:137]
    ds_write_b64 v4, v[184:185] offset:0
    v_mfma_f32_16x16x32_bf16 v[134:137], a[236:239], v[194:197], v[134:137]
    v_cvt_pk_bf16_f32 v155, v156, v157
    v_mov_b32 v169, 0x40000000
    v_lshrrev_b32 v116, 2, v254
    v_mfma_f32_16x16x32_bf16 v[158:161], a[240:243], v[146:149], 0
    ds_write_b64 v119, v[154:155] offset:4096
    v_mfma_f32_16x16x32_bf16 v[158:161], a[244:247], v[150:153], v[158:161]
    v_lshrrev_b32 v117, 3, v254
    v_xor_b32 v117, v117, v254
    v_fma_f32 v254, v134, v134, s33
    v_mfma_f32_16x16x32_bf16 v[158:161], a[248:251], v[162:165], v[158:161]
    s_waitcnt lgkmcnt(2)
    ds_read_b128 v[154:157], v167 offset:0
    ds_read_b64 v[170:171], v121 offset:4096
    v_fmac_f32 v254, v135, v135
    v_mfma_f32_16x16x32_bf16 v[158:161], a[252:255], v[210:213], v[158:161]
    ds_read_b128 v[178:181], v167 offset:2048
    v_fmac_f32 v254, v136, v136
    v_fmac_f32 v254, v137, v137
    v_mfma_f32_16x16x32_bf16 v[158:161], v[82:85], v[190:193], v[158:161]
    s_waitcnt lgkmcnt(4)
    ds_read_b128 v[198:201], v167 offset:4096
    v_and_b32 v117, 3, v117
    v_add_u32 v116, 0, v116
    v_mfma_f32_16x16x32_bf16 v[158:161], v[86:89], v[194:197], v[158:161]
    s_barrier
    ds_read_b128 v[202:205], v168 offset:0
    ds_read_b128 v[218:221], v168 offset:1024
    v_mul_u32_u24 v172, s20, v116
    v_mfma_f32_16x16x32_bf16 v[222:225], v[90:93], v[146:149], 0
    ds_read_b128 v[146:149], v167 offset:6144
    ds_read_b128 v[226:229], v167 offset:8192
    v_add_u32 v172, s38, v172
    v_mfma_f32_16x16x32_bf16 v[222:225], v[94:97], v[150:153], v[222:225]
    ds_read_b128 v[150:153], v167 offset:10240
    v_fmac_f32 v254, v158, v158
    v_fmac_f32 v254, v159, v159
    v_mfma_f32_16x16x32_bf16 v[222:225], v[98:101], v[162:165], v[222:225]
    s_waitcnt lgkmcnt(7)
    buffer_store_dwordx4 v[130:133], v16, s[12:15], s27 offen nt
    ds_read_b128 v[162:165], v168 offset:18432
    v_fmac_f32 v254, v160, v160
    v_fmac_f32 v254, v161, v161
    v_mfma_f32_16x16x32_bf16 v[222:225], v[102:105], v[210:213], v[222:225]
    s_waitcnt lgkmcnt(7)
    v_mul_u32_u24 v183, 911, v172
    v_lshrrev_b32 v183, 16, v183
    v_mul_u32_u24 v183, s22, v183
    v_mfma_f32_16x16x32_bf16 v[222:225], v[106:109], v[190:193], v[222:225]
    s_waitcnt lgkmcnt(6)
    v_mad_u32_u24 v183, v116, s21, v183
    v_bfe_u32 v172, s70, v116, 1
    v_cmp_ne_u32 vcc, 0, v172
    v_mfma_f32_16x16x32_bf16 v[222:225], v[110:113], v[194:197], v[222:225]
    s_waitcnt lgkmcnt(4)
    v_add_u32 v116, s7, v183
    v_cndmask_b32 v116, v169, v116, vcc
    v_mfma_f32_16x16x32_bf16 v[130:133], v[32:35], v[202:205], 0
    s_waitcnt lgkmcnt(2)
    v_lshl_add_u32 v172, v117, 4, v116
    v_add_u32 v172, s3, v172
    v_mfma_f32_16x16x32_bf16 v[130:133], v[32:35], v[218:221], v[130:133]
    s_waitcnt lgkmcnt(1)
    v_fmac_f32 v254, v222, v222
    v_fmac_f32 v254, v223, v223
    v_fmac_f32 v254, v224, v224
    v_mfma_f32_16x16x32_bf16 v[190:193], a[216:219], v[154:157], 0
    v_fmac_f32 v254, v225, v225
    v_cvt_pk_bf16_f32 v184, v254, v254
    v_cvt_pk_bf16_f32 v185, v254, v254
    v_mfma_f32_16x16x32_bf16 v[190:193], a[220:223], v[178:181], v[190:193]
    s_waitcnt lgkmcnt(0)
    ds_write_b64 v4, v[184:185] offset:2048
    v_mfma_f32_16x16x32_bf16 v[190:193], a[224:227], v[198:201], v[190:193]
    v_lshl_add_u32 v254, v117, 3, v116
    v_add_u32 v254, s4, v254
    v_add_u32 v166, 16, v166
    v_mfma_f32_16x16x32_bf16 v[190:193], a[228:231], v[146:149], v[190:193]
    v_min_u32 v116, 20, v166
    v_add_u32 v132, 12, v166
    v_lshrrev_b32 v132, 5, v132
    v_mfma_f32_16x16x32_bf16 v[190:193], a[232:235], v[226:229], v[190:193]
    v_sub_u32 v133, v166, v116
    v_mad_i32_i24 v133, v132, s6, v133
    v_mul_u32_u24 v117, s20, v116
    v_mfma_f32_16x16x32_bf16 v[190:193], a[236:239], v[150:153], v[190:193]
    v_add3_u32 v117, v117, v133, s38
    v_mul_u32_u24 v132, 911, v117
    v_lshrrev_b32 v132, 16, v132
    v_mfma_f32_16x16x32_bf16 v[194:197], a[240:243], v[154:157], 0
    v_mul_u32_u24 v132, s22, v132
    v_mad_u32_u24 v132, v116, s21, v132
    v_bfe_u32 v117, s70, v166, 1
    v_mfma_f32_16x16x32_bf16 v[194:197], a[244:247], v[178:181], v[194:197]
    buffer_store_dwordx2 v[114:115], v19, s[12:15], s27 offen nt
    v_fma_f32 v166, v190, v190, s33
    v_mfma_f32_16x16x32_bf16 v[194:197], a[248:251], v[198:201], v[194:197]
    ds_read_b128 v[202:205], v167 offset:256
    v_fmac_f32 v166, v191, v191
    v_fmac_f32 v166, v192, v192
    v_mfma_f32_16x16x32_bf16 v[194:197], a[252:255], v[146:149], v[194:197]
    ds_read_b128 v[210:213], v167 offset:2304
    v_fmac_f32 v166, v193, v193
    v_cmp_ne_u32 vcc, 0, v117
    v_mfma_f32_16x16x32_bf16 v[194:197], v[82:85], v[226:229], v[194:197]
    ds_read_b128 v[114:117], v167 offset:4352
    v_mul_i32_i24 v133, 2688, v133
    v_add3_u32 v132, v132, v133, s7
    v_mfma_f32_16x16x32_bf16 v[194:197], v[86:89], v[150:153], v[194:197]
    ds_read_b128 v[218:221], v167 offset:6400
    v_cndmask_b32 v132, v169, v132, vcc
    v_lshl_add_u32 v169, v255, 4, v132
    v_mfma_f32_16x16x32_bf16 v[230:233], v[90:93], v[154:157], 0
    ds_read_b128 v[154:157], v167 offset:8448
    v_add_u32 v169, s3, v169
    v_lshl_add_u32 v255, v255, 3, v132
    v_mfma_f32_16x16x32_bf16 v[230:233], v[94:97], v[178:181], v[230:233]
    ds_read_b128 v[178:181], v167 offset:10496
    v_fmac_f32 v166, v194, v194
    v_fmac_f32 v166, v195, v195
    v_mfma_f32_16x16x32_bf16 v[230:233], v[98:101], v[198:201], v[230:233]
    s_waitcnt lgkmcnt(5)
    v_fmac_f32 v166, v196, v196
    v_fmac_f32 v166, v197, v197
    v_add_u32 v255, s4, v255
    v_mfma_f32_16x16x32_bf16 v[230:233], v[102:105], v[146:149], v[230:233]
    s_waitcnt lgkmcnt(4)
    v_mul_f32 v167, 0x3baaaaab, v130
    v_mul_f32 v183, 0x3baaaaab, v131
    v_rsq_f32 v167, v167
    v_mfma_f32_16x16x32_bf16 v[230:233], v[106:109], v[226:229], v[230:233]
    s_waitcnt lgkmcnt(3)
    v_mul_f32 v122, v167, v122
    v_mul_f32 v123, v167, v123
    v_cvt_pk_bf16_f32 v122, v122, v123
    v_mfma_f32_16x16x32_bf16 v[230:233], v[110:113], v[150:153], v[230:233]
    s_waitcnt lgkmcnt(2)
    v_mul_f32 v124, v167, v124
    v_mul_f32 v125, v167, v125
    v_cvt_pk_bf16_f32 v123, v124, v125
    v_mfma_f32_16x16x32_bf16 v[130:133], a[216:219], v[202:205], 0
    s_waitcnt lgkmcnt(1)
    v_mul_f32 v186, v167, v186
    v_mul_f32 v187, v167, v187
    v_fmac_f32 v166, v230, v230
    v_mfma_f32_16x16x32_bf16 v[130:133], a[220:223], v[210:213], v[130:133]
    s_waitcnt lgkmcnt(0)
    v_fmac_f32 v166, v231, v231
    v_fmac_f32 v166, v232, v232
    v_fmac_f32 v166, v233, v233
    v_mfma_f32_16x16x32_bf16 v[130:133], a[224:227], v[114:117], v[130:133]
    buffer_store_dwordx4 v[138:141], v177, s[12:15], s27 offen nt
    v_cvt_pk_bf16_f32 v184, v166, v166
    v_cvt_pk_bf16_f32 v185, v166, v166
    v_cvt_pk_bf16_f32 v124, v186, v187
    v_mfma_f32_16x16x32_bf16 v[130:133], a[228:231], v[218:221], v[130:133]
    ds_write_b64 v4, v[184:185] offset:4096
    v_mfma_f32_16x16x32_bf16 v[130:133], a[232:235], v[154:157], v[130:133]
    v_mul_f32 v188, v167, v188
    v_mul_f32 v189, v167, v189
    v_cvt_pk_bf16_f32 v125, v188, v189
    v_mfma_f32_16x16x32_bf16 v[130:133], a[236:239], v[178:181], v[130:133]
    ds_write_b128 v118, v[122:125] offset:4608
    v_mfma_f32_16x16x32_bf16 v[122:125], a[240:243], v[202:205], 0
    buffer_store_dwordx2 v[170:171], v182, s[12:15], s27 offen nt
    v_mul_f32 v206, v167, v206
    v_mfma_f32_16x16x32_bf16 v[122:125], a[244:247], v[210:213], v[122:125]
    s_mov_b32 s14, s36
    v_mul_f32 v207, v167, v207
    v_cvt_pk_bf16_f32 v166, v206, v207
    v_fma_f32 v184, v130, v130, s33
    v_mfma_f32_16x16x32_bf16 v[122:125], a[248:251], v[114:117], v[122:125]
    ds_read_b128 v[138:141], v120 offset:4608
    v_fmac_f32 v184, v131, v131
    v_fmac_f32 v184, v132, v132
    v_mfma_f32_16x16x32_bf16 v[122:125], a[252:255], v[218:221], v[122:125]
    s_waitcnt lgkmcnt(2)
    v_fmac_f32 v184, v133, v133
    v_mul_f32 v208, v167, v208
    v_mul_f32 v209, v167, v209
    v_mfma_f32_16x16x32_bf16 v[122:125], v[82:85], v[154:157], v[122:125]
    s_barrier
    ds_read_b128 v[146:149], v168 offset:2048
    ds_read_b128 v[150:153], v168 offset:3072
    v_cvt_pk_bf16_f32 v167, v208, v209
    v_mfma_f32_16x16x32_bf16 v[122:125], v[86:89], v[178:181], v[122:125]
    ds_read_b128 v[186:189], v168 offset:4096
    ds_read_b128 v[198:201], v168 offset:5120
    v_rsq_f32 v183, v183
    v_mfma_f32_16x16x32_bf16 v[206:209], v[90:93], v[202:205], 0
    ds_write_b64 v119, v[166:167] offset:5632
    v_mfma_f32_16x16x32_bf16 v[206:209], v[94:97], v[210:213], v[206:209]
    v_mul_f32 v142, v183, v142
    v_mul_f32 v143, v183, v143
    v_fmac_f32 v184, v122, v122
    v_mfma_f32_16x16x32_bf16 v[206:209], v[98:101], v[114:117], v[206:209]
    s_waitcnt lgkmcnt(5)
    buffer_store_dwordx4 v[138:141], v173, s[12:15], s26 offen nt
    ds_read_b64 v[166:167], v121 offset:5632
    v_fmac_f32 v184, v123, v123
    v_fmac_f32 v184, v124, v124
    v_mfma_f32_16x16x32_bf16 v[206:209], v[102:105], v[218:221], v[206:209]
    v_fmac_f32 v184, v125, v125
    v_cvt_pk_bf16_f32 v114, v142, v143
    v_mul_f32 v144, v183, v144
    v_mfma_f32_16x16x32_bf16 v[206:209], v[106:109], v[154:157], v[206:209]
    s_waitcnt lgkmcnt(4)
    v_mul_f32 v145, v183, v145
    v_cvt_pk_bf16_f32 v115, v144, v145
    v_mfma_f32_16x16x32_bf16 v[138:141], v[32:35], v[146:149], 0
    s_waitcnt lgkmcnt(2)
    v_mul_f32 v126, v183, v126
    v_mul_f32 v127, v183, v127
    v_mfma_f32_16x16x32_bf16 v[138:141], v[32:35], v[150:153], v[138:141]
    v_cvt_pk_bf16_f32 v116, v126, v127
    v_mul_f32 v128, v183, v128
    v_mfma_f32_16x16x32_bf16 v[142:145], v[32:35], v[186:189], 0
    v_mul_f32 v129, v183, v129
    v_cvt_pk_bf16_f32 v117, v128, v129
    v_mfma_f32_16x16x32_bf16 v[142:145], v[32:35], v[198:201], v[142:145]
    ds_write_b128 v118, v[114:117] offset:6144
    v_mfma_f32_16x16x32_bf16 v[206:209], v[110:113], v[178:181], v[206:209]
    s_waitcnt lgkmcnt(1)
    buffer_store_dwordx2 v[166:167], v174, s[12:15], s26 offen nt
    v_mul_f32 v214, v183, v214
    v_mul_f32 v215, v183, v215
    v_cvt_pk_bf16_f32 v166, v214, v215
    ds_read_b128 v[114:117], v120 offset:6144
    v_mul_f32 v216, v183, v216
    v_mul_f32 v217, v183, v217
    v_fmac_f32 v184, v206, v206
    v_fmac_f32 v184, v207, v207
    v_fmac_f32 v184, v208, v208
    v_fmac_f32 v184, v209, v209
    v_cvt_pk_bf16_f32 v214, v184, v184
    v_cvt_pk_bf16_f32 v215, v184, v184
    ds_write_b64 v4, v[214:215] offset:6144
    v_cvt_pk_bf16_f32 v167, v216, v217
    v_mul_f32 v174, 0x3baaaaab, v138
    v_rsq_f32 v174, v174
    ds_write_b64 v119, v[166:167] offset:7168
    v_mul_f32 v134, v174, v134
    v_mul_f32 v135, v174, v135
    v_cvt_pk_bf16_f32 v126, v134, v135
    ds_read_b64 v[166:167], v121 offset:7168
    s_waitcnt lgkmcnt(3)
    buffer_store_dwordx4 v[114:117], v175, s[12:15], s26 offen nt
    v_mul_f32 v136, v174, v136
    v_mul_f32 v137, v174, v137
    v_cvt_pk_bf16_f32 v127, v136, v137
    v_mul_f32 v158, v174, v158
    v_mul_f32 v159, v174, v159
    v_cvt_pk_bf16_f32 v128, v158, v159
    v_mul_f32 v160, v174, v160
    s_waitcnt lgkmcnt(2)
    s_barrier
    ds_read_b128 v[114:117], v168 offset:6144
    ds_read_b128 v[134:137], v168 offset:7168
    v_mul_f32 v161, v174, v161
    v_cvt_pk_bf16_f32 v129, v160, v161
    ds_write_b128 v118, v[126:129] offset:0
    v_mul_f32 v222, v174, v222
    v_mul_f32 v223, v174, v223
    v_cvt_pk_bf16_f32 v222, v222, v223
    v_mul_f32 v224, v174, v224
    s_waitcnt lgkmcnt(3)
    buffer_store_dwordx2 v[166:167], v176, s[12:15], s26 offen nt
    ds_read_b128 v[126:129], v120 offset:0
    v_mul_f32 v225, v174, v225
    v_cvt_pk_bf16_f32 v223, v224, v225
    ds_write_b64 v119, v[222:223] offset:1024
    s_waitcnt lgkmcnt(4)
    v_mfma_f32_16x16x32_bf16 v[138:141], v[32:35], v[114:117], 0
    s_waitcnt lgkmcnt(3)
    v_mul_f32 v166, 0x3baaaaab, v142
    v_or3_b32 v162, v162, v163, v164
    v_mfma_f32_16x16x32_bf16 v[138:141], v[32:35], v[134:137], v[138:141]
    ds_read_b64 v[170:171], v121 offset:1024
    v_rsq_f32 v166, v166
    v_or_b32 v162, v162, v165
    v_mul_f32 v190, v166, v190
    v_mul_f32 v191, v166, v191
    v_cvt_pk_bf16_f32 v114, v190, v191
    v_mul_f32 v192, v166, v192
    v_mul_f32 v193, v166, v193
    v_cvt_pk_bf16_f32 v115, v192, v193
    v_mul_f32 v194, v166, v194
    v_mul_f32 v195, v166, v195
    v_cvt_pk_bf16_f32 v116, v194, v195
    s_waitcnt lgkmcnt(2)
    buffer_store_dwordx4 v[126:129], v177, s[12:15], s26 offen nt
    v_mul_f32 v196, v166, v196
    v_mul_f32 v197, v166, v197
    v_cvt_pk_bf16_f32 v117, v196, v197
    ds_write_b128 v118, v[114:117] offset:1536
    v_mul_f32 v230, v166, v230
    s_waitcnt lgkmcnt(1)
    v_mul_f32 v231, v166, v231
    v_cvt_pk_bf16_f32 v230, v230, v231
    v_mul_f32 v232, v166, v232
    v_mul_f32 v233, v166, v233
    buffer_store_dwordx2 v[170:171], v182, s[12:15], s26 offen nt
    ds_read_b128 v[114:117], v120 offset:1536
    v_cvt_pk_bf16_f32 v231, v232, v233
    ds_write_b64 v119, v[230:231] offset:2560
    v_mul_f32 v163, 0x3baaaaab, v138
    v_rsq_f32 v163, v163
    ds_read_b64 v[164:165], v121 offset:2560
    v_mul_f32 v130, v163, v130
    v_mul_f32 v131, v163, v131
    v_cvt_pk_bf16_f32 v118, v130, v131
    v_mul_f32 v132, v163, v132
    v_mul_f32 v133, v163, v133
    v_cvt_pk_bf16_f32 v119, v132, v133
    v_mul_f32 v122, v163, v122
    v_mul_f32 v123, v163, v123
    v_cvt_pk_bf16_f32 v120, v122, v123
    v_mul_f32 v124, v163, v124
    v_mul_f32 v125, v163, v125
    v_cvt_pk_bf16_f32 v121, v124, v125
    buffer_store_dwordx4 v[118:121], v169, s[12:15], 0 offen nt
    s_waitcnt lgkmcnt(2)
    v_mul_f32 v206, v163, v206
    v_mul_f32 v207, v163, v207
    v_cvt_pk_bf16_f32 v170, v206, v207
    v_mul_f32 v208, v163, v208
    v_mul_f32 v209, v163, v209
    v_cvt_pk_bf16_f32 v171, v208, v209
    v_cmp_gt_i32 s[46:47], 0, v162
    s_waitcnt lgkmcnt(0)
    buffer_store_dwordx4 v[114:117], v172, s[12:15], 0 offen nt
    buffer_store_dwordx2 v[164:165], v254, s[12:15], 0 offen nt
    buffer_store_dwordx2 v[170:171], v255, s[12:15], 0 offen nt
    s_branch L_end
.section .rodata,"a"
.p2align 6
.amdhsa_kernel standalone__window_attn_swin_v2__vision_kernel
  .amdhsa_next_free_vgpr 512
  .amdhsa_next_free_sgpr 102
  .amdhsa_accum_offset 256
  .amdhsa_group_segment_fixed_size 0
  .amdhsa_kernarg_size 96
  .amdhsa_user_sgpr_count 2
  .amdhsa_user_sgpr_kernarg_segment_ptr 1
  .amdhsa_system_sgpr_workgroup_id_x 1
  .amdhsa_float_denorm_mode_32 3
.end_amdhsa_kernel
```

```asm
; @launch grid=(256,1,1) block=(256,1,1) lds=163840
.amdgcn_target "amdgcn-amd-amdhsa--gfx950"
.text
.globl standalone__window_attn_swin_v2__vision_kernel
.p2align 12
.p2align 8
.type standalone__window_attn_swin_v2__vision_kernel,@function
standalone__window_attn_swin_v2__vision_kernel:
    s_mov_b32 s44, 0
L_again:
    s_load_dwordx16 s[76:91], s[0:1], 0
    v_readfirstlane_b32 s16, v0
    s_cmp_ge_u32 s2, 256
    s_cbranch_scc1 L_done
    s_lshr_b32 s16, s16, 6
    s_cbranch_scc1 L_nopf
    s_getpc_b64 s[96:97]
    s_bfe_u32 s3, s2, 0x30003
    s_mul_i32 s3, s3, 44
    v_cmp_gt_u32 vcc, 20, v0
    v_add_u32 v114, s3, v0
    v_mov_b32 v115, 0
    v_cndmask_b32 v114, v114, v0, vcc
    v_lshlrev_b32 v114, 7, v114
    v_lshl_add_u64 v[114:115], s[96:97], 0, v[114:115]
    global_load_dword a255, v[114:115], off offset:992
L_nopf:
    s_max_u32 s3, s2, s44
    s_cmp_ge_u32 s3, 247
    s_cbranch_scc1 L_edge
    v_mov_b32 v114, v0
    v_mov_b32 v115, 0x40000000
    v_and_b32 v254, 63, v0
    s_bfe_u32 s3, s2, 0x50003
    s_lshl_b32 s4, s16, 3
    s_lshr_b32 s98, 0x06143a01, s4
    s_and_b32 s98, s98, 0xff
    s_mul_i32 s3, s3, s98
    s_sub_u32 s98, s98, 1
    s_lshr_b32 s4, 0x0048d800, s4
    s_and_b32 s4, s4, 0xff
    s_lshl_b32 s4, s4, 3
    s_max_u32 s4, s4, 6
    s_sub_u32 s4, s4, s98
    s_sub_u32 s4, s4, 1
    s_min_u32 s3, s3, s4
    v_min_u32 v126, s98, v254
    v_add_lshl_u32 v126, v126, s3, 7
    v_mov_b32 v127, 0
    v_lshrrev_b32 v255, 4, v254
    v_and_b32 v128, 15, v254
    s_mov_b32 s10, 100270464
    s_mov_b32 s11, 0x00020000
    s_mov_b32 s50, 36096
    s_mov_b32 s51, 0x00020000
    s_mul_i32 s3, s16, 96
    v_lshl_add_u32 v129, v254, 4, s3
    v_mul_u32_u24 v130, 171, v254
    v_lshrrev_b32 v130, 10, v130
    v_lshrrev_b32 v131, 1, v130
    v_xor_b32 v131, v131, v130
    v_and_b32 v131, 4, v131
    v_mul_u32_u24 v131, 3, v131
    v_xor_b32 v131, v131, v130
    v_mul_u32_u24 v131, 1152, v131
    v_mul_u32_u24 v132, 96, v130
    v_sub_u32 v131, v131, v132
    v_add_u32 v132, v129, v131
    v_add_u32 v131, 64, v254
    v_mul_u32_u24 v131, 171, v131
    v_lshrrev_b32 v131, 10, v131
    v_lshrrev_b32 v133, 1, v131
    v_xor_b32 v133, v133, v131
    v_and_b32 v133, 4, v133
    v_mul_u32_u24 v133, 3, v133
    v_xor_b32 v133, v133, v131
    v_mul_u32_u24 v133, 1152, v133
    v_mul_u32_u24 v150, 96, v131
    v_sub_u32 v133, v133, v150
    v_add_u32 v150, v129, v133
    v_add_u32 v133, 128, v254
    v_mul_u32_u24 v133, 171, v133
    v_lshrrev_b32 v133, 10, v133
    v_lshrrev_b32 v151, 1, v133
    v_xor_b32 v151, v151, v133
    v_and_b32 v151, 4, v151
    v_mul_u32_u24 v151, 3, v151
    v_xor_b32 v151, v151, v133
    v_mul_u32_u24 v151, 1152, v151
    v_mul_u32_u24 v152, 96, v133
    v_sub_u32 v151, v151, v152
    v_add_u32 v152, v129, v151
    s_mul_i32 s68, s16, 6144
    s_add_u32 s69, s68, 65536
    s_cmp_eq_u32 s16, 3
    s_cselect_b32 s68, 149696, s68
    s_cselect_b32 s69, 155840, s69
    s_waitcnt lgkmcnt(0)
    s_cmp_eq_u32 s16, 2
    s_cselect_b64 s[98:99], s[80:81], s[78:79]
    s_cmp_eq_u32 s16, 3
    s_cselect_b64 s[98:99], s[88:89], s[98:99]
    s_mov_b64 s[8:9], s[76:77]
    v_lshl_add_u64 v[126:127], s[98:99], 0, v[126:127]
    s_cmp_eq_u32 s16, 2
    s_cselect_b64 s[98:99], s[84:85], s[82:83]
    s_cmp_eq_u32 s16, 3
    s_cselect_b64 s[98:99], s[86:87], s[98:99]
    v_writelane_b32 v126, s98, 63
    v_writelane_b32 v127, s99, 63
    s_cmp_eq_u32 s16, 0
    s_cbranch_scc1 L_nowu
    global_load_dword a254, v[126:127], off
L_nowu:
    s_mov_b64 s[48:49], s[78:79]
    s_mov_b64 s[52:53], s[80:81]
    s_mov_b64 s[60:61], s[84:85]
    s_mov_b64 s[64:65], s[86:87]
    s_mov_b64 s[56:57], s[88:89]
    s_mov_b64 s[46:47], s[82:83]
    s_load_dwordx4 s[40:43], s[0:1], 72
    s_add_u32 s48, s48, 384
    s_addc_u32 s49, s49, 0
    s_add_u32 m0, s68, 0
    v_lshlrev_b32 v151, 1, v255
    s_mov_b32 s54, 12288
    s_mov_b32 s55, 0x00020000
    s_mov_b32 s62, 64
    s_mov_b32 s63, 0x00020000
    s_mov_b32 s66, 128
    s_mov_b32 s67, 0x00020000
    s_mov_b32 s58, 676
    s_mov_b32 s59, 0x00020000
    s_mov_b32 s14, 0
    s_mov_b32 s15, 0x00020000
    s_mul_i32 s90, s16, 16
    v_mov_b32 v117, 0
    v_cmp_lt_u32 s[92:93], 7, v128
    v_mov_b32 v127, 0
    v_mov_b32 v129, 0
    v_mov_b32 v119, 0
    v_lshlrev_b32 v153, 1, v254
    v_mul_u32_u24 v126, 12, v128
    s_mul_i32 s71, s16, 192
    v_add_u32 v126, s71, v126
    v_lshlrev_b32 v120, 5, v255
    s_mul_i32 s72, s16, 9408
    s_add_u32 s72, s72, 104448
    s_mul_i32 s73, s16, 7616
    s_add_u32 s73, s73, 38912
    s_cmp_eq_u32 s16, 3
    s_cselect_b32 s73, 142080, s73
    s_mov_b32 s70, 193536
    s_mov_b32 s36, 100270464
    s_mov_b32 s22, 1180032
    s_mul_i32 s3, s2, 911
    s_lshr_b32 s3, s3, 16
    s_mul_i32 s35, s3, 72
    s_sub_u32 s38, s2, s35
    s_mul_i32 s3, s3, 1373568
    s_mul_i32 s35, s38, 2688
    s_add_u32 s3, s3, s35
    s_add_u32 s25, s3, 589824
    s_add_u32 s7, s3, 1769472
    s_mov_b32 s20, 31
    s_mov_b32 s21, 4204032
    s_mov_b32 s17, 20
    s_cmp_lt_u32 s2, 240
    s_cselect_b32 s45, 28, 24
    s_bfm_b32 s34, s45, 0
    s_and_b32 s4, s2, 7
    s_sub_u32 s4, 0, s4
    s_lshl_b32 s28, s16, 10
    s_add_u32 s28, s28, 20480
    s_mov_b32 s76, 0x3f80
    s_mul_i32 s79, s16, 64
    s_mul_i32 s80, s16, 32
    s_add_u32 s80, s80, 256
    s_mul_i32 s81, s16, 768
    s_add_u32 s81, s81, 98304
    s_mov_b32 s82, -24
    s_lshr_b32 s83, s16, 1
    s_and_b32 s84, s16, 1
    s_lshl_b32 s84, s84, 3
    s_lshl_b32 s85, s83, 10
    s_add_u32 s85, s85, s84
    s_lshl_b32 s83, s83, 11
    s_add_u32 s83, s83, s84
    s_add_u32 s83, s83, 157888
    s_mul_i32 s86, s16, 2048
    s_add_u32 s86, s86, 149696
    s_mul_i32 s87, s16, 128
    s_add_u32 s87, s87, 61760
    s_mov_b32 s32, 0x2a8cbccc
    s_mov_b32 s33, 0x38fba882
    s_add_u32 s75, s28, 16384
    s_cmp_lt_u32 s16, 2
    s_cselect_b32 s29, s75, 161984
    s_cselect_b32 s30, 65536, 0
    s_xor_b32 s74, s29, s30
    s_mul_i32 s77, s16, 64
    s_mul_i32 s78, s16, 32
    s_add_u32 s78, s78, 192
    buffer_load_dwordx4 v132, s[48:51], 0 offen lds
    v_mul_u32_u24 v116, 2731, v114
    v_bfe_u32 v118, v116, 17, 3
    v_lshrrev_b32 v116, 16, v116
    buffer_load_dwordx4 v150, s[48:51], 0 offen offset:1024 lds
    v_xor_b32 v121, v118, v114
    v_mul_u32_u24 v118, 37, v116
    v_lshrrev_b32 v118, 8, v118
    buffer_load_dwordx4 v152, s[48:51], 0 offen offset:2048 lds
    s_add_u32 m0, s28, 65536
    s_add_u32 s48, s48, 36864
    s_addc_u32 s49, s49, 0
    v_lshlrev_b32 v121, 4, v121
    v_mad_u32_u24 v10, v118, s70, v121
    v_mul_u32_u24 v118, s20, v116
    v_add_u32 v118, s38, v118
    v_mul_u32_u24 v122, 911, v118
    v_lshrrev_b32 v122, 16, v122
    v_mul_u32_u24 v122, s22, v122
    v_mad_u32_u24 v122, v116, s21, v122
    v_bfe_u32 v118, s34, v116, 1
    v_cmp_ne_u32 vcc, 0, v118
    v_add_u32 v118, s7, v122
    v_mul_u32_u24 v116, 384, v116
    v_cndmask_b32 v118, v115, v118, vcc
    v_sub_u32 v116, v121, v116
    v_add_u32 v118, v118, v116
    buffer_load_dwordx4 v118, s[8:11], 0 offen nt lds
    s_add_u32 m0, s28, 69632
    v_add_u32 v116, 256, v114
    v_mul_u32_u24 v118, 2731, v116
    v_bfe_u32 v121, v118, 17, 3
    v_lshrrev_b32 v118, 16, v118
    v_xor_b32 v116, v121, v116
    v_mul_u32_u24 v121, 37, v118
    v_lshrrev_b32 v121, 8, v121
    v_lshlrev_b32 v116, 4, v116
    v_mad_u32_u24 v11, v121, s70, v116
    v_min_u32 v121, 20, v118
    v_add_u32 v122, 12, v118
    v_lshrrev_b32 v122, 5, v122
    v_sub_u32 v123, v118, v121
    v_mad_i32_i24 v123, v122, s4, v123
    v_mul_u32_u24 v124, s20, v121
    v_add3_u32 v124, v124, v123, s38
    v_mul_u32_u24 v122, 911, v124
    v_lshrrev_b32 v122, 16, v122
    v_mul_u32_u24 v122, s22, v122
    v_mad_u32_u24 v122, v121, s21, v122
    v_bfe_u32 v124, s34, v118, 1
    v_cmp_ne_u32 vcc, 0, v124
    v_mul_i32_i24 v123, 2688, v123
    v_add3_u32 v121, v122, v123, s7
    v_cndmask_b32 v121, v115, v121, vcc
    v_mul_u32_u24 v118, 384, v118
    v_sub_u32 v118, v116, v118
    v_add_u32 v121, v121, v118
    buffer_load_dwordx4 v121, s[8:11], 0 offen lds
    s_add_u32 m0, s28, 73728
    v_add_u32 v116, 512, v114
    v_mul_u32_u24 v118, 2731, v116
    v_bfe_u32 v121, v118, 17, 3
    v_lshrrev_b32 v118, 16, v118
    v_xor_b32 v116, v121, v116
    v_mul_u32_u24 v121, 37, v118
    v_lshrrev_b32 v121, 8, v121
    v_lshlrev_b32 v116, 4, v116
    v_mad_u32_u24 v12, v121, s70, v116
    v_min_u32 v121, 20, v118
    v_add_u32 v122, 12, v118
    v_lshrrev_b32 v122, 5, v122
    v_sub_u32 v123, v118, v121
    v_mad_i32_i24 v123, v122, s4, v123
    v_mul_u32_u24 v124, s20, v121
    v_add3_u32 v124, v124, v123, s38
    v_mul_u32_u24 v122, 911, v124
    v_lshrrev_b32 v122, 16, v122
    v_mul_u32_u24 v122, s22, v122
    v_mad_u32_u24 v122, v121, s21, v122
    v_bfe_u32 v124, s34, v118, 1
    v_cmp_ne_u32 vcc, 0, v124
    v_mul_i32_i24 v123, 2688, v123
    v_add3_u32 v121, v122, v123, s7
    v_cndmask_b32 v121, v115, v121, vcc
    v_mul_u32_u24 v118, 384, v118
    v_sub_u32 v118, v116, v118
    v_add_u32 v121, v121, v118
    buffer_load_dwordx4 v121, s[8:11], 0 offen lds
    s_add_u32 m0, s68, 3072
    v_lshrrev_b32 v116, 2, v128
    v_and_b32 v121, 1, v116
    v_mul_u32_u24 v121, 0x020202, v121
    v_lshl_or_b32 v121, v121, 8, v121
    v_add_u32 v121, 0x05040100, v121
    v_and_b32 v118, 3, v128
    v_lshrrev_b32 v122, 1, v128
    v_xor_b32 v122, v122, v255
    v_mul_u32_u24 v123, 384, v128
    v_lshl_add_u32 v0, v122, 4, v123
    v_xor_b32 v1, 64, v0
    v_and_b32 v122, 2, v255
    v_add_u32 v122, v122, v255
    v_lshl_add_u32 v122, v122, 2, v116
    v_mul_u32_u24 v122, 96, v122
    v_lshl_add_u32 v122, v118, 3, v122
    v_add_u32 v123, s68, v122
    buffer_load_dwordx4 v132, s[48:51], 0 offen lds
    v_add_u32 v124, s69, v122
    v_add_u32 v125, s72, v122
    v_add_u32 v122, s73, v122
    v_mov_b32 v28, 0x3f803f80
    v_mov_b32 v29, 0x3f803f80
    v_mov_b32 v30, 0x3f803f80
    v_mov_b32 v31, 0x3f803f80
    v_mul_u32_u24 v134, 768, v255
    v_add_u32 v134, v126, v134
    v_add_u32 v134, 98304, v134
    v_and_b32 v135, 1, v128
    v_lshlrev_b32 v135, 4, v135
    v_lshlrev_b32 v136, v135, s76
    v_mov_b32 v137, 0x3c003c00
    v_mov_b32 v44, 1.0
    v_lshlrev_b32 v138, 4, v255
    v_lshl_add_u32 v139, v255, 4, s79
    v_lshl_add_u32 v140, v255, 3, s80
    buffer_load_dwordx4 v150, s[48:51], 0 offen offset:1024 lds
    v_add_u32 v141, 0, v128
    v_mul_u32_u24 v142, 37, v141
    v_mul_u32_u24 v143, 384, v141
    v_lshrrev_b32 v142, 8, v142
    v_mad_u32_u24 v143, v142, s70, v143
    v_add_u32 v15, v143, v139
    v_add_u32 v18, v143, v140
    v_add_u32 v143, 16, v128
    v_mul_u32_u24 v144, 37, v143
    v_mul_u32_u24 v145, 384, v143
    v_lshrrev_b32 v144, 8, v144
    v_mad_u32_u24 v145, v144, s70, v145
    v_add_u32 v16, v145, v139
    v_add_u32 v19, v145, v140
    v_add_u32 v145, 32, v128
    v_mul_u32_u24 v146, 37, v145
    v_mul_u32_u24 v147, 384, v145
    v_lshrrev_b32 v146, 8, v146
    v_mad_u32_u24 v147, v146, s70, v147
    v_add_u32 v17, v147, v139
    v_add_u32 v20, v147, v140
    v_mul_u32_u24 v142, 24, v142
    v_lshl_add_u32 v142, v141, 2, v142
    v_add_u32 v22, s81, v142
    v_sub_u32 v23, s81, v142
    v_sub_u32 v139, v22, v138
    v_mul_u32_u24 v140, 24, v144
    v_lshl_add_u32 v140, v143, 2, v140
    v_add_u32 v24, s81, v140
    v_sub_u32 v25, s81, v140
    v_sub_u32 v140, v24, v138
    v_mul_u32_u24 v141, 24, v146
    v_lshl_add_u32 v141, v145, 2, v141
    v_add_u32 v26, s81, v141
    v_sub_u32 v27, s81, v141
    v_sub_u32 v141, v26, v138
    v_mul_u32_u24 v142, 148, v255
    v_add_u32 v143, 0, v142
    v_lshrrev_b32 v143, 8, v143
    v_mad_i32_i24 v46, v143, s82, v139
    v_mad_i32_i24 v58, v143, s82, v140
    v_mad_i32_i24 v70, v143, s82, v141
    v_add_u32 v143, 37, v142
    v_lshrrev_b32 v143, 8, v143
    v_mad_i32_i24 v47, v143, s82, v139
    v_mad_i32_i24 v59, v143, s82, v140
    v_mad_i32_i24 v71, v143, s82, v141
    v_add_u32 v143, 74, v142
    v_lshrrev_b32 v143, 8, v143
    v_mad_i32_i24 v48, v143, s82, v139
    v_mad_i32_i24 v60, v143, s82, v140
    v_mad_i32_i24 v72, v143, s82, v141
    v_add_u32 v143, 111, v142
    v_lshrrev_b32 v143, 8, v143
    v_mad_i32_i24 v49, v143, s82, v139
    v_mad_i32_i24 v61, v143, s82, v140
    v_mad_i32_i24 v73, v143, s82, v141
    v_add_u32 v143, 592, v142
    v_lshrrev_b32 v143, 8, v143
    v_mad_i32_i24 v50, v143, s82, v139
    v_mad_i32_i24 v62, v143, s82, v140
    v_mad_i32_i24 v74, v143, s82, v141
    v_add_u32 v143, 629, v142
    v_lshrrev_b32 v143, 8, v143
    v_mad_i32_i24 v51, v143, s82, v139
    v_mad_i32_i24 v63, v143, s82, v140
    v_mad_i32_i24 v75, v143, s82, v141
    v_add_u32 v143, 666, v142
    v_lshrrev_b32 v143, 8, v143
    v_mad_i32_i24 v52, v143, s82, v139
    v_mad_i32_i24 v64, v143, s82, v140
    v_mad_i32_i24 v76, v143, s82, v141
    v_add_u32 v143, 703, v142
    v_lshrrev_b32 v143, 8, v143
    v_mad_i32_i24 v53, v143, s82, v139
    v_mad_i32_i24 v65, v143, s82, v140
    v_mad_i32_i24 v77, v143, s82, v141
    v_add_u32 v143, 1184, v142
    v_lshrrev_b32 v143, 8, v143
    v_mad_i32_i24 v54, v143, s82, v139
    v_mad_i32_i24 v66, v143, s82, v140
    v_mad_i32_i24 v78, v143, s82, v141
    v_add_u32 v143, 1221, v142
    v_lshrrev_b32 v143, 8, v143
    v_mad_i32_i24 v55, v143, s82, v139
    v_mad_i32_i24 v67, v143, s82, v140
    v_mad_i32_i24 v79, v143, s82, v141
    v_add_u32 v143, 1258, v142
    v_lshrrev_b32 v143, 8, v143
    v_mad_i32_i24 v56, v143, s82, v139
    v_mad_i32_i24 v68, v143, s82, v140
    v_mad_i32_i24 v80, v143, s82, v141
    v_add_u32 v142, 1295, v142
    v_lshrrev_b32 v142, 8, v142
    v_mad_i32_i24 v57, v142, s82, v139
    v_mad_i32_i24 v69, v142, s82, v140
    v_mad_i32_i24 v81, v142, s82, v141
    v_mov_b32 v139, s81
    v_lshlrev_b32 v140, 4, v254
    v_xor_b32 v2, 65536, v140
    v_lshl_add_u32 v3, s16, 10, v140
    v_add_u32 v4, s85, v140
    v_lshl_add_u32 v140, v255, 3, s86
    v_mov_b32 v141, s83
    v_mov_b32 v142, 163264
    v_mul_u32_u24 v143, 80, v255
    v_add3_u32 v154, v143, v135, s72
    v_add_u32 v5, s72, v143
    v_lshl_add_u32 v6, v128, 2, s73
    v_add_u32 v9, s87, v138
    v_lshrrev_b32 v135, 1, v255
    v_mul_u32_u24 v135, 48, v135
    v_lshl_add_u32 v135, v255, 3, v135
    v_lshl_add_u32 v135, v116, 4, v135
    v_lshl_add_u32 v135, v118, 1, v135
    v_add_u32 v8, s87, v135
    v_mov_b32 v37, 0
    v_mov_b32 v38, 0
    buffer_load_dwordx4 v152, s[48:51], 0 offen offset:2048 lds
    s_add_u32 s48, s48, 36864
    s_addc_u32 s49, s49, 0
    s_add_u32 m0, s69, 0
    v_mov_b32 v39, 0
    v_add_u32 v155, 86016, v0
    v_add_u32 v156, 86016, v1
    v_lshlrev_b32 v157, 4, v128
    v_add_u32 v157, 161984, v157
    v_mul_u32_u24 v135, 336, v128
    v_add3_u32 v135, v135, v143, s72
    v_mul_u32_u24 v143, 272, v128
    v_add3_u32 v143, v143, v138, s73
    v_mul_u32_u24 v158, 1088, v255
    v_add_u32 v158, v158, v6
    v_add_u32 v159, 5376, v135
    v_add_u32 v160, 4352, v143
    v_add_u32 v161, 4352, v158
    v_cmp_gt_u32 s[88:89], 16, v254
    buffer_load_dwordx4 v132, s[48:51], 0 offen lds
    v_mov_b32 v144, 0xf149f2ca
    v_add_u32 v145, 768, v114
    v_mul_u32_u24 v146, 2731, v145
    v_bfe_u32 v147, v146, 17, 3
    v_lshrrev_b32 v146, 16, v146
    v_xor_b32 v145, v147, v145
    v_mul_u32_u24 v147, 37, v146
    v_lshrrev_b32 v147, 8, v147
    v_lshlrev_b32 v145, 4, v145
    v_mad_u32_u24 v13, v147, s70, v145
    v_add_u32 v114, 1024, v114
    v_mul_u32_u24 v145, 2731, v114
    v_bfe_u32 v146, v145, 17, 3
    s_waitcnt vmcnt(7)
    ds_read_b64_tr_b16 a[72:73], v123 offset:0
    ds_read_b64_tr_b16 a[74:75], v123 offset:768
    ds_read_b64_tr_b16 a[96:97], v123 offset:32
    ds_read_b64_tr_b16 a[98:99], v123 offset:800
    ds_read_b64_tr_b16 a[120:121], v123 offset:64
    buffer_load_dwordx4 v150, s[48:51], 0 offen offset:1024 lds
    ds_read_b64_tr_b16 a[122:123], v123 offset:832
    v_lshrrev_b32 v145, 16, v145
    v_xor_b32 v114, v146, v114
    v_mul_u32_u24 v146, 37, v145
    v_lshrrev_b32 v146, 8, v146
    v_lshlrev_b32 v114, 4, v114
    v_mad_u32_u24 v14, v146, s70, v114
    v_cmp_gt_u32 vcc, 48, v145
    v_mul_u32_u24 v145, 6, v130
    v_sub_u32 v114, v254, v145
    v_cndmask_b32 v14, v115, v14, vcc
    v_cmp_gt_u32 vcc, 2, v118
    v_mul_u32_u24 v145, 384, v130
    v_lshl_add_u32 v145, v114, 4, v145
    v_cndmask_b32 v32, 0, v136, vcc
    v_cndmask_b32 v33, v136, 0, vcc
    v_cndmask_b32 v34, 0, v136, vcc
    v_cndmask_b32 v35, v136, 0, vcc
    buffer_load_dwordx4 v152, s[48:51], 0 offen offset:2048 lds
    s_add_u32 s48, s48, 36864
    s_addc_u32 s49, s49, 0
    s_add_u32 m0, s69, 3072
    v_cmp_eq_u32 vcc, 0, v118
    v_add_u32 v115, s78, v145
    v_add_u32 v145, s77, v145
    v_cndmask_b32 v40, 0, v137, vcc
    v_cmp_eq_u32 vcc, 1, v118
    v_mul_u32_u24 v136, 6, v131
    v_sub_u32 v130, v254, v136
    v_cndmask_b32 v41, 0, v137, vcc
    v_cmp_eq_u32 vcc, 2, v118
    v_mul_u32_u24 v136, 384, v131
    v_lshl_add_u32 v136, v130, 4, v136
    v_cndmask_b32 v42, 0, v137, vcc
    v_cmp_eq_u32 vcc, 3, v118
    v_add_u32 v131, s78, v136
    v_add_u32 v136, s77, v136
    v_cndmask_b32 v43, 0, v137, vcc
    v_cmp_eq_u32 vcc, v255, v116
    v_mul_u32_u24 v137, 6, v133
    v_sub_u32 v254, v254, v137
    v_cndmask_b32 v162, 0, v32, vcc
    v_cndmask_b32 v163, 0, v33, vcc
    v_cmp_gt_i32 vcc, 4, v114
    v_mul_u32_u24 v137, 384, v133
    v_lshl_add_u32 v137, v254, 4, v137
    v_cndmask_b32 v164, v115, v145, vcc
    v_cmp_gt_i32 vcc, -60, v130
    v_add_u32 v145, s78, v137
    v_add_u32 v137, s77, v137
    v_cndmask_b32 v165, v131, v136, vcc
    v_cmp_gt_i32 vcc, -124, v254
    v_mul_u32_u24 v254, 96, v128
    v_add3_u32 v130, v254, v138, s68
    v_cndmask_b32 v131, v145, v137, vcc
    v_cmp_gt_u32 vcc, 2, v255
    v_lshl_add_u32 v133, v255, 3, v254
    v_add3_u32 v133, v133, 64, s68
    v_cndmask_b32 v140, v141, v140, vcc
    v_lshl_add_u32 v140, v116, 9, v140
    v_lshl_add_u32 v140, v118, 1, v140
    v_cmp_gt_u32 vcc, 3, v255
    v_add3_u32 v114, v254, v138, s69
    v_lshl_add_u32 v254, v255, 3, v254
    v_cndmask_b32 v7, v142, v140, vcc
    v_cmp_gt_u32 vcc, 12, v128
    v_add3_u32 v254, v254, 64, s69
    v_add_u32 v118, 16, v128
    v_cndmask_b32 v159, v157, v159, vcc
    v_cndmask_b32 v160, v157, v160, vcc
    v_cmp_gt_u32 vcc, 3, v255
    v_cmp_gt_u32 s[94:95], s45, v118
    v_cndmask_b32 v255, v157, v143, s[88:89]
    v_cndmask_b32 v161, v157, v161, vcc
    v_cndmask_b32 v157, v157, v160, s[88:89]
    v_add_u32 v5, 336, v5
    buffer_load_dwordx4 v132, s[48:51], 0 offen lds
    buffer_load_dwordx4 v150, s[48:51], 0 offen offset:1024 lds
    buffer_load_dwordx4 v152, s[48:51], 0 offen offset:2048 lds
    s_waitcnt vmcnt(9)
    s_barrier
    ds_read_b128 v[146:149], v155 offset:6144
    ds_read_b128 v[166:169], v156 offset:6144
    ds_read_b128 v[170:173], v155 offset:6272
    s_add_u32 s48, s48, 36864
    s_addc_u32 s49, s49, 0
    ds_read_b128 v[174:177], v156 offset:6272
    s_add_u32 m0, s72, 0
    ds_read_b128 v[178:181], v155 offset:6400
    ds_read_b128 v[182:185], v156 offset:6400
    ds_read_b128 v[186:189], v155 offset:0
    buffer_load_ushort v116, v153, s[60:63], 0 offen
    s_mov_b64 s[60:61], s[8:9]
    ds_read_b128 v[190:193], v156 offset:0
    ds_read_b128 v[194:197], v155 offset:128
    ds_read_b128 v[198:201], v156 offset:128
    s_waitcnt lgkmcnt(7)
    v_mfma_f32_16x16x32_bf16 v[202:205], a[72:75], v[146:149], 0
    buffer_load_dwordx3 v[206:208], v126, s[56:59], 0 offen
    ds_read_b128 v[210:213], v155 offset:256
    v_mfma_f32_16x16x32_bf16 v[214:217], a[96:99], v[146:149], 0
    s_waitcnt lgkmcnt(7)
    ds_read_b128 v[218:221], v156 offset:256
    v_mfma_f32_16x16x32_bf16 v[222:225], a[120:123], v[146:149], 0
    s_waitcnt lgkmcnt(7)
    ds_read_b128 v[146:149], v155 offset:6144
    s_waitcnt lgkmcnt(6)
    v_mfma_f32_16x16x32_bf16 v[226:229], a[72:75], v[186:189], 0
    v_mfma_f32_16x16x32_bf16 v[230:233], a[96:99], v[186:189], 0
    s_waitcnt vmcnt(8)
    buffer_load_dwordx4 v[234:237], v120, s[64:67], 0 offen
    ds_read_b64_tr_b16 a[76:77], v123 offset:3072
    ds_read_b64_tr_b16 a[78:79], v123 offset:3840
    ds_read_b64_tr_b16 a[100:101], v123 offset:3104
    ds_read_b64_tr_b16 a[102:103], v123 offset:3872
    ds_read_b64_tr_b16 a[124:125], v123 offset:3136
    ds_read_b64_tr_b16 a[126:127], v123 offset:3904
    s_mov_b32 s19, s38
    s_mov_b32 s23, s25
    s_mov_b32 s26, 0
    s_mov_b32 s27, 0
    s_mov_b32 s18, 0
    s_add_u32 s19, s19, s20
    s_add_u32 s23, s23, s21
    s_cmp_ge_u32 s19, 72
    s_cselect_b32 s34, 72, 0
    s_cselect_b32 s35, s22, 0
    s_sub_u32 s19, s19, s34
    s_add_u32 s23, s23, s35
    s_mov_b32 s24, s23
    s_add_u32 s19, s19, s20
    s_add_u32 s23, s23, s21
    s_cmp_ge_u32 s19, 72
    s_cselect_b32 s34, 72, 0
    s_cselect_b32 s35, s22, 0
    s_sub_u32 s19, s19, s34
    s_add_u32 s23, s23, s35
    s_sub_u32 s62, s45, s17
    s_sub_u32 s45, s17, 1
    s_bfm_b32 s70, s17, 0
    s_waitcnt lgkmcnt(4)
    v_mfma_f32_16x16x32_bf16 v[202:205], a[76:79], v[166:169], v[202:205]
    s_waitcnt lgkmcnt(2)
    global_load_ushort v151, v151, s[46:47]
    s_mov_b32 s71, 1
    v_mfma_f32_16x16x32_bf16 v[214:217], a[100:103], v[166:169], v[214:217]
    s_waitcnt lgkmcnt(0)
    buffer_load_dwordx4 v132, s[48:51], 0 offen lds
    s_and_b32 s77, s2, 0xf8
    v_mfma_f32_16x16x32_bf16 v[222:225], a[124:127], v[166:169], v[222:225]
    s_add_u32 s77, s77, 4940
    ds_read_b128 v[166:169], v156 offset:6144
    s_mul_i32 s78, s77, 58255
    v_mfma_f32_16x16x32_bf16 v[226:229], a[76:79], v[190:193], v[226:229]
    s_lshr_b32 s78, s78, 22
    s_add_u32 s34, s18, 2
    s_mov_b32 s18, 1
    v_mfma_f32_16x16x32_bf16 v[230:233], a[100:103], v[190:193], v[230:233]
    s_mov_b32 s27, s26
    s_mov_b32 s26, s25
    s_add_u32 s19, s19, s20
    s_waitcnt vmcnt(8)
    ds_read_b64_tr_b16 a[80:81], v124 offset:0
    ds_read_b64_tr_b16 a[82:83], v124 offset:768
    ds_read_b64_tr_b16 a[104:105], v124 offset:32
    ds_read_b64_tr_b16 a[106:107], v124 offset:800
    ds_read_b64_tr_b16 a[128:129], v124 offset:64
    ds_read_b64_tr_b16 a[130:131], v124 offset:832
    buffer_load_dwordx4 v150, s[48:51], 0 offen offset:1024 lds
    buffer_load_dwordx4 v152, s[48:51], 0 offen offset:2048 lds
    s_add_u32 s48, s48, 36864
    s_waitcnt lgkmcnt(4)
    v_mfma_f32_16x16x32_bf16 v[202:205], a[80:83], v[170:173], v[202:205]
    s_waitcnt lgkmcnt(2)
    s_addc_u32 s49, s49, 0
    s_add_u32 m0, s72, 3072
    v_mfma_f32_16x16x32_bf16 v[214:217], a[104:107], v[170:173], v[214:217]
    s_waitcnt lgkmcnt(0)
    s_mov_b32 s72, 2
    v_mfma_f32_16x16x32_bf16 v[222:225], a[128:131], v[170:173], v[222:225]
    ds_read_b128 v[170:173], v155 offset:6272
    v_mfma_f32_16x16x32_bf16 v[226:229], a[80:83], v[194:197], v[226:229]
    v_mfma_f32_16x16x32_bf16 v[230:233], a[104:107], v[194:197], v[230:233]
    buffer_load_dwordx4 v132, s[48:51], 0 offen lds
    s_waitcnt vmcnt(8)
    ds_read_b64_tr_b16 a[84:85], v124 offset:3072
    ds_read_b64_tr_b16 a[86:87], v124 offset:3840
    ds_read_b64_tr_b16 a[108:109], v124 offset:3104
    ds_read_b64_tr_b16 a[110:111], v124 offset:3872
    ds_read_b64_tr_b16 a[132:133], v124 offset:3136
    ds_read_b64_tr_b16 a[134:135], v124 offset:3904
    s_waitcnt vmcnt(6)
    v_bfe_u32 v126, v206, v138, 16
    v_bfe_u32 v128, v207, v138, 16
    v_bfe_u32 v118, v208, v138, 16
    buffer_load_dwordx4 v150, s[48:51], 0 offen offset:1024 lds
    s_waitcnt vmcnt(6)
    v_cndmask_b32 v234, v234, v235, s[92:93]
    v_mfma_f32_16x16x16_bf16 v[206:209], v[116:117], v[126:127], 0
    v_cndmask_b32 v236, v236, v237, s[92:93]
    v_perm_b32 v136, v236, v234, v121
    v_mfma_f32_16x16x16_bf16 v[234:237], v[116:117], v[128:129], 0
    s_waitcnt lgkmcnt(4)
    v_mfma_f32_16x16x32_bf16 v[202:205], a[84:87], v[174:177], v[202:205]
    s_waitcnt lgkmcnt(0)
    v_mfma_f32_16x16x32_bf16 v[214:217], a[108:111], v[174:177], v[214:217]
    buffer_load_dwordx4 v152, s[48:51], 0 offen offset:2048 lds
    v_max_f32 v206, 0, v206
    v_mfma_f32_16x16x32_bf16 v[222:225], a[132:135], v[174:177], v[222:225]
    s_sub_u32 s48, s48, 184704
    ds_read_b128 v[126:129], v156 offset:6272
    v_max_f32 v207, 0, v207
    v_mfma_f32_16x16x32_bf16 v[226:229], a[84:87], v[198:201], v[226:229]
    s_subb_u32 s49, s49, 0
    v_max_f32 v208, 0, v208
    v_max_f32 v209, 0, v209
    v_mfma_f32_16x16x32_bf16 v[230:233], a[108:111], v[198:201], v[230:233]
    s_add_u32 m0, s73, 0
    v_cvt_pk_bf16_f32 v140, v206, v207
    v_cvt_pk_bf16_f32 v141, v208, v209
    v_max_f32 v234, 0, v234
    v_mfma_f32_16x16x16_bf16 v[174:177], v[116:117], v[118:119], 0
    v_max_f32 v235, 0, v235
    s_waitcnt vmcnt(6)
    v_lshlrev_b32 v151, 16, v151
    v_max_f32 v151, 0xc2c80000, v151
    v_mfma_f32_16x16x32_bf16 v[206:209], a[120:123], v[186:189], 0
    buffer_load_dwordx4 v[186:189], v120, s[64:67], 0 offen offset:16
    v_min_f32 v151, 0x40930000, v151
    v_mfma_f32_16x16x32_bf16 v[206:209], a[124:127], v[190:193], v[206:209]
    buffer_load_dwordx4 v132, s[48:51], 0 offen lds
    ds_read_b128 v[190:193], v155 offset:0
    v_mfma_f32_16x16x32_bf16 v[206:209], a[128:131], v[194:197], v[206:209]
    ds_read_b128 v[194:197], v156 offset:0
    v_mul_f32 v151, 0x3fb8aa3b, v151
    v_mfma_f32_16x16x32_bf16 v[206:209], a[132:135], v[198:201], v[206:209]
    s_waitcnt lgkmcnt(2)
    ds_read_b128 v[198:201], v155 offset:128
    v_exp_f32 v151, v151
    v_max_f32 v236, 0, v236
    v_cvt_pk_bf16_f32 v151, v151, v151
    v_and_b32 v151, 0xffff0000, v151
    v_mul_f32 v151, 0x3fb8aa3b, v151
    v_mul_f32 v138, 0xbea8f5c3, v151
    v_add_f32 v138, 0xc138aa3b, v138
    v_readlane_b32 s31, v151, s90
    v_max_f32 v237, 0, v237
    buffer_load_dwordx4 v150, s[48:51], 0 offen offset:1024 lds
    v_cvt_pk_bf16_f32 v116, v234, v235
    v_cvt_pk_bf16_f32 v117, v236, v237
    v_max_f32 v174, 0, v174
    v_max_f32 v175, 0, v175
    v_max_f32 v176, 0, v176
    v_max_f32 v177, 0, v177
    v_cvt_pk_bf16_f32 v118, v174, v175
    v_cvt_pk_bf16_f32 v119, v176, v177
    ds_read_b128 v[174:177], v156 offset:128
    buffer_load_dwordx4 v152, s[48:51], 0 offen offset:2048 lds
    s_add_u32 s48, s48, 36864
    s_waitcnt vmcnt(7)
    ds_read_b64_tr_b16 a[88:89], v125 offset:0
    ds_read_b64_tr_b16 a[90:91], v125 offset:768
    ds_read_b64_tr_b16 a[112:113], v125 offset:32
    ds_read_b64_tr_b16 a[114:115], v125 offset:800
    ds_read_b64_tr_b16 a[136:137], v125 offset:64
    ds_read_b64_tr_b16 a[138:139], v125 offset:832
    s_addc_u32 s49, s49, 0
    s_add_u32 m0, s73, 3072
    s_mov_b32 s73, 3
    buffer_load_dwordx4 v132, s[48:51], 0 offen lds
    s_waitcnt lgkmcnt(4)
    v_mfma_f32_16x16x32_bf16 v[202:205], a[88:91], v[178:181], v[202:205]
    s_waitcnt lgkmcnt(3)
    v_mfma_f32_16x16x32_bf16 v[226:229], a[88:91], v[210:213], v[226:229]
    s_waitcnt lgkmcnt(0)
    v_mfma_f32_16x16x32_bf16 v[214:217], a[112:115], v[178:181], v[214:217]
    buffer_load_dwordx4 v150, s[48:51], 0 offen offset:1024 lds
    v_mfma_f32_16x16x32_bf16 v[222:225], a[136:139], v[178:181], v[222:225]
    ds_read_b128 v[178:181], v155 offset:6400
    v_mfma_f32_16x16x32_bf16 v[230:233], a[112:115], v[210:213], v[230:233]
    v_mfma_f32_16x16x32_bf16 v[206:209], a[136:139], v[210:213], v[206:209]
    ds_read_b128 v[210:213], v155 offset:256
    s_waitcnt vmcnt(6)
    ds_read_b64_tr_b16 a[92:93], v125 offset:3072
    ds_read_b64_tr_b16 a[94:95], v125 offset:3840
    ds_read_b64_tr_b16 a[116:117], v125 offset:3104
    ds_read_b64_tr_b16 a[118:119], v125 offset:3872
    buffer_load_dwordx4 v152, s[48:51], 0 offen offset:2048 lds
    ds_read_b64_tr_b16 a[140:141], v125 offset:3136
    ds_read_b64_tr_b16 a[142:143], v125 offset:3904
    s_add_u32 s48, s48, 36864
    s_addc_u32 s49, s49, 0
    s_add_u32 m0, s68, 0
    v_mov_b32 v234, 0
    v_mov_b32 v235, 0
    v_mov_b32 v236, 0
    v_mov_b32 v237, 0
    v_mov_b32 v238, v144
    v_mov_b32 v239, v144
    v_mov_b32 v240, v144
    v_mov_b32 v241, v144
    s_waitcnt vmcnt(6)
    v_cndmask_b32 v186, v186, v187, s[92:93]
    buffer_load_dwordx4 v132, s[48:51], 0 offen lds
    v_cndmask_b32 v188, v188, v189, s[92:93]
    v_perm_b32 v137, v188, v186, v121
    s_waitcnt lgkmcnt(4)
    v_mfma_f32_16x16x32_bf16 v[202:205], a[92:95], v[182:185], v[202:205]
    s_waitcnt lgkmcnt(3)
    v_mfma_f32_16x16x32_bf16 v[226:229], a[92:95], v[218:221], v[226:229]
    s_waitcnt lgkmcnt(0)
    v_mfma_f32_16x16x32_bf16 v[214:217], a[116:119], v[182:185], v[214:217]
    v_mfma_f32_16x16x32_bf16 v[222:225], a[140:143], v[182:185], v[222:225]
    v_mfma_f32_16x16x32_bf16 v[230:233], a[116:119], v[218:221], v[230:233]
    buffer_load_dwordx4 v150, s[48:51], 0 offen offset:1024 lds
    v_mfma_f32_16x16x32_bf16 v[206:209], a[140:143], v[218:221], v[206:209]
    ds_read_b128 v[182:185], v156 offset:6400
    v_cvt_pk_f16_f32 v186, v202, v203
    v_pk_mul_f16 v203, v186, v186
    v_cvt_pk_f16_f32 v187, v204, v205
    v_pk_fma_f16 v203, v187, v187, v203
    v_cvt_pk_f16_f32 v188, v214, v215
    v_mfma_f32_16x16x16_bf16 v[218:221], v[136:137], v[140:141], 0
    v_pk_fma_f16 v203, v188, v188, v203
    v_cvt_pk_f16_f32 v189, v216, v217
    v_pk_fma_f16 v203, v189, v189, v203
    v_mfma_f32_16x16x16_bf16 v[214:217], v[136:137], v[116:117], 0
    v_cvt_pk_f16_f32 v120, v222, v223
    v_pk_fma_f16 v203, v120, v120, v203
    v_cvt_pk_f16_f32 v121, v224, v225
    v_mfma_f32_16x16x16_bf16 v[222:225], v[136:137], v[118:119], 0
    buffer_load_dwordx4 v152, s[48:51], 0 offen offset:2048 lds
    ds_read_b128 v[242:245], v156 offset:256
    s_add_u32 s48, s48, 36864
    s_addc_u32 s49, s49, 0
    s_add_u32 m0, s68, 3072
    v_cvt_pk_bf16_f32 v218, v218, v218
    v_and_b32 v218, 0xffff0000, v218
    s_waitcnt vmcnt(6)
    ds_read_b64_tr_b16 a[0:1], v122 offset:0
    ds_read_b64_tr_b16 a[2:3], v122 offset:768
    ds_read_b64_tr_b16 a[24:25], v122 offset:32
    ds_read_b64_tr_b16 a[26:27], v122 offset:800
    ds_read_b64_tr_b16 a[48:49], v122 offset:64
    ds_read_b64_tr_b16 a[50:51], v122 offset:832
    v_mul_f32 v218, 0xbfb8aa3b, v218
    v_exp_f32 v218, v218
    v_cvt_pk_bf16_f32 v214, v214, v214
    buffer_load_dwordx4 v132, s[48:51], 0 offen lds
    v_add_f32 v218, 1.0, v218
    v_rcp_f32 v218, v218
    v_and_b32 v214, 0xffff0000, v214
    v_cvt_pk_bf16_f32 v218, v218, v218
    v_and_b32 v218, 0xffff0000, v218
    v_fmamk_f32 v218, v218, 0x41b8aa3b, v138
    ds_write_b32 v134, v218 offset:0
    v_mul_f32 v214, 0xbfb8aa3b, v214
    v_exp_f32 v214, v214
    v_cvt_pk_bf16_f32 v222, v222, v222
    v_add_f32 v214, 1.0, v214
    s_waitcnt lgkmcnt(5)
    v_mfma_f32_16x16x32_bf16 v[218:221], a[0:3], v[146:149], 0
    s_waitcnt lgkmcnt(3)
    v_rcp_f32 v214, v214
    v_mfma_f32_16x16x32_bf16 v[246:249], a[24:27], v[146:149], 0
    s_waitcnt lgkmcnt(1)
    buffer_load_dwordx4 v150, s[48:51], 0 offen offset:1024 lds
    v_cvt_pk_bf16_f32 v214, v214, v214
    v_and_b32 v214, 0xffff0000, v214
    v_fmamk_f32 v214, v214, 0x41b8aa3b, v138
    ds_write_b32 v134, v214 offset:4
    v_and_b32 v222, 0xffff0000, v222
    v_mul_f32 v222, 0xbfb8aa3b, v222
    v_exp_f32 v222, v222
    v_pk_fma_f16 v203, v121, v121, v203
    v_add_f32 v222, 1.0, v222
    v_rcp_f32 v222, v222
    v_cvt_pk_f16_f32 v214, v226, v227
    s_waitcnt vmcnt(5)
    ds_read_b64_tr_b16 a[4:5], v122 offset:3072
    ds_read_b64_tr_b16 a[6:7], v122 offset:3840
    buffer_load_dwordx4 v152, s[48:51], 0 offen offset:2048 lds
    ds_read_b64_tr_b16 a[28:29], v122 offset:3104
    ds_read_b64_tr_b16 a[30:31], v122 offset:3872
    ds_read_b64_tr_b16 a[52:53], v122 offset:3136
    ds_read_b64_tr_b16 a[54:55], v122 offset:3904
    v_mfma_f32_16x16x32_bf16 v[250:253], a[48:51], v[146:149], 0
    s_add_u32 s48, s48, 36864
    ds_write_b128 v135, v[234:237] offset:16
    v_mfma_f32_16x16x32_bf16 v[146:149], a[0:3], v[190:193], 0
    s_addc_u32 s49, s49, 0
    s_add_u32 m0, s69, 0
    v_cvt_pk_bf16_f32 v222, v222, v222
    v_and_b32 v222, 0xffff0000, v222
    v_fmamk_f32 v222, v222, 0x41b8aa3b, v138
    v_pk_mul_f16 v223, v214, v214
    buffer_load_dwordx4 v132, s[48:51], 0 offen lds
    ds_write_b32 v134, v222 offset:8
    v_cvt_pk_f16_f32 v215, v228, v229
    v_pk_fma_f16 v223, v215, v215, v223
    v_cvt_pk_f16_f32 v216, v230, v231
    v_mfma_f32_16x16x32_bf16 v[226:229], a[24:27], v[190:193], 0
    s_waitcnt lgkmcnt(6)
    v_pk_fma_f16 v223, v216, v216, v223
    v_cvt_pk_f16_f32 v217, v232, v233
    v_mfma_f32_16x16x32_bf16 v[218:221], a[4:7], v[166:169], v[218:221]
    s_waitcnt lgkmcnt(2)
    ds_write_b64 v135, v[234:235] offset:56
    v_mfma_f32_16x16x32_bf16 v[246:249], a[28:31], v[166:169], v[246:249]
    v_pk_fma_f16 v223, v217, v217, v223
    v_cvt_pk_f16_f32 v140, v206, v207
    v_mfma_f32_16x16x32_bf16 v[250:253], a[52:55], v[166:169], v[250:253]
    buffer_load_dwordx4 v150, s[48:51], 0 offen offset:1024 lds
    v_pk_fma_f16 v223, v140, v140, v223
    v_mfma_f32_16x16x32_bf16 v[146:149], a[4:7], v[194:197], v[146:149]
    ds_write_b64 v135, v[234:235] offset:64
    v_mfma_f32_16x16x32_bf16 v[226:229], a[28:31], v[194:197], v[226:229]
    s_waitcnt lgkmcnt(2)
    v_cvt_pk_f16_f32 v141, v208, v209
    v_pk_fma_f16 v223, v141, v141, v223
    v_mfma_f32_16x16x32_bf16 v[166:169], a[48:51], v[190:193], 0
    s_barrier
    ds_read_b32 v22, v22 offset:0
    ds_read_b32 v23, v23 offset:672
    v_mfma_f32_16x16x32_bf16 v[166:169], a[52:55], v[194:197], v[166:169]
    ds_read_b32 v24, v24 offset:0
    s_waitcnt vmcnt(5)
    ds_read_b64_tr_b16 a[8:9], v123 offset:0
    ds_read_b64_tr_b16 a[10:11], v123 offset:768
    buffer_load_dwordx4 v152, s[48:51], 0 offen offset:2048 lds
    ds_read_b64_tr_b16 a[32:33], v123 offset:32
    ds_read_b64_tr_b16 a[34:35], v123 offset:800
    ds_read_b64_tr_b16 a[56:57], v123 offset:64
    ds_read_b64_tr_b16 a[58:59], v123 offset:832
    ds_read_b32 v25, v25 offset:672
    ds_read_b32 v26, v26 offset:0
    ds_read_b32 v27, v27 offset:672
    s_add_u32 s48, s48, 36864
    ds_read_b32 v46, v46 offset:336
    s_addc_u32 s49, s49, 0
    ds_read_b32 v58, v58 offset:336
    s_add_u32 m0, s69, 3072
    ds_read_b32 v70, v70 offset:336
    ds_read_b32 v47, v47 offset:332
    ds_read_b32 v59, v59 offset:332
    ds_read_b32 v71, v71 offset:332
    s_waitcnt lgkmcnt(15)
    buffer_load_dwordx4 v132, s[48:51], 0 offen lds
    ds_read_b32 v48, v48 offset:328
    ds_read_b32 v60, v60 offset:328
    s_waitcnt lgkmcnt(15)
    v_mfma_f32_16x16x32_bf16 v[218:221], a[8:11], v[170:173], v[218:221]
    s_waitcnt lgkmcnt(14)
    ds_read_b32 v72, v72 offset:328
    ds_read_b32 v49, v49 offset:324
    v_mfma_f32_16x16x32_bf16 v[146:149], a[8:11], v[198:201], v[146:149]
    s_waitcnt lgkmcnt(12)
    ds_read_b32 v61, v61 offset:324
    ds_read_b32 v73, v73 offset:324
    v_mfma_f32_16x16x32_bf16 v[246:249], a[32:35], v[170:173], v[246:249]
    s_waitcnt lgkmcnt(11)
    ds_read_b32 v50, v50 offset:272
    ds_read_b32 v62, v62 offset:272
    v_mfma_f32_16x16x32_bf16 v[250:253], a[56:59], v[170:173], v[250:253]
    s_waitcnt lgkmcnt(11)
    ds_read_b32 v74, v74 offset:272
    ds_read_b32 v51, v51 offset:268
    v_mfma_f32_16x16x32_bf16 v[226:229], a[32:35], v[198:201], v[226:229]
    s_waitcnt lgkmcnt(11)
    buffer_load_dwordx4 v150, s[48:51], 0 offen offset:1024 lds
    ds_read_b32 v63, v63 offset:268
    v_mfma_f32_16x16x32_bf16 v[166:169], a[56:59], v[198:201], v[166:169]
    s_waitcnt lgkmcnt(11)
    ds_read_b32 v75, v75 offset:268
    ds_read_b32 v52, v52 offset:264
    ds_read_b32 v64, v64 offset:264
    ds_read_b32 v76, v76 offset:264
    ds_read_b32 v53, v53 offset:260
    ds_read_b32 v65, v65 offset:260
    ds_read_b32 v77, v77 offset:260
    ds_read_b32 v54, v54 offset:208
    ds_read_b32 v66, v66 offset:208
    ds_read_b32 v78, v78 offset:208
    s_waitcnt vmcnt(5)
    ds_read_b64_tr_b16 a[12:13], v123 offset:3072
    buffer_load_dwordx4 v152, s[48:51], 0 offen offset:2048 lds
    ds_read_b64_tr_b16 a[14:15], v123 offset:3840
    ds_read_b64_tr_b16 a[36:37], v123 offset:3104
    s_add_u32 m0, s28, 0
    ds_read_b64_tr_b16 a[38:39], v123 offset:3872
    s_sub_u32 s48, s48, 183552
    ds_read_b64_tr_b16 a[60:61], v123 offset:3136
    s_subb_u32 s49, s49, 0
    ds_read_b64_tr_b16 a[62:63], v123 offset:3904
    ds_read_b32 v55, v55 offset:204
    ds_read_b32 v67, v67 offset:204
    ds_read_b32 v79, v79 offset:204
    ds_read_b32 v56, v56 offset:200
    ds_read_b32 v68, v68 offset:200
    buffer_load_dwordx4 v10, s[8:11], s25 offen nt lds
    ds_read_b32 v80, v80 offset:200
    ds_read_b32 v57, v57 offset:196
    ds_read_b32 v69, v69 offset:196
    s_add_u32 m0, s28, 4096
    ds_read_b32 v81, v81 offset:196
    ds_read_b32 v139, v139 offset:336
    s_waitcnt lgkmcnt(14)
    v_mfma_f32_16x16x32_bf16 v[218:221], a[12:15], v[126:129], v[218:221]
    s_waitcnt lgkmcnt(13)
    ds_write_b128 v159, v[234:237] offset:16
    v_mfma_f32_16x16x32_bf16 v[146:149], a[12:15], v[174:177], v[146:149]
    s_waitcnt lgkmcnt(10)
    v_cndmask_b32 v22, v144, v22, s[88:89]
    v_cndmask_b32 v24, v144, v24, s[88:89]
    v_mfma_f32_16x16x32_bf16 v[246:249], a[36:39], v[126:129], v[246:249]
    s_waitcnt lgkmcnt(8)
    buffer_load_dwordx4 v11, s[8:11], s25 offen nt lds
    v_mfma_f32_16x16x32_bf16 v[250:253], a[60:63], v[126:129], v[250:253]
    s_add_u32 m0, s28, 8192
    ds_write_b64 v159, v[234:235] offset:56
    v_mfma_f32_16x16x32_bf16 v[226:229], a[36:39], v[174:177], v[226:229]
    s_waitcnt lgkmcnt(5)
    v_mov_b32_dpp v23, v25 quad_perm:[0,1,2,3] row_mask:0x2 bank_mask:0xf
    v_cndmask_b32 v26, v144, v26, s[88:89]
    v_mfma_f32_16x16x32_bf16 v[166:169], a[60:63], v[174:177], v[166:169]
    s_waitcnt lgkmcnt(3)
    s_waitcnt lgkmcnt(2)
    ds_write_b64 v159, v[234:235] offset:64
    s_waitcnt vmcnt(5)
    v_readfirstlane_b32 s39, v139
    buffer_load_dwordx4 v12, s[8:11], s25 offen nt lds
    ds_read_b64_tr_b16 a[16:17], v124 offset:0
    ds_read_b64_tr_b16 a[18:19], v124 offset:768
    ds_read_b64_tr_b16 a[40:41], v124 offset:32
    ds_read_b64_tr_b16 a[42:43], v124 offset:800
    ds_read_b64_tr_b16 a[64:65], v124 offset:64
    ds_read_b64_tr_b16 a[66:67], v124 offset:832
    ds_write_b128 v143, v[238:241] offset:192
    s_add_u32 m0, s28, 12288
    v_mov_b32_dpp v23, v27 quad_perm:[0,1,2,3] row_mask:0x4 bank_mask:0xf
    buffer_load_dwordx4 v13, s[8:11], s25 offen nt lds
    ds_write_b128 v160, v[238:241] offset:192
    s_add_u32 m0, s29, 0
    s_nop 0
    s_waitcnt lgkmcnt(6)
    v_mfma_f32_16x16x32_bf16 v[218:221], a[16:19], v[178:181], v[218:221]
    s_waitcnt lgkmcnt(5)
    v_mfma_f32_16x16x32_bf16 v[146:149], a[16:19], v[210:213], v[146:149]
    s_waitcnt lgkmcnt(1)
    v_mfma_f32_16x16x32_bf16 v[246:249], a[40:43], v[178:181], v[246:249]
    v_mfma_f32_16x16x32_bf16 v[250:253], a[64:67], v[178:181], v[250:253]
    buffer_load_dwordx4 v14, s[8:11], s25 offen nt lds
    v_mfma_f32_16x16x32_bf16 v[226:229], a[40:43], v[210:213], v[226:229]
    s_add_u32 m0, s68, 0
    s_lshr_b32 s10, s17, 1
    s_cselect_b32 s10, s36, 0
    v_mfma_f32_16x16x32_bf16 v[166:169], a[64:67], v[210:213], v[166:169]
    s_mov_b32 s25, s24
    s_waitcnt vmcnt(5)
    ds_read_b64_tr_b16 a[20:21], v124 offset:3072
    ds_read_b64_tr_b16 a[22:23], v124 offset:3840
    ds_read_b64_tr_b16 a[44:45], v124 offset:3104
    buffer_load_dwordx4 v132, s[48:51], 0 offen lds
    ds_read_b64_tr_b16 a[46:47], v124 offset:3872
    ds_read_b64_tr_b16 a[68:69], v124 offset:3136
    ds_read_b64_tr_b16 a[70:71], v124 offset:3904
    buffer_load_dwordx4 v150, s[48:51], 0 offen offset:1024 lds
    s_waitcnt lgkmcnt(4)
    v_mfma_f32_16x16x32_bf16 v[218:221], a[20:23], v[182:185], v[218:221]
    s_waitcnt lgkmcnt(3)
    v_mfma_f32_16x16x32_bf16 v[146:149], a[20:23], v[242:245], v[146:149]
    s_waitcnt lgkmcnt(0)
    v_mfma_f32_16x16x32_bf16 v[246:249], a[44:47], v[182:185], v[246:249]
    v_mfma_f32_16x16x32_bf16 v[250:253], a[68:71], v[182:185], v[250:253]
    v_mov_b32 v205, 0
    v_mfma_f32_16x16x32_bf16 v[226:229], a[44:47], v[242:245], v[226:229]
    buffer_load_dwordx4 v152, s[48:51], 0 offen offset:2048 lds
    v_cvt_pk_f16_f32 v126, v218, v219
    v_mfma_f32_16x16x32_bf16 v[166:169], a[68:71], v[242:245], v[166:169]
    s_add_u32 s48, s48, 36864
    s_addc_u32 s49, s49, 0
    s_add_u32 m0, s68, 3072
    v_pk_mul_f16 v202, v126, v126
    v_cvt_pk_f16_f32 v127, v220, v221
    v_pk_fma_f16 v202, v127, v127, v202
    v_cvt_pk_f16_f32 v128, v246, v247
    v_pk_fma_f16 v202, v128, v128, v202
    v_cvt_pk_f16_f32 v129, v248, v249
    v_pk_fma_f16 v202, v129, v129, v202
    v_cvt_pk_f16_f32 v118, v250, v251
    v_pk_fma_f16 v202, v118, v118, v202
    v_cvt_pk_f16_f32 v119, v252, v253
    v_pk_fma_f16 v202, v119, v119, v202
    v_pk_mul_f16 v204, v126, v186
    v_pk_fma_f16 v204, v127, v187, v204
    buffer_load_dwordx4 v132, s[48:51], 0 offen lds
    v_pk_fma_f16 v204, v128, v188, v204
    v_pk_fma_f16 v204, v129, v189, v204
    v_pk_fma_f16 v204, v118, v120, v204
    v_pk_fma_f16 v204, v119, v121, v204
    v_cvt_pk_f16_f32 v142, v146, v147
    v_pk_mul_f16 v222, v142, v142
    v_mfma_f32_16x16x32_f16 v[170:173], v[40:43], v[202:205], 0
    v_cvt_pk_f16_f32 v143, v148, v149
    v_pk_fma_f16 v222, v143, v143, v222
    v_cvt_pk_f16_f32 v144, v226, v227
    v_pk_fma_f16 v222, v144, v144, v222
    v_cvt_pk_f16_f32 v145, v228, v229
    v_pk_fma_f16 v222, v145, v145, v222
    v_cvt_pk_f16_f32 v138, v166, v167
    v_pk_fma_f16 v222, v138, v138, v222
    v_rsq_f32 v170, v170
    v_rsq_f32 v171, v171
    v_mul_f32 v166, s31, v170
    v_cvt_pk_f16_f32 v167, v166, v171
    v_pk_mul_f16 v186, v186, v167 op_sel:[0,1] op_sel_hi:[1,1]
    v_pk_mul_f16 v187, v187, v167 op_sel:[0,1] op_sel_hi:[1,1]
    v_pk_mul_f16 v188, v188, v167 op_sel:[0,1] op_sel_hi:[1,1]
    v_pk_mul_f16 v189, v189, v167 op_sel:[0,1] op_sel_hi:[1,1]
    v_pk_mul_f16 v120, v120, v167 op_sel:[0,1] op_sel_hi:[1,1]
    v_pk_mul_f16 v121, v121, v167 op_sel:[0,1] op_sel_hi:[1,1]
    v_pk_mul_f16 v126, v126, v167 op_sel:[0,0] op_sel_hi:[1,0]
    v_pk_mul_f16 v127, v127, v167 op_sel:[0,0] op_sel_hi:[1,0]
    v_pk_mul_f16 v128, v128, v167 op_sel:[0,0] op_sel_hi:[1,0]
    v_pk_mul_f16 v129, v129, v167 op_sel:[0,0] op_sel_hi:[1,0]
    v_pk_mul_f16 v118, v118, v167 op_sel:[0,0] op_sel_hi:[1,0]
    v_pk_mul_f16 v119, v119, v167 op_sel:[0,0] op_sel_hi:[1,0]
    v_cndmask_b32 v170, 1.0, v170, s[94:95]
    v_cndmask_b32 v171, 1.0, v171, s[94:95]
    v_max3_u32 v44, v44, v170, v171
    v_mul_f32 v139, v172, v166
    v_fma_f32 v139, v139, v171, s39
    ds_write_b32 v157, v139 offset:192
    v_cvt_pk_f16_f32 v139, v168, v169
    v_pk_fma_f16 v222, v139, v139, v222
    v_pk_mul_f16 v224, v142, v214
    v_pk_fma_f16 v224, v143, v215, v224
    ds_write_b128 v159, v[186:189]
    v_pk_fma_f16 v224, v144, v216, v224
    v_pk_fma_f16 v224, v145, v217, v224
    v_pk_fma_f16 v224, v138, v140, v224
    v_pk_fma_f16 v224, v139, v141, v224
    v_mov_b32 v225, 0
    s_nop 0
    s_nop 0
    v_mfma_f32_16x16x32_f16 v[146:149], v[40:43], v[222:225], 0
    ds_write_b64 v159, v[120:121] offset:48
    s_nop 0
    s_nop 0
    s_nop 0
    ds_write_b128 v159, v[126:129] offset:32
    s_nop 0
    s_nop 0
    s_nop 0
    v_rsq_f32 v146, v146
    v_rsq_f32 v147, v147
    ds_write_b64 v159, v[118:119] offset:72
    v_mul_f32 v116, s31, v146
    v_cvt_pk_f16_f32 v117, v116, v147
    v_pk_mul_f16 v214, v214, v117 op_sel:[0,1] op_sel_hi:[1,1]
    v_pk_mul_f16 v215, v215, v117 op_sel:[0,1] op_sel_hi:[1,1]
    v_pk_mul_f16 v216, v216, v117 op_sel:[0,1] op_sel_hi:[1,1]
    v_pk_mul_f16 v217, v217, v117 op_sel:[0,1] op_sel_hi:[1,1]
    v_pk_mul_f16 v140, v140, v117 op_sel:[0,1] op_sel_hi:[1,1]
    v_pk_mul_f16 v141, v141, v117 op_sel:[0,1] op_sel_hi:[1,1]
    v_pk_mul_f16 v142, v142, v117 op_sel:[0,0] op_sel_hi:[1,0]
    v_pk_mul_f16 v143, v143, v117 op_sel:[0,0] op_sel_hi:[1,0]
    v_pk_mul_f16 v144, v144, v117 op_sel:[0,0] op_sel_hi:[1,0]
    v_pk_mul_f16 v145, v145, v117 op_sel:[0,0] op_sel_hi:[1,0]
    v_pk_mul_f16 v138, v138, v117 op_sel:[0,0] op_sel_hi:[1,0]
    v_pk_mul_f16 v139, v139, v117 op_sel:[0,0] op_sel_hi:[1,0]
    v_max3_u32 v44, v44, v146, v147
    v_mul_f32 v157, v148, v116
    v_fma_f32 v157, v157, v147, s39
    ds_write_b32 v255, v157 offset:192
    buffer_load_dwordx4 v150, s[48:51], 0 offen offset:1024 lds
    ds_write_b128 v135, v[214:217]
    buffer_load_dwordx4 v152, s[48:51], 0 offen offset:2048 lds
    ds_write_b64 v135, v[140:141] offset:48
    s_add_u32 s48, s48, 36864
    s_addc_u32 s49, s49, 0
    s_add_u32 m0, s69, 0
    ds_write_b128 v135, v[142:145] offset:32
    buffer_load_dwordx4 v132, s[48:51], 0 offen lds
    ds_write_b64 v135, v[138:139] offset:72
    buffer_load_dwordx4 v150, s[48:51], 0 offen offset:1024 lds
    buffer_load_dwordx4 v152, s[48:51], 0 offen offset:2048 lds
    s_waitcnt vmcnt(9)
    s_barrier
    ds_read_b128 v[126:129], v0 offset:20480
    ds_read_b128 v[170:173], v1 offset:20480
    ds_read_b128 v[174:177], v0 offset:20608
    s_add_u32 s48, s48, 36864
    s_addc_u32 s49, s49, 0
    ds_read_b128 v[178:181], v1 offset:20608
    s_add_u32 m0, s69, 3072
    ds_read_b128 v[182:185], v0 offset:20736
    ds_read_b128 v[186:189], v1 offset:20736
    buffer_load_dwordx4 v132, s[48:51], 0 offen lds
    s_waitcnt lgkmcnt(5)
    v_mfma_f32_16x16x32_bf16 v[118:121], a[72:75], v[126:129], 0
    s_waitcnt lgkmcnt(4)
    v_mfma_f32_16x16x32_bf16 v[118:121], a[76:79], v[170:173], v[118:121]
    s_waitcnt lgkmcnt(2)
    v_mfma_f32_16x16x32_bf16 v[118:121], a[80:83], v[174:177], v[118:121]
    s_waitcnt lgkmcnt(1)
    v_mfma_f32_16x16x32_bf16 v[118:121], a[84:87], v[178:181], v[118:121]
    s_waitcnt lgkmcnt(0)
    buffer_load_dwordx4 v150, s[48:51], 0 offen offset:1024 lds
    v_mfma_f32_16x16x32_bf16 v[118:121], a[88:91], v[182:185], v[118:121]
    v_mfma_f32_16x16x32_bf16 v[118:121], a[92:95], v[186:189], v[118:121]
    v_mfma_f32_16x16x32_bf16 v[190:193], a[96:99], v[126:129], 0
    s_waitcnt vmcnt(8)
    ds_read_b64_tr_b16 a[144:145], v123 offset:0
    ds_read_b64_tr_b16 a[146:147], v123 offset:768
    v_mfma_f32_16x16x32_bf16 v[190:193], a[100:103], v[170:173], v[190:193]
    ds_read_b64_tr_b16 a[168:169], v123 offset:32
    ds_read_b64_tr_b16 a[170:171], v123 offset:800
    v_mfma_f32_16x16x32_bf16 v[190:193], a[104:107], v[174:177], v[190:193]
    ds_read_b64_tr_b16 a[192:193], v123 offset:64
    buffer_load_dwordx4 v152, s[48:51], 0 offen offset:2048 lds
    v_mfma_f32_16x16x32_bf16 v[190:193], a[108:111], v[178:181], v[190:193]
    s_add_u32 s48, s48, 36864
    ds_read_b64_tr_b16 a[194:195], v123 offset:832
    v_cvt_pk_f16_f32 v146, v118, v119
    v_mfma_f32_16x16x32_bf16 v[190:193], a[112:115], v[182:185], v[190:193]
    s_addc_u32 s49, s49, 0
    v_pk_mul_f16 v143, v146, v146
    v_cvt_pk_f16_f32 v147, v120, v121
    v_mfma_f32_16x16x32_bf16 v[190:193], a[116:119], v[186:189], v[190:193]
    s_add_u32 m0, s68, 0
    v_pk_fma_f16 v143, v147, v147, v143
    v_mfma_f32_16x16x32_bf16 v[198:201], a[120:123], v[126:129], 0
    v_mfma_f32_16x16x32_bf16 v[198:201], a[124:127], v[170:173], v[198:201]
    v_mfma_f32_16x16x32_bf16 v[198:201], a[128:131], v[174:177], v[198:201]
    s_waitcnt lgkmcnt(4)
    v_mfma_f32_16x16x32_bf16 v[198:201], a[132:135], v[178:181], v[198:201]
    s_waitcnt lgkmcnt(2)
    v_cvt_pk_f16_f32 v148, v190, v191
    v_pk_fma_f16 v143, v148, v148, v143
    v_mfma_f32_16x16x32_bf16 v[198:201], a[136:139], v[182:185], v[198:201]
    s_waitcnt lgkmcnt(1)
    ds_read_b128 v[194:197], v0 offset:26624
    v_cvt_pk_f16_f32 v149, v192, v193
    v_mfma_f32_16x16x32_bf16 v[198:201], a[140:143], v[186:189], v[198:201]
    s_waitcnt lgkmcnt(1)
    buffer_load_dwordx4 v132, s[48:51], 0 offen lds
    ds_read_b128 v[190:193], v1 offset:26624
    v_mfma_f32_16x16x32_bf16 v[138:141], a[0:3], v[126:129], 0
    ds_read_b128 v[202:205], v0 offset:26752
    s_waitcnt vmcnt(7)
    v_mfma_f32_16x16x32_bf16 v[138:141], a[4:7], v[170:173], v[138:141]
    ds_read_b64_tr_b16 a[148:149], v123 offset:3072
    ds_read_b64_tr_b16 a[150:151], v123 offset:3840
    v_mfma_f32_16x16x32_bf16 v[138:141], a[8:11], v[174:177], v[138:141]
    ds_read_b64_tr_b16 a[172:173], v123 offset:3104
    ds_read_b64_tr_b16 a[174:175], v123 offset:3872
    v_mfma_f32_16x16x32_bf16 v[138:141], a[12:15], v[178:181], v[138:141]
    ds_read_b64_tr_b16 a[196:197], v123 offset:3136
    ds_read_b64_tr_b16 a[198:199], v123 offset:3904
    v_mfma_f32_16x16x32_bf16 v[138:141], a[16:19], v[182:185], v[138:141]
    ds_read_b128 v[206:209], v1 offset:26752
    buffer_load_dwordx4 v150, s[48:51], 0 offen offset:1024 lds
    v_mfma_f32_16x16x32_bf16 v[138:141], a[20:23], v[186:189], v[138:141]
    ds_read_b128 v[210:213], v0 offset:26880
    ds_read_b128 v[214:217], v1 offset:26880
    v_mfma_f32_16x16x32_bf16 v[166:169], a[24:27], v[126:129], 0
    s_waitcnt lgkmcnt(11)
    v_pk_fma_f16 v143, v149, v149, v143
    v_cvt_pk_f16_f32 v120, v198, v199
    v_mfma_f32_16x16x32_bf16 v[166:169], a[28:31], v[170:173], v[166:169]
    s_waitcnt lgkmcnt(10)
    v_pk_fma_f16 v143, v120, v120, v143
    v_cvt_pk_f16_f32 v121, v200, v201
    v_mfma_f32_16x16x32_bf16 v[166:169], a[32:35], v[174:177], v[166:169]
    s_waitcnt lgkmcnt(9)
    v_pk_fma_f16 v143, v121, v121, v143
    v_cvt_pk_f16_f32 v138, v138, v139
    v_mfma_f32_16x16x32_bf16 v[166:169], a[36:39], v[178:181], v[166:169]
    s_waitcnt lgkmcnt(7)
    v_pk_mul_f16 v142, v138, v138
    v_cvt_pk_f16_f32 v139, v140, v141
    v_mfma_f32_16x16x32_bf16 v[166:169], a[40:43], v[182:185], v[166:169]
    s_waitcnt lgkmcnt(5)
    buffer_load_dwordx4 v152, s[48:51], 0 offen offset:2048 lds
    v_pk_fma_f16 v142, v139, v139, v142
    v_mfma_f32_16x16x32_bf16 v[166:169], a[44:47], v[186:189], v[166:169]
    s_add_u32 s48, s48, 36864
    s_addc_u32 s49, s49, 0
    s_add_u32 m0, s68, 3072
    v_mfma_f32_16x16x32_bf16 v[134:137], a[48:51], v[126:129], 0
    s_waitcnt lgkmcnt(2)
    v_mfma_f32_16x16x32_bf16 v[134:137], a[52:55], v[170:173], v[134:137]
    s_waitcnt vmcnt(6)
    ds_read_b64_tr_b16 a[152:153], v124 offset:0
    ds_read_b64_tr_b16 a[154:155], v124 offset:768
    v_mfma_f32_16x16x32_bf16 v[134:137], a[56:59], v[174:177], v[134:137]
    s_waitcnt lgkmcnt(2)
    ds_read_b64_tr_b16 a[176:177], v124 offset:32
    ds_read_b64_tr_b16 a[178:179], v124 offset:800
    v_mfma_f32_16x16x32_bf16 v[134:137], a[60:63], v[178:181], v[134:137]
    ds_read_b64_tr_b16 a[200:201], v124 offset:64
    buffer_load_dwordx4 v132, s[48:51], 0 offen lds
    v_mfma_f32_16x16x32_bf16 v[134:137], a[64:67], v[182:185], v[134:137]
    ds_read_b64_tr_b16 a[202:203], v124 offset:832
    ds_read_b128 v[126:129], v0 offset:32768
    v_mfma_f32_16x16x32_bf16 v[134:137], a[68:71], v[186:189], v[134:137]
    ds_read_b128 v[170:173], v1 offset:32768
    v_cvt_pk_f16_f32 v140, v166, v167
    v_mfma_f32_16x16x32_bf16 v[174:177], a[72:75], v[194:197], 0
    ds_read_b128 v[178:181], v0 offset:32896
    v_pk_fma_f16 v142, v140, v140, v142
    v_mfma_f32_16x16x32_bf16 v[174:177], a[76:79], v[190:193], v[174:177]
    ds_read_b128 v[182:185], v1 offset:32896
    v_cvt_pk_f16_f32 v141, v168, v169
    v_mfma_f32_16x16x32_bf16 v[174:177], a[80:83], v[202:205], v[174:177]
    ds_read_b128 v[166:169], v0 offset:33024
    v_pk_fma_f16 v142, v141, v141, v142
    v_mfma_f32_16x16x32_bf16 v[174:177], a[84:87], v[206:209], v[174:177]
    s_waitcnt lgkmcnt(9)
    buffer_load_dwordx4 v150, s[48:51], 0 offen offset:1024 lds
    ds_read_b128 v[186:189], v1 offset:33024
    v_mfma_f32_16x16x32_bf16 v[174:177], a[88:91], v[210:213], v[174:177]
    s_waitcnt lgkmcnt(8)
    v_cvt_pk_f16_f32 v118, v134, v135
    v_pk_fma_f16 v142, v118, v118, v142
    v_mfma_f32_16x16x32_bf16 v[174:177], a[92:95], v[214:217], v[174:177]
    s_waitcnt lgkmcnt(7)
    v_cvt_pk_f16_f32 v119, v136, v137
    v_pk_fma_f16 v142, v119, v119, v142
    v_mfma_f32_16x16x32_bf16 v[134:137], a[96:99], v[194:197], 0
    s_waitcnt lgkmcnt(5)
    v_mov_b32 v144, 0
    v_mov_b32 v145, 0
    v_mfma_f32_16x16x32_bf16 v[134:137], a[100:103], v[190:193], v[134:137]
    s_waitcnt lgkmcnt(4)
    v_cvt_pk_f16_f32 v150, v174, v175
    v_pk_mul_f16 v175, v150, v150
    v_mfma_f32_16x16x32_f16 v[198:201], v[40:43], v[142:145], 0
    s_waitcnt vmcnt(5)
    ds_read_b64_tr_b16 a[156:157], v124 offset:3072
    buffer_load_dwordx4 v152, s[48:51], 0 offen offset:2048 lds
    v_mfma_f32_16x16x32_bf16 v[134:137], a[104:107], v[202:205], v[134:137]
    s_add_u32 m0, s69, 0
    ds_read_b64_tr_b16 a[158:159], v124 offset:3840
    ds_read_b64_tr_b16 a[180:181], v124 offset:3104
    v_mfma_f32_16x16x32_bf16 v[134:137], a[108:111], v[206:209], v[134:137]
    s_waitcnt lgkmcnt(4)
    ds_read_b64_tr_b16 a[182:183], v124 offset:3872
    ds_read_b64_tr_b16 a[204:205], v124 offset:3136
    v_mfma_f32_16x16x32_bf16 v[134:137], a[112:115], v[210:213], v[134:137]
    s_waitcnt lgkmcnt(5)
    ds_read_b64_tr_b16 a[206:207], v124 offset:3904
    v_cvt_pk_f16_f32 v151, v176, v177
    v_mfma_f32_16x16x32_bf16 v[134:137], a[116:119], v[214:217], v[134:137]
    v_rsq_f32 v198, v198
    v_mfma_f32_16x16x32_bf16 v[142:145], a[120:123], v[194:197], 0
    v_rsq_f32 v199, v199
    v_mfma_f32_16x16x32_bf16 v[142:145], a[124:127], v[190:193], v[142:145]
    buffer_load_dwordx4 v164, s[52:55], 0 offen lds
    v_mul_f32 v152, s31, v198
    v_mfma_f32_16x16x32_bf16 v[142:145], a[128:131], v[202:205], v[142:145]
    v_cvt_pk_f16_f32 v153, v152, v199
    v_pk_mul_f16 v146, v146, v153 op_sel:[0,1] op_sel_hi:[1,1]
    v_mfma_f32_16x16x32_bf16 v[142:145], a[132:135], v[206:209], v[142:145]
    s_waitcnt lgkmcnt(5)
    v_pk_mul_f16 v147, v147, v153 op_sel:[0,1] op_sel_hi:[1,1]
    v_pk_mul_f16 v148, v148, v153 op_sel:[0,1] op_sel_hi:[1,1]
    v_mfma_f32_16x16x32_bf16 v[142:145], a[136:139], v[210:213], v[142:145]
    s_waitcnt lgkmcnt(3)
    ds_read_b128 v[190:193], v155 offset:6144
    v_pk_mul_f16 v149, v149, v153 op_sel:[0,1] op_sel_hi:[1,1]
    v_mfma_f32_16x16x32_bf16 v[142:145], a[140:143], v[214:217], v[142:145]
    s_waitcnt lgkmcnt(2)
    ds_read_b128 v[194:197], v156 offset:6144
    v_pk_mul_f16 v120, v120, v153 op_sel:[0,1] op_sel_hi:[1,1]
    v_mfma_f32_16x16x32_bf16 v[202:205], a[72:75], v[126:129], 0
    s_waitcnt lgkmcnt(2)
    ds_read_b128 v[206:209], v155 offset:6272
    buffer_load_dwordx4 v165, s[52:55], 0 offen offset:1024 lds
    v_mfma_f32_16x16x32_bf16 v[202:205], a[76:79], v[170:173], v[202:205]
    ds_read_b128 v[210:213], v156 offset:6272
    v_pk_mul_f16 v121, v121, v153 op_sel:[0,1] op_sel_hi:[1,1]
    v_mfma_f32_16x16x32_bf16 v[202:205], a[80:83], v[178:181], v[202:205]
    ds_read_b128 v[214:217], v155 offset:6400
    v_pk_mul_f16 v138, v138, v153 op_sel:[0,0] op_sel_hi:[1,0]
    v_mfma_f32_16x16x32_bf16 v[202:205], a[84:87], v[182:185], v[202:205]
    ds_read_b128 v[218:221], v156 offset:6400
    v_pk_mul_f16 v139, v139, v153 op_sel:[0,0] op_sel_hi:[1,0]
    v_mfma_f32_16x16x32_bf16 v[202:205], a[88:91], v[166:169], v[202:205]
    v_pk_mul_f16 v140, v140, v153 op_sel:[0,0] op_sel_hi:[1,0]
    s_waitcnt vmcnt(5)
    v_mfma_f32_16x16x32_bf16 v[202:205], a[92:95], v[186:189], v[202:205]
    ds_read_b64_tr_b16 a[160:161], v123 offset:0
    ds_read_b64_tr_b16 a[162:163], v123 offset:768
    v_mfma_f32_16x16x32_bf16 v[222:225], a[96:99], v[126:129], 0
    s_waitcnt lgkmcnt(7)
    buffer_load_dwordx4 v131, s[52:55], 0 offen offset:2048 lds
    ds_read_b64_tr_b16 a[184:185], v123 offset:32
    v_mfma_f32_16x16x32_bf16 v[222:225], a[100:103], v[170:173], v[222:225]
    s_add_u32 s52, s52, 12288
    ds_read_b64_tr_b16 a[186:187], v123 offset:800
    ds_read_b64_tr_b16 a[208:209], v123 offset:64
    v_mfma_f32_16x16x32_bf16 v[222:225], a[104:107], v[178:181], v[222:225]
    s_addc_u32 s53, s53, 0
    ds_read_b64_tr_b16 a[210:211], v123 offset:832
    v_pk_mul_f16 v141, v141, v153 op_sel:[0,0] op_sel_hi:[1,0]
    v_mfma_f32_16x16x32_bf16 v[222:225], a[108:111], v[182:185], v[222:225]
    s_add_u32 m0, s69, 3072
    v_pk_mul_f16 v118, v118, v153 op_sel:[0,0] op_sel_hi:[1,0]
    v_pk_mul_f16 v119, v119, v153 op_sel:[0,0] op_sel_hi:[1,0]
    v_mfma_f32_16x16x32_bf16 v[222:225], a[112:115], v[166:169], v[222:225]
    s_waitcnt lgkmcnt(7)
    v_max3_u32 v44, v44, v198, v199
    v_pk_fma_f16 v175, v151, v151, v175
    v_mfma_f32_16x16x32_bf16 v[222:225], a[116:119], v[186:189], v[222:225]
    s_waitcnt lgkmcnt(6)
    v_cvt_pk_f16_f32 v152, v134, v135
    v_pk_fma_f16 v175, v152, v152, v175
    v_mfma_f32_16x16x32_bf16 v[198:201], a[120:123], v[126:129], 0
    buffer_load_dwordx4 v164, s[52:55], 0 offen lds
    v_cvt_pk_f16_f32 v153, v136, v137
    v_mfma_f32_16x16x32_bf16 v[198:201], a[124:127], v[170:173], v[198:201]
    s_waitcnt lgkmcnt(4)
    v_pk_fma_f16 v175, v153, v153, v175
    v_cvt_pk_f16_f32 v124, v142, v143
    v_mfma_f32_16x16x32_bf16 v[198:201], a[128:131], v[178:181], v[198:201]
    s_waitcnt lgkmcnt(3)
    v_pk_fma_f16 v175, v124, v124, v175
    v_cvt_pk_f16_f32 v125, v144, v145
    v_mfma_f32_16x16x32_bf16 v[198:201], a[132:135], v[182:185], v[198:201]
    s_waitcnt lgkmcnt(1)
    v_pk_fma_f16 v175, v125, v125, v175
    v_cvt_pk_f16_f32 v126, v202, v203
    v_mfma_f32_16x16x32_bf16 v[198:201], a[136:139], v[166:169], v[198:201]
    s_waitcnt lgkmcnt(0)
    ds_read_b128 v[134:137], v155 offset:0
    v_pk_mul_f16 v115, v126, v126
    v_mfma_f32_16x16x32_bf16 v[198:201], a[140:143], v[186:189], v[198:201]
    ds_read_b128 v[142:145], v156 offset:0
    buffer_load_dwordx4 v165, s[52:55], 0 offen offset:1024 lds
    v_mfma_f32_16x16x32_bf16 v[166:169], v[190:193], a[144:147], 0
    ds_read_b128 v[170:173], v155 offset:128
    v_cvt_pk_f16_f32 v127, v204, v205
    v_mfma_f32_16x16x32_bf16 v[166:169], v[194:197], a[148:151], v[166:169]
    ds_read_b128 v[178:181], v156 offset:128
    v_pk_fma_f16 v115, v127, v127, v115
    v_mfma_f32_16x16x32_bf16 v[166:169], v[206:209], a[152:155], v[166:169]
    ds_read_b128 v[182:185], v155 offset:256
    v_cvt_pk_f16_f32 v128, v222, v223
    s_waitcnt vmcnt(5)
    v_mfma_f32_16x16x32_bf16 v[166:169], v[210:213], a[156:159], v[166:169]
    ds_read_b64_tr_b16 a[164:165], v123 offset:3072
    ds_read_b64_tr_b16 a[166:167], v123 offset:3840
    v_mfma_f32_16x16x32_bf16 v[166:169], v[214:217], a[160:163], v[166:169]
    ds_read_b64_tr_b16 a[188:189], v123 offset:3104
    buffer_load_dwordx4 v131, s[52:55], 0 offen offset:2048 lds
    v_mfma_f32_16x16x32_bf16 v[186:189], v[190:193], a[168:171], 0
    s_waitcnt lgkmcnt(7)
    ds_read_b64_tr_b16 a[190:191], v123 offset:3872
    ds_read_b64_tr_b16 a[212:213], v123 offset:3136
    v_mfma_f32_16x16x32_bf16 v[186:189], v[194:197], a[172:175], v[186:189]
    s_add_u32 s52, s52, 12288
    ds_read_b64_tr_b16 a[214:215], v123 offset:3904
    ds_read_b128 v[202:205], v156 offset:256
    v_mfma_f32_16x16x32_bf16 v[186:189], v[206:209], a[176:179], v[186:189]
    s_addc_u32 s53, s53, 0
    v_pk_fma_f16 v115, v128, v128, v115
    v_cvt_pk_f16_f32 v129, v224, v225
    v_mfma_f32_16x16x32_bf16 v[186:189], v[210:213], a[180:183], v[186:189]
    s_add_u32 m0, s68, 0
    v_pk_fma_f16 v115, v129, v129, v115
    v_cvt_pk_f16_f32 v156, v198, v199
    v_mfma_f32_16x16x32_bf16 v[186:189], v[214:217], a[184:187], v[186:189]
    s_waitcnt lgkmcnt(7)
    v_pk_fma_f16 v115, v156, v156, v115
    v_cvt_pk_f16_f32 v157, v200, v201
    v_mfma_f32_16x16x32_bf16 v[198:201], v[190:193], a[192:195], 0
    buffer_load_dwordx4 v164, s[52:55], 0 offen lds
    v_pk_fma_f16 v115, v157, v157, v115
    v_mfma_f32_16x16x32_bf16 v[198:201], v[194:197], a[196:199], v[198:201]
    s_waitcnt lgkmcnt(5)
    v_xor_b32 v255, 65536, v2
    v_lshrrev_b32 v132, 2, v255
    v_mfma_f32_16x16x32_bf16 v[166:169], v[218:221], a[164:167], v[166:169]
    s_waitcnt lgkmcnt(4)
    v_lshrrev_b32 v159, 8, v255
    v_lshl_add_u32 v160, s16, 2, v255
    v_mfma_f32_16x16x32_bf16 v[198:201], v[206:209], a[200:203], v[198:201]
    s_waitcnt lgkmcnt(2)
    v_add_u32 v132, 62784, v132
    v_lshlrev_b32 v159, 4, v159
    v_mfma_f32_16x16x32_bf16 v[186:189], v[218:221], a[188:191], v[186:189]
    s_waitcnt lgkmcnt(0)
    v_cvt_pk_bf16_f32 v166, v166, v166
    v_cvt_pk_bf16_f32 v167, v167, v167
    v_mfma_f32_16x16x32_bf16 v[198:201], v[210:213], a[204:207], v[198:201]
    s_barrier
    ds_write2_b32 v161, v166, v167 offset0:0 offset1:68
    v_mfma_f32_16x16x32_bf16 v[198:201], v[214:217], a[208:211], v[198:201]
    buffer_load_dwordx4 v165, s[52:55], 0 offen offset:1024 lds
    v_cvt_pk_bf16_f32 v168, v168, v168
    v_mfma_f32_16x16x32_bf16 v[198:201], v[218:221], a[212:215], v[198:201]
    v_cvt_pk_bf16_f32 v169, v169, v169
    v_cvt_pk_bf16_f32 v186, v186, v186
    v_mfma_f32_16x16x32_bf16 v[190:193], v[134:137], a[144:147], 0
    ds_write2_b32 v161, v168, v169 offset0:136 offset1:204
    s_waitcnt vmcnt(5)
    v_mfma_f32_16x16x32_bf16 v[190:193], v[142:145], a[148:151], v[190:193]
    v_cvt_pk_bf16_f32 v187, v187, v187
    v_cvt_pk_bf16_f32 v188, v188, v188
    v_mfma_f32_16x16x32_bf16 v[190:193], v[170:173], a[152:155], v[190:193]
    ds_read_b64 a[216:217], v114 offset:0
    ds_read_b64 a[218:219], v114 offset:1536
    v_mfma_f32_16x16x32_bf16 v[190:193], v[178:181], a[156:159], v[190:193]
    buffer_load_dwordx4 v131, s[52:55], 0 offen offset:2048 lds
    ds_read_b64 a[240:241], v114 offset:8
    v_mfma_f32_16x16x32_bf16 v[190:193], v[182:185], a[160:163], v[190:193]
    s_add_u32 s52, s52, 12288
    ds_read_b64 a[242:243], v114 offset:1544
    ds_read_b64 v[90:91], v254 offset:0
    v_mfma_f32_16x16x32_bf16 v[190:193], v[202:205], a[164:167], v[190:193]
    s_addc_u32 s53, s53, 0
    ds_read_b64 v[92:93], v254 offset:1536
    ds_read_b128 v[166:169], v0 offset:26624
    v_mfma_f32_16x16x32_bf16 v[194:197], v[134:137], a[168:171], 0
    s_add_u32 m0, s68, 3072
    ds_read_b128 v[206:209], v1 offset:26624
    v_cvt_pk_bf16_f32 v189, v189, v189
    v_mfma_f32_16x16x32_bf16 v[194:197], v[142:145], a[172:175], v[194:197]
    s_mul_i32 s68, s78, 72
    ds_read_b128 v[210:213], v0 offset:26752
    v_cvt_pk_bf16_f32 v198, v198, v198
    v_mfma_f32_16x16x32_bf16 v[194:197], v[170:173], a[176:179], v[194:197]
    s_sub_u32 s68, s77, s68
    ds_read_b128 v[214:217], v1 offset:26752
    buffer_load_dwordx4 v164, s[52:55], 0 offen lds
    v_mfma_f32_16x16x32_bf16 v[194:197], v[178:181], a[180:183], v[194:197]
    s_mul_i32 s78, s78, 1373568
    ds_read_b128 v[218:221], v0 offset:26880
    v_cvt_pk_bf16_f32 v199, v199, v199
    v_mfma_f32_16x16x32_bf16 v[194:197], v[182:185], a[184:187], v[194:197]
    s_mul_i32 s77, s68, 2688
    ds_read_b128 v[222:225], v1 offset:26880
    v_cvt_pk_bf16_f32 v200, v200, v200
    v_mfma_f32_16x16x32_bf16 v[194:197], v[202:205], a[188:191], v[194:197]
    s_add_u32 s77, s77, s78
    ds_write2_b32 v161, v186, v187 offset0:16 offset1:84
    v_mfma_f32_16x16x32_bf16 v[226:229], v[134:137], a[192:195], 0
    s_waitcnt lgkmcnt(7)
    v_cvt_pk_bf16_f32 v201, v201, v201
    v_cvt_pk_bf16_f32 v190, v190, v190
    v_mfma_f32_16x16x32_bf16 v[226:229], v[142:145], a[196:199], v[226:229]
    s_waitcnt lgkmcnt(5)
    ds_write2_b32 v161, v188, v189 offset0:152 offset1:220
    v_mfma_f32_16x16x32_bf16 v[226:229], v[170:173], a[200:203], v[226:229]
    s_waitcnt lgkmcnt(5)
    buffer_load_dwordx4 v165, s[52:55], 0 offen offset:1024 lds
    v_cvt_pk_bf16_f32 v191, v191, v191
    v_mfma_f32_16x16x32_bf16 v[226:229], v[178:181], a[204:207], v[226:229]
    s_waitcnt lgkmcnt(4)
    ds_write2_b32 v161, v198, v199 offset0:32 offset1:100
    v_mfma_f32_16x16x32_bf16 v[226:229], v[182:185], a[208:211], v[226:229]
    s_waitcnt lgkmcnt(4)
    s_waitcnt vmcnt(5)
    v_cvt_pk_bf16_f32 v192, v192, v192
    v_mfma_f32_16x16x32_bf16 v[226:229], v[202:205], a[212:215], v[226:229]
    s_waitcnt lgkmcnt(3)
    ds_read_b64 a[232:233], v114 offset:3072
    ds_read_b64 a[220:221], v114 offset:4608
    v_mfma_f32_16x16x32_bf16 v[134:137], a[0:3], v[166:169], 0
    ds_read_b64 v[82:83], v114 offset:3080
    ds_read_b64 a[244:245], v114 offset:4616
    v_mfma_f32_16x16x32_bf16 v[134:137], a[4:7], v[206:209], v[134:137]
    buffer_load_dwordx4 v131, s[52:55], 0 offen offset:2048 lds
    ds_read_b64 v[106:107], v254 offset:3072
    v_mfma_f32_16x16x32_bf16 v[134:137], a[8:11], v[210:213], v[134:137]
    s_add_u32 s52, s52, 12288
    ds_read_b64 v[94:95], v254 offset:4608
    v_cvt_pk_bf16_f32 v193, v193, v193
    v_mfma_f32_16x16x32_bf16 v[134:137], a[12:15], v[214:217], v[134:137]
    s_addc_u32 s53, s53, 0
    ds_write2_b32 v161, v200, v201 offset0:168 offset1:236
    v_mfma_f32_16x16x32_bf16 v[134:137], a[16:19], v[218:221], v[134:137]
    s_add_u32 m0, s69, 0
    v_cvt_pk_bf16_f32 v194, v194, v194
    v_cvt_pk_bf16_f32 v195, v195, v195
    v_mfma_f32_16x16x32_bf16 v[134:137], a[20:23], v[222:225], v[134:137]
    ds_write2_b32 v158, v190, v191 offset0:0 offset1:68
    v_mfma_f32_16x16x32_bf16 v[142:145], a[24:27], v[166:169], 0
    s_waitcnt lgkmcnt(6)
    buffer_load_dwordx4 v164, s[52:55], 0 offen lds
    v_cvt_pk_bf16_f32 v196, v196, v196
    v_mfma_f32_16x16x32_bf16 v[142:145], a[28:31], v[206:209], v[142:145]
    s_waitcnt lgkmcnt(4)
    ds_write2_b32 v158, v192, v193 offset0:136 offset1:204
    v_mfma_f32_16x16x32_bf16 v[142:145], a[32:35], v[210:213], v[142:145]
    s_waitcnt lgkmcnt(4)
    v_cvt_pk_bf16_f32 v197, v197, v197
    v_cvt_pk_bf16_f32 v226, v226, v226
    v_mfma_f32_16x16x32_bf16 v[142:145], a[36:39], v[214:217], v[142:145]
    s_waitcnt lgkmcnt(3)
    ds_write2_b32 v158, v194, v195 offset0:16 offset1:84
    v_mfma_f32_16x16x32_bf16 v[142:145], a[40:43], v[218:221], v[142:145]
    v_cvt_pk_bf16_f32 v227, v227, v227
    v_cvt_pk_bf16_f32 v228, v228, v228
    v_mfma_f32_16x16x32_bf16 v[142:145], a[44:47], v[222:225], v[142:145]
    buffer_load_dwordx4 v165, s[52:55], 0 offen offset:1024 lds
    v_cvt_pk_bf16_f32 v229, v229, v229
    v_mfma_f32_16x16x32_bf16 v[170:173], a[48:51], v[166:169], 0
    ds_write2_b32 v158, v196, v197 offset0:152 offset1:220
    v_mfma_f32_16x16x32_bf16 v[170:173], a[52:55], v[206:209], v[170:173]
    v_cvt_pk_f16_f32 v134, v134, v135
    v_pk_mul_f16 v174, v134, v134
    v_mfma_f32_16x16x32_bf16 v[170:173], a[56:59], v[210:213], v[170:173]
    ds_write2_b32 v158, v226, v227 offset0:32 offset1:100
    s_waitcnt vmcnt(5)
    v_mfma_f32_16x16x32_bf16 v[170:173], a[60:63], v[214:217], v[170:173]
    v_cvt_pk_f16_f32 v135, v136, v137
    v_pk_fma_f16 v174, v135, v135, v174
    v_mfma_f32_16x16x32_bf16 v[170:173], a[64:67], v[218:221], v[170:173]
    buffer_load_dwordx4 v131, s[52:55], 0 offen offset:2048 lds
    ds_read_b64 a[222:223], v130 offset:0
    v_mfma_f32_16x16x32_bf16 v[170:173], a[68:71], v[222:225], v[170:173]
    s_add_u32 s52, s52, 12288
    ds_read_b64 a[234:235], v130 offset:1536
    ds_read_b64 a[246:247], v130 offset:8
    v_mfma_f32_16x16x32_bf16 v[178:181], v[166:169], a[144:147], 0
    s_addc_u32 s53, s53, 0
    ds_read_b64 v[84:85], v130 offset:1544
    ds_read_b64 v[96:97], v133 offset:0
    v_mfma_f32_16x16x32_bf16 v[178:181], v[206:209], a[148:151], v[178:181]
    s_add_u32 m0, s69, 3072
    ds_read_b64 v[108:109], v133 offset:1536
    v_cvt_pk_f16_f32 v136, v142, v143
    v_mfma_f32_16x16x32_bf16 v[178:181], v[210:213], a[152:155], v[178:181]
    s_add_u32 s69, s77, 589824
    ds_write2_b32 v158, v228, v229 offset0:168 offset1:236
    v_mfma_f32_16x16x32_bf16 v[178:181], v[214:217], a[156:159], v[178:181]
    buffer_load_dwordx4 v164, s[52:55], 0 offen lds
    v_pk_fma_f16 v174, v136, v136, v174
    v_mfma_f32_16x16x32_bf16 v[178:181], v[218:221], a[160:163], v[178:181]
    v_cvt_pk_f16_f32 v137, v144, v145
    v_pk_fma_f16 v174, v137, v137, v174
    v_mfma_f32_16x16x32_bf16 v[178:181], v[222:225], a[164:167], v[178:181]
    ds_read_b128 v[142:145], v0 offset:20480
    v_cvt_pk_f16_f32 v122, v170, v171
    v_mfma_f32_16x16x32_bf16 v[182:185], v[166:169], a[168:171], 0
    s_waitcnt lgkmcnt(6)
    ds_read_b128 v[186:189], v1 offset:20480
    v_pk_fma_f16 v174, v122, v122, v174
    v_mfma_f32_16x16x32_bf16 v[182:185], v[206:209], a[172:175], v[182:185]
    s_waitcnt lgkmcnt(5)
    ds_read_b128 v[190:193], v0 offset:20608
    v_cvt_pk_f16_f32 v123, v172, v173
    v_mfma_f32_16x16x32_bf16 v[182:185], v[210:213], a[176:179], v[182:185]
    s_waitcnt lgkmcnt(4)
    ds_read_b128 v[170:173], v1 offset:20608
    buffer_load_dwordx4 v165, s[52:55], 0 offen offset:1024 lds
    v_mfma_f32_16x16x32_bf16 v[182:185], v[214:217], a[180:183], v[182:185]
    ds_read_b128 v[194:197], v0 offset:20736
    v_pk_fma_f16 v174, v123, v123, v174
    v_mfma_f32_16x16x32_bf16 v[182:185], v[218:221], a[184:187], v[182:185]
    ds_read_b128 v[198:201], v1 offset:20736
    v_mov_b32 v176, 0
    v_mfma_f32_16x16x32_bf16 v[182:185], v[222:225], a[188:191], v[182:185]
    v_mov_b32 v177, 0
    v_cvt_pk_bf16_f32 v204, v178, v179
    v_mfma_f32_16x16x32_bf16 v[226:229], v[166:169], a[192:195], 0
    v_cvt_pk_bf16_f32 v205, v180, v181
    s_waitcnt vmcnt(5)
    v_mfma_f32_16x16x32_f16 v[166:169], v[40:43], v[174:177], 0
    s_waitcnt lgkmcnt(5)
    ds_read_b64 a[224:225], v130 offset:3072
    ds_read_b64 a[226:227], v130 offset:4608
    v_mfma_f32_16x16x32_bf16 v[226:229], v[206:209], a[196:199], v[226:229]
    s_waitcnt lgkmcnt(6)
    buffer_load_dwordx4 v131, s[52:55], 0 offen offset:2048 lds
    ds_read_b64 a[248:249], v130 offset:3080
    v_mfma_f32_16x16x32_bf16 v[226:229], v[210:213], a[200:203], v[226:229]
    s_add_u32 m0, s28, 65536
    ds_read_b64 a[250:251], v130 offset:4616
    ds_read_b64 v[98:99], v133 offset:3072
    v_mfma_f32_16x16x32_bf16 v[226:229], v[214:217], a[204:207], v[226:229]
    s_waitcnt lgkmcnt(7)
    ds_read_b64 v[100:101], v133 offset:4608
    v_cvt_pk_bf16_f32 v168, v182, v183
    v_mfma_f32_16x16x32_bf16 v[226:229], v[218:221], a[208:211], v[226:229]
    s_waitcnt lgkmcnt(7)
    v_rsq_f32 v166, v166
    v_mfma_f32_16x16x32_bf16 v[226:229], v[222:225], a[212:215], v[226:229]
    s_waitcnt lgkmcnt(6)
    v_rsq_f32 v167, v167
    v_mfma_f32_16x16x32_bf16 v[174:177], v[142:145], a[144:147], 0
    v_mul_f32 v116, s31, v166
    v_cvt_pk_f16_f32 v117, v116, v167
    v_mfma_f32_16x16x32_bf16 v[174:177], v[186:189], a[148:151], v[174:177]
    buffer_load_dwordx4 v10, s[8:11], s24 offen nt lds
    v_mfma_f32_16x16x32_bf16 v[174:177], v[190:193], a[152:155], v[174:177]
    s_add_u32 m0, s28, 69632
    v_pk_mul_f16 v150, v150, v117 op_sel:[0,1] op_sel_hi:[1,1]
    v_pk_mul_f16 v151, v151, v117 op_sel:[0,1] op_sel_hi:[1,1]
    v_mfma_f32_16x16x32_bf16 v[174:177], v[170:173], a[156:159], v[174:177]
    s_waitcnt lgkmcnt(3)
    v_pk_mul_f16 v152, v152, v117 op_sel:[0,1] op_sel_hi:[1,1]
    v_pk_mul_f16 v153, v153, v117 op_sel:[0,1] op_sel_hi:[1,1]
    v_mfma_f32_16x16x32_bf16 v[174:177], v[194:197], a[160:163], v[174:177]
    s_waitcnt lgkmcnt(1)
    v_pk_mul_f16 v124, v124, v117 op_sel:[0,1] op_sel_hi:[1,1]
    v_pk_mul_f16 v125, v125, v117 op_sel:[0,1] op_sel_hi:[1,1]
    v_mfma_f32_16x16x32_bf16 v[174:177], v[198:201], a[164:167], v[174:177]
    s_waitcnt lgkmcnt(0)
    ds_read_b128 v[178:181], v0 offset:32768
    v_pk_mul_f16 v134, v134, v117 op_sel:[0,0] op_sel_hi:[1,0]
    v_mfma_f32_16x16x32_bf16 v[206:209], v[142:145], a[168:171], 0
    ds_read_b128 v[210:213], v1 offset:32768
    v_pk_mul_f16 v135, v135, v117 op_sel:[0,0] op_sel_hi:[1,0]
    v_mfma_f32_16x16x32_bf16 v[206:209], v[186:189], a[172:175], v[206:209]
    buffer_load_dwordx4 v11, s[8:11], s24 offen nt lds
    v_mfma_f32_16x16x32_bf16 v[206:209], v[190:193], a[176:179], v[206:209]
    s_add_u32 m0, s28, 73728
    ds_read_b128 v[214:217], v0 offset:32896
    ds_read_b128 v[218:221], v1 offset:32896
    v_mfma_f32_16x16x32_bf16 v[206:209], v[170:173], a[180:183], v[206:209]
    ds_read_b128 v[222:225], v0 offset:33024
    v_pk_mul_f16 v136, v136, v117 op_sel:[0,0] op_sel_hi:[1,0]
    v_mfma_f32_16x16x32_bf16 v[206:209], v[194:197], a[184:187], v[206:209]
    ds_read_b128 v[230:233], v1 offset:33024
    s_waitcnt vmcnt(5)
    v_mfma_f32_16x16x32_bf16 v[206:209], v[198:201], a[188:191], v[206:209]
    ds_read_b64 a[236:237], v114 offset:0
    ds_read_b64 a[228:229], v114 offset:1536
    v_mfma_f32_16x16x32_bf16 v[234:237], v[142:145], a[192:195], 0
    ds_read_b64 v[86:87], v114 offset:8
    ds_read_b64 a[252:253], v114 offset:1544
    v_mfma_f32_16x16x32_bf16 v[234:237], v[186:189], a[196:199], v[234:237]
    s_waitcnt lgkmcnt(9)
    buffer_load_dwordx4 v12, s[8:11], s24 offen nt lds
    v_mfma_f32_16x16x32_bf16 v[234:237], v[190:193], a[200:203], v[234:237]
    s_add_u32 m0, s28, 77824
    ds_read_b64 v[110:111], v254 offset:0
    ds_read_b64 v[102:103], v254 offset:1536
    v_mfma_f32_16x16x32_bf16 v[234:237], v[170:173], a[204:207], v[234:237]
    s_waitcnt lgkmcnt(10)
    ds_read_b128 v[142:145], v154 offset:0
    ds_read_b128 v[170:173], v154 offset:16
    v_mfma_f32_16x16x32_bf16 v[234:237], v[194:197], a[208:211], v[234:237]
    s_waitcnt lgkmcnt(10)
    ds_read_b128 v[186:189], v154 offset:48
    ds_read_b32 v158, v6 offset:192
    v_mfma_f32_16x16x32_bf16 v[234:237], v[198:201], a[212:215], v[234:237]
    s_waitcnt lgkmcnt(11)
    v_pk_mul_f16 v137, v137, v117 op_sel:[0,0] op_sel_hi:[1,0]
    v_pk_mul_f16 v122, v122, v117 op_sel:[0,0] op_sel_hi:[1,0]
    v_mfma_f32_16x16x32_bf16 v[190:193], a[0:3], v[178:181], 0
    s_waitcnt lgkmcnt(10)
    v_pk_mul_f16 v123, v123, v117 op_sel:[0,0] op_sel_hi:[1,0]
    v_max3_u32 v44, v44, v166, v167
    v_mfma_f32_16x16x32_bf16 v[190:193], a[4:7], v[210:213], v[190:193]
    s_waitcnt lgkmcnt(8)
    buffer_load_dwordx4 v13, s[8:11], s24 offen nt lds
    v_mfma_f32_16x16x32_bf16 v[190:193], a[8:11], v[214:217], v[190:193]
    s_add_u32 m0, s74, 0
    v_cvt_pk_bf16_f32 v169, v184, v185
    v_cvt_pk_bf16_f32 v184, v226, v227
    v_mfma_f32_16x16x32_bf16 v[190:193], a[12:15], v[218:221], v[190:193]
    s_waitcnt lgkmcnt(6)
    v_cvt_pk_bf16_f32 v185, v228, v229
    v_cvt_pk_bf16_f32 v202, v174, v175
    v_mfma_f32_16x16x32_bf16 v[190:193], a[16:19], v[222:225], v[190:193]
    s_waitcnt lgkmcnt(4)
    v_cvt_pk_bf16_f32 v203, v176, v177
    v_cvt_pk_bf16_f32 v166, v206, v207
    v_mfma_f32_16x16x32_bf16 v[190:193], a[20:23], v[230:233], v[190:193]
    s_waitcnt lgkmcnt(2)
    v_cvt_pk_bf16_f32 v167, v208, v209
    v_cvt_pk_bf16_f32 v182, v234, v235
    v_mfma_f32_16x16x32_bf16 v[174:177], a[24:27], v[178:181], 0
    s_waitcnt lgkmcnt(0)
    v_cvt_pk_bf16_f32 v183, v236, v237
    v_xor_b32 v0, 65536, v0
    v_mfma_f32_16x16x32_bf16 v[174:177], a[28:31], v[210:213], v[174:177]
    buffer_load_dwordx4 v14, s[8:11], s24 offen nt lds
    v_mfma_f32_16x16x32_bf16 v[174:177], a[32:35], v[214:217], v[174:177]
    s_add_u32 s8, s60, s23
    v_cvt_pk_f16_f32 v190, v190, v191
    s_waitcnt vmcnt(5)
    v_mfma_f32_16x16x32_bf16 v[174:177], a[36:39], v[218:221], v[174:177]
    s_addc_u32 s9, s61, 0
    ds_read_b64 a[230:231], v114 offset:3072
    ds_read_b64 a[238:239], v114 offset:4608
    v_mfma_f32_16x16x32_bf16 v[174:177], a[40:43], v[222:225], v[174:177]
    s_sub_u32 s10, s36, s23
    ds_read_b64 a[254:255], v114 offset:3080
    ds_read_b64 v[88:89], v114 offset:4616
    v_mfma_f32_16x16x32_bf16 v[174:177], a[44:47], v[230:233], v[174:177]
    s_cmp_lt_u32 s34, s17
    ds_read_b64 v[104:105], v254 offset:3072
    ds_read_b64 v[112:113], v254 offset:4608
    v_mfma_f32_16x16x32_bf16 v[194:197], a[48:51], v[178:181], 0
    s_cselect_b32 s10, s10, 0
    v_pk_mul_f16 v114, v190, v190
    v_cvt_pk_f16_f32 v191, v192, v193
    v_mfma_f32_16x16x32_bf16 v[194:197], a[52:55], v[210:213], v[194:197]
    s_add_u32 m0, s28, 0
    v_pk_fma_f16 v114, v191, v191, v114
    v_cvt_pk_f16_f32 v192, v174, v175
    v_mfma_f32_16x16x32_f16 v[198:201], v[146:149], v[138:141], v[46:49]
    s_mov_b32 s24, s23
    v_pk_fma_f16 v114, v192, v192, v114
    v_cvt_pk_f16_f32 v193, v176, v177
    v_mfma_f32_16x16x32_f16 v[174:177], v[150:153], v[138:141], v[50:53]
    s_add_u32 s23, s23, s21
    v_pk_fma_f16 v114, v193, v193, v114
    v_xor_b32 v1, 65536, v1
    v_add_u32 v159, 62784, v159
    v_mfma_f32_16x16x16_f16 v[198:201], v[120:121], v[118:119], v[198:201]
    v_or_b32 v206, v32, v33
    v_and_b32 v206, 0xffff, v206
    v_lshl_or_b32 v206, v206, 16, v206
    v_mfma_f32_16x16x16_f16 v[174:177], v[124:125], v[118:119], v[174:177]
    v_or_b32 v207, v32, v33
    v_and_b32 v207, 0xffff, v207
    v_lshl_or_b32 v207, v207, 16, v207
    v_or_b32 v208, v32, v33
    v_mfma_f32_16x16x32_bf16 v[194:197], a[56:59], v[214:217], v[194:197]
    s_cmp_ge_u32 s19, 72
    v_exp_f32 v198, v198
    v_mfma_f32_16x16x32_bf16 v[194:197], a[60:63], v[218:221], v[194:197]
    s_cselect_b32 s34, 72, 0
    v_exp_f32 v199, v199
    v_mfma_f32_16x16x32_bf16 v[194:197], a[64:67], v[222:225], v[194:197]
    s_cselect_b32 s35, s22, 0
    v_cvt_pk_bf16_f32 v198, v198, v199
    v_lshrrev_b32 v208, 16, v208
    v_mfma_f32_16x16x32_bf16 v[194:197], a[68:71], v[230:233], v[194:197]
    s_sub_u32 s19, s19, s34
    v_mov_b32 v116, 0
    v_mov_b32 v117, 0
    v_mfma_f32_16x16x32_bf16 v[226:229], v[178:181], a[144:147], 0
    s_add_u32 s23, s23, s35
    v_exp_f32 v200, v200
    v_mfma_f32_16x16x32_bf16 v[226:229], v[210:213], a[148:151], v[226:229]
    s_waitcnt lgkmcnt(0)
    v_cvt_pk_f16_f32 v154, v194, v195
    v_pk_fma_f16 v114, v154, v154, v114
    v_mfma_f32_16x16x32_bf16 v[226:229], v[214:217], a[152:155], v[226:229]
    v_cvt_pk_f16_f32 v155, v196, v197
    v_pk_fma_f16 v114, v155, v155, v114
    v_mfma_f32_16x16x32_bf16 v[226:229], v[218:221], a[156:159], v[226:229]
    v_exp_f32 v201, v201
    v_mfma_f32_16x16x32_f16 v[194:197], v[40:43], v[114:117], 0
    v_cvt_pk_bf16_f32 v199, v200, v201
    v_lshl_or_b32 v208, v208, 16, v208
    v_mfma_f32_16x16x32_f16 v[114:117], v[142:145], v[138:141], v[22:25]
    v_exp_f32 v174, v174
    v_mfma_f32_16x16x32_f16 v[114:117], v[170:173], v[146:149], v[114:117]
    v_exp_f32 v175, v175
    v_mfma_f32_16x16x32_f16 v[114:117], v[186:189], v[118:121], v[114:117]
    v_cvt_pk_bf16_f32 v200, v174, v175
    v_or_b32 v209, v32, v33
    v_mfma_f32_16x16x32_bf16 v[226:229], v[222:225], a[160:163], v[226:229]
    v_rsq_f32 v194, v194
    v_mfma_f32_16x16x32_bf16 v[226:229], v[230:233], a[164:167], v[226:229]
    v_rsq_f32 v195, v195
    v_mfma_f32_16x16x32_bf16 v[234:237], v[178:181], a[168:171], 0
    v_mul_f32 v164, s31, v194
    v_cvt_pk_f16_f32 v165, v164, v195
    v_mfma_f32_16x16x32_bf16 v[234:237], v[210:213], a[172:175], v[234:237]
    v_pk_mul_f16 v126, v126, v165 op_sel:[0,1] op_sel_hi:[1,1]
    v_pk_mul_f16 v127, v127, v165 op_sel:[0,1] op_sel_hi:[1,1]
    v_mfma_f32_16x16x32_bf16 v[234:237], v[214:217], a[176:179], v[234:237]
    v_pk_mul_f16 v128, v128, v165 op_sel:[0,1] op_sel_hi:[1,1]
    v_pk_mul_f16 v129, v129, v165 op_sel:[0,1] op_sel_hi:[1,1]
    v_mfma_f32_16x16x32_bf16 v[234:237], v[218:221], a[180:183], v[234:237]
    v_pk_mul_f16 v156, v156, v165 op_sel:[0,1] op_sel_hi:[1,1]
    v_pk_mul_f16 v157, v157, v165 op_sel:[0,1] op_sel_hi:[1,1]
    v_mfma_f32_16x16x32_bf16 v[234:237], v[222:225], a[184:187], v[234:237]
    v_pk_mul_f16 v190, v190, v165 op_sel:[0,0] op_sel_hi:[1,0]
    v_pk_mul_f16 v191, v191, v165 op_sel:[0,0] op_sel_hi:[1,0]
    v_mfma_f32_16x16x32_bf16 v[234:237], v[230:233], a[188:191], v[234:237]
    v_pk_mul_f16 v192, v192, v165 op_sel:[0,0] op_sel_hi:[1,0]
    v_pk_mul_f16 v193, v193, v165 op_sel:[0,0] op_sel_hi:[1,0]
    v_pk_mul_f16 v154, v154, v165 op_sel:[0,0] op_sel_hi:[1,0]
    v_pk_mul_f16 v155, v155, v165 op_sel:[0,0] op_sel_hi:[1,0]
    v_mfma_f32_16x16x32_f16 v[238:241], v[126:129], v[138:141], v[54:57]
    v_max3_u32 v44, v44, v194, v195
    v_cvt_pk_bf16_f32 v138, v226, v227
    v_mfma_f32_16x16x32_f16 v[194:197], v[142:145], v[134:137], v[24:27]
    v_cvt_pk_bf16_f32 v139, v228, v229
    v_cvt_pk_bf16_f32 v174, v234, v235
    v_mfma_f32_16x16x32_f16 v[194:197], v[170:173], v[150:153], v[194:197]
    v_cvt_pk_bf16_f32 v175, v236, v237
    v_mov_b32_dpp v158, v115 quad_perm:[0,1,2,3] row_mask:0x1 bank_mask:0xf
    v_mov_b32 v25, 0
    v_mfma_f32_16x16x16_f16 v[238:241], v[156:157], v[118:119], v[238:241]
    v_exp_f32 v176, v176
    v_exp_f32 v177, v177
    v_mfma_f32_16x16x32_f16 v[194:197], v[186:189], v[122:125], v[194:197]
    v_cvt_pk_bf16_f32 v201, v176, v177
    v_lshrrev_b32 v209, 16, v209
    v_mfma_f32_16x16x32_bf16 v[226:229], v[178:181], a[192:195], 0
    v_exp_f32 v114, v114
    v_mfma_f32_16x16x32_bf16 v[226:229], v[210:213], a[196:199], v[226:229]
    ds_read2_b32 v[140:141], v6 offset0:0 offset1:0
    ds_read2_b32 v[176:177], v6 offset0:16 offset1:16
    v_mfma_f32_16x16x32_bf16 v[226:229], v[214:217], a[200:203], v[226:229]
    ds_read2_b32 v[116:117], v6 offset0:32 offset1:32
    v_add_u32 v6, 272, v6
    v_mfma_f32_16x16x32_f16 v[178:181], v[142:145], v[190:193], v[26:29]
    v_mov_b32_dpp v158, v195 quad_perm:[0,1,2,3] row_mask:0x2 bank_mask:0xf
    v_cvt_pk_bf16_f32 v39, v114, 0
    v_mfma_f32_16x16x32_f16 v[178:181], v[170:173], v[126:129], v[178:181]
    v_exp_f32 v194, v194
    v_mfma_f32_16x16x32_f16 v[178:181], v[186:189], v[154:157], v[178:181]
    v_exp_f32 v238, v238
    v_mfma_f32_16x16x32_bf16 v[226:229], v[218:221], a[204:207], v[226:229]
    v_exp_f32 v239, v239
    v_mfma_f32_16x16x32_bf16 v[226:229], v[222:225], a[208:211], v[226:229]
    v_cvt_pk_bf16_f32 v36, v238, v239
    v_lshl_or_b32 v209, v209, 16, v209
    v_mfma_f32_16x16x32_bf16 v[226:229], v[230:233], a[212:215], v[226:229]
    v_exp_f32 v240, v240
    v_mfma_f32_16x16x32_f16 v[142:145], v[146:149], v[134:137], v[58:61]
    s_waitcnt lgkmcnt(1)
    v_mov_b32_dpp v158, v179 quad_perm:[0,1,2,3] row_mask:0x4 bank_mask:0xf
    v_xor_b32 v2, 65536, v2
    v_mfma_f32_16x16x32_f16 v[170:173], v[150:153], v[134:137], v[62:65]
    s_waitcnt lgkmcnt(0)
    v_exp_f32 v158, v158
    v_mfma_f32_16x16x32_f16 v[186:189], v[126:129], v[134:137], v[66:69]
    v_cvt_pk_bf16_f32 v114, v226, v227
    v_cvt_pk_bf16_f32 v115, v228, v229
    v_cvt_pk_bf16_f32 v158, v158, v158
    v_mfma_f32_16x16x16_f16 v[142:145], v[120:121], v[122:123], v[142:145]
    v_exp_f32 v241, v241
    v_mfma_f32_16x16x16_f16 v[170:173], v[124:125], v[122:123], v[170:173]
    ds_write_b16 v8, v158
    v_cvt_pk_bf16_f32 v37, v240, v241
    v_mfma_f32_16x16x16_f16 v[186:189], v[156:157], v[122:123], v[186:189]
    v_exp_f32 v178, v178
    v_mfma_f32_16x16x32_bf16 v[134:137], v[28:31], v[36:39], 0
    v_mfma_f32_16x16x32_bf16 v[134:137], v[28:31], v[198:201], v[134:137]
    v_exp_f32 v142, v142
    v_mfma_f32_16x16x32_bf16 v[210:213], v[138:141], v[36:39], 0
    v_exp_f32 v143, v143
    v_mfma_f32_16x16x32_bf16 v[210:213], v[202:205], v[198:201], v[210:213]
    v_exp_f32 v144, v144
    v_mfma_f32_16x16x32_bf16 v[214:217], v[174:177], v[36:39], 0
    v_exp_f32 v145, v145
    v_mfma_f32_16x16x32_bf16 v[214:217], v[166:169], v[198:201], v[214:217]
    v_cvt_pk_bf16_f32 v142, v142, v143
    v_cvt_pk_bf16_f32 v143, v144, v145
    v_mfma_f32_16x16x32_bf16 v[218:221], v[114:117], v[36:39], 0
    v_exp_f32 v170, v170
    v_mfma_f32_16x16x32_bf16 v[218:221], v[182:185], v[198:201], v[218:221]
    v_exp_f32 v171, v171
    v_mfma_f32_16x16x32_f16 v[198:201], v[146:149], v[190:193], v[70:73]
    v_cvt_pk_bf16_f32 v144, v170, v171
    v_cvt_pk_bf16_f32 v39, v194, 0
    v_mfma_f32_16x16x32_f16 v[146:149], v[150:153], v[190:193], v[74:77]
    v_exp_f32 v172, v172
    v_mfma_f32_16x16x32_f16 v[150:153], v[126:129], v[190:193], v[78:81]
    v_exp_f32 v173, v173
    v_mfma_f32_16x16x16_f16 v[198:201], v[120:121], v[154:155], v[198:201]
    v_cvt_pk_bf16_f32 v145, v172, v173
    v_exp_f32 v186, v186
    v_mfma_f32_16x16x16_f16 v[146:149], v[124:125], v[154:155], v[146:149]
    v_exp_f32 v187, v187
    v_mfma_f32_16x16x16_f16 v[150:153], v[156:157], v[154:155], v[150:153]
    v_cvt_pk_bf16_f32 v36, v186, v187
    v_exp_f32 v188, v188
    v_mfma_f32_16x16x32_bf16 v[118:121], v[206:209], a[216:219], 0
    v_exp_f32 v189, v189
    v_mfma_f32_16x16x32_bf16 v[118:121], v[206:209], a[240:243], v[118:121]
    v_rcp_f32 v134, v134
    v_mfma_f32_16x16x32_bf16 v[118:121], v[206:209], v[90:93], v[118:121]
    v_cvt_pk_bf16_f32 v37, v188, v189
    v_max3_u32 v25, v25, v134, v135
    v_mfma_f32_16x16x32_bf16 v[122:125], v[206:209], a[220:223], 0
    v_mul_f32 v210, v134, v210
    v_mul_f32 v211, v134, v211
    v_mfma_f32_16x16x32_bf16 v[126:129], v[28:31], v[36:39], 0
    v_cvt_pk_bf16_f32 v154, v210, v211
    v_mul_f32 v212, v134, v212
    v_mfma_f32_16x16x32_bf16 v[126:129], v[28:31], v[142:145], v[126:129]
    v_mov_b32 v254, v118
    v_mul_f32 v213, v134, v213
    v_mfma_f32_16x16x32_bf16 v[170:173], v[138:141], v[36:39], 0
    v_mov_b32_dpp v254, v119 quad_perm:[0,1,2,3] row_mask:0x2 bank_mask:0xf
    v_cvt_pk_bf16_f32 v155, v212, v213
    v_mfma_f32_16x16x32_bf16 v[170:173], v[202:205], v[142:145], v[170:173]
    v_mul_f32 v214, v134, v214
    v_mul_f32 v215, v134, v215
    v_mfma_f32_16x16x32_bf16 v[210:213], v[174:177], v[36:39], 0
    v_cvt_pk_bf16_f32 v156, v214, v215
    v_mul_f32 v216, v134, v216
    v_mfma_f32_16x16x32_bf16 v[210:213], v[166:169], v[142:145], v[210:213]
    v_mul_f32 v217, v134, v217
    v_cvt_pk_bf16_f32 v157, v216, v217
    v_mfma_f32_16x16x32_bf16 v[214:217], v[114:117], v[36:39], 0
    v_mul_f32 v218, v134, v218
    v_mul_f32 v219, v134, v219
    v_mfma_f32_16x16x32_bf16 v[214:217], v[182:185], v[142:145], v[214:217]
    v_cvt_pk_bf16_f32 v164, v218, v219
    v_mul_f32 v220, v134, v220
    v_mfma_f32_16x16x32_bf16 v[122:125], v[206:209], a[244:247], v[122:125]
    v_mul_f32 v221, v134, v221
    v_cvt_pk_bf16_f32 v165, v220, v221
    v_mfma_f32_16x16x32_bf16 v[122:125], v[206:209], v[94:97], v[122:125]
    v_exp_f32 v198, v198
    v_mfma_f32_16x16x32_bf16 v[118:121], v[206:209], a[232:235], 0
    v_exp_f32 v199, v199
    v_mfma_f32_16x16x32_bf16 v[118:121], v[206:209], v[82:85], v[118:121]
    v_cvt_pk_bf16_f32 v134, v198, v199
    v_cvt_pk_bf16_f32 v39, v178, 0
    v_mfma_f32_16x16x32_bf16 v[118:121], v[206:209], v[106:109], v[118:121]
    v_exp_f32 v200, v200
    v_mfma_f32_16x16x32_bf16 v[142:145], v[206:209], a[224:227], 0
    v_exp_f32 v201, v201
    v_mfma_f32_16x16x32_bf16 v[142:145], v[206:209], a[248:251], v[142:145]
    v_mov_b32 v137, v123
    v_cvt_pk_bf16_f32 v135, v200, v201
    v_mfma_f32_16x16x32_bf16 v[142:145], v[206:209], v[98:101], v[142:145]
    v_exp_f32 v146, v146
    v_mfma_f32_16x16x32_bf16 v[178:181], v[206:209], a[228:231], 0
    v_mov_b32_dpp v254, v118 quad_perm:[0,1,2,3] row_mask:0x4 bank_mask:0xf
    v_mov_b32_dpp v137, v119 quad_perm:[0,1,2,3] row_mask:0x2 bank_mask:0xf
    v_mfma_f32_16x16x32_bf16 v[178:181], v[206:209], a[252:255], v[178:181]
    v_exp_f32 v147, v147
    v_mfma_f32_16x16x32_bf16 v[178:181], v[206:209], v[102:105], v[178:181]
    v_mov_b32_dpp v254, v122 quad_perm:[0,1,2,3] row_mask:0x8 bank_mask:0xf
    v_mov_b32_dpp v137, v142 quad_perm:[0,1,2,3] row_mask:0x4 bank_mask:0xf
    v_mfma_f32_16x16x32_bf16 v[118:121], v[206:209], a[236:239], 0
    ds_write_b32 v160, v254 offset:18432
    v_mfma_f32_16x16x32_bf16 v[118:121], v[206:209], v[86:89], v[118:121]
    v_mov_b32_dpp v137, v143 quad_perm:[0,1,2,3] row_mask:0x8 bank_mask:0xf
    v_cvt_pk_bf16_f32 v136, v146, v147
    v_mfma_f32_16x16x32_bf16 v[118:121], v[206:209], v[110:113], v[118:121]
    ds_write_b32 v160, v137 offset:19456
    v_exp_f32 v148, v148
    v_exp_f32 v149, v149
    v_exp_f32 v150, v150
    v_cvt_pk_bf16_f32 v137, v148, v149
    v_exp_f32 v151, v151
    v_exp_f32 v152, v152
    v_cvt_pk_bf16_f32 v36, v150, v151
    v_mov_b32 v254, v118
    v_exp_f32 v153, v153
    ds_read_b128 v[122:125], v9
    ds_read_b128 v[142:145], v9 offset:64
    v_mov_b32_dpp v254, v178 quad_perm:[0,1,2,3] row_mask:0x2 bank_mask:0xf
    v_cvt_pk_bf16_f32 v37, v152, v153
    v_rcp_f32 v126, v126
    v_mov_b32_dpp v254, v179 quad_perm:[0,1,2,3] row_mask:0x4 bank_mask:0xf
    v_mfma_f32_16x16x32_bf16 v[146:149], v[28:31], v[36:39], 0
    v_max3_u32 v25, v25, v126, v127
    v_mov_b32_dpp v254, v119 quad_perm:[0,1,2,3] row_mask:0x8 bank_mask:0xf
    v_mfma_f32_16x16x32_bf16 v[146:149], v[28:31], v[134:137], v[146:149]
    ds_write_b32 v160, v254 offset:63552
    v_mfma_f32_16x16x32_bf16 v[118:121], v[138:141], v[36:39], 0
    v_mul_f32 v170, v126, v170
    v_mul_f32 v171, v126, v171
    v_mfma_f32_16x16x32_bf16 v[118:121], v[202:205], v[134:137], v[118:121]
    v_cvt_pk_bf16_f32 v130, v170, v171
    v_mul_f32 v172, v126, v172
    v_mfma_f32_16x16x32_bf16 v[150:153], v[174:177], v[36:39], 0
    v_rcp_f32 v146, v146
    v_mfma_f32_16x16x32_bf16 v[150:153], v[166:169], v[134:137], v[150:153]
    s_waitcnt lgkmcnt(2)
    v_max3_u32 v25, v25, v146, v147
    v_mul_f32 v173, v126, v173
    v_mfma_f32_16x16x32_bf16 v[178:181], v[122:125], v[28:31], 0
    s_waitcnt lgkmcnt(1)
    v_mul_f32 v118, v146, v118
    v_mul_f32 v119, v146, v119
    v_mfma_f32_16x16x32_bf16 v[178:181], v[142:145], v[28:31], v[178:181]
    v_cvt_pk_bf16_f32 v206, v118, v119
    v_mul_f32 v120, v146, v120
    v_mfma_f32_16x16x32_bf16 v[218:221], v[122:125], v[202:205], 0
    v_mul_f32 v121, v146, v121
    v_cvt_pk_bf16_f32 v207, v120, v121
    v_mfma_f32_16x16x32_bf16 v[218:221], v[142:145], v[138:141], v[218:221]
    s_waitcnt lgkmcnt(0)
    v_mul_f32 v150, v146, v150
    v_mul_f32 v151, v146, v151
    v_mfma_f32_16x16x32_bf16 v[138:141], v[122:125], v[166:169], 0
    s_barrier
    s_waitcnt vmcnt(0)
    ds_read_b128 v[166:169], v255 offset:18432
    v_mfma_f32_16x16x32_bf16 v[138:141], v[142:145], v[174:177], v[138:141]
    s_barrier
    ds_read_b128 v[186:189], v0 offset:20480
    ds_read_b128 v[194:197], v1 offset:20480
    v_mfma_f32_16x16x32_bf16 v[174:177], v[122:125], v[182:185], 0
    ds_read_b128 v[122:125], v0 offset:20608
    buffer_load_dwordx4 v10, s[8:11], 0 offen nt lds
    v_mfma_f32_16x16x32_bf16 v[174:177], v[142:145], v[114:117], v[174:177]
    s_add_u32 m0, s28, 4096
    ds_read_b128 v[202:205], v1 offset:20608
    v_cvt_pk_bf16_f32 v208, v150, v151
    v_mfma_f32_16x16x32_bf16 v[142:145], v[114:117], v[36:39], 0
    ds_read_b128 v[230:233], v0 offset:20736
    v_mul_f32 v152, v146, v152
    v_mfma_f32_16x16x32_bf16 v[142:145], v[182:185], v[134:137], v[142:145]
    ds_read_b128 v[238:241], v1 offset:20736
    ds_read_b128 v[114:117], v255 offset:19456
    ds_read_b128 v[134:137], v255 offset:63552
    ds_write_b128 v3, v[154:157] offset:0
    s_waitcnt lgkmcnt(7)
    v_mfma_f32_16x16x32_bf16 v[118:121], a[72:75], v[186:189], 0
    s_waitcnt lgkmcnt(6)
    buffer_load_dwordx4 v11, s[8:11], 0 offen nt lds
    v_add_f32 v166, v166, v167
    v_mfma_f32_16x16x32_bf16 v[118:121], a[76:79], v[194:197], v[118:121]
    s_add_u32 m0, s28, 8192
    v_add_f32 v168, v168, v169
    v_add_f32 v166, v166, v168
    v_mfma_f32_16x16x32_bf16 v[118:121], a[80:83], v[122:125], v[118:121]
    s_waitcnt lgkmcnt(4)
    ds_write_b64 v4, v[164:165] offset:4096
    v_mfma_f32_16x16x32_bf16 v[118:121], a[84:87], v[202:205], v[118:121]
    s_waitcnt lgkmcnt(3)
    v_mul_f32 v166, 0xbbaaaaab, v166
    v_add_f32 v114, v114, v115
    v_mfma_f32_16x16x32_bf16 v[118:121], a[88:91], v[230:233], v[118:121]
    s_waitcnt lgkmcnt(2)
    ds_write_b32 v132, v166 offset:0
    v_mfma_f32_16x16x32_bf16 v[118:121], a[92:95], v[238:241], v[118:121]
    buffer_load_dwordx4 v12, s[8:11], 0 offen nt lds
    v_add_f32 v116, v116, v117
    v_mfma_f32_16x16x32_bf16 v[190:193], a[96:99], v[186:189], 0
    s_add_u32 m0, s28, 12288
    ds_read_b128 v[154:157], v159 offset:0
    ds_read_b128 v[166:169], v159 offset:64
    v_mfma_f32_16x16x32_bf16 v[190:193], a[100:103], v[194:197], v[190:193]
    s_xor_b32 s28, s28, 65536
    ds_read_b128 v[182:185], v159 offset:128
    ds_read_b128 v[222:225], v159 offset:192
    v_mfma_f32_16x16x32_bf16 v[190:193], a[104:107], v[122:125], v[190:193]
    v_add_f32 v114, v114, v116
    v_mul_f32 v114, 0xbbaaaaab, v114
    v_mfma_f32_16x16x32_bf16 v[190:193], a[108:111], v[202:205], v[190:193]
    ds_write_b32 v132, v114 offset:256
    v_mfma_f32_16x16x32_bf16 v[190:193], a[112:115], v[230:233], v[190:193]
    v_add_f32 v134, v134, v135
    v_add_f32 v136, v136, v137
    v_mfma_f32_16x16x32_bf16 v[190:193], a[116:119], v[238:241], v[190:193]
    buffer_load_dwordx4 v13, s[8:11], 0 offen nt lds
    v_add_f32 v134, v134, v136
    v_mfma_f32_16x16x32_bf16 v[198:201], a[120:123], v[186:189], 0
    s_mov_b32 m0, s29
    v_mul_f32 v134, 0xbbaaaaab, v134
    v_mul_f32 v153, v146, v153
    v_mfma_f32_16x16x32_bf16 v[198:201], a[124:127], v[194:197], v[198:201]
    s_xor_b32 s29, s29, s30
    ds_write_b32 v132, v134 offset:512
    v_mfma_f32_16x16x32_bf16 v[198:201], a[128:131], v[122:125], v[198:201]
    s_waitcnt lgkmcnt(4)
    v_rcp_f32 v178, v178
    v_cvt_pk_bf16_f32 v209, v152, v153
    v_mfma_f32_16x16x16_bf16 v[114:117], a[216:217], v[162:163], v[154:157]
    v_max3_u32 v25, v25, v178, v179
    v_mul_f32 v218, v218, v178
    v_mul_f32 v142, v146, v142
    v_mfma_f32_16x16x16_bf16 v[134:137], a[240:241], v[162:163], v[154:157]
    v_mul_f32_dpp v218, v138, v178 quad_perm:[0,1,2,3] row_mask:0x2 bank_mask:0xf
    v_mul_f32 v143, v146, v143
    v_cvt_pk_bf16_f32 v164, v142, v143
    v_mfma_f32_16x16x16_bf16 v[138:141], v[90:91], v[162:163], v[154:157]
    v_cvt_pk_bf16_f32 v114, v114, v115
    v_accvgpr_write_b32 a216, v114
    v_cvt_pk_bf16_f32 v116, v116, v117
    v_mfma_f32_16x16x16_bf16 v[150:153], a[218:219], v[162:163], v[166:169]
    v_accvgpr_write_b32 a217, v116
    v_cvt_pk_bf16_f32 v134, v134, v135
    v_accvgpr_write_b32 a240, v134
    v_mfma_f32_16x16x16_bf16 v[114:117], a[242:243], v[162:163], v[166:169]
    v_cvt_pk_bf16_f32 v136, v136, v137
    v_accvgpr_write_b32 a241, v136
    v_cvt_pk_bf16_f32 v90, v138, v139
    v_mfma_f32_16x16x16_bf16 v[134:137], v[92:93], v[162:163], v[166:169]
    v_cvt_pk_bf16_f32 v91, v140, v141
    v_cvt_pk_bf16_f32 v150, v150, v151
    v_accvgpr_write_b32 a218, v150
    v_cvt_pk_bf16_f32 v152, v152, v153
    v_mfma_f32_16x16x32_bf16 v[198:201], a[132:135], v[202:205], v[198:201]
    s_waitcnt lgkmcnt(0)
    buffer_load_dwordx4 v14, s[8:11], 0 offen nt lds
    ds_read_b128 v[138:141], v159 offset:256
    v_accvgpr_write_b32 a219, v152
    v_mfma_f32_16x16x16_bf16 v[150:153], a[232:233], v[162:163], v[182:185]
    v_cvt_pk_bf16_f32 v114, v114, v115
    v_accvgpr_write_b32 a242, v114
    v_cvt_pk_bf16_f32 v116, v116, v117
    v_mfma_f32_16x16x16_bf16 v[154:157], v[82:83], v[162:163], v[182:185]
    v_accvgpr_write_b32 a243, v116
    v_cvt_pk_bf16_f32 v92, v134, v135
    v_cvt_pk_bf16_f32 v93, v136, v137
    v_mfma_f32_16x16x16_bf16 v[114:117], v[106:107], v[162:163], v[182:185]
    v_cvt_pk_bf16_f32 v150, v150, v151
    v_accvgpr_write_b32 a232, v150
    v_cvt_pk_bf16_f32 v152, v152, v153
    v_mfma_f32_16x16x16_bf16 v[134:137], a[220:221], v[162:163], v[222:225]
    v_accvgpr_write_b32 a233, v152
    v_cvt_pk_bf16_f32 v82, v154, v155
    v_cvt_pk_bf16_f32 v83, v156, v157
    v_mfma_f32_16x16x16_bf16 v[150:153], a[244:245], v[162:163], v[222:225]
    v_cvt_pk_bf16_f32 v106, v114, v115
    v_cvt_pk_bf16_f32 v107, v116, v117
    v_mul_f32_dpp v218, v174, v178 quad_perm:[0,1,2,3] row_mask:0x4 bank_mask:0xf
    v_mfma_f32_16x16x16_bf16 v[114:117], v[94:95], v[162:163], v[222:225]
    v_cvt_pk_bf16_f32 v134, v134, v135
    v_accvgpr_write_b32 a220, v134
    v_cvt_pk_bf16_f32 v136, v136, v137
    v_accvgpr_write_b32 a221, v136
    v_mfma_f32_16x16x32_bf16 v[198:201], a[136:139], v[230:233], v[198:201]
    s_waitcnt lgkmcnt(0)
    ds_read_b128 v[134:137], v159 offset:320
    ds_read_b128 v[154:157], v159 offset:384
    v_cvt_pk_bf16_f32 v150, v150, v151
    v_mfma_f32_16x16x16_bf16 v[166:169], a[222:223], v[162:163], v[138:141]
    v_accvgpr_write_b32 a244, v150
    v_cvt_pk_bf16_f32 v152, v152, v153
    v_accvgpr_write_b32 a245, v152
    v_mfma_f32_16x16x16_bf16 v[150:153], a[246:247], v[162:163], v[138:141]
    v_cvt_pk_bf16_f32 v94, v114, v115
    v_cvt_pk_bf16_f32 v95, v116, v117
    v_cvt_pk_bf16_f32 v218, v218, v218
    v_mfma_f32_16x16x16_bf16 v[114:117], v[96:97], v[162:163], v[138:141]
    v_cvt_pk_bf16_f32 v166, v166, v167
    v_accvgpr_write_b32 a222, v166
    v_cvt_pk_bf16_f32 v168, v168, v169
    v_accvgpr_write_b32 a223, v168
    v_mfma_f32_16x16x32_bf16 v[198:201], a[140:143], v[238:241], v[198:201]
    ds_read_b128 v[166:169], v159 offset:448
    v_cvt_pk_bf16_f32 v150, v150, v151
    v_mfma_f32_16x16x32_bf16 v[138:141], a[0:3], v[186:189], 0
    ds_write_b128 v3, v[206:209] offset:12288
    v_mfma_f32_16x16x32_bf16 v[138:141], a[4:7], v[194:197], v[138:141]
    s_waitcnt lgkmcnt(3)
    v_accvgpr_write_b32 a246, v150
    v_cvt_pk_bf16_f32 v152, v152, v153
    v_accvgpr_write_b32 a247, v152
    v_mfma_f32_16x16x16_bf16 v[150:153], a[234:235], v[162:163], v[134:137]
    v_cvt_pk_bf16_f32 v96, v114, v115
    v_cvt_pk_bf16_f32 v97, v116, v117
    v_mul_f32 v144, v146, v144
    v_mfma_f32_16x16x16_bf16 v[114:117], v[84:85], v[162:163], v[134:137]
    v_mul_f32 v145, v146, v145
    v_cvt_pk_bf16_f32 v165, v144, v145
    v_cvt_pk_bf16_f32 v131, v172, v173
    v_mfma_f32_16x16x16_bf16 v[142:145], v[108:109], v[162:163], v[134:137]
    v_cvt_pk_bf16_f32 v150, v150, v151
    v_accvgpr_write_b32 a234, v150
    v_cvt_pk_bf16_f32 v152, v152, v153
    v_accvgpr_write_b32 a235, v152
    v_mfma_f32_16x16x32_bf16 v[138:141], a[8:11], v[122:125], v[138:141]
    s_waitcnt lgkmcnt(1)
    ds_read_b128 v[134:137], v159 offset:512
    ds_write_b64 v4, v[164:165] offset:16384
    v_mfma_f32_16x16x16_bf16 v[146:149], a[224:225], v[162:163], v[154:157]
    v_cvt_pk_bf16_f32 v84, v114, v115
    v_cvt_pk_bf16_f32 v85, v116, v117
    v_cvt_pk_bf16_f32 v108, v142, v143
    v_mfma_f32_16x16x16_bf16 v[114:117], a[248:249], v[162:163], v[154:157]
    v_cvt_pk_bf16_f32 v109, v144, v145
    v_mul_f32 v210, v126, v210
    v_mul_f32 v211, v126, v211
    v_mfma_f32_16x16x16_bf16 v[142:145], v[98:99], v[162:163], v[154:157]
    v_cvt_pk_bf16_f32 v146, v146, v147
    v_accvgpr_write_b32 a224, v146
    v_cvt_pk_bf16_f32 v148, v148, v149
    v_mfma_f32_16x16x16_bf16 v[150:153], a[226:227], v[162:163], v[166:169]
    v_accvgpr_write_b32 a225, v148
    v_cvt_pk_bf16_f32 v114, v114, v115
    v_accvgpr_write_b32 a248, v114
    v_mfma_f32_16x16x16_bf16 v[146:149], a[250:251], v[162:163], v[166:169]
    v_cvt_pk_bf16_f32 v116, v116, v117
    v_accvgpr_write_b32 a249, v116
    v_cvt_pk_bf16_f32 v98, v142, v143
    v_mfma_f32_16x16x16_bf16 v[114:117], v[100:101], v[162:163], v[166:169]
    v_cvt_pk_bf16_f32 v99, v144, v145
    v_cvt_pk_bf16_f32 v150, v150, v151
    v_accvgpr_write_b32 a226, v150
    v_cvt_pk_bf16_f32 v152, v152, v153
    v_mfma_f32_16x16x32_bf16 v[138:141], a[12:15], v[202:205], v[138:141]
    s_waitcnt lgkmcnt(0)
    ds_read_b128 v[142:145], v159 offset:576
    ds_read_b128 v[154:157], v159 offset:640
    v_accvgpr_write_b32 a227, v152
    v_mfma_f32_16x16x16_bf16 v[150:153], a[236:237], v[162:163], v[134:137]
    v_cvt_pk_bf16_f32 v146, v146, v147
    v_accvgpr_write_b32 a250, v146
    v_cvt_pk_bf16_f32 v148, v148, v149
    v_mfma_f32_16x16x16_bf16 v[170:173], v[86:87], v[162:163], v[134:137]
    v_accvgpr_write_b32 a251, v148
    v_cvt_pk_bf16_f32 v100, v114, v115
    v_cvt_pk_bf16_f32 v101, v116, v117
    v_mfma_f32_16x16x16_bf16 v[114:117], v[110:111], v[162:163], v[134:137]
    v_cvt_pk_bf16_f32 v150, v150, v151
    v_accvgpr_write_b32 a236, v150
    v_cvt_pk_bf16_f32 v152, v152, v153
    v_accvgpr_write_b32 a237, v152
    v_mfma_f32_16x16x32_bf16 v[138:141], a[16:19], v[230:233], v[138:141]
    ds_read_b128 v[134:137], v159 offset:704
    v_cvt_pk_bf16_f32 v86, v170, v171
    v_mfma_f32_16x16x32_bf16 v[138:141], a[20:23], v[238:241], v[138:141]
    ds_write_b16 v7, v218
    v_mfma_f32_16x16x32_bf16 v[166:169], a[24:27], v[186:189], 0
    v_add_u32 v7, 16, v7
    v_cvt_pk_bf16_f32 v87, v172, v173
    v_mfma_f32_16x16x32_bf16 v[166:169], a[28:31], v[194:197], v[166:169]
    s_waitcnt lgkmcnt(2)
    v_cvt_pk_bf16_f32 v110, v114, v115
    v_cvt_pk_bf16_f32 v111, v116, v117
    v_cvt_pk_bf16_f32 v132, v210, v211
    v_mfma_f32_16x16x16_bf16 v[114:117], a[228:229], v[162:163], v[142:145]
    v_mul_f32 v212, v126, v212
    v_mul_f32 v213, v126, v213
    v_cvt_pk_bf16_f32 v133, v212, v213
    v_mfma_f32_16x16x16_bf16 v[146:149], a[252:253], v[162:163], v[142:145]
    v_mul_f32 v214, v126, v214
    v_mul_f32 v215, v126, v215
    v_cvt_pk_bf16_f32 v254, v214, v215
    v_mfma_f32_16x16x16_bf16 v[150:153], v[102:103], v[162:163], v[142:145]
    v_cvt_pk_bf16_f32 v114, v114, v115
    v_accvgpr_write_b32 a228, v114
    v_cvt_pk_bf16_f32 v116, v116, v117
    v_mfma_f32_16x16x16_bf16 v[158:161], a[230:231], v[162:163], v[154:157]
    v_accvgpr_write_b32 a229, v116
    v_cvt_pk_bf16_f32 v146, v146, v147
    v_accvgpr_write_b32 a252, v146
    v_mfma_f32_16x16x16_bf16 v[114:117], a[254:255], v[162:163], v[154:157]
    v_cvt_pk_bf16_f32 v148, v148, v149
    v_accvgpr_write_b32 a253, v148
    v_cvt_pk_bf16_f32 v102, v150, v151
    v_mfma_f32_16x16x16_bf16 v[142:145], v[104:105], v[162:163], v[154:157]
    v_cvt_pk_bf16_f32 v103, v152, v153
    v_cvt_pk_bf16_f32 v158, v158, v159
    v_accvgpr_write_b32 a230, v158
    v_cvt_pk_bf16_f32 v160, v160, v161
    v_mfma_f32_16x16x32_bf16 v[166:169], a[32:35], v[122:125], v[166:169]
    s_waitcnt lgkmcnt(0)
    ds_write_b128 v3, v[130:133] offset:6144
    v_mfma_f32_16x16x16_bf16 v[130:133], a[238:239], v[162:163], v[134:137]
    v_accvgpr_write_b32 a231, v160
    v_cvt_pk_bf16_f32 v114, v114, v115
    v_accvgpr_write_b32 a254, v114
    v_mfma_f32_16x16x16_bf16 v[146:149], v[88:89], v[162:163], v[134:137]
    v_cvt_pk_bf16_f32 v116, v116, v117
    v_accvgpr_write_b32 a255, v116
    v_cvt_pk_bf16_f32 v104, v142, v143
    v_mfma_f32_16x16x16_bf16 v[114:117], v[112:113], v[162:163], v[134:137]
    v_cvt_pk_bf16_f32 v105, v144, v145
    v_cvt_pk_bf16_f32 v130, v130, v131
    v_accvgpr_write_b32 a238, v130
    v_cvt_pk_bf16_f32 v132, v132, v133
    v_mfma_f32_16x16x32_bf16 v[166:169], a[36:39], v[202:205], v[166:169]
    v_accvgpr_write_b32 a239, v132
    v_cvt_pk_bf16_f32 v88, v146, v147
    v_mfma_f32_16x16x32_bf16 v[166:169], a[40:43], v[230:233], v[166:169]
    v_cvt_pk_bf16_f32 v89, v148, v149
    v_cvt_pk_bf16_f32 v112, v114, v115
    v_mfma_f32_16x16x32_bf16 v[166:169], a[44:47], v[238:241], v[166:169]
    v_cvt_pk_bf16_f32 v113, v116, v117
    v_mul_f32 v216, v126, v216
    v_mfma_f32_16x16x32_bf16 v[134:137], a[48:51], v[186:189], 0
    v_mul_f32 v217, v126, v217
    v_cvt_pk_bf16_f32 v255, v216, v217
    v_mfma_f32_16x16x32_bf16 v[134:137], a[52:55], v[194:197], v[134:137]
    ds_write_b64 v4, v[254:255] offset:10240
    v_cvt_pk_f16_f32 v146, v118, v119
    v_pk_mul_f16 v143, v146, v146
    v_cvt_pk_f16_f32 v147, v120, v121
    v_pk_fma_f16 v143, v147, v147, v143
    v_cvt_pk_f16_f32 v148, v190, v191
    v_pk_fma_f16 v143, v148, v148, v143
    v_cvt_pk_f16_f32 v149, v192, v193
    v_pk_fma_f16 v143, v149, v149, v143
    v_cvt_pk_f16_f32 v120, v198, v199
    v_pk_fma_f16 v143, v120, v120, v143
    v_cvt_pk_f16_f32 v121, v200, v201
    v_pk_fma_f16 v143, v121, v121, v143
    v_xor_b32 v3, 65536, v3
    v_xor_b32 v4, 65536, v4
    s_waitcnt lgkmcnt(0)
    s_barrier
L_go:
    s_waitcnt lgkmcnt(0)
    s_and_b32 s3, s2, 0xf8
    s_add_u32 s64, s42, s3
    s_addc_u32 s65, s43, 0
    s_mov_b32 s67, 0x00020000
    s_cmp_eq_u32 s16, 1
    s_cbranch_scc1 L_loop_fast1
    s_cmp_eq_u32 s16, 2
    s_cbranch_scc1 L_loop_fast2
    s_cmp_eq_u32 s16, 3
    s_cbranch_scc1 L_loop_fast3
    s_branch L_loop_fast0
.p2align 6
L_loop_fast0:
    v_mfma_f32_16x16x32_bf16 v[134:137], a[56:59], v[122:125], v[134:137]
    s_add_u32 s12, s40, s27
    ds_read_b128 v[190:193], v2 offset:18432
    v_cvt_pk_f16_f32 v150, v138, v139
    v_mfma_f32_16x16x32_bf16 v[134:137], a[60:63], v[202:205], v[134:137]
    s_addc_u32 s13, s41, 0
    ds_read_b128 v[210:213], v2 offset:19456
    v_pk_mul_f16 v142, v150, v150
    v_mfma_f32_16x16x32_bf16 v[134:137], a[64:67], v[230:233], v[134:137]
    s_sub_u32 s14, s36, s27
    ds_read_b128 v[174:177], v5 offset:32
    v_cvt_pk_f16_f32 v151, v140, v141
    v_mfma_f32_16x16x32_bf16 v[134:137], a[68:71], v[238:241], v[134:137]
    s_cmp_ge_u32 s18, 2
    ds_read2_b64 v[162:165], v5 offset0:6 offset1:9
    v_pk_fma_f16 v142, v151, v151, v142
    v_mfma_f32_16x16x32_bf16 v[138:141], v[186:189], a[144:147], 0
    s_cselect_b32 s14, s14, 0
    ds_read_b128 v[170:173], v5
    v_cvt_pk_f16_f32 v152, v166, v167
    v_mfma_f32_16x16x32_bf16 v[138:141], v[194:197], a[148:151], v[138:141]
    s_sub_u32 s82, s72, s71
    ds_read_b32 v254, v6 offset:192
    v_pk_fma_f16 v142, v152, v152, v142
    v_mfma_f32_16x16x32_bf16 v[138:141], v[122:125], a[152:155], v[138:141]
    s_mul_i32 s74, s82, 336
    v_cvt_pk_f16_f32 v153, v168, v169
    v_pk_fma_f16 v142, v153, v153, v142
    v_mfma_f32_16x16x32_bf16 v[138:141], v[202:205], a[156:159], v[138:141]
    s_mul_i32 s75, s82, 272
    v_cvt_pk_f16_f32 v118, v134, v135
    v_pk_fma_f16 v142, v118, v118, v142
    v_mfma_f32_16x16x32_bf16 v[138:141], v[230:233], a[160:163], v[138:141]
    s_waitcnt lgkmcnt(5)
    ds_read_b128 v[182:185], v0 offset:26624
    v_cvt_pk_f16_f32 v119, v136, v137
    v_mfma_f32_16x16x32_bf16 v[166:169], v[32:35], v[190:193], 0
    s_waitcnt lgkmcnt(5)
    v_pk_fma_f16 v142, v119, v119, v142
    v_add_u32 v5, s74, v5
    v_mfma_f32_16x16x32_bf16 v[166:169], v[32:35], v[210:213], v[166:169]
    s_waitcnt lgkmcnt(4)
    v_pk_mul_f16 v145, v146, v174
    v_pk_fma_f16 v145, v147, v175, v145
    v_mfma_f32_16x16x32_bf16 v[138:141], v[238:241], a[164:167], v[138:141]
    s_mul_i32 s76, s82, 16
    ds_read_b128 v[210:213], v1 offset:26624
    v_pk_fma_f16 v145, v148, v176, v145
    v_mfma_f32_16x16x32_bf16 v[214:217], v[186:189], a[168:171], 0
    s_waitcnt lgkmcnt(3)
    ds_read_b128 v[218:221], v0 offset:26752
    v_pk_fma_f16 v145, v149, v177, v145
    v_mfma_f32_16x16x32_bf16 v[214:217], v[194:197], a[172:175], v[214:217]
    s_waitcnt lgkmcnt(3)
    ds_read_b128 v[222:225], v1 offset:26752
    v_mov_b32_dpp v254, v23 quad_perm:[0,1,2,3] row_mask:0x7 bank_mask:0xf
    v_mfma_f32_16x16x32_bf16 v[214:217], v[122:125], a[176:179], v[214:217]
    s_add_u32 s34, s18, 2
    ds_read_b128 v[226:229], v0 offset:26880
    v_pk_fma_f16 v145, v120, v164, v145
    v_mfma_f32_16x16x32_bf16 v[214:217], v[202:205], a[180:183], v[214:217]
    s_add_u32 s8, s60, s23
    ds_read_b128 v[190:193], v1 offset:26880
    v_pk_fma_f16 v145, v121, v165, v145
    v_mfma_f32_16x16x32_bf16 v[214:217], v[230:233], a[184:187], v[214:217]
    s_waitcnt lgkmcnt(5)
    v_pk_mul_f16 v144, v150, v170
    v_pk_fma_f16 v144, v151, v171, v144
    v_mfma_f32_16x16x32_bf16 v[214:217], v[238:241], a[188:191], v[214:217]
    s_addc_u32 s9, s61, 0
    v_pk_fma_f16 v144, v152, v172, v144
    v_pk_fma_f16 v144, v153, v173, v144
    v_mfma_f32_16x16x32_bf16 v[246:249], v[186:189], a[192:195], 0
    s_sub_u32 s10, s36, s23
    v_pk_fma_f16 v144, v118, v162, v144
    v_pk_fma_f16 v144, v119, v163, v144
    v_mfma_f32_16x16x32_bf16 v[246:249], v[194:197], a[196:199], v[246:249]
    s_cmp_le_u32 s34, s45
    v_cvt_pk_bf16_f32 v134, v138, v139
    v_cvt_pk_bf16_f32 v135, v140, v141
    v_mfma_f32_16x16x32_f16 v[234:237], v[40:43], v[142:145], 0
    s_cselect_b32 s10, s10, 0
    v_cvt_pk_bf16_f32 v138, v214, v215
    v_cvt_pk_bf16_f32 v139, v216, v217
    v_mfma_f32_16x16x32_bf16 v[246:249], v[122:125], a[200:203], v[246:249]
    s_add_u32 m0, s28, 0
    v_mul_f32 v136, 0x3baaaaab, v166
    v_mul_f32 v255, 0x3baaaaab, v167
    v_mfma_f32_16x16x32_bf16 v[246:249], v[202:205], a[204:207], v[246:249]
    s_mov_b32 s27, s26
    v_rsq_f32 v234, v234
    v_mfma_f32_16x16x32_bf16 v[246:249], v[230:233], a[208:211], v[246:249]
    s_mov_b32 s26, s25
    v_rsq_f32 v235, v235
    v_mfma_f32_16x16x32_bf16 v[246:249], v[238:241], a[212:215], v[246:249]
    s_mov_b32 s25, s24
    v_mul_f32 v140, s31, v234
    v_cvt_pk_f16_f32 v141, v140, v235
    v_mfma_f32_16x16x32_bf16 v[122:125], a[72:75], v[182:185], 0
    s_waitcnt lgkmcnt(0)
    v_fma_f32 v236, v236, v140, v22
    v_fmac_f32_dpp v254, v237, v235 quad_perm:[0,1,2,3] row_mask:0x1 bank_mask:0xf
    v_mfma_f32_16x16x32_bf16 v[122:125], a[76:79], v[210:213], v[122:125]
    s_mov_b32 s24, s23
    v_cvt_pk_bf16_f32 v142, v246, v247
    v_cvt_pk_bf16_f32 v143, v248, v249
    v_mfma_f32_16x16x32_bf16 v[122:125], a[80:83], v[218:221], v[122:125]
    s_mov_b32 s71, s72
    v_pk_mul_f16 v146, v146, v141 op_sel:[0,1] op_sel_hi:[1,1]
    v_pk_mul_f16 v147, v147, v141 op_sel:[0,1] op_sel_hi:[1,1]
    v_mfma_f32_16x16x32_bf16 v[122:125], a[84:87], v[222:225], v[122:125]
    s_mov_b32 s72, s73
    v_pk_mul_f16 v148, v148, v141 op_sel:[0,1] op_sel_hi:[1,1]
    v_pk_mul_f16 v149, v149, v141 op_sel:[0,1] op_sel_hi:[1,1]
    v_mfma_f32_16x16x32_bf16 v[122:125], a[88:91], v[226:229], v[122:125]
    v_pk_mul_f16 v120, v120, v141 op_sel:[0,1] op_sel_hi:[1,1]
    v_pk_mul_f16 v121, v121, v141 op_sel:[0,1] op_sel_hi:[1,1]
    v_mfma_f32_16x16x32_bf16 v[122:125], a[92:95], v[190:193], v[122:125]
    v_pk_mul_f16 v150, v150, v141 op_sel:[0,0] op_sel_hi:[1,0]
    v_pk_mul_f16 v151, v151, v141 op_sel:[0,0] op_sel_hi:[1,0]
    v_mfma_f32_16x16x32_bf16 v[186:189], a[96:99], v[182:185], 0
    v_pk_mul_f16 v152, v152, v141 op_sel:[0,0] op_sel_hi:[1,0]
    v_pk_mul_f16 v153, v153, v141 op_sel:[0,0] op_sel_hi:[1,0]
    v_mfma_f32_16x16x32_bf16 v[186:189], a[100:103], v[210:213], v[186:189]
    v_pk_mul_f16 v118, v118, v141 op_sel:[0,0] op_sel_hi:[1,0]
    v_pk_mul_f16 v119, v119, v141 op_sel:[0,0] op_sel_hi:[1,0]
    v_mfma_f32_16x16x32_bf16 v[186:189], a[104:107], v[218:221], v[186:189]
    v_max3_u32 v44, v44, v234, v235
    v_mul_f32 v144, 0x3baaaaab, v168
    v_mfma_f32_16x16x32_bf16 v[186:189], a[108:111], v[222:225], v[186:189]
    v_rsq_f32 v136, v136
    v_mfma_f32_16x16x32_bf16 v[186:189], a[112:115], v[226:229], v[186:189]
    v_rsq_f32 v255, v255
    v_mfma_f32_16x16x32_bf16 v[186:189], a[116:119], v[190:193], v[186:189]
    v_rsq_f32 v144, v144
    v_mfma_f32_16x16x32_bf16 v[194:197], a[120:123], v[182:185], 0
    v_mul_f32 v178, v136, v178
    v_mul_f32 v179, v136, v179
    v_mfma_f32_16x16x32_bf16 v[194:197], a[124:127], v[210:213], v[194:197]
    v_cvt_pk_bf16_f32 v166, v178, v179
    v_mul_f32 v180, v136, v180
    v_mfma_f32_16x16x32_bf16 v[194:197], a[128:131], v[218:221], v[194:197]
    v_mul_f32 v181, v136, v181
    v_cvt_pk_bf16_f32 v167, v180, v181
    v_mfma_f32_16x16x32_bf16 v[194:197], a[132:135], v[222:225], v[194:197]
    v_mul_f32 v198, v136, v198
    v_mul_f32 v199, v136, v199
    v_mfma_f32_16x16x32_bf16 v[194:197], a[136:139], v[226:229], v[194:197]
    v_cvt_pk_bf16_f32 v168, v198, v199
    v_mul_f32 v200, v136, v200
    v_mfma_f32_16x16x32_bf16 v[194:197], a[140:143], v[190:193], v[194:197]
    v_mul_f32 v201, v136, v201
    v_cvt_pk_bf16_f32 v169, v200, v201
    v_mfma_f32_16x16x32_bf16 v[178:181], a[0:3], v[182:185], 0
    buffer_store_dwordx4 v[166:169], v15, s[12:15], 0 offen nt
    v_mul_f32 v206, v136, v206
    v_mul_f32 v207, v136, v207
    v_cvt_pk_bf16_f32 v140, v206, v207
    v_mul_f32 v208, v136, v208
    v_mfma_f32_16x16x32_bf16 v[178:181], a[4:7], v[210:213], v[178:181]
    v_mul_f32 v209, v136, v209
    v_cvt_pk_bf16_f32 v141, v208, v209
    v_mfma_f32_16x16x32_bf16 v[178:181], a[8:11], v[218:221], v[178:181]
    v_cvt_pk_f16_f32 v166, v122, v123
    v_pk_mul_f16 v199, v166, v166
    v_mfma_f32_16x16x32_bf16 v[178:181], a[12:15], v[222:225], v[178:181]
    v_cvt_pk_f16_f32 v167, v124, v125
    v_pk_fma_f16 v199, v167, v167, v199
    v_mfma_f32_16x16x32_bf16 v[178:181], a[16:19], v[226:229], v[178:181]
    v_cvt_pk_f16_f32 v168, v186, v187
    v_pk_fma_f16 v199, v168, v168, v199
    v_mfma_f32_16x16x32_bf16 v[178:181], a[20:23], v[190:193], v[178:181]
    v_cvt_pk_f16_f32 v169, v188, v189
    v_pk_fma_f16 v199, v169, v169, v199
    v_mfma_f32_16x16x32_bf16 v[186:189], a[24:27], v[182:185], 0
    v_cvt_pk_f16_f32 v124, v194, v195
    v_pk_fma_f16 v199, v124, v124, v199
    v_mfma_f32_16x16x32_bf16 v[186:189], a[28:31], v[210:213], v[186:189]
    v_cvt_pk_f16_f32 v125, v196, v197
    v_pk_fma_f16 v199, v125, v125, v199
    v_mfma_f32_16x16x32_bf16 v[186:189], a[32:35], v[218:221], v[186:189]
    v_cvt_pk_f16_f32 v178, v178, v179
    v_pk_mul_f16 v198, v178, v178
    v_mfma_f32_16x16x32_bf16 v[186:189], a[36:39], v[222:225], v[186:189]
    v_cvt_pk_f16_f32 v179, v180, v181
    v_pk_fma_f16 v198, v179, v179, v198
    v_mfma_f32_16x16x32_bf16 v[186:189], a[40:43], v[226:229], v[186:189]
    v_pk_mul_f16 v200, v178, v170
    v_pk_fma_f16 v200, v179, v171, v200
    v_mfma_f32_16x16x32_bf16 v[186:189], a[44:47], v[190:193], v[186:189]
    v_pk_mul_f16 v201, v166, v174
    v_pk_fma_f16 v201, v167, v175, v201
    v_mfma_f32_16x16x32_bf16 v[194:197], a[48:51], v[182:185], 0
    v_pk_fma_f16 v201, v168, v176, v201
    v_pk_fma_f16 v201, v169, v177, v201
    v_mfma_f32_16x16x32_bf16 v[194:197], a[52:55], v[210:213], v[194:197]
    v_pk_fma_f16 v201, v124, v164, v201
    v_pk_fma_f16 v201, v125, v165, v201
    v_mfma_f32_16x16x32_bf16 v[194:197], a[56:59], v[218:221], v[194:197]
    v_cvt_pk_f16_f32 v180, v186, v187
    v_pk_fma_f16 v198, v180, v180, v198
    v_mfma_f32_16x16x32_bf16 v[194:197], a[60:63], v[222:225], v[194:197]
    v_cvt_pk_f16_f32 v181, v188, v189
    v_pk_fma_f16 v198, v181, v181, v198
    v_mfma_f32_16x16x32_bf16 v[194:197], a[64:67], v[226:229], v[194:197]
    v_pk_fma_f16 v200, v180, v172, v200
    v_pk_fma_f16 v200, v181, v173, v200
    v_mfma_f32_16x16x32_bf16 v[194:197], a[68:71], v[190:193], v[194:197]
    buffer_store_dwordx2 v[140:141], v18, s[12:15], 0 offen nt
    v_mul_f32 v242, v144, v242
    v_mul_f32 v243, v144, v243
    v_mfma_f32_16x16x32_bf16 v[186:189], v[182:185], a[144:147], 0
    v_cvt_pk_bf16_f32 v238, v242, v243
    v_mul_f32 v244, v144, v244
    v_mfma_f32_16x16x32_bf16 v[186:189], v[210:213], a[148:151], v[186:189]
    v_mul_f32 v245, v144, v245
    v_cvt_pk_f16_f32 v122, v194, v195
    v_mfma_f32_16x16x32_bf16 v[186:189], v[218:221], a[152:155], v[186:189]
    v_pk_fma_f16 v198, v122, v122, v198
    v_cvt_pk_f16_f32 v123, v196, v197
    v_mfma_f32_16x16x32_bf16 v[186:189], v[222:225], a[156:159], v[186:189]
    v_pk_fma_f16 v198, v123, v123, v198
    v_pk_fma_f16 v200, v122, v162, v200
    v_mfma_f32_16x16x32_bf16 v[186:189], v[226:229], a[160:163], v[186:189]
    ds_read_b128 v[202:205], v0 offset:32768
    v_pk_fma_f16 v200, v123, v163, v200
    v_mfma_f32_16x16x32_bf16 v[186:189], v[190:193], a[164:167], v[186:189]
    ds_read_b128 v[194:197], v1 offset:32768
    v_cvt_pk_bf16_f32 v239, v244, v245
    v_mfma_f32_16x16x32_f16 v[230:233], v[40:43], v[198:201], 0
    v_mul_f32 v158, v144, v158
    v_mul_f32 v159, v144, v159
    v_mfma_f32_16x16x32_bf16 v[246:249], v[182:185], a[168:171], 0
    ds_read_b128 v[214:217], v0 offset:32896
    v_cvt_pk_bf16_f32 v240, v158, v159
    v_mfma_f32_16x16x32_bf16 v[246:249], v[210:213], a[172:175], v[246:249]
    ds_read_b128 v[206:209], v1 offset:32896
    v_cvt_pk_bf16_f32 v136, v186, v187
    v_mfma_f32_16x16x32_bf16 v[246:249], v[218:221], a[176:179], v[246:249]
    ds_read_b128 v[198:201], v0 offset:33024
    v_cvt_pk_bf16_f32 v137, v188, v189
    v_mfma_f32_16x16x32_bf16 v[246:249], v[222:225], a[180:183], v[246:249]
    ds_read_b128 v[186:189], v1 offset:33024
    v_mul_f32 v160, v144, v160
    v_mfma_f32_16x16x32_bf16 v[246:249], v[226:229], a[184:187], v[246:249]
    v_rsq_f32 v230, v230
    v_mfma_f32_16x16x32_bf16 v[246:249], v[190:193], a[188:191], v[246:249]
    s_waitcnt lgkmcnt(5)
    v_rsq_f32 v231, v231
    v_mfma_f32_16x16x32_bf16 v[242:245], v[182:185], a[192:195], 0
    s_waitcnt lgkmcnt(4)
    v_mul_f32 v234, s31, v230
    v_cvt_pk_f16_f32 v235, v234, v231
    v_mfma_f32_16x16x32_bf16 v[242:245], v[210:213], a[196:199], v[242:245]
    v_fma_f32 v232, v232, v234, v24
    v_fmac_f32_dpp v254, v233, v231 quad_perm:[0,1,2,3] row_mask:0x2 bank_mask:0xf
    v_mfma_f32_16x16x32_bf16 v[242:245], v[218:221], a[200:203], v[242:245]
    s_waitcnt lgkmcnt(3)
    v_cvt_pk_bf16_f32 v140, v246, v247
    v_cvt_pk_bf16_f32 v141, v248, v249
    v_mfma_f32_16x16x32_bf16 v[242:245], v[222:225], a[204:207], v[242:245]
    s_waitcnt lgkmcnt(2)
    v_mul_f32 v161, v144, v161
    v_cvt_pk_bf16_f32 v241, v160, v161
    v_mfma_f32_16x16x32_bf16 v[242:245], v[226:229], a[208:211], v[242:245]
    s_waitcnt lgkmcnt(1)
    buffer_store_dwordx4 v[238:241], v17, s[12:15], 0 offen nt
    v_mul_f32 v154, v144, v154
    v_mul_f32 v155, v144, v155
    v_cvt_pk_bf16_f32 v154, v154, v155
    v_mul_f32 v156, v144, v156
    v_mfma_f32_16x16x32_bf16 v[242:245], v[190:193], a[212:215], v[242:245]
    s_waitcnt lgkmcnt(0)
    v_mul_f32 v157, v144, v157
    v_cvt_pk_bf16_f32 v155, v156, v157
    v_mfma_f32_16x16x32_bf16 v[158:161], a[72:75], v[202:205], 0
    v_pk_mul_f16 v166, v166, v235 op_sel:[0,1] op_sel_hi:[1,1]
    v_pk_mul_f16 v167, v167, v235 op_sel:[0,1] op_sel_hi:[1,1]
    v_mfma_f32_16x16x32_bf16 v[158:161], a[76:79], v[194:197], v[158:161]
    v_pk_mul_f16 v168, v168, v235 op_sel:[0,1] op_sel_hi:[1,1]
    v_cvt_pk_bf16_f32 v144, v242, v243
    v_mfma_f32_16x16x32_bf16 v[158:161], a[80:83], v[214:217], v[158:161]
    v_cvt_pk_bf16_f32 v145, v244, v245
    v_pk_mul_f16 v169, v169, v235 op_sel:[0,1] op_sel_hi:[1,1]
    v_mfma_f32_16x16x32_bf16 v[158:161], a[84:87], v[206:209], v[158:161]
    v_pk_mul_f16 v124, v124, v235 op_sel:[0,1] op_sel_hi:[1,1]
    v_pk_mul_f16 v125, v125, v235 op_sel:[0,1] op_sel_hi:[1,1]
    v_mfma_f32_16x16x32_bf16 v[158:161], a[88:91], v[198:201], v[158:161]
    v_pk_mul_f16 v178, v178, v235 op_sel:[0,0] op_sel_hi:[1,0]
    v_pk_mul_f16 v179, v179, v235 op_sel:[0,0] op_sel_hi:[1,0]
    v_mfma_f32_16x16x32_bf16 v[158:161], a[92:95], v[186:189], v[158:161]
    v_pk_mul_f16 v180, v180, v235 op_sel:[0,0] op_sel_hi:[1,0]
    v_pk_mul_f16 v181, v181, v235 op_sel:[0,0] op_sel_hi:[1,0]
    v_mfma_f32_16x16x32_bf16 v[182:185], a[96:99], v[202:205], 0
    v_pk_mul_f16 v122, v122, v235 op_sel:[0,0] op_sel_hi:[1,0]
    v_pk_mul_f16 v123, v123, v235 op_sel:[0,0] op_sel_hi:[1,0]
    v_mfma_f32_16x16x32_bf16 v[182:185], a[100:103], v[194:197], v[182:185]
    v_max3_u32 v44, v44, v230, v231
    v_mul_f32 v130, v255, v130
    v_mfma_f32_16x16x32_bf16 v[182:185], a[104:107], v[214:217], v[182:185]
    v_cvt_pk_f16_f32 v158, v158, v159
    v_pk_mul_f16 v191, v158, v158
    v_mfma_f32_16x16x32_bf16 v[182:185], a[108:111], v[206:209], v[182:185]
    v_cvt_pk_f16_f32 v159, v160, v161
    v_pk_fma_f16 v191, v159, v159, v191
    v_mfma_f32_16x16x32_bf16 v[182:185], a[112:115], v[198:201], v[182:185]
    v_pk_mul_f16 v193, v158, v174
    v_pk_fma_f16 v193, v159, v175, v193
    v_mfma_f32_16x16x32_bf16 v[182:185], a[116:119], v[186:189], v[182:185]
    v_exp_f32 v232, v232
    v_mfma_f32_16x16x32_bf16 v[210:213], a[120:123], v[202:205], 0
    v_exp_f32 v236, v236
    v_mfma_f32_16x16x32_bf16 v[210:213], a[124:127], v[194:197], v[210:213]
    v_cvt_pk_bf16_f32 v39, v236, 0
    v_mul_f32 v131, v255, v131
    v_mfma_f32_16x16x32_bf16 v[210:213], a[128:131], v[214:217], v[210:213]
    s_waitcnt vmcnt(3)
    ds_write_b16 v8, v45 offset:512
    v_mfma_f32_16x16x32_bf16 v[210:213], a[132:135], v[206:209], v[210:213]
    buffer_store_dwordx2 v[154:155], v20, s[12:15], 0 offen nt
    v_mov_b32 v45, 1
    v_cvt_pk_f16_f32 v160, v182, v183
    v_mfma_f32_16x16x32_bf16 v[210:213], a[136:139], v[198:201], v[210:213]
    v_pk_fma_f16 v191, v160, v160, v191
    v_cvt_pk_f16_f32 v161, v184, v185
    v_mfma_f32_16x16x32_bf16 v[210:213], a[140:143], v[186:189], v[210:213]
    v_pk_fma_f16 v191, v161, v161, v191
    v_pk_fma_f16 v193, v160, v176, v193
    v_mfma_f32_16x16x32_bf16 v[154:157], a[0:3], v[202:205], 0
    v_pk_fma_f16 v193, v161, v177, v193
    v_cvt_pk_bf16_f32 v130, v130, v131
    v_mfma_f32_16x16x32_bf16 v[154:157], a[4:7], v[194:197], v[154:157]
    v_mul_f32 v132, v255, v132
    v_mul_f32 v133, v255, v133
    v_mfma_f32_16x16x32_bf16 v[154:157], a[8:11], v[214:217], v[154:157]
    v_cvt_pk_f16_f32 v176, v210, v211
    v_pk_fma_f16 v191, v176, v176, v191
    v_mfma_f32_16x16x32_bf16 v[154:157], a[12:15], v[206:209], v[154:157]
    s_waitcnt lgkmcnt(0)
    v_cvt_pk_f16_f32 v177, v212, v213
    v_pk_fma_f16 v191, v177, v177, v191
    v_mfma_f32_16x16x32_bf16 v[154:157], a[16:19], v[198:201], v[154:157]
    s_barrier
    v_pk_fma_f16 v193, v176, v164, v193
    v_mfma_f32_16x16x32_bf16 v[154:157], a[20:23], v[186:189], v[154:157]
    v_pk_fma_f16 v193, v177, v165, v193
    v_mfma_f32_16x16x32_bf16 v[182:185], a[24:27], v[202:205], 0
    v_cvt_pk_bf16_f32 v131, v132, v133
    v_mfma_f32_16x16x32_bf16 v[182:185], a[28:31], v[194:197], v[182:185]
    ds_read2_b32 v[164:165], v6 offset0:0 offset1:0
    v_mfma_f32_16x16x32_bf16 v[182:185], a[32:35], v[214:217], v[182:185]
    ds_read2_b32 v[212:213], v6 offset0:16 offset1:16
    s_nop 0
    v_cvt_pk_f16_f32 v154, v154, v155
    v_mfma_f32_16x16x32_bf16 v[182:185], a[36:39], v[206:209], v[182:185]
    ds_read2_b32 v[220:221], v6 offset0:32 offset1:32
    v_pk_mul_f16 v190, v154, v154
    v_mfma_f32_16x16x32_bf16 v[182:185], a[40:43], v[198:201], v[182:185]
    ds_read_u16 v133, v9 offset:512
    v_cvt_pk_f16_f32 v155, v156, v157
    v_mfma_f32_16x16x32_bf16 v[182:185], a[44:47], v[186:189], v[182:185]
    v_pk_fma_f16 v190, v155, v155, v190
    v_pk_mul_f16 v192, v154, v170
    v_mfma_f32_16x16x32_bf16 v[222:225], a[48:51], v[202:205], 0
    v_pk_fma_f16 v192, v155, v171, v192
    v_mul_f32 v126, v255, v126
    v_mfma_f32_16x16x32_bf16 v[222:225], a[52:55], v[194:197], v[222:225]
    v_mul_f32 v127, v255, v127
    v_cvt_pk_bf16_f32 v132, v126, v127
    v_mfma_f32_16x16x32_bf16 v[222:225], a[56:59], v[214:217], v[222:225]
    buffer_load_dwordx4 v10, s[8:11], 0 offen nt lds
    v_cvt_pk_f16_f32 v156, v182, v183
    v_mfma_f32_16x16x32_bf16 v[222:225], a[60:63], v[206:209], v[222:225]
    s_add_u32 m0, s28, 4096
    v_pk_fma_f16 v190, v156, v156, v190
    v_cvt_pk_f16_f32 v157, v184, v185
    v_mfma_f32_16x16x32_bf16 v[222:225], a[64:67], v[198:201], v[222:225]
    s_waitcnt lgkmcnt(2)
    v_pk_fma_f16 v190, v157, v157, v190
    v_pk_fma_f16 v192, v156, v172, v192
    v_mfma_f32_16x16x32_bf16 v[222:225], a[68:71], v[186:189], v[222:225]
    s_waitcnt lgkmcnt(1)
    ds_read_b128 v[182:185], v2 offset:0
    v_pk_fma_f16 v192, v157, v173, v192
    v_mfma_f32_16x16x32_bf16 v[170:173], v[202:205], a[144:147], 0
    s_waitcnt lgkmcnt(1)
    ds_read_b128 v[226:229], v2 offset:1024
    v_readfirstlane_b32 s77, v133
    v_mfma_f32_16x16x32_bf16 v[170:173], v[194:197], a[148:151], v[170:173]
    ds_read_b128 v[234:237], v2 offset:2048
    buffer_load_dwordx4 v11, s[8:11], 0 offen nt lds
    v_mfma_f32_16x16x32_bf16 v[170:173], v[214:217], a[152:155], v[170:173]
    s_add_u32 m0, s28, 8192
    ds_read_b128 v[238:241], v2 offset:3072
    v_cvt_pk_f16_f32 v174, v222, v223
    v_mfma_f32_16x16x32_bf16 v[170:173], v[206:209], a[156:159], v[170:173]
    s_mul_i32 s78, s77, 2688
    ds_read_b128 v[242:245], v2 offset:4096
    v_pk_fma_f16 v190, v174, v174, v190
    v_mfma_f32_16x16x32_bf16 v[170:173], v[198:201], a[160:163], v[170:173]
    ds_read_b128 v[246:249], v2 offset:5120
    v_cvt_pk_f16_f32 v175, v224, v225
    v_mfma_f32_16x16x32_bf16 v[170:173], v[186:189], a[164:167], v[170:173]
    v_pk_fma_f16 v190, v175, v175, v190
    v_pk_fma_f16 v192, v174, v162, v192
    v_mfma_f32_16x16x32_bf16 v[222:225], v[202:205], a[168:171], 0
    buffer_load_dwordx4 v12, s[8:11], 0 offen nt lds
    v_pk_fma_f16 v192, v175, v163, v192
    v_mfma_f32_16x16x32_bf16 v[222:225], v[194:197], a[172:175], v[222:225]
    s_waitcnt lgkmcnt(5)
    v_mul_f32 v128, v255, v128
    v_cvt_pk_bf16_f32 v162, v170, v171
    v_mfma_f32_16x16x32_f16 v[250:253], v[40:43], v[190:193], 0
    s_add_u32 m0, s28, 12288
    v_cvt_pk_bf16_f32 v163, v172, v173
    v_mul_f32 v129, v255, v129
    v_mfma_f32_16x16x32_bf16 v[222:225], v[214:217], a[176:179], v[222:225]
    s_xor_b32 s28, s28, 65536
    v_cvt_pk_bf16_f32 v133, v128, v129
    v_mul_f32 v114, v255, v114
    v_mfma_f32_16x16x32_bf16 v[222:225], v[206:209], a[180:183], v[222:225]
    s_waitcnt lgkmcnt(2)
    v_rsq_f32 v250, v250
    v_mfma_f32_16x16x32_bf16 v[222:225], v[198:201], a[184:187], v[222:225]
    s_waitcnt lgkmcnt(1)
    buffer_load_dwordx4 v13, s[8:11], 0 offen nt lds
    v_mul_f32 v230, s31, v250
    v_mfma_f32_16x16x32_bf16 v[222:225], v[186:189], a[188:191], v[222:225]
    s_mov_b32 m0, s29
    v_rsq_f32 v251, v251
    v_mfma_f32_16x16x32_bf16 v[126:129], v[202:205], a[192:195], 0
    s_xor_b32 s29, s29, s30
    v_cvt_pk_f16_f32 v231, v230, v251
    v_fma_f32 v252, v252, v230, v26
    v_mfma_f32_16x16x32_bf16 v[126:129], v[194:197], a[196:199], v[126:129]
    s_add_u32 s19, s19, s20
    v_fmac_f32_dpp v254, v253, v251 quad_perm:[0,1,2,3] row_mask:0x4 bank_mask:0xf
    v_cvt_pk_bf16_f32 v210, v222, v223
    v_mfma_f32_16x16x32_bf16 v[126:129], v[214:217], a[200:203], v[126:129]
    s_add_u32 s23, s23, s21
    v_cvt_pk_bf16_f32 v211, v224, v225
    v_pk_mul_f16 v158, v158, v231 op_sel:[0,1] op_sel_hi:[1,1]
    v_mfma_f32_16x16x32_bf16 v[126:129], v[206:209], a[204:207], v[126:129]
    s_waitcnt lgkmcnt(0)
    buffer_load_dwordx4 v14, s[8:11], 0 offen nt lds
    v_pk_mul_f16 v159, v159, v231 op_sel:[0,1] op_sel_hi:[1,1]
    v_mfma_f32_16x16x32_bf16 v[126:129], v[198:201], a[208:211], v[126:129]
    s_cmp_ge_u32 s19, 72
    v_pk_mul_f16 v160, v160, v231 op_sel:[0,1] op_sel_hi:[1,1]
    v_pk_mul_f16 v161, v161, v231 op_sel:[0,1] op_sel_hi:[1,1]
    v_mfma_f32_16x16x32_bf16 v[126:129], v[186:189], a[212:215], v[126:129]
    s_cselect_b32 s34, 72, 0
    v_pk_mul_f16 v176, v176, v231 op_sel:[0,1] op_sel_hi:[1,1]
    v_pk_mul_f16 v177, v177, v231 op_sel:[0,1] op_sel_hi:[1,1]
    v_mfma_f32_16x16x32_f16 v[170:173], v[146:149], v[150:153], v[46:49]
    s_cselect_b32 s35, s22, 0
    v_pk_mul_f16 v154, v154, v231 op_sel:[0,0] op_sel_hi:[1,0]
    v_pk_mul_f16 v155, v155, v231 op_sel:[0,0] op_sel_hi:[1,0]
    v_mfma_f32_16x16x32_f16 v[186:189], v[166:169], v[150:153], v[50:53]
    s_sub_u32 s19, s19, s34
    v_cvt_pk_bf16_f32 v218, v126, v127
    v_cvt_pk_bf16_f32 v219, v128, v129
    v_mfma_f32_16x16x32_f16 v[126:129], v[158:161], v[150:153], v[54:57]
    buffer_store_dwordx4 v[130:133], v16, s[12:15], 0 offen nt
    v_pk_mul_f16 v156, v156, v231 op_sel:[0,0] op_sel_hi:[1,0]
    v_pk_mul_f16 v157, v157, v231 op_sel:[0,0] op_sel_hi:[1,0]
    v_pk_mul_f16 v174, v174, v231 op_sel:[0,0] op_sel_hi:[1,0]
    v_pk_mul_f16 v175, v175, v231 op_sel:[0,0] op_sel_hi:[1,0]
    v_mfma_f32_16x16x16_f16 v[170:173], v[120:121], v[118:119], v[170:173]
    v_max3_u32 v44, v44, v250, v251
    v_exp_f32 v254, v254
    v_mfma_f32_16x16x16_f16 v[186:189], v[124:125], v[118:119], v[186:189]
    v_cvt_pk_bf16_f32 v254, v254, v254
    v_exp_f32 v252, v252
    v_mfma_f32_16x16x16_f16 v[126:129], v[176:177], v[118:119], v[126:129]
    v_mul_f32 v115, v255, v115
    v_cvt_pk_bf16_f32 v118, v114, v115
    v_exp_f32 v170, v170
    v_mfma_f32_16x16x32_f16 v[130:133], v[146:149], v[178:181], v[58:61]
    s_add_u32 s23, s23, s35
    ds_write_b16 v8, v254
    v_mfma_f32_16x16x32_f16 v[150:153], v[166:169], v[178:181], v[62:65]
    s_add_u32 s78, s78, s69
    v_exp_f32 v171, v171
    v_mfma_f32_16x16x32_f16 v[190:193], v[158:161], v[178:181], v[66:69]
    s_add_u32 s80, s77, s68
    v_cvt_pk_bf16_f32 v170, v170, v171
    v_exp_f32 v172, v172
    v_mfma_f32_16x16x16_f16 v[130:133], v[120:121], v[122:123], v[130:133]
    v_exp_f32 v173, v173
    v_mul_f32 v116, v255, v116
    v_mfma_f32_16x16x16_f16 v[150:153], v[124:125], v[122:123], v[150:153]
    v_cvt_pk_bf16_f32 v171, v172, v173
    v_exp_f32 v186, v186
    v_mfma_f32_16x16x16_f16 v[190:193], v[176:177], v[122:123], v[190:193]
    v_exp_f32 v187, v187
    v_exp_f32 v188, v188
    v_mfma_f32_16x16x32_bf16 v[178:181], a[216:219], v[182:185], 0
    s_cmp_ge_u32 s80, 72
    v_exp_f32 v130, v130
    v_mfma_f32_16x16x32_bf16 v[178:181], a[220:223], v[226:229], v[178:181]
    s_cselect_b32 s80, s22, 0
    v_exp_f32 v131, v131
    v_mfma_f32_16x16x32_bf16 v[178:181], a[224:227], v[234:237], v[178:181]
    s_add_u32 s78, s78, s80
    v_cvt_pk_bf16_f32 v194, v130, v131
    v_cvt_pk_bf16_f32 v172, v186, v187
    v_mfma_f32_16x16x32_bf16 v[178:181], a[228:231], v[238:241], v[178:181]
    s_add_u32 s80, s77, 20
    v_exp_f32 v132, v132
    v_mfma_f32_16x16x32_bf16 v[178:181], a[232:235], v[242:245], v[178:181]
    s_add_u32 s34, s18, 3
    v_exp_f32 v133, v133
    v_mfma_f32_16x16x32_bf16 v[178:181], a[236:239], v[246:249], v[178:181]
    s_cmp_lt_u32 s77, s62
    v_cvt_pk_bf16_f32 v195, v132, v133
    v_mul_f32 v117, v255, v117
    v_mfma_f32_16x16x32_bf16 v[198:201], a[240:243], v[182:185], 0
    s_cselect_b32 s79, 1, 0
    v_exp_f32 v150, v150
    v_mfma_f32_16x16x32_f16 v[202:205], v[146:149], v[154:157], v[70:73]
    s_cselect_b32 s78, s78, 0
    v_exp_f32 v151, v151
    v_mfma_f32_16x16x32_f16 v[146:149], v[166:169], v[154:157], v[74:77]
    s_cmp_lt_u32 s34, s17
    v_cvt_pk_bf16_f32 v196, v150, v151
    v_cvt_pk_bf16_f32 v119, v116, v117
    v_mfma_f32_16x16x32_f16 v[166:169], v[158:161], v[154:157], v[78:81]
    buffer_store_dwordx2 v[118:119], v19, s[12:15], 0 offen nt
    v_exp_f32 v152, v152
    v_mfma_f32_16x16x16_f16 v[202:205], v[120:121], v[174:175], v[202:205]
    v_exp_f32 v153, v153
    v_fma_f32 v254, v178, v178, s33
    v_mfma_f32_16x16x16_f16 v[146:149], v[124:125], v[174:175], v[146:149]
    v_cvt_pk_bf16_f32 v197, v152, v153
    v_exp_f32 v190, v190
    v_mfma_f32_16x16x16_f16 v[166:169], v[176:177], v[174:175], v[166:169]
    v_exp_f32 v191, v191
    v_exp_f32 v192, v192
    v_mfma_f32_16x16x32_bf16 v[198:201], a[244:247], v[226:229], v[198:201]
    s_cselect_b32 s23, s23, s78
    v_exp_f32 v193, v193
    v_mfma_f32_16x16x32_bf16 v[198:201], a[248:251], v[234:237], v[198:201]
    s_cselect_b32 s73, s34, s80
    ds_read_b128 v[118:121], v2 offset:6144
    v_fmac_f32 v254, v179, v179
    v_mfma_f32_16x16x32_bf16 v[198:201], a[252:255], v[238:241], v[198:201]
    s_cselect_b32 s79, 0, s79
    ds_read_b128 v[122:125], v2 offset:7168
    v_fmac_f32 v254, v180, v180
    v_mfma_f32_16x16x32_bf16 v[198:201], v[82:85], v[242:245], v[198:201]
    s_cselect_b32 s81, 0, 1
    ds_read_b128 v[150:153], v2 offset:8192
    v_fmac_f32 v254, v181, v181
    v_mfma_f32_16x16x32_bf16 v[198:201], v[86:89], v[246:249], v[198:201]
    s_add_u32 s80, s77, 1
    ds_read_b128 v[154:157], v2 offset:9216
    v_xor_b32 v0, 65536, v0
    v_mfma_f32_16x16x32_bf16 v[206:209], v[90:93], v[182:185], 0
    s_mul_i32 s80, s80, s81
    ds_read_b128 v[158:161], v2 offset:10240
    v_xor_b32 v1, 65536, v1
    v_mfma_f32_16x16x32_bf16 v[206:209], v[94:97], v[226:229], v[206:209]
    s_cmp_lt_u32 s80, s62
    ds_read_b128 v[174:177], v2 offset:11264
    v_fmac_f32 v254, v198, v198
    v_mfma_f32_16x16x32_bf16 v[206:209], v[98:101], v[234:237], v[206:209]
    s_cselect_b32 s62, s62, 0
    v_exp_f32 v189, v189
    v_mfma_f32_16x16x32_bf16 v[206:209], v[102:105], v[238:241], v[206:209]
    s_add_u32 s80, s18, 4
    v_cvt_pk_bf16_f32 v173, v188, v189
    v_fmac_f32 v254, v199, v199
    v_mfma_f32_16x16x32_bf16 v[206:209], v[106:109], v[242:245], v[206:209]
    s_waitcnt lgkmcnt(5)
    v_exp_f32 v126, v126
    v_mfma_f32_16x16x32_bf16 v[206:209], v[110:113], v[246:249], v[206:209]
    s_cmp_ge_u32 s80, s17
    v_exp_f32 v127, v127
    v_mfma_f32_16x16x32_bf16 v[130:133], a[216:219], v[118:121], 0
    s_waitcnt lgkmcnt(3)
    v_cvt_pk_bf16_f32 v36, v126, v127
    v_fmac_f32 v254, v200, v200
    v_mfma_f32_16x16x32_bf16 v[130:133], a[220:223], v[122:125], v[130:133]
    s_cselect_b32 s66, s62, 0
    v_exp_f32 v128, v128
    v_mfma_f32_16x16x32_bf16 v[130:133], a[224:227], v[150:153], v[130:133]
    s_waitcnt lgkmcnt(1)
    buffer_atomic_add v45, v10, s[64:67], 0 offen sc0 sc1
    v_fmac_f32 v254, v201, v201
    v_mfma_f32_16x16x32_bf16 v[130:133], a[228:231], v[154:157], v[130:133]
    s_lshl_b32 s80, s79, s73
    v_exp_f32 v129, v129
    v_mfma_f32_16x16x32_bf16 v[130:133], a[232:235], v[158:161], v[130:133]
    s_waitcnt lgkmcnt(0)
    v_cvt_pk_bf16_f32 v37, v128, v129
    v_fmac_f32 v254, v206, v206
    v_mfma_f32_16x16x32_bf16 v[130:133], a[236:239], v[174:177], v[130:133]
    s_or_b32 s70, s70, s80
    v_exp_f32 v202, v202
    v_mfma_f32_16x16x32_bf16 v[182:185], v[28:31], v[36:39], 0
    s_add_u32 s45, s45, s79
    v_exp_f32 v203, v203
    v_mfma_f32_16x16x32_bf16 v[182:185], v[28:31], v[170:173], v[182:185]
    s_add_u32 s18, s18, 1
    v_cvt_pk_bf16_f32 v186, v202, v203
    v_fma_f32 v255, v130, v130, s33
    v_mfma_f32_16x16x32_bf16 v[214:217], v[162:165], v[36:39], 0
    s_cmp_lt_u32 s18, s45
    v_fmac_f32 v255, v131, v131
    v_fmac_f32 v255, v132, v132
    v_mfma_f32_16x16x32_bf16 v[214:217], v[134:137], v[170:173], v[214:217]
    v_fmac_f32 v255, v133, v133
    v_fmac_f32 v254, v207, v207
    v_mfma_f32_16x16x32_bf16 v[222:225], v[210:213], v[36:39], 0
    v_exp_f32 v204, v204
    v_mfma_f32_16x16x32_bf16 v[222:225], v[138:141], v[170:173], v[222:225]
    v_exp_f32 v205, v205
    v_mfma_f32_16x16x32_bf16 v[226:229], v[218:221], v[36:39], 0
    v_cvt_pk_bf16_f32 v36, v190, v191
    v_cvt_pk_bf16_f32 v37, v192, v193
    v_mfma_f32_16x16x32_bf16 v[226:229], v[142:145], v[170:173], v[226:229]
    v_cvt_pk_bf16_f32 v39, v232, 0
    v_cvt_pk_bf16_f32 v187, v204, v205
    v_mfma_f32_16x16x32_bf16 v[126:129], a[240:243], v[118:121], 0
    v_exp_f32 v146, v146
    v_mfma_f32_16x16x32_bf16 v[170:173], v[28:31], v[36:39], 0
    v_exp_f32 v147, v147
    v_mfma_f32_16x16x32_bf16 v[170:173], v[28:31], v[194:197], v[170:173]
    v_cvt_pk_bf16_f32 v188, v146, v147
    v_fmac_f32 v254, v208, v208
    v_mfma_f32_16x16x32_bf16 v[114:117], v[162:165], v[36:39], 0
    v_exp_f32 v148, v148
    v_mfma_f32_16x16x32_bf16 v[114:117], v[134:137], v[194:197], v[114:117]
    v_exp_f32 v149, v149
    v_mfma_f32_16x16x32_bf16 v[190:193], v[210:213], v[36:39], 0
    v_cvt_pk_bf16_f32 v189, v148, v149
    v_fmac_f32 v254, v209, v209
    v_mfma_f32_16x16x32_bf16 v[190:193], v[138:141], v[194:197], v[190:193]
    v_rcp_f32 v170, v170
    v_mfma_f32_16x16x32_bf16 v[146:149], v[218:221], v[36:39], 0
    v_exp_f32 v166, v166
    v_mfma_f32_16x16x32_bf16 v[146:149], v[142:145], v[194:197], v[146:149]
    v_mul_f32 v114, v170, v114
    v_mul_f32 v115, v170, v115
    v_mfma_f32_16x16x32_bf16 v[126:129], a[244:247], v[122:125], v[126:129]
    v_cvt_pk_bf16_f32 v194, v114, v115
    v_mul_f32 v116, v170, v116
    v_mfma_f32_16x16x32_bf16 v[126:129], a[248:251], v[150:153], v[126:129]
    ds_read_b128 v[202:205], v2 offset:12288
    v_mul_f32 v117, v170, v117
    v_mfma_f32_16x16x32_bf16 v[126:129], a[252:255], v[154:157], v[126:129]
    ds_read_b128 v[230:233], v2 offset:13312
    v_cvt_pk_bf16_f32 v195, v116, v117
    v_mfma_f32_16x16x32_bf16 v[126:129], v[82:85], v[158:161], v[126:129]
    ds_read_b128 v[234:237], v2 offset:14336
    v_mul_f32 v190, v170, v190
    v_mfma_f32_16x16x32_bf16 v[126:129], v[86:89], v[174:177], v[126:129]
    ds_read_b128 v[238:241], v2 offset:15360
    v_mul_f32 v191, v170, v191
    v_mfma_f32_16x16x32_bf16 v[114:117], v[90:93], v[118:121], 0
    ds_read_b128 v[118:121], v2 offset:16384
    v_cvt_pk_bf16_f32 v196, v190, v191
    v_mfma_f32_16x16x32_bf16 v[114:117], v[94:97], v[122:125], v[114:117]
    ds_read_b128 v[122:125], v2 offset:17408
    v_mul_f32 v192, v170, v192
    v_mfma_f32_16x16x32_bf16 v[114:117], v[98:101], v[150:153], v[114:117]
    v_fmac_f32 v255, v126, v126
    v_fmac_f32 v255, v127, v127
    v_mfma_f32_16x16x32_bf16 v[114:117], v[102:105], v[154:157], v[114:117]
    v_fmac_f32 v255, v128, v128
    v_fmac_f32 v255, v129, v129
    v_mfma_f32_16x16x32_bf16 v[114:117], v[106:109], v[158:161], v[114:117]
    s_waitcnt lgkmcnt(5)
    v_mul_f32 v193, v170, v193
    v_cvt_pk_bf16_f32 v197, v192, v193
    v_mfma_f32_16x16x32_bf16 v[114:117], v[110:113], v[174:177], v[114:117]
    s_waitcnt lgkmcnt(4)
    ds_write_b128 v3, v[194:197] offset:6144
    v_mfma_f32_16x16x32_bf16 v[242:245], a[216:219], v[202:205], 0
    s_waitcnt lgkmcnt(3)
    v_mul_f32 v146, v170, v146
    v_mul_f32 v147, v170, v147
    v_mfma_f32_16x16x32_bf16 v[242:245], a[220:223], v[230:233], v[242:245]
    s_waitcnt lgkmcnt(2)
    v_fmac_f32 v255, v114, v114
    v_fmac_f32 v255, v115, v115
    v_mfma_f32_16x16x32_bf16 v[242:245], a[224:227], v[234:237], v[242:245]
    s_waitcnt lgkmcnt(1)
    v_fmac_f32 v255, v116, v116
    v_fmac_f32 v255, v117, v117
    v_mfma_f32_16x16x32_bf16 v[242:245], a[228:231], v[238:241], v[242:245]
    v_cvt_pk_bf16_f32 v254, v254, v255
    v_cvt_pk_bf16_f32 v172, v146, v147
    v_mfma_f32_16x16x32_bf16 v[242:245], a[232:235], v[118:121], v[242:245]
    v_mul_f32 v148, v170, v148
    v_mul_f32 v149, v170, v149
    v_mfma_f32_16x16x32_bf16 v[242:245], a[236:239], v[122:125], v[242:245]
    v_cvt_pk_bf16_f32 v173, v148, v149
    v_cvt_pk_bf16_f32 v39, v252, 0
    v_mfma_f32_16x16x32_bf16 v[158:161], a[240:243], v[202:205], 0
    ds_write_b64 v4, v[172:173] offset:10240
    v_mfma_f32_16x16x32_bf16 v[158:161], a[244:247], v[230:233], v[158:161]
    v_exp_f32 v167, v167
    v_mfma_f32_16x16x32_bf16 v[158:161], a[248:251], v[234:237], v[158:161]
    v_cvt_pk_bf16_f32 v36, v166, v167
    v_fma_f32 v255, v242, v242, s33
    v_mfma_f32_16x16x32_bf16 v[158:161], a[252:255], v[238:241], v[158:161]
    v_fmac_f32 v255, v243, v243
    v_fmac_f32 v255, v244, v244
    v_mfma_f32_16x16x32_bf16 v[158:161], v[82:85], v[118:121], v[158:161]
    v_fmac_f32 v255, v245, v245
    v_xor_b32 v2, 65536, v2
    v_mfma_f32_16x16x32_bf16 v[158:161], v[86:89], v[122:125], v[158:161]
    v_exp_f32 v168, v168
    v_mfma_f32_16x16x32_bf16 v[154:157], v[90:93], v[202:205], 0
    v_exp_f32 v169, v169
    v_mfma_f32_16x16x32_bf16 v[154:157], v[94:97], v[230:233], v[154:157]
    ds_read_b128 v[146:149], v9
    v_cvt_pk_bf16_f32 v37, v168, v169
    v_mfma_f32_16x16x32_bf16 v[154:157], v[98:101], v[234:237], v[154:157]
    ds_read_b128 v[150:153], v9 offset:64
    v_fmac_f32 v255, v158, v158
    v_mfma_f32_16x16x32_bf16 v[166:169], v[28:31], v[36:39], 0
    v_fmac_f32 v255, v159, v159
    v_fmac_f32 v255, v160, v160
    v_mfma_f32_16x16x32_bf16 v[166:169], v[28:31], v[186:189], v[166:169]
    v_fmac_f32 v255, v161, v161
    v_add_u32 v6, s75, v6
    v_mfma_f32_16x16x32_bf16 v[174:177], v[162:165], v[36:39], 0
    v_rcp_f32 v182, v182
    v_mfma_f32_16x16x32_bf16 v[174:177], v[134:137], v[186:189], v[174:177]
    v_max3_u32 v25, v25, v182, v183
    v_max3_u32 v25, v25, v170, v171
    v_mfma_f32_16x16x32_bf16 v[170:173], v[210:213], v[36:39], 0
    v_rcp_f32 v166, v166
    v_mfma_f32_16x16x32_bf16 v[170:173], v[138:141], v[186:189], v[170:173]
    v_max3_u32 v25, v25, v166, v167
    v_mul_f32 v214, v182, v214
    v_mfma_f32_16x16x32_bf16 v[190:193], v[218:221], v[36:39], 0
    s_waitcnt lgkmcnt(1)
    v_mul_f32 v174, v166, v174
    v_mul_f32 v175, v166, v175
    v_mfma_f32_16x16x32_bf16 v[190:193], v[142:145], v[186:189], v[190:193]
    s_waitcnt lgkmcnt(0)
    v_cvt_pk_bf16_f32 v174, v174, v175
    v_mul_f32 v176, v166, v176
    v_mfma_f32_16x16x32_bf16 v[154:157], v[102:105], v[238:241], v[154:157]
    ds_read_b128 v[186:189], v0 offset:20480
    v_mul_f32 v177, v166, v177
    v_mfma_f32_16x16x32_bf16 v[154:157], v[106:109], v[118:121], v[154:157]
    ds_read_b128 v[194:197], v1 offset:20480
    v_cvt_pk_bf16_f32 v175, v176, v177
    v_mfma_f32_16x16x32_bf16 v[154:157], v[110:113], v[122:125], v[154:157]
    ds_read_b128 v[122:125], v0 offset:20608
    v_mul_f32 v170, v166, v170
    v_mfma_f32_16x16x32_bf16 v[118:121], v[146:149], v[28:31], 0
    ds_read_b128 v[202:205], v1 offset:20608
    v_mul_f32 v171, v166, v171
    v_mfma_f32_16x16x32_bf16 v[118:121], v[150:153], v[28:31], v[118:121]
    ds_read_b128 v[230:233], v0 offset:20736
    v_cvt_pk_bf16_f32 v176, v170, v171
    v_mfma_f32_16x16x32_bf16 v[234:237], v[146:149], v[134:137], 0
    ds_read_b128 v[238:241], v1 offset:20736
    v_fmac_f32 v255, v154, v154
    v_mfma_f32_16x16x32_bf16 v[234:237], v[150:153], v[162:165], v[234:237]
    v_fmac_f32 v255, v155, v155
    v_fmac_f32 v255, v156, v156
    v_mfma_f32_16x16x32_bf16 v[134:137], v[146:149], v[138:141], 0
    v_fmac_f32 v255, v157, v157
    v_cvt_pk_bf16_f32 v255, v255, v255
    v_mfma_f32_16x16x32_bf16 v[134:137], v[150:153], v[210:213], v[134:137]
    s_waitcnt lgkmcnt(5)
    ds_write_b64 v4, v[254:255] offset:18432
    v_mfma_f32_16x16x32_bf16 v[138:141], v[146:149], v[142:145], 0
    s_waitcnt lgkmcnt(4)
    v_mul_f32 v172, v166, v172
    v_mul_f32 v173, v166, v173
    v_mfma_f32_16x16x32_bf16 v[138:141], v[150:153], v[218:221], v[138:141]
    s_waitcnt lgkmcnt(3)
    v_cvt_pk_bf16_f32 v177, v172, v173
    v_mul_f32 v190, v166, v190
    v_mfma_f32_16x16x32_bf16 v[142:145], a[72:75], v[186:189], 0
    s_waitcnt lgkmcnt(2)
    ds_write_b128 v3, v[174:177] offset:12288
    v_mfma_f32_16x16x32_bf16 v[142:145], a[76:79], v[194:197], v[142:145]
    s_waitcnt lgkmcnt(2)
    v_mul_f32 v191, v166, v191
    v_cvt_pk_bf16_f32 v120, v190, v191
    v_mfma_f32_16x16x32_bf16 v[142:145], a[80:83], v[122:125], v[142:145]
    v_mul_f32 v192, v166, v192
    v_mul_f32 v193, v166, v193
    v_mfma_f32_16x16x32_bf16 v[142:145], a[84:87], v[202:205], v[142:145]
    v_cvt_pk_bf16_f32 v121, v192, v193
    v_mul_f32 v215, v182, v215
    v_mfma_f32_16x16x32_bf16 v[142:145], a[88:91], v[230:233], v[142:145]
    ds_write_b64 v4, v[120:121] offset:16384
    v_mfma_f32_16x16x32_bf16 v[142:145], a[92:95], v[238:241], v[142:145]
    v_rcp_f32 v118, v118
    v_mfma_f32_16x16x32_bf16 v[150:153], a[96:99], v[186:189], 0
    v_max3_u32 v25, v25, v118, v119
    v_mul_f32 v234, v234, v118
    v_mfma_f32_16x16x32_bf16 v[150:153], a[100:103], v[194:197], v[150:153]
    v_cvt_pk_bf16_f32 v146, v214, v215
    v_mul_f32_dpp v234, v134, v118 quad_perm:[0,1,2,3] row_mask:0x2 bank_mask:0xf
    v_mfma_f32_16x16x32_bf16 v[150:153], a[104:107], v[122:125], v[150:153]
    v_mul_f32 v216, v182, v216
    v_mul_f32_dpp v234, v138, v118 quad_perm:[0,1,2,3] row_mask:0x4 bank_mask:0xf
    v_mfma_f32_16x16x32_bf16 v[150:153], a[108:111], v[202:205], v[150:153]
    v_cvt_pk_bf16_f32 v234, v234, v234
    v_mul_f32 v217, v182, v217
    v_mfma_f32_16x16x32_bf16 v[150:153], a[112:115], v[230:233], v[150:153]
    ds_write_b16 v7, v234
    v_mfma_f32_16x16x32_bf16 v[150:153], a[116:119], v[238:241], v[150:153]
    v_cvt_pk_bf16_f32 v147, v216, v217
    v_mul_f32 v222, v182, v222
    v_mfma_f32_16x16x32_bf16 v[134:137], a[120:123], v[186:189], 0
    v_mul_f32 v223, v182, v223
    v_cvt_pk_bf16_f32 v148, v222, v223
    v_mfma_f32_16x16x32_bf16 v[134:137], a[124:127], v[194:197], v[134:137]
    v_mul_f32 v224, v182, v224
    v_mul_f32 v225, v182, v225
    v_mfma_f32_16x16x32_bf16 v[134:137], a[128:131], v[122:125], v[134:137]
    v_cvt_pk_bf16_f32 v149, v224, v225
    v_mul_f32 v226, v182, v226
    v_mfma_f32_16x16x32_bf16 v[134:137], a[132:135], v[202:205], v[134:137]
    ds_write_b128 v3, v[146:149] offset:0
    v_mfma_f32_16x16x32_bf16 v[134:137], a[136:139], v[230:233], v[134:137]
    v_mul_f32 v227, v182, v227
    v_cvt_pk_bf16_f32 v254, v226, v227
    v_mfma_f32_16x16x32_bf16 v[134:137], a[140:143], v[238:241], v[134:137]
    v_mul_f32 v228, v182, v228
    v_mul_f32 v229, v182, v229
    v_mfma_f32_16x16x32_bf16 v[138:141], a[0:3], v[186:189], 0
    v_cvt_pk_bf16_f32 v255, v228, v229
    v_xor_b32 v3, 65536, v3
    v_mfma_f32_16x16x32_bf16 v[138:141], a[4:7], v[194:197], v[138:141]
    ds_write_b64 v4, v[254:255] offset:4096
    v_mfma_f32_16x16x32_bf16 v[138:141], a[8:11], v[122:125], v[138:141]
    v_xor_b32 v4, 65536, v4
    v_add_u32 v7, s76, v7
    v_mfma_f32_16x16x32_bf16 v[138:141], a[12:15], v[202:205], v[138:141]
    v_cvt_pk_f16_f32 v146, v142, v143
    v_pk_mul_f16 v143, v146, v146
    v_mfma_f32_16x16x32_bf16 v[138:141], a[16:19], v[230:233], v[138:141]
    v_cvt_pk_f16_f32 v147, v144, v145
    v_pk_fma_f16 v143, v147, v147, v143
    v_mfma_f32_16x16x32_bf16 v[138:141], a[20:23], v[238:241], v[138:141]
    v_cvt_pk_f16_f32 v148, v150, v151
    v_pk_fma_f16 v143, v148, v148, v143
    v_mfma_f32_16x16x32_bf16 v[166:169], a[24:27], v[186:189], 0
    v_cvt_pk_f16_f32 v149, v152, v153
    v_pk_fma_f16 v143, v149, v149, v143
    v_mfma_f32_16x16x32_bf16 v[166:169], a[28:31], v[194:197], v[166:169]
    v_cvt_pk_f16_f32 v120, v134, v135
    v_pk_fma_f16 v143, v120, v120, v143
    v_mfma_f32_16x16x32_bf16 v[166:169], a[32:35], v[122:125], v[166:169]
    s_waitcnt lgkmcnt(0)
    v_cvt_pk_f16_f32 v121, v136, v137
    v_pk_fma_f16 v143, v121, v121, v143
    v_mfma_f32_16x16x32_bf16 v[166:169], a[36:39], v[202:205], v[166:169]
    s_barrier
    v_mfma_f32_16x16x32_bf16 v[166:169], a[40:43], v[230:233], v[166:169]
    s_nop 0
    v_mfma_f32_16x16x32_bf16 v[166:169], a[44:47], v[238:241], v[166:169]
    s_nop 0
    v_mfma_f32_16x16x32_bf16 v[134:137], a[48:51], v[186:189], 0
    s_nop 0
    v_mfma_f32_16x16x32_bf16 v[134:137], a[52:55], v[194:197], v[134:137]
    s_cbranch_scc1 L_loop_fast0
    s_branch L_final_fast
.p2align 6
L_loop_fast1:
    v_mfma_f32_16x16x32_bf16 v[134:137], a[56:59], v[122:125], v[134:137]
    s_add_u32 s12, s40, s27
    ds_read_b128 v[190:193], v2 offset:18432
    v_cvt_pk_f16_f32 v150, v138, v139
    v_mfma_f32_16x16x32_bf16 v[134:137], a[60:63], v[202:205], v[134:137]
    s_addc_u32 s13, s41, 0
    ds_read_b128 v[210:213], v2 offset:19456
    v_pk_mul_f16 v142, v150, v150
    v_mfma_f32_16x16x32_bf16 v[134:137], a[64:67], v[230:233], v[134:137]
    s_sub_u32 s14, s36, s27
    ds_read_b128 v[174:177], v5 offset:32
    v_cvt_pk_f16_f32 v151, v140, v141
    v_mfma_f32_16x16x32_bf16 v[134:137], a[68:71], v[238:241], v[134:137]
    s_cmp_ge_u32 s18, 2
    ds_read2_b64 v[162:165], v5 offset0:6 offset1:9
    v_pk_fma_f16 v142, v151, v151, v142
    v_mfma_f32_16x16x32_bf16 v[138:141], v[186:189], a[144:147], 0
    s_cselect_b32 s14, s14, 0
    ds_read_b128 v[170:173], v5
    v_cvt_pk_f16_f32 v152, v166, v167
    v_mfma_f32_16x16x32_bf16 v[138:141], v[194:197], a[148:151], v[138:141]
    s_sub_u32 s82, s72, s71
    ds_read_b32 v254, v6 offset:192
    v_pk_fma_f16 v142, v152, v152, v142
    v_mfma_f32_16x16x32_bf16 v[138:141], v[122:125], a[152:155], v[138:141]
    s_mul_i32 s74, s82, 336
    v_cvt_pk_f16_f32 v153, v168, v169
    v_pk_fma_f16 v142, v153, v153, v142
    v_mfma_f32_16x16x32_bf16 v[138:141], v[202:205], a[156:159], v[138:141]
    s_mul_i32 s75, s82, 272
    v_cvt_pk_f16_f32 v118, v134, v135
    v_pk_fma_f16 v142, v118, v118, v142
    v_mfma_f32_16x16x32_bf16 v[138:141], v[230:233], a[160:163], v[138:141]
    s_waitcnt lgkmcnt(5)
    ds_read_b128 v[182:185], v0 offset:26624
    v_cvt_pk_f16_f32 v119, v136, v137
    v_mfma_f32_16x16x32_bf16 v[166:169], v[32:35], v[190:193], 0
    s_waitcnt lgkmcnt(5)
    v_pk_fma_f16 v142, v119, v119, v142
    v_add_u32 v5, s74, v5
    v_mfma_f32_16x16x32_bf16 v[166:169], v[32:35], v[210:213], v[166:169]
    s_waitcnt lgkmcnt(4)
    v_pk_mul_f16 v145, v146, v174
    v_pk_fma_f16 v145, v147, v175, v145
    v_mfma_f32_16x16x32_bf16 v[138:141], v[238:241], a[164:167], v[138:141]
    s_mul_i32 s76, s82, 16
    ds_read_b128 v[210:213], v1 offset:26624
    v_pk_fma_f16 v145, v148, v176, v145
    v_mfma_f32_16x16x32_bf16 v[214:217], v[186:189], a[168:171], 0
    s_waitcnt lgkmcnt(3)
    ds_read_b128 v[218:221], v0 offset:26752
    v_pk_fma_f16 v145, v149, v177, v145
    v_mfma_f32_16x16x32_bf16 v[214:217], v[194:197], a[172:175], v[214:217]
    s_waitcnt lgkmcnt(3)
    ds_read_b128 v[222:225], v1 offset:26752
    v_mov_b32_dpp v254, v23 quad_perm:[0,1,2,3] row_mask:0x7 bank_mask:0xf
    v_mfma_f32_16x16x32_bf16 v[214:217], v[122:125], a[176:179], v[214:217]
    s_add_u32 s34, s18, 2
    ds_read_b128 v[226:229], v0 offset:26880
    v_pk_fma_f16 v145, v120, v164, v145
    v_mfma_f32_16x16x32_bf16 v[214:217], v[202:205], a[180:183], v[214:217]
    s_add_u32 s8, s60, s23
    ds_read_b128 v[190:193], v1 offset:26880
    v_pk_fma_f16 v145, v121, v165, v145
    v_mfma_f32_16x16x32_bf16 v[214:217], v[230:233], a[184:187], v[214:217]
    s_waitcnt lgkmcnt(5)
    v_pk_mul_f16 v144, v150, v170
    v_pk_fma_f16 v144, v151, v171, v144
    v_mfma_f32_16x16x32_bf16 v[214:217], v[238:241], a[188:191], v[214:217]
    s_addc_u32 s9, s61, 0
    v_pk_fma_f16 v144, v152, v172, v144
    v_pk_fma_f16 v144, v153, v173, v144
    v_mfma_f32_16x16x32_bf16 v[246:249], v[186:189], a[192:195], 0
    s_sub_u32 s10, s36, s23
    v_pk_fma_f16 v144, v118, v162, v144
    v_pk_fma_f16 v144, v119, v163, v144
    v_mfma_f32_16x16x32_bf16 v[246:249], v[194:197], a[196:199], v[246:249]
    s_cmp_le_u32 s34, s45
    v_cvt_pk_bf16_f32 v134, v138, v139
    v_cvt_pk_bf16_f32 v135, v140, v141
    v_mfma_f32_16x16x32_f16 v[234:237], v[40:43], v[142:145], 0
    s_cselect_b32 s10, s10, 0
    v_cvt_pk_bf16_f32 v138, v214, v215
    v_cvt_pk_bf16_f32 v139, v216, v217
    v_mfma_f32_16x16x32_bf16 v[246:249], v[122:125], a[200:203], v[246:249]
    s_add_u32 m0, s28, 0
    v_mul_f32 v136, 0x3baaaaab, v166
    v_mul_f32 v255, 0x3baaaaab, v167
    v_mfma_f32_16x16x32_bf16 v[246:249], v[202:205], a[204:207], v[246:249]
    s_mov_b32 s27, s26
    v_rsq_f32 v234, v234
    v_mfma_f32_16x16x32_bf16 v[246:249], v[230:233], a[208:211], v[246:249]
    s_mov_b32 s26, s25
    v_rsq_f32 v235, v235
    v_mfma_f32_16x16x32_bf16 v[246:249], v[238:241], a[212:215], v[246:249]
    s_mov_b32 s25, s24
    v_mul_f32 v140, s31, v234
    v_cvt_pk_f16_f32 v141, v140, v235
    v_mfma_f32_16x16x32_bf16 v[122:125], a[72:75], v[182:185], 0
    s_waitcnt lgkmcnt(0)
    v_fma_f32 v236, v236, v140, v22
    v_fmac_f32_dpp v254, v237, v235 quad_perm:[0,1,2,3] row_mask:0x1 bank_mask:0xf
    v_mfma_f32_16x16x32_bf16 v[122:125], a[76:79], v[210:213], v[122:125]
    s_mov_b32 s24, s23
    v_cvt_pk_bf16_f32 v142, v246, v247
    v_cvt_pk_bf16_f32 v143, v248, v249
    v_mfma_f32_16x16x32_bf16 v[122:125], a[80:83], v[218:221], v[122:125]
    s_mov_b32 s71, s72
    v_pk_mul_f16 v146, v146, v141 op_sel:[0,1] op_sel_hi:[1,1]
    v_pk_mul_f16 v147, v147, v141 op_sel:[0,1] op_sel_hi:[1,1]
    v_mfma_f32_16x16x32_bf16 v[122:125], a[84:87], v[222:225], v[122:125]
    s_mov_b32 s72, s73
    v_pk_mul_f16 v148, v148, v141 op_sel:[0,1] op_sel_hi:[1,1]
    v_pk_mul_f16 v149, v149, v141 op_sel:[0,1] op_sel_hi:[1,1]
    v_mfma_f32_16x16x32_bf16 v[122:125], a[88:91], v[226:229], v[122:125]
    v_pk_mul_f16 v120, v120, v141 op_sel:[0,1] op_sel_hi:[1,1]
    v_pk_mul_f16 v121, v121, v141 op_sel:[0,1] op_sel_hi:[1,1]
    v_mfma_f32_16x16x32_bf16 v[122:125], a[92:95], v[190:193], v[122:125]
    v_pk_mul_f16 v150, v150, v141 op_sel:[0,0] op_sel_hi:[1,0]
    v_pk_mul_f16 v151, v151, v141 op_sel:[0,0] op_sel_hi:[1,0]
    v_mfma_f32_16x16x32_bf16 v[186:189], a[96:99], v[182:185], 0
    v_pk_mul_f16 v152, v152, v141 op_sel:[0,0] op_sel_hi:[1,0]
    v_pk_mul_f16 v153, v153, v141 op_sel:[0,0] op_sel_hi:[1,0]
    v_mfma_f32_16x16x32_bf16 v[186:189], a[100:103], v[210:213], v[186:189]
    v_pk_mul_f16 v118, v118, v141 op_sel:[0,0] op_sel_hi:[1,0]
    v_pk_mul_f16 v119, v119, v141 op_sel:[0,0] op_sel_hi:[1,0]
    v_mfma_f32_16x16x32_bf16 v[186:189], a[104:107], v[218:221], v[186:189]
    v_max3_u32 v44, v44, v234, v235
    v_mul_f32 v144, 0x3baaaaab, v168
    v_mfma_f32_16x16x32_bf16 v[186:189], a[108:111], v[222:225], v[186:189]
    v_rsq_f32 v136, v136
    v_mfma_f32_16x16x32_bf16 v[186:189], a[112:115], v[226:229], v[186:189]
    v_rsq_f32 v255, v255
    v_mfma_f32_16x16x32_bf16 v[186:189], a[116:119], v[190:193], v[186:189]
    v_rsq_f32 v144, v144
    v_mfma_f32_16x16x32_bf16 v[194:197], a[120:123], v[182:185], 0
    v_mul_f32 v178, v136, v178
    v_mul_f32 v179, v136, v179
    v_mfma_f32_16x16x32_bf16 v[194:197], a[124:127], v[210:213], v[194:197]
    v_cvt_pk_bf16_f32 v166, v178, v179
    v_mul_f32 v180, v136, v180
    v_mfma_f32_16x16x32_bf16 v[194:197], a[128:131], v[218:221], v[194:197]
    v_mul_f32 v181, v136, v181
    v_cvt_pk_bf16_f32 v167, v180, v181
    v_mfma_f32_16x16x32_bf16 v[194:197], a[132:135], v[222:225], v[194:197]
    v_mul_f32 v198, v136, v198
    v_mul_f32 v199, v136, v199
    v_mfma_f32_16x16x32_bf16 v[194:197], a[136:139], v[226:229], v[194:197]
    v_cvt_pk_bf16_f32 v168, v198, v199
    v_mul_f32 v200, v136, v200
    v_mfma_f32_16x16x32_bf16 v[194:197], a[140:143], v[190:193], v[194:197]
    v_mul_f32 v201, v136, v201
    v_cvt_pk_bf16_f32 v169, v200, v201
    v_mfma_f32_16x16x32_bf16 v[178:181], a[0:3], v[182:185], 0
    buffer_store_dwordx4 v[166:169], v15, s[12:15], 0 offen nt
    v_mul_f32 v206, v136, v206
    v_mul_f32 v207, v136, v207
    v_cvt_pk_bf16_f32 v140, v206, v207
    v_mul_f32 v208, v136, v208
    v_mfma_f32_16x16x32_bf16 v[178:181], a[4:7], v[210:213], v[178:181]
    v_mul_f32 v209, v136, v209
    v_cvt_pk_bf16_f32 v141, v208, v209
    v_mfma_f32_16x16x32_bf16 v[178:181], a[8:11], v[218:221], v[178:181]
    v_cvt_pk_f16_f32 v166, v122, v123
    v_pk_mul_f16 v199, v166, v166
    v_mfma_f32_16x16x32_bf16 v[178:181], a[12:15], v[222:225], v[178:181]
    v_cvt_pk_f16_f32 v167, v124, v125
    v_pk_fma_f16 v199, v167, v167, v199
    v_mfma_f32_16x16x32_bf16 v[178:181], a[16:19], v[226:229], v[178:181]
    v_cvt_pk_f16_f32 v168, v186, v187
    v_pk_fma_f16 v199, v168, v168, v199
    v_mfma_f32_16x16x32_bf16 v[178:181], a[20:23], v[190:193], v[178:181]
    v_cvt_pk_f16_f32 v169, v188, v189
    v_pk_fma_f16 v199, v169, v169, v199
    v_mfma_f32_16x16x32_bf16 v[186:189], a[24:27], v[182:185], 0
    v_cvt_pk_f16_f32 v124, v194, v195
    v_pk_fma_f16 v199, v124, v124, v199
    v_mfma_f32_16x16x32_bf16 v[186:189], a[28:31], v[210:213], v[186:189]
    v_cvt_pk_f16_f32 v125, v196, v197
    v_pk_fma_f16 v199, v125, v125, v199
    v_mfma_f32_16x16x32_bf16 v[186:189], a[32:35], v[218:221], v[186:189]
    v_cvt_pk_f16_f32 v178, v178, v179
    v_pk_mul_f16 v198, v178, v178
    v_mfma_f32_16x16x32_bf16 v[186:189], a[36:39], v[222:225], v[186:189]
    v_cvt_pk_f16_f32 v179, v180, v181
    v_pk_fma_f16 v198, v179, v179, v198
    v_mfma_f32_16x16x32_bf16 v[186:189], a[40:43], v[226:229], v[186:189]
    v_pk_mul_f16 v200, v178, v170
    v_pk_fma_f16 v200, v179, v171, v200
    v_mfma_f32_16x16x32_bf16 v[186:189], a[44:47], v[190:193], v[186:189]
    v_pk_mul_f16 v201, v166, v174
    v_pk_fma_f16 v201, v167, v175, v201
    v_mfma_f32_16x16x32_bf16 v[194:197], a[48:51], v[182:185], 0
    v_pk_fma_f16 v201, v168, v176, v201
    v_pk_fma_f16 v201, v169, v177, v201
    v_mfma_f32_16x16x32_bf16 v[194:197], a[52:55], v[210:213], v[194:197]
    v_pk_fma_f16 v201, v124, v164, v201
    v_pk_fma_f16 v201, v125, v165, v201
    v_mfma_f32_16x16x32_bf16 v[194:197], a[56:59], v[218:221], v[194:197]
    v_cvt_pk_f16_f32 v180, v186, v187
    v_pk_fma_f16 v198, v180, v180, v198
    v_mfma_f32_16x16x32_bf16 v[194:197], a[60:63], v[222:225], v[194:197]
    v_cvt_pk_f16_f32 v181, v188, v189
    v_pk_fma_f16 v198, v181, v181, v198
    v_mfma_f32_16x16x32_bf16 v[194:197], a[64:67], v[226:229], v[194:197]
    v_pk_fma_f16 v200, v180, v172, v200
    v_pk_fma_f16 v200, v181, v173, v200
    v_mfma_f32_16x16x32_bf16 v[194:197], a[68:71], v[190:193], v[194:197]
    buffer_store_dwordx2 v[140:141], v18, s[12:15], 0 offen nt
    v_mul_f32 v242, v144, v242
    v_mul_f32 v243, v144, v243
    v_mfma_f32_16x16x32_bf16 v[186:189], v[182:185], a[144:147], 0
    v_cvt_pk_bf16_f32 v238, v242, v243
    v_mul_f32 v244, v144, v244
    v_mfma_f32_16x16x32_bf16 v[186:189], v[210:213], a[148:151], v[186:189]
    v_mul_f32 v245, v144, v245
    v_cvt_pk_f16_f32 v122, v194, v195
    v_mfma_f32_16x16x32_bf16 v[186:189], v[218:221], a[152:155], v[186:189]
    v_pk_fma_f16 v198, v122, v122, v198
    v_cvt_pk_f16_f32 v123, v196, v197
    v_mfma_f32_16x16x32_bf16 v[186:189], v[222:225], a[156:159], v[186:189]
    v_pk_fma_f16 v198, v123, v123, v198
    v_pk_fma_f16 v200, v122, v162, v200
    v_mfma_f32_16x16x32_bf16 v[186:189], v[226:229], a[160:163], v[186:189]
    ds_read_b128 v[202:205], v0 offset:32768
    v_pk_fma_f16 v200, v123, v163, v200
    v_mfma_f32_16x16x32_bf16 v[186:189], v[190:193], a[164:167], v[186:189]
    ds_read_b128 v[194:197], v1 offset:32768
    v_cvt_pk_bf16_f32 v239, v244, v245
    v_mfma_f32_16x16x32_f16 v[230:233], v[40:43], v[198:201], 0
    v_mul_f32 v158, v144, v158
    v_mul_f32 v159, v144, v159
    v_mfma_f32_16x16x32_bf16 v[246:249], v[182:185], a[168:171], 0
    ds_read_b128 v[214:217], v0 offset:32896
    v_cvt_pk_bf16_f32 v240, v158, v159
    v_mfma_f32_16x16x32_bf16 v[246:249], v[210:213], a[172:175], v[246:249]
    ds_read_b128 v[206:209], v1 offset:32896
    v_cvt_pk_bf16_f32 v136, v186, v187
    v_mfma_f32_16x16x32_bf16 v[246:249], v[218:221], a[176:179], v[246:249]
    ds_read_b128 v[198:201], v0 offset:33024
    v_cvt_pk_bf16_f32 v137, v188, v189
    v_mfma_f32_16x16x32_bf16 v[246:249], v[222:225], a[180:183], v[246:249]
    ds_read_b128 v[186:189], v1 offset:33024
    v_mul_f32 v160, v144, v160
    v_mfma_f32_16x16x32_bf16 v[246:249], v[226:229], a[184:187], v[246:249]
    v_rsq_f32 v230, v230
    v_mfma_f32_16x16x32_bf16 v[246:249], v[190:193], a[188:191], v[246:249]
    s_waitcnt lgkmcnt(5)
    v_rsq_f32 v231, v231
    v_mfma_f32_16x16x32_bf16 v[242:245], v[182:185], a[192:195], 0
    s_waitcnt lgkmcnt(4)
    v_mul_f32 v234, s31, v230
    v_cvt_pk_f16_f32 v235, v234, v231
    v_mfma_f32_16x16x32_bf16 v[242:245], v[210:213], a[196:199], v[242:245]
    v_fma_f32 v232, v232, v234, v24
    v_fmac_f32_dpp v254, v233, v231 quad_perm:[0,1,2,3] row_mask:0x2 bank_mask:0xf
    v_mfma_f32_16x16x32_bf16 v[242:245], v[218:221], a[200:203], v[242:245]
    s_waitcnt lgkmcnt(3)
    v_cvt_pk_bf16_f32 v140, v246, v247
    v_cvt_pk_bf16_f32 v141, v248, v249
    v_mfma_f32_16x16x32_bf16 v[242:245], v[222:225], a[204:207], v[242:245]
    s_waitcnt lgkmcnt(2)
    v_mul_f32 v161, v144, v161
    v_cvt_pk_bf16_f32 v241, v160, v161
    v_mfma_f32_16x16x32_bf16 v[242:245], v[226:229], a[208:211], v[242:245]
    s_waitcnt lgkmcnt(1)
    buffer_store_dwordx4 v[238:241], v17, s[12:15], 0 offen nt
    v_mul_f32 v154, v144, v154
    v_mul_f32 v155, v144, v155
    v_cvt_pk_bf16_f32 v154, v154, v155
    v_mul_f32 v156, v144, v156
    v_mfma_f32_16x16x32_bf16 v[242:245], v[190:193], a[212:215], v[242:245]
    s_waitcnt lgkmcnt(0)
    v_mul_f32 v157, v144, v157
    v_cvt_pk_bf16_f32 v155, v156, v157
    v_mfma_f32_16x16x32_bf16 v[158:161], a[72:75], v[202:205], 0
    v_pk_mul_f16 v166, v166, v235 op_sel:[0,1] op_sel_hi:[1,1]
    v_pk_mul_f16 v167, v167, v235 op_sel:[0,1] op_sel_hi:[1,1]
    v_mfma_f32_16x16x32_bf16 v[158:161], a[76:79], v[194:197], v[158:161]
    v_pk_mul_f16 v168, v168, v235 op_sel:[0,1] op_sel_hi:[1,1]
    v_cvt_pk_bf16_f32 v144, v242, v243
    v_mfma_f32_16x16x32_bf16 v[158:161], a[80:83], v[214:217], v[158:161]
    v_cvt_pk_bf16_f32 v145, v244, v245
    v_pk_mul_f16 v169, v169, v235 op_sel:[0,1] op_sel_hi:[1,1]
    v_mfma_f32_16x16x32_bf16 v[158:161], a[84:87], v[206:209], v[158:161]
    v_pk_mul_f16 v124, v124, v235 op_sel:[0,1] op_sel_hi:[1,1]
    v_pk_mul_f16 v125, v125, v235 op_sel:[0,1] op_sel_hi:[1,1]
    v_mfma_f32_16x16x32_bf16 v[158:161], a[88:91], v[198:201], v[158:161]
    v_pk_mul_f16 v178, v178, v235 op_sel:[0,0] op_sel_hi:[1,0]
    v_pk_mul_f16 v179, v179, v235 op_sel:[0,0] op_sel_hi:[1,0]
    v_mfma_f32_16x16x32_bf16 v[158:161], a[92:95], v[186:189], v[158:161]
    v_pk_mul_f16 v180, v180, v235 op_sel:[0,0] op_sel_hi:[1,0]
    v_pk_mul_f16 v181, v181, v235 op_sel:[0,0] op_sel_hi:[1,0]
    v_mfma_f32_16x16x32_bf16 v[182:185], a[96:99], v[202:205], 0
    v_pk_mul_f16 v122, v122, v235 op_sel:[0,0] op_sel_hi:[1,0]
    v_pk_mul_f16 v123, v123, v235 op_sel:[0,0] op_sel_hi:[1,0]
    v_mfma_f32_16x16x32_bf16 v[182:185], a[100:103], v[194:197], v[182:185]
    v_max3_u32 v44, v44, v230, v231
    v_mul_f32 v130, v255, v130
    v_mfma_f32_16x16x32_bf16 v[182:185], a[104:107], v[214:217], v[182:185]
    v_cvt_pk_f16_f32 v158, v158, v159
    v_pk_mul_f16 v191, v158, v158
    v_mfma_f32_16x16x32_bf16 v[182:185], a[108:111], v[206:209], v[182:185]
    v_cvt_pk_f16_f32 v159, v160, v161
    v_pk_fma_f16 v191, v159, v159, v191
    v_mfma_f32_16x16x32_bf16 v[182:185], a[112:115], v[198:201], v[182:185]
    v_pk_mul_f16 v193, v158, v174
    v_pk_fma_f16 v193, v159, v175, v193
    v_mfma_f32_16x16x32_bf16 v[182:185], a[116:119], v[186:189], v[182:185]
    v_exp_f32 v232, v232
    v_mfma_f32_16x16x32_bf16 v[210:213], a[120:123], v[202:205], 0
    v_exp_f32 v236, v236
    v_mfma_f32_16x16x32_bf16 v[210:213], a[124:127], v[194:197], v[210:213]
    v_cvt_pk_bf16_f32 v39, v236, 0
    v_mul_f32 v131, v255, v131
    v_mfma_f32_16x16x32_bf16 v[210:213], a[128:131], v[214:217], v[210:213]
    s_waitcnt vmcnt(3)
    ds_write_b16 v8, v45 offset:512
    v_mfma_f32_16x16x32_bf16 v[210:213], a[132:135], v[206:209], v[210:213]
    buffer_store_dwordx2 v[154:155], v20, s[12:15], 0 offen nt
    v_cvt_pk_f16_f32 v160, v182, v183
    v_mfma_f32_16x16x32_bf16 v[210:213], a[136:139], v[198:201], v[210:213]
    v_pk_fma_f16 v191, v160, v160, v191
    v_cvt_pk_f16_f32 v161, v184, v185
    v_mfma_f32_16x16x32_bf16 v[210:213], a[140:143], v[186:189], v[210:213]
    v_pk_fma_f16 v191, v161, v161, v191
    v_pk_fma_f16 v193, v160, v176, v193
    v_mfma_f32_16x16x32_bf16 v[154:157], a[0:3], v[202:205], 0
    v_pk_fma_f16 v193, v161, v177, v193
    v_cvt_pk_bf16_f32 v130, v130, v131
    v_mfma_f32_16x16x32_bf16 v[154:157], a[4:7], v[194:197], v[154:157]
    v_mul_f32 v132, v255, v132
    v_mul_f32 v133, v255, v133
    v_mfma_f32_16x16x32_bf16 v[154:157], a[8:11], v[214:217], v[154:157]
    v_cvt_pk_f16_f32 v176, v210, v211
    v_pk_fma_f16 v191, v176, v176, v191
    v_mfma_f32_16x16x32_bf16 v[154:157], a[12:15], v[206:209], v[154:157]
    s_waitcnt lgkmcnt(0)
    v_cvt_pk_f16_f32 v177, v212, v213
    v_pk_fma_f16 v191, v177, v177, v191
    v_mfma_f32_16x16x32_bf16 v[154:157], a[16:19], v[198:201], v[154:157]
    v_pk_fma_f16 v193, v176, v164, v193
    v_mfma_f32_16x16x32_bf16 v[154:157], a[20:23], v[186:189], v[154:157]
    s_barrier
    v_pk_fma_f16 v193, v177, v165, v193
    v_mfma_f32_16x16x32_bf16 v[182:185], a[24:27], v[202:205], 0
    v_cvt_pk_bf16_f32 v131, v132, v133
    v_mfma_f32_16x16x32_bf16 v[182:185], a[28:31], v[194:197], v[182:185]
    ds_read2_b32 v[164:165], v6 offset0:0 offset1:0
    v_mfma_f32_16x16x32_bf16 v[182:185], a[32:35], v[214:217], v[182:185]
    ds_read2_b32 v[212:213], v6 offset0:16 offset1:16
    v_cvt_pk_f16_f32 v154, v154, v155
    v_mfma_f32_16x16x32_bf16 v[182:185], a[36:39], v[206:209], v[182:185]
    ds_read2_b32 v[220:221], v6 offset0:32 offset1:32
    v_pk_mul_f16 v190, v154, v154
    v_mfma_f32_16x16x32_bf16 v[182:185], a[40:43], v[198:201], v[182:185]
    ds_read_u16 v133, v9 offset:384
    v_cvt_pk_f16_f32 v155, v156, v157
    v_mfma_f32_16x16x32_bf16 v[182:185], a[44:47], v[186:189], v[182:185]
    v_pk_fma_f16 v190, v155, v155, v190
    v_pk_mul_f16 v192, v154, v170
    v_mfma_f32_16x16x32_bf16 v[222:225], a[48:51], v[202:205], 0
    v_pk_fma_f16 v192, v155, v171, v192
    v_mul_f32 v126, v255, v126
    v_mfma_f32_16x16x32_bf16 v[222:225], a[52:55], v[194:197], v[222:225]
    v_mul_f32 v127, v255, v127
    v_cvt_pk_bf16_f32 v132, v126, v127
    v_mfma_f32_16x16x32_bf16 v[222:225], a[56:59], v[214:217], v[222:225]
    buffer_load_dwordx4 v10, s[8:11], 0 offen nt lds
    v_cvt_pk_f16_f32 v156, v182, v183
    v_mfma_f32_16x16x32_bf16 v[222:225], a[60:63], v[206:209], v[222:225]
    s_add_u32 m0, s28, 4096
    v_pk_fma_f16 v190, v156, v156, v190
    v_cvt_pk_f16_f32 v157, v184, v185
    v_mfma_f32_16x16x32_bf16 v[222:225], a[64:67], v[198:201], v[222:225]
    s_waitcnt lgkmcnt(2)
    v_pk_fma_f16 v190, v157, v157, v190
    v_pk_fma_f16 v192, v156, v172, v192
    v_mfma_f32_16x16x32_bf16 v[222:225], a[68:71], v[186:189], v[222:225]
    s_waitcnt lgkmcnt(1)
    ds_read_b128 v[182:185], v2 offset:0
    v_pk_fma_f16 v192, v157, v173, v192
    v_mfma_f32_16x16x32_bf16 v[170:173], v[202:205], a[144:147], 0
    s_waitcnt lgkmcnt(1)
    ds_read_b128 v[226:229], v2 offset:1024
    v_readfirstlane_b32 s77, v133
    v_mfma_f32_16x16x32_bf16 v[170:173], v[194:197], a[148:151], v[170:173]
    ds_read_b128 v[234:237], v2 offset:2048
    buffer_load_dwordx4 v11, s[8:11], 0 offen nt lds
    v_mfma_f32_16x16x32_bf16 v[170:173], v[214:217], a[152:155], v[170:173]
    s_add_u32 m0, s28, 8192
    ds_read_b128 v[238:241], v2 offset:3072
    v_cvt_pk_f16_f32 v174, v222, v223
    v_mfma_f32_16x16x32_bf16 v[170:173], v[206:209], a[156:159], v[170:173]
    s_mul_i32 s78, s77, 2688
    ds_read_b128 v[242:245], v2 offset:4096
    v_pk_fma_f16 v190, v174, v174, v190
    v_mfma_f32_16x16x32_bf16 v[170:173], v[198:201], a[160:163], v[170:173]
    ds_read_b128 v[246:249], v2 offset:5120
    v_cvt_pk_f16_f32 v175, v224, v225
    v_mfma_f32_16x16x32_bf16 v[170:173], v[186:189], a[164:167], v[170:173]
    v_pk_fma_f16 v190, v175, v175, v190
    v_pk_fma_f16 v192, v174, v162, v192
    v_mfma_f32_16x16x32_bf16 v[222:225], v[202:205], a[168:171], 0
    buffer_load_dwordx4 v12, s[8:11], 0 offen nt lds
    v_pk_fma_f16 v192, v175, v163, v192
    v_mfma_f32_16x16x32_bf16 v[222:225], v[194:197], a[172:175], v[222:225]
    s_waitcnt lgkmcnt(5)
    v_mul_f32 v128, v255, v128
    v_cvt_pk_bf16_f32 v162, v170, v171
    v_mfma_f32_16x16x32_f16 v[250:253], v[40:43], v[190:193], 0
    s_add_u32 m0, s28, 12288
    v_cvt_pk_bf16_f32 v163, v172, v173
    v_mul_f32 v129, v255, v129
    v_mfma_f32_16x16x32_bf16 v[222:225], v[214:217], a[176:179], v[222:225]
    s_xor_b32 s28, s28, 65536
    v_cvt_pk_bf16_f32 v133, v128, v129
    v_mul_f32 v114, v255, v114
    v_mfma_f32_16x16x32_bf16 v[222:225], v[206:209], a[180:183], v[222:225]
    s_waitcnt lgkmcnt(2)
    v_rsq_f32 v250, v250
    v_mfma_f32_16x16x32_bf16 v[222:225], v[198:201], a[184:187], v[222:225]
    s_waitcnt lgkmcnt(1)
    buffer_load_dwordx4 v13, s[8:11], 0 offen nt lds
    v_mul_f32 v230, s31, v250
    v_mfma_f32_16x16x32_bf16 v[222:225], v[186:189], a[188:191], v[222:225]
    s_mov_b32 m0, s29
    v_rsq_f32 v251, v251
    v_mfma_f32_16x16x32_bf16 v[126:129], v[202:205], a[192:195], 0
    s_xor_b32 s29, s29, s30
    v_cvt_pk_f16_f32 v231, v230, v251
    v_fma_f32 v252, v252, v230, v26
    v_mfma_f32_16x16x32_bf16 v[126:129], v[194:197], a[196:199], v[126:129]
    s_add_u32 s19, s19, s20
    v_fmac_f32_dpp v254, v253, v251 quad_perm:[0,1,2,3] row_mask:0x4 bank_mask:0xf
    v_cvt_pk_bf16_f32 v210, v222, v223
    v_mfma_f32_16x16x32_bf16 v[126:129], v[214:217], a[200:203], v[126:129]
    s_add_u32 s23, s23, s21
    v_cvt_pk_bf16_f32 v211, v224, v225
    v_pk_mul_f16 v158, v158, v231 op_sel:[0,1] op_sel_hi:[1,1]
    v_mfma_f32_16x16x32_bf16 v[126:129], v[206:209], a[204:207], v[126:129]
    s_waitcnt lgkmcnt(0)
    buffer_load_dwordx4 v14, s[8:11], 0 offen nt lds
    v_pk_mul_f16 v159, v159, v231 op_sel:[0,1] op_sel_hi:[1,1]
    v_mfma_f32_16x16x32_bf16 v[126:129], v[198:201], a[208:211], v[126:129]
    s_cmp_ge_u32 s19, 72
    v_pk_mul_f16 v160, v160, v231 op_sel:[0,1] op_sel_hi:[1,1]
    v_pk_mul_f16 v161, v161, v231 op_sel:[0,1] op_sel_hi:[1,1]
    v_mfma_f32_16x16x32_bf16 v[126:129], v[186:189], a[212:215], v[126:129]
    s_cselect_b32 s34, 72, 0
    v_pk_mul_f16 v176, v176, v231 op_sel:[0,1] op_sel_hi:[1,1]
    v_pk_mul_f16 v177, v177, v231 op_sel:[0,1] op_sel_hi:[1,1]
    v_mfma_f32_16x16x32_f16 v[170:173], v[146:149], v[150:153], v[46:49]
    s_cselect_b32 s35, s22, 0
    v_pk_mul_f16 v154, v154, v231 op_sel:[0,0] op_sel_hi:[1,0]
    v_pk_mul_f16 v155, v155, v231 op_sel:[0,0] op_sel_hi:[1,0]
    v_mfma_f32_16x16x32_f16 v[186:189], v[166:169], v[150:153], v[50:53]
    s_sub_u32 s19, s19, s34
    v_cvt_pk_bf16_f32 v218, v126, v127
    v_cvt_pk_bf16_f32 v219, v128, v129
    v_mfma_f32_16x16x32_f16 v[126:129], v[158:161], v[150:153], v[54:57]
    buffer_store_dwordx4 v[130:133], v16, s[12:15], 0 offen nt
    v_pk_mul_f16 v156, v156, v231 op_sel:[0,0] op_sel_hi:[1,0]
    v_pk_mul_f16 v157, v157, v231 op_sel:[0,0] op_sel_hi:[1,0]
    v_pk_mul_f16 v174, v174, v231 op_sel:[0,0] op_sel_hi:[1,0]
    v_pk_mul_f16 v175, v175, v231 op_sel:[0,0] op_sel_hi:[1,0]
    v_mfma_f32_16x16x16_f16 v[170:173], v[120:121], v[118:119], v[170:173]
    v_max3_u32 v44, v44, v250, v251
    v_exp_f32 v254, v254
    v_mfma_f32_16x16x16_f16 v[186:189], v[124:125], v[118:119], v[186:189]
    v_cvt_pk_bf16_f32 v254, v254, v254
    v_exp_f32 v252, v252
    v_mfma_f32_16x16x16_f16 v[126:129], v[176:177], v[118:119], v[126:129]
    v_mul_f32 v115, v255, v115
    v_cvt_pk_bf16_f32 v118, v114, v115
    v_exp_f32 v170, v170
    v_mfma_f32_16x16x32_f16 v[130:133], v[146:149], v[178:181], v[58:61]
    s_add_u32 s23, s23, s35
    ds_write_b16 v8, v254
    v_mfma_f32_16x16x32_f16 v[150:153], v[166:169], v[178:181], v[62:65]
    s_add_u32 s78, s78, s69
    v_exp_f32 v171, v171
    v_mfma_f32_16x16x32_f16 v[190:193], v[158:161], v[178:181], v[66:69]
    s_add_u32 s80, s77, s68
    v_cvt_pk_bf16_f32 v170, v170, v171
    v_exp_f32 v172, v172
    v_mfma_f32_16x16x16_f16 v[130:133], v[120:121], v[122:123], v[130:133]
    v_exp_f32 v173, v173
    v_mul_f32 v116, v255, v116
    v_mfma_f32_16x16x16_f16 v[150:153], v[124:125], v[122:123], v[150:153]
    v_cvt_pk_bf16_f32 v171, v172, v173
    v_exp_f32 v186, v186
    v_mfma_f32_16x16x16_f16 v[190:193], v[176:177], v[122:123], v[190:193]
    v_exp_f32 v187, v187
    v_exp_f32 v188, v188
    v_mfma_f32_16x16x32_bf16 v[178:181], a[216:219], v[182:185], 0
    s_cmp_ge_u32 s80, 72
    v_exp_f32 v130, v130
    v_mfma_f32_16x16x32_bf16 v[178:181], a[220:223], v[226:229], v[178:181]
    s_cselect_b32 s80, s22, 0
    v_exp_f32 v131, v131
    v_mfma_f32_16x16x32_bf16 v[178:181], a[224:227], v[234:237], v[178:181]
    s_add_u32 s78, s78, s80
    v_cvt_pk_bf16_f32 v194, v130, v131
    v_cvt_pk_bf16_f32 v172, v186, v187
    v_mfma_f32_16x16x32_bf16 v[178:181], a[228:231], v[238:241], v[178:181]
    s_add_u32 s80, s77, 20
    v_exp_f32 v132, v132
    v_mfma_f32_16x16x32_bf16 v[178:181], a[232:235], v[242:245], v[178:181]
    s_add_u32 s34, s18, 3
    v_exp_f32 v133, v133
    v_mfma_f32_16x16x32_bf16 v[178:181], a[236:239], v[246:249], v[178:181]
    s_cmp_lt_u32 s77, s62
    v_cvt_pk_bf16_f32 v195, v132, v133
    v_mul_f32 v117, v255, v117
    v_mfma_f32_16x16x32_bf16 v[198:201], a[240:243], v[182:185], 0
    s_cselect_b32 s79, 1, 0
    v_exp_f32 v150, v150
    v_mfma_f32_16x16x32_f16 v[202:205], v[146:149], v[154:157], v[70:73]
    s_cselect_b32 s78, s78, 0
    v_exp_f32 v151, v151
    v_mfma_f32_16x16x32_f16 v[146:149], v[166:169], v[154:157], v[74:77]
    s_cmp_lt_u32 s34, s17
    v_cvt_pk_bf16_f32 v196, v150, v151
    v_cvt_pk_bf16_f32 v119, v116, v117
    v_mfma_f32_16x16x32_f16 v[166:169], v[158:161], v[154:157], v[78:81]
    buffer_store_dwordx2 v[118:119], v19, s[12:15], 0 offen nt
    v_exp_f32 v152, v152
    v_mfma_f32_16x16x16_f16 v[202:205], v[120:121], v[174:175], v[202:205]
    v_exp_f32 v153, v153
    v_fma_f32 v254, v178, v178, s33
    v_mfma_f32_16x16x16_f16 v[146:149], v[124:125], v[174:175], v[146:149]
    v_cvt_pk_bf16_f32 v197, v152, v153
    v_exp_f32 v190, v190
    v_mfma_f32_16x16x16_f16 v[166:169], v[176:177], v[174:175], v[166:169]
    v_exp_f32 v191, v191
    v_exp_f32 v192, v192
    v_mfma_f32_16x16x32_bf16 v[198:201], a[244:247], v[226:229], v[198:201]
    s_cselect_b32 s23, s23, s78
    v_exp_f32 v193, v193
    v_mfma_f32_16x16x32_bf16 v[198:201], a[248:251], v[234:237], v[198:201]
    s_cselect_b32 s73, s34, s80
    ds_read_b128 v[118:121], v2 offset:6144
    v_fmac_f32 v254, v179, v179
    v_mfma_f32_16x16x32_bf16 v[198:201], a[252:255], v[238:241], v[198:201]
    s_cselect_b32 s79, 0, s79
    ds_read_b128 v[122:125], v2 offset:7168
    v_fmac_f32 v254, v180, v180
    v_mfma_f32_16x16x32_bf16 v[198:201], v[82:85], v[242:245], v[198:201]
    s_cselect_b32 s81, 0, 1
    ds_read_b128 v[150:153], v2 offset:8192
    v_fmac_f32 v254, v181, v181
    v_mfma_f32_16x16x32_bf16 v[198:201], v[86:89], v[246:249], v[198:201]
    s_add_u32 s80, s77, 1
    ds_read_b128 v[154:157], v2 offset:9216
    v_xor_b32 v0, 65536, v0
    v_mfma_f32_16x16x32_bf16 v[206:209], v[90:93], v[182:185], 0
    s_mul_i32 s80, s80, s81
    ds_read_b128 v[158:161], v2 offset:10240
    v_xor_b32 v1, 65536, v1
    v_mfma_f32_16x16x32_bf16 v[206:209], v[94:97], v[226:229], v[206:209]
    s_cmp_lt_u32 s80, s62
    ds_read_b128 v[174:177], v2 offset:11264
    v_fmac_f32 v254, v198, v198
    v_mfma_f32_16x16x32_bf16 v[206:209], v[98:101], v[234:237], v[206:209]
    s_cselect_b32 s62, s62, 0
    v_exp_f32 v189, v189
    v_mfma_f32_16x16x32_bf16 v[206:209], v[102:105], v[238:241], v[206:209]
    s_add_u32 s80, s18, 4
    v_cvt_pk_bf16_f32 v173, v188, v189
    v_fmac_f32 v254, v199, v199
    v_mfma_f32_16x16x32_bf16 v[206:209], v[106:109], v[242:245], v[206:209]
    s_waitcnt lgkmcnt(5)
    v_exp_f32 v126, v126
    v_mfma_f32_16x16x32_bf16 v[206:209], v[110:113], v[246:249], v[206:209]
    s_cmp_ge_u32 s80, s17
    v_exp_f32 v127, v127
    v_mfma_f32_16x16x32_bf16 v[130:133], a[216:219], v[118:121], 0
    s_waitcnt lgkmcnt(3)
    v_cvt_pk_bf16_f32 v36, v126, v127
    v_fmac_f32 v254, v200, v200
    v_mfma_f32_16x16x32_bf16 v[130:133], a[220:223], v[122:125], v[130:133]
    s_cselect_b32 s66, s62, 0
    v_exp_f32 v128, v128
    v_mfma_f32_16x16x32_bf16 v[130:133], a[224:227], v[150:153], v[130:133]
    s_waitcnt lgkmcnt(1)
    v_fmac_f32 v254, v201, v201
    v_mfma_f32_16x16x32_bf16 v[130:133], a[228:231], v[154:157], v[130:133]
    s_lshl_b32 s80, s79, s73
    v_exp_f32 v129, v129
    v_mfma_f32_16x16x32_bf16 v[130:133], a[232:235], v[158:161], v[130:133]
    s_waitcnt lgkmcnt(0)
    v_cvt_pk_bf16_f32 v37, v128, v129
    v_fmac_f32 v254, v206, v206
    v_mfma_f32_16x16x32_bf16 v[130:133], a[236:239], v[174:177], v[130:133]
    s_or_b32 s70, s70, s80
    v_exp_f32 v202, v202
    v_mfma_f32_16x16x32_bf16 v[182:185], v[28:31], v[36:39], 0
    s_add_u32 s45, s45, s79
    v_exp_f32 v203, v203
    v_mfma_f32_16x16x32_bf16 v[182:185], v[28:31], v[170:173], v[182:185]
    s_add_u32 s18, s18, 1
    v_cvt_pk_bf16_f32 v186, v202, v203
    v_fma_f32 v255, v130, v130, s33
    v_mfma_f32_16x16x32_bf16 v[214:217], v[162:165], v[36:39], 0
    s_cmp_lt_u32 s18, s45
    v_fmac_f32 v255, v131, v131
    v_fmac_f32 v255, v132, v132
    v_mfma_f32_16x16x32_bf16 v[214:217], v[134:137], v[170:173], v[214:217]
    v_fmac_f32 v255, v133, v133
    v_fmac_f32 v254, v207, v207
    v_mfma_f32_16x16x32_bf16 v[222:225], v[210:213], v[36:39], 0
    v_exp_f32 v204, v204
    v_mfma_f32_16x16x32_bf16 v[222:225], v[138:141], v[170:173], v[222:225]
    v_exp_f32 v205, v205
    v_mfma_f32_16x16x32_bf16 v[226:229], v[218:221], v[36:39], 0
    v_cvt_pk_bf16_f32 v36, v190, v191
    v_cvt_pk_bf16_f32 v37, v192, v193
    v_mfma_f32_16x16x32_bf16 v[226:229], v[142:145], v[170:173], v[226:229]
    v_cvt_pk_bf16_f32 v39, v232, 0
    v_cvt_pk_bf16_f32 v187, v204, v205
    v_mfma_f32_16x16x32_bf16 v[126:129], a[240:243], v[118:121], 0
    v_exp_f32 v146, v146
    v_mfma_f32_16x16x32_bf16 v[170:173], v[28:31], v[36:39], 0
    v_exp_f32 v147, v147
    v_mfma_f32_16x16x32_bf16 v[170:173], v[28:31], v[194:197], v[170:173]
    v_cvt_pk_bf16_f32 v188, v146, v147
    v_fmac_f32 v254, v208, v208
    v_mfma_f32_16x16x32_bf16 v[114:117], v[162:165], v[36:39], 0
    v_exp_f32 v148, v148
    v_mfma_f32_16x16x32_bf16 v[114:117], v[134:137], v[194:197], v[114:117]
    v_exp_f32 v149, v149
    v_mfma_f32_16x16x32_bf16 v[190:193], v[210:213], v[36:39], 0
    v_cvt_pk_bf16_f32 v189, v148, v149
    v_fmac_f32 v254, v209, v209
    v_mfma_f32_16x16x32_bf16 v[190:193], v[138:141], v[194:197], v[190:193]
    v_rcp_f32 v170, v170
    v_mfma_f32_16x16x32_bf16 v[146:149], v[218:221], v[36:39], 0
    v_exp_f32 v166, v166
    v_mfma_f32_16x16x32_bf16 v[146:149], v[142:145], v[194:197], v[146:149]
    v_mul_f32 v114, v170, v114
    v_mul_f32 v115, v170, v115
    v_mfma_f32_16x16x32_bf16 v[126:129], a[244:247], v[122:125], v[126:129]
    v_cvt_pk_bf16_f32 v194, v114, v115
    v_mul_f32 v116, v170, v116
    v_mfma_f32_16x16x32_bf16 v[126:129], a[248:251], v[150:153], v[126:129]
    ds_read_b128 v[202:205], v2 offset:12288
    v_mul_f32 v117, v170, v117
    v_mfma_f32_16x16x32_bf16 v[126:129], a[252:255], v[154:157], v[126:129]
    ds_read_b128 v[230:233], v2 offset:13312
    v_cvt_pk_bf16_f32 v195, v116, v117
    v_mfma_f32_16x16x32_bf16 v[126:129], v[82:85], v[158:161], v[126:129]
    ds_read_b128 v[234:237], v2 offset:14336
    v_mul_f32 v190, v170, v190
    v_mfma_f32_16x16x32_bf16 v[126:129], v[86:89], v[174:177], v[126:129]
    ds_read_b128 v[238:241], v2 offset:15360
    v_mul_f32 v191, v170, v191
    v_mfma_f32_16x16x32_bf16 v[114:117], v[90:93], v[118:121], 0
    ds_read_b128 v[118:121], v2 offset:16384
    v_cvt_pk_bf16_f32 v196, v190, v191
    v_mfma_f32_16x16x32_bf16 v[114:117], v[94:97], v[122:125], v[114:117]
    ds_read_b128 v[122:125], v2 offset:17408
    v_mul_f32 v192, v170, v192
    v_mfma_f32_16x16x32_bf16 v[114:117], v[98:101], v[150:153], v[114:117]
    v_fmac_f32 v255, v126, v126
    v_fmac_f32 v255, v127, v127
    v_mfma_f32_16x16x32_bf16 v[114:117], v[102:105], v[154:157], v[114:117]
    v_fmac_f32 v255, v128, v128
    v_fmac_f32 v255, v129, v129
    v_mfma_f32_16x16x32_bf16 v[114:117], v[106:109], v[158:161], v[114:117]
    s_waitcnt lgkmcnt(5)
    v_mul_f32 v193, v170, v193
    v_cvt_pk_bf16_f32 v197, v192, v193
    v_mfma_f32_16x16x32_bf16 v[114:117], v[110:113], v[174:177], v[114:117]
    s_waitcnt lgkmcnt(4)
    ds_write_b128 v3, v[194:197] offset:6144
    v_mfma_f32_16x16x32_bf16 v[242:245], a[216:219], v[202:205], 0
    s_waitcnt lgkmcnt(3)
    v_mul_f32 v146, v170, v146
    v_mul_f32 v147, v170, v147
    v_mfma_f32_16x16x32_bf16 v[242:245], a[220:223], v[230:233], v[242:245]
    s_waitcnt lgkmcnt(2)
    v_fmac_f32 v255, v114, v114
    v_fmac_f32 v255, v115, v115
    v_mfma_f32_16x16x32_bf16 v[242:245], a[224:227], v[234:237], v[242:245]
    s_waitcnt lgkmcnt(1)
    v_fmac_f32 v255, v116, v116
    v_fmac_f32 v255, v117, v117
    v_mfma_f32_16x16x32_bf16 v[242:245], a[228:231], v[238:241], v[242:245]
    v_cvt_pk_bf16_f32 v254, v254, v255
    v_cvt_pk_bf16_f32 v172, v146, v147
    v_mfma_f32_16x16x32_bf16 v[242:245], a[232:235], v[118:121], v[242:245]
    v_mul_f32 v148, v170, v148
    v_mul_f32 v149, v170, v149
    v_mfma_f32_16x16x32_bf16 v[242:245], a[236:239], v[122:125], v[242:245]
    v_cvt_pk_bf16_f32 v173, v148, v149
    v_cvt_pk_bf16_f32 v39, v252, 0
    v_mfma_f32_16x16x32_bf16 v[158:161], a[240:243], v[202:205], 0
    ds_write_b64 v4, v[172:173] offset:10240
    v_mfma_f32_16x16x32_bf16 v[158:161], a[244:247], v[230:233], v[158:161]
    v_exp_f32 v167, v167
    v_mfma_f32_16x16x32_bf16 v[158:161], a[248:251], v[234:237], v[158:161]
    v_cvt_pk_bf16_f32 v36, v166, v167
    v_fma_f32 v255, v242, v242, s33
    v_mfma_f32_16x16x32_bf16 v[158:161], a[252:255], v[238:241], v[158:161]
    v_fmac_f32 v255, v243, v243
    v_fmac_f32 v255, v244, v244
    v_mfma_f32_16x16x32_bf16 v[158:161], v[82:85], v[118:121], v[158:161]
    v_fmac_f32 v255, v245, v245
    v_xor_b32 v2, 65536, v2
    v_mfma_f32_16x16x32_bf16 v[158:161], v[86:89], v[122:125], v[158:161]
    v_exp_f32 v168, v168
    v_mfma_f32_16x16x32_bf16 v[154:157], v[90:93], v[202:205], 0
    v_exp_f32 v169, v169
    v_mfma_f32_16x16x32_bf16 v[154:157], v[94:97], v[230:233], v[154:157]
    ds_read_b128 v[146:149], v9
    v_cvt_pk_bf16_f32 v37, v168, v169
    v_mfma_f32_16x16x32_bf16 v[154:157], v[98:101], v[234:237], v[154:157]
    ds_read_b128 v[150:153], v9 offset:64
    v_fmac_f32 v255, v158, v158
    v_mfma_f32_16x16x32_bf16 v[166:169], v[28:31], v[36:39], 0
    v_fmac_f32 v255, v159, v159
    v_fmac_f32 v255, v160, v160
    v_mfma_f32_16x16x32_bf16 v[166:169], v[28:31], v[186:189], v[166:169]
    v_fmac_f32 v255, v161, v161
    v_add_u32 v6, s75, v6
    v_mfma_f32_16x16x32_bf16 v[174:177], v[162:165], v[36:39], 0
    v_rcp_f32 v182, v182
    v_mfma_f32_16x16x32_bf16 v[174:177], v[134:137], v[186:189], v[174:177]
    v_max3_u32 v25, v25, v182, v183
    v_max3_u32 v25, v25, v170, v171
    v_mfma_f32_16x16x32_bf16 v[170:173], v[210:213], v[36:39], 0
    v_rcp_f32 v166, v166
    v_mfma_f32_16x16x32_bf16 v[170:173], v[138:141], v[186:189], v[170:173]
    v_max3_u32 v25, v25, v166, v167
    v_mul_f32 v214, v182, v214
    v_mfma_f32_16x16x32_bf16 v[190:193], v[218:221], v[36:39], 0
    s_waitcnt lgkmcnt(1)
    v_mul_f32 v174, v166, v174
    v_mul_f32 v175, v166, v175
    v_mfma_f32_16x16x32_bf16 v[190:193], v[142:145], v[186:189], v[190:193]
    s_waitcnt lgkmcnt(0)
    v_cvt_pk_bf16_f32 v174, v174, v175
    v_mul_f32 v176, v166, v176
    v_mfma_f32_16x16x32_bf16 v[154:157], v[102:105], v[238:241], v[154:157]
    ds_read_b128 v[186:189], v0 offset:20480
    v_mul_f32 v177, v166, v177
    v_mfma_f32_16x16x32_bf16 v[154:157], v[106:109], v[118:121], v[154:157]
    ds_read_b128 v[194:197], v1 offset:20480
    v_cvt_pk_bf16_f32 v175, v176, v177
    v_mfma_f32_16x16x32_bf16 v[154:157], v[110:113], v[122:125], v[154:157]
    ds_read_b128 v[122:125], v0 offset:20608
    v_mul_f32 v170, v166, v170
    v_mfma_f32_16x16x32_bf16 v[118:121], v[146:149], v[28:31], 0
    ds_read_b128 v[202:205], v1 offset:20608
    v_mul_f32 v171, v166, v171
    v_mfma_f32_16x16x32_bf16 v[118:121], v[150:153], v[28:31], v[118:121]
    ds_read_b128 v[230:233], v0 offset:20736
    v_cvt_pk_bf16_f32 v176, v170, v171
    v_mfma_f32_16x16x32_bf16 v[234:237], v[146:149], v[134:137], 0
    ds_read_b128 v[238:241], v1 offset:20736
    v_fmac_f32 v255, v154, v154
    v_mfma_f32_16x16x32_bf16 v[234:237], v[150:153], v[162:165], v[234:237]
    v_fmac_f32 v255, v155, v155
    v_fmac_f32 v255, v156, v156
    v_mfma_f32_16x16x32_bf16 v[134:137], v[146:149], v[138:141], 0
    v_fmac_f32 v255, v157, v157
    v_cvt_pk_bf16_f32 v255, v255, v255
    v_mfma_f32_16x16x32_bf16 v[134:137], v[150:153], v[210:213], v[134:137]
    s_waitcnt lgkmcnt(5)
    ds_write_b64 v4, v[254:255] offset:18432
    v_mfma_f32_16x16x32_bf16 v[138:141], v[146:149], v[142:145], 0
    s_waitcnt lgkmcnt(4)
    v_mul_f32 v172, v166, v172
    v_mul_f32 v173, v166, v173
    v_mfma_f32_16x16x32_bf16 v[138:141], v[150:153], v[218:221], v[138:141]
    s_waitcnt lgkmcnt(3)
    v_cvt_pk_bf16_f32 v177, v172, v173
    v_mul_f32 v190, v166, v190
    v_mfma_f32_16x16x32_bf16 v[142:145], a[72:75], v[186:189], 0
    s_waitcnt lgkmcnt(2)
    ds_write_b128 v3, v[174:177] offset:12288
    v_mfma_f32_16x16x32_bf16 v[142:145], a[76:79], v[194:197], v[142:145]
    s_waitcnt lgkmcnt(2)
    v_mul_f32 v191, v166, v191
    v_cvt_pk_bf16_f32 v120, v190, v191
    v_mfma_f32_16x16x32_bf16 v[142:145], a[80:83], v[122:125], v[142:145]
    v_mul_f32 v192, v166, v192
    v_mul_f32 v193, v166, v193
    v_mfma_f32_16x16x32_bf16 v[142:145], a[84:87], v[202:205], v[142:145]
    v_cvt_pk_bf16_f32 v121, v192, v193
    v_mul_f32 v215, v182, v215
    v_mfma_f32_16x16x32_bf16 v[142:145], a[88:91], v[230:233], v[142:145]
    ds_write_b64 v4, v[120:121] offset:16384
    v_mfma_f32_16x16x32_bf16 v[142:145], a[92:95], v[238:241], v[142:145]
    v_rcp_f32 v118, v118
    v_mfma_f32_16x16x32_bf16 v[150:153], a[96:99], v[186:189], 0
    v_max3_u32 v25, v25, v118, v119
    v_mul_f32 v234, v234, v118
    v_mfma_f32_16x16x32_bf16 v[150:153], a[100:103], v[194:197], v[150:153]
    v_cvt_pk_bf16_f32 v146, v214, v215
    v_mul_f32_dpp v234, v134, v118 quad_perm:[0,1,2,3] row_mask:0x2 bank_mask:0xf
    v_mfma_f32_16x16x32_bf16 v[150:153], a[104:107], v[122:125], v[150:153]
    v_mul_f32 v216, v182, v216
    v_mul_f32_dpp v234, v138, v118 quad_perm:[0,1,2,3] row_mask:0x4 bank_mask:0xf
    v_mfma_f32_16x16x32_bf16 v[150:153], a[108:111], v[202:205], v[150:153]
    v_cvt_pk_bf16_f32 v234, v234, v234
    v_mul_f32 v217, v182, v217
    v_mfma_f32_16x16x32_bf16 v[150:153], a[112:115], v[230:233], v[150:153]
    ds_write_b16 v7, v234
    v_mfma_f32_16x16x32_bf16 v[150:153], a[116:119], v[238:241], v[150:153]
    v_cvt_pk_bf16_f32 v147, v216, v217
    v_mul_f32 v222, v182, v222
    v_mfma_f32_16x16x32_bf16 v[134:137], a[120:123], v[186:189], 0
    v_mul_f32 v223, v182, v223
    v_cvt_pk_bf16_f32 v148, v222, v223
    v_mfma_f32_16x16x32_bf16 v[134:137], a[124:127], v[194:197], v[134:137]
    v_mul_f32 v224, v182, v224
    v_mul_f32 v225, v182, v225
    v_mfma_f32_16x16x32_bf16 v[134:137], a[128:131], v[122:125], v[134:137]
    v_cvt_pk_bf16_f32 v149, v224, v225
    v_mul_f32 v226, v182, v226
    v_mfma_f32_16x16x32_bf16 v[134:137], a[132:135], v[202:205], v[134:137]
    ds_write_b128 v3, v[146:149] offset:0
    v_mfma_f32_16x16x32_bf16 v[134:137], a[136:139], v[230:233], v[134:137]
    v_mul_f32 v227, v182, v227
    v_cvt_pk_bf16_f32 v254, v226, v227
    v_mfma_f32_16x16x32_bf16 v[134:137], a[140:143], v[238:241], v[134:137]
    v_mul_f32 v228, v182, v228
    v_mul_f32 v229, v182, v229
    v_mfma_f32_16x16x32_bf16 v[138:141], a[0:3], v[186:189], 0
    v_cvt_pk_bf16_f32 v255, v228, v229
    v_xor_b32 v3, 65536, v3
    v_mfma_f32_16x16x32_bf16 v[138:141], a[4:7], v[194:197], v[138:141]
    ds_write_b64 v4, v[254:255] offset:4096
    v_mfma_f32_16x16x32_bf16 v[138:141], a[8:11], v[122:125], v[138:141]
    v_xor_b32 v4, 65536, v4
    v_add_u32 v7, s76, v7
    v_mfma_f32_16x16x32_bf16 v[138:141], a[12:15], v[202:205], v[138:141]
    v_cvt_pk_f16_f32 v146, v142, v143
    v_pk_mul_f16 v143, v146, v146
    v_mfma_f32_16x16x32_bf16 v[138:141], a[16:19], v[230:233], v[138:141]
    v_cvt_pk_f16_f32 v147, v144, v145
    v_pk_fma_f16 v143, v147, v147, v143
    v_mfma_f32_16x16x32_bf16 v[138:141], a[20:23], v[238:241], v[138:141]
    v_cvt_pk_f16_f32 v148, v150, v151
    v_pk_fma_f16 v143, v148, v148, v143
    v_mfma_f32_16x16x32_bf16 v[166:169], a[24:27], v[186:189], 0
    v_cvt_pk_f16_f32 v149, v152, v153
    v_pk_fma_f16 v143, v149, v149, v143
    v_mfma_f32_16x16x32_bf16 v[166:169], a[28:31], v[194:197], v[166:169]
    v_cvt_pk_f16_f32 v120, v134, v135
    v_pk_fma_f16 v143, v120, v120, v143
    v_mfma_f32_16x16x32_bf16 v[166:169], a[32:35], v[122:125], v[166:169]
    s_waitcnt lgkmcnt(0)
    v_cvt_pk_f16_f32 v121, v136, v137
    v_pk_fma_f16 v143, v121, v121, v143
    v_mfma_f32_16x16x32_bf16 v[166:169], a[36:39], v[202:205], v[166:169]
    s_nop 0
    v_mfma_f32_16x16x32_bf16 v[166:169], a[40:43], v[230:233], v[166:169]
    s_barrier
    v_mfma_f32_16x16x32_bf16 v[166:169], a[44:47], v[238:241], v[166:169]
    s_nop 0
    v_mfma_f32_16x16x32_bf16 v[134:137], a[48:51], v[186:189], 0
    s_nop 0
    v_mfma_f32_16x16x32_bf16 v[134:137], a[52:55], v[194:197], v[134:137]
    s_cbranch_scc1 L_loop_fast1
    s_branch L_final_fast
.p2align 6
L_loop_fast2:
    v_mfma_f32_16x16x32_bf16 v[134:137], a[56:59], v[122:125], v[134:137]
    s_add_u32 s12, s40, s27
    ds_read_b128 v[190:193], v2 offset:18432
    v_cvt_pk_f16_f32 v150, v138, v139
    v_mfma_f32_16x16x32_bf16 v[134:137], a[60:63], v[202:205], v[134:137]
    s_addc_u32 s13, s41, 0
    ds_read_b128 v[210:213], v2 offset:19456
    v_pk_mul_f16 v142, v150, v150
    v_mfma_f32_16x16x32_bf16 v[134:137], a[64:67], v[230:233], v[134:137]
    s_sub_u32 s14, s36, s27
    ds_read_b128 v[174:177], v5 offset:32
    v_cvt_pk_f16_f32 v151, v140, v141
    v_mfma_f32_16x16x32_bf16 v[134:137], a[68:71], v[238:241], v[134:137]
    s_cmp_ge_u32 s18, 2
    ds_read2_b64 v[162:165], v5 offset0:6 offset1:9
    v_pk_fma_f16 v142, v151, v151, v142
    v_mfma_f32_16x16x32_bf16 v[138:141], v[186:189], a[144:147], 0
    s_cselect_b32 s14, s14, 0
    ds_read_b128 v[170:173], v5
    v_cvt_pk_f16_f32 v152, v166, v167
    v_mfma_f32_16x16x32_bf16 v[138:141], v[194:197], a[148:151], v[138:141]
    s_sub_u32 s82, s72, s71
    ds_read_b32 v254, v6 offset:192
    v_pk_fma_f16 v142, v152, v152, v142
    v_mfma_f32_16x16x32_bf16 v[138:141], v[122:125], a[152:155], v[138:141]
    s_mul_i32 s74, s82, 336
    v_cvt_pk_f16_f32 v153, v168, v169
    v_pk_fma_f16 v142, v153, v153, v142
    v_mfma_f32_16x16x32_bf16 v[138:141], v[202:205], a[156:159], v[138:141]
    s_mul_i32 s75, s82, 272
    v_cvt_pk_f16_f32 v118, v134, v135
    v_pk_fma_f16 v142, v118, v118, v142
    v_mfma_f32_16x16x32_bf16 v[138:141], v[230:233], a[160:163], v[138:141]
    s_waitcnt lgkmcnt(5)
    ds_read_b128 v[182:185], v0 offset:26624
    v_cvt_pk_f16_f32 v119, v136, v137
    v_mfma_f32_16x16x32_bf16 v[166:169], v[32:35], v[190:193], 0
    s_waitcnt lgkmcnt(5)
    v_pk_fma_f16 v142, v119, v119, v142
    v_add_u32 v5, s74, v5
    v_mfma_f32_16x16x32_bf16 v[166:169], v[32:35], v[210:213], v[166:169]
    s_waitcnt lgkmcnt(4)
    v_pk_mul_f16 v145, v146, v174
    v_pk_fma_f16 v145, v147, v175, v145
    v_mfma_f32_16x16x32_bf16 v[138:141], v[238:241], a[164:167], v[138:141]
    s_mul_i32 s76, s82, 16
    ds_read_b128 v[210:213], v1 offset:26624
    v_pk_fma_f16 v145, v148, v176, v145
    v_mfma_f32_16x16x32_bf16 v[214:217], v[186:189], a[168:171], 0
    s_waitcnt lgkmcnt(3)
    ds_read_b128 v[218:221], v0 offset:26752
    v_pk_fma_f16 v145, v149, v177, v145
    v_mfma_f32_16x16x32_bf16 v[214:217], v[194:197], a[172:175], v[214:217]
    s_waitcnt lgkmcnt(3)
    ds_read_b128 v[222:225], v1 offset:26752
    v_mov_b32_dpp v254, v23 quad_perm:[0,1,2,3] row_mask:0x7 bank_mask:0xf
    v_mfma_f32_16x16x32_bf16 v[214:217], v[122:125], a[176:179], v[214:217]
    s_add_u32 s34, s18, 2
    ds_read_b128 v[226:229], v0 offset:26880
    v_pk_fma_f16 v145, v120, v164, v145
    v_mfma_f32_16x16x32_bf16 v[214:217], v[202:205], a[180:183], v[214:217]
    s_add_u32 s8, s60, s23
    ds_read_b128 v[190:193], v1 offset:26880
    v_pk_fma_f16 v145, v121, v165, v145
    v_mfma_f32_16x16x32_bf16 v[214:217], v[230:233], a[184:187], v[214:217]
    s_waitcnt lgkmcnt(5)
    v_pk_mul_f16 v144, v150, v170
    v_pk_fma_f16 v144, v151, v171, v144
    v_mfma_f32_16x16x32_bf16 v[214:217], v[238:241], a[188:191], v[214:217]
    s_addc_u32 s9, s61, 0
    v_pk_fma_f16 v144, v152, v172, v144
    v_pk_fma_f16 v144, v153, v173, v144
    v_mfma_f32_16x16x32_bf16 v[246:249], v[186:189], a[192:195], 0
    s_sub_u32 s10, s36, s23
    v_pk_fma_f16 v144, v118, v162, v144
    v_pk_fma_f16 v144, v119, v163, v144
    v_mfma_f32_16x16x32_bf16 v[246:249], v[194:197], a[196:199], v[246:249]
    s_cmp_le_u32 s34, s45
    v_cvt_pk_bf16_f32 v134, v138, v139
    v_cvt_pk_bf16_f32 v135, v140, v141
    v_mfma_f32_16x16x32_f16 v[234:237], v[40:43], v[142:145], 0
    s_cselect_b32 s10, s10, 0
    v_cvt_pk_bf16_f32 v138, v214, v215
    v_cvt_pk_bf16_f32 v139, v216, v217
    v_mfma_f32_16x16x32_bf16 v[246:249], v[122:125], a[200:203], v[246:249]
    s_add_u32 m0, s28, 0
    v_mul_f32 v136, 0x3baaaaab, v166
    v_mul_f32 v255, 0x3baaaaab, v167
    v_mfma_f32_16x16x32_bf16 v[246:249], v[202:205], a[204:207], v[246:249]
    s_mov_b32 s27, s26
    v_rsq_f32 v234, v234
    v_mfma_f32_16x16x32_bf16 v[246:249], v[230:233], a[208:211], v[246:249]
    s_mov_b32 s26, s25
    v_rsq_f32 v235, v235
    v_mfma_f32_16x16x32_bf16 v[246:249], v[238:241], a[212:215], v[246:249]
    s_mov_b32 s25, s24
    v_mul_f32 v140, s31, v234
    v_cvt_pk_f16_f32 v141, v140, v235
    v_mfma_f32_16x16x32_bf16 v[122:125], a[72:75], v[182:185], 0
    s_waitcnt lgkmcnt(0)
    v_fma_f32 v236, v236, v140, v22
    v_fmac_f32_dpp v254, v237, v235 quad_perm:[0,1,2,3] row_mask:0x1 bank_mask:0xf
    v_mfma_f32_16x16x32_bf16 v[122:125], a[76:79], v[210:213], v[122:125]
    s_mov_b32 s24, s23
    v_cvt_pk_bf16_f32 v142, v246, v247
    v_cvt_pk_bf16_f32 v143, v248, v249
    v_mfma_f32_16x16x32_bf16 v[122:125], a[80:83], v[218:221], v[122:125]
    s_mov_b32 s71, s72
    v_pk_mul_f16 v146, v146, v141 op_sel:[0,1] op_sel_hi:[1,1]
    v_pk_mul_f16 v147, v147, v141 op_sel:[0,1] op_sel_hi:[1,1]
    v_mfma_f32_16x16x32_bf16 v[122:125], a[84:87], v[222:225], v[122:125]
    s_mov_b32 s72, s73
    v_pk_mul_f16 v148, v148, v141 op_sel:[0,1] op_sel_hi:[1,1]
    v_pk_mul_f16 v149, v149, v141 op_sel:[0,1] op_sel_hi:[1,1]
    v_mfma_f32_16x16x32_bf16 v[122:125], a[88:91], v[226:229], v[122:125]
    v_pk_mul_f16 v120, v120, v141 op_sel:[0,1] op_sel_hi:[1,1]
    v_pk_mul_f16 v121, v121, v141 op_sel:[0,1] op_sel_hi:[1,1]
    v_mfma_f32_16x16x32_bf16 v[122:125], a[92:95], v[190:193], v[122:125]
    v_pk_mul_f16 v150, v150, v141 op_sel:[0,0] op_sel_hi:[1,0]
    v_pk_mul_f16 v151, v151, v141 op_sel:[0,0] op_sel_hi:[1,0]
    v_mfma_f32_16x16x32_bf16 v[186:189], a[96:99], v[182:185], 0
    v_pk_mul_f16 v152, v152, v141 op_sel:[0,0] op_sel_hi:[1,0]
    v_pk_mul_f16 v153, v153, v141 op_sel:[0,0] op_sel_hi:[1,0]
    v_mfma_f32_16x16x32_bf16 v[186:189], a[100:103], v[210:213], v[186:189]
    v_pk_mul_f16 v118, v118, v141 op_sel:[0,0] op_sel_hi:[1,0]
    v_pk_mul_f16 v119, v119, v141 op_sel:[0,0] op_sel_hi:[1,0]
    v_mfma_f32_16x16x32_bf16 v[186:189], a[104:107], v[218:221], v[186:189]
    v_max3_u32 v44, v44, v234, v235
    v_mul_f32 v144, 0x3baaaaab, v168
    v_mfma_f32_16x16x32_bf16 v[186:189], a[108:111], v[222:225], v[186:189]
    v_rsq_f32 v136, v136
    v_mfma_f32_16x16x32_bf16 v[186:189], a[112:115], v[226:229], v[186:189]
    v_rsq_f32 v255, v255
    v_mfma_f32_16x16x32_bf16 v[186:189], a[116:119], v[190:193], v[186:189]
    v_rsq_f32 v144, v144
    v_mfma_f32_16x16x32_bf16 v[194:197], a[120:123], v[182:185], 0
    v_mul_f32 v178, v136, v178
    v_mul_f32 v179, v136, v179
    v_mfma_f32_16x16x32_bf16 v[194:197], a[124:127], v[210:213], v[194:197]
    v_cvt_pk_bf16_f32 v166, v178, v179
    v_mul_f32 v180, v136, v180
    v_mfma_f32_16x16x32_bf16 v[194:197], a[128:131], v[218:221], v[194:197]
    v_mul_f32 v181, v136, v181
    v_cvt_pk_bf16_f32 v167, v180, v181
    v_mfma_f32_16x16x32_bf16 v[194:197], a[132:135], v[222:225], v[194:197]
    v_mul_f32 v198, v136, v198
    v_mul_f32 v199, v136, v199
    v_mfma_f32_16x16x32_bf16 v[194:197], a[136:139], v[226:229], v[194:197]
    v_cvt_pk_bf16_f32 v168, v198, v199
    v_mul_f32 v200, v136, v200
    v_mfma_f32_16x16x32_bf16 v[194:197], a[140:143], v[190:193], v[194:197]
    v_mul_f32 v201, v136, v201
    v_cvt_pk_bf16_f32 v169, v200, v201
    v_mfma_f32_16x16x32_bf16 v[178:181], a[0:3], v[182:185], 0
    buffer_store_dwordx4 v[166:169], v15, s[12:15], 0 offen nt
    v_mul_f32 v206, v136, v206
    v_mul_f32 v207, v136, v207
    v_cvt_pk_bf16_f32 v140, v206, v207
    v_mul_f32 v208, v136, v208
    v_mfma_f32_16x16x32_bf16 v[178:181], a[4:7], v[210:213], v[178:181]
    v_mul_f32 v209, v136, v209
    v_cvt_pk_bf16_f32 v141, v208, v209
    v_mfma_f32_16x16x32_bf16 v[178:181], a[8:11], v[218:221], v[178:181]
    v_cvt_pk_f16_f32 v166, v122, v123
    v_pk_mul_f16 v199, v166, v166
    v_mfma_f32_16x16x32_bf16 v[178:181], a[12:15], v[222:225], v[178:181]
    v_cvt_pk_f16_f32 v167, v124, v125
    v_pk_fma_f16 v199, v167, v167, v199
    v_mfma_f32_16x16x32_bf16 v[178:181], a[16:19], v[226:229], v[178:181]
    v_cvt_pk_f16_f32 v168, v186, v187
    v_pk_fma_f16 v199, v168, v168, v199
    v_mfma_f32_16x16x32_bf16 v[178:181], a[20:23], v[190:193], v[178:181]
    v_cvt_pk_f16_f32 v169, v188, v189
    v_pk_fma_f16 v199, v169, v169, v199
    v_mfma_f32_16x16x32_bf16 v[186:189], a[24:27], v[182:185], 0
    v_cvt_pk_f16_f32 v124, v194, v195
    v_pk_fma_f16 v199, v124, v124, v199
    v_mfma_f32_16x16x32_bf16 v[186:189], a[28:31], v[210:213], v[186:189]
    v_cvt_pk_f16_f32 v125, v196, v197
    v_pk_fma_f16 v199, v125, v125, v199
    v_mfma_f32_16x16x32_bf16 v[186:189], a[32:35], v[218:221], v[186:189]
    v_cvt_pk_f16_f32 v178, v178, v179
    v_pk_mul_f16 v198, v178, v178
    v_mfma_f32_16x16x32_bf16 v[186:189], a[36:39], v[222:225], v[186:189]
    v_cvt_pk_f16_f32 v179, v180, v181
    v_pk_fma_f16 v198, v179, v179, v198
    v_mfma_f32_16x16x32_bf16 v[186:189], a[40:43], v[226:229], v[186:189]
    v_pk_mul_f16 v200, v178, v170
    v_pk_fma_f16 v200, v179, v171, v200
    v_mfma_f32_16x16x32_bf16 v[186:189], a[44:47], v[190:193], v[186:189]
    v_pk_mul_f16 v201, v166, v174
    v_pk_fma_f16 v201, v167, v175, v201
    v_mfma_f32_16x16x32_bf16 v[194:197], a[48:51], v[182:185], 0
    v_pk_fma_f16 v201, v168, v176, v201
    v_pk_fma_f16 v201, v169, v177, v201
    v_mfma_f32_16x16x32_bf16 v[194:197], a[52:55], v[210:213], v[194:197]
    v_pk_fma_f16 v201, v124, v164, v201
    v_pk_fma_f16 v201, v125, v165, v201
    v_mfma_f32_16x16x32_bf16 v[194:197], a[56:59], v[218:221], v[194:197]
    v_cvt_pk_f16_f32 v180, v186, v187
    v_pk_fma_f16 v198, v180, v180, v198
    v_mfma_f32_16x16x32_bf16 v[194:197], a[60:63], v[222:225], v[194:197]
    v_cvt_pk_f16_f32 v181, v188, v189
    v_pk_fma_f16 v198, v181, v181, v198
    v_mfma_f32_16x16x32_bf16 v[194:197], a[64:67], v[226:229], v[194:197]
    v_pk_fma_f16 v200, v180, v172, v200
    v_pk_fma_f16 v200, v181, v173, v200
    v_mfma_f32_16x16x32_bf16 v[194:197], a[68:71], v[190:193], v[194:197]
    buffer_store_dwordx2 v[140:141], v18, s[12:15], 0 offen nt
    v_mul_f32 v242, v144, v242
    v_mul_f32 v243, v144, v243
    v_mfma_f32_16x16x32_bf16 v[186:189], v[182:185], a[144:147], 0
    v_cvt_pk_bf16_f32 v238, v242, v243
    v_mul_f32 v244, v144, v244
    v_mfma_f32_16x16x32_bf16 v[186:189], v[210:213], a[148:151], v[186:189]
    v_mul_f32 v245, v144, v245
    v_cvt_pk_f16_f32 v122, v194, v195
    v_mfma_f32_16x16x32_bf16 v[186:189], v[218:221], a[152:155], v[186:189]
    v_pk_fma_f16 v198, v122, v122, v198
    v_cvt_pk_f16_f32 v123, v196, v197
    v_mfma_f32_16x16x32_bf16 v[186:189], v[222:225], a[156:159], v[186:189]
    v_pk_fma_f16 v198, v123, v123, v198
    v_pk_fma_f16 v200, v122, v162, v200
    v_mfma_f32_16x16x32_bf16 v[186:189], v[226:229], a[160:163], v[186:189]
    ds_read_b128 v[202:205], v0 offset:32768
    v_pk_fma_f16 v200, v123, v163, v200
    v_mfma_f32_16x16x32_bf16 v[186:189], v[190:193], a[164:167], v[186:189]
    ds_read_b128 v[194:197], v1 offset:32768
    v_cvt_pk_bf16_f32 v239, v244, v245
    v_mfma_f32_16x16x32_f16 v[230:233], v[40:43], v[198:201], 0
    v_mul_f32 v158, v144, v158
    v_mul_f32 v159, v144, v159
    v_mfma_f32_16x16x32_bf16 v[246:249], v[182:185], a[168:171], 0
    ds_read_b128 v[214:217], v0 offset:32896
    v_cvt_pk_bf16_f32 v240, v158, v159
    v_mfma_f32_16x16x32_bf16 v[246:249], v[210:213], a[172:175], v[246:249]
    ds_read_b128 v[206:209], v1 offset:32896
    v_cvt_pk_bf16_f32 v136, v186, v187
    v_mfma_f32_16x16x32_bf16 v[246:249], v[218:221], a[176:179], v[246:249]
    ds_read_b128 v[198:201], v0 offset:33024
    v_cvt_pk_bf16_f32 v137, v188, v189
    v_mfma_f32_16x16x32_bf16 v[246:249], v[222:225], a[180:183], v[246:249]
    ds_read_b128 v[186:189], v1 offset:33024
    v_mul_f32 v160, v144, v160
    v_mfma_f32_16x16x32_bf16 v[246:249], v[226:229], a[184:187], v[246:249]
    v_rsq_f32 v230, v230
    v_mfma_f32_16x16x32_bf16 v[246:249], v[190:193], a[188:191], v[246:249]
    s_waitcnt lgkmcnt(5)
    v_rsq_f32 v231, v231
    v_mfma_f32_16x16x32_bf16 v[242:245], v[182:185], a[192:195], 0
    s_waitcnt lgkmcnt(4)
    v_mul_f32 v234, s31, v230
    v_cvt_pk_f16_f32 v235, v234, v231
    v_mfma_f32_16x16x32_bf16 v[242:245], v[210:213], a[196:199], v[242:245]
    v_fma_f32 v232, v232, v234, v24
    v_fmac_f32_dpp v254, v233, v231 quad_perm:[0,1,2,3] row_mask:0x2 bank_mask:0xf
    v_mfma_f32_16x16x32_bf16 v[242:245], v[218:221], a[200:203], v[242:245]
    s_waitcnt lgkmcnt(3)
    v_cvt_pk_bf16_f32 v140, v246, v247
    v_cvt_pk_bf16_f32 v141, v248, v249
    v_mfma_f32_16x16x32_bf16 v[242:245], v[222:225], a[204:207], v[242:245]
    s_waitcnt lgkmcnt(2)
    v_mul_f32 v161, v144, v161
    v_cvt_pk_bf16_f32 v241, v160, v161
    v_mfma_f32_16x16x32_bf16 v[242:245], v[226:229], a[208:211], v[242:245]
    s_waitcnt lgkmcnt(1)
    buffer_store_dwordx4 v[238:241], v17, s[12:15], 0 offen nt
    v_mul_f32 v154, v144, v154
    v_mul_f32 v155, v144, v155
    v_cvt_pk_bf16_f32 v154, v154, v155
    v_mul_f32 v156, v144, v156
    v_mfma_f32_16x16x32_bf16 v[242:245], v[190:193], a[212:215], v[242:245]
    s_waitcnt lgkmcnt(0)
    v_mul_f32 v157, v144, v157
    v_cvt_pk_bf16_f32 v155, v156, v157
    v_mfma_f32_16x16x32_bf16 v[158:161], a[72:75], v[202:205], 0
    v_pk_mul_f16 v166, v166, v235 op_sel:[0,1] op_sel_hi:[1,1]
    v_pk_mul_f16 v167, v167, v235 op_sel:[0,1] op_sel_hi:[1,1]
    v_mfma_f32_16x16x32_bf16 v[158:161], a[76:79], v[194:197], v[158:161]
    v_pk_mul_f16 v168, v168, v235 op_sel:[0,1] op_sel_hi:[1,1]
    v_cvt_pk_bf16_f32 v144, v242, v243
    v_mfma_f32_16x16x32_bf16 v[158:161], a[80:83], v[214:217], v[158:161]
    v_cvt_pk_bf16_f32 v145, v244, v245
    v_pk_mul_f16 v169, v169, v235 op_sel:[0,1] op_sel_hi:[1,1]
    v_mfma_f32_16x16x32_bf16 v[158:161], a[84:87], v[206:209], v[158:161]
    v_pk_mul_f16 v124, v124, v235 op_sel:[0,1] op_sel_hi:[1,1]
    v_pk_mul_f16 v125, v125, v235 op_sel:[0,1] op_sel_hi:[1,1]
    v_mfma_f32_16x16x32_bf16 v[158:161], a[88:91], v[198:201], v[158:161]
    v_pk_mul_f16 v178, v178, v235 op_sel:[0,0] op_sel_hi:[1,0]
    v_pk_mul_f16 v179, v179, v235 op_sel:[0,0] op_sel_hi:[1,0]
    v_mfma_f32_16x16x32_bf16 v[158:161], a[92:95], v[186:189], v[158:161]
    v_pk_mul_f16 v180, v180, v235 op_sel:[0,0] op_sel_hi:[1,0]
    v_pk_mul_f16 v181, v181, v235 op_sel:[0,0] op_sel_hi:[1,0]
    v_mfma_f32_16x16x32_bf16 v[182:185], a[96:99], v[202:205], 0
    v_pk_mul_f16 v122, v122, v235 op_sel:[0,0] op_sel_hi:[1,0]
    v_pk_mul_f16 v123, v123, v235 op_sel:[0,0] op_sel_hi:[1,0]
    v_mfma_f32_16x16x32_bf16 v[182:185], a[100:103], v[194:197], v[182:185]
    v_max3_u32 v44, v44, v230, v231
    v_mul_f32 v130, v255, v130
    v_mfma_f32_16x16x32_bf16 v[182:185], a[104:107], v[214:217], v[182:185]
    v_cvt_pk_f16_f32 v158, v158, v159
    v_pk_mul_f16 v191, v158, v158
    v_mfma_f32_16x16x32_bf16 v[182:185], a[108:111], v[206:209], v[182:185]
    v_cvt_pk_f16_f32 v159, v160, v161
    v_pk_fma_f16 v191, v159, v159, v191
    v_mfma_f32_16x16x32_bf16 v[182:185], a[112:115], v[198:201], v[182:185]
    v_pk_mul_f16 v193, v158, v174
    v_pk_fma_f16 v193, v159, v175, v193
    v_mfma_f32_16x16x32_bf16 v[182:185], a[116:119], v[186:189], v[182:185]
    v_exp_f32 v232, v232
    v_mfma_f32_16x16x32_bf16 v[210:213], a[120:123], v[202:205], 0
    v_exp_f32 v236, v236
    v_mfma_f32_16x16x32_bf16 v[210:213], a[124:127], v[194:197], v[210:213]
    v_cvt_pk_bf16_f32 v39, v236, 0
    v_mul_f32 v131, v255, v131
    v_mfma_f32_16x16x32_bf16 v[210:213], a[128:131], v[214:217], v[210:213]
    s_waitcnt vmcnt(3)
    ds_write_b16 v8, v45 offset:512
    v_mfma_f32_16x16x32_bf16 v[210:213], a[132:135], v[206:209], v[210:213]
    buffer_store_dwordx2 v[154:155], v20, s[12:15], 0 offen nt
    v_cvt_pk_f16_f32 v160, v182, v183
    v_mfma_f32_16x16x32_bf16 v[210:213], a[136:139], v[198:201], v[210:213]
    v_pk_fma_f16 v191, v160, v160, v191
    v_cvt_pk_f16_f32 v161, v184, v185
    v_mfma_f32_16x16x32_bf16 v[210:213], a[140:143], v[186:189], v[210:213]
    v_pk_fma_f16 v191, v161, v161, v191
    v_pk_fma_f16 v193, v160, v176, v193
    v_mfma_f32_16x16x32_bf16 v[154:157], a[0:3], v[202:205], 0
    v_pk_fma_f16 v193, v161, v177, v193
    v_cvt_pk_bf16_f32 v130, v130, v131
    v_mfma_f32_16x16x32_bf16 v[154:157], a[4:7], v[194:197], v[154:157]
    v_mul_f32 v132, v255, v132
    v_mul_f32 v133, v255, v133
    v_mfma_f32_16x16x32_bf16 v[154:157], a[8:11], v[214:217], v[154:157]
    v_cvt_pk_f16_f32 v176, v210, v211
    v_pk_fma_f16 v191, v176, v176, v191
    v_mfma_f32_16x16x32_bf16 v[154:157], a[12:15], v[206:209], v[154:157]
    s_waitcnt lgkmcnt(0)
    v_cvt_pk_f16_f32 v177, v212, v213
    v_pk_fma_f16 v191, v177, v177, v191
    v_mfma_f32_16x16x32_bf16 v[154:157], a[16:19], v[198:201], v[154:157]
    v_pk_fma_f16 v193, v176, v164, v193
    v_mfma_f32_16x16x32_bf16 v[154:157], a[20:23], v[186:189], v[154:157]
    v_pk_fma_f16 v193, v177, v165, v193
    v_mfma_f32_16x16x32_bf16 v[182:185], a[24:27], v[202:205], 0
    s_barrier
    v_cvt_pk_bf16_f32 v131, v132, v133
    v_mfma_f32_16x16x32_bf16 v[182:185], a[28:31], v[194:197], v[182:185]
    ds_read2_b32 v[164:165], v6 offset0:0 offset1:0
    v_mfma_f32_16x16x32_bf16 v[182:185], a[32:35], v[214:217], v[182:185]
    ds_read2_b32 v[212:213], v6 offset0:16 offset1:16
    v_cvt_pk_f16_f32 v154, v154, v155
    v_mfma_f32_16x16x32_bf16 v[182:185], a[36:39], v[206:209], v[182:185]
    ds_read2_b32 v[220:221], v6 offset0:32 offset1:32
    v_pk_mul_f16 v190, v154, v154
    v_mfma_f32_16x16x32_bf16 v[182:185], a[40:43], v[198:201], v[182:185]
    ds_read_u16 v133, v9 offset:256
    v_cvt_pk_f16_f32 v155, v156, v157
    v_mfma_f32_16x16x32_bf16 v[182:185], a[44:47], v[186:189], v[182:185]
    v_pk_fma_f16 v190, v155, v155, v190
    v_pk_mul_f16 v192, v154, v170
    v_mfma_f32_16x16x32_bf16 v[222:225], a[48:51], v[202:205], 0
    v_pk_fma_f16 v192, v155, v171, v192
    v_mul_f32 v126, v255, v126
    v_mfma_f32_16x16x32_bf16 v[222:225], a[52:55], v[194:197], v[222:225]
    v_mul_f32 v127, v255, v127
    v_cvt_pk_bf16_f32 v132, v126, v127
    v_mfma_f32_16x16x32_bf16 v[222:225], a[56:59], v[214:217], v[222:225]
    buffer_load_dwordx4 v10, s[8:11], 0 offen nt lds
    v_cvt_pk_f16_f32 v156, v182, v183
    v_mfma_f32_16x16x32_bf16 v[222:225], a[60:63], v[206:209], v[222:225]
    s_add_u32 m0, s28, 4096
    v_pk_fma_f16 v190, v156, v156, v190
    v_cvt_pk_f16_f32 v157, v184, v185
    v_mfma_f32_16x16x32_bf16 v[222:225], a[64:67], v[198:201], v[222:225]
    s_waitcnt lgkmcnt(2)
    v_pk_fma_f16 v190, v157, v157, v190
    v_pk_fma_f16 v192, v156, v172, v192
    v_mfma_f32_16x16x32_bf16 v[222:225], a[68:71], v[186:189], v[222:225]
    s_waitcnt lgkmcnt(1)
    ds_read_b128 v[182:185], v2 offset:0
    v_pk_fma_f16 v192, v157, v173, v192
    v_mfma_f32_16x16x32_bf16 v[170:173], v[202:205], a[144:147], 0
    s_waitcnt lgkmcnt(1)
    ds_read_b128 v[226:229], v2 offset:1024
    v_readfirstlane_b32 s77, v133
    v_mfma_f32_16x16x32_bf16 v[170:173], v[194:197], a[148:151], v[170:173]
    ds_read_b128 v[234:237], v2 offset:2048
    buffer_load_dwordx4 v11, s[8:11], 0 offen nt lds
    v_mfma_f32_16x16x32_bf16 v[170:173], v[214:217], a[152:155], v[170:173]
    s_add_u32 m0, s28, 8192
    ds_read_b128 v[238:241], v2 offset:3072
    v_cvt_pk_f16_f32 v174, v222, v223
    v_mfma_f32_16x16x32_bf16 v[170:173], v[206:209], a[156:159], v[170:173]
    s_mul_i32 s78, s77, 2688
    ds_read_b128 v[242:245], v2 offset:4096
    v_pk_fma_f16 v190, v174, v174, v190
    v_mfma_f32_16x16x32_bf16 v[170:173], v[198:201], a[160:163], v[170:173]
    ds_read_b128 v[246:249], v2 offset:5120
    v_cvt_pk_f16_f32 v175, v224, v225
    v_mfma_f32_16x16x32_bf16 v[170:173], v[186:189], a[164:167], v[170:173]
    v_pk_fma_f16 v190, v175, v175, v190
    v_pk_fma_f16 v192, v174, v162, v192
    v_mfma_f32_16x16x32_bf16 v[222:225], v[202:205], a[168:171], 0
    buffer_load_dwordx4 v12, s[8:11], 0 offen nt lds
    v_pk_fma_f16 v192, v175, v163, v192
    v_mfma_f32_16x16x32_bf16 v[222:225], v[194:197], a[172:175], v[222:225]
    s_waitcnt lgkmcnt(5)
    v_mul_f32 v128, v255, v128
    v_cvt_pk_bf16_f32 v162, v170, v171
    v_mfma_f32_16x16x32_f16 v[250:253], v[40:43], v[190:193], 0
    s_add_u32 m0, s28, 12288
    v_cvt_pk_bf16_f32 v163, v172, v173
    v_mul_f32 v129, v255, v129
    v_mfma_f32_16x16x32_bf16 v[222:225], v[214:217], a[176:179], v[222:225]
    s_xor_b32 s28, s28, 65536
    v_cvt_pk_bf16_f32 v133, v128, v129
    v_mul_f32 v114, v255, v114
    v_mfma_f32_16x16x32_bf16 v[222:225], v[206:209], a[180:183], v[222:225]
    s_waitcnt lgkmcnt(2)
    v_rsq_f32 v250, v250
    v_mfma_f32_16x16x32_bf16 v[222:225], v[198:201], a[184:187], v[222:225]
    s_waitcnt lgkmcnt(1)
    buffer_load_dwordx4 v13, s[8:11], 0 offen nt lds
    v_mul_f32 v230, s31, v250
    v_mfma_f32_16x16x32_bf16 v[222:225], v[186:189], a[188:191], v[222:225]
    s_mov_b32 m0, s29
    v_rsq_f32 v251, v251
    v_mfma_f32_16x16x32_bf16 v[126:129], v[202:205], a[192:195], 0
    s_xor_b32 s29, s29, s30
    v_cvt_pk_f16_f32 v231, v230, v251
    v_fma_f32 v252, v252, v230, v26
    v_mfma_f32_16x16x32_bf16 v[126:129], v[194:197], a[196:199], v[126:129]
    s_add_u32 s19, s19, s20
    v_fmac_f32_dpp v254, v253, v251 quad_perm:[0,1,2,3] row_mask:0x4 bank_mask:0xf
    v_cvt_pk_bf16_f32 v210, v222, v223
    v_mfma_f32_16x16x32_bf16 v[126:129], v[214:217], a[200:203], v[126:129]
    s_add_u32 s23, s23, s21
    v_cvt_pk_bf16_f32 v211, v224, v225
    v_pk_mul_f16 v158, v158, v231 op_sel:[0,1] op_sel_hi:[1,1]
    v_mfma_f32_16x16x32_bf16 v[126:129], v[206:209], a[204:207], v[126:129]
    s_waitcnt lgkmcnt(0)
    v_pk_mul_f16 v159, v159, v231 op_sel:[0,1] op_sel_hi:[1,1]
    v_mfma_f32_16x16x32_bf16 v[126:129], v[198:201], a[208:211], v[126:129]
    s_cmp_ge_u32 s19, 72
    v_pk_mul_f16 v160, v160, v231 op_sel:[0,1] op_sel_hi:[1,1]
    v_pk_mul_f16 v161, v161, v231 op_sel:[0,1] op_sel_hi:[1,1]
    v_mfma_f32_16x16x32_bf16 v[126:129], v[186:189], a[212:215], v[126:129]
    s_cselect_b32 s34, 72, 0
    v_pk_mul_f16 v176, v176, v231 op_sel:[0,1] op_sel_hi:[1,1]
    v_pk_mul_f16 v177, v177, v231 op_sel:[0,1] op_sel_hi:[1,1]
    v_mfma_f32_16x16x32_f16 v[170:173], v[146:149], v[150:153], v[46:49]
    s_cselect_b32 s35, s22, 0
    v_pk_mul_f16 v154, v154, v231 op_sel:[0,0] op_sel_hi:[1,0]
    v_pk_mul_f16 v155, v155, v231 op_sel:[0,0] op_sel_hi:[1,0]
    v_mfma_f32_16x16x32_f16 v[186:189], v[166:169], v[150:153], v[50:53]
    s_sub_u32 s19, s19, s34
    v_cvt_pk_bf16_f32 v218, v126, v127
    v_cvt_pk_bf16_f32 v219, v128, v129
    v_mfma_f32_16x16x32_f16 v[126:129], v[158:161], v[150:153], v[54:57]
    buffer_store_dwordx4 v[130:133], v16, s[12:15], 0 offen nt
    v_pk_mul_f16 v156, v156, v231 op_sel:[0,0] op_sel_hi:[1,0]
    v_pk_mul_f16 v157, v157, v231 op_sel:[0,0] op_sel_hi:[1,0]
    v_pk_mul_f16 v174, v174, v231 op_sel:[0,0] op_sel_hi:[1,0]
    v_pk_mul_f16 v175, v175, v231 op_sel:[0,0] op_sel_hi:[1,0]
    v_mfma_f32_16x16x16_f16 v[170:173], v[120:121], v[118:119], v[170:173]
    v_max3_u32 v44, v44, v250, v251
    v_exp_f32 v254, v254
    v_mfma_f32_16x16x16_f16 v[186:189], v[124:125], v[118:119], v[186:189]
    v_cvt_pk_bf16_f32 v254, v254, v254
    v_exp_f32 v252, v252
    v_mfma_f32_16x16x16_f16 v[126:129], v[176:177], v[118:119], v[126:129]
    v_mul_f32 v115, v255, v115
    v_cvt_pk_bf16_f32 v118, v114, v115
    v_exp_f32 v170, v170
    v_mfma_f32_16x16x32_f16 v[130:133], v[146:149], v[178:181], v[58:61]
    s_add_u32 s23, s23, s35
    ds_write_b16 v8, v254
    v_mfma_f32_16x16x32_f16 v[150:153], v[166:169], v[178:181], v[62:65]
    s_add_u32 s78, s78, s69
    v_exp_f32 v171, v171
    v_mfma_f32_16x16x32_f16 v[190:193], v[158:161], v[178:181], v[66:69]
    s_add_u32 s80, s77, s68
    v_cvt_pk_bf16_f32 v170, v170, v171
    v_exp_f32 v172, v172
    v_mfma_f32_16x16x16_f16 v[130:133], v[120:121], v[122:123], v[130:133]
    v_exp_f32 v173, v173
    v_mul_f32 v116, v255, v116
    v_mfma_f32_16x16x16_f16 v[150:153], v[124:125], v[122:123], v[150:153]
    v_cvt_pk_bf16_f32 v171, v172, v173
    v_exp_f32 v186, v186
    v_mfma_f32_16x16x16_f16 v[190:193], v[176:177], v[122:123], v[190:193]
    v_exp_f32 v187, v187
    v_exp_f32 v188, v188
    v_mfma_f32_16x16x32_bf16 v[178:181], a[216:219], v[182:185], 0
    s_cmp_ge_u32 s80, 72
    v_exp_f32 v130, v130
    v_mfma_f32_16x16x32_bf16 v[178:181], a[220:223], v[226:229], v[178:181]
    s_cselect_b32 s80, s22, 0
    v_exp_f32 v131, v131
    v_mfma_f32_16x16x32_bf16 v[178:181], a[224:227], v[234:237], v[178:181]
    s_add_u32 s78, s78, s80
    v_cvt_pk_bf16_f32 v194, v130, v131
    v_cvt_pk_bf16_f32 v172, v186, v187
    v_mfma_f32_16x16x32_bf16 v[178:181], a[228:231], v[238:241], v[178:181]
    s_add_u32 s80, s77, 20
    v_exp_f32 v132, v132
    v_mfma_f32_16x16x32_bf16 v[178:181], a[232:235], v[242:245], v[178:181]
    s_add_u32 s34, s18, 3
    v_exp_f32 v133, v133
    v_mfma_f32_16x16x32_bf16 v[178:181], a[236:239], v[246:249], v[178:181]
    s_cmp_lt_u32 s77, s62
    v_cvt_pk_bf16_f32 v195, v132, v133
    v_mul_f32 v117, v255, v117
    v_mfma_f32_16x16x32_bf16 v[198:201], a[240:243], v[182:185], 0
    s_cselect_b32 s79, 1, 0
    v_exp_f32 v150, v150
    v_mfma_f32_16x16x32_f16 v[202:205], v[146:149], v[154:157], v[70:73]
    s_cselect_b32 s78, s78, 0
    v_exp_f32 v151, v151
    v_mfma_f32_16x16x32_f16 v[146:149], v[166:169], v[154:157], v[74:77]
    s_cmp_lt_u32 s34, s17
    v_cvt_pk_bf16_f32 v196, v150, v151
    v_cvt_pk_bf16_f32 v119, v116, v117
    v_mfma_f32_16x16x32_f16 v[166:169], v[158:161], v[154:157], v[78:81]
    buffer_store_dwordx2 v[118:119], v19, s[12:15], 0 offen nt
    v_exp_f32 v152, v152
    v_mfma_f32_16x16x16_f16 v[202:205], v[120:121], v[174:175], v[202:205]
    v_exp_f32 v153, v153
    v_fma_f32 v254, v178, v178, s33
    v_mfma_f32_16x16x16_f16 v[146:149], v[124:125], v[174:175], v[146:149]
    v_cvt_pk_bf16_f32 v197, v152, v153
    v_exp_f32 v190, v190
    v_mfma_f32_16x16x16_f16 v[166:169], v[176:177], v[174:175], v[166:169]
    v_exp_f32 v191, v191
    v_exp_f32 v192, v192
    v_mfma_f32_16x16x32_bf16 v[198:201], a[244:247], v[226:229], v[198:201]
    s_cselect_b32 s23, s23, s78
    v_exp_f32 v193, v193
    v_mfma_f32_16x16x32_bf16 v[198:201], a[248:251], v[234:237], v[198:201]
    s_cselect_b32 s73, s34, s80
    ds_read_b128 v[118:121], v2 offset:6144
    v_fmac_f32 v254, v179, v179
    v_mfma_f32_16x16x32_bf16 v[198:201], a[252:255], v[238:241], v[198:201]
    s_cselect_b32 s79, 0, s79
    ds_read_b128 v[122:125], v2 offset:7168
    v_fmac_f32 v254, v180, v180
    v_mfma_f32_16x16x32_bf16 v[198:201], v[82:85], v[242:245], v[198:201]
    s_cselect_b32 s81, 0, 1
    ds_read_b128 v[150:153], v2 offset:8192
    v_fmac_f32 v254, v181, v181
    v_mfma_f32_16x16x32_bf16 v[198:201], v[86:89], v[246:249], v[198:201]
    s_add_u32 s80, s77, 1
    ds_read_b128 v[154:157], v2 offset:9216
    v_xor_b32 v0, 65536, v0
    v_mfma_f32_16x16x32_bf16 v[206:209], v[90:93], v[182:185], 0
    s_mul_i32 s80, s80, s81
    ds_read_b128 v[158:161], v2 offset:10240
    v_xor_b32 v1, 65536, v1
    v_mfma_f32_16x16x32_bf16 v[206:209], v[94:97], v[226:229], v[206:209]
    s_cmp_lt_u32 s80, s62
    ds_read_b128 v[174:177], v2 offset:11264
    v_fmac_f32 v254, v198, v198
    v_mfma_f32_16x16x32_bf16 v[206:209], v[98:101], v[234:237], v[206:209]
    s_cselect_b32 s62, s62, 0
    v_exp_f32 v189, v189
    v_mfma_f32_16x16x32_bf16 v[206:209], v[102:105], v[238:241], v[206:209]
    s_add_u32 s80, s18, 4
    v_cvt_pk_bf16_f32 v173, v188, v189
    v_fmac_f32 v254, v199, v199
    v_mfma_f32_16x16x32_bf16 v[206:209], v[106:109], v[242:245], v[206:209]
    s_waitcnt lgkmcnt(5)
    v_exp_f32 v126, v126
    v_mfma_f32_16x16x32_bf16 v[206:209], v[110:113], v[246:249], v[206:209]
    s_cmp_ge_u32 s80, s17
    v_exp_f32 v127, v127
    v_mfma_f32_16x16x32_bf16 v[130:133], a[216:219], v[118:121], 0
    s_waitcnt lgkmcnt(3)
    v_cvt_pk_bf16_f32 v36, v126, v127
    v_fmac_f32 v254, v200, v200
    v_mfma_f32_16x16x32_bf16 v[130:133], a[220:223], v[122:125], v[130:133]
    s_cselect_b32 s66, s62, 0
    v_exp_f32 v128, v128
    v_mfma_f32_16x16x32_bf16 v[130:133], a[224:227], v[150:153], v[130:133]
    s_waitcnt lgkmcnt(1)
    v_fmac_f32 v254, v201, v201
    v_mfma_f32_16x16x32_bf16 v[130:133], a[228:231], v[154:157], v[130:133]
    s_lshl_b32 s80, s79, s73
    v_exp_f32 v129, v129
    v_mfma_f32_16x16x32_bf16 v[130:133], a[232:235], v[158:161], v[130:133]
    s_waitcnt lgkmcnt(0)
    v_cvt_pk_bf16_f32 v37, v128, v129
    v_fmac_f32 v254, v206, v206
    v_mfma_f32_16x16x32_bf16 v[130:133], a[236:239], v[174:177], v[130:133]
    s_or_b32 s70, s70, s80
    v_exp_f32 v202, v202
    v_mfma_f32_16x16x32_bf16 v[182:185], v[28:31], v[36:39], 0
    s_add_u32 s45, s45, s79
    v_exp_f32 v203, v203
    v_mfma_f32_16x16x32_bf16 v[182:185], v[28:31], v[170:173], v[182:185]
    s_add_u32 s18, s18, 1
    v_cvt_pk_bf16_f32 v186, v202, v203
    v_fma_f32 v255, v130, v130, s33
    v_mfma_f32_16x16x32_bf16 v[214:217], v[162:165], v[36:39], 0
    s_cmp_lt_u32 s18, s45
    v_fmac_f32 v255, v131, v131
    v_fmac_f32 v255, v132, v132
    v_mfma_f32_16x16x32_bf16 v[214:217], v[134:137], v[170:173], v[214:217]
    v_fmac_f32 v255, v133, v133
    v_fmac_f32 v254, v207, v207
    v_mfma_f32_16x16x32_bf16 v[222:225], v[210:213], v[36:39], 0
    v_exp_f32 v204, v204
    v_mfma_f32_16x16x32_bf16 v[222:225], v[138:141], v[170:173], v[222:225]
    v_exp_f32 v205, v205
    v_mfma_f32_16x16x32_bf16 v[226:229], v[218:221], v[36:39], 0
    v_cvt_pk_bf16_f32 v36, v190, v191
    v_cvt_pk_bf16_f32 v37, v192, v193
    v_mfma_f32_16x16x32_bf16 v[226:229], v[142:145], v[170:173], v[226:229]
    v_cvt_pk_bf16_f32 v39, v232, 0
    v_cvt_pk_bf16_f32 v187, v204, v205
    v_mfma_f32_16x16x32_bf16 v[126:129], a[240:243], v[118:121], 0
    v_exp_f32 v146, v146
    v_mfma_f32_16x16x32_bf16 v[170:173], v[28:31], v[36:39], 0
    v_exp_f32 v147, v147
    v_mfma_f32_16x16x32_bf16 v[170:173], v[28:31], v[194:197], v[170:173]
    v_cvt_pk_bf16_f32 v188, v146, v147
    v_fmac_f32 v254, v208, v208
    v_mfma_f32_16x16x32_bf16 v[114:117], v[162:165], v[36:39], 0
    v_exp_f32 v148, v148
    v_mfma_f32_16x16x32_bf16 v[114:117], v[134:137], v[194:197], v[114:117]
    v_exp_f32 v149, v149
    v_mfma_f32_16x16x32_bf16 v[190:193], v[210:213], v[36:39], 0
    v_cvt_pk_bf16_f32 v189, v148, v149
    v_fmac_f32 v254, v209, v209
    v_mfma_f32_16x16x32_bf16 v[190:193], v[138:141], v[194:197], v[190:193]
    v_rcp_f32 v170, v170
    v_mfma_f32_16x16x32_bf16 v[146:149], v[218:221], v[36:39], 0
    v_exp_f32 v166, v166
    v_mfma_f32_16x16x32_bf16 v[146:149], v[142:145], v[194:197], v[146:149]
    v_mul_f32 v114, v170, v114
    v_mul_f32 v115, v170, v115
    v_mfma_f32_16x16x32_bf16 v[126:129], a[244:247], v[122:125], v[126:129]
    v_cvt_pk_bf16_f32 v194, v114, v115
    v_mul_f32 v116, v170, v116
    v_mfma_f32_16x16x32_bf16 v[126:129], a[248:251], v[150:153], v[126:129]
    ds_read_b128 v[202:205], v2 offset:12288
    v_mul_f32 v117, v170, v117
    v_mfma_f32_16x16x32_bf16 v[126:129], a[252:255], v[154:157], v[126:129]
    ds_read_b128 v[230:233], v2 offset:13312
    v_cvt_pk_bf16_f32 v195, v116, v117
    v_mfma_f32_16x16x32_bf16 v[126:129], v[82:85], v[158:161], v[126:129]
    ds_read_b128 v[234:237], v2 offset:14336
    v_mul_f32 v190, v170, v190
    v_mfma_f32_16x16x32_bf16 v[126:129], v[86:89], v[174:177], v[126:129]
    ds_read_b128 v[238:241], v2 offset:15360
    v_mul_f32 v191, v170, v191
    v_mfma_f32_16x16x32_bf16 v[114:117], v[90:93], v[118:121], 0
    ds_read_b128 v[118:121], v2 offset:16384
    v_cvt_pk_bf16_f32 v196, v190, v191
    v_mfma_f32_16x16x32_bf16 v[114:117], v[94:97], v[122:125], v[114:117]
    ds_read_b128 v[122:125], v2 offset:17408
    v_mul_f32 v192, v170, v192
    v_mfma_f32_16x16x32_bf16 v[114:117], v[98:101], v[150:153], v[114:117]
    v_fmac_f32 v255, v126, v126
    v_fmac_f32 v255, v127, v127
    v_mfma_f32_16x16x32_bf16 v[114:117], v[102:105], v[154:157], v[114:117]
    v_fmac_f32 v255, v128, v128
    v_fmac_f32 v255, v129, v129
    v_mfma_f32_16x16x32_bf16 v[114:117], v[106:109], v[158:161], v[114:117]
    s_waitcnt lgkmcnt(5)
    v_mul_f32 v193, v170, v193
    v_cvt_pk_bf16_f32 v197, v192, v193
    v_mfma_f32_16x16x32_bf16 v[114:117], v[110:113], v[174:177], v[114:117]
    s_waitcnt lgkmcnt(4)
    ds_write_b128 v3, v[194:197] offset:6144
    v_mfma_f32_16x16x32_bf16 v[242:245], a[216:219], v[202:205], 0
    s_waitcnt lgkmcnt(3)
    v_mul_f32 v146, v170, v146
    v_mul_f32 v147, v170, v147
    v_mfma_f32_16x16x32_bf16 v[242:245], a[220:223], v[230:233], v[242:245]
    s_waitcnt lgkmcnt(2)
    v_fmac_f32 v255, v114, v114
    v_fmac_f32 v255, v115, v115
    v_mfma_f32_16x16x32_bf16 v[242:245], a[224:227], v[234:237], v[242:245]
    s_waitcnt lgkmcnt(1)
    v_fmac_f32 v255, v116, v116
    v_fmac_f32 v255, v117, v117
    v_mfma_f32_16x16x32_bf16 v[242:245], a[228:231], v[238:241], v[242:245]
    v_cvt_pk_bf16_f32 v254, v254, v255
    v_cvt_pk_bf16_f32 v172, v146, v147
    v_mfma_f32_16x16x32_bf16 v[242:245], a[232:235], v[118:121], v[242:245]
    v_mul_f32 v148, v170, v148
    v_mul_f32 v149, v170, v149
    v_mfma_f32_16x16x32_bf16 v[242:245], a[236:239], v[122:125], v[242:245]
    v_cvt_pk_bf16_f32 v173, v148, v149
    v_cvt_pk_bf16_f32 v39, v252, 0
    v_mfma_f32_16x16x32_bf16 v[158:161], a[240:243], v[202:205], 0
    ds_write_b64 v4, v[172:173] offset:10240
    v_mfma_f32_16x16x32_bf16 v[158:161], a[244:247], v[230:233], v[158:161]
    v_exp_f32 v167, v167
    v_mfma_f32_16x16x32_bf16 v[158:161], a[248:251], v[234:237], v[158:161]
    v_cvt_pk_bf16_f32 v36, v166, v167
    v_fma_f32 v255, v242, v242, s33
    v_mfma_f32_16x16x32_bf16 v[158:161], a[252:255], v[238:241], v[158:161]
    v_fmac_f32 v255, v243, v243
    v_fmac_f32 v255, v244, v244
    v_mfma_f32_16x16x32_bf16 v[158:161], v[82:85], v[118:121], v[158:161]
    v_fmac_f32 v255, v245, v245
    v_xor_b32 v2, 65536, v2
    v_mfma_f32_16x16x32_bf16 v[158:161], v[86:89], v[122:125], v[158:161]
    v_exp_f32 v168, v168
    v_mfma_f32_16x16x32_bf16 v[154:157], v[90:93], v[202:205], 0
    v_exp_f32 v169, v169
    v_mfma_f32_16x16x32_bf16 v[154:157], v[94:97], v[230:233], v[154:157]
    ds_read_b128 v[146:149], v9
    v_cvt_pk_bf16_f32 v37, v168, v169
    v_mfma_f32_16x16x32_bf16 v[154:157], v[98:101], v[234:237], v[154:157]
    ds_read_b128 v[150:153], v9 offset:64
    v_fmac_f32 v255, v158, v158
    v_mfma_f32_16x16x32_bf16 v[166:169], v[28:31], v[36:39], 0
    v_fmac_f32 v255, v159, v159
    v_fmac_f32 v255, v160, v160
    v_mfma_f32_16x16x32_bf16 v[166:169], v[28:31], v[186:189], v[166:169]
    v_fmac_f32 v255, v161, v161
    v_add_u32 v6, s75, v6
    v_mfma_f32_16x16x32_bf16 v[174:177], v[162:165], v[36:39], 0
    v_rcp_f32 v182, v182
    v_mfma_f32_16x16x32_bf16 v[174:177], v[134:137], v[186:189], v[174:177]
    v_max3_u32 v25, v25, v182, v183
    v_max3_u32 v25, v25, v170, v171
    v_mfma_f32_16x16x32_bf16 v[170:173], v[210:213], v[36:39], 0
    v_rcp_f32 v166, v166
    v_mfma_f32_16x16x32_bf16 v[170:173], v[138:141], v[186:189], v[170:173]
    v_max3_u32 v25, v25, v166, v167
    v_mul_f32 v214, v182, v214
    v_mfma_f32_16x16x32_bf16 v[190:193], v[218:221], v[36:39], 0
    s_waitcnt lgkmcnt(1)
    v_mul_f32 v174, v166, v174
    v_mul_f32 v175, v166, v175
    v_mfma_f32_16x16x32_bf16 v[190:193], v[142:145], v[186:189], v[190:193]
    s_waitcnt lgkmcnt(0)
    v_cvt_pk_bf16_f32 v174, v174, v175
    v_mul_f32 v176, v166, v176
    v_mfma_f32_16x16x32_bf16 v[154:157], v[102:105], v[238:241], v[154:157]
    ds_read_b128 v[186:189], v0 offset:20480
    v_mul_f32 v177, v166, v177
    v_mfma_f32_16x16x32_bf16 v[154:157], v[106:109], v[118:121], v[154:157]
    ds_read_b128 v[194:197], v1 offset:20480
    v_cvt_pk_bf16_f32 v175, v176, v177
    v_mfma_f32_16x16x32_bf16 v[154:157], v[110:113], v[122:125], v[154:157]
    ds_read_b128 v[122:125], v0 offset:20608
    v_mul_f32 v170, v166, v170
    v_mfma_f32_16x16x32_bf16 v[118:121], v[146:149], v[28:31], 0
    ds_read_b128 v[202:205], v1 offset:20608
    v_mul_f32 v171, v166, v171
    v_mfma_f32_16x16x32_bf16 v[118:121], v[150:153], v[28:31], v[118:121]
    ds_read_b128 v[230:233], v0 offset:20736
    v_cvt_pk_bf16_f32 v176, v170, v171
    v_mfma_f32_16x16x32_bf16 v[234:237], v[146:149], v[134:137], 0
    ds_read_b128 v[238:241], v1 offset:20736
    v_fmac_f32 v255, v154, v154
    v_mfma_f32_16x16x32_bf16 v[234:237], v[150:153], v[162:165], v[234:237]
    v_fmac_f32 v255, v155, v155
    v_fmac_f32 v255, v156, v156
    v_mfma_f32_16x16x32_bf16 v[134:137], v[146:149], v[138:141], 0
    v_fmac_f32 v255, v157, v157
    v_cvt_pk_bf16_f32 v255, v255, v255
    v_mfma_f32_16x16x32_bf16 v[134:137], v[150:153], v[210:213], v[134:137]
    s_waitcnt lgkmcnt(5)
    ds_write_b64 v4, v[254:255] offset:18432
    v_mfma_f32_16x16x32_bf16 v[138:141], v[146:149], v[142:145], 0
    s_waitcnt lgkmcnt(4)
    v_mul_f32 v172, v166, v172
    v_mul_f32 v173, v166, v173
    v_mfma_f32_16x16x32_bf16 v[138:141], v[150:153], v[218:221], v[138:141]
    s_waitcnt lgkmcnt(3)
    v_cvt_pk_bf16_f32 v177, v172, v173
    v_mul_f32 v190, v166, v190
    v_mfma_f32_16x16x32_bf16 v[142:145], a[72:75], v[186:189], 0
    s_waitcnt lgkmcnt(2)
    ds_write_b128 v3, v[174:177] offset:12288
    v_mfma_f32_16x16x32_bf16 v[142:145], a[76:79], v[194:197], v[142:145]
    s_waitcnt lgkmcnt(2)
    v_mul_f32 v191, v166, v191
    v_cvt_pk_bf16_f32 v120, v190, v191
    v_mfma_f32_16x16x32_bf16 v[142:145], a[80:83], v[122:125], v[142:145]
    v_mul_f32 v192, v166, v192
    v_mul_f32 v193, v166, v193
    v_mfma_f32_16x16x32_bf16 v[142:145], a[84:87], v[202:205], v[142:145]
    v_cvt_pk_bf16_f32 v121, v192, v193
    v_mul_f32 v215, v182, v215
    v_mfma_f32_16x16x32_bf16 v[142:145], a[88:91], v[230:233], v[142:145]
    ds_write_b64 v4, v[120:121] offset:16384
    v_mfma_f32_16x16x32_bf16 v[142:145], a[92:95], v[238:241], v[142:145]
    v_rcp_f32 v118, v118
    v_mfma_f32_16x16x32_bf16 v[150:153], a[96:99], v[186:189], 0
    v_max3_u32 v25, v25, v118, v119
    v_mul_f32 v234, v234, v118
    v_mfma_f32_16x16x32_bf16 v[150:153], a[100:103], v[194:197], v[150:153]
    v_cvt_pk_bf16_f32 v146, v214, v215
    v_mul_f32_dpp v234, v134, v118 quad_perm:[0,1,2,3] row_mask:0x2 bank_mask:0xf
    v_mfma_f32_16x16x32_bf16 v[150:153], a[104:107], v[122:125], v[150:153]
    v_mul_f32 v216, v182, v216
    v_mul_f32_dpp v234, v138, v118 quad_perm:[0,1,2,3] row_mask:0x4 bank_mask:0xf
    v_mfma_f32_16x16x32_bf16 v[150:153], a[108:111], v[202:205], v[150:153]
    v_cvt_pk_bf16_f32 v234, v234, v234
    v_mul_f32 v217, v182, v217
    v_mfma_f32_16x16x32_bf16 v[150:153], a[112:115], v[230:233], v[150:153]
    ds_write_b16 v7, v234
    v_mfma_f32_16x16x32_bf16 v[150:153], a[116:119], v[238:241], v[150:153]
    v_cvt_pk_bf16_f32 v147, v216, v217
    v_mul_f32 v222, v182, v222
    v_mfma_f32_16x16x32_bf16 v[134:137], a[120:123], v[186:189], 0
    v_mul_f32 v223, v182, v223
    v_cvt_pk_bf16_f32 v148, v222, v223
    v_mfma_f32_16x16x32_bf16 v[134:137], a[124:127], v[194:197], v[134:137]
    v_mul_f32 v224, v182, v224
    v_mul_f32 v225, v182, v225
    v_mfma_f32_16x16x32_bf16 v[134:137], a[128:131], v[122:125], v[134:137]
    v_cvt_pk_bf16_f32 v149, v224, v225
    v_mul_f32 v226, v182, v226
    v_mfma_f32_16x16x32_bf16 v[134:137], a[132:135], v[202:205], v[134:137]
    ds_write_b128 v3, v[146:149] offset:0
    v_mfma_f32_16x16x32_bf16 v[134:137], a[136:139], v[230:233], v[134:137]
    v_mul_f32 v227, v182, v227
    v_cvt_pk_bf16_f32 v254, v226, v227
    v_mfma_f32_16x16x32_bf16 v[134:137], a[140:143], v[238:241], v[134:137]
    v_mul_f32 v228, v182, v228
    v_mul_f32 v229, v182, v229
    v_mfma_f32_16x16x32_bf16 v[138:141], a[0:3], v[186:189], 0
    v_cvt_pk_bf16_f32 v255, v228, v229
    v_xor_b32 v3, 65536, v3
    v_mfma_f32_16x16x32_bf16 v[138:141], a[4:7], v[194:197], v[138:141]
    ds_write_b64 v4, v[254:255] offset:4096
    v_mfma_f32_16x16x32_bf16 v[138:141], a[8:11], v[122:125], v[138:141]
    v_xor_b32 v4, 65536, v4
    v_add_u32 v7, s76, v7
    v_mfma_f32_16x16x32_bf16 v[138:141], a[12:15], v[202:205], v[138:141]
    v_cvt_pk_f16_f32 v146, v142, v143
    v_pk_mul_f16 v143, v146, v146
    v_mfma_f32_16x16x32_bf16 v[138:141], a[16:19], v[230:233], v[138:141]
    v_cvt_pk_f16_f32 v147, v144, v145
    v_pk_fma_f16 v143, v147, v147, v143
    v_mfma_f32_16x16x32_bf16 v[138:141], a[20:23], v[238:241], v[138:141]
    v_cvt_pk_f16_f32 v148, v150, v151
    v_pk_fma_f16 v143, v148, v148, v143
    v_mfma_f32_16x16x32_bf16 v[166:169], a[24:27], v[186:189], 0
    v_cvt_pk_f16_f32 v149, v152, v153
    v_pk_fma_f16 v143, v149, v149, v143
    v_mfma_f32_16x16x32_bf16 v[166:169], a[28:31], v[194:197], v[166:169]
    v_cvt_pk_f16_f32 v120, v134, v135
    v_pk_fma_f16 v143, v120, v120, v143
    v_mfma_f32_16x16x32_bf16 v[166:169], a[32:35], v[122:125], v[166:169]
    s_waitcnt lgkmcnt(0)
    v_cvt_pk_f16_f32 v121, v136, v137
    v_pk_fma_f16 v143, v121, v121, v143
    v_mfma_f32_16x16x32_bf16 v[166:169], a[36:39], v[202:205], v[166:169]
    s_nop 0
    v_mfma_f32_16x16x32_bf16 v[166:169], a[40:43], v[230:233], v[166:169]
    s_nop 0
    v_mfma_f32_16x16x32_bf16 v[166:169], a[44:47], v[238:241], v[166:169]
    s_barrier
    v_mfma_f32_16x16x32_bf16 v[134:137], a[48:51], v[186:189], 0
    s_nop 0
    v_mfma_f32_16x16x32_bf16 v[134:137], a[52:55], v[194:197], v[134:137]
    s_cbranch_scc1 L_loop_fast2
    s_branch L_final_fast
.p2align 6
L_loop_fast3:
    v_mfma_f32_16x16x32_bf16 v[134:137], a[56:59], v[122:125], v[134:137]
    s_add_u32 s12, s40, s27
    ds_read_b128 v[190:193], v2 offset:18432
    v_cvt_pk_f16_f32 v150, v138, v139
    v_mfma_f32_16x16x32_bf16 v[134:137], a[60:63], v[202:205], v[134:137]
    s_addc_u32 s13, s41, 0
    ds_read_b128 v[210:213], v2 offset:19456
    v_pk_mul_f16 v142, v150, v150
    v_mfma_f32_16x16x32_bf16 v[134:137], a[64:67], v[230:233], v[134:137]
    s_sub_u32 s14, s36, s27
    ds_read_b128 v[174:177], v5 offset:32
    v_cvt_pk_f16_f32 v151, v140, v141
    v_mfma_f32_16x16x32_bf16 v[134:137], a[68:71], v[238:241], v[134:137]
    s_cmp_ge_u32 s18, 2
    ds_read2_b64 v[162:165], v5 offset0:6 offset1:9
    v_pk_fma_f16 v142, v151, v151, v142
    v_mfma_f32_16x16x32_bf16 v[138:141], v[186:189], a[144:147], 0
    s_cselect_b32 s14, s14, 0
    ds_read_b128 v[170:173], v5
    v_cvt_pk_f16_f32 v152, v166, v167
    v_mfma_f32_16x16x32_bf16 v[138:141], v[194:197], a[148:151], v[138:141]
    s_sub_u32 s82, s72, s71
    ds_read_b32 v254, v6 offset:192
    v_pk_fma_f16 v142, v152, v152, v142
    v_mfma_f32_16x16x32_bf16 v[138:141], v[122:125], a[152:155], v[138:141]
    s_mul_i32 s74, s82, 336
    v_cvt_pk_f16_f32 v153, v168, v169
    v_pk_fma_f16 v142, v153, v153, v142
    v_mfma_f32_16x16x32_bf16 v[138:141], v[202:205], a[156:159], v[138:141]
    s_mul_i32 s75, s82, 272
    v_cvt_pk_f16_f32 v118, v134, v135
    v_pk_fma_f16 v142, v118, v118, v142
    v_mfma_f32_16x16x32_bf16 v[138:141], v[230:233], a[160:163], v[138:141]
    s_waitcnt lgkmcnt(5)
    ds_read_b128 v[182:185], v0 offset:26624
    v_cvt_pk_f16_f32 v119, v136, v137
    v_mfma_f32_16x16x32_bf16 v[166:169], v[32:35], v[190:193], 0
    s_waitcnt lgkmcnt(5)
    v_pk_fma_f16 v142, v119, v119, v142
    v_add_u32 v5, s74, v5
    v_mfma_f32_16x16x32_bf16 v[166:169], v[32:35], v[210:213], v[166:169]
    s_waitcnt lgkmcnt(4)
    v_pk_mul_f16 v145, v146, v174
    v_pk_fma_f16 v145, v147, v175, v145
    v_mfma_f32_16x16x32_bf16 v[138:141], v[238:241], a[164:167], v[138:141]
    s_mul_i32 s76, s82, 16
    ds_read_b128 v[210:213], v1 offset:26624
    v_pk_fma_f16 v145, v148, v176, v145
    v_mfma_f32_16x16x32_bf16 v[214:217], v[186:189], a[168:171], 0
    s_waitcnt lgkmcnt(3)
    ds_read_b128 v[218:221], v0 offset:26752
    v_pk_fma_f16 v145, v149, v177, v145
    v_mfma_f32_16x16x32_bf16 v[214:217], v[194:197], a[172:175], v[214:217]
    s_waitcnt lgkmcnt(3)
    ds_read_b128 v[222:225], v1 offset:26752
    v_mov_b32_dpp v254, v23 quad_perm:[0,1,2,3] row_mask:0x7 bank_mask:0xf
    v_mfma_f32_16x16x32_bf16 v[214:217], v[122:125], a[176:179], v[214:217]
    s_add_u32 s34, s18, 2
    ds_read_b128 v[226:229], v0 offset:26880
    v_pk_fma_f16 v145, v120, v164, v145
    v_mfma_f32_16x16x32_bf16 v[214:217], v[202:205], a[180:183], v[214:217]
    s_add_u32 s8, s60, s23
    ds_read_b128 v[190:193], v1 offset:26880
    v_pk_fma_f16 v145, v121, v165, v145
    v_mfma_f32_16x16x32_bf16 v[214:217], v[230:233], a[184:187], v[214:217]
    s_waitcnt lgkmcnt(5)
    v_pk_mul_f16 v144, v150, v170
    v_pk_fma_f16 v144, v151, v171, v144
    v_mfma_f32_16x16x32_bf16 v[214:217], v[238:241], a[188:191], v[214:217]
    s_addc_u32 s9, s61, 0
    v_pk_fma_f16 v144, v152, v172, v144
    v_pk_fma_f16 v144, v153, v173, v144
    v_mfma_f32_16x16x32_bf16 v[246:249], v[186:189], a[192:195], 0
    s_sub_u32 s10, s36, s23
    v_pk_fma_f16 v144, v118, v162, v144
    v_pk_fma_f16 v144, v119, v163, v144
    v_mfma_f32_16x16x32_bf16 v[246:249], v[194:197], a[196:199], v[246:249]
    s_cmp_le_u32 s34, s45
    v_cvt_pk_bf16_f32 v134, v138, v139
    v_cvt_pk_bf16_f32 v135, v140, v141
    v_mfma_f32_16x16x32_f16 v[234:237], v[40:43], v[142:145], 0
    s_cselect_b32 s10, s10, 0
    v_cvt_pk_bf16_f32 v138, v214, v215
    v_cvt_pk_bf16_f32 v139, v216, v217
    v_mfma_f32_16x16x32_bf16 v[246:249], v[122:125], a[200:203], v[246:249]
    s_add_u32 m0, s28, 0
    v_mul_f32 v136, 0x3baaaaab, v166
    v_mul_f32 v255, 0x3baaaaab, v167
    v_mfma_f32_16x16x32_bf16 v[246:249], v[202:205], a[204:207], v[246:249]
    s_mov_b32 s27, s26
    v_rsq_f32 v234, v234
    v_mfma_f32_16x16x32_bf16 v[246:249], v[230:233], a[208:211], v[246:249]
    s_mov_b32 s26, s25
    v_rsq_f32 v235, v235
    v_mfma_f32_16x16x32_bf16 v[246:249], v[238:241], a[212:215], v[246:249]
    s_mov_b32 s25, s24
    v_mul_f32 v140, s31, v234
    v_cvt_pk_f16_f32 v141, v140, v235
    v_mfma_f32_16x16x32_bf16 v[122:125], a[72:75], v[182:185], 0
    s_waitcnt lgkmcnt(0)
    v_fma_f32 v236, v236, v140, v22
    v_fmac_f32_dpp v254, v237, v235 quad_perm:[0,1,2,3] row_mask:0x1 bank_mask:0xf
    v_mfma_f32_16x16x32_bf16 v[122:125], a[76:79], v[210:213], v[122:125]
    s_mov_b32 s24, s23
    v_cvt_pk_bf16_f32 v142, v246, v247
    v_cvt_pk_bf16_f32 v143, v248, v249
    v_mfma_f32_16x16x32_bf16 v[122:125], a[80:83], v[218:221], v[122:125]
    s_mov_b32 s71, s72
    v_pk_mul_f16 v146, v146, v141 op_sel:[0,1] op_sel_hi:[1,1]
    v_pk_mul_f16 v147, v147, v141 op_sel:[0,1] op_sel_hi:[1,1]
    v_mfma_f32_16x16x32_bf16 v[122:125], a[84:87], v[222:225], v[122:125]
    s_mov_b32 s72, s73
    v_pk_mul_f16 v148, v148, v141 op_sel:[0,1] op_sel_hi:[1,1]
    v_pk_mul_f16 v149, v149, v141 op_sel:[0,1] op_sel_hi:[1,1]
    v_mfma_f32_16x16x32_bf16 v[122:125], a[88:91], v[226:229], v[122:125]
    v_pk_mul_f16 v120, v120, v141 op_sel:[0,1] op_sel_hi:[1,1]
    v_pk_mul_f16 v121, v121, v141 op_sel:[0,1] op_sel_hi:[1,1]
    v_mfma_f32_16x16x32_bf16 v[122:125], a[92:95], v[190:193], v[122:125]
    v_pk_mul_f16 v150, v150, v141 op_sel:[0,0] op_sel_hi:[1,0]
    v_pk_mul_f16 v151, v151, v141 op_sel:[0,0] op_sel_hi:[1,0]
    v_mfma_f32_16x16x32_bf16 v[186:189], a[96:99], v[182:185], 0
    v_pk_mul_f16 v152, v152, v141 op_sel:[0,0] op_sel_hi:[1,0]
    v_pk_mul_f16 v153, v153, v141 op_sel:[0,0] op_sel_hi:[1,0]
    v_mfma_f32_16x16x32_bf16 v[186:189], a[100:103], v[210:213], v[186:189]
    v_pk_mul_f16 v118, v118, v141 op_sel:[0,0] op_sel_hi:[1,0]
    v_pk_mul_f16 v119, v119, v141 op_sel:[0,0] op_sel_hi:[1,0]
    v_mfma_f32_16x16x32_bf16 v[186:189], a[104:107], v[218:221], v[186:189]
    v_max3_u32 v44, v44, v234, v235
    v_mul_f32 v144, 0x3baaaaab, v168
    v_mfma_f32_16x16x32_bf16 v[186:189], a[108:111], v[222:225], v[186:189]
    v_rsq_f32 v136, v136
    v_mfma_f32_16x16x32_bf16 v[186:189], a[112:115], v[226:229], v[186:189]
    v_rsq_f32 v255, v255
    v_mfma_f32_16x16x32_bf16 v[186:189], a[116:119], v[190:193], v[186:189]
    v_rsq_f32 v144, v144
    v_mfma_f32_16x16x32_bf16 v[194:197], a[120:123], v[182:185], 0
    v_mul_f32 v178, v136, v178
    v_mul_f32 v179, v136, v179
    v_mfma_f32_16x16x32_bf16 v[194:197], a[124:127], v[210:213], v[194:197]
    v_cvt_pk_bf16_f32 v166, v178, v179
    v_mul_f32 v180, v136, v180
    v_mfma_f32_16x16x32_bf16 v[194:197], a[128:131], v[218:221], v[194:197]
    v_mul_f32 v181, v136, v181
    v_cvt_pk_bf16_f32 v167, v180, v181
    v_mfma_f32_16x16x32_bf16 v[194:197], a[132:135], v[222:225], v[194:197]
    v_mul_f32 v198, v136, v198
    v_mul_f32 v199, v136, v199
    v_mfma_f32_16x16x32_bf16 v[194:197], a[136:139], v[226:229], v[194:197]
    v_cvt_pk_bf16_f32 v168, v198, v199
    v_mul_f32 v200, v136, v200
    v_mfma_f32_16x16x32_bf16 v[194:197], a[140:143], v[190:193], v[194:197]
    v_mul_f32 v201, v136, v201
    v_cvt_pk_bf16_f32 v169, v200, v201
    v_mfma_f32_16x16x32_bf16 v[178:181], a[0:3], v[182:185], 0
    buffer_store_dwordx4 v[166:169], v15, s[12:15], 0 offen nt
    v_mul_f32 v206, v136, v206
    v_mul_f32 v207, v136, v207
    v_cvt_pk_bf16_f32 v140, v206, v207
    v_mul_f32 v208, v136, v208
    v_mfma_f32_16x16x32_bf16 v[178:181], a[4:7], v[210:213], v[178:181]
    v_mul_f32 v209, v136, v209
    v_cvt_pk_bf16_f32 v141, v208, v209
    v_mfma_f32_16x16x32_bf16 v[178:181], a[8:11], v[218:221], v[178:181]
    v_cvt_pk_f16_f32 v166, v122, v123
    v_pk_mul_f16 v199, v166, v166
    v_mfma_f32_16x16x32_bf16 v[178:181], a[12:15], v[222:225], v[178:181]
    v_cvt_pk_f16_f32 v167, v124, v125
    v_pk_fma_f16 v199, v167, v167, v199
    v_mfma_f32_16x16x32_bf16 v[178:181], a[16:19], v[226:229], v[178:181]
    v_cvt_pk_f16_f32 v168, v186, v187
    v_pk_fma_f16 v199, v168, v168, v199
    v_mfma_f32_16x16x32_bf16 v[178:181], a[20:23], v[190:193], v[178:181]
    v_cvt_pk_f16_f32 v169, v188, v189
    v_pk_fma_f16 v199, v169, v169, v199
    v_mfma_f32_16x16x32_bf16 v[186:189], a[24:27], v[182:185], 0
    v_cvt_pk_f16_f32 v124, v194, v195
    v_pk_fma_f16 v199, v124, v124, v199
    v_mfma_f32_16x16x32_bf16 v[186:189], a[28:31], v[210:213], v[186:189]
    v_cvt_pk_f16_f32 v125, v196, v197
    v_pk_fma_f16 v199, v125, v125, v199
    v_mfma_f32_16x16x32_bf16 v[186:189], a[32:35], v[218:221], v[186:189]
    v_cvt_pk_f16_f32 v178, v178, v179
    v_pk_mul_f16 v198, v178, v178
    v_mfma_f32_16x16x32_bf16 v[186:189], a[36:39], v[222:225], v[186:189]
    v_cvt_pk_f16_f32 v179, v180, v181
    v_pk_fma_f16 v198, v179, v179, v198
    v_mfma_f32_16x16x32_bf16 v[186:189], a[40:43], v[226:229], v[186:189]
    v_pk_mul_f16 v200, v178, v170
    v_pk_fma_f16 v200, v179, v171, v200
    v_mfma_f32_16x16x32_bf16 v[186:189], a[44:47], v[190:193], v[186:189]
    v_pk_mul_f16 v201, v166, v174
    v_pk_fma_f16 v201, v167, v175, v201
    v_mfma_f32_16x16x32_bf16 v[194:197], a[48:51], v[182:185], 0
    v_pk_fma_f16 v201, v168, v176, v201
    v_pk_fma_f16 v201, v169, v177, v201
    v_mfma_f32_16x16x32_bf16 v[194:197], a[52:55], v[210:213], v[194:197]
    v_pk_fma_f16 v201, v124, v164, v201
    v_pk_fma_f16 v201, v125, v165, v201
    v_mfma_f32_16x16x32_bf16 v[194:197], a[56:59], v[218:221], v[194:197]
    v_cvt_pk_f16_f32 v180, v186, v187
    v_pk_fma_f16 v198, v180, v180, v198
    v_mfma_f32_16x16x32_bf16 v[194:197], a[60:63], v[222:225], v[194:197]
    v_cvt_pk_f16_f32 v181, v188, v189
    v_pk_fma_f16 v198, v181, v181, v198
    v_mfma_f32_16x16x32_bf16 v[194:197], a[64:67], v[226:229], v[194:197]
    v_pk_fma_f16 v200, v180, v172, v200
    v_pk_fma_f16 v200, v181, v173, v200
    v_mfma_f32_16x16x32_bf16 v[194:197], a[68:71], v[190:193], v[194:197]
    buffer_store_dwordx2 v[140:141], v18, s[12:15], 0 offen nt
    v_mul_f32 v242, v144, v242
    v_mul_f32 v243, v144, v243
    v_mfma_f32_16x16x32_bf16 v[186:189], v[182:185], a[144:147], 0
    v_cvt_pk_bf16_f32 v238, v242, v243
    v_mul_f32 v244, v144, v244
    v_mfma_f32_16x16x32_bf16 v[186:189], v[210:213], a[148:151], v[186:189]
    v_mul_f32 v245, v144, v245
    v_cvt_pk_f16_f32 v122, v194, v195
    v_mfma_f32_16x16x32_bf16 v[186:189], v[218:221], a[152:155], v[186:189]
    v_pk_fma_f16 v198, v122, v122, v198
    v_cvt_pk_f16_f32 v123, v196, v197
    v_mfma_f32_16x16x32_bf16 v[186:189], v[222:225], a[156:159], v[186:189]
    v_pk_fma_f16 v198, v123, v123, v198
    v_pk_fma_f16 v200, v122, v162, v200
    v_mfma_f32_16x16x32_bf16 v[186:189], v[226:229], a[160:163], v[186:189]
    ds_read_b128 v[202:205], v0 offset:32768
    v_pk_fma_f16 v200, v123, v163, v200
    v_mfma_f32_16x16x32_bf16 v[186:189], v[190:193], a[164:167], v[186:189]
    ds_read_b128 v[194:197], v1 offset:32768
    v_cvt_pk_bf16_f32 v239, v244, v245
    v_mfma_f32_16x16x32_f16 v[230:233], v[40:43], v[198:201], 0
    v_mul_f32 v158, v144, v158
    v_mul_f32 v159, v144, v159
    v_mfma_f32_16x16x32_bf16 v[246:249], v[182:185], a[168:171], 0
    ds_read_b128 v[214:217], v0 offset:32896
    v_cvt_pk_bf16_f32 v240, v158, v159
    v_mfma_f32_16x16x32_bf16 v[246:249], v[210:213], a[172:175], v[246:249]
    ds_read_b128 v[206:209], v1 offset:32896
    v_cvt_pk_bf16_f32 v136, v186, v187
    v_mfma_f32_16x16x32_bf16 v[246:249], v[218:221], a[176:179], v[246:249]
    ds_read_b128 v[198:201], v0 offset:33024
    v_cvt_pk_bf16_f32 v137, v188, v189
    v_mfma_f32_16x16x32_bf16 v[246:249], v[222:225], a[180:183], v[246:249]
    ds_read_b128 v[186:189], v1 offset:33024
    v_mul_f32 v160, v144, v160
    v_mfma_f32_16x16x32_bf16 v[246:249], v[226:229], a[184:187], v[246:249]
    v_rsq_f32 v230, v230
    v_mfma_f32_16x16x32_bf16 v[246:249], v[190:193], a[188:191], v[246:249]
    s_waitcnt lgkmcnt(5)
    v_rsq_f32 v231, v231
    v_mfma_f32_16x16x32_bf16 v[242:245], v[182:185], a[192:195], 0
    s_waitcnt lgkmcnt(4)
    v_mul_f32 v234, s31, v230
    v_cvt_pk_f16_f32 v235, v234, v231
    v_mfma_f32_16x16x32_bf16 v[242:245], v[210:213], a[196:199], v[242:245]
    v_fma_f32 v232, v232, v234, v24
    v_fmac_f32_dpp v254, v233, v231 quad_perm:[0,1,2,3] row_mask:0x2 bank_mask:0xf
    v_mfma_f32_16x16x32_bf16 v[242:245], v[218:221], a[200:203], v[242:245]
    s_waitcnt lgkmcnt(3)
    v_cvt_pk_bf16_f32 v140, v246, v247
    v_cvt_pk_bf16_f32 v141, v248, v249
    v_mfma_f32_16x16x32_bf16 v[242:245], v[222:225], a[204:207], v[242:245]
    s_waitcnt lgkmcnt(2)
    v_mul_f32 v161, v144, v161
    v_cvt_pk_bf16_f32 v241, v160, v161
    v_mfma_f32_16x16x32_bf16 v[242:245], v[226:229], a[208:211], v[242:245]
    s_waitcnt lgkmcnt(1)
    buffer_store_dwordx4 v[238:241], v17, s[12:15], 0 offen nt
    v_mul_f32 v154, v144, v154
    v_mul_f32 v155, v144, v155
    v_cvt_pk_bf16_f32 v154, v154, v155
    v_mul_f32 v156, v144, v156
    v_mfma_f32_16x16x32_bf16 v[242:245], v[190:193], a[212:215], v[242:245]
    s_waitcnt lgkmcnt(0)
    v_mul_f32 v157, v144, v157
    v_cvt_pk_bf16_f32 v155, v156, v157
    v_mfma_f32_16x16x32_bf16 v[158:161], a[72:75], v[202:205], 0
    v_pk_mul_f16 v166, v166, v235 op_sel:[0,1] op_sel_hi:[1,1]
    v_pk_mul_f16 v167, v167, v235 op_sel:[0,1] op_sel_hi:[1,1]
    v_mfma_f32_16x16x32_bf16 v[158:161], a[76:79], v[194:197], v[158:161]
    v_pk_mul_f16 v168, v168, v235 op_sel:[0,1] op_sel_hi:[1,1]
    v_cvt_pk_bf16_f32 v144, v242, v243
    v_mfma_f32_16x16x32_bf16 v[158:161], a[80:83], v[214:217], v[158:161]
    v_cvt_pk_bf16_f32 v145, v244, v245
    v_pk_mul_f16 v169, v169, v235 op_sel:[0,1] op_sel_hi:[1,1]
    v_mfma_f32_16x16x32_bf16 v[158:161], a[84:87], v[206:209], v[158:161]
    v_pk_mul_f16 v124, v124, v235 op_sel:[0,1] op_sel_hi:[1,1]
    v_pk_mul_f16 v125, v125, v235 op_sel:[0,1] op_sel_hi:[1,1]
    v_mfma_f32_16x16x32_bf16 v[158:161], a[88:91], v[198:201], v[158:161]
    v_pk_mul_f16 v178, v178, v235 op_sel:[0,0] op_sel_hi:[1,0]
    v_pk_mul_f16 v179, v179, v235 op_sel:[0,0] op_sel_hi:[1,0]
    v_mfma_f32_16x16x32_bf16 v[158:161], a[92:95], v[186:189], v[158:161]
    v_pk_mul_f16 v180, v180, v235 op_sel:[0,0] op_sel_hi:[1,0]
    v_pk_mul_f16 v181, v181, v235 op_sel:[0,0] op_sel_hi:[1,0]
    v_mfma_f32_16x16x32_bf16 v[182:185], a[96:99], v[202:205], 0
    v_pk_mul_f16 v122, v122, v235 op_sel:[0,0] op_sel_hi:[1,0]
    v_pk_mul_f16 v123, v123, v235 op_sel:[0,0] op_sel_hi:[1,0]
    v_mfma_f32_16x16x32_bf16 v[182:185], a[100:103], v[194:197], v[182:185]
    v_max3_u32 v44, v44, v230, v231
    v_mul_f32 v130, v255, v130
    v_mfma_f32_16x16x32_bf16 v[182:185], a[104:107], v[214:217], v[182:185]
    v_cvt_pk_f16_f32 v158, v158, v159
    v_pk_mul_f16 v191, v158, v158
    v_mfma_f32_16x16x32_bf16 v[182:185], a[108:111], v[206:209], v[182:185]
    v_cvt_pk_f16_f32 v159, v160, v161
    v_pk_fma_f16 v191, v159, v159, v191
    v_mfma_f32_16x16x32_bf16 v[182:185], a[112:115], v[198:201], v[182:185]
    v_pk_mul_f16 v193, v158, v174
    v_pk_fma_f16 v193, v159, v175, v193
    v_mfma_f32_16x16x32_bf16 v[182:185], a[116:119], v[186:189], v[182:185]
    v_exp_f32 v232, v232
    v_mfma_f32_16x16x32_bf16 v[210:213], a[120:123], v[202:205], 0
    v_exp_f32 v236, v236
    v_mfma_f32_16x16x32_bf16 v[210:213], a[124:127], v[194:197], v[210:213]
    v_cvt_pk_bf16_f32 v39, v236, 0
    v_mul_f32 v131, v255, v131
    v_mfma_f32_16x16x32_bf16 v[210:213], a[128:131], v[214:217], v[210:213]
    s_waitcnt vmcnt(3)
    ds_write_b16 v8, v45 offset:512
    v_mfma_f32_16x16x32_bf16 v[210:213], a[132:135], v[206:209], v[210:213]
    buffer_store_dwordx2 v[154:155], v20, s[12:15], 0 offen nt
    v_cvt_pk_f16_f32 v160, v182, v183
    v_mfma_f32_16x16x32_bf16 v[210:213], a[136:139], v[198:201], v[210:213]
    v_pk_fma_f16 v191, v160, v160, v191
    v_cvt_pk_f16_f32 v161, v184, v185
    v_mfma_f32_16x16x32_bf16 v[210:213], a[140:143], v[186:189], v[210:213]
    v_pk_fma_f16 v191, v161, v161, v191
    v_pk_fma_f16 v193, v160, v176, v193
    v_mfma_f32_16x16x32_bf16 v[154:157], a[0:3], v[202:205], 0
    v_pk_fma_f16 v193, v161, v177, v193
    v_cvt_pk_bf16_f32 v130, v130, v131
    v_mfma_f32_16x16x32_bf16 v[154:157], a[4:7], v[194:197], v[154:157]
    v_mul_f32 v132, v255, v132
    v_mul_f32 v133, v255, v133
    v_mfma_f32_16x16x32_bf16 v[154:157], a[8:11], v[214:217], v[154:157]
    v_cvt_pk_f16_f32 v176, v210, v211
    v_pk_fma_f16 v191, v176, v176, v191
    v_mfma_f32_16x16x32_bf16 v[154:157], a[12:15], v[206:209], v[154:157]
    s_waitcnt lgkmcnt(0)
    v_cvt_pk_f16_f32 v177, v212, v213
    v_pk_fma_f16 v191, v177, v177, v191
    v_mfma_f32_16x16x32_bf16 v[154:157], a[16:19], v[198:201], v[154:157]
    v_pk_fma_f16 v193, v176, v164, v193
    v_mfma_f32_16x16x32_bf16 v[154:157], a[20:23], v[186:189], v[154:157]
    v_pk_fma_f16 v193, v177, v165, v193
    v_mfma_f32_16x16x32_bf16 v[182:185], a[24:27], v[202:205], 0
    v_cvt_pk_bf16_f32 v131, v132, v133
    v_mfma_f32_16x16x32_bf16 v[182:185], a[28:31], v[194:197], v[182:185]
    s_barrier
    ds_read2_b32 v[164:165], v6 offset0:0 offset1:0
    v_mfma_f32_16x16x32_bf16 v[182:185], a[32:35], v[214:217], v[182:185]
    ds_read2_b32 v[212:213], v6 offset0:16 offset1:16
    v_cvt_pk_f16_f32 v154, v154, v155
    v_mfma_f32_16x16x32_bf16 v[182:185], a[36:39], v[206:209], v[182:185]
    ds_read2_b32 v[220:221], v6 offset0:32 offset1:32
    v_pk_mul_f16 v190, v154, v154
    v_mfma_f32_16x16x32_bf16 v[182:185], a[40:43], v[198:201], v[182:185]
    ds_read_u16 v133, v9 offset:128
    v_cvt_pk_f16_f32 v155, v156, v157
    v_mfma_f32_16x16x32_bf16 v[182:185], a[44:47], v[186:189], v[182:185]
    v_pk_fma_f16 v190, v155, v155, v190
    v_pk_mul_f16 v192, v154, v170
    v_mfma_f32_16x16x32_bf16 v[222:225], a[48:51], v[202:205], 0
    v_pk_fma_f16 v192, v155, v171, v192
    v_mul_f32 v126, v255, v126
    v_mfma_f32_16x16x32_bf16 v[222:225], a[52:55], v[194:197], v[222:225]
    v_mul_f32 v127, v255, v127
    v_cvt_pk_bf16_f32 v132, v126, v127
    v_mfma_f32_16x16x32_bf16 v[222:225], a[56:59], v[214:217], v[222:225]
    buffer_load_dwordx4 v10, s[8:11], 0 offen nt lds
    v_cvt_pk_f16_f32 v156, v182, v183
    v_mfma_f32_16x16x32_bf16 v[222:225], a[60:63], v[206:209], v[222:225]
    s_add_u32 m0, s28, 4096
    v_pk_fma_f16 v190, v156, v156, v190
    v_cvt_pk_f16_f32 v157, v184, v185
    v_mfma_f32_16x16x32_bf16 v[222:225], a[64:67], v[198:201], v[222:225]
    s_waitcnt lgkmcnt(2)
    v_pk_fma_f16 v190, v157, v157, v190
    v_pk_fma_f16 v192, v156, v172, v192
    v_mfma_f32_16x16x32_bf16 v[222:225], a[68:71], v[186:189], v[222:225]
    s_waitcnt lgkmcnt(1)
    ds_read_b128 v[182:185], v2 offset:0
    v_pk_fma_f16 v192, v157, v173, v192
    v_mfma_f32_16x16x32_bf16 v[170:173], v[202:205], a[144:147], 0
    s_waitcnt lgkmcnt(1)
    ds_read_b128 v[226:229], v2 offset:1024
    v_readfirstlane_b32 s77, v133
    v_mfma_f32_16x16x32_bf16 v[170:173], v[194:197], a[148:151], v[170:173]
    ds_read_b128 v[234:237], v2 offset:2048
    buffer_load_dwordx4 v11, s[8:11], 0 offen nt lds
    v_mfma_f32_16x16x32_bf16 v[170:173], v[214:217], a[152:155], v[170:173]
    s_add_u32 m0, s28, 8192
    ds_read_b128 v[238:241], v2 offset:3072
    v_cvt_pk_f16_f32 v174, v222, v223
    v_mfma_f32_16x16x32_bf16 v[170:173], v[206:209], a[156:159], v[170:173]
    s_mul_i32 s78, s77, 2688
    ds_read_b128 v[242:245], v2 offset:4096
    v_pk_fma_f16 v190, v174, v174, v190
    v_mfma_f32_16x16x32_bf16 v[170:173], v[198:201], a[160:163], v[170:173]
    ds_read_b128 v[246:249], v2 offset:5120
    v_cvt_pk_f16_f32 v175, v224, v225
    v_mfma_f32_16x16x32_bf16 v[170:173], v[186:189], a[164:167], v[170:173]
    v_pk_fma_f16 v190, v175, v175, v190
    v_pk_fma_f16 v192, v174, v162, v192
    v_mfma_f32_16x16x32_bf16 v[222:225], v[202:205], a[168:171], 0
    buffer_load_dwordx4 v12, s[8:11], 0 offen nt lds
    v_pk_fma_f16 v192, v175, v163, v192
    v_mfma_f32_16x16x32_bf16 v[222:225], v[194:197], a[172:175], v[222:225]
    s_waitcnt lgkmcnt(5)
    v_mul_f32 v128, v255, v128
    v_cvt_pk_bf16_f32 v162, v170, v171
    v_mfma_f32_16x16x32_f16 v[250:253], v[40:43], v[190:193], 0
    s_add_u32 m0, s28, 12288
    v_cvt_pk_bf16_f32 v163, v172, v173
    v_mul_f32 v129, v255, v129
    v_mfma_f32_16x16x32_bf16 v[222:225], v[214:217], a[176:179], v[222:225]
    s_xor_b32 s28, s28, 65536
    v_cvt_pk_bf16_f32 v133, v128, v129
    v_mul_f32 v114, v255, v114
    v_mfma_f32_16x16x32_bf16 v[222:225], v[206:209], a[180:183], v[222:225]
    s_waitcnt lgkmcnt(2)
    v_rsq_f32 v250, v250
    v_mfma_f32_16x16x32_bf16 v[222:225], v[198:201], a[184:187], v[222:225]
    s_waitcnt lgkmcnt(1)
    buffer_load_dwordx4 v13, s[8:11], 0 offen nt lds
    v_mul_f32 v230, s31, v250
    v_mfma_f32_16x16x32_bf16 v[222:225], v[186:189], a[188:191], v[222:225]
    s_mov_b32 m0, s29
    v_rsq_f32 v251, v251
    v_mfma_f32_16x16x32_bf16 v[126:129], v[202:205], a[192:195], 0
    s_xor_b32 s29, s29, s30
    v_cvt_pk_f16_f32 v231, v230, v251
    v_fma_f32 v252, v252, v230, v26
    v_mfma_f32_16x16x32_bf16 v[126:129], v[194:197], a[196:199], v[126:129]
    s_add_u32 s19, s19, s20
    v_fmac_f32_dpp v254, v253, v251 quad_perm:[0,1,2,3] row_mask:0x4 bank_mask:0xf
    v_cvt_pk_bf16_f32 v210, v222, v223
    v_mfma_f32_16x16x32_bf16 v[126:129], v[214:217], a[200:203], v[126:129]
    s_add_u32 s23, s23, s21
    v_cvt_pk_bf16_f32 v211, v224, v225
    v_pk_mul_f16 v158, v158, v231 op_sel:[0,1] op_sel_hi:[1,1]
    v_mfma_f32_16x16x32_bf16 v[126:129], v[206:209], a[204:207], v[126:129]
    s_waitcnt lgkmcnt(0)
    v_pk_mul_f16 v159, v159, v231 op_sel:[0,1] op_sel_hi:[1,1]
    v_mfma_f32_16x16x32_bf16 v[126:129], v[198:201], a[208:211], v[126:129]
    s_cmp_ge_u32 s19, 72
    v_pk_mul_f16 v160, v160, v231 op_sel:[0,1] op_sel_hi:[1,1]
    v_pk_mul_f16 v161, v161, v231 op_sel:[0,1] op_sel_hi:[1,1]
    v_mfma_f32_16x16x32_bf16 v[126:129], v[186:189], a[212:215], v[126:129]
    s_cselect_b32 s34, 72, 0
    v_pk_mul_f16 v176, v176, v231 op_sel:[0,1] op_sel_hi:[1,1]
    v_pk_mul_f16 v177, v177, v231 op_sel:[0,1] op_sel_hi:[1,1]
    v_mfma_f32_16x16x32_f16 v[170:173], v[146:149], v[150:153], v[46:49]
    s_cselect_b32 s35, s22, 0
    v_pk_mul_f16 v154, v154, v231 op_sel:[0,0] op_sel_hi:[1,0]
    v_pk_mul_f16 v155, v155, v231 op_sel:[0,0] op_sel_hi:[1,0]
    v_mfma_f32_16x16x32_f16 v[186:189], v[166:169], v[150:153], v[50:53]
    s_sub_u32 s19, s19, s34
    v_cvt_pk_bf16_f32 v218, v126, v127
    v_cvt_pk_bf16_f32 v219, v128, v129
    v_mfma_f32_16x16x32_f16 v[126:129], v[158:161], v[150:153], v[54:57]
    buffer_store_dwordx4 v[130:133], v16, s[12:15], 0 offen nt
    v_pk_mul_f16 v156, v156, v231 op_sel:[0,0] op_sel_hi:[1,0]
    v_pk_mul_f16 v157, v157, v231 op_sel:[0,0] op_sel_hi:[1,0]
    v_pk_mul_f16 v174, v174, v231 op_sel:[0,0] op_sel_hi:[1,0]
    v_pk_mul_f16 v175, v175, v231 op_sel:[0,0] op_sel_hi:[1,0]
    v_mfma_f32_16x16x16_f16 v[170:173], v[120:121], v[118:119], v[170:173]
    v_max3_u32 v44, v44, v250, v251
    v_exp_f32 v254, v254
    v_mfma_f32_16x16x16_f16 v[186:189], v[124:125], v[118:119], v[186:189]
    v_cvt_pk_bf16_f32 v254, v254, v254
    v_exp_f32 v252, v252
    v_mfma_f32_16x16x16_f16 v[126:129], v[176:177], v[118:119], v[126:129]
    v_mul_f32 v115, v255, v115
    v_cvt_pk_bf16_f32 v118, v114, v115
    v_exp_f32 v170, v170
    v_mfma_f32_16x16x32_f16 v[130:133], v[146:149], v[178:181], v[58:61]
    s_add_u32 s23, s23, s35
    ds_write_b16 v8, v254
    v_mfma_f32_16x16x32_f16 v[150:153], v[166:169], v[178:181], v[62:65]
    s_add_u32 s78, s78, s69
    v_exp_f32 v171, v171
    v_mfma_f32_16x16x32_f16 v[190:193], v[158:161], v[178:181], v[66:69]
    s_add_u32 s80, s77, s68
    v_cvt_pk_bf16_f32 v170, v170, v171
    v_exp_f32 v172, v172
    v_mfma_f32_16x16x16_f16 v[130:133], v[120:121], v[122:123], v[130:133]
    v_exp_f32 v173, v173
    v_mul_f32 v116, v255, v116
    v_mfma_f32_16x16x16_f16 v[150:153], v[124:125], v[122:123], v[150:153]
    v_cvt_pk_bf16_f32 v171, v172, v173
    v_exp_f32 v186, v186
    v_mfma_f32_16x16x16_f16 v[190:193], v[176:177], v[122:123], v[190:193]
    v_exp_f32 v187, v187
    v_exp_f32 v188, v188
    v_mfma_f32_16x16x32_bf16 v[178:181], a[216:219], v[182:185], 0
    s_cmp_ge_u32 s80, 72
    v_exp_f32 v130, v130
    v_mfma_f32_16x16x32_bf16 v[178:181], a[220:223], v[226:229], v[178:181]
    s_cselect_b32 s80, s22, 0
    v_exp_f32 v131, v131
    v_mfma_f32_16x16x32_bf16 v[178:181], a[224:227], v[234:237], v[178:181]
    s_add_u32 s78, s78, s80
    v_cvt_pk_bf16_f32 v194, v130, v131
    v_cvt_pk_bf16_f32 v172, v186, v187
    v_mfma_f32_16x16x32_bf16 v[178:181], a[228:231], v[238:241], v[178:181]
    s_add_u32 s80, s77, 20
    v_exp_f32 v132, v132
    v_mfma_f32_16x16x32_bf16 v[178:181], a[232:235], v[242:245], v[178:181]
    s_add_u32 s34, s18, 3
    v_exp_f32 v133, v133
    v_mfma_f32_16x16x32_bf16 v[178:181], a[236:239], v[246:249], v[178:181]
    s_cmp_lt_u32 s77, s62
    v_cvt_pk_bf16_f32 v195, v132, v133
    v_mul_f32 v117, v255, v117
    v_mfma_f32_16x16x32_bf16 v[198:201], a[240:243], v[182:185], 0
    s_cselect_b32 s79, 1, 0
    v_exp_f32 v150, v150
    v_mfma_f32_16x16x32_f16 v[202:205], v[146:149], v[154:157], v[70:73]
    s_cselect_b32 s78, s78, 0
    v_exp_f32 v151, v151
    v_mfma_f32_16x16x32_f16 v[146:149], v[166:169], v[154:157], v[74:77]
    s_cmp_lt_u32 s34, s17
    v_cvt_pk_bf16_f32 v196, v150, v151
    v_cvt_pk_bf16_f32 v119, v116, v117
    v_mfma_f32_16x16x32_f16 v[166:169], v[158:161], v[154:157], v[78:81]
    buffer_store_dwordx2 v[118:119], v19, s[12:15], 0 offen nt
    v_exp_f32 v152, v152
    v_mfma_f32_16x16x16_f16 v[202:205], v[120:121], v[174:175], v[202:205]
    v_exp_f32 v153, v153
    v_fma_f32 v254, v178, v178, s33
    v_mfma_f32_16x16x16_f16 v[146:149], v[124:125], v[174:175], v[146:149]
    v_cvt_pk_bf16_f32 v197, v152, v153
    v_exp_f32 v190, v190
    v_mfma_f32_16x16x16_f16 v[166:169], v[176:177], v[174:175], v[166:169]
    v_exp_f32 v191, v191
    v_exp_f32 v192, v192
    v_mfma_f32_16x16x32_bf16 v[198:201], a[244:247], v[226:229], v[198:201]
    s_cselect_b32 s23, s23, s78
    v_exp_f32 v193, v193
    v_mfma_f32_16x16x32_bf16 v[198:201], a[248:251], v[234:237], v[198:201]
    s_cselect_b32 s73, s34, s80
    ds_read_b128 v[118:121], v2 offset:6144
    v_fmac_f32 v254, v179, v179
    v_mfma_f32_16x16x32_bf16 v[198:201], a[252:255], v[238:241], v[198:201]
    s_cselect_b32 s79, 0, s79
    ds_read_b128 v[122:125], v2 offset:7168
    v_fmac_f32 v254, v180, v180
    v_mfma_f32_16x16x32_bf16 v[198:201], v[82:85], v[242:245], v[198:201]
    s_cselect_b32 s81, 0, 1
    ds_read_b128 v[150:153], v2 offset:8192
    v_fmac_f32 v254, v181, v181
    v_mfma_f32_16x16x32_bf16 v[198:201], v[86:89], v[246:249], v[198:201]
    s_add_u32 s80, s77, 1
    ds_read_b128 v[154:157], v2 offset:9216
    v_xor_b32 v0, 65536, v0
    v_mfma_f32_16x16x32_bf16 v[206:209], v[90:93], v[182:185], 0
    s_mul_i32 s80, s80, s81
    ds_read_b128 v[158:161], v2 offset:10240
    v_xor_b32 v1, 65536, v1
    v_mfma_f32_16x16x32_bf16 v[206:209], v[94:97], v[226:229], v[206:209]
    s_cmp_lt_u32 s80, s62
    ds_read_b128 v[174:177], v2 offset:11264
    v_fmac_f32 v254, v198, v198
    v_mfma_f32_16x16x32_bf16 v[206:209], v[98:101], v[234:237], v[206:209]
    s_cselect_b32 s62, s62, 0
    v_exp_f32 v189, v189
    v_mfma_f32_16x16x32_bf16 v[206:209], v[102:105], v[238:241], v[206:209]
    s_add_u32 s80, s18, 4
    v_cvt_pk_bf16_f32 v173, v188, v189
    v_fmac_f32 v254, v199, v199
    v_mfma_f32_16x16x32_bf16 v[206:209], v[106:109], v[242:245], v[206:209]
    s_waitcnt lgkmcnt(5)
    v_exp_f32 v126, v126
    v_mfma_f32_16x16x32_bf16 v[206:209], v[110:113], v[246:249], v[206:209]
    s_cmp_ge_u32 s80, s17
    v_exp_f32 v127, v127
    v_mfma_f32_16x16x32_bf16 v[130:133], a[216:219], v[118:121], 0
    s_waitcnt lgkmcnt(3)
    v_cvt_pk_bf16_f32 v36, v126, v127
    v_fmac_f32 v254, v200, v200
    v_mfma_f32_16x16x32_bf16 v[130:133], a[220:223], v[122:125], v[130:133]
    s_cselect_b32 s66, s62, 0
    v_exp_f32 v128, v128
    v_mfma_f32_16x16x32_bf16 v[130:133], a[224:227], v[150:153], v[130:133]
    s_waitcnt lgkmcnt(1)
    v_fmac_f32 v254, v201, v201
    v_mfma_f32_16x16x32_bf16 v[130:133], a[228:231], v[154:157], v[130:133]
    s_lshl_b32 s80, s79, s73
    v_exp_f32 v129, v129
    v_mfma_f32_16x16x32_bf16 v[130:133], a[232:235], v[158:161], v[130:133]
    s_waitcnt lgkmcnt(0)
    v_cvt_pk_bf16_f32 v37, v128, v129
    v_fmac_f32 v254, v206, v206
    v_mfma_f32_16x16x32_bf16 v[130:133], a[236:239], v[174:177], v[130:133]
    s_or_b32 s70, s70, s80
    v_exp_f32 v202, v202
    v_mfma_f32_16x16x32_bf16 v[182:185], v[28:31], v[36:39], 0
    s_add_u32 s45, s45, s79
    v_exp_f32 v203, v203
    v_mfma_f32_16x16x32_bf16 v[182:185], v[28:31], v[170:173], v[182:185]
    s_add_u32 s18, s18, 1
    v_cvt_pk_bf16_f32 v186, v202, v203
    v_fma_f32 v255, v130, v130, s33
    v_mfma_f32_16x16x32_bf16 v[214:217], v[162:165], v[36:39], 0
    s_cmp_lt_u32 s18, s45
    v_fmac_f32 v255, v131, v131
    v_fmac_f32 v255, v132, v132
    v_mfma_f32_16x16x32_bf16 v[214:217], v[134:137], v[170:173], v[214:217]
    v_fmac_f32 v255, v133, v133
    v_fmac_f32 v254, v207, v207
    v_mfma_f32_16x16x32_bf16 v[222:225], v[210:213], v[36:39], 0
    v_exp_f32 v204, v204
    v_mfma_f32_16x16x32_bf16 v[222:225], v[138:141], v[170:173], v[222:225]
    v_exp_f32 v205, v205
    v_mfma_f32_16x16x32_bf16 v[226:229], v[218:221], v[36:39], 0
    v_cvt_pk_bf16_f32 v36, v190, v191
    v_cvt_pk_bf16_f32 v37, v192, v193
    v_mfma_f32_16x16x32_bf16 v[226:229], v[142:145], v[170:173], v[226:229]
    v_cvt_pk_bf16_f32 v39, v232, 0
    v_cvt_pk_bf16_f32 v187, v204, v205
    v_mfma_f32_16x16x32_bf16 v[126:129], a[240:243], v[118:121], 0
    v_exp_f32 v146, v146
    v_mfma_f32_16x16x32_bf16 v[170:173], v[28:31], v[36:39], 0
    v_exp_f32 v147, v147
    v_mfma_f32_16x16x32_bf16 v[170:173], v[28:31], v[194:197], v[170:173]
    v_cvt_pk_bf16_f32 v188, v146, v147
    v_fmac_f32 v254, v208, v208
    v_mfma_f32_16x16x32_bf16 v[114:117], v[162:165], v[36:39], 0
    v_exp_f32 v148, v148
    v_mfma_f32_16x16x32_bf16 v[114:117], v[134:137], v[194:197], v[114:117]
    v_exp_f32 v149, v149
    v_mfma_f32_16x16x32_bf16 v[190:193], v[210:213], v[36:39], 0
    v_cvt_pk_bf16_f32 v189, v148, v149
    v_fmac_f32 v254, v209, v209
    v_mfma_f32_16x16x32_bf16 v[190:193], v[138:141], v[194:197], v[190:193]
    v_rcp_f32 v170, v170
    v_mfma_f32_16x16x32_bf16 v[146:149], v[218:221], v[36:39], 0
    v_exp_f32 v166, v166
    v_mfma_f32_16x16x32_bf16 v[146:149], v[142:145], v[194:197], v[146:149]
    v_mul_f32 v114, v170, v114
    v_mul_f32 v115, v170, v115
    v_mfma_f32_16x16x32_bf16 v[126:129], a[244:247], v[122:125], v[126:129]
    v_cvt_pk_bf16_f32 v194, v114, v115
    v_mul_f32 v116, v170, v116
    v_mfma_f32_16x16x32_bf16 v[126:129], a[248:251], v[150:153], v[126:129]
    ds_read_b128 v[202:205], v2 offset:12288
    v_mul_f32 v117, v170, v117
    v_mfma_f32_16x16x32_bf16 v[126:129], a[252:255], v[154:157], v[126:129]
    ds_read_b128 v[230:233], v2 offset:13312
    v_cvt_pk_bf16_f32 v195, v116, v117
    v_mfma_f32_16x16x32_bf16 v[126:129], v[82:85], v[158:161], v[126:129]
    ds_read_b128 v[234:237], v2 offset:14336
    v_mul_f32 v190, v170, v190
    v_mfma_f32_16x16x32_bf16 v[126:129], v[86:89], v[174:177], v[126:129]
    ds_read_b128 v[238:241], v2 offset:15360
    v_mul_f32 v191, v170, v191
    v_mfma_f32_16x16x32_bf16 v[114:117], v[90:93], v[118:121], 0
    ds_read_b128 v[118:121], v2 offset:16384
    v_cvt_pk_bf16_f32 v196, v190, v191
    v_mfma_f32_16x16x32_bf16 v[114:117], v[94:97], v[122:125], v[114:117]
    ds_read_b128 v[122:125], v2 offset:17408
    v_mul_f32 v192, v170, v192
    v_mfma_f32_16x16x32_bf16 v[114:117], v[98:101], v[150:153], v[114:117]
    v_fmac_f32 v255, v126, v126
    v_fmac_f32 v255, v127, v127
    v_mfma_f32_16x16x32_bf16 v[114:117], v[102:105], v[154:157], v[114:117]
    v_fmac_f32 v255, v128, v128
    v_fmac_f32 v255, v129, v129
    v_mfma_f32_16x16x32_bf16 v[114:117], v[106:109], v[158:161], v[114:117]
    s_waitcnt lgkmcnt(5)
    v_mul_f32 v193, v170, v193
    v_cvt_pk_bf16_f32 v197, v192, v193
    v_mfma_f32_16x16x32_bf16 v[114:117], v[110:113], v[174:177], v[114:117]
    s_waitcnt lgkmcnt(4)
    ds_write_b128 v3, v[194:197] offset:6144
    v_mfma_f32_16x16x32_bf16 v[242:245], a[216:219], v[202:205], 0
    s_waitcnt lgkmcnt(3)
    v_mul_f32 v146, v170, v146
    v_mul_f32 v147, v170, v147
    v_mfma_f32_16x16x32_bf16 v[242:245], a[220:223], v[230:233], v[242:245]
    s_waitcnt lgkmcnt(2)
    v_fmac_f32 v255, v114, v114
    v_fmac_f32 v255, v115, v115
    v_mfma_f32_16x16x32_bf16 v[242:245], a[224:227], v[234:237], v[242:245]
    s_waitcnt lgkmcnt(1)
    v_fmac_f32 v255, v116, v116
    v_fmac_f32 v255, v117, v117
    v_mfma_f32_16x16x32_bf16 v[242:245], a[228:231], v[238:241], v[242:245]
    v_cvt_pk_bf16_f32 v254, v254, v255
    v_cvt_pk_bf16_f32 v172, v146, v147
    v_mfma_f32_16x16x32_bf16 v[242:245], a[232:235], v[118:121], v[242:245]
    v_mul_f32 v148, v170, v148
    v_mul_f32 v149, v170, v149
    v_mfma_f32_16x16x32_bf16 v[242:245], a[236:239], v[122:125], v[242:245]
    v_cvt_pk_bf16_f32 v173, v148, v149
    v_cvt_pk_bf16_f32 v39, v252, 0
    v_mfma_f32_16x16x32_bf16 v[158:161], a[240:243], v[202:205], 0
    ds_write_b64 v4, v[172:173] offset:10240
    v_mfma_f32_16x16x32_bf16 v[158:161], a[244:247], v[230:233], v[158:161]
    v_exp_f32 v167, v167
    v_mfma_f32_16x16x32_bf16 v[158:161], a[248:251], v[234:237], v[158:161]
    v_cvt_pk_bf16_f32 v36, v166, v167
    v_fma_f32 v255, v242, v242, s33
    v_mfma_f32_16x16x32_bf16 v[158:161], a[252:255], v[238:241], v[158:161]
    v_fmac_f32 v255, v243, v243
    v_fmac_f32 v255, v244, v244
    v_mfma_f32_16x16x32_bf16 v[158:161], v[82:85], v[118:121], v[158:161]
    v_fmac_f32 v255, v245, v245
    v_xor_b32 v2, 65536, v2
    v_mfma_f32_16x16x32_bf16 v[158:161], v[86:89], v[122:125], v[158:161]
    v_exp_f32 v168, v168
    v_mfma_f32_16x16x32_bf16 v[154:157], v[90:93], v[202:205], 0
    v_exp_f32 v169, v169
    v_mfma_f32_16x16x32_bf16 v[154:157], v[94:97], v[230:233], v[154:157]
    ds_read_b128 v[146:149], v9
    v_cvt_pk_bf16_f32 v37, v168, v169
    v_mfma_f32_16x16x32_bf16 v[154:157], v[98:101], v[234:237], v[154:157]
    ds_read_b128 v[150:153], v9 offset:64
    v_fmac_f32 v255, v158, v158
    v_mfma_f32_16x16x32_bf16 v[166:169], v[28:31], v[36:39], 0
    v_fmac_f32 v255, v159, v159
    v_fmac_f32 v255, v160, v160
    v_mfma_f32_16x16x32_bf16 v[166:169], v[28:31], v[186:189], v[166:169]
    v_fmac_f32 v255, v161, v161
    v_add_u32 v6, s75, v6
    v_mfma_f32_16x16x32_bf16 v[174:177], v[162:165], v[36:39], 0
    v_rcp_f32 v182, v182
    v_mfma_f32_16x16x32_bf16 v[174:177], v[134:137], v[186:189], v[174:177]
    v_max3_u32 v25, v25, v182, v183
    v_max3_u32 v25, v25, v170, v171
    v_mfma_f32_16x16x32_bf16 v[170:173], v[210:213], v[36:39], 0
    v_rcp_f32 v166, v166
    v_mfma_f32_16x16x32_bf16 v[170:173], v[138:141], v[186:189], v[170:173]
    v_max3_u32 v25, v25, v166, v167
    v_mul_f32 v214, v182, v214
    v_mfma_f32_16x16x32_bf16 v[190:193], v[218:221], v[36:39], 0
    s_waitcnt lgkmcnt(1)
    v_mul_f32 v174, v166, v174
    v_mul_f32 v175, v166, v175
    v_mfma_f32_16x16x32_bf16 v[190:193], v[142:145], v[186:189], v[190:193]
    s_waitcnt lgkmcnt(0)
    v_cvt_pk_bf16_f32 v174, v174, v175
    v_mul_f32 v176, v166, v176
    v_mfma_f32_16x16x32_bf16 v[154:157], v[102:105], v[238:241], v[154:157]
    ds_read_b128 v[186:189], v0 offset:20480
    v_mul_f32 v177, v166, v177
    v_mfma_f32_16x16x32_bf16 v[154:157], v[106:109], v[118:121], v[154:157]
    ds_read_b128 v[194:197], v1 offset:20480
    v_cvt_pk_bf16_f32 v175, v176, v177
    v_mfma_f32_16x16x32_bf16 v[154:157], v[110:113], v[122:125], v[154:157]
    ds_read_b128 v[122:125], v0 offset:20608
    v_mul_f32 v170, v166, v170
    v_mfma_f32_16x16x32_bf16 v[118:121], v[146:149], v[28:31], 0
    ds_read_b128 v[202:205], v1 offset:20608
    v_mul_f32 v171, v166, v171
    v_mfma_f32_16x16x32_bf16 v[118:121], v[150:153], v[28:31], v[118:121]
    ds_read_b128 v[230:233], v0 offset:20736
    v_cvt_pk_bf16_f32 v176, v170, v171
    v_mfma_f32_16x16x32_bf16 v[234:237], v[146:149], v[134:137], 0
    ds_read_b128 v[238:241], v1 offset:20736
    v_fmac_f32 v255, v154, v154
    v_mfma_f32_16x16x32_bf16 v[234:237], v[150:153], v[162:165], v[234:237]
    v_fmac_f32 v255, v155, v155
    v_fmac_f32 v255, v156, v156
    v_mfma_f32_16x16x32_bf16 v[134:137], v[146:149], v[138:141], 0
    v_fmac_f32 v255, v157, v157
    v_cvt_pk_bf16_f32 v255, v255, v255
    v_mfma_f32_16x16x32_bf16 v[134:137], v[150:153], v[210:213], v[134:137]
    s_waitcnt lgkmcnt(5)
    ds_write_b64 v4, v[254:255] offset:18432
    v_mfma_f32_16x16x32_bf16 v[138:141], v[146:149], v[142:145], 0
    s_waitcnt lgkmcnt(4)
    v_mul_f32 v172, v166, v172
    v_mul_f32 v173, v166, v173
    v_mfma_f32_16x16x32_bf16 v[138:141], v[150:153], v[218:221], v[138:141]
    s_waitcnt lgkmcnt(3)
    v_cvt_pk_bf16_f32 v177, v172, v173
    v_mul_f32 v190, v166, v190
    v_mfma_f32_16x16x32_bf16 v[142:145], a[72:75], v[186:189], 0
    s_waitcnt lgkmcnt(2)
    ds_write_b128 v3, v[174:177] offset:12288
    v_mfma_f32_16x16x32_bf16 v[142:145], a[76:79], v[194:197], v[142:145]
    s_waitcnt lgkmcnt(2)
    v_mul_f32 v191, v166, v191
    v_cvt_pk_bf16_f32 v120, v190, v191
    v_mfma_f32_16x16x32_bf16 v[142:145], a[80:83], v[122:125], v[142:145]
    v_mul_f32 v192, v166, v192
    v_mul_f32 v193, v166, v193
    v_mfma_f32_16x16x32_bf16 v[142:145], a[84:87], v[202:205], v[142:145]
    v_cvt_pk_bf16_f32 v121, v192, v193
    v_mul_f32 v215, v182, v215
    v_mfma_f32_16x16x32_bf16 v[142:145], a[88:91], v[230:233], v[142:145]
    ds_write_b64 v4, v[120:121] offset:16384
    v_mfma_f32_16x16x32_bf16 v[142:145], a[92:95], v[238:241], v[142:145]
    v_rcp_f32 v118, v118
    v_mfma_f32_16x16x32_bf16 v[150:153], a[96:99], v[186:189], 0
    v_max3_u32 v25, v25, v118, v119
    v_mul_f32 v234, v234, v118
    v_mfma_f32_16x16x32_bf16 v[150:153], a[100:103], v[194:197], v[150:153]
    v_cvt_pk_bf16_f32 v146, v214, v215
    v_mul_f32_dpp v234, v134, v118 quad_perm:[0,1,2,3] row_mask:0x2 bank_mask:0xf
    v_mfma_f32_16x16x32_bf16 v[150:153], a[104:107], v[122:125], v[150:153]
    v_mul_f32 v216, v182, v216
    v_mul_f32_dpp v234, v138, v118 quad_perm:[0,1,2,3] row_mask:0x4 bank_mask:0xf
    v_mfma_f32_16x16x32_bf16 v[150:153], a[108:111], v[202:205], v[150:153]
    v_cvt_pk_bf16_f32 v234, v234, v234
    v_mul_f32 v217, v182, v217
    v_mfma_f32_16x16x32_bf16 v[150:153], a[112:115], v[230:233], v[150:153]
    ds_write_b16 v7, v234
    v_mfma_f32_16x16x32_bf16 v[150:153], a[116:119], v[238:241], v[150:153]
    v_cvt_pk_bf16_f32 v147, v216, v217
    v_mul_f32 v222, v182, v222
    v_mfma_f32_16x16x32_bf16 v[134:137], a[120:123], v[186:189], 0
    v_mul_f32 v223, v182, v223
    v_cvt_pk_bf16_f32 v148, v222, v223
    v_mfma_f32_16x16x32_bf16 v[134:137], a[124:127], v[194:197], v[134:137]
    v_mul_f32 v224, v182, v224
    v_mul_f32 v225, v182, v225
    v_mfma_f32_16x16x32_bf16 v[134:137], a[128:131], v[122:125], v[134:137]
    v_cvt_pk_bf16_f32 v149, v224, v225
    v_mul_f32 v226, v182, v226
    v_mfma_f32_16x16x32_bf16 v[134:137], a[132:135], v[202:205], v[134:137]
    ds_write_b128 v3, v[146:149] offset:0
    v_mfma_f32_16x16x32_bf16 v[134:137], a[136:139], v[230:233], v[134:137]
    v_mul_f32 v227, v182, v227
    v_cvt_pk_bf16_f32 v254, v226, v227
    v_mfma_f32_16x16x32_bf16 v[134:137], a[140:143], v[238:241], v[134:137]
    v_mul_f32 v228, v182, v228
    v_mul_f32 v229, v182, v229
    v_mfma_f32_16x16x32_bf16 v[138:141], a[0:3], v[186:189], 0
    v_cvt_pk_bf16_f32 v255, v228, v229
    v_xor_b32 v3, 65536, v3
    v_mfma_f32_16x16x32_bf16 v[138:141], a[4:7], v[194:197], v[138:141]
    ds_write_b64 v4, v[254:255] offset:4096
    v_mfma_f32_16x16x32_bf16 v[138:141], a[8:11], v[122:125], v[138:141]
    v_xor_b32 v4, 65536, v4
    v_add_u32 v7, s76, v7
    v_mfma_f32_16x16x32_bf16 v[138:141], a[12:15], v[202:205], v[138:141]
    v_cvt_pk_f16_f32 v146, v142, v143
    v_pk_mul_f16 v143, v146, v146
    v_mfma_f32_16x16x32_bf16 v[138:141], a[16:19], v[230:233], v[138:141]
    v_cvt_pk_f16_f32 v147, v144, v145
    v_pk_fma_f16 v143, v147, v147, v143
    v_mfma_f32_16x16x32_bf16 v[138:141], a[20:23], v[238:241], v[138:141]
    v_cvt_pk_f16_f32 v148, v150, v151
    v_pk_fma_f16 v143, v148, v148, v143
    v_mfma_f32_16x16x32_bf16 v[166:169], a[24:27], v[186:189], 0
    v_cvt_pk_f16_f32 v149, v152, v153
    v_pk_fma_f16 v143, v149, v149, v143
    v_mfma_f32_16x16x32_bf16 v[166:169], a[28:31], v[194:197], v[166:169]
    v_cvt_pk_f16_f32 v120, v134, v135
    v_pk_fma_f16 v143, v120, v120, v143
    v_mfma_f32_16x16x32_bf16 v[166:169], a[32:35], v[122:125], v[166:169]
    s_waitcnt lgkmcnt(0)
    v_cvt_pk_f16_f32 v121, v136, v137
    v_pk_fma_f16 v143, v121, v121, v143
    v_mfma_f32_16x16x32_bf16 v[166:169], a[36:39], v[202:205], v[166:169]
    s_nop 0
    v_mfma_f32_16x16x32_bf16 v[166:169], a[40:43], v[230:233], v[166:169]
    s_nop 0
    v_mfma_f32_16x16x32_bf16 v[166:169], a[44:47], v[238:241], v[166:169]
    s_nop 0
    v_mfma_f32_16x16x32_bf16 v[134:137], a[48:51], v[186:189], 0
    s_barrier
    v_mfma_f32_16x16x32_bf16 v[134:137], a[52:55], v[194:197], v[134:137]
    s_cbranch_scc1 L_loop_fast3
L_final_fast:
    v_mfma_f32_16x16x32_bf16 v[134:137], a[56:59], v[122:125], v[134:137]
    s_mov_b32 s12, s40
    ds_read_b128 v[150:153], v2 offset:18432
    ds_read_b128 v[162:165], v2 offset:19456
    v_mfma_f32_16x16x32_bf16 v[134:137], a[60:63], v[202:205], v[134:137]
    s_mov_b32 s13, s41
    ds_read_b128 v[170:173], v5 offset:32
    ds_read2_b64 v[174:177], v5 offset0:6 offset1:9
    v_mfma_f32_16x16x32_bf16 v[134:137], a[64:67], v[230:233], v[134:137]
    s_mov_b32 s14, s36
    v_cvt_pk_f16_f32 v138, v138, v139
    v_pk_mul_f16 v142, v138, v138
    v_mfma_f32_16x16x32_bf16 v[134:137], a[68:71], v[238:241], v[134:137]
    s_add_u32 s48, s40, s27
    ds_read_b128 v[182:185], v5
    ds_read_b32 v254, v6 offset:192
    v_mfma_f32_16x16x32_bf16 v[190:193], v[186:189], a[144:147], 0
    s_addc_u32 s49, s41, 0
    v_cvt_pk_f16_f32 v139, v140, v141
    v_pk_fma_f16 v142, v139, v139, v142
    v_mfma_f32_16x16x32_bf16 v[190:193], v[194:197], a[148:151], v[190:193]
    s_sub_u32 s50, s36, s27
    v_cvt_pk_f16_f32 v140, v166, v167
    v_pk_fma_f16 v142, v140, v140, v142
    v_mfma_f32_16x16x32_bf16 v[190:193], v[122:125], a[152:155], v[190:193]
    s_mov_b32 s51, 0x00020000
    v_cvt_pk_f16_f32 v141, v168, v169
    v_pk_fma_f16 v142, v141, v141, v142
    v_mfma_f32_16x16x32_bf16 v[190:193], v[202:205], a[156:159], v[190:193]
    s_waitcnt lgkmcnt(4)
    v_cvt_pk_f16_f32 v118, v134, v135
    v_pk_fma_f16 v142, v118, v118, v142
    v_mfma_f32_16x16x32_bf16 v[166:169], v[32:35], v[150:153], 0
    s_waitcnt lgkmcnt(2)
    v_cvt_pk_f16_f32 v119, v136, v137
    v_pk_fma_f16 v142, v119, v119, v142
    v_mfma_f32_16x16x32_bf16 v[166:169], v[32:35], v[162:165], v[166:169]
    s_add_u32 s52, s40, s26
    v_pk_mul_f16 v145, v146, v170
    v_pk_fma_f16 v145, v147, v171, v145
    v_mfma_f32_16x16x32_bf16 v[190:193], v[230:233], a[160:163], v[190:193]
    s_waitcnt lgkmcnt(0)
    v_mov_b32_dpp v254, v23 quad_perm:[0,1,2,3] row_mask:0x7 bank_mask:0xf
    v_pk_fma_f16 v145, v148, v172, v145
    v_mfma_f32_16x16x32_bf16 v[190:193], v[238:241], a[164:167], v[190:193]
    s_addc_u32 s53, s41, 0
    v_mul_f32 v144, 0x3baaaaab, v167
    v_mul_f32 v255, 0x3baaaaab, v166
    v_mfma_f32_16x16x32_bf16 v[134:137], v[186:189], a[168:171], 0
    s_sub_u32 s54, s36, s26
    v_rsq_f32 v144, v144
    v_mfma_f32_16x16x32_bf16 v[134:137], v[194:197], a[172:175], v[134:137]
    s_mov_b32 s55, 0x00020000
    v_mul_f32 v130, v144, v130
    v_mul_f32 v131, v144, v131
    v_mfma_f32_16x16x32_bf16 v[134:137], v[122:125], a[176:179], v[134:137]
    s_add_u32 s56, s40, s25
    v_cvt_pk_bf16_f32 v130, v130, v131
    v_mul_f32 v132, v144, v132
    v_mfma_f32_16x16x32_bf16 v[134:137], v[202:205], a[180:183], v[134:137]
    s_addc_u32 s57, s41, 0
    v_mul_f32 v133, v144, v133
    v_cvt_pk_bf16_f32 v131, v132, v133
    v_mfma_f32_16x16x32_bf16 v[134:137], v[230:233], a[184:187], v[134:137]
    s_sub_u32 s58, s36, s25
    ds_read_b128 v[150:153], v0 offset:26624
    v_mul_f32 v126, v144, v126
    v_mfma_f32_16x16x32_bf16 v[134:137], v[238:241], a[188:191], v[134:137]
    s_mov_b32 s59, 0x00020000
    ds_read_b128 v[162:165], v1 offset:26624
    v_mul_f32 v127, v144, v127
    v_mfma_f32_16x16x32_bf16 v[210:213], v[186:189], a[192:195], 0
    s_and_b32 s6, s2, 7
    ds_read_b128 v[186:189], v0 offset:26752
    v_cvt_pk_bf16_f32 v132, v126, v127
    v_mfma_f32_16x16x32_bf16 v[210:213], v[194:197], a[196:199], v[210:213]
    s_sub_u32 s6, 0, s6
    ds_read_b128 v[194:197], v1 offset:26752
    v_mul_f32 v128, v144, v128
    v_mfma_f32_16x16x32_bf16 v[210:213], v[122:125], a[200:203], v[210:213]
    s_lshl_b32 s3, s16, 6
    ds_read_b128 v[122:125], v0 offset:26880
    v_mul_f32 v129, v144, v129
    v_mfma_f32_16x16x32_bf16 v[210:213], v[202:205], a[204:207], v[210:213]
    s_lshl_b32 s4, s16, 5
    ds_read_b128 v[202:205], v1 offset:26880
    v_cvt_pk_bf16_f32 v133, v128, v129
    v_mfma_f32_16x16x32_bf16 v[210:213], v[230:233], a[208:211], v[210:213]
    buffer_store_dwordx4 v[130:133], v16, s[48:51], 0 offen nt
    v_mul_f32 v114, v144, v114
    v_mul_f32 v115, v144, v115
    v_cvt_pk_bf16_f32 v166, v114, v115
    v_mul_f32 v116, v144, v116
    v_mfma_f32_16x16x32_bf16 v[210:213], v[238:241], a[212:215], v[210:213]
    s_waitcnt lgkmcnt(4)
    v_mul_f32 v117, v144, v117
    v_cvt_pk_bf16_f32 v167, v116, v117
    v_mfma_f32_16x16x32_bf16 v[114:117], a[72:75], v[150:153], 0
    s_add_u32 s4, s4, 256
    ds_read_b128 v[126:129], v2 offset:0
    ds_read_b128 v[130:133], v2 offset:1024
    v_mfma_f32_16x16x32_bf16 v[114:117], a[76:79], v[162:165], v[114:117]
    s_waitcnt lgkmcnt(4)
    ds_read_b128 v[214:217], v2 offset:2048
    ds_read_b128 v[218:221], v2 offset:3072
    v_mfma_f32_16x16x32_bf16 v[114:117], a[80:83], v[186:189], v[114:117]
    s_mul_i32 s5, s16, 9408
    v_rsq_f32 v255, v255
    v_mfma_f32_16x16x32_bf16 v[114:117], a[84:87], v[194:197], v[114:117]
    s_waitcnt lgkmcnt(4)
    ds_read_b128 v[222:225], v2 offset:4096
    ds_read_b128 v[226:229], v2 offset:5120
    v_mfma_f32_16x16x32_bf16 v[114:117], a[88:91], v[122:125], v[114:117]
    s_add_u32 s5, s5, 104448
    v_mul_f32 v178, v255, v178
    v_mul_f32 v179, v255, v179
    v_mfma_f32_16x16x32_bf16 v[114:117], a[92:95], v[202:205], v[114:117]
    v_cvt_pk_bf16_f32 v178, v178, v179
    v_mul_f32 v180, v255, v180
    v_mfma_f32_16x16x32_bf16 v[230:233], a[96:99], v[150:153], 0
    v_mul_f32 v181, v255, v181
    v_cvt_pk_bf16_f32 v179, v180, v181
    v_mfma_f32_16x16x32_bf16 v[230:233], a[100:103], v[162:165], v[230:233]
    s_waitcnt lgkmcnt(4)
    v_mul_f32 v198, v255, v198
    v_mul_f32 v199, v255, v199
    v_mfma_f32_16x16x32_bf16 v[234:237], a[216:219], v[126:129], 0
    s_waitcnt lgkmcnt(2)
    v_cvt_pk_bf16_f32 v180, v198, v199
    v_mul_f32 v200, v255, v200
    v_mfma_f32_16x16x32_bf16 v[234:237], a[220:223], v[130:133], v[234:237]
    v_mul_f32 v201, v255, v201
    v_cvt_pk_bf16_f32 v181, v200, v201
    v_mfma_f32_16x16x32_bf16 v[234:237], a[224:227], v[214:217], v[234:237]
    s_waitcnt lgkmcnt(0)
    v_mul_f32 v206, v255, v206
    v_mul_f32 v207, v255, v207
    v_mfma_f32_16x16x32_bf16 v[234:237], a[228:231], v[218:221], v[234:237]
    v_cvt_pk_bf16_f32 v206, v206, v207
    v_mul_f32 v208, v255, v208
    v_mfma_f32_16x16x32_bf16 v[234:237], a[232:235], v[222:225], v[234:237]
    v_mul_f32 v209, v255, v209
    v_cvt_pk_bf16_f32 v207, v208, v209
    v_mfma_f32_16x16x32_bf16 v[234:237], a[236:239], v[226:229], v[234:237]
    v_pk_fma_f16 v145, v149, v173, v145
    v_pk_fma_f16 v145, v120, v176, v145
    v_mfma_f32_16x16x32_bf16 v[198:201], a[240:243], v[126:129], 0
    buffer_store_dwordx2 v[166:167], v19, s[48:51], 0 offen nt
    v_pk_fma_f16 v145, v121, v177, v145
    v_pk_mul_f16 v144, v138, v182
    v_mfma_f32_16x16x32_bf16 v[198:201], a[244:247], v[130:133], v[198:201]
    v_pk_fma_f16 v144, v139, v183, v144
    v_fma_f32 v255, v234, v234, s33
    v_mfma_f32_16x16x32_bf16 v[198:201], a[248:251], v[214:217], v[198:201]
    v_fmac_f32 v255, v235, v235
    v_fmac_f32 v255, v236, v236
    v_mfma_f32_16x16x32_bf16 v[198:201], a[252:255], v[218:221], v[198:201]
    v_fmac_f32 v255, v237, v237
    v_pk_fma_f16 v144, v140, v184, v144
    v_mfma_f32_16x16x32_bf16 v[198:201], v[82:85], v[222:225], v[198:201]
    v_pk_fma_f16 v144, v141, v185, v144
    v_pk_fma_f16 v144, v118, v174, v144
    v_mfma_f32_16x16x32_bf16 v[198:201], v[86:89], v[226:229], v[198:201]
    v_pk_fma_f16 v144, v119, v175, v144
    v_cvt_pk_bf16_f32 v166, v190, v191
    v_mfma_f32_16x16x32_bf16 v[230:233], a[104:107], v[186:189], v[230:233]
    v_cvt_pk_bf16_f32 v167, v192, v193
    v_cvt_pk_bf16_f32 v134, v134, v135
    v_mfma_f32_16x16x32_f16 v[190:193], v[40:43], v[142:145], 0
    v_cvt_pk_bf16_f32 v135, v136, v137
    v_cvt_pk_bf16_f32 v142, v210, v211
    v_mfma_f32_16x16x32_bf16 v[238:241], v[90:93], v[126:129], 0
    ds_read_b128 v[126:129], v2 offset:6144
    v_fmac_f32 v255, v198, v198
    v_mfma_f32_16x16x32_bf16 v[238:241], v[94:97], v[130:133], v[238:241]
    ds_read_b128 v[130:133], v2 offset:7168
    v_fmac_f32 v255, v199, v199
    v_mfma_f32_16x16x32_bf16 v[238:241], v[98:101], v[214:217], v[238:241]
    ds_read_b128 v[214:217], v2 offset:8192
    v_fmac_f32 v255, v200, v200
    v_mfma_f32_16x16x32_bf16 v[238:241], v[102:105], v[218:221], v[238:241]
    ds_read_b128 v[218:221], v2 offset:9216
    v_fmac_f32 v255, v201, v201
    v_mfma_f32_16x16x32_bf16 v[238:241], v[106:109], v[222:225], v[238:241]
    ds_read_b128 v[222:225], v2 offset:10240
    v_cvt_pk_bf16_f32 v143, v212, v213
    v_mfma_f32_16x16x32_bf16 v[238:241], v[110:113], v[226:229], v[238:241]
    ds_read_b128 v[210:213], v2 offset:11264
    v_cvt_pk_f16_f32 v114, v114, v115
    v_mfma_f32_16x16x32_bf16 v[230:233], a[108:111], v[194:197], v[230:233]
    v_rsq_f32 v190, v190
    v_mfma_f32_16x16x32_bf16 v[230:233], a[112:115], v[122:125], v[230:233]
    s_waitcnt lgkmcnt(5)
    v_rsq_f32 v191, v191
    v_mfma_f32_16x16x32_bf16 v[226:229], a[216:219], v[126:129], 0
    s_waitcnt lgkmcnt(4)
    buffer_store_dwordx4 v[178:181], v15, s[48:51], 0 offen nt
    v_fmac_f32 v255, v238, v238
    v_fmac_f32 v255, v239, v239
    v_fmac_f32 v255, v240, v240
    v_fmac_f32 v255, v241, v241
    v_mfma_f32_16x16x32_bf16 v[226:229], a[220:223], v[130:133], v[226:229]
    s_waitcnt lgkmcnt(2)
    v_mul_f32 v136, s31, v190
    v_cvt_pk_f16_f32 v137, v136, v191
    v_mfma_f32_16x16x32_bf16 v[226:229], a[224:227], v[214:217], v[226:229]
    s_waitcnt lgkmcnt(1)
    v_fma_f32 v192, v192, v136, v22
    v_fmac_f32_dpp v254, v193, v191 quad_perm:[0,1,2,3] row_mask:0x1 bank_mask:0xf
    v_mfma_f32_16x16x32_bf16 v[226:229], a[228:231], v[218:221], v[226:229]
    s_waitcnt lgkmcnt(0)
    v_pk_mul_f16 v146, v146, v137 op_sel:[0,1] op_sel_hi:[1,1]
    v_pk_mul_f16 v147, v147, v137 op_sel:[0,1] op_sel_hi:[1,1]
    v_mfma_f32_16x16x32_bf16 v[226:229], a[232:235], v[222:225], v[226:229]
    v_pk_mul_f16 v148, v148, v137 op_sel:[0,1] op_sel_hi:[1,1]
    v_pk_mul_f16 v149, v149, v137 op_sel:[0,1] op_sel_hi:[1,1]
    v_mfma_f32_16x16x32_bf16 v[226:229], a[236:239], v[210:213], v[226:229]
    v_pk_mul_f16 v120, v120, v137 op_sel:[0,1] op_sel_hi:[1,1]
    v_pk_mul_f16 v121, v121, v137 op_sel:[0,1] op_sel_hi:[1,1]
    v_mfma_f32_16x16x32_bf16 v[178:181], a[240:243], v[126:129], 0
    v_pk_mul_f16 v138, v138, v137 op_sel:[0,0] op_sel_hi:[1,0]
    v_pk_mul_f16 v139, v139, v137 op_sel:[0,0] op_sel_hi:[1,0]
    v_mfma_f32_16x16x32_bf16 v[178:181], a[244:247], v[130:133], v[178:181]
    v_pk_mul_f16 v140, v140, v137 op_sel:[0,0] op_sel_hi:[1,0]
    v_pk_mul_f16 v141, v141, v137 op_sel:[0,0] op_sel_hi:[1,0]
    v_mfma_f32_16x16x32_bf16 v[178:181], a[248:251], v[214:217], v[178:181]
    v_pk_mul_f16 v118, v118, v137 op_sel:[0,0] op_sel_hi:[1,0]
    v_pk_mul_f16 v119, v119, v137 op_sel:[0,0] op_sel_hi:[1,0]
    v_mfma_f32_16x16x32_bf16 v[178:181], a[252:255], v[218:221], v[178:181]
    v_max3_u32 v44, v44, v190, v191
    v_pk_mul_f16 v247, v114, v114
    v_mfma_f32_16x16x32_bf16 v[178:181], v[82:85], v[222:225], v[178:181]
    v_cvt_pk_f16_f32 v115, v116, v117
    v_pk_fma_f16 v247, v115, v115, v247
    v_mfma_f32_16x16x32_bf16 v[178:181], v[86:89], v[210:213], v[178:181]
    v_pk_mul_f16 v249, v114, v170
    v_pk_fma_f16 v249, v115, v171, v249
    v_mfma_f32_16x16x32_bf16 v[230:233], a[116:119], v[202:205], v[230:233]
    v_fma_f32 v169, v226, v226, s33
    v_fmac_f32 v169, v227, v227
    v_fmac_f32 v169, v228, v228
    v_fmac_f32 v169, v229, v229
    v_mul_f32 v168, 0x3baaaaab, v168
    v_fmac_f32 v169, v178, v178
    v_fmac_f32 v169, v179, v179
    v_fmac_f32 v169, v180, v180
    v_cvt_pk_f16_f32 v116, v230, v231
    v_pk_fma_f16 v247, v116, v116, v247
    v_cvt_pk_f16_f32 v117, v232, v233
    buffer_store_dwordx2 v[206:207], v18, s[48:51], 0 offen nt
    v_pk_fma_f16 v247, v117, v117, v247
    v_pk_fma_f16 v249, v116, v172, v249
    v_mfma_f32_16x16x32_bf16 v[230:233], v[90:93], v[126:129], 0
    v_pk_fma_f16 v249, v117, v173, v249
    v_fmac_f32 v169, v181, v181
    v_mfma_f32_16x16x32_bf16 v[230:233], v[94:97], v[130:133], v[230:233]
    v_rsq_f32 v168, v168
    v_mfma_f32_16x16x32_bf16 v[230:233], v[98:101], v[214:217], v[230:233]
    v_mul_f32 v242, v168, v242
    v_mul_f32 v243, v168, v243
    v_mfma_f32_16x16x32_bf16 v[230:233], v[102:105], v[218:221], v[230:233]
    v_cvt_pk_bf16_f32 v126, v242, v243
    v_mul_f32 v244, v168, v244
    v_mfma_f32_16x16x32_bf16 v[230:233], v[106:109], v[222:225], v[230:233]
    v_mul_f32 v245, v168, v245
    v_cvt_pk_bf16_f32 v127, v244, v245
    v_mfma_f32_16x16x32_bf16 v[230:233], v[110:113], v[210:213], v[230:233]
    v_mul_f32 v158, v168, v158
    v_mul_f32 v159, v168, v159
    v_mfma_f32_16x16x32_bf16 v[130:133], a[120:123], v[150:153], 0
    v_cvt_pk_bf16_f32 v128, v158, v159
    v_mul_f32 v160, v168, v160
    v_mfma_f32_16x16x32_bf16 v[130:133], a[124:127], v[162:165], v[130:133]
    v_mul_f32 v161, v168, v161
    v_cvt_pk_bf16_f32 v129, v160, v161
    v_mfma_f32_16x16x32_bf16 v[130:133], a[128:131], v[186:189], v[130:133]
    v_fmac_f32 v169, v230, v230
    v_fmac_f32 v169, v231, v231
    v_mfma_f32_16x16x32_bf16 v[130:133], a[132:135], v[194:197], v[130:133]
    v_fmac_f32 v169, v232, v232
    v_fmac_f32 v169, v233, v233
    v_mfma_f32_16x16x32_bf16 v[130:133], a[136:139], v[122:125], v[130:133]
    v_cvt_pk_bf16_f32 v136, v255, v169
    v_cvt_pk_bf16_f32 v137, v169, v169
    v_mfma_f32_16x16x32_bf16 v[130:133], a[140:143], v[202:205], v[130:133]
    v_mul_f32 v154, v168, v154
    v_mul_f32 v155, v168, v155
    v_mfma_f32_16x16x32_bf16 v[158:161], a[0:3], v[150:153], 0
    v_cvt_pk_bf16_f32 v144, v154, v155
    v_mul_f32 v156, v168, v156
    v_mfma_f32_16x16x32_bf16 v[158:161], a[4:7], v[162:165], v[158:161]
    v_mul_f32 v157, v168, v157
    v_cvt_pk_bf16_f32 v145, v156, v157
    v_mfma_f32_16x16x32_bf16 v[158:161], a[8:11], v[186:189], v[158:161]
    v_cvt_pk_f16_f32 v156, v130, v131
    v_pk_fma_f16 v247, v156, v156, v247
    v_mfma_f32_16x16x32_bf16 v[158:161], a[12:15], v[194:197], v[158:161]
    buffer_store_dwordx4 v[126:129], v17, s[48:51], 0 offen nt
    v_cvt_pk_f16_f32 v157, v132, v133
    v_pk_fma_f16 v247, v157, v157, v247
    v_pk_fma_f16 v249, v156, v176, v249
    v_pk_fma_f16 v249, v157, v177, v249
    v_mfma_f32_16x16x32_bf16 v[158:161], a[16:19], v[122:125], v[158:161]
    v_mov_b32 v255, 0x40000000
    v_bfe_u32 v190, v2, 4, 6
    v_mfma_f32_16x16x32_bf16 v[158:161], a[20:23], v[202:205], v[158:161]
    v_lshrrev_b32 v191, 4, v190
    v_and_b32 v193, 15, v190
    v_mfma_f32_16x16x32_bf16 v[126:129], a[24:27], v[150:153], 0
    v_add_u32 v154, 0, v193
    v_mul_u32_u24 v155, s20, v154
    v_mfma_f32_16x16x32_bf16 v[126:129], a[28:31], v[162:165], v[126:129]
    v_add_u32 v155, s38, v155
    v_mul_u32_u24 v168, 911, v155
    v_mfma_f32_16x16x32_bf16 v[126:129], a[32:35], v[186:189], v[126:129]
    v_cvt_pk_f16_f32 v130, v158, v159
    v_pk_mul_f16 v246, v130, v130
    v_mfma_f32_16x16x32_bf16 v[126:129], a[36:39], v[194:197], v[126:129]
    v_cvt_pk_f16_f32 v131, v160, v161
    v_pk_fma_f16 v246, v131, v131, v246
    v_mfma_f32_16x16x32_bf16 v[126:129], a[40:43], v[122:125], v[126:129]
    v_pk_mul_f16 v248, v130, v182
    v_pk_fma_f16 v248, v131, v183, v248
    v_mfma_f32_16x16x32_bf16 v[126:129], a[44:47], v[202:205], v[126:129]
    v_lshrrev_b32 v168, 16, v168
    v_mul_u32_u24 v168, s22, v168
    v_mfma_f32_16x16x32_bf16 v[158:161], a[48:51], v[150:153], 0
    v_mad_u32_u24 v168, v154, s21, v168
    v_bfe_u32 v155, s70, v154, 1
    v_mfma_f32_16x16x32_bf16 v[158:161], a[52:55], v[162:165], v[158:161]
    v_cmp_ne_u32 vcc, 0, v155
    v_add_u32 v154, s7, v168
    v_mfma_f32_16x16x32_bf16 v[158:161], a[56:59], v[186:189], v[158:161]
    v_cvt_pk_f16_f32 v132, v126, v127
    v_pk_fma_f16 v246, v132, v132, v246
    v_mfma_f32_16x16x32_bf16 v[158:161], a[60:63], v[194:197], v[158:161]
    v_cvt_pk_f16_f32 v133, v128, v129
    v_pk_fma_f16 v246, v133, v133, v246
    v_mfma_f32_16x16x32_bf16 v[158:161], a[64:67], v[122:125], v[158:161]
    v_pk_fma_f16 v248, v132, v184, v248
    v_pk_fma_f16 v248, v133, v185, v248
    v_mfma_f32_16x16x32_bf16 v[158:161], a[68:71], v[202:205], v[158:161]
    v_cndmask_b32 v154, v255, v154, vcc
    v_lshl_add_u32 v126, v191, 4, v154
    v_mfma_f32_16x16x32_bf16 v[206:209], v[150:153], a[144:147], 0
    v_add_u32 v126, s3, v126
    v_lshl_add_u32 v127, v191, 3, v154
    v_mfma_f32_16x16x32_bf16 v[206:209], v[162:165], a[148:151], v[206:209]
    buffer_store_dwordx2 v[144:145], v20, s[48:51], 0 offen nt
    v_add_u32 v127, s4, v127
    v_cvt_pk_f16_f32 v154, v158, v159
    v_mfma_f32_16x16x32_bf16 v[206:209], v[186:189], a[152:155], v[206:209]
    v_pk_fma_f16 v246, v154, v154, v246
    v_cvt_pk_f16_f32 v155, v160, v161
    v_mfma_f32_16x16x32_bf16 v[206:209], v[194:197], a[156:159], v[206:209]
    v_pk_fma_f16 v246, v155, v155, v246
    v_pk_fma_f16 v248, v154, v174, v248
    v_mfma_f32_16x16x32_bf16 v[206:209], v[122:125], a[160:163], v[206:209]
    v_pk_fma_f16 v248, v155, v175, v248
    v_lshlrev_b32 v128, 9, v191
    v_mfma_f32_16x16x32_bf16 v[206:209], v[202:205], a[164:167], v[206:209]
    v_lshl_add_u32 v128, v193, 4, v128
    v_add_u32 v128, 149696, v128
    v_mfma_f32_16x16x32_f16 v[158:161], v[40:43], v[246:249], 0
    v_and_b32 v129, 0xffff, v2
    v_add_u32 v129, 38912, v129
    v_mfma_f32_16x16x32_bf16 v[210:213], v[150:153], a[168:171], 0
    v_and_b32 v214, 0xffff, v4
    v_add_u32 v214, 38912, v214
    v_mfma_f32_16x16x32_bf16 v[210:213], v[162:165], a[172:175], v[210:213]
    ds_write_b64 v214, v[136:137] offset:0
    v_mfma_f32_16x16x32_bf16 v[210:213], v[186:189], a[176:179], v[210:213]
    v_cvt_pk_bf16_f32 v168, v206, v207
    v_cvt_pk_bf16_f32 v169, v208, v209
    v_mfma_f32_16x16x32_bf16 v[210:213], v[194:197], a[180:183], v[210:213]
    v_rsq_f32 v158, v158
    v_mfma_f32_16x16x32_bf16 v[210:213], v[122:125], a[184:187], v[210:213]
    ds_read_b128 v[206:209], v0 offset:32768
    v_mul_f32 v216, s31, v158
    v_mfma_f32_16x16x32_bf16 v[210:213], v[202:205], a[188:191], v[210:213]
    ds_read_b128 v[218:221], v1 offset:32768
    v_fma_f32 v160, v160, v216, v24
    v_mfma_f32_16x16x32_bf16 v[222:225], v[150:153], a[192:195], 0
    ds_read_b128 v[150:153], v0 offset:32896
    v_add_u32 v215, 16, v193
    v_mfma_f32_16x16x32_bf16 v[222:225], v[162:165], a[196:199], v[222:225]
    ds_read_b128 v[162:165], v1 offset:32896
    v_min_u32 v242, 20, v215
    v_mfma_f32_16x16x32_bf16 v[222:225], v[186:189], a[200:203], v[222:225]
    s_waitcnt lgkmcnt(4)
    ds_read_b128 v[186:189], v0 offset:33024
    v_cvt_pk_bf16_f32 v136, v210, v211
    v_mfma_f32_16x16x32_bf16 v[222:225], v[194:197], a[204:207], v[222:225]
    s_barrier
    ds_read_b128 v[194:197], v129 offset:0
    v_cvt_pk_bf16_f32 v137, v212, v213
    v_mfma_f32_16x16x32_bf16 v[222:225], v[122:125], a[208:211], v[222:225]
    ds_read_b128 v[122:125], v129 offset:1024
    v_add_u32 v243, 12, v215
    v_mfma_f32_16x16x32_bf16 v[222:225], v[202:205], a[212:215], v[222:225]
    s_waitcnt lgkmcnt(6)
    ds_read_b128 v[202:205], v1 offset:33024
    v_rsq_f32 v159, v159
    v_exp_f32 v192, v192
    v_cvt_pk_f16_f32 v217, v216, v159
    v_fmac_f32_dpp v254, v161, v159 quad_perm:[0,1,2,3] row_mask:0x2 bank_mask:0xf
    v_pk_mul_f16 v114, v114, v217 op_sel:[0,1] op_sel_hi:[1,1]
    v_pk_mul_f16 v115, v115, v217 op_sel:[0,1] op_sel_hi:[1,1]
    v_cvt_pk_bf16_f32 v144, v222, v223
    v_cvt_pk_bf16_f32 v145, v224, v225
    v_mfma_f32_16x16x32_bf16 v[210:213], a[72:75], v[206:209], 0
    s_waitcnt lgkmcnt(4)
    v_pk_mul_f16 v116, v116, v217 op_sel:[0,1] op_sel_hi:[1,1]
    v_pk_mul_f16 v117, v117, v217 op_sel:[0,1] op_sel_hi:[1,1]
    v_mfma_f32_16x16x32_bf16 v[210:213], a[76:79], v[218:221], v[210:213]
    s_waitcnt lgkmcnt(3)
    v_pk_mul_f16 v156, v156, v217 op_sel:[0,1] op_sel_hi:[1,1]
    v_pk_mul_f16 v157, v157, v217 op_sel:[0,1] op_sel_hi:[1,1]
    v_mfma_f32_16x16x32_bf16 v[210:213], a[80:83], v[150:153], v[210:213]
    s_waitcnt lgkmcnt(2)
    v_pk_mul_f16 v130, v130, v217 op_sel:[0,0] op_sel_hi:[1,0]
    v_pk_mul_f16 v131, v131, v217 op_sel:[0,0] op_sel_hi:[1,0]
    v_mfma_f32_16x16x32_bf16 v[210:213], a[84:87], v[162:165], v[210:213]
    s_waitcnt lgkmcnt(1)
    v_pk_mul_f16 v132, v132, v217 op_sel:[0,0] op_sel_hi:[1,0]
    v_pk_mul_f16 v133, v133, v217 op_sel:[0,0] op_sel_hi:[1,0]
    v_mfma_f32_16x16x32_bf16 v[210:213], a[88:91], v[186:189], v[210:213]
    s_waitcnt lgkmcnt(0)
    v_pk_mul_f16 v154, v154, v217 op_sel:[0,0] op_sel_hi:[1,0]
    v_pk_mul_f16 v155, v155, v217 op_sel:[0,0] op_sel_hi:[1,0]
    v_mfma_f32_16x16x32_bf16 v[210:213], a[92:95], v[202:205], v[210:213]
    v_max3_u32 v44, v44, v158, v159
    v_cvt_pk_bf16_f32 v39, v192, 0
    v_mfma_f32_16x16x32_bf16 v[222:225], v[32:35], v[194:197], 0
    v_exp_f32 v160, v160
    v_mfma_f32_16x16x32_bf16 v[222:225], v[32:35], v[122:125], v[222:225]
    v_lshrrev_b32 v243, 5, v243
    v_sub_u32 v192, v215, v242
    v_mfma_f32_16x16x32_bf16 v[122:125], a[96:99], v[206:209], 0
    v_cvt_pk_f16_f32 v194, v210, v211
    v_pk_mul_f16 v211, v194, v194
    v_mfma_f32_16x16x32_bf16 v[122:125], a[100:103], v[218:221], v[122:125]
    v_cvt_pk_f16_f32 v195, v212, v213
    v_pk_fma_f16 v211, v195, v195, v211
    v_mfma_f32_16x16x32_bf16 v[122:125], a[104:107], v[150:153], v[122:125]
    v_mul_f32 v196, 0x3baaaaab, v223
    v_mul_f32 v197, 0x3baaaaab, v222
    v_mfma_f32_16x16x32_bf16 v[122:125], a[108:111], v[162:165], v[122:125]
    v_rsq_f32 v196, v196
    v_mfma_f32_16x16x32_bf16 v[122:125], a[112:115], v[186:189], v[122:125]
    v_mul_f32 v226, v196, v226
    v_mul_f32 v227, v196, v227
    v_mfma_f32_16x16x32_bf16 v[122:125], a[116:119], v[202:205], v[122:125]
    v_cvt_pk_bf16_f32 v222, v226, v227
    v_mul_f32 v228, v196, v228
    v_mfma_f32_16x16x32_bf16 v[246:249], a[120:123], v[206:209], 0
    v_mul_f32 v229, v196, v229
    v_cvt_pk_bf16_f32 v223, v228, v229
    v_mfma_f32_16x16x32_bf16 v[246:249], a[124:127], v[218:221], v[246:249]
    v_mul_f32 v178, v196, v178
    v_mul_f32 v179, v196, v179
    v_mfma_f32_16x16x32_bf16 v[246:249], a[128:131], v[150:153], v[246:249]
    v_cvt_pk_bf16_f32 v224, v178, v179
    v_mul_f32 v180, v196, v180
    v_mfma_f32_16x16x32_bf16 v[246:249], a[132:135], v[162:165], v[246:249]
    v_mul_f32 v181, v196, v181
    v_cvt_pk_bf16_f32 v225, v180, v181
    v_mfma_f32_16x16x32_bf16 v[246:249], a[136:139], v[186:189], v[246:249]
    buffer_store_dwordx4 v[222:225], v16, s[52:55], 0 offen nt
    v_mul_f32 v230, v196, v230
    v_mul_f32 v231, v196, v231
    v_cvt_pk_bf16_f32 v216, v230, v231
    v_mul_f32 v232, v196, v232
    v_mfma_f32_16x16x32_bf16 v[246:249], a[140:143], v[202:205], v[246:249]
    v_mul_f32 v233, v196, v233
    v_cvt_pk_bf16_f32 v217, v232, v233
    v_mfma_f32_16x16x32_bf16 v[178:181], a[0:3], v[206:209], 0
    v_rsq_f32 v197, v197
    v_mfma_f32_16x16x32_bf16 v[178:181], a[4:7], v[218:221], v[178:181]
    v_mul_f32 v234, v197, v234
    v_mul_f32 v235, v197, v235
    v_mfma_f32_16x16x32_bf16 v[178:181], a[8:11], v[150:153], v[178:181]
    v_cvt_pk_bf16_f32 v222, v234, v235
    v_mul_f32 v236, v197, v236
    v_mfma_f32_16x16x32_bf16 v[178:181], a[12:15], v[162:165], v[178:181]
    v_mul_f32 v237, v197, v237
    v_cvt_pk_bf16_f32 v223, v236, v237
    v_mfma_f32_16x16x32_bf16 v[178:181], a[16:19], v[186:189], v[178:181]
    v_mul_f32 v198, v197, v198
    v_mul_f32 v199, v197, v199
    v_mfma_f32_16x16x32_bf16 v[178:181], a[20:23], v[202:205], v[178:181]
    v_cvt_pk_bf16_f32 v224, v198, v199
    v_mul_f32 v200, v197, v200
    v_mfma_f32_16x16x32_bf16 v[226:229], a[24:27], v[206:209], 0
    v_mul_f32 v201, v197, v201
    v_cvt_pk_bf16_f32 v225, v200, v201
    v_mfma_f32_16x16x32_bf16 v[226:229], a[28:31], v[218:221], v[226:229]
    v_mul_f32 v238, v197, v238
    v_mul_f32 v239, v197, v239
    v_mfma_f32_16x16x32_bf16 v[226:229], a[32:35], v[150:153], v[226:229]
    v_cvt_pk_bf16_f32 v244, v238, v239
    v_mul_f32 v240, v197, v240
    v_mfma_f32_16x16x32_bf16 v[226:229], a[36:39], v[162:165], v[226:229]
    v_mul_f32 v241, v197, v241
    v_cvt_pk_bf16_f32 v245, v240, v241
    v_mfma_f32_16x16x32_bf16 v[226:229], a[40:43], v[186:189], v[226:229]
    ds_read2_b32 v[200:201], v6 offset0:0 offset1:0
    ds_read2_b32 v[232:233], v6 offset0:16 offset1:16
    v_mfma_f32_16x16x32_bf16 v[226:229], a[44:47], v[202:205], v[226:229]
    ds_read2_b32 v[236:237], v6 offset0:32 offset1:32
    v_cvt_pk_f16_f32 v178, v178, v179
    v_mfma_f32_16x16x32_bf16 v[238:241], a[48:51], v[206:209], 0
    v_pk_mul_f16 v210, v178, v178
    v_cvt_pk_f16_f32 v179, v180, v181
    v_mfma_f32_16x16x32_bf16 v[238:241], a[52:55], v[218:221], v[238:241]
    v_pk_fma_f16 v210, v179, v179, v210
    v_pk_mul_f16 v212, v178, v182
    v_mfma_f32_16x16x32_bf16 v[238:241], a[56:59], v[150:153], v[238:241]
    buffer_store_dwordx2 v[216:217], v19, s[52:55], 0 offen nt
    v_cvt_pk_f16_f32 v180, v226, v227
    v_pk_fma_f16 v210, v180, v180, v210
    v_mfma_f32_16x16x32_bf16 v[238:241], a[60:63], v[162:165], v[238:241]
    v_cvt_pk_f16_f32 v181, v228, v229
    v_pk_fma_f16 v210, v181, v181, v210
    v_mfma_f32_16x16x32_bf16 v[238:241], a[64:67], v[186:189], v[238:241]
    v_pk_fma_f16 v212, v179, v183, v212
    v_pk_fma_f16 v212, v180, v184, v212
    v_mfma_f32_16x16x32_bf16 v[238:241], a[68:71], v[202:205], v[238:241]
    s_waitcnt lgkmcnt(1)
    v_pk_fma_f16 v212, v181, v185, v212
    v_cvt_pk_f16_f32 v196, v122, v123
    v_mfma_f32_16x16x32_bf16 v[182:185], v[206:209], a[144:147], 0
    s_waitcnt lgkmcnt(0)
    v_pk_fma_f16 v211, v196, v196, v211
    v_cvt_pk_f16_f32 v197, v124, v125
    v_mfma_f32_16x16x32_bf16 v[182:185], v[218:221], a[148:151], v[182:185]
    v_cvt_pk_f16_f32 v122, v238, v239
    v_pk_fma_f16 v210, v122, v122, v210
    v_mfma_f32_16x16x32_f16 v[226:229], v[146:149], v[138:141], v[46:49]
    v_cvt_pk_f16_f32 v123, v240, v241
    v_pk_fma_f16 v210, v123, v123, v210
    v_mfma_f32_16x16x32_f16 v[238:241], v[114:117], v[138:141], v[50:53]
    v_pk_fma_f16 v212, v122, v174, v212
    v_pk_fma_f16 v212, v123, v175, v212
    v_mfma_f32_16x16x32_bf16 v[182:185], v[150:153], a[152:155], v[182:185]
    v_pk_fma_f16 v211, v197, v197, v211
    v_cvt_pk_f16_f32 v124, v246, v247
    v_pk_fma_f16 v211, v124, v124, v211
    v_mfma_f32_16x16x16_f16 v[226:229], v[120:121], v[118:119], v[226:229]
    v_cvt_pk_f16_f32 v125, v248, v249
    v_pk_fma_f16 v211, v125, v125, v211
    v_pk_mul_f16 v213, v194, v170
    v_mfma_f32_16x16x16_f16 v[238:241], v[156:157], v[118:119], v[238:241]
    v_pk_fma_f16 v213, v195, v171, v213
    v_pk_fma_f16 v213, v196, v172, v213
    v_pk_fma_f16 v213, v197, v173, v213
    v_pk_fma_f16 v213, v124, v176, v213
    v_mfma_f32_16x16x32_bf16 v[182:185], v[162:165], a[156:159], v[182:185]
    v_pk_fma_f16 v213, v125, v177, v213
    v_mad_i32_i24 v192, v243, s6, v192
    v_mfma_f32_16x16x32_bf16 v[182:185], v[186:189], a[160:163], v[182:185]
    v_exp_f32 v226, v226
    v_mfma_f32_16x16x32_f16 v[170:173], v[40:43], v[210:213], 0
    v_exp_f32 v227, v227
    v_mfma_f32_16x16x32_bf16 v[182:185], v[202:205], a[164:167], v[182:185]
    v_cvt_pk_bf16_f32 v174, v226, v227
    v_mul_u32_u24 v216, s20, v242
    v_mfma_f32_16x16x32_bf16 v[210:213], v[206:209], a[168:171], 0
    v_exp_f32 v228, v228
    v_mfma_f32_16x16x32_bf16 v[210:213], v[218:221], a[172:175], v[210:213]
    buffer_store_dwordx4 v[222:225], v15, s[52:55], 0 offen nt
    v_rsq_f32 v170, v170
    v_rsq_f32 v171, v171
    v_mfma_f32_16x16x32_bf16 v[210:213], v[150:153], a[176:179], v[210:213]
    v_cvt_pk_bf16_f32 v198, v182, v183
    v_cvt_pk_bf16_f32 v199, v184, v185
    v_mfma_f32_16x16x32_bf16 v[210:213], v[162:165], a[180:183], v[210:213]
    ds_read_b128 v[182:185], v2 offset:12288
    ds_read_b128 v[222:225], v2 offset:13312
    v_mfma_f32_16x16x32_bf16 v[210:213], v[186:189], a[184:187], v[210:213]
    ds_read_b128 v[246:249], v2 offset:14336
    v_mul_f32 v226, s31, v170
    v_mfma_f32_16x16x32_bf16 v[210:213], v[202:205], a[188:191], v[210:213]
    v_cvt_pk_f16_f32 v227, v226, v171
    v_fma_f32 v172, v172, v226, v26
    v_fmac_f32_dpp v254, v173, v171 quad_perm:[0,1,2,3] row_mask:0x4 bank_mask:0xf
    v_exp_f32 v254, v254
    v_pk_mul_f16 v194, v194, v227 op_sel:[0,1] op_sel_hi:[1,1]
    v_cvt_pk_bf16_f32 v254, v254, v254
    ds_write_b16 v8, v254
    v_pk_mul_f16 v195, v195, v227 op_sel:[0,1] op_sel_hi:[1,1]
    v_cvt_pk_bf16_f32 v230, v210, v211
    v_mfma_f32_16x16x32_bf16 v[250:253], v[206:209], a[192:195], 0
    ds_read_b128 v[206:209], v2 offset:15360
    v_cvt_pk_bf16_f32 v231, v212, v213
    v_mfma_f32_16x16x32_bf16 v[250:253], v[218:221], a[196:199], v[250:253]
    s_waitcnt lgkmcnt(3)
    ds_read_b128 v[210:213], v2 offset:16384
    v_pk_mul_f16 v196, v196, v227 op_sel:[0,1] op_sel_hi:[1,1]
    v_mfma_f32_16x16x32_bf16 v[250:253], v[150:153], a[200:203], v[250:253]
    s_waitcnt lgkmcnt(3)
    ds_read_b128 v[150:153], v2 offset:17408
    v_pk_mul_f16 v197, v197, v227 op_sel:[0,1] op_sel_hi:[1,1]
    v_mfma_f32_16x16x32_bf16 v[250:253], v[162:165], a[204:207], v[250:253]
    v_pk_mul_f16 v124, v124, v227 op_sel:[0,1] op_sel_hi:[1,1]
    v_pk_mul_f16 v125, v125, v227 op_sel:[0,1] op_sel_hi:[1,1]
    v_mfma_f32_16x16x32_f16 v[162:165], v[194:197], v[138:141], v[54:57]
    v_pk_mul_f16 v178, v178, v227 op_sel:[0,0] op_sel_hi:[1,0]
    v_pk_mul_f16 v179, v179, v227 op_sel:[0,0] op_sel_hi:[1,0]
    v_mfma_f32_16x16x32_bf16 v[250:253], v[186:189], a[208:211], v[250:253]
    v_pk_mul_f16 v180, v180, v227 op_sel:[0,0] op_sel_hi:[1,0]
    v_pk_mul_f16 v181, v181, v227 op_sel:[0,0] op_sel_hi:[1,0]
    v_mfma_f32_16x16x32_bf16 v[250:253], v[202:205], a[212:215], v[250:253]
    v_pk_mul_f16 v122, v122, v227 op_sel:[0,0] op_sel_hi:[1,0]
    v_pk_mul_f16 v123, v123, v227 op_sel:[0,0] op_sel_hi:[1,0]
    v_max3_u32 v44, v44, v170, v171
    v_mfma_f32_16x16x16_f16 v[162:165], v[124:125], v[118:119], v[162:165]
    v_exp_f32 v229, v229
    v_exp_f32 v238, v238
    v_mfma_f32_16x16x32_bf16 v[138:141], a[216:219], v[182:185], 0
    s_waitcnt lgkmcnt(0)
    buffer_store_dwordx2 v[244:245], v18, s[52:55], 0 offen nt
    v_cvt_pk_bf16_f32 v234, v250, v251
    v_cvt_pk_bf16_f32 v235, v252, v253
    v_mfma_f32_16x16x32_bf16 v[138:141], a[220:223], v[222:225], v[138:141]
    v_cvt_pk_bf16_f32 v175, v228, v229
    v_sub_u32 v254, 0x40800000, v44
    v_mfma_f32_16x16x32_bf16 v[138:141], a[224:227], v[246:249], v[138:141]
    v_exp_f32 v239, v239
    v_mfma_f32_16x16x32_bf16 v[138:141], a[228:231], v[206:209], v[138:141]
    v_cvt_pk_bf16_f32 v176, v238, v239
    v_or_b32 v254, v254, v44
    v_mfma_f32_16x16x32_bf16 v[138:141], a[232:235], v[210:213], v[138:141]
    v_exp_f32 v240, v240
    v_mfma_f32_16x16x32_bf16 v[138:141], a[236:239], v[150:153], v[138:141]
    v_exp_f32 v241, v241
    v_mfma_f32_16x16x32_f16 v[186:189], v[146:149], v[130:133], v[58:61]
    v_cvt_pk_bf16_f32 v177, v240, v241
    v_add3_u32 v216, v216, v192, s38
    v_mfma_f32_16x16x32_bf16 v[202:205], a[240:243], v[182:185], 0
    v_exp_f32 v162, v162
    v_mfma_f32_16x16x32_bf16 v[202:205], a[244:247], v[222:225], v[202:205]
    v_exp_f32 v163, v163
    v_mfma_f32_16x16x32_f16 v[218:221], v[114:117], v[130:133], v[62:65]
    v_cvt_pk_bf16_f32 v36, v162, v163
    v_exp_f32 v164, v164
    v_mfma_f32_16x16x16_f16 v[186:189], v[120:121], v[154:155], v[186:189]
    v_exp_f32 v165, v165
    v_fma_f32 v217, v138, v138, s33
    v_cvt_pk_bf16_f32 v37, v164, v165
    v_mfma_f32_16x16x32_f16 v[162:165], v[194:197], v[130:133], v[66:69]
    v_fmac_f32 v217, v139, v139
    v_fmac_f32 v217, v140, v140
    v_mfma_f32_16x16x32_bf16 v[130:133], v[28:31], v[36:39], 0
    v_fmac_f32 v217, v141, v141
    v_mul_u32_u24 v243, 911, v216
    v_mfma_f32_16x16x32_bf16 v[130:133], v[28:31], v[174:177], v[130:133]
    v_exp_f32 v172, v172
    v_mfma_f32_16x16x32_bf16 v[226:229], v[198:201], v[36:39], 0
    v_exp_f32 v186, v186
    v_mfma_f32_16x16x32_bf16 v[226:229], v[166:169], v[174:177], v[226:229]
    v_exp_f32 v187, v187
    v_mfma_f32_16x16x32_bf16 v[238:241], v[230:233], v[36:39], 0
    v_cvt_pk_bf16_f32 v158, v186, v187
    v_lshrrev_b32 v243, 16, v243
    v_mfma_f32_16x16x32_bf16 v[238:241], v[134:137], v[174:177], v[238:241]
    v_rcp_f32 v130, v130
    v_mul_u32_u24 v243, s22, v243
    v_mfma_f32_16x16x16_f16 v[218:221], v[156:157], v[154:155], v[218:221]
    v_max3_u32 v25, v25, v130, v131
    v_mul_f32 v226, v130, v226
    v_mul_f32 v227, v130, v227
    v_mfma_f32_16x16x16_f16 v[162:165], v[124:125], v[154:155], v[162:165]
    v_cvt_pk_bf16_f32 v226, v226, v227
    v_mul_f32 v228, v130, v228
    v_mul_f32 v229, v130, v229
    v_cvt_pk_bf16_f32 v227, v228, v229
    v_mfma_f32_16x16x32_bf16 v[250:253], v[234:237], v[36:39], 0
    v_mul_f32 v238, v130, v238
    v_mul_f32 v239, v130, v239
    v_mfma_f32_16x16x32_bf16 v[250:253], v[142:145], v[174:177], v[250:253]
    v_cvt_pk_bf16_f32 v228, v238, v239
    v_mul_f32 v240, v130, v240
    v_mfma_f32_16x16x32_bf16 v[202:205], a[248:251], v[246:249], v[202:205]
    v_mul_f32 v241, v130, v241
    v_cvt_pk_bf16_f32 v229, v240, v241
    v_mfma_f32_16x16x32_bf16 v[202:205], a[252:255], v[206:209], v[202:205]
    ds_write_b128 v3, v[226:229] offset:0
    v_mfma_f32_16x16x32_bf16 v[202:205], v[82:85], v[210:213], v[202:205]
    v_mul_f32 v250, v130, v250
    v_mul_f32 v251, v130, v251
    v_mfma_f32_16x16x32_bf16 v[202:205], v[86:89], v[150:153], v[202:205]
    v_cvt_pk_bf16_f32 v118, v250, v251
    v_mul_f32 v252, v130, v252
    v_mfma_f32_16x16x32_bf16 v[174:177], v[90:93], v[182:185], 0
    ds_read_b128 v[182:185], v128 offset:0
    v_mul_f32 v253, v130, v253
    v_mfma_f32_16x16x32_bf16 v[174:177], v[94:97], v[222:225], v[174:177]
    ds_read_b128 v[130:133], v128 offset:2048
    v_cvt_pk_bf16_f32 v119, v252, v253
    v_mfma_f32_16x16x32_bf16 v[174:177], v[98:101], v[246:249], v[174:177]
    ds_read_b128 v[222:225], v128 offset:4096
    v_fmac_f32 v217, v202, v202
    v_mfma_f32_16x16x32_bf16 v[174:177], v[102:105], v[206:209], v[174:177]
    ds_read_b128 v[206:209], v128 offset:6144
    v_fmac_f32 v217, v203, v203
    v_mfma_f32_16x16x32_bf16 v[174:177], v[106:109], v[210:213], v[174:177]
    ds_read_b128 v[210:213], v128 offset:8192
    v_fmac_f32 v217, v204, v204
    v_mfma_f32_16x16x32_bf16 v[174:177], v[110:113], v[150:153], v[174:177]
    ds_read_b128 v[150:153], v128 offset:10240
    ds_write_b64 v4, v[118:119] offset:4096
    v_fmac_f32 v217, v205, v205
    s_waitcnt lgkmcnt(6)
    v_mfma_f32_16x16x32_bf16 v[226:229], a[216:219], v[182:185], 0
    v_exp_f32 v188, v188
    v_mfma_f32_16x16x32_bf16 v[238:241], a[240:243], v[182:185], 0
    s_waitcnt lgkmcnt(5)
    v_fmac_f32 v217, v174, v174
    v_fmac_f32 v217, v175, v175
    v_mfma_f32_16x16x32_bf16 v[226:229], a[220:223], v[130:133], v[226:229]
    s_waitcnt lgkmcnt(4)
    v_fmac_f32 v217, v176, v176
    v_fmac_f32 v217, v177, v177
    v_mfma_f32_16x16x32_bf16 v[226:229], a[224:227], v[222:225], v[226:229]
    s_waitcnt lgkmcnt(3)
    v_exp_f32 v189, v189
    v_mfma_f32_16x16x32_bf16 v[226:229], a[228:231], v[206:209], v[226:229]
    s_waitcnt lgkmcnt(2)
    v_cvt_pk_bf16_f32 v159, v188, v189
    v_cvt_pk_bf16_f32 v39, v160, 0
    v_mfma_f32_16x16x32_bf16 v[226:229], a[232:235], v[210:213], v[226:229]
    s_waitcnt lgkmcnt(0)
    v_exp_f32 v218, v218
    v_mfma_f32_16x16x32_f16 v[186:189], v[146:149], v[178:181], v[70:73]
    v_exp_f32 v219, v219
    v_mfma_f32_16x16x32_bf16 v[226:229], a[236:239], v[150:153], v[226:229]
    v_cvt_pk_bf16_f32 v160, v218, v219
    v_mad_u32_u24 v243, v242, s21, v243
    v_mfma_f32_16x16x32_bf16 v[238:241], a[244:247], v[130:133], v[238:241]
    v_exp_f32 v220, v220
    v_mfma_f32_16x16x32_f16 v[146:149], v[114:117], v[178:181], v[74:77]
    v_exp_f32 v221, v221
    v_bfe_u32 v216, s70, v215, 1
    v_mfma_f32_16x16x16_f16 v[186:189], v[120:121], v[122:123], v[186:189]
    v_fma_f32 v215, v226, v226, s33
    v_fmac_f32 v215, v227, v227
    v_fmac_f32 v215, v228, v228
    v_mfma_f32_16x16x16_f16 v[146:149], v[156:157], v[122:123], v[146:149]
    v_fmac_f32 v215, v229, v229
    v_cvt_pk_bf16_f32 v161, v220, v221
    v_exp_f32 v162, v162
    v_mfma_f32_16x16x32_f16 v[114:117], v[194:197], v[178:181], v[78:81]
    v_exp_f32 v186, v186
    v_mfma_f32_16x16x32_bf16 v[238:241], a[248:251], v[222:225], v[238:241]
    v_exp_f32 v187, v187
    v_mfma_f32_16x16x32_bf16 v[238:241], a[252:255], v[206:209], v[238:241]
    v_cvt_pk_bf16_f32 v118, v186, v187
    v_cmp_ne_u32 vcc, 0, v216
    v_mul_i32_i24 v192, 2688, v192
    v_mfma_f32_16x16x16_f16 v[114:117], v[124:125], v[122:123], v[114:117]
    v_exp_f32 v188, v188
    v_exp_f32 v189, v189
    v_mfma_f32_16x16x32_bf16 v[238:241], v[82:85], v[210:213], v[238:241]
    v_cvt_pk_bf16_f32 v119, v188, v189
    v_add3_u32 v192, v243, v192, s7
    v_mfma_f32_16x16x32_bf16 v[238:241], v[86:89], v[150:153], v[238:241]
    v_exp_f32 v146, v146
    v_mfma_f32_16x16x32_bf16 v[122:125], v[90:93], v[182:185], 0
    v_exp_f32 v147, v147
    v_mfma_f32_16x16x32_bf16 v[122:125], v[94:97], v[130:133], v[122:125]
    v_cvt_pk_bf16_f32 v120, v146, v147
    v_cndmask_b32 v192, v255, v192, vcc
    v_mfma_f32_16x16x32_bf16 v[122:125], v[98:101], v[222:225], v[122:125]
    v_exp_f32 v148, v148
    v_mfma_f32_16x16x32_bf16 v[122:125], v[102:105], v[206:209], v[122:125]
    v_fmac_f32 v215, v238, v238
    v_fmac_f32 v215, v239, v239
    v_mfma_f32_16x16x32_bf16 v[122:125], v[106:109], v[210:213], v[122:125]
    v_fmac_f32 v215, v240, v240
    v_fmac_f32 v215, v241, v241
    v_mfma_f32_16x16x32_bf16 v[122:125], v[110:113], v[150:153], v[122:125]
    v_exp_f32 v149, v149
    v_exp_f32 v114, v114
    ds_read_b128 v[130:133], v9
    ds_read_b128 v[150:153], v9 offset:64
    v_cvt_pk_bf16_f32 v121, v148, v149
    v_exp_f32 v115, v115
    v_exp_f32 v116, v116
    v_exp_f32 v117, v117
    v_fmac_f32 v215, v122, v122
    v_fmac_f32 v215, v123, v123
    v_fmac_f32 v215, v124, v124
    v_fmac_f32 v215, v125, v125
    v_cvt_pk_bf16_f32 v216, v217, v215
    v_cvt_pk_bf16_f32 v217, v215, v215
    ds_write_b64 v214, v[216:217] offset:2048
    v_exp_f32 v163, v163
    v_exp_f32 v164, v164
    v_cvt_pk_bf16_f32 v36, v162, v163
    s_waitcnt lgkmcnt(2)
    v_mfma_f32_16x16x32_bf16 v[146:149], v[130:133], v[28:31], 0
    s_waitcnt lgkmcnt(1)
    v_exp_f32 v165, v165
    v_mfma_f32_16x16x32_bf16 v[146:149], v[150:153], v[28:31], v[146:149]
    v_cvt_pk_bf16_f32 v37, v164, v165
    v_lshl_add_u32 v255, v191, 4, v192
    v_mfma_f32_16x16x32_bf16 v[154:157], v[130:133], v[166:169], 0
    v_add_u32 v255, s3, v255
    v_lshl_add_u32 v192, v191, 3, v192
    v_mfma_f32_16x16x32_bf16 v[162:165], v[28:31], v[36:39], 0
    v_add_u32 v192, s4, v192
    v_xor_b32 v215, 65536, v2
    v_mfma_f32_16x16x32_bf16 v[162:165], v[28:31], v[158:161], v[162:165]
    s_waitcnt lgkmcnt(0)
    v_rcp_f32 v146, v146
    v_mfma_f32_16x16x32_bf16 v[178:181], v[198:201], v[36:39], 0
    s_barrier
    ds_read_b128 v[182:185], v129 offset:2048
    ds_read_b128 v[186:189], v129 offset:3072
    v_mfma_f32_16x16x32_bf16 v[178:181], v[166:169], v[158:161], v[178:181]
    s_barrier
    ds_read_b128 v[194:197], v215 offset:0
    ds_read_b128 v[206:209], v215 offset:1024
    v_mfma_f32_16x16x32_bf16 v[210:213], v[230:233], v[36:39], 0
    v_rcp_f32 v162, v162
    v_mfma_f32_16x16x32_bf16 v[210:213], v[134:137], v[158:161], v[210:213]
    ds_read_b128 v[218:221], v215 offset:2048
    ds_read_b128 v[222:225], v215 offset:3072
    v_mfma_f32_16x16x32_bf16 v[242:245], v[234:237], v[36:39], 0
    v_cvt_pk_bf16_f32 v36, v114, v115
    v_cvt_pk_bf16_f32 v37, v116, v117
    v_mfma_f32_16x16x32_bf16 v[242:245], v[142:145], v[158:161], v[242:245]
    ds_read_b128 v[114:117], v215 offset:4096
    ds_read_b128 v[158:161], v215 offset:5120
    v_mfma_f32_16x16x32_bf16 v[154:157], v[150:153], v[198:201], v[154:157]
    v_cvt_pk_bf16_f32 v39, v172, 0
    v_max3_u32 v25, v25, v162, v163
    v_mfma_f32_16x16x32_bf16 v[170:173], v[130:133], v[134:137], 0
    s_waitcnt lgkmcnt(6)
    v_mul_f32 v178, v162, v178
    v_mul_f32 v179, v162, v179
    v_mfma_f32_16x16x32_bf16 v[170:173], v[150:153], v[230:233], v[170:173]
    s_waitcnt lgkmcnt(4)
    v_cvt_pk_bf16_f32 v178, v178, v179
    v_mul_f32 v180, v162, v180
    v_mfma_f32_16x16x32_bf16 v[246:249], v[32:35], v[182:185], 0
    v_mul_f32 v181, v162, v181
    v_cvt_pk_bf16_f32 v179, v180, v181
    v_mfma_f32_16x16x32_bf16 v[246:249], v[32:35], v[186:189], v[246:249]
    s_waitcnt lgkmcnt(2)
    v_mul_f32 v210, v162, v210
    v_mul_f32 v211, v162, v211
    v_mfma_f32_16x16x32_bf16 v[182:185], a[216:219], v[194:197], 0
    v_cvt_pk_bf16_f32 v180, v210, v211
    v_mul_f32 v212, v162, v212
    v_mfma_f32_16x16x32_bf16 v[182:185], a[220:223], v[206:209], v[182:185]
    s_waitcnt lgkmcnt(0)
    v_mul_f32 v213, v162, v213
    v_cvt_pk_bf16_f32 v181, v212, v213
    v_mfma_f32_16x16x32_bf16 v[182:185], a[224:227], v[218:221], v[182:185]
    ds_write_b128 v3, v[178:181] offset:6144
    v_mfma_f32_16x16x32_bf16 v[182:185], a[228:231], v[222:225], v[182:185]
    v_mul_f32 v242, v162, v242
    v_mul_f32 v243, v162, v243
    v_mfma_f32_16x16x32_bf16 v[182:185], a[232:235], v[114:117], v[182:185]
    v_cvt_pk_bf16_f32 v148, v242, v243
    v_mul_f32 v244, v162, v244
    v_mfma_f32_16x16x32_bf16 v[182:185], a[236:239], v[158:161], v[182:185]
    v_mul_f32 v245, v162, v245
    v_cvt_pk_bf16_f32 v149, v244, v245
    v_mfma_f32_16x16x32_bf16 v[162:165], a[240:243], v[194:197], 0
    ds_write_b64 v4, v[148:149] offset:10240
    v_mfma_f32_16x16x32_bf16 v[162:165], a[244:247], v[206:209], v[162:165]
    v_mul_f32 v148, 0x3baaaaab, v247
    v_mul_f32 v154, v154, v146
    v_mfma_f32_16x16x32_bf16 v[162:165], a[248:251], v[218:221], v[162:165]
    v_fma_f32 v149, v182, v182, s33
    v_fmac_f32 v149, v183, v183
    v_mfma_f32_16x16x32_bf16 v[162:165], a[252:255], v[222:225], v[162:165]
    v_fmac_f32 v149, v184, v184
    v_fmac_f32 v149, v185, v185
    v_mfma_f32_16x16x32_bf16 v[162:165], v[82:85], v[114:117], v[162:165]
    v_rsq_f32 v148, v148
    v_mfma_f32_16x16x32_bf16 v[162:165], v[86:89], v[158:161], v[162:165]
    v_mul_f32 v226, v148, v226
    v_mul_f32 v227, v148, v227
    v_mfma_f32_16x16x32_bf16 v[178:181], v[90:93], v[194:197], 0
    v_cvt_pk_bf16_f32 v186, v226, v227
    v_mul_f32 v228, v148, v228
    v_mfma_f32_16x16x32_bf16 v[178:181], v[94:97], v[206:209], v[178:181]
    v_mul_f32 v229, v148, v229
    v_cvt_pk_bf16_f32 v187, v228, v229
    v_mfma_f32_16x16x32_bf16 v[178:181], v[98:101], v[218:221], v[178:181]
    v_fmac_f32 v149, v162, v162
    v_fmac_f32 v149, v163, v163
    v_mfma_f32_16x16x32_bf16 v[178:181], v[102:105], v[222:225], v[178:181]
    v_fmac_f32 v149, v164, v164
    v_fmac_f32 v149, v165, v165
    v_mfma_f32_16x16x32_bf16 v[178:181], v[106:109], v[114:117], v[178:181]
    v_mul_f32 v238, v148, v238
    v_mul_f32 v239, v148, v239
    v_mfma_f32_16x16x32_bf16 v[178:181], v[110:113], v[158:161], v[178:181]
    v_cvt_pk_bf16_f32 v188, v238, v239
    v_mul_f32 v240, v148, v240
    v_mfma_f32_16x16x32_bf16 v[114:117], v[130:133], v[142:145], 0
    v_mul_f32 v241, v148, v241
    v_cvt_pk_bf16_f32 v189, v240, v241
    v_mfma_f32_16x16x32_bf16 v[114:117], v[150:153], v[234:237], v[114:117]
    buffer_store_dwordx4 v[186:189], v126, s[12:15], 0 offen nt
    v_mul_f32 v122, v148, v122
    v_fmac_f32 v149, v178, v178
    v_fmac_f32 v149, v179, v179
    v_fmac_f32 v149, v180, v180
    v_mfma_f32_16x16x32_bf16 v[130:133], v[28:31], v[36:39], 0
    v_fmac_f32 v149, v181, v181
    v_cvt_pk_bf16_f32 v216, v149, v149
    v_mfma_f32_16x16x32_bf16 v[130:133], v[28:31], v[118:121], v[130:133]
    v_cvt_pk_bf16_f32 v217, v149, v149
    v_mul_f32 v123, v148, v123
    v_mfma_f32_16x16x32_bf16 v[150:153], v[198:201], v[36:39], 0
    ds_write_b64 v214, v[216:217] offset:7616
    v_mfma_f32_16x16x32_bf16 v[150:153], v[166:169], v[118:121], v[150:153]
    v_cvt_pk_bf16_f32 v216, v122, v123
    v_mul_f32 v124, v148, v124
    v_mfma_f32_16x16x32_bf16 v[158:161], v[230:233], v[36:39], 0
    v_mul_f32 v125, v148, v125
    v_cvt_pk_bf16_f32 v217, v124, v125
    v_mfma_f32_16x16x32_bf16 v[158:161], v[134:137], v[118:121], v[158:161]
    v_mul_f32_dpp v154, v170, v146 quad_perm:[0,1,2,3] row_mask:0x2 bank_mask:0xf
    v_mul_f32 v126, 0x3baaaaab, v246
    v_mfma_f32_16x16x32_bf16 v[122:125], v[234:237], v[36:39], 0
    v_mul_f32_dpp v154, v114, v146 quad_perm:[0,1,2,3] row_mask:0x4 bank_mask:0xf
    v_cvt_pk_bf16_f32 v154, v154, v154
    v_mfma_f32_16x16x32_bf16 v[122:125], v[142:145], v[118:121], v[122:125]
    ds_write_b16 v7, v154
    v_rsq_f32 v126, v126
    v_rcp_f32 v130, v130
    v_mul_f32 v138, v126, v138
    v_mul_f32 v139, v126, v139
    v_cvt_pk_bf16_f32 v114, v138, v139
    v_mul_f32 v140, v126, v140
    v_mul_f32 v141, v126, v141
    v_cvt_pk_bf16_f32 v115, v140, v141
    v_mul_f32 v202, v126, v202
    v_mul_f32 v203, v126, v203
    v_cvt_pk_bf16_f32 v116, v202, v203
    v_mul_f32 v204, v126, v204
    v_mul_f32 v205, v126, v205
    v_cvt_pk_bf16_f32 v117, v204, v205
    v_mul_f32 v174, v126, v174
    v_mul_f32 v175, v126, v175
    v_cvt_pk_bf16_f32 v132, v174, v175
    v_mul_f32 v176, v126, v176
    v_mul_f32 v177, v126, v177
    v_cvt_pk_bf16_f32 v133, v176, v177
    v_max3_u32 v25, v25, v130, v131
    s_waitcnt lgkmcnt(0)
    s_barrier
    ds_read_b128 v[118:121], v129 offset:7616
    ds_read_b128 v[134:137], v129 offset:8640
    ds_read_b128 v[138:141], v215 offset:6144
    buffer_store_dwordx2 v[216:217], v127, s[12:15], 0 offen nt
    ds_read_b128 v[142:145], v215 offset:7168
    ds_read_b128 v[154:157], v215 offset:8192
    ds_read_b128 v[166:169], v215 offset:9216
    ds_read_b128 v[170:173], v215 offset:10240
    ds_read_b128 v[174:177], v215 offset:11264
    v_max3_u32 v25, v25, v146, v147
    v_sub_u32 v131, 0x67800000, v25
    v_or3_b32 v254, v254, v131, v25
    s_waitcnt lgkmcnt(7)
    v_mfma_f32_16x16x32_bf16 v[146:149], v[32:35], v[118:121], 0
    s_waitcnt lgkmcnt(5)
    v_lshl_add_u32 v131, s16, 2, v215
    v_mul_f32 v150, v130, v150
    v_mfma_f32_16x16x32_bf16 v[146:149], v[32:35], v[134:137], v[146:149]
    s_waitcnt lgkmcnt(4)
    ds_write_b32 v131, v254 offset:18432
    v_mfma_f32_16x16x32_bf16 v[118:121], a[216:219], v[138:141], 0
    s_waitcnt lgkmcnt(4)
    v_mul_f32 v151, v130, v151
    v_cvt_pk_bf16_f32 v134, v150, v151
    v_mfma_f32_16x16x32_bf16 v[118:121], a[220:223], v[142:145], v[118:121]
    s_waitcnt lgkmcnt(3)
    v_mul_f32 v152, v130, v152
    v_mul_f32 v153, v130, v153
    v_mfma_f32_16x16x32_bf16 v[118:121], a[224:227], v[154:157], v[118:121]
    s_waitcnt lgkmcnt(2)
    v_cvt_pk_bf16_f32 v135, v152, v153
    v_mul_f32 v158, v130, v158
    v_mfma_f32_16x16x32_bf16 v[118:121], a[228:231], v[166:169], v[118:121]
    s_waitcnt lgkmcnt(1)
    v_mul_f32 v159, v130, v159
    v_cvt_pk_bf16_f32 v136, v158, v159
    v_mfma_f32_16x16x32_bf16 v[118:121], a[232:235], v[170:173], v[118:121]
    v_mul_f32 v160, v130, v160
    v_mul_f32 v161, v130, v161
    v_mfma_f32_16x16x32_bf16 v[118:121], a[236:239], v[174:177], v[118:121]
    v_cvt_pk_bf16_f32 v137, v160, v161
    v_mul_f32 v122, v130, v122
    v_mfma_f32_16x16x32_bf16 v[150:153], a[240:243], v[138:141], 0
    ds_write_b128 v3, v[134:137] offset:12288
    v_mfma_f32_16x16x32_bf16 v[150:153], a[244:247], v[142:145], v[150:153]
    buffer_store_dwordx4 v[114:117], v17, s[52:55], 0 offen nt
    v_mul_f32 v123, v130, v123
    v_cvt_pk_bf16_f32 v126, v122, v123
    v_fma_f32 v254, v118, v118, s33
    v_fmac_f32 v254, v119, v119
    v_mfma_f32_16x16x32_bf16 v[150:153], a[248:251], v[154:157], v[150:153]
    v_fmac_f32 v254, v120, v120
    v_fmac_f32 v254, v121, v121
    v_mfma_f32_16x16x32_bf16 v[150:153], a[252:255], v[166:169], v[150:153]
    v_mul_f32 v124, v130, v124
    v_mul_f32 v125, v130, v125
    v_mfma_f32_16x16x32_bf16 v[150:153], v[82:85], v[170:173], v[150:153]
    v_cvt_pk_bf16_f32 v127, v124, v125
    v_mul_f32 v216, 0x3baaaaab, v146
    v_mfma_f32_16x16x32_bf16 v[150:153], v[86:89], v[174:177], v[150:153]
    ds_write_b64 v4, v[126:127] offset:16384
    v_mfma_f32_16x16x32_bf16 v[114:117], v[90:93], v[138:141], 0
    v_rsq_f32 v216, v216
    v_mfma_f32_16x16x32_bf16 v[114:117], v[94:97], v[142:145], v[114:117]
    ds_read_b128 v[122:125], v128 offset:256
    ds_read_b128 v[134:137], v128 offset:2304
    v_mfma_f32_16x16x32_bf16 v[114:117], v[98:101], v[154:157], v[114:117]
    ds_read_b128 v[138:141], v128 offset:4352
    v_fmac_f32 v254, v150, v150
    v_mfma_f32_16x16x32_bf16 v[114:117], v[102:105], v[166:169], v[114:117]
    ds_read_b128 v[142:145], v128 offset:6400
    v_fmac_f32 v254, v151, v151
    v_mfma_f32_16x16x32_bf16 v[114:117], v[106:109], v[170:173], v[114:117]
    ds_read_b128 v[146:149], v128 offset:8448
    v_fmac_f32 v254, v152, v152
    v_mfma_f32_16x16x32_bf16 v[114:117], v[110:113], v[174:177], v[114:117]
    ds_read_b128 v[154:157], v128 offset:10496
    v_fmac_f32 v254, v153, v153
    v_mul_f32 v182, v216, v182
    v_mul_f32 v183, v216, v183
    v_cvt_pk_bf16_f32 v130, v182, v183
    v_mul_f32 v184, v216, v184
    v_mul_f32 v185, v216, v185
    v_cvt_pk_bf16_f32 v131, v184, v185
    v_fmac_f32 v254, v114, v114
    s_waitcnt lgkmcnt(5)
    v_mfma_f32_16x16x32_bf16 v[158:161], a[216:219], v[122:125], 0
    s_waitcnt lgkmcnt(4)
    v_fmac_f32 v254, v115, v115
    v_fmac_f32 v254, v116, v116
    v_mfma_f32_16x16x32_bf16 v[158:161], a[220:223], v[134:137], v[158:161]
    s_waitcnt lgkmcnt(3)
    v_fmac_f32 v254, v117, v117
    v_cvt_pk_bf16_f32 v126, v254, v254
    v_mfma_f32_16x16x32_bf16 v[158:161], a[224:227], v[138:141], v[158:161]
    s_waitcnt lgkmcnt(2)
    buffer_store_dwordx2 v[132:133], v20, s[52:55], 0 offen nt
    v_cvt_pk_bf16_f32 v127, v254, v254
    v_mul_f32 v162, v216, v162
    v_mfma_f32_16x16x32_bf16 v[158:161], a[228:231], v[142:145], v[158:161]
    s_waitcnt lgkmcnt(1)
    ds_write_b64 v214, v[126:127] offset:9664
    v_mfma_f32_16x16x32_bf16 v[158:161], a[232:235], v[146:149], v[158:161]
    s_waitcnt lgkmcnt(1)
    v_mul_f32 v163, v216, v163
    v_cvt_pk_bf16_f32 v132, v162, v163
    v_mfma_f32_16x16x32_bf16 v[158:161], a[236:239], v[154:157], v[158:161]
    v_mul_f32 v164, v216, v164
    v_mul_f32 v165, v216, v165
    v_mfma_f32_16x16x32_bf16 v[166:169], a[240:243], v[122:125], 0
    v_cvt_pk_bf16_f32 v133, v164, v165
    v_mul_f32 v178, v216, v178
    v_mfma_f32_16x16x32_bf16 v[166:169], a[244:247], v[134:137], v[166:169]
    v_mul_f32 v179, v216, v179
    v_cvt_pk_bf16_f32 v126, v178, v179
    v_mfma_f32_16x16x32_bf16 v[166:169], a[248:251], v[138:141], v[166:169]
    v_fma_f32 v254, v158, v158, s33
    v_fmac_f32 v254, v159, v159
    v_mfma_f32_16x16x32_bf16 v[166:169], a[252:255], v[142:145], v[166:169]
    v_fmac_f32 v254, v160, v160
    v_fmac_f32 v254, v161, v161
    v_mfma_f32_16x16x32_bf16 v[166:169], v[82:85], v[146:149], v[166:169]
    s_waitcnt lgkmcnt(0)
    v_mul_f32 v180, v216, v180
    v_mul_f32 v181, v216, v181
    v_mfma_f32_16x16x32_bf16 v[166:169], v[86:89], v[154:157], v[166:169]
    s_barrier
    ds_read_b128 v[162:165], v129 offset:9664
    ds_read_b128 v[170:173], v129 offset:10688
    v_mfma_f32_16x16x32_bf16 v[174:177], v[90:93], v[122:125], 0
    ds_read_b128 v[122:125], v215 offset:12288
    v_cvt_pk_bf16_f32 v127, v180, v181
    v_mfma_f32_16x16x32_bf16 v[174:177], v[94:97], v[134:137], v[174:177]
    ds_read_b128 v[134:137], v215 offset:13312
    v_fmac_f32 v254, v166, v166
    v_mfma_f32_16x16x32_bf16 v[174:177], v[98:101], v[138:141], v[174:177]
    ds_read_b128 v[138:141], v215 offset:14336
    v_fmac_f32 v254, v167, v167
    v_mfma_f32_16x16x32_bf16 v[174:177], v[102:105], v[142:145], v[174:177]
    ds_read_b128 v[142:145], v215 offset:15360
    v_fmac_f32 v254, v168, v168
    v_mfma_f32_16x16x32_bf16 v[174:177], v[106:109], v[146:149], v[174:177]
    ds_read_b128 v[146:149], v215 offset:16384
    v_fmac_f32 v254, v169, v169
    v_mfma_f32_16x16x32_bf16 v[174:177], v[110:113], v[154:157], v[174:177]
    ds_read_b128 v[154:157], v215 offset:17408
    s_waitcnt lgkmcnt(7)
    v_mfma_f32_16x16x32_bf16 v[178:181], v[32:35], v[162:165], 0
    s_waitcnt lgkmcnt(6)
    buffer_store_dwordx4 v[130:133], v15, s[56:59], 0 offen nt
    v_bfe_u32 v128, v193, 1, 2
    v_xor_b32 v128, v128, v191
    v_lshl_add_u32 v128, v193, 2, v128
    v_fmac_f32 v254, v174, v174
    v_mfma_f32_16x16x32_bf16 v[178:181], v[32:35], v[170:173], v[178:181]
    s_waitcnt lgkmcnt(4)
    v_fmac_f32 v254, v175, v175
    v_fmac_f32 v254, v176, v176
    v_mfma_f32_16x16x32_bf16 v[130:133], a[216:219], v[122:125], 0
    s_waitcnt lgkmcnt(3)
    v_fmac_f32 v254, v177, v177
    v_cvt_pk_bf16_f32 v216, v254, v254
    v_mfma_f32_16x16x32_bf16 v[130:133], a[220:223], v[134:137], v[130:133]
    s_waitcnt lgkmcnt(2)
    v_cvt_pk_bf16_f32 v217, v254, v254
    v_lshl_add_u32 v254, v128, 4, s5
    v_mfma_f32_16x16x32_bf16 v[130:133], a[224:227], v[138:141], v[130:133]
    s_waitcnt lgkmcnt(1)
    ds_write_b64 v214, v[216:217] offset:17280
    v_mfma_f32_16x16x32_bf16 v[130:133], a[228:231], v[142:145], v[130:133]
    s_waitcnt lgkmcnt(1)
    v_lshl_add_u32 v191, v128, 3, s5
    v_lshl_add_u32 v193, v190, 4, s5
    v_mfma_f32_16x16x32_bf16 v[130:133], a[232:235], v[146:149], v[130:133]
    v_lshl_add_u32 v190, v190, 3, s5
    v_lshlrev_b32 v128, 2, v128
    v_mfma_f32_16x16x32_bf16 v[130:133], a[236:239], v[154:157], v[130:133]
    ds_permute_b32 v216, v128, v16
    ds_permute_b32 v217, v128, v19
    v_mfma_f32_16x16x32_bf16 v[162:165], a[240:243], v[122:125], 0
    ds_permute_b32 v179, v128, v17
    ds_permute_b32 v180, v128, v20
    v_mfma_f32_16x16x32_bf16 v[162:165], a[244:247], v[134:137], v[162:165]
    v_mul_f32 v178, 0x3baaaaab, v178
    v_mfma_f32_16x16x32_bf16 v[162:165], a[248:251], v[138:141], v[162:165]
    v_rsq_f32 v178, v178
    v_mfma_f32_16x16x32_bf16 v[162:165], a[252:255], v[142:145], v[162:165]
    v_fma_f32 v181, v130, v130, s33
    v_fmac_f32 v181, v131, v131
    v_mfma_f32_16x16x32_bf16 v[162:165], v[82:85], v[146:149], v[162:165]
    v_fmac_f32 v181, v132, v132
    v_fmac_f32 v181, v133, v133
    v_mfma_f32_16x16x32_bf16 v[162:165], v[86:89], v[154:157], v[162:165]
    v_mul_f32 v118, v178, v118
    v_mul_f32 v119, v178, v119
    v_mfma_f32_16x16x32_bf16 v[170:173], v[90:93], v[122:125], 0
    s_waitcnt lgkmcnt(2)
    v_cvt_pk_bf16_f32 v118, v118, v119
    v_mul_f32 v120, v178, v120
    v_mfma_f32_16x16x32_bf16 v[170:173], v[94:97], v[134:137], v[170:173]
    s_waitcnt lgkmcnt(0)
    buffer_store_dwordx2 v[126:127], v18, s[56:59], 0 offen nt
    v_fmac_f32 v181, v162, v162
    v_fmac_f32 v181, v163, v163
    v_mfma_f32_16x16x32_bf16 v[170:173], v[98:101], v[138:141], v[170:173]
    v_fmac_f32 v181, v164, v164
    v_fmac_f32 v181, v165, v165
    v_mfma_f32_16x16x32_bf16 v[170:173], v[102:105], v[142:145], v[170:173]
    v_mul_f32 v121, v178, v121
    v_cvt_pk_bf16_f32 v119, v120, v121
    v_mfma_f32_16x16x32_bf16 v[170:173], v[106:109], v[146:149], v[170:173]
    v_mul_f32 v150, v178, v150
    v_mul_f32 v151, v178, v151
    v_mfma_f32_16x16x32_bf16 v[170:173], v[110:113], v[154:157], v[170:173]
    v_cvt_pk_bf16_f32 v120, v150, v151
    v_mul_f32 v152, v178, v152
    v_mul_f32 v153, v178, v153
    v_cvt_pk_bf16_f32 v121, v152, v153
    ds_write_b128 v254, v[118:121] offset:1536
    v_mul_f32 v114, v178, v114
    v_mul_f32 v115, v178, v115
    v_cvt_pk_bf16_f32 v114, v114, v115
    v_fmac_f32 v181, v170, v170
    v_fmac_f32 v181, v171, v171
    v_fmac_f32 v181, v172, v172
    v_fmac_f32 v181, v173, v173
    v_cvt_pk_bf16_f32 v126, v181, v181
    v_cvt_pk_bf16_f32 v127, v181, v181
    ds_write_b64 v214, v[126:127] offset:15232
    v_mul_f32 v116, v178, v116
    v_mul_f32 v117, v178, v117
    v_cvt_pk_bf16_f32 v115, v116, v117
    ds_read_b128 v[118:121], v193 offset:1536
    ds_write_b64 v191, v[114:115] offset:2560
    ds_read_b64 v[126:127], v190 offset:2560
    s_waitcnt lgkmcnt(3)
    s_barrier
    ds_read_b128 v[114:117], v129 offset:15232
    ds_read_b128 v[122:125], v129 offset:16256
    ds_read_b128 v[134:137], v129 offset:17280
    ds_read_b128 v[138:141], v129 offset:18304
    ds_read_b128 v[142:145], v215 offset:18432
    s_waitcnt lgkmcnt(6)
    buffer_store_dwordx4 v[118:121], v216, s[56:59], 0 offen nt
    s_waitcnt lgkmcnt(5)
    s_waitcnt lgkmcnt(4)
    v_mfma_f32_16x16x32_bf16 v[146:149], v[32:35], v[114:117], 0
    s_waitcnt lgkmcnt(3)
    v_mfma_f32_16x16x32_bf16 v[146:149], v[32:35], v[122:125], v[146:149]
    s_waitcnt lgkmcnt(1)
    v_mfma_f32_16x16x32_bf16 v[114:117], v[32:35], v[134:137], 0
    s_waitcnt lgkmcnt(0)
    buffer_store_dwordx2 v[126:127], v217, s[56:59], 0 offen nt
    v_or3_b32 v142, v142, v143, v144
    v_or_b32 v142, v142, v145
    v_mfma_f32_16x16x32_bf16 v[114:117], v[32:35], v[138:141], v[114:117]
    v_cmp_gt_i32 s[46:47], 0, v142
    v_mul_f32 v178, 0x3baaaaab, v146
    v_rsq_f32 v178, v178
    s_nop 0
    v_mul_f32 v130, v178, v130
    v_mul_f32 v131, v178, v131
    v_cvt_pk_bf16_f32 v118, v130, v131
    v_mul_f32 v132, v178, v132
    v_mul_f32 v181, 0x3baaaaab, v114
    v_rsq_f32 v181, v181
    v_mul_f32 v133, v178, v133
    v_mul_f32 v158, v181, v158
    v_mul_f32 v159, v181, v159
    v_cvt_pk_bf16_f32 v114, v158, v159
    v_mul_f32 v160, v181, v160
    v_mul_f32 v161, v181, v161
    v_cvt_pk_bf16_f32 v115, v160, v161
    v_mul_f32 v166, v181, v166
    v_mul_f32 v167, v181, v167
    v_cvt_pk_bf16_f32 v116, v166, v167
    v_mul_f32 v168, v181, v168
    v_mul_f32 v169, v181, v169
    v_cvt_pk_bf16_f32 v117, v168, v169
    buffer_store_dwordx4 v[114:117], v255, s[12:15], 0 offen nt
    v_mul_f32 v174, v181, v174
    v_mul_f32 v175, v181, v175
    v_cvt_pk_bf16_f32 v130, v174, v175
    v_mul_f32 v176, v181, v176
    v_mul_f32 v177, v181, v177
    v_cvt_pk_bf16_f32 v131, v176, v177
    v_cvt_pk_bf16_f32 v119, v132, v133
    v_mul_f32 v162, v178, v162
    v_mul_f32 v163, v178, v163
    v_cvt_pk_bf16_f32 v120, v162, v163
    v_mul_f32 v164, v178, v164
    v_mul_f32 v165, v178, v165
    v_cvt_pk_bf16_f32 v121, v164, v165
    ds_write_b128 v254, v[118:121] offset:3072
    v_mul_f32 v170, v178, v170
    v_mul_f32 v171, v178, v171
    v_cvt_pk_bf16_f32 v132, v170, v171
    v_mul_f32 v172, v178, v172
    v_mul_f32 v173, v178, v173
    v_cvt_pk_bf16_f32 v133, v172, v173
    buffer_store_dwordx2 v[130:131], v192, s[12:15], 0 offen nt
    ds_read_b128 v[114:117], v193 offset:3072
    ds_write_b64 v191, v[132:133] offset:4096
    ds_read_b64 v[254:255], v190 offset:4096
    s_waitcnt lgkmcnt(2)
    buffer_store_dwordx4 v[114:117], v179, s[56:59], 0 offen nt
    s_waitcnt lgkmcnt(0)
    buffer_store_dwordx2 v[254:255], v180, s[56:59], 0 offen nt
L_end:
    s_nop 1
    s_cmp_lg_u64 s[46:47], 0
    s_cbranch_scc1 L_rerun
L_done:
    s_endpgm
L_rerun:
    s_mov_b32 s44, 0x7f000000
    s_lshr_b32 s100, s70, 20
    s_waitcnt vmcnt(0) lgkmcnt(0)
    s_barrier
    v_mbcnt_lo_u32_b32 v0, -1, 0
    v_mbcnt_hi_u32_b32 v0, -1, v0
    v_lshl_add_u32 v0, s16, 6, v0
    s_nop 7
    s_branch L_again
L_edge:
    v_mov_b32 v254, v0
    v_mov_b32 v255, 0x40000000
    s_lshl_b32 s3, s16, 4
    s_load_dwordx4 s[92:95], s[0:1], s3
    v_and_b32 v114, 63, v0
    s_bfe_u32 s3, s2, 0x50003
    s_lshl_b32 s4, s16, 3
    s_lshr_b32 s98, 0x06143a01, s4
    s_and_b32 s98, s98, 0xff
    s_mul_i32 s3, s3, s98
    s_sub_u32 s98, s98, 1
    s_lshr_b32 s4, 0x0048d800, s4
    s_and_b32 s4, s4, 0xff
    s_lshl_b32 s4, s4, 3
    s_max_u32 s4, s4, 6
    s_sub_u32 s4, s4, s98
    s_sub_u32 s4, s4, 1
    s_min_u32 s3, s3, s4
    v_min_u32 v116, s98, v114
    v_add_lshl_u32 v116, v116, s3, 7
    v_mov_b32 v117, 0
    v_lshrrev_b32 v115, 4, v114
    v_and_b32 v118, 15, v114
    s_mov_b32 s10, 100270464
    s_mov_b32 s11, 0x00020000
    s_mov_b32 s50, 36096
    s_mov_b32 s51, 0x00020000
    s_mul_i32 s3, s16, 96
    v_lshl_add_u32 v119, v114, 4, s3
    v_mul_u32_u24 v120, 171, v114
    v_lshrrev_b32 v120, 10, v120
    v_lshrrev_b32 v121, 1, v120
    v_xor_b32 v121, v121, v120
    v_and_b32 v121, 4, v121
    v_mul_u32_u24 v121, 3, v121
    v_xor_b32 v121, v121, v120
    v_mul_u32_u24 v121, 1152, v121
    v_mul_u32_u24 v126, 96, v120
    v_sub_u32 v121, v121, v126
    v_add_u32 v126, v119, v121
    v_add_u32 v121, 64, v114
    v_mul_u32_u24 v121, 171, v121
    v_lshrrev_b32 v121, 10, v121
    v_lshrrev_b32 v127, 1, v121
    v_xor_b32 v127, v127, v121
    v_and_b32 v127, 4, v127
    v_mul_u32_u24 v127, 3, v127
    v_xor_b32 v127, v127, v121
    v_mul_u32_u24 v127, 1152, v127
    v_mul_u32_u24 v128, 96, v121
    v_sub_u32 v127, v127, v128
    v_add_u32 v128, v119, v127
    v_add_u32 v127, 128, v114
    v_mul_u32_u24 v127, 171, v127
    v_lshrrev_b32 v127, 10, v127
    v_lshrrev_b32 v129, 1, v127
    v_xor_b32 v129, v129, v127
    v_and_b32 v129, 4, v129
    v_mul_u32_u24 v129, 3, v129
    v_xor_b32 v129, v129, v127
    v_mul_u32_u24 v129, 1152, v129
    v_mul_u32_u24 v130, 96, v127
    v_sub_u32 v129, v129, v130
    v_add_u32 v130, v119, v129
    s_mul_i32 s68, s16, 6144
    s_add_u32 s69, s68, 65536
    s_cmp_eq_u32 s16, 3
    s_cselect_b32 s68, 149696, s68
    s_cselect_b32 s69, 155840, s69
    s_mov_b32 s70, 193536
    s_mov_b32 s36, 100270464
    s_mov_b32 s22, 1180032
    s_mul_i32 s3, s2, 911
    s_lshr_b32 s3, s3, 16
    s_mul_i32 s35, s3, 72
    s_sub_u32 s38, s2, s35
    s_mul_i32 s3, s3, 1373568
    s_mul_i32 s35, s38, 2688
    s_add_u32 s3, s3, s35
    s_add_u32 s25, s3, 589824
    s_add_u32 s7, s3, 1769472
    s_mov_b32 s20, 31
    s_mov_b32 s21, 4204032
    s_mov_b32 s17, 20
    s_cmp_lt_u32 s2, 240
    s_cselect_b32 s45, 28, 24
    s_mov_b32 s5, 0
    s_mov_b32 s6, 0
    s_cmp_lt_u32 s2, 247
    s_cbranch_scc1 L_inner
    s_mov_b32 s20, 0
    s_mov_b32 s38, 0
    s_sub_u32 s3, s2, 247
    s_and_b32 s3, s3, 3
    s_mul_i32 s3, s3, 7
    s_add_u32 s3, s3, 3
    s_mov_b32 s35, 196224
    s_cmp_lt_u32 s2, 251
    s_cselect_b32 s35, s35, 384
    s_cselect_b32 s6, 1, 0
    s_cselect_b32 s5, 0, 1
    s_mul_i32 s25, s3, s35
    s_mul_i32 s21, s35, 28
    s_cmp_lt_u32 s2, 255
    s_cselect_b32 s17, 18, 1
    s_cselect_b32 s45, 18, 1
    s_cselect_b32 s25, s25, 0
    s_cselect_b32 s6, s6, 1
    s_add_u32 s7, s25, 1179648
L_inner:
    s_mul_i32 s3, s5, 99485568
    s_mul_i32 s35, s5, -784896
    v_mov_b32 v119, s3
    v_mov_b32 v129, s35
    s_add_u32 s7, s7, s35
    s_mul_i32 s3, s6, 194688
    s_mul_i32 s35, s6, -1536
    v_mov_b32 v131, s3
    v_mov_b32 v132, s35
    s_add_u32 s7, s7, s35
    s_bfm_b32 s34, s45, 0
    s_and_b32 s4, s2, 7
    s_sub_u32 s4, 0, s4
    v_mul_u32_u24 v133, 2731, v254
    v_bfe_u32 v142, v133, 17, 3
    v_lshrrev_b32 v133, 16, v133
    v_xor_b32 v143, v142, v254
    v_mul_u32_u24 v142, 37, v133
    v_lshrrev_b32 v142, 8, v142
    v_lshlrev_b32 v143, 4, v143
    v_mad_u32_u24 v10, v142, s70, v143
    v_mul_u32_u24 v142, 37, v133
    v_lshrrev_b32 v142, 8, v142
    v_mul_u32_u24 v144, 7, v142
    v_sub_u32 v144, v133, v144
    v_cmp_gt_u32 vcc, 4, v142
    s_nop 1
    v_cndmask_b32 v142, v129, v119, vcc
    v_cmp_gt_u32 vcc, 4, v144
    s_nop 1
    v_cndmask_b32 v144, v132, v131, vcc
    v_add3_u32 v10, v10, v142, v144
    v_mul_u32_u24 v142, s20, v133
    v_add_u32 v142, s38, v142
    v_mul_u32_u24 v144, 911, v142
    v_lshrrev_b32 v144, 16, v144
    v_mul_u32_u24 v144, s22, v144
    v_mad_u32_u24 v144, v133, s21, v144
    v_bfe_u32 v142, s34, v133, 1
    v_cmp_ne_u32 vcc, 0, v142
    v_add_u32 v142, s7, v144
    s_nop 0
    v_cndmask_b32 v142, v255, v142, vcc
    v_mul_u32_u24 v133, 384, v133
    v_sub_u32 v133, v143, v133
    v_add_u32 v142, v142, v133
    v_add_u32 v133, 256, v254
    v_mul_u32_u24 v143, 2731, v133
    v_bfe_u32 v144, v143, 17, 3
    v_lshrrev_b32 v143, 16, v143
    v_xor_b32 v133, v144, v133
    v_mul_u32_u24 v144, 37, v143
    v_lshrrev_b32 v144, 8, v144
    v_lshlrev_b32 v133, 4, v133
    v_mad_u32_u24 v11, v144, s70, v133
    v_mul_u32_u24 v144, 37, v143
    v_lshrrev_b32 v144, 8, v144
    v_mul_u32_u24 v145, 7, v144
    v_sub_u32 v145, v143, v145
    v_cmp_gt_u32 vcc, 4, v144
    s_nop 1
    v_cndmask_b32 v144, v129, v119, vcc
    v_cmp_gt_u32 vcc, 4, v145
    s_nop 1
    v_cndmask_b32 v145, v132, v131, vcc
    v_add3_u32 v11, v11, v144, v145
    v_min_u32 v144, 20, v143
    v_add_u32 v145, 12, v143
    v_lshrrev_b32 v145, 5, v145
    v_sub_u32 v146, v143, v144
    v_mad_i32_i24 v146, v145, s4, v146
    v_mul_u32_u24 v147, s20, v144
    v_add3_u32 v147, v147, v146, s38
    v_mul_u32_u24 v145, 911, v147
    v_lshrrev_b32 v145, 16, v145
    v_mul_u32_u24 v145, s22, v145
    v_mad_u32_u24 v145, v144, s21, v145
    v_bfe_u32 v147, s34, v143, 1
    v_cmp_ne_u32 vcc, 0, v147
    v_mul_i32_i24 v146, 2688, v146
    v_add3_u32 v144, v145, v146, s7
    v_cndmask_b32 v144, v255, v144, vcc
    v_mul_u32_u24 v143, 384, v143
    v_sub_u32 v143, v133, v143
    v_add_u32 v144, v144, v143
    v_add_u32 v133, 512, v254
    v_mul_u32_u24 v143, 2731, v133
    v_bfe_u32 v145, v143, 17, 3
    v_lshrrev_b32 v143, 16, v143
    v_xor_b32 v133, v145, v133
    v_mul_u32_u24 v145, 37, v143
    v_lshrrev_b32 v145, 8, v145
    v_lshlrev_b32 v133, 4, v133
    v_mad_u32_u24 v12, v145, s70, v133
    v_mul_u32_u24 v145, 37, v143
    v_lshrrev_b32 v145, 8, v145
    v_mul_u32_u24 v146, 7, v145
    v_sub_u32 v146, v143, v146
    v_cmp_gt_u32 vcc, 4, v145
    s_nop 1
    v_cndmask_b32 v145, v129, v119, vcc
    v_cmp_gt_u32 vcc, 4, v146
    s_nop 1
    v_cndmask_b32 v146, v132, v131, vcc
    v_add3_u32 v12, v12, v145, v146
    v_min_u32 v145, 20, v143
    v_add_u32 v146, 12, v143
    v_lshrrev_b32 v146, 5, v146
    v_sub_u32 v147, v143, v145
    v_mad_i32_i24 v147, v146, s4, v147
    v_mul_u32_u24 v148, s20, v145
    v_add3_u32 v148, v148, v147, s38
    v_mul_u32_u24 v146, 911, v148
    v_lshrrev_b32 v146, 16, v146
    v_mul_u32_u24 v146, s22, v146
    v_mad_u32_u24 v146, v145, s21, v146
    v_bfe_u32 v148, s34, v143, 1
    v_cmp_ne_u32 vcc, 0, v148
    v_mul_i32_i24 v147, 2688, v147
    v_add3_u32 v145, v146, v147, s7
    v_cndmask_b32 v145, v255, v145, vcc
    v_mul_u32_u24 v143, 384, v143
    v_sub_u32 v143, v133, v143
    v_add_u32 v145, v145, v143
    s_lshl_b32 s28, s16, 10
    s_add_u32 s28, s28, 20480
    s_waitcnt lgkmcnt(0)
    s_load_dword s101, s[92:93], 0
    s_load_dword s101, s[94:95], 0
    s_cmp_eq_u32 s16, 2
    s_cselect_b64 s[98:99], s[80:81], s[78:79]
    s_cmp_eq_u32 s16, 3
    s_cselect_b64 s[98:99], s[88:89], s[98:99]
    s_mov_b64 s[8:9], s[76:77]
    v_lshl_add_u64 v[116:117], s[98:99], 0, v[116:117]
    s_cmp_eq_u32 s16, 2
    s_cselect_b64 s[98:99], s[84:85], s[82:83]
    s_cmp_eq_u32 s16, 3
    s_cselect_b64 s[98:99], s[86:87], s[98:99]
    v_writelane_b32 v116, s98, 63
    v_writelane_b32 v117, s99, 63
    s_cmp_eq_u32 s16, 0
    s_cbranch_scc1 L_nowue
    global_load_dword a254, v[116:117], off
L_nowue:
    s_add_u32 m0, s28, 65536
    s_nop 0
    buffer_load_dwordx4 v142, s[8:11], 0 offen nt lds
    s_add_u32 m0, s28, 69632
    s_nop 0
    buffer_load_dwordx4 v144, s[8:11], 0 offen lds
    s_add_u32 m0, s28, 73728
    s_nop 0
    buffer_load_dwordx4 v145, s[8:11], 0 offen lds
    s_add_u32 m0, s28, 0
    s_nop 0
    buffer_load_dwordx4 v10, s[8:11], s25 offen nt lds
    s_add_u32 m0, s28, 4096
    s_nop 0
    buffer_load_dwordx4 v11, s[8:11], s25 offen nt lds
    s_mov_b64 s[48:49], s[78:79]
    s_mov_b64 s[52:53], s[80:81]
    s_mov_b64 s[60:61], s[84:85]
    s_mov_b64 s[64:65], s[86:87]
    s_mov_b64 s[56:57], s[88:89]
    s_mov_b64 s[46:47], s[82:83]
    s_load_dwordx4 s[40:43], s[0:1], 72
    s_add_u32 s48, s48, 384
    s_addc_u32 s49, s49, 0
    s_add_u32 m0, s68, 0
    v_lshlrev_b32 v133, 1, v115
    s_mov_b32 s54, 12288
    s_mov_b32 s55, 0x00020000
    s_mov_b32 s62, 64
    s_mov_b32 s63, 0x00020000
    s_mov_b32 s66, 128
    s_mov_b32 s67, 0x00020000
    s_mov_b32 s58, 676
    s_mov_b32 s59, 0x00020000
    s_mov_b32 s14, 0
    s_mov_b32 s15, 0x00020000
    s_mul_i32 s90, s16, 16
    v_mov_b32 v117, 0
    v_cmp_lt_u32 s[92:93], 7, v118
    v_mov_b32 v135, 0
    v_mov_b32 v125, 0
    v_mov_b32 v123, 0
    v_lshlrev_b32 v122, 1, v114
    v_mul_u32_u24 v124, 12, v118
    s_mul_i32 s71, s16, 192
    v_add_u32 v124, s71, v124
    v_lshlrev_b32 v134, 5, v115
    s_mul_i32 s72, s16, 9408
    s_add_u32 s72, s72, 104448
    s_mul_i32 s73, s16, 7616
    s_add_u32 s73, s73, 38912
    s_cmp_eq_u32 s16, 3
    s_cselect_b32 s73, 142080, s73
    v_lshrrev_b32 v136, 2, v118
    v_and_b32 v137, 1, v136
    v_mul_u32_u24 v137, 0x020202, v137
    v_lshl_or_b32 v137, v137, 8, v137
    v_add_u32 v137, 0x05040100, v137
    v_and_b32 v138, 3, v118
    v_lshrrev_b32 v116, 1, v118
    v_xor_b32 v116, v116, v115
    v_mul_u32_u24 v139, 384, v118
    v_lshl_add_u32 v0, v116, 4, v139
    v_xor_b32 v1, 64, v0
    v_and_b32 v116, 2, v115
    v_add_u32 v116, v116, v115
    v_lshl_add_u32 v116, v116, 2, v136
    v_mul_u32_u24 v116, 96, v116
    v_lshl_add_u32 v116, v138, 3, v116
    v_add_u32 v141, s68, v116
    v_add_u32 v139, s69, v116
    v_add_u32 v140, s72, v116
    v_add_u32 v142, s73, v116
    v_mov_b32 v28, 0x3f803f80
    v_mov_b32 v29, 0x3f803f80
    v_mov_b32 v30, 0x3f803f80
    v_mov_b32 v31, 0x3f803f80
    v_mul_u32_u24 v143, 768, v115
    v_add_u32 v143, v124, v143
    v_add_u32 v143, 98304, v143
    s_mov_b32 s76, 0x3f80
    v_and_b32 v116, 1, v118
    v_lshlrev_b32 v116, 4, v116
    v_lshlrev_b32 v144, v116, s76
    v_mov_b32 v145, 0x3c003c00
    v_mov_b32 v44, 1.0
    v_lshlrev_b32 v146, 4, v115
    s_mov_b32 s19, s38
    s_mov_b32 s23, s25
    s_mov_b32 s26, 0
    s_mov_b32 s27, 0
    s_mov_b32 s18, 0
    s_add_u32 s19, s19, s20
    s_add_u32 s23, s23, s21
    s_cmp_ge_u32 s19, 72
    s_cselect_b32 s34, 72, 0
    s_cselect_b32 s35, s22, 0
    s_sub_u32 s19, s19, s34
    s_add_u32 s23, s23, s35
    s_mov_b32 s24, s23
    s_add_u32 s19, s19, s20
    s_add_u32 s23, s23, s21
    s_cmp_ge_u32 s19, 72
    s_cselect_b32 s34, 72, 0
    s_cselect_b32 s35, s22, 0
    s_sub_u32 s19, s19, s34
    s_add_u32 s23, s23, s35
    s_mul_i32 s79, s16, 64
    v_lshl_add_u32 v147, v115, 4, s79
    s_mul_i32 s80, s16, 32
    s_add_u32 s80, s80, 256
    v_lshl_add_u32 v149, v115, 3, s80
    v_add_u32 v151, 0, v118
    v_mul_u32_u24 v148, 37, v151
    v_mul_u32_u24 v150, 384, v151
    v_lshrrev_b32 v148, 8, v148
    v_mad_u32_u24 v150, v148, s70, v150
    v_add_u32 v15, v150, v147
    v_add_u32 v18, v150, v149
    v_mul_u32_u24 v150, 37, v151
    v_lshrrev_b32 v150, 8, v150
    v_mul_u32_u24 v153, 7, v150
    v_sub_u32 v153, v151, v153
    v_add_u32 v152, 16, v118
    v_mul_u32_u24 v155, 37, v152
    v_mul_u32_u24 v154, 384, v152
    v_lshrrev_b32 v155, 8, v155
    v_mad_u32_u24 v154, v155, s70, v154
    v_add_u32 v16, v154, v147
    v_add_u32 v19, v154, v149
    v_mul_u32_u24 v154, 37, v152
    v_lshrrev_b32 v154, 8, v154
    v_mul_u32_u24 v157, 7, v154
    v_sub_u32 v157, v152, v157
    v_add_u32 v159, 32, v118
    v_mul_u32_u24 v158, 37, v159
    v_mul_u32_u24 v156, 384, v159
    v_lshrrev_b32 v158, 8, v158
    v_mad_u32_u24 v156, v158, s70, v156
    v_add_u32 v17, v156, v147
    v_add_u32 v20, v156, v149
    v_mul_u32_u24 v156, 37, v159
    v_lshrrev_b32 v156, 8, v156
    v_mul_u32_u24 v147, 7, v156
    v_sub_u32 v147, v159, v147
    s_mul_i32 s81, s16, 768
    s_add_u32 s81, s81, 98304
    v_mul_u32_u24 v148, 24, v148
    v_lshl_add_u32 v148, v151, 2, v148
    v_add_u32 v22, s81, v148
    v_sub_u32 v23, s81, v148
    v_sub_u32 v148, v22, v146
    v_mul_u32_u24 v155, 24, v155
    v_lshl_add_u32 v155, v152, 2, v155
    v_add_u32 v24, s81, v155
    v_sub_u32 v25, s81, v155
    v_sub_u32 v149, v24, v146
    v_mul_u32_u24 v155, 24, v158
    v_lshl_add_u32 v155, v159, 2, v155
    v_add_u32 v26, s81, v155
    v_sub_u32 v27, s81, v155
    v_sub_u32 v155, v26, v146
    v_mul_u32_u24 v158, 148, v115
    s_mov_b32 s82, -24
    v_add_u32 v160, 0, v158
    v_lshrrev_b32 v160, 8, v160
    v_mad_i32_i24 v46, v160, s82, v148
    v_mad_i32_i24 v58, v160, s82, v149
    v_mad_i32_i24 v70, v160, s82, v155
    v_add_u32 v160, 37, v158
    v_lshrrev_b32 v160, 8, v160
    v_mad_i32_i24 v47, v160, s82, v148
    v_mad_i32_i24 v59, v160, s82, v149
    v_mad_i32_i24 v71, v160, s82, v155
    v_add_u32 v160, 74, v158
    v_lshrrev_b32 v160, 8, v160
    v_mad_i32_i24 v48, v160, s82, v148
    v_mad_i32_i24 v60, v160, s82, v149
    v_mad_i32_i24 v72, v160, s82, v155
    v_add_u32 v160, 111, v158
    v_lshrrev_b32 v160, 8, v160
    v_mad_i32_i24 v49, v160, s82, v148
    v_mad_i32_i24 v61, v160, s82, v149
    v_mad_i32_i24 v73, v160, s82, v155
    v_add_u32 v160, 592, v158
    v_lshrrev_b32 v160, 8, v160
    v_mad_i32_i24 v50, v160, s82, v148
    v_mad_i32_i24 v62, v160, s82, v149
    v_mad_i32_i24 v74, v160, s82, v155
    v_add_u32 v160, 629, v158
    v_lshrrev_b32 v160, 8, v160
    v_mad_i32_i24 v51, v160, s82, v148
    v_mad_i32_i24 v63, v160, s82, v149
    v_mad_i32_i24 v75, v160, s82, v155
    v_add_u32 v160, 666, v158
    v_lshrrev_b32 v160, 8, v160
    v_mad_i32_i24 v52, v160, s82, v148
    v_mad_i32_i24 v64, v160, s82, v149
    v_mad_i32_i24 v76, v160, s82, v155
    v_add_u32 v160, 703, v158
    v_lshrrev_b32 v160, 8, v160
    v_mad_i32_i24 v53, v160, s82, v148
    v_mad_i32_i24 v65, v160, s82, v149
    v_mad_i32_i24 v77, v160, s82, v155
    v_add_u32 v160, 1184, v158
    v_lshrrev_b32 v160, 8, v160
    v_mad_i32_i24 v54, v160, s82, v148
    v_mad_i32_i24 v66, v160, s82, v149
    v_mad_i32_i24 v78, v160, s82, v155
    v_add_u32 v160, 1221, v158
    v_lshrrev_b32 v160, 8, v160
    v_mad_i32_i24 v55, v160, s82, v148
    v_mad_i32_i24 v67, v160, s82, v149
    v_mad_i32_i24 v79, v160, s82, v155
    v_add_u32 v160, 1258, v158
    v_lshrrev_b32 v160, 8, v160
    v_mad_i32_i24 v56, v160, s82, v148
    v_mad_i32_i24 v68, v160, s82, v149
    v_mad_i32_i24 v80, v160, s82, v155
    v_add_u32 v158, 1295, v158
    v_lshrrev_b32 v158, 8, v158
    v_mad_i32_i24 v57, v158, s82, v148
    v_mad_i32_i24 v69, v158, s82, v149
    v_mad_i32_i24 v81, v158, s82, v155
    v_mov_b32 v155, s81
    v_lshlrev_b32 v148, 4, v114
    v_xor_b32 v2, 65536, v148
    v_lshl_add_u32 v3, s16, 10, v148
    s_lshr_b32 s83, s16, 1
    s_and_b32 s84, s16, 1
    s_lshl_b32 s84, s84, 3
    s_lshl_b32 s85, s83, 10
    s_add_u32 s85, s85, s84
    v_add_u32 v4, s85, v148
    s_lshl_b32 s83, s83, 11
    s_add_u32 s83, s83, s84
    s_add_u32 s83, s83, 157888
    s_mul_i32 s86, s16, 2048
    s_add_u32 s86, s86, 149696
    v_lshl_add_u32 v160, v115, 3, s86
    v_mov_b32 v148, s83
    v_mov_b32 v149, 163264
    v_mul_u32_u24 v158, 80, v115
    v_add3_u32 v5, v158, v116, s72
    v_lshl_add_u32 v6, v118, 2, s73
    s_mul_i32 s87, s16, 128
    s_add_u32 s87, s87, 61760
    s_mov_b32 s32, 0x2a8cbccc
    s_mov_b32 s33, 0x38fba882
    s_add_u32 s75, s28, 16384
    s_cmp_lt_u32 s16, 2
    s_cselect_b32 s29, s75, 161984
    s_cselect_b32 s30, 65536, 0
    s_xor_b32 s74, s29, s30
    s_lshl_b32 s94, s5, 1
    s_or_b32 s94, s94, s6
    s_mul_i32 s77, s16, 64
    s_mul_i32 s78, s16, 32
    s_add_u32 s78, s78, 192
    s_add_u32 s34, s18, 2
    s_mov_b32 s27, s26
    s_mov_b32 s26, s25
    s_add_u32 s19, s19, s20
    s_mov_b32 s18, 1
    s_mov_b32 s71, 1
    buffer_load_dwordx4 v126, s[48:51], 0 offen lds
    v_add_u32 v9, s87, v146
    v_lshrrev_b32 v116, 1, v115
    v_mul_u32_u24 v116, 48, v116
    buffer_load_dwordx4 v128, s[48:51], 0 offen offset:1024 lds
    v_lshl_add_u32 v116, v115, 3, v116
    v_lshl_add_u32 v116, v136, 4, v116
    v_lshl_add_u32 v116, v138, 1, v116
    buffer_load_dwordx4 v130, s[48:51], 0 offen offset:2048 lds
    s_add_u32 s48, s48, 36864
    s_addc_u32 s49, s49, 0
    s_add_u32 m0, s68, 3072
    v_add_u32 v8, s87, v116
    buffer_load_dwordx4 v126, s[48:51], 0 offen lds
    v_mov_b32 v37, 0
    v_mov_b32 v38, 0
    v_mov_b32 v39, 0
    buffer_load_dwordx4 v128, s[48:51], 0 offen offset:1024 lds
    v_add_u32 v161, 86016, v0
    v_add_u32 v174, 86016, v1
    v_lshlrev_b32 v162, 4, v118
    buffer_load_dwordx4 v130, s[48:51], 0 offen offset:2048 lds
    s_add_u32 s48, s48, 36864
    s_addc_u32 s49, s49, 0
    s_add_u32 m0, s69, 0
    buffer_load_ushort v116, v122, s[60:63], 0 offen
    s_mov_b64 s[60:61], s[8:9]
    s_sub_u32 s62, s45, s17
    s_sub_u32 s45, s17, 1
    buffer_load_dwordx3 v[166:168], v124, s[56:59], 0 offen
    v_add_u32 v162, 161984, v162
    buffer_load_dwordx4 v[170:173], v134, s[64:67], 0 offen
    v_mul_u32_u24 v175, 336, v118
    v_add3_u32 v175, v175, v158, s72
    v_mul_u32_u24 v158, 272, v118
    v_add3_u32 v158, v158, v146, s73
    v_mul_u32_u24 v177, 1088, v115
    v_add_u32 v177, v177, v6
    v_add_u32 v176, 5376, v175
    buffer_load_dwordx4 v[186:189], v134, s[64:67], 0 offen offset:16
    v_add_u32 v179, 4352, v158
    v_add_u32 v178, 4352, v177
    v_cmp_gt_u32 s[88:89], 16, v114
    v_mov_b32 v180, 0xf149f2ca
    v_add_u32 v134, 768, v254
    v_mul_u32_u24 v169, 2731, v134
    v_bfe_u32 v181, v169, 17, 3
    v_lshrrev_b32 v169, 16, v169
    v_xor_b32 v134, v181, v134
    v_mul_u32_u24 v181, 37, v169
    v_lshrrev_b32 v181, 8, v181
    v_lshlrev_b32 v134, 4, v134
    v_mad_u32_u24 v13, v181, s70, v134
    v_mul_u32_u24 v181, 37, v169
    v_lshrrev_b32 v181, 8, v181
    v_mul_u32_u24 v134, 7, v181
    v_sub_u32 v134, v169, v134
    v_cmp_gt_u32 vcc, 4, v181
    v_add_u32 v169, 1024, v254
    v_mul_u32_u24 v254, 2731, v169
    v_cndmask_b32 v181, v129, v119, vcc
    v_cmp_gt_u32 vcc, 4, v134
    v_bfe_u32 v122, v254, 17, 3
    v_lshrrev_b32 v254, 16, v254
    v_cndmask_b32 v134, v132, v131, vcc
    v_add3_u32 v13, v13, v181, v134
    v_xor_b32 v169, v122, v169
    v_mul_u32_u24 v122, 37, v254
    v_lshrrev_b32 v122, 8, v122
    v_lshlrev_b32 v169, 4, v169
    v_mad_u32_u24 v14, v122, s70, v169
    v_mul_u32_u24 v169, 37, v254
    v_lshrrev_b32 v169, 8, v169
    v_mul_u32_u24 v134, 7, v169
    v_sub_u32 v134, v254, v134
    v_cmp_gt_u32 vcc, 4, v169
    v_mov_b32 v163, 0xc31044fe
    v_mul_u32_u24 v181, 37, v151
    v_cndmask_b32 v169, v129, v119, vcc
    v_cmp_gt_u32 vcc, 4, v134
    v_lshrrev_b32 v181, 8, v181
    v_mul_u32_u24 v122, 7, v181
    v_cndmask_b32 v134, v132, v131, vcc
    v_add3_u32 v14, v14, v169, v134
    v_cmp_gt_u32 vcc, 48, v254
    v_sub_u32 v122, v151, v122
    v_lshrrev_b32 v181, 2, v181
    v_cndmask_b32 v14, v255, v14, vcc
    v_cmp_gt_u32 vcc, 2, v138
    v_lshrrev_b32 v122, 2, v122
    v_and_b32 v181, s5, v181
    v_cndmask_b32 v32, 0, v144, vcc
    v_cndmask_b32 v33, v144, 0, vcc
    v_cndmask_b32 v34, 0, v144, vcc
    v_cndmask_b32 v35, v144, 0, vcc
    v_cmp_eq_u32 vcc, 0, v138
    v_and_b32 v122, s6, v122
    v_lshl_or_b32 v181, v181, 1, v122
    v_cndmask_b32 v40, 0, v145, vcc
    v_cmp_eq_u32 vcc, 1, v138
    v_mul_u32_u24 v254, 37, v152
    v_lshrrev_b32 v254, 8, v254
    v_cndmask_b32 v41, 0, v145, vcc
    v_cmp_eq_u32 vcc, 2, v138
    v_mul_u32_u24 v134, 7, v254
    v_sub_u32 v134, v152, v134
    s_bfm_b32 s70, s17, 0
    s_waitcnt vmcnt(9)
    s_barrier
    global_load_ushort v133, v133, s[46:47]
    v_cndmask_b32 v42, 0, v145, vcc
    v_cmp_eq_u32 vcc, 3, v138
    v_lshrrev_b32 v254, 2, v254
    v_lshrrev_b32 v134, 2, v134
    v_cndmask_b32 v43, 0, v145, vcc
    v_cmp_eq_u32 vcc, v115, v136
    v_and_b32 v254, s5, v254
    v_and_b32 v134, s6, v134
    v_cndmask_b32 v144, 0, v32, vcc
    v_cndmask_b32 v145, 0, v33, vcc
    v_lshl_or_b32 v254, v254, 1, v134
    buffer_load_dwordx4 v126, s[48:51], 0 offen lds
    v_mul_u32_u24 v255, 37, v159
    v_lshrrev_b32 v255, 8, v255
    v_mul_u32_u24 v134, 7, v255
    v_sub_u32 v134, v159, v134
    v_lshrrev_b32 v255, 2, v255
    v_lshrrev_b32 v134, 2, v134
    v_and_b32 v255, s5, v255
    v_and_b32 v134, s6, v134
    v_lshl_or_b32 v255, v255, 1, v134
    v_mul_u32_u24 v134, 6, v120
    v_sub_u32 v159, v114, v134
    v_mul_u32_u24 v134, 384, v120
    v_lshl_add_u32 v134, v159, 4, v134
    v_add_u32 v120, s78, v134
    v_add_u32 v134, s77, v134
    buffer_load_dwordx4 v128, s[48:51], 0 offen offset:1024 lds
    s_waitcnt vmcnt(10)
    ds_read_b64_tr_b16 a[72:73], v141 offset:0
    ds_read_b64_tr_b16 a[74:75], v141 offset:768
    ds_read_b64_tr_b16 a[96:97], v141 offset:32
    ds_read_b64_tr_b16 a[98:99], v141 offset:800
    ds_read_b64_tr_b16 a[120:121], v141 offset:64
    ds_read_b64_tr_b16 a[122:123], v141 offset:832
    v_cmp_gt_i32 vcc, 4, v159
    v_mul_u32_u24 v159, 6, v121
    v_sub_u32 v169, v114, v159
    v_cndmask_b32 v120, v120, v134, vcc
    v_mul_u32_u24 v159, 384, v121
    v_lshl_add_u32 v159, v169, 4, v159
    v_add_u32 v134, s78, v159
    v_add_u32 v159, s77, v159
    buffer_load_dwordx4 v130, s[48:51], 0 offen offset:2048 lds
    s_add_u32 s48, s48, 36864
    s_addc_u32 s49, s49, 0
    s_add_u32 m0, s69, 3072
    v_cmp_gt_i32 vcc, -60, v169
    v_mul_u32_u24 v121, 6, v127
    v_sub_u32 v114, v114, v121
    v_cndmask_b32 v159, v134, v159, vcc
    v_mul_u32_u24 v121, 384, v127
    v_lshl_add_u32 v121, v114, 4, v121
    v_add_u32 v127, s78, v121
    v_add_u32 v121, s77, v121
    v_cmp_gt_i32 vcc, -124, v114
    v_mul_u32_u24 v114, 96, v118
    v_add3_u32 v182, v114, v146, s68
    v_cndmask_b32 v121, v127, v121, vcc
    s_and_b32 s77, s2, 0xf8
    s_add_u32 s77, s77, 4940
    s_mul_i32 s78, s77, 58255
    s_lshr_b32 s78, s78, 22
    buffer_load_dwordx4 v126, s[48:51], 0 offen lds
    v_cmp_gt_u32 vcc, 4, v150
    v_lshl_add_u32 v127, v115, 3, v114
    v_add3_u32 v127, v127, 64, s68
    v_cndmask_b32 v150, v129, v119, vcc
    v_cmp_gt_u32 vcc, 4, v153
    v_add3_u32 v183, v114, v146, s69
    v_lshl_add_u32 v184, v115, 3, v114
    v_cndmask_b32 v153, v132, v131, vcc
    v_add3_u32 v15, v15, v150, v153
    s_waitcnt vmcnt(9)
    ds_read_b64_tr_b16 a[76:77], v141 offset:3072
    ds_read_b64_tr_b16 a[78:79], v141 offset:3840
    s_waitcnt vmcnt(7)
    ds_read_b64_tr_b16 a[100:101], v141 offset:3104
    s_waitcnt vmcnt(6)
    ds_read_b64_tr_b16 a[102:103], v141 offset:3872
    s_waitcnt vmcnt(5)
    buffer_load_dwordx4 v128, s[48:51], 0 offen offset:1024 lds
    ds_read_b64_tr_b16 a[124:125], v141 offset:3136
    ds_read_b64_tr_b16 a[126:127], v141 offset:3904
    v_cndmask_b32 v170, v170, v171, s[92:93]
    v_cndmask_b32 v172, v172, v173, s[92:93]
    v_perm_b32 v164, v172, v170, v137
    v_cndmask_b32 v186, v186, v187, s[92:93]
    v_cndmask_b32 v188, v188, v189, s[92:93]
    v_perm_b32 v165, v188, v186, v137
    v_bfe_u32 v134, v166, v146, 16
    v_bfe_u32 v124, v167, v146, 16
    v_bfe_u32 v122, v168, v146, 16
    v_mfma_f32_16x16x16_bf16 v[170:173], v[116:117], v[134:135], 0
    v_add3_u32 v18, v18, v150, v153
    v_cmp_gt_u32 vcc, 4, v154
    v_add3_u32 v184, v184, 64, s69
    v_mfma_f32_16x16x16_bf16 v[150:153], v[116:117], v[124:125], 0
    v_cndmask_b32 v154, v129, v119, vcc
    v_cmp_gt_u32 vcc, 4, v157
    v_mfma_f32_16x16x16_bf16 v[166:169], v[116:117], v[122:123], 0
    buffer_load_dwordx4 v130, s[48:51], 0 offen offset:2048 lds
    s_add_u32 s48, s48, 36864
    s_addc_u32 s49, s49, 0
    s_add_u32 m0, s72, 0
    v_max_f32 v170, 0, v170
    v_max_f32 v171, 0, v171
    v_max_f32 v172, 0, v172
    v_max_f32 v173, 0, v173
    v_cvt_pk_bf16_f32 v116, v170, v171
    v_cvt_pk_bf16_f32 v117, v172, v173
    v_max_f32 v150, 0, v150
    v_max_f32 v151, 0, v151
    s_waitcnt vmcnt(6)
    v_mfma_f32_16x16x16_bf16 v[122:125], v[164:165], v[116:117], 0
    v_lshlrev_b32 v133, 16, v133
    buffer_load_dwordx4 v126, s[48:51], 0 offen lds
    v_max_f32 v133, 0xc2c80000, v133
    v_min_f32 v133, 0x40930000, v133
    v_mul_f32 v133, 0x3fb8aa3b, v133
    v_exp_f32 v133, v133
    v_max_f32 v152, 0, v152
    v_cvt_pk_bf16_f32 v133, v133, v133
    v_and_b32 v133, 0xffff0000, v133
    v_mul_f32 v133, 0x3fb8aa3b, v133
    v_mul_f32 v146, 0xbea8f5c3, v133
    v_add_f32 v146, 0xc138aa3b, v146
    v_readlane_b32 s31, v133, s90
    v_cvt_pk_bf16_f32 v122, v122, v122
    v_and_b32 v122, 0xffff0000, v122
    v_mul_f32 v122, 0xbfb8aa3b, v122
    buffer_load_dwordx4 v128, s[48:51], 0 offen offset:1024 lds
    v_exp_f32 v122, v122
    v_max_f32 v153, 0, v153
    v_add_f32 v122, 1.0, v122
    v_rcp_f32 v122, v122
    v_cvt_pk_bf16_f32 v150, v150, v151
    v_cvt_pk_bf16_f32 v122, v122, v122
    v_and_b32 v122, 0xffff0000, v122
    v_fmamk_f32 v122, v122, 0x41b8aa3b, v146
    ds_write_b32 v143, v122 offset:0
    v_cvt_pk_bf16_f32 v151, v152, v153
    buffer_load_dwordx4 v130, s[48:51], 0 offen offset:2048 lds
    s_add_u32 s48, s48, 36864
    v_mfma_f32_16x16x16_bf16 v[122:125], v[164:165], v[150:151], 0
    s_addc_u32 s49, s49, 0
    s_add_u32 m0, s72, 3072
    v_max_f32 v166, 0, v166
    v_max_f32 v167, 0, v167
    v_max_f32 v168, 0, v168
    v_max_f32 v169, 0, v169
    v_cvt_pk_bf16_f32 v166, v166, v167
    s_waitcnt vmcnt(6)
    s_mov_b32 s72, 2
    ds_read_b64_tr_b16 a[80:81], v139 offset:0
    ds_read_b64_tr_b16 a[82:83], v139 offset:768
    ds_read_b64_tr_b16 a[104:105], v139 offset:32
    ds_read_b64_tr_b16 a[106:107], v139 offset:800
    ds_read_b64_tr_b16 a[128:129], v139 offset:64
    ds_read_b64_tr_b16 a[130:131], v139 offset:832
    buffer_load_dwordx4 v126, s[48:51], 0 offen lds
    v_cvt_pk_bf16_f32 v122, v122, v122
    v_and_b32 v122, 0xffff0000, v122
    v_mul_f32 v122, 0xbfb8aa3b, v122
    v_exp_f32 v122, v122
    v_cvt_pk_bf16_f32 v167, v168, v169
    v_add_f32 v122, 1.0, v122
    v_rcp_f32 v122, v122
    v_mfma_f32_16x16x16_bf16 v[150:153], v[164:165], v[166:167], 0
    v_cvt_pk_bf16_f32 v122, v122, v122
    v_and_b32 v122, 0xffff0000, v122
    v_fmamk_f32 v122, v122, 0x41b8aa3b, v146
    ds_write_b32 v143, v122 offset:4
    buffer_load_dwordx4 v128, s[48:51], 0 offen offset:1024 lds
    v_cndmask_b32 v157, v132, v131, vcc
    v_add3_u32 v16, v16, v154, v157
    v_add3_u32 v19, v19, v154, v157
    v_cvt_pk_bf16_f32 v150, v150, v150
    v_and_b32 v150, 0xffff0000, v150
    v_mul_f32 v150, 0xbfb8aa3b, v150
    v_exp_f32 v150, v150
    v_cmp_gt_u32 vcc, 4, v156
    v_add_f32 v150, 1.0, v150
    v_rcp_f32 v150, v150
    v_cndmask_b32 v156, v129, v119, vcc
    v_cvt_pk_bf16_f32 v150, v150, v150
    v_and_b32 v150, 0xffff0000, v150
    buffer_load_dwordx4 v130, s[48:51], 0 offen offset:2048 lds
    s_sub_u32 s48, s48, 184704
    s_subb_u32 s49, s49, 0
    s_add_u32 m0, s73, 0
    v_fmamk_f32 v150, v150, 0x41b8aa3b, v146
    ds_write_b32 v143, v150 offset:8
    v_cmp_gt_u32 vcc, 4, v147
    s_nop 0
    s_nop 0
    v_cndmask_b32 v147, v132, v131, vcc
    v_add3_u32 v17, v17, v156, v147
    v_add3_u32 v20, v20, v156, v147
    v_cmp_gt_u32 vcc, 2, v115
    buffer_load_dwordx4 v126, s[48:51], 0 offen lds
    s_waitcnt vmcnt(7)
    ds_read_b64_tr_b16 a[84:85], v139 offset:3072
    ds_read_b64_tr_b16 a[86:87], v139 offset:3840
    ds_read_b64_tr_b16 a[108:109], v139 offset:3104
    ds_read_b64_tr_b16 a[110:111], v139 offset:3872
    ds_read_b64_tr_b16 a[132:133], v139 offset:3136
    ds_read_b64_tr_b16 a[134:135], v139 offset:3904
    v_cndmask_b32 v160, v148, v160, vcc
    v_lshl_add_u32 v160, v136, 9, v160
    v_lshl_add_u32 v160, v138, 1, v160
    v_cmp_gt_u32 vcc, 3, v115
    s_nop 0
    s_nop 0
    v_cndmask_b32 v7, v149, v160, vcc
    v_cmp_gt_u32 vcc, 12, v118
    buffer_load_dwordx4 v128, s[48:51], 0 offen offset:1024 lds
    s_waitcnt lgkmcnt(6)
    s_barrier
    ds_read_b32 v22, v22 offset:0
    ds_read_b32 v23, v23 offset:672
    ds_read_b32 v24, v24 offset:0
    ds_read_b32 v25, v25 offset:672
    ds_read_b32 v26, v26 offset:0
    ds_read_b32 v27, v27 offset:672
    ds_read_b32 v46, v46 offset:336
    ds_read_b32 v58, v58 offset:336
    v_cndmask_b32 v176, v162, v176, vcc
    v_cndmask_b32 v179, v162, v179, vcc
    v_cmp_gt_u32 vcc, 3, v115
    ds_read_b32 v70, v70 offset:336
    ds_read_b32 v47, v47 offset:332
    buffer_load_dwordx4 v130, s[48:51], 0 offen offset:2048 lds
    ds_read_b32 v59, v59 offset:332
    ds_read_b32 v71, v71 offset:332
    ds_read_b32 v48, v48 offset:328
    ds_read_b32 v60, v60 offset:328
    s_add_u32 s48, s48, 36864
    ds_read_b32 v72, v72 offset:328
    s_addc_u32 s49, s49, 0
    ds_read_b32 v49, v49 offset:324
    s_add_u32 m0, s73, 3072
    ds_read_b32 v61, v61 offset:324
    v_cndmask_b32 v178, v162, v178, vcc
    s_mov_b32 s73, 3
    ds_read_b32 v73, v73 offset:324
    ds_read_b32 v50, v50 offset:272
    ds_read_b32 v62, v62 offset:272
    s_waitcnt vmcnt(6)
    buffer_load_dwordx4 v126, s[48:51], 0 offen lds
    ds_read_b64_tr_b16 a[88:89], v140 offset:0
    ds_read_b64_tr_b16 a[90:91], v140 offset:768
    ds_read_b64_tr_b16 a[112:113], v140 offset:32
    ds_read_b64_tr_b16 a[114:115], v140 offset:800
    ds_read_b64_tr_b16 a[136:137], v140 offset:64
    ds_read_b64_tr_b16 a[138:139], v140 offset:832
    ds_read_b32 v74, v74 offset:272
    ds_read_b32 v51, v51 offset:268
    ds_read_b32 v63, v63 offset:268
    buffer_load_dwordx4 v128, s[48:51], 0 offen offset:1024 lds
    ds_read_b32 v75, v75 offset:268
    ds_read_b32 v52, v52 offset:264
    ds_read_b32 v64, v64 offset:264
    ds_read_b32 v76, v76 offset:264
    ds_read_b32 v53, v53 offset:260
    ds_read_b32 v65, v65 offset:260
    ds_read_b32 v77, v77 offset:260
    ds_read_b32 v54, v54 offset:208
    ds_read_b32 v66, v66 offset:208
    buffer_load_dwordx4 v130, s[48:51], 0 offen offset:2048 lds
    ds_read_b32 v78, v78 offset:208
    ds_read_b32 v55, v55 offset:204
    s_add_u32 s48, s48, 36864
    ds_read_b32 v67, v67 offset:204
    s_addc_u32 s49, s49, 0
    ds_read_b32 v79, v79 offset:204
    s_add_u32 m0, s68, 0
    ds_read_b32 v56, v56 offset:200
    ds_read_b32 v68, v68 offset:200
    ds_read_b32 v80, v80 offset:200
    ds_read_b32 v57, v57 offset:196
    ds_read_b32 v69, v69 offset:196
    s_waitcnt vmcnt(6)
    buffer_load_dwordx4 v126, s[48:51], 0 offen lds
    ds_read_b64_tr_b16 a[92:93], v140 offset:3072
    ds_read_b64_tr_b16 a[94:95], v140 offset:3840
    ds_read_b64_tr_b16 a[116:117], v140 offset:3104
    ds_read_b64_tr_b16 a[118:119], v140 offset:3872
    ds_read_b64_tr_b16 a[140:141], v140 offset:3136
    ds_read_b64_tr_b16 a[142:143], v140 offset:3904
    ds_read_b32 v81, v81 offset:196
    ds_read_b32 v155, v155 offset:336
    v_cmp_ne_u32 vcc, s94, v181
    buffer_load_dwordx4 v128, s[48:51], 0 offen offset:1024 lds
    v_lshl_add_u32 v143, v115, 2, 0
    v_cndmask_b32 v129, 0, v163, vcc
    s_waitcnt lgkmcnt(11)
    v_add_f32 v22, v22, v129
    v_cmp_ne_u32 vcc, s94, v181
    v_mul_u32_u24 v129, 37, v143
    v_lshrrev_b32 v129, 8, v129
    v_cndmask_b32 v160, 0, v163, vcc
    v_add_f32 v23, v23, v160
    v_cmp_ne_u32 vcc, s94, v254
    v_mul_u32_u24 v160, 7, v129
    v_sub_u32 v160, v143, v160
    v_cndmask_b32 v143, 0, v163, vcc
    v_add_f32 v24, v24, v143
    v_cmp_ne_u32 vcc, s94, v254
    buffer_load_dwordx4 v130, s[48:51], 0 offen offset:2048 lds
    s_add_u32 s48, s48, 36864
    s_addc_u32 s49, s49, 0
    s_add_u32 m0, s68, 3072
    v_cndmask_b32 v143, 0, v163, vcc
    s_waitcnt lgkmcnt(0)
    v_readfirstlane_b32 s39, v155
    v_add_f32 v25, v25, v143
    v_cmp_ne_u32 vcc, s94, v255
    v_lshrrev_b32 v129, 2, v129
    v_lshrrev_b32 v160, 2, v160
    v_cndmask_b32 v143, 0, v163, vcc
    v_add_f32 v26, v26, v143
    v_cmp_ne_u32 vcc, s94, v255
    v_and_b32 v129, s5, v129
    buffer_load_dwordx4 v126, s[48:51], 0 offen lds
    s_waitcnt vmcnt(7)
    ds_read_b64_tr_b16 a[0:1], v142 offset:0
    ds_read_b64_tr_b16 a[2:3], v142 offset:768
    ds_read_b64_tr_b16 a[24:25], v142 offset:32
    ds_read_b64_tr_b16 a[26:27], v142 offset:800
    ds_read_b64_tr_b16 a[48:49], v142 offset:64
    ds_read_b64_tr_b16 a[50:51], v142 offset:832
    v_cndmask_b32 v143, 0, v163, vcc
    v_add_f32 v27, v27, v143
    v_and_b32 v160, s6, v160
    v_lshl_or_b32 v129, v129, 1, v160
    v_cmp_ne_u32 vcc, v129, v181
    v_lshl_add_u32 v185, v115, 2, 1
    v_mul_u32_u24 v160, 37, v185
    v_cndmask_b32 v143, 0, v163, vcc
    buffer_load_dwordx4 v128, s[48:51], 0 offen offset:1024 lds
    v_add_f32 v46, v46, v143
    v_cmp_ne_u32 vcc, v129, v254
    v_lshrrev_b32 v160, 8, v160
    v_mul_u32_u24 v118, 7, v160
    v_cndmask_b32 v143, 0, v163, vcc
    v_add_f32 v58, v58, v143
    v_cmp_ne_u32 vcc, v129, v255
    v_sub_u32 v118, v185, v118
    v_lshrrev_b32 v160, 2, v160
    v_cndmask_b32 v119, 0, v163, vcc
    v_add_f32 v70, v70, v119
    v_lshrrev_b32 v118, 2, v118
    v_and_b32 v160, s5, v160
    v_and_b32 v118, s6, v118
    v_lshl_or_b32 v160, v160, 1, v118
    buffer_load_dwordx4 v130, s[48:51], 0 offen offset:2048 lds
    s_add_u32 s48, s48, 36864
    s_addc_u32 s49, s49, 0
    s_add_u32 m0, s69, 0
    v_cmp_ne_u32 vcc, v160, v181
    v_lshl_add_u32 v129, v115, 2, 2
    v_mul_u32_u24 v185, 37, v129
    v_cndmask_b32 v143, 0, v163, vcc
    v_add_f32 v47, v47, v143
    v_cmp_ne_u32 vcc, v160, v254
    v_lshrrev_b32 v185, 8, v185
    v_mul_u32_u24 v143, 7, v185
    v_cndmask_b32 v118, 0, v163, vcc
    v_add_f32 v59, v59, v118
    v_cmp_ne_u32 vcc, v160, v255
    v_sub_u32 v143, v129, v143
    buffer_load_dwordx4 v126, s[48:51], 0 offen lds
    s_waitcnt vmcnt(7)
    ds_read_b64_tr_b16 a[4:5], v142 offset:3072
    ds_read_b64_tr_b16 a[6:7], v142 offset:3840
    ds_read_b64_tr_b16 a[28:29], v142 offset:3104
    ds_read_b64_tr_b16 a[30:31], v142 offset:3872
    ds_read_b64_tr_b16 a[52:53], v142 offset:3136
    ds_read_b64_tr_b16 a[54:55], v142 offset:3904
    v_cndmask_b32 v129, 0, v163, vcc
    v_add_f32 v71, v71, v129
    v_lshrrev_b32 v185, 2, v185
    v_lshrrev_b32 v143, 2, v143
    v_and_b32 v185, s5, v185
    v_and_b32 v143, s6, v143
    v_lshl_or_b32 v185, v185, 1, v143
    v_cmp_ne_u32 vcc, v185, v181
    buffer_load_dwordx4 v128, s[48:51], 0 offen offset:1024 lds
    v_lshl_add_u32 v129, v115, 2, 3
    v_cndmask_b32 v160, 0, v163, vcc
    v_add_f32 v48, v48, v160
    v_cmp_ne_u32 vcc, v185, v254
    v_mul_u32_u24 v160, 37, v129
    v_lshrrev_b32 v160, 8, v160
    v_cndmask_b32 v118, 0, v163, vcc
    v_add_f32 v60, v60, v118
    v_cmp_ne_u32 vcc, v185, v255
    v_mul_u32_u24 v185, 7, v160
    v_sub_u32 v185, v129, v185
    v_cndmask_b32 v129, 0, v163, vcc
    v_add_f32 v72, v72, v129
    v_lshrrev_b32 v160, 2, v160
    v_lshrrev_b32 v185, 2, v185
    buffer_load_dwordx4 v130, s[48:51], 0 offen offset:2048 lds
    s_add_u32 s48, s48, 36864
    s_addc_u32 s49, s49, 0
    s_add_u32 m0, s69, 3072
    v_and_b32 v160, s5, v160
    v_and_b32 v185, s6, v185
    v_lshl_or_b32 v160, v160, 1, v185
    v_cmp_ne_u32 vcc, v160, v181
    v_lshl_add_u32 v185, v115, 2, 16
    v_mul_u32_u24 v129, 37, v185
    v_cndmask_b32 v118, 0, v163, vcc
    v_add_f32 v49, v49, v118
    v_cmp_ne_u32 vcc, v160, v254
    v_lshrrev_b32 v129, 8, v129
    v_mul_u32_u24 v118, 7, v129
    v_cndmask_b32 v119, 0, v163, vcc
    buffer_load_dwordx4 v126, s[48:51], 0 offen lds
    s_waitcnt vmcnt(7)
    ds_read_b64_tr_b16 a[8:9], v141 offset:0
    ds_read_b64_tr_b16 a[10:11], v141 offset:768
    ds_read_b64_tr_b16 a[32:33], v141 offset:32
    ds_read_b64_tr_b16 a[34:35], v141 offset:800
    ds_read_b64_tr_b16 a[56:57], v141 offset:64
    ds_read_b64_tr_b16 a[58:59], v141 offset:832
    v_add_f32 v61, v61, v119
    v_cmp_ne_u32 vcc, v160, v255
    v_sub_u32 v118, v185, v118
    v_lshrrev_b32 v129, 2, v129
    v_cndmask_b32 v119, 0, v163, vcc
    v_add_f32 v73, v73, v119
    v_lshrrev_b32 v118, 2, v118
    v_and_b32 v129, s5, v129
    buffer_load_dwordx4 v128, s[48:51], 0 offen offset:1024 lds
    v_and_b32 v118, s6, v118
    v_lshl_or_b32 v129, v129, 1, v118
    v_cmp_ne_u32 vcc, v129, v181
    v_lshl_add_u32 v160, v115, 2, 17
    v_mul_u32_u24 v118, 37, v160
    v_cndmask_b32 v185, 0, v163, vcc
    v_add_f32 v50, v50, v185
    v_cmp_ne_u32 vcc, v129, v254
    v_lshrrev_b32 v118, 8, v118
    v_mul_u32_u24 v185, 7, v118
    v_cndmask_b32 v119, 0, v163, vcc
    v_add_f32 v62, v62, v119
    v_cmp_ne_u32 vcc, v129, v255
    v_sub_u32 v185, v160, v185
    v_lshrrev_b32 v118, 2, v118
    buffer_load_dwordx4 v130, s[48:51], 0 offen offset:2048 lds
    s_sub_u32 s48, s48, 183552
    s_subb_u32 s49, s49, 0
    s_add_u32 m0, s68, 0
    s_waitcnt lgkmcnt(0)
    v_cndmask_b32 v119, 0, v163, vcc
    v_add_f32 v74, v74, v119
    v_lshrrev_b32 v185, 2, v185
    v_and_b32 v118, s5, v118
    v_and_b32 v185, s6, v185
    v_lshl_or_b32 v118, v118, 1, v185
    v_cmp_ne_u32 vcc, v118, v181
    v_lshl_add_u32 v129, v115, 2, 18
    v_mul_u32_u24 v160, 37, v129
    v_cndmask_b32 v119, 0, v163, vcc
    v_add_f32 v51, v51, v119
    buffer_load_dwordx4 v126, s[48:51], 0 offen lds
    s_waitcnt vmcnt(7)
    ds_read_b64_tr_b16 a[12:13], v141 offset:3072
    ds_read_b64_tr_b16 a[14:15], v141 offset:3840
    ds_read_b64_tr_b16 a[36:37], v141 offset:3104
    ds_read_b64_tr_b16 a[38:39], v141 offset:3872
    ds_read_b64_tr_b16 a[60:61], v141 offset:3136
    ds_read_b64_tr_b16 a[62:63], v141 offset:3904
    v_cmp_ne_u32 vcc, v118, v254
    v_lshrrev_b32 v160, 8, v160
    v_mul_u32_u24 v185, 7, v160
    v_cndmask_b32 v119, 0, v163, vcc
    v_add_f32 v63, v63, v119
    v_cmp_ne_u32 vcc, v118, v255
    v_sub_u32 v185, v129, v185
    v_lshrrev_b32 v160, 2, v160
    buffer_load_dwordx4 v128, s[48:51], 0 offen offset:1024 lds
    v_cndmask_b32 v129, 0, v163, vcc
    v_add_f32 v75, v75, v129
    v_lshrrev_b32 v185, 2, v185
    v_and_b32 v160, s5, v160
    v_and_b32 v185, s6, v185
    v_lshl_or_b32 v160, v160, 1, v185
    v_cmp_ne_u32 vcc, v160, v181
    v_lshl_add_u32 v129, v115, 2, 19
    v_mul_u32_u24 v118, 37, v129
    v_cndmask_b32 v185, 0, v163, vcc
    v_add_f32 v52, v52, v185
    v_cmp_ne_u32 vcc, v160, v254
    v_lshrrev_b32 v118, 8, v118
    v_mul_u32_u24 v185, 7, v118
    v_cndmask_b32 v119, 0, v163, vcc
    buffer_load_dwordx4 v130, s[48:51], 0 offen offset:2048 lds
    s_add_u32 s48, s48, 36864
    s_addc_u32 s49, s49, 0
    s_add_u32 m0, s68, 3072
    s_waitcnt lgkmcnt(0)
    v_add_f32 v64, v64, v119
    v_cmp_ne_u32 vcc, v160, v255
    v_sub_u32 v185, v129, v185
    v_lshrrev_b32 v118, 2, v118
    v_cndmask_b32 v119, 0, v163, vcc
    v_add_f32 v76, v76, v119
    v_lshrrev_b32 v185, 2, v185
    v_and_b32 v118, s5, v118
    v_and_b32 v185, s6, v185
    v_lshl_or_b32 v118, v118, 1, v185
    v_cmp_ne_u32 vcc, v118, v181
    buffer_load_dwordx4 v126, s[48:51], 0 offen lds
    s_waitcnt vmcnt(7)
    ds_read_b64_tr_b16 a[16:17], v139 offset:0
    ds_read_b64_tr_b16 a[18:19], v139 offset:768
    ds_read_b64_tr_b16 a[40:41], v139 offset:32
    ds_read_b64_tr_b16 a[42:43], v139 offset:800
    ds_read_b64_tr_b16 a[64:65], v139 offset:64
    ds_read_b64_tr_b16 a[66:67], v139 offset:832
    v_cndmask_b32 v119, 0, v163, vcc
    v_add_f32 v53, v53, v119
    v_cmp_ne_u32 vcc, v118, v254
    v_lshl_add_u32 v160, v115, 2, 32
    v_mul_u32_u24 v129, 37, v160
    v_cndmask_b32 v119, 0, v163, vcc
    v_add_f32 v65, v65, v119
    v_cmp_ne_u32 vcc, v118, v255
    buffer_load_dwordx4 v128, s[48:51], 0 offen offset:1024 lds
    v_lshrrev_b32 v129, 8, v129
    v_cndmask_b32 v185, 0, v163, vcc
    v_add_f32 v77, v77, v185
    v_mul_u32_u24 v185, 7, v129
    v_sub_u32 v185, v160, v185
    v_lshrrev_b32 v129, 2, v129
    v_lshrrev_b32 v185, 2, v185
    v_and_b32 v129, s5, v129
    v_and_b32 v185, s6, v185
    v_lshl_or_b32 v129, v129, 1, v185
    v_cmp_ne_u32 vcc, v129, v181
    v_lshl_add_u32 v118, v115, 2, 33
    v_mul_u32_u24 v185, 37, v118
    v_cndmask_b32 v160, 0, v163, vcc
    v_add_f32 v54, v54, v160
    buffer_load_dwordx4 v130, s[48:51], 0 offen offset:2048 lds
    s_add_u32 s48, s48, 36864
    s_addc_u32 s49, s49, 0
    s_add_u32 m0, s69, 0
    s_waitcnt lgkmcnt(0)
    v_cmp_ne_u32 vcc, v129, v254
    v_lshrrev_b32 v185, 8, v185
    v_mul_u32_u24 v160, 7, v185
    v_cndmask_b32 v119, 0, v163, vcc
    v_add_f32 v66, v66, v119
    v_cmp_ne_u32 vcc, v129, v255
    v_sub_u32 v160, v118, v160
    v_lshrrev_b32 v185, 2, v185
    v_cndmask_b32 v129, 0, v163, vcc
    v_add_f32 v78, v78, v129
    v_lshrrev_b32 v160, 2, v160
    buffer_load_dwordx4 v126, s[48:51], 0 offen lds
    s_waitcnt vmcnt(7)
    ds_read_b64_tr_b16 a[20:21], v139 offset:3072
    ds_read_b64_tr_b16 a[22:23], v139 offset:3840
    ds_read_b64_tr_b16 a[44:45], v139 offset:3104
    ds_read_b64_tr_b16 a[46:47], v139 offset:3872
    ds_read_b64_tr_b16 a[68:69], v139 offset:3136
    ds_read_b64_tr_b16 a[70:71], v139 offset:3904
    v_and_b32 v185, s5, v185
    v_and_b32 v160, s6, v160
    v_lshl_or_b32 v185, v185, 1, v160
    v_cmp_ne_u32 vcc, v185, v181
    v_lshl_add_u32 v129, v115, 2, 34
    v_mul_u32_u24 v160, 37, v129
    v_cndmask_b32 v118, 0, v163, vcc
    v_add_f32 v55, v55, v118
    buffer_load_dwordx4 v128, s[48:51], 0 offen offset:1024 lds
    v_cmp_ne_u32 vcc, v185, v254
    v_lshrrev_b32 v160, 8, v160
    v_mul_u32_u24 v119, 7, v160
    v_cndmask_b32 v118, 0, v163, vcc
    v_add_f32 v67, v67, v118
    v_cmp_ne_u32 vcc, v185, v255
    v_sub_u32 v119, v129, v119
    v_lshrrev_b32 v160, 2, v160
    v_cndmask_b32 v129, 0, v163, vcc
    v_add_f32 v79, v79, v129
    v_lshrrev_b32 v119, 2, v119
    v_and_b32 v160, s5, v160
    v_and_b32 v119, s6, v119
    v_lshl_or_b32 v160, v160, 1, v119
    v_cmp_ne_u32 vcc, v160, v181
    buffer_load_dwordx4 v130, s[48:51], 0 offen offset:2048 lds
    s_add_u32 s48, s48, 36864
    s_addc_u32 s49, s49, 0
    s_add_u32 m0, s69, 3072
    s_waitcnt lgkmcnt(0)
    v_cndmask_b32 v129, 0, v163, vcc
    v_add_f32 v56, v56, v129
    v_cmp_ne_u32 vcc, v160, v254
    v_lshl_add_u32 v129, v115, 2, 35
    v_mul_u32_u24 v118, 37, v129
    v_cndmask_b32 v185, 0, v163, vcc
    v_add_f32 v68, v68, v185
    v_cmp_ne_u32 vcc, v160, v255
    v_lshrrev_b32 v118, 8, v118
    v_mul_u32_u24 v119, 7, v118
    buffer_load_dwordx4 v126, s[48:51], 0 offen lds
    s_waitcnt vmcnt(7)
    ds_read_b64_tr_b16 a[144:145], v141 offset:0
    ds_read_b64_tr_b16 a[146:147], v141 offset:768
    ds_read_b64_tr_b16 a[168:169], v141 offset:32
    ds_read_b64_tr_b16 a[170:171], v141 offset:800
    ds_read_b64_tr_b16 a[192:193], v141 offset:64
    ds_read_b64_tr_b16 a[194:195], v141 offset:832
    v_cndmask_b32 v160, 0, v163, vcc
    v_add_f32 v80, v80, v160
    v_sub_u32 v119, v129, v119
    v_lshrrev_b32 v118, 2, v118
    v_lshrrev_b32 v119, 2, v119
    v_and_b32 v118, s5, v118
    v_and_b32 v119, s6, v119
    v_lshl_or_b32 v118, v118, 1, v119
    buffer_load_dwordx4 v128, s[48:51], 0 offen offset:1024 lds
    v_cmp_ne_u32 vcc, v118, v181
    v_cndmask_b32 v22, v180, v22, s[88:89]
    v_cndmask_b32 v24, v180, v24, s[88:89]
    v_cndmask_b32 v119, 0, v163, vcc
    v_add_f32 v57, v57, v119
    v_cmp_ne_u32 vcc, v118, v254
    v_mov_b32_dpp v23, v25 quad_perm:[0,1,2,3] row_mask:0x2 bank_mask:0xf
    v_cndmask_b32 v26, v180, v26, s[88:89]
    v_cndmask_b32 v119, 0, v163, vcc
    v_add_f32 v69, v69, v119
    v_cmp_ne_u32 vcc, v118, v255
    v_mov_b32_dpp v23, v27 quad_perm:[0,1,2,3] row_mask:0x4 bank_mask:0xf
    v_mov_b32 v134, 0
    v_cndmask_b32 v129, 0, v163, vcc
    v_add_f32 v81, v81, v129
    buffer_load_dwordx4 v130, s[48:51], 0 offen offset:2048 lds
    ds_read_b128 v[150:153], v161 offset:0
    ds_read_b128 v[122:125], v174 offset:0
    ds_read_b128 v[170:173], v161 offset:128
    s_add_u32 s48, s48, 36864
    s_addc_u32 s49, s49, 0
    ds_read_b128 v[162:165], v174 offset:128
    s_add_u32 m0, s68, 0
    s_waitcnt lgkmcnt(4)
    ds_read_b128 v[166:169], v161 offset:256
    ds_read_b128 v[114:117], v174 offset:256
    v_mov_b32 v135, 0
    buffer_load_dwordx4 v126, s[48:51], 0 offen lds
    s_waitcnt vmcnt(7)
    ds_read_b64_tr_b16 a[148:149], v141 offset:3072
    ds_read_b64_tr_b16 a[150:151], v141 offset:3840
    ds_read_b64_tr_b16 a[172:173], v141 offset:3104
    ds_read_b64_tr_b16 a[174:175], v141 offset:3872
    ds_read_b64_tr_b16 a[196:197], v141 offset:3136
    ds_read_b64_tr_b16 a[198:199], v141 offset:3904
    s_waitcnt lgkmcnt(11)
    v_mfma_f32_16x16x32_bf16 v[146:149], a[72:75], v[150:153], 0
    s_waitcnt lgkmcnt(9)
    ds_write_b64 v175, v[134:135] offset:56
    v_mfma_f32_16x16x32_bf16 v[146:149], a[76:79], v[122:125], v[146:149]
    s_waitcnt lgkmcnt(9)
    buffer_load_dwordx4 v128, s[48:51], 0 offen offset:1024 lds
    v_mov_b32 v136, 0
    v_mfma_f32_16x16x32_bf16 v[146:149], a[80:83], v[170:173], v[146:149]
    s_waitcnt lgkmcnt(8)
    ds_write_b64 v175, v[134:135] offset:64
    v_mfma_f32_16x16x32_bf16 v[146:149], a[84:87], v[162:165], v[146:149]
    s_waitcnt lgkmcnt(8)
    v_mov_b32 v137, 0
    v_mfma_f32_16x16x32_bf16 v[146:149], a[88:91], v[166:169], v[146:149]
    s_waitcnt lgkmcnt(6)
    ds_write_b128 v175, v[134:137] offset:16
    v_mfma_f32_16x16x32_bf16 v[146:149], a[92:95], v[114:117], v[146:149]
    s_waitcnt lgkmcnt(3)
    buffer_load_dwordx4 v130, s[48:51], 0 offen offset:2048 lds
    s_add_u32 s48, s48, 36864
    v_mfma_f32_16x16x32_bf16 v[154:157], a[96:99], v[150:153], 0
    s_addc_u32 s49, s49, 0
    s_add_u32 m0, s68, 3072
    v_mfma_f32_16x16x32_bf16 v[154:157], a[100:103], v[122:125], v[154:157]
    ds_write_b128 v176, v[134:137] offset:16
    v_mfma_f32_16x16x32_bf16 v[154:157], a[104:107], v[170:173], v[154:157]
    s_waitcnt vmcnt(6)
    v_fma_f32 v160, v146, v146, s32
    v_fmac_f32 v160, v147, v147
    v_mfma_f32_16x16x32_bf16 v[154:157], a[108:111], v[162:165], v[154:157]
    buffer_load_dwordx4 v126, s[48:51], 0 offen lds
    v_fmac_f32 v160, v148, v148
    v_mfma_f32_16x16x32_bf16 v[154:157], a[112:115], v[166:169], v[154:157]
    ds_read_b64_tr_b16 a[152:153], v139 offset:0
    ds_read_b64_tr_b16 a[154:155], v139 offset:768
    v_mfma_f32_16x16x32_bf16 v[154:157], a[116:119], v[114:117], v[154:157]
    ds_read_b64_tr_b16 a[176:177], v139 offset:32
    ds_read_b64_tr_b16 a[178:179], v139 offset:800
    v_mfma_f32_16x16x32_bf16 v[190:193], a[120:123], v[150:153], 0
    ds_read_b64_tr_b16 a[200:201], v139 offset:64
    ds_read_b64_tr_b16 a[202:203], v139 offset:832
    v_mfma_f32_16x16x32_bf16 v[190:193], a[124:127], v[122:125], v[190:193]
    ds_read_b128 v[202:205], v161 offset:6144
    ds_read_b128 v[230:233], v174 offset:6144
    v_mfma_f32_16x16x32_bf16 v[190:193], a[128:131], v[170:173], v[190:193]
    buffer_load_dwordx4 v128, s[48:51], 0 offen offset:1024 lds
    ds_read_b128 v[238:241], v161 offset:6272
    v_mfma_f32_16x16x32_bf16 v[190:193], a[132:135], v[162:165], v[190:193]
    ds_read_b128 v[206:209], v174 offset:6272
    ds_read_b128 v[198:201], v161 offset:6400
    v_mfma_f32_16x16x32_bf16 v[190:193], a[136:139], v[166:169], v[190:193]
    v_fmac_f32 v160, v149, v149
    v_fmac_f32 v160, v154, v154
    v_mfma_f32_16x16x32_bf16 v[190:193], a[140:143], v[114:117], v[190:193]
    ds_read_b128 v[210:213], v174 offset:6400
    v_fmac_f32 v160, v155, v155
    v_mfma_f32_16x16x32_bf16 v[214:217], a[0:3], v[150:153], 0
    s_waitcnt lgkmcnt(10)
    ds_write_b64 v176, v[134:135] offset:56
    v_mfma_f32_16x16x32_bf16 v[214:217], a[4:7], v[122:125], v[214:217]
    s_waitcnt lgkmcnt(8)
    buffer_load_dwordx4 v130, s[48:51], 0 offen offset:2048 lds
    v_fmac_f32 v160, v156, v156
    v_mfma_f32_16x16x32_bf16 v[214:217], a[8:11], v[170:173], v[214:217]
    s_waitcnt lgkmcnt(6)
    ds_write_b64 v176, v[134:135] offset:64
    v_mfma_f32_16x16x32_bf16 v[130:133], a[72:75], v[202:205], 0
    s_waitcnt vmcnt(6)
    v_fmac_f32 v160, v157, v157
    v_fmac_f32 v160, v190, v190
    v_mfma_f32_16x16x32_bf16 v[218:221], a[96:99], v[202:205], 0
    s_waitcnt lgkmcnt(3)
    ds_read_b64_tr_b16 a[156:157], v139 offset:3072
    ds_read_b64_tr_b16 a[158:159], v139 offset:3840
    v_mfma_f32_16x16x32_bf16 v[130:133], a[76:79], v[230:233], v[130:133]
    s_add_u32 m0, s28, 8192
    ds_read_b64_tr_b16 a[180:181], v139 offset:3104
    ds_read_b64_tr_b16 a[182:183], v139 offset:3872
    v_mfma_f32_16x16x32_bf16 v[130:133], a[80:83], v[238:241], v[130:133]
    s_waitcnt lgkmcnt(6)
    buffer_load_dwordx4 v12, s[8:11], s25 offen nt lds
    v_mfma_f32_16x16x32_bf16 v[130:133], a[84:87], v[206:209], v[130:133]
    s_add_u32 m0, s28, 12288
    ds_read_b64_tr_b16 a[204:205], v139 offset:3136
    ds_read_b64_tr_b16 a[206:207], v139 offset:3904
    v_mfma_f32_16x16x32_bf16 v[130:133], a[88:91], v[198:201], v[130:133]
    v_fmac_f32 v160, v191, v191
    v_fmac_f32 v160, v192, v192
    v_mfma_f32_16x16x32_bf16 v[130:133], a[92:95], v[210:213], v[130:133]
    v_fmac_f32 v160, v193, v193
    v_mfma_f32_16x16x32_bf16 v[218:221], a[100:103], v[230:233], v[218:221]
    v_mfma_f32_16x16x32_bf16 v[218:221], a[104:107], v[238:241], v[218:221]
    buffer_load_dwordx4 v13, s[8:11], s25 offen nt lds
    v_mfma_f32_16x16x32_bf16 v[218:221], a[108:111], v[206:209], v[218:221]
    s_add_u32 m0, s29, 0
    v_mfma_f32_16x16x32_bf16 v[218:221], a[112:115], v[198:201], v[218:221]
    s_waitcnt lgkmcnt(2)
    v_fma_f32 v181, v130, v130, s32
    v_fmac_f32 v181, v131, v131
    v_mfma_f32_16x16x32_bf16 v[218:221], a[116:119], v[210:213], v[218:221]
    v_fmac_f32 v181, v132, v132
    v_fmac_f32 v181, v133, v133
    v_mfma_f32_16x16x32_bf16 v[222:225], a[120:123], v[202:205], 0
    s_waitcnt lgkmcnt(0)
    v_mfma_f32_16x16x32_bf16 v[222:225], a[124:127], v[230:233], v[222:225]
    buffer_load_dwordx4 v14, s[8:11], s25 offen nt lds
    v_mfma_f32_16x16x32_bf16 v[222:225], a[128:131], v[238:241], v[222:225]
    s_add_u32 m0, s69, 0
    s_waitcnt vmcnt(6)
    ds_read_b64_tr_b16 a[160:161], v141 offset:0
    v_mfma_f32_16x16x32_bf16 v[222:225], a[132:135], v[206:209], v[222:225]
    s_lshr_b32 s10, s17, 1
    ds_read_b64_tr_b16 a[162:163], v141 offset:768
    ds_read_b64_tr_b16 a[184:185], v141 offset:32
    v_mfma_f32_16x16x32_bf16 v[222:225], a[136:139], v[198:201], v[222:225]
    s_cselect_b32 s10, s36, 0
    ds_read_b64_tr_b16 a[186:187], v141 offset:800
    ds_read_b64_tr_b16 a[208:209], v141 offset:64
    v_mfma_f32_16x16x32_bf16 v[222:225], a[140:143], v[210:213], v[222:225]
    s_mov_b32 s25, s24
    ds_read_b64_tr_b16 a[210:211], v141 offset:832
    v_fmac_f32 v181, v218, v218
    v_mfma_f32_16x16x32_bf16 v[214:217], a[12:15], v[162:165], v[214:217]
    buffer_load_dwordx4 v120, s[52:55], 0 offen lds
    v_fmac_f32 v181, v219, v219
    v_mfma_f32_16x16x32_bf16 v[214:217], a[16:19], v[166:169], v[214:217]
    v_fmac_f32 v181, v220, v220
    v_fmac_f32 v181, v221, v221
    v_mfma_f32_16x16x32_bf16 v[214:217], a[20:23], v[114:117], v[214:217]
    v_fmac_f32 v181, v222, v222
    v_fmac_f32 v181, v223, v223
    v_mfma_f32_16x16x32_bf16 v[134:137], a[24:27], v[150:153], 0
    v_fmac_f32 v181, v224, v224
    v_fmac_f32 v181, v225, v225
    v_mfma_f32_16x16x32_bf16 v[134:137], a[28:31], v[122:125], v[134:137]
    s_waitcnt lgkmcnt(5)
    v_xor_b32 v185, 65536, v2
    v_fma_f32 v118, v214, v214, s32
    v_mfma_f32_16x16x32_bf16 v[134:137], a[32:35], v[170:173], v[134:137]
    s_waitcnt lgkmcnt(3)
    buffer_load_dwordx4 v159, s[52:55], 0 offen offset:1024 lds
    v_fmac_f32 v118, v215, v215
    v_mfma_f32_16x16x32_bf16 v[134:137], a[36:39], v[162:165], v[134:137]
    s_waitcnt lgkmcnt(1)
    v_fmac_f32 v118, v216, v216
    v_fmac_f32 v118, v217, v217
    v_mfma_f32_16x16x32_bf16 v[134:137], a[40:43], v[166:169], v[134:137]
    s_waitcnt lgkmcnt(0)
    v_lshrrev_b32 v142, 2, v185
    v_lshrrev_b32 v143, 8, v185
    v_mfma_f32_16x16x32_bf16 v[134:137], a[44:47], v[114:117], v[134:137]
    v_lshl_add_u32 v254, s16, 2, v185
    v_add_u32 v142, 62784, v142
    v_mfma_f32_16x16x32_bf16 v[226:229], a[48:51], v[150:153], 0
    v_lshlrev_b32 v143, 4, v143
    v_add_u32 v143, 62784, v143
    v_mfma_f32_16x16x32_bf16 v[226:229], a[52:55], v[122:125], v[226:229]
    buffer_load_dwordx4 v121, s[52:55], 0 offen offset:2048 lds
    v_or_b32 v234, v32, v33
    v_mfma_f32_16x16x32_bf16 v[226:229], a[56:59], v[170:173], v[226:229]
    s_add_u32 s52, s52, 12288
    s_waitcnt vmcnt(6)
    ds_read_b64_tr_b16 a[164:165], v141 offset:3072
    v_mfma_f32_16x16x32_bf16 v[226:229], a[60:63], v[162:165], v[226:229]
    s_addc_u32 s53, s53, 0
    ds_read_b64_tr_b16 a[166:167], v141 offset:3840
    ds_read_b64_tr_b16 a[188:189], v141 offset:3104
    v_mfma_f32_16x16x32_bf16 v[226:229], a[64:67], v[166:169], v[226:229]
    s_add_u32 m0, s69, 3072
    ds_read_b64_tr_b16 a[190:191], v141 offset:3872
    ds_read_b64_tr_b16 a[212:213], v141 offset:3136
    v_mfma_f32_16x16x32_bf16 v[226:229], a[68:71], v[114:117], v[226:229]
    ds_read_b64_tr_b16 a[214:215], v141 offset:3904
    v_fmac_f32 v118, v134, v134
    v_mfma_f32_16x16x32_bf16 v[138:141], a[0:3], v[202:205], 0
    buffer_load_dwordx4 v120, s[52:55], 0 offen lds
    v_fmac_f32 v118, v135, v135
    v_mfma_f32_16x16x32_bf16 v[138:141], a[4:7], v[230:233], v[138:141]
    v_fmac_f32 v118, v136, v136
    v_fmac_f32 v118, v137, v137
    v_mfma_f32_16x16x32_bf16 v[138:141], a[8:11], v[238:241], v[138:141]
    v_fmac_f32 v118, v226, v226
    v_fmac_f32 v118, v227, v227
    v_mfma_f32_16x16x32_bf16 v[138:141], a[12:15], v[206:209], v[138:141]
    v_fmac_f32 v118, v228, v228
    v_fmac_f32 v118, v229, v229
    v_mfma_f32_16x16x32_bf16 v[138:141], a[16:19], v[198:201], v[138:141]
    s_waitcnt lgkmcnt(5)
    v_cvt_pk_bf16_f32 v36, v118, v160
    v_and_b32 v234, 0xffff, v234
    v_mfma_f32_16x16x32_bf16 v[138:141], a[20:23], v[210:213], v[138:141]
    s_waitcnt lgkmcnt(3)
    buffer_load_dwordx4 v159, s[52:55], 0 offen offset:1024 lds
    v_lshl_or_b32 v234, v234, 16, v234
    v_mfma_f32_16x16x32_bf16 v[242:245], v[32:35], v[36:39], 0
    s_waitcnt lgkmcnt(1)
    v_or_b32 v235, v32, v33
    v_and_b32 v235, 0xffff, v235
    v_mfma_f32_16x16x32_bf16 v[114:117], a[24:27], v[202:205], 0
    s_waitcnt lgkmcnt(0)
    v_lshl_or_b32 v235, v235, 16, v235
    v_or_b32 v236, v32, v33
    v_mfma_f32_16x16x32_bf16 v[114:117], a[28:31], v[230:233], v[114:117]
    v_rsq_f32 v243, v243
    v_mfma_f32_16x16x32_bf16 v[114:117], a[32:35], v[238:241], v[114:117]
    v_rsq_f32 v242, v242
    v_mfma_f32_16x16x32_bf16 v[114:117], a[36:39], v[206:209], v[114:117]
    buffer_load_dwordx4 v121, s[52:55], 0 offen offset:2048 lds
    ds_read_b128 v[186:189], v0 offset:20480
    v_mfma_f32_16x16x32_bf16 v[114:117], a[40:43], v[198:201], v[114:117]
    s_add_u32 s52, s52, 12288
    ds_read_b128 v[194:197], v1 offset:20480
    v_mul_f32 v242, s31, v242
    v_mfma_f32_16x16x32_bf16 v[114:117], a[44:47], v[210:213], v[114:117]
    s_addc_u32 s53, s53, 0
    ds_read_b128 v[122:125], v0 offset:20608
    v_mul_f32 v146, v243, v146
    v_mfma_f32_16x16x32_bf16 v[246:249], a[48:51], v[202:205], 0
    s_add_u32 m0, s68, 0
    ds_read_b128 v[202:205], v1 offset:20608
    v_mul_f32 v147, v243, v147
    v_mfma_f32_16x16x32_bf16 v[246:249], a[52:55], v[230:233], v[246:249]
    ds_read_b128 v[230:233], v0 offset:20736
    v_cvt_pk_f16_f32 v150, v146, v147
    v_mfma_f32_16x16x32_bf16 v[246:249], a[56:59], v[238:241], v[246:249]
    buffer_load_dwordx4 v120, s[52:55], 0 offen lds
    ds_read_b128 v[238:241], v1 offset:20736
    v_mfma_f32_16x16x32_bf16 v[246:249], a[60:63], v[206:209], v[246:249]
    v_mul_f32 v148, v243, v148
    v_mul_f32 v149, v243, v149
    v_mfma_f32_16x16x32_bf16 v[246:249], a[64:67], v[198:201], v[246:249]
    v_cvt_pk_f16_f32 v151, v148, v149
    v_mul_f32 v154, v243, v154
    v_mfma_f32_16x16x32_bf16 v[246:249], a[68:71], v[210:213], v[246:249]
    s_waitcnt lgkmcnt(5)
    v_mul_f32 v155, v243, v155
    v_cvt_pk_f16_f32 v152, v154, v155
    v_mfma_f32_16x16x32_bf16 v[162:165], a[96:99], v[186:189], 0
    s_waitcnt lgkmcnt(4)
    v_mul_f32 v156, v243, v156
    v_mul_f32 v157, v243, v157
    v_mfma_f32_16x16x32_bf16 v[162:165], a[100:103], v[194:197], v[162:165]
    s_waitcnt lgkmcnt(3)
    v_cvt_pk_f16_f32 v153, v156, v157
    v_mul_f32 v190, v243, v190
    v_mfma_f32_16x16x32_bf16 v[162:165], a[104:107], v[122:125], v[162:165]
    s_waitcnt lgkmcnt(2)
    ds_write_b128 v175, v[150:153]
    v_mfma_f32_16x16x32_bf16 v[162:165], a[108:111], v[202:205], v[162:165]
    s_waitcnt lgkmcnt(1)
    v_mul_f32 v191, v243, v191
    v_cvt_pk_f16_f32 v208, v190, v191
    v_mfma_f32_16x16x32_bf16 v[162:165], a[112:115], v[230:233], v[162:165]
    v_mul_f32 v192, v243, v192
    v_mul_f32 v193, v243, v193
    v_mfma_f32_16x16x32_bf16 v[162:165], a[116:119], v[238:241], v[162:165]
    v_cvt_pk_f16_f32 v209, v192, v193
    v_mul_f32 v214, v242, v214
    v_mfma_f32_16x16x32_bf16 v[170:173], a[120:123], v[186:189], 0
    ds_write_b64 v175, v[208:209] offset:48
    v_mfma_f32_16x16x32_bf16 v[170:173], a[124:127], v[194:197], v[170:173]
    v_mul_f32 v215, v242, v215
    v_cvt_pk_f16_f32 v150, v214, v215
    v_mfma_f32_16x16x32_bf16 v[170:173], a[128:131], v[122:125], v[170:173]
    v_mul_f32 v216, v242, v216
    v_mul_f32 v217, v242, v217
    v_mfma_f32_16x16x32_bf16 v[170:173], a[132:135], v[202:205], v[170:173]
    v_cvt_pk_f16_f32 v151, v216, v217
    v_mul_f32 v134, v242, v134
    v_mfma_f32_16x16x32_bf16 v[170:173], a[136:139], v[230:233], v[170:173]
    v_mul_f32 v135, v242, v135
    v_cvt_pk_f16_f32 v152, v134, v135
    v_mfma_f32_16x16x32_bf16 v[170:173], a[140:143], v[238:241], v[170:173]
    v_mul_f32 v136, v242, v136
    v_mul_f32 v137, v242, v137
    v_mfma_f32_16x16x32_bf16 v[166:169], a[24:27], v[186:189], 0
    v_cvt_pk_f16_f32 v153, v136, v137
    v_mul_f32 v226, v242, v226
    v_mfma_f32_16x16x32_bf16 v[166:169], a[28:31], v[194:197], v[166:169]
    ds_write_b128 v175, v[150:153] offset:32
    v_mfma_f32_16x16x32_bf16 v[150:153], a[72:75], v[186:189], 0
    v_mul_f32 v227, v242, v227
    v_cvt_pk_f16_f32 v206, v226, v227
    v_mfma_f32_16x16x32_bf16 v[150:153], a[76:79], v[194:197], v[150:153]
    v_mul_f32 v228, v242, v228
    v_mul_f32 v229, v242, v229
    v_mfma_f32_16x16x32_bf16 v[150:153], a[80:83], v[122:125], v[150:153]
    v_cvt_pk_f16_f32 v207, v228, v229
    v_mul_f32 v146, v214, v146
    v_mfma_f32_16x16x32_bf16 v[150:153], a[84:87], v[202:205], v[150:153]
    ds_write_b64 v175, v[206:207] offset:72
    v_mfma_f32_16x16x32_bf16 v[150:153], a[88:91], v[230:233], v[150:153]
    v_fmac_f32 v146, v215, v147
    v_fmac_f32 v146, v216, v148
    v_mfma_f32_16x16x32_bf16 v[150:153], a[92:95], v[238:241], v[150:153]
    v_fmac_f32 v146, v217, v149
    v_fmac_f32 v146, v134, v154
    v_mfma_f32_16x16x32_bf16 v[166:169], a[32:35], v[122:125], v[166:169]
    v_fmac_f32 v146, v135, v155
    v_fmac_f32 v146, v136, v156
    v_mfma_f32_16x16x32_bf16 v[166:169], a[36:39], v[202:205], v[166:169]
    v_fmac_f32 v146, v137, v157
    v_fmac_f32 v146, v226, v190
    v_mfma_f32_16x16x32_bf16 v[166:169], a[40:43], v[230:233], v[166:169]
    v_fmac_f32 v146, v227, v191
    v_fmac_f32 v146, v228, v192
    v_mfma_f32_16x16x32_bf16 v[166:169], a[44:47], v[238:241], v[166:169]
    v_fmac_f32 v146, v229, v193
    v_mov_b32 v160, v146
    v_mfma_f32_16x16x32_bf16 v[134:137], a[48:51], v[186:189], 0
    v_lshrrev_b32 v236, 16, v236
    v_lshl_or_b32 v236, v236, 16, v236
    v_mfma_f32_16x16x32_bf16 v[134:137], a[52:55], v[194:197], v[134:137]
    v_permlane32_swap_b32 v146, v160
    v_mfma_f32_16x16x32_bf16 v[134:137], a[56:59], v[122:125], v[134:137]
    v_add_f32 v146, v146, v160
    v_mov_b32 v160, v146
    v_mfma_f32_16x16x32_bf16 v[134:137], a[60:63], v[202:205], v[134:137]
    v_or_b32 v237, v32, v33
    v_lshrrev_b32 v237, 16, v237
    v_mfma_f32_16x16x32_bf16 v[134:137], a[64:67], v[230:233], v[134:137]
    v_permlane16_swap_b32 v146, v160
    v_mfma_f32_16x16x32_bf16 v[134:137], a[68:71], v[238:241], v[134:137]
    v_add_f32 v146, v146, v160
    v_add_f32 v146, s39, v146
    v_mfma_f32_16x16x32_bf16 v[154:157], v[186:189], a[144:147], 0
    v_mov_b32 v147, v180
    v_mov_b32 v148, v180
    v_mfma_f32_16x16x32_bf16 v[154:157], v[194:197], a[148:151], v[154:157]
    v_mov_b32 v149, v180
    v_cndmask_b32 v146, v180, v146, s[88:89]
    v_mfma_f32_16x16x32_bf16 v[154:157], v[122:125], a[152:155], v[154:157]
    ds_write_b128 v158, v[146:149] offset:192
    v_mfma_f32_16x16x32_bf16 v[154:157], v[202:205], a[156:159], v[154:157]
    v_lshl_or_b32 v237, v237, 16, v237
    v_fma_f32 v175, v138, v138, s32
    v_mfma_f32_16x16x32_bf16 v[154:157], v[230:233], a[160:163], v[154:157]
    v_fmac_f32 v175, v139, v139
    v_fmac_f32 v175, v140, v140
    v_mfma_f32_16x16x32_bf16 v[154:157], v[238:241], a[164:167], v[154:157]
    v_fmac_f32 v175, v141, v141
    v_fmac_f32 v175, v114, v114
    v_mfma_f32_16x16x32_bf16 v[146:149], v[186:189], a[168:171], 0
    v_fmac_f32 v175, v115, v115
    v_fmac_f32 v175, v116, v116
    v_mfma_f32_16x16x32_bf16 v[146:149], v[194:197], a[172:175], v[146:149]
    v_fmac_f32 v175, v117, v117
    v_fmac_f32 v175, v246, v246
    v_mfma_f32_16x16x32_bf16 v[146:149], v[122:125], a[176:179], v[146:149]
    v_fmac_f32 v175, v247, v247
    v_fmac_f32 v175, v248, v248
    v_mfma_f32_16x16x32_bf16 v[146:149], v[202:205], a[180:183], v[146:149]
    ds_read_b128 v[190:193], v161 offset:0
    v_fmac_f32 v175, v249, v249
    v_mfma_f32_16x16x32_bf16 v[146:149], v[230:233], a[184:187], v[146:149]
    ds_read_b128 v[206:209], v174 offset:0
    v_cvt_pk_bf16_f32 v36, v175, v181
    v_mfma_f32_16x16x32_bf16 v[146:149], v[238:241], a[188:191], v[146:149]
    ds_read_b128 v[214:217], v161 offset:128
    v_fma_f32 v255, v150, v150, s32
    v_fmac_f32 v255, v151, v151
    v_fmac_f32 v255, v152, v152
    v_fmac_f32 v255, v153, v153
    v_fmac_f32 v255, v162, v162
    v_fmac_f32 v255, v163, v163
    v_fmac_f32 v255, v164, v164
    v_fmac_f32 v255, v165, v165
    v_fmac_f32 v255, v170, v170
    v_fmac_f32 v255, v171, v171
    v_fmac_f32 v255, v172, v172
    v_fmac_f32 v255, v173, v173
    v_cvt_pk_bf16_f32 v118, v154, v155
    v_mfma_f32_16x16x32_bf16 v[198:201], v[32:35], v[36:39], 0
    v_cvt_pk_bf16_f32 v119, v156, v157
    v_cvt_pk_bf16_f32 v146, v146, v147
    v_mfma_f32_16x16x32_bf16 v[154:157], v[186:189], a[192:195], 0
    v_cvt_pk_bf16_f32 v147, v148, v149
    v_xor_b32 v2, 65536, v2
    v_mfma_f32_16x16x32_bf16 v[154:157], v[194:197], a[196:199], v[154:157]
    s_waitcnt lgkmcnt(2)
    v_mfma_f32_16x16x32_bf16 v[154:157], v[122:125], a[200:203], v[154:157]
    s_waitcnt lgkmcnt(1)
    v_rsq_f32 v199, v199
    v_mfma_f32_16x16x32_bf16 v[154:157], v[202:205], a[204:207], v[154:157]
    s_waitcnt lgkmcnt(0)
    v_rsq_f32 v198, v198
    v_mfma_f32_16x16x32_bf16 v[154:157], v[230:233], a[208:211], v[154:157]
    v_mul_f32 v198, s31, v198
    v_mul_f32 v130, v199, v130
    v_mfma_f32_16x16x32_bf16 v[154:157], v[238:241], a[212:215], v[154:157]
    v_mul_f32 v131, v199, v131
    v_cvt_pk_f16_f32 v210, v130, v131
    v_mul_f32 v132, v199, v132
    v_mul_f32 v133, v199, v133
    v_cvt_pk_f16_f32 v211, v132, v133
    v_mul_f32 v218, v199, v218
    v_mul_f32 v219, v199, v219
    v_cvt_pk_f16_f32 v212, v218, v219
    v_mul_f32 v220, v199, v220
    v_mul_f32 v221, v199, v221
    v_cvt_pk_f16_f32 v213, v220, v221
    v_mul_f32 v222, v199, v222
    v_mul_f32 v223, v199, v223
    v_cvt_pk_f16_f32 v228, v222, v223
    v_mul_f32 v224, v199, v224
    v_mul_f32 v225, v199, v225
    v_cvt_pk_f16_f32 v229, v224, v225
    v_mul_f32 v138, v198, v138
    v_mul_f32 v139, v198, v139
    v_cvt_pk_f16_f32 v242, v138, v139
    v_mul_f32 v140, v198, v140
    v_mul_f32 v141, v198, v141
    v_cvt_pk_f16_f32 v243, v140, v141
    v_mul_f32 v114, v198, v114
    v_mul_f32 v115, v198, v115
    v_cvt_pk_f16_f32 v244, v114, v115
    v_mul_f32 v116, v198, v116
    v_mul_f32 v117, v198, v117
    v_cvt_pk_f16_f32 v245, v116, v117
    v_mul_f32 v246, v198, v246
    v_mul_f32 v247, v198, v247
    v_cvt_pk_f16_f32 v226, v246, v247
    v_mul_f32 v248, v198, v248
    v_mul_f32 v249, v198, v249
    v_cvt_pk_f16_f32 v227, v248, v249
    v_mul_f32 v130, v138, v130
    v_fmac_f32 v130, v139, v131
    buffer_load_dwordx4 v159, s[52:55], 0 offen offset:1024 lds
    ds_write_b128 v176, v[210:213]
    v_fmac_f32 v130, v140, v132
    v_fmac_f32 v130, v141, v133
    v_fmac_f32 v130, v114, v218
    v_mfma_f32_16x16x32_bf16 v[138:141], a[0:3], v[186:189], 0
    v_fmac_f32 v130, v115, v219
    v_fmac_f32 v130, v116, v220
    v_mfma_f32_16x16x32_bf16 v[138:141], a[4:7], v[194:197], v[138:141]
    ds_read_b128 v[194:197], v174 offset:128
    ds_read_b128 v[186:189], v161 offset:256
    v_mfma_f32_16x16x32_bf16 v[138:141], a[8:11], v[122:125], v[138:141]
    ds_read_b128 v[122:125], v174 offset:256
    buffer_load_dwordx4 v121, s[52:55], 0 offen offset:2048 lds
    v_mfma_f32_16x16x32_bf16 v[138:141], a[12:15], v[202:205], v[138:141]
    s_add_u32 s52, s52, 12288
    ds_write_b64 v176, v[228:229] offset:48
    v_mfma_f32_16x16x32_bf16 v[138:141], a[16:19], v[230:233], v[138:141]
    s_addc_u32 s53, s53, 0
    v_fmac_f32 v130, v117, v221
    v_fmac_f32 v130, v246, v222
    v_mfma_f32_16x16x32_bf16 v[138:141], a[20:23], v[238:241], v[138:141]
    s_add_u32 m0, s68, 3072
    ds_write_b128 v176, v[242:245] offset:32
    v_mfma_f32_16x16x32_bf16 v[114:117], v[190:193], a[144:147], 0
    s_mul_i32 s68, s78, 72
    v_fmac_f32 v130, v247, v223
    v_fmac_f32 v130, v248, v224
    v_mfma_f32_16x16x32_bf16 v[114:117], v[206:209], a[148:151], v[114:117]
    buffer_load_dwordx4 v120, s[52:55], 0 offen lds
    v_fmac_f32 v130, v249, v225
    v_mfma_f32_16x16x32_bf16 v[114:117], v[214:217], a[152:155], v[114:117]
    s_waitcnt lgkmcnt(3)
    ds_write_b64 v176, v[226:227] offset:72
    v_mfma_f32_16x16x32_bf16 v[114:117], v[194:197], a[156:159], v[114:117]
    s_sub_u32 s68, s77, s68
    v_mov_b32 v148, v130
    v_fma_f32 v181, v138, v138, s32
    v_mfma_f32_16x16x32_bf16 v[114:117], v[186:189], a[160:163], v[114:117]
    s_waitcnt lgkmcnt(2)
    v_permlane32_swap_b32 v130, v148
    v_mfma_f32_16x16x32_bf16 v[114:117], v[122:125], a[164:167], v[114:117]
    s_mul_i32 s78, s78, 1373568
    v_add_f32 v130, v130, v148
    v_mov_b32 v148, v130
    v_mfma_f32_16x16x32_bf16 v[230:233], v[190:193], a[168:171], 0
    buffer_load_dwordx4 v159, s[52:55], 0 offen offset:1024 lds
    v_fmac_f32 v181, v139, v139
    v_mfma_f32_16x16x32_bf16 v[230:233], v[206:209], a[172:175], v[230:233]
    s_mul_i32 s77, s68, 2688
    v_permlane16_swap_b32 v130, v148
    v_mfma_f32_16x16x32_bf16 v[230:233], v[214:217], a[176:179], v[230:233]
    s_add_u32 s77, s77, s78
    v_add_f32 v130, v130, v148
    v_add_f32 v130, s39, v130
    v_mfma_f32_16x16x32_bf16 v[230:233], v[194:197], a[180:183], v[230:233]
    ds_read_b128 v[238:241], v161 offset:6144
    v_mov_b32 v131, v180
    v_mfma_f32_16x16x32_bf16 v[230:233], v[186:189], a[184:187], v[230:233]
    ds_read_b128 v[202:205], v174 offset:6144
    v_mov_b32 v132, v180
    v_mfma_f32_16x16x32_bf16 v[230:233], v[122:125], a[188:191], v[230:233]
    buffer_load_dwordx4 v121, s[52:55], 0 offen offset:2048 lds
    ds_read_b128 v[218:221], v161 offset:6272
    v_mfma_f32_16x16x32_bf16 v[222:225], v[190:193], a[192:195], 0
    s_add_u32 s52, s52, 12288
    ds_read_b128 v[190:193], v174 offset:6272
    v_mov_b32 v133, v180
    v_mfma_f32_16x16x32_bf16 v[222:225], v[206:209], a[196:199], v[222:225]
    s_waitcnt vmcnt(9)
    ds_read_b64 a[216:217], v183 offset:0
    ds_read_b64 a[218:219], v183 offset:1536
    v_mfma_f32_16x16x32_bf16 v[222:225], v[214:217], a[200:203], v[222:225]
    s_addc_u32 s53, s53, 0
    ds_read_b64 a[240:241], v183 offset:8
    ds_read_b64 a[242:243], v183 offset:1544
    v_mfma_f32_16x16x32_bf16 v[222:225], v[194:197], a[204:207], v[222:225]
    s_add_u32 m0, s69, 0
    ds_read_b64 v[90:91], v184 offset:0
    ds_read_b64 v[92:93], v184 offset:1536
    v_mfma_f32_16x16x32_bf16 v[222:225], v[186:189], a[208:211], v[222:225]
    ds_read_b128 v[194:197], v161 offset:6400
    ds_read_b128 v[186:189], v174 offset:6400
    v_mfma_f32_16x16x32_bf16 v[222:225], v[122:125], a[212:215], v[222:225]
    s_waitcnt lgkmcnt(11)
    v_cndmask_b32 v130, v180, v130, s[88:89]
    v_fmac_f32 v181, v140, v140
    v_mfma_f32_16x16x32_bf16 v[122:125], v[238:241], a[144:147], 0
    s_waitcnt lgkmcnt(10)
    ds_write_b128 v179, v[130:133] offset:192
    v_mfma_f32_16x16x32_bf16 v[122:125], v[202:205], a[148:151], v[122:125]
    s_waitcnt lgkmcnt(9)
    v_fmac_f32 v181, v141, v141
    v_fmac_f32 v181, v166, v166
    v_mfma_f32_16x16x32_bf16 v[122:125], v[218:221], a[152:155], v[122:125]
    s_waitcnt lgkmcnt(7)
    v_fmac_f32 v181, v167, v167
    v_fmac_f32 v181, v168, v168
    v_mfma_f32_16x16x32_bf16 v[130:133], v[234:237], a[216:219], 0
    s_waitcnt lgkmcnt(5)
    v_fmac_f32 v181, v169, v169
    v_fmac_f32 v181, v134, v134
    v_mfma_f32_16x16x32_bf16 v[130:133], v[234:237], a[240:243], v[130:133]
    s_waitcnt lgkmcnt(3)
    buffer_load_dwordx4 v120, s[52:55], 0 offen lds
    v_fmac_f32 v181, v135, v135
    v_mfma_f32_16x16x32_bf16 v[130:133], v[234:237], v[90:93], v[130:133]
    s_waitcnt lgkmcnt(1)
    v_fmac_f32 v181, v136, v136
    v_fmac_f32 v181, v137, v137
    v_mfma_f32_16x16x32_bf16 v[122:125], v[190:193], a[156:159], v[122:125]
    v_cvt_pk_bf16_f32 v36, v181, v255
    v_cvt_pk_bf16_f32 v174, v154, v155
    v_mfma_f32_16x16x32_bf16 v[122:125], v[194:197], a[160:163], v[122:125]
    s_waitcnt vmcnt(7)
    ds_read_b64 a[232:233], v183 offset:3072
    ds_read_b64 a[220:221], v183 offset:4608
    v_mfma_f32_16x16x32_bf16 v[214:217], v[32:35], v[36:39], 0
    ds_read_b64 v[82:83], v183 offset:3080
    ds_read_b64 a[244:245], v183 offset:4616
    v_mfma_f32_16x16x32_bf16 v[122:125], v[186:189], a[164:167], v[122:125]
    buffer_load_dwordx4 v159, s[52:55], 0 offen offset:1024 lds
    ds_read_b64 v[106:107], v184 offset:3072
    v_mfma_f32_16x16x32_bf16 v[206:209], v[238:241], a[168:171], 0
    ds_read_b64 v[94:95], v184 offset:4608
    v_mov_b32 v255, v130
    v_mfma_f32_16x16x32_bf16 v[206:209], v[202:205], a[172:175], v[206:209]
    v_rsq_f32 v215, v215
    v_mfma_f32_16x16x32_bf16 v[206:209], v[218:221], a[176:179], v[206:209]
    v_mov_b32_dpp v255, v131 quad_perm:[0,1,2,3] row_mask:0x2 bank_mask:0xf
    v_mul_f32 v150, v215, v150
    v_mfma_f32_16x16x32_bf16 v[206:209], v[190:193], a[180:183], v[206:209]
    v_rsq_f32 v214, v214
    v_mfma_f32_16x16x32_bf16 v[206:209], v[194:197], a[184:187], v[206:209]
    buffer_load_dwordx4 v121, s[52:55], 0 offen offset:2048 lds
    v_mul_f32 v214, s31, v214
    v_mfma_f32_16x16x32_bf16 v[206:209], v[186:189], a[188:191], v[206:209]
    s_add_u32 s52, s52, 12288
    v_mul_f32 v151, v215, v151
    v_cvt_pk_f16_f32 v130, v150, v151
    v_mfma_f32_16x16x32_bf16 v[246:249], v[238:241], a[192:195], 0
    s_addc_u32 s53, s53, 0
    v_mul_f32 v152, v215, v152
    v_mul_f32 v153, v215, v153
    v_mfma_f32_16x16x32_bf16 v[246:249], v[202:205], a[196:199], v[246:249]
    s_add_u32 m0, s69, 3072
    v_cvt_pk_f16_f32 v131, v152, v153
    v_mul_f32 v162, v215, v162
    v_mfma_f32_16x16x32_bf16 v[246:249], v[218:221], a[200:203], v[246:249]
    s_waitcnt lgkmcnt(0)
    v_mul_f32 v163, v215, v163
    v_cvt_pk_f16_f32 v132, v162, v163
    v_mfma_f32_16x16x32_bf16 v[246:249], v[190:193], a[204:207], v[246:249]
    buffer_load_dwordx4 v120, s[52:55], 0 offen lds
    v_mul_f32 v164, v215, v164
    s_waitcnt vmcnt(7)
    v_mfma_f32_16x16x32_bf16 v[246:249], v[194:197], a[208:211], v[246:249]
    s_add_u32 s69, s77, 589824
    ds_read_b64 a[222:223], v182 offset:0
    ds_read_b64 a[234:235], v182 offset:1536
    v_mfma_f32_16x16x32_bf16 v[246:249], v[186:189], a[212:215], v[246:249]
    s_barrier
    s_barrier
    ds_read_b64 a[246:247], v182 offset:8
    ds_read_b64 v[84:85], v182 offset:1544
    ds_read_b64 v[96:97], v127 offset:0
    ds_read_b64 v[108:109], v127 offset:1536
    ds_read_b128 v[150:153], v0 offset:26624
    ds_read_b128 v[186:189], v1 offset:26624
    buffer_load_dwordx4 v159, s[52:55], 0 offen offset:1024 lds
    ds_read_b128 v[238:241], v0 offset:26752
    ds_read_b128 v[202:205], v1 offset:26752
    ds_read_b128 v[158:161], v0 offset:26880
    ds_read_b128 v[190:193], v1 offset:26880
    v_mul_f32 v165, v215, v165
    s_waitcnt lgkmcnt(11)
    v_mfma_f32_16x16x32_bf16 v[194:197], v[234:237], a[220:223], 0
    s_waitcnt lgkmcnt(10)
    buffer_load_dwordx4 v121, s[52:55], 0 offen offset:2048 lds
    v_cvt_pk_f16_f32 v133, v164, v165
    v_mfma_f32_16x16x32_bf16 v[162:165], v[234:237], a[232:235], 0
    s_waitcnt lgkmcnt(8)
    v_mul_f32 v170, v215, v170
    v_mul_f32 v171, v215, v171
    v_mfma_f32_16x16x32_bf16 v[194:197], v[234:237], a[244:247], v[194:197]
    s_waitcnt lgkmcnt(4)
    v_cvt_pk_f16_f32 v128, v170, v171
    v_mul_f32 v172, v215, v172
    v_mfma_f32_16x16x32_bf16 v[194:197], v[234:237], v[94:97], v[194:197]
    s_add_u32 m0, s28, 65536
    v_mul_f32 v173, v215, v173
    v_cvt_pk_f16_f32 v129, v172, v173
    v_mfma_f32_16x16x32_bf16 v[162:165], v[234:237], v[82:85], v[162:165]
    s_waitcnt lgkmcnt(2)
    v_mul_f32 v138, v214, v138
    s_waitcnt vmcnt(6)
    v_mfma_f32_16x16x32_bf16 v[162:165], v[234:237], v[106:109], v[162:165]
    s_waitcnt lgkmcnt(1)
    buffer_load_dwordx4 v10, s[8:11], s24 offen nt lds
    v_mfma_f32_16x16x32_bf16 v[170:173], a[72:75], v[150:153], 0
    s_add_u32 m0, s28, 69632
    ds_read_b64 a[224:225], v182 offset:3072
    ds_read_b64 a[226:227], v182 offset:4608
    v_mfma_f32_16x16x32_bf16 v[170:173], a[76:79], v[186:189], v[170:173]
    s_waitcnt lgkmcnt(2)
    ds_read_b64 a[248:249], v182 offset:3080
    ds_read_b64 a[250:251], v182 offset:4616
    v_mfma_f32_16x16x32_bf16 v[170:173], a[80:83], v[238:241], v[170:173]
    ds_read_b64 v[98:99], v127 offset:3072
    ds_read_b64 v[100:101], v127 offset:4608
    v_mfma_f32_16x16x32_bf16 v[170:173], a[84:87], v[202:205], v[170:173]
    v_mov_b32_dpp v255, v162 quad_perm:[0,1,2,3] row_mask:0x4 bank_mask:0xf
    v_mov_b32 v182, v195
    v_mfma_f32_16x16x32_bf16 v[170:173], a[88:91], v[158:161], v[170:173]
    buffer_load_dwordx4 v11, s[8:11], s24 offen nt lds
    v_mfma_f32_16x16x32_bf16 v[170:173], a[92:95], v[190:193], v[170:173]
    s_add_u32 m0, s28, 73728
    v_mov_b32_dpp v255, v194 quad_perm:[0,1,2,3] row_mask:0x8 bank_mask:0xf
    v_mov_b32_dpp v182, v163 quad_perm:[0,1,2,3] row_mask:0x2 bank_mask:0xf
    v_mfma_f32_16x16x32_bf16 v[162:165], a[96:99], v[150:153], 0
    ds_write_b32 v254, v255 offset:18432
    v_mfma_f32_16x16x32_bf16 v[162:165], a[100:103], v[186:189], v[162:165]
    v_mul_f32 v139, v214, v139
    v_cvt_pk_f16_f32 v138, v138, v139
    v_mfma_f32_16x16x32_bf16 v[162:165], a[104:107], v[238:241], v[162:165]
    s_waitcnt lgkmcnt(5)
    v_mul_f32 v140, v214, v140
    v_mul_f32 v141, v214, v141
    v_mfma_f32_16x16x32_bf16 v[194:197], v[234:237], a[224:227], 0
    s_waitcnt lgkmcnt(3)
    buffer_load_dwordx4 v12, s[8:11], s24 offen nt lds
    v_mfma_f32_16x16x32_bf16 v[194:197], v[234:237], a[248:251], v[194:197]
    s_waitcnt lgkmcnt(1)
    v_cvt_pk_f16_f32 v139, v140, v141
    v_mul_f32 v166, v214, v166
    v_mfma_f32_16x16x32_bf16 v[194:197], v[234:237], v[98:101], v[194:197]
    s_add_u32 m0, s28, 77824
    v_mul_f32 v167, v214, v167
    s_waitcnt vmcnt(6)
    v_mfma_f32_16x16x32_bf16 v[162:165], a[108:111], v[202:205], v[162:165]
    ds_read_b64 a[236:237], v183 offset:0
    ds_read_b64 a[228:229], v183 offset:1536
    v_mfma_f32_16x16x32_bf16 v[162:165], a[112:115], v[158:161], v[162:165]
    ds_read_b64 v[86:87], v183 offset:8
    ds_read_b64 a[252:253], v183 offset:1544
    v_mfma_f32_16x16x32_bf16 v[162:165], a[116:119], v[190:193], v[162:165]
    buffer_load_dwordx4 v13, s[8:11], s24 offen nt lds
    v_mfma_f32_16x16x32_bf16 v[218:221], a[120:123], v[150:153], 0
    s_add_u32 m0, s74, 0
    ds_read_b64 v[110:111], v184 offset:0
    ds_read_b64 v[102:103], v184 offset:1536
    v_mfma_f32_16x16x32_bf16 v[218:221], a[124:127], v[186:189], v[218:221]
    v_mov_b32_dpp v182, v194 quad_perm:[0,1,2,3] row_mask:0x4 bank_mask:0xf
    v_cvt_pk_f16_f32 v140, v166, v167
    v_mfma_f32_16x16x32_bf16 v[218:221], a[128:131], v[238:241], v[218:221]
    v_mov_b32_dpp v182, v195 quad_perm:[0,1,2,3] row_mask:0x8 bank_mask:0xf
    v_mul_f32 v168, v214, v168
    v_mfma_f32_16x16x32_bf16 v[218:221], a[132:135], v[202:205], v[218:221]
    ds_write_b32 v254, v182 offset:19456
    v_mfma_f32_16x16x32_bf16 v[218:221], a[136:139], v[158:161], v[218:221]
    buffer_load_dwordx4 v14, s[8:11], s24 offen nt lds
    v_mfma_f32_16x16x32_bf16 v[218:221], a[140:143], v[190:193], v[218:221]
    s_add_u32 s8, s60, s23
    v_mul_f32 v169, v214, v169
    v_cvt_pk_f16_f32 v141, v168, v169
    v_mfma_f32_16x16x32_bf16 v[166:169], a[0:3], v[150:153], 0
    s_addc_u32 s9, s61, 0
    v_mul_f32 v134, v214, v134
    v_mul_f32 v135, v214, v135
    v_mfma_f32_16x16x32_bf16 v[166:169], a[4:7], v[186:189], v[166:169]
    s_sub_u32 s10, s36, s23
    v_cvt_pk_f16_f32 v126, v134, v135
    v_mul_f32 v136, v214, v136
    v_mfma_f32_16x16x32_bf16 v[166:169], a[8:11], v[238:241], v[166:169]
    s_cmp_lt_u32 s34, s17
    v_mul_f32 v137, v214, v137
    v_cvt_pk_f16_f32 v127, v136, v137
    v_mfma_f32_16x16x32_bf16 v[166:169], a[12:15], v[202:205], v[166:169]
    s_cselect_b32 s10, s10, 0
    v_cvt_pk_bf16_f32 v175, v156, v157
    v_cvt_pk_bf16_f32 v114, v114, v114
    v_mfma_f32_16x16x32_bf16 v[166:169], a[16:19], v[158:161], v[166:169]
    s_add_u32 m0, s28, 0
    v_cvt_pk_bf16_f32 v115, v115, v115
    s_waitcnt vmcnt(5)
    v_mfma_f32_16x16x32_bf16 v[166:169], a[20:23], v[190:193], v[166:169]
    s_mov_b32 s24, s23
    ds_read_b64 a[230:231], v183 offset:3072
    ds_read_b64 a[238:239], v183 offset:4608
    v_mfma_f32_16x16x32_bf16 v[134:137], a[24:27], v[150:153], 0
    s_add_u32 s23, s23, s21
    ds_read_b64 a[254:255], v183 offset:3080
    ds_read_b64 v[88:89], v183 offset:4616
    v_mfma_f32_16x16x32_bf16 v[134:137], a[28:31], v[186:189], v[134:137]
    s_cmp_ge_u32 s19, 72
    ds_read_b64 v[104:105], v184 offset:3072
    ds_read_b64 v[112:113], v184 offset:4608
    v_mfma_f32_16x16x32_bf16 v[134:137], a[32:35], v[238:241], v[134:137]
    s_cselect_b32 s34, 72, 0
    ds_write2_b32 v177, v114, v115 offset0:0 offset1:68
    v_mfma_f32_16x16x32_bf16 v[134:137], a[36:39], v[202:205], v[134:137]
    s_cselect_b32 s35, s22, 0
    v_cvt_pk_bf16_f32 v116, v116, v116
    v_cvt_pk_bf16_f32 v117, v117, v117
    v_mfma_f32_16x16x32_bf16 v[134:137], a[40:43], v[158:161], v[134:137]
    s_sub_u32 s19, s19, s34
    ds_write2_b32 v177, v116, v117 offset0:136 offset1:204
    v_mfma_f32_16x16x32_bf16 v[134:137], a[44:47], v[190:193], v[134:137]
    s_add_u32 s23, s23, s35
    v_cvt_pk_bf16_f32 v230, v230, v230
    v_cvt_pk_bf16_f32 v231, v231, v231
    v_mfma_f32_16x16x32_bf16 v[114:117], a[48:51], v[150:153], 0
    s_waitcnt lgkmcnt(6)
    ds_write2_b32 v177, v230, v231 offset0:16 offset1:84
    v_mfma_f32_16x16x32_bf16 v[154:157], v[234:237], a[228:231], 0
    s_waitcnt lgkmcnt(5)
    v_cvt_pk_bf16_f32 v232, v232, v232
    v_cvt_pk_bf16_f32 v233, v233, v233
    v_mfma_f32_16x16x32_bf16 v[154:157], v[234:237], a[252:255], v[154:157]
    s_waitcnt lgkmcnt(3)
    ds_write2_b32 v177, v232, v233 offset0:152 offset1:220
    v_mfma_f32_16x16x32_bf16 v[154:157], v[234:237], v[102:105], v[154:157]
    v_cvt_pk_bf16_f32 v222, v222, v222
    v_cvt_pk_bf16_f32 v223, v223, v223
    v_mfma_f32_16x16x32_bf16 v[230:233], v[234:237], a[236:239], 0
    ds_write2_b32 v177, v222, v223 offset0:32 offset1:100
    v_mfma_f32_16x16x32_bf16 v[230:233], v[234:237], v[86:89], v[230:233]
    v_cvt_pk_bf16_f32 v224, v224, v224
    v_cvt_pk_bf16_f32 v225, v225, v225
    v_mfma_f32_16x16x32_bf16 v[230:233], v[234:237], v[110:113], v[230:233]
    ds_write2_b32 v177, v224, v225 offset0:168 offset1:236
    v_mfma_f32_16x16x32_bf16 v[114:117], a[52:55], v[186:189], v[114:117]
    v_cvt_pk_bf16_f32 v122, v122, v122
    v_cvt_pk_bf16_f32 v123, v123, v123
    v_mfma_f32_16x16x32_bf16 v[114:117], a[56:59], v[238:241], v[114:117]
    ds_write2_b32 v178, v122, v123 offset0:0 offset1:68
    v_mfma_f32_16x16x32_bf16 v[114:117], a[60:63], v[202:205], v[114:117]
    v_cvt_pk_bf16_f32 v124, v124, v124
    v_mov_b32 v255, v230
    v_mfma_f32_16x16x32_bf16 v[114:117], a[64:67], v[158:161], v[114:117]
    v_cvt_pk_bf16_f32 v125, v125, v125
    v_mov_b32_dpp v255, v154 quad_perm:[0,1,2,3] row_mask:0x2 bank_mask:0xf
    v_mfma_f32_16x16x32_bf16 v[114:117], a[68:71], v[190:193], v[114:117]
    ds_write2_b32 v178, v124, v125 offset0:136 offset1:204
    v_mfma_f32_16x16x32_bf16 v[122:125], v[150:153], a[144:147], 0
    v_mov_b32_dpp v255, v155 quad_perm:[0,1,2,3] row_mask:0x4 bank_mask:0xf
    v_cvt_pk_bf16_f32 v206, v206, v206
    v_mfma_f32_16x16x32_bf16 v[122:125], v[186:189], a[148:151], v[122:125]
    v_mov_b32_dpp v255, v231 quad_perm:[0,1,2,3] row_mask:0x8 bank_mask:0xf
    v_cvt_pk_bf16_f32 v207, v207, v207
    v_mfma_f32_16x16x32_bf16 v[122:125], v[238:241], a[152:155], v[122:125]
    ds_write_b32 v254, v255 offset:63552
    v_mfma_f32_16x16x32_bf16 v[122:125], v[202:205], a[156:159], v[122:125]
    v_cvt_pk_bf16_f32 v208, v208, v208
    v_cvt_pk_bf16_f32 v209, v209, v209
    v_mfma_f32_16x16x32_bf16 v[122:125], v[158:161], a[160:163], v[122:125]
    ds_write2_b32 v178, v206, v207 offset0:16 offset1:84
    v_mfma_f32_16x16x32_bf16 v[122:125], v[190:193], a[164:167], v[122:125]
    v_cvt_pk_bf16_f32 v246, v246, v246
    v_cvt_pk_bf16_f32 v247, v247, v247
    v_mfma_f32_16x16x32_bf16 v[154:157], v[150:153], a[168:171], 0
    ds_write2_b32 v178, v208, v209 offset0:152 offset1:220
    v_mfma_f32_16x16x32_bf16 v[154:157], v[186:189], a[172:175], v[154:157]
    v_cvt_pk_bf16_f32 v248, v248, v248
    v_cvt_pk_bf16_f32 v249, v249, v249
    v_mfma_f32_16x16x32_bf16 v[154:157], v[238:241], a[176:179], v[154:157]
    ds_write2_b32 v178, v246, v247 offset0:32 offset1:100
    v_mfma_f32_16x16x32_bf16 v[154:157], v[202:205], a[180:183], v[154:157]
    s_waitcnt lgkmcnt(3)
    v_cvt_pk_bf16_f32 v120, v122, v123
    v_cvt_pk_bf16_f32 v121, v124, v125
    v_mfma_f32_16x16x32_bf16 v[154:157], v[158:161], a[184:187], v[154:157]
    s_barrier
    ds_read_b128 v[230:233], v0 offset:32768
    ds_read_b128 v[122:125], v1 offset:32768
    v_mfma_f32_16x16x32_bf16 v[154:157], v[190:193], a[188:191], v[154:157]
    ds_read_b128 v[206:209], v0 offset:32896
    ds_read_b128 v[222:225], v185 offset:18432
    v_mfma_f32_16x16x32_bf16 v[234:237], v[150:153], a[192:195], 0
    v_fma_f32 v148, v166, v166, s32
    v_fmac_f32 v148, v167, v167
    v_mfma_f32_16x16x32_bf16 v[234:237], v[186:189], a[196:199], v[234:237]
    ds_read_b128 v[186:189], v1 offset:32896
    ds_read_b128 v[150:153], v0 offset:33024
    v_mfma_f32_16x16x32_bf16 v[234:237], v[238:241], a[200:203], v[234:237]
    v_fmac_f32 v148, v168, v168
    v_fmac_f32 v148, v169, v169
    v_mfma_f32_16x16x32_bf16 v[234:237], v[202:205], a[204:207], v[234:237]
    ds_read_b128 v[238:241], v1 offset:33024
    ds_read_b128 v[202:205], v185 offset:19456
    v_mfma_f32_16x16x32_bf16 v[234:237], v[158:161], a[208:211], v[234:237]
    v_fmac_f32 v148, v134, v134
    v_fmac_f32 v148, v135, v135
    v_mfma_f32_16x16x32_bf16 v[234:237], v[190:193], a[212:215], v[234:237]
    ds_read_b128 v[190:193], v185 offset:63552
    v_fmac_f32 v148, v136, v136
    v_mfma_f32_16x16x32_f16 v[158:161], v[130:133], v[138:141], v[46:49]
    s_waitcnt lgkmcnt(7)
    ds_write2_b32 v178, v248, v249 offset0:168 offset1:236
    v_mfma_f32_16x16x32_bf16 v[178:181], a[72:75], v[230:233], 0
    s_waitcnt lgkmcnt(6)
    v_add_f32 v222, v222, v223
    v_add_f32 v224, v224, v225
    v_mfma_f32_16x16x32_bf16 v[178:181], a[76:79], v[122:125], v[178:181]
    s_waitcnt lgkmcnt(5)
    v_add_f32 v222, v222, v224
    v_mul_f32 v222, 0xbbaaaaab, v222
    v_mfma_f32_16x16x32_bf16 v[178:181], a[80:83], v[206:209], v[178:181]
    s_waitcnt lgkmcnt(4)
    ds_write_b32 v142, v222 offset:0
    v_mfma_f32_16x16x32_bf16 v[178:181], a[84:87], v[186:189], v[178:181]
    s_waitcnt lgkmcnt(4)
    v_fmac_f32 v148, v137, v137
    v_fmac_f32 v148, v114, v114
    v_mfma_f32_16x16x32_bf16 v[178:181], a[88:91], v[150:153], v[178:181]
    s_waitcnt lgkmcnt(3)
    ds_read_b128 v[222:225], v143 offset:0
    ds_read_b128 v[182:185], v143 offset:64
    v_mfma_f32_16x16x32_bf16 v[178:181], a[92:95], v[238:241], v[178:181]
    s_waitcnt lgkmcnt(4)
    v_add_f32 v202, v202, v203
    v_add_f32 v204, v204, v205
    v_mfma_f32_16x16x32_bf16 v[194:197], a[96:99], v[230:233], 0
    v_add_f32 v202, v202, v204
    v_mul_f32 v202, 0xbbaaaaab, v202
    v_mfma_f32_16x16x32_bf16 v[194:197], a[100:103], v[122:125], v[194:197]
    ds_write_b32 v142, v202 offset:256
    v_mfma_f32_16x16x32_bf16 v[194:197], a[104:107], v[206:209], v[194:197]
    v_add_f32 v190, v190, v191
    v_add_f32 v192, v192, v193
    v_mfma_f32_16x16x32_bf16 v[194:197], a[108:111], v[186:189], v[194:197]
    v_add_f32 v190, v190, v192
    v_mul_f32 v190, 0xbbaaaaab, v190
    v_mfma_f32_16x16x32_bf16 v[194:197], a[112:115], v[150:153], v[194:197]
    ds_write_b32 v142, v190 offset:512
    v_mfma_f32_16x16x32_bf16 v[194:197], a[116:119], v[238:241], v[194:197]
    v_fmac_f32 v148, v115, v115
    v_fmac_f32 v148, v116, v116
    v_mfma_f32_16x16x32_bf16 v[202:205], a[120:123], v[230:233], 0
    s_waitcnt lgkmcnt(2)
    v_fmac_f32 v148, v117, v117
    v_fma_f32 v142, v170, v170, s32
    v_mfma_f32_16x16x32_bf16 v[202:205], a[124:127], v[122:125], v[202:205]
    v_fmac_f32 v142, v171, v171
    v_fmac_f32 v142, v172, v172
    v_mfma_f32_16x16x32_bf16 v[202:205], a[128:131], v[206:209], v[202:205]
    v_fmac_f32 v142, v173, v173
    v_fmac_f32 v142, v162, v162
    v_mfma_f32_16x16x32_bf16 v[202:205], a[132:135], v[186:189], v[202:205]
    v_fmac_f32 v142, v163, v163
    v_fmac_f32 v142, v164, v164
    v_mfma_f32_16x16x32_bf16 v[202:205], a[136:139], v[150:153], v[202:205]
    v_fmac_f32 v142, v165, v165
    v_fmac_f32 v142, v218, v218
    v_mfma_f32_16x16x32_bf16 v[202:205], a[140:143], v[238:241], v[202:205]
    v_fmac_f32 v142, v219, v219
    v_fmac_f32 v142, v220, v220
    v_mfma_f32_16x16x32_bf16 v[190:193], a[0:3], v[230:233], 0
    v_fmac_f32 v142, v221, v221
    v_cvt_pk_bf16_f32 v36, v148, v142
    v_mfma_f32_16x16x32_bf16 v[190:193], a[4:7], v[122:125], v[190:193]
    v_cvt_pk_bf16_f32 v148, v154, v155
    v_cvt_pk_bf16_f32 v149, v156, v157
    v_mfma_f32_16x16x32_bf16 v[154:157], v[32:35], v[36:39], 0
    v_cvt_pk_bf16_f32 v176, v234, v235
    v_cvt_pk_bf16_f32 v177, v236, v237
    v_mfma_f32_16x16x32_bf16 v[190:193], a[8:11], v[206:209], v[190:193]
    v_fma_f32 v142, v178, v178, s32
    v_fmac_f32 v142, v179, v179
    v_mfma_f32_16x16x32_bf16 v[190:193], a[12:15], v[186:189], v[190:193]
    v_fmac_f32 v142, v180, v180
    v_fmac_f32 v142, v181, v181
    v_mfma_f32_16x16x32_bf16 v[190:193], a[16:19], v[150:153], v[190:193]
    v_rsq_f32 v155, v155
    v_mfma_f32_16x16x32_bf16 v[190:193], a[20:23], v[238:241], v[190:193]
    v_rsq_f32 v154, v154
    v_mfma_f32_16x16x32_bf16 v[234:237], a[24:27], v[230:233], 0
    v_mul_f32 v154, s31, v154
    v_mul_f32 v170, v155, v170
    v_mfma_f32_16x16x32_bf16 v[234:237], a[28:31], v[122:125], v[234:237]
    ds_read2_b32 v[248:249], v6 offset0:0 offset1:0
    ds_read2_b32 v[156:157], v6 offset0:16 offset1:16
    v_mfma_f32_16x16x32_bf16 v[234:237], a[32:35], v[206:209], v[234:237]
    ds_read2_b32 v[216:217], v6 offset0:32 offset1:32
    v_mul_f32 v171, v155, v171
    v_mfma_f32_16x16x32_bf16 v[234:237], a[36:39], v[186:189], v[234:237]
    v_cvt_pk_f16_f32 v170, v170, v171
    v_mul_f32 v172, v155, v172
    v_mfma_f32_16x16x32_bf16 v[234:237], a[40:43], v[150:153], v[234:237]
    v_mul_f32 v173, v155, v173
    v_cvt_pk_f16_f32 v171, v172, v173
    v_mfma_f32_16x16x32_bf16 v[234:237], a[44:47], v[238:241], v[234:237]
    v_mul_f32 v162, v155, v162
    v_mul_f32 v163, v155, v163
    v_cvt_pk_f16_f32 v172, v162, v163
    v_mfma_f32_16x16x16_f16 v[158:161], v[128:129], v[126:127], v[158:161]
    v_mul_f32 v164, v155, v164
    v_mul_f32 v165, v155, v165
    v_cvt_pk_f16_f32 v173, v164, v165
    v_mul_f32 v218, v155, v218
    v_mfma_f32_16x16x32_bf16 v[162:165], a[48:51], v[230:233], 0
    v_mul_f32 v219, v155, v219
    v_cvt_pk_f16_f32 v228, v218, v219
    v_mfma_f32_16x16x32_bf16 v[162:165], a[52:55], v[122:125], v[162:165]
    s_waitcnt lgkmcnt(1)
    v_mul_f32 v220, v155, v220
    v_mul_f32 v221, v155, v221
    v_mfma_f32_16x16x32_bf16 v[162:165], a[56:59], v[206:209], v[162:165]
    s_waitcnt lgkmcnt(0)
    v_cvt_pk_f16_f32 v229, v220, v221
    v_mul_f32 v166, v154, v166
    v_mfma_f32_16x16x32_bf16 v[162:165], a[60:63], v[186:189], v[162:165]
    v_mul_f32 v167, v154, v167
    v_cvt_pk_f16_f32 v166, v166, v167
    v_mfma_f32_16x16x32_bf16 v[162:165], a[64:67], v[150:153], v[162:165]
    v_mul_f32 v168, v154, v168
    v_mul_f32 v169, v154, v169
    v_mfma_f32_16x16x32_bf16 v[162:165], a[68:71], v[238:241], v[162:165]
    v_cvt_pk_f16_f32 v167, v168, v169
    v_mul_f32 v134, v154, v134
    v_mfma_f32_16x16x32_bf16 v[218:221], v[230:233], a[144:147], 0
    v_mul_f32 v135, v154, v135
    v_cvt_pk_f16_f32 v168, v134, v135
    v_mfma_f32_16x16x32_bf16 v[218:221], v[122:125], a[148:151], v[218:221]
    v_mul_f32 v136, v154, v136
    v_mul_f32 v137, v154, v137
    v_mfma_f32_16x16x32_bf16 v[218:221], v[206:209], a[152:155], v[218:221]
    v_cvt_pk_f16_f32 v169, v136, v137
    v_mul_f32 v114, v154, v114
    v_mfma_f32_16x16x32_bf16 v[218:221], v[186:189], a[156:159], v[218:221]
    v_mul_f32 v115, v154, v115
    v_cvt_pk_f16_f32 v226, v114, v115
    v_mfma_f32_16x16x32_bf16 v[218:221], v[150:153], a[160:163], v[218:221]
    v_mul_f32 v116, v154, v116
    v_mul_f32 v117, v154, v117
    v_mfma_f32_16x16x32_bf16 v[218:221], v[238:241], a[164:167], v[218:221]
    v_cvt_pk_f16_f32 v227, v116, v117
    v_fma_f32 v154, v190, v190, s32
    v_mfma_f32_16x16x32_bf16 v[114:117], v[230:233], a[168:171], 0
    v_fmac_f32 v154, v191, v191
    v_fmac_f32 v154, v192, v192
    v_mfma_f32_16x16x32_bf16 v[114:117], v[122:125], a[172:175], v[114:117]
    ds_read_b32 v254, v6 offset:192
    v_fmac_f32 v154, v193, v193
    v_mfma_f32_16x16x32_bf16 v[114:117], v[206:209], a[176:179], v[114:117]
    v_cvt_pk_bf16_f32 v246, v218, v219
    v_cvt_pk_bf16_f32 v247, v220, v221
    v_mfma_f32_16x16x32_bf16 v[114:117], v[186:189], a[180:183], v[114:117]
    v_fmac_f32 v154, v234, v234
    v_fmac_f32 v154, v235, v235
    v_mfma_f32_16x16x32_bf16 v[114:117], v[150:153], a[184:187], v[114:117]
    v_fmac_f32 v154, v236, v236
    v_fmac_f32 v154, v237, v237
    v_mfma_f32_16x16x32_bf16 v[114:117], v[238:241], a[188:191], v[114:117]
    v_fmac_f32 v154, v162, v162
    v_fmac_f32 v154, v163, v163
    v_fmac_f32 v154, v164, v164
    v_fmac_f32 v154, v165, v165
    v_fmac_f32 v142, v194, v194
    v_fmac_f32 v142, v195, v195
    v_fmac_f32 v142, v196, v196
    v_fmac_f32 v142, v197, v197
    v_fmac_f32 v142, v202, v202
    v_fmac_f32 v142, v203, v203
    v_fmac_f32 v142, v204, v204
    v_fmac_f32 v142, v205, v205
    v_cvt_pk_bf16_f32 v36, v154, v142
    v_mfma_f32_16x16x32_bf16 v[218:221], v[230:233], a[192:195], 0
    s_waitcnt lgkmcnt(0)
    ds_read_b128 v[134:137], v5 offset:0
    v_cvt_pk_bf16_f32 v154, v114, v115
    v_mfma_f32_16x16x32_bf16 v[218:221], v[122:125], a[196:199], v[218:221]
    ds_read_b128 v[122:125], v5 offset:16
    v_cvt_pk_bf16_f32 v155, v116, v117
    v_mfma_f32_16x16x32_bf16 v[218:221], v[206:209], a[200:203], v[218:221]
    ds_read_b128 v[114:117], v5 offset:48
    v_xor_b32 v0, 65536, v0
    v_mfma_f32_16x16x32_bf16 v[218:221], v[186:189], a[204:207], v[218:221]
    v_xor_b32 v1, 65536, v1
    v_add_u32 v5, 336, v5
    v_mfma_f32_16x16x32_bf16 v[186:189], v[32:35], v[36:39], 0
    v_add_u32 v6, 272, v6
    v_mfma_f32_16x16x32_bf16 v[218:221], v[150:153], a[208:211], v[218:221]
    v_mfma_f32_16x16x32_f16 v[150:153], v[170:173], v[138:141], v[50:53]
    v_mfma_f32_16x16x32_bf16 v[218:221], v[238:241], a[212:215], v[218:221]
    v_mfma_f32_16x16x16_bf16 v[230:233], a[216:217], v[144:145], v[222:225]
    v_mfma_f32_16x16x16_bf16 v[238:241], a[240:241], v[144:145], v[222:225]
    s_nop 0
    s_nop 0
    v_rsq_f32 v187, v187
    v_mfma_f32_16x16x16_f16 v[150:153], v[228:229], v[126:127], v[150:153]
    v_rsq_f32 v186, v186
    v_mul_f32 v178, v187, v178
    v_mul_f32 v186, s31, v186
    s_waitcnt vmcnt(0)
    s_barrier
    buffer_load_dwordx4 v10, s[8:11], 0 offen nt lds
    s_add_u32 m0, s28, 4096
    v_cvt_pk_bf16_f32 v214, v218, v219
    v_cvt_pk_bf16_f32 v215, v220, v221
    v_mul_f32 v179, v187, v179
    v_cvt_pk_f16_f32 v178, v178, v179
    v_mul_f32 v180, v187, v180
    v_mul_f32 v181, v187, v181
    v_cvt_pk_f16_f32 v179, v180, v181
    v_mfma_f32_16x16x16_bf16 v[218:221], v[90:91], v[144:145], v[222:225]
    v_mul_f32 v194, v187, v194
    v_mul_f32 v195, v187, v195
    v_cvt_pk_f16_f32 v180, v194, v195
    v_mfma_f32_16x16x16_bf16 v[206:209], a[218:219], v[144:145], v[182:185]
    v_mul_f32 v196, v187, v196
    v_mul_f32 v197, v187, v197
    buffer_load_dwordx4 v11, s[8:11], 0 offen nt lds
    s_add_u32 m0, s28, 8192
    v_cvt_pk_f16_f32 v181, v196, v197
    v_mul_f32 v202, v187, v202
    v_mul_f32 v203, v187, v203
    v_cvt_pk_f16_f32 v224, v202, v203
    v_mul_f32 v204, v187, v204
    v_mul_f32 v205, v187, v205
    v_mfma_f32_16x16x32_f16 v[194:197], v[178:181], v[138:141], v[54:57]
    v_cvt_pk_f16_f32 v225, v204, v205
    v_mul_f32 v190, v186, v190
    v_mul_f32 v191, v186, v191
    v_cvt_pk_f16_f32 v202, v190, v191
    v_mul_f32 v192, v186, v192
    v_mul_f32 v193, v186, v193
    v_mfma_f32_16x16x16_f16 v[194:197], v[224:225], v[126:127], v[194:197]
    buffer_load_dwordx4 v12, s[8:11], 0 offen nt lds
    s_add_u32 m0, s28, 12288
    s_xor_b32 s28, s28, 65536
    v_cvt_pk_f16_f32 v203, v192, v193
    v_mul_f32 v234, v186, v234
    v_mul_f32 v235, v186, v235
    v_cvt_pk_f16_f32 v204, v234, v235
    v_mfma_f32_16x16x16_bf16 v[190:193], a[242:243], v[144:145], v[182:185]
    v_mul_f32 v236, v186, v236
    v_mul_f32 v237, v186, v237
    v_cvt_pk_f16_f32 v205, v236, v237
    v_mul_f32 v162, v186, v162
    v_mul_f32 v163, v186, v163
    v_cvt_pk_f16_f32 v222, v162, v163
    v_mul_f32 v164, v186, v164
    v_mul_f32 v165, v186, v165
    buffer_load_dwordx4 v13, s[8:11], 0 offen nt lds
    s_mov_b32 m0, s29
    s_xor_b32 s29, s29, s30
    v_cvt_pk_f16_f32 v223, v164, v165
    v_mfma_f32_16x16x16_bf16 v[162:165], v[92:93], v[144:145], v[182:185]
    s_waitcnt lgkmcnt(0)
    v_cvt_pk_bf16_f32 v230, v230, v231
    v_accvgpr_write_b32 a216, v230
    v_cvt_pk_bf16_f32 v232, v232, v233
    v_mfma_f32_16x16x32_f16 v[182:185], v[134:137], v[138:141], v[22:25]
    v_accvgpr_write_b32 a217, v232
    v_cvt_pk_bf16_f32 v238, v238, v239
    v_mfma_f32_16x16x32_f16 v[182:185], v[122:125], v[130:133], v[182:185]
    v_accvgpr_write_b32 a240, v238
    v_cvt_pk_bf16_f32 v240, v240, v241
    v_mfma_f32_16x16x32_f16 v[182:185], v[114:117], v[126:129], v[182:185]
    buffer_load_dwordx4 v14, s[8:11], 0 offen nt lds
    v_accvgpr_write_b32 a241, v240
    v_mfma_f32_16x16x32_f16 v[186:189], v[134:137], v[166:169], v[24:27]
    v_cvt_pk_bf16_f32 v90, v218, v219
    v_cvt_pk_bf16_f32 v91, v220, v221
    v_mfma_f32_16x16x32_f16 v[186:189], v[122:125], v[170:173], v[186:189]
    ds_read_b128 v[138:141], v143 offset:128
    v_cvt_pk_bf16_f32 v206, v206, v207
    v_mfma_f32_16x16x32_f16 v[186:189], v[114:117], v[226:229], v[186:189]
    v_mov_b32_dpp v254, v183 quad_perm:[0,1,2,3] row_mask:0x1 bank_mask:0xf
    v_max3_f32 v142, v182, v158, v159
    v_mfma_f32_16x16x32_f16 v[218:221], v[134:137], v[202:205], v[26:29]
    v_max3_f32 v142, v142, v160, v161
    v_max3_f32 v142, v142, v150, v151
    v_mfma_f32_16x16x32_f16 v[218:221], v[122:125], v[178:181], v[218:221]
    v_max3_f32 v142, v142, v152, v153
    v_max3_f32 v142, v142, v194, v195
    v_mfma_f32_16x16x32_f16 v[218:221], v[114:117], v[222:225], v[218:221]
    v_mov_b32_dpp v254, v187 quad_perm:[0,1,2,3] row_mask:0x2 bank_mask:0xf
    v_max3_f32 v142, v142, v196, v197
    v_mov_b32 v255, v142
    v_accvgpr_write_b32 a218, v206
    v_cvt_pk_bf16_f32 v208, v208, v209
    v_permlane32_swap_b32 v142, v255
    v_max_f32 v142, v142, v255
    v_mov_b32 v255, v142
    v_mov_b32_dpp v254, v219 quad_perm:[0,1,2,3] row_mask:0x4 bank_mask:0xf
    v_accvgpr_write_b32 a219, v208
    v_permlane16_swap_b32 v142, v255
    s_waitcnt lgkmcnt(0)
    v_mfma_f32_16x16x16_bf16 v[114:117], a[232:233], v[144:145], v[138:141]
    v_max_f32 v142, v142, v255
    v_sub_f32 v158, v158, v142
    v_sub_f32 v159, v159, v142
    v_mfma_f32_16x16x16_bf16 v[122:125], v[82:83], v[144:145], v[138:141]
    v_exp_f32 v158, v158
    v_sub_f32 v160, v160, v142
    v_mfma_f32_16x16x16_bf16 v[134:137], v[106:107], v[144:145], v[138:141]
    v_exp_f32 v159, v159
    v_exp_f32 v160, v160
    v_cvt_pk_bf16_f32 v158, v158, v159
    v_sub_f32 v161, v161, v142
    v_exp_f32 v161, v161
    v_sub_f32 v150, v150, v142
    v_cvt_pk_bf16_f32 v159, v160, v161
    v_exp_f32 v150, v150
    v_mfma_f32_16x16x32_f16 v[138:141], v[130:133], v[166:169], v[58:61]
    v_sub_f32 v151, v151, v142
    v_exp_f32 v151, v151
    v_sub_f32 v152, v152, v142
    v_cvt_pk_bf16_f32 v160, v150, v151
    v_exp_f32 v152, v152
    v_sub_f32 v153, v153, v142
    v_mfma_f32_16x16x16_f16 v[138:141], v[128:129], v[226:227], v[138:141]
    v_exp_f32 v153, v153
    v_sub_f32 v194, v194, v142
    v_cvt_pk_bf16_f32 v161, v152, v153
    v_mfma_f32_16x16x32_f16 v[150:153], v[170:173], v[166:169], v[62:65]
    v_exp_f32 v194, v194
    v_sub_f32 v195, v195, v142
    v_exp_f32 v195, v195
    v_sub_f32 v196, v196, v142
    v_cvt_pk_bf16_f32 v36, v194, v195
    v_exp_f32 v196, v196
    v_mfma_f32_16x16x32_f16 v[238:241], v[178:181], v[166:169], v[66:69]
    v_sub_f32 v197, v197, v142
    v_exp_f32 v197, v197
    v_mfma_f32_16x16x16_f16 v[150:153], v[228:229], v[226:227], v[150:153]
    v_cvt_pk_bf16_f32 v37, v196, v197
    v_sub_f32 v182, v182, v142
    v_exp_f32 v182, v182
    v_mfma_f32_16x16x16_f16 v[238:241], v[224:225], v[226:227], v[238:241]
    v_cvt_pk_bf16_f32 v39, v182, 0
    v_cvt_pk_bf16_f32 v190, v190, v191
    v_accvgpr_write_b32 a242, v190
    v_cvt_pk_bf16_f32 v192, v192, v193
    v_mfma_f32_16x16x32_bf16 v[182:185], v[28:31], v[36:39], 0
    v_accvgpr_write_b32 a243, v192
    v_cvt_pk_bf16_f32 v92, v162, v163
    v_mfma_f32_16x16x32_bf16 v[182:185], v[28:31], v[158:161], v[182:185]
    v_cvt_pk_bf16_f32 v93, v164, v165
    v_cvt_pk_bf16_f32 v114, v114, v115
    v_mfma_f32_16x16x32_bf16 v[162:165], v[246:249], v[36:39], 0
    ds_read_b128 v[166:169], v143 offset:192
    v_accvgpr_write_b32 a232, v114
    v_mfma_f32_16x16x32_bf16 v[162:165], v[118:121], v[158:161], v[162:165]
    v_cvt_pk_bf16_f32 v116, v116, v117
    v_accvgpr_write_b32 a233, v116
    v_mfma_f32_16x16x32_bf16 v[230:233], v[154:157], v[36:39], 0
    v_rcp_f32 v182, v182
    v_mfma_f32_16x16x32_bf16 v[230:233], v[146:149], v[158:161], v[230:233]
    v_cvt_pk_bf16_f32 v82, v122, v123
    v_cvt_pk_bf16_f32 v83, v124, v125
    v_mfma_f32_16x16x32_bf16 v[114:117], v[214:217], v[36:39], 0
    v_mul_f32 v162, v182, v162
    v_mul_f32 v163, v182, v163
    v_mfma_f32_16x16x32_bf16 v[114:117], v[174:177], v[158:161], v[114:117]
    v_cvt_pk_bf16_f32 v158, v162, v163
    v_mul_f32 v164, v182, v164
    v_mul_f32 v165, v182, v165
    v_cvt_pk_bf16_f32 v159, v164, v165
    v_mul_f32 v230, v182, v230
    v_mul_f32 v231, v182, v231
    v_cvt_pk_bf16_f32 v160, v230, v231
    v_mul_f32 v232, v182, v232
    s_waitcnt lgkmcnt(0)
    v_mfma_f32_16x16x16_bf16 v[122:125], a[220:221], v[144:145], v[166:169]
    v_mul_f32 v233, v182, v233
    v_cvt_pk_bf16_f32 v161, v232, v233
    v_mul_f32 v114, v182, v114
    v_mfma_f32_16x16x16_bf16 v[162:165], a[244:245], v[144:145], v[166:169]
    v_mul_f32 v115, v182, v115
    v_cvt_pk_bf16_f32 v126, v114, v115
    v_mul_f32 v116, v182, v116
    v_mfma_f32_16x16x16_bf16 v[230:233], v[94:95], v[144:145], v[166:169]
    ds_write_b128 v3, v[158:161] offset:0
    v_mul_f32 v117, v182, v117
    v_cvt_pk_bf16_f32 v127, v116, v117
    v_cvt_pk_bf16_f32 v106, v134, v135
    v_cvt_pk_bf16_f32 v107, v136, v137
    v_cvt_pk_bf16_f32 v122, v122, v123
    v_accvgpr_write_b32 a220, v122
    v_cvt_pk_bf16_f32 v124, v124, v125
    ds_read_b128 v[158:161], v143 offset:256
    ds_write_b64 v4, v[126:127] offset:4096
    v_accvgpr_write_b32 a221, v124
    v_cvt_pk_bf16_f32 v162, v162, v163
    v_accvgpr_write_b32 a244, v162
    v_cvt_pk_bf16_f32 v164, v164, v165
    v_accvgpr_write_b32 a245, v164
    v_cvt_pk_bf16_f32 v94, v230, v231
    v_cvt_pk_bf16_f32 v95, v232, v233
    ds_read_b128 v[114:117], v143 offset:320
    v_mov_b32 v142, v254
    v_max3_f32 v255, v186, v138, v139
    v_max3_f32 v255, v255, v140, v141
    v_max_f32_dpp v142, v142, v142 quad_perm:[1,0,3,2] row_mask:0xf bank_mask:0xf
    v_max3_f32 v255, v255, v150, v151
    v_max3_f32 v255, v255, v152, v153
    v_max_f32_dpp v142, v142, v142 quad_perm:[2,3,0,1] row_mask:0xf bank_mask:0xf
    v_max3_f32 v255, v255, v238, v239
    v_max3_f32 v255, v255, v240, v241
    v_max_f32_dpp v142, v142, v142 row_half_mirror row_mask:0xf bank_mask:0xf
    v_mov_b32 v127, v255
    s_nop 0
    v_max_f32_dpp v142, v142, v142 row_mirror row_mask:0xf bank_mask:0xf
    v_mov_b32 v126, v142
    s_waitcnt lgkmcnt(2)
    v_mfma_f32_16x16x16_bf16 v[122:125], a[222:223], v[144:145], v[158:161]
    v_permlane32_swap_b32 v142, v126
    v_max_f32 v142, v142, v126
    v_mfma_f32_16x16x16_bf16 v[182:185], a[246:247], v[144:145], v[158:161]
    v_mov_b32 v126, v142
    v_permlane32_swap_b32 v255, v127
    v_mfma_f32_16x16x16_bf16 v[162:165], v[96:97], v[144:145], v[158:161]
    v_permlane16_swap_b32 v142, v126
    v_max_f32 v142, v142, v126
    s_waitcnt lgkmcnt(0)
    v_mfma_f32_16x16x16_bf16 v[134:137], a[234:235], v[144:145], v[114:117]
    v_cvt_pk_bf16_f32 v122, v122, v123
    v_accvgpr_write_b32 a222, v122
    v_cvt_pk_bf16_f32 v124, v124, v125
    v_mfma_f32_16x16x16_bf16 v[158:161], v[84:85], v[144:145], v[114:117]
    v_accvgpr_write_b32 a223, v124
    v_cvt_pk_bf16_f32 v182, v182, v183
    v_accvgpr_write_b32 a246, v182
    v_mfma_f32_16x16x16_bf16 v[122:125], v[108:109], v[144:145], v[114:117]
    v_cvt_pk_bf16_f32 v184, v184, v185
    v_accvgpr_write_b32 a247, v184
    v_cvt_pk_bf16_f32 v96, v162, v163
    v_cvt_pk_bf16_f32 v97, v164, v165
    ds_read_b128 v[114:117], v143 offset:384
    v_cvt_pk_bf16_f32 v134, v134, v135
    v_accvgpr_write_b32 a234, v134
    v_cvt_pk_bf16_f32 v136, v136, v137
    v_accvgpr_write_b32 a235, v136
    v_cvt_pk_bf16_f32 v84, v158, v159
    v_cvt_pk_bf16_f32 v85, v160, v161
    v_cvt_pk_bf16_f32 v108, v122, v123
    v_cvt_pk_bf16_f32 v109, v124, v125
    ds_read_b128 v[158:161], v143 offset:448
    v_sub_f32 v254, v254, v142
    v_exp_f32 v254, v254
    v_max_f32 v255, v255, v127
    v_cvt_pk_bf16_f32 v254, v254, v254
    ds_write_b16 v8, v254
    v_mov_b32 v127, v255
    ds_read_b128 v[122:125], v9
    ds_read_b128 v[162:165], v9 offset:64
    v_permlane16_swap_b32 v255, v127
    s_waitcnt lgkmcnt(4)
    v_mfma_f32_16x16x16_bf16 v[182:185], a[224:225], v[144:145], v[114:117]
    v_max_f32 v255, v255, v127
    v_sub_f32 v138, v138, v255
    v_sub_f32 v139, v139, v255
    v_mfma_f32_16x16x16_bf16 v[134:137], a[248:249], v[144:145], v[114:117]
    v_exp_f32 v138, v138
    v_sub_f32 v140, v140, v255
    v_mfma_f32_16x16x16_bf16 v[166:169], v[98:99], v[144:145], v[114:117]
    v_exp_f32 v139, v139
    s_waitcnt lgkmcnt(3)
    v_mfma_f32_16x16x16_bf16 v[230:233], a[226:227], v[144:145], v[158:161]
    v_cvt_pk_bf16_f32 v182, v182, v183
    v_accvgpr_write_b32 a224, v182
    v_cvt_pk_bf16_f32 v184, v184, v185
    v_mfma_f32_16x16x16_bf16 v[114:117], a[250:251], v[144:145], v[158:161]
    v_accvgpr_write_b32 a225, v184
    v_cvt_pk_bf16_f32 v134, v134, v135
    v_accvgpr_write_b32 a248, v134
    v_mfma_f32_16x16x16_bf16 v[182:185], v[100:101], v[144:145], v[158:161]
    v_cvt_pk_bf16_f32 v136, v136, v137
    v_accvgpr_write_b32 a249, v136
    s_waitcnt lgkmcnt(1)
    v_cvt_pk_bf16_f32 v98, v166, v167
    v_mfma_f32_16x16x32_bf16 v[158:161], v[122:125], v[28:31], 0
    s_waitcnt lgkmcnt(0)
    v_cvt_pk_bf16_f32 v99, v168, v169
    v_cvt_pk_bf16_f32 v230, v230, v231
    v_mfma_f32_16x16x32_bf16 v[158:161], v[162:165], v[28:31], v[158:161]
    ds_read_b128 v[134:137], v143 offset:512
    v_accvgpr_write_b32 a226, v230
    v_mfma_f32_16x16x32_bf16 v[166:169], v[122:125], v[118:121], 0
    v_cvt_pk_bf16_f32 v232, v232, v233
    v_accvgpr_write_b32 a227, v232
    v_mfma_f32_16x16x32_bf16 v[166:169], v[162:165], v[246:249], v[166:169]
    v_cvt_pk_bf16_f32 v114, v114, v115
    v_accvgpr_write_b32 a250, v114
    v_mfma_f32_16x16x32_bf16 v[230:233], v[122:125], v[146:149], 0
    v_cvt_pk_bf16_f32 v116, v116, v117
    v_accvgpr_write_b32 a251, v116
    v_mfma_f32_16x16x32_bf16 v[230:233], v[162:165], v[154:157], v[230:233]
    v_cvt_pk_bf16_f32 v100, v182, v183
    v_cvt_pk_bf16_f32 v101, v184, v185
    v_mfma_f32_16x16x32_bf16 v[114:117], v[122:125], v[174:177], 0
    ds_read_b128 v[122:125], v143 offset:576
    v_cvt_pk_bf16_f32 v138, v138, v139
    v_mfma_f32_16x16x32_bf16 v[114:117], v[162:165], v[214:217], v[114:117]
    v_exp_f32 v140, v140
    v_sub_f32 v141, v141, v255
    v_exp_f32 v141, v141
    s_waitcnt lgkmcnt(1)
    v_mfma_f32_16x16x16_bf16 v[162:165], a[236:237], v[144:145], v[134:137]
    v_cvt_pk_bf16_f32 v139, v140, v141
    v_sub_f32 v150, v150, v255
    v_sub_f32 v151, v151, v255
    v_mfma_f32_16x16x16_bf16 v[182:185], v[86:87], v[144:145], v[134:137]
    v_exp_f32 v150, v150
    v_sub_f32 v152, v152, v255
    v_mfma_f32_16x16x16_bf16 v[190:193], v[110:111], v[144:145], v[134:137]
    v_exp_f32 v151, v151
    v_cvt_pk_bf16_f32 v162, v162, v163
    v_accvgpr_write_b32 a236, v162
    v_cvt_pk_bf16_f32 v164, v164, v165
    v_accvgpr_write_b32 a237, v164
    v_cvt_pk_bf16_f32 v86, v182, v183
    v_cvt_pk_bf16_f32 v87, v184, v185
    v_cvt_pk_bf16_f32 v140, v150, v151
    s_waitcnt lgkmcnt(0)
    v_mfma_f32_16x16x16_bf16 v[162:165], a[228:229], v[144:145], v[122:125]
    v_cvt_pk_bf16_f32 v110, v190, v191
    v_cvt_pk_bf16_f32 v111, v192, v193
    v_sub_f32 v153, v153, v255
    v_mfma_f32_16x16x16_bf16 v[182:185], a[252:253], v[144:145], v[122:125]
    v_exp_f32 v152, v152
    v_sub_f32 v238, v238, v255
    v_mfma_f32_16x16x16_bf16 v[134:137], v[102:103], v[144:145], v[122:125]
    ds_read_b128 v[190:193], v143 offset:640
    v_cvt_pk_bf16_f32 v162, v162, v163
    v_accvgpr_write_b32 a228, v162
    v_cvt_pk_bf16_f32 v164, v164, v165
    v_accvgpr_write_b32 a229, v164
    v_cvt_pk_bf16_f32 v182, v182, v183
    v_accvgpr_write_b32 a252, v182
    v_cvt_pk_bf16_f32 v184, v184, v185
    v_accvgpr_write_b32 a253, v184
    v_cvt_pk_bf16_f32 v102, v134, v135
    v_cvt_pk_bf16_f32 v103, v136, v137
    ds_read_b128 v[122:125], v143 offset:704
    v_exp_f32 v153, v153
    v_mfma_f32_16x16x32_f16 v[162:165], v[130:133], v[202:205], v[70:73]
    v_cvt_pk_bf16_f32 v141, v152, v153
    v_exp_f32 v238, v238
    v_sub_f32 v239, v239, v255
    v_exp_f32 v239, v239
    v_sub_f32 v240, v240, v255
    v_cvt_pk_bf16_f32 v36, v238, v239
    v_mfma_f32_16x16x16_f16 v[162:165], v[128:129], v[222:223], v[162:165]
    v_exp_f32 v240, v240
    v_sub_f32 v241, v241, v255
    v_sub_f32 v186, v186, v255
    v_mfma_f32_16x16x32_f16 v[130:133], v[170:173], v[202:205], v[74:77]
    s_waitcnt lgkmcnt(1)
    v_exp_f32 v241, v241
    v_mfma_f32_16x16x32_f16 v[126:129], v[178:181], v[202:205], v[78:81]
    v_cvt_pk_bf16_f32 v37, v240, v241
    v_exp_f32 v186, v186
    v_mfma_f32_16x16x16_bf16 v[178:181], a[230:231], v[144:145], v[190:193]
    v_max3_f32 v254, v218, v162, v163
    v_max3_f32 v254, v254, v164, v165
    v_cvt_pk_bf16_f32 v39, v186, 0
    v_mfma_f32_16x16x16_f16 v[130:133], v[228:229], v[222:223], v[130:133]
    v_rcp_f32 v158, v158
    v_mfma_f32_16x16x16_f16 v[126:129], v[224:225], v[222:223], v[126:129]
    v_mul_f32 v166, v166, v158
    v_mfma_f32_16x16x32_bf16 v[150:153], v[28:31], v[36:39], 0
    s_waitcnt lgkmcnt(0)
    v_cvt_pk_bf16_f32 v178, v178, v179
    v_accvgpr_write_b32 a230, v178
    v_mfma_f32_16x16x32_bf16 v[150:153], v[28:31], v[138:141], v[150:153]
    v_cvt_pk_bf16_f32 v180, v180, v181
    v_accvgpr_write_b32 a231, v180
    v_mfma_f32_16x16x32_bf16 v[178:181], v[246:249], v[36:39], 0
    v_max3_f32 v254, v254, v130, v131
    v_max3_f32 v254, v254, v132, v133
    v_mfma_f32_16x16x32_bf16 v[178:181], v[118:121], v[138:141], v[178:181]
    v_max3_f32 v254, v254, v126, v127
    v_max3_f32 v254, v254, v128, v129
    v_mfma_f32_16x16x32_bf16 v[182:185], v[154:157], v[36:39], 0
    v_rcp_f32 v150, v150
    v_mfma_f32_16x16x32_bf16 v[182:185], v[146:149], v[138:141], v[182:185]
    v_mov_b32 v255, v254
    v_mul_f32_dpp v166, v230, v158 quad_perm:[0,1,2,3] row_mask:0x2 bank_mask:0xf
    v_mfma_f32_16x16x32_bf16 v[134:137], v[214:217], v[36:39], 0
    v_mul_f32 v178, v150, v178
    v_mul_f32 v179, v150, v179
    v_mfma_f32_16x16x32_bf16 v[134:137], v[174:177], v[138:141], v[134:137]
    v_cvt_pk_bf16_f32 v138, v178, v179
    v_mul_f32 v180, v150, v180
    v_mul_f32 v181, v150, v181
    v_mfma_f32_16x16x16_bf16 v[170:173], a[254:255], v[144:145], v[190:193]
    v_cvt_pk_bf16_f32 v139, v180, v181
    v_mul_f32 v182, v150, v182
    v_mul_f32 v183, v150, v183
    v_mfma_f32_16x16x16_bf16 v[178:181], v[104:105], v[144:145], v[190:193]
    v_cvt_pk_bf16_f32 v140, v182, v183
    v_mul_f32 v184, v150, v184
    v_mul_f32 v185, v150, v185
    v_mfma_f32_16x16x16_bf16 v[202:205], a[238:239], v[144:145], v[122:125]
    v_cvt_pk_bf16_f32 v141, v184, v185
    v_mul_f32 v134, v150, v134
    v_mul_f32 v135, v150, v135
    v_mfma_f32_16x16x16_bf16 v[182:185], v[88:89], v[144:145], v[122:125]
    v_cvt_pk_bf16_f32 v116, v134, v135
    v_mul_f32 v136, v150, v136
    v_mul_f32 v137, v150, v137
    v_mfma_f32_16x16x16_bf16 v[150:153], v[112:113], v[144:145], v[122:125]
    ds_write_b128 v3, v[138:141] offset:6144
    v_cvt_pk_bf16_f32 v117, v136, v137
    v_cvt_pk_bf16_f32 v170, v170, v171
    v_accvgpr_write_b32 a254, v170
    v_cvt_pk_bf16_f32 v172, v172, v173
    v_accvgpr_write_b32 a255, v172
    v_cvt_pk_bf16_f32 v104, v178, v179
    v_cvt_pk_bf16_f32 v105, v180, v181
    ds_write_b64 v4, v[116:117] offset:10240
    v_cvt_pk_bf16_f32 v202, v202, v203
    v_accvgpr_write_b32 a238, v202
    v_cvt_pk_bf16_f32 v204, v204, v205
    v_accvgpr_write_b32 a239, v204
    v_cvt_pk_bf16_f32 v88, v182, v183
    v_cvt_pk_bf16_f32 v89, v184, v185
    v_cvt_pk_bf16_f32 v112, v150, v151
    v_cvt_pk_bf16_f32 v113, v152, v153
    v_permlane32_swap_b32 v254, v255
    v_max_f32 v254, v254, v255
    v_mov_b32 v255, v254
    v_mul_f32_dpp v166, v114, v158 quad_perm:[0,1,2,3] row_mask:0x4 bank_mask:0xf
    v_cvt_pk_bf16_f32 v166, v166, v166
    ds_write_b16 v7, v166
    v_permlane16_swap_b32 v254, v255
    v_max_f32 v254, v254, v255
    v_sub_f32 v162, v162, v254
    v_exp_f32 v162, v162
    v_sub_f32 v163, v163, v254
    v_exp_f32 v163, v163
    v_sub_f32 v164, v164, v254
    v_cvt_pk_bf16_f32 v138, v162, v163
    v_exp_f32 v164, v164
    ds_read_b128 v[186:189], v0 offset:20480
    ds_read_b128 v[194:197], v1 offset:20480
    ds_read_b128 v[122:125], v0 offset:20608
    ds_read_b128 v[202:205], v1 offset:20608
    ds_read_b128 v[230:233], v0 offset:20736
    ds_read_b128 v[238:241], v1 offset:20736
    v_sub_f32 v165, v165, v254
    v_exp_f32 v165, v165
    v_sub_f32 v130, v130, v254
    v_cvt_pk_bf16_f32 v139, v164, v165
    v_exp_f32 v130, v130
    v_sub_f32 v131, v131, v254
    v_exp_f32 v131, v131
    v_sub_f32 v132, v132, v254
    v_cvt_pk_bf16_f32 v140, v130, v131
    v_exp_f32 v132, v132
    s_waitcnt lgkmcnt(5)
    v_mfma_f32_16x16x32_bf16 v[150:153], a[72:75], v[186:189], 0
    s_waitcnt lgkmcnt(3)
    v_sub_f32 v133, v133, v254
    v_sub_f32 v126, v126, v254
    v_mfma_f32_16x16x32_bf16 v[150:153], a[76:79], v[194:197], v[150:153]
    s_waitcnt lgkmcnt(2)
    v_exp_f32 v133, v133
    v_mfma_f32_16x16x32_bf16 v[150:153], a[80:83], v[122:125], v[150:153]
    s_waitcnt lgkmcnt(1)
    v_cvt_pk_bf16_f32 v141, v132, v133
    v_sub_f32 v127, v127, v254
    v_mfma_f32_16x16x32_bf16 v[150:153], a[84:87], v[202:205], v[150:153]
    s_waitcnt lgkmcnt(0)
    v_exp_f32 v126, v126
    v_mfma_f32_16x16x32_bf16 v[150:153], a[88:91], v[230:233], v[150:153]
    v_exp_f32 v127, v127
    v_mfma_f32_16x16x32_bf16 v[150:153], a[92:95], v[238:241], v[150:153]
    v_cvt_pk_bf16_f32 v36, v126, v127
    v_sub_f32 v128, v128, v254
    v_mfma_f32_16x16x32_bf16 v[162:165], a[96:99], v[186:189], 0
    v_exp_f32 v128, v128
    v_mfma_f32_16x16x32_bf16 v[162:165], a[100:103], v[194:197], v[162:165]
    v_sub_f32 v129, v129, v254
    v_sub_f32 v218, v218, v254
    v_mfma_f32_16x16x32_bf16 v[162:165], a[104:107], v[122:125], v[162:165]
    v_exp_f32 v129, v129
    v_mfma_f32_16x16x32_bf16 v[162:165], a[108:111], v[202:205], v[162:165]
    v_cvt_pk_bf16_f32 v37, v128, v129
    v_add_u32 v7, 16, v7
    v_mfma_f32_16x16x32_bf16 v[162:165], a[112:115], v[230:233], v[162:165]
    v_exp_f32 v218, v218
    v_mfma_f32_16x16x32_bf16 v[162:165], a[116:119], v[238:241], v[162:165]
    v_cvt_pk_bf16_f32 v39, v218, 0
    v_mfma_f32_16x16x32_bf16 v[170:173], a[120:123], v[186:189], 0
    v_mfma_f32_16x16x32_bf16 v[170:173], a[124:127], v[194:197], v[170:173]
    v_mfma_f32_16x16x32_bf16 v[142:145], v[28:31], v[36:39], 0
    v_mfma_f32_16x16x32_bf16 v[142:145], v[28:31], v[138:141], v[142:145]
    v_mfma_f32_16x16x32_bf16 v[130:133], v[246:249], v[36:39], 0
    v_mfma_f32_16x16x32_bf16 v[130:133], v[118:121], v[138:141], v[130:133]
    v_mfma_f32_16x16x32_bf16 v[118:121], v[154:157], v[36:39], 0
    v_mfma_f32_16x16x32_bf16 v[118:121], v[146:149], v[138:141], v[118:121]
    v_mfma_f32_16x16x32_bf16 v[158:161], v[214:217], v[36:39], 0
    v_mfma_f32_16x16x32_bf16 v[158:161], v[174:177], v[138:141], v[158:161]
    v_mfma_f32_16x16x32_bf16 v[170:173], a[128:131], v[122:125], v[170:173]
    v_mfma_f32_16x16x32_bf16 v[170:173], a[132:135], v[202:205], v[170:173]
    v_rcp_f32 v142, v142
    v_mfma_f32_16x16x32_bf16 v[170:173], a[136:139], v[230:233], v[170:173]
    v_mul_f32 v130, v142, v130
    v_mul_f32 v131, v142, v131
    v_mfma_f32_16x16x32_bf16 v[170:173], a[140:143], v[238:241], v[170:173]
    v_cvt_pk_bf16_f32 v174, v130, v131
    v_mul_f32 v132, v142, v132
    v_mfma_f32_16x16x32_bf16 v[138:141], a[0:3], v[186:189], 0
    v_mul_f32 v133, v142, v133
    v_cvt_pk_bf16_f32 v175, v132, v133
    v_mfma_f32_16x16x32_bf16 v[138:141], a[4:7], v[194:197], v[138:141]
    v_mul_f32 v118, v142, v118
    v_mul_f32 v119, v142, v119
    v_mfma_f32_16x16x32_bf16 v[138:141], a[8:11], v[122:125], v[138:141]
    v_cvt_pk_bf16_f32 v176, v118, v119
    v_mul_f32 v120, v142, v120
    v_mfma_f32_16x16x32_bf16 v[138:141], a[12:15], v[202:205], v[138:141]
    v_mul_f32 v121, v142, v121
    v_cvt_pk_bf16_f32 v177, v120, v121
    v_mfma_f32_16x16x32_bf16 v[138:141], a[16:19], v[230:233], v[138:141]
    ds_write_b128 v3, v[174:177] offset:12288
    v_mfma_f32_16x16x32_bf16 v[138:141], a[20:23], v[238:241], v[138:141]
    v_mul_f32 v158, v142, v158
    v_mul_f32 v159, v142, v159
    v_mfma_f32_16x16x32_bf16 v[166:169], a[24:27], v[186:189], 0
    v_cvt_pk_bf16_f32 v254, v158, v159
    v_mul_f32 v160, v142, v160
    v_mfma_f32_16x16x32_bf16 v[166:169], a[28:31], v[194:197], v[166:169]
    v_mul_f32 v161, v142, v161
    v_cvt_pk_bf16_f32 v255, v160, v161
    v_mfma_f32_16x16x32_bf16 v[166:169], a[32:35], v[122:125], v[166:169]
    ds_write_b64 v4, v[254:255] offset:16384
    v_mfma_f32_16x16x32_bf16 v[166:169], a[36:39], v[202:205], v[166:169]
    v_xor_b32 v3, 65536, v3
    v_xor_b32 v4, 65536, v4
    v_mfma_f32_16x16x32_bf16 v[166:169], a[40:43], v[230:233], v[166:169]
    v_mfma_f32_16x16x32_bf16 v[166:169], a[44:47], v[238:241], v[166:169]
    v_mfma_f32_16x16x32_bf16 v[134:137], a[48:51], v[186:189], 0
    v_mfma_f32_16x16x32_bf16 v[134:137], a[52:55], v[194:197], v[134:137]
    s_waitcnt lgkmcnt(0)
    s_barrier
    s_waitcnt lgkmcnt(0)
    s_cmp_eq_u32 s45, 0
    s_cbranch_scc1 L_drain
    s_nop 0
    s_lshr_b32 s3, s44, 8
    s_cbranch_scc1 L_safe
    v_cvt_pk_f16_f32 v146, v150, v151
    v_pk_mul_f16 v143, v146, v146
    v_cvt_pk_f16_f32 v147, v152, v153
    v_pk_fma_f16 v143, v147, v147, v143
    v_cvt_pk_f16_f32 v148, v162, v163
    v_pk_fma_f16 v143, v148, v148, v143
    v_cvt_pk_f16_f32 v149, v164, v165
    v_pk_fma_f16 v143, v149, v149, v143
    v_cvt_pk_f16_f32 v120, v170, v171
    v_pk_fma_f16 v143, v120, v120, v143
    v_cvt_pk_f16_f32 v121, v172, v173
    v_pk_fma_f16 v143, v121, v121, v143
    v_and_b32 v118, 16, v2
    v_sub_u32 v5, v5, v118
    v_mov_b32 v25, 0
    s_nop 7
    s_branch L_go
L_safe:
    v_fma_f32 v174, v150, v150, s32
    v_fmac_f32 v174, v151, v151
    v_fmac_f32 v174, v152, v152
    v_fmac_f32 v174, v153, v153
    s_nop 7
L_LOOP:
    v_mfma_f32_16x16x32_bf16 v[134:137], a[56:59], v[122:125], v[134:137]
    s_add_u32 s12, s40, s27
    ds_read_b128 v[118:121], v2 offset:18432
    ds_read_b128 v[142:145], v2 offset:19456
    v_mfma_f32_16x16x32_bf16 v[134:137], a[60:63], v[202:205], v[134:137]
    s_addc_u32 s13, s41, 0
    v_fmac_f32 v174, v162, v162
    v_fmac_f32 v174, v163, v163
    v_mfma_f32_16x16x32_bf16 v[134:137], a[64:67], v[230:233], v[134:137]
    s_sub_u32 s14, s36, s27
    v_fmac_f32 v174, v164, v164
    v_fmac_f32 v174, v165, v165
    v_mfma_f32_16x16x32_bf16 v[134:137], a[68:71], v[238:241], v[134:137]
    s_cmp_ge_u32 s18, 2
    v_fmac_f32 v174, v170, v170
    v_fmac_f32 v174, v171, v171
    v_mfma_f32_16x16x32_bf16 v[146:149], v[186:189], a[144:147], 0
    s_cselect_b32 s14, s14, 0
    v_fmac_f32 v174, v172, v172
    v_fmac_f32 v174, v173, v173
    v_mfma_f32_16x16x32_bf16 v[146:149], v[194:197], a[148:151], v[146:149]
    s_sub_u32 s82, s72, s71
    v_fma_f32 v254, v138, v138, s32
    v_fmac_f32 v254, v139, v139
    v_mfma_f32_16x16x32_bf16 v[146:149], v[122:125], a[152:155], v[146:149]
    s_mul_i32 s74, s82, 336
    v_fmac_f32 v254, v140, v140
    v_fmac_f32 v254, v141, v141
    v_mfma_f32_16x16x32_bf16 v[146:149], v[202:205], a[156:159], v[146:149]
    s_mul_i32 s75, s82, 272
    v_fmac_f32 v254, v166, v166
    v_fmac_f32 v254, v167, v167
    v_mfma_f32_16x16x32_bf16 v[146:149], v[230:233], a[160:163], v[146:149]
    s_waitcnt lgkmcnt(0)
    v_fmac_f32 v254, v168, v168
    v_fmac_f32 v254, v169, v169
    v_mfma_f32_16x16x32_bf16 v[182:185], v[32:35], v[118:121], 0
    s_mul_i32 s76, s82, 16
    v_fmac_f32 v254, v134, v134
    v_fmac_f32 v254, v135, v135
    v_mfma_f32_16x16x32_bf16 v[182:185], v[32:35], v[142:145], v[182:185]
    s_add_u32 s34, s18, 2
    v_fmac_f32 v254, v136, v136
    v_fmac_f32 v254, v137, v137
    v_mfma_f32_16x16x32_bf16 v[146:149], v[238:241], a[164:167], v[146:149]
    s_add_u32 s8, s60, s23
    ds_read_b128 v[190:193], v0 offset:26624
    v_cvt_pk_bf16_f32 v36, v254, v174
    v_mfma_f32_16x16x32_bf16 v[118:121], v[186:189], a[168:171], 0
    s_addc_u32 s9, s61, 0
    ds_read_b128 v[210:213], v1 offset:26624
    v_mul_f32 v254, 0x3baaaaab, v182
    v_mfma_f32_16x16x32_bf16 v[214:217], v[32:35], v[36:39], 0
    s_sub_u32 s10, s36, s23
    v_cvt_pk_bf16_f32 v142, v146, v147
    v_cvt_pk_bf16_f32 v143, v148, v149
    v_mfma_f32_16x16x32_bf16 v[118:121], v[194:197], a[172:175], v[118:121]
    s_cmp_le_u32 s34, s45
    ds_read_b128 v[218:221], v0 offset:26752
    v_mul_f32 v255, 0x3baaaaab, v183
    v_mfma_f32_16x16x32_bf16 v[118:121], v[122:125], a[176:179], v[118:121]
    s_cselect_b32 s10, s10, 0
    ds_read_b128 v[222:225], v1 offset:26752
    v_mul_f32 v144, 0x3baaaaab, v184
    v_mfma_f32_16x16x32_bf16 v[118:121], v[202:205], a[180:183], v[118:121]
    s_add_u32 m0, s28, 0
    v_rsq_f32 v215, v215
    v_mfma_f32_16x16x32_bf16 v[118:121], v[230:233], a[184:187], v[118:121]
    s_mov_b32 s27, s26
    v_rsq_f32 v214, v214
    v_mfma_f32_16x16x32_bf16 v[118:121], v[238:241], a[188:191], v[118:121]
    s_mov_b32 s26, s25
    v_mul_f32 v214, s31, v214
    v_mul_f32 v150, v215, v150
    v_mul_f32 v151, v215, v151
    v_cvt_pk_f16_f32 v174, v150, v151
    v_mfma_f32_16x16x32_bf16 v[182:185], v[186:189], a[192:195], 0
    s_waitcnt lgkmcnt(2)
    ds_read_b128 v[186:189], v0 offset:26880
    v_cvt_pk_bf16_f32 v146, v118, v119
    v_mfma_f32_16x16x32_bf16 v[182:185], v[194:197], a[196:199], v[182:185]
    s_mov_b32 s25, s24
    ds_read_b128 v[194:197], v1 offset:26880
    v_cvt_pk_bf16_f32 v147, v120, v121
    v_mfma_f32_16x16x32_bf16 v[182:185], v[122:125], a[200:203], v[182:185]
    s_mov_b32 s24, s23
    v_mul_f32 v152, v215, v152
    v_mul_f32 v153, v215, v153
    v_mfma_f32_16x16x32_bf16 v[182:185], v[202:205], a[204:207], v[182:185]
    s_ff1_i32_b32 s77, s100
    v_cvt_pk_f16_f32 v175, v152, v153
    v_mul_f32 v162, v215, v162
    v_mfma_f32_16x16x32_bf16 v[182:185], v[230:233], a[208:211], v[182:185]
    s_mul_i32 s78, s77, 2688
    v_mul_f32 v163, v215, v163
    v_cvt_pk_f16_f32 v176, v162, v163
    v_mfma_f32_16x16x32_bf16 v[182:185], v[238:241], a[212:215], v[182:185]
    s_mov_b32 s71, s72
    v_mul_f32 v164, v215, v164
    v_mul_f32 v165, v215, v165
    v_mfma_f32_16x16x32_bf16 v[122:125], a[72:75], v[190:193], 0
    s_mov_b32 s72, s73
    v_cvt_pk_f16_f32 v177, v164, v165
    v_mul_f32 v170, v215, v170
    v_mfma_f32_16x16x32_bf16 v[122:125], a[76:79], v[210:213], v[122:125]
    s_waitcnt lgkmcnt(2)
    v_cvt_pk_bf16_f32 v150, v182, v183
    v_cvt_pk_bf16_f32 v151, v184, v185
    v_mfma_f32_16x16x32_bf16 v[122:125], a[80:83], v[218:221], v[122:125]
    s_waitcnt lgkmcnt(1)
    v_mul_f32 v171, v215, v171
    v_cvt_pk_f16_f32 v120, v170, v171
    v_mfma_f32_16x16x32_bf16 v[122:125], a[84:87], v[222:225], v[122:125]
    s_waitcnt lgkmcnt(0)
    v_mul_f32 v172, v215, v172
    v_mul_f32 v173, v215, v173
    v_mfma_f32_16x16x32_bf16 v[122:125], a[88:91], v[186:189], v[122:125]
    v_cvt_pk_f16_f32 v121, v172, v173
    v_mul_f32 v138, v214, v138
    v_mfma_f32_16x16x32_bf16 v[122:125], a[92:95], v[194:197], v[122:125]
    v_mul_f32 v139, v214, v139
    v_cvt_pk_f16_f32 v202, v138, v139
    v_mfma_f32_16x16x32_bf16 v[162:165], a[96:99], v[190:193], 0
    v_mul_f32 v140, v214, v140
    v_mul_f32 v141, v214, v141
    v_mfma_f32_16x16x32_bf16 v[162:165], a[100:103], v[210:213], v[162:165]
    v_cvt_pk_f16_f32 v203, v140, v141
    v_mul_f32 v166, v214, v166
    v_mfma_f32_16x16x32_bf16 v[162:165], a[104:107], v[218:221], v[162:165]
    v_mul_f32 v167, v214, v167
    v_cvt_pk_f16_f32 v204, v166, v167
    v_mfma_f32_16x16x32_bf16 v[162:165], a[108:111], v[222:225], v[162:165]
    v_mul_f32 v168, v214, v168
    v_mul_f32 v169, v214, v169
    v_mfma_f32_16x16x32_bf16 v[162:165], a[112:115], v[186:189], v[162:165]
    v_cvt_pk_f16_f32 v205, v168, v169
    v_mul_f32 v134, v214, v134
    v_mfma_f32_16x16x32_bf16 v[162:165], a[116:119], v[194:197], v[162:165]
    v_mul_f32 v135, v214, v135
    v_cvt_pk_f16_f32 v118, v134, v135
    v_mfma_f32_16x16x32_bf16 v[166:169], a[120:123], v[190:193], 0
    v_mul_f32 v136, v214, v136
    v_mul_f32 v137, v214, v137
    v_mfma_f32_16x16x32_bf16 v[166:169], a[124:127], v[210:213], v[166:169]
    v_cvt_pk_f16_f32 v119, v136, v137
    v_fma_f32 v145, v122, v122, s32
    v_mfma_f32_16x16x32_bf16 v[166:169], a[128:131], v[218:221], v[166:169]
    v_rsq_f32 v254, v254
    v_mfma_f32_16x16x32_bf16 v[166:169], a[132:135], v[222:225], v[166:169]
    v_fmac_f32 v145, v123, v123
    v_fmac_f32 v145, v124, v124
    v_mfma_f32_16x16x32_bf16 v[166:169], a[136:139], v[186:189], v[166:169]
    v_fmac_f32 v145, v125, v125
    v_fmac_f32 v145, v162, v162
    v_mfma_f32_16x16x32_bf16 v[166:169], a[140:143], v[194:197], v[166:169]
    v_fmac_f32 v145, v163, v163
    v_fmac_f32 v145, v164, v164
    v_mfma_f32_16x16x32_bf16 v[134:137], a[0:3], v[190:193], 0
    v_fmac_f32 v145, v165, v165
    v_mul_f32 v178, v254, v178
    v_mfma_f32_16x16x32_bf16 v[134:137], a[4:7], v[210:213], v[134:137]
    v_rsq_f32 v255, v255
    v_mfma_f32_16x16x32_bf16 v[134:137], a[8:11], v[218:221], v[134:137]
    v_fmac_f32 v145, v166, v166
    v_fmac_f32 v145, v167, v167
    v_mfma_f32_16x16x32_bf16 v[134:137], a[12:15], v[222:225], v[134:137]
    v_fmac_f32 v145, v168, v168
    v_fmac_f32 v145, v169, v169
    v_mfma_f32_16x16x32_bf16 v[134:137], a[16:19], v[186:189], v[134:137]
    v_rsq_f32 v144, v144
    v_mfma_f32_16x16x32_bf16 v[134:137], a[20:23], v[194:197], v[134:137]
    v_mul_f32 v242, v144, v242
    v_mul_f32 v243, v144, v243
    v_mfma_f32_16x16x32_bf16 v[170:173], a[24:27], v[190:193], 0
    v_cvt_pk_bf16_f32 v138, v242, v243
    v_mul_f32 v244, v144, v244
    v_mfma_f32_16x16x32_bf16 v[170:173], a[28:31], v[210:213], v[170:173]
    v_mul_f32 v245, v144, v245
    v_cvt_pk_bf16_f32 v139, v244, v245
    v_mfma_f32_16x16x32_bf16 v[170:173], a[32:35], v[218:221], v[170:173]
    v_fma_f32 v148, v134, v134, s32
    v_fmac_f32 v148, v135, v135
    v_mfma_f32_16x16x32_bf16 v[170:173], a[36:39], v[222:225], v[170:173]
    v_fmac_f32 v148, v136, v136
    v_fmac_f32 v148, v137, v137
    v_mfma_f32_16x16x32_bf16 v[170:173], a[40:43], v[186:189], v[170:173]
    v_mul_f32 v158, v144, v158
    v_mul_f32 v159, v144, v159
    v_mfma_f32_16x16x32_bf16 v[170:173], a[44:47], v[194:197], v[170:173]
    v_cvt_pk_bf16_f32 v140, v158, v159
    v_mul_f32 v160, v144, v160
    v_mfma_f32_16x16x32_bf16 v[182:185], a[48:51], v[190:193], 0
    v_mul_f32 v161, v144, v161
    v_cvt_pk_bf16_f32 v141, v160, v161
    v_mfma_f32_16x16x32_bf16 v[182:185], a[52:55], v[210:213], v[182:185]
    buffer_store_dwordx4 v[138:141], v17, s[12:15], 0 offen nt
    v_mul_f32 v154, v144, v154
    v_fmac_f32 v148, v170, v170
    v_fmac_f32 v148, v171, v171
    v_fmac_f32 v148, v172, v172
    v_mfma_f32_16x16x32_bf16 v[182:185], a[56:59], v[218:221], v[182:185]
    v_fmac_f32 v148, v173, v173
    v_mul_f32 v155, v144, v155
    v_mfma_f32_16x16x32_bf16 v[182:185], a[60:63], v[222:225], v[182:185]
    v_cvt_pk_bf16_f32 v152, v154, v155
    v_mul_f32 v156, v144, v156
    v_mfma_f32_16x16x32_bf16 v[182:185], a[64:67], v[186:189], v[182:185]
    v_mul_f32 v157, v144, v157
    v_cvt_pk_bf16_f32 v153, v156, v157
    v_mfma_f32_16x16x32_bf16 v[182:185], a[68:71], v[194:197], v[182:185]
    v_mul_f32 v179, v254, v179
    v_cvt_pk_bf16_f32 v158, v178, v179
    v_mfma_f32_16x16x32_bf16 v[138:141], v[190:193], a[144:147], 0
    v_mul_f32 v180, v254, v180
    v_mul_f32 v181, v254, v181
    v_mfma_f32_16x16x32_bf16 v[138:141], v[210:213], a[148:151], v[138:141]
    v_cvt_pk_bf16_f32 v159, v180, v181
    v_mul_f32 v198, v254, v198
    v_mfma_f32_16x16x32_bf16 v[138:141], v[218:221], a[152:155], v[138:141]
    v_fmac_f32 v148, v182, v182
    v_fmac_f32 v148, v183, v183
    v_mfma_f32_16x16x32_bf16 v[138:141], v[222:225], a[156:159], v[138:141]
    v_fmac_f32 v148, v184, v184
    v_fmac_f32 v148, v185, v185
    v_mfma_f32_16x16x32_bf16 v[138:141], v[186:189], a[160:163], v[138:141]
    v_cvt_pk_bf16_f32 v36, v148, v145
    v_mul_f32 v199, v254, v199
    v_mfma_f32_16x16x32_bf16 v[138:141], v[194:197], a[164:167], v[138:141]
    ds_read_b128 v[214:217], v0 offset:32768
    v_cvt_pk_bf16_f32 v160, v198, v199
    v_mfma_f32_16x16x32_bf16 v[178:181], v[32:35], v[36:39], 0
    v_mul_f32 v200, v254, v200
    v_mul_f32 v201, v254, v201
    v_mfma_f32_16x16x32_bf16 v[154:157], v[190:193], a[168:171], 0
    ds_read_b128 v[226:229], v1 offset:32768
    v_cvt_pk_bf16_f32 v161, v200, v201
    v_mfma_f32_16x16x32_bf16 v[154:157], v[210:213], a[172:175], v[154:157]
    ds_read_b128 v[198:201], v0 offset:32896
    v_cvt_pk_bf16_f32 v144, v138, v139
    v_mfma_f32_16x16x32_bf16 v[154:157], v[218:221], a[176:179], v[154:157]
    v_cvt_pk_bf16_f32 v145, v140, v141
    v_mul_f32 v206, v254, v206
    v_mfma_f32_16x16x32_bf16 v[154:157], v[222:225], a[180:183], v[154:157]
    ds_read_b128 v[230:233], v1 offset:32896
    v_mul_f32 v207, v254, v207
    v_mfma_f32_16x16x32_bf16 v[154:157], v[186:189], a[184:187], v[154:157]
    v_rsq_f32 v179, v179
    v_mfma_f32_16x16x32_bf16 v[154:157], v[194:197], a[188:191], v[154:157]
    buffer_store_dwordx2 v[152:153], v20, s[12:15], 0 offen nt
    v_rsq_f32 v178, v178
    v_mul_f32 v122, v179, v122
    v_mul_f32 v178, s31, v178
    v_mul_f32 v123, v179, v123
    v_cvt_pk_f16_f32 v138, v122, v123
    v_mul_f32 v124, v179, v124
    v_mul_f32 v125, v179, v125
    v_cvt_pk_bf16_f32 v148, v154, v155
    v_mfma_f32_16x16x32_bf16 v[234:237], v[190:193], a[192:195], 0
    s_waitcnt lgkmcnt(2)
    ds_read_b128 v[190:193], v0 offset:33024
    v_cvt_pk_bf16_f32 v149, v156, v157
    v_mfma_f32_16x16x32_bf16 v[234:237], v[210:213], a[196:199], v[234:237]
    s_waitcnt lgkmcnt(2)
    ds_read_b128 v[210:213], v1 offset:33024
    v_cvt_pk_f16_f32 v139, v124, v125
    v_mfma_f32_16x16x32_bf16 v[234:237], v[218:221], a[200:203], v[234:237]
    v_mul_f32 v162, v179, v162
    v_mul_f32 v163, v179, v163
    v_mfma_f32_16x16x32_bf16 v[234:237], v[222:225], a[204:207], v[234:237]
    s_waitcnt vmcnt(2)
    v_cvt_pk_f16_f32 v140, v162, v163
    v_mul_f32 v164, v179, v164
    v_mfma_f32_16x16x32_bf16 v[234:237], v[186:189], a[208:211], v[234:237]
    s_waitcnt lgkmcnt(2)
    v_mul_f32 v165, v179, v165
    v_cvt_pk_f16_f32 v141, v164, v165
    v_mfma_f32_16x16x32_bf16 v[234:237], v[194:197], a[212:215], v[234:237]
    v_mul_f32 v166, v179, v166
    v_mul_f32 v167, v179, v167
    v_mfma_f32_16x16x32_bf16 v[186:189], a[72:75], v[214:217], 0
    v_cvt_pk_f16_f32 v124, v166, v167
    v_mul_f32 v168, v179, v168
    v_mfma_f32_16x16x32_bf16 v[186:189], a[76:79], v[226:229], v[186:189]
    v_mul_f32 v169, v179, v169
    v_cvt_pk_f16_f32 v125, v168, v169
    v_mfma_f32_16x16x32_bf16 v[186:189], a[80:83], v[198:201], v[186:189]
    s_waitcnt lgkmcnt(1)
    v_cvt_pk_bf16_f32 v152, v234, v235
    v_cvt_pk_bf16_f32 v153, v236, v237
    v_mfma_f32_16x16x32_bf16 v[186:189], a[84:87], v[230:233], v[186:189]
    s_waitcnt lgkmcnt(0)
    v_mul_f32 v134, v178, v134
    v_mul_f32 v135, v178, v135
    v_mfma_f32_16x16x32_bf16 v[186:189], a[88:91], v[190:193], v[186:189]
    s_barrier
    v_cvt_pk_f16_f32 v154, v134, v135
    v_mul_f32 v136, v178, v136
    v_mfma_f32_16x16x32_bf16 v[186:189], a[92:95], v[210:213], v[186:189]
    v_mul_f32 v137, v178, v137
    v_cvt_pk_f16_f32 v155, v136, v137
    v_mfma_f32_16x16x32_bf16 v[134:137], a[96:99], v[214:217], 0
    v_mul_f32 v170, v178, v170
    v_mul_f32 v171, v178, v171
    v_mfma_f32_16x16x32_bf16 v[134:137], a[100:103], v[226:229], v[134:137]
    v_cvt_pk_f16_f32 v156, v170, v171
    v_mul_f32 v172, v178, v172
    v_mfma_f32_16x16x32_bf16 v[134:137], a[104:107], v[198:201], v[134:137]
    buffer_load_dwordx4 v10, s[8:11], 0 offen nt lds
    v_mul_f32 v173, v178, v173
    v_mfma_f32_16x16x32_bf16 v[134:137], a[108:111], v[230:233], v[134:137]
    s_add_u32 m0, s28, 4096
    v_cvt_pk_f16_f32 v157, v172, v173
    v_mul_f32 v182, v178, v182
    v_mfma_f32_16x16x32_bf16 v[134:137], a[112:115], v[190:193], v[134:137]
    v_mul_f32 v183, v178, v183
    v_cvt_pk_f16_f32 v122, v182, v183
    v_mfma_f32_16x16x32_bf16 v[134:137], a[116:119], v[210:213], v[134:137]
    v_mul_f32 v184, v178, v184
    v_mul_f32 v185, v178, v185
    v_mfma_f32_16x16x32_bf16 v[218:221], a[120:123], v[214:217], 0
    v_cvt_pk_f16_f32 v123, v184, v185
    v_cvt_pk_bf16_f32 v170, v206, v207
    v_mfma_f32_16x16x32_bf16 v[218:221], a[124:127], v[226:229], v[218:221]
    buffer_load_dwordx4 v11, s[8:11], 0 offen nt lds
    v_mul_f32 v208, v254, v208
    v_mfma_f32_16x16x32_bf16 v[218:221], a[128:131], v[198:201], v[218:221]
    s_add_u32 m0, s28, 8192
    v_mul_f32 v209, v254, v209
    v_cvt_pk_bf16_f32 v171, v208, v209
    v_mfma_f32_16x16x32_bf16 v[218:221], a[132:135], v[230:233], v[218:221]
    v_fma_f32 v162, v186, v186, s32
    v_fmac_f32 v162, v187, v187
    v_mfma_f32_16x16x32_bf16 v[218:221], a[136:139], v[190:193], v[218:221]
    v_fmac_f32 v162, v188, v188
    v_fmac_f32 v162, v189, v189
    v_mfma_f32_16x16x32_bf16 v[218:221], a[140:143], v[210:213], v[218:221]
    v_fmac_f32 v162, v134, v134
    v_fmac_f32 v162, v135, v135
    v_mfma_f32_16x16x32_bf16 v[222:225], a[0:3], v[214:217], 0
    buffer_load_dwordx4 v12, s[8:11], 0 offen nt lds
    v_fmac_f32 v162, v136, v136
    v_mfma_f32_16x16x32_bf16 v[222:225], a[4:7], v[226:229], v[222:225]
    s_add_u32 m0, s28, 12288
    v_fmac_f32 v162, v137, v137
    v_fmac_f32 v162, v218, v218
    v_mfma_f32_16x16x32_bf16 v[222:225], a[8:11], v[198:201], v[222:225]
    s_xor_b32 s28, s28, 65536
    v_fmac_f32 v162, v219, v219
    v_fmac_f32 v162, v220, v220
    v_mfma_f32_16x16x32_bf16 v[222:225], a[12:15], v[230:233], v[222:225]
    v_fmac_f32 v162, v221, v221
    v_mul_f32 v130, v255, v130
    v_mfma_f32_16x16x32_bf16 v[222:225], a[16:19], v[190:193], v[222:225]
    v_mul_f32 v131, v255, v131
    v_cvt_pk_bf16_f32 v130, v130, v131
    v_mfma_f32_16x16x32_bf16 v[222:225], a[20:23], v[210:213], v[222:225]
    buffer_load_dwordx4 v13, s[8:11], 0 offen nt lds
    v_mul_f32 v132, v255, v132
    v_mfma_f32_16x16x32_bf16 v[238:241], a[24:27], v[214:217], 0
    s_mov_b32 m0, s29
    v_mul_f32 v133, v255, v133
    v_cvt_pk_bf16_f32 v131, v132, v133
    v_mfma_f32_16x16x32_bf16 v[238:241], a[28:31], v[226:229], v[238:241]
    s_xor_b32 s29, s29, s30
    v_fma_f32 v163, v222, v222, s32
    v_fmac_f32 v163, v223, v223
    v_mfma_f32_16x16x32_bf16 v[238:241], a[32:35], v[198:201], v[238:241]
    s_add_u32 s19, s19, s20
    v_fmac_f32 v163, v224, v224
    v_fmac_f32 v163, v225, v225
    v_mfma_f32_16x16x32_bf16 v[238:241], a[36:39], v[230:233], v[238:241]
    s_add_u32 s23, s23, s21
    v_mul_f32 v126, v255, v126
    v_mul_f32 v127, v255, v127
    v_mfma_f32_16x16x32_bf16 v[238:241], a[40:43], v[190:193], v[238:241]
    buffer_load_dwordx4 v14, s[8:11], 0 offen nt lds
    v_cvt_pk_bf16_f32 v132, v126, v127
    v_mfma_f32_16x16x32_bf16 v[238:241], a[44:47], v[210:213], v[238:241]
    s_cmp_ge_u32 s19, 72
    v_mul_f32 v128, v255, v128
    v_mul_f32 v129, v255, v129
    v_mfma_f32_16x16x32_bf16 v[178:181], a[48:51], v[214:217], 0
    s_cselect_b32 s34, 72, 0
    v_cvt_pk_bf16_f32 v133, v128, v129
    v_mul_f32 v114, v255, v114
    v_mfma_f32_16x16x32_bf16 v[178:181], a[52:55], v[226:229], v[178:181]
    s_cselect_b32 s35, s22, 0
    v_fmac_f32 v163, v238, v238
    v_fmac_f32 v163, v239, v239
    v_mfma_f32_16x16x32_bf16 v[178:181], a[56:59], v[198:201], v[178:181]
    s_sub_u32 s19, s19, s34
    v_fmac_f32 v163, v240, v240
    v_fmac_f32 v163, v241, v241
    v_mfma_f32_16x16x32_bf16 v[178:181], a[60:63], v[230:233], v[178:181]
    buffer_store_dwordx4 v[158:161], v15, s[12:15], 0 offen nt
    v_mul_f32 v115, v255, v115
    v_cvt_pk_bf16_f32 v254, v114, v115
    v_mul_f32 v116, v255, v116
    v_mul_f32 v117, v255, v117
    v_mfma_f32_16x16x32_bf16 v[178:181], a[64:67], v[190:193], v[178:181]
    s_add_u32 s23, s23, s35
    v_cvt_pk_bf16_f32 v255, v116, v117
    v_xor_b32 v0, 65536, v0
    v_mfma_f32_16x16x32_bf16 v[178:181], a[68:71], v[210:213], v[178:181]
    s_add_u32 s78, s78, s69
    v_xor_b32 v1, 65536, v1
    s_add_u32 s80, s77, s68
    v_mfma_f32_16x16x32_bf16 v[114:117], v[214:217], a[144:147], 0
    s_cmp_ge_u32 s80, 72
    s_cselect_b32 s80, s22, 0
    s_add_u32 s78, s78, s80
    v_mfma_f32_16x16x32_bf16 v[114:117], v[226:229], a[148:151], v[114:117]
    s_add_u32 s80, s77, 20
    v_fmac_f32 v163, v178, v178
    v_fmac_f32 v163, v179, v179
    v_mfma_f32_16x16x32_bf16 v[114:117], v[198:201], a[152:155], v[114:117]
    s_add_u32 s34, s18, 3
    v_fmac_f32 v163, v180, v180
    v_fmac_f32 v163, v181, v181
    v_mfma_f32_16x16x32_bf16 v[114:117], v[230:233], a[156:159], v[114:117]
    s_cmp_lt_u32 s77, s62
    ds_read2_b32 v[164:165], v6 offset0:0 offset1:0
    ds_read2_b32 v[168:169], v6 offset0:16 offset1:16
    v_mfma_f32_16x16x32_bf16 v[114:117], v[190:193], a[160:163], v[114:117]
    s_cselect_b32 s79, 1, 0
    ds_read2_b32 v[172:173], v6 offset0:32 offset1:32
    v_cvt_pk_bf16_f32 v36, v163, v162
    v_mfma_f32_16x16x32_bf16 v[114:117], v[210:213], a[164:167], v[114:117]
    s_cselect_b32 s78, s78, 0
    s_cmp_lt_u32 s34, s17
    s_cselect_b32 s23, s23, s78
    v_mfma_f32_16x16x32_bf16 v[234:237], v[32:35], v[36:39], 0
    s_cselect_b32 s73, s34, s80
    s_cselect_b32 s79, 0, s79
    s_cselect_b32 s81, 0, 1
    v_mfma_f32_16x16x32_bf16 v[126:129], v[214:217], a[168:171], 0
    s_sub_u32 s80, s100, s81
    v_cvt_pk_bf16_f32 v162, v114, v115
    v_cvt_pk_bf16_f32 v163, v116, v117
    v_mfma_f32_16x16x32_bf16 v[126:129], v[226:229], a[172:175], v[126:129]
    s_and_b32 s100, s100, s80
    v_rsq_f32 v235, v235
    v_mfma_f32_16x16x32_bf16 v[126:129], v[198:201], a[176:179], v[126:129]
    s_lshl_b32 s80, s79, s73
    v_rsq_f32 v234, v234
    v_mfma_f32_16x16x32_bf16 v[126:129], v[230:233], a[180:183], v[126:129]
    s_or_b32 s70, s70, s80
    v_mul_f32 v234, s31, v234
    v_mul_f32 v186, v235, v186
    v_mfma_f32_16x16x32_bf16 v[126:129], v[190:193], a[184:187], v[126:129]
    s_add_u32 s45, s45, s79
    v_mul_f32 v187, v235, v187
    v_cvt_pk_f16_f32 v114, v186, v187
    v_mfma_f32_16x16x32_bf16 v[126:129], v[210:213], a[188:191], v[126:129]
    s_add_u32 s18, s18, 1
    v_mul_f32 v188, v235, v188
    v_mul_f32 v189, v235, v189
    v_mfma_f32_16x16x32_bf16 v[158:161], v[214:217], a[192:195], 0
    s_cmp_lt_u32 s18, s45
    v_cvt_pk_f16_f32 v115, v188, v189
    v_mul_f32 v134, v235, v134
    v_mfma_f32_16x16x32_bf16 v[158:161], v[226:229], a[196:199], v[158:161]
    s_waitcnt lgkmcnt(0)
    buffer_store_dwordx2 v[170:171], v18, s[12:15], 0 offen nt
    v_cvt_pk_bf16_f32 v166, v126, v127
    v_cvt_pk_bf16_f32 v167, v128, v129
    v_mfma_f32_16x16x32_bf16 v[158:161], v[198:201], a[200:203], v[158:161]
    ds_read_b128 v[226:229], v5 offset:0
    ds_read_b128 v[206:209], v5 offset:16
    v_mfma_f32_16x16x32_bf16 v[158:161], v[230:233], a[204:207], v[158:161]
    ds_read_b128 v[198:201], v5 offset:48
    ds_read_b32 v236, v6 offset:192
    v_mfma_f32_16x16x32_bf16 v[158:161], v[190:193], a[208:211], v[158:161]
    v_mul_f32 v135, v235, v135
    v_cvt_pk_f16_f32 v116, v134, v135
    v_mfma_f32_16x16x32_f16 v[186:189], v[174:177], v[202:205], v[46:49]
    v_mul_f32 v136, v235, v136
    v_mul_f32 v137, v235, v137
    v_mfma_f32_16x16x32_f16 v[182:185], v[138:141], v[202:205], v[50:53]
    v_cvt_pk_f16_f32 v117, v136, v137
    v_mul_f32 v218, v235, v218
    v_mfma_f32_16x16x32_bf16 v[158:161], v[210:213], a[212:215], v[158:161]
    ds_read_b128 v[194:197], v2 offset:0
    ds_read_b128 v[190:193], v2 offset:1024
    v_mfma_f32_16x16x32_f16 v[126:129], v[114:117], v[202:205], v[54:57]
    v_mul_f32 v219, v235, v219
    v_cvt_pk_f16_f32 v136, v218, v219
    v_mul_f32 v220, v235, v220
    v_mfma_f32_16x16x16_f16 v[186:189], v[120:121], v[118:119], v[186:189]
    v_mul_f32 v221, v235, v221
    v_cvt_pk_bf16_f32 v170, v158, v159
    v_cvt_pk_bf16_f32 v171, v160, v161
    v_mfma_f32_16x16x16_f16 v[182:185], v[124:125], v[118:119], v[182:185]
    v_cvt_pk_f16_f32 v137, v220, v221
    v_mul_f32 v222, v234, v222
    v_mul_f32 v223, v234, v223
    v_mfma_f32_16x16x16_f16 v[126:129], v[136:137], v[118:119], v[126:129]
    v_cvt_pk_f16_f32 v158, v222, v223
    v_mul_f32 v224, v234, v224
    v_mul_f32 v225, v234, v225
    s_waitcnt lgkmcnt(2)
    v_mfma_f32_16x16x32_f16 v[230:233], v[226:229], v[202:205], v[22:25]
    ds_read_b128 v[210:213], v2 offset:2048
    ds_read_b128 v[202:205], v2 offset:3072
    v_mfma_f32_16x16x32_f16 v[230:233], v[206:209], v[174:177], v[230:233]
    v_cvt_pk_f16_f32 v159, v224, v225
    v_mul_f32 v238, v234, v238
    v_mfma_f32_16x16x32_f16 v[230:233], v[198:201], v[118:121], v[230:233]
    s_waitcnt lgkmcnt(2)
    ds_read_b128 v[214:217], v2 offset:4096
    v_mul_f32 v239, v234, v239
    v_cvt_pk_f16_f32 v160, v238, v239
    v_mul_f32 v240, v234, v240
    v_mul_f32 v241, v234, v241
    v_cvt_pk_f16_f32 v161, v240, v241
    v_mfma_f32_16x16x32_f16 v[218:221], v[226:229], v[154:157], v[24:27]
    v_mul_f32 v178, v234, v178
    v_mul_f32 v179, v234, v179
    v_mfma_f32_16x16x32_f16 v[218:221], v[206:209], v[138:141], v[218:221]
    v_cvt_pk_f16_f32 v134, v178, v179
    v_mul_f32 v180, v234, v180
    v_mfma_f32_16x16x32_f16 v[218:221], v[198:201], v[122:125], v[218:221]
    buffer_store_dwordx4 v[130:133], v16, s[12:15], 0 offen nt
    ds_read_b128 v[222:225], v2 offset:5120
    v_mul_f32 v181, v234, v181
    v_cvt_pk_f16_f32 v135, v180, v181
    v_mov_b32_dpp v236, v231 quad_perm:[0,1,2,3] row_mask:0x1 bank_mask:0xf
    v_mfma_f32_16x16x32_f16 v[238:241], v[226:229], v[158:161], v[26:29]
    s_waitcnt lgkmcnt(2)
    v_max3_f32 v118, v230, v186, v187
    v_mov_b32_dpp v236, v219 quad_perm:[0,1,2,3] row_mask:0x2 bank_mask:0xf
    v_mfma_f32_16x16x32_f16 v[238:241], v[206:209], v[114:117], v[238:241]
    v_max3_f32 v118, v118, v188, v189
    v_max3_f32 v118, v118, v182, v183
    v_mfma_f32_16x16x32_f16 v[238:241], v[198:201], v[134:137], v[238:241]
    s_waitcnt lgkmcnt(1)
    v_max3_f32 v118, v118, v184, v185
    v_max3_f32 v118, v118, v126, v127
    v_mfma_f32_16x16x32_bf16 v[178:181], a[216:219], v[194:197], 0
    v_max3_f32 v118, v118, v128, v129
    v_mov_b32 v119, v118
    v_mfma_f32_16x16x32_bf16 v[178:181], a[220:223], v[190:193], v[178:181]
    v_add_u32 v5, s74, v5
    v_mov_b32_dpp v236, v239 quad_perm:[0,1,2,3] row_mask:0x4 bank_mask:0xf
    v_mfma_f32_16x16x32_bf16 v[178:181], a[224:227], v[210:213], v[178:181]
    v_permlane32_swap_b32 v118, v119
    v_mfma_f32_16x16x32_bf16 v[178:181], a[228:231], v[202:205], v[178:181]
    s_waitcnt lgkmcnt(0)
    v_max_f32 v118, v118, v119
    v_mov_b32 v119, v118
    v_mfma_f32_16x16x32_bf16 v[178:181], a[232:235], v[214:217], v[178:181]
    v_mov_b32 v219, v236
    v_add_u32 v6, s75, v6
    v_mfma_f32_16x16x32_bf16 v[178:181], a[236:239], v[222:225], v[178:181]
    v_permlane16_swap_b32 v118, v119
    v_mfma_f32_16x16x32_bf16 v[198:201], a[240:243], v[194:197], 0
    v_max_f32 v118, v118, v119
    v_sub_f32 v186, v186, v118
    v_mfma_f32_16x16x32_bf16 v[198:201], a[244:247], v[190:193], v[198:201]
    v_exp_f32 v186, v186
    v_mfma_f32_16x16x32_bf16 v[198:201], a[248:251], v[210:213], v[198:201]
    v_sub_f32 v187, v187, v118
    v_sub_f32 v188, v188, v118
    v_mfma_f32_16x16x32_bf16 v[198:201], a[252:255], v[202:205], v[198:201]
    v_exp_f32 v187, v187
    v_mfma_f32_16x16x32_bf16 v[198:201], v[82:85], v[214:217], v[198:201]
    v_cvt_pk_bf16_f32 v186, v186, v187
    v_sub_f32 v189, v189, v118
    v_mfma_f32_16x16x32_bf16 v[198:201], v[86:89], v[222:225], v[198:201]
    v_exp_f32 v188, v188
    v_mfma_f32_16x16x32_bf16 v[206:209], v[90:93], v[194:197], 0
    ds_read_b128 v[194:197], v2 offset:6144
    buffer_store_dwordx2 v[254:255], v19, s[12:15], 0 offen nt
    v_exp_f32 v189, v189
    v_mfma_f32_16x16x32_bf16 v[206:209], v[94:97], v[190:193], v[206:209]
    ds_read_b128 v[190:193], v2 offset:7168
    v_cvt_pk_bf16_f32 v187, v188, v189
    v_mfma_f32_16x16x32_bf16 v[206:209], v[98:101], v[210:213], v[206:209]
    ds_read_b128 v[210:213], v2 offset:8192
    v_sub_f32 v182, v182, v118
    v_mfma_f32_16x16x32_bf16 v[206:209], v[102:105], v[202:205], v[206:209]
    ds_read_b128 v[202:205], v2 offset:9216
    v_sub_f32 v183, v183, v118
    v_mfma_f32_16x16x32_bf16 v[206:209], v[106:109], v[214:217], v[206:209]
    ds_read_b128 v[214:217], v2 offset:10240
    v_sub_f32 v184, v184, v118
    v_mfma_f32_16x16x32_bf16 v[206:209], v[110:113], v[222:225], v[206:209]
    ds_read_b128 v[222:225], v2 offset:11264
    v_exp_f32 v182, v182
    v_mfma_f32_16x16x32_f16 v[226:229], v[174:177], v[154:157], v[58:61]
    v_exp_f32 v183, v183
    s_waitcnt lgkmcnt(5)
    v_mfma_f32_16x16x32_bf16 v[130:133], a[216:219], v[194:197], 0
    v_cvt_pk_bf16_f32 v188, v182, v183
    v_exp_f32 v184, v184
    s_waitcnt lgkmcnt(4)
    v_mfma_f32_16x16x16_f16 v[226:229], v[120:121], v[122:123], v[226:229]
    v_sub_f32 v185, v185, v118
    v_exp_f32 v185, v185
    v_sub_f32 v126, v126, v118
    v_mfma_f32_16x16x32_bf16 v[130:133], a[220:223], v[190:193], v[130:133]
    s_waitcnt lgkmcnt(2)
    v_cvt_pk_bf16_f32 v189, v184, v185
    v_sub_f32 v127, v127, v118
    v_mfma_f32_16x16x32_bf16 v[130:133], a[224:227], v[210:213], v[130:133]
    s_waitcnt lgkmcnt(1)
    v_exp_f32 v126, v126
    v_mfma_f32_16x16x32_bf16 v[130:133], a[228:231], v[202:205], v[130:133]
    s_waitcnt lgkmcnt(0)
    v_exp_f32 v127, v127
    v_mfma_f32_16x16x32_bf16 v[130:133], a[232:235], v[214:217], v[130:133]
    v_cvt_pk_bf16_f32 v36, v126, v127
    v_sub_f32 v128, v128, v118
    v_mfma_f32_16x16x32_f16 v[182:185], v[138:141], v[154:157], v[62:65]
    v_exp_f32 v128, v128
    v_mfma_f32_16x16x32_bf16 v[130:133], a[236:239], v[222:225], v[130:133]
    v_sub_f32 v129, v129, v118
    v_exp_f32 v129, v129
    v_sub_f32 v230, v230, v118
    v_cvt_pk_bf16_f32 v37, v128, v129
    v_mfma_f32_16x16x16_f16 v[182:185], v[124:125], v[122:123], v[182:185]
    v_exp_f32 v230, v230
    v_max_f32_dpp v219, v219, v219 quad_perm:[1,0,3,2] row_mask:0xf bank_mask:0xf
    v_cvt_pk_bf16_f32 v39, v230, 0
    v_mfma_f32_16x16x32_f16 v[230:233], v[114:117], v[154:157], v[66:69]
    v_max_f32_dpp v219, v219, v219 quad_perm:[2,3,0,1] row_mask:0xf bank_mask:0xf
    v_max3_f32 v254, v218, v226, v227
    v_max3_f32 v254, v254, v228, v229
    v_max_f32_dpp v219, v219, v219 row_half_mirror row_mask:0xf bank_mask:0xf
    v_max3_f32 v254, v254, v182, v183
    v_max3_f32 v254, v254, v184, v185
    v_mfma_f32_16x16x16_f16 v[230:233], v[136:137], v[122:123], v[230:233]
    v_max_f32_dpp v219, v219, v219 row_mirror row_mask:0xf bank_mask:0xf
    v_mov_b32 v255, v219
    v_fma_f32 v118, v178, v178, s33
    v_fmac_f32 v118, v179, v179
    v_permlane32_swap_b32 v219, v255
    v_max_f32 v219, v219, v255
    v_mfma_f32_16x16x32_bf16 v[154:157], v[28:31], v[36:39], 0
    v_mov_b32 v255, v219
    v_max3_f32 v254, v254, v230, v231
    v_mfma_f32_16x16x32_bf16 v[154:157], v[28:31], v[186:189], v[154:157]
    v_permlane16_swap_b32 v219, v255
    v_max_f32 v219, v219, v255
    v_sub_f32 v236, v236, v219
    v_mfma_f32_16x16x32_bf16 v[126:129], v[162:165], v[36:39], 0
    v_exp_f32 v236, v236
    v_mfma_f32_16x16x32_bf16 v[126:129], v[142:145], v[186:189], v[126:129]
    v_cvt_pk_bf16_f32 v236, v236, v236
    v_max3_f32 v254, v254, v232, v233
    v_rcp_f32 v154, v154
    v_mov_b32 v119, v254
    v_fmac_f32 v118, v180, v180
    v_fmac_f32 v118, v181, v181
    v_permlane32_swap_b32 v254, v119
    v_max_f32 v254, v254, v119
    v_mul_f32 v126, v154, v126
    v_mul_f32 v127, v154, v127
    v_cvt_pk_bf16_f32 v126, v126, v127
    v_mul_f32 v128, v154, v128
    v_mul_f32 v129, v154, v129
    v_cvt_pk_bf16_f32 v127, v128, v129
    v_mov_b32 v119, v254
    v_fmac_f32 v118, v198, v198
    v_fmac_f32 v118, v199, v199
    v_permlane16_swap_b32 v254, v119
    v_max_f32 v254, v254, v119
    v_sub_f32 v226, v226, v254
    v_exp_f32 v226, v226
    v_sub_f32 v227, v227, v254
    v_exp_f32 v227, v227
    v_sub_f32 v228, v228, v254
    v_cvt_pk_bf16_f32 v226, v226, v227
    v_exp_f32 v228, v228
    v_sub_f32 v229, v229, v254
    v_exp_f32 v229, v229
    v_sub_f32 v182, v182, v254
    v_cvt_pk_bf16_f32 v227, v228, v229
    v_mfma_f32_16x16x32_bf16 v[242:245], v[166:169], v[36:39], 0
    ds_write_b16 v8, v236
    v_mfma_f32_16x16x32_bf16 v[242:245], v[146:149], v[186:189], v[242:245]
    v_exp_f32 v182, v182
    v_sub_f32 v183, v183, v254
    v_exp_f32 v183, v183
    v_sub_f32 v184, v184, v254
    v_cvt_pk_bf16_f32 v228, v182, v183
    v_exp_f32 v184, v184
    v_sub_f32 v185, v185, v254
    v_exp_f32 v185, v185
    v_mul_f32 v242, v154, v242
    v_mul_f32 v243, v154, v243
    v_cvt_pk_bf16_f32 v128, v242, v243
    v_mul_f32 v244, v154, v244
    v_mul_f32 v245, v154, v245
    v_cvt_pk_bf16_f32 v129, v244, v245
    v_mfma_f32_16x16x32_bf16 v[234:237], v[170:173], v[36:39], 0
    ds_write_b128 v3, v[126:129] offset:0
    v_mfma_f32_16x16x32_bf16 v[234:237], v[150:153], v[186:189], v[234:237]
    v_cvt_pk_bf16_f32 v229, v184, v185
    v_sub_f32 v230, v230, v254
    v_mfma_f32_16x16x32_f16 v[182:185], v[174:177], v[158:161], v[70:73]
    v_exp_f32 v230, v230
    v_mfma_f32_16x16x32_bf16 v[126:129], a[240:243], v[194:197], 0
    ds_read_b128 v[174:177], v9
    v_sub_f32 v231, v231, v254
    v_mfma_f32_16x16x32_bf16 v[126:129], a[244:247], v[190:193], v[126:129]
    v_mul_f32 v234, v154, v234
    v_mul_f32 v235, v154, v235
    v_cvt_pk_bf16_f32 v122, v234, v235
    v_mfma_f32_16x16x16_f16 v[182:185], v[120:121], v[134:135], v[182:185]
    v_mul_f32 v236, v154, v236
    v_mul_f32 v237, v154, v237
    v_cvt_pk_bf16_f32 v123, v236, v237
    v_sub_f32 v232, v232, v254
    v_mfma_f32_16x16x32_bf16 v[126:129], a[248:251], v[210:213], v[126:129]
    ds_read_b128 v[154:157], v9 offset:64
    v_sub_f32 v233, v233, v254
    v_mfma_f32_16x16x32_bf16 v[126:129], a[252:255], v[202:205], v[126:129]
    ds_write_b64 v4, v[122:123] offset:4096
    v_mfma_f32_16x16x32_bf16 v[126:129], v[82:85], v[214:217], v[126:129]
    v_max3_f32 v255, v238, v182, v183
    v_max3_f32 v255, v255, v184, v185
    v_mfma_f32_16x16x32_bf16 v[126:129], v[86:89], v[222:225], v[126:129]
    v_exp_f32 v231, v231
    v_exp_f32 v232, v232
    v_cvt_pk_bf16_f32 v36, v230, v231
    v_mfma_f32_16x16x32_f16 v[186:189], v[138:141], v[158:161], v[74:77]
    s_waitcnt lgkmcnt(2)
    v_exp_f32 v233, v233
    v_mfma_f32_16x16x32_f16 v[138:141], v[114:117], v[158:161], v[78:81]
    v_cvt_pk_bf16_f32 v37, v232, v233
    v_sub_f32 v218, v218, v254
    v_mfma_f32_16x16x32_bf16 v[234:237], v[174:177], v[28:31], 0
    v_exp_f32 v218, v218
    v_fmac_f32 v118, v200, v200
    v_mfma_f32_16x16x16_f16 v[186:189], v[124:125], v[134:135], v[186:189]
    v_cvt_pk_bf16_f32 v39, v218, 0
    v_fmac_f32 v118, v201, v201
    v_fmac_f32 v118, v206, v206
    v_mfma_f32_16x16x16_f16 v[138:141], v[136:137], v[134:135], v[138:141]
    v_fmac_f32 v118, v207, v207
    v_fmac_f32 v118, v208, v208
    v_fmac_f32 v118, v209, v209
    v_fma_f32 v254, v130, v130, s33
    v_mfma_f32_16x16x32_bf16 v[122:125], v[28:31], v[36:39], 0
    s_waitcnt lgkmcnt(0)
    v_max3_f32 v255, v255, v186, v187
    v_max3_f32 v255, v255, v188, v189
    v_mfma_f32_16x16x32_bf16 v[122:125], v[28:31], v[226:229], v[122:125]
    v_max3_f32 v255, v255, v138, v139
    v_max3_f32 v255, v255, v140, v141
    v_mfma_f32_16x16x32_bf16 v[114:117], v[162:165], v[36:39], 0
    v_mov_b32 v119, v255
    v_fmac_f32 v254, v131, v131
    v_mfma_f32_16x16x32_bf16 v[114:117], v[142:145], v[226:229], v[114:117]
    v_permlane32_swap_b32 v255, v119
    v_mfma_f32_16x16x32_bf16 v[134:137], v[166:169], v[36:39], 0
    v_rcp_f32 v122, v122
    v_mfma_f32_16x16x32_bf16 v[134:137], v[146:149], v[226:229], v[134:137]
    v_max_f32 v255, v255, v119
    v_mov_b32 v119, v255
    v_mfma_f32_16x16x32_bf16 v[158:161], v[170:173], v[36:39], 0
    v_fmac_f32 v254, v132, v132
    v_mul_f32 v114, v122, v114
    v_mfma_f32_16x16x32_bf16 v[158:161], v[150:153], v[226:229], v[158:161]
    v_mul_f32 v115, v122, v115
    v_cvt_pk_bf16_f32 v114, v114, v115
    v_mfma_f32_16x16x32_bf16 v[234:237], v[154:157], v[28:31], v[234:237]
    v_mul_f32 v116, v122, v116
    v_mul_f32 v117, v122, v117
    v_mfma_f32_16x16x32_bf16 v[218:221], v[174:177], v[142:145], 0
    v_cvt_pk_bf16_f32 v115, v116, v117
    v_mul_f32 v134, v122, v134
    v_mfma_f32_16x16x32_bf16 v[218:221], v[154:157], v[162:165], v[218:221]
    v_mul_f32 v135, v122, v135
    v_cvt_pk_bf16_f32 v116, v134, v135
    v_mfma_f32_16x16x32_bf16 v[226:229], v[174:177], v[146:149], 0
    v_mul_f32 v136, v122, v136
    v_mul_f32 v137, v122, v137
    v_mfma_f32_16x16x32_bf16 v[226:229], v[154:157], v[166:169], v[226:229]
    v_cvt_pk_bf16_f32 v117, v136, v137
    v_mul_f32 v158, v122, v158
    v_mfma_f32_16x16x32_bf16 v[134:137], v[174:177], v[150:153], 0
    ds_write_b128 v3, v[114:117] offset:6144
    v_mfma_f32_16x16x32_bf16 v[134:137], v[154:157], v[170:173], v[134:137]
    v_mul_f32 v159, v122, v159
    v_cvt_pk_bf16_f32 v120, v158, v159
    v_mfma_f32_16x16x32_bf16 v[114:117], v[90:93], v[194:197], 0
    v_mul_f32 v160, v122, v160
    v_mul_f32 v161, v122, v161
    v_mfma_f32_16x16x32_bf16 v[114:117], v[94:97], v[190:193], v[114:117]
    ds_read_b128 v[122:125], v2 offset:12288
    ds_read_b128 v[174:177], v2 offset:13312
    v_mfma_f32_16x16x32_bf16 v[114:117], v[98:101], v[210:213], v[114:117]
    ds_read_b128 v[190:193], v2 offset:14336
    v_cvt_pk_bf16_f32 v121, v160, v161
    v_mfma_f32_16x16x32_bf16 v[114:117], v[102:105], v[202:205], v[114:117]
    ds_read_b128 v[194:197], v2 offset:15360
    v_fmac_f32 v254, v133, v133
    v_mfma_f32_16x16x32_bf16 v[114:117], v[106:109], v[214:217], v[114:117]
    ds_read_b128 v[202:205], v2 offset:16384
    v_fmac_f32 v254, v126, v126
    v_mfma_f32_16x16x32_bf16 v[114:117], v[110:113], v[222:225], v[114:117]
    ds_read_b128 v[210:213], v2 offset:17408
    ds_write_b64 v4, v[120:121] offset:10240
    v_permlane16_swap_b32 v255, v119
    v_max_f32 v255, v255, v119
    v_sub_f32 v182, v182, v255
    v_exp_f32 v182, v182
    v_sub_f32 v183, v183, v255
    v_exp_f32 v183, v183
    s_waitcnt lgkmcnt(5)
    v_mfma_f32_16x16x32_bf16 v[242:245], a[216:219], v[122:125], 0
    v_cvt_pk_bf16_f32 v182, v182, v183
    v_sub_f32 v184, v184, v255
    v_mfma_f32_16x16x32_bf16 v[242:245], a[220:223], v[174:177], v[242:245]
    s_waitcnt lgkmcnt(4)
    v_exp_f32 v184, v184
    v_mfma_f32_16x16x32_bf16 v[242:245], a[224:227], v[190:193], v[242:245]
    s_waitcnt lgkmcnt(3)
    v_sub_f32 v185, v185, v255
    v_sub_f32 v186, v186, v255
    v_mfma_f32_16x16x32_bf16 v[242:245], a[228:231], v[194:197], v[242:245]
    s_waitcnt lgkmcnt(2)
    v_exp_f32 v185, v185
    v_mfma_f32_16x16x32_bf16 v[242:245], a[232:235], v[202:205], v[242:245]
    s_waitcnt lgkmcnt(0)
    v_cvt_pk_bf16_f32 v183, v184, v185
    v_sub_f32 v187, v187, v255
    v_mfma_f32_16x16x32_bf16 v[242:245], a[236:239], v[210:213], v[242:245]
    v_exp_f32 v186, v186
    v_mfma_f32_16x16x32_bf16 v[158:161], a[240:243], v[122:125], 0
    v_exp_f32 v187, v187
    v_mfma_f32_16x16x32_bf16 v[158:161], a[244:247], v[174:177], v[158:161]
    v_cvt_pk_bf16_f32 v184, v186, v187
    v_sub_f32 v188, v188, v255
    v_mfma_f32_16x16x32_bf16 v[158:161], a[248:251], v[190:193], v[158:161]
    v_exp_f32 v188, v188
    v_mfma_f32_16x16x32_bf16 v[158:161], a[252:255], v[194:197], v[158:161]
    v_sub_f32 v189, v189, v255
    v_sub_f32 v138, v138, v255
    v_mfma_f32_16x16x32_bf16 v[158:161], v[82:85], v[202:205], v[158:161]
    v_exp_f32 v189, v189
    v_mfma_f32_16x16x32_bf16 v[158:161], v[86:89], v[210:213], v[158:161]
    v_cvt_pk_bf16_f32 v185, v188, v189
    v_sub_f32 v139, v139, v255
    v_mfma_f32_16x16x32_bf16 v[154:157], v[90:93], v[122:125], 0
    v_exp_f32 v138, v138
    v_mfma_f32_16x16x32_bf16 v[154:157], v[94:97], v[174:177], v[154:157]
    v_exp_f32 v139, v139
    v_mfma_f32_16x16x32_bf16 v[154:157], v[98:101], v[190:193], v[154:157]
    v_cvt_pk_bf16_f32 v36, v138, v139
    v_sub_f32 v140, v140, v255
    v_mfma_f32_16x16x32_bf16 v[154:157], v[102:105], v[194:197], v[154:157]
    v_exp_f32 v140, v140
    v_mfma_f32_16x16x32_bf16 v[154:157], v[106:109], v[202:205], v[154:157]
    v_sub_f32 v141, v141, v255
    v_sub_f32 v238, v238, v255
    v_mfma_f32_16x16x32_bf16 v[154:157], v[110:113], v[210:213], v[154:157]
    ds_read_b128 v[186:189], v0 offset:20480
    ds_read_b128 v[194:197], v1 offset:20480
    ds_read_b128 v[122:125], v0 offset:20608
    v_exp_f32 v141, v141
    v_exp_f32 v238, v238
    v_cvt_pk_bf16_f32 v37, v140, v141
    v_cvt_pk_bf16_f32 v39, v238, 0
    v_fma_f32 v255, v242, v242, s33
    v_fmac_f32 v255, v243, v243
    v_mfma_f32_16x16x32_bf16 v[138:141], v[28:31], v[36:39], 0
    ds_read_b128 v[202:205], v1 offset:20608
    ds_read_b128 v[230:233], v0 offset:20736
    v_mfma_f32_16x16x32_bf16 v[138:141], v[28:31], v[182:185], v[138:141]
    ds_read_b128 v[238:241], v1 offset:20736
    v_fmac_f32 v255, v244, v244
    v_mfma_f32_16x16x32_bf16 v[174:177], v[162:165], v[36:39], 0
    v_fmac_f32 v255, v245, v245
    v_fmac_f32 v255, v158, v158
    v_mfma_f32_16x16x32_bf16 v[174:177], v[142:145], v[182:185], v[174:177]
    v_fmac_f32 v255, v159, v159
    v_fmac_f32 v255, v160, v160
    v_mfma_f32_16x16x32_bf16 v[142:145], v[166:169], v[36:39], 0
    s_waitcnt lgkmcnt(5)
    v_rcp_f32 v138, v138
    v_mfma_f32_16x16x32_bf16 v[142:145], v[146:149], v[182:185], v[142:145]
    s_waitcnt lgkmcnt(3)
    v_fmac_f32 v255, v161, v161
    v_mul_f32 v174, v138, v174
    v_mfma_f32_16x16x32_bf16 v[146:149], v[170:173], v[36:39], 0
    v_mul_f32 v175, v138, v175
    v_cvt_pk_bf16_f32 v162, v174, v175
    v_mfma_f32_16x16x32_bf16 v[146:149], v[150:153], v[182:185], v[146:149]
    v_mul_f32 v176, v138, v176
    v_mul_f32 v177, v138, v177
    v_mfma_f32_16x16x32_bf16 v[150:153], a[72:75], v[186:189], 0
    s_waitcnt lgkmcnt(1)
    v_cvt_pk_bf16_f32 v163, v176, v177
    v_mul_f32 v142, v138, v142
    v_mfma_f32_16x16x32_bf16 v[150:153], a[76:79], v[194:197], v[150:153]
    s_waitcnt lgkmcnt(0)
    v_mul_f32 v143, v138, v143
    v_cvt_pk_bf16_f32 v164, v142, v143
    v_mfma_f32_16x16x32_bf16 v[150:153], a[80:83], v[122:125], v[150:153]
    v_mul_f32 v144, v138, v144
    v_mul_f32 v145, v138, v145
    v_mfma_f32_16x16x32_bf16 v[150:153], a[84:87], v[202:205], v[150:153]
    v_cvt_pk_bf16_f32 v165, v144, v145
    v_mul_f32 v146, v138, v146
    v_mfma_f32_16x16x32_bf16 v[150:153], a[88:91], v[230:233], v[150:153]
    ds_write_b128 v3, v[162:165] offset:12288
    v_mfma_f32_16x16x32_bf16 v[150:153], a[92:95], v[238:241], v[150:153]
    v_mul_f32 v147, v138, v147
    v_cvt_pk_bf16_f32 v146, v146, v147
    v_mfma_f32_16x16x32_bf16 v[162:165], a[96:99], v[186:189], 0
    v_mul_f32 v148, v138, v148
    v_mul_f32 v149, v138, v149
    v_mfma_f32_16x16x32_bf16 v[162:165], a[100:103], v[194:197], v[162:165]
    v_cvt_pk_bf16_f32 v147, v148, v149
    v_fmac_f32 v255, v154, v154
    v_mfma_f32_16x16x32_bf16 v[162:165], a[104:107], v[122:125], v[162:165]
    ds_write_b64 v4, v[146:147] offset:16384
    v_mfma_f32_16x16x32_bf16 v[162:165], a[108:111], v[202:205], v[162:165]
    v_fmac_f32 v255, v155, v155
    v_fmac_f32 v255, v156, v156
    v_mfma_f32_16x16x32_bf16 v[162:165], a[112:115], v[230:233], v[162:165]
    v_fmac_f32 v255, v157, v157
    v_cvt_pk_bf16_f32 v255, v255, v255
    v_mfma_f32_16x16x32_bf16 v[162:165], a[116:119], v[238:241], v[162:165]
    v_rcp_f32 v234, v234
    v_mfma_f32_16x16x32_bf16 v[170:173], a[120:123], v[186:189], 0
    v_mul_f32 v218, v218, v234
    v_fmac_f32 v254, v127, v127
    v_mfma_f32_16x16x32_bf16 v[170:173], a[124:127], v[194:197], v[170:173]
    v_mul_f32_dpp v218, v226, v234 quad_perm:[0,1,2,3] row_mask:0x2 bank_mask:0xf
    v_fmac_f32 v254, v128, v128
    v_mfma_f32_16x16x32_bf16 v[170:173], a[128:131], v[122:125], v[170:173]
    v_mul_f32_dpp v218, v134, v234 quad_perm:[0,1,2,3] row_mask:0x4 bank_mask:0xf
    v_cvt_pk_bf16_f32 v218, v218, v218
    v_mfma_f32_16x16x32_bf16 v[170:173], a[132:135], v[202:205], v[170:173]
    ds_write_b16 v7, v218
    v_mfma_f32_16x16x32_bf16 v[170:173], a[136:139], v[230:233], v[170:173]
    v_fmac_f32 v254, v129, v129
    v_fmac_f32 v254, v114, v114
    v_mfma_f32_16x16x32_bf16 v[170:173], a[140:143], v[238:241], v[170:173]
    v_fmac_f32 v254, v115, v115
    v_fmac_f32 v254, v116, v116
    v_mfma_f32_16x16x32_bf16 v[138:141], a[0:3], v[186:189], 0
    v_fmac_f32 v254, v117, v117
    v_cvt_pk_bf16_f32 v254, v118, v254
    v_mfma_f32_16x16x32_bf16 v[138:141], a[4:7], v[194:197], v[138:141]
    ds_write_b64 v4, v[254:255] offset:18432
    v_mfma_f32_16x16x32_bf16 v[138:141], a[8:11], v[122:125], v[138:141]
    v_fma_f32 v174, v150, v150, s32
    v_fmac_f32 v174, v151, v151
    v_mfma_f32_16x16x32_bf16 v[138:141], a[12:15], v[202:205], v[138:141]
    v_fmac_f32 v174, v152, v152
    v_fmac_f32 v174, v153, v153
    v_mfma_f32_16x16x32_bf16 v[138:141], a[16:19], v[230:233], v[138:141]
    v_xor_b32 v2, 65536, v2
    v_xor_b32 v3, 65536, v3
    v_mfma_f32_16x16x32_bf16 v[138:141], a[20:23], v[238:241], v[138:141]
    v_xor_b32 v4, 65536, v4
    v_add_u32 v7, s76, v7
    v_mfma_f32_16x16x32_bf16 v[166:169], a[24:27], v[186:189], 0
    v_mfma_f32_16x16x32_bf16 v[166:169], a[28:31], v[194:197], v[166:169]
    v_mfma_f32_16x16x32_bf16 v[166:169], a[32:35], v[122:125], v[166:169]
    s_waitcnt lgkmcnt(0)
    v_mfma_f32_16x16x32_bf16 v[166:169], a[36:39], v[202:205], v[166:169]
    s_barrier
    v_mfma_f32_16x16x32_bf16 v[166:169], a[40:43], v[230:233], v[166:169]
    v_mfma_f32_16x16x32_bf16 v[166:169], a[44:47], v[238:241], v[166:169]
    v_mfma_f32_16x16x32_bf16 v[134:137], a[48:51], v[186:189], 0
    v_mfma_f32_16x16x32_bf16 v[134:137], a[52:55], v[194:197], v[134:137]
    s_cbranch_scc1 L_LOOP
    v_mfma_f32_16x16x32_bf16 v[134:137], a[56:59], v[122:125], v[134:137]
    s_mov_b32 s12, s40
    ds_read_b128 v[118:121], v2 offset:18432
    ds_read_b128 v[142:145], v2 offset:19456
    v_mfma_f32_16x16x32_bf16 v[134:137], a[60:63], v[202:205], v[134:137]
    s_mov_b32 s13, s41
    v_fmac_f32 v174, v162, v162
    v_fmac_f32 v174, v163, v163
    v_mfma_f32_16x16x32_bf16 v[134:137], a[64:67], v[230:233], v[134:137]
    s_mov_b32 s14, s36
    v_fmac_f32 v174, v164, v164
    v_fmac_f32 v174, v165, v165
    v_mfma_f32_16x16x32_bf16 v[134:137], a[68:71], v[238:241], v[134:137]
    s_add_u32 s48, s40, s27
    v_fmac_f32 v174, v170, v170
    v_fmac_f32 v174, v171, v171
    v_mfma_f32_16x16x32_bf16 v[146:149], v[186:189], a[144:147], 0
    s_addc_u32 s49, s41, 0
    v_fmac_f32 v174, v172, v172
    v_fmac_f32 v174, v173, v173
    v_mfma_f32_16x16x32_bf16 v[146:149], v[194:197], a[148:151], v[146:149]
    s_sub_u32 s50, s36, s27
    v_fma_f32 v254, v138, v138, s32
    v_fmac_f32 v254, v139, v139
    v_mfma_f32_16x16x32_bf16 v[146:149], v[122:125], a[152:155], v[146:149]
    s_mov_b32 s51, 0x00020000
    v_fmac_f32 v254, v140, v140
    v_fmac_f32 v254, v141, v141
    v_mfma_f32_16x16x32_bf16 v[146:149], v[202:205], a[156:159], v[146:149]
    s_waitcnt lgkmcnt(0)
    v_fmac_f32 v254, v166, v166
    v_fmac_f32 v254, v167, v167
    v_mfma_f32_16x16x32_bf16 v[182:185], v[32:35], v[118:121], 0
    s_add_u32 s52, s40, s26
    v_fmac_f32 v254, v168, v168
    v_fmac_f32 v254, v169, v169
    v_mfma_f32_16x16x32_bf16 v[182:185], v[32:35], v[142:145], v[182:185]
    s_addc_u32 s53, s41, 0
    v_fmac_f32 v254, v134, v134
    v_fmac_f32 v254, v135, v135
    v_mfma_f32_16x16x32_bf16 v[146:149], v[230:233], a[160:163], v[146:149]
    s_sub_u32 s54, s36, s26
    v_fmac_f32 v254, v136, v136
    v_fmac_f32 v254, v137, v137
    v_mfma_f32_16x16x32_bf16 v[146:149], v[238:241], a[164:167], v[146:149]
    s_mov_b32 s55, 0x00020000
    v_mul_f32 v255, 0x3baaaaab, v183
    v_mul_f32 v175, 0x3baaaaab, v182
    v_mfma_f32_16x16x32_bf16 v[118:121], v[186:189], a[168:171], 0
    s_add_u32 s56, s40, s25
    v_rsq_f32 v255, v255
    v_mfma_f32_16x16x32_bf16 v[118:121], v[194:197], a[172:175], v[118:121]
    s_addc_u32 s57, s41, 0
    v_mul_f32 v130, v255, v130
    v_mul_f32 v131, v255, v131
    v_mfma_f32_16x16x32_bf16 v[118:121], v[122:125], a[176:179], v[118:121]
    s_sub_u32 s58, s36, s25
    v_cvt_pk_bf16_f32 v130, v130, v131
    v_mul_f32 v132, v255, v132
    v_mfma_f32_16x16x32_bf16 v[118:121], v[202:205], a[180:183], v[118:121]
    s_mov_b32 s59, 0x00020000
    v_mul_f32 v133, v255, v133
    v_cvt_pk_bf16_f32 v131, v132, v133
    v_mfma_f32_16x16x32_bf16 v[118:121], v[230:233], a[184:187], v[118:121]
    s_and_b32 s6, s2, 7
    ds_read_b128 v[142:145], v0 offset:26624
    v_mul_f32 v126, v255, v126
    v_mfma_f32_16x16x32_bf16 v[118:121], v[238:241], a[188:191], v[118:121]
    s_sub_u32 s6, 0, s6
    ds_read_b128 v[190:193], v1 offset:26624
    v_mul_f32 v127, v255, v127
    v_mfma_f32_16x16x32_bf16 v[210:213], v[186:189], a[192:195], 0
    s_lshl_b32 s3, s16, 6
    ds_read_b128 v[186:189], v0 offset:26752
    v_cvt_pk_bf16_f32 v132, v126, v127
    v_mfma_f32_16x16x32_bf16 v[210:213], v[194:197], a[196:199], v[210:213]
    s_lshl_b32 s4, s16, 5
    ds_read_b128 v[194:197], v1 offset:26752
    v_mul_f32 v128, v255, v128
    v_mfma_f32_16x16x32_bf16 v[210:213], v[122:125], a[200:203], v[210:213]
    s_add_u32 s4, s4, 256
    ds_read_b128 v[122:125], v0 offset:26880
    v_mul_f32 v129, v255, v129
    v_mfma_f32_16x16x32_bf16 v[210:213], v[202:205], a[204:207], v[210:213]
    s_mul_i32 s5, s16, 9408
    ds_read_b128 v[202:205], v1 offset:26880
    v_cvt_pk_bf16_f32 v133, v128, v129
    v_mfma_f32_16x16x32_bf16 v[210:213], v[230:233], a[208:211], v[210:213]
    buffer_store_dwordx4 v[130:133], v16, s[48:51], 0 offen nt
    v_mul_f32 v114, v255, v114
    v_mul_f32 v115, v255, v115
    v_cvt_pk_bf16_f32 v176, v114, v115
    v_mul_f32 v116, v255, v116
    v_mfma_f32_16x16x32_bf16 v[210:213], v[238:241], a[212:215], v[210:213]
    s_waitcnt lgkmcnt(4)
    v_mul_f32 v117, v255, v117
    v_cvt_pk_bf16_f32 v177, v116, v117
    v_mfma_f32_16x16x32_bf16 v[114:117], a[72:75], v[142:145], 0
    s_add_u32 s5, s5, 104448
    ds_read_b128 v[126:129], v2 offset:0
    ds_read_b128 v[130:133], v2 offset:1024
    v_mfma_f32_16x16x32_bf16 v[114:117], a[76:79], v[190:193], v[114:117]
    s_waitcnt lgkmcnt(4)
    ds_read_b128 v[214:217], v2 offset:2048
    ds_read_b128 v[218:221], v2 offset:3072
    v_mfma_f32_16x16x32_bf16 v[114:117], a[80:83], v[186:189], v[114:117]
    s_waitcnt lgkmcnt(5)
    v_rsq_f32 v175, v175
    v_mfma_f32_16x16x32_bf16 v[114:117], a[84:87], v[194:197], v[114:117]
    s_waitcnt lgkmcnt(4)
    ds_read_b128 v[222:225], v2 offset:4096
    v_mul_f32 v178, v175, v178
    v_mfma_f32_16x16x32_bf16 v[114:117], a[88:91], v[122:125], v[114:117]
    v_mul_f32 v179, v175, v179
    v_cvt_pk_bf16_f32 v178, v178, v179
    v_mfma_f32_16x16x32_bf16 v[114:117], a[92:95], v[202:205], v[114:117]
    ds_read_b128 v[226:229], v2 offset:5120
    v_mul_f32 v180, v175, v180
    v_mul_f32 v181, v175, v181
    v_cvt_pk_bf16_f32 v179, v180, v181
    v_mul_f32 v198, v175, v198
    v_mul_f32 v199, v175, v199
    v_cvt_pk_bf16_f32 v180, v198, v199
    v_mul_f32 v200, v175, v200
    v_mul_f32 v201, v175, v201
    v_cvt_pk_bf16_f32 v181, v200, v201
    v_mul_f32 v206, v175, v206
    v_mul_f32 v207, v175, v207
    v_cvt_pk_bf16_f32 v182, v206, v207
    v_mfma_f32_16x16x32_bf16 v[198:201], a[96:99], v[142:145], 0
    s_waitcnt lgkmcnt(2)
    v_mul_f32 v208, v175, v208
    v_mul_f32 v209, v175, v209
    v_mfma_f32_16x16x32_bf16 v[198:201], a[100:103], v[190:193], v[198:201]
    s_waitcnt lgkmcnt(1)
    v_cvt_pk_bf16_f32 v183, v208, v209
    v_cvt_pk_bf16_f32 v36, v254, v174
    v_mfma_f32_16x16x32_bf16 v[206:209], a[216:219], v[126:129], 0
    v_cvt_pk_bf16_f32 v146, v146, v147
    v_cvt_pk_bf16_f32 v147, v148, v149
    v_mfma_f32_16x16x32_bf16 v[206:209], a[220:223], v[130:133], v[206:209]
    s_waitcnt lgkmcnt(0)
    v_cvt_pk_bf16_f32 v118, v118, v119
    v_cvt_pk_bf16_f32 v119, v120, v121
    v_mfma_f32_16x16x32_bf16 v[230:233], v[32:35], v[36:39], 0
    v_cvt_pk_bf16_f32 v174, v210, v211
    v_cvt_pk_bf16_f32 v175, v212, v213
    v_mfma_f32_16x16x32_bf16 v[206:209], a[224:227], v[214:217], v[206:209]
    buffer_store_dwordx2 v[176:177], v19, s[48:51], 0 offen nt
    v_fma_f32 v120, v114, v114, s32
    v_fmac_f32 v120, v115, v115
    v_mfma_f32_16x16x32_bf16 v[206:209], a[228:231], v[218:221], v[206:209]
    v_fmac_f32 v120, v116, v116
    v_fmac_f32 v120, v117, v117
    v_mfma_f32_16x16x32_bf16 v[206:209], a[232:235], v[222:225], v[206:209]
    v_rsq_f32 v231, v231
    v_mfma_f32_16x16x32_bf16 v[206:209], a[236:239], v[226:229], v[206:209]
    v_rsq_f32 v230, v230
    v_mfma_f32_16x16x32_bf16 v[210:213], a[240:243], v[126:129], 0
    v_mul_f32 v230, s31, v230
    v_mul_f32 v150, v231, v150
    v_mfma_f32_16x16x32_bf16 v[210:213], a[244:247], v[130:133], v[210:213]
    v_mul_f32 v151, v231, v151
    v_cvt_pk_f16_f32 v150, v150, v151
    v_mfma_f32_16x16x32_bf16 v[210:213], a[248:251], v[214:217], v[210:213]
    v_fma_f32 v121, v206, v206, s33
    v_fmac_f32 v121, v207, v207
    v_mfma_f32_16x16x32_bf16 v[210:213], a[252:255], v[218:221], v[210:213]
    v_fmac_f32 v121, v208, v208
    v_fmac_f32 v121, v209, v209
    v_mfma_f32_16x16x32_bf16 v[210:213], v[82:85], v[222:225], v[210:213]
    v_mul_f32 v152, v231, v152
    v_mul_f32 v153, v231, v153
    v_mfma_f32_16x16x32_bf16 v[210:213], v[86:89], v[226:229], v[210:213]
    v_cvt_pk_f16_f32 v151, v152, v153
    v_mul_f32 v162, v231, v162
    v_mfma_f32_16x16x32_bf16 v[198:201], a[104:107], v[186:189], v[198:201]
    v_mul_f32 v163, v231, v163
    v_cvt_pk_f16_f32 v152, v162, v163
    v_mfma_f32_16x16x32_bf16 v[198:201], a[108:111], v[194:197], v[198:201]
    v_mul_f32 v164, v231, v164
    v_mul_f32 v165, v231, v165
    v_mfma_f32_16x16x32_bf16 v[198:201], a[112:115], v[122:125], v[198:201]
    v_fmac_f32 v121, v210, v210
    v_fmac_f32 v121, v211, v211
    v_mfma_f32_16x16x32_bf16 v[198:201], a[116:119], v[202:205], v[198:201]
    v_fmac_f32 v121, v212, v212
    v_fmac_f32 v121, v213, v213
    v_cvt_pk_f16_f32 v153, v164, v165
    v_mfma_f32_16x16x32_bf16 v[162:165], v[90:93], v[126:129], 0
    ds_read_b128 v[126:129], v2 offset:6144
    v_mul_f32 v170, v231, v170
    v_mfma_f32_16x16x32_bf16 v[162:165], v[94:97], v[130:133], v[162:165]
    ds_read_b128 v[130:133], v2 offset:7168
    v_mul_f32 v171, v231, v171
    v_mfma_f32_16x16x32_bf16 v[162:165], v[98:101], v[214:217], v[162:165]
    ds_read_b128 v[214:217], v2 offset:8192
    buffer_store_dwordx4 v[178:181], v15, s[48:51], 0 offen nt
    v_cvt_pk_f16_f32 v236, v170, v171
    v_mul_f32 v172, v231, v172
    v_mul_f32 v173, v231, v173
    v_cvt_pk_f16_f32 v237, v172, v173
    v_mfma_f32_16x16x32_bf16 v[162:165], v[102:105], v[218:221], v[162:165]
    ds_read_b128 v[170:173], v2 offset:9216
    v_mul_f32 v138, v230, v138
    v_mfma_f32_16x16x32_bf16 v[162:165], v[106:109], v[222:225], v[162:165]
    ds_read_b128 v[178:181], v2 offset:10240
    v_mul_f32 v139, v230, v139
    v_mfma_f32_16x16x32_bf16 v[162:165], v[110:113], v[226:229], v[162:165]
    ds_read_b128 v[218:221], v2 offset:11264
    v_cvt_pk_f16_f32 v138, v138, v139
    v_mfma_f32_16x16x32_bf16 v[222:225], a[120:123], v[142:145], 0
    s_waitcnt lgkmcnt(5)
    v_mul_f32 v140, v230, v140
    v_mul_f32 v141, v230, v141
    v_mfma_f32_16x16x32_bf16 v[226:229], a[216:219], v[126:129], 0
    s_waitcnt lgkmcnt(4)
    v_fmac_f32 v121, v162, v162
    v_fmac_f32 v121, v163, v163
    v_mfma_f32_16x16x32_bf16 v[226:229], a[220:223], v[130:133], v[226:229]
    s_waitcnt lgkmcnt(3)
    v_fmac_f32 v121, v164, v164
    v_fmac_f32 v121, v165, v165
    v_mfma_f32_16x16x32_bf16 v[226:229], a[224:227], v[214:217], v[226:229]
    v_cvt_pk_f16_f32 v139, v140, v141
    v_mul_f32 v166, v230, v166
    v_mfma_f32_16x16x32_bf16 v[222:225], a[124:127], v[190:193], v[222:225]
    s_waitcnt lgkmcnt(2)
    v_mul_f32 v167, v230, v167
    v_cvt_pk_f16_f32 v140, v166, v167
    v_mfma_f32_16x16x32_bf16 v[226:229], a[228:231], v[170:173], v[226:229]
    s_waitcnt lgkmcnt(1)
    v_mul_f32 v168, v230, v168
    v_mul_f32 v169, v230, v169
    v_mfma_f32_16x16x32_bf16 v[226:229], a[232:235], v[178:181], v[226:229]
    s_waitcnt lgkmcnt(0)
    v_cvt_pk_f16_f32 v141, v168, v169
    v_mul_f32 v134, v230, v134
    v_mfma_f32_16x16x32_bf16 v[226:229], a[236:239], v[218:221], v[226:229]
    v_mul_f32 v135, v230, v135
    v_cvt_pk_f16_f32 v234, v134, v135
    v_mfma_f32_16x16x32_bf16 v[166:169], a[240:243], v[126:129], 0
    v_mul_f32 v136, v230, v136
    v_mul_f32 v137, v230, v137
    v_mfma_f32_16x16x32_bf16 v[166:169], a[244:247], v[130:133], v[166:169]
    v_cvt_pk_f16_f32 v235, v136, v137
    v_fmac_f32 v120, v198, v198
    v_mfma_f32_16x16x32_bf16 v[166:169], a[248:251], v[214:217], v[166:169]
    v_fmac_f32 v120, v199, v199
    v_fmac_f32 v120, v200, v200
    v_mfma_f32_16x16x32_bf16 v[166:169], a[252:255], v[170:173], v[166:169]
    v_fmac_f32 v120, v201, v201
    v_fma_f32 v148, v226, v226, s33
    v_mfma_f32_16x16x32_bf16 v[166:169], v[82:85], v[178:181], v[166:169]
    buffer_store_dwordx2 v[182:183], v18, s[48:51], 0 offen nt
    v_fmac_f32 v148, v227, v227
    v_fmac_f32 v148, v228, v228
    v_mfma_f32_16x16x32_bf16 v[166:169], v[86:89], v[218:221], v[166:169]
    v_fmac_f32 v148, v229, v229
    v_mul_f32 v149, 0x3baaaaab, v184
    v_mfma_f32_16x16x32_bf16 v[222:225], a[128:131], v[186:189], v[222:225]
    v_rsq_f32 v149, v149
    v_mfma_f32_16x16x32_bf16 v[222:225], a[132:135], v[194:197], v[222:225]
    v_mul_f32 v242, v149, v242
    v_mul_f32 v243, v149, v243
    v_mfma_f32_16x16x32_bf16 v[222:225], a[136:139], v[122:125], v[222:225]
    v_fmac_f32 v148, v166, v166
    v_fmac_f32 v148, v167, v167
    v_mfma_f32_16x16x32_bf16 v[222:225], a[140:143], v[202:205], v[222:225]
    v_fmac_f32 v148, v168, v168
    v_fmac_f32 v148, v169, v169
    v_cvt_pk_bf16_f32 v134, v242, v243
    v_mfma_f32_16x16x32_bf16 v[182:185], v[90:93], v[126:129], 0
    v_mul_f32 v244, v149, v244
    v_mul_f32 v245, v149, v245
    v_mfma_f32_16x16x32_bf16 v[182:185], v[94:97], v[130:133], v[182:185]
    v_cvt_pk_bf16_f32 v135, v244, v245
    v_fmac_f32 v120, v222, v222
    v_mfma_f32_16x16x32_bf16 v[182:185], v[98:101], v[214:217], v[182:185]
    v_fmac_f32 v120, v223, v223
    v_fmac_f32 v120, v224, v224
    v_mfma_f32_16x16x32_bf16 v[182:185], v[102:105], v[170:173], v[182:185]
    v_fmac_f32 v120, v225, v225
    v_mul_f32 v158, v149, v158
    v_mfma_f32_16x16x32_bf16 v[182:185], v[106:109], v[178:181], v[182:185]
    v_mul_f32 v159, v149, v159
    v_cvt_pk_bf16_f32 v136, v158, v159
    v_mfma_f32_16x16x32_bf16 v[182:185], v[110:113], v[218:221], v[182:185]
    v_mul_f32 v160, v149, v160
    v_mul_f32 v161, v149, v161
    v_mfma_f32_16x16x32_bf16 v[126:129], a[0:3], v[142:145], 0
    v_cvt_pk_bf16_f32 v137, v160, v161
    v_mul_f32 v154, v149, v154
    v_mfma_f32_16x16x32_bf16 v[126:129], a[4:7], v[190:193], v[126:129]
    v_mul_f32 v155, v149, v155
    v_cvt_pk_bf16_f32 v176, v154, v155
    v_mfma_f32_16x16x32_bf16 v[126:129], a[8:11], v[186:189], v[126:129]
    v_fmac_f32 v148, v182, v182
    v_fmac_f32 v148, v183, v183
    v_mfma_f32_16x16x32_bf16 v[126:129], a[12:15], v[194:197], v[126:129]
    v_fmac_f32 v148, v184, v184
    v_fmac_f32 v148, v185, v185
    v_mfma_f32_16x16x32_bf16 v[126:129], a[16:19], v[122:125], v[126:129]
    buffer_store_dwordx4 v[134:137], v17, s[48:51], 0 offen nt
    v_cvt_pk_bf16_f32 v254, v121, v148
    v_cvt_pk_bf16_f32 v255, v148, v148
    v_mul_f32 v156, v149, v156
    v_mul_f32 v157, v149, v157
    v_mfma_f32_16x16x32_bf16 v[126:129], a[20:23], v[202:205], v[126:129]
    v_cvt_pk_bf16_f32 v177, v156, v157
    v_mov_b32 v130, 0x40000000
    v_mfma_f32_16x16x32_bf16 v[134:137], a[24:27], v[142:145], 0
    v_bfe_u32 v131, v2, 4, 6
    v_lshrrev_b32 v132, 4, v131
    v_mfma_f32_16x16x32_bf16 v[134:137], a[28:31], v[190:193], v[134:137]
    v_and_b32 v133, 15, v131
    v_add_u32 v121, 0, v133
    v_mfma_f32_16x16x32_bf16 v[134:137], a[32:35], v[186:189], v[134:137]
    v_fma_f32 v148, v126, v126, s32
    v_fmac_f32 v148, v127, v127
    v_mfma_f32_16x16x32_bf16 v[134:137], a[36:39], v[194:197], v[134:137]
    v_fmac_f32 v148, v128, v128
    v_fmac_f32 v148, v129, v129
    v_mfma_f32_16x16x32_bf16 v[134:137], a[40:43], v[122:125], v[134:137]
    v_mul_u32_u24 v149, s20, v121
    v_add_u32 v149, s38, v149
    v_mfma_f32_16x16x32_bf16 v[134:137], a[44:47], v[202:205], v[134:137]
    v_mul_u32_u24 v154, 911, v149
    v_lshrrev_b32 v154, 16, v154
    v_mfma_f32_16x16x32_bf16 v[158:161], a[48:51], v[142:145], 0
    v_mul_u32_u24 v154, s22, v154
    v_mad_u32_u24 v154, v121, s21, v154
    v_mfma_f32_16x16x32_bf16 v[158:161], a[52:55], v[190:193], v[158:161]
    v_bfe_u32 v149, s70, v121, 1
    v_cmp_ne_u32 vcc, 0, v149
    v_mfma_f32_16x16x32_bf16 v[158:161], a[56:59], v[186:189], v[158:161]
    v_fmac_f32 v148, v134, v134
    v_fmac_f32 v148, v135, v135
    v_mfma_f32_16x16x32_bf16 v[158:161], a[60:63], v[194:197], v[158:161]
    v_fmac_f32 v148, v136, v136
    v_fmac_f32 v148, v137, v137
    v_mfma_f32_16x16x32_bf16 v[158:161], a[64:67], v[122:125], v[158:161]
    v_add_u32 v121, s7, v154
    v_cndmask_b32 v121, v130, v121, vcc
    v_mfma_f32_16x16x32_bf16 v[158:161], a[68:71], v[202:205], v[158:161]
    v_lshl_add_u32 v154, v132, 4, v121
    v_add_u32 v154, s3, v154
    v_mfma_f32_16x16x32_bf16 v[170:173], v[142:145], a[144:147], 0
    v_lshl_add_u32 v155, v132, 3, v121
    v_add_u32 v155, s4, v155
    v_mfma_f32_16x16x32_bf16 v[170:173], v[190:193], a[148:151], v[170:173]
    v_lshlrev_b32 v156, 9, v132
    v_lshl_add_u32 v156, v133, 4, v156
    v_mfma_f32_16x16x32_bf16 v[170:173], v[186:189], a[152:155], v[170:173]
    buffer_store_dwordx2 v[176:177], v20, s[48:51], 0 offen nt
    v_fmac_f32 v148, v158, v158
    v_fmac_f32 v148, v159, v159
    v_mfma_f32_16x16x32_bf16 v[170:173], v[194:197], a[156:159], v[170:173]
    v_fmac_f32 v148, v160, v160
    v_fmac_f32 v148, v161, v161
    v_mfma_f32_16x16x32_bf16 v[170:173], v[122:125], a[160:163], v[170:173]
    v_cvt_pk_bf16_f32 v36, v148, v120
    v_add_u32 v156, 149696, v156
    v_mfma_f32_16x16x32_bf16 v[170:173], v[202:205], a[164:167], v[170:173]
    v_and_b32 v157, 0xffff, v2
    v_add_u32 v157, 38912, v157
    v_mfma_f32_16x16x32_bf16 v[178:181], v[32:35], v[36:39], 0
    v_and_b32 v214, 0xffff, v4
    v_add_u32 v214, 38912, v214
    v_mfma_f32_16x16x32_bf16 v[218:221], v[142:145], a[168:171], 0
    ds_write_b64 v214, v[254:255] offset:0
    v_mfma_f32_16x16x32_bf16 v[218:221], v[190:193], a[172:175], v[218:221]
    v_cvt_pk_bf16_f32 v148, v170, v171
    v_cvt_pk_bf16_f32 v149, v172, v173
    v_mfma_f32_16x16x32_bf16 v[218:221], v[186:189], a[176:179], v[218:221]
    v_rsq_f32 v179, v179
    v_mfma_f32_16x16x32_bf16 v[218:221], v[194:197], a[180:183], v[218:221]
    v_rsq_f32 v178, v178
    v_mfma_f32_16x16x32_bf16 v[218:221], v[122:125], a[184:187], v[218:221]
    ds_read_b128 v[170:173], v0 offset:32768
    v_mul_f32 v178, s31, v178
    v_mfma_f32_16x16x32_bf16 v[218:221], v[202:205], a[188:191], v[218:221]
    ds_read_b128 v[230:233], v1 offset:32768
    v_mul_f32 v114, v179, v114
    v_mul_f32 v115, v179, v115
    v_cvt_pk_f16_f32 v114, v114, v115
    s_waitcnt lgkmcnt(2)
    s_barrier
    v_mul_f32 v116, v179, v116
    v_mul_f32 v117, v179, v117
    v_cvt_pk_bf16_f32 v120, v218, v219
    v_mfma_f32_16x16x32_bf16 v[238:241], v[142:145], a[192:195], 0
    ds_read_b128 v[142:145], v157 offset:0
    v_cvt_pk_bf16_f32 v121, v220, v221
    v_mfma_f32_16x16x32_bf16 v[238:241], v[190:193], a[196:199], v[238:241]
    ds_read_b128 v[190:193], v157 offset:1024
    v_cvt_pk_f16_f32 v115, v116, v117
    v_mfma_f32_16x16x32_bf16 v[238:241], v[186:189], a[200:203], v[238:241]
    ds_read_b128 v[186:189], v0 offset:32896
    v_mul_f32 v198, v179, v198
    v_mfma_f32_16x16x32_bf16 v[238:241], v[194:197], a[204:207], v[238:241]
    s_waitcnt lgkmcnt(4)
    ds_read_b128 v[194:197], v1 offset:32896
    v_mul_f32 v199, v179, v199
    v_mfma_f32_16x16x32_bf16 v[238:241], v[122:125], a[208:211], v[238:241]
    s_waitcnt lgkmcnt(4)
    ds_read_b128 v[122:125], v0 offset:33024
    v_cvt_pk_f16_f32 v116, v198, v199
    v_mfma_f32_16x16x32_bf16 v[238:241], v[202:205], a[212:215], v[238:241]
    ds_read_b128 v[202:205], v1 offset:33024
    v_mul_f32 v200, v179, v200
    v_mul_f32 v201, v179, v201
    v_cvt_pk_f16_f32 v117, v200, v201
    v_mfma_f32_16x16x32_bf16 v[198:201], a[72:75], v[170:173], 0
    s_waitcnt lgkmcnt(5)
    v_mul_f32 v222, v179, v222
    v_mul_f32 v223, v179, v223
    v_mfma_f32_16x16x32_bf16 v[198:201], a[76:79], v[230:233], v[198:201]
    v_cvt_pk_bf16_f32 v176, v238, v239
    v_cvt_pk_bf16_f32 v177, v240, v241
    v_cvt_pk_f16_f32 v220, v222, v223
    s_waitcnt lgkmcnt(3)
    v_mfma_f32_16x16x32_bf16 v[198:201], a[80:83], v[186:189], v[198:201]
    v_mul_f32 v224, v179, v224
    s_waitcnt lgkmcnt(2)
    v_mfma_f32_16x16x32_bf16 v[198:201], a[84:87], v[194:197], v[198:201]
    v_mul_f32 v225, v179, v225
    v_cvt_pk_f16_f32 v221, v224, v225
    v_mfma_f32_16x16x32_bf16 v[222:225], v[32:35], v[142:145], 0
    s_waitcnt lgkmcnt(1)
    v_mul_f32 v126, v178, v126
    v_mul_f32 v127, v178, v127
    v_mfma_f32_16x16x32_bf16 v[222:225], v[32:35], v[190:193], v[222:225]
    s_waitcnt lgkmcnt(0)
    v_cvt_pk_f16_f32 v126, v126, v127
    v_mul_f32 v128, v178, v128
    v_mfma_f32_16x16x32_bf16 v[198:201], a[88:91], v[122:125], v[198:201]
    v_mul_f32 v129, v178, v129
    v_cvt_pk_f16_f32 v127, v128, v129
    v_mfma_f32_16x16x32_bf16 v[198:201], a[92:95], v[202:205], v[198:201]
    v_mul_f32 v134, v178, v134
    v_mul_f32 v128, 0x3baaaaab, v223
    v_mfma_f32_16x16x32_bf16 v[142:145], a[96:99], v[170:173], 0
    v_rsq_f32 v128, v128
    v_mfma_f32_16x16x32_bf16 v[142:145], a[100:103], v[230:233], v[142:145]
    v_mul_f32 v226, v128, v226
    v_mul_f32 v227, v128, v227
    v_mfma_f32_16x16x32_bf16 v[142:145], a[104:107], v[186:189], v[142:145]
    v_cvt_pk_bf16_f32 v190, v226, v227
    v_mul_f32 v228, v128, v228
    v_mfma_f32_16x16x32_bf16 v[142:145], a[108:111], v[194:197], v[142:145]
    ds_read_b128 v[238:241], v5 offset:0
    ds_read_b128 v[242:245], v5 offset:16
    v_mfma_f32_16x16x32_bf16 v[142:145], a[112:115], v[122:125], v[142:145]
    ds_read_b32 v254, v6 offset:192
    v_mul_f32 v229, v128, v229
    v_mfma_f32_16x16x32_bf16 v[142:145], a[116:119], v[202:205], v[142:145]
    v_cvt_pk_bf16_f32 v191, v228, v229
    v_mul_f32 v166, v128, v166
    v_mul_f32 v167, v128, v167
    v_cvt_pk_bf16_f32 v192, v166, v167
    v_mul_f32 v168, v128, v168
    v_mul_f32 v169, v128, v169
    v_cvt_pk_bf16_f32 v193, v168, v169
    v_mfma_f32_16x16x32_bf16 v[166:169], a[120:123], v[170:173], 0
    buffer_store_dwordx4 v[190:193], v16, s[52:55], 0 offen nt
    ds_read_b128 v[226:229], v5 offset:48
    v_mul_f32 v182, v128, v182
    v_mul_f32 v183, v128, v183
    v_cvt_pk_bf16_f32 v180, v182, v183
    v_mfma_f32_16x16x32_bf16 v[166:169], a[124:127], v[230:233], v[166:169]
    v_mul_f32 v184, v128, v184
    v_mul_f32 v185, v128, v185
    v_mfma_f32_16x16x32_bf16 v[166:169], a[128:131], v[186:189], v[166:169]
    s_waitcnt lgkmcnt(2)
    v_cvt_pk_bf16_f32 v181, v184, v185
    v_mul_f32 v179, 0x3baaaaab, v222
    v_mfma_f32_16x16x32_bf16 v[166:169], a[132:135], v[194:197], v[166:169]
    s_waitcnt lgkmcnt(1)
    v_rsq_f32 v179, v179
    v_mfma_f32_16x16x32_bf16 v[166:169], a[136:139], v[122:125], v[166:169]
    v_mul_f32 v206, v179, v206
    v_mul_f32 v207, v179, v207
    v_mfma_f32_16x16x32_bf16 v[166:169], a[140:143], v[202:205], v[166:169]
    v_cvt_pk_bf16_f32 v182, v206, v207
    v_mul_f32 v208, v179, v208
    v_mfma_f32_16x16x32_f16 v[190:193], v[238:241], v[138:141], v[22:25]
    s_waitcnt lgkmcnt(0)
    v_mul_f32 v209, v179, v209
    v_cvt_pk_bf16_f32 v183, v208, v209
    v_mfma_f32_16x16x32_f16 v[190:193], v[242:245], v[150:153], v[190:193]
    v_mul_f32 v210, v179, v210
    v_mul_f32 v211, v179, v211
    v_mfma_f32_16x16x32_f16 v[190:193], v[226:229], v[234:237], v[190:193]
    v_cvt_pk_bf16_f32 v184, v210, v211
    v_mul_f32 v212, v179, v212
    v_mfma_f32_16x16x32_bf16 v[206:209], a[0:3], v[170:173], 0
    v_mul_f32 v213, v179, v213
    v_cvt_pk_bf16_f32 v185, v212, v213
    v_mfma_f32_16x16x32_bf16 v[206:209], a[4:7], v[230:233], v[206:209]
    v_mul_f32 v162, v179, v162
    v_mul_f32 v163, v179, v163
    v_mfma_f32_16x16x32_bf16 v[206:209], a[8:11], v[186:189], v[206:209]
    v_cvt_pk_bf16_f32 v192, v162, v163
    v_mul_f32 v164, v179, v164
    v_mfma_f32_16x16x32_bf16 v[206:209], a[12:15], v[194:197], v[206:209]
    v_mul_f32 v165, v179, v165
    v_cvt_pk_bf16_f32 v193, v164, v165
    v_mfma_f32_16x16x32_bf16 v[206:209], a[16:19], v[122:125], v[206:209]
    v_mul_f32 v135, v178, v135
    v_cvt_pk_f16_f32 v128, v134, v135
    v_mfma_f32_16x16x32_bf16 v[206:209], a[20:23], v[202:205], v[206:209]
    v_mul_f32 v136, v178, v136
    v_mul_f32 v137, v178, v137
    v_mfma_f32_16x16x32_bf16 v[162:165], a[24:27], v[170:173], 0
    v_cvt_pk_f16_f32 v129, v136, v137
    v_mul_f32 v158, v178, v158
    v_mfma_f32_16x16x32_bf16 v[162:165], a[28:31], v[230:233], v[162:165]
    buffer_store_dwordx2 v[180:181], v19, s[52:55], 0 offen nt
    v_mul_f32 v159, v178, v159
    v_cvt_pk_f16_f32 v218, v158, v159
    v_mfma_f32_16x16x32_bf16 v[162:165], a[32:35], v[186:189], v[162:165]
    v_mul_f32 v160, v178, v160
    v_mul_f32 v161, v178, v161
    v_mfma_f32_16x16x32_bf16 v[162:165], a[36:39], v[194:197], v[162:165]
    v_cvt_pk_f16_f32 v219, v160, v161
    v_mov_b32_dpp v254, v191 quad_perm:[0,1,2,3] row_mask:0x1 bank_mask:0xf
    v_mfma_f32_16x16x32_bf16 v[162:165], a[40:43], v[122:125], v[162:165]
    ds_read2_b32 v[136:137], v6 offset0:0 offset1:0
    ds_read2_b32 v[160:161], v6 offset0:16 offset1:16
    v_mfma_f32_16x16x32_bf16 v[162:165], a[44:47], v[202:205], v[162:165]
    ds_read2_b32 v[180:181], v6 offset0:32 offset1:32
    v_fma_f32 v255, v206, v206, s32
    v_fmac_f32 v255, v207, v207
    v_fmac_f32 v255, v208, v208
    v_fmac_f32 v255, v209, v209
    v_fma_f32 v191, v198, v198, s32
    v_fmac_f32 v191, v199, v199
    v_fmac_f32 v191, v200, v200
    v_fmac_f32 v255, v162, v162
    v_fmac_f32 v255, v163, v163
    v_fmac_f32 v255, v164, v164
    v_fmac_f32 v255, v165, v165
    v_fmac_f32 v191, v201, v201
    v_fmac_f32 v191, v142, v142
    v_fmac_f32 v191, v143, v143
    v_fmac_f32 v191, v144, v144
    v_fmac_f32 v191, v145, v145
    v_fmac_f32 v191, v166, v166
    v_fmac_f32 v191, v167, v167
    v_fmac_f32 v191, v168, v168
    v_fmac_f32 v191, v169, v169
    v_sub_u32 v134, 0x40800000, v44
    v_or_b32 v134, v134, v44
    v_add_u32 v135, 16, v133
    v_min_u32 v158, 20, v135
    v_add_u32 v159, 12, v135
    v_lshrrev_b32 v159, 5, v159
    v_sub_u32 v178, v135, v158
    v_mad_i32_i24 v178, v159, s6, v178
    v_mul_u32_u24 v179, s20, v158
    v_add3_u32 v179, v179, v178, s38
    v_mul_u32_u24 v159, 911, v179
    v_lshrrev_b32 v159, 16, v159
    v_mul_u32_u24 v159, s22, v159
    v_mad_u32_u24 v159, v158, s21, v159
    v_bfe_u32 v179, s70, v135, 1
    v_cmp_ne_u32 vcc, 0, v179
    v_mul_i32_i24 v178, 2688, v178
    v_add3_u32 v135, v159, v178, s7
    v_cndmask_b32 v135, v130, v135, vcc
    v_lshl_add_u32 v215, v132, 4, v135
    v_add_u32 v215, s3, v215
    v_lshl_add_u32 v216, v132, 3, v135
    v_add_u32 v216, s4, v216
    v_xor_b32 v217, 65536, v2
    buffer_store_dwordx4 v[182:185], v15, s[52:55], 0 offen nt
    v_lshl_add_u32 v130, s16, 2, v217
    ds_write_b32 v130, v134 offset:18432
    v_bfe_u32 v134, v133, 1, 2
    v_xor_b32 v134, v134, v132
    v_lshl_add_u32 v134, v133, 2, v134
    v_lshl_add_u32 v130, v134, 4, s5
    v_lshl_add_u32 v132, v134, 3, s5
    v_lshl_add_u32 v133, v131, 4, s5
    v_lshl_add_u32 v131, v131, 3, s5
    v_lshlrev_b32 v134, 2, v134
    ds_permute_b32 v182, v134, v16
    ds_permute_b32 v183, v134, v19
    ds_permute_b32 v184, v134, v17
    ds_permute_b32 v185, v134, v20
    buffer_store_dwordx2 v[192:193], v18, s[52:55], 0 offen nt
    v_mfma_f32_16x16x32_bf16 v[210:213], a[48:51], v[170:173], 0
    s_waitcnt lgkmcnt(0)
    v_mfma_f32_16x16x32_bf16 v[210:213], a[52:55], v[230:233], v[210:213]
    v_mfma_f32_16x16x32_bf16 v[210:213], a[56:59], v[186:189], v[210:213]
    v_mfma_f32_16x16x32_bf16 v[210:213], a[60:63], v[194:197], v[210:213]
    v_mfma_f32_16x16x32_bf16 v[210:213], a[64:67], v[122:125], v[210:213]
    v_mfma_f32_16x16x32_bf16 v[210:213], a[68:71], v[202:205], v[210:213]
    s_nop 0
    s_nop 0
    s_nop 0
    s_nop 0
    s_nop 0
    s_nop 0
    s_nop 0
    s_nop 0
    v_fmac_f32 v255, v210, v210
    v_fmac_f32 v255, v211, v211
    v_fmac_f32 v255, v212, v212
    v_fmac_f32 v255, v213, v213
    v_cvt_pk_bf16_f32 v36, v255, v191
    s_nop 0
    s_nop 0
    v_mfma_f32_16x16x32_bf16 v[222:225], v[32:35], v[36:39], 0
    s_nop 0
    s_nop 0
    s_nop 0
    s_nop 0
    s_nop 0
    s_nop 0
    s_nop 0
    s_nop 0
    v_rsq_f32 v223, v223
    v_rsq_f32 v222, v222
    v_mul_f32 v198, v223, v198
    v_mul_f32 v222, s31, v222
    v_mul_f32 v199, v223, v199
    v_cvt_pk_f16_f32 v198, v198, v199
    v_mul_f32 v200, v223, v200
    v_mul_f32 v201, v223, v201
    v_cvt_pk_f16_f32 v199, v200, v201
    v_mul_f32 v142, v223, v142
    v_mul_f32 v143, v223, v143
    v_cvt_pk_f16_f32 v200, v142, v143
    v_mul_f32 v144, v223, v144
    v_mul_f32 v145, v223, v145
    v_cvt_pk_f16_f32 v201, v144, v145
    v_mul_f32 v166, v223, v166
    v_mul_f32 v167, v223, v167
    v_cvt_pk_f16_f32 v144, v166, v167
    v_mul_f32 v168, v223, v168
    v_mul_f32 v169, v223, v169
    v_cvt_pk_f16_f32 v145, v168, v169
    v_mul_f32 v206, v222, v206
    v_mul_f32 v207, v222, v207
    v_cvt_pk_f16_f32 v166, v206, v207
    v_mul_f32 v208, v222, v208
    v_mul_f32 v209, v222, v209
    v_cvt_pk_f16_f32 v167, v208, v209
    v_mfma_f32_16x16x32_bf16 v[206:209], v[170:173], a[144:147], 0
    v_mul_f32 v162, v222, v162
    v_mul_f32 v163, v222, v163
    v_mfma_f32_16x16x32_bf16 v[206:209], v[230:233], a[148:151], v[206:209]
    v_cvt_pk_f16_f32 v168, v162, v163
    v_mul_f32 v164, v222, v164
    v_mfma_f32_16x16x32_bf16 v[206:209], v[186:189], a[152:155], v[206:209]
    v_mul_f32 v165, v222, v165
    v_cvt_pk_f16_f32 v169, v164, v165
    v_mfma_f32_16x16x32_bf16 v[206:209], v[194:197], a[156:159], v[206:209]
    v_mul_f32 v210, v222, v210
    v_mul_f32 v211, v222, v211
    v_mfma_f32_16x16x32_bf16 v[206:209], v[122:125], a[160:163], v[206:209]
    v_cvt_pk_f16_f32 v142, v210, v211
    v_mul_f32 v212, v222, v212
    v_mfma_f32_16x16x32_bf16 v[206:209], v[202:205], a[164:167], v[206:209]
    v_mul_f32 v213, v222, v213
    v_cvt_pk_f16_f32 v143, v212, v213
    v_mfma_f32_16x16x32_f16 v[162:165], v[238:241], v[166:169], v[26:29]
    v_mfma_f32_16x16x32_f16 v[162:165], v[242:245], v[198:201], v[162:165]
    v_mfma_f32_16x16x32_f16 v[162:165], v[226:229], v[142:145], v[162:165]
    s_nop 0
    s_nop 0
    s_nop 0
    v_cvt_pk_bf16_f32 v134, v206, v207
    v_mfma_f32_16x16x32_f16 v[210:213], v[150:153], v[138:141], v[46:49]
    v_cvt_pk_bf16_f32 v135, v208, v209
    s_nop 0
    s_nop 0
    s_nop 0
    s_nop 0
    s_nop 0
    v_mfma_f32_16x16x16_f16 v[210:213], v[236:237], v[234:235], v[210:213]
    s_nop 0
    s_nop 0
    s_nop 0
    s_nop 0
    s_nop 0
    s_nop 0
    s_nop 0
    s_nop 0
    v_max3_f32 v255, v190, v210, v211
    v_max3_f32 v255, v255, v212, v213
    v_mfma_f32_16x16x32_bf16 v[206:209], v[170:173], a[168:171], 0
    v_mfma_f32_16x16x32_bf16 v[206:209], v[230:233], a[172:175], v[206:209]
    v_mfma_f32_16x16x32_bf16 v[206:209], v[186:189], a[176:179], v[206:209]
    v_mfma_f32_16x16x32_bf16 v[206:209], v[194:197], a[180:183], v[206:209]
    v_mfma_f32_16x16x32_bf16 v[206:209], v[122:125], a[184:187], v[206:209]
    v_mfma_f32_16x16x32_bf16 v[206:209], v[202:205], a[188:191], v[206:209]
    s_nop 0
    s_nop 0
    s_nop 0
    s_nop 0
    s_nop 0
    s_nop 0
    s_nop 0
    s_nop 0
    v_cvt_pk_bf16_f32 v158, v206, v207
    v_cvt_pk_bf16_f32 v159, v208, v209
    v_mfma_f32_16x16x32_bf16 v[206:209], v[170:173], a[192:195], 0
    v_mfma_f32_16x16x32_bf16 v[206:209], v[230:233], a[196:199], v[206:209]
    v_mfma_f32_16x16x32_bf16 v[206:209], v[186:189], a[200:203], v[206:209]
    ds_read_b128 v[170:173], v2 offset:12288
    v_mfma_f32_16x16x32_bf16 v[206:209], v[194:197], a[204:207], v[206:209]
    ds_read_b128 v[186:189], v2 offset:13312
    v_mfma_f32_16x16x32_bf16 v[206:209], v[122:125], a[208:211], v[206:209]
    ds_read_b128 v[122:125], v2 offset:14336
    v_mfma_f32_16x16x32_bf16 v[206:209], v[202:205], a[212:215], v[206:209]
    ds_read_b128 v[194:197], v2 offset:15360
    s_nop 0
    s_nop 0
    s_nop 0
    s_nop 0
    s_nop 0
    s_nop 0
    s_nop 0
    v_cvt_pk_bf16_f32 v178, v206, v207
    v_cvt_pk_bf16_f32 v179, v208, v209
    v_mfma_f32_16x16x32_f16 v[202:205], v[114:117], v[138:141], v[50:53]
    s_nop 0
    s_nop 0
    s_nop 0
    s_nop 0
    s_nop 0
    s_nop 0
    v_mfma_f32_16x16x16_f16 v[202:205], v[220:221], v[234:235], v[202:205]
    s_nop 0
    s_nop 0
    s_nop 0
    s_nop 0
    s_nop 0
    s_nop 0
    s_nop 0
    s_nop 0
    v_max3_f32 v255, v255, v202, v203
    v_max3_f32 v255, v255, v204, v205
    v_mfma_f32_16x16x32_f16 v[206:209], v[238:241], v[126:129], v[24:27]
    s_waitcnt lgkmcnt(0)
    v_mfma_f32_16x16x32_f16 v[206:209], v[242:245], v[114:117], v[206:209]
    ds_read_b128 v[222:225], v2 offset:16384
    v_mfma_f32_16x16x32_f16 v[206:209], v[226:229], v[218:221], v[206:209]
    ds_read_b128 v[226:229], v2 offset:17408
    s_nop 0
    s_nop 0
    s_nop 0
    s_nop 0
    s_nop 0
    s_nop 0
    s_nop 0
    v_mov_b32_dpp v254, v207 quad_perm:[0,1,2,3] row_mask:0x2 bank_mask:0xf
    s_nop 0
    s_nop 0
    v_mov_b32_dpp v254, v163 quad_perm:[0,1,2,3] row_mask:0x4 bank_mask:0xf
    v_mfma_f32_16x16x32_f16 v[230:233], v[198:201], v[138:141], v[54:57]
    v_mov_b32 v163, v254
    s_nop 0
    s_nop 0
    v_max_f32_dpp v163, v163, v163 quad_perm:[1,0,3,2] row_mask:0xf bank_mask:0xf
    s_nop 0
    s_nop 0
    v_mfma_f32_16x16x16_f16 v[230:233], v[144:145], v[234:235], v[230:233]
    v_max_f32_dpp v163, v163, v163 quad_perm:[2,3,0,1] row_mask:0xf bank_mask:0xf
    v_mfma_f32_16x16x32_bf16 v[138:141], a[216:219], v[170:173], 0
    s_waitcnt lgkmcnt(0)
    v_max_f32_dpp v163, v163, v163 row_half_mirror row_mask:0xf bank_mask:0xf
    v_mfma_f32_16x16x32_bf16 v[138:141], a[220:223], v[186:189], v[138:141]
    v_mfma_f32_16x16x32_bf16 v[138:141], a[224:227], v[122:125], v[138:141]
    v_max_f32_dpp v163, v163, v163 row_mirror row_mask:0xf bank_mask:0xf
    v_mov_b32 v164, v163
    v_mfma_f32_16x16x32_bf16 v[138:141], a[228:231], v[194:197], v[138:141]
    v_max3_f32 v255, v255, v230, v231
    v_max3_f32 v255, v255, v232, v233
    v_mfma_f32_16x16x32_bf16 v[138:141], a[232:235], v[222:225], v[138:141]
    v_permlane32_swap_b32 v163, v164
    v_mfma_f32_16x16x32_bf16 v[138:141], a[236:239], v[226:229], v[138:141]
    v_max_f32 v163, v163, v164
    v_mov_b32 v164, v163
    v_mov_b32 v234, v255
    s_nop 0
    v_permlane16_swap_b32 v163, v164
    v_max_f32 v163, v163, v164
    v_sub_f32 v254, v254, v163
    v_exp_f32 v254, v254
    v_permlane32_swap_b32 v255, v234
    v_cvt_pk_bf16_f32 v254, v254, v254
    ds_write_b16 v8, v254
    v_max_f32 v255, v255, v234
    v_mov_b32 v234, v255
    v_fma_f32 v254, v138, v138, s33
    v_fmac_f32 v254, v139, v139
    v_permlane16_swap_b32 v255, v234
    v_max_f32 v255, v255, v234
    v_sub_f32 v210, v210, v255
    v_exp_f32 v210, v210
    v_sub_f32 v211, v211, v255
    v_exp_f32 v211, v211
    v_sub_f32 v212, v212, v255
    v_cvt_pk_bf16_f32 v210, v210, v211
    v_exp_f32 v212, v212
    v_sub_f32 v213, v213, v255
    v_exp_f32 v213, v213
    v_sub_f32 v202, v202, v255
    v_cvt_pk_bf16_f32 v211, v212, v213
    v_mfma_f32_16x16x32_bf16 v[238:241], a[240:243], v[170:173], 0
    v_exp_f32 v202, v202
    v_mfma_f32_16x16x32_bf16 v[238:241], a[244:247], v[186:189], v[238:241]
    v_sub_f32 v203, v203, v255
    v_sub_f32 v204, v204, v255
    v_mfma_f32_16x16x32_bf16 v[238:241], a[248:251], v[122:125], v[238:241]
    v_exp_f32 v203, v203
    v_mfma_f32_16x16x32_bf16 v[238:241], a[252:255], v[194:197], v[238:241]
    v_cvt_pk_bf16_f32 v212, v202, v203
    v_sub_f32 v205, v205, v255
    v_mfma_f32_16x16x32_bf16 v[238:241], v[82:85], v[222:225], v[238:241]
    v_exp_f32 v204, v204
    v_mfma_f32_16x16x32_bf16 v[238:241], v[86:89], v[226:229], v[238:241]
    v_exp_f32 v205, v205
    v_sub_f32 v230, v230, v255
    v_cvt_pk_bf16_f32 v213, v204, v205
    v_exp_f32 v230, v230
    v_sub_f32 v231, v231, v255
    v_exp_f32 v231, v231
    v_sub_f32 v232, v232, v255
    v_cvt_pk_bf16_f32 v36, v230, v231
    v_mfma_f32_16x16x32_f16 v[202:205], v[150:153], v[126:129], v[58:61]
    v_exp_f32 v232, v232
    v_sub_f32 v233, v233, v255
    v_exp_f32 v233, v233
    v_sub_f32 v190, v190, v255
    v_cvt_pk_bf16_f32 v37, v232, v233
    v_exp_f32 v190, v190
    v_mfma_f32_16x16x16_f16 v[202:205], v[236:237], v[218:219], v[202:205]
    v_cvt_pk_bf16_f32 v39, v190, 0
    v_fmac_f32 v254, v140, v140
    v_fmac_f32 v254, v141, v141
    v_fmac_f32 v254, v238, v238
    v_mfma_f32_16x16x32_bf16 v[190:193], v[28:31], v[36:39], 0
    v_fmac_f32 v254, v239, v239
    v_fmac_f32 v254, v240, v240
    v_mfma_f32_16x16x32_bf16 v[190:193], v[28:31], v[210:213], v[190:193]
    v_fmac_f32 v254, v241, v241
    v_max3_f32 v255, v206, v202, v203
    v_max3_f32 v255, v255, v204, v205
    s_nop 0
    s_nop 0
    s_nop 0
    s_nop 0
    s_nop 0
    v_rcp_f32 v190, v190
    v_mfma_f32_16x16x32_f16 v[230:233], v[114:117], v[126:129], v[62:65]
    s_nop 0
    s_nop 0
    s_nop 0
    s_nop 0
    s_nop 0
    s_nop 0
    v_mfma_f32_16x16x16_f16 v[230:233], v[220:221], v[218:219], v[230:233]
    s_nop 0
    s_nop 0
    s_nop 0
    s_nop 0
    s_nop 0
    s_nop 0
    s_nop 0
    s_nop 0
    v_max3_f32 v255, v255, v230, v231
    v_max3_f32 v255, v255, v232, v233
    v_mfma_f32_16x16x32_f16 v[242:245], v[198:201], v[126:129], v[66:69]
    s_nop 0
    s_nop 0
    s_nop 0
    s_nop 0
    s_nop 0
    s_nop 0
    v_mfma_f32_16x16x16_f16 v[242:245], v[144:145], v[218:219], v[242:245]
    s_nop 0
    s_nop 0
    s_nop 0
    s_nop 0
    s_nop 0
    s_nop 0
    s_nop 0
    s_nop 0
    v_max3_f32 v255, v255, v242, v243
    v_max3_f32 v255, v255, v244, v245
    v_mov_b32 v218, v255
    s_nop 0
    s_nop 0
    v_permlane32_swap_b32 v255, v218
    v_max_f32 v255, v255, v218
    v_mov_b32 v218, v255
    s_nop 0
    s_nop 0
    v_permlane16_swap_b32 v255, v218
    v_max_f32 v255, v255, v218
    v_sub_f32 v202, v202, v255
    v_exp_f32 v202, v202
    v_sub_f32 v203, v203, v255
    v_exp_f32 v203, v203
    v_sub_f32 v204, v204, v255
    v_cvt_pk_bf16_f32 v126, v202, v203
    v_exp_f32 v204, v204
    v_sub_f32 v205, v205, v255
    v_exp_f32 v205, v205
    v_sub_f32 v230, v230, v255
    v_cvt_pk_bf16_f32 v127, v204, v205
    v_exp_f32 v230, v230
    v_sub_f32 v231, v231, v255
    v_exp_f32 v231, v231
    v_sub_f32 v232, v232, v255
    v_cvt_pk_bf16_f32 v128, v230, v231
    v_exp_f32 v232, v232
    v_sub_f32 v233, v233, v255
    v_exp_f32 v233, v233
    v_sub_f32 v242, v242, v255
    v_cvt_pk_bf16_f32 v129, v232, v233
    v_mfma_f32_16x16x32_bf16 v[202:205], v[134:137], v[36:39], 0
    v_exp_f32 v242, v242
    v_mfma_f32_16x16x32_bf16 v[202:205], v[146:149], v[210:213], v[202:205]
    v_sub_f32 v243, v243, v255
    v_exp_f32 v243, v243
    v_sub_f32 v244, v244, v255
    v_exp_f32 v244, v244
    v_sub_f32 v245, v245, v255
    v_exp_f32 v245, v245
    v_sub_f32 v206, v206, v255
    v_exp_f32 v206, v206
    v_mul_f32 v202, v190, v202
    v_mul_f32 v203, v190, v203
    v_cvt_pk_bf16_f32 v202, v202, v203
    v_mul_f32 v204, v190, v204
    v_mul_f32 v205, v190, v205
    v_cvt_pk_bf16_f32 v203, v204, v205
    v_mfma_f32_16x16x32_bf16 v[230:233], v[158:161], v[36:39], 0
    v_mfma_f32_16x16x32_bf16 v[230:233], v[118:121], v[210:213], v[230:233]
    s_nop 0
    s_nop 0
    s_nop 0
    s_nop 0
    s_nop 0
    s_nop 0
    s_nop 0
    s_nop 0
    v_mul_f32 v230, v190, v230
    v_mul_f32 v231, v190, v231
    v_cvt_pk_bf16_f32 v204, v230, v231
    v_mul_f32 v232, v190, v232
    v_mul_f32 v233, v190, v233
    v_cvt_pk_bf16_f32 v205, v232, v233
    ds_write_b128 v3, v[202:205] offset:0
    v_mfma_f32_16x16x32_bf16 v[202:205], v[178:181], v[36:39], 0
    v_cvt_pk_bf16_f32 v36, v242, v243
    v_cvt_pk_bf16_f32 v37, v244, v245
    v_mfma_f32_16x16x32_bf16 v[202:205], v[174:177], v[210:213], v[202:205]
    v_cvt_pk_bf16_f32 v39, v206, 0
    v_mfma_f32_16x16x32_bf16 v[206:209], v[90:93], v[170:173], 0
    ds_read_b128 v[170:173], v156 offset:0
    v_mfma_f32_16x16x32_bf16 v[210:213], v[28:31], v[36:39], 0
    v_mfma_f32_16x16x32_bf16 v[210:213], v[28:31], v[126:129], v[210:213]
    v_mfma_f32_16x16x32_bf16 v[230:233], v[134:137], v[36:39], 0
    v_mfma_f32_16x16x32_bf16 v[230:233], v[146:149], v[126:129], v[230:233]
    v_mfma_f32_16x16x32_bf16 v[206:209], v[94:97], v[186:189], v[206:209]
    ds_read_b128 v[186:189], v156 offset:2048
    v_mul_f32 v202, v190, v202
    v_mfma_f32_16x16x32_bf16 v[206:209], v[98:101], v[122:125], v[206:209]
    ds_read_b128 v[122:125], v156 offset:4096
    v_mul_f32 v203, v190, v203
    v_mfma_f32_16x16x32_bf16 v[206:209], v[102:105], v[194:197], v[206:209]
    s_waitcnt lgkmcnt(2)
    ds_read_b128 v[194:197], v156 offset:6144
    v_cvt_pk_bf16_f32 v218, v202, v203
    v_mfma_f32_16x16x32_bf16 v[206:209], v[106:109], v[222:225], v[206:209]
    ds_read_b128 v[222:225], v156 offset:8192
    v_mul_f32 v204, v190, v204
    v_mfma_f32_16x16x32_bf16 v[206:209], v[110:113], v[226:229], v[206:209]
    ds_read_b128 v[226:229], v156 offset:10240
    v_rcp_f32 v210, v210
    v_mul_f32 v205, v190, v205
    v_mul_f32 v230, v210, v230
    v_mul_f32 v231, v210, v231
    v_cvt_pk_bf16_f32 v190, v230, v231
    v_mfma_f32_16x16x32_bf16 v[242:245], v[158:161], v[36:39], 0
    v_mul_f32 v232, v210, v232
    v_fmac_f32 v254, v206, v206
    v_mfma_f32_16x16x32_bf16 v[242:245], v[118:121], v[126:129], v[242:245]
    v_fmac_f32 v254, v207, v207
    v_fmac_f32 v254, v208, v208
    v_fmac_f32 v254, v209, v209
    v_mul_f32 v233, v210, v233
    v_cvt_pk_bf16_f32 v191, v232, v233
    v_cvt_pk_bf16_f32 v219, v204, v205
    ds_write_b64 v4, v[218:219] offset:4096
    v_mfma_f32_16x16x32_bf16 v[202:205], v[178:181], v[36:39], 0
    s_waitcnt lgkmcnt(1)
    v_mul_f32 v242, v210, v242
    v_mul_f32 v243, v210, v243
    v_mfma_f32_16x16x32_bf16 v[202:205], v[174:177], v[126:129], v[202:205]
    v_cvt_pk_bf16_f32 v192, v242, v243
    v_mul_f32 v244, v210, v244
    v_mfma_f32_16x16x32_f16 v[126:129], v[150:153], v[166:169], v[70:73]
    v_mul_f32 v245, v210, v245
    v_cvt_pk_bf16_f32 v193, v244, v245
    v_mfma_f32_16x16x32_f16 v[150:153], v[114:117], v[166:169], v[74:77]
    ds_write_b128 v3, v[190:193] offset:6144
    v_mfma_f32_16x16x32_f16 v[114:117], v[198:201], v[166:169], v[78:81]
    v_mul_f32 v202, v210, v202
    v_mul_f32 v203, v210, v203
    v_cvt_pk_bf16_f32 v218, v202, v203
    v_mfma_f32_16x16x16_f16 v[126:129], v[236:237], v[142:143], v[126:129]
    v_mul_f32 v204, v210, v204
    v_mul_f32 v205, v210, v205
    v_cvt_pk_bf16_f32 v219, v204, v205
    v_mfma_f32_16x16x16_f16 v[150:153], v[220:221], v[142:143], v[150:153]
    v_mfma_f32_16x16x16_f16 v[114:117], v[144:145], v[142:143], v[114:117]
    ds_write_b64 v4, v[218:219] offset:10240
    v_mfma_f32_16x16x32_bf16 v[142:145], a[216:219], v[170:173], 0
    v_mfma_f32_16x16x32_bf16 v[142:145], a[220:223], v[186:189], v[142:145]
    v_max3_f32 v255, v162, v126, v127
    v_max3_f32 v255, v255, v128, v129
    v_mfma_f32_16x16x32_bf16 v[142:145], a[224:227], v[122:125], v[142:145]
    v_mfma_f32_16x16x32_bf16 v[142:145], a[228:231], v[194:197], v[142:145]
    v_max3_f32 v255, v255, v150, v151
    v_max3_f32 v255, v255, v152, v153
    v_mfma_f32_16x16x32_bf16 v[142:145], a[232:235], v[222:225], v[142:145]
    v_max3_f32 v255, v255, v114, v115
    v_max3_f32 v255, v255, v116, v117
    v_mfma_f32_16x16x32_bf16 v[142:145], a[236:239], v[226:229], v[142:145]
    v_mov_b32 v163, v255
    v_mfma_f32_16x16x32_bf16 v[166:169], a[240:243], v[170:173], 0
    v_mfma_f32_16x16x32_bf16 v[166:169], a[244:247], v[186:189], v[166:169]
    v_permlane32_swap_b32 v255, v163
    v_mfma_f32_16x16x32_bf16 v[166:169], a[248:251], v[122:125], v[166:169]
    v_max_f32 v255, v255, v163
    v_mov_b32 v163, v255
    v_mfma_f32_16x16x32_bf16 v[166:169], a[252:255], v[194:197], v[166:169]
    v_fma_f32 v164, v142, v142, s33
    v_fmac_f32 v164, v143, v143
    v_mfma_f32_16x16x32_bf16 v[166:169], v[82:85], v[222:225], v[166:169]
    v_permlane16_swap_b32 v255, v163
    v_mfma_f32_16x16x32_bf16 v[166:169], v[86:89], v[226:229], v[166:169]
    v_fmac_f32 v164, v144, v144
    v_fmac_f32 v164, v145, v145
    v_mfma_f32_16x16x32_bf16 v[190:193], v[90:93], v[170:173], 0
    v_max_f32 v255, v255, v163
    v_sub_f32 v126, v126, v255
    v_mfma_f32_16x16x32_bf16 v[190:193], v[94:97], v[186:189], v[190:193]
    v_exp_f32 v126, v126
    v_mfma_f32_16x16x32_bf16 v[190:193], v[98:101], v[122:125], v[190:193]
    v_fmac_f32 v164, v166, v166
    v_fmac_f32 v164, v167, v167
    v_mfma_f32_16x16x32_bf16 v[190:193], v[102:105], v[194:197], v[190:193]
    v_fmac_f32 v164, v168, v168
    v_fmac_f32 v164, v169, v169
    v_mfma_f32_16x16x32_bf16 v[190:193], v[106:109], v[222:225], v[190:193]
    v_sub_f32 v127, v127, v255
    v_sub_f32 v128, v128, v255
    v_mfma_f32_16x16x32_bf16 v[190:193], v[110:113], v[226:229], v[190:193]
    v_exp_f32 v127, v127
    v_exp_f32 v128, v128
    v_cvt_pk_bf16_f32 v122, v126, v127
    v_sub_f32 v129, v129, v255
    v_exp_f32 v129, v129
    v_sub_f32 v150, v150, v255
    v_cvt_pk_bf16_f32 v123, v128, v129
    v_exp_f32 v150, v150
    v_fmac_f32 v164, v190, v190
    v_fmac_f32 v164, v191, v191
    v_fmac_f32 v164, v192, v192
    v_fmac_f32 v164, v193, v193
    v_cvt_pk_bf16_f32 v124, v254, v164
    v_cvt_pk_bf16_f32 v125, v164, v164
    ds_write_b64 v214, v[124:125] offset:2048
    v_sub_f32 v151, v151, v255
    v_exp_f32 v151, v151
    v_sub_f32 v152, v152, v255
    v_cvt_pk_bf16_f32 v124, v150, v151
    v_exp_f32 v152, v152
    v_sub_f32 v153, v153, v255
    v_exp_f32 v153, v153
    v_sub_f32 v114, v114, v255
    v_cvt_pk_bf16_f32 v125, v152, v153
    v_exp_f32 v114, v114
    ds_read_b128 v[126:129], v9
    ds_read_b128 v[150:153], v9 offset:64
    v_sub_f32 v115, v115, v255
    v_exp_f32 v115, v115
    v_sub_f32 v116, v116, v255
    s_waitcnt lgkmcnt(2)
    s_barrier
    s_barrier
    ds_read_b128 v[170:173], v157 offset:2048
    ds_read_b128 v[186:189], v157 offset:3072
    ds_read_b128 v[194:197], v217 offset:0
    ds_read_b128 v[198:201], v217 offset:1024
    ds_read_b128 v[202:205], v217 offset:2048
    ds_read_b128 v[210:213], v217 offset:3072
    ds_read_b128 v[218:221], v217 offset:4096
    s_waitcnt lgkmcnt(7)
    v_mfma_f32_16x16x32_bf16 v[222:225], v[126:129], v[28:31], 0
    v_cvt_pk_bf16_f32 v36, v114, v115
    v_sub_f32 v117, v117, v255
    v_mfma_f32_16x16x32_bf16 v[222:225], v[150:153], v[28:31], v[222:225]
    ds_read_b128 v[226:229], v217 offset:5120
    v_sub_f32 v162, v162, v255
    v_mfma_f32_16x16x32_bf16 v[230:233], v[126:129], v[146:149], 0
    s_waitcnt lgkmcnt(5)
    v_exp_f32 v116, v116
    v_mfma_f32_16x16x32_bf16 v[230:233], v[150:153], v[134:137], v[230:233]
    s_waitcnt lgkmcnt(4)
    v_exp_f32 v117, v117
    v_mfma_f32_16x16x32_bf16 v[234:237], v[32:35], v[170:173], 0
    s_waitcnt lgkmcnt(3)
    v_exp_f32 v162, v162
    v_mfma_f32_16x16x32_bf16 v[234:237], v[32:35], v[186:189], v[234:237]
    s_waitcnt lgkmcnt(2)
    v_cvt_pk_bf16_f32 v37, v116, v117
    v_cvt_pk_bf16_f32 v39, v162, 0
    v_mfma_f32_16x16x32_bf16 v[114:117], a[216:219], v[194:197], 0
    s_waitcnt lgkmcnt(1)
    v_rcp_f32 v222, v222
    v_mfma_f32_16x16x32_bf16 v[114:117], a[220:223], v[198:201], v[114:117]
    v_mul_f32 v230, v230, v222
    v_mul_f32 v254, 0x3baaaaab, v235
    v_mfma_f32_16x16x32_bf16 v[114:117], a[224:227], v[202:205], v[114:117]
    s_waitcnt lgkmcnt(0)
    v_rsq_f32 v254, v254
    v_mfma_f32_16x16x32_bf16 v[114:117], a[228:231], v[210:213], v[114:117]
    v_mul_f32 v142, v254, v142
    v_mul_f32 v143, v254, v143
    v_mfma_f32_16x16x32_bf16 v[114:117], a[232:235], v[218:221], v[114:117]
    v_cvt_pk_bf16_f32 v142, v142, v143
    v_mul_f32 v144, v254, v144
    v_mfma_f32_16x16x32_bf16 v[114:117], a[236:239], v[226:229], v[114:117]
    v_mul_f32 v145, v254, v145
    v_cvt_pk_bf16_f32 v143, v144, v145
    v_mfma_f32_16x16x32_bf16 v[162:165], a[240:243], v[194:197], 0
    v_mul_f32 v166, v254, v166
    v_mul_f32 v167, v254, v167
    v_mfma_f32_16x16x32_bf16 v[162:165], a[244:247], v[198:201], v[162:165]
    v_cvt_pk_bf16_f32 v144, v166, v167
    v_mul_f32 v168, v254, v168
    v_mfma_f32_16x16x32_bf16 v[162:165], a[248:251], v[202:205], v[162:165]
    v_fma_f32 v255, v114, v114, s33
    v_fmac_f32 v255, v115, v115
    v_mfma_f32_16x16x32_bf16 v[162:165], a[252:255], v[210:213], v[162:165]
    v_fmac_f32 v255, v116, v116
    v_fmac_f32 v255, v117, v117
    v_mfma_f32_16x16x32_bf16 v[162:165], v[82:85], v[218:221], v[162:165]
    v_mul_f32 v169, v254, v169
    v_cvt_pk_bf16_f32 v145, v168, v169
    v_mfma_f32_16x16x32_bf16 v[162:165], v[86:89], v[226:229], v[162:165]
    buffer_store_dwordx4 v[142:145], v154, s[12:15], 0 offen nt
    v_mul_f32 v190, v254, v190
    v_mul_f32 v191, v254, v191
    v_cvt_pk_bf16_f32 v232, v190, v191
    v_mul_f32 v192, v254, v192
    v_mfma_f32_16x16x32_bf16 v[142:145], v[90:93], v[194:197], 0
    v_mul_f32 v193, v254, v193
    v_cvt_pk_bf16_f32 v233, v192, v193
    v_mfma_f32_16x16x32_bf16 v[142:145], v[94:97], v[198:201], v[142:145]
    v_fmac_f32 v255, v162, v162
    v_fmac_f32 v255, v163, v163
    v_mfma_f32_16x16x32_bf16 v[142:145], v[98:101], v[202:205], v[142:145]
    v_fmac_f32 v255, v164, v164
    v_fmac_f32 v255, v165, v165
    v_mfma_f32_16x16x32_bf16 v[142:145], v[102:105], v[210:213], v[142:145]
    v_mul_f32 v154, 0x3baaaaab, v234
    v_mfma_f32_16x16x32_bf16 v[142:145], v[106:109], v[218:221], v[142:145]
    v_rsq_f32 v154, v154
    v_mfma_f32_16x16x32_bf16 v[142:145], v[110:113], v[226:229], v[142:145]
    v_mul_f32 v138, v154, v138
    v_mul_f32 v139, v154, v139
    v_mfma_f32_16x16x32_bf16 v[166:169], v[126:129], v[118:121], 0
    v_cvt_pk_bf16_f32 v138, v138, v139
    v_mul_f32 v140, v154, v140
    v_mfma_f32_16x16x32_bf16 v[166:169], v[150:153], v[158:161], v[166:169]
    v_mul_f32 v141, v154, v141
    v_cvt_pk_bf16_f32 v139, v140, v141
    v_mfma_f32_16x16x32_bf16 v[170:173], v[126:129], v[174:177], 0
    v_fmac_f32 v255, v142, v142
    v_fmac_f32 v255, v143, v143
    v_mfma_f32_16x16x32_bf16 v[170:173], v[150:153], v[178:181], v[170:173]
    v_fmac_f32 v255, v144, v144
    v_fmac_f32 v255, v145, v145
    v_mfma_f32_16x16x32_bf16 v[126:129], v[28:31], v[36:39], 0
    v_cvt_pk_bf16_f32 v254, v255, v255
    v_cvt_pk_bf16_f32 v255, v255, v255
    v_mfma_f32_16x16x32_bf16 v[126:129], v[28:31], v[122:125], v[126:129]
    ds_write_b64 v214, v[254:255] offset:7616
    v_mfma_f32_16x16x32_bf16 v[150:153], v[134:137], v[36:39], 0
    v_mul_f32_dpp v230, v166, v222 quad_perm:[0,1,2,3] row_mask:0x2 bank_mask:0xf
    v_mul_f32 v238, v154, v238
    v_mfma_f32_16x16x32_bf16 v[150:153], v[146:149], v[122:125], v[150:153]
    v_mul_f32_dpp v230, v170, v222 quad_perm:[0,1,2,3] row_mask:0x4 bank_mask:0xf
    v_cvt_pk_bf16_f32 v230, v230, v230
    v_mfma_f32_16x16x32_bf16 v[134:137], v[158:161], v[36:39], 0
    ds_write_b16 v7, v230
    v_mfma_f32_16x16x32_bf16 v[134:137], v[118:121], v[122:125], v[134:137]
    buffer_store_dwordx2 v[232:233], v155, s[12:15], 0 offen nt
    v_mul_f32 v239, v154, v239
    v_cvt_pk_bf16_f32 v140, v238, v239
    v_mfma_f32_16x16x32_bf16 v[118:121], v[178:181], v[36:39], 0
    v_mul_f32 v240, v154, v240
    v_mul_f32 v241, v154, v241
    v_mfma_f32_16x16x32_bf16 v[118:121], v[174:177], v[122:125], v[118:121]
    v_cvt_pk_bf16_f32 v141, v240, v241
    v_mul_f32 v206, v154, v206
    v_mul_f32 v207, v154, v207
    v_cvt_pk_bf16_f32 v254, v206, v207
    v_mul_f32 v208, v154, v208
    v_mul_f32 v209, v154, v209
    v_cvt_pk_bf16_f32 v255, v208, v209
    v_rcp_f32 v126, v126
    s_nop 0
    v_mul_f32 v150, v126, v150
    v_mul_f32 v151, v126, v151
    s_waitcnt lgkmcnt(0)
    s_barrier
    ds_read_b128 v[122:125], v157 offset:7616
    ds_read_b128 v[146:149], v157 offset:8640
    ds_read_b128 v[158:161], v217 offset:6144
    ds_read_b128 v[166:169], v217 offset:7168
    ds_read_b128 v[170:173], v217 offset:8192
    ds_read_b128 v[174:177], v217 offset:9216
    ds_read_b128 v[178:181], v217 offset:10240
    ds_read_b128 v[186:189], v217 offset:11264
    v_cvt_pk_bf16_f32 v150, v150, v151
    v_mul_f32 v152, v126, v152
    v_mul_f32 v153, v126, v153
    s_waitcnt lgkmcnt(7)
    v_mfma_f32_16x16x32_bf16 v[190:193], v[32:35], v[122:125], 0
    s_waitcnt lgkmcnt(5)
    v_cvt_pk_bf16_f32 v151, v152, v153
    v_mul_f32 v134, v126, v134
    v_mfma_f32_16x16x32_bf16 v[190:193], v[32:35], v[146:149], v[190:193]
    s_waitcnt lgkmcnt(4)
    v_mul_f32 v135, v126, v135
    v_cvt_pk_bf16_f32 v152, v134, v135
    v_mfma_f32_16x16x32_bf16 v[122:125], a[216:219], v[158:161], 0
    s_waitcnt lgkmcnt(3)
    v_mul_f32 v136, v126, v136
    v_mul_f32 v137, v126, v137
    v_mfma_f32_16x16x32_bf16 v[122:125], a[220:223], v[166:169], v[122:125]
    s_waitcnt lgkmcnt(2)
    v_cvt_pk_bf16_f32 v153, v136, v137
    v_mul_f32 v118, v126, v118
    v_mfma_f32_16x16x32_bf16 v[122:125], a[224:227], v[170:173], v[122:125]
    s_waitcnt lgkmcnt(1)
    ds_write_b128 v3, v[150:153] offset:12288
    v_mfma_f32_16x16x32_bf16 v[122:125], a[228:231], v[174:177], v[122:125]
    s_waitcnt lgkmcnt(1)
    buffer_store_dwordx4 v[138:141], v17, s[52:55], 0 offen nt
    v_mul_f32 v119, v126, v119
    v_cvt_pk_bf16_f32 v154, v118, v119
    v_mul_f32 v120, v126, v120
    v_mul_f32 v121, v126, v121
    v_mfma_f32_16x16x32_bf16 v[122:125], a[232:235], v[178:181], v[122:125]
    v_cvt_pk_bf16_f32 v155, v120, v121
    v_mul_f32 v118, 0x3baaaaab, v190
    v_mfma_f32_16x16x32_bf16 v[122:125], a[236:239], v[186:189], v[122:125]
    ds_write_b64 v4, v[154:155] offset:16384
    v_mfma_f32_16x16x32_bf16 v[126:129], a[240:243], v[158:161], 0
    v_rsq_f32 v118, v118
    v_mfma_f32_16x16x32_bf16 v[126:129], a[244:247], v[166:169], v[126:129]
    v_mul_f32 v114, v118, v114
    v_mul_f32 v115, v118, v115
    v_mfma_f32_16x16x32_bf16 v[126:129], a[248:251], v[170:173], v[126:129]
    v_cvt_pk_bf16_f32 v114, v114, v115
    v_fma_f32 v154, v122, v122, s33
    v_mfma_f32_16x16x32_bf16 v[126:129], a[252:255], v[174:177], v[126:129]
    v_fmac_f32 v154, v123, v123
    v_fmac_f32 v154, v124, v124
    v_mfma_f32_16x16x32_bf16 v[126:129], v[82:85], v[178:181], v[126:129]
    v_fmac_f32 v154, v125, v125
    v_mul_f32 v116, v118, v116
    v_mfma_f32_16x16x32_bf16 v[126:129], v[86:89], v[186:189], v[126:129]
    v_mul_f32 v117, v118, v117
    v_cvt_pk_bf16_f32 v115, v116, v117
    v_mfma_f32_16x16x32_bf16 v[134:137], v[90:93], v[158:161], 0
    ds_read_b128 v[138:141], v156 offset:256
    v_mul_f32 v162, v118, v162
    v_mfma_f32_16x16x32_bf16 v[134:137], v[94:97], v[166:169], v[134:137]
    ds_read_b128 v[146:149], v156 offset:2304
    v_mul_f32 v163, v118, v163
    v_mfma_f32_16x16x32_bf16 v[134:137], v[98:101], v[170:173], v[134:137]
    ds_read_b128 v[150:153], v156 offset:4352
    v_fmac_f32 v154, v126, v126
    v_mfma_f32_16x16x32_bf16 v[134:137], v[102:105], v[174:177], v[134:137]
    ds_read_b128 v[158:161], v156 offset:6400
    v_fmac_f32 v154, v127, v127
    v_mfma_f32_16x16x32_bf16 v[134:137], v[106:109], v[178:181], v[134:137]
    ds_read_b128 v[166:169], v156 offset:8448
    v_fmac_f32 v154, v128, v128
    v_mfma_f32_16x16x32_bf16 v[134:137], v[110:113], v[186:189], v[134:137]
    ds_read_b128 v[170:173], v156 offset:10496
    v_fmac_f32 v154, v129, v129
    buffer_store_dwordx2 v[254:255], v20, s[52:55], 0 offen nt
    s_waitcnt lgkmcnt(5)
    v_cvt_pk_bf16_f32 v116, v162, v163
    v_mfma_f32_16x16x32_bf16 v[174:177], a[216:219], v[138:141], 0
    v_mul_f32 v164, v118, v164
    v_mul_f32 v165, v118, v165
    v_mfma_f32_16x16x32_bf16 v[178:181], a[240:243], v[138:141], 0
    s_waitcnt lgkmcnt(4)
    v_fmac_f32 v154, v134, v134
    v_fmac_f32 v154, v135, v135
    v_mfma_f32_16x16x32_bf16 v[174:177], a[220:223], v[146:149], v[174:177]
    s_waitcnt lgkmcnt(3)
    v_fmac_f32 v154, v136, v136
    v_fmac_f32 v154, v137, v137
    v_mfma_f32_16x16x32_bf16 v[174:177], a[224:227], v[150:153], v[174:177]
    s_waitcnt lgkmcnt(2)
    v_cvt_pk_bf16_f32 v162, v154, v154
    v_cvt_pk_bf16_f32 v163, v154, v154
    v_mfma_f32_16x16x32_bf16 v[174:177], a[228:231], v[158:161], v[174:177]
    s_waitcnt lgkmcnt(1)
    ds_write_b64 v214, v[162:163] offset:9664
    v_mfma_f32_16x16x32_bf16 v[174:177], a[232:235], v[166:169], v[174:177]
    s_waitcnt lgkmcnt(1)
    v_cvt_pk_bf16_f32 v117, v164, v165
    v_mul_f32 v142, v118, v142
    v_mfma_f32_16x16x32_bf16 v[174:177], a[236:239], v[170:173], v[174:177]
    v_mul_f32 v143, v118, v143
    v_cvt_pk_bf16_f32 v254, v142, v143
    v_mfma_f32_16x16x32_bf16 v[178:181], a[244:247], v[146:149], v[178:181]
    v_mul_f32 v144, v118, v144
    v_mul_f32 v145, v118, v145
    v_mfma_f32_16x16x32_bf16 v[178:181], a[248:251], v[150:153], v[178:181]
    v_cvt_pk_bf16_f32 v255, v144, v145
    v_mfma_f32_16x16x32_bf16 v[178:181], a[252:255], v[158:161], v[178:181]
    v_fma_f32 v154, v174, v174, s33
    v_fmac_f32 v154, v175, v175
    v_mfma_f32_16x16x32_bf16 v[178:181], v[82:85], v[166:169], v[178:181]
    v_fmac_f32 v154, v176, v176
    v_fmac_f32 v154, v177, v177
    v_mfma_f32_16x16x32_bf16 v[178:181], v[86:89], v[170:173], v[178:181]
    s_waitcnt lgkmcnt(0)
    v_mfma_f32_16x16x32_bf16 v[118:121], v[90:93], v[138:141], 0
    s_barrier
    ds_read_b128 v[138:141], v157 offset:9664
    ds_read_b128 v[142:145], v157 offset:10688
    v_mfma_f32_16x16x32_bf16 v[118:121], v[94:97], v[146:149], v[118:121]
    ds_read_b128 v[146:149], v217 offset:12288
    ds_read_b128 v[162:165], v217 offset:13312
    v_mfma_f32_16x16x32_bf16 v[118:121], v[98:101], v[150:153], v[118:121]
    v_fmac_f32 v154, v178, v178
    v_fmac_f32 v154, v179, v179
    v_mfma_f32_16x16x32_bf16 v[118:121], v[102:105], v[158:161], v[118:121]
    ds_read_b128 v[150:153], v217 offset:14336
    ds_read_b128 v[158:161], v217 offset:15360
    v_mfma_f32_16x16x32_bf16 v[118:121], v[106:109], v[166:169], v[118:121]
    buffer_store_dwordx4 v[114:117], v15, s[56:59], 0 offen nt
    ds_read_b128 v[166:169], v217 offset:16384
    v_fmac_f32 v154, v180, v180
    v_fmac_f32 v154, v181, v181
    v_mfma_f32_16x16x32_bf16 v[118:121], v[110:113], v[170:173], v[118:121]
    ds_read_b128 v[114:117], v217 offset:17408
    s_nop 0
    s_waitcnt lgkmcnt(7)
    v_mfma_f32_16x16x32_bf16 v[170:173], v[32:35], v[138:141], 0
    s_waitcnt lgkmcnt(6)
    v_mfma_f32_16x16x32_bf16 v[170:173], v[32:35], v[142:145], v[170:173]
    s_waitcnt lgkmcnt(4)
    v_mfma_f32_16x16x32_bf16 v[138:141], a[216:219], v[146:149], 0
    v_fmac_f32 v154, v118, v118
    v_fmac_f32 v154, v119, v119
    v_mfma_f32_16x16x32_bf16 v[138:141], a[220:223], v[162:165], v[138:141]
    s_waitcnt lgkmcnt(2)
    v_fmac_f32 v154, v120, v120
    v_fmac_f32 v154, v121, v121
    v_mfma_f32_16x16x32_bf16 v[138:141], a[224:227], v[150:153], v[138:141]
    s_waitcnt lgkmcnt(1)
    v_cvt_pk_bf16_f32 v172, v154, v154
    v_cvt_pk_bf16_f32 v173, v154, v154
    v_mfma_f32_16x16x32_bf16 v[138:141], a[228:231], v[158:161], v[138:141]
    ds_write_b64 v214, v[172:173] offset:17280
    v_mfma_f32_16x16x32_bf16 v[138:141], a[232:235], v[166:169], v[138:141]
    s_waitcnt lgkmcnt(1)
    v_mul_f32 v154, 0x3baaaaab, v170
    v_mfma_f32_16x16x32_bf16 v[138:141], a[236:239], v[114:117], v[138:141]
    v_rsq_f32 v154, v154
    v_mfma_f32_16x16x32_bf16 v[142:145], a[240:243], v[146:149], 0
    v_mul_f32 v122, v154, v122
    v_mul_f32 v123, v154, v123
    v_mfma_f32_16x16x32_bf16 v[142:145], a[244:247], v[162:165], v[142:145]
    v_cvt_pk_bf16_f32 v122, v122, v123
    v_mul_f32 v124, v154, v124
    v_mfma_f32_16x16x32_bf16 v[142:145], a[248:251], v[150:153], v[142:145]
    v_fma_f32 v155, v138, v138, s33
    v_fmac_f32 v155, v139, v139
    v_mfma_f32_16x16x32_bf16 v[142:145], a[252:255], v[158:161], v[142:145]
    v_fmac_f32 v155, v140, v140
    v_fmac_f32 v155, v141, v141
    v_mfma_f32_16x16x32_bf16 v[142:145], v[82:85], v[166:169], v[142:145]
    v_mul_f32 v125, v154, v125
    v_cvt_pk_bf16_f32 v123, v124, v125
    v_mfma_f32_16x16x32_bf16 v[142:145], v[86:89], v[114:117], v[142:145]
    buffer_store_dwordx2 v[254:255], v18, s[56:59], 0 offen nt
    v_mul_f32 v126, v154, v126
    v_mul_f32 v127, v154, v127
    v_mfma_f32_16x16x32_bf16 v[170:173], v[90:93], v[146:149], 0
    v_cvt_pk_bf16_f32 v124, v126, v127
    v_mul_f32 v128, v154, v128
    v_mfma_f32_16x16x32_bf16 v[170:173], v[94:97], v[162:165], v[170:173]
    v_mul_f32 v129, v154, v129
    v_fmac_f32 v155, v142, v142
    v_mfma_f32_16x16x32_bf16 v[170:173], v[98:101], v[150:153], v[170:173]
    v_fmac_f32 v155, v143, v143
    v_fmac_f32 v155, v144, v144
    v_mfma_f32_16x16x32_bf16 v[170:173], v[102:105], v[158:161], v[170:173]
    v_fmac_f32 v155, v145, v145
    v_cvt_pk_bf16_f32 v125, v128, v129
    v_mfma_f32_16x16x32_bf16 v[170:173], v[106:109], v[166:169], v[170:173]
    ds_write_b128 v130, v[122:125] offset:1536
    v_mfma_f32_16x16x32_bf16 v[170:173], v[110:113], v[114:117], v[170:173]
    v_mul_f32 v134, v154, v134
    v_mul_f32 v135, v154, v135
    v_cvt_pk_bf16_f32 v254, v134, v135
    v_mul_f32 v136, v154, v136
    v_mul_f32 v137, v154, v137
    ds_read_b128 v[114:117], v133 offset:1536
    v_cvt_pk_bf16_f32 v255, v136, v137
    ds_write_b64 v132, v[254:255] offset:2560
    v_fmac_f32 v155, v170, v170
    v_fmac_f32 v155, v171, v171
    v_fmac_f32 v155, v172, v172
    v_fmac_f32 v155, v173, v173
    v_cvt_pk_bf16_f32 v254, v155, v155
    v_cvt_pk_bf16_f32 v255, v155, v155
    ds_write_b64 v214, v[254:255] offset:15232
    ds_read_b64 v[254:255], v131 offset:2560
    s_waitcnt lgkmcnt(3)
    buffer_store_dwordx4 v[114:117], v182, s[56:59], 0 offen nt
    s_waitcnt lgkmcnt(1)
    s_barrier
    ds_read_b128 v[122:125], v157 offset:15232
    ds_read_b128 v[114:117], v157 offset:16256
    ds_read_b128 v[126:129], v157 offset:17280
    ds_read_b128 v[134:137], v157 offset:18304
    ds_read_b128 v[146:149], v217 offset:18432
    s_waitcnt lgkmcnt(5)
    buffer_store_dwordx2 v[254:255], v183, s[56:59], 0 offen nt
    s_waitcnt lgkmcnt(4)
    v_mfma_f32_16x16x32_bf16 v[150:153], v[32:35], v[122:125], 0
    s_waitcnt lgkmcnt(3)
    v_mfma_f32_16x16x32_bf16 v[150:153], v[32:35], v[114:117], v[150:153]
    s_waitcnt lgkmcnt(1)
    v_mfma_f32_16x16x32_bf16 v[114:117], v[32:35], v[126:129], 0
    s_waitcnt lgkmcnt(0)
    v_or3_b32 v146, v146, v147, v148
    v_or_b32 v146, v146, v149
    v_mfma_f32_16x16x32_bf16 v[114:117], v[32:35], v[134:137], v[114:117]
    v_cmp_gt_i32 s[46:47], 0, v146
    s_nop 0
    v_mul_f32 v182, 0x3baaaaab, v150
    v_rsq_f32 v182, v182
    s_nop 0
    v_mul_f32 v138, v182, v138
    v_mul_f32 v139, v182, v139
    v_cvt_pk_bf16_f32 v122, v138, v139
    v_mul_f32 v183, 0x3baaaaab, v114
    v_rsq_f32 v183, v183
    v_mul_f32 v140, v182, v140
    v_mul_f32 v174, v183, v174
    v_mul_f32 v175, v183, v175
    v_cvt_pk_bf16_f32 v114, v174, v175
    v_mul_f32 v176, v183, v176
    v_mul_f32 v177, v183, v177
    v_cvt_pk_bf16_f32 v115, v176, v177
    v_mul_f32 v178, v183, v178
    v_mul_f32 v179, v183, v179
    v_cvt_pk_bf16_f32 v116, v178, v179
    v_mul_f32 v180, v183, v180
    v_mul_f32 v181, v183, v181
    v_cvt_pk_bf16_f32 v117, v180, v181
    buffer_store_dwordx4 v[114:117], v215, s[12:15], 0 offen nt
    v_mul_f32 v118, v183, v118
    v_mul_f32 v119, v183, v119
    v_cvt_pk_bf16_f32 v254, v118, v119
    v_mul_f32 v120, v183, v120
    v_mul_f32 v121, v183, v121
    v_cvt_pk_bf16_f32 v255, v120, v121
    v_mul_f32 v141, v182, v141
    v_cvt_pk_bf16_f32 v123, v140, v141
    v_mul_f32 v142, v182, v142
    v_mul_f32 v143, v182, v143
    v_cvt_pk_bf16_f32 v124, v142, v143
    v_mul_f32 v144, v182, v144
    v_mul_f32 v145, v182, v145
    v_cvt_pk_bf16_f32 v125, v144, v145
    ds_write_b128 v130, v[122:125] offset:3072
    v_mul_f32 v170, v182, v170
    v_mul_f32 v171, v182, v171
    v_cvt_pk_bf16_f32 v170, v170, v171
    v_mul_f32 v172, v182, v172
    v_mul_f32 v173, v182, v173
    v_cvt_pk_bf16_f32 v171, v172, v173
    buffer_store_dwordx2 v[254:255], v216, s[12:15], 0 offen nt
    ds_read_b128 v[114:117], v133 offset:3072
    ds_write_b64 v132, v[170:171] offset:4096
    ds_read_b64 v[182:183], v131 offset:4096
    s_waitcnt lgkmcnt(2)
    buffer_store_dwordx4 v[114:117], v184, s[56:59], 0 offen nt
    s_waitcnt lgkmcnt(0)
    buffer_store_dwordx2 v[182:183], v185, s[56:59], 0 offen nt
    s_branch L_end
L_drain:
    ds_read_b128 v[118:121], v2 offset:18432
    ds_read_b128 v[122:125], v2 offset:19456
    s_nop 3
    ds_read_b128 v[134:137], v2 offset:0
    s_mul_i32 s5, s16, 9408
    s_mov_b32 s12, s40
    ds_read_b128 v[138:141], v2 offset:1024
    s_mov_b32 s13, s41
    s_cmp_ge_u32 s18, 2
    s_cselect_b32 s14, s36, 0
    ds_read_b128 v[142:145], v2 offset:2048
    s_add_u32 s5, s5, 104448
    s_and_b32 s6, s2, 7
    s_sub_u32 s6, 0, s6
    ds_read_b128 v[146:149], v2 offset:3072
    s_lshl_b32 s3, s16, 6
    s_lshl_b32 s4, s16, 5
    s_add_u32 s4, s4, 256
    ds_read_b128 v[150:153], v2 offset:4096
    ds_read_b128 v[162:165], v2 offset:5120
    v_bfe_u32 v254, v2, 4, 6
    v_lshrrev_b32 v255, 4, v254
    v_and_b32 v166, 15, v254
    v_lshlrev_b32 v167, 9, v255
    v_lshl_add_u32 v167, v166, 4, v167
    v_add_u32 v167, 149696, v167
    s_waitcnt lgkmcnt(7)
    v_mfma_f32_16x16x32_bf16 v[170:173], v[32:35], v[118:121], 0
    s_waitcnt lgkmcnt(5)
    v_xor_b32 v168, 65536, v2
    v_bfe_u32 v169, v166, 1, 2
    v_mfma_f32_16x16x32_bf16 v[170:173], v[32:35], v[122:125], v[170:173]
    s_waitcnt lgkmcnt(4)
    v_xor_b32 v169, v169, v255
    v_lshl_add_u32 v169, v166, 2, v169
    v_lshl_add_u32 v118, v169, 4, s5
    v_mfma_f32_16x16x32_bf16 v[122:125], a[216:219], v[134:137], 0
    s_waitcnt lgkmcnt(3)
    v_lshl_add_u32 v119, v169, 3, s5
    v_lshl_add_u32 v120, v254, 4, s5
    v_lshl_add_u32 v121, v254, 3, s5
    v_mfma_f32_16x16x32_bf16 v[122:125], a[220:223], v[138:141], v[122:125]
    s_waitcnt lgkmcnt(2)
    v_lshlrev_b32 v169, 2, v169
    v_mul_f32 v170, 0x3baaaaab, v170
    v_rsq_f32 v170, v170
    v_mfma_f32_16x16x32_bf16 v[122:125], a[224:227], v[142:145], v[122:125]
    s_waitcnt lgkmcnt(0)
    ds_permute_b32 v173, v169, v15
    ds_permute_b32 v174, v169, v18
    v_mul_f32 v178, v170, v178
    v_mfma_f32_16x16x32_bf16 v[122:125], a[228:231], v[146:149], v[122:125]
    ds_permute_b32 v175, v169, v16
    ds_permute_b32 v176, v169, v19
    v_mul_f32 v179, v170, v179
    v_mfma_f32_16x16x32_bf16 v[122:125], a[232:235], v[150:153], v[122:125]
    ds_permute_b32 v177, v169, v17
    ds_permute_b32 v182, v169, v20
    v_cvt_pk_bf16_f32 v178, v178, v179
    v_mfma_f32_16x16x32_bf16 v[122:125], a[236:239], v[162:165], v[122:125]
    v_mul_f32 v180, v170, v180
    v_mul_f32 v181, v170, v181
    v_cvt_pk_bf16_f32 v179, v180, v181
    v_mfma_f32_16x16x32_bf16 v[186:189], a[240:243], v[134:137], 0
    v_mul_f32 v198, v170, v198
    v_mul_f32 v199, v170, v199
    v_cvt_pk_bf16_f32 v180, v198, v199
    v_mfma_f32_16x16x32_bf16 v[186:189], a[244:247], v[138:141], v[186:189]
    v_mul_f32 v200, v170, v200
    v_mul_f32 v201, v170, v201
    v_cvt_pk_bf16_f32 v181, v200, v201
    v_mfma_f32_16x16x32_bf16 v[186:189], a[248:251], v[142:145], v[186:189]
    s_waitcnt lgkmcnt(4)
    ds_read_b128 v[190:193], v2 offset:6144
    v_mul_f32 v206, v170, v206
    v_mul_f32 v207, v170, v207
    v_mfma_f32_16x16x32_bf16 v[186:189], a[252:255], v[146:149], v[186:189]
    s_waitcnt lgkmcnt(3)
    ds_read_b128 v[194:197], v2 offset:7168
    v_cvt_pk_bf16_f32 v184, v206, v207
    v_mul_f32 v208, v170, v208
    v_mfma_f32_16x16x32_bf16 v[186:189], v[82:85], v[150:153], v[186:189]
    s_waitcnt lgkmcnt(2)
    ds_read_b128 v[198:201], v2 offset:8192
    v_mul_f32 v209, v170, v209
    v_cvt_pk_bf16_f32 v185, v208, v209
    v_mfma_f32_16x16x32_bf16 v[186:189], v[86:89], v[162:165], v[186:189]
    ds_read_b128 v[202:205], v2 offset:9216
    v_fma_f32 v169, v122, v122, s33
    v_fmac_f32 v169, v123, v123
    v_mfma_f32_16x16x32_bf16 v[206:209], v[90:93], v[134:137], 0
    ds_read_b128 v[134:137], v2 offset:10240
    v_fmac_f32 v169, v124, v124
    v_fmac_f32 v169, v125, v125
    v_mfma_f32_16x16x32_bf16 v[206:209], v[94:97], v[138:141], v[206:209]
    ds_read_b128 v[138:141], v2 offset:11264
    v_fmac_f32 v169, v186, v186
    v_fmac_f32 v169, v187, v187
    v_mfma_f32_16x16x32_bf16 v[206:209], v[98:101], v[142:145], v[206:209]
    s_waitcnt lgkmcnt(5)
    buffer_store_dwordx4 v[178:181], v15, s[12:15], s27 offen nt
    v_fmac_f32 v169, v188, v188
    v_fmac_f32 v169, v189, v189
    v_mul_f32 v183, 0x3baaaaab, v171
    v_mfma_f32_16x16x32_bf16 v[206:209], v[102:105], v[146:149], v[206:209]
    s_waitcnt lgkmcnt(4)
    v_rsq_f32 v183, v183
    v_sub_u32 v170, 0x40800000, v44
    v_mfma_f32_16x16x32_bf16 v[206:209], v[106:109], v[150:153], v[206:209]
    s_waitcnt lgkmcnt(3)
    v_mul_f32 v130, v183, v130
    v_mul_f32 v131, v183, v131
    v_cvt_pk_bf16_f32 v130, v130, v131
    v_mfma_f32_16x16x32_bf16 v[206:209], v[110:113], v[162:165], v[206:209]
    s_waitcnt lgkmcnt(2)
    v_mul_f32 v132, v183, v132
    v_mul_f32 v133, v183, v133
    v_cvt_pk_bf16_f32 v131, v132, v133
    v_mfma_f32_16x16x32_bf16 v[142:145], a[216:219], v[190:193], 0
    s_waitcnt lgkmcnt(1)
    v_mul_f32 v126, v183, v126
    v_mul_f32 v127, v183, v127
    v_fmac_f32 v169, v206, v206
    v_mfma_f32_16x16x32_bf16 v[142:145], a[220:223], v[194:197], v[142:145]
    s_waitcnt lgkmcnt(0)
    v_fmac_f32 v169, v207, v207
    v_fmac_f32 v169, v208, v208
    v_fmac_f32 v169, v209, v209
    v_mfma_f32_16x16x32_bf16 v[142:145], a[224:227], v[198:201], v[142:145]
    v_cvt_pk_bf16_f32 v132, v126, v127
    v_mul_f32 v128, v183, v128
    v_mul_f32 v129, v183, v129
    v_mfma_f32_16x16x32_bf16 v[142:145], a[228:231], v[202:205], v[142:145]
    v_cvt_pk_bf16_f32 v133, v128, v129
    v_mul_f32 v114, v183, v114
    v_mul_f32 v115, v183, v115
    v_mfma_f32_16x16x32_bf16 v[142:145], a[232:235], v[134:137], v[142:145]
    v_cvt_pk_bf16_f32 v114, v114, v115
    v_mul_f32 v116, v183, v116
    v_mul_f32 v117, v183, v117
    v_mfma_f32_16x16x32_bf16 v[142:145], a[236:239], v[138:141], v[142:145]
    v_cvt_pk_bf16_f32 v115, v116, v117
    v_or_b32 v170, v170, v44
    v_lshl_add_u32 v171, s16, 2, v168
    v_mfma_f32_16x16x32_bf16 v[126:129], a[240:243], v[190:193], 0
    ds_write_b32 v171, v170 offset:18432
    v_mul_f32 v183, 0x3baaaaab, v172
    v_mfma_f32_16x16x32_bf16 v[126:129], a[244:247], v[194:197], v[126:129]
    v_rsq_f32 v183, v183
    v_fma_f32 v116, v142, v142, s33
    v_mfma_f32_16x16x32_bf16 v[126:129], a[248:251], v[198:201], v[126:129]
    ds_read_b128 v[146:149], v2 offset:12288
    v_fmac_f32 v116, v143, v143
    v_fmac_f32 v116, v144, v144
    v_mfma_f32_16x16x32_bf16 v[126:129], a[252:255], v[202:205], v[126:129]
    ds_read_b128 v[150:153], v2 offset:13312
    v_fmac_f32 v116, v145, v145
    v_mul_f32 v242, v183, v242
    v_mfma_f32_16x16x32_bf16 v[126:129], v[82:85], v[134:137], v[126:129]
    ds_read_b128 v[162:165], v2 offset:14336
    v_mul_f32 v243, v183, v243
    v_cvt_pk_bf16_f32 v178, v242, v243
    v_mfma_f32_16x16x32_bf16 v[126:129], v[86:89], v[138:141], v[126:129]
    ds_read_b128 v[210:213], v2 offset:15360
    v_mul_f32 v244, v183, v244
    v_mul_f32 v245, v183, v245
    v_mfma_f32_16x16x32_bf16 v[214:217], v[90:93], v[190:193], 0
    ds_read_b128 v[190:193], v2 offset:16384
    v_cvt_pk_bf16_f32 v179, v244, v245
    v_mul_f32 v158, v183, v158
    v_mfma_f32_16x16x32_bf16 v[214:217], v[94:97], v[194:197], v[214:217]
    ds_read_b128 v[194:197], v2 offset:17408
    v_fmac_f32 v116, v126, v126
    v_fmac_f32 v116, v127, v127
    v_mfma_f32_16x16x32_bf16 v[214:217], v[98:101], v[198:201], v[214:217]
    s_waitcnt lgkmcnt(5)
    buffer_store_dwordx2 v[184:185], v18, s[12:15], s27 offen nt
    v_fmac_f32 v116, v128, v128
    v_mfma_f32_16x16x32_bf16 v[214:217], v[102:105], v[202:205], v[214:217]
    s_waitcnt lgkmcnt(4)
    v_fmac_f32 v116, v129, v129
    v_mul_f32 v159, v183, v159
    v_cvt_pk_bf16_f32 v180, v158, v159
    v_mfma_f32_16x16x32_bf16 v[214:217], v[106:109], v[134:137], v[214:217]
    s_waitcnt lgkmcnt(3)
    v_mul_f32 v160, v183, v160
    v_mul_f32 v161, v183, v161
    v_cvt_pk_bf16_f32 v181, v160, v161
    v_mfma_f32_16x16x32_bf16 v[214:217], v[110:113], v[138:141], v[214:217]
    s_waitcnt lgkmcnt(2)
    ds_write_b128 v118, v[178:181] offset:3072
    v_mfma_f32_16x16x32_bf16 v[134:137], a[216:219], v[146:149], 0
    s_waitcnt lgkmcnt(2)
    v_mul_f32 v154, v183, v154
    v_mul_f32 v155, v183, v155
    v_cvt_pk_bf16_f32 v154, v154, v155
    v_mfma_f32_16x16x32_bf16 v[134:137], a[220:223], v[150:153], v[134:137]
    s_waitcnt lgkmcnt(1)
    v_fmac_f32 v116, v214, v214
    v_fmac_f32 v116, v215, v215
    v_fmac_f32 v116, v216, v216
    v_mfma_f32_16x16x32_bf16 v[134:137], a[224:227], v[162:165], v[134:137]
    ds_read_b128 v[138:141], v120 offset:3072
    v_fmac_f32 v116, v217, v217
    v_cvt_pk_bf16_f32 v184, v169, v116
    v_mfma_f32_16x16x32_bf16 v[134:137], a[228:231], v[210:213], v[134:137]
    v_cvt_pk_bf16_f32 v185, v116, v116
    v_mul_f32 v156, v183, v156
    v_mul_f32 v157, v183, v157
    v_mfma_f32_16x16x32_bf16 v[134:137], a[232:235], v[190:193], v[134:137]
    ds_write_b64 v4, v[184:185] offset:0
    v_mfma_f32_16x16x32_bf16 v[134:137], a[236:239], v[194:197], v[134:137]
    v_cvt_pk_bf16_f32 v155, v156, v157
    v_mov_b32 v169, 0x40000000
    v_lshrrev_b32 v116, 2, v254
    v_mfma_f32_16x16x32_bf16 v[158:161], a[240:243], v[146:149], 0
    ds_write_b64 v119, v[154:155] offset:4096
    v_mfma_f32_16x16x32_bf16 v[158:161], a[244:247], v[150:153], v[158:161]
    v_lshrrev_b32 v117, 3, v254
    v_xor_b32 v117, v117, v254
    v_fma_f32 v254, v134, v134, s33
    v_mfma_f32_16x16x32_bf16 v[158:161], a[248:251], v[162:165], v[158:161]
    s_waitcnt lgkmcnt(2)
    ds_read_b128 v[154:157], v167 offset:0
    ds_read_b64 v[170:171], v121 offset:4096
    v_fmac_f32 v254, v135, v135
    v_mfma_f32_16x16x32_bf16 v[158:161], a[252:255], v[210:213], v[158:161]
    ds_read_b128 v[178:181], v167 offset:2048
    v_fmac_f32 v254, v136, v136
    v_fmac_f32 v254, v137, v137
    v_mfma_f32_16x16x32_bf16 v[158:161], v[82:85], v[190:193], v[158:161]
    s_waitcnt lgkmcnt(4)
    ds_read_b128 v[198:201], v167 offset:4096
    v_and_b32 v117, 3, v117
    v_add_u32 v116, 0, v116
    v_mfma_f32_16x16x32_bf16 v[158:161], v[86:89], v[194:197], v[158:161]
    s_barrier
    ds_read_b128 v[202:205], v168 offset:0
    ds_read_b128 v[218:221], v168 offset:1024
    v_mul_u32_u24 v172, s20, v116
    v_mfma_f32_16x16x32_bf16 v[222:225], v[90:93], v[146:149], 0
    ds_read_b128 v[146:149], v167 offset:6144
    ds_read_b128 v[226:229], v167 offset:8192
    v_add_u32 v172, s38, v172
    v_mfma_f32_16x16x32_bf16 v[222:225], v[94:97], v[150:153], v[222:225]
    ds_read_b128 v[150:153], v167 offset:10240
    v_fmac_f32 v254, v158, v158
    v_fmac_f32 v254, v159, v159
    v_mfma_f32_16x16x32_bf16 v[222:225], v[98:101], v[162:165], v[222:225]
    s_waitcnt lgkmcnt(7)
    buffer_store_dwordx4 v[130:133], v16, s[12:15], s27 offen nt
    ds_read_b128 v[162:165], v168 offset:18432
    v_fmac_f32 v254, v160, v160
    v_fmac_f32 v254, v161, v161
    v_mfma_f32_16x16x32_bf16 v[222:225], v[102:105], v[210:213], v[222:225]
    s_waitcnt lgkmcnt(7)
    v_mul_u32_u24 v183, 911, v172
    v_lshrrev_b32 v183, 16, v183
    v_mul_u32_u24 v183, s22, v183
    v_mfma_f32_16x16x32_bf16 v[222:225], v[106:109], v[190:193], v[222:225]
    s_waitcnt lgkmcnt(6)
    v_mad_u32_u24 v183, v116, s21, v183
    v_bfe_u32 v172, s70, v116, 1
    v_cmp_ne_u32 vcc, 0, v172
    v_mfma_f32_16x16x32_bf16 v[222:225], v[110:113], v[194:197], v[222:225]
    s_waitcnt lgkmcnt(4)
    v_add_u32 v116, s7, v183
    v_cndmask_b32 v116, v169, v116, vcc
    v_mfma_f32_16x16x32_bf16 v[130:133], v[32:35], v[202:205], 0
    s_waitcnt lgkmcnt(2)
    v_lshl_add_u32 v172, v117, 4, v116
    v_add_u32 v172, s3, v172
    v_mfma_f32_16x16x32_bf16 v[130:133], v[32:35], v[218:221], v[130:133]
    s_waitcnt lgkmcnt(1)
    v_fmac_f32 v254, v222, v222
    v_fmac_f32 v254, v223, v223
    v_fmac_f32 v254, v224, v224
    v_mfma_f32_16x16x32_bf16 v[190:193], a[216:219], v[154:157], 0
    v_fmac_f32 v254, v225, v225
    v_cvt_pk_bf16_f32 v184, v254, v254
    v_cvt_pk_bf16_f32 v185, v254, v254
    v_mfma_f32_16x16x32_bf16 v[190:193], a[220:223], v[178:181], v[190:193]
    s_waitcnt lgkmcnt(0)
    ds_write_b64 v4, v[184:185] offset:2048
    v_mfma_f32_16x16x32_bf16 v[190:193], a[224:227], v[198:201], v[190:193]
    v_lshl_add_u32 v254, v117, 3, v116
    v_add_u32 v254, s4, v254
    v_add_u32 v166, 16, v166
    v_mfma_f32_16x16x32_bf16 v[190:193], a[228:231], v[146:149], v[190:193]
    v_min_u32 v116, 20, v166
    v_add_u32 v132, 12, v166
    v_lshrrev_b32 v132, 5, v132
    v_mfma_f32_16x16x32_bf16 v[190:193], a[232:235], v[226:229], v[190:193]
    v_sub_u32 v133, v166, v116
    v_mad_i32_i24 v133, v132, s6, v133
    v_mul_u32_u24 v117, s20, v116
    v_mfma_f32_16x16x32_bf16 v[190:193], a[236:239], v[150:153], v[190:193]
    v_add3_u32 v117, v117, v133, s38
    v_mul_u32_u24 v132, 911, v117
    v_lshrrev_b32 v132, 16, v132
    v_mfma_f32_16x16x32_bf16 v[194:197], a[240:243], v[154:157], 0
    v_mul_u32_u24 v132, s22, v132
    v_mad_u32_u24 v132, v116, s21, v132
    v_bfe_u32 v117, s70, v166, 1
    v_mfma_f32_16x16x32_bf16 v[194:197], a[244:247], v[178:181], v[194:197]
    buffer_store_dwordx2 v[114:115], v19, s[12:15], s27 offen nt
    v_fma_f32 v166, v190, v190, s33
    v_mfma_f32_16x16x32_bf16 v[194:197], a[248:251], v[198:201], v[194:197]
    ds_read_b128 v[202:205], v167 offset:256
    v_fmac_f32 v166, v191, v191
    v_fmac_f32 v166, v192, v192
    v_mfma_f32_16x16x32_bf16 v[194:197], a[252:255], v[146:149], v[194:197]
    ds_read_b128 v[210:213], v167 offset:2304
    v_fmac_f32 v166, v193, v193
    v_cmp_ne_u32 vcc, 0, v117
    v_mfma_f32_16x16x32_bf16 v[194:197], v[82:85], v[226:229], v[194:197]
    ds_read_b128 v[114:117], v167 offset:4352
    v_mul_i32_i24 v133, 2688, v133
    v_add3_u32 v132, v132, v133, s7
    v_mfma_f32_16x16x32_bf16 v[194:197], v[86:89], v[150:153], v[194:197]
    ds_read_b128 v[218:221], v167 offset:6400
    v_cndmask_b32 v132, v169, v132, vcc
    v_lshl_add_u32 v169, v255, 4, v132
    v_mfma_f32_16x16x32_bf16 v[230:233], v[90:93], v[154:157], 0
    ds_read_b128 v[154:157], v167 offset:8448
    v_add_u32 v169, s3, v169
    v_lshl_add_u32 v255, v255, 3, v132
    v_mfma_f32_16x16x32_bf16 v[230:233], v[94:97], v[178:181], v[230:233]
    ds_read_b128 v[178:181], v167 offset:10496
    v_fmac_f32 v166, v194, v194
    v_fmac_f32 v166, v195, v195
    v_mfma_f32_16x16x32_bf16 v[230:233], v[98:101], v[198:201], v[230:233]
    s_waitcnt lgkmcnt(5)
    v_fmac_f32 v166, v196, v196
    v_fmac_f32 v166, v197, v197
    v_add_u32 v255, s4, v255
    v_mfma_f32_16x16x32_bf16 v[230:233], v[102:105], v[146:149], v[230:233]
    s_waitcnt lgkmcnt(4)
    v_mul_f32 v167, 0x3baaaaab, v130
    v_mul_f32 v183, 0x3baaaaab, v131
    v_rsq_f32 v167, v167
    v_mfma_f32_16x16x32_bf16 v[230:233], v[106:109], v[226:229], v[230:233]
    s_waitcnt lgkmcnt(3)
    v_mul_f32 v122, v167, v122
    v_mul_f32 v123, v167, v123
    v_cvt_pk_bf16_f32 v122, v122, v123
    v_mfma_f32_16x16x32_bf16 v[230:233], v[110:113], v[150:153], v[230:233]
    s_waitcnt lgkmcnt(2)
    v_mul_f32 v124, v167, v124
    v_mul_f32 v125, v167, v125
    v_cvt_pk_bf16_f32 v123, v124, v125
    v_mfma_f32_16x16x32_bf16 v[130:133], a[216:219], v[202:205], 0
    s_waitcnt lgkmcnt(1)
    v_mul_f32 v186, v167, v186
    v_mul_f32 v187, v167, v187
    v_fmac_f32 v166, v230, v230
    v_mfma_f32_16x16x32_bf16 v[130:133], a[220:223], v[210:213], v[130:133]
    s_waitcnt lgkmcnt(0)
    v_fmac_f32 v166, v231, v231
    v_fmac_f32 v166, v232, v232
    v_fmac_f32 v166, v233, v233
    v_mfma_f32_16x16x32_bf16 v[130:133], a[224:227], v[114:117], v[130:133]
    buffer_store_dwordx4 v[138:141], v177, s[12:15], s27 offen nt
    v_cvt_pk_bf16_f32 v184, v166, v166
    v_cvt_pk_bf16_f32 v185, v166, v166
    v_cvt_pk_bf16_f32 v124, v186, v187
    v_mfma_f32_16x16x32_bf16 v[130:133], a[228:231], v[218:221], v[130:133]
    ds_write_b64 v4, v[184:185] offset:4096
    v_mfma_f32_16x16x32_bf16 v[130:133], a[232:235], v[154:157], v[130:133]
    v_mul_f32 v188, v167, v188
    v_mul_f32 v189, v167, v189
    v_cvt_pk_bf16_f32 v125, v188, v189
    v_mfma_f32_16x16x32_bf16 v[130:133], a[236:239], v[178:181], v[130:133]
    ds_write_b128 v118, v[122:125] offset:4608
    v_mfma_f32_16x16x32_bf16 v[122:125], a[240:243], v[202:205], 0
    buffer_store_dwordx2 v[170:171], v182, s[12:15], s27 offen nt
    v_mul_f32 v206, v167, v206
    v_mfma_f32_16x16x32_bf16 v[122:125], a[244:247], v[210:213], v[122:125]
    s_mov_b32 s14, s36
    v_mul_f32 v207, v167, v207
    v_cvt_pk_bf16_f32 v166, v206, v207
    v_fma_f32 v184, v130, v130, s33
    v_mfma_f32_16x16x32_bf16 v[122:125], a[248:251], v[114:117], v[122:125]
    ds_read_b128 v[138:141], v120 offset:4608
    v_fmac_f32 v184, v131, v131
    v_fmac_f32 v184, v132, v132
    v_mfma_f32_16x16x32_bf16 v[122:125], a[252:255], v[218:221], v[122:125]
    s_waitcnt lgkmcnt(2)
    v_fmac_f32 v184, v133, v133
    v_mul_f32 v208, v167, v208
    v_mul_f32 v209, v167, v209
    v_mfma_f32_16x16x32_bf16 v[122:125], v[82:85], v[154:157], v[122:125]
    s_barrier
    ds_read_b128 v[146:149], v168 offset:2048
    ds_read_b128 v[150:153], v168 offset:3072
    v_cvt_pk_bf16_f32 v167, v208, v209
    v_mfma_f32_16x16x32_bf16 v[122:125], v[86:89], v[178:181], v[122:125]
    ds_read_b128 v[186:189], v168 offset:4096
    ds_read_b128 v[198:201], v168 offset:5120
    v_rsq_f32 v183, v183
    v_mfma_f32_16x16x32_bf16 v[206:209], v[90:93], v[202:205], 0
    ds_write_b64 v119, v[166:167] offset:5632
    v_mfma_f32_16x16x32_bf16 v[206:209], v[94:97], v[210:213], v[206:209]
    v_mul_f32 v142, v183, v142
    v_mul_f32 v143, v183, v143
    v_fmac_f32 v184, v122, v122
    v_mfma_f32_16x16x32_bf16 v[206:209], v[98:101], v[114:117], v[206:209]
    s_waitcnt lgkmcnt(5)
    buffer_store_dwordx4 v[138:141], v173, s[12:15], s26 offen nt
    ds_read_b64 v[166:167], v121 offset:5632
    v_fmac_f32 v184, v123, v123
    v_fmac_f32 v184, v124, v124
    v_mfma_f32_16x16x32_bf16 v[206:209], v[102:105], v[218:221], v[206:209]
    v_fmac_f32 v184, v125, v125
    v_cvt_pk_bf16_f32 v114, v142, v143
    v_mul_f32 v144, v183, v144
    v_mfma_f32_16x16x32_bf16 v[206:209], v[106:109], v[154:157], v[206:209]
    s_waitcnt lgkmcnt(4)
    v_mul_f32 v145, v183, v145
    v_cvt_pk_bf16_f32 v115, v144, v145
    v_mfma_f32_16x16x32_bf16 v[138:141], v[32:35], v[146:149], 0
    s_waitcnt lgkmcnt(2)
    v_mul_f32 v126, v183, v126
    v_mul_f32 v127, v183, v127
    v_mfma_f32_16x16x32_bf16 v[138:141], v[32:35], v[150:153], v[138:141]
    v_cvt_pk_bf16_f32 v116, v126, v127
    v_mul_f32 v128, v183, v128
    v_mfma_f32_16x16x32_bf16 v[142:145], v[32:35], v[186:189], 0
    v_mul_f32 v129, v183, v129
    v_cvt_pk_bf16_f32 v117, v128, v129
    v_mfma_f32_16x16x32_bf16 v[142:145], v[32:35], v[198:201], v[142:145]
    ds_write_b128 v118, v[114:117] offset:6144
    v_mfma_f32_16x16x32_bf16 v[206:209], v[110:113], v[178:181], v[206:209]
    s_waitcnt lgkmcnt(1)
    buffer_store_dwordx2 v[166:167], v174, s[12:15], s26 offen nt
    v_mul_f32 v214, v183, v214
    v_mul_f32 v215, v183, v215
    v_cvt_pk_bf16_f32 v166, v214, v215
    ds_read_b128 v[114:117], v120 offset:6144
    v_mul_f32 v216, v183, v216
    v_mul_f32 v217, v183, v217
    v_fmac_f32 v184, v206, v206
    v_fmac_f32 v184, v207, v207
    v_fmac_f32 v184, v208, v208
    v_fmac_f32 v184, v209, v209
    v_cvt_pk_bf16_f32 v214, v184, v184
    v_cvt_pk_bf16_f32 v215, v184, v184
    ds_write_b64 v4, v[214:215] offset:6144
    v_cvt_pk_bf16_f32 v167, v216, v217
    v_mul_f32 v174, 0x3baaaaab, v138
    v_rsq_f32 v174, v174
    ds_write_b64 v119, v[166:167] offset:7168
    v_mul_f32 v134, v174, v134
    v_mul_f32 v135, v174, v135
    v_cvt_pk_bf16_f32 v126, v134, v135
    ds_read_b64 v[166:167], v121 offset:7168
    s_waitcnt lgkmcnt(3)
    buffer_store_dwordx4 v[114:117], v175, s[12:15], s26 offen nt
    v_mul_f32 v136, v174, v136
    v_mul_f32 v137, v174, v137
    v_cvt_pk_bf16_f32 v127, v136, v137
    v_mul_f32 v158, v174, v158
    v_mul_f32 v159, v174, v159
    v_cvt_pk_bf16_f32 v128, v158, v159
    v_mul_f32 v160, v174, v160
    s_waitcnt lgkmcnt(2)
    s_barrier
    ds_read_b128 v[114:117], v168 offset:6144
    ds_read_b128 v[134:137], v168 offset:7168
    v_mul_f32 v161, v174, v161
    v_cvt_pk_bf16_f32 v129, v160, v161
    ds_write_b128 v118, v[126:129] offset:0
    v_mul_f32 v222, v174, v222
    v_mul_f32 v223, v174, v223
    v_cvt_pk_bf16_f32 v222, v222, v223
    v_mul_f32 v224, v174, v224
    s_waitcnt lgkmcnt(3)
    buffer_store_dwordx2 v[166:167], v176, s[12:15], s26 offen nt
    ds_read_b128 v[126:129], v120 offset:0
    v_mul_f32 v225, v174, v225
    v_cvt_pk_bf16_f32 v223, v224, v225
    ds_write_b64 v119, v[222:223] offset:1024
    s_waitcnt lgkmcnt(4)
    v_mfma_f32_16x16x32_bf16 v[138:141], v[32:35], v[114:117], 0
    s_waitcnt lgkmcnt(3)
    v_mul_f32 v166, 0x3baaaaab, v142
    v_or3_b32 v162, v162, v163, v164
    v_mfma_f32_16x16x32_bf16 v[138:141], v[32:35], v[134:137], v[138:141]
    ds_read_b64 v[170:171], v121 offset:1024
    v_rsq_f32 v166, v166
    v_or_b32 v162, v162, v165
    v_mul_f32 v190, v166, v190
    v_mul_f32 v191, v166, v191
    v_cvt_pk_bf16_f32 v114, v190, v191
    v_mul_f32 v192, v166, v192
    v_mul_f32 v193, v166, v193
    v_cvt_pk_bf16_f32 v115, v192, v193
    v_mul_f32 v194, v166, v194
    v_mul_f32 v195, v166, v195
    v_cvt_pk_bf16_f32 v116, v194, v195
    s_waitcnt lgkmcnt(2)
    buffer_store_dwordx4 v[126:129], v177, s[12:15], s26 offen nt
    v_mul_f32 v196, v166, v196
    v_mul_f32 v197, v166, v197
    v_cvt_pk_bf16_f32 v117, v196, v197
    ds_write_b128 v118, v[114:117] offset:1536
    v_mul_f32 v230, v166, v230
    s_waitcnt lgkmcnt(1)
    v_mul_f32 v231, v166, v231
    v_cvt_pk_bf16_f32 v230, v230, v231
    v_mul_f32 v232, v166, v232
    v_mul_f32 v233, v166, v233
    buffer_store_dwordx2 v[170:171], v182, s[12:15], s26 offen nt
    ds_read_b128 v[114:117], v120 offset:1536
    v_cvt_pk_bf16_f32 v231, v232, v233
    ds_write_b64 v119, v[230:231] offset:2560
    v_mul_f32 v163, 0x3baaaaab, v138
    v_rsq_f32 v163, v163
    ds_read_b64 v[164:165], v121 offset:2560
    v_mul_f32 v130, v163, v130
    v_mul_f32 v131, v163, v131
    v_cvt_pk_bf16_f32 v118, v130, v131
    v_mul_f32 v132, v163, v132
    v_mul_f32 v133, v163, v133
    v_cvt_pk_bf16_f32 v119, v132, v133
    v_mul_f32 v122, v163, v122
    v_mul_f32 v123, v163, v123
    v_cvt_pk_bf16_f32 v120, v122, v123
    v_mul_f32 v124, v163, v124
    v_mul_f32 v125, v163, v125
    v_cvt_pk_bf16_f32 v121, v124, v125
    buffer_store_dwordx4 v[118:121], v169, s[12:15], 0 offen nt
    s_waitcnt lgkmcnt(2)
    v_mul_f32 v206, v163, v206
    v_mul_f32 v207, v163, v207
    v_cvt_pk_bf16_f32 v170, v206, v207
    v_mul_f32 v208, v163, v208
    v_mul_f32 v209, v163, v209
    v_cvt_pk_bf16_f32 v171, v208, v209
    v_cmp_gt_i32 s[46:47], 0, v162
    s_waitcnt lgkmcnt(0)
    buffer_store_dwordx4 v[114:117], v172, s[12:15], 0 offen nt
    buffer_store_dwordx2 v[164:165], v254, s[12:15], 0 offen nt
    buffer_store_dwordx2 v[170:171], v255, s[12:15], 0 offen nt
    s_branch L_end
.section .rodata,"a"
.p2align 6
.amdhsa_kernel standalone__window_attn_swin_v2__vision_kernel
  .amdhsa_next_free_vgpr 512
  .amdhsa_next_free_sgpr 102
  .amdhsa_accum_offset 256
  .amdhsa_group_segment_fixed_size 0
  .amdhsa_kernarg_size 96
  .amdhsa_user_sgpr_count 2
  .amdhsa_user_sgpr_kernarg_segment_ptr 1
  .amdhsa_system_sgpr_workgroup_id_x 1
  .amdhsa_float_denorm_mode_32 3
.end_amdhsa_kernel
```

```asm
; @launch grid=(256,1,1) block=(256,1,1) lds=163840
.amdgcn_target "amdgcn-amd-amdhsa--gfx950"
.text
.globl standalone__window_attn_swin_v2__vision_kernel
.p2align 12
.p2align 8
.type standalone__window_attn_swin_v2__vision_kernel,@function
standalone__window_attn_swin_v2__vision_kernel:
    s_mov_b32 s44, 0
L_again:
    s_load_dwordx16 s[76:91], s[0:1], 0
    v_readfirstlane_b32 s16, v0
    s_cmp_ge_u32 s2, 256
    s_cbranch_scc1 L_done
    s_lshr_b32 s16, s16, 6
    s_cbranch_scc1 L_nopf
    s_getpc_b64 s[96:97]
    s_bfe_u32 s3, s2, 0x30003
    s_mul_i32 s3, s3, 44
    v_cmp_gt_u32 vcc, 20, v0
    v_add_u32 v114, s3, v0
    v_mov_b32 v115, 0
    v_cndmask_b32 v114, v114, v0, vcc
    v_lshlrev_b32 v114, 7, v114
    v_lshl_add_u64 v[114:115], s[96:97], 0, v[114:115]
    global_load_dword a255, v[114:115], off offset:992
L_nopf:
    s_max_u32 s3, s2, s44
    s_cmp_ge_u32 s3, 247
    s_cbranch_scc1 L_edge
    v_mov_b32 v114, v0
    v_mov_b32 v115, 0x40000000
    v_and_b32 v254, 63, v0
    s_bfe_u32 s3, s2, 0x50003
    s_lshl_b32 s4, s16, 3
    s_lshr_b32 s98, 0x06143a01, s4
    s_and_b32 s98, s98, 0xff
    s_mul_i32 s3, s3, s98
    s_sub_u32 s98, s98, 1
    s_lshr_b32 s4, 0x0048d800, s4
    s_and_b32 s4, s4, 0xff
    s_lshl_b32 s4, s4, 3
    s_max_u32 s4, s4, 6
    s_sub_u32 s4, s4, s98
    s_sub_u32 s4, s4, 1
    s_min_u32 s3, s3, s4
    v_min_u32 v126, s98, v254
    v_add_lshl_u32 v126, v126, s3, 7
    v_mov_b32 v127, 0
    v_lshrrev_b32 v255, 4, v254
    v_and_b32 v128, 15, v254
    s_mov_b32 s10, 100270464
    s_mov_b32 s11, 0x00020000
    s_mov_b32 s50, 36096
    s_mov_b32 s51, 0x00020000
    s_mul_i32 s3, s16, 96
    v_lshl_add_u32 v129, v254, 4, s3
    v_mul_u32_u24 v130, 171, v254
    v_lshrrev_b32 v130, 10, v130
    v_lshrrev_b32 v131, 1, v130
    v_xor_b32 v131, v131, v130
    v_and_b32 v131, 4, v131
    v_mul_u32_u24 v131, 3, v131
    v_xor_b32 v131, v131, v130
    v_mul_u32_u24 v131, 1152, v131
    v_mul_u32_u24 v132, 96, v130
    v_sub_u32 v131, v131, v132
    v_add_u32 v132, v129, v131
    v_add_u32 v131, 64, v254
    v_mul_u32_u24 v131, 171, v131
    v_lshrrev_b32 v131, 10, v131
    v_lshrrev_b32 v133, 1, v131
    v_xor_b32 v133, v133, v131
    v_and_b32 v133, 4, v133
    v_mul_u32_u24 v133, 3, v133
    v_xor_b32 v133, v133, v131
    v_mul_u32_u24 v133, 1152, v133
    v_mul_u32_u24 v150, 96, v131
    v_sub_u32 v133, v133, v150
    v_add_u32 v150, v129, v133
    v_add_u32 v133, 128, v254
    v_mul_u32_u24 v133, 171, v133
    v_lshrrev_b32 v133, 10, v133
    v_lshrrev_b32 v151, 1, v133
    v_xor_b32 v151, v151, v133
    v_and_b32 v151, 4, v151
    v_mul_u32_u24 v151, 3, v151
    v_xor_b32 v151, v151, v133
    v_mul_u32_u24 v151, 1152, v151
    v_mul_u32_u24 v152, 96, v133
    v_sub_u32 v151, v151, v152
    v_add_u32 v152, v129, v151
    s_mul_i32 s68, s16, 6144
    s_add_u32 s69, s68, 65536
    s_cmp_eq_u32 s16, 3
    s_cselect_b32 s68, 149696, s68
    s_cselect_b32 s69, 155840, s69
    s_waitcnt lgkmcnt(0)
    s_cmp_eq_u32 s16, 2
    s_cselect_b64 s[98:99], s[80:81], s[78:79]
    s_cmp_eq_u32 s16, 3
    s_cselect_b64 s[98:99], s[88:89], s[98:99]
    s_mov_b64 s[8:9], s[76:77]
    v_lshl_add_u64 v[126:127], s[98:99], 0, v[126:127]
    s_cmp_eq_u32 s16, 2
    s_cselect_b64 s[98:99], s[84:85], s[82:83]
    s_cmp_eq_u32 s16, 3
    s_cselect_b64 s[98:99], s[86:87], s[98:99]
    v_writelane_b32 v126, s98, 63
    v_writelane_b32 v127, s99, 63
    s_cmp_eq_u32 s16, 0
    s_cbranch_scc1 L_nowu
    global_load_dword a254, v[126:127], off
L_nowu:
    s_mov_b64 s[48:49], s[78:79]
    s_mov_b64 s[52:53], s[80:81]
    s_mov_b64 s[60:61], s[84:85]
    s_mov_b64 s[64:65], s[86:87]
    s_mov_b64 s[56:57], s[88:89]
    s_mov_b64 s[46:47], s[82:83]
    s_load_dwordx4 s[40:43], s[0:1], 72
    s_add_u32 s48, s48, 384
    s_addc_u32 s49, s49, 0
    s_add_u32 m0, s68, 0
    v_lshlrev_b32 v151, 1, v255
    s_mov_b32 s54, 12288
    s_mov_b32 s55, 0x00020000
    s_mov_b32 s62, 64
    s_mov_b32 s63, 0x00020000
    s_mov_b32 s66, 128
    s_mov_b32 s67, 0x00020000
    s_mov_b32 s58, 676
    s_mov_b32 s59, 0x00020000
    s_mov_b32 s14, 0
    s_mov_b32 s15, 0x00020000
    s_mul_i32 s90, s16, 16
    v_mov_b32 v117, 0
    v_cmp_lt_u32 s[92:93], 7, v128
    v_mov_b32 v127, 0
    v_mov_b32 v129, 0
    v_mov_b32 v119, 0
    v_lshlrev_b32 v153, 1, v254
    v_mul_u32_u24 v126, 12, v128
    s_mul_i32 s71, s16, 192
    v_add_u32 v126, s71, v126
    v_lshlrev_b32 v120, 5, v255
    s_mul_i32 s72, s16, 9408
    s_add_u32 s72, s72, 104448
    s_mul_i32 s73, s16, 7616
    s_add_u32 s73, s73, 38912
    s_cmp_eq_u32 s16, 3
    s_cselect_b32 s73, 142080, s73
    s_mov_b32 s70, 193536
    s_mov_b32 s36, 100270464
    s_mov_b32 s22, 1180032
    s_mul_i32 s3, s2, 911
    s_lshr_b32 s3, s3, 16
    s_mul_i32 s35, s3, 72
    s_sub_u32 s38, s2, s35
    s_mul_i32 s3, s3, 1373568
    s_mul_i32 s35, s38, 2688
    s_add_u32 s3, s3, s35
    s_add_u32 s25, s3, 589824
    s_add_u32 s7, s3, 1769472
    s_mov_b32 s20, 31
    s_mov_b32 s21, 4204032
    s_mov_b32 s17, 20
    s_cmp_lt_u32 s2, 240
    s_cselect_b32 s45, 28, 24
    s_bfm_b32 s34, s45, 0
    s_and_b32 s4, s2, 7
    s_sub_u32 s4, 0, s4
    s_lshl_b32 s28, s16, 10
    s_add_u32 s28, s28, 20480
    s_mov_b32 s76, 0x3f80
    s_mul_i32 s79, s16, 64
    s_mul_i32 s80, s16, 32
    s_add_u32 s80, s80, 256
    s_mul_i32 s81, s16, 768
    s_add_u32 s81, s81, 98304
    s_mov_b32 s82, -24
    s_lshr_b32 s83, s16, 1
    s_and_b32 s84, s16, 1
    s_lshl_b32 s84, s84, 3
    s_lshl_b32 s85, s83, 10
    s_add_u32 s85, s85, s84
    s_lshl_b32 s83, s83, 11
    s_add_u32 s83, s83, s84
    s_add_u32 s83, s83, 157888
    s_mul_i32 s86, s16, 2048
    s_add_u32 s86, s86, 149696
    s_mul_i32 s87, s16, 128
    s_add_u32 s87, s87, 61760
    s_mov_b32 s32, 0x2a8cbccc
    s_mov_b32 s33, 0x38fba882
    s_add_u32 s75, s28, 16384
    s_cmp_lt_u32 s16, 2
    s_cselect_b32 s29, s75, 161984
    s_cselect_b32 s30, 65536, 0
    s_xor_b32 s74, s29, s30
    s_mul_i32 s77, s16, 64
    s_mul_i32 s78, s16, 32
    s_add_u32 s78, s78, 192
    buffer_load_dwordx4 v132, s[48:51], 0 offen lds
    v_mul_u32_u24 v116, 2731, v114
    v_bfe_u32 v118, v116, 17, 3
    v_lshrrev_b32 v116, 16, v116
    buffer_load_dwordx4 v150, s[48:51], 0 offen offset:1024 lds
    v_xor_b32 v121, v118, v114
    v_mul_u32_u24 v118, 37, v116
    v_lshrrev_b32 v118, 8, v118
    buffer_load_dwordx4 v152, s[48:51], 0 offen offset:2048 lds
    s_add_u32 m0, s28, 65536
    s_add_u32 s48, s48, 36864
    s_addc_u32 s49, s49, 0
    v_lshlrev_b32 v121, 4, v121
    v_mad_u32_u24 v10, v118, s70, v121
    v_mul_u32_u24 v118, s20, v116
    v_add_u32 v118, s38, v118
    v_mul_u32_u24 v122, 911, v118
    v_lshrrev_b32 v122, 16, v122
    v_mul_u32_u24 v122, s22, v122
    v_mad_u32_u24 v122, v116, s21, v122
    v_bfe_u32 v118, s34, v116, 1
    v_cmp_ne_u32 vcc, 0, v118
    v_add_u32 v118, s7, v122
    v_mul_u32_u24 v116, 384, v116
    v_cndmask_b32 v118, v115, v118, vcc
    v_sub_u32 v116, v121, v116
    v_add_u32 v118, v118, v116
    buffer_load_dwordx4 v118, s[8:11], 0 offen nt lds
    s_add_u32 m0, s28, 69632
    v_add_u32 v116, 256, v114
    v_mul_u32_u24 v118, 2731, v116
    v_bfe_u32 v121, v118, 17, 3
    v_lshrrev_b32 v118, 16, v118
    v_xor_b32 v116, v121, v116
    v_mul_u32_u24 v121, 37, v118
    v_lshrrev_b32 v121, 8, v121
    v_lshlrev_b32 v116, 4, v116
    v_mad_u32_u24 v11, v121, s70, v116
    v_min_u32 v121, 20, v118
    v_add_u32 v122, 12, v118
    v_lshrrev_b32 v122, 5, v122
    v_sub_u32 v123, v118, v121
    v_mad_i32_i24 v123, v122, s4, v123
    v_mul_u32_u24 v124, s20, v121
    v_add3_u32 v124, v124, v123, s38
    v_mul_u32_u24 v122, 911, v124
    v_lshrrev_b32 v122, 16, v122
    v_mul_u32_u24 v122, s22, v122
    v_mad_u32_u24 v122, v121, s21, v122
    v_bfe_u32 v124, s34, v118, 1
    v_cmp_ne_u32 vcc, 0, v124
    v_mul_i32_i24 v123, 2688, v123
    v_add3_u32 v121, v122, v123, s7
    v_cndmask_b32 v121, v115, v121, vcc
    v_mul_u32_u24 v118, 384, v118
    v_sub_u32 v118, v116, v118
    v_add_u32 v121, v121, v118
    buffer_load_dwordx4 v121, s[8:11], 0 offen lds
    s_add_u32 m0, s28, 73728
    v_add_u32 v116, 512, v114
    v_mul_u32_u24 v118, 2731, v116
    v_bfe_u32 v121, v118, 17, 3
    v_lshrrev_b32 v118, 16, v118
    v_xor_b32 v116, v121, v116
    v_mul_u32_u24 v121, 37, v118
    v_lshrrev_b32 v121, 8, v121
    v_lshlrev_b32 v116, 4, v116
    v_mad_u32_u24 v12, v121, s70, v116
    v_min_u32 v121, 20, v118
    v_add_u32 v122, 12, v118
    v_lshrrev_b32 v122, 5, v122
    v_sub_u32 v123, v118, v121
    v_mad_i32_i24 v123, v122, s4, v123
    v_mul_u32_u24 v124, s20, v121
    v_add3_u32 v124, v124, v123, s38
    v_mul_u32_u24 v122, 911, v124
    v_lshrrev_b32 v122, 16, v122
    v_mul_u32_u24 v122, s22, v122
    v_mad_u32_u24 v122, v121, s21, v122
    v_bfe_u32 v124, s34, v118, 1
    v_cmp_ne_u32 vcc, 0, v124
    v_mul_i32_i24 v123, 2688, v123
    v_add3_u32 v121, v122, v123, s7
    v_cndmask_b32 v121, v115, v121, vcc
    v_mul_u32_u24 v118, 384, v118
    v_sub_u32 v118, v116, v118
    v_add_u32 v121, v121, v118
    buffer_load_dwordx4 v121, s[8:11], 0 offen lds
    s_add_u32 m0, s68, 3072
    v_lshrrev_b32 v116, 2, v128
    v_and_b32 v121, 1, v116
    v_mul_u32_u24 v121, 0x020202, v121
    v_lshl_or_b32 v121, v121, 8, v121
    v_add_u32 v121, 0x05040100, v121
    v_and_b32 v118, 3, v128
    v_lshrrev_b32 v122, 1, v128
    v_xor_b32 v122, v122, v255
    v_mul_u32_u24 v123, 384, v128
    v_lshl_add_u32 v0, v122, 4, v123
    v_xor_b32 v1, 64, v0
    v_and_b32 v122, 2, v255
    v_add_u32 v122, v122, v255
    v_lshl_add_u32 v122, v122, 2, v116
    v_mul_u32_u24 v122, 96, v122
    v_lshl_add_u32 v122, v118, 3, v122
    v_add_u32 v123, s68, v122
    buffer_load_dwordx4 v132, s[48:51], 0 offen lds
    v_add_u32 v124, s69, v122
    v_add_u32 v125, s72, v122
    v_add_u32 v122, s73, v122
    v_mov_b32 v28, 0x3f803f80
    v_mov_b32 v29, 0x3f803f80
    v_mov_b32 v30, 0x3f803f80
    v_mov_b32 v31, 0x3f803f80
    v_mul_u32_u24 v134, 768, v255
    v_add_u32 v134, v126, v134
    v_add_u32 v134, 98304, v134
    v_and_b32 v135, 1, v128
    v_lshlrev_b32 v135, 4, v135
    v_lshlrev_b32 v136, v135, s76
    v_mov_b32 v137, 0x3c003c00
    v_mov_b32 v44, 1.0
    v_lshlrev_b32 v138, 4, v255
    v_lshl_add_u32 v139, v255, 4, s79
    v_lshl_add_u32 v140, v255, 3, s80
    buffer_load_dwordx4 v150, s[48:51], 0 offen offset:1024 lds
    v_add_u32 v141, 0, v128
    v_mul_u32_u24 v142, 37, v141
    v_mul_u32_u24 v143, 384, v141
    v_lshrrev_b32 v142, 8, v142
    v_mad_u32_u24 v143, v142, s70, v143
    v_add_u32 v15, v143, v139
    v_add_u32 v18, v143, v140
    v_add_u32 v143, 16, v128
    v_mul_u32_u24 v144, 37, v143
    v_mul_u32_u24 v145, 384, v143
    v_lshrrev_b32 v144, 8, v144
    v_mad_u32_u24 v145, v144, s70, v145
    v_add_u32 v16, v145, v139
    v_add_u32 v19, v145, v140
    v_add_u32 v145, 32, v128
    v_mul_u32_u24 v146, 37, v145
    v_mul_u32_u24 v147, 384, v145
    v_lshrrev_b32 v146, 8, v146
    v_mad_u32_u24 v147, v146, s70, v147
    v_add_u32 v17, v147, v139
    v_add_u32 v20, v147, v140
    v_mul_u32_u24 v142, 24, v142
    v_lshl_add_u32 v142, v141, 2, v142
    v_add_u32 v22, s81, v142
    v_sub_u32 v23, s81, v142
    v_sub_u32 v139, v22, v138
    v_mul_u32_u24 v140, 24, v144
    v_lshl_add_u32 v140, v143, 2, v140
    v_add_u32 v24, s81, v140
    v_sub_u32 v25, s81, v140
    v_sub_u32 v140, v24, v138
    v_mul_u32_u24 v141, 24, v146
    v_lshl_add_u32 v141, v145, 2, v141
    v_add_u32 v26, s81, v141
    v_sub_u32 v27, s81, v141
    v_sub_u32 v141, v26, v138
    v_mul_u32_u24 v142, 148, v255
    v_add_u32 v143, 0, v142
    v_lshrrev_b32 v143, 8, v143
    v_mad_i32_i24 v46, v143, s82, v139
    v_mad_i32_i24 v58, v143, s82, v140
    v_mad_i32_i24 v70, v143, s82, v141
    v_add_u32 v143, 37, v142
    v_lshrrev_b32 v143, 8, v143
    v_mad_i32_i24 v47, v143, s82, v139
    v_mad_i32_i24 v59, v143, s82, v140
    v_mad_i32_i24 v71, v143, s82, v141
    v_add_u32 v143, 74, v142
    v_lshrrev_b32 v143, 8, v143
    v_mad_i32_i24 v48, v143, s82, v139
    v_mad_i32_i24 v60, v143, s82, v140
    v_mad_i32_i24 v72, v143, s82, v141
    v_add_u32 v143, 111, v142
    v_lshrrev_b32 v143, 8, v143
    v_mad_i32_i24 v49, v143, s82, v139
    v_mad_i32_i24 v61, v143, s82, v140
    v_mad_i32_i24 v73, v143, s82, v141
    v_add_u32 v143, 592, v142
    v_lshrrev_b32 v143, 8, v143
    v_mad_i32_i24 v50, v143, s82, v139
    v_mad_i32_i24 v62, v143, s82, v140
    v_mad_i32_i24 v74, v143, s82, v141
    v_add_u32 v143, 629, v142
    v_lshrrev_b32 v143, 8, v143
    v_mad_i32_i24 v51, v143, s82, v139
    v_mad_i32_i24 v63, v143, s82, v140
    v_mad_i32_i24 v75, v143, s82, v141
    v_add_u32 v143, 666, v142
    v_lshrrev_b32 v143, 8, v143
    v_mad_i32_i24 v52, v143, s82, v139
    v_mad_i32_i24 v64, v143, s82, v140
    v_mad_i32_i24 v76, v143, s82, v141
    v_add_u32 v143, 703, v142
    v_lshrrev_b32 v143, 8, v143
    v_mad_i32_i24 v53, v143, s82, v139
    v_mad_i32_i24 v65, v143, s82, v140
    v_mad_i32_i24 v77, v143, s82, v141
    v_add_u32 v143, 1184, v142
    v_lshrrev_b32 v143, 8, v143
    v_mad_i32_i24 v54, v143, s82, v139
    v_mad_i32_i24 v66, v143, s82, v140
    v_mad_i32_i24 v78, v143, s82, v141
    v_add_u32 v143, 1221, v142
    v_lshrrev_b32 v143, 8, v143
    v_mad_i32_i24 v55, v143, s82, v139
    v_mad_i32_i24 v67, v143, s82, v140
    v_mad_i32_i24 v79, v143, s82, v141
    v_add_u32 v143, 1258, v142
    v_lshrrev_b32 v143, 8, v143
    v_mad_i32_i24 v56, v143, s82, v139
    v_mad_i32_i24 v68, v143, s82, v140
    v_mad_i32_i24 v80, v143, s82, v141
    v_add_u32 v142, 1295, v142
    v_lshrrev_b32 v142, 8, v142
    v_mad_i32_i24 v57, v142, s82, v139
    v_mad_i32_i24 v69, v142, s82, v140
    v_mad_i32_i24 v81, v142, s82, v141
    v_mov_b32 v139, s81
    v_lshlrev_b32 v140, 4, v254
    v_xor_b32 v2, 65536, v140
    v_lshl_add_u32 v3, s16, 10, v140
    v_add_u32 v4, s85, v140
    v_lshl_add_u32 v140, v255, 3, s86
    v_mov_b32 v141, s83
    v_mov_b32 v142, 163264
    v_mul_u32_u24 v143, 80, v255
    v_add3_u32 v154, v143, v135, s72
    v_add_u32 v5, s72, v143
    v_lshl_add_u32 v6, v128, 2, s73
    v_add_u32 v9, s87, v138
    v_lshrrev_b32 v135, 1, v255
    v_mul_u32_u24 v135, 48, v135
    v_lshl_add_u32 v135, v255, 3, v135
    v_lshl_add_u32 v135, v116, 4, v135
    v_lshl_add_u32 v135, v118, 1, v135
    v_add_u32 v8, s87, v135
    v_mov_b32 v37, 0
    v_mov_b32 v38, 0
    buffer_load_dwordx4 v152, s[48:51], 0 offen offset:2048 lds
    s_add_u32 s48, s48, 36864
    s_addc_u32 s49, s49, 0
    s_add_u32 m0, s69, 0
    v_mov_b32 v39, 0
    v_add_u32 v155, 86016, v0
    v_add_u32 v156, 86016, v1
    v_lshlrev_b32 v157, 4, v128
    v_add_u32 v157, 161984, v157
    v_mul_u32_u24 v135, 336, v128
    v_add3_u32 v135, v135, v143, s72
    v_mul_u32_u24 v143, 272, v128
    v_add3_u32 v143, v143, v138, s73
    v_mul_u32_u24 v158, 1088, v255
    v_add_u32 v158, v158, v6
    v_add_u32 v159, 5376, v135
    v_add_u32 v160, 4352, v143
    v_add_u32 v161, 4352, v158
    v_cmp_gt_u32 s[88:89], 16, v254
    buffer_load_dwordx4 v132, s[48:51], 0 offen lds
    v_mov_b32 v144, 0xf149f2ca
    v_add_u32 v145, 768, v114
    v_mul_u32_u24 v146, 2731, v145
    v_bfe_u32 v147, v146, 17, 3
    v_lshrrev_b32 v146, 16, v146
    v_xor_b32 v145, v147, v145
    v_mul_u32_u24 v147, 37, v146
    v_lshrrev_b32 v147, 8, v147
    v_lshlrev_b32 v145, 4, v145
    v_mad_u32_u24 v13, v147, s70, v145
    v_add_u32 v114, 1024, v114
    v_mul_u32_u24 v145, 2731, v114
    v_bfe_u32 v146, v145, 17, 3
    s_waitcnt vmcnt(7)
    ds_read_b64_tr_b16 a[72:73], v123 offset:0
    ds_read_b64_tr_b16 a[74:75], v123 offset:768
    ds_read_b64_tr_b16 a[96:97], v123 offset:32
    ds_read_b64_tr_b16 a[98:99], v123 offset:800
    ds_read_b64_tr_b16 a[120:121], v123 offset:64
    buffer_load_dwordx4 v150, s[48:51], 0 offen offset:1024 lds
    ds_read_b64_tr_b16 a[122:123], v123 offset:832
    v_lshrrev_b32 v145, 16, v145
    v_xor_b32 v114, v146, v114
    v_mul_u32_u24 v146, 37, v145
    v_lshrrev_b32 v146, 8, v146
    v_lshlrev_b32 v114, 4, v114
    v_mad_u32_u24 v14, v146, s70, v114
    v_cmp_gt_u32 vcc, 48, v145
    v_mul_u32_u24 v145, 6, v130
    v_sub_u32 v114, v254, v145
    v_cndmask_b32 v14, v115, v14, vcc
    v_cmp_gt_u32 vcc, 2, v118
    v_mul_u32_u24 v145, 384, v130
    v_lshl_add_u32 v145, v114, 4, v145
    v_cndmask_b32 v32, 0, v136, vcc
    v_cndmask_b32 v33, v136, 0, vcc
    v_cndmask_b32 v34, 0, v136, vcc
    v_cndmask_b32 v35, v136, 0, vcc
    buffer_load_dwordx4 v152, s[48:51], 0 offen offset:2048 lds
    s_add_u32 s48, s48, 36864
    s_addc_u32 s49, s49, 0
    s_add_u32 m0, s69, 3072
    v_cmp_eq_u32 vcc, 0, v118
    v_add_u32 v115, s78, v145
    v_add_u32 v145, s77, v145
    v_cndmask_b32 v40, 0, v137, vcc
    v_cmp_eq_u32 vcc, 1, v118
    v_mul_u32_u24 v136, 6, v131
    v_sub_u32 v130, v254, v136
    v_cndmask_b32 v41, 0, v137, vcc
    v_cmp_eq_u32 vcc, 2, v118
    v_mul_u32_u24 v136, 384, v131
    v_lshl_add_u32 v136, v130, 4, v136
    v_cndmask_b32 v42, 0, v137, vcc
    v_cmp_eq_u32 vcc, 3, v118
    v_add_u32 v131, s78, v136
    v_add_u32 v136, s77, v136
    v_cndmask_b32 v43, 0, v137, vcc
    v_cmp_eq_u32 vcc, v255, v116
    v_mul_u32_u24 v137, 6, v133
    v_sub_u32 v254, v254, v137
    v_cndmask_b32 v162, 0, v32, vcc
    v_cndmask_b32 v163, 0, v33, vcc
    v_cmp_gt_i32 vcc, 4, v114
    v_mul_u32_u24 v137, 384, v133
    v_lshl_add_u32 v137, v254, 4, v137
    v_cndmask_b32 v164, v115, v145, vcc
    v_cmp_gt_i32 vcc, -60, v130
    v_add_u32 v145, s78, v137
    v_add_u32 v137, s77, v137
    v_cndmask_b32 v165, v131, v136, vcc
    v_cmp_gt_i32 vcc, -124, v254
    v_mul_u32_u24 v254, 96, v128
    v_add3_u32 v130, v254, v138, s68
    v_cndmask_b32 v131, v145, v137, vcc
    v_cmp_gt_u32 vcc, 2, v255
    v_lshl_add_u32 v133, v255, 3, v254
    v_add3_u32 v133, v133, 64, s68
    v_cndmask_b32 v140, v141, v140, vcc
    v_lshl_add_u32 v140, v116, 9, v140
    v_lshl_add_u32 v140, v118, 1, v140
    v_cmp_gt_u32 vcc, 3, v255
    v_add3_u32 v114, v254, v138, s69
    v_lshl_add_u32 v254, v255, 3, v254
    v_cndmask_b32 v7, v142, v140, vcc
    v_cmp_gt_u32 vcc, 12, v128
    v_add3_u32 v254, v254, 64, s69
    v_add_u32 v118, 16, v128
    v_cndmask_b32 v159, v157, v159, vcc
    v_cndmask_b32 v160, v157, v160, vcc
    v_cmp_gt_u32 vcc, 3, v255
    v_cmp_gt_u32 s[94:95], s45, v118
    v_cndmask_b32 v255, v157, v143, s[88:89]
    v_cndmask_b32 v161, v157, v161, vcc
    v_cndmask_b32 v157, v157, v160, s[88:89]
    v_add_u32 v5, 336, v5
    buffer_load_dwordx4 v132, s[48:51], 0 offen lds
    buffer_load_dwordx4 v150, s[48:51], 0 offen offset:1024 lds
    buffer_load_dwordx4 v152, s[48:51], 0 offen offset:2048 lds
    s_waitcnt vmcnt(9)
    s_barrier
    ds_read_b128 v[146:149], v155 offset:6144
    ds_read_b128 v[166:169], v156 offset:6144
    ds_read_b128 v[170:173], v155 offset:6272
    s_add_u32 s48, s48, 36864
    s_addc_u32 s49, s49, 0
    ds_read_b128 v[174:177], v156 offset:6272
    s_add_u32 m0, s72, 0
    ds_read_b128 v[178:181], v155 offset:6400
    ds_read_b128 v[182:185], v156 offset:6400
    ds_read_b128 v[186:189], v155 offset:0
    buffer_load_ushort v116, v153, s[60:63], 0 offen
    s_mov_b64 s[60:61], s[8:9]
    ds_read_b128 v[190:193], v156 offset:0
    ds_read_b128 v[194:197], v155 offset:128
    ds_read_b128 v[198:201], v156 offset:128
    s_waitcnt lgkmcnt(7)
    v_mfma_f32_16x16x32_bf16 v[202:205], a[72:75], v[146:149], 0
    buffer_load_dwordx3 v[206:208], v126, s[56:59], 0 offen
    ds_read_b128 v[210:213], v155 offset:256
    v_mfma_f32_16x16x32_bf16 v[214:217], a[96:99], v[146:149], 0
    s_waitcnt lgkmcnt(7)
    ds_read_b128 v[218:221], v156 offset:256
    v_mfma_f32_16x16x32_bf16 v[222:225], a[120:123], v[146:149], 0
    s_waitcnt lgkmcnt(7)
    ds_read_b128 v[146:149], v155 offset:6144
    s_waitcnt lgkmcnt(6)
    v_mfma_f32_16x16x32_bf16 v[226:229], a[72:75], v[186:189], 0
    v_mfma_f32_16x16x32_bf16 v[230:233], a[96:99], v[186:189], 0
    s_waitcnt vmcnt(8)
    buffer_load_dwordx4 v[234:237], v120, s[64:67], 0 offen
    ds_read_b64_tr_b16 a[76:77], v123 offset:3072
    ds_read_b64_tr_b16 a[78:79], v123 offset:3840
    ds_read_b64_tr_b16 a[100:101], v123 offset:3104
    ds_read_b64_tr_b16 a[102:103], v123 offset:3872
    ds_read_b64_tr_b16 a[124:125], v123 offset:3136
    ds_read_b64_tr_b16 a[126:127], v123 offset:3904
    s_mov_b32 s19, s38
    s_mov_b32 s23, s25
    s_mov_b32 s26, 0
    s_mov_b32 s27, 0
    s_mov_b32 s18, 0
    s_add_u32 s19, s19, s20
    s_add_u32 s23, s23, s21
    s_cmp_ge_u32 s19, 72
    s_cselect_b32 s34, 72, 0
    s_cselect_b32 s35, s22, 0
    s_sub_u32 s19, s19, s34
    s_add_u32 s23, s23, s35
    s_mov_b32 s24, s23
    s_add_u32 s19, s19, s20
    s_add_u32 s23, s23, s21
    s_cmp_ge_u32 s19, 72
    s_cselect_b32 s34, 72, 0
    s_cselect_b32 s35, s22, 0
    s_sub_u32 s19, s19, s34
    s_add_u32 s23, s23, s35
    s_sub_u32 s62, s45, s17
    s_sub_u32 s45, s17, 1
    s_bfm_b32 s70, s17, 0
    s_waitcnt lgkmcnt(4)
    v_mfma_f32_16x16x32_bf16 v[202:205], a[76:79], v[166:169], v[202:205]
    s_waitcnt lgkmcnt(2)
    global_load_ushort v151, v151, s[46:47]
    s_mov_b32 s71, 1
    v_mfma_f32_16x16x32_bf16 v[214:217], a[100:103], v[166:169], v[214:217]
    s_waitcnt lgkmcnt(0)
    buffer_load_dwordx4 v132, s[48:51], 0 offen lds
    s_and_b32 s77, s2, 0xf8
    v_mfma_f32_16x16x32_bf16 v[222:225], a[124:127], v[166:169], v[222:225]
    s_add_u32 s77, s77, 4940
    ds_read_b128 v[166:169], v156 offset:6144
    s_mul_i32 s78, s77, 58255
    v_mfma_f32_16x16x32_bf16 v[226:229], a[76:79], v[190:193], v[226:229]
    s_lshr_b32 s78, s78, 22
    s_add_u32 s34, s18, 2
    s_mov_b32 s18, 1
    v_mfma_f32_16x16x32_bf16 v[230:233], a[100:103], v[190:193], v[230:233]
    s_mov_b32 s27, s26
    s_mov_b32 s26, s25
    s_add_u32 s19, s19, s20
    s_waitcnt vmcnt(8)
    ds_read_b64_tr_b16 a[80:81], v124 offset:0
    ds_read_b64_tr_b16 a[82:83], v124 offset:768
    ds_read_b64_tr_b16 a[104:105], v124 offset:32
    ds_read_b64_tr_b16 a[106:107], v124 offset:800
    ds_read_b64_tr_b16 a[128:129], v124 offset:64
    ds_read_b64_tr_b16 a[130:131], v124 offset:832
    buffer_load_dwordx4 v150, s[48:51], 0 offen offset:1024 lds
    buffer_load_dwordx4 v152, s[48:51], 0 offen offset:2048 lds
    s_add_u32 s48, s48, 36864
    s_waitcnt lgkmcnt(4)
    v_mfma_f32_16x16x32_bf16 v[202:205], a[80:83], v[170:173], v[202:205]
    s_waitcnt lgkmcnt(2)
    s_addc_u32 s49, s49, 0
    s_add_u32 m0, s72, 3072
    v_mfma_f32_16x16x32_bf16 v[214:217], a[104:107], v[170:173], v[214:217]
    s_waitcnt lgkmcnt(0)
    s_mov_b32 s72, 2
    v_mfma_f32_16x16x32_bf16 v[222:225], a[128:131], v[170:173], v[222:225]
    ds_read_b128 v[170:173], v155 offset:6272
    v_mfma_f32_16x16x32_bf16 v[226:229], a[80:83], v[194:197], v[226:229]
    v_mfma_f32_16x16x32_bf16 v[230:233], a[104:107], v[194:197], v[230:233]
    buffer_load_dwordx4 v132, s[48:51], 0 offen lds
    s_waitcnt vmcnt(8)
    ds_read_b64_tr_b16 a[84:85], v124 offset:3072
    ds_read_b64_tr_b16 a[86:87], v124 offset:3840
    ds_read_b64_tr_b16 a[108:109], v124 offset:3104
    ds_read_b64_tr_b16 a[110:111], v124 offset:3872
    ds_read_b64_tr_b16 a[132:133], v124 offset:3136
    ds_read_b64_tr_b16 a[134:135], v124 offset:3904
    s_waitcnt vmcnt(6)
    v_bfe_u32 v126, v206, v138, 16
    v_bfe_u32 v128, v207, v138, 16
    v_bfe_u32 v118, v208, v138, 16
    buffer_load_dwordx4 v150, s[48:51], 0 offen offset:1024 lds
    s_waitcnt vmcnt(6)
    v_cndmask_b32 v234, v234, v235, s[92:93]
    v_mfma_f32_16x16x16_bf16 v[206:209], v[116:117], v[126:127], 0
    v_cndmask_b32 v236, v236, v237, s[92:93]
    v_perm_b32 v136, v236, v234, v121
    v_mfma_f32_16x16x16_bf16 v[234:237], v[116:117], v[128:129], 0
    s_waitcnt lgkmcnt(4)
    v_mfma_f32_16x16x32_bf16 v[202:205], a[84:87], v[174:177], v[202:205]
    s_waitcnt lgkmcnt(0)
    v_mfma_f32_16x16x32_bf16 v[214:217], a[108:111], v[174:177], v[214:217]
    buffer_load_dwordx4 v152, s[48:51], 0 offen offset:2048 lds
    v_max_f32 v206, 0, v206
    v_mfma_f32_16x16x32_bf16 v[222:225], a[132:135], v[174:177], v[222:225]
    s_sub_u32 s48, s48, 184704
    ds_read_b128 v[126:129], v156 offset:6272
    v_max_f32 v207, 0, v207
    v_mfma_f32_16x16x32_bf16 v[226:229], a[84:87], v[198:201], v[226:229]
    s_subb_u32 s49, s49, 0
    v_max_f32 v208, 0, v208
    v_max_f32 v209, 0, v209
    v_mfma_f32_16x16x32_bf16 v[230:233], a[108:111], v[198:201], v[230:233]
    s_add_u32 m0, s73, 0
    v_cvt_pk_bf16_f32 v140, v206, v207
    v_cvt_pk_bf16_f32 v141, v208, v209
    v_max_f32 v234, 0, v234
    v_mfma_f32_16x16x16_bf16 v[174:177], v[116:117], v[118:119], 0
    v_max_f32 v235, 0, v235
    s_waitcnt vmcnt(6)
    v_lshlrev_b32 v151, 16, v151
    v_max_f32 v151, 0xc2c80000, v151
    v_mfma_f32_16x16x32_bf16 v[206:209], a[120:123], v[186:189], 0
    buffer_load_dwordx4 v[186:189], v120, s[64:67], 0 offen offset:16
    v_min_f32 v151, 0x40930000, v151
    v_mfma_f32_16x16x32_bf16 v[206:209], a[124:127], v[190:193], v[206:209]
    buffer_load_dwordx4 v132, s[48:51], 0 offen lds
    ds_read_b128 v[190:193], v155 offset:0
    v_mfma_f32_16x16x32_bf16 v[206:209], a[128:131], v[194:197], v[206:209]
    ds_read_b128 v[194:197], v156 offset:0
    v_mul_f32 v151, 0x3fb8aa3b, v151
    v_mfma_f32_16x16x32_bf16 v[206:209], a[132:135], v[198:201], v[206:209]
    s_waitcnt lgkmcnt(2)
    ds_read_b128 v[198:201], v155 offset:128
    v_exp_f32 v151, v151
    v_max_f32 v236, 0, v236
    v_cvt_pk_bf16_f32 v151, v151, v151
    v_and_b32 v151, 0xffff0000, v151
    v_mul_f32 v151, 0x3fb8aa3b, v151
    v_mul_f32 v138, 0xbea8f5c3, v151
    v_add_f32 v138, 0xc138aa3b, v138
    v_readlane_b32 s31, v151, s90
    v_max_f32 v237, 0, v237
    buffer_load_dwordx4 v150, s[48:51], 0 offen offset:1024 lds
    v_cvt_pk_bf16_f32 v116, v234, v235
    v_cvt_pk_bf16_f32 v117, v236, v237
    v_max_f32 v174, 0, v174
    v_max_f32 v175, 0, v175
    v_max_f32 v176, 0, v176
    v_max_f32 v177, 0, v177
    v_cvt_pk_bf16_f32 v118, v174, v175
    v_cvt_pk_bf16_f32 v119, v176, v177
    ds_read_b128 v[174:177], v156 offset:128
    buffer_load_dwordx4 v152, s[48:51], 0 offen offset:2048 lds
    s_add_u32 s48, s48, 36864
    s_waitcnt vmcnt(7)
    ds_read_b64_tr_b16 a[88:89], v125 offset:0
    ds_read_b64_tr_b16 a[90:91], v125 offset:768
    ds_read_b64_tr_b16 a[112:113], v125 offset:32
    ds_read_b64_tr_b16 a[114:115], v125 offset:800
    ds_read_b64_tr_b16 a[136:137], v125 offset:64
    ds_read_b64_tr_b16 a[138:139], v125 offset:832
    s_addc_u32 s49, s49, 0
    s_add_u32 m0, s73, 3072
    s_mov_b32 s73, 3
    buffer_load_dwordx4 v132, s[48:51], 0 offen lds
    s_waitcnt lgkmcnt(4)
    v_mfma_f32_16x16x32_bf16 v[202:205], a[88:91], v[178:181], v[202:205]
    s_waitcnt lgkmcnt(3)
    v_mfma_f32_16x16x32_bf16 v[226:229], a[88:91], v[210:213], v[226:229]
    s_waitcnt lgkmcnt(0)
    v_mfma_f32_16x16x32_bf16 v[214:217], a[112:115], v[178:181], v[214:217]
    buffer_load_dwordx4 v150, s[48:51], 0 offen offset:1024 lds
    v_mfma_f32_16x16x32_bf16 v[222:225], a[136:139], v[178:181], v[222:225]
    ds_read_b128 v[178:181], v155 offset:6400
    v_mfma_f32_16x16x32_bf16 v[230:233], a[112:115], v[210:213], v[230:233]
    v_mfma_f32_16x16x32_bf16 v[206:209], a[136:139], v[210:213], v[206:209]
    ds_read_b128 v[210:213], v155 offset:256
    s_waitcnt vmcnt(6)
    ds_read_b64_tr_b16 a[92:93], v125 offset:3072
    ds_read_b64_tr_b16 a[94:95], v125 offset:3840
    ds_read_b64_tr_b16 a[116:117], v125 offset:3104
    ds_read_b64_tr_b16 a[118:119], v125 offset:3872
    buffer_load_dwordx4 v152, s[48:51], 0 offen offset:2048 lds
    ds_read_b64_tr_b16 a[140:141], v125 offset:3136
    ds_read_b64_tr_b16 a[142:143], v125 offset:3904
    s_add_u32 s48, s48, 36864
    s_addc_u32 s49, s49, 0
    s_add_u32 m0, s68, 0
    v_mov_b32 v234, 0
    v_mov_b32 v235, 0
    v_mov_b32 v236, 0
    v_mov_b32 v237, 0
    v_mov_b32 v238, v144
    v_mov_b32 v239, v144
    v_mov_b32 v240, v144
    v_mov_b32 v241, v144
    s_waitcnt vmcnt(6)
    v_cndmask_b32 v186, v186, v187, s[92:93]
    buffer_load_dwordx4 v132, s[48:51], 0 offen lds
    v_cndmask_b32 v188, v188, v189, s[92:93]
    v_perm_b32 v137, v188, v186, v121
    s_waitcnt lgkmcnt(4)
    v_mfma_f32_16x16x32_bf16 v[202:205], a[92:95], v[182:185], v[202:205]
    s_waitcnt lgkmcnt(3)
    v_mfma_f32_16x16x32_bf16 v[226:229], a[92:95], v[218:221], v[226:229]
    s_waitcnt lgkmcnt(0)
    v_mfma_f32_16x16x32_bf16 v[214:217], a[116:119], v[182:185], v[214:217]
    v_mfma_f32_16x16x32_bf16 v[222:225], a[140:143], v[182:185], v[222:225]
    v_mfma_f32_16x16x32_bf16 v[230:233], a[116:119], v[218:221], v[230:233]
    buffer_load_dwordx4 v150, s[48:51], 0 offen offset:1024 lds
    v_mfma_f32_16x16x32_bf16 v[206:209], a[140:143], v[218:221], v[206:209]
    ds_read_b128 v[182:185], v156 offset:6400
    v_cvt_pk_f16_f32 v186, v202, v203
    v_pk_mul_f16 v203, v186, v186
    v_cvt_pk_f16_f32 v187, v204, v205
    v_pk_fma_f16 v203, v187, v187, v203
    v_cvt_pk_f16_f32 v188, v214, v215
    v_mfma_f32_16x16x16_bf16 v[218:221], v[136:137], v[140:141], 0
    v_pk_fma_f16 v203, v188, v188, v203
    v_cvt_pk_f16_f32 v189, v216, v217
    v_pk_fma_f16 v203, v189, v189, v203
    v_mfma_f32_16x16x16_bf16 v[214:217], v[136:137], v[116:117], 0
    v_cvt_pk_f16_f32 v120, v222, v223
    v_pk_fma_f16 v203, v120, v120, v203
    v_cvt_pk_f16_f32 v121, v224, v225
    v_mfma_f32_16x16x16_bf16 v[222:225], v[136:137], v[118:119], 0
    buffer_load_dwordx4 v152, s[48:51], 0 offen offset:2048 lds
    ds_read_b128 v[242:245], v156 offset:256
    s_add_u32 s48, s48, 36864
    s_addc_u32 s49, s49, 0
    s_add_u32 m0, s68, 3072
    v_cvt_pk_bf16_f32 v218, v218, v218
    v_and_b32 v218, 0xffff0000, v218
    s_waitcnt vmcnt(6)
    ds_read_b64_tr_b16 a[0:1], v122 offset:0
    ds_read_b64_tr_b16 a[2:3], v122 offset:768
    ds_read_b64_tr_b16 a[24:25], v122 offset:32
    ds_read_b64_tr_b16 a[26:27], v122 offset:800
    ds_read_b64_tr_b16 a[48:49], v122 offset:64
    ds_read_b64_tr_b16 a[50:51], v122 offset:832
    v_mul_f32 v218, 0xbfb8aa3b, v218
    v_exp_f32 v218, v218
    v_cvt_pk_bf16_f32 v214, v214, v214
    buffer_load_dwordx4 v132, s[48:51], 0 offen lds
    v_add_f32 v218, 1.0, v218
    v_rcp_f32 v218, v218
    v_and_b32 v214, 0xffff0000, v214
    v_cvt_pk_bf16_f32 v218, v218, v218
    v_and_b32 v218, 0xffff0000, v218
    v_fmamk_f32 v218, v218, 0x41b8aa3b, v138
    ds_write_b32 v134, v218 offset:0
    v_mul_f32 v214, 0xbfb8aa3b, v214
    v_exp_f32 v214, v214
    v_cvt_pk_bf16_f32 v222, v222, v222
    v_add_f32 v214, 1.0, v214
    s_waitcnt lgkmcnt(5)
    v_mfma_f32_16x16x32_bf16 v[218:221], a[0:3], v[146:149], 0
    s_waitcnt lgkmcnt(3)
    v_rcp_f32 v214, v214
    v_mfma_f32_16x16x32_bf16 v[246:249], a[24:27], v[146:149], 0
    s_waitcnt lgkmcnt(1)
    buffer_load_dwordx4 v150, s[48:51], 0 offen offset:1024 lds
    v_cvt_pk_bf16_f32 v214, v214, v214
    v_and_b32 v214, 0xffff0000, v214
    v_fmamk_f32 v214, v214, 0x41b8aa3b, v138
    ds_write_b32 v134, v214 offset:4
    v_and_b32 v222, 0xffff0000, v222
    v_mul_f32 v222, 0xbfb8aa3b, v222
    v_exp_f32 v222, v222
    v_pk_fma_f16 v203, v121, v121, v203
    v_add_f32 v222, 1.0, v222
    v_rcp_f32 v222, v222
    v_cvt_pk_f16_f32 v214, v226, v227
    s_waitcnt vmcnt(5)
    ds_read_b64_tr_b16 a[4:5], v122 offset:3072
    ds_read_b64_tr_b16 a[6:7], v122 offset:3840
    buffer_load_dwordx4 v152, s[48:51], 0 offen offset:2048 lds
    ds_read_b64_tr_b16 a[28:29], v122 offset:3104
    ds_read_b64_tr_b16 a[30:31], v122 offset:3872
    ds_read_b64_tr_b16 a[52:53], v122 offset:3136
    ds_read_b64_tr_b16 a[54:55], v122 offset:3904
    v_mfma_f32_16x16x32_bf16 v[250:253], a[48:51], v[146:149], 0
    s_add_u32 s48, s48, 36864
    ds_write_b128 v135, v[234:237] offset:16
    v_mfma_f32_16x16x32_bf16 v[146:149], a[0:3], v[190:193], 0
    s_addc_u32 s49, s49, 0
    s_add_u32 m0, s69, 0
    v_cvt_pk_bf16_f32 v222, v222, v222
    v_and_b32 v222, 0xffff0000, v222
    v_fmamk_f32 v222, v222, 0x41b8aa3b, v138
    v_pk_mul_f16 v223, v214, v214
    buffer_load_dwordx4 v132, s[48:51], 0 offen lds
    ds_write_b32 v134, v222 offset:8
    v_cvt_pk_f16_f32 v215, v228, v229
    v_pk_fma_f16 v223, v215, v215, v223
    v_cvt_pk_f16_f32 v216, v230, v231
    v_mfma_f32_16x16x32_bf16 v[226:229], a[24:27], v[190:193], 0
    s_waitcnt lgkmcnt(6)
    v_pk_fma_f16 v223, v216, v216, v223
    v_cvt_pk_f16_f32 v217, v232, v233
    v_mfma_f32_16x16x32_bf16 v[218:221], a[4:7], v[166:169], v[218:221]
    s_waitcnt lgkmcnt(2)
    ds_write_b64 v135, v[234:235] offset:56
    v_mfma_f32_16x16x32_bf16 v[246:249], a[28:31], v[166:169], v[246:249]
    v_pk_fma_f16 v223, v217, v217, v223
    v_cvt_pk_f16_f32 v140, v206, v207
    v_mfma_f32_16x16x32_bf16 v[250:253], a[52:55], v[166:169], v[250:253]
    buffer_load_dwordx4 v150, s[48:51], 0 offen offset:1024 lds
    v_pk_fma_f16 v223, v140, v140, v223
    v_mfma_f32_16x16x32_bf16 v[146:149], a[4:7], v[194:197], v[146:149]
    ds_write_b64 v135, v[234:235] offset:64
    v_mfma_f32_16x16x32_bf16 v[226:229], a[28:31], v[194:197], v[226:229]
    s_waitcnt lgkmcnt(2)
    v_cvt_pk_f16_f32 v141, v208, v209
    v_pk_fma_f16 v223, v141, v141, v223
    v_mfma_f32_16x16x32_bf16 v[166:169], a[48:51], v[190:193], 0
    s_barrier
    ds_read_b32 v22, v22 offset:0
    ds_read_b32 v23, v23 offset:672
    v_mfma_f32_16x16x32_bf16 v[166:169], a[52:55], v[194:197], v[166:169]
    ds_read_b32 v24, v24 offset:0
    s_waitcnt vmcnt(5)
    ds_read_b64_tr_b16 a[8:9], v123 offset:0
    ds_read_b64_tr_b16 a[10:11], v123 offset:768
    buffer_load_dwordx4 v152, s[48:51], 0 offen offset:2048 lds
    ds_read_b64_tr_b16 a[32:33], v123 offset:32
    ds_read_b64_tr_b16 a[34:35], v123 offset:800
    ds_read_b64_tr_b16 a[56:57], v123 offset:64
    ds_read_b64_tr_b16 a[58:59], v123 offset:832
    ds_read_b32 v25, v25 offset:672
    ds_read_b32 v26, v26 offset:0
    ds_read_b32 v27, v27 offset:672
    s_add_u32 s48, s48, 36864
    ds_read_b32 v46, v46 offset:336
    s_addc_u32 s49, s49, 0
    ds_read_b32 v58, v58 offset:336
    s_add_u32 m0, s69, 3072
    ds_read_b32 v70, v70 offset:336
    ds_read_b32 v47, v47 offset:332
    ds_read_b32 v59, v59 offset:332
    ds_read_b32 v71, v71 offset:332
    s_waitcnt lgkmcnt(15)
    buffer_load_dwordx4 v132, s[48:51], 0 offen lds
    ds_read_b32 v48, v48 offset:328
    ds_read_b32 v60, v60 offset:328
    s_waitcnt lgkmcnt(15)
    v_mfma_f32_16x16x32_bf16 v[218:221], a[8:11], v[170:173], v[218:221]
    s_waitcnt lgkmcnt(14)
    ds_read_b32 v72, v72 offset:328
    ds_read_b32 v49, v49 offset:324
    v_mfma_f32_16x16x32_bf16 v[146:149], a[8:11], v[198:201], v[146:149]
    s_waitcnt lgkmcnt(12)
    ds_read_b32 v61, v61 offset:324
    ds_read_b32 v73, v73 offset:324
    v_mfma_f32_16x16x32_bf16 v[246:249], a[32:35], v[170:173], v[246:249]
    s_waitcnt lgkmcnt(11)
    ds_read_b32 v50, v50 offset:272
    ds_read_b32 v62, v62 offset:272
    v_mfma_f32_16x16x32_bf16 v[250:253], a[56:59], v[170:173], v[250:253]
    s_waitcnt lgkmcnt(11)
    ds_read_b32 v74, v74 offset:272
    ds_read_b32 v51, v51 offset:268
    v_mfma_f32_16x16x32_bf16 v[226:229], a[32:35], v[198:201], v[226:229]
    s_waitcnt lgkmcnt(11)
    buffer_load_dwordx4 v150, s[48:51], 0 offen offset:1024 lds
    ds_read_b32 v63, v63 offset:268
    v_mfma_f32_16x16x32_bf16 v[166:169], a[56:59], v[198:201], v[166:169]
    s_waitcnt lgkmcnt(11)
    ds_read_b32 v75, v75 offset:268
    ds_read_b32 v52, v52 offset:264
    ds_read_b32 v64, v64 offset:264
    ds_read_b32 v76, v76 offset:264
    ds_read_b32 v53, v53 offset:260
    ds_read_b32 v65, v65 offset:260
    ds_read_b32 v77, v77 offset:260
    ds_read_b32 v54, v54 offset:208
    ds_read_b32 v66, v66 offset:208
    ds_read_b32 v78, v78 offset:208
    s_waitcnt vmcnt(5)
    ds_read_b64_tr_b16 a[12:13], v123 offset:3072
    buffer_load_dwordx4 v152, s[48:51], 0 offen offset:2048 lds
    ds_read_b64_tr_b16 a[14:15], v123 offset:3840
    ds_read_b64_tr_b16 a[36:37], v123 offset:3104
    s_add_u32 m0, s28, 0
    ds_read_b64_tr_b16 a[38:39], v123 offset:3872
    s_sub_u32 s48, s48, 183552
    ds_read_b64_tr_b16 a[60:61], v123 offset:3136
    s_subb_u32 s49, s49, 0
    ds_read_b64_tr_b16 a[62:63], v123 offset:3904
    ds_read_b32 v55, v55 offset:204
    ds_read_b32 v67, v67 offset:204
    ds_read_b32 v79, v79 offset:204
    ds_read_b32 v56, v56 offset:200
    ds_read_b32 v68, v68 offset:200
    buffer_load_dwordx4 v10, s[8:11], s25 offen nt lds
    ds_read_b32 v80, v80 offset:200
    ds_read_b32 v57, v57 offset:196
    ds_read_b32 v69, v69 offset:196
    s_add_u32 m0, s28, 4096
    ds_read_b32 v81, v81 offset:196
    ds_read_b32 v139, v139 offset:336
    s_waitcnt lgkmcnt(14)
    v_mfma_f32_16x16x32_bf16 v[218:221], a[12:15], v[126:129], v[218:221]
    s_waitcnt lgkmcnt(13)
    ds_write_b128 v159, v[234:237] offset:16
    v_mfma_f32_16x16x32_bf16 v[146:149], a[12:15], v[174:177], v[146:149]
    s_waitcnt lgkmcnt(10)
    v_cndmask_b32 v22, v144, v22, s[88:89]
    v_cndmask_b32 v24, v144, v24, s[88:89]
    v_mfma_f32_16x16x32_bf16 v[246:249], a[36:39], v[126:129], v[246:249]
    s_waitcnt lgkmcnt(8)
    buffer_load_dwordx4 v11, s[8:11], s25 offen nt lds
    v_mfma_f32_16x16x32_bf16 v[250:253], a[60:63], v[126:129], v[250:253]
    s_add_u32 m0, s28, 8192
    ds_write_b64 v159, v[234:235] offset:56
    v_mfma_f32_16x16x32_bf16 v[226:229], a[36:39], v[174:177], v[226:229]
    s_waitcnt lgkmcnt(5)
    v_mov_b32_dpp v23, v25 quad_perm:[0,1,2,3] row_mask:0x2 bank_mask:0xf
    v_cndmask_b32 v26, v144, v26, s[88:89]
    v_mfma_f32_16x16x32_bf16 v[166:169], a[60:63], v[174:177], v[166:169]
    s_waitcnt lgkmcnt(3)
    s_waitcnt lgkmcnt(2)
    ds_write_b64 v159, v[234:235] offset:64
    s_waitcnt vmcnt(5)
    v_readfirstlane_b32 s39, v139
    buffer_load_dwordx4 v12, s[8:11], s25 offen nt lds
    ds_read_b64_tr_b16 a[16:17], v124 offset:0
    ds_read_b64_tr_b16 a[18:19], v124 offset:768
    ds_read_b64_tr_b16 a[40:41], v124 offset:32
    ds_read_b64_tr_b16 a[42:43], v124 offset:800
    ds_read_b64_tr_b16 a[64:65], v124 offset:64
    ds_read_b64_tr_b16 a[66:67], v124 offset:832
    ds_write_b128 v143, v[238:241] offset:192
    s_add_u32 m0, s28, 12288
    v_mov_b32_dpp v23, v27 quad_perm:[0,1,2,3] row_mask:0x4 bank_mask:0xf
    buffer_load_dwordx4 v13, s[8:11], s25 offen nt lds
    ds_write_b128 v160, v[238:241] offset:192
    s_add_u32 m0, s29, 0
    s_nop 0
    s_waitcnt lgkmcnt(6)
    v_mfma_f32_16x16x32_bf16 v[218:221], a[16:19], v[178:181], v[218:221]
    s_waitcnt lgkmcnt(5)
    v_mfma_f32_16x16x32_bf16 v[146:149], a[16:19], v[210:213], v[146:149]
    s_waitcnt lgkmcnt(1)
    v_mfma_f32_16x16x32_bf16 v[246:249], a[40:43], v[178:181], v[246:249]
    v_mfma_f32_16x16x32_bf16 v[250:253], a[64:67], v[178:181], v[250:253]
    buffer_load_dwordx4 v14, s[8:11], s25 offen nt lds
    v_mfma_f32_16x16x32_bf16 v[226:229], a[40:43], v[210:213], v[226:229]
    s_add_u32 m0, s68, 0
    s_lshr_b32 s10, s17, 1
    s_cselect_b32 s10, s36, 0
    v_mfma_f32_16x16x32_bf16 v[166:169], a[64:67], v[210:213], v[166:169]
    s_mov_b32 s25, s24
    s_waitcnt vmcnt(5)
    ds_read_b64_tr_b16 a[20:21], v124 offset:3072
    ds_read_b64_tr_b16 a[22:23], v124 offset:3840
    ds_read_b64_tr_b16 a[44:45], v124 offset:3104
    buffer_load_dwordx4 v132, s[48:51], 0 offen lds
    ds_read_b64_tr_b16 a[46:47], v124 offset:3872
    ds_read_b64_tr_b16 a[68:69], v124 offset:3136
    ds_read_b64_tr_b16 a[70:71], v124 offset:3904
    buffer_load_dwordx4 v150, s[48:51], 0 offen offset:1024 lds
    s_waitcnt lgkmcnt(4)
    v_mfma_f32_16x16x32_bf16 v[218:221], a[20:23], v[182:185], v[218:221]
    s_waitcnt lgkmcnt(3)
    v_mfma_f32_16x16x32_bf16 v[146:149], a[20:23], v[242:245], v[146:149]
    s_waitcnt lgkmcnt(0)
    v_mfma_f32_16x16x32_bf16 v[246:249], a[44:47], v[182:185], v[246:249]
    v_mfma_f32_16x16x32_bf16 v[250:253], a[68:71], v[182:185], v[250:253]
    v_mov_b32 v205, 0
    v_mfma_f32_16x16x32_bf16 v[226:229], a[44:47], v[242:245], v[226:229]
    buffer_load_dwordx4 v152, s[48:51], 0 offen offset:2048 lds
    v_cvt_pk_f16_f32 v126, v218, v219
    v_mfma_f32_16x16x32_bf16 v[166:169], a[68:71], v[242:245], v[166:169]
    s_add_u32 s48, s48, 36864
    s_addc_u32 s49, s49, 0
    s_add_u32 m0, s68, 3072
    v_pk_mul_f16 v202, v126, v126
    v_cvt_pk_f16_f32 v127, v220, v221
    v_pk_fma_f16 v202, v127, v127, v202
    v_cvt_pk_f16_f32 v128, v246, v247
    v_pk_fma_f16 v202, v128, v128, v202
    v_cvt_pk_f16_f32 v129, v248, v249
    v_pk_fma_f16 v202, v129, v129, v202
    v_cvt_pk_f16_f32 v118, v250, v251
    v_pk_fma_f16 v202, v118, v118, v202
    v_cvt_pk_f16_f32 v119, v252, v253
    v_pk_fma_f16 v202, v119, v119, v202
    v_pk_mul_f16 v204, v126, v186
    v_pk_fma_f16 v204, v127, v187, v204
    buffer_load_dwordx4 v132, s[48:51], 0 offen lds
    v_pk_fma_f16 v204, v128, v188, v204
    v_pk_fma_f16 v204, v129, v189, v204
    v_pk_fma_f16 v204, v118, v120, v204
    v_pk_fma_f16 v204, v119, v121, v204
    v_cvt_pk_f16_f32 v142, v146, v147
    v_pk_mul_f16 v222, v142, v142
    v_mfma_f32_16x16x32_f16 v[170:173], v[40:43], v[202:205], 0
    v_cvt_pk_f16_f32 v143, v148, v149
    v_pk_fma_f16 v222, v143, v143, v222
    v_cvt_pk_f16_f32 v144, v226, v227
    v_pk_fma_f16 v222, v144, v144, v222
    v_cvt_pk_f16_f32 v145, v228, v229
    v_pk_fma_f16 v222, v145, v145, v222
    v_cvt_pk_f16_f32 v138, v166, v167
    v_pk_fma_f16 v222, v138, v138, v222
    v_rsq_f32 v170, v170
    v_rsq_f32 v171, v171
    v_mul_f32 v166, s31, v170
    v_cvt_pk_f16_f32 v167, v166, v171
    v_pk_mul_f16 v186, v186, v167 op_sel:[0,1] op_sel_hi:[1,1]
    v_pk_mul_f16 v187, v187, v167 op_sel:[0,1] op_sel_hi:[1,1]
    v_pk_mul_f16 v188, v188, v167 op_sel:[0,1] op_sel_hi:[1,1]
    v_pk_mul_f16 v189, v189, v167 op_sel:[0,1] op_sel_hi:[1,1]
    v_pk_mul_f16 v120, v120, v167 op_sel:[0,1] op_sel_hi:[1,1]
    v_pk_mul_f16 v121, v121, v167 op_sel:[0,1] op_sel_hi:[1,1]
    v_pk_mul_f16 v126, v126, v167 op_sel:[0,0] op_sel_hi:[1,0]
    v_pk_mul_f16 v127, v127, v167 op_sel:[0,0] op_sel_hi:[1,0]
    v_pk_mul_f16 v128, v128, v167 op_sel:[0,0] op_sel_hi:[1,0]
    v_pk_mul_f16 v129, v129, v167 op_sel:[0,0] op_sel_hi:[1,0]
    v_pk_mul_f16 v118, v118, v167 op_sel:[0,0] op_sel_hi:[1,0]
    v_pk_mul_f16 v119, v119, v167 op_sel:[0,0] op_sel_hi:[1,0]
    v_cndmask_b32 v170, 1.0, v170, s[94:95]
    v_cndmask_b32 v171, 1.0, v171, s[94:95]
    v_max3_u32 v44, v44, v170, v171
    v_mul_f32 v139, v172, v166
    v_fma_f32 v139, v139, v171, s39
    ds_write_b32 v157, v139 offset:192
    v_cvt_pk_f16_f32 v139, v168, v169
    v_pk_fma_f16 v222, v139, v139, v222
    v_pk_mul_f16 v224, v142, v214
    v_pk_fma_f16 v224, v143, v215, v224
    ds_write_b128 v159, v[186:189]
    v_pk_fma_f16 v224, v144, v216, v224
    v_pk_fma_f16 v224, v145, v217, v224
    v_pk_fma_f16 v224, v138, v140, v224
    v_pk_fma_f16 v224, v139, v141, v224
    v_mov_b32 v225, 0
    s_nop 0
    s_nop 0
    v_mfma_f32_16x16x32_f16 v[146:149], v[40:43], v[222:225], 0
    ds_write_b64 v159, v[120:121] offset:48
    s_nop 0
    s_nop 0
    s_nop 0
    ds_write_b128 v159, v[126:129] offset:32
    s_nop 0
    s_nop 0
    s_nop 0
    v_rsq_f32 v146, v146
    v_rsq_f32 v147, v147
    ds_write_b64 v159, v[118:119] offset:72
    v_mul_f32 v116, s31, v146
    v_cvt_pk_f16_f32 v117, v116, v147
    v_pk_mul_f16 v214, v214, v117 op_sel:[0,1] op_sel_hi:[1,1]
    v_pk_mul_f16 v215, v215, v117 op_sel:[0,1] op_sel_hi:[1,1]
    v_pk_mul_f16 v216, v216, v117 op_sel:[0,1] op_sel_hi:[1,1]
    v_pk_mul_f16 v217, v217, v117 op_sel:[0,1] op_sel_hi:[1,1]
    v_pk_mul_f16 v140, v140, v117 op_sel:[0,1] op_sel_hi:[1,1]
    v_pk_mul_f16 v141, v141, v117 op_sel:[0,1] op_sel_hi:[1,1]
    v_pk_mul_f16 v142, v142, v117 op_sel:[0,0] op_sel_hi:[1,0]
    v_pk_mul_f16 v143, v143, v117 op_sel:[0,0] op_sel_hi:[1,0]
    v_pk_mul_f16 v144, v144, v117 op_sel:[0,0] op_sel_hi:[1,0]
    v_pk_mul_f16 v145, v145, v117 op_sel:[0,0] op_sel_hi:[1,0]
    v_pk_mul_f16 v138, v138, v117 op_sel:[0,0] op_sel_hi:[1,0]
    v_pk_mul_f16 v139, v139, v117 op_sel:[0,0] op_sel_hi:[1,0]
    v_max3_u32 v44, v44, v146, v147
    v_mul_f32 v157, v148, v116
    v_fma_f32 v157, v157, v147, s39
    ds_write_b32 v255, v157 offset:192
    buffer_load_dwordx4 v150, s[48:51], 0 offen offset:1024 lds
    ds_write_b128 v135, v[214:217]
    buffer_load_dwordx4 v152, s[48:51], 0 offen offset:2048 lds
    ds_write_b64 v135, v[140:141] offset:48
    s_add_u32 s48, s48, 36864
    s_addc_u32 s49, s49, 0
    s_add_u32 m0, s69, 0
    ds_write_b128 v135, v[142:145] offset:32
    buffer_load_dwordx4 v132, s[48:51], 0 offen lds
    ds_write_b64 v135, v[138:139] offset:72
    buffer_load_dwordx4 v150, s[48:51], 0 offen offset:1024 lds
    buffer_load_dwordx4 v152, s[48:51], 0 offen offset:2048 lds
    s_waitcnt vmcnt(9)
    s_barrier
    ds_read_b128 v[126:129], v0 offset:20480
    ds_read_b128 v[170:173], v1 offset:20480
    ds_read_b128 v[174:177], v0 offset:20608
    s_add_u32 s48, s48, 36864
    s_addc_u32 s49, s49, 0
    ds_read_b128 v[178:181], v1 offset:20608
    s_add_u32 m0, s69, 3072
    ds_read_b128 v[182:185], v0 offset:20736
    ds_read_b128 v[186:189], v1 offset:20736
    buffer_load_dwordx4 v132, s[48:51], 0 offen lds
    s_waitcnt lgkmcnt(5)
    v_mfma_f32_16x16x32_bf16 v[118:121], a[72:75], v[126:129], 0
    s_waitcnt lgkmcnt(4)
    v_mfma_f32_16x16x32_bf16 v[118:121], a[76:79], v[170:173], v[118:121]
    s_waitcnt lgkmcnt(2)
    v_mfma_f32_16x16x32_bf16 v[118:121], a[80:83], v[174:177], v[118:121]
    s_waitcnt lgkmcnt(1)
    v_mfma_f32_16x16x32_bf16 v[118:121], a[84:87], v[178:181], v[118:121]
    s_waitcnt lgkmcnt(0)
    buffer_load_dwordx4 v150, s[48:51], 0 offen offset:1024 lds
    v_mfma_f32_16x16x32_bf16 v[118:121], a[88:91], v[182:185], v[118:121]
    v_mfma_f32_16x16x32_bf16 v[118:121], a[92:95], v[186:189], v[118:121]
    v_mfma_f32_16x16x32_bf16 v[190:193], a[96:99], v[126:129], 0
    s_waitcnt vmcnt(8)
    ds_read_b64_tr_b16 a[144:145], v123 offset:0
    ds_read_b64_tr_b16 a[146:147], v123 offset:768
    v_mfma_f32_16x16x32_bf16 v[190:193], a[100:103], v[170:173], v[190:193]
    ds_read_b64_tr_b16 a[168:169], v123 offset:32
    ds_read_b64_tr_b16 a[170:171], v123 offset:800
    v_mfma_f32_16x16x32_bf16 v[190:193], a[104:107], v[174:177], v[190:193]
    ds_read_b64_tr_b16 a[192:193], v123 offset:64
    buffer_load_dwordx4 v152, s[48:51], 0 offen offset:2048 lds
    v_mfma_f32_16x16x32_bf16 v[190:193], a[108:111], v[178:181], v[190:193]
    s_add_u32 s48, s48, 36864
    ds_read_b64_tr_b16 a[194:195], v123 offset:832
    v_cvt_pk_f16_f32 v146, v118, v119
    v_mfma_f32_16x16x32_bf16 v[190:193], a[112:115], v[182:185], v[190:193]
    s_addc_u32 s49, s49, 0
    v_pk_mul_f16 v143, v146, v146
    v_cvt_pk_f16_f32 v147, v120, v121
    v_mfma_f32_16x16x32_bf16 v[190:193], a[116:119], v[186:189], v[190:193]
    s_add_u32 m0, s68, 0
    v_pk_fma_f16 v143, v147, v147, v143
    v_mfma_f32_16x16x32_bf16 v[198:201], a[120:123], v[126:129], 0
    v_mfma_f32_16x16x32_bf16 v[198:201], a[124:127], v[170:173], v[198:201]
    v_mfma_f32_16x16x32_bf16 v[198:201], a[128:131], v[174:177], v[198:201]
    s_waitcnt lgkmcnt(4)
    v_mfma_f32_16x16x32_bf16 v[198:201], a[132:135], v[178:181], v[198:201]
    s_waitcnt lgkmcnt(2)
    v_cvt_pk_f16_f32 v148, v190, v191
    v_pk_fma_f16 v143, v148, v148, v143
    v_mfma_f32_16x16x32_bf16 v[198:201], a[136:139], v[182:185], v[198:201]
    s_waitcnt lgkmcnt(1)
    ds_read_b128 v[194:197], v0 offset:26624
    v_cvt_pk_f16_f32 v149, v192, v193
    v_mfma_f32_16x16x32_bf16 v[198:201], a[140:143], v[186:189], v[198:201]
    s_waitcnt lgkmcnt(1)
    buffer_load_dwordx4 v132, s[48:51], 0 offen lds
    ds_read_b128 v[190:193], v1 offset:26624
    v_mfma_f32_16x16x32_bf16 v[138:141], a[0:3], v[126:129], 0
    ds_read_b128 v[202:205], v0 offset:26752
    s_waitcnt vmcnt(7)
    v_mfma_f32_16x16x32_bf16 v[138:141], a[4:7], v[170:173], v[138:141]
    ds_read_b64_tr_b16 a[148:149], v123 offset:3072
    ds_read_b64_tr_b16 a[150:151], v123 offset:3840
    v_mfma_f32_16x16x32_bf16 v[138:141], a[8:11], v[174:177], v[138:141]
    ds_read_b64_tr_b16 a[172:173], v123 offset:3104
    ds_read_b64_tr_b16 a[174:175], v123 offset:3872
    v_mfma_f32_16x16x32_bf16 v[138:141], a[12:15], v[178:181], v[138:141]
    ds_read_b64_tr_b16 a[196:197], v123 offset:3136
    ds_read_b64_tr_b16 a[198:199], v123 offset:3904
    v_mfma_f32_16x16x32_bf16 v[138:141], a[16:19], v[182:185], v[138:141]
    ds_read_b128 v[206:209], v1 offset:26752
    buffer_load_dwordx4 v150, s[48:51], 0 offen offset:1024 lds
    v_mfma_f32_16x16x32_bf16 v[138:141], a[20:23], v[186:189], v[138:141]
    ds_read_b128 v[210:213], v0 offset:26880
    ds_read_b128 v[214:217], v1 offset:26880
    v_mfma_f32_16x16x32_bf16 v[166:169], a[24:27], v[126:129], 0
    s_waitcnt lgkmcnt(11)
    v_pk_fma_f16 v143, v149, v149, v143
    v_cvt_pk_f16_f32 v120, v198, v199
    v_mfma_f32_16x16x32_bf16 v[166:169], a[28:31], v[170:173], v[166:169]
    s_waitcnt lgkmcnt(10)
    v_pk_fma_f16 v143, v120, v120, v143
    v_cvt_pk_f16_f32 v121, v200, v201
    v_mfma_f32_16x16x32_bf16 v[166:169], a[32:35], v[174:177], v[166:169]
    s_waitcnt lgkmcnt(9)
    v_pk_fma_f16 v143, v121, v121, v143
    v_cvt_pk_f16_f32 v138, v138, v139
    v_mfma_f32_16x16x32_bf16 v[166:169], a[36:39], v[178:181], v[166:169]
    s_waitcnt lgkmcnt(7)
    v_pk_mul_f16 v142, v138, v138
    v_cvt_pk_f16_f32 v139, v140, v141
    v_mfma_f32_16x16x32_bf16 v[166:169], a[40:43], v[182:185], v[166:169]
    s_waitcnt lgkmcnt(5)
    buffer_load_dwordx4 v152, s[48:51], 0 offen offset:2048 lds
    v_pk_fma_f16 v142, v139, v139, v142
    v_mfma_f32_16x16x32_bf16 v[166:169], a[44:47], v[186:189], v[166:169]
    s_add_u32 s48, s48, 36864
    s_addc_u32 s49, s49, 0
    s_add_u32 m0, s68, 3072
    v_mfma_f32_16x16x32_bf16 v[134:137], a[48:51], v[126:129], 0
    s_waitcnt lgkmcnt(2)
    v_mfma_f32_16x16x32_bf16 v[134:137], a[52:55], v[170:173], v[134:137]
    s_waitcnt vmcnt(6)
    ds_read_b64_tr_b16 a[152:153], v124 offset:0
    ds_read_b64_tr_b16 a[154:155], v124 offset:768
    v_mfma_f32_16x16x32_bf16 v[134:137], a[56:59], v[174:177], v[134:137]
    s_waitcnt lgkmcnt(2)
    ds_read_b64_tr_b16 a[176:177], v124 offset:32
    ds_read_b64_tr_b16 a[178:179], v124 offset:800
    v_mfma_f32_16x16x32_bf16 v[134:137], a[60:63], v[178:181], v[134:137]
    ds_read_b64_tr_b16 a[200:201], v124 offset:64
    buffer_load_dwordx4 v132, s[48:51], 0 offen lds
    v_mfma_f32_16x16x32_bf16 v[134:137], a[64:67], v[182:185], v[134:137]
    ds_read_b64_tr_b16 a[202:203], v124 offset:832
    ds_read_b128 v[126:129], v0 offset:32768
    v_mfma_f32_16x16x32_bf16 v[134:137], a[68:71], v[186:189], v[134:137]
    ds_read_b128 v[170:173], v1 offset:32768
    v_cvt_pk_f16_f32 v140, v166, v167
    v_mfma_f32_16x16x32_bf16 v[174:177], a[72:75], v[194:197], 0
    ds_read_b128 v[178:181], v0 offset:32896
    v_pk_fma_f16 v142, v140, v140, v142
    v_mfma_f32_16x16x32_bf16 v[174:177], a[76:79], v[190:193], v[174:177]
    ds_read_b128 v[182:185], v1 offset:32896
    v_cvt_pk_f16_f32 v141, v168, v169
    v_mfma_f32_16x16x32_bf16 v[174:177], a[80:83], v[202:205], v[174:177]
    ds_read_b128 v[166:169], v0 offset:33024
    v_pk_fma_f16 v142, v141, v141, v142
    v_mfma_f32_16x16x32_bf16 v[174:177], a[84:87], v[206:209], v[174:177]
    s_waitcnt lgkmcnt(9)
    buffer_load_dwordx4 v150, s[48:51], 0 offen offset:1024 lds
    ds_read_b128 v[186:189], v1 offset:33024
    v_mfma_f32_16x16x32_bf16 v[174:177], a[88:91], v[210:213], v[174:177]
    s_waitcnt lgkmcnt(8)
    v_cvt_pk_f16_f32 v118, v134, v135
    v_pk_fma_f16 v142, v118, v118, v142
    v_mfma_f32_16x16x32_bf16 v[174:177], a[92:95], v[214:217], v[174:177]
    s_waitcnt lgkmcnt(7)
    v_cvt_pk_f16_f32 v119, v136, v137
    v_pk_fma_f16 v142, v119, v119, v142
    v_mfma_f32_16x16x32_bf16 v[134:137], a[96:99], v[194:197], 0
    s_waitcnt lgkmcnt(5)
    v_mov_b32 v144, 0
    v_mov_b32 v145, 0
    v_mfma_f32_16x16x32_bf16 v[134:137], a[100:103], v[190:193], v[134:137]
    s_waitcnt lgkmcnt(4)
    v_cvt_pk_f16_f32 v150, v174, v175
    v_pk_mul_f16 v175, v150, v150
    v_mfma_f32_16x16x32_f16 v[198:201], v[40:43], v[142:145], 0
    s_waitcnt vmcnt(5)
    ds_read_b64_tr_b16 a[156:157], v124 offset:3072
    buffer_load_dwordx4 v152, s[48:51], 0 offen offset:2048 lds
    v_mfma_f32_16x16x32_bf16 v[134:137], a[104:107], v[202:205], v[134:137]
    s_add_u32 m0, s69, 0
    ds_read_b64_tr_b16 a[158:159], v124 offset:3840
    ds_read_b64_tr_b16 a[180:181], v124 offset:3104
    v_mfma_f32_16x16x32_bf16 v[134:137], a[108:111], v[206:209], v[134:137]
    s_waitcnt lgkmcnt(4)
    ds_read_b64_tr_b16 a[182:183], v124 offset:3872
    ds_read_b64_tr_b16 a[204:205], v124 offset:3136
    v_mfma_f32_16x16x32_bf16 v[134:137], a[112:115], v[210:213], v[134:137]
    s_waitcnt lgkmcnt(5)
    ds_read_b64_tr_b16 a[206:207], v124 offset:3904
    v_cvt_pk_f16_f32 v151, v176, v177
    v_mfma_f32_16x16x32_bf16 v[134:137], a[116:119], v[214:217], v[134:137]
    v_rsq_f32 v198, v198
    v_mfma_f32_16x16x32_bf16 v[142:145], a[120:123], v[194:197], 0
    v_rsq_f32 v199, v199
    v_mfma_f32_16x16x32_bf16 v[142:145], a[124:127], v[190:193], v[142:145]
    buffer_load_dwordx4 v164, s[52:55], 0 offen lds
    v_mul_f32 v152, s31, v198
    v_mfma_f32_16x16x32_bf16 v[142:145], a[128:131], v[202:205], v[142:145]
    v_cvt_pk_f16_f32 v153, v152, v199
    v_pk_mul_f16 v146, v146, v153 op_sel:[0,1] op_sel_hi:[1,1]
    v_mfma_f32_16x16x32_bf16 v[142:145], a[132:135], v[206:209], v[142:145]
    s_waitcnt lgkmcnt(5)
    v_pk_mul_f16 v147, v147, v153 op_sel:[0,1] op_sel_hi:[1,1]
    v_pk_mul_f16 v148, v148, v153 op_sel:[0,1] op_sel_hi:[1,1]
    v_mfma_f32_16x16x32_bf16 v[142:145], a[136:139], v[210:213], v[142:145]
    s_waitcnt lgkmcnt(3)
    ds_read_b128 v[190:193], v155 offset:6144
    v_pk_mul_f16 v149, v149, v153 op_sel:[0,1] op_sel_hi:[1,1]
    v_mfma_f32_16x16x32_bf16 v[142:145], a[140:143], v[214:217], v[142:145]
    s_waitcnt lgkmcnt(2)
    ds_read_b128 v[194:197], v156 offset:6144
    v_pk_mul_f16 v120, v120, v153 op_sel:[0,1] op_sel_hi:[1,1]
    v_mfma_f32_16x16x32_bf16 v[202:205], a[72:75], v[126:129], 0
    s_waitcnt lgkmcnt(2)
    ds_read_b128 v[206:209], v155 offset:6272
    buffer_load_dwordx4 v165, s[52:55], 0 offen offset:1024 lds
    v_mfma_f32_16x16x32_bf16 v[202:205], a[76:79], v[170:173], v[202:205]
    ds_read_b128 v[210:213], v156 offset:6272
    v_pk_mul_f16 v121, v121, v153 op_sel:[0,1] op_sel_hi:[1,1]
    v_mfma_f32_16x16x32_bf16 v[202:205], a[80:83], v[178:181], v[202:205]
    ds_read_b128 v[214:217], v155 offset:6400
    v_pk_mul_f16 v138, v138, v153 op_sel:[0,0] op_sel_hi:[1,0]
    v_mfma_f32_16x16x32_bf16 v[202:205], a[84:87], v[182:185], v[202:205]
    ds_read_b128 v[218:221], v156 offset:6400
    v_pk_mul_f16 v139, v139, v153 op_sel:[0,0] op_sel_hi:[1,0]
    v_mfma_f32_16x16x32_bf16 v[202:205], a[88:91], v[166:169], v[202:205]
    v_pk_mul_f16 v140, v140, v153 op_sel:[0,0] op_sel_hi:[1,0]
    s_waitcnt vmcnt(5)
    v_mfma_f32_16x16x32_bf16 v[202:205], a[92:95], v[186:189], v[202:205]
    ds_read_b64_tr_b16 a[160:161], v123 offset:0
    ds_read_b64_tr_b16 a[162:163], v123 offset:768
    v_mfma_f32_16x16x32_bf16 v[222:225], a[96:99], v[126:129], 0
    s_waitcnt lgkmcnt(7)
    buffer_load_dwordx4 v131, s[52:55], 0 offen offset:2048 lds
    ds_read_b64_tr_b16 a[184:185], v123 offset:32
    v_mfma_f32_16x16x32_bf16 v[222:225], a[100:103], v[170:173], v[222:225]
    s_add_u32 s52, s52, 12288
    ds_read_b64_tr_b16 a[186:187], v123 offset:800
    ds_read_b64_tr_b16 a[208:209], v123 offset:64
    v_mfma_f32_16x16x32_bf16 v[222:225], a[104:107], v[178:181], v[222:225]
    s_addc_u32 s53, s53, 0
    ds_read_b64_tr_b16 a[210:211], v123 offset:832
    v_pk_mul_f16 v141, v141, v153 op_sel:[0,0] op_sel_hi:[1,0]
    v_mfma_f32_16x16x32_bf16 v[222:225], a[108:111], v[182:185], v[222:225]
    s_add_u32 m0, s69, 3072
    v_pk_mul_f16 v118, v118, v153 op_sel:[0,0] op_sel_hi:[1,0]
    v_pk_mul_f16 v119, v119, v153 op_sel:[0,0] op_sel_hi:[1,0]
    v_mfma_f32_16x16x32_bf16 v[222:225], a[112:115], v[166:169], v[222:225]
    s_waitcnt lgkmcnt(7)
    v_max3_u32 v44, v44, v198, v199
    v_pk_fma_f16 v175, v151, v151, v175
    v_mfma_f32_16x16x32_bf16 v[222:225], a[116:119], v[186:189], v[222:225]
    s_waitcnt lgkmcnt(6)
    v_cvt_pk_f16_f32 v152, v134, v135
    v_pk_fma_f16 v175, v152, v152, v175
    v_mfma_f32_16x16x32_bf16 v[198:201], a[120:123], v[126:129], 0
    buffer_load_dwordx4 v164, s[52:55], 0 offen lds
    v_cvt_pk_f16_f32 v153, v136, v137
    v_mfma_f32_16x16x32_bf16 v[198:201], a[124:127], v[170:173], v[198:201]
    s_waitcnt lgkmcnt(4)
    v_pk_fma_f16 v175, v153, v153, v175
    v_cvt_pk_f16_f32 v124, v142, v143
    v_mfma_f32_16x16x32_bf16 v[198:201], a[128:131], v[178:181], v[198:201]
    s_waitcnt lgkmcnt(3)
    v_pk_fma_f16 v175, v124, v124, v175
    v_cvt_pk_f16_f32 v125, v144, v145
    v_mfma_f32_16x16x32_bf16 v[198:201], a[132:135], v[182:185], v[198:201]
    s_waitcnt lgkmcnt(1)
    v_pk_fma_f16 v175, v125, v125, v175
    v_cvt_pk_f16_f32 v126, v202, v203
    v_mfma_f32_16x16x32_bf16 v[198:201], a[136:139], v[166:169], v[198:201]
    s_waitcnt lgkmcnt(0)
    ds_read_b128 v[134:137], v155 offset:0
    v_pk_mul_f16 v115, v126, v126
    v_mfma_f32_16x16x32_bf16 v[198:201], a[140:143], v[186:189], v[198:201]
    ds_read_b128 v[142:145], v156 offset:0
    buffer_load_dwordx4 v165, s[52:55], 0 offen offset:1024 lds
    v_mfma_f32_16x16x32_bf16 v[166:169], v[190:193], a[144:147], 0
    ds_read_b128 v[170:173], v155 offset:128
    v_cvt_pk_f16_f32 v127, v204, v205
    v_mfma_f32_16x16x32_bf16 v[166:169], v[194:197], a[148:151], v[166:169]
    ds_read_b128 v[178:181], v156 offset:128
    v_pk_fma_f16 v115, v127, v127, v115
    v_mfma_f32_16x16x32_bf16 v[166:169], v[206:209], a[152:155], v[166:169]
    ds_read_b128 v[182:185], v155 offset:256
    v_cvt_pk_f16_f32 v128, v222, v223
    s_waitcnt vmcnt(5)
    v_mfma_f32_16x16x32_bf16 v[166:169], v[210:213], a[156:159], v[166:169]
    ds_read_b64_tr_b16 a[164:165], v123 offset:3072
    ds_read_b64_tr_b16 a[166:167], v123 offset:3840
    v_mfma_f32_16x16x32_bf16 v[166:169], v[214:217], a[160:163], v[166:169]
    ds_read_b64_tr_b16 a[188:189], v123 offset:3104
    buffer_load_dwordx4 v131, s[52:55], 0 offen offset:2048 lds
    v_mfma_f32_16x16x32_bf16 v[186:189], v[190:193], a[168:171], 0
    s_waitcnt lgkmcnt(7)
    ds_read_b64_tr_b16 a[190:191], v123 offset:3872
    ds_read_b64_tr_b16 a[212:213], v123 offset:3136
    v_mfma_f32_16x16x32_bf16 v[186:189], v[194:197], a[172:175], v[186:189]
    s_add_u32 s52, s52, 12288
    ds_read_b64_tr_b16 a[214:215], v123 offset:3904
    ds_read_b128 v[202:205], v156 offset:256
    v_mfma_f32_16x16x32_bf16 v[186:189], v[206:209], a[176:179], v[186:189]
    s_addc_u32 s53, s53, 0
    v_pk_fma_f16 v115, v128, v128, v115
    v_cvt_pk_f16_f32 v129, v224, v225
    v_mfma_f32_16x16x32_bf16 v[186:189], v[210:213], a[180:183], v[186:189]
    s_add_u32 m0, s68, 0
    v_pk_fma_f16 v115, v129, v129, v115
    v_cvt_pk_f16_f32 v156, v198, v199
    v_mfma_f32_16x16x32_bf16 v[186:189], v[214:217], a[184:187], v[186:189]
    s_waitcnt lgkmcnt(7)
    v_pk_fma_f16 v115, v156, v156, v115
    v_cvt_pk_f16_f32 v157, v200, v201
    v_mfma_f32_16x16x32_bf16 v[198:201], v[190:193], a[192:195], 0
    buffer_load_dwordx4 v164, s[52:55], 0 offen lds
    v_pk_fma_f16 v115, v157, v157, v115
    v_mfma_f32_16x16x32_bf16 v[198:201], v[194:197], a[196:199], v[198:201]
    s_waitcnt lgkmcnt(5)
    v_xor_b32 v255, 65536, v2
    v_lshrrev_b32 v132, 2, v255
    v_mfma_f32_16x16x32_bf16 v[166:169], v[218:221], a[164:167], v[166:169]
    s_waitcnt lgkmcnt(4)
    v_lshrrev_b32 v159, 8, v255
    v_lshl_add_u32 v160, s16, 2, v255
    v_mfma_f32_16x16x32_bf16 v[198:201], v[206:209], a[200:203], v[198:201]
    s_waitcnt lgkmcnt(2)
    v_add_u32 v132, 62784, v132
    v_lshlrev_b32 v159, 4, v159
    v_mfma_f32_16x16x32_bf16 v[186:189], v[218:221], a[188:191], v[186:189]
    s_waitcnt lgkmcnt(0)
    v_cvt_pk_bf16_f32 v166, v166, v166
    v_cvt_pk_bf16_f32 v167, v167, v167
    v_mfma_f32_16x16x32_bf16 v[198:201], v[210:213], a[204:207], v[198:201]
    s_barrier
    ds_write2_b32 v161, v166, v167 offset0:0 offset1:68
    v_mfma_f32_16x16x32_bf16 v[198:201], v[214:217], a[208:211], v[198:201]
    buffer_load_dwordx4 v165, s[52:55], 0 offen offset:1024 lds
    v_cvt_pk_bf16_f32 v168, v168, v168
    v_mfma_f32_16x16x32_bf16 v[198:201], v[218:221], a[212:215], v[198:201]
    v_cvt_pk_bf16_f32 v169, v169, v169
    v_cvt_pk_bf16_f32 v186, v186, v186
    v_mfma_f32_16x16x32_bf16 v[190:193], v[134:137], a[144:147], 0
    ds_write2_b32 v161, v168, v169 offset0:136 offset1:204
    s_waitcnt vmcnt(5)
    v_mfma_f32_16x16x32_bf16 v[190:193], v[142:145], a[148:151], v[190:193]
    v_cvt_pk_bf16_f32 v187, v187, v187
    v_cvt_pk_bf16_f32 v188, v188, v188
    v_mfma_f32_16x16x32_bf16 v[190:193], v[170:173], a[152:155], v[190:193]
    ds_read_b64 a[216:217], v114 offset:0
    ds_read_b64 a[218:219], v114 offset:1536
    v_mfma_f32_16x16x32_bf16 v[190:193], v[178:181], a[156:159], v[190:193]
    buffer_load_dwordx4 v131, s[52:55], 0 offen offset:2048 lds
    ds_read_b64 a[240:241], v114 offset:8
    v_mfma_f32_16x16x32_bf16 v[190:193], v[182:185], a[160:163], v[190:193]
    s_add_u32 s52, s52, 12288
    ds_read_b64 a[242:243], v114 offset:1544
    ds_read_b64 v[90:91], v254 offset:0
    v_mfma_f32_16x16x32_bf16 v[190:193], v[202:205], a[164:167], v[190:193]
    s_addc_u32 s53, s53, 0
    ds_read_b64 v[92:93], v254 offset:1536
    ds_read_b128 v[166:169], v0 offset:26624
    v_mfma_f32_16x16x32_bf16 v[194:197], v[134:137], a[168:171], 0
    s_add_u32 m0, s68, 3072
    ds_read_b128 v[206:209], v1 offset:26624
    v_cvt_pk_bf16_f32 v189, v189, v189
    v_mfma_f32_16x16x32_bf16 v[194:197], v[142:145], a[172:175], v[194:197]
    s_mul_i32 s68, s78, 72
    ds_read_b128 v[210:213], v0 offset:26752
    v_cvt_pk_bf16_f32 v198, v198, v198
    v_mfma_f32_16x16x32_bf16 v[194:197], v[170:173], a[176:179], v[194:197]
    s_sub_u32 s68, s77, s68
    ds_read_b128 v[214:217], v1 offset:26752
    buffer_load_dwordx4 v164, s[52:55], 0 offen lds
    v_mfma_f32_16x16x32_bf16 v[194:197], v[178:181], a[180:183], v[194:197]
    s_mul_i32 s78, s78, 1373568
    ds_read_b128 v[218:221], v0 offset:26880
    v_cvt_pk_bf16_f32 v199, v199, v199
    v_mfma_f32_16x16x32_bf16 v[194:197], v[182:185], a[184:187], v[194:197]
    s_mul_i32 s77, s68, 2688
    ds_read_b128 v[222:225], v1 offset:26880
    v_cvt_pk_bf16_f32 v200, v200, v200
    v_mfma_f32_16x16x32_bf16 v[194:197], v[202:205], a[188:191], v[194:197]
    s_add_u32 s77, s77, s78
    ds_write2_b32 v161, v186, v187 offset0:16 offset1:84
    v_mfma_f32_16x16x32_bf16 v[226:229], v[134:137], a[192:195], 0
    s_waitcnt lgkmcnt(7)
    v_cvt_pk_bf16_f32 v201, v201, v201
    v_cvt_pk_bf16_f32 v190, v190, v190
    v_mfma_f32_16x16x32_bf16 v[226:229], v[142:145], a[196:199], v[226:229]
    s_waitcnt lgkmcnt(5)
    ds_write2_b32 v161, v188, v189 offset0:152 offset1:220
    v_mfma_f32_16x16x32_bf16 v[226:229], v[170:173], a[200:203], v[226:229]
    s_waitcnt lgkmcnt(5)
    buffer_load_dwordx4 v165, s[52:55], 0 offen offset:1024 lds
    v_cvt_pk_bf16_f32 v191, v191, v191
    v_mfma_f32_16x16x32_bf16 v[226:229], v[178:181], a[204:207], v[226:229]
    s_waitcnt lgkmcnt(4)
    ds_write2_b32 v161, v198, v199 offset0:32 offset1:100
    v_mfma_f32_16x16x32_bf16 v[226:229], v[182:185], a[208:211], v[226:229]
    s_waitcnt lgkmcnt(4)
    s_waitcnt vmcnt(5)
    v_cvt_pk_bf16_f32 v192, v192, v192
    v_mfma_f32_16x16x32_bf16 v[226:229], v[202:205], a[212:215], v[226:229]
    s_waitcnt lgkmcnt(3)
    ds_read_b64 a[232:233], v114 offset:3072
    ds_read_b64 a[220:221], v114 offset:4608
    v_mfma_f32_16x16x32_bf16 v[134:137], a[0:3], v[166:169], 0
    ds_read_b64 v[82:83], v114 offset:3080
    ds_read_b64 a[244:245], v114 offset:4616
    v_mfma_f32_16x16x32_bf16 v[134:137], a[4:7], v[206:209], v[134:137]
    buffer_load_dwordx4 v131, s[52:55], 0 offen offset:2048 lds
    ds_read_b64 v[106:107], v254 offset:3072
    v_mfma_f32_16x16x32_bf16 v[134:137], a[8:11], v[210:213], v[134:137]
    s_add_u32 s52, s52, 12288
    ds_read_b64 v[94:95], v254 offset:4608
    v_cvt_pk_bf16_f32 v193, v193, v193
    v_mfma_f32_16x16x32_bf16 v[134:137], a[12:15], v[214:217], v[134:137]
    s_addc_u32 s53, s53, 0
    ds_write2_b32 v161, v200, v201 offset0:168 offset1:236
    v_mfma_f32_16x16x32_bf16 v[134:137], a[16:19], v[218:221], v[134:137]
    s_add_u32 m0, s69, 0
    v_cvt_pk_bf16_f32 v194, v194, v194
    v_cvt_pk_bf16_f32 v195, v195, v195
    v_mfma_f32_16x16x32_bf16 v[134:137], a[20:23], v[222:225], v[134:137]
    ds_write2_b32 v158, v190, v191 offset0:0 offset1:68
    v_mfma_f32_16x16x32_bf16 v[142:145], a[24:27], v[166:169], 0
    s_waitcnt lgkmcnt(6)
    buffer_load_dwordx4 v164, s[52:55], 0 offen lds
    v_cvt_pk_bf16_f32 v196, v196, v196
    v_mfma_f32_16x16x32_bf16 v[142:145], a[28:31], v[206:209], v[142:145]
    s_waitcnt lgkmcnt(4)
    ds_write2_b32 v158, v192, v193 offset0:136 offset1:204
    v_mfma_f32_16x16x32_bf16 v[142:145], a[32:35], v[210:213], v[142:145]
    s_waitcnt lgkmcnt(4)
    v_cvt_pk_bf16_f32 v197, v197, v197
    v_cvt_pk_bf16_f32 v226, v226, v226
    v_mfma_f32_16x16x32_bf16 v[142:145], a[36:39], v[214:217], v[142:145]
    s_waitcnt lgkmcnt(3)
    ds_write2_b32 v158, v194, v195 offset0:16 offset1:84
    v_mfma_f32_16x16x32_bf16 v[142:145], a[40:43], v[218:221], v[142:145]
    v_cvt_pk_bf16_f32 v227, v227, v227
    v_cvt_pk_bf16_f32 v228, v228, v228
    v_mfma_f32_16x16x32_bf16 v[142:145], a[44:47], v[222:225], v[142:145]
    buffer_load_dwordx4 v165, s[52:55], 0 offen offset:1024 lds
    v_cvt_pk_bf16_f32 v229, v229, v229
    v_mfma_f32_16x16x32_bf16 v[170:173], a[48:51], v[166:169], 0
    ds_write2_b32 v158, v196, v197 offset0:152 offset1:220
    v_mfma_f32_16x16x32_bf16 v[170:173], a[52:55], v[206:209], v[170:173]
    v_cvt_pk_f16_f32 v134, v134, v135
    v_pk_mul_f16 v174, v134, v134
    v_mfma_f32_16x16x32_bf16 v[170:173], a[56:59], v[210:213], v[170:173]
    ds_write2_b32 v158, v226, v227 offset0:32 offset1:100
    s_waitcnt vmcnt(5)
    v_mfma_f32_16x16x32_bf16 v[170:173], a[60:63], v[214:217], v[170:173]
    v_cvt_pk_f16_f32 v135, v136, v137
    v_pk_fma_f16 v174, v135, v135, v174
    v_mfma_f32_16x16x32_bf16 v[170:173], a[64:67], v[218:221], v[170:173]
    buffer_load_dwordx4 v131, s[52:55], 0 offen offset:2048 lds
    ds_read_b64 a[222:223], v130 offset:0
    v_mfma_f32_16x16x32_bf16 v[170:173], a[68:71], v[222:225], v[170:173]
    s_add_u32 s52, s52, 12288
    ds_read_b64 a[234:235], v130 offset:1536
    ds_read_b64 a[246:247], v130 offset:8
    v_mfma_f32_16x16x32_bf16 v[178:181], v[166:169], a[144:147], 0
    s_addc_u32 s53, s53, 0
    ds_read_b64 v[84:85], v130 offset:1544
    ds_read_b64 v[96:97], v133 offset:0
    v_mfma_f32_16x16x32_bf16 v[178:181], v[206:209], a[148:151], v[178:181]
    s_add_u32 m0, s69, 3072
    ds_read_b64 v[108:109], v133 offset:1536
    v_cvt_pk_f16_f32 v136, v142, v143
    v_mfma_f32_16x16x32_bf16 v[178:181], v[210:213], a[152:155], v[178:181]
    s_add_u32 s69, s77, 589824
    ds_write2_b32 v158, v228, v229 offset0:168 offset1:236
    v_mfma_f32_16x16x32_bf16 v[178:181], v[214:217], a[156:159], v[178:181]
    buffer_load_dwordx4 v164, s[52:55], 0 offen lds
    v_pk_fma_f16 v174, v136, v136, v174
    v_mfma_f32_16x16x32_bf16 v[178:181], v[218:221], a[160:163], v[178:181]
    v_cvt_pk_f16_f32 v137, v144, v145
    v_pk_fma_f16 v174, v137, v137, v174
    v_mfma_f32_16x16x32_bf16 v[178:181], v[222:225], a[164:167], v[178:181]
    ds_read_b128 v[142:145], v0 offset:20480
    v_cvt_pk_f16_f32 v122, v170, v171
    v_mfma_f32_16x16x32_bf16 v[182:185], v[166:169], a[168:171], 0
    s_waitcnt lgkmcnt(6)
    ds_read_b128 v[186:189], v1 offset:20480
    v_pk_fma_f16 v174, v122, v122, v174
    v_mfma_f32_16x16x32_bf16 v[182:185], v[206:209], a[172:175], v[182:185]
    s_waitcnt lgkmcnt(5)
    ds_read_b128 v[190:193], v0 offset:20608
    v_cvt_pk_f16_f32 v123, v172, v173
    v_mfma_f32_16x16x32_bf16 v[182:185], v[210:213], a[176:179], v[182:185]
    s_waitcnt lgkmcnt(4)
    ds_read_b128 v[170:173], v1 offset:20608
    buffer_load_dwordx4 v165, s[52:55], 0 offen offset:1024 lds
    v_mfma_f32_16x16x32_bf16 v[182:185], v[214:217], a[180:183], v[182:185]
    ds_read_b128 v[194:197], v0 offset:20736
    v_pk_fma_f16 v174, v123, v123, v174
    v_mfma_f32_16x16x32_bf16 v[182:185], v[218:221], a[184:187], v[182:185]
    ds_read_b128 v[198:201], v1 offset:20736
    v_mov_b32 v176, 0
    v_mfma_f32_16x16x32_bf16 v[182:185], v[222:225], a[188:191], v[182:185]
    v_mov_b32 v177, 0
    v_cvt_pk_bf16_f32 v204, v178, v179
    v_mfma_f32_16x16x32_bf16 v[226:229], v[166:169], a[192:195], 0
    v_cvt_pk_bf16_f32 v205, v180, v181
    s_waitcnt vmcnt(5)
    v_mfma_f32_16x16x32_f16 v[166:169], v[40:43], v[174:177], 0
    s_waitcnt lgkmcnt(5)
    ds_read_b64 a[224:225], v130 offset:3072
    ds_read_b64 a[226:227], v130 offset:4608
    v_mfma_f32_16x16x32_bf16 v[226:229], v[206:209], a[196:199], v[226:229]
    s_waitcnt lgkmcnt(6)
    buffer_load_dwordx4 v131, s[52:55], 0 offen offset:2048 lds
    ds_read_b64 a[248:249], v130 offset:3080
    v_mfma_f32_16x16x32_bf16 v[226:229], v[210:213], a[200:203], v[226:229]
    s_add_u32 m0, s28, 65536
    ds_read_b64 a[250:251], v130 offset:4616
    ds_read_b64 v[98:99], v133 offset:3072
    v_mfma_f32_16x16x32_bf16 v[226:229], v[214:217], a[204:207], v[226:229]
    s_waitcnt lgkmcnt(7)
    ds_read_b64 v[100:101], v133 offset:4608
    v_cvt_pk_bf16_f32 v168, v182, v183
    v_mfma_f32_16x16x32_bf16 v[226:229], v[218:221], a[208:211], v[226:229]
    s_waitcnt lgkmcnt(7)
    v_rsq_f32 v166, v166
    v_mfma_f32_16x16x32_bf16 v[226:229], v[222:225], a[212:215], v[226:229]
    s_waitcnt lgkmcnt(6)
    v_rsq_f32 v167, v167
    v_mfma_f32_16x16x32_bf16 v[174:177], v[142:145], a[144:147], 0
    v_mul_f32 v116, s31, v166
    v_cvt_pk_f16_f32 v117, v116, v167
    v_mfma_f32_16x16x32_bf16 v[174:177], v[186:189], a[148:151], v[174:177]
    buffer_load_dwordx4 v10, s[8:11], s24 offen nt lds
    v_mfma_f32_16x16x32_bf16 v[174:177], v[190:193], a[152:155], v[174:177]
    s_add_u32 m0, s28, 69632
    v_pk_mul_f16 v150, v150, v117 op_sel:[0,1] op_sel_hi:[1,1]
    v_pk_mul_f16 v151, v151, v117 op_sel:[0,1] op_sel_hi:[1,1]
    v_mfma_f32_16x16x32_bf16 v[174:177], v[170:173], a[156:159], v[174:177]
    s_waitcnt lgkmcnt(3)
    v_pk_mul_f16 v152, v152, v117 op_sel:[0,1] op_sel_hi:[1,1]
    v_pk_mul_f16 v153, v153, v117 op_sel:[0,1] op_sel_hi:[1,1]
    v_mfma_f32_16x16x32_bf16 v[174:177], v[194:197], a[160:163], v[174:177]
    s_waitcnt lgkmcnt(1)
    v_pk_mul_f16 v124, v124, v117 op_sel:[0,1] op_sel_hi:[1,1]
    v_pk_mul_f16 v125, v125, v117 op_sel:[0,1] op_sel_hi:[1,1]
    v_mfma_f32_16x16x32_bf16 v[174:177], v[198:201], a[164:167], v[174:177]
    s_waitcnt lgkmcnt(0)
    ds_read_b128 v[178:181], v0 offset:32768
    v_pk_mul_f16 v134, v134, v117 op_sel:[0,0] op_sel_hi:[1,0]
    v_mfma_f32_16x16x32_bf16 v[206:209], v[142:145], a[168:171], 0
    ds_read_b128 v[210:213], v1 offset:32768
    v_pk_mul_f16 v135, v135, v117 op_sel:[0,0] op_sel_hi:[1,0]
    v_mfma_f32_16x16x32_bf16 v[206:209], v[186:189], a[172:175], v[206:209]
    buffer_load_dwordx4 v11, s[8:11], s24 offen nt lds
    v_mfma_f32_16x16x32_bf16 v[206:209], v[190:193], a[176:179], v[206:209]
    s_add_u32 m0, s28, 73728
    ds_read_b128 v[214:217], v0 offset:32896
    ds_read_b128 v[218:221], v1 offset:32896
    v_mfma_f32_16x16x32_bf16 v[206:209], v[170:173], a[180:183], v[206:209]
    ds_read_b128 v[222:225], v0 offset:33024
    v_pk_mul_f16 v136, v136, v117 op_sel:[0,0] op_sel_hi:[1,0]
    v_mfma_f32_16x16x32_bf16 v[206:209], v[194:197], a[184:187], v[206:209]
    ds_read_b128 v[230:233], v1 offset:33024
    s_waitcnt vmcnt(5)
    v_mfma_f32_16x16x32_bf16 v[206:209], v[198:201], a[188:191], v[206:209]
    ds_read_b64 a[236:237], v114 offset:0
    ds_read_b64 a[228:229], v114 offset:1536
    v_mfma_f32_16x16x32_bf16 v[234:237], v[142:145], a[192:195], 0
    ds_read_b64 v[86:87], v114 offset:8
    ds_read_b64 a[252:253], v114 offset:1544
    v_mfma_f32_16x16x32_bf16 v[234:237], v[186:189], a[196:199], v[234:237]
    s_waitcnt lgkmcnt(9)
    buffer_load_dwordx4 v12, s[8:11], s24 offen nt lds
    v_mfma_f32_16x16x32_bf16 v[234:237], v[190:193], a[200:203], v[234:237]
    s_add_u32 m0, s28, 77824
    ds_read_b64 v[110:111], v254 offset:0
    ds_read_b64 v[102:103], v254 offset:1536
    v_mfma_f32_16x16x32_bf16 v[234:237], v[170:173], a[204:207], v[234:237]
    s_waitcnt lgkmcnt(10)
    ds_read_b128 v[142:145], v154 offset:0
    ds_read_b128 v[170:173], v154 offset:16
    v_mfma_f32_16x16x32_bf16 v[234:237], v[194:197], a[208:211], v[234:237]
    s_waitcnt lgkmcnt(10)
    ds_read_b128 v[186:189], v154 offset:48
    ds_read_b32 v158, v6 offset:192
    v_mfma_f32_16x16x32_bf16 v[234:237], v[198:201], a[212:215], v[234:237]
    s_waitcnt lgkmcnt(11)
    v_pk_mul_f16 v137, v137, v117 op_sel:[0,0] op_sel_hi:[1,0]
    v_pk_mul_f16 v122, v122, v117 op_sel:[0,0] op_sel_hi:[1,0]
    v_mfma_f32_16x16x32_bf16 v[190:193], a[0:3], v[178:181], 0
    s_waitcnt lgkmcnt(10)
    v_pk_mul_f16 v123, v123, v117 op_sel:[0,0] op_sel_hi:[1,0]
    v_max3_u32 v44, v44, v166, v167
    v_mfma_f32_16x16x32_bf16 v[190:193], a[4:7], v[210:213], v[190:193]
    s_waitcnt lgkmcnt(8)
    buffer_load_dwordx4 v13, s[8:11], s24 offen nt lds
    v_mfma_f32_16x16x32_bf16 v[190:193], a[8:11], v[214:217], v[190:193]
    s_add_u32 m0, s74, 0
    v_cvt_pk_bf16_f32 v169, v184, v185
    v_cvt_pk_bf16_f32 v184, v226, v227
    v_mfma_f32_16x16x32_bf16 v[190:193], a[12:15], v[218:221], v[190:193]
    s_waitcnt lgkmcnt(6)
    v_cvt_pk_bf16_f32 v185, v228, v229
    v_cvt_pk_bf16_f32 v202, v174, v175
    v_mfma_f32_16x16x32_bf16 v[190:193], a[16:19], v[222:225], v[190:193]
    s_waitcnt lgkmcnt(4)
    v_cvt_pk_bf16_f32 v203, v176, v177
    v_cvt_pk_bf16_f32 v166, v206, v207
    v_mfma_f32_16x16x32_bf16 v[190:193], a[20:23], v[230:233], v[190:193]
    s_waitcnt lgkmcnt(2)
    v_cvt_pk_bf16_f32 v167, v208, v209
    v_cvt_pk_bf16_f32 v182, v234, v235
    v_mfma_f32_16x16x32_bf16 v[174:177], a[24:27], v[178:181], 0
    s_waitcnt lgkmcnt(0)
    v_cvt_pk_bf16_f32 v183, v236, v237
    v_xor_b32 v0, 65536, v0
    v_mfma_f32_16x16x32_bf16 v[174:177], a[28:31], v[210:213], v[174:177]
    buffer_load_dwordx4 v14, s[8:11], s24 offen nt lds
    v_mfma_f32_16x16x32_bf16 v[174:177], a[32:35], v[214:217], v[174:177]
    s_add_u32 s8, s60, s23
    v_cvt_pk_f16_f32 v190, v190, v191
    s_waitcnt vmcnt(5)
    v_mfma_f32_16x16x32_bf16 v[174:177], a[36:39], v[218:221], v[174:177]
    s_addc_u32 s9, s61, 0
    ds_read_b64 a[230:231], v114 offset:3072
    ds_read_b64 a[238:239], v114 offset:4608
    v_mfma_f32_16x16x32_bf16 v[174:177], a[40:43], v[222:225], v[174:177]
    s_sub_u32 s10, s36, s23
    ds_read_b64 a[254:255], v114 offset:3080
    ds_read_b64 v[88:89], v114 offset:4616
    v_mfma_f32_16x16x32_bf16 v[174:177], a[44:47], v[230:233], v[174:177]
    s_cmp_lt_u32 s34, s17
    ds_read_b64 v[104:105], v254 offset:3072
    ds_read_b64 v[112:113], v254 offset:4608
    v_mfma_f32_16x16x32_bf16 v[194:197], a[48:51], v[178:181], 0
    s_cselect_b32 s10, s10, 0
    v_pk_mul_f16 v114, v190, v190
    v_cvt_pk_f16_f32 v191, v192, v193
    v_mfma_f32_16x16x32_bf16 v[194:197], a[52:55], v[210:213], v[194:197]
    s_add_u32 m0, s28, 0
    v_pk_fma_f16 v114, v191, v191, v114
    v_cvt_pk_f16_f32 v192, v174, v175
    v_mfma_f32_16x16x32_f16 v[198:201], v[146:149], v[138:141], v[46:49]
    s_mov_b32 s24, s23
    v_pk_fma_f16 v114, v192, v192, v114
    v_cvt_pk_f16_f32 v193, v176, v177
    v_mfma_f32_16x16x32_f16 v[174:177], v[150:153], v[138:141], v[50:53]
    s_add_u32 s23, s23, s21
    v_pk_fma_f16 v114, v193, v193, v114
    v_xor_b32 v1, 65536, v1
    v_add_u32 v159, 62784, v159
    v_mfma_f32_16x16x16_f16 v[198:201], v[120:121], v[118:119], v[198:201]
    v_or_b32 v206, v32, v33
    v_and_b32 v206, 0xffff, v206
    v_lshl_or_b32 v206, v206, 16, v206
    v_mfma_f32_16x16x16_f16 v[174:177], v[124:125], v[118:119], v[174:177]
    v_or_b32 v207, v32, v33
    v_and_b32 v207, 0xffff, v207
    v_lshl_or_b32 v207, v207, 16, v207
    v_or_b32 v208, v32, v33
    v_mfma_f32_16x16x32_bf16 v[194:197], a[56:59], v[214:217], v[194:197]
    s_cmp_ge_u32 s19, 72
    v_exp_f32 v198, v198
    v_mfma_f32_16x16x32_bf16 v[194:197], a[60:63], v[218:221], v[194:197]
    s_cselect_b32 s34, 72, 0
    v_exp_f32 v199, v199
    v_mfma_f32_16x16x32_bf16 v[194:197], a[64:67], v[222:225], v[194:197]
    s_cselect_b32 s35, s22, 0
    v_cvt_pk_bf16_f32 v198, v198, v199
    v_lshrrev_b32 v208, 16, v208
    v_mfma_f32_16x16x32_bf16 v[194:197], a[68:71], v[230:233], v[194:197]
    s_sub_u32 s19, s19, s34
    v_mov_b32 v116, 0
    v_mov_b32 v117, 0
    v_mfma_f32_16x16x32_bf16 v[226:229], v[178:181], a[144:147], 0
    s_add_u32 s23, s23, s35
    v_exp_f32 v200, v200
    v_mfma_f32_16x16x32_bf16 v[226:229], v[210:213], a[148:151], v[226:229]
    s_waitcnt lgkmcnt(0)
    v_cvt_pk_f16_f32 v154, v194, v195
    v_pk_fma_f16 v114, v154, v154, v114
    v_mfma_f32_16x16x32_bf16 v[226:229], v[214:217], a[152:155], v[226:229]
    v_cvt_pk_f16_f32 v155, v196, v197
    v_pk_fma_f16 v114, v155, v155, v114
    v_mfma_f32_16x16x32_bf16 v[226:229], v[218:221], a[156:159], v[226:229]
    v_exp_f32 v201, v201
    v_mfma_f32_16x16x32_f16 v[194:197], v[40:43], v[114:117], 0
    v_cvt_pk_bf16_f32 v199, v200, v201
    v_lshl_or_b32 v208, v208, 16, v208
    v_mfma_f32_16x16x32_f16 v[114:117], v[142:145], v[138:141], v[22:25]
    v_exp_f32 v174, v174
    v_mfma_f32_16x16x32_f16 v[114:117], v[170:173], v[146:149], v[114:117]
    v_exp_f32 v175, v175
    v_mfma_f32_16x16x32_f16 v[114:117], v[186:189], v[118:121], v[114:117]
    v_cvt_pk_bf16_f32 v200, v174, v175
    v_or_b32 v209, v32, v33
    v_mfma_f32_16x16x32_bf16 v[226:229], v[222:225], a[160:163], v[226:229]
    v_rsq_f32 v194, v194
    v_mfma_f32_16x16x32_bf16 v[226:229], v[230:233], a[164:167], v[226:229]
    v_rsq_f32 v195, v195
    v_mfma_f32_16x16x32_bf16 v[234:237], v[178:181], a[168:171], 0
    v_mul_f32 v164, s31, v194
    v_cvt_pk_f16_f32 v165, v164, v195
    v_mfma_f32_16x16x32_bf16 v[234:237], v[210:213], a[172:175], v[234:237]
    v_pk_mul_f16 v126, v126, v165 op_sel:[0,1] op_sel_hi:[1,1]
    v_pk_mul_f16 v127, v127, v165 op_sel:[0,1] op_sel_hi:[1,1]
    v_mfma_f32_16x16x32_bf16 v[234:237], v[214:217], a[176:179], v[234:237]
    v_pk_mul_f16 v128, v128, v165 op_sel:[0,1] op_sel_hi:[1,1]
    v_pk_mul_f16 v129, v129, v165 op_sel:[0,1] op_sel_hi:[1,1]
    v_mfma_f32_16x16x32_bf16 v[234:237], v[218:221], a[180:183], v[234:237]
    v_pk_mul_f16 v156, v156, v165 op_sel:[0,1] op_sel_hi:[1,1]
    v_pk_mul_f16 v157, v157, v165 op_sel:[0,1] op_sel_hi:[1,1]
    v_mfma_f32_16x16x32_bf16 v[234:237], v[222:225], a[184:187], v[234:237]
    v_pk_mul_f16 v190, v190, v165 op_sel:[0,0] op_sel_hi:[1,0]
    v_pk_mul_f16 v191, v191, v165 op_sel:[0,0] op_sel_hi:[1,0]
    v_mfma_f32_16x16x32_bf16 v[234:237], v[230:233], a[188:191], v[234:237]
    v_pk_mul_f16 v192, v192, v165 op_sel:[0,0] op_sel_hi:[1,0]
    v_pk_mul_f16 v193, v193, v165 op_sel:[0,0] op_sel_hi:[1,0]
    v_pk_mul_f16 v154, v154, v165 op_sel:[0,0] op_sel_hi:[1,0]
    v_pk_mul_f16 v155, v155, v165 op_sel:[0,0] op_sel_hi:[1,0]
    v_mfma_f32_16x16x32_f16 v[238:241], v[126:129], v[138:141], v[54:57]
    v_max3_u32 v44, v44, v194, v195
    v_cvt_pk_bf16_f32 v138, v226, v227
    v_mfma_f32_16x16x32_f16 v[194:197], v[142:145], v[134:137], v[24:27]
    v_cvt_pk_bf16_f32 v139, v228, v229
    v_cvt_pk_bf16_f32 v174, v234, v235
    v_mfma_f32_16x16x32_f16 v[194:197], v[170:173], v[150:153], v[194:197]
    v_cvt_pk_bf16_f32 v175, v236, v237
    v_mov_b32_dpp v158, v115 quad_perm:[0,1,2,3] row_mask:0x1 bank_mask:0xf
    v_mov_b32 v25, 0
    v_mfma_f32_16x16x16_f16 v[238:241], v[156:157], v[118:119], v[238:241]
    v_exp_f32 v176, v176
    v_exp_f32 v177, v177
    v_mfma_f32_16x16x32_f16 v[194:197], v[186:189], v[122:125], v[194:197]
    v_cvt_pk_bf16_f32 v201, v176, v177
    v_lshrrev_b32 v209, 16, v209
    v_mfma_f32_16x16x32_bf16 v[226:229], v[178:181], a[192:195], 0
    v_exp_f32 v114, v114
    v_mfma_f32_16x16x32_bf16 v[226:229], v[210:213], a[196:199], v[226:229]
    ds_read2_b32 v[140:141], v6 offset0:0 offset1:0
    ds_read2_b32 v[176:177], v6 offset0:16 offset1:16
    v_mfma_f32_16x16x32_bf16 v[226:229], v[214:217], a[200:203], v[226:229]
    ds_read2_b32 v[116:117], v6 offset0:32 offset1:32
    v_add_u32 v6, 272, v6
    v_mfma_f32_16x16x32_f16 v[178:181], v[142:145], v[190:193], v[26:29]
    v_mov_b32_dpp v158, v195 quad_perm:[0,1,2,3] row_mask:0x2 bank_mask:0xf
    v_cvt_pk_bf16_f32 v39, v114, 0
    v_mfma_f32_16x16x32_f16 v[178:181], v[170:173], v[126:129], v[178:181]
    v_exp_f32 v194, v194
    v_mfma_f32_16x16x32_f16 v[178:181], v[186:189], v[154:157], v[178:181]
    v_exp_f32 v238, v238
    v_mfma_f32_16x16x32_bf16 v[226:229], v[218:221], a[204:207], v[226:229]
    v_exp_f32 v239, v239
    v_mfma_f32_16x16x32_bf16 v[226:229], v[222:225], a[208:211], v[226:229]
    v_cvt_pk_bf16_f32 v36, v238, v239
    v_lshl_or_b32 v209, v209, 16, v209
    v_mfma_f32_16x16x32_bf16 v[226:229], v[230:233], a[212:215], v[226:229]
    v_exp_f32 v240, v240
    v_mfma_f32_16x16x32_f16 v[142:145], v[146:149], v[134:137], v[58:61]
    s_waitcnt lgkmcnt(1)
    v_mov_b32_dpp v158, v179 quad_perm:[0,1,2,3] row_mask:0x4 bank_mask:0xf
    v_xor_b32 v2, 65536, v2
    v_mfma_f32_16x16x32_f16 v[170:173], v[150:153], v[134:137], v[62:65]
    s_waitcnt lgkmcnt(0)
    v_exp_f32 v158, v158
    v_mfma_f32_16x16x32_f16 v[186:189], v[126:129], v[134:137], v[66:69]
    v_cvt_pk_bf16_f32 v114, v226, v227
    v_cvt_pk_bf16_f32 v115, v228, v229
    v_cvt_pk_bf16_f32 v158, v158, v158
    v_mfma_f32_16x16x16_f16 v[142:145], v[120:121], v[122:123], v[142:145]
    v_exp_f32 v241, v241
    v_mfma_f32_16x16x16_f16 v[170:173], v[124:125], v[122:123], v[170:173]
    ds_write_b16 v8, v158
    v_cvt_pk_bf16_f32 v37, v240, v241
    v_mfma_f32_16x16x16_f16 v[186:189], v[156:157], v[122:123], v[186:189]
    v_exp_f32 v178, v178
    v_mfma_f32_16x16x32_bf16 v[134:137], v[28:31], v[36:39], 0
    v_mfma_f32_16x16x32_bf16 v[134:137], v[28:31], v[198:201], v[134:137]
    v_exp_f32 v142, v142
    v_mfma_f32_16x16x32_bf16 v[210:213], v[138:141], v[36:39], 0
    v_exp_f32 v143, v143
    v_mfma_f32_16x16x32_bf16 v[210:213], v[202:205], v[198:201], v[210:213]
    v_exp_f32 v144, v144
    v_mfma_f32_16x16x32_bf16 v[214:217], v[174:177], v[36:39], 0
    v_exp_f32 v145, v145
    v_mfma_f32_16x16x32_bf16 v[214:217], v[166:169], v[198:201], v[214:217]
    v_cvt_pk_bf16_f32 v142, v142, v143
    v_cvt_pk_bf16_f32 v143, v144, v145
    v_mfma_f32_16x16x32_bf16 v[218:221], v[114:117], v[36:39], 0
    v_exp_f32 v170, v170
    v_mfma_f32_16x16x32_bf16 v[218:221], v[182:185], v[198:201], v[218:221]
    v_exp_f32 v171, v171
    v_mfma_f32_16x16x32_f16 v[198:201], v[146:149], v[190:193], v[70:73]
    v_cvt_pk_bf16_f32 v144, v170, v171
    v_cvt_pk_bf16_f32 v39, v194, 0
    v_mfma_f32_16x16x32_f16 v[146:149], v[150:153], v[190:193], v[74:77]
    v_exp_f32 v172, v172
    v_mfma_f32_16x16x32_f16 v[150:153], v[126:129], v[190:193], v[78:81]
    v_exp_f32 v173, v173
    v_mfma_f32_16x16x16_f16 v[198:201], v[120:121], v[154:155], v[198:201]
    v_cvt_pk_bf16_f32 v145, v172, v173
    v_exp_f32 v186, v186
    v_mfma_f32_16x16x16_f16 v[146:149], v[124:125], v[154:155], v[146:149]
    v_exp_f32 v187, v187
    v_mfma_f32_16x16x16_f16 v[150:153], v[156:157], v[154:155], v[150:153]
    v_cvt_pk_bf16_f32 v36, v186, v187
    v_exp_f32 v188, v188
    v_mfma_f32_16x16x32_bf16 v[118:121], v[206:209], a[216:219], 0
    v_exp_f32 v189, v189
    v_mfma_f32_16x16x32_bf16 v[118:121], v[206:209], a[240:243], v[118:121]
    v_rcp_f32 v134, v134
    v_mfma_f32_16x16x32_bf16 v[118:121], v[206:209], v[90:93], v[118:121]
    v_cvt_pk_bf16_f32 v37, v188, v189
    v_max3_u32 v25, v25, v134, v135
    v_mfma_f32_16x16x32_bf16 v[122:125], v[206:209], a[220:223], 0
    v_mul_f32 v210, v134, v210
    v_mul_f32 v211, v134, v211
    v_mfma_f32_16x16x32_bf16 v[126:129], v[28:31], v[36:39], 0
    v_cvt_pk_bf16_f32 v154, v210, v211
    v_mul_f32 v212, v134, v212
    v_mfma_f32_16x16x32_bf16 v[126:129], v[28:31], v[142:145], v[126:129]
    v_mov_b32 v254, v118
    v_mul_f32 v213, v134, v213
    v_mfma_f32_16x16x32_bf16 v[170:173], v[138:141], v[36:39], 0
    v_mov_b32_dpp v254, v119 quad_perm:[0,1,2,3] row_mask:0x2 bank_mask:0xf
    v_cvt_pk_bf16_f32 v155, v212, v213
    v_mfma_f32_16x16x32_bf16 v[170:173], v[202:205], v[142:145], v[170:173]
    v_mul_f32 v214, v134, v214
    v_mul_f32 v215, v134, v215
    v_mfma_f32_16x16x32_bf16 v[210:213], v[174:177], v[36:39], 0
    v_cvt_pk_bf16_f32 v156, v214, v215
    v_mul_f32 v216, v134, v216
    v_mfma_f32_16x16x32_bf16 v[210:213], v[166:169], v[142:145], v[210:213]
    v_mul_f32 v217, v134, v217
    v_cvt_pk_bf16_f32 v157, v216, v217
    v_mfma_f32_16x16x32_bf16 v[214:217], v[114:117], v[36:39], 0
    v_mul_f32 v218, v134, v218
    v_mul_f32 v219, v134, v219
    v_mfma_f32_16x16x32_bf16 v[214:217], v[182:185], v[142:145], v[214:217]
    v_cvt_pk_bf16_f32 v164, v218, v219
    v_mul_f32 v220, v134, v220
    v_mfma_f32_16x16x32_bf16 v[122:125], v[206:209], a[244:247], v[122:125]
    v_mul_f32 v221, v134, v221
    v_cvt_pk_bf16_f32 v165, v220, v221
    v_mfma_f32_16x16x32_bf16 v[122:125], v[206:209], v[94:97], v[122:125]
    v_exp_f32 v198, v198
    v_mfma_f32_16x16x32_bf16 v[118:121], v[206:209], a[232:235], 0
    v_exp_f32 v199, v199
    v_mfma_f32_16x16x32_bf16 v[118:121], v[206:209], v[82:85], v[118:121]
    v_cvt_pk_bf16_f32 v134, v198, v199
    v_cvt_pk_bf16_f32 v39, v178, 0
    v_mfma_f32_16x16x32_bf16 v[118:121], v[206:209], v[106:109], v[118:121]
    v_exp_f32 v200, v200
    v_mfma_f32_16x16x32_bf16 v[142:145], v[206:209], a[224:227], 0
    v_exp_f32 v201, v201
    v_mfma_f32_16x16x32_bf16 v[142:145], v[206:209], a[248:251], v[142:145]
    v_mov_b32 v137, v123
    v_cvt_pk_bf16_f32 v135, v200, v201
    v_mfma_f32_16x16x32_bf16 v[142:145], v[206:209], v[98:101], v[142:145]
    v_exp_f32 v146, v146
    v_mfma_f32_16x16x32_bf16 v[178:181], v[206:209], a[228:231], 0
    v_mov_b32_dpp v254, v118 quad_perm:[0,1,2,3] row_mask:0x4 bank_mask:0xf
    v_mov_b32_dpp v137, v119 quad_perm:[0,1,2,3] row_mask:0x2 bank_mask:0xf
    v_mfma_f32_16x16x32_bf16 v[178:181], v[206:209], a[252:255], v[178:181]
    v_exp_f32 v147, v147
    v_mfma_f32_16x16x32_bf16 v[178:181], v[206:209], v[102:105], v[178:181]
    v_mov_b32_dpp v254, v122 quad_perm:[0,1,2,3] row_mask:0x8 bank_mask:0xf
    v_mov_b32_dpp v137, v142 quad_perm:[0,1,2,3] row_mask:0x4 bank_mask:0xf
    v_mfma_f32_16x16x32_bf16 v[118:121], v[206:209], a[236:239], 0
    ds_write_b32 v160, v254 offset:18432
    v_mfma_f32_16x16x32_bf16 v[118:121], v[206:209], v[86:89], v[118:121]
    v_mov_b32_dpp v137, v143 quad_perm:[0,1,2,3] row_mask:0x8 bank_mask:0xf
    v_cvt_pk_bf16_f32 v136, v146, v147
    v_mfma_f32_16x16x32_bf16 v[118:121], v[206:209], v[110:113], v[118:121]
    ds_write_b32 v160, v137 offset:19456
    v_exp_f32 v148, v148
    v_exp_f32 v149, v149
    v_exp_f32 v150, v150
    v_cvt_pk_bf16_f32 v137, v148, v149
    v_exp_f32 v151, v151
    v_exp_f32 v152, v152
    v_cvt_pk_bf16_f32 v36, v150, v151
    v_mov_b32 v254, v118
    v_exp_f32 v153, v153
    ds_read_b128 v[122:125], v9
    ds_read_b128 v[142:145], v9 offset:64
    v_mov_b32_dpp v254, v178 quad_perm:[0,1,2,3] row_mask:0x2 bank_mask:0xf
    v_cvt_pk_bf16_f32 v37, v152, v153
    v_rcp_f32 v126, v126
    v_mov_b32_dpp v254, v179 quad_perm:[0,1,2,3] row_mask:0x4 bank_mask:0xf
    v_mfma_f32_16x16x32_bf16 v[146:149], v[28:31], v[36:39], 0
    v_max3_u32 v25, v25, v126, v127
    v_mov_b32_dpp v254, v119 quad_perm:[0,1,2,3] row_mask:0x8 bank_mask:0xf
    v_mfma_f32_16x16x32_bf16 v[146:149], v[28:31], v[134:137], v[146:149]
    ds_write_b32 v160, v254 offset:63552
    v_mfma_f32_16x16x32_bf16 v[118:121], v[138:141], v[36:39], 0
    v_mul_f32 v170, v126, v170
    v_mul_f32 v171, v126, v171
    v_mfma_f32_16x16x32_bf16 v[118:121], v[202:205], v[134:137], v[118:121]
    v_cvt_pk_bf16_f32 v130, v170, v171
    v_mul_f32 v172, v126, v172
    v_mfma_f32_16x16x32_bf16 v[150:153], v[174:177], v[36:39], 0
    v_rcp_f32 v146, v146
    v_mfma_f32_16x16x32_bf16 v[150:153], v[166:169], v[134:137], v[150:153]
    s_waitcnt lgkmcnt(2)
    v_max3_u32 v25, v25, v146, v147
    v_mul_f32 v173, v126, v173
    v_mfma_f32_16x16x32_bf16 v[178:181], v[122:125], v[28:31], 0
    s_waitcnt lgkmcnt(1)
    v_mul_f32 v118, v146, v118
    v_mul_f32 v119, v146, v119
    v_mfma_f32_16x16x32_bf16 v[178:181], v[142:145], v[28:31], v[178:181]
    v_cvt_pk_bf16_f32 v206, v118, v119
    v_mul_f32 v120, v146, v120
    v_mfma_f32_16x16x32_bf16 v[218:221], v[122:125], v[202:205], 0
    v_mul_f32 v121, v146, v121
    v_cvt_pk_bf16_f32 v207, v120, v121
    v_mfma_f32_16x16x32_bf16 v[218:221], v[142:145], v[138:141], v[218:221]
    s_waitcnt lgkmcnt(0)
    v_mul_f32 v150, v146, v150
    v_mul_f32 v151, v146, v151
    v_mfma_f32_16x16x32_bf16 v[138:141], v[122:125], v[166:169], 0
    s_barrier
    s_waitcnt vmcnt(0)
    ds_read_b128 v[166:169], v255 offset:18432
    v_mfma_f32_16x16x32_bf16 v[138:141], v[142:145], v[174:177], v[138:141]
    s_barrier
    ds_read_b128 v[186:189], v0 offset:20480
    ds_read_b128 v[194:197], v1 offset:20480
    v_mfma_f32_16x16x32_bf16 v[174:177], v[122:125], v[182:185], 0
    ds_read_b128 v[122:125], v0 offset:20608
    buffer_load_dwordx4 v10, s[8:11], 0 offen nt lds
    v_mfma_f32_16x16x32_bf16 v[174:177], v[142:145], v[114:117], v[174:177]
    s_add_u32 m0, s28, 4096
    ds_read_b128 v[202:205], v1 offset:20608
    v_cvt_pk_bf16_f32 v208, v150, v151
    v_mfma_f32_16x16x32_bf16 v[142:145], v[114:117], v[36:39], 0
    ds_read_b128 v[230:233], v0 offset:20736
    v_mul_f32 v152, v146, v152
    v_mfma_f32_16x16x32_bf16 v[142:145], v[182:185], v[134:137], v[142:145]
    ds_read_b128 v[238:241], v1 offset:20736
    ds_read_b128 v[114:117], v255 offset:19456
    ds_read_b128 v[134:137], v255 offset:63552
    ds_write_b128 v3, v[154:157] offset:0
    s_waitcnt lgkmcnt(7)
    v_mfma_f32_16x16x32_bf16 v[118:121], a[72:75], v[186:189], 0
    s_waitcnt lgkmcnt(6)
    buffer_load_dwordx4 v11, s[8:11], 0 offen nt lds
    v_add_f32 v166, v166, v167
    v_mfma_f32_16x16x32_bf16 v[118:121], a[76:79], v[194:197], v[118:121]
    s_add_u32 m0, s28, 8192
    v_add_f32 v168, v168, v169
    v_add_f32 v166, v166, v168
    v_mfma_f32_16x16x32_bf16 v[118:121], a[80:83], v[122:125], v[118:121]
    s_waitcnt lgkmcnt(4)
    ds_write_b64 v4, v[164:165] offset:4096
    v_mfma_f32_16x16x32_bf16 v[118:121], a[84:87], v[202:205], v[118:121]
    s_waitcnt lgkmcnt(3)
    v_mul_f32 v166, 0xbbaaaaab, v166
    v_add_f32 v114, v114, v115
    v_mfma_f32_16x16x32_bf16 v[118:121], a[88:91], v[230:233], v[118:121]
    s_waitcnt lgkmcnt(2)
    ds_write_b32 v132, v166 offset:0
    v_mfma_f32_16x16x32_bf16 v[118:121], a[92:95], v[238:241], v[118:121]
    buffer_load_dwordx4 v12, s[8:11], 0 offen nt lds
    v_add_f32 v116, v116, v117
    v_mfma_f32_16x16x32_bf16 v[190:193], a[96:99], v[186:189], 0
    s_add_u32 m0, s28, 12288
    ds_read_b128 v[154:157], v159 offset:0
    ds_read_b128 v[166:169], v159 offset:64
    v_mfma_f32_16x16x32_bf16 v[190:193], a[100:103], v[194:197], v[190:193]
    s_xor_b32 s28, s28, 65536
    ds_read_b128 v[182:185], v159 offset:128
    ds_read_b128 v[222:225], v159 offset:192
    v_mfma_f32_16x16x32_bf16 v[190:193], a[104:107], v[122:125], v[190:193]
    v_add_f32 v114, v114, v116
    v_mul_f32 v114, 0xbbaaaaab, v114
    v_mfma_f32_16x16x32_bf16 v[190:193], a[108:111], v[202:205], v[190:193]
    ds_write_b32 v132, v114 offset:256
    v_mfma_f32_16x16x32_bf16 v[190:193], a[112:115], v[230:233], v[190:193]
    v_add_f32 v134, v134, v135
    v_add_f32 v136, v136, v137
    v_mfma_f32_16x16x32_bf16 v[190:193], a[116:119], v[238:241], v[190:193]
    buffer_load_dwordx4 v13, s[8:11], 0 offen nt lds
    v_add_f32 v134, v134, v136
    v_mfma_f32_16x16x32_bf16 v[198:201], a[120:123], v[186:189], 0
    s_mov_b32 m0, s29
    v_mul_f32 v134, 0xbbaaaaab, v134
    v_mul_f32 v153, v146, v153
    v_mfma_f32_16x16x32_bf16 v[198:201], a[124:127], v[194:197], v[198:201]
    s_xor_b32 s29, s29, s30
    ds_write_b32 v132, v134 offset:512
    v_mfma_f32_16x16x32_bf16 v[198:201], a[128:131], v[122:125], v[198:201]
    s_waitcnt lgkmcnt(4)
    v_rcp_f32 v178, v178
    v_cvt_pk_bf16_f32 v209, v152, v153
    v_mfma_f32_16x16x16_bf16 v[114:117], a[216:217], v[162:163], v[154:157]
    v_max3_u32 v25, v25, v178, v179
    v_mul_f32 v218, v218, v178
    v_mul_f32 v142, v146, v142
    v_mfma_f32_16x16x16_bf16 v[134:137], a[240:241], v[162:163], v[154:157]
    v_mul_f32_dpp v218, v138, v178 quad_perm:[0,1,2,3] row_mask:0x2 bank_mask:0xf
    v_mul_f32 v143, v146, v143
    v_cvt_pk_bf16_f32 v164, v142, v143
    v_mfma_f32_16x16x16_bf16 v[138:141], v[90:91], v[162:163], v[154:157]
    v_cvt_pk_bf16_f32 v114, v114, v115
    v_accvgpr_write_b32 a216, v114
    v_cvt_pk_bf16_f32 v116, v116, v117
    v_mfma_f32_16x16x16_bf16 v[150:153], a[218:219], v[162:163], v[166:169]
    v_accvgpr_write_b32 a217, v116
    v_cvt_pk_bf16_f32 v134, v134, v135
    v_accvgpr_write_b32 a240, v134
    v_mfma_f32_16x16x16_bf16 v[114:117], a[242:243], v[162:163], v[166:169]
    v_cvt_pk_bf16_f32 v136, v136, v137
    v_accvgpr_write_b32 a241, v136
    v_cvt_pk_bf16_f32 v90, v138, v139
    v_mfma_f32_16x16x16_bf16 v[134:137], v[92:93], v[162:163], v[166:169]
    v_cvt_pk_bf16_f32 v91, v140, v141
    v_cvt_pk_bf16_f32 v150, v150, v151
    v_accvgpr_write_b32 a218, v150
    v_cvt_pk_bf16_f32 v152, v152, v153
    v_mfma_f32_16x16x32_bf16 v[198:201], a[132:135], v[202:205], v[198:201]
    s_waitcnt lgkmcnt(0)
    buffer_load_dwordx4 v14, s[8:11], 0 offen nt lds
    ds_read_b128 v[138:141], v159 offset:256
    v_accvgpr_write_b32 a219, v152
    v_mfma_f32_16x16x16_bf16 v[150:153], a[232:233], v[162:163], v[182:185]
    v_cvt_pk_bf16_f32 v114, v114, v115
    v_accvgpr_write_b32 a242, v114
    v_cvt_pk_bf16_f32 v116, v116, v117
    v_mfma_f32_16x16x16_bf16 v[154:157], v[82:83], v[162:163], v[182:185]
    v_accvgpr_write_b32 a243, v116
    v_cvt_pk_bf16_f32 v92, v134, v135
    v_cvt_pk_bf16_f32 v93, v136, v137
    v_mfma_f32_16x16x16_bf16 v[114:117], v[106:107], v[162:163], v[182:185]
    v_cvt_pk_bf16_f32 v150, v150, v151
    v_accvgpr_write_b32 a232, v150
    v_cvt_pk_bf16_f32 v152, v152, v153
    v_mfma_f32_16x16x16_bf16 v[134:137], a[220:221], v[162:163], v[222:225]
    v_accvgpr_write_b32 a233, v152
    v_cvt_pk_bf16_f32 v82, v154, v155
    v_cvt_pk_bf16_f32 v83, v156, v157
    v_mfma_f32_16x16x16_bf16 v[150:153], a[244:245], v[162:163], v[222:225]
    v_cvt_pk_bf16_f32 v106, v114, v115
    v_cvt_pk_bf16_f32 v107, v116, v117
    v_mul_f32_dpp v218, v174, v178 quad_perm:[0,1,2,3] row_mask:0x4 bank_mask:0xf
    v_mfma_f32_16x16x16_bf16 v[114:117], v[94:95], v[162:163], v[222:225]
    v_cvt_pk_bf16_f32 v134, v134, v135
    v_accvgpr_write_b32 a220, v134
    v_cvt_pk_bf16_f32 v136, v136, v137
    v_accvgpr_write_b32 a221, v136
    v_mfma_f32_16x16x32_bf16 v[198:201], a[136:139], v[230:233], v[198:201]
    s_waitcnt lgkmcnt(0)
    ds_read_b128 v[134:137], v159 offset:320
    ds_read_b128 v[154:157], v159 offset:384
    v_cvt_pk_bf16_f32 v150, v150, v151
    v_mfma_f32_16x16x16_bf16 v[166:169], a[222:223], v[162:163], v[138:141]
    v_accvgpr_write_b32 a244, v150
    v_cvt_pk_bf16_f32 v152, v152, v153
    v_accvgpr_write_b32 a245, v152
    v_mfma_f32_16x16x16_bf16 v[150:153], a[246:247], v[162:163], v[138:141]
    v_cvt_pk_bf16_f32 v94, v114, v115
    v_cvt_pk_bf16_f32 v95, v116, v117
    v_cvt_pk_bf16_f32 v218, v218, v218
    v_mfma_f32_16x16x16_bf16 v[114:117], v[96:97], v[162:163], v[138:141]
    v_cvt_pk_bf16_f32 v166, v166, v167
    v_accvgpr_write_b32 a222, v166
    v_cvt_pk_bf16_f32 v168, v168, v169
    v_accvgpr_write_b32 a223, v168
    v_mfma_f32_16x16x32_bf16 v[198:201], a[140:143], v[238:241], v[198:201]
    ds_read_b128 v[166:169], v159 offset:448
    v_cvt_pk_bf16_f32 v150, v150, v151
    v_mfma_f32_16x16x32_bf16 v[138:141], a[0:3], v[186:189], 0
    ds_write_b128 v3, v[206:209] offset:12288
    v_mfma_f32_16x16x32_bf16 v[138:141], a[4:7], v[194:197], v[138:141]
    s_waitcnt lgkmcnt(3)
    v_accvgpr_write_b32 a246, v150
    v_cvt_pk_bf16_f32 v152, v152, v153
    v_accvgpr_write_b32 a247, v152
    v_mfma_f32_16x16x16_bf16 v[150:153], a[234:235], v[162:163], v[134:137]
    v_cvt_pk_bf16_f32 v96, v114, v115
    v_cvt_pk_bf16_f32 v97, v116, v117
    v_mul_f32 v144, v146, v144
    v_mfma_f32_16x16x16_bf16 v[114:117], v[84:85], v[162:163], v[134:137]
    v_mul_f32 v145, v146, v145
    v_cvt_pk_bf16_f32 v165, v144, v145
    v_cvt_pk_bf16_f32 v131, v172, v173
    v_mfma_f32_16x16x16_bf16 v[142:145], v[108:109], v[162:163], v[134:137]
    v_cvt_pk_bf16_f32 v150, v150, v151
    v_accvgpr_write_b32 a234, v150
    v_cvt_pk_bf16_f32 v152, v152, v153
    v_accvgpr_write_b32 a235, v152
    v_mfma_f32_16x16x32_bf16 v[138:141], a[8:11], v[122:125], v[138:141]
    s_waitcnt lgkmcnt(1)
    ds_read_b128 v[134:137], v159 offset:512
    ds_write_b64 v4, v[164:165] offset:16384
    v_mfma_f32_16x16x16_bf16 v[146:149], a[224:225], v[162:163], v[154:157]
    v_cvt_pk_bf16_f32 v84, v114, v115
    v_cvt_pk_bf16_f32 v85, v116, v117
    v_cvt_pk_bf16_f32 v108, v142, v143
    v_mfma_f32_16x16x16_bf16 v[114:117], a[248:249], v[162:163], v[154:157]
    v_cvt_pk_bf16_f32 v109, v144, v145
    v_mul_f32 v210, v126, v210
    v_mul_f32 v211, v126, v211
    v_mfma_f32_16x16x16_bf16 v[142:145], v[98:99], v[162:163], v[154:157]
    v_cvt_pk_bf16_f32 v146, v146, v147
    v_accvgpr_write_b32 a224, v146
    v_cvt_pk_bf16_f32 v148, v148, v149
    v_mfma_f32_16x16x16_bf16 v[150:153], a[226:227], v[162:163], v[166:169]
    v_accvgpr_write_b32 a225, v148
    v_cvt_pk_bf16_f32 v114, v114, v115
    v_accvgpr_write_b32 a248, v114
    v_mfma_f32_16x16x16_bf16 v[146:149], a[250:251], v[162:163], v[166:169]
    v_cvt_pk_bf16_f32 v116, v116, v117
    v_accvgpr_write_b32 a249, v116
    v_cvt_pk_bf16_f32 v98, v142, v143
    v_mfma_f32_16x16x16_bf16 v[114:117], v[100:101], v[162:163], v[166:169]
    v_cvt_pk_bf16_f32 v99, v144, v145
    v_cvt_pk_bf16_f32 v150, v150, v151
    v_accvgpr_write_b32 a226, v150
    v_cvt_pk_bf16_f32 v152, v152, v153
    v_mfma_f32_16x16x32_bf16 v[138:141], a[12:15], v[202:205], v[138:141]
    s_waitcnt lgkmcnt(0)
    ds_read_b128 v[142:145], v159 offset:576
    ds_read_b128 v[154:157], v159 offset:640
    v_accvgpr_write_b32 a227, v152
    v_mfma_f32_16x16x16_bf16 v[150:153], a[236:237], v[162:163], v[134:137]
    v_cvt_pk_bf16_f32 v146, v146, v147
    v_accvgpr_write_b32 a250, v146
    v_cvt_pk_bf16_f32 v148, v148, v149
    v_mfma_f32_16x16x16_bf16 v[170:173], v[86:87], v[162:163], v[134:137]
    v_accvgpr_write_b32 a251, v148
    v_cvt_pk_bf16_f32 v100, v114, v115
    v_cvt_pk_bf16_f32 v101, v116, v117
    v_mfma_f32_16x16x16_bf16 v[114:117], v[110:111], v[162:163], v[134:137]
    v_cvt_pk_bf16_f32 v150, v150, v151
    v_accvgpr_write_b32 a236, v150
    v_cvt_pk_bf16_f32 v152, v152, v153
    v_accvgpr_write_b32 a237, v152
    v_mfma_f32_16x16x32_bf16 v[138:141], a[16:19], v[230:233], v[138:141]
    ds_read_b128 v[134:137], v159 offset:704
    v_cvt_pk_bf16_f32 v86, v170, v171
    v_mfma_f32_16x16x32_bf16 v[138:141], a[20:23], v[238:241], v[138:141]
    ds_write_b16 v7, v218
    v_mfma_f32_16x16x32_bf16 v[166:169], a[24:27], v[186:189], 0
    v_add_u32 v7, 16, v7
    v_cvt_pk_bf16_f32 v87, v172, v173
    v_mfma_f32_16x16x32_bf16 v[166:169], a[28:31], v[194:197], v[166:169]
    s_waitcnt lgkmcnt(2)
    v_cvt_pk_bf16_f32 v110, v114, v115
    v_cvt_pk_bf16_f32 v111, v116, v117
    v_cvt_pk_bf16_f32 v132, v210, v211
    v_mfma_f32_16x16x16_bf16 v[114:117], a[228:229], v[162:163], v[142:145]
    v_mul_f32 v212, v126, v212
    v_mul_f32 v213, v126, v213
    v_cvt_pk_bf16_f32 v133, v212, v213
    v_mfma_f32_16x16x16_bf16 v[146:149], a[252:253], v[162:163], v[142:145]
    v_mul_f32 v214, v126, v214
    v_mul_f32 v215, v126, v215
    v_cvt_pk_bf16_f32 v254, v214, v215
    v_mfma_f32_16x16x16_bf16 v[150:153], v[102:103], v[162:163], v[142:145]
    v_cvt_pk_bf16_f32 v114, v114, v115
    v_accvgpr_write_b32 a228, v114
    v_cvt_pk_bf16_f32 v116, v116, v117
    v_mfma_f32_16x16x16_bf16 v[158:161], a[230:231], v[162:163], v[154:157]
    v_accvgpr_write_b32 a229, v116
    v_cvt_pk_bf16_f32 v146, v146, v147
    v_accvgpr_write_b32 a252, v146
    v_mfma_f32_16x16x16_bf16 v[114:117], a[254:255], v[162:163], v[154:157]
    v_cvt_pk_bf16_f32 v148, v148, v149
    v_accvgpr_write_b32 a253, v148
    v_cvt_pk_bf16_f32 v102, v150, v151
    v_mfma_f32_16x16x16_bf16 v[142:145], v[104:105], v[162:163], v[154:157]
    v_cvt_pk_bf16_f32 v103, v152, v153
    v_cvt_pk_bf16_f32 v158, v158, v159
    v_accvgpr_write_b32 a230, v158
    v_cvt_pk_bf16_f32 v160, v160, v161
    v_mfma_f32_16x16x32_bf16 v[166:169], a[32:35], v[122:125], v[166:169]
    s_waitcnt lgkmcnt(0)
    ds_write_b128 v3, v[130:133] offset:6144
    v_mfma_f32_16x16x16_bf16 v[130:133], a[238:239], v[162:163], v[134:137]
    v_accvgpr_write_b32 a231, v160
    v_cvt_pk_bf16_f32 v114, v114, v115
    v_accvgpr_write_b32 a254, v114
    v_mfma_f32_16x16x16_bf16 v[146:149], v[88:89], v[162:163], v[134:137]
    v_cvt_pk_bf16_f32 v116, v116, v117
    v_accvgpr_write_b32 a255, v116
    v_cvt_pk_bf16_f32 v104, v142, v143
    v_mfma_f32_16x16x16_bf16 v[114:117], v[112:113], v[162:163], v[134:137]
    v_cvt_pk_bf16_f32 v105, v144, v145
    v_cvt_pk_bf16_f32 v130, v130, v131
    v_accvgpr_write_b32 a238, v130
    v_cvt_pk_bf16_f32 v132, v132, v133
    v_mfma_f32_16x16x32_bf16 v[166:169], a[36:39], v[202:205], v[166:169]
    v_accvgpr_write_b32 a239, v132
    v_cvt_pk_bf16_f32 v88, v146, v147
    v_mfma_f32_16x16x32_bf16 v[166:169], a[40:43], v[230:233], v[166:169]
    v_cvt_pk_bf16_f32 v89, v148, v149
    v_cvt_pk_bf16_f32 v112, v114, v115
    v_mfma_f32_16x16x32_bf16 v[166:169], a[44:47], v[238:241], v[166:169]
    v_cvt_pk_bf16_f32 v113, v116, v117
    v_mul_f32 v216, v126, v216
    v_mfma_f32_16x16x32_bf16 v[134:137], a[48:51], v[186:189], 0
    v_mul_f32 v217, v126, v217
    v_cvt_pk_bf16_f32 v255, v216, v217
    v_mfma_f32_16x16x32_bf16 v[134:137], a[52:55], v[194:197], v[134:137]
    ds_write_b64 v4, v[254:255] offset:10240
    v_cvt_pk_f16_f32 v146, v118, v119
    v_pk_mul_f16 v143, v146, v146
    v_cvt_pk_f16_f32 v147, v120, v121
    v_pk_fma_f16 v143, v147, v147, v143
    v_cvt_pk_f16_f32 v148, v190, v191
    v_pk_fma_f16 v143, v148, v148, v143
    v_cvt_pk_f16_f32 v149, v192, v193
    v_pk_fma_f16 v143, v149, v149, v143
    v_cvt_pk_f16_f32 v120, v198, v199
    v_pk_fma_f16 v143, v120, v120, v143
    v_cvt_pk_f16_f32 v121, v200, v201
    v_pk_fma_f16 v143, v121, v121, v143
    v_xor_b32 v3, 65536, v3
    v_xor_b32 v4, 65536, v4
    s_waitcnt lgkmcnt(0)
    s_barrier
L_go:
    s_waitcnt lgkmcnt(0)
    s_and_b32 s3, s2, 0xf8
    s_add_u32 s64, s42, s3
    s_addc_u32 s65, s43, 0
    s_mov_b32 s67, 0x00020000
    s_cmp_eq_u32 s16, 1
    s_cbranch_scc1 L_loop_fast1
    s_cmp_eq_u32 s16, 2
    s_cbranch_scc1 L_loop_fast2
    s_cmp_eq_u32 s16, 3
    s_cbranch_scc1 L_loop_fast3
    s_branch L_loop_fast0
.p2align 6
L_loop_fast0:
    v_mfma_f32_16x16x32_bf16 v[134:137], a[56:59], v[122:125], v[134:137]
    s_add_u32 s12, s40, s27
    ds_read_b128 v[190:193], v2 offset:18432
    v_cvt_pk_f16_f32 v150, v138, v139
    v_mfma_f32_16x16x32_bf16 v[134:137], a[60:63], v[202:205], v[134:137]
    s_addc_u32 s13, s41, 0
    ds_read_b128 v[210:213], v2 offset:19456
    v_pk_mul_f16 v142, v150, v150
    v_mfma_f32_16x16x32_bf16 v[134:137], a[64:67], v[230:233], v[134:137]
    s_sub_u32 s14, s36, s27
    ds_read_b128 v[174:177], v5 offset:32
    v_cvt_pk_f16_f32 v151, v140, v141
    v_mfma_f32_16x16x32_bf16 v[134:137], a[68:71], v[238:241], v[134:137]
    s_cmp_ge_u32 s18, 2
    ds_read2_b64 v[162:165], v5 offset0:6 offset1:9
    v_pk_fma_f16 v142, v151, v151, v142
    v_mfma_f32_16x16x32_bf16 v[138:141], v[186:189], a[144:147], 0
    s_cselect_b32 s14, s14, 0
    ds_read_b128 v[170:173], v5
    v_cvt_pk_f16_f32 v152, v166, v167
    v_mfma_f32_16x16x32_bf16 v[138:141], v[194:197], a[148:151], v[138:141]
    s_sub_u32 s82, s72, s71
    ds_read_b32 v254, v6 offset:192
    v_pk_fma_f16 v142, v152, v152, v142
    v_mfma_f32_16x16x32_bf16 v[138:141], v[122:125], a[152:155], v[138:141]
    s_mul_i32 s74, s82, 336
    v_cvt_pk_f16_f32 v153, v168, v169
    v_pk_fma_f16 v142, v153, v153, v142
    v_mfma_f32_16x16x32_bf16 v[138:141], v[202:205], a[156:159], v[138:141]
    s_mul_i32 s75, s82, 272
    v_cvt_pk_f16_f32 v118, v134, v135
    v_pk_fma_f16 v142, v118, v118, v142
    v_mfma_f32_16x16x32_bf16 v[138:141], v[230:233], a[160:163], v[138:141]
    s_waitcnt lgkmcnt(5)
    ds_read_b128 v[182:185], v0 offset:26624
    v_cvt_pk_f16_f32 v119, v136, v137
    v_mfma_f32_16x16x32_bf16 v[166:169], v[32:35], v[190:193], 0
    s_waitcnt lgkmcnt(5)
    v_pk_fma_f16 v142, v119, v119, v142
    v_add_u32 v5, s74, v5
    v_mfma_f32_16x16x32_bf16 v[166:169], v[32:35], v[210:213], v[166:169]
    s_waitcnt lgkmcnt(4)
    v_pk_mul_f16 v145, v146, v174
    v_pk_fma_f16 v145, v147, v175, v145
    v_mfma_f32_16x16x32_bf16 v[138:141], v[238:241], a[164:167], v[138:141]
    s_mul_i32 s76, s82, 16
    ds_read_b128 v[210:213], v1 offset:26624
    v_pk_fma_f16 v145, v148, v176, v145
    v_mfma_f32_16x16x32_bf16 v[214:217], v[186:189], a[168:171], 0
    s_waitcnt lgkmcnt(3)
    ds_read_b128 v[218:221], v0 offset:26752
    v_pk_fma_f16 v145, v149, v177, v145
    v_mfma_f32_16x16x32_bf16 v[214:217], v[194:197], a[172:175], v[214:217]
    s_waitcnt lgkmcnt(3)
    ds_read_b128 v[222:225], v1 offset:26752
    v_mov_b32_dpp v254, v23 quad_perm:[0,1,2,3] row_mask:0x7 bank_mask:0xf
    v_mfma_f32_16x16x32_bf16 v[214:217], v[122:125], a[176:179], v[214:217]
    s_add_u32 s34, s18, 2
    ds_read_b128 v[226:229], v0 offset:26880
    v_pk_fma_f16 v145, v120, v164, v145
    v_mfma_f32_16x16x32_bf16 v[214:217], v[202:205], a[180:183], v[214:217]
    s_add_u32 s8, s60, s23
    ds_read_b128 v[190:193], v1 offset:26880
    v_pk_fma_f16 v145, v121, v165, v145
    v_mfma_f32_16x16x32_bf16 v[214:217], v[230:233], a[184:187], v[214:217]
    s_waitcnt lgkmcnt(5)
    v_pk_mul_f16 v144, v150, v170
    v_pk_fma_f16 v144, v151, v171, v144
    v_mfma_f32_16x16x32_bf16 v[214:217], v[238:241], a[188:191], v[214:217]
    s_addc_u32 s9, s61, 0
    v_pk_fma_f16 v144, v152, v172, v144
    v_pk_fma_f16 v144, v153, v173, v144
    v_mfma_f32_16x16x32_bf16 v[246:249], v[186:189], a[192:195], 0
    s_sub_u32 s10, s36, s23
    v_pk_fma_f16 v144, v118, v162, v144
    v_pk_fma_f16 v144, v119, v163, v144
    v_mfma_f32_16x16x32_bf16 v[246:249], v[194:197], a[196:199], v[246:249]
    s_cmp_le_u32 s34, s45
    v_cvt_pk_bf16_f32 v134, v138, v139
    v_cvt_pk_bf16_f32 v135, v140, v141
    v_mfma_f32_16x16x32_f16 v[234:237], v[40:43], v[142:145], 0
    s_cselect_b32 s10, s10, 0
    v_cvt_pk_bf16_f32 v138, v214, v215
    v_cvt_pk_bf16_f32 v139, v216, v217
    v_mfma_f32_16x16x32_bf16 v[246:249], v[122:125], a[200:203], v[246:249]
    s_add_u32 m0, s28, 0
    v_mul_f32 v136, 0x3baaaaab, v166
    v_mul_f32 v255, 0x3baaaaab, v167
    v_mfma_f32_16x16x32_bf16 v[246:249], v[202:205], a[204:207], v[246:249]
    s_mov_b32 s27, s26
    v_rsq_f32 v234, v234
    v_mfma_f32_16x16x32_bf16 v[246:249], v[230:233], a[208:211], v[246:249]
    s_mov_b32 s26, s25
    v_rsq_f32 v235, v235
    v_mfma_f32_16x16x32_bf16 v[246:249], v[238:241], a[212:215], v[246:249]
    s_mov_b32 s25, s24
    v_mul_f32 v140, s31, v234
    v_cvt_pk_f16_f32 v141, v140, v235
    v_mfma_f32_16x16x32_bf16 v[122:125], a[72:75], v[182:185], 0
    s_waitcnt lgkmcnt(0)
    v_fma_f32 v236, v236, v140, v22
    v_fmac_f32_dpp v254, v237, v235 quad_perm:[0,1,2,3] row_mask:0x1 bank_mask:0xf
    v_mfma_f32_16x16x32_bf16 v[122:125], a[76:79], v[210:213], v[122:125]
    s_mov_b32 s24, s23
    v_cvt_pk_bf16_f32 v142, v246, v247
    v_cvt_pk_bf16_f32 v143, v248, v249
    v_mfma_f32_16x16x32_bf16 v[122:125], a[80:83], v[218:221], v[122:125]
    s_mov_b32 s71, s72
    v_pk_mul_f16 v146, v146, v141 op_sel:[0,1] op_sel_hi:[1,1]
    v_pk_mul_f16 v147, v147, v141 op_sel:[0,1] op_sel_hi:[1,1]
    v_mfma_f32_16x16x32_bf16 v[122:125], a[84:87], v[222:225], v[122:125]
    s_mov_b32 s72, s73
    v_pk_mul_f16 v148, v148, v141 op_sel:[0,1] op_sel_hi:[1,1]
    v_pk_mul_f16 v149, v149, v141 op_sel:[0,1] op_sel_hi:[1,1]
    v_mfma_f32_16x16x32_bf16 v[122:125], a[88:91], v[226:229], v[122:125]
    v_pk_mul_f16 v120, v120, v141 op_sel:[0,1] op_sel_hi:[1,1]
    v_pk_mul_f16 v121, v121, v141 op_sel:[0,1] op_sel_hi:[1,1]
    v_mfma_f32_16x16x32_bf16 v[122:125], a[92:95], v[190:193], v[122:125]
    v_pk_mul_f16 v150, v150, v141 op_sel:[0,0] op_sel_hi:[1,0]
    v_pk_mul_f16 v151, v151, v141 op_sel:[0,0] op_sel_hi:[1,0]
    v_mfma_f32_16x16x32_bf16 v[186:189], a[96:99], v[182:185], 0
    v_pk_mul_f16 v152, v152, v141 op_sel:[0,0] op_sel_hi:[1,0]
    v_pk_mul_f16 v153, v153, v141 op_sel:[0,0] op_sel_hi:[1,0]
    v_mfma_f32_16x16x32_bf16 v[186:189], a[100:103], v[210:213], v[186:189]
    v_pk_mul_f16 v118, v118, v141 op_sel:[0,0] op_sel_hi:[1,0]
    v_pk_mul_f16 v119, v119, v141 op_sel:[0,0] op_sel_hi:[1,0]
    v_mfma_f32_16x16x32_bf16 v[186:189], a[104:107], v[218:221], v[186:189]
    v_max3_u32 v44, v44, v234, v235
    v_mul_f32 v144, 0x3baaaaab, v168
    v_mfma_f32_16x16x32_bf16 v[186:189], a[108:111], v[222:225], v[186:189]
    v_rsq_f32 v136, v136
    v_mfma_f32_16x16x32_bf16 v[186:189], a[112:115], v[226:229], v[186:189]
    v_rsq_f32 v255, v255
    v_mfma_f32_16x16x32_bf16 v[186:189], a[116:119], v[190:193], v[186:189]
    v_rsq_f32 v144, v144
    v_mfma_f32_16x16x32_bf16 v[194:197], a[120:123], v[182:185], 0
    v_mul_f32 v178, v136, v178
    v_mul_f32 v179, v136, v179
    v_mfma_f32_16x16x32_bf16 v[194:197], a[124:127], v[210:213], v[194:197]
    v_cvt_pk_bf16_f32 v166, v178, v179
    v_mul_f32 v180, v136, v180
    v_mfma_f32_16x16x32_bf16 v[194:197], a[128:131], v[218:221], v[194:197]
    v_mul_f32 v181, v136, v181
    v_cvt_pk_bf16_f32 v167, v180, v181
    v_mfma_f32_16x16x32_bf16 v[194:197], a[132:135], v[222:225], v[194:197]
    v_mul_f32 v198, v136, v198
    v_mul_f32 v199, v136, v199
    v_mfma_f32_16x16x32_bf16 v[194:197], a[136:139], v[226:229], v[194:197]
    v_cvt_pk_bf16_f32 v168, v198, v199
    v_mul_f32 v200, v136, v200
    v_mfma_f32_16x16x32_bf16 v[194:197], a[140:143], v[190:193], v[194:197]
    v_mul_f32 v201, v136, v201
    v_cvt_pk_bf16_f32 v169, v200, v201
    v_mfma_f32_16x16x32_bf16 v[178:181], a[0:3], v[182:185], 0
    buffer_store_dwordx4 v[166:169], v15, s[12:15], 0 offen nt
    v_mul_f32 v206, v136, v206
    v_mul_f32 v207, v136, v207
    v_cvt_pk_bf16_f32 v140, v206, v207
    v_mul_f32 v208, v136, v208
    v_mfma_f32_16x16x32_bf16 v[178:181], a[4:7], v[210:213], v[178:181]
    v_mul_f32 v209, v136, v209
    v_cvt_pk_bf16_f32 v141, v208, v209
    v_mfma_f32_16x16x32_bf16 v[178:181], a[8:11], v[218:221], v[178:181]
    v_cvt_pk_f16_f32 v166, v122, v123
    v_pk_mul_f16 v199, v166, v166
    v_mfma_f32_16x16x32_bf16 v[178:181], a[12:15], v[222:225], v[178:181]
    v_cvt_pk_f16_f32 v167, v124, v125
    v_pk_fma_f16 v199, v167, v167, v199
    v_mfma_f32_16x16x32_bf16 v[178:181], a[16:19], v[226:229], v[178:181]
    v_cvt_pk_f16_f32 v168, v186, v187
    v_pk_fma_f16 v199, v168, v168, v199
    v_mfma_f32_16x16x32_bf16 v[178:181], a[20:23], v[190:193], v[178:181]
    v_cvt_pk_f16_f32 v169, v188, v189
    v_pk_fma_f16 v199, v169, v169, v199
    v_mfma_f32_16x16x32_bf16 v[186:189], a[24:27], v[182:185], 0
    v_cvt_pk_f16_f32 v124, v194, v195
    v_pk_fma_f16 v199, v124, v124, v199
    v_mfma_f32_16x16x32_bf16 v[186:189], a[28:31], v[210:213], v[186:189]
    v_cvt_pk_f16_f32 v125, v196, v197
    v_pk_fma_f16 v199, v125, v125, v199
    v_mfma_f32_16x16x32_bf16 v[186:189], a[32:35], v[218:221], v[186:189]
    v_cvt_pk_f16_f32 v178, v178, v179
    v_pk_mul_f16 v198, v178, v178
    v_mfma_f32_16x16x32_bf16 v[186:189], a[36:39], v[222:225], v[186:189]
    v_cvt_pk_f16_f32 v179, v180, v181
    v_pk_fma_f16 v198, v179, v179, v198
    v_mfma_f32_16x16x32_bf16 v[186:189], a[40:43], v[226:229], v[186:189]
    v_pk_mul_f16 v200, v178, v170
    v_pk_fma_f16 v200, v179, v171, v200
    v_mfma_f32_16x16x32_bf16 v[186:189], a[44:47], v[190:193], v[186:189]
    v_pk_mul_f16 v201, v166, v174
    v_pk_fma_f16 v201, v167, v175, v201
    v_mfma_f32_16x16x32_bf16 v[194:197], a[48:51], v[182:185], 0
    v_pk_fma_f16 v201, v168, v176, v201
    v_pk_fma_f16 v201, v169, v177, v201
    v_mfma_f32_16x16x32_bf16 v[194:197], a[52:55], v[210:213], v[194:197]
    v_pk_fma_f16 v201, v124, v164, v201
    v_pk_fma_f16 v201, v125, v165, v201
    v_mfma_f32_16x16x32_bf16 v[194:197], a[56:59], v[218:221], v[194:197]
    v_cvt_pk_f16_f32 v180, v186, v187
    v_pk_fma_f16 v198, v180, v180, v198
    v_mfma_f32_16x16x32_bf16 v[194:197], a[60:63], v[222:225], v[194:197]
    v_cvt_pk_f16_f32 v181, v188, v189
    v_pk_fma_f16 v198, v181, v181, v198
    v_mfma_f32_16x16x32_bf16 v[194:197], a[64:67], v[226:229], v[194:197]
    v_pk_fma_f16 v200, v180, v172, v200
    v_pk_fma_f16 v200, v181, v173, v200
    v_mfma_f32_16x16x32_bf16 v[194:197], a[68:71], v[190:193], v[194:197]
    buffer_store_dwordx2 v[140:141], v18, s[12:15], 0 offen nt
    v_mul_f32 v242, v144, v242
    v_mul_f32 v243, v144, v243
    v_mfma_f32_16x16x32_bf16 v[186:189], v[182:185], a[144:147], 0
    v_cvt_pk_bf16_f32 v238, v242, v243
    v_mul_f32 v244, v144, v244
    v_mfma_f32_16x16x32_bf16 v[186:189], v[210:213], a[148:151], v[186:189]
    v_mul_f32 v245, v144, v245
    v_cvt_pk_f16_f32 v122, v194, v195
    v_mfma_f32_16x16x32_bf16 v[186:189], v[218:221], a[152:155], v[186:189]
    v_pk_fma_f16 v198, v122, v122, v198
    v_cvt_pk_f16_f32 v123, v196, v197
    v_mfma_f32_16x16x32_bf16 v[186:189], v[222:225], a[156:159], v[186:189]
    v_pk_fma_f16 v198, v123, v123, v198
    v_pk_fma_f16 v200, v122, v162, v200
    v_mfma_f32_16x16x32_bf16 v[186:189], v[226:229], a[160:163], v[186:189]
    ds_read_b128 v[202:205], v0 offset:32768
    v_pk_fma_f16 v200, v123, v163, v200
    v_mfma_f32_16x16x32_bf16 v[186:189], v[190:193], a[164:167], v[186:189]
    ds_read_b128 v[194:197], v1 offset:32768
    v_cvt_pk_bf16_f32 v239, v244, v245
    v_mfma_f32_16x16x32_f16 v[230:233], v[40:43], v[198:201], 0
    v_mul_f32 v158, v144, v158
    v_mul_f32 v159, v144, v159
    v_mfma_f32_16x16x32_bf16 v[246:249], v[182:185], a[168:171], 0
    ds_read_b128 v[214:217], v0 offset:32896
    v_cvt_pk_bf16_f32 v240, v158, v159
    v_mfma_f32_16x16x32_bf16 v[246:249], v[210:213], a[172:175], v[246:249]
    ds_read_b128 v[206:209], v1 offset:32896
    v_cvt_pk_bf16_f32 v136, v186, v187
    v_mfma_f32_16x16x32_bf16 v[246:249], v[218:221], a[176:179], v[246:249]
    ds_read_b128 v[198:201], v0 offset:33024
    v_cvt_pk_bf16_f32 v137, v188, v189
    v_mfma_f32_16x16x32_bf16 v[246:249], v[222:225], a[180:183], v[246:249]
    ds_read_b128 v[186:189], v1 offset:33024
    v_mul_f32 v160, v144, v160
    v_mfma_f32_16x16x32_bf16 v[246:249], v[226:229], a[184:187], v[246:249]
    v_rsq_f32 v230, v230
    v_mfma_f32_16x16x32_bf16 v[246:249], v[190:193], a[188:191], v[246:249]
    s_waitcnt lgkmcnt(5)
    v_rsq_f32 v231, v231
    v_mfma_f32_16x16x32_bf16 v[242:245], v[182:185], a[192:195], 0
    s_waitcnt lgkmcnt(4)
    v_mul_f32 v234, s31, v230
    v_cvt_pk_f16_f32 v235, v234, v231
    v_mfma_f32_16x16x32_bf16 v[242:245], v[210:213], a[196:199], v[242:245]
    v_fma_f32 v232, v232, v234, v24
    v_fmac_f32_dpp v254, v233, v231 quad_perm:[0,1,2,3] row_mask:0x2 bank_mask:0xf
    v_mfma_f32_16x16x32_bf16 v[242:245], v[218:221], a[200:203], v[242:245]
    s_waitcnt lgkmcnt(3)
    v_cvt_pk_bf16_f32 v140, v246, v247
    v_cvt_pk_bf16_f32 v141, v248, v249
    v_mfma_f32_16x16x32_bf16 v[242:245], v[222:225], a[204:207], v[242:245]
    s_waitcnt lgkmcnt(2)
    v_mul_f32 v161, v144, v161
    v_cvt_pk_bf16_f32 v241, v160, v161
    v_mfma_f32_16x16x32_bf16 v[242:245], v[226:229], a[208:211], v[242:245]
    s_waitcnt lgkmcnt(1)
    buffer_store_dwordx4 v[238:241], v17, s[12:15], 0 offen nt
    v_mul_f32 v154, v144, v154
    v_mul_f32 v155, v144, v155
    v_cvt_pk_bf16_f32 v154, v154, v155
    v_mul_f32 v156, v144, v156
    v_mfma_f32_16x16x32_bf16 v[242:245], v[190:193], a[212:215], v[242:245]
    s_waitcnt lgkmcnt(0)
    v_mul_f32 v157, v144, v157
    v_cvt_pk_bf16_f32 v155, v156, v157
    v_mfma_f32_16x16x32_bf16 v[158:161], a[72:75], v[202:205], 0
    v_pk_mul_f16 v166, v166, v235 op_sel:[0,1] op_sel_hi:[1,1]
    v_pk_mul_f16 v167, v167, v235 op_sel:[0,1] op_sel_hi:[1,1]
    v_mfma_f32_16x16x32_bf16 v[158:161], a[76:79], v[194:197], v[158:161]
    v_pk_mul_f16 v168, v168, v235 op_sel:[0,1] op_sel_hi:[1,1]
    v_cvt_pk_bf16_f32 v144, v242, v243
    v_mfma_f32_16x16x32_bf16 v[158:161], a[80:83], v[214:217], v[158:161]
    v_cvt_pk_bf16_f32 v145, v244, v245
    v_pk_mul_f16 v169, v169, v235 op_sel:[0,1] op_sel_hi:[1,1]
    v_mfma_f32_16x16x32_bf16 v[158:161], a[84:87], v[206:209], v[158:161]
    v_pk_mul_f16 v124, v124, v235 op_sel:[0,1] op_sel_hi:[1,1]
    v_pk_mul_f16 v125, v125, v235 op_sel:[0,1] op_sel_hi:[1,1]
    v_mfma_f32_16x16x32_bf16 v[158:161], a[88:91], v[198:201], v[158:161]
    v_pk_mul_f16 v178, v178, v235 op_sel:[0,0] op_sel_hi:[1,0]
    v_pk_mul_f16 v179, v179, v235 op_sel:[0,0] op_sel_hi:[1,0]
    v_mfma_f32_16x16x32_bf16 v[158:161], a[92:95], v[186:189], v[158:161]
    v_pk_mul_f16 v180, v180, v235 op_sel:[0,0] op_sel_hi:[1,0]
    v_pk_mul_f16 v181, v181, v235 op_sel:[0,0] op_sel_hi:[1,0]
    v_mfma_f32_16x16x32_bf16 v[182:185], a[96:99], v[202:205], 0
    v_pk_mul_f16 v122, v122, v235 op_sel:[0,0] op_sel_hi:[1,0]
    v_pk_mul_f16 v123, v123, v235 op_sel:[0,0] op_sel_hi:[1,0]
    v_mfma_f32_16x16x32_bf16 v[182:185], a[100:103], v[194:197], v[182:185]
    v_max3_u32 v44, v44, v230, v231
    v_mul_f32 v130, v255, v130
    v_mfma_f32_16x16x32_bf16 v[182:185], a[104:107], v[214:217], v[182:185]
    v_cvt_pk_f16_f32 v158, v158, v159
    v_pk_mul_f16 v191, v158, v158
    v_mfma_f32_16x16x32_bf16 v[182:185], a[108:111], v[206:209], v[182:185]
    v_cvt_pk_f16_f32 v159, v160, v161
    v_pk_fma_f16 v191, v159, v159, v191
    v_mfma_f32_16x16x32_bf16 v[182:185], a[112:115], v[198:201], v[182:185]
    v_pk_mul_f16 v193, v158, v174
    v_pk_fma_f16 v193, v159, v175, v193
    v_mfma_f32_16x16x32_bf16 v[182:185], a[116:119], v[186:189], v[182:185]
    v_exp_f32 v232, v232
    v_mfma_f32_16x16x32_bf16 v[210:213], a[120:123], v[202:205], 0
    v_exp_f32 v236, v236
    v_mfma_f32_16x16x32_bf16 v[210:213], a[124:127], v[194:197], v[210:213]
    v_cvt_pk_bf16_f32 v39, v236, 0
    v_mul_f32 v131, v255, v131
    v_mfma_f32_16x16x32_bf16 v[210:213], a[128:131], v[214:217], v[210:213]
    s_waitcnt vmcnt(3)
    ds_write_b16 v8, v45 offset:512
    v_mfma_f32_16x16x32_bf16 v[210:213], a[132:135], v[206:209], v[210:213]
    buffer_store_dwordx2 v[154:155], v20, s[12:15], 0 offen nt
    v_mov_b32 v45, 1
    v_cvt_pk_f16_f32 v160, v182, v183
    v_mfma_f32_16x16x32_bf16 v[210:213], a[136:139], v[198:201], v[210:213]
    v_pk_fma_f16 v191, v160, v160, v191
    v_cvt_pk_f16_f32 v161, v184, v185
    v_mfma_f32_16x16x32_bf16 v[210:213], a[140:143], v[186:189], v[210:213]
    v_pk_fma_f16 v191, v161, v161, v191
    v_pk_fma_f16 v193, v160, v176, v193
    v_mfma_f32_16x16x32_bf16 v[154:157], a[0:3], v[202:205], 0
    v_pk_fma_f16 v193, v161, v177, v193
    v_cvt_pk_bf16_f32 v130, v130, v131
    v_mfma_f32_16x16x32_bf16 v[154:157], a[4:7], v[194:197], v[154:157]
    v_mul_f32 v132, v255, v132
    v_mul_f32 v133, v255, v133
    v_mfma_f32_16x16x32_bf16 v[154:157], a[8:11], v[214:217], v[154:157]
    v_cvt_pk_f16_f32 v176, v210, v211
    v_pk_fma_f16 v191, v176, v176, v191
    v_mfma_f32_16x16x32_bf16 v[154:157], a[12:15], v[206:209], v[154:157]
    s_waitcnt lgkmcnt(0)
    v_cvt_pk_f16_f32 v177, v212, v213
    v_pk_fma_f16 v191, v177, v177, v191
    v_mfma_f32_16x16x32_bf16 v[154:157], a[16:19], v[198:201], v[154:157]
    s_barrier
    v_pk_fma_f16 v193, v176, v164, v193
    v_mfma_f32_16x16x32_bf16 v[154:157], a[20:23], v[186:189], v[154:157]
    v_pk_fma_f16 v193, v177, v165, v193
    v_mfma_f32_16x16x32_bf16 v[182:185], a[24:27], v[202:205], 0
    v_cvt_pk_bf16_f32 v131, v132, v133
    v_mfma_f32_16x16x32_bf16 v[182:185], a[28:31], v[194:197], v[182:185]
    ds_read2_b32 v[164:165], v6 offset0:0 offset1:0
    v_mfma_f32_16x16x32_bf16 v[182:185], a[32:35], v[214:217], v[182:185]
    ds_read2_b32 v[212:213], v6 offset0:16 offset1:16
    s_nop 0
    v_cvt_pk_f16_f32 v154, v154, v155
    v_mfma_f32_16x16x32_bf16 v[182:185], a[36:39], v[206:209], v[182:185]
    ds_read2_b32 v[220:221], v6 offset0:32 offset1:32
    v_pk_mul_f16 v190, v154, v154
    v_mfma_f32_16x16x32_bf16 v[182:185], a[40:43], v[198:201], v[182:185]
    ds_read_u16 v133, v9 offset:512
    v_cvt_pk_f16_f32 v155, v156, v157
    v_mfma_f32_16x16x32_bf16 v[182:185], a[44:47], v[186:189], v[182:185]
    v_pk_fma_f16 v190, v155, v155, v190
    v_pk_mul_f16 v192, v154, v170
    v_mfma_f32_16x16x32_bf16 v[222:225], a[48:51], v[202:205], 0
    v_pk_fma_f16 v192, v155, v171, v192
    v_mul_f32 v126, v255, v126
    v_mfma_f32_16x16x32_bf16 v[222:225], a[52:55], v[194:197], v[222:225]
    v_mul_f32 v127, v255, v127
    v_cvt_pk_bf16_f32 v132, v126, v127
    v_mfma_f32_16x16x32_bf16 v[222:225], a[56:59], v[214:217], v[222:225]
    buffer_load_dwordx4 v10, s[8:11], 0 offen nt lds
    v_cvt_pk_f16_f32 v156, v182, v183
    v_mfma_f32_16x16x32_bf16 v[222:225], a[60:63], v[206:209], v[222:225]
    s_add_u32 m0, s28, 4096
    v_pk_fma_f16 v190, v156, v156, v190
    v_cvt_pk_f16_f32 v157, v184, v185
    v_mfma_f32_16x16x32_bf16 v[222:225], a[64:67], v[198:201], v[222:225]
    s_waitcnt lgkmcnt(2)
    v_pk_fma_f16 v190, v157, v157, v190
    v_pk_fma_f16 v192, v156, v172, v192
    v_mfma_f32_16x16x32_bf16 v[222:225], a[68:71], v[186:189], v[222:225]
    s_waitcnt lgkmcnt(1)
    ds_read_b128 v[182:185], v2 offset:0
    v_pk_fma_f16 v192, v157, v173, v192
    v_mfma_f32_16x16x32_bf16 v[170:173], v[202:205], a[144:147], 0
    s_waitcnt lgkmcnt(1)
    ds_read_b128 v[226:229], v2 offset:1024
    v_readfirstlane_b32 s77, v133
    v_mfma_f32_16x16x32_bf16 v[170:173], v[194:197], a[148:151], v[170:173]
    ds_read_b128 v[234:237], v2 offset:2048
    buffer_load_dwordx4 v11, s[8:11], 0 offen nt lds
    v_mfma_f32_16x16x32_bf16 v[170:173], v[214:217], a[152:155], v[170:173]
    s_add_u32 m0, s28, 8192
    ds_read_b128 v[238:241], v2 offset:3072
    v_cvt_pk_f16_f32 v174, v222, v223
    v_mfma_f32_16x16x32_bf16 v[170:173], v[206:209], a[156:159], v[170:173]
    s_mul_i32 s78, s77, 2688
    ds_read_b128 v[242:245], v2 offset:4096
    v_pk_fma_f16 v190, v174, v174, v190
    v_mfma_f32_16x16x32_bf16 v[170:173], v[198:201], a[160:163], v[170:173]
    ds_read_b128 v[246:249], v2 offset:5120
    v_cvt_pk_f16_f32 v175, v224, v225
    v_mfma_f32_16x16x32_bf16 v[170:173], v[186:189], a[164:167], v[170:173]
    v_pk_fma_f16 v190, v175, v175, v190
    v_pk_fma_f16 v192, v174, v162, v192
    v_mfma_f32_16x16x32_bf16 v[222:225], v[202:205], a[168:171], 0
    buffer_load_dwordx4 v12, s[8:11], 0 offen nt lds
    v_pk_fma_f16 v192, v175, v163, v192
    v_mfma_f32_16x16x32_bf16 v[222:225], v[194:197], a[172:175], v[222:225]
    s_waitcnt lgkmcnt(5)
    v_mul_f32 v128, v255, v128
    v_cvt_pk_bf16_f32 v162, v170, v171
    v_mfma_f32_16x16x32_f16 v[250:253], v[40:43], v[190:193], 0
    s_add_u32 m0, s28, 12288
    v_cvt_pk_bf16_f32 v163, v172, v173
    v_mul_f32 v129, v255, v129
    v_mfma_f32_16x16x32_bf16 v[222:225], v[214:217], a[176:179], v[222:225]
    s_xor_b32 s28, s28, 65536
    v_cvt_pk_bf16_f32 v133, v128, v129
    v_mul_f32 v114, v255, v114
    v_mfma_f32_16x16x32_bf16 v[222:225], v[206:209], a[180:183], v[222:225]
    s_waitcnt lgkmcnt(2)
    v_rsq_f32 v250, v250
    v_mfma_f32_16x16x32_bf16 v[222:225], v[198:201], a[184:187], v[222:225]
    s_waitcnt lgkmcnt(1)
    buffer_load_dwordx4 v13, s[8:11], 0 offen nt lds
    v_mul_f32 v230, s31, v250
    v_mfma_f32_16x16x32_bf16 v[222:225], v[186:189], a[188:191], v[222:225]
    s_mov_b32 m0, s29
    v_rsq_f32 v251, v251
    v_mfma_f32_16x16x32_bf16 v[126:129], v[202:205], a[192:195], 0
    s_xor_b32 s29, s29, s30
    v_cvt_pk_f16_f32 v231, v230, v251
    v_fma_f32 v252, v252, v230, v26
    v_mfma_f32_16x16x32_bf16 v[126:129], v[194:197], a[196:199], v[126:129]
    s_add_u32 s19, s19, s20
    v_fmac_f32_dpp v254, v253, v251 quad_perm:[0,1,2,3] row_mask:0x4 bank_mask:0xf
    v_cvt_pk_bf16_f32 v210, v222, v223
    v_mfma_f32_16x16x32_bf16 v[126:129], v[214:217], a[200:203], v[126:129]
    s_add_u32 s23, s23, s21
    v_cvt_pk_bf16_f32 v211, v224, v225
    v_pk_mul_f16 v158, v158, v231 op_sel:[0,1] op_sel_hi:[1,1]
    v_mfma_f32_16x16x32_bf16 v[126:129], v[206:209], a[204:207], v[126:129]
    s_waitcnt lgkmcnt(0)
    buffer_load_dwordx4 v14, s[8:11], 0 offen nt lds
    v_pk_mul_f16 v159, v159, v231 op_sel:[0,1] op_sel_hi:[1,1]
    v_mfma_f32_16x16x32_bf16 v[126:129], v[198:201], a[208:211], v[126:129]
    s_cmp_ge_u32 s19, 72
    v_pk_mul_f16 v160, v160, v231 op_sel:[0,1] op_sel_hi:[1,1]
    v_pk_mul_f16 v161, v161, v231 op_sel:[0,1] op_sel_hi:[1,1]
    v_mfma_f32_16x16x32_bf16 v[126:129], v[186:189], a[212:215], v[126:129]
    s_cselect_b32 s34, 72, 0
    v_pk_mul_f16 v176, v176, v231 op_sel:[0,1] op_sel_hi:[1,1]
    v_pk_mul_f16 v177, v177, v231 op_sel:[0,1] op_sel_hi:[1,1]
    v_mfma_f32_16x16x32_f16 v[170:173], v[146:149], v[150:153], v[46:49]
    s_cselect_b32 s35, s22, 0
    v_pk_mul_f16 v154, v154, v231 op_sel:[0,0] op_sel_hi:[1,0]
    v_pk_mul_f16 v155, v155, v231 op_sel:[0,0] op_sel_hi:[1,0]
    v_mfma_f32_16x16x32_f16 v[186:189], v[166:169], v[150:153], v[50:53]
    s_sub_u32 s19, s19, s34
    v_cvt_pk_bf16_f32 v218, v126, v127
    v_cvt_pk_bf16_f32 v219, v128, v129
    v_mfma_f32_16x16x32_f16 v[126:129], v[158:161], v[150:153], v[54:57]
    buffer_store_dwordx4 v[130:133], v16, s[12:15], 0 offen nt
    v_pk_mul_f16 v156, v156, v231 op_sel:[0,0] op_sel_hi:[1,0]
    v_pk_mul_f16 v157, v157, v231 op_sel:[0,0] op_sel_hi:[1,0]
    v_pk_mul_f16 v174, v174, v231 op_sel:[0,0] op_sel_hi:[1,0]
    v_pk_mul_f16 v175, v175, v231 op_sel:[0,0] op_sel_hi:[1,0]
    v_mfma_f32_16x16x16_f16 v[170:173], v[120:121], v[118:119], v[170:173]
    v_max3_u32 v44, v44, v250, v251
    v_exp_f32 v254, v254
    v_mfma_f32_16x16x16_f16 v[186:189], v[124:125], v[118:119], v[186:189]
    v_cvt_pk_bf16_f32 v254, v254, v254
    v_exp_f32 v252, v252
    v_mfma_f32_16x16x16_f16 v[126:129], v[176:177], v[118:119], v[126:129]
    v_mul_f32 v115, v255, v115
    v_cvt_pk_bf16_f32 v118, v114, v115
    v_exp_f32 v170, v170
    v_mfma_f32_16x16x32_f16 v[130:133], v[146:149], v[178:181], v[58:61]
    s_add_u32 s23, s23, s35
    ds_write_b16 v8, v254
    v_mfma_f32_16x16x32_f16 v[150:153], v[166:169], v[178:181], v[62:65]
    s_add_u32 s78, s78, s69
    v_exp_f32 v171, v171
    v_mfma_f32_16x16x32_f16 v[190:193], v[158:161], v[178:181], v[66:69]
    s_add_u32 s80, s77, s68
    v_cvt_pk_bf16_f32 v170, v170, v171
    v_exp_f32 v172, v172
    v_mfma_f32_16x16x16_f16 v[130:133], v[120:121], v[122:123], v[130:133]
    v_exp_f32 v173, v173
    v_mul_f32 v116, v255, v116
    v_mfma_f32_16x16x16_f16 v[150:153], v[124:125], v[122:123], v[150:153]
    v_cvt_pk_bf16_f32 v171, v172, v173
    v_exp_f32 v186, v186
    v_mfma_f32_16x16x16_f16 v[190:193], v[176:177], v[122:123], v[190:193]
    v_exp_f32 v187, v187
    v_exp_f32 v188, v188
    v_mfma_f32_16x16x32_bf16 v[178:181], a[216:219], v[182:185], 0
    s_cmp_ge_u32 s80, 72
    v_exp_f32 v130, v130
    v_mfma_f32_16x16x32_bf16 v[178:181], a[220:223], v[226:229], v[178:181]
    s_cselect_b32 s80, s22, 0
    v_exp_f32 v131, v131
    v_mfma_f32_16x16x32_bf16 v[178:181], a[224:227], v[234:237], v[178:181]
    s_add_u32 s78, s78, s80
    v_cvt_pk_bf16_f32 v194, v130, v131
    v_cvt_pk_bf16_f32 v172, v186, v187
    v_mfma_f32_16x16x32_bf16 v[178:181], a[228:231], v[238:241], v[178:181]
    s_add_u32 s80, s77, 20
    v_exp_f32 v132, v132
    v_mfma_f32_16x16x32_bf16 v[178:181], a[232:235], v[242:245], v[178:181]
    s_add_u32 s34, s18, 3
    v_exp_f32 v133, v133
    v_mfma_f32_16x16x32_bf16 v[178:181], a[236:239], v[246:249], v[178:181]
    s_cmp_lt_u32 s77, s62
    v_cvt_pk_bf16_f32 v195, v132, v133
    v_mul_f32 v117, v255, v117
    v_mfma_f32_16x16x32_bf16 v[198:201], a[240:243], v[182:185], 0
    s_cselect_b32 s79, 1, 0
    v_exp_f32 v150, v150
    v_mfma_f32_16x16x32_f16 v[202:205], v[146:149], v[154:157], v[70:73]
    s_cselect_b32 s78, s78, 0
    v_exp_f32 v151, v151
    v_mfma_f32_16x16x32_f16 v[146:149], v[166:169], v[154:157], v[74:77]
    s_cmp_lt_u32 s34, s17
    v_cvt_pk_bf16_f32 v196, v150, v151
    v_cvt_pk_bf16_f32 v119, v116, v117
    v_mfma_f32_16x16x32_f16 v[166:169], v[158:161], v[154:157], v[78:81]
    buffer_store_dwordx2 v[118:119], v19, s[12:15], 0 offen nt
    v_exp_f32 v152, v152
    v_mfma_f32_16x16x16_f16 v[202:205], v[120:121], v[174:175], v[202:205]
    v_exp_f32 v153, v153
    v_fma_f32 v254, v178, v178, s33
    v_mfma_f32_16x16x16_f16 v[146:149], v[124:125], v[174:175], v[146:149]
    v_cvt_pk_bf16_f32 v197, v152, v153
    v_exp_f32 v190, v190
    v_mfma_f32_16x16x16_f16 v[166:169], v[176:177], v[174:175], v[166:169]
    v_exp_f32 v191, v191
    v_exp_f32 v192, v192
    v_mfma_f32_16x16x32_bf16 v[198:201], a[244:247], v[226:229], v[198:201]
    s_cselect_b32 s23, s23, s78
    v_exp_f32 v193, v193
    v_mfma_f32_16x16x32_bf16 v[198:201], a[248:251], v[234:237], v[198:201]
    s_cselect_b32 s73, s34, s80
    ds_read_b128 v[118:121], v2 offset:6144
    v_fmac_f32 v254, v179, v179
    v_mfma_f32_16x16x32_bf16 v[198:201], a[252:255], v[238:241], v[198:201]
    s_cselect_b32 s79, 0, s79
    ds_read_b128 v[122:125], v2 offset:7168
    v_fmac_f32 v254, v180, v180
    v_mfma_f32_16x16x32_bf16 v[198:201], v[82:85], v[242:245], v[198:201]
    s_cselect_b32 s81, 0, 1
    ds_read_b128 v[150:153], v2 offset:8192
    v_fmac_f32 v254, v181, v181
    v_mfma_f32_16x16x32_bf16 v[198:201], v[86:89], v[246:249], v[198:201]
    s_add_u32 s80, s77, 1
    ds_read_b128 v[154:157], v2 offset:9216
    v_xor_b32 v0, 65536, v0
    v_mfma_f32_16x16x32_bf16 v[206:209], v[90:93], v[182:185], 0
    s_mul_i32 s80, s80, s81
    ds_read_b128 v[158:161], v2 offset:10240
    v_xor_b32 v1, 65536, v1
    v_mfma_f32_16x16x32_bf16 v[206:209], v[94:97], v[226:229], v[206:209]
    s_cmp_lt_u32 s80, s62
    ds_read_b128 v[174:177], v2 offset:11264
    v_fmac_f32 v254, v198, v198
    v_mfma_f32_16x16x32_bf16 v[206:209], v[98:101], v[234:237], v[206:209]
    s_cselect_b32 s62, s62, 0
    v_exp_f32 v189, v189
    v_mfma_f32_16x16x32_bf16 v[206:209], v[102:105], v[238:241], v[206:209]
    s_add_u32 s80, s18, 4
    v_cvt_pk_bf16_f32 v173, v188, v189
    v_fmac_f32 v254, v199, v199
    v_mfma_f32_16x16x32_bf16 v[206:209], v[106:109], v[242:245], v[206:209]
    s_waitcnt lgkmcnt(5)
    v_exp_f32 v126, v126
    v_mfma_f32_16x16x32_bf16 v[206:209], v[110:113], v[246:249], v[206:209]
    s_cmp_ge_u32 s80, s17
    v_exp_f32 v127, v127
    v_mfma_f32_16x16x32_bf16 v[130:133], a[216:219], v[118:121], 0
    s_waitcnt lgkmcnt(3)
    v_cvt_pk_bf16_f32 v36, v126, v127
    v_fmac_f32 v254, v200, v200
    v_mfma_f32_16x16x32_bf16 v[130:133], a[220:223], v[122:125], v[130:133]
    s_cselect_b32 s66, s62, 0
    v_exp_f32 v128, v128
    v_mfma_f32_16x16x32_bf16 v[130:133], a[224:227], v[150:153], v[130:133]
    s_waitcnt lgkmcnt(1)
    buffer_atomic_add v45, v10, s[64:67], 0 offen sc0 sc1
    v_fmac_f32 v254, v201, v201
    v_mfma_f32_16x16x32_bf16 v[130:133], a[228:231], v[154:157], v[130:133]
    s_lshl_b32 s80, s79, s73
    v_exp_f32 v129, v129
    v_mfma_f32_16x16x32_bf16 v[130:133], a[232:235], v[158:161], v[130:133]
    s_waitcnt lgkmcnt(0)
    v_cvt_pk_bf16_f32 v37, v128, v129
    v_fmac_f32 v254, v206, v206
    v_mfma_f32_16x16x32_bf16 v[130:133], a[236:239], v[174:177], v[130:133]
    s_or_b32 s70, s70, s80
    v_exp_f32 v202, v202
    v_mfma_f32_16x16x32_bf16 v[182:185], v[28:31], v[36:39], 0
    s_add_u32 s45, s45, s79
    v_exp_f32 v203, v203
    v_mfma_f32_16x16x32_bf16 v[182:185], v[28:31], v[170:173], v[182:185]
    s_add_u32 s18, s18, 1
    v_cvt_pk_bf16_f32 v186, v202, v203
    v_fma_f32 v255, v130, v130, s33
    v_mfma_f32_16x16x32_bf16 v[214:217], v[162:165], v[36:39], 0
    s_cmp_lt_u32 s18, s45
    v_fmac_f32 v255, v131, v131
    v_fmac_f32 v255, v132, v132
    v_mfma_f32_16x16x32_bf16 v[214:217], v[134:137], v[170:173], v[214:217]
    v_fmac_f32 v255, v133, v133
    v_fmac_f32 v254, v207, v207
    v_mfma_f32_16x16x32_bf16 v[222:225], v[210:213], v[36:39], 0
    v_exp_f32 v204, v204
    v_mfma_f32_16x16x32_bf16 v[222:225], v[138:141], v[170:173], v[222:225]
    v_exp_f32 v205, v205
    v_mfma_f32_16x16x32_bf16 v[226:229], v[218:221], v[36:39], 0
    v_cvt_pk_bf16_f32 v36, v190, v191
    v_cvt_pk_bf16_f32 v37, v192, v193
    v_mfma_f32_16x16x32_bf16 v[226:229], v[142:145], v[170:173], v[226:229]
    v_cvt_pk_bf16_f32 v39, v232, 0
    v_cvt_pk_bf16_f32 v187, v204, v205
    v_mfma_f32_16x16x32_bf16 v[126:129], a[240:243], v[118:121], 0
    v_exp_f32 v146, v146
    v_mfma_f32_16x16x32_bf16 v[170:173], v[28:31], v[36:39], 0
    v_exp_f32 v147, v147
    v_mfma_f32_16x16x32_bf16 v[170:173], v[28:31], v[194:197], v[170:173]
    v_cvt_pk_bf16_f32 v188, v146, v147
    v_fmac_f32 v254, v208, v208
    v_mfma_f32_16x16x32_bf16 v[114:117], v[162:165], v[36:39], 0
    v_exp_f32 v148, v148
    v_mfma_f32_16x16x32_bf16 v[114:117], v[134:137], v[194:197], v[114:117]
    v_exp_f32 v149, v149
    v_mfma_f32_16x16x32_bf16 v[190:193], v[210:213], v[36:39], 0
    v_cvt_pk_bf16_f32 v189, v148, v149
    v_fmac_f32 v254, v209, v209
    v_mfma_f32_16x16x32_bf16 v[190:193], v[138:141], v[194:197], v[190:193]
    v_rcp_f32 v170, v170
    v_mfma_f32_16x16x32_bf16 v[146:149], v[218:221], v[36:39], 0
    v_exp_f32 v166, v166
    v_mfma_f32_16x16x32_bf16 v[146:149], v[142:145], v[194:197], v[146:149]
    v_mul_f32 v114, v170, v114
    v_mul_f32 v115, v170, v115
    v_mfma_f32_16x16x32_bf16 v[126:129], a[244:247], v[122:125], v[126:129]
    v_cvt_pk_bf16_f32 v194, v114, v115
    v_mul_f32 v116, v170, v116
    v_mfma_f32_16x16x32_bf16 v[126:129], a[248:251], v[150:153], v[126:129]
    ds_read_b128 v[202:205], v2 offset:12288
    v_mul_f32 v117, v170, v117
    v_mfma_f32_16x16x32_bf16 v[126:129], a[252:255], v[154:157], v[126:129]
    ds_read_b128 v[230:233], v2 offset:13312
    v_cvt_pk_bf16_f32 v195, v116, v117
    v_mfma_f32_16x16x32_bf16 v[126:129], v[82:85], v[158:161], v[126:129]
    ds_read_b128 v[234:237], v2 offset:14336
    v_mul_f32 v190, v170, v190
    v_mfma_f32_16x16x32_bf16 v[126:129], v[86:89], v[174:177], v[126:129]
    ds_read_b128 v[238:241], v2 offset:15360
    v_mul_f32 v191, v170, v191
    v_mfma_f32_16x16x32_bf16 v[114:117], v[90:93], v[118:121], 0
    ds_read_b128 v[118:121], v2 offset:16384
    v_cvt_pk_bf16_f32 v196, v190, v191
    v_mfma_f32_16x16x32_bf16 v[114:117], v[94:97], v[122:125], v[114:117]
    ds_read_b128 v[122:125], v2 offset:17408
    v_mul_f32 v192, v170, v192
    v_mfma_f32_16x16x32_bf16 v[114:117], v[98:101], v[150:153], v[114:117]
    v_fmac_f32 v255, v126, v126
    v_fmac_f32 v255, v127, v127
    v_mfma_f32_16x16x32_bf16 v[114:117], v[102:105], v[154:157], v[114:117]
    v_fmac_f32 v255, v128, v128
    v_fmac_f32 v255, v129, v129
    v_mfma_f32_16x16x32_bf16 v[114:117], v[106:109], v[158:161], v[114:117]
    s_waitcnt lgkmcnt(5)
    v_mul_f32 v193, v170, v193
    v_cvt_pk_bf16_f32 v197, v192, v193
    v_mfma_f32_16x16x32_bf16 v[114:117], v[110:113], v[174:177], v[114:117]
    s_waitcnt lgkmcnt(4)
    ds_write_b128 v3, v[194:197] offset:6144
    v_mfma_f32_16x16x32_bf16 v[242:245], a[216:219], v[202:205], 0
    s_waitcnt lgkmcnt(3)
    v_mul_f32 v146, v170, v146
    v_mul_f32 v147, v170, v147
    v_mfma_f32_16x16x32_bf16 v[242:245], a[220:223], v[230:233], v[242:245]
    s_waitcnt lgkmcnt(2)
    v_fmac_f32 v255, v114, v114
    v_fmac_f32 v255, v115, v115
    v_mfma_f32_16x16x32_bf16 v[242:245], a[224:227], v[234:237], v[242:245]
    s_waitcnt lgkmcnt(1)
    v_fmac_f32 v255, v116, v116
    v_fmac_f32 v255, v117, v117
    v_mfma_f32_16x16x32_bf16 v[242:245], a[228:231], v[238:241], v[242:245]
    v_cvt_pk_bf16_f32 v254, v254, v255
    v_cvt_pk_bf16_f32 v172, v146, v147
    v_mfma_f32_16x16x32_bf16 v[242:245], a[232:235], v[118:121], v[242:245]
    v_mul_f32 v148, v170, v148
    v_mul_f32 v149, v170, v149
    v_mfma_f32_16x16x32_bf16 v[242:245], a[236:239], v[122:125], v[242:245]
    v_cvt_pk_bf16_f32 v173, v148, v149
    v_cvt_pk_bf16_f32 v39, v252, 0
    v_mfma_f32_16x16x32_bf16 v[158:161], a[240:243], v[202:205], 0
    ds_write_b64 v4, v[172:173] offset:10240
    v_mfma_f32_16x16x32_bf16 v[158:161], a[244:247], v[230:233], v[158:161]
    v_exp_f32 v167, v167
    v_mfma_f32_16x16x32_bf16 v[158:161], a[248:251], v[234:237], v[158:161]
    v_cvt_pk_bf16_f32 v36, v166, v167
    v_fma_f32 v255, v242, v242, s33
    v_mfma_f32_16x16x32_bf16 v[158:161], a[252:255], v[238:241], v[158:161]
    v_fmac_f32 v255, v243, v243
    v_fmac_f32 v255, v244, v244
    v_mfma_f32_16x16x32_bf16 v[158:161], v[82:85], v[118:121], v[158:161]
    v_fmac_f32 v255, v245, v245
    v_xor_b32 v2, 65536, v2
    v_mfma_f32_16x16x32_bf16 v[158:161], v[86:89], v[122:125], v[158:161]
    v_exp_f32 v168, v168
    v_mfma_f32_16x16x32_bf16 v[154:157], v[90:93], v[202:205], 0
    v_exp_f32 v169, v169
    v_mfma_f32_16x16x32_bf16 v[154:157], v[94:97], v[230:233], v[154:157]
    ds_read_b128 v[146:149], v9
    v_cvt_pk_bf16_f32 v37, v168, v169
    v_mfma_f32_16x16x32_bf16 v[154:157], v[98:101], v[234:237], v[154:157]
    ds_read_b128 v[150:153], v9 offset:64
    v_fmac_f32 v255, v158, v158
    v_mfma_f32_16x16x32_bf16 v[166:169], v[28:31], v[36:39], 0
    v_fmac_f32 v255, v159, v159
    v_fmac_f32 v255, v160, v160
    v_mfma_f32_16x16x32_bf16 v[166:169], v[28:31], v[186:189], v[166:169]
    v_fmac_f32 v255, v161, v161
    v_add_u32 v6, s75, v6
    v_mfma_f32_16x16x32_bf16 v[174:177], v[162:165], v[36:39], 0
    v_rcp_f32 v182, v182
    v_mfma_f32_16x16x32_bf16 v[174:177], v[134:137], v[186:189], v[174:177]
    v_max3_u32 v25, v25, v182, v183
    v_max3_u32 v25, v25, v170, v171
    v_mfma_f32_16x16x32_bf16 v[170:173], v[210:213], v[36:39], 0
    v_rcp_f32 v166, v166
    v_mfma_f32_16x16x32_bf16 v[170:173], v[138:141], v[186:189], v[170:173]
    v_max3_u32 v25, v25, v166, v167
    v_mul_f32 v214, v182, v214
    v_mfma_f32_16x16x32_bf16 v[190:193], v[218:221], v[36:39], 0
    s_waitcnt lgkmcnt(1)
    v_mul_f32 v174, v166, v174
    v_mul_f32 v175, v166, v175
    v_mfma_f32_16x16x32_bf16 v[190:193], v[142:145], v[186:189], v[190:193]
    s_waitcnt lgkmcnt(0)
    v_cvt_pk_bf16_f32 v174, v174, v175
    v_mul_f32 v176, v166, v176
    v_mfma_f32_16x16x32_bf16 v[154:157], v[102:105], v[238:241], v[154:157]
    ds_read_b128 v[186:189], v0 offset:20480
    v_mul_f32 v177, v166, v177
    v_mfma_f32_16x16x32_bf16 v[154:157], v[106:109], v[118:121], v[154:157]
    ds_read_b128 v[194:197], v1 offset:20480
    v_cvt_pk_bf16_f32 v175, v176, v177
    v_mfma_f32_16x16x32_bf16 v[154:157], v[110:113], v[122:125], v[154:157]
    ds_read_b128 v[122:125], v0 offset:20608
    v_mul_f32 v170, v166, v170
    v_mfma_f32_16x16x32_bf16 v[118:121], v[146:149], v[28:31], 0
    ds_read_b128 v[202:205], v1 offset:20608
    v_mul_f32 v171, v166, v171
    v_mfma_f32_16x16x32_bf16 v[118:121], v[150:153], v[28:31], v[118:121]
    ds_read_b128 v[230:233], v0 offset:20736
    v_cvt_pk_bf16_f32 v176, v170, v171
    v_mfma_f32_16x16x32_bf16 v[234:237], v[146:149], v[134:137], 0
    ds_read_b128 v[238:241], v1 offset:20736
    v_fmac_f32 v255, v154, v154
    v_mfma_f32_16x16x32_bf16 v[234:237], v[150:153], v[162:165], v[234:237]
    v_fmac_f32 v255, v155, v155
    v_fmac_f32 v255, v156, v156
    v_mfma_f32_16x16x32_bf16 v[134:137], v[146:149], v[138:141], 0
    v_fmac_f32 v255, v157, v157
    v_cvt_pk_bf16_f32 v255, v255, v255
    v_mfma_f32_16x16x32_bf16 v[134:137], v[150:153], v[210:213], v[134:137]
    s_waitcnt lgkmcnt(5)
    ds_write_b64 v4, v[254:255] offset:18432
    v_mfma_f32_16x16x32_bf16 v[138:141], v[146:149], v[142:145], 0
    s_waitcnt lgkmcnt(4)
    v_mul_f32 v172, v166, v172
    v_mul_f32 v173, v166, v173
    v_mfma_f32_16x16x32_bf16 v[138:141], v[150:153], v[218:221], v[138:141]
    s_waitcnt lgkmcnt(3)
    v_cvt_pk_bf16_f32 v177, v172, v173
    v_mul_f32 v190, v166, v190
    v_mfma_f32_16x16x32_bf16 v[142:145], a[72:75], v[186:189], 0
    s_waitcnt lgkmcnt(2)
    ds_write_b128 v3, v[174:177] offset:12288
    v_mfma_f32_16x16x32_bf16 v[142:145], a[76:79], v[194:197], v[142:145]
    s_waitcnt lgkmcnt(2)
    v_mul_f32 v191, v166, v191
    v_cvt_pk_bf16_f32 v120, v190, v191
    v_mfma_f32_16x16x32_bf16 v[142:145], a[80:83], v[122:125], v[142:145]
    v_mul_f32 v192, v166, v192
    v_mul_f32 v193, v166, v193
    v_mfma_f32_16x16x32_bf16 v[142:145], a[84:87], v[202:205], v[142:145]
    v_cvt_pk_bf16_f32 v121, v192, v193
    v_mul_f32 v215, v182, v215
    v_mfma_f32_16x16x32_bf16 v[142:145], a[88:91], v[230:233], v[142:145]
    ds_write_b64 v4, v[120:121] offset:16384
    v_mfma_f32_16x16x32_bf16 v[142:145], a[92:95], v[238:241], v[142:145]
    v_rcp_f32 v118, v118
    v_mfma_f32_16x16x32_bf16 v[150:153], a[96:99], v[186:189], 0
    v_max3_u32 v25, v25, v118, v119
    v_mul_f32 v234, v234, v118
    v_mfma_f32_16x16x32_bf16 v[150:153], a[100:103], v[194:197], v[150:153]
    v_cvt_pk_bf16_f32 v146, v214, v215
    v_mul_f32_dpp v234, v134, v118 quad_perm:[0,1,2,3] row_mask:0x2 bank_mask:0xf
    v_mfma_f32_16x16x32_bf16 v[150:153], a[104:107], v[122:125], v[150:153]
    v_mul_f32 v216, v182, v216
    v_mul_f32_dpp v234, v138, v118 quad_perm:[0,1,2,3] row_mask:0x4 bank_mask:0xf
    v_mfma_f32_16x16x32_bf16 v[150:153], a[108:111], v[202:205], v[150:153]
    v_cvt_pk_bf16_f32 v234, v234, v234
    v_mul_f32 v217, v182, v217
    v_mfma_f32_16x16x32_bf16 v[150:153], a[112:115], v[230:233], v[150:153]
    ds_write_b16 v7, v234
    v_mfma_f32_16x16x32_bf16 v[150:153], a[116:119], v[238:241], v[150:153]
    v_cvt_pk_bf16_f32 v147, v216, v217
    v_mul_f32 v222, v182, v222
    v_mfma_f32_16x16x32_bf16 v[134:137], a[120:123], v[186:189], 0
    v_mul_f32 v223, v182, v223
    v_cvt_pk_bf16_f32 v148, v222, v223
    v_mfma_f32_16x16x32_bf16 v[134:137], a[124:127], v[194:197], v[134:137]
    v_mul_f32 v224, v182, v224
    v_mul_f32 v225, v182, v225
    v_mfma_f32_16x16x32_bf16 v[134:137], a[128:131], v[122:125], v[134:137]
    v_cvt_pk_bf16_f32 v149, v224, v225
    v_mul_f32 v226, v182, v226
    v_mfma_f32_16x16x32_bf16 v[134:137], a[132:135], v[202:205], v[134:137]
    ds_write_b128 v3, v[146:149] offset:0
    v_mfma_f32_16x16x32_bf16 v[134:137], a[136:139], v[230:233], v[134:137]
    v_mul_f32 v227, v182, v227
    v_cvt_pk_bf16_f32 v254, v226, v227
    v_mfma_f32_16x16x32_bf16 v[134:137], a[140:143], v[238:241], v[134:137]
    v_mul_f32 v228, v182, v228
    v_mul_f32 v229, v182, v229
    v_mfma_f32_16x16x32_bf16 v[138:141], a[0:3], v[186:189], 0
    v_cvt_pk_bf16_f32 v255, v228, v229
    v_xor_b32 v3, 65536, v3
    v_mfma_f32_16x16x32_bf16 v[138:141], a[4:7], v[194:197], v[138:141]
    ds_write_b64 v4, v[254:255] offset:4096
    v_mfma_f32_16x16x32_bf16 v[138:141], a[8:11], v[122:125], v[138:141]
    v_xor_b32 v4, 65536, v4
    v_add_u32 v7, s76, v7
    v_mfma_f32_16x16x32_bf16 v[138:141], a[12:15], v[202:205], v[138:141]
    v_cvt_pk_f16_f32 v146, v142, v143
    v_pk_mul_f16 v143, v146, v146
    v_mfma_f32_16x16x32_bf16 v[138:141], a[16:19], v[230:233], v[138:141]
    v_cvt_pk_f16_f32 v147, v144, v145
    v_pk_fma_f16 v143, v147, v147, v143
    v_mfma_f32_16x16x32_bf16 v[138:141], a[20:23], v[238:241], v[138:141]
    v_cvt_pk_f16_f32 v148, v150, v151
    v_pk_fma_f16 v143, v148, v148, v143
    v_mfma_f32_16x16x32_bf16 v[166:169], a[24:27], v[186:189], 0
    v_cvt_pk_f16_f32 v149, v152, v153
    v_pk_fma_f16 v143, v149, v149, v143
    v_mfma_f32_16x16x32_bf16 v[166:169], a[28:31], v[194:197], v[166:169]
    v_cvt_pk_f16_f32 v120, v134, v135
    v_pk_fma_f16 v143, v120, v120, v143
    v_mfma_f32_16x16x32_bf16 v[166:169], a[32:35], v[122:125], v[166:169]
    s_waitcnt lgkmcnt(0)
    v_cvt_pk_f16_f32 v121, v136, v137
    v_pk_fma_f16 v143, v121, v121, v143
    v_mfma_f32_16x16x32_bf16 v[166:169], a[36:39], v[202:205], v[166:169]
    s_barrier
    v_mfma_f32_16x16x32_bf16 v[166:169], a[40:43], v[230:233], v[166:169]
    s_nop 0
    v_mfma_f32_16x16x32_bf16 v[166:169], a[44:47], v[238:241], v[166:169]
    s_nop 0
    v_mfma_f32_16x16x32_bf16 v[134:137], a[48:51], v[186:189], 0
    s_nop 0
    v_mfma_f32_16x16x32_bf16 v[134:137], a[52:55], v[194:197], v[134:137]
    s_cbranch_scc1 L_loop_fast0
    s_branch L_final_fast
.p2align 6
L_loop_fast1:
    v_mfma_f32_16x16x32_bf16 v[134:137], a[56:59], v[122:125], v[134:137]
    s_add_u32 s12, s40, s27
    ds_read_b128 v[190:193], v2 offset:18432
    v_cvt_pk_f16_f32 v150, v138, v139
    v_mfma_f32_16x16x32_bf16 v[134:137], a[60:63], v[202:205], v[134:137]
    s_addc_u32 s13, s41, 0
    ds_read_b128 v[210:213], v2 offset:19456
    v_pk_mul_f16 v142, v150, v150
    v_mfma_f32_16x16x32_bf16 v[134:137], a[64:67], v[230:233], v[134:137]
    s_sub_u32 s14, s36, s27
    ds_read_b128 v[174:177], v5 offset:32
    v_cvt_pk_f16_f32 v151, v140, v141
    v_mfma_f32_16x16x32_bf16 v[134:137], a[68:71], v[238:241], v[134:137]
    s_cmp_ge_u32 s18, 2
    ds_read2_b64 v[162:165], v5 offset0:6 offset1:9
    v_pk_fma_f16 v142, v151, v151, v142
    v_mfma_f32_16x16x32_bf16 v[138:141], v[186:189], a[144:147], 0
    s_cselect_b32 s14, s14, 0
    ds_read_b128 v[170:173], v5
    v_cvt_pk_f16_f32 v152, v166, v167
    v_mfma_f32_16x16x32_bf16 v[138:141], v[194:197], a[148:151], v[138:141]
    s_sub_u32 s82, s72, s71
    ds_read_b32 v254, v6 offset:192
    v_pk_fma_f16 v142, v152, v152, v142
    v_mfma_f32_16x16x32_bf16 v[138:141], v[122:125], a[152:155], v[138:141]
    s_mul_i32 s74, s82, 336
    v_cvt_pk_f16_f32 v153, v168, v169
    v_pk_fma_f16 v142, v153, v153, v142
    v_mfma_f32_16x16x32_bf16 v[138:141], v[202:205], a[156:159], v[138:141]
    s_mul_i32 s75, s82, 272
    v_cvt_pk_f16_f32 v118, v134, v135
    v_pk_fma_f16 v142, v118, v118, v142
    v_mfma_f32_16x16x32_bf16 v[138:141], v[230:233], a[160:163], v[138:141]
    s_waitcnt lgkmcnt(5)
    ds_read_b128 v[182:185], v0 offset:26624
    v_cvt_pk_f16_f32 v119, v136, v137
    v_mfma_f32_16x16x32_bf16 v[166:169], v[32:35], v[190:193], 0
    s_waitcnt lgkmcnt(5)
    v_pk_fma_f16 v142, v119, v119, v142
    v_add_u32 v5, s74, v5
    v_mfma_f32_16x16x32_bf16 v[166:169], v[32:35], v[210:213], v[166:169]
    s_waitcnt lgkmcnt(4)
    v_pk_mul_f16 v145, v146, v174
    v_pk_fma_f16 v145, v147, v175, v145
    v_mfma_f32_16x16x32_bf16 v[138:141], v[238:241], a[164:167], v[138:141]
    s_mul_i32 s76, s82, 16
    ds_read_b128 v[210:213], v1 offset:26624
    v_pk_fma_f16 v145, v148, v176, v145
    v_mfma_f32_16x16x32_bf16 v[214:217], v[186:189], a[168:171], 0
    s_waitcnt lgkmcnt(3)
    ds_read_b128 v[218:221], v0 offset:26752
    v_pk_fma_f16 v145, v149, v177, v145
    v_mfma_f32_16x16x32_bf16 v[214:217], v[194:197], a[172:175], v[214:217]
    s_waitcnt lgkmcnt(3)
    ds_read_b128 v[222:225], v1 offset:26752
    v_mov_b32_dpp v254, v23 quad_perm:[0,1,2,3] row_mask:0x7 bank_mask:0xf
    v_mfma_f32_16x16x32_bf16 v[214:217], v[122:125], a[176:179], v[214:217]
    s_add_u32 s34, s18, 2
    ds_read_b128 v[226:229], v0 offset:26880
    v_pk_fma_f16 v145, v120, v164, v145
    v_mfma_f32_16x16x32_bf16 v[214:217], v[202:205], a[180:183], v[214:217]
    s_add_u32 s8, s60, s23
    ds_read_b128 v[190:193], v1 offset:26880
    v_pk_fma_f16 v145, v121, v165, v145
    v_mfma_f32_16x16x32_bf16 v[214:217], v[230:233], a[184:187], v[214:217]
    s_waitcnt lgkmcnt(5)
    v_pk_mul_f16 v144, v150, v170
    v_pk_fma_f16 v144, v151, v171, v144
    v_mfma_f32_16x16x32_bf16 v[214:217], v[238:241], a[188:191], v[214:217]
    s_addc_u32 s9, s61, 0
    v_pk_fma_f16 v144, v152, v172, v144
    v_pk_fma_f16 v144, v153, v173, v144
    v_mfma_f32_16x16x32_bf16 v[246:249], v[186:189], a[192:195], 0
    s_sub_u32 s10, s36, s23
    v_pk_fma_f16 v144, v118, v162, v144
    v_pk_fma_f16 v144, v119, v163, v144
    v_mfma_f32_16x16x32_bf16 v[246:249], v[194:197], a[196:199], v[246:249]
    s_cmp_le_u32 s34, s45
    v_cvt_pk_bf16_f32 v134, v138, v139
    v_cvt_pk_bf16_f32 v135, v140, v141
    v_mfma_f32_16x16x32_f16 v[234:237], v[40:43], v[142:145], 0
    s_cselect_b32 s10, s10, 0
    v_cvt_pk_bf16_f32 v138, v214, v215
    v_cvt_pk_bf16_f32 v139, v216, v217
    v_mfma_f32_16x16x32_bf16 v[246:249], v[122:125], a[200:203], v[246:249]
    s_add_u32 m0, s28, 0
    v_mul_f32 v136, 0x3baaaaab, v166
    v_mul_f32 v255, 0x3baaaaab, v167
    v_mfma_f32_16x16x32_bf16 v[246:249], v[202:205], a[204:207], v[246:249]
    s_mov_b32 s27, s26
    v_rsq_f32 v234, v234
    v_mfma_f32_16x16x32_bf16 v[246:249], v[230:233], a[208:211], v[246:249]
    s_mov_b32 s26, s25
    v_rsq_f32 v235, v235
    v_mfma_f32_16x16x32_bf16 v[246:249], v[238:241], a[212:215], v[246:249]
    s_mov_b32 s25, s24
    v_mul_f32 v140, s31, v234
    v_cvt_pk_f16_f32 v141, v140, v235
    v_mfma_f32_16x16x32_bf16 v[122:125], a[72:75], v[182:185], 0
    s_waitcnt lgkmcnt(0)
    v_fma_f32 v236, v236, v140, v22
    v_fmac_f32_dpp v254, v237, v235 quad_perm:[0,1,2,3] row_mask:0x1 bank_mask:0xf
    v_mfma_f32_16x16x32_bf16 v[122:125], a[76:79], v[210:213], v[122:125]
    s_mov_b32 s24, s23
    v_cvt_pk_bf16_f32 v142, v246, v247
    v_cvt_pk_bf16_f32 v143, v248, v249
    v_mfma_f32_16x16x32_bf16 v[122:125], a[80:83], v[218:221], v[122:125]
    s_mov_b32 s71, s72
    v_pk_mul_f16 v146, v146, v141 op_sel:[0,1] op_sel_hi:[1,1]
    v_pk_mul_f16 v147, v147, v141 op_sel:[0,1] op_sel_hi:[1,1]
    v_mfma_f32_16x16x32_bf16 v[122:125], a[84:87], v[222:225], v[122:125]
    s_mov_b32 s72, s73
    v_pk_mul_f16 v148, v148, v141 op_sel:[0,1] op_sel_hi:[1,1]
    v_pk_mul_f16 v149, v149, v141 op_sel:[0,1] op_sel_hi:[1,1]
    v_mfma_f32_16x16x32_bf16 v[122:125], a[88:91], v[226:229], v[122:125]
    v_pk_mul_f16 v120, v120, v141 op_sel:[0,1] op_sel_hi:[1,1]
    v_pk_mul_f16 v121, v121, v141 op_sel:[0,1] op_sel_hi:[1,1]
    v_mfma_f32_16x16x32_bf16 v[122:125], a[92:95], v[190:193], v[122:125]
    v_pk_mul_f16 v150, v150, v141 op_sel:[0,0] op_sel_hi:[1,0]
    v_pk_mul_f16 v151, v151, v141 op_sel:[0,0] op_sel_hi:[1,0]
    v_mfma_f32_16x16x32_bf16 v[186:189], a[96:99], v[182:185], 0
    v_pk_mul_f16 v152, v152, v141 op_sel:[0,0] op_sel_hi:[1,0]
    v_pk_mul_f16 v153, v153, v141 op_sel:[0,0] op_sel_hi:[1,0]
    v_mfma_f32_16x16x32_bf16 v[186:189], a[100:103], v[210:213], v[186:189]
    v_pk_mul_f16 v118, v118, v141 op_sel:[0,0] op_sel_hi:[1,0]
    v_pk_mul_f16 v119, v119, v141 op_sel:[0,0] op_sel_hi:[1,0]
    v_mfma_f32_16x16x32_bf16 v[186:189], a[104:107], v[218:221], v[186:189]
    v_max3_u32 v44, v44, v234, v235
    v_mul_f32 v144, 0x3baaaaab, v168
    v_mfma_f32_16x16x32_bf16 v[186:189], a[108:111], v[222:225], v[186:189]
    v_rsq_f32 v136, v136
    v_mfma_f32_16x16x32_bf16 v[186:189], a[112:115], v[226:229], v[186:189]
    v_rsq_f32 v255, v255
    v_mfma_f32_16x16x32_bf16 v[186:189], a[116:119], v[190:193], v[186:189]
    v_rsq_f32 v144, v144
    v_mfma_f32_16x16x32_bf16 v[194:197], a[120:123], v[182:185], 0
    v_mul_f32 v178, v136, v178
    v_mul_f32 v179, v136, v179
    v_mfma_f32_16x16x32_bf16 v[194:197], a[124:127], v[210:213], v[194:197]
    v_cvt_pk_bf16_f32 v166, v178, v179
    v_mul_f32 v180, v136, v180
    v_mfma_f32_16x16x32_bf16 v[194:197], a[128:131], v[218:221], v[194:197]
    v_mul_f32 v181, v136, v181
    v_cvt_pk_bf16_f32 v167, v180, v181
    v_mfma_f32_16x16x32_bf16 v[194:197], a[132:135], v[222:225], v[194:197]
    v_mul_f32 v198, v136, v198
    v_mul_f32 v199, v136, v199
    v_mfma_f32_16x16x32_bf16 v[194:197], a[136:139], v[226:229], v[194:197]
    v_cvt_pk_bf16_f32 v168, v198, v199
    v_mul_f32 v200, v136, v200
    v_mfma_f32_16x16x32_bf16 v[194:197], a[140:143], v[190:193], v[194:197]
    v_mul_f32 v201, v136, v201
    v_cvt_pk_bf16_f32 v169, v200, v201
    v_mfma_f32_16x16x32_bf16 v[178:181], a[0:3], v[182:185], 0
    buffer_store_dwordx4 v[166:169], v15, s[12:15], 0 offen nt
    v_mul_f32 v206, v136, v206
    v_mul_f32 v207, v136, v207
    v_cvt_pk_bf16_f32 v140, v206, v207
    v_mul_f32 v208, v136, v208
    v_mfma_f32_16x16x32_bf16 v[178:181], a[4:7], v[210:213], v[178:181]
    v_mul_f32 v209, v136, v209
    v_cvt_pk_bf16_f32 v141, v208, v209
    v_mfma_f32_16x16x32_bf16 v[178:181], a[8:11], v[218:221], v[178:181]
    v_cvt_pk_f16_f32 v166, v122, v123
    v_pk_mul_f16 v199, v166, v166
    v_mfma_f32_16x16x32_bf16 v[178:181], a[12:15], v[222:225], v[178:181]
    v_cvt_pk_f16_f32 v167, v124, v125
    v_pk_fma_f16 v199, v167, v167, v199
    v_mfma_f32_16x16x32_bf16 v[178:181], a[16:19], v[226:229], v[178:181]
    v_cvt_pk_f16_f32 v168, v186, v187
    v_pk_fma_f16 v199, v168, v168, v199
    v_mfma_f32_16x16x32_bf16 v[178:181], a[20:23], v[190:193], v[178:181]
    v_cvt_pk_f16_f32 v169, v188, v189
    v_pk_fma_f16 v199, v169, v169, v199
    v_mfma_f32_16x16x32_bf16 v[186:189], a[24:27], v[182:185], 0
    v_cvt_pk_f16_f32 v124, v194, v195
    v_pk_fma_f16 v199, v124, v124, v199
    v_mfma_f32_16x16x32_bf16 v[186:189], a[28:31], v[210:213], v[186:189]
    v_cvt_pk_f16_f32 v125, v196, v197
    v_pk_fma_f16 v199, v125, v125, v199
    v_mfma_f32_16x16x32_bf16 v[186:189], a[32:35], v[218:221], v[186:189]
    v_cvt_pk_f16_f32 v178, v178, v179
    v_pk_mul_f16 v198, v178, v178
    v_mfma_f32_16x16x32_bf16 v[186:189], a[36:39], v[222:225], v[186:189]
    v_cvt_pk_f16_f32 v179, v180, v181
    v_pk_fma_f16 v198, v179, v179, v198
    v_mfma_f32_16x16x32_bf16 v[186:189], a[40:43], v[226:229], v[186:189]
    v_pk_mul_f16 v200, v178, v170
    v_pk_fma_f16 v200, v179, v171, v200
    v_mfma_f32_16x16x32_bf16 v[186:189], a[44:47], v[190:193], v[186:189]
    v_pk_mul_f16 v201, v166, v174
    v_pk_fma_f16 v201, v167, v175, v201
    v_mfma_f32_16x16x32_bf16 v[194:197], a[48:51], v[182:185], 0
    v_pk_fma_f16 v201, v168, v176, v201
    v_pk_fma_f16 v201, v169, v177, v201
    v_mfma_f32_16x16x32_bf16 v[194:197], a[52:55], v[210:213], v[194:197]
    v_pk_fma_f16 v201, v124, v164, v201
    v_pk_fma_f16 v201, v125, v165, v201
    v_mfma_f32_16x16x32_bf16 v[194:197], a[56:59], v[218:221], v[194:197]
    v_cvt_pk_f16_f32 v180, v186, v187
    v_pk_fma_f16 v198, v180, v180, v198
    v_mfma_f32_16x16x32_bf16 v[194:197], a[60:63], v[222:225], v[194:197]
    v_cvt_pk_f16_f32 v181, v188, v189
    v_pk_fma_f16 v198, v181, v181, v198
    v_mfma_f32_16x16x32_bf16 v[194:197], a[64:67], v[226:229], v[194:197]
    v_pk_fma_f16 v200, v180, v172, v200
    v_pk_fma_f16 v200, v181, v173, v200
    v_mfma_f32_16x16x32_bf16 v[194:197], a[68:71], v[190:193], v[194:197]
    buffer_store_dwordx2 v[140:141], v18, s[12:15], 0 offen nt
    v_mul_f32 v242, v144, v242
    v_mul_f32 v243, v144, v243
    v_mfma_f32_16x16x32_bf16 v[186:189], v[182:185], a[144:147], 0
    v_cvt_pk_bf16_f32 v238, v242, v243
    v_mul_f32 v244, v144, v244
    v_mfma_f32_16x16x32_bf16 v[186:189], v[210:213], a[148:151], v[186:189]
    v_mul_f32 v245, v144, v245
    v_cvt_pk_f16_f32 v122, v194, v195
    v_mfma_f32_16x16x32_bf16 v[186:189], v[218:221], a[152:155], v[186:189]
    v_pk_fma_f16 v198, v122, v122, v198
    v_cvt_pk_f16_f32 v123, v196, v197
    v_mfma_f32_16x16x32_bf16 v[186:189], v[222:225], a[156:159], v[186:189]
    v_pk_fma_f16 v198, v123, v123, v198
    v_pk_fma_f16 v200, v122, v162, v200
    v_mfma_f32_16x16x32_bf16 v[186:189], v[226:229], a[160:163], v[186:189]
    ds_read_b128 v[202:205], v0 offset:32768
    v_pk_fma_f16 v200, v123, v163, v200
    v_mfma_f32_16x16x32_bf16 v[186:189], v[190:193], a[164:167], v[186:189]
    ds_read_b128 v[194:197], v1 offset:32768
    v_cvt_pk_bf16_f32 v239, v244, v245
    v_mfma_f32_16x16x32_f16 v[230:233], v[40:43], v[198:201], 0
    v_mul_f32 v158, v144, v158
    v_mul_f32 v159, v144, v159
    v_mfma_f32_16x16x32_bf16 v[246:249], v[182:185], a[168:171], 0
    ds_read_b128 v[214:217], v0 offset:32896
    v_cvt_pk_bf16_f32 v240, v158, v159
    v_mfma_f32_16x16x32_bf16 v[246:249], v[210:213], a[172:175], v[246:249]
    ds_read_b128 v[206:209], v1 offset:32896
    v_cvt_pk_bf16_f32 v136, v186, v187
    v_mfma_f32_16x16x32_bf16 v[246:249], v[218:221], a[176:179], v[246:249]
    ds_read_b128 v[198:201], v0 offset:33024
    v_cvt_pk_bf16_f32 v137, v188, v189
    v_mfma_f32_16x16x32_bf16 v[246:249], v[222:225], a[180:183], v[246:249]
    ds_read_b128 v[186:189], v1 offset:33024
    v_mul_f32 v160, v144, v160
    v_mfma_f32_16x16x32_bf16 v[246:249], v[226:229], a[184:187], v[246:249]
    v_rsq_f32 v230, v230
    v_mfma_f32_16x16x32_bf16 v[246:249], v[190:193], a[188:191], v[246:249]
    s_waitcnt lgkmcnt(5)
    v_rsq_f32 v231, v231
    v_mfma_f32_16x16x32_bf16 v[242:245], v[182:185], a[192:195], 0
    s_waitcnt lgkmcnt(4)
    v_mul_f32 v234, s31, v230
    v_cvt_pk_f16_f32 v235, v234, v231
    v_mfma_f32_16x16x32_bf16 v[242:245], v[210:213], a[196:199], v[242:245]
    v_fma_f32 v232, v232, v234, v24
    v_fmac_f32_dpp v254, v233, v231 quad_perm:[0,1,2,3] row_mask:0x2 bank_mask:0xf
    v_mfma_f32_16x16x32_bf16 v[242:245], v[218:221], a[200:203], v[242:245]
    s_waitcnt lgkmcnt(3)
    v_cvt_pk_bf16_f32 v140, v246, v247
    v_cvt_pk_bf16_f32 v141, v248, v249
    v_mfma_f32_16x16x32_bf16 v[242:245], v[222:225], a[204:207], v[242:245]
    s_waitcnt lgkmcnt(2)
    v_mul_f32 v161, v144, v161
    v_cvt_pk_bf16_f32 v241, v160, v161
    v_mfma_f32_16x16x32_bf16 v[242:245], v[226:229], a[208:211], v[242:245]
    s_waitcnt lgkmcnt(1)
    buffer_store_dwordx4 v[238:241], v17, s[12:15], 0 offen nt
    v_mul_f32 v154, v144, v154
    v_mul_f32 v155, v144, v155
    v_cvt_pk_bf16_f32 v154, v154, v155
    v_mul_f32 v156, v144, v156
    v_mfma_f32_16x16x32_bf16 v[242:245], v[190:193], a[212:215], v[242:245]
    s_waitcnt lgkmcnt(0)
    v_mul_f32 v157, v144, v157
    v_cvt_pk_bf16_f32 v155, v156, v157
    v_mfma_f32_16x16x32_bf16 v[158:161], a[72:75], v[202:205], 0
    v_pk_mul_f16 v166, v166, v235 op_sel:[0,1] op_sel_hi:[1,1]
    v_pk_mul_f16 v167, v167, v235 op_sel:[0,1] op_sel_hi:[1,1]
    v_mfma_f32_16x16x32_bf16 v[158:161], a[76:79], v[194:197], v[158:161]
    v_pk_mul_f16 v168, v168, v235 op_sel:[0,1] op_sel_hi:[1,1]
    v_cvt_pk_bf16_f32 v144, v242, v243
    v_mfma_f32_16x16x32_bf16 v[158:161], a[80:83], v[214:217], v[158:161]
    v_cvt_pk_bf16_f32 v145, v244, v245
    v_pk_mul_f16 v169, v169, v235 op_sel:[0,1] op_sel_hi:[1,1]
    v_mfma_f32_16x16x32_bf16 v[158:161], a[84:87], v[206:209], v[158:161]
    v_pk_mul_f16 v124, v124, v235 op_sel:[0,1] op_sel_hi:[1,1]
    v_pk_mul_f16 v125, v125, v235 op_sel:[0,1] op_sel_hi:[1,1]
    v_mfma_f32_16x16x32_bf16 v[158:161], a[88:91], v[198:201], v[158:161]
    v_pk_mul_f16 v178, v178, v235 op_sel:[0,0] op_sel_hi:[1,0]
    v_pk_mul_f16 v179, v179, v235 op_sel:[0,0] op_sel_hi:[1,0]
    v_mfma_f32_16x16x32_bf16 v[158:161], a[92:95], v[186:189], v[158:161]
    v_pk_mul_f16 v180, v180, v235 op_sel:[0,0] op_sel_hi:[1,0]
    v_pk_mul_f16 v181, v181, v235 op_sel:[0,0] op_sel_hi:[1,0]
    v_mfma_f32_16x16x32_bf16 v[182:185], a[96:99], v[202:205], 0
    v_pk_mul_f16 v122, v122, v235 op_sel:[0,0] op_sel_hi:[1,0]
    v_pk_mul_f16 v123, v123, v235 op_sel:[0,0] op_sel_hi:[1,0]
    v_mfma_f32_16x16x32_bf16 v[182:185], a[100:103], v[194:197], v[182:185]
    v_max3_u32 v44, v44, v230, v231
    v_mul_f32 v130, v255, v130
    v_mfma_f32_16x16x32_bf16 v[182:185], a[104:107], v[214:217], v[182:185]
    v_cvt_pk_f16_f32 v158, v158, v159
    v_pk_mul_f16 v191, v158, v158
    v_mfma_f32_16x16x32_bf16 v[182:185], a[108:111], v[206:209], v[182:185]
    v_cvt_pk_f16_f32 v159, v160, v161
    v_pk_fma_f16 v191, v159, v159, v191
    v_mfma_f32_16x16x32_bf16 v[182:185], a[112:115], v[198:201], v[182:185]
    v_pk_mul_f16 v193, v158, v174
    v_pk_fma_f16 v193, v159, v175, v193
    v_mfma_f32_16x16x32_bf16 v[182:185], a[116:119], v[186:189], v[182:185]
    v_exp_f32 v232, v232
    v_mfma_f32_16x16x32_bf16 v[210:213], a[120:123], v[202:205], 0
    v_exp_f32 v236, v236
    v_mfma_f32_16x16x32_bf16 v[210:213], a[124:127], v[194:197], v[210:213]
    v_cvt_pk_bf16_f32 v39, v236, 0
    v_mul_f32 v131, v255, v131
    v_mfma_f32_16x16x32_bf16 v[210:213], a[128:131], v[214:217], v[210:213]
    s_waitcnt vmcnt(3)
    ds_write_b16 v8, v45 offset:512
    v_mfma_f32_16x16x32_bf16 v[210:213], a[132:135], v[206:209], v[210:213]
    buffer_store_dwordx2 v[154:155], v20, s[12:15], 0 offen nt
    v_cvt_pk_f16_f32 v160, v182, v183
    v_mfma_f32_16x16x32_bf16 v[210:213], a[136:139], v[198:201], v[210:213]
    v_pk_fma_f16 v191, v160, v160, v191
    v_cvt_pk_f16_f32 v161, v184, v185
    v_mfma_f32_16x16x32_bf16 v[210:213], a[140:143], v[186:189], v[210:213]
    v_pk_fma_f16 v191, v161, v161, v191
    v_pk_fma_f16 v193, v160, v176, v193
    v_mfma_f32_16x16x32_bf16 v[154:157], a[0:3], v[202:205], 0
    v_pk_fma_f16 v193, v161, v177, v193
    v_cvt_pk_bf16_f32 v130, v130, v131
    v_mfma_f32_16x16x32_bf16 v[154:157], a[4:7], v[194:197], v[154:157]
    v_mul_f32 v132, v255, v132
    v_mul_f32 v133, v255, v133
    v_mfma_f32_16x16x32_bf16 v[154:157], a[8:11], v[214:217], v[154:157]
    v_cvt_pk_f16_f32 v176, v210, v211
    v_pk_fma_f16 v191, v176, v176, v191
    v_mfma_f32_16x16x32_bf16 v[154:157], a[12:15], v[206:209], v[154:157]
    s_waitcnt lgkmcnt(0)
    v_cvt_pk_f16_f32 v177, v212, v213
    v_pk_fma_f16 v191, v177, v177, v191
    v_mfma_f32_16x16x32_bf16 v[154:157], a[16:19], v[198:201], v[154:157]
    v_pk_fma_f16 v193, v176, v164, v193
    v_mfma_f32_16x16x32_bf16 v[154:157], a[20:23], v[186:189], v[154:157]
    s_barrier
    v_pk_fma_f16 v193, v177, v165, v193
    v_mfma_f32_16x16x32_bf16 v[182:185], a[24:27], v[202:205], 0
    v_cvt_pk_bf16_f32 v131, v132, v133
    v_mfma_f32_16x16x32_bf16 v[182:185], a[28:31], v[194:197], v[182:185]
    ds_read2_b32 v[164:165], v6 offset0:0 offset1:0
    v_mfma_f32_16x16x32_bf16 v[182:185], a[32:35], v[214:217], v[182:185]
    ds_read2_b32 v[212:213], v6 offset0:16 offset1:16
    v_cvt_pk_f16_f32 v154, v154, v155
    v_mfma_f32_16x16x32_bf16 v[182:185], a[36:39], v[206:209], v[182:185]
    ds_read2_b32 v[220:221], v6 offset0:32 offset1:32
    v_pk_mul_f16 v190, v154, v154
    v_mfma_f32_16x16x32_bf16 v[182:185], a[40:43], v[198:201], v[182:185]
    ds_read_u16 v133, v9 offset:384
    v_cvt_pk_f16_f32 v155, v156, v157
    v_mfma_f32_16x16x32_bf16 v[182:185], a[44:47], v[186:189], v[182:185]
    v_pk_fma_f16 v190, v155, v155, v190
    v_pk_mul_f16 v192, v154, v170
    v_mfma_f32_16x16x32_bf16 v[222:225], a[48:51], v[202:205], 0
    v_pk_fma_f16 v192, v155, v171, v192
    v_mul_f32 v126, v255, v126
    v_mfma_f32_16x16x32_bf16 v[222:225], a[52:55], v[194:197], v[222:225]
    v_mul_f32 v127, v255, v127
    v_cvt_pk_bf16_f32 v132, v126, v127
    v_mfma_f32_16x16x32_bf16 v[222:225], a[56:59], v[214:217], v[222:225]
    buffer_load_dwordx4 v10, s[8:11], 0 offen nt lds
    v_cvt_pk_f16_f32 v156, v182, v183
    v_mfma_f32_16x16x32_bf16 v[222:225], a[60:63], v[206:209], v[222:225]
    s_add_u32 m0, s28, 4096
    v_pk_fma_f16 v190, v156, v156, v190
    v_cvt_pk_f16_f32 v157, v184, v185
    v_mfma_f32_16x16x32_bf16 v[222:225], a[64:67], v[198:201], v[222:225]
    s_waitcnt lgkmcnt(2)
    v_pk_fma_f16 v190, v157, v157, v190
    v_pk_fma_f16 v192, v156, v172, v192
    v_mfma_f32_16x16x32_bf16 v[222:225], a[68:71], v[186:189], v[222:225]
    s_waitcnt lgkmcnt(1)
    ds_read_b128 v[182:185], v2 offset:0
    v_pk_fma_f16 v192, v157, v173, v192
    v_mfma_f32_16x16x32_bf16 v[170:173], v[202:205], a[144:147], 0
    s_waitcnt lgkmcnt(1)
    ds_read_b128 v[226:229], v2 offset:1024
    v_readfirstlane_b32 s77, v133
    v_mfma_f32_16x16x32_bf16 v[170:173], v[194:197], a[148:151], v[170:173]
    ds_read_b128 v[234:237], v2 offset:2048
    buffer_load_dwordx4 v11, s[8:11], 0 offen nt lds
    v_mfma_f32_16x16x32_bf16 v[170:173], v[214:217], a[152:155], v[170:173]
    s_add_u32 m0, s28, 8192
    ds_read_b128 v[238:241], v2 offset:3072
    v_cvt_pk_f16_f32 v174, v222, v223
    v_mfma_f32_16x16x32_bf16 v[170:173], v[206:209], a[156:159], v[170:173]
    s_mul_i32 s78, s77, 2688
    ds_read_b128 v[242:245], v2 offset:4096
    v_pk_fma_f16 v190, v174, v174, v190
    v_mfma_f32_16x16x32_bf16 v[170:173], v[198:201], a[160:163], v[170:173]
    ds_read_b128 v[246:249], v2 offset:5120
    v_cvt_pk_f16_f32 v175, v224, v225
    v_mfma_f32_16x16x32_bf16 v[170:173], v[186:189], a[164:167], v[170:173]
    v_pk_fma_f16 v190, v175, v175, v190
    v_pk_fma_f16 v192, v174, v162, v192
    v_mfma_f32_16x16x32_bf16 v[222:225], v[202:205], a[168:171], 0
    buffer_load_dwordx4 v12, s[8:11], 0 offen nt lds
    v_pk_fma_f16 v192, v175, v163, v192
    v_mfma_f32_16x16x32_bf16 v[222:225], v[194:197], a[172:175], v[222:225]
    s_waitcnt lgkmcnt(5)
    v_mul_f32 v128, v255, v128
    v_cvt_pk_bf16_f32 v162, v170, v171
    v_mfma_f32_16x16x32_f16 v[250:253], v[40:43], v[190:193], 0
    s_add_u32 m0, s28, 12288
    v_cvt_pk_bf16_f32 v163, v172, v173
    v_mul_f32 v129, v255, v129
    v_mfma_f32_16x16x32_bf16 v[222:225], v[214:217], a[176:179], v[222:225]
    s_xor_b32 s28, s28, 65536
    v_cvt_pk_bf16_f32 v133, v128, v129
    v_mul_f32 v114, v255, v114
    v_mfma_f32_16x16x32_bf16 v[222:225], v[206:209], a[180:183], v[222:225]
    s_waitcnt lgkmcnt(2)
    v_rsq_f32 v250, v250
    v_mfma_f32_16x16x32_bf16 v[222:225], v[198:201], a[184:187], v[222:225]
    s_waitcnt lgkmcnt(1)
    buffer_load_dwordx4 v13, s[8:11], 0 offen nt lds
    v_mul_f32 v230, s31, v250
    v_mfma_f32_16x16x32_bf16 v[222:225], v[186:189], a[188:191], v[222:225]
    s_mov_b32 m0, s29
    v_rsq_f32 v251, v251
    v_mfma_f32_16x16x32_bf16 v[126:129], v[202:205], a[192:195], 0
    s_xor_b32 s29, s29, s30
    v_cvt_pk_f16_f32 v231, v230, v251
    v_fma_f32 v252, v252, v230, v26
    v_mfma_f32_16x16x32_bf16 v[126:129], v[194:197], a[196:199], v[126:129]
    s_add_u32 s19, s19, s20
    v_fmac_f32_dpp v254, v253, v251 quad_perm:[0,1,2,3] row_mask:0x4 bank_mask:0xf
    v_cvt_pk_bf16_f32 v210, v222, v223
    v_mfma_f32_16x16x32_bf16 v[126:129], v[214:217], a[200:203], v[126:129]
    s_add_u32 s23, s23, s21
    v_cvt_pk_bf16_f32 v211, v224, v225
    v_pk_mul_f16 v158, v158, v231 op_sel:[0,1] op_sel_hi:[1,1]
    v_mfma_f32_16x16x32_bf16 v[126:129], v[206:209], a[204:207], v[126:129]
    s_waitcnt lgkmcnt(0)
    buffer_load_dwordx4 v14, s[8:11], 0 offen nt lds
    v_pk_mul_f16 v159, v159, v231 op_sel:[0,1] op_sel_hi:[1,1]
    v_mfma_f32_16x16x32_bf16 v[126:129], v[198:201], a[208:211], v[126:129]
    s_cmp_ge_u32 s19, 72
    v_pk_mul_f16 v160, v160, v231 op_sel:[0,1] op_sel_hi:[1,1]
    v_pk_mul_f16 v161, v161, v231 op_sel:[0,1] op_sel_hi:[1,1]
    v_mfma_f32_16x16x32_bf16 v[126:129], v[186:189], a[212:215], v[126:129]
    s_cselect_b32 s34, 72, 0
    v_pk_mul_f16 v176, v176, v231 op_sel:[0,1] op_sel_hi:[1,1]
    v_pk_mul_f16 v177, v177, v231 op_sel:[0,1] op_sel_hi:[1,1]
    v_mfma_f32_16x16x32_f16 v[170:173], v[146:149], v[150:153], v[46:49]
    s_cselect_b32 s35, s22, 0
    v_pk_mul_f16 v154, v154, v231 op_sel:[0,0] op_sel_hi:[1,0]
    v_pk_mul_f16 v155, v155, v231 op_sel:[0,0] op_sel_hi:[1,0]
    v_mfma_f32_16x16x32_f16 v[186:189], v[166:169], v[150:153], v[50:53]
    s_sub_u32 s19, s19, s34
    v_cvt_pk_bf16_f32 v218, v126, v127
    v_cvt_pk_bf16_f32 v219, v128, v129
    v_mfma_f32_16x16x32_f16 v[126:129], v[158:161], v[150:153], v[54:57]
    buffer_store_dwordx4 v[130:133], v16, s[12:15], 0 offen nt
    v_pk_mul_f16 v156, v156, v231 op_sel:[0,0] op_sel_hi:[1,0]
    v_pk_mul_f16 v157, v157, v231 op_sel:[0,0] op_sel_hi:[1,0]
    v_pk_mul_f16 v174, v174, v231 op_sel:[0,0] op_sel_hi:[1,0]
    v_pk_mul_f16 v175, v175, v231 op_sel:[0,0] op_sel_hi:[1,0]
    v_mfma_f32_16x16x16_f16 v[170:173], v[120:121], v[118:119], v[170:173]
    v_max3_u32 v44, v44, v250, v251
    v_exp_f32 v254, v254
    v_mfma_f32_16x16x16_f16 v[186:189], v[124:125], v[118:119], v[186:189]
    v_cvt_pk_bf16_f32 v254, v254, v254
    v_exp_f32 v252, v252
    v_mfma_f32_16x16x16_f16 v[126:129], v[176:177], v[118:119], v[126:129]
    v_mul_f32 v115, v255, v115
    v_cvt_pk_bf16_f32 v118, v114, v115
    v_exp_f32 v170, v170
    v_mfma_f32_16x16x32_f16 v[130:133], v[146:149], v[178:181], v[58:61]
    s_add_u32 s23, s23, s35
    ds_write_b16 v8, v254
    v_mfma_f32_16x16x32_f16 v[150:153], v[166:169], v[178:181], v[62:65]
    s_add_u32 s78, s78, s69
    v_exp_f32 v171, v171
    v_mfma_f32_16x16x32_f16 v[190:193], v[158:161], v[178:181], v[66:69]
    s_add_u32 s80, s77, s68
    v_cvt_pk_bf16_f32 v170, v170, v171
    v_exp_f32 v172, v172
    v_mfma_f32_16x16x16_f16 v[130:133], v[120:121], v[122:123], v[130:133]
    v_exp_f32 v173, v173
    v_mul_f32 v116, v255, v116
    v_mfma_f32_16x16x16_f16 v[150:153], v[124:125], v[122:123], v[150:153]
    v_cvt_pk_bf16_f32 v171, v172, v173
    v_exp_f32 v186, v186
    v_mfma_f32_16x16x16_f16 v[190:193], v[176:177], v[122:123], v[190:193]
    v_exp_f32 v187, v187
    v_exp_f32 v188, v188
    v_mfma_f32_16x16x32_bf16 v[178:181], a[216:219], v[182:185], 0
    s_cmp_ge_u32 s80, 72
    v_exp_f32 v130, v130
    v_mfma_f32_16x16x32_bf16 v[178:181], a[220:223], v[226:229], v[178:181]
    s_cselect_b32 s80, s22, 0
    v_exp_f32 v131, v131
    v_mfma_f32_16x16x32_bf16 v[178:181], a[224:227], v[234:237], v[178:181]
    s_add_u32 s78, s78, s80
    v_cvt_pk_bf16_f32 v194, v130, v131
    v_cvt_pk_bf16_f32 v172, v186, v187
    v_mfma_f32_16x16x32_bf16 v[178:181], a[228:231], v[238:241], v[178:181]
    s_add_u32 s80, s77, 20
    v_exp_f32 v132, v132
    v_mfma_f32_16x16x32_bf16 v[178:181], a[232:235], v[242:245], v[178:181]
    s_add_u32 s34, s18, 3
    v_exp_f32 v133, v133
    v_mfma_f32_16x16x32_bf16 v[178:181], a[236:239], v[246:249], v[178:181]
    s_cmp_lt_u32 s77, s62
    v_cvt_pk_bf16_f32 v195, v132, v133
    v_mul_f32 v117, v255, v117
    v_mfma_f32_16x16x32_bf16 v[198:201], a[240:243], v[182:185], 0
    s_cselect_b32 s79, 1, 0
    v_exp_f32 v150, v150
    v_mfma_f32_16x16x32_f16 v[202:205], v[146:149], v[154:157], v[70:73]
    s_cselect_b32 s78, s78, 0
    v_exp_f32 v151, v151
    v_mfma_f32_16x16x32_f16 v[146:149], v[166:169], v[154:157], v[74:77]
    s_cmp_lt_u32 s34, s17
    v_cvt_pk_bf16_f32 v196, v150, v151
    v_cvt_pk_bf16_f32 v119, v116, v117
    v_mfma_f32_16x16x32_f16 v[166:169], v[158:161], v[154:157], v[78:81]
    buffer_store_dwordx2 v[118:119], v19, s[12:15], 0 offen nt
    v_exp_f32 v152, v152
    v_mfma_f32_16x16x16_f16 v[202:205], v[120:121], v[174:175], v[202:205]
    v_exp_f32 v153, v153
    v_fma_f32 v254, v178, v178, s33
    v_mfma_f32_16x16x16_f16 v[146:149], v[124:125], v[174:175], v[146:149]
    v_cvt_pk_bf16_f32 v197, v152, v153
    v_exp_f32 v190, v190
    v_mfma_f32_16x16x16_f16 v[166:169], v[176:177], v[174:175], v[166:169]
    v_exp_f32 v191, v191
    v_exp_f32 v192, v192
    v_mfma_f32_16x16x32_bf16 v[198:201], a[244:247], v[226:229], v[198:201]
    s_cselect_b32 s23, s23, s78
    v_exp_f32 v193, v193
    v_mfma_f32_16x16x32_bf16 v[198:201], a[248:251], v[234:237], v[198:201]
    s_cselect_b32 s73, s34, s80
    ds_read_b128 v[118:121], v2 offset:6144
    v_fmac_f32 v254, v179, v179
    v_mfma_f32_16x16x32_bf16 v[198:201], a[252:255], v[238:241], v[198:201]
    s_cselect_b32 s79, 0, s79
    ds_read_b128 v[122:125], v2 offset:7168
    v_fmac_f32 v254, v180, v180
    v_mfma_f32_16x16x32_bf16 v[198:201], v[82:85], v[242:245], v[198:201]
    s_cselect_b32 s81, 0, 1
    ds_read_b128 v[150:153], v2 offset:8192
    v_fmac_f32 v254, v181, v181
    v_mfma_f32_16x16x32_bf16 v[198:201], v[86:89], v[246:249], v[198:201]
    s_add_u32 s80, s77, 1
    ds_read_b128 v[154:157], v2 offset:9216
    v_xor_b32 v0, 65536, v0
    v_mfma_f32_16x16x32_bf16 v[206:209], v[90:93], v[182:185], 0
    s_mul_i32 s80, s80, s81
    ds_read_b128 v[158:161], v2 offset:10240
    v_xor_b32 v1, 65536, v1
    v_mfma_f32_16x16x32_bf16 v[206:209], v[94:97], v[226:229], v[206:209]
    s_cmp_lt_u32 s80, s62
    ds_read_b128 v[174:177], v2 offset:11264
    v_fmac_f32 v254, v198, v198
    v_mfma_f32_16x16x32_bf16 v[206:209], v[98:101], v[234:237], v[206:209]
    s_cselect_b32 s62, s62, 0
    v_exp_f32 v189, v189
    v_mfma_f32_16x16x32_bf16 v[206:209], v[102:105], v[238:241], v[206:209]
    s_add_u32 s80, s18, 4
    v_cvt_pk_bf16_f32 v173, v188, v189
    v_fmac_f32 v254, v199, v199
    v_mfma_f32_16x16x32_bf16 v[206:209], v[106:109], v[242:245], v[206:209]
    s_waitcnt lgkmcnt(5)
    v_exp_f32 v126, v126
    v_mfma_f32_16x16x32_bf16 v[206:209], v[110:113], v[246:249], v[206:209]
    s_cmp_ge_u32 s80, s17
    v_exp_f32 v127, v127
    v_mfma_f32_16x16x32_bf16 v[130:133], a[216:219], v[118:121], 0
    s_waitcnt lgkmcnt(3)
    v_cvt_pk_bf16_f32 v36, v126, v127
    v_fmac_f32 v254, v200, v200
    v_mfma_f32_16x16x32_bf16 v[130:133], a[220:223], v[122:125], v[130:133]
    s_cselect_b32 s66, s62, 0
    v_exp_f32 v128, v128
    v_mfma_f32_16x16x32_bf16 v[130:133], a[224:227], v[150:153], v[130:133]
    s_waitcnt lgkmcnt(1)
    v_fmac_f32 v254, v201, v201
    v_mfma_f32_16x16x32_bf16 v[130:133], a[228:231], v[154:157], v[130:133]
    s_lshl_b32 s80, s79, s73
    v_exp_f32 v129, v129
    v_mfma_f32_16x16x32_bf16 v[130:133], a[232:235], v[158:161], v[130:133]
    s_waitcnt lgkmcnt(0)
    v_cvt_pk_bf16_f32 v37, v128, v129
    v_fmac_f32 v254, v206, v206
    v_mfma_f32_16x16x32_bf16 v[130:133], a[236:239], v[174:177], v[130:133]
    s_or_b32 s70, s70, s80
    v_exp_f32 v202, v202
    v_mfma_f32_16x16x32_bf16 v[182:185], v[28:31], v[36:39], 0
    s_add_u32 s45, s45, s79
    v_exp_f32 v203, v203
    v_mfma_f32_16x16x32_bf16 v[182:185], v[28:31], v[170:173], v[182:185]
    s_add_u32 s18, s18, 1
    v_cvt_pk_bf16_f32 v186, v202, v203
    v_fma_f32 v255, v130, v130, s33
    v_mfma_f32_16x16x32_bf16 v[214:217], v[162:165], v[36:39], 0
    s_cmp_lt_u32 s18, s45
    v_fmac_f32 v255, v131, v131
    v_fmac_f32 v255, v132, v132
    v_mfma_f32_16x16x32_bf16 v[214:217], v[134:137], v[170:173], v[214:217]
    v_fmac_f32 v255, v133, v133
    v_fmac_f32 v254, v207, v207
    v_mfma_f32_16x16x32_bf16 v[222:225], v[210:213], v[36:39], 0
    v_exp_f32 v204, v204
    v_mfma_f32_16x16x32_bf16 v[222:225], v[138:141], v[170:173], v[222:225]
    v_exp_f32 v205, v205
    v_mfma_f32_16x16x32_bf16 v[226:229], v[218:221], v[36:39], 0
    v_cvt_pk_bf16_f32 v36, v190, v191
    v_cvt_pk_bf16_f32 v37, v192, v193
    v_mfma_f32_16x16x32_bf16 v[226:229], v[142:145], v[170:173], v[226:229]
    v_cvt_pk_bf16_f32 v39, v232, 0
    v_cvt_pk_bf16_f32 v187, v204, v205
    v_mfma_f32_16x16x32_bf16 v[126:129], a[240:243], v[118:121], 0
    v_exp_f32 v146, v146
    v_mfma_f32_16x16x32_bf16 v[170:173], v[28:31], v[36:39], 0
    v_exp_f32 v147, v147
    v_mfma_f32_16x16x32_bf16 v[170:173], v[28:31], v[194:197], v[170:173]
    v_cvt_pk_bf16_f32 v188, v146, v147
    v_fmac_f32 v254, v208, v208
    v_mfma_f32_16x16x32_bf16 v[114:117], v[162:165], v[36:39], 0
    v_exp_f32 v148, v148
    v_mfma_f32_16x16x32_bf16 v[114:117], v[134:137], v[194:197], v[114:117]
    v_exp_f32 v149, v149
    v_mfma_f32_16x16x32_bf16 v[190:193], v[210:213], v[36:39], 0
    v_cvt_pk_bf16_f32 v189, v148, v149
    v_fmac_f32 v254, v209, v209
    v_mfma_f32_16x16x32_bf16 v[190:193], v[138:141], v[194:197], v[190:193]
    v_rcp_f32 v170, v170
    v_mfma_f32_16x16x32_bf16 v[146:149], v[218:221], v[36:39], 0
    v_exp_f32 v166, v166
    v_mfma_f32_16x16x32_bf16 v[146:149], v[142:145], v[194:197], v[146:149]
    v_mul_f32 v114, v170, v114
    v_mul_f32 v115, v170, v115
    v_mfma_f32_16x16x32_bf16 v[126:129], a[244:247], v[122:125], v[126:129]
    v_cvt_pk_bf16_f32 v194, v114, v115
    v_mul_f32 v116, v170, v116
    v_mfma_f32_16x16x32_bf16 v[126:129], a[248:251], v[150:153], v[126:129]
    ds_read_b128 v[202:205], v2 offset:12288
    v_mul_f32 v117, v170, v117
    v_mfma_f32_16x16x32_bf16 v[126:129], a[252:255], v[154:157], v[126:129]
    ds_read_b128 v[230:233], v2 offset:13312
    v_cvt_pk_bf16_f32 v195, v116, v117
    v_mfma_f32_16x16x32_bf16 v[126:129], v[82:85], v[158:161], v[126:129]
    ds_read_b128 v[234:237], v2 offset:14336
    v_mul_f32 v190, v170, v190
    v_mfma_f32_16x16x32_bf16 v[126:129], v[86:89], v[174:177], v[126:129]
    ds_read_b128 v[238:241], v2 offset:15360
    v_mul_f32 v191, v170, v191
    v_mfma_f32_16x16x32_bf16 v[114:117], v[90:93], v[118:121], 0
    ds_read_b128 v[118:121], v2 offset:16384
    v_cvt_pk_bf16_f32 v196, v190, v191
    v_mfma_f32_16x16x32_bf16 v[114:117], v[94:97], v[122:125], v[114:117]
    ds_read_b128 v[122:125], v2 offset:17408
    v_mul_f32 v192, v170, v192
    v_mfma_f32_16x16x32_bf16 v[114:117], v[98:101], v[150:153], v[114:117]
    v_fmac_f32 v255, v126, v126
    v_fmac_f32 v255, v127, v127
    v_mfma_f32_16x16x32_bf16 v[114:117], v[102:105], v[154:157], v[114:117]
    v_fmac_f32 v255, v128, v128
    v_fmac_f32 v255, v129, v129
    v_mfma_f32_16x16x32_bf16 v[114:117], v[106:109], v[158:161], v[114:117]
    s_waitcnt lgkmcnt(5)
    v_mul_f32 v193, v170, v193
    v_cvt_pk_bf16_f32 v197, v192, v193
    v_mfma_f32_16x16x32_bf16 v[114:117], v[110:113], v[174:177], v[114:117]
    s_waitcnt lgkmcnt(4)
    ds_write_b128 v3, v[194:197] offset:6144
    v_mfma_f32_16x16x32_bf16 v[242:245], a[216:219], v[202:205], 0
    s_waitcnt lgkmcnt(3)
    v_mul_f32 v146, v170, v146
    v_mul_f32 v147, v170, v147
    v_mfma_f32_16x16x32_bf16 v[242:245], a[220:223], v[230:233], v[242:245]
    s_waitcnt lgkmcnt(2)
    v_fmac_f32 v255, v114, v114
    v_fmac_f32 v255, v115, v115
    v_mfma_f32_16x16x32_bf16 v[242:245], a[224:227], v[234:237], v[242:245]
    s_waitcnt lgkmcnt(1)
    v_fmac_f32 v255, v116, v116
    v_fmac_f32 v255, v117, v117
    v_mfma_f32_16x16x32_bf16 v[242:245], a[228:231], v[238:241], v[242:245]
    v_cvt_pk_bf16_f32 v254, v254, v255
    v_cvt_pk_bf16_f32 v172, v146, v147
    v_mfma_f32_16x16x32_bf16 v[242:245], a[232:235], v[118:121], v[242:245]
    v_mul_f32 v148, v170, v148
    v_mul_f32 v149, v170, v149
    v_mfma_f32_16x16x32_bf16 v[242:245], a[236:239], v[122:125], v[242:245]
    v_cvt_pk_bf16_f32 v173, v148, v149
    v_cvt_pk_bf16_f32 v39, v252, 0
    v_mfma_f32_16x16x32_bf16 v[158:161], a[240:243], v[202:205], 0
    ds_write_b64 v4, v[172:173] offset:10240
    v_mfma_f32_16x16x32_bf16 v[158:161], a[244:247], v[230:233], v[158:161]
    v_exp_f32 v167, v167
    v_mfma_f32_16x16x32_bf16 v[158:161], a[248:251], v[234:237], v[158:161]
    v_cvt_pk_bf16_f32 v36, v166, v167
    v_fma_f32 v255, v242, v242, s33
    v_mfma_f32_16x16x32_bf16 v[158:161], a[252:255], v[238:241], v[158:161]
    v_fmac_f32 v255, v243, v243
    v_fmac_f32 v255, v244, v244
    v_mfma_f32_16x16x32_bf16 v[158:161], v[82:85], v[118:121], v[158:161]
    v_fmac_f32 v255, v245, v245
    v_xor_b32 v2, 65536, v2
    v_mfma_f32_16x16x32_bf16 v[158:161], v[86:89], v[122:125], v[158:161]
    v_exp_f32 v168, v168
    v_mfma_f32_16x16x32_bf16 v[154:157], v[90:93], v[202:205], 0
    v_exp_f32 v169, v169
    v_mfma_f32_16x16x32_bf16 v[154:157], v[94:97], v[230:233], v[154:157]
    ds_read_b128 v[146:149], v9
    v_cvt_pk_bf16_f32 v37, v168, v169
    v_mfma_f32_16x16x32_bf16 v[154:157], v[98:101], v[234:237], v[154:157]
    ds_read_b128 v[150:153], v9 offset:64
    v_fmac_f32 v255, v158, v158
    v_mfma_f32_16x16x32_bf16 v[166:169], v[28:31], v[36:39], 0
    v_fmac_f32 v255, v159, v159
    v_fmac_f32 v255, v160, v160
    v_mfma_f32_16x16x32_bf16 v[166:169], v[28:31], v[186:189], v[166:169]
    v_fmac_f32 v255, v161, v161
    v_add_u32 v6, s75, v6
    v_mfma_f32_16x16x32_bf16 v[174:177], v[162:165], v[36:39], 0
    v_rcp_f32 v182, v182
    v_mfma_f32_16x16x32_bf16 v[174:177], v[134:137], v[186:189], v[174:177]
    v_max3_u32 v25, v25, v182, v183
    v_max3_u32 v25, v25, v170, v171
    v_mfma_f32_16x16x32_bf16 v[170:173], v[210:213], v[36:39], 0
    v_rcp_f32 v166, v166
    v_mfma_f32_16x16x32_bf16 v[170:173], v[138:141], v[186:189], v[170:173]
    v_max3_u32 v25, v25, v166, v167
    v_mul_f32 v214, v182, v214
    v_mfma_f32_16x16x32_bf16 v[190:193], v[218:221], v[36:39], 0
    s_waitcnt lgkmcnt(1)
    v_mul_f32 v174, v166, v174
    v_mul_f32 v175, v166, v175
    v_mfma_f32_16x16x32_bf16 v[190:193], v[142:145], v[186:189], v[190:193]
    s_waitcnt lgkmcnt(0)
    v_cvt_pk_bf16_f32 v174, v174, v175
    v_mul_f32 v176, v166, v176
    v_mfma_f32_16x16x32_bf16 v[154:157], v[102:105], v[238:241], v[154:157]
    ds_read_b128 v[186:189], v0 offset:20480
    v_mul_f32 v177, v166, v177
    v_mfma_f32_16x16x32_bf16 v[154:157], v[106:109], v[118:121], v[154:157]
    ds_read_b128 v[194:197], v1 offset:20480
    v_cvt_pk_bf16_f32 v175, v176, v177
    v_mfma_f32_16x16x32_bf16 v[154:157], v[110:113], v[122:125], v[154:157]
    ds_read_b128 v[122:125], v0 offset:20608
    v_mul_f32 v170, v166, v170
    v_mfma_f32_16x16x32_bf16 v[118:121], v[146:149], v[28:31], 0
    ds_read_b128 v[202:205], v1 offset:20608
    v_mul_f32 v171, v166, v171
    v_mfma_f32_16x16x32_bf16 v[118:121], v[150:153], v[28:31], v[118:121]
    ds_read_b128 v[230:233], v0 offset:20736
    v_cvt_pk_bf16_f32 v176, v170, v171
    v_mfma_f32_16x16x32_bf16 v[234:237], v[146:149], v[134:137], 0
    ds_read_b128 v[238:241], v1 offset:20736
    v_fmac_f32 v255, v154, v154
    v_mfma_f32_16x16x32_bf16 v[234:237], v[150:153], v[162:165], v[234:237]
    v_fmac_f32 v255, v155, v155
    v_fmac_f32 v255, v156, v156
    v_mfma_f32_16x16x32_bf16 v[134:137], v[146:149], v[138:141], 0
    v_fmac_f32 v255, v157, v157
    v_cvt_pk_bf16_f32 v255, v255, v255
    v_mfma_f32_16x16x32_bf16 v[134:137], v[150:153], v[210:213], v[134:137]
    s_waitcnt lgkmcnt(5)
    ds_write_b64 v4, v[254:255] offset:18432
    v_mfma_f32_16x16x32_bf16 v[138:141], v[146:149], v[142:145], 0
    s_waitcnt lgkmcnt(4)
    v_mul_f32 v172, v166, v172
    v_mul_f32 v173, v166, v173
    v_mfma_f32_16x16x32_bf16 v[138:141], v[150:153], v[218:221], v[138:141]
    s_waitcnt lgkmcnt(3)
    v_cvt_pk_bf16_f32 v177, v172, v173
    v_mul_f32 v190, v166, v190
    v_mfma_f32_16x16x32_bf16 v[142:145], a[72:75], v[186:189], 0
    s_waitcnt lgkmcnt(2)
    ds_write_b128 v3, v[174:177] offset:12288
    v_mfma_f32_16x16x32_bf16 v[142:145], a[76:79], v[194:197], v[142:145]
    s_waitcnt lgkmcnt(2)
    v_mul_f32 v191, v166, v191
    v_cvt_pk_bf16_f32 v120, v190, v191
    v_mfma_f32_16x16x32_bf16 v[142:145], a[80:83], v[122:125], v[142:145]
    v_mul_f32 v192, v166, v192
    v_mul_f32 v193, v166, v193
    v_mfma_f32_16x16x32_bf16 v[142:145], a[84:87], v[202:205], v[142:145]
    v_cvt_pk_bf16_f32 v121, v192, v193
    v_mul_f32 v215, v182, v215
    v_mfma_f32_16x16x32_bf16 v[142:145], a[88:91], v[230:233], v[142:145]
    ds_write_b64 v4, v[120:121] offset:16384
    v_mfma_f32_16x16x32_bf16 v[142:145], a[92:95], v[238:241], v[142:145]
    v_rcp_f32 v118, v118
    v_mfma_f32_16x16x32_bf16 v[150:153], a[96:99], v[186:189], 0
    v_max3_u32 v25, v25, v118, v119
    v_mul_f32 v234, v234, v118
    v_mfma_f32_16x16x32_bf16 v[150:153], a[100:103], v[194:197], v[150:153]
    v_cvt_pk_bf16_f32 v146, v214, v215
    v_mul_f32_dpp v234, v134, v118 quad_perm:[0,1,2,3] row_mask:0x2 bank_mask:0xf
    v_mfma_f32_16x16x32_bf16 v[150:153], a[104:107], v[122:125], v[150:153]
    v_mul_f32 v216, v182, v216
    v_mul_f32_dpp v234, v138, v118 quad_perm:[0,1,2,3] row_mask:0x4 bank_mask:0xf
    v_mfma_f32_16x16x32_bf16 v[150:153], a[108:111], v[202:205], v[150:153]
    v_cvt_pk_bf16_f32 v234, v234, v234
    v_mul_f32 v217, v182, v217
    v_mfma_f32_16x16x32_bf16 v[150:153], a[112:115], v[230:233], v[150:153]
    ds_write_b16 v7, v234
    v_mfma_f32_16x16x32_bf16 v[150:153], a[116:119], v[238:241], v[150:153]
    v_cvt_pk_bf16_f32 v147, v216, v217
    v_mul_f32 v222, v182, v222
    v_mfma_f32_16x16x32_bf16 v[134:137], a[120:123], v[186:189], 0
    v_mul_f32 v223, v182, v223
    v_cvt_pk_bf16_f32 v148, v222, v223
    v_mfma_f32_16x16x32_bf16 v[134:137], a[124:127], v[194:197], v[134:137]
    v_mul_f32 v224, v182, v224
    v_mul_f32 v225, v182, v225
    v_mfma_f32_16x16x32_bf16 v[134:137], a[128:131], v[122:125], v[134:137]
    v_cvt_pk_bf16_f32 v149, v224, v225
    v_mul_f32 v226, v182, v226
    v_mfma_f32_16x16x32_bf16 v[134:137], a[132:135], v[202:205], v[134:137]
    ds_write_b128 v3, v[146:149] offset:0
    v_mfma_f32_16x16x32_bf16 v[134:137], a[136:139], v[230:233], v[134:137]
    v_mul_f32 v227, v182, v227
    v_cvt_pk_bf16_f32 v254, v226, v227
    v_mfma_f32_16x16x32_bf16 v[134:137], a[140:143], v[238:241], v[134:137]
    v_mul_f32 v228, v182, v228
    v_mul_f32 v229, v182, v229
    v_mfma_f32_16x16x32_bf16 v[138:141], a[0:3], v[186:189], 0
    v_cvt_pk_bf16_f32 v255, v228, v229
    v_xor_b32 v3, 65536, v3
    v_mfma_f32_16x16x32_bf16 v[138:141], a[4:7], v[194:197], v[138:141]
    ds_write_b64 v4, v[254:255] offset:4096
    v_mfma_f32_16x16x32_bf16 v[138:141], a[8:11], v[122:125], v[138:141]
    v_xor_b32 v4, 65536, v4
    v_add_u32 v7, s76, v7
    v_mfma_f32_16x16x32_bf16 v[138:141], a[12:15], v[202:205], v[138:141]
    v_cvt_pk_f16_f32 v146, v142, v143
    v_pk_mul_f16 v143, v146, v146
    v_mfma_f32_16x16x32_bf16 v[138:141], a[16:19], v[230:233], v[138:141]
    v_cvt_pk_f16_f32 v147, v144, v145
    v_pk_fma_f16 v143, v147, v147, v143
    v_mfma_f32_16x16x32_bf16 v[138:141], a[20:23], v[238:241], v[138:141]
    v_cvt_pk_f16_f32 v148, v150, v151
    v_pk_fma_f16 v143, v148, v148, v143
    v_mfma_f32_16x16x32_bf16 v[166:169], a[24:27], v[186:189], 0
    v_cvt_pk_f16_f32 v149, v152, v153
    v_pk_fma_f16 v143, v149, v149, v143
    v_mfma_f32_16x16x32_bf16 v[166:169], a[28:31], v[194:197], v[166:169]
    v_cvt_pk_f16_f32 v120, v134, v135
    v_pk_fma_f16 v143, v120, v120, v143
    v_mfma_f32_16x16x32_bf16 v[166:169], a[32:35], v[122:125], v[166:169]
    s_waitcnt lgkmcnt(0)
    v_cvt_pk_f16_f32 v121, v136, v137
    v_pk_fma_f16 v143, v121, v121, v143
    v_mfma_f32_16x16x32_bf16 v[166:169], a[36:39], v[202:205], v[166:169]
    s_nop 0
    v_mfma_f32_16x16x32_bf16 v[166:169], a[40:43], v[230:233], v[166:169]
    s_barrier
    v_mfma_f32_16x16x32_bf16 v[166:169], a[44:47], v[238:241], v[166:169]
    s_nop 0
    v_mfma_f32_16x16x32_bf16 v[134:137], a[48:51], v[186:189], 0
    s_nop 0
    v_mfma_f32_16x16x32_bf16 v[134:137], a[52:55], v[194:197], v[134:137]
    s_cbranch_scc1 L_loop_fast1
    s_branch L_final_fast
.p2align 6
L_loop_fast2:
    v_mfma_f32_16x16x32_bf16 v[134:137], a[56:59], v[122:125], v[134:137]
    s_add_u32 s12, s40, s27
    ds_read_b128 v[190:193], v2 offset:18432
    v_cvt_pk_f16_f32 v150, v138, v139
    v_mfma_f32_16x16x32_bf16 v[134:137], a[60:63], v[202:205], v[134:137]
    s_addc_u32 s13, s41, 0
    ds_read_b128 v[210:213], v2 offset:19456
    v_pk_mul_f16 v142, v150, v150
    v_mfma_f32_16x16x32_bf16 v[134:137], a[64:67], v[230:233], v[134:137]
    s_sub_u32 s14, s36, s27
    ds_read_b128 v[174:177], v5 offset:32
    v_cvt_pk_f16_f32 v151, v140, v141
    v_mfma_f32_16x16x32_bf16 v[134:137], a[68:71], v[238:241], v[134:137]
    s_cmp_ge_u32 s18, 2
    ds_read2_b64 v[162:165], v5 offset0:6 offset1:9
    v_pk_fma_f16 v142, v151, v151, v142
    v_mfma_f32_16x16x32_bf16 v[138:141], v[186:189], a[144:147], 0
    s_cselect_b32 s14, s14, 0
    ds_read_b128 v[170:173], v5
    v_cvt_pk_f16_f32 v152, v166, v167
    v_mfma_f32_16x16x32_bf16 v[138:141], v[194:197], a[148:151], v[138:141]
    s_sub_u32 s82, s72, s71
    ds_read_b32 v254, v6 offset:192
    v_pk_fma_f16 v142, v152, v152, v142
    v_mfma_f32_16x16x32_bf16 v[138:141], v[122:125], a[152:155], v[138:141]
    s_mul_i32 s74, s82, 336
    v_cvt_pk_f16_f32 v153, v168, v169
    v_pk_fma_f16 v142, v153, v153, v142
    v_mfma_f32_16x16x32_bf16 v[138:141], v[202:205], a[156:159], v[138:141]
    s_mul_i32 s75, s82, 272
    v_cvt_pk_f16_f32 v118, v134, v135
    v_pk_fma_f16 v142, v118, v118, v142
    v_mfma_f32_16x16x32_bf16 v[138:141], v[230:233], a[160:163], v[138:141]
    s_waitcnt lgkmcnt(5)
    ds_read_b128 v[182:185], v0 offset:26624
    v_cvt_pk_f16_f32 v119, v136, v137
    v_mfma_f32_16x16x32_bf16 v[166:169], v[32:35], v[190:193], 0
    s_waitcnt lgkmcnt(5)
    v_pk_fma_f16 v142, v119, v119, v142
    v_add_u32 v5, s74, v5
    v_mfma_f32_16x16x32_bf16 v[166:169], v[32:35], v[210:213], v[166:169]
    s_waitcnt lgkmcnt(4)
    v_pk_mul_f16 v145, v146, v174
    v_pk_fma_f16 v145, v147, v175, v145
    v_mfma_f32_16x16x32_bf16 v[138:141], v[238:241], a[164:167], v[138:141]
    s_mul_i32 s76, s82, 16
    ds_read_b128 v[210:213], v1 offset:26624
    v_pk_fma_f16 v145, v148, v176, v145
    v_mfma_f32_16x16x32_bf16 v[214:217], v[186:189], a[168:171], 0
    s_waitcnt lgkmcnt(3)
    ds_read_b128 v[218:221], v0 offset:26752
    v_pk_fma_f16 v145, v149, v177, v145
    v_mfma_f32_16x16x32_bf16 v[214:217], v[194:197], a[172:175], v[214:217]
    s_waitcnt lgkmcnt(3)
    ds_read_b128 v[222:225], v1 offset:26752
    v_mov_b32_dpp v254, v23 quad_perm:[0,1,2,3] row_mask:0x7 bank_mask:0xf
    v_mfma_f32_16x16x32_bf16 v[214:217], v[122:125], a[176:179], v[214:217]
    s_add_u32 s34, s18, 2
    ds_read_b128 v[226:229], v0 offset:26880
    v_pk_fma_f16 v145, v120, v164, v145
    v_mfma_f32_16x16x32_bf16 v[214:217], v[202:205], a[180:183], v[214:217]
    s_add_u32 s8, s60, s23
    ds_read_b128 v[190:193], v1 offset:26880
    v_pk_fma_f16 v145, v121, v165, v145
    v_mfma_f32_16x16x32_bf16 v[214:217], v[230:233], a[184:187], v[214:217]
    s_waitcnt lgkmcnt(5)
    v_pk_mul_f16 v144, v150, v170
    v_pk_fma_f16 v144, v151, v171, v144
    v_mfma_f32_16x16x32_bf16 v[214:217], v[238:241], a[188:191], v[214:217]
    s_addc_u32 s9, s61, 0
    v_pk_fma_f16 v144, v152, v172, v144
    v_pk_fma_f16 v144, v153, v173, v144
    v_mfma_f32_16x16x32_bf16 v[246:249], v[186:189], a[192:195], 0
    s_sub_u32 s10, s36, s23
    v_pk_fma_f16 v144, v118, v162, v144
    v_pk_fma_f16 v144, v119, v163, v144
    v_mfma_f32_16x16x32_bf16 v[246:249], v[194:197], a[196:199], v[246:249]
    s_cmp_le_u32 s34, s45
    v_cvt_pk_bf16_f32 v134, v138, v139
    v_cvt_pk_bf16_f32 v135, v140, v141
    v_mfma_f32_16x16x32_f16 v[234:237], v[40:43], v[142:145], 0
    s_cselect_b32 s10, s10, 0
    v_cvt_pk_bf16_f32 v138, v214, v215
    v_cvt_pk_bf16_f32 v139, v216, v217
    v_mfma_f32_16x16x32_bf16 v[246:249], v[122:125], a[200:203], v[246:249]
    s_add_u32 m0, s28, 0
    v_mul_f32 v136, 0x3baaaaab, v166
    v_mul_f32 v255, 0x3baaaaab, v167
    v_mfma_f32_16x16x32_bf16 v[246:249], v[202:205], a[204:207], v[246:249]
    s_mov_b32 s27, s26
    v_rsq_f32 v234, v234
    v_mfma_f32_16x16x32_bf16 v[246:249], v[230:233], a[208:211], v[246:249]
    s_mov_b32 s26, s25
    v_rsq_f32 v235, v235
    v_mfma_f32_16x16x32_bf16 v[246:249], v[238:241], a[212:215], v[246:249]
    s_mov_b32 s25, s24
    v_mul_f32 v140, s31, v234
    v_cvt_pk_f16_f32 v141, v140, v235
    v_mfma_f32_16x16x32_bf16 v[122:125], a[72:75], v[182:185], 0
    s_waitcnt lgkmcnt(0)
    v_fma_f32 v236, v236, v140, v22
    v_fmac_f32_dpp v254, v237, v235 quad_perm:[0,1,2,3] row_mask:0x1 bank_mask:0xf
    v_mfma_f32_16x16x32_bf16 v[122:125], a[76:79], v[210:213], v[122:125]
    s_mov_b32 s24, s23
    v_cvt_pk_bf16_f32 v142, v246, v247
    v_cvt_pk_bf16_f32 v143, v248, v249
    v_mfma_f32_16x16x32_bf16 v[122:125], a[80:83], v[218:221], v[122:125]
    s_mov_b32 s71, s72
    v_pk_mul_f16 v146, v146, v141 op_sel:[0,1] op_sel_hi:[1,1]
    v_pk_mul_f16 v147, v147, v141 op_sel:[0,1] op_sel_hi:[1,1]
    v_mfma_f32_16x16x32_bf16 v[122:125], a[84:87], v[222:225], v[122:125]
    s_mov_b32 s72, s73
    v_pk_mul_f16 v148, v148, v141 op_sel:[0,1] op_sel_hi:[1,1]
    v_pk_mul_f16 v149, v149, v141 op_sel:[0,1] op_sel_hi:[1,1]
    v_mfma_f32_16x16x32_bf16 v[122:125], a[88:91], v[226:229], v[122:125]
    v_pk_mul_f16 v120, v120, v141 op_sel:[0,1] op_sel_hi:[1,1]
    v_pk_mul_f16 v121, v121, v141 op_sel:[0,1] op_sel_hi:[1,1]
    v_mfma_f32_16x16x32_bf16 v[122:125], a[92:95], v[190:193], v[122:125]
    v_pk_mul_f16 v150, v150, v141 op_sel:[0,0] op_sel_hi:[1,0]
    v_pk_mul_f16 v151, v151, v141 op_sel:[0,0] op_sel_hi:[1,0]
    v_mfma_f32_16x16x32_bf16 v[186:189], a[96:99], v[182:185], 0
    v_pk_mul_f16 v152, v152, v141 op_sel:[0,0] op_sel_hi:[1,0]
    v_pk_mul_f16 v153, v153, v141 op_sel:[0,0] op_sel_hi:[1,0]
    v_mfma_f32_16x16x32_bf16 v[186:189], a[100:103], v[210:213], v[186:189]
    v_pk_mul_f16 v118, v118, v141 op_sel:[0,0] op_sel_hi:[1,0]
    v_pk_mul_f16 v119, v119, v141 op_sel:[0,0] op_sel_hi:[1,0]
    v_mfma_f32_16x16x32_bf16 v[186:189], a[104:107], v[218:221], v[186:189]
    v_max3_u32 v44, v44, v234, v235
    v_mul_f32 v144, 0x3baaaaab, v168
    v_mfma_f32_16x16x32_bf16 v[186:189], a[108:111], v[222:225], v[186:189]
    v_rsq_f32 v136, v136
    v_mfma_f32_16x16x32_bf16 v[186:189], a[112:115], v[226:229], v[186:189]
    v_rsq_f32 v255, v255
    v_mfma_f32_16x16x32_bf16 v[186:189], a[116:119], v[190:193], v[186:189]
    v_rsq_f32 v144, v144
    v_mfma_f32_16x16x32_bf16 v[194:197], a[120:123], v[182:185], 0
    v_mul_f32 v178, v136, v178
    v_mul_f32 v179, v136, v179
    v_mfma_f32_16x16x32_bf16 v[194:197], a[124:127], v[210:213], v[194:197]
    v_cvt_pk_bf16_f32 v166, v178, v179
    v_mul_f32 v180, v136, v180
    v_mfma_f32_16x16x32_bf16 v[194:197], a[128:131], v[218:221], v[194:197]
    v_mul_f32 v181, v136, v181
    v_cvt_pk_bf16_f32 v167, v180, v181
    v_mfma_f32_16x16x32_bf16 v[194:197], a[132:135], v[222:225], v[194:197]
    v_mul_f32 v198, v136, v198
    v_mul_f32 v199, v136, v199
    v_mfma_f32_16x16x32_bf16 v[194:197], a[136:139], v[226:229], v[194:197]
    v_cvt_pk_bf16_f32 v168, v198, v199
    v_mul_f32 v200, v136, v200
    v_mfma_f32_16x16x32_bf16 v[194:197], a[140:143], v[190:193], v[194:197]
    v_mul_f32 v201, v136, v201
    v_cvt_pk_bf16_f32 v169, v200, v201
    v_mfma_f32_16x16x32_bf16 v[178:181], a[0:3], v[182:185], 0
    buffer_store_dwordx4 v[166:169], v15, s[12:15], 0 offen nt
    v_mul_f32 v206, v136, v206
    v_mul_f32 v207, v136, v207
    v_cvt_pk_bf16_f32 v140, v206, v207
    v_mul_f32 v208, v136, v208
    v_mfma_f32_16x16x32_bf16 v[178:181], a[4:7], v[210:213], v[178:181]
    v_mul_f32 v209, v136, v209
    v_cvt_pk_bf16_f32 v141, v208, v209
    v_mfma_f32_16x16x32_bf16 v[178:181], a[8:11], v[218:221], v[178:181]
    v_cvt_pk_f16_f32 v166, v122, v123
    v_pk_mul_f16 v199, v166, v166
    v_mfma_f32_16x16x32_bf16 v[178:181], a[12:15], v[222:225], v[178:181]
    v_cvt_pk_f16_f32 v167, v124, v125
    v_pk_fma_f16 v199, v167, v167, v199
    v_mfma_f32_16x16x32_bf16 v[178:181], a[16:19], v[226:229], v[178:181]
    v_cvt_pk_f16_f32 v168, v186, v187
    v_pk_fma_f16 v199, v168, v168, v199
    v_mfma_f32_16x16x32_bf16 v[178:181], a[20:23], v[190:193], v[178:181]
    v_cvt_pk_f16_f32 v169, v188, v189
    v_pk_fma_f16 v199, v169, v169, v199
    v_mfma_f32_16x16x32_bf16 v[186:189], a[24:27], v[182:185], 0
    v_cvt_pk_f16_f32 v124, v194, v195
    v_pk_fma_f16 v199, v124, v124, v199
    v_mfma_f32_16x16x32_bf16 v[186:189], a[28:31], v[210:213], v[186:189]
    v_cvt_pk_f16_f32 v125, v196, v197
    v_pk_fma_f16 v199, v125, v125, v199
    v_mfma_f32_16x16x32_bf16 v[186:189], a[32:35], v[218:221], v[186:189]
    v_cvt_pk_f16_f32 v178, v178, v179
    v_pk_mul_f16 v198, v178, v178
    v_mfma_f32_16x16x32_bf16 v[186:189], a[36:39], v[222:225], v[186:189]
    v_cvt_pk_f16_f32 v179, v180, v181
    v_pk_fma_f16 v198, v179, v179, v198
    v_mfma_f32_16x16x32_bf16 v[186:189], a[40:43], v[226:229], v[186:189]
    v_pk_mul_f16 v200, v178, v170
    v_pk_fma_f16 v200, v179, v171, v200
    v_mfma_f32_16x16x32_bf16 v[186:189], a[44:47], v[190:193], v[186:189]
    v_pk_mul_f16 v201, v166, v174
    v_pk_fma_f16 v201, v167, v175, v201
    v_mfma_f32_16x16x32_bf16 v[194:197], a[48:51], v[182:185], 0
    v_pk_fma_f16 v201, v168, v176, v201
    v_pk_fma_f16 v201, v169, v177, v201
    v_mfma_f32_16x16x32_bf16 v[194:197], a[52:55], v[210:213], v[194:197]
    v_pk_fma_f16 v201, v124, v164, v201
    v_pk_fma_f16 v201, v125, v165, v201
    v_mfma_f32_16x16x32_bf16 v[194:197], a[56:59], v[218:221], v[194:197]
    v_cvt_pk_f16_f32 v180, v186, v187
    v_pk_fma_f16 v198, v180, v180, v198
    v_mfma_f32_16x16x32_bf16 v[194:197], a[60:63], v[222:225], v[194:197]
    v_cvt_pk_f16_f32 v181, v188, v189
    v_pk_fma_f16 v198, v181, v181, v198
    v_mfma_f32_16x16x32_bf16 v[194:197], a[64:67], v[226:229], v[194:197]
    v_pk_fma_f16 v200, v180, v172, v200
    v_pk_fma_f16 v200, v181, v173, v200
    v_mfma_f32_16x16x32_bf16 v[194:197], a[68:71], v[190:193], v[194:197]
    buffer_store_dwordx2 v[140:141], v18, s[12:15], 0 offen nt
    v_mul_f32 v242, v144, v242
    v_mul_f32 v243, v144, v243
    v_mfma_f32_16x16x32_bf16 v[186:189], v[182:185], a[144:147], 0
    v_cvt_pk_bf16_f32 v238, v242, v243
    v_mul_f32 v244, v144, v244
    v_mfma_f32_16x16x32_bf16 v[186:189], v[210:213], a[148:151], v[186:189]
    v_mul_f32 v245, v144, v245
    v_cvt_pk_f16_f32 v122, v194, v195
    v_mfma_f32_16x16x32_bf16 v[186:189], v[218:221], a[152:155], v[186:189]
    v_pk_fma_f16 v198, v122, v122, v198
    v_cvt_pk_f16_f32 v123, v196, v197
    v_mfma_f32_16x16x32_bf16 v[186:189], v[222:225], a[156:159], v[186:189]
    v_pk_fma_f16 v198, v123, v123, v198
    v_pk_fma_f16 v200, v122, v162, v200
    v_mfma_f32_16x16x32_bf16 v[186:189], v[226:229], a[160:163], v[186:189]
    ds_read_b128 v[202:205], v0 offset:32768
    v_pk_fma_f16 v200, v123, v163, v200
    v_mfma_f32_16x16x32_bf16 v[186:189], v[190:193], a[164:167], v[186:189]
    ds_read_b128 v[194:197], v1 offset:32768
    v_cvt_pk_bf16_f32 v239, v244, v245
    v_mfma_f32_16x16x32_f16 v[230:233], v[40:43], v[198:201], 0
    v_mul_f32 v158, v144, v158
    v_mul_f32 v159, v144, v159
    v_mfma_f32_16x16x32_bf16 v[246:249], v[182:185], a[168:171], 0
    ds_read_b128 v[214:217], v0 offset:32896
    v_cvt_pk_bf16_f32 v240, v158, v159
    v_mfma_f32_16x16x32_bf16 v[246:249], v[210:213], a[172:175], v[246:249]
    ds_read_b128 v[206:209], v1 offset:32896
    v_cvt_pk_bf16_f32 v136, v186, v187
    v_mfma_f32_16x16x32_bf16 v[246:249], v[218:221], a[176:179], v[246:249]
    ds_read_b128 v[198:201], v0 offset:33024
    v_cvt_pk_bf16_f32 v137, v188, v189
    v_mfma_f32_16x16x32_bf16 v[246:249], v[222:225], a[180:183], v[246:249]
    ds_read_b128 v[186:189], v1 offset:33024
    v_mul_f32 v160, v144, v160
    v_mfma_f32_16x16x32_bf16 v[246:249], v[226:229], a[184:187], v[246:249]
    v_rsq_f32 v230, v230
    v_mfma_f32_16x16x32_bf16 v[246:249], v[190:193], a[188:191], v[246:249]
    s_waitcnt lgkmcnt(5)
    v_rsq_f32 v231, v231
    v_mfma_f32_16x16x32_bf16 v[242:245], v[182:185], a[192:195], 0
    s_waitcnt lgkmcnt(4)
    v_mul_f32 v234, s31, v230
    v_cvt_pk_f16_f32 v235, v234, v231
    v_mfma_f32_16x16x32_bf16 v[242:245], v[210:213], a[196:199], v[242:245]
    v_fma_f32 v232, v232, v234, v24
    v_fmac_f32_dpp v254, v233, v231 quad_perm:[0,1,2,3] row_mask:0x2 bank_mask:0xf
    v_mfma_f32_16x16x32_bf16 v[242:245], v[218:221], a[200:203], v[242:245]
    s_waitcnt lgkmcnt(3)
    v_cvt_pk_bf16_f32 v140, v246, v247
    v_cvt_pk_bf16_f32 v141, v248, v249
    v_mfma_f32_16x16x32_bf16 v[242:245], v[222:225], a[204:207], v[242:245]
    s_waitcnt lgkmcnt(2)
    v_mul_f32 v161, v144, v161
    v_cvt_pk_bf16_f32 v241, v160, v161
    v_mfma_f32_16x16x32_bf16 v[242:245], v[226:229], a[208:211], v[242:245]
    s_waitcnt lgkmcnt(1)
    buffer_store_dwordx4 v[238:241], v17, s[12:15], 0 offen nt
    v_mul_f32 v154, v144, v154
    v_mul_f32 v155, v144, v155
    v_cvt_pk_bf16_f32 v154, v154, v155
    v_mul_f32 v156, v144, v156
    v_mfma_f32_16x16x32_bf16 v[242:245], v[190:193], a[212:215], v[242:245]
    s_waitcnt lgkmcnt(0)
    v_mul_f32 v157, v144, v157
    v_cvt_pk_bf16_f32 v155, v156, v157
    v_mfma_f32_16x16x32_bf16 v[158:161], a[72:75], v[202:205], 0
    v_pk_mul_f16 v166, v166, v235 op_sel:[0,1] op_sel_hi:[1,1]
    v_pk_mul_f16 v167, v167, v235 op_sel:[0,1] op_sel_hi:[1,1]
    v_mfma_f32_16x16x32_bf16 v[158:161], a[76:79], v[194:197], v[158:161]
    v_pk_mul_f16 v168, v168, v235 op_sel:[0,1] op_sel_hi:[1,1]
    v_cvt_pk_bf16_f32 v144, v242, v243
    v_mfma_f32_16x16x32_bf16 v[158:161], a[80:83], v[214:217], v[158:161]
    v_cvt_pk_bf16_f32 v145, v244, v245
    v_pk_mul_f16 v169, v169, v235 op_sel:[0,1] op_sel_hi:[1,1]
    v_mfma_f32_16x16x32_bf16 v[158:161], a[84:87], v[206:209], v[158:161]
    v_pk_mul_f16 v124, v124, v235 op_sel:[0,1] op_sel_hi:[1,1]
    v_pk_mul_f16 v125, v125, v235 op_sel:[0,1] op_sel_hi:[1,1]
    v_mfma_f32_16x16x32_bf16 v[158:161], a[88:91], v[198:201], v[158:161]
    v_pk_mul_f16 v178, v178, v235 op_sel:[0,0] op_sel_hi:[1,0]
    v_pk_mul_f16 v179, v179, v235 op_sel:[0,0] op_sel_hi:[1,0]
    v_mfma_f32_16x16x32_bf16 v[158:161], a[92:95], v[186:189], v[158:161]
    v_pk_mul_f16 v180, v180, v235 op_sel:[0,0] op_sel_hi:[1,0]
    v_pk_mul_f16 v181, v181, v235 op_sel:[0,0] op_sel_hi:[1,0]
    v_mfma_f32_16x16x32_bf16 v[182:185], a[96:99], v[202:205], 0
    v_pk_mul_f16 v122, v122, v235 op_sel:[0,0] op_sel_hi:[1,0]
    v_pk_mul_f16 v123, v123, v235 op_sel:[0,0] op_sel_hi:[1,0]
    v_mfma_f32_16x16x32_bf16 v[182:185], a[100:103], v[194:197], v[182:185]
    v_max3_u32 v44, v44, v230, v231
    v_mul_f32 v130, v255, v130
    v_mfma_f32_16x16x32_bf16 v[182:185], a[104:107], v[214:217], v[182:185]
    v_cvt_pk_f16_f32 v158, v158, v159
    v_pk_mul_f16 v191, v158, v158
    v_mfma_f32_16x16x32_bf16 v[182:185], a[108:111], v[206:209], v[182:185]
    v_cvt_pk_f16_f32 v159, v160, v161
    v_pk_fma_f16 v191, v159, v159, v191
    v_mfma_f32_16x16x32_bf16 v[182:185], a[112:115], v[198:201], v[182:185]
    v_pk_mul_f16 v193, v158, v174
    v_pk_fma_f16 v193, v159, v175, v193
    v_mfma_f32_16x16x32_bf16 v[182:185], a[116:119], v[186:189], v[182:185]
    v_exp_f32 v232, v232
    v_mfma_f32_16x16x32_bf16 v[210:213], a[120:123], v[202:205], 0
    v_exp_f32 v236, v236
    v_mfma_f32_16x16x32_bf16 v[210:213], a[124:127], v[194:197], v[210:213]
    v_cvt_pk_bf16_f32 v39, v236, 0
    v_mul_f32 v131, v255, v131
    v_mfma_f32_16x16x32_bf16 v[210:213], a[128:131], v[214:217], v[210:213]
    s_waitcnt vmcnt(3)
    ds_write_b16 v8, v45 offset:512
    v_mfma_f32_16x16x32_bf16 v[210:213], a[132:135], v[206:209], v[210:213]
    buffer_store_dwordx2 v[154:155], v20, s[12:15], 0 offen nt
    v_cvt_pk_f16_f32 v160, v182, v183
    v_mfma_f32_16x16x32_bf16 v[210:213], a[136:139], v[198:201], v[210:213]
    v_pk_fma_f16 v191, v160, v160, v191
    v_cvt_pk_f16_f32 v161, v184, v185
    v_mfma_f32_16x16x32_bf16 v[210:213], a[140:143], v[186:189], v[210:213]
    v_pk_fma_f16 v191, v161, v161, v191
    v_pk_fma_f16 v193, v160, v176, v193
    v_mfma_f32_16x16x32_bf16 v[154:157], a[0:3], v[202:205], 0
    v_pk_fma_f16 v193, v161, v177, v193
    v_cvt_pk_bf16_f32 v130, v130, v131
    v_mfma_f32_16x16x32_bf16 v[154:157], a[4:7], v[194:197], v[154:157]
    v_mul_f32 v132, v255, v132
    v_mul_f32 v133, v255, v133
    v_mfma_f32_16x16x32_bf16 v[154:157], a[8:11], v[214:217], v[154:157]
    v_cvt_pk_f16_f32 v176, v210, v211
    v_pk_fma_f16 v191, v176, v176, v191
    v_mfma_f32_16x16x32_bf16 v[154:157], a[12:15], v[206:209], v[154:157]
    s_waitcnt lgkmcnt(0)
    v_cvt_pk_f16_f32 v177, v212, v213
    v_pk_fma_f16 v191, v177, v177, v191
    v_mfma_f32_16x16x32_bf16 v[154:157], a[16:19], v[198:201], v[154:157]
    v_pk_fma_f16 v193, v176, v164, v193
    v_mfma_f32_16x16x32_bf16 v[154:157], a[20:23], v[186:189], v[154:157]
    v_pk_fma_f16 v193, v177, v165, v193
    v_mfma_f32_16x16x32_bf16 v[182:185], a[24:27], v[202:205], 0
    s_barrier
    v_cvt_pk_bf16_f32 v131, v132, v133
    v_mfma_f32_16x16x32_bf16 v[182:185], a[28:31], v[194:197], v[182:185]
    ds_read2_b32 v[164:165], v6 offset0:0 offset1:0
    v_mfma_f32_16x16x32_bf16 v[182:185], a[32:35], v[214:217], v[182:185]
    ds_read2_b32 v[212:213], v6 offset0:16 offset1:16
    v_cvt_pk_f16_f32 v154, v154, v155
    v_mfma_f32_16x16x32_bf16 v[182:185], a[36:39], v[206:209], v[182:185]
    ds_read2_b32 v[220:221], v6 offset0:32 offset1:32
    v_pk_mul_f16 v190, v154, v154
    v_mfma_f32_16x16x32_bf16 v[182:185], a[40:43], v[198:201], v[182:185]
    ds_read_u16 v133, v9 offset:256
    v_cvt_pk_f16_f32 v155, v156, v157
    v_mfma_f32_16x16x32_bf16 v[182:185], a[44:47], v[186:189], v[182:185]
    v_pk_fma_f16 v190, v155, v155, v190
    v_pk_mul_f16 v192, v154, v170
    v_mfma_f32_16x16x32_bf16 v[222:225], a[48:51], v[202:205], 0
    v_pk_fma_f16 v192, v155, v171, v192
    v_mul_f32 v126, v255, v126
    v_mfma_f32_16x16x32_bf16 v[222:225], a[52:55], v[194:197], v[222:225]
    v_mul_f32 v127, v255, v127
    v_cvt_pk_bf16_f32 v132, v126, v127
    v_mfma_f32_16x16x32_bf16 v[222:225], a[56:59], v[214:217], v[222:225]
    buffer_load_dwordx4 v10, s[8:11], 0 offen nt lds
    v_cvt_pk_f16_f32 v156, v182, v183
    v_mfma_f32_16x16x32_bf16 v[222:225], a[60:63], v[206:209], v[222:225]
    s_add_u32 m0, s28, 4096
    v_pk_fma_f16 v190, v156, v156, v190
    v_cvt_pk_f16_f32 v157, v184, v185
    v_mfma_f32_16x16x32_bf16 v[222:225], a[64:67], v[198:201], v[222:225]
    s_waitcnt lgkmcnt(2)
    v_pk_fma_f16 v190, v157, v157, v190
    v_pk_fma_f16 v192, v156, v172, v192
    v_mfma_f32_16x16x32_bf16 v[222:225], a[68:71], v[186:189], v[222:225]
    s_waitcnt lgkmcnt(1)
    ds_read_b128 v[182:185], v2 offset:0
    v_pk_fma_f16 v192, v157, v173, v192
    v_mfma_f32_16x16x32_bf16 v[170:173], v[202:205], a[144:147], 0
    s_waitcnt lgkmcnt(1)
    ds_read_b128 v[226:229], v2 offset:1024
    v_readfirstlane_b32 s77, v133
    v_mfma_f32_16x16x32_bf16 v[170:173], v[194:197], a[148:151], v[170:173]
    ds_read_b128 v[234:237], v2 offset:2048
    buffer_load_dwordx4 v11, s[8:11], 0 offen nt lds
    v_mfma_f32_16x16x32_bf16 v[170:173], v[214:217], a[152:155], v[170:173]
    s_add_u32 m0, s28, 8192
    ds_read_b128 v[238:241], v2 offset:3072
    v_cvt_pk_f16_f32 v174, v222, v223
    v_mfma_f32_16x16x32_bf16 v[170:173], v[206:209], a[156:159], v[170:173]
    s_mul_i32 s78, s77, 2688
    ds_read_b128 v[242:245], v2 offset:4096
    v_pk_fma_f16 v190, v174, v174, v190
    v_mfma_f32_16x16x32_bf16 v[170:173], v[198:201], a[160:163], v[170:173]
    ds_read_b128 v[246:249], v2 offset:5120
    v_cvt_pk_f16_f32 v175, v224, v225
    v_mfma_f32_16x16x32_bf16 v[170:173], v[186:189], a[164:167], v[170:173]
    v_pk_fma_f16 v190, v175, v175, v190
    v_pk_fma_f16 v192, v174, v162, v192
    v_mfma_f32_16x16x32_bf16 v[222:225], v[202:205], a[168:171], 0
    buffer_load_dwordx4 v12, s[8:11], 0 offen nt lds
    v_pk_fma_f16 v192, v175, v163, v192
    v_mfma_f32_16x16x32_bf16 v[222:225], v[194:197], a[172:175], v[222:225]
    s_waitcnt lgkmcnt(5)
    v_mul_f32 v128, v255, v128
    v_cvt_pk_bf16_f32 v162, v170, v171
    v_mfma_f32_16x16x32_f16 v[250:253], v[40:43], v[190:193], 0
    s_add_u32 m0, s28, 12288
    v_cvt_pk_bf16_f32 v163, v172, v173
    v_mul_f32 v129, v255, v129
    v_mfma_f32_16x16x32_bf16 v[222:225], v[214:217], a[176:179], v[222:225]
    s_xor_b32 s28, s28, 65536
    v_cvt_pk_bf16_f32 v133, v128, v129
    v_mul_f32 v114, v255, v114
    v_mfma_f32_16x16x32_bf16 v[222:225], v[206:209], a[180:183], v[222:225]
    s_waitcnt lgkmcnt(2)
    v_rsq_f32 v250, v250
    v_mfma_f32_16x16x32_bf16 v[222:225], v[198:201], a[184:187], v[222:225]
    s_waitcnt lgkmcnt(1)
    buffer_load_dwordx4 v13, s[8:11], 0 offen nt lds
    v_mul_f32 v230, s31, v250
    v_mfma_f32_16x16x32_bf16 v[222:225], v[186:189], a[188:191], v[222:225]
    s_mov_b32 m0, s29
    v_rsq_f32 v251, v251
    v_mfma_f32_16x16x32_bf16 v[126:129], v[202:205], a[192:195], 0
    s_xor_b32 s29, s29, s30
    v_cvt_pk_f16_f32 v231, v230, v251
    v_fma_f32 v252, v252, v230, v26
    v_mfma_f32_16x16x32_bf16 v[126:129], v[194:197], a[196:199], v[126:129]
    s_add_u32 s19, s19, s20
    v_fmac_f32_dpp v254, v253, v251 quad_perm:[0,1,2,3] row_mask:0x4 bank_mask:0xf
    v_cvt_pk_bf16_f32 v210, v222, v223
    v_mfma_f32_16x16x32_bf16 v[126:129], v[214:217], a[200:203], v[126:129]
    s_add_u32 s23, s23, s21
    v_cvt_pk_bf16_f32 v211, v224, v225
    v_pk_mul_f16 v158, v158, v231 op_sel:[0,1] op_sel_hi:[1,1]
    v_mfma_f32_16x16x32_bf16 v[126:129], v[206:209], a[204:207], v[126:129]
    s_waitcnt lgkmcnt(0)
    v_pk_mul_f16 v159, v159, v231 op_sel:[0,1] op_sel_hi:[1,1]
    v_mfma_f32_16x16x32_bf16 v[126:129], v[198:201], a[208:211], v[126:129]
    s_cmp_ge_u32 s19, 72
    v_pk_mul_f16 v160, v160, v231 op_sel:[0,1] op_sel_hi:[1,1]
    v_pk_mul_f16 v161, v161, v231 op_sel:[0,1] op_sel_hi:[1,1]
    v_mfma_f32_16x16x32_bf16 v[126:129], v[186:189], a[212:215], v[126:129]
    s_cselect_b32 s34, 72, 0
    v_pk_mul_f16 v176, v176, v231 op_sel:[0,1] op_sel_hi:[1,1]
    v_pk_mul_f16 v177, v177, v231 op_sel:[0,1] op_sel_hi:[1,1]
    v_mfma_f32_16x16x32_f16 v[170:173], v[146:149], v[150:153], v[46:49]
    s_cselect_b32 s35, s22, 0
    v_pk_mul_f16 v154, v154, v231 op_sel:[0,0] op_sel_hi:[1,0]
    v_pk_mul_f16 v155, v155, v231 op_sel:[0,0] op_sel_hi:[1,0]
    v_mfma_f32_16x16x32_f16 v[186:189], v[166:169], v[150:153], v[50:53]
    s_sub_u32 s19, s19, s34
    v_cvt_pk_bf16_f32 v218, v126, v127
    v_cvt_pk_bf16_f32 v219, v128, v129
    v_mfma_f32_16x16x32_f16 v[126:129], v[158:161], v[150:153], v[54:57]
    buffer_store_dwordx4 v[130:133], v16, s[12:15], 0 offen nt
    v_pk_mul_f16 v156, v156, v231 op_sel:[0,0] op_sel_hi:[1,0]
    v_pk_mul_f16 v157, v157, v231 op_sel:[0,0] op_sel_hi:[1,0]
    v_pk_mul_f16 v174, v174, v231 op_sel:[0,0] op_sel_hi:[1,0]
    v_pk_mul_f16 v175, v175, v231 op_sel:[0,0] op_sel_hi:[1,0]
    v_mfma_f32_16x16x16_f16 v[170:173], v[120:121], v[118:119], v[170:173]
    v_max3_u32 v44, v44, v250, v251
    v_exp_f32 v254, v254
    v_mfma_f32_16x16x16_f16 v[186:189], v[124:125], v[118:119], v[186:189]
    v_cvt_pk_bf16_f32 v254, v254, v254
    v_exp_f32 v252, v252
    v_mfma_f32_16x16x16_f16 v[126:129], v[176:177], v[118:119], v[126:129]
    v_mul_f32 v115, v255, v115
    v_cvt_pk_bf16_f32 v118, v114, v115
    v_exp_f32 v170, v170
    v_mfma_f32_16x16x32_f16 v[130:133], v[146:149], v[178:181], v[58:61]
    s_add_u32 s23, s23, s35
    ds_write_b16 v8, v254
    v_mfma_f32_16x16x32_f16 v[150:153], v[166:169], v[178:181], v[62:65]
    s_add_u32 s78, s78, s69
    v_exp_f32 v171, v171
    v_mfma_f32_16x16x32_f16 v[190:193], v[158:161], v[178:181], v[66:69]
    s_add_u32 s80, s77, s68
    v_cvt_pk_bf16_f32 v170, v170, v171
    v_exp_f32 v172, v172
    v_mfma_f32_16x16x16_f16 v[130:133], v[120:121], v[122:123], v[130:133]
    v_exp_f32 v173, v173
    v_mul_f32 v116, v255, v116
    v_mfma_f32_16x16x16_f16 v[150:153], v[124:125], v[122:123], v[150:153]
    v_cvt_pk_bf16_f32 v171, v172, v173
    v_exp_f32 v186, v186
    v_mfma_f32_16x16x16_f16 v[190:193], v[176:177], v[122:123], v[190:193]
    v_exp_f32 v187, v187
    v_exp_f32 v188, v188
    v_mfma_f32_16x16x32_bf16 v[178:181], a[216:219], v[182:185], 0
    s_cmp_ge_u32 s80, 72
    v_exp_f32 v130, v130
    v_mfma_f32_16x16x32_bf16 v[178:181], a[220:223], v[226:229], v[178:181]
    s_cselect_b32 s80, s22, 0
    v_exp_f32 v131, v131
    v_mfma_f32_16x16x32_bf16 v[178:181], a[224:227], v[234:237], v[178:181]
    s_add_u32 s78, s78, s80
    v_cvt_pk_bf16_f32 v194, v130, v131
    v_cvt_pk_bf16_f32 v172, v186, v187
    v_mfma_f32_16x16x32_bf16 v[178:181], a[228:231], v[238:241], v[178:181]
    s_add_u32 s80, s77, 20
    v_exp_f32 v132, v132
    v_mfma_f32_16x16x32_bf16 v[178:181], a[232:235], v[242:245], v[178:181]
    s_add_u32 s34, s18, 3
    v_exp_f32 v133, v133
    v_mfma_f32_16x16x32_bf16 v[178:181], a[236:239], v[246:249], v[178:181]
    s_cmp_lt_u32 s77, s62
    v_cvt_pk_bf16_f32 v195, v132, v133
    v_mul_f32 v117, v255, v117
    v_mfma_f32_16x16x32_bf16 v[198:201], a[240:243], v[182:185], 0
    s_cselect_b32 s79, 1, 0
    v_exp_f32 v150, v150
    v_mfma_f32_16x16x32_f16 v[202:205], v[146:149], v[154:157], v[70:73]
    s_cselect_b32 s78, s78, 0
    v_exp_f32 v151, v151
    v_mfma_f32_16x16x32_f16 v[146:149], v[166:169], v[154:157], v[74:77]
    s_cmp_lt_u32 s34, s17
    v_cvt_pk_bf16_f32 v196, v150, v151
    v_cvt_pk_bf16_f32 v119, v116, v117
    v_mfma_f32_16x16x32_f16 v[166:169], v[158:161], v[154:157], v[78:81]
    buffer_store_dwordx2 v[118:119], v19, s[12:15], 0 offen nt
    v_exp_f32 v152, v152
    v_mfma_f32_16x16x16_f16 v[202:205], v[120:121], v[174:175], v[202:205]
    v_exp_f32 v153, v153
    v_fma_f32 v254, v178, v178, s33
    v_mfma_f32_16x16x16_f16 v[146:149], v[124:125], v[174:175], v[146:149]
    v_cvt_pk_bf16_f32 v197, v152, v153
    v_exp_f32 v190, v190
    v_mfma_f32_16x16x16_f16 v[166:169], v[176:177], v[174:175], v[166:169]
    v_exp_f32 v191, v191
    v_exp_f32 v192, v192
    v_mfma_f32_16x16x32_bf16 v[198:201], a[244:247], v[226:229], v[198:201]
    s_cselect_b32 s23, s23, s78
    v_exp_f32 v193, v193
    v_mfma_f32_16x16x32_bf16 v[198:201], a[248:251], v[234:237], v[198:201]
    s_cselect_b32 s73, s34, s80
    ds_read_b128 v[118:121], v2 offset:6144
    v_fmac_f32 v254, v179, v179
    v_mfma_f32_16x16x32_bf16 v[198:201], a[252:255], v[238:241], v[198:201]
    s_cselect_b32 s79, 0, s79
    ds_read_b128 v[122:125], v2 offset:7168
    v_fmac_f32 v254, v180, v180
    v_mfma_f32_16x16x32_bf16 v[198:201], v[82:85], v[242:245], v[198:201]
    s_cselect_b32 s81, 0, 1
    ds_read_b128 v[150:153], v2 offset:8192
    v_fmac_f32 v254, v181, v181
    v_mfma_f32_16x16x32_bf16 v[198:201], v[86:89], v[246:249], v[198:201]
    s_add_u32 s80, s77, 1
    ds_read_b128 v[154:157], v2 offset:9216
    v_xor_b32 v0, 65536, v0
    v_mfma_f32_16x16x32_bf16 v[206:209], v[90:93], v[182:185], 0
    s_mul_i32 s80, s80, s81
    ds_read_b128 v[158:161], v2 offset:10240
    v_xor_b32 v1, 65536, v1
    v_mfma_f32_16x16x32_bf16 v[206:209], v[94:97], v[226:229], v[206:209]
    s_cmp_lt_u32 s80, s62
    ds_read_b128 v[174:177], v2 offset:11264
    v_fmac_f32 v254, v198, v198
    v_mfma_f32_16x16x32_bf16 v[206:209], v[98:101], v[234:237], v[206:209]
    s_cselect_b32 s62, s62, 0
    v_exp_f32 v189, v189
    v_mfma_f32_16x16x32_bf16 v[206:209], v[102:105], v[238:241], v[206:209]
    s_add_u32 s80, s18, 4
    v_cvt_pk_bf16_f32 v173, v188, v189
    v_fmac_f32 v254, v199, v199
    v_mfma_f32_16x16x32_bf16 v[206:209], v[106:109], v[242:245], v[206:209]
    s_waitcnt lgkmcnt(5)
    v_exp_f32 v126, v126
    v_mfma_f32_16x16x32_bf16 v[206:209], v[110:113], v[246:249], v[206:209]
    s_cmp_ge_u32 s80, s17
    v_exp_f32 v127, v127
    v_mfma_f32_16x16x32_bf16 v[130:133], a[216:219], v[118:121], 0
    s_waitcnt lgkmcnt(3)
    v_cvt_pk_bf16_f32 v36, v126, v127
    v_fmac_f32 v254, v200, v200
    v_mfma_f32_16x16x32_bf16 v[130:133], a[220:223], v[122:125], v[130:133]
    s_cselect_b32 s66, s62, 0
    v_exp_f32 v128, v128
    v_mfma_f32_16x16x32_bf16 v[130:133], a[224:227], v[150:153], v[130:133]
    s_waitcnt lgkmcnt(1)
    v_fmac_f32 v254, v201, v201
    v_mfma_f32_16x16x32_bf16 v[130:133], a[228:231], v[154:157], v[130:133]
    s_lshl_b32 s80, s79, s73
    v_exp_f32 v129, v129
    v_mfma_f32_16x16x32_bf16 v[130:133], a[232:235], v[158:161], v[130:133]
    s_waitcnt lgkmcnt(0)
    v_cvt_pk_bf16_f32 v37, v128, v129
    v_fmac_f32 v254, v206, v206
    v_mfma_f32_16x16x32_bf16 v[130:133], a[236:239], v[174:177], v[130:133]
    s_or_b32 s70, s70, s80
    v_exp_f32 v202, v202
    v_mfma_f32_16x16x32_bf16 v[182:185], v[28:31], v[36:39], 0
    s_add_u32 s45, s45, s79
    v_exp_f32 v203, v203
    v_mfma_f32_16x16x32_bf16 v[182:185], v[28:31], v[170:173], v[182:185]
    s_add_u32 s18, s18, 1
    v_cvt_pk_bf16_f32 v186, v202, v203
    v_fma_f32 v255, v130, v130, s33
    v_mfma_f32_16x16x32_bf16 v[214:217], v[162:165], v[36:39], 0
    s_cmp_lt_u32 s18, s45
    v_fmac_f32 v255, v131, v131
    v_fmac_f32 v255, v132, v132
    v_mfma_f32_16x16x32_bf16 v[214:217], v[134:137], v[170:173], v[214:217]
    v_fmac_f32 v255, v133, v133
    v_fmac_f32 v254, v207, v207
    v_mfma_f32_16x16x32_bf16 v[222:225], v[210:213], v[36:39], 0
    v_exp_f32 v204, v204
    v_mfma_f32_16x16x32_bf16 v[222:225], v[138:141], v[170:173], v[222:225]
    v_exp_f32 v205, v205
    v_mfma_f32_16x16x32_bf16 v[226:229], v[218:221], v[36:39], 0
    v_cvt_pk_bf16_f32 v36, v190, v191
    v_cvt_pk_bf16_f32 v37, v192, v193
    v_mfma_f32_16x16x32_bf16 v[226:229], v[142:145], v[170:173], v[226:229]
    v_cvt_pk_bf16_f32 v39, v232, 0
    v_cvt_pk_bf16_f32 v187, v204, v205
    v_mfma_f32_16x16x32_bf16 v[126:129], a[240:243], v[118:121], 0
    v_exp_f32 v146, v146
    v_mfma_f32_16x16x32_bf16 v[170:173], v[28:31], v[36:39], 0
    v_exp_f32 v147, v147
    v_mfma_f32_16x16x32_bf16 v[170:173], v[28:31], v[194:197], v[170:173]
    v_cvt_pk_bf16_f32 v188, v146, v147
    v_fmac_f32 v254, v208, v208
    v_mfma_f32_16x16x32_bf16 v[114:117], v[162:165], v[36:39], 0
    v_exp_f32 v148, v148
    v_mfma_f32_16x16x32_bf16 v[114:117], v[134:137], v[194:197], v[114:117]
    v_exp_f32 v149, v149
    v_mfma_f32_16x16x32_bf16 v[190:193], v[210:213], v[36:39], 0
    v_cvt_pk_bf16_f32 v189, v148, v149
    v_fmac_f32 v254, v209, v209
    v_mfma_f32_16x16x32_bf16 v[190:193], v[138:141], v[194:197], v[190:193]
    v_rcp_f32 v170, v170
    v_mfma_f32_16x16x32_bf16 v[146:149], v[218:221], v[36:39], 0
    v_exp_f32 v166, v166
    v_mfma_f32_16x16x32_bf16 v[146:149], v[142:145], v[194:197], v[146:149]
    v_mul_f32 v114, v170, v114
    v_mul_f32 v115, v170, v115
    v_mfma_f32_16x16x32_bf16 v[126:129], a[244:247], v[122:125], v[126:129]
    v_cvt_pk_bf16_f32 v194, v114, v115
    v_mul_f32 v116, v170, v116
    v_mfma_f32_16x16x32_bf16 v[126:129], a[248:251], v[150:153], v[126:129]
    ds_read_b128 v[202:205], v2 offset:12288
    v_mul_f32 v117, v170, v117
    v_mfma_f32_16x16x32_bf16 v[126:129], a[252:255], v[154:157], v[126:129]
    ds_read_b128 v[230:233], v2 offset:13312
    v_cvt_pk_bf16_f32 v195, v116, v117
    v_mfma_f32_16x16x32_bf16 v[126:129], v[82:85], v[158:161], v[126:129]
    ds_read_b128 v[234:237], v2 offset:14336
    v_mul_f32 v190, v170, v190
    v_mfma_f32_16x16x32_bf16 v[126:129], v[86:89], v[174:177], v[126:129]
    ds_read_b128 v[238:241], v2 offset:15360
    v_mul_f32 v191, v170, v191
    v_mfma_f32_16x16x32_bf16 v[114:117], v[90:93], v[118:121], 0
    ds_read_b128 v[118:121], v2 offset:16384
    v_cvt_pk_bf16_f32 v196, v190, v191
    v_mfma_f32_16x16x32_bf16 v[114:117], v[94:97], v[122:125], v[114:117]
    ds_read_b128 v[122:125], v2 offset:17408
    v_mul_f32 v192, v170, v192
    v_mfma_f32_16x16x32_bf16 v[114:117], v[98:101], v[150:153], v[114:117]
    v_fmac_f32 v255, v126, v126
    v_fmac_f32 v255, v127, v127
    v_mfma_f32_16x16x32_bf16 v[114:117], v[102:105], v[154:157], v[114:117]
    v_fmac_f32 v255, v128, v128
    v_fmac_f32 v255, v129, v129
    v_mfma_f32_16x16x32_bf16 v[114:117], v[106:109], v[158:161], v[114:117]
    s_waitcnt lgkmcnt(5)
    v_mul_f32 v193, v170, v193
    v_cvt_pk_bf16_f32 v197, v192, v193
    v_mfma_f32_16x16x32_bf16 v[114:117], v[110:113], v[174:177], v[114:117]
    s_waitcnt lgkmcnt(4)
    ds_write_b128 v3, v[194:197] offset:6144
    v_mfma_f32_16x16x32_bf16 v[242:245], a[216:219], v[202:205], 0
    s_waitcnt lgkmcnt(3)
    v_mul_f32 v146, v170, v146
    v_mul_f32 v147, v170, v147
    v_mfma_f32_16x16x32_bf16 v[242:245], a[220:223], v[230:233], v[242:245]
    s_waitcnt lgkmcnt(2)
    v_fmac_f32 v255, v114, v114
    v_fmac_f32 v255, v115, v115
    v_mfma_f32_16x16x32_bf16 v[242:245], a[224:227], v[234:237], v[242:245]
    s_waitcnt lgkmcnt(1)
    v_fmac_f32 v255, v116, v116
    v_fmac_f32 v255, v117, v117
    v_mfma_f32_16x16x32_bf16 v[242:245], a[228:231], v[238:241], v[242:245]
    v_cvt_pk_bf16_f32 v254, v254, v255
    v_cvt_pk_bf16_f32 v172, v146, v147
    v_mfma_f32_16x16x32_bf16 v[242:245], a[232:235], v[118:121], v[242:245]
    v_mul_f32 v148, v170, v148
    v_mul_f32 v149, v170, v149
    v_mfma_f32_16x16x32_bf16 v[242:245], a[236:239], v[122:125], v[242:245]
    v_cvt_pk_bf16_f32 v173, v148, v149
    v_cvt_pk_bf16_f32 v39, v252, 0
    v_mfma_f32_16x16x32_bf16 v[158:161], a[240:243], v[202:205], 0
    ds_write_b64 v4, v[172:173] offset:10240
    v_mfma_f32_16x16x32_bf16 v[158:161], a[244:247], v[230:233], v[158:161]
    v_exp_f32 v167, v167
    v_mfma_f32_16x16x32_bf16 v[158:161], a[248:251], v[234:237], v[158:161]
    v_cvt_pk_bf16_f32 v36, v166, v167
    v_fma_f32 v255, v242, v242, s33
    v_mfma_f32_16x16x32_bf16 v[158:161], a[252:255], v[238:241], v[158:161]
    v_fmac_f32 v255, v243, v243
    v_fmac_f32 v255, v244, v244
    v_mfma_f32_16x16x32_bf16 v[158:161], v[82:85], v[118:121], v[158:161]
    v_fmac_f32 v255, v245, v245
    v_xor_b32 v2, 65536, v2
    v_mfma_f32_16x16x32_bf16 v[158:161], v[86:89], v[122:125], v[158:161]
    v_exp_f32 v168, v168
    v_mfma_f32_16x16x32_bf16 v[154:157], v[90:93], v[202:205], 0
    v_exp_f32 v169, v169
    v_mfma_f32_16x16x32_bf16 v[154:157], v[94:97], v[230:233], v[154:157]
    ds_read_b128 v[146:149], v9
    v_cvt_pk_bf16_f32 v37, v168, v169
    v_mfma_f32_16x16x32_bf16 v[154:157], v[98:101], v[234:237], v[154:157]
    ds_read_b128 v[150:153], v9 offset:64
    v_fmac_f32 v255, v158, v158
    v_mfma_f32_16x16x32_bf16 v[166:169], v[28:31], v[36:39], 0
    v_fmac_f32 v255, v159, v159
    v_fmac_f32 v255, v160, v160
    v_mfma_f32_16x16x32_bf16 v[166:169], v[28:31], v[186:189], v[166:169]
    v_fmac_f32 v255, v161, v161
    v_add_u32 v6, s75, v6
    v_mfma_f32_16x16x32_bf16 v[174:177], v[162:165], v[36:39], 0
    v_rcp_f32 v182, v182
    v_mfma_f32_16x16x32_bf16 v[174:177], v[134:137], v[186:189], v[174:177]
    v_max3_u32 v25, v25, v182, v183
    v_max3_u32 v25, v25, v170, v171
    v_mfma_f32_16x16x32_bf16 v[170:173], v[210:213], v[36:39], 0
    v_rcp_f32 v166, v166
    v_mfma_f32_16x16x32_bf16 v[170:173], v[138:141], v[186:189], v[170:173]
    v_max3_u32 v25, v25, v166, v167
    v_mul_f32 v214, v182, v214
    v_mfma_f32_16x16x32_bf16 v[190:193], v[218:221], v[36:39], 0
    s_waitcnt lgkmcnt(1)
    v_mul_f32 v174, v166, v174
    v_mul_f32 v175, v166, v175
    v_mfma_f32_16x16x32_bf16 v[190:193], v[142:145], v[186:189], v[190:193]
    s_waitcnt lgkmcnt(0)
    v_cvt_pk_bf16_f32 v174, v174, v175
    v_mul_f32 v176, v166, v176
    v_mfma_f32_16x16x32_bf16 v[154:157], v[102:105], v[238:241], v[154:157]
    ds_read_b128 v[186:189], v0 offset:20480
    v_mul_f32 v177, v166, v177
    v_mfma_f32_16x16x32_bf16 v[154:157], v[106:109], v[118:121], v[154:157]
    ds_read_b128 v[194:197], v1 offset:20480
    v_cvt_pk_bf16_f32 v175, v176, v177
    v_mfma_f32_16x16x32_bf16 v[154:157], v[110:113], v[122:125], v[154:157]
    ds_read_b128 v[122:125], v0 offset:20608
    v_mul_f32 v170, v166, v170
    v_mfma_f32_16x16x32_bf16 v[118:121], v[146:149], v[28:31], 0
    ds_read_b128 v[202:205], v1 offset:20608
    v_mul_f32 v171, v166, v171
    v_mfma_f32_16x16x32_bf16 v[118:121], v[150:153], v[28:31], v[118:121]
    ds_read_b128 v[230:233], v0 offset:20736
    v_cvt_pk_bf16_f32 v176, v170, v171
    v_mfma_f32_16x16x32_bf16 v[234:237], v[146:149], v[134:137], 0
    ds_read_b128 v[238:241], v1 offset:20736
    v_fmac_f32 v255, v154, v154
    v_mfma_f32_16x16x32_bf16 v[234:237], v[150:153], v[162:165], v[234:237]
    v_fmac_f32 v255, v155, v155
    v_fmac_f32 v255, v156, v156
    v_mfma_f32_16x16x32_bf16 v[134:137], v[146:149], v[138:141], 0
    v_fmac_f32 v255, v157, v157
    v_cvt_pk_bf16_f32 v255, v255, v255
    v_mfma_f32_16x16x32_bf16 v[134:137], v[150:153], v[210:213], v[134:137]
    s_waitcnt lgkmcnt(5)
    ds_write_b64 v4, v[254:255] offset:18432
    v_mfma_f32_16x16x32_bf16 v[138:141], v[146:149], v[142:145], 0
    s_waitcnt lgkmcnt(4)
    v_mul_f32 v172, v166, v172
    v_mul_f32 v173, v166, v173
    v_mfma_f32_16x16x32_bf16 v[138:141], v[150:153], v[218:221], v[138:141]
    s_waitcnt lgkmcnt(3)
    v_cvt_pk_bf16_f32 v177, v172, v173
    v_mul_f32 v190, v166, v190
    v_mfma_f32_16x16x32_bf16 v[142:145], a[72:75], v[186:189], 0
    s_waitcnt lgkmcnt(2)
    ds_write_b128 v3, v[174:177] offset:12288
    v_mfma_f32_16x16x32_bf16 v[142:145], a[76:79], v[194:197], v[142:145]
    s_waitcnt lgkmcnt(2)
    v_mul_f32 v191, v166, v191
    v_cvt_pk_bf16_f32 v120, v190, v191
    v_mfma_f32_16x16x32_bf16 v[142:145], a[80:83], v[122:125], v[142:145]
    v_mul_f32 v192, v166, v192
    v_mul_f32 v193, v166, v193
    v_mfma_f32_16x16x32_bf16 v[142:145], a[84:87], v[202:205], v[142:145]
    v_cvt_pk_bf16_f32 v121, v192, v193
    v_mul_f32 v215, v182, v215
    v_mfma_f32_16x16x32_bf16 v[142:145], a[88:91], v[230:233], v[142:145]
    ds_write_b64 v4, v[120:121] offset:16384
    v_mfma_f32_16x16x32_bf16 v[142:145], a[92:95], v[238:241], v[142:145]
    v_rcp_f32 v118, v118
    v_mfma_f32_16x16x32_bf16 v[150:153], a[96:99], v[186:189], 0
    v_max3_u32 v25, v25, v118, v119
    v_mul_f32 v234, v234, v118
    v_mfma_f32_16x16x32_bf16 v[150:153], a[100:103], v[194:197], v[150:153]
    v_cvt_pk_bf16_f32 v146, v214, v215
    v_mul_f32_dpp v234, v134, v118 quad_perm:[0,1,2,3] row_mask:0x2 bank_mask:0xf
    v_mfma_f32_16x16x32_bf16 v[150:153], a[104:107], v[122:125], v[150:153]
    v_mul_f32 v216, v182, v216
    v_mul_f32_dpp v234, v138, v118 quad_perm:[0,1,2,3] row_mask:0x4 bank_mask:0xf
    v_mfma_f32_16x16x32_bf16 v[150:153], a[108:111], v[202:205], v[150:153]
    v_cvt_pk_bf16_f32 v234, v234, v234
    v_mul_f32 v217, v182, v217
    v_mfma_f32_16x16x32_bf16 v[150:153], a[112:115], v[230:233], v[150:153]
    ds_write_b16 v7, v234
    v_mfma_f32_16x16x32_bf16 v[150:153], a[116:119], v[238:241], v[150:153]
    v_cvt_pk_bf16_f32 v147, v216, v217
    v_mul_f32 v222, v182, v222
    v_mfma_f32_16x16x32_bf16 v[134:137], a[120:123], v[186:189], 0
    v_mul_f32 v223, v182, v223
    v_cvt_pk_bf16_f32 v148, v222, v223
    v_mfma_f32_16x16x32_bf16 v[134:137], a[124:127], v[194:197], v[134:137]
    v_mul_f32 v224, v182, v224
    v_mul_f32 v225, v182, v225
    v_mfma_f32_16x16x32_bf16 v[134:137], a[128:131], v[122:125], v[134:137]
    v_cvt_pk_bf16_f32 v149, v224, v225
    v_mul_f32 v226, v182, v226
    v_mfma_f32_16x16x32_bf16 v[134:137], a[132:135], v[202:205], v[134:137]
    ds_write_b128 v3, v[146:149] offset:0
    v_mfma_f32_16x16x32_bf16 v[134:137], a[136:139], v[230:233], v[134:137]
    v_mul_f32 v227, v182, v227
    v_cvt_pk_bf16_f32 v254, v226, v227
    v_mfma_f32_16x16x32_bf16 v[134:137], a[140:143], v[238:241], v[134:137]
    v_mul_f32 v228, v182, v228
    v_mul_f32 v229, v182, v229
    v_mfma_f32_16x16x32_bf16 v[138:141], a[0:3], v[186:189], 0
    v_cvt_pk_bf16_f32 v255, v228, v229
    v_xor_b32 v3, 65536, v3
    v_mfma_f32_16x16x32_bf16 v[138:141], a[4:7], v[194:197], v[138:141]
    ds_write_b64 v4, v[254:255] offset:4096
    v_mfma_f32_16x16x32_bf16 v[138:141], a[8:11], v[122:125], v[138:141]
    v_xor_b32 v4, 65536, v4
    v_add_u32 v7, s76, v7
    v_mfma_f32_16x16x32_bf16 v[138:141], a[12:15], v[202:205], v[138:141]
    v_cvt_pk_f16_f32 v146, v142, v143
    v_pk_mul_f16 v143, v146, v146
    v_mfma_f32_16x16x32_bf16 v[138:141], a[16:19], v[230:233], v[138:141]
    v_cvt_pk_f16_f32 v147, v144, v145
    v_pk_fma_f16 v143, v147, v147, v143
    v_mfma_f32_16x16x32_bf16 v[138:141], a[20:23], v[238:241], v[138:141]
    v_cvt_pk_f16_f32 v148, v150, v151
    v_pk_fma_f16 v143, v148, v148, v143
    v_mfma_f32_16x16x32_bf16 v[166:169], a[24:27], v[186:189], 0
    v_cvt_pk_f16_f32 v149, v152, v153
    v_pk_fma_f16 v143, v149, v149, v143
    v_mfma_f32_16x16x32_bf16 v[166:169], a[28:31], v[194:197], v[166:169]
    v_cvt_pk_f16_f32 v120, v134, v135
    v_pk_fma_f16 v143, v120, v120, v143
    v_mfma_f32_16x16x32_bf16 v[166:169], a[32:35], v[122:125], v[166:169]
    s_waitcnt lgkmcnt(0)
    v_cvt_pk_f16_f32 v121, v136, v137
    v_pk_fma_f16 v143, v121, v121, v143
    v_mfma_f32_16x16x32_bf16 v[166:169], a[36:39], v[202:205], v[166:169]
    s_nop 0
    v_mfma_f32_16x16x32_bf16 v[166:169], a[40:43], v[230:233], v[166:169]
    s_nop 0
    v_mfma_f32_16x16x32_bf16 v[166:169], a[44:47], v[238:241], v[166:169]
    s_barrier
    v_mfma_f32_16x16x32_bf16 v[134:137], a[48:51], v[186:189], 0
    s_nop 0
    v_mfma_f32_16x16x32_bf16 v[134:137], a[52:55], v[194:197], v[134:137]
    s_cbranch_scc1 L_loop_fast2
    s_branch L_final_fast
.p2align 6
L_loop_fast3:
    v_mfma_f32_16x16x32_bf16 v[134:137], a[56:59], v[122:125], v[134:137]
    s_add_u32 s12, s40, s27
    ds_read_b128 v[190:193], v2 offset:18432
    v_cvt_pk_f16_f32 v150, v138, v139
    v_mfma_f32_16x16x32_bf16 v[134:137], a[60:63], v[202:205], v[134:137]
    s_addc_u32 s13, s41, 0
    ds_read_b128 v[210:213], v2 offset:19456
    v_pk_mul_f16 v142, v150, v150
    v_mfma_f32_16x16x32_bf16 v[134:137], a[64:67], v[230:233], v[134:137]
    s_sub_u32 s14, s36, s27
    ds_read_b128 v[174:177], v5 offset:32
    v_cvt_pk_f16_f32 v151, v140, v141
    v_mfma_f32_16x16x32_bf16 v[134:137], a[68:71], v[238:241], v[134:137]
    s_cmp_ge_u32 s18, 2
    ds_read2_b64 v[162:165], v5 offset0:6 offset1:9
    v_pk_fma_f16 v142, v151, v151, v142
    v_mfma_f32_16x16x32_bf16 v[138:141], v[186:189], a[144:147], 0
    s_cselect_b32 s14, s14, 0
    ds_read_b128 v[170:173], v5
    v_cvt_pk_f16_f32 v152, v166, v167
    v_mfma_f32_16x16x32_bf16 v[138:141], v[194:197], a[148:151], v[138:141]
    s_sub_u32 s82, s72, s71
    ds_read_b32 v254, v6 offset:192
    v_pk_fma_f16 v142, v152, v152, v142
    v_mfma_f32_16x16x32_bf16 v[138:141], v[122:125], a[152:155], v[138:141]
    s_mul_i32 s74, s82, 336
    v_cvt_pk_f16_f32 v153, v168, v169
    v_pk_fma_f16 v142, v153, v153, v142
    v_mfma_f32_16x16x32_bf16 v[138:141], v[202:205], a[156:159], v[138:141]
    s_mul_i32 s75, s82, 272
    v_cvt_pk_f16_f32 v118, v134, v135
    v_pk_fma_f16 v142, v118, v118, v142
    v_mfma_f32_16x16x32_bf16 v[138:141], v[230:233], a[160:163], v[138:141]
    s_waitcnt lgkmcnt(5)
    ds_read_b128 v[182:185], v0 offset:26624
    v_cvt_pk_f16_f32 v119, v136, v137
    v_mfma_f32_16x16x32_bf16 v[166:169], v[32:35], v[190:193], 0
    s_waitcnt lgkmcnt(5)
    v_pk_fma_f16 v142, v119, v119, v142
    v_add_u32 v5, s74, v5
    v_mfma_f32_16x16x32_bf16 v[166:169], v[32:35], v[210:213], v[166:169]
    s_waitcnt lgkmcnt(4)
    v_pk_mul_f16 v145, v146, v174
    v_pk_fma_f16 v145, v147, v175, v145
    v_mfma_f32_16x16x32_bf16 v[138:141], v[238:241], a[164:167], v[138:141]
    s_mul_i32 s76, s82, 16
    ds_read_b128 v[210:213], v1 offset:26624
    v_pk_fma_f16 v145, v148, v176, v145
    v_mfma_f32_16x16x32_bf16 v[214:217], v[186:189], a[168:171], 0
    s_waitcnt lgkmcnt(3)
    ds_read_b128 v[218:221], v0 offset:26752
    v_pk_fma_f16 v145, v149, v177, v145
    v_mfma_f32_16x16x32_bf16 v[214:217], v[194:197], a[172:175], v[214:217]
    s_waitcnt lgkmcnt(3)
    ds_read_b128 v[222:225], v1 offset:26752
    v_mov_b32_dpp v254, v23 quad_perm:[0,1,2,3] row_mask:0x7 bank_mask:0xf
    v_mfma_f32_16x16x32_bf16 v[214:217], v[122:125], a[176:179], v[214:217]
    s_add_u32 s34, s18, 2
    ds_read_b128 v[226:229], v0 offset:26880
    v_pk_fma_f16 v145, v120, v164, v145
    v_mfma_f32_16x16x32_bf16 v[214:217], v[202:205], a[180:183], v[214:217]
    s_add_u32 s8, s60, s23
    ds_read_b128 v[190:193], v1 offset:26880
    v_pk_fma_f16 v145, v121, v165, v145
    v_mfma_f32_16x16x32_bf16 v[214:217], v[230:233], a[184:187], v[214:217]
    s_waitcnt lgkmcnt(5)
    v_pk_mul_f16 v144, v150, v170
    v_pk_fma_f16 v144, v151, v171, v144
    v_mfma_f32_16x16x32_bf16 v[214:217], v[238:241], a[188:191], v[214:217]
    s_addc_u32 s9, s61, 0
    v_pk_fma_f16 v144, v152, v172, v144
    v_pk_fma_f16 v144, v153, v173, v144
    v_mfma_f32_16x16x32_bf16 v[246:249], v[186:189], a[192:195], 0
    s_sub_u32 s10, s36, s23
    v_pk_fma_f16 v144, v118, v162, v144
    v_pk_fma_f16 v144, v119, v163, v144
    v_mfma_f32_16x16x32_bf16 v[246:249], v[194:197], a[196:199], v[246:249]
    s_cmp_le_u32 s34, s45
    v_cvt_pk_bf16_f32 v134, v138, v139
    v_cvt_pk_bf16_f32 v135, v140, v141
    v_mfma_f32_16x16x32_f16 v[234:237], v[40:43], v[142:145], 0
    s_cselect_b32 s10, s10, 0
    v_cvt_pk_bf16_f32 v138, v214, v215
    v_cvt_pk_bf16_f32 v139, v216, v217
    v_mfma_f32_16x16x32_bf16 v[246:249], v[122:125], a[200:203], v[246:249]
    s_add_u32 m0, s28, 0
    v_mul_f32 v136, 0x3baaaaab, v166
    v_mul_f32 v255, 0x3baaaaab, v167
    v_mfma_f32_16x16x32_bf16 v[246:249], v[202:205], a[204:207], v[246:249]
    s_mov_b32 s27, s26
    v_rsq_f32 v234, v234
    v_mfma_f32_16x16x32_bf16 v[246:249], v[230:233], a[208:211], v[246:249]
    s_mov_b32 s26, s25
    v_rsq_f32 v235, v235
    v_mfma_f32_16x16x32_bf16 v[246:249], v[238:241], a[212:215], v[246:249]
    s_mov_b32 s25, s24
    v_mul_f32 v140, s31, v234
    v_cvt_pk_f16_f32 v141, v140, v235
    v_mfma_f32_16x16x32_bf16 v[122:125], a[72:75], v[182:185], 0
    s_waitcnt lgkmcnt(0)
    v_fma_f32 v236, v236, v140, v22
    v_fmac_f32_dpp v254, v237, v235 quad_perm:[0,1,2,3] row_mask:0x1 bank_mask:0xf
    v_mfma_f32_16x16x32_bf16 v[122:125], a[76:79], v[210:213], v[122:125]
    s_mov_b32 s24, s23
    v_cvt_pk_bf16_f32 v142, v246, v247
    v_cvt_pk_bf16_f32 v143, v248, v249
    v_mfma_f32_16x16x32_bf16 v[122:125], a[80:83], v[218:221], v[122:125]
    s_mov_b32 s71, s72
    v_pk_mul_f16 v146, v146, v141 op_sel:[0,1] op_sel_hi:[1,1]
    v_pk_mul_f16 v147, v147, v141 op_sel:[0,1] op_sel_hi:[1,1]
    v_mfma_f32_16x16x32_bf16 v[122:125], a[84:87], v[222:225], v[122:125]
    s_mov_b32 s72, s73
    v_pk_mul_f16 v148, v148, v141 op_sel:[0,1] op_sel_hi:[1,1]
    v_pk_mul_f16 v149, v149, v141 op_sel:[0,1] op_sel_hi:[1,1]
    v_mfma_f32_16x16x32_bf16 v[122:125], a[88:91], v[226:229], v[122:125]
    v_pk_mul_f16 v120, v120, v141 op_sel:[0,1] op_sel_hi:[1,1]
    v_pk_mul_f16 v121, v121, v141 op_sel:[0,1] op_sel_hi:[1,1]
    v_mfma_f32_16x16x32_bf16 v[122:125], a[92:95], v[190:193], v[122:125]
    v_pk_mul_f16 v150, v150, v141 op_sel:[0,0] op_sel_hi:[1,0]
    v_pk_mul_f16 v151, v151, v141 op_sel:[0,0] op_sel_hi:[1,0]
    v_mfma_f32_16x16x32_bf16 v[186:189], a[96:99], v[182:185], 0
    v_pk_mul_f16 v152, v152, v141 op_sel:[0,0] op_sel_hi:[1,0]
    v_pk_mul_f16 v153, v153, v141 op_sel:[0,0] op_sel_hi:[1,0]
    v_mfma_f32_16x16x32_bf16 v[186:189], a[100:103], v[210:213], v[186:189]
    v_pk_mul_f16 v118, v118, v141 op_sel:[0,0] op_sel_hi:[1,0]
    v_pk_mul_f16 v119, v119, v141 op_sel:[0,0] op_sel_hi:[1,0]
    v_mfma_f32_16x16x32_bf16 v[186:189], a[104:107], v[218:221], v[186:189]
    v_max3_u32 v44, v44, v234, v235
    v_mul_f32 v144, 0x3baaaaab, v168
    v_mfma_f32_16x16x32_bf16 v[186:189], a[108:111], v[222:225], v[186:189]
    v_rsq_f32 v136, v136
    v_mfma_f32_16x16x32_bf16 v[186:189], a[112:115], v[226:229], v[186:189]
    v_rsq_f32 v255, v255
    v_mfma_f32_16x16x32_bf16 v[186:189], a[116:119], v[190:193], v[186:189]
    v_rsq_f32 v144, v144
    v_mfma_f32_16x16x32_bf16 v[194:197], a[120:123], v[182:185], 0
    v_mul_f32 v178, v136, v178
    v_mul_f32 v179, v136, v179
    v_mfma_f32_16x16x32_bf16 v[194:197], a[124:127], v[210:213], v[194:197]
    v_cvt_pk_bf16_f32 v166, v178, v179
    v_mul_f32 v180, v136, v180
    v_mfma_f32_16x16x32_bf16 v[194:197], a[128:131], v[218:221], v[194:197]
    v_mul_f32 v181, v136, v181
    v_cvt_pk_bf16_f32 v167, v180, v181
    v_mfma_f32_16x16x32_bf16 v[194:197], a[132:135], v[222:225], v[194:197]
    v_mul_f32 v198, v136, v198
    v_mul_f32 v199, v136, v199
    v_mfma_f32_16x16x32_bf16 v[194:197], a[136:139], v[226:229], v[194:197]
    v_cvt_pk_bf16_f32 v168, v198, v199
    v_mul_f32 v200, v136, v200
    v_mfma_f32_16x16x32_bf16 v[194:197], a[140:143], v[190:193], v[194:197]
    v_mul_f32 v201, v136, v201
    v_cvt_pk_bf16_f32 v169, v200, v201
    v_mfma_f32_16x16x32_bf16 v[178:181], a[0:3], v[182:185], 0
    buffer_store_dwordx4 v[166:169], v15, s[12:15], 0 offen nt
    v_mul_f32 v206, v136, v206
    v_mul_f32 v207, v136, v207
    v_cvt_pk_bf16_f32 v140, v206, v207
    v_mul_f32 v208, v136, v208
    v_mfma_f32_16x16x32_bf16 v[178:181], a[4:7], v[210:213], v[178:181]
    v_mul_f32 v209, v136, v209
    v_cvt_pk_bf16_f32 v141, v208, v209
    v_mfma_f32_16x16x32_bf16 v[178:181], a[8:11], v[218:221], v[178:181]
    v_cvt_pk_f16_f32 v166, v122, v123
    v_pk_mul_f16 v199, v166, v166
    v_mfma_f32_16x16x32_bf16 v[178:181], a[12:15], v[222:225], v[178:181]
    v_cvt_pk_f16_f32 v167, v124, v125
    v_pk_fma_f16 v199, v167, v167, v199
    v_mfma_f32_16x16x32_bf16 v[178:181], a[16:19], v[226:229], v[178:181]
    v_cvt_pk_f16_f32 v168, v186, v187
    v_pk_fma_f16 v199, v168, v168, v199
    v_mfma_f32_16x16x32_bf16 v[178:181], a[20:23], v[190:193], v[178:181]
    v_cvt_pk_f16_f32 v169, v188, v189
    v_pk_fma_f16 v199, v169, v169, v199
    v_mfma_f32_16x16x32_bf16 v[186:189], a[24:27], v[182:185], 0
    v_cvt_pk_f16_f32 v124, v194, v195
    v_pk_fma_f16 v199, v124, v124, v199
    v_mfma_f32_16x16x32_bf16 v[186:189], a[28:31], v[210:213], v[186:189]
    v_cvt_pk_f16_f32 v125, v196, v197
    v_pk_fma_f16 v199, v125, v125, v199
    v_mfma_f32_16x16x32_bf16 v[186:189], a[32:35], v[218:221], v[186:189]
    v_cvt_pk_f16_f32 v178, v178, v179
    v_pk_mul_f16 v198, v178, v178
    v_mfma_f32_16x16x32_bf16 v[186:189], a[36:39], v[222:225], v[186:189]
    v_cvt_pk_f16_f32 v179, v180, v181
    v_pk_fma_f16 v198, v179, v179, v198
    v_mfma_f32_16x16x32_bf16 v[186:189], a[40:43], v[226:229], v[186:189]
    v_pk_mul_f16 v200, v178, v170
    v_pk_fma_f16 v200, v179, v171, v200
    v_mfma_f32_16x16x32_bf16 v[186:189], a[44:47], v[190:193], v[186:189]
    v_pk_mul_f16 v201, v166, v174
    v_pk_fma_f16 v201, v167, v175, v201
    v_mfma_f32_16x16x32_bf16 v[194:197], a[48:51], v[182:185], 0
    v_pk_fma_f16 v201, v168, v176, v201
    v_pk_fma_f16 v201, v169, v177, v201
    v_mfma_f32_16x16x32_bf16 v[194:197], a[52:55], v[210:213], v[194:197]
    v_pk_fma_f16 v201, v124, v164, v201
    v_pk_fma_f16 v201, v125, v165, v201
    v_mfma_f32_16x16x32_bf16 v[194:197], a[56:59], v[218:221], v[194:197]
    v_cvt_pk_f16_f32 v180, v186, v187
    v_pk_fma_f16 v198, v180, v180, v198
    v_mfma_f32_16x16x32_bf16 v[194:197], a[60:63], v[222:225], v[194:197]
    v_cvt_pk_f16_f32 v181, v188, v189
    v_pk_fma_f16 v198, v181, v181, v198
    v_mfma_f32_16x16x32_bf16 v[194:197], a[64:67], v[226:229], v[194:197]
    v_pk_fma_f16 v200, v180, v172, v200
    v_pk_fma_f16 v200, v181, v173, v200
    v_mfma_f32_16x16x32_bf16 v[194:197], a[68:71], v[190:193], v[194:197]
    buffer_store_dwordx2 v[140:141], v18, s[12:15], 0 offen nt
    v_mul_f32 v242, v144, v242
    v_mul_f32 v243, v144, v243
    v_mfma_f32_16x16x32_bf16 v[186:189], v[182:185], a[144:147], 0
    v_cvt_pk_bf16_f32 v238, v242, v243
    v_mul_f32 v244, v144, v244
    v_mfma_f32_16x16x32_bf16 v[186:189], v[210:213], a[148:151], v[186:189]
    v_mul_f32 v245, v144, v245
    v_cvt_pk_f16_f32 v122, v194, v195
    v_mfma_f32_16x16x32_bf16 v[186:189], v[218:221], a[152:155], v[186:189]
    v_pk_fma_f16 v198, v122, v122, v198
    v_cvt_pk_f16_f32 v123, v196, v197
    v_mfma_f32_16x16x32_bf16 v[186:189], v[222:225], a[156:159], v[186:189]
    v_pk_fma_f16 v198, v123, v123, v198
    v_pk_fma_f16 v200, v122, v162, v200
    v_mfma_f32_16x16x32_bf16 v[186:189], v[226:229], a[160:163], v[186:189]
    ds_read_b128 v[202:205], v0 offset:32768
    v_pk_fma_f16 v200, v123, v163, v200
    v_mfma_f32_16x16x32_bf16 v[186:189], v[190:193], a[164:167], v[186:189]
    ds_read_b128 v[194:197], v1 offset:32768
    v_cvt_pk_bf16_f32 v239, v244, v245
    v_mfma_f32_16x16x32_f16 v[230:233], v[40:43], v[198:201], 0
    v_mul_f32 v158, v144, v158
    v_mul_f32 v159, v144, v159
    v_mfma_f32_16x16x32_bf16 v[246:249], v[182:185], a[168:171], 0
    ds_read_b128 v[214:217], v0 offset:32896
    v_cvt_pk_bf16_f32 v240, v158, v159
    v_mfma_f32_16x16x32_bf16 v[246:249], v[210:213], a[172:175], v[246:249]
    ds_read_b128 v[206:209], v1 offset:32896
    v_cvt_pk_bf16_f32 v136, v186, v187
    v_mfma_f32_16x16x32_bf16 v[246:249], v[218:221], a[176:179], v[246:249]
    ds_read_b128 v[198:201], v0 offset:33024
    v_cvt_pk_bf16_f32 v137, v188, v189
    v_mfma_f32_16x16x32_bf16 v[246:249], v[222:225], a[180:183], v[246:249]
    ds_read_b128 v[186:189], v1 offset:33024
    v_mul_f32 v160, v144, v160
    v_mfma_f32_16x16x32_bf16 v[246:249], v[226:229], a[184:187], v[246:249]
    v_rsq_f32 v230, v230
    v_mfma_f32_16x16x32_bf16 v[246:249], v[190:193], a[188:191], v[246:249]
    s_waitcnt lgkmcnt(5)
    v_rsq_f32 v231, v231
    v_mfma_f32_16x16x32_bf16 v[242:245], v[182:185], a[192:195], 0
    s_waitcnt lgkmcnt(4)
    v_mul_f32 v234, s31, v230
    v_cvt_pk_f16_f32 v235, v234, v231
    v_mfma_f32_16x16x32_bf16 v[242:245], v[210:213], a[196:199], v[242:245]
    v_fma_f32 v232, v232, v234, v24
    v_fmac_f32_dpp v254, v233, v231 quad_perm:[0,1,2,3] row_mask:0x2 bank_mask:0xf
    v_mfma_f32_16x16x32_bf16 v[242:245], v[218:221], a[200:203], v[242:245]
    s_waitcnt lgkmcnt(3)
    v_cvt_pk_bf16_f32 v140, v246, v247
    v_cvt_pk_bf16_f32 v141, v248, v249
    v_mfma_f32_16x16x32_bf16 v[242:245], v[222:225], a[204:207], v[242:245]
    s_waitcnt lgkmcnt(2)
    v_mul_f32 v161, v144, v161
    v_cvt_pk_bf16_f32 v241, v160, v161
    v_mfma_f32_16x16x32_bf16 v[242:245], v[226:229], a[208:211], v[242:245]
    s_waitcnt lgkmcnt(1)
    buffer_store_dwordx4 v[238:241], v17, s[12:15], 0 offen nt
    v_mul_f32 v154, v144, v154
    v_mul_f32 v155, v144, v155
    v_cvt_pk_bf16_f32 v154, v154, v155
    v_mul_f32 v156, v144, v156
    v_mfma_f32_16x16x32_bf16 v[242:245], v[190:193], a[212:215], v[242:245]
    s_waitcnt lgkmcnt(0)
    v_mul_f32 v157, v144, v157
    v_cvt_pk_bf16_f32 v155, v156, v157
    v_mfma_f32_16x16x32_bf16 v[158:161], a[72:75], v[202:205], 0
    v_pk_mul_f16 v166, v166, v235 op_sel:[0,1] op_sel_hi:[1,1]
    v_pk_mul_f16 v167, v167, v235 op_sel:[0,1] op_sel_hi:[1,1]
    v_mfma_f32_16x16x32_bf16 v[158:161], a[76:79], v[194:197], v[158:161]
    v_pk_mul_f16 v168, v168, v235 op_sel:[0,1] op_sel_hi:[1,1]
    v_cvt_pk_bf16_f32 v144, v242, v243
    v_mfma_f32_16x16x32_bf16 v[158:161], a[80:83], v[214:217], v[158:161]
    v_cvt_pk_bf16_f32 v145, v244, v245
    v_pk_mul_f16 v169, v169, v235 op_sel:[0,1] op_sel_hi:[1,1]
    v_mfma_f32_16x16x32_bf16 v[158:161], a[84:87], v[206:209], v[158:161]
    v_pk_mul_f16 v124, v124, v235 op_sel:[0,1] op_sel_hi:[1,1]
    v_pk_mul_f16 v125, v125, v235 op_sel:[0,1] op_sel_hi:[1,1]
    v_mfma_f32_16x16x32_bf16 v[158:161], a[88:91], v[198:201], v[158:161]
    v_pk_mul_f16 v178, v178, v235 op_sel:[0,0] op_sel_hi:[1,0]
    v_pk_mul_f16 v179, v179, v235 op_sel:[0,0] op_sel_hi:[1,0]
    v_mfma_f32_16x16x32_bf16 v[158:161], a[92:95], v[186:189], v[158:161]
    v_pk_mul_f16 v180, v180, v235 op_sel:[0,0] op_sel_hi:[1,0]
    v_pk_mul_f16 v181, v181, v235 op_sel:[0,0] op_sel_hi:[1,0]
    v_mfma_f32_16x16x32_bf16 v[182:185], a[96:99], v[202:205], 0
    v_pk_mul_f16 v122, v122, v235 op_sel:[0,0] op_sel_hi:[1,0]
    v_pk_mul_f16 v123, v123, v235 op_sel:[0,0] op_sel_hi:[1,0]
    v_mfma_f32_16x16x32_bf16 v[182:185], a[100:103], v[194:197], v[182:185]
    v_max3_u32 v44, v44, v230, v231
    v_mul_f32 v130, v255, v130
    v_mfma_f32_16x16x32_bf16 v[182:185], a[104:107], v[214:217], v[182:185]
    v_cvt_pk_f16_f32 v158, v158, v159
    v_pk_mul_f16 v191, v158, v158
    v_mfma_f32_16x16x32_bf16 v[182:185], a[108:111], v[206:209], v[182:185]
    v_cvt_pk_f16_f32 v159, v160, v161
    v_pk_fma_f16 v191, v159, v159, v191
    v_mfma_f32_16x16x32_bf16 v[182:185], a[112:115], v[198:201], v[182:185]
    v_pk_mul_f16 v193, v158, v174
    v_pk_fma_f16 v193, v159, v175, v193
    v_mfma_f32_16x16x32_bf16 v[182:185], a[116:119], v[186:189], v[182:185]
    v_exp_f32 v232, v232
    v_mfma_f32_16x16x32_bf16 v[210:213], a[120:123], v[202:205], 0
    v_exp_f32 v236, v236
    v_mfma_f32_16x16x32_bf16 v[210:213], a[124:127], v[194:197], v[210:213]
    v_cvt_pk_bf16_f32 v39, v236, 0
    v_mul_f32 v131, v255, v131
    v_mfma_f32_16x16x32_bf16 v[210:213], a[128:131], v[214:217], v[210:213]
    s_waitcnt vmcnt(3)
    ds_write_b16 v8, v45 offset:512
    v_mfma_f32_16x16x32_bf16 v[210:213], a[132:135], v[206:209], v[210:213]
    buffer_store_dwordx2 v[154:155], v20, s[12:15], 0 offen nt
    v_cvt_pk_f16_f32 v160, v182, v183
    v_mfma_f32_16x16x32_bf16 v[210:213], a[136:139], v[198:201], v[210:213]
    v_pk_fma_f16 v191, v160, v160, v191
    v_cvt_pk_f16_f32 v161, v184, v185
    v_mfma_f32_16x16x32_bf16 v[210:213], a[140:143], v[186:189], v[210:213]
    v_pk_fma_f16 v191, v161, v161, v191
    v_pk_fma_f16 v193, v160, v176, v193
    v_mfma_f32_16x16x32_bf16 v[154:157], a[0:3], v[202:205], 0
    v_pk_fma_f16 v193, v161, v177, v193
    v_cvt_pk_bf16_f32 v130, v130, v131
    v_mfma_f32_16x16x32_bf16 v[154:157], a[4:7], v[194:197], v[154:157]
    v_mul_f32 v132, v255, v132
    v_mul_f32 v133, v255, v133
    v_mfma_f32_16x16x32_bf16 v[154:157], a[8:11], v[214:217], v[154:157]
    v_cvt_pk_f16_f32 v176, v210, v211
    v_pk_fma_f16 v191, v176, v176, v191
    v_mfma_f32_16x16x32_bf16 v[154:157], a[12:15], v[206:209], v[154:157]
    s_waitcnt lgkmcnt(0)
    v_cvt_pk_f16_f32 v177, v212, v213
    v_pk_fma_f16 v191, v177, v177, v191
    v_mfma_f32_16x16x32_bf16 v[154:157], a[16:19], v[198:201], v[154:157]
    v_pk_fma_f16 v193, v176, v164, v193
    v_mfma_f32_16x16x32_bf16 v[154:157], a[20:23], v[186:189], v[154:157]
    v_pk_fma_f16 v193, v177, v165, v193
    v_mfma_f32_16x16x32_bf16 v[182:185], a[24:27], v[202:205], 0
    v_cvt_pk_bf16_f32 v131, v132, v133
    v_mfma_f32_16x16x32_bf16 v[182:185], a[28:31], v[194:197], v[182:185]
    s_barrier
    ds_read2_b32 v[164:165], v6 offset0:0 offset1:0
    v_mfma_f32_16x16x32_bf16 v[182:185], a[32:35], v[214:217], v[182:185]
    ds_read2_b32 v[212:213], v6 offset0:16 offset1:16
    v_cvt_pk_f16_f32 v154, v154, v155
    v_mfma_f32_16x16x32_bf16 v[182:185], a[36:39], v[206:209], v[182:185]
    ds_read2_b32 v[220:221], v6 offset0:32 offset1:32
    v_pk_mul_f16 v190, v154, v154
    v_mfma_f32_16x16x32_bf16 v[182:185], a[40:43], v[198:201], v[182:185]
    ds_read_u16 v133, v9 offset:128
    v_cvt_pk_f16_f32 v155, v156, v157
    v_mfma_f32_16x16x32_bf16 v[182:185], a[44:47], v[186:189], v[182:185]
    v_pk_fma_f16 v190, v155, v155, v190
    v_pk_mul_f16 v192, v154, v170
    v_mfma_f32_16x16x32_bf16 v[222:225], a[48:51], v[202:205], 0
    v_pk_fma_f16 v192, v155, v171, v192
    v_mul_f32 v126, v255, v126
    v_mfma_f32_16x16x32_bf16 v[222:225], a[52:55], v[194:197], v[222:225]
    v_mul_f32 v127, v255, v127
    v_cvt_pk_bf16_f32 v132, v126, v127
    v_mfma_f32_16x16x32_bf16 v[222:225], a[56:59], v[214:217], v[222:225]
    buffer_load_dwordx4 v10, s[8:11], 0 offen nt lds
    v_cvt_pk_f16_f32 v156, v182, v183
    v_mfma_f32_16x16x32_bf16 v[222:225], a[60:63], v[206:209], v[222:225]
    s_add_u32 m0, s28, 4096
    v_pk_fma_f16 v190, v156, v156, v190
    v_cvt_pk_f16_f32 v157, v184, v185
    v_mfma_f32_16x16x32_bf16 v[222:225], a[64:67], v[198:201], v[222:225]
    s_waitcnt lgkmcnt(2)
    v_pk_fma_f16 v190, v157, v157, v190
    v_pk_fma_f16 v192, v156, v172, v192
    v_mfma_f32_16x16x32_bf16 v[222:225], a[68:71], v[186:189], v[222:225]
    s_waitcnt lgkmcnt(1)
    ds_read_b128 v[182:185], v2 offset:0
    v_pk_fma_f16 v192, v157, v173, v192
    v_mfma_f32_16x16x32_bf16 v[170:173], v[202:205], a[144:147], 0
    s_waitcnt lgkmcnt(1)
    ds_read_b128 v[226:229], v2 offset:1024
    v_readfirstlane_b32 s77, v133
    v_mfma_f32_16x16x32_bf16 v[170:173], v[194:197], a[148:151], v[170:173]
    ds_read_b128 v[234:237], v2 offset:2048
    buffer_load_dwordx4 v11, s[8:11], 0 offen nt lds
    v_mfma_f32_16x16x32_bf16 v[170:173], v[214:217], a[152:155], v[170:173]
    s_add_u32 m0, s28, 8192
    ds_read_b128 v[238:241], v2 offset:3072
    v_cvt_pk_f16_f32 v174, v222, v223
    v_mfma_f32_16x16x32_bf16 v[170:173], v[206:209], a[156:159], v[170:173]
    s_mul_i32 s78, s77, 2688
    ds_read_b128 v[242:245], v2 offset:4096
    v_pk_fma_f16 v190, v174, v174, v190
    v_mfma_f32_16x16x32_bf16 v[170:173], v[198:201], a[160:163], v[170:173]
    ds_read_b128 v[246:249], v2 offset:5120
    v_cvt_pk_f16_f32 v175, v224, v225
    v_mfma_f32_16x16x32_bf16 v[170:173], v[186:189], a[164:167], v[170:173]
    v_pk_fma_f16 v190, v175, v175, v190
    v_pk_fma_f16 v192, v174, v162, v192
    v_mfma_f32_16x16x32_bf16 v[222:225], v[202:205], a[168:171], 0
    buffer_load_dwordx4 v12, s[8:11], 0 offen nt lds
    v_pk_fma_f16 v192, v175, v163, v192
    v_mfma_f32_16x16x32_bf16 v[222:225], v[194:197], a[172:175], v[222:225]
    s_waitcnt lgkmcnt(5)
    v_mul_f32 v128, v255, v128
    v_cvt_pk_bf16_f32 v162, v170, v171
    v_mfma_f32_16x16x32_f16 v[250:253], v[40:43], v[190:193], 0
    s_add_u32 m0, s28, 12288
    v_cvt_pk_bf16_f32 v163, v172, v173
    v_mul_f32 v129, v255, v129
    v_mfma_f32_16x16x32_bf16 v[222:225], v[214:217], a[176:179], v[222:225]
    s_xor_b32 s28, s28, 65536
    v_cvt_pk_bf16_f32 v133, v128, v129
    v_mul_f32 v114, v255, v114
    v_mfma_f32_16x16x32_bf16 v[222:225], v[206:209], a[180:183], v[222:225]
    s_waitcnt lgkmcnt(2)
    v_rsq_f32 v250, v250
    v_mfma_f32_16x16x32_bf16 v[222:225], v[198:201], a[184:187], v[222:225]
    s_waitcnt lgkmcnt(1)
    buffer_load_dwordx4 v13, s[8:11], 0 offen nt lds
    v_mul_f32 v230, s31, v250
    v_mfma_f32_16x16x32_bf16 v[222:225], v[186:189], a[188:191], v[222:225]
    s_mov_b32 m0, s29
    v_rsq_f32 v251, v251
    v_mfma_f32_16x16x32_bf16 v[126:129], v[202:205], a[192:195], 0
    s_xor_b32 s29, s29, s30
    v_cvt_pk_f16_f32 v231, v230, v251
    v_fma_f32 v252, v252, v230, v26
    v_mfma_f32_16x16x32_bf16 v[126:129], v[194:197], a[196:199], v[126:129]
    s_add_u32 s19, s19, s20
    v_fmac_f32_dpp v254, v253, v251 quad_perm:[0,1,2,3] row_mask:0x4 bank_mask:0xf
    v_cvt_pk_bf16_f32 v210, v222, v223
    v_mfma_f32_16x16x32_bf16 v[126:129], v[214:217], a[200:203], v[126:129]
    s_add_u32 s23, s23, s21
    v_cvt_pk_bf16_f32 v211, v224, v225
    v_pk_mul_f16 v158, v158, v231 op_sel:[0,1] op_sel_hi:[1,1]
    v_mfma_f32_16x16x32_bf16 v[126:129], v[206:209], a[204:207], v[126:129]
    s_waitcnt lgkmcnt(0)
    v_pk_mul_f16 v159, v159, v231 op_sel:[0,1] op_sel_hi:[1,1]
    v_mfma_f32_16x16x32_bf16 v[126:129], v[198:201], a[208:211], v[126:129]
    s_cmp_ge_u32 s19, 72
    v_pk_mul_f16 v160, v160, v231 op_sel:[0,1] op_sel_hi:[1,1]
    v_pk_mul_f16 v161, v161, v231 op_sel:[0,1] op_sel_hi:[1,1]
    v_mfma_f32_16x16x32_bf16 v[126:129], v[186:189], a[212:215], v[126:129]
    s_cselect_b32 s34, 72, 0
    v_pk_mul_f16 v176, v176, v231 op_sel:[0,1] op_sel_hi:[1,1]
    v_pk_mul_f16 v177, v177, v231 op_sel:[0,1] op_sel_hi:[1,1]
    v_mfma_f32_16x16x32_f16 v[170:173], v[146:149], v[150:153], v[46:49]
    s_cselect_b32 s35, s22, 0
    v_pk_mul_f16 v154, v154, v231 op_sel:[0,0] op_sel_hi:[1,0]
    v_pk_mul_f16 v155, v155, v231 op_sel:[0,0] op_sel_hi:[1,0]
    v_mfma_f32_16x16x32_f16 v[186:189], v[166:169], v[150:153], v[50:53]
    s_sub_u32 s19, s19, s34
    v_cvt_pk_bf16_f32 v218, v126, v127
    v_cvt_pk_bf16_f32 v219, v128, v129
    v_mfma_f32_16x16x32_f16 v[126:129], v[158:161], v[150:153], v[54:57]
    buffer_store_dwordx4 v[130:133], v16, s[12:15], 0 offen nt
    v_pk_mul_f16 v156, v156, v231 op_sel:[0,0] op_sel_hi:[1,0]
    v_pk_mul_f16 v157, v157, v231 op_sel:[0,0] op_sel_hi:[1,0]
    v_pk_mul_f16 v174, v174, v231 op_sel:[0,0] op_sel_hi:[1,0]
    v_pk_mul_f16 v175, v175, v231 op_sel:[0,0] op_sel_hi:[1,0]
    v_mfma_f32_16x16x16_f16 v[170:173], v[120:121], v[118:119], v[170:173]
    v_max3_u32 v44, v44, v250, v251
    v_exp_f32 v254, v254
    v_mfma_f32_16x16x16_f16 v[186:189], v[124:125], v[118:119], v[186:189]
    v_cvt_pk_bf16_f32 v254, v254, v254
    v_exp_f32 v252, v252
    v_mfma_f32_16x16x16_f16 v[126:129], v[176:177], v[118:119], v[126:129]
    v_mul_f32 v115, v255, v115
    v_cvt_pk_bf16_f32 v118, v114, v115
    v_exp_f32 v170, v170
    v_mfma_f32_16x16x32_f16 v[130:133], v[146:149], v[178:181], v[58:61]
    s_add_u32 s23, s23, s35
    ds_write_b16 v8, v254
    v_mfma_f32_16x16x32_f16 v[150:153], v[166:169], v[178:181], v[62:65]
    s_add_u32 s78, s78, s69
    v_exp_f32 v171, v171
    v_mfma_f32_16x16x32_f16 v[190:193], v[158:161], v[178:181], v[66:69]
    s_add_u32 s80, s77, s68
    v_cvt_pk_bf16_f32 v170, v170, v171
    v_exp_f32 v172, v172
    v_mfma_f32_16x16x16_f16 v[130:133], v[120:121], v[122:123], v[130:133]
    v_exp_f32 v173, v173
    v_mul_f32 v116, v255, v116
    v_mfma_f32_16x16x16_f16 v[150:153], v[124:125], v[122:123], v[150:153]
    v_cvt_pk_bf16_f32 v171, v172, v173
    v_exp_f32 v186, v186
    v_mfma_f32_16x16x16_f16 v[190:193], v[176:177], v[122:123], v[190:193]
    v_exp_f32 v187, v187
    v_exp_f32 v188, v188
    v_mfma_f32_16x16x32_bf16 v[178:181], a[216:219], v[182:185], 0
    s_cmp_ge_u32 s80, 72
    v_exp_f32 v130, v130
    v_mfma_f32_16x16x32_bf16 v[178:181], a[220:223], v[226:229], v[178:181]
    s_cselect_b32 s80, s22, 0
    v_exp_f32 v131, v131
    v_mfma_f32_16x16x32_bf16 v[178:181], a[224:227], v[234:237], v[178:181]
    s_add_u32 s78, s78, s80
    v_cvt_pk_bf16_f32 v194, v130, v131
    v_cvt_pk_bf16_f32 v172, v186, v187
    v_mfma_f32_16x16x32_bf16 v[178:181], a[228:231], v[238:241], v[178:181]
    s_add_u32 s80, s77, 20
    v_exp_f32 v132, v132
    v_mfma_f32_16x16x32_bf16 v[178:181], a[232:235], v[242:245], v[178:181]
    s_add_u32 s34, s18, 3
    v_exp_f32 v133, v133
    v_mfma_f32_16x16x32_bf16 v[178:181], a[236:239], v[246:249], v[178:181]
    s_cmp_lt_u32 s77, s62
    v_cvt_pk_bf16_f32 v195, v132, v133
    v_mul_f32 v117, v255, v117
    v_mfma_f32_16x16x32_bf16 v[198:201], a[240:243], v[182:185], 0
    s_cselect_b32 s79, 1, 0
    v_exp_f32 v150, v150
    v_mfma_f32_16x16x32_f16 v[202:205], v[146:149], v[154:157], v[70:73]
    s_cselect_b32 s78, s78, 0
    v_exp_f32 v151, v151
    v_mfma_f32_16x16x32_f16 v[146:149], v[166:169], v[154:157], v[74:77]
    s_cmp_lt_u32 s34, s17
    v_cvt_pk_bf16_f32 v196, v150, v151
    v_cvt_pk_bf16_f32 v119, v116, v117
    v_mfma_f32_16x16x32_f16 v[166:169], v[158:161], v[154:157], v[78:81]
    buffer_store_dwordx2 v[118:119], v19, s[12:15], 0 offen nt
    v_exp_f32 v152, v152
    v_mfma_f32_16x16x16_f16 v[202:205], v[120:121], v[174:175], v[202:205]
    v_exp_f32 v153, v153
    v_fma_f32 v254, v178, v178, s33
    v_mfma_f32_16x16x16_f16 v[146:149], v[124:125], v[174:175], v[146:149]
    v_cvt_pk_bf16_f32 v197, v152, v153
    v_exp_f32 v190, v190
    v_mfma_f32_16x16x16_f16 v[166:169], v[176:177], v[174:175], v[166:169]
    v_exp_f32 v191, v191
    v_exp_f32 v192, v192
    v_mfma_f32_16x16x32_bf16 v[198:201], a[244:247], v[226:229], v[198:201]
    s_cselect_b32 s23, s23, s78
    v_exp_f32 v193, v193
    v_mfma_f32_16x16x32_bf16 v[198:201], a[248:251], v[234:237], v[198:201]
    s_cselect_b32 s73, s34, s80
    ds_read_b128 v[118:121], v2 offset:6144
    v_fmac_f32 v254, v179, v179
    v_mfma_f32_16x16x32_bf16 v[198:201], a[252:255], v[238:241], v[198:201]
    s_cselect_b32 s79, 0, s79
    ds_read_b128 v[122:125], v2 offset:7168
    v_fmac_f32 v254, v180, v180
    v_mfma_f32_16x16x32_bf16 v[198:201], v[82:85], v[242:245], v[198:201]
    s_cselect_b32 s81, 0, 1
    ds_read_b128 v[150:153], v2 offset:8192
    v_fmac_f32 v254, v181, v181
    v_mfma_f32_16x16x32_bf16 v[198:201], v[86:89], v[246:249], v[198:201]
    s_add_u32 s80, s77, 1
    ds_read_b128 v[154:157], v2 offset:9216
    v_xor_b32 v0, 65536, v0
    v_mfma_f32_16x16x32_bf16 v[206:209], v[90:93], v[182:185], 0
    s_mul_i32 s80, s80, s81
    ds_read_b128 v[158:161], v2 offset:10240
    v_xor_b32 v1, 65536, v1
    v_mfma_f32_16x16x32_bf16 v[206:209], v[94:97], v[226:229], v[206:209]
    s_cmp_lt_u32 s80, s62
    ds_read_b128 v[174:177], v2 offset:11264
    v_fmac_f32 v254, v198, v198
    v_mfma_f32_16x16x32_bf16 v[206:209], v[98:101], v[234:237], v[206:209]
    s_cselect_b32 s62, s62, 0
    v_exp_f32 v189, v189
    v_mfma_f32_16x16x32_bf16 v[206:209], v[102:105], v[238:241], v[206:209]
    s_add_u32 s80, s18, 4
    v_cvt_pk_bf16_f32 v173, v188, v189
    v_fmac_f32 v254, v199, v199
    v_mfma_f32_16x16x32_bf16 v[206:209], v[106:109], v[242:245], v[206:209]
    s_waitcnt lgkmcnt(5)
    v_exp_f32 v126, v126
    v_mfma_f32_16x16x32_bf16 v[206:209], v[110:113], v[246:249], v[206:209]
    s_cmp_ge_u32 s80, s17
    v_exp_f32 v127, v127
    v_mfma_f32_16x16x32_bf16 v[130:133], a[216:219], v[118:121], 0
    s_waitcnt lgkmcnt(3)
    v_cvt_pk_bf16_f32 v36, v126, v127
    v_fmac_f32 v254, v200, v200
    v_mfma_f32_16x16x32_bf16 v[130:133], a[220:223], v[122:125], v[130:133]
    s_cselect_b32 s66, s62, 0
    v_exp_f32 v128, v128
    v_mfma_f32_16x16x32_bf16 v[130:133], a[224:227], v[150:153], v[130:133]
    s_waitcnt lgkmcnt(1)
    v_fmac_f32 v254, v201, v201
    v_mfma_f32_16x16x32_bf16 v[130:133], a[228:231], v[154:157], v[130:133]
    s_lshl_b32 s80, s79, s73
    v_exp_f32 v129, v129
    v_mfma_f32_16x16x32_bf16 v[130:133], a[232:235], v[158:161], v[130:133]
    s_waitcnt lgkmcnt(0)
    v_cvt_pk_bf16_f32 v37, v128, v129
    v_fmac_f32 v254, v206, v206
    v_mfma_f32_16x16x32_bf16 v[130:133], a[236:239], v[174:177], v[130:133]
    s_or_b32 s70, s70, s80
    v_exp_f32 v202, v202
    v_mfma_f32_16x16x32_bf16 v[182:185], v[28:31], v[36:39], 0
    s_add_u32 s45, s45, s79
    v_exp_f32 v203, v203
    v_mfma_f32_16x16x32_bf16 v[182:185], v[28:31], v[170:173], v[182:185]
    s_add_u32 s18, s18, 1
    v_cvt_pk_bf16_f32 v186, v202, v203
    v_fma_f32 v255, v130, v130, s33
    v_mfma_f32_16x16x32_bf16 v[214:217], v[162:165], v[36:39], 0
    s_cmp_lt_u32 s18, s45
    v_fmac_f32 v255, v131, v131
    v_fmac_f32 v255, v132, v132
    v_mfma_f32_16x16x32_bf16 v[214:217], v[134:137], v[170:173], v[214:217]
    v_fmac_f32 v255, v133, v133
    v_fmac_f32 v254, v207, v207
    v_mfma_f32_16x16x32_bf16 v[222:225], v[210:213], v[36:39], 0
    v_exp_f32 v204, v204
    v_mfma_f32_16x16x32_bf16 v[222:225], v[138:141], v[170:173], v[222:225]
    v_exp_f32 v205, v205
    v_mfma_f32_16x16x32_bf16 v[226:229], v[218:221], v[36:39], 0
    v_cvt_pk_bf16_f32 v36, v190, v191
    v_cvt_pk_bf16_f32 v37, v192, v193
    v_mfma_f32_16x16x32_bf16 v[226:229], v[142:145], v[170:173], v[226:229]
    v_cvt_pk_bf16_f32 v39, v232, 0
    v_cvt_pk_bf16_f32 v187, v204, v205
    v_mfma_f32_16x16x32_bf16 v[126:129], a[240:243], v[118:121], 0
    v_exp_f32 v146, v146
    v_mfma_f32_16x16x32_bf16 v[170:173], v[28:31], v[36:39], 0
    v_exp_f32 v147, v147
    v_mfma_f32_16x16x32_bf16 v[170:173], v[28:31], v[194:197], v[170:173]
    v_cvt_pk_bf16_f32 v188, v146, v147
    v_fmac_f32 v254, v208, v208
    v_mfma_f32_16x16x32_bf16 v[114:117], v[162:165], v[36:39], 0
    v_exp_f32 v148, v148
    v_mfma_f32_16x16x32_bf16 v[114:117], v[134:137], v[194:197], v[114:117]
    v_exp_f32 v149, v149
    v_mfma_f32_16x16x32_bf16 v[190:193], v[210:213], v[36:39], 0
    v_cvt_pk_bf16_f32 v189, v148, v149
    v_fmac_f32 v254, v209, v209
    v_mfma_f32_16x16x32_bf16 v[190:193], v[138:141], v[194:197], v[190:193]
    v_rcp_f32 v170, v170
    v_mfma_f32_16x16x32_bf16 v[146:149], v[218:221], v[36:39], 0
    v_exp_f32 v166, v166
    v_mfma_f32_16x16x32_bf16 v[146:149], v[142:145], v[194:197], v[146:149]
    v_mul_f32 v114, v170, v114
    v_mul_f32 v115, v170, v115
    v_mfma_f32_16x16x32_bf16 v[126:129], a[244:247], v[122:125], v[126:129]
    v_cvt_pk_bf16_f32 v194, v114, v115
    v_mul_f32 v116, v170, v116
    v_mfma_f32_16x16x32_bf16 v[126:129], a[248:251], v[150:153], v[126:129]
    ds_read_b128 v[202:205], v2 offset:12288
    v_mul_f32 v117, v170, v117
    v_mfma_f32_16x16x32_bf16 v[126:129], a[252:255], v[154:157], v[126:129]
    ds_read_b128 v[230:233], v2 offset:13312
    v_cvt_pk_bf16_f32 v195, v116, v117
    v_mfma_f32_16x16x32_bf16 v[126:129], v[82:85], v[158:161], v[126:129]
    ds_read_b128 v[234:237], v2 offset:14336
    v_mul_f32 v190, v170, v190
    v_mfma_f32_16x16x32_bf16 v[126:129], v[86:89], v[174:177], v[126:129]
    ds_read_b128 v[238:241], v2 offset:15360
    v_mul_f32 v191, v170, v191
    v_mfma_f32_16x16x32_bf16 v[114:117], v[90:93], v[118:121], 0
    ds_read_b128 v[118:121], v2 offset:16384
    v_cvt_pk_bf16_f32 v196, v190, v191
    v_mfma_f32_16x16x32_bf16 v[114:117], v[94:97], v[122:125], v[114:117]
    ds_read_b128 v[122:125], v2 offset:17408
    v_mul_f32 v192, v170, v192
    v_mfma_f32_16x16x32_bf16 v[114:117], v[98:101], v[150:153], v[114:117]
    v_fmac_f32 v255, v126, v126
    v_fmac_f32 v255, v127, v127
    v_mfma_f32_16x16x32_bf16 v[114:117], v[102:105], v[154:157], v[114:117]
    v_fmac_f32 v255, v128, v128
    v_fmac_f32 v255, v129, v129
    v_mfma_f32_16x16x32_bf16 v[114:117], v[106:109], v[158:161], v[114:117]
    s_waitcnt lgkmcnt(5)
    v_mul_f32 v193, v170, v193
    v_cvt_pk_bf16_f32 v197, v192, v193
    v_mfma_f32_16x16x32_bf16 v[114:117], v[110:113], v[174:177], v[114:117]
    s_waitcnt lgkmcnt(4)
    ds_write_b128 v3, v[194:197] offset:6144
    v_mfma_f32_16x16x32_bf16 v[242:245], a[216:219], v[202:205], 0
    s_waitcnt lgkmcnt(3)
    v_mul_f32 v146, v170, v146
    v_mul_f32 v147, v170, v147
    v_mfma_f32_16x16x32_bf16 v[242:245], a[220:223], v[230:233], v[242:245]
    s_waitcnt lgkmcnt(2)
    v_fmac_f32 v255, v114, v114
    v_fmac_f32 v255, v115, v115
    v_mfma_f32_16x16x32_bf16 v[242:245], a[224:227], v[234:237], v[242:245]
    s_waitcnt lgkmcnt(1)
    v_fmac_f32 v255, v116, v116
    v_fmac_f32 v255, v117, v117
    v_mfma_f32_16x16x32_bf16 v[242:245], a[228:231], v[238:241], v[242:245]
    v_cvt_pk_bf16_f32 v254, v254, v255
    v_cvt_pk_bf16_f32 v172, v146, v147
    v_mfma_f32_16x16x32_bf16 v[242:245], a[232:235], v[118:121], v[242:245]
    v_mul_f32 v148, v170, v148
    v_mul_f32 v149, v170, v149
    v_mfma_f32_16x16x32_bf16 v[242:245], a[236:239], v[122:125], v[242:245]
    v_cvt_pk_bf16_f32 v173, v148, v149
    v_cvt_pk_bf16_f32 v39, v252, 0
    v_mfma_f32_16x16x32_bf16 v[158:161], a[240:243], v[202:205], 0
    ds_write_b64 v4, v[172:173] offset:10240
    v_mfma_f32_16x16x32_bf16 v[158:161], a[244:247], v[230:233], v[158:161]
    v_exp_f32 v167, v167
    v_mfma_f32_16x16x32_bf16 v[158:161], a[248:251], v[234:237], v[158:161]
    v_cvt_pk_bf16_f32 v36, v166, v167
    v_fma_f32 v255, v242, v242, s33
    v_mfma_f32_16x16x32_bf16 v[158:161], a[252:255], v[238:241], v[158:161]
    v_fmac_f32 v255, v243, v243
    v_fmac_f32 v255, v244, v244
    v_mfma_f32_16x16x32_bf16 v[158:161], v[82:85], v[118:121], v[158:161]
    v_fmac_f32 v255, v245, v245
    v_xor_b32 v2, 65536, v2
    v_mfma_f32_16x16x32_bf16 v[158:161], v[86:89], v[122:125], v[158:161]
    v_exp_f32 v168, v168
    v_mfma_f32_16x16x32_bf16 v[154:157], v[90:93], v[202:205], 0
    v_exp_f32 v169, v169
    v_mfma_f32_16x16x32_bf16 v[154:157], v[94:97], v[230:233], v[154:157]
    ds_read_b128 v[146:149], v9
    v_cvt_pk_bf16_f32 v37, v168, v169
    v_mfma_f32_16x16x32_bf16 v[154:157], v[98:101], v[234:237], v[154:157]
    ds_read_b128 v[150:153], v9 offset:64
    v_fmac_f32 v255, v158, v158
    v_mfma_f32_16x16x32_bf16 v[166:169], v[28:31], v[36:39], 0
    v_fmac_f32 v255, v159, v159
    v_fmac_f32 v255, v160, v160
    v_mfma_f32_16x16x32_bf16 v[166:169], v[28:31], v[186:189], v[166:169]
    v_fmac_f32 v255, v161, v161
    v_add_u32 v6, s75, v6
    v_mfma_f32_16x16x32_bf16 v[174:177], v[162:165], v[36:39], 0
    v_rcp_f32 v182, v182
    v_mfma_f32_16x16x32_bf16 v[174:177], v[134:137], v[186:189], v[174:177]
    v_max3_u32 v25, v25, v182, v183
    v_max3_u32 v25, v25, v170, v171
    v_mfma_f32_16x16x32_bf16 v[170:173], v[210:213], v[36:39], 0
    v_rcp_f32 v166, v166
    v_mfma_f32_16x16x32_bf16 v[170:173], v[138:141], v[186:189], v[170:173]
    v_max3_u32 v25, v25, v166, v167
    v_mul_f32 v214, v182, v214
    v_mfma_f32_16x16x32_bf16 v[190:193], v[218:221], v[36:39], 0
    s_waitcnt lgkmcnt(1)
    v_mul_f32 v174, v166, v174
    v_mul_f32 v175, v166, v175
    v_mfma_f32_16x16x32_bf16 v[190:193], v[142:145], v[186:189], v[190:193]
    s_waitcnt lgkmcnt(0)
    v_cvt_pk_bf16_f32 v174, v174, v175
    v_mul_f32 v176, v166, v176
    v_mfma_f32_16x16x32_bf16 v[154:157], v[102:105], v[238:241], v[154:157]
    ds_read_b128 v[186:189], v0 offset:20480
    v_mul_f32 v177, v166, v177
    v_mfma_f32_16x16x32_bf16 v[154:157], v[106:109], v[118:121], v[154:157]
    ds_read_b128 v[194:197], v1 offset:20480
    v_cvt_pk_bf16_f32 v175, v176, v177
    v_mfma_f32_16x16x32_bf16 v[154:157], v[110:113], v[122:125], v[154:157]
    ds_read_b128 v[122:125], v0 offset:20608
    v_mul_f32 v170, v166, v170
    v_mfma_f32_16x16x32_bf16 v[118:121], v[146:149], v[28:31], 0
    ds_read_b128 v[202:205], v1 offset:20608
    v_mul_f32 v171, v166, v171
    v_mfma_f32_16x16x32_bf16 v[118:121], v[150:153], v[28:31], v[118:121]
    ds_read_b128 v[230:233], v0 offset:20736
    v_cvt_pk_bf16_f32 v176, v170, v171
    v_mfma_f32_16x16x32_bf16 v[234:237], v[146:149], v[134:137], 0
    ds_read_b128 v[238:241], v1 offset:20736
    v_fmac_f32 v255, v154, v154
    v_mfma_f32_16x16x32_bf16 v[234:237], v[150:153], v[162:165], v[234:237]
    v_fmac_f32 v255, v155, v155
    v_fmac_f32 v255, v156, v156
    v_mfma_f32_16x16x32_bf16 v[134:137], v[146:149], v[138:141], 0
    v_fmac_f32 v255, v157, v157
    v_cvt_pk_bf16_f32 v255, v255, v255
    v_mfma_f32_16x16x32_bf16 v[134:137], v[150:153], v[210:213], v[134:137]
    s_waitcnt lgkmcnt(5)
    ds_write_b64 v4, v[254:255] offset:18432
    v_mfma_f32_16x16x32_bf16 v[138:141], v[146:149], v[142:145], 0
    s_waitcnt lgkmcnt(4)
    v_mul_f32 v172, v166, v172
    v_mul_f32 v173, v166, v173
    v_mfma_f32_16x16x32_bf16 v[138:141], v[150:153], v[218:221], v[138:141]
    s_waitcnt lgkmcnt(3)
    v_cvt_pk_bf16_f32 v177, v172, v173
    v_mul_f32 v190, v166, v190
    v_mfma_f32_16x16x32_bf16 v[142:145], a[72:75], v[186:189], 0
    s_waitcnt lgkmcnt(2)
    ds_write_b128 v3, v[174:177] offset:12288
    v_mfma_f32_16x16x32_bf16 v[142:145], a[76:79], v[194:197], v[142:145]
    s_waitcnt lgkmcnt(2)
    v_mul_f32 v191, v166, v191
    v_cvt_pk_bf16_f32 v120, v190, v191
    v_mfma_f32_16x16x32_bf16 v[142:145], a[80:83], v[122:125], v[142:145]
    v_mul_f32 v192, v166, v192
    v_mul_f32 v193, v166, v193
    v_mfma_f32_16x16x32_bf16 v[142:145], a[84:87], v[202:205], v[142:145]
    v_cvt_pk_bf16_f32 v121, v192, v193
    v_mul_f32 v215, v182, v215
    v_mfma_f32_16x16x32_bf16 v[142:145], a[88:91], v[230:233], v[142:145]
    ds_write_b64 v4, v[120:121] offset:16384
    v_mfma_f32_16x16x32_bf16 v[142:145], a[92:95], v[238:241], v[142:145]
    v_rcp_f32 v118, v118
    v_mfma_f32_16x16x32_bf16 v[150:153], a[96:99], v[186:189], 0
    v_max3_u32 v25, v25, v118, v119
    v_mul_f32 v234, v234, v118
    v_mfma_f32_16x16x32_bf16 v[150:153], a[100:103], v[194:197], v[150:153]
    v_cvt_pk_bf16_f32 v146, v214, v215
    v_mul_f32_dpp v234, v134, v118 quad_perm:[0,1,2,3] row_mask:0x2 bank_mask:0xf
    v_mfma_f32_16x16x32_bf16 v[150:153], a[104:107], v[122:125], v[150:153]
    v_mul_f32 v216, v182, v216
    v_mul_f32_dpp v234, v138, v118 quad_perm:[0,1,2,3] row_mask:0x4 bank_mask:0xf
    v_mfma_f32_16x16x32_bf16 v[150:153], a[108:111], v[202:205], v[150:153]
    v_cvt_pk_bf16_f32 v234, v234, v234
    v_mul_f32 v217, v182, v217
    v_mfma_f32_16x16x32_bf16 v[150:153], a[112:115], v[230:233], v[150:153]
    ds_write_b16 v7, v234
    v_mfma_f32_16x16x32_bf16 v[150:153], a[116:119], v[238:241], v[150:153]
    v_cvt_pk_bf16_f32 v147, v216, v217
    v_mul_f32 v222, v182, v222
    v_mfma_f32_16x16x32_bf16 v[134:137], a[120:123], v[186:189], 0
    v_mul_f32 v223, v182, v223
    v_cvt_pk_bf16_f32 v148, v222, v223
    v_mfma_f32_16x16x32_bf16 v[134:137], a[124:127], v[194:197], v[134:137]
    v_mul_f32 v224, v182, v224
    v_mul_f32 v225, v182, v225
    v_mfma_f32_16x16x32_bf16 v[134:137], a[128:131], v[122:125], v[134:137]
    v_cvt_pk_bf16_f32 v149, v224, v225
    v_mul_f32 v226, v182, v226
    v_mfma_f32_16x16x32_bf16 v[134:137], a[132:135], v[202:205], v[134:137]
    ds_write_b128 v3, v[146:149] offset:0
    v_mfma_f32_16x16x32_bf16 v[134:137], a[136:139], v[230:233], v[134:137]
    v_mul_f32 v227, v182, v227
    v_cvt_pk_bf16_f32 v254, v226, v227
    v_mfma_f32_16x16x32_bf16 v[134:137], a[140:143], v[238:241], v[134:137]
    v_mul_f32 v228, v182, v228
    v_mul_f32 v229, v182, v229
    v_mfma_f32_16x16x32_bf16 v[138:141], a[0:3], v[186:189], 0
    v_cvt_pk_bf16_f32 v255, v228, v229
    v_xor_b32 v3, 65536, v3
    v_mfma_f32_16x16x32_bf16 v[138:141], a[4:7], v[194:197], v[138:141]
    ds_write_b64 v4, v[254:255] offset:4096
    v_mfma_f32_16x16x32_bf16 v[138:141], a[8:11], v[122:125], v[138:141]
    v_xor_b32 v4, 65536, v4
    v_add_u32 v7, s76, v7
    v_mfma_f32_16x16x32_bf16 v[138:141], a[12:15], v[202:205], v[138:141]
    v_cvt_pk_f16_f32 v146, v142, v143
    v_pk_mul_f16 v143, v146, v146
    v_mfma_f32_16x16x32_bf16 v[138:141], a[16:19], v[230:233], v[138:141]
    v_cvt_pk_f16_f32 v147, v144, v145
    v_pk_fma_f16 v143, v147, v147, v143
    v_mfma_f32_16x16x32_bf16 v[138:141], a[20:23], v[238:241], v[138:141]
    v_cvt_pk_f16_f32 v148, v150, v151
    v_pk_fma_f16 v143, v148, v148, v143
    v_mfma_f32_16x16x32_bf16 v[166:169], a[24:27], v[186:189], 0
    v_cvt_pk_f16_f32 v149, v152, v153
    v_pk_fma_f16 v143, v149, v149, v143
    v_mfma_f32_16x16x32_bf16 v[166:169], a[28:31], v[194:197], v[166:169]
    v_cvt_pk_f16_f32 v120, v134, v135
    v_pk_fma_f16 v143, v120, v120, v143
    v_mfma_f32_16x16x32_bf16 v[166:169], a[32:35], v[122:125], v[166:169]
    s_waitcnt lgkmcnt(0)
    v_cvt_pk_f16_f32 v121, v136, v137
    v_pk_fma_f16 v143, v121, v121, v143
    v_mfma_f32_16x16x32_bf16 v[166:169], a[36:39], v[202:205], v[166:169]
    s_nop 0
    v_mfma_f32_16x16x32_bf16 v[166:169], a[40:43], v[230:233], v[166:169]
    s_nop 0
    v_mfma_f32_16x16x32_bf16 v[166:169], a[44:47], v[238:241], v[166:169]
    s_nop 0
    v_mfma_f32_16x16x32_bf16 v[134:137], a[48:51], v[186:189], 0
    s_barrier
    v_mfma_f32_16x16x32_bf16 v[134:137], a[52:55], v[194:197], v[134:137]
    s_cbranch_scc1 L_loop_fast3
L_final_fast:
    v_mfma_f32_16x16x32_bf16 v[134:137], a[56:59], v[122:125], v[134:137]
    s_mov_b32 s12, s40
    ds_read_b128 v[150:153], v2 offset:18432
    ds_read_b128 v[162:165], v2 offset:19456
    v_mfma_f32_16x16x32_bf16 v[134:137], a[60:63], v[202:205], v[134:137]
    s_mov_b32 s13, s41
    ds_read_b128 v[170:173], v5 offset:32
    ds_read2_b64 v[174:177], v5 offset0:6 offset1:9
    v_mfma_f32_16x16x32_bf16 v[134:137], a[64:67], v[230:233], v[134:137]
    s_mov_b32 s14, s36
    v_cvt_pk_f16_f32 v138, v138, v139
    v_pk_mul_f16 v142, v138, v138
    v_mfma_f32_16x16x32_bf16 v[134:137], a[68:71], v[238:241], v[134:137]
    s_add_u32 s48, s40, s27
    ds_read_b128 v[182:185], v5
    ds_read_b32 v254, v6 offset:192
    v_mfma_f32_16x16x32_bf16 v[190:193], v[186:189], a[144:147], 0
    s_addc_u32 s49, s41, 0
    v_cvt_pk_f16_f32 v139, v140, v141
    v_pk_fma_f16 v142, v139, v139, v142
    v_mfma_f32_16x16x32_bf16 v[190:193], v[194:197], a[148:151], v[190:193]
    s_sub_u32 s50, s36, s27
    v_cvt_pk_f16_f32 v140, v166, v167
    v_pk_fma_f16 v142, v140, v140, v142
    v_mfma_f32_16x16x32_bf16 v[190:193], v[122:125], a[152:155], v[190:193]
    s_mov_b32 s51, 0x00020000
    v_cvt_pk_f16_f32 v141, v168, v169
    v_pk_fma_f16 v142, v141, v141, v142
    v_mfma_f32_16x16x32_bf16 v[190:193], v[202:205], a[156:159], v[190:193]
    s_add_u32 s52, s40, s26
    v_cvt_pk_f16_f32 v118, v134, v135
    v_pk_fma_f16 v142, v118, v118, v142
    v_mfma_f32_16x16x32_bf16 v[190:193], v[230:233], a[160:163], v[190:193]
    s_waitcnt lgkmcnt(4)
    v_cvt_pk_f16_f32 v119, v136, v137
    v_pk_fma_f16 v142, v119, v119, v142
    v_mfma_f32_16x16x32_bf16 v[134:137], v[32:35], v[150:153], 0
    s_waitcnt lgkmcnt(2)
    v_pk_mul_f16 v145, v146, v170
    v_pk_fma_f16 v145, v147, v171, v145
    v_mfma_f32_16x16x32_bf16 v[134:137], v[32:35], v[162:165], v[134:137]
    s_addc_u32 s53, s41, 0
    v_pk_fma_f16 v145, v148, v172, v145
    v_pk_fma_f16 v145, v149, v173, v145
    v_mfma_f32_16x16x32_bf16 v[190:193], v[238:241], a[164:167], v[190:193]
    s_waitcnt lgkmcnt(0)
    v_mov_b32_dpp v254, v23 quad_perm:[0,1,2,3] row_mask:0x7 bank_mask:0xf
    v_pk_fma_f16 v145, v120, v176, v145
    v_mfma_f32_16x16x32_bf16 v[150:153], v[186:189], a[168:171], 0
    s_sub_u32 s54, s36, s26
    v_mul_f32 v144, 0x3baaaaab, v135
    v_mul_f32 v255, 0x3baaaaab, v134
    v_mfma_f32_16x16x32_bf16 v[150:153], v[194:197], a[172:175], v[150:153]
    s_mov_b32 s55, 0x00020000
    v_rsq_f32 v144, v144
    v_mfma_f32_16x16x32_bf16 v[150:153], v[122:125], a[176:179], v[150:153]
    s_add_u32 s56, s40, s25
    v_mul_f32 v130, v144, v130
    v_mul_f32 v131, v144, v131
    v_mfma_f32_16x16x32_bf16 v[150:153], v[202:205], a[180:183], v[150:153]
    s_addc_u32 s57, s41, 0
    v_cvt_pk_bf16_f32 v130, v130, v131
    v_mul_f32 v132, v144, v132
    v_mfma_f32_16x16x32_bf16 v[150:153], v[230:233], a[184:187], v[150:153]
    s_sub_u32 s58, s36, s25
    ds_read_b128 v[162:165], v0 offset:26624
    v_mul_f32 v133, v144, v133
    v_mfma_f32_16x16x32_bf16 v[150:153], v[238:241], a[188:191], v[150:153]
    s_mov_b32 s59, 0x00020000
    ds_read_b128 v[166:169], v1 offset:26624
    v_cvt_pk_bf16_f32 v131, v132, v133
    v_mfma_f32_16x16x32_bf16 v[210:213], v[186:189], a[192:195], 0
    s_and_b32 s6, s2, 7
    ds_read_b128 v[186:189], v0 offset:26752
    v_mul_f32 v126, v144, v126
    v_mfma_f32_16x16x32_bf16 v[210:213], v[194:197], a[196:199], v[210:213]
    s_sub_u32 s6, 0, s6
    ds_read_b128 v[194:197], v1 offset:26752
    v_mul_f32 v127, v144, v127
    v_mfma_f32_16x16x32_bf16 v[210:213], v[122:125], a[200:203], v[210:213]
    s_lshl_b32 s3, s16, 6
    ds_read_b128 v[122:125], v0 offset:26880
    v_cvt_pk_bf16_f32 v132, v126, v127
    v_mfma_f32_16x16x32_bf16 v[210:213], v[202:205], a[204:207], v[210:213]
    s_lshl_b32 s4, s16, 5
    ds_read_b128 v[202:205], v1 offset:26880
    v_mul_f32 v128, v144, v128
    v_mfma_f32_16x16x32_bf16 v[210:213], v[230:233], a[208:211], v[210:213]
    s_add_u32 s4, s4, 256
    v_mul_f32 v129, v144, v129
    v_cvt_pk_bf16_f32 v133, v128, v129
    v_mfma_f32_16x16x32_bf16 v[210:213], v[238:241], a[212:215], v[210:213]
    s_mul_i32 s5, s16, 9408
    s_waitcnt lgkmcnt(5)
    ds_read_b128 v[126:129], v2 offset:0
    v_mfma_f32_16x16x32_bf16 v[214:217], a[72:75], v[162:165], 0
    s_add_u32 s5, s5, 104448
    ds_read_b128 v[218:221], v2 offset:1024
    ds_read_b128 v[222:225], v2 offset:2048
    v_mfma_f32_16x16x32_bf16 v[226:229], a[96:99], v[162:165], 0
    s_waitcnt lgkmcnt(7)
    ds_read_b128 v[230:233], v2 offset:3072
    buffer_store_dwordx4 v[130:133], v16, s[48:51], 0 offen nt
    ds_read_b128 v[234:237], v2 offset:4096
    v_mul_f32 v114, v144, v114
    v_mul_f32 v115, v144, v115
    v_cvt_pk_bf16_f32 v134, v114, v115
    v_mfma_f32_16x16x32_bf16 v[214:217], a[76:79], v[166:169], v[214:217]
    s_waitcnt lgkmcnt(7)
    ds_read_b128 v[130:133], v2 offset:5120
    v_mul_f32 v116, v144, v116
    v_mfma_f32_16x16x32_bf16 v[214:217], a[80:83], v[186:189], v[214:217]
    s_waitcnt lgkmcnt(7)
    v_mul_f32 v117, v144, v117
    v_cvt_pk_bf16_f32 v135, v116, v117
    v_mfma_f32_16x16x32_bf16 v[214:217], a[84:87], v[194:197], v[214:217]
    s_waitcnt lgkmcnt(6)
    v_rsq_f32 v255, v255
    v_mfma_f32_16x16x32_bf16 v[214:217], a[88:91], v[122:125], v[214:217]
    v_mul_f32 v178, v255, v178
    v_mul_f32 v179, v255, v179
    v_mfma_f32_16x16x32_bf16 v[214:217], a[92:95], v[202:205], v[214:217]
    s_waitcnt lgkmcnt(5)
    v_cvt_pk_bf16_f32 v114, v178, v179
    v_mul_f32 v180, v255, v180
    v_mfma_f32_16x16x32_bf16 v[226:229], a[100:103], v[166:169], v[226:229]
    s_waitcnt lgkmcnt(3)
    v_mul_f32 v181, v255, v181
    v_cvt_pk_bf16_f32 v115, v180, v181
    v_mfma_f32_16x16x32_bf16 v[178:181], a[216:219], v[126:129], 0
    s_waitcnt lgkmcnt(1)
    v_mul_f32 v198, v255, v198
    v_mul_f32 v199, v255, v199
    v_mfma_f32_16x16x32_bf16 v[178:181], a[220:223], v[218:221], v[178:181]
    v_cvt_pk_bf16_f32 v116, v198, v199
    v_mul_f32 v200, v255, v200
    v_mfma_f32_16x16x32_bf16 v[178:181], a[224:227], v[222:225], v[178:181]
    s_waitcnt lgkmcnt(0)
    v_mul_f32 v201, v255, v201
    v_cvt_pk_bf16_f32 v117, v200, v201
    v_mfma_f32_16x16x32_bf16 v[178:181], a[228:231], v[230:233], v[178:181]
    v_mul_f32 v206, v255, v206
    v_mul_f32 v207, v255, v207
    v_mfma_f32_16x16x32_bf16 v[178:181], a[232:235], v[234:237], v[178:181]
    v_cvt_pk_bf16_f32 v206, v206, v207
    v_mul_f32 v208, v255, v208
    v_mfma_f32_16x16x32_bf16 v[178:181], a[236:239], v[130:133], v[178:181]
    v_mul_f32 v209, v255, v209
    v_cvt_pk_bf16_f32 v207, v208, v209
    v_mfma_f32_16x16x32_bf16 v[198:201], a[240:243], v[126:129], 0
    v_pk_fma_f16 v145, v121, v177, v145
    v_pk_mul_f16 v144, v138, v182
    v_mfma_f32_16x16x32_bf16 v[198:201], a[244:247], v[218:221], v[198:201]
    v_pk_fma_f16 v144, v139, v183, v144
    v_pk_fma_f16 v144, v140, v184, v144
    v_mfma_f32_16x16x32_bf16 v[198:201], a[248:251], v[222:225], v[198:201]
    v_fma_f32 v255, v178, v178, s33
    v_fmac_f32 v255, v179, v179
    v_mfma_f32_16x16x32_bf16 v[198:201], a[252:255], v[230:233], v[198:201]
    buffer_store_dwordx2 v[134:135], v19, s[48:51], 0 offen nt
    v_fmac_f32 v255, v180, v180
    v_fmac_f32 v255, v181, v181
    v_mfma_f32_16x16x32_bf16 v[198:201], v[82:85], v[234:237], v[198:201]
    v_pk_fma_f16 v144, v141, v185, v144
    v_pk_fma_f16 v144, v118, v174, v144
    v_mfma_f32_16x16x32_bf16 v[198:201], v[86:89], v[130:133], v[198:201]
    v_pk_fma_f16 v144, v119, v175, v144
    v_cvt_pk_bf16_f32 v134, v190, v191
    v_mfma_f32_16x16x32_bf16 v[226:229], a[104:107], v[186:189], v[226:229]
    v_cvt_pk_bf16_f32 v135, v192, v193
    v_cvt_pk_bf16_f32 v150, v150, v151
    v_mfma_f32_16x16x32_f16 v[190:193], v[40:43], v[142:145], 0
    v_cvt_pk_bf16_f32 v151, v152, v153
    v_cvt_pk_bf16_f32 v142, v210, v211
    v_mfma_f32_16x16x32_bf16 v[238:241], v[90:93], v[126:129], 0
    v_fmac_f32 v255, v198, v198
    v_fmac_f32 v255, v199, v199
    v_mfma_f32_16x16x32_bf16 v[238:241], v[94:97], v[218:221], v[238:241]
    v_fmac_f32 v255, v200, v200
    v_fmac_f32 v255, v201, v201
    v_mfma_f32_16x16x32_bf16 v[238:241], v[98:101], v[222:225], v[238:241]
    v_rsq_f32 v190, v190
    v_mfma_f32_16x16x32_bf16 v[238:241], v[102:105], v[230:233], v[238:241]
    v_rsq_f32 v191, v191
    v_mfma_f32_16x16x32_bf16 v[238:241], v[106:109], v[234:237], v[238:241]
    v_mul_f32 v152, s31, v190
    v_cvt_pk_f16_f32 v153, v152, v191
    v_mfma_f32_16x16x32_bf16 v[238:241], v[110:113], v[130:133], v[238:241]
    v_cvt_pk_bf16_f32 v143, v212, v213
    v_fma_f32 v192, v192, v152, v22
    v_mfma_f32_16x16x32_bf16 v[226:229], a[108:111], v[194:197], v[226:229]
    v_fmac_f32_dpp v254, v193, v191 quad_perm:[0,1,2,3] row_mask:0x1 bank_mask:0xf
    v_pk_mul_f16 v146, v146, v153 op_sel:[0,1] op_sel_hi:[1,1]
    v_mfma_f32_16x16x32_bf16 v[226:229], a[112:115], v[122:125], v[226:229]
    v_pk_mul_f16 v147, v147, v153 op_sel:[0,1] op_sel_hi:[1,1]
    v_pk_mul_f16 v148, v148, v153 op_sel:[0,1] op_sel_hi:[1,1]
    v_mfma_f32_16x16x32_bf16 v[226:229], a[116:119], v[202:205], v[226:229]
    ds_read_b128 v[126:129], v2 offset:6144
    ds_read_b128 v[130:133], v2 offset:7168
    v_mfma_f32_16x16x32_bf16 v[210:213], a[120:123], v[162:165], 0
    ds_read_b128 v[218:221], v2 offset:8192
    ds_read_b128 v[222:225], v2 offset:9216
    v_mfma_f32_16x16x32_bf16 v[210:213], a[124:127], v[166:169], v[210:213]
    v_fmac_f32 v255, v238, v238
    v_fmac_f32 v255, v239, v239
    v_mfma_f32_16x16x32_bf16 v[210:213], a[128:131], v[186:189], v[210:213]
    ds_read_b128 v[230:233], v2 offset:10240
    buffer_store_dwordx4 v[114:117], v15, s[48:51], 0 offen nt
    ds_read_b128 v[234:237], v2 offset:11264
    v_fmac_f32 v255, v240, v240
    v_fmac_f32 v255, v241, v241
    v_pk_mul_f16 v149, v149, v153 op_sel:[0,1] op_sel_hi:[1,1]
    v_mfma_f32_16x16x32_bf16 v[210:213], a[132:135], v[194:197], v[210:213]
    v_pk_mul_f16 v120, v120, v153 op_sel:[0,1] op_sel_hi:[1,1]
    v_pk_mul_f16 v121, v121, v153 op_sel:[0,1] op_sel_hi:[1,1]
    v_mfma_f32_16x16x32_bf16 v[210:213], a[136:139], v[122:125], v[210:213]
    v_pk_mul_f16 v138, v138, v153 op_sel:[0,0] op_sel_hi:[1,0]
    v_pk_mul_f16 v139, v139, v153 op_sel:[0,0] op_sel_hi:[1,0]
    v_mfma_f32_16x16x32_bf16 v[210:213], a[140:143], v[202:205], v[210:213]
    v_pk_mul_f16 v140, v140, v153 op_sel:[0,0] op_sel_hi:[1,0]
    v_pk_mul_f16 v141, v141, v153 op_sel:[0,0] op_sel_hi:[1,0]
    v_pk_mul_f16 v118, v118, v153 op_sel:[0,0] op_sel_hi:[1,0]
    v_pk_mul_f16 v119, v119, v153 op_sel:[0,0] op_sel_hi:[1,0]
    v_mfma_f32_16x16x32_bf16 v[114:117], a[0:3], v[162:165], 0
    s_waitcnt lgkmcnt(2)
    v_max3_u32 v44, v44, v190, v191
    v_cvt_pk_f16_f32 v214, v214, v215
    v_mfma_f32_16x16x32_bf16 v[114:117], a[4:7], v[166:169], v[114:117]
    v_pk_mul_f16 v247, v214, v214
    v_cvt_pk_f16_f32 v215, v216, v217
    v_mfma_f32_16x16x32_bf16 v[114:117], a[8:11], v[186:189], v[114:117]
    s_waitcnt lgkmcnt(1)
    v_pk_fma_f16 v247, v215, v215, v247
    v_cvt_pk_f16_f32 v216, v226, v227
    v_mfma_f32_16x16x32_bf16 v[250:253], a[216:219], v[126:129], 0
    s_waitcnt lgkmcnt(0)
    v_pk_fma_f16 v247, v216, v216, v247
    v_cvt_pk_f16_f32 v217, v228, v229
    v_mfma_f32_16x16x32_bf16 v[250:253], a[220:223], v[130:133], v[250:253]
    v_pk_fma_f16 v247, v217, v217, v247
    v_cvt_pk_f16_f32 v208, v210, v211
    v_mfma_f32_16x16x32_bf16 v[250:253], a[224:227], v[218:221], v[250:253]
    v_pk_fma_f16 v247, v208, v208, v247
    v_cvt_pk_f16_f32 v209, v212, v213
    v_mfma_f32_16x16x32_bf16 v[250:253], a[228:231], v[222:225], v[250:253]
    v_pk_fma_f16 v247, v209, v209, v247
    v_pk_mul_f16 v249, v214, v170
    v_mfma_f32_16x16x32_bf16 v[250:253], a[232:235], v[230:233], v[250:253]
    v_pk_fma_f16 v249, v215, v171, v249
    v_pk_fma_f16 v249, v216, v172, v249
    v_mfma_f32_16x16x32_bf16 v[250:253], a[236:239], v[234:237], v[250:253]
    v_pk_fma_f16 v249, v217, v173, v249
    v_pk_fma_f16 v249, v208, v176, v249
    v_mfma_f32_16x16x32_bf16 v[114:117], a[12:15], v[194:197], v[114:117]
    v_pk_fma_f16 v249, v209, v177, v249
    v_mul_f32 v136, 0x3baaaaab, v136
    v_mfma_f32_16x16x32_bf16 v[114:117], a[16:19], v[122:125], v[114:117]
    v_rsq_f32 v136, v136
    v_mfma_f32_16x16x32_bf16 v[114:117], a[20:23], v[202:205], v[114:117]
    buffer_store_dwordx2 v[206:207], v18, s[48:51], 0 offen nt
    v_fma_f32 v137, v250, v250, s33
    v_fmac_f32 v137, v251, v251
    v_fmac_f32 v137, v252, v252
    v_fmac_f32 v137, v253, v253
    v_mul_f32 v242, v136, v242
    v_mul_f32 v243, v136, v243
    v_cvt_pk_bf16_f32 v210, v242, v243
    v_mfma_f32_16x16x32_bf16 v[226:229], a[240:243], v[126:129], 0
    v_cvt_pk_f16_f32 v114, v114, v115
    v_pk_mul_f16 v246, v114, v114
    v_mfma_f32_16x16x32_bf16 v[226:229], a[244:247], v[130:133], v[226:229]
    v_cvt_pk_f16_f32 v115, v116, v117
    v_pk_fma_f16 v246, v115, v115, v246
    v_mfma_f32_16x16x32_bf16 v[226:229], a[248:251], v[218:221], v[226:229]
    v_pk_mul_f16 v248, v114, v182
    v_pk_fma_f16 v248, v115, v183, v248
    v_mfma_f32_16x16x32_bf16 v[226:229], a[252:255], v[222:225], v[226:229]
    v_mul_f32 v244, v136, v244
    v_mul_f32 v245, v136, v245
    v_mfma_f32_16x16x32_bf16 v[226:229], v[82:85], v[230:233], v[226:229]
    v_cvt_pk_bf16_f32 v211, v244, v245
    v_mul_f32 v158, v136, v158
    v_mfma_f32_16x16x32_bf16 v[226:229], v[86:89], v[234:237], v[226:229]
    v_mul_f32 v159, v136, v159
    v_cvt_pk_bf16_f32 v212, v158, v159
    v_mul_f32 v160, v136, v160
    v_mul_f32 v161, v136, v161
    v_cvt_pk_bf16_f32 v213, v160, v161
    v_mul_f32 v154, v136, v154
    v_mul_f32 v155, v136, v155
    v_cvt_pk_bf16_f32 v144, v154, v155
    v_mfma_f32_16x16x32_bf16 v[158:161], v[90:93], v[126:129], 0
    v_fmac_f32 v137, v226, v226
    v_fmac_f32 v137, v227, v227
    v_mfma_f32_16x16x32_bf16 v[158:161], v[94:97], v[130:133], v[158:161]
    v_fmac_f32 v137, v228, v228
    v_fmac_f32 v137, v229, v229
    v_mfma_f32_16x16x32_bf16 v[158:161], v[98:101], v[218:221], v[158:161]
    v_mul_f32 v156, v136, v156
    v_mul_f32 v157, v136, v157
    v_mfma_f32_16x16x32_bf16 v[158:161], v[102:105], v[222:225], v[158:161]
    v_cvt_pk_bf16_f32 v145, v156, v157
    v_bfe_u32 v190, v2, 4, 6
    v_mfma_f32_16x16x32_bf16 v[158:161], v[106:109], v[230:233], v[158:161]
    v_lshrrev_b32 v191, 4, v190
    v_and_b32 v193, 15, v190
    v_mfma_f32_16x16x32_bf16 v[158:161], v[110:113], v[234:237], v[158:161]
    v_lshlrev_b32 v126, 9, v191
    v_lshl_add_u32 v126, v193, 4, v126
    v_mfma_f32_16x16x32_bf16 v[130:133], a[24:27], v[162:165], 0
    buffer_store_dwordx4 v[210:213], v17, s[48:51], 0 offen nt
    v_add_u32 v126, 149696, v126
    v_and_b32 v127, 0xffff, v2
    v_add_u32 v127, 38912, v127
    v_and_b32 v128, 0xffff, v4
    v_mfma_f32_16x16x32_bf16 v[130:133], a[28:31], v[166:169], v[130:133]
    v_fmac_f32 v137, v158, v158
    v_fmac_f32 v137, v159, v159
    v_mfma_f32_16x16x32_bf16 v[130:133], a[32:35], v[186:189], v[130:133]
    v_fmac_f32 v137, v160, v160
    v_fmac_f32 v137, v161, v161
    v_mfma_f32_16x16x32_bf16 v[130:133], a[36:39], v[194:197], v[130:133]
    v_cvt_pk_bf16_f32 v136, v255, v137
    v_cvt_pk_bf16_f32 v137, v137, v137
    v_mfma_f32_16x16x32_bf16 v[130:133], a[40:43], v[122:125], v[130:133]
    v_add_u32 v128, 38912, v128
    v_mov_b32 v129, 0x40000000
    v_mfma_f32_16x16x32_bf16 v[130:133], a[44:47], v[202:205], v[130:133]
    ds_write_b64 v128, v[136:137] offset:0
    v_mfma_f32_16x16x32_bf16 v[154:157], a[48:51], v[162:165], 0
    v_exp_f32 v192, v192
    v_mfma_f32_16x16x32_bf16 v[154:157], a[52:55], v[166:169], v[154:157]
    v_cvt_pk_bf16_f32 v39, v192, 0
    v_add_u32 v192, 0, v193
    v_mfma_f32_16x16x32_bf16 v[154:157], a[56:59], v[186:189], v[154:157]
    v_mul_u32_u24 v255, s20, v192
    v_cvt_pk_f16_f32 v116, v130, v131
    v_mfma_f32_16x16x32_bf16 v[154:157], a[60:63], v[194:197], v[154:157]
    v_pk_fma_f16 v246, v116, v116, v246
    v_cvt_pk_f16_f32 v117, v132, v133
    v_mfma_f32_16x16x32_bf16 v[154:157], a[64:67], v[122:125], v[154:157]
    v_pk_fma_f16 v246, v117, v117, v246
    v_pk_fma_f16 v248, v116, v184, v248
    v_mfma_f32_16x16x32_bf16 v[154:157], a[68:71], v[202:205], v[154:157]
    v_pk_fma_f16 v248, v117, v185, v248
    v_add_u32 v255, s38, v255
    v_mfma_f32_16x16x32_bf16 v[130:133], v[162:165], a[144:147], 0
    s_waitcnt lgkmcnt(0)
    v_mul_u32_u24 v136, 911, v255
    v_lshrrev_b32 v136, 16, v136
    v_mfma_f32_16x16x32_bf16 v[130:133], v[166:169], a[148:151], v[130:133]
    s_barrier
    ds_read_b128 v[210:213], v127 offset:0
    ds_read_b128 v[218:221], v127 offset:1024
    v_mfma_f32_16x16x32_bf16 v[130:133], v[186:189], a[152:155], v[130:133]
    v_cvt_pk_f16_f32 v206, v154, v155
    v_pk_fma_f16 v246, v206, v206, v246
    v_mfma_f32_16x16x32_bf16 v[130:133], v[194:197], a[156:159], v[130:133]
    buffer_store_dwordx2 v[144:145], v20, s[48:51], 0 offen nt
    v_cvt_pk_f16_f32 v207, v156, v157
    v_pk_fma_f16 v246, v207, v207, v246
    v_mfma_f32_16x16x32_bf16 v[130:133], v[122:125], a[160:163], v[130:133]
    v_pk_fma_f16 v248, v206, v174, v248
    v_pk_fma_f16 v248, v207, v175, v248
    v_mfma_f32_16x16x32_bf16 v[130:133], v[202:205], a[164:167], v[130:133]
    v_mul_u32_u24 v136, s22, v136
    v_mad_u32_u24 v136, v192, s21, v136
    v_mfma_f32_16x16x32_f16 v[154:157], v[40:43], v[246:249], 0
    v_bfe_u32 v255, s70, v192, 1
    v_cmp_ne_u32 vcc, 0, v255
    v_mfma_f32_16x16x32_bf16 v[222:225], v[162:165], a[168:171], 0
    v_add_u32 v192, s7, v136
    v_cndmask_b32 v192, v129, v192, vcc
    v_mfma_f32_16x16x32_bf16 v[222:225], v[166:169], a[172:175], v[222:225]
    s_waitcnt lgkmcnt(1)
    v_cvt_pk_bf16_f32 v136, v130, v131
    v_cvt_pk_bf16_f32 v137, v132, v133
    v_mfma_f32_16x16x32_bf16 v[130:133], v[32:35], v[210:213], 0
    s_waitcnt lgkmcnt(0)
    v_rsq_f32 v154, v154
    v_mfma_f32_16x16x32_bf16 v[130:133], v[32:35], v[218:221], v[130:133]
    v_rsq_f32 v155, v155
    v_mfma_f32_16x16x32_bf16 v[222:225], v[186:189], a[176:179], v[222:225]
    v_mul_f32 v210, s31, v154
    v_cvt_pk_f16_f32 v211, v210, v155
    v_mfma_f32_16x16x32_bf16 v[222:225], v[194:197], a[180:183], v[222:225]
    v_fma_f32 v156, v156, v210, v24
    v_fmac_f32_dpp v254, v157, v155 quad_perm:[0,1,2,3] row_mask:0x2 bank_mask:0xf
    v_mfma_f32_16x16x32_bf16 v[222:225], v[122:125], a[184:187], v[222:225]
    ds_read_b128 v[218:221], v0 offset:32768
    v_mul_f32 v157, 0x3baaaaab, v131
    v_mfma_f32_16x16x32_bf16 v[222:225], v[202:205], a[188:191], v[222:225]
    ds_read_b128 v[230:233], v1 offset:32768
    v_pk_mul_f16 v214, v214, v211 op_sel:[0,1] op_sel_hi:[1,1]
    v_mfma_f32_16x16x32_bf16 v[234:237], v[162:165], a[192:195], 0
    ds_read_b128 v[162:165], v0 offset:32896
    v_pk_mul_f16 v215, v215, v211 op_sel:[0,1] op_sel_hi:[1,1]
    v_mfma_f32_16x16x32_bf16 v[234:237], v[166:169], a[196:199], v[234:237]
    ds_read_b128 v[166:169], v1 offset:32896
    v_pk_mul_f16 v216, v216, v211 op_sel:[0,1] op_sel_hi:[1,1]
    v_mfma_f32_16x16x32_bf16 v[234:237], v[186:189], a[200:203], v[234:237]
    ds_read_b128 v[186:189], v0 offset:33024
    v_cvt_pk_bf16_f32 v152, v222, v223
    v_mfma_f32_16x16x32_bf16 v[234:237], v[194:197], a[204:207], v[234:237]
    ds_read_b128 v[194:197], v1 offset:33024
    v_cvt_pk_bf16_f32 v153, v224, v225
    v_mfma_f32_16x16x32_bf16 v[234:237], v[122:125], a[208:211], v[234:237]
    v_rsq_f32 v157, v157
    v_mfma_f32_16x16x32_bf16 v[234:237], v[202:205], a[212:215], v[234:237]
    v_mul_f32 v250, v157, v250
    v_mul_f32 v251, v157, v251
    v_mfma_f32_16x16x32_f16 v[122:125], v[146:149], v[138:141], v[46:49]
    s_waitcnt lgkmcnt(5)
    v_cvt_pk_bf16_f32 v202, v250, v251
    v_mul_f32 v252, v157, v252
    v_mfma_f32_16x16x32_bf16 v[222:225], a[72:75], v[218:221], 0
    s_waitcnt lgkmcnt(4)
    v_mul_f32 v253, v157, v253
    v_cvt_pk_bf16_f32 v203, v252, v253
    v_mfma_f32_16x16x32_bf16 v[222:225], a[76:79], v[230:233], v[222:225]
    s_waitcnt lgkmcnt(3)
    v_mul_f32 v226, v157, v226
    v_mul_f32 v227, v157, v227
    v_mfma_f32_16x16x32_bf16 v[222:225], a[80:83], v[162:165], v[222:225]
    s_waitcnt lgkmcnt(2)
    v_cvt_pk_bf16_f32 v204, v226, v227
    v_mul_f32 v228, v157, v228
    v_mfma_f32_16x16x32_bf16 v[222:225], a[84:87], v[166:169], v[222:225]
    s_waitcnt lgkmcnt(1)
    v_mul_f32 v229, v157, v229
    v_cvt_pk_bf16_f32 v205, v228, v229
    v_mfma_f32_16x16x32_bf16 v[222:225], a[88:91], v[186:189], v[222:225]
    s_waitcnt lgkmcnt(0)
    buffer_store_dwordx4 v[202:205], v16, s[52:55], 0 offen nt
    v_mul_f32 v158, v157, v158
    v_mul_f32 v159, v157, v159
    v_cvt_pk_bf16_f32 v132, v158, v159
    v_mul_f32 v160, v157, v160
    v_mfma_f32_16x16x32_bf16 v[222:225], a[92:95], v[194:197], v[222:225]
    v_mul_f32 v161, v157, v161
    v_cvt_pk_bf16_f32 v133, v160, v161
    v_mfma_f32_16x16x32_bf16 v[158:161], a[96:99], v[218:221], 0
    v_cvt_pk_bf16_f32 v144, v234, v235
    v_cvt_pk_bf16_f32 v145, v236, v237
    v_mfma_f32_16x16x32_bf16 v[158:161], a[100:103], v[230:233], v[158:161]
    v_pk_mul_f16 v217, v217, v211 op_sel:[0,1] op_sel_hi:[1,1]
    v_pk_mul_f16 v208, v208, v211 op_sel:[0,1] op_sel_hi:[1,1]
    v_mfma_f32_16x16x32_bf16 v[158:161], a[104:107], v[162:165], v[158:161]
    v_pk_mul_f16 v209, v209, v211 op_sel:[0,1] op_sel_hi:[1,1]
    v_pk_mul_f16 v114, v114, v211 op_sel:[0,0] op_sel_hi:[1,0]
    v_mfma_f32_16x16x32_bf16 v[158:161], a[108:111], v[166:169], v[158:161]
    v_pk_mul_f16 v115, v115, v211 op_sel:[0,0] op_sel_hi:[1,0]
    v_pk_mul_f16 v116, v116, v211 op_sel:[0,0] op_sel_hi:[1,0]
    v_mfma_f32_16x16x32_bf16 v[158:161], a[112:115], v[186:189], v[158:161]
    v_pk_mul_f16 v117, v117, v211 op_sel:[0,0] op_sel_hi:[1,0]
    v_pk_mul_f16 v206, v206, v211 op_sel:[0,0] op_sel_hi:[1,0]
    v_mfma_f32_16x16x32_bf16 v[158:161], a[116:119], v[194:197], v[158:161]
    v_pk_mul_f16 v207, v207, v211 op_sel:[0,0] op_sel_hi:[1,0]
    v_max3_u32 v44, v44, v154, v155
    v_mfma_f32_16x16x32_bf16 v[202:205], a[120:123], v[218:221], 0
    v_mul_f32 v255, 0x3baaaaab, v130
    v_cvt_pk_f16_f32 v130, v222, v223
    v_mfma_f32_16x16x32_bf16 v[202:205], a[124:127], v[230:233], v[202:205]
    v_rsq_f32 v255, v255
    v_mfma_f32_16x16x32_bf16 v[202:205], a[128:131], v[162:165], v[202:205]
    v_mul_f32 v178, v255, v178
    v_mul_f32 v179, v255, v179
    v_mfma_f32_16x16x32_bf16 v[202:205], a[132:135], v[166:169], v[202:205]
    v_cvt_pk_bf16_f32 v178, v178, v179
    v_mul_f32 v180, v255, v180
    v_mfma_f32_16x16x32_bf16 v[202:205], a[136:139], v[186:189], v[202:205]
    v_mul_f32 v181, v255, v181
    v_cvt_pk_bf16_f32 v179, v180, v181
    v_mfma_f32_16x16x32_bf16 v[202:205], a[140:143], v[194:197], v[202:205]
    v_mul_f32 v198, v255, v198
    v_mul_f32 v199, v255, v199
    v_mfma_f32_16x16x32_bf16 v[210:213], a[0:3], v[218:221], 0
    v_cvt_pk_bf16_f32 v180, v198, v199
    v_mul_f32 v200, v255, v200
    v_mfma_f32_16x16x32_bf16 v[210:213], a[4:7], v[230:233], v[210:213]
    v_mul_f32 v201, v255, v201
    v_cvt_pk_bf16_f32 v181, v200, v201
    v_mfma_f32_16x16x32_bf16 v[210:213], a[8:11], v[162:165], v[210:213]
    buffer_store_dwordx2 v[132:133], v19, s[52:55], 0 offen nt
    v_mul_f32 v238, v255, v238
    v_mul_f32 v239, v255, v239
    v_mfma_f32_16x16x32_bf16 v[210:213], a[12:15], v[166:169], v[210:213]
    v_cvt_pk_bf16_f32 v154, v238, v239
    v_mul_f32 v240, v255, v240
    v_mfma_f32_16x16x32_bf16 v[210:213], a[16:19], v[186:189], v[210:213]
    v_mul_f32 v241, v255, v241
    v_cvt_pk_bf16_f32 v155, v240, v241
    v_mfma_f32_16x16x32_bf16 v[210:213], a[20:23], v[194:197], v[210:213]
    v_pk_mul_f16 v199, v130, v130
    v_cvt_pk_f16_f32 v131, v224, v225
    v_mfma_f32_16x16x32_bf16 v[222:225], a[24:27], v[218:221], 0
    v_pk_fma_f16 v199, v131, v131, v199
    v_cvt_pk_f16_f32 v132, v158, v159
    v_mfma_f32_16x16x32_f16 v[226:229], v[214:217], v[138:141], v[50:53]
    v_pk_fma_f16 v199, v132, v132, v199
    v_cvt_pk_f16_f32 v133, v160, v161
    v_cvt_pk_f16_f32 v158, v210, v211
    v_mfma_f32_16x16x16_f16 v[122:125], v[120:121], v[118:119], v[122:125]
    v_pk_mul_f16 v198, v158, v158
    v_cvt_pk_f16_f32 v159, v212, v213
    v_pk_fma_f16 v198, v159, v159, v198
    v_mfma_f32_16x16x16_f16 v[226:229], v[208:209], v[118:119], v[226:229]
    v_pk_mul_f16 v200, v158, v182
    v_pk_fma_f16 v200, v159, v183, v200
    v_pk_fma_f16 v199, v133, v133, v199
    v_cvt_pk_f16_f32 v212, v202, v203
    v_mfma_f32_16x16x32_bf16 v[222:225], a[28:31], v[230:233], v[222:225]
    v_pk_fma_f16 v199, v212, v212, v199
    v_cvt_pk_f16_f32 v213, v204, v205
    v_mfma_f32_16x16x32_bf16 v[222:225], a[32:35], v[162:165], v[222:225]
    v_pk_fma_f16 v199, v213, v213, v199
    v_pk_mul_f16 v201, v130, v170
    v_mfma_f32_16x16x32_bf16 v[222:225], a[36:39], v[166:169], v[222:225]
    v_pk_fma_f16 v201, v131, v171, v201
    v_pk_fma_f16 v201, v132, v172, v201
    v_mfma_f32_16x16x32_bf16 v[222:225], a[40:43], v[186:189], v[222:225]
    v_pk_fma_f16 v201, v133, v173, v201
    v_pk_fma_f16 v201, v212, v176, v201
    v_mfma_f32_16x16x32_bf16 v[222:225], a[44:47], v[194:197], v[222:225]
    v_pk_fma_f16 v201, v213, v177, v201
    v_lshl_add_u32 v255, v191, 4, v192
    v_mfma_f32_16x16x32_bf16 v[170:173], a[48:51], v[218:221], 0
    v_exp_f32 v122, v122
    v_mfma_f32_16x16x32_bf16 v[170:173], a[52:55], v[230:233], v[170:173]
    v_exp_f32 v123, v123
    v_mfma_f32_16x16x32_bf16 v[170:173], a[56:59], v[162:165], v[170:173]
    v_cvt_pk_bf16_f32 v122, v122, v123
    v_cvt_pk_f16_f32 v160, v222, v223
    v_mfma_f32_16x16x32_bf16 v[170:173], a[60:63], v[166:169], v[170:173]
    buffer_store_dwordx4 v[178:181], v15, s[52:55], 0 offen nt
    v_pk_fma_f16 v198, v160, v160, v198
    v_cvt_pk_f16_f32 v161, v224, v225
    v_pk_fma_f16 v198, v161, v161, v198
    v_pk_fma_f16 v200, v160, v184, v200
    v_mfma_f32_16x16x32_bf16 v[170:173], a[64:67], v[186:189], v[170:173]
    v_pk_fma_f16 v200, v161, v185, v200
    v_add_u32 v255, s3, v255
    v_mfma_f32_16x16x32_bf16 v[170:173], a[68:71], v[194:197], v[170:173]
    ds_read2_b32 v[176:177], v6 offset0:0 offset1:0
    ds_read2_b32 v[180:181], v6 offset0:16 offset1:16
    v_mfma_f32_16x16x32_bf16 v[182:185], v[218:221], a[144:147], 0
    ds_read2_b32 v[204:205], v6 offset0:32 offset1:32
    v_lshl_add_u32 v192, v191, 3, v192
    v_mfma_f32_16x16x32_bf16 v[182:185], v[230:233], a[148:151], v[182:185]
    v_exp_f32 v124, v124
    v_mfma_f32_16x16x32_bf16 v[182:185], v[162:165], a[152:155], v[182:185]
    v_cvt_pk_f16_f32 v210, v170, v171
    v_pk_fma_f16 v198, v210, v210, v198
    v_mfma_f32_16x16x32_bf16 v[182:185], v[166:169], a[156:159], v[182:185]
    v_cvt_pk_f16_f32 v211, v172, v173
    v_pk_fma_f16 v198, v211, v211, v198
    v_mfma_f32_16x16x32_bf16 v[182:185], v[186:189], a[160:163], v[182:185]
    v_pk_fma_f16 v200, v210, v174, v200
    v_pk_fma_f16 v200, v211, v175, v200
    v_mfma_f32_16x16x32_bf16 v[182:185], v[194:197], a[164:167], v[182:185]
    v_exp_f32 v125, v125
    v_mfma_f32_16x16x32_f16 v[170:173], v[40:43], v[198:201], 0
    v_cvt_pk_bf16_f32 v123, v124, v125
    v_add_u32 v192, s4, v192
    v_mfma_f32_16x16x32_bf16 v[198:201], v[218:221], a[168:171], 0
    s_waitcnt lgkmcnt(1)
    v_exp_f32 v226, v226
    v_mfma_f32_16x16x32_bf16 v[198:201], v[230:233], a[172:175], v[198:201]
    s_waitcnt lgkmcnt(0)
    v_cvt_pk_bf16_f32 v174, v182, v183
    v_cvt_pk_bf16_f32 v175, v184, v185
    v_mfma_f32_16x16x32_bf16 v[198:201], v[162:165], a[176:179], v[198:201]
    v_rsq_f32 v170, v170
    v_mfma_f32_16x16x32_bf16 v[198:201], v[166:169], a[180:183], v[198:201]
    ds_read_b128 v[182:185], v2 offset:12288
    ds_read_b128 v[222:225], v2 offset:13312
    v_mfma_f32_16x16x32_bf16 v[198:201], v[186:189], a[184:187], v[198:201]
    ds_read_b128 v[234:237], v2 offset:14336
    ds_read_b128 v[238:241], v2 offset:15360
    v_mfma_f32_16x16x32_bf16 v[198:201], v[194:197], a[188:191], v[198:201]
    buffer_store_dwordx2 v[154:155], v18, s[52:55], 0 offen nt
    ds_read_b128 v[242:245], v2 offset:16384
    v_rsq_f32 v171, v171
    v_mul_f32 v124, s31, v170
    v_cvt_pk_f16_f32 v125, v124, v171
    v_fma_f32 v172, v172, v124, v26
    v_fmac_f32_dpp v254, v173, v171 quad_perm:[0,1,2,3] row_mask:0x4 bank_mask:0xf
    v_pk_mul_f16 v130, v130, v125 op_sel:[0,1] op_sel_hi:[1,1]
    v_cvt_pk_bf16_f32 v178, v198, v199
    v_cvt_pk_bf16_f32 v179, v200, v201
    v_pk_mul_f16 v131, v131, v125 op_sel:[0,1] op_sel_hi:[1,1]
    v_pk_mul_f16 v132, v132, v125 op_sel:[0,1] op_sel_hi:[1,1]
    v_pk_mul_f16 v133, v133, v125 op_sel:[0,1] op_sel_hi:[1,1]
    v_pk_mul_f16 v212, v212, v125 op_sel:[0,1] op_sel_hi:[1,1]
    v_pk_mul_f16 v213, v213, v125 op_sel:[0,1] op_sel_hi:[1,1]
    v_pk_mul_f16 v158, v158, v125 op_sel:[0,0] op_sel_hi:[1,0]
    v_pk_mul_f16 v159, v159, v125 op_sel:[0,0] op_sel_hi:[1,0]
    v_pk_mul_f16 v160, v160, v125 op_sel:[0,0] op_sel_hi:[1,0]
    v_pk_mul_f16 v161, v161, v125 op_sel:[0,0] op_sel_hi:[1,0]
    v_pk_mul_f16 v210, v210, v125 op_sel:[0,0] op_sel_hi:[1,0]
    v_pk_mul_f16 v211, v211, v125 op_sel:[0,0] op_sel_hi:[1,0]
    v_mfma_f32_16x16x32_f16 v[198:201], v[130:133], v[138:141], v[54:57]
    s_waitcnt lgkmcnt(2)
    ds_read_b128 v[138:141], v2 offset:17408
    v_max3_u32 v44, v44, v170, v171
    v_exp_f32 v227, v227
    v_exp_f32 v228, v228
    v_cvt_pk_bf16_f32 v124, v226, v227
    v_mfma_f32_16x16x16_f16 v[198:201], v[212:213], v[118:119], v[198:201]
    v_exp_f32 v229, v229
    v_sub_u32 v170, 0x40800000, v44
    v_cvt_pk_bf16_f32 v125, v228, v229
    v_mfma_f32_16x16x32_bf16 v[226:229], v[218:221], a[192:195], 0
    s_waitcnt lgkmcnt(1)
    v_or_b32 v170, v170, v44
    v_xor_b32 v171, 65536, v2
    v_mfma_f32_16x16x32_bf16 v[226:229], v[230:233], a[196:199], v[226:229]
    v_exp_f32 v198, v198
    v_mfma_f32_16x16x32_bf16 v[226:229], v[162:165], a[200:203], v[226:229]
    v_exp_f32 v199, v199
    v_mfma_f32_16x16x32_bf16 v[226:229], v[166:169], a[204:207], v[226:229]
    v_cvt_pk_bf16_f32 v36, v198, v199
    v_bfe_u32 v173, v193, 1, 2
    v_mfma_f32_16x16x32_bf16 v[226:229], v[186:189], a[208:211], v[226:229]
    s_waitcnt lgkmcnt(0)
    v_exp_f32 v200, v200
    v_mfma_f32_16x16x32_bf16 v[226:229], v[194:197], a[212:215], v[226:229]
    v_exp_f32 v201, v201
    v_mfma_f32_16x16x32_f16 v[162:165], v[146:149], v[114:117], v[58:61]
    v_cvt_pk_bf16_f32 v37, v200, v201
    v_xor_b32 v173, v173, v191
    v_mfma_f32_16x16x32_f16 v[166:169], v[214:217], v[114:117], v[62:65]
    v_exp_f32 v254, v254
    v_mfma_f32_16x16x32_bf16 v[186:189], v[28:31], v[36:39], 0
    v_cvt_pk_bf16_f32 v254, v254, v254
    v_cvt_pk_bf16_f32 v202, v226, v227
    v_mfma_f32_16x16x32_bf16 v[186:189], v[28:31], v[122:125], v[186:189]
    ds_write_b16 v8, v254
    v_mfma_f32_16x16x32_bf16 v[194:197], v[174:177], v[36:39], 0
    v_cvt_pk_bf16_f32 v203, v228, v229
    v_lshl_add_u32 v173, v193, 2, v173
    v_mfma_f32_16x16x32_bf16 v[194:197], v[134:137], v[122:125], v[194:197]
    ds_read_b128 v[198:201], v9
    ds_read_b128 v[218:221], v9 offset:64
    v_mfma_f32_16x16x32_bf16 v[226:229], v[178:181], v[36:39], 0
    v_exp_f32 v156, v156
    v_mfma_f32_16x16x32_bf16 v[226:229], v[150:153], v[122:125], v[226:229]
    v_exp_f32 v172, v172
    v_mfma_f32_16x16x32_bf16 v[230:233], v[202:205], v[36:39], 0
    v_cvt_pk_bf16_f32 v39, v156, 0
    v_lshl_add_u32 v254, v173, 4, s5
    v_mfma_f32_16x16x32_bf16 v[230:233], v[142:145], v[122:125], v[230:233]
    v_rcp_f32 v186, v186
    v_mfma_f32_16x16x32_f16 v[122:125], v[130:133], v[114:117], v[66:69]
    v_max3_u32 v25, v25, v186, v187
    v_mul_f32 v194, v186, v194
    v_mul_f32 v195, v186, v195
    v_mfma_f32_16x16x16_f16 v[162:165], v[120:121], v[206:207], v[162:165]
    v_cvt_pk_bf16_f32 v114, v194, v195
    v_mul_f32 v196, v186, v196
    v_mul_f32 v197, v186, v197
    v_mfma_f32_16x16x16_f16 v[166:169], v[208:209], v[206:207], v[166:169]
    v_cvt_pk_bf16_f32 v115, v196, v197
    v_mul_f32 v226, v186, v226
    v_mul_f32 v227, v186, v227
    v_mfma_f32_16x16x16_f16 v[122:125], v[212:213], v[206:207], v[122:125]
    v_exp_f32 v162, v162
    v_exp_f32 v163, v163
    v_mfma_f32_16x16x32_bf16 v[154:157], a[216:219], v[182:185], 0
    s_waitcnt lgkmcnt(0)
    v_cvt_pk_bf16_f32 v162, v162, v163
    v_cvt_pk_bf16_f32 v116, v226, v227
    v_mfma_f32_16x16x32_bf16 v[154:157], a[220:223], v[222:225], v[154:157]
    v_exp_f32 v164, v164
    v_mfma_f32_16x16x32_bf16 v[154:157], a[224:227], v[234:237], v[154:157]
    v_exp_f32 v165, v165
    v_mfma_f32_16x16x32_bf16 v[154:157], a[228:231], v[238:241], v[154:157]
    v_cvt_pk_bf16_f32 v163, v164, v165
    v_mul_f32 v228, v186, v228
    v_mfma_f32_16x16x32_bf16 v[154:157], a[232:235], v[242:245], v[154:157]
    v_exp_f32 v166, v166
    v_mfma_f32_16x16x32_f16 v[194:197], v[146:149], v[158:161], v[70:73]
    v_exp_f32 v167, v167
    v_mfma_f32_16x16x32_f16 v[146:149], v[214:217], v[158:161], v[74:77]
    v_cvt_pk_bf16_f32 v164, v166, v167
    v_mul_f32 v229, v186, v229
    v_mfma_f32_16x16x32_f16 v[214:217], v[130:133], v[158:161], v[78:81]
    v_exp_f32 v168, v168
    v_cvt_pk_bf16_f32 v117, v228, v229
    v_mfma_f32_16x16x16_f16 v[194:197], v[120:121], v[210:211], v[194:197]
    v_exp_f32 v169, v169
    v_mul_f32 v230, v186, v230
    v_mfma_f32_16x16x16_f16 v[146:149], v[208:209], v[210:211], v[146:149]
    v_cvt_pk_bf16_f32 v165, v168, v169
    v_exp_f32 v122, v122
    v_mfma_f32_16x16x16_f16 v[214:217], v[212:213], v[210:211], v[214:217]
    v_exp_f32 v123, v123
    v_exp_f32 v124, v124
    v_mfma_f32_16x16x32_bf16 v[154:157], a[236:239], v[138:141], v[154:157]
    ds_write_b128 v3, v[114:117] offset:0
    v_mfma_f32_16x16x32_bf16 v[114:117], a[240:243], v[182:185], 0
    v_cvt_pk_bf16_f32 v36, v122, v123
    v_mul_f32 v231, v186, v231
    v_mfma_f32_16x16x32_bf16 v[114:117], a[244:247], v[222:225], v[114:117]
    v_exp_f32 v125, v125
    v_mfma_f32_16x16x32_bf16 v[114:117], a[248:251], v[234:237], v[114:117]
    v_cvt_pk_bf16_f32 v37, v124, v125
    v_fma_f32 v187, v154, v154, s33
    v_mfma_f32_16x16x32_bf16 v[114:117], a[252:255], v[238:241], v[114:117]
    v_fmac_f32 v187, v155, v155
    v_fmac_f32 v187, v156, v156
    v_mfma_f32_16x16x32_bf16 v[118:121], v[28:31], v[36:39], 0
    v_fmac_f32 v187, v157, v157
    v_cvt_pk_bf16_f32 v230, v230, v231
    v_mfma_f32_16x16x32_bf16 v[118:121], v[28:31], v[162:165], v[118:121]
    v_exp_f32 v194, v194
    v_mfma_f32_16x16x32_bf16 v[122:125], v[174:177], v[36:39], 0
    v_exp_f32 v195, v195
    v_mfma_f32_16x16x32_bf16 v[122:125], v[134:137], v[162:165], v[122:125]
    v_cvt_pk_bf16_f32 v130, v194, v195
    v_mul_f32 v232, v186, v232
    v_mfma_f32_16x16x32_bf16 v[158:161], v[178:181], v[36:39], 0
    v_exp_f32 v196, v196
    v_mfma_f32_16x16x32_bf16 v[158:161], v[150:153], v[162:165], v[158:161]
    v_rcp_f32 v118, v118
    v_mfma_f32_16x16x32_bf16 v[166:169], v[202:205], v[36:39], 0
    v_exp_f32 v197, v197
    v_mfma_f32_16x16x32_bf16 v[166:169], v[142:145], v[162:165], v[166:169]
    v_mul_f32 v122, v118, v122
    v_mul_f32 v123, v118, v123
    v_mfma_f32_16x16x32_bf16 v[114:117], v[82:85], v[242:245], v[114:117]
    v_cvt_pk_bf16_f32 v122, v122, v123
    v_mul_f32 v124, v118, v124
    v_mfma_f32_16x16x32_bf16 v[114:117], v[86:89], v[138:141], v[114:117]
    ds_read_b128 v[162:165], v126 offset:0
    v_mul_f32 v125, v118, v125
    v_mfma_f32_16x16x32_bf16 v[206:209], v[90:93], v[182:185], 0
    ds_read_b128 v[182:185], v126 offset:2048
    v_cvt_pk_bf16_f32 v123, v124, v125
    v_mfma_f32_16x16x32_bf16 v[206:209], v[94:97], v[222:225], v[206:209]
    ds_read_b128 v[210:213], v126 offset:4096
    v_mul_f32 v158, v118, v158
    v_mfma_f32_16x16x32_bf16 v[206:209], v[98:101], v[234:237], v[206:209]
    ds_read_b128 v[222:225], v126 offset:6144
    v_fmac_f32 v187, v114, v114
    v_mfma_f32_16x16x32_bf16 v[206:209], v[102:105], v[238:241], v[206:209]
    ds_read_b128 v[226:229], v126 offset:8192
    v_fmac_f32 v187, v115, v115
    v_mfma_f32_16x16x32_bf16 v[206:209], v[106:109], v[242:245], v[206:209]
    ds_read_b128 v[234:237], v126 offset:10240
    v_fmac_f32 v187, v116, v116
    v_mfma_f32_16x16x32_bf16 v[206:209], v[110:113], v[138:141], v[206:209]
    v_fmac_f32 v187, v117, v117
    v_mul_f32 v159, v118, v159
    v_mfma_f32_16x16x32_bf16 v[138:141], v[198:201], v[28:31], 0
    v_cvt_pk_bf16_f32 v124, v158, v159
    v_mul_f32 v160, v118, v160
    v_mfma_f32_16x16x32_bf16 v[138:141], v[218:221], v[28:31], v[138:141]
    s_waitcnt lgkmcnt(5)
    v_mul_f32 v161, v118, v161
    v_fmac_f32 v187, v206, v206
    v_mfma_f32_16x16x32_bf16 v[238:241], a[216:219], v[162:165], 0
    s_waitcnt lgkmcnt(4)
    v_fmac_f32 v187, v207, v207
    v_fmac_f32 v187, v208, v208
    v_mfma_f32_16x16x32_bf16 v[238:241], a[220:223], v[182:185], v[238:241]
    s_waitcnt lgkmcnt(3)
    v_fmac_f32 v187, v209, v209
    v_cvt_pk_bf16_f32 v125, v160, v161
    v_mfma_f32_16x16x32_bf16 v[238:241], a[224:227], v[210:213], v[238:241]
    s_waitcnt lgkmcnt(2)
    ds_write_b128 v3, v[122:125] offset:6144
    v_mfma_f32_16x16x32_bf16 v[238:241], a[228:231], v[222:225], v[238:241]
    s_waitcnt lgkmcnt(1)
    v_mul_f32 v166, v118, v166
    v_mul_f32 v167, v118, v167
    v_mfma_f32_16x16x32_bf16 v[238:241], a[232:235], v[226:229], v[238:241]
    v_cvt_pk_bf16_f32 v120, v166, v167
    v_mul_f32 v168, v118, v168
    v_mfma_f32_16x16x32_bf16 v[238:241], a[236:239], v[234:237], v[238:241]
    v_mul_f32 v169, v118, v169
    v_cvt_pk_bf16_f32 v121, v168, v169
    v_mfma_f32_16x16x32_bf16 v[122:125], a[240:243], v[162:165], 0
    ds_write_b64 v4, v[120:121] offset:10240
    v_mfma_f32_16x16x32_bf16 v[122:125], a[244:247], v[182:185], v[122:125]
    v_rcp_f32 v138, v138
    v_mfma_f32_16x16x32_bf16 v[122:125], a[248:251], v[210:213], v[122:125]
    v_max3_u32 v25, v25, v138, v139
    v_fma_f32 v188, v238, v238, s33
    v_mfma_f32_16x16x32_bf16 v[122:125], a[252:255], v[222:225], v[122:125]
    v_fmac_f32 v188, v239, v239
    v_fmac_f32 v188, v240, v240
    v_mfma_f32_16x16x32_bf16 v[122:125], v[82:85], v[226:229], v[122:125]
    v_fmac_f32 v188, v241, v241
    v_max3_u32 v25, v25, v118, v119
    v_mfma_f32_16x16x32_bf16 v[122:125], v[86:89], v[234:237], v[122:125]
    v_cvt_pk_bf16_f32 v131, v196, v197
    v_cvt_pk_bf16_f32 v39, v172, 0
    v_mfma_f32_16x16x32_bf16 v[118:121], v[90:93], v[162:165], 0
    v_exp_f32 v146, v146
    v_mfma_f32_16x16x32_bf16 v[118:121], v[94:97], v[182:185], v[118:121]
    v_exp_f32 v147, v147
    v_mfma_f32_16x16x32_bf16 v[118:121], v[98:101], v[210:213], v[118:121]
    v_cvt_pk_bf16_f32 v132, v146, v147
    v_fmac_f32 v188, v122, v122
    v_mfma_f32_16x16x32_bf16 v[118:121], v[102:105], v[222:225], v[118:121]
    v_fmac_f32 v188, v123, v123
    v_fmac_f32 v188, v124, v124
    v_mfma_f32_16x16x32_bf16 v[118:121], v[106:109], v[226:229], v[118:121]
    v_fmac_f32 v188, v125, v125
    v_mul_f32 v233, v186, v233
    v_mfma_f32_16x16x32_bf16 v[118:121], v[110:113], v[234:237], v[118:121]
    v_exp_f32 v148, v148
    v_mfma_f32_16x16x32_bf16 v[158:161], v[198:201], v[134:137], 0
    v_exp_f32 v149, v149
    v_mfma_f32_16x16x32_bf16 v[158:161], v[218:221], v[174:177], v[158:161]
    v_cvt_pk_bf16_f32 v133, v148, v149
    v_cvt_pk_bf16_f32 v231, v232, v233
    v_mfma_f32_16x16x32_bf16 v[146:149], v[198:201], v[150:153], 0
    ds_write_b64 v4, v[230:231] offset:4096
    v_mfma_f32_16x16x32_bf16 v[146:149], v[218:221], v[178:181], v[146:149]
    v_fmac_f32 v188, v118, v118
    v_fmac_f32 v188, v119, v119
    v_mfma_f32_16x16x32_bf16 v[162:165], v[198:201], v[142:145], 0
    v_fmac_f32 v188, v120, v120
    v_fmac_f32 v188, v121, v121
    v_mfma_f32_16x16x32_bf16 v[162:165], v[218:221], v[202:205], v[162:165]
    v_cvt_pk_bf16_f32 v140, v187, v188
    v_cvt_pk_bf16_f32 v141, v188, v188
    ds_write_b64 v128, v[140:141] offset:2048
    v_mul_f32 v158, v158, v138
    v_exp_f32 v214, v214
    v_exp_f32 v215, v215
    v_mul_f32_dpp v158, v146, v138 quad_perm:[0,1,2,3] row_mask:0x2 bank_mask:0xf
    v_cvt_pk_bf16_f32 v36, v214, v215
    v_exp_f32 v216, v216
    v_mul_f32_dpp v158, v162, v138 quad_perm:[0,1,2,3] row_mask:0x4 bank_mask:0xf
    v_cvt_pk_bf16_f32 v158, v158, v158
    ds_write_b16 v7, v158
    v_exp_f32 v217, v217
    v_lshl_add_u32 v172, v173, 3, s5
    v_cvt_pk_bf16_f32 v37, v216, v217
    v_lshl_add_u32 v138, v190, 4, s5
    v_lshl_add_u32 v139, v190, 3, s5
    v_mfma_f32_16x16x32_bf16 v[146:149], v[28:31], v[36:39], 0
    v_lshlrev_b32 v173, 2, v173
    v_add_u32 v140, 16, v193
    v_mfma_f32_16x16x32_bf16 v[146:149], v[28:31], v[130:133], v[146:149]
    s_waitcnt lgkmcnt(1)
    ds_permute_b32 v141, v173, v16
    ds_permute_b32 v190, v173, v19
    v_mfma_f32_16x16x32_bf16 v[158:161], v[174:177], v[36:39], 0
    s_barrier
    ds_read_b128 v[162:165], v127 offset:2048
    ds_read_b128 v[166:169], v127 offset:3072
    v_mfma_f32_16x16x32_bf16 v[158:161], v[134:137], v[130:133], v[158:161]
    ds_read_b128 v[134:137], v171 offset:0
    ds_read_b128 v[174:177], v171 offset:1024
    v_mfma_f32_16x16x32_bf16 v[182:185], v[178:181], v[36:39], 0
    v_rcp_f32 v146, v146
    v_mfma_f32_16x16x32_bf16 v[182:185], v[150:153], v[130:133], v[182:185]
    ds_read_b128 v[150:153], v171 offset:2048
    ds_read_b128 v[178:181], v171 offset:3072
    v_mfma_f32_16x16x32_bf16 v[186:189], v[202:205], v[36:39], 0
    v_max3_u32 v25, v25, v146, v147
    v_sub_u32 v193, 0x67800000, v25
    v_mfma_f32_16x16x32_bf16 v[186:189], v[142:145], v[130:133], v[186:189]
    ds_read_b128 v[130:133], v171 offset:4096
    ds_read_b128 v[142:145], v171 offset:5120
    v_or3_b32 v170, v170, v193, v25
    v_lshl_add_u32 v193, s16, 2, v171
    ds_write_b32 v193, v170 offset:18432
    s_waitcnt lgkmcnt(8)
    v_mfma_f32_16x16x32_bf16 v[194:197], v[32:35], v[162:165], 0
    s_waitcnt lgkmcnt(7)
    v_mul_f32 v158, v146, v158
    v_mul_f32 v159, v146, v159
    v_mfma_f32_16x16x32_bf16 v[194:197], v[32:35], v[166:169], v[194:197]
    s_waitcnt lgkmcnt(5)
    ds_permute_b32 v170, v173, v17
    ds_permute_b32 v193, v173, v20
    v_mfma_f32_16x16x32_bf16 v[162:165], a[216:219], v[134:137], 0
    v_cvt_pk_bf16_f32 v158, v158, v159
    v_mul_f32 v160, v146, v160
    v_mfma_f32_16x16x32_bf16 v[162:165], a[220:223], v[174:177], v[162:165]
    s_waitcnt lgkmcnt(5)
    v_mul_f32 v159, 0x3baaaaab, v195
    v_mul_f32 v161, v146, v161
    v_mfma_f32_16x16x32_bf16 v[162:165], a[224:227], v[150:153], v[162:165]
    v_rsq_f32 v159, v159
    v_mfma_f32_16x16x32_bf16 v[162:165], a[228:231], v[178:181], v[162:165]
    s_waitcnt lgkmcnt(3)
    v_mul_f32 v238, v159, v238
    v_mul_f32 v239, v159, v239
    v_mfma_f32_16x16x32_bf16 v[162:165], a[232:235], v[130:133], v[162:165]
    v_cvt_pk_bf16_f32 v166, v238, v239
    v_mul_f32 v240, v159, v240
    v_mfma_f32_16x16x32_bf16 v[162:165], a[236:239], v[142:145], v[162:165]
    v_mul_f32 v241, v159, v241
    v_cvt_pk_bf16_f32 v167, v240, v241
    v_mfma_f32_16x16x32_bf16 v[198:201], a[240:243], v[134:137], 0
    v_mul_f32 v122, v159, v122
    v_mul_f32 v123, v159, v123
    v_mfma_f32_16x16x32_bf16 v[198:201], a[244:247], v[174:177], v[198:201]
    s_waitcnt lgkmcnt(0)
    v_cvt_pk_bf16_f32 v168, v122, v123
    v_mul_f32 v124, v159, v124
    v_mfma_f32_16x16x32_bf16 v[198:201], a[248:251], v[150:153], v[198:201]
    v_mul_f32 v125, v159, v125
    v_cvt_pk_bf16_f32 v169, v124, v125
    v_mfma_f32_16x16x32_bf16 v[198:201], a[252:255], v[178:181], v[198:201]
    buffer_store_dwordx4 v[166:169], v255, s[12:15], 0 offen nt
    v_mul_f32 v118, v159, v118
    v_mul_f32 v119, v159, v119
    v_cvt_pk_bf16_f32 v148, v118, v119
    v_mul_f32 v120, v159, v120
    v_mfma_f32_16x16x32_bf16 v[198:201], v[82:85], v[130:133], v[198:201]
    v_mul_f32 v121, v159, v121
    v_cvt_pk_bf16_f32 v149, v120, v121
    v_mfma_f32_16x16x32_bf16 v[198:201], v[86:89], v[142:145], v[198:201]
    ds_read_b128 v[118:121], v171 offset:6144
    v_fma_f32 v173, v162, v162, s33
    v_mfma_f32_16x16x32_bf16 v[122:125], v[90:93], v[134:137], 0
    ds_read_b128 v[134:137], v171 offset:7168
    v_fmac_f32 v173, v163, v163
    v_mfma_f32_16x16x32_bf16 v[122:125], v[94:97], v[174:177], v[122:125]
    ds_read_b128 v[166:169], v171 offset:8192
    v_fmac_f32 v173, v164, v164
    v_mfma_f32_16x16x32_bf16 v[122:125], v[98:101], v[150:153], v[122:125]
    ds_read_b128 v[150:153], v171 offset:9216
    v_fmac_f32 v173, v165, v165
    v_mfma_f32_16x16x32_bf16 v[122:125], v[102:105], v[178:181], v[122:125]
    ds_read_b128 v[174:177], v171 offset:10240
    v_fmac_f32 v173, v198, v198
    v_mfma_f32_16x16x32_bf16 v[122:125], v[106:109], v[130:133], v[122:125]
    ds_read_b128 v[130:133], v171 offset:11264
    v_fmac_f32 v173, v199, v199
    v_mfma_f32_16x16x32_bf16 v[122:125], v[110:113], v[142:145], v[122:125]
    v_fmac_f32 v173, v200, v200
    v_fmac_f32 v173, v201, v201
    v_cvt_pk_bf16_f32 v159, v160, v161
    v_mul_f32 v182, v146, v182
    s_waitcnt lgkmcnt(5)
    v_mfma_f32_16x16x32_bf16 v[142:145], a[216:219], v[118:121], 0
    v_mul_f32 v183, v146, v183
    v_cvt_pk_bf16_f32 v160, v182, v183
    v_mfma_f32_16x16x32_bf16 v[178:181], a[240:243], v[118:121], 0
    s_waitcnt lgkmcnt(4)
    v_fmac_f32 v173, v122, v122
    v_fmac_f32 v173, v123, v123
    v_mfma_f32_16x16x32_bf16 v[142:145], a[220:223], v[134:137], v[142:145]
    s_waitcnt lgkmcnt(3)
    v_fmac_f32 v173, v124, v124
    v_fmac_f32 v173, v125, v125
    v_mfma_f32_16x16x32_bf16 v[142:145], a[224:227], v[166:169], v[142:145]
    s_waitcnt lgkmcnt(2)
    v_mul_f32 v184, v146, v184
    v_mul_f32 v185, v146, v185
    v_mfma_f32_16x16x32_bf16 v[142:145], a[228:231], v[150:153], v[142:145]
    s_waitcnt lgkmcnt(1)
    v_cvt_pk_bf16_f32 v161, v184, v185
    v_mul_f32 v186, v146, v186
    v_mfma_f32_16x16x32_bf16 v[142:145], a[232:235], v[174:177], v[142:145]
    s_waitcnt lgkmcnt(0)
    ds_write_b128 v3, v[158:161] offset:12288
    v_mfma_f32_16x16x32_bf16 v[142:145], a[236:239], v[130:133], v[142:145]
    buffer_store_dwordx2 v[148:149], v192, s[12:15], 0 offen nt
    v_mul_f32 v187, v146, v187
    v_cvt_pk_bf16_f32 v186, v186, v187
    v_mfma_f32_16x16x32_bf16 v[178:181], a[244:247], v[134:137], v[178:181]
    v_mul_f32 v188, v146, v188
    v_mul_f32 v189, v146, v189
    v_mfma_f32_16x16x32_bf16 v[178:181], a[248:251], v[166:169], v[178:181]
    v_cvt_pk_bf16_f32 v187, v188, v189
    v_fma_f32 v192, v142, v142, s33
    v_mfma_f32_16x16x32_bf16 v[178:181], a[252:255], v[150:153], v[178:181]
    ds_write_b64 v4, v[186:187] offset:16384
    v_mfma_f32_16x16x32_bf16 v[178:181], v[82:85], v[174:177], v[178:181]
    v_fmac_f32 v192, v143, v143
    v_fmac_f32 v192, v144, v144
    v_mfma_f32_16x16x32_bf16 v[178:181], v[86:89], v[130:133], v[178:181]
    v_fmac_f32 v192, v145, v145
    v_mul_f32 v255, 0x3baaaaab, v194
    v_mfma_f32_16x16x32_bf16 v[146:149], v[90:93], v[118:121], 0
    v_rsq_f32 v255, v255
    v_mfma_f32_16x16x32_bf16 v[146:149], v[94:97], v[134:137], v[146:149]
    v_mul_f32 v154, v255, v154
    v_mul_f32 v155, v255, v155
    v_mfma_f32_16x16x32_bf16 v[146:149], v[98:101], v[166:169], v[146:149]
    v_fmac_f32 v192, v178, v178
    v_fmac_f32 v192, v179, v179
    v_mfma_f32_16x16x32_bf16 v[146:149], v[102:105], v[150:153], v[146:149]
    v_fmac_f32 v192, v180, v180
    v_fmac_f32 v192, v181, v181
    v_mfma_f32_16x16x32_bf16 v[146:149], v[106:109], v[174:177], v[146:149]
    v_cvt_pk_bf16_f32 v118, v154, v155
    v_mul_f32 v156, v255, v156
    v_mfma_f32_16x16x32_bf16 v[146:149], v[110:113], v[130:133], v[146:149]
    v_mul_f32 v157, v255, v157
    v_cvt_pk_bf16_f32 v119, v156, v157
    v_mul_f32 v114, v255, v114
    v_mul_f32 v115, v255, v115
    v_cvt_pk_bf16_f32 v120, v114, v115
    v_mul_f32 v116, v255, v116
    v_mul_f32 v117, v255, v117
    v_cvt_pk_bf16_f32 v121, v116, v117
    v_fmac_f32 v192, v146, v146
    v_fmac_f32 v192, v147, v147
    v_fmac_f32 v192, v148, v148
    v_fmac_f32 v192, v149, v149
    v_cvt_pk_bf16_f32 v114, v173, v192
    v_cvt_pk_bf16_f32 v115, v192, v192
    ds_write_b64 v128, v[114:115] offset:7616
    buffer_store_dwordx4 v[118:121], v17, s[52:55], 0 offen nt
    v_mul_f32 v206, v255, v206
    v_mul_f32 v207, v255, v207
    v_cvt_pk_bf16_f32 v206, v206, v207
    v_mul_f32 v208, v255, v208
    v_mul_f32 v209, v255, v209
    v_cvt_pk_bf16_f32 v207, v208, v209
    v_min_u32 v173, 20, v140
    v_add_u32 v192, 12, v140
    v_lshrrev_b32 v192, 5, v192
    v_sub_u32 v255, v140, v173
    v_mad_i32_i24 v255, v192, s6, v255
    v_mul_u32_u24 v208, s20, v173
    v_add3_u32 v208, v208, v255, s38
    v_mul_u32_u24 v192, 911, v208
    v_lshrrev_b32 v192, 16, v192
    v_mul_u32_u24 v192, s22, v192
    v_mad_u32_u24 v192, v173, s21, v192
    v_bfe_u32 v208, s70, v140, 1
    v_cmp_ne_u32 vcc, 0, v208
    v_mul_i32_i24 v255, 2688, v255
    v_add3_u32 v140, v192, v255, s7
    v_cndmask_b32 v140, v129, v140, vcc
    v_lshl_add_u32 v255, v191, 4, v140
    v_add_u32 v255, s3, v255
    s_waitcnt lgkmcnt(0)
    s_barrier
    ds_read_b128 v[114:117], v127 offset:7616
    ds_read_b128 v[118:121], v127 offset:8640
    ds_read_b128 v[130:133], v171 offset:12288
    ds_read_b128 v[134:137], v171 offset:13312
    ds_read_b128 v[150:153], v171 offset:14336
    ds_read_b128 v[154:157], v171 offset:15360
    ds_read_b128 v[158:161], v171 offset:16384
    ds_read_b128 v[166:169], v171 offset:17408
    v_lshl_add_u32 v173, v191, 3, v140
    v_add_u32 v173, s4, v173
    s_waitcnt lgkmcnt(7)
    v_mfma_f32_16x16x32_bf16 v[174:177], v[32:35], v[114:117], 0
    s_waitcnt lgkmcnt(6)
    v_mfma_f32_16x16x32_bf16 v[174:177], v[32:35], v[118:121], v[174:177]
    s_waitcnt lgkmcnt(4)
    v_mfma_f32_16x16x32_bf16 v[114:117], a[216:219], v[130:133], 0
    s_waitcnt lgkmcnt(3)
    buffer_store_dwordx2 v[206:207], v20, s[52:55], 0 offen nt
    v_mfma_f32_16x16x32_bf16 v[114:117], a[220:223], v[134:137], v[114:117]
    s_waitcnt lgkmcnt(2)
    v_mfma_f32_16x16x32_bf16 v[114:117], a[224:227], v[150:153], v[114:117]
    s_waitcnt lgkmcnt(1)
    v_mul_f32 v140, 0x3baaaaab, v174
    v_mul_f32 v129, 0x3baaaaab, v175
    v_mfma_f32_16x16x32_bf16 v[114:117], a[228:231], v[154:157], v[114:117]
    s_waitcnt lgkmcnt(0)
    v_rsq_f32 v140, v140
    v_mfma_f32_16x16x32_bf16 v[114:117], a[232:235], v[158:161], v[114:117]
    v_mul_f32 v162, v140, v162
    v_mul_f32 v163, v140, v163
    v_mfma_f32_16x16x32_bf16 v[114:117], a[236:239], v[166:169], v[114:117]
    v_cvt_pk_bf16_f32 v118, v162, v163
    v_mul_f32 v164, v140, v164
    v_mfma_f32_16x16x32_bf16 v[174:177], a[240:243], v[130:133], 0
    v_mul_f32 v165, v140, v165
    v_cvt_pk_bf16_f32 v119, v164, v165
    v_mfma_f32_16x16x32_bf16 v[174:177], a[244:247], v[134:137], v[174:177]
    v_mul_f32 v198, v140, v198
    v_mul_f32 v199, v140, v199
    v_mfma_f32_16x16x32_bf16 v[174:177], a[248:251], v[150:153], v[174:177]
    v_fma_f32 v191, v114, v114, s33
    v_fmac_f32 v191, v115, v115
    v_mfma_f32_16x16x32_bf16 v[174:177], a[252:255], v[154:157], v[174:177]
    v_fmac_f32 v191, v116, v116
    v_fmac_f32 v191, v117, v117
    v_mfma_f32_16x16x32_bf16 v[174:177], v[82:85], v[158:161], v[174:177]
    v_cvt_pk_bf16_f32 v120, v198, v199
    v_mul_f32 v200, v140, v200
    v_mfma_f32_16x16x32_bf16 v[174:177], v[86:89], v[166:169], v[174:177]
    ds_read_b128 v[162:165], v126 offset:256
    v_mul_f32 v201, v140, v201
    v_mfma_f32_16x16x32_bf16 v[182:185], v[90:93], v[130:133], 0
    ds_read_b128 v[130:133], v126 offset:2304
    v_cvt_pk_bf16_f32 v121, v200, v201
    v_mfma_f32_16x16x32_bf16 v[182:185], v[94:97], v[134:137], v[182:185]
    ds_read_b128 v[134:137], v126 offset:4352
    v_mul_f32 v122, v140, v122
    v_mfma_f32_16x16x32_bf16 v[182:185], v[98:101], v[150:153], v[182:185]
    ds_read_b128 v[150:153], v126 offset:6400
    v_fmac_f32 v191, v174, v174
    v_mfma_f32_16x16x32_bf16 v[182:185], v[102:105], v[154:157], v[182:185]
    ds_read_b128 v[154:157], v126 offset:8448
    v_fmac_f32 v191, v175, v175
    v_mfma_f32_16x16x32_bf16 v[182:185], v[106:109], v[158:161], v[182:185]
    ds_read_b128 v[158:161], v126 offset:10496
    buffer_store_dwordx4 v[118:121], v15, s[56:59], 0 offen nt
    v_fmac_f32 v191, v176, v176
    v_fmac_f32 v191, v177, v177
    v_mul_f32 v123, v140, v123
    v_cvt_pk_bf16_f32 v122, v122, v123
    v_mfma_f32_16x16x32_bf16 v[182:185], v[110:113], v[166:169], v[182:185]
    v_mul_f32 v124, v140, v124
    s_waitcnt lgkmcnt(5)
    v_mfma_f32_16x16x32_bf16 v[118:121], a[216:219], v[162:165], 0
    v_mul_f32 v125, v140, v125
    v_cvt_pk_bf16_f32 v123, v124, v125
    v_mfma_f32_16x16x32_bf16 v[166:169], a[240:243], v[162:165], 0
    s_waitcnt lgkmcnt(4)
    v_rsq_f32 v129, v129
    v_mfma_f32_16x16x32_bf16 v[118:121], a[220:223], v[130:133], v[118:121]
    s_waitcnt lgkmcnt(3)
    v_fmac_f32 v191, v182, v182
    v_fmac_f32 v191, v183, v183
    v_mfma_f32_16x16x32_bf16 v[118:121], a[224:227], v[134:137], v[118:121]
    s_waitcnt lgkmcnt(2)
    v_fmac_f32 v191, v184, v184
    v_fmac_f32 v191, v185, v185
    v_mfma_f32_16x16x32_bf16 v[118:121], a[228:231], v[150:153], v[118:121]
    s_waitcnt lgkmcnt(1)
    v_cvt_pk_bf16_f32 v124, v191, v191
    v_cvt_pk_bf16_f32 v125, v191, v191
    v_mfma_f32_16x16x32_bf16 v[118:121], a[232:235], v[154:157], v[118:121]
    s_waitcnt lgkmcnt(0)
    ds_write_b64 v128, v[124:125] offset:9664
    v_mfma_f32_16x16x32_bf16 v[118:121], a[236:239], v[158:161], v[118:121]
    v_mul_f32 v142, v129, v142
    v_mul_f32 v143, v129, v143
    v_mfma_f32_16x16x32_bf16 v[166:169], a[244:247], v[130:133], v[166:169]
    v_cvt_pk_bf16_f32 v142, v142, v143
    v_mul_f32 v144, v129, v144
    v_mfma_f32_16x16x32_bf16 v[166:169], a[248:251], v[134:137], v[166:169]
    v_mul_f32 v145, v129, v145
    v_cvt_pk_bf16_f32 v143, v144, v145
    v_mfma_f32_16x16x32_bf16 v[166:169], a[252:255], v[150:153], v[166:169]
    v_fma_f32 v140, v118, v118, s33
    v_fmac_f32 v140, v119, v119
    v_mfma_f32_16x16x32_bf16 v[166:169], v[82:85], v[154:157], v[166:169]
    v_fmac_f32 v140, v120, v120
    v_fmac_f32 v140, v121, v121
    v_mfma_f32_16x16x32_bf16 v[166:169], v[86:89], v[158:161], v[166:169]
    v_mul_f32 v178, v129, v178
    v_mul_f32 v179, v129, v179
    v_mfma_f32_16x16x32_bf16 v[186:189], v[90:93], v[162:165], 0
    v_cvt_pk_bf16_f32 v144, v178, v179
    v_mul_f32 v180, v129, v180
    v_mfma_f32_16x16x32_bf16 v[186:189], v[94:97], v[130:133], v[186:189]
    buffer_store_dwordx2 v[122:123], v18, s[56:59], 0 offen nt
    v_mul_f32 v181, v129, v181
    v_fmac_f32 v140, v166, v166
    v_mfma_f32_16x16x32_bf16 v[186:189], v[98:101], v[134:137], v[186:189]
    v_fmac_f32 v140, v167, v167
    v_fmac_f32 v140, v168, v168
    v_mfma_f32_16x16x32_bf16 v[186:189], v[102:105], v[150:153], v[186:189]
    v_fmac_f32 v140, v169, v169
    v_cvt_pk_bf16_f32 v145, v180, v181
    v_mfma_f32_16x16x32_bf16 v[186:189], v[106:109], v[154:157], v[186:189]
    ds_write_b128 v254, v[142:145] offset:1536
    v_mfma_f32_16x16x32_bf16 v[186:189], v[110:113], v[158:161], v[186:189]
    v_mul_f32 v146, v129, v146
    v_mul_f32 v147, v129, v147
    v_cvt_pk_bf16_f32 v146, v146, v147
    v_mul_f32 v148, v129, v148
    v_mul_f32 v149, v129, v149
    ds_read_b128 v[122:125], v138 offset:1536
    v_cvt_pk_bf16_f32 v147, v148, v149
    ds_write_b64 v172, v[146:147] offset:2560
    v_fmac_f32 v140, v186, v186
    v_fmac_f32 v140, v187, v187
    v_fmac_f32 v140, v188, v188
    v_fmac_f32 v140, v189, v189
    v_cvt_pk_bf16_f32 v130, v140, v140
    v_cvt_pk_bf16_f32 v131, v140, v140
    ds_write_b64 v128, v[130:131] offset:15232
    ds_read_b64 v[128:129], v139 offset:2560
    s_waitcnt lgkmcnt(3)
    buffer_store_dwordx4 v[122:125], v141, s[56:59], 0 offen nt
    s_waitcnt lgkmcnt(1)
    s_barrier
    ds_read_b128 v[130:133], v127 offset:9664
    ds_read_b128 v[122:125], v127 offset:10688
    ds_read_b128 v[134:137], v127 offset:15232
    ds_read_b128 v[142:145], v127 offset:16256
    ds_read_b128 v[146:149], v171 offset:18432
    s_waitcnt lgkmcnt(5)
    buffer_store_dwordx2 v[128:129], v190, s[56:59], 0 offen nt
    s_waitcnt lgkmcnt(4)
    v_mfma_f32_16x16x32_bf16 v[150:153], v[32:35], v[130:133], 0
    s_waitcnt lgkmcnt(3)
    v_mfma_f32_16x16x32_bf16 v[150:153], v[32:35], v[122:125], v[150:153]
    s_waitcnt lgkmcnt(1)
    v_mfma_f32_16x16x32_bf16 v[122:125], v[32:35], v[134:137], 0
    s_waitcnt lgkmcnt(0)
    v_or3_b32 v146, v146, v147, v148
    v_or_b32 v146, v146, v149
    v_mfma_f32_16x16x32_bf16 v[122:125], v[32:35], v[142:145], v[122:125]
    v_cmp_gt_i32 s[46:47], 0, v146
    s_nop 0
    v_mul_f32 v171, 0x3baaaaab, v150
    v_rsq_f32 v171, v171
    s_nop 0
    v_mul_f32 v114, v171, v114
    v_mul_f32 v115, v171, v115
    v_cvt_pk_bf16_f32 v114, v114, v115
    v_mul_f32 v115, 0x3baaaaab, v122
    v_rsq_f32 v115, v115
    v_mul_f32 v116, v171, v116
    v_mul_f32 v118, v115, v118
    v_mul_f32 v119, v115, v119
    v_cvt_pk_bf16_f32 v118, v118, v119
    v_mul_f32 v120, v115, v120
    v_mul_f32 v121, v115, v121
    v_cvt_pk_bf16_f32 v119, v120, v121
    v_mul_f32 v166, v115, v166
    v_mul_f32 v167, v115, v167
    v_cvt_pk_bf16_f32 v120, v166, v167
    v_mul_f32 v168, v115, v168
    v_mul_f32 v169, v115, v169
    v_cvt_pk_bf16_f32 v121, v168, v169
    buffer_store_dwordx4 v[118:121], v255, s[12:15], 0 offen nt
    v_mul_f32 v186, v115, v186
    v_mul_f32 v187, v115, v187
    v_cvt_pk_bf16_f32 v140, v186, v187
    v_mul_f32 v188, v115, v188
    v_mul_f32 v189, v115, v189
    v_cvt_pk_bf16_f32 v141, v188, v189
    v_mul_f32 v117, v171, v117
    v_cvt_pk_bf16_f32 v115, v116, v117
    v_mul_f32 v174, v171, v174
    v_mul_f32 v175, v171, v175
    v_cvt_pk_bf16_f32 v116, v174, v175
    v_mul_f32 v176, v171, v176
    v_mul_f32 v177, v171, v177
    v_cvt_pk_bf16_f32 v117, v176, v177
    ds_write_b128 v254, v[114:117] offset:3072
    v_mul_f32 v182, v171, v182
    v_mul_f32 v183, v171, v183
    v_cvt_pk_bf16_f32 v254, v182, v183
    v_mul_f32 v184, v171, v184
    v_mul_f32 v185, v171, v185
    v_cvt_pk_bf16_f32 v255, v184, v185
    buffer_store_dwordx2 v[140:141], v173, s[12:15], 0 offen nt
    ds_read_b128 v[114:117], v138 offset:3072
    ds_write_b64 v172, v[254:255] offset:4096
    ds_read_b64 v[254:255], v139 offset:4096
    s_waitcnt lgkmcnt(2)
    buffer_store_dwordx4 v[114:117], v170, s[56:59], 0 offen nt
    s_waitcnt lgkmcnt(0)
    buffer_store_dwordx2 v[254:255], v193, s[56:59], 0 offen nt
L_end:
    s_nop 1
    s_cmp_lg_u64 s[46:47], 0
    s_cbranch_scc1 L_rerun
L_done:
    s_endpgm
L_rerun:
    s_mov_b32 s44, 0x7f000000
    s_lshr_b32 s100, s70, 20
    s_waitcnt vmcnt(0) lgkmcnt(0)
    s_barrier
    v_mbcnt_lo_u32_b32 v0, -1, 0
    v_mbcnt_hi_u32_b32 v0, -1, v0
    v_lshl_add_u32 v0, s16, 6, v0
    s_nop 7
    s_branch L_again
L_edge:
    v_mov_b32 v254, v0
    v_mov_b32 v255, 0x40000000
    s_lshl_b32 s3, s16, 4
    s_load_dwordx4 s[92:95], s[0:1], s3
    v_and_b32 v114, 63, v0
    s_bfe_u32 s3, s2, 0x50003
    s_lshl_b32 s4, s16, 3
    s_lshr_b32 s98, 0x06143a01, s4
    s_and_b32 s98, s98, 0xff
    s_mul_i32 s3, s3, s98
    s_sub_u32 s98, s98, 1
    s_lshr_b32 s4, 0x0048d800, s4
    s_and_b32 s4, s4, 0xff
    s_lshl_b32 s4, s4, 3
    s_max_u32 s4, s4, 6
    s_sub_u32 s4, s4, s98
    s_sub_u32 s4, s4, 1
    s_min_u32 s3, s3, s4
    v_min_u32 v116, s98, v114
    v_add_lshl_u32 v116, v116, s3, 7
    v_mov_b32 v117, 0
    v_lshrrev_b32 v115, 4, v114
    v_and_b32 v118, 15, v114
    s_mov_b32 s10, 100270464
    s_mov_b32 s11, 0x00020000
    s_mov_b32 s50, 36096
    s_mov_b32 s51, 0x00020000
    s_mul_i32 s3, s16, 96
    v_lshl_add_u32 v119, v114, 4, s3
    v_mul_u32_u24 v120, 171, v114
    v_lshrrev_b32 v120, 10, v120
    v_lshrrev_b32 v121, 1, v120
    v_xor_b32 v121, v121, v120
    v_and_b32 v121, 4, v121
    v_mul_u32_u24 v121, 3, v121
    v_xor_b32 v121, v121, v120
    v_mul_u32_u24 v121, 1152, v121
    v_mul_u32_u24 v126, 96, v120
    v_sub_u32 v121, v121, v126
    v_add_u32 v126, v119, v121
    v_add_u32 v121, 64, v114
    v_mul_u32_u24 v121, 171, v121
    v_lshrrev_b32 v121, 10, v121
    v_lshrrev_b32 v127, 1, v121
    v_xor_b32 v127, v127, v121
    v_and_b32 v127, 4, v127
    v_mul_u32_u24 v127, 3, v127
    v_xor_b32 v127, v127, v121
    v_mul_u32_u24 v127, 1152, v127
    v_mul_u32_u24 v128, 96, v121
    v_sub_u32 v127, v127, v128
    v_add_u32 v128, v119, v127
    v_add_u32 v127, 128, v114
    v_mul_u32_u24 v127, 171, v127
    v_lshrrev_b32 v127, 10, v127
    v_lshrrev_b32 v129, 1, v127
    v_xor_b32 v129, v129, v127
    v_and_b32 v129, 4, v129
    v_mul_u32_u24 v129, 3, v129
    v_xor_b32 v129, v129, v127
    v_mul_u32_u24 v129, 1152, v129
    v_mul_u32_u24 v130, 96, v127
    v_sub_u32 v129, v129, v130
    v_add_u32 v130, v119, v129
    s_mul_i32 s68, s16, 6144
    s_add_u32 s69, s68, 65536
    s_cmp_eq_u32 s16, 3
    s_cselect_b32 s68, 149696, s68
    s_cselect_b32 s69, 155840, s69
    s_mov_b32 s70, 193536
    s_mov_b32 s36, 100270464
    s_mov_b32 s22, 1180032
    s_mul_i32 s3, s2, 911
    s_lshr_b32 s3, s3, 16
    s_mul_i32 s35, s3, 72
    s_sub_u32 s38, s2, s35
    s_mul_i32 s3, s3, 1373568
    s_mul_i32 s35, s38, 2688
    s_add_u32 s3, s3, s35
    s_add_u32 s25, s3, 589824
    s_add_u32 s7, s3, 1769472
    s_mov_b32 s20, 31
    s_mov_b32 s21, 4204032
    s_mov_b32 s17, 20
    s_cmp_lt_u32 s2, 240
    s_cselect_b32 s45, 28, 24
    s_mov_b32 s5, 0
    s_mov_b32 s6, 0
    s_cmp_lt_u32 s2, 247
    s_cbranch_scc1 L_inner
    s_mov_b32 s20, 0
    s_mov_b32 s38, 0
    s_sub_u32 s3, s2, 247
    s_and_b32 s3, s3, 3
    s_mul_i32 s3, s3, 7
    s_add_u32 s3, s3, 3
    s_mov_b32 s35, 196224
    s_cmp_lt_u32 s2, 251
    s_cselect_b32 s35, s35, 384
    s_cselect_b32 s6, 1, 0
    s_cselect_b32 s5, 0, 1
    s_mul_i32 s25, s3, s35
    s_mul_i32 s21, s35, 28
    s_cmp_lt_u32 s2, 255
    s_cselect_b32 s17, 18, 1
    s_cselect_b32 s45, 18, 1
    s_cselect_b32 s25, s25, 0
    s_cselect_b32 s6, s6, 1
    s_add_u32 s7, s25, 1179648
L_inner:
    s_mul_i32 s3, s5, 99485568
    s_mul_i32 s35, s5, -784896
    v_mov_b32 v119, s3
    v_mov_b32 v129, s35
    s_add_u32 s7, s7, s35
    s_mul_i32 s3, s6, 194688
    s_mul_i32 s35, s6, -1536
    v_mov_b32 v131, s3
    v_mov_b32 v132, s35
    s_add_u32 s7, s7, s35
    s_bfm_b32 s34, s45, 0
    s_and_b32 s4, s2, 7
    s_sub_u32 s4, 0, s4
    v_mul_u32_u24 v133, 2731, v254
    v_bfe_u32 v142, v133, 17, 3
    v_lshrrev_b32 v133, 16, v133
    v_xor_b32 v143, v142, v254
    v_mul_u32_u24 v142, 37, v133
    v_lshrrev_b32 v142, 8, v142
    v_lshlrev_b32 v143, 4, v143
    v_mad_u32_u24 v10, v142, s70, v143
    v_mul_u32_u24 v142, 37, v133
    v_lshrrev_b32 v142, 8, v142
    v_mul_u32_u24 v144, 7, v142
    v_sub_u32 v144, v133, v144
    v_cmp_gt_u32 vcc, 4, v142
    s_nop 1
    v_cndmask_b32 v142, v129, v119, vcc
    v_cmp_gt_u32 vcc, 4, v144
    s_nop 1
    v_cndmask_b32 v144, v132, v131, vcc
    v_add3_u32 v10, v10, v142, v144
    v_mul_u32_u24 v142, s20, v133
    v_add_u32 v142, s38, v142
    v_mul_u32_u24 v144, 911, v142
    v_lshrrev_b32 v144, 16, v144
    v_mul_u32_u24 v144, s22, v144
    v_mad_u32_u24 v144, v133, s21, v144
    v_bfe_u32 v142, s34, v133, 1
    v_cmp_ne_u32 vcc, 0, v142
    v_add_u32 v142, s7, v144
    s_nop 0
    v_cndmask_b32 v142, v255, v142, vcc
    v_mul_u32_u24 v133, 384, v133
    v_sub_u32 v133, v143, v133
    v_add_u32 v142, v142, v133
    v_add_u32 v133, 256, v254
    v_mul_u32_u24 v143, 2731, v133
    v_bfe_u32 v144, v143, 17, 3
    v_lshrrev_b32 v143, 16, v143
    v_xor_b32 v133, v144, v133
    v_mul_u32_u24 v144, 37, v143
    v_lshrrev_b32 v144, 8, v144
    v_lshlrev_b32 v133, 4, v133
    v_mad_u32_u24 v11, v144, s70, v133
    v_mul_u32_u24 v144, 37, v143
    v_lshrrev_b32 v144, 8, v144
    v_mul_u32_u24 v145, 7, v144
    v_sub_u32 v145, v143, v145
    v_cmp_gt_u32 vcc, 4, v144
    s_nop 1
    v_cndmask_b32 v144, v129, v119, vcc
    v_cmp_gt_u32 vcc, 4, v145
    s_nop 1
    v_cndmask_b32 v145, v132, v131, vcc
    v_add3_u32 v11, v11, v144, v145
    v_min_u32 v144, 20, v143
    v_add_u32 v145, 12, v143
    v_lshrrev_b32 v145, 5, v145
    v_sub_u32 v146, v143, v144
    v_mad_i32_i24 v146, v145, s4, v146
    v_mul_u32_u24 v147, s20, v144
    v_add3_u32 v147, v147, v146, s38
    v_mul_u32_u24 v145, 911, v147
    v_lshrrev_b32 v145, 16, v145
    v_mul_u32_u24 v145, s22, v145
    v_mad_u32_u24 v145, v144, s21, v145
    v_bfe_u32 v147, s34, v143, 1
    v_cmp_ne_u32 vcc, 0, v147
    v_mul_i32_i24 v146, 2688, v146
    v_add3_u32 v144, v145, v146, s7
    v_cndmask_b32 v144, v255, v144, vcc
    v_mul_u32_u24 v143, 384, v143
    v_sub_u32 v143, v133, v143
    v_add_u32 v144, v144, v143
    v_add_u32 v133, 512, v254
    v_mul_u32_u24 v143, 2731, v133
    v_bfe_u32 v145, v143, 17, 3
    v_lshrrev_b32 v143, 16, v143
    v_xor_b32 v133, v145, v133
    v_mul_u32_u24 v145, 37, v143
    v_lshrrev_b32 v145, 8, v145
    v_lshlrev_b32 v133, 4, v133
    v_mad_u32_u24 v12, v145, s70, v133
    v_mul_u32_u24 v145, 37, v143
    v_lshrrev_b32 v145, 8, v145
    v_mul_u32_u24 v146, 7, v145
    v_sub_u32 v146, v143, v146
    v_cmp_gt_u32 vcc, 4, v145
    s_nop 1
    v_cndmask_b32 v145, v129, v119, vcc
    v_cmp_gt_u32 vcc, 4, v146
    s_nop 1
    v_cndmask_b32 v146, v132, v131, vcc
    v_add3_u32 v12, v12, v145, v146
    v_min_u32 v145, 20, v143
    v_add_u32 v146, 12, v143
    v_lshrrev_b32 v146, 5, v146
    v_sub_u32 v147, v143, v145
    v_mad_i32_i24 v147, v146, s4, v147
    v_mul_u32_u24 v148, s20, v145
    v_add3_u32 v148, v148, v147, s38
    v_mul_u32_u24 v146, 911, v148
    v_lshrrev_b32 v146, 16, v146
    v_mul_u32_u24 v146, s22, v146
    v_mad_u32_u24 v146, v145, s21, v146
    v_bfe_u32 v148, s34, v143, 1
    v_cmp_ne_u32 vcc, 0, v148
    v_mul_i32_i24 v147, 2688, v147
    v_add3_u32 v145, v146, v147, s7
    v_cndmask_b32 v145, v255, v145, vcc
    v_mul_u32_u24 v143, 384, v143
    v_sub_u32 v143, v133, v143
    v_add_u32 v145, v145, v143
    s_lshl_b32 s28, s16, 10
    s_add_u32 s28, s28, 20480
    s_waitcnt lgkmcnt(0)
    s_load_dword s101, s[92:93], 0
    s_load_dword s101, s[94:95], 0
    s_cmp_eq_u32 s16, 2
    s_cselect_b64 s[98:99], s[80:81], s[78:79]
    s_cmp_eq_u32 s16, 3
    s_cselect_b64 s[98:99], s[88:89], s[98:99]
    s_mov_b64 s[8:9], s[76:77]
    v_lshl_add_u64 v[116:117], s[98:99], 0, v[116:117]
    s_cmp_eq_u32 s16, 2
    s_cselect_b64 s[98:99], s[84:85], s[82:83]
    s_cmp_eq_u32 s16, 3
    s_cselect_b64 s[98:99], s[86:87], s[98:99]
    v_writelane_b32 v116, s98, 63
    v_writelane_b32 v117, s99, 63
    s_cmp_eq_u32 s16, 0
    s_cbranch_scc1 L_nowue
    global_load_dword a254, v[116:117], off
L_nowue:
    s_add_u32 m0, s28, 65536
    s_nop 0
    buffer_load_dwordx4 v142, s[8:11], 0 offen nt lds
    s_add_u32 m0, s28, 69632
    s_nop 0
    buffer_load_dwordx4 v144, s[8:11], 0 offen lds
    s_add_u32 m0, s28, 73728
    s_nop 0
    buffer_load_dwordx4 v145, s[8:11], 0 offen lds
    s_add_u32 m0, s28, 0
    s_nop 0
    buffer_load_dwordx4 v10, s[8:11], s25 offen nt lds
    s_add_u32 m0, s28, 4096
    s_nop 0
    buffer_load_dwordx4 v11, s[8:11], s25 offen nt lds
    s_mov_b64 s[48:49], s[78:79]
    s_mov_b64 s[52:53], s[80:81]
    s_mov_b64 s[60:61], s[84:85]
    s_mov_b64 s[64:65], s[86:87]
    s_mov_b64 s[56:57], s[88:89]
    s_mov_b64 s[46:47], s[82:83]
    s_load_dwordx4 s[40:43], s[0:1], 72
    s_add_u32 s48, s48, 384
    s_addc_u32 s49, s49, 0
    s_add_u32 m0, s68, 0
    v_lshlrev_b32 v133, 1, v115
    s_mov_b32 s54, 12288
    s_mov_b32 s55, 0x00020000
    s_mov_b32 s62, 64
    s_mov_b32 s63, 0x00020000
    s_mov_b32 s66, 128
    s_mov_b32 s67, 0x00020000
    s_mov_b32 s58, 676
    s_mov_b32 s59, 0x00020000
    s_mov_b32 s14, 0
    s_mov_b32 s15, 0x00020000
    s_mul_i32 s90, s16, 16
    v_mov_b32 v117, 0
    v_cmp_lt_u32 s[92:93], 7, v118
    v_mov_b32 v135, 0
    v_mov_b32 v125, 0
    v_mov_b32 v123, 0
    v_lshlrev_b32 v122, 1, v114
    v_mul_u32_u24 v124, 12, v118
    s_mul_i32 s71, s16, 192
    v_add_u32 v124, s71, v124
    v_lshlrev_b32 v134, 5, v115
    s_mul_i32 s72, s16, 9408
    s_add_u32 s72, s72, 104448
    s_mul_i32 s73, s16, 7616
    s_add_u32 s73, s73, 38912
    s_cmp_eq_u32 s16, 3
    s_cselect_b32 s73, 142080, s73
    v_lshrrev_b32 v136, 2, v118
    v_and_b32 v137, 1, v136
    v_mul_u32_u24 v137, 0x020202, v137
    v_lshl_or_b32 v137, v137, 8, v137
    v_add_u32 v137, 0x05040100, v137
    v_and_b32 v138, 3, v118
    v_lshrrev_b32 v116, 1, v118
    v_xor_b32 v116, v116, v115
    v_mul_u32_u24 v139, 384, v118
    v_lshl_add_u32 v0, v116, 4, v139
    v_xor_b32 v1, 64, v0
    v_and_b32 v116, 2, v115
    v_add_u32 v116, v116, v115
    v_lshl_add_u32 v116, v116, 2, v136
    v_mul_u32_u24 v116, 96, v116
    v_lshl_add_u32 v116, v138, 3, v116
    v_add_u32 v141, s68, v116
    v_add_u32 v139, s69, v116
    v_add_u32 v140, s72, v116
    v_add_u32 v142, s73, v116
    v_mov_b32 v28, 0x3f803f80
    v_mov_b32 v29, 0x3f803f80
    v_mov_b32 v30, 0x3f803f80
    v_mov_b32 v31, 0x3f803f80
    v_mul_u32_u24 v143, 768, v115
    v_add_u32 v143, v124, v143
    v_add_u32 v143, 98304, v143
    s_mov_b32 s76, 0x3f80
    v_and_b32 v116, 1, v118
    v_lshlrev_b32 v116, 4, v116
    v_lshlrev_b32 v144, v116, s76
    v_mov_b32 v145, 0x3c003c00
    v_mov_b32 v44, 1.0
    v_lshlrev_b32 v146, 4, v115
    s_mov_b32 s19, s38
    s_mov_b32 s23, s25
    s_mov_b32 s26, 0
    s_mov_b32 s27, 0
    s_mov_b32 s18, 0
    s_add_u32 s19, s19, s20
    s_add_u32 s23, s23, s21
    s_cmp_ge_u32 s19, 72
    s_cselect_b32 s34, 72, 0
    s_cselect_b32 s35, s22, 0
    s_sub_u32 s19, s19, s34
    s_add_u32 s23, s23, s35
    s_mov_b32 s24, s23
    s_add_u32 s19, s19, s20
    s_add_u32 s23, s23, s21
    s_cmp_ge_u32 s19, 72
    s_cselect_b32 s34, 72, 0
    s_cselect_b32 s35, s22, 0
    s_sub_u32 s19, s19, s34
    s_add_u32 s23, s23, s35
    s_mul_i32 s79, s16, 64
    v_lshl_add_u32 v147, v115, 4, s79
    s_mul_i32 s80, s16, 32
    s_add_u32 s80, s80, 256
    v_lshl_add_u32 v149, v115, 3, s80
    v_add_u32 v151, 0, v118
    v_mul_u32_u24 v148, 37, v151
    v_mul_u32_u24 v150, 384, v151
    v_lshrrev_b32 v148, 8, v148
    v_mad_u32_u24 v150, v148, s70, v150
    v_add_u32 v15, v150, v147
    v_add_u32 v18, v150, v149
    v_mul_u32_u24 v150, 37, v151
    v_lshrrev_b32 v150, 8, v150
    v_mul_u32_u24 v153, 7, v150
    v_sub_u32 v153, v151, v153
    v_add_u32 v152, 16, v118
    v_mul_u32_u24 v155, 37, v152
    v_mul_u32_u24 v154, 384, v152
    v_lshrrev_b32 v155, 8, v155
    v_mad_u32_u24 v154, v155, s70, v154
    v_add_u32 v16, v154, v147
    v_add_u32 v19, v154, v149
    v_mul_u32_u24 v154, 37, v152
    v_lshrrev_b32 v154, 8, v154
    v_mul_u32_u24 v157, 7, v154
    v_sub_u32 v157, v152, v157
    v_add_u32 v159, 32, v118
    v_mul_u32_u24 v158, 37, v159
    v_mul_u32_u24 v156, 384, v159
    v_lshrrev_b32 v158, 8, v158
    v_mad_u32_u24 v156, v158, s70, v156
    v_add_u32 v17, v156, v147
    v_add_u32 v20, v156, v149
    v_mul_u32_u24 v156, 37, v159
    v_lshrrev_b32 v156, 8, v156
    v_mul_u32_u24 v147, 7, v156
    v_sub_u32 v147, v159, v147
    s_mul_i32 s81, s16, 768
    s_add_u32 s81, s81, 98304
    v_mul_u32_u24 v148, 24, v148
    v_lshl_add_u32 v148, v151, 2, v148
    v_add_u32 v22, s81, v148
    v_sub_u32 v23, s81, v148
    v_sub_u32 v148, v22, v146
    v_mul_u32_u24 v155, 24, v155
    v_lshl_add_u32 v155, v152, 2, v155
    v_add_u32 v24, s81, v155
    v_sub_u32 v25, s81, v155
    v_sub_u32 v149, v24, v146
    v_mul_u32_u24 v155, 24, v158
    v_lshl_add_u32 v155, v159, 2, v155
    v_add_u32 v26, s81, v155
    v_sub_u32 v27, s81, v155
    v_sub_u32 v155, v26, v146
    v_mul_u32_u24 v158, 148, v115
    s_mov_b32 s82, -24
    v_add_u32 v160, 0, v158
    v_lshrrev_b32 v160, 8, v160
    v_mad_i32_i24 v46, v160, s82, v148
    v_mad_i32_i24 v58, v160, s82, v149
    v_mad_i32_i24 v70, v160, s82, v155
    v_add_u32 v160, 37, v158
    v_lshrrev_b32 v160, 8, v160
    v_mad_i32_i24 v47, v160, s82, v148
    v_mad_i32_i24 v59, v160, s82, v149
    v_mad_i32_i24 v71, v160, s82, v155
    v_add_u32 v160, 74, v158
    v_lshrrev_b32 v160, 8, v160
    v_mad_i32_i24 v48, v160, s82, v148
    v_mad_i32_i24 v60, v160, s82, v149
    v_mad_i32_i24 v72, v160, s82, v155
    v_add_u32 v160, 111, v158
    v_lshrrev_b32 v160, 8, v160
    v_mad_i32_i24 v49, v160, s82, v148
    v_mad_i32_i24 v61, v160, s82, v149
    v_mad_i32_i24 v73, v160, s82, v155
    v_add_u32 v160, 592, v158
    v_lshrrev_b32 v160, 8, v160
    v_mad_i32_i24 v50, v160, s82, v148
    v_mad_i32_i24 v62, v160, s82, v149
    v_mad_i32_i24 v74, v160, s82, v155
    v_add_u32 v160, 629, v158
    v_lshrrev_b32 v160, 8, v160
    v_mad_i32_i24 v51, v160, s82, v148
    v_mad_i32_i24 v63, v160, s82, v149
    v_mad_i32_i24 v75, v160, s82, v155
    v_add_u32 v160, 666, v158
    v_lshrrev_b32 v160, 8, v160
    v_mad_i32_i24 v52, v160, s82, v148
    v_mad_i32_i24 v64, v160, s82, v149
    v_mad_i32_i24 v76, v160, s82, v155
    v_add_u32 v160, 703, v158
    v_lshrrev_b32 v160, 8, v160
    v_mad_i32_i24 v53, v160, s82, v148
    v_mad_i32_i24 v65, v160, s82, v149
    v_mad_i32_i24 v77, v160, s82, v155
    v_add_u32 v160, 1184, v158
    v_lshrrev_b32 v160, 8, v160
    v_mad_i32_i24 v54, v160, s82, v148
    v_mad_i32_i24 v66, v160, s82, v149
    v_mad_i32_i24 v78, v160, s82, v155
    v_add_u32 v160, 1221, v158
    v_lshrrev_b32 v160, 8, v160
    v_mad_i32_i24 v55, v160, s82, v148
    v_mad_i32_i24 v67, v160, s82, v149
    v_mad_i32_i24 v79, v160, s82, v155
    v_add_u32 v160, 1258, v158
    v_lshrrev_b32 v160, 8, v160
    v_mad_i32_i24 v56, v160, s82, v148
    v_mad_i32_i24 v68, v160, s82, v149
    v_mad_i32_i24 v80, v160, s82, v155
    v_add_u32 v158, 1295, v158
    v_lshrrev_b32 v158, 8, v158
    v_mad_i32_i24 v57, v158, s82, v148
    v_mad_i32_i24 v69, v158, s82, v149
    v_mad_i32_i24 v81, v158, s82, v155
    v_mov_b32 v155, s81
    v_lshlrev_b32 v148, 4, v114
    v_xor_b32 v2, 65536, v148
    v_lshl_add_u32 v3, s16, 10, v148
    s_lshr_b32 s83, s16, 1
    s_and_b32 s84, s16, 1
    s_lshl_b32 s84, s84, 3
    s_lshl_b32 s85, s83, 10
    s_add_u32 s85, s85, s84
    v_add_u32 v4, s85, v148
    s_lshl_b32 s83, s83, 11
    s_add_u32 s83, s83, s84
    s_add_u32 s83, s83, 157888
    s_mul_i32 s86, s16, 2048
    s_add_u32 s86, s86, 149696
    v_lshl_add_u32 v160, v115, 3, s86
    v_mov_b32 v148, s83
    v_mov_b32 v149, 163264
    v_mul_u32_u24 v158, 80, v115
    v_add3_u32 v5, v158, v116, s72
    v_lshl_add_u32 v6, v118, 2, s73
    s_mul_i32 s87, s16, 128
    s_add_u32 s87, s87, 61760
    s_mov_b32 s32, 0x2a8cbccc
    s_mov_b32 s33, 0x38fba882
    s_add_u32 s75, s28, 16384
    s_cmp_lt_u32 s16, 2
    s_cselect_b32 s29, s75, 161984
    s_cselect_b32 s30, 65536, 0
    s_xor_b32 s74, s29, s30
    s_lshl_b32 s94, s5, 1
    s_or_b32 s94, s94, s6
    s_mul_i32 s77, s16, 64
    s_mul_i32 s78, s16, 32
    s_add_u32 s78, s78, 192
    s_add_u32 s34, s18, 2
    s_mov_b32 s27, s26
    s_mov_b32 s26, s25
    s_add_u32 s19, s19, s20
    s_mov_b32 s18, 1
    s_mov_b32 s71, 1
    buffer_load_dwordx4 v126, s[48:51], 0 offen lds
    v_add_u32 v9, s87, v146
    v_lshrrev_b32 v116, 1, v115
    v_mul_u32_u24 v116, 48, v116
    buffer_load_dwordx4 v128, s[48:51], 0 offen offset:1024 lds
    v_lshl_add_u32 v116, v115, 3, v116
    v_lshl_add_u32 v116, v136, 4, v116
    v_lshl_add_u32 v116, v138, 1, v116
    buffer_load_dwordx4 v130, s[48:51], 0 offen offset:2048 lds
    s_add_u32 s48, s48, 36864
    s_addc_u32 s49, s49, 0
    s_add_u32 m0, s68, 3072
    v_add_u32 v8, s87, v116
    buffer_load_dwordx4 v126, s[48:51], 0 offen lds
    v_mov_b32 v37, 0
    v_mov_b32 v38, 0
    v_mov_b32 v39, 0
    buffer_load_dwordx4 v128, s[48:51], 0 offen offset:1024 lds
    v_add_u32 v161, 86016, v0
    v_add_u32 v174, 86016, v1
    v_lshlrev_b32 v162, 4, v118
    buffer_load_dwordx4 v130, s[48:51], 0 offen offset:2048 lds
    s_add_u32 s48, s48, 36864
    s_addc_u32 s49, s49, 0
    s_add_u32 m0, s69, 0
    buffer_load_ushort v116, v122, s[60:63], 0 offen
    s_mov_b64 s[60:61], s[8:9]
    s_sub_u32 s62, s45, s17
    s_sub_u32 s45, s17, 1
    buffer_load_dwordx3 v[166:168], v124, s[56:59], 0 offen
    v_add_u32 v162, 161984, v162
    buffer_load_dwordx4 v[170:173], v134, s[64:67], 0 offen
    v_mul_u32_u24 v175, 336, v118
    v_add3_u32 v175, v175, v158, s72
    v_mul_u32_u24 v158, 272, v118
    v_add3_u32 v158, v158, v146, s73
    v_mul_u32_u24 v177, 1088, v115
    v_add_u32 v177, v177, v6
    v_add_u32 v176, 5376, v175
    buffer_load_dwordx4 v[186:189], v134, s[64:67], 0 offen offset:16
    v_add_u32 v179, 4352, v158
    v_add_u32 v178, 4352, v177
    v_cmp_gt_u32 s[88:89], 16, v114
    v_mov_b32 v180, 0xf149f2ca
    v_add_u32 v134, 768, v254
    v_mul_u32_u24 v169, 2731, v134
    v_bfe_u32 v181, v169, 17, 3
    v_lshrrev_b32 v169, 16, v169
    v_xor_b32 v134, v181, v134
    v_mul_u32_u24 v181, 37, v169
    v_lshrrev_b32 v181, 8, v181
    v_lshlrev_b32 v134, 4, v134
    v_mad_u32_u24 v13, v181, s70, v134
    v_mul_u32_u24 v181, 37, v169
    v_lshrrev_b32 v181, 8, v181
    v_mul_u32_u24 v134, 7, v181
    v_sub_u32 v134, v169, v134
    v_cmp_gt_u32 vcc, 4, v181
    v_add_u32 v169, 1024, v254
    v_mul_u32_u24 v254, 2731, v169
    v_cndmask_b32 v181, v129, v119, vcc
    v_cmp_gt_u32 vcc, 4, v134
    v_bfe_u32 v122, v254, 17, 3
    v_lshrrev_b32 v254, 16, v254
    v_cndmask_b32 v134, v132, v131, vcc
    v_add3_u32 v13, v13, v181, v134
    v_xor_b32 v169, v122, v169
    v_mul_u32_u24 v122, 37, v254
    v_lshrrev_b32 v122, 8, v122
    v_lshlrev_b32 v169, 4, v169
    v_mad_u32_u24 v14, v122, s70, v169
    v_mul_u32_u24 v169, 37, v254
    v_lshrrev_b32 v169, 8, v169
    v_mul_u32_u24 v134, 7, v169
    v_sub_u32 v134, v254, v134
    v_cmp_gt_u32 vcc, 4, v169
    v_mov_b32 v163, 0xc31044fe
    v_mul_u32_u24 v181, 37, v151
    v_cndmask_b32 v169, v129, v119, vcc
    v_cmp_gt_u32 vcc, 4, v134
    v_lshrrev_b32 v181, 8, v181
    v_mul_u32_u24 v122, 7, v181
    v_cndmask_b32 v134, v132, v131, vcc
    v_add3_u32 v14, v14, v169, v134
    v_cmp_gt_u32 vcc, 48, v254
    v_sub_u32 v122, v151, v122
    v_lshrrev_b32 v181, 2, v181
    v_cndmask_b32 v14, v255, v14, vcc
    v_cmp_gt_u32 vcc, 2, v138
    v_lshrrev_b32 v122, 2, v122
    v_and_b32 v181, s5, v181
    v_cndmask_b32 v32, 0, v144, vcc
    v_cndmask_b32 v33, v144, 0, vcc
    v_cndmask_b32 v34, 0, v144, vcc
    v_cndmask_b32 v35, v144, 0, vcc
    v_cmp_eq_u32 vcc, 0, v138
    v_and_b32 v122, s6, v122
    v_lshl_or_b32 v181, v181, 1, v122
    v_cndmask_b32 v40, 0, v145, vcc
    v_cmp_eq_u32 vcc, 1, v138
    v_mul_u32_u24 v254, 37, v152
    v_lshrrev_b32 v254, 8, v254
    v_cndmask_b32 v41, 0, v145, vcc
    v_cmp_eq_u32 vcc, 2, v138
    v_mul_u32_u24 v134, 7, v254
    v_sub_u32 v134, v152, v134
    s_bfm_b32 s70, s17, 0
    s_waitcnt vmcnt(9)
    s_barrier
    global_load_ushort v133, v133, s[46:47]
    v_cndmask_b32 v42, 0, v145, vcc
    v_cmp_eq_u32 vcc, 3, v138
    v_lshrrev_b32 v254, 2, v254
    v_lshrrev_b32 v134, 2, v134
    v_cndmask_b32 v43, 0, v145, vcc
    v_cmp_eq_u32 vcc, v115, v136
    v_and_b32 v254, s5, v254
    v_and_b32 v134, s6, v134
    v_cndmask_b32 v144, 0, v32, vcc
    v_cndmask_b32 v145, 0, v33, vcc
    v_lshl_or_b32 v254, v254, 1, v134
    buffer_load_dwordx4 v126, s[48:51], 0 offen lds
    v_mul_u32_u24 v255, 37, v159
    v_lshrrev_b32 v255, 8, v255
    v_mul_u32_u24 v134, 7, v255
    v_sub_u32 v134, v159, v134
    v_lshrrev_b32 v255, 2, v255
    v_lshrrev_b32 v134, 2, v134
    v_and_b32 v255, s5, v255
    v_and_b32 v134, s6, v134
    v_lshl_or_b32 v255, v255, 1, v134
    v_mul_u32_u24 v134, 6, v120
    v_sub_u32 v159, v114, v134
    v_mul_u32_u24 v134, 384, v120
    v_lshl_add_u32 v134, v159, 4, v134
    v_add_u32 v120, s78, v134
    v_add_u32 v134, s77, v134
    buffer_load_dwordx4 v128, s[48:51], 0 offen offset:1024 lds
    s_waitcnt vmcnt(10)
    ds_read_b64_tr_b16 a[72:73], v141 offset:0
    ds_read_b64_tr_b16 a[74:75], v141 offset:768
    ds_read_b64_tr_b16 a[96:97], v141 offset:32
    ds_read_b64_tr_b16 a[98:99], v141 offset:800
    ds_read_b64_tr_b16 a[120:121], v141 offset:64
    ds_read_b64_tr_b16 a[122:123], v141 offset:832
    v_cmp_gt_i32 vcc, 4, v159
    v_mul_u32_u24 v159, 6, v121
    v_sub_u32 v169, v114, v159
    v_cndmask_b32 v120, v120, v134, vcc
    v_mul_u32_u24 v159, 384, v121
    v_lshl_add_u32 v159, v169, 4, v159
    v_add_u32 v134, s78, v159
    v_add_u32 v159, s77, v159
    buffer_load_dwordx4 v130, s[48:51], 0 offen offset:2048 lds
    s_add_u32 s48, s48, 36864
    s_addc_u32 s49, s49, 0
    s_add_u32 m0, s69, 3072
    v_cmp_gt_i32 vcc, -60, v169
    v_mul_u32_u24 v121, 6, v127
    v_sub_u32 v114, v114, v121
    v_cndmask_b32 v159, v134, v159, vcc
    v_mul_u32_u24 v121, 384, v127
    v_lshl_add_u32 v121, v114, 4, v121
    v_add_u32 v127, s78, v121
    v_add_u32 v121, s77, v121
    v_cmp_gt_i32 vcc, -124, v114
    v_mul_u32_u24 v114, 96, v118
    v_add3_u32 v182, v114, v146, s68
    v_cndmask_b32 v121, v127, v121, vcc
    s_and_b32 s77, s2, 0xf8
    s_add_u32 s77, s77, 4940
    s_mul_i32 s78, s77, 58255
    s_lshr_b32 s78, s78, 22
    buffer_load_dwordx4 v126, s[48:51], 0 offen lds
    v_cmp_gt_u32 vcc, 4, v150
    v_lshl_add_u32 v127, v115, 3, v114
    v_add3_u32 v127, v127, 64, s68
    v_cndmask_b32 v150, v129, v119, vcc
    v_cmp_gt_u32 vcc, 4, v153
    v_add3_u32 v183, v114, v146, s69
    v_lshl_add_u32 v184, v115, 3, v114
    v_cndmask_b32 v153, v132, v131, vcc
    v_add3_u32 v15, v15, v150, v153
    s_waitcnt vmcnt(9)
    ds_read_b64_tr_b16 a[76:77], v141 offset:3072
    ds_read_b64_tr_b16 a[78:79], v141 offset:3840
    s_waitcnt vmcnt(7)
    ds_read_b64_tr_b16 a[100:101], v141 offset:3104
    s_waitcnt vmcnt(6)
    ds_read_b64_tr_b16 a[102:103], v141 offset:3872
    s_waitcnt vmcnt(5)
    buffer_load_dwordx4 v128, s[48:51], 0 offen offset:1024 lds
    ds_read_b64_tr_b16 a[124:125], v141 offset:3136
    ds_read_b64_tr_b16 a[126:127], v141 offset:3904
    v_cndmask_b32 v170, v170, v171, s[92:93]
    v_cndmask_b32 v172, v172, v173, s[92:93]
    v_perm_b32 v164, v172, v170, v137
    v_cndmask_b32 v186, v186, v187, s[92:93]
    v_cndmask_b32 v188, v188, v189, s[92:93]
    v_perm_b32 v165, v188, v186, v137
    v_bfe_u32 v134, v166, v146, 16
    v_bfe_u32 v124, v167, v146, 16
    v_bfe_u32 v122, v168, v146, 16
    v_mfma_f32_16x16x16_bf16 v[170:173], v[116:117], v[134:135], 0
    v_add3_u32 v18, v18, v150, v153
    v_cmp_gt_u32 vcc, 4, v154
    v_add3_u32 v184, v184, 64, s69
    v_mfma_f32_16x16x16_bf16 v[150:153], v[116:117], v[124:125], 0
    v_cndmask_b32 v154, v129, v119, vcc
    v_cmp_gt_u32 vcc, 4, v157
    v_mfma_f32_16x16x16_bf16 v[166:169], v[116:117], v[122:123], 0
    buffer_load_dwordx4 v130, s[48:51], 0 offen offset:2048 lds
    s_add_u32 s48, s48, 36864
    s_addc_u32 s49, s49, 0
    s_add_u32 m0, s72, 0
    v_max_f32 v170, 0, v170
    v_max_f32 v171, 0, v171
    v_max_f32 v172, 0, v172
    v_max_f32 v173, 0, v173
    v_cvt_pk_bf16_f32 v116, v170, v171
    v_cvt_pk_bf16_f32 v117, v172, v173
    v_max_f32 v150, 0, v150
    v_max_f32 v151, 0, v151
    s_waitcnt vmcnt(6)
    v_mfma_f32_16x16x16_bf16 v[122:125], v[164:165], v[116:117], 0
    v_lshlrev_b32 v133, 16, v133
    buffer_load_dwordx4 v126, s[48:51], 0 offen lds
    v_max_f32 v133, 0xc2c80000, v133
    v_min_f32 v133, 0x40930000, v133
    v_mul_f32 v133, 0x3fb8aa3b, v133
    v_exp_f32 v133, v133
    v_max_f32 v152, 0, v152
    v_cvt_pk_bf16_f32 v133, v133, v133
    v_and_b32 v133, 0xffff0000, v133
    v_mul_f32 v133, 0x3fb8aa3b, v133
    v_mul_f32 v146, 0xbea8f5c3, v133
    v_add_f32 v146, 0xc138aa3b, v146
    v_readlane_b32 s31, v133, s90
    v_cvt_pk_bf16_f32 v122, v122, v122
    v_and_b32 v122, 0xffff0000, v122
    v_mul_f32 v122, 0xbfb8aa3b, v122
    buffer_load_dwordx4 v128, s[48:51], 0 offen offset:1024 lds
    v_exp_f32 v122, v122
    v_max_f32 v153, 0, v153
    v_add_f32 v122, 1.0, v122
    v_rcp_f32 v122, v122
    v_cvt_pk_bf16_f32 v150, v150, v151
    v_cvt_pk_bf16_f32 v122, v122, v122
    v_and_b32 v122, 0xffff0000, v122
    v_fmamk_f32 v122, v122, 0x41b8aa3b, v146
    ds_write_b32 v143, v122 offset:0
    v_cvt_pk_bf16_f32 v151, v152, v153
    buffer_load_dwordx4 v130, s[48:51], 0 offen offset:2048 lds
    s_add_u32 s48, s48, 36864
    v_mfma_f32_16x16x16_bf16 v[122:125], v[164:165], v[150:151], 0
    s_addc_u32 s49, s49, 0
    s_add_u32 m0, s72, 3072
    v_max_f32 v166, 0, v166
    v_max_f32 v167, 0, v167
    v_max_f32 v168, 0, v168
    v_max_f32 v169, 0, v169
    v_cvt_pk_bf16_f32 v166, v166, v167
    s_waitcnt vmcnt(6)
    s_mov_b32 s72, 2
    ds_read_b64_tr_b16 a[80:81], v139 offset:0
    ds_read_b64_tr_b16 a[82:83], v139 offset:768
    ds_read_b64_tr_b16 a[104:105], v139 offset:32
    ds_read_b64_tr_b16 a[106:107], v139 offset:800
    ds_read_b64_tr_b16 a[128:129], v139 offset:64
    ds_read_b64_tr_b16 a[130:131], v139 offset:832
    buffer_load_dwordx4 v126, s[48:51], 0 offen lds
    v_cvt_pk_bf16_f32 v122, v122, v122
    v_and_b32 v122, 0xffff0000, v122
    v_mul_f32 v122, 0xbfb8aa3b, v122
    v_exp_f32 v122, v122
    v_cvt_pk_bf16_f32 v167, v168, v169
    v_add_f32 v122, 1.0, v122
    v_rcp_f32 v122, v122
    v_mfma_f32_16x16x16_bf16 v[150:153], v[164:165], v[166:167], 0
    v_cvt_pk_bf16_f32 v122, v122, v122
    v_and_b32 v122, 0xffff0000, v122
    v_fmamk_f32 v122, v122, 0x41b8aa3b, v146
    ds_write_b32 v143, v122 offset:4
    buffer_load_dwordx4 v128, s[48:51], 0 offen offset:1024 lds
    v_cndmask_b32 v157, v132, v131, vcc
    v_add3_u32 v16, v16, v154, v157
    v_add3_u32 v19, v19, v154, v157
    v_cvt_pk_bf16_f32 v150, v150, v150
    v_and_b32 v150, 0xffff0000, v150
    v_mul_f32 v150, 0xbfb8aa3b, v150
    v_exp_f32 v150, v150
    v_cmp_gt_u32 vcc, 4, v156
    v_add_f32 v150, 1.0, v150
    v_rcp_f32 v150, v150
    v_cndmask_b32 v156, v129, v119, vcc
    v_cvt_pk_bf16_f32 v150, v150, v150
    v_and_b32 v150, 0xffff0000, v150
    buffer_load_dwordx4 v130, s[48:51], 0 offen offset:2048 lds
    s_sub_u32 s48, s48, 184704
    s_subb_u32 s49, s49, 0
    s_add_u32 m0, s73, 0
    v_fmamk_f32 v150, v150, 0x41b8aa3b, v146
    ds_write_b32 v143, v150 offset:8
    v_cmp_gt_u32 vcc, 4, v147
    s_nop 0
    s_nop 0
    v_cndmask_b32 v147, v132, v131, vcc
    v_add3_u32 v17, v17, v156, v147
    v_add3_u32 v20, v20, v156, v147
    v_cmp_gt_u32 vcc, 2, v115
    buffer_load_dwordx4 v126, s[48:51], 0 offen lds
    s_waitcnt vmcnt(7)
    ds_read_b64_tr_b16 a[84:85], v139 offset:3072
    ds_read_b64_tr_b16 a[86:87], v139 offset:3840
    ds_read_b64_tr_b16 a[108:109], v139 offset:3104
    ds_read_b64_tr_b16 a[110:111], v139 offset:3872
    ds_read_b64_tr_b16 a[132:133], v139 offset:3136
    ds_read_b64_tr_b16 a[134:135], v139 offset:3904
    v_cndmask_b32 v160, v148, v160, vcc
    v_lshl_add_u32 v160, v136, 9, v160
    v_lshl_add_u32 v160, v138, 1, v160
    v_cmp_gt_u32 vcc, 3, v115
    s_nop 0
    s_nop 0
    v_cndmask_b32 v7, v149, v160, vcc
    v_cmp_gt_u32 vcc, 12, v118
    buffer_load_dwordx4 v128, s[48:51], 0 offen offset:1024 lds
    s_waitcnt lgkmcnt(6)
    s_barrier
    ds_read_b32 v22, v22 offset:0
    ds_read_b32 v23, v23 offset:672
    ds_read_b32 v24, v24 offset:0
    ds_read_b32 v25, v25 offset:672
    ds_read_b32 v26, v26 offset:0
    ds_read_b32 v27, v27 offset:672
    ds_read_b32 v46, v46 offset:336
    ds_read_b32 v58, v58 offset:336
    v_cndmask_b32 v176, v162, v176, vcc
    v_cndmask_b32 v179, v162, v179, vcc
    v_cmp_gt_u32 vcc, 3, v115
    ds_read_b32 v70, v70 offset:336
    ds_read_b32 v47, v47 offset:332
    buffer_load_dwordx4 v130, s[48:51], 0 offen offset:2048 lds
    ds_read_b32 v59, v59 offset:332
    ds_read_b32 v71, v71 offset:332
    ds_read_b32 v48, v48 offset:328
    ds_read_b32 v60, v60 offset:328
    s_add_u32 s48, s48, 36864
    ds_read_b32 v72, v72 offset:328
    s_addc_u32 s49, s49, 0
    ds_read_b32 v49, v49 offset:324
    s_add_u32 m0, s73, 3072
    ds_read_b32 v61, v61 offset:324
    v_cndmask_b32 v178, v162, v178, vcc
    s_mov_b32 s73, 3
    ds_read_b32 v73, v73 offset:324
    ds_read_b32 v50, v50 offset:272
    ds_read_b32 v62, v62 offset:272
    s_waitcnt vmcnt(6)
    buffer_load_dwordx4 v126, s[48:51], 0 offen lds
    ds_read_b64_tr_b16 a[88:89], v140 offset:0
    ds_read_b64_tr_b16 a[90:91], v140 offset:768
    ds_read_b64_tr_b16 a[112:113], v140 offset:32
    ds_read_b64_tr_b16 a[114:115], v140 offset:800
    ds_read_b64_tr_b16 a[136:137], v140 offset:64
    ds_read_b64_tr_b16 a[138:139], v140 offset:832
    ds_read_b32 v74, v74 offset:272
    ds_read_b32 v51, v51 offset:268
    ds_read_b32 v63, v63 offset:268
    buffer_load_dwordx4 v128, s[48:51], 0 offen offset:1024 lds
    ds_read_b32 v75, v75 offset:268
    ds_read_b32 v52, v52 offset:264
    ds_read_b32 v64, v64 offset:264
    ds_read_b32 v76, v76 offset:264
    ds_read_b32 v53, v53 offset:260
    ds_read_b32 v65, v65 offset:260
    ds_read_b32 v77, v77 offset:260
    ds_read_b32 v54, v54 offset:208
    ds_read_b32 v66, v66 offset:208
    buffer_load_dwordx4 v130, s[48:51], 0 offen offset:2048 lds
    ds_read_b32 v78, v78 offset:208
    ds_read_b32 v55, v55 offset:204
    s_add_u32 s48, s48, 36864
    ds_read_b32 v67, v67 offset:204
    s_addc_u32 s49, s49, 0
    ds_read_b32 v79, v79 offset:204
    s_add_u32 m0, s68, 0
    ds_read_b32 v56, v56 offset:200
    ds_read_b32 v68, v68 offset:200
    ds_read_b32 v80, v80 offset:200
    ds_read_b32 v57, v57 offset:196
    ds_read_b32 v69, v69 offset:196
    s_waitcnt vmcnt(6)
    buffer_load_dwordx4 v126, s[48:51], 0 offen lds
    ds_read_b64_tr_b16 a[92:93], v140 offset:3072
    ds_read_b64_tr_b16 a[94:95], v140 offset:3840
    ds_read_b64_tr_b16 a[116:117], v140 offset:3104
    ds_read_b64_tr_b16 a[118:119], v140 offset:3872
    ds_read_b64_tr_b16 a[140:141], v140 offset:3136
    ds_read_b64_tr_b16 a[142:143], v140 offset:3904
    ds_read_b32 v81, v81 offset:196
    ds_read_b32 v155, v155 offset:336
    v_cmp_ne_u32 vcc, s94, v181
    buffer_load_dwordx4 v128, s[48:51], 0 offen offset:1024 lds
    v_lshl_add_u32 v143, v115, 2, 0
    v_cndmask_b32 v129, 0, v163, vcc
    s_waitcnt lgkmcnt(11)
    v_add_f32 v22, v22, v129
    v_cmp_ne_u32 vcc, s94, v181
    v_mul_u32_u24 v129, 37, v143
    v_lshrrev_b32 v129, 8, v129
    v_cndmask_b32 v160, 0, v163, vcc
    v_add_f32 v23, v23, v160
    v_cmp_ne_u32 vcc, s94, v254
    v_mul_u32_u24 v160, 7, v129
    v_sub_u32 v160, v143, v160
    v_cndmask_b32 v143, 0, v163, vcc
    v_add_f32 v24, v24, v143
    v_cmp_ne_u32 vcc, s94, v254
    buffer_load_dwordx4 v130, s[48:51], 0 offen offset:2048 lds
    s_add_u32 s48, s48, 36864
    s_addc_u32 s49, s49, 0
    s_add_u32 m0, s68, 3072
    v_cndmask_b32 v143, 0, v163, vcc
    s_waitcnt lgkmcnt(0)
    v_readfirstlane_b32 s39, v155
    v_add_f32 v25, v25, v143
    v_cmp_ne_u32 vcc, s94, v255
    v_lshrrev_b32 v129, 2, v129
    v_lshrrev_b32 v160, 2, v160
    v_cndmask_b32 v143, 0, v163, vcc
    v_add_f32 v26, v26, v143
    v_cmp_ne_u32 vcc, s94, v255
    v_and_b32 v129, s5, v129
    buffer_load_dwordx4 v126, s[48:51], 0 offen lds
    s_waitcnt vmcnt(7)
    ds_read_b64_tr_b16 a[0:1], v142 offset:0
    ds_read_b64_tr_b16 a[2:3], v142 offset:768
    ds_read_b64_tr_b16 a[24:25], v142 offset:32
    ds_read_b64_tr_b16 a[26:27], v142 offset:800
    ds_read_b64_tr_b16 a[48:49], v142 offset:64
    ds_read_b64_tr_b16 a[50:51], v142 offset:832
    v_cndmask_b32 v143, 0, v163, vcc
    v_add_f32 v27, v27, v143
    v_and_b32 v160, s6, v160
    v_lshl_or_b32 v129, v129, 1, v160
    v_cmp_ne_u32 vcc, v129, v181
    v_lshl_add_u32 v185, v115, 2, 1
    v_mul_u32_u24 v160, 37, v185
    v_cndmask_b32 v143, 0, v163, vcc
    buffer_load_dwordx4 v128, s[48:51], 0 offen offset:1024 lds
    v_add_f32 v46, v46, v143
    v_cmp_ne_u32 vcc, v129, v254
    v_lshrrev_b32 v160, 8, v160
    v_mul_u32_u24 v118, 7, v160
    v_cndmask_b32 v143, 0, v163, vcc
    v_add_f32 v58, v58, v143
    v_cmp_ne_u32 vcc, v129, v255
    v_sub_u32 v118, v185, v118
    v_lshrrev_b32 v160, 2, v160
    v_cndmask_b32 v119, 0, v163, vcc
    v_add_f32 v70, v70, v119
    v_lshrrev_b32 v118, 2, v118
    v_and_b32 v160, s5, v160
    v_and_b32 v118, s6, v118
    v_lshl_or_b32 v160, v160, 1, v118
    buffer_load_dwordx4 v130, s[48:51], 0 offen offset:2048 lds
    s_add_u32 s48, s48, 36864
    s_addc_u32 s49, s49, 0
    s_add_u32 m0, s69, 0
    v_cmp_ne_u32 vcc, v160, v181
    v_lshl_add_u32 v129, v115, 2, 2
    v_mul_u32_u24 v185, 37, v129
    v_cndmask_b32 v143, 0, v163, vcc
    v_add_f32 v47, v47, v143
    v_cmp_ne_u32 vcc, v160, v254
    v_lshrrev_b32 v185, 8, v185
    v_mul_u32_u24 v143, 7, v185
    v_cndmask_b32 v118, 0, v163, vcc
    v_add_f32 v59, v59, v118
    v_cmp_ne_u32 vcc, v160, v255
    v_sub_u32 v143, v129, v143
    buffer_load_dwordx4 v126, s[48:51], 0 offen lds
    s_waitcnt vmcnt(7)
    ds_read_b64_tr_b16 a[4:5], v142 offset:3072
    ds_read_b64_tr_b16 a[6:7], v142 offset:3840
    ds_read_b64_tr_b16 a[28:29], v142 offset:3104
    ds_read_b64_tr_b16 a[30:31], v142 offset:3872
    ds_read_b64_tr_b16 a[52:53], v142 offset:3136
    ds_read_b64_tr_b16 a[54:55], v142 offset:3904
    v_cndmask_b32 v129, 0, v163, vcc
    v_add_f32 v71, v71, v129
    v_lshrrev_b32 v185, 2, v185
    v_lshrrev_b32 v143, 2, v143
    v_and_b32 v185, s5, v185
    v_and_b32 v143, s6, v143
    v_lshl_or_b32 v185, v185, 1, v143
    v_cmp_ne_u32 vcc, v185, v181
    buffer_load_dwordx4 v128, s[48:51], 0 offen offset:1024 lds
    v_lshl_add_u32 v129, v115, 2, 3
    v_cndmask_b32 v160, 0, v163, vcc
    v_add_f32 v48, v48, v160
    v_cmp_ne_u32 vcc, v185, v254
    v_mul_u32_u24 v160, 37, v129
    v_lshrrev_b32 v160, 8, v160
    v_cndmask_b32 v118, 0, v163, vcc
    v_add_f32 v60, v60, v118
    v_cmp_ne_u32 vcc, v185, v255
    v_mul_u32_u24 v185, 7, v160
    v_sub_u32 v185, v129, v185
    v_cndmask_b32 v129, 0, v163, vcc
    v_add_f32 v72, v72, v129
    v_lshrrev_b32 v160, 2, v160
    v_lshrrev_b32 v185, 2, v185
    buffer_load_dwordx4 v130, s[48:51], 0 offen offset:2048 lds
    s_add_u32 s48, s48, 36864
    s_addc_u32 s49, s49, 0
    s_add_u32 m0, s69, 3072
    v_and_b32 v160, s5, v160
    v_and_b32 v185, s6, v185
    v_lshl_or_b32 v160, v160, 1, v185
    v_cmp_ne_u32 vcc, v160, v181
    v_lshl_add_u32 v185, v115, 2, 16
    v_mul_u32_u24 v129, 37, v185
    v_cndmask_b32 v118, 0, v163, vcc
    v_add_f32 v49, v49, v118
    v_cmp_ne_u32 vcc, v160, v254
    v_lshrrev_b32 v129, 8, v129
    v_mul_u32_u24 v118, 7, v129
    v_cndmask_b32 v119, 0, v163, vcc
    buffer_load_dwordx4 v126, s[48:51], 0 offen lds
    s_waitcnt vmcnt(7)
    ds_read_b64_tr_b16 a[8:9], v141 offset:0
    ds_read_b64_tr_b16 a[10:11], v141 offset:768
    ds_read_b64_tr_b16 a[32:33], v141 offset:32
    ds_read_b64_tr_b16 a[34:35], v141 offset:800
    ds_read_b64_tr_b16 a[56:57], v141 offset:64
    ds_read_b64_tr_b16 a[58:59], v141 offset:832
    v_add_f32 v61, v61, v119
    v_cmp_ne_u32 vcc, v160, v255
    v_sub_u32 v118, v185, v118
    v_lshrrev_b32 v129, 2, v129
    v_cndmask_b32 v119, 0, v163, vcc
    v_add_f32 v73, v73, v119
    v_lshrrev_b32 v118, 2, v118
    v_and_b32 v129, s5, v129
    buffer_load_dwordx4 v128, s[48:51], 0 offen offset:1024 lds
    v_and_b32 v118, s6, v118
    v_lshl_or_b32 v129, v129, 1, v118
    v_cmp_ne_u32 vcc, v129, v181
    v_lshl_add_u32 v160, v115, 2, 17
    v_mul_u32_u24 v118, 37, v160
    v_cndmask_b32 v185, 0, v163, vcc
    v_add_f32 v50, v50, v185
    v_cmp_ne_u32 vcc, v129, v254
    v_lshrrev_b32 v118, 8, v118
    v_mul_u32_u24 v185, 7, v118
    v_cndmask_b32 v119, 0, v163, vcc
    v_add_f32 v62, v62, v119
    v_cmp_ne_u32 vcc, v129, v255
    v_sub_u32 v185, v160, v185
    v_lshrrev_b32 v118, 2, v118
    buffer_load_dwordx4 v130, s[48:51], 0 offen offset:2048 lds
    s_sub_u32 s48, s48, 183552
    s_subb_u32 s49, s49, 0
    s_add_u32 m0, s68, 0
    s_waitcnt lgkmcnt(0)
    v_cndmask_b32 v119, 0, v163, vcc
    v_add_f32 v74, v74, v119
    v_lshrrev_b32 v185, 2, v185
    v_and_b32 v118, s5, v118
    v_and_b32 v185, s6, v185
    v_lshl_or_b32 v118, v118, 1, v185
    v_cmp_ne_u32 vcc, v118, v181
    v_lshl_add_u32 v129, v115, 2, 18
    v_mul_u32_u24 v160, 37, v129
    v_cndmask_b32 v119, 0, v163, vcc
    v_add_f32 v51, v51, v119
    buffer_load_dwordx4 v126, s[48:51], 0 offen lds
    s_waitcnt vmcnt(7)
    ds_read_b64_tr_b16 a[12:13], v141 offset:3072
    ds_read_b64_tr_b16 a[14:15], v141 offset:3840
    ds_read_b64_tr_b16 a[36:37], v141 offset:3104
    ds_read_b64_tr_b16 a[38:39], v141 offset:3872
    ds_read_b64_tr_b16 a[60:61], v141 offset:3136
    ds_read_b64_tr_b16 a[62:63], v141 offset:3904
    v_cmp_ne_u32 vcc, v118, v254
    v_lshrrev_b32 v160, 8, v160
    v_mul_u32_u24 v185, 7, v160
    v_cndmask_b32 v119, 0, v163, vcc
    v_add_f32 v63, v63, v119
    v_cmp_ne_u32 vcc, v118, v255
    v_sub_u32 v185, v129, v185
    v_lshrrev_b32 v160, 2, v160
    buffer_load_dwordx4 v128, s[48:51], 0 offen offset:1024 lds
    v_cndmask_b32 v129, 0, v163, vcc
    v_add_f32 v75, v75, v129
    v_lshrrev_b32 v185, 2, v185
    v_and_b32 v160, s5, v160
    v_and_b32 v185, s6, v185
    v_lshl_or_b32 v160, v160, 1, v185
    v_cmp_ne_u32 vcc, v160, v181
    v_lshl_add_u32 v129, v115, 2, 19
    v_mul_u32_u24 v118, 37, v129
    v_cndmask_b32 v185, 0, v163, vcc
    v_add_f32 v52, v52, v185
    v_cmp_ne_u32 vcc, v160, v254
    v_lshrrev_b32 v118, 8, v118
    v_mul_u32_u24 v185, 7, v118
    v_cndmask_b32 v119, 0, v163, vcc
    buffer_load_dwordx4 v130, s[48:51], 0 offen offset:2048 lds
    s_add_u32 s48, s48, 36864
    s_addc_u32 s49, s49, 0
    s_add_u32 m0, s68, 3072
    s_waitcnt lgkmcnt(0)
    v_add_f32 v64, v64, v119
    v_cmp_ne_u32 vcc, v160, v255
    v_sub_u32 v185, v129, v185
    v_lshrrev_b32 v118, 2, v118
    v_cndmask_b32 v119, 0, v163, vcc
    v_add_f32 v76, v76, v119
    v_lshrrev_b32 v185, 2, v185
    v_and_b32 v118, s5, v118
    v_and_b32 v185, s6, v185
    v_lshl_or_b32 v118, v118, 1, v185
    v_cmp_ne_u32 vcc, v118, v181
    buffer_load_dwordx4 v126, s[48:51], 0 offen lds
    s_waitcnt vmcnt(7)
    ds_read_b64_tr_b16 a[16:17], v139 offset:0
    ds_read_b64_tr_b16 a[18:19], v139 offset:768
    ds_read_b64_tr_b16 a[40:41], v139 offset:32
    ds_read_b64_tr_b16 a[42:43], v139 offset:800
    ds_read_b64_tr_b16 a[64:65], v139 offset:64
    ds_read_b64_tr_b16 a[66:67], v139 offset:832
    v_cndmask_b32 v119, 0, v163, vcc
    v_add_f32 v53, v53, v119
    v_cmp_ne_u32 vcc, v118, v254
    v_lshl_add_u32 v160, v115, 2, 32
    v_mul_u32_u24 v129, 37, v160
    v_cndmask_b32 v119, 0, v163, vcc
    v_add_f32 v65, v65, v119
    v_cmp_ne_u32 vcc, v118, v255
    buffer_load_dwordx4 v128, s[48:51], 0 offen offset:1024 lds
    v_lshrrev_b32 v129, 8, v129
    v_cndmask_b32 v185, 0, v163, vcc
    v_add_f32 v77, v77, v185
    v_mul_u32_u24 v185, 7, v129
    v_sub_u32 v185, v160, v185
    v_lshrrev_b32 v129, 2, v129
    v_lshrrev_b32 v185, 2, v185
    v_and_b32 v129, s5, v129
    v_and_b32 v185, s6, v185
    v_lshl_or_b32 v129, v129, 1, v185
    v_cmp_ne_u32 vcc, v129, v181
    v_lshl_add_u32 v118, v115, 2, 33
    v_mul_u32_u24 v185, 37, v118
    v_cndmask_b32 v160, 0, v163, vcc
    v_add_f32 v54, v54, v160
    buffer_load_dwordx4 v130, s[48:51], 0 offen offset:2048 lds
    s_add_u32 s48, s48, 36864
    s_addc_u32 s49, s49, 0
    s_add_u32 m0, s69, 0
    s_waitcnt lgkmcnt(0)
    v_cmp_ne_u32 vcc, v129, v254
    v_lshrrev_b32 v185, 8, v185
    v_mul_u32_u24 v160, 7, v185
    v_cndmask_b32 v119, 0, v163, vcc
    v_add_f32 v66, v66, v119
    v_cmp_ne_u32 vcc, v129, v255
    v_sub_u32 v160, v118, v160
    v_lshrrev_b32 v185, 2, v185
    v_cndmask_b32 v129, 0, v163, vcc
    v_add_f32 v78, v78, v129
    v_lshrrev_b32 v160, 2, v160
    buffer_load_dwordx4 v126, s[48:51], 0 offen lds
    s_waitcnt vmcnt(7)
    ds_read_b64_tr_b16 a[20:21], v139 offset:3072
    ds_read_b64_tr_b16 a[22:23], v139 offset:3840
    ds_read_b64_tr_b16 a[44:45], v139 offset:3104
    ds_read_b64_tr_b16 a[46:47], v139 offset:3872
    ds_read_b64_tr_b16 a[68:69], v139 offset:3136
    ds_read_b64_tr_b16 a[70:71], v139 offset:3904
    v_and_b32 v185, s5, v185
    v_and_b32 v160, s6, v160
    v_lshl_or_b32 v185, v185, 1, v160
    v_cmp_ne_u32 vcc, v185, v181
    v_lshl_add_u32 v129, v115, 2, 34
    v_mul_u32_u24 v160, 37, v129
    v_cndmask_b32 v118, 0, v163, vcc
    v_add_f32 v55, v55, v118
    buffer_load_dwordx4 v128, s[48:51], 0 offen offset:1024 lds
    v_cmp_ne_u32 vcc, v185, v254
    v_lshrrev_b32 v160, 8, v160
    v_mul_u32_u24 v119, 7, v160
    v_cndmask_b32 v118, 0, v163, vcc
    v_add_f32 v67, v67, v118
    v_cmp_ne_u32 vcc, v185, v255
    v_sub_u32 v119, v129, v119
    v_lshrrev_b32 v160, 2, v160
    v_cndmask_b32 v129, 0, v163, vcc
    v_add_f32 v79, v79, v129
    v_lshrrev_b32 v119, 2, v119
    v_and_b32 v160, s5, v160
    v_and_b32 v119, s6, v119
    v_lshl_or_b32 v160, v160, 1, v119
    v_cmp_ne_u32 vcc, v160, v181
    buffer_load_dwordx4 v130, s[48:51], 0 offen offset:2048 lds
    s_add_u32 s48, s48, 36864
    s_addc_u32 s49, s49, 0
    s_add_u32 m0, s69, 3072
    s_waitcnt lgkmcnt(0)
    v_cndmask_b32 v129, 0, v163, vcc
    v_add_f32 v56, v56, v129
    v_cmp_ne_u32 vcc, v160, v254
    v_lshl_add_u32 v129, v115, 2, 35
    v_mul_u32_u24 v118, 37, v129
    v_cndmask_b32 v185, 0, v163, vcc
    v_add_f32 v68, v68, v185
    v_cmp_ne_u32 vcc, v160, v255
    v_lshrrev_b32 v118, 8, v118
    v_mul_u32_u24 v119, 7, v118
    buffer_load_dwordx4 v126, s[48:51], 0 offen lds
    s_waitcnt vmcnt(7)
    ds_read_b64_tr_b16 a[144:145], v141 offset:0
    ds_read_b64_tr_b16 a[146:147], v141 offset:768
    ds_read_b64_tr_b16 a[168:169], v141 offset:32
    ds_read_b64_tr_b16 a[170:171], v141 offset:800
    ds_read_b64_tr_b16 a[192:193], v141 offset:64
    ds_read_b64_tr_b16 a[194:195], v141 offset:832
    v_cndmask_b32 v160, 0, v163, vcc
    v_add_f32 v80, v80, v160
    v_sub_u32 v119, v129, v119
    v_lshrrev_b32 v118, 2, v118
    v_lshrrev_b32 v119, 2, v119
    v_and_b32 v118, s5, v118
    v_and_b32 v119, s6, v119
    v_lshl_or_b32 v118, v118, 1, v119
    buffer_load_dwordx4 v128, s[48:51], 0 offen offset:1024 lds
    v_cmp_ne_u32 vcc, v118, v181
    v_cndmask_b32 v22, v180, v22, s[88:89]
    v_cndmask_b32 v24, v180, v24, s[88:89]
    v_cndmask_b32 v119, 0, v163, vcc
    v_add_f32 v57, v57, v119
    v_cmp_ne_u32 vcc, v118, v254
    v_mov_b32_dpp v23, v25 quad_perm:[0,1,2,3] row_mask:0x2 bank_mask:0xf
    v_cndmask_b32 v26, v180, v26, s[88:89]
    v_cndmask_b32 v119, 0, v163, vcc
    v_add_f32 v69, v69, v119
    v_cmp_ne_u32 vcc, v118, v255
    v_mov_b32_dpp v23, v27 quad_perm:[0,1,2,3] row_mask:0x4 bank_mask:0xf
    v_mov_b32 v134, 0
    v_cndmask_b32 v129, 0, v163, vcc
    v_add_f32 v81, v81, v129
    buffer_load_dwordx4 v130, s[48:51], 0 offen offset:2048 lds
    ds_read_b128 v[150:153], v161 offset:0
    ds_read_b128 v[122:125], v174 offset:0
    ds_read_b128 v[170:173], v161 offset:128
    s_add_u32 s48, s48, 36864
    s_addc_u32 s49, s49, 0
    ds_read_b128 v[162:165], v174 offset:128
    s_add_u32 m0, s68, 0
    s_waitcnt lgkmcnt(4)
    ds_read_b128 v[166:169], v161 offset:256
    ds_read_b128 v[114:117], v174 offset:256
    v_mov_b32 v135, 0
    buffer_load_dwordx4 v126, s[48:51], 0 offen lds
    s_waitcnt vmcnt(7)
    ds_read_b64_tr_b16 a[148:149], v141 offset:3072
    ds_read_b64_tr_b16 a[150:151], v141 offset:3840
    ds_read_b64_tr_b16 a[172:173], v141 offset:3104
    ds_read_b64_tr_b16 a[174:175], v141 offset:3872
    ds_read_b64_tr_b16 a[196:197], v141 offset:3136
    ds_read_b64_tr_b16 a[198:199], v141 offset:3904
    s_waitcnt lgkmcnt(11)
    v_mfma_f32_16x16x32_bf16 v[146:149], a[72:75], v[150:153], 0
    s_waitcnt lgkmcnt(9)
    ds_write_b64 v175, v[134:135] offset:56
    v_mfma_f32_16x16x32_bf16 v[146:149], a[76:79], v[122:125], v[146:149]
    s_waitcnt lgkmcnt(9)
    buffer_load_dwordx4 v128, s[48:51], 0 offen offset:1024 lds
    v_mov_b32 v136, 0
    v_mfma_f32_16x16x32_bf16 v[146:149], a[80:83], v[170:173], v[146:149]
    s_waitcnt lgkmcnt(8)
    ds_write_b64 v175, v[134:135] offset:64
    v_mfma_f32_16x16x32_bf16 v[146:149], a[84:87], v[162:165], v[146:149]
    s_waitcnt lgkmcnt(8)
    v_mov_b32 v137, 0
    v_mfma_f32_16x16x32_bf16 v[146:149], a[88:91], v[166:169], v[146:149]
    s_waitcnt lgkmcnt(6)
    ds_write_b128 v175, v[134:137] offset:16
    v_mfma_f32_16x16x32_bf16 v[146:149], a[92:95], v[114:117], v[146:149]
    s_waitcnt lgkmcnt(3)
    buffer_load_dwordx4 v130, s[48:51], 0 offen offset:2048 lds
    s_add_u32 s48, s48, 36864
    v_mfma_f32_16x16x32_bf16 v[154:157], a[96:99], v[150:153], 0
    s_addc_u32 s49, s49, 0
    s_add_u32 m0, s68, 3072
    v_mfma_f32_16x16x32_bf16 v[154:157], a[100:103], v[122:125], v[154:157]
    ds_write_b128 v176, v[134:137] offset:16
    v_mfma_f32_16x16x32_bf16 v[154:157], a[104:107], v[170:173], v[154:157]
    s_waitcnt vmcnt(6)
    v_fma_f32 v160, v146, v146, s32
    v_fmac_f32 v160, v147, v147
    v_mfma_f32_16x16x32_bf16 v[154:157], a[108:111], v[162:165], v[154:157]
    buffer_load_dwordx4 v126, s[48:51], 0 offen lds
    v_fmac_f32 v160, v148, v148
    v_mfma_f32_16x16x32_bf16 v[154:157], a[112:115], v[166:169], v[154:157]
    ds_read_b64_tr_b16 a[152:153], v139 offset:0
    ds_read_b64_tr_b16 a[154:155], v139 offset:768
    v_mfma_f32_16x16x32_bf16 v[154:157], a[116:119], v[114:117], v[154:157]
    ds_read_b64_tr_b16 a[176:177], v139 offset:32
    ds_read_b64_tr_b16 a[178:179], v139 offset:800
    v_mfma_f32_16x16x32_bf16 v[190:193], a[120:123], v[150:153], 0
    ds_read_b64_tr_b16 a[200:201], v139 offset:64
    ds_read_b64_tr_b16 a[202:203], v139 offset:832
    v_mfma_f32_16x16x32_bf16 v[190:193], a[124:127], v[122:125], v[190:193]
    ds_read_b128 v[202:205], v161 offset:6144
    ds_read_b128 v[230:233], v174 offset:6144
    v_mfma_f32_16x16x32_bf16 v[190:193], a[128:131], v[170:173], v[190:193]
    buffer_load_dwordx4 v128, s[48:51], 0 offen offset:1024 lds
    ds_read_b128 v[238:241], v161 offset:6272
    v_mfma_f32_16x16x32_bf16 v[190:193], a[132:135], v[162:165], v[190:193]
    ds_read_b128 v[206:209], v174 offset:6272
    ds_read_b128 v[198:201], v161 offset:6400
    v_mfma_f32_16x16x32_bf16 v[190:193], a[136:139], v[166:169], v[190:193]
    v_fmac_f32 v160, v149, v149
    v_fmac_f32 v160, v154, v154
    v_mfma_f32_16x16x32_bf16 v[190:193], a[140:143], v[114:117], v[190:193]
    ds_read_b128 v[210:213], v174 offset:6400
    v_fmac_f32 v160, v155, v155
    v_mfma_f32_16x16x32_bf16 v[214:217], a[0:3], v[150:153], 0
    s_waitcnt lgkmcnt(10)
    ds_write_b64 v176, v[134:135] offset:56
    v_mfma_f32_16x16x32_bf16 v[214:217], a[4:7], v[122:125], v[214:217]
    s_waitcnt lgkmcnt(8)
    buffer_load_dwordx4 v130, s[48:51], 0 offen offset:2048 lds
    v_fmac_f32 v160, v156, v156
    v_mfma_f32_16x16x32_bf16 v[214:217], a[8:11], v[170:173], v[214:217]
    s_waitcnt lgkmcnt(6)
    ds_write_b64 v176, v[134:135] offset:64
    v_mfma_f32_16x16x32_bf16 v[130:133], a[72:75], v[202:205], 0
    s_waitcnt vmcnt(6)
    v_fmac_f32 v160, v157, v157
    v_fmac_f32 v160, v190, v190
    v_mfma_f32_16x16x32_bf16 v[218:221], a[96:99], v[202:205], 0
    s_waitcnt lgkmcnt(3)
    ds_read_b64_tr_b16 a[156:157], v139 offset:3072
    ds_read_b64_tr_b16 a[158:159], v139 offset:3840
    v_mfma_f32_16x16x32_bf16 v[130:133], a[76:79], v[230:233], v[130:133]
    s_add_u32 m0, s28, 8192
    ds_read_b64_tr_b16 a[180:181], v139 offset:3104
    ds_read_b64_tr_b16 a[182:183], v139 offset:3872
    v_mfma_f32_16x16x32_bf16 v[130:133], a[80:83], v[238:241], v[130:133]
    s_waitcnt lgkmcnt(6)
    buffer_load_dwordx4 v12, s[8:11], s25 offen nt lds
    v_mfma_f32_16x16x32_bf16 v[130:133], a[84:87], v[206:209], v[130:133]
    s_add_u32 m0, s28, 12288
    ds_read_b64_tr_b16 a[204:205], v139 offset:3136
    ds_read_b64_tr_b16 a[206:207], v139 offset:3904
    v_mfma_f32_16x16x32_bf16 v[130:133], a[88:91], v[198:201], v[130:133]
    v_fmac_f32 v160, v191, v191
    v_fmac_f32 v160, v192, v192
    v_mfma_f32_16x16x32_bf16 v[130:133], a[92:95], v[210:213], v[130:133]
    v_fmac_f32 v160, v193, v193
    v_mfma_f32_16x16x32_bf16 v[218:221], a[100:103], v[230:233], v[218:221]
    v_mfma_f32_16x16x32_bf16 v[218:221], a[104:107], v[238:241], v[218:221]
    buffer_load_dwordx4 v13, s[8:11], s25 offen nt lds
    v_mfma_f32_16x16x32_bf16 v[218:221], a[108:111], v[206:209], v[218:221]
    s_add_u32 m0, s29, 0
    v_mfma_f32_16x16x32_bf16 v[218:221], a[112:115], v[198:201], v[218:221]
    s_waitcnt lgkmcnt(2)
    v_fma_f32 v181, v130, v130, s32
    v_fmac_f32 v181, v131, v131
    v_mfma_f32_16x16x32_bf16 v[218:221], a[116:119], v[210:213], v[218:221]
    v_fmac_f32 v181, v132, v132
    v_fmac_f32 v181, v133, v133
    v_mfma_f32_16x16x32_bf16 v[222:225], a[120:123], v[202:205], 0
    s_waitcnt lgkmcnt(0)
    v_mfma_f32_16x16x32_bf16 v[222:225], a[124:127], v[230:233], v[222:225]
    buffer_load_dwordx4 v14, s[8:11], s25 offen nt lds
    v_mfma_f32_16x16x32_bf16 v[222:225], a[128:131], v[238:241], v[222:225]
    s_add_u32 m0, s69, 0
    s_waitcnt vmcnt(6)
    ds_read_b64_tr_b16 a[160:161], v141 offset:0
    v_mfma_f32_16x16x32_bf16 v[222:225], a[132:135], v[206:209], v[222:225]
    s_lshr_b32 s10, s17, 1
    ds_read_b64_tr_b16 a[162:163], v141 offset:768
    ds_read_b64_tr_b16 a[184:185], v141 offset:32
    v_mfma_f32_16x16x32_bf16 v[222:225], a[136:139], v[198:201], v[222:225]
    s_cselect_b32 s10, s36, 0
    ds_read_b64_tr_b16 a[186:187], v141 offset:800
    ds_read_b64_tr_b16 a[208:209], v141 offset:64
    v_mfma_f32_16x16x32_bf16 v[222:225], a[140:143], v[210:213], v[222:225]
    s_mov_b32 s25, s24
    ds_read_b64_tr_b16 a[210:211], v141 offset:832
    v_fmac_f32 v181, v218, v218
    v_mfma_f32_16x16x32_bf16 v[214:217], a[12:15], v[162:165], v[214:217]
    buffer_load_dwordx4 v120, s[52:55], 0 offen lds
    v_fmac_f32 v181, v219, v219
    v_mfma_f32_16x16x32_bf16 v[214:217], a[16:19], v[166:169], v[214:217]
    v_fmac_f32 v181, v220, v220
    v_fmac_f32 v181, v221, v221
    v_mfma_f32_16x16x32_bf16 v[214:217], a[20:23], v[114:117], v[214:217]
    v_fmac_f32 v181, v222, v222
    v_fmac_f32 v181, v223, v223
    v_mfma_f32_16x16x32_bf16 v[134:137], a[24:27], v[150:153], 0
    v_fmac_f32 v181, v224, v224
    v_fmac_f32 v181, v225, v225
    v_mfma_f32_16x16x32_bf16 v[134:137], a[28:31], v[122:125], v[134:137]
    s_waitcnt lgkmcnt(5)
    v_xor_b32 v185, 65536, v2
    v_fma_f32 v118, v214, v214, s32
    v_mfma_f32_16x16x32_bf16 v[134:137], a[32:35], v[170:173], v[134:137]
    s_waitcnt lgkmcnt(3)
    buffer_load_dwordx4 v159, s[52:55], 0 offen offset:1024 lds
    v_fmac_f32 v118, v215, v215
    v_mfma_f32_16x16x32_bf16 v[134:137], a[36:39], v[162:165], v[134:137]
    s_waitcnt lgkmcnt(1)
    v_fmac_f32 v118, v216, v216
    v_fmac_f32 v118, v217, v217
    v_mfma_f32_16x16x32_bf16 v[134:137], a[40:43], v[166:169], v[134:137]
    s_waitcnt lgkmcnt(0)
    v_lshrrev_b32 v142, 2, v185
    v_lshrrev_b32 v143, 8, v185
    v_mfma_f32_16x16x32_bf16 v[134:137], a[44:47], v[114:117], v[134:137]
    v_lshl_add_u32 v254, s16, 2, v185
    v_add_u32 v142, 62784, v142
    v_mfma_f32_16x16x32_bf16 v[226:229], a[48:51], v[150:153], 0
    v_lshlrev_b32 v143, 4, v143
    v_add_u32 v143, 62784, v143
    v_mfma_f32_16x16x32_bf16 v[226:229], a[52:55], v[122:125], v[226:229]
    buffer_load_dwordx4 v121, s[52:55], 0 offen offset:2048 lds
    v_or_b32 v234, v32, v33
    v_mfma_f32_16x16x32_bf16 v[226:229], a[56:59], v[170:173], v[226:229]
    s_add_u32 s52, s52, 12288
    s_waitcnt vmcnt(6)
    ds_read_b64_tr_b16 a[164:165], v141 offset:3072
    v_mfma_f32_16x16x32_bf16 v[226:229], a[60:63], v[162:165], v[226:229]
    s_addc_u32 s53, s53, 0
    ds_read_b64_tr_b16 a[166:167], v141 offset:3840
    ds_read_b64_tr_b16 a[188:189], v141 offset:3104
    v_mfma_f32_16x16x32_bf16 v[226:229], a[64:67], v[166:169], v[226:229]
    s_add_u32 m0, s69, 3072
    ds_read_b64_tr_b16 a[190:191], v141 offset:3872
    ds_read_b64_tr_b16 a[212:213], v141 offset:3136
    v_mfma_f32_16x16x32_bf16 v[226:229], a[68:71], v[114:117], v[226:229]
    ds_read_b64_tr_b16 a[214:215], v141 offset:3904
    v_fmac_f32 v118, v134, v134
    v_mfma_f32_16x16x32_bf16 v[138:141], a[0:3], v[202:205], 0
    buffer_load_dwordx4 v120, s[52:55], 0 offen lds
    v_fmac_f32 v118, v135, v135
    v_mfma_f32_16x16x32_bf16 v[138:141], a[4:7], v[230:233], v[138:141]
    v_fmac_f32 v118, v136, v136
    v_fmac_f32 v118, v137, v137
    v_mfma_f32_16x16x32_bf16 v[138:141], a[8:11], v[238:241], v[138:141]
    v_fmac_f32 v118, v226, v226
    v_fmac_f32 v118, v227, v227
    v_mfma_f32_16x16x32_bf16 v[138:141], a[12:15], v[206:209], v[138:141]
    v_fmac_f32 v118, v228, v228
    v_fmac_f32 v118, v229, v229
    v_mfma_f32_16x16x32_bf16 v[138:141], a[16:19], v[198:201], v[138:141]
    s_waitcnt lgkmcnt(5)
    v_cvt_pk_bf16_f32 v36, v118, v160
    v_and_b32 v234, 0xffff, v234
    v_mfma_f32_16x16x32_bf16 v[138:141], a[20:23], v[210:213], v[138:141]
    s_waitcnt lgkmcnt(3)
    buffer_load_dwordx4 v159, s[52:55], 0 offen offset:1024 lds
    v_lshl_or_b32 v234, v234, 16, v234
    v_mfma_f32_16x16x32_bf16 v[242:245], v[32:35], v[36:39], 0
    s_waitcnt lgkmcnt(1)
    v_or_b32 v235, v32, v33
    v_and_b32 v235, 0xffff, v235
    v_mfma_f32_16x16x32_bf16 v[114:117], a[24:27], v[202:205], 0
    s_waitcnt lgkmcnt(0)
    v_lshl_or_b32 v235, v235, 16, v235
    v_or_b32 v236, v32, v33
    v_mfma_f32_16x16x32_bf16 v[114:117], a[28:31], v[230:233], v[114:117]
    v_rsq_f32 v243, v243
    v_mfma_f32_16x16x32_bf16 v[114:117], a[32:35], v[238:241], v[114:117]
    v_rsq_f32 v242, v242
    v_mfma_f32_16x16x32_bf16 v[114:117], a[36:39], v[206:209], v[114:117]
    buffer_load_dwordx4 v121, s[52:55], 0 offen offset:2048 lds
    ds_read_b128 v[186:189], v0 offset:20480
    v_mfma_f32_16x16x32_bf16 v[114:117], a[40:43], v[198:201], v[114:117]
    s_add_u32 s52, s52, 12288
    ds_read_b128 v[194:197], v1 offset:20480
    v_mul_f32 v242, s31, v242
    v_mfma_f32_16x16x32_bf16 v[114:117], a[44:47], v[210:213], v[114:117]
    s_addc_u32 s53, s53, 0
    ds_read_b128 v[122:125], v0 offset:20608
    v_mul_f32 v146, v243, v146
    v_mfma_f32_16x16x32_bf16 v[246:249], a[48:51], v[202:205], 0
    s_add_u32 m0, s68, 0
    ds_read_b128 v[202:205], v1 offset:20608
    v_mul_f32 v147, v243, v147
    v_mfma_f32_16x16x32_bf16 v[246:249], a[52:55], v[230:233], v[246:249]
    ds_read_b128 v[230:233], v0 offset:20736
    v_cvt_pk_f16_f32 v150, v146, v147
    v_mfma_f32_16x16x32_bf16 v[246:249], a[56:59], v[238:241], v[246:249]
    buffer_load_dwordx4 v120, s[52:55], 0 offen lds
    ds_read_b128 v[238:241], v1 offset:20736
    v_mfma_f32_16x16x32_bf16 v[246:249], a[60:63], v[206:209], v[246:249]
    v_mul_f32 v148, v243, v148
    v_mul_f32 v149, v243, v149
    v_mfma_f32_16x16x32_bf16 v[246:249], a[64:67], v[198:201], v[246:249]
    v_cvt_pk_f16_f32 v151, v148, v149
    v_mul_f32 v154, v243, v154
    v_mfma_f32_16x16x32_bf16 v[246:249], a[68:71], v[210:213], v[246:249]
    s_waitcnt lgkmcnt(5)
    v_mul_f32 v155, v243, v155
    v_cvt_pk_f16_f32 v152, v154, v155
    v_mfma_f32_16x16x32_bf16 v[162:165], a[96:99], v[186:189], 0
    s_waitcnt lgkmcnt(4)
    v_mul_f32 v156, v243, v156
    v_mul_f32 v157, v243, v157
    v_mfma_f32_16x16x32_bf16 v[162:165], a[100:103], v[194:197], v[162:165]
    s_waitcnt lgkmcnt(3)
    v_cvt_pk_f16_f32 v153, v156, v157
    v_mul_f32 v190, v243, v190
    v_mfma_f32_16x16x32_bf16 v[162:165], a[104:107], v[122:125], v[162:165]
    s_waitcnt lgkmcnt(2)
    ds_write_b128 v175, v[150:153]
    v_mfma_f32_16x16x32_bf16 v[162:165], a[108:111], v[202:205], v[162:165]
    s_waitcnt lgkmcnt(1)
    v_mul_f32 v191, v243, v191
    v_cvt_pk_f16_f32 v208, v190, v191
    v_mfma_f32_16x16x32_bf16 v[162:165], a[112:115], v[230:233], v[162:165]
    v_mul_f32 v192, v243, v192
    v_mul_f32 v193, v243, v193
    v_mfma_f32_16x16x32_bf16 v[162:165], a[116:119], v[238:241], v[162:165]
    v_cvt_pk_f16_f32 v209, v192, v193
    v_mul_f32 v214, v242, v214
    v_mfma_f32_16x16x32_bf16 v[170:173], a[120:123], v[186:189], 0
    ds_write_b64 v175, v[208:209] offset:48
    v_mfma_f32_16x16x32_bf16 v[170:173], a[124:127], v[194:197], v[170:173]
    v_mul_f32 v215, v242, v215
    v_cvt_pk_f16_f32 v150, v214, v215
    v_mfma_f32_16x16x32_bf16 v[170:173], a[128:131], v[122:125], v[170:173]
    v_mul_f32 v216, v242, v216
    v_mul_f32 v217, v242, v217
    v_mfma_f32_16x16x32_bf16 v[170:173], a[132:135], v[202:205], v[170:173]
    v_cvt_pk_f16_f32 v151, v216, v217
    v_mul_f32 v134, v242, v134
    v_mfma_f32_16x16x32_bf16 v[170:173], a[136:139], v[230:233], v[170:173]
    v_mul_f32 v135, v242, v135
    v_cvt_pk_f16_f32 v152, v134, v135
    v_mfma_f32_16x16x32_bf16 v[170:173], a[140:143], v[238:241], v[170:173]
    v_mul_f32 v136, v242, v136
    v_mul_f32 v137, v242, v137
    v_mfma_f32_16x16x32_bf16 v[166:169], a[24:27], v[186:189], 0
    v_cvt_pk_f16_f32 v153, v136, v137
    v_mul_f32 v226, v242, v226
    v_mfma_f32_16x16x32_bf16 v[166:169], a[28:31], v[194:197], v[166:169]
    ds_write_b128 v175, v[150:153] offset:32
    v_mfma_f32_16x16x32_bf16 v[150:153], a[72:75], v[186:189], 0
    v_mul_f32 v227, v242, v227
    v_cvt_pk_f16_f32 v206, v226, v227
    v_mfma_f32_16x16x32_bf16 v[150:153], a[76:79], v[194:197], v[150:153]
    v_mul_f32 v228, v242, v228
    v_mul_f32 v229, v242, v229
    v_mfma_f32_16x16x32_bf16 v[150:153], a[80:83], v[122:125], v[150:153]
    v_cvt_pk_f16_f32 v207, v228, v229
    v_mul_f32 v146, v214, v146
    v_mfma_f32_16x16x32_bf16 v[150:153], a[84:87], v[202:205], v[150:153]
    ds_write_b64 v175, v[206:207] offset:72
    v_mfma_f32_16x16x32_bf16 v[150:153], a[88:91], v[230:233], v[150:153]
    v_fmac_f32 v146, v215, v147
    v_fmac_f32 v146, v216, v148
    v_mfma_f32_16x16x32_bf16 v[150:153], a[92:95], v[238:241], v[150:153]
    v_fmac_f32 v146, v217, v149
    v_fmac_f32 v146, v134, v154
    v_mfma_f32_16x16x32_bf16 v[166:169], a[32:35], v[122:125], v[166:169]
    v_fmac_f32 v146, v135, v155
    v_fmac_f32 v146, v136, v156
    v_mfma_f32_16x16x32_bf16 v[166:169], a[36:39], v[202:205], v[166:169]
    v_fmac_f32 v146, v137, v157
    v_fmac_f32 v146, v226, v190
    v_mfma_f32_16x16x32_bf16 v[166:169], a[40:43], v[230:233], v[166:169]
    v_fmac_f32 v146, v227, v191
    v_fmac_f32 v146, v228, v192
    v_mfma_f32_16x16x32_bf16 v[166:169], a[44:47], v[238:241], v[166:169]
    v_fmac_f32 v146, v229, v193
    v_mov_b32 v160, v146
    v_mfma_f32_16x16x32_bf16 v[134:137], a[48:51], v[186:189], 0
    v_lshrrev_b32 v236, 16, v236
    v_lshl_or_b32 v236, v236, 16, v236
    v_mfma_f32_16x16x32_bf16 v[134:137], a[52:55], v[194:197], v[134:137]
    v_permlane32_swap_b32 v146, v160
    v_mfma_f32_16x16x32_bf16 v[134:137], a[56:59], v[122:125], v[134:137]
    v_add_f32 v146, v146, v160
    v_mov_b32 v160, v146
    v_mfma_f32_16x16x32_bf16 v[134:137], a[60:63], v[202:205], v[134:137]
    v_or_b32 v237, v32, v33
    v_lshrrev_b32 v237, 16, v237
    v_mfma_f32_16x16x32_bf16 v[134:137], a[64:67], v[230:233], v[134:137]
    v_permlane16_swap_b32 v146, v160
    v_mfma_f32_16x16x32_bf16 v[134:137], a[68:71], v[238:241], v[134:137]
    v_add_f32 v146, v146, v160
    v_add_f32 v146, s39, v146
    v_mfma_f32_16x16x32_bf16 v[154:157], v[186:189], a[144:147], 0
    v_mov_b32 v147, v180
    v_mov_b32 v148, v180
    v_mfma_f32_16x16x32_bf16 v[154:157], v[194:197], a[148:151], v[154:157]
    v_mov_b32 v149, v180
    v_cndmask_b32 v146, v180, v146, s[88:89]
    v_mfma_f32_16x16x32_bf16 v[154:157], v[122:125], a[152:155], v[154:157]
    ds_write_b128 v158, v[146:149] offset:192
    v_mfma_f32_16x16x32_bf16 v[154:157], v[202:205], a[156:159], v[154:157]
    v_lshl_or_b32 v237, v237, 16, v237
    v_fma_f32 v175, v138, v138, s32
    v_mfma_f32_16x16x32_bf16 v[154:157], v[230:233], a[160:163], v[154:157]
    v_fmac_f32 v175, v139, v139
    v_fmac_f32 v175, v140, v140
    v_mfma_f32_16x16x32_bf16 v[154:157], v[238:241], a[164:167], v[154:157]
    v_fmac_f32 v175, v141, v141
    v_fmac_f32 v175, v114, v114
    v_mfma_f32_16x16x32_bf16 v[146:149], v[186:189], a[168:171], 0
    v_fmac_f32 v175, v115, v115
    v_fmac_f32 v175, v116, v116
    v_mfma_f32_16x16x32_bf16 v[146:149], v[194:197], a[172:175], v[146:149]
    v_fmac_f32 v175, v117, v117
    v_fmac_f32 v175, v246, v246
    v_mfma_f32_16x16x32_bf16 v[146:149], v[122:125], a[176:179], v[146:149]
    v_fmac_f32 v175, v247, v247
    v_fmac_f32 v175, v248, v248
    v_mfma_f32_16x16x32_bf16 v[146:149], v[202:205], a[180:183], v[146:149]
    ds_read_b128 v[190:193], v161 offset:0
    v_fmac_f32 v175, v249, v249
    v_mfma_f32_16x16x32_bf16 v[146:149], v[230:233], a[184:187], v[146:149]
    ds_read_b128 v[206:209], v174 offset:0
    v_cvt_pk_bf16_f32 v36, v175, v181
    v_mfma_f32_16x16x32_bf16 v[146:149], v[238:241], a[188:191], v[146:149]
    ds_read_b128 v[214:217], v161 offset:128
    v_fma_f32 v255, v150, v150, s32
    v_fmac_f32 v255, v151, v151
    v_fmac_f32 v255, v152, v152
    v_fmac_f32 v255, v153, v153
    v_fmac_f32 v255, v162, v162
    v_fmac_f32 v255, v163, v163
    v_fmac_f32 v255, v164, v164
    v_fmac_f32 v255, v165, v165
    v_fmac_f32 v255, v170, v170
    v_fmac_f32 v255, v171, v171
    v_fmac_f32 v255, v172, v172
    v_fmac_f32 v255, v173, v173
    v_cvt_pk_bf16_f32 v118, v154, v155
    v_mfma_f32_16x16x32_bf16 v[198:201], v[32:35], v[36:39], 0
    v_cvt_pk_bf16_f32 v119, v156, v157
    v_cvt_pk_bf16_f32 v146, v146, v147
    v_mfma_f32_16x16x32_bf16 v[154:157], v[186:189], a[192:195], 0
    v_cvt_pk_bf16_f32 v147, v148, v149
    v_xor_b32 v2, 65536, v2
    v_mfma_f32_16x16x32_bf16 v[154:157], v[194:197], a[196:199], v[154:157]
    s_waitcnt lgkmcnt(2)
    v_mfma_f32_16x16x32_bf16 v[154:157], v[122:125], a[200:203], v[154:157]
    s_waitcnt lgkmcnt(1)
    v_rsq_f32 v199, v199
    v_mfma_f32_16x16x32_bf16 v[154:157], v[202:205], a[204:207], v[154:157]
    s_waitcnt lgkmcnt(0)
    v_rsq_f32 v198, v198
    v_mfma_f32_16x16x32_bf16 v[154:157], v[230:233], a[208:211], v[154:157]
    v_mul_f32 v198, s31, v198
    v_mul_f32 v130, v199, v130
    v_mfma_f32_16x16x32_bf16 v[154:157], v[238:241], a[212:215], v[154:157]
    v_mul_f32 v131, v199, v131
    v_cvt_pk_f16_f32 v210, v130, v131
    v_mul_f32 v132, v199, v132
    v_mul_f32 v133, v199, v133
    v_cvt_pk_f16_f32 v211, v132, v133
    v_mul_f32 v218, v199, v218
    v_mul_f32 v219, v199, v219
    v_cvt_pk_f16_f32 v212, v218, v219
    v_mul_f32 v220, v199, v220
    v_mul_f32 v221, v199, v221
    v_cvt_pk_f16_f32 v213, v220, v221
    v_mul_f32 v222, v199, v222
    v_mul_f32 v223, v199, v223
    v_cvt_pk_f16_f32 v228, v222, v223
    v_mul_f32 v224, v199, v224
    v_mul_f32 v225, v199, v225
    v_cvt_pk_f16_f32 v229, v224, v225
    v_mul_f32 v138, v198, v138
    v_mul_f32 v139, v198, v139
    v_cvt_pk_f16_f32 v242, v138, v139
    v_mul_f32 v140, v198, v140
    v_mul_f32 v141, v198, v141
    v_cvt_pk_f16_f32 v243, v140, v141
    v_mul_f32 v114, v198, v114
    v_mul_f32 v115, v198, v115
    v_cvt_pk_f16_f32 v244, v114, v115
    v_mul_f32 v116, v198, v116
    v_mul_f32 v117, v198, v117
    v_cvt_pk_f16_f32 v245, v116, v117
    v_mul_f32 v246, v198, v246
    v_mul_f32 v247, v198, v247
    v_cvt_pk_f16_f32 v226, v246, v247
    v_mul_f32 v248, v198, v248
    v_mul_f32 v249, v198, v249
    v_cvt_pk_f16_f32 v227, v248, v249
    v_mul_f32 v130, v138, v130
    v_fmac_f32 v130, v139, v131
    buffer_load_dwordx4 v159, s[52:55], 0 offen offset:1024 lds
    ds_write_b128 v176, v[210:213]
    v_fmac_f32 v130, v140, v132
    v_fmac_f32 v130, v141, v133
    v_fmac_f32 v130, v114, v218
    v_mfma_f32_16x16x32_bf16 v[138:141], a[0:3], v[186:189], 0
    v_fmac_f32 v130, v115, v219
    v_fmac_f32 v130, v116, v220
    v_mfma_f32_16x16x32_bf16 v[138:141], a[4:7], v[194:197], v[138:141]
    ds_read_b128 v[194:197], v174 offset:128
    ds_read_b128 v[186:189], v161 offset:256
    v_mfma_f32_16x16x32_bf16 v[138:141], a[8:11], v[122:125], v[138:141]
    ds_read_b128 v[122:125], v174 offset:256
    buffer_load_dwordx4 v121, s[52:55], 0 offen offset:2048 lds
    v_mfma_f32_16x16x32_bf16 v[138:141], a[12:15], v[202:205], v[138:141]
    s_add_u32 s52, s52, 12288
    ds_write_b64 v176, v[228:229] offset:48
    v_mfma_f32_16x16x32_bf16 v[138:141], a[16:19], v[230:233], v[138:141]
    s_addc_u32 s53, s53, 0
    v_fmac_f32 v130, v117, v221
    v_fmac_f32 v130, v246, v222
    v_mfma_f32_16x16x32_bf16 v[138:141], a[20:23], v[238:241], v[138:141]
    s_add_u32 m0, s68, 3072
    ds_write_b128 v176, v[242:245] offset:32
    v_mfma_f32_16x16x32_bf16 v[114:117], v[190:193], a[144:147], 0
    s_mul_i32 s68, s78, 72
    v_fmac_f32 v130, v247, v223
    v_fmac_f32 v130, v248, v224
    v_mfma_f32_16x16x32_bf16 v[114:117], v[206:209], a[148:151], v[114:117]
    buffer_load_dwordx4 v120, s[52:55], 0 offen lds
    v_fmac_f32 v130, v249, v225
    v_mfma_f32_16x16x32_bf16 v[114:117], v[214:217], a[152:155], v[114:117]
    s_waitcnt lgkmcnt(3)
    ds_write_b64 v176, v[226:227] offset:72
    v_mfma_f32_16x16x32_bf16 v[114:117], v[194:197], a[156:159], v[114:117]
    s_sub_u32 s68, s77, s68
    v_mov_b32 v148, v130
    v_fma_f32 v181, v138, v138, s32
    v_mfma_f32_16x16x32_bf16 v[114:117], v[186:189], a[160:163], v[114:117]
    s_waitcnt lgkmcnt(2)
    v_permlane32_swap_b32 v130, v148
    v_mfma_f32_16x16x32_bf16 v[114:117], v[122:125], a[164:167], v[114:117]
    s_mul_i32 s78, s78, 1373568
    v_add_f32 v130, v130, v148
    v_mov_b32 v148, v130
    v_mfma_f32_16x16x32_bf16 v[230:233], v[190:193], a[168:171], 0
    buffer_load_dwordx4 v159, s[52:55], 0 offen offset:1024 lds
    v_fmac_f32 v181, v139, v139
    v_mfma_f32_16x16x32_bf16 v[230:233], v[206:209], a[172:175], v[230:233]
    s_mul_i32 s77, s68, 2688
    v_permlane16_swap_b32 v130, v148
    v_mfma_f32_16x16x32_bf16 v[230:233], v[214:217], a[176:179], v[230:233]
    s_add_u32 s77, s77, s78
    v_add_f32 v130, v130, v148
    v_add_f32 v130, s39, v130
    v_mfma_f32_16x16x32_bf16 v[230:233], v[194:197], a[180:183], v[230:233]
    ds_read_b128 v[238:241], v161 offset:6144
    v_mov_b32 v131, v180
    v_mfma_f32_16x16x32_bf16 v[230:233], v[186:189], a[184:187], v[230:233]
    ds_read_b128 v[202:205], v174 offset:6144
    v_mov_b32 v132, v180
    v_mfma_f32_16x16x32_bf16 v[230:233], v[122:125], a[188:191], v[230:233]
    buffer_load_dwordx4 v121, s[52:55], 0 offen offset:2048 lds
    ds_read_b128 v[218:221], v161 offset:6272
    v_mfma_f32_16x16x32_bf16 v[222:225], v[190:193], a[192:195], 0
    s_add_u32 s52, s52, 12288
    ds_read_b128 v[190:193], v174 offset:6272
    v_mov_b32 v133, v180
    v_mfma_f32_16x16x32_bf16 v[222:225], v[206:209], a[196:199], v[222:225]
    s_waitcnt vmcnt(9)
    ds_read_b64 a[216:217], v183 offset:0
    ds_read_b64 a[218:219], v183 offset:1536
    v_mfma_f32_16x16x32_bf16 v[222:225], v[214:217], a[200:203], v[222:225]
    s_addc_u32 s53, s53, 0
    ds_read_b64 a[240:241], v183 offset:8
    ds_read_b64 a[242:243], v183 offset:1544
    v_mfma_f32_16x16x32_bf16 v[222:225], v[194:197], a[204:207], v[222:225]
    s_add_u32 m0, s69, 0
    ds_read_b64 v[90:91], v184 offset:0
    ds_read_b64 v[92:93], v184 offset:1536
    v_mfma_f32_16x16x32_bf16 v[222:225], v[186:189], a[208:211], v[222:225]
    ds_read_b128 v[194:197], v161 offset:6400
    ds_read_b128 v[186:189], v174 offset:6400
    v_mfma_f32_16x16x32_bf16 v[222:225], v[122:125], a[212:215], v[222:225]
    s_waitcnt lgkmcnt(11)
    v_cndmask_b32 v130, v180, v130, s[88:89]
    v_fmac_f32 v181, v140, v140
    v_mfma_f32_16x16x32_bf16 v[122:125], v[238:241], a[144:147], 0
    s_waitcnt lgkmcnt(10)
    ds_write_b128 v179, v[130:133] offset:192
    v_mfma_f32_16x16x32_bf16 v[122:125], v[202:205], a[148:151], v[122:125]
    s_waitcnt lgkmcnt(9)
    v_fmac_f32 v181, v141, v141
    v_fmac_f32 v181, v166, v166
    v_mfma_f32_16x16x32_bf16 v[122:125], v[218:221], a[152:155], v[122:125]
    s_waitcnt lgkmcnt(7)
    v_fmac_f32 v181, v167, v167
    v_fmac_f32 v181, v168, v168
    v_mfma_f32_16x16x32_bf16 v[130:133], v[234:237], a[216:219], 0
    s_waitcnt lgkmcnt(5)
    v_fmac_f32 v181, v169, v169
    v_fmac_f32 v181, v134, v134
    v_mfma_f32_16x16x32_bf16 v[130:133], v[234:237], a[240:243], v[130:133]
    s_waitcnt lgkmcnt(3)
    buffer_load_dwordx4 v120, s[52:55], 0 offen lds
    v_fmac_f32 v181, v135, v135
    v_mfma_f32_16x16x32_bf16 v[130:133], v[234:237], v[90:93], v[130:133]
    s_waitcnt lgkmcnt(1)
    v_fmac_f32 v181, v136, v136
    v_fmac_f32 v181, v137, v137
    v_mfma_f32_16x16x32_bf16 v[122:125], v[190:193], a[156:159], v[122:125]
    v_cvt_pk_bf16_f32 v36, v181, v255
    v_cvt_pk_bf16_f32 v174, v154, v155
    v_mfma_f32_16x16x32_bf16 v[122:125], v[194:197], a[160:163], v[122:125]
    s_waitcnt vmcnt(7)
    ds_read_b64 a[232:233], v183 offset:3072
    ds_read_b64 a[220:221], v183 offset:4608
    v_mfma_f32_16x16x32_bf16 v[214:217], v[32:35], v[36:39], 0
    ds_read_b64 v[82:83], v183 offset:3080
    ds_read_b64 a[244:245], v183 offset:4616
    v_mfma_f32_16x16x32_bf16 v[122:125], v[186:189], a[164:167], v[122:125]
    buffer_load_dwordx4 v159, s[52:55], 0 offen offset:1024 lds
    ds_read_b64 v[106:107], v184 offset:3072
    v_mfma_f32_16x16x32_bf16 v[206:209], v[238:241], a[168:171], 0
    ds_read_b64 v[94:95], v184 offset:4608
    v_mov_b32 v255, v130
    v_mfma_f32_16x16x32_bf16 v[206:209], v[202:205], a[172:175], v[206:209]
    v_rsq_f32 v215, v215
    v_mfma_f32_16x16x32_bf16 v[206:209], v[218:221], a[176:179], v[206:209]
    v_mov_b32_dpp v255, v131 quad_perm:[0,1,2,3] row_mask:0x2 bank_mask:0xf
    v_mul_f32 v150, v215, v150
    v_mfma_f32_16x16x32_bf16 v[206:209], v[190:193], a[180:183], v[206:209]
    v_rsq_f32 v214, v214
    v_mfma_f32_16x16x32_bf16 v[206:209], v[194:197], a[184:187], v[206:209]
    buffer_load_dwordx4 v121, s[52:55], 0 offen offset:2048 lds
    v_mul_f32 v214, s31, v214
    v_mfma_f32_16x16x32_bf16 v[206:209], v[186:189], a[188:191], v[206:209]
    s_add_u32 s52, s52, 12288
    v_mul_f32 v151, v215, v151
    v_cvt_pk_f16_f32 v130, v150, v151
    v_mfma_f32_16x16x32_bf16 v[246:249], v[238:241], a[192:195], 0
    s_addc_u32 s53, s53, 0
    v_mul_f32 v152, v215, v152
    v_mul_f32 v153, v215, v153
    v_mfma_f32_16x16x32_bf16 v[246:249], v[202:205], a[196:199], v[246:249]
    s_add_u32 m0, s69, 3072
    v_cvt_pk_f16_f32 v131, v152, v153
    v_mul_f32 v162, v215, v162
    v_mfma_f32_16x16x32_bf16 v[246:249], v[218:221], a[200:203], v[246:249]
    s_waitcnt lgkmcnt(0)
    v_mul_f32 v163, v215, v163
    v_cvt_pk_f16_f32 v132, v162, v163
    v_mfma_f32_16x16x32_bf16 v[246:249], v[190:193], a[204:207], v[246:249]
    buffer_load_dwordx4 v120, s[52:55], 0 offen lds
    v_mul_f32 v164, v215, v164
    s_waitcnt vmcnt(7)
    v_mfma_f32_16x16x32_bf16 v[246:249], v[194:197], a[208:211], v[246:249]
    s_add_u32 s69, s77, 589824
    ds_read_b64 a[222:223], v182 offset:0
    ds_read_b64 a[234:235], v182 offset:1536
    v_mfma_f32_16x16x32_bf16 v[246:249], v[186:189], a[212:215], v[246:249]
    s_barrier
    s_barrier
    ds_read_b64 a[246:247], v182 offset:8
    ds_read_b64 v[84:85], v182 offset:1544
    ds_read_b64 v[96:97], v127 offset:0
    ds_read_b64 v[108:109], v127 offset:1536
    ds_read_b128 v[150:153], v0 offset:26624
    ds_read_b128 v[186:189], v1 offset:26624
    buffer_load_dwordx4 v159, s[52:55], 0 offen offset:1024 lds
    ds_read_b128 v[238:241], v0 offset:26752
    ds_read_b128 v[202:205], v1 offset:26752
    ds_read_b128 v[158:161], v0 offset:26880
    ds_read_b128 v[190:193], v1 offset:26880
    v_mul_f32 v165, v215, v165
    s_waitcnt lgkmcnt(11)
    v_mfma_f32_16x16x32_bf16 v[194:197], v[234:237], a[220:223], 0
    s_waitcnt lgkmcnt(10)
    buffer_load_dwordx4 v121, s[52:55], 0 offen offset:2048 lds
    v_cvt_pk_f16_f32 v133, v164, v165
    v_mfma_f32_16x16x32_bf16 v[162:165], v[234:237], a[232:235], 0
    s_waitcnt lgkmcnt(8)
    v_mul_f32 v170, v215, v170
    v_mul_f32 v171, v215, v171
    v_mfma_f32_16x16x32_bf16 v[194:197], v[234:237], a[244:247], v[194:197]
    s_waitcnt lgkmcnt(4)
    v_cvt_pk_f16_f32 v128, v170, v171
    v_mul_f32 v172, v215, v172
    v_mfma_f32_16x16x32_bf16 v[194:197], v[234:237], v[94:97], v[194:197]
    s_add_u32 m0, s28, 65536
    v_mul_f32 v173, v215, v173
    v_cvt_pk_f16_f32 v129, v172, v173
    v_mfma_f32_16x16x32_bf16 v[162:165], v[234:237], v[82:85], v[162:165]
    s_waitcnt lgkmcnt(2)
    v_mul_f32 v138, v214, v138
    s_waitcnt vmcnt(6)
    v_mfma_f32_16x16x32_bf16 v[162:165], v[234:237], v[106:109], v[162:165]
    s_waitcnt lgkmcnt(1)
    buffer_load_dwordx4 v10, s[8:11], s24 offen nt lds
    v_mfma_f32_16x16x32_bf16 v[170:173], a[72:75], v[150:153], 0
    s_add_u32 m0, s28, 69632
    ds_read_b64 a[224:225], v182 offset:3072
    ds_read_b64 a[226:227], v182 offset:4608
    v_mfma_f32_16x16x32_bf16 v[170:173], a[76:79], v[186:189], v[170:173]
    s_waitcnt lgkmcnt(2)
    ds_read_b64 a[248:249], v182 offset:3080
    ds_read_b64 a[250:251], v182 offset:4616
    v_mfma_f32_16x16x32_bf16 v[170:173], a[80:83], v[238:241], v[170:173]
    ds_read_b64 v[98:99], v127 offset:3072
    ds_read_b64 v[100:101], v127 offset:4608
    v_mfma_f32_16x16x32_bf16 v[170:173], a[84:87], v[202:205], v[170:173]
    v_mov_b32_dpp v255, v162 quad_perm:[0,1,2,3] row_mask:0x4 bank_mask:0xf
    v_mov_b32 v182, v195
    v_mfma_f32_16x16x32_bf16 v[170:173], a[88:91], v[158:161], v[170:173]
    buffer_load_dwordx4 v11, s[8:11], s24 offen nt lds
    v_mfma_f32_16x16x32_bf16 v[170:173], a[92:95], v[190:193], v[170:173]
    s_add_u32 m0, s28, 73728
    v_mov_b32_dpp v255, v194 quad_perm:[0,1,2,3] row_mask:0x8 bank_mask:0xf
    v_mov_b32_dpp v182, v163 quad_perm:[0,1,2,3] row_mask:0x2 bank_mask:0xf
    v_mfma_f32_16x16x32_bf16 v[162:165], a[96:99], v[150:153], 0
    ds_write_b32 v254, v255 offset:18432
    v_mfma_f32_16x16x32_bf16 v[162:165], a[100:103], v[186:189], v[162:165]
    v_mul_f32 v139, v214, v139
    v_cvt_pk_f16_f32 v138, v138, v139
    v_mfma_f32_16x16x32_bf16 v[162:165], a[104:107], v[238:241], v[162:165]
    s_waitcnt lgkmcnt(5)
    v_mul_f32 v140, v214, v140
    v_mul_f32 v141, v214, v141
    v_mfma_f32_16x16x32_bf16 v[194:197], v[234:237], a[224:227], 0
    s_waitcnt lgkmcnt(3)
    buffer_load_dwordx4 v12, s[8:11], s24 offen nt lds
    v_mfma_f32_16x16x32_bf16 v[194:197], v[234:237], a[248:251], v[194:197]
    s_waitcnt lgkmcnt(1)
    v_cvt_pk_f16_f32 v139, v140, v141
    v_mul_f32 v166, v214, v166
    v_mfma_f32_16x16x32_bf16 v[194:197], v[234:237], v[98:101], v[194:197]
    s_add_u32 m0, s28, 77824
    v_mul_f32 v167, v214, v167
    s_waitcnt vmcnt(6)
    v_mfma_f32_16x16x32_bf16 v[162:165], a[108:111], v[202:205], v[162:165]
    ds_read_b64 a[236:237], v183 offset:0
    ds_read_b64 a[228:229], v183 offset:1536
    v_mfma_f32_16x16x32_bf16 v[162:165], a[112:115], v[158:161], v[162:165]
    ds_read_b64 v[86:87], v183 offset:8
    ds_read_b64 a[252:253], v183 offset:1544
    v_mfma_f32_16x16x32_bf16 v[162:165], a[116:119], v[190:193], v[162:165]
    buffer_load_dwordx4 v13, s[8:11], s24 offen nt lds
    v_mfma_f32_16x16x32_bf16 v[218:221], a[120:123], v[150:153], 0
    s_add_u32 m0, s74, 0
    ds_read_b64 v[110:111], v184 offset:0
    ds_read_b64 v[102:103], v184 offset:1536
    v_mfma_f32_16x16x32_bf16 v[218:221], a[124:127], v[186:189], v[218:221]
    v_mov_b32_dpp v182, v194 quad_perm:[0,1,2,3] row_mask:0x4 bank_mask:0xf
    v_cvt_pk_f16_f32 v140, v166, v167
    v_mfma_f32_16x16x32_bf16 v[218:221], a[128:131], v[238:241], v[218:221]
    v_mov_b32_dpp v182, v195 quad_perm:[0,1,2,3] row_mask:0x8 bank_mask:0xf
    v_mul_f32 v168, v214, v168
    v_mfma_f32_16x16x32_bf16 v[218:221], a[132:135], v[202:205], v[218:221]
    ds_write_b32 v254, v182 offset:19456
    v_mfma_f32_16x16x32_bf16 v[218:221], a[136:139], v[158:161], v[218:221]
    buffer_load_dwordx4 v14, s[8:11], s24 offen nt lds
    v_mfma_f32_16x16x32_bf16 v[218:221], a[140:143], v[190:193], v[218:221]
    s_add_u32 s8, s60, s23
    v_mul_f32 v169, v214, v169
    v_cvt_pk_f16_f32 v141, v168, v169
    v_mfma_f32_16x16x32_bf16 v[166:169], a[0:3], v[150:153], 0
    s_addc_u32 s9, s61, 0
    v_mul_f32 v134, v214, v134
    v_mul_f32 v135, v214, v135
    v_mfma_f32_16x16x32_bf16 v[166:169], a[4:7], v[186:189], v[166:169]
    s_sub_u32 s10, s36, s23
    v_cvt_pk_f16_f32 v126, v134, v135
    v_mul_f32 v136, v214, v136
    v_mfma_f32_16x16x32_bf16 v[166:169], a[8:11], v[238:241], v[166:169]
    s_cmp_lt_u32 s34, s17
    v_mul_f32 v137, v214, v137
    v_cvt_pk_f16_f32 v127, v136, v137
    v_mfma_f32_16x16x32_bf16 v[166:169], a[12:15], v[202:205], v[166:169]
    s_cselect_b32 s10, s10, 0
    v_cvt_pk_bf16_f32 v175, v156, v157
    v_cvt_pk_bf16_f32 v114, v114, v114
    v_mfma_f32_16x16x32_bf16 v[166:169], a[16:19], v[158:161], v[166:169]
    s_add_u32 m0, s28, 0
    v_cvt_pk_bf16_f32 v115, v115, v115
    s_waitcnt vmcnt(5)
    v_mfma_f32_16x16x32_bf16 v[166:169], a[20:23], v[190:193], v[166:169]
    s_mov_b32 s24, s23
    ds_read_b64 a[230:231], v183 offset:3072
    ds_read_b64 a[238:239], v183 offset:4608
    v_mfma_f32_16x16x32_bf16 v[134:137], a[24:27], v[150:153], 0
    s_add_u32 s23, s23, s21
    ds_read_b64 a[254:255], v183 offset:3080
    ds_read_b64 v[88:89], v183 offset:4616
    v_mfma_f32_16x16x32_bf16 v[134:137], a[28:31], v[186:189], v[134:137]
    s_cmp_ge_u32 s19, 72
    ds_read_b64 v[104:105], v184 offset:3072
    ds_read_b64 v[112:113], v184 offset:4608
    v_mfma_f32_16x16x32_bf16 v[134:137], a[32:35], v[238:241], v[134:137]
    s_cselect_b32 s34, 72, 0
    ds_write2_b32 v177, v114, v115 offset0:0 offset1:68
    v_mfma_f32_16x16x32_bf16 v[134:137], a[36:39], v[202:205], v[134:137]
    s_cselect_b32 s35, s22, 0
    v_cvt_pk_bf16_f32 v116, v116, v116
    v_cvt_pk_bf16_f32 v117, v117, v117
    v_mfma_f32_16x16x32_bf16 v[134:137], a[40:43], v[158:161], v[134:137]
    s_sub_u32 s19, s19, s34
    ds_write2_b32 v177, v116, v117 offset0:136 offset1:204
    v_mfma_f32_16x16x32_bf16 v[134:137], a[44:47], v[190:193], v[134:137]
    s_add_u32 s23, s23, s35
    v_cvt_pk_bf16_f32 v230, v230, v230
    v_cvt_pk_bf16_f32 v231, v231, v231
    v_mfma_f32_16x16x32_bf16 v[114:117], a[48:51], v[150:153], 0
    s_waitcnt lgkmcnt(6)
    ds_write2_b32 v177, v230, v231 offset0:16 offset1:84
    v_mfma_f32_16x16x32_bf16 v[154:157], v[234:237], a[228:231], 0
    s_waitcnt lgkmcnt(5)
    v_cvt_pk_bf16_f32 v232, v232, v232
    v_cvt_pk_bf16_f32 v233, v233, v233
    v_mfma_f32_16x16x32_bf16 v[154:157], v[234:237], a[252:255], v[154:157]
    s_waitcnt lgkmcnt(3)
    ds_write2_b32 v177, v232, v233 offset0:152 offset1:220
    v_mfma_f32_16x16x32_bf16 v[154:157], v[234:237], v[102:105], v[154:157]
    v_cvt_pk_bf16_f32 v222, v222, v222
    v_cvt_pk_bf16_f32 v223, v223, v223
    v_mfma_f32_16x16x32_bf16 v[230:233], v[234:237], a[236:239], 0
    ds_write2_b32 v177, v222, v223 offset0:32 offset1:100
    v_mfma_f32_16x16x32_bf16 v[230:233], v[234:237], v[86:89], v[230:233]
    v_cvt_pk_bf16_f32 v224, v224, v224
    v_cvt_pk_bf16_f32 v225, v225, v225
    v_mfma_f32_16x16x32_bf16 v[230:233], v[234:237], v[110:113], v[230:233]
    ds_write2_b32 v177, v224, v225 offset0:168 offset1:236
    v_mfma_f32_16x16x32_bf16 v[114:117], a[52:55], v[186:189], v[114:117]
    v_cvt_pk_bf16_f32 v122, v122, v122
    v_cvt_pk_bf16_f32 v123, v123, v123
    v_mfma_f32_16x16x32_bf16 v[114:117], a[56:59], v[238:241], v[114:117]
    ds_write2_b32 v178, v122, v123 offset0:0 offset1:68
    v_mfma_f32_16x16x32_bf16 v[114:117], a[60:63], v[202:205], v[114:117]
    v_cvt_pk_bf16_f32 v124, v124, v124
    v_mov_b32 v255, v230
    v_mfma_f32_16x16x32_bf16 v[114:117], a[64:67], v[158:161], v[114:117]
    v_cvt_pk_bf16_f32 v125, v125, v125
    v_mov_b32_dpp v255, v154 quad_perm:[0,1,2,3] row_mask:0x2 bank_mask:0xf
    v_mfma_f32_16x16x32_bf16 v[114:117], a[68:71], v[190:193], v[114:117]
    ds_write2_b32 v178, v124, v125 offset0:136 offset1:204
    v_mfma_f32_16x16x32_bf16 v[122:125], v[150:153], a[144:147], 0
    v_mov_b32_dpp v255, v155 quad_perm:[0,1,2,3] row_mask:0x4 bank_mask:0xf
    v_cvt_pk_bf16_f32 v206, v206, v206
    v_mfma_f32_16x16x32_bf16 v[122:125], v[186:189], a[148:151], v[122:125]
    v_mov_b32_dpp v255, v231 quad_perm:[0,1,2,3] row_mask:0x8 bank_mask:0xf
    v_cvt_pk_bf16_f32 v207, v207, v207
    v_mfma_f32_16x16x32_bf16 v[122:125], v[238:241], a[152:155], v[122:125]
    ds_write_b32 v254, v255 offset:63552
    v_mfma_f32_16x16x32_bf16 v[122:125], v[202:205], a[156:159], v[122:125]
    v_cvt_pk_bf16_f32 v208, v208, v208
    v_cvt_pk_bf16_f32 v209, v209, v209
    v_mfma_f32_16x16x32_bf16 v[122:125], v[158:161], a[160:163], v[122:125]
    ds_write2_b32 v178, v206, v207 offset0:16 offset1:84
    v_mfma_f32_16x16x32_bf16 v[122:125], v[190:193], a[164:167], v[122:125]
    v_cvt_pk_bf16_f32 v246, v246, v246
    v_cvt_pk_bf16_f32 v247, v247, v247
    v_mfma_f32_16x16x32_bf16 v[154:157], v[150:153], a[168:171], 0
    ds_write2_b32 v178, v208, v209 offset0:152 offset1:220
    v_mfma_f32_16x16x32_bf16 v[154:157], v[186:189], a[172:175], v[154:157]
    v_cvt_pk_bf16_f32 v248, v248, v248
    v_cvt_pk_bf16_f32 v249, v249, v249
    v_mfma_f32_16x16x32_bf16 v[154:157], v[238:241], a[176:179], v[154:157]
    ds_write2_b32 v178, v246, v247 offset0:32 offset1:100
    v_mfma_f32_16x16x32_bf16 v[154:157], v[202:205], a[180:183], v[154:157]
    s_waitcnt lgkmcnt(3)
    v_cvt_pk_bf16_f32 v120, v122, v123
    v_cvt_pk_bf16_f32 v121, v124, v125
    v_mfma_f32_16x16x32_bf16 v[154:157], v[158:161], a[184:187], v[154:157]
    s_barrier
    ds_read_b128 v[230:233], v0 offset:32768
    ds_read_b128 v[122:125], v1 offset:32768
    v_mfma_f32_16x16x32_bf16 v[154:157], v[190:193], a[188:191], v[154:157]
    ds_read_b128 v[206:209], v0 offset:32896
    ds_read_b128 v[222:225], v185 offset:18432
    v_mfma_f32_16x16x32_bf16 v[234:237], v[150:153], a[192:195], 0
    v_fma_f32 v148, v166, v166, s32
    v_fmac_f32 v148, v167, v167
    v_mfma_f32_16x16x32_bf16 v[234:237], v[186:189], a[196:199], v[234:237]
    ds_read_b128 v[186:189], v1 offset:32896
    ds_read_b128 v[150:153], v0 offset:33024
    v_mfma_f32_16x16x32_bf16 v[234:237], v[238:241], a[200:203], v[234:237]
    v_fmac_f32 v148, v168, v168
    v_fmac_f32 v148, v169, v169
    v_mfma_f32_16x16x32_bf16 v[234:237], v[202:205], a[204:207], v[234:237]
    ds_read_b128 v[238:241], v1 offset:33024
    ds_read_b128 v[202:205], v185 offset:19456
    v_mfma_f32_16x16x32_bf16 v[234:237], v[158:161], a[208:211], v[234:237]
    v_fmac_f32 v148, v134, v134
    v_fmac_f32 v148, v135, v135
    v_mfma_f32_16x16x32_bf16 v[234:237], v[190:193], a[212:215], v[234:237]
    ds_read_b128 v[190:193], v185 offset:63552
    v_fmac_f32 v148, v136, v136
    v_mfma_f32_16x16x32_f16 v[158:161], v[130:133], v[138:141], v[46:49]
    s_waitcnt lgkmcnt(7)
    ds_write2_b32 v178, v248, v249 offset0:168 offset1:236
    v_mfma_f32_16x16x32_bf16 v[178:181], a[72:75], v[230:233], 0
    s_waitcnt lgkmcnt(6)
    v_add_f32 v222, v222, v223
    v_add_f32 v224, v224, v225
    v_mfma_f32_16x16x32_bf16 v[178:181], a[76:79], v[122:125], v[178:181]
    s_waitcnt lgkmcnt(5)
    v_add_f32 v222, v222, v224
    v_mul_f32 v222, 0xbbaaaaab, v222
    v_mfma_f32_16x16x32_bf16 v[178:181], a[80:83], v[206:209], v[178:181]
    s_waitcnt lgkmcnt(4)
    ds_write_b32 v142, v222 offset:0
    v_mfma_f32_16x16x32_bf16 v[178:181], a[84:87], v[186:189], v[178:181]
    s_waitcnt lgkmcnt(4)
    v_fmac_f32 v148, v137, v137
    v_fmac_f32 v148, v114, v114
    v_mfma_f32_16x16x32_bf16 v[178:181], a[88:91], v[150:153], v[178:181]
    s_waitcnt lgkmcnt(3)
    ds_read_b128 v[222:225], v143 offset:0
    ds_read_b128 v[182:185], v143 offset:64
    v_mfma_f32_16x16x32_bf16 v[178:181], a[92:95], v[238:241], v[178:181]
    s_waitcnt lgkmcnt(4)
    v_add_f32 v202, v202, v203
    v_add_f32 v204, v204, v205
    v_mfma_f32_16x16x32_bf16 v[194:197], a[96:99], v[230:233], 0
    v_add_f32 v202, v202, v204
    v_mul_f32 v202, 0xbbaaaaab, v202
    v_mfma_f32_16x16x32_bf16 v[194:197], a[100:103], v[122:125], v[194:197]
    ds_write_b32 v142, v202 offset:256
    v_mfma_f32_16x16x32_bf16 v[194:197], a[104:107], v[206:209], v[194:197]
    v_add_f32 v190, v190, v191
    v_add_f32 v192, v192, v193
    v_mfma_f32_16x16x32_bf16 v[194:197], a[108:111], v[186:189], v[194:197]
    v_add_f32 v190, v190, v192
    v_mul_f32 v190, 0xbbaaaaab, v190
    v_mfma_f32_16x16x32_bf16 v[194:197], a[112:115], v[150:153], v[194:197]
    ds_write_b32 v142, v190 offset:512
    v_mfma_f32_16x16x32_bf16 v[194:197], a[116:119], v[238:241], v[194:197]
    v_fmac_f32 v148, v115, v115
    v_fmac_f32 v148, v116, v116
    v_mfma_f32_16x16x32_bf16 v[202:205], a[120:123], v[230:233], 0
    s_waitcnt lgkmcnt(2)
    v_fmac_f32 v148, v117, v117
    v_fma_f32 v142, v170, v170, s32
    v_mfma_f32_16x16x32_bf16 v[202:205], a[124:127], v[122:125], v[202:205]
    v_fmac_f32 v142, v171, v171
    v_fmac_f32 v142, v172, v172
    v_mfma_f32_16x16x32_bf16 v[202:205], a[128:131], v[206:209], v[202:205]
    v_fmac_f32 v142, v173, v173
    v_fmac_f32 v142, v162, v162
    v_mfma_f32_16x16x32_bf16 v[202:205], a[132:135], v[186:189], v[202:205]
    v_fmac_f32 v142, v163, v163
    v_fmac_f32 v142, v164, v164
    v_mfma_f32_16x16x32_bf16 v[202:205], a[136:139], v[150:153], v[202:205]
    v_fmac_f32 v142, v165, v165
    v_fmac_f32 v142, v218, v218
    v_mfma_f32_16x16x32_bf16 v[202:205], a[140:143], v[238:241], v[202:205]
    v_fmac_f32 v142, v219, v219
    v_fmac_f32 v142, v220, v220
    v_mfma_f32_16x16x32_bf16 v[190:193], a[0:3], v[230:233], 0
    v_fmac_f32 v142, v221, v221
    v_cvt_pk_bf16_f32 v36, v148, v142
    v_mfma_f32_16x16x32_bf16 v[190:193], a[4:7], v[122:125], v[190:193]
    v_cvt_pk_bf16_f32 v148, v154, v155
    v_cvt_pk_bf16_f32 v149, v156, v157
    v_mfma_f32_16x16x32_bf16 v[154:157], v[32:35], v[36:39], 0
    v_cvt_pk_bf16_f32 v176, v234, v235
    v_cvt_pk_bf16_f32 v177, v236, v237
    v_mfma_f32_16x16x32_bf16 v[190:193], a[8:11], v[206:209], v[190:193]
    v_fma_f32 v142, v178, v178, s32
    v_fmac_f32 v142, v179, v179
    v_mfma_f32_16x16x32_bf16 v[190:193], a[12:15], v[186:189], v[190:193]
    v_fmac_f32 v142, v180, v180
    v_fmac_f32 v142, v181, v181
    v_mfma_f32_16x16x32_bf16 v[190:193], a[16:19], v[150:153], v[190:193]
    v_rsq_f32 v155, v155
    v_mfma_f32_16x16x32_bf16 v[190:193], a[20:23], v[238:241], v[190:193]
    v_rsq_f32 v154, v154
    v_mfma_f32_16x16x32_bf16 v[234:237], a[24:27], v[230:233], 0
    v_mul_f32 v154, s31, v154
    v_mul_f32 v170, v155, v170
    v_mfma_f32_16x16x32_bf16 v[234:237], a[28:31], v[122:125], v[234:237]
    ds_read2_b32 v[248:249], v6 offset0:0 offset1:0
    ds_read2_b32 v[156:157], v6 offset0:16 offset1:16
    v_mfma_f32_16x16x32_bf16 v[234:237], a[32:35], v[206:209], v[234:237]
    ds_read2_b32 v[216:217], v6 offset0:32 offset1:32
    v_mul_f32 v171, v155, v171
    v_mfma_f32_16x16x32_bf16 v[234:237], a[36:39], v[186:189], v[234:237]
    v_cvt_pk_f16_f32 v170, v170, v171
    v_mul_f32 v172, v155, v172
    v_mfma_f32_16x16x32_bf16 v[234:237], a[40:43], v[150:153], v[234:237]
    v_mul_f32 v173, v155, v173
    v_cvt_pk_f16_f32 v171, v172, v173
    v_mfma_f32_16x16x32_bf16 v[234:237], a[44:47], v[238:241], v[234:237]
    v_mul_f32 v162, v155, v162
    v_mul_f32 v163, v155, v163
    v_cvt_pk_f16_f32 v172, v162, v163
    v_mfma_f32_16x16x16_f16 v[158:161], v[128:129], v[126:127], v[158:161]
    v_mul_f32 v164, v155, v164
    v_mul_f32 v165, v155, v165
    v_cvt_pk_f16_f32 v173, v164, v165
    v_mul_f32 v218, v155, v218
    v_mfma_f32_16x16x32_bf16 v[162:165], a[48:51], v[230:233], 0
    v_mul_f32 v219, v155, v219
    v_cvt_pk_f16_f32 v228, v218, v219
    v_mfma_f32_16x16x32_bf16 v[162:165], a[52:55], v[122:125], v[162:165]
    s_waitcnt lgkmcnt(1)
    v_mul_f32 v220, v155, v220
    v_mul_f32 v221, v155, v221
    v_mfma_f32_16x16x32_bf16 v[162:165], a[56:59], v[206:209], v[162:165]
    s_waitcnt lgkmcnt(0)
    v_cvt_pk_f16_f32 v229, v220, v221
    v_mul_f32 v166, v154, v166
    v_mfma_f32_16x16x32_bf16 v[162:165], a[60:63], v[186:189], v[162:165]
    v_mul_f32 v167, v154, v167
    v_cvt_pk_f16_f32 v166, v166, v167
    v_mfma_f32_16x16x32_bf16 v[162:165], a[64:67], v[150:153], v[162:165]
    v_mul_f32 v168, v154, v168
    v_mul_f32 v169, v154, v169
    v_mfma_f32_16x16x32_bf16 v[162:165], a[68:71], v[238:241], v[162:165]
    v_cvt_pk_f16_f32 v167, v168, v169
    v_mul_f32 v134, v154, v134
    v_mfma_f32_16x16x32_bf16 v[218:221], v[230:233], a[144:147], 0
    v_mul_f32 v135, v154, v135
    v_cvt_pk_f16_f32 v168, v134, v135
    v_mfma_f32_16x16x32_bf16 v[218:221], v[122:125], a[148:151], v[218:221]
    v_mul_f32 v136, v154, v136
    v_mul_f32 v137, v154, v137
    v_mfma_f32_16x16x32_bf16 v[218:221], v[206:209], a[152:155], v[218:221]
    v_cvt_pk_f16_f32 v169, v136, v137
    v_mul_f32 v114, v154, v114
    v_mfma_f32_16x16x32_bf16 v[218:221], v[186:189], a[156:159], v[218:221]
    v_mul_f32 v115, v154, v115
    v_cvt_pk_f16_f32 v226, v114, v115
    v_mfma_f32_16x16x32_bf16 v[218:221], v[150:153], a[160:163], v[218:221]
    v_mul_f32 v116, v154, v116
    v_mul_f32 v117, v154, v117
    v_mfma_f32_16x16x32_bf16 v[218:221], v[238:241], a[164:167], v[218:221]
    v_cvt_pk_f16_f32 v227, v116, v117
    v_fma_f32 v154, v190, v190, s32
    v_mfma_f32_16x16x32_bf16 v[114:117], v[230:233], a[168:171], 0
    v_fmac_f32 v154, v191, v191
    v_fmac_f32 v154, v192, v192
    v_mfma_f32_16x16x32_bf16 v[114:117], v[122:125], a[172:175], v[114:117]
    ds_read_b32 v254, v6 offset:192
    v_fmac_f32 v154, v193, v193
    v_mfma_f32_16x16x32_bf16 v[114:117], v[206:209], a[176:179], v[114:117]
    v_cvt_pk_bf16_f32 v246, v218, v219
    v_cvt_pk_bf16_f32 v247, v220, v221
    v_mfma_f32_16x16x32_bf16 v[114:117], v[186:189], a[180:183], v[114:117]
    v_fmac_f32 v154, v234, v234
    v_fmac_f32 v154, v235, v235
    v_mfma_f32_16x16x32_bf16 v[114:117], v[150:153], a[184:187], v[114:117]
    v_fmac_f32 v154, v236, v236
    v_fmac_f32 v154, v237, v237
    v_mfma_f32_16x16x32_bf16 v[114:117], v[238:241], a[188:191], v[114:117]
    v_fmac_f32 v154, v162, v162
    v_fmac_f32 v154, v163, v163
    v_fmac_f32 v154, v164, v164
    v_fmac_f32 v154, v165, v165
    v_fmac_f32 v142, v194, v194
    v_fmac_f32 v142, v195, v195
    v_fmac_f32 v142, v196, v196
    v_fmac_f32 v142, v197, v197
    v_fmac_f32 v142, v202, v202
    v_fmac_f32 v142, v203, v203
    v_fmac_f32 v142, v204, v204
    v_fmac_f32 v142, v205, v205
    v_cvt_pk_bf16_f32 v36, v154, v142
    v_mfma_f32_16x16x32_bf16 v[218:221], v[230:233], a[192:195], 0
    s_waitcnt lgkmcnt(0)
    ds_read_b128 v[134:137], v5 offset:0
    v_cvt_pk_bf16_f32 v154, v114, v115
    v_mfma_f32_16x16x32_bf16 v[218:221], v[122:125], a[196:199], v[218:221]
    ds_read_b128 v[122:125], v5 offset:16
    v_cvt_pk_bf16_f32 v155, v116, v117
    v_mfma_f32_16x16x32_bf16 v[218:221], v[206:209], a[200:203], v[218:221]
    ds_read_b128 v[114:117], v5 offset:48
    v_xor_b32 v0, 65536, v0
    v_mfma_f32_16x16x32_bf16 v[218:221], v[186:189], a[204:207], v[218:221]
    v_xor_b32 v1, 65536, v1
    v_add_u32 v5, 336, v5
    v_mfma_f32_16x16x32_bf16 v[186:189], v[32:35], v[36:39], 0
    v_add_u32 v6, 272, v6
    v_mfma_f32_16x16x32_bf16 v[218:221], v[150:153], a[208:211], v[218:221]
    v_mfma_f32_16x16x32_f16 v[150:153], v[170:173], v[138:141], v[50:53]
    v_mfma_f32_16x16x32_bf16 v[218:221], v[238:241], a[212:215], v[218:221]
    v_mfma_f32_16x16x16_bf16 v[230:233], a[216:217], v[144:145], v[222:225]
    v_mfma_f32_16x16x16_bf16 v[238:241], a[240:241], v[144:145], v[222:225]
    s_nop 0
    s_nop 0
    v_rsq_f32 v187, v187
    v_mfma_f32_16x16x16_f16 v[150:153], v[228:229], v[126:127], v[150:153]
    v_rsq_f32 v186, v186
    v_mul_f32 v178, v187, v178
    v_mul_f32 v186, s31, v186
    s_waitcnt vmcnt(0)
    s_barrier
    buffer_load_dwordx4 v10, s[8:11], 0 offen nt lds
    s_add_u32 m0, s28, 4096
    v_cvt_pk_bf16_f32 v214, v218, v219
    v_cvt_pk_bf16_f32 v215, v220, v221
    v_mul_f32 v179, v187, v179
    v_cvt_pk_f16_f32 v178, v178, v179
    v_mul_f32 v180, v187, v180
    v_mul_f32 v181, v187, v181
    v_cvt_pk_f16_f32 v179, v180, v181
    v_mfma_f32_16x16x16_bf16 v[218:221], v[90:91], v[144:145], v[222:225]
    v_mul_f32 v194, v187, v194
    v_mul_f32 v195, v187, v195
    v_cvt_pk_f16_f32 v180, v194, v195
    v_mfma_f32_16x16x16_bf16 v[206:209], a[218:219], v[144:145], v[182:185]
    v_mul_f32 v196, v187, v196
    v_mul_f32 v197, v187, v197
    buffer_load_dwordx4 v11, s[8:11], 0 offen nt lds
    s_add_u32 m0, s28, 8192
    v_cvt_pk_f16_f32 v181, v196, v197
    v_mul_f32 v202, v187, v202
    v_mul_f32 v203, v187, v203
    v_cvt_pk_f16_f32 v224, v202, v203
    v_mul_f32 v204, v187, v204
    v_mul_f32 v205, v187, v205
    v_mfma_f32_16x16x32_f16 v[194:197], v[178:181], v[138:141], v[54:57]
    v_cvt_pk_f16_f32 v225, v204, v205
    v_mul_f32 v190, v186, v190
    v_mul_f32 v191, v186, v191
    v_cvt_pk_f16_f32 v202, v190, v191
    v_mul_f32 v192, v186, v192
    v_mul_f32 v193, v186, v193
    v_mfma_f32_16x16x16_f16 v[194:197], v[224:225], v[126:127], v[194:197]
    buffer_load_dwordx4 v12, s[8:11], 0 offen nt lds
    s_add_u32 m0, s28, 12288
    s_xor_b32 s28, s28, 65536
    v_cvt_pk_f16_f32 v203, v192, v193
    v_mul_f32 v234, v186, v234
    v_mul_f32 v235, v186, v235
    v_cvt_pk_f16_f32 v204, v234, v235
    v_mfma_f32_16x16x16_bf16 v[190:193], a[242:243], v[144:145], v[182:185]
    v_mul_f32 v236, v186, v236
    v_mul_f32 v237, v186, v237
    v_cvt_pk_f16_f32 v205, v236, v237
    v_mul_f32 v162, v186, v162
    v_mul_f32 v163, v186, v163
    v_cvt_pk_f16_f32 v222, v162, v163
    v_mul_f32 v164, v186, v164
    v_mul_f32 v165, v186, v165
    buffer_load_dwordx4 v13, s[8:11], 0 offen nt lds
    s_mov_b32 m0, s29
    s_xor_b32 s29, s29, s30
    v_cvt_pk_f16_f32 v223, v164, v165
    v_mfma_f32_16x16x16_bf16 v[162:165], v[92:93], v[144:145], v[182:185]
    s_waitcnt lgkmcnt(0)
    v_cvt_pk_bf16_f32 v230, v230, v231
    v_accvgpr_write_b32 a216, v230
    v_cvt_pk_bf16_f32 v232, v232, v233
    v_mfma_f32_16x16x32_f16 v[182:185], v[134:137], v[138:141], v[22:25]
    v_accvgpr_write_b32 a217, v232
    v_cvt_pk_bf16_f32 v238, v238, v239
    v_mfma_f32_16x16x32_f16 v[182:185], v[122:125], v[130:133], v[182:185]
    v_accvgpr_write_b32 a240, v238
    v_cvt_pk_bf16_f32 v240, v240, v241
    v_mfma_f32_16x16x32_f16 v[182:185], v[114:117], v[126:129], v[182:185]
    buffer_load_dwordx4 v14, s[8:11], 0 offen nt lds
    v_accvgpr_write_b32 a241, v240
    v_mfma_f32_16x16x32_f16 v[186:189], v[134:137], v[166:169], v[24:27]
    v_cvt_pk_bf16_f32 v90, v218, v219
    v_cvt_pk_bf16_f32 v91, v220, v221
    v_mfma_f32_16x16x32_f16 v[186:189], v[122:125], v[170:173], v[186:189]
    ds_read_b128 v[138:141], v143 offset:128
    v_cvt_pk_bf16_f32 v206, v206, v207
    v_mfma_f32_16x16x32_f16 v[186:189], v[114:117], v[226:229], v[186:189]
    v_mov_b32_dpp v254, v183 quad_perm:[0,1,2,3] row_mask:0x1 bank_mask:0xf
    v_max3_f32 v142, v182, v158, v159
    v_mfma_f32_16x16x32_f16 v[218:221], v[134:137], v[202:205], v[26:29]
    v_max3_f32 v142, v142, v160, v161
    v_max3_f32 v142, v142, v150, v151
    v_mfma_f32_16x16x32_f16 v[218:221], v[122:125], v[178:181], v[218:221]
    v_max3_f32 v142, v142, v152, v153
    v_max3_f32 v142, v142, v194, v195
    v_mfma_f32_16x16x32_f16 v[218:221], v[114:117], v[222:225], v[218:221]
    v_mov_b32_dpp v254, v187 quad_perm:[0,1,2,3] row_mask:0x2 bank_mask:0xf
    v_max3_f32 v142, v142, v196, v197
    v_mov_b32 v255, v142
    v_accvgpr_write_b32 a218, v206
    v_cvt_pk_bf16_f32 v208, v208, v209
    v_permlane32_swap_b32 v142, v255
    v_max_f32 v142, v142, v255
    v_mov_b32 v255, v142
    v_mov_b32_dpp v254, v219 quad_perm:[0,1,2,3] row_mask:0x4 bank_mask:0xf
    v_accvgpr_write_b32 a219, v208
    v_permlane16_swap_b32 v142, v255
    s_waitcnt lgkmcnt(0)
    v_mfma_f32_16x16x16_bf16 v[114:117], a[232:233], v[144:145], v[138:141]
    v_max_f32 v142, v142, v255
    v_sub_f32 v158, v158, v142
    v_sub_f32 v159, v159, v142
    v_mfma_f32_16x16x16_bf16 v[122:125], v[82:83], v[144:145], v[138:141]
    v_exp_f32 v158, v158
    v_sub_f32 v160, v160, v142
    v_mfma_f32_16x16x16_bf16 v[134:137], v[106:107], v[144:145], v[138:141]
    v_exp_f32 v159, v159
    v_exp_f32 v160, v160
    v_cvt_pk_bf16_f32 v158, v158, v159
    v_sub_f32 v161, v161, v142
    v_exp_f32 v161, v161
    v_sub_f32 v150, v150, v142
    v_cvt_pk_bf16_f32 v159, v160, v161
    v_exp_f32 v150, v150
    v_mfma_f32_16x16x32_f16 v[138:141], v[130:133], v[166:169], v[58:61]
    v_sub_f32 v151, v151, v142
    v_exp_f32 v151, v151
    v_sub_f32 v152, v152, v142
    v_cvt_pk_bf16_f32 v160, v150, v151
    v_exp_f32 v152, v152
    v_sub_f32 v153, v153, v142
    v_mfma_f32_16x16x16_f16 v[138:141], v[128:129], v[226:227], v[138:141]
    v_exp_f32 v153, v153
    v_sub_f32 v194, v194, v142
    v_cvt_pk_bf16_f32 v161, v152, v153
    v_mfma_f32_16x16x32_f16 v[150:153], v[170:173], v[166:169], v[62:65]
    v_exp_f32 v194, v194
    v_sub_f32 v195, v195, v142
    v_exp_f32 v195, v195
    v_sub_f32 v196, v196, v142
    v_cvt_pk_bf16_f32 v36, v194, v195
    v_exp_f32 v196, v196
    v_mfma_f32_16x16x32_f16 v[238:241], v[178:181], v[166:169], v[66:69]
    v_sub_f32 v197, v197, v142
    v_exp_f32 v197, v197
    v_mfma_f32_16x16x16_f16 v[150:153], v[228:229], v[226:227], v[150:153]
    v_cvt_pk_bf16_f32 v37, v196, v197
    v_sub_f32 v182, v182, v142
    v_exp_f32 v182, v182
    v_mfma_f32_16x16x16_f16 v[238:241], v[224:225], v[226:227], v[238:241]
    v_cvt_pk_bf16_f32 v39, v182, 0
    v_cvt_pk_bf16_f32 v190, v190, v191
    v_accvgpr_write_b32 a242, v190
    v_cvt_pk_bf16_f32 v192, v192, v193
    v_mfma_f32_16x16x32_bf16 v[182:185], v[28:31], v[36:39], 0
    v_accvgpr_write_b32 a243, v192
    v_cvt_pk_bf16_f32 v92, v162, v163
    v_mfma_f32_16x16x32_bf16 v[182:185], v[28:31], v[158:161], v[182:185]
    v_cvt_pk_bf16_f32 v93, v164, v165
    v_cvt_pk_bf16_f32 v114, v114, v115
    v_mfma_f32_16x16x32_bf16 v[162:165], v[246:249], v[36:39], 0
    ds_read_b128 v[166:169], v143 offset:192
    v_accvgpr_write_b32 a232, v114
    v_mfma_f32_16x16x32_bf16 v[162:165], v[118:121], v[158:161], v[162:165]
    v_cvt_pk_bf16_f32 v116, v116, v117
    v_accvgpr_write_b32 a233, v116
    v_mfma_f32_16x16x32_bf16 v[230:233], v[154:157], v[36:39], 0
    v_rcp_f32 v182, v182
    v_mfma_f32_16x16x32_bf16 v[230:233], v[146:149], v[158:161], v[230:233]
    v_cvt_pk_bf16_f32 v82, v122, v123
    v_cvt_pk_bf16_f32 v83, v124, v125
    v_mfma_f32_16x16x32_bf16 v[114:117], v[214:217], v[36:39], 0
    v_mul_f32 v162, v182, v162
    v_mul_f32 v163, v182, v163
    v_mfma_f32_16x16x32_bf16 v[114:117], v[174:177], v[158:161], v[114:117]
    v_cvt_pk_bf16_f32 v158, v162, v163
    v_mul_f32 v164, v182, v164
    v_mul_f32 v165, v182, v165
    v_cvt_pk_bf16_f32 v159, v164, v165
    v_mul_f32 v230, v182, v230
    v_mul_f32 v231, v182, v231
    v_cvt_pk_bf16_f32 v160, v230, v231
    v_mul_f32 v232, v182, v232
    s_waitcnt lgkmcnt(0)
    v_mfma_f32_16x16x16_bf16 v[122:125], a[220:221], v[144:145], v[166:169]
    v_mul_f32 v233, v182, v233
    v_cvt_pk_bf16_f32 v161, v232, v233
    v_mul_f32 v114, v182, v114
    v_mfma_f32_16x16x16_bf16 v[162:165], a[244:245], v[144:145], v[166:169]
    v_mul_f32 v115, v182, v115
    v_cvt_pk_bf16_f32 v126, v114, v115
    v_mul_f32 v116, v182, v116
    v_mfma_f32_16x16x16_bf16 v[230:233], v[94:95], v[144:145], v[166:169]
    ds_write_b128 v3, v[158:161] offset:0
    v_mul_f32 v117, v182, v117
    v_cvt_pk_bf16_f32 v127, v116, v117
    v_cvt_pk_bf16_f32 v106, v134, v135
    v_cvt_pk_bf16_f32 v107, v136, v137
    v_cvt_pk_bf16_f32 v122, v122, v123
    v_accvgpr_write_b32 a220, v122
    v_cvt_pk_bf16_f32 v124, v124, v125
    ds_read_b128 v[158:161], v143 offset:256
    ds_write_b64 v4, v[126:127] offset:4096
    v_accvgpr_write_b32 a221, v124
    v_cvt_pk_bf16_f32 v162, v162, v163
    v_accvgpr_write_b32 a244, v162
    v_cvt_pk_bf16_f32 v164, v164, v165
    v_accvgpr_write_b32 a245, v164
    v_cvt_pk_bf16_f32 v94, v230, v231
    v_cvt_pk_bf16_f32 v95, v232, v233
    ds_read_b128 v[114:117], v143 offset:320
    v_mov_b32 v142, v254
    v_max3_f32 v255, v186, v138, v139
    v_max3_f32 v255, v255, v140, v141
    v_max_f32_dpp v142, v142, v142 quad_perm:[1,0,3,2] row_mask:0xf bank_mask:0xf
    v_max3_f32 v255, v255, v150, v151
    v_max3_f32 v255, v255, v152, v153
    v_max_f32_dpp v142, v142, v142 quad_perm:[2,3,0,1] row_mask:0xf bank_mask:0xf
    v_max3_f32 v255, v255, v238, v239
    v_max3_f32 v255, v255, v240, v241
    v_max_f32_dpp v142, v142, v142 row_half_mirror row_mask:0xf bank_mask:0xf
    v_mov_b32 v127, v255
    s_nop 0
    v_max_f32_dpp v142, v142, v142 row_mirror row_mask:0xf bank_mask:0xf
    v_mov_b32 v126, v142
    s_waitcnt lgkmcnt(2)
    v_mfma_f32_16x16x16_bf16 v[122:125], a[222:223], v[144:145], v[158:161]
    v_permlane32_swap_b32 v142, v126
    v_max_f32 v142, v142, v126
    v_mfma_f32_16x16x16_bf16 v[182:185], a[246:247], v[144:145], v[158:161]
    v_mov_b32 v126, v142
    v_permlane32_swap_b32 v255, v127
    v_mfma_f32_16x16x16_bf16 v[162:165], v[96:97], v[144:145], v[158:161]
    v_permlane16_swap_b32 v142, v126
    v_max_f32 v142, v142, v126
    s_waitcnt lgkmcnt(0)
    v_mfma_f32_16x16x16_bf16 v[134:137], a[234:235], v[144:145], v[114:117]
    v_cvt_pk_bf16_f32 v122, v122, v123
    v_accvgpr_write_b32 a222, v122
    v_cvt_pk_bf16_f32 v124, v124, v125
    v_mfma_f32_16x16x16_bf16 v[158:161], v[84:85], v[144:145], v[114:117]
    v_accvgpr_write_b32 a223, v124
    v_cvt_pk_bf16_f32 v182, v182, v183
    v_accvgpr_write_b32 a246, v182
    v_mfma_f32_16x16x16_bf16 v[122:125], v[108:109], v[144:145], v[114:117]
    v_cvt_pk_bf16_f32 v184, v184, v185
    v_accvgpr_write_b32 a247, v184
    v_cvt_pk_bf16_f32 v96, v162, v163
    v_cvt_pk_bf16_f32 v97, v164, v165
    ds_read_b128 v[114:117], v143 offset:384
    v_cvt_pk_bf16_f32 v134, v134, v135
    v_accvgpr_write_b32 a234, v134
    v_cvt_pk_bf16_f32 v136, v136, v137
    v_accvgpr_write_b32 a235, v136
    v_cvt_pk_bf16_f32 v84, v158, v159
    v_cvt_pk_bf16_f32 v85, v160, v161
    v_cvt_pk_bf16_f32 v108, v122, v123
    v_cvt_pk_bf16_f32 v109, v124, v125
    ds_read_b128 v[158:161], v143 offset:448
    v_sub_f32 v254, v254, v142
    v_exp_f32 v254, v254
    v_max_f32 v255, v255, v127
    v_cvt_pk_bf16_f32 v254, v254, v254
    ds_write_b16 v8, v254
    v_mov_b32 v127, v255
    ds_read_b128 v[122:125], v9
    ds_read_b128 v[162:165], v9 offset:64
    v_permlane16_swap_b32 v255, v127
    s_waitcnt lgkmcnt(4)
    v_mfma_f32_16x16x16_bf16 v[182:185], a[224:225], v[144:145], v[114:117]
    v_max_f32 v255, v255, v127
    v_sub_f32 v138, v138, v255
    v_sub_f32 v139, v139, v255
    v_mfma_f32_16x16x16_bf16 v[134:137], a[248:249], v[144:145], v[114:117]
    v_exp_f32 v138, v138
    v_sub_f32 v140, v140, v255
    v_mfma_f32_16x16x16_bf16 v[166:169], v[98:99], v[144:145], v[114:117]
    v_exp_f32 v139, v139
    s_waitcnt lgkmcnt(3)
    v_mfma_f32_16x16x16_bf16 v[230:233], a[226:227], v[144:145], v[158:161]
    v_cvt_pk_bf16_f32 v182, v182, v183
    v_accvgpr_write_b32 a224, v182
    v_cvt_pk_bf16_f32 v184, v184, v185
    v_mfma_f32_16x16x16_bf16 v[114:117], a[250:251], v[144:145], v[158:161]
    v_accvgpr_write_b32 a225, v184
    v_cvt_pk_bf16_f32 v134, v134, v135
    v_accvgpr_write_b32 a248, v134
    v_mfma_f32_16x16x16_bf16 v[182:185], v[100:101], v[144:145], v[158:161]
    v_cvt_pk_bf16_f32 v136, v136, v137
    v_accvgpr_write_b32 a249, v136
    s_waitcnt lgkmcnt(1)
    v_cvt_pk_bf16_f32 v98, v166, v167
    v_mfma_f32_16x16x32_bf16 v[158:161], v[122:125], v[28:31], 0
    s_waitcnt lgkmcnt(0)
    v_cvt_pk_bf16_f32 v99, v168, v169
    v_cvt_pk_bf16_f32 v230, v230, v231
    v_mfma_f32_16x16x32_bf16 v[158:161], v[162:165], v[28:31], v[158:161]
    ds_read_b128 v[134:137], v143 offset:512
    v_accvgpr_write_b32 a226, v230
    v_mfma_f32_16x16x32_bf16 v[166:169], v[122:125], v[118:121], 0
    v_cvt_pk_bf16_f32 v232, v232, v233
    v_accvgpr_write_b32 a227, v232
    v_mfma_f32_16x16x32_bf16 v[166:169], v[162:165], v[246:249], v[166:169]
    v_cvt_pk_bf16_f32 v114, v114, v115
    v_accvgpr_write_b32 a250, v114
    v_mfma_f32_16x16x32_bf16 v[230:233], v[122:125], v[146:149], 0
    v_cvt_pk_bf16_f32 v116, v116, v117
    v_accvgpr_write_b32 a251, v116
    v_mfma_f32_16x16x32_bf16 v[230:233], v[162:165], v[154:157], v[230:233]
    v_cvt_pk_bf16_f32 v100, v182, v183
    v_cvt_pk_bf16_f32 v101, v184, v185
    v_mfma_f32_16x16x32_bf16 v[114:117], v[122:125], v[174:177], 0
    ds_read_b128 v[122:125], v143 offset:576
    v_cvt_pk_bf16_f32 v138, v138, v139
    v_mfma_f32_16x16x32_bf16 v[114:117], v[162:165], v[214:217], v[114:117]
    v_exp_f32 v140, v140
    v_sub_f32 v141, v141, v255
    v_exp_f32 v141, v141
    s_waitcnt lgkmcnt(1)
    v_mfma_f32_16x16x16_bf16 v[162:165], a[236:237], v[144:145], v[134:137]
    v_cvt_pk_bf16_f32 v139, v140, v141
    v_sub_f32 v150, v150, v255
    v_sub_f32 v151, v151, v255
    v_mfma_f32_16x16x16_bf16 v[182:185], v[86:87], v[144:145], v[134:137]
    v_exp_f32 v150, v150
    v_sub_f32 v152, v152, v255
    v_mfma_f32_16x16x16_bf16 v[190:193], v[110:111], v[144:145], v[134:137]
    v_exp_f32 v151, v151
    v_cvt_pk_bf16_f32 v162, v162, v163
    v_accvgpr_write_b32 a236, v162
    v_cvt_pk_bf16_f32 v164, v164, v165
    v_accvgpr_write_b32 a237, v164
    v_cvt_pk_bf16_f32 v86, v182, v183
    v_cvt_pk_bf16_f32 v87, v184, v185
    v_cvt_pk_bf16_f32 v140, v150, v151
    s_waitcnt lgkmcnt(0)
    v_mfma_f32_16x16x16_bf16 v[162:165], a[228:229], v[144:145], v[122:125]
    v_cvt_pk_bf16_f32 v110, v190, v191
    v_cvt_pk_bf16_f32 v111, v192, v193
    v_sub_f32 v153, v153, v255
    v_mfma_f32_16x16x16_bf16 v[182:185], a[252:253], v[144:145], v[122:125]
    v_exp_f32 v152, v152
    v_sub_f32 v238, v238, v255
    v_mfma_f32_16x16x16_bf16 v[134:137], v[102:103], v[144:145], v[122:125]
    ds_read_b128 v[190:193], v143 offset:640
    v_cvt_pk_bf16_f32 v162, v162, v163
    v_accvgpr_write_b32 a228, v162
    v_cvt_pk_bf16_f32 v164, v164, v165
    v_accvgpr_write_b32 a229, v164
    v_cvt_pk_bf16_f32 v182, v182, v183
    v_accvgpr_write_b32 a252, v182
    v_cvt_pk_bf16_f32 v184, v184, v185
    v_accvgpr_write_b32 a253, v184
    v_cvt_pk_bf16_f32 v102, v134, v135
    v_cvt_pk_bf16_f32 v103, v136, v137
    ds_read_b128 v[122:125], v143 offset:704
    v_exp_f32 v153, v153
    v_mfma_f32_16x16x32_f16 v[162:165], v[130:133], v[202:205], v[70:73]
    v_cvt_pk_bf16_f32 v141, v152, v153
    v_exp_f32 v238, v238
    v_sub_f32 v239, v239, v255
    v_exp_f32 v239, v239
    v_sub_f32 v240, v240, v255
    v_cvt_pk_bf16_f32 v36, v238, v239
    v_mfma_f32_16x16x16_f16 v[162:165], v[128:129], v[222:223], v[162:165]
    v_exp_f32 v240, v240
    v_sub_f32 v241, v241, v255
    v_sub_f32 v186, v186, v255
    v_mfma_f32_16x16x32_f16 v[130:133], v[170:173], v[202:205], v[74:77]
    s_waitcnt lgkmcnt(1)
    v_exp_f32 v241, v241
    v_mfma_f32_16x16x32_f16 v[126:129], v[178:181], v[202:205], v[78:81]
    v_cvt_pk_bf16_f32 v37, v240, v241
    v_exp_f32 v186, v186
    v_mfma_f32_16x16x16_bf16 v[178:181], a[230:231], v[144:145], v[190:193]
    v_max3_f32 v254, v218, v162, v163
    v_max3_f32 v254, v254, v164, v165
    v_cvt_pk_bf16_f32 v39, v186, 0
    v_mfma_f32_16x16x16_f16 v[130:133], v[228:229], v[222:223], v[130:133]
    v_rcp_f32 v158, v158
    v_mfma_f32_16x16x16_f16 v[126:129], v[224:225], v[222:223], v[126:129]
    v_mul_f32 v166, v166, v158
    v_mfma_f32_16x16x32_bf16 v[150:153], v[28:31], v[36:39], 0
    s_waitcnt lgkmcnt(0)
    v_cvt_pk_bf16_f32 v178, v178, v179
    v_accvgpr_write_b32 a230, v178
    v_mfma_f32_16x16x32_bf16 v[150:153], v[28:31], v[138:141], v[150:153]
    v_cvt_pk_bf16_f32 v180, v180, v181
    v_accvgpr_write_b32 a231, v180
    v_mfma_f32_16x16x32_bf16 v[178:181], v[246:249], v[36:39], 0
    v_max3_f32 v254, v254, v130, v131
    v_max3_f32 v254, v254, v132, v133
    v_mfma_f32_16x16x32_bf16 v[178:181], v[118:121], v[138:141], v[178:181]
    v_max3_f32 v254, v254, v126, v127
    v_max3_f32 v254, v254, v128, v129
    v_mfma_f32_16x16x32_bf16 v[182:185], v[154:157], v[36:39], 0
    v_rcp_f32 v150, v150
    v_mfma_f32_16x16x32_bf16 v[182:185], v[146:149], v[138:141], v[182:185]
    v_mov_b32 v255, v254
    v_mul_f32_dpp v166, v230, v158 quad_perm:[0,1,2,3] row_mask:0x2 bank_mask:0xf
    v_mfma_f32_16x16x32_bf16 v[134:137], v[214:217], v[36:39], 0
    v_mul_f32 v178, v150, v178
    v_mul_f32 v179, v150, v179
    v_mfma_f32_16x16x32_bf16 v[134:137], v[174:177], v[138:141], v[134:137]
    v_cvt_pk_bf16_f32 v138, v178, v179
    v_mul_f32 v180, v150, v180
    v_mul_f32 v181, v150, v181
    v_mfma_f32_16x16x16_bf16 v[170:173], a[254:255], v[144:145], v[190:193]
    v_cvt_pk_bf16_f32 v139, v180, v181
    v_mul_f32 v182, v150, v182
    v_mul_f32 v183, v150, v183
    v_mfma_f32_16x16x16_bf16 v[178:181], v[104:105], v[144:145], v[190:193]
    v_cvt_pk_bf16_f32 v140, v182, v183
    v_mul_f32 v184, v150, v184
    v_mul_f32 v185, v150, v185
    v_mfma_f32_16x16x16_bf16 v[202:205], a[238:239], v[144:145], v[122:125]
    v_cvt_pk_bf16_f32 v141, v184, v185
    v_mul_f32 v134, v150, v134
    v_mul_f32 v135, v150, v135
    v_mfma_f32_16x16x16_bf16 v[182:185], v[88:89], v[144:145], v[122:125]
    v_cvt_pk_bf16_f32 v116, v134, v135
    v_mul_f32 v136, v150, v136
    v_mul_f32 v137, v150, v137
    v_mfma_f32_16x16x16_bf16 v[150:153], v[112:113], v[144:145], v[122:125]
    ds_write_b128 v3, v[138:141] offset:6144
    v_cvt_pk_bf16_f32 v117, v136, v137
    v_cvt_pk_bf16_f32 v170, v170, v171
    v_accvgpr_write_b32 a254, v170
    v_cvt_pk_bf16_f32 v172, v172, v173
    v_accvgpr_write_b32 a255, v172
    v_cvt_pk_bf16_f32 v104, v178, v179
    v_cvt_pk_bf16_f32 v105, v180, v181
    ds_write_b64 v4, v[116:117] offset:10240
    v_cvt_pk_bf16_f32 v202, v202, v203
    v_accvgpr_write_b32 a238, v202
    v_cvt_pk_bf16_f32 v204, v204, v205
    v_accvgpr_write_b32 a239, v204
    v_cvt_pk_bf16_f32 v88, v182, v183
    v_cvt_pk_bf16_f32 v89, v184, v185
    v_cvt_pk_bf16_f32 v112, v150, v151
    v_cvt_pk_bf16_f32 v113, v152, v153
    v_permlane32_swap_b32 v254, v255
    v_max_f32 v254, v254, v255
    v_mov_b32 v255, v254
    v_mul_f32_dpp v166, v114, v158 quad_perm:[0,1,2,3] row_mask:0x4 bank_mask:0xf
    v_cvt_pk_bf16_f32 v166, v166, v166
    ds_write_b16 v7, v166
    v_permlane16_swap_b32 v254, v255
    v_max_f32 v254, v254, v255
    v_sub_f32 v162, v162, v254
    v_exp_f32 v162, v162
    v_sub_f32 v163, v163, v254
    v_exp_f32 v163, v163
    v_sub_f32 v164, v164, v254
    v_cvt_pk_bf16_f32 v138, v162, v163
    v_exp_f32 v164, v164
    ds_read_b128 v[186:189], v0 offset:20480
    ds_read_b128 v[194:197], v1 offset:20480
    ds_read_b128 v[122:125], v0 offset:20608
    ds_read_b128 v[202:205], v1 offset:20608
    ds_read_b128 v[230:233], v0 offset:20736
    ds_read_b128 v[238:241], v1 offset:20736
    v_sub_f32 v165, v165, v254
    v_exp_f32 v165, v165
    v_sub_f32 v130, v130, v254
    v_cvt_pk_bf16_f32 v139, v164, v165
    v_exp_f32 v130, v130
    v_sub_f32 v131, v131, v254
    v_exp_f32 v131, v131
    v_sub_f32 v132, v132, v254
    v_cvt_pk_bf16_f32 v140, v130, v131
    v_exp_f32 v132, v132
    s_waitcnt lgkmcnt(5)
    v_mfma_f32_16x16x32_bf16 v[150:153], a[72:75], v[186:189], 0
    s_waitcnt lgkmcnt(3)
    v_sub_f32 v133, v133, v254
    v_sub_f32 v126, v126, v254
    v_mfma_f32_16x16x32_bf16 v[150:153], a[76:79], v[194:197], v[150:153]
    s_waitcnt lgkmcnt(2)
    v_exp_f32 v133, v133
    v_mfma_f32_16x16x32_bf16 v[150:153], a[80:83], v[122:125], v[150:153]
    s_waitcnt lgkmcnt(1)
    v_cvt_pk_bf16_f32 v141, v132, v133
    v_sub_f32 v127, v127, v254
    v_mfma_f32_16x16x32_bf16 v[150:153], a[84:87], v[202:205], v[150:153]
    s_waitcnt lgkmcnt(0)
    v_exp_f32 v126, v126
    v_mfma_f32_16x16x32_bf16 v[150:153], a[88:91], v[230:233], v[150:153]
    v_exp_f32 v127, v127
    v_mfma_f32_16x16x32_bf16 v[150:153], a[92:95], v[238:241], v[150:153]
    v_cvt_pk_bf16_f32 v36, v126, v127
    v_sub_f32 v128, v128, v254
    v_mfma_f32_16x16x32_bf16 v[162:165], a[96:99], v[186:189], 0
    v_exp_f32 v128, v128
    v_mfma_f32_16x16x32_bf16 v[162:165], a[100:103], v[194:197], v[162:165]
    v_sub_f32 v129, v129, v254
    v_sub_f32 v218, v218, v254
    v_mfma_f32_16x16x32_bf16 v[162:165], a[104:107], v[122:125], v[162:165]
    v_exp_f32 v129, v129
    v_mfma_f32_16x16x32_bf16 v[162:165], a[108:111], v[202:205], v[162:165]
    v_cvt_pk_bf16_f32 v37, v128, v129
    v_add_u32 v7, 16, v7
    v_mfma_f32_16x16x32_bf16 v[162:165], a[112:115], v[230:233], v[162:165]
    v_exp_f32 v218, v218
    v_mfma_f32_16x16x32_bf16 v[162:165], a[116:119], v[238:241], v[162:165]
    v_cvt_pk_bf16_f32 v39, v218, 0
    v_mfma_f32_16x16x32_bf16 v[170:173], a[120:123], v[186:189], 0
    v_mfma_f32_16x16x32_bf16 v[170:173], a[124:127], v[194:197], v[170:173]
    v_mfma_f32_16x16x32_bf16 v[142:145], v[28:31], v[36:39], 0
    v_mfma_f32_16x16x32_bf16 v[142:145], v[28:31], v[138:141], v[142:145]
    v_mfma_f32_16x16x32_bf16 v[130:133], v[246:249], v[36:39], 0
    v_mfma_f32_16x16x32_bf16 v[130:133], v[118:121], v[138:141], v[130:133]
    v_mfma_f32_16x16x32_bf16 v[118:121], v[154:157], v[36:39], 0
    v_mfma_f32_16x16x32_bf16 v[118:121], v[146:149], v[138:141], v[118:121]
    v_mfma_f32_16x16x32_bf16 v[158:161], v[214:217], v[36:39], 0
    v_mfma_f32_16x16x32_bf16 v[158:161], v[174:177], v[138:141], v[158:161]
    v_mfma_f32_16x16x32_bf16 v[170:173], a[128:131], v[122:125], v[170:173]
    v_mfma_f32_16x16x32_bf16 v[170:173], a[132:135], v[202:205], v[170:173]
    v_rcp_f32 v142, v142
    v_mfma_f32_16x16x32_bf16 v[170:173], a[136:139], v[230:233], v[170:173]
    v_mul_f32 v130, v142, v130
    v_mul_f32 v131, v142, v131
    v_mfma_f32_16x16x32_bf16 v[170:173], a[140:143], v[238:241], v[170:173]
    v_cvt_pk_bf16_f32 v174, v130, v131
    v_mul_f32 v132, v142, v132
    v_mfma_f32_16x16x32_bf16 v[138:141], a[0:3], v[186:189], 0
    v_mul_f32 v133, v142, v133
    v_cvt_pk_bf16_f32 v175, v132, v133
    v_mfma_f32_16x16x32_bf16 v[138:141], a[4:7], v[194:197], v[138:141]
    v_mul_f32 v118, v142, v118
    v_mul_f32 v119, v142, v119
    v_mfma_f32_16x16x32_bf16 v[138:141], a[8:11], v[122:125], v[138:141]
    v_cvt_pk_bf16_f32 v176, v118, v119
    v_mul_f32 v120, v142, v120
    v_mfma_f32_16x16x32_bf16 v[138:141], a[12:15], v[202:205], v[138:141]
    v_mul_f32 v121, v142, v121
    v_cvt_pk_bf16_f32 v177, v120, v121
    v_mfma_f32_16x16x32_bf16 v[138:141], a[16:19], v[230:233], v[138:141]
    ds_write_b128 v3, v[174:177] offset:12288
    v_mfma_f32_16x16x32_bf16 v[138:141], a[20:23], v[238:241], v[138:141]
    v_mul_f32 v158, v142, v158
    v_mul_f32 v159, v142, v159
    v_mfma_f32_16x16x32_bf16 v[166:169], a[24:27], v[186:189], 0
    v_cvt_pk_bf16_f32 v254, v158, v159
    v_mul_f32 v160, v142, v160
    v_mfma_f32_16x16x32_bf16 v[166:169], a[28:31], v[194:197], v[166:169]
    v_mul_f32 v161, v142, v161
    v_cvt_pk_bf16_f32 v255, v160, v161
    v_mfma_f32_16x16x32_bf16 v[166:169], a[32:35], v[122:125], v[166:169]
    ds_write_b64 v4, v[254:255] offset:16384
    v_mfma_f32_16x16x32_bf16 v[166:169], a[36:39], v[202:205], v[166:169]
    v_xor_b32 v3, 65536, v3
    v_xor_b32 v4, 65536, v4
    v_mfma_f32_16x16x32_bf16 v[166:169], a[40:43], v[230:233], v[166:169]
    v_mfma_f32_16x16x32_bf16 v[166:169], a[44:47], v[238:241], v[166:169]
    v_mfma_f32_16x16x32_bf16 v[134:137], a[48:51], v[186:189], 0
    v_mfma_f32_16x16x32_bf16 v[134:137], a[52:55], v[194:197], v[134:137]
    s_waitcnt lgkmcnt(0)
    s_barrier
    s_waitcnt lgkmcnt(0)
    s_cmp_eq_u32 s45, 0
    s_cbranch_scc1 L_drain
    s_nop 0
    s_lshr_b32 s3, s44, 8
    s_cbranch_scc1 L_safe
    v_cvt_pk_f16_f32 v146, v150, v151
    v_pk_mul_f16 v143, v146, v146
    v_cvt_pk_f16_f32 v147, v152, v153
    v_pk_fma_f16 v143, v147, v147, v143
    v_cvt_pk_f16_f32 v148, v162, v163
    v_pk_fma_f16 v143, v148, v148, v143
    v_cvt_pk_f16_f32 v149, v164, v165
    v_pk_fma_f16 v143, v149, v149, v143
    v_cvt_pk_f16_f32 v120, v170, v171
    v_pk_fma_f16 v143, v120, v120, v143
    v_cvt_pk_f16_f32 v121, v172, v173
    v_pk_fma_f16 v143, v121, v121, v143
    v_and_b32 v118, 16, v2
    v_sub_u32 v5, v5, v118
    v_mov_b32 v25, 0
    s_nop 7
    s_branch L_go
L_safe:
    v_fma_f32 v174, v150, v150, s32
    v_fmac_f32 v174, v151, v151
    v_fmac_f32 v174, v152, v152
    v_fmac_f32 v174, v153, v153
    s_nop 7
L_LOOP:
    v_mfma_f32_16x16x32_bf16 v[134:137], a[56:59], v[122:125], v[134:137]
    s_add_u32 s12, s40, s27
    ds_read_b128 v[118:121], v2 offset:18432
    ds_read_b128 v[142:145], v2 offset:19456
    v_mfma_f32_16x16x32_bf16 v[134:137], a[60:63], v[202:205], v[134:137]
    s_addc_u32 s13, s41, 0
    v_fmac_f32 v174, v162, v162
    v_fmac_f32 v174, v163, v163
    v_mfma_f32_16x16x32_bf16 v[134:137], a[64:67], v[230:233], v[134:137]
    s_sub_u32 s14, s36, s27
    v_fmac_f32 v174, v164, v164
    v_fmac_f32 v174, v165, v165
    v_mfma_f32_16x16x32_bf16 v[134:137], a[68:71], v[238:241], v[134:137]
    s_cmp_ge_u32 s18, 2
    v_fmac_f32 v174, v170, v170
    v_fmac_f32 v174, v171, v171
    v_mfma_f32_16x16x32_bf16 v[146:149], v[186:189], a[144:147], 0
    s_cselect_b32 s14, s14, 0
    v_fmac_f32 v174, v172, v172
    v_fmac_f32 v174, v173, v173
    v_mfma_f32_16x16x32_bf16 v[146:149], v[194:197], a[148:151], v[146:149]
    s_sub_u32 s82, s72, s71
    v_fma_f32 v254, v138, v138, s32
    v_fmac_f32 v254, v139, v139
    v_mfma_f32_16x16x32_bf16 v[146:149], v[122:125], a[152:155], v[146:149]
    s_mul_i32 s74, s82, 336
    v_fmac_f32 v254, v140, v140
    v_fmac_f32 v254, v141, v141
    v_mfma_f32_16x16x32_bf16 v[146:149], v[202:205], a[156:159], v[146:149]
    s_mul_i32 s75, s82, 272
    v_fmac_f32 v254, v166, v166
    v_fmac_f32 v254, v167, v167
    v_mfma_f32_16x16x32_bf16 v[146:149], v[230:233], a[160:163], v[146:149]
    s_waitcnt lgkmcnt(0)
    v_fmac_f32 v254, v168, v168
    v_fmac_f32 v254, v169, v169
    v_mfma_f32_16x16x32_bf16 v[182:185], v[32:35], v[118:121], 0
    s_mul_i32 s76, s82, 16
    v_fmac_f32 v254, v134, v134
    v_fmac_f32 v254, v135, v135
    v_mfma_f32_16x16x32_bf16 v[182:185], v[32:35], v[142:145], v[182:185]
    s_add_u32 s34, s18, 2
    v_fmac_f32 v254, v136, v136
    v_fmac_f32 v254, v137, v137
    v_mfma_f32_16x16x32_bf16 v[146:149], v[238:241], a[164:167], v[146:149]
    s_add_u32 s8, s60, s23
    ds_read_b128 v[190:193], v0 offset:26624
    v_cvt_pk_bf16_f32 v36, v254, v174
    v_mfma_f32_16x16x32_bf16 v[118:121], v[186:189], a[168:171], 0
    s_addc_u32 s9, s61, 0
    ds_read_b128 v[210:213], v1 offset:26624
    v_mul_f32 v254, 0x3baaaaab, v182
    v_mfma_f32_16x16x32_bf16 v[214:217], v[32:35], v[36:39], 0
    s_sub_u32 s10, s36, s23
    v_cvt_pk_bf16_f32 v142, v146, v147
    v_cvt_pk_bf16_f32 v143, v148, v149
    v_mfma_f32_16x16x32_bf16 v[118:121], v[194:197], a[172:175], v[118:121]
    s_cmp_le_u32 s34, s45
    ds_read_b128 v[218:221], v0 offset:26752
    v_mul_f32 v255, 0x3baaaaab, v183
    v_mfma_f32_16x16x32_bf16 v[118:121], v[122:125], a[176:179], v[118:121]
    s_cselect_b32 s10, s10, 0
    ds_read_b128 v[222:225], v1 offset:26752
    v_mul_f32 v144, 0x3baaaaab, v184
    v_mfma_f32_16x16x32_bf16 v[118:121], v[202:205], a[180:183], v[118:121]
    s_add_u32 m0, s28, 0
    v_rsq_f32 v215, v215
    v_mfma_f32_16x16x32_bf16 v[118:121], v[230:233], a[184:187], v[118:121]
    s_mov_b32 s27, s26
    v_rsq_f32 v214, v214
    v_mfma_f32_16x16x32_bf16 v[118:121], v[238:241], a[188:191], v[118:121]
    s_mov_b32 s26, s25
    v_mul_f32 v214, s31, v214
    v_mul_f32 v150, v215, v150
    v_mul_f32 v151, v215, v151
    v_cvt_pk_f16_f32 v174, v150, v151
    v_mfma_f32_16x16x32_bf16 v[182:185], v[186:189], a[192:195], 0
    s_waitcnt lgkmcnt(2)
    ds_read_b128 v[186:189], v0 offset:26880
    v_cvt_pk_bf16_f32 v146, v118, v119
    v_mfma_f32_16x16x32_bf16 v[182:185], v[194:197], a[196:199], v[182:185]
    s_mov_b32 s25, s24
    ds_read_b128 v[194:197], v1 offset:26880
    v_cvt_pk_bf16_f32 v147, v120, v121
    v_mfma_f32_16x16x32_bf16 v[182:185], v[122:125], a[200:203], v[182:185]
    s_mov_b32 s24, s23
    v_mul_f32 v152, v215, v152
    v_mul_f32 v153, v215, v153
    v_mfma_f32_16x16x32_bf16 v[182:185], v[202:205], a[204:207], v[182:185]
    s_ff1_i32_b32 s77, s100
    v_cvt_pk_f16_f32 v175, v152, v153
    v_mul_f32 v162, v215, v162
    v_mfma_f32_16x16x32_bf16 v[182:185], v[230:233], a[208:211], v[182:185]
    s_mul_i32 s78, s77, 2688
    v_mul_f32 v163, v215, v163
    v_cvt_pk_f16_f32 v176, v162, v163
    v_mfma_f32_16x16x32_bf16 v[182:185], v[238:241], a[212:215], v[182:185]
    s_mov_b32 s71, s72
    v_mul_f32 v164, v215, v164
    v_mul_f32 v165, v215, v165
    v_mfma_f32_16x16x32_bf16 v[122:125], a[72:75], v[190:193], 0
    s_mov_b32 s72, s73
    v_cvt_pk_f16_f32 v177, v164, v165
    v_mul_f32 v170, v215, v170
    v_mfma_f32_16x16x32_bf16 v[122:125], a[76:79], v[210:213], v[122:125]
    s_waitcnt lgkmcnt(2)
    v_cvt_pk_bf16_f32 v150, v182, v183
    v_cvt_pk_bf16_f32 v151, v184, v185
    v_mfma_f32_16x16x32_bf16 v[122:125], a[80:83], v[218:221], v[122:125]
    s_waitcnt lgkmcnt(1)
    v_mul_f32 v171, v215, v171
    v_cvt_pk_f16_f32 v120, v170, v171
    v_mfma_f32_16x16x32_bf16 v[122:125], a[84:87], v[222:225], v[122:125]
    s_waitcnt lgkmcnt(0)
    v_mul_f32 v172, v215, v172
    v_mul_f32 v173, v215, v173
    v_mfma_f32_16x16x32_bf16 v[122:125], a[88:91], v[186:189], v[122:125]
    v_cvt_pk_f16_f32 v121, v172, v173
    v_mul_f32 v138, v214, v138
    v_mfma_f32_16x16x32_bf16 v[122:125], a[92:95], v[194:197], v[122:125]
    v_mul_f32 v139, v214, v139
    v_cvt_pk_f16_f32 v202, v138, v139
    v_mfma_f32_16x16x32_bf16 v[162:165], a[96:99], v[190:193], 0
    v_mul_f32 v140, v214, v140
    v_mul_f32 v141, v214, v141
    v_mfma_f32_16x16x32_bf16 v[162:165], a[100:103], v[210:213], v[162:165]
    v_cvt_pk_f16_f32 v203, v140, v141
    v_mul_f32 v166, v214, v166
    v_mfma_f32_16x16x32_bf16 v[162:165], a[104:107], v[218:221], v[162:165]
    v_mul_f32 v167, v214, v167
    v_cvt_pk_f16_f32 v204, v166, v167
    v_mfma_f32_16x16x32_bf16 v[162:165], a[108:111], v[222:225], v[162:165]
    v_mul_f32 v168, v214, v168
    v_mul_f32 v169, v214, v169
    v_mfma_f32_16x16x32_bf16 v[162:165], a[112:115], v[186:189], v[162:165]
    v_cvt_pk_f16_f32 v205, v168, v169
    v_mul_f32 v134, v214, v134
    v_mfma_f32_16x16x32_bf16 v[162:165], a[116:119], v[194:197], v[162:165]
    v_mul_f32 v135, v214, v135
    v_cvt_pk_f16_f32 v118, v134, v135
    v_mfma_f32_16x16x32_bf16 v[166:169], a[120:123], v[190:193], 0
    v_mul_f32 v136, v214, v136
    v_mul_f32 v137, v214, v137
    v_mfma_f32_16x16x32_bf16 v[166:169], a[124:127], v[210:213], v[166:169]
    v_cvt_pk_f16_f32 v119, v136, v137
    v_fma_f32 v145, v122, v122, s32
    v_mfma_f32_16x16x32_bf16 v[166:169], a[128:131], v[218:221], v[166:169]
    v_rsq_f32 v254, v254
    v_mfma_f32_16x16x32_bf16 v[166:169], a[132:135], v[222:225], v[166:169]
    v_fmac_f32 v145, v123, v123
    v_fmac_f32 v145, v124, v124
    v_mfma_f32_16x16x32_bf16 v[166:169], a[136:139], v[186:189], v[166:169]
    v_fmac_f32 v145, v125, v125
    v_fmac_f32 v145, v162, v162
    v_mfma_f32_16x16x32_bf16 v[166:169], a[140:143], v[194:197], v[166:169]
    v_fmac_f32 v145, v163, v163
    v_fmac_f32 v145, v164, v164
    v_mfma_f32_16x16x32_bf16 v[134:137], a[0:3], v[190:193], 0
    v_fmac_f32 v145, v165, v165
    v_mul_f32 v178, v254, v178
    v_mfma_f32_16x16x32_bf16 v[134:137], a[4:7], v[210:213], v[134:137]
    v_rsq_f32 v255, v255
    v_mfma_f32_16x16x32_bf16 v[134:137], a[8:11], v[218:221], v[134:137]
    v_fmac_f32 v145, v166, v166
    v_fmac_f32 v145, v167, v167
    v_mfma_f32_16x16x32_bf16 v[134:137], a[12:15], v[222:225], v[134:137]
    v_fmac_f32 v145, v168, v168
    v_fmac_f32 v145, v169, v169
    v_mfma_f32_16x16x32_bf16 v[134:137], a[16:19], v[186:189], v[134:137]
    v_rsq_f32 v144, v144
    v_mfma_f32_16x16x32_bf16 v[134:137], a[20:23], v[194:197], v[134:137]
    v_mul_f32 v242, v144, v242
    v_mul_f32 v243, v144, v243
    v_mfma_f32_16x16x32_bf16 v[170:173], a[24:27], v[190:193], 0
    v_cvt_pk_bf16_f32 v138, v242, v243
    v_mul_f32 v244, v144, v244
    v_mfma_f32_16x16x32_bf16 v[170:173], a[28:31], v[210:213], v[170:173]
    v_mul_f32 v245, v144, v245
    v_cvt_pk_bf16_f32 v139, v244, v245
    v_mfma_f32_16x16x32_bf16 v[170:173], a[32:35], v[218:221], v[170:173]
    v_fma_f32 v148, v134, v134, s32
    v_fmac_f32 v148, v135, v135
    v_mfma_f32_16x16x32_bf16 v[170:173], a[36:39], v[222:225], v[170:173]
    v_fmac_f32 v148, v136, v136
    v_fmac_f32 v148, v137, v137
    v_mfma_f32_16x16x32_bf16 v[170:173], a[40:43], v[186:189], v[170:173]
    v_mul_f32 v158, v144, v158
    v_mul_f32 v159, v144, v159
    v_mfma_f32_16x16x32_bf16 v[170:173], a[44:47], v[194:197], v[170:173]
    v_cvt_pk_bf16_f32 v140, v158, v159
    v_mul_f32 v160, v144, v160
    v_mfma_f32_16x16x32_bf16 v[182:185], a[48:51], v[190:193], 0
    v_mul_f32 v161, v144, v161
    v_cvt_pk_bf16_f32 v141, v160, v161
    v_mfma_f32_16x16x32_bf16 v[182:185], a[52:55], v[210:213], v[182:185]
    buffer_store_dwordx4 v[138:141], v17, s[12:15], 0 offen nt
    v_mul_f32 v154, v144, v154
    v_fmac_f32 v148, v170, v170
    v_fmac_f32 v148, v171, v171
    v_fmac_f32 v148, v172, v172
    v_mfma_f32_16x16x32_bf16 v[182:185], a[56:59], v[218:221], v[182:185]
    v_fmac_f32 v148, v173, v173
    v_mul_f32 v155, v144, v155
    v_mfma_f32_16x16x32_bf16 v[182:185], a[60:63], v[222:225], v[182:185]
    v_cvt_pk_bf16_f32 v152, v154, v155
    v_mul_f32 v156, v144, v156
    v_mfma_f32_16x16x32_bf16 v[182:185], a[64:67], v[186:189], v[182:185]
    v_mul_f32 v157, v144, v157
    v_cvt_pk_bf16_f32 v153, v156, v157
    v_mfma_f32_16x16x32_bf16 v[182:185], a[68:71], v[194:197], v[182:185]
    v_mul_f32 v179, v254, v179
    v_cvt_pk_bf16_f32 v158, v178, v179
    v_mfma_f32_16x16x32_bf16 v[138:141], v[190:193], a[144:147], 0
    v_mul_f32 v180, v254, v180
    v_mul_f32 v181, v254, v181
    v_mfma_f32_16x16x32_bf16 v[138:141], v[210:213], a[148:151], v[138:141]
    v_cvt_pk_bf16_f32 v159, v180, v181
    v_mul_f32 v198, v254, v198
    v_mfma_f32_16x16x32_bf16 v[138:141], v[218:221], a[152:155], v[138:141]
    v_fmac_f32 v148, v182, v182
    v_fmac_f32 v148, v183, v183
    v_mfma_f32_16x16x32_bf16 v[138:141], v[222:225], a[156:159], v[138:141]
    v_fmac_f32 v148, v184, v184
    v_fmac_f32 v148, v185, v185
    v_mfma_f32_16x16x32_bf16 v[138:141], v[186:189], a[160:163], v[138:141]
    v_cvt_pk_bf16_f32 v36, v148, v145
    v_mul_f32 v199, v254, v199
    v_mfma_f32_16x16x32_bf16 v[138:141], v[194:197], a[164:167], v[138:141]
    ds_read_b128 v[214:217], v0 offset:32768
    v_cvt_pk_bf16_f32 v160, v198, v199
    v_mfma_f32_16x16x32_bf16 v[178:181], v[32:35], v[36:39], 0
    v_mul_f32 v200, v254, v200
    v_mul_f32 v201, v254, v201
    v_mfma_f32_16x16x32_bf16 v[154:157], v[190:193], a[168:171], 0
    ds_read_b128 v[226:229], v1 offset:32768
    v_cvt_pk_bf16_f32 v161, v200, v201
    v_mfma_f32_16x16x32_bf16 v[154:157], v[210:213], a[172:175], v[154:157]
    ds_read_b128 v[198:201], v0 offset:32896
    v_cvt_pk_bf16_f32 v144, v138, v139
    v_mfma_f32_16x16x32_bf16 v[154:157], v[218:221], a[176:179], v[154:157]
    v_cvt_pk_bf16_f32 v145, v140, v141
    v_mul_f32 v206, v254, v206
    v_mfma_f32_16x16x32_bf16 v[154:157], v[222:225], a[180:183], v[154:157]
    ds_read_b128 v[230:233], v1 offset:32896
    v_mul_f32 v207, v254, v207
    v_mfma_f32_16x16x32_bf16 v[154:157], v[186:189], a[184:187], v[154:157]
    v_rsq_f32 v179, v179
    v_mfma_f32_16x16x32_bf16 v[154:157], v[194:197], a[188:191], v[154:157]
    buffer_store_dwordx2 v[152:153], v20, s[12:15], 0 offen nt
    v_rsq_f32 v178, v178
    v_mul_f32 v122, v179, v122
    v_mul_f32 v178, s31, v178
    v_mul_f32 v123, v179, v123
    v_cvt_pk_f16_f32 v138, v122, v123
    v_mul_f32 v124, v179, v124
    v_mul_f32 v125, v179, v125
    v_cvt_pk_bf16_f32 v148, v154, v155
    v_mfma_f32_16x16x32_bf16 v[234:237], v[190:193], a[192:195], 0
    s_waitcnt lgkmcnt(2)
    ds_read_b128 v[190:193], v0 offset:33024
    v_cvt_pk_bf16_f32 v149, v156, v157
    v_mfma_f32_16x16x32_bf16 v[234:237], v[210:213], a[196:199], v[234:237]
    s_waitcnt lgkmcnt(2)
    ds_read_b128 v[210:213], v1 offset:33024
    v_cvt_pk_f16_f32 v139, v124, v125
    v_mfma_f32_16x16x32_bf16 v[234:237], v[218:221], a[200:203], v[234:237]
    v_mul_f32 v162, v179, v162
    v_mul_f32 v163, v179, v163
    v_mfma_f32_16x16x32_bf16 v[234:237], v[222:225], a[204:207], v[234:237]
    s_waitcnt vmcnt(2)
    v_cvt_pk_f16_f32 v140, v162, v163
    v_mul_f32 v164, v179, v164
    v_mfma_f32_16x16x32_bf16 v[234:237], v[186:189], a[208:211], v[234:237]
    s_waitcnt lgkmcnt(2)
    v_mul_f32 v165, v179, v165
    v_cvt_pk_f16_f32 v141, v164, v165
    v_mfma_f32_16x16x32_bf16 v[234:237], v[194:197], a[212:215], v[234:237]
    v_mul_f32 v166, v179, v166
    v_mul_f32 v167, v179, v167
    v_mfma_f32_16x16x32_bf16 v[186:189], a[72:75], v[214:217], 0
    v_cvt_pk_f16_f32 v124, v166, v167
    v_mul_f32 v168, v179, v168
    v_mfma_f32_16x16x32_bf16 v[186:189], a[76:79], v[226:229], v[186:189]
    v_mul_f32 v169, v179, v169
    v_cvt_pk_f16_f32 v125, v168, v169
    v_mfma_f32_16x16x32_bf16 v[186:189], a[80:83], v[198:201], v[186:189]
    s_waitcnt lgkmcnt(1)
    v_cvt_pk_bf16_f32 v152, v234, v235
    v_cvt_pk_bf16_f32 v153, v236, v237
    v_mfma_f32_16x16x32_bf16 v[186:189], a[84:87], v[230:233], v[186:189]
    s_waitcnt lgkmcnt(0)
    v_mul_f32 v134, v178, v134
    v_mul_f32 v135, v178, v135
    v_mfma_f32_16x16x32_bf16 v[186:189], a[88:91], v[190:193], v[186:189]
    s_barrier
    v_cvt_pk_f16_f32 v154, v134, v135
    v_mul_f32 v136, v178, v136
    v_mfma_f32_16x16x32_bf16 v[186:189], a[92:95], v[210:213], v[186:189]
    v_mul_f32 v137, v178, v137
    v_cvt_pk_f16_f32 v155, v136, v137
    v_mfma_f32_16x16x32_bf16 v[134:137], a[96:99], v[214:217], 0
    v_mul_f32 v170, v178, v170
    v_mul_f32 v171, v178, v171
    v_mfma_f32_16x16x32_bf16 v[134:137], a[100:103], v[226:229], v[134:137]
    v_cvt_pk_f16_f32 v156, v170, v171
    v_mul_f32 v172, v178, v172
    v_mfma_f32_16x16x32_bf16 v[134:137], a[104:107], v[198:201], v[134:137]
    buffer_load_dwordx4 v10, s[8:11], 0 offen nt lds
    v_mul_f32 v173, v178, v173
    v_mfma_f32_16x16x32_bf16 v[134:137], a[108:111], v[230:233], v[134:137]
    s_add_u32 m0, s28, 4096
    v_cvt_pk_f16_f32 v157, v172, v173
    v_mul_f32 v182, v178, v182
    v_mfma_f32_16x16x32_bf16 v[134:137], a[112:115], v[190:193], v[134:137]
    v_mul_f32 v183, v178, v183
    v_cvt_pk_f16_f32 v122, v182, v183
    v_mfma_f32_16x16x32_bf16 v[134:137], a[116:119], v[210:213], v[134:137]
    v_mul_f32 v184, v178, v184
    v_mul_f32 v185, v178, v185
    v_mfma_f32_16x16x32_bf16 v[218:221], a[120:123], v[214:217], 0
    v_cvt_pk_f16_f32 v123, v184, v185
    v_cvt_pk_bf16_f32 v170, v206, v207
    v_mfma_f32_16x16x32_bf16 v[218:221], a[124:127], v[226:229], v[218:221]
    buffer_load_dwordx4 v11, s[8:11], 0 offen nt lds
    v_mul_f32 v208, v254, v208
    v_mfma_f32_16x16x32_bf16 v[218:221], a[128:131], v[198:201], v[218:221]
    s_add_u32 m0, s28, 8192
    v_mul_f32 v209, v254, v209
    v_cvt_pk_bf16_f32 v171, v208, v209
    v_mfma_f32_16x16x32_bf16 v[218:221], a[132:135], v[230:233], v[218:221]
    v_fma_f32 v162, v186, v186, s32
    v_fmac_f32 v162, v187, v187
    v_mfma_f32_16x16x32_bf16 v[218:221], a[136:139], v[190:193], v[218:221]
    v_fmac_f32 v162, v188, v188
    v_fmac_f32 v162, v189, v189
    v_mfma_f32_16x16x32_bf16 v[218:221], a[140:143], v[210:213], v[218:221]
    v_fmac_f32 v162, v134, v134
    v_fmac_f32 v162, v135, v135
    v_mfma_f32_16x16x32_bf16 v[222:225], a[0:3], v[214:217], 0
    buffer_load_dwordx4 v12, s[8:11], 0 offen nt lds
    v_fmac_f32 v162, v136, v136
    v_mfma_f32_16x16x32_bf16 v[222:225], a[4:7], v[226:229], v[222:225]
    s_add_u32 m0, s28, 12288
    v_fmac_f32 v162, v137, v137
    v_fmac_f32 v162, v218, v218
    v_mfma_f32_16x16x32_bf16 v[222:225], a[8:11], v[198:201], v[222:225]
    s_xor_b32 s28, s28, 65536
    v_fmac_f32 v162, v219, v219
    v_fmac_f32 v162, v220, v220
    v_mfma_f32_16x16x32_bf16 v[222:225], a[12:15], v[230:233], v[222:225]
    v_fmac_f32 v162, v221, v221
    v_mul_f32 v130, v255, v130
    v_mfma_f32_16x16x32_bf16 v[222:225], a[16:19], v[190:193], v[222:225]
    v_mul_f32 v131, v255, v131
    v_cvt_pk_bf16_f32 v130, v130, v131
    v_mfma_f32_16x16x32_bf16 v[222:225], a[20:23], v[210:213], v[222:225]
    buffer_load_dwordx4 v13, s[8:11], 0 offen nt lds
    v_mul_f32 v132, v255, v132
    v_mfma_f32_16x16x32_bf16 v[238:241], a[24:27], v[214:217], 0
    s_mov_b32 m0, s29
    v_mul_f32 v133, v255, v133
    v_cvt_pk_bf16_f32 v131, v132, v133
    v_mfma_f32_16x16x32_bf16 v[238:241], a[28:31], v[226:229], v[238:241]
    s_xor_b32 s29, s29, s30
    v_fma_f32 v163, v222, v222, s32
    v_fmac_f32 v163, v223, v223
    v_mfma_f32_16x16x32_bf16 v[238:241], a[32:35], v[198:201], v[238:241]
    s_add_u32 s19, s19, s20
    v_fmac_f32 v163, v224, v224
    v_fmac_f32 v163, v225, v225
    v_mfma_f32_16x16x32_bf16 v[238:241], a[36:39], v[230:233], v[238:241]
    s_add_u32 s23, s23, s21
    v_mul_f32 v126, v255, v126
    v_mul_f32 v127, v255, v127
    v_mfma_f32_16x16x32_bf16 v[238:241], a[40:43], v[190:193], v[238:241]
    buffer_load_dwordx4 v14, s[8:11], 0 offen nt lds
    v_cvt_pk_bf16_f32 v132, v126, v127
    v_mfma_f32_16x16x32_bf16 v[238:241], a[44:47], v[210:213], v[238:241]
    s_cmp_ge_u32 s19, 72
    v_mul_f32 v128, v255, v128
    v_mul_f32 v129, v255, v129
    v_mfma_f32_16x16x32_bf16 v[178:181], a[48:51], v[214:217], 0
    s_cselect_b32 s34, 72, 0
    v_cvt_pk_bf16_f32 v133, v128, v129
    v_mul_f32 v114, v255, v114
    v_mfma_f32_16x16x32_bf16 v[178:181], a[52:55], v[226:229], v[178:181]
    s_cselect_b32 s35, s22, 0
    v_fmac_f32 v163, v238, v238
    v_fmac_f32 v163, v239, v239
    v_mfma_f32_16x16x32_bf16 v[178:181], a[56:59], v[198:201], v[178:181]
    s_sub_u32 s19, s19, s34
    v_fmac_f32 v163, v240, v240
    v_fmac_f32 v163, v241, v241
    v_mfma_f32_16x16x32_bf16 v[178:181], a[60:63], v[230:233], v[178:181]
    buffer_store_dwordx4 v[158:161], v15, s[12:15], 0 offen nt
    v_mul_f32 v115, v255, v115
    v_cvt_pk_bf16_f32 v254, v114, v115
    v_mul_f32 v116, v255, v116
    v_mul_f32 v117, v255, v117
    v_mfma_f32_16x16x32_bf16 v[178:181], a[64:67], v[190:193], v[178:181]
    s_add_u32 s23, s23, s35
    v_cvt_pk_bf16_f32 v255, v116, v117
    v_xor_b32 v0, 65536, v0
    v_mfma_f32_16x16x32_bf16 v[178:181], a[68:71], v[210:213], v[178:181]
    s_add_u32 s78, s78, s69
    v_xor_b32 v1, 65536, v1
    s_add_u32 s80, s77, s68
    v_mfma_f32_16x16x32_bf16 v[114:117], v[214:217], a[144:147], 0
    s_cmp_ge_u32 s80, 72
    s_cselect_b32 s80, s22, 0
    s_add_u32 s78, s78, s80
    v_mfma_f32_16x16x32_bf16 v[114:117], v[226:229], a[148:151], v[114:117]
    s_add_u32 s80, s77, 20
    v_fmac_f32 v163, v178, v178
    v_fmac_f32 v163, v179, v179
    v_mfma_f32_16x16x32_bf16 v[114:117], v[198:201], a[152:155], v[114:117]
    s_add_u32 s34, s18, 3
    v_fmac_f32 v163, v180, v180
    v_fmac_f32 v163, v181, v181
    v_mfma_f32_16x16x32_bf16 v[114:117], v[230:233], a[156:159], v[114:117]
    s_cmp_lt_u32 s77, s62
    ds_read2_b32 v[164:165], v6 offset0:0 offset1:0
    ds_read2_b32 v[168:169], v6 offset0:16 offset1:16
    v_mfma_f32_16x16x32_bf16 v[114:117], v[190:193], a[160:163], v[114:117]
    s_cselect_b32 s79, 1, 0
    ds_read2_b32 v[172:173], v6 offset0:32 offset1:32
    v_cvt_pk_bf16_f32 v36, v163, v162
    v_mfma_f32_16x16x32_bf16 v[114:117], v[210:213], a[164:167], v[114:117]
    s_cselect_b32 s78, s78, 0
    s_cmp_lt_u32 s34, s17
    s_cselect_b32 s23, s23, s78
    v_mfma_f32_16x16x32_bf16 v[234:237], v[32:35], v[36:39], 0
    s_cselect_b32 s73, s34, s80
    s_cselect_b32 s79, 0, s79
    s_cselect_b32 s81, 0, 1
    v_mfma_f32_16x16x32_bf16 v[126:129], v[214:217], a[168:171], 0
    s_sub_u32 s80, s100, s81
    v_cvt_pk_bf16_f32 v162, v114, v115
    v_cvt_pk_bf16_f32 v163, v116, v117
    v_mfma_f32_16x16x32_bf16 v[126:129], v[226:229], a[172:175], v[126:129]
    s_and_b32 s100, s100, s80
    v_rsq_f32 v235, v235
    v_mfma_f32_16x16x32_bf16 v[126:129], v[198:201], a[176:179], v[126:129]
    s_lshl_b32 s80, s79, s73
    v_rsq_f32 v234, v234
    v_mfma_f32_16x16x32_bf16 v[126:129], v[230:233], a[180:183], v[126:129]
    s_or_b32 s70, s70, s80
    v_mul_f32 v234, s31, v234
    v_mul_f32 v186, v235, v186
    v_mfma_f32_16x16x32_bf16 v[126:129], v[190:193], a[184:187], v[126:129]
    s_add_u32 s45, s45, s79
    v_mul_f32 v187, v235, v187
    v_cvt_pk_f16_f32 v114, v186, v187
    v_mfma_f32_16x16x32_bf16 v[126:129], v[210:213], a[188:191], v[126:129]
    s_add_u32 s18, s18, 1
    v_mul_f32 v188, v235, v188
    v_mul_f32 v189, v235, v189
    v_mfma_f32_16x16x32_bf16 v[158:161], v[214:217], a[192:195], 0
    s_cmp_lt_u32 s18, s45
    v_cvt_pk_f16_f32 v115, v188, v189
    v_mul_f32 v134, v235, v134
    v_mfma_f32_16x16x32_bf16 v[158:161], v[226:229], a[196:199], v[158:161]
    s_waitcnt lgkmcnt(0)
    buffer_store_dwordx2 v[170:171], v18, s[12:15], 0 offen nt
    v_cvt_pk_bf16_f32 v166, v126, v127
    v_cvt_pk_bf16_f32 v167, v128, v129
    v_mfma_f32_16x16x32_bf16 v[158:161], v[198:201], a[200:203], v[158:161]
    ds_read_b128 v[226:229], v5 offset:0
    ds_read_b128 v[206:209], v5 offset:16
    v_mfma_f32_16x16x32_bf16 v[158:161], v[230:233], a[204:207], v[158:161]
    ds_read_b128 v[198:201], v5 offset:48
    ds_read_b32 v236, v6 offset:192
    v_mfma_f32_16x16x32_bf16 v[158:161], v[190:193], a[208:211], v[158:161]
    v_mul_f32 v135, v235, v135
    v_cvt_pk_f16_f32 v116, v134, v135
    v_mfma_f32_16x16x32_f16 v[186:189], v[174:177], v[202:205], v[46:49]
    v_mul_f32 v136, v235, v136
    v_mul_f32 v137, v235, v137
    v_mfma_f32_16x16x32_f16 v[182:185], v[138:141], v[202:205], v[50:53]
    v_cvt_pk_f16_f32 v117, v136, v137
    v_mul_f32 v218, v235, v218
    v_mfma_f32_16x16x32_bf16 v[158:161], v[210:213], a[212:215], v[158:161]
    ds_read_b128 v[194:197], v2 offset:0
    ds_read_b128 v[190:193], v2 offset:1024
    v_mfma_f32_16x16x32_f16 v[126:129], v[114:117], v[202:205], v[54:57]
    v_mul_f32 v219, v235, v219
    v_cvt_pk_f16_f32 v136, v218, v219
    v_mul_f32 v220, v235, v220
    v_mfma_f32_16x16x16_f16 v[186:189], v[120:121], v[118:119], v[186:189]
    v_mul_f32 v221, v235, v221
    v_cvt_pk_bf16_f32 v170, v158, v159
    v_cvt_pk_bf16_f32 v171, v160, v161
    v_mfma_f32_16x16x16_f16 v[182:185], v[124:125], v[118:119], v[182:185]
    v_cvt_pk_f16_f32 v137, v220, v221
    v_mul_f32 v222, v234, v222
    v_mul_f32 v223, v234, v223
    v_mfma_f32_16x16x16_f16 v[126:129], v[136:137], v[118:119], v[126:129]
    v_cvt_pk_f16_f32 v158, v222, v223
    v_mul_f32 v224, v234, v224
    v_mul_f32 v225, v234, v225
    s_waitcnt lgkmcnt(2)
    v_mfma_f32_16x16x32_f16 v[230:233], v[226:229], v[202:205], v[22:25]
    ds_read_b128 v[210:213], v2 offset:2048
    ds_read_b128 v[202:205], v2 offset:3072
    v_mfma_f32_16x16x32_f16 v[230:233], v[206:209], v[174:177], v[230:233]
    v_cvt_pk_f16_f32 v159, v224, v225
    v_mul_f32 v238, v234, v238
    v_mfma_f32_16x16x32_f16 v[230:233], v[198:201], v[118:121], v[230:233]
    s_waitcnt lgkmcnt(2)
    ds_read_b128 v[214:217], v2 offset:4096
    v_mul_f32 v239, v234, v239
    v_cvt_pk_f16_f32 v160, v238, v239
    v_mul_f32 v240, v234, v240
    v_mul_f32 v241, v234, v241
    v_cvt_pk_f16_f32 v161, v240, v241
    v_mfma_f32_16x16x32_f16 v[218:221], v[226:229], v[154:157], v[24:27]
    v_mul_f32 v178, v234, v178
    v_mul_f32 v179, v234, v179
    v_mfma_f32_16x16x32_f16 v[218:221], v[206:209], v[138:141], v[218:221]
    v_cvt_pk_f16_f32 v134, v178, v179
    v_mul_f32 v180, v234, v180
    v_mfma_f32_16x16x32_f16 v[218:221], v[198:201], v[122:125], v[218:221]
    buffer_store_dwordx4 v[130:133], v16, s[12:15], 0 offen nt
    ds_read_b128 v[222:225], v2 offset:5120
    v_mul_f32 v181, v234, v181
    v_cvt_pk_f16_f32 v135, v180, v181
    v_mov_b32_dpp v236, v231 quad_perm:[0,1,2,3] row_mask:0x1 bank_mask:0xf
    v_mfma_f32_16x16x32_f16 v[238:241], v[226:229], v[158:161], v[26:29]
    s_waitcnt lgkmcnt(2)
    v_max3_f32 v118, v230, v186, v187
    v_mov_b32_dpp v236, v219 quad_perm:[0,1,2,3] row_mask:0x2 bank_mask:0xf
    v_mfma_f32_16x16x32_f16 v[238:241], v[206:209], v[114:117], v[238:241]
    v_max3_f32 v118, v118, v188, v189
    v_max3_f32 v118, v118, v182, v183
    v_mfma_f32_16x16x32_f16 v[238:241], v[198:201], v[134:137], v[238:241]
    s_waitcnt lgkmcnt(1)
    v_max3_f32 v118, v118, v184, v185
    v_max3_f32 v118, v118, v126, v127
    v_mfma_f32_16x16x32_bf16 v[178:181], a[216:219], v[194:197], 0
    v_max3_f32 v118, v118, v128, v129
    v_mov_b32 v119, v118
    v_mfma_f32_16x16x32_bf16 v[178:181], a[220:223], v[190:193], v[178:181]
    v_add_u32 v5, s74, v5
    v_mov_b32_dpp v236, v239 quad_perm:[0,1,2,3] row_mask:0x4 bank_mask:0xf
    v_mfma_f32_16x16x32_bf16 v[178:181], a[224:227], v[210:213], v[178:181]
    v_permlane32_swap_b32 v118, v119
    v_mfma_f32_16x16x32_bf16 v[178:181], a[228:231], v[202:205], v[178:181]
    s_waitcnt lgkmcnt(0)
    v_max_f32 v118, v118, v119
    v_mov_b32 v119, v118
    v_mfma_f32_16x16x32_bf16 v[178:181], a[232:235], v[214:217], v[178:181]
    v_mov_b32 v219, v236
    v_add_u32 v6, s75, v6
    v_mfma_f32_16x16x32_bf16 v[178:181], a[236:239], v[222:225], v[178:181]
    v_permlane16_swap_b32 v118, v119
    v_mfma_f32_16x16x32_bf16 v[198:201], a[240:243], v[194:197], 0
    v_max_f32 v118, v118, v119
    v_sub_f32 v186, v186, v118
    v_mfma_f32_16x16x32_bf16 v[198:201], a[244:247], v[190:193], v[198:201]
    v_exp_f32 v186, v186
    v_mfma_f32_16x16x32_bf16 v[198:201], a[248:251], v[210:213], v[198:201]
    v_sub_f32 v187, v187, v118
    v_sub_f32 v188, v188, v118
    v_mfma_f32_16x16x32_bf16 v[198:201], a[252:255], v[202:205], v[198:201]
    v_exp_f32 v187, v187
    v_mfma_f32_16x16x32_bf16 v[198:201], v[82:85], v[214:217], v[198:201]
    v_cvt_pk_bf16_f32 v186, v186, v187
    v_sub_f32 v189, v189, v118
    v_mfma_f32_16x16x32_bf16 v[198:201], v[86:89], v[222:225], v[198:201]
    v_exp_f32 v188, v188
    v_mfma_f32_16x16x32_bf16 v[206:209], v[90:93], v[194:197], 0
    ds_read_b128 v[194:197], v2 offset:6144
    buffer_store_dwordx2 v[254:255], v19, s[12:15], 0 offen nt
    v_exp_f32 v189, v189
    v_mfma_f32_16x16x32_bf16 v[206:209], v[94:97], v[190:193], v[206:209]
    ds_read_b128 v[190:193], v2 offset:7168
    v_cvt_pk_bf16_f32 v187, v188, v189
    v_mfma_f32_16x16x32_bf16 v[206:209], v[98:101], v[210:213], v[206:209]
    ds_read_b128 v[210:213], v2 offset:8192
    v_sub_f32 v182, v182, v118
    v_mfma_f32_16x16x32_bf16 v[206:209], v[102:105], v[202:205], v[206:209]
    ds_read_b128 v[202:205], v2 offset:9216
    v_sub_f32 v183, v183, v118
    v_mfma_f32_16x16x32_bf16 v[206:209], v[106:109], v[214:217], v[206:209]
    ds_read_b128 v[214:217], v2 offset:10240
    v_sub_f32 v184, v184, v118
    v_mfma_f32_16x16x32_bf16 v[206:209], v[110:113], v[222:225], v[206:209]
    ds_read_b128 v[222:225], v2 offset:11264
    v_exp_f32 v182, v182
    v_mfma_f32_16x16x32_f16 v[226:229], v[174:177], v[154:157], v[58:61]
    v_exp_f32 v183, v183
    s_waitcnt lgkmcnt(5)
    v_mfma_f32_16x16x32_bf16 v[130:133], a[216:219], v[194:197], 0
    v_cvt_pk_bf16_f32 v188, v182, v183
    v_exp_f32 v184, v184
    s_waitcnt lgkmcnt(4)
    v_mfma_f32_16x16x16_f16 v[226:229], v[120:121], v[122:123], v[226:229]
    v_sub_f32 v185, v185, v118
    v_exp_f32 v185, v185
    v_sub_f32 v126, v126, v118
    v_mfma_f32_16x16x32_bf16 v[130:133], a[220:223], v[190:193], v[130:133]
    s_waitcnt lgkmcnt(2)
    v_cvt_pk_bf16_f32 v189, v184, v185
    v_sub_f32 v127, v127, v118
    v_mfma_f32_16x16x32_bf16 v[130:133], a[224:227], v[210:213], v[130:133]
    s_waitcnt lgkmcnt(1)
    v_exp_f32 v126, v126
    v_mfma_f32_16x16x32_bf16 v[130:133], a[228:231], v[202:205], v[130:133]
    s_waitcnt lgkmcnt(0)
    v_exp_f32 v127, v127
    v_mfma_f32_16x16x32_bf16 v[130:133], a[232:235], v[214:217], v[130:133]
    v_cvt_pk_bf16_f32 v36, v126, v127
    v_sub_f32 v128, v128, v118
    v_mfma_f32_16x16x32_f16 v[182:185], v[138:141], v[154:157], v[62:65]
    v_exp_f32 v128, v128
    v_mfma_f32_16x16x32_bf16 v[130:133], a[236:239], v[222:225], v[130:133]
    v_sub_f32 v129, v129, v118
    v_exp_f32 v129, v129
    v_sub_f32 v230, v230, v118
    v_cvt_pk_bf16_f32 v37, v128, v129
    v_mfma_f32_16x16x16_f16 v[182:185], v[124:125], v[122:123], v[182:185]
    v_exp_f32 v230, v230
    v_max_f32_dpp v219, v219, v219 quad_perm:[1,0,3,2] row_mask:0xf bank_mask:0xf
    v_cvt_pk_bf16_f32 v39, v230, 0
    v_mfma_f32_16x16x32_f16 v[230:233], v[114:117], v[154:157], v[66:69]
    v_max_f32_dpp v219, v219, v219 quad_perm:[2,3,0,1] row_mask:0xf bank_mask:0xf
    v_max3_f32 v254, v218, v226, v227
    v_max3_f32 v254, v254, v228, v229
    v_max_f32_dpp v219, v219, v219 row_half_mirror row_mask:0xf bank_mask:0xf
    v_max3_f32 v254, v254, v182, v183
    v_max3_f32 v254, v254, v184, v185
    v_mfma_f32_16x16x16_f16 v[230:233], v[136:137], v[122:123], v[230:233]
    v_max_f32_dpp v219, v219, v219 row_mirror row_mask:0xf bank_mask:0xf
    v_mov_b32 v255, v219
    v_fma_f32 v118, v178, v178, s33
    v_fmac_f32 v118, v179, v179
    v_permlane32_swap_b32 v219, v255
    v_max_f32 v219, v219, v255
    v_mfma_f32_16x16x32_bf16 v[154:157], v[28:31], v[36:39], 0
    v_mov_b32 v255, v219
    v_max3_f32 v254, v254, v230, v231
    v_mfma_f32_16x16x32_bf16 v[154:157], v[28:31], v[186:189], v[154:157]
    v_permlane16_swap_b32 v219, v255
    v_max_f32 v219, v219, v255
    v_sub_f32 v236, v236, v219
    v_mfma_f32_16x16x32_bf16 v[126:129], v[162:165], v[36:39], 0
    v_exp_f32 v236, v236
    v_mfma_f32_16x16x32_bf16 v[126:129], v[142:145], v[186:189], v[126:129]
    v_cvt_pk_bf16_f32 v236, v236, v236
    v_max3_f32 v254, v254, v232, v233
    v_rcp_f32 v154, v154
    v_mov_b32 v119, v254
    v_fmac_f32 v118, v180, v180
    v_fmac_f32 v118, v181, v181
    v_permlane32_swap_b32 v254, v119
    v_max_f32 v254, v254, v119
    v_mul_f32 v126, v154, v126
    v_mul_f32 v127, v154, v127
    v_cvt_pk_bf16_f32 v126, v126, v127
    v_mul_f32 v128, v154, v128
    v_mul_f32 v129, v154, v129
    v_cvt_pk_bf16_f32 v127, v128, v129
    v_mov_b32 v119, v254
    v_fmac_f32 v118, v198, v198
    v_fmac_f32 v118, v199, v199
    v_permlane16_swap_b32 v254, v119
    v_max_f32 v254, v254, v119
    v_sub_f32 v226, v226, v254
    v_exp_f32 v226, v226
    v_sub_f32 v227, v227, v254
    v_exp_f32 v227, v227
    v_sub_f32 v228, v228, v254
    v_cvt_pk_bf16_f32 v226, v226, v227
    v_exp_f32 v228, v228
    v_sub_f32 v229, v229, v254
    v_exp_f32 v229, v229
    v_sub_f32 v182, v182, v254
    v_cvt_pk_bf16_f32 v227, v228, v229
    v_mfma_f32_16x16x32_bf16 v[242:245], v[166:169], v[36:39], 0
    ds_write_b16 v8, v236
    v_mfma_f32_16x16x32_bf16 v[242:245], v[146:149], v[186:189], v[242:245]
    v_exp_f32 v182, v182
    v_sub_f32 v183, v183, v254
    v_exp_f32 v183, v183
    v_sub_f32 v184, v184, v254
    v_cvt_pk_bf16_f32 v228, v182, v183
    v_exp_f32 v184, v184
    v_sub_f32 v185, v185, v254
    v_exp_f32 v185, v185
    v_mul_f32 v242, v154, v242
    v_mul_f32 v243, v154, v243
    v_cvt_pk_bf16_f32 v128, v242, v243
    v_mul_f32 v244, v154, v244
    v_mul_f32 v245, v154, v245
    v_cvt_pk_bf16_f32 v129, v244, v245
    v_mfma_f32_16x16x32_bf16 v[234:237], v[170:173], v[36:39], 0
    ds_write_b128 v3, v[126:129] offset:0
    v_mfma_f32_16x16x32_bf16 v[234:237], v[150:153], v[186:189], v[234:237]
    v_cvt_pk_bf16_f32 v229, v184, v185
    v_sub_f32 v230, v230, v254
    v_mfma_f32_16x16x32_f16 v[182:185], v[174:177], v[158:161], v[70:73]
    v_exp_f32 v230, v230
    v_mfma_f32_16x16x32_bf16 v[126:129], a[240:243], v[194:197], 0
    ds_read_b128 v[174:177], v9
    v_sub_f32 v231, v231, v254
    v_mfma_f32_16x16x32_bf16 v[126:129], a[244:247], v[190:193], v[126:129]
    v_mul_f32 v234, v154, v234
    v_mul_f32 v235, v154, v235
    v_cvt_pk_bf16_f32 v122, v234, v235
    v_mfma_f32_16x16x16_f16 v[182:185], v[120:121], v[134:135], v[182:185]
    v_mul_f32 v236, v154, v236
    v_mul_f32 v237, v154, v237
    v_cvt_pk_bf16_f32 v123, v236, v237
    v_sub_f32 v232, v232, v254
    v_mfma_f32_16x16x32_bf16 v[126:129], a[248:251], v[210:213], v[126:129]
    ds_read_b128 v[154:157], v9 offset:64
    v_sub_f32 v233, v233, v254
    v_mfma_f32_16x16x32_bf16 v[126:129], a[252:255], v[202:205], v[126:129]
    ds_write_b64 v4, v[122:123] offset:4096
    v_mfma_f32_16x16x32_bf16 v[126:129], v[82:85], v[214:217], v[126:129]
    v_max3_f32 v255, v238, v182, v183
    v_max3_f32 v255, v255, v184, v185
    v_mfma_f32_16x16x32_bf16 v[126:129], v[86:89], v[222:225], v[126:129]
    v_exp_f32 v231, v231
    v_exp_f32 v232, v232
    v_cvt_pk_bf16_f32 v36, v230, v231
    v_mfma_f32_16x16x32_f16 v[186:189], v[138:141], v[158:161], v[74:77]
    s_waitcnt lgkmcnt(2)
    v_exp_f32 v233, v233
    v_mfma_f32_16x16x32_f16 v[138:141], v[114:117], v[158:161], v[78:81]
    v_cvt_pk_bf16_f32 v37, v232, v233
    v_sub_f32 v218, v218, v254
    v_mfma_f32_16x16x32_bf16 v[234:237], v[174:177], v[28:31], 0
    v_exp_f32 v218, v218
    v_fmac_f32 v118, v200, v200
    v_mfma_f32_16x16x16_f16 v[186:189], v[124:125], v[134:135], v[186:189]
    v_cvt_pk_bf16_f32 v39, v218, 0
    v_fmac_f32 v118, v201, v201
    v_fmac_f32 v118, v206, v206
    v_mfma_f32_16x16x16_f16 v[138:141], v[136:137], v[134:135], v[138:141]
    v_fmac_f32 v118, v207, v207
    v_fmac_f32 v118, v208, v208
    v_fmac_f32 v118, v209, v209
    v_fma_f32 v254, v130, v130, s33
    v_mfma_f32_16x16x32_bf16 v[122:125], v[28:31], v[36:39], 0
    s_waitcnt lgkmcnt(0)
    v_max3_f32 v255, v255, v186, v187
    v_max3_f32 v255, v255, v188, v189
    v_mfma_f32_16x16x32_bf16 v[122:125], v[28:31], v[226:229], v[122:125]
    v_max3_f32 v255, v255, v138, v139
    v_max3_f32 v255, v255, v140, v141
    v_mfma_f32_16x16x32_bf16 v[114:117], v[162:165], v[36:39], 0
    v_mov_b32 v119, v255
    v_fmac_f32 v254, v131, v131
    v_mfma_f32_16x16x32_bf16 v[114:117], v[142:145], v[226:229], v[114:117]
    v_permlane32_swap_b32 v255, v119
    v_mfma_f32_16x16x32_bf16 v[134:137], v[166:169], v[36:39], 0
    v_rcp_f32 v122, v122
    v_mfma_f32_16x16x32_bf16 v[134:137], v[146:149], v[226:229], v[134:137]
    v_max_f32 v255, v255, v119
    v_mov_b32 v119, v255
    v_mfma_f32_16x16x32_bf16 v[158:161], v[170:173], v[36:39], 0
    v_fmac_f32 v254, v132, v132
    v_mul_f32 v114, v122, v114
    v_mfma_f32_16x16x32_bf16 v[158:161], v[150:153], v[226:229], v[158:161]
    v_mul_f32 v115, v122, v115
    v_cvt_pk_bf16_f32 v114, v114, v115
    v_mfma_f32_16x16x32_bf16 v[234:237], v[154:157], v[28:31], v[234:237]
    v_mul_f32 v116, v122, v116
    v_mul_f32 v117, v122, v117
    v_mfma_f32_16x16x32_bf16 v[218:221], v[174:177], v[142:145], 0
    v_cvt_pk_bf16_f32 v115, v116, v117
    v_mul_f32 v134, v122, v134
    v_mfma_f32_16x16x32_bf16 v[218:221], v[154:157], v[162:165], v[218:221]
    v_mul_f32 v135, v122, v135
    v_cvt_pk_bf16_f32 v116, v134, v135
    v_mfma_f32_16x16x32_bf16 v[226:229], v[174:177], v[146:149], 0
    v_mul_f32 v136, v122, v136
    v_mul_f32 v137, v122, v137
    v_mfma_f32_16x16x32_bf16 v[226:229], v[154:157], v[166:169], v[226:229]
    v_cvt_pk_bf16_f32 v117, v136, v137
    v_mul_f32 v158, v122, v158
    v_mfma_f32_16x16x32_bf16 v[134:137], v[174:177], v[150:153], 0
    ds_write_b128 v3, v[114:117] offset:6144
    v_mfma_f32_16x16x32_bf16 v[134:137], v[154:157], v[170:173], v[134:137]
    v_mul_f32 v159, v122, v159
    v_cvt_pk_bf16_f32 v120, v158, v159
    v_mfma_f32_16x16x32_bf16 v[114:117], v[90:93], v[194:197], 0
    v_mul_f32 v160, v122, v160
    v_mul_f32 v161, v122, v161
    v_mfma_f32_16x16x32_bf16 v[114:117], v[94:97], v[190:193], v[114:117]
    ds_read_b128 v[122:125], v2 offset:12288
    ds_read_b128 v[174:177], v2 offset:13312
    v_mfma_f32_16x16x32_bf16 v[114:117], v[98:101], v[210:213], v[114:117]
    ds_read_b128 v[190:193], v2 offset:14336
    v_cvt_pk_bf16_f32 v121, v160, v161
    v_mfma_f32_16x16x32_bf16 v[114:117], v[102:105], v[202:205], v[114:117]
    ds_read_b128 v[194:197], v2 offset:15360
    v_fmac_f32 v254, v133, v133
    v_mfma_f32_16x16x32_bf16 v[114:117], v[106:109], v[214:217], v[114:117]
    ds_read_b128 v[202:205], v2 offset:16384
    v_fmac_f32 v254, v126, v126
    v_mfma_f32_16x16x32_bf16 v[114:117], v[110:113], v[222:225], v[114:117]
    ds_read_b128 v[210:213], v2 offset:17408
    ds_write_b64 v4, v[120:121] offset:10240
    v_permlane16_swap_b32 v255, v119
    v_max_f32 v255, v255, v119
    v_sub_f32 v182, v182, v255
    v_exp_f32 v182, v182
    v_sub_f32 v183, v183, v255
    v_exp_f32 v183, v183
    s_waitcnt lgkmcnt(5)
    v_mfma_f32_16x16x32_bf16 v[242:245], a[216:219], v[122:125], 0
    v_cvt_pk_bf16_f32 v182, v182, v183
    v_sub_f32 v184, v184, v255
    v_mfma_f32_16x16x32_bf16 v[242:245], a[220:223], v[174:177], v[242:245]
    s_waitcnt lgkmcnt(4)
    v_exp_f32 v184, v184
    v_mfma_f32_16x16x32_bf16 v[242:245], a[224:227], v[190:193], v[242:245]
    s_waitcnt lgkmcnt(3)
    v_sub_f32 v185, v185, v255
    v_sub_f32 v186, v186, v255
    v_mfma_f32_16x16x32_bf16 v[242:245], a[228:231], v[194:197], v[242:245]
    s_waitcnt lgkmcnt(2)
    v_exp_f32 v185, v185
    v_mfma_f32_16x16x32_bf16 v[242:245], a[232:235], v[202:205], v[242:245]
    s_waitcnt lgkmcnt(0)
    v_cvt_pk_bf16_f32 v183, v184, v185
    v_sub_f32 v187, v187, v255
    v_mfma_f32_16x16x32_bf16 v[242:245], a[236:239], v[210:213], v[242:245]
    v_exp_f32 v186, v186
    v_mfma_f32_16x16x32_bf16 v[158:161], a[240:243], v[122:125], 0
    v_exp_f32 v187, v187
    v_mfma_f32_16x16x32_bf16 v[158:161], a[244:247], v[174:177], v[158:161]
    v_cvt_pk_bf16_f32 v184, v186, v187
    v_sub_f32 v188, v188, v255
    v_mfma_f32_16x16x32_bf16 v[158:161], a[248:251], v[190:193], v[158:161]
    v_exp_f32 v188, v188
    v_mfma_f32_16x16x32_bf16 v[158:161], a[252:255], v[194:197], v[158:161]
    v_sub_f32 v189, v189, v255
    v_sub_f32 v138, v138, v255
    v_mfma_f32_16x16x32_bf16 v[158:161], v[82:85], v[202:205], v[158:161]
    v_exp_f32 v189, v189
    v_mfma_f32_16x16x32_bf16 v[158:161], v[86:89], v[210:213], v[158:161]
    v_cvt_pk_bf16_f32 v185, v188, v189
    v_sub_f32 v139, v139, v255
    v_mfma_f32_16x16x32_bf16 v[154:157], v[90:93], v[122:125], 0
    v_exp_f32 v138, v138
    v_mfma_f32_16x16x32_bf16 v[154:157], v[94:97], v[174:177], v[154:157]
    v_exp_f32 v139, v139
    v_mfma_f32_16x16x32_bf16 v[154:157], v[98:101], v[190:193], v[154:157]
    v_cvt_pk_bf16_f32 v36, v138, v139
    v_sub_f32 v140, v140, v255
    v_mfma_f32_16x16x32_bf16 v[154:157], v[102:105], v[194:197], v[154:157]
    v_exp_f32 v140, v140
    v_mfma_f32_16x16x32_bf16 v[154:157], v[106:109], v[202:205], v[154:157]
    v_sub_f32 v141, v141, v255
    v_sub_f32 v238, v238, v255
    v_mfma_f32_16x16x32_bf16 v[154:157], v[110:113], v[210:213], v[154:157]
    ds_read_b128 v[186:189], v0 offset:20480
    ds_read_b128 v[194:197], v1 offset:20480
    ds_read_b128 v[122:125], v0 offset:20608
    v_exp_f32 v141, v141
    v_exp_f32 v238, v238
    v_cvt_pk_bf16_f32 v37, v140, v141
    v_cvt_pk_bf16_f32 v39, v238, 0
    v_fma_f32 v255, v242, v242, s33
    v_fmac_f32 v255, v243, v243
    v_mfma_f32_16x16x32_bf16 v[138:141], v[28:31], v[36:39], 0
    ds_read_b128 v[202:205], v1 offset:20608
    ds_read_b128 v[230:233], v0 offset:20736
    v_mfma_f32_16x16x32_bf16 v[138:141], v[28:31], v[182:185], v[138:141]
    ds_read_b128 v[238:241], v1 offset:20736
    v_fmac_f32 v255, v244, v244
    v_mfma_f32_16x16x32_bf16 v[174:177], v[162:165], v[36:39], 0
    v_fmac_f32 v255, v245, v245
    v_fmac_f32 v255, v158, v158
    v_mfma_f32_16x16x32_bf16 v[174:177], v[142:145], v[182:185], v[174:177]
    v_fmac_f32 v255, v159, v159
    v_fmac_f32 v255, v160, v160
    v_mfma_f32_16x16x32_bf16 v[142:145], v[166:169], v[36:39], 0
    s_waitcnt lgkmcnt(5)
    v_rcp_f32 v138, v138
    v_mfma_f32_16x16x32_bf16 v[142:145], v[146:149], v[182:185], v[142:145]
    s_waitcnt lgkmcnt(3)
    v_fmac_f32 v255, v161, v161
    v_mul_f32 v174, v138, v174
    v_mfma_f32_16x16x32_bf16 v[146:149], v[170:173], v[36:39], 0
    v_mul_f32 v175, v138, v175
    v_cvt_pk_bf16_f32 v162, v174, v175
    v_mfma_f32_16x16x32_bf16 v[146:149], v[150:153], v[182:185], v[146:149]
    v_mul_f32 v176, v138, v176
    v_mul_f32 v177, v138, v177
    v_mfma_f32_16x16x32_bf16 v[150:153], a[72:75], v[186:189], 0
    s_waitcnt lgkmcnt(1)
    v_cvt_pk_bf16_f32 v163, v176, v177
    v_mul_f32 v142, v138, v142
    v_mfma_f32_16x16x32_bf16 v[150:153], a[76:79], v[194:197], v[150:153]
    s_waitcnt lgkmcnt(0)
    v_mul_f32 v143, v138, v143
    v_cvt_pk_bf16_f32 v164, v142, v143
    v_mfma_f32_16x16x32_bf16 v[150:153], a[80:83], v[122:125], v[150:153]
    v_mul_f32 v144, v138, v144
    v_mul_f32 v145, v138, v145
    v_mfma_f32_16x16x32_bf16 v[150:153], a[84:87], v[202:205], v[150:153]
    v_cvt_pk_bf16_f32 v165, v144, v145
    v_mul_f32 v146, v138, v146
    v_mfma_f32_16x16x32_bf16 v[150:153], a[88:91], v[230:233], v[150:153]
    ds_write_b128 v3, v[162:165] offset:12288
    v_mfma_f32_16x16x32_bf16 v[150:153], a[92:95], v[238:241], v[150:153]
    v_mul_f32 v147, v138, v147
    v_cvt_pk_bf16_f32 v146, v146, v147
    v_mfma_f32_16x16x32_bf16 v[162:165], a[96:99], v[186:189], 0
    v_mul_f32 v148, v138, v148
    v_mul_f32 v149, v138, v149
    v_mfma_f32_16x16x32_bf16 v[162:165], a[100:103], v[194:197], v[162:165]
    v_cvt_pk_bf16_f32 v147, v148, v149
    v_fmac_f32 v255, v154, v154
    v_mfma_f32_16x16x32_bf16 v[162:165], a[104:107], v[122:125], v[162:165]
    ds_write_b64 v4, v[146:147] offset:16384
    v_mfma_f32_16x16x32_bf16 v[162:165], a[108:111], v[202:205], v[162:165]
    v_fmac_f32 v255, v155, v155
    v_fmac_f32 v255, v156, v156
    v_mfma_f32_16x16x32_bf16 v[162:165], a[112:115], v[230:233], v[162:165]
    v_fmac_f32 v255, v157, v157
    v_cvt_pk_bf16_f32 v255, v255, v255
    v_mfma_f32_16x16x32_bf16 v[162:165], a[116:119], v[238:241], v[162:165]
    v_rcp_f32 v234, v234
    v_mfma_f32_16x16x32_bf16 v[170:173], a[120:123], v[186:189], 0
    v_mul_f32 v218, v218, v234
    v_fmac_f32 v254, v127, v127
    v_mfma_f32_16x16x32_bf16 v[170:173], a[124:127], v[194:197], v[170:173]
    v_mul_f32_dpp v218, v226, v234 quad_perm:[0,1,2,3] row_mask:0x2 bank_mask:0xf
    v_fmac_f32 v254, v128, v128
    v_mfma_f32_16x16x32_bf16 v[170:173], a[128:131], v[122:125], v[170:173]
    v_mul_f32_dpp v218, v134, v234 quad_perm:[0,1,2,3] row_mask:0x4 bank_mask:0xf
    v_cvt_pk_bf16_f32 v218, v218, v218
    v_mfma_f32_16x16x32_bf16 v[170:173], a[132:135], v[202:205], v[170:173]
    ds_write_b16 v7, v218
    v_mfma_f32_16x16x32_bf16 v[170:173], a[136:139], v[230:233], v[170:173]
    v_fmac_f32 v254, v129, v129
    v_fmac_f32 v254, v114, v114
    v_mfma_f32_16x16x32_bf16 v[170:173], a[140:143], v[238:241], v[170:173]
    v_fmac_f32 v254, v115, v115
    v_fmac_f32 v254, v116, v116
    v_mfma_f32_16x16x32_bf16 v[138:141], a[0:3], v[186:189], 0
    v_fmac_f32 v254, v117, v117
    v_cvt_pk_bf16_f32 v254, v118, v254
    v_mfma_f32_16x16x32_bf16 v[138:141], a[4:7], v[194:197], v[138:141]
    ds_write_b64 v4, v[254:255] offset:18432
    v_mfma_f32_16x16x32_bf16 v[138:141], a[8:11], v[122:125], v[138:141]
    v_fma_f32 v174, v150, v150, s32
    v_fmac_f32 v174, v151, v151
    v_mfma_f32_16x16x32_bf16 v[138:141], a[12:15], v[202:205], v[138:141]
    v_fmac_f32 v174, v152, v152
    v_fmac_f32 v174, v153, v153
    v_mfma_f32_16x16x32_bf16 v[138:141], a[16:19], v[230:233], v[138:141]
    v_xor_b32 v2, 65536, v2
    v_xor_b32 v3, 65536, v3
    v_mfma_f32_16x16x32_bf16 v[138:141], a[20:23], v[238:241], v[138:141]
    v_xor_b32 v4, 65536, v4
    v_add_u32 v7, s76, v7
    v_mfma_f32_16x16x32_bf16 v[166:169], a[24:27], v[186:189], 0
    v_mfma_f32_16x16x32_bf16 v[166:169], a[28:31], v[194:197], v[166:169]
    v_mfma_f32_16x16x32_bf16 v[166:169], a[32:35], v[122:125], v[166:169]
    s_waitcnt lgkmcnt(0)
    v_mfma_f32_16x16x32_bf16 v[166:169], a[36:39], v[202:205], v[166:169]
    s_barrier
    v_mfma_f32_16x16x32_bf16 v[166:169], a[40:43], v[230:233], v[166:169]
    v_mfma_f32_16x16x32_bf16 v[166:169], a[44:47], v[238:241], v[166:169]
    v_mfma_f32_16x16x32_bf16 v[134:137], a[48:51], v[186:189], 0
    v_mfma_f32_16x16x32_bf16 v[134:137], a[52:55], v[194:197], v[134:137]
    s_cbranch_scc1 L_LOOP
    v_mfma_f32_16x16x32_bf16 v[134:137], a[56:59], v[122:125], v[134:137]
    s_mov_b32 s12, s40
    ds_read_b128 v[118:121], v2 offset:18432
    ds_read_b128 v[142:145], v2 offset:19456
    v_mfma_f32_16x16x32_bf16 v[134:137], a[60:63], v[202:205], v[134:137]
    s_mov_b32 s13, s41
    v_fmac_f32 v174, v162, v162
    v_fmac_f32 v174, v163, v163
    v_mfma_f32_16x16x32_bf16 v[134:137], a[64:67], v[230:233], v[134:137]
    s_mov_b32 s14, s36
    v_fmac_f32 v174, v164, v164
    v_fmac_f32 v174, v165, v165
    v_mfma_f32_16x16x32_bf16 v[134:137], a[68:71], v[238:241], v[134:137]
    s_add_u32 s48, s40, s27
    v_fmac_f32 v174, v170, v170
    v_fmac_f32 v174, v171, v171
    v_mfma_f32_16x16x32_bf16 v[146:149], v[186:189], a[144:147], 0
    s_addc_u32 s49, s41, 0
    v_fmac_f32 v174, v172, v172
    v_fmac_f32 v174, v173, v173
    v_mfma_f32_16x16x32_bf16 v[146:149], v[194:197], a[148:151], v[146:149]
    s_sub_u32 s50, s36, s27
    v_fma_f32 v254, v138, v138, s32
    v_fmac_f32 v254, v139, v139
    v_mfma_f32_16x16x32_bf16 v[146:149], v[122:125], a[152:155], v[146:149]
    s_mov_b32 s51, 0x00020000
    v_fmac_f32 v254, v140, v140
    v_fmac_f32 v254, v141, v141
    v_mfma_f32_16x16x32_bf16 v[146:149], v[202:205], a[156:159], v[146:149]
    s_add_u32 s52, s40, s26
    v_fmac_f32 v254, v166, v166
    v_fmac_f32 v254, v167, v167
    v_mfma_f32_16x16x32_bf16 v[146:149], v[230:233], a[160:163], v[146:149]
    s_waitcnt lgkmcnt(0)
    v_fmac_f32 v254, v168, v168
    v_fmac_f32 v254, v169, v169
    v_mfma_f32_16x16x32_bf16 v[182:185], v[32:35], v[118:121], 0
    s_addc_u32 s53, s41, 0
    v_fmac_f32 v254, v134, v134
    v_fmac_f32 v254, v135, v135
    v_mfma_f32_16x16x32_bf16 v[182:185], v[32:35], v[142:145], v[182:185]
    s_sub_u32 s54, s36, s26
    v_fmac_f32 v254, v136, v136
    v_fmac_f32 v254, v137, v137
    v_mfma_f32_16x16x32_bf16 v[146:149], v[238:241], a[164:167], v[146:149]
    s_mov_b32 s55, 0x00020000
    v_cvt_pk_bf16_f32 v36, v254, v174
    v_bfe_u32 v254, v2, 4, 6
    v_mfma_f32_16x16x32_bf16 v[118:121], v[186:189], a[168:171], 0
    s_add_u32 s56, s40, s25
    v_mul_f32 v255, 0x3baaaaab, v183
    v_mul_f32 v182, 0x3baaaaab, v182
    v_mfma_f32_16x16x32_bf16 v[142:145], v[32:35], v[36:39], 0
    s_addc_u32 s57, s41, 0
    v_rsq_f32 v255, v255
    v_mfma_f32_16x16x32_bf16 v[118:121], v[194:197], a[172:175], v[118:121]
    s_sub_u32 s58, s36, s25
    v_mul_f32 v130, v255, v130
    v_mul_f32 v131, v255, v131
    v_mfma_f32_16x16x32_bf16 v[118:121], v[122:125], a[176:179], v[118:121]
    s_mov_b32 s59, 0x00020000
    v_cvt_pk_bf16_f32 v130, v130, v131
    v_mul_f32 v132, v255, v132
    v_mfma_f32_16x16x32_bf16 v[118:121], v[202:205], a[180:183], v[118:121]
    s_and_b32 s6, s2, 7
    v_mul_f32 v133, v255, v133
    v_cvt_pk_bf16_f32 v131, v132, v133
    v_mfma_f32_16x16x32_bf16 v[118:121], v[230:233], a[184:187], v[118:121]
    s_sub_u32 s6, 0, s6
    ds_read_b128 v[174:177], v0 offset:26624
    v_mul_f32 v126, v255, v126
    v_mfma_f32_16x16x32_bf16 v[118:121], v[238:241], a[188:191], v[118:121]
    s_lshl_b32 s3, s16, 6
    ds_read_b128 v[190:193], v1 offset:26624
    v_mul_f32 v127, v255, v127
    v_mfma_f32_16x16x32_bf16 v[210:213], v[186:189], a[192:195], 0
    s_lshl_b32 s4, s16, 5
    ds_read_b128 v[186:189], v0 offset:26752
    v_cvt_pk_bf16_f32 v132, v126, v127
    v_mfma_f32_16x16x32_bf16 v[210:213], v[194:197], a[196:199], v[210:213]
    s_add_u32 s4, s4, 256
    ds_read_b128 v[194:197], v1 offset:26752
    v_mul_f32 v128, v255, v128
    v_mfma_f32_16x16x32_bf16 v[210:213], v[122:125], a[200:203], v[210:213]
    s_mul_i32 s5, s16, 9408
    ds_read_b128 v[122:125], v0 offset:26880
    v_mul_f32 v129, v255, v129
    v_mfma_f32_16x16x32_bf16 v[210:213], v[202:205], a[204:207], v[210:213]
    s_add_u32 s5, s5, 104448
    ds_read_b128 v[202:205], v1 offset:26880
    v_cvt_pk_bf16_f32 v133, v128, v129
    v_mfma_f32_16x16x32_bf16 v[210:213], v[230:233], a[208:211], v[210:213]
    buffer_store_dwordx4 v[130:133], v16, s[48:51], 0 offen nt
    v_mul_f32 v114, v255, v114
    v_mul_f32 v115, v255, v115
    v_cvt_pk_bf16_f32 v144, v114, v115
    v_mul_f32 v116, v255, v116
    v_mfma_f32_16x16x32_bf16 v[210:213], v[238:241], a[212:215], v[210:213]
    s_waitcnt lgkmcnt(5)
    ds_read_b128 v[126:129], v2 offset:0
    ds_read_b128 v[130:133], v2 offset:1024
    v_mfma_f32_16x16x32_bf16 v[214:217], a[72:75], v[174:177], 0
    s_waitcnt lgkmcnt(6)
    ds_read_b128 v[218:221], v2 offset:2048
    ds_read_b128 v[222:225], v2 offset:3072
    v_mfma_f32_16x16x32_bf16 v[214:217], a[76:79], v[190:193], v[214:217]
    s_waitcnt lgkmcnt(7)
    v_mul_f32 v117, v255, v117
    v_cvt_pk_bf16_f32 v145, v116, v117
    v_mfma_f32_16x16x32_bf16 v[214:217], a[80:83], v[186:189], v[214:217]
    s_waitcnt lgkmcnt(6)
    ds_read_b128 v[114:117], v2 offset:4096
    ds_read_b128 v[226:229], v2 offset:5120
    v_mfma_f32_16x16x32_bf16 v[214:217], a[84:87], v[194:197], v[214:217]
    s_waitcnt lgkmcnt(7)
    v_rsq_f32 v182, v182
    v_mfma_f32_16x16x32_bf16 v[214:217], a[88:91], v[122:125], v[214:217]
    s_waitcnt lgkmcnt(6)
    v_mul_f32 v178, v182, v178
    v_mul_f32 v179, v182, v179
    v_mfma_f32_16x16x32_bf16 v[214:217], a[92:95], v[202:205], v[214:217]
    v_cvt_pk_bf16_f32 v178, v178, v179
    v_mul_f32 v180, v182, v180
    v_mfma_f32_16x16x32_bf16 v[230:233], a[96:99], v[174:177], 0
    v_mul_f32 v181, v182, v181
    v_cvt_pk_bf16_f32 v179, v180, v181
    v_mfma_f32_16x16x32_bf16 v[230:233], a[100:103], v[190:193], v[230:233]
    s_waitcnt lgkmcnt(4)
    v_mul_f32 v198, v182, v198
    v_mul_f32 v199, v182, v199
    v_mfma_f32_16x16x32_bf16 v[230:233], a[104:107], v[186:189], v[230:233]
    s_waitcnt lgkmcnt(2)
    v_cvt_pk_bf16_f32 v180, v198, v199
    v_mul_f32 v200, v182, v200
    v_mfma_f32_16x16x32_bf16 v[230:233], a[108:111], v[194:197], v[230:233]
    v_mul_f32 v201, v182, v201
    v_cvt_pk_bf16_f32 v181, v200, v201
    v_mfma_f32_16x16x32_bf16 v[198:201], a[216:219], v[126:129], 0
    s_waitcnt lgkmcnt(0)
    v_mul_f32 v206, v182, v206
    v_mul_f32 v207, v182, v207
    v_mfma_f32_16x16x32_bf16 v[198:201], a[220:223], v[130:133], v[198:201]
    v_cvt_pk_bf16_f32 v206, v206, v207
    v_mul_f32 v208, v182, v208
    v_mfma_f32_16x16x32_bf16 v[198:201], a[224:227], v[218:221], v[198:201]
    v_mul_f32 v209, v182, v209
    v_cvt_pk_bf16_f32 v207, v208, v209
    v_mfma_f32_16x16x32_bf16 v[198:201], a[228:231], v[222:225], v[198:201]
    v_rsq_f32 v143, v143
    v_mfma_f32_16x16x32_bf16 v[198:201], a[232:235], v[114:117], v[198:201]
    buffer_store_dwordx2 v[144:145], v19, s[48:51], 0 offen nt
    v_rsq_f32 v142, v142
    v_mfma_f32_16x16x32_bf16 v[198:201], a[236:239], v[226:229], v[198:201]
    v_mul_f32 v142, s31, v142
    v_cvt_pk_bf16_f32 v146, v146, v147
    v_mfma_f32_16x16x32_bf16 v[234:237], a[240:243], v[126:129], 0
    v_cvt_pk_bf16_f32 v147, v148, v149
    v_cvt_pk_bf16_f32 v118, v118, v119
    v_mfma_f32_16x16x32_bf16 v[234:237], a[244:247], v[130:133], v[234:237]
    v_cvt_pk_bf16_f32 v119, v120, v121
    v_cvt_pk_bf16_f32 v182, v210, v211
    v_mfma_f32_16x16x32_bf16 v[234:237], a[248:251], v[218:221], v[234:237]
    v_fma_f32 v255, v198, v198, s33
    v_fmac_f32 v255, v199, v199
    v_mfma_f32_16x16x32_bf16 v[234:237], a[252:255], v[222:225], v[234:237]
    v_fmac_f32 v255, v200, v200
    v_fmac_f32 v255, v201, v201
    v_mfma_f32_16x16x32_bf16 v[234:237], v[82:85], v[114:117], v[234:237]
    v_cvt_pk_bf16_f32 v183, v212, v213
    v_mul_f32 v150, v143, v150
    v_mfma_f32_16x16x32_bf16 v[234:237], v[86:89], v[226:229], v[234:237]
    v_mul_f32 v151, v143, v151
    v_cvt_pk_f16_f32 v150, v150, v151
    v_mfma_f32_16x16x32_bf16 v[210:213], v[90:93], v[126:129], 0
    v_mul_f32 v152, v143, v152
    v_mul_f32 v153, v143, v153
    v_mfma_f32_16x16x32_bf16 v[210:213], v[94:97], v[130:133], v[210:213]
    v_cvt_pk_f16_f32 v151, v152, v153
    v_mul_f32 v162, v143, v162
    v_mfma_f32_16x16x32_bf16 v[210:213], v[98:101], v[218:221], v[210:213]
    v_fmac_f32 v255, v234, v234
    v_fmac_f32 v255, v235, v235
    v_mfma_f32_16x16x32_bf16 v[210:213], v[102:105], v[222:225], v[210:213]
    v_fmac_f32 v255, v236, v236
    v_fmac_f32 v255, v237, v237
    v_mfma_f32_16x16x32_bf16 v[210:213], v[106:109], v[114:117], v[210:213]
    v_mul_f32 v163, v143, v163
    v_cvt_pk_f16_f32 v152, v162, v163
    v_mfma_f32_16x16x32_bf16 v[210:213], v[110:113], v[226:229], v[210:213]
    v_mul_f32 v164, v143, v164
    v_mul_f32 v165, v143, v165
    v_mfma_f32_16x16x32_bf16 v[230:233], a[112:115], v[122:125], v[230:233]
    v_cvt_pk_f16_f32 v153, v164, v165
    v_mul_f32 v170, v143, v170
    v_mfma_f32_16x16x32_bf16 v[230:233], a[116:119], v[202:205], v[230:233]
    ds_read_b128 v[114:117], v2 offset:6144
    ds_read_b128 v[126:129], v2 offset:7168
    v_mfma_f32_16x16x32_bf16 v[130:133], a[120:123], v[174:177], 0
    ds_read_b128 v[162:165], v2 offset:8192
    ds_read_b128 v[218:221], v2 offset:9216
    v_mfma_f32_16x16x32_bf16 v[130:133], a[124:127], v[190:193], v[130:133]
    buffer_store_dwordx4 v[178:181], v15, s[48:51], 0 offen nt
    ds_read_b128 v[222:225], v2 offset:10240
    v_fmac_f32 v255, v210, v210
    v_fmac_f32 v255, v211, v211
    v_fmac_f32 v255, v212, v212
    v_mfma_f32_16x16x32_bf16 v[130:133], a[128:131], v[186:189], v[130:133]
    ds_read_b128 v[178:181], v2 offset:11264
    v_fmac_f32 v255, v213, v213
    v_mfma_f32_16x16x32_bf16 v[130:133], a[132:135], v[194:197], v[130:133]
    v_mul_f32 v171, v143, v171
    v_cvt_pk_f16_f32 v228, v170, v171
    v_mfma_f32_16x16x32_bf16 v[130:133], a[136:139], v[122:125], v[130:133]
    v_mul_f32 v172, v143, v172
    v_mul_f32 v173, v143, v173
    v_mfma_f32_16x16x32_bf16 v[130:133], a[140:143], v[202:205], v[130:133]
    v_cvt_pk_f16_f32 v229, v172, v173
    v_mul_f32 v138, v142, v138
    v_mfma_f32_16x16x32_bf16 v[170:173], a[0:3], v[174:177], 0
    s_waitcnt lgkmcnt(4)
    v_mul_f32 v139, v142, v139
    v_cvt_pk_f16_f32 v138, v138, v139
    v_mfma_f32_16x16x32_bf16 v[238:241], a[216:219], v[114:117], 0
    s_waitcnt lgkmcnt(2)
    v_mul_f32 v140, v142, v140
    v_mul_f32 v141, v142, v141
    v_mfma_f32_16x16x32_bf16 v[238:241], a[220:223], v[126:129], v[238:241]
    s_waitcnt lgkmcnt(1)
    v_cvt_pk_f16_f32 v139, v140, v141
    v_mul_f32 v166, v142, v166
    v_mfma_f32_16x16x32_bf16 v[238:241], a[224:227], v[162:165], v[238:241]
    v_mul_f32 v167, v142, v167
    v_cvt_pk_f16_f32 v140, v166, v167
    v_mfma_f32_16x16x32_bf16 v[238:241], a[228:231], v[218:221], v[238:241]
    s_waitcnt lgkmcnt(0)
    v_mul_f32 v168, v142, v168
    v_mul_f32 v169, v142, v169
    v_mfma_f32_16x16x32_bf16 v[238:241], a[232:235], v[222:225], v[238:241]
    v_cvt_pk_f16_f32 v141, v168, v169
    v_mul_f32 v134, v142, v134
    v_mfma_f32_16x16x32_bf16 v[238:241], a[236:239], v[178:181], v[238:241]
    v_mul_f32 v135, v142, v135
    v_cvt_pk_f16_f32 v226, v134, v135
    v_mfma_f32_16x16x32_bf16 v[166:169], a[240:243], v[114:117], 0
    v_mul_f32 v136, v142, v136
    v_mul_f32 v137, v142, v137
    v_mfma_f32_16x16x32_bf16 v[166:169], a[244:247], v[126:129], v[166:169]
    v_cvt_pk_f16_f32 v227, v136, v137
    v_fma_f32 v185, v214, v214, s32
    v_mfma_f32_16x16x32_bf16 v[166:169], a[248:251], v[162:165], v[166:169]
    v_fma_f32 v120, v238, v238, s33
    v_fmac_f32 v120, v239, v239
    v_mfma_f32_16x16x32_bf16 v[166:169], a[252:255], v[218:221], v[166:169]
    v_fmac_f32 v120, v240, v240
    v_fmac_f32 v120, v241, v241
    v_mfma_f32_16x16x32_bf16 v[166:169], v[82:85], v[222:225], v[166:169]
    buffer_store_dwordx2 v[206:207], v18, s[48:51], 0 offen nt
    v_fmac_f32 v185, v215, v215
    v_fmac_f32 v185, v216, v216
    v_mfma_f32_16x16x32_bf16 v[166:169], v[86:89], v[178:181], v[166:169]
    v_fmac_f32 v185, v217, v217
    v_fmac_f32 v185, v230, v230
    v_mfma_f32_16x16x32_bf16 v[134:137], v[90:93], v[114:117], 0
    v_fmac_f32 v185, v231, v231
    v_fmac_f32 v185, v232, v232
    v_mfma_f32_16x16x32_bf16 v[134:137], v[94:97], v[126:129], v[134:137]
    v_fmac_f32 v185, v233, v233
    v_fmac_f32 v185, v130, v130
    v_mfma_f32_16x16x32_bf16 v[134:137], v[98:101], v[162:165], v[134:137]
    v_fmac_f32 v120, v166, v166
    v_fmac_f32 v120, v167, v167
    v_mfma_f32_16x16x32_bf16 v[134:137], v[102:105], v[218:221], v[134:137]
    v_fmac_f32 v120, v168, v168
    v_fmac_f32 v120, v169, v169
    v_mfma_f32_16x16x32_bf16 v[134:137], v[106:109], v[222:225], v[134:137]
    v_fmac_f32 v185, v131, v131
    v_fmac_f32 v185, v132, v132
    v_mfma_f32_16x16x32_bf16 v[134:137], v[110:113], v[178:181], v[134:137]
    v_fmac_f32 v185, v133, v133
    v_mul_f32 v184, 0x3baaaaab, v184
    v_mfma_f32_16x16x32_bf16 v[170:173], a[4:7], v[190:193], v[170:173]
    v_rsq_f32 v184, v184
    v_mfma_f32_16x16x32_bf16 v[170:173], a[8:11], v[186:189], v[170:173]
    v_mul_f32 v242, v184, v242
    v_mul_f32 v243, v184, v243
    v_mfma_f32_16x16x32_bf16 v[170:173], a[12:15], v[194:197], v[170:173]
    v_fmac_f32 v120, v134, v134
    v_fmac_f32 v120, v135, v135
    v_mfma_f32_16x16x32_bf16 v[170:173], a[16:19], v[122:125], v[170:173]
    v_fmac_f32 v120, v136, v136
    v_fmac_f32 v120, v137, v137
    v_mfma_f32_16x16x32_bf16 v[170:173], a[20:23], v[202:205], v[170:173]
    v_cvt_pk_bf16_f32 v148, v255, v120
    v_cvt_pk_bf16_f32 v149, v120, v120
    v_mfma_f32_16x16x32_bf16 v[114:117], a[24:27], v[174:177], 0
    v_cvt_pk_bf16_f32 v126, v242, v243
    v_mul_f32 v244, v184, v244
    v_mfma_f32_16x16x32_bf16 v[114:117], a[28:31], v[190:193], v[114:117]
    v_mul_f32 v245, v184, v245
    v_cvt_pk_bf16_f32 v127, v244, v245
    v_mfma_f32_16x16x32_bf16 v[114:117], a[32:35], v[186:189], v[114:117]
    v_fma_f32 v255, v170, v170, s32
    v_fmac_f32 v255, v171, v171
    v_mfma_f32_16x16x32_bf16 v[114:117], a[36:39], v[194:197], v[114:117]
    v_fmac_f32 v255, v172, v172
    v_fmac_f32 v255, v173, v173
    v_mfma_f32_16x16x32_bf16 v[114:117], a[40:43], v[122:125], v[114:117]
    v_mul_f32 v158, v184, v158
    v_mul_f32 v159, v184, v159
    v_mfma_f32_16x16x32_bf16 v[114:117], a[44:47], v[202:205], v[114:117]
    v_cvt_pk_bf16_f32 v128, v158, v159
    v_mul_f32 v160, v184, v160
    v_mfma_f32_16x16x32_bf16 v[142:145], a[48:51], v[174:177], 0
    v_mul_f32 v161, v184, v161
    v_cvt_pk_bf16_f32 v129, v160, v161
    v_mfma_f32_16x16x32_bf16 v[142:145], a[52:55], v[190:193], v[142:145]
    buffer_store_dwordx4 v[126:129], v17, s[48:51], 0 offen nt
    v_mul_f32 v154, v184, v154
    v_fmac_f32 v255, v114, v114
    v_fmac_f32 v255, v115, v115
    v_fmac_f32 v255, v116, v116
    v_mfma_f32_16x16x32_bf16 v[142:145], a[56:59], v[186:189], v[142:145]
    v_fmac_f32 v255, v117, v117
    v_mul_f32 v155, v184, v155
    v_mfma_f32_16x16x32_bf16 v[142:145], a[60:63], v[194:197], v[142:145]
    v_cvt_pk_bf16_f32 v120, v154, v155
    v_mul_f32 v156, v184, v156
    v_mfma_f32_16x16x32_bf16 v[142:145], a[64:67], v[122:125], v[142:145]
    v_mul_f32 v157, v184, v157
    v_cvt_pk_bf16_f32 v121, v156, v157
    v_mfma_f32_16x16x32_bf16 v[142:145], a[68:71], v[202:205], v[142:145]
    v_lshrrev_b32 v126, 4, v254
    v_and_b32 v127, 15, v254
    v_mfma_f32_16x16x32_bf16 v[154:157], v[174:177], a[144:147], 0
    v_lshlrev_b32 v128, 9, v126
    v_lshl_add_u32 v128, v127, 4, v128
    v_mfma_f32_16x16x32_bf16 v[154:157], v[190:193], a[148:151], v[154:157]
    v_add_u32 v128, 149696, v128
    v_and_b32 v129, 0xffff, v2
    v_mfma_f32_16x16x32_bf16 v[154:157], v[186:189], a[152:155], v[154:157]
    v_fmac_f32 v255, v142, v142
    v_fmac_f32 v255, v143, v143
    v_mfma_f32_16x16x32_bf16 v[154:157], v[194:197], a[156:159], v[154:157]
    v_fmac_f32 v255, v144, v144
    v_fmac_f32 v255, v145, v145
    v_mfma_f32_16x16x32_bf16 v[154:157], v[122:125], a[160:163], v[154:157]
    v_cvt_pk_bf16_f32 v36, v255, v185
    v_add_u32 v129, 38912, v129
    v_mfma_f32_16x16x32_bf16 v[154:157], v[202:205], a[164:167], v[154:157]
    v_and_b32 v255, 0xffff, v4
    v_add_u32 v255, 38912, v255
    v_mfma_f32_16x16x32_bf16 v[158:161], v[32:35], v[36:39], 0
    ds_write_b64 v255, v[148:149] offset:0
    v_mfma_f32_16x16x32_bf16 v[162:165], v[174:177], a[168:171], 0
    v_mov_b32 v178, 0x40000000
    v_add_u32 v179, 0, v127
    v_mfma_f32_16x16x32_bf16 v[162:165], v[190:193], a[172:175], v[162:165]
    v_cvt_pk_bf16_f32 v148, v154, v155
    v_cvt_pk_bf16_f32 v149, v156, v157
    v_mfma_f32_16x16x32_bf16 v[162:165], v[186:189], a[176:179], v[162:165]
    v_rsq_f32 v159, v159
    v_mfma_f32_16x16x32_bf16 v[162:165], v[194:197], a[180:183], v[162:165]
    buffer_store_dwordx2 v[120:121], v20, s[48:51], 0 offen nt
    v_rsq_f32 v158, v158
    v_mfma_f32_16x16x32_bf16 v[162:165], v[122:125], a[184:187], v[162:165]
    ds_read_b128 v[154:157], v0 offset:32768
    v_mul_f32 v158, s31, v158
    v_mfma_f32_16x16x32_bf16 v[162:165], v[202:205], a[188:191], v[162:165]
    ds_read_b128 v[206:209], v1 offset:32768
    v_mul_f32 v214, v159, v214
    v_mfma_f32_16x16x32_bf16 v[218:221], v[174:177], a[192:195], 0
    s_waitcnt lgkmcnt(2)
    ds_read_b128 v[174:177], v0 offset:32896
    v_mul_f32 v215, v159, v215
    v_mfma_f32_16x16x32_bf16 v[218:221], v[190:193], a[196:199], v[218:221]
    s_barrier
    ds_read_b128 v[190:193], v129 offset:0
    ds_read_b128 v[222:225], v129 offset:1024
    v_mfma_f32_16x16x32_bf16 v[218:221], v[186:189], a[200:203], v[218:221]
    ds_read_b128 v[186:189], v1 offset:32896
    v_cvt_pk_bf16_f32 v120, v162, v163
    v_mfma_f32_16x16x32_bf16 v[218:221], v[194:197], a[204:207], v[218:221]
    ds_read_b128 v[194:197], v0 offset:33024
    v_cvt_pk_bf16_f32 v121, v164, v165
    v_mfma_f32_16x16x32_bf16 v[218:221], v[122:125], a[208:211], v[218:221]
    ds_read_b128 v[122:125], v1 offset:33024
    v_cvt_pk_f16_f32 v162, v214, v215
    v_mfma_f32_16x16x32_bf16 v[218:221], v[202:205], a[212:215], v[218:221]
    v_mul_f32 v216, v159, v216
    v_mul_f32 v217, v159, v217
    v_mfma_f32_16x16x32_f16 v[202:205], v[150:153], v[138:141], v[46:49]
    s_waitcnt lgkmcnt(7)
    v_cvt_pk_f16_f32 v163, v216, v217
    v_mul_f32 v230, v159, v230
    v_mfma_f32_16x16x32_bf16 v[214:217], a[72:75], v[154:157], 0
    s_waitcnt lgkmcnt(6)
    v_cvt_pk_bf16_f32 v184, v218, v219
    v_cvt_pk_bf16_f32 v185, v220, v221
    v_mfma_f32_16x16x32_bf16 v[214:217], a[76:79], v[206:209], v[214:217]
    s_waitcnt lgkmcnt(5)
    v_mul_f32 v231, v159, v231
    v_cvt_pk_f16_f32 v164, v230, v231
    v_mfma_f32_16x16x32_bf16 v[214:217], a[80:83], v[174:177], v[214:217]
    s_waitcnt lgkmcnt(3)
    v_mul_f32 v232, v159, v232
    v_mul_f32 v233, v159, v233
    v_mfma_f32_16x16x32_bf16 v[218:221], v[32:35], v[190:193], 0
    s_waitcnt lgkmcnt(2)
    v_cvt_pk_f16_f32 v165, v232, v233
    v_mul_f32 v130, v159, v130
    v_mfma_f32_16x16x32_bf16 v[218:221], v[32:35], v[222:225], v[218:221]
    s_waitcnt lgkmcnt(1)
    v_mul_f32 v131, v159, v131
    v_cvt_pk_f16_f32 v192, v130, v131
    v_mfma_f32_16x16x32_bf16 v[214:217], a[84:87], v[186:189], v[214:217]
    s_waitcnt lgkmcnt(0)
    v_mul_f32 v132, v159, v132
    v_mul_f32 v133, v159, v133
    v_mfma_f32_16x16x32_bf16 v[214:217], a[88:91], v[194:197], v[214:217]
    v_mul_f32 v180, 0x3baaaaab, v219
    v_cvt_pk_f16_f32 v193, v132, v133
    v_mfma_f32_16x16x32_bf16 v[214:217], a[92:95], v[122:125], v[214:217]
    v_rsq_f32 v180, v180
    v_mfma_f32_16x16x32_bf16 v[130:133], a[96:99], v[154:157], 0
    v_mul_f32 v238, v180, v238
    v_mul_f32 v239, v180, v239
    v_mfma_f32_16x16x32_bf16 v[130:133], a[100:103], v[206:209], v[130:133]
    v_cvt_pk_bf16_f32 v222, v238, v239
    v_mul_f32 v240, v180, v240
    v_mfma_f32_16x16x32_bf16 v[130:133], a[104:107], v[174:177], v[130:133]
    v_mul_f32 v241, v180, v241
    v_cvt_pk_bf16_f32 v223, v240, v241
    v_mfma_f32_16x16x32_bf16 v[130:133], a[108:111], v[186:189], v[130:133]
    v_mul_f32 v166, v180, v166
    v_mul_f32 v167, v180, v167
    v_mfma_f32_16x16x32_bf16 v[130:133], a[112:115], v[194:197], v[130:133]
    v_cvt_pk_bf16_f32 v224, v166, v167
    v_mul_f32 v168, v180, v168
    v_mfma_f32_16x16x32_bf16 v[130:133], a[116:119], v[122:125], v[130:133]
    v_mul_f32 v169, v180, v169
    v_cvt_pk_bf16_f32 v225, v168, v169
    v_mfma_f32_16x16x32_bf16 v[166:169], a[120:123], v[154:157], 0
    buffer_store_dwordx4 v[222:225], v16, s[52:55], 0 offen nt
    v_mul_f32 v134, v180, v134
    v_mul_f32 v135, v180, v135
    v_cvt_pk_bf16_f32 v220, v134, v135
    v_mul_f32 v136, v180, v136
    v_mfma_f32_16x16x32_bf16 v[166:169], a[124:127], v[206:209], v[166:169]
    v_mul_f32 v137, v180, v137
    v_cvt_pk_bf16_f32 v221, v136, v137
    v_mfma_f32_16x16x32_bf16 v[166:169], a[128:131], v[174:177], v[166:169]
    v_mul_f32 v170, v158, v170
    v_mul_f32 v171, v158, v171
    v_mfma_f32_16x16x32_bf16 v[166:169], a[132:135], v[186:189], v[166:169]
    v_cvt_pk_f16_f32 v134, v170, v171
    v_mul_f32 v172, v158, v172
    v_mfma_f32_16x16x32_bf16 v[166:169], a[136:139], v[194:197], v[166:169]
    v_mul_f32 v173, v158, v173
    v_cvt_pk_f16_f32 v135, v172, v173
    v_mfma_f32_16x16x32_bf16 v[166:169], a[140:143], v[122:125], v[166:169]
    v_mul_f32 v114, v158, v114
    v_mul_f32 v115, v158, v115
    v_mfma_f32_16x16x32_bf16 v[170:173], a[0:3], v[154:157], 0
    v_cvt_pk_f16_f32 v136, v114, v115
    v_mul_f32 v116, v158, v116
    v_mfma_f32_16x16x32_bf16 v[170:173], a[4:7], v[206:209], v[170:173]
    v_mul_f32 v117, v158, v117
    v_cvt_pk_f16_f32 v137, v116, v117
    v_mfma_f32_16x16x32_bf16 v[170:173], a[8:11], v[174:177], v[170:173]
    v_mul_f32 v142, v158, v142
    v_mul_f32 v143, v158, v143
    v_mfma_f32_16x16x32_bf16 v[170:173], a[12:15], v[186:189], v[170:173]
    v_cvt_pk_f16_f32 v190, v142, v143
    v_mul_f32 v144, v158, v144
    v_mfma_f32_16x16x32_bf16 v[170:173], a[16:19], v[194:197], v[170:173]
    v_mul_f32 v145, v158, v145
    v_cvt_pk_f16_f32 v191, v144, v145
    v_mfma_f32_16x16x32_bf16 v[170:173], a[20:23], v[122:125], v[170:173]
    v_mul_f32 v180, 0x3baaaaab, v218
    v_fma_f32 v181, v214, v214, s32
    v_mfma_f32_16x16x32_bf16 v[114:117], a[24:27], v[154:157], 0
    v_rsq_f32 v180, v180
    v_mfma_f32_16x16x32_f16 v[142:145], v[162:165], v[138:141], v[50:53]
    v_mul_f32 v198, v180, v198
    v_mul_f32 v199, v180, v199
    v_cvt_pk_bf16_f32 v158, v198, v199
    v_mfma_f32_16x16x16_f16 v[202:205], v[228:229], v[226:227], v[202:205]
    v_mul_f32 v200, v180, v200
    v_mul_f32 v201, v180, v201
    v_cvt_pk_bf16_f32 v159, v200, v201
    v_mfma_f32_16x16x16_f16 v[142:145], v[192:193], v[226:227], v[142:145]
    v_mul_f32 v234, v180, v234
    v_mul_f32 v235, v180, v235
    v_cvt_pk_bf16_f32 v160, v234, v235
    v_mul_f32 v236, v180, v236
    v_mfma_f32_16x16x32_bf16 v[114:117], a[28:31], v[206:209], v[114:117]
    buffer_store_dwordx2 v[220:221], v19, s[52:55], 0 offen nt
    v_mul_f32 v237, v180, v237
    v_cvt_pk_bf16_f32 v161, v236, v237
    v_mfma_f32_16x16x32_bf16 v[114:117], a[32:35], v[174:177], v[114:117]
    v_mul_f32 v210, v180, v210
    v_mul_f32 v211, v180, v211
    v_mfma_f32_16x16x32_bf16 v[114:117], a[36:39], v[186:189], v[114:117]
    v_cvt_pk_bf16_f32 v210, v210, v211
    v_mul_f32 v212, v180, v212
    v_mfma_f32_16x16x32_bf16 v[114:117], a[40:43], v[194:197], v[114:117]
    v_mul_f32 v213, v180, v213
    v_cvt_pk_bf16_f32 v211, v212, v213
    v_mfma_f32_16x16x32_bf16 v[114:117], a[44:47], v[122:125], v[114:117]
    v_fma_f32 v180, v170, v170, s32
    v_fmac_f32 v180, v171, v171
    v_mfma_f32_16x16x32_bf16 v[198:201], a[48:51], v[154:157], 0
    v_fmac_f32 v180, v172, v172
    v_fmac_f32 v180, v173, v173
    v_mfma_f32_16x16x32_bf16 v[198:201], a[52:55], v[206:209], v[198:201]
    v_fmac_f32 v181, v215, v215
    v_fmac_f32 v181, v216, v216
    v_mfma_f32_16x16x32_bf16 v[198:201], a[56:59], v[174:177], v[198:201]
    v_fmac_f32 v180, v114, v114
    v_fmac_f32 v180, v115, v115
    v_mfma_f32_16x16x32_bf16 v[198:201], a[60:63], v[186:189], v[198:201]
    v_fmac_f32 v180, v116, v116
    v_fmac_f32 v180, v117, v117
    v_mfma_f32_16x16x32_bf16 v[198:201], a[64:67], v[194:197], v[198:201]
    v_fmac_f32 v181, v217, v217
    v_fmac_f32 v181, v130, v130
    v_mfma_f32_16x16x32_bf16 v[198:201], a[68:71], v[122:125], v[198:201]
    ds_read2_b32 v[220:221], v6 offset0:0 offset1:0
    ds_read2_b32 v[224:225], v6 offset0:16 offset1:16
    v_mfma_f32_16x16x32_bf16 v[230:233], v[154:157], a[144:147], 0
    ds_read2_b32 v[212:213], v6 offset0:32 offset1:32
    v_fmac_f32 v181, v131, v131
    v_mfma_f32_16x16x32_bf16 v[230:233], v[206:209], a[148:151], v[230:233]
    v_fmac_f32 v181, v132, v132
    v_fmac_f32 v181, v133, v133
    v_mfma_f32_16x16x32_bf16 v[230:233], v[174:177], a[152:155], v[230:233]
    v_fmac_f32 v180, v198, v198
    v_fmac_f32 v180, v199, v199
    v_mfma_f32_16x16x32_bf16 v[230:233], v[186:189], a[156:159], v[230:233]
    v_fmac_f32 v180, v200, v200
    v_fmac_f32 v180, v201, v201
    v_mfma_f32_16x16x32_bf16 v[230:233], v[194:197], a[160:163], v[230:233]
    v_fmac_f32 v181, v166, v166
    v_fmac_f32 v181, v167, v167
    v_mfma_f32_16x16x32_bf16 v[230:233], v[122:125], a[164:167], v[230:233]
    buffer_store_dwordx4 v[158:161], v15, s[52:55], 0 offen nt
    v_fmac_f32 v181, v168, v168
    v_fmac_f32 v181, v169, v169
    v_cvt_pk_bf16_f32 v36, v180, v181
    v_mul_u32_u24 v222, s20, v179
    v_mfma_f32_16x16x32_bf16 v[158:161], v[154:157], a[168:171], 0
    s_waitcnt lgkmcnt(1)
    v_add_u32 v222, s38, v222
    v_cvt_pk_bf16_f32 v218, v230, v231
    v_mfma_f32_16x16x32_bf16 v[234:237], v[32:35], v[36:39], 0
    s_waitcnt lgkmcnt(0)
    v_cvt_pk_bf16_f32 v219, v232, v233
    v_mul_u32_u24 v180, 911, v222
    v_mfma_f32_16x16x32_bf16 v[158:161], v[206:209], a[172:175], v[158:161]
    v_lshrrev_b32 v180, 16, v180
    v_mul_u32_u24 v180, s22, v180
    v_mfma_f32_16x16x32_bf16 v[158:161], v[174:177], a[176:179], v[158:161]
    v_mad_u32_u24 v180, v179, s21, v180
    v_bfe_u32 v222, s70, v179, 1
    v_mfma_f32_16x16x32_bf16 v[158:161], v[186:189], a[180:183], v[158:161]
    ds_read_b128 v[230:233], v2 offset:12288
    v_cmp_ne_u32 vcc, 0, v222
    v_mfma_f32_16x16x32_bf16 v[158:161], v[194:197], a[184:187], v[158:161]
    v_rsq_f32 v235, v235
    v_mfma_f32_16x16x32_bf16 v[158:161], v[122:125], a[188:191], v[158:161]
    v_rsq_f32 v234, v234
    v_mul_f32 v214, v235, v214
    v_mul_f32 v234, s31, v234
    v_mul_f32 v215, v235, v215
    v_cvt_pk_f16_f32 v214, v214, v215
    v_mfma_f32_16x16x32_bf16 v[238:241], v[154:157], a[192:195], 0
    ds_read_b128 v[154:157], v2 offset:13312
    ds_read_b32 v179, v6 offset:192
    v_mfma_f32_16x16x32_bf16 v[238:241], v[206:209], a[196:199], v[238:241]
    v_cvt_pk_bf16_f32 v222, v158, v159
    v_cvt_pk_bf16_f32 v223, v160, v161
    v_mfma_f32_16x16x32_bf16 v[238:241], v[174:177], a[200:203], v[238:241]
    ds_read_b128 v[158:161], v2 offset:14336
    ds_read_b128 v[174:177], v2 offset:15360
    v_mfma_f32_16x16x32_bf16 v[238:241], v[186:189], a[204:207], v[238:241]
    ds_read_b128 v[186:189], v2 offset:16384
    v_mul_f32 v216, v235, v216
    v_mfma_f32_16x16x32_bf16 v[238:241], v[194:197], a[208:211], v[238:241]
    s_waitcnt lgkmcnt(5)
    ds_read_b128 v[194:197], v2 offset:17408
    v_mul_f32 v217, v235, v217
    v_mfma_f32_16x16x32_bf16 v[238:241], v[122:125], a[212:215], v[238:241]
    ds_read_b128 v[122:125], v5 offset:0
    v_cvt_pk_f16_f32 v215, v216, v217
    v_mul_f32 v130, v235, v130
    buffer_store_dwordx2 v[210:211], v18, s[52:55], 0 offen nt
    ds_read_b128 v[206:209], v5 offset:16
    v_mul_f32 v131, v235, v131
    v_cvt_pk_f16_f32 v216, v130, v131
    v_mul_f32 v132, v235, v132
    v_cvt_pk_bf16_f32 v210, v238, v239
    v_cvt_pk_bf16_f32 v211, v240, v241
    v_mul_f32 v133, v235, v133
    v_cvt_pk_f16_f32 v217, v132, v133
    v_mfma_f32_16x16x32_bf16 v[130:133], a[216:219], v[230:233], 0
    s_waitcnt lgkmcnt(6)
    v_mul_f32 v166, v235, v166
    v_mul_f32 v167, v235, v167
    v_mfma_f32_16x16x32_bf16 v[130:133], a[220:223], v[154:157], v[130:133]
    s_waitcnt lgkmcnt(4)
    v_cvt_pk_f16_f32 v240, v166, v167
    v_mul_f32 v168, v235, v168
    v_mfma_f32_16x16x32_bf16 v[130:133], a[224:227], v[158:161], v[130:133]
    s_waitcnt lgkmcnt(3)
    v_mul_f32 v169, v235, v169
    v_cvt_pk_f16_f32 v241, v168, v169
    v_mfma_f32_16x16x32_bf16 v[130:133], a[228:231], v[174:177], v[130:133]
    s_waitcnt lgkmcnt(2)
    v_mul_f32 v170, v234, v170
    v_mul_f32 v171, v234, v171
    v_mfma_f32_16x16x32_bf16 v[130:133], a[232:235], v[186:189], v[130:133]
    s_waitcnt lgkmcnt(1)
    v_cvt_pk_f16_f32 v166, v170, v171
    v_mul_f32 v172, v234, v172
    v_mfma_f32_16x16x32_f16 v[242:245], v[122:125], v[134:137], v[24:27]
    s_waitcnt lgkmcnt(0)
    v_mul_f32 v173, v234, v173
    v_cvt_pk_f16_f32 v167, v172, v173
    v_mfma_f32_16x16x32_f16 v[242:245], v[206:209], v[162:165], v[242:245]
    v_mul_f32 v114, v234, v114
    v_mul_f32 v115, v234, v115
    v_mfma_f32_16x16x32_bf16 v[130:133], a[236:239], v[194:197], v[130:133]
    v_cvt_pk_f16_f32 v168, v114, v115
    v_mul_f32 v116, v234, v116
    v_mul_f32 v117, v234, v117
    v_cvt_pk_f16_f32 v169, v116, v117
    v_mul_f32 v198, v234, v198
    v_mul_f32 v199, v234, v199
    v_cvt_pk_f16_f32 v238, v198, v199
    v_mfma_f32_16x16x32_f16 v[114:117], v[122:125], v[166:169], v[26:29]
    v_mul_f32 v200, v234, v200
    v_mul_f32 v201, v234, v201
    v_mfma_f32_16x16x32_f16 v[114:117], v[206:209], v[214:217], v[114:117]
    v_cvt_pk_f16_f32 v239, v200, v201
    v_add_u32 v180, s7, v180
    v_cndmask_b32 v180, v178, v180, vcc
    v_lshl_add_u32 v181, v126, 4, v180
    v_add_u32 v181, s3, v181
    v_lshl_add_u32 v180, v126, 3, v180
    v_add_u32 v180, s4, v180
    v_sub_u32 v170, 0x40800000, v44
    v_or_b32 v170, v170, v44
    v_fma_f32 v171, v130, v130, s33
    v_fmac_f32 v171, v131, v131
    v_fmac_f32 v171, v132, v132
    v_fmac_f32 v171, v133, v133
    v_xor_b32 v172, 65536, v2
    v_lshl_add_u32 v173, s16, 2, v172
    ds_write_b32 v173, v170 offset:18432
    v_bfe_u32 v170, v127, 1, 2
    v_xor_b32 v170, v170, v126
    v_lshl_add_u32 v170, v127, 2, v170
    v_lshl_add_u32 v173, v170, 4, s5
    v_lshl_add_u32 v198, v170, 3, s5
    v_lshl_add_u32 v199, v254, 4, s5
    v_lshl_add_u32 v254, v254, 3, s5
    v_lshlrev_b32 v170, 2, v170
    ds_permute_b32 v200, v170, v16
    ds_permute_b32 v201, v170, v19
    ds_permute_b32 v234, v170, v17
    ds_permute_b32 v235, v170, v20
    v_add_u32 v127, 16, v127
    v_min_u32 v170, 20, v127
    v_add_u32 v236, 12, v127
    v_lshrrev_b32 v236, 5, v236
    v_sub_u32 v237, v127, v170
    v_mad_i32_i24 v237, v236, s6, v237
    v_mul_u32_u24 v246, s20, v170
    v_add3_u32 v246, v246, v237, s38
    v_mul_u32_u24 v236, 911, v246
    v_lshrrev_b32 v236, 16, v236
    v_mul_u32_u24 v236, s22, v236
    v_mad_u32_u24 v236, v170, s21, v236
    v_bfe_u32 v246, s70, v127, 1
    v_cmp_ne_u32 vcc, 0, v246
    v_mul_i32_i24 v237, 2688, v237
    v_add3_u32 v127, v236, v237, s7
    v_cndmask_b32 v127, v178, v127, vcc
    v_lshl_add_u32 v170, v126, 4, v127
    v_add_u32 v170, s3, v170
    v_lshl_add_u32 v236, v126, 3, v127
    v_add_u32 v236, s4, v236
    ds_read_b128 v[246:249], v5 offset:48
    s_waitcnt lgkmcnt(0)
    v_mfma_f32_16x16x32_f16 v[114:117], v[246:249], v[238:241], v[114:117]
    v_mfma_f32_16x16x32_f16 v[242:245], v[246:249], v[190:193], v[242:245]
    v_mfma_f32_16x16x32_f16 v[250:253], v[122:125], v[138:141], v[22:25]
    v_mfma_f32_16x16x32_f16 v[250:253], v[206:209], v[150:153], v[250:253]
    v_mfma_f32_16x16x32_f16 v[250:253], v[246:249], v[226:229], v[250:253]
    s_nop 0
    s_nop 0
    s_nop 0
    s_nop 0
    s_nop 0
    s_nop 0
    s_nop 0
    s_nop 0
    v_max3_f32 v178, v250, v202, v203
    v_max3_f32 v178, v178, v204, v205
    v_max3_f32 v178, v178, v142, v143
    v_max3_f32 v178, v178, v144, v145
    v_mov_b32_dpp v179, v251 quad_perm:[0,1,2,3] row_mask:0x1 bank_mask:0xf
    s_nop 0
    s_nop 0
    v_mov_b32_dpp v179, v243 quad_perm:[0,1,2,3] row_mask:0x2 bank_mask:0xf
    v_mfma_f32_16x16x32_f16 v[122:125], v[214:217], v[138:141], v[54:57]
    v_mfma_f32_16x16x32_bf16 v[138:141], a[240:243], v[230:233], 0
    v_mov_b32_dpp v179, v115 quad_perm:[0,1,2,3] row_mask:0x4 bank_mask:0xf
    v_mov_b32 v237, v179
    v_mfma_f32_16x16x32_bf16 v[138:141], a[244:247], v[154:157], v[138:141]
    v_mfma_f32_16x16x32_bf16 v[138:141], a[248:251], v[158:161], v[138:141]
    v_max_f32_dpp v237, v237, v237 quad_perm:[1,0,3,2] row_mask:0xf bank_mask:0xf
    v_mfma_f32_16x16x16_f16 v[122:125], v[240:241], v[226:227], v[122:125]
    v_mfma_f32_16x16x32_bf16 v[138:141], a[252:255], v[174:177], v[138:141]
    v_max_f32_dpp v237, v237, v237 quad_perm:[2,3,0,1] row_mask:0xf bank_mask:0xf
    v_mfma_f32_16x16x32_bf16 v[138:141], v[82:85], v[186:189], v[138:141]
    v_mfma_f32_16x16x32_bf16 v[138:141], v[86:89], v[194:197], v[138:141]
    v_max_f32_dpp v237, v237, v237 row_half_mirror row_mask:0xf bank_mask:0xf
    s_nop 0
    s_nop 0
    v_max_f32_dpp v237, v237, v237 row_mirror row_mask:0xf bank_mask:0xf
    v_max3_f32 v178, v178, v122, v123
    v_max3_f32 v178, v178, v124, v125
    v_mov_b32 v126, v178
    v_mov_b32 v127, v237
    v_fmac_f32 v171, v138, v138
    v_permlane32_swap_b32 v178, v126
    v_max_f32 v178, v178, v126
    v_mov_b32 v126, v178
    v_fmac_f32 v171, v139, v139
    v_fmac_f32 v171, v140, v140
    v_permlane16_swap_b32 v178, v126
    v_max_f32 v178, v178, v126
    v_sub_f32 v202, v202, v178
    v_exp_f32 v202, v202
    v_sub_f32 v203, v203, v178
    v_exp_f32 v203, v203
    v_sub_f32 v204, v204, v178
    v_cvt_pk_bf16_f32 v202, v202, v203
    v_exp_f32 v204, v204
    v_sub_f32 v205, v205, v178
    v_exp_f32 v205, v205
    v_sub_f32 v142, v142, v178
    v_cvt_pk_bf16_f32 v203, v204, v205
    v_exp_f32 v142, v142
    v_sub_f32 v143, v143, v178
    v_exp_f32 v143, v143
    v_sub_f32 v144, v144, v178
    v_cvt_pk_bf16_f32 v204, v142, v143
    v_mfma_f32_16x16x32_bf16 v[206:209], v[90:93], v[230:233], 0
    ds_read_b128 v[230:233], v128 offset:0
    v_sub_f32 v145, v145, v178
    v_mfma_f32_16x16x32_bf16 v[206:209], v[94:97], v[154:157], v[206:209]
    ds_read_b128 v[154:157], v128 offset:2048
    v_sub_f32 v122, v122, v178
    v_mfma_f32_16x16x32_bf16 v[206:209], v[98:101], v[158:161], v[206:209]
    ds_read_b128 v[158:161], v128 offset:4096
    v_sub_f32 v123, v123, v178
    v_mfma_f32_16x16x32_bf16 v[206:209], v[102:105], v[174:177], v[206:209]
    ds_read_b128 v[174:177], v128 offset:6144
    v_sub_f32 v124, v124, v178
    v_mfma_f32_16x16x32_bf16 v[206:209], v[106:109], v[186:189], v[206:209]
    ds_read_b128 v[186:189], v128 offset:8192
    v_sub_f32 v125, v125, v178
    v_mfma_f32_16x16x32_bf16 v[206:209], v[110:113], v[194:197], v[206:209]
    ds_read_b128 v[194:197], v128 offset:10240
    v_exp_f32 v144, v144
    v_exp_f32 v145, v145
    v_exp_f32 v122, v122
    v_cvt_pk_bf16_f32 v205, v144, v145
    v_exp_f32 v123, v123
    v_exp_f32 v124, v124
    v_cvt_pk_bf16_f32 v36, v122, v123
    v_exp_f32 v125, v125
    v_sub_f32 v250, v250, v178
    v_mfma_f32_16x16x32_f16 v[142:145], v[150:153], v[134:137], v[58:61]
    v_cvt_pk_bf16_f32 v37, v124, v125
    v_exp_f32 v250, v250
    v_fmac_f32 v171, v141, v141
    v_cvt_pk_bf16_f32 v39, v250, 0
    v_fmac_f32 v171, v206, v206
    v_fmac_f32 v171, v207, v207
    v_mfma_f32_16x16x16_f16 v[142:145], v[228:229], v[190:191], v[142:145]
    v_fmac_f32 v171, v208, v208
    v_fmac_f32 v171, v209, v209
    v_permlane32_swap_b32 v237, v127
    v_max_f32 v237, v237, v127
    v_mfma_f32_16x16x32_bf16 v[122:125], v[28:31], v[36:39], 0
    s_waitcnt lgkmcnt(0)
    v_mov_b32 v127, v237
    v_mfma_f32_16x16x32_bf16 v[122:125], v[28:31], v[202:205], v[122:125]
    v_max3_f32 v178, v242, v142, v143
    v_permlane16_swap_b32 v237, v127
    v_max_f32 v237, v237, v127
    v_sub_f32 v179, v179, v237
    v_exp_f32 v179, v179
    v_max3_f32 v178, v178, v144, v145
    v_cvt_pk_bf16_f32 v179, v179, v179
    ds_write_b16 v8, v179
    v_mfma_f32_16x16x32_bf16 v[246:249], v[218:221], v[36:39], 0
    v_rcp_f32 v122, v122
    v_mfma_f32_16x16x32_bf16 v[246:249], v[146:149], v[202:205], v[246:249]
    s_nop 0
    s_nop 0
    s_nop 0
    s_nop 0
    s_nop 0
    s_nop 0
    s_nop 0
    s_nop 0
    v_mul_f32 v246, v122, v246
    v_mul_f32 v247, v122, v247
    v_cvt_pk_bf16_f32 v246, v246, v247
    v_mul_f32 v248, v122, v248
    v_mul_f32 v249, v122, v249
    v_cvt_pk_bf16_f32 v247, v248, v249
    v_mfma_f32_16x16x32_f16 v[250:253], v[162:165], v[134:137], v[62:65]
    s_nop 0
    s_nop 0
    s_nop 0
    s_nop 0
    s_nop 0
    s_nop 0
    v_mfma_f32_16x16x16_f16 v[250:253], v[192:193], v[190:191], v[250:253]
    s_nop 0
    s_nop 0
    s_nop 0
    s_nop 0
    s_nop 0
    s_nop 0
    s_nop 0
    s_nop 0
    v_max3_f32 v178, v178, v250, v251
    v_max3_f32 v178, v178, v252, v253
    v_mfma_f32_16x16x32_f16 v[124:127], v[214:217], v[134:137], v[66:69]
    s_nop 0
    s_nop 0
    s_nop 0
    s_nop 0
    s_nop 0
    s_nop 0
    v_mfma_f32_16x16x16_f16 v[124:127], v[240:241], v[190:191], v[124:127]
    s_nop 0
    s_nop 0
    s_nop 0
    s_nop 0
    s_nop 0
    s_nop 0
    s_nop 0
    s_nop 0
    v_max3_f32 v178, v178, v124, v125
    v_max3_f32 v178, v178, v126, v127
    v_mov_b32 v123, v178
    s_nop 0
    s_nop 0
    v_permlane32_swap_b32 v178, v123
    v_max_f32 v178, v178, v123
    v_mov_b32 v123, v178
    s_nop 0
    s_nop 0
    v_permlane16_swap_b32 v178, v123
    v_max_f32 v178, v178, v123
    v_sub_f32 v142, v142, v178
    v_exp_f32 v142, v142
    v_sub_f32 v143, v143, v178
    v_exp_f32 v143, v143
    v_sub_f32 v144, v144, v178
    v_cvt_pk_bf16_f32 v134, v142, v143
    v_exp_f32 v144, v144
    v_sub_f32 v145, v145, v178
    v_exp_f32 v145, v145
    v_sub_f32 v250, v250, v178
    v_cvt_pk_bf16_f32 v135, v144, v145
    v_exp_f32 v250, v250
    v_sub_f32 v251, v251, v178
    v_exp_f32 v251, v251
    v_sub_f32 v252, v252, v178
    v_cvt_pk_bf16_f32 v136, v250, v251
    v_exp_f32 v252, v252
    v_sub_f32 v253, v253, v178
    v_exp_f32 v253, v253
    v_sub_f32 v124, v124, v178
    v_cvt_pk_bf16_f32 v137, v252, v253
    v_mfma_f32_16x16x32_bf16 v[142:145], v[222:225], v[36:39], 0
    v_exp_f32 v124, v124
    v_mfma_f32_16x16x32_bf16 v[142:145], v[118:121], v[202:205], v[142:145]
    v_sub_f32 v125, v125, v178
    v_exp_f32 v125, v125
    v_sub_f32 v126, v126, v178
    v_exp_f32 v126, v126
    v_sub_f32 v127, v127, v178
    v_exp_f32 v127, v127
    v_sub_f32 v242, v242, v178
    v_exp_f32 v242, v242
    v_mul_f32 v142, v122, v142
    v_mul_f32 v143, v122, v143
    v_cvt_pk_bf16_f32 v248, v142, v143
    v_mul_f32 v144, v122, v144
    v_mul_f32 v145, v122, v145
    v_cvt_pk_bf16_f32 v249, v144, v145
    ds_write_b128 v3, v[246:249] offset:0
    v_mfma_f32_16x16x32_bf16 v[142:145], v[210:213], v[36:39], 0
    v_cvt_pk_bf16_f32 v36, v124, v125
    v_cvt_pk_bf16_f32 v37, v126, v127
    v_mfma_f32_16x16x32_bf16 v[142:145], v[182:185], v[202:205], v[142:145]
    v_cvt_pk_bf16_f32 v39, v242, 0
    v_mfma_f32_16x16x32_f16 v[202:205], v[150:153], v[166:169], v[70:73]
    ds_read_b128 v[150:153], v9
    ds_read_b128 v[242:245], v9 offset:64
    v_mfma_f32_16x16x32_f16 v[246:249], v[162:165], v[166:169], v[74:77]
    v_mfma_f32_16x16x32_f16 v[162:165], v[214:217], v[166:169], v[78:81]
    v_mfma_f32_16x16x32_bf16 v[166:169], v[28:31], v[36:39], 0
    v_mfma_f32_16x16x32_bf16 v[166:169], v[28:31], v[134:137], v[166:169]
    v_mul_f32 v142, v122, v142
    v_mul_f32 v143, v122, v143
    v_cvt_pk_bf16_f32 v126, v142, v143
    v_mfma_f32_16x16x16_f16 v[202:205], v[228:229], v[238:239], v[202:205]
    v_mul_f32 v144, v122, v144
    v_mul_f32 v145, v122, v145
    v_cvt_pk_bf16_f32 v127, v144, v145
    v_mfma_f32_16x16x16_f16 v[246:249], v[192:193], v[238:239], v[246:249]
    v_rcp_f32 v166, v166
    v_mfma_f32_16x16x16_f16 v[162:165], v[240:241], v[238:239], v[162:165]
    ds_write_b64 v4, v[126:127] offset:4096
    v_mfma_f32_16x16x32_bf16 v[122:125], v[218:221], v[36:39], 0
    s_waitcnt lgkmcnt(1)
    v_max3_f32 v237, v114, v202, v203
    v_max3_f32 v237, v237, v204, v205
    v_mfma_f32_16x16x32_bf16 v[122:125], v[146:149], v[134:137], v[122:125]
    v_max3_f32 v237, v237, v246, v247
    v_max3_f32 v237, v237, v248, v249
    v_mfma_f32_16x16x32_bf16 v[142:145], v[222:225], v[36:39], 0
    v_max3_f32 v237, v237, v162, v163
    v_max3_f32 v237, v237, v164, v165
    v_mfma_f32_16x16x32_bf16 v[142:145], v[118:121], v[134:137], v[142:145]
    v_mov_b32 v126, v237
    v_mfma_f32_16x16x32_bf16 v[190:193], v[210:213], v[36:39], 0
    v_mul_f32 v122, v166, v122
    v_mul_f32 v123, v166, v123
    v_mfma_f32_16x16x32_bf16 v[190:193], v[182:185], v[134:137], v[190:193]
    v_cvt_pk_bf16_f32 v122, v122, v123
    v_mul_f32 v124, v166, v124
    v_mfma_f32_16x16x32_bf16 v[134:137], a[216:219], v[230:233], 0
    v_mul_f32 v125, v166, v125
    v_cvt_pk_bf16_f32 v123, v124, v125
    v_mfma_f32_16x16x32_bf16 v[134:137], a[220:223], v[154:157], v[134:137]
    v_mul_f32 v142, v166, v142
    v_mul_f32 v143, v166, v143
    v_mfma_f32_16x16x32_bf16 v[134:137], a[224:227], v[158:161], v[134:137]
    v_cvt_pk_bf16_f32 v124, v142, v143
    v_mul_f32 v144, v166, v144
    v_mfma_f32_16x16x32_bf16 v[134:137], a[228:231], v[174:177], v[134:137]
    v_mul_f32 v145, v166, v145
    v_cvt_pk_bf16_f32 v125, v144, v145
    v_mfma_f32_16x16x32_bf16 v[134:137], a[232:235], v[186:189], v[134:137]
    ds_write_b128 v3, v[122:125] offset:6144
    v_mfma_f32_16x16x32_bf16 v[134:137], a[236:239], v[194:197], v[134:137]
    v_mul_f32 v190, v166, v190
    v_mul_f32 v191, v166, v191
    v_mfma_f32_16x16x32_bf16 v[122:125], a[240:243], v[230:233], 0
    v_cvt_pk_bf16_f32 v178, v190, v191
    v_mul_f32 v192, v166, v192
    v_mfma_f32_16x16x32_bf16 v[122:125], a[244:247], v[154:157], v[122:125]
    v_mul_f32 v193, v166, v193
    v_cvt_pk_bf16_f32 v179, v192, v193
    v_mfma_f32_16x16x32_bf16 v[122:125], a[248:251], v[158:161], v[122:125]
    ds_write_b64 v4, v[178:179] offset:10240
    v_mfma_f32_16x16x32_bf16 v[122:125], a[252:255], v[174:177], v[122:125]
    v_permlane32_swap_b32 v237, v126
    v_mfma_f32_16x16x32_bf16 v[122:125], v[82:85], v[186:189], v[122:125]
    v_fma_f32 v127, v134, v134, s33
    v_fmac_f32 v127, v135, v135
    v_mfma_f32_16x16x32_bf16 v[122:125], v[86:89], v[194:197], v[122:125]
    v_fmac_f32 v127, v136, v136
    v_fmac_f32 v127, v137, v137
    v_mfma_f32_16x16x32_bf16 v[142:145], v[90:93], v[230:233], 0
    v_max_f32 v237, v237, v126
    v_mov_b32 v126, v237
    v_mfma_f32_16x16x32_bf16 v[142:145], v[94:97], v[154:157], v[142:145]
    v_mfma_f32_16x16x32_bf16 v[142:145], v[98:101], v[158:161], v[142:145]
    v_permlane16_swap_b32 v237, v126
    v_mfma_f32_16x16x32_bf16 v[142:145], v[102:105], v[174:177], v[142:145]
    v_fmac_f32 v127, v122, v122
    v_fmac_f32 v127, v123, v123
    v_mfma_f32_16x16x32_bf16 v[142:145], v[106:109], v[186:189], v[142:145]
    v_fmac_f32 v127, v124, v124
    v_fmac_f32 v127, v125, v125
    v_mfma_f32_16x16x32_bf16 v[142:145], v[110:113], v[194:197], v[142:145]
    v_max_f32 v237, v237, v126
    v_sub_f32 v202, v202, v237
    v_mfma_f32_16x16x32_bf16 v[154:157], v[150:153], v[28:31], 0
    v_exp_f32 v202, v202
    v_mfma_f32_16x16x32_bf16 v[154:157], v[242:245], v[28:31], v[154:157]
    v_sub_f32 v203, v203, v237
    v_sub_f32 v204, v204, v237
    v_mfma_f32_16x16x32_bf16 v[158:161], v[150:153], v[146:149], 0
    v_fmac_f32 v127, v142, v142
    v_fmac_f32 v127, v143, v143
    v_mfma_f32_16x16x32_bf16 v[158:161], v[242:245], v[218:221], v[158:161]
    v_fmac_f32 v127, v144, v144
    v_fmac_f32 v127, v145, v145
    v_mfma_f32_16x16x32_bf16 v[166:169], v[150:153], v[118:121], 0
    v_cvt_pk_bf16_f32 v126, v171, v127
    v_cvt_pk_bf16_f32 v127, v127, v127
    v_mfma_f32_16x16x32_bf16 v[166:169], v[242:245], v[222:225], v[166:169]
    ds_write_b64 v255, v[126:127] offset:2048
    v_mfma_f32_16x16x32_bf16 v[174:177], v[150:153], v[182:185], 0
    v_rcp_f32 v154, v154
    v_mfma_f32_16x16x32_bf16 v[174:177], v[242:245], v[210:213], v[174:177]
    v_mul_f32 v158, v158, v154
    v_exp_f32 v203, v203
    v_exp_f32 v204, v204
    v_cvt_pk_bf16_f32 v150, v202, v203
    v_mul_f32_dpp v158, v166, v154 quad_perm:[0,1,2,3] row_mask:0x2 bank_mask:0xf
    v_sub_f32 v205, v205, v237
    v_exp_f32 v205, v205
    v_sub_f32 v246, v246, v237
    v_mul_f32_dpp v158, v174, v154 quad_perm:[0,1,2,3] row_mask:0x4 bank_mask:0xf
    v_cvt_pk_bf16_f32 v158, v158, v158
    ds_write_b16 v7, v158
    v_cvt_pk_bf16_f32 v151, v204, v205
    v_exp_f32 v246, v246
    s_waitcnt lgkmcnt(1)
    s_barrier
    ds_read_b128 v[154:157], v129 offset:2048
    ds_read_b128 v[158:161], v129 offset:3072
    ds_read_b128 v[166:169], v172 offset:0
    ds_read_b128 v[174:177], v172 offset:1024
    ds_read_b128 v[186:189], v172 offset:2048
    ds_read_b128 v[190:193], v172 offset:3072
    ds_read_b128 v[194:197], v172 offset:4096
    ds_read_b128 v[202:205], v172 offset:5120
    v_sub_f32 v247, v247, v237
    v_exp_f32 v247, v247
    v_sub_f32 v248, v248, v237
    v_cvt_pk_bf16_f32 v152, v246, v247
    v_exp_f32 v248, v248
    s_waitcnt lgkmcnt(6)
    v_mfma_f32_16x16x32_bf16 v[214:217], v[32:35], v[154:157], 0
    s_waitcnt lgkmcnt(5)
    v_sub_f32 v249, v249, v237
    v_sub_f32 v162, v162, v237
    v_mfma_f32_16x16x32_bf16 v[214:217], v[32:35], v[158:161], v[214:217]
    s_waitcnt lgkmcnt(4)
    v_exp_f32 v249, v249
    v_mfma_f32_16x16x32_bf16 v[154:157], a[216:219], v[166:169], 0
    s_waitcnt lgkmcnt(3)
    v_cvt_pk_bf16_f32 v153, v248, v249
    v_sub_f32 v163, v163, v237
    v_mfma_f32_16x16x32_bf16 v[154:157], a[220:223], v[174:177], v[154:157]
    s_waitcnt lgkmcnt(2)
    v_mul_f32 v171, 0x3baaaaab, v215
    v_mul_f32 v126, 0x3baaaaab, v214
    v_mfma_f32_16x16x32_bf16 v[154:157], a[224:227], v[186:189], v[154:157]
    s_waitcnt lgkmcnt(1)
    v_rsq_f32 v171, v171
    v_mfma_f32_16x16x32_bf16 v[154:157], a[228:231], v[190:193], v[154:157]
    s_waitcnt lgkmcnt(0)
    v_mul_f32 v134, v171, v134
    v_mul_f32 v135, v171, v135
    v_mfma_f32_16x16x32_bf16 v[154:157], a[232:235], v[194:197], v[154:157]
    v_cvt_pk_bf16_f32 v134, v134, v135
    v_mul_f32 v136, v171, v136
    v_mfma_f32_16x16x32_bf16 v[154:157], a[236:239], v[202:205], v[154:157]
    v_mul_f32 v137, v171, v137
    v_cvt_pk_bf16_f32 v135, v136, v137
    v_mfma_f32_16x16x32_bf16 v[158:161], a[240:243], v[166:169], 0
    v_mul_f32 v122, v171, v122
    v_mul_f32 v123, v171, v123
    v_mfma_f32_16x16x32_bf16 v[158:161], a[244:247], v[174:177], v[158:161]
    v_cvt_pk_bf16_f32 v136, v122, v123
    v_mul_f32 v124, v171, v124
    v_mfma_f32_16x16x32_bf16 v[158:161], a[248:251], v[186:189], v[158:161]
    v_mul_f32 v125, v171, v125
    v_cvt_pk_bf16_f32 v137, v124, v125
    v_mfma_f32_16x16x32_bf16 v[158:161], a[252:255], v[190:193], v[158:161]
    buffer_store_dwordx4 v[134:137], v181, s[12:15], 0 offen nt
    v_mul_f32 v142, v171, v142
    v_mul_f32 v143, v171, v143
    v_cvt_pk_bf16_f32 v116, v142, v143
    v_mul_f32 v144, v171, v144
    v_mfma_f32_16x16x32_bf16 v[158:161], v[82:85], v[194:197], v[158:161]
    v_mul_f32 v145, v171, v145
    v_cvt_pk_bf16_f32 v117, v144, v145
    v_mfma_f32_16x16x32_bf16 v[158:161], v[86:89], v[202:205], v[158:161]
    ds_read_b128 v[122:125], v172 offset:6144
    v_fma_f32 v171, v154, v154, s33
    v_mfma_f32_16x16x32_bf16 v[134:137], v[90:93], v[166:169], 0
    ds_read_b128 v[142:145], v172 offset:7168
    v_fmac_f32 v171, v155, v155
    v_mfma_f32_16x16x32_bf16 v[134:137], v[94:97], v[174:177], v[134:137]
    ds_read_b128 v[166:169], v172 offset:8192
    v_fmac_f32 v171, v156, v156
    v_mfma_f32_16x16x32_bf16 v[134:137], v[98:101], v[186:189], v[134:137]
    ds_read_b128 v[174:177], v172 offset:9216
    v_fmac_f32 v171, v157, v157
    v_mfma_f32_16x16x32_bf16 v[134:137], v[102:105], v[190:193], v[134:137]
    ds_read_b128 v[186:189], v172 offset:10240
    v_fmac_f32 v171, v158, v158
    v_mfma_f32_16x16x32_bf16 v[134:137], v[106:109], v[194:197], v[134:137]
    ds_read_b128 v[190:193], v172 offset:11264
    v_fmac_f32 v171, v159, v159
    v_mfma_f32_16x16x32_bf16 v[134:137], v[110:113], v[202:205], v[134:137]
    v_fmac_f32 v171, v160, v160
    v_fmac_f32 v171, v161, v161
    v_rsq_f32 v126, v126
    s_waitcnt lgkmcnt(5)
    v_mfma_f32_16x16x32_bf16 v[194:197], a[216:219], v[122:125], 0
    v_mul_f32 v130, v126, v130
    v_mul_f32 v131, v126, v131
    v_mfma_f32_16x16x32_bf16 v[202:205], a[240:243], v[122:125], 0
    s_waitcnt lgkmcnt(4)
    v_fmac_f32 v171, v134, v134
    v_fmac_f32 v171, v135, v135
    v_mfma_f32_16x16x32_bf16 v[194:197], a[220:223], v[142:145], v[194:197]
    s_waitcnt lgkmcnt(3)
    v_fmac_f32 v171, v136, v136
    v_fmac_f32 v171, v137, v137
    v_mfma_f32_16x16x32_bf16 v[194:197], a[224:227], v[166:169], v[194:197]
    s_waitcnt lgkmcnt(2)
    v_cvt_pk_bf16_f32 v130, v130, v131
    v_mul_f32 v132, v126, v132
    v_mfma_f32_16x16x32_bf16 v[194:197], a[228:231], v[174:177], v[194:197]
    s_waitcnt lgkmcnt(1)
    v_mul_f32 v133, v126, v133
    v_cvt_pk_bf16_f32 v131, v132, v133
    v_mfma_f32_16x16x32_bf16 v[194:197], a[232:235], v[186:189], v[194:197]
    s_waitcnt lgkmcnt(0)
    v_mul_f32 v138, v126, v138
    v_mul_f32 v139, v126, v139
    v_mfma_f32_16x16x32_bf16 v[194:197], a[236:239], v[190:193], v[194:197]
    buffer_store_dwordx2 v[116:117], v180, s[12:15], 0 offen nt
    v_cvt_pk_bf16_f32 v132, v138, v139
    v_mul_f32 v140, v126, v140
    v_mfma_f32_16x16x32_bf16 v[202:205], a[244:247], v[142:145], v[202:205]
    v_mul_f32 v141, v126, v141
    v_cvt_pk_bf16_f32 v133, v140, v141
    v_mfma_f32_16x16x32_bf16 v[202:205], a[248:251], v[166:169], v[202:205]
    v_mul_f32 v206, v126, v206
    v_fma_f32 v127, v194, v194, s33
    v_mfma_f32_16x16x32_bf16 v[202:205], a[252:255], v[174:177], v[202:205]
    v_fmac_f32 v127, v195, v195
    v_fmac_f32 v127, v196, v196
    v_mfma_f32_16x16x32_bf16 v[202:205], v[82:85], v[186:189], v[202:205]
    v_fmac_f32 v127, v197, v197
    v_mul_f32 v207, v126, v207
    v_mfma_f32_16x16x32_bf16 v[202:205], v[86:89], v[190:193], v[202:205]
    v_cvt_pk_bf16_f32 v116, v206, v207
    v_mul_f32 v208, v126, v208
    v_mfma_f32_16x16x32_bf16 v[138:141], v[90:93], v[122:125], 0
    v_mul_f32 v209, v126, v209
    v_cvt_pk_bf16_f32 v117, v208, v209
    v_mfma_f32_16x16x32_bf16 v[138:141], v[94:97], v[142:145], v[138:141]
    v_exp_f32 v162, v162
    v_mfma_f32_16x16x32_bf16 v[138:141], v[98:101], v[166:169], v[138:141]
    v_fmac_f32 v127, v202, v202
    v_fmac_f32 v127, v203, v203
    v_mfma_f32_16x16x32_bf16 v[138:141], v[102:105], v[174:177], v[138:141]
    v_fmac_f32 v127, v204, v204
    v_fmac_f32 v127, v205, v205
    v_mfma_f32_16x16x32_bf16 v[138:141], v[106:109], v[186:189], v[138:141]
    v_exp_f32 v163, v163
    v_mfma_f32_16x16x32_bf16 v[138:141], v[110:113], v[190:193], v[138:141]
    v_cvt_pk_bf16_f32 v36, v162, v163
    v_sub_f32 v164, v164, v237
    v_exp_f32 v164, v164
    v_sub_f32 v165, v165, v237
    v_exp_f32 v165, v165
    v_sub_f32 v114, v114, v237
    v_cvt_pk_bf16_f32 v37, v164, v165
    v_exp_f32 v114, v114
    v_fmac_f32 v127, v138, v138
    v_fmac_f32 v127, v139, v139
    v_fmac_f32 v127, v140, v140
    v_fmac_f32 v127, v141, v141
    v_cvt_pk_bf16_f32 v126, v171, v127
    v_cvt_pk_bf16_f32 v127, v127, v127
    ds_write_b64 v255, v[126:127] offset:7616
    buffer_store_dwordx4 v[130:133], v17, s[52:55], 0 offen nt
    v_cvt_pk_bf16_f32 v39, v114, 0
    s_nop 0
    s_nop 0
    v_mfma_f32_16x16x32_bf16 v[122:125], v[28:31], v[36:39], 0
    v_mfma_f32_16x16x32_bf16 v[122:125], v[28:31], v[150:153], v[122:125]
    v_mfma_f32_16x16x32_bf16 v[130:133], v[218:221], v[36:39], 0
    v_mfma_f32_16x16x32_bf16 v[130:133], v[146:149], v[150:153], v[130:133]
    v_mfma_f32_16x16x32_bf16 v[142:145], v[222:225], v[36:39], 0
    v_mfma_f32_16x16x32_bf16 v[142:145], v[118:121], v[150:153], v[142:145]
    v_mfma_f32_16x16x32_bf16 v[118:121], v[210:213], v[36:39], 0
    v_mfma_f32_16x16x32_bf16 v[118:121], v[182:185], v[150:153], v[118:121]
    s_nop 0
    s_nop 0
    v_rcp_f32 v122, v122
    s_nop 0
    v_mul_f32 v130, v122, v130
    v_mul_f32 v131, v122, v131
    v_cvt_pk_bf16_f32 v130, v130, v131
    v_mul_f32 v132, v122, v132
    v_mul_f32 v133, v122, v133
    v_cvt_pk_bf16_f32 v131, v132, v133
    v_mul_f32 v142, v122, v142
    v_mul_f32 v143, v122, v143
    v_cvt_pk_bf16_f32 v132, v142, v143
    v_mul_f32 v144, v122, v144
    v_mul_f32 v145, v122, v145
    v_cvt_pk_bf16_f32 v133, v144, v145
    ds_write_b128 v3, v[130:133] offset:12288
    v_mul_f32 v118, v122, v118
    v_mul_f32 v119, v122, v119
    v_cvt_pk_bf16_f32 v114, v118, v119
    v_mul_f32 v120, v122, v120
    v_mul_f32 v121, v122, v121
    v_cvt_pk_bf16_f32 v115, v120, v121
    buffer_store_dwordx2 v[116:117], v20, s[52:55], 0 offen nt
    ds_write_b64 v4, v[114:115] offset:16384
    s_waitcnt lgkmcnt(0)
    s_barrier
    ds_read_b128 v[114:117], v129 offset:7616
    ds_read_b128 v[118:121], v129 offset:8640
    ds_read_b128 v[122:125], v172 offset:12288
    ds_read_b128 v[130:133], v172 offset:13312
    ds_read_b128 v[142:145], v172 offset:14336
    ds_read_b128 v[146:149], v172 offset:15360
    ds_read_b128 v[150:153], v172 offset:16384
    ds_read_b128 v[162:165], v172 offset:17408
    s_waitcnt lgkmcnt(7)
    v_mfma_f32_16x16x32_bf16 v[166:169], v[32:35], v[114:117], 0
    s_waitcnt lgkmcnt(6)
    v_mfma_f32_16x16x32_bf16 v[166:169], v[32:35], v[118:121], v[166:169]
    s_waitcnt lgkmcnt(4)
    v_mfma_f32_16x16x32_bf16 v[114:117], a[216:219], v[122:125], 0
    s_waitcnt lgkmcnt(3)
    v_mfma_f32_16x16x32_bf16 v[114:117], a[220:223], v[130:133], v[114:117]
    s_waitcnt lgkmcnt(2)
    v_mfma_f32_16x16x32_bf16 v[114:117], a[224:227], v[142:145], v[114:117]
    s_waitcnt lgkmcnt(1)
    v_mfma_f32_16x16x32_bf16 v[114:117], a[228:231], v[146:149], v[114:117]
    s_waitcnt lgkmcnt(0)
    v_mul_f32 v171, 0x3baaaaab, v166
    v_mul_f32 v237, 0x3baaaaab, v167
    v_mfma_f32_16x16x32_bf16 v[114:117], a[232:235], v[150:153], v[114:117]
    v_rsq_f32 v171, v171
    v_mfma_f32_16x16x32_bf16 v[114:117], a[236:239], v[162:165], v[114:117]
    v_mul_f32 v154, v171, v154
    v_mul_f32 v155, v171, v155
    v_mfma_f32_16x16x32_bf16 v[118:121], a[240:243], v[122:125], 0
    v_cvt_pk_bf16_f32 v154, v154, v155
    v_mul_f32 v156, v171, v156
    v_mfma_f32_16x16x32_bf16 v[118:121], a[244:247], v[130:133], v[118:121]
    v_mul_f32 v157, v171, v157
    v_cvt_pk_bf16_f32 v155, v156, v157
    v_mfma_f32_16x16x32_bf16 v[118:121], a[248:251], v[142:145], v[118:121]
    v_fma_f32 v126, v114, v114, s33
    v_fmac_f32 v126, v115, v115
    v_mfma_f32_16x16x32_bf16 v[118:121], a[252:255], v[146:149], v[118:121]
    v_fmac_f32 v126, v116, v116
    v_fmac_f32 v126, v117, v117
    v_mfma_f32_16x16x32_bf16 v[118:121], v[82:85], v[150:153], v[118:121]
    v_mul_f32 v158, v171, v158
    v_mul_f32 v159, v171, v159
    v_mfma_f32_16x16x32_bf16 v[118:121], v[86:89], v[162:165], v[118:121]
    ds_read_b128 v[166:169], v128 offset:256
    v_cvt_pk_bf16_f32 v156, v158, v159
    v_mfma_f32_16x16x32_bf16 v[174:177], v[90:93], v[122:125], 0
    ds_read_b128 v[122:125], v128 offset:2304
    v_mul_f32 v160, v171, v160
    v_mfma_f32_16x16x32_bf16 v[174:177], v[94:97], v[130:133], v[174:177]
    ds_read_b128 v[130:133], v128 offset:4352
    v_mul_f32 v161, v171, v161
    v_mfma_f32_16x16x32_bf16 v[174:177], v[98:101], v[142:145], v[174:177]
    ds_read_b128 v[142:145], v128 offset:6400
    v_fmac_f32 v126, v118, v118
    v_mfma_f32_16x16x32_bf16 v[174:177], v[102:105], v[146:149], v[174:177]
    ds_read_b128 v[146:149], v128 offset:8448
    v_fmac_f32 v126, v119, v119
    v_mfma_f32_16x16x32_bf16 v[174:177], v[106:109], v[150:153], v[174:177]
    ds_read_b128 v[150:153], v128 offset:10496
    v_fmac_f32 v126, v120, v120
    v_mfma_f32_16x16x32_bf16 v[174:177], v[110:113], v[162:165], v[174:177]
    v_fmac_f32 v126, v121, v121
    v_cvt_pk_bf16_f32 v157, v160, v161
    buffer_store_dwordx4 v[154:157], v15, s[56:59], 0 offen nt
    s_waitcnt lgkmcnt(5)
    v_mul_f32 v134, v171, v134
    v_mul_f32 v135, v171, v135
    v_cvt_pk_bf16_f32 v134, v134, v135
    v_mfma_f32_16x16x32_bf16 v[154:157], a[216:219], v[166:169], 0
    s_waitcnt lgkmcnt(4)
    v_fmac_f32 v126, v174, v174
    v_fmac_f32 v126, v175, v175
    v_mfma_f32_16x16x32_bf16 v[154:157], a[220:223], v[122:125], v[154:157]
    s_waitcnt lgkmcnt(3)
    v_fmac_f32 v126, v176, v176
    v_fmac_f32 v126, v177, v177
    v_mfma_f32_16x16x32_bf16 v[154:157], a[224:227], v[130:133], v[154:157]
    s_waitcnt lgkmcnt(2)
    v_cvt_pk_bf16_f32 v158, v126, v126
    v_cvt_pk_bf16_f32 v159, v126, v126
    v_mfma_f32_16x16x32_bf16 v[154:157], a[228:231], v[142:145], v[154:157]
    s_waitcnt lgkmcnt(1)
    ds_write_b64 v255, v[158:159] offset:9664
    v_mfma_f32_16x16x32_bf16 v[154:157], a[232:235], v[146:149], v[154:157]
    s_waitcnt lgkmcnt(1)
    v_mul_f32 v136, v171, v136
    v_mul_f32 v137, v171, v137
    v_mfma_f32_16x16x32_bf16 v[154:157], a[236:239], v[150:153], v[154:157]
    v_rsq_f32 v237, v237
    v_mfma_f32_16x16x32_bf16 v[158:161], a[240:243], v[166:169], 0
    v_cvt_pk_bf16_f32 v135, v136, v137
    v_mul_f32 v194, v237, v194
    v_mfma_f32_16x16x32_bf16 v[158:161], a[244:247], v[122:125], v[158:161]
    v_mul_f32 v195, v237, v195
    v_cvt_pk_bf16_f32 v162, v194, v195
    v_mfma_f32_16x16x32_bf16 v[158:161], a[248:251], v[130:133], v[158:161]
    v_fma_f32 v171, v154, v154, s33
    v_fmac_f32 v171, v155, v155
    v_mfma_f32_16x16x32_bf16 v[158:161], a[252:255], v[142:145], v[158:161]
    v_fmac_f32 v171, v156, v156
    v_fmac_f32 v171, v157, v157
    v_mfma_f32_16x16x32_bf16 v[158:161], v[82:85], v[146:149], v[158:161]
    v_mul_f32 v196, v237, v196
    v_mul_f32 v197, v237, v197
    v_mfma_f32_16x16x32_bf16 v[158:161], v[86:89], v[150:153], v[158:161]
    v_cvt_pk_bf16_f32 v163, v196, v197
    v_mul_f32 v202, v237, v202
    v_mfma_f32_16x16x32_bf16 v[178:181], v[90:93], v[166:169], 0
    v_mul_f32 v203, v237, v203
    v_cvt_pk_bf16_f32 v164, v202, v203
    v_mfma_f32_16x16x32_bf16 v[178:181], v[94:97], v[122:125], v[178:181]
    v_mul_f32 v204, v237, v204
    v_mul_f32 v205, v237, v205
    v_mfma_f32_16x16x32_bf16 v[178:181], v[98:101], v[130:133], v[178:181]
    buffer_store_dwordx2 v[134:135], v18, s[56:59], 0 offen nt
    v_fmac_f32 v171, v158, v158
    v_fmac_f32 v171, v159, v159
    v_mfma_f32_16x16x32_bf16 v[178:181], v[102:105], v[142:145], v[178:181]
    v_fmac_f32 v171, v160, v160
    v_fmac_f32 v171, v161, v161
    v_mfma_f32_16x16x32_bf16 v[178:181], v[106:109], v[146:149], v[178:181]
    v_cvt_pk_bf16_f32 v165, v204, v205
    v_mul_f32 v138, v237, v138
    v_mfma_f32_16x16x32_bf16 v[178:181], v[110:113], v[150:153], v[178:181]
    ds_write_b128 v173, v[162:165] offset:1536
    v_mul_f32 v139, v237, v139
    v_cvt_pk_bf16_f32 v126, v138, v139
    v_mul_f32 v140, v237, v140
    v_mul_f32 v141, v237, v141
    v_cvt_pk_bf16_f32 v127, v140, v141
    s_nop 0
    s_nop 0
    v_fmac_f32 v171, v178, v178
    v_fmac_f32 v171, v179, v179
    v_fmac_f32 v171, v180, v180
    v_fmac_f32 v171, v181, v181
    v_cvt_pk_bf16_f32 v122, v171, v171
    v_cvt_pk_bf16_f32 v123, v171, v171
    ds_write_b64 v255, v[122:123] offset:15232
    ds_read_b128 v[122:125], v199 offset:1536
    ds_write_b64 v198, v[126:127] offset:2560
    ds_read_b64 v[126:127], v254 offset:2560
    s_waitcnt lgkmcnt(3)
    s_barrier
    ds_read_b128 v[130:133], v129 offset:9664
    ds_read_b128 v[134:137], v129 offset:10688
    ds_read_b128 v[138:141], v129 offset:15232
    ds_read_b128 v[142:145], v129 offset:16256
    ds_read_b128 v[146:149], v172 offset:18432
    s_waitcnt lgkmcnt(6)
    buffer_store_dwordx4 v[122:125], v200, s[56:59], 0 offen nt
    s_waitcnt lgkmcnt(5)
    s_waitcnt lgkmcnt(4)
    v_mfma_f32_16x16x32_bf16 v[150:153], v[32:35], v[130:133], 0
    s_waitcnt lgkmcnt(3)
    v_mfma_f32_16x16x32_bf16 v[150:153], v[32:35], v[134:137], v[150:153]
    s_waitcnt lgkmcnt(1)
    buffer_store_dwordx2 v[126:127], v201, s[56:59], 0 offen nt
    v_mfma_f32_16x16x32_bf16 v[122:125], v[32:35], v[138:141], 0
    s_waitcnt lgkmcnt(0)
    v_or3_b32 v146, v146, v147, v148
    v_or_b32 v146, v146, v149
    v_mfma_f32_16x16x32_bf16 v[122:125], v[32:35], v[142:145], v[122:125]
    v_cmp_gt_i32 s[46:47], 0, v146
    v_mul_f32 v237, 0x3baaaaab, v150
    v_rsq_f32 v237, v237
    s_nop 0
    v_mul_f32 v114, v237, v114
    v_mul_f32 v115, v237, v115
    v_cvt_pk_bf16_f32 v114, v114, v115
    v_mul_f32 v116, v237, v116
    v_mul_f32 v115, 0x3baaaaab, v122
    v_rsq_f32 v115, v115
    v_mul_f32 v117, v237, v117
    v_mul_f32 v154, v115, v154
    v_mul_f32 v155, v115, v155
    v_cvt_pk_bf16_f32 v122, v154, v155
    v_mul_f32 v156, v115, v156
    v_mul_f32 v157, v115, v157
    v_cvt_pk_bf16_f32 v123, v156, v157
    v_mul_f32 v158, v115, v158
    v_mul_f32 v159, v115, v159
    v_cvt_pk_bf16_f32 v124, v158, v159
    v_mul_f32 v160, v115, v160
    v_mul_f32 v161, v115, v161
    v_cvt_pk_bf16_f32 v125, v160, v161
    buffer_store_dwordx4 v[122:125], v170, s[12:15], 0 offen nt
    v_mul_f32 v178, v115, v178
    v_mul_f32 v179, v115, v179
    v_cvt_pk_bf16_f32 v200, v178, v179
    v_mul_f32 v180, v115, v180
    v_mul_f32 v181, v115, v181
    v_cvt_pk_bf16_f32 v201, v180, v181
    v_cvt_pk_bf16_f32 v115, v116, v117
    v_mul_f32 v118, v237, v118
    v_mul_f32 v119, v237, v119
    v_cvt_pk_bf16_f32 v116, v118, v119
    v_mul_f32 v120, v237, v120
    v_mul_f32 v121, v237, v121
    v_cvt_pk_bf16_f32 v117, v120, v121
    ds_write_b128 v173, v[114:117] offset:3072
    v_mul_f32 v174, v237, v174
    v_mul_f32 v175, v237, v175
    v_cvt_pk_bf16_f32 v174, v174, v175
    v_mul_f32 v176, v237, v176
    v_mul_f32 v177, v237, v177
    v_cvt_pk_bf16_f32 v175, v176, v177
    buffer_store_dwordx2 v[200:201], v236, s[12:15], 0 offen nt
    ds_read_b128 v[114:117], v199 offset:3072
    ds_write_b64 v198, v[174:175] offset:4096
    ds_read_b64 v[236:237], v254 offset:4096
    s_waitcnt lgkmcnt(2)
    buffer_store_dwordx4 v[114:117], v234, s[56:59], 0 offen nt
    s_waitcnt lgkmcnt(0)
    buffer_store_dwordx2 v[236:237], v235, s[56:59], 0 offen nt
    s_branch L_end
L_drain:
    ds_read_b128 v[118:121], v2 offset:18432
    ds_read_b128 v[122:125], v2 offset:19456
    s_nop 3
    ds_read_b128 v[134:137], v2 offset:0
    s_mul_i32 s5, s16, 9408
    s_mov_b32 s12, s40
    ds_read_b128 v[138:141], v2 offset:1024
    s_mov_b32 s13, s41
    s_cmp_ge_u32 s18, 2
    s_cselect_b32 s14, s36, 0
    ds_read_b128 v[142:145], v2 offset:2048
    s_add_u32 s5, s5, 104448
    s_and_b32 s6, s2, 7
    s_sub_u32 s6, 0, s6
    ds_read_b128 v[146:149], v2 offset:3072
    s_lshl_b32 s3, s16, 6
    s_lshl_b32 s4, s16, 5
    s_add_u32 s4, s4, 256
    ds_read_b128 v[150:153], v2 offset:4096
    ds_read_b128 v[162:165], v2 offset:5120
    v_bfe_u32 v254, v2, 4, 6
    v_lshrrev_b32 v255, 4, v254
    v_and_b32 v166, 15, v254
    v_lshlrev_b32 v167, 9, v255
    v_lshl_add_u32 v167, v166, 4, v167
    v_add_u32 v167, 149696, v167
    s_waitcnt lgkmcnt(7)
    v_mfma_f32_16x16x32_bf16 v[170:173], v[32:35], v[118:121], 0
    s_waitcnt lgkmcnt(5)
    v_xor_b32 v168, 65536, v2
    v_bfe_u32 v169, v166, 1, 2
    v_mfma_f32_16x16x32_bf16 v[170:173], v[32:35], v[122:125], v[170:173]
    s_waitcnt lgkmcnt(4)
    v_xor_b32 v169, v169, v255
    v_lshl_add_u32 v169, v166, 2, v169
    v_lshl_add_u32 v118, v169, 4, s5
    v_mfma_f32_16x16x32_bf16 v[122:125], a[216:219], v[134:137], 0
    s_waitcnt lgkmcnt(3)
    v_lshl_add_u32 v119, v169, 3, s5
    v_lshl_add_u32 v120, v254, 4, s5
    v_lshl_add_u32 v121, v254, 3, s5
    v_mfma_f32_16x16x32_bf16 v[122:125], a[220:223], v[138:141], v[122:125]
    s_waitcnt lgkmcnt(2)
    v_lshlrev_b32 v169, 2, v169
    v_mul_f32 v170, 0x3baaaaab, v170
    v_rsq_f32 v170, v170
    v_mfma_f32_16x16x32_bf16 v[122:125], a[224:227], v[142:145], v[122:125]
    s_waitcnt lgkmcnt(0)
    ds_permute_b32 v173, v169, v15
    ds_permute_b32 v174, v169, v18
    v_mul_f32 v178, v170, v178
    v_mfma_f32_16x16x32_bf16 v[122:125], a[228:231], v[146:149], v[122:125]
    ds_permute_b32 v175, v169, v16
    ds_permute_b32 v176, v169, v19
    v_mul_f32 v179, v170, v179
    v_mfma_f32_16x16x32_bf16 v[122:125], a[232:235], v[150:153], v[122:125]
    ds_permute_b32 v177, v169, v17
    ds_permute_b32 v182, v169, v20
    v_cvt_pk_bf16_f32 v178, v178, v179
    v_mfma_f32_16x16x32_bf16 v[122:125], a[236:239], v[162:165], v[122:125]
    v_mul_f32 v180, v170, v180
    v_mul_f32 v181, v170, v181
    v_cvt_pk_bf16_f32 v179, v180, v181
    v_mfma_f32_16x16x32_bf16 v[186:189], a[240:243], v[134:137], 0
    v_mul_f32 v198, v170, v198
    v_mul_f32 v199, v170, v199
    v_cvt_pk_bf16_f32 v180, v198, v199
    v_mfma_f32_16x16x32_bf16 v[186:189], a[244:247], v[138:141], v[186:189]
    v_mul_f32 v200, v170, v200
    v_mul_f32 v201, v170, v201
    v_cvt_pk_bf16_f32 v181, v200, v201
    v_mfma_f32_16x16x32_bf16 v[186:189], a[248:251], v[142:145], v[186:189]
    s_waitcnt lgkmcnt(4)
    ds_read_b128 v[190:193], v2 offset:6144
    v_mul_f32 v206, v170, v206
    v_mul_f32 v207, v170, v207
    v_mfma_f32_16x16x32_bf16 v[186:189], a[252:255], v[146:149], v[186:189]
    s_waitcnt lgkmcnt(3)
    ds_read_b128 v[194:197], v2 offset:7168
    v_cvt_pk_bf16_f32 v184, v206, v207
    v_mul_f32 v208, v170, v208
    v_mfma_f32_16x16x32_bf16 v[186:189], v[82:85], v[150:153], v[186:189]
    s_waitcnt lgkmcnt(2)
    ds_read_b128 v[198:201], v2 offset:8192
    v_mul_f32 v209, v170, v209
    v_cvt_pk_bf16_f32 v185, v208, v209
    v_mfma_f32_16x16x32_bf16 v[186:189], v[86:89], v[162:165], v[186:189]
    ds_read_b128 v[202:205], v2 offset:9216
    v_fma_f32 v169, v122, v122, s33
    v_fmac_f32 v169, v123, v123
    v_mfma_f32_16x16x32_bf16 v[206:209], v[90:93], v[134:137], 0
    ds_read_b128 v[134:137], v2 offset:10240
    v_fmac_f32 v169, v124, v124
    v_fmac_f32 v169, v125, v125
    v_mfma_f32_16x16x32_bf16 v[206:209], v[94:97], v[138:141], v[206:209]
    ds_read_b128 v[138:141], v2 offset:11264
    v_fmac_f32 v169, v186, v186
    v_fmac_f32 v169, v187, v187
    v_mfma_f32_16x16x32_bf16 v[206:209], v[98:101], v[142:145], v[206:209]
    s_waitcnt lgkmcnt(5)
    buffer_store_dwordx4 v[178:181], v15, s[12:15], s27 offen nt
    v_fmac_f32 v169, v188, v188
    v_fmac_f32 v169, v189, v189
    v_mul_f32 v183, 0x3baaaaab, v171
    v_mfma_f32_16x16x32_bf16 v[206:209], v[102:105], v[146:149], v[206:209]
    s_waitcnt lgkmcnt(4)
    v_rsq_f32 v183, v183
    v_sub_u32 v170, 0x40800000, v44
    v_mfma_f32_16x16x32_bf16 v[206:209], v[106:109], v[150:153], v[206:209]
    s_waitcnt lgkmcnt(3)
    v_mul_f32 v130, v183, v130
    v_mul_f32 v131, v183, v131
    v_cvt_pk_bf16_f32 v130, v130, v131
    v_mfma_f32_16x16x32_bf16 v[206:209], v[110:113], v[162:165], v[206:209]
    s_waitcnt lgkmcnt(2)
    v_mul_f32 v132, v183, v132
    v_mul_f32 v133, v183, v133
    v_cvt_pk_bf16_f32 v131, v132, v133
    v_mfma_f32_16x16x32_bf16 v[142:145], a[216:219], v[190:193], 0
    s_waitcnt lgkmcnt(1)
    v_mul_f32 v126, v183, v126
    v_mul_f32 v127, v183, v127
    v_fmac_f32 v169, v206, v206
    v_mfma_f32_16x16x32_bf16 v[142:145], a[220:223], v[194:197], v[142:145]
    s_waitcnt lgkmcnt(0)
    v_fmac_f32 v169, v207, v207
    v_fmac_f32 v169, v208, v208
    v_fmac_f32 v169, v209, v209
    v_mfma_f32_16x16x32_bf16 v[142:145], a[224:227], v[198:201], v[142:145]
    v_cvt_pk_bf16_f32 v132, v126, v127
    v_mul_f32 v128, v183, v128
    v_mul_f32 v129, v183, v129
    v_mfma_f32_16x16x32_bf16 v[142:145], a[228:231], v[202:205], v[142:145]
    v_cvt_pk_bf16_f32 v133, v128, v129
    v_mul_f32 v114, v183, v114
    v_mul_f32 v115, v183, v115
    v_mfma_f32_16x16x32_bf16 v[142:145], a[232:235], v[134:137], v[142:145]
    v_cvt_pk_bf16_f32 v114, v114, v115
    v_mul_f32 v116, v183, v116
    v_mul_f32 v117, v183, v117
    v_mfma_f32_16x16x32_bf16 v[142:145], a[236:239], v[138:141], v[142:145]
    v_cvt_pk_bf16_f32 v115, v116, v117
    v_or_b32 v170, v170, v44
    v_lshl_add_u32 v171, s16, 2, v168
    v_mfma_f32_16x16x32_bf16 v[126:129], a[240:243], v[190:193], 0
    ds_write_b32 v171, v170 offset:18432
    v_mul_f32 v183, 0x3baaaaab, v172
    v_mfma_f32_16x16x32_bf16 v[126:129], a[244:247], v[194:197], v[126:129]
    v_rsq_f32 v183, v183
    v_fma_f32 v116, v142, v142, s33
    v_mfma_f32_16x16x32_bf16 v[126:129], a[248:251], v[198:201], v[126:129]
    ds_read_b128 v[146:149], v2 offset:12288
    v_fmac_f32 v116, v143, v143
    v_fmac_f32 v116, v144, v144
    v_mfma_f32_16x16x32_bf16 v[126:129], a[252:255], v[202:205], v[126:129]
    ds_read_b128 v[150:153], v2 offset:13312
    v_fmac_f32 v116, v145, v145
    v_mul_f32 v242, v183, v242
    v_mfma_f32_16x16x32_bf16 v[126:129], v[82:85], v[134:137], v[126:129]
    ds_read_b128 v[162:165], v2 offset:14336
    v_mul_f32 v243, v183, v243
    v_cvt_pk_bf16_f32 v178, v242, v243
    v_mfma_f32_16x16x32_bf16 v[126:129], v[86:89], v[138:141], v[126:129]
    ds_read_b128 v[210:213], v2 offset:15360
    v_mul_f32 v244, v183, v244
    v_mul_f32 v245, v183, v245
    v_mfma_f32_16x16x32_bf16 v[214:217], v[90:93], v[190:193], 0
    ds_read_b128 v[190:193], v2 offset:16384
    v_cvt_pk_bf16_f32 v179, v244, v245
    v_mul_f32 v158, v183, v158
    v_mfma_f32_16x16x32_bf16 v[214:217], v[94:97], v[194:197], v[214:217]
    ds_read_b128 v[194:197], v2 offset:17408
    v_fmac_f32 v116, v126, v126
    v_fmac_f32 v116, v127, v127
    v_mfma_f32_16x16x32_bf16 v[214:217], v[98:101], v[198:201], v[214:217]
    s_waitcnt lgkmcnt(5)
    buffer_store_dwordx2 v[184:185], v18, s[12:15], s27 offen nt
    v_fmac_f32 v116, v128, v128
    v_mfma_f32_16x16x32_bf16 v[214:217], v[102:105], v[202:205], v[214:217]
    s_waitcnt lgkmcnt(4)
    v_fmac_f32 v116, v129, v129
    v_mul_f32 v159, v183, v159
    v_cvt_pk_bf16_f32 v180, v158, v159
    v_mfma_f32_16x16x32_bf16 v[214:217], v[106:109], v[134:137], v[214:217]
    s_waitcnt lgkmcnt(3)
    v_mul_f32 v160, v183, v160
    v_mul_f32 v161, v183, v161
    v_cvt_pk_bf16_f32 v181, v160, v161
    v_mfma_f32_16x16x32_bf16 v[214:217], v[110:113], v[138:141], v[214:217]
    s_waitcnt lgkmcnt(2)
    ds_write_b128 v118, v[178:181] offset:3072
    v_mfma_f32_16x16x32_bf16 v[134:137], a[216:219], v[146:149], 0
    s_waitcnt lgkmcnt(2)
    v_mul_f32 v154, v183, v154
    v_mul_f32 v155, v183, v155
    v_cvt_pk_bf16_f32 v154, v154, v155
    v_mfma_f32_16x16x32_bf16 v[134:137], a[220:223], v[150:153], v[134:137]
    s_waitcnt lgkmcnt(1)
    v_fmac_f32 v116, v214, v214
    v_fmac_f32 v116, v215, v215
    v_fmac_f32 v116, v216, v216
    v_mfma_f32_16x16x32_bf16 v[134:137], a[224:227], v[162:165], v[134:137]
    ds_read_b128 v[138:141], v120 offset:3072
    v_fmac_f32 v116, v217, v217
    v_cvt_pk_bf16_f32 v184, v169, v116
    v_mfma_f32_16x16x32_bf16 v[134:137], a[228:231], v[210:213], v[134:137]
    v_cvt_pk_bf16_f32 v185, v116, v116
    v_mul_f32 v156, v183, v156
    v_mul_f32 v157, v183, v157
    v_mfma_f32_16x16x32_bf16 v[134:137], a[232:235], v[190:193], v[134:137]
    ds_write_b64 v4, v[184:185] offset:0
    v_mfma_f32_16x16x32_bf16 v[134:137], a[236:239], v[194:197], v[134:137]
    v_cvt_pk_bf16_f32 v155, v156, v157
    v_mov_b32 v169, 0x40000000
    v_lshrrev_b32 v116, 2, v254
    v_mfma_f32_16x16x32_bf16 v[158:161], a[240:243], v[146:149], 0
    ds_write_b64 v119, v[154:155] offset:4096
    v_mfma_f32_16x16x32_bf16 v[158:161], a[244:247], v[150:153], v[158:161]
    v_lshrrev_b32 v117, 3, v254
    v_xor_b32 v117, v117, v254
    v_fma_f32 v254, v134, v134, s33
    v_mfma_f32_16x16x32_bf16 v[158:161], a[248:251], v[162:165], v[158:161]
    s_waitcnt lgkmcnt(2)
    ds_read_b128 v[154:157], v167 offset:0
    ds_read_b64 v[170:171], v121 offset:4096
    v_fmac_f32 v254, v135, v135
    v_mfma_f32_16x16x32_bf16 v[158:161], a[252:255], v[210:213], v[158:161]
    ds_read_b128 v[178:181], v167 offset:2048
    v_fmac_f32 v254, v136, v136
    v_fmac_f32 v254, v137, v137
    v_mfma_f32_16x16x32_bf16 v[158:161], v[82:85], v[190:193], v[158:161]
    s_waitcnt lgkmcnt(4)
    ds_read_b128 v[198:201], v167 offset:4096
    v_and_b32 v117, 3, v117
    v_add_u32 v116, 0, v116
    v_mfma_f32_16x16x32_bf16 v[158:161], v[86:89], v[194:197], v[158:161]
    s_barrier
    ds_read_b128 v[202:205], v168 offset:0
    ds_read_b128 v[218:221], v168 offset:1024
    v_mul_u32_u24 v172, s20, v116
    v_mfma_f32_16x16x32_bf16 v[222:225], v[90:93], v[146:149], 0
    ds_read_b128 v[146:149], v167 offset:6144
    ds_read_b128 v[226:229], v167 offset:8192
    v_add_u32 v172, s38, v172
    v_mfma_f32_16x16x32_bf16 v[222:225], v[94:97], v[150:153], v[222:225]
    ds_read_b128 v[150:153], v167 offset:10240
    v_fmac_f32 v254, v158, v158
    v_fmac_f32 v254, v159, v159
    v_mfma_f32_16x16x32_bf16 v[222:225], v[98:101], v[162:165], v[222:225]
    s_waitcnt lgkmcnt(7)
    buffer_store_dwordx4 v[130:133], v16, s[12:15], s27 offen nt
    ds_read_b128 v[162:165], v168 offset:18432
    v_fmac_f32 v254, v160, v160
    v_fmac_f32 v254, v161, v161
    v_mfma_f32_16x16x32_bf16 v[222:225], v[102:105], v[210:213], v[222:225]
    s_waitcnt lgkmcnt(7)
    v_mul_u32_u24 v183, 911, v172
    v_lshrrev_b32 v183, 16, v183
    v_mul_u32_u24 v183, s22, v183
    v_mfma_f32_16x16x32_bf16 v[222:225], v[106:109], v[190:193], v[222:225]
    s_waitcnt lgkmcnt(6)
    v_mad_u32_u24 v183, v116, s21, v183
    v_bfe_u32 v172, s70, v116, 1
    v_cmp_ne_u32 vcc, 0, v172
    v_mfma_f32_16x16x32_bf16 v[222:225], v[110:113], v[194:197], v[222:225]
    s_waitcnt lgkmcnt(4)
    v_add_u32 v116, s7, v183
    v_cndmask_b32 v116, v169, v116, vcc
    v_mfma_f32_16x16x32_bf16 v[130:133], v[32:35], v[202:205], 0
    s_waitcnt lgkmcnt(2)
    v_lshl_add_u32 v172, v117, 4, v116
    v_add_u32 v172, s3, v172
    v_mfma_f32_16x16x32_bf16 v[130:133], v[32:35], v[218:221], v[130:133]
    s_waitcnt lgkmcnt(1)
    v_fmac_f32 v254, v222, v222
    v_fmac_f32 v254, v223, v223
    v_fmac_f32 v254, v224, v224
    v_mfma_f32_16x16x32_bf16 v[190:193], a[216:219], v[154:157], 0
    v_fmac_f32 v254, v225, v225
    v_cvt_pk_bf16_f32 v184, v254, v254
    v_cvt_pk_bf16_f32 v185, v254, v254
    v_mfma_f32_16x16x32_bf16 v[190:193], a[220:223], v[178:181], v[190:193]
    s_waitcnt lgkmcnt(0)
    ds_write_b64 v4, v[184:185] offset:2048
    v_mfma_f32_16x16x32_bf16 v[190:193], a[224:227], v[198:201], v[190:193]
    v_lshl_add_u32 v254, v117, 3, v116
    v_add_u32 v254, s4, v254
    v_add_u32 v166, 16, v166
    v_mfma_f32_16x16x32_bf16 v[190:193], a[228:231], v[146:149], v[190:193]
    v_min_u32 v116, 20, v166
    v_add_u32 v132, 12, v166
    v_lshrrev_b32 v132, 5, v132
    v_mfma_f32_16x16x32_bf16 v[190:193], a[232:235], v[226:229], v[190:193]
    v_sub_u32 v133, v166, v116
    v_mad_i32_i24 v133, v132, s6, v133
    v_mul_u32_u24 v117, s20, v116
    v_mfma_f32_16x16x32_bf16 v[190:193], a[236:239], v[150:153], v[190:193]
    v_add3_u32 v117, v117, v133, s38
    v_mul_u32_u24 v132, 911, v117
    v_lshrrev_b32 v132, 16, v132
    v_mfma_f32_16x16x32_bf16 v[194:197], a[240:243], v[154:157], 0
    v_mul_u32_u24 v132, s22, v132
    v_mad_u32_u24 v132, v116, s21, v132
    v_bfe_u32 v117, s70, v166, 1
    v_mfma_f32_16x16x32_bf16 v[194:197], a[244:247], v[178:181], v[194:197]
    buffer_store_dwordx2 v[114:115], v19, s[12:15], s27 offen nt
    v_fma_f32 v166, v190, v190, s33
    v_mfma_f32_16x16x32_bf16 v[194:197], a[248:251], v[198:201], v[194:197]
    ds_read_b128 v[202:205], v167 offset:256
    v_fmac_f32 v166, v191, v191
    v_fmac_f32 v166, v192, v192
    v_mfma_f32_16x16x32_bf16 v[194:197], a[252:255], v[146:149], v[194:197]
    ds_read_b128 v[210:213], v167 offset:2304
    v_fmac_f32 v166, v193, v193
    v_cmp_ne_u32 vcc, 0, v117
    v_mfma_f32_16x16x32_bf16 v[194:197], v[82:85], v[226:229], v[194:197]
    ds_read_b128 v[114:117], v167 offset:4352
    v_mul_i32_i24 v133, 2688, v133
    v_add3_u32 v132, v132, v133, s7
    v_mfma_f32_16x16x32_bf16 v[194:197], v[86:89], v[150:153], v[194:197]
    ds_read_b128 v[218:221], v167 offset:6400
    v_cndmask_b32 v132, v169, v132, vcc
    v_lshl_add_u32 v169, v255, 4, v132
    v_mfma_f32_16x16x32_bf16 v[230:233], v[90:93], v[154:157], 0
    ds_read_b128 v[154:157], v167 offset:8448
    v_add_u32 v169, s3, v169
    v_lshl_add_u32 v255, v255, 3, v132
    v_mfma_f32_16x16x32_bf16 v[230:233], v[94:97], v[178:181], v[230:233]
    ds_read_b128 v[178:181], v167 offset:10496
    v_fmac_f32 v166, v194, v194
    v_fmac_f32 v166, v195, v195
    v_mfma_f32_16x16x32_bf16 v[230:233], v[98:101], v[198:201], v[230:233]
    s_waitcnt lgkmcnt(5)
    v_fmac_f32 v166, v196, v196
    v_fmac_f32 v166, v197, v197
    v_add_u32 v255, s4, v255
    v_mfma_f32_16x16x32_bf16 v[230:233], v[102:105], v[146:149], v[230:233]
    s_waitcnt lgkmcnt(4)
    v_mul_f32 v167, 0x3baaaaab, v130
    v_mul_f32 v183, 0x3baaaaab, v131
    v_rsq_f32 v167, v167
    v_mfma_f32_16x16x32_bf16 v[230:233], v[106:109], v[226:229], v[230:233]
    s_waitcnt lgkmcnt(3)
    v_mul_f32 v122, v167, v122
    v_mul_f32 v123, v167, v123
    v_cvt_pk_bf16_f32 v122, v122, v123
    v_mfma_f32_16x16x32_bf16 v[230:233], v[110:113], v[150:153], v[230:233]
    s_waitcnt lgkmcnt(2)
    v_mul_f32 v124, v167, v124
    v_mul_f32 v125, v167, v125
    v_cvt_pk_bf16_f32 v123, v124, v125
    v_mfma_f32_16x16x32_bf16 v[130:133], a[216:219], v[202:205], 0
    s_waitcnt lgkmcnt(1)
    v_mul_f32 v186, v167, v186
    v_mul_f32 v187, v167, v187
    v_fmac_f32 v166, v230, v230
    v_mfma_f32_16x16x32_bf16 v[130:133], a[220:223], v[210:213], v[130:133]
    s_waitcnt lgkmcnt(0)
    v_fmac_f32 v166, v231, v231
    v_fmac_f32 v166, v232, v232
    v_fmac_f32 v166, v233, v233
    v_mfma_f32_16x16x32_bf16 v[130:133], a[224:227], v[114:117], v[130:133]
    buffer_store_dwordx4 v[138:141], v177, s[12:15], s27 offen nt
    v_cvt_pk_bf16_f32 v184, v166, v166
    v_cvt_pk_bf16_f32 v185, v166, v166
    v_cvt_pk_bf16_f32 v124, v186, v187
    v_mfma_f32_16x16x32_bf16 v[130:133], a[228:231], v[218:221], v[130:133]
    ds_write_b64 v4, v[184:185] offset:4096
    v_mfma_f32_16x16x32_bf16 v[130:133], a[232:235], v[154:157], v[130:133]
    v_mul_f32 v188, v167, v188
    v_mul_f32 v189, v167, v189
    v_cvt_pk_bf16_f32 v125, v188, v189
    v_mfma_f32_16x16x32_bf16 v[130:133], a[236:239], v[178:181], v[130:133]
    ds_write_b128 v118, v[122:125] offset:4608
    v_mfma_f32_16x16x32_bf16 v[122:125], a[240:243], v[202:205], 0
    buffer_store_dwordx2 v[170:171], v182, s[12:15], s27 offen nt
    v_mul_f32 v206, v167, v206
    v_mfma_f32_16x16x32_bf16 v[122:125], a[244:247], v[210:213], v[122:125]
    s_mov_b32 s14, s36
    v_mul_f32 v207, v167, v207
    v_cvt_pk_bf16_f32 v166, v206, v207
    v_fma_f32 v184, v130, v130, s33
    v_mfma_f32_16x16x32_bf16 v[122:125], a[248:251], v[114:117], v[122:125]
    ds_read_b128 v[138:141], v120 offset:4608
    v_fmac_f32 v184, v131, v131
    v_fmac_f32 v184, v132, v132
    v_mfma_f32_16x16x32_bf16 v[122:125], a[252:255], v[218:221], v[122:125]
    s_waitcnt lgkmcnt(2)
    v_fmac_f32 v184, v133, v133
    v_mul_f32 v208, v167, v208
    v_mul_f32 v209, v167, v209
    v_mfma_f32_16x16x32_bf16 v[122:125], v[82:85], v[154:157], v[122:125]
    s_barrier
    ds_read_b128 v[146:149], v168 offset:2048
    ds_read_b128 v[150:153], v168 offset:3072
    v_cvt_pk_bf16_f32 v167, v208, v209
    v_mfma_f32_16x16x32_bf16 v[122:125], v[86:89], v[178:181], v[122:125]
    ds_read_b128 v[186:189], v168 offset:4096
    ds_read_b128 v[198:201], v168 offset:5120
    v_rsq_f32 v183, v183
    v_mfma_f32_16x16x32_bf16 v[206:209], v[90:93], v[202:205], 0
    ds_write_b64 v119, v[166:167] offset:5632
    v_mfma_f32_16x16x32_bf16 v[206:209], v[94:97], v[210:213], v[206:209]
    v_mul_f32 v142, v183, v142
    v_mul_f32 v143, v183, v143
    v_fmac_f32 v184, v122, v122
    v_mfma_f32_16x16x32_bf16 v[206:209], v[98:101], v[114:117], v[206:209]
    s_waitcnt lgkmcnt(5)
    buffer_store_dwordx4 v[138:141], v173, s[12:15], s26 offen nt
    ds_read_b64 v[166:167], v121 offset:5632
    v_fmac_f32 v184, v123, v123
    v_fmac_f32 v184, v124, v124
    v_mfma_f32_16x16x32_bf16 v[206:209], v[102:105], v[218:221], v[206:209]
    v_fmac_f32 v184, v125, v125
    v_cvt_pk_bf16_f32 v114, v142, v143
    v_mul_f32 v144, v183, v144
    v_mfma_f32_16x16x32_bf16 v[206:209], v[106:109], v[154:157], v[206:209]
    s_waitcnt lgkmcnt(4)
    v_mul_f32 v145, v183, v145
    v_cvt_pk_bf16_f32 v115, v144, v145
    v_mfma_f32_16x16x32_bf16 v[138:141], v[32:35], v[146:149], 0
    s_waitcnt lgkmcnt(2)
    v_mul_f32 v126, v183, v126
    v_mul_f32 v127, v183, v127
    v_mfma_f32_16x16x32_bf16 v[138:141], v[32:35], v[150:153], v[138:141]
    v_cvt_pk_bf16_f32 v116, v126, v127
    v_mul_f32 v128, v183, v128
    v_mfma_f32_16x16x32_bf16 v[142:145], v[32:35], v[186:189], 0
    v_mul_f32 v129, v183, v129
    v_cvt_pk_bf16_f32 v117, v128, v129
    v_mfma_f32_16x16x32_bf16 v[142:145], v[32:35], v[198:201], v[142:145]
    ds_write_b128 v118, v[114:117] offset:6144
    v_mfma_f32_16x16x32_bf16 v[206:209], v[110:113], v[178:181], v[206:209]
    s_waitcnt lgkmcnt(1)
    buffer_store_dwordx2 v[166:167], v174, s[12:15], s26 offen nt
    v_mul_f32 v214, v183, v214
    v_mul_f32 v215, v183, v215
    v_cvt_pk_bf16_f32 v166, v214, v215
    ds_read_b128 v[114:117], v120 offset:6144
    v_mul_f32 v216, v183, v216
    v_mul_f32 v217, v183, v217
    v_fmac_f32 v184, v206, v206
    v_fmac_f32 v184, v207, v207
    v_fmac_f32 v184, v208, v208
    v_fmac_f32 v184, v209, v209
    v_cvt_pk_bf16_f32 v214, v184, v184
    v_cvt_pk_bf16_f32 v215, v184, v184
    ds_write_b64 v4, v[214:215] offset:6144
    v_cvt_pk_bf16_f32 v167, v216, v217
    v_mul_f32 v174, 0x3baaaaab, v138
    v_rsq_f32 v174, v174
    ds_write_b64 v119, v[166:167] offset:7168
    v_mul_f32 v134, v174, v134
    v_mul_f32 v135, v174, v135
    v_cvt_pk_bf16_f32 v126, v134, v135
    ds_read_b64 v[166:167], v121 offset:7168
    s_waitcnt lgkmcnt(3)
    buffer_store_dwordx4 v[114:117], v175, s[12:15], s26 offen nt
    v_mul_f32 v136, v174, v136
    v_mul_f32 v137, v174, v137
    v_cvt_pk_bf16_f32 v127, v136, v137
    v_mul_f32 v158, v174, v158
    v_mul_f32 v159, v174, v159
    v_cvt_pk_bf16_f32 v128, v158, v159
    v_mul_f32 v160, v174, v160
    s_waitcnt lgkmcnt(2)
    s_barrier
    ds_read_b128 v[114:117], v168 offset:6144
    ds_read_b128 v[134:137], v168 offset:7168
    v_mul_f32 v161, v174, v161
    v_cvt_pk_bf16_f32 v129, v160, v161
    ds_write_b128 v118, v[126:129] offset:0
    v_mul_f32 v222, v174, v222
    v_mul_f32 v223, v174, v223
    v_cvt_pk_bf16_f32 v222, v222, v223
    v_mul_f32 v224, v174, v224
    s_waitcnt lgkmcnt(3)
    buffer_store_dwordx2 v[166:167], v176, s[12:15], s26 offen nt
    ds_read_b128 v[126:129], v120 offset:0
    v_mul_f32 v225, v174, v225
    v_cvt_pk_bf16_f32 v223, v224, v225
    ds_write_b64 v119, v[222:223] offset:1024
    s_waitcnt lgkmcnt(4)
    v_mfma_f32_16x16x32_bf16 v[138:141], v[32:35], v[114:117], 0
    s_waitcnt lgkmcnt(3)
    v_mul_f32 v166, 0x3baaaaab, v142
    v_or3_b32 v162, v162, v163, v164
    v_mfma_f32_16x16x32_bf16 v[138:141], v[32:35], v[134:137], v[138:141]
    ds_read_b64 v[170:171], v121 offset:1024
    v_rsq_f32 v166, v166
    v_or_b32 v162, v162, v165
    v_mul_f32 v190, v166, v190
    v_mul_f32 v191, v166, v191
    v_cvt_pk_bf16_f32 v114, v190, v191
    v_mul_f32 v192, v166, v192
    v_mul_f32 v193, v166, v193
    v_cvt_pk_bf16_f32 v115, v192, v193
    v_mul_f32 v194, v166, v194
    v_mul_f32 v195, v166, v195
    v_cvt_pk_bf16_f32 v116, v194, v195
    s_waitcnt lgkmcnt(2)
    buffer_store_dwordx4 v[126:129], v177, s[12:15], s26 offen nt
    v_mul_f32 v196, v166, v196
    v_mul_f32 v197, v166, v197
    v_cvt_pk_bf16_f32 v117, v196, v197
    ds_write_b128 v118, v[114:117] offset:1536
    v_mul_f32 v230, v166, v230
    s_waitcnt lgkmcnt(1)
    v_mul_f32 v231, v166, v231
    v_cvt_pk_bf16_f32 v230, v230, v231
    v_mul_f32 v232, v166, v232
    v_mul_f32 v233, v166, v233
    buffer_store_dwordx2 v[170:171], v182, s[12:15], s26 offen nt
    ds_read_b128 v[114:117], v120 offset:1536
    v_cvt_pk_bf16_f32 v231, v232, v233
    ds_write_b64 v119, v[230:231] offset:2560
    v_mul_f32 v163, 0x3baaaaab, v138
    v_rsq_f32 v163, v163
    ds_read_b64 v[164:165], v121 offset:2560
    v_mul_f32 v130, v163, v130
    v_mul_f32 v131, v163, v131
    v_cvt_pk_bf16_f32 v118, v130, v131
    v_mul_f32 v132, v163, v132
    v_mul_f32 v133, v163, v133
    v_cvt_pk_bf16_f32 v119, v132, v133
    v_mul_f32 v122, v163, v122
    v_mul_f32 v123, v163, v123
    v_cvt_pk_bf16_f32 v120, v122, v123
    v_mul_f32 v124, v163, v124
    v_mul_f32 v125, v163, v125
    v_cvt_pk_bf16_f32 v121, v124, v125
    buffer_store_dwordx4 v[118:121], v169, s[12:15], 0 offen nt
    s_waitcnt lgkmcnt(2)
    v_mul_f32 v206, v163, v206
    v_mul_f32 v207, v163, v207
    v_cvt_pk_bf16_f32 v170, v206, v207
    v_mul_f32 v208, v163, v208
    v_mul_f32 v209, v163, v209
    v_cvt_pk_bf16_f32 v171, v208, v209
    v_cmp_gt_i32 s[46:47], 0, v162
    s_waitcnt lgkmcnt(0)
    buffer_store_dwordx4 v[114:117], v172, s[12:15], 0 offen nt
    buffer_store_dwordx2 v[164:165], v254, s[12:15], 0 offen nt
    buffer_store_dwordx2 v[170:171], v255, s[12:15], 0 offen nt
    s_branch L_end
.section .rodata,"a"
.p2align 6
.amdhsa_kernel standalone__window_attn_swin_v2__vision_kernel
  .amdhsa_next_free_vgpr 512
  .amdhsa_next_free_sgpr 102
  .amdhsa_accum_offset 256
  .amdhsa_group_segment_fixed_size 0
  .amdhsa_kernarg_size 96
  .amdhsa_user_sgpr_count 2
  .amdhsa_user_sgpr_kernarg_segment_ptr 1
  .amdhsa_system_sgpr_workgroup_id_x 1
  .amdhsa_float_denorm_mode_32 3
.end_amdhsa_kernel
```

```asm
; @launch grid=(256,1,1) block=(256,1,1) lds=163840
.amdgcn_target "amdgcn-amd-amdhsa--gfx950"
.text
.globl standalone__window_attn_swin_v2__vision_kernel
.p2align 12
.p2align 8
.type standalone__window_attn_swin_v2__vision_kernel,@function
standalone__window_attn_swin_v2__vision_kernel:
    s_mov_b32 s44, 0
L_again:
    s_load_dwordx16 s[76:91], s[0:1], 0
    v_readfirstlane_b32 s16, v0
    s_cmp_ge_u32 s2, 256
    s_cbranch_scc1 L_done
    s_lshr_b32 s16, s16, 6
    s_cbranch_scc1 L_nopf
    s_getpc_b64 s[96:97]
    s_bfe_u32 s3, s2, 0x30003
    s_mul_i32 s3, s3, 44
    v_cmp_gt_u32 vcc, 20, v0
    v_add_u32 v114, s3, v0
    v_mov_b32 v115, 0
    v_cndmask_b32 v114, v114, v0, vcc
    v_lshlrev_b32 v114, 7, v114
    v_lshl_add_u64 v[114:115], s[96:97], 0, v[114:115]
    global_load_dword a255, v[114:115], off offset:992
L_nopf:
    s_max_u32 s3, s2, s44
    s_cmp_ge_u32 s3, 247
    s_cbranch_scc1 L_edge
    v_mov_b32 v114, v0
    v_mov_b32 v115, 0x40000000
    v_and_b32 v254, 63, v0
    s_bfe_u32 s3, s2, 0x50003
    s_lshl_b32 s4, s16, 3
    s_lshr_b32 s98, 0x06143a01, s4
    s_and_b32 s98, s98, 0xff
    s_mul_i32 s3, s3, s98
    s_sub_u32 s98, s98, 1
    s_lshr_b32 s4, 0x0048d800, s4
    s_and_b32 s4, s4, 0xff
    s_lshl_b32 s4, s4, 3
    s_max_u32 s4, s4, 6
    s_sub_u32 s4, s4, s98
    s_sub_u32 s4, s4, 1
    s_min_u32 s3, s3, s4
    v_min_u32 v126, s98, v254
    v_add_lshl_u32 v126, v126, s3, 7
    v_mov_b32 v127, 0
    v_lshrrev_b32 v255, 4, v254
    v_and_b32 v128, 15, v254
    s_mov_b32 s10, 100270464
    s_mov_b32 s11, 0x00020000
    s_mov_b32 s50, 36096
    s_mov_b32 s51, 0x00020000
    s_mul_i32 s3, s16, 96
    v_lshl_add_u32 v129, v254, 4, s3
    v_mul_u32_u24 v130, 171, v254
    v_lshrrev_b32 v130, 10, v130
    v_lshrrev_b32 v131, 1, v130
    v_xor_b32 v131, v131, v130
    v_and_b32 v131, 4, v131
    v_mul_u32_u24 v131, 3, v131
    v_xor_b32 v131, v131, v130
    v_mul_u32_u24 v131, 1152, v131
    v_mul_u32_u24 v132, 96, v130
    v_sub_u32 v131, v131, v132
    v_add_u32 v132, v129, v131
    v_add_u32 v131, 64, v254
    v_mul_u32_u24 v131, 171, v131
    v_lshrrev_b32 v131, 10, v131
    v_lshrrev_b32 v133, 1, v131
    v_xor_b32 v133, v133, v131
    v_and_b32 v133, 4, v133
    v_mul_u32_u24 v133, 3, v133
    v_xor_b32 v133, v133, v131
    v_mul_u32_u24 v133, 1152, v133
    v_mul_u32_u24 v150, 96, v131
    v_sub_u32 v133, v133, v150
    v_add_u32 v150, v129, v133
    v_add_u32 v133, 128, v254
    v_mul_u32_u24 v133, 171, v133
    v_lshrrev_b32 v133, 10, v133
    v_lshrrev_b32 v151, 1, v133
    v_xor_b32 v151, v151, v133
    v_and_b32 v151, 4, v151
    v_mul_u32_u24 v151, 3, v151
    v_xor_b32 v151, v151, v133
    v_mul_u32_u24 v151, 1152, v151
    v_mul_u32_u24 v152, 96, v133
    v_sub_u32 v151, v151, v152
    v_add_u32 v152, v129, v151
    s_mul_i32 s68, s16, 6144
    s_add_u32 s69, s68, 65536
    s_cmp_eq_u32 s16, 3
    s_cselect_b32 s68, 149696, s68
    s_cselect_b32 s69, 155840, s69
    s_waitcnt lgkmcnt(0)
    s_cmp_eq_u32 s16, 2
    s_cselect_b64 s[98:99], s[80:81], s[78:79]
    s_cmp_eq_u32 s16, 3
    s_cselect_b64 s[98:99], s[88:89], s[98:99]
    s_mov_b64 s[8:9], s[76:77]
    v_lshl_add_u64 v[126:127], s[98:99], 0, v[126:127]
    s_cmp_eq_u32 s16, 2
    s_cselect_b64 s[98:99], s[84:85], s[82:83]
    s_cmp_eq_u32 s16, 3
    s_cselect_b64 s[98:99], s[86:87], s[98:99]
    v_writelane_b32 v126, s98, 63
    v_writelane_b32 v127, s99, 63
    s_cmp_eq_u32 s16, 0
    s_cbranch_scc1 L_nowu
    global_load_dword a254, v[126:127], off
L_nowu:
    s_mov_b64 s[48:49], s[78:79]
    s_mov_b64 s[52:53], s[80:81]
    s_mov_b64 s[60:61], s[84:85]
    s_mov_b64 s[64:65], s[86:87]
    s_mov_b64 s[56:57], s[88:89]
    s_mov_b64 s[46:47], s[82:83]
    s_load_dwordx4 s[40:43], s[0:1], 72
    s_add_u32 s48, s48, 384
    s_addc_u32 s49, s49, 0
    s_add_u32 m0, s68, 0
    v_lshlrev_b32 v151, 1, v255
    s_mov_b32 s54, 12288
    s_mov_b32 s55, 0x00020000
    s_mov_b32 s62, 64
    s_mov_b32 s63, 0x00020000
    s_mov_b32 s66, 128
    s_mov_b32 s67, 0x00020000
    s_mov_b32 s58, 676
    s_mov_b32 s59, 0x00020000
    s_mov_b32 s14, 0
    s_mov_b32 s15, 0x00020000
    s_mul_i32 s90, s16, 16
    v_mov_b32 v117, 0
    v_cmp_lt_u32 s[92:93], 7, v128
    v_mov_b32 v127, 0
    v_mov_b32 v129, 0
    v_mov_b32 v119, 0
    v_lshlrev_b32 v153, 1, v254
    v_mul_u32_u24 v126, 12, v128
    s_mul_i32 s71, s16, 192
    v_add_u32 v126, s71, v126
    v_lshlrev_b32 v120, 5, v255
    s_mul_i32 s72, s16, 9408
    s_add_u32 s72, s72, 104448
    s_mul_i32 s73, s16, 7616
    s_add_u32 s73, s73, 38912
    s_cmp_eq_u32 s16, 3
    s_cselect_b32 s73, 142080, s73
    s_mov_b32 s70, 193536
    s_mov_b32 s36, 100270464
    s_mov_b32 s22, 1180032
    s_mul_i32 s3, s2, 911
    s_lshr_b32 s3, s3, 16
    s_mul_i32 s35, s3, 72
    s_sub_u32 s38, s2, s35
    s_mul_i32 s3, s3, 1373568
    s_mul_i32 s35, s38, 2688
    s_add_u32 s3, s3, s35
    s_add_u32 s25, s3, 589824
    s_add_u32 s7, s3, 1769472
    s_mov_b32 s20, 31
    s_mov_b32 s21, 4204032
    s_mov_b32 s17, 20
    s_cmp_lt_u32 s2, 240
    s_cselect_b32 s45, 28, 24
    s_bfm_b32 s34, s45, 0
    s_and_b32 s4, s2, 7
    s_sub_u32 s4, 0, s4
    s_lshl_b32 s28, s16, 10
    s_add_u32 s28, s28, 20480
    s_mov_b32 s76, 0x3f80
    s_mul_i32 s79, s16, 64
    s_mul_i32 s80, s16, 32
    s_add_u32 s80, s80, 256
    s_mul_i32 s81, s16, 768
    s_add_u32 s81, s81, 98304
    s_mov_b32 s82, -24
    s_lshr_b32 s83, s16, 1
    s_and_b32 s84, s16, 1
    s_lshl_b32 s84, s84, 3
    s_lshl_b32 s85, s83, 10
    s_add_u32 s85, s85, s84
    s_lshl_b32 s83, s83, 11
    s_add_u32 s83, s83, s84
    s_add_u32 s83, s83, 157888
    s_mul_i32 s86, s16, 2048
    s_add_u32 s86, s86, 149696
    s_mul_i32 s87, s16, 128
    s_add_u32 s87, s87, 61760
    s_mov_b32 s32, 0x2a8cbccc
    s_mov_b32 s33, 0x38fba882
    s_add_u32 s75, s28, 16384
    s_cmp_lt_u32 s16, 2
    s_cselect_b32 s29, s75, 161984
    s_cselect_b32 s30, 65536, 0
    s_xor_b32 s74, s29, s30
    s_mul_i32 s77, s16, 64
    s_mul_i32 s78, s16, 32
    s_add_u32 s78, s78, 192
    buffer_load_dwordx4 v132, s[48:51], 0 offen lds
    v_mul_u32_u24 v116, 2731, v114
    v_bfe_u32 v118, v116, 17, 3
    v_lshrrev_b32 v116, 16, v116
    buffer_load_dwordx4 v150, s[48:51], 0 offen offset:1024 lds
    v_xor_b32 v121, v118, v114
    v_mul_u32_u24 v118, 37, v116
    v_lshrrev_b32 v118, 8, v118
    buffer_load_dwordx4 v152, s[48:51], 0 offen offset:2048 lds
    s_add_u32 m0, s28, 65536
    s_add_u32 s48, s48, 36864
    s_addc_u32 s49, s49, 0
    v_lshlrev_b32 v121, 4, v121
    v_mad_u32_u24 v10, v118, s70, v121
    v_mul_u32_u24 v118, s20, v116
    v_add_u32 v118, s38, v118
    v_mul_u32_u24 v122, 911, v118
    v_lshrrev_b32 v122, 16, v122
    v_mul_u32_u24 v122, s22, v122
    v_mad_u32_u24 v122, v116, s21, v122
    v_bfe_u32 v118, s34, v116, 1
    v_cmp_ne_u32 vcc, 0, v118
    v_add_u32 v118, s7, v122
    v_mul_u32_u24 v116, 384, v116
    v_cndmask_b32 v118, v115, v118, vcc
    v_sub_u32 v116, v121, v116
    v_add_u32 v118, v118, v116
    buffer_load_dwordx4 v118, s[8:11], 0 offen nt lds
    s_add_u32 m0, s28, 69632
    v_add_u32 v116, 256, v114
    v_mul_u32_u24 v118, 2731, v116
    v_bfe_u32 v121, v118, 17, 3
    v_lshrrev_b32 v118, 16, v118
    v_xor_b32 v116, v121, v116
    v_mul_u32_u24 v121, 37, v118
    v_lshrrev_b32 v121, 8, v121
    v_lshlrev_b32 v116, 4, v116
    v_mad_u32_u24 v11, v121, s70, v116
    v_min_u32 v121, 20, v118
    v_add_u32 v122, 12, v118
    v_lshrrev_b32 v122, 5, v122
    v_sub_u32 v123, v118, v121
    v_mad_i32_i24 v123, v122, s4, v123
    v_mul_u32_u24 v124, s20, v121
    v_add3_u32 v124, v124, v123, s38
    v_mul_u32_u24 v122, 911, v124
    v_lshrrev_b32 v122, 16, v122
    v_mul_u32_u24 v122, s22, v122
    v_mad_u32_u24 v122, v121, s21, v122
    v_bfe_u32 v124, s34, v118, 1
    v_cmp_ne_u32 vcc, 0, v124
    v_mul_i32_i24 v123, 2688, v123
    v_add3_u32 v121, v122, v123, s7
    v_cndmask_b32 v121, v115, v121, vcc
    v_mul_u32_u24 v118, 384, v118
    v_sub_u32 v118, v116, v118
    v_add_u32 v121, v121, v118
    buffer_load_dwordx4 v121, s[8:11], 0 offen lds
    s_add_u32 m0, s28, 73728
    v_add_u32 v116, 512, v114
    v_mul_u32_u24 v118, 2731, v116
    v_bfe_u32 v121, v118, 17, 3
    v_lshrrev_b32 v118, 16, v118
    v_xor_b32 v116, v121, v116
    v_mul_u32_u24 v121, 37, v118
    v_lshrrev_b32 v121, 8, v121
    v_lshlrev_b32 v116, 4, v116
    v_mad_u32_u24 v12, v121, s70, v116
    v_min_u32 v121, 20, v118
    v_add_u32 v122, 12, v118
    v_lshrrev_b32 v122, 5, v122
    v_sub_u32 v123, v118, v121
    v_mad_i32_i24 v123, v122, s4, v123
    v_mul_u32_u24 v124, s20, v121
    v_add3_u32 v124, v124, v123, s38
    v_mul_u32_u24 v122, 911, v124
    v_lshrrev_b32 v122, 16, v122
    v_mul_u32_u24 v122, s22, v122
    v_mad_u32_u24 v122, v121, s21, v122
    v_bfe_u32 v124, s34, v118, 1
    v_cmp_ne_u32 vcc, 0, v124
    v_mul_i32_i24 v123, 2688, v123
    v_add3_u32 v121, v122, v123, s7
    v_cndmask_b32 v121, v115, v121, vcc
    v_mul_u32_u24 v118, 384, v118
    v_sub_u32 v118, v116, v118
    v_add_u32 v121, v121, v118
    buffer_load_dwordx4 v121, s[8:11], 0 offen lds
    s_add_u32 m0, s68, 3072
    v_lshrrev_b32 v116, 2, v128
    v_and_b32 v121, 1, v116
    v_mul_u32_u24 v121, 0x020202, v121
    v_lshl_or_b32 v121, v121, 8, v121
    v_add_u32 v121, 0x05040100, v121
    v_and_b32 v118, 3, v128
    v_lshrrev_b32 v122, 1, v128
    v_xor_b32 v122, v122, v255
    v_mul_u32_u24 v123, 384, v128
    v_lshl_add_u32 v0, v122, 4, v123
    v_xor_b32 v1, 64, v0
    v_and_b32 v122, 2, v255
    v_add_u32 v122, v122, v255
    v_lshl_add_u32 v122, v122, 2, v116
    v_mul_u32_u24 v122, 96, v122
    v_lshl_add_u32 v122, v118, 3, v122
    v_add_u32 v123, s68, v122
    buffer_load_dwordx4 v132, s[48:51], 0 offen lds
    v_add_u32 v124, s69, v122
    v_add_u32 v125, s72, v122
    v_add_u32 v122, s73, v122
    v_mov_b32 v28, 0x3f803f80
    v_mov_b32 v29, 0x3f803f80
    v_mov_b32 v30, 0x3f803f80
    v_mov_b32 v31, 0x3f803f80
    v_mul_u32_u24 v134, 768, v255
    v_add_u32 v134, v126, v134
    v_add_u32 v134, 98304, v134
    v_and_b32 v135, 1, v128
    v_lshlrev_b32 v135, 4, v135
    v_lshlrev_b32 v136, v135, s76
    v_mov_b32 v137, 0x3c003c00
    v_mov_b32 v44, 1.0
    v_lshlrev_b32 v138, 4, v255
    v_lshl_add_u32 v139, v255, 4, s79
    v_lshl_add_u32 v140, v255, 3, s80
    buffer_load_dwordx4 v150, s[48:51], 0 offen offset:1024 lds
    v_add_u32 v141, 0, v128
    v_mul_u32_u24 v142, 37, v141
    v_mul_u32_u24 v143, 384, v141
    v_lshrrev_b32 v142, 8, v142
    v_mad_u32_u24 v143, v142, s70, v143
    v_add_u32 v15, v143, v139
    v_add_u32 v18, v143, v140
    v_add_u32 v143, 16, v128
    v_mul_u32_u24 v144, 37, v143
    v_mul_u32_u24 v145, 384, v143
    v_lshrrev_b32 v144, 8, v144
    v_mad_u32_u24 v145, v144, s70, v145
    v_add_u32 v16, v145, v139
    v_add_u32 v19, v145, v140
    v_add_u32 v145, 32, v128
    v_mul_u32_u24 v146, 37, v145
    v_mul_u32_u24 v147, 384, v145
    v_lshrrev_b32 v146, 8, v146
    v_mad_u32_u24 v147, v146, s70, v147
    v_add_u32 v17, v147, v139
    v_add_u32 v20, v147, v140
    v_mul_u32_u24 v142, 24, v142
    v_lshl_add_u32 v142, v141, 2, v142
    v_add_u32 v22, s81, v142
    v_sub_u32 v23, s81, v142
    v_sub_u32 v139, v22, v138
    v_mul_u32_u24 v140, 24, v144
    v_lshl_add_u32 v140, v143, 2, v140
    v_add_u32 v24, s81, v140
    v_sub_u32 v25, s81, v140
    v_sub_u32 v140, v24, v138
    v_mul_u32_u24 v141, 24, v146
    v_lshl_add_u32 v141, v145, 2, v141
    v_add_u32 v26, s81, v141
    v_sub_u32 v27, s81, v141
    v_sub_u32 v141, v26, v138
    v_mul_u32_u24 v142, 148, v255
    v_add_u32 v143, 0, v142
    v_lshrrev_b32 v143, 8, v143
    v_mad_i32_i24 v46, v143, s82, v139
    v_mad_i32_i24 v58, v143, s82, v140
    v_mad_i32_i24 v70, v143, s82, v141
    v_add_u32 v143, 37, v142
    v_lshrrev_b32 v143, 8, v143
    v_mad_i32_i24 v47, v143, s82, v139
    v_mad_i32_i24 v59, v143, s82, v140
    v_mad_i32_i24 v71, v143, s82, v141
    v_add_u32 v143, 74, v142
    v_lshrrev_b32 v143, 8, v143
    v_mad_i32_i24 v48, v143, s82, v139
    v_mad_i32_i24 v60, v143, s82, v140
    v_mad_i32_i24 v72, v143, s82, v141
    v_add_u32 v143, 111, v142
    v_lshrrev_b32 v143, 8, v143
    v_mad_i32_i24 v49, v143, s82, v139
    v_mad_i32_i24 v61, v143, s82, v140
    v_mad_i32_i24 v73, v143, s82, v141
    v_add_u32 v143, 592, v142
    v_lshrrev_b32 v143, 8, v143
    v_mad_i32_i24 v50, v143, s82, v139
    v_mad_i32_i24 v62, v143, s82, v140
    v_mad_i32_i24 v74, v143, s82, v141
    v_add_u32 v143, 629, v142
    v_lshrrev_b32 v143, 8, v143
    v_mad_i32_i24 v51, v143, s82, v139
    v_mad_i32_i24 v63, v143, s82, v140
    v_mad_i32_i24 v75, v143, s82, v141
    v_add_u32 v143, 666, v142
    v_lshrrev_b32 v143, 8, v143
    v_mad_i32_i24 v52, v143, s82, v139
    v_mad_i32_i24 v64, v143, s82, v140
    v_mad_i32_i24 v76, v143, s82, v141
    v_add_u32 v143, 703, v142
    v_lshrrev_b32 v143, 8, v143
    v_mad_i32_i24 v53, v143, s82, v139
    v_mad_i32_i24 v65, v143, s82, v140
    v_mad_i32_i24 v77, v143, s82, v141
    v_add_u32 v143, 1184, v142
    v_lshrrev_b32 v143, 8, v143
    v_mad_i32_i24 v54, v143, s82, v139
    v_mad_i32_i24 v66, v143, s82, v140
    v_mad_i32_i24 v78, v143, s82, v141
    v_add_u32 v143, 1221, v142
    v_lshrrev_b32 v143, 8, v143
    v_mad_i32_i24 v55, v143, s82, v139
    v_mad_i32_i24 v67, v143, s82, v140
    v_mad_i32_i24 v79, v143, s82, v141
    v_add_u32 v143, 1258, v142
    v_lshrrev_b32 v143, 8, v143
    v_mad_i32_i24 v56, v143, s82, v139
    v_mad_i32_i24 v68, v143, s82, v140
    v_mad_i32_i24 v80, v143, s82, v141
    v_add_u32 v142, 1295, v142
    v_lshrrev_b32 v142, 8, v142
    v_mad_i32_i24 v57, v142, s82, v139
    v_mad_i32_i24 v69, v142, s82, v140
    v_mad_i32_i24 v81, v142, s82, v141
    v_mov_b32 v139, s81
    v_lshlrev_b32 v140, 4, v254
    v_xor_b32 v2, 65536, v140
    v_lshl_add_u32 v3, s16, 10, v140
    v_add_u32 v4, s85, v140
    v_lshl_add_u32 v140, v255, 3, s86
    v_mov_b32 v141, s83
    v_mov_b32 v142, 163264
    v_mul_u32_u24 v143, 80, v255
    v_add3_u32 v154, v143, v135, s72
    v_add_u32 v5, s72, v143
    v_lshl_add_u32 v6, v128, 2, s73
    v_add_u32 v9, s87, v138
    v_lshrrev_b32 v135, 1, v255
    v_mul_u32_u24 v135, 48, v135
    v_lshl_add_u32 v135, v255, 3, v135
    v_lshl_add_u32 v135, v116, 4, v135
    v_lshl_add_u32 v135, v118, 1, v135
    v_add_u32 v8, s87, v135
    v_mov_b32 v37, 0
    v_mov_b32 v38, 0
    buffer_load_dwordx4 v152, s[48:51], 0 offen offset:2048 lds
    s_add_u32 s48, s48, 36864
    s_addc_u32 s49, s49, 0
    s_add_u32 m0, s69, 0
    v_mov_b32 v39, 0
    v_add_u32 v155, 86016, v0
    v_add_u32 v156, 86016, v1
    v_lshlrev_b32 v157, 4, v128
    v_add_u32 v157, 161984, v157
    v_mul_u32_u24 v135, 336, v128
    v_add3_u32 v135, v135, v143, s72
    v_mul_u32_u24 v143, 272, v128
    v_add3_u32 v143, v143, v138, s73
    v_mul_u32_u24 v158, 1088, v255
    v_add_u32 v158, v158, v6
    v_add_u32 v159, 5376, v135
    v_add_u32 v160, 4352, v143
    v_add_u32 v161, 4352, v158
    v_cmp_gt_u32 s[88:89], 16, v254
    buffer_load_dwordx4 v132, s[48:51], 0 offen lds
    v_mov_b32 v144, 0xf149f2ca
    v_add_u32 v145, 768, v114
    v_mul_u32_u24 v146, 2731, v145
    v_bfe_u32 v147, v146, 17, 3
    v_lshrrev_b32 v146, 16, v146
    v_xor_b32 v145, v147, v145
    v_mul_u32_u24 v147, 37, v146
    v_lshrrev_b32 v147, 8, v147
    v_lshlrev_b32 v145, 4, v145
    v_mad_u32_u24 v13, v147, s70, v145
    v_add_u32 v114, 1024, v114
    v_mul_u32_u24 v145, 2731, v114
    v_bfe_u32 v146, v145, 17, 3
    s_waitcnt vmcnt(7)
    ds_read_b64_tr_b16 a[72:73], v123 offset:0
    ds_read_b64_tr_b16 a[74:75], v123 offset:768
    ds_read_b64_tr_b16 a[96:97], v123 offset:32
    ds_read_b64_tr_b16 a[98:99], v123 offset:800
    ds_read_b64_tr_b16 a[120:121], v123 offset:64
    buffer_load_dwordx4 v150, s[48:51], 0 offen offset:1024 lds
    ds_read_b64_tr_b16 a[122:123], v123 offset:832
    v_lshrrev_b32 v145, 16, v145
    v_xor_b32 v114, v146, v114
    v_mul_u32_u24 v146, 37, v145
    v_lshrrev_b32 v146, 8, v146
    v_lshlrev_b32 v114, 4, v114
    v_mad_u32_u24 v14, v146, s70, v114
    v_cmp_gt_u32 vcc, 48, v145
    v_mul_u32_u24 v145, 6, v130
    v_sub_u32 v114, v254, v145
    v_cndmask_b32 v14, v115, v14, vcc
    v_cmp_gt_u32 vcc, 2, v118
    v_mul_u32_u24 v145, 384, v130
    v_lshl_add_u32 v145, v114, 4, v145
    v_cndmask_b32 v32, 0, v136, vcc
    v_cndmask_b32 v33, v136, 0, vcc
    v_cndmask_b32 v34, 0, v136, vcc
    v_cndmask_b32 v35, v136, 0, vcc
    buffer_load_dwordx4 v152, s[48:51], 0 offen offset:2048 lds
    s_add_u32 s48, s48, 36864
    s_addc_u32 s49, s49, 0
    s_add_u32 m0, s69, 3072
    v_cmp_eq_u32 vcc, 0, v118
    v_add_u32 v115, s78, v145
    v_add_u32 v145, s77, v145
    v_cndmask_b32 v40, 0, v137, vcc
    v_cmp_eq_u32 vcc, 1, v118
    v_mul_u32_u24 v136, 6, v131
    v_sub_u32 v130, v254, v136
    v_cndmask_b32 v41, 0, v137, vcc
    v_cmp_eq_u32 vcc, 2, v118
    v_mul_u32_u24 v136, 384, v131
    v_lshl_add_u32 v136, v130, 4, v136
    v_cndmask_b32 v42, 0, v137, vcc
    v_cmp_eq_u32 vcc, 3, v118
    v_add_u32 v131, s78, v136
    v_add_u32 v136, s77, v136
    v_cndmask_b32 v43, 0, v137, vcc
    v_cmp_eq_u32 vcc, v255, v116
    v_mul_u32_u24 v137, 6, v133
    v_sub_u32 v254, v254, v137
    v_cndmask_b32 v162, 0, v32, vcc
    v_cndmask_b32 v163, 0, v33, vcc
    v_cmp_gt_i32 vcc, 4, v114
    v_mul_u32_u24 v137, 384, v133
    v_lshl_add_u32 v137, v254, 4, v137
    v_cndmask_b32 v164, v115, v145, vcc
    v_cmp_gt_i32 vcc, -60, v130
    v_add_u32 v145, s78, v137
    v_add_u32 v137, s77, v137
    v_cndmask_b32 v165, v131, v136, vcc
    v_cmp_gt_i32 vcc, -124, v254
    v_mul_u32_u24 v254, 96, v128
    v_add3_u32 v130, v254, v138, s68
    v_cndmask_b32 v131, v145, v137, vcc
    v_cmp_gt_u32 vcc, 2, v255
    v_lshl_add_u32 v133, v255, 3, v254
    v_add3_u32 v133, v133, 64, s68
    v_cndmask_b32 v140, v141, v140, vcc
    v_lshl_add_u32 v140, v116, 9, v140
    v_lshl_add_u32 v140, v118, 1, v140
    v_cmp_gt_u32 vcc, 3, v255
    v_add3_u32 v114, v254, v138, s69
    v_lshl_add_u32 v254, v255, 3, v254
    v_cndmask_b32 v7, v142, v140, vcc
    v_cmp_gt_u32 vcc, 12, v128
    v_add3_u32 v254, v254, 64, s69
    v_add_u32 v118, 16, v128
    v_cndmask_b32 v159, v157, v159, vcc
    v_cndmask_b32 v160, v157, v160, vcc
    v_cmp_gt_u32 vcc, 3, v255
    v_cmp_gt_u32 s[94:95], s45, v118
    v_cndmask_b32 v255, v157, v143, s[88:89]
    v_cndmask_b32 v161, v157, v161, vcc
    v_cndmask_b32 v157, v157, v160, s[88:89]
    v_add_u32 v5, 336, v5
    buffer_load_dwordx4 v132, s[48:51], 0 offen lds
    buffer_load_dwordx4 v150, s[48:51], 0 offen offset:1024 lds
    buffer_load_dwordx4 v152, s[48:51], 0 offen offset:2048 lds
    s_waitcnt vmcnt(9)
    s_barrier
    ds_read_b128 v[146:149], v155 offset:6144
    ds_read_b128 v[166:169], v156 offset:6144
    ds_read_b128 v[170:173], v155 offset:6272
    s_add_u32 s48, s48, 36864
    s_addc_u32 s49, s49, 0
    ds_read_b128 v[174:177], v156 offset:6272
    s_add_u32 m0, s72, 0
    ds_read_b128 v[178:181], v155 offset:6400
    ds_read_b128 v[182:185], v156 offset:6400
    ds_read_b128 v[186:189], v155 offset:0
    buffer_load_ushort v116, v153, s[60:63], 0 offen
    s_mov_b64 s[60:61], s[8:9]
    ds_read_b128 v[190:193], v156 offset:0
    ds_read_b128 v[194:197], v155 offset:128
    ds_read_b128 v[198:201], v156 offset:128
    s_waitcnt lgkmcnt(7)
    v_mfma_f32_16x16x32_bf16 v[202:205], a[72:75], v[146:149], 0
    buffer_load_dwordx3 v[206:208], v126, s[56:59], 0 offen
    ds_read_b128 v[210:213], v155 offset:256
    v_mfma_f32_16x16x32_bf16 v[214:217], a[96:99], v[146:149], 0
    s_waitcnt lgkmcnt(7)
    ds_read_b128 v[218:221], v156 offset:256
    v_mfma_f32_16x16x32_bf16 v[222:225], a[120:123], v[146:149], 0
    s_waitcnt lgkmcnt(7)
    ds_read_b128 v[146:149], v155 offset:6144
    s_waitcnt lgkmcnt(6)
    v_mfma_f32_16x16x32_bf16 v[226:229], a[72:75], v[186:189], 0
    v_mfma_f32_16x16x32_bf16 v[230:233], a[96:99], v[186:189], 0
    s_waitcnt vmcnt(8)
    buffer_load_dwordx4 v[234:237], v120, s[64:67], 0 offen
    ds_read_b64_tr_b16 a[76:77], v123 offset:3072
    ds_read_b64_tr_b16 a[78:79], v123 offset:3840
    ds_read_b64_tr_b16 a[100:101], v123 offset:3104
    ds_read_b64_tr_b16 a[102:103], v123 offset:3872
    ds_read_b64_tr_b16 a[124:125], v123 offset:3136
    ds_read_b64_tr_b16 a[126:127], v123 offset:3904
    s_mov_b32 s19, s38
    s_mov_b32 s23, s25
    s_mov_b32 s26, 0
    s_mov_b32 s27, 0
    s_mov_b32 s18, 0
    s_add_u32 s19, s19, s20
    s_add_u32 s23, s23, s21
    s_cmp_ge_u32 s19, 72
    s_cselect_b32 s34, 72, 0
    s_cselect_b32 s35, s22, 0
    s_sub_u32 s19, s19, s34
    s_add_u32 s23, s23, s35
    s_mov_b32 s24, s23
    s_add_u32 s19, s19, s20
    s_add_u32 s23, s23, s21
    s_cmp_ge_u32 s19, 72
    s_cselect_b32 s34, 72, 0
    s_cselect_b32 s35, s22, 0
    s_sub_u32 s19, s19, s34
    s_add_u32 s23, s23, s35
    s_sub_u32 s62, s45, s17
    s_sub_u32 s45, s17, 1
    s_bfm_b32 s70, s17, 0
    s_waitcnt lgkmcnt(4)
    v_mfma_f32_16x16x32_bf16 v[202:205], a[76:79], v[166:169], v[202:205]
    s_waitcnt lgkmcnt(2)
    global_load_ushort v151, v151, s[46:47]
    s_mov_b32 s71, 1
    v_mfma_f32_16x16x32_bf16 v[214:217], a[100:103], v[166:169], v[214:217]
    s_waitcnt lgkmcnt(0)
    buffer_load_dwordx4 v132, s[48:51], 0 offen lds
    s_and_b32 s77, s2, 0xf8
    v_mfma_f32_16x16x32_bf16 v[222:225], a[124:127], v[166:169], v[222:225]
    s_add_u32 s77, s77, 4940
    ds_read_b128 v[166:169], v156 offset:6144
    s_mul_i32 s78, s77, 58255
    v_mfma_f32_16x16x32_bf16 v[226:229], a[76:79], v[190:193], v[226:229]
    s_lshr_b32 s78, s78, 22
    s_add_u32 s34, s18, 2
    s_mov_b32 s18, 1
    v_mfma_f32_16x16x32_bf16 v[230:233], a[100:103], v[190:193], v[230:233]
    s_mov_b32 s27, s26
    s_mov_b32 s26, s25
    s_add_u32 s19, s19, s20
    s_waitcnt vmcnt(8)
    ds_read_b64_tr_b16 a[80:81], v124 offset:0
    ds_read_b64_tr_b16 a[82:83], v124 offset:768
    ds_read_b64_tr_b16 a[104:105], v124 offset:32
    ds_read_b64_tr_b16 a[106:107], v124 offset:800
    ds_read_b64_tr_b16 a[128:129], v124 offset:64
    ds_read_b64_tr_b16 a[130:131], v124 offset:832
    buffer_load_dwordx4 v150, s[48:51], 0 offen offset:1024 lds
    buffer_load_dwordx4 v152, s[48:51], 0 offen offset:2048 lds
    s_add_u32 s48, s48, 36864
    s_waitcnt lgkmcnt(4)
    v_mfma_f32_16x16x32_bf16 v[202:205], a[80:83], v[170:173], v[202:205]
    s_waitcnt lgkmcnt(2)
    s_addc_u32 s49, s49, 0
    s_add_u32 m0, s72, 3072
    v_mfma_f32_16x16x32_bf16 v[214:217], a[104:107], v[170:173], v[214:217]
    s_waitcnt lgkmcnt(0)
    s_mov_b32 s72, 2
    v_mfma_f32_16x16x32_bf16 v[222:225], a[128:131], v[170:173], v[222:225]
    ds_read_b128 v[170:173], v155 offset:6272
    v_mfma_f32_16x16x32_bf16 v[226:229], a[80:83], v[194:197], v[226:229]
    v_mfma_f32_16x16x32_bf16 v[230:233], a[104:107], v[194:197], v[230:233]
    buffer_load_dwordx4 v132, s[48:51], 0 offen lds
    s_waitcnt vmcnt(8)
    ds_read_b64_tr_b16 a[84:85], v124 offset:3072
    ds_read_b64_tr_b16 a[86:87], v124 offset:3840
    ds_read_b64_tr_b16 a[108:109], v124 offset:3104
    ds_read_b64_tr_b16 a[110:111], v124 offset:3872
    ds_read_b64_tr_b16 a[132:133], v124 offset:3136
    ds_read_b64_tr_b16 a[134:135], v124 offset:3904
    s_waitcnt vmcnt(6)
    v_bfe_u32 v126, v206, v138, 16
    v_bfe_u32 v128, v207, v138, 16
    v_bfe_u32 v118, v208, v138, 16
    buffer_load_dwordx4 v150, s[48:51], 0 offen offset:1024 lds
    s_waitcnt vmcnt(6)
    v_cndmask_b32 v234, v234, v235, s[92:93]
    v_mfma_f32_16x16x16_bf16 v[206:209], v[116:117], v[126:127], 0
    v_cndmask_b32 v236, v236, v237, s[92:93]
    v_perm_b32 v136, v236, v234, v121
    v_mfma_f32_16x16x16_bf16 v[234:237], v[116:117], v[128:129], 0
    s_waitcnt lgkmcnt(4)
    v_mfma_f32_16x16x32_bf16 v[202:205], a[84:87], v[174:177], v[202:205]
    s_waitcnt lgkmcnt(0)
    v_mfma_f32_16x16x32_bf16 v[214:217], a[108:111], v[174:177], v[214:217]
    buffer_load_dwordx4 v152, s[48:51], 0 offen offset:2048 lds
    v_max_f32 v206, 0, v206
    v_mfma_f32_16x16x32_bf16 v[222:225], a[132:135], v[174:177], v[222:225]
    s_sub_u32 s48, s48, 184704
    ds_read_b128 v[126:129], v156 offset:6272
    v_max_f32 v207, 0, v207
    v_mfma_f32_16x16x32_bf16 v[226:229], a[84:87], v[198:201], v[226:229]
    s_subb_u32 s49, s49, 0
    v_max_f32 v208, 0, v208
    v_max_f32 v209, 0, v209
    v_mfma_f32_16x16x32_bf16 v[230:233], a[108:111], v[198:201], v[230:233]
    s_add_u32 m0, s73, 0
    v_cvt_pk_bf16_f32 v140, v206, v207
    v_cvt_pk_bf16_f32 v141, v208, v209
    v_max_f32 v234, 0, v234
    v_mfma_f32_16x16x16_bf16 v[174:177], v[116:117], v[118:119], 0
    v_max_f32 v235, 0, v235
    s_waitcnt vmcnt(6)
    v_lshlrev_b32 v151, 16, v151
    v_max_f32 v151, 0xc2c80000, v151
    v_mfma_f32_16x16x32_bf16 v[206:209], a[120:123], v[186:189], 0
    buffer_load_dwordx4 v[186:189], v120, s[64:67], 0 offen offset:16
    v_min_f32 v151, 0x40930000, v151
    v_mfma_f32_16x16x32_bf16 v[206:209], a[124:127], v[190:193], v[206:209]
    buffer_load_dwordx4 v132, s[48:51], 0 offen lds
    ds_read_b128 v[190:193], v155 offset:0
    v_mfma_f32_16x16x32_bf16 v[206:209], a[128:131], v[194:197], v[206:209]
    ds_read_b128 v[194:197], v156 offset:0
    v_mul_f32 v151, 0x3fb8aa3b, v151
    v_mfma_f32_16x16x32_bf16 v[206:209], a[132:135], v[198:201], v[206:209]
    s_waitcnt lgkmcnt(2)
    ds_read_b128 v[198:201], v155 offset:128
    v_exp_f32 v151, v151
    v_max_f32 v236, 0, v236
    v_cvt_pk_bf16_f32 v151, v151, v151
    v_and_b32 v151, 0xffff0000, v151
    v_mul_f32 v151, 0x3fb8aa3b, v151
    v_mul_f32 v138, 0xbea8f5c3, v151
    v_add_f32 v138, 0xc138aa3b, v138
    v_readlane_b32 s31, v151, s90
    v_max_f32 v237, 0, v237
    buffer_load_dwordx4 v150, s[48:51], 0 offen offset:1024 lds
    v_cvt_pk_bf16_f32 v116, v234, v235
    v_cvt_pk_bf16_f32 v117, v236, v237
    v_max_f32 v174, 0, v174
    v_max_f32 v175, 0, v175
    v_max_f32 v176, 0, v176
    v_max_f32 v177, 0, v177
    v_cvt_pk_bf16_f32 v118, v174, v175
    v_cvt_pk_bf16_f32 v119, v176, v177
    ds_read_b128 v[174:177], v156 offset:128
    buffer_load_dwordx4 v152, s[48:51], 0 offen offset:2048 lds
    s_add_u32 s48, s48, 36864
    s_waitcnt vmcnt(7)
    ds_read_b64_tr_b16 a[88:89], v125 offset:0
    ds_read_b64_tr_b16 a[90:91], v125 offset:768
    ds_read_b64_tr_b16 a[112:113], v125 offset:32
    ds_read_b64_tr_b16 a[114:115], v125 offset:800
    ds_read_b64_tr_b16 a[136:137], v125 offset:64
    ds_read_b64_tr_b16 a[138:139], v125 offset:832
    s_addc_u32 s49, s49, 0
    s_add_u32 m0, s73, 3072
    s_mov_b32 s73, 3
    buffer_load_dwordx4 v132, s[48:51], 0 offen lds
    s_waitcnt lgkmcnt(4)
    v_mfma_f32_16x16x32_bf16 v[202:205], a[88:91], v[178:181], v[202:205]
    s_waitcnt lgkmcnt(3)
    v_mfma_f32_16x16x32_bf16 v[226:229], a[88:91], v[210:213], v[226:229]
    s_waitcnt lgkmcnt(0)
    v_mfma_f32_16x16x32_bf16 v[214:217], a[112:115], v[178:181], v[214:217]
    buffer_load_dwordx4 v150, s[48:51], 0 offen offset:1024 lds
    v_mfma_f32_16x16x32_bf16 v[222:225], a[136:139], v[178:181], v[222:225]
    ds_read_b128 v[178:181], v155 offset:6400
    v_mfma_f32_16x16x32_bf16 v[230:233], a[112:115], v[210:213], v[230:233]
    v_mfma_f32_16x16x32_bf16 v[206:209], a[136:139], v[210:213], v[206:209]
    ds_read_b128 v[210:213], v155 offset:256
    s_waitcnt vmcnt(6)
    ds_read_b64_tr_b16 a[92:93], v125 offset:3072
    ds_read_b64_tr_b16 a[94:95], v125 offset:3840
    ds_read_b64_tr_b16 a[116:117], v125 offset:3104
    ds_read_b64_tr_b16 a[118:119], v125 offset:3872
    buffer_load_dwordx4 v152, s[48:51], 0 offen offset:2048 lds
    ds_read_b64_tr_b16 a[140:141], v125 offset:3136
    ds_read_b64_tr_b16 a[142:143], v125 offset:3904
    s_add_u32 s48, s48, 36864
    s_addc_u32 s49, s49, 0
    s_add_u32 m0, s68, 0
    v_mov_b32 v234, 0
    v_mov_b32 v235, 0
    v_mov_b32 v236, 0
    v_mov_b32 v237, 0
    v_mov_b32 v238, v144
    v_mov_b32 v239, v144
    v_mov_b32 v240, v144
    v_mov_b32 v241, v144
    s_waitcnt vmcnt(6)
    v_cndmask_b32 v186, v186, v187, s[92:93]
    buffer_load_dwordx4 v132, s[48:51], 0 offen lds
    v_cndmask_b32 v188, v188, v189, s[92:93]
    v_perm_b32 v137, v188, v186, v121
    s_waitcnt lgkmcnt(4)
    v_mfma_f32_16x16x32_bf16 v[202:205], a[92:95], v[182:185], v[202:205]
    s_waitcnt lgkmcnt(3)
    v_mfma_f32_16x16x32_bf16 v[226:229], a[92:95], v[218:221], v[226:229]
    s_waitcnt lgkmcnt(0)
    v_mfma_f32_16x16x32_bf16 v[214:217], a[116:119], v[182:185], v[214:217]
    v_mfma_f32_16x16x32_bf16 v[222:225], a[140:143], v[182:185], v[222:225]
    v_mfma_f32_16x16x32_bf16 v[230:233], a[116:119], v[218:221], v[230:233]
    buffer_load_dwordx4 v150, s[48:51], 0 offen offset:1024 lds
    v_mfma_f32_16x16x32_bf16 v[206:209], a[140:143], v[218:221], v[206:209]
    ds_read_b128 v[182:185], v156 offset:6400
    v_cvt_pk_f16_f32 v186, v202, v203
    v_pk_mul_f16 v203, v186, v186
    v_cvt_pk_f16_f32 v187, v204, v205
    v_pk_fma_f16 v203, v187, v187, v203
    v_cvt_pk_f16_f32 v188, v214, v215
    v_mfma_f32_16x16x16_bf16 v[218:221], v[136:137], v[140:141], 0
    v_pk_fma_f16 v203, v188, v188, v203
    v_cvt_pk_f16_f32 v189, v216, v217
    v_pk_fma_f16 v203, v189, v189, v203
    v_mfma_f32_16x16x16_bf16 v[214:217], v[136:137], v[116:117], 0
    v_cvt_pk_f16_f32 v120, v222, v223
    v_pk_fma_f16 v203, v120, v120, v203
    v_cvt_pk_f16_f32 v121, v224, v225
    v_mfma_f32_16x16x16_bf16 v[222:225], v[136:137], v[118:119], 0
    buffer_load_dwordx4 v152, s[48:51], 0 offen offset:2048 lds
    ds_read_b128 v[242:245], v156 offset:256
    s_add_u32 s48, s48, 36864
    s_addc_u32 s49, s49, 0
    s_add_u32 m0, s68, 3072
    v_cvt_pk_bf16_f32 v218, v218, v218
    v_and_b32 v218, 0xffff0000, v218
    s_waitcnt vmcnt(6)
    ds_read_b64_tr_b16 a[0:1], v122 offset:0
    ds_read_b64_tr_b16 a[2:3], v122 offset:768
    ds_read_b64_tr_b16 a[24:25], v122 offset:32
    ds_read_b64_tr_b16 a[26:27], v122 offset:800
    ds_read_b64_tr_b16 a[48:49], v122 offset:64
    ds_read_b64_tr_b16 a[50:51], v122 offset:832
    v_mul_f32 v218, 0xbfb8aa3b, v218
    v_exp_f32 v218, v218
    v_cvt_pk_bf16_f32 v214, v214, v214
    buffer_load_dwordx4 v132, s[48:51], 0 offen lds
    v_add_f32 v218, 1.0, v218
    v_rcp_f32 v218, v218
    v_and_b32 v214, 0xffff0000, v214
    v_cvt_pk_bf16_f32 v218, v218, v218
    v_and_b32 v218, 0xffff0000, v218
    v_fmamk_f32 v218, v218, 0x41b8aa3b, v138
    ds_write_b32 v134, v218 offset:0
    v_mul_f32 v214, 0xbfb8aa3b, v214
    v_exp_f32 v214, v214
    v_cvt_pk_bf16_f32 v222, v222, v222
    v_add_f32 v214, 1.0, v214
    s_waitcnt lgkmcnt(5)
    v_mfma_f32_16x16x32_bf16 v[218:221], a[0:3], v[146:149], 0
    s_waitcnt lgkmcnt(3)
    v_rcp_f32 v214, v214
    v_mfma_f32_16x16x32_bf16 v[246:249], a[24:27], v[146:149], 0
    s_waitcnt lgkmcnt(1)
    buffer_load_dwordx4 v150, s[48:51], 0 offen offset:1024 lds
    v_cvt_pk_bf16_f32 v214, v214, v214
    v_and_b32 v214, 0xffff0000, v214
    v_fmamk_f32 v214, v214, 0x41b8aa3b, v138
    ds_write_b32 v134, v214 offset:4
    v_and_b32 v222, 0xffff0000, v222
    v_mul_f32 v222, 0xbfb8aa3b, v222
    v_exp_f32 v222, v222
    v_pk_fma_f16 v203, v121, v121, v203
    v_add_f32 v222, 1.0, v222
    v_rcp_f32 v222, v222
    v_cvt_pk_f16_f32 v214, v226, v227
    s_waitcnt vmcnt(5)
    ds_read_b64_tr_b16 a[4:5], v122 offset:3072
    ds_read_b64_tr_b16 a[6:7], v122 offset:3840
    buffer_load_dwordx4 v152, s[48:51], 0 offen offset:2048 lds
    ds_read_b64_tr_b16 a[28:29], v122 offset:3104
    ds_read_b64_tr_b16 a[30:31], v122 offset:3872
    ds_read_b64_tr_b16 a[52:53], v122 offset:3136
    ds_read_b64_tr_b16 a[54:55], v122 offset:3904
    v_mfma_f32_16x16x32_bf16 v[250:253], a[48:51], v[146:149], 0
    s_add_u32 s48, s48, 36864
    ds_write_b128 v135, v[234:237] offset:16
    v_mfma_f32_16x16x32_bf16 v[146:149], a[0:3], v[190:193], 0
    s_addc_u32 s49, s49, 0
    s_add_u32 m0, s69, 0
    v_cvt_pk_bf16_f32 v222, v222, v222
    v_and_b32 v222, 0xffff0000, v222
    v_fmamk_f32 v222, v222, 0x41b8aa3b, v138
    v_pk_mul_f16 v223, v214, v214
    buffer_load_dwordx4 v132, s[48:51], 0 offen lds
    ds_write_b32 v134, v222 offset:8
    v_cvt_pk_f16_f32 v215, v228, v229
    v_pk_fma_f16 v223, v215, v215, v223
    v_cvt_pk_f16_f32 v216, v230, v231
    v_mfma_f32_16x16x32_bf16 v[226:229], a[24:27], v[190:193], 0
    s_waitcnt lgkmcnt(6)
    v_pk_fma_f16 v223, v216, v216, v223
    v_cvt_pk_f16_f32 v217, v232, v233
    v_mfma_f32_16x16x32_bf16 v[218:221], a[4:7], v[166:169], v[218:221]
    s_waitcnt lgkmcnt(2)
    ds_write_b64 v135, v[234:235] offset:56
    v_mfma_f32_16x16x32_bf16 v[246:249], a[28:31], v[166:169], v[246:249]
    v_pk_fma_f16 v223, v217, v217, v223
    v_cvt_pk_f16_f32 v140, v206, v207
    v_mfma_f32_16x16x32_bf16 v[250:253], a[52:55], v[166:169], v[250:253]
    buffer_load_dwordx4 v150, s[48:51], 0 offen offset:1024 lds
    v_pk_fma_f16 v223, v140, v140, v223
    v_mfma_f32_16x16x32_bf16 v[146:149], a[4:7], v[194:197], v[146:149]
    ds_write_b64 v135, v[234:235] offset:64
    v_mfma_f32_16x16x32_bf16 v[226:229], a[28:31], v[194:197], v[226:229]
    s_waitcnt lgkmcnt(2)
    v_cvt_pk_f16_f32 v141, v208, v209
    v_pk_fma_f16 v223, v141, v141, v223
    v_mfma_f32_16x16x32_bf16 v[166:169], a[48:51], v[190:193], 0
    s_barrier
    ds_read_b32 v22, v22 offset:0
    ds_read_b32 v23, v23 offset:672
    v_mfma_f32_16x16x32_bf16 v[166:169], a[52:55], v[194:197], v[166:169]
    ds_read_b32 v24, v24 offset:0
    s_waitcnt vmcnt(5)
    ds_read_b64_tr_b16 a[8:9], v123 offset:0
    ds_read_b64_tr_b16 a[10:11], v123 offset:768
    buffer_load_dwordx4 v152, s[48:51], 0 offen offset:2048 lds
    ds_read_b64_tr_b16 a[32:33], v123 offset:32
    ds_read_b64_tr_b16 a[34:35], v123 offset:800
    ds_read_b64_tr_b16 a[56:57], v123 offset:64
    ds_read_b64_tr_b16 a[58:59], v123 offset:832
    ds_read_b32 v25, v25 offset:672
    ds_read_b32 v26, v26 offset:0
    ds_read_b32 v27, v27 offset:672
    s_add_u32 s48, s48, 36864
    ds_read_b32 v46, v46 offset:336
    s_addc_u32 s49, s49, 0
    ds_read_b32 v58, v58 offset:336
    s_add_u32 m0, s69, 3072
    ds_read_b32 v70, v70 offset:336
    ds_read_b32 v47, v47 offset:332
    ds_read_b32 v59, v59 offset:332
    ds_read_b32 v71, v71 offset:332
    s_waitcnt lgkmcnt(15)
    buffer_load_dwordx4 v132, s[48:51], 0 offen lds
    ds_read_b32 v48, v48 offset:328
    ds_read_b32 v60, v60 offset:328
    s_waitcnt lgkmcnt(15)
    v_mfma_f32_16x16x32_bf16 v[218:221], a[8:11], v[170:173], v[218:221]
    s_waitcnt lgkmcnt(14)
    ds_read_b32 v72, v72 offset:328
    ds_read_b32 v49, v49 offset:324
    v_mfma_f32_16x16x32_bf16 v[146:149], a[8:11], v[198:201], v[146:149]
    s_waitcnt lgkmcnt(12)
    ds_read_b32 v61, v61 offset:324
    ds_read_b32 v73, v73 offset:324
    v_mfma_f32_16x16x32_bf16 v[246:249], a[32:35], v[170:173], v[246:249]
    s_waitcnt lgkmcnt(11)
    ds_read_b32 v50, v50 offset:272
    ds_read_b32 v62, v62 offset:272
    v_mfma_f32_16x16x32_bf16 v[250:253], a[56:59], v[170:173], v[250:253]
    s_waitcnt lgkmcnt(11)
    ds_read_b32 v74, v74 offset:272
    ds_read_b32 v51, v51 offset:268
    v_mfma_f32_16x16x32_bf16 v[226:229], a[32:35], v[198:201], v[226:229]
    s_waitcnt lgkmcnt(11)
    buffer_load_dwordx4 v150, s[48:51], 0 offen offset:1024 lds
    ds_read_b32 v63, v63 offset:268
    v_mfma_f32_16x16x32_bf16 v[166:169], a[56:59], v[198:201], v[166:169]
    s_waitcnt lgkmcnt(11)
    ds_read_b32 v75, v75 offset:268
    ds_read_b32 v52, v52 offset:264
    ds_read_b32 v64, v64 offset:264
    ds_read_b32 v76, v76 offset:264
    ds_read_b32 v53, v53 offset:260
    ds_read_b32 v65, v65 offset:260
    ds_read_b32 v77, v77 offset:260
    ds_read_b32 v54, v54 offset:208
    ds_read_b32 v66, v66 offset:208
    ds_read_b32 v78, v78 offset:208
    s_waitcnt vmcnt(5)
    ds_read_b64_tr_b16 a[12:13], v123 offset:3072
    buffer_load_dwordx4 v152, s[48:51], 0 offen offset:2048 lds
    ds_read_b64_tr_b16 a[14:15], v123 offset:3840
    ds_read_b64_tr_b16 a[36:37], v123 offset:3104
    s_add_u32 m0, s28, 0
    ds_read_b64_tr_b16 a[38:39], v123 offset:3872
    s_sub_u32 s48, s48, 183552
    ds_read_b64_tr_b16 a[60:61], v123 offset:3136
    s_subb_u32 s49, s49, 0
    ds_read_b64_tr_b16 a[62:63], v123 offset:3904
    ds_read_b32 v55, v55 offset:204
    ds_read_b32 v67, v67 offset:204
    ds_read_b32 v79, v79 offset:204
    ds_read_b32 v56, v56 offset:200
    ds_read_b32 v68, v68 offset:200
    buffer_load_dwordx4 v10, s[8:11], s25 offen nt lds
    ds_read_b32 v80, v80 offset:200
    ds_read_b32 v57, v57 offset:196
    ds_read_b32 v69, v69 offset:196
    s_add_u32 m0, s28, 4096
    ds_read_b32 v81, v81 offset:196
    ds_read_b32 v139, v139 offset:336
    s_waitcnt lgkmcnt(14)
    v_mfma_f32_16x16x32_bf16 v[218:221], a[12:15], v[126:129], v[218:221]
    s_waitcnt lgkmcnt(13)
    ds_write_b128 v159, v[234:237] offset:16
    v_mfma_f32_16x16x32_bf16 v[146:149], a[12:15], v[174:177], v[146:149]
    s_waitcnt lgkmcnt(10)
    v_cndmask_b32 v22, v144, v22, s[88:89]
    v_cndmask_b32 v24, v144, v24, s[88:89]
    v_mfma_f32_16x16x32_bf16 v[246:249], a[36:39], v[126:129], v[246:249]
    s_waitcnt lgkmcnt(8)
    buffer_load_dwordx4 v11, s[8:11], s25 offen nt lds
    v_mfma_f32_16x16x32_bf16 v[250:253], a[60:63], v[126:129], v[250:253]
    s_add_u32 m0, s28, 8192
    ds_write_b64 v159, v[234:235] offset:56
    v_mfma_f32_16x16x32_bf16 v[226:229], a[36:39], v[174:177], v[226:229]
    s_waitcnt lgkmcnt(5)
    v_mov_b32_dpp v23, v25 quad_perm:[0,1,2,3] row_mask:0x2 bank_mask:0xf
    v_cndmask_b32 v26, v144, v26, s[88:89]
    v_mfma_f32_16x16x32_bf16 v[166:169], a[60:63], v[174:177], v[166:169]
    s_waitcnt lgkmcnt(3)
    s_waitcnt lgkmcnt(2)
    ds_write_b64 v159, v[234:235] offset:64
    s_waitcnt vmcnt(5)
    v_readfirstlane_b32 s39, v139
    buffer_load_dwordx4 v12, s[8:11], s25 offen nt lds
    ds_read_b64_tr_b16 a[16:17], v124 offset:0
    ds_read_b64_tr_b16 a[18:19], v124 offset:768
    ds_read_b64_tr_b16 a[40:41], v124 offset:32
    ds_read_b64_tr_b16 a[42:43], v124 offset:800
    ds_read_b64_tr_b16 a[64:65], v124 offset:64
    ds_read_b64_tr_b16 a[66:67], v124 offset:832
    ds_write_b128 v143, v[238:241] offset:192
    s_add_u32 m0, s28, 12288
    v_mov_b32_dpp v23, v27 quad_perm:[0,1,2,3] row_mask:0x4 bank_mask:0xf
    buffer_load_dwordx4 v13, s[8:11], s25 offen nt lds
    ds_write_b128 v160, v[238:241] offset:192
    s_add_u32 m0, s29, 0
    s_nop 0
    s_waitcnt lgkmcnt(6)
    v_mfma_f32_16x16x32_bf16 v[218:221], a[16:19], v[178:181], v[218:221]
    s_waitcnt lgkmcnt(5)
    v_mfma_f32_16x16x32_bf16 v[146:149], a[16:19], v[210:213], v[146:149]
    s_waitcnt lgkmcnt(1)
    v_mfma_f32_16x16x32_bf16 v[246:249], a[40:43], v[178:181], v[246:249]
    v_mfma_f32_16x16x32_bf16 v[250:253], a[64:67], v[178:181], v[250:253]
    buffer_load_dwordx4 v14, s[8:11], s25 offen nt lds
    v_mfma_f32_16x16x32_bf16 v[226:229], a[40:43], v[210:213], v[226:229]
    s_add_u32 m0, s68, 0
    s_lshr_b32 s10, s17, 1
    s_cselect_b32 s10, s36, 0
    v_mfma_f32_16x16x32_bf16 v[166:169], a[64:67], v[210:213], v[166:169]
    s_mov_b32 s25, s24
    s_waitcnt vmcnt(5)
    ds_read_b64_tr_b16 a[20:21], v124 offset:3072
    ds_read_b64_tr_b16 a[22:23], v124 offset:3840
    ds_read_b64_tr_b16 a[44:45], v124 offset:3104
    buffer_load_dwordx4 v132, s[48:51], 0 offen lds
    ds_read_b64_tr_b16 a[46:47], v124 offset:3872
    ds_read_b64_tr_b16 a[68:69], v124 offset:3136
    ds_read_b64_tr_b16 a[70:71], v124 offset:3904
    buffer_load_dwordx4 v150, s[48:51], 0 offen offset:1024 lds
    s_waitcnt lgkmcnt(4)
    v_mfma_f32_16x16x32_bf16 v[218:221], a[20:23], v[182:185], v[218:221]
    s_waitcnt lgkmcnt(3)
    v_mfma_f32_16x16x32_bf16 v[146:149], a[20:23], v[242:245], v[146:149]
    s_waitcnt lgkmcnt(0)
    v_mfma_f32_16x16x32_bf16 v[246:249], a[44:47], v[182:185], v[246:249]
    v_mfma_f32_16x16x32_bf16 v[250:253], a[68:71], v[182:185], v[250:253]
    v_mfma_f32_16x16x32_bf16 v[226:229], a[44:47], v[242:245], v[226:229]
    buffer_load_dwordx4 v152, s[48:51], 0 offen offset:2048 lds
    s_add_u32 s48, s48, 36864
    v_mfma_f32_16x16x32_bf16 v[166:169], a[68:71], v[242:245], v[166:169]
    s_addc_u32 s49, s49, 0
    s_add_u32 m0, s68, 3072
    v_cvt_pk_f16_f32 v126, v218, v219
    v_pk_mul_f16 v202, v126, v126
    v_cvt_pk_f16_f32 v127, v220, v221
    v_pk_fma_f16 v202, v127, v127, v202
    v_cvt_pk_f16_f32 v128, v246, v247
    v_pk_fma_f16 v202, v128, v128, v202
    v_cvt_pk_f16_f32 v129, v248, v249
    v_pk_fma_f16 v202, v129, v129, v202
    v_cvt_pk_f16_f32 v118, v250, v251
    v_pk_fma_f16 v202, v118, v118, v202
    v_cvt_pk_f16_f32 v119, v252, v253
    v_pk_fma_f16 v202, v119, v119, v202
    v_pk_mul_f16 v204, v126, v186
    v_pk_fma_f16 v204, v127, v187, v204
    buffer_load_dwordx4 v132, s[48:51], 0 offen lds
    v_pk_fma_f16 v204, v128, v188, v204
    v_pk_fma_f16 v204, v129, v189, v204
    v_pk_fma_f16 v204, v118, v120, v204
    v_pk_fma_f16 v204, v119, v121, v204
    v_mov_b32 v205, v202
    v_cvt_pk_f16_f32 v142, v146, v147
    v_pk_mul_f16 v222, v142, v142
    v_mfma_f32_16x16x32_f16 v[170:173], v[40:43], v[202:205], 0
    v_cvt_pk_f16_f32 v143, v148, v149
    v_pk_fma_f16 v222, v143, v143, v222
    v_cvt_pk_f16_f32 v144, v226, v227
    v_pk_fma_f16 v222, v144, v144, v222
    v_cvt_pk_f16_f32 v145, v228, v229
    v_pk_fma_f16 v222, v145, v145, v222
    v_cvt_pk_f16_f32 v138, v166, v167
    v_pk_fma_f16 v222, v138, v138, v222
    v_rsq_f32 v170, v170
    v_rsq_f32 v171, v171
    v_mul_f32 v166, s31, v170
    v_cvt_pk_f16_f32 v167, v166, v171
    v_pk_mul_f16 v186, v186, v167 op_sel:[0,1] op_sel_hi:[1,1]
    v_pk_mul_f16 v187, v187, v167 op_sel:[0,1] op_sel_hi:[1,1]
    v_pk_mul_f16 v188, v188, v167 op_sel:[0,1] op_sel_hi:[1,1]
    v_pk_mul_f16 v189, v189, v167 op_sel:[0,1] op_sel_hi:[1,1]
    v_pk_mul_f16 v120, v120, v167 op_sel:[0,1] op_sel_hi:[1,1]
    v_pk_mul_f16 v121, v121, v167 op_sel:[0,1] op_sel_hi:[1,1]
    v_pk_mul_f16 v126, v126, v167 op_sel:[0,0] op_sel_hi:[1,0]
    v_pk_mul_f16 v127, v127, v167 op_sel:[0,0] op_sel_hi:[1,0]
    v_pk_mul_f16 v128, v128, v167 op_sel:[0,0] op_sel_hi:[1,0]
    v_pk_mul_f16 v129, v129, v167 op_sel:[0,0] op_sel_hi:[1,0]
    v_pk_mul_f16 v118, v118, v167 op_sel:[0,0] op_sel_hi:[1,0]
    v_pk_mul_f16 v119, v119, v167 op_sel:[0,0] op_sel_hi:[1,0]
    v_cndmask_b32 v170, 1.0, v170, s[94:95]
    v_cndmask_b32 v171, 1.0, v171, s[94:95]
    v_max3_u32 v44, v44, v170, v171
    v_mul_f32 v139, v172, v166
    v_fma_f32 v139, v139, v171, s39
    ds_write_b32 v157, v139 offset:192
    v_cvt_pk_f16_f32 v139, v168, v169
    v_pk_fma_f16 v222, v139, v139, v222
    v_pk_mul_f16 v224, v142, v214
    v_pk_fma_f16 v224, v143, v215, v224
    ds_write_b128 v159, v[186:189]
    v_pk_fma_f16 v224, v144, v216, v224
    v_pk_fma_f16 v224, v145, v217, v224
    v_pk_fma_f16 v224, v138, v140, v224
    v_pk_fma_f16 v224, v139, v141, v224
    v_mov_b32 v225, v222
    s_nop 0
    s_nop 0
    v_mfma_f32_16x16x32_f16 v[146:149], v[40:43], v[222:225], 0
    ds_write_b64 v159, v[120:121] offset:48
    s_nop 0
    s_nop 0
    s_nop 0
    ds_write_b128 v159, v[126:129] offset:32
    s_nop 0
    s_nop 0
    s_nop 0
    v_rsq_f32 v146, v146
    v_rsq_f32 v147, v147
    ds_write_b64 v159, v[118:119] offset:72
    v_mul_f32 v116, s31, v146
    v_cvt_pk_f16_f32 v117, v116, v147
    v_pk_mul_f16 v214, v214, v117 op_sel:[0,1] op_sel_hi:[1,1]
    v_pk_mul_f16 v215, v215, v117 op_sel:[0,1] op_sel_hi:[1,1]
    v_pk_mul_f16 v216, v216, v117 op_sel:[0,1] op_sel_hi:[1,1]
    v_pk_mul_f16 v217, v217, v117 op_sel:[0,1] op_sel_hi:[1,1]
    v_pk_mul_f16 v140, v140, v117 op_sel:[0,1] op_sel_hi:[1,1]
    v_pk_mul_f16 v141, v141, v117 op_sel:[0,1] op_sel_hi:[1,1]
    v_pk_mul_f16 v142, v142, v117 op_sel:[0,0] op_sel_hi:[1,0]
    v_pk_mul_f16 v143, v143, v117 op_sel:[0,0] op_sel_hi:[1,0]
    v_pk_mul_f16 v144, v144, v117 op_sel:[0,0] op_sel_hi:[1,0]
    v_pk_mul_f16 v145, v145, v117 op_sel:[0,0] op_sel_hi:[1,0]
    v_pk_mul_f16 v138, v138, v117 op_sel:[0,0] op_sel_hi:[1,0]
    v_pk_mul_f16 v139, v139, v117 op_sel:[0,0] op_sel_hi:[1,0]
    v_max3_u32 v44, v44, v146, v147
    v_mul_f32 v157, v148, v116
    v_fma_f32 v157, v157, v147, s39
    ds_write_b32 v255, v157 offset:192
    buffer_load_dwordx4 v150, s[48:51], 0 offen offset:1024 lds
    ds_write_b128 v135, v[214:217]
    buffer_load_dwordx4 v152, s[48:51], 0 offen offset:2048 lds
    ds_write_b64 v135, v[140:141] offset:48
    s_add_u32 s48, s48, 36864
    s_addc_u32 s49, s49, 0
    s_add_u32 m0, s69, 0
    ds_write_b128 v135, v[142:145] offset:32
    buffer_load_dwordx4 v132, s[48:51], 0 offen lds
    ds_write_b64 v135, v[138:139] offset:72
    buffer_load_dwordx4 v150, s[48:51], 0 offen offset:1024 lds
    buffer_load_dwordx4 v152, s[48:51], 0 offen offset:2048 lds
    s_waitcnt vmcnt(9)
    s_barrier
    ds_read_b128 v[126:129], v0 offset:20480
    ds_read_b128 v[170:173], v1 offset:20480
    ds_read_b128 v[174:177], v0 offset:20608
    s_add_u32 s48, s48, 36864
    s_addc_u32 s49, s49, 0
    ds_read_b128 v[178:181], v1 offset:20608
    s_add_u32 m0, s69, 3072
    ds_read_b128 v[182:185], v0 offset:20736
    ds_read_b128 v[186:189], v1 offset:20736
    buffer_load_dwordx4 v132, s[48:51], 0 offen lds
    s_waitcnt lgkmcnt(5)
    v_mfma_f32_16x16x32_bf16 v[118:121], a[72:75], v[126:129], 0
    s_waitcnt lgkmcnt(4)
    v_mfma_f32_16x16x32_bf16 v[118:121], a[76:79], v[170:173], v[118:121]
    s_waitcnt lgkmcnt(2)
    v_mfma_f32_16x16x32_bf16 v[118:121], a[80:83], v[174:177], v[118:121]
    s_waitcnt lgkmcnt(1)
    v_mfma_f32_16x16x32_bf16 v[118:121], a[84:87], v[178:181], v[118:121]
    s_waitcnt lgkmcnt(0)
    buffer_load_dwordx4 v150, s[48:51], 0 offen offset:1024 lds
    v_mfma_f32_16x16x32_bf16 v[118:121], a[88:91], v[182:185], v[118:121]
    v_mfma_f32_16x16x32_bf16 v[118:121], a[92:95], v[186:189], v[118:121]
    v_mfma_f32_16x16x32_bf16 v[190:193], a[96:99], v[126:129], 0
    s_waitcnt vmcnt(8)
    ds_read_b64_tr_b16 a[144:145], v123 offset:0
    ds_read_b64_tr_b16 a[146:147], v123 offset:768
    v_mfma_f32_16x16x32_bf16 v[190:193], a[100:103], v[170:173], v[190:193]
    ds_read_b64_tr_b16 a[168:169], v123 offset:32
    ds_read_b64_tr_b16 a[170:171], v123 offset:800
    v_mfma_f32_16x16x32_bf16 v[190:193], a[104:107], v[174:177], v[190:193]
    ds_read_b64_tr_b16 a[192:193], v123 offset:64
    buffer_load_dwordx4 v152, s[48:51], 0 offen offset:2048 lds
    v_mfma_f32_16x16x32_bf16 v[190:193], a[108:111], v[178:181], v[190:193]
    s_add_u32 s48, s48, 36864
    ds_read_b64_tr_b16 a[194:195], v123 offset:832
    v_cvt_pk_f16_f32 v146, v118, v119
    v_mfma_f32_16x16x32_bf16 v[190:193], a[112:115], v[182:185], v[190:193]
    s_addc_u32 s49, s49, 0
    v_pk_mul_f16 v143, v146, v146
    v_cvt_pk_f16_f32 v147, v120, v121
    v_mfma_f32_16x16x32_bf16 v[190:193], a[116:119], v[186:189], v[190:193]
    s_add_u32 m0, s68, 0
    v_pk_fma_f16 v143, v147, v147, v143
    v_mfma_f32_16x16x32_bf16 v[198:201], a[120:123], v[126:129], 0
    v_mfma_f32_16x16x32_bf16 v[198:201], a[124:127], v[170:173], v[198:201]
    v_mfma_f32_16x16x32_bf16 v[198:201], a[128:131], v[174:177], v[198:201]
    s_waitcnt lgkmcnt(4)
    v_mfma_f32_16x16x32_bf16 v[198:201], a[132:135], v[178:181], v[198:201]
    s_waitcnt lgkmcnt(2)
    v_cvt_pk_f16_f32 v148, v190, v191
    v_pk_fma_f16 v143, v148, v148, v143
    v_mfma_f32_16x16x32_bf16 v[198:201], a[136:139], v[182:185], v[198:201]
    s_waitcnt lgkmcnt(1)
    ds_read_b128 v[194:197], v0 offset:26624
    v_cvt_pk_f16_f32 v149, v192, v193
    v_mfma_f32_16x16x32_bf16 v[198:201], a[140:143], v[186:189], v[198:201]
    s_waitcnt lgkmcnt(1)
    buffer_load_dwordx4 v132, s[48:51], 0 offen lds
    ds_read_b128 v[190:193], v1 offset:26624
    v_mfma_f32_16x16x32_bf16 v[138:141], a[0:3], v[126:129], 0
    ds_read_b128 v[202:205], v0 offset:26752
    s_waitcnt vmcnt(7)
    v_mfma_f32_16x16x32_bf16 v[138:141], a[4:7], v[170:173], v[138:141]
    ds_read_b64_tr_b16 a[148:149], v123 offset:3072
    ds_read_b64_tr_b16 a[150:151], v123 offset:3840
    v_mfma_f32_16x16x32_bf16 v[138:141], a[8:11], v[174:177], v[138:141]
    ds_read_b64_tr_b16 a[172:173], v123 offset:3104
    ds_read_b64_tr_b16 a[174:175], v123 offset:3872
    v_mfma_f32_16x16x32_bf16 v[138:141], a[12:15], v[178:181], v[138:141]
    ds_read_b64_tr_b16 a[196:197], v123 offset:3136
    ds_read_b64_tr_b16 a[198:199], v123 offset:3904
    v_mfma_f32_16x16x32_bf16 v[138:141], a[16:19], v[182:185], v[138:141]
    ds_read_b128 v[206:209], v1 offset:26752
    buffer_load_dwordx4 v150, s[48:51], 0 offen offset:1024 lds
    v_mfma_f32_16x16x32_bf16 v[138:141], a[20:23], v[186:189], v[138:141]
    ds_read_b128 v[210:213], v0 offset:26880
    ds_read_b128 v[214:217], v1 offset:26880
    v_mfma_f32_16x16x32_bf16 v[166:169], a[24:27], v[126:129], 0
    s_waitcnt lgkmcnt(11)
    v_pk_fma_f16 v143, v149, v149, v143
    v_cvt_pk_f16_f32 v120, v198, v199
    v_mfma_f32_16x16x32_bf16 v[166:169], a[28:31], v[170:173], v[166:169]
    s_waitcnt lgkmcnt(10)
    v_pk_fma_f16 v143, v120, v120, v143
    v_cvt_pk_f16_f32 v121, v200, v201
    v_mfma_f32_16x16x32_bf16 v[166:169], a[32:35], v[174:177], v[166:169]
    s_waitcnt lgkmcnt(9)
    v_pk_fma_f16 v143, v121, v121, v143
    v_cvt_pk_f16_f32 v138, v138, v139
    v_mfma_f32_16x16x32_bf16 v[166:169], a[36:39], v[178:181], v[166:169]
    s_waitcnt lgkmcnt(7)
    v_pk_mul_f16 v142, v138, v138
    v_cvt_pk_f16_f32 v139, v140, v141
    v_mfma_f32_16x16x32_bf16 v[166:169], a[40:43], v[182:185], v[166:169]
    s_waitcnt lgkmcnt(5)
    buffer_load_dwordx4 v152, s[48:51], 0 offen offset:2048 lds
    v_pk_fma_f16 v142, v139, v139, v142
    v_mfma_f32_16x16x32_bf16 v[166:169], a[44:47], v[186:189], v[166:169]
    s_add_u32 s48, s48, 36864
    s_addc_u32 s49, s49, 0
    s_add_u32 m0, s68, 3072
    v_mfma_f32_16x16x32_bf16 v[134:137], a[48:51], v[126:129], 0
    s_waitcnt lgkmcnt(2)
    v_mfma_f32_16x16x32_bf16 v[134:137], a[52:55], v[170:173], v[134:137]
    s_waitcnt vmcnt(6)
    ds_read_b64_tr_b16 a[152:153], v124 offset:0
    ds_read_b64_tr_b16 a[154:155], v124 offset:768
    v_mfma_f32_16x16x32_bf16 v[134:137], a[56:59], v[174:177], v[134:137]
    s_waitcnt lgkmcnt(2)
    ds_read_b64_tr_b16 a[176:177], v124 offset:32
    ds_read_b64_tr_b16 a[178:179], v124 offset:800
    v_mfma_f32_16x16x32_bf16 v[134:137], a[60:63], v[178:181], v[134:137]
    ds_read_b64_tr_b16 a[200:201], v124 offset:64
    buffer_load_dwordx4 v132, s[48:51], 0 offen lds
    v_mfma_f32_16x16x32_bf16 v[134:137], a[64:67], v[182:185], v[134:137]
    ds_read_b64_tr_b16 a[202:203], v124 offset:832
    ds_read_b128 v[126:129], v0 offset:32768
    v_mfma_f32_16x16x32_bf16 v[134:137], a[68:71], v[186:189], v[134:137]
    ds_read_b128 v[170:173], v1 offset:32768
    v_cvt_pk_f16_f32 v140, v166, v167
    v_mfma_f32_16x16x32_bf16 v[174:177], a[72:75], v[194:197], 0
    ds_read_b128 v[178:181], v0 offset:32896
    v_pk_fma_f16 v142, v140, v140, v142
    v_mfma_f32_16x16x32_bf16 v[174:177], a[76:79], v[190:193], v[174:177]
    ds_read_b128 v[182:185], v1 offset:32896
    v_cvt_pk_f16_f32 v141, v168, v169
    v_mfma_f32_16x16x32_bf16 v[174:177], a[80:83], v[202:205], v[174:177]
    ds_read_b128 v[166:169], v0 offset:33024
    v_pk_fma_f16 v142, v141, v141, v142
    v_mfma_f32_16x16x32_bf16 v[174:177], a[84:87], v[206:209], v[174:177]
    s_waitcnt lgkmcnt(9)
    buffer_load_dwordx4 v150, s[48:51], 0 offen offset:1024 lds
    ds_read_b128 v[186:189], v1 offset:33024
    v_mfma_f32_16x16x32_bf16 v[174:177], a[88:91], v[210:213], v[174:177]
    s_waitcnt lgkmcnt(8)
    v_cvt_pk_f16_f32 v118, v134, v135
    v_pk_fma_f16 v142, v118, v118, v142
    v_mfma_f32_16x16x32_bf16 v[174:177], a[92:95], v[214:217], v[174:177]
    s_waitcnt lgkmcnt(7)
    v_cvt_pk_f16_f32 v119, v136, v137
    v_pk_fma_f16 v142, v119, v119, v142
    v_mfma_f32_16x16x32_bf16 v[134:137], a[96:99], v[194:197], 0
    s_waitcnt lgkmcnt(5)
    v_mov_b32 v144, v142
    v_mov_b32 v145, v142
    v_mfma_f32_16x16x32_bf16 v[134:137], a[100:103], v[190:193], v[134:137]
    s_waitcnt lgkmcnt(4)
    v_cvt_pk_f16_f32 v150, v174, v175
    v_pk_mul_f16 v175, v150, v150
    v_mfma_f32_16x16x32_f16 v[198:201], v[40:43], v[142:145], 0
    s_waitcnt vmcnt(5)
    ds_read_b64_tr_b16 a[156:157], v124 offset:3072
    buffer_load_dwordx4 v152, s[48:51], 0 offen offset:2048 lds
    v_mfma_f32_16x16x32_bf16 v[134:137], a[104:107], v[202:205], v[134:137]
    s_add_u32 m0, s69, 0
    ds_read_b64_tr_b16 a[158:159], v124 offset:3840
    ds_read_b64_tr_b16 a[180:181], v124 offset:3104
    v_mfma_f32_16x16x32_bf16 v[134:137], a[108:111], v[206:209], v[134:137]
    s_waitcnt lgkmcnt(4)
    ds_read_b64_tr_b16 a[182:183], v124 offset:3872
    ds_read_b64_tr_b16 a[204:205], v124 offset:3136
    v_mfma_f32_16x16x32_bf16 v[134:137], a[112:115], v[210:213], v[134:137]
    s_waitcnt lgkmcnt(5)
    ds_read_b64_tr_b16 a[206:207], v124 offset:3904
    v_cvt_pk_f16_f32 v151, v176, v177
    v_mfma_f32_16x16x32_bf16 v[134:137], a[116:119], v[214:217], v[134:137]
    v_rsq_f32 v198, v198
    v_mfma_f32_16x16x32_bf16 v[142:145], a[120:123], v[194:197], 0
    v_rsq_f32 v199, v199
    v_mfma_f32_16x16x32_bf16 v[142:145], a[124:127], v[190:193], v[142:145]
    buffer_load_dwordx4 v164, s[52:55], 0 offen lds
    v_mul_f32 v152, s31, v198
    v_mfma_f32_16x16x32_bf16 v[142:145], a[128:131], v[202:205], v[142:145]
    v_cvt_pk_f16_f32 v153, v152, v199
    v_pk_mul_f16 v146, v146, v153 op_sel:[0,1] op_sel_hi:[1,1]
    v_mfma_f32_16x16x32_bf16 v[142:145], a[132:135], v[206:209], v[142:145]
    s_waitcnt lgkmcnt(5)
    v_pk_mul_f16 v147, v147, v153 op_sel:[0,1] op_sel_hi:[1,1]
    v_pk_mul_f16 v148, v148, v153 op_sel:[0,1] op_sel_hi:[1,1]
    v_mfma_f32_16x16x32_bf16 v[142:145], a[136:139], v[210:213], v[142:145]
    s_waitcnt lgkmcnt(3)
    ds_read_b128 v[190:193], v155 offset:6144
    v_pk_mul_f16 v149, v149, v153 op_sel:[0,1] op_sel_hi:[1,1]
    v_mfma_f32_16x16x32_bf16 v[142:145], a[140:143], v[214:217], v[142:145]
    s_waitcnt lgkmcnt(2)
    ds_read_b128 v[194:197], v156 offset:6144
    v_pk_mul_f16 v120, v120, v153 op_sel:[0,1] op_sel_hi:[1,1]
    v_mfma_f32_16x16x32_bf16 v[202:205], a[72:75], v[126:129], 0
    s_waitcnt lgkmcnt(2)
    ds_read_b128 v[206:209], v155 offset:6272
    buffer_load_dwordx4 v165, s[52:55], 0 offen offset:1024 lds
    v_mfma_f32_16x16x32_bf16 v[202:205], a[76:79], v[170:173], v[202:205]
    ds_read_b128 v[210:213], v156 offset:6272
    v_pk_mul_f16 v121, v121, v153 op_sel:[0,1] op_sel_hi:[1,1]
    v_mfma_f32_16x16x32_bf16 v[202:205], a[80:83], v[178:181], v[202:205]
    ds_read_b128 v[214:217], v155 offset:6400
    v_pk_mul_f16 v138, v138, v153 op_sel:[0,0] op_sel_hi:[1,0]
    v_mfma_f32_16x16x32_bf16 v[202:205], a[84:87], v[182:185], v[202:205]
    ds_read_b128 v[218:221], v156 offset:6400
    v_pk_mul_f16 v139, v139, v153 op_sel:[0,0] op_sel_hi:[1,0]
    v_mfma_f32_16x16x32_bf16 v[202:205], a[88:91], v[166:169], v[202:205]
    v_pk_mul_f16 v140, v140, v153 op_sel:[0,0] op_sel_hi:[1,0]
    s_waitcnt vmcnt(5)
    v_mfma_f32_16x16x32_bf16 v[202:205], a[92:95], v[186:189], v[202:205]
    ds_read_b64_tr_b16 a[160:161], v123 offset:0
    ds_read_b64_tr_b16 a[162:163], v123 offset:768
    v_mfma_f32_16x16x32_bf16 v[222:225], a[96:99], v[126:129], 0
    s_waitcnt lgkmcnt(7)
    buffer_load_dwordx4 v131, s[52:55], 0 offen offset:2048 lds
    ds_read_b64_tr_b16 a[184:185], v123 offset:32
    v_mfma_f32_16x16x32_bf16 v[222:225], a[100:103], v[170:173], v[222:225]
    s_add_u32 s52, s52, 12288
    ds_read_b64_tr_b16 a[186:187], v123 offset:800
    ds_read_b64_tr_b16 a[208:209], v123 offset:64
    v_mfma_f32_16x16x32_bf16 v[222:225], a[104:107], v[178:181], v[222:225]
    s_addc_u32 s53, s53, 0
    ds_read_b64_tr_b16 a[210:211], v123 offset:832
    v_pk_mul_f16 v141, v141, v153 op_sel:[0,0] op_sel_hi:[1,0]
    v_mfma_f32_16x16x32_bf16 v[222:225], a[108:111], v[182:185], v[222:225]
    s_add_u32 m0, s69, 3072
    v_pk_mul_f16 v118, v118, v153 op_sel:[0,0] op_sel_hi:[1,0]
    v_pk_mul_f16 v119, v119, v153 op_sel:[0,0] op_sel_hi:[1,0]
    v_mfma_f32_16x16x32_bf16 v[222:225], a[112:115], v[166:169], v[222:225]
    s_waitcnt lgkmcnt(7)
    v_max3_u32 v44, v44, v198, v199
    v_pk_fma_f16 v175, v151, v151, v175
    v_mfma_f32_16x16x32_bf16 v[222:225], a[116:119], v[186:189], v[222:225]
    s_waitcnt lgkmcnt(6)
    v_cvt_pk_f16_f32 v152, v134, v135
    v_pk_fma_f16 v175, v152, v152, v175
    v_mfma_f32_16x16x32_bf16 v[198:201], a[120:123], v[126:129], 0
    buffer_load_dwordx4 v164, s[52:55], 0 offen lds
    v_cvt_pk_f16_f32 v153, v136, v137
    v_mfma_f32_16x16x32_bf16 v[198:201], a[124:127], v[170:173], v[198:201]
    s_waitcnt lgkmcnt(4)
    v_pk_fma_f16 v175, v153, v153, v175
    v_cvt_pk_f16_f32 v124, v142, v143
    v_mfma_f32_16x16x32_bf16 v[198:201], a[128:131], v[178:181], v[198:201]
    s_waitcnt lgkmcnt(3)
    v_pk_fma_f16 v175, v124, v124, v175
    v_cvt_pk_f16_f32 v125, v144, v145
    v_mfma_f32_16x16x32_bf16 v[198:201], a[132:135], v[182:185], v[198:201]
    s_waitcnt lgkmcnt(1)
    v_pk_fma_f16 v175, v125, v125, v175
    v_cvt_pk_f16_f32 v126, v202, v203
    v_mfma_f32_16x16x32_bf16 v[198:201], a[136:139], v[166:169], v[198:201]
    s_waitcnt lgkmcnt(0)
    ds_read_b128 v[134:137], v155 offset:0
    v_pk_mul_f16 v115, v126, v126
    v_mfma_f32_16x16x32_bf16 v[198:201], a[140:143], v[186:189], v[198:201]
    ds_read_b128 v[142:145], v156 offset:0
    buffer_load_dwordx4 v165, s[52:55], 0 offen offset:1024 lds
    v_mfma_f32_16x16x32_bf16 v[166:169], v[190:193], a[144:147], 0
    ds_read_b128 v[170:173], v155 offset:128
    v_cvt_pk_f16_f32 v127, v204, v205
    v_mfma_f32_16x16x32_bf16 v[166:169], v[194:197], a[148:151], v[166:169]
    ds_read_b128 v[178:181], v156 offset:128
    v_pk_fma_f16 v115, v127, v127, v115
    v_mfma_f32_16x16x32_bf16 v[166:169], v[206:209], a[152:155], v[166:169]
    ds_read_b128 v[182:185], v155 offset:256
    v_cvt_pk_f16_f32 v128, v222, v223
    s_waitcnt vmcnt(5)
    v_mfma_f32_16x16x32_bf16 v[166:169], v[210:213], a[156:159], v[166:169]
    ds_read_b64_tr_b16 a[164:165], v123 offset:3072
    ds_read_b64_tr_b16 a[166:167], v123 offset:3840
    v_mfma_f32_16x16x32_bf16 v[166:169], v[214:217], a[160:163], v[166:169]
    ds_read_b64_tr_b16 a[188:189], v123 offset:3104
    buffer_load_dwordx4 v131, s[52:55], 0 offen offset:2048 lds
    v_mfma_f32_16x16x32_bf16 v[186:189], v[190:193], a[168:171], 0
    s_waitcnt lgkmcnt(7)
    ds_read_b64_tr_b16 a[190:191], v123 offset:3872
    ds_read_b64_tr_b16 a[212:213], v123 offset:3136
    v_mfma_f32_16x16x32_bf16 v[186:189], v[194:197], a[172:175], v[186:189]
    s_add_u32 s52, s52, 12288
    ds_read_b64_tr_b16 a[214:215], v123 offset:3904
    ds_read_b128 v[202:205], v156 offset:256
    v_mfma_f32_16x16x32_bf16 v[186:189], v[206:209], a[176:179], v[186:189]
    s_addc_u32 s53, s53, 0
    v_pk_fma_f16 v115, v128, v128, v115
    v_cvt_pk_f16_f32 v129, v224, v225
    v_mfma_f32_16x16x32_bf16 v[186:189], v[210:213], a[180:183], v[186:189]
    s_add_u32 m0, s68, 0
    v_pk_fma_f16 v115, v129, v129, v115
    v_cvt_pk_f16_f32 v156, v198, v199
    v_mfma_f32_16x16x32_bf16 v[186:189], v[214:217], a[184:187], v[186:189]
    s_waitcnt lgkmcnt(7)
    v_pk_fma_f16 v115, v156, v156, v115
    v_cvt_pk_f16_f32 v157, v200, v201
    v_mfma_f32_16x16x32_bf16 v[198:201], v[190:193], a[192:195], 0
    buffer_load_dwordx4 v164, s[52:55], 0 offen lds
    v_pk_fma_f16 v115, v157, v157, v115
    v_mfma_f32_16x16x32_bf16 v[198:201], v[194:197], a[196:199], v[198:201]
    s_waitcnt lgkmcnt(5)
    v_xor_b32 v255, 65536, v2
    v_lshrrev_b32 v132, 2, v255
    v_mfma_f32_16x16x32_bf16 v[166:169], v[218:221], a[164:167], v[166:169]
    s_waitcnt lgkmcnt(4)
    v_lshrrev_b32 v159, 8, v255
    v_lshl_add_u32 v160, s16, 2, v255
    v_mfma_f32_16x16x32_bf16 v[198:201], v[206:209], a[200:203], v[198:201]
    s_waitcnt lgkmcnt(2)
    v_add_u32 v132, 62784, v132
    v_lshlrev_b32 v159, 4, v159
    v_mfma_f32_16x16x32_bf16 v[186:189], v[218:221], a[188:191], v[186:189]
    s_waitcnt lgkmcnt(0)
    v_cvt_pk_bf16_f32 v166, v166, v166
    v_cvt_pk_bf16_f32 v167, v167, v167
    v_mfma_f32_16x16x32_bf16 v[198:201], v[210:213], a[204:207], v[198:201]
    s_barrier
    ds_write2_b32 v161, v166, v167 offset0:0 offset1:68
    v_mfma_f32_16x16x32_bf16 v[198:201], v[214:217], a[208:211], v[198:201]
    buffer_load_dwordx4 v165, s[52:55], 0 offen offset:1024 lds
    v_cvt_pk_bf16_f32 v168, v168, v168
    v_mfma_f32_16x16x32_bf16 v[198:201], v[218:221], a[212:215], v[198:201]
    v_cvt_pk_bf16_f32 v169, v169, v169
    v_cvt_pk_bf16_f32 v186, v186, v186
    v_mfma_f32_16x16x32_bf16 v[190:193], v[134:137], a[144:147], 0
    ds_write2_b32 v161, v168, v169 offset0:136 offset1:204
    s_waitcnt vmcnt(5)
    v_mfma_f32_16x16x32_bf16 v[190:193], v[142:145], a[148:151], v[190:193]
    v_cvt_pk_bf16_f32 v187, v187, v187
    v_cvt_pk_bf16_f32 v188, v188, v188
    v_mfma_f32_16x16x32_bf16 v[190:193], v[170:173], a[152:155], v[190:193]
    ds_read_b64 a[216:217], v114 offset:0
    ds_read_b64 a[218:219], v114 offset:1536
    v_mfma_f32_16x16x32_bf16 v[190:193], v[178:181], a[156:159], v[190:193]
    buffer_load_dwordx4 v131, s[52:55], 0 offen offset:2048 lds
    ds_read_b64 a[240:241], v114 offset:8
    v_mfma_f32_16x16x32_bf16 v[190:193], v[182:185], a[160:163], v[190:193]
    s_add_u32 s52, s52, 12288
    ds_read_b64 a[242:243], v114 offset:1544
    ds_read_b64 v[90:91], v254 offset:0
    v_mfma_f32_16x16x32_bf16 v[190:193], v[202:205], a[164:167], v[190:193]
    s_addc_u32 s53, s53, 0
    ds_read_b64 v[92:93], v254 offset:1536
    ds_read_b128 v[166:169], v0 offset:26624
    v_mfma_f32_16x16x32_bf16 v[194:197], v[134:137], a[168:171], 0
    s_add_u32 m0, s68, 3072
    ds_read_b128 v[206:209], v1 offset:26624
    v_cvt_pk_bf16_f32 v189, v189, v189
    v_mfma_f32_16x16x32_bf16 v[194:197], v[142:145], a[172:175], v[194:197]
    s_mul_i32 s68, s78, 72
    ds_read_b128 v[210:213], v0 offset:26752
    v_cvt_pk_bf16_f32 v198, v198, v198
    v_mfma_f32_16x16x32_bf16 v[194:197], v[170:173], a[176:179], v[194:197]
    s_sub_u32 s68, s77, s68
    ds_read_b128 v[214:217], v1 offset:26752
    buffer_load_dwordx4 v164, s[52:55], 0 offen lds
    v_mfma_f32_16x16x32_bf16 v[194:197], v[178:181], a[180:183], v[194:197]
    s_mul_i32 s78, s78, 1373568
    ds_read_b128 v[218:221], v0 offset:26880
    v_cvt_pk_bf16_f32 v199, v199, v199
    v_mfma_f32_16x16x32_bf16 v[194:197], v[182:185], a[184:187], v[194:197]
    s_mul_i32 s77, s68, 2688
    ds_read_b128 v[222:225], v1 offset:26880
    v_cvt_pk_bf16_f32 v200, v200, v200
    v_mfma_f32_16x16x32_bf16 v[194:197], v[202:205], a[188:191], v[194:197]
    s_add_u32 s77, s77, s78
    ds_write2_b32 v161, v186, v187 offset0:16 offset1:84
    v_mfma_f32_16x16x32_bf16 v[226:229], v[134:137], a[192:195], 0
    s_waitcnt lgkmcnt(7)
    v_cvt_pk_bf16_f32 v201, v201, v201
    v_cvt_pk_bf16_f32 v190, v190, v190
    v_mfma_f32_16x16x32_bf16 v[226:229], v[142:145], a[196:199], v[226:229]
    s_waitcnt lgkmcnt(5)
    ds_write2_b32 v161, v188, v189 offset0:152 offset1:220
    v_mfma_f32_16x16x32_bf16 v[226:229], v[170:173], a[200:203], v[226:229]
    s_waitcnt lgkmcnt(5)
    buffer_load_dwordx4 v165, s[52:55], 0 offen offset:1024 lds
    v_cvt_pk_bf16_f32 v191, v191, v191
    v_mfma_f32_16x16x32_bf16 v[226:229], v[178:181], a[204:207], v[226:229]
    s_waitcnt lgkmcnt(4)
    ds_write2_b32 v161, v198, v199 offset0:32 offset1:100
    v_mfma_f32_16x16x32_bf16 v[226:229], v[182:185], a[208:211], v[226:229]
    s_waitcnt lgkmcnt(4)
    s_waitcnt vmcnt(5)
    v_cvt_pk_bf16_f32 v192, v192, v192
    v_mfma_f32_16x16x32_bf16 v[226:229], v[202:205], a[212:215], v[226:229]
    s_waitcnt lgkmcnt(3)
    ds_read_b64 a[232:233], v114 offset:3072
    ds_read_b64 a[220:221], v114 offset:4608
    v_mfma_f32_16x16x32_bf16 v[134:137], a[0:3], v[166:169], 0
    ds_read_b64 v[82:83], v114 offset:3080
    ds_read_b64 a[244:245], v114 offset:4616
    v_mfma_f32_16x16x32_bf16 v[134:137], a[4:7], v[206:209], v[134:137]
    buffer_load_dwordx4 v131, s[52:55], 0 offen offset:2048 lds
    ds_read_b64 v[106:107], v254 offset:3072
    v_mfma_f32_16x16x32_bf16 v[134:137], a[8:11], v[210:213], v[134:137]
    s_add_u32 s52, s52, 12288
    ds_read_b64 v[94:95], v254 offset:4608
    v_cvt_pk_bf16_f32 v193, v193, v193
    v_mfma_f32_16x16x32_bf16 v[134:137], a[12:15], v[214:217], v[134:137]
    s_addc_u32 s53, s53, 0
    ds_write2_b32 v161, v200, v201 offset0:168 offset1:236
    v_mfma_f32_16x16x32_bf16 v[134:137], a[16:19], v[218:221], v[134:137]
    s_add_u32 m0, s69, 0
    v_cvt_pk_bf16_f32 v194, v194, v194
    v_cvt_pk_bf16_f32 v195, v195, v195
    v_mfma_f32_16x16x32_bf16 v[134:137], a[20:23], v[222:225], v[134:137]
    ds_write2_b32 v158, v190, v191 offset0:0 offset1:68
    v_mfma_f32_16x16x32_bf16 v[142:145], a[24:27], v[166:169], 0
    s_waitcnt lgkmcnt(6)
    buffer_load_dwordx4 v164, s[52:55], 0 offen lds
    v_cvt_pk_bf16_f32 v196, v196, v196
    v_mfma_f32_16x16x32_bf16 v[142:145], a[28:31], v[206:209], v[142:145]
    s_waitcnt lgkmcnt(4)
    ds_write2_b32 v158, v192, v193 offset0:136 offset1:204
    v_mfma_f32_16x16x32_bf16 v[142:145], a[32:35], v[210:213], v[142:145]
    s_waitcnt lgkmcnt(4)
    v_cvt_pk_bf16_f32 v197, v197, v197
    v_cvt_pk_bf16_f32 v226, v226, v226
    v_mfma_f32_16x16x32_bf16 v[142:145], a[36:39], v[214:217], v[142:145]
    s_waitcnt lgkmcnt(3)
    ds_write2_b32 v158, v194, v195 offset0:16 offset1:84
    v_mfma_f32_16x16x32_bf16 v[142:145], a[40:43], v[218:221], v[142:145]
    v_cvt_pk_bf16_f32 v227, v227, v227
    v_cvt_pk_bf16_f32 v228, v228, v228
    v_mfma_f32_16x16x32_bf16 v[142:145], a[44:47], v[222:225], v[142:145]
    buffer_load_dwordx4 v165, s[52:55], 0 offen offset:1024 lds
    v_cvt_pk_bf16_f32 v229, v229, v229
    v_mfma_f32_16x16x32_bf16 v[170:173], a[48:51], v[166:169], 0
    ds_write2_b32 v158, v196, v197 offset0:152 offset1:220
    v_mfma_f32_16x16x32_bf16 v[170:173], a[52:55], v[206:209], v[170:173]
    v_cvt_pk_f16_f32 v134, v134, v135
    v_pk_mul_f16 v174, v134, v134
    v_mfma_f32_16x16x32_bf16 v[170:173], a[56:59], v[210:213], v[170:173]
    ds_write2_b32 v158, v226, v227 offset0:32 offset1:100
    s_waitcnt vmcnt(5)
    v_mfma_f32_16x16x32_bf16 v[170:173], a[60:63], v[214:217], v[170:173]
    v_cvt_pk_f16_f32 v135, v136, v137
    v_pk_fma_f16 v174, v135, v135, v174
    v_mfma_f32_16x16x32_bf16 v[170:173], a[64:67], v[218:221], v[170:173]
    buffer_load_dwordx4 v131, s[52:55], 0 offen offset:2048 lds
    ds_read_b64 a[222:223], v130 offset:0
    v_mfma_f32_16x16x32_bf16 v[170:173], a[68:71], v[222:225], v[170:173]
    s_add_u32 s52, s52, 12288
    ds_read_b64 a[234:235], v130 offset:1536
    ds_read_b64 a[246:247], v130 offset:8
    v_mfma_f32_16x16x32_bf16 v[178:181], v[166:169], a[144:147], 0
    s_addc_u32 s53, s53, 0
    ds_read_b64 v[84:85], v130 offset:1544
    ds_read_b64 v[96:97], v133 offset:0
    v_mfma_f32_16x16x32_bf16 v[178:181], v[206:209], a[148:151], v[178:181]
    s_add_u32 m0, s69, 3072
    ds_read_b64 v[108:109], v133 offset:1536
    v_cvt_pk_f16_f32 v136, v142, v143
    v_mfma_f32_16x16x32_bf16 v[178:181], v[210:213], a[152:155], v[178:181]
    s_add_u32 s69, s77, 589824
    ds_write2_b32 v158, v228, v229 offset0:168 offset1:236
    v_mfma_f32_16x16x32_bf16 v[178:181], v[214:217], a[156:159], v[178:181]
    buffer_load_dwordx4 v164, s[52:55], 0 offen lds
    v_pk_fma_f16 v174, v136, v136, v174
    v_mfma_f32_16x16x32_bf16 v[178:181], v[218:221], a[160:163], v[178:181]
    v_cvt_pk_f16_f32 v137, v144, v145
    v_pk_fma_f16 v174, v137, v137, v174
    v_mfma_f32_16x16x32_bf16 v[178:181], v[222:225], a[164:167], v[178:181]
    ds_read_b128 v[142:145], v0 offset:20480
    v_cvt_pk_f16_f32 v122, v170, v171
    v_mfma_f32_16x16x32_bf16 v[182:185], v[166:169], a[168:171], 0
    s_waitcnt lgkmcnt(6)
    ds_read_b128 v[186:189], v1 offset:20480
    v_pk_fma_f16 v174, v122, v122, v174
    v_mfma_f32_16x16x32_bf16 v[182:185], v[206:209], a[172:175], v[182:185]
    s_waitcnt lgkmcnt(5)
    ds_read_b128 v[190:193], v0 offset:20608
    v_cvt_pk_f16_f32 v123, v172, v173
    v_mfma_f32_16x16x32_bf16 v[182:185], v[210:213], a[176:179], v[182:185]
    s_waitcnt lgkmcnt(4)
    ds_read_b128 v[170:173], v1 offset:20608
    buffer_load_dwordx4 v165, s[52:55], 0 offen offset:1024 lds
    v_mfma_f32_16x16x32_bf16 v[182:185], v[214:217], a[180:183], v[182:185]
    ds_read_b128 v[194:197], v0 offset:20736
    v_pk_fma_f16 v174, v123, v123, v174
    v_mfma_f32_16x16x32_bf16 v[182:185], v[218:221], a[184:187], v[182:185]
    ds_read_b128 v[198:201], v1 offset:20736
    v_mov_b32 v176, v174
    v_mfma_f32_16x16x32_bf16 v[182:185], v[222:225], a[188:191], v[182:185]
    v_mov_b32 v177, v174
    v_cvt_pk_bf16_f32 v204, v178, v179
    v_mfma_f32_16x16x32_bf16 v[226:229], v[166:169], a[192:195], 0
    v_cvt_pk_bf16_f32 v205, v180, v181
    s_waitcnt vmcnt(5)
    v_mfma_f32_16x16x32_f16 v[166:169], v[40:43], v[174:177], 0
    s_waitcnt lgkmcnt(5)
    ds_read_b64 a[224:225], v130 offset:3072
    ds_read_b64 a[226:227], v130 offset:4608
    v_mfma_f32_16x16x32_bf16 v[226:229], v[206:209], a[196:199], v[226:229]
    s_waitcnt lgkmcnt(6)
    buffer_load_dwordx4 v131, s[52:55], 0 offen offset:2048 lds
    ds_read_b64 a[248:249], v130 offset:3080
    v_mfma_f32_16x16x32_bf16 v[226:229], v[210:213], a[200:203], v[226:229]
    s_add_u32 m0, s28, 65536
    ds_read_b64 a[250:251], v130 offset:4616
    ds_read_b64 v[98:99], v133 offset:3072
    v_mfma_f32_16x16x32_bf16 v[226:229], v[214:217], a[204:207], v[226:229]
    s_waitcnt lgkmcnt(7)
    ds_read_b64 v[100:101], v133 offset:4608
    v_cvt_pk_bf16_f32 v168, v182, v183
    v_mfma_f32_16x16x32_bf16 v[226:229], v[218:221], a[208:211], v[226:229]
    s_waitcnt lgkmcnt(7)
    v_rsq_f32 v166, v166
    v_mfma_f32_16x16x32_bf16 v[226:229], v[222:225], a[212:215], v[226:229]
    s_waitcnt lgkmcnt(6)
    v_rsq_f32 v167, v167
    v_mfma_f32_16x16x32_bf16 v[174:177], v[142:145], a[144:147], 0
    v_mul_f32 v116, s31, v166
    v_cvt_pk_f16_f32 v117, v116, v167
    v_mfma_f32_16x16x32_bf16 v[174:177], v[186:189], a[148:151], v[174:177]
    buffer_load_dwordx4 v10, s[8:11], s24 offen nt lds
    v_mfma_f32_16x16x32_bf16 v[174:177], v[190:193], a[152:155], v[174:177]
    s_add_u32 m0, s28, 69632
    v_pk_mul_f16 v150, v150, v117 op_sel:[0,1] op_sel_hi:[1,1]
    v_pk_mul_f16 v151, v151, v117 op_sel:[0,1] op_sel_hi:[1,1]
    v_mfma_f32_16x16x32_bf16 v[174:177], v[170:173], a[156:159], v[174:177]
    s_waitcnt lgkmcnt(3)
    v_pk_mul_f16 v152, v152, v117 op_sel:[0,1] op_sel_hi:[1,1]
    v_pk_mul_f16 v153, v153, v117 op_sel:[0,1] op_sel_hi:[1,1]
    v_mfma_f32_16x16x32_bf16 v[174:177], v[194:197], a[160:163], v[174:177]
    s_waitcnt lgkmcnt(1)
    v_pk_mul_f16 v124, v124, v117 op_sel:[0,1] op_sel_hi:[1,1]
    v_pk_mul_f16 v125, v125, v117 op_sel:[0,1] op_sel_hi:[1,1]
    v_mfma_f32_16x16x32_bf16 v[174:177], v[198:201], a[164:167], v[174:177]
    s_waitcnt lgkmcnt(0)
    ds_read_b128 v[178:181], v0 offset:32768
    v_pk_mul_f16 v134, v134, v117 op_sel:[0,0] op_sel_hi:[1,0]
    v_mfma_f32_16x16x32_bf16 v[206:209], v[142:145], a[168:171], 0
    ds_read_b128 v[210:213], v1 offset:32768
    v_pk_mul_f16 v135, v135, v117 op_sel:[0,0] op_sel_hi:[1,0]
    v_mfma_f32_16x16x32_bf16 v[206:209], v[186:189], a[172:175], v[206:209]
    buffer_load_dwordx4 v11, s[8:11], s24 offen nt lds
    v_mfma_f32_16x16x32_bf16 v[206:209], v[190:193], a[176:179], v[206:209]
    s_add_u32 m0, s28, 73728
    ds_read_b128 v[214:217], v0 offset:32896
    ds_read_b128 v[218:221], v1 offset:32896
    v_mfma_f32_16x16x32_bf16 v[206:209], v[170:173], a[180:183], v[206:209]
    ds_read_b128 v[222:225], v0 offset:33024
    v_pk_mul_f16 v136, v136, v117 op_sel:[0,0] op_sel_hi:[1,0]
    v_mfma_f32_16x16x32_bf16 v[206:209], v[194:197], a[184:187], v[206:209]
    ds_read_b128 v[230:233], v1 offset:33024
    s_waitcnt vmcnt(5)
    v_mfma_f32_16x16x32_bf16 v[206:209], v[198:201], a[188:191], v[206:209]
    ds_read_b64 a[236:237], v114 offset:0
    ds_read_b64 a[228:229], v114 offset:1536
    v_mfma_f32_16x16x32_bf16 v[234:237], v[142:145], a[192:195], 0
    ds_read_b64 v[86:87], v114 offset:8
    ds_read_b64 a[252:253], v114 offset:1544
    v_mfma_f32_16x16x32_bf16 v[234:237], v[186:189], a[196:199], v[234:237]
    s_waitcnt lgkmcnt(9)
    buffer_load_dwordx4 v12, s[8:11], s24 offen nt lds
    v_mfma_f32_16x16x32_bf16 v[234:237], v[190:193], a[200:203], v[234:237]
    s_add_u32 m0, s28, 77824
    ds_read_b64 v[110:111], v254 offset:0
    ds_read_b64 v[102:103], v254 offset:1536
    v_mfma_f32_16x16x32_bf16 v[234:237], v[170:173], a[204:207], v[234:237]
    s_waitcnt lgkmcnt(10)
    ds_read_b128 v[142:145], v154 offset:0
    ds_read_b128 v[170:173], v154 offset:16
    v_mfma_f32_16x16x32_bf16 v[234:237], v[194:197], a[208:211], v[234:237]
    s_waitcnt lgkmcnt(10)
    ds_read_b128 v[186:189], v154 offset:48
    ds_read_b32 v158, v6 offset:192
    v_mfma_f32_16x16x32_bf16 v[234:237], v[198:201], a[212:215], v[234:237]
    s_waitcnt lgkmcnt(11)
    v_pk_mul_f16 v137, v137, v117 op_sel:[0,0] op_sel_hi:[1,0]
    v_pk_mul_f16 v122, v122, v117 op_sel:[0,0] op_sel_hi:[1,0]
    v_mfma_f32_16x16x32_bf16 v[190:193], a[0:3], v[178:181], 0
    s_waitcnt lgkmcnt(10)
    v_pk_mul_f16 v123, v123, v117 op_sel:[0,0] op_sel_hi:[1,0]
    v_max3_u32 v44, v44, v166, v167
    v_mfma_f32_16x16x32_bf16 v[190:193], a[4:7], v[210:213], v[190:193]
    s_waitcnt lgkmcnt(8)
    buffer_load_dwordx4 v13, s[8:11], s24 offen nt lds
    v_mfma_f32_16x16x32_bf16 v[190:193], a[8:11], v[214:217], v[190:193]
    s_add_u32 m0, s74, 0
    v_cvt_pk_bf16_f32 v169, v184, v185
    v_cvt_pk_bf16_f32 v184, v226, v227
    v_mfma_f32_16x16x32_bf16 v[190:193], a[12:15], v[218:221], v[190:193]
    s_waitcnt lgkmcnt(6)
    v_cvt_pk_bf16_f32 v185, v228, v229
    v_cvt_pk_bf16_f32 v202, v174, v175
    v_mfma_f32_16x16x32_bf16 v[190:193], a[16:19], v[222:225], v[190:193]
    s_waitcnt lgkmcnt(4)
    v_cvt_pk_bf16_f32 v203, v176, v177
    v_cvt_pk_bf16_f32 v166, v206, v207
    v_mfma_f32_16x16x32_bf16 v[190:193], a[20:23], v[230:233], v[190:193]
    s_waitcnt lgkmcnt(2)
    v_cvt_pk_bf16_f32 v167, v208, v209
    v_cvt_pk_bf16_f32 v182, v234, v235
    v_mfma_f32_16x16x32_bf16 v[174:177], a[24:27], v[178:181], 0
    s_waitcnt lgkmcnt(0)
    v_cvt_pk_bf16_f32 v183, v236, v237
    v_xor_b32 v0, 65536, v0
    v_mfma_f32_16x16x32_bf16 v[174:177], a[28:31], v[210:213], v[174:177]
    buffer_load_dwordx4 v14, s[8:11], s24 offen nt lds
    v_mfma_f32_16x16x32_bf16 v[174:177], a[32:35], v[214:217], v[174:177]
    s_add_u32 s8, s60, s23
    v_cvt_pk_f16_f32 v190, v190, v191
    s_waitcnt vmcnt(5)
    v_mfma_f32_16x16x32_bf16 v[174:177], a[36:39], v[218:221], v[174:177]
    s_addc_u32 s9, s61, 0
    ds_read_b64 a[230:231], v114 offset:3072
    ds_read_b64 a[238:239], v114 offset:4608
    v_mfma_f32_16x16x32_bf16 v[174:177], a[40:43], v[222:225], v[174:177]
    s_sub_u32 s10, s36, s23
    ds_read_b64 a[254:255], v114 offset:3080
    ds_read_b64 v[88:89], v114 offset:4616
    v_mfma_f32_16x16x32_bf16 v[174:177], a[44:47], v[230:233], v[174:177]
    s_cmp_lt_u32 s34, s17
    ds_read_b64 v[104:105], v254 offset:3072
    ds_read_b64 v[112:113], v254 offset:4608
    v_mfma_f32_16x16x32_bf16 v[194:197], a[48:51], v[178:181], 0
    s_cselect_b32 s10, s10, 0
    v_pk_mul_f16 v114, v190, v190
    v_cvt_pk_f16_f32 v191, v192, v193
    v_mfma_f32_16x16x32_bf16 v[194:197], a[52:55], v[210:213], v[194:197]
    s_add_u32 m0, s28, 0
    v_pk_fma_f16 v114, v191, v191, v114
    v_cvt_pk_f16_f32 v192, v174, v175
    v_mfma_f32_16x16x32_f16 v[198:201], v[146:149], v[138:141], v[46:49]
    s_mov_b32 s24, s23
    v_pk_fma_f16 v114, v192, v192, v114
    v_cvt_pk_f16_f32 v193, v176, v177
    v_mfma_f32_16x16x32_f16 v[174:177], v[150:153], v[138:141], v[50:53]
    s_add_u32 s23, s23, s21
    v_pk_fma_f16 v114, v193, v193, v114
    v_xor_b32 v1, 65536, v1
    v_add_u32 v159, 62784, v159
    v_mfma_f32_16x16x16_f16 v[198:201], v[120:121], v[118:119], v[198:201]
    v_or_b32 v206, v32, v33
    v_and_b32 v206, 0xffff, v206
    v_lshl_or_b32 v206, v206, 16, v206
    v_mfma_f32_16x16x16_f16 v[174:177], v[124:125], v[118:119], v[174:177]
    v_or_b32 v207, v32, v33
    v_and_b32 v207, 0xffff, v207
    v_lshl_or_b32 v207, v207, 16, v207
    v_or_b32 v208, v32, v33
    v_mfma_f32_16x16x32_bf16 v[194:197], a[56:59], v[214:217], v[194:197]
    s_cmp_ge_u32 s19, 72
    v_exp_f32 v198, v198
    v_mfma_f32_16x16x32_bf16 v[194:197], a[60:63], v[218:221], v[194:197]
    s_cselect_b32 s34, 72, 0
    v_exp_f32 v199, v199
    v_mfma_f32_16x16x32_bf16 v[194:197], a[64:67], v[222:225], v[194:197]
    s_cselect_b32 s35, s22, 0
    v_cvt_pk_bf16_f32 v198, v198, v199
    v_lshrrev_b32 v208, 16, v208
    v_mfma_f32_16x16x32_bf16 v[194:197], a[68:71], v[230:233], v[194:197]
    s_sub_u32 s19, s19, s34
    v_exp_f32 v200, v200
    v_mfma_f32_16x16x32_bf16 v[226:229], v[178:181], a[144:147], 0
    s_add_u32 s23, s23, s35
    v_exp_f32 v201, v201
    v_mfma_f32_16x16x32_bf16 v[226:229], v[210:213], a[148:151], v[226:229]
    s_waitcnt lgkmcnt(0)
    v_cvt_pk_bf16_f32 v199, v200, v201
    v_cvt_pk_f16_f32 v154, v194, v195
    v_mfma_f32_16x16x32_bf16 v[226:229], v[214:217], a[152:155], v[226:229]
    v_pk_fma_f16 v114, v154, v154, v114
    v_cvt_pk_f16_f32 v155, v196, v197
    v_mfma_f32_16x16x32_bf16 v[226:229], v[218:221], a[156:159], v[226:229]
    v_pk_fma_f16 v114, v155, v155, v114
    v_mov_b32 v116, v114
    v_mfma_f32_16x16x32_f16 v[194:197], v[142:145], v[138:141], v[22:25]
    v_mov_b32 v117, v114
    v_lshl_or_b32 v208, v208, 16, v208
    v_mfma_f32_16x16x32_f16 v[194:197], v[170:173], v[146:149], v[194:197]
    v_exp_f32 v174, v174
    v_mfma_f32_16x16x32_f16 v[234:237], v[40:43], v[114:117], 0
    v_exp_f32 v175, v175
    v_mfma_f32_16x16x32_f16 v[194:197], v[186:189], v[118:121], v[194:197]
    v_cvt_pk_bf16_f32 v200, v174, v175
    v_or_b32 v209, v32, v33
    v_mfma_f32_16x16x32_bf16 v[226:229], v[222:225], a[160:163], v[226:229]
    v_exp_f32 v176, v176
    v_mfma_f32_16x16x32_bf16 v[226:229], v[230:233], a[164:167], v[226:229]
    v_exp_f32 v177, v177
    v_mfma_f32_16x16x32_bf16 v[114:117], v[178:181], a[168:171], 0
    v_rsq_f32 v234, v234
    v_mfma_f32_16x16x32_bf16 v[114:117], v[210:213], a[172:175], v[114:117]
    v_rsq_f32 v235, v235
    v_mfma_f32_16x16x32_bf16 v[114:117], v[214:217], a[176:179], v[114:117]
    v_mul_f32 v164, s31, v234
    v_cvt_pk_f16_f32 v165, v164, v235
    v_mfma_f32_16x16x32_bf16 v[114:117], v[218:221], a[180:183], v[114:117]
    v_pk_mul_f16 v126, v126, v165 op_sel:[0,1] op_sel_hi:[1,1]
    v_pk_mul_f16 v127, v127, v165 op_sel:[0,1] op_sel_hi:[1,1]
    v_mfma_f32_16x16x32_bf16 v[114:117], v[222:225], a[184:187], v[114:117]
    v_pk_mul_f16 v128, v128, v165 op_sel:[0,1] op_sel_hi:[1,1]
    v_pk_mul_f16 v129, v129, v165 op_sel:[0,1] op_sel_hi:[1,1]
    v_mfma_f32_16x16x32_bf16 v[114:117], v[230:233], a[188:191], v[114:117]
    v_pk_mul_f16 v156, v156, v165 op_sel:[0,1] op_sel_hi:[1,1]
    v_pk_mul_f16 v157, v157, v165 op_sel:[0,1] op_sel_hi:[1,1]
    v_pk_mul_f16 v190, v190, v165 op_sel:[0,0] op_sel_hi:[1,0]
    v_pk_mul_f16 v191, v191, v165 op_sel:[0,0] op_sel_hi:[1,0]
    v_pk_mul_f16 v192, v192, v165 op_sel:[0,0] op_sel_hi:[1,0]
    v_pk_mul_f16 v193, v193, v165 op_sel:[0,0] op_sel_hi:[1,0]
    v_pk_mul_f16 v154, v154, v165 op_sel:[0,0] op_sel_hi:[1,0]
    v_pk_mul_f16 v155, v155, v165 op_sel:[0,0] op_sel_hi:[1,0]
    v_mfma_f32_16x16x32_f16 v[238:241], v[126:129], v[138:141], v[54:57]
    v_max3_u32 v44, v44, v234, v235
    v_cvt_pk_bf16_f32 v138, v226, v227
    v_mfma_f32_16x16x32_f16 v[234:237], v[142:145], v[134:137], v[24:27]
    v_cvt_pk_bf16_f32 v139, v228, v229
    v_cvt_pk_bf16_f32 v114, v114, v115
    v_mfma_f32_16x16x32_f16 v[234:237], v[170:173], v[150:153], v[234:237]
    v_cvt_pk_bf16_f32 v115, v116, v117
    v_mov_b32_dpp v158, v195 quad_perm:[0,1,2,3] row_mask:0x1 bank_mask:0xf
    v_mov_b32 v25, 0
    v_mfma_f32_16x16x16_f16 v[238:241], v[156:157], v[118:119], v[238:241]
    v_cvt_pk_bf16_f32 v201, v176, v177
    v_exp_f32 v194, v194
    v_lshrrev_b32 v209, 16, v209
    v_mfma_f32_16x16x32_f16 v[234:237], v[186:189], v[122:125], v[234:237]
    v_cvt_pk_bf16_f32 v39, v194, 0
    v_lshl_or_b32 v209, v209, 16, v209
    v_mfma_f32_16x16x32_bf16 v[174:177], v[178:181], a[192:195], 0
    v_xor_b32 v2, 65536, v2
    v_mfma_f32_16x16x32_bf16 v[174:177], v[210:213], a[196:199], v[174:177]
    ds_read2_b32 v[140:141], v6 offset0:0 offset1:0
    ds_read2_b32 v[116:117], v6 offset0:16 offset1:16
    v_mfma_f32_16x16x32_bf16 v[174:177], v[214:217], a[200:203], v[174:177]
    ds_read2_b32 v[180:181], v6 offset0:32 offset1:32
    v_add_u32 v6, 272, v6
    v_mfma_f32_16x16x32_f16 v[194:197], v[142:145], v[190:193], v[26:29]
    v_exp_f32 v234, v234
    v_mfma_f32_16x16x32_f16 v[194:197], v[170:173], v[126:129], v[194:197]
    v_exp_f32 v238, v238
    v_mfma_f32_16x16x32_f16 v[194:197], v[186:189], v[154:157], v[194:197]
    v_exp_f32 v239, v239
    v_mfma_f32_16x16x32_bf16 v[174:177], v[218:221], a[204:207], v[174:177]
    v_mov_b32_dpp v158, v235 quad_perm:[0,1,2,3] row_mask:0x2 bank_mask:0xf
    v_cvt_pk_bf16_f32 v36, v238, v239
    v_mfma_f32_16x16x32_bf16 v[174:177], v[222:225], a[208:211], v[174:177]
    v_exp_f32 v240, v240
    v_mfma_f32_16x16x32_bf16 v[174:177], v[230:233], a[212:215], v[174:177]
    v_exp_f32 v241, v241
    v_mfma_f32_16x16x32_f16 v[142:145], v[146:149], v[134:137], v[58:61]
    s_waitcnt lgkmcnt(1)
    v_mov_b32_dpp v158, v195 quad_perm:[0,1,2,3] row_mask:0x4 bank_mask:0xf
    v_cvt_pk_bf16_f32 v37, v240, v241
    v_mfma_f32_16x16x32_f16 v[170:173], v[150:153], v[134:137], v[62:65]
    s_waitcnt lgkmcnt(0)
    v_exp_f32 v158, v158
    v_mfma_f32_16x16x32_bf16 v[186:189], v[28:31], v[36:39], 0
    v_cvt_pk_bf16_f32 v178, v174, v175
    v_cvt_pk_bf16_f32 v179, v176, v177
    v_mfma_f32_16x16x32_bf16 v[186:189], v[28:31], v[198:201], v[186:189]
    v_exp_f32 v194, v194
    v_mfma_f32_16x16x32_bf16 v[174:177], v[138:141], v[36:39], 0
    v_cvt_pk_bf16_f32 v158, v158, v158
    v_mfma_f32_16x16x32_bf16 v[174:177], v[202:205], v[198:201], v[174:177]
    ds_write_b16 v8, v158
    v_mfma_f32_16x16x32_bf16 v[210:213], v[114:117], v[36:39], 0
    v_mfma_f32_16x16x32_bf16 v[210:213], v[166:169], v[198:201], v[210:213]
    v_mfma_f32_16x16x32_bf16 v[214:217], v[178:181], v[36:39], 0
    v_rcp_f32 v186, v186
    v_mfma_f32_16x16x32_bf16 v[214:217], v[182:185], v[198:201], v[214:217]
    v_cvt_pk_bf16_f32 v39, v234, 0
    v_max3_u32 v25, v25, v186, v187
    v_mfma_f32_16x16x32_f16 v[198:201], v[126:129], v[134:137], v[66:69]
    v_mul_f32 v174, v186, v174
    v_mul_f32 v175, v186, v175
    v_cvt_pk_bf16_f32 v134, v174, v175
    v_mfma_f32_16x16x16_f16 v[142:145], v[120:121], v[122:123], v[142:145]
    v_mul_f32 v176, v186, v176
    v_mul_f32 v177, v186, v177
    v_cvt_pk_bf16_f32 v135, v176, v177
    v_mfma_f32_16x16x16_f16 v[170:173], v[124:125], v[122:123], v[170:173]
    v_mul_f32 v210, v186, v210
    v_mul_f32 v211, v186, v211
    v_cvt_pk_bf16_f32 v136, v210, v211
    v_mfma_f32_16x16x16_f16 v[198:201], v[156:157], v[122:123], v[198:201]
    v_exp_f32 v142, v142
    v_exp_f32 v143, v143
    v_mfma_f32_16x16x32_f16 v[174:177], v[146:149], v[190:193], v[70:73]
    v_cvt_pk_bf16_f32 v118, v142, v143
    v_mul_f32 v212, v186, v212
    v_mfma_f32_16x16x32_bf16 v[146:149], v[206:209], a[216:219], 0
    v_exp_f32 v144, v144
    v_mfma_f32_16x16x32_f16 v[218:221], v[150:153], v[190:193], v[74:77]
    v_exp_f32 v145, v145
    v_mul_f32 v213, v186, v213
    v_mfma_f32_16x16x16_f16 v[174:177], v[120:121], v[154:155], v[174:177]
    v_cvt_pk_bf16_f32 v119, v144, v145
    v_exp_f32 v170, v170
    v_cvt_pk_bf16_f32 v137, v212, v213
    v_mfma_f32_16x16x32_f16 v[142:145], v[126:129], v[190:193], v[78:81]
    v_exp_f32 v171, v171
    v_mul_f32 v214, v186, v214
    v_mfma_f32_16x16x16_f16 v[218:221], v[124:125], v[154:155], v[218:221]
    v_cvt_pk_bf16_f32 v120, v170, v171
    v_exp_f32 v172, v172
    v_mul_f32 v215, v186, v215
    v_mfma_f32_16x16x16_f16 v[142:145], v[156:157], v[154:155], v[142:145]
    v_exp_f32 v173, v173
    v_exp_f32 v198, v198
    v_mfma_f32_16x16x32_bf16 v[146:149], v[206:209], a[240:243], v[146:149]
    v_cvt_pk_bf16_f32 v121, v172, v173
    v_cvt_pk_bf16_f32 v164, v214, v215
    v_mfma_f32_16x16x32_bf16 v[146:149], v[206:209], v[90:93], v[146:149]
    v_exp_f32 v199, v199
    v_mfma_f32_16x16x32_bf16 v[122:125], v[206:209], a[220:223], 0
    v_cvt_pk_bf16_f32 v36, v198, v199
    v_mul_f32 v216, v186, v216
    v_mfma_f32_16x16x32_bf16 v[122:125], v[206:209], a[244:247], v[122:125]
    v_exp_f32 v200, v200
    v_mfma_f32_16x16x32_bf16 v[122:125], v[206:209], v[94:97], v[122:125]
    v_exp_f32 v201, v201
    v_mfma_f32_16x16x32_bf16 v[126:129], v[206:209], a[232:235], 0
    v_mov_b32 v254, v146
    v_cvt_pk_bf16_f32 v37, v200, v201
    v_mfma_f32_16x16x32_bf16 v[126:129], v[206:209], v[82:85], v[126:129]
    v_mov_b32_dpp v254, v147 quad_perm:[0,1,2,3] row_mask:0x2 bank_mask:0xf
    v_mul_f32 v217, v186, v217
    v_mfma_f32_16x16x32_bf16 v[146:149], v[28:31], v[36:39], 0
    v_mov_b32 v158, v123
    v_cvt_pk_bf16_f32 v165, v216, v217
    v_mfma_f32_16x16x32_bf16 v[146:149], v[28:31], v[118:121], v[146:149]
    v_exp_f32 v174, v174
    v_mfma_f32_16x16x32_bf16 v[150:153], v[138:141], v[36:39], 0
    v_exp_f32 v175, v175
    v_mfma_f32_16x16x32_bf16 v[150:153], v[202:205], v[118:121], v[150:153]
    v_exp_f32 v176, v176
    v_mfma_f32_16x16x32_bf16 v[154:157], v[114:117], v[36:39], 0
    v_exp_f32 v177, v177
    v_mfma_f32_16x16x32_bf16 v[154:157], v[166:169], v[118:121], v[154:157]
    v_cvt_pk_bf16_f32 v170, v174, v175
    v_cvt_pk_bf16_f32 v171, v176, v177
    v_mfma_f32_16x16x32_bf16 v[174:177], v[178:181], v[36:39], 0
    v_exp_f32 v218, v218
    v_mfma_f32_16x16x32_bf16 v[174:177], v[182:185], v[118:121], v[174:177]
    v_exp_f32 v219, v219
    v_mfma_f32_16x16x32_bf16 v[126:129], v[206:209], v[106:109], v[126:129]
    v_cvt_pk_bf16_f32 v172, v218, v219
    v_cvt_pk_bf16_f32 v39, v194, 0
    v_mfma_f32_16x16x32_bf16 v[118:121], v[206:209], a[224:227], 0
    v_exp_f32 v220, v220
    v_mfma_f32_16x16x32_bf16 v[118:121], v[206:209], a[248:251], v[118:121]
    v_exp_f32 v221, v221
    v_mfma_f32_16x16x32_bf16 v[118:121], v[206:209], v[98:101], v[118:121]
    v_exp_f32 v142, v142
    v_mfma_f32_16x16x32_bf16 v[186:189], v[206:209], a[228:231], 0
    v_mov_b32_dpp v254, v126 quad_perm:[0,1,2,3] row_mask:0x4 bank_mask:0xf
    v_mov_b32_dpp v158, v127 quad_perm:[0,1,2,3] row_mask:0x2 bank_mask:0xf
    v_mfma_f32_16x16x32_bf16 v[186:189], v[206:209], a[252:255], v[186:189]
    v_mov_b32_dpp v254, v122 quad_perm:[0,1,2,3] row_mask:0x8 bank_mask:0xf
    v_cvt_pk_bf16_f32 v173, v220, v221
    v_mfma_f32_16x16x32_bf16 v[186:189], v[206:209], v[102:105], v[186:189]
    ds_write_b32 v160, v254 offset:18432
    v_mfma_f32_16x16x32_bf16 v[122:125], v[206:209], a[236:239], 0
    v_exp_f32 v143, v143
    v_mfma_f32_16x16x32_bf16 v[122:125], v[206:209], v[86:89], v[122:125]
    v_mov_b32_dpp v158, v118 quad_perm:[0,1,2,3] row_mask:0x4 bank_mask:0xf
    v_cvt_pk_bf16_f32 v36, v142, v143
    v_mfma_f32_16x16x32_bf16 v[122:125], v[206:209], v[110:113], v[122:125]
    v_mov_b32_dpp v158, v119 quad_perm:[0,1,2,3] row_mask:0x8 bank_mask:0xf
    v_exp_f32 v144, v144
    v_exp_f32 v145, v145
    ds_read_b128 v[118:121], v9
    ds_read_b128 v[126:129], v9 offset:64
    ds_write_b32 v160, v158 offset:19456
    v_cvt_pk_bf16_f32 v37, v144, v145
    v_rcp_f32 v146, v146
    v_mov_b32 v254, v122
    v_mfma_f32_16x16x32_bf16 v[142:145], v[28:31], v[36:39], 0
    v_max3_u32 v25, v25, v146, v147
    v_mov_b32_dpp v254, v186 quad_perm:[0,1,2,3] row_mask:0x2 bank_mask:0xf
    v_mfma_f32_16x16x32_bf16 v[142:145], v[28:31], v[170:173], v[142:145]
    v_mul_f32 v150, v146, v150
    v_mov_b32_dpp v254, v187 quad_perm:[0,1,2,3] row_mask:0x4 bank_mask:0xf
    v_mfma_f32_16x16x32_bf16 v[186:189], v[138:141], v[36:39], 0
    v_mul_f32 v151, v146, v151
    v_mov_b32_dpp v254, v123 quad_perm:[0,1,2,3] row_mask:0x8 bank_mask:0xf
    v_mfma_f32_16x16x32_bf16 v[186:189], v[202:205], v[170:173], v[186:189]
    ds_write_b32 v160, v254 offset:63552
    v_mfma_f32_16x16x32_bf16 v[206:209], v[114:117], v[36:39], 0
    v_rcp_f32 v142, v142
    v_mfma_f32_16x16x32_bf16 v[206:209], v[166:169], v[170:173], v[206:209]
    s_waitcnt lgkmcnt(2)
    v_max3_u32 v25, v25, v142, v143
    v_cvt_pk_bf16_f32 v130, v150, v151
    v_mfma_f32_16x16x32_bf16 v[210:213], v[118:121], v[28:31], 0
    v_mul_f32 v186, v142, v186
    v_mul_f32 v187, v142, v187
    v_mfma_f32_16x16x32_bf16 v[210:213], v[126:129], v[28:31], v[210:213]
    v_cvt_pk_bf16_f32 v214, v186, v187
    v_mul_f32 v188, v142, v188
    v_mfma_f32_16x16x32_bf16 v[218:221], v[118:121], v[202:205], 0
    v_mul_f32 v189, v142, v189
    v_cvt_pk_bf16_f32 v215, v188, v189
    v_mfma_f32_16x16x32_bf16 v[218:221], v[126:129], v[138:141], v[218:221]
    v_mul_f32 v206, v142, v206
    v_mul_f32 v207, v142, v207
    v_mfma_f32_16x16x32_bf16 v[138:141], v[118:121], v[166:169], 0
    v_rcp_f32 v210, v210
    v_mfma_f32_16x16x32_bf16 v[138:141], v[126:129], v[114:117], v[138:141]
    s_waitcnt lgkmcnt(0)
    v_max3_u32 v25, v25, v210, v211
    v_cvt_pk_bf16_f32 v216, v206, v207
    v_mfma_f32_16x16x32_bf16 v[114:117], v[118:121], v[182:185], 0
    s_barrier
    s_waitcnt vmcnt(0)
    ds_read_b128 v[166:169], v255 offset:18432
    v_mfma_f32_16x16x32_bf16 v[114:117], v[126:129], v[178:181], v[114:117]
    s_barrier
    ds_read_b128 v[186:189], v0 offset:20480
    ds_read_b128 v[194:197], v1 offset:20480
    v_mfma_f32_16x16x32_bf16 v[126:129], v[178:181], v[36:39], 0
    ds_read_b128 v[122:125], v0 offset:20608
    buffer_load_dwordx4 v10, s[8:11], 0 offen nt lds
    v_mfma_f32_16x16x32_bf16 v[126:129], v[182:185], v[170:173], v[126:129]
    s_add_u32 m0, s28, 4096
    ds_read_b128 v[202:205], v1 offset:20608
    ds_read_b128 v[230:233], v0 offset:20736
    ds_read_b128 v[238:241], v1 offset:20736
    ds_read_b128 v[170:173], v255 offset:19456
    ds_read_b128 v[178:181], v255 offset:63552
    ds_write_b128 v3, v[134:137] offset:0
    s_waitcnt lgkmcnt(7)
    v_mfma_f32_16x16x32_bf16 v[118:121], a[72:75], v[186:189], 0
    s_waitcnt lgkmcnt(6)
    buffer_load_dwordx4 v11, s[8:11], 0 offen nt lds
    v_add_f32 v166, v166, v167
    v_mfma_f32_16x16x32_bf16 v[118:121], a[76:79], v[194:197], v[118:121]
    s_add_u32 m0, s28, 8192
    v_add_f32 v168, v168, v169
    v_add_f32 v166, v166, v168
    v_mfma_f32_16x16x32_bf16 v[118:121], a[80:83], v[122:125], v[118:121]
    s_waitcnt lgkmcnt(4)
    ds_write_b64 v4, v[164:165] offset:4096
    v_mfma_f32_16x16x32_bf16 v[118:121], a[84:87], v[202:205], v[118:121]
    s_waitcnt lgkmcnt(3)
    v_mul_f32 v166, 0xbbaaaaab, v166
    v_add_f32 v170, v170, v171
    v_mfma_f32_16x16x32_bf16 v[118:121], a[88:91], v[230:233], v[118:121]
    s_waitcnt lgkmcnt(2)
    ds_write_b32 v132, v166 offset:0
    v_mfma_f32_16x16x32_bf16 v[118:121], a[92:95], v[238:241], v[118:121]
    buffer_load_dwordx4 v12, s[8:11], 0 offen nt lds
    v_add_f32 v172, v172, v173
    v_mfma_f32_16x16x32_bf16 v[190:193], a[96:99], v[186:189], 0
    s_add_u32 m0, s28, 12288
    ds_read_b128 v[134:137], v159 offset:0
    ds_read_b128 v[166:169], v159 offset:64
    v_mfma_f32_16x16x32_bf16 v[190:193], a[100:103], v[194:197], v[190:193]
    s_xor_b32 s28, s28, 65536
    ds_read_b128 v[182:185], v159 offset:128
    ds_read_b128 v[222:225], v159 offset:192
    v_mfma_f32_16x16x32_bf16 v[190:193], a[104:107], v[122:125], v[190:193]
    v_add_f32 v170, v170, v172
    v_mul_f32 v170, 0xbbaaaaab, v170
    v_mfma_f32_16x16x32_bf16 v[190:193], a[108:111], v[202:205], v[190:193]
    ds_write_b32 v132, v170 offset:256
    v_mfma_f32_16x16x32_bf16 v[190:193], a[112:115], v[230:233], v[190:193]
    v_add_f32 v178, v178, v179
    v_add_f32 v180, v180, v181
    v_mfma_f32_16x16x32_bf16 v[190:193], a[116:119], v[238:241], v[190:193]
    buffer_load_dwordx4 v13, s[8:11], 0 offen nt lds
    v_add_f32 v178, v178, v180
    v_mfma_f32_16x16x32_bf16 v[198:201], a[120:123], v[186:189], 0
    s_mov_b32 m0, s29
    v_mul_f32 v178, 0xbbaaaaab, v178
    v_mul_f32 v218, v218, v210
    v_mfma_f32_16x16x32_bf16 v[198:201], a[124:127], v[194:197], v[198:201]
    s_xor_b32 s29, s29, s30
    ds_write_b32 v132, v178 offset:512
    v_mfma_f32_16x16x32_bf16 v[198:201], a[128:131], v[122:125], v[198:201]
    s_waitcnt lgkmcnt(4)
    v_mul_f32_dpp v218, v138, v210 quad_perm:[0,1,2,3] row_mask:0x2 bank_mask:0xf
    v_mul_f32 v208, v142, v208
    v_mul_f32 v209, v142, v209
    v_mfma_f32_16x16x16_bf16 v[138:141], a[216:217], v[162:163], v[134:137]
    v_mul_f32_dpp v218, v114, v210 quad_perm:[0,1,2,3] row_mask:0x4 bank_mask:0xf
    v_cvt_pk_bf16_f32 v218, v218, v218
    v_cvt_pk_bf16_f32 v217, v208, v209
    v_mfma_f32_16x16x16_bf16 v[114:117], a[240:241], v[162:163], v[134:137]
    v_mul_f32 v126, v142, v126
    v_mul_f32 v127, v142, v127
    v_cvt_pk_bf16_f32 v164, v126, v127
    v_mfma_f32_16x16x16_bf16 v[170:173], v[90:91], v[162:163], v[134:137]
    v_cvt_pk_bf16_f32 v138, v138, v139
    v_accvgpr_write_b32 a216, v138
    v_cvt_pk_bf16_f32 v140, v140, v141
    v_mfma_f32_16x16x16_bf16 v[178:181], a[218:219], v[162:163], v[166:169]
    v_accvgpr_write_b32 a217, v140
    v_cvt_pk_bf16_f32 v114, v114, v115
    v_accvgpr_write_b32 a240, v114
    v_mfma_f32_16x16x16_bf16 v[134:137], a[242:243], v[162:163], v[166:169]
    v_cvt_pk_bf16_f32 v116, v116, v117
    v_accvgpr_write_b32 a241, v116
    v_cvt_pk_bf16_f32 v90, v170, v171
    v_mfma_f32_16x16x16_bf16 v[114:117], v[92:93], v[162:163], v[166:169]
    v_cvt_pk_bf16_f32 v91, v172, v173
    v_cvt_pk_bf16_f32 v178, v178, v179
    v_accvgpr_write_b32 a218, v178
    v_cvt_pk_bf16_f32 v180, v180, v181
    v_mfma_f32_16x16x32_bf16 v[198:201], a[132:135], v[202:205], v[198:201]
    s_waitcnt lgkmcnt(0)
    buffer_load_dwordx4 v14, s[8:11], 0 offen nt lds
    ds_read_b128 v[138:141], v159 offset:256
    v_accvgpr_write_b32 a219, v180
    v_mfma_f32_16x16x16_bf16 v[166:169], a[232:233], v[162:163], v[182:185]
    v_cvt_pk_bf16_f32 v134, v134, v135
    v_accvgpr_write_b32 a242, v134
    v_cvt_pk_bf16_f32 v136, v136, v137
    v_mfma_f32_16x16x16_bf16 v[170:173], v[82:83], v[162:163], v[182:185]
    v_accvgpr_write_b32 a243, v136
    v_cvt_pk_bf16_f32 v92, v114, v115
    v_cvt_pk_bf16_f32 v93, v116, v117
    v_mfma_f32_16x16x16_bf16 v[114:117], v[106:107], v[162:163], v[182:185]
    v_cvt_pk_bf16_f32 v166, v166, v167
    v_accvgpr_write_b32 a232, v166
    v_cvt_pk_bf16_f32 v168, v168, v169
    v_mfma_f32_16x16x16_bf16 v[134:137], a[220:221], v[162:163], v[222:225]
    v_accvgpr_write_b32 a233, v168
    v_cvt_pk_bf16_f32 v82, v170, v171
    v_cvt_pk_bf16_f32 v83, v172, v173
    v_mfma_f32_16x16x16_bf16 v[166:169], a[244:245], v[162:163], v[222:225]
    v_cvt_pk_bf16_f32 v106, v114, v115
    v_cvt_pk_bf16_f32 v107, v116, v117
    v_mul_f32 v128, v142, v128
    v_mfma_f32_16x16x16_bf16 v[114:117], v[94:95], v[162:163], v[222:225]
    v_cvt_pk_bf16_f32 v134, v134, v135
    v_accvgpr_write_b32 a220, v134
    v_cvt_pk_bf16_f32 v136, v136, v137
    v_accvgpr_write_b32 a221, v136
    v_mfma_f32_16x16x32_bf16 v[198:201], a[136:139], v[230:233], v[198:201]
    s_waitcnt lgkmcnt(0)
    ds_read_b128 v[134:137], v159 offset:320
    ds_read_b128 v[170:173], v159 offset:384
    v_cvt_pk_bf16_f32 v166, v166, v167
    v_mfma_f32_16x16x16_bf16 v[178:181], a[222:223], v[162:163], v[138:141]
    v_accvgpr_write_b32 a244, v166
    v_cvt_pk_bf16_f32 v168, v168, v169
    v_accvgpr_write_b32 a245, v168
    v_mfma_f32_16x16x16_bf16 v[166:169], a[246:247], v[162:163], v[138:141]
    v_cvt_pk_bf16_f32 v94, v114, v115
    v_cvt_pk_bf16_f32 v95, v116, v117
    v_mul_f32 v129, v142, v129
    v_mfma_f32_16x16x16_bf16 v[114:117], v[96:97], v[162:163], v[138:141]
    v_cvt_pk_bf16_f32 v178, v178, v179
    v_accvgpr_write_b32 a222, v178
    v_cvt_pk_bf16_f32 v180, v180, v181
    v_accvgpr_write_b32 a223, v180
    v_mfma_f32_16x16x32_bf16 v[198:201], a[140:143], v[238:241], v[198:201]
    ds_read_b128 v[142:145], v159 offset:448
    v_cvt_pk_bf16_f32 v166, v166, v167
    v_mfma_f32_16x16x32_bf16 v[138:141], a[0:3], v[186:189], 0
    ds_write_b128 v3, v[214:217] offset:12288
    v_mfma_f32_16x16x32_bf16 v[138:141], a[4:7], v[194:197], v[138:141]
    s_waitcnt lgkmcnt(3)
    v_accvgpr_write_b32 a246, v166
    v_cvt_pk_bf16_f32 v168, v168, v169
    v_accvgpr_write_b32 a247, v168
    v_mfma_f32_16x16x16_bf16 v[166:169], a[234:235], v[162:163], v[134:137]
    v_cvt_pk_bf16_f32 v96, v114, v115
    v_cvt_pk_bf16_f32 v97, v116, v117
    v_cvt_pk_bf16_f32 v165, v128, v129
    v_mfma_f32_16x16x16_bf16 v[114:117], v[84:85], v[162:163], v[134:137]
    v_mul_f32 v152, v146, v152
    v_mul_f32 v153, v146, v153
    v_cvt_pk_bf16_f32 v131, v152, v153
    v_mfma_f32_16x16x16_bf16 v[126:129], v[108:109], v[162:163], v[134:137]
    v_cvt_pk_bf16_f32 v166, v166, v167
    v_accvgpr_write_b32 a234, v166
    v_cvt_pk_bf16_f32 v168, v168, v169
    v_accvgpr_write_b32 a235, v168
    v_mfma_f32_16x16x32_bf16 v[138:141], a[8:11], v[122:125], v[138:141]
    s_waitcnt lgkmcnt(1)
    ds_read_b128 v[134:137], v159 offset:512
    ds_write_b64 v4, v[164:165] offset:16384
    v_mfma_f32_16x16x16_bf16 v[150:153], a[224:225], v[162:163], v[170:173]
    v_cvt_pk_bf16_f32 v84, v114, v115
    v_cvt_pk_bf16_f32 v85, v116, v117
    v_cvt_pk_bf16_f32 v108, v126, v127
    v_mfma_f32_16x16x16_bf16 v[114:117], a[248:249], v[162:163], v[170:173]
    v_cvt_pk_bf16_f32 v109, v128, v129
    v_mul_f32 v154, v146, v154
    v_mul_f32 v155, v146, v155
    v_mfma_f32_16x16x16_bf16 v[126:129], v[98:99], v[162:163], v[170:173]
    v_cvt_pk_bf16_f32 v150, v150, v151
    v_accvgpr_write_b32 a224, v150
    v_cvt_pk_bf16_f32 v152, v152, v153
    v_mfma_f32_16x16x16_bf16 v[166:169], a[226:227], v[162:163], v[142:145]
    v_accvgpr_write_b32 a225, v152
    v_cvt_pk_bf16_f32 v114, v114, v115
    v_accvgpr_write_b32 a248, v114
    v_mfma_f32_16x16x16_bf16 v[150:153], a[250:251], v[162:163], v[142:145]
    v_cvt_pk_bf16_f32 v116, v116, v117
    v_accvgpr_write_b32 a249, v116
    v_cvt_pk_bf16_f32 v98, v126, v127
    v_mfma_f32_16x16x16_bf16 v[114:117], v[100:101], v[162:163], v[142:145]
    v_cvt_pk_bf16_f32 v99, v128, v129
    v_cvt_pk_bf16_f32 v166, v166, v167
    v_accvgpr_write_b32 a226, v166
    v_cvt_pk_bf16_f32 v168, v168, v169
    v_mfma_f32_16x16x32_bf16 v[138:141], a[12:15], v[202:205], v[138:141]
    s_waitcnt lgkmcnt(0)
    ds_read_b128 v[126:129], v159 offset:576
    ds_read_b128 v[142:145], v159 offset:640
    v_accvgpr_write_b32 a227, v168
    v_mfma_f32_16x16x16_bf16 v[166:169], a[236:237], v[162:163], v[134:137]
    v_cvt_pk_bf16_f32 v150, v150, v151
    v_accvgpr_write_b32 a250, v150
    v_cvt_pk_bf16_f32 v152, v152, v153
    v_mfma_f32_16x16x16_bf16 v[170:173], v[86:87], v[162:163], v[134:137]
    v_accvgpr_write_b32 a251, v152
    v_cvt_pk_bf16_f32 v100, v114, v115
    v_cvt_pk_bf16_f32 v101, v116, v117
    v_mfma_f32_16x16x16_bf16 v[114:117], v[110:111], v[162:163], v[134:137]
    v_cvt_pk_bf16_f32 v166, v166, v167
    v_accvgpr_write_b32 a236, v166
    v_cvt_pk_bf16_f32 v168, v168, v169
    v_accvgpr_write_b32 a237, v168
    v_mfma_f32_16x16x32_bf16 v[138:141], a[16:19], v[230:233], v[138:141]
    ds_read_b128 v[134:137], v159 offset:704
    v_cvt_pk_bf16_f32 v86, v170, v171
    v_mfma_f32_16x16x32_bf16 v[138:141], a[20:23], v[238:241], v[138:141]
    ds_write_b16 v7, v218
    v_mfma_f32_16x16x32_bf16 v[166:169], a[24:27], v[186:189], 0
    v_add_u32 v7, 16, v7
    v_cvt_pk_bf16_f32 v87, v172, v173
    v_mfma_f32_16x16x32_bf16 v[166:169], a[28:31], v[194:197], v[166:169]
    s_waitcnt lgkmcnt(2)
    v_cvt_pk_bf16_f32 v110, v114, v115
    v_cvt_pk_bf16_f32 v111, v116, v117
    v_cvt_pk_bf16_f32 v132, v154, v155
    v_mfma_f32_16x16x16_bf16 v[114:117], a[228:229], v[162:163], v[126:129]
    v_mul_f32 v156, v146, v156
    v_mul_f32 v157, v146, v157
    v_cvt_pk_bf16_f32 v133, v156, v157
    v_mfma_f32_16x16x16_bf16 v[150:153], a[252:253], v[162:163], v[126:129]
    v_mul_f32 v174, v146, v174
    v_mul_f32 v175, v146, v175
    v_cvt_pk_bf16_f32 v254, v174, v175
    v_mfma_f32_16x16x16_bf16 v[154:157], v[102:103], v[162:163], v[126:129]
    v_cvt_pk_bf16_f32 v114, v114, v115
    v_accvgpr_write_b32 a228, v114
    v_cvt_pk_bf16_f32 v116, v116, v117
    v_mfma_f32_16x16x16_bf16 v[158:161], a[230:231], v[162:163], v[142:145]
    v_accvgpr_write_b32 a229, v116
    v_cvt_pk_bf16_f32 v150, v150, v151
    v_accvgpr_write_b32 a252, v150
    v_mfma_f32_16x16x16_bf16 v[114:117], a[254:255], v[162:163], v[142:145]
    v_cvt_pk_bf16_f32 v152, v152, v153
    v_accvgpr_write_b32 a253, v152
    v_cvt_pk_bf16_f32 v102, v154, v155
    v_mfma_f32_16x16x16_bf16 v[126:129], v[104:105], v[162:163], v[142:145]
    v_cvt_pk_bf16_f32 v103, v156, v157
    v_cvt_pk_bf16_f32 v158, v158, v159
    v_accvgpr_write_b32 a230, v158
    v_cvt_pk_bf16_f32 v160, v160, v161
    v_mfma_f32_16x16x32_bf16 v[166:169], a[32:35], v[122:125], v[166:169]
    s_waitcnt lgkmcnt(0)
    ds_write_b128 v3, v[130:133] offset:6144
    v_mfma_f32_16x16x16_bf16 v[130:133], a[238:239], v[162:163], v[134:137]
    v_accvgpr_write_b32 a231, v160
    v_cvt_pk_bf16_f32 v114, v114, v115
    v_accvgpr_write_b32 a254, v114
    v_mfma_f32_16x16x16_bf16 v[142:145], v[88:89], v[162:163], v[134:137]
    v_cvt_pk_bf16_f32 v116, v116, v117
    v_accvgpr_write_b32 a255, v116
    v_cvt_pk_bf16_f32 v104, v126, v127
    v_mfma_f32_16x16x16_bf16 v[114:117], v[112:113], v[162:163], v[134:137]
    v_cvt_pk_bf16_f32 v105, v128, v129
    v_cvt_pk_bf16_f32 v130, v130, v131
    v_accvgpr_write_b32 a238, v130
    v_cvt_pk_bf16_f32 v132, v132, v133
    v_mfma_f32_16x16x32_bf16 v[166:169], a[36:39], v[202:205], v[166:169]
    v_accvgpr_write_b32 a239, v132
    v_cvt_pk_bf16_f32 v88, v142, v143
    v_mfma_f32_16x16x32_bf16 v[166:169], a[40:43], v[230:233], v[166:169]
    v_cvt_pk_bf16_f32 v89, v144, v145
    v_cvt_pk_bf16_f32 v112, v114, v115
    v_mfma_f32_16x16x32_bf16 v[166:169], a[44:47], v[238:241], v[166:169]
    v_cvt_pk_bf16_f32 v113, v116, v117
    v_mul_f32 v176, v146, v176
    v_mfma_f32_16x16x32_bf16 v[134:137], a[48:51], v[186:189], 0
    v_mul_f32 v177, v146, v177
    v_cvt_pk_bf16_f32 v255, v176, v177
    v_mfma_f32_16x16x32_bf16 v[134:137], a[52:55], v[194:197], v[134:137]
    ds_write_b64 v4, v[254:255] offset:10240
    v_cvt_pk_f16_f32 v146, v118, v119
    v_pk_mul_f16 v143, v146, v146
    v_cvt_pk_f16_f32 v147, v120, v121
    v_pk_fma_f16 v143, v147, v147, v143
    v_cvt_pk_f16_f32 v148, v190, v191
    v_pk_fma_f16 v143, v148, v148, v143
    v_cvt_pk_f16_f32 v149, v192, v193
    v_pk_fma_f16 v143, v149, v149, v143
    v_cvt_pk_f16_f32 v120, v198, v199
    v_pk_fma_f16 v143, v120, v120, v143
    v_cvt_pk_f16_f32 v121, v200, v201
    v_pk_fma_f16 v143, v121, v121, v143
    v_xor_b32 v3, 65536, v3
    v_xor_b32 v4, 65536, v4
    s_waitcnt lgkmcnt(0)
    s_barrier
L_go:
    s_waitcnt lgkmcnt(0)
    s_and_b32 s3, s2, 0xf8
    s_add_u32 s64, s42, s3
    s_addc_u32 s65, s43, 0
    s_mov_b32 s67, 0x00020000
    s_cmp_eq_u32 s16, 1
    s_cbranch_scc1 L_loop_fast1
    s_cmp_eq_u32 s16, 2
    s_cbranch_scc1 L_loop_fast2
    s_cmp_eq_u32 s16, 3
    s_cbranch_scc1 L_loop_fast3
    s_branch L_loop_fast0
.p2align 6
L_loop_fast0:
    v_mfma_f32_16x16x32_bf16 v[134:137], a[56:59], v[122:125], v[134:137]
    s_add_u32 s12, s40, s27
    ds_read_b128 v[190:193], v2 offset:18432
    v_cvt_pk_f16_f32 v150, v138, v139
    v_mfma_f32_16x16x32_bf16 v[134:137], a[60:63], v[202:205], v[134:137]
    s_addc_u32 s13, s41, 0
    ds_read_b128 v[210:213], v2 offset:19456
    v_pk_mul_f16 v142, v150, v150
    v_mfma_f32_16x16x32_bf16 v[134:137], a[64:67], v[230:233], v[134:137]
    s_sub_u32 s14, s36, s27
    ds_read_b128 v[174:177], v5 offset:32
    v_cvt_pk_f16_f32 v151, v140, v141
    v_mfma_f32_16x16x32_bf16 v[134:137], a[68:71], v[238:241], v[134:137]
    s_cmp_ge_u32 s18, 2
    ds_read2_b64 v[162:165], v5 offset0:6 offset1:9
    v_pk_fma_f16 v142, v151, v151, v142
    v_mfma_f32_16x16x32_bf16 v[138:141], v[186:189], a[144:147], 0
    s_cselect_b32 s14, s14, 0
    ds_read_b128 v[170:173], v5
    v_cvt_pk_f16_f32 v152, v166, v167
    v_mfma_f32_16x16x32_bf16 v[138:141], v[194:197], a[148:151], v[138:141]
    s_sub_u32 s82, s72, s71
    ds_read_b32 v254, v6 offset:192
    v_pk_fma_f16 v142, v152, v152, v142
    v_mfma_f32_16x16x32_bf16 v[138:141], v[122:125], a[152:155], v[138:141]
    s_mul_i32 s74, s82, 336
    v_cvt_pk_f16_f32 v153, v168, v169
    v_pk_fma_f16 v142, v153, v153, v142
    v_mfma_f32_16x16x32_bf16 v[138:141], v[202:205], a[156:159], v[138:141]
    s_mul_i32 s75, s82, 272
    v_cvt_pk_f16_f32 v118, v134, v135
    v_pk_fma_f16 v142, v118, v118, v142
    v_mfma_f32_16x16x32_bf16 v[138:141], v[230:233], a[160:163], v[138:141]
    s_waitcnt lgkmcnt(5)
    ds_read_b128 v[182:185], v0 offset:26624
    v_cvt_pk_f16_f32 v119, v136, v137
    v_mfma_f32_16x16x32_bf16 v[166:169], v[32:35], v[190:193], 0
    s_waitcnt lgkmcnt(5)
    v_pk_fma_f16 v142, v119, v119, v142
    v_add_u32 v5, s74, v5
    v_mfma_f32_16x16x32_bf16 v[166:169], v[32:35], v[210:213], v[166:169]
    s_waitcnt lgkmcnt(4)
    v_pk_mul_f16 v145, v146, v174
    v_pk_fma_f16 v145, v147, v175, v145
    v_mfma_f32_16x16x32_bf16 v[138:141], v[238:241], a[164:167], v[138:141]
    s_mul_i32 s76, s82, 16
    ds_read_b128 v[210:213], v1 offset:26624
    v_pk_fma_f16 v145, v148, v176, v145
    v_mfma_f32_16x16x32_bf16 v[214:217], v[186:189], a[168:171], 0
    s_waitcnt lgkmcnt(3)
    ds_read_b128 v[218:221], v0 offset:26752
    v_pk_fma_f16 v145, v149, v177, v145
    v_mfma_f32_16x16x32_bf16 v[214:217], v[194:197], a[172:175], v[214:217]
    s_waitcnt lgkmcnt(3)
    ds_read_b128 v[222:225], v1 offset:26752
    v_mov_b32_dpp v254, v23 quad_perm:[0,1,2,3] row_mask:0x7 bank_mask:0xf
    v_mfma_f32_16x16x32_bf16 v[214:217], v[122:125], a[176:179], v[214:217]
    s_add_u32 s34, s18, 2
    ds_read_b128 v[226:229], v0 offset:26880
    v_pk_fma_f16 v145, v120, v164, v145
    v_mfma_f32_16x16x32_bf16 v[214:217], v[202:205], a[180:183], v[214:217]
    s_add_u32 s8, s60, s23
    ds_read_b128 v[190:193], v1 offset:26880
    v_pk_fma_f16 v145, v121, v165, v145
    v_mfma_f32_16x16x32_bf16 v[214:217], v[230:233], a[184:187], v[214:217]
    s_waitcnt lgkmcnt(5)
    v_pk_mul_f16 v144, v150, v170
    v_pk_fma_f16 v144, v151, v171, v144
    v_mfma_f32_16x16x32_bf16 v[214:217], v[238:241], a[188:191], v[214:217]
    s_addc_u32 s9, s61, 0
    v_pk_fma_f16 v144, v152, v172, v144
    v_pk_fma_f16 v144, v153, v173, v144
    v_mfma_f32_16x16x32_bf16 v[246:249], v[186:189], a[192:195], 0
    s_sub_u32 s10, s36, s23
    v_pk_fma_f16 v144, v118, v162, v144
    v_pk_fma_f16 v144, v119, v163, v144
    v_mfma_f32_16x16x32_bf16 v[246:249], v[194:197], a[196:199], v[246:249]
    s_cmp_le_u32 s34, s45
    v_cvt_pk_bf16_f32 v134, v138, v139
    v_cvt_pk_bf16_f32 v135, v140, v141
    v_mfma_f32_16x16x32_f16 v[234:237], v[40:43], v[142:145], 0
    s_cselect_b32 s10, s10, 0
    v_cvt_pk_bf16_f32 v138, v214, v215
    v_cvt_pk_bf16_f32 v139, v216, v217
    v_mfma_f32_16x16x32_bf16 v[246:249], v[122:125], a[200:203], v[246:249]
    s_add_u32 m0, s28, 0
    v_mul_f32 v136, 0x3baaaaab, v166
    v_mul_f32 v255, 0x3baaaaab, v167
    v_mfma_f32_16x16x32_bf16 v[246:249], v[202:205], a[204:207], v[246:249]
    s_mov_b32 s27, s26
    v_rsq_f32 v234, v234
    v_mfma_f32_16x16x32_bf16 v[246:249], v[230:233], a[208:211], v[246:249]
    s_mov_b32 s26, s25
    v_rsq_f32 v235, v235
    v_mfma_f32_16x16x32_bf16 v[246:249], v[238:241], a[212:215], v[246:249]
    s_mov_b32 s25, s24
    v_mul_f32 v140, s31, v234
    v_cvt_pk_f16_f32 v141, v140, v235
    v_mfma_f32_16x16x32_bf16 v[122:125], a[72:75], v[182:185], 0
    s_waitcnt lgkmcnt(0)
    v_fma_f32 v236, v236, v140, v22
    v_fmac_f32_dpp v254, v237, v235 quad_perm:[0,1,2,3] row_mask:0x1 bank_mask:0xf
    v_mfma_f32_16x16x32_bf16 v[122:125], a[76:79], v[210:213], v[122:125]
    s_mov_b32 s24, s23
    v_cvt_pk_bf16_f32 v142, v246, v247
    v_cvt_pk_bf16_f32 v143, v248, v249
    v_mfma_f32_16x16x32_bf16 v[122:125], a[80:83], v[218:221], v[122:125]
    s_mov_b32 s71, s72
    v_pk_mul_f16 v146, v146, v141 op_sel:[0,1] op_sel_hi:[1,1]
    v_pk_mul_f16 v147, v147, v141 op_sel:[0,1] op_sel_hi:[1,1]
    v_mfma_f32_16x16x32_bf16 v[122:125], a[84:87], v[222:225], v[122:125]
    s_mov_b32 s72, s73
    v_pk_mul_f16 v148, v148, v141 op_sel:[0,1] op_sel_hi:[1,1]
    v_pk_mul_f16 v149, v149, v141 op_sel:[0,1] op_sel_hi:[1,1]
    v_mfma_f32_16x16x32_bf16 v[122:125], a[88:91], v[226:229], v[122:125]
    v_pk_mul_f16 v120, v120, v141 op_sel:[0,1] op_sel_hi:[1,1]
    v_pk_mul_f16 v121, v121, v141 op_sel:[0,1] op_sel_hi:[1,1]
    v_mfma_f32_16x16x32_bf16 v[122:125], a[92:95], v[190:193], v[122:125]
    v_pk_mul_f16 v150, v150, v141 op_sel:[0,0] op_sel_hi:[1,0]
    v_pk_mul_f16 v151, v151, v141 op_sel:[0,0] op_sel_hi:[1,0]
    v_mfma_f32_16x16x32_bf16 v[186:189], a[96:99], v[182:185], 0
    v_pk_mul_f16 v152, v152, v141 op_sel:[0,0] op_sel_hi:[1,0]
    v_pk_mul_f16 v153, v153, v141 op_sel:[0,0] op_sel_hi:[1,0]
    v_mfma_f32_16x16x32_bf16 v[186:189], a[100:103], v[210:213], v[186:189]
    v_pk_mul_f16 v118, v118, v141 op_sel:[0,0] op_sel_hi:[1,0]
    v_pk_mul_f16 v119, v119, v141 op_sel:[0,0] op_sel_hi:[1,0]
    v_mfma_f32_16x16x32_bf16 v[186:189], a[104:107], v[218:221], v[186:189]
    v_max3_u32 v44, v44, v234, v235
    v_mul_f32 v144, 0x3baaaaab, v168
    v_mfma_f32_16x16x32_bf16 v[186:189], a[108:111], v[222:225], v[186:189]
    v_rsq_f32 v136, v136
    v_mfma_f32_16x16x32_bf16 v[186:189], a[112:115], v[226:229], v[186:189]
    v_rsq_f32 v255, v255
    v_mfma_f32_16x16x32_bf16 v[186:189], a[116:119], v[190:193], v[186:189]
    v_rsq_f32 v144, v144
    v_mfma_f32_16x16x32_bf16 v[194:197], a[120:123], v[182:185], 0
    v_mul_f32 v178, v136, v178
    v_mul_f32 v179, v136, v179
    v_mfma_f32_16x16x32_bf16 v[194:197], a[124:127], v[210:213], v[194:197]
    v_cvt_pk_bf16_f32 v166, v178, v179
    v_mul_f32 v180, v136, v180
    v_mfma_f32_16x16x32_bf16 v[194:197], a[128:131], v[218:221], v[194:197]
    v_mul_f32 v181, v136, v181
    v_cvt_pk_bf16_f32 v167, v180, v181
    v_mfma_f32_16x16x32_bf16 v[194:197], a[132:135], v[222:225], v[194:197]
    v_mul_f32 v198, v136, v198
    v_mul_f32 v199, v136, v199
    v_mfma_f32_16x16x32_bf16 v[194:197], a[136:139], v[226:229], v[194:197]
    v_cvt_pk_bf16_f32 v168, v198, v199
    v_mul_f32 v200, v136, v200
    v_mfma_f32_16x16x32_bf16 v[194:197], a[140:143], v[190:193], v[194:197]
    v_mul_f32 v201, v136, v201
    v_cvt_pk_bf16_f32 v169, v200, v201
    v_mfma_f32_16x16x32_bf16 v[178:181], a[0:3], v[182:185], 0
    buffer_store_dwordx4 v[166:169], v15, s[12:15], 0 offen nt
    v_mul_f32 v206, v136, v206
    v_mul_f32 v207, v136, v207
    v_cvt_pk_bf16_f32 v140, v206, v207
    v_mul_f32 v208, v136, v208
    v_mfma_f32_16x16x32_bf16 v[178:181], a[4:7], v[210:213], v[178:181]
    v_mul_f32 v209, v136, v209
    v_cvt_pk_bf16_f32 v141, v208, v209
    v_mfma_f32_16x16x32_bf16 v[178:181], a[8:11], v[218:221], v[178:181]
    v_cvt_pk_f16_f32 v166, v122, v123
    v_pk_mul_f16 v199, v166, v166
    v_mfma_f32_16x16x32_bf16 v[178:181], a[12:15], v[222:225], v[178:181]
    v_cvt_pk_f16_f32 v167, v124, v125
    v_pk_fma_f16 v199, v167, v167, v199
    v_mfma_f32_16x16x32_bf16 v[178:181], a[16:19], v[226:229], v[178:181]
    v_cvt_pk_f16_f32 v168, v186, v187
    v_pk_fma_f16 v199, v168, v168, v199
    v_mfma_f32_16x16x32_bf16 v[178:181], a[20:23], v[190:193], v[178:181]
    v_cvt_pk_f16_f32 v169, v188, v189
    v_pk_fma_f16 v199, v169, v169, v199
    v_mfma_f32_16x16x32_bf16 v[186:189], a[24:27], v[182:185], 0
    v_cvt_pk_f16_f32 v124, v194, v195
    v_pk_fma_f16 v199, v124, v124, v199
    v_mfma_f32_16x16x32_bf16 v[186:189], a[28:31], v[210:213], v[186:189]
    v_cvt_pk_f16_f32 v125, v196, v197
    v_pk_fma_f16 v199, v125, v125, v199
    v_mfma_f32_16x16x32_bf16 v[186:189], a[32:35], v[218:221], v[186:189]
    v_cvt_pk_f16_f32 v178, v178, v179
    v_pk_mul_f16 v198, v178, v178
    v_mfma_f32_16x16x32_bf16 v[186:189], a[36:39], v[222:225], v[186:189]
    v_cvt_pk_f16_f32 v179, v180, v181
    v_pk_fma_f16 v198, v179, v179, v198
    v_mfma_f32_16x16x32_bf16 v[186:189], a[40:43], v[226:229], v[186:189]
    v_pk_mul_f16 v200, v178, v170
    v_pk_fma_f16 v200, v179, v171, v200
    v_mfma_f32_16x16x32_bf16 v[186:189], a[44:47], v[190:193], v[186:189]
    v_pk_mul_f16 v201, v166, v174
    v_pk_fma_f16 v201, v167, v175, v201
    v_mfma_f32_16x16x32_bf16 v[194:197], a[48:51], v[182:185], 0
    v_pk_fma_f16 v201, v168, v176, v201
    v_pk_fma_f16 v201, v169, v177, v201
    v_mfma_f32_16x16x32_bf16 v[194:197], a[52:55], v[210:213], v[194:197]
    v_pk_fma_f16 v201, v124, v164, v201
    v_pk_fma_f16 v201, v125, v165, v201
    v_mfma_f32_16x16x32_bf16 v[194:197], a[56:59], v[218:221], v[194:197]
    v_cvt_pk_f16_f32 v180, v186, v187
    v_pk_fma_f16 v198, v180, v180, v198
    v_mfma_f32_16x16x32_bf16 v[194:197], a[60:63], v[222:225], v[194:197]
    v_cvt_pk_f16_f32 v181, v188, v189
    v_pk_fma_f16 v198, v181, v181, v198
    v_mfma_f32_16x16x32_bf16 v[194:197], a[64:67], v[226:229], v[194:197]
    v_pk_fma_f16 v200, v180, v172, v200
    v_pk_fma_f16 v200, v181, v173, v200
    v_mfma_f32_16x16x32_bf16 v[194:197], a[68:71], v[190:193], v[194:197]
    buffer_store_dwordx2 v[140:141], v18, s[12:15], 0 offen nt
    v_mul_f32 v242, v144, v242
    v_mul_f32 v243, v144, v243
    v_mfma_f32_16x16x32_bf16 v[186:189], v[182:185], a[144:147], 0
    v_cvt_pk_bf16_f32 v238, v242, v243
    v_mul_f32 v244, v144, v244
    v_mfma_f32_16x16x32_bf16 v[186:189], v[210:213], a[148:151], v[186:189]
    v_mul_f32 v245, v144, v245
    v_cvt_pk_f16_f32 v122, v194, v195
    v_mfma_f32_16x16x32_bf16 v[186:189], v[218:221], a[152:155], v[186:189]
    v_pk_fma_f16 v198, v122, v122, v198
    v_cvt_pk_f16_f32 v123, v196, v197
    v_mfma_f32_16x16x32_bf16 v[186:189], v[222:225], a[156:159], v[186:189]
    v_pk_fma_f16 v198, v123, v123, v198
    v_pk_fma_f16 v200, v122, v162, v200
    v_mfma_f32_16x16x32_bf16 v[186:189], v[226:229], a[160:163], v[186:189]
    ds_read_b128 v[202:205], v0 offset:32768
    v_pk_fma_f16 v200, v123, v163, v200
    v_mfma_f32_16x16x32_bf16 v[186:189], v[190:193], a[164:167], v[186:189]
    ds_read_b128 v[194:197], v1 offset:32768
    v_cvt_pk_bf16_f32 v239, v244, v245
    v_mfma_f32_16x16x32_f16 v[230:233], v[40:43], v[198:201], 0
    v_mul_f32 v158, v144, v158
    v_mul_f32 v159, v144, v159
    v_mfma_f32_16x16x32_bf16 v[246:249], v[182:185], a[168:171], 0
    ds_read_b128 v[214:217], v0 offset:32896
    v_cvt_pk_bf16_f32 v240, v158, v159
    v_mfma_f32_16x16x32_bf16 v[246:249], v[210:213], a[172:175], v[246:249]
    ds_read_b128 v[206:209], v1 offset:32896
    v_cvt_pk_bf16_f32 v136, v186, v187
    v_mfma_f32_16x16x32_bf16 v[246:249], v[218:221], a[176:179], v[246:249]
    ds_read_b128 v[198:201], v0 offset:33024
    v_cvt_pk_bf16_f32 v137, v188, v189
    v_mfma_f32_16x16x32_bf16 v[246:249], v[222:225], a[180:183], v[246:249]
    ds_read_b128 v[186:189], v1 offset:33024
    v_mul_f32 v160, v144, v160
    v_mfma_f32_16x16x32_bf16 v[246:249], v[226:229], a[184:187], v[246:249]
    v_rsq_f32 v230, v230
    v_mfma_f32_16x16x32_bf16 v[246:249], v[190:193], a[188:191], v[246:249]
    s_waitcnt lgkmcnt(5)
    v_rsq_f32 v231, v231
    v_mfma_f32_16x16x32_bf16 v[242:245], v[182:185], a[192:195], 0
    s_waitcnt lgkmcnt(4)
    v_mul_f32 v234, s31, v230
    v_cvt_pk_f16_f32 v235, v234, v231
    v_mfma_f32_16x16x32_bf16 v[242:245], v[210:213], a[196:199], v[242:245]
    v_fma_f32 v232, v232, v234, v24
    v_fmac_f32_dpp v254, v233, v231 quad_perm:[0,1,2,3] row_mask:0x2 bank_mask:0xf
    v_mfma_f32_16x16x32_bf16 v[242:245], v[218:221], a[200:203], v[242:245]
    s_waitcnt lgkmcnt(3)
    v_cvt_pk_bf16_f32 v140, v246, v247
    v_cvt_pk_bf16_f32 v141, v248, v249
    v_mfma_f32_16x16x32_bf16 v[242:245], v[222:225], a[204:207], v[242:245]
    s_waitcnt lgkmcnt(2)
    v_mul_f32 v161, v144, v161
    v_cvt_pk_bf16_f32 v241, v160, v161
    v_mfma_f32_16x16x32_bf16 v[242:245], v[226:229], a[208:211], v[242:245]
    s_waitcnt lgkmcnt(1)
    buffer_store_dwordx4 v[238:241], v17, s[12:15], 0 offen nt
    v_mul_f32 v154, v144, v154
    v_mul_f32 v155, v144, v155
    v_cvt_pk_bf16_f32 v154, v154, v155
    v_mul_f32 v156, v144, v156
    v_mfma_f32_16x16x32_bf16 v[242:245], v[190:193], a[212:215], v[242:245]
    s_waitcnt lgkmcnt(0)
    v_mul_f32 v157, v144, v157
    v_cvt_pk_bf16_f32 v155, v156, v157
    v_mfma_f32_16x16x32_bf16 v[158:161], a[72:75], v[202:205], 0
    v_pk_mul_f16 v166, v166, v235 op_sel:[0,1] op_sel_hi:[1,1]
    v_pk_mul_f16 v167, v167, v235 op_sel:[0,1] op_sel_hi:[1,1]
    v_mfma_f32_16x16x32_bf16 v[158:161], a[76:79], v[194:197], v[158:161]
    v_pk_mul_f16 v168, v168, v235 op_sel:[0,1] op_sel_hi:[1,1]
    v_cvt_pk_bf16_f32 v144, v242, v243
    v_mfma_f32_16x16x32_bf16 v[158:161], a[80:83], v[214:217], v[158:161]
    v_cvt_pk_bf16_f32 v145, v244, v245
    v_pk_mul_f16 v169, v169, v235 op_sel:[0,1] op_sel_hi:[1,1]
    v_mfma_f32_16x16x32_bf16 v[158:161], a[84:87], v[206:209], v[158:161]
    v_pk_mul_f16 v124, v124, v235 op_sel:[0,1] op_sel_hi:[1,1]
    v_pk_mul_f16 v125, v125, v235 op_sel:[0,1] op_sel_hi:[1,1]
    v_mfma_f32_16x16x32_bf16 v[158:161], a[88:91], v[198:201], v[158:161]
    v_pk_mul_f16 v178, v178, v235 op_sel:[0,0] op_sel_hi:[1,0]
    v_pk_mul_f16 v179, v179, v235 op_sel:[0,0] op_sel_hi:[1,0]
    v_mfma_f32_16x16x32_bf16 v[158:161], a[92:95], v[186:189], v[158:161]
    v_pk_mul_f16 v180, v180, v235 op_sel:[0,0] op_sel_hi:[1,0]
    v_pk_mul_f16 v181, v181, v235 op_sel:[0,0] op_sel_hi:[1,0]
    v_mfma_f32_16x16x32_bf16 v[182:185], a[96:99], v[202:205], 0
    v_pk_mul_f16 v122, v122, v235 op_sel:[0,0] op_sel_hi:[1,0]
    v_pk_mul_f16 v123, v123, v235 op_sel:[0,0] op_sel_hi:[1,0]
    v_mfma_f32_16x16x32_bf16 v[182:185], a[100:103], v[194:197], v[182:185]
    v_max3_u32 v44, v44, v230, v231
    v_mul_f32 v130, v255, v130
    v_mfma_f32_16x16x32_bf16 v[182:185], a[104:107], v[214:217], v[182:185]
    v_cvt_pk_f16_f32 v158, v158, v159
    v_pk_mul_f16 v191, v158, v158
    v_mfma_f32_16x16x32_bf16 v[182:185], a[108:111], v[206:209], v[182:185]
    v_cvt_pk_f16_f32 v159, v160, v161
    v_pk_fma_f16 v191, v159, v159, v191
    v_mfma_f32_16x16x32_bf16 v[182:185], a[112:115], v[198:201], v[182:185]
    v_pk_mul_f16 v193, v158, v174
    v_pk_fma_f16 v193, v159, v175, v193
    v_mfma_f32_16x16x32_bf16 v[182:185], a[116:119], v[186:189], v[182:185]
    v_exp_f32 v232, v232
    v_mfma_f32_16x16x32_bf16 v[210:213], a[120:123], v[202:205], 0
    v_exp_f32 v236, v236
    v_mfma_f32_16x16x32_bf16 v[210:213], a[124:127], v[194:197], v[210:213]
    v_cvt_pk_bf16_f32 v39, v236, 0
    v_mul_f32 v131, v255, v131
    v_mfma_f32_16x16x32_bf16 v[210:213], a[128:131], v[214:217], v[210:213]
    s_waitcnt vmcnt(3)
    ds_write_b16 v8, v45 offset:512
    v_mfma_f32_16x16x32_bf16 v[210:213], a[132:135], v[206:209], v[210:213]
    buffer_store_dwordx2 v[154:155], v20, s[12:15], 0 offen nt
    v_mov_b32 v45, 1
    v_cvt_pk_f16_f32 v160, v182, v183
    v_mfma_f32_16x16x32_bf16 v[210:213], a[136:139], v[198:201], v[210:213]
    v_pk_fma_f16 v191, v160, v160, v191
    v_cvt_pk_f16_f32 v161, v184, v185
    v_mfma_f32_16x16x32_bf16 v[210:213], a[140:143], v[186:189], v[210:213]
    v_pk_fma_f16 v191, v161, v161, v191
    v_pk_fma_f16 v193, v160, v176, v193
    v_mfma_f32_16x16x32_bf16 v[154:157], a[0:3], v[202:205], 0
    v_pk_fma_f16 v193, v161, v177, v193
    v_cvt_pk_bf16_f32 v130, v130, v131
    v_mfma_f32_16x16x32_bf16 v[154:157], a[4:7], v[194:197], v[154:157]
    v_mul_f32 v132, v255, v132
    v_mul_f32 v133, v255, v133
    v_mfma_f32_16x16x32_bf16 v[154:157], a[8:11], v[214:217], v[154:157]
    v_cvt_pk_f16_f32 v176, v210, v211
    v_pk_fma_f16 v191, v176, v176, v191
    v_mfma_f32_16x16x32_bf16 v[154:157], a[12:15], v[206:209], v[154:157]
    s_waitcnt lgkmcnt(0)
    v_cvt_pk_f16_f32 v177, v212, v213
    v_pk_fma_f16 v191, v177, v177, v191
    v_mfma_f32_16x16x32_bf16 v[154:157], a[16:19], v[198:201], v[154:157]
    s_barrier
    v_pk_fma_f16 v193, v176, v164, v193
    v_mfma_f32_16x16x32_bf16 v[154:157], a[20:23], v[186:189], v[154:157]
    v_pk_fma_f16 v193, v177, v165, v193
    v_mfma_f32_16x16x32_bf16 v[182:185], a[24:27], v[202:205], 0
    v_cvt_pk_bf16_f32 v131, v132, v133
    v_mfma_f32_16x16x32_bf16 v[182:185], a[28:31], v[194:197], v[182:185]
    ds_read2_b32 v[164:165], v6 offset0:0 offset1:0
    v_mfma_f32_16x16x32_bf16 v[182:185], a[32:35], v[214:217], v[182:185]
    ds_read2_b32 v[212:213], v6 offset0:16 offset1:16
    s_nop 0
    v_cvt_pk_f16_f32 v154, v154, v155
    v_mfma_f32_16x16x32_bf16 v[182:185], a[36:39], v[206:209], v[182:185]
    ds_read2_b32 v[220:221], v6 offset0:32 offset1:32
    v_pk_mul_f16 v190, v154, v154
    v_mfma_f32_16x16x32_bf16 v[182:185], a[40:43], v[198:201], v[182:185]
    ds_read_u16 v133, v9 offset:512
    v_cvt_pk_f16_f32 v155, v156, v157
    v_mfma_f32_16x16x32_bf16 v[182:185], a[44:47], v[186:189], v[182:185]
    v_pk_fma_f16 v190, v155, v155, v190
    v_pk_mul_f16 v192, v154, v170
    v_mfma_f32_16x16x32_bf16 v[222:225], a[48:51], v[202:205], 0
    v_pk_fma_f16 v192, v155, v171, v192
    v_mul_f32 v126, v255, v126
    v_mfma_f32_16x16x32_bf16 v[222:225], a[52:55], v[194:197], v[222:225]
    v_mul_f32 v127, v255, v127
    v_cvt_pk_bf16_f32 v132, v126, v127
    v_mfma_f32_16x16x32_bf16 v[222:225], a[56:59], v[214:217], v[222:225]
    buffer_load_dwordx4 v10, s[8:11], 0 offen nt lds
    v_cvt_pk_f16_f32 v156, v182, v183
    v_mfma_f32_16x16x32_bf16 v[222:225], a[60:63], v[206:209], v[222:225]
    s_add_u32 m0, s28, 4096
    v_pk_fma_f16 v190, v156, v156, v190
    v_cvt_pk_f16_f32 v157, v184, v185
    v_mfma_f32_16x16x32_bf16 v[222:225], a[64:67], v[198:201], v[222:225]
    s_waitcnt lgkmcnt(2)
    v_pk_fma_f16 v190, v157, v157, v190
    v_pk_fma_f16 v192, v156, v172, v192
    v_mfma_f32_16x16x32_bf16 v[222:225], a[68:71], v[186:189], v[222:225]
    s_waitcnt lgkmcnt(1)
    ds_read_b128 v[182:185], v2 offset:0
    v_pk_fma_f16 v192, v157, v173, v192
    v_mfma_f32_16x16x32_bf16 v[170:173], v[202:205], a[144:147], 0
    s_waitcnt lgkmcnt(1)
    ds_read_b128 v[226:229], v2 offset:1024
    v_readfirstlane_b32 s77, v133
    v_mfma_f32_16x16x32_bf16 v[170:173], v[194:197], a[148:151], v[170:173]
    ds_read_b128 v[234:237], v2 offset:2048
    buffer_load_dwordx4 v11, s[8:11], 0 offen nt lds
    v_mfma_f32_16x16x32_bf16 v[170:173], v[214:217], a[152:155], v[170:173]
    s_add_u32 m0, s28, 8192
    ds_read_b128 v[238:241], v2 offset:3072
    v_cvt_pk_f16_f32 v174, v222, v223
    v_mfma_f32_16x16x32_bf16 v[170:173], v[206:209], a[156:159], v[170:173]
    s_mul_i32 s78, s77, 2688
    ds_read_b128 v[242:245], v2 offset:4096
    v_pk_fma_f16 v190, v174, v174, v190
    v_mfma_f32_16x16x32_bf16 v[170:173], v[198:201], a[160:163], v[170:173]
    ds_read_b128 v[246:249], v2 offset:5120
    v_cvt_pk_f16_f32 v175, v224, v225
    v_mfma_f32_16x16x32_bf16 v[170:173], v[186:189], a[164:167], v[170:173]
    v_pk_fma_f16 v190, v175, v175, v190
    v_pk_fma_f16 v192, v174, v162, v192
    v_mfma_f32_16x16x32_bf16 v[222:225], v[202:205], a[168:171], 0
    buffer_load_dwordx4 v12, s[8:11], 0 offen nt lds
    v_pk_fma_f16 v192, v175, v163, v192
    v_mfma_f32_16x16x32_bf16 v[222:225], v[194:197], a[172:175], v[222:225]
    s_waitcnt lgkmcnt(5)
    v_mul_f32 v128, v255, v128
    v_cvt_pk_bf16_f32 v162, v170, v171
    v_mfma_f32_16x16x32_f16 v[250:253], v[40:43], v[190:193], 0
    s_add_u32 m0, s28, 12288
    v_cvt_pk_bf16_f32 v163, v172, v173
    v_mul_f32 v129, v255, v129
    v_mfma_f32_16x16x32_bf16 v[222:225], v[214:217], a[176:179], v[222:225]
    s_xor_b32 s28, s28, 65536
    v_cvt_pk_bf16_f32 v133, v128, v129
    v_mul_f32 v114, v255, v114
    v_mfma_f32_16x16x32_bf16 v[222:225], v[206:209], a[180:183], v[222:225]
    s_waitcnt lgkmcnt(2)
    v_rsq_f32 v250, v250
    v_mfma_f32_16x16x32_bf16 v[222:225], v[198:201], a[184:187], v[222:225]
    s_waitcnt lgkmcnt(1)
    buffer_load_dwordx4 v13, s[8:11], 0 offen nt lds
    v_mul_f32 v230, s31, v250
    v_mfma_f32_16x16x32_bf16 v[222:225], v[186:189], a[188:191], v[222:225]
    s_mov_b32 m0, s29
    v_rsq_f32 v251, v251
    v_mfma_f32_16x16x32_bf16 v[126:129], v[202:205], a[192:195], 0
    s_xor_b32 s29, s29, s30
    v_cvt_pk_f16_f32 v231, v230, v251
    v_fma_f32 v252, v252, v230, v26
    v_mfma_f32_16x16x32_bf16 v[126:129], v[194:197], a[196:199], v[126:129]
    s_add_u32 s19, s19, s20
    v_fmac_f32_dpp v254, v253, v251 quad_perm:[0,1,2,3] row_mask:0x4 bank_mask:0xf
    v_cvt_pk_bf16_f32 v210, v222, v223
    v_mfma_f32_16x16x32_bf16 v[126:129], v[214:217], a[200:203], v[126:129]
    s_add_u32 s23, s23, s21
    v_cvt_pk_bf16_f32 v211, v224, v225
    v_pk_mul_f16 v158, v158, v231 op_sel:[0,1] op_sel_hi:[1,1]
    v_mfma_f32_16x16x32_bf16 v[126:129], v[206:209], a[204:207], v[126:129]
    s_waitcnt lgkmcnt(0)
    buffer_load_dwordx4 v14, s[8:11], 0 offen nt lds
    v_pk_mul_f16 v159, v159, v231 op_sel:[0,1] op_sel_hi:[1,1]
    v_mfma_f32_16x16x32_bf16 v[126:129], v[198:201], a[208:211], v[126:129]
    s_cmp_ge_u32 s19, 72
    v_pk_mul_f16 v160, v160, v231 op_sel:[0,1] op_sel_hi:[1,1]
    v_pk_mul_f16 v161, v161, v231 op_sel:[0,1] op_sel_hi:[1,1]
    v_mfma_f32_16x16x32_bf16 v[126:129], v[186:189], a[212:215], v[126:129]
    s_cselect_b32 s34, 72, 0
    v_pk_mul_f16 v176, v176, v231 op_sel:[0,1] op_sel_hi:[1,1]
    v_pk_mul_f16 v177, v177, v231 op_sel:[0,1] op_sel_hi:[1,1]
    v_mfma_f32_16x16x32_f16 v[170:173], v[146:149], v[150:153], v[46:49]
    s_cselect_b32 s35, s22, 0
    v_pk_mul_f16 v154, v154, v231 op_sel:[0,0] op_sel_hi:[1,0]
    v_pk_mul_f16 v155, v155, v231 op_sel:[0,0] op_sel_hi:[1,0]
    v_mfma_f32_16x16x32_f16 v[186:189], v[166:169], v[150:153], v[50:53]
    s_sub_u32 s19, s19, s34
    v_cvt_pk_bf16_f32 v218, v126, v127
    v_cvt_pk_bf16_f32 v219, v128, v129
    v_mfma_f32_16x16x32_f16 v[126:129], v[158:161], v[150:153], v[54:57]
    buffer_store_dwordx4 v[130:133], v16, s[12:15], 0 offen nt
    v_pk_mul_f16 v156, v156, v231 op_sel:[0,0] op_sel_hi:[1,0]
    v_pk_mul_f16 v157, v157, v231 op_sel:[0,0] op_sel_hi:[1,0]
    v_pk_mul_f16 v174, v174, v231 op_sel:[0,0] op_sel_hi:[1,0]
    v_pk_mul_f16 v175, v175, v231 op_sel:[0,0] op_sel_hi:[1,0]
    v_mfma_f32_16x16x16_f16 v[170:173], v[120:121], v[118:119], v[170:173]
    v_max3_u32 v44, v44, v250, v251
    v_exp_f32 v254, v254
    v_mfma_f32_16x16x16_f16 v[186:189], v[124:125], v[118:119], v[186:189]
    v_cvt_pk_bf16_f32 v254, v254, v254
    v_exp_f32 v252, v252
    v_mfma_f32_16x16x16_f16 v[126:129], v[176:177], v[118:119], v[126:129]
    v_mul_f32 v115, v255, v115
    v_cvt_pk_bf16_f32 v118, v114, v115
    v_exp_f32 v170, v170
    v_mfma_f32_16x16x32_f16 v[130:133], v[146:149], v[178:181], v[58:61]
    s_add_u32 s23, s23, s35
    ds_write_b16 v8, v254
    v_mfma_f32_16x16x32_f16 v[150:153], v[166:169], v[178:181], v[62:65]
    s_add_u32 s78, s78, s69
    v_exp_f32 v171, v171
    v_mfma_f32_16x16x32_f16 v[190:193], v[158:161], v[178:181], v[66:69]
    s_add_u32 s80, s77, s68
    v_cvt_pk_bf16_f32 v170, v170, v171
    v_exp_f32 v172, v172
    v_mfma_f32_16x16x16_f16 v[130:133], v[120:121], v[122:123], v[130:133]
    v_exp_f32 v173, v173
    v_mul_f32 v116, v255, v116
    v_mfma_f32_16x16x16_f16 v[150:153], v[124:125], v[122:123], v[150:153]
    v_cvt_pk_bf16_f32 v171, v172, v173
    v_exp_f32 v186, v186
    v_mfma_f32_16x16x16_f16 v[190:193], v[176:177], v[122:123], v[190:193]
    v_exp_f32 v187, v187
    v_exp_f32 v188, v188
    v_mfma_f32_16x16x32_bf16 v[178:181], a[216:219], v[182:185], 0
    s_cmp_ge_u32 s80, 72
    v_exp_f32 v130, v130
    v_mfma_f32_16x16x32_bf16 v[178:181], a[220:223], v[226:229], v[178:181]
    s_cselect_b32 s80, s22, 0
    v_exp_f32 v131, v131
    v_mfma_f32_16x16x32_bf16 v[178:181], a[224:227], v[234:237], v[178:181]
    s_add_u32 s78, s78, s80
    v_cvt_pk_bf16_f32 v194, v130, v131
    v_cvt_pk_bf16_f32 v172, v186, v187
    v_mfma_f32_16x16x32_bf16 v[178:181], a[228:231], v[238:241], v[178:181]
    s_add_u32 s80, s77, 20
    v_exp_f32 v132, v132
    v_mfma_f32_16x16x32_bf16 v[178:181], a[232:235], v[242:245], v[178:181]
    s_add_u32 s34, s18, 3
    v_exp_f32 v133, v133
    v_mfma_f32_16x16x32_bf16 v[178:181], a[236:239], v[246:249], v[178:181]
    s_cmp_lt_u32 s77, s62
    v_cvt_pk_bf16_f32 v195, v132, v133
    v_mul_f32 v117, v255, v117
    v_mfma_f32_16x16x32_bf16 v[198:201], a[240:243], v[182:185], 0
    s_cselect_b32 s79, 1, 0
    v_exp_f32 v150, v150
    v_mfma_f32_16x16x32_f16 v[202:205], v[146:149], v[154:157], v[70:73]
    s_cselect_b32 s78, s78, 0
    v_exp_f32 v151, v151
    v_mfma_f32_16x16x32_f16 v[146:149], v[166:169], v[154:157], v[74:77]
    s_cmp_lt_u32 s34, s17
    v_cvt_pk_bf16_f32 v196, v150, v151
    v_cvt_pk_bf16_f32 v119, v116, v117
    v_mfma_f32_16x16x32_f16 v[166:169], v[158:161], v[154:157], v[78:81]
    buffer_store_dwordx2 v[118:119], v19, s[12:15], 0 offen nt
    v_exp_f32 v152, v152
    v_mfma_f32_16x16x16_f16 v[202:205], v[120:121], v[174:175], v[202:205]
    v_exp_f32 v153, v153
    v_fma_f32 v254, v178, v178, s33
    v_mfma_f32_16x16x16_f16 v[146:149], v[124:125], v[174:175], v[146:149]
    v_cvt_pk_bf16_f32 v197, v152, v153
    v_exp_f32 v190, v190
    v_mfma_f32_16x16x16_f16 v[166:169], v[176:177], v[174:175], v[166:169]
    v_exp_f32 v191, v191
    v_exp_f32 v192, v192
    v_mfma_f32_16x16x32_bf16 v[198:201], a[244:247], v[226:229], v[198:201]
    s_cselect_b32 s23, s23, s78
    v_exp_f32 v193, v193
    v_mfma_f32_16x16x32_bf16 v[198:201], a[248:251], v[234:237], v[198:201]
    s_cselect_b32 s73, s34, s80
    ds_read_b128 v[118:121], v2 offset:6144
    v_fmac_f32 v254, v179, v179
    v_mfma_f32_16x16x32_bf16 v[198:201], a[252:255], v[238:241], v[198:201]
    s_cselect_b32 s79, 0, s79
    ds_read_b128 v[122:125], v2 offset:7168
    v_fmac_f32 v254, v180, v180
    v_mfma_f32_16x16x32_bf16 v[198:201], v[82:85], v[242:245], v[198:201]
    s_cselect_b32 s81, 0, 1
    ds_read_b128 v[150:153], v2 offset:8192
    v_fmac_f32 v254, v181, v181
    v_mfma_f32_16x16x32_bf16 v[198:201], v[86:89], v[246:249], v[198:201]
    s_add_u32 s80, s77, 1
    ds_read_b128 v[154:157], v2 offset:9216
    v_xor_b32 v0, 65536, v0
    v_mfma_f32_16x16x32_bf16 v[206:209], v[90:93], v[182:185], 0
    s_mul_i32 s80, s80, s81
    ds_read_b128 v[158:161], v2 offset:10240
    v_xor_b32 v1, 65536, v1
    v_mfma_f32_16x16x32_bf16 v[206:209], v[94:97], v[226:229], v[206:209]
    s_cmp_lt_u32 s80, s62
    ds_read_b128 v[174:177], v2 offset:11264
    v_fmac_f32 v254, v198, v198
    v_mfma_f32_16x16x32_bf16 v[206:209], v[98:101], v[234:237], v[206:209]
    s_cselect_b32 s62, s62, 0
    v_exp_f32 v189, v189
    v_mfma_f32_16x16x32_bf16 v[206:209], v[102:105], v[238:241], v[206:209]
    s_add_u32 s80, s18, 4
    v_cvt_pk_bf16_f32 v173, v188, v189
    v_fmac_f32 v254, v199, v199
    v_mfma_f32_16x16x32_bf16 v[206:209], v[106:109], v[242:245], v[206:209]
    s_waitcnt lgkmcnt(5)
    v_exp_f32 v126, v126
    v_mfma_f32_16x16x32_bf16 v[206:209], v[110:113], v[246:249], v[206:209]
    s_cmp_ge_u32 s80, s17
    v_exp_f32 v127, v127
    v_mfma_f32_16x16x32_bf16 v[130:133], a[216:219], v[118:121], 0
    s_waitcnt lgkmcnt(3)
    v_cvt_pk_bf16_f32 v36, v126, v127
    v_fmac_f32 v254, v200, v200
    v_mfma_f32_16x16x32_bf16 v[130:133], a[220:223], v[122:125], v[130:133]
    s_cselect_b32 s66, s62, 0
    v_exp_f32 v128, v128
    v_mfma_f32_16x16x32_bf16 v[130:133], a[224:227], v[150:153], v[130:133]
    s_waitcnt lgkmcnt(1)
    buffer_atomic_add v45, v10, s[64:67], 0 offen sc0 sc1
    v_fmac_f32 v254, v201, v201
    v_mfma_f32_16x16x32_bf16 v[130:133], a[228:231], v[154:157], v[130:133]
    s_lshl_b32 s80, s79, s73
    v_exp_f32 v129, v129
    v_mfma_f32_16x16x32_bf16 v[130:133], a[232:235], v[158:161], v[130:133]
    s_waitcnt lgkmcnt(0)
    v_cvt_pk_bf16_f32 v37, v128, v129
    v_fmac_f32 v254, v206, v206
    v_mfma_f32_16x16x32_bf16 v[130:133], a[236:239], v[174:177], v[130:133]
    s_or_b32 s70, s70, s80
    v_exp_f32 v202, v202
    v_mfma_f32_16x16x32_bf16 v[182:185], v[28:31], v[36:39], 0
    s_add_u32 s45, s45, s79
    v_exp_f32 v203, v203
    v_mfma_f32_16x16x32_bf16 v[182:185], v[28:31], v[170:173], v[182:185]
    s_add_u32 s18, s18, 1
    v_cvt_pk_bf16_f32 v186, v202, v203
    v_fma_f32 v255, v130, v130, s33
    v_mfma_f32_16x16x32_bf16 v[214:217], v[162:165], v[36:39], 0
    s_cmp_lt_u32 s18, s45
    v_fmac_f32 v255, v131, v131
    v_fmac_f32 v255, v132, v132
    v_mfma_f32_16x16x32_bf16 v[214:217], v[134:137], v[170:173], v[214:217]
    v_fmac_f32 v255, v133, v133
    v_fmac_f32 v254, v207, v207
    v_mfma_f32_16x16x32_bf16 v[222:225], v[210:213], v[36:39], 0
    v_exp_f32 v204, v204
    v_mfma_f32_16x16x32_bf16 v[222:225], v[138:141], v[170:173], v[222:225]
    v_exp_f32 v205, v205
    v_mfma_f32_16x16x32_bf16 v[226:229], v[218:221], v[36:39], 0
    v_cvt_pk_bf16_f32 v36, v190, v191
    v_cvt_pk_bf16_f32 v37, v192, v193
    v_mfma_f32_16x16x32_bf16 v[226:229], v[142:145], v[170:173], v[226:229]
    v_cvt_pk_bf16_f32 v39, v232, 0
    v_cvt_pk_bf16_f32 v187, v204, v205
    v_mfma_f32_16x16x32_bf16 v[126:129], a[240:243], v[118:121], 0
    v_exp_f32 v146, v146
    v_mfma_f32_16x16x32_bf16 v[170:173], v[28:31], v[36:39], 0
    v_exp_f32 v147, v147
    v_mfma_f32_16x16x32_bf16 v[170:173], v[28:31], v[194:197], v[170:173]
    v_cvt_pk_bf16_f32 v188, v146, v147
    v_fmac_f32 v254, v208, v208
    v_mfma_f32_16x16x32_bf16 v[114:117], v[162:165], v[36:39], 0
    v_exp_f32 v148, v148
    v_mfma_f32_16x16x32_bf16 v[114:117], v[134:137], v[194:197], v[114:117]
    v_exp_f32 v149, v149
    v_mfma_f32_16x16x32_bf16 v[190:193], v[210:213], v[36:39], 0
    v_cvt_pk_bf16_f32 v189, v148, v149
    v_fmac_f32 v254, v209, v209
    v_mfma_f32_16x16x32_bf16 v[190:193], v[138:141], v[194:197], v[190:193]
    v_rcp_f32 v170, v170
    v_mfma_f32_16x16x32_bf16 v[146:149], v[218:221], v[36:39], 0
    v_exp_f32 v166, v166
    v_mfma_f32_16x16x32_bf16 v[146:149], v[142:145], v[194:197], v[146:149]
    v_mul_f32 v114, v170, v114
    v_mul_f32 v115, v170, v115
    v_mfma_f32_16x16x32_bf16 v[126:129], a[244:247], v[122:125], v[126:129]
    v_cvt_pk_bf16_f32 v194, v114, v115
    v_mul_f32 v116, v170, v116
    v_mfma_f32_16x16x32_bf16 v[126:129], a[248:251], v[150:153], v[126:129]
    ds_read_b128 v[202:205], v2 offset:12288
    v_mul_f32 v117, v170, v117
    v_mfma_f32_16x16x32_bf16 v[126:129], a[252:255], v[154:157], v[126:129]
    ds_read_b128 v[230:233], v2 offset:13312
    v_cvt_pk_bf16_f32 v195, v116, v117
    v_mfma_f32_16x16x32_bf16 v[126:129], v[82:85], v[158:161], v[126:129]
    ds_read_b128 v[234:237], v2 offset:14336
    v_mul_f32 v190, v170, v190
    v_mfma_f32_16x16x32_bf16 v[126:129], v[86:89], v[174:177], v[126:129]
    ds_read_b128 v[238:241], v2 offset:15360
    v_mul_f32 v191, v170, v191
    v_mfma_f32_16x16x32_bf16 v[114:117], v[90:93], v[118:121], 0
    ds_read_b128 v[118:121], v2 offset:16384
    v_cvt_pk_bf16_f32 v196, v190, v191
    v_mfma_f32_16x16x32_bf16 v[114:117], v[94:97], v[122:125], v[114:117]
    ds_read_b128 v[122:125], v2 offset:17408
    v_mul_f32 v192, v170, v192
    v_mfma_f32_16x16x32_bf16 v[114:117], v[98:101], v[150:153], v[114:117]
    v_fmac_f32 v255, v126, v126
    v_fmac_f32 v255, v127, v127
    v_mfma_f32_16x16x32_bf16 v[114:117], v[102:105], v[154:157], v[114:117]
    v_fmac_f32 v255, v128, v128
    v_fmac_f32 v255, v129, v129
    v_mfma_f32_16x16x32_bf16 v[114:117], v[106:109], v[158:161], v[114:117]
    s_waitcnt lgkmcnt(5)
    v_mul_f32 v193, v170, v193
    v_cvt_pk_bf16_f32 v197, v192, v193
    v_mfma_f32_16x16x32_bf16 v[114:117], v[110:113], v[174:177], v[114:117]
    s_waitcnt lgkmcnt(4)
    ds_write_b128 v3, v[194:197] offset:6144
    v_mfma_f32_16x16x32_bf16 v[242:245], a[216:219], v[202:205], 0
    s_waitcnt lgkmcnt(3)
    v_mul_f32 v146, v170, v146
    v_mul_f32 v147, v170, v147
    v_mfma_f32_16x16x32_bf16 v[242:245], a[220:223], v[230:233], v[242:245]
    s_waitcnt lgkmcnt(2)
    v_fmac_f32 v255, v114, v114
    v_fmac_f32 v255, v115, v115
    v_mfma_f32_16x16x32_bf16 v[242:245], a[224:227], v[234:237], v[242:245]
    s_waitcnt lgkmcnt(1)
    v_fmac_f32 v255, v116, v116
    v_fmac_f32 v255, v117, v117
    v_mfma_f32_16x16x32_bf16 v[242:245], a[228:231], v[238:241], v[242:245]
    v_cvt_pk_bf16_f32 v254, v254, v255
    v_cvt_pk_bf16_f32 v172, v146, v147
    v_mfma_f32_16x16x32_bf16 v[242:245], a[232:235], v[118:121], v[242:245]
    v_mul_f32 v148, v170, v148
    v_mul_f32 v149, v170, v149
    v_mfma_f32_16x16x32_bf16 v[242:245], a[236:239], v[122:125], v[242:245]
    v_cvt_pk_bf16_f32 v173, v148, v149
    v_cvt_pk_bf16_f32 v39, v252, 0
    v_mfma_f32_16x16x32_bf16 v[158:161], a[240:243], v[202:205], 0
    ds_write_b64 v4, v[172:173] offset:10240
    v_mfma_f32_16x16x32_bf16 v[158:161], a[244:247], v[230:233], v[158:161]
    v_exp_f32 v167, v167
    v_mfma_f32_16x16x32_bf16 v[158:161], a[248:251], v[234:237], v[158:161]
    v_cvt_pk_bf16_f32 v36, v166, v167
    v_fma_f32 v255, v242, v242, s33
    v_mfma_f32_16x16x32_bf16 v[158:161], a[252:255], v[238:241], v[158:161]
    v_fmac_f32 v255, v243, v243
    v_fmac_f32 v255, v244, v244
    v_mfma_f32_16x16x32_bf16 v[158:161], v[82:85], v[118:121], v[158:161]
    v_fmac_f32 v255, v245, v245
    v_xor_b32 v2, 65536, v2
    v_mfma_f32_16x16x32_bf16 v[158:161], v[86:89], v[122:125], v[158:161]
    v_exp_f32 v168, v168
    v_mfma_f32_16x16x32_bf16 v[154:157], v[90:93], v[202:205], 0
    v_exp_f32 v169, v169
    v_mfma_f32_16x16x32_bf16 v[154:157], v[94:97], v[230:233], v[154:157]
    ds_read_b128 v[146:149], v9
    v_cvt_pk_bf16_f32 v37, v168, v169
    v_mfma_f32_16x16x32_bf16 v[154:157], v[98:101], v[234:237], v[154:157]
    ds_read_b128 v[150:153], v9 offset:64
    v_fmac_f32 v255, v158, v158
    v_mfma_f32_16x16x32_bf16 v[166:169], v[28:31], v[36:39], 0
    v_fmac_f32 v255, v159, v159
    v_fmac_f32 v255, v160, v160
    v_mfma_f32_16x16x32_bf16 v[166:169], v[28:31], v[186:189], v[166:169]
    v_fmac_f32 v255, v161, v161
    v_add_u32 v6, s75, v6
    v_mfma_f32_16x16x32_bf16 v[174:177], v[162:165], v[36:39], 0
    v_rcp_f32 v182, v182
    v_mfma_f32_16x16x32_bf16 v[174:177], v[134:137], v[186:189], v[174:177]
    v_max3_u32 v25, v25, v182, v183
    v_max3_u32 v25, v25, v170, v171
    v_mfma_f32_16x16x32_bf16 v[170:173], v[210:213], v[36:39], 0
    v_rcp_f32 v166, v166
    v_mfma_f32_16x16x32_bf16 v[170:173], v[138:141], v[186:189], v[170:173]
    v_max3_u32 v25, v25, v166, v167
    v_mul_f32 v214, v182, v214
    v_mfma_f32_16x16x32_bf16 v[190:193], v[218:221], v[36:39], 0
    s_waitcnt lgkmcnt(1)
    v_mul_f32 v174, v166, v174
    v_mul_f32 v175, v166, v175
    v_mfma_f32_16x16x32_bf16 v[190:193], v[142:145], v[186:189], v[190:193]
    s_waitcnt lgkmcnt(0)
    v_cvt_pk_bf16_f32 v174, v174, v175
    v_mul_f32 v176, v166, v176
    v_mfma_f32_16x16x32_bf16 v[154:157], v[102:105], v[238:241], v[154:157]
    ds_read_b128 v[186:189], v0 offset:20480
    v_mul_f32 v177, v166, v177
    v_mfma_f32_16x16x32_bf16 v[154:157], v[106:109], v[118:121], v[154:157]
    ds_read_b128 v[194:197], v1 offset:20480
    v_cvt_pk_bf16_f32 v175, v176, v177
    v_mfma_f32_16x16x32_bf16 v[154:157], v[110:113], v[122:125], v[154:157]
    ds_read_b128 v[122:125], v0 offset:20608
    v_mul_f32 v170, v166, v170
    v_mfma_f32_16x16x32_bf16 v[118:121], v[146:149], v[28:31], 0
    ds_read_b128 v[202:205], v1 offset:20608
    v_mul_f32 v171, v166, v171
    v_mfma_f32_16x16x32_bf16 v[118:121], v[150:153], v[28:31], v[118:121]
    ds_read_b128 v[230:233], v0 offset:20736
    v_cvt_pk_bf16_f32 v176, v170, v171
    v_mfma_f32_16x16x32_bf16 v[234:237], v[146:149], v[134:137], 0
    ds_read_b128 v[238:241], v1 offset:20736
    v_fmac_f32 v255, v154, v154
    v_mfma_f32_16x16x32_bf16 v[234:237], v[150:153], v[162:165], v[234:237]
    v_fmac_f32 v255, v155, v155
    v_fmac_f32 v255, v156, v156
    v_mfma_f32_16x16x32_bf16 v[134:137], v[146:149], v[138:141], 0
    v_fmac_f32 v255, v157, v157
    v_cvt_pk_bf16_f32 v255, v255, v255
    v_mfma_f32_16x16x32_bf16 v[134:137], v[150:153], v[210:213], v[134:137]
    s_waitcnt lgkmcnt(5)
    ds_write_b64 v4, v[254:255] offset:18432
    v_mfma_f32_16x16x32_bf16 v[138:141], v[146:149], v[142:145], 0
    s_waitcnt lgkmcnt(4)
    v_mul_f32 v172, v166, v172
    v_mul_f32 v173, v166, v173
    v_mfma_f32_16x16x32_bf16 v[138:141], v[150:153], v[218:221], v[138:141]
    s_waitcnt lgkmcnt(3)
    v_cvt_pk_bf16_f32 v177, v172, v173
    v_mul_f32 v190, v166, v190
    v_mfma_f32_16x16x32_bf16 v[142:145], a[72:75], v[186:189], 0
    s_waitcnt lgkmcnt(2)
    ds_write_b128 v3, v[174:177] offset:12288
    v_mfma_f32_16x16x32_bf16 v[142:145], a[76:79], v[194:197], v[142:145]
    s_waitcnt lgkmcnt(2)
    v_mul_f32 v191, v166, v191
    v_cvt_pk_bf16_f32 v120, v190, v191
    v_mfma_f32_16x16x32_bf16 v[142:145], a[80:83], v[122:125], v[142:145]
    v_mul_f32 v192, v166, v192
    v_mul_f32 v193, v166, v193
    v_mfma_f32_16x16x32_bf16 v[142:145], a[84:87], v[202:205], v[142:145]
    v_cvt_pk_bf16_f32 v121, v192, v193
    v_mul_f32 v215, v182, v215
    v_mfma_f32_16x16x32_bf16 v[142:145], a[88:91], v[230:233], v[142:145]
    ds_write_b64 v4, v[120:121] offset:16384
    v_mfma_f32_16x16x32_bf16 v[142:145], a[92:95], v[238:241], v[142:145]
    v_rcp_f32 v118, v118
    v_mfma_f32_16x16x32_bf16 v[150:153], a[96:99], v[186:189], 0
    v_max3_u32 v25, v25, v118, v119
    v_mul_f32 v234, v234, v118
    v_mfma_f32_16x16x32_bf16 v[150:153], a[100:103], v[194:197], v[150:153]
    v_cvt_pk_bf16_f32 v146, v214, v215
    v_mul_f32_dpp v234, v134, v118 quad_perm:[0,1,2,3] row_mask:0x2 bank_mask:0xf
    v_mfma_f32_16x16x32_bf16 v[150:153], a[104:107], v[122:125], v[150:153]
    v_mul_f32 v216, v182, v216
    v_mul_f32_dpp v234, v138, v118 quad_perm:[0,1,2,3] row_mask:0x4 bank_mask:0xf
    v_mfma_f32_16x16x32_bf16 v[150:153], a[108:111], v[202:205], v[150:153]
    v_cvt_pk_bf16_f32 v234, v234, v234
    v_mul_f32 v217, v182, v217
    v_mfma_f32_16x16x32_bf16 v[150:153], a[112:115], v[230:233], v[150:153]
    ds_write_b16 v7, v234
    v_mfma_f32_16x16x32_bf16 v[150:153], a[116:119], v[238:241], v[150:153]
    v_cvt_pk_bf16_f32 v147, v216, v217
    v_mul_f32 v222, v182, v222
    v_mfma_f32_16x16x32_bf16 v[134:137], a[120:123], v[186:189], 0
    v_mul_f32 v223, v182, v223
    v_cvt_pk_bf16_f32 v148, v222, v223
    v_mfma_f32_16x16x32_bf16 v[134:137], a[124:127], v[194:197], v[134:137]
    v_mul_f32 v224, v182, v224
    v_mul_f32 v225, v182, v225
    v_mfma_f32_16x16x32_bf16 v[134:137], a[128:131], v[122:125], v[134:137]
    v_cvt_pk_bf16_f32 v149, v224, v225
    v_mul_f32 v226, v182, v226
    v_mfma_f32_16x16x32_bf16 v[134:137], a[132:135], v[202:205], v[134:137]
    ds_write_b128 v3, v[146:149] offset:0
    v_mfma_f32_16x16x32_bf16 v[134:137], a[136:139], v[230:233], v[134:137]
    v_mul_f32 v227, v182, v227
    v_cvt_pk_bf16_f32 v254, v226, v227
    v_mfma_f32_16x16x32_bf16 v[134:137], a[140:143], v[238:241], v[134:137]
    v_mul_f32 v228, v182, v228
    v_mul_f32 v229, v182, v229
    v_mfma_f32_16x16x32_bf16 v[138:141], a[0:3], v[186:189], 0
    v_cvt_pk_bf16_f32 v255, v228, v229
    v_xor_b32 v3, 65536, v3
    v_mfma_f32_16x16x32_bf16 v[138:141], a[4:7], v[194:197], v[138:141]
    ds_write_b64 v4, v[254:255] offset:4096
    v_mfma_f32_16x16x32_bf16 v[138:141], a[8:11], v[122:125], v[138:141]
    v_xor_b32 v4, 65536, v4
    v_add_u32 v7, s76, v7
    v_mfma_f32_16x16x32_bf16 v[138:141], a[12:15], v[202:205], v[138:141]
    v_cvt_pk_f16_f32 v146, v142, v143
    v_pk_mul_f16 v143, v146, v146
    v_mfma_f32_16x16x32_bf16 v[138:141], a[16:19], v[230:233], v[138:141]
    v_cvt_pk_f16_f32 v147, v144, v145
    v_pk_fma_f16 v143, v147, v147, v143
    v_mfma_f32_16x16x32_bf16 v[138:141], a[20:23], v[238:241], v[138:141]
    v_cvt_pk_f16_f32 v148, v150, v151
    v_pk_fma_f16 v143, v148, v148, v143
    v_mfma_f32_16x16x32_bf16 v[166:169], a[24:27], v[186:189], 0
    v_cvt_pk_f16_f32 v149, v152, v153
    v_pk_fma_f16 v143, v149, v149, v143
    v_mfma_f32_16x16x32_bf16 v[166:169], a[28:31], v[194:197], v[166:169]
    v_cvt_pk_f16_f32 v120, v134, v135
    v_pk_fma_f16 v143, v120, v120, v143
    v_mfma_f32_16x16x32_bf16 v[166:169], a[32:35], v[122:125], v[166:169]
    s_waitcnt lgkmcnt(0)
    v_cvt_pk_f16_f32 v121, v136, v137
    v_pk_fma_f16 v143, v121, v121, v143
    v_mfma_f32_16x16x32_bf16 v[166:169], a[36:39], v[202:205], v[166:169]
    s_barrier
    v_mfma_f32_16x16x32_bf16 v[166:169], a[40:43], v[230:233], v[166:169]
    s_nop 0
    v_mfma_f32_16x16x32_bf16 v[166:169], a[44:47], v[238:241], v[166:169]
    s_nop 0
    v_mfma_f32_16x16x32_bf16 v[134:137], a[48:51], v[186:189], 0
    s_nop 0
    v_mfma_f32_16x16x32_bf16 v[134:137], a[52:55], v[194:197], v[134:137]
    s_cbranch_scc1 L_loop_fast0
    s_branch L_final_fast
.p2align 6
L_loop_fast1:
    v_mfma_f32_16x16x32_bf16 v[134:137], a[56:59], v[122:125], v[134:137]
    s_add_u32 s12, s40, s27
    ds_read_b128 v[190:193], v2 offset:18432
    v_cvt_pk_f16_f32 v150, v138, v139
    v_mfma_f32_16x16x32_bf16 v[134:137], a[60:63], v[202:205], v[134:137]
    s_addc_u32 s13, s41, 0
    ds_read_b128 v[210:213], v2 offset:19456
    v_pk_mul_f16 v142, v150, v150
    v_mfma_f32_16x16x32_bf16 v[134:137], a[64:67], v[230:233], v[134:137]
    s_sub_u32 s14, s36, s27
    ds_read_b128 v[174:177], v5 offset:32
    v_cvt_pk_f16_f32 v151, v140, v141
    v_mfma_f32_16x16x32_bf16 v[134:137], a[68:71], v[238:241], v[134:137]
    s_cmp_ge_u32 s18, 2
    ds_read2_b64 v[162:165], v5 offset0:6 offset1:9
    v_pk_fma_f16 v142, v151, v151, v142
    v_mfma_f32_16x16x32_bf16 v[138:141], v[186:189], a[144:147], 0
    s_cselect_b32 s14, s14, 0
    ds_read_b128 v[170:173], v5
    v_cvt_pk_f16_f32 v152, v166, v167
    v_mfma_f32_16x16x32_bf16 v[138:141], v[194:197], a[148:151], v[138:141]
    s_sub_u32 s82, s72, s71
    ds_read_b32 v254, v6 offset:192
    v_pk_fma_f16 v142, v152, v152, v142
    v_mfma_f32_16x16x32_bf16 v[138:141], v[122:125], a[152:155], v[138:141]
    s_mul_i32 s74, s82, 336
    v_cvt_pk_f16_f32 v153, v168, v169
    v_pk_fma_f16 v142, v153, v153, v142
    v_mfma_f32_16x16x32_bf16 v[138:141], v[202:205], a[156:159], v[138:141]
    s_mul_i32 s75, s82, 272
    v_cvt_pk_f16_f32 v118, v134, v135
    v_pk_fma_f16 v142, v118, v118, v142
    v_mfma_f32_16x16x32_bf16 v[138:141], v[230:233], a[160:163], v[138:141]
    s_waitcnt lgkmcnt(5)
    ds_read_b128 v[182:185], v0 offset:26624
    v_cvt_pk_f16_f32 v119, v136, v137
    v_mfma_f32_16x16x32_bf16 v[166:169], v[32:35], v[190:193], 0
    s_waitcnt lgkmcnt(5)
    v_pk_fma_f16 v142, v119, v119, v142
    v_add_u32 v5, s74, v5
    v_mfma_f32_16x16x32_bf16 v[166:169], v[32:35], v[210:213], v[166:169]
    s_waitcnt lgkmcnt(4)
    v_pk_mul_f16 v145, v146, v174
    v_pk_fma_f16 v145, v147, v175, v145
    v_mfma_f32_16x16x32_bf16 v[138:141], v[238:241], a[164:167], v[138:141]
    s_mul_i32 s76, s82, 16
    ds_read_b128 v[210:213], v1 offset:26624
    v_pk_fma_f16 v145, v148, v176, v145
    v_mfma_f32_16x16x32_bf16 v[214:217], v[186:189], a[168:171], 0
    s_waitcnt lgkmcnt(3)
    ds_read_b128 v[218:221], v0 offset:26752
    v_pk_fma_f16 v145, v149, v177, v145
    v_mfma_f32_16x16x32_bf16 v[214:217], v[194:197], a[172:175], v[214:217]
    s_waitcnt lgkmcnt(3)
    ds_read_b128 v[222:225], v1 offset:26752
    v_mov_b32_dpp v254, v23 quad_perm:[0,1,2,3] row_mask:0x7 bank_mask:0xf
    v_mfma_f32_16x16x32_bf16 v[214:217], v[122:125], a[176:179], v[214:217]
    s_add_u32 s34, s18, 2
    ds_read_b128 v[226:229], v0 offset:26880
    v_pk_fma_f16 v145, v120, v164, v145
    v_mfma_f32_16x16x32_bf16 v[214:217], v[202:205], a[180:183], v[214:217]
    s_add_u32 s8, s60, s23
    ds_read_b128 v[190:193], v1 offset:26880
    v_pk_fma_f16 v145, v121, v165, v145
    v_mfma_f32_16x16x32_bf16 v[214:217], v[230:233], a[184:187], v[214:217]
    s_waitcnt lgkmcnt(5)
    v_pk_mul_f16 v144, v150, v170
    v_pk_fma_f16 v144, v151, v171, v144
    v_mfma_f32_16x16x32_bf16 v[214:217], v[238:241], a[188:191], v[214:217]
    s_addc_u32 s9, s61, 0
    v_pk_fma_f16 v144, v152, v172, v144
    v_pk_fma_f16 v144, v153, v173, v144
    v_mfma_f32_16x16x32_bf16 v[246:249], v[186:189], a[192:195], 0
    s_sub_u32 s10, s36, s23
    v_pk_fma_f16 v144, v118, v162, v144
    v_pk_fma_f16 v144, v119, v163, v144
    v_mfma_f32_16x16x32_bf16 v[246:249], v[194:197], a[196:199], v[246:249]
    s_cmp_le_u32 s34, s45
    v_cvt_pk_bf16_f32 v134, v138, v139
    v_cvt_pk_bf16_f32 v135, v140, v141
    v_mfma_f32_16x16x32_f16 v[234:237], v[40:43], v[142:145], 0
    s_cselect_b32 s10, s10, 0
    v_cvt_pk_bf16_f32 v138, v214, v215
    v_cvt_pk_bf16_f32 v139, v216, v217
    v_mfma_f32_16x16x32_bf16 v[246:249], v[122:125], a[200:203], v[246:249]
    s_add_u32 m0, s28, 0
    v_mul_f32 v136, 0x3baaaaab, v166
    v_mul_f32 v255, 0x3baaaaab, v167
    v_mfma_f32_16x16x32_bf16 v[246:249], v[202:205], a[204:207], v[246:249]
    s_mov_b32 s27, s26
    v_rsq_f32 v234, v234
    v_mfma_f32_16x16x32_bf16 v[246:249], v[230:233], a[208:211], v[246:249]
    s_mov_b32 s26, s25
    v_rsq_f32 v235, v235
    v_mfma_f32_16x16x32_bf16 v[246:249], v[238:241], a[212:215], v[246:249]
    s_mov_b32 s25, s24
    v_mul_f32 v140, s31, v234
    v_cvt_pk_f16_f32 v141, v140, v235
    v_mfma_f32_16x16x32_bf16 v[122:125], a[72:75], v[182:185], 0
    s_waitcnt lgkmcnt(0)
    v_fma_f32 v236, v236, v140, v22
    v_fmac_f32_dpp v254, v237, v235 quad_perm:[0,1,2,3] row_mask:0x1 bank_mask:0xf
    v_mfma_f32_16x16x32_bf16 v[122:125], a[76:79], v[210:213], v[122:125]
    s_mov_b32 s24, s23
    v_cvt_pk_bf16_f32 v142, v246, v247
    v_cvt_pk_bf16_f32 v143, v248, v249
    v_mfma_f32_16x16x32_bf16 v[122:125], a[80:83], v[218:221], v[122:125]
    s_mov_b32 s71, s72
    v_pk_mul_f16 v146, v146, v141 op_sel:[0,1] op_sel_hi:[1,1]
    v_pk_mul_f16 v147, v147, v141 op_sel:[0,1] op_sel_hi:[1,1]
    v_mfma_f32_16x16x32_bf16 v[122:125], a[84:87], v[222:225], v[122:125]
    s_mov_b32 s72, s73
    v_pk_mul_f16 v148, v148, v141 op_sel:[0,1] op_sel_hi:[1,1]
    v_pk_mul_f16 v149, v149, v141 op_sel:[0,1] op_sel_hi:[1,1]
    v_mfma_f32_16x16x32_bf16 v[122:125], a[88:91], v[226:229], v[122:125]
    v_pk_mul_f16 v120, v120, v141 op_sel:[0,1] op_sel_hi:[1,1]
    v_pk_mul_f16 v121, v121, v141 op_sel:[0,1] op_sel_hi:[1,1]
    v_mfma_f32_16x16x32_bf16 v[122:125], a[92:95], v[190:193], v[122:125]
    v_pk_mul_f16 v150, v150, v141 op_sel:[0,0] op_sel_hi:[1,0]
    v_pk_mul_f16 v151, v151, v141 op_sel:[0,0] op_sel_hi:[1,0]
    v_mfma_f32_16x16x32_bf16 v[186:189], a[96:99], v[182:185], 0
    v_pk_mul_f16 v152, v152, v141 op_sel:[0,0] op_sel_hi:[1,0]
    v_pk_mul_f16 v153, v153, v141 op_sel:[0,0] op_sel_hi:[1,0]
    v_mfma_f32_16x16x32_bf16 v[186:189], a[100:103], v[210:213], v[186:189]
    v_pk_mul_f16 v118, v118, v141 op_sel:[0,0] op_sel_hi:[1,0]
    v_pk_mul_f16 v119, v119, v141 op_sel:[0,0] op_sel_hi:[1,0]
    v_mfma_f32_16x16x32_bf16 v[186:189], a[104:107], v[218:221], v[186:189]
    v_max3_u32 v44, v44, v234, v235
    v_mul_f32 v144, 0x3baaaaab, v168
    v_mfma_f32_16x16x32_bf16 v[186:189], a[108:111], v[222:225], v[186:189]
    v_rsq_f32 v136, v136
    v_mfma_f32_16x16x32_bf16 v[186:189], a[112:115], v[226:229], v[186:189]
    v_rsq_f32 v255, v255
    v_mfma_f32_16x16x32_bf16 v[186:189], a[116:119], v[190:193], v[186:189]
    v_rsq_f32 v144, v144
    v_mfma_f32_16x16x32_bf16 v[194:197], a[120:123], v[182:185], 0
    v_mul_f32 v178, v136, v178
    v_mul_f32 v179, v136, v179
    v_mfma_f32_16x16x32_bf16 v[194:197], a[124:127], v[210:213], v[194:197]
    v_cvt_pk_bf16_f32 v166, v178, v179
    v_mul_f32 v180, v136, v180
    v_mfma_f32_16x16x32_bf16 v[194:197], a[128:131], v[218:221], v[194:197]
    v_mul_f32 v181, v136, v181
    v_cvt_pk_bf16_f32 v167, v180, v181
    v_mfma_f32_16x16x32_bf16 v[194:197], a[132:135], v[222:225], v[194:197]
    v_mul_f32 v198, v136, v198
    v_mul_f32 v199, v136, v199
    v_mfma_f32_16x16x32_bf16 v[194:197], a[136:139], v[226:229], v[194:197]
    v_cvt_pk_bf16_f32 v168, v198, v199
    v_mul_f32 v200, v136, v200
    v_mfma_f32_16x16x32_bf16 v[194:197], a[140:143], v[190:193], v[194:197]
    v_mul_f32 v201, v136, v201
    v_cvt_pk_bf16_f32 v169, v200, v201
    v_mfma_f32_16x16x32_bf16 v[178:181], a[0:3], v[182:185], 0
    buffer_store_dwordx4 v[166:169], v15, s[12:15], 0 offen nt
    v_mul_f32 v206, v136, v206
    v_mul_f32 v207, v136, v207
    v_cvt_pk_bf16_f32 v140, v206, v207
    v_mul_f32 v208, v136, v208
    v_mfma_f32_16x16x32_bf16 v[178:181], a[4:7], v[210:213], v[178:181]
    v_mul_f32 v209, v136, v209
    v_cvt_pk_bf16_f32 v141, v208, v209
    v_mfma_f32_16x16x32_bf16 v[178:181], a[8:11], v[218:221], v[178:181]
    v_cvt_pk_f16_f32 v166, v122, v123
    v_pk_mul_f16 v199, v166, v166
    v_mfma_f32_16x16x32_bf16 v[178:181], a[12:15], v[222:225], v[178:181]
    v_cvt_pk_f16_f32 v167, v124, v125
    v_pk_fma_f16 v199, v167, v167, v199
    v_mfma_f32_16x16x32_bf16 v[178:181], a[16:19], v[226:229], v[178:181]
    v_cvt_pk_f16_f32 v168, v186, v187
    v_pk_fma_f16 v199, v168, v168, v199
    v_mfma_f32_16x16x32_bf16 v[178:181], a[20:23], v[190:193], v[178:181]
    v_cvt_pk_f16_f32 v169, v188, v189
    v_pk_fma_f16 v199, v169, v169, v199
    v_mfma_f32_16x16x32_bf16 v[186:189], a[24:27], v[182:185], 0
    v_cvt_pk_f16_f32 v124, v194, v195
    v_pk_fma_f16 v199, v124, v124, v199
    v_mfma_f32_16x16x32_bf16 v[186:189], a[28:31], v[210:213], v[186:189]
    v_cvt_pk_f16_f32 v125, v196, v197
    v_pk_fma_f16 v199, v125, v125, v199
    v_mfma_f32_16x16x32_bf16 v[186:189], a[32:35], v[218:221], v[186:189]
    v_cvt_pk_f16_f32 v178, v178, v179
    v_pk_mul_f16 v198, v178, v178
    v_mfma_f32_16x16x32_bf16 v[186:189], a[36:39], v[222:225], v[186:189]
    v_cvt_pk_f16_f32 v179, v180, v181
    v_pk_fma_f16 v198, v179, v179, v198
    v_mfma_f32_16x16x32_bf16 v[186:189], a[40:43], v[226:229], v[186:189]
    v_pk_mul_f16 v200, v178, v170
    v_pk_fma_f16 v200, v179, v171, v200
    v_mfma_f32_16x16x32_bf16 v[186:189], a[44:47], v[190:193], v[186:189]
    v_pk_mul_f16 v201, v166, v174
    v_pk_fma_f16 v201, v167, v175, v201
    v_mfma_f32_16x16x32_bf16 v[194:197], a[48:51], v[182:185], 0
    v_pk_fma_f16 v201, v168, v176, v201
    v_pk_fma_f16 v201, v169, v177, v201
    v_mfma_f32_16x16x32_bf16 v[194:197], a[52:55], v[210:213], v[194:197]
    v_pk_fma_f16 v201, v124, v164, v201
    v_pk_fma_f16 v201, v125, v165, v201
    v_mfma_f32_16x16x32_bf16 v[194:197], a[56:59], v[218:221], v[194:197]
    v_cvt_pk_f16_f32 v180, v186, v187
    v_pk_fma_f16 v198, v180, v180, v198
    v_mfma_f32_16x16x32_bf16 v[194:197], a[60:63], v[222:225], v[194:197]
    v_cvt_pk_f16_f32 v181, v188, v189
    v_pk_fma_f16 v198, v181, v181, v198
    v_mfma_f32_16x16x32_bf16 v[194:197], a[64:67], v[226:229], v[194:197]
    v_pk_fma_f16 v200, v180, v172, v200
    v_pk_fma_f16 v200, v181, v173, v200
    v_mfma_f32_16x16x32_bf16 v[194:197], a[68:71], v[190:193], v[194:197]
    buffer_store_dwordx2 v[140:141], v18, s[12:15], 0 offen nt
    v_mul_f32 v242, v144, v242
    v_mul_f32 v243, v144, v243
    v_mfma_f32_16x16x32_bf16 v[186:189], v[182:185], a[144:147], 0
    v_cvt_pk_bf16_f32 v238, v242, v243
    v_mul_f32 v244, v144, v244
    v_mfma_f32_16x16x32_bf16 v[186:189], v[210:213], a[148:151], v[186:189]
    v_mul_f32 v245, v144, v245
    v_cvt_pk_f16_f32 v122, v194, v195
    v_mfma_f32_16x16x32_bf16 v[186:189], v[218:221], a[152:155], v[186:189]
    v_pk_fma_f16 v198, v122, v122, v198
    v_cvt_pk_f16_f32 v123, v196, v197
    v_mfma_f32_16x16x32_bf16 v[186:189], v[222:225], a[156:159], v[186:189]
    v_pk_fma_f16 v198, v123, v123, v198
    v_pk_fma_f16 v200, v122, v162, v200
    v_mfma_f32_16x16x32_bf16 v[186:189], v[226:229], a[160:163], v[186:189]
    ds_read_b128 v[202:205], v0 offset:32768
    v_pk_fma_f16 v200, v123, v163, v200
    v_mfma_f32_16x16x32_bf16 v[186:189], v[190:193], a[164:167], v[186:189]
    ds_read_b128 v[194:197], v1 offset:32768
    v_cvt_pk_bf16_f32 v239, v244, v245
    v_mfma_f32_16x16x32_f16 v[230:233], v[40:43], v[198:201], 0
    v_mul_f32 v158, v144, v158
    v_mul_f32 v159, v144, v159
    v_mfma_f32_16x16x32_bf16 v[246:249], v[182:185], a[168:171], 0
    ds_read_b128 v[214:217], v0 offset:32896
    v_cvt_pk_bf16_f32 v240, v158, v159
    v_mfma_f32_16x16x32_bf16 v[246:249], v[210:213], a[172:175], v[246:249]
    ds_read_b128 v[206:209], v1 offset:32896
    v_cvt_pk_bf16_f32 v136, v186, v187
    v_mfma_f32_16x16x32_bf16 v[246:249], v[218:221], a[176:179], v[246:249]
    ds_read_b128 v[198:201], v0 offset:33024
    v_cvt_pk_bf16_f32 v137, v188, v189
    v_mfma_f32_16x16x32_bf16 v[246:249], v[222:225], a[180:183], v[246:249]
    ds_read_b128 v[186:189], v1 offset:33024
    v_mul_f32 v160, v144, v160
    v_mfma_f32_16x16x32_bf16 v[246:249], v[226:229], a[184:187], v[246:249]
    v_rsq_f32 v230, v230
    v_mfma_f32_16x16x32_bf16 v[246:249], v[190:193], a[188:191], v[246:249]
    s_waitcnt lgkmcnt(5)
    v_rsq_f32 v231, v231
    v_mfma_f32_16x16x32_bf16 v[242:245], v[182:185], a[192:195], 0
    s_waitcnt lgkmcnt(4)
    v_mul_f32 v234, s31, v230
    v_cvt_pk_f16_f32 v235, v234, v231
    v_mfma_f32_16x16x32_bf16 v[242:245], v[210:213], a[196:199], v[242:245]
    v_fma_f32 v232, v232, v234, v24
    v_fmac_f32_dpp v254, v233, v231 quad_perm:[0,1,2,3] row_mask:0x2 bank_mask:0xf
    v_mfma_f32_16x16x32_bf16 v[242:245], v[218:221], a[200:203], v[242:245]
    s_waitcnt lgkmcnt(3)
    v_cvt_pk_bf16_f32 v140, v246, v247
    v_cvt_pk_bf16_f32 v141, v248, v249
    v_mfma_f32_16x16x32_bf16 v[242:245], v[222:225], a[204:207], v[242:245]
    s_waitcnt lgkmcnt(2)
    v_mul_f32 v161, v144, v161
    v_cvt_pk_bf16_f32 v241, v160, v161
    v_mfma_f32_16x16x32_bf16 v[242:245], v[226:229], a[208:211], v[242:245]
    s_waitcnt lgkmcnt(1)
    buffer_store_dwordx4 v[238:241], v17, s[12:15], 0 offen nt
    v_mul_f32 v154, v144, v154
    v_mul_f32 v155, v144, v155
    v_cvt_pk_bf16_f32 v154, v154, v155
    v_mul_f32 v156, v144, v156
    v_mfma_f32_16x16x32_bf16 v[242:245], v[190:193], a[212:215], v[242:245]
    s_waitcnt lgkmcnt(0)
    v_mul_f32 v157, v144, v157
    v_cvt_pk_bf16_f32 v155, v156, v157
    v_mfma_f32_16x16x32_bf16 v[158:161], a[72:75], v[202:205], 0
    v_pk_mul_f16 v166, v166, v235 op_sel:[0,1] op_sel_hi:[1,1]
    v_pk_mul_f16 v167, v167, v235 op_sel:[0,1] op_sel_hi:[1,1]
    v_mfma_f32_16x16x32_bf16 v[158:161], a[76:79], v[194:197], v[158:161]
    v_pk_mul_f16 v168, v168, v235 op_sel:[0,1] op_sel_hi:[1,1]
    v_cvt_pk_bf16_f32 v144, v242, v243
    v_mfma_f32_16x16x32_bf16 v[158:161], a[80:83], v[214:217], v[158:161]
    v_cvt_pk_bf16_f32 v145, v244, v245
    v_pk_mul_f16 v169, v169, v235 op_sel:[0,1] op_sel_hi:[1,1]
    v_mfma_f32_16x16x32_bf16 v[158:161], a[84:87], v[206:209], v[158:161]
    v_pk_mul_f16 v124, v124, v235 op_sel:[0,1] op_sel_hi:[1,1]
    v_pk_mul_f16 v125, v125, v235 op_sel:[0,1] op_sel_hi:[1,1]
    v_mfma_f32_16x16x32_bf16 v[158:161], a[88:91], v[198:201], v[158:161]
    v_pk_mul_f16 v178, v178, v235 op_sel:[0,0] op_sel_hi:[1,0]
    v_pk_mul_f16 v179, v179, v235 op_sel:[0,0] op_sel_hi:[1,0]
    v_mfma_f32_16x16x32_bf16 v[158:161], a[92:95], v[186:189], v[158:161]
    v_pk_mul_f16 v180, v180, v235 op_sel:[0,0] op_sel_hi:[1,0]
    v_pk_mul_f16 v181, v181, v235 op_sel:[0,0] op_sel_hi:[1,0]
    v_mfma_f32_16x16x32_bf16 v[182:185], a[96:99], v[202:205], 0
    v_pk_mul_f16 v122, v122, v235 op_sel:[0,0] op_sel_hi:[1,0]
    v_pk_mul_f16 v123, v123, v235 op_sel:[0,0] op_sel_hi:[1,0]
    v_mfma_f32_16x16x32_bf16 v[182:185], a[100:103], v[194:197], v[182:185]
    v_max3_u32 v44, v44, v230, v231
    v_mul_f32 v130, v255, v130
    v_mfma_f32_16x16x32_bf16 v[182:185], a[104:107], v[214:217], v[182:185]
    v_cvt_pk_f16_f32 v158, v158, v159
    v_pk_mul_f16 v191, v158, v158
    v_mfma_f32_16x16x32_bf16 v[182:185], a[108:111], v[206:209], v[182:185]
    v_cvt_pk_f16_f32 v159, v160, v161
    v_pk_fma_f16 v191, v159, v159, v191
    v_mfma_f32_16x16x32_bf16 v[182:185], a[112:115], v[198:201], v[182:185]
    v_pk_mul_f16 v193, v158, v174
    v_pk_fma_f16 v193, v159, v175, v193
    v_mfma_f32_16x16x32_bf16 v[182:185], a[116:119], v[186:189], v[182:185]
    v_exp_f32 v232, v232
    v_mfma_f32_16x16x32_bf16 v[210:213], a[120:123], v[202:205], 0
    v_exp_f32 v236, v236
    v_mfma_f32_16x16x32_bf16 v[210:213], a[124:127], v[194:197], v[210:213]
    v_cvt_pk_bf16_f32 v39, v236, 0
    v_mul_f32 v131, v255, v131
    v_mfma_f32_16x16x32_bf16 v[210:213], a[128:131], v[214:217], v[210:213]
    s_waitcnt vmcnt(3)
    ds_write_b16 v8, v45 offset:512
    v_mfma_f32_16x16x32_bf16 v[210:213], a[132:135], v[206:209], v[210:213]
    buffer_store_dwordx2 v[154:155], v20, s[12:15], 0 offen nt
    v_cvt_pk_f16_f32 v160, v182, v183
    v_mfma_f32_16x16x32_bf16 v[210:213], a[136:139], v[198:201], v[210:213]
    v_pk_fma_f16 v191, v160, v160, v191
    v_cvt_pk_f16_f32 v161, v184, v185
    v_mfma_f32_16x16x32_bf16 v[210:213], a[140:143], v[186:189], v[210:213]
    v_pk_fma_f16 v191, v161, v161, v191
    v_pk_fma_f16 v193, v160, v176, v193
    v_mfma_f32_16x16x32_bf16 v[154:157], a[0:3], v[202:205], 0
    v_pk_fma_f16 v193, v161, v177, v193
    v_cvt_pk_bf16_f32 v130, v130, v131
    v_mfma_f32_16x16x32_bf16 v[154:157], a[4:7], v[194:197], v[154:157]
    v_mul_f32 v132, v255, v132
    v_mul_f32 v133, v255, v133
    v_mfma_f32_16x16x32_bf16 v[154:157], a[8:11], v[214:217], v[154:157]
    v_cvt_pk_f16_f32 v176, v210, v211
    v_pk_fma_f16 v191, v176, v176, v191
    v_mfma_f32_16x16x32_bf16 v[154:157], a[12:15], v[206:209], v[154:157]
    s_waitcnt lgkmcnt(0)
    v_cvt_pk_f16_f32 v177, v212, v213
    v_pk_fma_f16 v191, v177, v177, v191
    v_mfma_f32_16x16x32_bf16 v[154:157], a[16:19], v[198:201], v[154:157]
    v_pk_fma_f16 v193, v176, v164, v193
    v_mfma_f32_16x16x32_bf16 v[154:157], a[20:23], v[186:189], v[154:157]
    s_barrier
    v_pk_fma_f16 v193, v177, v165, v193
    v_mfma_f32_16x16x32_bf16 v[182:185], a[24:27], v[202:205], 0
    v_cvt_pk_bf16_f32 v131, v132, v133
    v_mfma_f32_16x16x32_bf16 v[182:185], a[28:31], v[194:197], v[182:185]
    ds_read2_b32 v[164:165], v6 offset0:0 offset1:0
    v_mfma_f32_16x16x32_bf16 v[182:185], a[32:35], v[214:217], v[182:185]
    ds_read2_b32 v[212:213], v6 offset0:16 offset1:16
    v_cvt_pk_f16_f32 v154, v154, v155
    v_mfma_f32_16x16x32_bf16 v[182:185], a[36:39], v[206:209], v[182:185]
    ds_read2_b32 v[220:221], v6 offset0:32 offset1:32
    v_pk_mul_f16 v190, v154, v154
    v_mfma_f32_16x16x32_bf16 v[182:185], a[40:43], v[198:201], v[182:185]
    ds_read_u16 v133, v9 offset:384
    v_cvt_pk_f16_f32 v155, v156, v157
    v_mfma_f32_16x16x32_bf16 v[182:185], a[44:47], v[186:189], v[182:185]
    v_pk_fma_f16 v190, v155, v155, v190
    v_pk_mul_f16 v192, v154, v170
    v_mfma_f32_16x16x32_bf16 v[222:225], a[48:51], v[202:205], 0
    v_pk_fma_f16 v192, v155, v171, v192
    v_mul_f32 v126, v255, v126
    v_mfma_f32_16x16x32_bf16 v[222:225], a[52:55], v[194:197], v[222:225]
    v_mul_f32 v127, v255, v127
    v_cvt_pk_bf16_f32 v132, v126, v127
    v_mfma_f32_16x16x32_bf16 v[222:225], a[56:59], v[214:217], v[222:225]
    buffer_load_dwordx4 v10, s[8:11], 0 offen nt lds
    v_cvt_pk_f16_f32 v156, v182, v183
    v_mfma_f32_16x16x32_bf16 v[222:225], a[60:63], v[206:209], v[222:225]
    s_add_u32 m0, s28, 4096
    v_pk_fma_f16 v190, v156, v156, v190
    v_cvt_pk_f16_f32 v157, v184, v185
    v_mfma_f32_16x16x32_bf16 v[222:225], a[64:67], v[198:201], v[222:225]
    s_waitcnt lgkmcnt(2)
    v_pk_fma_f16 v190, v157, v157, v190
    v_pk_fma_f16 v192, v156, v172, v192
    v_mfma_f32_16x16x32_bf16 v[222:225], a[68:71], v[186:189], v[222:225]
    s_waitcnt lgkmcnt(1)
    ds_read_b128 v[182:185], v2 offset:0
    v_pk_fma_f16 v192, v157, v173, v192
    v_mfma_f32_16x16x32_bf16 v[170:173], v[202:205], a[144:147], 0
    s_waitcnt lgkmcnt(1)
    ds_read_b128 v[226:229], v2 offset:1024
    v_readfirstlane_b32 s77, v133
    v_mfma_f32_16x16x32_bf16 v[170:173], v[194:197], a[148:151], v[170:173]
    ds_read_b128 v[234:237], v2 offset:2048
    buffer_load_dwordx4 v11, s[8:11], 0 offen nt lds
    v_mfma_f32_16x16x32_bf16 v[170:173], v[214:217], a[152:155], v[170:173]
    s_add_u32 m0, s28, 8192
    ds_read_b128 v[238:241], v2 offset:3072
    v_cvt_pk_f16_f32 v174, v222, v223
    v_mfma_f32_16x16x32_bf16 v[170:173], v[206:209], a[156:159], v[170:173]
    s_mul_i32 s78, s77, 2688
    ds_read_b128 v[242:245], v2 offset:4096
    v_pk_fma_f16 v190, v174, v174, v190
    v_mfma_f32_16x16x32_bf16 v[170:173], v[198:201], a[160:163], v[170:173]
    ds_read_b128 v[246:249], v2 offset:5120
    v_cvt_pk_f16_f32 v175, v224, v225
    v_mfma_f32_16x16x32_bf16 v[170:173], v[186:189], a[164:167], v[170:173]
    v_pk_fma_f16 v190, v175, v175, v190
    v_pk_fma_f16 v192, v174, v162, v192
    v_mfma_f32_16x16x32_bf16 v[222:225], v[202:205], a[168:171], 0
    buffer_load_dwordx4 v12, s[8:11], 0 offen nt lds
    v_pk_fma_f16 v192, v175, v163, v192
    v_mfma_f32_16x16x32_bf16 v[222:225], v[194:197], a[172:175], v[222:225]
    s_waitcnt lgkmcnt(5)
    v_mul_f32 v128, v255, v128
    v_cvt_pk_bf16_f32 v162, v170, v171
    v_mfma_f32_16x16x32_f16 v[250:253], v[40:43], v[190:193], 0
    s_add_u32 m0, s28, 12288
    v_cvt_pk_bf16_f32 v163, v172, v173
    v_mul_f32 v129, v255, v129
    v_mfma_f32_16x16x32_bf16 v[222:225], v[214:217], a[176:179], v[222:225]
    s_xor_b32 s28, s28, 65536
    v_cvt_pk_bf16_f32 v133, v128, v129
    v_mul_f32 v114, v255, v114
    v_mfma_f32_16x16x32_bf16 v[222:225], v[206:209], a[180:183], v[222:225]
    s_waitcnt lgkmcnt(2)
    v_rsq_f32 v250, v250
    v_mfma_f32_16x16x32_bf16 v[222:225], v[198:201], a[184:187], v[222:225]
    s_waitcnt lgkmcnt(1)
    buffer_load_dwordx4 v13, s[8:11], 0 offen nt lds
    v_mul_f32 v230, s31, v250
    v_mfma_f32_16x16x32_bf16 v[222:225], v[186:189], a[188:191], v[222:225]
    s_mov_b32 m0, s29
    v_rsq_f32 v251, v251
    v_mfma_f32_16x16x32_bf16 v[126:129], v[202:205], a[192:195], 0
    s_xor_b32 s29, s29, s30
    v_cvt_pk_f16_f32 v231, v230, v251
    v_fma_f32 v252, v252, v230, v26
    v_mfma_f32_16x16x32_bf16 v[126:129], v[194:197], a[196:199], v[126:129]
    s_add_u32 s19, s19, s20
    v_fmac_f32_dpp v254, v253, v251 quad_perm:[0,1,2,3] row_mask:0x4 bank_mask:0xf
    v_cvt_pk_bf16_f32 v210, v222, v223
    v_mfma_f32_16x16x32_bf16 v[126:129], v[214:217], a[200:203], v[126:129]
    s_add_u32 s23, s23, s21
    v_cvt_pk_bf16_f32 v211, v224, v225
    v_pk_mul_f16 v158, v158, v231 op_sel:[0,1] op_sel_hi:[1,1]
    v_mfma_f32_16x16x32_bf16 v[126:129], v[206:209], a[204:207], v[126:129]
    s_waitcnt lgkmcnt(0)
    buffer_load_dwordx4 v14, s[8:11], 0 offen nt lds
    v_pk_mul_f16 v159, v159, v231 op_sel:[0,1] op_sel_hi:[1,1]
    v_mfma_f32_16x16x32_bf16 v[126:129], v[198:201], a[208:211], v[126:129]
    s_cmp_ge_u32 s19, 72
    v_pk_mul_f16 v160, v160, v231 op_sel:[0,1] op_sel_hi:[1,1]
    v_pk_mul_f16 v161, v161, v231 op_sel:[0,1] op_sel_hi:[1,1]
    v_mfma_f32_16x16x32_bf16 v[126:129], v[186:189], a[212:215], v[126:129]
    s_cselect_b32 s34, 72, 0
    v_pk_mul_f16 v176, v176, v231 op_sel:[0,1] op_sel_hi:[1,1]
    v_pk_mul_f16 v177, v177, v231 op_sel:[0,1] op_sel_hi:[1,1]
    v_mfma_f32_16x16x32_f16 v[170:173], v[146:149], v[150:153], v[46:49]
    s_cselect_b32 s35, s22, 0
    v_pk_mul_f16 v154, v154, v231 op_sel:[0,0] op_sel_hi:[1,0]
    v_pk_mul_f16 v155, v155, v231 op_sel:[0,0] op_sel_hi:[1,0]
    v_mfma_f32_16x16x32_f16 v[186:189], v[166:169], v[150:153], v[50:53]
    s_sub_u32 s19, s19, s34
    v_cvt_pk_bf16_f32 v218, v126, v127
    v_cvt_pk_bf16_f32 v219, v128, v129
    v_mfma_f32_16x16x32_f16 v[126:129], v[158:161], v[150:153], v[54:57]
    buffer_store_dwordx4 v[130:133], v16, s[12:15], 0 offen nt
    v_pk_mul_f16 v156, v156, v231 op_sel:[0,0] op_sel_hi:[1,0]
    v_pk_mul_f16 v157, v157, v231 op_sel:[0,0] op_sel_hi:[1,0]
    v_pk_mul_f16 v174, v174, v231 op_sel:[0,0] op_sel_hi:[1,0]
    v_pk_mul_f16 v175, v175, v231 op_sel:[0,0] op_sel_hi:[1,0]
    v_mfma_f32_16x16x16_f16 v[170:173], v[120:121], v[118:119], v[170:173]
    v_max3_u32 v44, v44, v250, v251
    v_exp_f32 v254, v254
    v_mfma_f32_16x16x16_f16 v[186:189], v[124:125], v[118:119], v[186:189]
    v_cvt_pk_bf16_f32 v254, v254, v254
    v_exp_f32 v252, v252
    v_mfma_f32_16x16x16_f16 v[126:129], v[176:177], v[118:119], v[126:129]
    v_mul_f32 v115, v255, v115
    v_cvt_pk_bf16_f32 v118, v114, v115
    v_exp_f32 v170, v170
    v_mfma_f32_16x16x32_f16 v[130:133], v[146:149], v[178:181], v[58:61]
    s_add_u32 s23, s23, s35
    ds_write_b16 v8, v254
    v_mfma_f32_16x16x32_f16 v[150:153], v[166:169], v[178:181], v[62:65]
    s_add_u32 s78, s78, s69
    v_exp_f32 v171, v171
    v_mfma_f32_16x16x32_f16 v[190:193], v[158:161], v[178:181], v[66:69]
    s_add_u32 s80, s77, s68
    v_cvt_pk_bf16_f32 v170, v170, v171
    v_exp_f32 v172, v172
    v_mfma_f32_16x16x16_f16 v[130:133], v[120:121], v[122:123], v[130:133]
    v_exp_f32 v173, v173
    v_mul_f32 v116, v255, v116
    v_mfma_f32_16x16x16_f16 v[150:153], v[124:125], v[122:123], v[150:153]
    v_cvt_pk_bf16_f32 v171, v172, v173
    v_exp_f32 v186, v186
    v_mfma_f32_16x16x16_f16 v[190:193], v[176:177], v[122:123], v[190:193]
    v_exp_f32 v187, v187
    v_exp_f32 v188, v188
    v_mfma_f32_16x16x32_bf16 v[178:181], a[216:219], v[182:185], 0
    s_cmp_ge_u32 s80, 72
    v_exp_f32 v130, v130
    v_mfma_f32_16x16x32_bf16 v[178:181], a[220:223], v[226:229], v[178:181]
    s_cselect_b32 s80, s22, 0
    v_exp_f32 v131, v131
    v_mfma_f32_16x16x32_bf16 v[178:181], a[224:227], v[234:237], v[178:181]
    s_add_u32 s78, s78, s80
    v_cvt_pk_bf16_f32 v194, v130, v131
    v_cvt_pk_bf16_f32 v172, v186, v187
    v_mfma_f32_16x16x32_bf16 v[178:181], a[228:231], v[238:241], v[178:181]
    s_add_u32 s80, s77, 20
    v_exp_f32 v132, v132
    v_mfma_f32_16x16x32_bf16 v[178:181], a[232:235], v[242:245], v[178:181]
    s_add_u32 s34, s18, 3
    v_exp_f32 v133, v133
    v_mfma_f32_16x16x32_bf16 v[178:181], a[236:239], v[246:249], v[178:181]
    s_cmp_lt_u32 s77, s62
    v_cvt_pk_bf16_f32 v195, v132, v133
    v_mul_f32 v117, v255, v117
    v_mfma_f32_16x16x32_bf16 v[198:201], a[240:243], v[182:185], 0
    s_cselect_b32 s79, 1, 0
    v_exp_f32 v150, v150
    v_mfma_f32_16x16x32_f16 v[202:205], v[146:149], v[154:157], v[70:73]
    s_cselect_b32 s78, s78, 0
    v_exp_f32 v151, v151
    v_mfma_f32_16x16x32_f16 v[146:149], v[166:169], v[154:157], v[74:77]
    s_cmp_lt_u32 s34, s17
    v_cvt_pk_bf16_f32 v196, v150, v151
    v_cvt_pk_bf16_f32 v119, v116, v117
    v_mfma_f32_16x16x32_f16 v[166:169], v[158:161], v[154:157], v[78:81]
    buffer_store_dwordx2 v[118:119], v19, s[12:15], 0 offen nt
    v_exp_f32 v152, v152
    v_mfma_f32_16x16x16_f16 v[202:205], v[120:121], v[174:175], v[202:205]
    v_exp_f32 v153, v153
    v_fma_f32 v254, v178, v178, s33
    v_mfma_f32_16x16x16_f16 v[146:149], v[124:125], v[174:175], v[146:149]
    v_cvt_pk_bf16_f32 v197, v152, v153
    v_exp_f32 v190, v190
    v_mfma_f32_16x16x16_f16 v[166:169], v[176:177], v[174:175], v[166:169]
    v_exp_f32 v191, v191
    v_exp_f32 v192, v192
    v_mfma_f32_16x16x32_bf16 v[198:201], a[244:247], v[226:229], v[198:201]
    s_cselect_b32 s23, s23, s78
    v_exp_f32 v193, v193
    v_mfma_f32_16x16x32_bf16 v[198:201], a[248:251], v[234:237], v[198:201]
    s_cselect_b32 s73, s34, s80
    ds_read_b128 v[118:121], v2 offset:6144
    v_fmac_f32 v254, v179, v179
    v_mfma_f32_16x16x32_bf16 v[198:201], a[252:255], v[238:241], v[198:201]
    s_cselect_b32 s79, 0, s79
    ds_read_b128 v[122:125], v2 offset:7168
    v_fmac_f32 v254, v180, v180
    v_mfma_f32_16x16x32_bf16 v[198:201], v[82:85], v[242:245], v[198:201]
    s_cselect_b32 s81, 0, 1
    ds_read_b128 v[150:153], v2 offset:8192
    v_fmac_f32 v254, v181, v181
    v_mfma_f32_16x16x32_bf16 v[198:201], v[86:89], v[246:249], v[198:201]
    s_add_u32 s80, s77, 1
    ds_read_b128 v[154:157], v2 offset:9216
    v_xor_b32 v0, 65536, v0
    v_mfma_f32_16x16x32_bf16 v[206:209], v[90:93], v[182:185], 0
    s_mul_i32 s80, s80, s81
    ds_read_b128 v[158:161], v2 offset:10240
    v_xor_b32 v1, 65536, v1
    v_mfma_f32_16x16x32_bf16 v[206:209], v[94:97], v[226:229], v[206:209]
    s_cmp_lt_u32 s80, s62
    ds_read_b128 v[174:177], v2 offset:11264
    v_fmac_f32 v254, v198, v198
    v_mfma_f32_16x16x32_bf16 v[206:209], v[98:101], v[234:237], v[206:209]
    s_cselect_b32 s62, s62, 0
    v_exp_f32 v189, v189
    v_mfma_f32_16x16x32_bf16 v[206:209], v[102:105], v[238:241], v[206:209]
    s_add_u32 s80, s18, 4
    v_cvt_pk_bf16_f32 v173, v188, v189
    v_fmac_f32 v254, v199, v199
    v_mfma_f32_16x16x32_bf16 v[206:209], v[106:109], v[242:245], v[206:209]
    s_waitcnt lgkmcnt(5)
    v_exp_f32 v126, v126
    v_mfma_f32_16x16x32_bf16 v[206:209], v[110:113], v[246:249], v[206:209]
    s_cmp_ge_u32 s80, s17
    v_exp_f32 v127, v127
    v_mfma_f32_16x16x32_bf16 v[130:133], a[216:219], v[118:121], 0
    s_waitcnt lgkmcnt(3)
    v_cvt_pk_bf16_f32 v36, v126, v127
    v_fmac_f32 v254, v200, v200
    v_mfma_f32_16x16x32_bf16 v[130:133], a[220:223], v[122:125], v[130:133]
    s_cselect_b32 s66, s62, 0
    v_exp_f32 v128, v128
    v_mfma_f32_16x16x32_bf16 v[130:133], a[224:227], v[150:153], v[130:133]
    s_waitcnt lgkmcnt(1)
    v_fmac_f32 v254, v201, v201
    v_mfma_f32_16x16x32_bf16 v[130:133], a[228:231], v[154:157], v[130:133]
    s_lshl_b32 s80, s79, s73
    v_exp_f32 v129, v129
    v_mfma_f32_16x16x32_bf16 v[130:133], a[232:235], v[158:161], v[130:133]
    s_waitcnt lgkmcnt(0)
    v_cvt_pk_bf16_f32 v37, v128, v129
    v_fmac_f32 v254, v206, v206
    v_mfma_f32_16x16x32_bf16 v[130:133], a[236:239], v[174:177], v[130:133]
    s_or_b32 s70, s70, s80
    v_exp_f32 v202, v202
    v_mfma_f32_16x16x32_bf16 v[182:185], v[28:31], v[36:39], 0
    s_add_u32 s45, s45, s79
    v_exp_f32 v203, v203
    v_mfma_f32_16x16x32_bf16 v[182:185], v[28:31], v[170:173], v[182:185]
    s_add_u32 s18, s18, 1
    v_cvt_pk_bf16_f32 v186, v202, v203
    v_fma_f32 v255, v130, v130, s33
    v_mfma_f32_16x16x32_bf16 v[214:217], v[162:165], v[36:39], 0
    s_cmp_lt_u32 s18, s45
    v_fmac_f32 v255, v131, v131
    v_fmac_f32 v255, v132, v132
    v_mfma_f32_16x16x32_bf16 v[214:217], v[134:137], v[170:173], v[214:217]
    v_fmac_f32 v255, v133, v133
    v_fmac_f32 v254, v207, v207
    v_mfma_f32_16x16x32_bf16 v[222:225], v[210:213], v[36:39], 0
    v_exp_f32 v204, v204
    v_mfma_f32_16x16x32_bf16 v[222:225], v[138:141], v[170:173], v[222:225]
    v_exp_f32 v205, v205
    v_mfma_f32_16x16x32_bf16 v[226:229], v[218:221], v[36:39], 0
    v_cvt_pk_bf16_f32 v36, v190, v191
    v_cvt_pk_bf16_f32 v37, v192, v193
    v_mfma_f32_16x16x32_bf16 v[226:229], v[142:145], v[170:173], v[226:229]
    v_cvt_pk_bf16_f32 v39, v232, 0
    v_cvt_pk_bf16_f32 v187, v204, v205
    v_mfma_f32_16x16x32_bf16 v[126:129], a[240:243], v[118:121], 0
    v_exp_f32 v146, v146
    v_mfma_f32_16x16x32_bf16 v[170:173], v[28:31], v[36:39], 0
    v_exp_f32 v147, v147
    v_mfma_f32_16x16x32_bf16 v[170:173], v[28:31], v[194:197], v[170:173]
    v_cvt_pk_bf16_f32 v188, v146, v147
    v_fmac_f32 v254, v208, v208
    v_mfma_f32_16x16x32_bf16 v[114:117], v[162:165], v[36:39], 0
    v_exp_f32 v148, v148
    v_mfma_f32_16x16x32_bf16 v[114:117], v[134:137], v[194:197], v[114:117]
    v_exp_f32 v149, v149
    v_mfma_f32_16x16x32_bf16 v[190:193], v[210:213], v[36:39], 0
    v_cvt_pk_bf16_f32 v189, v148, v149
    v_fmac_f32 v254, v209, v209
    v_mfma_f32_16x16x32_bf16 v[190:193], v[138:141], v[194:197], v[190:193]
    v_rcp_f32 v170, v170
    v_mfma_f32_16x16x32_bf16 v[146:149], v[218:221], v[36:39], 0
    v_exp_f32 v166, v166
    v_mfma_f32_16x16x32_bf16 v[146:149], v[142:145], v[194:197], v[146:149]
    v_mul_f32 v114, v170, v114
    v_mul_f32 v115, v170, v115
    v_mfma_f32_16x16x32_bf16 v[126:129], a[244:247], v[122:125], v[126:129]
    v_cvt_pk_bf16_f32 v194, v114, v115
    v_mul_f32 v116, v170, v116
    v_mfma_f32_16x16x32_bf16 v[126:129], a[248:251], v[150:153], v[126:129]
    ds_read_b128 v[202:205], v2 offset:12288
    v_mul_f32 v117, v170, v117
    v_mfma_f32_16x16x32_bf16 v[126:129], a[252:255], v[154:157], v[126:129]
    ds_read_b128 v[230:233], v2 offset:13312
    v_cvt_pk_bf16_f32 v195, v116, v117
    v_mfma_f32_16x16x32_bf16 v[126:129], v[82:85], v[158:161], v[126:129]
    ds_read_b128 v[234:237], v2 offset:14336
    v_mul_f32 v190, v170, v190
    v_mfma_f32_16x16x32_bf16 v[126:129], v[86:89], v[174:177], v[126:129]
    ds_read_b128 v[238:241], v2 offset:15360
    v_mul_f32 v191, v170, v191
    v_mfma_f32_16x16x32_bf16 v[114:117], v[90:93], v[118:121], 0
    ds_read_b128 v[118:121], v2 offset:16384
    v_cvt_pk_bf16_f32 v196, v190, v191
    v_mfma_f32_16x16x32_bf16 v[114:117], v[94:97], v[122:125], v[114:117]
    ds_read_b128 v[122:125], v2 offset:17408
    v_mul_f32 v192, v170, v192
    v_mfma_f32_16x16x32_bf16 v[114:117], v[98:101], v[150:153], v[114:117]
    v_fmac_f32 v255, v126, v126
    v_fmac_f32 v255, v127, v127
    v_mfma_f32_16x16x32_bf16 v[114:117], v[102:105], v[154:157], v[114:117]
    v_fmac_f32 v255, v128, v128
    v_fmac_f32 v255, v129, v129
    v_mfma_f32_16x16x32_bf16 v[114:117], v[106:109], v[158:161], v[114:117]
    s_waitcnt lgkmcnt(5)
    v_mul_f32 v193, v170, v193
    v_cvt_pk_bf16_f32 v197, v192, v193
    v_mfma_f32_16x16x32_bf16 v[114:117], v[110:113], v[174:177], v[114:117]
    s_waitcnt lgkmcnt(4)
    ds_write_b128 v3, v[194:197] offset:6144
    v_mfma_f32_16x16x32_bf16 v[242:245], a[216:219], v[202:205], 0
    s_waitcnt lgkmcnt(3)
    v_mul_f32 v146, v170, v146
    v_mul_f32 v147, v170, v147
    v_mfma_f32_16x16x32_bf16 v[242:245], a[220:223], v[230:233], v[242:245]
    s_waitcnt lgkmcnt(2)
    v_fmac_f32 v255, v114, v114
    v_fmac_f32 v255, v115, v115
    v_mfma_f32_16x16x32_bf16 v[242:245], a[224:227], v[234:237], v[242:245]
    s_waitcnt lgkmcnt(1)
    v_fmac_f32 v255, v116, v116
    v_fmac_f32 v255, v117, v117
    v_mfma_f32_16x16x32_bf16 v[242:245], a[228:231], v[238:241], v[242:245]
    v_cvt_pk_bf16_f32 v254, v254, v255
    v_cvt_pk_bf16_f32 v172, v146, v147
    v_mfma_f32_16x16x32_bf16 v[242:245], a[232:235], v[118:121], v[242:245]
    v_mul_f32 v148, v170, v148
    v_mul_f32 v149, v170, v149
    v_mfma_f32_16x16x32_bf16 v[242:245], a[236:239], v[122:125], v[242:245]
    v_cvt_pk_bf16_f32 v173, v148, v149
    v_cvt_pk_bf16_f32 v39, v252, 0
    v_mfma_f32_16x16x32_bf16 v[158:161], a[240:243], v[202:205], 0
    ds_write_b64 v4, v[172:173] offset:10240
    v_mfma_f32_16x16x32_bf16 v[158:161], a[244:247], v[230:233], v[158:161]
    v_exp_f32 v167, v167
    v_mfma_f32_16x16x32_bf16 v[158:161], a[248:251], v[234:237], v[158:161]
    v_cvt_pk_bf16_f32 v36, v166, v167
    v_fma_f32 v255, v242, v242, s33
    v_mfma_f32_16x16x32_bf16 v[158:161], a[252:255], v[238:241], v[158:161]
    v_fmac_f32 v255, v243, v243
    v_fmac_f32 v255, v244, v244
    v_mfma_f32_16x16x32_bf16 v[158:161], v[82:85], v[118:121], v[158:161]
    v_fmac_f32 v255, v245, v245
    v_xor_b32 v2, 65536, v2
    v_mfma_f32_16x16x32_bf16 v[158:161], v[86:89], v[122:125], v[158:161]
    v_exp_f32 v168, v168
    v_mfma_f32_16x16x32_bf16 v[154:157], v[90:93], v[202:205], 0
    v_exp_f32 v169, v169
    v_mfma_f32_16x16x32_bf16 v[154:157], v[94:97], v[230:233], v[154:157]
    ds_read_b128 v[146:149], v9
    v_cvt_pk_bf16_f32 v37, v168, v169
    v_mfma_f32_16x16x32_bf16 v[154:157], v[98:101], v[234:237], v[154:157]
    ds_read_b128 v[150:153], v9 offset:64
    v_fmac_f32 v255, v158, v158
    v_mfma_f32_16x16x32_bf16 v[166:169], v[28:31], v[36:39], 0
    v_fmac_f32 v255, v159, v159
    v_fmac_f32 v255, v160, v160
    v_mfma_f32_16x16x32_bf16 v[166:169], v[28:31], v[186:189], v[166:169]
    v_fmac_f32 v255, v161, v161
    v_add_u32 v6, s75, v6
    v_mfma_f32_16x16x32_bf16 v[174:177], v[162:165], v[36:39], 0
    v_rcp_f32 v182, v182
    v_mfma_f32_16x16x32_bf16 v[174:177], v[134:137], v[186:189], v[174:177]
    v_max3_u32 v25, v25, v182, v183
    v_max3_u32 v25, v25, v170, v171
    v_mfma_f32_16x16x32_bf16 v[170:173], v[210:213], v[36:39], 0
    v_rcp_f32 v166, v166
    v_mfma_f32_16x16x32_bf16 v[170:173], v[138:141], v[186:189], v[170:173]
    v_max3_u32 v25, v25, v166, v167
    v_mul_f32 v214, v182, v214
    v_mfma_f32_16x16x32_bf16 v[190:193], v[218:221], v[36:39], 0
    s_waitcnt lgkmcnt(1)
    v_mul_f32 v174, v166, v174
    v_mul_f32 v175, v166, v175
    v_mfma_f32_16x16x32_bf16 v[190:193], v[142:145], v[186:189], v[190:193]
    s_waitcnt lgkmcnt(0)
    v_cvt_pk_bf16_f32 v174, v174, v175
    v_mul_f32 v176, v166, v176
    v_mfma_f32_16x16x32_bf16 v[154:157], v[102:105], v[238:241], v[154:157]
    ds_read_b128 v[186:189], v0 offset:20480
    v_mul_f32 v177, v166, v177
    v_mfma_f32_16x16x32_bf16 v[154:157], v[106:109], v[118:121], v[154:157]
    ds_read_b128 v[194:197], v1 offset:20480
    v_cvt_pk_bf16_f32 v175, v176, v177
    v_mfma_f32_16x16x32_bf16 v[154:157], v[110:113], v[122:125], v[154:157]
    ds_read_b128 v[122:125], v0 offset:20608
    v_mul_f32 v170, v166, v170
    v_mfma_f32_16x16x32_bf16 v[118:121], v[146:149], v[28:31], 0
    ds_read_b128 v[202:205], v1 offset:20608
    v_mul_f32 v171, v166, v171
    v_mfma_f32_16x16x32_bf16 v[118:121], v[150:153], v[28:31], v[118:121]
    ds_read_b128 v[230:233], v0 offset:20736
    v_cvt_pk_bf16_f32 v176, v170, v171
    v_mfma_f32_16x16x32_bf16 v[234:237], v[146:149], v[134:137], 0
    ds_read_b128 v[238:241], v1 offset:20736
    v_fmac_f32 v255, v154, v154
    v_mfma_f32_16x16x32_bf16 v[234:237], v[150:153], v[162:165], v[234:237]
    v_fmac_f32 v255, v155, v155
    v_fmac_f32 v255, v156, v156
    v_mfma_f32_16x16x32_bf16 v[134:137], v[146:149], v[138:141], 0
    v_fmac_f32 v255, v157, v157
    v_cvt_pk_bf16_f32 v255, v255, v255
    v_mfma_f32_16x16x32_bf16 v[134:137], v[150:153], v[210:213], v[134:137]
    s_waitcnt lgkmcnt(5)
    ds_write_b64 v4, v[254:255] offset:18432
    v_mfma_f32_16x16x32_bf16 v[138:141], v[146:149], v[142:145], 0
    s_waitcnt lgkmcnt(4)
    v_mul_f32 v172, v166, v172
    v_mul_f32 v173, v166, v173
    v_mfma_f32_16x16x32_bf16 v[138:141], v[150:153], v[218:221], v[138:141]
    s_waitcnt lgkmcnt(3)
    v_cvt_pk_bf16_f32 v177, v172, v173
    v_mul_f32 v190, v166, v190
    v_mfma_f32_16x16x32_bf16 v[142:145], a[72:75], v[186:189], 0
    s_waitcnt lgkmcnt(2)
    ds_write_b128 v3, v[174:177] offset:12288
    v_mfma_f32_16x16x32_bf16 v[142:145], a[76:79], v[194:197], v[142:145]
    s_waitcnt lgkmcnt(2)
    v_mul_f32 v191, v166, v191
    v_cvt_pk_bf16_f32 v120, v190, v191
    v_mfma_f32_16x16x32_bf16 v[142:145], a[80:83], v[122:125], v[142:145]
    v_mul_f32 v192, v166, v192
    v_mul_f32 v193, v166, v193
    v_mfma_f32_16x16x32_bf16 v[142:145], a[84:87], v[202:205], v[142:145]
    v_cvt_pk_bf16_f32 v121, v192, v193
    v_mul_f32 v215, v182, v215
    v_mfma_f32_16x16x32_bf16 v[142:145], a[88:91], v[230:233], v[142:145]
    ds_write_b64 v4, v[120:121] offset:16384
    v_mfma_f32_16x16x32_bf16 v[142:145], a[92:95], v[238:241], v[142:145]
    v_rcp_f32 v118, v118
    v_mfma_f32_16x16x32_bf16 v[150:153], a[96:99], v[186:189], 0
    v_max3_u32 v25, v25, v118, v119
    v_mul_f32 v234, v234, v118
    v_mfma_f32_16x16x32_bf16 v[150:153], a[100:103], v[194:197], v[150:153]
    v_cvt_pk_bf16_f32 v146, v214, v215
    v_mul_f32_dpp v234, v134, v118 quad_perm:[0,1,2,3] row_mask:0x2 bank_mask:0xf
    v_mfma_f32_16x16x32_bf16 v[150:153], a[104:107], v[122:125], v[150:153]
    v_mul_f32 v216, v182, v216
    v_mul_f32_dpp v234, v138, v118 quad_perm:[0,1,2,3] row_mask:0x4 bank_mask:0xf
    v_mfma_f32_16x16x32_bf16 v[150:153], a[108:111], v[202:205], v[150:153]
    v_cvt_pk_bf16_f32 v234, v234, v234
    v_mul_f32 v217, v182, v217
    v_mfma_f32_16x16x32_bf16 v[150:153], a[112:115], v[230:233], v[150:153]
    ds_write_b16 v7, v234
    v_mfma_f32_16x16x32_bf16 v[150:153], a[116:119], v[238:241], v[150:153]
    v_cvt_pk_bf16_f32 v147, v216, v217
    v_mul_f32 v222, v182, v222
    v_mfma_f32_16x16x32_bf16 v[134:137], a[120:123], v[186:189], 0
    v_mul_f32 v223, v182, v223
    v_cvt_pk_bf16_f32 v148, v222, v223
    v_mfma_f32_16x16x32_bf16 v[134:137], a[124:127], v[194:197], v[134:137]
    v_mul_f32 v224, v182, v224
    v_mul_f32 v225, v182, v225
    v_mfma_f32_16x16x32_bf16 v[134:137], a[128:131], v[122:125], v[134:137]
    v_cvt_pk_bf16_f32 v149, v224, v225
    v_mul_f32 v226, v182, v226
    v_mfma_f32_16x16x32_bf16 v[134:137], a[132:135], v[202:205], v[134:137]
    ds_write_b128 v3, v[146:149] offset:0
    v_mfma_f32_16x16x32_bf16 v[134:137], a[136:139], v[230:233], v[134:137]
    v_mul_f32 v227, v182, v227
    v_cvt_pk_bf16_f32 v254, v226, v227
    v_mfma_f32_16x16x32_bf16 v[134:137], a[140:143], v[238:241], v[134:137]
    v_mul_f32 v228, v182, v228
    v_mul_f32 v229, v182, v229
    v_mfma_f32_16x16x32_bf16 v[138:141], a[0:3], v[186:189], 0
    v_cvt_pk_bf16_f32 v255, v228, v229
    v_xor_b32 v3, 65536, v3
    v_mfma_f32_16x16x32_bf16 v[138:141], a[4:7], v[194:197], v[138:141]
    ds_write_b64 v4, v[254:255] offset:4096
    v_mfma_f32_16x16x32_bf16 v[138:141], a[8:11], v[122:125], v[138:141]
    v_xor_b32 v4, 65536, v4
    v_add_u32 v7, s76, v7
    v_mfma_f32_16x16x32_bf16 v[138:141], a[12:15], v[202:205], v[138:141]
    v_cvt_pk_f16_f32 v146, v142, v143
    v_pk_mul_f16 v143, v146, v146
    v_mfma_f32_16x16x32_bf16 v[138:141], a[16:19], v[230:233], v[138:141]
    v_cvt_pk_f16_f32 v147, v144, v145
    v_pk_fma_f16 v143, v147, v147, v143
    v_mfma_f32_16x16x32_bf16 v[138:141], a[20:23], v[238:241], v[138:141]
    v_cvt_pk_f16_f32 v148, v150, v151
    v_pk_fma_f16 v143, v148, v148, v143
    v_mfma_f32_16x16x32_bf16 v[166:169], a[24:27], v[186:189], 0
    v_cvt_pk_f16_f32 v149, v152, v153
    v_pk_fma_f16 v143, v149, v149, v143
    v_mfma_f32_16x16x32_bf16 v[166:169], a[28:31], v[194:197], v[166:169]
    v_cvt_pk_f16_f32 v120, v134, v135
    v_pk_fma_f16 v143, v120, v120, v143
    v_mfma_f32_16x16x32_bf16 v[166:169], a[32:35], v[122:125], v[166:169]
    s_waitcnt lgkmcnt(0)
    v_cvt_pk_f16_f32 v121, v136, v137
    v_pk_fma_f16 v143, v121, v121, v143
    v_mfma_f32_16x16x32_bf16 v[166:169], a[36:39], v[202:205], v[166:169]
    s_nop 0
    v_mfma_f32_16x16x32_bf16 v[166:169], a[40:43], v[230:233], v[166:169]
    s_barrier
    v_mfma_f32_16x16x32_bf16 v[166:169], a[44:47], v[238:241], v[166:169]
    s_nop 0
    v_mfma_f32_16x16x32_bf16 v[134:137], a[48:51], v[186:189], 0
    s_nop 0
    v_mfma_f32_16x16x32_bf16 v[134:137], a[52:55], v[194:197], v[134:137]
    s_cbranch_scc1 L_loop_fast1
    s_branch L_final_fast
.p2align 6
L_loop_fast2:
    v_mfma_f32_16x16x32_bf16 v[134:137], a[56:59], v[122:125], v[134:137]
    s_add_u32 s12, s40, s27
    ds_read_b128 v[190:193], v2 offset:18432
    v_cvt_pk_f16_f32 v150, v138, v139
    v_mfma_f32_16x16x32_bf16 v[134:137], a[60:63], v[202:205], v[134:137]
    s_addc_u32 s13, s41, 0
    ds_read_b128 v[210:213], v2 offset:19456
    v_pk_mul_f16 v142, v150, v150
    v_mfma_f32_16x16x32_bf16 v[134:137], a[64:67], v[230:233], v[134:137]
    s_sub_u32 s14, s36, s27
    ds_read_b128 v[174:177], v5 offset:32
    v_cvt_pk_f16_f32 v151, v140, v141
    v_mfma_f32_16x16x32_bf16 v[134:137], a[68:71], v[238:241], v[134:137]
    s_cmp_ge_u32 s18, 2
    ds_read2_b64 v[162:165], v5 offset0:6 offset1:9
    v_pk_fma_f16 v142, v151, v151, v142
    v_mfma_f32_16x16x32_bf16 v[138:141], v[186:189], a[144:147], 0
    s_cselect_b32 s14, s14, 0
    ds_read_b128 v[170:173], v5
    v_cvt_pk_f16_f32 v152, v166, v167
    v_mfma_f32_16x16x32_bf16 v[138:141], v[194:197], a[148:151], v[138:141]
    s_sub_u32 s82, s72, s71
    ds_read_b32 v254, v6 offset:192
    v_pk_fma_f16 v142, v152, v152, v142
    v_mfma_f32_16x16x32_bf16 v[138:141], v[122:125], a[152:155], v[138:141]
    s_mul_i32 s74, s82, 336
    v_cvt_pk_f16_f32 v153, v168, v169
    v_pk_fma_f16 v142, v153, v153, v142
    v_mfma_f32_16x16x32_bf16 v[138:141], v[202:205], a[156:159], v[138:141]
    s_mul_i32 s75, s82, 272
    v_cvt_pk_f16_f32 v118, v134, v135
    v_pk_fma_f16 v142, v118, v118, v142
    v_mfma_f32_16x16x32_bf16 v[138:141], v[230:233], a[160:163], v[138:141]
    s_waitcnt lgkmcnt(5)
    ds_read_b128 v[182:185], v0 offset:26624
    v_cvt_pk_f16_f32 v119, v136, v137
    v_mfma_f32_16x16x32_bf16 v[166:169], v[32:35], v[190:193], 0
    s_waitcnt lgkmcnt(5)
    v_pk_fma_f16 v142, v119, v119, v142
    v_add_u32 v5, s74, v5
    v_mfma_f32_16x16x32_bf16 v[166:169], v[32:35], v[210:213], v[166:169]
    s_waitcnt lgkmcnt(4)
    v_pk_mul_f16 v145, v146, v174
    v_pk_fma_f16 v145, v147, v175, v145
    v_mfma_f32_16x16x32_bf16 v[138:141], v[238:241], a[164:167], v[138:141]
    s_mul_i32 s76, s82, 16
    ds_read_b128 v[210:213], v1 offset:26624
    v_pk_fma_f16 v145, v148, v176, v145
    v_mfma_f32_16x16x32_bf16 v[214:217], v[186:189], a[168:171], 0
    s_waitcnt lgkmcnt(3)
    ds_read_b128 v[218:221], v0 offset:26752
    v_pk_fma_f16 v145, v149, v177, v145
    v_mfma_f32_16x16x32_bf16 v[214:217], v[194:197], a[172:175], v[214:217]
    s_waitcnt lgkmcnt(3)
    ds_read_b128 v[222:225], v1 offset:26752
    v_mov_b32_dpp v254, v23 quad_perm:[0,1,2,3] row_mask:0x7 bank_mask:0xf
    v_mfma_f32_16x16x32_bf16 v[214:217], v[122:125], a[176:179], v[214:217]
    s_add_u32 s34, s18, 2
    ds_read_b128 v[226:229], v0 offset:26880
    v_pk_fma_f16 v145, v120, v164, v145
    v_mfma_f32_16x16x32_bf16 v[214:217], v[202:205], a[180:183], v[214:217]
    s_add_u32 s8, s60, s23
    ds_read_b128 v[190:193], v1 offset:26880
    v_pk_fma_f16 v145, v121, v165, v145
    v_mfma_f32_16x16x32_bf16 v[214:217], v[230:233], a[184:187], v[214:217]
    s_waitcnt lgkmcnt(5)
    v_pk_mul_f16 v144, v150, v170
    v_pk_fma_f16 v144, v151, v171, v144
    v_mfma_f32_16x16x32_bf16 v[214:217], v[238:241], a[188:191], v[214:217]
    s_addc_u32 s9, s61, 0
    v_pk_fma_f16 v144, v152, v172, v144
    v_pk_fma_f16 v144, v153, v173, v144
    v_mfma_f32_16x16x32_bf16 v[246:249], v[186:189], a[192:195], 0
    s_sub_u32 s10, s36, s23
    v_pk_fma_f16 v144, v118, v162, v144
    v_pk_fma_f16 v144, v119, v163, v144
    v_mfma_f32_16x16x32_bf16 v[246:249], v[194:197], a[196:199], v[246:249]
    s_cmp_le_u32 s34, s45
    v_cvt_pk_bf16_f32 v134, v138, v139
    v_cvt_pk_bf16_f32 v135, v140, v141
    v_mfma_f32_16x16x32_f16 v[234:237], v[40:43], v[142:145], 0
    s_cselect_b32 s10, s10, 0
    v_cvt_pk_bf16_f32 v138, v214, v215
    v_cvt_pk_bf16_f32 v139, v216, v217
    v_mfma_f32_16x16x32_bf16 v[246:249], v[122:125], a[200:203], v[246:249]
    s_add_u32 m0, s28, 0
    v_mul_f32 v136, 0x3baaaaab, v166
    v_mul_f32 v255, 0x3baaaaab, v167
    v_mfma_f32_16x16x32_bf16 v[246:249], v[202:205], a[204:207], v[246:249]
    s_mov_b32 s27, s26
    v_rsq_f32 v234, v234
    v_mfma_f32_16x16x32_bf16 v[246:249], v[230:233], a[208:211], v[246:249]
    s_mov_b32 s26, s25
    v_rsq_f32 v235, v235
    v_mfma_f32_16x16x32_bf16 v[246:249], v[238:241], a[212:215], v[246:249]
    s_mov_b32 s25, s24
    v_mul_f32 v140, s31, v234
    v_cvt_pk_f16_f32 v141, v140, v235
    v_mfma_f32_16x16x32_bf16 v[122:125], a[72:75], v[182:185], 0
    s_waitcnt lgkmcnt(0)
    v_fma_f32 v236, v236, v140, v22
    v_fmac_f32_dpp v254, v237, v235 quad_perm:[0,1,2,3] row_mask:0x1 bank_mask:0xf
    v_mfma_f32_16x16x32_bf16 v[122:125], a[76:79], v[210:213], v[122:125]
    s_mov_b32 s24, s23
    v_cvt_pk_bf16_f32 v142, v246, v247
    v_cvt_pk_bf16_f32 v143, v248, v249
    v_mfma_f32_16x16x32_bf16 v[122:125], a[80:83], v[218:221], v[122:125]
    s_mov_b32 s71, s72
    v_pk_mul_f16 v146, v146, v141 op_sel:[0,1] op_sel_hi:[1,1]
    v_pk_mul_f16 v147, v147, v141 op_sel:[0,1] op_sel_hi:[1,1]
    v_mfma_f32_16x16x32_bf16 v[122:125], a[84:87], v[222:225], v[122:125]
    s_mov_b32 s72, s73
    v_pk_mul_f16 v148, v148, v141 op_sel:[0,1] op_sel_hi:[1,1]
    v_pk_mul_f16 v149, v149, v141 op_sel:[0,1] op_sel_hi:[1,1]
    v_mfma_f32_16x16x32_bf16 v[122:125], a[88:91], v[226:229], v[122:125]
    v_pk_mul_f16 v120, v120, v141 op_sel:[0,1] op_sel_hi:[1,1]
    v_pk_mul_f16 v121, v121, v141 op_sel:[0,1] op_sel_hi:[1,1]
    v_mfma_f32_16x16x32_bf16 v[122:125], a[92:95], v[190:193], v[122:125]
    v_pk_mul_f16 v150, v150, v141 op_sel:[0,0] op_sel_hi:[1,0]
    v_pk_mul_f16 v151, v151, v141 op_sel:[0,0] op_sel_hi:[1,0]
    v_mfma_f32_16x16x32_bf16 v[186:189], a[96:99], v[182:185], 0
    v_pk_mul_f16 v152, v152, v141 op_sel:[0,0] op_sel_hi:[1,0]
    v_pk_mul_f16 v153, v153, v141 op_sel:[0,0] op_sel_hi:[1,0]
    v_mfma_f32_16x16x32_bf16 v[186:189], a[100:103], v[210:213], v[186:189]
    v_pk_mul_f16 v118, v118, v141 op_sel:[0,0] op_sel_hi:[1,0]
    v_pk_mul_f16 v119, v119, v141 op_sel:[0,0] op_sel_hi:[1,0]
    v_mfma_f32_16x16x32_bf16 v[186:189], a[104:107], v[218:221], v[186:189]
    v_max3_u32 v44, v44, v234, v235
    v_mul_f32 v144, 0x3baaaaab, v168
    v_mfma_f32_16x16x32_bf16 v[186:189], a[108:111], v[222:225], v[186:189]
    v_rsq_f32 v136, v136
    v_mfma_f32_16x16x32_bf16 v[186:189], a[112:115], v[226:229], v[186:189]
    v_rsq_f32 v255, v255
    v_mfma_f32_16x16x32_bf16 v[186:189], a[116:119], v[190:193], v[186:189]
    v_rsq_f32 v144, v144
    v_mfma_f32_16x16x32_bf16 v[194:197], a[120:123], v[182:185], 0
    v_mul_f32 v178, v136, v178
    v_mul_f32 v179, v136, v179
    v_mfma_f32_16x16x32_bf16 v[194:197], a[124:127], v[210:213], v[194:197]
    v_cvt_pk_bf16_f32 v166, v178, v179
    v_mul_f32 v180, v136, v180
    v_mfma_f32_16x16x32_bf16 v[194:197], a[128:131], v[218:221], v[194:197]
    v_mul_f32 v181, v136, v181
    v_cvt_pk_bf16_f32 v167, v180, v181
    v_mfma_f32_16x16x32_bf16 v[194:197], a[132:135], v[222:225], v[194:197]
    v_mul_f32 v198, v136, v198
    v_mul_f32 v199, v136, v199
    v_mfma_f32_16x16x32_bf16 v[194:197], a[136:139], v[226:229], v[194:197]
    v_cvt_pk_bf16_f32 v168, v198, v199
    v_mul_f32 v200, v136, v200
    v_mfma_f32_16x16x32_bf16 v[194:197], a[140:143], v[190:193], v[194:197]
    v_mul_f32 v201, v136, v201
    v_cvt_pk_bf16_f32 v169, v200, v201
    v_mfma_f32_16x16x32_bf16 v[178:181], a[0:3], v[182:185], 0
    buffer_store_dwordx4 v[166:169], v15, s[12:15], 0 offen nt
    v_mul_f32 v206, v136, v206
    v_mul_f32 v207, v136, v207
    v_cvt_pk_bf16_f32 v140, v206, v207
    v_mul_f32 v208, v136, v208
    v_mfma_f32_16x16x32_bf16 v[178:181], a[4:7], v[210:213], v[178:181]
    v_mul_f32 v209, v136, v209
    v_cvt_pk_bf16_f32 v141, v208, v209
    v_mfma_f32_16x16x32_bf16 v[178:181], a[8:11], v[218:221], v[178:181]
    v_cvt_pk_f16_f32 v166, v122, v123
    v_pk_mul_f16 v199, v166, v166
    v_mfma_f32_16x16x32_bf16 v[178:181], a[12:15], v[222:225], v[178:181]
    v_cvt_pk_f16_f32 v167, v124, v125
    v_pk_fma_f16 v199, v167, v167, v199
    v_mfma_f32_16x16x32_bf16 v[178:181], a[16:19], v[226:229], v[178:181]
    v_cvt_pk_f16_f32 v168, v186, v187
    v_pk_fma_f16 v199, v168, v168, v199
    v_mfma_f32_16x16x32_bf16 v[178:181], a[20:23], v[190:193], v[178:181]
    v_cvt_pk_f16_f32 v169, v188, v189
    v_pk_fma_f16 v199, v169, v169, v199
    v_mfma_f32_16x16x32_bf16 v[186:189], a[24:27], v[182:185], 0
    v_cvt_pk_f16_f32 v124, v194, v195
    v_pk_fma_f16 v199, v124, v124, v199
    v_mfma_f32_16x16x32_bf16 v[186:189], a[28:31], v[210:213], v[186:189]
    v_cvt_pk_f16_f32 v125, v196, v197
    v_pk_fma_f16 v199, v125, v125, v199
    v_mfma_f32_16x16x32_bf16 v[186:189], a[32:35], v[218:221], v[186:189]
    v_cvt_pk_f16_f32 v178, v178, v179
    v_pk_mul_f16 v198, v178, v178
    v_mfma_f32_16x16x32_bf16 v[186:189], a[36:39], v[222:225], v[186:189]
    v_cvt_pk_f16_f32 v179, v180, v181
    v_pk_fma_f16 v198, v179, v179, v198
    v_mfma_f32_16x16x32_bf16 v[186:189], a[40:43], v[226:229], v[186:189]
    v_pk_mul_f16 v200, v178, v170
    v_pk_fma_f16 v200, v179, v171, v200
    v_mfma_f32_16x16x32_bf16 v[186:189], a[44:47], v[190:193], v[186:189]
    v_pk_mul_f16 v201, v166, v174
    v_pk_fma_f16 v201, v167, v175, v201
    v_mfma_f32_16x16x32_bf16 v[194:197], a[48:51], v[182:185], 0
    v_pk_fma_f16 v201, v168, v176, v201
    v_pk_fma_f16 v201, v169, v177, v201
    v_mfma_f32_16x16x32_bf16 v[194:197], a[52:55], v[210:213], v[194:197]
    v_pk_fma_f16 v201, v124, v164, v201
    v_pk_fma_f16 v201, v125, v165, v201
    v_mfma_f32_16x16x32_bf16 v[194:197], a[56:59], v[218:221], v[194:197]
    v_cvt_pk_f16_f32 v180, v186, v187
    v_pk_fma_f16 v198, v180, v180, v198
    v_mfma_f32_16x16x32_bf16 v[194:197], a[60:63], v[222:225], v[194:197]
    v_cvt_pk_f16_f32 v181, v188, v189
    v_pk_fma_f16 v198, v181, v181, v198
    v_mfma_f32_16x16x32_bf16 v[194:197], a[64:67], v[226:229], v[194:197]
    v_pk_fma_f16 v200, v180, v172, v200
    v_pk_fma_f16 v200, v181, v173, v200
    v_mfma_f32_16x16x32_bf16 v[194:197], a[68:71], v[190:193], v[194:197]
    buffer_store_dwordx2 v[140:141], v18, s[12:15], 0 offen nt
    v_mul_f32 v242, v144, v242
    v_mul_f32 v243, v144, v243
    v_mfma_f32_16x16x32_bf16 v[186:189], v[182:185], a[144:147], 0
    v_cvt_pk_bf16_f32 v238, v242, v243
    v_mul_f32 v244, v144, v244
    v_mfma_f32_16x16x32_bf16 v[186:189], v[210:213], a[148:151], v[186:189]
    v_mul_f32 v245, v144, v245
    v_cvt_pk_f16_f32 v122, v194, v195
    v_mfma_f32_16x16x32_bf16 v[186:189], v[218:221], a[152:155], v[186:189]
    v_pk_fma_f16 v198, v122, v122, v198
    v_cvt_pk_f16_f32 v123, v196, v197
    v_mfma_f32_16x16x32_bf16 v[186:189], v[222:225], a[156:159], v[186:189]
    v_pk_fma_f16 v198, v123, v123, v198
    v_pk_fma_f16 v200, v122, v162, v200
    v_mfma_f32_16x16x32_bf16 v[186:189], v[226:229], a[160:163], v[186:189]
    ds_read_b128 v[202:205], v0 offset:32768
    v_pk_fma_f16 v200, v123, v163, v200
    v_mfma_f32_16x16x32_bf16 v[186:189], v[190:193], a[164:167], v[186:189]
    ds_read_b128 v[194:197], v1 offset:32768
    v_cvt_pk_bf16_f32 v239, v244, v245
    v_mfma_f32_16x16x32_f16 v[230:233], v[40:43], v[198:201], 0
    v_mul_f32 v158, v144, v158
    v_mul_f32 v159, v144, v159
    v_mfma_f32_16x16x32_bf16 v[246:249], v[182:185], a[168:171], 0
    ds_read_b128 v[214:217], v0 offset:32896
    v_cvt_pk_bf16_f32 v240, v158, v159
    v_mfma_f32_16x16x32_bf16 v[246:249], v[210:213], a[172:175], v[246:249]
    ds_read_b128 v[206:209], v1 offset:32896
    v_cvt_pk_bf16_f32 v136, v186, v187
    v_mfma_f32_16x16x32_bf16 v[246:249], v[218:221], a[176:179], v[246:249]
    ds_read_b128 v[198:201], v0 offset:33024
    v_cvt_pk_bf16_f32 v137, v188, v189
    v_mfma_f32_16x16x32_bf16 v[246:249], v[222:225], a[180:183], v[246:249]
    ds_read_b128 v[186:189], v1 offset:33024
    v_mul_f32 v160, v144, v160
    v_mfma_f32_16x16x32_bf16 v[246:249], v[226:229], a[184:187], v[246:249]
    v_rsq_f32 v230, v230
    v_mfma_f32_16x16x32_bf16 v[246:249], v[190:193], a[188:191], v[246:249]
    s_waitcnt lgkmcnt(5)
    v_rsq_f32 v231, v231
    v_mfma_f32_16x16x32_bf16 v[242:245], v[182:185], a[192:195], 0
    s_waitcnt lgkmcnt(4)
    v_mul_f32 v234, s31, v230
    v_cvt_pk_f16_f32 v235, v234, v231
    v_mfma_f32_16x16x32_bf16 v[242:245], v[210:213], a[196:199], v[242:245]
    v_fma_f32 v232, v232, v234, v24
    v_fmac_f32_dpp v254, v233, v231 quad_perm:[0,1,2,3] row_mask:0x2 bank_mask:0xf
    v_mfma_f32_16x16x32_bf16 v[242:245], v[218:221], a[200:203], v[242:245]
    s_waitcnt lgkmcnt(3)
    v_cvt_pk_bf16_f32 v140, v246, v247
    v_cvt_pk_bf16_f32 v141, v248, v249
    v_mfma_f32_16x16x32_bf16 v[242:245], v[222:225], a[204:207], v[242:245]
    s_waitcnt lgkmcnt(2)
    v_mul_f32 v161, v144, v161
    v_cvt_pk_bf16_f32 v241, v160, v161
    v_mfma_f32_16x16x32_bf16 v[242:245], v[226:229], a[208:211], v[242:245]
    s_waitcnt lgkmcnt(1)
    buffer_store_dwordx4 v[238:241], v17, s[12:15], 0 offen nt
    v_mul_f32 v154, v144, v154
    v_mul_f32 v155, v144, v155
    v_cvt_pk_bf16_f32 v154, v154, v155
    v_mul_f32 v156, v144, v156
    v_mfma_f32_16x16x32_bf16 v[242:245], v[190:193], a[212:215], v[242:245]
    s_waitcnt lgkmcnt(0)
    v_mul_f32 v157, v144, v157
    v_cvt_pk_bf16_f32 v155, v156, v157
    v_mfma_f32_16x16x32_bf16 v[158:161], a[72:75], v[202:205], 0
    v_pk_mul_f16 v166, v166, v235 op_sel:[0,1] op_sel_hi:[1,1]
    v_pk_mul_f16 v167, v167, v235 op_sel:[0,1] op_sel_hi:[1,1]
    v_mfma_f32_16x16x32_bf16 v[158:161], a[76:79], v[194:197], v[158:161]
    v_pk_mul_f16 v168, v168, v235 op_sel:[0,1] op_sel_hi:[1,1]
    v_cvt_pk_bf16_f32 v144, v242, v243
    v_mfma_f32_16x16x32_bf16 v[158:161], a[80:83], v[214:217], v[158:161]
    v_cvt_pk_bf16_f32 v145, v244, v245
    v_pk_mul_f16 v169, v169, v235 op_sel:[0,1] op_sel_hi:[1,1]
    v_mfma_f32_16x16x32_bf16 v[158:161], a[84:87], v[206:209], v[158:161]
    v_pk_mul_f16 v124, v124, v235 op_sel:[0,1] op_sel_hi:[1,1]
    v_pk_mul_f16 v125, v125, v235 op_sel:[0,1] op_sel_hi:[1,1]
    v_mfma_f32_16x16x32_bf16 v[158:161], a[88:91], v[198:201], v[158:161]
    v_pk_mul_f16 v178, v178, v235 op_sel:[0,0] op_sel_hi:[1,0]
    v_pk_mul_f16 v179, v179, v235 op_sel:[0,0] op_sel_hi:[1,0]
    v_mfma_f32_16x16x32_bf16 v[158:161], a[92:95], v[186:189], v[158:161]
    v_pk_mul_f16 v180, v180, v235 op_sel:[0,0] op_sel_hi:[1,0]
    v_pk_mul_f16 v181, v181, v235 op_sel:[0,0] op_sel_hi:[1,0]
    v_mfma_f32_16x16x32_bf16 v[182:185], a[96:99], v[202:205], 0
    v_pk_mul_f16 v122, v122, v235 op_sel:[0,0] op_sel_hi:[1,0]
    v_pk_mul_f16 v123, v123, v235 op_sel:[0,0] op_sel_hi:[1,0]
    v_mfma_f32_16x16x32_bf16 v[182:185], a[100:103], v[194:197], v[182:185]
    v_max3_u32 v44, v44, v230, v231
    v_mul_f32 v130, v255, v130
    v_mfma_f32_16x16x32_bf16 v[182:185], a[104:107], v[214:217], v[182:185]
    v_cvt_pk_f16_f32 v158, v158, v159
    v_pk_mul_f16 v191, v158, v158
    v_mfma_f32_16x16x32_bf16 v[182:185], a[108:111], v[206:209], v[182:185]
    v_cvt_pk_f16_f32 v159, v160, v161
    v_pk_fma_f16 v191, v159, v159, v191
    v_mfma_f32_16x16x32_bf16 v[182:185], a[112:115], v[198:201], v[182:185]
    v_pk_mul_f16 v193, v158, v174
    v_pk_fma_f16 v193, v159, v175, v193
    v_mfma_f32_16x16x32_bf16 v[182:185], a[116:119], v[186:189], v[182:185]
    v_exp_f32 v232, v232
    v_mfma_f32_16x16x32_bf16 v[210:213], a[120:123], v[202:205], 0
    v_exp_f32 v236, v236
    v_mfma_f32_16x16x32_bf16 v[210:213], a[124:127], v[194:197], v[210:213]
    v_cvt_pk_bf16_f32 v39, v236, 0
    v_mul_f32 v131, v255, v131
    v_mfma_f32_16x16x32_bf16 v[210:213], a[128:131], v[214:217], v[210:213]
    s_waitcnt vmcnt(3)
    ds_write_b16 v8, v45 offset:512
    v_mfma_f32_16x16x32_bf16 v[210:213], a[132:135], v[206:209], v[210:213]
    buffer_store_dwordx2 v[154:155], v20, s[12:15], 0 offen nt
    v_cvt_pk_f16_f32 v160, v182, v183
    v_mfma_f32_16x16x32_bf16 v[210:213], a[136:139], v[198:201], v[210:213]
    v_pk_fma_f16 v191, v160, v160, v191
    v_cvt_pk_f16_f32 v161, v184, v185
    v_mfma_f32_16x16x32_bf16 v[210:213], a[140:143], v[186:189], v[210:213]
    v_pk_fma_f16 v191, v161, v161, v191
    v_pk_fma_f16 v193, v160, v176, v193
    v_mfma_f32_16x16x32_bf16 v[154:157], a[0:3], v[202:205], 0
    v_pk_fma_f16 v193, v161, v177, v193
    v_cvt_pk_bf16_f32 v130, v130, v131
    v_mfma_f32_16x16x32_bf16 v[154:157], a[4:7], v[194:197], v[154:157]
    v_mul_f32 v132, v255, v132
    v_mul_f32 v133, v255, v133
    v_mfma_f32_16x16x32_bf16 v[154:157], a[8:11], v[214:217], v[154:157]
    v_cvt_pk_f16_f32 v176, v210, v211
    v_pk_fma_f16 v191, v176, v176, v191
    v_mfma_f32_16x16x32_bf16 v[154:157], a[12:15], v[206:209], v[154:157]
    s_waitcnt lgkmcnt(0)
    v_cvt_pk_f16_f32 v177, v212, v213
    v_pk_fma_f16 v191, v177, v177, v191
    v_mfma_f32_16x16x32_bf16 v[154:157], a[16:19], v[198:201], v[154:157]
    v_pk_fma_f16 v193, v176, v164, v193
    v_mfma_f32_16x16x32_bf16 v[154:157], a[20:23], v[186:189], v[154:157]
    v_pk_fma_f16 v193, v177, v165, v193
    v_mfma_f32_16x16x32_bf16 v[182:185], a[24:27], v[202:205], 0
    s_barrier
    v_cvt_pk_bf16_f32 v131, v132, v133
    v_mfma_f32_16x16x32_bf16 v[182:185], a[28:31], v[194:197], v[182:185]
    ds_read2_b32 v[164:165], v6 offset0:0 offset1:0
    v_mfma_f32_16x16x32_bf16 v[182:185], a[32:35], v[214:217], v[182:185]
    ds_read2_b32 v[212:213], v6 offset0:16 offset1:16
    v_cvt_pk_f16_f32 v154, v154, v155
    v_mfma_f32_16x16x32_bf16 v[182:185], a[36:39], v[206:209], v[182:185]
    ds_read2_b32 v[220:221], v6 offset0:32 offset1:32
    v_pk_mul_f16 v190, v154, v154
    v_mfma_f32_16x16x32_bf16 v[182:185], a[40:43], v[198:201], v[182:185]
    ds_read_u16 v133, v9 offset:256
    v_cvt_pk_f16_f32 v155, v156, v157
    v_mfma_f32_16x16x32_bf16 v[182:185], a[44:47], v[186:189], v[182:185]
    v_pk_fma_f16 v190, v155, v155, v190
    v_pk_mul_f16 v192, v154, v170
    v_mfma_f32_16x16x32_bf16 v[222:225], a[48:51], v[202:205], 0
    v_pk_fma_f16 v192, v155, v171, v192
    v_mul_f32 v126, v255, v126
    v_mfma_f32_16x16x32_bf16 v[222:225], a[52:55], v[194:197], v[222:225]
    v_mul_f32 v127, v255, v127
    v_cvt_pk_bf16_f32 v132, v126, v127
    v_mfma_f32_16x16x32_bf16 v[222:225], a[56:59], v[214:217], v[222:225]
    buffer_load_dwordx4 v10, s[8:11], 0 offen nt lds
    v_cvt_pk_f16_f32 v156, v182, v183
    v_mfma_f32_16x16x32_bf16 v[222:225], a[60:63], v[206:209], v[222:225]
    s_add_u32 m0, s28, 4096
    v_pk_fma_f16 v190, v156, v156, v190
    v_cvt_pk_f16_f32 v157, v184, v185
    v_mfma_f32_16x16x32_bf16 v[222:225], a[64:67], v[198:201], v[222:225]
    s_waitcnt lgkmcnt(2)
    v_pk_fma_f16 v190, v157, v157, v190
    v_pk_fma_f16 v192, v156, v172, v192
    v_mfma_f32_16x16x32_bf16 v[222:225], a[68:71], v[186:189], v[222:225]
    s_waitcnt lgkmcnt(1)
    ds_read_b128 v[182:185], v2 offset:0
    v_pk_fma_f16 v192, v157, v173, v192
    v_mfma_f32_16x16x32_bf16 v[170:173], v[202:205], a[144:147], 0
    s_waitcnt lgkmcnt(1)
    ds_read_b128 v[226:229], v2 offset:1024
    v_readfirstlane_b32 s77, v133
    v_mfma_f32_16x16x32_bf16 v[170:173], v[194:197], a[148:151], v[170:173]
    ds_read_b128 v[234:237], v2 offset:2048
    buffer_load_dwordx4 v11, s[8:11], 0 offen nt lds
    v_mfma_f32_16x16x32_bf16 v[170:173], v[214:217], a[152:155], v[170:173]
    s_add_u32 m0, s28, 8192
    ds_read_b128 v[238:241], v2 offset:3072
    v_cvt_pk_f16_f32 v174, v222, v223
    v_mfma_f32_16x16x32_bf16 v[170:173], v[206:209], a[156:159], v[170:173]
    s_mul_i32 s78, s77, 2688
    ds_read_b128 v[242:245], v2 offset:4096
    v_pk_fma_f16 v190, v174, v174, v190
    v_mfma_f32_16x16x32_bf16 v[170:173], v[198:201], a[160:163], v[170:173]
    ds_read_b128 v[246:249], v2 offset:5120
    v_cvt_pk_f16_f32 v175, v224, v225
    v_mfma_f32_16x16x32_bf16 v[170:173], v[186:189], a[164:167], v[170:173]
    v_pk_fma_f16 v190, v175, v175, v190
    v_pk_fma_f16 v192, v174, v162, v192
    v_mfma_f32_16x16x32_bf16 v[222:225], v[202:205], a[168:171], 0
    buffer_load_dwordx4 v12, s[8:11], 0 offen nt lds
    v_pk_fma_f16 v192, v175, v163, v192
    v_mfma_f32_16x16x32_bf16 v[222:225], v[194:197], a[172:175], v[222:225]
    s_waitcnt lgkmcnt(5)
    v_mul_f32 v128, v255, v128
    v_cvt_pk_bf16_f32 v162, v170, v171
    v_mfma_f32_16x16x32_f16 v[250:253], v[40:43], v[190:193], 0
    s_add_u32 m0, s28, 12288
    v_cvt_pk_bf16_f32 v163, v172, v173
    v_mul_f32 v129, v255, v129
    v_mfma_f32_16x16x32_bf16 v[222:225], v[214:217], a[176:179], v[222:225]
    s_xor_b32 s28, s28, 65536
    v_cvt_pk_bf16_f32 v133, v128, v129
    v_mul_f32 v114, v255, v114
    v_mfma_f32_16x16x32_bf16 v[222:225], v[206:209], a[180:183], v[222:225]
    s_waitcnt lgkmcnt(2)
    v_rsq_f32 v250, v250
    v_mfma_f32_16x16x32_bf16 v[222:225], v[198:201], a[184:187], v[222:225]
    s_waitcnt lgkmcnt(1)
    buffer_load_dwordx4 v13, s[8:11], 0 offen nt lds
    v_mul_f32 v230, s31, v250
    v_mfma_f32_16x16x32_bf16 v[222:225], v[186:189], a[188:191], v[222:225]
    s_mov_b32 m0, s29
    v_rsq_f32 v251, v251
    v_mfma_f32_16x16x32_bf16 v[126:129], v[202:205], a[192:195], 0
    s_xor_b32 s29, s29, s30
    v_cvt_pk_f16_f32 v231, v230, v251
    v_fma_f32 v252, v252, v230, v26
    v_mfma_f32_16x16x32_bf16 v[126:129], v[194:197], a[196:199], v[126:129]
    s_add_u32 s19, s19, s20
    v_fmac_f32_dpp v254, v253, v251 quad_perm:[0,1,2,3] row_mask:0x4 bank_mask:0xf
    v_cvt_pk_bf16_f32 v210, v222, v223
    v_mfma_f32_16x16x32_bf16 v[126:129], v[214:217], a[200:203], v[126:129]
    s_add_u32 s23, s23, s21
    v_cvt_pk_bf16_f32 v211, v224, v225
    v_pk_mul_f16 v158, v158, v231 op_sel:[0,1] op_sel_hi:[1,1]
    v_mfma_f32_16x16x32_bf16 v[126:129], v[206:209], a[204:207], v[126:129]
    s_waitcnt lgkmcnt(0)
    v_pk_mul_f16 v159, v159, v231 op_sel:[0,1] op_sel_hi:[1,1]
    v_mfma_f32_16x16x32_bf16 v[126:129], v[198:201], a[208:211], v[126:129]
    s_cmp_ge_u32 s19, 72
    v_pk_mul_f16 v160, v160, v231 op_sel:[0,1] op_sel_hi:[1,1]
    v_pk_mul_f16 v161, v161, v231 op_sel:[0,1] op_sel_hi:[1,1]
    v_mfma_f32_16x16x32_bf16 v[126:129], v[186:189], a[212:215], v[126:129]
    s_cselect_b32 s34, 72, 0
    v_pk_mul_f16 v176, v176, v231 op_sel:[0,1] op_sel_hi:[1,1]
    v_pk_mul_f16 v177, v177, v231 op_sel:[0,1] op_sel_hi:[1,1]
    v_mfma_f32_16x16x32_f16 v[170:173], v[146:149], v[150:153], v[46:49]
    s_cselect_b32 s35, s22, 0
    v_pk_mul_f16 v154, v154, v231 op_sel:[0,0] op_sel_hi:[1,0]
    v_pk_mul_f16 v155, v155, v231 op_sel:[0,0] op_sel_hi:[1,0]
    v_mfma_f32_16x16x32_f16 v[186:189], v[166:169], v[150:153], v[50:53]
    s_sub_u32 s19, s19, s34
    v_cvt_pk_bf16_f32 v218, v126, v127
    v_cvt_pk_bf16_f32 v219, v128, v129
    v_mfma_f32_16x16x32_f16 v[126:129], v[158:161], v[150:153], v[54:57]
    buffer_store_dwordx4 v[130:133], v16, s[12:15], 0 offen nt
    v_pk_mul_f16 v156, v156, v231 op_sel:[0,0] op_sel_hi:[1,0]
    v_pk_mul_f16 v157, v157, v231 op_sel:[0,0] op_sel_hi:[1,0]
    v_pk_mul_f16 v174, v174, v231 op_sel:[0,0] op_sel_hi:[1,0]
    v_pk_mul_f16 v175, v175, v231 op_sel:[0,0] op_sel_hi:[1,0]
    v_mfma_f32_16x16x16_f16 v[170:173], v[120:121], v[118:119], v[170:173]
    v_max3_u32 v44, v44, v250, v251
    v_exp_f32 v254, v254
    v_mfma_f32_16x16x16_f16 v[186:189], v[124:125], v[118:119], v[186:189]
    v_cvt_pk_bf16_f32 v254, v254, v254
    v_exp_f32 v252, v252
    v_mfma_f32_16x16x16_f16 v[126:129], v[176:177], v[118:119], v[126:129]
    v_mul_f32 v115, v255, v115
    v_cvt_pk_bf16_f32 v118, v114, v115
    v_exp_f32 v170, v170
    v_mfma_f32_16x16x32_f16 v[130:133], v[146:149], v[178:181], v[58:61]
    s_add_u32 s23, s23, s35
    ds_write_b16 v8, v254
    v_mfma_f32_16x16x32_f16 v[150:153], v[166:169], v[178:181], v[62:65]
    s_add_u32 s78, s78, s69
    v_exp_f32 v171, v171
    v_mfma_f32_16x16x32_f16 v[190:193], v[158:161], v[178:181], v[66:69]
    s_add_u32 s80, s77, s68
    v_cvt_pk_bf16_f32 v170, v170, v171
    v_exp_f32 v172, v172
    v_mfma_f32_16x16x16_f16 v[130:133], v[120:121], v[122:123], v[130:133]
    v_exp_f32 v173, v173
    v_mul_f32 v116, v255, v116
    v_mfma_f32_16x16x16_f16 v[150:153], v[124:125], v[122:123], v[150:153]
    v_cvt_pk_bf16_f32 v171, v172, v173
    v_exp_f32 v186, v186
    v_mfma_f32_16x16x16_f16 v[190:193], v[176:177], v[122:123], v[190:193]
    v_exp_f32 v187, v187
    v_exp_f32 v188, v188
    v_mfma_f32_16x16x32_bf16 v[178:181], a[216:219], v[182:185], 0
    s_cmp_ge_u32 s80, 72
    v_exp_f32 v130, v130
    v_mfma_f32_16x16x32_bf16 v[178:181], a[220:223], v[226:229], v[178:181]
    s_cselect_b32 s80, s22, 0
    v_exp_f32 v131, v131
    v_mfma_f32_16x16x32_bf16 v[178:181], a[224:227], v[234:237], v[178:181]
    s_add_u32 s78, s78, s80
    v_cvt_pk_bf16_f32 v194, v130, v131
    v_cvt_pk_bf16_f32 v172, v186, v187
    v_mfma_f32_16x16x32_bf16 v[178:181], a[228:231], v[238:241], v[178:181]
    s_add_u32 s80, s77, 20
    v_exp_f32 v132, v132
    v_mfma_f32_16x16x32_bf16 v[178:181], a[232:235], v[242:245], v[178:181]
    s_add_u32 s34, s18, 3
    v_exp_f32 v133, v133
    v_mfma_f32_16x16x32_bf16 v[178:181], a[236:239], v[246:249], v[178:181]
    s_cmp_lt_u32 s77, s62
    v_cvt_pk_bf16_f32 v195, v132, v133
    v_mul_f32 v117, v255, v117
    v_mfma_f32_16x16x32_bf16 v[198:201], a[240:243], v[182:185], 0
    s_cselect_b32 s79, 1, 0
    v_exp_f32 v150, v150
    v_mfma_f32_16x16x32_f16 v[202:205], v[146:149], v[154:157], v[70:73]
    s_cselect_b32 s78, s78, 0
    v_exp_f32 v151, v151
    v_mfma_f32_16x16x32_f16 v[146:149], v[166:169], v[154:157], v[74:77]
    s_cmp_lt_u32 s34, s17
    v_cvt_pk_bf16_f32 v196, v150, v151
    v_cvt_pk_bf16_f32 v119, v116, v117
    v_mfma_f32_16x16x32_f16 v[166:169], v[158:161], v[154:157], v[78:81]
    buffer_store_dwordx2 v[118:119], v19, s[12:15], 0 offen nt
    v_exp_f32 v152, v152
    v_mfma_f32_16x16x16_f16 v[202:205], v[120:121], v[174:175], v[202:205]
    v_exp_f32 v153, v153
    v_fma_f32 v254, v178, v178, s33
    v_mfma_f32_16x16x16_f16 v[146:149], v[124:125], v[174:175], v[146:149]
    v_cvt_pk_bf16_f32 v197, v152, v153
    v_exp_f32 v190, v190
    v_mfma_f32_16x16x16_f16 v[166:169], v[176:177], v[174:175], v[166:169]
    v_exp_f32 v191, v191
    v_exp_f32 v192, v192
    v_mfma_f32_16x16x32_bf16 v[198:201], a[244:247], v[226:229], v[198:201]
    s_cselect_b32 s23, s23, s78
    v_exp_f32 v193, v193
    v_mfma_f32_16x16x32_bf16 v[198:201], a[248:251], v[234:237], v[198:201]
    s_cselect_b32 s73, s34, s80
    ds_read_b128 v[118:121], v2 offset:6144
    v_fmac_f32 v254, v179, v179
    v_mfma_f32_16x16x32_bf16 v[198:201], a[252:255], v[238:241], v[198:201]
    s_cselect_b32 s79, 0, s79
    ds_read_b128 v[122:125], v2 offset:7168
    v_fmac_f32 v254, v180, v180
    v_mfma_f32_16x16x32_bf16 v[198:201], v[82:85], v[242:245], v[198:201]
    s_cselect_b32 s81, 0, 1
    ds_read_b128 v[150:153], v2 offset:8192
    v_fmac_f32 v254, v181, v181
    v_mfma_f32_16x16x32_bf16 v[198:201], v[86:89], v[246:249], v[198:201]
    s_add_u32 s80, s77, 1
    ds_read_b128 v[154:157], v2 offset:9216
    v_xor_b32 v0, 65536, v0
    v_mfma_f32_16x16x32_bf16 v[206:209], v[90:93], v[182:185], 0
    s_mul_i32 s80, s80, s81
    ds_read_b128 v[158:161], v2 offset:10240
    v_xor_b32 v1, 65536, v1
    v_mfma_f32_16x16x32_bf16 v[206:209], v[94:97], v[226:229], v[206:209]
    s_cmp_lt_u32 s80, s62
    ds_read_b128 v[174:177], v2 offset:11264
    v_fmac_f32 v254, v198, v198
    v_mfma_f32_16x16x32_bf16 v[206:209], v[98:101], v[234:237], v[206:209]
    s_cselect_b32 s62, s62, 0
    v_exp_f32 v189, v189
    v_mfma_f32_16x16x32_bf16 v[206:209], v[102:105], v[238:241], v[206:209]
    s_add_u32 s80, s18, 4
    v_cvt_pk_bf16_f32 v173, v188, v189
    v_fmac_f32 v254, v199, v199
    v_mfma_f32_16x16x32_bf16 v[206:209], v[106:109], v[242:245], v[206:209]
    s_waitcnt lgkmcnt(5)
    v_exp_f32 v126, v126
    v_mfma_f32_16x16x32_bf16 v[206:209], v[110:113], v[246:249], v[206:209]
    s_cmp_ge_u32 s80, s17
    v_exp_f32 v127, v127
    v_mfma_f32_16x16x32_bf16 v[130:133], a[216:219], v[118:121], 0
    s_waitcnt lgkmcnt(3)
    v_cvt_pk_bf16_f32 v36, v126, v127
    v_fmac_f32 v254, v200, v200
    v_mfma_f32_16x16x32_bf16 v[130:133], a[220:223], v[122:125], v[130:133]
    s_cselect_b32 s66, s62, 0
    v_exp_f32 v128, v128
    v_mfma_f32_16x16x32_bf16 v[130:133], a[224:227], v[150:153], v[130:133]
    s_waitcnt lgkmcnt(1)
    v_fmac_f32 v254, v201, v201
    v_mfma_f32_16x16x32_bf16 v[130:133], a[228:231], v[154:157], v[130:133]
    s_lshl_b32 s80, s79, s73
    v_exp_f32 v129, v129
    v_mfma_f32_16x16x32_bf16 v[130:133], a[232:235], v[158:161], v[130:133]
    s_waitcnt lgkmcnt(0)
    v_cvt_pk_bf16_f32 v37, v128, v129
    v_fmac_f32 v254, v206, v206
    v_mfma_f32_16x16x32_bf16 v[130:133], a[236:239], v[174:177], v[130:133]
    s_or_b32 s70, s70, s80
    v_exp_f32 v202, v202
    v_mfma_f32_16x16x32_bf16 v[182:185], v[28:31], v[36:39], 0
    s_add_u32 s45, s45, s79
    v_exp_f32 v203, v203
    v_mfma_f32_16x16x32_bf16 v[182:185], v[28:31], v[170:173], v[182:185]
    s_add_u32 s18, s18, 1
    v_cvt_pk_bf16_f32 v186, v202, v203
    v_fma_f32 v255, v130, v130, s33
    v_mfma_f32_16x16x32_bf16 v[214:217], v[162:165], v[36:39], 0
    s_cmp_lt_u32 s18, s45
    v_fmac_f32 v255, v131, v131
    v_fmac_f32 v255, v132, v132
    v_mfma_f32_16x16x32_bf16 v[214:217], v[134:137], v[170:173], v[214:217]
    v_fmac_f32 v255, v133, v133
    v_fmac_f32 v254, v207, v207
    v_mfma_f32_16x16x32_bf16 v[222:225], v[210:213], v[36:39], 0
    v_exp_f32 v204, v204
    v_mfma_f32_16x16x32_bf16 v[222:225], v[138:141], v[170:173], v[222:225]
    v_exp_f32 v205, v205
    v_mfma_f32_16x16x32_bf16 v[226:229], v[218:221], v[36:39], 0
    v_cvt_pk_bf16_f32 v36, v190, v191
    v_cvt_pk_bf16_f32 v37, v192, v193
    v_mfma_f32_16x16x32_bf16 v[226:229], v[142:145], v[170:173], v[226:229]
    v_cvt_pk_bf16_f32 v39, v232, 0
    v_cvt_pk_bf16_f32 v187, v204, v205
    v_mfma_f32_16x16x32_bf16 v[126:129], a[240:243], v[118:121], 0
    v_exp_f32 v146, v146
    v_mfma_f32_16x16x32_bf16 v[170:173], v[28:31], v[36:39], 0
    v_exp_f32 v147, v147
    v_mfma_f32_16x16x32_bf16 v[170:173], v[28:31], v[194:197], v[170:173]
    v_cvt_pk_bf16_f32 v188, v146, v147
    v_fmac_f32 v254, v208, v208
    v_mfma_f32_16x16x32_bf16 v[114:117], v[162:165], v[36:39], 0
    v_exp_f32 v148, v148
    v_mfma_f32_16x16x32_bf16 v[114:117], v[134:137], v[194:197], v[114:117]
    v_exp_f32 v149, v149
    v_mfma_f32_16x16x32_bf16 v[190:193], v[210:213], v[36:39], 0
    v_cvt_pk_bf16_f32 v189, v148, v149
    v_fmac_f32 v254, v209, v209
    v_mfma_f32_16x16x32_bf16 v[190:193], v[138:141], v[194:197], v[190:193]
    v_rcp_f32 v170, v170
    v_mfma_f32_16x16x32_bf16 v[146:149], v[218:221], v[36:39], 0
    v_exp_f32 v166, v166
    v_mfma_f32_16x16x32_bf16 v[146:149], v[142:145], v[194:197], v[146:149]
    v_mul_f32 v114, v170, v114
    v_mul_f32 v115, v170, v115
    v_mfma_f32_16x16x32_bf16 v[126:129], a[244:247], v[122:125], v[126:129]
    v_cvt_pk_bf16_f32 v194, v114, v115
    v_mul_f32 v116, v170, v116
    v_mfma_f32_16x16x32_bf16 v[126:129], a[248:251], v[150:153], v[126:129]
    ds_read_b128 v[202:205], v2 offset:12288
    v_mul_f32 v117, v170, v117
    v_mfma_f32_16x16x32_bf16 v[126:129], a[252:255], v[154:157], v[126:129]
    ds_read_b128 v[230:233], v2 offset:13312
    v_cvt_pk_bf16_f32 v195, v116, v117
    v_mfma_f32_16x16x32_bf16 v[126:129], v[82:85], v[158:161], v[126:129]
    ds_read_b128 v[234:237], v2 offset:14336
    v_mul_f32 v190, v170, v190
    v_mfma_f32_16x16x32_bf16 v[126:129], v[86:89], v[174:177], v[126:129]
    ds_read_b128 v[238:241], v2 offset:15360
    v_mul_f32 v191, v170, v191
    v_mfma_f32_16x16x32_bf16 v[114:117], v[90:93], v[118:121], 0
    ds_read_b128 v[118:121], v2 offset:16384
    v_cvt_pk_bf16_f32 v196, v190, v191
    v_mfma_f32_16x16x32_bf16 v[114:117], v[94:97], v[122:125], v[114:117]
    ds_read_b128 v[122:125], v2 offset:17408
    v_mul_f32 v192, v170, v192
    v_mfma_f32_16x16x32_bf16 v[114:117], v[98:101], v[150:153], v[114:117]
    v_fmac_f32 v255, v126, v126
    v_fmac_f32 v255, v127, v127
    v_mfma_f32_16x16x32_bf16 v[114:117], v[102:105], v[154:157], v[114:117]
    v_fmac_f32 v255, v128, v128
    v_fmac_f32 v255, v129, v129
    v_mfma_f32_16x16x32_bf16 v[114:117], v[106:109], v[158:161], v[114:117]
    s_waitcnt lgkmcnt(5)
    v_mul_f32 v193, v170, v193
    v_cvt_pk_bf16_f32 v197, v192, v193
    v_mfma_f32_16x16x32_bf16 v[114:117], v[110:113], v[174:177], v[114:117]
    s_waitcnt lgkmcnt(4)
    ds_write_b128 v3, v[194:197] offset:6144
    v_mfma_f32_16x16x32_bf16 v[242:245], a[216:219], v[202:205], 0
    s_waitcnt lgkmcnt(3)
    v_mul_f32 v146, v170, v146
    v_mul_f32 v147, v170, v147
    v_mfma_f32_16x16x32_bf16 v[242:245], a[220:223], v[230:233], v[242:245]
    s_waitcnt lgkmcnt(2)
    v_fmac_f32 v255, v114, v114
    v_fmac_f32 v255, v115, v115
    v_mfma_f32_16x16x32_bf16 v[242:245], a[224:227], v[234:237], v[242:245]
    s_waitcnt lgkmcnt(1)
    v_fmac_f32 v255, v116, v116
    v_fmac_f32 v255, v117, v117
    v_mfma_f32_16x16x32_bf16 v[242:245], a[228:231], v[238:241], v[242:245]
    v_cvt_pk_bf16_f32 v254, v254, v255
    v_cvt_pk_bf16_f32 v172, v146, v147
    v_mfma_f32_16x16x32_bf16 v[242:245], a[232:235], v[118:121], v[242:245]
    v_mul_f32 v148, v170, v148
    v_mul_f32 v149, v170, v149
    v_mfma_f32_16x16x32_bf16 v[242:245], a[236:239], v[122:125], v[242:245]
    v_cvt_pk_bf16_f32 v173, v148, v149
    v_cvt_pk_bf16_f32 v39, v252, 0
    v_mfma_f32_16x16x32_bf16 v[158:161], a[240:243], v[202:205], 0
    ds_write_b64 v4, v[172:173] offset:10240
    v_mfma_f32_16x16x32_bf16 v[158:161], a[244:247], v[230:233], v[158:161]
    v_exp_f32 v167, v167
    v_mfma_f32_16x16x32_bf16 v[158:161], a[248:251], v[234:237], v[158:161]
    v_cvt_pk_bf16_f32 v36, v166, v167
    v_fma_f32 v255, v242, v242, s33
    v_mfma_f32_16x16x32_bf16 v[158:161], a[252:255], v[238:241], v[158:161]
    v_fmac_f32 v255, v243, v243
    v_fmac_f32 v255, v244, v244
    v_mfma_f32_16x16x32_bf16 v[158:161], v[82:85], v[118:121], v[158:161]
    v_fmac_f32 v255, v245, v245
    v_xor_b32 v2, 65536, v2
    v_mfma_f32_16x16x32_bf16 v[158:161], v[86:89], v[122:125], v[158:161]
    v_exp_f32 v168, v168
    v_mfma_f32_16x16x32_bf16 v[154:157], v[90:93], v[202:205], 0
    v_exp_f32 v169, v169
    v_mfma_f32_16x16x32_bf16 v[154:157], v[94:97], v[230:233], v[154:157]
    ds_read_b128 v[146:149], v9
    v_cvt_pk_bf16_f32 v37, v168, v169
    v_mfma_f32_16x16x32_bf16 v[154:157], v[98:101], v[234:237], v[154:157]
    ds_read_b128 v[150:153], v9 offset:64
    v_fmac_f32 v255, v158, v158
    v_mfma_f32_16x16x32_bf16 v[166:169], v[28:31], v[36:39], 0
    v_fmac_f32 v255, v159, v159
    v_fmac_f32 v255, v160, v160
    v_mfma_f32_16x16x32_bf16 v[166:169], v[28:31], v[186:189], v[166:169]
    v_fmac_f32 v255, v161, v161
    v_add_u32 v6, s75, v6
    v_mfma_f32_16x16x32_bf16 v[174:177], v[162:165], v[36:39], 0
    v_rcp_f32 v182, v182
    v_mfma_f32_16x16x32_bf16 v[174:177], v[134:137], v[186:189], v[174:177]
    v_max3_u32 v25, v25, v182, v183
    v_max3_u32 v25, v25, v170, v171
    v_mfma_f32_16x16x32_bf16 v[170:173], v[210:213], v[36:39], 0
    v_rcp_f32 v166, v166
    v_mfma_f32_16x16x32_bf16 v[170:173], v[138:141], v[186:189], v[170:173]
    v_max3_u32 v25, v25, v166, v167
    v_mul_f32 v214, v182, v214
    v_mfma_f32_16x16x32_bf16 v[190:193], v[218:221], v[36:39], 0
    s_waitcnt lgkmcnt(1)
    v_mul_f32 v174, v166, v174
    v_mul_f32 v175, v166, v175
    v_mfma_f32_16x16x32_bf16 v[190:193], v[142:145], v[186:189], v[190:193]
    s_waitcnt lgkmcnt(0)
    v_cvt_pk_bf16_f32 v174, v174, v175
    v_mul_f32 v176, v166, v176
    v_mfma_f32_16x16x32_bf16 v[154:157], v[102:105], v[238:241], v[154:157]
    ds_read_b128 v[186:189], v0 offset:20480
    v_mul_f32 v177, v166, v177
    v_mfma_f32_16x16x32_bf16 v[154:157], v[106:109], v[118:121], v[154:157]
    ds_read_b128 v[194:197], v1 offset:20480
    v_cvt_pk_bf16_f32 v175, v176, v177
    v_mfma_f32_16x16x32_bf16 v[154:157], v[110:113], v[122:125], v[154:157]
    ds_read_b128 v[122:125], v0 offset:20608
    v_mul_f32 v170, v166, v170
    v_mfma_f32_16x16x32_bf16 v[118:121], v[146:149], v[28:31], 0
    ds_read_b128 v[202:205], v1 offset:20608
    v_mul_f32 v171, v166, v171
    v_mfma_f32_16x16x32_bf16 v[118:121], v[150:153], v[28:31], v[118:121]
    ds_read_b128 v[230:233], v0 offset:20736
    v_cvt_pk_bf16_f32 v176, v170, v171
    v_mfma_f32_16x16x32_bf16 v[234:237], v[146:149], v[134:137], 0
    ds_read_b128 v[238:241], v1 offset:20736
    v_fmac_f32 v255, v154, v154
    v_mfma_f32_16x16x32_bf16 v[234:237], v[150:153], v[162:165], v[234:237]
    v_fmac_f32 v255, v155, v155
    v_fmac_f32 v255, v156, v156
    v_mfma_f32_16x16x32_bf16 v[134:137], v[146:149], v[138:141], 0
    v_fmac_f32 v255, v157, v157
    v_cvt_pk_bf16_f32 v255, v255, v255
    v_mfma_f32_16x16x32_bf16 v[134:137], v[150:153], v[210:213], v[134:137]
    s_waitcnt lgkmcnt(5)
    ds_write_b64 v4, v[254:255] offset:18432
    v_mfma_f32_16x16x32_bf16 v[138:141], v[146:149], v[142:145], 0
    s_waitcnt lgkmcnt(4)
    v_mul_f32 v172, v166, v172
    v_mul_f32 v173, v166, v173
    v_mfma_f32_16x16x32_bf16 v[138:141], v[150:153], v[218:221], v[138:141]
    s_waitcnt lgkmcnt(3)
    v_cvt_pk_bf16_f32 v177, v172, v173
    v_mul_f32 v190, v166, v190
    v_mfma_f32_16x16x32_bf16 v[142:145], a[72:75], v[186:189], 0
    s_waitcnt lgkmcnt(2)
    ds_write_b128 v3, v[174:177] offset:12288
    v_mfma_f32_16x16x32_bf16 v[142:145], a[76:79], v[194:197], v[142:145]
    s_waitcnt lgkmcnt(2)
    v_mul_f32 v191, v166, v191
    v_cvt_pk_bf16_f32 v120, v190, v191
    v_mfma_f32_16x16x32_bf16 v[142:145], a[80:83], v[122:125], v[142:145]
    v_mul_f32 v192, v166, v192
    v_mul_f32 v193, v166, v193
    v_mfma_f32_16x16x32_bf16 v[142:145], a[84:87], v[202:205], v[142:145]
    v_cvt_pk_bf16_f32 v121, v192, v193
    v_mul_f32 v215, v182, v215
    v_mfma_f32_16x16x32_bf16 v[142:145], a[88:91], v[230:233], v[142:145]
    ds_write_b64 v4, v[120:121] offset:16384
    v_mfma_f32_16x16x32_bf16 v[142:145], a[92:95], v[238:241], v[142:145]
    v_rcp_f32 v118, v118
    v_mfma_f32_16x16x32_bf16 v[150:153], a[96:99], v[186:189], 0
    v_max3_u32 v25, v25, v118, v119
    v_mul_f32 v234, v234, v118
    v_mfma_f32_16x16x32_bf16 v[150:153], a[100:103], v[194:197], v[150:153]
    v_cvt_pk_bf16_f32 v146, v214, v215
    v_mul_f32_dpp v234, v134, v118 quad_perm:[0,1,2,3] row_mask:0x2 bank_mask:0xf
    v_mfma_f32_16x16x32_bf16 v[150:153], a[104:107], v[122:125], v[150:153]
    v_mul_f32 v216, v182, v216
    v_mul_f32_dpp v234, v138, v118 quad_perm:[0,1,2,3] row_mask:0x4 bank_mask:0xf
    v_mfma_f32_16x16x32_bf16 v[150:153], a[108:111], v[202:205], v[150:153]
    v_cvt_pk_bf16_f32 v234, v234, v234
    v_mul_f32 v217, v182, v217
    v_mfma_f32_16x16x32_bf16 v[150:153], a[112:115], v[230:233], v[150:153]
    ds_write_b16 v7, v234
    v_mfma_f32_16x16x32_bf16 v[150:153], a[116:119], v[238:241], v[150:153]
    v_cvt_pk_bf16_f32 v147, v216, v217
    v_mul_f32 v222, v182, v222
    v_mfma_f32_16x16x32_bf16 v[134:137], a[120:123], v[186:189], 0
    v_mul_f32 v223, v182, v223
    v_cvt_pk_bf16_f32 v148, v222, v223
    v_mfma_f32_16x16x32_bf16 v[134:137], a[124:127], v[194:197], v[134:137]
    v_mul_f32 v224, v182, v224
    v_mul_f32 v225, v182, v225
    v_mfma_f32_16x16x32_bf16 v[134:137], a[128:131], v[122:125], v[134:137]
    v_cvt_pk_bf16_f32 v149, v224, v225
    v_mul_f32 v226, v182, v226
    v_mfma_f32_16x16x32_bf16 v[134:137], a[132:135], v[202:205], v[134:137]
    ds_write_b128 v3, v[146:149] offset:0
    v_mfma_f32_16x16x32_bf16 v[134:137], a[136:139], v[230:233], v[134:137]
    v_mul_f32 v227, v182, v227
    v_cvt_pk_bf16_f32 v254, v226, v227
    v_mfma_f32_16x16x32_bf16 v[134:137], a[140:143], v[238:241], v[134:137]
    v_mul_f32 v228, v182, v228
    v_mul_f32 v229, v182, v229
    v_mfma_f32_16x16x32_bf16 v[138:141], a[0:3], v[186:189], 0
    v_cvt_pk_bf16_f32 v255, v228, v229
    v_xor_b32 v3, 65536, v3
    v_mfma_f32_16x16x32_bf16 v[138:141], a[4:7], v[194:197], v[138:141]
    ds_write_b64 v4, v[254:255] offset:4096
    v_mfma_f32_16x16x32_bf16 v[138:141], a[8:11], v[122:125], v[138:141]
    v_xor_b32 v4, 65536, v4
    v_add_u32 v7, s76, v7
    v_mfma_f32_16x16x32_bf16 v[138:141], a[12:15], v[202:205], v[138:141]
    v_cvt_pk_f16_f32 v146, v142, v143
    v_pk_mul_f16 v143, v146, v146
    v_mfma_f32_16x16x32_bf16 v[138:141], a[16:19], v[230:233], v[138:141]
    v_cvt_pk_f16_f32 v147, v144, v145
    v_pk_fma_f16 v143, v147, v147, v143
    v_mfma_f32_16x16x32_bf16 v[138:141], a[20:23], v[238:241], v[138:141]
    v_cvt_pk_f16_f32 v148, v150, v151
    v_pk_fma_f16 v143, v148, v148, v143
    v_mfma_f32_16x16x32_bf16 v[166:169], a[24:27], v[186:189], 0
    v_cvt_pk_f16_f32 v149, v152, v153
    v_pk_fma_f16 v143, v149, v149, v143
    v_mfma_f32_16x16x32_bf16 v[166:169], a[28:31], v[194:197], v[166:169]
    v_cvt_pk_f16_f32 v120, v134, v135
    v_pk_fma_f16 v143, v120, v120, v143
    v_mfma_f32_16x16x32_bf16 v[166:169], a[32:35], v[122:125], v[166:169]
    s_waitcnt lgkmcnt(0)
    v_cvt_pk_f16_f32 v121, v136, v137
    v_pk_fma_f16 v143, v121, v121, v143
    v_mfma_f32_16x16x32_bf16 v[166:169], a[36:39], v[202:205], v[166:169]
    s_nop 0
    v_mfma_f32_16x16x32_bf16 v[166:169], a[40:43], v[230:233], v[166:169]
    s_nop 0
    v_mfma_f32_16x16x32_bf16 v[166:169], a[44:47], v[238:241], v[166:169]
    s_barrier
    v_mfma_f32_16x16x32_bf16 v[134:137], a[48:51], v[186:189], 0
    s_nop 0
    v_mfma_f32_16x16x32_bf16 v[134:137], a[52:55], v[194:197], v[134:137]
    s_cbranch_scc1 L_loop_fast2
    s_branch L_final_fast
.p2align 6
L_loop_fast3:
    v_mfma_f32_16x16x32_bf16 v[134:137], a[56:59], v[122:125], v[134:137]
    s_add_u32 s12, s40, s27
    ds_read_b128 v[190:193], v2 offset:18432
    v_cvt_pk_f16_f32 v150, v138, v139
    v_mfma_f32_16x16x32_bf16 v[134:137], a[60:63], v[202:205], v[134:137]
    s_addc_u32 s13, s41, 0
    ds_read_b128 v[210:213], v2 offset:19456
    v_pk_mul_f16 v142, v150, v150
    v_mfma_f32_16x16x32_bf16 v[134:137], a[64:67], v[230:233], v[134:137]
    s_sub_u32 s14, s36, s27
    ds_read_b128 v[174:177], v5 offset:32
    v_cvt_pk_f16_f32 v151, v140, v141
    v_mfma_f32_16x16x32_bf16 v[134:137], a[68:71], v[238:241], v[134:137]
    s_cmp_ge_u32 s18, 2
    ds_read2_b64 v[162:165], v5 offset0:6 offset1:9
    v_pk_fma_f16 v142, v151, v151, v142
    v_mfma_f32_16x16x32_bf16 v[138:141], v[186:189], a[144:147], 0
    s_cselect_b32 s14, s14, 0
    ds_read_b128 v[170:173], v5
    v_cvt_pk_f16_f32 v152, v166, v167
    v_mfma_f32_16x16x32_bf16 v[138:141], v[194:197], a[148:151], v[138:141]
    s_sub_u32 s82, s72, s71
    ds_read_b32 v254, v6 offset:192
    v_pk_fma_f16 v142, v152, v152, v142
    v_mfma_f32_16x16x32_bf16 v[138:141], v[122:125], a[152:155], v[138:141]
    s_mul_i32 s74, s82, 336
    v_cvt_pk_f16_f32 v153, v168, v169
    v_pk_fma_f16 v142, v153, v153, v142
    v_mfma_f32_16x16x32_bf16 v[138:141], v[202:205], a[156:159], v[138:141]
    s_mul_i32 s75, s82, 272
    v_cvt_pk_f16_f32 v118, v134, v135
    v_pk_fma_f16 v142, v118, v118, v142
    v_mfma_f32_16x16x32_bf16 v[138:141], v[230:233], a[160:163], v[138:141]
    s_waitcnt lgkmcnt(5)
    ds_read_b128 v[182:185], v0 offset:26624
    v_cvt_pk_f16_f32 v119, v136, v137
    v_mfma_f32_16x16x32_bf16 v[166:169], v[32:35], v[190:193], 0
    s_waitcnt lgkmcnt(5)
    v_pk_fma_f16 v142, v119, v119, v142
    v_add_u32 v5, s74, v5
    v_mfma_f32_16x16x32_bf16 v[166:169], v[32:35], v[210:213], v[166:169]
    s_waitcnt lgkmcnt(4)
    v_pk_mul_f16 v145, v146, v174
    v_pk_fma_f16 v145, v147, v175, v145
    v_mfma_f32_16x16x32_bf16 v[138:141], v[238:241], a[164:167], v[138:141]
    s_mul_i32 s76, s82, 16
    ds_read_b128 v[210:213], v1 offset:26624
    v_pk_fma_f16 v145, v148, v176, v145
    v_mfma_f32_16x16x32_bf16 v[214:217], v[186:189], a[168:171], 0
    s_waitcnt lgkmcnt(3)
    ds_read_b128 v[218:221], v0 offset:26752
    v_pk_fma_f16 v145, v149, v177, v145
    v_mfma_f32_16x16x32_bf16 v[214:217], v[194:197], a[172:175], v[214:217]
    s_waitcnt lgkmcnt(3)
    ds_read_b128 v[222:225], v1 offset:26752
    v_mov_b32_dpp v254, v23 quad_perm:[0,1,2,3] row_mask:0x7 bank_mask:0xf
    v_mfma_f32_16x16x32_bf16 v[214:217], v[122:125], a[176:179], v[214:217]
    s_add_u32 s34, s18, 2
    ds_read_b128 v[226:229], v0 offset:26880
    v_pk_fma_f16 v145, v120, v164, v145
    v_mfma_f32_16x16x32_bf16 v[214:217], v[202:205], a[180:183], v[214:217]
    s_add_u32 s8, s60, s23
    ds_read_b128 v[190:193], v1 offset:26880
    v_pk_fma_f16 v145, v121, v165, v145
    v_mfma_f32_16x16x32_bf16 v[214:217], v[230:233], a[184:187], v[214:217]
    s_waitcnt lgkmcnt(5)
    v_pk_mul_f16 v144, v150, v170
    v_pk_fma_f16 v144, v151, v171, v144
    v_mfma_f32_16x16x32_bf16 v[214:217], v[238:241], a[188:191], v[214:217]
    s_addc_u32 s9, s61, 0
    v_pk_fma_f16 v144, v152, v172, v144
    v_pk_fma_f16 v144, v153, v173, v144
    v_mfma_f32_16x16x32_bf16 v[246:249], v[186:189], a[192:195], 0
    s_sub_u32 s10, s36, s23
    v_pk_fma_f16 v144, v118, v162, v144
    v_pk_fma_f16 v144, v119, v163, v144
    v_mfma_f32_16x16x32_bf16 v[246:249], v[194:197], a[196:199], v[246:249]
    s_cmp_le_u32 s34, s45
    v_cvt_pk_bf16_f32 v134, v138, v139
    v_cvt_pk_bf16_f32 v135, v140, v141
    v_mfma_f32_16x16x32_f16 v[234:237], v[40:43], v[142:145], 0
    s_cselect_b32 s10, s10, 0
    v_cvt_pk_bf16_f32 v138, v214, v215
    v_cvt_pk_bf16_f32 v139, v216, v217
    v_mfma_f32_16x16x32_bf16 v[246:249], v[122:125], a[200:203], v[246:249]
    s_add_u32 m0, s28, 0
    v_mul_f32 v136, 0x3baaaaab, v166
    v_mul_f32 v255, 0x3baaaaab, v167
    v_mfma_f32_16x16x32_bf16 v[246:249], v[202:205], a[204:207], v[246:249]
    s_mov_b32 s27, s26
    v_rsq_f32 v234, v234
    v_mfma_f32_16x16x32_bf16 v[246:249], v[230:233], a[208:211], v[246:249]
    s_mov_b32 s26, s25
    v_rsq_f32 v235, v235
    v_mfma_f32_16x16x32_bf16 v[246:249], v[238:241], a[212:215], v[246:249]
    s_mov_b32 s25, s24
    v_mul_f32 v140, s31, v234
    v_cvt_pk_f16_f32 v141, v140, v235
    v_mfma_f32_16x16x32_bf16 v[122:125], a[72:75], v[182:185], 0
    s_waitcnt lgkmcnt(0)
    v_fma_f32 v236, v236, v140, v22
    v_fmac_f32_dpp v254, v237, v235 quad_perm:[0,1,2,3] row_mask:0x1 bank_mask:0xf
    v_mfma_f32_16x16x32_bf16 v[122:125], a[76:79], v[210:213], v[122:125]
    s_mov_b32 s24, s23
    v_cvt_pk_bf16_f32 v142, v246, v247
    v_cvt_pk_bf16_f32 v143, v248, v249
    v_mfma_f32_16x16x32_bf16 v[122:125], a[80:83], v[218:221], v[122:125]
    s_mov_b32 s71, s72
    v_pk_mul_f16 v146, v146, v141 op_sel:[0,1] op_sel_hi:[1,1]
    v_pk_mul_f16 v147, v147, v141 op_sel:[0,1] op_sel_hi:[1,1]
    v_mfma_f32_16x16x32_bf16 v[122:125], a[84:87], v[222:225], v[122:125]
    s_mov_b32 s72, s73
    v_pk_mul_f16 v148, v148, v141 op_sel:[0,1] op_sel_hi:[1,1]
    v_pk_mul_f16 v149, v149, v141 op_sel:[0,1] op_sel_hi:[1,1]
    v_mfma_f32_16x16x32_bf16 v[122:125], a[88:91], v[226:229], v[122:125]
    v_pk_mul_f16 v120, v120, v141 op_sel:[0,1] op_sel_hi:[1,1]
    v_pk_mul_f16 v121, v121, v141 op_sel:[0,1] op_sel_hi:[1,1]
    v_mfma_f32_16x16x32_bf16 v[122:125], a[92:95], v[190:193], v[122:125]
    v_pk_mul_f16 v150, v150, v141 op_sel:[0,0] op_sel_hi:[1,0]
    v_pk_mul_f16 v151, v151, v141 op_sel:[0,0] op_sel_hi:[1,0]
    v_mfma_f32_16x16x32_bf16 v[186:189], a[96:99], v[182:185], 0
    v_pk_mul_f16 v152, v152, v141 op_sel:[0,0] op_sel_hi:[1,0]
    v_pk_mul_f16 v153, v153, v141 op_sel:[0,0] op_sel_hi:[1,0]
    v_mfma_f32_16x16x32_bf16 v[186:189], a[100:103], v[210:213], v[186:189]
    v_pk_mul_f16 v118, v118, v141 op_sel:[0,0] op_sel_hi:[1,0]
    v_pk_mul_f16 v119, v119, v141 op_sel:[0,0] op_sel_hi:[1,0]
    v_mfma_f32_16x16x32_bf16 v[186:189], a[104:107], v[218:221], v[186:189]
    v_max3_u32 v44, v44, v234, v235
    v_mul_f32 v144, 0x3baaaaab, v168
    v_mfma_f32_16x16x32_bf16 v[186:189], a[108:111], v[222:225], v[186:189]
    v_rsq_f32 v136, v136
    v_mfma_f32_16x16x32_bf16 v[186:189], a[112:115], v[226:229], v[186:189]
    v_rsq_f32 v255, v255
    v_mfma_f32_16x16x32_bf16 v[186:189], a[116:119], v[190:193], v[186:189]
    v_rsq_f32 v144, v144
    v_mfma_f32_16x16x32_bf16 v[194:197], a[120:123], v[182:185], 0
    v_mul_f32 v178, v136, v178
    v_mul_f32 v179, v136, v179
    v_mfma_f32_16x16x32_bf16 v[194:197], a[124:127], v[210:213], v[194:197]
    v_cvt_pk_bf16_f32 v166, v178, v179
    v_mul_f32 v180, v136, v180
    v_mfma_f32_16x16x32_bf16 v[194:197], a[128:131], v[218:221], v[194:197]
    v_mul_f32 v181, v136, v181
    v_cvt_pk_bf16_f32 v167, v180, v181
    v_mfma_f32_16x16x32_bf16 v[194:197], a[132:135], v[222:225], v[194:197]
    v_mul_f32 v198, v136, v198
    v_mul_f32 v199, v136, v199
    v_mfma_f32_16x16x32_bf16 v[194:197], a[136:139], v[226:229], v[194:197]
    v_cvt_pk_bf16_f32 v168, v198, v199
    v_mul_f32 v200, v136, v200
    v_mfma_f32_16x16x32_bf16 v[194:197], a[140:143], v[190:193], v[194:197]
    v_mul_f32 v201, v136, v201
    v_cvt_pk_bf16_f32 v169, v200, v201
    v_mfma_f32_16x16x32_bf16 v[178:181], a[0:3], v[182:185], 0
    buffer_store_dwordx4 v[166:169], v15, s[12:15], 0 offen nt
    v_mul_f32 v206, v136, v206
    v_mul_f32 v207, v136, v207
    v_cvt_pk_bf16_f32 v140, v206, v207
    v_mul_f32 v208, v136, v208
    v_mfma_f32_16x16x32_bf16 v[178:181], a[4:7], v[210:213], v[178:181]
    v_mul_f32 v209, v136, v209
    v_cvt_pk_bf16_f32 v141, v208, v209
    v_mfma_f32_16x16x32_bf16 v[178:181], a[8:11], v[218:221], v[178:181]
    v_cvt_pk_f16_f32 v166, v122, v123
    v_pk_mul_f16 v199, v166, v166
    v_mfma_f32_16x16x32_bf16 v[178:181], a[12:15], v[222:225], v[178:181]
    v_cvt_pk_f16_f32 v167, v124, v125
    v_pk_fma_f16 v199, v167, v167, v199
    v_mfma_f32_16x16x32_bf16 v[178:181], a[16:19], v[226:229], v[178:181]
    v_cvt_pk_f16_f32 v168, v186, v187
    v_pk_fma_f16 v199, v168, v168, v199
    v_mfma_f32_16x16x32_bf16 v[178:181], a[20:23], v[190:193], v[178:181]
    v_cvt_pk_f16_f32 v169, v188, v189
    v_pk_fma_f16 v199, v169, v169, v199
    v_mfma_f32_16x16x32_bf16 v[186:189], a[24:27], v[182:185], 0
    v_cvt_pk_f16_f32 v124, v194, v195
    v_pk_fma_f16 v199, v124, v124, v199
    v_mfma_f32_16x16x32_bf16 v[186:189], a[28:31], v[210:213], v[186:189]
    v_cvt_pk_f16_f32 v125, v196, v197
    v_pk_fma_f16 v199, v125, v125, v199
    v_mfma_f32_16x16x32_bf16 v[186:189], a[32:35], v[218:221], v[186:189]
    v_cvt_pk_f16_f32 v178, v178, v179
    v_pk_mul_f16 v198, v178, v178
    v_mfma_f32_16x16x32_bf16 v[186:189], a[36:39], v[222:225], v[186:189]
    v_cvt_pk_f16_f32 v179, v180, v181
    v_pk_fma_f16 v198, v179, v179, v198
    v_mfma_f32_16x16x32_bf16 v[186:189], a[40:43], v[226:229], v[186:189]
    v_pk_mul_f16 v200, v178, v170
    v_pk_fma_f16 v200, v179, v171, v200
    v_mfma_f32_16x16x32_bf16 v[186:189], a[44:47], v[190:193], v[186:189]
    v_pk_mul_f16 v201, v166, v174
    v_pk_fma_f16 v201, v167, v175, v201
    v_mfma_f32_16x16x32_bf16 v[194:197], a[48:51], v[182:185], 0
    v_pk_fma_f16 v201, v168, v176, v201
    v_pk_fma_f16 v201, v169, v177, v201
    v_mfma_f32_16x16x32_bf16 v[194:197], a[52:55], v[210:213], v[194:197]
    v_pk_fma_f16 v201, v124, v164, v201
    v_pk_fma_f16 v201, v125, v165, v201
    v_mfma_f32_16x16x32_bf16 v[194:197], a[56:59], v[218:221], v[194:197]
    v_cvt_pk_f16_f32 v180, v186, v187
    v_pk_fma_f16 v198, v180, v180, v198
    v_mfma_f32_16x16x32_bf16 v[194:197], a[60:63], v[222:225], v[194:197]
    v_cvt_pk_f16_f32 v181, v188, v189
    v_pk_fma_f16 v198, v181, v181, v198
    v_mfma_f32_16x16x32_bf16 v[194:197], a[64:67], v[226:229], v[194:197]
    v_pk_fma_f16 v200, v180, v172, v200
    v_pk_fma_f16 v200, v181, v173, v200
    v_mfma_f32_16x16x32_bf16 v[194:197], a[68:71], v[190:193], v[194:197]
    buffer_store_dwordx2 v[140:141], v18, s[12:15], 0 offen nt
    v_mul_f32 v242, v144, v242
    v_mul_f32 v243, v144, v243
    v_mfma_f32_16x16x32_bf16 v[186:189], v[182:185], a[144:147], 0
    v_cvt_pk_bf16_f32 v238, v242, v243
    v_mul_f32 v244, v144, v244
    v_mfma_f32_16x16x32_bf16 v[186:189], v[210:213], a[148:151], v[186:189]
    v_mul_f32 v245, v144, v245
    v_cvt_pk_f16_f32 v122, v194, v195
    v_mfma_f32_16x16x32_bf16 v[186:189], v[218:221], a[152:155], v[186:189]
    v_pk_fma_f16 v198, v122, v122, v198
    v_cvt_pk_f16_f32 v123, v196, v197
    v_mfma_f32_16x16x32_bf16 v[186:189], v[222:225], a[156:159], v[186:189]
    v_pk_fma_f16 v198, v123, v123, v198
    v_pk_fma_f16 v200, v122, v162, v200
    v_mfma_f32_16x16x32_bf16 v[186:189], v[226:229], a[160:163], v[186:189]
    ds_read_b128 v[202:205], v0 offset:32768
    v_pk_fma_f16 v200, v123, v163, v200
    v_mfma_f32_16x16x32_bf16 v[186:189], v[190:193], a[164:167], v[186:189]
    ds_read_b128 v[194:197], v1 offset:32768
    v_cvt_pk_bf16_f32 v239, v244, v245
    v_mfma_f32_16x16x32_f16 v[230:233], v[40:43], v[198:201], 0
    v_mul_f32 v158, v144, v158
    v_mul_f32 v159, v144, v159
    v_mfma_f32_16x16x32_bf16 v[246:249], v[182:185], a[168:171], 0
    ds_read_b128 v[214:217], v0 offset:32896
    v_cvt_pk_bf16_f32 v240, v158, v159
    v_mfma_f32_16x16x32_bf16 v[246:249], v[210:213], a[172:175], v[246:249]
    ds_read_b128 v[206:209], v1 offset:32896
    v_cvt_pk_bf16_f32 v136, v186, v187
    v_mfma_f32_16x16x32_bf16 v[246:249], v[218:221], a[176:179], v[246:249]
    ds_read_b128 v[198:201], v0 offset:33024
    v_cvt_pk_bf16_f32 v137, v188, v189
    v_mfma_f32_16x16x32_bf16 v[246:249], v[222:225], a[180:183], v[246:249]
    ds_read_b128 v[186:189], v1 offset:33024
    v_mul_f32 v160, v144, v160
    v_mfma_f32_16x16x32_bf16 v[246:249], v[226:229], a[184:187], v[246:249]
    v_rsq_f32 v230, v230
    v_mfma_f32_16x16x32_bf16 v[246:249], v[190:193], a[188:191], v[246:249]
    s_waitcnt lgkmcnt(5)
    v_rsq_f32 v231, v231
    v_mfma_f32_16x16x32_bf16 v[242:245], v[182:185], a[192:195], 0
    s_waitcnt lgkmcnt(4)
    v_mul_f32 v234, s31, v230
    v_cvt_pk_f16_f32 v235, v234, v231
    v_mfma_f32_16x16x32_bf16 v[242:245], v[210:213], a[196:199], v[242:245]
    v_fma_f32 v232, v232, v234, v24
    v_fmac_f32_dpp v254, v233, v231 quad_perm:[0,1,2,3] row_mask:0x2 bank_mask:0xf
    v_mfma_f32_16x16x32_bf16 v[242:245], v[218:221], a[200:203], v[242:245]
    s_waitcnt lgkmcnt(3)
    v_cvt_pk_bf16_f32 v140, v246, v247
    v_cvt_pk_bf16_f32 v141, v248, v249
    v_mfma_f32_16x16x32_bf16 v[242:245], v[222:225], a[204:207], v[242:245]
    s_waitcnt lgkmcnt(2)
    v_mul_f32 v161, v144, v161
    v_cvt_pk_bf16_f32 v241, v160, v161
    v_mfma_f32_16x16x32_bf16 v[242:245], v[226:229], a[208:211], v[242:245]
    s_waitcnt lgkmcnt(1)
    buffer_store_dwordx4 v[238:241], v17, s[12:15], 0 offen nt
    v_mul_f32 v154, v144, v154
    v_mul_f32 v155, v144, v155
    v_cvt_pk_bf16_f32 v154, v154, v155
    v_mul_f32 v156, v144, v156
    v_mfma_f32_16x16x32_bf16 v[242:245], v[190:193], a[212:215], v[242:245]
    s_waitcnt lgkmcnt(0)
    v_mul_f32 v157, v144, v157
    v_cvt_pk_bf16_f32 v155, v156, v157
    v_mfma_f32_16x16x32_bf16 v[158:161], a[72:75], v[202:205], 0
    v_pk_mul_f16 v166, v166, v235 op_sel:[0,1] op_sel_hi:[1,1]
    v_pk_mul_f16 v167, v167, v235 op_sel:[0,1] op_sel_hi:[1,1]
    v_mfma_f32_16x16x32_bf16 v[158:161], a[76:79], v[194:197], v[158:161]
    v_pk_mul_f16 v168, v168, v235 op_sel:[0,1] op_sel_hi:[1,1]
    v_cvt_pk_bf16_f32 v144, v242, v243
    v_mfma_f32_16x16x32_bf16 v[158:161], a[80:83], v[214:217], v[158:161]
    v_cvt_pk_bf16_f32 v145, v244, v245
    v_pk_mul_f16 v169, v169, v235 op_sel:[0,1] op_sel_hi:[1,1]
    v_mfma_f32_16x16x32_bf16 v[158:161], a[84:87], v[206:209], v[158:161]
    v_pk_mul_f16 v124, v124, v235 op_sel:[0,1] op_sel_hi:[1,1]
    v_pk_mul_f16 v125, v125, v235 op_sel:[0,1] op_sel_hi:[1,1]
    v_mfma_f32_16x16x32_bf16 v[158:161], a[88:91], v[198:201], v[158:161]
    v_pk_mul_f16 v178, v178, v235 op_sel:[0,0] op_sel_hi:[1,0]
    v_pk_mul_f16 v179, v179, v235 op_sel:[0,0] op_sel_hi:[1,0]
    v_mfma_f32_16x16x32_bf16 v[158:161], a[92:95], v[186:189], v[158:161]
    v_pk_mul_f16 v180, v180, v235 op_sel:[0,0] op_sel_hi:[1,0]
    v_pk_mul_f16 v181, v181, v235 op_sel:[0,0] op_sel_hi:[1,0]
    v_mfma_f32_16x16x32_bf16 v[182:185], a[96:99], v[202:205], 0
    v_pk_mul_f16 v122, v122, v235 op_sel:[0,0] op_sel_hi:[1,0]
    v_pk_mul_f16 v123, v123, v235 op_sel:[0,0] op_sel_hi:[1,0]
    v_mfma_f32_16x16x32_bf16 v[182:185], a[100:103], v[194:197], v[182:185]
    v_max3_u32 v44, v44, v230, v231
    v_mul_f32 v130, v255, v130
    v_mfma_f32_16x16x32_bf16 v[182:185], a[104:107], v[214:217], v[182:185]
    v_cvt_pk_f16_f32 v158, v158, v159
    v_pk_mul_f16 v191, v158, v158
    v_mfma_f32_16x16x32_bf16 v[182:185], a[108:111], v[206:209], v[182:185]
    v_cvt_pk_f16_f32 v159, v160, v161
    v_pk_fma_f16 v191, v159, v159, v191
    v_mfma_f32_16x16x32_bf16 v[182:185], a[112:115], v[198:201], v[182:185]
    v_pk_mul_f16 v193, v158, v174
    v_pk_fma_f16 v193, v159, v175, v193
    v_mfma_f32_16x16x32_bf16 v[182:185], a[116:119], v[186:189], v[182:185]
    v_exp_f32 v232, v232
    v_mfma_f32_16x16x32_bf16 v[210:213], a[120:123], v[202:205], 0
    v_exp_f32 v236, v236
    v_mfma_f32_16x16x32_bf16 v[210:213], a[124:127], v[194:197], v[210:213]
    v_cvt_pk_bf16_f32 v39, v236, 0
    v_mul_f32 v131, v255, v131
    v_mfma_f32_16x16x32_bf16 v[210:213], a[128:131], v[214:217], v[210:213]
    s_waitcnt vmcnt(3)
    ds_write_b16 v8, v45 offset:512
    v_mfma_f32_16x16x32_bf16 v[210:213], a[132:135], v[206:209], v[210:213]
    buffer_store_dwordx2 v[154:155], v20, s[12:15], 0 offen nt
    v_cvt_pk_f16_f32 v160, v182, v183
    v_mfma_f32_16x16x32_bf16 v[210:213], a[136:139], v[198:201], v[210:213]
    v_pk_fma_f16 v191, v160, v160, v191
    v_cvt_pk_f16_f32 v161, v184, v185
    v_mfma_f32_16x16x32_bf16 v[210:213], a[140:143], v[186:189], v[210:213]
    v_pk_fma_f16 v191, v161, v161, v191
    v_pk_fma_f16 v193, v160, v176, v193
    v_mfma_f32_16x16x32_bf16 v[154:157], a[0:3], v[202:205], 0
    v_pk_fma_f16 v193, v161, v177, v193
    v_cvt_pk_bf16_f32 v130, v130, v131
    v_mfma_f32_16x16x32_bf16 v[154:157], a[4:7], v[194:197], v[154:157]
    v_mul_f32 v132, v255, v132
    v_mul_f32 v133, v255, v133
    v_mfma_f32_16x16x32_bf16 v[154:157], a[8:11], v[214:217], v[154:157]
    v_cvt_pk_f16_f32 v176, v210, v211
    v_pk_fma_f16 v191, v176, v176, v191
    v_mfma_f32_16x16x32_bf16 v[154:157], a[12:15], v[206:209], v[154:157]
    s_waitcnt lgkmcnt(0)
    v_cvt_pk_f16_f32 v177, v212, v213
    v_pk_fma_f16 v191, v177, v177, v191
    v_mfma_f32_16x16x32_bf16 v[154:157], a[16:19], v[198:201], v[154:157]
    v_pk_fma_f16 v193, v176, v164, v193
    v_mfma_f32_16x16x32_bf16 v[154:157], a[20:23], v[186:189], v[154:157]
    v_pk_fma_f16 v193, v177, v165, v193
    v_mfma_f32_16x16x32_bf16 v[182:185], a[24:27], v[202:205], 0
    v_cvt_pk_bf16_f32 v131, v132, v133
    v_mfma_f32_16x16x32_bf16 v[182:185], a[28:31], v[194:197], v[182:185]
    s_barrier
    ds_read2_b32 v[164:165], v6 offset0:0 offset1:0
    v_mfma_f32_16x16x32_bf16 v[182:185], a[32:35], v[214:217], v[182:185]
    ds_read2_b32 v[212:213], v6 offset0:16 offset1:16
    v_cvt_pk_f16_f32 v154, v154, v155
    v_mfma_f32_16x16x32_bf16 v[182:185], a[36:39], v[206:209], v[182:185]
    ds_read2_b32 v[220:221], v6 offset0:32 offset1:32
    v_pk_mul_f16 v190, v154, v154
    v_mfma_f32_16x16x32_bf16 v[182:185], a[40:43], v[198:201], v[182:185]
    ds_read_u16 v133, v9 offset:128
    v_cvt_pk_f16_f32 v155, v156, v157
    v_mfma_f32_16x16x32_bf16 v[182:185], a[44:47], v[186:189], v[182:185]
    v_pk_fma_f16 v190, v155, v155, v190
    v_pk_mul_f16 v192, v154, v170
    v_mfma_f32_16x16x32_bf16 v[222:225], a[48:51], v[202:205], 0
    v_pk_fma_f16 v192, v155, v171, v192
    v_mul_f32 v126, v255, v126
    v_mfma_f32_16x16x32_bf16 v[222:225], a[52:55], v[194:197], v[222:225]
    v_mul_f32 v127, v255, v127
    v_cvt_pk_bf16_f32 v132, v126, v127
    v_mfma_f32_16x16x32_bf16 v[222:225], a[56:59], v[214:217], v[222:225]
    buffer_load_dwordx4 v10, s[8:11], 0 offen nt lds
    v_cvt_pk_f16_f32 v156, v182, v183
    v_mfma_f32_16x16x32_bf16 v[222:225], a[60:63], v[206:209], v[222:225]
    s_add_u32 m0, s28, 4096
    v_pk_fma_f16 v190, v156, v156, v190
    v_cvt_pk_f16_f32 v157, v184, v185
    v_mfma_f32_16x16x32_bf16 v[222:225], a[64:67], v[198:201], v[222:225]
    s_waitcnt lgkmcnt(2)
    v_pk_fma_f16 v190, v157, v157, v190
    v_pk_fma_f16 v192, v156, v172, v192
    v_mfma_f32_16x16x32_bf16 v[222:225], a[68:71], v[186:189], v[222:225]
    s_waitcnt lgkmcnt(1)
    ds_read_b128 v[182:185], v2 offset:0
    v_pk_fma_f16 v192, v157, v173, v192
    v_mfma_f32_16x16x32_bf16 v[170:173], v[202:205], a[144:147], 0
    s_waitcnt lgkmcnt(1)
    ds_read_b128 v[226:229], v2 offset:1024
    v_readfirstlane_b32 s77, v133
    v_mfma_f32_16x16x32_bf16 v[170:173], v[194:197], a[148:151], v[170:173]
    ds_read_b128 v[234:237], v2 offset:2048
    buffer_load_dwordx4 v11, s[8:11], 0 offen nt lds
    v_mfma_f32_16x16x32_bf16 v[170:173], v[214:217], a[152:155], v[170:173]
    s_add_u32 m0, s28, 8192
    ds_read_b128 v[238:241], v2 offset:3072
    v_cvt_pk_f16_f32 v174, v222, v223
    v_mfma_f32_16x16x32_bf16 v[170:173], v[206:209], a[156:159], v[170:173]
    s_mul_i32 s78, s77, 2688
    ds_read_b128 v[242:245], v2 offset:4096
    v_pk_fma_f16 v190, v174, v174, v190
    v_mfma_f32_16x16x32_bf16 v[170:173], v[198:201], a[160:163], v[170:173]
    ds_read_b128 v[246:249], v2 offset:5120
    v_cvt_pk_f16_f32 v175, v224, v225
    v_mfma_f32_16x16x32_bf16 v[170:173], v[186:189], a[164:167], v[170:173]
    v_pk_fma_f16 v190, v175, v175, v190
    v_pk_fma_f16 v192, v174, v162, v192
    v_mfma_f32_16x16x32_bf16 v[222:225], v[202:205], a[168:171], 0
    buffer_load_dwordx4 v12, s[8:11], 0 offen nt lds
    v_pk_fma_f16 v192, v175, v163, v192
    v_mfma_f32_16x16x32_bf16 v[222:225], v[194:197], a[172:175], v[222:225]
    s_waitcnt lgkmcnt(5)
    v_mul_f32 v128, v255, v128
    v_cvt_pk_bf16_f32 v162, v170, v171
    v_mfma_f32_16x16x32_f16 v[250:253], v[40:43], v[190:193], 0
    s_add_u32 m0, s28, 12288
    v_cvt_pk_bf16_f32 v163, v172, v173
    v_mul_f32 v129, v255, v129
    v_mfma_f32_16x16x32_bf16 v[222:225], v[214:217], a[176:179], v[222:225]
    s_xor_b32 s28, s28, 65536
    v_cvt_pk_bf16_f32 v133, v128, v129
    v_mul_f32 v114, v255, v114
    v_mfma_f32_16x16x32_bf16 v[222:225], v[206:209], a[180:183], v[222:225]
    s_waitcnt lgkmcnt(2)
    v_rsq_f32 v250, v250
    v_mfma_f32_16x16x32_bf16 v[222:225], v[198:201], a[184:187], v[222:225]
    s_waitcnt lgkmcnt(1)
    buffer_load_dwordx4 v13, s[8:11], 0 offen nt lds
    v_mul_f32 v230, s31, v250
    v_mfma_f32_16x16x32_bf16 v[222:225], v[186:189], a[188:191], v[222:225]
    s_mov_b32 m0, s29
    v_rsq_f32 v251, v251
    v_mfma_f32_16x16x32_bf16 v[126:129], v[202:205], a[192:195], 0
    s_xor_b32 s29, s29, s30
    v_cvt_pk_f16_f32 v231, v230, v251
    v_fma_f32 v252, v252, v230, v26
    v_mfma_f32_16x16x32_bf16 v[126:129], v[194:197], a[196:199], v[126:129]
    s_add_u32 s19, s19, s20
    v_fmac_f32_dpp v254, v253, v251 quad_perm:[0,1,2,3] row_mask:0x4 bank_mask:0xf
    v_cvt_pk_bf16_f32 v210, v222, v223
    v_mfma_f32_16x16x32_bf16 v[126:129], v[214:217], a[200:203], v[126:129]
    s_add_u32 s23, s23, s21
    v_cvt_pk_bf16_f32 v211, v224, v225
    v_pk_mul_f16 v158, v158, v231 op_sel:[0,1] op_sel_hi:[1,1]
    v_mfma_f32_16x16x32_bf16 v[126:129], v[206:209], a[204:207], v[126:129]
    s_waitcnt lgkmcnt(0)
    v_pk_mul_f16 v159, v159, v231 op_sel:[0,1] op_sel_hi:[1,1]
    v_mfma_f32_16x16x32_bf16 v[126:129], v[198:201], a[208:211], v[126:129]
    s_cmp_ge_u32 s19, 72
    v_pk_mul_f16 v160, v160, v231 op_sel:[0,1] op_sel_hi:[1,1]
    v_pk_mul_f16 v161, v161, v231 op_sel:[0,1] op_sel_hi:[1,1]
    v_mfma_f32_16x16x32_bf16 v[126:129], v[186:189], a[212:215], v[126:129]
    s_cselect_b32 s34, 72, 0
    v_pk_mul_f16 v176, v176, v231 op_sel:[0,1] op_sel_hi:[1,1]
    v_pk_mul_f16 v177, v177, v231 op_sel:[0,1] op_sel_hi:[1,1]
    v_mfma_f32_16x16x32_f16 v[170:173], v[146:149], v[150:153], v[46:49]
    s_cselect_b32 s35, s22, 0
    v_pk_mul_f16 v154, v154, v231 op_sel:[0,0] op_sel_hi:[1,0]
    v_pk_mul_f16 v155, v155, v231 op_sel:[0,0] op_sel_hi:[1,0]
    v_mfma_f32_16x16x32_f16 v[186:189], v[166:169], v[150:153], v[50:53]
    s_sub_u32 s19, s19, s34
    v_cvt_pk_bf16_f32 v218, v126, v127
    v_cvt_pk_bf16_f32 v219, v128, v129
    v_mfma_f32_16x16x32_f16 v[126:129], v[158:161], v[150:153], v[54:57]
    buffer_store_dwordx4 v[130:133], v16, s[12:15], 0 offen nt
    v_pk_mul_f16 v156, v156, v231 op_sel:[0,0] op_sel_hi:[1,0]
    v_pk_mul_f16 v157, v157, v231 op_sel:[0,0] op_sel_hi:[1,0]
    v_pk_mul_f16 v174, v174, v231 op_sel:[0,0] op_sel_hi:[1,0]
    v_pk_mul_f16 v175, v175, v231 op_sel:[0,0] op_sel_hi:[1,0]
    v_mfma_f32_16x16x16_f16 v[170:173], v[120:121], v[118:119], v[170:173]
    v_max3_u32 v44, v44, v250, v251
    v_exp_f32 v254, v254
    v_mfma_f32_16x16x16_f16 v[186:189], v[124:125], v[118:119], v[186:189]
    v_cvt_pk_bf16_f32 v254, v254, v254
    v_exp_f32 v252, v252
    v_mfma_f32_16x16x16_f16 v[126:129], v[176:177], v[118:119], v[126:129]
    v_mul_f32 v115, v255, v115
    v_cvt_pk_bf16_f32 v118, v114, v115
    v_exp_f32 v170, v170
    v_mfma_f32_16x16x32_f16 v[130:133], v[146:149], v[178:181], v[58:61]
    s_add_u32 s23, s23, s35
    ds_write_b16 v8, v254
    v_mfma_f32_16x16x32_f16 v[150:153], v[166:169], v[178:181], v[62:65]
    s_add_u32 s78, s78, s69
    v_exp_f32 v171, v171
    v_mfma_f32_16x16x32_f16 v[190:193], v[158:161], v[178:181], v[66:69]
    s_add_u32 s80, s77, s68
    v_cvt_pk_bf16_f32 v170, v170, v171
    v_exp_f32 v172, v172
    v_mfma_f32_16x16x16_f16 v[130:133], v[120:121], v[122:123], v[130:133]
    v_exp_f32 v173, v173
    v_mul_f32 v116, v255, v116
    v_mfma_f32_16x16x16_f16 v[150:153], v[124:125], v[122:123], v[150:153]
    v_cvt_pk_bf16_f32 v171, v172, v173
    v_exp_f32 v186, v186
    v_mfma_f32_16x16x16_f16 v[190:193], v[176:177], v[122:123], v[190:193]
    v_exp_f32 v187, v187
    v_exp_f32 v188, v188
    v_mfma_f32_16x16x32_bf16 v[178:181], a[216:219], v[182:185], 0
    s_cmp_ge_u32 s80, 72
    v_exp_f32 v130, v130
    v_mfma_f32_16x16x32_bf16 v[178:181], a[220:223], v[226:229], v[178:181]
    s_cselect_b32 s80, s22, 0
    v_exp_f32 v131, v131
    v_mfma_f32_16x16x32_bf16 v[178:181], a[224:227], v[234:237], v[178:181]
    s_add_u32 s78, s78, s80
    v_cvt_pk_bf16_f32 v194, v130, v131
    v_cvt_pk_bf16_f32 v172, v186, v187
    v_mfma_f32_16x16x32_bf16 v[178:181], a[228:231], v[238:241], v[178:181]
    s_add_u32 s80, s77, 20
    v_exp_f32 v132, v132
    v_mfma_f32_16x16x32_bf16 v[178:181], a[232:235], v[242:245], v[178:181]
    s_add_u32 s34, s18, 3
    v_exp_f32 v133, v133
    v_mfma_f32_16x16x32_bf16 v[178:181], a[236:239], v[246:249], v[178:181]
    s_cmp_lt_u32 s77, s62
    v_cvt_pk_bf16_f32 v195, v132, v133
    v_mul_f32 v117, v255, v117
    v_mfma_f32_16x16x32_bf16 v[198:201], a[240:243], v[182:185], 0
    s_cselect_b32 s79, 1, 0
    v_exp_f32 v150, v150
    v_mfma_f32_16x16x32_f16 v[202:205], v[146:149], v[154:157], v[70:73]
    s_cselect_b32 s78, s78, 0
    v_exp_f32 v151, v151
    v_mfma_f32_16x16x32_f16 v[146:149], v[166:169], v[154:157], v[74:77]
    s_cmp_lt_u32 s34, s17
    v_cvt_pk_bf16_f32 v196, v150, v151
    v_cvt_pk_bf16_f32 v119, v116, v117
    v_mfma_f32_16x16x32_f16 v[166:169], v[158:161], v[154:157], v[78:81]
    buffer_store_dwordx2 v[118:119], v19, s[12:15], 0 offen nt
    v_exp_f32 v152, v152
    v_mfma_f32_16x16x16_f16 v[202:205], v[120:121], v[174:175], v[202:205]
    v_exp_f32 v153, v153
    v_fma_f32 v254, v178, v178, s33
    v_mfma_f32_16x16x16_f16 v[146:149], v[124:125], v[174:175], v[146:149]
    v_cvt_pk_bf16_f32 v197, v152, v153
    v_exp_f32 v190, v190
    v_mfma_f32_16x16x16_f16 v[166:169], v[176:177], v[174:175], v[166:169]
    v_exp_f32 v191, v191
    v_exp_f32 v192, v192
    v_mfma_f32_16x16x32_bf16 v[198:201], a[244:247], v[226:229], v[198:201]
    s_cselect_b32 s23, s23, s78
    v_exp_f32 v193, v193
    v_mfma_f32_16x16x32_bf16 v[198:201], a[248:251], v[234:237], v[198:201]
    s_cselect_b32 s73, s34, s80
    ds_read_b128 v[118:121], v2 offset:6144
    v_fmac_f32 v254, v179, v179
    v_mfma_f32_16x16x32_bf16 v[198:201], a[252:255], v[238:241], v[198:201]
    s_cselect_b32 s79, 0, s79
    ds_read_b128 v[122:125], v2 offset:7168
    v_fmac_f32 v254, v180, v180
    v_mfma_f32_16x16x32_bf16 v[198:201], v[82:85], v[242:245], v[198:201]
    s_cselect_b32 s81, 0, 1
    ds_read_b128 v[150:153], v2 offset:8192
    v_fmac_f32 v254, v181, v181
    v_mfma_f32_16x16x32_bf16 v[198:201], v[86:89], v[246:249], v[198:201]
    s_add_u32 s80, s77, 1
    ds_read_b128 v[154:157], v2 offset:9216
    v_xor_b32 v0, 65536, v0
    v_mfma_f32_16x16x32_bf16 v[206:209], v[90:93], v[182:185], 0
    s_mul_i32 s80, s80, s81
    ds_read_b128 v[158:161], v2 offset:10240
    v_xor_b32 v1, 65536, v1
    v_mfma_f32_16x16x32_bf16 v[206:209], v[94:97], v[226:229], v[206:209]
    s_cmp_lt_u32 s80, s62
    ds_read_b128 v[174:177], v2 offset:11264
    v_fmac_f32 v254, v198, v198
    v_mfma_f32_16x16x32_bf16 v[206:209], v[98:101], v[234:237], v[206:209]
    s_cselect_b32 s62, s62, 0
    v_exp_f32 v189, v189
    v_mfma_f32_16x16x32_bf16 v[206:209], v[102:105], v[238:241], v[206:209]
    s_add_u32 s80, s18, 4
    v_cvt_pk_bf16_f32 v173, v188, v189
    v_fmac_f32 v254, v199, v199
    v_mfma_f32_16x16x32_bf16 v[206:209], v[106:109], v[242:245], v[206:209]
    s_waitcnt lgkmcnt(5)
    v_exp_f32 v126, v126
    v_mfma_f32_16x16x32_bf16 v[206:209], v[110:113], v[246:249], v[206:209]
    s_cmp_ge_u32 s80, s17
    v_exp_f32 v127, v127
    v_mfma_f32_16x16x32_bf16 v[130:133], a[216:219], v[118:121], 0
    s_waitcnt lgkmcnt(3)
    v_cvt_pk_bf16_f32 v36, v126, v127
    v_fmac_f32 v254, v200, v200
    v_mfma_f32_16x16x32_bf16 v[130:133], a[220:223], v[122:125], v[130:133]
    s_cselect_b32 s66, s62, 0
    v_exp_f32 v128, v128
    v_mfma_f32_16x16x32_bf16 v[130:133], a[224:227], v[150:153], v[130:133]
    s_waitcnt lgkmcnt(1)
    v_fmac_f32 v254, v201, v201
    v_mfma_f32_16x16x32_bf16 v[130:133], a[228:231], v[154:157], v[130:133]
    s_lshl_b32 s80, s79, s73
    v_exp_f32 v129, v129
    v_mfma_f32_16x16x32_bf16 v[130:133], a[232:235], v[158:161], v[130:133]
    s_waitcnt lgkmcnt(0)
    v_cvt_pk_bf16_f32 v37, v128, v129
    v_fmac_f32 v254, v206, v206
    v_mfma_f32_16x16x32_bf16 v[130:133], a[236:239], v[174:177], v[130:133]
    s_or_b32 s70, s70, s80
    v_exp_f32 v202, v202
    v_mfma_f32_16x16x32_bf16 v[182:185], v[28:31], v[36:39], 0
    s_add_u32 s45, s45, s79
    v_exp_f32 v203, v203
    v_mfma_f32_16x16x32_bf16 v[182:185], v[28:31], v[170:173], v[182:185]
    s_add_u32 s18, s18, 1
    v_cvt_pk_bf16_f32 v186, v202, v203
    v_fma_f32 v255, v130, v130, s33
    v_mfma_f32_16x16x32_bf16 v[214:217], v[162:165], v[36:39], 0
    s_cmp_lt_u32 s18, s45
    v_fmac_f32 v255, v131, v131
    v_fmac_f32 v255, v132, v132
    v_mfma_f32_16x16x32_bf16 v[214:217], v[134:137], v[170:173], v[214:217]
    v_fmac_f32 v255, v133, v133
    v_fmac_f32 v254, v207, v207
    v_mfma_f32_16x16x32_bf16 v[222:225], v[210:213], v[36:39], 0
    v_exp_f32 v204, v204
    v_mfma_f32_16x16x32_bf16 v[222:225], v[138:141], v[170:173], v[222:225]
    v_exp_f32 v205, v205
    v_mfma_f32_16x16x32_bf16 v[226:229], v[218:221], v[36:39], 0
    v_cvt_pk_bf16_f32 v36, v190, v191
    v_cvt_pk_bf16_f32 v37, v192, v193
    v_mfma_f32_16x16x32_bf16 v[226:229], v[142:145], v[170:173], v[226:229]
    v_cvt_pk_bf16_f32 v39, v232, 0
    v_cvt_pk_bf16_f32 v187, v204, v205
    v_mfma_f32_16x16x32_bf16 v[126:129], a[240:243], v[118:121], 0
    v_exp_f32 v146, v146
    v_mfma_f32_16x16x32_bf16 v[170:173], v[28:31], v[36:39], 0
    v_exp_f32 v147, v147
    v_mfma_f32_16x16x32_bf16 v[170:173], v[28:31], v[194:197], v[170:173]
    v_cvt_pk_bf16_f32 v188, v146, v147
    v_fmac_f32 v254, v208, v208
    v_mfma_f32_16x16x32_bf16 v[114:117], v[162:165], v[36:39], 0
    v_exp_f32 v148, v148
    v_mfma_f32_16x16x32_bf16 v[114:117], v[134:137], v[194:197], v[114:117]
    v_exp_f32 v149, v149
    v_mfma_f32_16x16x32_bf16 v[190:193], v[210:213], v[36:39], 0
    v_cvt_pk_bf16_f32 v189, v148, v149
    v_fmac_f32 v254, v209, v209
    v_mfma_f32_16x16x32_bf16 v[190:193], v[138:141], v[194:197], v[190:193]
    v_rcp_f32 v170, v170
    v_mfma_f32_16x16x32_bf16 v[146:149], v[218:221], v[36:39], 0
    v_exp_f32 v166, v166
    v_mfma_f32_16x16x32_bf16 v[146:149], v[142:145], v[194:197], v[146:149]
    v_mul_f32 v114, v170, v114
    v_mul_f32 v115, v170, v115
    v_mfma_f32_16x16x32_bf16 v[126:129], a[244:247], v[122:125], v[126:129]
    v_cvt_pk_bf16_f32 v194, v114, v115
    v_mul_f32 v116, v170, v116
    v_mfma_f32_16x16x32_bf16 v[126:129], a[248:251], v[150:153], v[126:129]
    ds_read_b128 v[202:205], v2 offset:12288
    v_mul_f32 v117, v170, v117
    v_mfma_f32_16x16x32_bf16 v[126:129], a[252:255], v[154:157], v[126:129]
    ds_read_b128 v[230:233], v2 offset:13312
    v_cvt_pk_bf16_f32 v195, v116, v117
    v_mfma_f32_16x16x32_bf16 v[126:129], v[82:85], v[158:161], v[126:129]
    ds_read_b128 v[234:237], v2 offset:14336
    v_mul_f32 v190, v170, v190
    v_mfma_f32_16x16x32_bf16 v[126:129], v[86:89], v[174:177], v[126:129]
    ds_read_b128 v[238:241], v2 offset:15360
    v_mul_f32 v191, v170, v191
    v_mfma_f32_16x16x32_bf16 v[114:117], v[90:93], v[118:121], 0
    ds_read_b128 v[118:121], v2 offset:16384
    v_cvt_pk_bf16_f32 v196, v190, v191
    v_mfma_f32_16x16x32_bf16 v[114:117], v[94:97], v[122:125], v[114:117]
    ds_read_b128 v[122:125], v2 offset:17408
    v_mul_f32 v192, v170, v192
    v_mfma_f32_16x16x32_bf16 v[114:117], v[98:101], v[150:153], v[114:117]
    v_fmac_f32 v255, v126, v126
    v_fmac_f32 v255, v127, v127
    v_mfma_f32_16x16x32_bf16 v[114:117], v[102:105], v[154:157], v[114:117]
    v_fmac_f32 v255, v128, v128
    v_fmac_f32 v255, v129, v129
    v_mfma_f32_16x16x32_bf16 v[114:117], v[106:109], v[158:161], v[114:117]
    s_waitcnt lgkmcnt(5)
    v_mul_f32 v193, v170, v193
    v_cvt_pk_bf16_f32 v197, v192, v193
    v_mfma_f32_16x16x32_bf16 v[114:117], v[110:113], v[174:177], v[114:117]
    s_waitcnt lgkmcnt(4)
    ds_write_b128 v3, v[194:197] offset:6144
    v_mfma_f32_16x16x32_bf16 v[242:245], a[216:219], v[202:205], 0
    s_waitcnt lgkmcnt(3)
    v_mul_f32 v146, v170, v146
    v_mul_f32 v147, v170, v147
    v_mfma_f32_16x16x32_bf16 v[242:245], a[220:223], v[230:233], v[242:245]
    s_waitcnt lgkmcnt(2)
    v_fmac_f32 v255, v114, v114
    v_fmac_f32 v255, v115, v115
    v_mfma_f32_16x16x32_bf16 v[242:245], a[224:227], v[234:237], v[242:245]
    s_waitcnt lgkmcnt(1)
    v_fmac_f32 v255, v116, v116
    v_fmac_f32 v255, v117, v117
    v_mfma_f32_16x16x32_bf16 v[242:245], a[228:231], v[238:241], v[242:245]
    v_cvt_pk_bf16_f32 v254, v254, v255
    v_cvt_pk_bf16_f32 v172, v146, v147
    v_mfma_f32_16x16x32_bf16 v[242:245], a[232:235], v[118:121], v[242:245]
    v_mul_f32 v148, v170, v148
    v_mul_f32 v149, v170, v149
    v_mfma_f32_16x16x32_bf16 v[242:245], a[236:239], v[122:125], v[242:245]
    v_cvt_pk_bf16_f32 v173, v148, v149
    v_cvt_pk_bf16_f32 v39, v252, 0
    v_mfma_f32_16x16x32_bf16 v[158:161], a[240:243], v[202:205], 0
    ds_write_b64 v4, v[172:173] offset:10240
    v_mfma_f32_16x16x32_bf16 v[158:161], a[244:247], v[230:233], v[158:161]
    v_exp_f32 v167, v167
    v_mfma_f32_16x16x32_bf16 v[158:161], a[248:251], v[234:237], v[158:161]
    v_cvt_pk_bf16_f32 v36, v166, v167
    v_fma_f32 v255, v242, v242, s33
    v_mfma_f32_16x16x32_bf16 v[158:161], a[252:255], v[238:241], v[158:161]
    v_fmac_f32 v255, v243, v243
    v_fmac_f32 v255, v244, v244
    v_mfma_f32_16x16x32_bf16 v[158:161], v[82:85], v[118:121], v[158:161]
    v_fmac_f32 v255, v245, v245
    v_xor_b32 v2, 65536, v2
    v_mfma_f32_16x16x32_bf16 v[158:161], v[86:89], v[122:125], v[158:161]
    v_exp_f32 v168, v168
    v_mfma_f32_16x16x32_bf16 v[154:157], v[90:93], v[202:205], 0
    v_exp_f32 v169, v169
    v_mfma_f32_16x16x32_bf16 v[154:157], v[94:97], v[230:233], v[154:157]
    ds_read_b128 v[146:149], v9
    v_cvt_pk_bf16_f32 v37, v168, v169
    v_mfma_f32_16x16x32_bf16 v[154:157], v[98:101], v[234:237], v[154:157]
    ds_read_b128 v[150:153], v9 offset:64
    v_fmac_f32 v255, v158, v158
    v_mfma_f32_16x16x32_bf16 v[166:169], v[28:31], v[36:39], 0
    v_fmac_f32 v255, v159, v159
    v_fmac_f32 v255, v160, v160
    v_mfma_f32_16x16x32_bf16 v[166:169], v[28:31], v[186:189], v[166:169]
    v_fmac_f32 v255, v161, v161
    v_add_u32 v6, s75, v6
    v_mfma_f32_16x16x32_bf16 v[174:177], v[162:165], v[36:39], 0
    v_rcp_f32 v182, v182
    v_mfma_f32_16x16x32_bf16 v[174:177], v[134:137], v[186:189], v[174:177]
    v_max3_u32 v25, v25, v182, v183
    v_max3_u32 v25, v25, v170, v171
    v_mfma_f32_16x16x32_bf16 v[170:173], v[210:213], v[36:39], 0
    v_rcp_f32 v166, v166
    v_mfma_f32_16x16x32_bf16 v[170:173], v[138:141], v[186:189], v[170:173]
    v_max3_u32 v25, v25, v166, v167
    v_mul_f32 v214, v182, v214
    v_mfma_f32_16x16x32_bf16 v[190:193], v[218:221], v[36:39], 0
    s_waitcnt lgkmcnt(1)
    v_mul_f32 v174, v166, v174
    v_mul_f32 v175, v166, v175
    v_mfma_f32_16x16x32_bf16 v[190:193], v[142:145], v[186:189], v[190:193]
    s_waitcnt lgkmcnt(0)
    v_cvt_pk_bf16_f32 v174, v174, v175
    v_mul_f32 v176, v166, v176
    v_mfma_f32_16x16x32_bf16 v[154:157], v[102:105], v[238:241], v[154:157]
    ds_read_b128 v[186:189], v0 offset:20480
    v_mul_f32 v177, v166, v177
    v_mfma_f32_16x16x32_bf16 v[154:157], v[106:109], v[118:121], v[154:157]
    ds_read_b128 v[194:197], v1 offset:20480
    v_cvt_pk_bf16_f32 v175, v176, v177
    v_mfma_f32_16x16x32_bf16 v[154:157], v[110:113], v[122:125], v[154:157]
    ds_read_b128 v[122:125], v0 offset:20608
    v_mul_f32 v170, v166, v170
    v_mfma_f32_16x16x32_bf16 v[118:121], v[146:149], v[28:31], 0
    ds_read_b128 v[202:205], v1 offset:20608
    v_mul_f32 v171, v166, v171
    v_mfma_f32_16x16x32_bf16 v[118:121], v[150:153], v[28:31], v[118:121]
    ds_read_b128 v[230:233], v0 offset:20736
    v_cvt_pk_bf16_f32 v176, v170, v171
    v_mfma_f32_16x16x32_bf16 v[234:237], v[146:149], v[134:137], 0
    ds_read_b128 v[238:241], v1 offset:20736
    v_fmac_f32 v255, v154, v154
    v_mfma_f32_16x16x32_bf16 v[234:237], v[150:153], v[162:165], v[234:237]
    v_fmac_f32 v255, v155, v155
    v_fmac_f32 v255, v156, v156
    v_mfma_f32_16x16x32_bf16 v[134:137], v[146:149], v[138:141], 0
    v_fmac_f32 v255, v157, v157
    v_cvt_pk_bf16_f32 v255, v255, v255
    v_mfma_f32_16x16x32_bf16 v[134:137], v[150:153], v[210:213], v[134:137]
    s_waitcnt lgkmcnt(5)
    ds_write_b64 v4, v[254:255] offset:18432
    v_mfma_f32_16x16x32_bf16 v[138:141], v[146:149], v[142:145], 0
    s_waitcnt lgkmcnt(4)
    v_mul_f32 v172, v166, v172
    v_mul_f32 v173, v166, v173
    v_mfma_f32_16x16x32_bf16 v[138:141], v[150:153], v[218:221], v[138:141]
    s_waitcnt lgkmcnt(3)
    v_cvt_pk_bf16_f32 v177, v172, v173
    v_mul_f32 v190, v166, v190
    v_mfma_f32_16x16x32_bf16 v[142:145], a[72:75], v[186:189], 0
    s_waitcnt lgkmcnt(2)
    ds_write_b128 v3, v[174:177] offset:12288
    v_mfma_f32_16x16x32_bf16 v[142:145], a[76:79], v[194:197], v[142:145]
    s_waitcnt lgkmcnt(2)
    v_mul_f32 v191, v166, v191
    v_cvt_pk_bf16_f32 v120, v190, v191
    v_mfma_f32_16x16x32_bf16 v[142:145], a[80:83], v[122:125], v[142:145]
    v_mul_f32 v192, v166, v192
    v_mul_f32 v193, v166, v193
    v_mfma_f32_16x16x32_bf16 v[142:145], a[84:87], v[202:205], v[142:145]
    v_cvt_pk_bf16_f32 v121, v192, v193
    v_mul_f32 v215, v182, v215
    v_mfma_f32_16x16x32_bf16 v[142:145], a[88:91], v[230:233], v[142:145]
    ds_write_b64 v4, v[120:121] offset:16384
    v_mfma_f32_16x16x32_bf16 v[142:145], a[92:95], v[238:241], v[142:145]
    v_rcp_f32 v118, v118
    v_mfma_f32_16x16x32_bf16 v[150:153], a[96:99], v[186:189], 0
    v_max3_u32 v25, v25, v118, v119
    v_mul_f32 v234, v234, v118
    v_mfma_f32_16x16x32_bf16 v[150:153], a[100:103], v[194:197], v[150:153]
    v_cvt_pk_bf16_f32 v146, v214, v215
    v_mul_f32_dpp v234, v134, v118 quad_perm:[0,1,2,3] row_mask:0x2 bank_mask:0xf
    v_mfma_f32_16x16x32_bf16 v[150:153], a[104:107], v[122:125], v[150:153]
    v_mul_f32 v216, v182, v216
    v_mul_f32_dpp v234, v138, v118 quad_perm:[0,1,2,3] row_mask:0x4 bank_mask:0xf
    v_mfma_f32_16x16x32_bf16 v[150:153], a[108:111], v[202:205], v[150:153]
    v_cvt_pk_bf16_f32 v234, v234, v234
    v_mul_f32 v217, v182, v217
    v_mfma_f32_16x16x32_bf16 v[150:153], a[112:115], v[230:233], v[150:153]
    ds_write_b16 v7, v234
    v_mfma_f32_16x16x32_bf16 v[150:153], a[116:119], v[238:241], v[150:153]
    v_cvt_pk_bf16_f32 v147, v216, v217
    v_mul_f32 v222, v182, v222
    v_mfma_f32_16x16x32_bf16 v[134:137], a[120:123], v[186:189], 0
    v_mul_f32 v223, v182, v223
    v_cvt_pk_bf16_f32 v148, v222, v223
    v_mfma_f32_16x16x32_bf16 v[134:137], a[124:127], v[194:197], v[134:137]
    v_mul_f32 v224, v182, v224
    v_mul_f32 v225, v182, v225
    v_mfma_f32_16x16x32_bf16 v[134:137], a[128:131], v[122:125], v[134:137]
    v_cvt_pk_bf16_f32 v149, v224, v225
    v_mul_f32 v226, v182, v226
    v_mfma_f32_16x16x32_bf16 v[134:137], a[132:135], v[202:205], v[134:137]
    ds_write_b128 v3, v[146:149] offset:0
    v_mfma_f32_16x16x32_bf16 v[134:137], a[136:139], v[230:233], v[134:137]
    v_mul_f32 v227, v182, v227
    v_cvt_pk_bf16_f32 v254, v226, v227
    v_mfma_f32_16x16x32_bf16 v[134:137], a[140:143], v[238:241], v[134:137]
    v_mul_f32 v228, v182, v228
    v_mul_f32 v229, v182, v229
    v_mfma_f32_16x16x32_bf16 v[138:141], a[0:3], v[186:189], 0
    v_cvt_pk_bf16_f32 v255, v228, v229
    v_xor_b32 v3, 65536, v3
    v_mfma_f32_16x16x32_bf16 v[138:141], a[4:7], v[194:197], v[138:141]
    ds_write_b64 v4, v[254:255] offset:4096
    v_mfma_f32_16x16x32_bf16 v[138:141], a[8:11], v[122:125], v[138:141]
    v_xor_b32 v4, 65536, v4
    v_add_u32 v7, s76, v7
    v_mfma_f32_16x16x32_bf16 v[138:141], a[12:15], v[202:205], v[138:141]
    v_cvt_pk_f16_f32 v146, v142, v143
    v_pk_mul_f16 v143, v146, v146
    v_mfma_f32_16x16x32_bf16 v[138:141], a[16:19], v[230:233], v[138:141]
    v_cvt_pk_f16_f32 v147, v144, v145
    v_pk_fma_f16 v143, v147, v147, v143
    v_mfma_f32_16x16x32_bf16 v[138:141], a[20:23], v[238:241], v[138:141]
    v_cvt_pk_f16_f32 v148, v150, v151
    v_pk_fma_f16 v143, v148, v148, v143
    v_mfma_f32_16x16x32_bf16 v[166:169], a[24:27], v[186:189], 0
    v_cvt_pk_f16_f32 v149, v152, v153
    v_pk_fma_f16 v143, v149, v149, v143
    v_mfma_f32_16x16x32_bf16 v[166:169], a[28:31], v[194:197], v[166:169]
    v_cvt_pk_f16_f32 v120, v134, v135
    v_pk_fma_f16 v143, v120, v120, v143
    v_mfma_f32_16x16x32_bf16 v[166:169], a[32:35], v[122:125], v[166:169]
    s_waitcnt lgkmcnt(0)
    v_cvt_pk_f16_f32 v121, v136, v137
    v_pk_fma_f16 v143, v121, v121, v143
    v_mfma_f32_16x16x32_bf16 v[166:169], a[36:39], v[202:205], v[166:169]
    s_nop 0
    v_mfma_f32_16x16x32_bf16 v[166:169], a[40:43], v[230:233], v[166:169]
    s_nop 0
    v_mfma_f32_16x16x32_bf16 v[166:169], a[44:47], v[238:241], v[166:169]
    s_nop 0
    v_mfma_f32_16x16x32_bf16 v[134:137], a[48:51], v[186:189], 0
    s_barrier
    v_mfma_f32_16x16x32_bf16 v[134:137], a[52:55], v[194:197], v[134:137]
    s_cbranch_scc1 L_loop_fast3
L_final_fast:
    v_mfma_f32_16x16x32_bf16 v[134:137], a[56:59], v[122:125], v[134:137]
    s_mov_b32 s12, s40
    ds_read_b128 v[150:153], v2 offset:18432
    ds_read_b128 v[162:165], v2 offset:19456
    v_mfma_f32_16x16x32_bf16 v[134:137], a[60:63], v[202:205], v[134:137]
    s_mov_b32 s13, s41
    ds_read_b128 v[170:173], v5 offset:32
    ds_read2_b64 v[174:177], v5 offset0:6 offset1:9
    v_mfma_f32_16x16x32_bf16 v[134:137], a[64:67], v[230:233], v[134:137]
    s_mov_b32 s14, s36
    v_cvt_pk_f16_f32 v138, v138, v139
    v_pk_mul_f16 v142, v138, v138
    v_mfma_f32_16x16x32_bf16 v[134:137], a[68:71], v[238:241], v[134:137]
    s_add_u32 s48, s40, s27
    ds_read_b128 v[182:185], v5
    ds_read_b32 v254, v6 offset:192
    v_mfma_f32_16x16x32_bf16 v[190:193], v[186:189], a[144:147], 0
    s_addc_u32 s49, s41, 0
    v_cvt_pk_f16_f32 v139, v140, v141
    v_pk_fma_f16 v142, v139, v139, v142
    v_mfma_f32_16x16x32_bf16 v[190:193], v[194:197], a[148:151], v[190:193]
    s_sub_u32 s50, s36, s27
    v_cvt_pk_f16_f32 v140, v166, v167
    v_pk_fma_f16 v142, v140, v140, v142
    v_mfma_f32_16x16x32_bf16 v[190:193], v[122:125], a[152:155], v[190:193]
    s_mov_b32 s51, 0x00020000
    v_cvt_pk_f16_f32 v141, v168, v169
    v_pk_fma_f16 v142, v141, v141, v142
    v_mfma_f32_16x16x32_bf16 v[190:193], v[202:205], a[156:159], v[190:193]
    s_add_u32 s52, s40, s26
    v_cvt_pk_f16_f32 v118, v134, v135
    v_pk_fma_f16 v142, v118, v118, v142
    v_mfma_f32_16x16x32_bf16 v[190:193], v[230:233], a[160:163], v[190:193]
    s_waitcnt lgkmcnt(4)
    v_cvt_pk_f16_f32 v119, v136, v137
    v_pk_fma_f16 v142, v119, v119, v142
    v_mfma_f32_16x16x32_bf16 v[134:137], v[32:35], v[150:153], 0
    s_waitcnt lgkmcnt(2)
    v_pk_mul_f16 v145, v146, v170
    v_pk_fma_f16 v145, v147, v171, v145
    v_mfma_f32_16x16x32_bf16 v[134:137], v[32:35], v[162:165], v[134:137]
    s_addc_u32 s53, s41, 0
    v_pk_fma_f16 v145, v148, v172, v145
    v_pk_fma_f16 v145, v149, v173, v145
    v_mfma_f32_16x16x32_bf16 v[190:193], v[238:241], a[164:167], v[190:193]
    s_waitcnt lgkmcnt(0)
    v_mov_b32_dpp v254, v23 quad_perm:[0,1,2,3] row_mask:0x7 bank_mask:0xf
    v_pk_fma_f16 v145, v120, v176, v145
    v_mfma_f32_16x16x32_bf16 v[150:153], v[186:189], a[168:171], 0
    s_sub_u32 s54, s36, s26
    v_mul_f32 v144, 0x3baaaaab, v135
    v_mul_f32 v255, 0x3baaaaab, v134
    v_mfma_f32_16x16x32_bf16 v[150:153], v[194:197], a[172:175], v[150:153]
    s_mov_b32 s55, 0x00020000
    v_rsq_f32 v144, v144
    v_mfma_f32_16x16x32_bf16 v[150:153], v[122:125], a[176:179], v[150:153]
    s_add_u32 s56, s40, s25
    v_mul_f32 v130, v144, v130
    v_mul_f32 v131, v144, v131
    v_mfma_f32_16x16x32_bf16 v[150:153], v[202:205], a[180:183], v[150:153]
    s_addc_u32 s57, s41, 0
    v_cvt_pk_bf16_f32 v130, v130, v131
    v_mul_f32 v132, v144, v132
    v_mfma_f32_16x16x32_bf16 v[150:153], v[230:233], a[184:187], v[150:153]
    s_sub_u32 s58, s36, s25
    ds_read_b128 v[162:165], v0 offset:26624
    v_mul_f32 v133, v144, v133
    v_mfma_f32_16x16x32_bf16 v[150:153], v[238:241], a[188:191], v[150:153]
    s_mov_b32 s59, 0x00020000
    ds_read_b128 v[166:169], v1 offset:26624
    v_cvt_pk_bf16_f32 v131, v132, v133
    v_mfma_f32_16x16x32_bf16 v[210:213], v[186:189], a[192:195], 0
    s_and_b32 s6, s2, 7
    ds_read_b128 v[186:189], v0 offset:26752
    v_mul_f32 v126, v144, v126
    v_mfma_f32_16x16x32_bf16 v[210:213], v[194:197], a[196:199], v[210:213]
    s_sub_u32 s6, 0, s6
    ds_read_b128 v[194:197], v1 offset:26752
    v_mul_f32 v127, v144, v127
    v_mfma_f32_16x16x32_bf16 v[210:213], v[122:125], a[200:203], v[210:213]
    s_lshl_b32 s3, s16, 6
    ds_read_b128 v[122:125], v0 offset:26880
    v_cvt_pk_bf16_f32 v132, v126, v127
    v_mfma_f32_16x16x32_bf16 v[210:213], v[202:205], a[204:207], v[210:213]
    s_lshl_b32 s4, s16, 5
    ds_read_b128 v[202:205], v1 offset:26880
    v_mul_f32 v128, v144, v128
    v_mfma_f32_16x16x32_bf16 v[210:213], v[230:233], a[208:211], v[210:213]
    s_add_u32 s4, s4, 256
    v_mul_f32 v129, v144, v129
    v_cvt_pk_bf16_f32 v133, v128, v129
    v_mfma_f32_16x16x32_bf16 v[210:213], v[238:241], a[212:215], v[210:213]
    s_mul_i32 s5, s16, 9408
    s_waitcnt lgkmcnt(5)
    ds_read_b128 v[126:129], v2 offset:0
    v_mfma_f32_16x16x32_bf16 v[214:217], a[72:75], v[162:165], 0
    s_add_u32 s5, s5, 104448
    ds_read_b128 v[218:221], v2 offset:1024
    ds_read_b128 v[222:225], v2 offset:2048
    v_mfma_f32_16x16x32_bf16 v[226:229], a[96:99], v[162:165], 0
    s_waitcnt lgkmcnt(7)
    ds_read_b128 v[230:233], v2 offset:3072
    buffer_store_dwordx4 v[130:133], v16, s[48:51], 0 offen nt
    ds_read_b128 v[234:237], v2 offset:4096
    v_mul_f32 v114, v144, v114
    v_mul_f32 v115, v144, v115
    v_cvt_pk_bf16_f32 v134, v114, v115
    v_mfma_f32_16x16x32_bf16 v[214:217], a[76:79], v[166:169], v[214:217]
    s_waitcnt lgkmcnt(7)
    ds_read_b128 v[130:133], v2 offset:5120
    v_mul_f32 v116, v144, v116
    v_mfma_f32_16x16x32_bf16 v[214:217], a[80:83], v[186:189], v[214:217]
    s_waitcnt lgkmcnt(7)
    v_mul_f32 v117, v144, v117
    v_cvt_pk_bf16_f32 v135, v116, v117
    v_mfma_f32_16x16x32_bf16 v[214:217], a[84:87], v[194:197], v[214:217]
    s_waitcnt lgkmcnt(6)
    v_rsq_f32 v255, v255
    v_mfma_f32_16x16x32_bf16 v[214:217], a[88:91], v[122:125], v[214:217]
    v_mul_f32 v178, v255, v178
    v_mul_f32 v179, v255, v179
    v_mfma_f32_16x16x32_bf16 v[214:217], a[92:95], v[202:205], v[214:217]
    s_waitcnt lgkmcnt(5)
    v_cvt_pk_bf16_f32 v114, v178, v179
    v_mul_f32 v180, v255, v180
    v_mfma_f32_16x16x32_bf16 v[226:229], a[100:103], v[166:169], v[226:229]
    s_waitcnt lgkmcnt(3)
    v_mul_f32 v181, v255, v181
    v_cvt_pk_bf16_f32 v115, v180, v181
    v_mfma_f32_16x16x32_bf16 v[178:181], a[216:219], v[126:129], 0
    s_waitcnt lgkmcnt(1)
    v_mul_f32 v198, v255, v198
    v_mul_f32 v199, v255, v199
    v_mfma_f32_16x16x32_bf16 v[178:181], a[220:223], v[218:221], v[178:181]
    v_cvt_pk_bf16_f32 v116, v198, v199
    v_mul_f32 v200, v255, v200
    v_mfma_f32_16x16x32_bf16 v[178:181], a[224:227], v[222:225], v[178:181]
    s_waitcnt lgkmcnt(0)
    v_mul_f32 v201, v255, v201
    v_cvt_pk_bf16_f32 v117, v200, v201
    v_mfma_f32_16x16x32_bf16 v[178:181], a[228:231], v[230:233], v[178:181]
    v_mul_f32 v206, v255, v206
    v_mul_f32 v207, v255, v207
    v_mfma_f32_16x16x32_bf16 v[178:181], a[232:235], v[234:237], v[178:181]
    v_cvt_pk_bf16_f32 v206, v206, v207
    v_mul_f32 v208, v255, v208
    v_mfma_f32_16x16x32_bf16 v[178:181], a[236:239], v[130:133], v[178:181]
    v_mul_f32 v209, v255, v209
    v_cvt_pk_bf16_f32 v207, v208, v209
    v_mfma_f32_16x16x32_bf16 v[198:201], a[240:243], v[126:129], 0
    v_pk_fma_f16 v145, v121, v177, v145
    v_pk_mul_f16 v144, v138, v182
    v_mfma_f32_16x16x32_bf16 v[198:201], a[244:247], v[218:221], v[198:201]
    v_pk_fma_f16 v144, v139, v183, v144
    v_pk_fma_f16 v144, v140, v184, v144
    v_mfma_f32_16x16x32_bf16 v[198:201], a[248:251], v[222:225], v[198:201]
    v_fma_f32 v255, v178, v178, s33
    v_fmac_f32 v255, v179, v179
    v_mfma_f32_16x16x32_bf16 v[198:201], a[252:255], v[230:233], v[198:201]
    buffer_store_dwordx2 v[134:135], v19, s[48:51], 0 offen nt
    v_fmac_f32 v255, v180, v180
    v_fmac_f32 v255, v181, v181
    v_mfma_f32_16x16x32_bf16 v[198:201], v[82:85], v[234:237], v[198:201]
    v_pk_fma_f16 v144, v141, v185, v144
    v_pk_fma_f16 v144, v118, v174, v144
    v_mfma_f32_16x16x32_bf16 v[198:201], v[86:89], v[130:133], v[198:201]
    v_pk_fma_f16 v144, v119, v175, v144
    v_cvt_pk_bf16_f32 v134, v190, v191
    v_mfma_f32_16x16x32_bf16 v[226:229], a[104:107], v[186:189], v[226:229]
    v_cvt_pk_bf16_f32 v135, v192, v193
    v_cvt_pk_bf16_f32 v150, v150, v151
    v_mfma_f32_16x16x32_f16 v[190:193], v[40:43], v[142:145], 0
    v_cvt_pk_bf16_f32 v151, v152, v153
    v_cvt_pk_bf16_f32 v142, v210, v211
    v_mfma_f32_16x16x32_bf16 v[238:241], v[90:93], v[126:129], 0
    v_fmac_f32 v255, v198, v198
    v_fmac_f32 v255, v199, v199
    v_mfma_f32_16x16x32_bf16 v[238:241], v[94:97], v[218:221], v[238:241]
    v_fmac_f32 v255, v200, v200
    v_fmac_f32 v255, v201, v201
    v_mfma_f32_16x16x32_bf16 v[238:241], v[98:101], v[222:225], v[238:241]
    v_rsq_f32 v190, v190
    v_mfma_f32_16x16x32_bf16 v[238:241], v[102:105], v[230:233], v[238:241]
    v_rsq_f32 v191, v191
    v_mfma_f32_16x16x32_bf16 v[238:241], v[106:109], v[234:237], v[238:241]
    v_mul_f32 v152, s31, v190
    v_cvt_pk_f16_f32 v153, v152, v191
    v_mfma_f32_16x16x32_bf16 v[238:241], v[110:113], v[130:133], v[238:241]
    v_cvt_pk_bf16_f32 v143, v212, v213
    v_fma_f32 v192, v192, v152, v22
    v_mfma_f32_16x16x32_bf16 v[226:229], a[108:111], v[194:197], v[226:229]
    v_fmac_f32_dpp v254, v193, v191 quad_perm:[0,1,2,3] row_mask:0x1 bank_mask:0xf
    v_pk_mul_f16 v146, v146, v153 op_sel:[0,1] op_sel_hi:[1,1]
    v_mfma_f32_16x16x32_bf16 v[226:229], a[112:115], v[122:125], v[226:229]
    v_pk_mul_f16 v147, v147, v153 op_sel:[0,1] op_sel_hi:[1,1]
    v_pk_mul_f16 v148, v148, v153 op_sel:[0,1] op_sel_hi:[1,1]
    v_mfma_f32_16x16x32_bf16 v[226:229], a[116:119], v[202:205], v[226:229]
    ds_read_b128 v[126:129], v2 offset:6144
    ds_read_b128 v[130:133], v2 offset:7168
    v_mfma_f32_16x16x32_bf16 v[210:213], a[120:123], v[162:165], 0
    ds_read_b128 v[218:221], v2 offset:8192
    ds_read_b128 v[222:225], v2 offset:9216
    v_mfma_f32_16x16x32_bf16 v[210:213], a[124:127], v[166:169], v[210:213]
    v_fmac_f32 v255, v238, v238
    v_fmac_f32 v255, v239, v239
    v_mfma_f32_16x16x32_bf16 v[210:213], a[128:131], v[186:189], v[210:213]
    ds_read_b128 v[230:233], v2 offset:10240
    buffer_store_dwordx4 v[114:117], v15, s[48:51], 0 offen nt
    ds_read_b128 v[234:237], v2 offset:11264
    v_fmac_f32 v255, v240, v240
    v_fmac_f32 v255, v241, v241
    v_pk_mul_f16 v149, v149, v153 op_sel:[0,1] op_sel_hi:[1,1]
    v_mfma_f32_16x16x32_bf16 v[210:213], a[132:135], v[194:197], v[210:213]
    v_pk_mul_f16 v120, v120, v153 op_sel:[0,1] op_sel_hi:[1,1]
    v_pk_mul_f16 v121, v121, v153 op_sel:[0,1] op_sel_hi:[1,1]
    v_mfma_f32_16x16x32_bf16 v[210:213], a[136:139], v[122:125], v[210:213]
    v_pk_mul_f16 v138, v138, v153 op_sel:[0,0] op_sel_hi:[1,0]
    v_pk_mul_f16 v139, v139, v153 op_sel:[0,0] op_sel_hi:[1,0]
    v_mfma_f32_16x16x32_bf16 v[210:213], a[140:143], v[202:205], v[210:213]
    v_pk_mul_f16 v140, v140, v153 op_sel:[0,0] op_sel_hi:[1,0]
    v_pk_mul_f16 v141, v141, v153 op_sel:[0,0] op_sel_hi:[1,0]
    v_pk_mul_f16 v118, v118, v153 op_sel:[0,0] op_sel_hi:[1,0]
    v_pk_mul_f16 v119, v119, v153 op_sel:[0,0] op_sel_hi:[1,0]
    v_mfma_f32_16x16x32_bf16 v[114:117], a[0:3], v[162:165], 0
    s_waitcnt lgkmcnt(2)
    v_max3_u32 v44, v44, v190, v191
    v_cvt_pk_f16_f32 v214, v214, v215
    v_mfma_f32_16x16x32_bf16 v[114:117], a[4:7], v[166:169], v[114:117]
    v_pk_mul_f16 v247, v214, v214
    v_cvt_pk_f16_f32 v215, v216, v217
    v_mfma_f32_16x16x32_bf16 v[114:117], a[8:11], v[186:189], v[114:117]
    s_waitcnt lgkmcnt(1)
    v_pk_fma_f16 v247, v215, v215, v247
    v_cvt_pk_f16_f32 v216, v226, v227
    v_mfma_f32_16x16x32_bf16 v[250:253], a[216:219], v[126:129], 0
    s_waitcnt lgkmcnt(0)
    v_pk_fma_f16 v247, v216, v216, v247
    v_cvt_pk_f16_f32 v217, v228, v229
    v_mfma_f32_16x16x32_bf16 v[250:253], a[220:223], v[130:133], v[250:253]
    v_pk_fma_f16 v247, v217, v217, v247
    v_cvt_pk_f16_f32 v208, v210, v211
    v_mfma_f32_16x16x32_bf16 v[250:253], a[224:227], v[218:221], v[250:253]
    v_pk_fma_f16 v247, v208, v208, v247
    v_cvt_pk_f16_f32 v209, v212, v213
    v_mfma_f32_16x16x32_bf16 v[250:253], a[228:231], v[222:225], v[250:253]
    v_pk_fma_f16 v247, v209, v209, v247
    v_pk_mul_f16 v249, v214, v170
    v_mfma_f32_16x16x32_bf16 v[250:253], a[232:235], v[230:233], v[250:253]
    v_pk_fma_f16 v249, v215, v171, v249
    v_pk_fma_f16 v249, v216, v172, v249
    v_mfma_f32_16x16x32_bf16 v[250:253], a[236:239], v[234:237], v[250:253]
    v_pk_fma_f16 v249, v217, v173, v249
    v_pk_fma_f16 v249, v208, v176, v249
    v_mfma_f32_16x16x32_bf16 v[114:117], a[12:15], v[194:197], v[114:117]
    v_pk_fma_f16 v249, v209, v177, v249
    v_mul_f32 v136, 0x3baaaaab, v136
    v_mfma_f32_16x16x32_bf16 v[114:117], a[16:19], v[122:125], v[114:117]
    v_rsq_f32 v136, v136
    v_mfma_f32_16x16x32_bf16 v[114:117], a[20:23], v[202:205], v[114:117]
    buffer_store_dwordx2 v[206:207], v18, s[48:51], 0 offen nt
    v_fma_f32 v137, v250, v250, s33
    v_fmac_f32 v137, v251, v251
    v_fmac_f32 v137, v252, v252
    v_fmac_f32 v137, v253, v253
    v_mul_f32 v242, v136, v242
    v_mul_f32 v243, v136, v243
    v_cvt_pk_bf16_f32 v210, v242, v243
    v_mfma_f32_16x16x32_bf16 v[226:229], a[240:243], v[126:129], 0
    v_cvt_pk_f16_f32 v114, v114, v115
    v_pk_mul_f16 v246, v114, v114
    v_mfma_f32_16x16x32_bf16 v[226:229], a[244:247], v[130:133], v[226:229]
    v_cvt_pk_f16_f32 v115, v116, v117
    v_pk_fma_f16 v246, v115, v115, v246
    v_mfma_f32_16x16x32_bf16 v[226:229], a[248:251], v[218:221], v[226:229]
    v_pk_mul_f16 v248, v114, v182
    v_pk_fma_f16 v248, v115, v183, v248
    v_mfma_f32_16x16x32_bf16 v[226:229], a[252:255], v[222:225], v[226:229]
    v_mul_f32 v244, v136, v244
    v_mul_f32 v245, v136, v245
    v_mfma_f32_16x16x32_bf16 v[226:229], v[82:85], v[230:233], v[226:229]
    v_cvt_pk_bf16_f32 v211, v244, v245
    v_mul_f32 v158, v136, v158
    v_mfma_f32_16x16x32_bf16 v[226:229], v[86:89], v[234:237], v[226:229]
    v_mul_f32 v159, v136, v159
    v_cvt_pk_bf16_f32 v212, v158, v159
    v_mul_f32 v160, v136, v160
    v_mul_f32 v161, v136, v161
    v_cvt_pk_bf16_f32 v213, v160, v161
    v_mul_f32 v154, v136, v154
    v_mul_f32 v155, v136, v155
    v_cvt_pk_bf16_f32 v144, v154, v155
    v_mfma_f32_16x16x32_bf16 v[158:161], v[90:93], v[126:129], 0
    v_fmac_f32 v137, v226, v226
    v_fmac_f32 v137, v227, v227
    v_mfma_f32_16x16x32_bf16 v[158:161], v[94:97], v[130:133], v[158:161]
    v_fmac_f32 v137, v228, v228
    v_fmac_f32 v137, v229, v229
    v_mfma_f32_16x16x32_bf16 v[158:161], v[98:101], v[218:221], v[158:161]
    v_mul_f32 v156, v136, v156
    v_mul_f32 v157, v136, v157
    v_mfma_f32_16x16x32_bf16 v[158:161], v[102:105], v[222:225], v[158:161]
    v_cvt_pk_bf16_f32 v145, v156, v157
    v_bfe_u32 v190, v2, 4, 6
    v_mfma_f32_16x16x32_bf16 v[158:161], v[106:109], v[230:233], v[158:161]
    v_lshrrev_b32 v191, 4, v190
    v_and_b32 v193, 15, v190
    v_mfma_f32_16x16x32_bf16 v[158:161], v[110:113], v[234:237], v[158:161]
    v_lshlrev_b32 v126, 9, v191
    v_lshl_add_u32 v126, v193, 4, v126
    v_mfma_f32_16x16x32_bf16 v[130:133], a[24:27], v[162:165], 0
    buffer_store_dwordx4 v[210:213], v17, s[48:51], 0 offen nt
    v_add_u32 v126, 149696, v126
    v_and_b32 v127, 0xffff, v2
    v_add_u32 v127, 38912, v127
    v_and_b32 v128, 0xffff, v4
    v_mfma_f32_16x16x32_bf16 v[130:133], a[28:31], v[166:169], v[130:133]
    v_fmac_f32 v137, v158, v158
    v_fmac_f32 v137, v159, v159
    v_mfma_f32_16x16x32_bf16 v[130:133], a[32:35], v[186:189], v[130:133]
    v_fmac_f32 v137, v160, v160
    v_fmac_f32 v137, v161, v161
    v_mfma_f32_16x16x32_bf16 v[130:133], a[36:39], v[194:197], v[130:133]
    v_cvt_pk_bf16_f32 v136, v255, v137
    v_cvt_pk_bf16_f32 v137, v137, v137
    v_mfma_f32_16x16x32_bf16 v[130:133], a[40:43], v[122:125], v[130:133]
    v_add_u32 v128, 38912, v128
    v_mov_b32 v129, 0x40000000
    v_mfma_f32_16x16x32_bf16 v[130:133], a[44:47], v[202:205], v[130:133]
    ds_write_b64 v128, v[136:137] offset:0
    v_mfma_f32_16x16x32_bf16 v[154:157], a[48:51], v[162:165], 0
    v_exp_f32 v192, v192
    v_mfma_f32_16x16x32_bf16 v[154:157], a[52:55], v[166:169], v[154:157]
    v_cvt_pk_bf16_f32 v39, v192, 0
    v_add_u32 v192, 0, v193
    v_mfma_f32_16x16x32_bf16 v[154:157], a[56:59], v[186:189], v[154:157]
    v_mul_u32_u24 v255, s20, v192
    v_cvt_pk_f16_f32 v116, v130, v131
    v_mfma_f32_16x16x32_bf16 v[154:157], a[60:63], v[194:197], v[154:157]
    v_pk_fma_f16 v246, v116, v116, v246
    v_cvt_pk_f16_f32 v117, v132, v133
    v_mfma_f32_16x16x32_bf16 v[154:157], a[64:67], v[122:125], v[154:157]
    v_pk_fma_f16 v246, v117, v117, v246
    v_pk_fma_f16 v248, v116, v184, v248
    v_mfma_f32_16x16x32_bf16 v[154:157], a[68:71], v[202:205], v[154:157]
    v_pk_fma_f16 v248, v117, v185, v248
    v_add_u32 v255, s38, v255
    v_mfma_f32_16x16x32_bf16 v[130:133], v[162:165], a[144:147], 0
    s_waitcnt lgkmcnt(0)
    v_mul_u32_u24 v136, 911, v255
    v_lshrrev_b32 v136, 16, v136
    v_mfma_f32_16x16x32_bf16 v[130:133], v[166:169], a[148:151], v[130:133]
    s_barrier
    ds_read_b128 v[210:213], v127 offset:0
    ds_read_b128 v[218:221], v127 offset:1024
    v_mfma_f32_16x16x32_bf16 v[130:133], v[186:189], a[152:155], v[130:133]
    v_cvt_pk_f16_f32 v206, v154, v155
    v_pk_fma_f16 v246, v206, v206, v246
    v_mfma_f32_16x16x32_bf16 v[130:133], v[194:197], a[156:159], v[130:133]
    buffer_store_dwordx2 v[144:145], v20, s[48:51], 0 offen nt
    v_cvt_pk_f16_f32 v207, v156, v157
    v_pk_fma_f16 v246, v207, v207, v246
    v_mfma_f32_16x16x32_bf16 v[130:133], v[122:125], a[160:163], v[130:133]
    v_pk_fma_f16 v248, v206, v174, v248
    v_pk_fma_f16 v248, v207, v175, v248
    v_mfma_f32_16x16x32_bf16 v[130:133], v[202:205], a[164:167], v[130:133]
    v_mul_u32_u24 v136, s22, v136
    v_mad_u32_u24 v136, v192, s21, v136
    v_mfma_f32_16x16x32_f16 v[154:157], v[40:43], v[246:249], 0
    v_bfe_u32 v255, s70, v192, 1
    v_cmp_ne_u32 vcc, 0, v255
    v_mfma_f32_16x16x32_bf16 v[222:225], v[162:165], a[168:171], 0
    v_add_u32 v192, s7, v136
    v_cndmask_b32 v192, v129, v192, vcc
    v_mfma_f32_16x16x32_bf16 v[222:225], v[166:169], a[172:175], v[222:225]
    s_waitcnt lgkmcnt(1)
    v_cvt_pk_bf16_f32 v136, v130, v131
    v_cvt_pk_bf16_f32 v137, v132, v133
    v_mfma_f32_16x16x32_bf16 v[130:133], v[32:35], v[210:213], 0
    s_waitcnt lgkmcnt(0)
    v_rsq_f32 v154, v154
    v_mfma_f32_16x16x32_bf16 v[130:133], v[32:35], v[218:221], v[130:133]
    v_rsq_f32 v155, v155
    v_mfma_f32_16x16x32_bf16 v[222:225], v[186:189], a[176:179], v[222:225]
    v_mul_f32 v210, s31, v154
    v_cvt_pk_f16_f32 v211, v210, v155
    v_mfma_f32_16x16x32_bf16 v[222:225], v[194:197], a[180:183], v[222:225]
    v_fma_f32 v156, v156, v210, v24
    v_fmac_f32_dpp v254, v157, v155 quad_perm:[0,1,2,3] row_mask:0x2 bank_mask:0xf
    v_mfma_f32_16x16x32_bf16 v[222:225], v[122:125], a[184:187], v[222:225]
    ds_read_b128 v[218:221], v0 offset:32768
    v_mul_f32 v157, 0x3baaaaab, v131
    v_mfma_f32_16x16x32_bf16 v[222:225], v[202:205], a[188:191], v[222:225]
    ds_read_b128 v[230:233], v1 offset:32768
    v_pk_mul_f16 v214, v214, v211 op_sel:[0,1] op_sel_hi:[1,1]
    v_mfma_f32_16x16x32_bf16 v[234:237], v[162:165], a[192:195], 0
    ds_read_b128 v[162:165], v0 offset:32896
    v_pk_mul_f16 v215, v215, v211 op_sel:[0,1] op_sel_hi:[1,1]
    v_mfma_f32_16x16x32_bf16 v[234:237], v[166:169], a[196:199], v[234:237]
    ds_read_b128 v[166:169], v1 offset:32896
    v_pk_mul_f16 v216, v216, v211 op_sel:[0,1] op_sel_hi:[1,1]
    v_mfma_f32_16x16x32_bf16 v[234:237], v[186:189], a[200:203], v[234:237]
    ds_read_b128 v[186:189], v0 offset:33024
    v_cvt_pk_bf16_f32 v152, v222, v223
    v_mfma_f32_16x16x32_bf16 v[234:237], v[194:197], a[204:207], v[234:237]
    ds_read_b128 v[194:197], v1 offset:33024
    v_cvt_pk_bf16_f32 v153, v224, v225
    v_mfma_f32_16x16x32_bf16 v[234:237], v[122:125], a[208:211], v[234:237]
    v_rsq_f32 v157, v157
    v_mfma_f32_16x16x32_bf16 v[234:237], v[202:205], a[212:215], v[234:237]
    v_mul_f32 v250, v157, v250
    v_mul_f32 v251, v157, v251
    v_mfma_f32_16x16x32_f16 v[122:125], v[146:149], v[138:141], v[46:49]
    s_waitcnt lgkmcnt(5)
    v_cvt_pk_bf16_f32 v202, v250, v251
    v_mul_f32 v252, v157, v252
    v_mfma_f32_16x16x32_bf16 v[222:225], a[72:75], v[218:221], 0
    s_waitcnt lgkmcnt(4)
    v_mul_f32 v253, v157, v253
    v_cvt_pk_bf16_f32 v203, v252, v253
    v_mfma_f32_16x16x32_bf16 v[222:225], a[76:79], v[230:233], v[222:225]
    s_waitcnt lgkmcnt(3)
    v_mul_f32 v226, v157, v226
    v_mul_f32 v227, v157, v227
    v_mfma_f32_16x16x32_bf16 v[222:225], a[80:83], v[162:165], v[222:225]
    s_waitcnt lgkmcnt(2)
    v_cvt_pk_bf16_f32 v204, v226, v227
    v_mul_f32 v228, v157, v228
    v_mfma_f32_16x16x32_bf16 v[222:225], a[84:87], v[166:169], v[222:225]
    s_waitcnt lgkmcnt(1)
    v_mul_f32 v229, v157, v229
    v_cvt_pk_bf16_f32 v205, v228, v229
    v_mfma_f32_16x16x32_bf16 v[222:225], a[88:91], v[186:189], v[222:225]
    s_waitcnt lgkmcnt(0)
    buffer_store_dwordx4 v[202:205], v16, s[52:55], 0 offen nt
    v_mul_f32 v158, v157, v158
    v_mul_f32 v159, v157, v159
    v_cvt_pk_bf16_f32 v132, v158, v159
    v_mul_f32 v160, v157, v160
    v_mfma_f32_16x16x32_bf16 v[222:225], a[92:95], v[194:197], v[222:225]
    v_mul_f32 v161, v157, v161
    v_cvt_pk_bf16_f32 v133, v160, v161
    v_mfma_f32_16x16x32_bf16 v[158:161], a[96:99], v[218:221], 0
    v_cvt_pk_bf16_f32 v144, v234, v235
    v_cvt_pk_bf16_f32 v145, v236, v237
    v_mfma_f32_16x16x32_bf16 v[158:161], a[100:103], v[230:233], v[158:161]
    v_pk_mul_f16 v217, v217, v211 op_sel:[0,1] op_sel_hi:[1,1]
    v_pk_mul_f16 v208, v208, v211 op_sel:[0,1] op_sel_hi:[1,1]
    v_mfma_f32_16x16x32_bf16 v[158:161], a[104:107], v[162:165], v[158:161]
    v_pk_mul_f16 v209, v209, v211 op_sel:[0,1] op_sel_hi:[1,1]
    v_pk_mul_f16 v114, v114, v211 op_sel:[0,0] op_sel_hi:[1,0]
    v_mfma_f32_16x16x32_bf16 v[158:161], a[108:111], v[166:169], v[158:161]
    v_pk_mul_f16 v115, v115, v211 op_sel:[0,0] op_sel_hi:[1,0]
    v_pk_mul_f16 v116, v116, v211 op_sel:[0,0] op_sel_hi:[1,0]
    v_mfma_f32_16x16x32_bf16 v[158:161], a[112:115], v[186:189], v[158:161]
    v_pk_mul_f16 v117, v117, v211 op_sel:[0,0] op_sel_hi:[1,0]
    v_pk_mul_f16 v206, v206, v211 op_sel:[0,0] op_sel_hi:[1,0]
    v_mfma_f32_16x16x32_bf16 v[158:161], a[116:119], v[194:197], v[158:161]
    v_pk_mul_f16 v207, v207, v211 op_sel:[0,0] op_sel_hi:[1,0]
    v_max3_u32 v44, v44, v154, v155
    v_mfma_f32_16x16x32_bf16 v[202:205], a[120:123], v[218:221], 0
    v_mul_f32 v255, 0x3baaaaab, v130
    v_cvt_pk_f16_f32 v130, v222, v223
    v_mfma_f32_16x16x32_bf16 v[202:205], a[124:127], v[230:233], v[202:205]
    v_rsq_f32 v255, v255
    v_mfma_f32_16x16x32_bf16 v[202:205], a[128:131], v[162:165], v[202:205]
    v_mul_f32 v178, v255, v178
    v_mul_f32 v179, v255, v179
    v_mfma_f32_16x16x32_bf16 v[202:205], a[132:135], v[166:169], v[202:205]
    v_cvt_pk_bf16_f32 v178, v178, v179
    v_mul_f32 v180, v255, v180
    v_mfma_f32_16x16x32_bf16 v[202:205], a[136:139], v[186:189], v[202:205]
    v_mul_f32 v181, v255, v181
    v_cvt_pk_bf16_f32 v179, v180, v181
    v_mfma_f32_16x16x32_bf16 v[202:205], a[140:143], v[194:197], v[202:205]
    v_mul_f32 v198, v255, v198
    v_mul_f32 v199, v255, v199
    v_mfma_f32_16x16x32_bf16 v[210:213], a[0:3], v[218:221], 0
    v_cvt_pk_bf16_f32 v180, v198, v199
    v_mul_f32 v200, v255, v200
    v_mfma_f32_16x16x32_bf16 v[210:213], a[4:7], v[230:233], v[210:213]
    v_mul_f32 v201, v255, v201
    v_cvt_pk_bf16_f32 v181, v200, v201
    v_mfma_f32_16x16x32_bf16 v[210:213], a[8:11], v[162:165], v[210:213]
    buffer_store_dwordx2 v[132:133], v19, s[52:55], 0 offen nt
    v_mul_f32 v238, v255, v238
    v_mul_f32 v239, v255, v239
    v_mfma_f32_16x16x32_bf16 v[210:213], a[12:15], v[166:169], v[210:213]
    v_cvt_pk_bf16_f32 v154, v238, v239
    v_mul_f32 v240, v255, v240
    v_mfma_f32_16x16x32_bf16 v[210:213], a[16:19], v[186:189], v[210:213]
    v_mul_f32 v241, v255, v241
    v_cvt_pk_bf16_f32 v155, v240, v241
    v_mfma_f32_16x16x32_bf16 v[210:213], a[20:23], v[194:197], v[210:213]
    v_pk_mul_f16 v199, v130, v130
    v_cvt_pk_f16_f32 v131, v224, v225
    v_mfma_f32_16x16x32_bf16 v[222:225], a[24:27], v[218:221], 0
    v_pk_fma_f16 v199, v131, v131, v199
    v_cvt_pk_f16_f32 v132, v158, v159
    v_mfma_f32_16x16x32_f16 v[226:229], v[214:217], v[138:141], v[50:53]
    v_pk_fma_f16 v199, v132, v132, v199
    v_cvt_pk_f16_f32 v133, v160, v161
    v_cvt_pk_f16_f32 v158, v210, v211
    v_mfma_f32_16x16x16_f16 v[122:125], v[120:121], v[118:119], v[122:125]
    v_pk_mul_f16 v198, v158, v158
    v_cvt_pk_f16_f32 v159, v212, v213
    v_pk_fma_f16 v198, v159, v159, v198
    v_mfma_f32_16x16x16_f16 v[226:229], v[208:209], v[118:119], v[226:229]
    v_pk_mul_f16 v200, v158, v182
    v_pk_fma_f16 v200, v159, v183, v200
    v_pk_fma_f16 v199, v133, v133, v199
    v_cvt_pk_f16_f32 v212, v202, v203
    v_mfma_f32_16x16x32_bf16 v[222:225], a[28:31], v[230:233], v[222:225]
    v_pk_fma_f16 v199, v212, v212, v199
    v_cvt_pk_f16_f32 v213, v204, v205
    v_mfma_f32_16x16x32_bf16 v[222:225], a[32:35], v[162:165], v[222:225]
    v_pk_fma_f16 v199, v213, v213, v199
    v_pk_mul_f16 v201, v130, v170
    v_mfma_f32_16x16x32_bf16 v[222:225], a[36:39], v[166:169], v[222:225]
    v_pk_fma_f16 v201, v131, v171, v201
    v_pk_fma_f16 v201, v132, v172, v201
    v_mfma_f32_16x16x32_bf16 v[222:225], a[40:43], v[186:189], v[222:225]
    v_pk_fma_f16 v201, v133, v173, v201
    v_pk_fma_f16 v201, v212, v176, v201
    v_mfma_f32_16x16x32_bf16 v[222:225], a[44:47], v[194:197], v[222:225]
    v_pk_fma_f16 v201, v213, v177, v201
    v_lshl_add_u32 v255, v191, 4, v192
    v_mfma_f32_16x16x32_bf16 v[170:173], a[48:51], v[218:221], 0
    v_exp_f32 v122, v122
    v_mfma_f32_16x16x32_bf16 v[170:173], a[52:55], v[230:233], v[170:173]
    v_exp_f32 v123, v123
    v_mfma_f32_16x16x32_bf16 v[170:173], a[56:59], v[162:165], v[170:173]
    v_cvt_pk_bf16_f32 v122, v122, v123
    v_cvt_pk_f16_f32 v160, v222, v223
    v_mfma_f32_16x16x32_bf16 v[170:173], a[60:63], v[166:169], v[170:173]
    buffer_store_dwordx4 v[178:181], v15, s[52:55], 0 offen nt
    v_pk_fma_f16 v198, v160, v160, v198
    v_cvt_pk_f16_f32 v161, v224, v225
    v_pk_fma_f16 v198, v161, v161, v198
    v_pk_fma_f16 v200, v160, v184, v200
    v_mfma_f32_16x16x32_bf16 v[170:173], a[64:67], v[186:189], v[170:173]
    v_pk_fma_f16 v200, v161, v185, v200
    v_add_u32 v255, s3, v255
    v_mfma_f32_16x16x32_bf16 v[170:173], a[68:71], v[194:197], v[170:173]
    ds_read2_b32 v[176:177], v6 offset0:0 offset1:0
    ds_read2_b32 v[180:181], v6 offset0:16 offset1:16
    v_mfma_f32_16x16x32_bf16 v[182:185], v[218:221], a[144:147], 0
    ds_read2_b32 v[204:205], v6 offset0:32 offset1:32
    v_lshl_add_u32 v192, v191, 3, v192
    v_mfma_f32_16x16x32_bf16 v[182:185], v[230:233], a[148:151], v[182:185]
    v_exp_f32 v124, v124
    v_mfma_f32_16x16x32_bf16 v[182:185], v[162:165], a[152:155], v[182:185]
    v_cvt_pk_f16_f32 v210, v170, v171
    v_pk_fma_f16 v198, v210, v210, v198
    v_mfma_f32_16x16x32_bf16 v[182:185], v[166:169], a[156:159], v[182:185]
    v_cvt_pk_f16_f32 v211, v172, v173
    v_pk_fma_f16 v198, v211, v211, v198
    v_mfma_f32_16x16x32_bf16 v[182:185], v[186:189], a[160:163], v[182:185]
    v_pk_fma_f16 v200, v210, v174, v200
    v_pk_fma_f16 v200, v211, v175, v200
    v_mfma_f32_16x16x32_bf16 v[182:185], v[194:197], a[164:167], v[182:185]
    v_exp_f32 v125, v125
    v_mfma_f32_16x16x32_f16 v[170:173], v[40:43], v[198:201], 0
    v_cvt_pk_bf16_f32 v123, v124, v125
    v_add_u32 v192, s4, v192
    v_mfma_f32_16x16x32_bf16 v[198:201], v[218:221], a[168:171], 0
    s_waitcnt lgkmcnt(1)
    v_exp_f32 v226, v226
    v_mfma_f32_16x16x32_bf16 v[198:201], v[230:233], a[172:175], v[198:201]
    s_waitcnt lgkmcnt(0)
    v_cvt_pk_bf16_f32 v174, v182, v183
    v_cvt_pk_bf16_f32 v175, v184, v185
    v_mfma_f32_16x16x32_bf16 v[198:201], v[162:165], a[176:179], v[198:201]
    v_rsq_f32 v170, v170
    v_mfma_f32_16x16x32_bf16 v[198:201], v[166:169], a[180:183], v[198:201]
    ds_read_b128 v[182:185], v2 offset:12288
    ds_read_b128 v[222:225], v2 offset:13312
    v_mfma_f32_16x16x32_bf16 v[198:201], v[186:189], a[184:187], v[198:201]
    ds_read_b128 v[234:237], v2 offset:14336
    ds_read_b128 v[238:241], v2 offset:15360
    v_mfma_f32_16x16x32_bf16 v[198:201], v[194:197], a[188:191], v[198:201]
    buffer_store_dwordx2 v[154:155], v18, s[52:55], 0 offen nt
    ds_read_b128 v[242:245], v2 offset:16384
    v_rsq_f32 v171, v171
    v_mul_f32 v124, s31, v170
    v_cvt_pk_f16_f32 v125, v124, v171
    v_fma_f32 v172, v172, v124, v26
    v_fmac_f32_dpp v254, v173, v171 quad_perm:[0,1,2,3] row_mask:0x4 bank_mask:0xf
    v_pk_mul_f16 v130, v130, v125 op_sel:[0,1] op_sel_hi:[1,1]
    v_cvt_pk_bf16_f32 v178, v198, v199
    v_cvt_pk_bf16_f32 v179, v200, v201
    v_pk_mul_f16 v131, v131, v125 op_sel:[0,1] op_sel_hi:[1,1]
    v_pk_mul_f16 v132, v132, v125 op_sel:[0,1] op_sel_hi:[1,1]
    v_pk_mul_f16 v133, v133, v125 op_sel:[0,1] op_sel_hi:[1,1]
    v_pk_mul_f16 v212, v212, v125 op_sel:[0,1] op_sel_hi:[1,1]
    v_pk_mul_f16 v213, v213, v125 op_sel:[0,1] op_sel_hi:[1,1]
    v_pk_mul_f16 v158, v158, v125 op_sel:[0,0] op_sel_hi:[1,0]
    v_pk_mul_f16 v159, v159, v125 op_sel:[0,0] op_sel_hi:[1,0]
    v_pk_mul_f16 v160, v160, v125 op_sel:[0,0] op_sel_hi:[1,0]
    v_pk_mul_f16 v161, v161, v125 op_sel:[0,0] op_sel_hi:[1,0]
    v_pk_mul_f16 v210, v210, v125 op_sel:[0,0] op_sel_hi:[1,0]
    v_pk_mul_f16 v211, v211, v125 op_sel:[0,0] op_sel_hi:[1,0]
    v_mfma_f32_16x16x32_f16 v[198:201], v[130:133], v[138:141], v[54:57]
    s_waitcnt lgkmcnt(2)
    ds_read_b128 v[138:141], v2 offset:17408
    v_max3_u32 v44, v44, v170, v171
    v_exp_f32 v227, v227
    v_exp_f32 v228, v228
    v_cvt_pk_bf16_f32 v124, v226, v227
    v_mfma_f32_16x16x16_f16 v[198:201], v[212:213], v[118:119], v[198:201]
    v_exp_f32 v229, v229
    v_sub_u32 v170, 0x40800000, v44
    v_cvt_pk_bf16_f32 v125, v228, v229
    v_mfma_f32_16x16x32_bf16 v[226:229], v[218:221], a[192:195], 0
    s_waitcnt lgkmcnt(1)
    v_or_b32 v170, v170, v44
    v_xor_b32 v171, 65536, v2
    v_mfma_f32_16x16x32_bf16 v[226:229], v[230:233], a[196:199], v[226:229]
    v_exp_f32 v198, v198
    v_mfma_f32_16x16x32_bf16 v[226:229], v[162:165], a[200:203], v[226:229]
    v_exp_f32 v199, v199
    v_mfma_f32_16x16x32_bf16 v[226:229], v[166:169], a[204:207], v[226:229]
    v_cvt_pk_bf16_f32 v36, v198, v199
    v_bfe_u32 v173, v193, 1, 2
    v_mfma_f32_16x16x32_bf16 v[226:229], v[186:189], a[208:211], v[226:229]
    s_waitcnt lgkmcnt(0)
    v_exp_f32 v200, v200
    v_mfma_f32_16x16x32_bf16 v[226:229], v[194:197], a[212:215], v[226:229]
    v_exp_f32 v201, v201
    v_mfma_f32_16x16x32_f16 v[162:165], v[146:149], v[114:117], v[58:61]
    v_cvt_pk_bf16_f32 v37, v200, v201
    v_xor_b32 v173, v173, v191
    v_mfma_f32_16x16x32_f16 v[166:169], v[214:217], v[114:117], v[62:65]
    v_exp_f32 v254, v254
    v_mfma_f32_16x16x32_bf16 v[186:189], v[28:31], v[36:39], 0
    v_cvt_pk_bf16_f32 v254, v254, v254
    v_cvt_pk_bf16_f32 v202, v226, v227
    v_mfma_f32_16x16x32_bf16 v[186:189], v[28:31], v[122:125], v[186:189]
    ds_write_b16 v8, v254
    v_mfma_f32_16x16x32_bf16 v[194:197], v[174:177], v[36:39], 0
    v_cvt_pk_bf16_f32 v203, v228, v229
    v_lshl_add_u32 v173, v193, 2, v173
    v_mfma_f32_16x16x32_bf16 v[194:197], v[134:137], v[122:125], v[194:197]
    ds_read_b128 v[198:201], v9
    ds_read_b128 v[218:221], v9 offset:64
    v_mfma_f32_16x16x32_bf16 v[226:229], v[178:181], v[36:39], 0
    v_exp_f32 v156, v156
    v_mfma_f32_16x16x32_bf16 v[226:229], v[150:153], v[122:125], v[226:229]
    v_exp_f32 v172, v172
    v_mfma_f32_16x16x32_bf16 v[230:233], v[202:205], v[36:39], 0
    v_cvt_pk_bf16_f32 v39, v156, 0
    v_lshl_add_u32 v254, v173, 4, s5
    v_mfma_f32_16x16x32_bf16 v[230:233], v[142:145], v[122:125], v[230:233]
    v_rcp_f32 v186, v186
    v_mfma_f32_16x16x32_f16 v[122:125], v[130:133], v[114:117], v[66:69]
    v_max3_u32 v25, v25, v186, v187
    v_mul_f32 v194, v186, v194
    v_mul_f32 v195, v186, v195
    v_mfma_f32_16x16x16_f16 v[162:165], v[120:121], v[206:207], v[162:165]
    v_cvt_pk_bf16_f32 v114, v194, v195
    v_mul_f32 v196, v186, v196
    v_mul_f32 v197, v186, v197
    v_mfma_f32_16x16x16_f16 v[166:169], v[208:209], v[206:207], v[166:169]
    v_cvt_pk_bf16_f32 v115, v196, v197
    v_mul_f32 v226, v186, v226
    v_mul_f32 v227, v186, v227
    v_mfma_f32_16x16x16_f16 v[122:125], v[212:213], v[206:207], v[122:125]
    v_exp_f32 v162, v162
    v_exp_f32 v163, v163
    v_mfma_f32_16x16x32_bf16 v[154:157], a[216:219], v[182:185], 0
    s_waitcnt lgkmcnt(0)
    v_cvt_pk_bf16_f32 v162, v162, v163
    v_cvt_pk_bf16_f32 v116, v226, v227
    v_mfma_f32_16x16x32_bf16 v[154:157], a[220:223], v[222:225], v[154:157]
    v_exp_f32 v164, v164
    v_mfma_f32_16x16x32_bf16 v[154:157], a[224:227], v[234:237], v[154:157]
    v_exp_f32 v165, v165
    v_mfma_f32_16x16x32_bf16 v[154:157], a[228:231], v[238:241], v[154:157]
    v_cvt_pk_bf16_f32 v163, v164, v165
    v_mul_f32 v228, v186, v228
    v_mfma_f32_16x16x32_bf16 v[154:157], a[232:235], v[242:245], v[154:157]
    v_exp_f32 v166, v166
    v_mfma_f32_16x16x32_f16 v[194:197], v[146:149], v[158:161], v[70:73]
    v_exp_f32 v167, v167
    v_mfma_f32_16x16x32_f16 v[146:149], v[214:217], v[158:161], v[74:77]
    v_cvt_pk_bf16_f32 v164, v166, v167
    v_mul_f32 v229, v186, v229
    v_mfma_f32_16x16x32_f16 v[214:217], v[130:133], v[158:161], v[78:81]
    v_exp_f32 v168, v168
    v_cvt_pk_bf16_f32 v117, v228, v229
    v_mfma_f32_16x16x16_f16 v[194:197], v[120:121], v[210:211], v[194:197]
    v_exp_f32 v169, v169
    v_mul_f32 v230, v186, v230
    v_mfma_f32_16x16x16_f16 v[146:149], v[208:209], v[210:211], v[146:149]
    v_cvt_pk_bf16_f32 v165, v168, v169
    v_exp_f32 v122, v122
    v_mfma_f32_16x16x16_f16 v[214:217], v[212:213], v[210:211], v[214:217]
    v_exp_f32 v123, v123
    v_exp_f32 v124, v124
    v_mfma_f32_16x16x32_bf16 v[154:157], a[236:239], v[138:141], v[154:157]
    ds_write_b128 v3, v[114:117] offset:0
    v_mfma_f32_16x16x32_bf16 v[114:117], a[240:243], v[182:185], 0
    v_cvt_pk_bf16_f32 v36, v122, v123
    v_mul_f32 v231, v186, v231
    v_mfma_f32_16x16x32_bf16 v[114:117], a[244:247], v[222:225], v[114:117]
    v_exp_f32 v125, v125
    v_mfma_f32_16x16x32_bf16 v[114:117], a[248:251], v[234:237], v[114:117]
    v_cvt_pk_bf16_f32 v37, v124, v125
    v_fma_f32 v187, v154, v154, s33
    v_mfma_f32_16x16x32_bf16 v[114:117], a[252:255], v[238:241], v[114:117]
    v_fmac_f32 v187, v155, v155
    v_fmac_f32 v187, v156, v156
    v_mfma_f32_16x16x32_bf16 v[118:121], v[28:31], v[36:39], 0
    v_fmac_f32 v187, v157, v157
    v_cvt_pk_bf16_f32 v230, v230, v231
    v_mfma_f32_16x16x32_bf16 v[118:121], v[28:31], v[162:165], v[118:121]
    v_exp_f32 v194, v194
    v_mfma_f32_16x16x32_bf16 v[122:125], v[174:177], v[36:39], 0
    v_exp_f32 v195, v195
    v_mfma_f32_16x16x32_bf16 v[122:125], v[134:137], v[162:165], v[122:125]
    v_cvt_pk_bf16_f32 v130, v194, v195
    v_mul_f32 v232, v186, v232
    v_mfma_f32_16x16x32_bf16 v[158:161], v[178:181], v[36:39], 0
    v_exp_f32 v196, v196
    v_mfma_f32_16x16x32_bf16 v[158:161], v[150:153], v[162:165], v[158:161]
    v_rcp_f32 v118, v118
    v_mfma_f32_16x16x32_bf16 v[166:169], v[202:205], v[36:39], 0
    v_exp_f32 v197, v197
    v_mfma_f32_16x16x32_bf16 v[166:169], v[142:145], v[162:165], v[166:169]
    v_mul_f32 v122, v118, v122
    v_mul_f32 v123, v118, v123
    v_mfma_f32_16x16x32_bf16 v[114:117], v[82:85], v[242:245], v[114:117]
    v_cvt_pk_bf16_f32 v122, v122, v123
    v_mul_f32 v124, v118, v124
    v_mfma_f32_16x16x32_bf16 v[114:117], v[86:89], v[138:141], v[114:117]
    ds_read_b128 v[162:165], v126 offset:0
    v_mul_f32 v125, v118, v125
    v_mfma_f32_16x16x32_bf16 v[206:209], v[90:93], v[182:185], 0
    ds_read_b128 v[182:185], v126 offset:2048
    v_cvt_pk_bf16_f32 v123, v124, v125
    v_mfma_f32_16x16x32_bf16 v[206:209], v[94:97], v[222:225], v[206:209]
    ds_read_b128 v[210:213], v126 offset:4096
    v_mul_f32 v158, v118, v158
    v_mfma_f32_16x16x32_bf16 v[206:209], v[98:101], v[234:237], v[206:209]
    ds_read_b128 v[222:225], v126 offset:6144
    v_fmac_f32 v187, v114, v114
    v_mfma_f32_16x16x32_bf16 v[206:209], v[102:105], v[238:241], v[206:209]
    ds_read_b128 v[226:229], v126 offset:8192
    v_fmac_f32 v187, v115, v115
    v_mfma_f32_16x16x32_bf16 v[206:209], v[106:109], v[242:245], v[206:209]
    ds_read_b128 v[234:237], v126 offset:10240
    v_fmac_f32 v187, v116, v116
    v_mfma_f32_16x16x32_bf16 v[206:209], v[110:113], v[138:141], v[206:209]
    v_fmac_f32 v187, v117, v117
    v_mul_f32 v159, v118, v159
    v_mfma_f32_16x16x32_bf16 v[138:141], v[198:201], v[28:31], 0
    v_cvt_pk_bf16_f32 v124, v158, v159
    v_mul_f32 v160, v118, v160
    v_mfma_f32_16x16x32_bf16 v[138:141], v[218:221], v[28:31], v[138:141]
    s_waitcnt lgkmcnt(5)
    v_mul_f32 v161, v118, v161
    v_fmac_f32 v187, v206, v206
    v_mfma_f32_16x16x32_bf16 v[238:241], a[216:219], v[162:165], 0
    s_waitcnt lgkmcnt(4)
    v_fmac_f32 v187, v207, v207
    v_fmac_f32 v187, v208, v208
    v_mfma_f32_16x16x32_bf16 v[238:241], a[220:223], v[182:185], v[238:241]
    s_waitcnt lgkmcnt(3)
    v_fmac_f32 v187, v209, v209
    v_cvt_pk_bf16_f32 v125, v160, v161
    v_mfma_f32_16x16x32_bf16 v[238:241], a[224:227], v[210:213], v[238:241]
    s_waitcnt lgkmcnt(2)
    ds_write_b128 v3, v[122:125] offset:6144
    v_mfma_f32_16x16x32_bf16 v[238:241], a[228:231], v[222:225], v[238:241]
    s_waitcnt lgkmcnt(1)
    v_mul_f32 v166, v118, v166
    v_mul_f32 v167, v118, v167
    v_mfma_f32_16x16x32_bf16 v[238:241], a[232:235], v[226:229], v[238:241]
    v_cvt_pk_bf16_f32 v120, v166, v167
    v_mul_f32 v168, v118, v168
    v_mfma_f32_16x16x32_bf16 v[238:241], a[236:239], v[234:237], v[238:241]
    v_mul_f32 v169, v118, v169
    v_cvt_pk_bf16_f32 v121, v168, v169
    v_mfma_f32_16x16x32_bf16 v[122:125], a[240:243], v[162:165], 0
    ds_write_b64 v4, v[120:121] offset:10240
    v_mfma_f32_16x16x32_bf16 v[122:125], a[244:247], v[182:185], v[122:125]
    v_rcp_f32 v138, v138
    v_mfma_f32_16x16x32_bf16 v[122:125], a[248:251], v[210:213], v[122:125]
    v_max3_u32 v25, v25, v138, v139
    v_fma_f32 v188, v238, v238, s33
    v_mfma_f32_16x16x32_bf16 v[122:125], a[252:255], v[222:225], v[122:125]
    v_fmac_f32 v188, v239, v239
    v_fmac_f32 v188, v240, v240
    v_mfma_f32_16x16x32_bf16 v[122:125], v[82:85], v[226:229], v[122:125]
    v_fmac_f32 v188, v241, v241
    v_max3_u32 v25, v25, v118, v119
    v_mfma_f32_16x16x32_bf16 v[122:125], v[86:89], v[234:237], v[122:125]
    v_cvt_pk_bf16_f32 v131, v196, v197
    v_cvt_pk_bf16_f32 v39, v172, 0
    v_mfma_f32_16x16x32_bf16 v[118:121], v[90:93], v[162:165], 0
    v_exp_f32 v146, v146
    v_mfma_f32_16x16x32_bf16 v[118:121], v[94:97], v[182:185], v[118:121]
    v_exp_f32 v147, v147
    v_mfma_f32_16x16x32_bf16 v[118:121], v[98:101], v[210:213], v[118:121]
    v_cvt_pk_bf16_f32 v132, v146, v147
    v_fmac_f32 v188, v122, v122
    v_mfma_f32_16x16x32_bf16 v[118:121], v[102:105], v[222:225], v[118:121]
    v_fmac_f32 v188, v123, v123
    v_fmac_f32 v188, v124, v124
    v_mfma_f32_16x16x32_bf16 v[118:121], v[106:109], v[226:229], v[118:121]
    v_fmac_f32 v188, v125, v125
    v_mul_f32 v233, v186, v233
    v_mfma_f32_16x16x32_bf16 v[118:121], v[110:113], v[234:237], v[118:121]
    v_exp_f32 v148, v148
    v_mfma_f32_16x16x32_bf16 v[158:161], v[198:201], v[134:137], 0
    v_exp_f32 v149, v149
    v_mfma_f32_16x16x32_bf16 v[158:161], v[218:221], v[174:177], v[158:161]
    v_cvt_pk_bf16_f32 v133, v148, v149
    v_cvt_pk_bf16_f32 v231, v232, v233
    v_mfma_f32_16x16x32_bf16 v[146:149], v[198:201], v[150:153], 0
    ds_write_b64 v4, v[230:231] offset:4096
    v_mfma_f32_16x16x32_bf16 v[146:149], v[218:221], v[178:181], v[146:149]
    v_fmac_f32 v188, v118, v118
    v_fmac_f32 v188, v119, v119
    v_mfma_f32_16x16x32_bf16 v[162:165], v[198:201], v[142:145], 0
    v_fmac_f32 v188, v120, v120
    v_fmac_f32 v188, v121, v121
    v_mfma_f32_16x16x32_bf16 v[162:165], v[218:221], v[202:205], v[162:165]
    v_cvt_pk_bf16_f32 v140, v187, v188
    v_cvt_pk_bf16_f32 v141, v188, v188
    ds_write_b64 v128, v[140:141] offset:2048
    v_mul_f32 v158, v158, v138
    v_exp_f32 v214, v214
    v_exp_f32 v215, v215
    v_mul_f32_dpp v158, v146, v138 quad_perm:[0,1,2,3] row_mask:0x2 bank_mask:0xf
    v_cvt_pk_bf16_f32 v36, v214, v215
    v_exp_f32 v216, v216
    v_mul_f32_dpp v158, v162, v138 quad_perm:[0,1,2,3] row_mask:0x4 bank_mask:0xf
    v_cvt_pk_bf16_f32 v158, v158, v158
    ds_write_b16 v7, v158
    v_exp_f32 v217, v217
    v_lshl_add_u32 v172, v173, 3, s5
    v_cvt_pk_bf16_f32 v37, v216, v217
    v_lshl_add_u32 v138, v190, 4, s5
    v_lshl_add_u32 v139, v190, 3, s5
    v_mfma_f32_16x16x32_bf16 v[146:149], v[28:31], v[36:39], 0
    v_lshlrev_b32 v173, 2, v173
    v_add_u32 v140, 16, v193
    v_mfma_f32_16x16x32_bf16 v[146:149], v[28:31], v[130:133], v[146:149]
    s_waitcnt lgkmcnt(1)
    ds_permute_b32 v141, v173, v16
    ds_permute_b32 v190, v173, v19
    v_mfma_f32_16x16x32_bf16 v[158:161], v[174:177], v[36:39], 0
    s_barrier
    ds_read_b128 v[162:165], v127 offset:2048
    ds_read_b128 v[166:169], v127 offset:3072
    v_mfma_f32_16x16x32_bf16 v[158:161], v[134:137], v[130:133], v[158:161]
    ds_read_b128 v[134:137], v171 offset:0
    ds_read_b128 v[174:177], v171 offset:1024
    v_mfma_f32_16x16x32_bf16 v[182:185], v[178:181], v[36:39], 0
    v_rcp_f32 v146, v146
    v_mfma_f32_16x16x32_bf16 v[182:185], v[150:153], v[130:133], v[182:185]
    ds_read_b128 v[150:153], v171 offset:2048
    ds_read_b128 v[178:181], v171 offset:3072
    v_mfma_f32_16x16x32_bf16 v[186:189], v[202:205], v[36:39], 0
    v_max3_u32 v25, v25, v146, v147
    v_sub_u32 v193, 0x67800000, v25
    v_mfma_f32_16x16x32_bf16 v[186:189], v[142:145], v[130:133], v[186:189]
    ds_read_b128 v[130:133], v171 offset:4096
    ds_read_b128 v[142:145], v171 offset:5120
    v_or3_b32 v170, v170, v193, v25
    v_lshl_add_u32 v193, s16, 2, v171
    ds_write_b32 v193, v170 offset:18432
    s_waitcnt lgkmcnt(8)
    v_mfma_f32_16x16x32_bf16 v[194:197], v[32:35], v[162:165], 0
    s_waitcnt lgkmcnt(7)
    v_mul_f32 v158, v146, v158
    v_mul_f32 v159, v146, v159
    v_mfma_f32_16x16x32_bf16 v[194:197], v[32:35], v[166:169], v[194:197]
    s_waitcnt lgkmcnt(5)
    ds_permute_b32 v170, v173, v17
    ds_permute_b32 v193, v173, v20
    v_mfma_f32_16x16x32_bf16 v[162:165], a[216:219], v[134:137], 0
    v_cvt_pk_bf16_f32 v158, v158, v159
    v_mul_f32 v160, v146, v160
    v_mfma_f32_16x16x32_bf16 v[162:165], a[220:223], v[174:177], v[162:165]
    s_waitcnt lgkmcnt(5)
    v_mul_f32 v159, 0x3baaaaab, v195
    v_mul_f32 v161, v146, v161
    v_mfma_f32_16x16x32_bf16 v[162:165], a[224:227], v[150:153], v[162:165]
    v_rsq_f32 v159, v159
    v_mfma_f32_16x16x32_bf16 v[162:165], a[228:231], v[178:181], v[162:165]
    s_waitcnt lgkmcnt(3)
    v_mul_f32 v238, v159, v238
    v_mul_f32 v239, v159, v239
    v_mfma_f32_16x16x32_bf16 v[162:165], a[232:235], v[130:133], v[162:165]
    v_cvt_pk_bf16_f32 v166, v238, v239
    v_mul_f32 v240, v159, v240
    v_mfma_f32_16x16x32_bf16 v[162:165], a[236:239], v[142:145], v[162:165]
    v_mul_f32 v241, v159, v241
    v_cvt_pk_bf16_f32 v167, v240, v241
    v_mfma_f32_16x16x32_bf16 v[198:201], a[240:243], v[134:137], 0
    v_mul_f32 v122, v159, v122
    v_mul_f32 v123, v159, v123
    v_mfma_f32_16x16x32_bf16 v[198:201], a[244:247], v[174:177], v[198:201]
    s_waitcnt lgkmcnt(0)
    v_cvt_pk_bf16_f32 v168, v122, v123
    v_mul_f32 v124, v159, v124
    v_mfma_f32_16x16x32_bf16 v[198:201], a[248:251], v[150:153], v[198:201]
    v_mul_f32 v125, v159, v125
    v_cvt_pk_bf16_f32 v169, v124, v125
    v_mfma_f32_16x16x32_bf16 v[198:201], a[252:255], v[178:181], v[198:201]
    buffer_store_dwordx4 v[166:169], v255, s[12:15], 0 offen nt
    v_mul_f32 v118, v159, v118
    v_mul_f32 v119, v159, v119
    v_cvt_pk_bf16_f32 v148, v118, v119
    v_mul_f32 v120, v159, v120
    v_mfma_f32_16x16x32_bf16 v[198:201], v[82:85], v[130:133], v[198:201]
    v_mul_f32 v121, v159, v121
    v_cvt_pk_bf16_f32 v149, v120, v121
    v_mfma_f32_16x16x32_bf16 v[198:201], v[86:89], v[142:145], v[198:201]
    ds_read_b128 v[118:121], v171 offset:6144
    v_fma_f32 v173, v162, v162, s33
    v_mfma_f32_16x16x32_bf16 v[122:125], v[90:93], v[134:137], 0
    ds_read_b128 v[134:137], v171 offset:7168
    v_fmac_f32 v173, v163, v163
    v_mfma_f32_16x16x32_bf16 v[122:125], v[94:97], v[174:177], v[122:125]
    ds_read_b128 v[166:169], v171 offset:8192
    v_fmac_f32 v173, v164, v164
    v_mfma_f32_16x16x32_bf16 v[122:125], v[98:101], v[150:153], v[122:125]
    ds_read_b128 v[150:153], v171 offset:9216
    v_fmac_f32 v173, v165, v165
    v_mfma_f32_16x16x32_bf16 v[122:125], v[102:105], v[178:181], v[122:125]
    ds_read_b128 v[174:177], v171 offset:10240
    v_fmac_f32 v173, v198, v198
    v_mfma_f32_16x16x32_bf16 v[122:125], v[106:109], v[130:133], v[122:125]
    ds_read_b128 v[130:133], v171 offset:11264
    v_fmac_f32 v173, v199, v199
    v_mfma_f32_16x16x32_bf16 v[122:125], v[110:113], v[142:145], v[122:125]
    v_fmac_f32 v173, v200, v200
    v_fmac_f32 v173, v201, v201
    v_cvt_pk_bf16_f32 v159, v160, v161
    v_mul_f32 v182, v146, v182
    s_waitcnt lgkmcnt(5)
    v_mfma_f32_16x16x32_bf16 v[142:145], a[216:219], v[118:121], 0
    v_mul_f32 v183, v146, v183
    v_cvt_pk_bf16_f32 v160, v182, v183
    v_mfma_f32_16x16x32_bf16 v[178:181], a[240:243], v[118:121], 0
    s_waitcnt lgkmcnt(4)
    v_fmac_f32 v173, v122, v122
    v_fmac_f32 v173, v123, v123
    v_mfma_f32_16x16x32_bf16 v[142:145], a[220:223], v[134:137], v[142:145]
    s_waitcnt lgkmcnt(3)
    v_fmac_f32 v173, v124, v124
    v_fmac_f32 v173, v125, v125
    v_mfma_f32_16x16x32_bf16 v[142:145], a[224:227], v[166:169], v[142:145]
    s_waitcnt lgkmcnt(2)
    v_mul_f32 v184, v146, v184
    v_mul_f32 v185, v146, v185
    v_mfma_f32_16x16x32_bf16 v[142:145], a[228:231], v[150:153], v[142:145]
    s_waitcnt lgkmcnt(1)
    v_cvt_pk_bf16_f32 v161, v184, v185
    v_mul_f32 v186, v146, v186
    v_mfma_f32_16x16x32_bf16 v[142:145], a[232:235], v[174:177], v[142:145]
    s_waitcnt lgkmcnt(0)
    ds_write_b128 v3, v[158:161] offset:12288
    v_mfma_f32_16x16x32_bf16 v[142:145], a[236:239], v[130:133], v[142:145]
    buffer_store_dwordx2 v[148:149], v192, s[12:15], 0 offen nt
    v_mul_f32 v187, v146, v187
    v_cvt_pk_bf16_f32 v186, v186, v187
    v_mfma_f32_16x16x32_bf16 v[178:181], a[244:247], v[134:137], v[178:181]
    v_mul_f32 v188, v146, v188
    v_mul_f32 v189, v146, v189
    v_mfma_f32_16x16x32_bf16 v[178:181], a[248:251], v[166:169], v[178:181]
    v_cvt_pk_bf16_f32 v187, v188, v189
    v_fma_f32 v192, v142, v142, s33
    v_mfma_f32_16x16x32_bf16 v[178:181], a[252:255], v[150:153], v[178:181]
    ds_write_b64 v4, v[186:187] offset:16384
    v_mfma_f32_16x16x32_bf16 v[178:181], v[82:85], v[174:177], v[178:181]
    v_fmac_f32 v192, v143, v143
    v_fmac_f32 v192, v144, v144
    v_mfma_f32_16x16x32_bf16 v[178:181], v[86:89], v[130:133], v[178:181]
    v_fmac_f32 v192, v145, v145
    v_mul_f32 v255, 0x3baaaaab, v194
    v_mfma_f32_16x16x32_bf16 v[146:149], v[90:93], v[118:121], 0
    v_rsq_f32 v255, v255
    v_mfma_f32_16x16x32_bf16 v[146:149], v[94:97], v[134:137], v[146:149]
    v_mul_f32 v154, v255, v154
    v_mul_f32 v155, v255, v155
    v_mfma_f32_16x16x32_bf16 v[146:149], v[98:101], v[166:169], v[146:149]
    v_fmac_f32 v192, v178, v178
    v_fmac_f32 v192, v179, v179
    v_mfma_f32_16x16x32_bf16 v[146:149], v[102:105], v[150:153], v[146:149]
    v_fmac_f32 v192, v180, v180
    v_fmac_f32 v192, v181, v181
    v_mfma_f32_16x16x32_bf16 v[146:149], v[106:109], v[174:177], v[146:149]
    v_cvt_pk_bf16_f32 v118, v154, v155
    v_mul_f32 v156, v255, v156
    v_mfma_f32_16x16x32_bf16 v[146:149], v[110:113], v[130:133], v[146:149]
    v_mul_f32 v157, v255, v157
    v_cvt_pk_bf16_f32 v119, v156, v157
    v_mul_f32 v114, v255, v114
    v_mul_f32 v115, v255, v115
    v_cvt_pk_bf16_f32 v120, v114, v115
    v_mul_f32 v116, v255, v116
    v_mul_f32 v117, v255, v117
    v_cvt_pk_bf16_f32 v121, v116, v117
    v_fmac_f32 v192, v146, v146
    v_fmac_f32 v192, v147, v147
    v_fmac_f32 v192, v148, v148
    v_fmac_f32 v192, v149, v149
    v_cvt_pk_bf16_f32 v114, v173, v192
    v_cvt_pk_bf16_f32 v115, v192, v192
    ds_write_b64 v128, v[114:115] offset:7616
    buffer_store_dwordx4 v[118:121], v17, s[52:55], 0 offen nt
    v_mul_f32 v206, v255, v206
    v_mul_f32 v207, v255, v207
    v_cvt_pk_bf16_f32 v206, v206, v207
    v_mul_f32 v208, v255, v208
    v_mul_f32 v209, v255, v209
    v_cvt_pk_bf16_f32 v207, v208, v209
    v_min_u32 v173, 20, v140
    v_add_u32 v192, 12, v140
    v_lshrrev_b32 v192, 5, v192
    v_sub_u32 v255, v140, v173
    v_mad_i32_i24 v255, v192, s6, v255
    v_mul_u32_u24 v208, s20, v173
    v_add3_u32 v208, v208, v255, s38
    v_mul_u32_u24 v192, 911, v208
    v_lshrrev_b32 v192, 16, v192
    v_mul_u32_u24 v192, s22, v192
    v_mad_u32_u24 v192, v173, s21, v192
    v_bfe_u32 v208, s70, v140, 1
    v_cmp_ne_u32 vcc, 0, v208
    v_mul_i32_i24 v255, 2688, v255
    v_add3_u32 v140, v192, v255, s7
    v_cndmask_b32 v140, v129, v140, vcc
    v_lshl_add_u32 v255, v191, 4, v140
    v_add_u32 v255, s3, v255
    s_waitcnt lgkmcnt(0)
    s_barrier
    ds_read_b128 v[114:117], v127 offset:7616
    ds_read_b128 v[118:121], v127 offset:8640
    ds_read_b128 v[130:133], v171 offset:12288
    ds_read_b128 v[134:137], v171 offset:13312
    ds_read_b128 v[150:153], v171 offset:14336
    ds_read_b128 v[154:157], v171 offset:15360
    ds_read_b128 v[158:161], v171 offset:16384
    ds_read_b128 v[166:169], v171 offset:17408
    v_lshl_add_u32 v173, v191, 3, v140
    v_add_u32 v173, s4, v173
    s_waitcnt lgkmcnt(7)
    v_mfma_f32_16x16x32_bf16 v[174:177], v[32:35], v[114:117], 0
    s_waitcnt lgkmcnt(6)
    v_mfma_f32_16x16x32_bf16 v[174:177], v[32:35], v[118:121], v[174:177]
    s_waitcnt lgkmcnt(4)
    v_mfma_f32_16x16x32_bf16 v[114:117], a[216:219], v[130:133], 0
    s_waitcnt lgkmcnt(3)
    buffer_store_dwordx2 v[206:207], v20, s[52:55], 0 offen nt
    v_mfma_f32_16x16x32_bf16 v[114:117], a[220:223], v[134:137], v[114:117]
    s_waitcnt lgkmcnt(2)
    v_mfma_f32_16x16x32_bf16 v[114:117], a[224:227], v[150:153], v[114:117]
    s_waitcnt lgkmcnt(1)
    v_mul_f32 v140, 0x3baaaaab, v174
    v_mul_f32 v129, 0x3baaaaab, v175
    v_mfma_f32_16x16x32_bf16 v[114:117], a[228:231], v[154:157], v[114:117]
    s_waitcnt lgkmcnt(0)
    v_rsq_f32 v140, v140
    v_mfma_f32_16x16x32_bf16 v[114:117], a[232:235], v[158:161], v[114:117]
    v_mul_f32 v162, v140, v162
    v_mul_f32 v163, v140, v163
    v_mfma_f32_16x16x32_bf16 v[114:117], a[236:239], v[166:169], v[114:117]
    v_cvt_pk_bf16_f32 v118, v162, v163
    v_mul_f32 v164, v140, v164
    v_mfma_f32_16x16x32_bf16 v[174:177], a[240:243], v[130:133], 0
    v_mul_f32 v165, v140, v165
    v_cvt_pk_bf16_f32 v119, v164, v165
    v_mfma_f32_16x16x32_bf16 v[174:177], a[244:247], v[134:137], v[174:177]
    v_mul_f32 v198, v140, v198
    v_mul_f32 v199, v140, v199
    v_mfma_f32_16x16x32_bf16 v[174:177], a[248:251], v[150:153], v[174:177]
    v_fma_f32 v191, v114, v114, s33
    v_fmac_f32 v191, v115, v115
    v_mfma_f32_16x16x32_bf16 v[174:177], a[252:255], v[154:157], v[174:177]
    v_fmac_f32 v191, v116, v116
    v_fmac_f32 v191, v117, v117
    v_mfma_f32_16x16x32_bf16 v[174:177], v[82:85], v[158:161], v[174:177]
    v_cvt_pk_bf16_f32 v120, v198, v199
    v_mul_f32 v200, v140, v200
    v_mfma_f32_16x16x32_bf16 v[174:177], v[86:89], v[166:169], v[174:177]
    ds_read_b128 v[162:165], v126 offset:256
    v_mul_f32 v201, v140, v201
    v_mfma_f32_16x16x32_bf16 v[182:185], v[90:93], v[130:133], 0
    ds_read_b128 v[130:133], v126 offset:2304
    v_cvt_pk_bf16_f32 v121, v200, v201
    v_mfma_f32_16x16x32_bf16 v[182:185], v[94:97], v[134:137], v[182:185]
    ds_read_b128 v[134:137], v126 offset:4352
    v_mul_f32 v122, v140, v122
    v_mfma_f32_16x16x32_bf16 v[182:185], v[98:101], v[150:153], v[182:185]
    ds_read_b128 v[150:153], v126 offset:6400
    v_fmac_f32 v191, v174, v174
    v_mfma_f32_16x16x32_bf16 v[182:185], v[102:105], v[154:157], v[182:185]
    ds_read_b128 v[154:157], v126 offset:8448
    v_fmac_f32 v191, v175, v175
    v_mfma_f32_16x16x32_bf16 v[182:185], v[106:109], v[158:161], v[182:185]
    ds_read_b128 v[158:161], v126 offset:10496
    buffer_store_dwordx4 v[118:121], v15, s[56:59], 0 offen nt
    v_fmac_f32 v191, v176, v176
    v_fmac_f32 v191, v177, v177
    v_mul_f32 v123, v140, v123
    v_cvt_pk_bf16_f32 v122, v122, v123
    v_mfma_f32_16x16x32_bf16 v[182:185], v[110:113], v[166:169], v[182:185]
    v_mul_f32 v124, v140, v124
    s_waitcnt lgkmcnt(5)
    v_mfma_f32_16x16x32_bf16 v[118:121], a[216:219], v[162:165], 0
    v_mul_f32 v125, v140, v125
    v_cvt_pk_bf16_f32 v123, v124, v125
    v_mfma_f32_16x16x32_bf16 v[166:169], a[240:243], v[162:165], 0
    s_waitcnt lgkmcnt(4)
    v_rsq_f32 v129, v129
    v_mfma_f32_16x16x32_bf16 v[118:121], a[220:223], v[130:133], v[118:121]
    s_waitcnt lgkmcnt(3)
    v_fmac_f32 v191, v182, v182
    v_fmac_f32 v191, v183, v183
    v_mfma_f32_16x16x32_bf16 v[118:121], a[224:227], v[134:137], v[118:121]
    s_waitcnt lgkmcnt(2)
    v_fmac_f32 v191, v184, v184
    v_fmac_f32 v191, v185, v185
    v_mfma_f32_16x16x32_bf16 v[118:121], a[228:231], v[150:153], v[118:121]
    s_waitcnt lgkmcnt(1)
    v_cvt_pk_bf16_f32 v124, v191, v191
    v_cvt_pk_bf16_f32 v125, v191, v191
    v_mfma_f32_16x16x32_bf16 v[118:121], a[232:235], v[154:157], v[118:121]
    s_waitcnt lgkmcnt(0)
    ds_write_b64 v128, v[124:125] offset:9664
    v_mfma_f32_16x16x32_bf16 v[118:121], a[236:239], v[158:161], v[118:121]
    v_mul_f32 v142, v129, v142
    v_mul_f32 v143, v129, v143
    v_mfma_f32_16x16x32_bf16 v[166:169], a[244:247], v[130:133], v[166:169]
    v_cvt_pk_bf16_f32 v142, v142, v143
    v_mul_f32 v144, v129, v144
    v_mfma_f32_16x16x32_bf16 v[166:169], a[248:251], v[134:137], v[166:169]
    v_mul_f32 v145, v129, v145
    v_cvt_pk_bf16_f32 v143, v144, v145
    v_mfma_f32_16x16x32_bf16 v[166:169], a[252:255], v[150:153], v[166:169]
    v_fma_f32 v140, v118, v118, s33
    v_fmac_f32 v140, v119, v119
    v_mfma_f32_16x16x32_bf16 v[166:169], v[82:85], v[154:157], v[166:169]
    v_fmac_f32 v140, v120, v120
    v_fmac_f32 v140, v121, v121
    v_mfma_f32_16x16x32_bf16 v[166:169], v[86:89], v[158:161], v[166:169]
    v_mul_f32 v178, v129, v178
    v_mul_f32 v179, v129, v179
    v_mfma_f32_16x16x32_bf16 v[186:189], v[90:93], v[162:165], 0
    v_cvt_pk_bf16_f32 v144, v178, v179
    v_mul_f32 v180, v129, v180
    v_mfma_f32_16x16x32_bf16 v[186:189], v[94:97], v[130:133], v[186:189]
    buffer_store_dwordx2 v[122:123], v18, s[56:59], 0 offen nt
    v_mul_f32 v181, v129, v181
    v_fmac_f32 v140, v166, v166
    v_mfma_f32_16x16x32_bf16 v[186:189], v[98:101], v[134:137], v[186:189]
    v_fmac_f32 v140, v167, v167
    v_fmac_f32 v140, v168, v168
    v_mfma_f32_16x16x32_bf16 v[186:189], v[102:105], v[150:153], v[186:189]
    v_fmac_f32 v140, v169, v169
    v_cvt_pk_bf16_f32 v145, v180, v181
    v_mfma_f32_16x16x32_bf16 v[186:189], v[106:109], v[154:157], v[186:189]
    ds_write_b128 v254, v[142:145] offset:1536
    v_mfma_f32_16x16x32_bf16 v[186:189], v[110:113], v[158:161], v[186:189]
    v_mul_f32 v146, v129, v146
    v_mul_f32 v147, v129, v147
    v_cvt_pk_bf16_f32 v146, v146, v147
    v_mul_f32 v148, v129, v148
    v_mul_f32 v149, v129, v149
    ds_read_b128 v[122:125], v138 offset:1536
    v_cvt_pk_bf16_f32 v147, v148, v149
    ds_write_b64 v172, v[146:147] offset:2560
    v_fmac_f32 v140, v186, v186
    v_fmac_f32 v140, v187, v187
    v_fmac_f32 v140, v188, v188
    v_fmac_f32 v140, v189, v189
    v_cvt_pk_bf16_f32 v130, v140, v140
    v_cvt_pk_bf16_f32 v131, v140, v140
    ds_write_b64 v128, v[130:131] offset:15232
    ds_read_b64 v[128:129], v139 offset:2560
    s_waitcnt lgkmcnt(3)
    buffer_store_dwordx4 v[122:125], v141, s[56:59], 0 offen nt
    s_waitcnt lgkmcnt(1)
    s_barrier
    ds_read_b128 v[130:133], v127 offset:9664
    ds_read_b128 v[122:125], v127 offset:10688
    ds_read_b128 v[134:137], v127 offset:15232
    ds_read_b128 v[142:145], v127 offset:16256
    ds_read_b128 v[146:149], v171 offset:18432
    s_waitcnt lgkmcnt(5)
    buffer_store_dwordx2 v[128:129], v190, s[56:59], 0 offen nt
    s_waitcnt lgkmcnt(4)
    v_mfma_f32_16x16x32_bf16 v[150:153], v[32:35], v[130:133], 0
    s_waitcnt lgkmcnt(3)
    v_mfma_f32_16x16x32_bf16 v[150:153], v[32:35], v[122:125], v[150:153]
    s_waitcnt lgkmcnt(1)
    v_mfma_f32_16x16x32_bf16 v[122:125], v[32:35], v[134:137], 0
    s_waitcnt lgkmcnt(0)
    v_or3_b32 v146, v146, v147, v148
    v_or_b32 v146, v146, v149
    v_mfma_f32_16x16x32_bf16 v[122:125], v[32:35], v[142:145], v[122:125]
    v_cmp_gt_i32 s[46:47], 0, v146
    s_nop 0
    v_mul_f32 v171, 0x3baaaaab, v150
    v_rsq_f32 v171, v171
    s_nop 0
    v_mul_f32 v114, v171, v114
    v_mul_f32 v115, v171, v115
    v_cvt_pk_bf16_f32 v114, v114, v115
    v_mul_f32 v115, 0x3baaaaab, v122
    v_rsq_f32 v115, v115
    v_mul_f32 v116, v171, v116
    v_mul_f32 v118, v115, v118
    v_mul_f32 v119, v115, v119
    v_cvt_pk_bf16_f32 v118, v118, v119
    v_mul_f32 v120, v115, v120
    v_mul_f32 v121, v115, v121
    v_cvt_pk_bf16_f32 v119, v120, v121
    v_mul_f32 v166, v115, v166
    v_mul_f32 v167, v115, v167
    v_cvt_pk_bf16_f32 v120, v166, v167
    v_mul_f32 v168, v115, v168
    v_mul_f32 v169, v115, v169
    v_cvt_pk_bf16_f32 v121, v168, v169
    buffer_store_dwordx4 v[118:121], v255, s[12:15], 0 offen nt
    v_mul_f32 v186, v115, v186
    v_mul_f32 v187, v115, v187
    v_cvt_pk_bf16_f32 v140, v186, v187
    v_mul_f32 v188, v115, v188
    v_mul_f32 v189, v115, v189
    v_cvt_pk_bf16_f32 v141, v188, v189
    v_mul_f32 v117, v171, v117
    v_cvt_pk_bf16_f32 v115, v116, v117
    v_mul_f32 v174, v171, v174
    v_mul_f32 v175, v171, v175
    v_cvt_pk_bf16_f32 v116, v174, v175
    v_mul_f32 v176, v171, v176
    v_mul_f32 v177, v171, v177
    v_cvt_pk_bf16_f32 v117, v176, v177
    ds_write_b128 v254, v[114:117] offset:3072
    v_mul_f32 v182, v171, v182
    v_mul_f32 v183, v171, v183
    v_cvt_pk_bf16_f32 v254, v182, v183
    v_mul_f32 v184, v171, v184
    v_mul_f32 v185, v171, v185
    v_cvt_pk_bf16_f32 v255, v184, v185
    buffer_store_dwordx2 v[140:141], v173, s[12:15], 0 offen nt
    ds_read_b128 v[114:117], v138 offset:3072
    ds_write_b64 v172, v[254:255] offset:4096
    ds_read_b64 v[254:255], v139 offset:4096
    s_waitcnt lgkmcnt(2)
    buffer_store_dwordx4 v[114:117], v170, s[56:59], 0 offen nt
    s_waitcnt lgkmcnt(0)
    buffer_store_dwordx2 v[254:255], v193, s[56:59], 0 offen nt
L_end:
    s_nop 1
    s_cmp_lg_u64 s[46:47], 0
    s_cbranch_scc1 L_rerun
L_done:
    s_endpgm
L_rerun:
    s_mov_b32 s44, 0x7f000000
    s_lshr_b32 s100, s70, 20
    s_waitcnt vmcnt(0) lgkmcnt(0)
    s_barrier
    v_mbcnt_lo_u32_b32 v0, -1, 0
    v_mbcnt_hi_u32_b32 v0, -1, v0
    v_lshl_add_u32 v0, s16, 6, v0
    s_nop 7
    s_branch L_again
L_edge:
    v_mov_b32 v254, v0
    v_mov_b32 v255, 0x40000000
    s_lshl_b32 s3, s16, 4
    s_load_dwordx4 s[92:95], s[0:1], s3
    v_and_b32 v114, 63, v0
    s_bfe_u32 s3, s2, 0x50003
    s_lshl_b32 s4, s16, 3
    s_lshr_b32 s98, 0x06143a01, s4
    s_and_b32 s98, s98, 0xff
    s_mul_i32 s3, s3, s98
    s_sub_u32 s98, s98, 1
    s_lshr_b32 s4, 0x0048d800, s4
    s_and_b32 s4, s4, 0xff
    s_lshl_b32 s4, s4, 3
    s_max_u32 s4, s4, 6
    s_sub_u32 s4, s4, s98
    s_sub_u32 s4, s4, 1
    s_min_u32 s3, s3, s4
    v_min_u32 v116, s98, v114
    v_add_lshl_u32 v116, v116, s3, 7
    v_mov_b32 v117, 0
    v_lshrrev_b32 v115, 4, v114
    v_and_b32 v118, 15, v114
    s_mov_b32 s10, 100270464
    s_mov_b32 s11, 0x00020000
    s_mov_b32 s50, 36096
    s_mov_b32 s51, 0x00020000
    s_mul_i32 s3, s16, 96
    v_lshl_add_u32 v119, v114, 4, s3
    v_mul_u32_u24 v120, 171, v114
    v_lshrrev_b32 v120, 10, v120
    v_lshrrev_b32 v121, 1, v120
    v_xor_b32 v121, v121, v120
    v_and_b32 v121, 4, v121
    v_mul_u32_u24 v121, 3, v121
    v_xor_b32 v121, v121, v120
    v_mul_u32_u24 v121, 1152, v121
    v_mul_u32_u24 v126, 96, v120
    v_sub_u32 v121, v121, v126
    v_add_u32 v126, v119, v121
    v_add_u32 v121, 64, v114
    v_mul_u32_u24 v121, 171, v121
    v_lshrrev_b32 v121, 10, v121
    v_lshrrev_b32 v127, 1, v121
    v_xor_b32 v127, v127, v121
    v_and_b32 v127, 4, v127
    v_mul_u32_u24 v127, 3, v127
    v_xor_b32 v127, v127, v121
    v_mul_u32_u24 v127, 1152, v127
    v_mul_u32_u24 v128, 96, v121
    v_sub_u32 v127, v127, v128
    v_add_u32 v128, v119, v127
    v_add_u32 v127, 128, v114
    v_mul_u32_u24 v127, 171, v127
    v_lshrrev_b32 v127, 10, v127
    v_lshrrev_b32 v129, 1, v127
    v_xor_b32 v129, v129, v127
    v_and_b32 v129, 4, v129
    v_mul_u32_u24 v129, 3, v129
    v_xor_b32 v129, v129, v127
    v_mul_u32_u24 v129, 1152, v129
    v_mul_u32_u24 v130, 96, v127
    v_sub_u32 v129, v129, v130
    v_add_u32 v130, v119, v129
    s_mul_i32 s68, s16, 6144
    s_add_u32 s69, s68, 65536
    s_cmp_eq_u32 s16, 3
    s_cselect_b32 s68, 149696, s68
    s_cselect_b32 s69, 155840, s69
    s_mov_b32 s70, 193536
    s_mov_b32 s36, 100270464
    s_mov_b32 s22, 1180032
    s_mul_i32 s3, s2, 911
    s_lshr_b32 s3, s3, 16
    s_mul_i32 s35, s3, 72
    s_sub_u32 s38, s2, s35
    s_mul_i32 s3, s3, 1373568
    s_mul_i32 s35, s38, 2688
    s_add_u32 s3, s3, s35
    s_add_u32 s25, s3, 589824
    s_add_u32 s7, s3, 1769472
    s_mov_b32 s20, 31
    s_mov_b32 s21, 4204032
    s_mov_b32 s17, 20
    s_cmp_lt_u32 s2, 240
    s_cselect_b32 s45, 28, 24
    s_mov_b32 s5, 0
    s_mov_b32 s6, 0
    s_cmp_lt_u32 s2, 247
    s_cbranch_scc1 L_inner
    s_mov_b32 s20, 0
    s_mov_b32 s38, 0
    s_sub_u32 s3, s2, 247
    s_and_b32 s3, s3, 3
    s_mul_i32 s3, s3, 7
    s_add_u32 s3, s3, 3
    s_mov_b32 s35, 196224
    s_cmp_lt_u32 s2, 251
    s_cselect_b32 s35, s35, 384
    s_cselect_b32 s6, 1, 0
    s_cselect_b32 s5, 0, 1
    s_mul_i32 s25, s3, s35
    s_mul_i32 s21, s35, 28
    s_cmp_lt_u32 s2, 255
    s_cselect_b32 s17, 18, 1
    s_cselect_b32 s45, 18, 1
    s_cselect_b32 s25, s25, 0
    s_cselect_b32 s6, s6, 1
    s_add_u32 s7, s25, 1179648
L_inner:
    s_mul_i32 s3, s5, 99485568
    s_mul_i32 s35, s5, -784896
    v_mov_b32 v119, s3
    v_mov_b32 v129, s35
    s_add_u32 s7, s7, s35
    s_mul_i32 s3, s6, 194688
    s_mul_i32 s35, s6, -1536
    v_mov_b32 v131, s3
    v_mov_b32 v132, s35
    s_add_u32 s7, s7, s35
    s_bfm_b32 s34, s45, 0
    s_and_b32 s4, s2, 7
    s_sub_u32 s4, 0, s4
    v_mul_u32_u24 v133, 2731, v254
    v_bfe_u32 v142, v133, 17, 3
    v_lshrrev_b32 v133, 16, v133
    v_xor_b32 v143, v142, v254
    v_mul_u32_u24 v142, 37, v133
    v_lshrrev_b32 v142, 8, v142
    v_lshlrev_b32 v143, 4, v143
    v_mad_u32_u24 v10, v142, s70, v143
    v_mul_u32_u24 v142, 37, v133
    v_lshrrev_b32 v142, 8, v142
    v_mul_u32_u24 v144, 7, v142
    v_sub_u32 v144, v133, v144
    v_cmp_gt_u32 vcc, 4, v142
    s_nop 1
    v_cndmask_b32 v142, v129, v119, vcc
    v_cmp_gt_u32 vcc, 4, v144
    s_nop 1
    v_cndmask_b32 v144, v132, v131, vcc
    v_add3_u32 v10, v10, v142, v144
    v_mul_u32_u24 v142, s20, v133
    v_add_u32 v142, s38, v142
    v_mul_u32_u24 v144, 911, v142
    v_lshrrev_b32 v144, 16, v144
    v_mul_u32_u24 v144, s22, v144
    v_mad_u32_u24 v144, v133, s21, v144
    v_bfe_u32 v142, s34, v133, 1
    v_cmp_ne_u32 vcc, 0, v142
    v_add_u32 v142, s7, v144
    s_nop 0
    v_cndmask_b32 v142, v255, v142, vcc
    v_mul_u32_u24 v133, 384, v133
    v_sub_u32 v133, v143, v133
    v_add_u32 v142, v142, v133
    v_add_u32 v133, 256, v254
    v_mul_u32_u24 v143, 2731, v133
    v_bfe_u32 v144, v143, 17, 3
    v_lshrrev_b32 v143, 16, v143
    v_xor_b32 v133, v144, v133
    v_mul_u32_u24 v144, 37, v143
    v_lshrrev_b32 v144, 8, v144
    v_lshlrev_b32 v133, 4, v133
    v_mad_u32_u24 v11, v144, s70, v133
    v_mul_u32_u24 v144, 37, v143
    v_lshrrev_b32 v144, 8, v144
    v_mul_u32_u24 v145, 7, v144
    v_sub_u32 v145, v143, v145
    v_cmp_gt_u32 vcc, 4, v144
    s_nop 1
    v_cndmask_b32 v144, v129, v119, vcc
    v_cmp_gt_u32 vcc, 4, v145
    s_nop 1
    v_cndmask_b32 v145, v132, v131, vcc
    v_add3_u32 v11, v11, v144, v145
    v_min_u32 v144, 20, v143
    v_add_u32 v145, 12, v143
    v_lshrrev_b32 v145, 5, v145
    v_sub_u32 v146, v143, v144
    v_mad_i32_i24 v146, v145, s4, v146
    v_mul_u32_u24 v147, s20, v144
    v_add3_u32 v147, v147, v146, s38
    v_mul_u32_u24 v145, 911, v147
    v_lshrrev_b32 v145, 16, v145
    v_mul_u32_u24 v145, s22, v145
    v_mad_u32_u24 v145, v144, s21, v145
    v_bfe_u32 v147, s34, v143, 1
    v_cmp_ne_u32 vcc, 0, v147
    v_mul_i32_i24 v146, 2688, v146
    v_add3_u32 v144, v145, v146, s7
    v_cndmask_b32 v144, v255, v144, vcc
    v_mul_u32_u24 v143, 384, v143
    v_sub_u32 v143, v133, v143
    v_add_u32 v144, v144, v143
    v_add_u32 v133, 512, v254
    v_mul_u32_u24 v143, 2731, v133
    v_bfe_u32 v145, v143, 17, 3
    v_lshrrev_b32 v143, 16, v143
    v_xor_b32 v133, v145, v133
    v_mul_u32_u24 v145, 37, v143
    v_lshrrev_b32 v145, 8, v145
    v_lshlrev_b32 v133, 4, v133
    v_mad_u32_u24 v12, v145, s70, v133
    v_mul_u32_u24 v145, 37, v143
    v_lshrrev_b32 v145, 8, v145
    v_mul_u32_u24 v146, 7, v145
    v_sub_u32 v146, v143, v146
    v_cmp_gt_u32 vcc, 4, v145
    s_nop 1
    v_cndmask_b32 v145, v129, v119, vcc
    v_cmp_gt_u32 vcc, 4, v146
    s_nop 1
    v_cndmask_b32 v146, v132, v131, vcc
    v_add3_u32 v12, v12, v145, v146
    v_min_u32 v145, 20, v143
    v_add_u32 v146, 12, v143
    v_lshrrev_b32 v146, 5, v146
    v_sub_u32 v147, v143, v145
    v_mad_i32_i24 v147, v146, s4, v147
    v_mul_u32_u24 v148, s20, v145
    v_add3_u32 v148, v148, v147, s38
    v_mul_u32_u24 v146, 911, v148
    v_lshrrev_b32 v146, 16, v146
    v_mul_u32_u24 v146, s22, v146
    v_mad_u32_u24 v146, v145, s21, v146
    v_bfe_u32 v148, s34, v143, 1
    v_cmp_ne_u32 vcc, 0, v148
    v_mul_i32_i24 v147, 2688, v147
    v_add3_u32 v145, v146, v147, s7
    v_cndmask_b32 v145, v255, v145, vcc
    v_mul_u32_u24 v143, 384, v143
    v_sub_u32 v143, v133, v143
    v_add_u32 v145, v145, v143
    s_lshl_b32 s28, s16, 10
    s_add_u32 s28, s28, 20480
    s_waitcnt lgkmcnt(0)
    s_load_dword s101, s[92:93], 0
    s_load_dword s101, s[94:95], 0
    s_cmp_eq_u32 s16, 2
    s_cselect_b64 s[98:99], s[80:81], s[78:79]
    s_cmp_eq_u32 s16, 3
    s_cselect_b64 s[98:99], s[88:89], s[98:99]
    s_mov_b64 s[8:9], s[76:77]
    v_lshl_add_u64 v[116:117], s[98:99], 0, v[116:117]
    s_cmp_eq_u32 s16, 2
    s_cselect_b64 s[98:99], s[84:85], s[82:83]
    s_cmp_eq_u32 s16, 3
    s_cselect_b64 s[98:99], s[86:87], s[98:99]
    v_writelane_b32 v116, s98, 63
    v_writelane_b32 v117, s99, 63
    s_cmp_eq_u32 s16, 0
    s_cbranch_scc1 L_nowue
    global_load_dword a254, v[116:117], off
L_nowue:
    s_add_u32 m0, s28, 65536
    s_nop 0
    buffer_load_dwordx4 v142, s[8:11], 0 offen nt lds
    s_add_u32 m0, s28, 69632
    s_nop 0
    buffer_load_dwordx4 v144, s[8:11], 0 offen lds
    s_add_u32 m0, s28, 73728
    s_nop 0
    buffer_load_dwordx4 v145, s[8:11], 0 offen lds
    s_add_u32 m0, s28, 0
    s_nop 0
    buffer_load_dwordx4 v10, s[8:11], s25 offen nt lds
    s_add_u32 m0, s28, 4096
    s_nop 0
    buffer_load_dwordx4 v11, s[8:11], s25 offen nt lds
    s_mov_b64 s[48:49], s[78:79]
    s_mov_b64 s[52:53], s[80:81]
    s_mov_b64 s[60:61], s[84:85]
    s_mov_b64 s[64:65], s[86:87]
    s_mov_b64 s[56:57], s[88:89]
    s_mov_b64 s[46:47], s[82:83]
    s_load_dwordx4 s[40:43], s[0:1], 72
    s_add_u32 s48, s48, 384
    s_addc_u32 s49, s49, 0
    s_add_u32 m0, s68, 0
    v_lshlrev_b32 v133, 1, v115
    s_mov_b32 s54, 12288
    s_mov_b32 s55, 0x00020000
    s_mov_b32 s62, 64
    s_mov_b32 s63, 0x00020000
    s_mov_b32 s66, 128
    s_mov_b32 s67, 0x00020000
    s_mov_b32 s58, 676
    s_mov_b32 s59, 0x00020000
    s_mov_b32 s14, 0
    s_mov_b32 s15, 0x00020000
    s_mul_i32 s90, s16, 16
    v_mov_b32 v117, 0
    v_cmp_lt_u32 s[92:93], 7, v118
    v_mov_b32 v135, 0
    v_mov_b32 v125, 0
    v_mov_b32 v123, 0
    v_lshlrev_b32 v122, 1, v114
    v_mul_u32_u24 v124, 12, v118
    s_mul_i32 s71, s16, 192
    v_add_u32 v124, s71, v124
    v_lshlrev_b32 v134, 5, v115
    s_mul_i32 s72, s16, 9408
    s_add_u32 s72, s72, 104448
    s_mul_i32 s73, s16, 7616
    s_add_u32 s73, s73, 38912
    s_cmp_eq_u32 s16, 3
    s_cselect_b32 s73, 142080, s73
    v_lshrrev_b32 v136, 2, v118
    v_and_b32 v137, 1, v136
    v_mul_u32_u24 v137, 0x020202, v137
    v_lshl_or_b32 v137, v137, 8, v137
    v_add_u32 v137, 0x05040100, v137
    v_and_b32 v138, 3, v118
    v_lshrrev_b32 v116, 1, v118
    v_xor_b32 v116, v116, v115
    v_mul_u32_u24 v139, 384, v118
    v_lshl_add_u32 v0, v116, 4, v139
    v_xor_b32 v1, 64, v0
    v_and_b32 v116, 2, v115
    v_add_u32 v116, v116, v115
    v_lshl_add_u32 v116, v116, 2, v136
    v_mul_u32_u24 v116, 96, v116
    v_lshl_add_u32 v116, v138, 3, v116
    v_add_u32 v141, s68, v116
    v_add_u32 v139, s69, v116
    v_add_u32 v140, s72, v116
    v_add_u32 v142, s73, v116
    v_mov_b32 v28, 0x3f803f80
    v_mov_b32 v29, 0x3f803f80
    v_mov_b32 v30, 0x3f803f80
    v_mov_b32 v31, 0x3f803f80
    v_mul_u32_u24 v143, 768, v115
    v_add_u32 v143, v124, v143
    v_add_u32 v143, 98304, v143
    s_mov_b32 s76, 0x3f80
    v_and_b32 v116, 1, v118
    v_lshlrev_b32 v116, 4, v116
    v_lshlrev_b32 v144, v116, s76
    v_mov_b32 v145, 0x3c003c00
    v_mov_b32 v44, 1.0
    v_lshlrev_b32 v146, 4, v115
    s_mov_b32 s19, s38
    s_mov_b32 s23, s25
    s_mov_b32 s26, 0
    s_mov_b32 s27, 0
    s_mov_b32 s18, 0
    s_add_u32 s19, s19, s20
    s_add_u32 s23, s23, s21
    s_cmp_ge_u32 s19, 72
    s_cselect_b32 s34, 72, 0
    s_cselect_b32 s35, s22, 0
    s_sub_u32 s19, s19, s34
    s_add_u32 s23, s23, s35
    s_mov_b32 s24, s23
    s_add_u32 s19, s19, s20
    s_add_u32 s23, s23, s21
    s_cmp_ge_u32 s19, 72
    s_cselect_b32 s34, 72, 0
    s_cselect_b32 s35, s22, 0
    s_sub_u32 s19, s19, s34
    s_add_u32 s23, s23, s35
    s_mul_i32 s79, s16, 64
    v_lshl_add_u32 v147, v115, 4, s79
    s_mul_i32 s80, s16, 32
    s_add_u32 s80, s80, 256
    v_lshl_add_u32 v149, v115, 3, s80
    v_add_u32 v151, 0, v118
    v_mul_u32_u24 v148, 37, v151
    v_mul_u32_u24 v150, 384, v151
    v_lshrrev_b32 v148, 8, v148
    v_mad_u32_u24 v150, v148, s70, v150
    v_add_u32 v15, v150, v147
    v_add_u32 v18, v150, v149
    v_mul_u32_u24 v150, 37, v151
    v_lshrrev_b32 v150, 8, v150
    v_mul_u32_u24 v153, 7, v150
    v_sub_u32 v153, v151, v153
    v_add_u32 v152, 16, v118
    v_mul_u32_u24 v155, 37, v152
    v_mul_u32_u24 v154, 384, v152
    v_lshrrev_b32 v155, 8, v155
    v_mad_u32_u24 v154, v155, s70, v154
    v_add_u32 v16, v154, v147
    v_add_u32 v19, v154, v149
    v_mul_u32_u24 v154, 37, v152
    v_lshrrev_b32 v154, 8, v154
    v_mul_u32_u24 v157, 7, v154
    v_sub_u32 v157, v152, v157
    v_add_u32 v159, 32, v118
    v_mul_u32_u24 v158, 37, v159
    v_mul_u32_u24 v156, 384, v159
    v_lshrrev_b32 v158, 8, v158
    v_mad_u32_u24 v156, v158, s70, v156
    v_add_u32 v17, v156, v147
    v_add_u32 v20, v156, v149
    v_mul_u32_u24 v156, 37, v159
    v_lshrrev_b32 v156, 8, v156
    v_mul_u32_u24 v147, 7, v156
    v_sub_u32 v147, v159, v147
    s_mul_i32 s81, s16, 768
    s_add_u32 s81, s81, 98304
    v_mul_u32_u24 v148, 24, v148
    v_lshl_add_u32 v148, v151, 2, v148
    v_add_u32 v22, s81, v148
    v_sub_u32 v23, s81, v148
    v_sub_u32 v148, v22, v146
    v_mul_u32_u24 v155, 24, v155
    v_lshl_add_u32 v155, v152, 2, v155
    v_add_u32 v24, s81, v155
    v_sub_u32 v25, s81, v155
    v_sub_u32 v149, v24, v146
    v_mul_u32_u24 v155, 24, v158
    v_lshl_add_u32 v155, v159, 2, v155
    v_add_u32 v26, s81, v155
    v_sub_u32 v27, s81, v155
    v_sub_u32 v155, v26, v146
    v_mul_u32_u24 v158, 148, v115
    s_mov_b32 s82, -24
    v_add_u32 v160, 0, v158
    v_lshrrev_b32 v160, 8, v160
    v_mad_i32_i24 v46, v160, s82, v148
    v_mad_i32_i24 v58, v160, s82, v149
    v_mad_i32_i24 v70, v160, s82, v155
    v_add_u32 v160, 37, v158
    v_lshrrev_b32 v160, 8, v160
    v_mad_i32_i24 v47, v160, s82, v148
    v_mad_i32_i24 v59, v160, s82, v149
    v_mad_i32_i24 v71, v160, s82, v155
    v_add_u32 v160, 74, v158
    v_lshrrev_b32 v160, 8, v160
    v_mad_i32_i24 v48, v160, s82, v148
    v_mad_i32_i24 v60, v160, s82, v149
    v_mad_i32_i24 v72, v160, s82, v155
    v_add_u32 v160, 111, v158
    v_lshrrev_b32 v160, 8, v160
    v_mad_i32_i24 v49, v160, s82, v148
    v_mad_i32_i24 v61, v160, s82, v149
    v_mad_i32_i24 v73, v160, s82, v155
    v_add_u32 v160, 592, v158
    v_lshrrev_b32 v160, 8, v160
    v_mad_i32_i24 v50, v160, s82, v148
    v_mad_i32_i24 v62, v160, s82, v149
    v_mad_i32_i24 v74, v160, s82, v155
    v_add_u32 v160, 629, v158
    v_lshrrev_b32 v160, 8, v160
    v_mad_i32_i24 v51, v160, s82, v148
    v_mad_i32_i24 v63, v160, s82, v149
    v_mad_i32_i24 v75, v160, s82, v155
    v_add_u32 v160, 666, v158
    v_lshrrev_b32 v160, 8, v160
    v_mad_i32_i24 v52, v160, s82, v148
    v_mad_i32_i24 v64, v160, s82, v149
    v_mad_i32_i24 v76, v160, s82, v155
    v_add_u32 v160, 703, v158
    v_lshrrev_b32 v160, 8, v160
    v_mad_i32_i24 v53, v160, s82, v148
    v_mad_i32_i24 v65, v160, s82, v149
    v_mad_i32_i24 v77, v160, s82, v155
    v_add_u32 v160, 1184, v158
    v_lshrrev_b32 v160, 8, v160
    v_mad_i32_i24 v54, v160, s82, v148
    v_mad_i32_i24 v66, v160, s82, v149
    v_mad_i32_i24 v78, v160, s82, v155
    v_add_u32 v160, 1221, v158
    v_lshrrev_b32 v160, 8, v160
    v_mad_i32_i24 v55, v160, s82, v148
    v_mad_i32_i24 v67, v160, s82, v149
    v_mad_i32_i24 v79, v160, s82, v155
    v_add_u32 v160, 1258, v158
    v_lshrrev_b32 v160, 8, v160
    v_mad_i32_i24 v56, v160, s82, v148
    v_mad_i32_i24 v68, v160, s82, v149
    v_mad_i32_i24 v80, v160, s82, v155
    v_add_u32 v158, 1295, v158
    v_lshrrev_b32 v158, 8, v158
    v_mad_i32_i24 v57, v158, s82, v148
    v_mad_i32_i24 v69, v158, s82, v149
    v_mad_i32_i24 v81, v158, s82, v155
    v_mov_b32 v155, s81
    v_lshlrev_b32 v148, 4, v114
    v_xor_b32 v2, 65536, v148
    v_lshl_add_u32 v3, s16, 10, v148
    s_lshr_b32 s83, s16, 1
    s_and_b32 s84, s16, 1
    s_lshl_b32 s84, s84, 3
    s_lshl_b32 s85, s83, 10
    s_add_u32 s85, s85, s84
    v_add_u32 v4, s85, v148
    s_lshl_b32 s83, s83, 11
    s_add_u32 s83, s83, s84
    s_add_u32 s83, s83, 157888
    s_mul_i32 s86, s16, 2048
    s_add_u32 s86, s86, 149696
    v_lshl_add_u32 v160, v115, 3, s86
    v_mov_b32 v148, s83
    v_mov_b32 v149, 163264
    v_mul_u32_u24 v158, 80, v115
    v_add3_u32 v5, v158, v116, s72
    v_lshl_add_u32 v6, v118, 2, s73
    s_mul_i32 s87, s16, 128
    s_add_u32 s87, s87, 61760
    s_mov_b32 s32, 0x2a8cbccc
    s_mov_b32 s33, 0x38fba882
    s_add_u32 s75, s28, 16384
    s_cmp_lt_u32 s16, 2
    s_cselect_b32 s29, s75, 161984
    s_cselect_b32 s30, 65536, 0
    s_xor_b32 s74, s29, s30
    s_lshl_b32 s94, s5, 1
    s_or_b32 s94, s94, s6
    s_mul_i32 s77, s16, 64
    s_mul_i32 s78, s16, 32
    s_add_u32 s78, s78, 192
    s_add_u32 s34, s18, 2
    s_mov_b32 s27, s26
    s_mov_b32 s26, s25
    s_add_u32 s19, s19, s20
    s_mov_b32 s18, 1
    s_mov_b32 s71, 1
    buffer_load_dwordx4 v126, s[48:51], 0 offen lds
    v_add_u32 v9, s87, v146
    v_lshrrev_b32 v116, 1, v115
    v_mul_u32_u24 v116, 48, v116
    buffer_load_dwordx4 v128, s[48:51], 0 offen offset:1024 lds
    v_lshl_add_u32 v116, v115, 3, v116
    v_lshl_add_u32 v116, v136, 4, v116
    v_lshl_add_u32 v116, v138, 1, v116
    buffer_load_dwordx4 v130, s[48:51], 0 offen offset:2048 lds
    s_add_u32 s48, s48, 36864
    s_addc_u32 s49, s49, 0
    s_add_u32 m0, s68, 3072
    v_add_u32 v8, s87, v116
    buffer_load_dwordx4 v126, s[48:51], 0 offen lds
    v_mov_b32 v37, 0
    v_mov_b32 v38, 0
    v_mov_b32 v39, 0
    buffer_load_dwordx4 v128, s[48:51], 0 offen offset:1024 lds
    v_add_u32 v161, 86016, v0
    v_add_u32 v174, 86016, v1
    v_lshlrev_b32 v162, 4, v118
    buffer_load_dwordx4 v130, s[48:51], 0 offen offset:2048 lds
    s_add_u32 s48, s48, 36864
    s_addc_u32 s49, s49, 0
    s_add_u32 m0, s69, 0
    buffer_load_ushort v116, v122, s[60:63], 0 offen
    s_mov_b64 s[60:61], s[8:9]
    s_sub_u32 s62, s45, s17
    s_sub_u32 s45, s17, 1
    buffer_load_dwordx3 v[166:168], v124, s[56:59], 0 offen
    v_add_u32 v162, 161984, v162
    buffer_load_dwordx4 v[170:173], v134, s[64:67], 0 offen
    v_mul_u32_u24 v175, 336, v118
    v_add3_u32 v175, v175, v158, s72
    v_mul_u32_u24 v158, 272, v118
    v_add3_u32 v158, v158, v146, s73
    v_mul_u32_u24 v177, 1088, v115
    v_add_u32 v177, v177, v6
    v_add_u32 v176, 5376, v175
    buffer_load_dwordx4 v[186:189], v134, s[64:67], 0 offen offset:16
    v_add_u32 v179, 4352, v158
    v_add_u32 v178, 4352, v177
    v_cmp_gt_u32 s[88:89], 16, v114
    v_mov_b32 v180, 0xf149f2ca
    v_add_u32 v134, 768, v254
    v_mul_u32_u24 v169, 2731, v134
    v_bfe_u32 v181, v169, 17, 3
    v_lshrrev_b32 v169, 16, v169
    v_xor_b32 v134, v181, v134
    v_mul_u32_u24 v181, 37, v169
    v_lshrrev_b32 v181, 8, v181
    v_lshlrev_b32 v134, 4, v134
    v_mad_u32_u24 v13, v181, s70, v134
    v_mul_u32_u24 v181, 37, v169
    v_lshrrev_b32 v181, 8, v181
    v_mul_u32_u24 v134, 7, v181
    v_sub_u32 v134, v169, v134
    v_cmp_gt_u32 vcc, 4, v181
    v_add_u32 v169, 1024, v254
    v_mul_u32_u24 v254, 2731, v169
    v_cndmask_b32 v181, v129, v119, vcc
    v_cmp_gt_u32 vcc, 4, v134
    v_bfe_u32 v122, v254, 17, 3
    v_lshrrev_b32 v254, 16, v254
    v_cndmask_b32 v134, v132, v131, vcc
    v_add3_u32 v13, v13, v181, v134
    v_xor_b32 v169, v122, v169
    v_mul_u32_u24 v122, 37, v254
    v_lshrrev_b32 v122, 8, v122
    v_lshlrev_b32 v169, 4, v169
    v_mad_u32_u24 v14, v122, s70, v169
    v_mul_u32_u24 v169, 37, v254
    v_lshrrev_b32 v169, 8, v169
    v_mul_u32_u24 v134, 7, v169
    v_sub_u32 v134, v254, v134
    v_cmp_gt_u32 vcc, 4, v169
    v_mov_b32 v163, 0xc31044fe
    v_mul_u32_u24 v181, 37, v151
    v_cndmask_b32 v169, v129, v119, vcc
    v_cmp_gt_u32 vcc, 4, v134
    v_lshrrev_b32 v181, 8, v181
    v_mul_u32_u24 v122, 7, v181
    v_cndmask_b32 v134, v132, v131, vcc
    v_add3_u32 v14, v14, v169, v134
    v_cmp_gt_u32 vcc, 48, v254
    v_sub_u32 v122, v151, v122
    v_lshrrev_b32 v181, 2, v181
    v_cndmask_b32 v14, v255, v14, vcc
    v_cmp_gt_u32 vcc, 2, v138
    v_lshrrev_b32 v122, 2, v122
    v_and_b32 v181, s5, v181
    v_cndmask_b32 v32, 0, v144, vcc
    v_cndmask_b32 v33, v144, 0, vcc
    v_cndmask_b32 v34, 0, v144, vcc
    v_cndmask_b32 v35, v144, 0, vcc
    v_cmp_eq_u32 vcc, 0, v138
    v_and_b32 v122, s6, v122
    v_lshl_or_b32 v181, v181, 1, v122
    v_cndmask_b32 v40, 0, v145, vcc
    v_cmp_eq_u32 vcc, 1, v138
    v_mul_u32_u24 v254, 37, v152
    v_lshrrev_b32 v254, 8, v254
    v_cndmask_b32 v41, 0, v145, vcc
    v_cmp_eq_u32 vcc, 2, v138
    v_mul_u32_u24 v134, 7, v254
    v_sub_u32 v134, v152, v134
    s_bfm_b32 s70, s17, 0
    s_waitcnt vmcnt(9)
    s_barrier
    global_load_ushort v133, v133, s[46:47]
    v_cndmask_b32 v42, 0, v145, vcc
    v_cmp_eq_u32 vcc, 3, v138
    v_lshrrev_b32 v254, 2, v254
    v_lshrrev_b32 v134, 2, v134
    v_cndmask_b32 v43, 0, v145, vcc
    v_cmp_eq_u32 vcc, v115, v136
    v_and_b32 v254, s5, v254
    v_and_b32 v134, s6, v134
    v_cndmask_b32 v144, 0, v32, vcc
    v_cndmask_b32 v145, 0, v33, vcc
    v_lshl_or_b32 v254, v254, 1, v134
    buffer_load_dwordx4 v126, s[48:51], 0 offen lds
    v_mul_u32_u24 v255, 37, v159
    v_lshrrev_b32 v255, 8, v255
    v_mul_u32_u24 v134, 7, v255
    v_sub_u32 v134, v159, v134
    v_lshrrev_b32 v255, 2, v255
    v_lshrrev_b32 v134, 2, v134
    v_and_b32 v255, s5, v255
    v_and_b32 v134, s6, v134
    v_lshl_or_b32 v255, v255, 1, v134
    v_mul_u32_u24 v134, 6, v120
    v_sub_u32 v159, v114, v134
    v_mul_u32_u24 v134, 384, v120
    v_lshl_add_u32 v134, v159, 4, v134
    v_add_u32 v120, s78, v134
    v_add_u32 v134, s77, v134
    buffer_load_dwordx4 v128, s[48:51], 0 offen offset:1024 lds
    s_waitcnt vmcnt(10)
    ds_read_b64_tr_b16 a[72:73], v141 offset:0
    ds_read_b64_tr_b16 a[74:75], v141 offset:768
    ds_read_b64_tr_b16 a[96:97], v141 offset:32
    ds_read_b64_tr_b16 a[98:99], v141 offset:800
    ds_read_b64_tr_b16 a[120:121], v141 offset:64
    ds_read_b64_tr_b16 a[122:123], v141 offset:832
    v_cmp_gt_i32 vcc, 4, v159
    v_mul_u32_u24 v159, 6, v121
    v_sub_u32 v169, v114, v159
    v_cndmask_b32 v120, v120, v134, vcc
    v_mul_u32_u24 v159, 384, v121
    v_lshl_add_u32 v159, v169, 4, v159
    v_add_u32 v134, s78, v159
    v_add_u32 v159, s77, v159
    buffer_load_dwordx4 v130, s[48:51], 0 offen offset:2048 lds
    s_add_u32 s48, s48, 36864
    s_addc_u32 s49, s49, 0
    s_add_u32 m0, s69, 3072
    v_cmp_gt_i32 vcc, -60, v169
    v_mul_u32_u24 v121, 6, v127
    v_sub_u32 v114, v114, v121
    v_cndmask_b32 v159, v134, v159, vcc
    v_mul_u32_u24 v121, 384, v127
    v_lshl_add_u32 v121, v114, 4, v121
    v_add_u32 v127, s78, v121
    v_add_u32 v121, s77, v121
    v_cmp_gt_i32 vcc, -124, v114
    v_mul_u32_u24 v114, 96, v118
    v_add3_u32 v182, v114, v146, s68
    v_cndmask_b32 v121, v127, v121, vcc
    s_and_b32 s77, s2, 0xf8
    s_add_u32 s77, s77, 4940
    s_mul_i32 s78, s77, 58255
    s_lshr_b32 s78, s78, 22
    buffer_load_dwordx4 v126, s[48:51], 0 offen lds
    v_cmp_gt_u32 vcc, 4, v150
    v_lshl_add_u32 v127, v115, 3, v114
    v_add3_u32 v127, v127, 64, s68
    v_cndmask_b32 v150, v129, v119, vcc
    v_cmp_gt_u32 vcc, 4, v153
    v_add3_u32 v183, v114, v146, s69
    v_lshl_add_u32 v184, v115, 3, v114
    v_cndmask_b32 v153, v132, v131, vcc
    v_add3_u32 v15, v15, v150, v153
    s_waitcnt vmcnt(9)
    ds_read_b64_tr_b16 a[76:77], v141 offset:3072
    ds_read_b64_tr_b16 a[78:79], v141 offset:3840
    s_waitcnt vmcnt(7)
    ds_read_b64_tr_b16 a[100:101], v141 offset:3104
    s_waitcnt vmcnt(6)
    ds_read_b64_tr_b16 a[102:103], v141 offset:3872
    s_waitcnt vmcnt(5)
    buffer_load_dwordx4 v128, s[48:51], 0 offen offset:1024 lds
    ds_read_b64_tr_b16 a[124:125], v141 offset:3136
    ds_read_b64_tr_b16 a[126:127], v141 offset:3904
    v_cndmask_b32 v170, v170, v171, s[92:93]
    v_cndmask_b32 v172, v172, v173, s[92:93]
    v_perm_b32 v164, v172, v170, v137
    v_cndmask_b32 v186, v186, v187, s[92:93]
    v_cndmask_b32 v188, v188, v189, s[92:93]
    v_perm_b32 v165, v188, v186, v137
    v_bfe_u32 v134, v166, v146, 16
    v_bfe_u32 v124, v167, v146, 16
    v_bfe_u32 v122, v168, v146, 16
    v_mfma_f32_16x16x16_bf16 v[170:173], v[116:117], v[134:135], 0
    v_add3_u32 v18, v18, v150, v153
    v_cmp_gt_u32 vcc, 4, v154
    v_add3_u32 v184, v184, 64, s69
    v_mfma_f32_16x16x16_bf16 v[150:153], v[116:117], v[124:125], 0
    v_cndmask_b32 v154, v129, v119, vcc
    v_cmp_gt_u32 vcc, 4, v157
    v_mfma_f32_16x16x16_bf16 v[166:169], v[116:117], v[122:123], 0
    buffer_load_dwordx4 v130, s[48:51], 0 offen offset:2048 lds
    s_add_u32 s48, s48, 36864
    s_addc_u32 s49, s49, 0
    s_add_u32 m0, s72, 0
    v_max_f32 v170, 0, v170
    v_max_f32 v171, 0, v171
    v_max_f32 v172, 0, v172
    v_max_f32 v173, 0, v173
    v_cvt_pk_bf16_f32 v116, v170, v171
    v_cvt_pk_bf16_f32 v117, v172, v173
    v_max_f32 v150, 0, v150
    v_max_f32 v151, 0, v151
    s_waitcnt vmcnt(6)
    v_mfma_f32_16x16x16_bf16 v[122:125], v[164:165], v[116:117], 0
    v_lshlrev_b32 v133, 16, v133
    buffer_load_dwordx4 v126, s[48:51], 0 offen lds
    v_max_f32 v133, 0xc2c80000, v133
    v_min_f32 v133, 0x40930000, v133
    v_mul_f32 v133, 0x3fb8aa3b, v133
    v_exp_f32 v133, v133
    v_max_f32 v152, 0, v152
    v_cvt_pk_bf16_f32 v133, v133, v133
    v_and_b32 v133, 0xffff0000, v133
    v_mul_f32 v133, 0x3fb8aa3b, v133
    v_mul_f32 v146, 0xbea8f5c3, v133
    v_add_f32 v146, 0xc138aa3b, v146
    v_readlane_b32 s31, v133, s90
    v_cvt_pk_bf16_f32 v122, v122, v122
    v_and_b32 v122, 0xffff0000, v122
    v_mul_f32 v122, 0xbfb8aa3b, v122
    buffer_load_dwordx4 v128, s[48:51], 0 offen offset:1024 lds
    v_exp_f32 v122, v122
    v_max_f32 v153, 0, v153
    v_add_f32 v122, 1.0, v122
    v_rcp_f32 v122, v122
    v_cvt_pk_bf16_f32 v150, v150, v151
    v_cvt_pk_bf16_f32 v122, v122, v122
    v_and_b32 v122, 0xffff0000, v122
    v_fmamk_f32 v122, v122, 0x41b8aa3b, v146
    ds_write_b32 v143, v122 offset:0
    v_cvt_pk_bf16_f32 v151, v152, v153
    buffer_load_dwordx4 v130, s[48:51], 0 offen offset:2048 lds
    s_add_u32 s48, s48, 36864
    v_mfma_f32_16x16x16_bf16 v[122:125], v[164:165], v[150:151], 0
    s_addc_u32 s49, s49, 0
    s_add_u32 m0, s72, 3072
    v_max_f32 v166, 0, v166
    v_max_f32 v167, 0, v167
    v_max_f32 v168, 0, v168
    v_max_f32 v169, 0, v169
    v_cvt_pk_bf16_f32 v166, v166, v167
    s_waitcnt vmcnt(6)
    s_mov_b32 s72, 2
    ds_read_b64_tr_b16 a[80:81], v139 offset:0
    ds_read_b64_tr_b16 a[82:83], v139 offset:768
    ds_read_b64_tr_b16 a[104:105], v139 offset:32
    ds_read_b64_tr_b16 a[106:107], v139 offset:800
    ds_read_b64_tr_b16 a[128:129], v139 offset:64
    ds_read_b64_tr_b16 a[130:131], v139 offset:832
    buffer_load_dwordx4 v126, s[48:51], 0 offen lds
    v_cvt_pk_bf16_f32 v122, v122, v122
    v_and_b32 v122, 0xffff0000, v122
    v_mul_f32 v122, 0xbfb8aa3b, v122
    v_exp_f32 v122, v122
    v_cvt_pk_bf16_f32 v167, v168, v169
    v_add_f32 v122, 1.0, v122
    v_rcp_f32 v122, v122
    v_mfma_f32_16x16x16_bf16 v[150:153], v[164:165], v[166:167], 0
    v_cvt_pk_bf16_f32 v122, v122, v122
    v_and_b32 v122, 0xffff0000, v122
    v_fmamk_f32 v122, v122, 0x41b8aa3b, v146
    ds_write_b32 v143, v122 offset:4
    buffer_load_dwordx4 v128, s[48:51], 0 offen offset:1024 lds
    v_cndmask_b32 v157, v132, v131, vcc
    v_add3_u32 v16, v16, v154, v157
    v_add3_u32 v19, v19, v154, v157
    v_cvt_pk_bf16_f32 v150, v150, v150
    v_and_b32 v150, 0xffff0000, v150
    v_mul_f32 v150, 0xbfb8aa3b, v150
    v_exp_f32 v150, v150
    v_cmp_gt_u32 vcc, 4, v156
    v_add_f32 v150, 1.0, v150
    v_rcp_f32 v150, v150
    v_cndmask_b32 v156, v129, v119, vcc
    v_cvt_pk_bf16_f32 v150, v150, v150
    v_and_b32 v150, 0xffff0000, v150
    buffer_load_dwordx4 v130, s[48:51], 0 offen offset:2048 lds
    s_sub_u32 s48, s48, 184704
    s_subb_u32 s49, s49, 0
    s_add_u32 m0, s73, 0
    v_fmamk_f32 v150, v150, 0x41b8aa3b, v146
    ds_write_b32 v143, v150 offset:8
    v_cmp_gt_u32 vcc, 4, v147
    s_nop 0
    s_nop 0
    v_cndmask_b32 v147, v132, v131, vcc
    v_add3_u32 v17, v17, v156, v147
    v_add3_u32 v20, v20, v156, v147
    v_cmp_gt_u32 vcc, 2, v115
    buffer_load_dwordx4 v126, s[48:51], 0 offen lds
    s_waitcnt vmcnt(7)
    ds_read_b64_tr_b16 a[84:85], v139 offset:3072
    ds_read_b64_tr_b16 a[86:87], v139 offset:3840
    ds_read_b64_tr_b16 a[108:109], v139 offset:3104
    ds_read_b64_tr_b16 a[110:111], v139 offset:3872
    ds_read_b64_tr_b16 a[132:133], v139 offset:3136
    ds_read_b64_tr_b16 a[134:135], v139 offset:3904
    v_cndmask_b32 v160, v148, v160, vcc
    v_lshl_add_u32 v160, v136, 9, v160
    v_lshl_add_u32 v160, v138, 1, v160
    v_cmp_gt_u32 vcc, 3, v115
    s_nop 0
    s_nop 0
    v_cndmask_b32 v7, v149, v160, vcc
    v_cmp_gt_u32 vcc, 12, v118
    buffer_load_dwordx4 v128, s[48:51], 0 offen offset:1024 lds
    s_waitcnt lgkmcnt(6)
    s_barrier
    ds_read_b32 v22, v22 offset:0
    ds_read_b32 v23, v23 offset:672
    ds_read_b32 v24, v24 offset:0
    ds_read_b32 v25, v25 offset:672
    ds_read_b32 v26, v26 offset:0
    ds_read_b32 v27, v27 offset:672
    ds_read_b32 v46, v46 offset:336
    ds_read_b32 v58, v58 offset:336
    v_cndmask_b32 v176, v162, v176, vcc
    v_cndmask_b32 v179, v162, v179, vcc
    v_cmp_gt_u32 vcc, 3, v115
    ds_read_b32 v70, v70 offset:336
    ds_read_b32 v47, v47 offset:332
    buffer_load_dwordx4 v130, s[48:51], 0 offen offset:2048 lds
    ds_read_b32 v59, v59 offset:332
    ds_read_b32 v71, v71 offset:332
    ds_read_b32 v48, v48 offset:328
    ds_read_b32 v60, v60 offset:328
    s_add_u32 s48, s48, 36864
    ds_read_b32 v72, v72 offset:328
    s_addc_u32 s49, s49, 0
    ds_read_b32 v49, v49 offset:324
    s_add_u32 m0, s73, 3072
    ds_read_b32 v61, v61 offset:324
    v_cndmask_b32 v178, v162, v178, vcc
    s_mov_b32 s73, 3
    ds_read_b32 v73, v73 offset:324
    ds_read_b32 v50, v50 offset:272
    ds_read_b32 v62, v62 offset:272
    s_waitcnt vmcnt(6)
    buffer_load_dwordx4 v126, s[48:51], 0 offen lds
    ds_read_b64_tr_b16 a[88:89], v140 offset:0
    ds_read_b64_tr_b16 a[90:91], v140 offset:768
    ds_read_b64_tr_b16 a[112:113], v140 offset:32
    ds_read_b64_tr_b16 a[114:115], v140 offset:800
    ds_read_b64_tr_b16 a[136:137], v140 offset:64
    ds_read_b64_tr_b16 a[138:139], v140 offset:832
    ds_read_b32 v74, v74 offset:272
    ds_read_b32 v51, v51 offset:268
    ds_read_b32 v63, v63 offset:268
    buffer_load_dwordx4 v128, s[48:51], 0 offen offset:1024 lds
    ds_read_b32 v75, v75 offset:268
    ds_read_b32 v52, v52 offset:264
    ds_read_b32 v64, v64 offset:264
    ds_read_b32 v76, v76 offset:264
    ds_read_b32 v53, v53 offset:260
    ds_read_b32 v65, v65 offset:260
    ds_read_b32 v77, v77 offset:260
    ds_read_b32 v54, v54 offset:208
    ds_read_b32 v66, v66 offset:208
    buffer_load_dwordx4 v130, s[48:51], 0 offen offset:2048 lds
    ds_read_b32 v78, v78 offset:208
    ds_read_b32 v55, v55 offset:204
    s_add_u32 s48, s48, 36864
    ds_read_b32 v67, v67 offset:204
    s_addc_u32 s49, s49, 0
    ds_read_b32 v79, v79 offset:204
    s_add_u32 m0, s68, 0
    ds_read_b32 v56, v56 offset:200
    ds_read_b32 v68, v68 offset:200
    ds_read_b32 v80, v80 offset:200
    ds_read_b32 v57, v57 offset:196
    ds_read_b32 v69, v69 offset:196
    s_waitcnt vmcnt(6)
    buffer_load_dwordx4 v126, s[48:51], 0 offen lds
    ds_read_b64_tr_b16 a[92:93], v140 offset:3072
    ds_read_b64_tr_b16 a[94:95], v140 offset:3840
    ds_read_b64_tr_b16 a[116:117], v140 offset:3104
    ds_read_b64_tr_b16 a[118:119], v140 offset:3872
    ds_read_b64_tr_b16 a[140:141], v140 offset:3136
    ds_read_b64_tr_b16 a[142:143], v140 offset:3904
    ds_read_b32 v81, v81 offset:196
    ds_read_b32 v155, v155 offset:336
    v_cmp_ne_u32 vcc, s94, v181
    buffer_load_dwordx4 v128, s[48:51], 0 offen offset:1024 lds
    v_lshl_add_u32 v143, v115, 2, 0
    v_cndmask_b32 v129, 0, v163, vcc
    s_waitcnt lgkmcnt(11)
    v_add_f32 v22, v22, v129
    v_cmp_ne_u32 vcc, s94, v181
    v_mul_u32_u24 v129, 37, v143
    v_lshrrev_b32 v129, 8, v129
    v_cndmask_b32 v160, 0, v163, vcc
    v_add_f32 v23, v23, v160
    v_cmp_ne_u32 vcc, s94, v254
    v_mul_u32_u24 v160, 7, v129
    v_sub_u32 v160, v143, v160
    v_cndmask_b32 v143, 0, v163, vcc
    v_add_f32 v24, v24, v143
    v_cmp_ne_u32 vcc, s94, v254
    buffer_load_dwordx4 v130, s[48:51], 0 offen offset:2048 lds
    s_add_u32 s48, s48, 36864
    s_addc_u32 s49, s49, 0
    s_add_u32 m0, s68, 3072
    v_cndmask_b32 v143, 0, v163, vcc
    s_waitcnt lgkmcnt(0)
    v_readfirstlane_b32 s39, v155
    v_add_f32 v25, v25, v143
    v_cmp_ne_u32 vcc, s94, v255
    v_lshrrev_b32 v129, 2, v129
    v_lshrrev_b32 v160, 2, v160
    v_cndmask_b32 v143, 0, v163, vcc
    v_add_f32 v26, v26, v143
    v_cmp_ne_u32 vcc, s94, v255
    v_and_b32 v129, s5, v129
    buffer_load_dwordx4 v126, s[48:51], 0 offen lds
    s_waitcnt vmcnt(7)
    ds_read_b64_tr_b16 a[0:1], v142 offset:0
    ds_read_b64_tr_b16 a[2:3], v142 offset:768
    ds_read_b64_tr_b16 a[24:25], v142 offset:32
    ds_read_b64_tr_b16 a[26:27], v142 offset:800
    ds_read_b64_tr_b16 a[48:49], v142 offset:64
    ds_read_b64_tr_b16 a[50:51], v142 offset:832
    v_cndmask_b32 v143, 0, v163, vcc
    v_add_f32 v27, v27, v143
    v_and_b32 v160, s6, v160
    v_lshl_or_b32 v129, v129, 1, v160
    v_cmp_ne_u32 vcc, v129, v181
    v_lshl_add_u32 v185, v115, 2, 1
    v_mul_u32_u24 v160, 37, v185
    v_cndmask_b32 v143, 0, v163, vcc
    buffer_load_dwordx4 v128, s[48:51], 0 offen offset:1024 lds
    v_add_f32 v46, v46, v143
    v_cmp_ne_u32 vcc, v129, v254
    v_lshrrev_b32 v160, 8, v160
    v_mul_u32_u24 v118, 7, v160
    v_cndmask_b32 v143, 0, v163, vcc
    v_add_f32 v58, v58, v143
    v_cmp_ne_u32 vcc, v129, v255
    v_sub_u32 v118, v185, v118
    v_lshrrev_b32 v160, 2, v160
    v_cndmask_b32 v119, 0, v163, vcc
    v_add_f32 v70, v70, v119
    v_lshrrev_b32 v118, 2, v118
    v_and_b32 v160, s5, v160
    v_and_b32 v118, s6, v118
    v_lshl_or_b32 v160, v160, 1, v118
    buffer_load_dwordx4 v130, s[48:51], 0 offen offset:2048 lds
    s_add_u32 s48, s48, 36864
    s_addc_u32 s49, s49, 0
    s_add_u32 m0, s69, 0
    v_cmp_ne_u32 vcc, v160, v181
    v_lshl_add_u32 v129, v115, 2, 2
    v_mul_u32_u24 v185, 37, v129
    v_cndmask_b32 v143, 0, v163, vcc
    v_add_f32 v47, v47, v143
    v_cmp_ne_u32 vcc, v160, v254
    v_lshrrev_b32 v185, 8, v185
    v_mul_u32_u24 v143, 7, v185
    v_cndmask_b32 v118, 0, v163, vcc
    v_add_f32 v59, v59, v118
    v_cmp_ne_u32 vcc, v160, v255
    v_sub_u32 v143, v129, v143
    buffer_load_dwordx4 v126, s[48:51], 0 offen lds
    s_waitcnt vmcnt(7)
    ds_read_b64_tr_b16 a[4:5], v142 offset:3072
    ds_read_b64_tr_b16 a[6:7], v142 offset:3840
    ds_read_b64_tr_b16 a[28:29], v142 offset:3104
    ds_read_b64_tr_b16 a[30:31], v142 offset:3872
    ds_read_b64_tr_b16 a[52:53], v142 offset:3136
    ds_read_b64_tr_b16 a[54:55], v142 offset:3904
    v_cndmask_b32 v129, 0, v163, vcc
    v_add_f32 v71, v71, v129
    v_lshrrev_b32 v185, 2, v185
    v_lshrrev_b32 v143, 2, v143
    v_and_b32 v185, s5, v185
    v_and_b32 v143, s6, v143
    v_lshl_or_b32 v185, v185, 1, v143
    v_cmp_ne_u32 vcc, v185, v181
    buffer_load_dwordx4 v128, s[48:51], 0 offen offset:1024 lds
    v_lshl_add_u32 v129, v115, 2, 3
    v_cndmask_b32 v160, 0, v163, vcc
    v_add_f32 v48, v48, v160
    v_cmp_ne_u32 vcc, v185, v254
    v_mul_u32_u24 v160, 37, v129
    v_lshrrev_b32 v160, 8, v160
    v_cndmask_b32 v118, 0, v163, vcc
    v_add_f32 v60, v60, v118
    v_cmp_ne_u32 vcc, v185, v255
    v_mul_u32_u24 v185, 7, v160
    v_sub_u32 v185, v129, v185
    v_cndmask_b32 v129, 0, v163, vcc
    v_add_f32 v72, v72, v129
    v_lshrrev_b32 v160, 2, v160
    v_lshrrev_b32 v185, 2, v185
    buffer_load_dwordx4 v130, s[48:51], 0 offen offset:2048 lds
    s_add_u32 s48, s48, 36864
    s_addc_u32 s49, s49, 0
    s_add_u32 m0, s69, 3072
    v_and_b32 v160, s5, v160
    v_and_b32 v185, s6, v185
    v_lshl_or_b32 v160, v160, 1, v185
    v_cmp_ne_u32 vcc, v160, v181
    v_lshl_add_u32 v185, v115, 2, 16
    v_mul_u32_u24 v129, 37, v185
    v_cndmask_b32 v118, 0, v163, vcc
    v_add_f32 v49, v49, v118
    v_cmp_ne_u32 vcc, v160, v254
    v_lshrrev_b32 v129, 8, v129
    v_mul_u32_u24 v118, 7, v129
    v_cndmask_b32 v119, 0, v163, vcc
    buffer_load_dwordx4 v126, s[48:51], 0 offen lds
    s_waitcnt vmcnt(7)
    ds_read_b64_tr_b16 a[8:9], v141 offset:0
    ds_read_b64_tr_b16 a[10:11], v141 offset:768
    ds_read_b64_tr_b16 a[32:33], v141 offset:32
    ds_read_b64_tr_b16 a[34:35], v141 offset:800
    ds_read_b64_tr_b16 a[56:57], v141 offset:64
    ds_read_b64_tr_b16 a[58:59], v141 offset:832
    v_add_f32 v61, v61, v119
    v_cmp_ne_u32 vcc, v160, v255
    v_sub_u32 v118, v185, v118
    v_lshrrev_b32 v129, 2, v129
    v_cndmask_b32 v119, 0, v163, vcc
    v_add_f32 v73, v73, v119
    v_lshrrev_b32 v118, 2, v118
    v_and_b32 v129, s5, v129
    buffer_load_dwordx4 v128, s[48:51], 0 offen offset:1024 lds
    v_and_b32 v118, s6, v118
    v_lshl_or_b32 v129, v129, 1, v118
    v_cmp_ne_u32 vcc, v129, v181
    v_lshl_add_u32 v160, v115, 2, 17
    v_mul_u32_u24 v118, 37, v160
    v_cndmask_b32 v185, 0, v163, vcc
    v_add_f32 v50, v50, v185
    v_cmp_ne_u32 vcc, v129, v254
    v_lshrrev_b32 v118, 8, v118
    v_mul_u32_u24 v185, 7, v118
    v_cndmask_b32 v119, 0, v163, vcc
    v_add_f32 v62, v62, v119
    v_cmp_ne_u32 vcc, v129, v255
    v_sub_u32 v185, v160, v185
    v_lshrrev_b32 v118, 2, v118
    buffer_load_dwordx4 v130, s[48:51], 0 offen offset:2048 lds
    s_sub_u32 s48, s48, 183552
    s_subb_u32 s49, s49, 0
    s_add_u32 m0, s68, 0
    s_waitcnt lgkmcnt(0)
    v_cndmask_b32 v119, 0, v163, vcc
    v_add_f32 v74, v74, v119
    v_lshrrev_b32 v185, 2, v185
    v_and_b32 v118, s5, v118
    v_and_b32 v185, s6, v185
    v_lshl_or_b32 v118, v118, 1, v185
    v_cmp_ne_u32 vcc, v118, v181
    v_lshl_add_u32 v129, v115, 2, 18
    v_mul_u32_u24 v160, 37, v129
    v_cndmask_b32 v119, 0, v163, vcc
    v_add_f32 v51, v51, v119
    buffer_load_dwordx4 v126, s[48:51], 0 offen lds
    s_waitcnt vmcnt(7)
    ds_read_b64_tr_b16 a[12:13], v141 offset:3072
    ds_read_b64_tr_b16 a[14:15], v141 offset:3840
    ds_read_b64_tr_b16 a[36:37], v141 offset:3104
    ds_read_b64_tr_b16 a[38:39], v141 offset:3872
    ds_read_b64_tr_b16 a[60:61], v141 offset:3136
    ds_read_b64_tr_b16 a[62:63], v141 offset:3904
    v_cmp_ne_u32 vcc, v118, v254
    v_lshrrev_b32 v160, 8, v160
    v_mul_u32_u24 v185, 7, v160
    v_cndmask_b32 v119, 0, v163, vcc
    v_add_f32 v63, v63, v119
    v_cmp_ne_u32 vcc, v118, v255
    v_sub_u32 v185, v129, v185
    v_lshrrev_b32 v160, 2, v160
    buffer_load_dwordx4 v128, s[48:51], 0 offen offset:1024 lds
    v_cndmask_b32 v129, 0, v163, vcc
    v_add_f32 v75, v75, v129
    v_lshrrev_b32 v185, 2, v185
    v_and_b32 v160, s5, v160
    v_and_b32 v185, s6, v185
    v_lshl_or_b32 v160, v160, 1, v185
    v_cmp_ne_u32 vcc, v160, v181
    v_lshl_add_u32 v129, v115, 2, 19
    v_mul_u32_u24 v118, 37, v129
    v_cndmask_b32 v185, 0, v163, vcc
    v_add_f32 v52, v52, v185
    v_cmp_ne_u32 vcc, v160, v254
    v_lshrrev_b32 v118, 8, v118
    v_mul_u32_u24 v185, 7, v118
    v_cndmask_b32 v119, 0, v163, vcc
    buffer_load_dwordx4 v130, s[48:51], 0 offen offset:2048 lds
    s_add_u32 s48, s48, 36864
    s_addc_u32 s49, s49, 0
    s_add_u32 m0, s68, 3072
    s_waitcnt lgkmcnt(0)
    v_add_f32 v64, v64, v119
    v_cmp_ne_u32 vcc, v160, v255
    v_sub_u32 v185, v129, v185
    v_lshrrev_b32 v118, 2, v118
    v_cndmask_b32 v119, 0, v163, vcc
    v_add_f32 v76, v76, v119
    v_lshrrev_b32 v185, 2, v185
    v_and_b32 v118, s5, v118
    v_and_b32 v185, s6, v185
    v_lshl_or_b32 v118, v118, 1, v185
    v_cmp_ne_u32 vcc, v118, v181
    buffer_load_dwordx4 v126, s[48:51], 0 offen lds
    s_waitcnt vmcnt(7)
    ds_read_b64_tr_b16 a[16:17], v139 offset:0
    ds_read_b64_tr_b16 a[18:19], v139 offset:768
    ds_read_b64_tr_b16 a[40:41], v139 offset:32
    ds_read_b64_tr_b16 a[42:43], v139 offset:800
    ds_read_b64_tr_b16 a[64:65], v139 offset:64
    ds_read_b64_tr_b16 a[66:67], v139 offset:832
    v_cndmask_b32 v119, 0, v163, vcc
    v_add_f32 v53, v53, v119
    v_cmp_ne_u32 vcc, v118, v254
    v_lshl_add_u32 v160, v115, 2, 32
    v_mul_u32_u24 v129, 37, v160
    v_cndmask_b32 v119, 0, v163, vcc
    v_add_f32 v65, v65, v119
    v_cmp_ne_u32 vcc, v118, v255
    buffer_load_dwordx4 v128, s[48:51], 0 offen offset:1024 lds
    v_lshrrev_b32 v129, 8, v129
    v_cndmask_b32 v185, 0, v163, vcc
    v_add_f32 v77, v77, v185
    v_mul_u32_u24 v185, 7, v129
    v_sub_u32 v185, v160, v185
    v_lshrrev_b32 v129, 2, v129
    v_lshrrev_b32 v185, 2, v185
    v_and_b32 v129, s5, v129
    v_and_b32 v185, s6, v185
    v_lshl_or_b32 v129, v129, 1, v185
    v_cmp_ne_u32 vcc, v129, v181
    v_lshl_add_u32 v118, v115, 2, 33
    v_mul_u32_u24 v185, 37, v118
    v_cndmask_b32 v160, 0, v163, vcc
    v_add_f32 v54, v54, v160
    buffer_load_dwordx4 v130, s[48:51], 0 offen offset:2048 lds
    s_add_u32 s48, s48, 36864
    s_addc_u32 s49, s49, 0
    s_add_u32 m0, s69, 0
    s_waitcnt lgkmcnt(0)
    v_cmp_ne_u32 vcc, v129, v254
    v_lshrrev_b32 v185, 8, v185
    v_mul_u32_u24 v160, 7, v185
    v_cndmask_b32 v119, 0, v163, vcc
    v_add_f32 v66, v66, v119
    v_cmp_ne_u32 vcc, v129, v255
    v_sub_u32 v160, v118, v160
    v_lshrrev_b32 v185, 2, v185
    v_cndmask_b32 v129, 0, v163, vcc
    v_add_f32 v78, v78, v129
    v_lshrrev_b32 v160, 2, v160
    buffer_load_dwordx4 v126, s[48:51], 0 offen lds
    s_waitcnt vmcnt(7)
    ds_read_b64_tr_b16 a[20:21], v139 offset:3072
    ds_read_b64_tr_b16 a[22:23], v139 offset:3840
    ds_read_b64_tr_b16 a[44:45], v139 offset:3104
    ds_read_b64_tr_b16 a[46:47], v139 offset:3872
    ds_read_b64_tr_b16 a[68:69], v139 offset:3136
    ds_read_b64_tr_b16 a[70:71], v139 offset:3904
    v_and_b32 v185, s5, v185
    v_and_b32 v160, s6, v160
    v_lshl_or_b32 v185, v185, 1, v160
    v_cmp_ne_u32 vcc, v185, v181
    v_lshl_add_u32 v129, v115, 2, 34
    v_mul_u32_u24 v160, 37, v129
    v_cndmask_b32 v118, 0, v163, vcc
    v_add_f32 v55, v55, v118
    buffer_load_dwordx4 v128, s[48:51], 0 offen offset:1024 lds
    v_cmp_ne_u32 vcc, v185, v254
    v_lshrrev_b32 v160, 8, v160
    v_mul_u32_u24 v119, 7, v160
    v_cndmask_b32 v118, 0, v163, vcc
    v_add_f32 v67, v67, v118
    v_cmp_ne_u32 vcc, v185, v255
    v_sub_u32 v119, v129, v119
    v_lshrrev_b32 v160, 2, v160
    v_cndmask_b32 v129, 0, v163, vcc
    v_add_f32 v79, v79, v129
    v_lshrrev_b32 v119, 2, v119
    v_and_b32 v160, s5, v160
    v_and_b32 v119, s6, v119
    v_lshl_or_b32 v160, v160, 1, v119
    v_cmp_ne_u32 vcc, v160, v181
    buffer_load_dwordx4 v130, s[48:51], 0 offen offset:2048 lds
    s_add_u32 s48, s48, 36864
    s_addc_u32 s49, s49, 0
    s_add_u32 m0, s69, 3072
    s_waitcnt lgkmcnt(0)
    v_cndmask_b32 v129, 0, v163, vcc
    v_add_f32 v56, v56, v129
    v_cmp_ne_u32 vcc, v160, v254
    v_lshl_add_u32 v129, v115, 2, 35
    v_mul_u32_u24 v118, 37, v129
    v_cndmask_b32 v185, 0, v163, vcc
    v_add_f32 v68, v68, v185
    v_cmp_ne_u32 vcc, v160, v255
    v_lshrrev_b32 v118, 8, v118
    v_mul_u32_u24 v119, 7, v118
    buffer_load_dwordx4 v126, s[48:51], 0 offen lds
    s_waitcnt vmcnt(7)
    ds_read_b64_tr_b16 a[144:145], v141 offset:0
    ds_read_b64_tr_b16 a[146:147], v141 offset:768
    ds_read_b64_tr_b16 a[168:169], v141 offset:32
    ds_read_b64_tr_b16 a[170:171], v141 offset:800
    ds_read_b64_tr_b16 a[192:193], v141 offset:64
    ds_read_b64_tr_b16 a[194:195], v141 offset:832
    v_cndmask_b32 v160, 0, v163, vcc
    v_add_f32 v80, v80, v160
    v_sub_u32 v119, v129, v119
    v_lshrrev_b32 v118, 2, v118
    v_lshrrev_b32 v119, 2, v119
    v_and_b32 v118, s5, v118
    v_and_b32 v119, s6, v119
    v_lshl_or_b32 v118, v118, 1, v119
    buffer_load_dwordx4 v128, s[48:51], 0 offen offset:1024 lds
    v_cmp_ne_u32 vcc, v118, v181
    v_cndmask_b32 v22, v180, v22, s[88:89]
    v_cndmask_b32 v24, v180, v24, s[88:89]
    v_cndmask_b32 v119, 0, v163, vcc
    v_add_f32 v57, v57, v119
    v_cmp_ne_u32 vcc, v118, v254
    v_mov_b32_dpp v23, v25 quad_perm:[0,1,2,3] row_mask:0x2 bank_mask:0xf
    v_cndmask_b32 v26, v180, v26, s[88:89]
    v_cndmask_b32 v119, 0, v163, vcc
    v_add_f32 v69, v69, v119
    v_cmp_ne_u32 vcc, v118, v255
    v_mov_b32_dpp v23, v27 quad_perm:[0,1,2,3] row_mask:0x4 bank_mask:0xf
    v_mov_b32 v134, 0
    v_cndmask_b32 v129, 0, v163, vcc
    v_add_f32 v81, v81, v129
    buffer_load_dwordx4 v130, s[48:51], 0 offen offset:2048 lds
    ds_read_b128 v[150:153], v161 offset:0
    ds_read_b128 v[122:125], v174 offset:0
    ds_read_b128 v[170:173], v161 offset:128
    s_add_u32 s48, s48, 36864
    s_addc_u32 s49, s49, 0
    ds_read_b128 v[162:165], v174 offset:128
    s_add_u32 m0, s68, 0
    s_waitcnt lgkmcnt(4)
    ds_read_b128 v[166:169], v161 offset:256
    ds_read_b128 v[114:117], v174 offset:256
    v_mov_b32 v135, 0
    buffer_load_dwordx4 v126, s[48:51], 0 offen lds
    s_waitcnt vmcnt(7)
    ds_read_b64_tr_b16 a[148:149], v141 offset:3072
    ds_read_b64_tr_b16 a[150:151], v141 offset:3840
    ds_read_b64_tr_b16 a[172:173], v141 offset:3104
    ds_read_b64_tr_b16 a[174:175], v141 offset:3872
    ds_read_b64_tr_b16 a[196:197], v141 offset:3136
    ds_read_b64_tr_b16 a[198:199], v141 offset:3904
    s_waitcnt lgkmcnt(11)
    v_mfma_f32_16x16x32_bf16 v[146:149], a[72:75], v[150:153], 0
    s_waitcnt lgkmcnt(9)
    ds_write_b64 v175, v[134:135] offset:56
    v_mfma_f32_16x16x32_bf16 v[146:149], a[76:79], v[122:125], v[146:149]
    s_waitcnt lgkmcnt(9)
    buffer_load_dwordx4 v128, s[48:51], 0 offen offset:1024 lds
    v_mov_b32 v136, 0
    v_mfma_f32_16x16x32_bf16 v[146:149], a[80:83], v[170:173], v[146:149]
    s_waitcnt lgkmcnt(8)
    ds_write_b64 v175, v[134:135] offset:64
    v_mfma_f32_16x16x32_bf16 v[146:149], a[84:87], v[162:165], v[146:149]
    s_waitcnt lgkmcnt(8)
    v_mov_b32 v137, 0
    v_mfma_f32_16x16x32_bf16 v[146:149], a[88:91], v[166:169], v[146:149]
    s_waitcnt lgkmcnt(6)
    ds_write_b128 v175, v[134:137] offset:16
    v_mfma_f32_16x16x32_bf16 v[146:149], a[92:95], v[114:117], v[146:149]
    s_waitcnt lgkmcnt(3)
    buffer_load_dwordx4 v130, s[48:51], 0 offen offset:2048 lds
    s_add_u32 s48, s48, 36864
    v_mfma_f32_16x16x32_bf16 v[154:157], a[96:99], v[150:153], 0
    s_addc_u32 s49, s49, 0
    s_add_u32 m0, s68, 3072
    v_mfma_f32_16x16x32_bf16 v[154:157], a[100:103], v[122:125], v[154:157]
    ds_write_b128 v176, v[134:137] offset:16
    v_mfma_f32_16x16x32_bf16 v[154:157], a[104:107], v[170:173], v[154:157]
    s_waitcnt vmcnt(6)
    v_fma_f32 v160, v146, v146, s32
    v_fmac_f32 v160, v147, v147
    v_mfma_f32_16x16x32_bf16 v[154:157], a[108:111], v[162:165], v[154:157]
    buffer_load_dwordx4 v126, s[48:51], 0 offen lds
    v_fmac_f32 v160, v148, v148
    v_mfma_f32_16x16x32_bf16 v[154:157], a[112:115], v[166:169], v[154:157]
    ds_read_b64_tr_b16 a[152:153], v139 offset:0
    ds_read_b64_tr_b16 a[154:155], v139 offset:768
    v_mfma_f32_16x16x32_bf16 v[154:157], a[116:119], v[114:117], v[154:157]
    ds_read_b64_tr_b16 a[176:177], v139 offset:32
    ds_read_b64_tr_b16 a[178:179], v139 offset:800
    v_mfma_f32_16x16x32_bf16 v[190:193], a[120:123], v[150:153], 0
    ds_read_b64_tr_b16 a[200:201], v139 offset:64
    ds_read_b64_tr_b16 a[202:203], v139 offset:832
    v_mfma_f32_16x16x32_bf16 v[190:193], a[124:127], v[122:125], v[190:193]
    ds_read_b128 v[202:205], v161 offset:6144
    ds_read_b128 v[230:233], v174 offset:6144
    v_mfma_f32_16x16x32_bf16 v[190:193], a[128:131], v[170:173], v[190:193]
    buffer_load_dwordx4 v128, s[48:51], 0 offen offset:1024 lds
    ds_read_b128 v[238:241], v161 offset:6272
    v_mfma_f32_16x16x32_bf16 v[190:193], a[132:135], v[162:165], v[190:193]
    ds_read_b128 v[206:209], v174 offset:6272
    ds_read_b128 v[198:201], v161 offset:6400
    v_mfma_f32_16x16x32_bf16 v[190:193], a[136:139], v[166:169], v[190:193]
    v_fmac_f32 v160, v149, v149
    v_fmac_f32 v160, v154, v154
    v_mfma_f32_16x16x32_bf16 v[190:193], a[140:143], v[114:117], v[190:193]
    ds_read_b128 v[210:213], v174 offset:6400
    v_fmac_f32 v160, v155, v155
    v_mfma_f32_16x16x32_bf16 v[214:217], a[0:3], v[150:153], 0
    s_waitcnt lgkmcnt(10)
    ds_write_b64 v176, v[134:135] offset:56
    v_mfma_f32_16x16x32_bf16 v[214:217], a[4:7], v[122:125], v[214:217]
    s_waitcnt lgkmcnt(8)
    buffer_load_dwordx4 v130, s[48:51], 0 offen offset:2048 lds
    v_fmac_f32 v160, v156, v156
    v_mfma_f32_16x16x32_bf16 v[214:217], a[8:11], v[170:173], v[214:217]
    s_waitcnt lgkmcnt(6)
    ds_write_b64 v176, v[134:135] offset:64
    v_mfma_f32_16x16x32_bf16 v[130:133], a[72:75], v[202:205], 0
    s_waitcnt vmcnt(6)
    v_fmac_f32 v160, v157, v157
    v_fmac_f32 v160, v190, v190
    v_mfma_f32_16x16x32_bf16 v[218:221], a[96:99], v[202:205], 0
    s_waitcnt lgkmcnt(3)
    ds_read_b64_tr_b16 a[156:157], v139 offset:3072
    ds_read_b64_tr_b16 a[158:159], v139 offset:3840
    v_mfma_f32_16x16x32_bf16 v[130:133], a[76:79], v[230:233], v[130:133]
    s_add_u32 m0, s28, 8192
    ds_read_b64_tr_b16 a[180:181], v139 offset:3104
    ds_read_b64_tr_b16 a[182:183], v139 offset:3872
    v_mfma_f32_16x16x32_bf16 v[130:133], a[80:83], v[238:241], v[130:133]
    s_waitcnt lgkmcnt(6)
    buffer_load_dwordx4 v12, s[8:11], s25 offen nt lds
    v_mfma_f32_16x16x32_bf16 v[130:133], a[84:87], v[206:209], v[130:133]
    s_add_u32 m0, s28, 12288
    ds_read_b64_tr_b16 a[204:205], v139 offset:3136
    ds_read_b64_tr_b16 a[206:207], v139 offset:3904
    v_mfma_f32_16x16x32_bf16 v[130:133], a[88:91], v[198:201], v[130:133]
    v_fmac_f32 v160, v191, v191
    v_fmac_f32 v160, v192, v192
    v_mfma_f32_16x16x32_bf16 v[130:133], a[92:95], v[210:213], v[130:133]
    v_fmac_f32 v160, v193, v193
    v_mfma_f32_16x16x32_bf16 v[218:221], a[100:103], v[230:233], v[218:221]
    v_mfma_f32_16x16x32_bf16 v[218:221], a[104:107], v[238:241], v[218:221]
    buffer_load_dwordx4 v13, s[8:11], s25 offen nt lds
    v_mfma_f32_16x16x32_bf16 v[218:221], a[108:111], v[206:209], v[218:221]
    s_add_u32 m0, s29, 0
    v_mfma_f32_16x16x32_bf16 v[218:221], a[112:115], v[198:201], v[218:221]
    s_waitcnt lgkmcnt(2)
    v_fma_f32 v181, v130, v130, s32
    v_fmac_f32 v181, v131, v131
    v_mfma_f32_16x16x32_bf16 v[218:221], a[116:119], v[210:213], v[218:221]
    v_fmac_f32 v181, v132, v132
    v_fmac_f32 v181, v133, v133
    v_mfma_f32_16x16x32_bf16 v[222:225], a[120:123], v[202:205], 0
    s_waitcnt lgkmcnt(0)
    v_mfma_f32_16x16x32_bf16 v[222:225], a[124:127], v[230:233], v[222:225]
    buffer_load_dwordx4 v14, s[8:11], s25 offen nt lds
    v_mfma_f32_16x16x32_bf16 v[222:225], a[128:131], v[238:241], v[222:225]
    s_add_u32 m0, s69, 0
    s_waitcnt vmcnt(6)
    ds_read_b64_tr_b16 a[160:161], v141 offset:0
    v_mfma_f32_16x16x32_bf16 v[222:225], a[132:135], v[206:209], v[222:225]
    s_lshr_b32 s10, s17, 1
    ds_read_b64_tr_b16 a[162:163], v141 offset:768
    ds_read_b64_tr_b16 a[184:185], v141 offset:32
    v_mfma_f32_16x16x32_bf16 v[222:225], a[136:139], v[198:201], v[222:225]
    s_cselect_b32 s10, s36, 0
    ds_read_b64_tr_b16 a[186:187], v141 offset:800
    ds_read_b64_tr_b16 a[208:209], v141 offset:64
    v_mfma_f32_16x16x32_bf16 v[222:225], a[140:143], v[210:213], v[222:225]
    s_mov_b32 s25, s24
    ds_read_b64_tr_b16 a[210:211], v141 offset:832
    v_fmac_f32 v181, v218, v218
    v_mfma_f32_16x16x32_bf16 v[214:217], a[12:15], v[162:165], v[214:217]
    buffer_load_dwordx4 v120, s[52:55], 0 offen lds
    v_fmac_f32 v181, v219, v219
    v_mfma_f32_16x16x32_bf16 v[214:217], a[16:19], v[166:169], v[214:217]
    v_fmac_f32 v181, v220, v220
    v_fmac_f32 v181, v221, v221
    v_mfma_f32_16x16x32_bf16 v[214:217], a[20:23], v[114:117], v[214:217]
    v_fmac_f32 v181, v222, v222
    v_fmac_f32 v181, v223, v223
    v_mfma_f32_16x16x32_bf16 v[134:137], a[24:27], v[150:153], 0
    v_fmac_f32 v181, v224, v224
    v_fmac_f32 v181, v225, v225
    v_mfma_f32_16x16x32_bf16 v[134:137], a[28:31], v[122:125], v[134:137]
    s_waitcnt lgkmcnt(5)
    v_xor_b32 v185, 65536, v2
    v_fma_f32 v118, v214, v214, s32
    v_mfma_f32_16x16x32_bf16 v[134:137], a[32:35], v[170:173], v[134:137]
    s_waitcnt lgkmcnt(3)
    buffer_load_dwordx4 v159, s[52:55], 0 offen offset:1024 lds
    v_fmac_f32 v118, v215, v215
    v_mfma_f32_16x16x32_bf16 v[134:137], a[36:39], v[162:165], v[134:137]
    s_waitcnt lgkmcnt(1)
    v_fmac_f32 v118, v216, v216
    v_fmac_f32 v118, v217, v217
    v_mfma_f32_16x16x32_bf16 v[134:137], a[40:43], v[166:169], v[134:137]
    s_waitcnt lgkmcnt(0)
    v_lshrrev_b32 v142, 2, v185
    v_lshrrev_b32 v143, 8, v185
    v_mfma_f32_16x16x32_bf16 v[134:137], a[44:47], v[114:117], v[134:137]
    v_lshl_add_u32 v254, s16, 2, v185
    v_add_u32 v142, 62784, v142
    v_mfma_f32_16x16x32_bf16 v[226:229], a[48:51], v[150:153], 0
    v_lshlrev_b32 v143, 4, v143
    v_add_u32 v143, 62784, v143
    v_mfma_f32_16x16x32_bf16 v[226:229], a[52:55], v[122:125], v[226:229]
    buffer_load_dwordx4 v121, s[52:55], 0 offen offset:2048 lds
    v_or_b32 v234, v32, v33
    v_mfma_f32_16x16x32_bf16 v[226:229], a[56:59], v[170:173], v[226:229]
    s_add_u32 s52, s52, 12288
    s_waitcnt vmcnt(6)
    ds_read_b64_tr_b16 a[164:165], v141 offset:3072
    v_mfma_f32_16x16x32_bf16 v[226:229], a[60:63], v[162:165], v[226:229]
    s_addc_u32 s53, s53, 0
    ds_read_b64_tr_b16 a[166:167], v141 offset:3840
    ds_read_b64_tr_b16 a[188:189], v141 offset:3104
    v_mfma_f32_16x16x32_bf16 v[226:229], a[64:67], v[166:169], v[226:229]
    s_add_u32 m0, s69, 3072
    ds_read_b64_tr_b16 a[190:191], v141 offset:3872
    ds_read_b64_tr_b16 a[212:213], v141 offset:3136
    v_mfma_f32_16x16x32_bf16 v[226:229], a[68:71], v[114:117], v[226:229]
    ds_read_b64_tr_b16 a[214:215], v141 offset:3904
    v_fmac_f32 v118, v134, v134
    v_mfma_f32_16x16x32_bf16 v[138:141], a[0:3], v[202:205], 0
    buffer_load_dwordx4 v120, s[52:55], 0 offen lds
    v_fmac_f32 v118, v135, v135
    v_mfma_f32_16x16x32_bf16 v[138:141], a[4:7], v[230:233], v[138:141]
    v_fmac_f32 v118, v136, v136
    v_fmac_f32 v118, v137, v137
    v_mfma_f32_16x16x32_bf16 v[138:141], a[8:11], v[238:241], v[138:141]
    v_fmac_f32 v118, v226, v226
    v_fmac_f32 v118, v227, v227
    v_mfma_f32_16x16x32_bf16 v[138:141], a[12:15], v[206:209], v[138:141]
    v_fmac_f32 v118, v228, v228
    v_fmac_f32 v118, v229, v229
    v_mfma_f32_16x16x32_bf16 v[138:141], a[16:19], v[198:201], v[138:141]
    s_waitcnt lgkmcnt(5)
    v_cvt_pk_bf16_f32 v36, v118, v160
    v_and_b32 v234, 0xffff, v234
    v_mfma_f32_16x16x32_bf16 v[138:141], a[20:23], v[210:213], v[138:141]
    s_waitcnt lgkmcnt(3)
    buffer_load_dwordx4 v159, s[52:55], 0 offen offset:1024 lds
    v_lshl_or_b32 v234, v234, 16, v234
    v_mfma_f32_16x16x32_bf16 v[242:245], v[32:35], v[36:39], 0
    s_waitcnt lgkmcnt(1)
    v_or_b32 v235, v32, v33
    v_and_b32 v235, 0xffff, v235
    v_mfma_f32_16x16x32_bf16 v[114:117], a[24:27], v[202:205], 0
    s_waitcnt lgkmcnt(0)
    v_lshl_or_b32 v235, v235, 16, v235
    v_or_b32 v236, v32, v33
    v_mfma_f32_16x16x32_bf16 v[114:117], a[28:31], v[230:233], v[114:117]
    v_rsq_f32 v243, v243
    v_mfma_f32_16x16x32_bf16 v[114:117], a[32:35], v[238:241], v[114:117]
    v_rsq_f32 v242, v242
    v_mfma_f32_16x16x32_bf16 v[114:117], a[36:39], v[206:209], v[114:117]
    buffer_load_dwordx4 v121, s[52:55], 0 offen offset:2048 lds
    ds_read_b128 v[186:189], v0 offset:20480
    v_mfma_f32_16x16x32_bf16 v[114:117], a[40:43], v[198:201], v[114:117]
    s_add_u32 s52, s52, 12288
    ds_read_b128 v[194:197], v1 offset:20480
    v_mul_f32 v242, s31, v242
    v_mfma_f32_16x16x32_bf16 v[114:117], a[44:47], v[210:213], v[114:117]
    s_addc_u32 s53, s53, 0
    ds_read_b128 v[122:125], v0 offset:20608
    v_mul_f32 v146, v243, v146
    v_mfma_f32_16x16x32_bf16 v[246:249], a[48:51], v[202:205], 0
    s_add_u32 m0, s68, 0
    ds_read_b128 v[202:205], v1 offset:20608
    v_mul_f32 v147, v243, v147
    v_mfma_f32_16x16x32_bf16 v[246:249], a[52:55], v[230:233], v[246:249]
    ds_read_b128 v[230:233], v0 offset:20736
    v_cvt_pk_f16_f32 v150, v146, v147
    v_mfma_f32_16x16x32_bf16 v[246:249], a[56:59], v[238:241], v[246:249]
    buffer_load_dwordx4 v120, s[52:55], 0 offen lds
    ds_read_b128 v[238:241], v1 offset:20736
    v_mfma_f32_16x16x32_bf16 v[246:249], a[60:63], v[206:209], v[246:249]
    v_mul_f32 v148, v243, v148
    v_mul_f32 v149, v243, v149
    v_mfma_f32_16x16x32_bf16 v[246:249], a[64:67], v[198:201], v[246:249]
    v_cvt_pk_f16_f32 v151, v148, v149
    v_mul_f32 v154, v243, v154
    v_mfma_f32_16x16x32_bf16 v[246:249], a[68:71], v[210:213], v[246:249]
    s_waitcnt lgkmcnt(5)
    v_mul_f32 v155, v243, v155
    v_cvt_pk_f16_f32 v152, v154, v155
    v_mfma_f32_16x16x32_bf16 v[162:165], a[96:99], v[186:189], 0
    s_waitcnt lgkmcnt(4)
    v_mul_f32 v156, v243, v156
    v_mul_f32 v157, v243, v157
    v_mfma_f32_16x16x32_bf16 v[162:165], a[100:103], v[194:197], v[162:165]
    s_waitcnt lgkmcnt(3)
    v_cvt_pk_f16_f32 v153, v156, v157
    v_mul_f32 v190, v243, v190
    v_mfma_f32_16x16x32_bf16 v[162:165], a[104:107], v[122:125], v[162:165]
    s_waitcnt lgkmcnt(2)
    ds_write_b128 v175, v[150:153]
    v_mfma_f32_16x16x32_bf16 v[162:165], a[108:111], v[202:205], v[162:165]
    s_waitcnt lgkmcnt(1)
    v_mul_f32 v191, v243, v191
    v_cvt_pk_f16_f32 v208, v190, v191
    v_mfma_f32_16x16x32_bf16 v[162:165], a[112:115], v[230:233], v[162:165]
    v_mul_f32 v192, v243, v192
    v_mul_f32 v193, v243, v193
    v_mfma_f32_16x16x32_bf16 v[162:165], a[116:119], v[238:241], v[162:165]
    v_cvt_pk_f16_f32 v209, v192, v193
    v_mul_f32 v214, v242, v214
    v_mfma_f32_16x16x32_bf16 v[170:173], a[120:123], v[186:189], 0
    ds_write_b64 v175, v[208:209] offset:48
    v_mfma_f32_16x16x32_bf16 v[170:173], a[124:127], v[194:197], v[170:173]
    v_mul_f32 v215, v242, v215
    v_cvt_pk_f16_f32 v150, v214, v215
    v_mfma_f32_16x16x32_bf16 v[170:173], a[128:131], v[122:125], v[170:173]
    v_mul_f32 v216, v242, v216
    v_mul_f32 v217, v242, v217
    v_mfma_f32_16x16x32_bf16 v[170:173], a[132:135], v[202:205], v[170:173]
    v_cvt_pk_f16_f32 v151, v216, v217
    v_mul_f32 v134, v242, v134
    v_mfma_f32_16x16x32_bf16 v[170:173], a[136:139], v[230:233], v[170:173]
    v_mul_f32 v135, v242, v135
    v_cvt_pk_f16_f32 v152, v134, v135
    v_mfma_f32_16x16x32_bf16 v[170:173], a[140:143], v[238:241], v[170:173]
    v_mul_f32 v136, v242, v136
    v_mul_f32 v137, v242, v137
    v_mfma_f32_16x16x32_bf16 v[166:169], a[24:27], v[186:189], 0
    v_cvt_pk_f16_f32 v153, v136, v137
    v_mul_f32 v226, v242, v226
    v_mfma_f32_16x16x32_bf16 v[166:169], a[28:31], v[194:197], v[166:169]
    ds_write_b128 v175, v[150:153] offset:32
    v_mfma_f32_16x16x32_bf16 v[150:153], a[72:75], v[186:189], 0
    v_mul_f32 v227, v242, v227
    v_cvt_pk_f16_f32 v206, v226, v227
    v_mfma_f32_16x16x32_bf16 v[150:153], a[76:79], v[194:197], v[150:153]
    v_mul_f32 v228, v242, v228
    v_mul_f32 v229, v242, v229
    v_mfma_f32_16x16x32_bf16 v[150:153], a[80:83], v[122:125], v[150:153]
    v_cvt_pk_f16_f32 v207, v228, v229
    v_mul_f32 v146, v214, v146
    v_mfma_f32_16x16x32_bf16 v[150:153], a[84:87], v[202:205], v[150:153]
    ds_write_b64 v175, v[206:207] offset:72
    v_mfma_f32_16x16x32_bf16 v[150:153], a[88:91], v[230:233], v[150:153]
    v_fmac_f32 v146, v215, v147
    v_fmac_f32 v146, v216, v148
    v_mfma_f32_16x16x32_bf16 v[150:153], a[92:95], v[238:241], v[150:153]
    v_fmac_f32 v146, v217, v149
    v_fmac_f32 v146, v134, v154
    v_mfma_f32_16x16x32_bf16 v[166:169], a[32:35], v[122:125], v[166:169]
    v_fmac_f32 v146, v135, v155
    v_fmac_f32 v146, v136, v156
    v_mfma_f32_16x16x32_bf16 v[166:169], a[36:39], v[202:205], v[166:169]
    v_fmac_f32 v146, v137, v157
    v_fmac_f32 v146, v226, v190
    v_mfma_f32_16x16x32_bf16 v[166:169], a[40:43], v[230:233], v[166:169]
    v_fmac_f32 v146, v227, v191
    v_fmac_f32 v146, v228, v192
    v_mfma_f32_16x16x32_bf16 v[166:169], a[44:47], v[238:241], v[166:169]
    v_fmac_f32 v146, v229, v193
    v_mov_b32 v160, v146
    v_mfma_f32_16x16x32_bf16 v[134:137], a[48:51], v[186:189], 0
    v_lshrrev_b32 v236, 16, v236
    v_lshl_or_b32 v236, v236, 16, v236
    v_mfma_f32_16x16x32_bf16 v[134:137], a[52:55], v[194:197], v[134:137]
    v_permlane32_swap_b32 v146, v160
    v_mfma_f32_16x16x32_bf16 v[134:137], a[56:59], v[122:125], v[134:137]
    v_add_f32 v146, v146, v160
    v_mov_b32 v160, v146
    v_mfma_f32_16x16x32_bf16 v[134:137], a[60:63], v[202:205], v[134:137]
    v_or_b32 v237, v32, v33
    v_lshrrev_b32 v237, 16, v237
    v_mfma_f32_16x16x32_bf16 v[134:137], a[64:67], v[230:233], v[134:137]
    v_permlane16_swap_b32 v146, v160
    v_mfma_f32_16x16x32_bf16 v[134:137], a[68:71], v[238:241], v[134:137]
    v_add_f32 v146, v146, v160
    v_add_f32 v146, s39, v146
    v_mfma_f32_16x16x32_bf16 v[154:157], v[186:189], a[144:147], 0
    v_mov_b32 v147, v180
    v_mov_b32 v148, v180
    v_mfma_f32_16x16x32_bf16 v[154:157], v[194:197], a[148:151], v[154:157]
    v_mov_b32 v149, v180
    v_cndmask_b32 v146, v180, v146, s[88:89]
    v_mfma_f32_16x16x32_bf16 v[154:157], v[122:125], a[152:155], v[154:157]
    ds_write_b128 v158, v[146:149] offset:192
    v_mfma_f32_16x16x32_bf16 v[154:157], v[202:205], a[156:159], v[154:157]
    v_lshl_or_b32 v237, v237, 16, v237
    v_fma_f32 v175, v138, v138, s32
    v_mfma_f32_16x16x32_bf16 v[154:157], v[230:233], a[160:163], v[154:157]
    v_fmac_f32 v175, v139, v139
    v_fmac_f32 v175, v140, v140
    v_mfma_f32_16x16x32_bf16 v[154:157], v[238:241], a[164:167], v[154:157]
    v_fmac_f32 v175, v141, v141
    v_fmac_f32 v175, v114, v114
    v_mfma_f32_16x16x32_bf16 v[146:149], v[186:189], a[168:171], 0
    v_fmac_f32 v175, v115, v115
    v_fmac_f32 v175, v116, v116
    v_mfma_f32_16x16x32_bf16 v[146:149], v[194:197], a[172:175], v[146:149]
    v_fmac_f32 v175, v117, v117
    v_fmac_f32 v175, v246, v246
    v_mfma_f32_16x16x32_bf16 v[146:149], v[122:125], a[176:179], v[146:149]
    v_fmac_f32 v175, v247, v247
    v_fmac_f32 v175, v248, v248
    v_mfma_f32_16x16x32_bf16 v[146:149], v[202:205], a[180:183], v[146:149]
    ds_read_b128 v[190:193], v161 offset:0
    v_fmac_f32 v175, v249, v249
    v_mfma_f32_16x16x32_bf16 v[146:149], v[230:233], a[184:187], v[146:149]
    ds_read_b128 v[206:209], v174 offset:0
    v_cvt_pk_bf16_f32 v36, v175, v181
    v_mfma_f32_16x16x32_bf16 v[146:149], v[238:241], a[188:191], v[146:149]
    ds_read_b128 v[214:217], v161 offset:128
    v_fma_f32 v255, v150, v150, s32
    v_fmac_f32 v255, v151, v151
    v_fmac_f32 v255, v152, v152
    v_fmac_f32 v255, v153, v153
    v_fmac_f32 v255, v162, v162
    v_fmac_f32 v255, v163, v163
    v_fmac_f32 v255, v164, v164
    v_fmac_f32 v255, v165, v165
    v_fmac_f32 v255, v170, v170
    v_fmac_f32 v255, v171, v171
    v_fmac_f32 v255, v172, v172
    v_fmac_f32 v255, v173, v173
    v_cvt_pk_bf16_f32 v118, v154, v155
    v_mfma_f32_16x16x32_bf16 v[198:201], v[32:35], v[36:39], 0
    v_cvt_pk_bf16_f32 v119, v156, v157
    v_cvt_pk_bf16_f32 v146, v146, v147
    v_mfma_f32_16x16x32_bf16 v[154:157], v[186:189], a[192:195], 0
    v_cvt_pk_bf16_f32 v147, v148, v149
    v_xor_b32 v2, 65536, v2
    v_mfma_f32_16x16x32_bf16 v[154:157], v[194:197], a[196:199], v[154:157]
    s_waitcnt lgkmcnt(2)
    v_mfma_f32_16x16x32_bf16 v[154:157], v[122:125], a[200:203], v[154:157]
    s_waitcnt lgkmcnt(1)
    v_rsq_f32 v199, v199
    v_mfma_f32_16x16x32_bf16 v[154:157], v[202:205], a[204:207], v[154:157]
    s_waitcnt lgkmcnt(0)
    v_rsq_f32 v198, v198
    v_mfma_f32_16x16x32_bf16 v[154:157], v[230:233], a[208:211], v[154:157]
    v_mul_f32 v198, s31, v198
    v_mul_f32 v130, v199, v130
    v_mfma_f32_16x16x32_bf16 v[154:157], v[238:241], a[212:215], v[154:157]
    v_mul_f32 v131, v199, v131
    v_cvt_pk_f16_f32 v210, v130, v131
    v_mul_f32 v132, v199, v132
    v_mul_f32 v133, v199, v133
    v_cvt_pk_f16_f32 v211, v132, v133
    v_mul_f32 v218, v199, v218
    v_mul_f32 v219, v199, v219
    v_cvt_pk_f16_f32 v212, v218, v219
    v_mul_f32 v220, v199, v220
    v_mul_f32 v221, v199, v221
    v_cvt_pk_f16_f32 v213, v220, v221
    v_mul_f32 v222, v199, v222
    v_mul_f32 v223, v199, v223
    v_cvt_pk_f16_f32 v228, v222, v223
    v_mul_f32 v224, v199, v224
    v_mul_f32 v225, v199, v225
    v_cvt_pk_f16_f32 v229, v224, v225
    v_mul_f32 v138, v198, v138
    v_mul_f32 v139, v198, v139
    v_cvt_pk_f16_f32 v242, v138, v139
    v_mul_f32 v140, v198, v140
    v_mul_f32 v141, v198, v141
    v_cvt_pk_f16_f32 v243, v140, v141
    v_mul_f32 v114, v198, v114
    v_mul_f32 v115, v198, v115
    v_cvt_pk_f16_f32 v244, v114, v115
    v_mul_f32 v116, v198, v116
    v_mul_f32 v117, v198, v117
    v_cvt_pk_f16_f32 v245, v116, v117
    v_mul_f32 v246, v198, v246
    v_mul_f32 v247, v198, v247
    v_cvt_pk_f16_f32 v226, v246, v247
    v_mul_f32 v248, v198, v248
    v_mul_f32 v249, v198, v249
    v_cvt_pk_f16_f32 v227, v248, v249
    v_mul_f32 v130, v138, v130
    v_fmac_f32 v130, v139, v131
    buffer_load_dwordx4 v159, s[52:55], 0 offen offset:1024 lds
    ds_write_b128 v176, v[210:213]
    v_fmac_f32 v130, v140, v132
    v_fmac_f32 v130, v141, v133
    v_fmac_f32 v130, v114, v218
    v_mfma_f32_16x16x32_bf16 v[138:141], a[0:3], v[186:189], 0
    v_fmac_f32 v130, v115, v219
    v_fmac_f32 v130, v116, v220
    v_mfma_f32_16x16x32_bf16 v[138:141], a[4:7], v[194:197], v[138:141]
    ds_read_b128 v[194:197], v174 offset:128
    ds_read_b128 v[186:189], v161 offset:256
    v_mfma_f32_16x16x32_bf16 v[138:141], a[8:11], v[122:125], v[138:141]
    ds_read_b128 v[122:125], v174 offset:256
    buffer_load_dwordx4 v121, s[52:55], 0 offen offset:2048 lds
    v_mfma_f32_16x16x32_bf16 v[138:141], a[12:15], v[202:205], v[138:141]
    s_add_u32 s52, s52, 12288
    ds_write_b64 v176, v[228:229] offset:48
    v_mfma_f32_16x16x32_bf16 v[138:141], a[16:19], v[230:233], v[138:141]
    s_addc_u32 s53, s53, 0
    v_fmac_f32 v130, v117, v221
    v_fmac_f32 v130, v246, v222
    v_mfma_f32_16x16x32_bf16 v[138:141], a[20:23], v[238:241], v[138:141]
    s_add_u32 m0, s68, 3072
    ds_write_b128 v176, v[242:245] offset:32
    v_mfma_f32_16x16x32_bf16 v[114:117], v[190:193], a[144:147], 0
    s_mul_i32 s68, s78, 72
    v_fmac_f32 v130, v247, v223
    v_fmac_f32 v130, v248, v224
    v_mfma_f32_16x16x32_bf16 v[114:117], v[206:209], a[148:151], v[114:117]
    buffer_load_dwordx4 v120, s[52:55], 0 offen lds
    v_fmac_f32 v130, v249, v225
    v_mfma_f32_16x16x32_bf16 v[114:117], v[214:217], a[152:155], v[114:117]
    s_waitcnt lgkmcnt(3)
    ds_write_b64 v176, v[226:227] offset:72
    v_mfma_f32_16x16x32_bf16 v[114:117], v[194:197], a[156:159], v[114:117]
    s_sub_u32 s68, s77, s68
    v_mov_b32 v148, v130
    v_fma_f32 v181, v138, v138, s32
    v_mfma_f32_16x16x32_bf16 v[114:117], v[186:189], a[160:163], v[114:117]
    s_waitcnt lgkmcnt(2)
    v_permlane32_swap_b32 v130, v148
    v_mfma_f32_16x16x32_bf16 v[114:117], v[122:125], a[164:167], v[114:117]
    s_mul_i32 s78, s78, 1373568
    v_add_f32 v130, v130, v148
    v_mov_b32 v148, v130
    v_mfma_f32_16x16x32_bf16 v[230:233], v[190:193], a[168:171], 0
    buffer_load_dwordx4 v159, s[52:55], 0 offen offset:1024 lds
    v_fmac_f32 v181, v139, v139
    v_mfma_f32_16x16x32_bf16 v[230:233], v[206:209], a[172:175], v[230:233]
    s_mul_i32 s77, s68, 2688
    v_permlane16_swap_b32 v130, v148
    v_mfma_f32_16x16x32_bf16 v[230:233], v[214:217], a[176:179], v[230:233]
    s_add_u32 s77, s77, s78
    v_add_f32 v130, v130, v148
    v_add_f32 v130, s39, v130
    v_mfma_f32_16x16x32_bf16 v[230:233], v[194:197], a[180:183], v[230:233]
    ds_read_b128 v[238:241], v161 offset:6144
    v_mov_b32 v131, v180
    v_mfma_f32_16x16x32_bf16 v[230:233], v[186:189], a[184:187], v[230:233]
    ds_read_b128 v[202:205], v174 offset:6144
    v_mov_b32 v132, v180
    v_mfma_f32_16x16x32_bf16 v[230:233], v[122:125], a[188:191], v[230:233]
    buffer_load_dwordx4 v121, s[52:55], 0 offen offset:2048 lds
    ds_read_b128 v[218:221], v161 offset:6272
    v_mfma_f32_16x16x32_bf16 v[222:225], v[190:193], a[192:195], 0
    s_add_u32 s52, s52, 12288
    ds_read_b128 v[190:193], v174 offset:6272
    v_mov_b32 v133, v180
    v_mfma_f32_16x16x32_bf16 v[222:225], v[206:209], a[196:199], v[222:225]
    s_waitcnt vmcnt(9)
    ds_read_b64 a[216:217], v183 offset:0
    ds_read_b64 a[218:219], v183 offset:1536
    v_mfma_f32_16x16x32_bf16 v[222:225], v[214:217], a[200:203], v[222:225]
    s_addc_u32 s53, s53, 0
    ds_read_b64 a[240:241], v183 offset:8
    ds_read_b64 a[242:243], v183 offset:1544
    v_mfma_f32_16x16x32_bf16 v[222:225], v[194:197], a[204:207], v[222:225]
    s_add_u32 m0, s69, 0
    ds_read_b64 v[90:91], v184 offset:0
    ds_read_b64 v[92:93], v184 offset:1536
    v_mfma_f32_16x16x32_bf16 v[222:225], v[186:189], a[208:211], v[222:225]
    ds_read_b128 v[194:197], v161 offset:6400
    ds_read_b128 v[186:189], v174 offset:6400
    v_mfma_f32_16x16x32_bf16 v[222:225], v[122:125], a[212:215], v[222:225]
    s_waitcnt lgkmcnt(11)
    v_cndmask_b32 v130, v180, v130, s[88:89]
    v_fmac_f32 v181, v140, v140
    v_mfma_f32_16x16x32_bf16 v[122:125], v[238:241], a[144:147], 0
    s_waitcnt lgkmcnt(10)
    ds_write_b128 v179, v[130:133] offset:192
    v_mfma_f32_16x16x32_bf16 v[122:125], v[202:205], a[148:151], v[122:125]
    s_waitcnt lgkmcnt(9)
    v_fmac_f32 v181, v141, v141
    v_fmac_f32 v181, v166, v166
    v_mfma_f32_16x16x32_bf16 v[122:125], v[218:221], a[152:155], v[122:125]
    s_waitcnt lgkmcnt(7)
    v_fmac_f32 v181, v167, v167
    v_fmac_f32 v181, v168, v168
    v_mfma_f32_16x16x32_bf16 v[130:133], v[234:237], a[216:219], 0
    s_waitcnt lgkmcnt(5)
    v_fmac_f32 v181, v169, v169
    v_fmac_f32 v181, v134, v134
    v_mfma_f32_16x16x32_bf16 v[130:133], v[234:237], a[240:243], v[130:133]
    s_waitcnt lgkmcnt(3)
    buffer_load_dwordx4 v120, s[52:55], 0 offen lds
    v_fmac_f32 v181, v135, v135
    v_mfma_f32_16x16x32_bf16 v[130:133], v[234:237], v[90:93], v[130:133]
    s_waitcnt lgkmcnt(1)
    v_fmac_f32 v181, v136, v136
    v_fmac_f32 v181, v137, v137
    v_mfma_f32_16x16x32_bf16 v[122:125], v[190:193], a[156:159], v[122:125]
    v_cvt_pk_bf16_f32 v36, v181, v255
    v_cvt_pk_bf16_f32 v174, v154, v155
    v_mfma_f32_16x16x32_bf16 v[122:125], v[194:197], a[160:163], v[122:125]
    s_waitcnt vmcnt(7)
    ds_read_b64 a[232:233], v183 offset:3072
    ds_read_b64 a[220:221], v183 offset:4608
    v_mfma_f32_16x16x32_bf16 v[214:217], v[32:35], v[36:39], 0
    ds_read_b64 v[82:83], v183 offset:3080
    ds_read_b64 a[244:245], v183 offset:4616
    v_mfma_f32_16x16x32_bf16 v[122:125], v[186:189], a[164:167], v[122:125]
    buffer_load_dwordx4 v159, s[52:55], 0 offen offset:1024 lds
    ds_read_b64 v[106:107], v184 offset:3072
    v_mfma_f32_16x16x32_bf16 v[206:209], v[238:241], a[168:171], 0
    ds_read_b64 v[94:95], v184 offset:4608
    v_mov_b32 v255, v130
    v_mfma_f32_16x16x32_bf16 v[206:209], v[202:205], a[172:175], v[206:209]
    v_rsq_f32 v215, v215
    v_mfma_f32_16x16x32_bf16 v[206:209], v[218:221], a[176:179], v[206:209]
    v_mov_b32_dpp v255, v131 quad_perm:[0,1,2,3] row_mask:0x2 bank_mask:0xf
    v_mul_f32 v150, v215, v150
    v_mfma_f32_16x16x32_bf16 v[206:209], v[190:193], a[180:183], v[206:209]
    v_rsq_f32 v214, v214
    v_mfma_f32_16x16x32_bf16 v[206:209], v[194:197], a[184:187], v[206:209]
    buffer_load_dwordx4 v121, s[52:55], 0 offen offset:2048 lds
    v_mul_f32 v214, s31, v214
    v_mfma_f32_16x16x32_bf16 v[206:209], v[186:189], a[188:191], v[206:209]
    s_add_u32 s52, s52, 12288
    v_mul_f32 v151, v215, v151
    v_cvt_pk_f16_f32 v130, v150, v151
    v_mfma_f32_16x16x32_bf16 v[246:249], v[238:241], a[192:195], 0
    s_addc_u32 s53, s53, 0
    v_mul_f32 v152, v215, v152
    v_mul_f32 v153, v215, v153
    v_mfma_f32_16x16x32_bf16 v[246:249], v[202:205], a[196:199], v[246:249]
    s_add_u32 m0, s69, 3072
    v_cvt_pk_f16_f32 v131, v152, v153
    v_mul_f32 v162, v215, v162
    v_mfma_f32_16x16x32_bf16 v[246:249], v[218:221], a[200:203], v[246:249]
    s_waitcnt lgkmcnt(0)
    v_mul_f32 v163, v215, v163
    v_cvt_pk_f16_f32 v132, v162, v163
    v_mfma_f32_16x16x32_bf16 v[246:249], v[190:193], a[204:207], v[246:249]
    buffer_load_dwordx4 v120, s[52:55], 0 offen lds
    v_mul_f32 v164, v215, v164
    s_waitcnt vmcnt(7)
    v_mfma_f32_16x16x32_bf16 v[246:249], v[194:197], a[208:211], v[246:249]
    s_add_u32 s69, s77, 589824
    ds_read_b64 a[222:223], v182 offset:0
    ds_read_b64 a[234:235], v182 offset:1536
    v_mfma_f32_16x16x32_bf16 v[246:249], v[186:189], a[212:215], v[246:249]
    s_barrier
    s_barrier
    ds_read_b64 a[246:247], v182 offset:8
    ds_read_b64 v[84:85], v182 offset:1544
    ds_read_b64 v[96:97], v127 offset:0
    ds_read_b64 v[108:109], v127 offset:1536
    ds_read_b128 v[150:153], v0 offset:26624
    ds_read_b128 v[186:189], v1 offset:26624
    buffer_load_dwordx4 v159, s[52:55], 0 offen offset:1024 lds
    ds_read_b128 v[238:241], v0 offset:26752
    ds_read_b128 v[202:205], v1 offset:26752
    ds_read_b128 v[158:161], v0 offset:26880
    ds_read_b128 v[190:193], v1 offset:26880
    v_mul_f32 v165, v215, v165
    s_waitcnt lgkmcnt(11)
    v_mfma_f32_16x16x32_bf16 v[194:197], v[234:237], a[220:223], 0
    s_waitcnt lgkmcnt(10)
    buffer_load_dwordx4 v121, s[52:55], 0 offen offset:2048 lds
    v_cvt_pk_f16_f32 v133, v164, v165
    v_mfma_f32_16x16x32_bf16 v[162:165], v[234:237], a[232:235], 0
    s_waitcnt lgkmcnt(8)
    v_mul_f32 v170, v215, v170
    v_mul_f32 v171, v215, v171
    v_mfma_f32_16x16x32_bf16 v[194:197], v[234:237], a[244:247], v[194:197]
    s_waitcnt lgkmcnt(4)
    v_cvt_pk_f16_f32 v128, v170, v171
    v_mul_f32 v172, v215, v172
    v_mfma_f32_16x16x32_bf16 v[194:197], v[234:237], v[94:97], v[194:197]
    s_add_u32 m0, s28, 65536
    v_mul_f32 v173, v215, v173
    v_cvt_pk_f16_f32 v129, v172, v173
    v_mfma_f32_16x16x32_bf16 v[162:165], v[234:237], v[82:85], v[162:165]
    s_waitcnt lgkmcnt(2)
    v_mul_f32 v138, v214, v138
    s_waitcnt vmcnt(6)
    v_mfma_f32_16x16x32_bf16 v[162:165], v[234:237], v[106:109], v[162:165]
    s_waitcnt lgkmcnt(1)
    buffer_load_dwordx4 v10, s[8:11], s24 offen nt lds
    v_mfma_f32_16x16x32_bf16 v[170:173], a[72:75], v[150:153], 0
    s_add_u32 m0, s28, 69632
    ds_read_b64 a[224:225], v182 offset:3072
    ds_read_b64 a[226:227], v182 offset:4608
    v_mfma_f32_16x16x32_bf16 v[170:173], a[76:79], v[186:189], v[170:173]
    s_waitcnt lgkmcnt(2)
    ds_read_b64 a[248:249], v182 offset:3080
    ds_read_b64 a[250:251], v182 offset:4616
    v_mfma_f32_16x16x32_bf16 v[170:173], a[80:83], v[238:241], v[170:173]
    ds_read_b64 v[98:99], v127 offset:3072
    ds_read_b64 v[100:101], v127 offset:4608
    v_mfma_f32_16x16x32_bf16 v[170:173], a[84:87], v[202:205], v[170:173]
    v_mov_b32_dpp v255, v162 quad_perm:[0,1,2,3] row_mask:0x4 bank_mask:0xf
    v_mov_b32 v182, v195
    v_mfma_f32_16x16x32_bf16 v[170:173], a[88:91], v[158:161], v[170:173]
    buffer_load_dwordx4 v11, s[8:11], s24 offen nt lds
    v_mfma_f32_16x16x32_bf16 v[170:173], a[92:95], v[190:193], v[170:173]
    s_add_u32 m0, s28, 73728
    v_mov_b32_dpp v255, v194 quad_perm:[0,1,2,3] row_mask:0x8 bank_mask:0xf
    v_mov_b32_dpp v182, v163 quad_perm:[0,1,2,3] row_mask:0x2 bank_mask:0xf
    v_mfma_f32_16x16x32_bf16 v[162:165], a[96:99], v[150:153], 0
    ds_write_b32 v254, v255 offset:18432
    v_mfma_f32_16x16x32_bf16 v[162:165], a[100:103], v[186:189], v[162:165]
    v_mul_f32 v139, v214, v139
    v_cvt_pk_f16_f32 v138, v138, v139
    v_mfma_f32_16x16x32_bf16 v[162:165], a[104:107], v[238:241], v[162:165]
    s_waitcnt lgkmcnt(5)
    v_mul_f32 v140, v214, v140
    v_mul_f32 v141, v214, v141
    v_mfma_f32_16x16x32_bf16 v[194:197], v[234:237], a[224:227], 0
    s_waitcnt lgkmcnt(3)
    buffer_load_dwordx4 v12, s[8:11], s24 offen nt lds
    v_mfma_f32_16x16x32_bf16 v[194:197], v[234:237], a[248:251], v[194:197]
    s_waitcnt lgkmcnt(1)
    v_cvt_pk_f16_f32 v139, v140, v141
    v_mul_f32 v166, v214, v166
    v_mfma_f32_16x16x32_bf16 v[194:197], v[234:237], v[98:101], v[194:197]
    s_add_u32 m0, s28, 77824
    v_mul_f32 v167, v214, v167
    s_waitcnt vmcnt(6)
    v_mfma_f32_16x16x32_bf16 v[162:165], a[108:111], v[202:205], v[162:165]
    ds_read_b64 a[236:237], v183 offset:0
    ds_read_b64 a[228:229], v183 offset:1536
    v_mfma_f32_16x16x32_bf16 v[162:165], a[112:115], v[158:161], v[162:165]
    ds_read_b64 v[86:87], v183 offset:8
    ds_read_b64 a[252:253], v183 offset:1544
    v_mfma_f32_16x16x32_bf16 v[162:165], a[116:119], v[190:193], v[162:165]
    buffer_load_dwordx4 v13, s[8:11], s24 offen nt lds
    v_mfma_f32_16x16x32_bf16 v[218:221], a[120:123], v[150:153], 0
    s_add_u32 m0, s74, 0
    ds_read_b64 v[110:111], v184 offset:0
    ds_read_b64 v[102:103], v184 offset:1536
    v_mfma_f32_16x16x32_bf16 v[218:221], a[124:127], v[186:189], v[218:221]
    v_mov_b32_dpp v182, v194 quad_perm:[0,1,2,3] row_mask:0x4 bank_mask:0xf
    v_cvt_pk_f16_f32 v140, v166, v167
    v_mfma_f32_16x16x32_bf16 v[218:221], a[128:131], v[238:241], v[218:221]
    v_mov_b32_dpp v182, v195 quad_perm:[0,1,2,3] row_mask:0x8 bank_mask:0xf
    v_mul_f32 v168, v214, v168
    v_mfma_f32_16x16x32_bf16 v[218:221], a[132:135], v[202:205], v[218:221]
    ds_write_b32 v254, v182 offset:19456
    v_mfma_f32_16x16x32_bf16 v[218:221], a[136:139], v[158:161], v[218:221]
    buffer_load_dwordx4 v14, s[8:11], s24 offen nt lds
    v_mfma_f32_16x16x32_bf16 v[218:221], a[140:143], v[190:193], v[218:221]
    s_add_u32 s8, s60, s23
    v_mul_f32 v169, v214, v169
    v_cvt_pk_f16_f32 v141, v168, v169
    v_mfma_f32_16x16x32_bf16 v[166:169], a[0:3], v[150:153], 0
    s_addc_u32 s9, s61, 0
    v_mul_f32 v134, v214, v134
    v_mul_f32 v135, v214, v135
    v_mfma_f32_16x16x32_bf16 v[166:169], a[4:7], v[186:189], v[166:169]
    s_sub_u32 s10, s36, s23
    v_cvt_pk_f16_f32 v126, v134, v135
    v_mul_f32 v136, v214, v136
    v_mfma_f32_16x16x32_bf16 v[166:169], a[8:11], v[238:241], v[166:169]
    s_cmp_lt_u32 s34, s17
    v_mul_f32 v137, v214, v137
    v_cvt_pk_f16_f32 v127, v136, v137
    v_mfma_f32_16x16x32_bf16 v[166:169], a[12:15], v[202:205], v[166:169]
    s_cselect_b32 s10, s10, 0
    v_cvt_pk_bf16_f32 v175, v156, v157
    v_cvt_pk_bf16_f32 v114, v114, v114
    v_mfma_f32_16x16x32_bf16 v[166:169], a[16:19], v[158:161], v[166:169]
    s_add_u32 m0, s28, 0
    v_cvt_pk_bf16_f32 v115, v115, v115
    s_waitcnt vmcnt(5)
    v_mfma_f32_16x16x32_bf16 v[166:169], a[20:23], v[190:193], v[166:169]
    s_mov_b32 s24, s23
    ds_read_b64 a[230:231], v183 offset:3072
    ds_read_b64 a[238:239], v183 offset:4608
    v_mfma_f32_16x16x32_bf16 v[134:137], a[24:27], v[150:153], 0
    s_add_u32 s23, s23, s21
    ds_read_b64 a[254:255], v183 offset:3080
    ds_read_b64 v[88:89], v183 offset:4616
    v_mfma_f32_16x16x32_bf16 v[134:137], a[28:31], v[186:189], v[134:137]
    s_cmp_ge_u32 s19, 72
    ds_read_b64 v[104:105], v184 offset:3072
    ds_read_b64 v[112:113], v184 offset:4608
    v_mfma_f32_16x16x32_bf16 v[134:137], a[32:35], v[238:241], v[134:137]
    s_cselect_b32 s34, 72, 0
    ds_write2_b32 v177, v114, v115 offset0:0 offset1:68
    v_mfma_f32_16x16x32_bf16 v[134:137], a[36:39], v[202:205], v[134:137]
    s_cselect_b32 s35, s22, 0
    v_cvt_pk_bf16_f32 v116, v116, v116
    v_cvt_pk_bf16_f32 v117, v117, v117
    v_mfma_f32_16x16x32_bf16 v[134:137], a[40:43], v[158:161], v[134:137]
    s_sub_u32 s19, s19, s34
    ds_write2_b32 v177, v116, v117 offset0:136 offset1:204
    v_mfma_f32_16x16x32_bf16 v[134:137], a[44:47], v[190:193], v[134:137]
    s_add_u32 s23, s23, s35
    v_cvt_pk_bf16_f32 v230, v230, v230
    v_cvt_pk_bf16_f32 v231, v231, v231
    v_mfma_f32_16x16x32_bf16 v[114:117], a[48:51], v[150:153], 0
    s_waitcnt lgkmcnt(6)
    ds_write2_b32 v177, v230, v231 offset0:16 offset1:84
    v_mfma_f32_16x16x32_bf16 v[154:157], v[234:237], a[228:231], 0
    s_waitcnt lgkmcnt(5)
    v_cvt_pk_bf16_f32 v232, v232, v232
    v_cvt_pk_bf16_f32 v233, v233, v233
    v_mfma_f32_16x16x32_bf16 v[154:157], v[234:237], a[252:255], v[154:157]
    s_waitcnt lgkmcnt(3)
    ds_write2_b32 v177, v232, v233 offset0:152 offset1:220
    v_mfma_f32_16x16x32_bf16 v[154:157], v[234:237], v[102:105], v[154:157]
    v_cvt_pk_bf16_f32 v222, v222, v222
    v_cvt_pk_bf16_f32 v223, v223, v223
    v_mfma_f32_16x16x32_bf16 v[230:233], v[234:237], a[236:239], 0
    ds_write2_b32 v177, v222, v223 offset0:32 offset1:100
    v_mfma_f32_16x16x32_bf16 v[230:233], v[234:237], v[86:89], v[230:233]
    v_cvt_pk_bf16_f32 v224, v224, v224
    v_cvt_pk_bf16_f32 v225, v225, v225
    v_mfma_f32_16x16x32_bf16 v[230:233], v[234:237], v[110:113], v[230:233]
    ds_write2_b32 v177, v224, v225 offset0:168 offset1:236
    v_mfma_f32_16x16x32_bf16 v[114:117], a[52:55], v[186:189], v[114:117]
    v_cvt_pk_bf16_f32 v122, v122, v122
    v_cvt_pk_bf16_f32 v123, v123, v123
    v_mfma_f32_16x16x32_bf16 v[114:117], a[56:59], v[238:241], v[114:117]
    ds_write2_b32 v178, v122, v123 offset0:0 offset1:68
    v_mfma_f32_16x16x32_bf16 v[114:117], a[60:63], v[202:205], v[114:117]
    v_cvt_pk_bf16_f32 v124, v124, v124
    v_mov_b32 v255, v230
    v_mfma_f32_16x16x32_bf16 v[114:117], a[64:67], v[158:161], v[114:117]
    v_cvt_pk_bf16_f32 v125, v125, v125
    v_mov_b32_dpp v255, v154 quad_perm:[0,1,2,3] row_mask:0x2 bank_mask:0xf
    v_mfma_f32_16x16x32_bf16 v[114:117], a[68:71], v[190:193], v[114:117]
    ds_write2_b32 v178, v124, v125 offset0:136 offset1:204
    v_mfma_f32_16x16x32_bf16 v[122:125], v[150:153], a[144:147], 0
    v_mov_b32_dpp v255, v155 quad_perm:[0,1,2,3] row_mask:0x4 bank_mask:0xf
    v_cvt_pk_bf16_f32 v206, v206, v206
    v_mfma_f32_16x16x32_bf16 v[122:125], v[186:189], a[148:151], v[122:125]
    v_mov_b32_dpp v255, v231 quad_perm:[0,1,2,3] row_mask:0x8 bank_mask:0xf
    v_cvt_pk_bf16_f32 v207, v207, v207
    v_mfma_f32_16x16x32_bf16 v[122:125], v[238:241], a[152:155], v[122:125]
    ds_write_b32 v254, v255 offset:63552
    v_mfma_f32_16x16x32_bf16 v[122:125], v[202:205], a[156:159], v[122:125]
    v_cvt_pk_bf16_f32 v208, v208, v208
    v_cvt_pk_bf16_f32 v209, v209, v209
    v_mfma_f32_16x16x32_bf16 v[122:125], v[158:161], a[160:163], v[122:125]
    ds_write2_b32 v178, v206, v207 offset0:16 offset1:84
    v_mfma_f32_16x16x32_bf16 v[122:125], v[190:193], a[164:167], v[122:125]
    v_cvt_pk_bf16_f32 v246, v246, v246
    v_cvt_pk_bf16_f32 v247, v247, v247
    v_mfma_f32_16x16x32_bf16 v[154:157], v[150:153], a[168:171], 0
    ds_write2_b32 v178, v208, v209 offset0:152 offset1:220
    v_mfma_f32_16x16x32_bf16 v[154:157], v[186:189], a[172:175], v[154:157]
    v_cvt_pk_bf16_f32 v248, v248, v248
    v_cvt_pk_bf16_f32 v249, v249, v249
    v_mfma_f32_16x16x32_bf16 v[154:157], v[238:241], a[176:179], v[154:157]
    ds_write2_b32 v178, v246, v247 offset0:32 offset1:100
    v_mfma_f32_16x16x32_bf16 v[154:157], v[202:205], a[180:183], v[154:157]
    s_waitcnt lgkmcnt(3)
    v_cvt_pk_bf16_f32 v120, v122, v123
    v_cvt_pk_bf16_f32 v121, v124, v125
    v_mfma_f32_16x16x32_bf16 v[154:157], v[158:161], a[184:187], v[154:157]
    s_barrier
    ds_read_b128 v[230:233], v0 offset:32768
    ds_read_b128 v[122:125], v1 offset:32768
    v_mfma_f32_16x16x32_bf16 v[154:157], v[190:193], a[188:191], v[154:157]
    ds_read_b128 v[206:209], v0 offset:32896
    ds_read_b128 v[222:225], v185 offset:18432
    v_mfma_f32_16x16x32_bf16 v[234:237], v[150:153], a[192:195], 0
    v_fma_f32 v148, v166, v166, s32
    v_fmac_f32 v148, v167, v167
    v_mfma_f32_16x16x32_bf16 v[234:237], v[186:189], a[196:199], v[234:237]
    ds_read_b128 v[186:189], v1 offset:32896
    ds_read_b128 v[150:153], v0 offset:33024
    v_mfma_f32_16x16x32_bf16 v[234:237], v[238:241], a[200:203], v[234:237]
    v_fmac_f32 v148, v168, v168
    v_fmac_f32 v148, v169, v169
    v_mfma_f32_16x16x32_bf16 v[234:237], v[202:205], a[204:207], v[234:237]
    ds_read_b128 v[238:241], v1 offset:33024
    ds_read_b128 v[202:205], v185 offset:19456
    v_mfma_f32_16x16x32_bf16 v[234:237], v[158:161], a[208:211], v[234:237]
    v_fmac_f32 v148, v134, v134
    v_fmac_f32 v148, v135, v135
    v_mfma_f32_16x16x32_bf16 v[234:237], v[190:193], a[212:215], v[234:237]
    ds_read_b128 v[190:193], v185 offset:63552
    v_fmac_f32 v148, v136, v136
    v_mfma_f32_16x16x32_f16 v[158:161], v[130:133], v[138:141], v[46:49]
    s_waitcnt lgkmcnt(7)
    ds_write2_b32 v178, v248, v249 offset0:168 offset1:236
    v_mfma_f32_16x16x32_bf16 v[178:181], a[72:75], v[230:233], 0
    s_waitcnt lgkmcnt(6)
    v_add_f32 v222, v222, v223
    v_add_f32 v224, v224, v225
    v_mfma_f32_16x16x32_bf16 v[178:181], a[76:79], v[122:125], v[178:181]
    s_waitcnt lgkmcnt(5)
    v_add_f32 v222, v222, v224
    v_mul_f32 v222, 0xbbaaaaab, v222
    v_mfma_f32_16x16x32_bf16 v[178:181], a[80:83], v[206:209], v[178:181]
    s_waitcnt lgkmcnt(4)
    ds_write_b32 v142, v222 offset:0
    v_mfma_f32_16x16x32_bf16 v[178:181], a[84:87], v[186:189], v[178:181]
    s_waitcnt lgkmcnt(4)
    v_fmac_f32 v148, v137, v137
    v_fmac_f32 v148, v114, v114
    v_mfma_f32_16x16x32_bf16 v[178:181], a[88:91], v[150:153], v[178:181]
    s_waitcnt lgkmcnt(3)
    ds_read_b128 v[222:225], v143 offset:0
    ds_read_b128 v[182:185], v143 offset:64
    v_mfma_f32_16x16x32_bf16 v[178:181], a[92:95], v[238:241], v[178:181]
    s_waitcnt lgkmcnt(4)
    v_add_f32 v202, v202, v203
    v_add_f32 v204, v204, v205
    v_mfma_f32_16x16x32_bf16 v[194:197], a[96:99], v[230:233], 0
    v_add_f32 v202, v202, v204
    v_mul_f32 v202, 0xbbaaaaab, v202
    v_mfma_f32_16x16x32_bf16 v[194:197], a[100:103], v[122:125], v[194:197]
    ds_write_b32 v142, v202 offset:256
    v_mfma_f32_16x16x32_bf16 v[194:197], a[104:107], v[206:209], v[194:197]
    v_add_f32 v190, v190, v191
    v_add_f32 v192, v192, v193
    v_mfma_f32_16x16x32_bf16 v[194:197], a[108:111], v[186:189], v[194:197]
    v_add_f32 v190, v190, v192
    v_mul_f32 v190, 0xbbaaaaab, v190
    v_mfma_f32_16x16x32_bf16 v[194:197], a[112:115], v[150:153], v[194:197]
    ds_write_b32 v142, v190 offset:512
    v_mfma_f32_16x16x32_bf16 v[194:197], a[116:119], v[238:241], v[194:197]
    v_fmac_f32 v148, v115, v115
    v_fmac_f32 v148, v116, v116
    v_mfma_f32_16x16x32_bf16 v[202:205], a[120:123], v[230:233], 0
    s_waitcnt lgkmcnt(2)
    v_fmac_f32 v148, v117, v117
    v_fma_f32 v142, v170, v170, s32
    v_mfma_f32_16x16x32_bf16 v[202:205], a[124:127], v[122:125], v[202:205]
    v_fmac_f32 v142, v171, v171
    v_fmac_f32 v142, v172, v172
    v_mfma_f32_16x16x32_bf16 v[202:205], a[128:131], v[206:209], v[202:205]
    v_fmac_f32 v142, v173, v173
    v_fmac_f32 v142, v162, v162
    v_mfma_f32_16x16x32_bf16 v[202:205], a[132:135], v[186:189], v[202:205]
    v_fmac_f32 v142, v163, v163
    v_fmac_f32 v142, v164, v164
    v_mfma_f32_16x16x32_bf16 v[202:205], a[136:139], v[150:153], v[202:205]
    v_fmac_f32 v142, v165, v165
    v_fmac_f32 v142, v218, v218
    v_mfma_f32_16x16x32_bf16 v[202:205], a[140:143], v[238:241], v[202:205]
    v_fmac_f32 v142, v219, v219
    v_fmac_f32 v142, v220, v220
    v_mfma_f32_16x16x32_bf16 v[190:193], a[0:3], v[230:233], 0
    v_fmac_f32 v142, v221, v221
    v_cvt_pk_bf16_f32 v36, v148, v142
    v_mfma_f32_16x16x32_bf16 v[190:193], a[4:7], v[122:125], v[190:193]
    v_cvt_pk_bf16_f32 v148, v154, v155
    v_cvt_pk_bf16_f32 v149, v156, v157
    v_mfma_f32_16x16x32_bf16 v[154:157], v[32:35], v[36:39], 0
    v_cvt_pk_bf16_f32 v176, v234, v235
    v_cvt_pk_bf16_f32 v177, v236, v237
    v_mfma_f32_16x16x32_bf16 v[190:193], a[8:11], v[206:209], v[190:193]
    v_fma_f32 v142, v178, v178, s32
    v_fmac_f32 v142, v179, v179
    v_mfma_f32_16x16x32_bf16 v[190:193], a[12:15], v[186:189], v[190:193]
    v_fmac_f32 v142, v180, v180
    v_fmac_f32 v142, v181, v181
    v_mfma_f32_16x16x32_bf16 v[190:193], a[16:19], v[150:153], v[190:193]
    v_rsq_f32 v155, v155
    v_mfma_f32_16x16x32_bf16 v[190:193], a[20:23], v[238:241], v[190:193]
    v_rsq_f32 v154, v154
    v_mfma_f32_16x16x32_bf16 v[234:237], a[24:27], v[230:233], 0
    v_mul_f32 v154, s31, v154
    v_mul_f32 v170, v155, v170
    v_mfma_f32_16x16x32_bf16 v[234:237], a[28:31], v[122:125], v[234:237]
    ds_read2_b32 v[248:249], v6 offset0:0 offset1:0
    ds_read2_b32 v[156:157], v6 offset0:16 offset1:16
    v_mfma_f32_16x16x32_bf16 v[234:237], a[32:35], v[206:209], v[234:237]
    ds_read2_b32 v[216:217], v6 offset0:32 offset1:32
    v_mul_f32 v171, v155, v171
    v_mfma_f32_16x16x32_bf16 v[234:237], a[36:39], v[186:189], v[234:237]
    v_cvt_pk_f16_f32 v170, v170, v171
    v_mul_f32 v172, v155, v172
    v_mfma_f32_16x16x32_bf16 v[234:237], a[40:43], v[150:153], v[234:237]
    v_mul_f32 v173, v155, v173
    v_cvt_pk_f16_f32 v171, v172, v173
    v_mfma_f32_16x16x32_bf16 v[234:237], a[44:47], v[238:241], v[234:237]
    v_mul_f32 v162, v155, v162
    v_mul_f32 v163, v155, v163
    v_cvt_pk_f16_f32 v172, v162, v163
    v_mfma_f32_16x16x16_f16 v[158:161], v[128:129], v[126:127], v[158:161]
    v_mul_f32 v164, v155, v164
    v_mul_f32 v165, v155, v165
    v_cvt_pk_f16_f32 v173, v164, v165
    v_mul_f32 v218, v155, v218
    v_mfma_f32_16x16x32_bf16 v[162:165], a[48:51], v[230:233], 0
    v_mul_f32 v219, v155, v219
    v_cvt_pk_f16_f32 v228, v218, v219
    v_mfma_f32_16x16x32_bf16 v[162:165], a[52:55], v[122:125], v[162:165]
    s_waitcnt lgkmcnt(1)
    v_mul_f32 v220, v155, v220
    v_mul_f32 v221, v155, v221
    v_mfma_f32_16x16x32_bf16 v[162:165], a[56:59], v[206:209], v[162:165]
    s_waitcnt lgkmcnt(0)
    v_cvt_pk_f16_f32 v229, v220, v221
    v_mul_f32 v166, v154, v166
    v_mfma_f32_16x16x32_bf16 v[162:165], a[60:63], v[186:189], v[162:165]
    v_mul_f32 v167, v154, v167
    v_cvt_pk_f16_f32 v166, v166, v167
    v_mfma_f32_16x16x32_bf16 v[162:165], a[64:67], v[150:153], v[162:165]
    v_mul_f32 v168, v154, v168
    v_mul_f32 v169, v154, v169
    v_mfma_f32_16x16x32_bf16 v[162:165], a[68:71], v[238:241], v[162:165]
    v_cvt_pk_f16_f32 v167, v168, v169
    v_mul_f32 v134, v154, v134
    v_mfma_f32_16x16x32_bf16 v[218:221], v[230:233], a[144:147], 0
    v_mul_f32 v135, v154, v135
    v_cvt_pk_f16_f32 v168, v134, v135
    v_mfma_f32_16x16x32_bf16 v[218:221], v[122:125], a[148:151], v[218:221]
    v_mul_f32 v136, v154, v136
    v_mul_f32 v137, v154, v137
    v_mfma_f32_16x16x32_bf16 v[218:221], v[206:209], a[152:155], v[218:221]
    v_cvt_pk_f16_f32 v169, v136, v137
    v_mul_f32 v114, v154, v114
    v_mfma_f32_16x16x32_bf16 v[218:221], v[186:189], a[156:159], v[218:221]
    v_mul_f32 v115, v154, v115
    v_cvt_pk_f16_f32 v226, v114, v115
    v_mfma_f32_16x16x32_bf16 v[218:221], v[150:153], a[160:163], v[218:221]
    v_mul_f32 v116, v154, v116
    v_mul_f32 v117, v154, v117
    v_mfma_f32_16x16x32_bf16 v[218:221], v[238:241], a[164:167], v[218:221]
    v_cvt_pk_f16_f32 v227, v116, v117
    v_fma_f32 v154, v190, v190, s32
    v_mfma_f32_16x16x32_bf16 v[114:117], v[230:233], a[168:171], 0
    v_fmac_f32 v154, v191, v191
    v_fmac_f32 v154, v192, v192
    v_mfma_f32_16x16x32_bf16 v[114:117], v[122:125], a[172:175], v[114:117]
    ds_read_b32 v254, v6 offset:192
    v_fmac_f32 v154, v193, v193
    v_mfma_f32_16x16x32_bf16 v[114:117], v[206:209], a[176:179], v[114:117]
    v_cvt_pk_bf16_f32 v246, v218, v219
    v_cvt_pk_bf16_f32 v247, v220, v221
    v_mfma_f32_16x16x32_bf16 v[114:117], v[186:189], a[180:183], v[114:117]
    v_fmac_f32 v154, v234, v234
    v_fmac_f32 v154, v235, v235
    v_mfma_f32_16x16x32_bf16 v[114:117], v[150:153], a[184:187], v[114:117]
    v_fmac_f32 v154, v236, v236
    v_fmac_f32 v154, v237, v237
    v_mfma_f32_16x16x32_bf16 v[114:117], v[238:241], a[188:191], v[114:117]
    v_fmac_f32 v154, v162, v162
    v_fmac_f32 v154, v163, v163
    v_fmac_f32 v154, v164, v164
    v_fmac_f32 v154, v165, v165
    v_fmac_f32 v142, v194, v194
    v_fmac_f32 v142, v195, v195
    v_fmac_f32 v142, v196, v196
    v_fmac_f32 v142, v197, v197
    v_fmac_f32 v142, v202, v202
    v_fmac_f32 v142, v203, v203
    v_fmac_f32 v142, v204, v204
    v_fmac_f32 v142, v205, v205
    v_cvt_pk_bf16_f32 v36, v154, v142
    v_mfma_f32_16x16x32_bf16 v[218:221], v[230:233], a[192:195], 0
    s_waitcnt lgkmcnt(0)
    ds_read_b128 v[134:137], v5 offset:0
    v_cvt_pk_bf16_f32 v154, v114, v115
    v_mfma_f32_16x16x32_bf16 v[218:221], v[122:125], a[196:199], v[218:221]
    ds_read_b128 v[122:125], v5 offset:16
    v_cvt_pk_bf16_f32 v155, v116, v117
    v_mfma_f32_16x16x32_bf16 v[218:221], v[206:209], a[200:203], v[218:221]
    ds_read_b128 v[114:117], v5 offset:48
    v_xor_b32 v0, 65536, v0
    v_mfma_f32_16x16x32_bf16 v[218:221], v[186:189], a[204:207], v[218:221]
    v_xor_b32 v1, 65536, v1
    v_add_u32 v5, 336, v5
    v_mfma_f32_16x16x32_bf16 v[186:189], v[32:35], v[36:39], 0
    v_add_u32 v6, 272, v6
    v_mfma_f32_16x16x32_bf16 v[218:221], v[150:153], a[208:211], v[218:221]
    v_mfma_f32_16x16x32_f16 v[150:153], v[170:173], v[138:141], v[50:53]
    v_mfma_f32_16x16x32_bf16 v[218:221], v[238:241], a[212:215], v[218:221]
    v_mfma_f32_16x16x16_bf16 v[230:233], a[216:217], v[144:145], v[222:225]
    v_mfma_f32_16x16x16_bf16 v[238:241], a[240:241], v[144:145], v[222:225]
    s_nop 0
    s_nop 0
    v_rsq_f32 v187, v187
    v_mfma_f32_16x16x16_f16 v[150:153], v[228:229], v[126:127], v[150:153]
    v_rsq_f32 v186, v186
    v_mul_f32 v178, v187, v178
    v_mul_f32 v186, s31, v186
    s_waitcnt vmcnt(0)
    s_barrier
    buffer_load_dwordx4 v10, s[8:11], 0 offen nt lds
    s_add_u32 m0, s28, 4096
    v_cvt_pk_bf16_f32 v214, v218, v219
    v_cvt_pk_bf16_f32 v215, v220, v221
    v_mul_f32 v179, v187, v179
    v_cvt_pk_f16_f32 v178, v178, v179
    v_mul_f32 v180, v187, v180
    v_mul_f32 v181, v187, v181
    v_cvt_pk_f16_f32 v179, v180, v181
    v_mfma_f32_16x16x16_bf16 v[218:221], v[90:91], v[144:145], v[222:225]
    v_mul_f32 v194, v187, v194
    v_mul_f32 v195, v187, v195
    v_cvt_pk_f16_f32 v180, v194, v195
    v_mfma_f32_16x16x16_bf16 v[206:209], a[218:219], v[144:145], v[182:185]
    v_mul_f32 v196, v187, v196
    v_mul_f32 v197, v187, v197
    buffer_load_dwordx4 v11, s[8:11], 0 offen nt lds
    s_add_u32 m0, s28, 8192
    v_cvt_pk_f16_f32 v181, v196, v197
    v_mul_f32 v202, v187, v202
    v_mul_f32 v203, v187, v203
    v_cvt_pk_f16_f32 v224, v202, v203
    v_mul_f32 v204, v187, v204
    v_mul_f32 v205, v187, v205
    v_mfma_f32_16x16x32_f16 v[194:197], v[178:181], v[138:141], v[54:57]
    v_cvt_pk_f16_f32 v225, v204, v205
    v_mul_f32 v190, v186, v190
    v_mul_f32 v191, v186, v191
    v_cvt_pk_f16_f32 v202, v190, v191
    v_mul_f32 v192, v186, v192
    v_mul_f32 v193, v186, v193
    v_mfma_f32_16x16x16_f16 v[194:197], v[224:225], v[126:127], v[194:197]
    buffer_load_dwordx4 v12, s[8:11], 0 offen nt lds
    s_add_u32 m0, s28, 12288
    s_xor_b32 s28, s28, 65536
    v_cvt_pk_f16_f32 v203, v192, v193
    v_mul_f32 v234, v186, v234
    v_mul_f32 v235, v186, v235
    v_cvt_pk_f16_f32 v204, v234, v235
    v_mfma_f32_16x16x16_bf16 v[190:193], a[242:243], v[144:145], v[182:185]
    v_mul_f32 v236, v186, v236
    v_mul_f32 v237, v186, v237
    v_cvt_pk_f16_f32 v205, v236, v237
    v_mul_f32 v162, v186, v162
    v_mul_f32 v163, v186, v163
    v_cvt_pk_f16_f32 v222, v162, v163
    v_mul_f32 v164, v186, v164
    v_mul_f32 v165, v186, v165
    buffer_load_dwordx4 v13, s[8:11], 0 offen nt lds
    s_mov_b32 m0, s29
    s_xor_b32 s29, s29, s30
    v_cvt_pk_f16_f32 v223, v164, v165
    v_mfma_f32_16x16x16_bf16 v[162:165], v[92:93], v[144:145], v[182:185]
    s_waitcnt lgkmcnt(0)
    v_cvt_pk_bf16_f32 v230, v230, v231
    v_accvgpr_write_b32 a216, v230
    v_cvt_pk_bf16_f32 v232, v232, v233
    v_mfma_f32_16x16x32_f16 v[182:185], v[134:137], v[138:141], v[22:25]
    v_accvgpr_write_b32 a217, v232
    v_cvt_pk_bf16_f32 v238, v238, v239
    v_mfma_f32_16x16x32_f16 v[182:185], v[122:125], v[130:133], v[182:185]
    v_accvgpr_write_b32 a240, v238
    v_cvt_pk_bf16_f32 v240, v240, v241
    v_mfma_f32_16x16x32_f16 v[182:185], v[114:117], v[126:129], v[182:185]
    buffer_load_dwordx4 v14, s[8:11], 0 offen nt lds
    v_accvgpr_write_b32 a241, v240
    v_mfma_f32_16x16x32_f16 v[186:189], v[134:137], v[166:169], v[24:27]
    v_cvt_pk_bf16_f32 v90, v218, v219
    v_cvt_pk_bf16_f32 v91, v220, v221
    v_mfma_f32_16x16x32_f16 v[186:189], v[122:125], v[170:173], v[186:189]
    ds_read_b128 v[138:141], v143 offset:128
    v_cvt_pk_bf16_f32 v206, v206, v207
    v_mfma_f32_16x16x32_f16 v[186:189], v[114:117], v[226:229], v[186:189]
    v_mov_b32_dpp v254, v183 quad_perm:[0,1,2,3] row_mask:0x1 bank_mask:0xf
    v_max3_f32 v142, v182, v158, v159
    v_mfma_f32_16x16x32_f16 v[218:221], v[134:137], v[202:205], v[26:29]
    v_max3_f32 v142, v142, v160, v161
    v_max3_f32 v142, v142, v150, v151
    v_mfma_f32_16x16x32_f16 v[218:221], v[122:125], v[178:181], v[218:221]
    v_max3_f32 v142, v142, v152, v153
    v_max3_f32 v142, v142, v194, v195
    v_mfma_f32_16x16x32_f16 v[218:221], v[114:117], v[222:225], v[218:221]
    v_mov_b32_dpp v254, v187 quad_perm:[0,1,2,3] row_mask:0x2 bank_mask:0xf
    v_max3_f32 v142, v142, v196, v197
    v_mov_b32 v255, v142
    v_accvgpr_write_b32 a218, v206
    v_cvt_pk_bf16_f32 v208, v208, v209
    v_permlane32_swap_b32 v142, v255
    v_max_f32 v142, v142, v255
    v_mov_b32 v255, v142
    v_mov_b32_dpp v254, v219 quad_perm:[0,1,2,3] row_mask:0x4 bank_mask:0xf
    v_accvgpr_write_b32 a219, v208
    v_permlane16_swap_b32 v142, v255
    s_waitcnt lgkmcnt(0)
    v_mfma_f32_16x16x16_bf16 v[114:117], a[232:233], v[144:145], v[138:141]
    v_max_f32 v142, v142, v255
    v_sub_f32 v158, v158, v142
    v_sub_f32 v159, v159, v142
    v_mfma_f32_16x16x16_bf16 v[122:125], v[82:83], v[144:145], v[138:141]
    v_exp_f32 v158, v158
    v_sub_f32 v160, v160, v142
    v_mfma_f32_16x16x16_bf16 v[134:137], v[106:107], v[144:145], v[138:141]
    v_exp_f32 v159, v159
    v_exp_f32 v160, v160
    v_cvt_pk_bf16_f32 v158, v158, v159
    v_sub_f32 v161, v161, v142
    v_exp_f32 v161, v161
    v_sub_f32 v150, v150, v142
    v_cvt_pk_bf16_f32 v159, v160, v161
    v_exp_f32 v150, v150
    v_mfma_f32_16x16x32_f16 v[138:141], v[130:133], v[166:169], v[58:61]
    v_sub_f32 v151, v151, v142
    v_exp_f32 v151, v151
    v_sub_f32 v152, v152, v142
    v_cvt_pk_bf16_f32 v160, v150, v151
    v_exp_f32 v152, v152
    v_sub_f32 v153, v153, v142
    v_mfma_f32_16x16x16_f16 v[138:141], v[128:129], v[226:227], v[138:141]
    v_exp_f32 v153, v153
    v_sub_f32 v194, v194, v142
    v_cvt_pk_bf16_f32 v161, v152, v153
    v_mfma_f32_16x16x32_f16 v[150:153], v[170:173], v[166:169], v[62:65]
    v_exp_f32 v194, v194
    v_sub_f32 v195, v195, v142
    v_exp_f32 v195, v195
    v_sub_f32 v196, v196, v142
    v_cvt_pk_bf16_f32 v36, v194, v195
    v_exp_f32 v196, v196
    v_mfma_f32_16x16x32_f16 v[238:241], v[178:181], v[166:169], v[66:69]
    v_sub_f32 v197, v197, v142
    v_exp_f32 v197, v197
    v_mfma_f32_16x16x16_f16 v[150:153], v[228:229], v[226:227], v[150:153]
    v_cvt_pk_bf16_f32 v37, v196, v197
    v_sub_f32 v182, v182, v142
    v_exp_f32 v182, v182
    v_mfma_f32_16x16x16_f16 v[238:241], v[224:225], v[226:227], v[238:241]
    v_cvt_pk_bf16_f32 v39, v182, 0
    v_cvt_pk_bf16_f32 v190, v190, v191
    v_accvgpr_write_b32 a242, v190
    v_cvt_pk_bf16_f32 v192, v192, v193
    v_mfma_f32_16x16x32_bf16 v[182:185], v[28:31], v[36:39], 0
    v_accvgpr_write_b32 a243, v192
    v_cvt_pk_bf16_f32 v92, v162, v163
    v_mfma_f32_16x16x32_bf16 v[182:185], v[28:31], v[158:161], v[182:185]
    v_cvt_pk_bf16_f32 v93, v164, v165
    v_cvt_pk_bf16_f32 v114, v114, v115
    v_mfma_f32_16x16x32_bf16 v[162:165], v[246:249], v[36:39], 0
    ds_read_b128 v[166:169], v143 offset:192
    v_accvgpr_write_b32 a232, v114
    v_mfma_f32_16x16x32_bf16 v[162:165], v[118:121], v[158:161], v[162:165]
    v_cvt_pk_bf16_f32 v116, v116, v117
    v_accvgpr_write_b32 a233, v116
    v_mfma_f32_16x16x32_bf16 v[230:233], v[154:157], v[36:39], 0
    v_rcp_f32 v182, v182
    v_mfma_f32_16x16x32_bf16 v[230:233], v[146:149], v[158:161], v[230:233]
    v_cvt_pk_bf16_f32 v82, v122, v123
    v_cvt_pk_bf16_f32 v83, v124, v125
    v_mfma_f32_16x16x32_bf16 v[114:117], v[214:217], v[36:39], 0
    v_mul_f32 v162, v182, v162
    v_mul_f32 v163, v182, v163
    v_mfma_f32_16x16x32_bf16 v[114:117], v[174:177], v[158:161], v[114:117]
    v_cvt_pk_bf16_f32 v158, v162, v163
    v_mul_f32 v164, v182, v164
    v_mul_f32 v165, v182, v165
    v_cvt_pk_bf16_f32 v159, v164, v165
    v_mul_f32 v230, v182, v230
    v_mul_f32 v231, v182, v231
    v_cvt_pk_bf16_f32 v160, v230, v231
    v_mul_f32 v232, v182, v232
    s_waitcnt lgkmcnt(0)
    v_mfma_f32_16x16x16_bf16 v[122:125], a[220:221], v[144:145], v[166:169]
    v_mul_f32 v233, v182, v233
    v_cvt_pk_bf16_f32 v161, v232, v233
    v_mul_f32 v114, v182, v114
    v_mfma_f32_16x16x16_bf16 v[162:165], a[244:245], v[144:145], v[166:169]
    v_mul_f32 v115, v182, v115
    v_cvt_pk_bf16_f32 v126, v114, v115
    v_mul_f32 v116, v182, v116
    v_mfma_f32_16x16x16_bf16 v[230:233], v[94:95], v[144:145], v[166:169]
    ds_write_b128 v3, v[158:161] offset:0
    v_mul_f32 v117, v182, v117
    v_cvt_pk_bf16_f32 v127, v116, v117
    v_cvt_pk_bf16_f32 v106, v134, v135
    v_cvt_pk_bf16_f32 v107, v136, v137
    v_cvt_pk_bf16_f32 v122, v122, v123
    v_accvgpr_write_b32 a220, v122
    v_cvt_pk_bf16_f32 v124, v124, v125
    ds_read_b128 v[158:161], v143 offset:256
    ds_write_b64 v4, v[126:127] offset:4096
    v_accvgpr_write_b32 a221, v124
    v_cvt_pk_bf16_f32 v162, v162, v163
    v_accvgpr_write_b32 a244, v162
    v_cvt_pk_bf16_f32 v164, v164, v165
    v_accvgpr_write_b32 a245, v164
    v_cvt_pk_bf16_f32 v94, v230, v231
    v_cvt_pk_bf16_f32 v95, v232, v233
    ds_read_b128 v[114:117], v143 offset:320
    v_mov_b32 v142, v254
    v_max3_f32 v255, v186, v138, v139
    v_max3_f32 v255, v255, v140, v141
    v_max_f32_dpp v142, v142, v142 quad_perm:[1,0,3,2] row_mask:0xf bank_mask:0xf
    v_max3_f32 v255, v255, v150, v151
    v_max3_f32 v255, v255, v152, v153
    v_max_f32_dpp v142, v142, v142 quad_perm:[2,3,0,1] row_mask:0xf bank_mask:0xf
    v_max3_f32 v255, v255, v238, v239
    v_max3_f32 v255, v255, v240, v241
    v_max_f32_dpp v142, v142, v142 row_half_mirror row_mask:0xf bank_mask:0xf
    v_mov_b32 v127, v255
    s_nop 0
    v_max_f32_dpp v142, v142, v142 row_mirror row_mask:0xf bank_mask:0xf
    v_mov_b32 v126, v142
    s_waitcnt lgkmcnt(2)
    v_mfma_f32_16x16x16_bf16 v[122:125], a[222:223], v[144:145], v[158:161]
    v_permlane32_swap_b32 v142, v126
    v_max_f32 v142, v142, v126
    v_mfma_f32_16x16x16_bf16 v[182:185], a[246:247], v[144:145], v[158:161]
    v_mov_b32 v126, v142
    v_permlane32_swap_b32 v255, v127
    v_mfma_f32_16x16x16_bf16 v[162:165], v[96:97], v[144:145], v[158:161]
    v_permlane16_swap_b32 v142, v126
    v_max_f32 v142, v142, v126
    s_waitcnt lgkmcnt(0)
    v_mfma_f32_16x16x16_bf16 v[134:137], a[234:235], v[144:145], v[114:117]
    v_cvt_pk_bf16_f32 v122, v122, v123
    v_accvgpr_write_b32 a222, v122
    v_cvt_pk_bf16_f32 v124, v124, v125
    v_mfma_f32_16x16x16_bf16 v[158:161], v[84:85], v[144:145], v[114:117]
    v_accvgpr_write_b32 a223, v124
    v_cvt_pk_bf16_f32 v182, v182, v183
    v_accvgpr_write_b32 a246, v182
    v_mfma_f32_16x16x16_bf16 v[122:125], v[108:109], v[144:145], v[114:117]
    v_cvt_pk_bf16_f32 v184, v184, v185
    v_accvgpr_write_b32 a247, v184
    v_cvt_pk_bf16_f32 v96, v162, v163
    v_cvt_pk_bf16_f32 v97, v164, v165
    ds_read_b128 v[114:117], v143 offset:384
    v_cvt_pk_bf16_f32 v134, v134, v135
    v_accvgpr_write_b32 a234, v134
    v_cvt_pk_bf16_f32 v136, v136, v137
    v_accvgpr_write_b32 a235, v136
    v_cvt_pk_bf16_f32 v84, v158, v159
    v_cvt_pk_bf16_f32 v85, v160, v161
    v_cvt_pk_bf16_f32 v108, v122, v123
    v_cvt_pk_bf16_f32 v109, v124, v125
    ds_read_b128 v[158:161], v143 offset:448
    v_sub_f32 v254, v254, v142
    v_exp_f32 v254, v254
    v_max_f32 v255, v255, v127
    v_cvt_pk_bf16_f32 v254, v254, v254
    ds_write_b16 v8, v254
    v_mov_b32 v127, v255
    ds_read_b128 v[122:125], v9
    ds_read_b128 v[162:165], v9 offset:64
    v_permlane16_swap_b32 v255, v127
    s_waitcnt lgkmcnt(4)
    v_mfma_f32_16x16x16_bf16 v[182:185], a[224:225], v[144:145], v[114:117]
    v_max_f32 v255, v255, v127
    v_sub_f32 v138, v138, v255
    v_sub_f32 v139, v139, v255
    v_mfma_f32_16x16x16_bf16 v[134:137], a[248:249], v[144:145], v[114:117]
    v_exp_f32 v138, v138
    v_sub_f32 v140, v140, v255
    v_mfma_f32_16x16x16_bf16 v[166:169], v[98:99], v[144:145], v[114:117]
    v_exp_f32 v139, v139
    s_waitcnt lgkmcnt(3)
    v_mfma_f32_16x16x16_bf16 v[230:233], a[226:227], v[144:145], v[158:161]
    v_cvt_pk_bf16_f32 v182, v182, v183
    v_accvgpr_write_b32 a224, v182
    v_cvt_pk_bf16_f32 v184, v184, v185
    v_mfma_f32_16x16x16_bf16 v[114:117], a[250:251], v[144:145], v[158:161]
    v_accvgpr_write_b32 a225, v184
    v_cvt_pk_bf16_f32 v134, v134, v135
    v_accvgpr_write_b32 a248, v134
    v_mfma_f32_16x16x16_bf16 v[182:185], v[100:101], v[144:145], v[158:161]
    v_cvt_pk_bf16_f32 v136, v136, v137
    v_accvgpr_write_b32 a249, v136
    s_waitcnt lgkmcnt(1)
    v_cvt_pk_bf16_f32 v98, v166, v167
    v_mfma_f32_16x16x32_bf16 v[158:161], v[122:125], v[28:31], 0
    s_waitcnt lgkmcnt(0)
    v_cvt_pk_bf16_f32 v99, v168, v169
    v_cvt_pk_bf16_f32 v230, v230, v231
    v_mfma_f32_16x16x32_bf16 v[158:161], v[162:165], v[28:31], v[158:161]
    ds_read_b128 v[134:137], v143 offset:512
    v_accvgpr_write_b32 a226, v230
    v_mfma_f32_16x16x32_bf16 v[166:169], v[122:125], v[118:121], 0
    v_cvt_pk_bf16_f32 v232, v232, v233
    v_accvgpr_write_b32 a227, v232
    v_mfma_f32_16x16x32_bf16 v[166:169], v[162:165], v[246:249], v[166:169]
    v_cvt_pk_bf16_f32 v114, v114, v115
    v_accvgpr_write_b32 a250, v114
    v_mfma_f32_16x16x32_bf16 v[230:233], v[122:125], v[146:149], 0
    v_cvt_pk_bf16_f32 v116, v116, v117
    v_accvgpr_write_b32 a251, v116
    v_mfma_f32_16x16x32_bf16 v[230:233], v[162:165], v[154:157], v[230:233]
    v_cvt_pk_bf16_f32 v100, v182, v183
    v_cvt_pk_bf16_f32 v101, v184, v185
    v_mfma_f32_16x16x32_bf16 v[114:117], v[122:125], v[174:177], 0
    ds_read_b128 v[122:125], v143 offset:576
    v_cvt_pk_bf16_f32 v138, v138, v139
    v_mfma_f32_16x16x32_bf16 v[114:117], v[162:165], v[214:217], v[114:117]
    v_exp_f32 v140, v140
    v_sub_f32 v141, v141, v255
    v_exp_f32 v141, v141
    s_waitcnt lgkmcnt(1)
    v_mfma_f32_16x16x16_bf16 v[162:165], a[236:237], v[144:145], v[134:137]
    v_cvt_pk_bf16_f32 v139, v140, v141
    v_sub_f32 v150, v150, v255
    v_sub_f32 v151, v151, v255
    v_mfma_f32_16x16x16_bf16 v[182:185], v[86:87], v[144:145], v[134:137]
    v_exp_f32 v150, v150
    v_sub_f32 v152, v152, v255
    v_mfma_f32_16x16x16_bf16 v[190:193], v[110:111], v[144:145], v[134:137]
    v_exp_f32 v151, v151
    v_cvt_pk_bf16_f32 v162, v162, v163
    v_accvgpr_write_b32 a236, v162
    v_cvt_pk_bf16_f32 v164, v164, v165
    v_accvgpr_write_b32 a237, v164
    v_cvt_pk_bf16_f32 v86, v182, v183
    v_cvt_pk_bf16_f32 v87, v184, v185
    v_cvt_pk_bf16_f32 v140, v150, v151
    s_waitcnt lgkmcnt(0)
    v_mfma_f32_16x16x16_bf16 v[162:165], a[228:229], v[144:145], v[122:125]
    v_cvt_pk_bf16_f32 v110, v190, v191
    v_cvt_pk_bf16_f32 v111, v192, v193
    v_sub_f32 v153, v153, v255
    v_mfma_f32_16x16x16_bf16 v[182:185], a[252:253], v[144:145], v[122:125]
    v_exp_f32 v152, v152
    v_sub_f32 v238, v238, v255
    v_mfma_f32_16x16x16_bf16 v[134:137], v[102:103], v[144:145], v[122:125]
    ds_read_b128 v[190:193], v143 offset:640
    v_cvt_pk_bf16_f32 v162, v162, v163
    v_accvgpr_write_b32 a228, v162
    v_cvt_pk_bf16_f32 v164, v164, v165
    v_accvgpr_write_b32 a229, v164
    v_cvt_pk_bf16_f32 v182, v182, v183
    v_accvgpr_write_b32 a252, v182
    v_cvt_pk_bf16_f32 v184, v184, v185
    v_accvgpr_write_b32 a253, v184
    v_cvt_pk_bf16_f32 v102, v134, v135
    v_cvt_pk_bf16_f32 v103, v136, v137
    ds_read_b128 v[122:125], v143 offset:704
    v_exp_f32 v153, v153
    v_mfma_f32_16x16x32_f16 v[162:165], v[130:133], v[202:205], v[70:73]
    v_cvt_pk_bf16_f32 v141, v152, v153
    v_exp_f32 v238, v238
    v_sub_f32 v239, v239, v255
    v_exp_f32 v239, v239
    v_sub_f32 v240, v240, v255
    v_cvt_pk_bf16_f32 v36, v238, v239
    v_mfma_f32_16x16x16_f16 v[162:165], v[128:129], v[222:223], v[162:165]
    v_exp_f32 v240, v240
    v_sub_f32 v241, v241, v255
    v_sub_f32 v186, v186, v255
    v_mfma_f32_16x16x32_f16 v[130:133], v[170:173], v[202:205], v[74:77]
    s_waitcnt lgkmcnt(1)
    v_exp_f32 v241, v241
    v_mfma_f32_16x16x32_f16 v[126:129], v[178:181], v[202:205], v[78:81]
    v_cvt_pk_bf16_f32 v37, v240, v241
    v_exp_f32 v186, v186
    v_mfma_f32_16x16x16_bf16 v[178:181], a[230:231], v[144:145], v[190:193]
    v_max3_f32 v254, v218, v162, v163
    v_max3_f32 v254, v254, v164, v165
    v_cvt_pk_bf16_f32 v39, v186, 0
    v_mfma_f32_16x16x16_f16 v[130:133], v[228:229], v[222:223], v[130:133]
    v_rcp_f32 v158, v158
    v_mfma_f32_16x16x16_f16 v[126:129], v[224:225], v[222:223], v[126:129]
    v_mul_f32 v166, v166, v158
    v_mfma_f32_16x16x32_bf16 v[150:153], v[28:31], v[36:39], 0
    s_waitcnt lgkmcnt(0)
    v_cvt_pk_bf16_f32 v178, v178, v179
    v_accvgpr_write_b32 a230, v178
    v_mfma_f32_16x16x32_bf16 v[150:153], v[28:31], v[138:141], v[150:153]
    v_cvt_pk_bf16_f32 v180, v180, v181
    v_accvgpr_write_b32 a231, v180
    v_mfma_f32_16x16x32_bf16 v[178:181], v[246:249], v[36:39], 0
    v_max3_f32 v254, v254, v130, v131
    v_max3_f32 v254, v254, v132, v133
    v_mfma_f32_16x16x32_bf16 v[178:181], v[118:121], v[138:141], v[178:181]
    v_max3_f32 v254, v254, v126, v127
    v_max3_f32 v254, v254, v128, v129
    v_mfma_f32_16x16x32_bf16 v[182:185], v[154:157], v[36:39], 0
    v_rcp_f32 v150, v150
    v_mfma_f32_16x16x32_bf16 v[182:185], v[146:149], v[138:141], v[182:185]
    v_mov_b32 v255, v254
    v_mul_f32_dpp v166, v230, v158 quad_perm:[0,1,2,3] row_mask:0x2 bank_mask:0xf
    v_mfma_f32_16x16x32_bf16 v[134:137], v[214:217], v[36:39], 0
    v_mul_f32 v178, v150, v178
    v_mul_f32 v179, v150, v179
    v_mfma_f32_16x16x32_bf16 v[134:137], v[174:177], v[138:141], v[134:137]
    v_cvt_pk_bf16_f32 v138, v178, v179
    v_mul_f32 v180, v150, v180
    v_mul_f32 v181, v150, v181
    v_mfma_f32_16x16x16_bf16 v[170:173], a[254:255], v[144:145], v[190:193]
    v_cvt_pk_bf16_f32 v139, v180, v181
    v_mul_f32 v182, v150, v182
    v_mul_f32 v183, v150, v183
    v_mfma_f32_16x16x16_bf16 v[178:181], v[104:105], v[144:145], v[190:193]
    v_cvt_pk_bf16_f32 v140, v182, v183
    v_mul_f32 v184, v150, v184
    v_mul_f32 v185, v150, v185
    v_mfma_f32_16x16x16_bf16 v[202:205], a[238:239], v[144:145], v[122:125]
    v_cvt_pk_bf16_f32 v141, v184, v185
    v_mul_f32 v134, v150, v134
    v_mul_f32 v135, v150, v135
    v_mfma_f32_16x16x16_bf16 v[182:185], v[88:89], v[144:145], v[122:125]
    v_cvt_pk_bf16_f32 v116, v134, v135
    v_mul_f32 v136, v150, v136
    v_mul_f32 v137, v150, v137
    v_mfma_f32_16x16x16_bf16 v[150:153], v[112:113], v[144:145], v[122:125]
    ds_write_b128 v3, v[138:141] offset:6144
    v_cvt_pk_bf16_f32 v117, v136, v137
    v_cvt_pk_bf16_f32 v170, v170, v171
    v_accvgpr_write_b32 a254, v170
    v_cvt_pk_bf16_f32 v172, v172, v173
    v_accvgpr_write_b32 a255, v172
    v_cvt_pk_bf16_f32 v104, v178, v179
    v_cvt_pk_bf16_f32 v105, v180, v181
    ds_write_b64 v4, v[116:117] offset:10240
    v_cvt_pk_bf16_f32 v202, v202, v203
    v_accvgpr_write_b32 a238, v202
    v_cvt_pk_bf16_f32 v204, v204, v205
    v_accvgpr_write_b32 a239, v204
    v_cvt_pk_bf16_f32 v88, v182, v183
    v_cvt_pk_bf16_f32 v89, v184, v185
    v_cvt_pk_bf16_f32 v112, v150, v151
    v_cvt_pk_bf16_f32 v113, v152, v153
    v_permlane32_swap_b32 v254, v255
    v_max_f32 v254, v254, v255
    v_mov_b32 v255, v254
    v_mul_f32_dpp v166, v114, v158 quad_perm:[0,1,2,3] row_mask:0x4 bank_mask:0xf
    v_cvt_pk_bf16_f32 v166, v166, v166
    ds_write_b16 v7, v166
    v_permlane16_swap_b32 v254, v255
    v_max_f32 v254, v254, v255
    v_sub_f32 v162, v162, v254
    v_exp_f32 v162, v162
    v_sub_f32 v163, v163, v254
    v_exp_f32 v163, v163
    v_sub_f32 v164, v164, v254
    v_cvt_pk_bf16_f32 v138, v162, v163
    v_exp_f32 v164, v164
    ds_read_b128 v[186:189], v0 offset:20480
    ds_read_b128 v[194:197], v1 offset:20480
    ds_read_b128 v[122:125], v0 offset:20608
    ds_read_b128 v[202:205], v1 offset:20608
    ds_read_b128 v[230:233], v0 offset:20736
    ds_read_b128 v[238:241], v1 offset:20736
    v_sub_f32 v165, v165, v254
    v_exp_f32 v165, v165
    v_sub_f32 v130, v130, v254
    v_cvt_pk_bf16_f32 v139, v164, v165
    v_exp_f32 v130, v130
    v_sub_f32 v131, v131, v254
    v_exp_f32 v131, v131
    v_sub_f32 v132, v132, v254
    v_cvt_pk_bf16_f32 v140, v130, v131
    v_exp_f32 v132, v132
    s_waitcnt lgkmcnt(5)
    v_mfma_f32_16x16x32_bf16 v[150:153], a[72:75], v[186:189], 0
    s_waitcnt lgkmcnt(3)
    v_sub_f32 v133, v133, v254
    v_sub_f32 v126, v126, v254
    v_mfma_f32_16x16x32_bf16 v[150:153], a[76:79], v[194:197], v[150:153]
    s_waitcnt lgkmcnt(2)
    v_exp_f32 v133, v133
    v_mfma_f32_16x16x32_bf16 v[150:153], a[80:83], v[122:125], v[150:153]
    s_waitcnt lgkmcnt(1)
    v_cvt_pk_bf16_f32 v141, v132, v133
    v_sub_f32 v127, v127, v254
    v_mfma_f32_16x16x32_bf16 v[150:153], a[84:87], v[202:205], v[150:153]
    s_waitcnt lgkmcnt(0)
    v_exp_f32 v126, v126
    v_mfma_f32_16x16x32_bf16 v[150:153], a[88:91], v[230:233], v[150:153]
    v_exp_f32 v127, v127
    v_mfma_f32_16x16x32_bf16 v[150:153], a[92:95], v[238:241], v[150:153]
    v_cvt_pk_bf16_f32 v36, v126, v127
    v_sub_f32 v128, v128, v254
    v_mfma_f32_16x16x32_bf16 v[162:165], a[96:99], v[186:189], 0
    v_exp_f32 v128, v128
    v_mfma_f32_16x16x32_bf16 v[162:165], a[100:103], v[194:197], v[162:165]
    v_sub_f32 v129, v129, v254
    v_sub_f32 v218, v218, v254
    v_mfma_f32_16x16x32_bf16 v[162:165], a[104:107], v[122:125], v[162:165]
    v_exp_f32 v129, v129
    v_mfma_f32_16x16x32_bf16 v[162:165], a[108:111], v[202:205], v[162:165]
    v_cvt_pk_bf16_f32 v37, v128, v129
    v_add_u32 v7, 16, v7
    v_mfma_f32_16x16x32_bf16 v[162:165], a[112:115], v[230:233], v[162:165]
    v_exp_f32 v218, v218
    v_mfma_f32_16x16x32_bf16 v[162:165], a[116:119], v[238:241], v[162:165]
    v_cvt_pk_bf16_f32 v39, v218, 0
    v_mfma_f32_16x16x32_bf16 v[170:173], a[120:123], v[186:189], 0
    v_mfma_f32_16x16x32_bf16 v[170:173], a[124:127], v[194:197], v[170:173]
    v_mfma_f32_16x16x32_bf16 v[142:145], v[28:31], v[36:39], 0
    v_mfma_f32_16x16x32_bf16 v[142:145], v[28:31], v[138:141], v[142:145]
    v_mfma_f32_16x16x32_bf16 v[130:133], v[246:249], v[36:39], 0
    v_mfma_f32_16x16x32_bf16 v[130:133], v[118:121], v[138:141], v[130:133]
    v_mfma_f32_16x16x32_bf16 v[118:121], v[154:157], v[36:39], 0
    v_mfma_f32_16x16x32_bf16 v[118:121], v[146:149], v[138:141], v[118:121]
    v_mfma_f32_16x16x32_bf16 v[158:161], v[214:217], v[36:39], 0
    v_mfma_f32_16x16x32_bf16 v[158:161], v[174:177], v[138:141], v[158:161]
    v_mfma_f32_16x16x32_bf16 v[170:173], a[128:131], v[122:125], v[170:173]
    v_mfma_f32_16x16x32_bf16 v[170:173], a[132:135], v[202:205], v[170:173]
    v_rcp_f32 v142, v142
    v_mfma_f32_16x16x32_bf16 v[170:173], a[136:139], v[230:233], v[170:173]
    v_mul_f32 v130, v142, v130
    v_mul_f32 v131, v142, v131
    v_mfma_f32_16x16x32_bf16 v[170:173], a[140:143], v[238:241], v[170:173]
    v_cvt_pk_bf16_f32 v174, v130, v131
    v_mul_f32 v132, v142, v132
    v_mfma_f32_16x16x32_bf16 v[138:141], a[0:3], v[186:189], 0
    v_mul_f32 v133, v142, v133
    v_cvt_pk_bf16_f32 v175, v132, v133
    v_mfma_f32_16x16x32_bf16 v[138:141], a[4:7], v[194:197], v[138:141]
    v_mul_f32 v118, v142, v118
    v_mul_f32 v119, v142, v119
    v_mfma_f32_16x16x32_bf16 v[138:141], a[8:11], v[122:125], v[138:141]
    v_cvt_pk_bf16_f32 v176, v118, v119
    v_mul_f32 v120, v142, v120
    v_mfma_f32_16x16x32_bf16 v[138:141], a[12:15], v[202:205], v[138:141]
    v_mul_f32 v121, v142, v121
    v_cvt_pk_bf16_f32 v177, v120, v121
    v_mfma_f32_16x16x32_bf16 v[138:141], a[16:19], v[230:233], v[138:141]
    ds_write_b128 v3, v[174:177] offset:12288
    v_mfma_f32_16x16x32_bf16 v[138:141], a[20:23], v[238:241], v[138:141]
    v_mul_f32 v158, v142, v158
    v_mul_f32 v159, v142, v159
    v_mfma_f32_16x16x32_bf16 v[166:169], a[24:27], v[186:189], 0
    v_cvt_pk_bf16_f32 v254, v158, v159
    v_mul_f32 v160, v142, v160
    v_mfma_f32_16x16x32_bf16 v[166:169], a[28:31], v[194:197], v[166:169]
    v_mul_f32 v161, v142, v161
    v_cvt_pk_bf16_f32 v255, v160, v161
    v_mfma_f32_16x16x32_bf16 v[166:169], a[32:35], v[122:125], v[166:169]
    ds_write_b64 v4, v[254:255] offset:16384
    v_mfma_f32_16x16x32_bf16 v[166:169], a[36:39], v[202:205], v[166:169]
    v_xor_b32 v3, 65536, v3
    v_xor_b32 v4, 65536, v4
    v_mfma_f32_16x16x32_bf16 v[166:169], a[40:43], v[230:233], v[166:169]
    v_mfma_f32_16x16x32_bf16 v[166:169], a[44:47], v[238:241], v[166:169]
    v_mfma_f32_16x16x32_bf16 v[134:137], a[48:51], v[186:189], 0
    v_mfma_f32_16x16x32_bf16 v[134:137], a[52:55], v[194:197], v[134:137]
    s_waitcnt lgkmcnt(0)
    s_barrier
    s_waitcnt lgkmcnt(0)
    s_cmp_eq_u32 s45, 0
    s_cbranch_scc1 L_drain
    s_nop 0
    s_lshr_b32 s3, s44, 8
    s_cbranch_scc1 L_safe
    v_cvt_pk_f16_f32 v146, v150, v151
    v_pk_mul_f16 v143, v146, v146
    v_cvt_pk_f16_f32 v147, v152, v153
    v_pk_fma_f16 v143, v147, v147, v143
    v_cvt_pk_f16_f32 v148, v162, v163
    v_pk_fma_f16 v143, v148, v148, v143
    v_cvt_pk_f16_f32 v149, v164, v165
    v_pk_fma_f16 v143, v149, v149, v143
    v_cvt_pk_f16_f32 v120, v170, v171
    v_pk_fma_f16 v143, v120, v120, v143
    v_cvt_pk_f16_f32 v121, v172, v173
    v_pk_fma_f16 v143, v121, v121, v143
    v_and_b32 v118, 16, v2
    v_sub_u32 v5, v5, v118
    v_mov_b32 v25, 0
    s_nop 7
    s_branch L_go
L_safe:
    v_fma_f32 v174, v150, v150, s32
    v_fmac_f32 v174, v151, v151
    v_fmac_f32 v174, v152, v152
    v_fmac_f32 v174, v153, v153
    s_nop 7
L_LOOP:
    v_mfma_f32_16x16x32_bf16 v[134:137], a[56:59], v[122:125], v[134:137]
    s_add_u32 s12, s40, s27
    ds_read_b128 v[118:121], v2 offset:18432
    ds_read_b128 v[142:145], v2 offset:19456
    v_mfma_f32_16x16x32_bf16 v[134:137], a[60:63], v[202:205], v[134:137]
    s_addc_u32 s13, s41, 0
    v_fmac_f32 v174, v162, v162
    v_fmac_f32 v174, v163, v163
    v_mfma_f32_16x16x32_bf16 v[134:137], a[64:67], v[230:233], v[134:137]
    s_sub_u32 s14, s36, s27
    v_fmac_f32 v174, v164, v164
    v_fmac_f32 v174, v165, v165
    v_mfma_f32_16x16x32_bf16 v[134:137], a[68:71], v[238:241], v[134:137]
    s_cmp_ge_u32 s18, 2
    v_fmac_f32 v174, v170, v170
    v_fmac_f32 v174, v171, v171
    v_mfma_f32_16x16x32_bf16 v[146:149], v[186:189], a[144:147], 0
    s_cselect_b32 s14, s14, 0
    v_fmac_f32 v174, v172, v172
    v_fmac_f32 v174, v173, v173
    v_mfma_f32_16x16x32_bf16 v[146:149], v[194:197], a[148:151], v[146:149]
    s_sub_u32 s82, s72, s71
    v_fma_f32 v254, v138, v138, s32
    v_fmac_f32 v254, v139, v139
    v_mfma_f32_16x16x32_bf16 v[146:149], v[122:125], a[152:155], v[146:149]
    s_mul_i32 s74, s82, 336
    v_fmac_f32 v254, v140, v140
    v_fmac_f32 v254, v141, v141
    v_mfma_f32_16x16x32_bf16 v[146:149], v[202:205], a[156:159], v[146:149]
    s_mul_i32 s75, s82, 272
    v_fmac_f32 v254, v166, v166
    v_fmac_f32 v254, v167, v167
    v_mfma_f32_16x16x32_bf16 v[146:149], v[230:233], a[160:163], v[146:149]
    s_waitcnt lgkmcnt(0)
    v_fmac_f32 v254, v168, v168
    v_fmac_f32 v254, v169, v169
    v_mfma_f32_16x16x32_bf16 v[182:185], v[32:35], v[118:121], 0
    s_mul_i32 s76, s82, 16
    v_fmac_f32 v254, v134, v134
    v_fmac_f32 v254, v135, v135
    v_mfma_f32_16x16x32_bf16 v[182:185], v[32:35], v[142:145], v[182:185]
    s_add_u32 s34, s18, 2
    v_fmac_f32 v254, v136, v136
    v_fmac_f32 v254, v137, v137
    v_mfma_f32_16x16x32_bf16 v[146:149], v[238:241], a[164:167], v[146:149]
    s_add_u32 s8, s60, s23
    ds_read_b128 v[190:193], v0 offset:26624
    v_cvt_pk_bf16_f32 v36, v254, v174
    v_mfma_f32_16x16x32_bf16 v[118:121], v[186:189], a[168:171], 0
    s_addc_u32 s9, s61, 0
    ds_read_b128 v[210:213], v1 offset:26624
    v_mul_f32 v254, 0x3baaaaab, v182
    v_mfma_f32_16x16x32_bf16 v[214:217], v[32:35], v[36:39], 0
    s_sub_u32 s10, s36, s23
    v_cvt_pk_bf16_f32 v142, v146, v147
    v_cvt_pk_bf16_f32 v143, v148, v149
    v_mfma_f32_16x16x32_bf16 v[118:121], v[194:197], a[172:175], v[118:121]
    s_cmp_le_u32 s34, s45
    ds_read_b128 v[218:221], v0 offset:26752
    v_mul_f32 v255, 0x3baaaaab, v183
    v_mfma_f32_16x16x32_bf16 v[118:121], v[122:125], a[176:179], v[118:121]
    s_cselect_b32 s10, s10, 0
    ds_read_b128 v[222:225], v1 offset:26752
    v_mul_f32 v144, 0x3baaaaab, v184
    v_mfma_f32_16x16x32_bf16 v[118:121], v[202:205], a[180:183], v[118:121]
    s_add_u32 m0, s28, 0
    v_rsq_f32 v215, v215
    v_mfma_f32_16x16x32_bf16 v[118:121], v[230:233], a[184:187], v[118:121]
    s_mov_b32 s27, s26
    v_rsq_f32 v214, v214
    v_mfma_f32_16x16x32_bf16 v[118:121], v[238:241], a[188:191], v[118:121]
    s_mov_b32 s26, s25
    v_mul_f32 v214, s31, v214
    v_mul_f32 v150, v215, v150
    v_mul_f32 v151, v215, v151
    v_cvt_pk_f16_f32 v174, v150, v151
    v_mfma_f32_16x16x32_bf16 v[182:185], v[186:189], a[192:195], 0
    s_waitcnt lgkmcnt(2)
    ds_read_b128 v[186:189], v0 offset:26880
    v_cvt_pk_bf16_f32 v146, v118, v119
    v_mfma_f32_16x16x32_bf16 v[182:185], v[194:197], a[196:199], v[182:185]
    s_mov_b32 s25, s24
    ds_read_b128 v[194:197], v1 offset:26880
    v_cvt_pk_bf16_f32 v147, v120, v121
    v_mfma_f32_16x16x32_bf16 v[182:185], v[122:125], a[200:203], v[182:185]
    s_mov_b32 s24, s23
    v_mul_f32 v152, v215, v152
    v_mul_f32 v153, v215, v153
    v_mfma_f32_16x16x32_bf16 v[182:185], v[202:205], a[204:207], v[182:185]
    s_ff1_i32_b32 s77, s100
    v_cvt_pk_f16_f32 v175, v152, v153
    v_mul_f32 v162, v215, v162
    v_mfma_f32_16x16x32_bf16 v[182:185], v[230:233], a[208:211], v[182:185]
    s_mul_i32 s78, s77, 2688
    v_mul_f32 v163, v215, v163
    v_cvt_pk_f16_f32 v176, v162, v163
    v_mfma_f32_16x16x32_bf16 v[182:185], v[238:241], a[212:215], v[182:185]
    s_mov_b32 s71, s72
    v_mul_f32 v164, v215, v164
    v_mul_f32 v165, v215, v165
    v_mfma_f32_16x16x32_bf16 v[122:125], a[72:75], v[190:193], 0
    s_mov_b32 s72, s73
    v_cvt_pk_f16_f32 v177, v164, v165
    v_mul_f32 v170, v215, v170
    v_mfma_f32_16x16x32_bf16 v[122:125], a[76:79], v[210:213], v[122:125]
    s_waitcnt lgkmcnt(2)
    v_cvt_pk_bf16_f32 v150, v182, v183
    v_cvt_pk_bf16_f32 v151, v184, v185
    v_mfma_f32_16x16x32_bf16 v[122:125], a[80:83], v[218:221], v[122:125]
    s_waitcnt lgkmcnt(1)
    v_mul_f32 v171, v215, v171
    v_cvt_pk_f16_f32 v120, v170, v171
    v_mfma_f32_16x16x32_bf16 v[122:125], a[84:87], v[222:225], v[122:125]
    s_waitcnt lgkmcnt(0)
    v_mul_f32 v172, v215, v172
    v_mul_f32 v173, v215, v173
    v_mfma_f32_16x16x32_bf16 v[122:125], a[88:91], v[186:189], v[122:125]
    v_cvt_pk_f16_f32 v121, v172, v173
    v_mul_f32 v138, v214, v138
    v_mfma_f32_16x16x32_bf16 v[122:125], a[92:95], v[194:197], v[122:125]
    v_mul_f32 v139, v214, v139
    v_cvt_pk_f16_f32 v202, v138, v139
    v_mfma_f32_16x16x32_bf16 v[162:165], a[96:99], v[190:193], 0
    v_mul_f32 v140, v214, v140
    v_mul_f32 v141, v214, v141
    v_mfma_f32_16x16x32_bf16 v[162:165], a[100:103], v[210:213], v[162:165]
    v_cvt_pk_f16_f32 v203, v140, v141
    v_mul_f32 v166, v214, v166
    v_mfma_f32_16x16x32_bf16 v[162:165], a[104:107], v[218:221], v[162:165]
    v_mul_f32 v167, v214, v167
    v_cvt_pk_f16_f32 v204, v166, v167
    v_mfma_f32_16x16x32_bf16 v[162:165], a[108:111], v[222:225], v[162:165]
    v_mul_f32 v168, v214, v168
    v_mul_f32 v169, v214, v169
    v_mfma_f32_16x16x32_bf16 v[162:165], a[112:115], v[186:189], v[162:165]
    v_cvt_pk_f16_f32 v205, v168, v169
    v_mul_f32 v134, v214, v134
    v_mfma_f32_16x16x32_bf16 v[162:165], a[116:119], v[194:197], v[162:165]
    v_mul_f32 v135, v214, v135
    v_cvt_pk_f16_f32 v118, v134, v135
    v_mfma_f32_16x16x32_bf16 v[166:169], a[120:123], v[190:193], 0
    v_mul_f32 v136, v214, v136
    v_mul_f32 v137, v214, v137
    v_mfma_f32_16x16x32_bf16 v[166:169], a[124:127], v[210:213], v[166:169]
    v_cvt_pk_f16_f32 v119, v136, v137
    v_fma_f32 v145, v122, v122, s32
    v_mfma_f32_16x16x32_bf16 v[166:169], a[128:131], v[218:221], v[166:169]
    v_rsq_f32 v254, v254
    v_mfma_f32_16x16x32_bf16 v[166:169], a[132:135], v[222:225], v[166:169]
    v_fmac_f32 v145, v123, v123
    v_fmac_f32 v145, v124, v124
    v_mfma_f32_16x16x32_bf16 v[166:169], a[136:139], v[186:189], v[166:169]
    v_fmac_f32 v145, v125, v125
    v_fmac_f32 v145, v162, v162
    v_mfma_f32_16x16x32_bf16 v[166:169], a[140:143], v[194:197], v[166:169]
    v_fmac_f32 v145, v163, v163
    v_fmac_f32 v145, v164, v164
    v_mfma_f32_16x16x32_bf16 v[134:137], a[0:3], v[190:193], 0
    v_fmac_f32 v145, v165, v165
    v_mul_f32 v178, v254, v178
    v_mfma_f32_16x16x32_bf16 v[134:137], a[4:7], v[210:213], v[134:137]
    v_rsq_f32 v255, v255
    v_mfma_f32_16x16x32_bf16 v[134:137], a[8:11], v[218:221], v[134:137]
    v_fmac_f32 v145, v166, v166
    v_fmac_f32 v145, v167, v167
    v_mfma_f32_16x16x32_bf16 v[134:137], a[12:15], v[222:225], v[134:137]
    v_fmac_f32 v145, v168, v168
    v_fmac_f32 v145, v169, v169
    v_mfma_f32_16x16x32_bf16 v[134:137], a[16:19], v[186:189], v[134:137]
    v_rsq_f32 v144, v144
    v_mfma_f32_16x16x32_bf16 v[134:137], a[20:23], v[194:197], v[134:137]
    v_mul_f32 v242, v144, v242
    v_mul_f32 v243, v144, v243
    v_mfma_f32_16x16x32_bf16 v[170:173], a[24:27], v[190:193], 0
    v_cvt_pk_bf16_f32 v138, v242, v243
    v_mul_f32 v244, v144, v244
    v_mfma_f32_16x16x32_bf16 v[170:173], a[28:31], v[210:213], v[170:173]
    v_mul_f32 v245, v144, v245
    v_cvt_pk_bf16_f32 v139, v244, v245
    v_mfma_f32_16x16x32_bf16 v[170:173], a[32:35], v[218:221], v[170:173]
    v_fma_f32 v148, v134, v134, s32
    v_fmac_f32 v148, v135, v135
    v_mfma_f32_16x16x32_bf16 v[170:173], a[36:39], v[222:225], v[170:173]
    v_fmac_f32 v148, v136, v136
    v_fmac_f32 v148, v137, v137
    v_mfma_f32_16x16x32_bf16 v[170:173], a[40:43], v[186:189], v[170:173]
    v_mul_f32 v158, v144, v158
    v_mul_f32 v159, v144, v159
    v_mfma_f32_16x16x32_bf16 v[170:173], a[44:47], v[194:197], v[170:173]
    v_cvt_pk_bf16_f32 v140, v158, v159
    v_mul_f32 v160, v144, v160
    v_mfma_f32_16x16x32_bf16 v[182:185], a[48:51], v[190:193], 0
    v_mul_f32 v161, v144, v161
    v_cvt_pk_bf16_f32 v141, v160, v161
    v_mfma_f32_16x16x32_bf16 v[182:185], a[52:55], v[210:213], v[182:185]
    buffer_store_dwordx4 v[138:141], v17, s[12:15], 0 offen nt
    v_mul_f32 v154, v144, v154
    v_fmac_f32 v148, v170, v170
    v_fmac_f32 v148, v171, v171
    v_fmac_f32 v148, v172, v172
    v_mfma_f32_16x16x32_bf16 v[182:185], a[56:59], v[218:221], v[182:185]
    v_fmac_f32 v148, v173, v173
    v_mul_f32 v155, v144, v155
    v_mfma_f32_16x16x32_bf16 v[182:185], a[60:63], v[222:225], v[182:185]
    v_cvt_pk_bf16_f32 v152, v154, v155
    v_mul_f32 v156, v144, v156
    v_mfma_f32_16x16x32_bf16 v[182:185], a[64:67], v[186:189], v[182:185]
    v_mul_f32 v157, v144, v157
    v_cvt_pk_bf16_f32 v153, v156, v157
    v_mfma_f32_16x16x32_bf16 v[182:185], a[68:71], v[194:197], v[182:185]
    v_mul_f32 v179, v254, v179
    v_cvt_pk_bf16_f32 v158, v178, v179
    v_mfma_f32_16x16x32_bf16 v[138:141], v[190:193], a[144:147], 0
    v_mul_f32 v180, v254, v180
    v_mul_f32 v181, v254, v181
    v_mfma_f32_16x16x32_bf16 v[138:141], v[210:213], a[148:151], v[138:141]
    v_cvt_pk_bf16_f32 v159, v180, v181
    v_mul_f32 v198, v254, v198
    v_mfma_f32_16x16x32_bf16 v[138:141], v[218:221], a[152:155], v[138:141]
    v_fmac_f32 v148, v182, v182
    v_fmac_f32 v148, v183, v183
    v_mfma_f32_16x16x32_bf16 v[138:141], v[222:225], a[156:159], v[138:141]
    v_fmac_f32 v148, v184, v184
    v_fmac_f32 v148, v185, v185
    v_mfma_f32_16x16x32_bf16 v[138:141], v[186:189], a[160:163], v[138:141]
    v_cvt_pk_bf16_f32 v36, v148, v145
    v_mul_f32 v199, v254, v199
    v_mfma_f32_16x16x32_bf16 v[138:141], v[194:197], a[164:167], v[138:141]
    ds_read_b128 v[214:217], v0 offset:32768
    v_cvt_pk_bf16_f32 v160, v198, v199
    v_mfma_f32_16x16x32_bf16 v[178:181], v[32:35], v[36:39], 0
    v_mul_f32 v200, v254, v200
    v_mul_f32 v201, v254, v201
    v_mfma_f32_16x16x32_bf16 v[154:157], v[190:193], a[168:171], 0
    ds_read_b128 v[226:229], v1 offset:32768
    v_cvt_pk_bf16_f32 v161, v200, v201
    v_mfma_f32_16x16x32_bf16 v[154:157], v[210:213], a[172:175], v[154:157]
    ds_read_b128 v[198:201], v0 offset:32896
    v_cvt_pk_bf16_f32 v144, v138, v139
    v_mfma_f32_16x16x32_bf16 v[154:157], v[218:221], a[176:179], v[154:157]
    v_cvt_pk_bf16_f32 v145, v140, v141
    v_mul_f32 v206, v254, v206
    v_mfma_f32_16x16x32_bf16 v[154:157], v[222:225], a[180:183], v[154:157]
    ds_read_b128 v[230:233], v1 offset:32896
    v_mul_f32 v207, v254, v207
    v_mfma_f32_16x16x32_bf16 v[154:157], v[186:189], a[184:187], v[154:157]
    v_rsq_f32 v179, v179
    v_mfma_f32_16x16x32_bf16 v[154:157], v[194:197], a[188:191], v[154:157]
    buffer_store_dwordx2 v[152:153], v20, s[12:15], 0 offen nt
    v_rsq_f32 v178, v178
    v_mul_f32 v122, v179, v122
    v_mul_f32 v178, s31, v178
    v_mul_f32 v123, v179, v123
    v_cvt_pk_f16_f32 v138, v122, v123
    v_mul_f32 v124, v179, v124
    v_mul_f32 v125, v179, v125
    v_cvt_pk_bf16_f32 v148, v154, v155
    v_mfma_f32_16x16x32_bf16 v[234:237], v[190:193], a[192:195], 0
    s_waitcnt lgkmcnt(2)
    ds_read_b128 v[190:193], v0 offset:33024
    v_cvt_pk_bf16_f32 v149, v156, v157
    v_mfma_f32_16x16x32_bf16 v[234:237], v[210:213], a[196:199], v[234:237]
    s_waitcnt lgkmcnt(2)
    ds_read_b128 v[210:213], v1 offset:33024
    v_cvt_pk_f16_f32 v139, v124, v125
    v_mfma_f32_16x16x32_bf16 v[234:237], v[218:221], a[200:203], v[234:237]
    v_mul_f32 v162, v179, v162
    v_mul_f32 v163, v179, v163
    v_mfma_f32_16x16x32_bf16 v[234:237], v[222:225], a[204:207], v[234:237]
    s_waitcnt vmcnt(2)
    v_cvt_pk_f16_f32 v140, v162, v163
    v_mul_f32 v164, v179, v164
    v_mfma_f32_16x16x32_bf16 v[234:237], v[186:189], a[208:211], v[234:237]
    s_waitcnt lgkmcnt(2)
    v_mul_f32 v165, v179, v165
    v_cvt_pk_f16_f32 v141, v164, v165
    v_mfma_f32_16x16x32_bf16 v[234:237], v[194:197], a[212:215], v[234:237]
    v_mul_f32 v166, v179, v166
    v_mul_f32 v167, v179, v167
    v_mfma_f32_16x16x32_bf16 v[186:189], a[72:75], v[214:217], 0
    v_cvt_pk_f16_f32 v124, v166, v167
    v_mul_f32 v168, v179, v168
    v_mfma_f32_16x16x32_bf16 v[186:189], a[76:79], v[226:229], v[186:189]
    v_mul_f32 v169, v179, v169
    v_cvt_pk_f16_f32 v125, v168, v169
    v_mfma_f32_16x16x32_bf16 v[186:189], a[80:83], v[198:201], v[186:189]
    s_waitcnt lgkmcnt(1)
    v_cvt_pk_bf16_f32 v152, v234, v235
    v_cvt_pk_bf16_f32 v153, v236, v237
    v_mfma_f32_16x16x32_bf16 v[186:189], a[84:87], v[230:233], v[186:189]
    s_waitcnt lgkmcnt(0)
    v_mul_f32 v134, v178, v134
    v_mul_f32 v135, v178, v135
    v_mfma_f32_16x16x32_bf16 v[186:189], a[88:91], v[190:193], v[186:189]
    s_barrier
    v_cvt_pk_f16_f32 v154, v134, v135
    v_mul_f32 v136, v178, v136
    v_mfma_f32_16x16x32_bf16 v[186:189], a[92:95], v[210:213], v[186:189]
    v_mul_f32 v137, v178, v137
    v_cvt_pk_f16_f32 v155, v136, v137
    v_mfma_f32_16x16x32_bf16 v[134:137], a[96:99], v[214:217], 0
    v_mul_f32 v170, v178, v170
    v_mul_f32 v171, v178, v171
    v_mfma_f32_16x16x32_bf16 v[134:137], a[100:103], v[226:229], v[134:137]
    v_cvt_pk_f16_f32 v156, v170, v171
    v_mul_f32 v172, v178, v172
    v_mfma_f32_16x16x32_bf16 v[134:137], a[104:107], v[198:201], v[134:137]
    buffer_load_dwordx4 v10, s[8:11], 0 offen nt lds
    v_mul_f32 v173, v178, v173
    v_mfma_f32_16x16x32_bf16 v[134:137], a[108:111], v[230:233], v[134:137]
    s_add_u32 m0, s28, 4096
    v_cvt_pk_f16_f32 v157, v172, v173
    v_mul_f32 v182, v178, v182
    v_mfma_f32_16x16x32_bf16 v[134:137], a[112:115], v[190:193], v[134:137]
    v_mul_f32 v183, v178, v183
    v_cvt_pk_f16_f32 v122, v182, v183
    v_mfma_f32_16x16x32_bf16 v[134:137], a[116:119], v[210:213], v[134:137]
    v_mul_f32 v184, v178, v184
    v_mul_f32 v185, v178, v185
    v_mfma_f32_16x16x32_bf16 v[218:221], a[120:123], v[214:217], 0
    v_cvt_pk_f16_f32 v123, v184, v185
    v_cvt_pk_bf16_f32 v170, v206, v207
    v_mfma_f32_16x16x32_bf16 v[218:221], a[124:127], v[226:229], v[218:221]
    buffer_load_dwordx4 v11, s[8:11], 0 offen nt lds
    v_mul_f32 v208, v254, v208
    v_mfma_f32_16x16x32_bf16 v[218:221], a[128:131], v[198:201], v[218:221]
    s_add_u32 m0, s28, 8192
    v_mul_f32 v209, v254, v209
    v_cvt_pk_bf16_f32 v171, v208, v209
    v_mfma_f32_16x16x32_bf16 v[218:221], a[132:135], v[230:233], v[218:221]
    v_fma_f32 v162, v186, v186, s32
    v_fmac_f32 v162, v187, v187
    v_mfma_f32_16x16x32_bf16 v[218:221], a[136:139], v[190:193], v[218:221]
    v_fmac_f32 v162, v188, v188
    v_fmac_f32 v162, v189, v189
    v_mfma_f32_16x16x32_bf16 v[218:221], a[140:143], v[210:213], v[218:221]
    v_fmac_f32 v162, v134, v134
    v_fmac_f32 v162, v135, v135
    v_mfma_f32_16x16x32_bf16 v[222:225], a[0:3], v[214:217], 0
    buffer_load_dwordx4 v12, s[8:11], 0 offen nt lds
    v_fmac_f32 v162, v136, v136
    v_mfma_f32_16x16x32_bf16 v[222:225], a[4:7], v[226:229], v[222:225]
    s_add_u32 m0, s28, 12288
    v_fmac_f32 v162, v137, v137
    v_fmac_f32 v162, v218, v218
    v_mfma_f32_16x16x32_bf16 v[222:225], a[8:11], v[198:201], v[222:225]
    s_xor_b32 s28, s28, 65536
    v_fmac_f32 v162, v219, v219
    v_fmac_f32 v162, v220, v220
    v_mfma_f32_16x16x32_bf16 v[222:225], a[12:15], v[230:233], v[222:225]
    v_fmac_f32 v162, v221, v221
    v_mul_f32 v130, v255, v130
    v_mfma_f32_16x16x32_bf16 v[222:225], a[16:19], v[190:193], v[222:225]
    v_mul_f32 v131, v255, v131
    v_cvt_pk_bf16_f32 v130, v130, v131
    v_mfma_f32_16x16x32_bf16 v[222:225], a[20:23], v[210:213], v[222:225]
    buffer_load_dwordx4 v13, s[8:11], 0 offen nt lds
    v_mul_f32 v132, v255, v132
    v_mfma_f32_16x16x32_bf16 v[238:241], a[24:27], v[214:217], 0
    s_mov_b32 m0, s29
    v_mul_f32 v133, v255, v133
    v_cvt_pk_bf16_f32 v131, v132, v133
    v_mfma_f32_16x16x32_bf16 v[238:241], a[28:31], v[226:229], v[238:241]
    s_xor_b32 s29, s29, s30
    v_fma_f32 v163, v222, v222, s32
    v_fmac_f32 v163, v223, v223
    v_mfma_f32_16x16x32_bf16 v[238:241], a[32:35], v[198:201], v[238:241]
    s_add_u32 s19, s19, s20
    v_fmac_f32 v163, v224, v224
    v_fmac_f32 v163, v225, v225
    v_mfma_f32_16x16x32_bf16 v[238:241], a[36:39], v[230:233], v[238:241]
    s_add_u32 s23, s23, s21
    v_mul_f32 v126, v255, v126
    v_mul_f32 v127, v255, v127
    v_mfma_f32_16x16x32_bf16 v[238:241], a[40:43], v[190:193], v[238:241]
    buffer_load_dwordx4 v14, s[8:11], 0 offen nt lds
    v_cvt_pk_bf16_f32 v132, v126, v127
    v_mfma_f32_16x16x32_bf16 v[238:241], a[44:47], v[210:213], v[238:241]
    s_cmp_ge_u32 s19, 72
    v_mul_f32 v128, v255, v128
    v_mul_f32 v129, v255, v129
    v_mfma_f32_16x16x32_bf16 v[178:181], a[48:51], v[214:217], 0
    s_cselect_b32 s34, 72, 0
    v_cvt_pk_bf16_f32 v133, v128, v129
    v_mul_f32 v114, v255, v114
    v_mfma_f32_16x16x32_bf16 v[178:181], a[52:55], v[226:229], v[178:181]
    s_cselect_b32 s35, s22, 0
    v_fmac_f32 v163, v238, v238
    v_fmac_f32 v163, v239, v239
    v_mfma_f32_16x16x32_bf16 v[178:181], a[56:59], v[198:201], v[178:181]
    s_sub_u32 s19, s19, s34
    v_fmac_f32 v163, v240, v240
    v_fmac_f32 v163, v241, v241
    v_mfma_f32_16x16x32_bf16 v[178:181], a[60:63], v[230:233], v[178:181]
    buffer_store_dwordx4 v[158:161], v15, s[12:15], 0 offen nt
    v_mul_f32 v115, v255, v115
    v_cvt_pk_bf16_f32 v254, v114, v115
    v_mul_f32 v116, v255, v116
    v_mul_f32 v117, v255, v117
    v_mfma_f32_16x16x32_bf16 v[178:181], a[64:67], v[190:193], v[178:181]
    s_add_u32 s23, s23, s35
    v_cvt_pk_bf16_f32 v255, v116, v117
    v_xor_b32 v0, 65536, v0
    v_mfma_f32_16x16x32_bf16 v[178:181], a[68:71], v[210:213], v[178:181]
    s_add_u32 s78, s78, s69
    v_xor_b32 v1, 65536, v1
    s_add_u32 s80, s77, s68
    v_mfma_f32_16x16x32_bf16 v[114:117], v[214:217], a[144:147], 0
    s_cmp_ge_u32 s80, 72
    s_cselect_b32 s80, s22, 0
    s_add_u32 s78, s78, s80
    v_mfma_f32_16x16x32_bf16 v[114:117], v[226:229], a[148:151], v[114:117]
    s_add_u32 s80, s77, 20
    v_fmac_f32 v163, v178, v178
    v_fmac_f32 v163, v179, v179
    v_mfma_f32_16x16x32_bf16 v[114:117], v[198:201], a[152:155], v[114:117]
    s_add_u32 s34, s18, 3
    v_fmac_f32 v163, v180, v180
    v_fmac_f32 v163, v181, v181
    v_mfma_f32_16x16x32_bf16 v[114:117], v[230:233], a[156:159], v[114:117]
    s_cmp_lt_u32 s77, s62
    ds_read2_b32 v[164:165], v6 offset0:0 offset1:0
    ds_read2_b32 v[168:169], v6 offset0:16 offset1:16
    v_mfma_f32_16x16x32_bf16 v[114:117], v[190:193], a[160:163], v[114:117]
    s_cselect_b32 s79, 1, 0
    ds_read2_b32 v[172:173], v6 offset0:32 offset1:32
    v_cvt_pk_bf16_f32 v36, v163, v162
    v_mfma_f32_16x16x32_bf16 v[114:117], v[210:213], a[164:167], v[114:117]
    s_cselect_b32 s78, s78, 0
    s_cmp_lt_u32 s34, s17
    s_cselect_b32 s23, s23, s78
    v_mfma_f32_16x16x32_bf16 v[234:237], v[32:35], v[36:39], 0
    s_cselect_b32 s73, s34, s80
    s_cselect_b32 s79, 0, s79
    s_cselect_b32 s81, 0, 1
    v_mfma_f32_16x16x32_bf16 v[126:129], v[214:217], a[168:171], 0
    s_sub_u32 s80, s100, s81
    v_cvt_pk_bf16_f32 v162, v114, v115
    v_cvt_pk_bf16_f32 v163, v116, v117
    v_mfma_f32_16x16x32_bf16 v[126:129], v[226:229], a[172:175], v[126:129]
    s_and_b32 s100, s100, s80
    v_rsq_f32 v235, v235
    v_mfma_f32_16x16x32_bf16 v[126:129], v[198:201], a[176:179], v[126:129]
    s_lshl_b32 s80, s79, s73
    v_rsq_f32 v234, v234
    v_mfma_f32_16x16x32_bf16 v[126:129], v[230:233], a[180:183], v[126:129]
    s_or_b32 s70, s70, s80
    v_mul_f32 v234, s31, v234
    v_mul_f32 v186, v235, v186
    v_mfma_f32_16x16x32_bf16 v[126:129], v[190:193], a[184:187], v[126:129]
    s_add_u32 s45, s45, s79
    v_mul_f32 v187, v235, v187
    v_cvt_pk_f16_f32 v114, v186, v187
    v_mfma_f32_16x16x32_bf16 v[126:129], v[210:213], a[188:191], v[126:129]
    s_add_u32 s18, s18, 1
    v_mul_f32 v188, v235, v188
    v_mul_f32 v189, v235, v189
    v_mfma_f32_16x16x32_bf16 v[158:161], v[214:217], a[192:195], 0
    s_cmp_lt_u32 s18, s45
    v_cvt_pk_f16_f32 v115, v188, v189
    v_mul_f32 v134, v235, v134
    v_mfma_f32_16x16x32_bf16 v[158:161], v[226:229], a[196:199], v[158:161]
    s_waitcnt lgkmcnt(0)
    buffer_store_dwordx2 v[170:171], v18, s[12:15], 0 offen nt
    v_cvt_pk_bf16_f32 v166, v126, v127
    v_cvt_pk_bf16_f32 v167, v128, v129
    v_mfma_f32_16x16x32_bf16 v[158:161], v[198:201], a[200:203], v[158:161]
    ds_read_b128 v[226:229], v5 offset:0
    ds_read_b128 v[206:209], v5 offset:16
    v_mfma_f32_16x16x32_bf16 v[158:161], v[230:233], a[204:207], v[158:161]
    ds_read_b128 v[198:201], v5 offset:48
    ds_read_b32 v236, v6 offset:192
    v_mfma_f32_16x16x32_bf16 v[158:161], v[190:193], a[208:211], v[158:161]
    v_mul_f32 v135, v235, v135
    v_cvt_pk_f16_f32 v116, v134, v135
    v_mfma_f32_16x16x32_f16 v[186:189], v[174:177], v[202:205], v[46:49]
    v_mul_f32 v136, v235, v136
    v_mul_f32 v137, v235, v137
    v_mfma_f32_16x16x32_f16 v[182:185], v[138:141], v[202:205], v[50:53]
    v_cvt_pk_f16_f32 v117, v136, v137
    v_mul_f32 v218, v235, v218
    v_mfma_f32_16x16x32_bf16 v[158:161], v[210:213], a[212:215], v[158:161]
    ds_read_b128 v[194:197], v2 offset:0
    ds_read_b128 v[190:193], v2 offset:1024
    v_mfma_f32_16x16x32_f16 v[126:129], v[114:117], v[202:205], v[54:57]
    v_mul_f32 v219, v235, v219
    v_cvt_pk_f16_f32 v136, v218, v219
    v_mul_f32 v220, v235, v220
    v_mfma_f32_16x16x16_f16 v[186:189], v[120:121], v[118:119], v[186:189]
    v_mul_f32 v221, v235, v221
    v_cvt_pk_bf16_f32 v170, v158, v159
    v_cvt_pk_bf16_f32 v171, v160, v161
    v_mfma_f32_16x16x16_f16 v[182:185], v[124:125], v[118:119], v[182:185]
    v_cvt_pk_f16_f32 v137, v220, v221
    v_mul_f32 v222, v234, v222
    v_mul_f32 v223, v234, v223
    v_mfma_f32_16x16x16_f16 v[126:129], v[136:137], v[118:119], v[126:129]
    v_cvt_pk_f16_f32 v158, v222, v223
    v_mul_f32 v224, v234, v224
    v_mul_f32 v225, v234, v225
    s_waitcnt lgkmcnt(2)
    v_mfma_f32_16x16x32_f16 v[230:233], v[226:229], v[202:205], v[22:25]
    ds_read_b128 v[210:213], v2 offset:2048
    ds_read_b128 v[202:205], v2 offset:3072
    v_mfma_f32_16x16x32_f16 v[230:233], v[206:209], v[174:177], v[230:233]
    v_cvt_pk_f16_f32 v159, v224, v225
    v_mul_f32 v238, v234, v238
    v_mfma_f32_16x16x32_f16 v[230:233], v[198:201], v[118:121], v[230:233]
    s_waitcnt lgkmcnt(2)
    ds_read_b128 v[214:217], v2 offset:4096
    v_mul_f32 v239, v234, v239
    v_cvt_pk_f16_f32 v160, v238, v239
    v_mul_f32 v240, v234, v240
    v_mul_f32 v241, v234, v241
    v_cvt_pk_f16_f32 v161, v240, v241
    v_mfma_f32_16x16x32_f16 v[218:221], v[226:229], v[154:157], v[24:27]
    v_mul_f32 v178, v234, v178
    v_mul_f32 v179, v234, v179
    v_mfma_f32_16x16x32_f16 v[218:221], v[206:209], v[138:141], v[218:221]
    v_cvt_pk_f16_f32 v134, v178, v179
    v_mul_f32 v180, v234, v180
    v_mfma_f32_16x16x32_f16 v[218:221], v[198:201], v[122:125], v[218:221]
    buffer_store_dwordx4 v[130:133], v16, s[12:15], 0 offen nt
    ds_read_b128 v[222:225], v2 offset:5120
    v_mul_f32 v181, v234, v181
    v_cvt_pk_f16_f32 v135, v180, v181
    v_mov_b32_dpp v236, v231 quad_perm:[0,1,2,3] row_mask:0x1 bank_mask:0xf
    v_mfma_f32_16x16x32_f16 v[238:241], v[226:229], v[158:161], v[26:29]
    s_waitcnt lgkmcnt(2)
    v_max3_f32 v118, v230, v186, v187
    v_mov_b32_dpp v236, v219 quad_perm:[0,1,2,3] row_mask:0x2 bank_mask:0xf
    v_mfma_f32_16x16x32_f16 v[238:241], v[206:209], v[114:117], v[238:241]
    v_max3_f32 v118, v118, v188, v189
    v_max3_f32 v118, v118, v182, v183
    v_mfma_f32_16x16x32_f16 v[238:241], v[198:201], v[134:137], v[238:241]
    s_waitcnt lgkmcnt(1)
    v_max3_f32 v118, v118, v184, v185
    v_max3_f32 v118, v118, v126, v127
    v_mfma_f32_16x16x32_bf16 v[178:181], a[216:219], v[194:197], 0
    v_max3_f32 v118, v118, v128, v129
    v_mov_b32 v119, v118
    v_mfma_f32_16x16x32_bf16 v[178:181], a[220:223], v[190:193], v[178:181]
    v_add_u32 v5, s74, v5
    v_mov_b32_dpp v236, v239 quad_perm:[0,1,2,3] row_mask:0x4 bank_mask:0xf
    v_mfma_f32_16x16x32_bf16 v[178:181], a[224:227], v[210:213], v[178:181]
    v_permlane32_swap_b32 v118, v119
    v_mfma_f32_16x16x32_bf16 v[178:181], a[228:231], v[202:205], v[178:181]
    s_waitcnt lgkmcnt(0)
    v_max_f32 v118, v118, v119
    v_mov_b32 v119, v118
    v_mfma_f32_16x16x32_bf16 v[178:181], a[232:235], v[214:217], v[178:181]
    v_mov_b32 v219, v236
    v_add_u32 v6, s75, v6
    v_mfma_f32_16x16x32_bf16 v[178:181], a[236:239], v[222:225], v[178:181]
    v_permlane16_swap_b32 v118, v119
    v_mfma_f32_16x16x32_bf16 v[198:201], a[240:243], v[194:197], 0
    v_max_f32 v118, v118, v119
    v_sub_f32 v186, v186, v118
    v_mfma_f32_16x16x32_bf16 v[198:201], a[244:247], v[190:193], v[198:201]
    v_exp_f32 v186, v186
    v_mfma_f32_16x16x32_bf16 v[198:201], a[248:251], v[210:213], v[198:201]
    v_sub_f32 v187, v187, v118
    v_sub_f32 v188, v188, v118
    v_mfma_f32_16x16x32_bf16 v[198:201], a[252:255], v[202:205], v[198:201]
    v_exp_f32 v187, v187
    v_mfma_f32_16x16x32_bf16 v[198:201], v[82:85], v[214:217], v[198:201]
    v_cvt_pk_bf16_f32 v186, v186, v187
    v_sub_f32 v189, v189, v118
    v_mfma_f32_16x16x32_bf16 v[198:201], v[86:89], v[222:225], v[198:201]
    v_exp_f32 v188, v188
    v_mfma_f32_16x16x32_bf16 v[206:209], v[90:93], v[194:197], 0
    ds_read_b128 v[194:197], v2 offset:6144
    buffer_store_dwordx2 v[254:255], v19, s[12:15], 0 offen nt
    v_exp_f32 v189, v189
    v_mfma_f32_16x16x32_bf16 v[206:209], v[94:97], v[190:193], v[206:209]
    ds_read_b128 v[190:193], v2 offset:7168
    v_cvt_pk_bf16_f32 v187, v188, v189
    v_mfma_f32_16x16x32_bf16 v[206:209], v[98:101], v[210:213], v[206:209]
    ds_read_b128 v[210:213], v2 offset:8192
    v_sub_f32 v182, v182, v118
    v_mfma_f32_16x16x32_bf16 v[206:209], v[102:105], v[202:205], v[206:209]
    ds_read_b128 v[202:205], v2 offset:9216
    v_sub_f32 v183, v183, v118
    v_mfma_f32_16x16x32_bf16 v[206:209], v[106:109], v[214:217], v[206:209]
    ds_read_b128 v[214:217], v2 offset:10240
    v_sub_f32 v184, v184, v118
    v_mfma_f32_16x16x32_bf16 v[206:209], v[110:113], v[222:225], v[206:209]
    ds_read_b128 v[222:225], v2 offset:11264
    v_exp_f32 v182, v182
    v_mfma_f32_16x16x32_f16 v[226:229], v[174:177], v[154:157], v[58:61]
    v_exp_f32 v183, v183
    s_waitcnt lgkmcnt(5)
    v_mfma_f32_16x16x32_bf16 v[130:133], a[216:219], v[194:197], 0
    v_cvt_pk_bf16_f32 v188, v182, v183
    v_exp_f32 v184, v184
    s_waitcnt lgkmcnt(4)
    v_mfma_f32_16x16x16_f16 v[226:229], v[120:121], v[122:123], v[226:229]
    v_sub_f32 v185, v185, v118
    v_exp_f32 v185, v185
    v_sub_f32 v126, v126, v118
    v_mfma_f32_16x16x32_bf16 v[130:133], a[220:223], v[190:193], v[130:133]
    s_waitcnt lgkmcnt(2)
    v_cvt_pk_bf16_f32 v189, v184, v185
    v_sub_f32 v127, v127, v118
    v_mfma_f32_16x16x32_bf16 v[130:133], a[224:227], v[210:213], v[130:133]
    s_waitcnt lgkmcnt(1)
    v_exp_f32 v126, v126
    v_mfma_f32_16x16x32_bf16 v[130:133], a[228:231], v[202:205], v[130:133]
    s_waitcnt lgkmcnt(0)
    v_exp_f32 v127, v127
    v_mfma_f32_16x16x32_bf16 v[130:133], a[232:235], v[214:217], v[130:133]
    v_cvt_pk_bf16_f32 v36, v126, v127
    v_sub_f32 v128, v128, v118
    v_mfma_f32_16x16x32_f16 v[182:185], v[138:141], v[154:157], v[62:65]
    v_exp_f32 v128, v128
    v_mfma_f32_16x16x32_bf16 v[130:133], a[236:239], v[222:225], v[130:133]
    v_sub_f32 v129, v129, v118
    v_exp_f32 v129, v129
    v_sub_f32 v230, v230, v118
    v_cvt_pk_bf16_f32 v37, v128, v129
    v_mfma_f32_16x16x16_f16 v[182:185], v[124:125], v[122:123], v[182:185]
    v_exp_f32 v230, v230
    v_max_f32_dpp v219, v219, v219 quad_perm:[1,0,3,2] row_mask:0xf bank_mask:0xf
    v_cvt_pk_bf16_f32 v39, v230, 0
    v_mfma_f32_16x16x32_f16 v[230:233], v[114:117], v[154:157], v[66:69]
    v_max_f32_dpp v219, v219, v219 quad_perm:[2,3,0,1] row_mask:0xf bank_mask:0xf
    v_max3_f32 v254, v218, v226, v227
    v_max3_f32 v254, v254, v228, v229
    v_max_f32_dpp v219, v219, v219 row_half_mirror row_mask:0xf bank_mask:0xf
    v_max3_f32 v254, v254, v182, v183
    v_max3_f32 v254, v254, v184, v185
    v_mfma_f32_16x16x16_f16 v[230:233], v[136:137], v[122:123], v[230:233]
    v_max_f32_dpp v219, v219, v219 row_mirror row_mask:0xf bank_mask:0xf
    v_mov_b32 v255, v219
    v_fma_f32 v118, v178, v178, s33
    v_fmac_f32 v118, v179, v179
    v_permlane32_swap_b32 v219, v255
    v_max_f32 v219, v219, v255
    v_mfma_f32_16x16x32_bf16 v[154:157], v[28:31], v[36:39], 0
    v_mov_b32 v255, v219
    v_max3_f32 v254, v254, v230, v231
    v_mfma_f32_16x16x32_bf16 v[154:157], v[28:31], v[186:189], v[154:157]
    v_permlane16_swap_b32 v219, v255
    v_max_f32 v219, v219, v255
    v_sub_f32 v236, v236, v219
    v_mfma_f32_16x16x32_bf16 v[126:129], v[162:165], v[36:39], 0
    v_exp_f32 v236, v236
    v_mfma_f32_16x16x32_bf16 v[126:129], v[142:145], v[186:189], v[126:129]
    v_cvt_pk_bf16_f32 v236, v236, v236
    v_max3_f32 v254, v254, v232, v233
    v_rcp_f32 v154, v154
    v_mov_b32 v119, v254
    v_fmac_f32 v118, v180, v180
    v_fmac_f32 v118, v181, v181
    v_permlane32_swap_b32 v254, v119
    v_max_f32 v254, v254, v119
    v_mul_f32 v126, v154, v126
    v_mul_f32 v127, v154, v127
    v_cvt_pk_bf16_f32 v126, v126, v127
    v_mul_f32 v128, v154, v128
    v_mul_f32 v129, v154, v129
    v_cvt_pk_bf16_f32 v127, v128, v129
    v_mov_b32 v119, v254
    v_fmac_f32 v118, v198, v198
    v_fmac_f32 v118, v199, v199
    v_permlane16_swap_b32 v254, v119
    v_max_f32 v254, v254, v119
    v_sub_f32 v226, v226, v254
    v_exp_f32 v226, v226
    v_sub_f32 v227, v227, v254
    v_exp_f32 v227, v227
    v_sub_f32 v228, v228, v254
    v_cvt_pk_bf16_f32 v226, v226, v227
    v_exp_f32 v228, v228
    v_sub_f32 v229, v229, v254
    v_exp_f32 v229, v229
    v_sub_f32 v182, v182, v254
    v_cvt_pk_bf16_f32 v227, v228, v229
    v_mfma_f32_16x16x32_bf16 v[242:245], v[166:169], v[36:39], 0
    ds_write_b16 v8, v236
    v_mfma_f32_16x16x32_bf16 v[242:245], v[146:149], v[186:189], v[242:245]
    v_exp_f32 v182, v182
    v_sub_f32 v183, v183, v254
    v_exp_f32 v183, v183
    v_sub_f32 v184, v184, v254
    v_cvt_pk_bf16_f32 v228, v182, v183
    v_exp_f32 v184, v184
    v_sub_f32 v185, v185, v254
    v_exp_f32 v185, v185
    v_mul_f32 v242, v154, v242
    v_mul_f32 v243, v154, v243
    v_cvt_pk_bf16_f32 v128, v242, v243
    v_mul_f32 v244, v154, v244
    v_mul_f32 v245, v154, v245
    v_cvt_pk_bf16_f32 v129, v244, v245
    v_mfma_f32_16x16x32_bf16 v[234:237], v[170:173], v[36:39], 0
    ds_write_b128 v3, v[126:129] offset:0
    v_mfma_f32_16x16x32_bf16 v[234:237], v[150:153], v[186:189], v[234:237]
    v_cvt_pk_bf16_f32 v229, v184, v185
    v_sub_f32 v230, v230, v254
    v_mfma_f32_16x16x32_f16 v[182:185], v[174:177], v[158:161], v[70:73]
    v_exp_f32 v230, v230
    v_mfma_f32_16x16x32_bf16 v[126:129], a[240:243], v[194:197], 0
    ds_read_b128 v[174:177], v9
    v_sub_f32 v231, v231, v254
    v_mfma_f32_16x16x32_bf16 v[126:129], a[244:247], v[190:193], v[126:129]
    v_mul_f32 v234, v154, v234
    v_mul_f32 v235, v154, v235
    v_cvt_pk_bf16_f32 v122, v234, v235
    v_mfma_f32_16x16x16_f16 v[182:185], v[120:121], v[134:135], v[182:185]
    v_mul_f32 v236, v154, v236
    v_mul_f32 v237, v154, v237
    v_cvt_pk_bf16_f32 v123, v236, v237
    v_sub_f32 v232, v232, v254
    v_mfma_f32_16x16x32_bf16 v[126:129], a[248:251], v[210:213], v[126:129]
    ds_read_b128 v[154:157], v9 offset:64
    v_sub_f32 v233, v233, v254
    v_mfma_f32_16x16x32_bf16 v[126:129], a[252:255], v[202:205], v[126:129]
    ds_write_b64 v4, v[122:123] offset:4096
    v_mfma_f32_16x16x32_bf16 v[126:129], v[82:85], v[214:217], v[126:129]
    v_max3_f32 v255, v238, v182, v183
    v_max3_f32 v255, v255, v184, v185
    v_mfma_f32_16x16x32_bf16 v[126:129], v[86:89], v[222:225], v[126:129]
    v_exp_f32 v231, v231
    v_exp_f32 v232, v232
    v_cvt_pk_bf16_f32 v36, v230, v231
    v_mfma_f32_16x16x32_f16 v[186:189], v[138:141], v[158:161], v[74:77]
    s_waitcnt lgkmcnt(2)
    v_exp_f32 v233, v233
    v_mfma_f32_16x16x32_f16 v[138:141], v[114:117], v[158:161], v[78:81]
    v_cvt_pk_bf16_f32 v37, v232, v233
    v_sub_f32 v218, v218, v254
    v_mfma_f32_16x16x32_bf16 v[234:237], v[174:177], v[28:31], 0
    v_exp_f32 v218, v218
    v_fmac_f32 v118, v200, v200
    v_mfma_f32_16x16x16_f16 v[186:189], v[124:125], v[134:135], v[186:189]
    v_cvt_pk_bf16_f32 v39, v218, 0
    v_fmac_f32 v118, v201, v201
    v_fmac_f32 v118, v206, v206
    v_mfma_f32_16x16x16_f16 v[138:141], v[136:137], v[134:135], v[138:141]
    v_fmac_f32 v118, v207, v207
    v_fmac_f32 v118, v208, v208
    v_fmac_f32 v118, v209, v209
    v_fma_f32 v254, v130, v130, s33
    v_mfma_f32_16x16x32_bf16 v[122:125], v[28:31], v[36:39], 0
    s_waitcnt lgkmcnt(0)
    v_max3_f32 v255, v255, v186, v187
    v_max3_f32 v255, v255, v188, v189
    v_mfma_f32_16x16x32_bf16 v[122:125], v[28:31], v[226:229], v[122:125]
    v_max3_f32 v255, v255, v138, v139
    v_max3_f32 v255, v255, v140, v141
    v_mfma_f32_16x16x32_bf16 v[114:117], v[162:165], v[36:39], 0
    v_mov_b32 v119, v255
    v_fmac_f32 v254, v131, v131
    v_mfma_f32_16x16x32_bf16 v[114:117], v[142:145], v[226:229], v[114:117]
    v_permlane32_swap_b32 v255, v119
    v_mfma_f32_16x16x32_bf16 v[134:137], v[166:169], v[36:39], 0
    v_rcp_f32 v122, v122
    v_mfma_f32_16x16x32_bf16 v[134:137], v[146:149], v[226:229], v[134:137]
    v_max_f32 v255, v255, v119
    v_mov_b32 v119, v255
    v_mfma_f32_16x16x32_bf16 v[158:161], v[170:173], v[36:39], 0
    v_fmac_f32 v254, v132, v132
    v_mul_f32 v114, v122, v114
    v_mfma_f32_16x16x32_bf16 v[158:161], v[150:153], v[226:229], v[158:161]
    v_mul_f32 v115, v122, v115
    v_cvt_pk_bf16_f32 v114, v114, v115
    v_mfma_f32_16x16x32_bf16 v[234:237], v[154:157], v[28:31], v[234:237]
    v_mul_f32 v116, v122, v116
    v_mul_f32 v117, v122, v117
    v_mfma_f32_16x16x32_bf16 v[218:221], v[174:177], v[142:145], 0
    v_cvt_pk_bf16_f32 v115, v116, v117
    v_mul_f32 v134, v122, v134
    v_mfma_f32_16x16x32_bf16 v[218:221], v[154:157], v[162:165], v[218:221]
    v_mul_f32 v135, v122, v135
    v_cvt_pk_bf16_f32 v116, v134, v135
    v_mfma_f32_16x16x32_bf16 v[226:229], v[174:177], v[146:149], 0
    v_mul_f32 v136, v122, v136
    v_mul_f32 v137, v122, v137
    v_mfma_f32_16x16x32_bf16 v[226:229], v[154:157], v[166:169], v[226:229]
    v_cvt_pk_bf16_f32 v117, v136, v137
    v_mul_f32 v158, v122, v158
    v_mfma_f32_16x16x32_bf16 v[134:137], v[174:177], v[150:153], 0
    ds_write_b128 v3, v[114:117] offset:6144
    v_mfma_f32_16x16x32_bf16 v[134:137], v[154:157], v[170:173], v[134:137]
    v_mul_f32 v159, v122, v159
    v_cvt_pk_bf16_f32 v120, v158, v159
    v_mfma_f32_16x16x32_bf16 v[114:117], v[90:93], v[194:197], 0
    v_mul_f32 v160, v122, v160
    v_mul_f32 v161, v122, v161
    v_mfma_f32_16x16x32_bf16 v[114:117], v[94:97], v[190:193], v[114:117]
    ds_read_b128 v[122:125], v2 offset:12288
    ds_read_b128 v[174:177], v2 offset:13312
    v_mfma_f32_16x16x32_bf16 v[114:117], v[98:101], v[210:213], v[114:117]
    ds_read_b128 v[190:193], v2 offset:14336
    v_cvt_pk_bf16_f32 v121, v160, v161
    v_mfma_f32_16x16x32_bf16 v[114:117], v[102:105], v[202:205], v[114:117]
    ds_read_b128 v[194:197], v2 offset:15360
    v_fmac_f32 v254, v133, v133
    v_mfma_f32_16x16x32_bf16 v[114:117], v[106:109], v[214:217], v[114:117]
    ds_read_b128 v[202:205], v2 offset:16384
    v_fmac_f32 v254, v126, v126
    v_mfma_f32_16x16x32_bf16 v[114:117], v[110:113], v[222:225], v[114:117]
    ds_read_b128 v[210:213], v2 offset:17408
    ds_write_b64 v4, v[120:121] offset:10240
    v_permlane16_swap_b32 v255, v119
    v_max_f32 v255, v255, v119
    v_sub_f32 v182, v182, v255
    v_exp_f32 v182, v182
    v_sub_f32 v183, v183, v255
    v_exp_f32 v183, v183
    s_waitcnt lgkmcnt(5)
    v_mfma_f32_16x16x32_bf16 v[242:245], a[216:219], v[122:125], 0
    v_cvt_pk_bf16_f32 v182, v182, v183
    v_sub_f32 v184, v184, v255
    v_mfma_f32_16x16x32_bf16 v[242:245], a[220:223], v[174:177], v[242:245]
    s_waitcnt lgkmcnt(4)
    v_exp_f32 v184, v184
    v_mfma_f32_16x16x32_bf16 v[242:245], a[224:227], v[190:193], v[242:245]
    s_waitcnt lgkmcnt(3)
    v_sub_f32 v185, v185, v255
    v_sub_f32 v186, v186, v255
    v_mfma_f32_16x16x32_bf16 v[242:245], a[228:231], v[194:197], v[242:245]
    s_waitcnt lgkmcnt(2)
    v_exp_f32 v185, v185
    v_mfma_f32_16x16x32_bf16 v[242:245], a[232:235], v[202:205], v[242:245]
    s_waitcnt lgkmcnt(0)
    v_cvt_pk_bf16_f32 v183, v184, v185
    v_sub_f32 v187, v187, v255
    v_mfma_f32_16x16x32_bf16 v[242:245], a[236:239], v[210:213], v[242:245]
    v_exp_f32 v186, v186
    v_mfma_f32_16x16x32_bf16 v[158:161], a[240:243], v[122:125], 0
    v_exp_f32 v187, v187
    v_mfma_f32_16x16x32_bf16 v[158:161], a[244:247], v[174:177], v[158:161]
    v_cvt_pk_bf16_f32 v184, v186, v187
    v_sub_f32 v188, v188, v255
    v_mfma_f32_16x16x32_bf16 v[158:161], a[248:251], v[190:193], v[158:161]
    v_exp_f32 v188, v188
    v_mfma_f32_16x16x32_bf16 v[158:161], a[252:255], v[194:197], v[158:161]
    v_sub_f32 v189, v189, v255
    v_sub_f32 v138, v138, v255
    v_mfma_f32_16x16x32_bf16 v[158:161], v[82:85], v[202:205], v[158:161]
    v_exp_f32 v189, v189
    v_mfma_f32_16x16x32_bf16 v[158:161], v[86:89], v[210:213], v[158:161]
    v_cvt_pk_bf16_f32 v185, v188, v189
    v_sub_f32 v139, v139, v255
    v_mfma_f32_16x16x32_bf16 v[154:157], v[90:93], v[122:125], 0
    v_exp_f32 v138, v138
    v_mfma_f32_16x16x32_bf16 v[154:157], v[94:97], v[174:177], v[154:157]
    v_exp_f32 v139, v139
    v_mfma_f32_16x16x32_bf16 v[154:157], v[98:101], v[190:193], v[154:157]
    v_cvt_pk_bf16_f32 v36, v138, v139
    v_sub_f32 v140, v140, v255
    v_mfma_f32_16x16x32_bf16 v[154:157], v[102:105], v[194:197], v[154:157]
    v_exp_f32 v140, v140
    v_mfma_f32_16x16x32_bf16 v[154:157], v[106:109], v[202:205], v[154:157]
    v_sub_f32 v141, v141, v255
    v_sub_f32 v238, v238, v255
    v_mfma_f32_16x16x32_bf16 v[154:157], v[110:113], v[210:213], v[154:157]
    ds_read_b128 v[186:189], v0 offset:20480
    ds_read_b128 v[194:197], v1 offset:20480
    ds_read_b128 v[122:125], v0 offset:20608
    v_exp_f32 v141, v141
    v_exp_f32 v238, v238
    v_cvt_pk_bf16_f32 v37, v140, v141
    v_cvt_pk_bf16_f32 v39, v238, 0
    v_fma_f32 v255, v242, v242, s33
    v_fmac_f32 v255, v243, v243
    v_mfma_f32_16x16x32_bf16 v[138:141], v[28:31], v[36:39], 0
    ds_read_b128 v[202:205], v1 offset:20608
    ds_read_b128 v[230:233], v0 offset:20736
    v_mfma_f32_16x16x32_bf16 v[138:141], v[28:31], v[182:185], v[138:141]
    ds_read_b128 v[238:241], v1 offset:20736
    v_fmac_f32 v255, v244, v244
    v_mfma_f32_16x16x32_bf16 v[174:177], v[162:165], v[36:39], 0
    v_fmac_f32 v255, v245, v245
    v_fmac_f32 v255, v158, v158
    v_mfma_f32_16x16x32_bf16 v[174:177], v[142:145], v[182:185], v[174:177]
    v_fmac_f32 v255, v159, v159
    v_fmac_f32 v255, v160, v160
    v_mfma_f32_16x16x32_bf16 v[142:145], v[166:169], v[36:39], 0
    s_waitcnt lgkmcnt(5)
    v_rcp_f32 v138, v138
    v_mfma_f32_16x16x32_bf16 v[142:145], v[146:149], v[182:185], v[142:145]
    s_waitcnt lgkmcnt(3)
    v_fmac_f32 v255, v161, v161
    v_mul_f32 v174, v138, v174
    v_mfma_f32_16x16x32_bf16 v[146:149], v[170:173], v[36:39], 0
    v_mul_f32 v175, v138, v175
    v_cvt_pk_bf16_f32 v162, v174, v175
    v_mfma_f32_16x16x32_bf16 v[146:149], v[150:153], v[182:185], v[146:149]
    v_mul_f32 v176, v138, v176
    v_mul_f32 v177, v138, v177
    v_mfma_f32_16x16x32_bf16 v[150:153], a[72:75], v[186:189], 0
    s_waitcnt lgkmcnt(1)
    v_cvt_pk_bf16_f32 v163, v176, v177
    v_mul_f32 v142, v138, v142
    v_mfma_f32_16x16x32_bf16 v[150:153], a[76:79], v[194:197], v[150:153]
    s_waitcnt lgkmcnt(0)
    v_mul_f32 v143, v138, v143
    v_cvt_pk_bf16_f32 v164, v142, v143
    v_mfma_f32_16x16x32_bf16 v[150:153], a[80:83], v[122:125], v[150:153]
    v_mul_f32 v144, v138, v144
    v_mul_f32 v145, v138, v145
    v_mfma_f32_16x16x32_bf16 v[150:153], a[84:87], v[202:205], v[150:153]
    v_cvt_pk_bf16_f32 v165, v144, v145
    v_mul_f32 v146, v138, v146
    v_mfma_f32_16x16x32_bf16 v[150:153], a[88:91], v[230:233], v[150:153]
    ds_write_b128 v3, v[162:165] offset:12288
    v_mfma_f32_16x16x32_bf16 v[150:153], a[92:95], v[238:241], v[150:153]
    v_mul_f32 v147, v138, v147
    v_cvt_pk_bf16_f32 v146, v146, v147
    v_mfma_f32_16x16x32_bf16 v[162:165], a[96:99], v[186:189], 0
    v_mul_f32 v148, v138, v148
    v_mul_f32 v149, v138, v149
    v_mfma_f32_16x16x32_bf16 v[162:165], a[100:103], v[194:197], v[162:165]
    v_cvt_pk_bf16_f32 v147, v148, v149
    v_fmac_f32 v255, v154, v154
    v_mfma_f32_16x16x32_bf16 v[162:165], a[104:107], v[122:125], v[162:165]
    ds_write_b64 v4, v[146:147] offset:16384
    v_mfma_f32_16x16x32_bf16 v[162:165], a[108:111], v[202:205], v[162:165]
    v_fmac_f32 v255, v155, v155
    v_fmac_f32 v255, v156, v156
    v_mfma_f32_16x16x32_bf16 v[162:165], a[112:115], v[230:233], v[162:165]
    v_fmac_f32 v255, v157, v157
    v_cvt_pk_bf16_f32 v255, v255, v255
    v_mfma_f32_16x16x32_bf16 v[162:165], a[116:119], v[238:241], v[162:165]
    v_rcp_f32 v234, v234
    v_mfma_f32_16x16x32_bf16 v[170:173], a[120:123], v[186:189], 0
    v_mul_f32 v218, v218, v234
    v_fmac_f32 v254, v127, v127
    v_mfma_f32_16x16x32_bf16 v[170:173], a[124:127], v[194:197], v[170:173]
    v_mul_f32_dpp v218, v226, v234 quad_perm:[0,1,2,3] row_mask:0x2 bank_mask:0xf
    v_fmac_f32 v254, v128, v128
    v_mfma_f32_16x16x32_bf16 v[170:173], a[128:131], v[122:125], v[170:173]
    v_mul_f32_dpp v218, v134, v234 quad_perm:[0,1,2,3] row_mask:0x4 bank_mask:0xf
    v_cvt_pk_bf16_f32 v218, v218, v218
    v_mfma_f32_16x16x32_bf16 v[170:173], a[132:135], v[202:205], v[170:173]
    ds_write_b16 v7, v218
    v_mfma_f32_16x16x32_bf16 v[170:173], a[136:139], v[230:233], v[170:173]
    v_fmac_f32 v254, v129, v129
    v_fmac_f32 v254, v114, v114
    v_mfma_f32_16x16x32_bf16 v[170:173], a[140:143], v[238:241], v[170:173]
    v_fmac_f32 v254, v115, v115
    v_fmac_f32 v254, v116, v116
    v_mfma_f32_16x16x32_bf16 v[138:141], a[0:3], v[186:189], 0
    v_fmac_f32 v254, v117, v117
    v_cvt_pk_bf16_f32 v254, v118, v254
    v_mfma_f32_16x16x32_bf16 v[138:141], a[4:7], v[194:197], v[138:141]
    ds_write_b64 v4, v[254:255] offset:18432
    v_mfma_f32_16x16x32_bf16 v[138:141], a[8:11], v[122:125], v[138:141]
    v_fma_f32 v174, v150, v150, s32
    v_fmac_f32 v174, v151, v151
    v_mfma_f32_16x16x32_bf16 v[138:141], a[12:15], v[202:205], v[138:141]
    v_fmac_f32 v174, v152, v152
    v_fmac_f32 v174, v153, v153
    v_mfma_f32_16x16x32_bf16 v[138:141], a[16:19], v[230:233], v[138:141]
    v_xor_b32 v2, 65536, v2
    v_xor_b32 v3, 65536, v3
    v_mfma_f32_16x16x32_bf16 v[138:141], a[20:23], v[238:241], v[138:141]
    v_xor_b32 v4, 65536, v4
    v_add_u32 v7, s76, v7
    v_mfma_f32_16x16x32_bf16 v[166:169], a[24:27], v[186:189], 0
    v_mfma_f32_16x16x32_bf16 v[166:169], a[28:31], v[194:197], v[166:169]
    v_mfma_f32_16x16x32_bf16 v[166:169], a[32:35], v[122:125], v[166:169]
    s_waitcnt lgkmcnt(0)
    v_mfma_f32_16x16x32_bf16 v[166:169], a[36:39], v[202:205], v[166:169]
    s_barrier
    v_mfma_f32_16x16x32_bf16 v[166:169], a[40:43], v[230:233], v[166:169]
    v_mfma_f32_16x16x32_bf16 v[166:169], a[44:47], v[238:241], v[166:169]
    v_mfma_f32_16x16x32_bf16 v[134:137], a[48:51], v[186:189], 0
    v_mfma_f32_16x16x32_bf16 v[134:137], a[52:55], v[194:197], v[134:137]
    s_cbranch_scc1 L_LOOP
    v_mfma_f32_16x16x32_bf16 v[134:137], a[56:59], v[122:125], v[134:137]
    s_mov_b32 s12, s40
    ds_read_b128 v[118:121], v2 offset:18432
    ds_read_b128 v[142:145], v2 offset:19456
    v_mfma_f32_16x16x32_bf16 v[134:137], a[60:63], v[202:205], v[134:137]
    s_mov_b32 s13, s41
    v_fmac_f32 v174, v162, v162
    v_fmac_f32 v174, v163, v163
    v_mfma_f32_16x16x32_bf16 v[134:137], a[64:67], v[230:233], v[134:137]
    s_mov_b32 s14, s36
    v_fmac_f32 v174, v164, v164
    v_fmac_f32 v174, v165, v165
    v_mfma_f32_16x16x32_bf16 v[134:137], a[68:71], v[238:241], v[134:137]
    s_add_u32 s48, s40, s27
    v_fmac_f32 v174, v170, v170
    v_fmac_f32 v174, v171, v171
    v_mfma_f32_16x16x32_bf16 v[146:149], v[186:189], a[144:147], 0
    s_addc_u32 s49, s41, 0
    v_fmac_f32 v174, v172, v172
    v_fmac_f32 v174, v173, v173
    v_mfma_f32_16x16x32_bf16 v[146:149], v[194:197], a[148:151], v[146:149]
    s_sub_u32 s50, s36, s27
    v_fma_f32 v254, v138, v138, s32
    v_fmac_f32 v254, v139, v139
    v_mfma_f32_16x16x32_bf16 v[146:149], v[122:125], a[152:155], v[146:149]
    s_mov_b32 s51, 0x00020000
    v_fmac_f32 v254, v140, v140
    v_fmac_f32 v254, v141, v141
    v_mfma_f32_16x16x32_bf16 v[146:149], v[202:205], a[156:159], v[146:149]
    s_add_u32 s52, s40, s26
    v_fmac_f32 v254, v166, v166
    v_fmac_f32 v254, v167, v167
    v_mfma_f32_16x16x32_bf16 v[146:149], v[230:233], a[160:163], v[146:149]
    s_waitcnt lgkmcnt(0)
    v_fmac_f32 v254, v168, v168
    v_fmac_f32 v254, v169, v169
    v_mfma_f32_16x16x32_bf16 v[182:185], v[32:35], v[118:121], 0
    s_addc_u32 s53, s41, 0
    v_fmac_f32 v254, v134, v134
    v_fmac_f32 v254, v135, v135
    v_mfma_f32_16x16x32_bf16 v[182:185], v[32:35], v[142:145], v[182:185]
    s_sub_u32 s54, s36, s26
    v_fmac_f32 v254, v136, v136
    v_fmac_f32 v254, v137, v137
    v_mfma_f32_16x16x32_bf16 v[146:149], v[238:241], a[164:167], v[146:149]
    s_mov_b32 s55, 0x00020000
    v_cvt_pk_bf16_f32 v36, v254, v174
    v_bfe_u32 v254, v2, 4, 6
    v_mfma_f32_16x16x32_bf16 v[118:121], v[186:189], a[168:171], 0
    s_add_u32 s56, s40, s25
    v_mul_f32 v255, 0x3baaaaab, v183
    v_mul_f32 v182, 0x3baaaaab, v182
    v_mfma_f32_16x16x32_bf16 v[142:145], v[32:35], v[36:39], 0
    s_addc_u32 s57, s41, 0
    v_rsq_f32 v255, v255
    v_mfma_f32_16x16x32_bf16 v[118:121], v[194:197], a[172:175], v[118:121]
    s_sub_u32 s58, s36, s25
    v_mul_f32 v130, v255, v130
    v_mul_f32 v131, v255, v131
    v_mfma_f32_16x16x32_bf16 v[118:121], v[122:125], a[176:179], v[118:121]
    s_mov_b32 s59, 0x00020000
    v_cvt_pk_bf16_f32 v130, v130, v131
    v_mul_f32 v132, v255, v132
    v_mfma_f32_16x16x32_bf16 v[118:121], v[202:205], a[180:183], v[118:121]
    s_and_b32 s6, s2, 7
    v_mul_f32 v133, v255, v133
    v_cvt_pk_bf16_f32 v131, v132, v133
    v_mfma_f32_16x16x32_bf16 v[118:121], v[230:233], a[184:187], v[118:121]
    s_sub_u32 s6, 0, s6
    ds_read_b128 v[174:177], v0 offset:26624
    v_mul_f32 v126, v255, v126
    v_mfma_f32_16x16x32_bf16 v[118:121], v[238:241], a[188:191], v[118:121]
    s_lshl_b32 s3, s16, 6
    ds_read_b128 v[190:193], v1 offset:26624
    v_mul_f32 v127, v255, v127
    v_mfma_f32_16x16x32_bf16 v[210:213], v[186:189], a[192:195], 0
    s_lshl_b32 s4, s16, 5
    ds_read_b128 v[186:189], v0 offset:26752
    v_cvt_pk_bf16_f32 v132, v126, v127
    v_mfma_f32_16x16x32_bf16 v[210:213], v[194:197], a[196:199], v[210:213]
    s_add_u32 s4, s4, 256
    ds_read_b128 v[194:197], v1 offset:26752
    v_mul_f32 v128, v255, v128
    v_mfma_f32_16x16x32_bf16 v[210:213], v[122:125], a[200:203], v[210:213]
    s_mul_i32 s5, s16, 9408
    ds_read_b128 v[122:125], v0 offset:26880
    v_mul_f32 v129, v255, v129
    v_mfma_f32_16x16x32_bf16 v[210:213], v[202:205], a[204:207], v[210:213]
    s_add_u32 s5, s5, 104448
    ds_read_b128 v[202:205], v1 offset:26880
    v_cvt_pk_bf16_f32 v133, v128, v129
    v_mfma_f32_16x16x32_bf16 v[210:213], v[230:233], a[208:211], v[210:213]
    buffer_store_dwordx4 v[130:133], v16, s[48:51], 0 offen nt
    v_mul_f32 v114, v255, v114
    v_mul_f32 v115, v255, v115
    v_cvt_pk_bf16_f32 v144, v114, v115
    v_mul_f32 v116, v255, v116
    v_mfma_f32_16x16x32_bf16 v[210:213], v[238:241], a[212:215], v[210:213]
    s_waitcnt lgkmcnt(5)
    ds_read_b128 v[126:129], v2 offset:0
    ds_read_b128 v[130:133], v2 offset:1024
    v_mfma_f32_16x16x32_bf16 v[214:217], a[72:75], v[174:177], 0
    s_waitcnt lgkmcnt(6)
    ds_read_b128 v[218:221], v2 offset:2048
    ds_read_b128 v[222:225], v2 offset:3072
    v_mfma_f32_16x16x32_bf16 v[214:217], a[76:79], v[190:193], v[214:217]
    s_waitcnt lgkmcnt(7)
    v_mul_f32 v117, v255, v117
    v_cvt_pk_bf16_f32 v145, v116, v117
    v_mfma_f32_16x16x32_bf16 v[214:217], a[80:83], v[186:189], v[214:217]
    s_waitcnt lgkmcnt(6)
    ds_read_b128 v[114:117], v2 offset:4096
    ds_read_b128 v[226:229], v2 offset:5120
    v_mfma_f32_16x16x32_bf16 v[214:217], a[84:87], v[194:197], v[214:217]
    s_waitcnt lgkmcnt(7)
    v_rsq_f32 v182, v182
    v_mfma_f32_16x16x32_bf16 v[214:217], a[88:91], v[122:125], v[214:217]
    s_waitcnt lgkmcnt(6)
    v_mul_f32 v178, v182, v178
    v_mul_f32 v179, v182, v179
    v_mfma_f32_16x16x32_bf16 v[214:217], a[92:95], v[202:205], v[214:217]
    v_cvt_pk_bf16_f32 v178, v178, v179
    v_mul_f32 v180, v182, v180
    v_mfma_f32_16x16x32_bf16 v[230:233], a[96:99], v[174:177], 0
    v_mul_f32 v181, v182, v181
    v_cvt_pk_bf16_f32 v179, v180, v181
    v_mfma_f32_16x16x32_bf16 v[230:233], a[100:103], v[190:193], v[230:233]
    s_waitcnt lgkmcnt(4)
    v_mul_f32 v198, v182, v198
    v_mul_f32 v199, v182, v199
    v_mfma_f32_16x16x32_bf16 v[230:233], a[104:107], v[186:189], v[230:233]
    s_waitcnt lgkmcnt(2)
    v_cvt_pk_bf16_f32 v180, v198, v199
    v_mul_f32 v200, v182, v200
    v_mfma_f32_16x16x32_bf16 v[230:233], a[108:111], v[194:197], v[230:233]
    v_mul_f32 v201, v182, v201
    v_cvt_pk_bf16_f32 v181, v200, v201
    v_mfma_f32_16x16x32_bf16 v[198:201], a[216:219], v[126:129], 0
    s_waitcnt lgkmcnt(0)
    v_mul_f32 v206, v182, v206
    v_mul_f32 v207, v182, v207
    v_mfma_f32_16x16x32_bf16 v[198:201], a[220:223], v[130:133], v[198:201]
    v_cvt_pk_bf16_f32 v206, v206, v207
    v_mul_f32 v208, v182, v208
    v_mfma_f32_16x16x32_bf16 v[198:201], a[224:227], v[218:221], v[198:201]
    v_mul_f32 v209, v182, v209
    v_cvt_pk_bf16_f32 v207, v208, v209
    v_mfma_f32_16x16x32_bf16 v[198:201], a[228:231], v[222:225], v[198:201]
    v_rsq_f32 v143, v143
    v_mfma_f32_16x16x32_bf16 v[198:201], a[232:235], v[114:117], v[198:201]
    buffer_store_dwordx2 v[144:145], v19, s[48:51], 0 offen nt
    v_rsq_f32 v142, v142
    v_mfma_f32_16x16x32_bf16 v[198:201], a[236:239], v[226:229], v[198:201]
    v_mul_f32 v142, s31, v142
    v_cvt_pk_bf16_f32 v146, v146, v147
    v_mfma_f32_16x16x32_bf16 v[234:237], a[240:243], v[126:129], 0
    v_cvt_pk_bf16_f32 v147, v148, v149
    v_cvt_pk_bf16_f32 v118, v118, v119
    v_mfma_f32_16x16x32_bf16 v[234:237], a[244:247], v[130:133], v[234:237]
    v_cvt_pk_bf16_f32 v119, v120, v121
    v_cvt_pk_bf16_f32 v182, v210, v211
    v_mfma_f32_16x16x32_bf16 v[234:237], a[248:251], v[218:221], v[234:237]
    v_fma_f32 v255, v198, v198, s33
    v_fmac_f32 v255, v199, v199
    v_mfma_f32_16x16x32_bf16 v[234:237], a[252:255], v[222:225], v[234:237]
    v_fmac_f32 v255, v200, v200
    v_fmac_f32 v255, v201, v201
    v_mfma_f32_16x16x32_bf16 v[234:237], v[82:85], v[114:117], v[234:237]
    v_cvt_pk_bf16_f32 v183, v212, v213
    v_mul_f32 v150, v143, v150
    v_mfma_f32_16x16x32_bf16 v[234:237], v[86:89], v[226:229], v[234:237]
    v_mul_f32 v151, v143, v151
    v_cvt_pk_f16_f32 v150, v150, v151
    v_mfma_f32_16x16x32_bf16 v[210:213], v[90:93], v[126:129], 0
    v_mul_f32 v152, v143, v152
    v_mul_f32 v153, v143, v153
    v_mfma_f32_16x16x32_bf16 v[210:213], v[94:97], v[130:133], v[210:213]
    v_cvt_pk_f16_f32 v151, v152, v153
    v_mul_f32 v162, v143, v162
    v_mfma_f32_16x16x32_bf16 v[210:213], v[98:101], v[218:221], v[210:213]
    v_fmac_f32 v255, v234, v234
    v_fmac_f32 v255, v235, v235
    v_mfma_f32_16x16x32_bf16 v[210:213], v[102:105], v[222:225], v[210:213]
    v_fmac_f32 v255, v236, v236
    v_fmac_f32 v255, v237, v237
    v_mfma_f32_16x16x32_bf16 v[210:213], v[106:109], v[114:117], v[210:213]
    v_mul_f32 v163, v143, v163
    v_cvt_pk_f16_f32 v152, v162, v163
    v_mfma_f32_16x16x32_bf16 v[210:213], v[110:113], v[226:229], v[210:213]
    v_mul_f32 v164, v143, v164
    v_mul_f32 v165, v143, v165
    v_mfma_f32_16x16x32_bf16 v[230:233], a[112:115], v[122:125], v[230:233]
    v_cvt_pk_f16_f32 v153, v164, v165
    v_mul_f32 v170, v143, v170
    v_mfma_f32_16x16x32_bf16 v[230:233], a[116:119], v[202:205], v[230:233]
    ds_read_b128 v[114:117], v2 offset:6144
    ds_read_b128 v[126:129], v2 offset:7168
    v_mfma_f32_16x16x32_bf16 v[130:133], a[120:123], v[174:177], 0
    ds_read_b128 v[162:165], v2 offset:8192
    ds_read_b128 v[218:221], v2 offset:9216
    v_mfma_f32_16x16x32_bf16 v[130:133], a[124:127], v[190:193], v[130:133]
    buffer_store_dwordx4 v[178:181], v15, s[48:51], 0 offen nt
    ds_read_b128 v[222:225], v2 offset:10240
    v_fmac_f32 v255, v210, v210
    v_fmac_f32 v255, v211, v211
    v_fmac_f32 v255, v212, v212
    v_mfma_f32_16x16x32_bf16 v[130:133], a[128:131], v[186:189], v[130:133]
    ds_read_b128 v[178:181], v2 offset:11264
    v_fmac_f32 v255, v213, v213
    v_mfma_f32_16x16x32_bf16 v[130:133], a[132:135], v[194:197], v[130:133]
    v_mul_f32 v171, v143, v171
    v_cvt_pk_f16_f32 v228, v170, v171
    v_mfma_f32_16x16x32_bf16 v[130:133], a[136:139], v[122:125], v[130:133]
    v_mul_f32 v172, v143, v172
    v_mul_f32 v173, v143, v173
    v_mfma_f32_16x16x32_bf16 v[130:133], a[140:143], v[202:205], v[130:133]
    v_cvt_pk_f16_f32 v229, v172, v173
    v_mul_f32 v138, v142, v138
    v_mfma_f32_16x16x32_bf16 v[170:173], a[0:3], v[174:177], 0
    s_waitcnt lgkmcnt(4)
    v_mul_f32 v139, v142, v139
    v_cvt_pk_f16_f32 v138, v138, v139
    v_mfma_f32_16x16x32_bf16 v[238:241], a[216:219], v[114:117], 0
    s_waitcnt lgkmcnt(2)
    v_mul_f32 v140, v142, v140
    v_mul_f32 v141, v142, v141
    v_mfma_f32_16x16x32_bf16 v[238:241], a[220:223], v[126:129], v[238:241]
    s_waitcnt lgkmcnt(1)
    v_cvt_pk_f16_f32 v139, v140, v141
    v_mul_f32 v166, v142, v166
    v_mfma_f32_16x16x32_bf16 v[238:241], a[224:227], v[162:165], v[238:241]
    v_mul_f32 v167, v142, v167
    v_cvt_pk_f16_f32 v140, v166, v167
    v_mfma_f32_16x16x32_bf16 v[238:241], a[228:231], v[218:221], v[238:241]
    s_waitcnt lgkmcnt(0)
    v_mul_f32 v168, v142, v168
    v_mul_f32 v169, v142, v169
    v_mfma_f32_16x16x32_bf16 v[238:241], a[232:235], v[222:225], v[238:241]
    v_cvt_pk_f16_f32 v141, v168, v169
    v_mul_f32 v134, v142, v134
    v_mfma_f32_16x16x32_bf16 v[238:241], a[236:239], v[178:181], v[238:241]
    v_mul_f32 v135, v142, v135
    v_cvt_pk_f16_f32 v226, v134, v135
    v_mfma_f32_16x16x32_bf16 v[166:169], a[240:243], v[114:117], 0
    v_mul_f32 v136, v142, v136
    v_mul_f32 v137, v142, v137
    v_mfma_f32_16x16x32_bf16 v[166:169], a[244:247], v[126:129], v[166:169]
    v_cvt_pk_f16_f32 v227, v136, v137
    v_fma_f32 v185, v214, v214, s32
    v_mfma_f32_16x16x32_bf16 v[166:169], a[248:251], v[162:165], v[166:169]
    v_fma_f32 v120, v238, v238, s33
    v_fmac_f32 v120, v239, v239
    v_mfma_f32_16x16x32_bf16 v[166:169], a[252:255], v[218:221], v[166:169]
    v_fmac_f32 v120, v240, v240
    v_fmac_f32 v120, v241, v241
    v_mfma_f32_16x16x32_bf16 v[166:169], v[82:85], v[222:225], v[166:169]
    buffer_store_dwordx2 v[206:207], v18, s[48:51], 0 offen nt
    v_fmac_f32 v185, v215, v215
    v_fmac_f32 v185, v216, v216
    v_mfma_f32_16x16x32_bf16 v[166:169], v[86:89], v[178:181], v[166:169]
    v_fmac_f32 v185, v217, v217
    v_fmac_f32 v185, v230, v230
    v_mfma_f32_16x16x32_bf16 v[134:137], v[90:93], v[114:117], 0
    v_fmac_f32 v185, v231, v231
    v_fmac_f32 v185, v232, v232
    v_mfma_f32_16x16x32_bf16 v[134:137], v[94:97], v[126:129], v[134:137]
    v_fmac_f32 v185, v233, v233
    v_fmac_f32 v185, v130, v130
    v_mfma_f32_16x16x32_bf16 v[134:137], v[98:101], v[162:165], v[134:137]
    v_fmac_f32 v120, v166, v166
    v_fmac_f32 v120, v167, v167
    v_mfma_f32_16x16x32_bf16 v[134:137], v[102:105], v[218:221], v[134:137]
    v_fmac_f32 v120, v168, v168
    v_fmac_f32 v120, v169, v169
    v_mfma_f32_16x16x32_bf16 v[134:137], v[106:109], v[222:225], v[134:137]
    v_fmac_f32 v185, v131, v131
    v_fmac_f32 v185, v132, v132
    v_mfma_f32_16x16x32_bf16 v[134:137], v[110:113], v[178:181], v[134:137]
    v_fmac_f32 v185, v133, v133
    v_mul_f32 v184, 0x3baaaaab, v184
    v_mfma_f32_16x16x32_bf16 v[170:173], a[4:7], v[190:193], v[170:173]
    v_rsq_f32 v184, v184
    v_mfma_f32_16x16x32_bf16 v[170:173], a[8:11], v[186:189], v[170:173]
    v_mul_f32 v242, v184, v242
    v_mul_f32 v243, v184, v243
    v_mfma_f32_16x16x32_bf16 v[170:173], a[12:15], v[194:197], v[170:173]
    v_fmac_f32 v120, v134, v134
    v_fmac_f32 v120, v135, v135
    v_mfma_f32_16x16x32_bf16 v[170:173], a[16:19], v[122:125], v[170:173]
    v_fmac_f32 v120, v136, v136
    v_fmac_f32 v120, v137, v137
    v_mfma_f32_16x16x32_bf16 v[170:173], a[20:23], v[202:205], v[170:173]
    v_cvt_pk_bf16_f32 v148, v255, v120
    v_cvt_pk_bf16_f32 v149, v120, v120
    v_mfma_f32_16x16x32_bf16 v[114:117], a[24:27], v[174:177], 0
    v_cvt_pk_bf16_f32 v126, v242, v243
    v_mul_f32 v244, v184, v244
    v_mfma_f32_16x16x32_bf16 v[114:117], a[28:31], v[190:193], v[114:117]
    v_mul_f32 v245, v184, v245
    v_cvt_pk_bf16_f32 v127, v244, v245
    v_mfma_f32_16x16x32_bf16 v[114:117], a[32:35], v[186:189], v[114:117]
    v_fma_f32 v255, v170, v170, s32
    v_fmac_f32 v255, v171, v171
    v_mfma_f32_16x16x32_bf16 v[114:117], a[36:39], v[194:197], v[114:117]
    v_fmac_f32 v255, v172, v172
    v_fmac_f32 v255, v173, v173
    v_mfma_f32_16x16x32_bf16 v[114:117], a[40:43], v[122:125], v[114:117]
    v_mul_f32 v158, v184, v158
    v_mul_f32 v159, v184, v159
    v_mfma_f32_16x16x32_bf16 v[114:117], a[44:47], v[202:205], v[114:117]
    v_cvt_pk_bf16_f32 v128, v158, v159
    v_mul_f32 v160, v184, v160
    v_mfma_f32_16x16x32_bf16 v[142:145], a[48:51], v[174:177], 0
    v_mul_f32 v161, v184, v161
    v_cvt_pk_bf16_f32 v129, v160, v161
    v_mfma_f32_16x16x32_bf16 v[142:145], a[52:55], v[190:193], v[142:145]
    buffer_store_dwordx4 v[126:129], v17, s[48:51], 0 offen nt
    v_mul_f32 v154, v184, v154
    v_fmac_f32 v255, v114, v114
    v_fmac_f32 v255, v115, v115
    v_fmac_f32 v255, v116, v116
    v_mfma_f32_16x16x32_bf16 v[142:145], a[56:59], v[186:189], v[142:145]
    v_fmac_f32 v255, v117, v117
    v_mul_f32 v155, v184, v155
    v_mfma_f32_16x16x32_bf16 v[142:145], a[60:63], v[194:197], v[142:145]
    v_cvt_pk_bf16_f32 v120, v154, v155
    v_mul_f32 v156, v184, v156
    v_mfma_f32_16x16x32_bf16 v[142:145], a[64:67], v[122:125], v[142:145]
    v_mul_f32 v157, v184, v157
    v_cvt_pk_bf16_f32 v121, v156, v157
    v_mfma_f32_16x16x32_bf16 v[142:145], a[68:71], v[202:205], v[142:145]
    v_lshrrev_b32 v126, 4, v254
    v_and_b32 v127, 15, v254
    v_mfma_f32_16x16x32_bf16 v[154:157], v[174:177], a[144:147], 0
    v_lshlrev_b32 v128, 9, v126
    v_lshl_add_u32 v128, v127, 4, v128
    v_mfma_f32_16x16x32_bf16 v[154:157], v[190:193], a[148:151], v[154:157]
    v_add_u32 v128, 149696, v128
    v_and_b32 v129, 0xffff, v2
    v_mfma_f32_16x16x32_bf16 v[154:157], v[186:189], a[152:155], v[154:157]
    v_fmac_f32 v255, v142, v142
    v_fmac_f32 v255, v143, v143
    v_mfma_f32_16x16x32_bf16 v[154:157], v[194:197], a[156:159], v[154:157]
    v_fmac_f32 v255, v144, v144
    v_fmac_f32 v255, v145, v145
    v_mfma_f32_16x16x32_bf16 v[154:157], v[122:125], a[160:163], v[154:157]
    v_cvt_pk_bf16_f32 v36, v255, v185
    v_add_u32 v129, 38912, v129
    v_mfma_f32_16x16x32_bf16 v[154:157], v[202:205], a[164:167], v[154:157]
    v_and_b32 v255, 0xffff, v4
    v_add_u32 v255, 38912, v255
    v_mfma_f32_16x16x32_bf16 v[158:161], v[32:35], v[36:39], 0
    ds_write_b64 v255, v[148:149] offset:0
    v_mfma_f32_16x16x32_bf16 v[162:165], v[174:177], a[168:171], 0
    v_mov_b32 v178, 0x40000000
    v_add_u32 v179, 0, v127
    v_mfma_f32_16x16x32_bf16 v[162:165], v[190:193], a[172:175], v[162:165]
    v_cvt_pk_bf16_f32 v148, v154, v155
    v_cvt_pk_bf16_f32 v149, v156, v157
    v_mfma_f32_16x16x32_bf16 v[162:165], v[186:189], a[176:179], v[162:165]
    v_rsq_f32 v159, v159
    v_mfma_f32_16x16x32_bf16 v[162:165], v[194:197], a[180:183], v[162:165]
    buffer_store_dwordx2 v[120:121], v20, s[48:51], 0 offen nt
    v_rsq_f32 v158, v158
    v_mfma_f32_16x16x32_bf16 v[162:165], v[122:125], a[184:187], v[162:165]
    ds_read_b128 v[154:157], v0 offset:32768
    v_mul_f32 v158, s31, v158
    v_mfma_f32_16x16x32_bf16 v[162:165], v[202:205], a[188:191], v[162:165]
    ds_read_b128 v[206:209], v1 offset:32768
    v_mul_f32 v214, v159, v214
    v_mfma_f32_16x16x32_bf16 v[218:221], v[174:177], a[192:195], 0
    s_waitcnt lgkmcnt(2)
    ds_read_b128 v[174:177], v0 offset:32896
    v_mul_f32 v215, v159, v215
    v_mfma_f32_16x16x32_bf16 v[218:221], v[190:193], a[196:199], v[218:221]
    s_barrier
    ds_read_b128 v[190:193], v129 offset:0
    ds_read_b128 v[222:225], v129 offset:1024
    v_mfma_f32_16x16x32_bf16 v[218:221], v[186:189], a[200:203], v[218:221]
    ds_read_b128 v[186:189], v1 offset:32896
    v_cvt_pk_bf16_f32 v120, v162, v163
    v_mfma_f32_16x16x32_bf16 v[218:221], v[194:197], a[204:207], v[218:221]
    ds_read_b128 v[194:197], v0 offset:33024
    v_cvt_pk_bf16_f32 v121, v164, v165
    v_mfma_f32_16x16x32_bf16 v[218:221], v[122:125], a[208:211], v[218:221]
    ds_read_b128 v[122:125], v1 offset:33024
    v_cvt_pk_f16_f32 v162, v214, v215
    v_mfma_f32_16x16x32_bf16 v[218:221], v[202:205], a[212:215], v[218:221]
    v_mul_f32 v216, v159, v216
    v_mul_f32 v217, v159, v217
    v_mfma_f32_16x16x32_f16 v[202:205], v[150:153], v[138:141], v[46:49]
    s_waitcnt lgkmcnt(7)
    v_cvt_pk_f16_f32 v163, v216, v217
    v_mul_f32 v230, v159, v230
    v_mfma_f32_16x16x32_bf16 v[214:217], a[72:75], v[154:157], 0
    s_waitcnt lgkmcnt(6)
    v_cvt_pk_bf16_f32 v184, v218, v219
    v_cvt_pk_bf16_f32 v185, v220, v221
    v_mfma_f32_16x16x32_bf16 v[214:217], a[76:79], v[206:209], v[214:217]
    s_waitcnt lgkmcnt(5)
    v_mul_f32 v231, v159, v231
    v_cvt_pk_f16_f32 v164, v230, v231
    v_mfma_f32_16x16x32_bf16 v[214:217], a[80:83], v[174:177], v[214:217]
    s_waitcnt lgkmcnt(3)
    v_mul_f32 v232, v159, v232
    v_mul_f32 v233, v159, v233
    v_mfma_f32_16x16x32_bf16 v[218:221], v[32:35], v[190:193], 0
    s_waitcnt lgkmcnt(2)
    v_cvt_pk_f16_f32 v165, v232, v233
    v_mul_f32 v130, v159, v130
    v_mfma_f32_16x16x32_bf16 v[218:221], v[32:35], v[222:225], v[218:221]
    s_waitcnt lgkmcnt(1)
    v_mul_f32 v131, v159, v131
    v_cvt_pk_f16_f32 v192, v130, v131
    v_mfma_f32_16x16x32_bf16 v[214:217], a[84:87], v[186:189], v[214:217]
    s_waitcnt lgkmcnt(0)
    v_mul_f32 v132, v159, v132
    v_mul_f32 v133, v159, v133
    v_mfma_f32_16x16x32_bf16 v[214:217], a[88:91], v[194:197], v[214:217]
    v_mul_f32 v180, 0x3baaaaab, v219
    v_cvt_pk_f16_f32 v193, v132, v133
    v_mfma_f32_16x16x32_bf16 v[214:217], a[92:95], v[122:125], v[214:217]
    v_rsq_f32 v180, v180
    v_mfma_f32_16x16x32_bf16 v[130:133], a[96:99], v[154:157], 0
    v_mul_f32 v238, v180, v238
    v_mul_f32 v239, v180, v239
    v_mfma_f32_16x16x32_bf16 v[130:133], a[100:103], v[206:209], v[130:133]
    v_cvt_pk_bf16_f32 v222, v238, v239
    v_mul_f32 v240, v180, v240
    v_mfma_f32_16x16x32_bf16 v[130:133], a[104:107], v[174:177], v[130:133]
    v_mul_f32 v241, v180, v241
    v_cvt_pk_bf16_f32 v223, v240, v241
    v_mfma_f32_16x16x32_bf16 v[130:133], a[108:111], v[186:189], v[130:133]
    v_mul_f32 v166, v180, v166
    v_mul_f32 v167, v180, v167
    v_mfma_f32_16x16x32_bf16 v[130:133], a[112:115], v[194:197], v[130:133]
    v_cvt_pk_bf16_f32 v224, v166, v167
    v_mul_f32 v168, v180, v168
    v_mfma_f32_16x16x32_bf16 v[130:133], a[116:119], v[122:125], v[130:133]
    v_mul_f32 v169, v180, v169
    v_cvt_pk_bf16_f32 v225, v168, v169
    v_mfma_f32_16x16x32_bf16 v[166:169], a[120:123], v[154:157], 0
    buffer_store_dwordx4 v[222:225], v16, s[52:55], 0 offen nt
    v_mul_f32 v134, v180, v134
    v_mul_f32 v135, v180, v135
    v_cvt_pk_bf16_f32 v220, v134, v135
    v_mul_f32 v136, v180, v136
    v_mfma_f32_16x16x32_bf16 v[166:169], a[124:127], v[206:209], v[166:169]
    v_mul_f32 v137, v180, v137
    v_cvt_pk_bf16_f32 v221, v136, v137
    v_mfma_f32_16x16x32_bf16 v[166:169], a[128:131], v[174:177], v[166:169]
    v_mul_f32 v170, v158, v170
    v_mul_f32 v171, v158, v171
    v_mfma_f32_16x16x32_bf16 v[166:169], a[132:135], v[186:189], v[166:169]
    v_cvt_pk_f16_f32 v134, v170, v171
    v_mul_f32 v172, v158, v172
    v_mfma_f32_16x16x32_bf16 v[166:169], a[136:139], v[194:197], v[166:169]
    v_mul_f32 v173, v158, v173
    v_cvt_pk_f16_f32 v135, v172, v173
    v_mfma_f32_16x16x32_bf16 v[166:169], a[140:143], v[122:125], v[166:169]
    v_mul_f32 v114, v158, v114
    v_mul_f32 v115, v158, v115
    v_mfma_f32_16x16x32_bf16 v[170:173], a[0:3], v[154:157], 0
    v_cvt_pk_f16_f32 v136, v114, v115
    v_mul_f32 v116, v158, v116
    v_mfma_f32_16x16x32_bf16 v[170:173], a[4:7], v[206:209], v[170:173]
    v_mul_f32 v117, v158, v117
    v_cvt_pk_f16_f32 v137, v116, v117
    v_mfma_f32_16x16x32_bf16 v[170:173], a[8:11], v[174:177], v[170:173]
    v_mul_f32 v142, v158, v142
    v_mul_f32 v143, v158, v143
    v_mfma_f32_16x16x32_bf16 v[170:173], a[12:15], v[186:189], v[170:173]
    v_cvt_pk_f16_f32 v190, v142, v143
    v_mul_f32 v144, v158, v144
    v_mfma_f32_16x16x32_bf16 v[170:173], a[16:19], v[194:197], v[170:173]
    v_mul_f32 v145, v158, v145
    v_cvt_pk_f16_f32 v191, v144, v145
    v_mfma_f32_16x16x32_bf16 v[170:173], a[20:23], v[122:125], v[170:173]
    v_mul_f32 v180, 0x3baaaaab, v218
    v_fma_f32 v181, v214, v214, s32
    v_mfma_f32_16x16x32_bf16 v[114:117], a[24:27], v[154:157], 0
    v_rsq_f32 v180, v180
    v_mfma_f32_16x16x32_f16 v[142:145], v[162:165], v[138:141], v[50:53]
    v_mul_f32 v198, v180, v198
    v_mul_f32 v199, v180, v199
    v_cvt_pk_bf16_f32 v158, v198, v199
    v_mfma_f32_16x16x16_f16 v[202:205], v[228:229], v[226:227], v[202:205]
    v_mul_f32 v200, v180, v200
    v_mul_f32 v201, v180, v201
    v_cvt_pk_bf16_f32 v159, v200, v201
    v_mfma_f32_16x16x16_f16 v[142:145], v[192:193], v[226:227], v[142:145]
    v_mul_f32 v234, v180, v234
    v_mul_f32 v235, v180, v235
    v_cvt_pk_bf16_f32 v160, v234, v235
    v_mul_f32 v236, v180, v236
    v_mfma_f32_16x16x32_bf16 v[114:117], a[28:31], v[206:209], v[114:117]
    buffer_store_dwordx2 v[220:221], v19, s[52:55], 0 offen nt
    v_mul_f32 v237, v180, v237
    v_cvt_pk_bf16_f32 v161, v236, v237
    v_mfma_f32_16x16x32_bf16 v[114:117], a[32:35], v[174:177], v[114:117]
    v_mul_f32 v210, v180, v210
    v_mul_f32 v211, v180, v211
    v_mfma_f32_16x16x32_bf16 v[114:117], a[36:39], v[186:189], v[114:117]
    v_cvt_pk_bf16_f32 v210, v210, v211
    v_mul_f32 v212, v180, v212
    v_mfma_f32_16x16x32_bf16 v[114:117], a[40:43], v[194:197], v[114:117]
    v_mul_f32 v213, v180, v213
    v_cvt_pk_bf16_f32 v211, v212, v213
    v_mfma_f32_16x16x32_bf16 v[114:117], a[44:47], v[122:125], v[114:117]
    v_fma_f32 v180, v170, v170, s32
    v_fmac_f32 v180, v171, v171
    v_mfma_f32_16x16x32_bf16 v[198:201], a[48:51], v[154:157], 0
    v_fmac_f32 v180, v172, v172
    v_fmac_f32 v180, v173, v173
    v_mfma_f32_16x16x32_bf16 v[198:201], a[52:55], v[206:209], v[198:201]
    v_fmac_f32 v181, v215, v215
    v_fmac_f32 v181, v216, v216
    v_mfma_f32_16x16x32_bf16 v[198:201], a[56:59], v[174:177], v[198:201]
    v_fmac_f32 v180, v114, v114
    v_fmac_f32 v180, v115, v115
    v_mfma_f32_16x16x32_bf16 v[198:201], a[60:63], v[186:189], v[198:201]
    v_fmac_f32 v180, v116, v116
    v_fmac_f32 v180, v117, v117
    v_mfma_f32_16x16x32_bf16 v[198:201], a[64:67], v[194:197], v[198:201]
    v_fmac_f32 v181, v217, v217
    v_fmac_f32 v181, v130, v130
    v_mfma_f32_16x16x32_bf16 v[198:201], a[68:71], v[122:125], v[198:201]
    ds_read2_b32 v[220:221], v6 offset0:0 offset1:0
    ds_read2_b32 v[224:225], v6 offset0:16 offset1:16
    v_mfma_f32_16x16x32_bf16 v[230:233], v[154:157], a[144:147], 0
    ds_read2_b32 v[212:213], v6 offset0:32 offset1:32
    v_fmac_f32 v181, v131, v131
    v_mfma_f32_16x16x32_bf16 v[230:233], v[206:209], a[148:151], v[230:233]
    v_fmac_f32 v181, v132, v132
    v_fmac_f32 v181, v133, v133
    v_mfma_f32_16x16x32_bf16 v[230:233], v[174:177], a[152:155], v[230:233]
    v_fmac_f32 v180, v198, v198
    v_fmac_f32 v180, v199, v199
    v_mfma_f32_16x16x32_bf16 v[230:233], v[186:189], a[156:159], v[230:233]
    v_fmac_f32 v180, v200, v200
    v_fmac_f32 v180, v201, v201
    v_mfma_f32_16x16x32_bf16 v[230:233], v[194:197], a[160:163], v[230:233]
    v_fmac_f32 v181, v166, v166
    v_fmac_f32 v181, v167, v167
    v_mfma_f32_16x16x32_bf16 v[230:233], v[122:125], a[164:167], v[230:233]
    buffer_store_dwordx4 v[158:161], v15, s[52:55], 0 offen nt
    v_fmac_f32 v181, v168, v168
    v_fmac_f32 v181, v169, v169
    v_cvt_pk_bf16_f32 v36, v180, v181
    v_mul_u32_u24 v222, s20, v179
    v_mfma_f32_16x16x32_bf16 v[158:161], v[154:157], a[168:171], 0
    s_waitcnt lgkmcnt(1)
    v_add_u32 v222, s38, v222
    v_cvt_pk_bf16_f32 v218, v230, v231
    v_mfma_f32_16x16x32_bf16 v[234:237], v[32:35], v[36:39], 0
    s_waitcnt lgkmcnt(0)
    v_cvt_pk_bf16_f32 v219, v232, v233
    v_mul_u32_u24 v180, 911, v222
    v_mfma_f32_16x16x32_bf16 v[158:161], v[206:209], a[172:175], v[158:161]
    v_lshrrev_b32 v180, 16, v180
    v_mul_u32_u24 v180, s22, v180
    v_mfma_f32_16x16x32_bf16 v[158:161], v[174:177], a[176:179], v[158:161]
    v_mad_u32_u24 v180, v179, s21, v180
    v_bfe_u32 v222, s70, v179, 1
    v_mfma_f32_16x16x32_bf16 v[158:161], v[186:189], a[180:183], v[158:161]
    ds_read_b128 v[230:233], v2 offset:12288
    v_cmp_ne_u32 vcc, 0, v222
    v_mfma_f32_16x16x32_bf16 v[158:161], v[194:197], a[184:187], v[158:161]
    v_rsq_f32 v235, v235
    v_mfma_f32_16x16x32_bf16 v[158:161], v[122:125], a[188:191], v[158:161]
    v_rsq_f32 v234, v234
    v_mul_f32 v214, v235, v214
    v_mul_f32 v234, s31, v234
    v_mul_f32 v215, v235, v215
    v_cvt_pk_f16_f32 v214, v214, v215
    v_mfma_f32_16x16x32_bf16 v[238:241], v[154:157], a[192:195], 0
    ds_read_b128 v[154:157], v2 offset:13312
    ds_read_b32 v179, v6 offset:192
    v_mfma_f32_16x16x32_bf16 v[238:241], v[206:209], a[196:199], v[238:241]
    v_cvt_pk_bf16_f32 v222, v158, v159
    v_cvt_pk_bf16_f32 v223, v160, v161
    v_mfma_f32_16x16x32_bf16 v[238:241], v[174:177], a[200:203], v[238:241]
    ds_read_b128 v[158:161], v2 offset:14336
    ds_read_b128 v[174:177], v2 offset:15360
    v_mfma_f32_16x16x32_bf16 v[238:241], v[186:189], a[204:207], v[238:241]
    ds_read_b128 v[186:189], v2 offset:16384
    v_mul_f32 v216, v235, v216
    v_mfma_f32_16x16x32_bf16 v[238:241], v[194:197], a[208:211], v[238:241]
    s_waitcnt lgkmcnt(5)
    ds_read_b128 v[194:197], v2 offset:17408
    v_mul_f32 v217, v235, v217
    v_mfma_f32_16x16x32_bf16 v[238:241], v[122:125], a[212:215], v[238:241]
    ds_read_b128 v[122:125], v5 offset:0
    v_cvt_pk_f16_f32 v215, v216, v217
    v_mul_f32 v130, v235, v130
    buffer_store_dwordx2 v[210:211], v18, s[52:55], 0 offen nt
    ds_read_b128 v[206:209], v5 offset:16
    v_mul_f32 v131, v235, v131
    v_cvt_pk_f16_f32 v216, v130, v131
    v_mul_f32 v132, v235, v132
    v_cvt_pk_bf16_f32 v210, v238, v239
    v_cvt_pk_bf16_f32 v211, v240, v241
    v_mul_f32 v133, v235, v133
    v_cvt_pk_f16_f32 v217, v132, v133
    v_mfma_f32_16x16x32_bf16 v[130:133], a[216:219], v[230:233], 0
    s_waitcnt lgkmcnt(6)
    v_mul_f32 v166, v235, v166
    v_mul_f32 v167, v235, v167
    v_mfma_f32_16x16x32_bf16 v[130:133], a[220:223], v[154:157], v[130:133]
    s_waitcnt lgkmcnt(4)
    v_cvt_pk_f16_f32 v240, v166, v167
    v_mul_f32 v168, v235, v168
    v_mfma_f32_16x16x32_bf16 v[130:133], a[224:227], v[158:161], v[130:133]
    s_waitcnt lgkmcnt(3)
    v_mul_f32 v169, v235, v169
    v_cvt_pk_f16_f32 v241, v168, v169
    v_mfma_f32_16x16x32_bf16 v[130:133], a[228:231], v[174:177], v[130:133]
    s_waitcnt lgkmcnt(2)
    v_mul_f32 v170, v234, v170
    v_mul_f32 v171, v234, v171
    v_mfma_f32_16x16x32_bf16 v[130:133], a[232:235], v[186:189], v[130:133]
    s_waitcnt lgkmcnt(1)
    v_cvt_pk_f16_f32 v166, v170, v171
    v_mul_f32 v172, v234, v172
    v_mfma_f32_16x16x32_f16 v[242:245], v[122:125], v[134:137], v[24:27]
    s_waitcnt lgkmcnt(0)
    v_mul_f32 v173, v234, v173
    v_cvt_pk_f16_f32 v167, v172, v173
    v_mfma_f32_16x16x32_f16 v[242:245], v[206:209], v[162:165], v[242:245]
    v_mul_f32 v114, v234, v114
    v_mul_f32 v115, v234, v115
    v_mfma_f32_16x16x32_bf16 v[130:133], a[236:239], v[194:197], v[130:133]
    v_cvt_pk_f16_f32 v168, v114, v115
    v_mul_f32 v116, v234, v116
    v_mul_f32 v117, v234, v117
    v_cvt_pk_f16_f32 v169, v116, v117
    v_mul_f32 v198, v234, v198
    v_mul_f32 v199, v234, v199
    v_cvt_pk_f16_f32 v238, v198, v199
    v_mfma_f32_16x16x32_f16 v[114:117], v[122:125], v[166:169], v[26:29]
    v_mul_f32 v200, v234, v200
    v_mul_f32 v201, v234, v201
    v_mfma_f32_16x16x32_f16 v[114:117], v[206:209], v[214:217], v[114:117]
    v_cvt_pk_f16_f32 v239, v200, v201
    v_add_u32 v180, s7, v180
    v_cndmask_b32 v180, v178, v180, vcc
    v_lshl_add_u32 v181, v126, 4, v180
    v_add_u32 v181, s3, v181
    v_lshl_add_u32 v180, v126, 3, v180
    v_add_u32 v180, s4, v180
    v_sub_u32 v170, 0x40800000, v44
    v_or_b32 v170, v170, v44
    v_fma_f32 v171, v130, v130, s33
    v_fmac_f32 v171, v131, v131
    v_fmac_f32 v171, v132, v132
    v_fmac_f32 v171, v133, v133
    v_xor_b32 v172, 65536, v2
    v_lshl_add_u32 v173, s16, 2, v172
    ds_write_b32 v173, v170 offset:18432
    v_bfe_u32 v170, v127, 1, 2
    v_xor_b32 v170, v170, v126
    v_lshl_add_u32 v170, v127, 2, v170
    v_lshl_add_u32 v173, v170, 4, s5
    v_lshl_add_u32 v198, v170, 3, s5
    v_lshl_add_u32 v199, v254, 4, s5
    v_lshl_add_u32 v254, v254, 3, s5
    v_lshlrev_b32 v170, 2, v170
    ds_permute_b32 v200, v170, v16
    ds_permute_b32 v201, v170, v19
    ds_permute_b32 v234, v170, v17
    ds_permute_b32 v235, v170, v20
    v_add_u32 v127, 16, v127
    v_min_u32 v170, 20, v127
    v_add_u32 v236, 12, v127
    v_lshrrev_b32 v236, 5, v236
    v_sub_u32 v237, v127, v170
    v_mad_i32_i24 v237, v236, s6, v237
    v_mul_u32_u24 v246, s20, v170
    v_add3_u32 v246, v246, v237, s38
    v_mul_u32_u24 v236, 911, v246
    v_lshrrev_b32 v236, 16, v236
    v_mul_u32_u24 v236, s22, v236
    v_mad_u32_u24 v236, v170, s21, v236
    v_bfe_u32 v246, s70, v127, 1
    v_cmp_ne_u32 vcc, 0, v246
    v_mul_i32_i24 v237, 2688, v237
    v_add3_u32 v127, v236, v237, s7
    v_cndmask_b32 v127, v178, v127, vcc
    v_lshl_add_u32 v170, v126, 4, v127
    v_add_u32 v170, s3, v170
    v_lshl_add_u32 v236, v126, 3, v127
    v_add_u32 v236, s4, v236
    ds_read_b128 v[246:249], v5 offset:48
    s_waitcnt lgkmcnt(0)
    v_mfma_f32_16x16x32_f16 v[114:117], v[246:249], v[238:241], v[114:117]
    v_mfma_f32_16x16x32_f16 v[242:245], v[246:249], v[190:193], v[242:245]
    v_mfma_f32_16x16x32_f16 v[250:253], v[122:125], v[138:141], v[22:25]
    v_mfma_f32_16x16x32_f16 v[250:253], v[206:209], v[150:153], v[250:253]
    v_mfma_f32_16x16x32_f16 v[250:253], v[246:249], v[226:229], v[250:253]
    s_nop 0
    s_nop 0
    s_nop 0
    s_nop 0
    s_nop 0
    s_nop 0
    s_nop 0
    s_nop 0
    v_max3_f32 v178, v250, v202, v203
    v_max3_f32 v178, v178, v204, v205
    v_max3_f32 v178, v178, v142, v143
    v_max3_f32 v178, v178, v144, v145
    v_mov_b32_dpp v179, v251 quad_perm:[0,1,2,3] row_mask:0x1 bank_mask:0xf
    s_nop 0
    s_nop 0
    v_mov_b32_dpp v179, v243 quad_perm:[0,1,2,3] row_mask:0x2 bank_mask:0xf
    v_mfma_f32_16x16x32_f16 v[122:125], v[214:217], v[138:141], v[54:57]
    v_mfma_f32_16x16x32_bf16 v[138:141], a[240:243], v[230:233], 0
    v_mov_b32_dpp v179, v115 quad_perm:[0,1,2,3] row_mask:0x4 bank_mask:0xf
    v_mov_b32 v237, v179
    v_mfma_f32_16x16x32_bf16 v[138:141], a[244:247], v[154:157], v[138:141]
    v_mfma_f32_16x16x32_bf16 v[138:141], a[248:251], v[158:161], v[138:141]
    v_max_f32_dpp v237, v237, v237 quad_perm:[1,0,3,2] row_mask:0xf bank_mask:0xf
    v_mfma_f32_16x16x16_f16 v[122:125], v[240:241], v[226:227], v[122:125]
    v_mfma_f32_16x16x32_bf16 v[138:141], a[252:255], v[174:177], v[138:141]
    v_max_f32_dpp v237, v237, v237 quad_perm:[2,3,0,1] row_mask:0xf bank_mask:0xf
    v_mfma_f32_16x16x32_bf16 v[138:141], v[82:85], v[186:189], v[138:141]
    v_mfma_f32_16x16x32_bf16 v[138:141], v[86:89], v[194:197], v[138:141]
    v_max_f32_dpp v237, v237, v237 row_half_mirror row_mask:0xf bank_mask:0xf
    s_nop 0
    s_nop 0
    v_max_f32_dpp v237, v237, v237 row_mirror row_mask:0xf bank_mask:0xf
    v_max3_f32 v178, v178, v122, v123
    v_max3_f32 v178, v178, v124, v125
    v_mov_b32 v126, v178
    v_mov_b32 v127, v237
    v_fmac_f32 v171, v138, v138
    v_permlane32_swap_b32 v178, v126
    v_max_f32 v178, v178, v126
    v_mov_b32 v126, v178
    v_fmac_f32 v171, v139, v139
    v_fmac_f32 v171, v140, v140
    v_permlane16_swap_b32 v178, v126
    v_max_f32 v178, v178, v126
    v_sub_f32 v202, v202, v178
    v_exp_f32 v202, v202
    v_sub_f32 v203, v203, v178
    v_exp_f32 v203, v203
    v_sub_f32 v204, v204, v178
    v_cvt_pk_bf16_f32 v202, v202, v203
    v_exp_f32 v204, v204
    v_sub_f32 v205, v205, v178
    v_exp_f32 v205, v205
    v_sub_f32 v142, v142, v178
    v_cvt_pk_bf16_f32 v203, v204, v205
    v_exp_f32 v142, v142
    v_sub_f32 v143, v143, v178
    v_exp_f32 v143, v143
    v_sub_f32 v144, v144, v178
    v_cvt_pk_bf16_f32 v204, v142, v143
    v_mfma_f32_16x16x32_bf16 v[206:209], v[90:93], v[230:233], 0
    ds_read_b128 v[230:233], v128 offset:0
    v_sub_f32 v145, v145, v178
    v_mfma_f32_16x16x32_bf16 v[206:209], v[94:97], v[154:157], v[206:209]
    ds_read_b128 v[154:157], v128 offset:2048
    v_sub_f32 v122, v122, v178
    v_mfma_f32_16x16x32_bf16 v[206:209], v[98:101], v[158:161], v[206:209]
    ds_read_b128 v[158:161], v128 offset:4096
    v_sub_f32 v123, v123, v178
    v_mfma_f32_16x16x32_bf16 v[206:209], v[102:105], v[174:177], v[206:209]
    ds_read_b128 v[174:177], v128 offset:6144
    v_sub_f32 v124, v124, v178
    v_mfma_f32_16x16x32_bf16 v[206:209], v[106:109], v[186:189], v[206:209]
    ds_read_b128 v[186:189], v128 offset:8192
    v_sub_f32 v125, v125, v178
    v_mfma_f32_16x16x32_bf16 v[206:209], v[110:113], v[194:197], v[206:209]
    ds_read_b128 v[194:197], v128 offset:10240
    v_exp_f32 v144, v144
    v_exp_f32 v145, v145
    v_exp_f32 v122, v122
    v_cvt_pk_bf16_f32 v205, v144, v145
    v_exp_f32 v123, v123
    v_exp_f32 v124, v124
    v_cvt_pk_bf16_f32 v36, v122, v123
    v_exp_f32 v125, v125
    v_sub_f32 v250, v250, v178
    v_mfma_f32_16x16x32_f16 v[142:145], v[150:153], v[134:137], v[58:61]
    v_cvt_pk_bf16_f32 v37, v124, v125
    v_exp_f32 v250, v250
    v_fmac_f32 v171, v141, v141
    v_cvt_pk_bf16_f32 v39, v250, 0
    v_fmac_f32 v171, v206, v206
    v_fmac_f32 v171, v207, v207
    v_mfma_f32_16x16x16_f16 v[142:145], v[228:229], v[190:191], v[142:145]
    v_fmac_f32 v171, v208, v208
    v_fmac_f32 v171, v209, v209
    v_permlane32_swap_b32 v237, v127
    v_max_f32 v237, v237, v127
    v_mfma_f32_16x16x32_bf16 v[122:125], v[28:31], v[36:39], 0
    s_waitcnt lgkmcnt(0)
    v_mov_b32 v127, v237
    v_mfma_f32_16x16x32_bf16 v[122:125], v[28:31], v[202:205], v[122:125]
    v_max3_f32 v178, v242, v142, v143
    v_permlane16_swap_b32 v237, v127
    v_max_f32 v237, v237, v127
    v_sub_f32 v179, v179, v237
    v_exp_f32 v179, v179
    v_max3_f32 v178, v178, v144, v145
    v_cvt_pk_bf16_f32 v179, v179, v179
    ds_write_b16 v8, v179
    v_mfma_f32_16x16x32_bf16 v[246:249], v[218:221], v[36:39], 0
    v_rcp_f32 v122, v122
    v_mfma_f32_16x16x32_bf16 v[246:249], v[146:149], v[202:205], v[246:249]
    s_nop 0
    s_nop 0
    s_nop 0
    s_nop 0
    s_nop 0
    s_nop 0
    s_nop 0
    s_nop 0
    v_mul_f32 v246, v122, v246
    v_mul_f32 v247, v122, v247
    v_cvt_pk_bf16_f32 v246, v246, v247
    v_mul_f32 v248, v122, v248
    v_mul_f32 v249, v122, v249
    v_cvt_pk_bf16_f32 v247, v248, v249
    v_mfma_f32_16x16x32_f16 v[250:253], v[162:165], v[134:137], v[62:65]
    s_nop 0
    s_nop 0
    s_nop 0
    s_nop 0
    s_nop 0
    s_nop 0
    v_mfma_f32_16x16x16_f16 v[250:253], v[192:193], v[190:191], v[250:253]
    s_nop 0
    s_nop 0
    s_nop 0
    s_nop 0
    s_nop 0
    s_nop 0
    s_nop 0
    s_nop 0
    v_max3_f32 v178, v178, v250, v251
    v_max3_f32 v178, v178, v252, v253
    v_mfma_f32_16x16x32_f16 v[124:127], v[214:217], v[134:137], v[66:69]
    s_nop 0
    s_nop 0
    s_nop 0
    s_nop 0
    s_nop 0
    s_nop 0
    v_mfma_f32_16x16x16_f16 v[124:127], v[240:241], v[190:191], v[124:127]
    s_nop 0
    s_nop 0
    s_nop 0
    s_nop 0
    s_nop 0
    s_nop 0
    s_nop 0
    s_nop 0
    v_max3_f32 v178, v178, v124, v125
    v_max3_f32 v178, v178, v126, v127
    v_mov_b32 v123, v178
    s_nop 0
    s_nop 0
    v_permlane32_swap_b32 v178, v123
    v_max_f32 v178, v178, v123
    v_mov_b32 v123, v178
    s_nop 0
    s_nop 0
    v_permlane16_swap_b32 v178, v123
    v_max_f32 v178, v178, v123
    v_sub_f32 v142, v142, v178
    v_exp_f32 v142, v142
    v_sub_f32 v143, v143, v178
    v_exp_f32 v143, v143
    v_sub_f32 v144, v144, v178
    v_cvt_pk_bf16_f32 v134, v142, v143
    v_exp_f32 v144, v144
    v_sub_f32 v145, v145, v178
    v_exp_f32 v145, v145
    v_sub_f32 v250, v250, v178
    v_cvt_pk_bf16_f32 v135, v144, v145
    v_exp_f32 v250, v250
    v_sub_f32 v251, v251, v178
    v_exp_f32 v251, v251
    v_sub_f32 v252, v252, v178
    v_cvt_pk_bf16_f32 v136, v250, v251
    v_exp_f32 v252, v252
    v_sub_f32 v253, v253, v178
    v_exp_f32 v253, v253
    v_sub_f32 v124, v124, v178
    v_cvt_pk_bf16_f32 v137, v252, v253
    v_mfma_f32_16x16x32_bf16 v[142:145], v[222:225], v[36:39], 0
    v_exp_f32 v124, v124
    v_mfma_f32_16x16x32_bf16 v[142:145], v[118:121], v[202:205], v[142:145]
    v_sub_f32 v125, v125, v178
    v_exp_f32 v125, v125
    v_sub_f32 v126, v126, v178
    v_exp_f32 v126, v126
    v_sub_f32 v127, v127, v178
    v_exp_f32 v127, v127
    v_sub_f32 v242, v242, v178
    v_exp_f32 v242, v242
    v_mul_f32 v142, v122, v142
    v_mul_f32 v143, v122, v143
    v_cvt_pk_bf16_f32 v248, v142, v143
    v_mul_f32 v144, v122, v144
    v_mul_f32 v145, v122, v145
    v_cvt_pk_bf16_f32 v249, v144, v145
    ds_write_b128 v3, v[246:249] offset:0
    v_mfma_f32_16x16x32_bf16 v[142:145], v[210:213], v[36:39], 0
    v_cvt_pk_bf16_f32 v36, v124, v125
    v_cvt_pk_bf16_f32 v37, v126, v127
    v_mfma_f32_16x16x32_bf16 v[142:145], v[182:185], v[202:205], v[142:145]
    v_cvt_pk_bf16_f32 v39, v242, 0
    v_mfma_f32_16x16x32_f16 v[202:205], v[150:153], v[166:169], v[70:73]
    ds_read_b128 v[150:153], v9
    ds_read_b128 v[242:245], v9 offset:64
    v_mfma_f32_16x16x32_f16 v[246:249], v[162:165], v[166:169], v[74:77]
    v_mfma_f32_16x16x32_f16 v[162:165], v[214:217], v[166:169], v[78:81]
    v_mfma_f32_16x16x32_bf16 v[166:169], v[28:31], v[36:39], 0
    v_mfma_f32_16x16x32_bf16 v[166:169], v[28:31], v[134:137], v[166:169]
    v_mul_f32 v142, v122, v142
    v_mul_f32 v143, v122, v143
    v_cvt_pk_bf16_f32 v126, v142, v143
    v_mfma_f32_16x16x16_f16 v[202:205], v[228:229], v[238:239], v[202:205]
    v_mul_f32 v144, v122, v144
    v_mul_f32 v145, v122, v145
    v_cvt_pk_bf16_f32 v127, v144, v145
    v_mfma_f32_16x16x16_f16 v[246:249], v[192:193], v[238:239], v[246:249]
    v_rcp_f32 v166, v166
    v_mfma_f32_16x16x16_f16 v[162:165], v[240:241], v[238:239], v[162:165]
    ds_write_b64 v4, v[126:127] offset:4096
    v_mfma_f32_16x16x32_bf16 v[122:125], v[218:221], v[36:39], 0
    s_waitcnt lgkmcnt(1)
    v_max3_f32 v237, v114, v202, v203
    v_max3_f32 v237, v237, v204, v205
    v_mfma_f32_16x16x32_bf16 v[122:125], v[146:149], v[134:137], v[122:125]
    v_max3_f32 v237, v237, v246, v247
    v_max3_f32 v237, v237, v248, v249
    v_mfma_f32_16x16x32_bf16 v[142:145], v[222:225], v[36:39], 0
    v_max3_f32 v237, v237, v162, v163
    v_max3_f32 v237, v237, v164, v165
    v_mfma_f32_16x16x32_bf16 v[142:145], v[118:121], v[134:137], v[142:145]
    v_mov_b32 v126, v237
    v_mfma_f32_16x16x32_bf16 v[190:193], v[210:213], v[36:39], 0
    v_mul_f32 v122, v166, v122
    v_mul_f32 v123, v166, v123
    v_mfma_f32_16x16x32_bf16 v[190:193], v[182:185], v[134:137], v[190:193]
    v_cvt_pk_bf16_f32 v122, v122, v123
    v_mul_f32 v124, v166, v124
    v_mfma_f32_16x16x32_bf16 v[134:137], a[216:219], v[230:233], 0
    v_mul_f32 v125, v166, v125
    v_cvt_pk_bf16_f32 v123, v124, v125
    v_mfma_f32_16x16x32_bf16 v[134:137], a[220:223], v[154:157], v[134:137]
    v_mul_f32 v142, v166, v142
    v_mul_f32 v143, v166, v143
    v_mfma_f32_16x16x32_bf16 v[134:137], a[224:227], v[158:161], v[134:137]
    v_cvt_pk_bf16_f32 v124, v142, v143
    v_mul_f32 v144, v166, v144
    v_mfma_f32_16x16x32_bf16 v[134:137], a[228:231], v[174:177], v[134:137]
    v_mul_f32 v145, v166, v145
    v_cvt_pk_bf16_f32 v125, v144, v145
    v_mfma_f32_16x16x32_bf16 v[134:137], a[232:235], v[186:189], v[134:137]
    ds_write_b128 v3, v[122:125] offset:6144
    v_mfma_f32_16x16x32_bf16 v[134:137], a[236:239], v[194:197], v[134:137]
    v_mul_f32 v190, v166, v190
    v_mul_f32 v191, v166, v191
    v_mfma_f32_16x16x32_bf16 v[122:125], a[240:243], v[230:233], 0
    v_cvt_pk_bf16_f32 v178, v190, v191
    v_mul_f32 v192, v166, v192
    v_mfma_f32_16x16x32_bf16 v[122:125], a[244:247], v[154:157], v[122:125]
    v_mul_f32 v193, v166, v193
    v_cvt_pk_bf16_f32 v179, v192, v193
    v_mfma_f32_16x16x32_bf16 v[122:125], a[248:251], v[158:161], v[122:125]
    ds_write_b64 v4, v[178:179] offset:10240
    v_mfma_f32_16x16x32_bf16 v[122:125], a[252:255], v[174:177], v[122:125]
    v_permlane32_swap_b32 v237, v126
    v_mfma_f32_16x16x32_bf16 v[122:125], v[82:85], v[186:189], v[122:125]
    v_fma_f32 v127, v134, v134, s33
    v_fmac_f32 v127, v135, v135
    v_mfma_f32_16x16x32_bf16 v[122:125], v[86:89], v[194:197], v[122:125]
    v_fmac_f32 v127, v136, v136
    v_fmac_f32 v127, v137, v137
    v_mfma_f32_16x16x32_bf16 v[142:145], v[90:93], v[230:233], 0
    v_max_f32 v237, v237, v126
    v_mov_b32 v126, v237
    v_mfma_f32_16x16x32_bf16 v[142:145], v[94:97], v[154:157], v[142:145]
    v_mfma_f32_16x16x32_bf16 v[142:145], v[98:101], v[158:161], v[142:145]
    v_permlane16_swap_b32 v237, v126
    v_mfma_f32_16x16x32_bf16 v[142:145], v[102:105], v[174:177], v[142:145]
    v_fmac_f32 v127, v122, v122
    v_fmac_f32 v127, v123, v123
    v_mfma_f32_16x16x32_bf16 v[142:145], v[106:109], v[186:189], v[142:145]
    v_fmac_f32 v127, v124, v124
    v_fmac_f32 v127, v125, v125
    v_mfma_f32_16x16x32_bf16 v[142:145], v[110:113], v[194:197], v[142:145]
    v_max_f32 v237, v237, v126
    v_sub_f32 v202, v202, v237
    v_mfma_f32_16x16x32_bf16 v[154:157], v[150:153], v[28:31], 0
    v_exp_f32 v202, v202
    v_mfma_f32_16x16x32_bf16 v[154:157], v[242:245], v[28:31], v[154:157]
    v_sub_f32 v203, v203, v237
    v_sub_f32 v204, v204, v237
    v_mfma_f32_16x16x32_bf16 v[158:161], v[150:153], v[146:149], 0
    v_fmac_f32 v127, v142, v142
    v_fmac_f32 v127, v143, v143
    v_mfma_f32_16x16x32_bf16 v[158:161], v[242:245], v[218:221], v[158:161]
    v_fmac_f32 v127, v144, v144
    v_fmac_f32 v127, v145, v145
    v_mfma_f32_16x16x32_bf16 v[166:169], v[150:153], v[118:121], 0
    v_cvt_pk_bf16_f32 v126, v171, v127
    v_cvt_pk_bf16_f32 v127, v127, v127
    v_mfma_f32_16x16x32_bf16 v[166:169], v[242:245], v[222:225], v[166:169]
    ds_write_b64 v255, v[126:127] offset:2048
    v_mfma_f32_16x16x32_bf16 v[174:177], v[150:153], v[182:185], 0
    v_rcp_f32 v154, v154
    v_mfma_f32_16x16x32_bf16 v[174:177], v[242:245], v[210:213], v[174:177]
    v_mul_f32 v158, v158, v154
    v_exp_f32 v203, v203
    v_exp_f32 v204, v204
    v_cvt_pk_bf16_f32 v150, v202, v203
    v_mul_f32_dpp v158, v166, v154 quad_perm:[0,1,2,3] row_mask:0x2 bank_mask:0xf
    v_sub_f32 v205, v205, v237
    v_exp_f32 v205, v205
    v_sub_f32 v246, v246, v237
    v_mul_f32_dpp v158, v174, v154 quad_perm:[0,1,2,3] row_mask:0x4 bank_mask:0xf
    v_cvt_pk_bf16_f32 v158, v158, v158
    ds_write_b16 v7, v158
    v_cvt_pk_bf16_f32 v151, v204, v205
    v_exp_f32 v246, v246
    s_waitcnt lgkmcnt(1)
    s_barrier
    ds_read_b128 v[154:157], v129 offset:2048
    ds_read_b128 v[158:161], v129 offset:3072
    ds_read_b128 v[166:169], v172 offset:0
    ds_read_b128 v[174:177], v172 offset:1024
    ds_read_b128 v[186:189], v172 offset:2048
    ds_read_b128 v[190:193], v172 offset:3072
    ds_read_b128 v[194:197], v172 offset:4096
    ds_read_b128 v[202:205], v172 offset:5120
    v_sub_f32 v247, v247, v237
    v_exp_f32 v247, v247
    v_sub_f32 v248, v248, v237
    v_cvt_pk_bf16_f32 v152, v246, v247
    v_exp_f32 v248, v248
    s_waitcnt lgkmcnt(6)
    v_mfma_f32_16x16x32_bf16 v[214:217], v[32:35], v[154:157], 0
    s_waitcnt lgkmcnt(5)
    v_sub_f32 v249, v249, v237
    v_sub_f32 v162, v162, v237
    v_mfma_f32_16x16x32_bf16 v[214:217], v[32:35], v[158:161], v[214:217]
    s_waitcnt lgkmcnt(4)
    v_exp_f32 v249, v249
    v_mfma_f32_16x16x32_bf16 v[154:157], a[216:219], v[166:169], 0
    s_waitcnt lgkmcnt(3)
    v_cvt_pk_bf16_f32 v153, v248, v249
    v_sub_f32 v163, v163, v237
    v_mfma_f32_16x16x32_bf16 v[154:157], a[220:223], v[174:177], v[154:157]
    s_waitcnt lgkmcnt(2)
    v_mul_f32 v171, 0x3baaaaab, v215
    v_mul_f32 v126, 0x3baaaaab, v214
    v_mfma_f32_16x16x32_bf16 v[154:157], a[224:227], v[186:189], v[154:157]
    s_waitcnt lgkmcnt(1)
    v_rsq_f32 v171, v171
    v_mfma_f32_16x16x32_bf16 v[154:157], a[228:231], v[190:193], v[154:157]
    s_waitcnt lgkmcnt(0)
    v_mul_f32 v134, v171, v134
    v_mul_f32 v135, v171, v135
    v_mfma_f32_16x16x32_bf16 v[154:157], a[232:235], v[194:197], v[154:157]
    v_cvt_pk_bf16_f32 v134, v134, v135
    v_mul_f32 v136, v171, v136
    v_mfma_f32_16x16x32_bf16 v[154:157], a[236:239], v[202:205], v[154:157]
    v_mul_f32 v137, v171, v137
    v_cvt_pk_bf16_f32 v135, v136, v137
    v_mfma_f32_16x16x32_bf16 v[158:161], a[240:243], v[166:169], 0
    v_mul_f32 v122, v171, v122
    v_mul_f32 v123, v171, v123
    v_mfma_f32_16x16x32_bf16 v[158:161], a[244:247], v[174:177], v[158:161]
    v_cvt_pk_bf16_f32 v136, v122, v123
    v_mul_f32 v124, v171, v124
    v_mfma_f32_16x16x32_bf16 v[158:161], a[248:251], v[186:189], v[158:161]
    v_mul_f32 v125, v171, v125
    v_cvt_pk_bf16_f32 v137, v124, v125
    v_mfma_f32_16x16x32_bf16 v[158:161], a[252:255], v[190:193], v[158:161]
    buffer_store_dwordx4 v[134:137], v181, s[12:15], 0 offen nt
    v_mul_f32 v142, v171, v142
    v_mul_f32 v143, v171, v143
    v_cvt_pk_bf16_f32 v116, v142, v143
    v_mul_f32 v144, v171, v144
    v_mfma_f32_16x16x32_bf16 v[158:161], v[82:85], v[194:197], v[158:161]
    v_mul_f32 v145, v171, v145
    v_cvt_pk_bf16_f32 v117, v144, v145
    v_mfma_f32_16x16x32_bf16 v[158:161], v[86:89], v[202:205], v[158:161]
    ds_read_b128 v[122:125], v172 offset:6144
    v_fma_f32 v171, v154, v154, s33
    v_mfma_f32_16x16x32_bf16 v[134:137], v[90:93], v[166:169], 0
    ds_read_b128 v[142:145], v172 offset:7168
    v_fmac_f32 v171, v155, v155
    v_mfma_f32_16x16x32_bf16 v[134:137], v[94:97], v[174:177], v[134:137]
    ds_read_b128 v[166:169], v172 offset:8192
    v_fmac_f32 v171, v156, v156
    v_mfma_f32_16x16x32_bf16 v[134:137], v[98:101], v[186:189], v[134:137]
    ds_read_b128 v[174:177], v172 offset:9216
    v_fmac_f32 v171, v157, v157
    v_mfma_f32_16x16x32_bf16 v[134:137], v[102:105], v[190:193], v[134:137]
    ds_read_b128 v[186:189], v172 offset:10240
    v_fmac_f32 v171, v158, v158
    v_mfma_f32_16x16x32_bf16 v[134:137], v[106:109], v[194:197], v[134:137]
    ds_read_b128 v[190:193], v172 offset:11264
    v_fmac_f32 v171, v159, v159
    v_mfma_f32_16x16x32_bf16 v[134:137], v[110:113], v[202:205], v[134:137]
    v_fmac_f32 v171, v160, v160
    v_fmac_f32 v171, v161, v161
    v_rsq_f32 v126, v126
    s_waitcnt lgkmcnt(5)
    v_mfma_f32_16x16x32_bf16 v[194:197], a[216:219], v[122:125], 0
    v_mul_f32 v130, v126, v130
    v_mul_f32 v131, v126, v131
    v_mfma_f32_16x16x32_bf16 v[202:205], a[240:243], v[122:125], 0
    s_waitcnt lgkmcnt(4)
    v_fmac_f32 v171, v134, v134
    v_fmac_f32 v171, v135, v135
    v_mfma_f32_16x16x32_bf16 v[194:197], a[220:223], v[142:145], v[194:197]
    s_waitcnt lgkmcnt(3)
    v_fmac_f32 v171, v136, v136
    v_fmac_f32 v171, v137, v137
    v_mfma_f32_16x16x32_bf16 v[194:197], a[224:227], v[166:169], v[194:197]
    s_waitcnt lgkmcnt(2)
    v_cvt_pk_bf16_f32 v130, v130, v131
    v_mul_f32 v132, v126, v132
    v_mfma_f32_16x16x32_bf16 v[194:197], a[228:231], v[174:177], v[194:197]
    s_waitcnt lgkmcnt(1)
    v_mul_f32 v133, v126, v133
    v_cvt_pk_bf16_f32 v131, v132, v133
    v_mfma_f32_16x16x32_bf16 v[194:197], a[232:235], v[186:189], v[194:197]
    s_waitcnt lgkmcnt(0)
    v_mul_f32 v138, v126, v138
    v_mul_f32 v139, v126, v139
    v_mfma_f32_16x16x32_bf16 v[194:197], a[236:239], v[190:193], v[194:197]
    buffer_store_dwordx2 v[116:117], v180, s[12:15], 0 offen nt
    v_cvt_pk_bf16_f32 v132, v138, v139
    v_mul_f32 v140, v126, v140
    v_mfma_f32_16x16x32_bf16 v[202:205], a[244:247], v[142:145], v[202:205]
    v_mul_f32 v141, v126, v141
    v_cvt_pk_bf16_f32 v133, v140, v141
    v_mfma_f32_16x16x32_bf16 v[202:205], a[248:251], v[166:169], v[202:205]
    v_mul_f32 v206, v126, v206
    v_fma_f32 v127, v194, v194, s33
    v_mfma_f32_16x16x32_bf16 v[202:205], a[252:255], v[174:177], v[202:205]
    v_fmac_f32 v127, v195, v195
    v_fmac_f32 v127, v196, v196
    v_mfma_f32_16x16x32_bf16 v[202:205], v[82:85], v[186:189], v[202:205]
    v_fmac_f32 v127, v197, v197
    v_mul_f32 v207, v126, v207
    v_mfma_f32_16x16x32_bf16 v[202:205], v[86:89], v[190:193], v[202:205]
    v_cvt_pk_bf16_f32 v116, v206, v207
    v_mul_f32 v208, v126, v208
    v_mfma_f32_16x16x32_bf16 v[138:141], v[90:93], v[122:125], 0
    v_mul_f32 v209, v126, v209
    v_cvt_pk_bf16_f32 v117, v208, v209
    v_mfma_f32_16x16x32_bf16 v[138:141], v[94:97], v[142:145], v[138:141]
    v_exp_f32 v162, v162
    v_mfma_f32_16x16x32_bf16 v[138:141], v[98:101], v[166:169], v[138:141]
    v_fmac_f32 v127, v202, v202
    v_fmac_f32 v127, v203, v203
    v_mfma_f32_16x16x32_bf16 v[138:141], v[102:105], v[174:177], v[138:141]
    v_fmac_f32 v127, v204, v204
    v_fmac_f32 v127, v205, v205
    v_mfma_f32_16x16x32_bf16 v[138:141], v[106:109], v[186:189], v[138:141]
    v_exp_f32 v163, v163
    v_mfma_f32_16x16x32_bf16 v[138:141], v[110:113], v[190:193], v[138:141]
    v_cvt_pk_bf16_f32 v36, v162, v163
    v_sub_f32 v164, v164, v237
    v_exp_f32 v164, v164
    v_sub_f32 v165, v165, v237
    v_exp_f32 v165, v165
    v_sub_f32 v114, v114, v237
    v_cvt_pk_bf16_f32 v37, v164, v165
    v_exp_f32 v114, v114
    v_fmac_f32 v127, v138, v138
    v_fmac_f32 v127, v139, v139
    v_fmac_f32 v127, v140, v140
    v_fmac_f32 v127, v141, v141
    v_cvt_pk_bf16_f32 v126, v171, v127
    v_cvt_pk_bf16_f32 v127, v127, v127
    ds_write_b64 v255, v[126:127] offset:7616
    buffer_store_dwordx4 v[130:133], v17, s[52:55], 0 offen nt
    v_cvt_pk_bf16_f32 v39, v114, 0
    s_nop 0
    s_nop 0
    v_mfma_f32_16x16x32_bf16 v[122:125], v[28:31], v[36:39], 0
    v_mfma_f32_16x16x32_bf16 v[122:125], v[28:31], v[150:153], v[122:125]
    v_mfma_f32_16x16x32_bf16 v[130:133], v[218:221], v[36:39], 0
    v_mfma_f32_16x16x32_bf16 v[130:133], v[146:149], v[150:153], v[130:133]
    v_mfma_f32_16x16x32_bf16 v[142:145], v[222:225], v[36:39], 0
    v_mfma_f32_16x16x32_bf16 v[142:145], v[118:121], v[150:153], v[142:145]
    v_mfma_f32_16x16x32_bf16 v[118:121], v[210:213], v[36:39], 0
    v_mfma_f32_16x16x32_bf16 v[118:121], v[182:185], v[150:153], v[118:121]
    s_nop 0
    s_nop 0
    v_rcp_f32 v122, v122
    s_nop 0
    v_mul_f32 v130, v122, v130
    v_mul_f32 v131, v122, v131
    v_cvt_pk_bf16_f32 v130, v130, v131
    v_mul_f32 v132, v122, v132
    v_mul_f32 v133, v122, v133
    v_cvt_pk_bf16_f32 v131, v132, v133
    v_mul_f32 v142, v122, v142
    v_mul_f32 v143, v122, v143
    v_cvt_pk_bf16_f32 v132, v142, v143
    v_mul_f32 v144, v122, v144
    v_mul_f32 v145, v122, v145
    v_cvt_pk_bf16_f32 v133, v144, v145
    ds_write_b128 v3, v[130:133] offset:12288
    v_mul_f32 v118, v122, v118
    v_mul_f32 v119, v122, v119
    v_cvt_pk_bf16_f32 v114, v118, v119
    v_mul_f32 v120, v122, v120
    v_mul_f32 v121, v122, v121
    v_cvt_pk_bf16_f32 v115, v120, v121
    buffer_store_dwordx2 v[116:117], v20, s[52:55], 0 offen nt
    ds_write_b64 v4, v[114:115] offset:16384
    s_waitcnt lgkmcnt(0)
    s_barrier
    ds_read_b128 v[114:117], v129 offset:7616
    ds_read_b128 v[118:121], v129 offset:8640
    ds_read_b128 v[122:125], v172 offset:12288
    ds_read_b128 v[130:133], v172 offset:13312
    ds_read_b128 v[142:145], v172 offset:14336
    ds_read_b128 v[146:149], v172 offset:15360
    ds_read_b128 v[150:153], v172 offset:16384
    ds_read_b128 v[162:165], v172 offset:17408
    s_waitcnt lgkmcnt(7)
    v_mfma_f32_16x16x32_bf16 v[166:169], v[32:35], v[114:117], 0
    s_waitcnt lgkmcnt(6)
    v_mfma_f32_16x16x32_bf16 v[166:169], v[32:35], v[118:121], v[166:169]
    s_waitcnt lgkmcnt(4)
    v_mfma_f32_16x16x32_bf16 v[114:117], a[216:219], v[122:125], 0
    s_waitcnt lgkmcnt(3)
    v_mfma_f32_16x16x32_bf16 v[114:117], a[220:223], v[130:133], v[114:117]
    s_waitcnt lgkmcnt(2)
    v_mfma_f32_16x16x32_bf16 v[114:117], a[224:227], v[142:145], v[114:117]
    s_waitcnt lgkmcnt(1)
    v_mfma_f32_16x16x32_bf16 v[114:117], a[228:231], v[146:149], v[114:117]
    s_waitcnt lgkmcnt(0)
    v_mul_f32 v171, 0x3baaaaab, v166
    v_mul_f32 v237, 0x3baaaaab, v167
    v_mfma_f32_16x16x32_bf16 v[114:117], a[232:235], v[150:153], v[114:117]
    v_rsq_f32 v171, v171
    v_mfma_f32_16x16x32_bf16 v[114:117], a[236:239], v[162:165], v[114:117]
    v_mul_f32 v154, v171, v154
    v_mul_f32 v155, v171, v155
    v_mfma_f32_16x16x32_bf16 v[118:121], a[240:243], v[122:125], 0
    v_cvt_pk_bf16_f32 v154, v154, v155
    v_mul_f32 v156, v171, v156
    v_mfma_f32_16x16x32_bf16 v[118:121], a[244:247], v[130:133], v[118:121]
    v_mul_f32 v157, v171, v157
    v_cvt_pk_bf16_f32 v155, v156, v157
    v_mfma_f32_16x16x32_bf16 v[118:121], a[248:251], v[142:145], v[118:121]
    v_fma_f32 v126, v114, v114, s33
    v_fmac_f32 v126, v115, v115
    v_mfma_f32_16x16x32_bf16 v[118:121], a[252:255], v[146:149], v[118:121]
    v_fmac_f32 v126, v116, v116
    v_fmac_f32 v126, v117, v117
    v_mfma_f32_16x16x32_bf16 v[118:121], v[82:85], v[150:153], v[118:121]
    v_mul_f32 v158, v171, v158
    v_mul_f32 v159, v171, v159
    v_mfma_f32_16x16x32_bf16 v[118:121], v[86:89], v[162:165], v[118:121]
    ds_read_b128 v[166:169], v128 offset:256
    v_cvt_pk_bf16_f32 v156, v158, v159
    v_mfma_f32_16x16x32_bf16 v[174:177], v[90:93], v[122:125], 0
    ds_read_b128 v[122:125], v128 offset:2304
    v_mul_f32 v160, v171, v160
    v_mfma_f32_16x16x32_bf16 v[174:177], v[94:97], v[130:133], v[174:177]
    ds_read_b128 v[130:133], v128 offset:4352
    v_mul_f32 v161, v171, v161
    v_mfma_f32_16x16x32_bf16 v[174:177], v[98:101], v[142:145], v[174:177]
    ds_read_b128 v[142:145], v128 offset:6400
    v_fmac_f32 v126, v118, v118
    v_mfma_f32_16x16x32_bf16 v[174:177], v[102:105], v[146:149], v[174:177]
    ds_read_b128 v[146:149], v128 offset:8448
    v_fmac_f32 v126, v119, v119
    v_mfma_f32_16x16x32_bf16 v[174:177], v[106:109], v[150:153], v[174:177]
    ds_read_b128 v[150:153], v128 offset:10496
    v_fmac_f32 v126, v120, v120
    v_mfma_f32_16x16x32_bf16 v[174:177], v[110:113], v[162:165], v[174:177]
    v_fmac_f32 v126, v121, v121
    v_cvt_pk_bf16_f32 v157, v160, v161
    buffer_store_dwordx4 v[154:157], v15, s[56:59], 0 offen nt
    s_waitcnt lgkmcnt(5)
    v_mul_f32 v134, v171, v134
    v_mul_f32 v135, v171, v135
    v_cvt_pk_bf16_f32 v134, v134, v135
    v_mfma_f32_16x16x32_bf16 v[154:157], a[216:219], v[166:169], 0
    s_waitcnt lgkmcnt(4)
    v_fmac_f32 v126, v174, v174
    v_fmac_f32 v126, v175, v175
    v_mfma_f32_16x16x32_bf16 v[154:157], a[220:223], v[122:125], v[154:157]
    s_waitcnt lgkmcnt(3)
    v_fmac_f32 v126, v176, v176
    v_fmac_f32 v126, v177, v177
    v_mfma_f32_16x16x32_bf16 v[154:157], a[224:227], v[130:133], v[154:157]
    s_waitcnt lgkmcnt(2)
    v_cvt_pk_bf16_f32 v158, v126, v126
    v_cvt_pk_bf16_f32 v159, v126, v126
    v_mfma_f32_16x16x32_bf16 v[154:157], a[228:231], v[142:145], v[154:157]
    s_waitcnt lgkmcnt(1)
    ds_write_b64 v255, v[158:159] offset:9664
    v_mfma_f32_16x16x32_bf16 v[154:157], a[232:235], v[146:149], v[154:157]
    s_waitcnt lgkmcnt(1)
    v_mul_f32 v136, v171, v136
    v_mul_f32 v137, v171, v137
    v_mfma_f32_16x16x32_bf16 v[154:157], a[236:239], v[150:153], v[154:157]
    v_rsq_f32 v237, v237
    v_mfma_f32_16x16x32_bf16 v[158:161], a[240:243], v[166:169], 0
    v_cvt_pk_bf16_f32 v135, v136, v137
    v_mul_f32 v194, v237, v194
    v_mfma_f32_16x16x32_bf16 v[158:161], a[244:247], v[122:125], v[158:161]
    v_mul_f32 v195, v237, v195
    v_cvt_pk_bf16_f32 v162, v194, v195
    v_mfma_f32_16x16x32_bf16 v[158:161], a[248:251], v[130:133], v[158:161]
    v_fma_f32 v171, v154, v154, s33
    v_fmac_f32 v171, v155, v155
    v_mfma_f32_16x16x32_bf16 v[158:161], a[252:255], v[142:145], v[158:161]
    v_fmac_f32 v171, v156, v156
    v_fmac_f32 v171, v157, v157
    v_mfma_f32_16x16x32_bf16 v[158:161], v[82:85], v[146:149], v[158:161]
    v_mul_f32 v196, v237, v196
    v_mul_f32 v197, v237, v197
    v_mfma_f32_16x16x32_bf16 v[158:161], v[86:89], v[150:153], v[158:161]
    v_cvt_pk_bf16_f32 v163, v196, v197
    v_mul_f32 v202, v237, v202
    v_mfma_f32_16x16x32_bf16 v[178:181], v[90:93], v[166:169], 0
    v_mul_f32 v203, v237, v203
    v_cvt_pk_bf16_f32 v164, v202, v203
    v_mfma_f32_16x16x32_bf16 v[178:181], v[94:97], v[122:125], v[178:181]
    v_mul_f32 v204, v237, v204
    v_mul_f32 v205, v237, v205
    v_mfma_f32_16x16x32_bf16 v[178:181], v[98:101], v[130:133], v[178:181]
    buffer_store_dwordx2 v[134:135], v18, s[56:59], 0 offen nt
    v_fmac_f32 v171, v158, v158
    v_fmac_f32 v171, v159, v159
    v_mfma_f32_16x16x32_bf16 v[178:181], v[102:105], v[142:145], v[178:181]
    v_fmac_f32 v171, v160, v160
    v_fmac_f32 v171, v161, v161
    v_mfma_f32_16x16x32_bf16 v[178:181], v[106:109], v[146:149], v[178:181]
    v_cvt_pk_bf16_f32 v165, v204, v205
    v_mul_f32 v138, v237, v138
    v_mfma_f32_16x16x32_bf16 v[178:181], v[110:113], v[150:153], v[178:181]
    ds_write_b128 v173, v[162:165] offset:1536
    v_mul_f32 v139, v237, v139
    v_cvt_pk_bf16_f32 v126, v138, v139
    v_mul_f32 v140, v237, v140
    v_mul_f32 v141, v237, v141
    v_cvt_pk_bf16_f32 v127, v140, v141
    s_nop 0
    s_nop 0
    v_fmac_f32 v171, v178, v178
    v_fmac_f32 v171, v179, v179
    v_fmac_f32 v171, v180, v180
    v_fmac_f32 v171, v181, v181
    v_cvt_pk_bf16_f32 v122, v171, v171
    v_cvt_pk_bf16_f32 v123, v171, v171
    ds_write_b64 v255, v[122:123] offset:15232
    ds_read_b128 v[122:125], v199 offset:1536
    ds_write_b64 v198, v[126:127] offset:2560
    ds_read_b64 v[126:127], v254 offset:2560
    s_waitcnt lgkmcnt(3)
    s_barrier
    ds_read_b128 v[130:133], v129 offset:9664
    ds_read_b128 v[134:137], v129 offset:10688
    ds_read_b128 v[138:141], v129 offset:15232
    ds_read_b128 v[142:145], v129 offset:16256
    ds_read_b128 v[146:149], v172 offset:18432
    s_waitcnt lgkmcnt(6)
    buffer_store_dwordx4 v[122:125], v200, s[56:59], 0 offen nt
    s_waitcnt lgkmcnt(5)
    s_waitcnt lgkmcnt(4)
    v_mfma_f32_16x16x32_bf16 v[150:153], v[32:35], v[130:133], 0
    s_waitcnt lgkmcnt(3)
    v_mfma_f32_16x16x32_bf16 v[150:153], v[32:35], v[134:137], v[150:153]
    s_waitcnt lgkmcnt(1)
    buffer_store_dwordx2 v[126:127], v201, s[56:59], 0 offen nt
    v_mfma_f32_16x16x32_bf16 v[122:125], v[32:35], v[138:141], 0
    s_waitcnt lgkmcnt(0)
    v_or3_b32 v146, v146, v147, v148
    v_or_b32 v146, v146, v149
    v_mfma_f32_16x16x32_bf16 v[122:125], v[32:35], v[142:145], v[122:125]
    v_cmp_gt_i32 s[46:47], 0, v146
    v_mul_f32 v237, 0x3baaaaab, v150
    v_rsq_f32 v237, v237
    s_nop 0
    v_mul_f32 v114, v237, v114
    v_mul_f32 v115, v237, v115
    v_cvt_pk_bf16_f32 v114, v114, v115
    v_mul_f32 v116, v237, v116
    v_mul_f32 v115, 0x3baaaaab, v122
    v_rsq_f32 v115, v115
    v_mul_f32 v117, v237, v117
    v_mul_f32 v154, v115, v154
    v_mul_f32 v155, v115, v155
    v_cvt_pk_bf16_f32 v122, v154, v155
    v_mul_f32 v156, v115, v156
    v_mul_f32 v157, v115, v157
    v_cvt_pk_bf16_f32 v123, v156, v157
    v_mul_f32 v158, v115, v158
    v_mul_f32 v159, v115, v159
    v_cvt_pk_bf16_f32 v124, v158, v159
    v_mul_f32 v160, v115, v160
    v_mul_f32 v161, v115, v161
    v_cvt_pk_bf16_f32 v125, v160, v161
    buffer_store_dwordx4 v[122:125], v170, s[12:15], 0 offen nt
    v_mul_f32 v178, v115, v178
    v_mul_f32 v179, v115, v179
    v_cvt_pk_bf16_f32 v200, v178, v179
    v_mul_f32 v180, v115, v180
    v_mul_f32 v181, v115, v181
    v_cvt_pk_bf16_f32 v201, v180, v181
    v_cvt_pk_bf16_f32 v115, v116, v117
    v_mul_f32 v118, v237, v118
    v_mul_f32 v119, v237, v119
    v_cvt_pk_bf16_f32 v116, v118, v119
    v_mul_f32 v120, v237, v120
    v_mul_f32 v121, v237, v121
    v_cvt_pk_bf16_f32 v117, v120, v121
    ds_write_b128 v173, v[114:117] offset:3072
    v_mul_f32 v174, v237, v174
    v_mul_f32 v175, v237, v175
    v_cvt_pk_bf16_f32 v174, v174, v175
    v_mul_f32 v176, v237, v176
    v_mul_f32 v177, v237, v177
    v_cvt_pk_bf16_f32 v175, v176, v177
    buffer_store_dwordx2 v[200:201], v236, s[12:15], 0 offen nt
    ds_read_b128 v[114:117], v199 offset:3072
    ds_write_b64 v198, v[174:175] offset:4096
    ds_read_b64 v[236:237], v254 offset:4096
    s_waitcnt lgkmcnt(2)
    buffer_store_dwordx4 v[114:117], v234, s[56:59], 0 offen nt
    s_waitcnt lgkmcnt(0)
    buffer_store_dwordx2 v[236:237], v235, s[56:59], 0 offen nt
    s_branch L_end
L_drain:
    ds_read_b128 v[118:121], v2 offset:18432
    ds_read_b128 v[122:125], v2 offset:19456
    s_nop 3
    ds_read_b128 v[134:137], v2 offset:0
    s_mul_i32 s5, s16, 9408
    s_mov_b32 s12, s40
    ds_read_b128 v[138:141], v2 offset:1024
    s_mov_b32 s13, s41
    s_cmp_ge_u32 s18, 2
    s_cselect_b32 s14, s36, 0
    ds_read_b128 v[142:145], v2 offset:2048
    s_add_u32 s5, s5, 104448
    s_and_b32 s6, s2, 7
    s_sub_u32 s6, 0, s6
    ds_read_b128 v[146:149], v2 offset:3072
    s_lshl_b32 s3, s16, 6
    s_lshl_b32 s4, s16, 5
    s_add_u32 s4, s4, 256
    ds_read_b128 v[150:153], v2 offset:4096
    ds_read_b128 v[162:165], v2 offset:5120
    v_bfe_u32 v254, v2, 4, 6
    v_lshrrev_b32 v255, 4, v254
    v_and_b32 v166, 15, v254
    v_lshlrev_b32 v167, 9, v255
    v_lshl_add_u32 v167, v166, 4, v167
    v_add_u32 v167, 149696, v167
    s_waitcnt lgkmcnt(7)
    v_mfma_f32_16x16x32_bf16 v[170:173], v[32:35], v[118:121], 0
    s_waitcnt lgkmcnt(5)
    v_xor_b32 v168, 65536, v2
    v_bfe_u32 v169, v166, 1, 2
    v_mfma_f32_16x16x32_bf16 v[170:173], v[32:35], v[122:125], v[170:173]
    s_waitcnt lgkmcnt(4)
    v_xor_b32 v169, v169, v255
    v_lshl_add_u32 v169, v166, 2, v169
    v_lshl_add_u32 v118, v169, 4, s5
    v_mfma_f32_16x16x32_bf16 v[122:125], a[216:219], v[134:137], 0
    s_waitcnt lgkmcnt(3)
    v_lshl_add_u32 v119, v169, 3, s5
    v_lshl_add_u32 v120, v254, 4, s5
    v_lshl_add_u32 v121, v254, 3, s5
    v_mfma_f32_16x16x32_bf16 v[122:125], a[220:223], v[138:141], v[122:125]
    s_waitcnt lgkmcnt(2)
    v_lshlrev_b32 v169, 2, v169
    v_mul_f32 v170, 0x3baaaaab, v170
    v_rsq_f32 v170, v170
    v_mfma_f32_16x16x32_bf16 v[122:125], a[224:227], v[142:145], v[122:125]
    s_waitcnt lgkmcnt(0)
    ds_permute_b32 v173, v169, v15
    ds_permute_b32 v174, v169, v18
    v_mul_f32 v178, v170, v178
    v_mfma_f32_16x16x32_bf16 v[122:125], a[228:231], v[146:149], v[122:125]
    ds_permute_b32 v175, v169, v16
    ds_permute_b32 v176, v169, v19
    v_mul_f32 v179, v170, v179
    v_mfma_f32_16x16x32_bf16 v[122:125], a[232:235], v[150:153], v[122:125]
    ds_permute_b32 v177, v169, v17
    ds_permute_b32 v182, v169, v20
    v_cvt_pk_bf16_f32 v178, v178, v179
    v_mfma_f32_16x16x32_bf16 v[122:125], a[236:239], v[162:165], v[122:125]
    v_mul_f32 v180, v170, v180
    v_mul_f32 v181, v170, v181
    v_cvt_pk_bf16_f32 v179, v180, v181
    v_mfma_f32_16x16x32_bf16 v[186:189], a[240:243], v[134:137], 0
    v_mul_f32 v198, v170, v198
    v_mul_f32 v199, v170, v199
    v_cvt_pk_bf16_f32 v180, v198, v199
    v_mfma_f32_16x16x32_bf16 v[186:189], a[244:247], v[138:141], v[186:189]
    v_mul_f32 v200, v170, v200
    v_mul_f32 v201, v170, v201
    v_cvt_pk_bf16_f32 v181, v200, v201
    v_mfma_f32_16x16x32_bf16 v[186:189], a[248:251], v[142:145], v[186:189]
    s_waitcnt lgkmcnt(4)
    ds_read_b128 v[190:193], v2 offset:6144
    v_mul_f32 v206, v170, v206
    v_mul_f32 v207, v170, v207
    v_mfma_f32_16x16x32_bf16 v[186:189], a[252:255], v[146:149], v[186:189]
    s_waitcnt lgkmcnt(3)
    ds_read_b128 v[194:197], v2 offset:7168
    v_cvt_pk_bf16_f32 v184, v206, v207
    v_mul_f32 v208, v170, v208
    v_mfma_f32_16x16x32_bf16 v[186:189], v[82:85], v[150:153], v[186:189]
    s_waitcnt lgkmcnt(2)
    ds_read_b128 v[198:201], v2 offset:8192
    v_mul_f32 v209, v170, v209
    v_cvt_pk_bf16_f32 v185, v208, v209
    v_mfma_f32_16x16x32_bf16 v[186:189], v[86:89], v[162:165], v[186:189]
    ds_read_b128 v[202:205], v2 offset:9216
    v_fma_f32 v169, v122, v122, s33
    v_fmac_f32 v169, v123, v123
    v_mfma_f32_16x16x32_bf16 v[206:209], v[90:93], v[134:137], 0
    ds_read_b128 v[134:137], v2 offset:10240
    v_fmac_f32 v169, v124, v124
    v_fmac_f32 v169, v125, v125
    v_mfma_f32_16x16x32_bf16 v[206:209], v[94:97], v[138:141], v[206:209]
    ds_read_b128 v[138:141], v2 offset:11264
    v_fmac_f32 v169, v186, v186
    v_fmac_f32 v169, v187, v187
    v_mfma_f32_16x16x32_bf16 v[206:209], v[98:101], v[142:145], v[206:209]
    s_waitcnt lgkmcnt(5)
    buffer_store_dwordx4 v[178:181], v15, s[12:15], s27 offen nt
    v_fmac_f32 v169, v188, v188
    v_fmac_f32 v169, v189, v189
    v_mul_f32 v183, 0x3baaaaab, v171
    v_mfma_f32_16x16x32_bf16 v[206:209], v[102:105], v[146:149], v[206:209]
    s_waitcnt lgkmcnt(4)
    v_rsq_f32 v183, v183
    v_sub_u32 v170, 0x40800000, v44
    v_mfma_f32_16x16x32_bf16 v[206:209], v[106:109], v[150:153], v[206:209]
    s_waitcnt lgkmcnt(3)
    v_mul_f32 v130, v183, v130
    v_mul_f32 v131, v183, v131
    v_cvt_pk_bf16_f32 v130, v130, v131
    v_mfma_f32_16x16x32_bf16 v[206:209], v[110:113], v[162:165], v[206:209]
    s_waitcnt lgkmcnt(2)
    v_mul_f32 v132, v183, v132
    v_mul_f32 v133, v183, v133
    v_cvt_pk_bf16_f32 v131, v132, v133
    v_mfma_f32_16x16x32_bf16 v[142:145], a[216:219], v[190:193], 0
    s_waitcnt lgkmcnt(1)
    v_mul_f32 v126, v183, v126
    v_mul_f32 v127, v183, v127
    v_fmac_f32 v169, v206, v206
    v_mfma_f32_16x16x32_bf16 v[142:145], a[220:223], v[194:197], v[142:145]
    s_waitcnt lgkmcnt(0)
    v_fmac_f32 v169, v207, v207
    v_fmac_f32 v169, v208, v208
    v_fmac_f32 v169, v209, v209
    v_mfma_f32_16x16x32_bf16 v[142:145], a[224:227], v[198:201], v[142:145]
    v_cvt_pk_bf16_f32 v132, v126, v127
    v_mul_f32 v128, v183, v128
    v_mul_f32 v129, v183, v129
    v_mfma_f32_16x16x32_bf16 v[142:145], a[228:231], v[202:205], v[142:145]
    v_cvt_pk_bf16_f32 v133, v128, v129
    v_mul_f32 v114, v183, v114
    v_mul_f32 v115, v183, v115
    v_mfma_f32_16x16x32_bf16 v[142:145], a[232:235], v[134:137], v[142:145]
    v_cvt_pk_bf16_f32 v114, v114, v115
    v_mul_f32 v116, v183, v116
    v_mul_f32 v117, v183, v117
    v_mfma_f32_16x16x32_bf16 v[142:145], a[236:239], v[138:141], v[142:145]
    v_cvt_pk_bf16_f32 v115, v116, v117
    v_or_b32 v170, v170, v44
    v_lshl_add_u32 v171, s16, 2, v168
    v_mfma_f32_16x16x32_bf16 v[126:129], a[240:243], v[190:193], 0
    ds_write_b32 v171, v170 offset:18432
    v_mul_f32 v183, 0x3baaaaab, v172
    v_mfma_f32_16x16x32_bf16 v[126:129], a[244:247], v[194:197], v[126:129]
    v_rsq_f32 v183, v183
    v_fma_f32 v116, v142, v142, s33
    v_mfma_f32_16x16x32_bf16 v[126:129], a[248:251], v[198:201], v[126:129]
    ds_read_b128 v[146:149], v2 offset:12288
    v_fmac_f32 v116, v143, v143
    v_fmac_f32 v116, v144, v144
    v_mfma_f32_16x16x32_bf16 v[126:129], a[252:255], v[202:205], v[126:129]
    ds_read_b128 v[150:153], v2 offset:13312
    v_fmac_f32 v116, v145, v145
    v_mul_f32 v242, v183, v242
    v_mfma_f32_16x16x32_bf16 v[126:129], v[82:85], v[134:137], v[126:129]
    ds_read_b128 v[162:165], v2 offset:14336
    v_mul_f32 v243, v183, v243
    v_cvt_pk_bf16_f32 v178, v242, v243
    v_mfma_f32_16x16x32_bf16 v[126:129], v[86:89], v[138:141], v[126:129]
    ds_read_b128 v[210:213], v2 offset:15360
    v_mul_f32 v244, v183, v244
    v_mul_f32 v245, v183, v245
    v_mfma_f32_16x16x32_bf16 v[214:217], v[90:93], v[190:193], 0
    ds_read_b128 v[190:193], v2 offset:16384
    v_cvt_pk_bf16_f32 v179, v244, v245
    v_mul_f32 v158, v183, v158
    v_mfma_f32_16x16x32_bf16 v[214:217], v[94:97], v[194:197], v[214:217]
    ds_read_b128 v[194:197], v2 offset:17408
    v_fmac_f32 v116, v126, v126
    v_fmac_f32 v116, v127, v127
    v_mfma_f32_16x16x32_bf16 v[214:217], v[98:101], v[198:201], v[214:217]
    s_waitcnt lgkmcnt(5)
    buffer_store_dwordx2 v[184:185], v18, s[12:15], s27 offen nt
    v_fmac_f32 v116, v128, v128
    v_mfma_f32_16x16x32_bf16 v[214:217], v[102:105], v[202:205], v[214:217]
    s_waitcnt lgkmcnt(4)
    v_fmac_f32 v116, v129, v129
    v_mul_f32 v159, v183, v159
    v_cvt_pk_bf16_f32 v180, v158, v159
    v_mfma_f32_16x16x32_bf16 v[214:217], v[106:109], v[134:137], v[214:217]
    s_waitcnt lgkmcnt(3)
    v_mul_f32 v160, v183, v160
    v_mul_f32 v161, v183, v161
    v_cvt_pk_bf16_f32 v181, v160, v161
    v_mfma_f32_16x16x32_bf16 v[214:217], v[110:113], v[138:141], v[214:217]
    s_waitcnt lgkmcnt(2)
    ds_write_b128 v118, v[178:181] offset:3072
    v_mfma_f32_16x16x32_bf16 v[134:137], a[216:219], v[146:149], 0
    s_waitcnt lgkmcnt(2)
    v_mul_f32 v154, v183, v154
    v_mul_f32 v155, v183, v155
    v_cvt_pk_bf16_f32 v154, v154, v155
    v_mfma_f32_16x16x32_bf16 v[134:137], a[220:223], v[150:153], v[134:137]
    s_waitcnt lgkmcnt(1)
    v_fmac_f32 v116, v214, v214
    v_fmac_f32 v116, v215, v215
    v_fmac_f32 v116, v216, v216
    v_mfma_f32_16x16x32_bf16 v[134:137], a[224:227], v[162:165], v[134:137]
    ds_read_b128 v[138:141], v120 offset:3072
    v_fmac_f32 v116, v217, v217
    v_cvt_pk_bf16_f32 v184, v169, v116
    v_mfma_f32_16x16x32_bf16 v[134:137], a[228:231], v[210:213], v[134:137]
    v_cvt_pk_bf16_f32 v185, v116, v116
    v_mul_f32 v156, v183, v156
    v_mul_f32 v157, v183, v157
    v_mfma_f32_16x16x32_bf16 v[134:137], a[232:235], v[190:193], v[134:137]
    ds_write_b64 v4, v[184:185] offset:0
    v_mfma_f32_16x16x32_bf16 v[134:137], a[236:239], v[194:197], v[134:137]
    v_cvt_pk_bf16_f32 v155, v156, v157
    v_mov_b32 v169, 0x40000000
    v_lshrrev_b32 v116, 2, v254
    v_mfma_f32_16x16x32_bf16 v[158:161], a[240:243], v[146:149], 0
    ds_write_b64 v119, v[154:155] offset:4096
    v_mfma_f32_16x16x32_bf16 v[158:161], a[244:247], v[150:153], v[158:161]
    v_lshrrev_b32 v117, 3, v254
    v_xor_b32 v117, v117, v254
    v_fma_f32 v254, v134, v134, s33
    v_mfma_f32_16x16x32_bf16 v[158:161], a[248:251], v[162:165], v[158:161]
    s_waitcnt lgkmcnt(2)
    ds_read_b128 v[154:157], v167 offset:0
    ds_read_b64 v[170:171], v121 offset:4096
    v_fmac_f32 v254, v135, v135
    v_mfma_f32_16x16x32_bf16 v[158:161], a[252:255], v[210:213], v[158:161]
    ds_read_b128 v[178:181], v167 offset:2048
    v_fmac_f32 v254, v136, v136
    v_fmac_f32 v254, v137, v137
    v_mfma_f32_16x16x32_bf16 v[158:161], v[82:85], v[190:193], v[158:161]
    s_waitcnt lgkmcnt(4)
    ds_read_b128 v[198:201], v167 offset:4096
    v_and_b32 v117, 3, v117
    v_add_u32 v116, 0, v116
    v_mfma_f32_16x16x32_bf16 v[158:161], v[86:89], v[194:197], v[158:161]
    s_barrier
    ds_read_b128 v[202:205], v168 offset:0
    ds_read_b128 v[218:221], v168 offset:1024
    v_mul_u32_u24 v172, s20, v116
    v_mfma_f32_16x16x32_bf16 v[222:225], v[90:93], v[146:149], 0
    ds_read_b128 v[146:149], v167 offset:6144
    ds_read_b128 v[226:229], v167 offset:8192
    v_add_u32 v172, s38, v172
    v_mfma_f32_16x16x32_bf16 v[222:225], v[94:97], v[150:153], v[222:225]
    ds_read_b128 v[150:153], v167 offset:10240
    v_fmac_f32 v254, v158, v158
    v_fmac_f32 v254, v159, v159
    v_mfma_f32_16x16x32_bf16 v[222:225], v[98:101], v[162:165], v[222:225]
    s_waitcnt lgkmcnt(7)
    buffer_store_dwordx4 v[130:133], v16, s[12:15], s27 offen nt
    ds_read_b128 v[162:165], v168 offset:18432
    v_fmac_f32 v254, v160, v160
    v_fmac_f32 v254, v161, v161
    v_mfma_f32_16x16x32_bf16 v[222:225], v[102:105], v[210:213], v[222:225]
    s_waitcnt lgkmcnt(7)
    v_mul_u32_u24 v183, 911, v172
    v_lshrrev_b32 v183, 16, v183
    v_mul_u32_u24 v183, s22, v183
    v_mfma_f32_16x16x32_bf16 v[222:225], v[106:109], v[190:193], v[222:225]
    s_waitcnt lgkmcnt(6)
    v_mad_u32_u24 v183, v116, s21, v183
    v_bfe_u32 v172, s70, v116, 1
    v_cmp_ne_u32 vcc, 0, v172
    v_mfma_f32_16x16x32_bf16 v[222:225], v[110:113], v[194:197], v[222:225]
    s_waitcnt lgkmcnt(4)
    v_add_u32 v116, s7, v183
    v_cndmask_b32 v116, v169, v116, vcc
    v_mfma_f32_16x16x32_bf16 v[130:133], v[32:35], v[202:205], 0
    s_waitcnt lgkmcnt(2)
    v_lshl_add_u32 v172, v117, 4, v116
    v_add_u32 v172, s3, v172
    v_mfma_f32_16x16x32_bf16 v[130:133], v[32:35], v[218:221], v[130:133]
    s_waitcnt lgkmcnt(1)
    v_fmac_f32 v254, v222, v222
    v_fmac_f32 v254, v223, v223
    v_fmac_f32 v254, v224, v224
    v_mfma_f32_16x16x32_bf16 v[190:193], a[216:219], v[154:157], 0
    v_fmac_f32 v254, v225, v225
    v_cvt_pk_bf16_f32 v184, v254, v254
    v_cvt_pk_bf16_f32 v185, v254, v254
    v_mfma_f32_16x16x32_bf16 v[190:193], a[220:223], v[178:181], v[190:193]
    s_waitcnt lgkmcnt(0)
    ds_write_b64 v4, v[184:185] offset:2048
    v_mfma_f32_16x16x32_bf16 v[190:193], a[224:227], v[198:201], v[190:193]
    v_lshl_add_u32 v254, v117, 3, v116
    v_add_u32 v254, s4, v254
    v_add_u32 v166, 16, v166
    v_mfma_f32_16x16x32_bf16 v[190:193], a[228:231], v[146:149], v[190:193]
    v_min_u32 v116, 20, v166
    v_add_u32 v132, 12, v166
    v_lshrrev_b32 v132, 5, v132
    v_mfma_f32_16x16x32_bf16 v[190:193], a[232:235], v[226:229], v[190:193]
    v_sub_u32 v133, v166, v116
    v_mad_i32_i24 v133, v132, s6, v133
    v_mul_u32_u24 v117, s20, v116
    v_mfma_f32_16x16x32_bf16 v[190:193], a[236:239], v[150:153], v[190:193]
    v_add3_u32 v117, v117, v133, s38
    v_mul_u32_u24 v132, 911, v117
    v_lshrrev_b32 v132, 16, v132
    v_mfma_f32_16x16x32_bf16 v[194:197], a[240:243], v[154:157], 0
    v_mul_u32_u24 v132, s22, v132
    v_mad_u32_u24 v132, v116, s21, v132
    v_bfe_u32 v117, s70, v166, 1
    v_mfma_f32_16x16x32_bf16 v[194:197], a[244:247], v[178:181], v[194:197]
    buffer_store_dwordx2 v[114:115], v19, s[12:15], s27 offen nt
    v_fma_f32 v166, v190, v190, s33
    v_mfma_f32_16x16x32_bf16 v[194:197], a[248:251], v[198:201], v[194:197]
    ds_read_b128 v[202:205], v167 offset:256
    v_fmac_f32 v166, v191, v191
    v_fmac_f32 v166, v192, v192
    v_mfma_f32_16x16x32_bf16 v[194:197], a[252:255], v[146:149], v[194:197]
    ds_read_b128 v[210:213], v167 offset:2304
    v_fmac_f32 v166, v193, v193
    v_cmp_ne_u32 vcc, 0, v117
    v_mfma_f32_16x16x32_bf16 v[194:197], v[82:85], v[226:229], v[194:197]
    ds_read_b128 v[114:117], v167 offset:4352
    v_mul_i32_i24 v133, 2688, v133
    v_add3_u32 v132, v132, v133, s7
    v_mfma_f32_16x16x32_bf16 v[194:197], v[86:89], v[150:153], v[194:197]
    ds_read_b128 v[218:221], v167 offset:6400
    v_cndmask_b32 v132, v169, v132, vcc
    v_lshl_add_u32 v169, v255, 4, v132
    v_mfma_f32_16x16x32_bf16 v[230:233], v[90:93], v[154:157], 0
    ds_read_b128 v[154:157], v167 offset:8448
    v_add_u32 v169, s3, v169
    v_lshl_add_u32 v255, v255, 3, v132
    v_mfma_f32_16x16x32_bf16 v[230:233], v[94:97], v[178:181], v[230:233]
    ds_read_b128 v[178:181], v167 offset:10496
    v_fmac_f32 v166, v194, v194
    v_fmac_f32 v166, v195, v195
    v_mfma_f32_16x16x32_bf16 v[230:233], v[98:101], v[198:201], v[230:233]
    s_waitcnt lgkmcnt(5)
    v_fmac_f32 v166, v196, v196
    v_fmac_f32 v166, v197, v197
    v_add_u32 v255, s4, v255
    v_mfma_f32_16x16x32_bf16 v[230:233], v[102:105], v[146:149], v[230:233]
    s_waitcnt lgkmcnt(4)
    v_mul_f32 v167, 0x3baaaaab, v130
    v_mul_f32 v183, 0x3baaaaab, v131
    v_rsq_f32 v167, v167
    v_mfma_f32_16x16x32_bf16 v[230:233], v[106:109], v[226:229], v[230:233]
    s_waitcnt lgkmcnt(3)
    v_mul_f32 v122, v167, v122
    v_mul_f32 v123, v167, v123
    v_cvt_pk_bf16_f32 v122, v122, v123
    v_mfma_f32_16x16x32_bf16 v[230:233], v[110:113], v[150:153], v[230:233]
    s_waitcnt lgkmcnt(2)
    v_mul_f32 v124, v167, v124
    v_mul_f32 v125, v167, v125
    v_cvt_pk_bf16_f32 v123, v124, v125
    v_mfma_f32_16x16x32_bf16 v[130:133], a[216:219], v[202:205], 0
    s_waitcnt lgkmcnt(1)
    v_mul_f32 v186, v167, v186
    v_mul_f32 v187, v167, v187
    v_fmac_f32 v166, v230, v230
    v_mfma_f32_16x16x32_bf16 v[130:133], a[220:223], v[210:213], v[130:133]
    s_waitcnt lgkmcnt(0)
    v_fmac_f32 v166, v231, v231
    v_fmac_f32 v166, v232, v232
    v_fmac_f32 v166, v233, v233
    v_mfma_f32_16x16x32_bf16 v[130:133], a[224:227], v[114:117], v[130:133]
    buffer_store_dwordx4 v[138:141], v177, s[12:15], s27 offen nt
    v_cvt_pk_bf16_f32 v184, v166, v166
    v_cvt_pk_bf16_f32 v185, v166, v166
    v_cvt_pk_bf16_f32 v124, v186, v187
    v_mfma_f32_16x16x32_bf16 v[130:133], a[228:231], v[218:221], v[130:133]
    ds_write_b64 v4, v[184:185] offset:4096
    v_mfma_f32_16x16x32_bf16 v[130:133], a[232:235], v[154:157], v[130:133]
    v_mul_f32 v188, v167, v188
    v_mul_f32 v189, v167, v189
    v_cvt_pk_bf16_f32 v125, v188, v189
    v_mfma_f32_16x16x32_bf16 v[130:133], a[236:239], v[178:181], v[130:133]
    ds_write_b128 v118, v[122:125] offset:4608
    v_mfma_f32_16x16x32_bf16 v[122:125], a[240:243], v[202:205], 0
    buffer_store_dwordx2 v[170:171], v182, s[12:15], s27 offen nt
    v_mul_f32 v206, v167, v206
    v_mfma_f32_16x16x32_bf16 v[122:125], a[244:247], v[210:213], v[122:125]
    s_mov_b32 s14, s36
    v_mul_f32 v207, v167, v207
    v_cvt_pk_bf16_f32 v166, v206, v207
    v_fma_f32 v184, v130, v130, s33
    v_mfma_f32_16x16x32_bf16 v[122:125], a[248:251], v[114:117], v[122:125]
    ds_read_b128 v[138:141], v120 offset:4608
    v_fmac_f32 v184, v131, v131
    v_fmac_f32 v184, v132, v132
    v_mfma_f32_16x16x32_bf16 v[122:125], a[252:255], v[218:221], v[122:125]
    s_waitcnt lgkmcnt(2)
    v_fmac_f32 v184, v133, v133
    v_mul_f32 v208, v167, v208
    v_mul_f32 v209, v167, v209
    v_mfma_f32_16x16x32_bf16 v[122:125], v[82:85], v[154:157], v[122:125]
    s_barrier
    ds_read_b128 v[146:149], v168 offset:2048
    ds_read_b128 v[150:153], v168 offset:3072
    v_cvt_pk_bf16_f32 v167, v208, v209
    v_mfma_f32_16x16x32_bf16 v[122:125], v[86:89], v[178:181], v[122:125]
    ds_read_b128 v[186:189], v168 offset:4096
    ds_read_b128 v[198:201], v168 offset:5120
    v_rsq_f32 v183, v183
    v_mfma_f32_16x16x32_bf16 v[206:209], v[90:93], v[202:205], 0
    ds_write_b64 v119, v[166:167] offset:5632
    v_mfma_f32_16x16x32_bf16 v[206:209], v[94:97], v[210:213], v[206:209]
    v_mul_f32 v142, v183, v142
    v_mul_f32 v143, v183, v143
    v_fmac_f32 v184, v122, v122
    v_mfma_f32_16x16x32_bf16 v[206:209], v[98:101], v[114:117], v[206:209]
    s_waitcnt lgkmcnt(5)
    buffer_store_dwordx4 v[138:141], v173, s[12:15], s26 offen nt
    ds_read_b64 v[166:167], v121 offset:5632
    v_fmac_f32 v184, v123, v123
    v_fmac_f32 v184, v124, v124
    v_mfma_f32_16x16x32_bf16 v[206:209], v[102:105], v[218:221], v[206:209]
    v_fmac_f32 v184, v125, v125
    v_cvt_pk_bf16_f32 v114, v142, v143
    v_mul_f32 v144, v183, v144
    v_mfma_f32_16x16x32_bf16 v[206:209], v[106:109], v[154:157], v[206:209]
    s_waitcnt lgkmcnt(4)
    v_mul_f32 v145, v183, v145
    v_cvt_pk_bf16_f32 v115, v144, v145
    v_mfma_f32_16x16x32_bf16 v[138:141], v[32:35], v[146:149], 0
    s_waitcnt lgkmcnt(2)
    v_mul_f32 v126, v183, v126
    v_mul_f32 v127, v183, v127
    v_mfma_f32_16x16x32_bf16 v[138:141], v[32:35], v[150:153], v[138:141]
    v_cvt_pk_bf16_f32 v116, v126, v127
    v_mul_f32 v128, v183, v128
    v_mfma_f32_16x16x32_bf16 v[142:145], v[32:35], v[186:189], 0
    v_mul_f32 v129, v183, v129
    v_cvt_pk_bf16_f32 v117, v128, v129
    v_mfma_f32_16x16x32_bf16 v[142:145], v[32:35], v[198:201], v[142:145]
    ds_write_b128 v118, v[114:117] offset:6144
    v_mfma_f32_16x16x32_bf16 v[206:209], v[110:113], v[178:181], v[206:209]
    s_waitcnt lgkmcnt(1)
    buffer_store_dwordx2 v[166:167], v174, s[12:15], s26 offen nt
    v_mul_f32 v214, v183, v214
    v_mul_f32 v215, v183, v215
    v_cvt_pk_bf16_f32 v166, v214, v215
    ds_read_b128 v[114:117], v120 offset:6144
    v_mul_f32 v216, v183, v216
    v_mul_f32 v217, v183, v217
    v_fmac_f32 v184, v206, v206
    v_fmac_f32 v184, v207, v207
    v_fmac_f32 v184, v208, v208
    v_fmac_f32 v184, v209, v209
    v_cvt_pk_bf16_f32 v214, v184, v184
    v_cvt_pk_bf16_f32 v215, v184, v184
    ds_write_b64 v4, v[214:215] offset:6144
    v_cvt_pk_bf16_f32 v167, v216, v217
    v_mul_f32 v174, 0x3baaaaab, v138
    v_rsq_f32 v174, v174
    ds_write_b64 v119, v[166:167] offset:7168
    v_mul_f32 v134, v174, v134
    v_mul_f32 v135, v174, v135
    v_cvt_pk_bf16_f32 v126, v134, v135
    ds_read_b64 v[166:167], v121 offset:7168
    s_waitcnt lgkmcnt(3)
    buffer_store_dwordx4 v[114:117], v175, s[12:15], s26 offen nt
    v_mul_f32 v136, v174, v136
    v_mul_f32 v137, v174, v137
    v_cvt_pk_bf16_f32 v127, v136, v137
    v_mul_f32 v158, v174, v158
    v_mul_f32 v159, v174, v159
    v_cvt_pk_bf16_f32 v128, v158, v159
    v_mul_f32 v160, v174, v160
    s_waitcnt lgkmcnt(2)
    s_barrier
    ds_read_b128 v[114:117], v168 offset:6144
    ds_read_b128 v[134:137], v168 offset:7168
    v_mul_f32 v161, v174, v161
    v_cvt_pk_bf16_f32 v129, v160, v161
    ds_write_b128 v118, v[126:129] offset:0
    v_mul_f32 v222, v174, v222
    v_mul_f32 v223, v174, v223
    v_cvt_pk_bf16_f32 v222, v222, v223
    v_mul_f32 v224, v174, v224
    s_waitcnt lgkmcnt(3)
    buffer_store_dwordx2 v[166:167], v176, s[12:15], s26 offen nt
    ds_read_b128 v[126:129], v120 offset:0
    v_mul_f32 v225, v174, v225
    v_cvt_pk_bf16_f32 v223, v224, v225
    ds_write_b64 v119, v[222:223] offset:1024
    s_waitcnt lgkmcnt(4)
    v_mfma_f32_16x16x32_bf16 v[138:141], v[32:35], v[114:117], 0
    s_waitcnt lgkmcnt(3)
    v_mul_f32 v166, 0x3baaaaab, v142
    v_or3_b32 v162, v162, v163, v164
    v_mfma_f32_16x16x32_bf16 v[138:141], v[32:35], v[134:137], v[138:141]
    ds_read_b64 v[170:171], v121 offset:1024
    v_rsq_f32 v166, v166
    v_or_b32 v162, v162, v165
    v_mul_f32 v190, v166, v190
    v_mul_f32 v191, v166, v191
    v_cvt_pk_bf16_f32 v114, v190, v191
    v_mul_f32 v192, v166, v192
    v_mul_f32 v193, v166, v193
    v_cvt_pk_bf16_f32 v115, v192, v193
    v_mul_f32 v194, v166, v194
    v_mul_f32 v195, v166, v195
    v_cvt_pk_bf16_f32 v116, v194, v195
    s_waitcnt lgkmcnt(2)
    buffer_store_dwordx4 v[126:129], v177, s[12:15], s26 offen nt
    v_mul_f32 v196, v166, v196
    v_mul_f32 v197, v166, v197
    v_cvt_pk_bf16_f32 v117, v196, v197
    ds_write_b128 v118, v[114:117] offset:1536
    v_mul_f32 v230, v166, v230
    s_waitcnt lgkmcnt(1)
    v_mul_f32 v231, v166, v231
    v_cvt_pk_bf16_f32 v230, v230, v231
    v_mul_f32 v232, v166, v232
    v_mul_f32 v233, v166, v233
    buffer_store_dwordx2 v[170:171], v182, s[12:15], s26 offen nt
    ds_read_b128 v[114:117], v120 offset:1536
    v_cvt_pk_bf16_f32 v231, v232, v233
    ds_write_b64 v119, v[230:231] offset:2560
    v_mul_f32 v163, 0x3baaaaab, v138
    v_rsq_f32 v163, v163
    ds_read_b64 v[164:165], v121 offset:2560
    v_mul_f32 v130, v163, v130
    v_mul_f32 v131, v163, v131
    v_cvt_pk_bf16_f32 v118, v130, v131
    v_mul_f32 v132, v163, v132
    v_mul_f32 v133, v163, v133
    v_cvt_pk_bf16_f32 v119, v132, v133
    v_mul_f32 v122, v163, v122
    v_mul_f32 v123, v163, v123
    v_cvt_pk_bf16_f32 v120, v122, v123
    v_mul_f32 v124, v163, v124
    v_mul_f32 v125, v163, v125
    v_cvt_pk_bf16_f32 v121, v124, v125
    buffer_store_dwordx4 v[118:121], v169, s[12:15], 0 offen nt
    s_waitcnt lgkmcnt(2)
    v_mul_f32 v206, v163, v206
    v_mul_f32 v207, v163, v207
    v_cvt_pk_bf16_f32 v170, v206, v207
    v_mul_f32 v208, v163, v208
    v_mul_f32 v209, v163, v209
    v_cvt_pk_bf16_f32 v171, v208, v209
    v_cmp_gt_i32 s[46:47], 0, v162
    s_waitcnt lgkmcnt(0)
    buffer_store_dwordx4 v[114:117], v172, s[12:15], 0 offen nt
    buffer_store_dwordx2 v[164:165], v254, s[12:15], 0 offen nt
    buffer_store_dwordx2 v[170:171], v255, s[12:15], 0 offen nt
    s_branch L_end
.section .rodata,"a"
.p2align 6
.amdhsa_kernel standalone__window_attn_swin_v2__vision_kernel
  .amdhsa_next_free_vgpr 512
  .amdhsa_next_free_sgpr 102
  .amdhsa_accum_offset 256
  .amdhsa_group_segment_fixed_size 0
  .amdhsa_kernarg_size 96
  .amdhsa_user_sgpr_count 2
  .amdhsa_user_sgpr_kernarg_segment_ptr 1
  .amdhsa_system_sgpr_workgroup_id_x 1
  .amdhsa_float_denorm_mode_32 3
.end_amdhsa_kernel
```

```asm
; @launch grid=(256,1,1) block=(256,1,1) lds=163840
.amdgcn_target "amdgcn-amd-amdhsa--gfx950"
.text
.globl standalone__window_attn_swin_v2__vision_kernel
.p2align 12
.p2align 8
.type standalone__window_attn_swin_v2__vision_kernel,@function
standalone__window_attn_swin_v2__vision_kernel:
    s_mov_b32 s44, 0
L_again:
    s_load_dwordx16 s[76:91], s[0:1], 0
    v_readfirstlane_b32 s16, v0
    s_cmp_ge_u32 s2, 256
    s_cbranch_scc1 L_done
    s_lshr_b32 s16, s16, 6
    s_cbranch_scc1 L_nopf
    s_getpc_b64 s[96:97]
    s_bfe_u32 s3, s2, 0x30003
    s_mul_i32 s3, s3, 44
    v_cmp_gt_u32 vcc, 20, v0
    v_add_u32 v114, s3, v0
    v_mov_b32 v115, 0
    v_cndmask_b32 v114, v114, v0, vcc
    v_lshlrev_b32 v114, 7, v114
    v_lshl_add_u64 v[114:115], s[96:97], 0, v[114:115]
    global_load_dword a255, v[114:115], off offset:992
L_nopf:
    s_max_u32 s3, s2, s44
    s_cmp_ge_u32 s3, 247
    s_cbranch_scc1 L_edge
    v_mov_b32 v114, v0
    v_mov_b32 v115, 0x40000000
    v_and_b32 v254, 63, v0
    s_bfe_u32 s3, s2, 0x50003
    s_lshl_b32 s4, s16, 3
    s_lshr_b32 s98, 0x06143a01, s4
    s_and_b32 s98, s98, 0xff
    s_mul_i32 s3, s3, s98
    s_sub_u32 s98, s98, 1
    s_lshr_b32 s4, 0x0048d800, s4
    s_and_b32 s4, s4, 0xff
    s_lshl_b32 s4, s4, 3
    s_max_u32 s4, s4, 6
    s_sub_u32 s4, s4, s98
    s_sub_u32 s4, s4, 1
    s_min_u32 s3, s3, s4
    v_min_u32 v126, s98, v254
    v_add_lshl_u32 v126, v126, s3, 7
    v_mov_b32 v127, 0
    v_lshrrev_b32 v255, 4, v254
    v_and_b32 v128, 15, v254
    s_mov_b32 s10, 100270464
    s_mov_b32 s11, 0x00020000
    s_mov_b32 s50, 36096
    s_mov_b32 s51, 0x00020000
    s_mul_i32 s3, s16, 96
    v_lshl_add_u32 v129, v254, 4, s3
    v_mul_u32_u24 v130, 171, v254
    v_lshrrev_b32 v130, 10, v130
    v_lshrrev_b32 v131, 1, v130
    v_xor_b32 v131, v131, v130
    v_and_b32 v131, 4, v131
    v_mul_u32_u24 v131, 3, v131
    v_xor_b32 v131, v131, v130
    v_mul_u32_u24 v131, 1152, v131
    v_mul_u32_u24 v132, 96, v130
    v_sub_u32 v131, v131, v132
    v_add_u32 v132, v129, v131
    v_add_u32 v131, 64, v254
    v_mul_u32_u24 v131, 171, v131
    v_lshrrev_b32 v131, 10, v131
    v_lshrrev_b32 v133, 1, v131
    v_xor_b32 v133, v133, v131
    v_and_b32 v133, 4, v133
    v_mul_u32_u24 v133, 3, v133
    v_xor_b32 v133, v133, v131
    v_mul_u32_u24 v133, 1152, v133
    v_mul_u32_u24 v150, 96, v131
    v_sub_u32 v133, v133, v150
    v_add_u32 v150, v129, v133
    v_add_u32 v133, 128, v254
    v_mul_u32_u24 v133, 171, v133
    v_lshrrev_b32 v133, 10, v133
    v_lshrrev_b32 v151, 1, v133
    v_xor_b32 v151, v151, v133
    v_and_b32 v151, 4, v151
    v_mul_u32_u24 v151, 3, v151
    v_xor_b32 v151, v151, v133
    v_mul_u32_u24 v151, 1152, v151
    v_mul_u32_u24 v152, 96, v133
    v_sub_u32 v151, v151, v152
    v_add_u32 v152, v129, v151
    s_mul_i32 s68, s16, 6144
    s_add_u32 s69, s68, 65536
    s_cmp_eq_u32 s16, 3
    s_cselect_b32 s68, 149696, s68
    s_cselect_b32 s69, 155840, s69
    s_waitcnt lgkmcnt(0)
    s_cmp_eq_u32 s16, 2
    s_cselect_b64 s[98:99], s[80:81], s[78:79]
    s_cmp_eq_u32 s16, 3
    s_cselect_b64 s[98:99], s[88:89], s[98:99]
    s_mov_b64 s[8:9], s[76:77]
    v_lshl_add_u64 v[126:127], s[98:99], 0, v[126:127]
    s_cmp_eq_u32 s16, 2
    s_cselect_b64 s[98:99], s[84:85], s[82:83]
    s_cmp_eq_u32 s16, 3
    s_cselect_b64 s[98:99], s[86:87], s[98:99]
    v_writelane_b32 v126, s98, 63
    v_writelane_b32 v127, s99, 63
    s_cmp_eq_u32 s16, 0
    s_cbranch_scc1 L_nowu
    global_load_dword a254, v[126:127], off
L_nowu:
    s_mov_b64 s[48:49], s[78:79]
    s_mov_b64 s[52:53], s[80:81]
    s_mov_b64 s[60:61], s[84:85]
    s_mov_b64 s[64:65], s[86:87]
    s_mov_b64 s[56:57], s[88:89]
    s_mov_b64 s[46:47], s[82:83]
    s_load_dwordx4 s[40:43], s[0:1], 72
    s_add_u32 s48, s48, 384
    s_addc_u32 s49, s49, 0
    s_add_u32 m0, s68, 0
    v_lshlrev_b32 v151, 1, v255
    s_mov_b32 s54, 12288
    s_mov_b32 s55, 0x00020000
    s_mov_b32 s62, 64
    s_mov_b32 s63, 0x00020000
    s_mov_b32 s66, 128
    s_mov_b32 s67, 0x00020000
    s_mov_b32 s58, 676
    s_mov_b32 s59, 0x00020000
    s_mov_b32 s14, 0
    s_mov_b32 s15, 0x00020000
    s_mul_i32 s90, s16, 16
    v_mov_b32 v117, 0
    v_cmp_lt_u32 s[92:93], 7, v128
    v_mov_b32 v127, 0
    v_mov_b32 v129, 0
    v_mov_b32 v119, 0
    v_lshlrev_b32 v153, 1, v254
    v_mul_u32_u24 v126, 12, v128
    s_mul_i32 s71, s16, 192
    v_add_u32 v126, s71, v126
    v_lshlrev_b32 v120, 5, v255
    s_mul_i32 s72, s16, 9408
    s_add_u32 s72, s72, 104448
    s_mul_i32 s73, s16, 7616
    s_add_u32 s73, s73, 38912
    s_cmp_eq_u32 s16, 3
    s_cselect_b32 s73, 142080, s73
    s_mov_b32 s70, 193536
    s_mov_b32 s36, 100270464
    s_mov_b32 s22, 1180032
    s_mul_i32 s3, s2, 911
    s_lshr_b32 s3, s3, 16
    s_mul_i32 s35, s3, 72
    s_sub_u32 s38, s2, s35
    s_mul_i32 s3, s3, 1373568
    s_mul_i32 s35, s38, 2688
    s_add_u32 s3, s3, s35
    s_add_u32 s25, s3, 589824
    s_add_u32 s7, s3, 1769472
    s_mov_b32 s20, 31
    s_mov_b32 s21, 4204032
    s_mov_b32 s17, 20
    s_cmp_lt_u32 s2, 240
    s_cselect_b32 s45, 28, 24
    s_bfm_b32 s34, s45, 0
    s_and_b32 s4, s2, 7
    s_sub_u32 s4, 0, s4
    s_lshl_b32 s28, s16, 10
    s_add_u32 s28, s28, 20480
    s_mov_b32 s76, 0x3f80
    s_mul_i32 s79, s16, 64
    s_mul_i32 s80, s16, 32
    s_add_u32 s80, s80, 256
    s_mul_i32 s81, s16, 768
    s_add_u32 s81, s81, 98304
    s_mov_b32 s82, -24
    s_lshr_b32 s83, s16, 1
    s_and_b32 s84, s16, 1
    s_lshl_b32 s84, s84, 3
    s_lshl_b32 s85, s83, 10
    s_add_u32 s85, s85, s84
    s_lshl_b32 s83, s83, 11
    s_add_u32 s83, s83, s84
    s_add_u32 s83, s83, 157888
    s_mul_i32 s86, s16, 2048
    s_add_u32 s86, s86, 149696
    s_mul_i32 s87, s16, 128
    s_add_u32 s87, s87, 61760
    s_mov_b32 s32, 0x2a8cbccc
    s_mov_b32 s33, 0x38fba882
    s_add_u32 s75, s28, 16384
    s_cmp_lt_u32 s16, 2
    s_cselect_b32 s29, s75, 161984
    s_cselect_b32 s30, 65536, 0
    s_xor_b32 s74, s29, s30
    s_mul_i32 s77, s16, 64
    s_mul_i32 s78, s16, 32
    s_add_u32 s78, s78, 192
    buffer_load_dwordx4 v132, s[48:51], 0 offen lds
    v_mul_u32_u24 v116, 2731, v114
    v_bfe_u32 v118, v116, 17, 3
    v_lshrrev_b32 v116, 16, v116
    buffer_load_dwordx4 v150, s[48:51], 0 offen offset:1024 lds
    v_xor_b32 v121, v118, v114
    v_mul_u32_u24 v118, 37, v116
    v_lshrrev_b32 v118, 8, v118
    buffer_load_dwordx4 v152, s[48:51], 0 offen offset:2048 lds
    s_add_u32 m0, s28, 65536
    s_add_u32 s48, s48, 36864
    s_addc_u32 s49, s49, 0
    v_lshlrev_b32 v121, 4, v121
    v_mad_u32_u24 v10, v118, s70, v121
    v_mul_u32_u24 v118, s20, v116
    v_add_u32 v118, s38, v118
    v_mul_u32_u24 v122, 911, v118
    v_lshrrev_b32 v122, 16, v122
    v_mul_u32_u24 v122, s22, v122
    v_mad_u32_u24 v122, v116, s21, v122
    v_bfe_u32 v118, s34, v116, 1
    v_cmp_ne_u32 vcc, 0, v118
    v_add_u32 v118, s7, v122
    v_mul_u32_u24 v116, 384, v116
    v_cndmask_b32 v118, v115, v118, vcc
    v_sub_u32 v116, v121, v116
    v_add_u32 v118, v118, v116
    buffer_load_dwordx4 v118, s[8:11], 0 offen nt lds
    s_add_u32 m0, s28, 69632
    v_add_u32 v116, 256, v114
    v_mul_u32_u24 v118, 2731, v116
    v_bfe_u32 v121, v118, 17, 3
    v_lshrrev_b32 v118, 16, v118
    v_xor_b32 v116, v121, v116
    v_mul_u32_u24 v121, 37, v118
    v_lshrrev_b32 v121, 8, v121
    v_lshlrev_b32 v116, 4, v116
    v_mad_u32_u24 v11, v121, s70, v116
    v_min_u32 v121, 20, v118
    v_add_u32 v122, 12, v118
    v_lshrrev_b32 v122, 5, v122
    v_sub_u32 v123, v118, v121
    v_mad_i32_i24 v123, v122, s4, v123
    v_mul_u32_u24 v124, s20, v121
    v_add3_u32 v124, v124, v123, s38
    v_mul_u32_u24 v122, 911, v124
    v_lshrrev_b32 v122, 16, v122
    v_mul_u32_u24 v122, s22, v122
    v_mad_u32_u24 v122, v121, s21, v122
    v_bfe_u32 v124, s34, v118, 1
    v_cmp_ne_u32 vcc, 0, v124
    v_mul_i32_i24 v123, 2688, v123
    v_add3_u32 v121, v122, v123, s7
    v_cndmask_b32 v121, v115, v121, vcc
    v_mul_u32_u24 v118, 384, v118
    v_sub_u32 v118, v116, v118
    v_add_u32 v121, v121, v118
    buffer_load_dwordx4 v121, s[8:11], 0 offen lds
    s_add_u32 m0, s28, 73728
    v_add_u32 v116, 512, v114
    v_mul_u32_u24 v118, 2731, v116
    v_bfe_u32 v121, v118, 17, 3
    v_lshrrev_b32 v118, 16, v118
    v_xor_b32 v116, v121, v116
    v_mul_u32_u24 v121, 37, v118
    v_lshrrev_b32 v121, 8, v121
    v_lshlrev_b32 v116, 4, v116
    v_mad_u32_u24 v12, v121, s70, v116
    v_min_u32 v121, 20, v118
    v_add_u32 v122, 12, v118
    v_lshrrev_b32 v122, 5, v122
    v_sub_u32 v123, v118, v121
    v_mad_i32_i24 v123, v122, s4, v123
    v_mul_u32_u24 v124, s20, v121
    v_add3_u32 v124, v124, v123, s38
    v_mul_u32_u24 v122, 911, v124
    v_lshrrev_b32 v122, 16, v122
    v_mul_u32_u24 v122, s22, v122
    v_mad_u32_u24 v122, v121, s21, v122
    v_bfe_u32 v124, s34, v118, 1
    v_cmp_ne_u32 vcc, 0, v124
    v_mul_i32_i24 v123, 2688, v123
    v_add3_u32 v121, v122, v123, s7
    v_cndmask_b32 v121, v115, v121, vcc
    v_mul_u32_u24 v118, 384, v118
    v_sub_u32 v118, v116, v118
    v_add_u32 v121, v121, v118
    buffer_load_dwordx4 v121, s[8:11], 0 offen lds
    s_add_u32 m0, s68, 3072
    v_lshrrev_b32 v116, 2, v128
    v_and_b32 v121, 1, v116
    v_mul_u32_u24 v121, 0x020202, v121
    v_lshl_or_b32 v121, v121, 8, v121
    v_add_u32 v121, 0x05040100, v121
    v_and_b32 v118, 3, v128
    v_lshrrev_b32 v122, 1, v128
    v_xor_b32 v122, v122, v255
    v_mul_u32_u24 v123, 384, v128
    v_lshl_add_u32 v0, v122, 4, v123
    v_xor_b32 v1, 64, v0
    v_and_b32 v122, 2, v255
    v_add_u32 v122, v122, v255
    v_lshl_add_u32 v122, v122, 2, v116
    v_mul_u32_u24 v122, 96, v122
    v_lshl_add_u32 v122, v118, 3, v122
    v_add_u32 v123, s68, v122
    buffer_load_dwordx4 v132, s[48:51], 0 offen lds
    v_add_u32 v124, s69, v122
    v_add_u32 v125, s72, v122
    v_add_u32 v122, s73, v122
    v_mov_b32 v28, 0x3f803f80
    v_mov_b32 v29, 0x3f803f80
    v_mov_b32 v30, 0x3f803f80
    v_mov_b32 v31, 0x3f803f80
    v_mul_u32_u24 v134, 768, v255
    v_add_u32 v134, v126, v134
    v_add_u32 v134, 98304, v134
    v_and_b32 v135, 1, v128
    v_lshlrev_b32 v135, 4, v135
    v_lshlrev_b32 v136, v135, s76
    v_mov_b32 v137, 0x3c003c00
    v_mov_b32 v44, 1.0
    v_lshlrev_b32 v138, 4, v255
    v_lshl_add_u32 v139, v255, 4, s79
    v_lshl_add_u32 v140, v255, 3, s80
    buffer_load_dwordx4 v150, s[48:51], 0 offen offset:1024 lds
    v_add_u32 v141, 0, v128
    v_mul_u32_u24 v142, 37, v141
    v_mul_u32_u24 v143, 384, v141
    v_lshrrev_b32 v142, 8, v142
    v_mad_u32_u24 v143, v142, s70, v143
    v_add_u32 v15, v143, v139
    v_add_u32 v18, v143, v140
    v_add_u32 v143, 16, v128
    v_mul_u32_u24 v144, 37, v143
    v_mul_u32_u24 v145, 384, v143
    v_lshrrev_b32 v144, 8, v144
    v_mad_u32_u24 v145, v144, s70, v145
    v_add_u32 v16, v145, v139
    v_add_u32 v19, v145, v140
    v_add_u32 v145, 32, v128
    v_mul_u32_u24 v146, 37, v145
    v_mul_u32_u24 v147, 384, v145
    v_lshrrev_b32 v146, 8, v146
    v_mad_u32_u24 v147, v146, s70, v147
    v_add_u32 v17, v147, v139
    v_add_u32 v20, v147, v140
    v_mul_u32_u24 v142, 24, v142
    v_lshl_add_u32 v142, v141, 2, v142
    v_add_u32 v22, s81, v142
    v_sub_u32 v23, s81, v142
    v_sub_u32 v139, v22, v138
    v_mul_u32_u24 v140, 24, v144
    v_lshl_add_u32 v140, v143, 2, v140
    v_add_u32 v24, s81, v140
    v_sub_u32 v25, s81, v140
    v_sub_u32 v140, v24, v138
    v_mul_u32_u24 v141, 24, v146
    v_lshl_add_u32 v141, v145, 2, v141
    v_add_u32 v26, s81, v141
    v_sub_u32 v27, s81, v141
    v_sub_u32 v141, v26, v138
    v_mul_u32_u24 v142, 148, v255
    v_add_u32 v143, 0, v142
    v_lshrrev_b32 v143, 8, v143
    v_mad_i32_i24 v46, v143, s82, v139
    v_mad_i32_i24 v58, v143, s82, v140
    v_mad_i32_i24 v70, v143, s82, v141
    v_add_u32 v143, 37, v142
    v_lshrrev_b32 v143, 8, v143
    v_mad_i32_i24 v47, v143, s82, v139
    v_mad_i32_i24 v59, v143, s82, v140
    v_mad_i32_i24 v71, v143, s82, v141
    v_add_u32 v143, 74, v142
    v_lshrrev_b32 v143, 8, v143
    v_mad_i32_i24 v48, v143, s82, v139
    v_mad_i32_i24 v60, v143, s82, v140
    v_mad_i32_i24 v72, v143, s82, v141
    v_add_u32 v143, 111, v142
    v_lshrrev_b32 v143, 8, v143
    v_mad_i32_i24 v49, v143, s82, v139
    v_mad_i32_i24 v61, v143, s82, v140
    v_mad_i32_i24 v73, v143, s82, v141
    v_add_u32 v143, 592, v142
    v_lshrrev_b32 v143, 8, v143
    v_mad_i32_i24 v50, v143, s82, v139
    v_mad_i32_i24 v62, v143, s82, v140
    v_mad_i32_i24 v74, v143, s82, v141
    v_add_u32 v143, 629, v142
    v_lshrrev_b32 v143, 8, v143
    v_mad_i32_i24 v51, v143, s82, v139
    v_mad_i32_i24 v63, v143, s82, v140
    v_mad_i32_i24 v75, v143, s82, v141
    v_add_u32 v143, 666, v142
    v_lshrrev_b32 v143, 8, v143
    v_mad_i32_i24 v52, v143, s82, v139
    v_mad_i32_i24 v64, v143, s82, v140
    v_mad_i32_i24 v76, v143, s82, v141
    v_add_u32 v143, 703, v142
    v_lshrrev_b32 v143, 8, v143
    v_mad_i32_i24 v53, v143, s82, v139
    v_mad_i32_i24 v65, v143, s82, v140
    v_mad_i32_i24 v77, v143, s82, v141
    v_add_u32 v143, 1184, v142
    v_lshrrev_b32 v143, 8, v143
    v_mad_i32_i24 v54, v143, s82, v139
    v_mad_i32_i24 v66, v143, s82, v140
    v_mad_i32_i24 v78, v143, s82, v141
    v_add_u32 v143, 1221, v142
    v_lshrrev_b32 v143, 8, v143
    v_mad_i32_i24 v55, v143, s82, v139
    v_mad_i32_i24 v67, v143, s82, v140
    v_mad_i32_i24 v79, v143, s82, v141
    v_add_u32 v143, 1258, v142
    v_lshrrev_b32 v143, 8, v143
    v_mad_i32_i24 v56, v143, s82, v139
    v_mad_i32_i24 v68, v143, s82, v140
    v_mad_i32_i24 v80, v143, s82, v141
    v_add_u32 v142, 1295, v142
    v_lshrrev_b32 v142, 8, v142
    v_mad_i32_i24 v57, v142, s82, v139
    v_mad_i32_i24 v69, v142, s82, v140
    v_mad_i32_i24 v81, v142, s82, v141
    v_mov_b32 v139, s81
    v_lshlrev_b32 v140, 4, v254
    v_xor_b32 v2, 65536, v140
    v_lshl_add_u32 v3, s16, 10, v140
    v_add_u32 v4, s85, v140
    v_lshl_add_u32 v140, v255, 3, s86
    v_mov_b32 v141, s83
    v_mov_b32 v142, 163264
    v_mul_u32_u24 v143, 80, v255
    v_add3_u32 v154, v143, v135, s72
    v_add_u32 v5, s72, v143
    v_lshl_add_u32 v6, v128, 2, s73
    v_add_u32 v9, s87, v138
    v_lshrrev_b32 v135, 1, v255
    v_mul_u32_u24 v135, 48, v135
    v_lshl_add_u32 v135, v255, 3, v135
    v_lshl_add_u32 v135, v116, 4, v135
    v_lshl_add_u32 v135, v118, 1, v135
    v_add_u32 v8, s87, v135
    v_mov_b32 v37, 0
    v_mov_b32 v38, 0
    buffer_load_dwordx4 v152, s[48:51], 0 offen offset:2048 lds
    s_add_u32 s48, s48, 36864
    s_addc_u32 s49, s49, 0
    s_add_u32 m0, s69, 0
    v_mov_b32 v39, 0
    v_add_u32 v155, 86016, v0
    v_add_u32 v156, 86016, v1
    v_lshlrev_b32 v157, 4, v128
    v_add_u32 v157, 161984, v157
    v_mul_u32_u24 v135, 336, v128
    v_add3_u32 v135, v135, v143, s72
    v_mul_u32_u24 v143, 272, v128
    v_add3_u32 v143, v143, v138, s73
    v_mul_u32_u24 v158, 1088, v255
    v_add_u32 v158, v158, v6
    v_add_u32 v159, 5376, v135
    v_add_u32 v160, 4352, v143
    v_add_u32 v161, 4352, v158
    v_cmp_gt_u32 s[88:89], 16, v254
    buffer_load_dwordx4 v132, s[48:51], 0 offen lds
    v_mov_b32 v144, 0xf149f2ca
    v_add_u32 v145, 768, v114
    v_mul_u32_u24 v146, 2731, v145
    v_bfe_u32 v147, v146, 17, 3
    v_lshrrev_b32 v146, 16, v146
    v_xor_b32 v145, v147, v145
    v_mul_u32_u24 v147, 37, v146
    v_lshrrev_b32 v147, 8, v147
    v_lshlrev_b32 v145, 4, v145
    v_mad_u32_u24 v13, v147, s70, v145
    v_add_u32 v114, 1024, v114
    v_mul_u32_u24 v145, 2731, v114
    v_bfe_u32 v146, v145, 17, 3
    s_waitcnt vmcnt(7)
    ds_read_b64_tr_b16 a[72:73], v123 offset:0
    ds_read_b64_tr_b16 a[74:75], v123 offset:768
    ds_read_b64_tr_b16 a[96:97], v123 offset:32
    ds_read_b64_tr_b16 a[98:99], v123 offset:800
    ds_read_b64_tr_b16 a[120:121], v123 offset:64
    buffer_load_dwordx4 v150, s[48:51], 0 offen offset:1024 lds
    ds_read_b64_tr_b16 a[122:123], v123 offset:832
    v_lshrrev_b32 v145, 16, v145
    v_xor_b32 v114, v146, v114
    v_mul_u32_u24 v146, 37, v145
    v_lshrrev_b32 v146, 8, v146
    v_lshlrev_b32 v114, 4, v114
    v_mad_u32_u24 v14, v146, s70, v114
    v_cmp_gt_u32 vcc, 48, v145
    v_mul_u32_u24 v145, 6, v130
    v_sub_u32 v114, v254, v145
    v_cndmask_b32 v14, v115, v14, vcc
    v_cmp_gt_u32 vcc, 2, v118
    v_mul_u32_u24 v145, 384, v130
    v_lshl_add_u32 v145, v114, 4, v145
    v_cndmask_b32 v32, 0, v136, vcc
    v_cndmask_b32 v33, v136, 0, vcc
    v_cndmask_b32 v34, 0, v136, vcc
    v_cndmask_b32 v35, v136, 0, vcc
    buffer_load_dwordx4 v152, s[48:51], 0 offen offset:2048 lds
    s_add_u32 s48, s48, 36864
    s_addc_u32 s49, s49, 0
    s_add_u32 m0, s69, 3072
    v_cmp_eq_u32 vcc, 0, v118
    v_add_u32 v115, s78, v145
    v_add_u32 v145, s77, v145
    v_cndmask_b32 v40, 0, v137, vcc
    v_cmp_eq_u32 vcc, 1, v118
    v_mul_u32_u24 v136, 6, v131
    v_sub_u32 v130, v254, v136
    v_cndmask_b32 v41, 0, v137, vcc
    v_cmp_eq_u32 vcc, 2, v118
    v_mul_u32_u24 v136, 384, v131
    v_lshl_add_u32 v136, v130, 4, v136
    v_cndmask_b32 v42, 0, v137, vcc
    v_cmp_eq_u32 vcc, 3, v118
    v_add_u32 v131, s78, v136
    v_add_u32 v136, s77, v136
    v_cndmask_b32 v43, 0, v137, vcc
    v_cmp_eq_u32 vcc, v255, v116
    v_mul_u32_u24 v137, 6, v133
    v_sub_u32 v254, v254, v137
    v_cndmask_b32 v162, 0, v32, vcc
    v_cndmask_b32 v163, 0, v33, vcc
    v_cmp_gt_i32 vcc, 4, v114
    v_mul_u32_u24 v137, 384, v133
    v_lshl_add_u32 v137, v254, 4, v137
    v_cndmask_b32 v164, v115, v145, vcc
    v_cmp_gt_i32 vcc, -60, v130
    v_add_u32 v145, s78, v137
    v_add_u32 v137, s77, v137
    v_cndmask_b32 v165, v131, v136, vcc
    v_cmp_gt_i32 vcc, -124, v254
    v_mul_u32_u24 v254, 96, v128
    v_add3_u32 v130, v254, v138, s68
    v_cndmask_b32 v131, v145, v137, vcc
    v_cmp_gt_u32 vcc, 2, v255
    v_lshl_add_u32 v133, v255, 3, v254
    v_add3_u32 v133, v133, 64, s68
    v_cndmask_b32 v140, v141, v140, vcc
    v_lshl_add_u32 v140, v116, 9, v140
    v_lshl_add_u32 v140, v118, 1, v140
    v_cmp_gt_u32 vcc, 3, v255
    v_add3_u32 v114, v254, v138, s69
    v_lshl_add_u32 v254, v255, 3, v254
    v_cndmask_b32 v7, v142, v140, vcc
    v_cmp_gt_u32 vcc, 12, v128
    v_add3_u32 v254, v254, 64, s69
    v_add_u32 v118, 16, v128
    v_cndmask_b32 v159, v157, v159, vcc
    v_cndmask_b32 v160, v157, v160, vcc
    v_cmp_gt_u32 vcc, 3, v255
    v_cmp_gt_u32 s[94:95], s45, v118
    v_cndmask_b32 v255, v157, v143, s[88:89]
    v_cndmask_b32 v161, v157, v161, vcc
    v_cndmask_b32 v157, v157, v160, s[88:89]
    v_add_u32 v5, 336, v5
    buffer_load_dwordx4 v132, s[48:51], 0 offen lds
    buffer_load_dwordx4 v150, s[48:51], 0 offen offset:1024 lds
    buffer_load_dwordx4 v152, s[48:51], 0 offen offset:2048 lds
    s_waitcnt vmcnt(9)
    s_barrier
    ds_read_b128 v[146:149], v155 offset:6144
    ds_read_b128 v[166:169], v156 offset:6144
    ds_read_b128 v[170:173], v155 offset:6272
    s_add_u32 s48, s48, 36864
    s_addc_u32 s49, s49, 0
    ds_read_b128 v[174:177], v156 offset:6272
    s_add_u32 m0, s72, 0
    ds_read_b128 v[178:181], v155 offset:6400
    ds_read_b128 v[182:185], v156 offset:6400
    ds_read_b128 v[186:189], v155 offset:0
    buffer_load_ushort v116, v153, s[60:63], 0 offen
    s_mov_b64 s[60:61], s[8:9]
    ds_read_b128 v[190:193], v156 offset:0
    ds_read_b128 v[194:197], v155 offset:128
    ds_read_b128 v[198:201], v156 offset:128
    s_waitcnt lgkmcnt(7)
    v_mfma_f32_16x16x32_bf16 v[202:205], a[72:75], v[146:149], 0
    buffer_load_dwordx3 v[206:208], v126, s[56:59], 0 offen
    ds_read_b128 v[210:213], v155 offset:256
    v_mfma_f32_16x16x32_bf16 v[214:217], a[96:99], v[146:149], 0
    s_waitcnt lgkmcnt(7)
    ds_read_b128 v[218:221], v156 offset:256
    v_mfma_f32_16x16x32_bf16 v[222:225], a[120:123], v[146:149], 0
    s_waitcnt lgkmcnt(7)
    ds_read_b128 v[146:149], v155 offset:6144
    s_waitcnt lgkmcnt(6)
    v_mfma_f32_16x16x32_bf16 v[226:229], a[72:75], v[186:189], 0
    v_mfma_f32_16x16x32_bf16 v[230:233], a[96:99], v[186:189], 0
    s_waitcnt vmcnt(8)
    buffer_load_dwordx4 v[234:237], v120, s[64:67], 0 offen
    ds_read_b64_tr_b16 a[76:77], v123 offset:3072
    ds_read_b64_tr_b16 a[78:79], v123 offset:3840
    ds_read_b64_tr_b16 a[100:101], v123 offset:3104
    ds_read_b64_tr_b16 a[102:103], v123 offset:3872
    ds_read_b64_tr_b16 a[124:125], v123 offset:3136
    ds_read_b64_tr_b16 a[126:127], v123 offset:3904
    s_mov_b32 s19, s38
    s_mov_b32 s23, s25
    s_mov_b32 s26, 0
    s_mov_b32 s27, 0
    s_mov_b32 s18, 0
    s_add_u32 s19, s19, s20
    s_add_u32 s23, s23, s21
    s_cmp_ge_u32 s19, 72
    s_cselect_b32 s34, 72, 0
    s_cselect_b32 s35, s22, 0
    s_sub_u32 s19, s19, s34
    s_add_u32 s23, s23, s35
    s_mov_b32 s24, s23
    s_add_u32 s19, s19, s20
    s_add_u32 s23, s23, s21
    s_cmp_ge_u32 s19, 72
    s_cselect_b32 s34, 72, 0
    s_cselect_b32 s35, s22, 0
    s_sub_u32 s19, s19, s34
    s_add_u32 s23, s23, s35
    s_sub_u32 s62, s45, s17
    s_sub_u32 s45, s17, 1
    s_bfm_b32 s70, s17, 0
    s_waitcnt lgkmcnt(4)
    v_mfma_f32_16x16x32_bf16 v[202:205], a[76:79], v[166:169], v[202:205]
    s_waitcnt lgkmcnt(2)
    global_load_ushort v151, v151, s[46:47]
    s_mov_b32 s71, 1
    v_mfma_f32_16x16x32_bf16 v[214:217], a[100:103], v[166:169], v[214:217]
    s_waitcnt lgkmcnt(0)
    buffer_load_dwordx4 v132, s[48:51], 0 offen lds
    s_and_b32 s77, s2, 0xf8
    v_mfma_f32_16x16x32_bf16 v[222:225], a[124:127], v[166:169], v[222:225]
    s_add_u32 s77, s77, 4940
    ds_read_b128 v[166:169], v156 offset:6144
    s_mul_i32 s78, s77, 58255
    v_mfma_f32_16x16x32_bf16 v[226:229], a[76:79], v[190:193], v[226:229]
    s_lshr_b32 s78, s78, 22
    s_add_u32 s34, s18, 2
    s_mov_b32 s18, 1
    v_mfma_f32_16x16x32_bf16 v[230:233], a[100:103], v[190:193], v[230:233]
    s_mov_b32 s27, s26
    s_mov_b32 s26, s25
    s_add_u32 s19, s19, s20
    s_waitcnt vmcnt(8)
    ds_read_b64_tr_b16 a[80:81], v124 offset:0
    ds_read_b64_tr_b16 a[82:83], v124 offset:768
    ds_read_b64_tr_b16 a[104:105], v124 offset:32
    ds_read_b64_tr_b16 a[106:107], v124 offset:800
    ds_read_b64_tr_b16 a[128:129], v124 offset:64
    ds_read_b64_tr_b16 a[130:131], v124 offset:832
    buffer_load_dwordx4 v150, s[48:51], 0 offen offset:1024 lds
    buffer_load_dwordx4 v152, s[48:51], 0 offen offset:2048 lds
    s_add_u32 s48, s48, 36864
    s_waitcnt lgkmcnt(4)
    v_mfma_f32_16x16x32_bf16 v[202:205], a[80:83], v[170:173], v[202:205]
    s_waitcnt lgkmcnt(2)
    s_addc_u32 s49, s49, 0
    s_add_u32 m0, s72, 3072
    v_mfma_f32_16x16x32_bf16 v[214:217], a[104:107], v[170:173], v[214:217]
    s_waitcnt lgkmcnt(0)
    s_mov_b32 s72, 2
    v_mfma_f32_16x16x32_bf16 v[222:225], a[128:131], v[170:173], v[222:225]
    ds_read_b128 v[170:173], v155 offset:6272
    v_mfma_f32_16x16x32_bf16 v[226:229], a[80:83], v[194:197], v[226:229]
    v_mfma_f32_16x16x32_bf16 v[230:233], a[104:107], v[194:197], v[230:233]
    buffer_load_dwordx4 v132, s[48:51], 0 offen lds
    s_waitcnt vmcnt(8)
    ds_read_b64_tr_b16 a[84:85], v124 offset:3072
    ds_read_b64_tr_b16 a[86:87], v124 offset:3840
    ds_read_b64_tr_b16 a[108:109], v124 offset:3104
    ds_read_b64_tr_b16 a[110:111], v124 offset:3872
    ds_read_b64_tr_b16 a[132:133], v124 offset:3136
    ds_read_b64_tr_b16 a[134:135], v124 offset:3904
    s_waitcnt vmcnt(6)
    v_bfe_u32 v126, v206, v138, 16
    v_bfe_u32 v128, v207, v138, 16
    v_bfe_u32 v118, v208, v138, 16
    buffer_load_dwordx4 v150, s[48:51], 0 offen offset:1024 lds
    s_waitcnt vmcnt(6)
    v_cndmask_b32 v234, v234, v235, s[92:93]
    v_mfma_f32_16x16x16_bf16 v[206:209], v[116:117], v[126:127], 0
    v_cndmask_b32 v236, v236, v237, s[92:93]
    v_perm_b32 v136, v236, v234, v121
    v_mfma_f32_16x16x16_bf16 v[234:237], v[116:117], v[128:129], 0
    s_waitcnt lgkmcnt(4)
    v_mfma_f32_16x16x32_bf16 v[202:205], a[84:87], v[174:177], v[202:205]
    s_waitcnt lgkmcnt(0)
    v_mfma_f32_16x16x32_bf16 v[214:217], a[108:111], v[174:177], v[214:217]
    buffer_load_dwordx4 v152, s[48:51], 0 offen offset:2048 lds
    v_max_f32 v206, 0, v206
    v_mfma_f32_16x16x32_bf16 v[222:225], a[132:135], v[174:177], v[222:225]
    s_sub_u32 s48, s48, 184704
    ds_read_b128 v[126:129], v156 offset:6272
    v_max_f32 v207, 0, v207
    v_mfma_f32_16x16x32_bf16 v[226:229], a[84:87], v[198:201], v[226:229]
    s_subb_u32 s49, s49, 0
    v_max_f32 v208, 0, v208
    v_max_f32 v209, 0, v209
    v_mfma_f32_16x16x32_bf16 v[230:233], a[108:111], v[198:201], v[230:233]
    s_add_u32 m0, s73, 0
    v_cvt_pk_bf16_f32 v140, v206, v207
    v_cvt_pk_bf16_f32 v141, v208, v209
    v_max_f32 v234, 0, v234
    v_mfma_f32_16x16x16_bf16 v[174:177], v[116:117], v[118:119], 0
    v_max_f32 v235, 0, v235
    s_waitcnt vmcnt(6)
    v_lshlrev_b32 v151, 16, v151
    v_max_f32 v151, 0xc2c80000, v151
    v_mfma_f32_16x16x32_bf16 v[206:209], a[120:123], v[186:189], 0
    buffer_load_dwordx4 v[186:189], v120, s[64:67], 0 offen offset:16
    v_min_f32 v151, 0x40930000, v151
    v_mfma_f32_16x16x32_bf16 v[206:209], a[124:127], v[190:193], v[206:209]
    buffer_load_dwordx4 v132, s[48:51], 0 offen lds
    ds_read_b128 v[190:193], v155 offset:0
    v_mfma_f32_16x16x32_bf16 v[206:209], a[128:131], v[194:197], v[206:209]
    ds_read_b128 v[194:197], v156 offset:0
    v_mul_f32 v151, 0x3fb8aa3b, v151
    v_mfma_f32_16x16x32_bf16 v[206:209], a[132:135], v[198:201], v[206:209]
    s_waitcnt lgkmcnt(2)
    ds_read_b128 v[198:201], v155 offset:128
    v_exp_f32 v151, v151
    v_max_f32 v236, 0, v236
    v_cvt_pk_bf16_f32 v151, v151, v151
    v_and_b32 v151, 0xffff0000, v151
    v_mul_f32 v151, 0x3fb8aa3b, v151
    v_mul_f32 v138, 0xbea8f5c3, v151
    v_add_f32 v138, 0xc138aa3b, v138
    v_readlane_b32 s31, v151, s90
    v_max_f32 v237, 0, v237
    buffer_load_dwordx4 v150, s[48:51], 0 offen offset:1024 lds
    v_cvt_pk_bf16_f32 v116, v234, v235
    v_cvt_pk_bf16_f32 v117, v236, v237
    v_max_f32 v174, 0, v174
    v_max_f32 v175, 0, v175
    v_max_f32 v176, 0, v176
    v_max_f32 v177, 0, v177
    v_cvt_pk_bf16_f32 v118, v174, v175
    v_cvt_pk_bf16_f32 v119, v176, v177
    ds_read_b128 v[174:177], v156 offset:128
    buffer_load_dwordx4 v152, s[48:51], 0 offen offset:2048 lds
    s_add_u32 s48, s48, 36864
    s_waitcnt vmcnt(7)
    ds_read_b64_tr_b16 a[88:89], v125 offset:0
    ds_read_b64_tr_b16 a[90:91], v125 offset:768
    ds_read_b64_tr_b16 a[112:113], v125 offset:32
    ds_read_b64_tr_b16 a[114:115], v125 offset:800
    ds_read_b64_tr_b16 a[136:137], v125 offset:64
    ds_read_b64_tr_b16 a[138:139], v125 offset:832
    s_addc_u32 s49, s49, 0
    s_add_u32 m0, s73, 3072
    s_mov_b32 s73, 3
    buffer_load_dwordx4 v132, s[48:51], 0 offen lds
    s_waitcnt lgkmcnt(4)
    v_mfma_f32_16x16x32_bf16 v[202:205], a[88:91], v[178:181], v[202:205]
    s_waitcnt lgkmcnt(3)
    v_mfma_f32_16x16x32_bf16 v[226:229], a[88:91], v[210:213], v[226:229]
    s_waitcnt lgkmcnt(0)
    v_mfma_f32_16x16x32_bf16 v[214:217], a[112:115], v[178:181], v[214:217]
    buffer_load_dwordx4 v150, s[48:51], 0 offen offset:1024 lds
    v_mfma_f32_16x16x32_bf16 v[222:225], a[136:139], v[178:181], v[222:225]
    ds_read_b128 v[178:181], v155 offset:6400
    v_mfma_f32_16x16x32_bf16 v[230:233], a[112:115], v[210:213], v[230:233]
    v_mfma_f32_16x16x32_bf16 v[206:209], a[136:139], v[210:213], v[206:209]
    ds_read_b128 v[210:213], v155 offset:256
    s_waitcnt vmcnt(6)
    ds_read_b64_tr_b16 a[92:93], v125 offset:3072
    ds_read_b64_tr_b16 a[94:95], v125 offset:3840
    ds_read_b64_tr_b16 a[116:117], v125 offset:3104
    ds_read_b64_tr_b16 a[118:119], v125 offset:3872
    buffer_load_dwordx4 v152, s[48:51], 0 offen offset:2048 lds
    ds_read_b64_tr_b16 a[140:141], v125 offset:3136
    ds_read_b64_tr_b16 a[142:143], v125 offset:3904
    s_add_u32 s48, s48, 36864
    s_addc_u32 s49, s49, 0
    s_add_u32 m0, s68, 0
    v_mov_b32 v234, 0
    v_mov_b32 v235, 0
    v_mov_b32 v236, 0
    v_mov_b32 v237, 0
    v_mov_b32 v238, v144
    v_mov_b32 v239, v144
    v_mov_b32 v240, v144
    v_mov_b32 v241, v144
    s_waitcnt vmcnt(6)
    v_cndmask_b32 v186, v186, v187, s[92:93]
    buffer_load_dwordx4 v132, s[48:51], 0 offen lds
    v_cndmask_b32 v188, v188, v189, s[92:93]
    v_perm_b32 v137, v188, v186, v121
    s_waitcnt lgkmcnt(4)
    v_mfma_f32_16x16x32_bf16 v[202:205], a[92:95], v[182:185], v[202:205]
    s_waitcnt lgkmcnt(3)
    v_mfma_f32_16x16x32_bf16 v[226:229], a[92:95], v[218:221], v[226:229]
    s_waitcnt lgkmcnt(0)
    v_mfma_f32_16x16x32_bf16 v[214:217], a[116:119], v[182:185], v[214:217]
    v_mfma_f32_16x16x32_bf16 v[222:225], a[140:143], v[182:185], v[222:225]
    v_mfma_f32_16x16x32_bf16 v[230:233], a[116:119], v[218:221], v[230:233]
    buffer_load_dwordx4 v150, s[48:51], 0 offen offset:1024 lds
    v_mfma_f32_16x16x32_bf16 v[206:209], a[140:143], v[218:221], v[206:209]
    ds_read_b128 v[182:185], v156 offset:6400
    v_cvt_pk_f16_f32 v186, v202, v203
    v_pk_mul_f16 v203, v186, v186
    v_cvt_pk_f16_f32 v187, v204, v205
    v_pk_fma_f16 v203, v187, v187, v203
    v_cvt_pk_f16_f32 v188, v214, v215
    v_mfma_f32_16x16x16_bf16 v[218:221], v[136:137], v[140:141], 0
    v_pk_fma_f16 v203, v188, v188, v203
    v_cvt_pk_f16_f32 v189, v216, v217
    v_pk_fma_f16 v203, v189, v189, v203
    v_mfma_f32_16x16x16_bf16 v[214:217], v[136:137], v[116:117], 0
    v_cvt_pk_f16_f32 v120, v222, v223
    v_pk_fma_f16 v203, v120, v120, v203
    v_cvt_pk_f16_f32 v121, v224, v225
    v_mfma_f32_16x16x16_bf16 v[222:225], v[136:137], v[118:119], 0
    buffer_load_dwordx4 v152, s[48:51], 0 offen offset:2048 lds
    ds_read_b128 v[242:245], v156 offset:256
    s_add_u32 s48, s48, 36864
    s_addc_u32 s49, s49, 0
    s_add_u32 m0, s68, 3072
    v_cvt_pk_bf16_f32 v218, v218, v218
    v_and_b32 v218, 0xffff0000, v218
    s_waitcnt vmcnt(6)
    ds_read_b64_tr_b16 a[0:1], v122 offset:0
    ds_read_b64_tr_b16 a[2:3], v122 offset:768
    ds_read_b64_tr_b16 a[24:25], v122 offset:32
    ds_read_b64_tr_b16 a[26:27], v122 offset:800
    ds_read_b64_tr_b16 a[48:49], v122 offset:64
    ds_read_b64_tr_b16 a[50:51], v122 offset:832
    v_mul_f32 v218, 0xbfb8aa3b, v218
    v_exp_f32 v218, v218
    v_cvt_pk_bf16_f32 v214, v214, v214
    buffer_load_dwordx4 v132, s[48:51], 0 offen lds
    v_add_f32 v218, 1.0, v218
    v_rcp_f32 v218, v218
    v_and_b32 v214, 0xffff0000, v214
    v_cvt_pk_bf16_f32 v218, v218, v218
    v_and_b32 v218, 0xffff0000, v218
    v_fmamk_f32 v218, v218, 0x41b8aa3b, v138
    ds_write_b32 v134, v218 offset:0
    v_mul_f32 v214, 0xbfb8aa3b, v214
    v_exp_f32 v214, v214
    v_cvt_pk_bf16_f32 v222, v222, v222
    v_add_f32 v214, 1.0, v214
    s_waitcnt lgkmcnt(5)
    v_mfma_f32_16x16x32_bf16 v[218:221], a[0:3], v[146:149], 0
    s_waitcnt lgkmcnt(3)
    v_rcp_f32 v214, v214
    v_mfma_f32_16x16x32_bf16 v[246:249], a[24:27], v[146:149], 0
    s_waitcnt lgkmcnt(1)
    buffer_load_dwordx4 v150, s[48:51], 0 offen offset:1024 lds
    v_cvt_pk_bf16_f32 v214, v214, v214
    v_and_b32 v214, 0xffff0000, v214
    v_fmamk_f32 v214, v214, 0x41b8aa3b, v138
    ds_write_b32 v134, v214 offset:4
    v_and_b32 v222, 0xffff0000, v222
    v_mul_f32 v222, 0xbfb8aa3b, v222
    v_exp_f32 v222, v222
    v_pk_fma_f16 v203, v121, v121, v203
    v_add_f32 v222, 1.0, v222
    v_rcp_f32 v222, v222
    v_cvt_pk_f16_f32 v214, v226, v227
    s_waitcnt vmcnt(5)
    ds_read_b64_tr_b16 a[4:5], v122 offset:3072
    ds_read_b64_tr_b16 a[6:7], v122 offset:3840
    buffer_load_dwordx4 v152, s[48:51], 0 offen offset:2048 lds
    ds_read_b64_tr_b16 a[28:29], v122 offset:3104
    ds_read_b64_tr_b16 a[30:31], v122 offset:3872
    ds_read_b64_tr_b16 a[52:53], v122 offset:3136
    ds_read_b64_tr_b16 a[54:55], v122 offset:3904
    v_mfma_f32_16x16x32_bf16 v[250:253], a[48:51], v[146:149], 0
    s_add_u32 s48, s48, 36864
    ds_write_b128 v135, v[234:237] offset:16
    v_mfma_f32_16x16x32_bf16 v[146:149], a[0:3], v[190:193], 0
    s_addc_u32 s49, s49, 0
    s_add_u32 m0, s69, 0
    v_cvt_pk_bf16_f32 v222, v222, v222
    v_and_b32 v222, 0xffff0000, v222
    v_fmamk_f32 v222, v222, 0x41b8aa3b, v138
    v_pk_mul_f16 v223, v214, v214
    buffer_load_dwordx4 v132, s[48:51], 0 offen lds
    ds_write_b32 v134, v222 offset:8
    v_cvt_pk_f16_f32 v215, v228, v229
    v_pk_fma_f16 v223, v215, v215, v223
    v_cvt_pk_f16_f32 v216, v230, v231
    v_mfma_f32_16x16x32_bf16 v[226:229], a[24:27], v[190:193], 0
    s_waitcnt lgkmcnt(6)
    v_pk_fma_f16 v223, v216, v216, v223
    v_cvt_pk_f16_f32 v217, v232, v233
    v_mfma_f32_16x16x32_bf16 v[218:221], a[4:7], v[166:169], v[218:221]
    s_waitcnt lgkmcnt(2)
    ds_write_b64 v135, v[234:235] offset:56
    v_mfma_f32_16x16x32_bf16 v[246:249], a[28:31], v[166:169], v[246:249]
    v_pk_fma_f16 v223, v217, v217, v223
    v_cvt_pk_f16_f32 v140, v206, v207
    v_mfma_f32_16x16x32_bf16 v[250:253], a[52:55], v[166:169], v[250:253]
    buffer_load_dwordx4 v150, s[48:51], 0 offen offset:1024 lds
    v_pk_fma_f16 v223, v140, v140, v223
    v_mfma_f32_16x16x32_bf16 v[146:149], a[4:7], v[194:197], v[146:149]
    ds_write_b64 v135, v[234:235] offset:64
    v_mfma_f32_16x16x32_bf16 v[226:229], a[28:31], v[194:197], v[226:229]
    s_waitcnt lgkmcnt(2)
    v_cvt_pk_f16_f32 v141, v208, v209
    v_pk_fma_f16 v223, v141, v141, v223
    v_mfma_f32_16x16x32_bf16 v[166:169], a[48:51], v[190:193], 0
    s_barrier
    ds_read_b32 v22, v22 offset:0
    ds_read_b32 v23, v23 offset:672
    v_mfma_f32_16x16x32_bf16 v[166:169], a[52:55], v[194:197], v[166:169]
    ds_read_b32 v24, v24 offset:0
    s_waitcnt vmcnt(5)
    ds_read_b64_tr_b16 a[8:9], v123 offset:0
    ds_read_b64_tr_b16 a[10:11], v123 offset:768
    buffer_load_dwordx4 v152, s[48:51], 0 offen offset:2048 lds
    ds_read_b64_tr_b16 a[32:33], v123 offset:32
    ds_read_b64_tr_b16 a[34:35], v123 offset:800
    ds_read_b64_tr_b16 a[56:57], v123 offset:64
    ds_read_b64_tr_b16 a[58:59], v123 offset:832
    ds_read_b32 v25, v25 offset:672
    ds_read_b32 v26, v26 offset:0
    ds_read_b32 v27, v27 offset:672
    s_add_u32 s48, s48, 36864
    ds_read_b32 v46, v46 offset:336
    s_addc_u32 s49, s49, 0
    ds_read_b32 v58, v58 offset:336
    s_add_u32 m0, s69, 3072
    ds_read_b32 v70, v70 offset:336
    ds_read_b32 v47, v47 offset:332
    ds_read_b32 v59, v59 offset:332
    ds_read_b32 v71, v71 offset:332
    s_waitcnt lgkmcnt(15)
    buffer_load_dwordx4 v132, s[48:51], 0 offen lds
    ds_read_b32 v48, v48 offset:328
    ds_read_b32 v60, v60 offset:328
    s_waitcnt lgkmcnt(15)
    v_mfma_f32_16x16x32_bf16 v[218:221], a[8:11], v[170:173], v[218:221]
    s_waitcnt lgkmcnt(14)
    ds_read_b32 v72, v72 offset:328
    ds_read_b32 v49, v49 offset:324
    v_mfma_f32_16x16x32_bf16 v[146:149], a[8:11], v[198:201], v[146:149]
    s_waitcnt lgkmcnt(12)
    ds_read_b32 v61, v61 offset:324
    ds_read_b32 v73, v73 offset:324
    v_mfma_f32_16x16x32_bf16 v[246:249], a[32:35], v[170:173], v[246:249]
    s_waitcnt lgkmcnt(11)
    ds_read_b32 v50, v50 offset:272
    ds_read_b32 v62, v62 offset:272
    v_mfma_f32_16x16x32_bf16 v[250:253], a[56:59], v[170:173], v[250:253]
    s_waitcnt lgkmcnt(11)
    ds_read_b32 v74, v74 offset:272
    ds_read_b32 v51, v51 offset:268
    v_mfma_f32_16x16x32_bf16 v[226:229], a[32:35], v[198:201], v[226:229]
    s_waitcnt lgkmcnt(11)
    buffer_load_dwordx4 v150, s[48:51], 0 offen offset:1024 lds
    ds_read_b32 v63, v63 offset:268
    v_mfma_f32_16x16x32_bf16 v[166:169], a[56:59], v[198:201], v[166:169]
    s_waitcnt lgkmcnt(11)
    ds_read_b32 v75, v75 offset:268
    ds_read_b32 v52, v52 offset:264
    ds_read_b32 v64, v64 offset:264
    ds_read_b32 v76, v76 offset:264
    ds_read_b32 v53, v53 offset:260
    ds_read_b32 v65, v65 offset:260
    ds_read_b32 v77, v77 offset:260
    ds_read_b32 v54, v54 offset:208
    ds_read_b32 v66, v66 offset:208
    ds_read_b32 v78, v78 offset:208
    s_waitcnt vmcnt(5)
    ds_read_b64_tr_b16 a[12:13], v123 offset:3072
    buffer_load_dwordx4 v152, s[48:51], 0 offen offset:2048 lds
    ds_read_b64_tr_b16 a[14:15], v123 offset:3840
    ds_read_b64_tr_b16 a[36:37], v123 offset:3104
    s_add_u32 m0, s28, 0
    ds_read_b64_tr_b16 a[38:39], v123 offset:3872
    s_sub_u32 s48, s48, 183552
    ds_read_b64_tr_b16 a[60:61], v123 offset:3136
    s_subb_u32 s49, s49, 0
    ds_read_b64_tr_b16 a[62:63], v123 offset:3904
    ds_read_b32 v55, v55 offset:204
    ds_read_b32 v67, v67 offset:204
    ds_read_b32 v79, v79 offset:204
    ds_read_b32 v56, v56 offset:200
    ds_read_b32 v68, v68 offset:200
    buffer_load_dwordx4 v10, s[8:11], s25 offen nt lds
    ds_read_b32 v80, v80 offset:200
    ds_read_b32 v57, v57 offset:196
    ds_read_b32 v69, v69 offset:196
    s_add_u32 m0, s28, 4096
    ds_read_b32 v81, v81 offset:196
    ds_read_b32 v139, v139 offset:336
    s_waitcnt lgkmcnt(14)
    v_mfma_f32_16x16x32_bf16 v[218:221], a[12:15], v[126:129], v[218:221]
    s_waitcnt lgkmcnt(13)
    ds_write_b128 v159, v[234:237] offset:16
    v_mfma_f32_16x16x32_bf16 v[146:149], a[12:15], v[174:177], v[146:149]
    s_waitcnt lgkmcnt(10)
    v_cndmask_b32 v22, v144, v22, s[88:89]
    v_cndmask_b32 v24, v144, v24, s[88:89]
    v_mfma_f32_16x16x32_bf16 v[246:249], a[36:39], v[126:129], v[246:249]
    s_waitcnt lgkmcnt(8)
    buffer_load_dwordx4 v11, s[8:11], s25 offen nt lds
    v_mfma_f32_16x16x32_bf16 v[250:253], a[60:63], v[126:129], v[250:253]
    s_add_u32 m0, s28, 8192
    ds_write_b64 v159, v[234:235] offset:56
    v_mfma_f32_16x16x32_bf16 v[226:229], a[36:39], v[174:177], v[226:229]
    s_waitcnt lgkmcnt(5)
    v_mov_b32_dpp v23, v25 quad_perm:[0,1,2,3] row_mask:0x2 bank_mask:0xf
    v_cndmask_b32 v26, v144, v26, s[88:89]
    v_mfma_f32_16x16x32_bf16 v[166:169], a[60:63], v[174:177], v[166:169]
    s_waitcnt lgkmcnt(3)
    s_waitcnt lgkmcnt(2)
    ds_write_b64 v159, v[234:235] offset:64
    s_waitcnt vmcnt(5)
    v_readfirstlane_b32 s39, v139
    buffer_load_dwordx4 v12, s[8:11], s25 offen nt lds
    ds_read_b64_tr_b16 a[16:17], v124 offset:0
    ds_read_b64_tr_b16 a[18:19], v124 offset:768
    ds_read_b64_tr_b16 a[40:41], v124 offset:32
    ds_read_b64_tr_b16 a[42:43], v124 offset:800
    ds_read_b64_tr_b16 a[64:65], v124 offset:64
    ds_read_b64_tr_b16 a[66:67], v124 offset:832
    ds_write_b128 v143, v[238:241] offset:192
    s_add_u32 m0, s28, 12288
    v_mov_b32_dpp v23, v27 quad_perm:[0,1,2,3] row_mask:0x4 bank_mask:0xf
    buffer_load_dwordx4 v13, s[8:11], s25 offen nt lds
    ds_write_b128 v160, v[238:241] offset:192
    s_add_u32 m0, s29, 0
    s_nop 0
    s_waitcnt lgkmcnt(6)
    v_mfma_f32_16x16x32_bf16 v[218:221], a[16:19], v[178:181], v[218:221]
    s_waitcnt lgkmcnt(5)
    v_mfma_f32_16x16x32_bf16 v[146:149], a[16:19], v[210:213], v[146:149]
    s_waitcnt lgkmcnt(1)
    v_mfma_f32_16x16x32_bf16 v[246:249], a[40:43], v[178:181], v[246:249]
    v_mfma_f32_16x16x32_bf16 v[250:253], a[64:67], v[178:181], v[250:253]
    buffer_load_dwordx4 v14, s[8:11], s25 offen nt lds
    v_mfma_f32_16x16x32_bf16 v[226:229], a[40:43], v[210:213], v[226:229]
    s_add_u32 m0, s68, 0
    s_lshr_b32 s10, s17, 1
    s_cselect_b32 s10, s36, 0
    v_mfma_f32_16x16x32_bf16 v[166:169], a[64:67], v[210:213], v[166:169]
    s_mov_b32 s25, s24
    s_waitcnt vmcnt(5)
    ds_read_b64_tr_b16 a[20:21], v124 offset:3072
    ds_read_b64_tr_b16 a[22:23], v124 offset:3840
    ds_read_b64_tr_b16 a[44:45], v124 offset:3104
    buffer_load_dwordx4 v132, s[48:51], 0 offen lds
    ds_read_b64_tr_b16 a[46:47], v124 offset:3872
    ds_read_b64_tr_b16 a[68:69], v124 offset:3136
    ds_read_b64_tr_b16 a[70:71], v124 offset:3904
    buffer_load_dwordx4 v150, s[48:51], 0 offen offset:1024 lds
    s_waitcnt lgkmcnt(4)
    v_mfma_f32_16x16x32_bf16 v[218:221], a[20:23], v[182:185], v[218:221]
    s_waitcnt lgkmcnt(3)
    v_mfma_f32_16x16x32_bf16 v[146:149], a[20:23], v[242:245], v[146:149]
    s_waitcnt lgkmcnt(0)
    v_mfma_f32_16x16x32_bf16 v[246:249], a[44:47], v[182:185], v[246:249]
    v_mfma_f32_16x16x32_bf16 v[250:253], a[68:71], v[182:185], v[250:253]
    v_mfma_f32_16x16x32_bf16 v[226:229], a[44:47], v[242:245], v[226:229]
    buffer_load_dwordx4 v152, s[48:51], 0 offen offset:2048 lds
    s_add_u32 s48, s48, 36864
    v_mfma_f32_16x16x32_bf16 v[166:169], a[68:71], v[242:245], v[166:169]
    s_addc_u32 s49, s49, 0
    s_add_u32 m0, s68, 3072
    v_cvt_pk_f16_f32 v126, v218, v219
    v_pk_mul_f16 v202, v126, v126
    v_cvt_pk_f16_f32 v127, v220, v221
    v_pk_fma_f16 v202, v127, v127, v202
    v_cvt_pk_f16_f32 v128, v246, v247
    v_pk_fma_f16 v202, v128, v128, v202
    v_cvt_pk_f16_f32 v129, v248, v249
    v_pk_fma_f16 v202, v129, v129, v202
    v_cvt_pk_f16_f32 v118, v250, v251
    v_pk_fma_f16 v202, v118, v118, v202
    v_cvt_pk_f16_f32 v119, v252, v253
    v_pk_fma_f16 v202, v119, v119, v202
    v_pk_mul_f16 v204, v126, v186
    v_pk_fma_f16 v204, v127, v187, v204
    buffer_load_dwordx4 v132, s[48:51], 0 offen lds
    v_pk_fma_f16 v204, v128, v188, v204
    v_pk_fma_f16 v204, v129, v189, v204
    v_pk_fma_f16 v204, v118, v120, v204
    v_pk_fma_f16 v204, v119, v121, v204
    v_mov_b32 v205, v202
    v_cvt_pk_f16_f32 v142, v146, v147
    v_pk_mul_f16 v222, v142, v142
    v_mfma_f32_16x16x32_f16 v[170:173], v[40:43], v[202:205], 0
    v_cvt_pk_f16_f32 v143, v148, v149
    v_pk_fma_f16 v222, v143, v143, v222
    v_cvt_pk_f16_f32 v144, v226, v227
    v_pk_fma_f16 v222, v144, v144, v222
    v_cvt_pk_f16_f32 v145, v228, v229
    v_pk_fma_f16 v222, v145, v145, v222
    v_cvt_pk_f16_f32 v138, v166, v167
    v_pk_fma_f16 v222, v138, v138, v222
    v_rsq_f32 v170, v170
    v_rsq_f32 v171, v171
    v_mul_f32 v166, s31, v170
    v_cvt_pk_f16_f32 v167, v166, v171
    v_pk_mul_f16 v186, v186, v167 op_sel:[0,1] op_sel_hi:[1,1]
    v_pk_mul_f16 v187, v187, v167 op_sel:[0,1] op_sel_hi:[1,1]
    v_pk_mul_f16 v188, v188, v167 op_sel:[0,1] op_sel_hi:[1,1]
    v_pk_mul_f16 v189, v189, v167 op_sel:[0,1] op_sel_hi:[1,1]
    v_pk_mul_f16 v120, v120, v167 op_sel:[0,1] op_sel_hi:[1,1]
    v_pk_mul_f16 v121, v121, v167 op_sel:[0,1] op_sel_hi:[1,1]
    v_pk_mul_f16 v126, v126, v167 op_sel:[0,0] op_sel_hi:[1,0]
    v_pk_mul_f16 v127, v127, v167 op_sel:[0,0] op_sel_hi:[1,0]
    v_pk_mul_f16 v128, v128, v167 op_sel:[0,0] op_sel_hi:[1,0]
    v_pk_mul_f16 v129, v129, v167 op_sel:[0,0] op_sel_hi:[1,0]
    v_pk_mul_f16 v118, v118, v167 op_sel:[0,0] op_sel_hi:[1,0]
    v_pk_mul_f16 v119, v119, v167 op_sel:[0,0] op_sel_hi:[1,0]
    v_cndmask_b32 v170, 1.0, v170, s[94:95]
    v_cndmask_b32 v171, 1.0, v171, s[94:95]
    v_max3_u32 v44, v44, v170, v171
    v_mul_f32 v139, v172, v166
    v_fma_f32 v139, v139, v171, s39
    ds_write_b32 v157, v139 offset:192
    v_cvt_pk_f16_f32 v139, v168, v169
    v_pk_fma_f16 v222, v139, v139, v222
    v_pk_mul_f16 v224, v142, v214
    v_pk_fma_f16 v224, v143, v215, v224
    ds_write_b128 v159, v[186:189]
    v_pk_fma_f16 v224, v144, v216, v224
    v_pk_fma_f16 v224, v145, v217, v224
    v_pk_fma_f16 v224, v138, v140, v224
    v_pk_fma_f16 v224, v139, v141, v224
    v_mov_b32 v225, v222
    s_nop 0
    s_nop 0
    v_mfma_f32_16x16x32_f16 v[146:149], v[40:43], v[222:225], 0
    ds_write_b64 v159, v[120:121] offset:48
    s_nop 0
    s_nop 0
    s_nop 0
    ds_write_b128 v159, v[126:129] offset:32
    s_nop 0
    s_nop 0
    s_nop 0
    v_rsq_f32 v146, v146
    v_rsq_f32 v147, v147
    ds_write_b64 v159, v[118:119] offset:72
    v_mul_f32 v116, s31, v146
    v_cvt_pk_f16_f32 v117, v116, v147
    v_pk_mul_f16 v214, v214, v117 op_sel:[0,1] op_sel_hi:[1,1]
    v_pk_mul_f16 v215, v215, v117 op_sel:[0,1] op_sel_hi:[1,1]
    v_pk_mul_f16 v216, v216, v117 op_sel:[0,1] op_sel_hi:[1,1]
    v_pk_mul_f16 v217, v217, v117 op_sel:[0,1] op_sel_hi:[1,1]
    v_pk_mul_f16 v140, v140, v117 op_sel:[0,1] op_sel_hi:[1,1]
    v_pk_mul_f16 v141, v141, v117 op_sel:[0,1] op_sel_hi:[1,1]
    v_pk_mul_f16 v142, v142, v117 op_sel:[0,0] op_sel_hi:[1,0]
    v_pk_mul_f16 v143, v143, v117 op_sel:[0,0] op_sel_hi:[1,0]
    v_pk_mul_f16 v144, v144, v117 op_sel:[0,0] op_sel_hi:[1,0]
    v_pk_mul_f16 v145, v145, v117 op_sel:[0,0] op_sel_hi:[1,0]
    v_pk_mul_f16 v138, v138, v117 op_sel:[0,0] op_sel_hi:[1,0]
    v_pk_mul_f16 v139, v139, v117 op_sel:[0,0] op_sel_hi:[1,0]
    v_max3_u32 v44, v44, v146, v147
    v_mul_f32 v157, v148, v116
    v_fma_f32 v157, v157, v147, s39
    ds_write_b32 v255, v157 offset:192
    buffer_load_dwordx4 v150, s[48:51], 0 offen offset:1024 lds
    ds_write_b128 v135, v[214:217]
    buffer_load_dwordx4 v152, s[48:51], 0 offen offset:2048 lds
    ds_write_b64 v135, v[140:141] offset:48
    s_add_u32 s48, s48, 36864
    s_addc_u32 s49, s49, 0
    s_add_u32 m0, s69, 0
    ds_write_b128 v135, v[142:145] offset:32
    buffer_load_dwordx4 v132, s[48:51], 0 offen lds
    ds_write_b64 v135, v[138:139] offset:72
    buffer_load_dwordx4 v150, s[48:51], 0 offen offset:1024 lds
    buffer_load_dwordx4 v152, s[48:51], 0 offen offset:2048 lds
    s_waitcnt vmcnt(9)
    s_barrier
    ds_read_b128 v[126:129], v0 offset:20480
    ds_read_b128 v[170:173], v1 offset:20480
    ds_read_b128 v[174:177], v0 offset:20608
    s_add_u32 s48, s48, 36864
    s_addc_u32 s49, s49, 0
    ds_read_b128 v[178:181], v1 offset:20608
    s_add_u32 m0, s69, 3072
    ds_read_b128 v[182:185], v0 offset:20736
    ds_read_b128 v[186:189], v1 offset:20736
    buffer_load_dwordx4 v132, s[48:51], 0 offen lds
    s_waitcnt lgkmcnt(5)
    v_mfma_f32_16x16x32_bf16 v[118:121], a[72:75], v[126:129], 0
    s_waitcnt lgkmcnt(4)
    v_mfma_f32_16x16x32_bf16 v[118:121], a[76:79], v[170:173], v[118:121]
    s_waitcnt lgkmcnt(2)
    v_mfma_f32_16x16x32_bf16 v[118:121], a[80:83], v[174:177], v[118:121]
    s_waitcnt lgkmcnt(1)
    v_mfma_f32_16x16x32_bf16 v[118:121], a[84:87], v[178:181], v[118:121]
    s_waitcnt lgkmcnt(0)
    buffer_load_dwordx4 v150, s[48:51], 0 offen offset:1024 lds
    v_mfma_f32_16x16x32_bf16 v[118:121], a[88:91], v[182:185], v[118:121]
    v_mfma_f32_16x16x32_bf16 v[118:121], a[92:95], v[186:189], v[118:121]
    v_mfma_f32_16x16x32_bf16 v[190:193], a[96:99], v[126:129], 0
    s_waitcnt vmcnt(8)
    ds_read_b64_tr_b16 a[144:145], v123 offset:0
    ds_read_b64_tr_b16 a[146:147], v123 offset:768
    v_mfma_f32_16x16x32_bf16 v[190:193], a[100:103], v[170:173], v[190:193]
    ds_read_b64_tr_b16 a[168:169], v123 offset:32
    ds_read_b64_tr_b16 a[170:171], v123 offset:800
    v_mfma_f32_16x16x32_bf16 v[190:193], a[104:107], v[174:177], v[190:193]
    ds_read_b64_tr_b16 a[192:193], v123 offset:64
    buffer_load_dwordx4 v152, s[48:51], 0 offen offset:2048 lds
    v_mfma_f32_16x16x32_bf16 v[190:193], a[108:111], v[178:181], v[190:193]
    s_add_u32 s48, s48, 36864
    ds_read_b64_tr_b16 a[194:195], v123 offset:832
    v_cvt_pk_f16_f32 v146, v118, v119
    v_mfma_f32_16x16x32_bf16 v[190:193], a[112:115], v[182:185], v[190:193]
    s_addc_u32 s49, s49, 0
    v_pk_mul_f16 v143, v146, v146
    v_cvt_pk_f16_f32 v147, v120, v121
    v_mfma_f32_16x16x32_bf16 v[190:193], a[116:119], v[186:189], v[190:193]
    s_add_u32 m0, s68, 0
    v_pk_fma_f16 v143, v147, v147, v143
    v_mfma_f32_16x16x32_bf16 v[198:201], a[120:123], v[126:129], 0
    v_mfma_f32_16x16x32_bf16 v[198:201], a[124:127], v[170:173], v[198:201]
    v_mfma_f32_16x16x32_bf16 v[198:201], a[128:131], v[174:177], v[198:201]
    s_waitcnt lgkmcnt(4)
    v_mfma_f32_16x16x32_bf16 v[198:201], a[132:135], v[178:181], v[198:201]
    s_waitcnt lgkmcnt(2)
    v_cvt_pk_f16_f32 v148, v190, v191
    v_pk_fma_f16 v143, v148, v148, v143
    v_mfma_f32_16x16x32_bf16 v[198:201], a[136:139], v[182:185], v[198:201]
    s_waitcnt lgkmcnt(1)
    ds_read_b128 v[194:197], v0 offset:26624
    v_cvt_pk_f16_f32 v149, v192, v193
    v_mfma_f32_16x16x32_bf16 v[198:201], a[140:143], v[186:189], v[198:201]
    s_waitcnt lgkmcnt(1)
    buffer_load_dwordx4 v132, s[48:51], 0 offen lds
    ds_read_b128 v[190:193], v1 offset:26624
    v_mfma_f32_16x16x32_bf16 v[138:141], a[0:3], v[126:129], 0
    ds_read_b128 v[202:205], v0 offset:26752
    s_waitcnt vmcnt(7)
    v_mfma_f32_16x16x32_bf16 v[138:141], a[4:7], v[170:173], v[138:141]
    ds_read_b64_tr_b16 a[148:149], v123 offset:3072
    ds_read_b64_tr_b16 a[150:151], v123 offset:3840
    v_mfma_f32_16x16x32_bf16 v[138:141], a[8:11], v[174:177], v[138:141]
    ds_read_b64_tr_b16 a[172:173], v123 offset:3104
    ds_read_b64_tr_b16 a[174:175], v123 offset:3872
    v_mfma_f32_16x16x32_bf16 v[138:141], a[12:15], v[178:181], v[138:141]
    ds_read_b64_tr_b16 a[196:197], v123 offset:3136
    ds_read_b64_tr_b16 a[198:199], v123 offset:3904
    v_mfma_f32_16x16x32_bf16 v[138:141], a[16:19], v[182:185], v[138:141]
    ds_read_b128 v[206:209], v1 offset:26752
    buffer_load_dwordx4 v150, s[48:51], 0 offen offset:1024 lds
    v_mfma_f32_16x16x32_bf16 v[138:141], a[20:23], v[186:189], v[138:141]
    ds_read_b128 v[210:213], v0 offset:26880
    ds_read_b128 v[214:217], v1 offset:26880
    v_mfma_f32_16x16x32_bf16 v[166:169], a[24:27], v[126:129], 0
    s_waitcnt lgkmcnt(11)
    v_pk_fma_f16 v143, v149, v149, v143
    v_cvt_pk_f16_f32 v120, v198, v199
    v_mfma_f32_16x16x32_bf16 v[166:169], a[28:31], v[170:173], v[166:169]
    s_waitcnt lgkmcnt(10)
    v_pk_fma_f16 v143, v120, v120, v143
    v_cvt_pk_f16_f32 v121, v200, v201
    v_mfma_f32_16x16x32_bf16 v[166:169], a[32:35], v[174:177], v[166:169]
    s_waitcnt lgkmcnt(9)
    v_pk_fma_f16 v143, v121, v121, v143
    v_cvt_pk_f16_f32 v138, v138, v139
    v_mfma_f32_16x16x32_bf16 v[166:169], a[36:39], v[178:181], v[166:169]
    s_waitcnt lgkmcnt(7)
    v_pk_mul_f16 v142, v138, v138
    v_cvt_pk_f16_f32 v139, v140, v141
    v_mfma_f32_16x16x32_bf16 v[166:169], a[40:43], v[182:185], v[166:169]
    s_waitcnt lgkmcnt(5)
    buffer_load_dwordx4 v152, s[48:51], 0 offen offset:2048 lds
    v_pk_fma_f16 v142, v139, v139, v142
    v_mfma_f32_16x16x32_bf16 v[166:169], a[44:47], v[186:189], v[166:169]
    s_add_u32 s48, s48, 36864
    s_addc_u32 s49, s49, 0
    s_add_u32 m0, s68, 3072
    v_mfma_f32_16x16x32_bf16 v[134:137], a[48:51], v[126:129], 0
    s_waitcnt lgkmcnt(2)
    v_mfma_f32_16x16x32_bf16 v[134:137], a[52:55], v[170:173], v[134:137]
    s_waitcnt vmcnt(6)
    ds_read_b64_tr_b16 a[152:153], v124 offset:0
    ds_read_b64_tr_b16 a[154:155], v124 offset:768
    v_mfma_f32_16x16x32_bf16 v[134:137], a[56:59], v[174:177], v[134:137]
    s_waitcnt lgkmcnt(2)
    ds_read_b64_tr_b16 a[176:177], v124 offset:32
    ds_read_b64_tr_b16 a[178:179], v124 offset:800
    v_mfma_f32_16x16x32_bf16 v[134:137], a[60:63], v[178:181], v[134:137]
    ds_read_b64_tr_b16 a[200:201], v124 offset:64
    buffer_load_dwordx4 v132, s[48:51], 0 offen lds
    v_mfma_f32_16x16x32_bf16 v[134:137], a[64:67], v[182:185], v[134:137]
    ds_read_b64_tr_b16 a[202:203], v124 offset:832
    ds_read_b128 v[126:129], v0 offset:32768
    v_mfma_f32_16x16x32_bf16 v[134:137], a[68:71], v[186:189], v[134:137]
    ds_read_b128 v[170:173], v1 offset:32768
    v_cvt_pk_f16_f32 v140, v166, v167
    v_mfma_f32_16x16x32_bf16 v[174:177], a[72:75], v[194:197], 0
    ds_read_b128 v[178:181], v0 offset:32896
    v_pk_fma_f16 v142, v140, v140, v142
    v_mfma_f32_16x16x32_bf16 v[174:177], a[76:79], v[190:193], v[174:177]
    ds_read_b128 v[182:185], v1 offset:32896
    v_cvt_pk_f16_f32 v141, v168, v169
    v_mfma_f32_16x16x32_bf16 v[174:177], a[80:83], v[202:205], v[174:177]
    ds_read_b128 v[166:169], v0 offset:33024
    v_pk_fma_f16 v142, v141, v141, v142
    v_mfma_f32_16x16x32_bf16 v[174:177], a[84:87], v[206:209], v[174:177]
    s_waitcnt lgkmcnt(9)
    buffer_load_dwordx4 v150, s[48:51], 0 offen offset:1024 lds
    ds_read_b128 v[186:189], v1 offset:33024
    v_mfma_f32_16x16x32_bf16 v[174:177], a[88:91], v[210:213], v[174:177]
    s_waitcnt lgkmcnt(8)
    v_cvt_pk_f16_f32 v118, v134, v135
    v_pk_fma_f16 v142, v118, v118, v142
    v_mfma_f32_16x16x32_bf16 v[174:177], a[92:95], v[214:217], v[174:177]
    s_waitcnt lgkmcnt(7)
    v_cvt_pk_f16_f32 v119, v136, v137
    v_pk_fma_f16 v142, v119, v119, v142
    v_mfma_f32_16x16x32_bf16 v[134:137], a[96:99], v[194:197], 0
    s_waitcnt lgkmcnt(5)
    v_mov_b32 v144, v142
    v_mov_b32 v145, v142
    v_mfma_f32_16x16x32_bf16 v[134:137], a[100:103], v[190:193], v[134:137]
    s_waitcnt lgkmcnt(4)
    v_cvt_pk_f16_f32 v150, v174, v175
    v_pk_mul_f16 v175, v150, v150
    v_mfma_f32_16x16x32_f16 v[198:201], v[40:43], v[142:145], 0
    s_waitcnt vmcnt(5)
    ds_read_b64_tr_b16 a[156:157], v124 offset:3072
    buffer_load_dwordx4 v152, s[48:51], 0 offen offset:2048 lds
    v_mfma_f32_16x16x32_bf16 v[134:137], a[104:107], v[202:205], v[134:137]
    s_add_u32 m0, s69, 0
    ds_read_b64_tr_b16 a[158:159], v124 offset:3840
    ds_read_b64_tr_b16 a[180:181], v124 offset:3104
    v_mfma_f32_16x16x32_bf16 v[134:137], a[108:111], v[206:209], v[134:137]
    s_waitcnt lgkmcnt(4)
    ds_read_b64_tr_b16 a[182:183], v124 offset:3872
    ds_read_b64_tr_b16 a[204:205], v124 offset:3136
    v_mfma_f32_16x16x32_bf16 v[134:137], a[112:115], v[210:213], v[134:137]
    s_waitcnt lgkmcnt(5)
    ds_read_b64_tr_b16 a[206:207], v124 offset:3904
    v_cvt_pk_f16_f32 v151, v176, v177
    v_mfma_f32_16x16x32_bf16 v[134:137], a[116:119], v[214:217], v[134:137]
    v_rsq_f32 v198, v198
    v_mfma_f32_16x16x32_bf16 v[142:145], a[120:123], v[194:197], 0
    v_rsq_f32 v199, v199
    v_mfma_f32_16x16x32_bf16 v[142:145], a[124:127], v[190:193], v[142:145]
    buffer_load_dwordx4 v164, s[52:55], 0 offen lds
    v_mul_f32 v152, s31, v198
    v_mfma_f32_16x16x32_bf16 v[142:145], a[128:131], v[202:205], v[142:145]
    v_cvt_pk_f16_f32 v153, v152, v199
    v_pk_mul_f16 v146, v146, v153 op_sel:[0,1] op_sel_hi:[1,1]
    v_mfma_f32_16x16x32_bf16 v[142:145], a[132:135], v[206:209], v[142:145]
    s_waitcnt lgkmcnt(5)
    v_pk_mul_f16 v147, v147, v153 op_sel:[0,1] op_sel_hi:[1,1]
    v_pk_mul_f16 v148, v148, v153 op_sel:[0,1] op_sel_hi:[1,1]
    v_mfma_f32_16x16x32_bf16 v[142:145], a[136:139], v[210:213], v[142:145]
    s_waitcnt lgkmcnt(3)
    ds_read_b128 v[190:193], v155 offset:6144
    v_pk_mul_f16 v149, v149, v153 op_sel:[0,1] op_sel_hi:[1,1]
    v_mfma_f32_16x16x32_bf16 v[142:145], a[140:143], v[214:217], v[142:145]
    s_waitcnt lgkmcnt(2)
    ds_read_b128 v[194:197], v156 offset:6144
    v_pk_mul_f16 v120, v120, v153 op_sel:[0,1] op_sel_hi:[1,1]
    v_mfma_f32_16x16x32_bf16 v[202:205], a[72:75], v[126:129], 0
    s_waitcnt lgkmcnt(2)
    ds_read_b128 v[206:209], v155 offset:6272
    buffer_load_dwordx4 v165, s[52:55], 0 offen offset:1024 lds
    v_mfma_f32_16x16x32_bf16 v[202:205], a[76:79], v[170:173], v[202:205]
    ds_read_b128 v[210:213], v156 offset:6272
    v_pk_mul_f16 v121, v121, v153 op_sel:[0,1] op_sel_hi:[1,1]
    v_mfma_f32_16x16x32_bf16 v[202:205], a[80:83], v[178:181], v[202:205]
    ds_read_b128 v[214:217], v155 offset:6400
    v_pk_mul_f16 v138, v138, v153 op_sel:[0,0] op_sel_hi:[1,0]
    v_mfma_f32_16x16x32_bf16 v[202:205], a[84:87], v[182:185], v[202:205]
    ds_read_b128 v[218:221], v156 offset:6400
    v_pk_mul_f16 v139, v139, v153 op_sel:[0,0] op_sel_hi:[1,0]
    v_mfma_f32_16x16x32_bf16 v[202:205], a[88:91], v[166:169], v[202:205]
    v_pk_mul_f16 v140, v140, v153 op_sel:[0,0] op_sel_hi:[1,0]
    s_waitcnt vmcnt(5)
    v_mfma_f32_16x16x32_bf16 v[202:205], a[92:95], v[186:189], v[202:205]
    ds_read_b64_tr_b16 a[160:161], v123 offset:0
    ds_read_b64_tr_b16 a[162:163], v123 offset:768
    v_mfma_f32_16x16x32_bf16 v[222:225], a[96:99], v[126:129], 0
    s_waitcnt lgkmcnt(7)
    buffer_load_dwordx4 v131, s[52:55], 0 offen offset:2048 lds
    ds_read_b64_tr_b16 a[184:185], v123 offset:32
    v_mfma_f32_16x16x32_bf16 v[222:225], a[100:103], v[170:173], v[222:225]
    s_add_u32 s52, s52, 12288
    ds_read_b64_tr_b16 a[186:187], v123 offset:800
    ds_read_b64_tr_b16 a[208:209], v123 offset:64
    v_mfma_f32_16x16x32_bf16 v[222:225], a[104:107], v[178:181], v[222:225]
    s_addc_u32 s53, s53, 0
    ds_read_b64_tr_b16 a[210:211], v123 offset:832
    v_pk_mul_f16 v141, v141, v153 op_sel:[0,0] op_sel_hi:[1,0]
    v_mfma_f32_16x16x32_bf16 v[222:225], a[108:111], v[182:185], v[222:225]
    s_add_u32 m0, s69, 3072
    v_pk_mul_f16 v118, v118, v153 op_sel:[0,0] op_sel_hi:[1,0]
    v_pk_mul_f16 v119, v119, v153 op_sel:[0,0] op_sel_hi:[1,0]
    v_mfma_f32_16x16x32_bf16 v[222:225], a[112:115], v[166:169], v[222:225]
    s_waitcnt lgkmcnt(7)
    v_max3_u32 v44, v44, v198, v199
    v_pk_fma_f16 v175, v151, v151, v175
    v_mfma_f32_16x16x32_bf16 v[222:225], a[116:119], v[186:189], v[222:225]
    s_waitcnt lgkmcnt(6)
    v_cvt_pk_f16_f32 v152, v134, v135
    v_pk_fma_f16 v175, v152, v152, v175
    v_mfma_f32_16x16x32_bf16 v[198:201], a[120:123], v[126:129], 0
    buffer_load_dwordx4 v164, s[52:55], 0 offen lds
    v_cvt_pk_f16_f32 v153, v136, v137
    v_mfma_f32_16x16x32_bf16 v[198:201], a[124:127], v[170:173], v[198:201]
    s_waitcnt lgkmcnt(4)
    v_pk_fma_f16 v175, v153, v153, v175
    v_cvt_pk_f16_f32 v124, v142, v143
    v_mfma_f32_16x16x32_bf16 v[198:201], a[128:131], v[178:181], v[198:201]
    s_waitcnt lgkmcnt(3)
    v_pk_fma_f16 v175, v124, v124, v175
    v_cvt_pk_f16_f32 v125, v144, v145
    v_mfma_f32_16x16x32_bf16 v[198:201], a[132:135], v[182:185], v[198:201]
    s_waitcnt lgkmcnt(1)
    v_pk_fma_f16 v175, v125, v125, v175
    v_cvt_pk_f16_f32 v126, v202, v203
    v_mfma_f32_16x16x32_bf16 v[198:201], a[136:139], v[166:169], v[198:201]
    s_waitcnt lgkmcnt(0)
    ds_read_b128 v[134:137], v155 offset:0
    v_pk_mul_f16 v115, v126, v126
    v_mfma_f32_16x16x32_bf16 v[198:201], a[140:143], v[186:189], v[198:201]
    ds_read_b128 v[142:145], v156 offset:0
    buffer_load_dwordx4 v165, s[52:55], 0 offen offset:1024 lds
    v_mfma_f32_16x16x32_bf16 v[166:169], v[190:193], a[144:147], 0
    ds_read_b128 v[170:173], v155 offset:128
    v_cvt_pk_f16_f32 v127, v204, v205
    v_mfma_f32_16x16x32_bf16 v[166:169], v[194:197], a[148:151], v[166:169]
    ds_read_b128 v[178:181], v156 offset:128
    v_pk_fma_f16 v115, v127, v127, v115
    v_mfma_f32_16x16x32_bf16 v[166:169], v[206:209], a[152:155], v[166:169]
    ds_read_b128 v[182:185], v155 offset:256
    v_cvt_pk_f16_f32 v128, v222, v223
    s_waitcnt vmcnt(5)
    v_mfma_f32_16x16x32_bf16 v[166:169], v[210:213], a[156:159], v[166:169]
    ds_read_b64_tr_b16 a[164:165], v123 offset:3072
    ds_read_b64_tr_b16 a[166:167], v123 offset:3840
    v_mfma_f32_16x16x32_bf16 v[166:169], v[214:217], a[160:163], v[166:169]
    ds_read_b64_tr_b16 a[188:189], v123 offset:3104
    buffer_load_dwordx4 v131, s[52:55], 0 offen offset:2048 lds
    v_mfma_f32_16x16x32_bf16 v[186:189], v[190:193], a[168:171], 0
    s_waitcnt lgkmcnt(7)
    ds_read_b64_tr_b16 a[190:191], v123 offset:3872
    ds_read_b64_tr_b16 a[212:213], v123 offset:3136
    v_mfma_f32_16x16x32_bf16 v[186:189], v[194:197], a[172:175], v[186:189]
    s_add_u32 s52, s52, 12288
    ds_read_b64_tr_b16 a[214:215], v123 offset:3904
    ds_read_b128 v[202:205], v156 offset:256
    v_mfma_f32_16x16x32_bf16 v[186:189], v[206:209], a[176:179], v[186:189]
    s_addc_u32 s53, s53, 0
    v_pk_fma_f16 v115, v128, v128, v115
    v_cvt_pk_f16_f32 v129, v224, v225
    v_mfma_f32_16x16x32_bf16 v[186:189], v[210:213], a[180:183], v[186:189]
    s_add_u32 m0, s68, 0
    v_pk_fma_f16 v115, v129, v129, v115
    v_cvt_pk_f16_f32 v156, v198, v199
    v_mfma_f32_16x16x32_bf16 v[186:189], v[214:217], a[184:187], v[186:189]
    s_waitcnt lgkmcnt(7)
    v_pk_fma_f16 v115, v156, v156, v115
    v_cvt_pk_f16_f32 v157, v200, v201
    v_mfma_f32_16x16x32_bf16 v[198:201], v[190:193], a[192:195], 0
    buffer_load_dwordx4 v164, s[52:55], 0 offen lds
    v_pk_fma_f16 v115, v157, v157, v115
    v_mfma_f32_16x16x32_bf16 v[198:201], v[194:197], a[196:199], v[198:201]
    s_waitcnt lgkmcnt(5)
    v_xor_b32 v255, 65536, v2
    v_lshrrev_b32 v132, 2, v255
    v_mfma_f32_16x16x32_bf16 v[166:169], v[218:221], a[164:167], v[166:169]
    s_waitcnt lgkmcnt(4)
    v_lshrrev_b32 v159, 8, v255
    v_lshl_add_u32 v160, s16, 2, v255
    v_mfma_f32_16x16x32_bf16 v[198:201], v[206:209], a[200:203], v[198:201]
    s_waitcnt lgkmcnt(2)
    v_add_u32 v132, 62784, v132
    v_lshlrev_b32 v159, 4, v159
    v_mfma_f32_16x16x32_bf16 v[186:189], v[218:221], a[188:191], v[186:189]
    s_waitcnt lgkmcnt(0)
    v_cvt_pk_bf16_f32 v166, v166, v166
    v_cvt_pk_bf16_f32 v167, v167, v167
    v_mfma_f32_16x16x32_bf16 v[198:201], v[210:213], a[204:207], v[198:201]
    s_barrier
    ds_write2_b32 v161, v166, v167 offset0:0 offset1:68
    v_mfma_f32_16x16x32_bf16 v[198:201], v[214:217], a[208:211], v[198:201]
    buffer_load_dwordx4 v165, s[52:55], 0 offen offset:1024 lds
    v_cvt_pk_bf16_f32 v168, v168, v168
    v_mfma_f32_16x16x32_bf16 v[198:201], v[218:221], a[212:215], v[198:201]
    v_cvt_pk_bf16_f32 v169, v169, v169
    v_cvt_pk_bf16_f32 v186, v186, v186
    v_mfma_f32_16x16x32_bf16 v[190:193], v[134:137], a[144:147], 0
    ds_write2_b32 v161, v168, v169 offset0:136 offset1:204
    s_waitcnt vmcnt(5)
    v_mfma_f32_16x16x32_bf16 v[190:193], v[142:145], a[148:151], v[190:193]
    v_cvt_pk_bf16_f32 v187, v187, v187
    v_cvt_pk_bf16_f32 v188, v188, v188
    v_mfma_f32_16x16x32_bf16 v[190:193], v[170:173], a[152:155], v[190:193]
    ds_read_b64 a[216:217], v114 offset:0
    ds_read_b64 a[218:219], v114 offset:1536
    v_mfma_f32_16x16x32_bf16 v[190:193], v[178:181], a[156:159], v[190:193]
    buffer_load_dwordx4 v131, s[52:55], 0 offen offset:2048 lds
    ds_read_b64 a[240:241], v114 offset:8
    v_mfma_f32_16x16x32_bf16 v[190:193], v[182:185], a[160:163], v[190:193]
    s_add_u32 s52, s52, 12288
    ds_read_b64 a[242:243], v114 offset:1544
    ds_read_b64 v[90:91], v254 offset:0
    v_mfma_f32_16x16x32_bf16 v[190:193], v[202:205], a[164:167], v[190:193]
    s_addc_u32 s53, s53, 0
    ds_read_b64 v[92:93], v254 offset:1536
    ds_read_b128 v[166:169], v0 offset:26624
    v_mfma_f32_16x16x32_bf16 v[194:197], v[134:137], a[168:171], 0
    s_add_u32 m0, s68, 3072
    ds_read_b128 v[206:209], v1 offset:26624
    v_cvt_pk_bf16_f32 v189, v189, v189
    v_mfma_f32_16x16x32_bf16 v[194:197], v[142:145], a[172:175], v[194:197]
    s_mul_i32 s68, s78, 72
    ds_read_b128 v[210:213], v0 offset:26752
    v_cvt_pk_bf16_f32 v198, v198, v198
    v_mfma_f32_16x16x32_bf16 v[194:197], v[170:173], a[176:179], v[194:197]
    s_sub_u32 s68, s77, s68
    ds_read_b128 v[214:217], v1 offset:26752
    buffer_load_dwordx4 v164, s[52:55], 0 offen lds
    v_mfma_f32_16x16x32_bf16 v[194:197], v[178:181], a[180:183], v[194:197]
    s_mul_i32 s78, s78, 1373568
    ds_read_b128 v[218:221], v0 offset:26880
    v_cvt_pk_bf16_f32 v199, v199, v199
    v_mfma_f32_16x16x32_bf16 v[194:197], v[182:185], a[184:187], v[194:197]
    s_mul_i32 s77, s68, 2688
    ds_read_b128 v[222:225], v1 offset:26880
    v_cvt_pk_bf16_f32 v200, v200, v200
    v_mfma_f32_16x16x32_bf16 v[194:197], v[202:205], a[188:191], v[194:197]
    s_add_u32 s77, s77, s78
    ds_write2_b32 v161, v186, v187 offset0:16 offset1:84
    v_mfma_f32_16x16x32_bf16 v[226:229], v[134:137], a[192:195], 0
    s_waitcnt lgkmcnt(7)
    v_cvt_pk_bf16_f32 v201, v201, v201
    v_cvt_pk_bf16_f32 v190, v190, v190
    v_mfma_f32_16x16x32_bf16 v[226:229], v[142:145], a[196:199], v[226:229]
    s_waitcnt lgkmcnt(5)
    ds_write2_b32 v161, v188, v189 offset0:152 offset1:220
    v_mfma_f32_16x16x32_bf16 v[226:229], v[170:173], a[200:203], v[226:229]
    s_waitcnt lgkmcnt(5)
    buffer_load_dwordx4 v165, s[52:55], 0 offen offset:1024 lds
    v_cvt_pk_bf16_f32 v191, v191, v191
    v_mfma_f32_16x16x32_bf16 v[226:229], v[178:181], a[204:207], v[226:229]
    s_waitcnt lgkmcnt(4)
    ds_write2_b32 v161, v198, v199 offset0:32 offset1:100
    v_mfma_f32_16x16x32_bf16 v[226:229], v[182:185], a[208:211], v[226:229]
    s_waitcnt lgkmcnt(4)
    s_waitcnt vmcnt(5)
    v_cvt_pk_bf16_f32 v192, v192, v192
    v_mfma_f32_16x16x32_bf16 v[226:229], v[202:205], a[212:215], v[226:229]
    s_waitcnt lgkmcnt(3)
    ds_read_b64 a[232:233], v114 offset:3072
    ds_read_b64 a[220:221], v114 offset:4608
    v_mfma_f32_16x16x32_bf16 v[134:137], a[0:3], v[166:169], 0
    ds_read_b64 v[82:83], v114 offset:3080
    ds_read_b64 a[244:245], v114 offset:4616
    v_mfma_f32_16x16x32_bf16 v[134:137], a[4:7], v[206:209], v[134:137]
    buffer_load_dwordx4 v131, s[52:55], 0 offen offset:2048 lds
    ds_read_b64 v[106:107], v254 offset:3072
    v_mfma_f32_16x16x32_bf16 v[134:137], a[8:11], v[210:213], v[134:137]
    s_add_u32 s52, s52, 12288
    ds_read_b64 v[94:95], v254 offset:4608
    v_cvt_pk_bf16_f32 v193, v193, v193
    v_mfma_f32_16x16x32_bf16 v[134:137], a[12:15], v[214:217], v[134:137]
    s_addc_u32 s53, s53, 0
    ds_write2_b32 v161, v200, v201 offset0:168 offset1:236
    v_mfma_f32_16x16x32_bf16 v[134:137], a[16:19], v[218:221], v[134:137]
    s_add_u32 m0, s69, 0
    v_cvt_pk_bf16_f32 v194, v194, v194
    v_cvt_pk_bf16_f32 v195, v195, v195
    v_mfma_f32_16x16x32_bf16 v[134:137], a[20:23], v[222:225], v[134:137]
    ds_write2_b32 v158, v190, v191 offset0:0 offset1:68
    v_mfma_f32_16x16x32_bf16 v[142:145], a[24:27], v[166:169], 0
    s_waitcnt lgkmcnt(6)
    buffer_load_dwordx4 v164, s[52:55], 0 offen lds
    v_cvt_pk_bf16_f32 v196, v196, v196
    v_mfma_f32_16x16x32_bf16 v[142:145], a[28:31], v[206:209], v[142:145]
    s_waitcnt lgkmcnt(4)
    ds_write2_b32 v158, v192, v193 offset0:136 offset1:204
    v_mfma_f32_16x16x32_bf16 v[142:145], a[32:35], v[210:213], v[142:145]
    s_waitcnt lgkmcnt(4)
    v_cvt_pk_bf16_f32 v197, v197, v197
    v_cvt_pk_bf16_f32 v226, v226, v226
    v_mfma_f32_16x16x32_bf16 v[142:145], a[36:39], v[214:217], v[142:145]
    s_waitcnt lgkmcnt(3)
    ds_write2_b32 v158, v194, v195 offset0:16 offset1:84
    v_mfma_f32_16x16x32_bf16 v[142:145], a[40:43], v[218:221], v[142:145]
    v_cvt_pk_bf16_f32 v227, v227, v227
    v_cvt_pk_bf16_f32 v228, v228, v228
    v_mfma_f32_16x16x32_bf16 v[142:145], a[44:47], v[222:225], v[142:145]
    buffer_load_dwordx4 v165, s[52:55], 0 offen offset:1024 lds
    v_cvt_pk_bf16_f32 v229, v229, v229
    v_mfma_f32_16x16x32_bf16 v[170:173], a[48:51], v[166:169], 0
    ds_write2_b32 v158, v196, v197 offset0:152 offset1:220
    v_mfma_f32_16x16x32_bf16 v[170:173], a[52:55], v[206:209], v[170:173]
    v_cvt_pk_f16_f32 v134, v134, v135
    v_pk_mul_f16 v174, v134, v134
    v_mfma_f32_16x16x32_bf16 v[170:173], a[56:59], v[210:213], v[170:173]
    ds_write2_b32 v158, v226, v227 offset0:32 offset1:100
    s_waitcnt vmcnt(5)
    v_mfma_f32_16x16x32_bf16 v[170:173], a[60:63], v[214:217], v[170:173]
    v_cvt_pk_f16_f32 v135, v136, v137
    v_pk_fma_f16 v174, v135, v135, v174
    v_mfma_f32_16x16x32_bf16 v[170:173], a[64:67], v[218:221], v[170:173]
    buffer_load_dwordx4 v131, s[52:55], 0 offen offset:2048 lds
    ds_read_b64 a[222:223], v130 offset:0
    v_mfma_f32_16x16x32_bf16 v[170:173], a[68:71], v[222:225], v[170:173]
    s_add_u32 s52, s52, 12288
    ds_read_b64 a[234:235], v130 offset:1536
    ds_read_b64 a[246:247], v130 offset:8
    v_mfma_f32_16x16x32_bf16 v[178:181], v[166:169], a[144:147], 0
    s_addc_u32 s53, s53, 0
    ds_read_b64 v[84:85], v130 offset:1544
    ds_read_b64 v[96:97], v133 offset:0
    v_mfma_f32_16x16x32_bf16 v[178:181], v[206:209], a[148:151], v[178:181]
    s_add_u32 m0, s69, 3072
    ds_read_b64 v[108:109], v133 offset:1536
    v_cvt_pk_f16_f32 v136, v142, v143
    v_mfma_f32_16x16x32_bf16 v[178:181], v[210:213], a[152:155], v[178:181]
    s_add_u32 s69, s77, 589824
    ds_write2_b32 v158, v228, v229 offset0:168 offset1:236
    v_mfma_f32_16x16x32_bf16 v[178:181], v[214:217], a[156:159], v[178:181]
    buffer_load_dwordx4 v164, s[52:55], 0 offen lds
    v_pk_fma_f16 v174, v136, v136, v174
    v_mfma_f32_16x16x32_bf16 v[178:181], v[218:221], a[160:163], v[178:181]
    v_cvt_pk_f16_f32 v137, v144, v145
    v_pk_fma_f16 v174, v137, v137, v174
    v_mfma_f32_16x16x32_bf16 v[178:181], v[222:225], a[164:167], v[178:181]
    ds_read_b128 v[142:145], v0 offset:20480
    v_cvt_pk_f16_f32 v122, v170, v171
    v_mfma_f32_16x16x32_bf16 v[182:185], v[166:169], a[168:171], 0
    s_waitcnt lgkmcnt(6)
    ds_read_b128 v[186:189], v1 offset:20480
    v_pk_fma_f16 v174, v122, v122, v174
    v_mfma_f32_16x16x32_bf16 v[182:185], v[206:209], a[172:175], v[182:185]
    s_waitcnt lgkmcnt(5)
    ds_read_b128 v[190:193], v0 offset:20608
    v_cvt_pk_f16_f32 v123, v172, v173
    v_mfma_f32_16x16x32_bf16 v[182:185], v[210:213], a[176:179], v[182:185]
    s_waitcnt lgkmcnt(4)
    ds_read_b128 v[170:173], v1 offset:20608
    buffer_load_dwordx4 v165, s[52:55], 0 offen offset:1024 lds
    v_mfma_f32_16x16x32_bf16 v[182:185], v[214:217], a[180:183], v[182:185]
    ds_read_b128 v[194:197], v0 offset:20736
    v_pk_fma_f16 v174, v123, v123, v174
    v_mfma_f32_16x16x32_bf16 v[182:185], v[218:221], a[184:187], v[182:185]
    ds_read_b128 v[198:201], v1 offset:20736
    v_mov_b32 v176, v174
    v_mfma_f32_16x16x32_bf16 v[182:185], v[222:225], a[188:191], v[182:185]
    v_mov_b32 v177, v174
    v_cvt_pk_bf16_f32 v204, v178, v179
    v_mfma_f32_16x16x32_bf16 v[226:229], v[166:169], a[192:195], 0
    v_cvt_pk_bf16_f32 v205, v180, v181
    s_waitcnt vmcnt(5)
    v_mfma_f32_16x16x32_f16 v[166:169], v[40:43], v[174:177], 0
    s_waitcnt lgkmcnt(5)
    ds_read_b64 a[224:225], v130 offset:3072
    ds_read_b64 a[226:227], v130 offset:4608
    v_mfma_f32_16x16x32_bf16 v[226:229], v[206:209], a[196:199], v[226:229]
    s_waitcnt lgkmcnt(6)
    buffer_load_dwordx4 v131, s[52:55], 0 offen offset:2048 lds
    ds_read_b64 a[248:249], v130 offset:3080
    v_mfma_f32_16x16x32_bf16 v[226:229], v[210:213], a[200:203], v[226:229]
    s_add_u32 m0, s28, 65536
    ds_read_b64 a[250:251], v130 offset:4616
    ds_read_b64 v[98:99], v133 offset:3072
    v_mfma_f32_16x16x32_bf16 v[226:229], v[214:217], a[204:207], v[226:229]
    s_waitcnt lgkmcnt(7)
    ds_read_b64 v[100:101], v133 offset:4608
    v_cvt_pk_bf16_f32 v168, v182, v183
    v_mfma_f32_16x16x32_bf16 v[226:229], v[218:221], a[208:211], v[226:229]
    s_waitcnt lgkmcnt(7)
    v_rsq_f32 v166, v166
    v_mfma_f32_16x16x32_bf16 v[226:229], v[222:225], a[212:215], v[226:229]
    s_waitcnt lgkmcnt(6)
    v_rsq_f32 v167, v167
    v_mfma_f32_16x16x32_bf16 v[174:177], v[142:145], a[144:147], 0
    v_mul_f32 v116, s31, v166
    v_cvt_pk_f16_f32 v117, v116, v167
    v_mfma_f32_16x16x32_bf16 v[174:177], v[186:189], a[148:151], v[174:177]
    buffer_load_dwordx4 v10, s[8:11], s24 offen nt lds
    v_mfma_f32_16x16x32_bf16 v[174:177], v[190:193], a[152:155], v[174:177]
    s_add_u32 m0, s28, 69632
    v_pk_mul_f16 v150, v150, v117 op_sel:[0,1] op_sel_hi:[1,1]
    v_pk_mul_f16 v151, v151, v117 op_sel:[0,1] op_sel_hi:[1,1]
    v_mfma_f32_16x16x32_bf16 v[174:177], v[170:173], a[156:159], v[174:177]
    s_waitcnt lgkmcnt(3)
    v_pk_mul_f16 v152, v152, v117 op_sel:[0,1] op_sel_hi:[1,1]
    v_pk_mul_f16 v153, v153, v117 op_sel:[0,1] op_sel_hi:[1,1]
    v_mfma_f32_16x16x32_bf16 v[174:177], v[194:197], a[160:163], v[174:177]
    s_waitcnt lgkmcnt(1)
    v_pk_mul_f16 v124, v124, v117 op_sel:[0,1] op_sel_hi:[1,1]
    v_pk_mul_f16 v125, v125, v117 op_sel:[0,1] op_sel_hi:[1,1]
    v_mfma_f32_16x16x32_bf16 v[174:177], v[198:201], a[164:167], v[174:177]
    s_waitcnt lgkmcnt(0)
    ds_read_b128 v[178:181], v0 offset:32768
    v_pk_mul_f16 v134, v134, v117 op_sel:[0,0] op_sel_hi:[1,0]
    v_mfma_f32_16x16x32_bf16 v[206:209], v[142:145], a[168:171], 0
    ds_read_b128 v[210:213], v1 offset:32768
    v_pk_mul_f16 v135, v135, v117 op_sel:[0,0] op_sel_hi:[1,0]
    v_mfma_f32_16x16x32_bf16 v[206:209], v[186:189], a[172:175], v[206:209]
    buffer_load_dwordx4 v11, s[8:11], s24 offen nt lds
    v_mfma_f32_16x16x32_bf16 v[206:209], v[190:193], a[176:179], v[206:209]
    s_add_u32 m0, s28, 73728
    ds_read_b128 v[214:217], v0 offset:32896
    ds_read_b128 v[218:221], v1 offset:32896
    v_mfma_f32_16x16x32_bf16 v[206:209], v[170:173], a[180:183], v[206:209]
    ds_read_b128 v[222:225], v0 offset:33024
    v_pk_mul_f16 v136, v136, v117 op_sel:[0,0] op_sel_hi:[1,0]
    v_mfma_f32_16x16x32_bf16 v[206:209], v[194:197], a[184:187], v[206:209]
    ds_read_b128 v[230:233], v1 offset:33024
    s_waitcnt vmcnt(5)
    v_mfma_f32_16x16x32_bf16 v[206:209], v[198:201], a[188:191], v[206:209]
    ds_read_b64 a[236:237], v114 offset:0
    ds_read_b64 a[228:229], v114 offset:1536
    v_mfma_f32_16x16x32_bf16 v[234:237], v[142:145], a[192:195], 0
    ds_read_b64 v[86:87], v114 offset:8
    ds_read_b64 a[252:253], v114 offset:1544
    v_mfma_f32_16x16x32_bf16 v[234:237], v[186:189], a[196:199], v[234:237]
    s_waitcnt lgkmcnt(9)
    buffer_load_dwordx4 v12, s[8:11], s24 offen nt lds
    v_mfma_f32_16x16x32_bf16 v[234:237], v[190:193], a[200:203], v[234:237]
    s_add_u32 m0, s28, 77824
    ds_read_b64 v[110:111], v254 offset:0
    ds_read_b64 v[102:103], v254 offset:1536
    v_mfma_f32_16x16x32_bf16 v[234:237], v[170:173], a[204:207], v[234:237]
    s_waitcnt lgkmcnt(10)
    ds_read_b128 v[142:145], v154 offset:0
    ds_read_b128 v[170:173], v154 offset:16
    v_mfma_f32_16x16x32_bf16 v[234:237], v[194:197], a[208:211], v[234:237]
    s_waitcnt lgkmcnt(10)
    ds_read_b128 v[186:189], v154 offset:48
    ds_read_b32 v158, v6 offset:192
    v_mfma_f32_16x16x32_bf16 v[234:237], v[198:201], a[212:215], v[234:237]
    s_waitcnt lgkmcnt(11)
    v_pk_mul_f16 v137, v137, v117 op_sel:[0,0] op_sel_hi:[1,0]
    v_pk_mul_f16 v122, v122, v117 op_sel:[0,0] op_sel_hi:[1,0]
    v_mfma_f32_16x16x32_bf16 v[190:193], a[0:3], v[178:181], 0
    s_waitcnt lgkmcnt(10)
    v_pk_mul_f16 v123, v123, v117 op_sel:[0,0] op_sel_hi:[1,0]
    v_max3_u32 v44, v44, v166, v167
    v_mfma_f32_16x16x32_bf16 v[190:193], a[4:7], v[210:213], v[190:193]
    s_waitcnt lgkmcnt(8)
    buffer_load_dwordx4 v13, s[8:11], s24 offen nt lds
    v_mfma_f32_16x16x32_bf16 v[190:193], a[8:11], v[214:217], v[190:193]
    s_add_u32 m0, s74, 0
    v_cvt_pk_bf16_f32 v169, v184, v185
    v_cvt_pk_bf16_f32 v184, v226, v227
    v_mfma_f32_16x16x32_bf16 v[190:193], a[12:15], v[218:221], v[190:193]
    s_waitcnt lgkmcnt(6)
    v_cvt_pk_bf16_f32 v185, v228, v229
    v_cvt_pk_bf16_f32 v202, v174, v175
    v_mfma_f32_16x16x32_bf16 v[190:193], a[16:19], v[222:225], v[190:193]
    s_waitcnt lgkmcnt(4)
    v_cvt_pk_bf16_f32 v203, v176, v177
    v_cvt_pk_bf16_f32 v166, v206, v207
    v_mfma_f32_16x16x32_bf16 v[190:193], a[20:23], v[230:233], v[190:193]
    s_waitcnt lgkmcnt(2)
    v_cvt_pk_bf16_f32 v167, v208, v209
    v_cvt_pk_bf16_f32 v182, v234, v235
    v_mfma_f32_16x16x32_bf16 v[174:177], a[24:27], v[178:181], 0
    s_waitcnt lgkmcnt(0)
    v_cvt_pk_bf16_f32 v183, v236, v237
    v_xor_b32 v0, 65536, v0
    v_mfma_f32_16x16x32_bf16 v[174:177], a[28:31], v[210:213], v[174:177]
    buffer_load_dwordx4 v14, s[8:11], s24 offen nt lds
    v_mfma_f32_16x16x32_bf16 v[174:177], a[32:35], v[214:217], v[174:177]
    s_add_u32 s8, s60, s23
    v_cvt_pk_f16_f32 v190, v190, v191
    s_waitcnt vmcnt(5)
    v_mfma_f32_16x16x32_bf16 v[174:177], a[36:39], v[218:221], v[174:177]
    s_addc_u32 s9, s61, 0
    ds_read_b64 a[230:231], v114 offset:3072
    ds_read_b64 a[238:239], v114 offset:4608
    v_mfma_f32_16x16x32_bf16 v[174:177], a[40:43], v[222:225], v[174:177]
    s_sub_u32 s10, s36, s23
    ds_read_b64 a[254:255], v114 offset:3080
    ds_read_b64 v[88:89], v114 offset:4616
    v_mfma_f32_16x16x32_bf16 v[174:177], a[44:47], v[230:233], v[174:177]
    s_cmp_lt_u32 s34, s17
    ds_read_b64 v[104:105], v254 offset:3072
    ds_read_b64 v[112:113], v254 offset:4608
    v_mfma_f32_16x16x32_bf16 v[194:197], a[48:51], v[178:181], 0
    s_cselect_b32 s10, s10, 0
    v_pk_mul_f16 v114, v190, v190
    v_cvt_pk_f16_f32 v191, v192, v193
    v_mfma_f32_16x16x32_bf16 v[194:197], a[52:55], v[210:213], v[194:197]
    s_add_u32 m0, s28, 0
    v_pk_fma_f16 v114, v191, v191, v114
    v_cvt_pk_f16_f32 v192, v174, v175
    v_mfma_f32_16x16x32_f16 v[198:201], v[146:149], v[138:141], v[46:49]
    s_mov_b32 s24, s23
    v_pk_fma_f16 v114, v192, v192, v114
    v_cvt_pk_f16_f32 v193, v176, v177
    v_mfma_f32_16x16x32_f16 v[174:177], v[150:153], v[138:141], v[50:53]
    s_add_u32 s23, s23, s21
    v_pk_fma_f16 v114, v193, v193, v114
    v_xor_b32 v1, 65536, v1
    v_add_u32 v159, 62784, v159
    v_mfma_f32_16x16x16_f16 v[198:201], v[120:121], v[118:119], v[198:201]
    v_or_b32 v206, v32, v33
    v_and_b32 v206, 0xffff, v206
    v_lshl_or_b32 v206, v206, 16, v206
    v_mfma_f32_16x16x16_f16 v[174:177], v[124:125], v[118:119], v[174:177]
    v_or_b32 v207, v32, v33
    v_and_b32 v207, 0xffff, v207
    v_lshl_or_b32 v207, v207, 16, v207
    v_or_b32 v208, v32, v33
    v_mfma_f32_16x16x32_bf16 v[194:197], a[56:59], v[214:217], v[194:197]
    s_cmp_ge_u32 s19, 72
    v_exp_f32 v198, v198
    v_mfma_f32_16x16x32_bf16 v[194:197], a[60:63], v[218:221], v[194:197]
    s_cselect_b32 s34, 72, 0
    v_exp_f32 v199, v199
    v_mfma_f32_16x16x32_bf16 v[194:197], a[64:67], v[222:225], v[194:197]
    s_cselect_b32 s35, s22, 0
    v_cvt_pk_bf16_f32 v198, v198, v199
    v_lshrrev_b32 v208, 16, v208
    v_mfma_f32_16x16x32_bf16 v[194:197], a[68:71], v[230:233], v[194:197]
    s_sub_u32 s19, s19, s34
    v_exp_f32 v200, v200
    v_mfma_f32_16x16x32_bf16 v[226:229], v[178:181], a[144:147], 0
    s_add_u32 s23, s23, s35
    v_exp_f32 v201, v201
    v_mfma_f32_16x16x32_bf16 v[226:229], v[210:213], a[148:151], v[226:229]
    s_waitcnt lgkmcnt(0)
    v_cvt_pk_bf16_f32 v199, v200, v201
    v_cvt_pk_f16_f32 v154, v194, v195
    v_mfma_f32_16x16x32_bf16 v[226:229], v[214:217], a[152:155], v[226:229]
    v_pk_fma_f16 v114, v154, v154, v114
    v_cvt_pk_f16_f32 v155, v196, v197
    v_mfma_f32_16x16x32_bf16 v[226:229], v[218:221], a[156:159], v[226:229]
    v_pk_fma_f16 v114, v155, v155, v114
    v_mov_b32 v116, v114
    v_mfma_f32_16x16x32_f16 v[194:197], v[142:145], v[138:141], v[22:25]
    v_mov_b32 v117, v114
    v_lshl_or_b32 v208, v208, 16, v208
    v_mfma_f32_16x16x32_f16 v[194:197], v[170:173], v[146:149], v[194:197]
    v_exp_f32 v174, v174
    v_mfma_f32_16x16x32_f16 v[234:237], v[40:43], v[114:117], 0
    v_exp_f32 v175, v175
    v_mfma_f32_16x16x32_f16 v[194:197], v[186:189], v[118:121], v[194:197]
    v_cvt_pk_bf16_f32 v200, v174, v175
    v_or_b32 v209, v32, v33
    v_mfma_f32_16x16x32_bf16 v[226:229], v[222:225], a[160:163], v[226:229]
    v_exp_f32 v176, v176
    v_mfma_f32_16x16x32_bf16 v[226:229], v[230:233], a[164:167], v[226:229]
    v_exp_f32 v177, v177
    v_mfma_f32_16x16x32_bf16 v[114:117], v[178:181], a[168:171], 0
    v_rsq_f32 v234, v234
    v_mfma_f32_16x16x32_bf16 v[114:117], v[210:213], a[172:175], v[114:117]
    v_rsq_f32 v235, v235
    v_mfma_f32_16x16x32_bf16 v[114:117], v[214:217], a[176:179], v[114:117]
    v_mul_f32 v164, s31, v234
    v_cvt_pk_f16_f32 v165, v164, v235
    v_mfma_f32_16x16x32_bf16 v[114:117], v[218:221], a[180:183], v[114:117]
    v_pk_mul_f16 v126, v126, v165 op_sel:[0,1] op_sel_hi:[1,1]
    v_pk_mul_f16 v127, v127, v165 op_sel:[0,1] op_sel_hi:[1,1]
    v_mfma_f32_16x16x32_bf16 v[114:117], v[222:225], a[184:187], v[114:117]
    v_pk_mul_f16 v128, v128, v165 op_sel:[0,1] op_sel_hi:[1,1]
    v_pk_mul_f16 v129, v129, v165 op_sel:[0,1] op_sel_hi:[1,1]
    v_mfma_f32_16x16x32_bf16 v[114:117], v[230:233], a[188:191], v[114:117]
    v_pk_mul_f16 v156, v156, v165 op_sel:[0,1] op_sel_hi:[1,1]
    v_pk_mul_f16 v157, v157, v165 op_sel:[0,1] op_sel_hi:[1,1]
    v_pk_mul_f16 v190, v190, v165 op_sel:[0,0] op_sel_hi:[1,0]
    v_pk_mul_f16 v191, v191, v165 op_sel:[0,0] op_sel_hi:[1,0]
    v_pk_mul_f16 v192, v192, v165 op_sel:[0,0] op_sel_hi:[1,0]
    v_pk_mul_f16 v193, v193, v165 op_sel:[0,0] op_sel_hi:[1,0]
    v_pk_mul_f16 v154, v154, v165 op_sel:[0,0] op_sel_hi:[1,0]
    v_pk_mul_f16 v155, v155, v165 op_sel:[0,0] op_sel_hi:[1,0]
    v_mfma_f32_16x16x32_f16 v[238:241], v[126:129], v[138:141], v[54:57]
    v_max3_u32 v44, v44, v234, v235
    v_cvt_pk_bf16_f32 v138, v226, v227
    v_mfma_f32_16x16x32_f16 v[234:237], v[142:145], v[134:137], v[24:27]
    v_cvt_pk_bf16_f32 v139, v228, v229
    v_cvt_pk_bf16_f32 v114, v114, v115
    v_mfma_f32_16x16x32_f16 v[234:237], v[170:173], v[150:153], v[234:237]
    v_cvt_pk_bf16_f32 v115, v116, v117
    v_mov_b32_dpp v158, v195 quad_perm:[0,1,2,3] row_mask:0x1 bank_mask:0xf
    v_mov_b32 v25, 0
    v_mfma_f32_16x16x16_f16 v[238:241], v[156:157], v[118:119], v[238:241]
    v_cvt_pk_bf16_f32 v201, v176, v177
    v_exp_f32 v194, v194
    v_lshrrev_b32 v209, 16, v209
    v_mfma_f32_16x16x32_f16 v[234:237], v[186:189], v[122:125], v[234:237]
    v_cvt_pk_bf16_f32 v39, v194, 0
    v_lshl_or_b32 v209, v209, 16, v209
    v_mfma_f32_16x16x32_bf16 v[174:177], v[178:181], a[192:195], 0
    v_xor_b32 v2, 65536, v2
    v_mfma_f32_16x16x32_bf16 v[174:177], v[210:213], a[196:199], v[174:177]
    ds_read2_b32 v[140:141], v6 offset0:0 offset1:0
    ds_read2_b32 v[116:117], v6 offset0:16 offset1:16
    v_mfma_f32_16x16x32_bf16 v[174:177], v[214:217], a[200:203], v[174:177]
    ds_read2_b32 v[180:181], v6 offset0:32 offset1:32
    v_add_u32 v6, 272, v6
    v_mfma_f32_16x16x32_f16 v[194:197], v[142:145], v[190:193], v[26:29]
    v_exp_f32 v234, v234
    v_mfma_f32_16x16x32_f16 v[194:197], v[170:173], v[126:129], v[194:197]
    v_exp_f32 v238, v238
    v_mfma_f32_16x16x32_f16 v[194:197], v[186:189], v[154:157], v[194:197]
    v_exp_f32 v239, v239
    v_mfma_f32_16x16x32_bf16 v[174:177], v[218:221], a[204:207], v[174:177]
    v_mov_b32_dpp v158, v235 quad_perm:[0,1,2,3] row_mask:0x2 bank_mask:0xf
    v_cvt_pk_bf16_f32 v36, v238, v239
    v_mfma_f32_16x16x32_bf16 v[174:177], v[222:225], a[208:211], v[174:177]
    v_exp_f32 v240, v240
    v_mfma_f32_16x16x32_bf16 v[174:177], v[230:233], a[212:215], v[174:177]
    v_exp_f32 v241, v241
    v_mfma_f32_16x16x32_f16 v[142:145], v[146:149], v[134:137], v[58:61]
    s_waitcnt lgkmcnt(1)
    v_mov_b32_dpp v158, v195 quad_perm:[0,1,2,3] row_mask:0x4 bank_mask:0xf
    v_cvt_pk_bf16_f32 v37, v240, v241
    v_mfma_f32_16x16x32_f16 v[170:173], v[150:153], v[134:137], v[62:65]
    s_waitcnt lgkmcnt(0)
    v_exp_f32 v158, v158
    v_mfma_f32_16x16x32_bf16 v[186:189], v[28:31], v[36:39], 0
    v_cvt_pk_bf16_f32 v178, v174, v175
    v_cvt_pk_bf16_f32 v179, v176, v177
    v_mfma_f32_16x16x32_bf16 v[186:189], v[28:31], v[198:201], v[186:189]
    v_exp_f32 v194, v194
    v_mfma_f32_16x16x32_bf16 v[174:177], v[138:141], v[36:39], 0
    v_cvt_pk_bf16_f32 v158, v158, v158
    v_mfma_f32_16x16x32_bf16 v[174:177], v[202:205], v[198:201], v[174:177]
    ds_write_b16 v8, v158
    v_mfma_f32_16x16x32_bf16 v[210:213], v[114:117], v[36:39], 0
    v_mfma_f32_16x16x32_bf16 v[210:213], v[166:169], v[198:201], v[210:213]
    v_mfma_f32_16x16x32_bf16 v[214:217], v[178:181], v[36:39], 0
    v_rcp_f32 v186, v186
    v_mfma_f32_16x16x32_bf16 v[214:217], v[182:185], v[198:201], v[214:217]
    v_cvt_pk_bf16_f32 v39, v234, 0
    v_max3_u32 v25, v25, v186, v187
    v_mfma_f32_16x16x32_f16 v[198:201], v[126:129], v[134:137], v[66:69]
    v_mul_f32 v174, v186, v174
    v_mul_f32 v175, v186, v175
    v_cvt_pk_bf16_f32 v134, v174, v175
    v_mfma_f32_16x16x16_f16 v[142:145], v[120:121], v[122:123], v[142:145]
    v_mul_f32 v176, v186, v176
    v_mul_f32 v177, v186, v177
    v_cvt_pk_bf16_f32 v135, v176, v177
    v_mfma_f32_16x16x16_f16 v[170:173], v[124:125], v[122:123], v[170:173]
    v_mul_f32 v210, v186, v210
    v_mul_f32 v211, v186, v211
    v_cvt_pk_bf16_f32 v136, v210, v211
    v_mfma_f32_16x16x16_f16 v[198:201], v[156:157], v[122:123], v[198:201]
    v_exp_f32 v142, v142
    v_exp_f32 v143, v143
    v_mfma_f32_16x16x32_f16 v[174:177], v[146:149], v[190:193], v[70:73]
    v_cvt_pk_bf16_f32 v118, v142, v143
    v_mul_f32 v212, v186, v212
    v_mfma_f32_16x16x32_bf16 v[146:149], v[206:209], a[216:219], 0
    v_exp_f32 v144, v144
    v_mfma_f32_16x16x32_f16 v[218:221], v[150:153], v[190:193], v[74:77]
    v_exp_f32 v145, v145
    v_mul_f32 v213, v186, v213
    v_mfma_f32_16x16x16_f16 v[174:177], v[120:121], v[154:155], v[174:177]
    v_cvt_pk_bf16_f32 v119, v144, v145
    v_exp_f32 v170, v170
    v_cvt_pk_bf16_f32 v137, v212, v213
    v_mfma_f32_16x16x32_f16 v[142:145], v[126:129], v[190:193], v[78:81]
    v_exp_f32 v171, v171
    v_mul_f32 v214, v186, v214
    v_mfma_f32_16x16x16_f16 v[218:221], v[124:125], v[154:155], v[218:221]
    v_cvt_pk_bf16_f32 v120, v170, v171
    v_exp_f32 v172, v172
    v_mul_f32 v215, v186, v215
    v_mfma_f32_16x16x16_f16 v[142:145], v[156:157], v[154:155], v[142:145]
    v_exp_f32 v173, v173
    v_exp_f32 v198, v198
    v_mfma_f32_16x16x32_bf16 v[146:149], v[206:209], a[240:243], v[146:149]
    v_cvt_pk_bf16_f32 v121, v172, v173
    v_cvt_pk_bf16_f32 v164, v214, v215
    v_mfma_f32_16x16x32_bf16 v[146:149], v[206:209], v[90:93], v[146:149]
    v_exp_f32 v199, v199
    v_mfma_f32_16x16x32_bf16 v[122:125], v[206:209], a[220:223], 0
    v_cvt_pk_bf16_f32 v36, v198, v199
    v_mul_f32 v216, v186, v216
    v_mfma_f32_16x16x32_bf16 v[122:125], v[206:209], a[244:247], v[122:125]
    v_exp_f32 v200, v200
    v_mfma_f32_16x16x32_bf16 v[122:125], v[206:209], v[94:97], v[122:125]
    v_exp_f32 v201, v201
    v_mfma_f32_16x16x32_bf16 v[126:129], v[206:209], a[232:235], 0
    v_mov_b32 v254, v146
    v_cvt_pk_bf16_f32 v37, v200, v201
    v_mfma_f32_16x16x32_bf16 v[126:129], v[206:209], v[82:85], v[126:129]
    v_mov_b32_dpp v254, v147 quad_perm:[0,1,2,3] row_mask:0x2 bank_mask:0xf
    v_mul_f32 v217, v186, v217
    v_mfma_f32_16x16x32_bf16 v[146:149], v[28:31], v[36:39], 0
    v_mov_b32 v158, v123
    v_cvt_pk_bf16_f32 v165, v216, v217
    v_mfma_f32_16x16x32_bf16 v[146:149], v[28:31], v[118:121], v[146:149]
    v_exp_f32 v174, v174
    v_mfma_f32_16x16x32_bf16 v[150:153], v[138:141], v[36:39], 0
    v_exp_f32 v175, v175
    v_mfma_f32_16x16x32_bf16 v[150:153], v[202:205], v[118:121], v[150:153]
    v_exp_f32 v176, v176
    v_mfma_f32_16x16x32_bf16 v[154:157], v[114:117], v[36:39], 0
    v_exp_f32 v177, v177
    v_mfma_f32_16x16x32_bf16 v[154:157], v[166:169], v[118:121], v[154:157]
    v_cvt_pk_bf16_f32 v170, v174, v175
    v_cvt_pk_bf16_f32 v171, v176, v177
    v_mfma_f32_16x16x32_bf16 v[174:177], v[178:181], v[36:39], 0
    v_exp_f32 v218, v218
    v_mfma_f32_16x16x32_bf16 v[174:177], v[182:185], v[118:121], v[174:177]
    v_exp_f32 v219, v219
    v_mfma_f32_16x16x32_bf16 v[126:129], v[206:209], v[106:109], v[126:129]
    v_cvt_pk_bf16_f32 v172, v218, v219
    v_cvt_pk_bf16_f32 v39, v194, 0
    v_mfma_f32_16x16x32_bf16 v[118:121], v[206:209], a[224:227], 0
    v_exp_f32 v220, v220
    v_mfma_f32_16x16x32_bf16 v[118:121], v[206:209], a[248:251], v[118:121]
    v_exp_f32 v221, v221
    v_mfma_f32_16x16x32_bf16 v[118:121], v[206:209], v[98:101], v[118:121]
    v_exp_f32 v142, v142
    v_mfma_f32_16x16x32_bf16 v[186:189], v[206:209], a[228:231], 0
    v_mov_b32_dpp v254, v126 quad_perm:[0,1,2,3] row_mask:0x4 bank_mask:0xf
    v_mov_b32_dpp v158, v127 quad_perm:[0,1,2,3] row_mask:0x2 bank_mask:0xf
    v_mfma_f32_16x16x32_bf16 v[186:189], v[206:209], a[252:255], v[186:189]
    v_mov_b32_dpp v254, v122 quad_perm:[0,1,2,3] row_mask:0x8 bank_mask:0xf
    v_cvt_pk_bf16_f32 v173, v220, v221
    v_mfma_f32_16x16x32_bf16 v[186:189], v[206:209], v[102:105], v[186:189]
    ds_write_b32 v160, v254 offset:18432
    v_mfma_f32_16x16x32_bf16 v[122:125], v[206:209], a[236:239], 0
    v_exp_f32 v143, v143
    v_mfma_f32_16x16x32_bf16 v[122:125], v[206:209], v[86:89], v[122:125]
    v_mov_b32_dpp v158, v118 quad_perm:[0,1,2,3] row_mask:0x4 bank_mask:0xf
    v_cvt_pk_bf16_f32 v36, v142, v143
    v_mfma_f32_16x16x32_bf16 v[122:125], v[206:209], v[110:113], v[122:125]
    v_mov_b32_dpp v158, v119 quad_perm:[0,1,2,3] row_mask:0x8 bank_mask:0xf
    v_exp_f32 v144, v144
    v_exp_f32 v145, v145
    ds_read_b128 v[118:121], v9
    ds_read_b128 v[126:129], v9 offset:64
    ds_write_b32 v160, v158 offset:19456
    v_cvt_pk_bf16_f32 v37, v144, v145
    v_rcp_f32 v146, v146
    v_mov_b32 v254, v122
    v_mfma_f32_16x16x32_bf16 v[142:145], v[28:31], v[36:39], 0
    v_max3_u32 v25, v25, v146, v147
    v_mov_b32_dpp v254, v186 quad_perm:[0,1,2,3] row_mask:0x2 bank_mask:0xf
    v_mfma_f32_16x16x32_bf16 v[142:145], v[28:31], v[170:173], v[142:145]
    v_mul_f32 v150, v146, v150
    v_mov_b32_dpp v254, v187 quad_perm:[0,1,2,3] row_mask:0x4 bank_mask:0xf
    v_mfma_f32_16x16x32_bf16 v[186:189], v[138:141], v[36:39], 0
    v_mul_f32 v151, v146, v151
    v_mov_b32_dpp v254, v123 quad_perm:[0,1,2,3] row_mask:0x8 bank_mask:0xf
    v_mfma_f32_16x16x32_bf16 v[186:189], v[202:205], v[170:173], v[186:189]
    ds_write_b32 v160, v254 offset:63552
    v_mfma_f32_16x16x32_bf16 v[206:209], v[114:117], v[36:39], 0
    v_rcp_f32 v142, v142
    v_mfma_f32_16x16x32_bf16 v[206:209], v[166:169], v[170:173], v[206:209]
    s_waitcnt lgkmcnt(2)
    v_max3_u32 v25, v25, v142, v143
    v_cvt_pk_bf16_f32 v130, v150, v151
    v_mfma_f32_16x16x32_bf16 v[210:213], v[118:121], v[28:31], 0
    v_mul_f32 v186, v142, v186
    v_mul_f32 v187, v142, v187
    v_mfma_f32_16x16x32_bf16 v[210:213], v[126:129], v[28:31], v[210:213]
    v_cvt_pk_bf16_f32 v214, v186, v187
    v_mul_f32 v188, v142, v188
    v_mfma_f32_16x16x32_bf16 v[218:221], v[118:121], v[202:205], 0
    v_mul_f32 v189, v142, v189
    v_cvt_pk_bf16_f32 v215, v188, v189
    v_mfma_f32_16x16x32_bf16 v[218:221], v[126:129], v[138:141], v[218:221]
    v_mul_f32 v206, v142, v206
    v_mul_f32 v207, v142, v207
    v_mfma_f32_16x16x32_bf16 v[138:141], v[118:121], v[166:169], 0
    v_rcp_f32 v210, v210
    v_mfma_f32_16x16x32_bf16 v[138:141], v[126:129], v[114:117], v[138:141]
    s_waitcnt lgkmcnt(0)
    v_max3_u32 v25, v25, v210, v211
    v_cvt_pk_bf16_f32 v216, v206, v207
    v_mfma_f32_16x16x32_bf16 v[114:117], v[118:121], v[182:185], 0
    s_barrier
    s_waitcnt vmcnt(0)
    ds_read_b128 v[166:169], v255 offset:18432
    v_mfma_f32_16x16x32_bf16 v[114:117], v[126:129], v[178:181], v[114:117]
    s_barrier
    ds_read_b128 v[186:189], v0 offset:20480
    ds_read_b128 v[194:197], v1 offset:20480
    v_mfma_f32_16x16x32_bf16 v[126:129], v[178:181], v[36:39], 0
    ds_read_b128 v[122:125], v0 offset:20608
    buffer_load_dwordx4 v10, s[8:11], 0 offen nt lds
    v_mfma_f32_16x16x32_bf16 v[126:129], v[182:185], v[170:173], v[126:129]
    s_add_u32 m0, s28, 4096
    ds_read_b128 v[202:205], v1 offset:20608
    ds_read_b128 v[230:233], v0 offset:20736
    ds_read_b128 v[238:241], v1 offset:20736
    ds_read_b128 v[170:173], v255 offset:19456
    ds_read_b128 v[178:181], v255 offset:63552
    ds_write_b128 v3, v[134:137] offset:0
    s_waitcnt lgkmcnt(7)
    v_mfma_f32_16x16x32_bf16 v[118:121], a[72:75], v[186:189], 0
    s_waitcnt lgkmcnt(6)
    buffer_load_dwordx4 v11, s[8:11], 0 offen nt lds
    v_add_f32 v166, v166, v167
    v_mfma_f32_16x16x32_bf16 v[118:121], a[76:79], v[194:197], v[118:121]
    s_add_u32 m0, s28, 8192
    v_add_f32 v168, v168, v169
    v_add_f32 v166, v166, v168
    v_mfma_f32_16x16x32_bf16 v[118:121], a[80:83], v[122:125], v[118:121]
    s_waitcnt lgkmcnt(4)
    ds_write_b64 v4, v[164:165] offset:4096
    v_mfma_f32_16x16x32_bf16 v[118:121], a[84:87], v[202:205], v[118:121]
    s_waitcnt lgkmcnt(3)
    v_mul_f32 v166, 0xbbaaaaab, v166
    v_add_f32 v170, v170, v171
    v_mfma_f32_16x16x32_bf16 v[118:121], a[88:91], v[230:233], v[118:121]
    s_waitcnt lgkmcnt(2)
    ds_write_b32 v132, v166 offset:0
    v_mfma_f32_16x16x32_bf16 v[118:121], a[92:95], v[238:241], v[118:121]
    buffer_load_dwordx4 v12, s[8:11], 0 offen nt lds
    v_add_f32 v172, v172, v173
    v_mfma_f32_16x16x32_bf16 v[190:193], a[96:99], v[186:189], 0
    s_add_u32 m0, s28, 12288
    ds_read_b128 v[134:137], v159 offset:0
    ds_read_b128 v[166:169], v159 offset:64
    v_mfma_f32_16x16x32_bf16 v[190:193], a[100:103], v[194:197], v[190:193]
    s_xor_b32 s28, s28, 65536
    ds_read_b128 v[182:185], v159 offset:128
    ds_read_b128 v[222:225], v159 offset:192
    v_mfma_f32_16x16x32_bf16 v[190:193], a[104:107], v[122:125], v[190:193]
    v_add_f32 v170, v170, v172
    v_mul_f32 v170, 0xbbaaaaab, v170
    v_mfma_f32_16x16x32_bf16 v[190:193], a[108:111], v[202:205], v[190:193]
    ds_write_b32 v132, v170 offset:256
    v_mfma_f32_16x16x32_bf16 v[190:193], a[112:115], v[230:233], v[190:193]
    v_add_f32 v178, v178, v179
    v_add_f32 v180, v180, v181
    v_mfma_f32_16x16x32_bf16 v[190:193], a[116:119], v[238:241], v[190:193]
    buffer_load_dwordx4 v13, s[8:11], 0 offen nt lds
    v_add_f32 v178, v178, v180
    v_mfma_f32_16x16x32_bf16 v[198:201], a[120:123], v[186:189], 0
    s_mov_b32 m0, s29
    v_mul_f32 v178, 0xbbaaaaab, v178
    v_mul_f32 v218, v218, v210
    v_mfma_f32_16x16x32_bf16 v[198:201], a[124:127], v[194:197], v[198:201]
    s_xor_b32 s29, s29, s30
    ds_write_b32 v132, v178 offset:512
    v_mfma_f32_16x16x32_bf16 v[198:201], a[128:131], v[122:125], v[198:201]
    s_waitcnt lgkmcnt(4)
    v_mul_f32_dpp v218, v138, v210 quad_perm:[0,1,2,3] row_mask:0x2 bank_mask:0xf
    v_mul_f32 v208, v142, v208
    v_mul_f32 v209, v142, v209
    v_mfma_f32_16x16x16_bf16 v[138:141], a[216:217], v[162:163], v[134:137]
    v_mul_f32_dpp v218, v114, v210 quad_perm:[0,1,2,3] row_mask:0x4 bank_mask:0xf
    v_cvt_pk_bf16_f32 v218, v218, v218
    v_cvt_pk_bf16_f32 v217, v208, v209
    v_mfma_f32_16x16x16_bf16 v[114:117], a[240:241], v[162:163], v[134:137]
    v_mul_f32 v126, v142, v126
    v_mul_f32 v127, v142, v127
    v_cvt_pk_bf16_f32 v164, v126, v127
    v_mfma_f32_16x16x16_bf16 v[170:173], v[90:91], v[162:163], v[134:137]
    v_cvt_pk_bf16_f32 v138, v138, v139
    v_accvgpr_write_b32 a216, v138
    v_cvt_pk_bf16_f32 v140, v140, v141
    v_mfma_f32_16x16x16_bf16 v[178:181], a[218:219], v[162:163], v[166:169]
    v_accvgpr_write_b32 a217, v140
    v_cvt_pk_bf16_f32 v114, v114, v115
    v_accvgpr_write_b32 a240, v114
    v_mfma_f32_16x16x16_bf16 v[134:137], a[242:243], v[162:163], v[166:169]
    v_cvt_pk_bf16_f32 v116, v116, v117
    v_accvgpr_write_b32 a241, v116
    v_cvt_pk_bf16_f32 v90, v170, v171
    v_mfma_f32_16x16x16_bf16 v[114:117], v[92:93], v[162:163], v[166:169]
    v_cvt_pk_bf16_f32 v91, v172, v173
    v_cvt_pk_bf16_f32 v178, v178, v179
    v_accvgpr_write_b32 a218, v178
    v_cvt_pk_bf16_f32 v180, v180, v181
    v_mfma_f32_16x16x32_bf16 v[198:201], a[132:135], v[202:205], v[198:201]
    s_waitcnt lgkmcnt(0)
    buffer_load_dwordx4 v14, s[8:11], 0 offen nt lds
    ds_read_b128 v[138:141], v159 offset:256
    v_accvgpr_write_b32 a219, v180
    v_mfma_f32_16x16x16_bf16 v[166:169], a[232:233], v[162:163], v[182:185]
    v_cvt_pk_bf16_f32 v134, v134, v135
    v_accvgpr_write_b32 a242, v134
    v_cvt_pk_bf16_f32 v136, v136, v137
    v_mfma_f32_16x16x16_bf16 v[170:173], v[82:83], v[162:163], v[182:185]
    v_accvgpr_write_b32 a243, v136
    v_cvt_pk_bf16_f32 v92, v114, v115
    v_cvt_pk_bf16_f32 v93, v116, v117
    v_mfma_f32_16x16x16_bf16 v[114:117], v[106:107], v[162:163], v[182:185]
    v_cvt_pk_bf16_f32 v166, v166, v167
    v_accvgpr_write_b32 a232, v166
    v_cvt_pk_bf16_f32 v168, v168, v169
    v_mfma_f32_16x16x16_bf16 v[134:137], a[220:221], v[162:163], v[222:225]
    v_accvgpr_write_b32 a233, v168
    v_cvt_pk_bf16_f32 v82, v170, v171
    v_cvt_pk_bf16_f32 v83, v172, v173
    v_mfma_f32_16x16x16_bf16 v[166:169], a[244:245], v[162:163], v[222:225]
    v_cvt_pk_bf16_f32 v106, v114, v115
    v_cvt_pk_bf16_f32 v107, v116, v117
    v_mul_f32 v128, v142, v128
    v_mfma_f32_16x16x16_bf16 v[114:117], v[94:95], v[162:163], v[222:225]
    v_cvt_pk_bf16_f32 v134, v134, v135
    v_accvgpr_write_b32 a220, v134
    v_cvt_pk_bf16_f32 v136, v136, v137
    v_accvgpr_write_b32 a221, v136
    v_mfma_f32_16x16x32_bf16 v[198:201], a[136:139], v[230:233], v[198:201]
    s_waitcnt lgkmcnt(0)
    ds_read_b128 v[134:137], v159 offset:320
    ds_read_b128 v[170:173], v159 offset:384
    v_cvt_pk_bf16_f32 v166, v166, v167
    v_mfma_f32_16x16x16_bf16 v[178:181], a[222:223], v[162:163], v[138:141]
    v_accvgpr_write_b32 a244, v166
    v_cvt_pk_bf16_f32 v168, v168, v169
    v_accvgpr_write_b32 a245, v168
    v_mfma_f32_16x16x16_bf16 v[166:169], a[246:247], v[162:163], v[138:141]
    v_cvt_pk_bf16_f32 v94, v114, v115
    v_cvt_pk_bf16_f32 v95, v116, v117
    v_mul_f32 v129, v142, v129
    v_mfma_f32_16x16x16_bf16 v[114:117], v[96:97], v[162:163], v[138:141]
    v_cvt_pk_bf16_f32 v178, v178, v179
    v_accvgpr_write_b32 a222, v178
    v_cvt_pk_bf16_f32 v180, v180, v181
    v_accvgpr_write_b32 a223, v180
    v_mfma_f32_16x16x32_bf16 v[198:201], a[140:143], v[238:241], v[198:201]
    ds_read_b128 v[142:145], v159 offset:448
    v_cvt_pk_bf16_f32 v166, v166, v167
    v_mfma_f32_16x16x32_bf16 v[138:141], a[0:3], v[186:189], 0
    ds_write_b128 v3, v[214:217] offset:12288
    v_mfma_f32_16x16x32_bf16 v[138:141], a[4:7], v[194:197], v[138:141]
    s_waitcnt lgkmcnt(3)
    v_accvgpr_write_b32 a246, v166
    v_cvt_pk_bf16_f32 v168, v168, v169
    v_accvgpr_write_b32 a247, v168
    v_mfma_f32_16x16x16_bf16 v[166:169], a[234:235], v[162:163], v[134:137]
    v_cvt_pk_bf16_f32 v96, v114, v115
    v_cvt_pk_bf16_f32 v97, v116, v117
    v_cvt_pk_bf16_f32 v165, v128, v129
    v_mfma_f32_16x16x16_bf16 v[114:117], v[84:85], v[162:163], v[134:137]
    v_mul_f32 v152, v146, v152
    v_mul_f32 v153, v146, v153
    v_cvt_pk_bf16_f32 v131, v152, v153
    v_mfma_f32_16x16x16_bf16 v[126:129], v[108:109], v[162:163], v[134:137]
    v_cvt_pk_bf16_f32 v166, v166, v167
    v_accvgpr_write_b32 a234, v166
    v_cvt_pk_bf16_f32 v168, v168, v169
    v_accvgpr_write_b32 a235, v168
    v_mfma_f32_16x16x32_bf16 v[138:141], a[8:11], v[122:125], v[138:141]
    s_waitcnt lgkmcnt(1)
    ds_read_b128 v[134:137], v159 offset:512
    ds_write_b64 v4, v[164:165] offset:16384
    v_mfma_f32_16x16x16_bf16 v[150:153], a[224:225], v[162:163], v[170:173]
    v_cvt_pk_bf16_f32 v84, v114, v115
    v_cvt_pk_bf16_f32 v85, v116, v117
    v_cvt_pk_bf16_f32 v108, v126, v127
    v_mfma_f32_16x16x16_bf16 v[114:117], a[248:249], v[162:163], v[170:173]
    v_cvt_pk_bf16_f32 v109, v128, v129
    v_mul_f32 v154, v146, v154
    v_mul_f32 v155, v146, v155
    v_mfma_f32_16x16x16_bf16 v[126:129], v[98:99], v[162:163], v[170:173]
    v_cvt_pk_bf16_f32 v150, v150, v151
    v_accvgpr_write_b32 a224, v150
    v_cvt_pk_bf16_f32 v152, v152, v153
    v_mfma_f32_16x16x16_bf16 v[166:169], a[226:227], v[162:163], v[142:145]
    v_accvgpr_write_b32 a225, v152
    v_cvt_pk_bf16_f32 v114, v114, v115
    v_accvgpr_write_b32 a248, v114
    v_mfma_f32_16x16x16_bf16 v[150:153], a[250:251], v[162:163], v[142:145]
    v_cvt_pk_bf16_f32 v116, v116, v117
    v_accvgpr_write_b32 a249, v116
    v_cvt_pk_bf16_f32 v98, v126, v127
    v_mfma_f32_16x16x16_bf16 v[114:117], v[100:101], v[162:163], v[142:145]
    v_cvt_pk_bf16_f32 v99, v128, v129
    v_cvt_pk_bf16_f32 v166, v166, v167
    v_accvgpr_write_b32 a226, v166
    v_cvt_pk_bf16_f32 v168, v168, v169
    v_mfma_f32_16x16x32_bf16 v[138:141], a[12:15], v[202:205], v[138:141]
    s_waitcnt lgkmcnt(0)
    ds_read_b128 v[126:129], v159 offset:576
    ds_read_b128 v[142:145], v159 offset:640
    v_accvgpr_write_b32 a227, v168
    v_mfma_f32_16x16x16_bf16 v[166:169], a[236:237], v[162:163], v[134:137]
    v_cvt_pk_bf16_f32 v150, v150, v151
    v_accvgpr_write_b32 a250, v150
    v_cvt_pk_bf16_f32 v152, v152, v153
    v_mfma_f32_16x16x16_bf16 v[170:173], v[86:87], v[162:163], v[134:137]
    v_accvgpr_write_b32 a251, v152
    v_cvt_pk_bf16_f32 v100, v114, v115
    v_cvt_pk_bf16_f32 v101, v116, v117
    v_mfma_f32_16x16x16_bf16 v[114:117], v[110:111], v[162:163], v[134:137]
    v_cvt_pk_bf16_f32 v166, v166, v167
    v_accvgpr_write_b32 a236, v166
    v_cvt_pk_bf16_f32 v168, v168, v169
    v_accvgpr_write_b32 a237, v168
    v_mfma_f32_16x16x32_bf16 v[138:141], a[16:19], v[230:233], v[138:141]
    ds_read_b128 v[134:137], v159 offset:704
    v_cvt_pk_bf16_f32 v86, v170, v171
    v_mfma_f32_16x16x32_bf16 v[138:141], a[20:23], v[238:241], v[138:141]
    ds_write_b16 v7, v218
    v_mfma_f32_16x16x32_bf16 v[166:169], a[24:27], v[186:189], 0
    v_add_u32 v7, 16, v7
    v_cvt_pk_bf16_f32 v87, v172, v173
    v_mfma_f32_16x16x32_bf16 v[166:169], a[28:31], v[194:197], v[166:169]
    s_waitcnt lgkmcnt(2)
    v_cvt_pk_bf16_f32 v110, v114, v115
    v_cvt_pk_bf16_f32 v111, v116, v117
    v_cvt_pk_bf16_f32 v132, v154, v155
    v_mfma_f32_16x16x16_bf16 v[114:117], a[228:229], v[162:163], v[126:129]
    v_mul_f32 v156, v146, v156
    v_mul_f32 v157, v146, v157
    v_cvt_pk_bf16_f32 v133, v156, v157
    v_mfma_f32_16x16x16_bf16 v[150:153], a[252:253], v[162:163], v[126:129]
    v_mul_f32 v174, v146, v174
    v_mul_f32 v175, v146, v175
    v_cvt_pk_bf16_f32 v254, v174, v175
    v_mfma_f32_16x16x16_bf16 v[154:157], v[102:103], v[162:163], v[126:129]
    v_cvt_pk_bf16_f32 v114, v114, v115
    v_accvgpr_write_b32 a228, v114
    v_cvt_pk_bf16_f32 v116, v116, v117
    v_mfma_f32_16x16x16_bf16 v[158:161], a[230:231], v[162:163], v[142:145]
    v_accvgpr_write_b32 a229, v116
    v_cvt_pk_bf16_f32 v150, v150, v151
    v_accvgpr_write_b32 a252, v150
    v_mfma_f32_16x16x16_bf16 v[114:117], a[254:255], v[162:163], v[142:145]
    v_cvt_pk_bf16_f32 v152, v152, v153
    v_accvgpr_write_b32 a253, v152
    v_cvt_pk_bf16_f32 v102, v154, v155
    v_mfma_f32_16x16x16_bf16 v[126:129], v[104:105], v[162:163], v[142:145]
    v_cvt_pk_bf16_f32 v103, v156, v157
    v_cvt_pk_bf16_f32 v158, v158, v159
    v_accvgpr_write_b32 a230, v158
    v_cvt_pk_bf16_f32 v160, v160, v161
    v_mfma_f32_16x16x32_bf16 v[166:169], a[32:35], v[122:125], v[166:169]
    s_waitcnt lgkmcnt(0)
    ds_write_b128 v3, v[130:133] offset:6144
    v_mfma_f32_16x16x16_bf16 v[130:133], a[238:239], v[162:163], v[134:137]
    v_accvgpr_write_b32 a231, v160
    v_cvt_pk_bf16_f32 v114, v114, v115
    v_accvgpr_write_b32 a254, v114
    v_mfma_f32_16x16x16_bf16 v[142:145], v[88:89], v[162:163], v[134:137]
    v_cvt_pk_bf16_f32 v116, v116, v117
    v_accvgpr_write_b32 a255, v116
    v_cvt_pk_bf16_f32 v104, v126, v127
    v_mfma_f32_16x16x16_bf16 v[114:117], v[112:113], v[162:163], v[134:137]
    v_cvt_pk_bf16_f32 v105, v128, v129
    v_cvt_pk_bf16_f32 v130, v130, v131
    v_accvgpr_write_b32 a238, v130
    v_cvt_pk_bf16_f32 v132, v132, v133
    v_mfma_f32_16x16x32_bf16 v[166:169], a[36:39], v[202:205], v[166:169]
    v_accvgpr_write_b32 a239, v132
    v_cvt_pk_bf16_f32 v88, v142, v143
    v_mfma_f32_16x16x32_bf16 v[166:169], a[40:43], v[230:233], v[166:169]
    v_cvt_pk_bf16_f32 v89, v144, v145
    v_cvt_pk_bf16_f32 v112, v114, v115
    v_mfma_f32_16x16x32_bf16 v[166:169], a[44:47], v[238:241], v[166:169]
    v_cvt_pk_bf16_f32 v113, v116, v117
    v_mul_f32 v176, v146, v176
    v_mfma_f32_16x16x32_bf16 v[134:137], a[48:51], v[186:189], 0
    v_mul_f32 v177, v146, v177
    v_cvt_pk_bf16_f32 v255, v176, v177
    v_mfma_f32_16x16x32_bf16 v[134:137], a[52:55], v[194:197], v[134:137]
    ds_write_b64 v4, v[254:255] offset:10240
    v_cvt_pk_f16_f32 v146, v118, v119
    v_pk_mul_f16 v143, v146, v146
    v_cvt_pk_f16_f32 v147, v120, v121
    v_pk_fma_f16 v143, v147, v147, v143
    v_cvt_pk_f16_f32 v148, v190, v191
    v_pk_fma_f16 v143, v148, v148, v143
    v_cvt_pk_f16_f32 v149, v192, v193
    v_pk_fma_f16 v143, v149, v149, v143
    v_cvt_pk_f16_f32 v120, v198, v199
    v_pk_fma_f16 v143, v120, v120, v143
    v_cvt_pk_f16_f32 v121, v200, v201
    v_pk_fma_f16 v143, v121, v121, v143
    v_xor_b32 v3, 65536, v3
    v_xor_b32 v4, 65536, v4
    s_waitcnt lgkmcnt(0)
    s_barrier
L_go:
    s_waitcnt lgkmcnt(0)
    s_and_b32 s3, s2, 0xf8
    s_add_u32 s64, s42, s3
    s_addc_u32 s65, s43, 0
    s_mov_b32 s67, 0x00020000
    s_cmp_eq_u32 s16, 1
    s_cbranch_scc1 L_loop_fast1
    s_cmp_eq_u32 s16, 2
    s_cbranch_scc1 L_loop_fast2
    s_cmp_eq_u32 s16, 3
    s_cbranch_scc1 L_loop_fast3
    s_branch L_loop_fast0
.p2align 6
L_loop_fast0:
    v_mfma_f32_16x16x32_bf16 v[134:137], a[56:59], v[122:125], v[134:137]
    s_add_u32 s12, s40, s27
    ds_read_b128 v[190:193], v2 offset:18432
    v_cvt_pk_f16_f32 v150, v138, v139
    v_mfma_f32_16x16x32_bf16 v[134:137], a[60:63], v[202:205], v[134:137]
    s_addc_u32 s13, s41, 0
    ds_read_b128 v[210:213], v2 offset:19456
    v_pk_mul_f16 v142, v150, v150
    v_mfma_f32_16x16x32_bf16 v[134:137], a[64:67], v[230:233], v[134:137]
    s_sub_u32 s14, s36, s27
    ds_read_b128 v[174:177], v5 offset:32
    v_cvt_pk_f16_f32 v151, v140, v141
    v_mfma_f32_16x16x32_bf16 v[134:137], a[68:71], v[238:241], v[134:137]
    s_cmp_ge_u32 s18, 2
    ds_read2_b64 v[162:165], v5 offset0:6 offset1:9
    v_pk_fma_f16 v142, v151, v151, v142
    v_mfma_f32_16x16x32_bf16 v[138:141], v[186:189], a[144:147], 0
    s_cselect_b32 s14, s14, 0
    ds_read_b128 v[170:173], v5
    v_cvt_pk_f16_f32 v152, v166, v167
    v_mfma_f32_16x16x32_bf16 v[138:141], v[194:197], a[148:151], v[138:141]
    s_sub_u32 s82, s72, s71
    ds_read_b32 v254, v6 offset:192
    v_pk_fma_f16 v142, v152, v152, v142
    v_mfma_f32_16x16x32_bf16 v[138:141], v[122:125], a[152:155], v[138:141]
    s_mul_i32 s74, s82, 336
    v_cvt_pk_f16_f32 v153, v168, v169
    v_pk_fma_f16 v142, v153, v153, v142
    v_mfma_f32_16x16x32_bf16 v[138:141], v[202:205], a[156:159], v[138:141]
    s_mul_i32 s75, s82, 272
    v_cvt_pk_f16_f32 v118, v134, v135
    v_pk_fma_f16 v142, v118, v118, v142
    v_mfma_f32_16x16x32_bf16 v[138:141], v[230:233], a[160:163], v[138:141]
    s_waitcnt lgkmcnt(5)
    ds_read_b128 v[182:185], v0 offset:26624
    v_cvt_pk_f16_f32 v119, v136, v137
    v_mfma_f32_16x16x32_bf16 v[166:169], v[32:35], v[190:193], 0
    s_waitcnt lgkmcnt(5)
    v_pk_fma_f16 v142, v119, v119, v142
    v_add_u32 v5, s74, v5
    v_mfma_f32_16x16x32_bf16 v[166:169], v[32:35], v[210:213], v[166:169]
    s_waitcnt lgkmcnt(4)
    v_pk_mul_f16 v145, v146, v174
    v_pk_fma_f16 v145, v147, v175, v145
    v_mfma_f32_16x16x32_bf16 v[138:141], v[238:241], a[164:167], v[138:141]
    s_mul_i32 s76, s82, 16
    ds_read_b128 v[210:213], v1 offset:26624
    v_pk_fma_f16 v145, v148, v176, v145
    v_mfma_f32_16x16x32_bf16 v[214:217], v[186:189], a[168:171], 0
    s_waitcnt lgkmcnt(3)
    ds_read_b128 v[218:221], v0 offset:26752
    v_pk_fma_f16 v145, v149, v177, v145
    v_mfma_f32_16x16x32_bf16 v[214:217], v[194:197], a[172:175], v[214:217]
    s_waitcnt lgkmcnt(3)
    ds_read_b128 v[222:225], v1 offset:26752
    v_mov_b32_dpp v254, v23 quad_perm:[0,1,2,3] row_mask:0x7 bank_mask:0xf
    v_mfma_f32_16x16x32_bf16 v[214:217], v[122:125], a[176:179], v[214:217]
    s_add_u32 s34, s18, 2
    ds_read_b128 v[226:229], v0 offset:26880
    v_pk_fma_f16 v145, v120, v164, v145
    v_mfma_f32_16x16x32_bf16 v[214:217], v[202:205], a[180:183], v[214:217]
    s_add_u32 s8, s60, s23
    ds_read_b128 v[190:193], v1 offset:26880
    v_pk_fma_f16 v145, v121, v165, v145
    v_mfma_f32_16x16x32_bf16 v[214:217], v[230:233], a[184:187], v[214:217]
    s_waitcnt lgkmcnt(5)
    v_pk_mul_f16 v144, v150, v170
    v_pk_fma_f16 v144, v151, v171, v144
    v_mfma_f32_16x16x32_bf16 v[214:217], v[238:241], a[188:191], v[214:217]
    s_addc_u32 s9, s61, 0
    v_pk_fma_f16 v144, v152, v172, v144
    v_pk_fma_f16 v144, v153, v173, v144
    v_mfma_f32_16x16x32_bf16 v[246:249], v[186:189], a[192:195], 0
    s_sub_u32 s10, s36, s23
    v_pk_fma_f16 v144, v118, v162, v144
    v_pk_fma_f16 v144, v119, v163, v144
    v_mfma_f32_16x16x32_bf16 v[246:249], v[194:197], a[196:199], v[246:249]
    s_cmp_le_u32 s34, s45
    v_cvt_pk_bf16_f32 v134, v138, v139
    v_cvt_pk_bf16_f32 v135, v140, v141
    v_mfma_f32_16x16x32_f16 v[234:237], v[40:43], v[142:145], 0
    s_cselect_b32 s10, s10, 0
    v_cvt_pk_bf16_f32 v138, v214, v215
    v_cvt_pk_bf16_f32 v139, v216, v217
    v_mfma_f32_16x16x32_bf16 v[246:249], v[122:125], a[200:203], v[246:249]
    s_add_u32 m0, s28, 0
    v_mul_f32 v136, 0x3baaaaab, v166
    v_mul_f32 v255, 0x3baaaaab, v167
    v_mfma_f32_16x16x32_bf16 v[246:249], v[202:205], a[204:207], v[246:249]
    s_mov_b32 s27, s26
    v_rsq_f32 v234, v234
    v_mfma_f32_16x16x32_bf16 v[246:249], v[230:233], a[208:211], v[246:249]
    s_mov_b32 s26, s25
    v_rsq_f32 v235, v235
    v_mfma_f32_16x16x32_bf16 v[246:249], v[238:241], a[212:215], v[246:249]
    s_mov_b32 s25, s24
    v_mul_f32 v140, s31, v234
    v_cvt_pk_f16_f32 v141, v140, v235
    v_mfma_f32_16x16x32_bf16 v[122:125], a[72:75], v[182:185], 0
    s_waitcnt lgkmcnt(0)
    v_fma_f32 v236, v236, v140, v22
    v_fmac_f32_dpp v254, v237, v235 quad_perm:[0,1,2,3] row_mask:0x1 bank_mask:0xf
    v_mfma_f32_16x16x32_bf16 v[122:125], a[76:79], v[210:213], v[122:125]
    s_mov_b32 s24, s23
    v_cvt_pk_bf16_f32 v142, v246, v247
    v_cvt_pk_bf16_f32 v143, v248, v249
    v_mfma_f32_16x16x32_bf16 v[122:125], a[80:83], v[218:221], v[122:125]
    s_mov_b32 s71, s72
    v_pk_mul_f16 v146, v146, v141 op_sel:[0,1] op_sel_hi:[1,1]
    v_pk_mul_f16 v147, v147, v141 op_sel:[0,1] op_sel_hi:[1,1]
    v_mfma_f32_16x16x32_bf16 v[122:125], a[84:87], v[222:225], v[122:125]
    s_mov_b32 s72, s73
    v_pk_mul_f16 v148, v148, v141 op_sel:[0,1] op_sel_hi:[1,1]
    v_pk_mul_f16 v149, v149, v141 op_sel:[0,1] op_sel_hi:[1,1]
    v_mfma_f32_16x16x32_bf16 v[122:125], a[88:91], v[226:229], v[122:125]
    v_pk_mul_f16 v120, v120, v141 op_sel:[0,1] op_sel_hi:[1,1]
    v_pk_mul_f16 v121, v121, v141 op_sel:[0,1] op_sel_hi:[1,1]
    v_mfma_f32_16x16x32_bf16 v[122:125], a[92:95], v[190:193], v[122:125]
    v_pk_mul_f16 v150, v150, v141 op_sel:[0,0] op_sel_hi:[1,0]
    v_pk_mul_f16 v151, v151, v141 op_sel:[0,0] op_sel_hi:[1,0]
    v_mfma_f32_16x16x32_bf16 v[186:189], a[96:99], v[182:185], 0
    v_pk_mul_f16 v152, v152, v141 op_sel:[0,0] op_sel_hi:[1,0]
    v_pk_mul_f16 v153, v153, v141 op_sel:[0,0] op_sel_hi:[1,0]
    v_mfma_f32_16x16x32_bf16 v[186:189], a[100:103], v[210:213], v[186:189]
    v_pk_mul_f16 v118, v118, v141 op_sel:[0,0] op_sel_hi:[1,0]
    v_pk_mul_f16 v119, v119, v141 op_sel:[0,0] op_sel_hi:[1,0]
    v_mfma_f32_16x16x32_bf16 v[186:189], a[104:107], v[218:221], v[186:189]
    v_max3_u32 v44, v44, v234, v235
    v_mul_f32 v144, 0x3baaaaab, v168
    v_mfma_f32_16x16x32_bf16 v[186:189], a[108:111], v[222:225], v[186:189]
    v_rsq_f32 v136, v136
    v_mfma_f32_16x16x32_bf16 v[186:189], a[112:115], v[226:229], v[186:189]
    v_rsq_f32 v255, v255
    v_mfma_f32_16x16x32_bf16 v[186:189], a[116:119], v[190:193], v[186:189]
    v_rsq_f32 v144, v144
    v_mfma_f32_16x16x32_bf16 v[194:197], a[120:123], v[182:185], 0
    v_mul_f32 v178, v136, v178
    v_mul_f32 v179, v136, v179
    v_mfma_f32_16x16x32_bf16 v[194:197], a[124:127], v[210:213], v[194:197]
    v_cvt_pk_bf16_f32 v166, v178, v179
    v_mul_f32 v180, v136, v180
    v_mfma_f32_16x16x32_bf16 v[194:197], a[128:131], v[218:221], v[194:197]
    v_mul_f32 v181, v136, v181
    v_cvt_pk_bf16_f32 v167, v180, v181
    v_mfma_f32_16x16x32_bf16 v[194:197], a[132:135], v[222:225], v[194:197]
    v_mul_f32 v198, v136, v198
    v_mul_f32 v199, v136, v199
    v_mfma_f32_16x16x32_bf16 v[194:197], a[136:139], v[226:229], v[194:197]
    v_cvt_pk_bf16_f32 v168, v198, v199
    v_mul_f32 v200, v136, v200
    v_mfma_f32_16x16x32_bf16 v[194:197], a[140:143], v[190:193], v[194:197]
    v_mul_f32 v201, v136, v201
    v_cvt_pk_bf16_f32 v169, v200, v201
    v_mfma_f32_16x16x32_bf16 v[178:181], a[0:3], v[182:185], 0
    buffer_store_dwordx4 v[166:169], v15, s[12:15], 0 offen nt
    v_mul_f32 v206, v136, v206
    v_mul_f32 v207, v136, v207
    v_cvt_pk_bf16_f32 v140, v206, v207
    v_mul_f32 v208, v136, v208
    v_mfma_f32_16x16x32_bf16 v[178:181], a[4:7], v[210:213], v[178:181]
    v_mul_f32 v209, v136, v209
    v_cvt_pk_bf16_f32 v141, v208, v209
    v_mfma_f32_16x16x32_bf16 v[178:181], a[8:11], v[218:221], v[178:181]
    v_cvt_pk_f16_f32 v166, v122, v123
    v_pk_mul_f16 v199, v166, v166
    v_mfma_f32_16x16x32_bf16 v[178:181], a[12:15], v[222:225], v[178:181]
    v_cvt_pk_f16_f32 v167, v124, v125
    v_pk_fma_f16 v199, v167, v167, v199
    v_mfma_f32_16x16x32_bf16 v[178:181], a[16:19], v[226:229], v[178:181]
    v_cvt_pk_f16_f32 v168, v186, v187
    v_pk_fma_f16 v199, v168, v168, v199
    v_mfma_f32_16x16x32_bf16 v[178:181], a[20:23], v[190:193], v[178:181]
    v_cvt_pk_f16_f32 v169, v188, v189
    v_pk_fma_f16 v199, v169, v169, v199
    v_mfma_f32_16x16x32_bf16 v[186:189], a[24:27], v[182:185], 0
    v_cvt_pk_f16_f32 v124, v194, v195
    v_pk_fma_f16 v199, v124, v124, v199
    v_mfma_f32_16x16x32_bf16 v[186:189], a[28:31], v[210:213], v[186:189]
    v_cvt_pk_f16_f32 v125, v196, v197
    v_pk_fma_f16 v199, v125, v125, v199
    v_mfma_f32_16x16x32_bf16 v[186:189], a[32:35], v[218:221], v[186:189]
    v_cvt_pk_f16_f32 v178, v178, v179
    v_pk_mul_f16 v198, v178, v178
    v_mfma_f32_16x16x32_bf16 v[186:189], a[36:39], v[222:225], v[186:189]
    v_cvt_pk_f16_f32 v179, v180, v181
    v_pk_fma_f16 v198, v179, v179, v198
    v_mfma_f32_16x16x32_bf16 v[186:189], a[40:43], v[226:229], v[186:189]
    v_pk_mul_f16 v200, v178, v170
    v_pk_fma_f16 v200, v179, v171, v200
    v_mfma_f32_16x16x32_bf16 v[186:189], a[44:47], v[190:193], v[186:189]
    v_pk_mul_f16 v201, v166, v174
    v_pk_fma_f16 v201, v167, v175, v201
    v_mfma_f32_16x16x32_bf16 v[194:197], a[48:51], v[182:185], 0
    v_pk_fma_f16 v201, v168, v176, v201
    v_pk_fma_f16 v201, v169, v177, v201
    v_mfma_f32_16x16x32_bf16 v[194:197], a[52:55], v[210:213], v[194:197]
    v_pk_fma_f16 v201, v124, v164, v201
    v_pk_fma_f16 v201, v125, v165, v201
    v_mfma_f32_16x16x32_bf16 v[194:197], a[56:59], v[218:221], v[194:197]
    v_cvt_pk_f16_f32 v180, v186, v187
    v_pk_fma_f16 v198, v180, v180, v198
    v_mfma_f32_16x16x32_bf16 v[194:197], a[60:63], v[222:225], v[194:197]
    v_cvt_pk_f16_f32 v181, v188, v189
    v_pk_fma_f16 v198, v181, v181, v198
    v_mfma_f32_16x16x32_bf16 v[194:197], a[64:67], v[226:229], v[194:197]
    v_pk_fma_f16 v200, v180, v172, v200
    v_pk_fma_f16 v200, v181, v173, v200
    v_mfma_f32_16x16x32_bf16 v[194:197], a[68:71], v[190:193], v[194:197]
    buffer_store_dwordx2 v[140:141], v18, s[12:15], 0 offen nt
    v_mul_f32 v242, v144, v242
    v_mul_f32 v243, v144, v243
    v_mfma_f32_16x16x32_bf16 v[186:189], v[182:185], a[144:147], 0
    v_cvt_pk_bf16_f32 v238, v242, v243
    v_mul_f32 v244, v144, v244
    v_mfma_f32_16x16x32_bf16 v[186:189], v[210:213], a[148:151], v[186:189]
    v_mul_f32 v245, v144, v245
    v_cvt_pk_f16_f32 v122, v194, v195
    v_mfma_f32_16x16x32_bf16 v[186:189], v[218:221], a[152:155], v[186:189]
    v_pk_fma_f16 v198, v122, v122, v198
    v_cvt_pk_f16_f32 v123, v196, v197
    v_mfma_f32_16x16x32_bf16 v[186:189], v[222:225], a[156:159], v[186:189]
    v_pk_fma_f16 v198, v123, v123, v198
    v_pk_fma_f16 v200, v122, v162, v200
    v_mfma_f32_16x16x32_bf16 v[186:189], v[226:229], a[160:163], v[186:189]
    ds_read_b128 v[202:205], v0 offset:32768
    v_pk_fma_f16 v200, v123, v163, v200
    v_mfma_f32_16x16x32_bf16 v[186:189], v[190:193], a[164:167], v[186:189]
    ds_read_b128 v[194:197], v1 offset:32768
    v_cvt_pk_bf16_f32 v239, v244, v245
    v_mfma_f32_16x16x32_f16 v[230:233], v[40:43], v[198:201], 0
    v_mul_f32 v158, v144, v158
    v_mul_f32 v159, v144, v159
    v_mfma_f32_16x16x32_bf16 v[246:249], v[182:185], a[168:171], 0
    ds_read_b128 v[214:217], v0 offset:32896
    v_cvt_pk_bf16_f32 v240, v158, v159
    v_mfma_f32_16x16x32_bf16 v[246:249], v[210:213], a[172:175], v[246:249]
    ds_read_b128 v[206:209], v1 offset:32896
    v_cvt_pk_bf16_f32 v136, v186, v187
    v_mfma_f32_16x16x32_bf16 v[246:249], v[218:221], a[176:179], v[246:249]
    ds_read_b128 v[198:201], v0 offset:33024
    v_cvt_pk_bf16_f32 v137, v188, v189
    v_mfma_f32_16x16x32_bf16 v[246:249], v[222:225], a[180:183], v[246:249]
    ds_read_b128 v[186:189], v1 offset:33024
    v_mul_f32 v160, v144, v160
    v_mfma_f32_16x16x32_bf16 v[246:249], v[226:229], a[184:187], v[246:249]
    v_rsq_f32 v230, v230
    v_mfma_f32_16x16x32_bf16 v[246:249], v[190:193], a[188:191], v[246:249]
    s_waitcnt lgkmcnt(5)
    v_rsq_f32 v231, v231
    v_mfma_f32_16x16x32_bf16 v[242:245], v[182:185], a[192:195], 0
    s_waitcnt lgkmcnt(4)
    v_mul_f32 v234, s31, v230
    v_cvt_pk_f16_f32 v235, v234, v231
    v_mfma_f32_16x16x32_bf16 v[242:245], v[210:213], a[196:199], v[242:245]
    v_fma_f32 v232, v232, v234, v24
    v_fmac_f32_dpp v254, v233, v231 quad_perm:[0,1,2,3] row_mask:0x2 bank_mask:0xf
    v_mfma_f32_16x16x32_bf16 v[242:245], v[218:221], a[200:203], v[242:245]
    s_waitcnt lgkmcnt(3)
    v_cvt_pk_bf16_f32 v140, v246, v247
    v_cvt_pk_bf16_f32 v141, v248, v249
    v_mfma_f32_16x16x32_bf16 v[242:245], v[222:225], a[204:207], v[242:245]
    s_waitcnt lgkmcnt(2)
    v_mul_f32 v161, v144, v161
    v_cvt_pk_bf16_f32 v241, v160, v161
    v_mfma_f32_16x16x32_bf16 v[242:245], v[226:229], a[208:211], v[242:245]
    s_waitcnt lgkmcnt(1)
    buffer_store_dwordx4 v[238:241], v17, s[12:15], 0 offen nt
    v_mul_f32 v154, v144, v154
    v_mul_f32 v155, v144, v155
    v_cvt_pk_bf16_f32 v154, v154, v155
    v_mul_f32 v156, v144, v156
    v_mfma_f32_16x16x32_bf16 v[242:245], v[190:193], a[212:215], v[242:245]
    s_waitcnt lgkmcnt(0)
    v_mul_f32 v157, v144, v157
    v_cvt_pk_bf16_f32 v155, v156, v157
    v_mfma_f32_16x16x32_bf16 v[158:161], a[72:75], v[202:205], 0
    v_pk_mul_f16 v166, v166, v235 op_sel:[0,1] op_sel_hi:[1,1]
    v_pk_mul_f16 v167, v167, v235 op_sel:[0,1] op_sel_hi:[1,1]
    v_mfma_f32_16x16x32_bf16 v[158:161], a[76:79], v[194:197], v[158:161]
    v_pk_mul_f16 v168, v168, v235 op_sel:[0,1] op_sel_hi:[1,1]
    v_cvt_pk_bf16_f32 v144, v242, v243
    v_mfma_f32_16x16x32_bf16 v[158:161], a[80:83], v[214:217], v[158:161]
    v_cvt_pk_bf16_f32 v145, v244, v245
    v_pk_mul_f16 v169, v169, v235 op_sel:[0,1] op_sel_hi:[1,1]
    v_mfma_f32_16x16x32_bf16 v[158:161], a[84:87], v[206:209], v[158:161]
    v_pk_mul_f16 v124, v124, v235 op_sel:[0,1] op_sel_hi:[1,1]
    v_pk_mul_f16 v125, v125, v235 op_sel:[0,1] op_sel_hi:[1,1]
    v_mfma_f32_16x16x32_bf16 v[158:161], a[88:91], v[198:201], v[158:161]
    v_pk_mul_f16 v178, v178, v235 op_sel:[0,0] op_sel_hi:[1,0]
    v_pk_mul_f16 v179, v179, v235 op_sel:[0,0] op_sel_hi:[1,0]
    v_mfma_f32_16x16x32_bf16 v[158:161], a[92:95], v[186:189], v[158:161]
    v_pk_mul_f16 v180, v180, v235 op_sel:[0,0] op_sel_hi:[1,0]
    v_pk_mul_f16 v181, v181, v235 op_sel:[0,0] op_sel_hi:[1,0]
    v_mfma_f32_16x16x32_bf16 v[182:185], a[96:99], v[202:205], 0
    v_pk_mul_f16 v122, v122, v235 op_sel:[0,0] op_sel_hi:[1,0]
    v_pk_mul_f16 v123, v123, v235 op_sel:[0,0] op_sel_hi:[1,0]
    v_mfma_f32_16x16x32_bf16 v[182:185], a[100:103], v[194:197], v[182:185]
    v_max3_u32 v44, v44, v230, v231
    v_mul_f32 v130, v255, v130
    v_mfma_f32_16x16x32_bf16 v[182:185], a[104:107], v[214:217], v[182:185]
    v_cvt_pk_f16_f32 v158, v158, v159
    v_pk_mul_f16 v191, v158, v158
    v_mfma_f32_16x16x32_bf16 v[182:185], a[108:111], v[206:209], v[182:185]
    v_cvt_pk_f16_f32 v159, v160, v161
    v_pk_fma_f16 v191, v159, v159, v191
    v_mfma_f32_16x16x32_bf16 v[182:185], a[112:115], v[198:201], v[182:185]
    v_pk_mul_f16 v193, v158, v174
    v_pk_fma_f16 v193, v159, v175, v193
    v_mfma_f32_16x16x32_bf16 v[182:185], a[116:119], v[186:189], v[182:185]
    v_exp_f32 v232, v232
    v_mfma_f32_16x16x32_bf16 v[210:213], a[120:123], v[202:205], 0
    v_exp_f32 v236, v236
    v_mfma_f32_16x16x32_bf16 v[210:213], a[124:127], v[194:197], v[210:213]
    v_cvt_pk_bf16_f32 v39, v236, 0
    v_mul_f32 v131, v255, v131
    v_mfma_f32_16x16x32_bf16 v[210:213], a[128:131], v[214:217], v[210:213]
    s_waitcnt vmcnt(3)
    ds_write_b16 v8, v45 offset:512
    v_mfma_f32_16x16x32_bf16 v[210:213], a[132:135], v[206:209], v[210:213]
    buffer_store_dwordx2 v[154:155], v20, s[12:15], 0 offen nt
    v_mov_b32 v45, 1
    v_cvt_pk_f16_f32 v160, v182, v183
    v_mfma_f32_16x16x32_bf16 v[210:213], a[136:139], v[198:201], v[210:213]
    v_pk_fma_f16 v191, v160, v160, v191
    v_cvt_pk_f16_f32 v161, v184, v185
    v_mfma_f32_16x16x32_bf16 v[210:213], a[140:143], v[186:189], v[210:213]
    v_pk_fma_f16 v191, v161, v161, v191
    v_pk_fma_f16 v193, v160, v176, v193
    v_mfma_f32_16x16x32_bf16 v[154:157], a[0:3], v[202:205], 0
    v_pk_fma_f16 v193, v161, v177, v193
    v_cvt_pk_bf16_f32 v130, v130, v131
    v_mfma_f32_16x16x32_bf16 v[154:157], a[4:7], v[194:197], v[154:157]
    v_mul_f32 v132, v255, v132
    v_mul_f32 v133, v255, v133
    v_mfma_f32_16x16x32_bf16 v[154:157], a[8:11], v[214:217], v[154:157]
    v_cvt_pk_f16_f32 v176, v210, v211
    v_pk_fma_f16 v191, v176, v176, v191
    v_mfma_f32_16x16x32_bf16 v[154:157], a[12:15], v[206:209], v[154:157]
    s_waitcnt lgkmcnt(0)
    v_cvt_pk_f16_f32 v177, v212, v213
    v_pk_fma_f16 v191, v177, v177, v191
    v_mfma_f32_16x16x32_bf16 v[154:157], a[16:19], v[198:201], v[154:157]
    s_barrier
    v_pk_fma_f16 v193, v176, v164, v193
    v_mfma_f32_16x16x32_bf16 v[154:157], a[20:23], v[186:189], v[154:157]
    v_pk_fma_f16 v193, v177, v165, v193
    v_mfma_f32_16x16x32_bf16 v[182:185], a[24:27], v[202:205], 0
    v_cvt_pk_bf16_f32 v131, v132, v133
    v_mfma_f32_16x16x32_bf16 v[182:185], a[28:31], v[194:197], v[182:185]
    ds_read2_b32 v[164:165], v6 offset0:0 offset1:0
    v_mfma_f32_16x16x32_bf16 v[182:185], a[32:35], v[214:217], v[182:185]
    ds_read2_b32 v[212:213], v6 offset0:16 offset1:16
    s_nop 0
    v_cvt_pk_f16_f32 v154, v154, v155
    v_mfma_f32_16x16x32_bf16 v[182:185], a[36:39], v[206:209], v[182:185]
    ds_read2_b32 v[220:221], v6 offset0:32 offset1:32
    v_pk_mul_f16 v190, v154, v154
    v_mfma_f32_16x16x32_bf16 v[182:185], a[40:43], v[198:201], v[182:185]
    ds_read_u16 v133, v9 offset:512
    v_cvt_pk_f16_f32 v155, v156, v157
    v_mfma_f32_16x16x32_bf16 v[182:185], a[44:47], v[186:189], v[182:185]
    v_pk_fma_f16 v190, v155, v155, v190
    v_pk_mul_f16 v192, v154, v170
    v_mfma_f32_16x16x32_bf16 v[222:225], a[48:51], v[202:205], 0
    v_pk_fma_f16 v192, v155, v171, v192
    v_mul_f32 v126, v255, v126
    v_mfma_f32_16x16x32_bf16 v[222:225], a[52:55], v[194:197], v[222:225]
    v_mul_f32 v127, v255, v127
    v_cvt_pk_bf16_f32 v132, v126, v127
    v_mfma_f32_16x16x32_bf16 v[222:225], a[56:59], v[214:217], v[222:225]
    buffer_load_dwordx4 v10, s[8:11], 0 offen nt lds
    v_cvt_pk_f16_f32 v156, v182, v183
    v_mfma_f32_16x16x32_bf16 v[222:225], a[60:63], v[206:209], v[222:225]
    s_add_u32 m0, s28, 4096
    v_pk_fma_f16 v190, v156, v156, v190
    v_cvt_pk_f16_f32 v157, v184, v185
    v_mfma_f32_16x16x32_bf16 v[222:225], a[64:67], v[198:201], v[222:225]
    s_waitcnt lgkmcnt(2)
    v_pk_fma_f16 v190, v157, v157, v190
    v_pk_fma_f16 v192, v156, v172, v192
    v_mfma_f32_16x16x32_bf16 v[222:225], a[68:71], v[186:189], v[222:225]
    s_waitcnt lgkmcnt(1)
    ds_read_b128 v[182:185], v2 offset:0
    v_pk_fma_f16 v192, v157, v173, v192
    v_mfma_f32_16x16x32_bf16 v[170:173], v[202:205], a[144:147], 0
    s_waitcnt lgkmcnt(1)
    ds_read_b128 v[226:229], v2 offset:1024
    v_readfirstlane_b32 s77, v133
    v_mfma_f32_16x16x32_bf16 v[170:173], v[194:197], a[148:151], v[170:173]
    ds_read_b128 v[234:237], v2 offset:2048
    buffer_load_dwordx4 v11, s[8:11], 0 offen nt lds
    v_mfma_f32_16x16x32_bf16 v[170:173], v[214:217], a[152:155], v[170:173]
    s_add_u32 m0, s28, 8192
    ds_read_b128 v[238:241], v2 offset:3072
    v_cvt_pk_f16_f32 v174, v222, v223
    v_mfma_f32_16x16x32_bf16 v[170:173], v[206:209], a[156:159], v[170:173]
    s_mul_i32 s78, s77, 2688
    ds_read_b128 v[242:245], v2 offset:4096
    v_pk_fma_f16 v190, v174, v174, v190
    v_mfma_f32_16x16x32_bf16 v[170:173], v[198:201], a[160:163], v[170:173]
    ds_read_b128 v[246:249], v2 offset:5120
    v_cvt_pk_f16_f32 v175, v224, v225
    v_mfma_f32_16x16x32_bf16 v[170:173], v[186:189], a[164:167], v[170:173]
    v_pk_fma_f16 v190, v175, v175, v190
    v_pk_fma_f16 v192, v174, v162, v192
    v_mfma_f32_16x16x32_bf16 v[222:225], v[202:205], a[168:171], 0
    buffer_load_dwordx4 v12, s[8:11], 0 offen nt lds
    v_pk_fma_f16 v192, v175, v163, v192
    v_mfma_f32_16x16x32_bf16 v[222:225], v[194:197], a[172:175], v[222:225]
    s_waitcnt lgkmcnt(5)
    v_mul_f32 v128, v255, v128
    v_cvt_pk_bf16_f32 v162, v170, v171
    v_mfma_f32_16x16x32_f16 v[250:253], v[40:43], v[190:193], 0
    s_add_u32 m0, s28, 12288
    v_cvt_pk_bf16_f32 v163, v172, v173
    v_mul_f32 v129, v255, v129
    v_mfma_f32_16x16x32_bf16 v[222:225], v[214:217], a[176:179], v[222:225]
    s_xor_b32 s28, s28, 65536
    v_cvt_pk_bf16_f32 v133, v128, v129
    v_mul_f32 v114, v255, v114
    v_mfma_f32_16x16x32_bf16 v[222:225], v[206:209], a[180:183], v[222:225]
    s_waitcnt lgkmcnt(2)
    v_rsq_f32 v250, v250
    v_mfma_f32_16x16x32_bf16 v[222:225], v[198:201], a[184:187], v[222:225]
    s_waitcnt lgkmcnt(1)
    buffer_load_dwordx4 v13, s[8:11], 0 offen nt lds
    v_mul_f32 v230, s31, v250
    v_mfma_f32_16x16x32_bf16 v[222:225], v[186:189], a[188:191], v[222:225]
    s_mov_b32 m0, s29
    v_rsq_f32 v251, v251
    v_mfma_f32_16x16x32_bf16 v[126:129], v[202:205], a[192:195], 0
    s_xor_b32 s29, s29, s30
    v_cvt_pk_f16_f32 v231, v230, v251
    v_fma_f32 v252, v252, v230, v26
    v_mfma_f32_16x16x32_bf16 v[126:129], v[194:197], a[196:199], v[126:129]
    s_add_u32 s19, s19, s20
    v_fmac_f32_dpp v254, v253, v251 quad_perm:[0,1,2,3] row_mask:0x4 bank_mask:0xf
    v_cvt_pk_bf16_f32 v210, v222, v223
    v_mfma_f32_16x16x32_bf16 v[126:129], v[214:217], a[200:203], v[126:129]
    s_add_u32 s23, s23, s21
    v_cvt_pk_bf16_f32 v211, v224, v225
    v_pk_mul_f16 v158, v158, v231 op_sel:[0,1] op_sel_hi:[1,1]
    v_mfma_f32_16x16x32_bf16 v[126:129], v[206:209], a[204:207], v[126:129]
    s_waitcnt lgkmcnt(0)
    buffer_load_dwordx4 v14, s[8:11], 0 offen nt lds
    v_pk_mul_f16 v159, v159, v231 op_sel:[0,1] op_sel_hi:[1,1]
    v_mfma_f32_16x16x32_bf16 v[126:129], v[198:201], a[208:211], v[126:129]
    s_cmp_ge_u32 s19, 72
    v_pk_mul_f16 v160, v160, v231 op_sel:[0,1] op_sel_hi:[1,1]
    v_pk_mul_f16 v161, v161, v231 op_sel:[0,1] op_sel_hi:[1,1]
    v_mfma_f32_16x16x32_bf16 v[126:129], v[186:189], a[212:215], v[126:129]
    s_cselect_b32 s34, 72, 0
    v_pk_mul_f16 v176, v176, v231 op_sel:[0,1] op_sel_hi:[1,1]
    v_pk_mul_f16 v177, v177, v231 op_sel:[0,1] op_sel_hi:[1,1]
    v_mfma_f32_16x16x32_f16 v[170:173], v[146:149], v[150:153], v[46:49]
    s_cselect_b32 s35, s22, 0
    v_pk_mul_f16 v154, v154, v231 op_sel:[0,0] op_sel_hi:[1,0]
    v_pk_mul_f16 v155, v155, v231 op_sel:[0,0] op_sel_hi:[1,0]
    v_mfma_f32_16x16x32_f16 v[186:189], v[166:169], v[150:153], v[50:53]
    s_sub_u32 s19, s19, s34
    v_cvt_pk_bf16_f32 v218, v126, v127
    v_cvt_pk_bf16_f32 v219, v128, v129
    v_mfma_f32_16x16x32_f16 v[126:129], v[158:161], v[150:153], v[54:57]
    buffer_store_dwordx4 v[130:133], v16, s[12:15], 0 offen nt
    v_pk_mul_f16 v156, v156, v231 op_sel:[0,0] op_sel_hi:[1,0]
    v_pk_mul_f16 v157, v157, v231 op_sel:[0,0] op_sel_hi:[1,0]
    v_pk_mul_f16 v174, v174, v231 op_sel:[0,0] op_sel_hi:[1,0]
    v_pk_mul_f16 v175, v175, v231 op_sel:[0,0] op_sel_hi:[1,0]
    v_mfma_f32_16x16x16_f16 v[170:173], v[120:121], v[118:119], v[170:173]
    v_max3_u32 v44, v44, v250, v251
    v_exp_f32 v254, v254
    v_mfma_f32_16x16x16_f16 v[186:189], v[124:125], v[118:119], v[186:189]
    v_cvt_pk_bf16_f32 v254, v254, v254
    v_exp_f32 v252, v252
    v_mfma_f32_16x16x16_f16 v[126:129], v[176:177], v[118:119], v[126:129]
    v_mul_f32 v115, v255, v115
    v_cvt_pk_bf16_f32 v118, v114, v115
    v_exp_f32 v170, v170
    v_mfma_f32_16x16x32_f16 v[130:133], v[146:149], v[178:181], v[58:61]
    s_add_u32 s23, s23, s35
    ds_write_b16 v8, v254
    v_mfma_f32_16x16x32_f16 v[150:153], v[166:169], v[178:181], v[62:65]
    s_add_u32 s78, s78, s69
    v_exp_f32 v171, v171
    v_mfma_f32_16x16x32_f16 v[190:193], v[158:161], v[178:181], v[66:69]
    s_add_u32 s80, s77, s68
    v_cvt_pk_bf16_f32 v170, v170, v171
    v_exp_f32 v172, v172
    v_mfma_f32_16x16x16_f16 v[130:133], v[120:121], v[122:123], v[130:133]
    v_exp_f32 v173, v173
    v_mul_f32 v116, v255, v116
    v_mfma_f32_16x16x16_f16 v[150:153], v[124:125], v[122:123], v[150:153]
    v_cvt_pk_bf16_f32 v171, v172, v173
    v_exp_f32 v186, v186
    v_mfma_f32_16x16x16_f16 v[190:193], v[176:177], v[122:123], v[190:193]
    v_exp_f32 v187, v187
    v_exp_f32 v188, v188
    v_mfma_f32_16x16x32_bf16 v[178:181], a[216:219], v[182:185], 0
    s_cmp_ge_u32 s80, 72
    v_exp_f32 v130, v130
    v_mfma_f32_16x16x32_bf16 v[178:181], a[220:223], v[226:229], v[178:181]
    s_cselect_b32 s80, s22, 0
    v_exp_f32 v131, v131
    v_mfma_f32_16x16x32_bf16 v[178:181], a[224:227], v[234:237], v[178:181]
    s_add_u32 s78, s78, s80
    v_cvt_pk_bf16_f32 v194, v130, v131
    v_cvt_pk_bf16_f32 v172, v186, v187
    v_mfma_f32_16x16x32_bf16 v[178:181], a[228:231], v[238:241], v[178:181]
    s_add_u32 s80, s77, 20
    v_exp_f32 v132, v132
    v_mfma_f32_16x16x32_bf16 v[178:181], a[232:235], v[242:245], v[178:181]
    s_add_u32 s34, s18, 3
    v_exp_f32 v133, v133
    v_mfma_f32_16x16x32_bf16 v[178:181], a[236:239], v[246:249], v[178:181]
    s_cmp_lt_u32 s77, s62
    v_cvt_pk_bf16_f32 v195, v132, v133
    v_mul_f32 v117, v255, v117
    v_mfma_f32_16x16x32_bf16 v[198:201], a[240:243], v[182:185], 0
    s_cselect_b32 s79, 1, 0
    v_exp_f32 v150, v150
    v_mfma_f32_16x16x32_f16 v[202:205], v[146:149], v[154:157], v[70:73]
    s_cselect_b32 s78, s78, 0
    v_exp_f32 v151, v151
    v_mfma_f32_16x16x32_f16 v[146:149], v[166:169], v[154:157], v[74:77]
    s_cmp_lt_u32 s34, s17
    v_cvt_pk_bf16_f32 v196, v150, v151
    v_cvt_pk_bf16_f32 v119, v116, v117
    v_mfma_f32_16x16x32_f16 v[166:169], v[158:161], v[154:157], v[78:81]
    buffer_store_dwordx2 v[118:119], v19, s[12:15], 0 offen nt
    v_exp_f32 v152, v152
    v_mfma_f32_16x16x16_f16 v[202:205], v[120:121], v[174:175], v[202:205]
    v_exp_f32 v153, v153
    v_fma_f32 v254, v178, v178, s33
    v_mfma_f32_16x16x16_f16 v[146:149], v[124:125], v[174:175], v[146:149]
    v_cvt_pk_bf16_f32 v197, v152, v153
    v_exp_f32 v190, v190
    v_mfma_f32_16x16x16_f16 v[166:169], v[176:177], v[174:175], v[166:169]
    v_exp_f32 v191, v191
    v_exp_f32 v192, v192
    v_mfma_f32_16x16x32_bf16 v[198:201], a[244:247], v[226:229], v[198:201]
    s_cselect_b32 s23, s23, s78
    v_exp_f32 v193, v193
    v_mfma_f32_16x16x32_bf16 v[198:201], a[248:251], v[234:237], v[198:201]
    s_cselect_b32 s73, s34, s80
    ds_read_b128 v[118:121], v2 offset:6144
    v_fmac_f32 v254, v179, v179
    v_mfma_f32_16x16x32_bf16 v[198:201], a[252:255], v[238:241], v[198:201]
    s_cselect_b32 s79, 0, s79
    ds_read_b128 v[122:125], v2 offset:7168
    v_fmac_f32 v254, v180, v180
    v_mfma_f32_16x16x32_bf16 v[198:201], v[82:85], v[242:245], v[198:201]
    s_cselect_b32 s81, 0, 1
    ds_read_b128 v[150:153], v2 offset:8192
    v_fmac_f32 v254, v181, v181
    v_mfma_f32_16x16x32_bf16 v[198:201], v[86:89], v[246:249], v[198:201]
    s_add_u32 s80, s77, 1
    ds_read_b128 v[154:157], v2 offset:9216
    v_xor_b32 v0, 65536, v0
    v_mfma_f32_16x16x32_bf16 v[206:209], v[90:93], v[182:185], 0
    s_mul_i32 s80, s80, s81
    ds_read_b128 v[158:161], v2 offset:10240
    v_xor_b32 v1, 65536, v1
    v_mfma_f32_16x16x32_bf16 v[206:209], v[94:97], v[226:229], v[206:209]
    s_cmp_lt_u32 s80, s62
    ds_read_b128 v[174:177], v2 offset:11264
    v_fmac_f32 v254, v198, v198
    v_mfma_f32_16x16x32_bf16 v[206:209], v[98:101], v[234:237], v[206:209]
    s_cselect_b32 s62, s62, 0
    v_exp_f32 v189, v189
    v_mfma_f32_16x16x32_bf16 v[206:209], v[102:105], v[238:241], v[206:209]
    s_add_u32 s80, s18, 4
    v_cvt_pk_bf16_f32 v173, v188, v189
    v_fmac_f32 v254, v199, v199
    v_mfma_f32_16x16x32_bf16 v[206:209], v[106:109], v[242:245], v[206:209]
    s_waitcnt lgkmcnt(5)
    v_exp_f32 v126, v126
    v_mfma_f32_16x16x32_bf16 v[206:209], v[110:113], v[246:249], v[206:209]
    s_cmp_ge_u32 s80, s17
    v_exp_f32 v127, v127
    v_mfma_f32_16x16x32_bf16 v[130:133], a[216:219], v[118:121], 0
    s_waitcnt lgkmcnt(3)
    v_cvt_pk_bf16_f32 v36, v126, v127
    v_fmac_f32 v254, v200, v200
    v_mfma_f32_16x16x32_bf16 v[130:133], a[220:223], v[122:125], v[130:133]
    s_cselect_b32 s66, s62, 0
    v_exp_f32 v128, v128
    v_mfma_f32_16x16x32_bf16 v[130:133], a[224:227], v[150:153], v[130:133]
    s_waitcnt lgkmcnt(1)
    buffer_atomic_add v45, v10, s[64:67], 0 offen sc0 sc1
    v_fmac_f32 v254, v201, v201
    v_mfma_f32_16x16x32_bf16 v[130:133], a[228:231], v[154:157], v[130:133]
    s_lshl_b32 s80, s79, s73
    v_exp_f32 v129, v129
    v_mfma_f32_16x16x32_bf16 v[130:133], a[232:235], v[158:161], v[130:133]
    s_waitcnt lgkmcnt(0)
    v_cvt_pk_bf16_f32 v37, v128, v129
    v_fmac_f32 v254, v206, v206
    v_mfma_f32_16x16x32_bf16 v[130:133], a[236:239], v[174:177], v[130:133]
    s_or_b32 s70, s70, s80
    v_exp_f32 v202, v202
    v_mfma_f32_16x16x32_bf16 v[182:185], v[28:31], v[36:39], 0
    s_add_u32 s45, s45, s79
    v_exp_f32 v203, v203
    v_mfma_f32_16x16x32_bf16 v[182:185], v[28:31], v[170:173], v[182:185]
    s_add_u32 s18, s18, 1
    v_cvt_pk_bf16_f32 v186, v202, v203
    v_fma_f32 v255, v130, v130, s33
    v_mfma_f32_16x16x32_bf16 v[214:217], v[162:165], v[36:39], 0
    s_cmp_lt_u32 s18, s45
    v_fmac_f32 v255, v131, v131
    v_fmac_f32 v255, v132, v132
    v_mfma_f32_16x16x32_bf16 v[214:217], v[134:137], v[170:173], v[214:217]
    v_fmac_f32 v255, v133, v133
    v_fmac_f32 v254, v207, v207
    v_mfma_f32_16x16x32_bf16 v[222:225], v[210:213], v[36:39], 0
    v_exp_f32 v204, v204
    v_mfma_f32_16x16x32_bf16 v[222:225], v[138:141], v[170:173], v[222:225]
    v_exp_f32 v205, v205
    v_mfma_f32_16x16x32_bf16 v[226:229], v[218:221], v[36:39], 0
    v_cvt_pk_bf16_f32 v36, v190, v191
    v_cvt_pk_bf16_f32 v37, v192, v193
    v_mfma_f32_16x16x32_bf16 v[226:229], v[142:145], v[170:173], v[226:229]
    v_cvt_pk_bf16_f32 v39, v232, 0
    v_cvt_pk_bf16_f32 v187, v204, v205
    v_mfma_f32_16x16x32_bf16 v[126:129], a[240:243], v[118:121], 0
    v_exp_f32 v146, v146
    v_mfma_f32_16x16x32_bf16 v[170:173], v[28:31], v[36:39], 0
    v_exp_f32 v147, v147
    v_mfma_f32_16x16x32_bf16 v[170:173], v[28:31], v[194:197], v[170:173]
    v_cvt_pk_bf16_f32 v188, v146, v147
    v_fmac_f32 v254, v208, v208
    v_mfma_f32_16x16x32_bf16 v[114:117], v[162:165], v[36:39], 0
    v_exp_f32 v148, v148
    v_mfma_f32_16x16x32_bf16 v[114:117], v[134:137], v[194:197], v[114:117]
    v_exp_f32 v149, v149
    v_mfma_f32_16x16x32_bf16 v[190:193], v[210:213], v[36:39], 0
    v_cvt_pk_bf16_f32 v189, v148, v149
    v_fmac_f32 v254, v209, v209
    v_mfma_f32_16x16x32_bf16 v[190:193], v[138:141], v[194:197], v[190:193]
    v_rcp_f32 v170, v170
    v_mfma_f32_16x16x32_bf16 v[146:149], v[218:221], v[36:39], 0
    v_exp_f32 v166, v166
    v_mfma_f32_16x16x32_bf16 v[146:149], v[142:145], v[194:197], v[146:149]
    v_mul_f32 v114, v170, v114
    v_mul_f32 v115, v170, v115
    v_mfma_f32_16x16x32_bf16 v[126:129], a[244:247], v[122:125], v[126:129]
    v_cvt_pk_bf16_f32 v194, v114, v115
    v_mul_f32 v116, v170, v116
    v_mfma_f32_16x16x32_bf16 v[126:129], a[248:251], v[150:153], v[126:129]
    ds_read_b128 v[202:205], v2 offset:12288
    v_mul_f32 v117, v170, v117
    v_mfma_f32_16x16x32_bf16 v[126:129], a[252:255], v[154:157], v[126:129]
    ds_read_b128 v[230:233], v2 offset:13312
    v_cvt_pk_bf16_f32 v195, v116, v117
    v_mfma_f32_16x16x32_bf16 v[126:129], v[82:85], v[158:161], v[126:129]
    ds_read_b128 v[234:237], v2 offset:14336
    v_mul_f32 v190, v170, v190
    v_mfma_f32_16x16x32_bf16 v[126:129], v[86:89], v[174:177], v[126:129]
    ds_read_b128 v[238:241], v2 offset:15360
    v_mul_f32 v191, v170, v191
    v_mfma_f32_16x16x32_bf16 v[114:117], v[90:93], v[118:121], 0
    ds_read_b128 v[118:121], v2 offset:16384
    v_cvt_pk_bf16_f32 v196, v190, v191
    v_mfma_f32_16x16x32_bf16 v[114:117], v[94:97], v[122:125], v[114:117]
    ds_read_b128 v[122:125], v2 offset:17408
    v_mul_f32 v192, v170, v192
    v_mfma_f32_16x16x32_bf16 v[114:117], v[98:101], v[150:153], v[114:117]
    v_fmac_f32 v255, v126, v126
    v_fmac_f32 v255, v127, v127
    v_mfma_f32_16x16x32_bf16 v[114:117], v[102:105], v[154:157], v[114:117]
    v_fmac_f32 v255, v128, v128
    v_fmac_f32 v255, v129, v129
    v_mfma_f32_16x16x32_bf16 v[114:117], v[106:109], v[158:161], v[114:117]
    s_waitcnt lgkmcnt(5)
    v_mul_f32 v193, v170, v193
    v_cvt_pk_bf16_f32 v197, v192, v193
    v_mfma_f32_16x16x32_bf16 v[114:117], v[110:113], v[174:177], v[114:117]
    s_waitcnt lgkmcnt(4)
    ds_write_b128 v3, v[194:197] offset:6144
    v_mfma_f32_16x16x32_bf16 v[242:245], a[216:219], v[202:205], 0
    s_waitcnt lgkmcnt(3)
    v_mul_f32 v146, v170, v146
    v_mul_f32 v147, v170, v147
    v_mfma_f32_16x16x32_bf16 v[242:245], a[220:223], v[230:233], v[242:245]
    s_waitcnt lgkmcnt(2)
    v_fmac_f32 v255, v114, v114
    v_fmac_f32 v255, v115, v115
    v_mfma_f32_16x16x32_bf16 v[242:245], a[224:227], v[234:237], v[242:245]
    s_waitcnt lgkmcnt(1)
    v_fmac_f32 v255, v116, v116
    v_fmac_f32 v255, v117, v117
    v_mfma_f32_16x16x32_bf16 v[242:245], a[228:231], v[238:241], v[242:245]
    v_cvt_pk_bf16_f32 v254, v254, v255
    v_cvt_pk_bf16_f32 v172, v146, v147
    v_mfma_f32_16x16x32_bf16 v[242:245], a[232:235], v[118:121], v[242:245]
    v_mul_f32 v148, v170, v148
    v_mul_f32 v149, v170, v149
    v_mfma_f32_16x16x32_bf16 v[242:245], a[236:239], v[122:125], v[242:245]
    v_cvt_pk_bf16_f32 v173, v148, v149
    v_cvt_pk_bf16_f32 v39, v252, 0
    v_mfma_f32_16x16x32_bf16 v[158:161], a[240:243], v[202:205], 0
    ds_write_b64 v4, v[172:173] offset:10240
    v_mfma_f32_16x16x32_bf16 v[158:161], a[244:247], v[230:233], v[158:161]
    v_exp_f32 v167, v167
    v_mfma_f32_16x16x32_bf16 v[158:161], a[248:251], v[234:237], v[158:161]
    v_cvt_pk_bf16_f32 v36, v166, v167
    v_fma_f32 v255, v242, v242, s33
    v_mfma_f32_16x16x32_bf16 v[158:161], a[252:255], v[238:241], v[158:161]
    v_fmac_f32 v255, v243, v243
    v_fmac_f32 v255, v244, v244
    v_mfma_f32_16x16x32_bf16 v[158:161], v[82:85], v[118:121], v[158:161]
    v_fmac_f32 v255, v245, v245
    v_xor_b32 v2, 65536, v2
    v_mfma_f32_16x16x32_bf16 v[158:161], v[86:89], v[122:125], v[158:161]
    v_exp_f32 v168, v168
    v_mfma_f32_16x16x32_bf16 v[154:157], v[90:93], v[202:205], 0
    v_exp_f32 v169, v169
    v_mfma_f32_16x16x32_bf16 v[154:157], v[94:97], v[230:233], v[154:157]
    ds_read_b128 v[146:149], v9
    v_cvt_pk_bf16_f32 v37, v168, v169
    v_mfma_f32_16x16x32_bf16 v[154:157], v[98:101], v[234:237], v[154:157]
    ds_read_b128 v[150:153], v9 offset:64
    v_fmac_f32 v255, v158, v158
    v_mfma_f32_16x16x32_bf16 v[166:169], v[28:31], v[36:39], 0
    v_fmac_f32 v255, v159, v159
    v_fmac_f32 v255, v160, v160
    v_mfma_f32_16x16x32_bf16 v[166:169], v[28:31], v[186:189], v[166:169]
    v_fmac_f32 v255, v161, v161
    v_add_u32 v6, s75, v6
    v_mfma_f32_16x16x32_bf16 v[174:177], v[162:165], v[36:39], 0
    v_rcp_f32 v182, v182
    v_mfma_f32_16x16x32_bf16 v[174:177], v[134:137], v[186:189], v[174:177]
    v_max3_u32 v25, v25, v182, v183
    v_max3_u32 v25, v25, v170, v171
    v_mfma_f32_16x16x32_bf16 v[170:173], v[210:213], v[36:39], 0
    v_rcp_f32 v166, v166
    v_mfma_f32_16x16x32_bf16 v[170:173], v[138:141], v[186:189], v[170:173]
    v_max3_u32 v25, v25, v166, v167
    v_mul_f32 v214, v182, v214
    v_mfma_f32_16x16x32_bf16 v[190:193], v[218:221], v[36:39], 0
    s_waitcnt lgkmcnt(1)
    v_mul_f32 v174, v166, v174
    v_mul_f32 v175, v166, v175
    v_mfma_f32_16x16x32_bf16 v[190:193], v[142:145], v[186:189], v[190:193]
    s_waitcnt lgkmcnt(0)
    v_cvt_pk_bf16_f32 v174, v174, v175
    v_mul_f32 v176, v166, v176
    v_mfma_f32_16x16x32_bf16 v[154:157], v[102:105], v[238:241], v[154:157]
    ds_read_b128 v[186:189], v0 offset:20480
    v_mul_f32 v177, v166, v177
    v_mfma_f32_16x16x32_bf16 v[154:157], v[106:109], v[118:121], v[154:157]
    ds_read_b128 v[194:197], v1 offset:20480
    v_cvt_pk_bf16_f32 v175, v176, v177
    v_mfma_f32_16x16x32_bf16 v[154:157], v[110:113], v[122:125], v[154:157]
    ds_read_b128 v[122:125], v0 offset:20608
    v_mul_f32 v170, v166, v170
    v_mfma_f32_16x16x32_bf16 v[118:121], v[146:149], v[28:31], 0
    ds_read_b128 v[202:205], v1 offset:20608
    v_mul_f32 v171, v166, v171
    v_mfma_f32_16x16x32_bf16 v[118:121], v[150:153], v[28:31], v[118:121]
    ds_read_b128 v[230:233], v0 offset:20736
    v_cvt_pk_bf16_f32 v176, v170, v171
    v_mfma_f32_16x16x32_bf16 v[234:237], v[146:149], v[134:137], 0
    ds_read_b128 v[238:241], v1 offset:20736
    v_fmac_f32 v255, v154, v154
    v_mfma_f32_16x16x32_bf16 v[234:237], v[150:153], v[162:165], v[234:237]
    v_fmac_f32 v255, v155, v155
    v_fmac_f32 v255, v156, v156
    v_mfma_f32_16x16x32_bf16 v[134:137], v[146:149], v[138:141], 0
    v_fmac_f32 v255, v157, v157
    v_cvt_pk_bf16_f32 v255, v255, v255
    v_mfma_f32_16x16x32_bf16 v[134:137], v[150:153], v[210:213], v[134:137]
    s_waitcnt lgkmcnt(5)
    ds_write_b64 v4, v[254:255] offset:18432
    v_mfma_f32_16x16x32_bf16 v[138:141], v[146:149], v[142:145], 0
    s_waitcnt lgkmcnt(4)
    v_mul_f32 v172, v166, v172
    v_mul_f32 v173, v166, v173
    v_mfma_f32_16x16x32_bf16 v[138:141], v[150:153], v[218:221], v[138:141]
    s_waitcnt lgkmcnt(3)
    v_cvt_pk_bf16_f32 v177, v172, v173
    v_mul_f32 v190, v166, v190
    v_mfma_f32_16x16x32_bf16 v[142:145], a[72:75], v[186:189], 0
    s_waitcnt lgkmcnt(2)
    ds_write_b128 v3, v[174:177] offset:12288
    v_mfma_f32_16x16x32_bf16 v[142:145], a[76:79], v[194:197], v[142:145]
    s_waitcnt lgkmcnt(2)
    v_mul_f32 v191, v166, v191
    v_cvt_pk_bf16_f32 v120, v190, v191
    v_mfma_f32_16x16x32_bf16 v[142:145], a[80:83], v[122:125], v[142:145]
    v_mul_f32 v192, v166, v192
    v_mul_f32 v193, v166, v193
    v_mfma_f32_16x16x32_bf16 v[142:145], a[84:87], v[202:205], v[142:145]
    v_cvt_pk_bf16_f32 v121, v192, v193
    v_mul_f32 v215, v182, v215
    v_mfma_f32_16x16x32_bf16 v[142:145], a[88:91], v[230:233], v[142:145]
    ds_write_b64 v4, v[120:121] offset:16384
    v_mfma_f32_16x16x32_bf16 v[142:145], a[92:95], v[238:241], v[142:145]
    v_rcp_f32 v118, v118
    v_mfma_f32_16x16x32_bf16 v[150:153], a[96:99], v[186:189], 0
    v_max3_u32 v25, v25, v118, v119
    v_mul_f32 v234, v234, v118
    v_mfma_f32_16x16x32_bf16 v[150:153], a[100:103], v[194:197], v[150:153]
    v_cvt_pk_bf16_f32 v146, v214, v215
    v_mul_f32_dpp v234, v134, v118 quad_perm:[0,1,2,3] row_mask:0x2 bank_mask:0xf
    v_mfma_f32_16x16x32_bf16 v[150:153], a[104:107], v[122:125], v[150:153]
    v_mul_f32 v216, v182, v216
    v_mul_f32_dpp v234, v138, v118 quad_perm:[0,1,2,3] row_mask:0x4 bank_mask:0xf
    v_mfma_f32_16x16x32_bf16 v[150:153], a[108:111], v[202:205], v[150:153]
    v_cvt_pk_bf16_f32 v234, v234, v234
    v_mul_f32 v217, v182, v217
    v_mfma_f32_16x16x32_bf16 v[150:153], a[112:115], v[230:233], v[150:153]
    ds_write_b16 v7, v234
    v_mfma_f32_16x16x32_bf16 v[150:153], a[116:119], v[238:241], v[150:153]
    v_cvt_pk_bf16_f32 v147, v216, v217
    v_mul_f32 v222, v182, v222
    v_mfma_f32_16x16x32_bf16 v[134:137], a[120:123], v[186:189], 0
    v_mul_f32 v223, v182, v223
    v_cvt_pk_bf16_f32 v148, v222, v223
    v_mfma_f32_16x16x32_bf16 v[134:137], a[124:127], v[194:197], v[134:137]
    v_mul_f32 v224, v182, v224
    v_mul_f32 v225, v182, v225
    v_mfma_f32_16x16x32_bf16 v[134:137], a[128:131], v[122:125], v[134:137]
    v_cvt_pk_bf16_f32 v149, v224, v225
    v_mul_f32 v226, v182, v226
    v_mfma_f32_16x16x32_bf16 v[134:137], a[132:135], v[202:205], v[134:137]
    ds_write_b128 v3, v[146:149] offset:0
    v_mfma_f32_16x16x32_bf16 v[134:137], a[136:139], v[230:233], v[134:137]
    v_mul_f32 v227, v182, v227
    v_cvt_pk_bf16_f32 v254, v226, v227
    v_mfma_f32_16x16x32_bf16 v[134:137], a[140:143], v[238:241], v[134:137]
    v_mul_f32 v228, v182, v228
    v_mul_f32 v229, v182, v229
    v_mfma_f32_16x16x32_bf16 v[138:141], a[0:3], v[186:189], 0
    v_cvt_pk_bf16_f32 v255, v228, v229
    v_xor_b32 v3, 65536, v3
    v_mfma_f32_16x16x32_bf16 v[138:141], a[4:7], v[194:197], v[138:141]
    ds_write_b64 v4, v[254:255] offset:4096
    v_mfma_f32_16x16x32_bf16 v[138:141], a[8:11], v[122:125], v[138:141]
    v_xor_b32 v4, 65536, v4
    v_add_u32 v7, s76, v7
    v_mfma_f32_16x16x32_bf16 v[138:141], a[12:15], v[202:205], v[138:141]
    v_cvt_pk_f16_f32 v146, v142, v143
    v_pk_mul_f16 v143, v146, v146
    v_mfma_f32_16x16x32_bf16 v[138:141], a[16:19], v[230:233], v[138:141]
    v_cvt_pk_f16_f32 v147, v144, v145
    v_pk_fma_f16 v143, v147, v147, v143
    v_mfma_f32_16x16x32_bf16 v[138:141], a[20:23], v[238:241], v[138:141]
    v_cvt_pk_f16_f32 v148, v150, v151
    v_pk_fma_f16 v143, v148, v148, v143
    v_mfma_f32_16x16x32_bf16 v[166:169], a[24:27], v[186:189], 0
    v_cvt_pk_f16_f32 v149, v152, v153
    v_pk_fma_f16 v143, v149, v149, v143
    v_mfma_f32_16x16x32_bf16 v[166:169], a[28:31], v[194:197], v[166:169]
    v_cvt_pk_f16_f32 v120, v134, v135
    v_pk_fma_f16 v143, v120, v120, v143
    v_mfma_f32_16x16x32_bf16 v[166:169], a[32:35], v[122:125], v[166:169]
    s_waitcnt lgkmcnt(0)
    v_cvt_pk_f16_f32 v121, v136, v137
    v_pk_fma_f16 v143, v121, v121, v143
    v_mfma_f32_16x16x32_bf16 v[166:169], a[36:39], v[202:205], v[166:169]
    s_barrier
    v_mfma_f32_16x16x32_bf16 v[166:169], a[40:43], v[230:233], v[166:169]
    s_nop 0
    v_mfma_f32_16x16x32_bf16 v[166:169], a[44:47], v[238:241], v[166:169]
    s_nop 0
    v_mfma_f32_16x16x32_bf16 v[134:137], a[48:51], v[186:189], 0
    s_nop 0
    v_mfma_f32_16x16x32_bf16 v[134:137], a[52:55], v[194:197], v[134:137]
    s_cbranch_scc1 L_loop_fast0
    s_branch L_final_fast
.p2align 6
L_loop_fast1:
    v_mfma_f32_16x16x32_bf16 v[134:137], a[56:59], v[122:125], v[134:137]
    s_add_u32 s12, s40, s27
    ds_read_b128 v[190:193], v2 offset:18432
    v_cvt_pk_f16_f32 v150, v138, v139
    v_mfma_f32_16x16x32_bf16 v[134:137], a[60:63], v[202:205], v[134:137]
    s_addc_u32 s13, s41, 0
    ds_read_b128 v[210:213], v2 offset:19456
    v_pk_mul_f16 v142, v150, v150
    v_mfma_f32_16x16x32_bf16 v[134:137], a[64:67], v[230:233], v[134:137]
    s_sub_u32 s14, s36, s27
    ds_read_b128 v[174:177], v5 offset:32
    v_cvt_pk_f16_f32 v151, v140, v141
    v_mfma_f32_16x16x32_bf16 v[134:137], a[68:71], v[238:241], v[134:137]
    s_cmp_ge_u32 s18, 2
    ds_read2_b64 v[162:165], v5 offset0:6 offset1:9
    v_pk_fma_f16 v142, v151, v151, v142
    v_mfma_f32_16x16x32_bf16 v[138:141], v[186:189], a[144:147], 0
    s_cselect_b32 s14, s14, 0
    ds_read_b128 v[170:173], v5
    v_cvt_pk_f16_f32 v152, v166, v167
    v_mfma_f32_16x16x32_bf16 v[138:141], v[194:197], a[148:151], v[138:141]
    s_sub_u32 s82, s72, s71
    ds_read_b32 v254, v6 offset:192
    v_pk_fma_f16 v142, v152, v152, v142
    v_mfma_f32_16x16x32_bf16 v[138:141], v[122:125], a[152:155], v[138:141]
    s_mul_i32 s74, s82, 336
    v_cvt_pk_f16_f32 v153, v168, v169
    v_pk_fma_f16 v142, v153, v153, v142
    v_mfma_f32_16x16x32_bf16 v[138:141], v[202:205], a[156:159], v[138:141]
    s_mul_i32 s75, s82, 272
    v_cvt_pk_f16_f32 v118, v134, v135
    v_pk_fma_f16 v142, v118, v118, v142
    v_mfma_f32_16x16x32_bf16 v[138:141], v[230:233], a[160:163], v[138:141]
    s_waitcnt lgkmcnt(5)
    ds_read_b128 v[182:185], v0 offset:26624
    v_cvt_pk_f16_f32 v119, v136, v137
    v_mfma_f32_16x16x32_bf16 v[166:169], v[32:35], v[190:193], 0
    s_waitcnt lgkmcnt(5)
    v_pk_fma_f16 v142, v119, v119, v142
    v_add_u32 v5, s74, v5
    v_mfma_f32_16x16x32_bf16 v[166:169], v[32:35], v[210:213], v[166:169]
    s_waitcnt lgkmcnt(4)
    v_pk_mul_f16 v145, v146, v174
    v_pk_fma_f16 v145, v147, v175, v145
    v_mfma_f32_16x16x32_bf16 v[138:141], v[238:241], a[164:167], v[138:141]
    s_mul_i32 s76, s82, 16
    ds_read_b128 v[210:213], v1 offset:26624
    v_pk_fma_f16 v145, v148, v176, v145
    v_mfma_f32_16x16x32_bf16 v[214:217], v[186:189], a[168:171], 0
    s_waitcnt lgkmcnt(3)
    ds_read_b128 v[218:221], v0 offset:26752
    v_pk_fma_f16 v145, v149, v177, v145
    v_mfma_f32_16x16x32_bf16 v[214:217], v[194:197], a[172:175], v[214:217]
    s_waitcnt lgkmcnt(3)
    ds_read_b128 v[222:225], v1 offset:26752
    v_mov_b32_dpp v254, v23 quad_perm:[0,1,2,3] row_mask:0x7 bank_mask:0xf
    v_mfma_f32_16x16x32_bf16 v[214:217], v[122:125], a[176:179], v[214:217]
    s_add_u32 s34, s18, 2
    ds_read_b128 v[226:229], v0 offset:26880
    v_pk_fma_f16 v145, v120, v164, v145
    v_mfma_f32_16x16x32_bf16 v[214:217], v[202:205], a[180:183], v[214:217]
    s_add_u32 s8, s60, s23
    ds_read_b128 v[190:193], v1 offset:26880
    v_pk_fma_f16 v145, v121, v165, v145
    v_mfma_f32_16x16x32_bf16 v[214:217], v[230:233], a[184:187], v[214:217]
    s_waitcnt lgkmcnt(5)
    v_pk_mul_f16 v144, v150, v170
    v_pk_fma_f16 v144, v151, v171, v144
    v_mfma_f32_16x16x32_bf16 v[214:217], v[238:241], a[188:191], v[214:217]
    s_addc_u32 s9, s61, 0
    v_pk_fma_f16 v144, v152, v172, v144
    v_pk_fma_f16 v144, v153, v173, v144
    v_mfma_f32_16x16x32_bf16 v[246:249], v[186:189], a[192:195], 0
    s_sub_u32 s10, s36, s23
    v_pk_fma_f16 v144, v118, v162, v144
    v_pk_fma_f16 v144, v119, v163, v144
    v_mfma_f32_16x16x32_bf16 v[246:249], v[194:197], a[196:199], v[246:249]
    s_cmp_le_u32 s34, s45
    v_cvt_pk_bf16_f32 v134, v138, v139
    v_cvt_pk_bf16_f32 v135, v140, v141
    v_mfma_f32_16x16x32_f16 v[234:237], v[40:43], v[142:145], 0
    s_cselect_b32 s10, s10, 0
    v_cvt_pk_bf16_f32 v138, v214, v215
    v_cvt_pk_bf16_f32 v139, v216, v217
    v_mfma_f32_16x16x32_bf16 v[246:249], v[122:125], a[200:203], v[246:249]
    s_add_u32 m0, s28, 0
    v_mul_f32 v136, 0x3baaaaab, v166
    v_mul_f32 v255, 0x3baaaaab, v167
    v_mfma_f32_16x16x32_bf16 v[246:249], v[202:205], a[204:207], v[246:249]
    s_mov_b32 s27, s26
    v_rsq_f32 v234, v234
    v_mfma_f32_16x16x32_bf16 v[246:249], v[230:233], a[208:211], v[246:249]
    s_mov_b32 s26, s25
    v_rsq_f32 v235, v235
    v_mfma_f32_16x16x32_bf16 v[246:249], v[238:241], a[212:215], v[246:249]
    s_mov_b32 s25, s24
    v_mul_f32 v140, s31, v234
    v_cvt_pk_f16_f32 v141, v140, v235
    v_mfma_f32_16x16x32_bf16 v[122:125], a[72:75], v[182:185], 0
    s_waitcnt lgkmcnt(0)
    v_fma_f32 v236, v236, v140, v22
    v_fmac_f32_dpp v254, v237, v235 quad_perm:[0,1,2,3] row_mask:0x1 bank_mask:0xf
    v_mfma_f32_16x16x32_bf16 v[122:125], a[76:79], v[210:213], v[122:125]
    s_mov_b32 s24, s23
    v_cvt_pk_bf16_f32 v142, v246, v247
    v_cvt_pk_bf16_f32 v143, v248, v249
    v_mfma_f32_16x16x32_bf16 v[122:125], a[80:83], v[218:221], v[122:125]
    s_mov_b32 s71, s72
    v_pk_mul_f16 v146, v146, v141 op_sel:[0,1] op_sel_hi:[1,1]
    v_pk_mul_f16 v147, v147, v141 op_sel:[0,1] op_sel_hi:[1,1]
    v_mfma_f32_16x16x32_bf16 v[122:125], a[84:87], v[222:225], v[122:125]
    s_mov_b32 s72, s73
    v_pk_mul_f16 v148, v148, v141 op_sel:[0,1] op_sel_hi:[1,1]
    v_pk_mul_f16 v149, v149, v141 op_sel:[0,1] op_sel_hi:[1,1]
    v_mfma_f32_16x16x32_bf16 v[122:125], a[88:91], v[226:229], v[122:125]
    v_pk_mul_f16 v120, v120, v141 op_sel:[0,1] op_sel_hi:[1,1]
    v_pk_mul_f16 v121, v121, v141 op_sel:[0,1] op_sel_hi:[1,1]
    v_mfma_f32_16x16x32_bf16 v[122:125], a[92:95], v[190:193], v[122:125]
    v_pk_mul_f16 v150, v150, v141 op_sel:[0,0] op_sel_hi:[1,0]
    v_pk_mul_f16 v151, v151, v141 op_sel:[0,0] op_sel_hi:[1,0]
    v_mfma_f32_16x16x32_bf16 v[186:189], a[96:99], v[182:185], 0
    v_pk_mul_f16 v152, v152, v141 op_sel:[0,0] op_sel_hi:[1,0]
    v_pk_mul_f16 v153, v153, v141 op_sel:[0,0] op_sel_hi:[1,0]
    v_mfma_f32_16x16x32_bf16 v[186:189], a[100:103], v[210:213], v[186:189]
    v_pk_mul_f16 v118, v118, v141 op_sel:[0,0] op_sel_hi:[1,0]
    v_pk_mul_f16 v119, v119, v141 op_sel:[0,0] op_sel_hi:[1,0]
    v_mfma_f32_16x16x32_bf16 v[186:189], a[104:107], v[218:221], v[186:189]
    v_max3_u32 v44, v44, v234, v235
    v_mul_f32 v144, 0x3baaaaab, v168
    v_mfma_f32_16x16x32_bf16 v[186:189], a[108:111], v[222:225], v[186:189]
    v_rsq_f32 v136, v136
    v_mfma_f32_16x16x32_bf16 v[186:189], a[112:115], v[226:229], v[186:189]
    v_rsq_f32 v255, v255
    v_mfma_f32_16x16x32_bf16 v[186:189], a[116:119], v[190:193], v[186:189]
    v_rsq_f32 v144, v144
    v_mfma_f32_16x16x32_bf16 v[194:197], a[120:123], v[182:185], 0
    v_mul_f32 v178, v136, v178
    v_mul_f32 v179, v136, v179
    v_mfma_f32_16x16x32_bf16 v[194:197], a[124:127], v[210:213], v[194:197]
    v_cvt_pk_bf16_f32 v166, v178, v179
    v_mul_f32 v180, v136, v180
    v_mfma_f32_16x16x32_bf16 v[194:197], a[128:131], v[218:221], v[194:197]
    v_mul_f32 v181, v136, v181
    v_cvt_pk_bf16_f32 v167, v180, v181
    v_mfma_f32_16x16x32_bf16 v[194:197], a[132:135], v[222:225], v[194:197]
    v_mul_f32 v198, v136, v198
    v_mul_f32 v199, v136, v199
    v_mfma_f32_16x16x32_bf16 v[194:197], a[136:139], v[226:229], v[194:197]
    v_cvt_pk_bf16_f32 v168, v198, v199
    v_mul_f32 v200, v136, v200
    v_mfma_f32_16x16x32_bf16 v[194:197], a[140:143], v[190:193], v[194:197]
    v_mul_f32 v201, v136, v201
    v_cvt_pk_bf16_f32 v169, v200, v201
    v_mfma_f32_16x16x32_bf16 v[178:181], a[0:3], v[182:185], 0
    buffer_store_dwordx4 v[166:169], v15, s[12:15], 0 offen nt
    v_mul_f32 v206, v136, v206
    v_mul_f32 v207, v136, v207
    v_cvt_pk_bf16_f32 v140, v206, v207
    v_mul_f32 v208, v136, v208
    v_mfma_f32_16x16x32_bf16 v[178:181], a[4:7], v[210:213], v[178:181]
    v_mul_f32 v209, v136, v209
    v_cvt_pk_bf16_f32 v141, v208, v209
    v_mfma_f32_16x16x32_bf16 v[178:181], a[8:11], v[218:221], v[178:181]
    v_cvt_pk_f16_f32 v166, v122, v123
    v_pk_mul_f16 v199, v166, v166
    v_mfma_f32_16x16x32_bf16 v[178:181], a[12:15], v[222:225], v[178:181]
    v_cvt_pk_f16_f32 v167, v124, v125
    v_pk_fma_f16 v199, v167, v167, v199
    v_mfma_f32_16x16x32_bf16 v[178:181], a[16:19], v[226:229], v[178:181]
    v_cvt_pk_f16_f32 v168, v186, v187
    v_pk_fma_f16 v199, v168, v168, v199
    v_mfma_f32_16x16x32_bf16 v[178:181], a[20:23], v[190:193], v[178:181]
    v_cvt_pk_f16_f32 v169, v188, v189
    v_pk_fma_f16 v199, v169, v169, v199
    v_mfma_f32_16x16x32_bf16 v[186:189], a[24:27], v[182:185], 0
    v_cvt_pk_f16_f32 v124, v194, v195
    v_pk_fma_f16 v199, v124, v124, v199
    v_mfma_f32_16x16x32_bf16 v[186:189], a[28:31], v[210:213], v[186:189]
    v_cvt_pk_f16_f32 v125, v196, v197
    v_pk_fma_f16 v199, v125, v125, v199
    v_mfma_f32_16x16x32_bf16 v[186:189], a[32:35], v[218:221], v[186:189]
    v_cvt_pk_f16_f32 v178, v178, v179
    v_pk_mul_f16 v198, v178, v178
    v_mfma_f32_16x16x32_bf16 v[186:189], a[36:39], v[222:225], v[186:189]
    v_cvt_pk_f16_f32 v179, v180, v181
    v_pk_fma_f16 v198, v179, v179, v198
    v_mfma_f32_16x16x32_bf16 v[186:189], a[40:43], v[226:229], v[186:189]
    v_pk_mul_f16 v200, v178, v170
    v_pk_fma_f16 v200, v179, v171, v200
    v_mfma_f32_16x16x32_bf16 v[186:189], a[44:47], v[190:193], v[186:189]
    v_pk_mul_f16 v201, v166, v174
    v_pk_fma_f16 v201, v167, v175, v201
    v_mfma_f32_16x16x32_bf16 v[194:197], a[48:51], v[182:185], 0
    v_pk_fma_f16 v201, v168, v176, v201
    v_pk_fma_f16 v201, v169, v177, v201
    v_mfma_f32_16x16x32_bf16 v[194:197], a[52:55], v[210:213], v[194:197]
    v_pk_fma_f16 v201, v124, v164, v201
    v_pk_fma_f16 v201, v125, v165, v201
    v_mfma_f32_16x16x32_bf16 v[194:197], a[56:59], v[218:221], v[194:197]
    v_cvt_pk_f16_f32 v180, v186, v187
    v_pk_fma_f16 v198, v180, v180, v198
    v_mfma_f32_16x16x32_bf16 v[194:197], a[60:63], v[222:225], v[194:197]
    v_cvt_pk_f16_f32 v181, v188, v189
    v_pk_fma_f16 v198, v181, v181, v198
    v_mfma_f32_16x16x32_bf16 v[194:197], a[64:67], v[226:229], v[194:197]
    v_pk_fma_f16 v200, v180, v172, v200
    v_pk_fma_f16 v200, v181, v173, v200
    v_mfma_f32_16x16x32_bf16 v[194:197], a[68:71], v[190:193], v[194:197]
    buffer_store_dwordx2 v[140:141], v18, s[12:15], 0 offen nt
    v_mul_f32 v242, v144, v242
    v_mul_f32 v243, v144, v243
    v_mfma_f32_16x16x32_bf16 v[186:189], v[182:185], a[144:147], 0
    v_cvt_pk_bf16_f32 v238, v242, v243
    v_mul_f32 v244, v144, v244
    v_mfma_f32_16x16x32_bf16 v[186:189], v[210:213], a[148:151], v[186:189]
    v_mul_f32 v245, v144, v245
    v_cvt_pk_f16_f32 v122, v194, v195
    v_mfma_f32_16x16x32_bf16 v[186:189], v[218:221], a[152:155], v[186:189]
    v_pk_fma_f16 v198, v122, v122, v198
    v_cvt_pk_f16_f32 v123, v196, v197
    v_mfma_f32_16x16x32_bf16 v[186:189], v[222:225], a[156:159], v[186:189]
    v_pk_fma_f16 v198, v123, v123, v198
    v_pk_fma_f16 v200, v122, v162, v200
    v_mfma_f32_16x16x32_bf16 v[186:189], v[226:229], a[160:163], v[186:189]
    ds_read_b128 v[202:205], v0 offset:32768
    v_pk_fma_f16 v200, v123, v163, v200
    v_mfma_f32_16x16x32_bf16 v[186:189], v[190:193], a[164:167], v[186:189]
    ds_read_b128 v[194:197], v1 offset:32768
    v_cvt_pk_bf16_f32 v239, v244, v245
    v_mfma_f32_16x16x32_f16 v[230:233], v[40:43], v[198:201], 0
    v_mul_f32 v158, v144, v158
    v_mul_f32 v159, v144, v159
    v_mfma_f32_16x16x32_bf16 v[246:249], v[182:185], a[168:171], 0
    ds_read_b128 v[214:217], v0 offset:32896
    v_cvt_pk_bf16_f32 v240, v158, v159
    v_mfma_f32_16x16x32_bf16 v[246:249], v[210:213], a[172:175], v[246:249]
    ds_read_b128 v[206:209], v1 offset:32896
    v_cvt_pk_bf16_f32 v136, v186, v187
    v_mfma_f32_16x16x32_bf16 v[246:249], v[218:221], a[176:179], v[246:249]
    ds_read_b128 v[198:201], v0 offset:33024
    v_cvt_pk_bf16_f32 v137, v188, v189
    v_mfma_f32_16x16x32_bf16 v[246:249], v[222:225], a[180:183], v[246:249]
    ds_read_b128 v[186:189], v1 offset:33024
    v_mul_f32 v160, v144, v160
    v_mfma_f32_16x16x32_bf16 v[246:249], v[226:229], a[184:187], v[246:249]
    v_rsq_f32 v230, v230
    v_mfma_f32_16x16x32_bf16 v[246:249], v[190:193], a[188:191], v[246:249]
    s_waitcnt lgkmcnt(5)
    v_rsq_f32 v231, v231
    v_mfma_f32_16x16x32_bf16 v[242:245], v[182:185], a[192:195], 0
    s_waitcnt lgkmcnt(4)
    v_mul_f32 v234, s31, v230
    v_cvt_pk_f16_f32 v235, v234, v231
    v_mfma_f32_16x16x32_bf16 v[242:245], v[210:213], a[196:199], v[242:245]
    v_fma_f32 v232, v232, v234, v24
    v_fmac_f32_dpp v254, v233, v231 quad_perm:[0,1,2,3] row_mask:0x2 bank_mask:0xf
    v_mfma_f32_16x16x32_bf16 v[242:245], v[218:221], a[200:203], v[242:245]
    s_waitcnt lgkmcnt(3)
    v_cvt_pk_bf16_f32 v140, v246, v247
    v_cvt_pk_bf16_f32 v141, v248, v249
    v_mfma_f32_16x16x32_bf16 v[242:245], v[222:225], a[204:207], v[242:245]
    s_waitcnt lgkmcnt(2)
    v_mul_f32 v161, v144, v161
    v_cvt_pk_bf16_f32 v241, v160, v161
    v_mfma_f32_16x16x32_bf16 v[242:245], v[226:229], a[208:211], v[242:245]
    s_waitcnt lgkmcnt(1)
    buffer_store_dwordx4 v[238:241], v17, s[12:15], 0 offen nt
    v_mul_f32 v154, v144, v154
    v_mul_f32 v155, v144, v155
    v_cvt_pk_bf16_f32 v154, v154, v155
    v_mul_f32 v156, v144, v156
    v_mfma_f32_16x16x32_bf16 v[242:245], v[190:193], a[212:215], v[242:245]
    s_waitcnt lgkmcnt(0)
    v_mul_f32 v157, v144, v157
    v_cvt_pk_bf16_f32 v155, v156, v157
    v_mfma_f32_16x16x32_bf16 v[158:161], a[72:75], v[202:205], 0
    v_pk_mul_f16 v166, v166, v235 op_sel:[0,1] op_sel_hi:[1,1]
    v_pk_mul_f16 v167, v167, v235 op_sel:[0,1] op_sel_hi:[1,1]
    v_mfma_f32_16x16x32_bf16 v[158:161], a[76:79], v[194:197], v[158:161]
    v_pk_mul_f16 v168, v168, v235 op_sel:[0,1] op_sel_hi:[1,1]
    v_cvt_pk_bf16_f32 v144, v242, v243
    v_mfma_f32_16x16x32_bf16 v[158:161], a[80:83], v[214:217], v[158:161]
    v_cvt_pk_bf16_f32 v145, v244, v245
    v_pk_mul_f16 v169, v169, v235 op_sel:[0,1] op_sel_hi:[1,1]
    v_mfma_f32_16x16x32_bf16 v[158:161], a[84:87], v[206:209], v[158:161]
    v_pk_mul_f16 v124, v124, v235 op_sel:[0,1] op_sel_hi:[1,1]
    v_pk_mul_f16 v125, v125, v235 op_sel:[0,1] op_sel_hi:[1,1]
    v_mfma_f32_16x16x32_bf16 v[158:161], a[88:91], v[198:201], v[158:161]
    v_pk_mul_f16 v178, v178, v235 op_sel:[0,0] op_sel_hi:[1,0]
    v_pk_mul_f16 v179, v179, v235 op_sel:[0,0] op_sel_hi:[1,0]
    v_mfma_f32_16x16x32_bf16 v[158:161], a[92:95], v[186:189], v[158:161]
    v_pk_mul_f16 v180, v180, v235 op_sel:[0,0] op_sel_hi:[1,0]
    v_pk_mul_f16 v181, v181, v235 op_sel:[0,0] op_sel_hi:[1,0]
    v_mfma_f32_16x16x32_bf16 v[182:185], a[96:99], v[202:205], 0
    v_pk_mul_f16 v122, v122, v235 op_sel:[0,0] op_sel_hi:[1,0]
    v_pk_mul_f16 v123, v123, v235 op_sel:[0,0] op_sel_hi:[1,0]
    v_mfma_f32_16x16x32_bf16 v[182:185], a[100:103], v[194:197], v[182:185]
    v_max3_u32 v44, v44, v230, v231
    v_mul_f32 v130, v255, v130
    v_mfma_f32_16x16x32_bf16 v[182:185], a[104:107], v[214:217], v[182:185]
    v_cvt_pk_f16_f32 v158, v158, v159
    v_pk_mul_f16 v191, v158, v158
    v_mfma_f32_16x16x32_bf16 v[182:185], a[108:111], v[206:209], v[182:185]
    v_cvt_pk_f16_f32 v159, v160, v161
    v_pk_fma_f16 v191, v159, v159, v191
    v_mfma_f32_16x16x32_bf16 v[182:185], a[112:115], v[198:201], v[182:185]
    v_pk_mul_f16 v193, v158, v174
    v_pk_fma_f16 v193, v159, v175, v193
    v_mfma_f32_16x16x32_bf16 v[182:185], a[116:119], v[186:189], v[182:185]
    v_exp_f32 v232, v232
    v_mfma_f32_16x16x32_bf16 v[210:213], a[120:123], v[202:205], 0
    v_exp_f32 v236, v236
    v_mfma_f32_16x16x32_bf16 v[210:213], a[124:127], v[194:197], v[210:213]
    v_cvt_pk_bf16_f32 v39, v236, 0
    v_mul_f32 v131, v255, v131
    v_mfma_f32_16x16x32_bf16 v[210:213], a[128:131], v[214:217], v[210:213]
    s_waitcnt vmcnt(3)
    ds_write_b16 v8, v45 offset:512
    v_mfma_f32_16x16x32_bf16 v[210:213], a[132:135], v[206:209], v[210:213]
    buffer_store_dwordx2 v[154:155], v20, s[12:15], 0 offen nt
    v_cvt_pk_f16_f32 v160, v182, v183
    v_mfma_f32_16x16x32_bf16 v[210:213], a[136:139], v[198:201], v[210:213]
    v_pk_fma_f16 v191, v160, v160, v191
    v_cvt_pk_f16_f32 v161, v184, v185
    v_mfma_f32_16x16x32_bf16 v[210:213], a[140:143], v[186:189], v[210:213]
    v_pk_fma_f16 v191, v161, v161, v191
    v_pk_fma_f16 v193, v160, v176, v193
    v_mfma_f32_16x16x32_bf16 v[154:157], a[0:3], v[202:205], 0
    v_pk_fma_f16 v193, v161, v177, v193
    v_cvt_pk_bf16_f32 v130, v130, v131
    v_mfma_f32_16x16x32_bf16 v[154:157], a[4:7], v[194:197], v[154:157]
    v_mul_f32 v132, v255, v132
    v_mul_f32 v133, v255, v133
    v_mfma_f32_16x16x32_bf16 v[154:157], a[8:11], v[214:217], v[154:157]
    v_cvt_pk_f16_f32 v176, v210, v211
    v_pk_fma_f16 v191, v176, v176, v191
    v_mfma_f32_16x16x32_bf16 v[154:157], a[12:15], v[206:209], v[154:157]
    s_waitcnt lgkmcnt(0)
    v_cvt_pk_f16_f32 v177, v212, v213
    v_pk_fma_f16 v191, v177, v177, v191
    v_mfma_f32_16x16x32_bf16 v[154:157], a[16:19], v[198:201], v[154:157]
    v_pk_fma_f16 v193, v176, v164, v193
    v_mfma_f32_16x16x32_bf16 v[154:157], a[20:23], v[186:189], v[154:157]
    s_barrier
    v_pk_fma_f16 v193, v177, v165, v193
    v_mfma_f32_16x16x32_bf16 v[182:185], a[24:27], v[202:205], 0
    v_cvt_pk_bf16_f32 v131, v132, v133
    v_mfma_f32_16x16x32_bf16 v[182:185], a[28:31], v[194:197], v[182:185]
    ds_read2_b32 v[164:165], v6 offset0:0 offset1:0
    v_mfma_f32_16x16x32_bf16 v[182:185], a[32:35], v[214:217], v[182:185]
    ds_read2_b32 v[212:213], v6 offset0:16 offset1:16
    v_cvt_pk_f16_f32 v154, v154, v155
    v_mfma_f32_16x16x32_bf16 v[182:185], a[36:39], v[206:209], v[182:185]
    ds_read2_b32 v[220:221], v6 offset0:32 offset1:32
    v_pk_mul_f16 v190, v154, v154
    v_mfma_f32_16x16x32_bf16 v[182:185], a[40:43], v[198:201], v[182:185]
    ds_read_u16 v133, v9 offset:384
    v_cvt_pk_f16_f32 v155, v156, v157
    v_mfma_f32_16x16x32_bf16 v[182:185], a[44:47], v[186:189], v[182:185]
    v_pk_fma_f16 v190, v155, v155, v190
    v_pk_mul_f16 v192, v154, v170
    v_mfma_f32_16x16x32_bf16 v[222:225], a[48:51], v[202:205], 0
    v_pk_fma_f16 v192, v155, v171, v192
    v_mul_f32 v126, v255, v126
    v_mfma_f32_16x16x32_bf16 v[222:225], a[52:55], v[194:197], v[222:225]
    v_mul_f32 v127, v255, v127
    v_cvt_pk_bf16_f32 v132, v126, v127
    v_mfma_f32_16x16x32_bf16 v[222:225], a[56:59], v[214:217], v[222:225]
    buffer_load_dwordx4 v10, s[8:11], 0 offen nt lds
    v_cvt_pk_f16_f32 v156, v182, v183
    v_mfma_f32_16x16x32_bf16 v[222:225], a[60:63], v[206:209], v[222:225]
    s_add_u32 m0, s28, 4096
    v_pk_fma_f16 v190, v156, v156, v190
    v_cvt_pk_f16_f32 v157, v184, v185
    v_mfma_f32_16x16x32_bf16 v[222:225], a[64:67], v[198:201], v[222:225]
    s_waitcnt lgkmcnt(2)
    v_pk_fma_f16 v190, v157, v157, v190
    v_pk_fma_f16 v192, v156, v172, v192
    v_mfma_f32_16x16x32_bf16 v[222:225], a[68:71], v[186:189], v[222:225]
    s_waitcnt lgkmcnt(1)
    ds_read_b128 v[182:185], v2 offset:0
    v_pk_fma_f16 v192, v157, v173, v192
    v_mfma_f32_16x16x32_bf16 v[170:173], v[202:205], a[144:147], 0
    s_waitcnt lgkmcnt(1)
    ds_read_b128 v[226:229], v2 offset:1024
    v_readfirstlane_b32 s77, v133
    v_mfma_f32_16x16x32_bf16 v[170:173], v[194:197], a[148:151], v[170:173]
    ds_read_b128 v[234:237], v2 offset:2048
    buffer_load_dwordx4 v11, s[8:11], 0 offen nt lds
    v_mfma_f32_16x16x32_bf16 v[170:173], v[214:217], a[152:155], v[170:173]
    s_add_u32 m0, s28, 8192
    ds_read_b128 v[238:241], v2 offset:3072
    v_cvt_pk_f16_f32 v174, v222, v223
    v_mfma_f32_16x16x32_bf16 v[170:173], v[206:209], a[156:159], v[170:173]
    s_mul_i32 s78, s77, 2688
    ds_read_b128 v[242:245], v2 offset:4096
    v_pk_fma_f16 v190, v174, v174, v190
    v_mfma_f32_16x16x32_bf16 v[170:173], v[198:201], a[160:163], v[170:173]
    ds_read_b128 v[246:249], v2 offset:5120
    v_cvt_pk_f16_f32 v175, v224, v225
    v_mfma_f32_16x16x32_bf16 v[170:173], v[186:189], a[164:167], v[170:173]
    v_pk_fma_f16 v190, v175, v175, v190
    v_pk_fma_f16 v192, v174, v162, v192
    v_mfma_f32_16x16x32_bf16 v[222:225], v[202:205], a[168:171], 0
    buffer_load_dwordx4 v12, s[8:11], 0 offen nt lds
    v_pk_fma_f16 v192, v175, v163, v192
    v_mfma_f32_16x16x32_bf16 v[222:225], v[194:197], a[172:175], v[222:225]
    s_waitcnt lgkmcnt(5)
    v_mul_f32 v128, v255, v128
    v_cvt_pk_bf16_f32 v162, v170, v171
    v_mfma_f32_16x16x32_f16 v[250:253], v[40:43], v[190:193], 0
    s_add_u32 m0, s28, 12288
    v_cvt_pk_bf16_f32 v163, v172, v173
    v_mul_f32 v129, v255, v129
    v_mfma_f32_16x16x32_bf16 v[222:225], v[214:217], a[176:179], v[222:225]
    s_xor_b32 s28, s28, 65536
    v_cvt_pk_bf16_f32 v133, v128, v129
    v_mul_f32 v114, v255, v114
    v_mfma_f32_16x16x32_bf16 v[222:225], v[206:209], a[180:183], v[222:225]
    s_waitcnt lgkmcnt(2)
    v_rsq_f32 v250, v250
    v_mfma_f32_16x16x32_bf16 v[222:225], v[198:201], a[184:187], v[222:225]
    s_waitcnt lgkmcnt(1)
    buffer_load_dwordx4 v13, s[8:11], 0 offen nt lds
    v_mul_f32 v230, s31, v250
    v_mfma_f32_16x16x32_bf16 v[222:225], v[186:189], a[188:191], v[222:225]
    s_mov_b32 m0, s29
    v_rsq_f32 v251, v251
    v_mfma_f32_16x16x32_bf16 v[126:129], v[202:205], a[192:195], 0
    s_xor_b32 s29, s29, s30
    v_cvt_pk_f16_f32 v231, v230, v251
    v_fma_f32 v252, v252, v230, v26
    v_mfma_f32_16x16x32_bf16 v[126:129], v[194:197], a[196:199], v[126:129]
    s_add_u32 s19, s19, s20
    v_fmac_f32_dpp v254, v253, v251 quad_perm:[0,1,2,3] row_mask:0x4 bank_mask:0xf
    v_cvt_pk_bf16_f32 v210, v222, v223
    v_mfma_f32_16x16x32_bf16 v[126:129], v[214:217], a[200:203], v[126:129]
    s_add_u32 s23, s23, s21
    v_cvt_pk_bf16_f32 v211, v224, v225
    v_pk_mul_f16 v158, v158, v231 op_sel:[0,1] op_sel_hi:[1,1]
    v_mfma_f32_16x16x32_bf16 v[126:129], v[206:209], a[204:207], v[126:129]
    s_waitcnt lgkmcnt(0)
    buffer_load_dwordx4 v14, s[8:11], 0 offen nt lds
    v_pk_mul_f16 v159, v159, v231 op_sel:[0,1] op_sel_hi:[1,1]
    v_mfma_f32_16x16x32_bf16 v[126:129], v[198:201], a[208:211], v[126:129]
    s_cmp_ge_u32 s19, 72
    v_pk_mul_f16 v160, v160, v231 op_sel:[0,1] op_sel_hi:[1,1]
    v_pk_mul_f16 v161, v161, v231 op_sel:[0,1] op_sel_hi:[1,1]
    v_mfma_f32_16x16x32_bf16 v[126:129], v[186:189], a[212:215], v[126:129]
    s_cselect_b32 s34, 72, 0
    v_pk_mul_f16 v176, v176, v231 op_sel:[0,1] op_sel_hi:[1,1]
    v_pk_mul_f16 v177, v177, v231 op_sel:[0,1] op_sel_hi:[1,1]
    v_mfma_f32_16x16x32_f16 v[170:173], v[146:149], v[150:153], v[46:49]
    s_cselect_b32 s35, s22, 0
    v_pk_mul_f16 v154, v154, v231 op_sel:[0,0] op_sel_hi:[1,0]
    v_pk_mul_f16 v155, v155, v231 op_sel:[0,0] op_sel_hi:[1,0]
    v_mfma_f32_16x16x32_f16 v[186:189], v[166:169], v[150:153], v[50:53]
    s_sub_u32 s19, s19, s34
    v_cvt_pk_bf16_f32 v218, v126, v127
    v_cvt_pk_bf16_f32 v219, v128, v129
    v_mfma_f32_16x16x32_f16 v[126:129], v[158:161], v[150:153], v[54:57]
    buffer_store_dwordx4 v[130:133], v16, s[12:15], 0 offen nt
    v_pk_mul_f16 v156, v156, v231 op_sel:[0,0] op_sel_hi:[1,0]
    v_pk_mul_f16 v157, v157, v231 op_sel:[0,0] op_sel_hi:[1,0]
    v_pk_mul_f16 v174, v174, v231 op_sel:[0,0] op_sel_hi:[1,0]
    v_pk_mul_f16 v175, v175, v231 op_sel:[0,0] op_sel_hi:[1,0]
    v_mfma_f32_16x16x16_f16 v[170:173], v[120:121], v[118:119], v[170:173]
    v_max3_u32 v44, v44, v250, v251
    v_exp_f32 v254, v254
    v_mfma_f32_16x16x16_f16 v[186:189], v[124:125], v[118:119], v[186:189]
    v_cvt_pk_bf16_f32 v254, v254, v254
    v_exp_f32 v252, v252
    v_mfma_f32_16x16x16_f16 v[126:129], v[176:177], v[118:119], v[126:129]
    v_mul_f32 v115, v255, v115
    v_cvt_pk_bf16_f32 v118, v114, v115
    v_exp_f32 v170, v170
    v_mfma_f32_16x16x32_f16 v[130:133], v[146:149], v[178:181], v[58:61]
    s_add_u32 s23, s23, s35
    ds_write_b16 v8, v254
    v_mfma_f32_16x16x32_f16 v[150:153], v[166:169], v[178:181], v[62:65]
    s_add_u32 s78, s78, s69
    v_exp_f32 v171, v171
    v_mfma_f32_16x16x32_f16 v[190:193], v[158:161], v[178:181], v[66:69]
    s_add_u32 s80, s77, s68
    v_cvt_pk_bf16_f32 v170, v170, v171
    v_exp_f32 v172, v172
    v_mfma_f32_16x16x16_f16 v[130:133], v[120:121], v[122:123], v[130:133]
    v_exp_f32 v173, v173
    v_mul_f32 v116, v255, v116
    v_mfma_f32_16x16x16_f16 v[150:153], v[124:125], v[122:123], v[150:153]
    v_cvt_pk_bf16_f32 v171, v172, v173
    v_exp_f32 v186, v186
    v_mfma_f32_16x16x16_f16 v[190:193], v[176:177], v[122:123], v[190:193]
    v_exp_f32 v187, v187
    v_exp_f32 v188, v188
    v_mfma_f32_16x16x32_bf16 v[178:181], a[216:219], v[182:185], 0
    s_cmp_ge_u32 s80, 72
    v_exp_f32 v130, v130
    v_mfma_f32_16x16x32_bf16 v[178:181], a[220:223], v[226:229], v[178:181]
    s_cselect_b32 s80, s22, 0
    v_exp_f32 v131, v131
    v_mfma_f32_16x16x32_bf16 v[178:181], a[224:227], v[234:237], v[178:181]
    s_add_u32 s78, s78, s80
    v_cvt_pk_bf16_f32 v194, v130, v131
    v_cvt_pk_bf16_f32 v172, v186, v187
    v_mfma_f32_16x16x32_bf16 v[178:181], a[228:231], v[238:241], v[178:181]
    s_add_u32 s80, s77, 20
    v_exp_f32 v132, v132
    v_mfma_f32_16x16x32_bf16 v[178:181], a[232:235], v[242:245], v[178:181]
    s_add_u32 s34, s18, 3
    v_exp_f32 v133, v133
    v_mfma_f32_16x16x32_bf16 v[178:181], a[236:239], v[246:249], v[178:181]
    s_cmp_lt_u32 s77, s62
    v_cvt_pk_bf16_f32 v195, v132, v133
    v_mul_f32 v117, v255, v117
    v_mfma_f32_16x16x32_bf16 v[198:201], a[240:243], v[182:185], 0
    s_cselect_b32 s79, 1, 0
    v_exp_f32 v150, v150
    v_mfma_f32_16x16x32_f16 v[202:205], v[146:149], v[154:157], v[70:73]
    s_cselect_b32 s78, s78, 0
    v_exp_f32 v151, v151
    v_mfma_f32_16x16x32_f16 v[146:149], v[166:169], v[154:157], v[74:77]
    s_cmp_lt_u32 s34, s17
    v_cvt_pk_bf16_f32 v196, v150, v151
    v_cvt_pk_bf16_f32 v119, v116, v117
    v_mfma_f32_16x16x32_f16 v[166:169], v[158:161], v[154:157], v[78:81]
    buffer_store_dwordx2 v[118:119], v19, s[12:15], 0 offen nt
    v_exp_f32 v152, v152
    v_mfma_f32_16x16x16_f16 v[202:205], v[120:121], v[174:175], v[202:205]
    v_exp_f32 v153, v153
    v_fma_f32 v254, v178, v178, s33
    v_mfma_f32_16x16x16_f16 v[146:149], v[124:125], v[174:175], v[146:149]
    v_cvt_pk_bf16_f32 v197, v152, v153
    v_exp_f32 v190, v190
    v_mfma_f32_16x16x16_f16 v[166:169], v[176:177], v[174:175], v[166:169]
    v_exp_f32 v191, v191
    v_exp_f32 v192, v192
    v_mfma_f32_16x16x32_bf16 v[198:201], a[244:247], v[226:229], v[198:201]
    s_cselect_b32 s23, s23, s78
    v_exp_f32 v193, v193
    v_mfma_f32_16x16x32_bf16 v[198:201], a[248:251], v[234:237], v[198:201]
    s_cselect_b32 s73, s34, s80
    ds_read_b128 v[118:121], v2 offset:6144
    v_fmac_f32 v254, v179, v179
    v_mfma_f32_16x16x32_bf16 v[198:201], a[252:255], v[238:241], v[198:201]
    s_cselect_b32 s79, 0, s79
    ds_read_b128 v[122:125], v2 offset:7168
    v_fmac_f32 v254, v180, v180
    v_mfma_f32_16x16x32_bf16 v[198:201], v[82:85], v[242:245], v[198:201]
    s_cselect_b32 s81, 0, 1
    ds_read_b128 v[150:153], v2 offset:8192
    v_fmac_f32 v254, v181, v181
    v_mfma_f32_16x16x32_bf16 v[198:201], v[86:89], v[246:249], v[198:201]
    s_add_u32 s80, s77, 1
    ds_read_b128 v[154:157], v2 offset:9216
    v_xor_b32 v0, 65536, v0
    v_mfma_f32_16x16x32_bf16 v[206:209], v[90:93], v[182:185], 0
    s_mul_i32 s80, s80, s81
    ds_read_b128 v[158:161], v2 offset:10240
    v_xor_b32 v1, 65536, v1
    v_mfma_f32_16x16x32_bf16 v[206:209], v[94:97], v[226:229], v[206:209]
    s_cmp_lt_u32 s80, s62
    ds_read_b128 v[174:177], v2 offset:11264
    v_fmac_f32 v254, v198, v198
    v_mfma_f32_16x16x32_bf16 v[206:209], v[98:101], v[234:237], v[206:209]
    s_cselect_b32 s62, s62, 0
    v_exp_f32 v189, v189
    v_mfma_f32_16x16x32_bf16 v[206:209], v[102:105], v[238:241], v[206:209]
    s_add_u32 s80, s18, 4
    v_cvt_pk_bf16_f32 v173, v188, v189
    v_fmac_f32 v254, v199, v199
    v_mfma_f32_16x16x32_bf16 v[206:209], v[106:109], v[242:245], v[206:209]
    s_waitcnt lgkmcnt(5)
    v_exp_f32 v126, v126
    v_mfma_f32_16x16x32_bf16 v[206:209], v[110:113], v[246:249], v[206:209]
    s_cmp_ge_u32 s80, s17
    v_exp_f32 v127, v127
    v_mfma_f32_16x16x32_bf16 v[130:133], a[216:219], v[118:121], 0
    s_waitcnt lgkmcnt(3)
    v_cvt_pk_bf16_f32 v36, v126, v127
    v_fmac_f32 v254, v200, v200
    v_mfma_f32_16x16x32_bf16 v[130:133], a[220:223], v[122:125], v[130:133]
    s_cselect_b32 s66, s62, 0
    v_exp_f32 v128, v128
    v_mfma_f32_16x16x32_bf16 v[130:133], a[224:227], v[150:153], v[130:133]
    s_waitcnt lgkmcnt(1)
    v_fmac_f32 v254, v201, v201
    v_mfma_f32_16x16x32_bf16 v[130:133], a[228:231], v[154:157], v[130:133]
    s_lshl_b32 s80, s79, s73
    v_exp_f32 v129, v129
    v_mfma_f32_16x16x32_bf16 v[130:133], a[232:235], v[158:161], v[130:133]
    s_waitcnt lgkmcnt(0)
    v_cvt_pk_bf16_f32 v37, v128, v129
    v_fmac_f32 v254, v206, v206
    v_mfma_f32_16x16x32_bf16 v[130:133], a[236:239], v[174:177], v[130:133]
    s_or_b32 s70, s70, s80
    v_exp_f32 v202, v202
    v_mfma_f32_16x16x32_bf16 v[182:185], v[28:31], v[36:39], 0
    s_add_u32 s45, s45, s79
    v_exp_f32 v203, v203
    v_mfma_f32_16x16x32_bf16 v[182:185], v[28:31], v[170:173], v[182:185]
    s_add_u32 s18, s18, 1
    v_cvt_pk_bf16_f32 v186, v202, v203
    v_fma_f32 v255, v130, v130, s33
    v_mfma_f32_16x16x32_bf16 v[214:217], v[162:165], v[36:39], 0
    s_cmp_lt_u32 s18, s45
    v_fmac_f32 v255, v131, v131
    v_fmac_f32 v255, v132, v132
    v_mfma_f32_16x16x32_bf16 v[214:217], v[134:137], v[170:173], v[214:217]
    v_fmac_f32 v255, v133, v133
    v_fmac_f32 v254, v207, v207
    v_mfma_f32_16x16x32_bf16 v[222:225], v[210:213], v[36:39], 0
    v_exp_f32 v204, v204
    v_mfma_f32_16x16x32_bf16 v[222:225], v[138:141], v[170:173], v[222:225]
    v_exp_f32 v205, v205
    v_mfma_f32_16x16x32_bf16 v[226:229], v[218:221], v[36:39], 0
    v_cvt_pk_bf16_f32 v36, v190, v191
    v_cvt_pk_bf16_f32 v37, v192, v193
    v_mfma_f32_16x16x32_bf16 v[226:229], v[142:145], v[170:173], v[226:229]
    v_cvt_pk_bf16_f32 v39, v232, 0
    v_cvt_pk_bf16_f32 v187, v204, v205
    v_mfma_f32_16x16x32_bf16 v[126:129], a[240:243], v[118:121], 0
    v_exp_f32 v146, v146
    v_mfma_f32_16x16x32_bf16 v[170:173], v[28:31], v[36:39], 0
    v_exp_f32 v147, v147
    v_mfma_f32_16x16x32_bf16 v[170:173], v[28:31], v[194:197], v[170:173]
    v_cvt_pk_bf16_f32 v188, v146, v147
    v_fmac_f32 v254, v208, v208
    v_mfma_f32_16x16x32_bf16 v[114:117], v[162:165], v[36:39], 0
    v_exp_f32 v148, v148
    v_mfma_f32_16x16x32_bf16 v[114:117], v[134:137], v[194:197], v[114:117]
    v_exp_f32 v149, v149
    v_mfma_f32_16x16x32_bf16 v[190:193], v[210:213], v[36:39], 0
    v_cvt_pk_bf16_f32 v189, v148, v149
    v_fmac_f32 v254, v209, v209
    v_mfma_f32_16x16x32_bf16 v[190:193], v[138:141], v[194:197], v[190:193]
    v_rcp_f32 v170, v170
    v_mfma_f32_16x16x32_bf16 v[146:149], v[218:221], v[36:39], 0
    v_exp_f32 v166, v166
    v_mfma_f32_16x16x32_bf16 v[146:149], v[142:145], v[194:197], v[146:149]
    v_mul_f32 v114, v170, v114
    v_mul_f32 v115, v170, v115
    v_mfma_f32_16x16x32_bf16 v[126:129], a[244:247], v[122:125], v[126:129]
    v_cvt_pk_bf16_f32 v194, v114, v115
    v_mul_f32 v116, v170, v116
    v_mfma_f32_16x16x32_bf16 v[126:129], a[248:251], v[150:153], v[126:129]
    ds_read_b128 v[202:205], v2 offset:12288
    v_mul_f32 v117, v170, v117
    v_mfma_f32_16x16x32_bf16 v[126:129], a[252:255], v[154:157], v[126:129]
    ds_read_b128 v[230:233], v2 offset:13312
    v_cvt_pk_bf16_f32 v195, v116, v117
    v_mfma_f32_16x16x32_bf16 v[126:129], v[82:85], v[158:161], v[126:129]
    ds_read_b128 v[234:237], v2 offset:14336
    v_mul_f32 v190, v170, v190
    v_mfma_f32_16x16x32_bf16 v[126:129], v[86:89], v[174:177], v[126:129]
    ds_read_b128 v[238:241], v2 offset:15360
    v_mul_f32 v191, v170, v191
    v_mfma_f32_16x16x32_bf16 v[114:117], v[90:93], v[118:121], 0
    ds_read_b128 v[118:121], v2 offset:16384
    v_cvt_pk_bf16_f32 v196, v190, v191
    v_mfma_f32_16x16x32_bf16 v[114:117], v[94:97], v[122:125], v[114:117]
    ds_read_b128 v[122:125], v2 offset:17408
    v_mul_f32 v192, v170, v192
    v_mfma_f32_16x16x32_bf16 v[114:117], v[98:101], v[150:153], v[114:117]
    v_fmac_f32 v255, v126, v126
    v_fmac_f32 v255, v127, v127
    v_mfma_f32_16x16x32_bf16 v[114:117], v[102:105], v[154:157], v[114:117]
    v_fmac_f32 v255, v128, v128
    v_fmac_f32 v255, v129, v129
    v_mfma_f32_16x16x32_bf16 v[114:117], v[106:109], v[158:161], v[114:117]
    s_waitcnt lgkmcnt(5)
    v_mul_f32 v193, v170, v193
    v_cvt_pk_bf16_f32 v197, v192, v193
    v_mfma_f32_16x16x32_bf16 v[114:117], v[110:113], v[174:177], v[114:117]
    s_waitcnt lgkmcnt(4)
    ds_write_b128 v3, v[194:197] offset:6144
    v_mfma_f32_16x16x32_bf16 v[242:245], a[216:219], v[202:205], 0
    s_waitcnt lgkmcnt(3)
    v_mul_f32 v146, v170, v146
    v_mul_f32 v147, v170, v147
    v_mfma_f32_16x16x32_bf16 v[242:245], a[220:223], v[230:233], v[242:245]
    s_waitcnt lgkmcnt(2)
    v_fmac_f32 v255, v114, v114
    v_fmac_f32 v255, v115, v115
    v_mfma_f32_16x16x32_bf16 v[242:245], a[224:227], v[234:237], v[242:245]
    s_waitcnt lgkmcnt(1)
    v_fmac_f32 v255, v116, v116
    v_fmac_f32 v255, v117, v117
    v_mfma_f32_16x16x32_bf16 v[242:245], a[228:231], v[238:241], v[242:245]
    v_cvt_pk_bf16_f32 v254, v254, v255
    v_cvt_pk_bf16_f32 v172, v146, v147
    v_mfma_f32_16x16x32_bf16 v[242:245], a[232:235], v[118:121], v[242:245]
    v_mul_f32 v148, v170, v148
    v_mul_f32 v149, v170, v149
    v_mfma_f32_16x16x32_bf16 v[242:245], a[236:239], v[122:125], v[242:245]
    v_cvt_pk_bf16_f32 v173, v148, v149
    v_cvt_pk_bf16_f32 v39, v252, 0
    v_mfma_f32_16x16x32_bf16 v[158:161], a[240:243], v[202:205], 0
    ds_write_b64 v4, v[172:173] offset:10240
    v_mfma_f32_16x16x32_bf16 v[158:161], a[244:247], v[230:233], v[158:161]
    v_exp_f32 v167, v167
    v_mfma_f32_16x16x32_bf16 v[158:161], a[248:251], v[234:237], v[158:161]
    v_cvt_pk_bf16_f32 v36, v166, v167
    v_fma_f32 v255, v242, v242, s33
    v_mfma_f32_16x16x32_bf16 v[158:161], a[252:255], v[238:241], v[158:161]
    v_fmac_f32 v255, v243, v243
    v_fmac_f32 v255, v244, v244
    v_mfma_f32_16x16x32_bf16 v[158:161], v[82:85], v[118:121], v[158:161]
    v_fmac_f32 v255, v245, v245
    v_xor_b32 v2, 65536, v2
    v_mfma_f32_16x16x32_bf16 v[158:161], v[86:89], v[122:125], v[158:161]
    v_exp_f32 v168, v168
    v_mfma_f32_16x16x32_bf16 v[154:157], v[90:93], v[202:205], 0
    v_exp_f32 v169, v169
    v_mfma_f32_16x16x32_bf16 v[154:157], v[94:97], v[230:233], v[154:157]
    ds_read_b128 v[146:149], v9
    v_cvt_pk_bf16_f32 v37, v168, v169
    v_mfma_f32_16x16x32_bf16 v[154:157], v[98:101], v[234:237], v[154:157]
    ds_read_b128 v[150:153], v9 offset:64
    v_fmac_f32 v255, v158, v158
    v_mfma_f32_16x16x32_bf16 v[166:169], v[28:31], v[36:39], 0
    v_fmac_f32 v255, v159, v159
    v_fmac_f32 v255, v160, v160
    v_mfma_f32_16x16x32_bf16 v[166:169], v[28:31], v[186:189], v[166:169]
    v_fmac_f32 v255, v161, v161
    v_add_u32 v6, s75, v6
    v_mfma_f32_16x16x32_bf16 v[174:177], v[162:165], v[36:39], 0
    v_rcp_f32 v182, v182
    v_mfma_f32_16x16x32_bf16 v[174:177], v[134:137], v[186:189], v[174:177]
    v_max3_u32 v25, v25, v182, v183
    v_max3_u32 v25, v25, v170, v171
    v_mfma_f32_16x16x32_bf16 v[170:173], v[210:213], v[36:39], 0
    v_rcp_f32 v166, v166
    v_mfma_f32_16x16x32_bf16 v[170:173], v[138:141], v[186:189], v[170:173]
    v_max3_u32 v25, v25, v166, v167
    v_mul_f32 v214, v182, v214
    v_mfma_f32_16x16x32_bf16 v[190:193], v[218:221], v[36:39], 0
    s_waitcnt lgkmcnt(1)
    v_mul_f32 v174, v166, v174
    v_mul_f32 v175, v166, v175
    v_mfma_f32_16x16x32_bf16 v[190:193], v[142:145], v[186:189], v[190:193]
    s_waitcnt lgkmcnt(0)
    v_cvt_pk_bf16_f32 v174, v174, v175
    v_mul_f32 v176, v166, v176
    v_mfma_f32_16x16x32_bf16 v[154:157], v[102:105], v[238:241], v[154:157]
    ds_read_b128 v[186:189], v0 offset:20480
    v_mul_f32 v177, v166, v177
    v_mfma_f32_16x16x32_bf16 v[154:157], v[106:109], v[118:121], v[154:157]
    ds_read_b128 v[194:197], v1 offset:20480
    v_cvt_pk_bf16_f32 v175, v176, v177
    v_mfma_f32_16x16x32_bf16 v[154:157], v[110:113], v[122:125], v[154:157]
    ds_read_b128 v[122:125], v0 offset:20608
    v_mul_f32 v170, v166, v170
    v_mfma_f32_16x16x32_bf16 v[118:121], v[146:149], v[28:31], 0
    ds_read_b128 v[202:205], v1 offset:20608
    v_mul_f32 v171, v166, v171
    v_mfma_f32_16x16x32_bf16 v[118:121], v[150:153], v[28:31], v[118:121]
    ds_read_b128 v[230:233], v0 offset:20736
    v_cvt_pk_bf16_f32 v176, v170, v171
    v_mfma_f32_16x16x32_bf16 v[234:237], v[146:149], v[134:137], 0
    ds_read_b128 v[238:241], v1 offset:20736
    v_fmac_f32 v255, v154, v154
    v_mfma_f32_16x16x32_bf16 v[234:237], v[150:153], v[162:165], v[234:237]
    v_fmac_f32 v255, v155, v155
    v_fmac_f32 v255, v156, v156
    v_mfma_f32_16x16x32_bf16 v[134:137], v[146:149], v[138:141], 0
    v_fmac_f32 v255, v157, v157
    v_cvt_pk_bf16_f32 v255, v255, v255
    v_mfma_f32_16x16x32_bf16 v[134:137], v[150:153], v[210:213], v[134:137]
    s_waitcnt lgkmcnt(5)
    ds_write_b64 v4, v[254:255] offset:18432
    v_mfma_f32_16x16x32_bf16 v[138:141], v[146:149], v[142:145], 0
    s_waitcnt lgkmcnt(4)
    v_mul_f32 v172, v166, v172
    v_mul_f32 v173, v166, v173
    v_mfma_f32_16x16x32_bf16 v[138:141], v[150:153], v[218:221], v[138:141]
    s_waitcnt lgkmcnt(3)
    v_cvt_pk_bf16_f32 v177, v172, v173
    v_mul_f32 v190, v166, v190
    v_mfma_f32_16x16x32_bf16 v[142:145], a[72:75], v[186:189], 0
    s_waitcnt lgkmcnt(2)
    ds_write_b128 v3, v[174:177] offset:12288
    v_mfma_f32_16x16x32_bf16 v[142:145], a[76:79], v[194:197], v[142:145]
    s_waitcnt lgkmcnt(2)
    v_mul_f32 v191, v166, v191
    v_cvt_pk_bf16_f32 v120, v190, v191
    v_mfma_f32_16x16x32_bf16 v[142:145], a[80:83], v[122:125], v[142:145]
    v_mul_f32 v192, v166, v192
    v_mul_f32 v193, v166, v193
    v_mfma_f32_16x16x32_bf16 v[142:145], a[84:87], v[202:205], v[142:145]
    v_cvt_pk_bf16_f32 v121, v192, v193
    v_mul_f32 v215, v182, v215
    v_mfma_f32_16x16x32_bf16 v[142:145], a[88:91], v[230:233], v[142:145]
    ds_write_b64 v4, v[120:121] offset:16384
    v_mfma_f32_16x16x32_bf16 v[142:145], a[92:95], v[238:241], v[142:145]
    v_rcp_f32 v118, v118
    v_mfma_f32_16x16x32_bf16 v[150:153], a[96:99], v[186:189], 0
    v_max3_u32 v25, v25, v118, v119
    v_mul_f32 v234, v234, v118
    v_mfma_f32_16x16x32_bf16 v[150:153], a[100:103], v[194:197], v[150:153]
    v_cvt_pk_bf16_f32 v146, v214, v215
    v_mul_f32_dpp v234, v134, v118 quad_perm:[0,1,2,3] row_mask:0x2 bank_mask:0xf
    v_mfma_f32_16x16x32_bf16 v[150:153], a[104:107], v[122:125], v[150:153]
    v_mul_f32 v216, v182, v216
    v_mul_f32_dpp v234, v138, v118 quad_perm:[0,1,2,3] row_mask:0x4 bank_mask:0xf
    v_mfma_f32_16x16x32_bf16 v[150:153], a[108:111], v[202:205], v[150:153]
    v_cvt_pk_bf16_f32 v234, v234, v234
    v_mul_f32 v217, v182, v217
    v_mfma_f32_16x16x32_bf16 v[150:153], a[112:115], v[230:233], v[150:153]
    ds_write_b16 v7, v234
    v_mfma_f32_16x16x32_bf16 v[150:153], a[116:119], v[238:241], v[150:153]
    v_cvt_pk_bf16_f32 v147, v216, v217
    v_mul_f32 v222, v182, v222
    v_mfma_f32_16x16x32_bf16 v[134:137], a[120:123], v[186:189], 0
    v_mul_f32 v223, v182, v223
    v_cvt_pk_bf16_f32 v148, v222, v223
    v_mfma_f32_16x16x32_bf16 v[134:137], a[124:127], v[194:197], v[134:137]
    v_mul_f32 v224, v182, v224
    v_mul_f32 v225, v182, v225
    v_mfma_f32_16x16x32_bf16 v[134:137], a[128:131], v[122:125], v[134:137]
    v_cvt_pk_bf16_f32 v149, v224, v225
    v_mul_f32 v226, v182, v226
    v_mfma_f32_16x16x32_bf16 v[134:137], a[132:135], v[202:205], v[134:137]
    ds_write_b128 v3, v[146:149] offset:0
    v_mfma_f32_16x16x32_bf16 v[134:137], a[136:139], v[230:233], v[134:137]
    v_mul_f32 v227, v182, v227
    v_cvt_pk_bf16_f32 v254, v226, v227
    v_mfma_f32_16x16x32_bf16 v[134:137], a[140:143], v[238:241], v[134:137]
    v_mul_f32 v228, v182, v228
    v_mul_f32 v229, v182, v229
    v_mfma_f32_16x16x32_bf16 v[138:141], a[0:3], v[186:189], 0
    v_cvt_pk_bf16_f32 v255, v228, v229
    v_xor_b32 v3, 65536, v3
    v_mfma_f32_16x16x32_bf16 v[138:141], a[4:7], v[194:197], v[138:141]
    ds_write_b64 v4, v[254:255] offset:4096
    v_mfma_f32_16x16x32_bf16 v[138:141], a[8:11], v[122:125], v[138:141]
    v_xor_b32 v4, 65536, v4
    v_add_u32 v7, s76, v7
    v_mfma_f32_16x16x32_bf16 v[138:141], a[12:15], v[202:205], v[138:141]
    v_cvt_pk_f16_f32 v146, v142, v143
    v_pk_mul_f16 v143, v146, v146
    v_mfma_f32_16x16x32_bf16 v[138:141], a[16:19], v[230:233], v[138:141]
    v_cvt_pk_f16_f32 v147, v144, v145
    v_pk_fma_f16 v143, v147, v147, v143
    v_mfma_f32_16x16x32_bf16 v[138:141], a[20:23], v[238:241], v[138:141]
    v_cvt_pk_f16_f32 v148, v150, v151
    v_pk_fma_f16 v143, v148, v148, v143
    v_mfma_f32_16x16x32_bf16 v[166:169], a[24:27], v[186:189], 0
    v_cvt_pk_f16_f32 v149, v152, v153
    v_pk_fma_f16 v143, v149, v149, v143
    v_mfma_f32_16x16x32_bf16 v[166:169], a[28:31], v[194:197], v[166:169]
    v_cvt_pk_f16_f32 v120, v134, v135
    v_pk_fma_f16 v143, v120, v120, v143
    v_mfma_f32_16x16x32_bf16 v[166:169], a[32:35], v[122:125], v[166:169]
    s_waitcnt lgkmcnt(0)
    v_cvt_pk_f16_f32 v121, v136, v137
    v_pk_fma_f16 v143, v121, v121, v143
    v_mfma_f32_16x16x32_bf16 v[166:169], a[36:39], v[202:205], v[166:169]
    s_nop 0
    v_mfma_f32_16x16x32_bf16 v[166:169], a[40:43], v[230:233], v[166:169]
    s_barrier
    v_mfma_f32_16x16x32_bf16 v[166:169], a[44:47], v[238:241], v[166:169]
    s_nop 0
    v_mfma_f32_16x16x32_bf16 v[134:137], a[48:51], v[186:189], 0
    s_nop 0
    v_mfma_f32_16x16x32_bf16 v[134:137], a[52:55], v[194:197], v[134:137]
    s_cbranch_scc1 L_loop_fast1
    s_branch L_final_fast
.p2align 6
L_loop_fast2:
    v_mfma_f32_16x16x32_bf16 v[134:137], a[56:59], v[122:125], v[134:137]
    s_add_u32 s12, s40, s27
    ds_read_b128 v[190:193], v2 offset:18432
    v_cvt_pk_f16_f32 v150, v138, v139
    v_mfma_f32_16x16x32_bf16 v[134:137], a[60:63], v[202:205], v[134:137]
    s_addc_u32 s13, s41, 0
    ds_read_b128 v[210:213], v2 offset:19456
    v_pk_mul_f16 v142, v150, v150
    v_mfma_f32_16x16x32_bf16 v[134:137], a[64:67], v[230:233], v[134:137]
    s_sub_u32 s14, s36, s27
    ds_read_b128 v[174:177], v5 offset:32
    v_cvt_pk_f16_f32 v151, v140, v141
    v_mfma_f32_16x16x32_bf16 v[134:137], a[68:71], v[238:241], v[134:137]
    s_cmp_ge_u32 s18, 2
    ds_read2_b64 v[162:165], v5 offset0:6 offset1:9
    v_pk_fma_f16 v142, v151, v151, v142
    v_mfma_f32_16x16x32_bf16 v[138:141], v[186:189], a[144:147], 0
    s_cselect_b32 s14, s14, 0
    ds_read_b128 v[170:173], v5
    v_cvt_pk_f16_f32 v152, v166, v167
    v_mfma_f32_16x16x32_bf16 v[138:141], v[194:197], a[148:151], v[138:141]
    s_sub_u32 s82, s72, s71
    ds_read_b32 v254, v6 offset:192
    v_pk_fma_f16 v142, v152, v152, v142
    v_mfma_f32_16x16x32_bf16 v[138:141], v[122:125], a[152:155], v[138:141]
    s_mul_i32 s74, s82, 336
    v_cvt_pk_f16_f32 v153, v168, v169
    v_pk_fma_f16 v142, v153, v153, v142
    v_mfma_f32_16x16x32_bf16 v[138:141], v[202:205], a[156:159], v[138:141]
    s_mul_i32 s75, s82, 272
    v_cvt_pk_f16_f32 v118, v134, v135
    v_pk_fma_f16 v142, v118, v118, v142
    v_mfma_f32_16x16x32_bf16 v[138:141], v[230:233], a[160:163], v[138:141]
    s_waitcnt lgkmcnt(5)
    ds_read_b128 v[182:185], v0 offset:26624
    v_cvt_pk_f16_f32 v119, v136, v137
    v_mfma_f32_16x16x32_bf16 v[166:169], v[32:35], v[190:193], 0
    s_waitcnt lgkmcnt(5)
    v_pk_fma_f16 v142, v119, v119, v142
    v_add_u32 v5, s74, v5
    v_mfma_f32_16x16x32_bf16 v[166:169], v[32:35], v[210:213], v[166:169]
    s_waitcnt lgkmcnt(4)
    v_pk_mul_f16 v145, v146, v174
    v_pk_fma_f16 v145, v147, v175, v145
    v_mfma_f32_16x16x32_bf16 v[138:141], v[238:241], a[164:167], v[138:141]
    s_mul_i32 s76, s82, 16
    ds_read_b128 v[210:213], v1 offset:26624
    v_pk_fma_f16 v145, v148, v176, v145
    v_mfma_f32_16x16x32_bf16 v[214:217], v[186:189], a[168:171], 0
    s_waitcnt lgkmcnt(3)
    ds_read_b128 v[218:221], v0 offset:26752
    v_pk_fma_f16 v145, v149, v177, v145
    v_mfma_f32_16x16x32_bf16 v[214:217], v[194:197], a[172:175], v[214:217]
    s_waitcnt lgkmcnt(3)
    ds_read_b128 v[222:225], v1 offset:26752
    v_mov_b32_dpp v254, v23 quad_perm:[0,1,2,3] row_mask:0x7 bank_mask:0xf
    v_mfma_f32_16x16x32_bf16 v[214:217], v[122:125], a[176:179], v[214:217]
    s_add_u32 s34, s18, 2
    ds_read_b128 v[226:229], v0 offset:26880
    v_pk_fma_f16 v145, v120, v164, v145
    v_mfma_f32_16x16x32_bf16 v[214:217], v[202:205], a[180:183], v[214:217]
    s_add_u32 s8, s60, s23
    ds_read_b128 v[190:193], v1 offset:26880
    v_pk_fma_f16 v145, v121, v165, v145
    v_mfma_f32_16x16x32_bf16 v[214:217], v[230:233], a[184:187], v[214:217]
    s_waitcnt lgkmcnt(5)
    v_pk_mul_f16 v144, v150, v170
    v_pk_fma_f16 v144, v151, v171, v144
    v_mfma_f32_16x16x32_bf16 v[214:217], v[238:241], a[188:191], v[214:217]
    s_addc_u32 s9, s61, 0
    v_pk_fma_f16 v144, v152, v172, v144
    v_pk_fma_f16 v144, v153, v173, v144
    v_mfma_f32_16x16x32_bf16 v[246:249], v[186:189], a[192:195], 0
    s_sub_u32 s10, s36, s23
    v_pk_fma_f16 v144, v118, v162, v144
    v_pk_fma_f16 v144, v119, v163, v144
    v_mfma_f32_16x16x32_bf16 v[246:249], v[194:197], a[196:199], v[246:249]
    s_cmp_le_u32 s34, s45
    v_cvt_pk_bf16_f32 v134, v138, v139
    v_cvt_pk_bf16_f32 v135, v140, v141
    v_mfma_f32_16x16x32_f16 v[234:237], v[40:43], v[142:145], 0
    s_cselect_b32 s10, s10, 0
    v_cvt_pk_bf16_f32 v138, v214, v215
    v_cvt_pk_bf16_f32 v139, v216, v217
    v_mfma_f32_16x16x32_bf16 v[246:249], v[122:125], a[200:203], v[246:249]
    s_add_u32 m0, s28, 0
    v_mul_f32 v136, 0x3baaaaab, v166
    v_mul_f32 v255, 0x3baaaaab, v167
    v_mfma_f32_16x16x32_bf16 v[246:249], v[202:205], a[204:207], v[246:249]
    s_mov_b32 s27, s26
    v_rsq_f32 v234, v234
    v_mfma_f32_16x16x32_bf16 v[246:249], v[230:233], a[208:211], v[246:249]
    s_mov_b32 s26, s25
    v_rsq_f32 v235, v235
    v_mfma_f32_16x16x32_bf16 v[246:249], v[238:241], a[212:215], v[246:249]
    s_mov_b32 s25, s24
    v_mul_f32 v140, s31, v234
    v_cvt_pk_f16_f32 v141, v140, v235
    v_mfma_f32_16x16x32_bf16 v[122:125], a[72:75], v[182:185], 0
    s_waitcnt lgkmcnt(0)
    v_fma_f32 v236, v236, v140, v22
    v_fmac_f32_dpp v254, v237, v235 quad_perm:[0,1,2,3] row_mask:0x1 bank_mask:0xf
    v_mfma_f32_16x16x32_bf16 v[122:125], a[76:79], v[210:213], v[122:125]
    s_mov_b32 s24, s23
    v_cvt_pk_bf16_f32 v142, v246, v247
    v_cvt_pk_bf16_f32 v143, v248, v249
    v_mfma_f32_16x16x32_bf16 v[122:125], a[80:83], v[218:221], v[122:125]
    s_mov_b32 s71, s72
    v_pk_mul_f16 v146, v146, v141 op_sel:[0,1] op_sel_hi:[1,1]
    v_pk_mul_f16 v147, v147, v141 op_sel:[0,1] op_sel_hi:[1,1]
    v_mfma_f32_16x16x32_bf16 v[122:125], a[84:87], v[222:225], v[122:125]
    s_mov_b32 s72, s73
    v_pk_mul_f16 v148, v148, v141 op_sel:[0,1] op_sel_hi:[1,1]
    v_pk_mul_f16 v149, v149, v141 op_sel:[0,1] op_sel_hi:[1,1]
    v_mfma_f32_16x16x32_bf16 v[122:125], a[88:91], v[226:229], v[122:125]
    v_pk_mul_f16 v120, v120, v141 op_sel:[0,1] op_sel_hi:[1,1]
    v_pk_mul_f16 v121, v121, v141 op_sel:[0,1] op_sel_hi:[1,1]
    v_mfma_f32_16x16x32_bf16 v[122:125], a[92:95], v[190:193], v[122:125]
    v_pk_mul_f16 v150, v150, v141 op_sel:[0,0] op_sel_hi:[1,0]
    v_pk_mul_f16 v151, v151, v141 op_sel:[0,0] op_sel_hi:[1,0]
    v_mfma_f32_16x16x32_bf16 v[186:189], a[96:99], v[182:185], 0
    v_pk_mul_f16 v152, v152, v141 op_sel:[0,0] op_sel_hi:[1,0]
    v_pk_mul_f16 v153, v153, v141 op_sel:[0,0] op_sel_hi:[1,0]
    v_mfma_f32_16x16x32_bf16 v[186:189], a[100:103], v[210:213], v[186:189]
    v_pk_mul_f16 v118, v118, v141 op_sel:[0,0] op_sel_hi:[1,0]
    v_pk_mul_f16 v119, v119, v141 op_sel:[0,0] op_sel_hi:[1,0]
    v_mfma_f32_16x16x32_bf16 v[186:189], a[104:107], v[218:221], v[186:189]
    v_max3_u32 v44, v44, v234, v235
    v_mul_f32 v144, 0x3baaaaab, v168
    v_mfma_f32_16x16x32_bf16 v[186:189], a[108:111], v[222:225], v[186:189]
    v_rsq_f32 v136, v136
    v_mfma_f32_16x16x32_bf16 v[186:189], a[112:115], v[226:229], v[186:189]
    v_rsq_f32 v255, v255
    v_mfma_f32_16x16x32_bf16 v[186:189], a[116:119], v[190:193], v[186:189]
    v_rsq_f32 v144, v144
    v_mfma_f32_16x16x32_bf16 v[194:197], a[120:123], v[182:185], 0
    v_mul_f32 v178, v136, v178
    v_mul_f32 v179, v136, v179
    v_mfma_f32_16x16x32_bf16 v[194:197], a[124:127], v[210:213], v[194:197]
    v_cvt_pk_bf16_f32 v166, v178, v179
    v_mul_f32 v180, v136, v180
    v_mfma_f32_16x16x32_bf16 v[194:197], a[128:131], v[218:221], v[194:197]
    v_mul_f32 v181, v136, v181
    v_cvt_pk_bf16_f32 v167, v180, v181
    v_mfma_f32_16x16x32_bf16 v[194:197], a[132:135], v[222:225], v[194:197]
    v_mul_f32 v198, v136, v198
    v_mul_f32 v199, v136, v199
    v_mfma_f32_16x16x32_bf16 v[194:197], a[136:139], v[226:229], v[194:197]
    v_cvt_pk_bf16_f32 v168, v198, v199
    v_mul_f32 v200, v136, v200
    v_mfma_f32_16x16x32_bf16 v[194:197], a[140:143], v[190:193], v[194:197]
    v_mul_f32 v201, v136, v201
    v_cvt_pk_bf16_f32 v169, v200, v201
    v_mfma_f32_16x16x32_bf16 v[178:181], a[0:3], v[182:185], 0
    buffer_store_dwordx4 v[166:169], v15, s[12:15], 0 offen nt
    v_mul_f32 v206, v136, v206
    v_mul_f32 v207, v136, v207
    v_cvt_pk_bf16_f32 v140, v206, v207
    v_mul_f32 v208, v136, v208
    v_mfma_f32_16x16x32_bf16 v[178:181], a[4:7], v[210:213], v[178:181]
    v_mul_f32 v209, v136, v209
    v_cvt_pk_bf16_f32 v141, v208, v209
    v_mfma_f32_16x16x32_bf16 v[178:181], a[8:11], v[218:221], v[178:181]
    v_cvt_pk_f16_f32 v166, v122, v123
    v_pk_mul_f16 v199, v166, v166
    v_mfma_f32_16x16x32_bf16 v[178:181], a[12:15], v[222:225], v[178:181]
    v_cvt_pk_f16_f32 v167, v124, v125
    v_pk_fma_f16 v199, v167, v167, v199
    v_mfma_f32_16x16x32_bf16 v[178:181], a[16:19], v[226:229], v[178:181]
    v_cvt_pk_f16_f32 v168, v186, v187
    v_pk_fma_f16 v199, v168, v168, v199
    v_mfma_f32_16x16x32_bf16 v[178:181], a[20:23], v[190:193], v[178:181]
    v_cvt_pk_f16_f32 v169, v188, v189
    v_pk_fma_f16 v199, v169, v169, v199
    v_mfma_f32_16x16x32_bf16 v[186:189], a[24:27], v[182:185], 0
    v_cvt_pk_f16_f32 v124, v194, v195
    v_pk_fma_f16 v199, v124, v124, v199
    v_mfma_f32_16x16x32_bf16 v[186:189], a[28:31], v[210:213], v[186:189]
    v_cvt_pk_f16_f32 v125, v196, v197
    v_pk_fma_f16 v199, v125, v125, v199
    v_mfma_f32_16x16x32_bf16 v[186:189], a[32:35], v[218:221], v[186:189]
    v_cvt_pk_f16_f32 v178, v178, v179
    v_pk_mul_f16 v198, v178, v178
    v_mfma_f32_16x16x32_bf16 v[186:189], a[36:39], v[222:225], v[186:189]
    v_cvt_pk_f16_f32 v179, v180, v181
    v_pk_fma_f16 v198, v179, v179, v198
    v_mfma_f32_16x16x32_bf16 v[186:189], a[40:43], v[226:229], v[186:189]
    v_pk_mul_f16 v200, v178, v170
    v_pk_fma_f16 v200, v179, v171, v200
    v_mfma_f32_16x16x32_bf16 v[186:189], a[44:47], v[190:193], v[186:189]
    v_pk_mul_f16 v201, v166, v174
    v_pk_fma_f16 v201, v167, v175, v201
    v_mfma_f32_16x16x32_bf16 v[194:197], a[48:51], v[182:185], 0
    v_pk_fma_f16 v201, v168, v176, v201
    v_pk_fma_f16 v201, v169, v177, v201
    v_mfma_f32_16x16x32_bf16 v[194:197], a[52:55], v[210:213], v[194:197]
    v_pk_fma_f16 v201, v124, v164, v201
    v_pk_fma_f16 v201, v125, v165, v201
    v_mfma_f32_16x16x32_bf16 v[194:197], a[56:59], v[218:221], v[194:197]
    v_cvt_pk_f16_f32 v180, v186, v187
    v_pk_fma_f16 v198, v180, v180, v198
    v_mfma_f32_16x16x32_bf16 v[194:197], a[60:63], v[222:225], v[194:197]
    v_cvt_pk_f16_f32 v181, v188, v189
    v_pk_fma_f16 v198, v181, v181, v198
    v_mfma_f32_16x16x32_bf16 v[194:197], a[64:67], v[226:229], v[194:197]
    v_pk_fma_f16 v200, v180, v172, v200
    v_pk_fma_f16 v200, v181, v173, v200
    v_mfma_f32_16x16x32_bf16 v[194:197], a[68:71], v[190:193], v[194:197]
    buffer_store_dwordx2 v[140:141], v18, s[12:15], 0 offen nt
    v_mul_f32 v242, v144, v242
    v_mul_f32 v243, v144, v243
    v_mfma_f32_16x16x32_bf16 v[186:189], v[182:185], a[144:147], 0
    v_cvt_pk_bf16_f32 v238, v242, v243
    v_mul_f32 v244, v144, v244
    v_mfma_f32_16x16x32_bf16 v[186:189], v[210:213], a[148:151], v[186:189]
    v_mul_f32 v245, v144, v245
    v_cvt_pk_f16_f32 v122, v194, v195
    v_mfma_f32_16x16x32_bf16 v[186:189], v[218:221], a[152:155], v[186:189]
    v_pk_fma_f16 v198, v122, v122, v198
    v_cvt_pk_f16_f32 v123, v196, v197
    v_mfma_f32_16x16x32_bf16 v[186:189], v[222:225], a[156:159], v[186:189]
    v_pk_fma_f16 v198, v123, v123, v198
    v_pk_fma_f16 v200, v122, v162, v200
    v_mfma_f32_16x16x32_bf16 v[186:189], v[226:229], a[160:163], v[186:189]
    ds_read_b128 v[202:205], v0 offset:32768
    v_pk_fma_f16 v200, v123, v163, v200
    v_mfma_f32_16x16x32_bf16 v[186:189], v[190:193], a[164:167], v[186:189]
    ds_read_b128 v[194:197], v1 offset:32768
    v_cvt_pk_bf16_f32 v239, v244, v245
    v_mfma_f32_16x16x32_f16 v[230:233], v[40:43], v[198:201], 0
    v_mul_f32 v158, v144, v158
    v_mul_f32 v159, v144, v159
    v_mfma_f32_16x16x32_bf16 v[246:249], v[182:185], a[168:171], 0
    ds_read_b128 v[214:217], v0 offset:32896
    v_cvt_pk_bf16_f32 v240, v158, v159
    v_mfma_f32_16x16x32_bf16 v[246:249], v[210:213], a[172:175], v[246:249]
    ds_read_b128 v[206:209], v1 offset:32896
    v_cvt_pk_bf16_f32 v136, v186, v187
    v_mfma_f32_16x16x32_bf16 v[246:249], v[218:221], a[176:179], v[246:249]
    ds_read_b128 v[198:201], v0 offset:33024
    v_cvt_pk_bf16_f32 v137, v188, v189
    v_mfma_f32_16x16x32_bf16 v[246:249], v[222:225], a[180:183], v[246:249]
    ds_read_b128 v[186:189], v1 offset:33024
    v_mul_f32 v160, v144, v160
    v_mfma_f32_16x16x32_bf16 v[246:249], v[226:229], a[184:187], v[246:249]
    v_rsq_f32 v230, v230
    v_mfma_f32_16x16x32_bf16 v[246:249], v[190:193], a[188:191], v[246:249]
    s_waitcnt lgkmcnt(5)
    v_rsq_f32 v231, v231
    v_mfma_f32_16x16x32_bf16 v[242:245], v[182:185], a[192:195], 0
    s_waitcnt lgkmcnt(4)
    v_mul_f32 v234, s31, v230
    v_cvt_pk_f16_f32 v235, v234, v231
    v_mfma_f32_16x16x32_bf16 v[242:245], v[210:213], a[196:199], v[242:245]
    v_fma_f32 v232, v232, v234, v24
    v_fmac_f32_dpp v254, v233, v231 quad_perm:[0,1,2,3] row_mask:0x2 bank_mask:0xf
    v_mfma_f32_16x16x32_bf16 v[242:245], v[218:221], a[200:203], v[242:245]
    s_waitcnt lgkmcnt(3)
    v_cvt_pk_bf16_f32 v140, v246, v247
    v_cvt_pk_bf16_f32 v141, v248, v249
    v_mfma_f32_16x16x32_bf16 v[242:245], v[222:225], a[204:207], v[242:245]
    s_waitcnt lgkmcnt(2)
    v_mul_f32 v161, v144, v161
    v_cvt_pk_bf16_f32 v241, v160, v161
    v_mfma_f32_16x16x32_bf16 v[242:245], v[226:229], a[208:211], v[242:245]
    s_waitcnt lgkmcnt(1)
    buffer_store_dwordx4 v[238:241], v17, s[12:15], 0 offen nt
    v_mul_f32 v154, v144, v154
    v_mul_f32 v155, v144, v155
    v_cvt_pk_bf16_f32 v154, v154, v155
    v_mul_f32 v156, v144, v156
    v_mfma_f32_16x16x32_bf16 v[242:245], v[190:193], a[212:215], v[242:245]
    s_waitcnt lgkmcnt(0)
    v_mul_f32 v157, v144, v157
    v_cvt_pk_bf16_f32 v155, v156, v157
    v_mfma_f32_16x16x32_bf16 v[158:161], a[72:75], v[202:205], 0
    v_pk_mul_f16 v166, v166, v235 op_sel:[0,1] op_sel_hi:[1,1]
    v_pk_mul_f16 v167, v167, v235 op_sel:[0,1] op_sel_hi:[1,1]
    v_mfma_f32_16x16x32_bf16 v[158:161], a[76:79], v[194:197], v[158:161]
    v_pk_mul_f16 v168, v168, v235 op_sel:[0,1] op_sel_hi:[1,1]
    v_cvt_pk_bf16_f32 v144, v242, v243
    v_mfma_f32_16x16x32_bf16 v[158:161], a[80:83], v[214:217], v[158:161]
    v_cvt_pk_bf16_f32 v145, v244, v245
    v_pk_mul_f16 v169, v169, v235 op_sel:[0,1] op_sel_hi:[1,1]
    v_mfma_f32_16x16x32_bf16 v[158:161], a[84:87], v[206:209], v[158:161]
    v_pk_mul_f16 v124, v124, v235 op_sel:[0,1] op_sel_hi:[1,1]
    v_pk_mul_f16 v125, v125, v235 op_sel:[0,1] op_sel_hi:[1,1]
    v_mfma_f32_16x16x32_bf16 v[158:161], a[88:91], v[198:201], v[158:161]
    v_pk_mul_f16 v178, v178, v235 op_sel:[0,0] op_sel_hi:[1,0]
    v_pk_mul_f16 v179, v179, v235 op_sel:[0,0] op_sel_hi:[1,0]
    v_mfma_f32_16x16x32_bf16 v[158:161], a[92:95], v[186:189], v[158:161]
    v_pk_mul_f16 v180, v180, v235 op_sel:[0,0] op_sel_hi:[1,0]
    v_pk_mul_f16 v181, v181, v235 op_sel:[0,0] op_sel_hi:[1,0]
    v_mfma_f32_16x16x32_bf16 v[182:185], a[96:99], v[202:205], 0
    v_pk_mul_f16 v122, v122, v235 op_sel:[0,0] op_sel_hi:[1,0]
    v_pk_mul_f16 v123, v123, v235 op_sel:[0,0] op_sel_hi:[1,0]
    v_mfma_f32_16x16x32_bf16 v[182:185], a[100:103], v[194:197], v[182:185]
    v_max3_u32 v44, v44, v230, v231
    v_mul_f32 v130, v255, v130
    v_mfma_f32_16x16x32_bf16 v[182:185], a[104:107], v[214:217], v[182:185]
    v_cvt_pk_f16_f32 v158, v158, v159
    v_pk_mul_f16 v191, v158, v158
    v_mfma_f32_16x16x32_bf16 v[182:185], a[108:111], v[206:209], v[182:185]
    v_cvt_pk_f16_f32 v159, v160, v161
    v_pk_fma_f16 v191, v159, v159, v191
    v_mfma_f32_16x16x32_bf16 v[182:185], a[112:115], v[198:201], v[182:185]
    v_pk_mul_f16 v193, v158, v174
    v_pk_fma_f16 v193, v159, v175, v193
    v_mfma_f32_16x16x32_bf16 v[182:185], a[116:119], v[186:189], v[182:185]
    v_exp_f32 v232, v232
    v_mfma_f32_16x16x32_bf16 v[210:213], a[120:123], v[202:205], 0
    v_exp_f32 v236, v236
    v_mfma_f32_16x16x32_bf16 v[210:213], a[124:127], v[194:197], v[210:213]
    v_cvt_pk_bf16_f32 v39, v236, 0
    v_mul_f32 v131, v255, v131
    v_mfma_f32_16x16x32_bf16 v[210:213], a[128:131], v[214:217], v[210:213]
    s_waitcnt vmcnt(3)
    ds_write_b16 v8, v45 offset:512
    v_mfma_f32_16x16x32_bf16 v[210:213], a[132:135], v[206:209], v[210:213]
    buffer_store_dwordx2 v[154:155], v20, s[12:15], 0 offen nt
    v_cvt_pk_f16_f32 v160, v182, v183
    v_mfma_f32_16x16x32_bf16 v[210:213], a[136:139], v[198:201], v[210:213]
    v_pk_fma_f16 v191, v160, v160, v191
    v_cvt_pk_f16_f32 v161, v184, v185
    v_mfma_f32_16x16x32_bf16 v[210:213], a[140:143], v[186:189], v[210:213]
    v_pk_fma_f16 v191, v161, v161, v191
    v_pk_fma_f16 v193, v160, v176, v193
    v_mfma_f32_16x16x32_bf16 v[154:157], a[0:3], v[202:205], 0
    v_pk_fma_f16 v193, v161, v177, v193
    v_cvt_pk_bf16_f32 v130, v130, v131
    v_mfma_f32_16x16x32_bf16 v[154:157], a[4:7], v[194:197], v[154:157]
    v_mul_f32 v132, v255, v132
    v_mul_f32 v133, v255, v133
    v_mfma_f32_16x16x32_bf16 v[154:157], a[8:11], v[214:217], v[154:157]
    v_cvt_pk_f16_f32 v176, v210, v211
    v_pk_fma_f16 v191, v176, v176, v191
    v_mfma_f32_16x16x32_bf16 v[154:157], a[12:15], v[206:209], v[154:157]
    s_waitcnt lgkmcnt(0)
    v_cvt_pk_f16_f32 v177, v212, v213
    v_pk_fma_f16 v191, v177, v177, v191
    v_mfma_f32_16x16x32_bf16 v[154:157], a[16:19], v[198:201], v[154:157]
    v_pk_fma_f16 v193, v176, v164, v193
    v_mfma_f32_16x16x32_bf16 v[154:157], a[20:23], v[186:189], v[154:157]
    v_pk_fma_f16 v193, v177, v165, v193
    v_mfma_f32_16x16x32_bf16 v[182:185], a[24:27], v[202:205], 0
    s_barrier
    v_cvt_pk_bf16_f32 v131, v132, v133
    v_mfma_f32_16x16x32_bf16 v[182:185], a[28:31], v[194:197], v[182:185]
    ds_read2_b32 v[164:165], v6 offset0:0 offset1:0
    v_mfma_f32_16x16x32_bf16 v[182:185], a[32:35], v[214:217], v[182:185]
    ds_read2_b32 v[212:213], v6 offset0:16 offset1:16
    v_cvt_pk_f16_f32 v154, v154, v155
    v_mfma_f32_16x16x32_bf16 v[182:185], a[36:39], v[206:209], v[182:185]
    ds_read2_b32 v[220:221], v6 offset0:32 offset1:32
    v_pk_mul_f16 v190, v154, v154
    v_mfma_f32_16x16x32_bf16 v[182:185], a[40:43], v[198:201], v[182:185]
    ds_read_u16 v133, v9 offset:256
    v_cvt_pk_f16_f32 v155, v156, v157
    v_mfma_f32_16x16x32_bf16 v[182:185], a[44:47], v[186:189], v[182:185]
    v_pk_fma_f16 v190, v155, v155, v190
    v_pk_mul_f16 v192, v154, v170
    v_mfma_f32_16x16x32_bf16 v[222:225], a[48:51], v[202:205], 0
    v_pk_fma_f16 v192, v155, v171, v192
    v_mul_f32 v126, v255, v126
    v_mfma_f32_16x16x32_bf16 v[222:225], a[52:55], v[194:197], v[222:225]
    v_mul_f32 v127, v255, v127
    v_cvt_pk_bf16_f32 v132, v126, v127
    v_mfma_f32_16x16x32_bf16 v[222:225], a[56:59], v[214:217], v[222:225]
    buffer_load_dwordx4 v10, s[8:11], 0 offen nt lds
    v_cvt_pk_f16_f32 v156, v182, v183
    v_mfma_f32_16x16x32_bf16 v[222:225], a[60:63], v[206:209], v[222:225]
    s_add_u32 m0, s28, 4096
    v_pk_fma_f16 v190, v156, v156, v190
    v_cvt_pk_f16_f32 v157, v184, v185
    v_mfma_f32_16x16x32_bf16 v[222:225], a[64:67], v[198:201], v[222:225]
    s_waitcnt lgkmcnt(2)
    v_pk_fma_f16 v190, v157, v157, v190
    v_pk_fma_f16 v192, v156, v172, v192
    v_mfma_f32_16x16x32_bf16 v[222:225], a[68:71], v[186:189], v[222:225]
    s_waitcnt lgkmcnt(1)
    ds_read_b128 v[182:185], v2 offset:0
    v_pk_fma_f16 v192, v157, v173, v192
    v_mfma_f32_16x16x32_bf16 v[170:173], v[202:205], a[144:147], 0
    s_waitcnt lgkmcnt(1)
    ds_read_b128 v[226:229], v2 offset:1024
    v_readfirstlane_b32 s77, v133
    v_mfma_f32_16x16x32_bf16 v[170:173], v[194:197], a[148:151], v[170:173]
    ds_read_b128 v[234:237], v2 offset:2048
    buffer_load_dwordx4 v11, s[8:11], 0 offen nt lds
    v_mfma_f32_16x16x32_bf16 v[170:173], v[214:217], a[152:155], v[170:173]
    s_add_u32 m0, s28, 8192
    ds_read_b128 v[238:241], v2 offset:3072
    v_cvt_pk_f16_f32 v174, v222, v223
    v_mfma_f32_16x16x32_bf16 v[170:173], v[206:209], a[156:159], v[170:173]
    s_mul_i32 s78, s77, 2688
    ds_read_b128 v[242:245], v2 offset:4096
    v_pk_fma_f16 v190, v174, v174, v190
    v_mfma_f32_16x16x32_bf16 v[170:173], v[198:201], a[160:163], v[170:173]
    ds_read_b128 v[246:249], v2 offset:5120
    v_cvt_pk_f16_f32 v175, v224, v225
    v_mfma_f32_16x16x32_bf16 v[170:173], v[186:189], a[164:167], v[170:173]
    v_pk_fma_f16 v190, v175, v175, v190
    v_pk_fma_f16 v192, v174, v162, v192
    v_mfma_f32_16x16x32_bf16 v[222:225], v[202:205], a[168:171], 0
    buffer_load_dwordx4 v12, s[8:11], 0 offen nt lds
    v_pk_fma_f16 v192, v175, v163, v192
    v_mfma_f32_16x16x32_bf16 v[222:225], v[194:197], a[172:175], v[222:225]
    s_waitcnt lgkmcnt(5)
    v_mul_f32 v128, v255, v128
    v_cvt_pk_bf16_f32 v162, v170, v171
    v_mfma_f32_16x16x32_f16 v[250:253], v[40:43], v[190:193], 0
    s_add_u32 m0, s28, 12288
    v_cvt_pk_bf16_f32 v163, v172, v173
    v_mul_f32 v129, v255, v129
    v_mfma_f32_16x16x32_bf16 v[222:225], v[214:217], a[176:179], v[222:225]
    s_xor_b32 s28, s28, 65536
    v_cvt_pk_bf16_f32 v133, v128, v129
    v_mul_f32 v114, v255, v114
    v_mfma_f32_16x16x32_bf16 v[222:225], v[206:209], a[180:183], v[222:225]
    s_waitcnt lgkmcnt(2)
    v_rsq_f32 v250, v250
    v_mfma_f32_16x16x32_bf16 v[222:225], v[198:201], a[184:187], v[222:225]
    s_waitcnt lgkmcnt(1)
    buffer_load_dwordx4 v13, s[8:11], 0 offen nt lds
    v_mul_f32 v230, s31, v250
    v_mfma_f32_16x16x32_bf16 v[222:225], v[186:189], a[188:191], v[222:225]
    s_mov_b32 m0, s29
    v_rsq_f32 v251, v251
    v_mfma_f32_16x16x32_bf16 v[126:129], v[202:205], a[192:195], 0
    s_xor_b32 s29, s29, s30
    v_cvt_pk_f16_f32 v231, v230, v251
    v_fma_f32 v252, v252, v230, v26
    v_mfma_f32_16x16x32_bf16 v[126:129], v[194:197], a[196:199], v[126:129]
    s_add_u32 s19, s19, s20
    v_fmac_f32_dpp v254, v253, v251 quad_perm:[0,1,2,3] row_mask:0x4 bank_mask:0xf
    v_cvt_pk_bf16_f32 v210, v222, v223
    v_mfma_f32_16x16x32_bf16 v[126:129], v[214:217], a[200:203], v[126:129]
    s_add_u32 s23, s23, s21
    v_cvt_pk_bf16_f32 v211, v224, v225
    v_pk_mul_f16 v158, v158, v231 op_sel:[0,1] op_sel_hi:[1,1]
    v_mfma_f32_16x16x32_bf16 v[126:129], v[206:209], a[204:207], v[126:129]
    s_waitcnt lgkmcnt(0)
    v_pk_mul_f16 v159, v159, v231 op_sel:[0,1] op_sel_hi:[1,1]
    v_mfma_f32_16x16x32_bf16 v[126:129], v[198:201], a[208:211], v[126:129]
    s_cmp_ge_u32 s19, 72
    v_pk_mul_f16 v160, v160, v231 op_sel:[0,1] op_sel_hi:[1,1]
    v_pk_mul_f16 v161, v161, v231 op_sel:[0,1] op_sel_hi:[1,1]
    v_mfma_f32_16x16x32_bf16 v[126:129], v[186:189], a[212:215], v[126:129]
    s_cselect_b32 s34, 72, 0
    v_pk_mul_f16 v176, v176, v231 op_sel:[0,1] op_sel_hi:[1,1]
    v_pk_mul_f16 v177, v177, v231 op_sel:[0,1] op_sel_hi:[1,1]
    v_mfma_f32_16x16x32_f16 v[170:173], v[146:149], v[150:153], v[46:49]
    s_cselect_b32 s35, s22, 0
    v_pk_mul_f16 v154, v154, v231 op_sel:[0,0] op_sel_hi:[1,0]
    v_pk_mul_f16 v155, v155, v231 op_sel:[0,0] op_sel_hi:[1,0]
    v_mfma_f32_16x16x32_f16 v[186:189], v[166:169], v[150:153], v[50:53]
    s_sub_u32 s19, s19, s34
    v_cvt_pk_bf16_f32 v218, v126, v127
    v_cvt_pk_bf16_f32 v219, v128, v129
    v_mfma_f32_16x16x32_f16 v[126:129], v[158:161], v[150:153], v[54:57]
    buffer_store_dwordx4 v[130:133], v16, s[12:15], 0 offen nt
    v_pk_mul_f16 v156, v156, v231 op_sel:[0,0] op_sel_hi:[1,0]
    v_pk_mul_f16 v157, v157, v231 op_sel:[0,0] op_sel_hi:[1,0]
    v_pk_mul_f16 v174, v174, v231 op_sel:[0,0] op_sel_hi:[1,0]
    v_pk_mul_f16 v175, v175, v231 op_sel:[0,0] op_sel_hi:[1,0]
    v_mfma_f32_16x16x16_f16 v[170:173], v[120:121], v[118:119], v[170:173]
    v_max3_u32 v44, v44, v250, v251
    v_exp_f32 v254, v254
    v_mfma_f32_16x16x16_f16 v[186:189], v[124:125], v[118:119], v[186:189]
    v_cvt_pk_bf16_f32 v254, v254, v254
    v_exp_f32 v252, v252
    v_mfma_f32_16x16x16_f16 v[126:129], v[176:177], v[118:119], v[126:129]
    v_mul_f32 v115, v255, v115
    v_cvt_pk_bf16_f32 v118, v114, v115
    v_exp_f32 v170, v170
    v_mfma_f32_16x16x32_f16 v[130:133], v[146:149], v[178:181], v[58:61]
    s_add_u32 s23, s23, s35
    ds_write_b16 v8, v254
    v_mfma_f32_16x16x32_f16 v[150:153], v[166:169], v[178:181], v[62:65]
    s_add_u32 s78, s78, s69
    v_exp_f32 v171, v171
    v_mfma_f32_16x16x32_f16 v[190:193], v[158:161], v[178:181], v[66:69]
    s_add_u32 s80, s77, s68
    v_cvt_pk_bf16_f32 v170, v170, v171
    v_exp_f32 v172, v172
    v_mfma_f32_16x16x16_f16 v[130:133], v[120:121], v[122:123], v[130:133]
    v_exp_f32 v173, v173
    v_mul_f32 v116, v255, v116
    v_mfma_f32_16x16x16_f16 v[150:153], v[124:125], v[122:123], v[150:153]
    v_cvt_pk_bf16_f32 v171, v172, v173
    v_exp_f32 v186, v186
    v_mfma_f32_16x16x16_f16 v[190:193], v[176:177], v[122:123], v[190:193]
    v_exp_f32 v187, v187
    v_exp_f32 v188, v188
    v_mfma_f32_16x16x32_bf16 v[178:181], a[216:219], v[182:185], 0
    s_cmp_ge_u32 s80, 72
    v_exp_f32 v130, v130
    v_mfma_f32_16x16x32_bf16 v[178:181], a[220:223], v[226:229], v[178:181]
    s_cselect_b32 s80, s22, 0
    v_exp_f32 v131, v131
    v_mfma_f32_16x16x32_bf16 v[178:181], a[224:227], v[234:237], v[178:181]
    s_add_u32 s78, s78, s80
    v_cvt_pk_bf16_f32 v194, v130, v131
    v_cvt_pk_bf16_f32 v172, v186, v187
    v_mfma_f32_16x16x32_bf16 v[178:181], a[228:231], v[238:241], v[178:181]
    s_add_u32 s80, s77, 20
    v_exp_f32 v132, v132
    v_mfma_f32_16x16x32_bf16 v[178:181], a[232:235], v[242:245], v[178:181]
    s_add_u32 s34, s18, 3
    v_exp_f32 v133, v133
    v_mfma_f32_16x16x32_bf16 v[178:181], a[236:239], v[246:249], v[178:181]
    s_cmp_lt_u32 s77, s62
    v_cvt_pk_bf16_f32 v195, v132, v133
    v_mul_f32 v117, v255, v117
    v_mfma_f32_16x16x32_bf16 v[198:201], a[240:243], v[182:185], 0
    s_cselect_b32 s79, 1, 0
    v_exp_f32 v150, v150
    v_mfma_f32_16x16x32_f16 v[202:205], v[146:149], v[154:157], v[70:73]
    s_cselect_b32 s78, s78, 0
    v_exp_f32 v151, v151
    v_mfma_f32_16x16x32_f16 v[146:149], v[166:169], v[154:157], v[74:77]
    s_cmp_lt_u32 s34, s17
    v_cvt_pk_bf16_f32 v196, v150, v151
    v_cvt_pk_bf16_f32 v119, v116, v117
    v_mfma_f32_16x16x32_f16 v[166:169], v[158:161], v[154:157], v[78:81]
    buffer_store_dwordx2 v[118:119], v19, s[12:15], 0 offen nt
    v_exp_f32 v152, v152
    v_mfma_f32_16x16x16_f16 v[202:205], v[120:121], v[174:175], v[202:205]
    v_exp_f32 v153, v153
    v_fma_f32 v254, v178, v178, s33
    v_mfma_f32_16x16x16_f16 v[146:149], v[124:125], v[174:175], v[146:149]
    v_cvt_pk_bf16_f32 v197, v152, v153
    v_exp_f32 v190, v190
    v_mfma_f32_16x16x16_f16 v[166:169], v[176:177], v[174:175], v[166:169]
    v_exp_f32 v191, v191
    v_exp_f32 v192, v192
    v_mfma_f32_16x16x32_bf16 v[198:201], a[244:247], v[226:229], v[198:201]
    s_cselect_b32 s23, s23, s78
    v_exp_f32 v193, v193
    v_mfma_f32_16x16x32_bf16 v[198:201], a[248:251], v[234:237], v[198:201]
    s_cselect_b32 s73, s34, s80
    ds_read_b128 v[118:121], v2 offset:6144
    v_fmac_f32 v254, v179, v179
    v_mfma_f32_16x16x32_bf16 v[198:201], a[252:255], v[238:241], v[198:201]
    s_cselect_b32 s79, 0, s79
    ds_read_b128 v[122:125], v2 offset:7168
    v_fmac_f32 v254, v180, v180
    v_mfma_f32_16x16x32_bf16 v[198:201], v[82:85], v[242:245], v[198:201]
    s_cselect_b32 s81, 0, 1
    ds_read_b128 v[150:153], v2 offset:8192
    v_fmac_f32 v254, v181, v181
    v_mfma_f32_16x16x32_bf16 v[198:201], v[86:89], v[246:249], v[198:201]
    s_add_u32 s80, s77, 1
    ds_read_b128 v[154:157], v2 offset:9216
    v_xor_b32 v0, 65536, v0
    v_mfma_f32_16x16x32_bf16 v[206:209], v[90:93], v[182:185], 0
    s_mul_i32 s80, s80, s81
    ds_read_b128 v[158:161], v2 offset:10240
    v_xor_b32 v1, 65536, v1
    v_mfma_f32_16x16x32_bf16 v[206:209], v[94:97], v[226:229], v[206:209]
    s_cmp_lt_u32 s80, s62
    ds_read_b128 v[174:177], v2 offset:11264
    v_fmac_f32 v254, v198, v198
    v_mfma_f32_16x16x32_bf16 v[206:209], v[98:101], v[234:237], v[206:209]
    s_cselect_b32 s62, s62, 0
    v_exp_f32 v189, v189
    v_mfma_f32_16x16x32_bf16 v[206:209], v[102:105], v[238:241], v[206:209]
    s_add_u32 s80, s18, 4
    v_cvt_pk_bf16_f32 v173, v188, v189
    v_fmac_f32 v254, v199, v199
    v_mfma_f32_16x16x32_bf16 v[206:209], v[106:109], v[242:245], v[206:209]
    s_waitcnt lgkmcnt(5)
    v_exp_f32 v126, v126
    v_mfma_f32_16x16x32_bf16 v[206:209], v[110:113], v[246:249], v[206:209]
    s_cmp_ge_u32 s80, s17
    v_exp_f32 v127, v127
    v_mfma_f32_16x16x32_bf16 v[130:133], a[216:219], v[118:121], 0
    s_waitcnt lgkmcnt(3)
    v_cvt_pk_bf16_f32 v36, v126, v127
    v_fmac_f32 v254, v200, v200
    v_mfma_f32_16x16x32_bf16 v[130:133], a[220:223], v[122:125], v[130:133]
    s_cselect_b32 s66, s62, 0
    v_exp_f32 v128, v128
    v_mfma_f32_16x16x32_bf16 v[130:133], a[224:227], v[150:153], v[130:133]
    s_waitcnt lgkmcnt(1)
    v_fmac_f32 v254, v201, v201
    v_mfma_f32_16x16x32_bf16 v[130:133], a[228:231], v[154:157], v[130:133]
    s_lshl_b32 s80, s79, s73
    v_exp_f32 v129, v129
    v_mfma_f32_16x16x32_bf16 v[130:133], a[232:235], v[158:161], v[130:133]
    s_waitcnt lgkmcnt(0)
    v_cvt_pk_bf16_f32 v37, v128, v129
    v_fmac_f32 v254, v206, v206
    v_mfma_f32_16x16x32_bf16 v[130:133], a[236:239], v[174:177], v[130:133]
    s_or_b32 s70, s70, s80
    v_exp_f32 v202, v202
    v_mfma_f32_16x16x32_bf16 v[182:185], v[28:31], v[36:39], 0
    s_add_u32 s45, s45, s79
    v_exp_f32 v203, v203
    v_mfma_f32_16x16x32_bf16 v[182:185], v[28:31], v[170:173], v[182:185]
    s_add_u32 s18, s18, 1
    v_cvt_pk_bf16_f32 v186, v202, v203
    v_fma_f32 v255, v130, v130, s33
    v_mfma_f32_16x16x32_bf16 v[214:217], v[162:165], v[36:39], 0
    s_cmp_lt_u32 s18, s45
    v_fmac_f32 v255, v131, v131
    v_fmac_f32 v255, v132, v132
    v_mfma_f32_16x16x32_bf16 v[214:217], v[134:137], v[170:173], v[214:217]
    v_fmac_f32 v255, v133, v133
    v_fmac_f32 v254, v207, v207
    v_mfma_f32_16x16x32_bf16 v[222:225], v[210:213], v[36:39], 0
    v_exp_f32 v204, v204
    v_mfma_f32_16x16x32_bf16 v[222:225], v[138:141], v[170:173], v[222:225]
    v_exp_f32 v205, v205
    v_mfma_f32_16x16x32_bf16 v[226:229], v[218:221], v[36:39], 0
    v_cvt_pk_bf16_f32 v36, v190, v191
    v_cvt_pk_bf16_f32 v37, v192, v193
    v_mfma_f32_16x16x32_bf16 v[226:229], v[142:145], v[170:173], v[226:229]
    v_cvt_pk_bf16_f32 v39, v232, 0
    v_cvt_pk_bf16_f32 v187, v204, v205
    v_mfma_f32_16x16x32_bf16 v[126:129], a[240:243], v[118:121], 0
    v_exp_f32 v146, v146
    v_mfma_f32_16x16x32_bf16 v[170:173], v[28:31], v[36:39], 0
    v_exp_f32 v147, v147
    v_mfma_f32_16x16x32_bf16 v[170:173], v[28:31], v[194:197], v[170:173]
    v_cvt_pk_bf16_f32 v188, v146, v147
    v_fmac_f32 v254, v208, v208
    v_mfma_f32_16x16x32_bf16 v[114:117], v[162:165], v[36:39], 0
    v_exp_f32 v148, v148
    v_mfma_f32_16x16x32_bf16 v[114:117], v[134:137], v[194:197], v[114:117]
    v_exp_f32 v149, v149
    v_mfma_f32_16x16x32_bf16 v[190:193], v[210:213], v[36:39], 0
    v_cvt_pk_bf16_f32 v189, v148, v149
    v_fmac_f32 v254, v209, v209
    v_mfma_f32_16x16x32_bf16 v[190:193], v[138:141], v[194:197], v[190:193]
    v_rcp_f32 v170, v170
    v_mfma_f32_16x16x32_bf16 v[146:149], v[218:221], v[36:39], 0
    v_exp_f32 v166, v166
    v_mfma_f32_16x16x32_bf16 v[146:149], v[142:145], v[194:197], v[146:149]
    v_mul_f32 v114, v170, v114
    v_mul_f32 v115, v170, v115
    v_mfma_f32_16x16x32_bf16 v[126:129], a[244:247], v[122:125], v[126:129]
    v_cvt_pk_bf16_f32 v194, v114, v115
    v_mul_f32 v116, v170, v116
    v_mfma_f32_16x16x32_bf16 v[126:129], a[248:251], v[150:153], v[126:129]
    ds_read_b128 v[202:205], v2 offset:12288
    v_mul_f32 v117, v170, v117
    v_mfma_f32_16x16x32_bf16 v[126:129], a[252:255], v[154:157], v[126:129]
    ds_read_b128 v[230:233], v2 offset:13312
    v_cvt_pk_bf16_f32 v195, v116, v117
    v_mfma_f32_16x16x32_bf16 v[126:129], v[82:85], v[158:161], v[126:129]
    ds_read_b128 v[234:237], v2 offset:14336
    v_mul_f32 v190, v170, v190
    v_mfma_f32_16x16x32_bf16 v[126:129], v[86:89], v[174:177], v[126:129]
    ds_read_b128 v[238:241], v2 offset:15360
    v_mul_f32 v191, v170, v191
    v_mfma_f32_16x16x32_bf16 v[114:117], v[90:93], v[118:121], 0
    ds_read_b128 v[118:121], v2 offset:16384
    v_cvt_pk_bf16_f32 v196, v190, v191
    v_mfma_f32_16x16x32_bf16 v[114:117], v[94:97], v[122:125], v[114:117]
    ds_read_b128 v[122:125], v2 offset:17408
    v_mul_f32 v192, v170, v192
    v_mfma_f32_16x16x32_bf16 v[114:117], v[98:101], v[150:153], v[114:117]
    v_fmac_f32 v255, v126, v126
    v_fmac_f32 v255, v127, v127
    v_mfma_f32_16x16x32_bf16 v[114:117], v[102:105], v[154:157], v[114:117]
    v_fmac_f32 v255, v128, v128
    v_fmac_f32 v255, v129, v129
    v_mfma_f32_16x16x32_bf16 v[114:117], v[106:109], v[158:161], v[114:117]
    s_waitcnt lgkmcnt(5)
    v_mul_f32 v193, v170, v193
    v_cvt_pk_bf16_f32 v197, v192, v193
    v_mfma_f32_16x16x32_bf16 v[114:117], v[110:113], v[174:177], v[114:117]
    s_waitcnt lgkmcnt(4)
    ds_write_b128 v3, v[194:197] offset:6144
    v_mfma_f32_16x16x32_bf16 v[242:245], a[216:219], v[202:205], 0
    s_waitcnt lgkmcnt(3)
    v_mul_f32 v146, v170, v146
    v_mul_f32 v147, v170, v147
    v_mfma_f32_16x16x32_bf16 v[242:245], a[220:223], v[230:233], v[242:245]
    s_waitcnt lgkmcnt(2)
    v_fmac_f32 v255, v114, v114
    v_fmac_f32 v255, v115, v115
    v_mfma_f32_16x16x32_bf16 v[242:245], a[224:227], v[234:237], v[242:245]
    s_waitcnt lgkmcnt(1)
    v_fmac_f32 v255, v116, v116
    v_fmac_f32 v255, v117, v117
    v_mfma_f32_16x16x32_bf16 v[242:245], a[228:231], v[238:241], v[242:245]
    v_cvt_pk_bf16_f32 v254, v254, v255
    v_cvt_pk_bf16_f32 v172, v146, v147
    v_mfma_f32_16x16x32_bf16 v[242:245], a[232:235], v[118:121], v[242:245]
    v_mul_f32 v148, v170, v148
    v_mul_f32 v149, v170, v149
    v_mfma_f32_16x16x32_bf16 v[242:245], a[236:239], v[122:125], v[242:245]
    v_cvt_pk_bf16_f32 v173, v148, v149
    v_cvt_pk_bf16_f32 v39, v252, 0
    v_mfma_f32_16x16x32_bf16 v[158:161], a[240:243], v[202:205], 0
    ds_write_b64 v4, v[172:173] offset:10240
    v_mfma_f32_16x16x32_bf16 v[158:161], a[244:247], v[230:233], v[158:161]
    v_exp_f32 v167, v167
    v_mfma_f32_16x16x32_bf16 v[158:161], a[248:251], v[234:237], v[158:161]
    v_cvt_pk_bf16_f32 v36, v166, v167
    v_fma_f32 v255, v242, v242, s33
    v_mfma_f32_16x16x32_bf16 v[158:161], a[252:255], v[238:241], v[158:161]
    v_fmac_f32 v255, v243, v243
    v_fmac_f32 v255, v244, v244
    v_mfma_f32_16x16x32_bf16 v[158:161], v[82:85], v[118:121], v[158:161]
    v_fmac_f32 v255, v245, v245
    v_xor_b32 v2, 65536, v2
    v_mfma_f32_16x16x32_bf16 v[158:161], v[86:89], v[122:125], v[158:161]
    v_exp_f32 v168, v168
    v_mfma_f32_16x16x32_bf16 v[154:157], v[90:93], v[202:205], 0
    v_exp_f32 v169, v169
    v_mfma_f32_16x16x32_bf16 v[154:157], v[94:97], v[230:233], v[154:157]
    ds_read_b128 v[146:149], v9
    v_cvt_pk_bf16_f32 v37, v168, v169
    v_mfma_f32_16x16x32_bf16 v[154:157], v[98:101], v[234:237], v[154:157]
    ds_read_b128 v[150:153], v9 offset:64
    v_fmac_f32 v255, v158, v158
    v_mfma_f32_16x16x32_bf16 v[166:169], v[28:31], v[36:39], 0
    v_fmac_f32 v255, v159, v159
    v_fmac_f32 v255, v160, v160
    v_mfma_f32_16x16x32_bf16 v[166:169], v[28:31], v[186:189], v[166:169]
    v_fmac_f32 v255, v161, v161
    v_add_u32 v6, s75, v6
    v_mfma_f32_16x16x32_bf16 v[174:177], v[162:165], v[36:39], 0
    v_rcp_f32 v182, v182
    v_mfma_f32_16x16x32_bf16 v[174:177], v[134:137], v[186:189], v[174:177]
    v_max3_u32 v25, v25, v182, v183
    v_max3_u32 v25, v25, v170, v171
    v_mfma_f32_16x16x32_bf16 v[170:173], v[210:213], v[36:39], 0
    v_rcp_f32 v166, v166
    v_mfma_f32_16x16x32_bf16 v[170:173], v[138:141], v[186:189], v[170:173]
    v_max3_u32 v25, v25, v166, v167
    v_mul_f32 v214, v182, v214
    v_mfma_f32_16x16x32_bf16 v[190:193], v[218:221], v[36:39], 0
    s_waitcnt lgkmcnt(1)
    v_mul_f32 v174, v166, v174
    v_mul_f32 v175, v166, v175
    v_mfma_f32_16x16x32_bf16 v[190:193], v[142:145], v[186:189], v[190:193]
    s_waitcnt lgkmcnt(0)
    v_cvt_pk_bf16_f32 v174, v174, v175
    v_mul_f32 v176, v166, v176
    v_mfma_f32_16x16x32_bf16 v[154:157], v[102:105], v[238:241], v[154:157]
    ds_read_b128 v[186:189], v0 offset:20480
    v_mul_f32 v177, v166, v177
    v_mfma_f32_16x16x32_bf16 v[154:157], v[106:109], v[118:121], v[154:157]
    ds_read_b128 v[194:197], v1 offset:20480
    v_cvt_pk_bf16_f32 v175, v176, v177
    v_mfma_f32_16x16x32_bf16 v[154:157], v[110:113], v[122:125], v[154:157]
    ds_read_b128 v[122:125], v0 offset:20608
    v_mul_f32 v170, v166, v170
    v_mfma_f32_16x16x32_bf16 v[118:121], v[146:149], v[28:31], 0
    ds_read_b128 v[202:205], v1 offset:20608
    v_mul_f32 v171, v166, v171
    v_mfma_f32_16x16x32_bf16 v[118:121], v[150:153], v[28:31], v[118:121]
    ds_read_b128 v[230:233], v0 offset:20736
    v_cvt_pk_bf16_f32 v176, v170, v171
    v_mfma_f32_16x16x32_bf16 v[234:237], v[146:149], v[134:137], 0
    ds_read_b128 v[238:241], v1 offset:20736
    v_fmac_f32 v255, v154, v154
    v_mfma_f32_16x16x32_bf16 v[234:237], v[150:153], v[162:165], v[234:237]
    v_fmac_f32 v255, v155, v155
    v_fmac_f32 v255, v156, v156
    v_mfma_f32_16x16x32_bf16 v[134:137], v[146:149], v[138:141], 0
    v_fmac_f32 v255, v157, v157
    v_cvt_pk_bf16_f32 v255, v255, v255
    v_mfma_f32_16x16x32_bf16 v[134:137], v[150:153], v[210:213], v[134:137]
    s_waitcnt lgkmcnt(5)
    ds_write_b64 v4, v[254:255] offset:18432
    v_mfma_f32_16x16x32_bf16 v[138:141], v[146:149], v[142:145], 0
    s_waitcnt lgkmcnt(4)
    v_mul_f32 v172, v166, v172
    v_mul_f32 v173, v166, v173
    v_mfma_f32_16x16x32_bf16 v[138:141], v[150:153], v[218:221], v[138:141]
    s_waitcnt lgkmcnt(3)
    v_cvt_pk_bf16_f32 v177, v172, v173
    v_mul_f32 v190, v166, v190
    v_mfma_f32_16x16x32_bf16 v[142:145], a[72:75], v[186:189], 0
    s_waitcnt lgkmcnt(2)
    ds_write_b128 v3, v[174:177] offset:12288
    v_mfma_f32_16x16x32_bf16 v[142:145], a[76:79], v[194:197], v[142:145]
    s_waitcnt lgkmcnt(2)
    v_mul_f32 v191, v166, v191
    v_cvt_pk_bf16_f32 v120, v190, v191
    v_mfma_f32_16x16x32_bf16 v[142:145], a[80:83], v[122:125], v[142:145]
    v_mul_f32 v192, v166, v192
    v_mul_f32 v193, v166, v193
    v_mfma_f32_16x16x32_bf16 v[142:145], a[84:87], v[202:205], v[142:145]
    v_cvt_pk_bf16_f32 v121, v192, v193
    v_mul_f32 v215, v182, v215
    v_mfma_f32_16x16x32_bf16 v[142:145], a[88:91], v[230:233], v[142:145]
    ds_write_b64 v4, v[120:121] offset:16384
    v_mfma_f32_16x16x32_bf16 v[142:145], a[92:95], v[238:241], v[142:145]
    v_rcp_f32 v118, v118
    v_mfma_f32_16x16x32_bf16 v[150:153], a[96:99], v[186:189], 0
    v_max3_u32 v25, v25, v118, v119
    v_mul_f32 v234, v234, v118
    v_mfma_f32_16x16x32_bf16 v[150:153], a[100:103], v[194:197], v[150:153]
    v_cvt_pk_bf16_f32 v146, v214, v215
    v_mul_f32_dpp v234, v134, v118 quad_perm:[0,1,2,3] row_mask:0x2 bank_mask:0xf
    v_mfma_f32_16x16x32_bf16 v[150:153], a[104:107], v[122:125], v[150:153]
    v_mul_f32 v216, v182, v216
    v_mul_f32_dpp v234, v138, v118 quad_perm:[0,1,2,3] row_mask:0x4 bank_mask:0xf
    v_mfma_f32_16x16x32_bf16 v[150:153], a[108:111], v[202:205], v[150:153]
    v_cvt_pk_bf16_f32 v234, v234, v234
    v_mul_f32 v217, v182, v217
    v_mfma_f32_16x16x32_bf16 v[150:153], a[112:115], v[230:233], v[150:153]
    ds_write_b16 v7, v234
    v_mfma_f32_16x16x32_bf16 v[150:153], a[116:119], v[238:241], v[150:153]
    v_cvt_pk_bf16_f32 v147, v216, v217
    v_mul_f32 v222, v182, v222
    v_mfma_f32_16x16x32_bf16 v[134:137], a[120:123], v[186:189], 0
    v_mul_f32 v223, v182, v223
    v_cvt_pk_bf16_f32 v148, v222, v223
    v_mfma_f32_16x16x32_bf16 v[134:137], a[124:127], v[194:197], v[134:137]
    v_mul_f32 v224, v182, v224
    v_mul_f32 v225, v182, v225
    v_mfma_f32_16x16x32_bf16 v[134:137], a[128:131], v[122:125], v[134:137]
    v_cvt_pk_bf16_f32 v149, v224, v225
    v_mul_f32 v226, v182, v226
    v_mfma_f32_16x16x32_bf16 v[134:137], a[132:135], v[202:205], v[134:137]
    ds_write_b128 v3, v[146:149] offset:0
    v_mfma_f32_16x16x32_bf16 v[134:137], a[136:139], v[230:233], v[134:137]
    v_mul_f32 v227, v182, v227
    v_cvt_pk_bf16_f32 v254, v226, v227
    v_mfma_f32_16x16x32_bf16 v[134:137], a[140:143], v[238:241], v[134:137]
    v_mul_f32 v228, v182, v228
    v_mul_f32 v229, v182, v229
    v_mfma_f32_16x16x32_bf16 v[138:141], a[0:3], v[186:189], 0
    v_cvt_pk_bf16_f32 v255, v228, v229
    v_xor_b32 v3, 65536, v3
    v_mfma_f32_16x16x32_bf16 v[138:141], a[4:7], v[194:197], v[138:141]
    ds_write_b64 v4, v[254:255] offset:4096
    v_mfma_f32_16x16x32_bf16 v[138:141], a[8:11], v[122:125], v[138:141]
    v_xor_b32 v4, 65536, v4
    v_add_u32 v7, s76, v7
    v_mfma_f32_16x16x32_bf16 v[138:141], a[12:15], v[202:205], v[138:141]
    v_cvt_pk_f16_f32 v146, v142, v143
    v_pk_mul_f16 v143, v146, v146
    v_mfma_f32_16x16x32_bf16 v[138:141], a[16:19], v[230:233], v[138:141]
    v_cvt_pk_f16_f32 v147, v144, v145
    v_pk_fma_f16 v143, v147, v147, v143
    v_mfma_f32_16x16x32_bf16 v[138:141], a[20:23], v[238:241], v[138:141]
    v_cvt_pk_f16_f32 v148, v150, v151
    v_pk_fma_f16 v143, v148, v148, v143
    v_mfma_f32_16x16x32_bf16 v[166:169], a[24:27], v[186:189], 0
    v_cvt_pk_f16_f32 v149, v152, v153
    v_pk_fma_f16 v143, v149, v149, v143
    v_mfma_f32_16x16x32_bf16 v[166:169], a[28:31], v[194:197], v[166:169]
    v_cvt_pk_f16_f32 v120, v134, v135
    v_pk_fma_f16 v143, v120, v120, v143
    v_mfma_f32_16x16x32_bf16 v[166:169], a[32:35], v[122:125], v[166:169]
    s_waitcnt lgkmcnt(0)
    v_cvt_pk_f16_f32 v121, v136, v137
    v_pk_fma_f16 v143, v121, v121, v143
    v_mfma_f32_16x16x32_bf16 v[166:169], a[36:39], v[202:205], v[166:169]
    s_nop 0
    v_mfma_f32_16x16x32_bf16 v[166:169], a[40:43], v[230:233], v[166:169]
    s_nop 0
    v_mfma_f32_16x16x32_bf16 v[166:169], a[44:47], v[238:241], v[166:169]
    s_barrier
    v_mfma_f32_16x16x32_bf16 v[134:137], a[48:51], v[186:189], 0
    s_nop 0
    v_mfma_f32_16x16x32_bf16 v[134:137], a[52:55], v[194:197], v[134:137]
    s_cbranch_scc1 L_loop_fast2
    s_branch L_final_fast
.p2align 6
L_loop_fast3:
    v_mfma_f32_16x16x32_bf16 v[134:137], a[56:59], v[122:125], v[134:137]
    s_add_u32 s12, s40, s27
    ds_read_b128 v[190:193], v2 offset:18432
    v_cvt_pk_f16_f32 v150, v138, v139
    v_mfma_f32_16x16x32_bf16 v[134:137], a[60:63], v[202:205], v[134:137]
    s_addc_u32 s13, s41, 0
    ds_read_b128 v[210:213], v2 offset:19456
    v_pk_mul_f16 v142, v150, v150
    v_mfma_f32_16x16x32_bf16 v[134:137], a[64:67], v[230:233], v[134:137]
    s_sub_u32 s14, s36, s27
    ds_read_b128 v[174:177], v5 offset:32
    v_cvt_pk_f16_f32 v151, v140, v141
    v_mfma_f32_16x16x32_bf16 v[134:137], a[68:71], v[238:241], v[134:137]
    s_cmp_ge_u32 s18, 2
    ds_read2_b64 v[162:165], v5 offset0:6 offset1:9
    v_pk_fma_f16 v142, v151, v151, v142
    v_mfma_f32_16x16x32_bf16 v[138:141], v[186:189], a[144:147], 0
    s_cselect_b32 s14, s14, 0
    ds_read_b128 v[170:173], v5
    v_cvt_pk_f16_f32 v152, v166, v167
    v_mfma_f32_16x16x32_bf16 v[138:141], v[194:197], a[148:151], v[138:141]
    s_sub_u32 s82, s72, s71
    ds_read_b32 v254, v6 offset:192
    v_pk_fma_f16 v142, v152, v152, v142
    v_mfma_f32_16x16x32_bf16 v[138:141], v[122:125], a[152:155], v[138:141]
    s_mul_i32 s74, s82, 336
    v_cvt_pk_f16_f32 v153, v168, v169
    v_pk_fma_f16 v142, v153, v153, v142
    v_mfma_f32_16x16x32_bf16 v[138:141], v[202:205], a[156:159], v[138:141]
    s_mul_i32 s75, s82, 272
    v_cvt_pk_f16_f32 v118, v134, v135
    v_pk_fma_f16 v142, v118, v118, v142
    v_mfma_f32_16x16x32_bf16 v[138:141], v[230:233], a[160:163], v[138:141]
    s_waitcnt lgkmcnt(5)
    ds_read_b128 v[182:185], v0 offset:26624
    v_cvt_pk_f16_f32 v119, v136, v137
    v_mfma_f32_16x16x32_bf16 v[166:169], v[32:35], v[190:193], 0
    s_waitcnt lgkmcnt(5)
    v_pk_fma_f16 v142, v119, v119, v142
    v_add_u32 v5, s74, v5
    v_mfma_f32_16x16x32_bf16 v[166:169], v[32:35], v[210:213], v[166:169]
    s_waitcnt lgkmcnt(4)
    v_pk_mul_f16 v145, v146, v174
    v_pk_fma_f16 v145, v147, v175, v145
    v_mfma_f32_16x16x32_bf16 v[138:141], v[238:241], a[164:167], v[138:141]
    s_mul_i32 s76, s82, 16
    ds_read_b128 v[210:213], v1 offset:26624
    v_pk_fma_f16 v145, v148, v176, v145
    v_mfma_f32_16x16x32_bf16 v[214:217], v[186:189], a[168:171], 0
    s_waitcnt lgkmcnt(3)
    ds_read_b128 v[218:221], v0 offset:26752
    v_pk_fma_f16 v145, v149, v177, v145
    v_mfma_f32_16x16x32_bf16 v[214:217], v[194:197], a[172:175], v[214:217]
    s_waitcnt lgkmcnt(3)
    ds_read_b128 v[222:225], v1 offset:26752
    v_mov_b32_dpp v254, v23 quad_perm:[0,1,2,3] row_mask:0x7 bank_mask:0xf
    v_mfma_f32_16x16x32_bf16 v[214:217], v[122:125], a[176:179], v[214:217]
    s_add_u32 s34, s18, 2
    ds_read_b128 v[226:229], v0 offset:26880
    v_pk_fma_f16 v145, v120, v164, v145
    v_mfma_f32_16x16x32_bf16 v[214:217], v[202:205], a[180:183], v[214:217]
    s_add_u32 s8, s60, s23
    ds_read_b128 v[190:193], v1 offset:26880
    v_pk_fma_f16 v145, v121, v165, v145
    v_mfma_f32_16x16x32_bf16 v[214:217], v[230:233], a[184:187], v[214:217]
    s_waitcnt lgkmcnt(5)
    v_pk_mul_f16 v144, v150, v170
    v_pk_fma_f16 v144, v151, v171, v144
    v_mfma_f32_16x16x32_bf16 v[214:217], v[238:241], a[188:191], v[214:217]
    s_addc_u32 s9, s61, 0
    v_pk_fma_f16 v144, v152, v172, v144
    v_pk_fma_f16 v144, v153, v173, v144
    v_mfma_f32_16x16x32_bf16 v[246:249], v[186:189], a[192:195], 0
    s_sub_u32 s10, s36, s23
    v_pk_fma_f16 v144, v118, v162, v144
    v_pk_fma_f16 v144, v119, v163, v144
    v_mfma_f32_16x16x32_bf16 v[246:249], v[194:197], a[196:199], v[246:249]
    s_cmp_le_u32 s34, s45
    v_cvt_pk_bf16_f32 v134, v138, v139
    v_cvt_pk_bf16_f32 v135, v140, v141
    v_mfma_f32_16x16x32_f16 v[234:237], v[40:43], v[142:145], 0
    s_cselect_b32 s10, s10, 0
    v_cvt_pk_bf16_f32 v138, v214, v215
    v_cvt_pk_bf16_f32 v139, v216, v217
    v_mfma_f32_16x16x32_bf16 v[246:249], v[122:125], a[200:203], v[246:249]
    s_add_u32 m0, s28, 0
    v_mul_f32 v136, 0x3baaaaab, v166
    v_mul_f32 v255, 0x3baaaaab, v167
    v_mfma_f32_16x16x32_bf16 v[246:249], v[202:205], a[204:207], v[246:249]
    s_mov_b32 s27, s26
    v_rsq_f32 v234, v234
    v_mfma_f32_16x16x32_bf16 v[246:249], v[230:233], a[208:211], v[246:249]
    s_mov_b32 s26, s25
    v_rsq_f32 v235, v235
    v_mfma_f32_16x16x32_bf16 v[246:249], v[238:241], a[212:215], v[246:249]
    s_mov_b32 s25, s24
    v_mul_f32 v140, s31, v234
    v_cvt_pk_f16_f32 v141, v140, v235
    v_mfma_f32_16x16x32_bf16 v[122:125], a[72:75], v[182:185], 0
    s_waitcnt lgkmcnt(0)
    v_fma_f32 v236, v236, v140, v22
    v_fmac_f32_dpp v254, v237, v235 quad_perm:[0,1,2,3] row_mask:0x1 bank_mask:0xf
    v_mfma_f32_16x16x32_bf16 v[122:125], a[76:79], v[210:213], v[122:125]
    s_mov_b32 s24, s23
    v_cvt_pk_bf16_f32 v142, v246, v247
    v_cvt_pk_bf16_f32 v143, v248, v249
    v_mfma_f32_16x16x32_bf16 v[122:125], a[80:83], v[218:221], v[122:125]
    s_mov_b32 s71, s72
    v_pk_mul_f16 v146, v146, v141 op_sel:[0,1] op_sel_hi:[1,1]
    v_pk_mul_f16 v147, v147, v141 op_sel:[0,1] op_sel_hi:[1,1]
    v_mfma_f32_16x16x32_bf16 v[122:125], a[84:87], v[222:225], v[122:125]
    s_mov_b32 s72, s73
    v_pk_mul_f16 v148, v148, v141 op_sel:[0,1] op_sel_hi:[1,1]
    v_pk_mul_f16 v149, v149, v141 op_sel:[0,1] op_sel_hi:[1,1]
    v_mfma_f32_16x16x32_bf16 v[122:125], a[88:91], v[226:229], v[122:125]
    v_pk_mul_f16 v120, v120, v141 op_sel:[0,1] op_sel_hi:[1,1]
    v_pk_mul_f16 v121, v121, v141 op_sel:[0,1] op_sel_hi:[1,1]
    v_mfma_f32_16x16x32_bf16 v[122:125], a[92:95], v[190:193], v[122:125]
    v_pk_mul_f16 v150, v150, v141 op_sel:[0,0] op_sel_hi:[1,0]
    v_pk_mul_f16 v151, v151, v141 op_sel:[0,0] op_sel_hi:[1,0]
    v_mfma_f32_16x16x32_bf16 v[186:189], a[96:99], v[182:185], 0
    v_pk_mul_f16 v152, v152, v141 op_sel:[0,0] op_sel_hi:[1,0]
    v_pk_mul_f16 v153, v153, v141 op_sel:[0,0] op_sel_hi:[1,0]
    v_mfma_f32_16x16x32_bf16 v[186:189], a[100:103], v[210:213], v[186:189]
    v_pk_mul_f16 v118, v118, v141 op_sel:[0,0] op_sel_hi:[1,0]
    v_pk_mul_f16 v119, v119, v141 op_sel:[0,0] op_sel_hi:[1,0]
    v_mfma_f32_16x16x32_bf16 v[186:189], a[104:107], v[218:221], v[186:189]
    v_max3_u32 v44, v44, v234, v235
    v_mul_f32 v144, 0x3baaaaab, v168
    v_mfma_f32_16x16x32_bf16 v[186:189], a[108:111], v[222:225], v[186:189]
    v_rsq_f32 v136, v136
    v_mfma_f32_16x16x32_bf16 v[186:189], a[112:115], v[226:229], v[186:189]
    v_rsq_f32 v255, v255
    v_mfma_f32_16x16x32_bf16 v[186:189], a[116:119], v[190:193], v[186:189]
    v_rsq_f32 v144, v144
    v_mfma_f32_16x16x32_bf16 v[194:197], a[120:123], v[182:185], 0
    v_mul_f32 v178, v136, v178
    v_mul_f32 v179, v136, v179
    v_mfma_f32_16x16x32_bf16 v[194:197], a[124:127], v[210:213], v[194:197]
    v_cvt_pk_bf16_f32 v166, v178, v179
    v_mul_f32 v180, v136, v180
    v_mfma_f32_16x16x32_bf16 v[194:197], a[128:131], v[218:221], v[194:197]
    v_mul_f32 v181, v136, v181
    v_cvt_pk_bf16_f32 v167, v180, v181
    v_mfma_f32_16x16x32_bf16 v[194:197], a[132:135], v[222:225], v[194:197]
    v_mul_f32 v198, v136, v198
    v_mul_f32 v199, v136, v199
    v_mfma_f32_16x16x32_bf16 v[194:197], a[136:139], v[226:229], v[194:197]
    v_cvt_pk_bf16_f32 v168, v198, v199
    v_mul_f32 v200, v136, v200
    v_mfma_f32_16x16x32_bf16 v[194:197], a[140:143], v[190:193], v[194:197]
    v_mul_f32 v201, v136, v201
    v_cvt_pk_bf16_f32 v169, v200, v201
    v_mfma_f32_16x16x32_bf16 v[178:181], a[0:3], v[182:185], 0
    buffer_store_dwordx4 v[166:169], v15, s[12:15], 0 offen nt
    v_mul_f32 v206, v136, v206
    v_mul_f32 v207, v136, v207
    v_cvt_pk_bf16_f32 v140, v206, v207
    v_mul_f32 v208, v136, v208
    v_mfma_f32_16x16x32_bf16 v[178:181], a[4:7], v[210:213], v[178:181]
    v_mul_f32 v209, v136, v209
    v_cvt_pk_bf16_f32 v141, v208, v209
    v_mfma_f32_16x16x32_bf16 v[178:181], a[8:11], v[218:221], v[178:181]
    v_cvt_pk_f16_f32 v166, v122, v123
    v_pk_mul_f16 v199, v166, v166
    v_mfma_f32_16x16x32_bf16 v[178:181], a[12:15], v[222:225], v[178:181]
    v_cvt_pk_f16_f32 v167, v124, v125
    v_pk_fma_f16 v199, v167, v167, v199
    v_mfma_f32_16x16x32_bf16 v[178:181], a[16:19], v[226:229], v[178:181]
    v_cvt_pk_f16_f32 v168, v186, v187
    v_pk_fma_f16 v199, v168, v168, v199
    v_mfma_f32_16x16x32_bf16 v[178:181], a[20:23], v[190:193], v[178:181]
    v_cvt_pk_f16_f32 v169, v188, v189
    v_pk_fma_f16 v199, v169, v169, v199
    v_mfma_f32_16x16x32_bf16 v[186:189], a[24:27], v[182:185], 0
    v_cvt_pk_f16_f32 v124, v194, v195
    v_pk_fma_f16 v199, v124, v124, v199
    v_mfma_f32_16x16x32_bf16 v[186:189], a[28:31], v[210:213], v[186:189]
    v_cvt_pk_f16_f32 v125, v196, v197
    v_pk_fma_f16 v199, v125, v125, v199
    v_mfma_f32_16x16x32_bf16 v[186:189], a[32:35], v[218:221], v[186:189]
    v_cvt_pk_f16_f32 v178, v178, v179
    v_pk_mul_f16 v198, v178, v178
    v_mfma_f32_16x16x32_bf16 v[186:189], a[36:39], v[222:225], v[186:189]
    v_cvt_pk_f16_f32 v179, v180, v181
    v_pk_fma_f16 v198, v179, v179, v198
    v_mfma_f32_16x16x32_bf16 v[186:189], a[40:43], v[226:229], v[186:189]
    v_pk_mul_f16 v200, v178, v170
    v_pk_fma_f16 v200, v179, v171, v200
    v_mfma_f32_16x16x32_bf16 v[186:189], a[44:47], v[190:193], v[186:189]
    v_pk_mul_f16 v201, v166, v174
    v_pk_fma_f16 v201, v167, v175, v201
    v_mfma_f32_16x16x32_bf16 v[194:197], a[48:51], v[182:185], 0
    v_pk_fma_f16 v201, v168, v176, v201
    v_pk_fma_f16 v201, v169, v177, v201
    v_mfma_f32_16x16x32_bf16 v[194:197], a[52:55], v[210:213], v[194:197]
    v_pk_fma_f16 v201, v124, v164, v201
    v_pk_fma_f16 v201, v125, v165, v201
    v_mfma_f32_16x16x32_bf16 v[194:197], a[56:59], v[218:221], v[194:197]
    v_cvt_pk_f16_f32 v180, v186, v187
    v_pk_fma_f16 v198, v180, v180, v198
    v_mfma_f32_16x16x32_bf16 v[194:197], a[60:63], v[222:225], v[194:197]
    v_cvt_pk_f16_f32 v181, v188, v189
    v_pk_fma_f16 v198, v181, v181, v198
    v_mfma_f32_16x16x32_bf16 v[194:197], a[64:67], v[226:229], v[194:197]
    v_pk_fma_f16 v200, v180, v172, v200
    v_pk_fma_f16 v200, v181, v173, v200
    v_mfma_f32_16x16x32_bf16 v[194:197], a[68:71], v[190:193], v[194:197]
    buffer_store_dwordx2 v[140:141], v18, s[12:15], 0 offen nt
    v_mul_f32 v242, v144, v242
    v_mul_f32 v243, v144, v243
    v_mfma_f32_16x16x32_bf16 v[186:189], v[182:185], a[144:147], 0
    v_cvt_pk_bf16_f32 v238, v242, v243
    v_mul_f32 v244, v144, v244
    v_mfma_f32_16x16x32_bf16 v[186:189], v[210:213], a[148:151], v[186:189]
    v_mul_f32 v245, v144, v245
    v_cvt_pk_f16_f32 v122, v194, v195
    v_mfma_f32_16x16x32_bf16 v[186:189], v[218:221], a[152:155], v[186:189]
    v_pk_fma_f16 v198, v122, v122, v198
    v_cvt_pk_f16_f32 v123, v196, v197
    v_mfma_f32_16x16x32_bf16 v[186:189], v[222:225], a[156:159], v[186:189]
    v_pk_fma_f16 v198, v123, v123, v198
    v_pk_fma_f16 v200, v122, v162, v200
    v_mfma_f32_16x16x32_bf16 v[186:189], v[226:229], a[160:163], v[186:189]
    ds_read_b128 v[202:205], v0 offset:32768
    v_pk_fma_f16 v200, v123, v163, v200
    v_mfma_f32_16x16x32_bf16 v[186:189], v[190:193], a[164:167], v[186:189]
    ds_read_b128 v[194:197], v1 offset:32768
    v_cvt_pk_bf16_f32 v239, v244, v245
    v_mfma_f32_16x16x32_f16 v[230:233], v[40:43], v[198:201], 0
    v_mul_f32 v158, v144, v158
    v_mul_f32 v159, v144, v159
    v_mfma_f32_16x16x32_bf16 v[246:249], v[182:185], a[168:171], 0
    ds_read_b128 v[214:217], v0 offset:32896
    v_cvt_pk_bf16_f32 v240, v158, v159
    v_mfma_f32_16x16x32_bf16 v[246:249], v[210:213], a[172:175], v[246:249]
    ds_read_b128 v[206:209], v1 offset:32896
    v_cvt_pk_bf16_f32 v136, v186, v187
    v_mfma_f32_16x16x32_bf16 v[246:249], v[218:221], a[176:179], v[246:249]
    ds_read_b128 v[198:201], v0 offset:33024
    v_cvt_pk_bf16_f32 v137, v188, v189
    v_mfma_f32_16x16x32_bf16 v[246:249], v[222:225], a[180:183], v[246:249]
    ds_read_b128 v[186:189], v1 offset:33024
    v_mul_f32 v160, v144, v160
    v_mfma_f32_16x16x32_bf16 v[246:249], v[226:229], a[184:187], v[246:249]
    v_rsq_f32 v230, v230
    v_mfma_f32_16x16x32_bf16 v[246:249], v[190:193], a[188:191], v[246:249]
    s_waitcnt lgkmcnt(5)
    v_rsq_f32 v231, v231
    v_mfma_f32_16x16x32_bf16 v[242:245], v[182:185], a[192:195], 0
    s_waitcnt lgkmcnt(4)
    v_mul_f32 v234, s31, v230
    v_cvt_pk_f16_f32 v235, v234, v231
    v_mfma_f32_16x16x32_bf16 v[242:245], v[210:213], a[196:199], v[242:245]
    v_fma_f32 v232, v232, v234, v24
    v_fmac_f32_dpp v254, v233, v231 quad_perm:[0,1,2,3] row_mask:0x2 bank_mask:0xf
    v_mfma_f32_16x16x32_bf16 v[242:245], v[218:221], a[200:203], v[242:245]
    s_waitcnt lgkmcnt(3)
    v_cvt_pk_bf16_f32 v140, v246, v247
    v_cvt_pk_bf16_f32 v141, v248, v249
    v_mfma_f32_16x16x32_bf16 v[242:245], v[222:225], a[204:207], v[242:245]
    s_waitcnt lgkmcnt(2)
    v_mul_f32 v161, v144, v161
    v_cvt_pk_bf16_f32 v241, v160, v161
    v_mfma_f32_16x16x32_bf16 v[242:245], v[226:229], a[208:211], v[242:245]
    s_waitcnt lgkmcnt(1)
    buffer_store_dwordx4 v[238:241], v17, s[12:15], 0 offen nt
    v_mul_f32 v154, v144, v154
    v_mul_f32 v155, v144, v155
    v_cvt_pk_bf16_f32 v154, v154, v155
    v_mul_f32 v156, v144, v156
    v_mfma_f32_16x16x32_bf16 v[242:245], v[190:193], a[212:215], v[242:245]
    s_waitcnt lgkmcnt(0)
    v_mul_f32 v157, v144, v157
    v_cvt_pk_bf16_f32 v155, v156, v157
    v_mfma_f32_16x16x32_bf16 v[158:161], a[72:75], v[202:205], 0
    v_pk_mul_f16 v166, v166, v235 op_sel:[0,1] op_sel_hi:[1,1]
    v_pk_mul_f16 v167, v167, v235 op_sel:[0,1] op_sel_hi:[1,1]
    v_mfma_f32_16x16x32_bf16 v[158:161], a[76:79], v[194:197], v[158:161]
    v_pk_mul_f16 v168, v168, v235 op_sel:[0,1] op_sel_hi:[1,1]
    v_cvt_pk_bf16_f32 v144, v242, v243
    v_mfma_f32_16x16x32_bf16 v[158:161], a[80:83], v[214:217], v[158:161]
    v_cvt_pk_bf16_f32 v145, v244, v245
    v_pk_mul_f16 v169, v169, v235 op_sel:[0,1] op_sel_hi:[1,1]
    v_mfma_f32_16x16x32_bf16 v[158:161], a[84:87], v[206:209], v[158:161]
    v_pk_mul_f16 v124, v124, v235 op_sel:[0,1] op_sel_hi:[1,1]
    v_pk_mul_f16 v125, v125, v235 op_sel:[0,1] op_sel_hi:[1,1]
    v_mfma_f32_16x16x32_bf16 v[158:161], a[88:91], v[198:201], v[158:161]
    v_pk_mul_f16 v178, v178, v235 op_sel:[0,0] op_sel_hi:[1,0]
    v_pk_mul_f16 v179, v179, v235 op_sel:[0,0] op_sel_hi:[1,0]
    v_mfma_f32_16x16x32_bf16 v[158:161], a[92:95], v[186:189], v[158:161]
    v_pk_mul_f16 v180, v180, v235 op_sel:[0,0] op_sel_hi:[1,0]
    v_pk_mul_f16 v181, v181, v235 op_sel:[0,0] op_sel_hi:[1,0]
    v_mfma_f32_16x16x32_bf16 v[182:185], a[96:99], v[202:205], 0
    v_pk_mul_f16 v122, v122, v235 op_sel:[0,0] op_sel_hi:[1,0]
    v_pk_mul_f16 v123, v123, v235 op_sel:[0,0] op_sel_hi:[1,0]
    v_mfma_f32_16x16x32_bf16 v[182:185], a[100:103], v[194:197], v[182:185]
    v_max3_u32 v44, v44, v230, v231
    v_mul_f32 v130, v255, v130
    v_mfma_f32_16x16x32_bf16 v[182:185], a[104:107], v[214:217], v[182:185]
    v_cvt_pk_f16_f32 v158, v158, v159
    v_pk_mul_f16 v191, v158, v158
    v_mfma_f32_16x16x32_bf16 v[182:185], a[108:111], v[206:209], v[182:185]
    v_cvt_pk_f16_f32 v159, v160, v161
    v_pk_fma_f16 v191, v159, v159, v191
    v_mfma_f32_16x16x32_bf16 v[182:185], a[112:115], v[198:201], v[182:185]
    v_pk_mul_f16 v193, v158, v174
    v_pk_fma_f16 v193, v159, v175, v193
    v_mfma_f32_16x16x32_bf16 v[182:185], a[116:119], v[186:189], v[182:185]
    v_exp_f32 v232, v232
    v_mfma_f32_16x16x32_bf16 v[210:213], a[120:123], v[202:205], 0
    v_exp_f32 v236, v236
    v_mfma_f32_16x16x32_bf16 v[210:213], a[124:127], v[194:197], v[210:213]
    v_cvt_pk_bf16_f32 v39, v236, 0
    v_mul_f32 v131, v255, v131
    v_mfma_f32_16x16x32_bf16 v[210:213], a[128:131], v[214:217], v[210:213]
    s_waitcnt vmcnt(3)
    ds_write_b16 v8, v45 offset:512
    v_mfma_f32_16x16x32_bf16 v[210:213], a[132:135], v[206:209], v[210:213]
    buffer_store_dwordx2 v[154:155], v20, s[12:15], 0 offen nt
    v_cvt_pk_f16_f32 v160, v182, v183
    v_mfma_f32_16x16x32_bf16 v[210:213], a[136:139], v[198:201], v[210:213]
    v_pk_fma_f16 v191, v160, v160, v191
    v_cvt_pk_f16_f32 v161, v184, v185
    v_mfma_f32_16x16x32_bf16 v[210:213], a[140:143], v[186:189], v[210:213]
    v_pk_fma_f16 v191, v161, v161, v191
    v_pk_fma_f16 v193, v160, v176, v193
    v_mfma_f32_16x16x32_bf16 v[154:157], a[0:3], v[202:205], 0
    v_pk_fma_f16 v193, v161, v177, v193
    v_cvt_pk_bf16_f32 v130, v130, v131
    v_mfma_f32_16x16x32_bf16 v[154:157], a[4:7], v[194:197], v[154:157]
    v_mul_f32 v132, v255, v132
    v_mul_f32 v133, v255, v133
    v_mfma_f32_16x16x32_bf16 v[154:157], a[8:11], v[214:217], v[154:157]
    v_cvt_pk_f16_f32 v176, v210, v211
    v_pk_fma_f16 v191, v176, v176, v191
    v_mfma_f32_16x16x32_bf16 v[154:157], a[12:15], v[206:209], v[154:157]
    s_waitcnt lgkmcnt(0)
    v_cvt_pk_f16_f32 v177, v212, v213
    v_pk_fma_f16 v191, v177, v177, v191
    v_mfma_f32_16x16x32_bf16 v[154:157], a[16:19], v[198:201], v[154:157]
    v_pk_fma_f16 v193, v176, v164, v193
    v_mfma_f32_16x16x32_bf16 v[154:157], a[20:23], v[186:189], v[154:157]
    v_pk_fma_f16 v193, v177, v165, v193
    v_mfma_f32_16x16x32_bf16 v[182:185], a[24:27], v[202:205], 0
    v_cvt_pk_bf16_f32 v131, v132, v133
    v_mfma_f32_16x16x32_bf16 v[182:185], a[28:31], v[194:197], v[182:185]
    s_barrier
    ds_read2_b32 v[164:165], v6 offset0:0 offset1:0
    v_mfma_f32_16x16x32_bf16 v[182:185], a[32:35], v[214:217], v[182:185]
    ds_read2_b32 v[212:213], v6 offset0:16 offset1:16
    v_cvt_pk_f16_f32 v154, v154, v155
    v_mfma_f32_16x16x32_bf16 v[182:185], a[36:39], v[206:209], v[182:185]
    ds_read2_b32 v[220:221], v6 offset0:32 offset1:32
    v_pk_mul_f16 v190, v154, v154
    v_mfma_f32_16x16x32_bf16 v[182:185], a[40:43], v[198:201], v[182:185]
    ds_read_u16 v133, v9 offset:128
    v_cvt_pk_f16_f32 v155, v156, v157
    v_mfma_f32_16x16x32_bf16 v[182:185], a[44:47], v[186:189], v[182:185]
    v_pk_fma_f16 v190, v155, v155, v190
    v_pk_mul_f16 v192, v154, v170
    v_mfma_f32_16x16x32_bf16 v[222:225], a[48:51], v[202:205], 0
    v_pk_fma_f16 v192, v155, v171, v192
    v_mul_f32 v126, v255, v126
    v_mfma_f32_16x16x32_bf16 v[222:225], a[52:55], v[194:197], v[222:225]
    v_mul_f32 v127, v255, v127
    v_cvt_pk_bf16_f32 v132, v126, v127
    v_mfma_f32_16x16x32_bf16 v[222:225], a[56:59], v[214:217], v[222:225]
    buffer_load_dwordx4 v10, s[8:11], 0 offen nt lds
    v_cvt_pk_f16_f32 v156, v182, v183
    v_mfma_f32_16x16x32_bf16 v[222:225], a[60:63], v[206:209], v[222:225]
    s_add_u32 m0, s28, 4096
    v_pk_fma_f16 v190, v156, v156, v190
    v_cvt_pk_f16_f32 v157, v184, v185
    v_mfma_f32_16x16x32_bf16 v[222:225], a[64:67], v[198:201], v[222:225]
    s_waitcnt lgkmcnt(2)
    v_pk_fma_f16 v190, v157, v157, v190
    v_pk_fma_f16 v192, v156, v172, v192
    v_mfma_f32_16x16x32_bf16 v[222:225], a[68:71], v[186:189], v[222:225]
    s_waitcnt lgkmcnt(1)
    ds_read_b128 v[182:185], v2 offset:0
    v_pk_fma_f16 v192, v157, v173, v192
    v_mfma_f32_16x16x32_bf16 v[170:173], v[202:205], a[144:147], 0
    s_waitcnt lgkmcnt(1)
    ds_read_b128 v[226:229], v2 offset:1024
    v_readfirstlane_b32 s77, v133
    v_mfma_f32_16x16x32_bf16 v[170:173], v[194:197], a[148:151], v[170:173]
    ds_read_b128 v[234:237], v2 offset:2048
    buffer_load_dwordx4 v11, s[8:11], 0 offen nt lds
    v_mfma_f32_16x16x32_bf16 v[170:173], v[214:217], a[152:155], v[170:173]
    s_add_u32 m0, s28, 8192
    ds_read_b128 v[238:241], v2 offset:3072
    v_cvt_pk_f16_f32 v174, v222, v223
    v_mfma_f32_16x16x32_bf16 v[170:173], v[206:209], a[156:159], v[170:173]
    s_mul_i32 s78, s77, 2688
    ds_read_b128 v[242:245], v2 offset:4096
    v_pk_fma_f16 v190, v174, v174, v190
    v_mfma_f32_16x16x32_bf16 v[170:173], v[198:201], a[160:163], v[170:173]
    ds_read_b128 v[246:249], v2 offset:5120
    v_cvt_pk_f16_f32 v175, v224, v225
    v_mfma_f32_16x16x32_bf16 v[170:173], v[186:189], a[164:167], v[170:173]
    v_pk_fma_f16 v190, v175, v175, v190
    v_pk_fma_f16 v192, v174, v162, v192
    v_mfma_f32_16x16x32_bf16 v[222:225], v[202:205], a[168:171], 0
    buffer_load_dwordx4 v12, s[8:11], 0 offen nt lds
    v_pk_fma_f16 v192, v175, v163, v192
    v_mfma_f32_16x16x32_bf16 v[222:225], v[194:197], a[172:175], v[222:225]
    s_waitcnt lgkmcnt(5)
    v_mul_f32 v128, v255, v128
    v_cvt_pk_bf16_f32 v162, v170, v171
    v_mfma_f32_16x16x32_f16 v[250:253], v[40:43], v[190:193], 0
    s_add_u32 m0, s28, 12288
    v_cvt_pk_bf16_f32 v163, v172, v173
    v_mul_f32 v129, v255, v129
    v_mfma_f32_16x16x32_bf16 v[222:225], v[214:217], a[176:179], v[222:225]
    s_xor_b32 s28, s28, 65536
    v_cvt_pk_bf16_f32 v133, v128, v129
    v_mul_f32 v114, v255, v114
    v_mfma_f32_16x16x32_bf16 v[222:225], v[206:209], a[180:183], v[222:225]
    s_waitcnt lgkmcnt(2)
    v_rsq_f32 v250, v250
    v_mfma_f32_16x16x32_bf16 v[222:225], v[198:201], a[184:187], v[222:225]
    s_waitcnt lgkmcnt(1)
    buffer_load_dwordx4 v13, s[8:11], 0 offen nt lds
    v_mul_f32 v230, s31, v250
    v_mfma_f32_16x16x32_bf16 v[222:225], v[186:189], a[188:191], v[222:225]
    s_mov_b32 m0, s29
    v_rsq_f32 v251, v251
    v_mfma_f32_16x16x32_bf16 v[126:129], v[202:205], a[192:195], 0
    s_xor_b32 s29, s29, s30
    v_cvt_pk_f16_f32 v231, v230, v251
    v_fma_f32 v252, v252, v230, v26
    v_mfma_f32_16x16x32_bf16 v[126:129], v[194:197], a[196:199], v[126:129]
    s_add_u32 s19, s19, s20
    v_fmac_f32_dpp v254, v253, v251 quad_perm:[0,1,2,3] row_mask:0x4 bank_mask:0xf
    v_cvt_pk_bf16_f32 v210, v222, v223
    v_mfma_f32_16x16x32_bf16 v[126:129], v[214:217], a[200:203], v[126:129]
    s_add_u32 s23, s23, s21
    v_cvt_pk_bf16_f32 v211, v224, v225
    v_pk_mul_f16 v158, v158, v231 op_sel:[0,1] op_sel_hi:[1,1]
    v_mfma_f32_16x16x32_bf16 v[126:129], v[206:209], a[204:207], v[126:129]
    s_waitcnt lgkmcnt(0)
    v_pk_mul_f16 v159, v159, v231 op_sel:[0,1] op_sel_hi:[1,1]
    v_mfma_f32_16x16x32_bf16 v[126:129], v[198:201], a[208:211], v[126:129]
    s_cmp_ge_u32 s19, 72
    v_pk_mul_f16 v160, v160, v231 op_sel:[0,1] op_sel_hi:[1,1]
    v_pk_mul_f16 v161, v161, v231 op_sel:[0,1] op_sel_hi:[1,1]
    v_mfma_f32_16x16x32_bf16 v[126:129], v[186:189], a[212:215], v[126:129]
    s_cselect_b32 s34, 72, 0
    v_pk_mul_f16 v176, v176, v231 op_sel:[0,1] op_sel_hi:[1,1]
    v_pk_mul_f16 v177, v177, v231 op_sel:[0,1] op_sel_hi:[1,1]
    v_mfma_f32_16x16x32_f16 v[170:173], v[146:149], v[150:153], v[46:49]
    s_cselect_b32 s35, s22, 0
    v_pk_mul_f16 v154, v154, v231 op_sel:[0,0] op_sel_hi:[1,0]
    v_pk_mul_f16 v155, v155, v231 op_sel:[0,0] op_sel_hi:[1,0]
    v_mfma_f32_16x16x32_f16 v[186:189], v[166:169], v[150:153], v[50:53]
    s_sub_u32 s19, s19, s34
    v_cvt_pk_bf16_f32 v218, v126, v127
    v_cvt_pk_bf16_f32 v219, v128, v129
    v_mfma_f32_16x16x32_f16 v[126:129], v[158:161], v[150:153], v[54:57]
    buffer_store_dwordx4 v[130:133], v16, s[12:15], 0 offen nt
    v_pk_mul_f16 v156, v156, v231 op_sel:[0,0] op_sel_hi:[1,0]
    v_pk_mul_f16 v157, v157, v231 op_sel:[0,0] op_sel_hi:[1,0]
    v_pk_mul_f16 v174, v174, v231 op_sel:[0,0] op_sel_hi:[1,0]
    v_pk_mul_f16 v175, v175, v231 op_sel:[0,0] op_sel_hi:[1,0]
    v_mfma_f32_16x16x16_f16 v[170:173], v[120:121], v[118:119], v[170:173]
    v_max3_u32 v44, v44, v250, v251
    v_exp_f32 v254, v254
    v_mfma_f32_16x16x16_f16 v[186:189], v[124:125], v[118:119], v[186:189]
    v_cvt_pk_bf16_f32 v254, v254, v254
    v_exp_f32 v252, v252
    v_mfma_f32_16x16x16_f16 v[126:129], v[176:177], v[118:119], v[126:129]
    v_mul_f32 v115, v255, v115
    v_cvt_pk_bf16_f32 v118, v114, v115
    v_exp_f32 v170, v170
    v_mfma_f32_16x16x32_f16 v[130:133], v[146:149], v[178:181], v[58:61]
    s_add_u32 s23, s23, s35
    ds_write_b16 v8, v254
    v_mfma_f32_16x16x32_f16 v[150:153], v[166:169], v[178:181], v[62:65]
    s_add_u32 s78, s78, s69
    v_exp_f32 v171, v171
    v_mfma_f32_16x16x32_f16 v[190:193], v[158:161], v[178:181], v[66:69]
    s_add_u32 s80, s77, s68
    v_cvt_pk_bf16_f32 v170, v170, v171
    v_exp_f32 v172, v172
    v_mfma_f32_16x16x16_f16 v[130:133], v[120:121], v[122:123], v[130:133]
    v_exp_f32 v173, v173
    v_mul_f32 v116, v255, v116
    v_mfma_f32_16x16x16_f16 v[150:153], v[124:125], v[122:123], v[150:153]
    v_cvt_pk_bf16_f32 v171, v172, v173
    v_exp_f32 v186, v186
    v_mfma_f32_16x16x16_f16 v[190:193], v[176:177], v[122:123], v[190:193]
    v_exp_f32 v187, v187
    v_exp_f32 v188, v188
    v_mfma_f32_16x16x32_bf16 v[178:181], a[216:219], v[182:185], 0
    s_cmp_ge_u32 s80, 72
    v_exp_f32 v130, v130
    v_mfma_f32_16x16x32_bf16 v[178:181], a[220:223], v[226:229], v[178:181]
    s_cselect_b32 s80, s22, 0
    v_exp_f32 v131, v131
    v_mfma_f32_16x16x32_bf16 v[178:181], a[224:227], v[234:237], v[178:181]
    s_add_u32 s78, s78, s80
    v_cvt_pk_bf16_f32 v194, v130, v131
    v_cvt_pk_bf16_f32 v172, v186, v187
    v_mfma_f32_16x16x32_bf16 v[178:181], a[228:231], v[238:241], v[178:181]
    s_add_u32 s80, s77, 20
    v_exp_f32 v132, v132
    v_mfma_f32_16x16x32_bf16 v[178:181], a[232:235], v[242:245], v[178:181]
    s_add_u32 s34, s18, 3
    v_exp_f32 v133, v133
    v_mfma_f32_16x16x32_bf16 v[178:181], a[236:239], v[246:249], v[178:181]
    s_cmp_lt_u32 s77, s62
    v_cvt_pk_bf16_f32 v195, v132, v133
    v_mul_f32 v117, v255, v117
    v_mfma_f32_16x16x32_bf16 v[198:201], a[240:243], v[182:185], 0
    s_cselect_b32 s79, 1, 0
    v_exp_f32 v150, v150
    v_mfma_f32_16x16x32_f16 v[202:205], v[146:149], v[154:157], v[70:73]
    s_cselect_b32 s78, s78, 0
    v_exp_f32 v151, v151
    v_mfma_f32_16x16x32_f16 v[146:149], v[166:169], v[154:157], v[74:77]
    s_cmp_lt_u32 s34, s17
    v_cvt_pk_bf16_f32 v196, v150, v151
    v_cvt_pk_bf16_f32 v119, v116, v117
    v_mfma_f32_16x16x32_f16 v[166:169], v[158:161], v[154:157], v[78:81]
    buffer_store_dwordx2 v[118:119], v19, s[12:15], 0 offen nt
    v_exp_f32 v152, v152
    v_mfma_f32_16x16x16_f16 v[202:205], v[120:121], v[174:175], v[202:205]
    v_exp_f32 v153, v153
    v_fma_f32 v254, v178, v178, s33
    v_mfma_f32_16x16x16_f16 v[146:149], v[124:125], v[174:175], v[146:149]
    v_cvt_pk_bf16_f32 v197, v152, v153
    v_exp_f32 v190, v190
    v_mfma_f32_16x16x16_f16 v[166:169], v[176:177], v[174:175], v[166:169]
    v_exp_f32 v191, v191
    v_exp_f32 v192, v192
    v_mfma_f32_16x16x32_bf16 v[198:201], a[244:247], v[226:229], v[198:201]
    s_cselect_b32 s23, s23, s78
    v_exp_f32 v193, v193
    v_mfma_f32_16x16x32_bf16 v[198:201], a[248:251], v[234:237], v[198:201]
    s_cselect_b32 s73, s34, s80
    ds_read_b128 v[118:121], v2 offset:6144
    v_fmac_f32 v254, v179, v179
    v_mfma_f32_16x16x32_bf16 v[198:201], a[252:255], v[238:241], v[198:201]
    s_cselect_b32 s79, 0, s79
    ds_read_b128 v[122:125], v2 offset:7168
    v_fmac_f32 v254, v180, v180
    v_mfma_f32_16x16x32_bf16 v[198:201], v[82:85], v[242:245], v[198:201]
    s_cselect_b32 s81, 0, 1
    ds_read_b128 v[150:153], v2 offset:8192
    v_fmac_f32 v254, v181, v181
    v_mfma_f32_16x16x32_bf16 v[198:201], v[86:89], v[246:249], v[198:201]
    s_add_u32 s80, s77, 1
    ds_read_b128 v[154:157], v2 offset:9216
    v_xor_b32 v0, 65536, v0
    v_mfma_f32_16x16x32_bf16 v[206:209], v[90:93], v[182:185], 0
    s_mul_i32 s80, s80, s81
    ds_read_b128 v[158:161], v2 offset:10240
    v_xor_b32 v1, 65536, v1
    v_mfma_f32_16x16x32_bf16 v[206:209], v[94:97], v[226:229], v[206:209]
    s_cmp_lt_u32 s80, s62
    ds_read_b128 v[174:177], v2 offset:11264
    v_fmac_f32 v254, v198, v198
    v_mfma_f32_16x16x32_bf16 v[206:209], v[98:101], v[234:237], v[206:209]
    s_cselect_b32 s62, s62, 0
    v_exp_f32 v189, v189
    v_mfma_f32_16x16x32_bf16 v[206:209], v[102:105], v[238:241], v[206:209]
    s_add_u32 s80, s18, 4
    v_cvt_pk_bf16_f32 v173, v188, v189
    v_fmac_f32 v254, v199, v199
    v_mfma_f32_16x16x32_bf16 v[206:209], v[106:109], v[242:245], v[206:209]
    s_waitcnt lgkmcnt(5)
    v_exp_f32 v126, v126
    v_mfma_f32_16x16x32_bf16 v[206:209], v[110:113], v[246:249], v[206:209]
    s_cmp_ge_u32 s80, s17
    v_exp_f32 v127, v127
    v_mfma_f32_16x16x32_bf16 v[130:133], a[216:219], v[118:121], 0
    s_waitcnt lgkmcnt(3)
    v_cvt_pk_bf16_f32 v36, v126, v127
    v_fmac_f32 v254, v200, v200
    v_mfma_f32_16x16x32_bf16 v[130:133], a[220:223], v[122:125], v[130:133]
    s_cselect_b32 s66, s62, 0
    v_exp_f32 v128, v128
    v_mfma_f32_16x16x32_bf16 v[130:133], a[224:227], v[150:153], v[130:133]
    s_waitcnt lgkmcnt(1)
    v_fmac_f32 v254, v201, v201
    v_mfma_f32_16x16x32_bf16 v[130:133], a[228:231], v[154:157], v[130:133]
    s_lshl_b32 s80, s79, s73
    v_exp_f32 v129, v129
    v_mfma_f32_16x16x32_bf16 v[130:133], a[232:235], v[158:161], v[130:133]
    s_waitcnt lgkmcnt(0)
    v_cvt_pk_bf16_f32 v37, v128, v129
    v_fmac_f32 v254, v206, v206
    v_mfma_f32_16x16x32_bf16 v[130:133], a[236:239], v[174:177], v[130:133]
    s_or_b32 s70, s70, s80
    v_exp_f32 v202, v202
    v_mfma_f32_16x16x32_bf16 v[182:185], v[28:31], v[36:39], 0
    s_add_u32 s45, s45, s79
    v_exp_f32 v203, v203
    v_mfma_f32_16x16x32_bf16 v[182:185], v[28:31], v[170:173], v[182:185]
    s_add_u32 s18, s18, 1
    v_cvt_pk_bf16_f32 v186, v202, v203
    v_fma_f32 v255, v130, v130, s33
    v_mfma_f32_16x16x32_bf16 v[214:217], v[162:165], v[36:39], 0
    s_cmp_lt_u32 s18, s45
    v_fmac_f32 v255, v131, v131
    v_fmac_f32 v255, v132, v132
    v_mfma_f32_16x16x32_bf16 v[214:217], v[134:137], v[170:173], v[214:217]
    v_fmac_f32 v255, v133, v133
    v_fmac_f32 v254, v207, v207
    v_mfma_f32_16x16x32_bf16 v[222:225], v[210:213], v[36:39], 0
    v_exp_f32 v204, v204
    v_mfma_f32_16x16x32_bf16 v[222:225], v[138:141], v[170:173], v[222:225]
    v_exp_f32 v205, v205
    v_mfma_f32_16x16x32_bf16 v[226:229], v[218:221], v[36:39], 0
    v_cvt_pk_bf16_f32 v36, v190, v191
    v_cvt_pk_bf16_f32 v37, v192, v193
    v_mfma_f32_16x16x32_bf16 v[226:229], v[142:145], v[170:173], v[226:229]
    v_cvt_pk_bf16_f32 v39, v232, 0
    v_cvt_pk_bf16_f32 v187, v204, v205
    v_mfma_f32_16x16x32_bf16 v[126:129], a[240:243], v[118:121], 0
    v_exp_f32 v146, v146
    v_mfma_f32_16x16x32_bf16 v[170:173], v[28:31], v[36:39], 0
    v_exp_f32 v147, v147
    v_mfma_f32_16x16x32_bf16 v[170:173], v[28:31], v[194:197], v[170:173]
    v_cvt_pk_bf16_f32 v188, v146, v147
    v_fmac_f32 v254, v208, v208
    v_mfma_f32_16x16x32_bf16 v[114:117], v[162:165], v[36:39], 0
    v_exp_f32 v148, v148
    v_mfma_f32_16x16x32_bf16 v[114:117], v[134:137], v[194:197], v[114:117]
    v_exp_f32 v149, v149
    v_mfma_f32_16x16x32_bf16 v[190:193], v[210:213], v[36:39], 0
    v_cvt_pk_bf16_f32 v189, v148, v149
    v_fmac_f32 v254, v209, v209
    v_mfma_f32_16x16x32_bf16 v[190:193], v[138:141], v[194:197], v[190:193]
    v_rcp_f32 v170, v170
    v_mfma_f32_16x16x32_bf16 v[146:149], v[218:221], v[36:39], 0
    v_exp_f32 v166, v166
    v_mfma_f32_16x16x32_bf16 v[146:149], v[142:145], v[194:197], v[146:149]
    v_mul_f32 v114, v170, v114
    v_mul_f32 v115, v170, v115
    v_mfma_f32_16x16x32_bf16 v[126:129], a[244:247], v[122:125], v[126:129]
    v_cvt_pk_bf16_f32 v194, v114, v115
    v_mul_f32 v116, v170, v116
    v_mfma_f32_16x16x32_bf16 v[126:129], a[248:251], v[150:153], v[126:129]
    ds_read_b128 v[202:205], v2 offset:12288
    v_mul_f32 v117, v170, v117
    v_mfma_f32_16x16x32_bf16 v[126:129], a[252:255], v[154:157], v[126:129]
    ds_read_b128 v[230:233], v2 offset:13312
    v_cvt_pk_bf16_f32 v195, v116, v117
    v_mfma_f32_16x16x32_bf16 v[126:129], v[82:85], v[158:161], v[126:129]
    ds_read_b128 v[234:237], v2 offset:14336
    v_mul_f32 v190, v170, v190
    v_mfma_f32_16x16x32_bf16 v[126:129], v[86:89], v[174:177], v[126:129]
    ds_read_b128 v[238:241], v2 offset:15360
    v_mul_f32 v191, v170, v191
    v_mfma_f32_16x16x32_bf16 v[114:117], v[90:93], v[118:121], 0
    ds_read_b128 v[118:121], v2 offset:16384
    v_cvt_pk_bf16_f32 v196, v190, v191
    v_mfma_f32_16x16x32_bf16 v[114:117], v[94:97], v[122:125], v[114:117]
    ds_read_b128 v[122:125], v2 offset:17408
    v_mul_f32 v192, v170, v192
    v_mfma_f32_16x16x32_bf16 v[114:117], v[98:101], v[150:153], v[114:117]
    v_fmac_f32 v255, v126, v126
    v_fmac_f32 v255, v127, v127
    v_mfma_f32_16x16x32_bf16 v[114:117], v[102:105], v[154:157], v[114:117]
    v_fmac_f32 v255, v128, v128
    v_fmac_f32 v255, v129, v129
    v_mfma_f32_16x16x32_bf16 v[114:117], v[106:109], v[158:161], v[114:117]
    s_waitcnt lgkmcnt(5)
    v_mul_f32 v193, v170, v193
    v_cvt_pk_bf16_f32 v197, v192, v193
    v_mfma_f32_16x16x32_bf16 v[114:117], v[110:113], v[174:177], v[114:117]
    s_waitcnt lgkmcnt(4)
    ds_write_b128 v3, v[194:197] offset:6144
    v_mfma_f32_16x16x32_bf16 v[242:245], a[216:219], v[202:205], 0
    s_waitcnt lgkmcnt(3)
    v_mul_f32 v146, v170, v146
    v_mul_f32 v147, v170, v147
    v_mfma_f32_16x16x32_bf16 v[242:245], a[220:223], v[230:233], v[242:245]
    s_waitcnt lgkmcnt(2)
    v_fmac_f32 v255, v114, v114
    v_fmac_f32 v255, v115, v115
    v_mfma_f32_16x16x32_bf16 v[242:245], a[224:227], v[234:237], v[242:245]
    s_waitcnt lgkmcnt(1)
    v_fmac_f32 v255, v116, v116
    v_fmac_f32 v255, v117, v117
    v_mfma_f32_16x16x32_bf16 v[242:245], a[228:231], v[238:241], v[242:245]
    v_cvt_pk_bf16_f32 v254, v254, v255
    v_cvt_pk_bf16_f32 v172, v146, v147
    v_mfma_f32_16x16x32_bf16 v[242:245], a[232:235], v[118:121], v[242:245]
    v_mul_f32 v148, v170, v148
    v_mul_f32 v149, v170, v149
    v_mfma_f32_16x16x32_bf16 v[242:245], a[236:239], v[122:125], v[242:245]
    v_cvt_pk_bf16_f32 v173, v148, v149
    v_cvt_pk_bf16_f32 v39, v252, 0
    v_mfma_f32_16x16x32_bf16 v[158:161], a[240:243], v[202:205], 0
    ds_write_b64 v4, v[172:173] offset:10240
    v_mfma_f32_16x16x32_bf16 v[158:161], a[244:247], v[230:233], v[158:161]
    v_exp_f32 v167, v167
    v_mfma_f32_16x16x32_bf16 v[158:161], a[248:251], v[234:237], v[158:161]
    v_cvt_pk_bf16_f32 v36, v166, v167
    v_fma_f32 v255, v242, v242, s33
    v_mfma_f32_16x16x32_bf16 v[158:161], a[252:255], v[238:241], v[158:161]
    v_fmac_f32 v255, v243, v243
    v_fmac_f32 v255, v244, v244
    v_mfma_f32_16x16x32_bf16 v[158:161], v[82:85], v[118:121], v[158:161]
    v_fmac_f32 v255, v245, v245
    v_xor_b32 v2, 65536, v2
    v_mfma_f32_16x16x32_bf16 v[158:161], v[86:89], v[122:125], v[158:161]
    v_exp_f32 v168, v168
    v_mfma_f32_16x16x32_bf16 v[154:157], v[90:93], v[202:205], 0
    v_exp_f32 v169, v169
    v_mfma_f32_16x16x32_bf16 v[154:157], v[94:97], v[230:233], v[154:157]
    ds_read_b128 v[146:149], v9
    v_cvt_pk_bf16_f32 v37, v168, v169
    v_mfma_f32_16x16x32_bf16 v[154:157], v[98:101], v[234:237], v[154:157]
    ds_read_b128 v[150:153], v9 offset:64
    v_fmac_f32 v255, v158, v158
    v_mfma_f32_16x16x32_bf16 v[166:169], v[28:31], v[36:39], 0
    v_fmac_f32 v255, v159, v159
    v_fmac_f32 v255, v160, v160
    v_mfma_f32_16x16x32_bf16 v[166:169], v[28:31], v[186:189], v[166:169]
    v_fmac_f32 v255, v161, v161
    v_add_u32 v6, s75, v6
    v_mfma_f32_16x16x32_bf16 v[174:177], v[162:165], v[36:39], 0
    v_rcp_f32 v182, v182
    v_mfma_f32_16x16x32_bf16 v[174:177], v[134:137], v[186:189], v[174:177]
    v_max3_u32 v25, v25, v182, v183
    v_max3_u32 v25, v25, v170, v171
    v_mfma_f32_16x16x32_bf16 v[170:173], v[210:213], v[36:39], 0
    v_rcp_f32 v166, v166
    v_mfma_f32_16x16x32_bf16 v[170:173], v[138:141], v[186:189], v[170:173]
    v_max3_u32 v25, v25, v166, v167
    v_mul_f32 v214, v182, v214
    v_mfma_f32_16x16x32_bf16 v[190:193], v[218:221], v[36:39], 0
    s_waitcnt lgkmcnt(1)
    v_mul_f32 v174, v166, v174
    v_mul_f32 v175, v166, v175
    v_mfma_f32_16x16x32_bf16 v[190:193], v[142:145], v[186:189], v[190:193]
    s_waitcnt lgkmcnt(0)
    v_cvt_pk_bf16_f32 v174, v174, v175
    v_mul_f32 v176, v166, v176
    v_mfma_f32_16x16x32_bf16 v[154:157], v[102:105], v[238:241], v[154:157]
    ds_read_b128 v[186:189], v0 offset:20480
    v_mul_f32 v177, v166, v177
    v_mfma_f32_16x16x32_bf16 v[154:157], v[106:109], v[118:121], v[154:157]
    ds_read_b128 v[194:197], v1 offset:20480
    v_cvt_pk_bf16_f32 v175, v176, v177
    v_mfma_f32_16x16x32_bf16 v[154:157], v[110:113], v[122:125], v[154:157]
    ds_read_b128 v[122:125], v0 offset:20608
    v_mul_f32 v170, v166, v170
    v_mfma_f32_16x16x32_bf16 v[118:121], v[146:149], v[28:31], 0
    ds_read_b128 v[202:205], v1 offset:20608
    v_mul_f32 v171, v166, v171
    v_mfma_f32_16x16x32_bf16 v[118:121], v[150:153], v[28:31], v[118:121]
    ds_read_b128 v[230:233], v0 offset:20736
    v_cvt_pk_bf16_f32 v176, v170, v171
    v_mfma_f32_16x16x32_bf16 v[234:237], v[146:149], v[134:137], 0
    ds_read_b128 v[238:241], v1 offset:20736
    v_fmac_f32 v255, v154, v154
    v_mfma_f32_16x16x32_bf16 v[234:237], v[150:153], v[162:165], v[234:237]
    v_fmac_f32 v255, v155, v155
    v_fmac_f32 v255, v156, v156
    v_mfma_f32_16x16x32_bf16 v[134:137], v[146:149], v[138:141], 0
    v_fmac_f32 v255, v157, v157
    v_cvt_pk_bf16_f32 v255, v255, v255
    v_mfma_f32_16x16x32_bf16 v[134:137], v[150:153], v[210:213], v[134:137]
    s_waitcnt lgkmcnt(5)
    ds_write_b64 v4, v[254:255] offset:18432
    v_mfma_f32_16x16x32_bf16 v[138:141], v[146:149], v[142:145], 0
    s_waitcnt lgkmcnt(4)
    v_mul_f32 v172, v166, v172
    v_mul_f32 v173, v166, v173
    v_mfma_f32_16x16x32_bf16 v[138:141], v[150:153], v[218:221], v[138:141]
    s_waitcnt lgkmcnt(3)
    v_cvt_pk_bf16_f32 v177, v172, v173
    v_mul_f32 v190, v166, v190
    v_mfma_f32_16x16x32_bf16 v[142:145], a[72:75], v[186:189], 0
    s_waitcnt lgkmcnt(2)
    ds_write_b128 v3, v[174:177] offset:12288
    v_mfma_f32_16x16x32_bf16 v[142:145], a[76:79], v[194:197], v[142:145]
    s_waitcnt lgkmcnt(2)
    v_mul_f32 v191, v166, v191
    v_cvt_pk_bf16_f32 v120, v190, v191
    v_mfma_f32_16x16x32_bf16 v[142:145], a[80:83], v[122:125], v[142:145]
    v_mul_f32 v192, v166, v192
    v_mul_f32 v193, v166, v193
    v_mfma_f32_16x16x32_bf16 v[142:145], a[84:87], v[202:205], v[142:145]
    v_cvt_pk_bf16_f32 v121, v192, v193
    v_mul_f32 v215, v182, v215
    v_mfma_f32_16x16x32_bf16 v[142:145], a[88:91], v[230:233], v[142:145]
    ds_write_b64 v4, v[120:121] offset:16384
    v_mfma_f32_16x16x32_bf16 v[142:145], a[92:95], v[238:241], v[142:145]
    v_rcp_f32 v118, v118
    v_mfma_f32_16x16x32_bf16 v[150:153], a[96:99], v[186:189], 0
    v_max3_u32 v25, v25, v118, v119
    v_mul_f32 v234, v234, v118
    v_mfma_f32_16x16x32_bf16 v[150:153], a[100:103], v[194:197], v[150:153]
    v_cvt_pk_bf16_f32 v146, v214, v215
    v_mul_f32_dpp v234, v134, v118 quad_perm:[0,1,2,3] row_mask:0x2 bank_mask:0xf
    v_mfma_f32_16x16x32_bf16 v[150:153], a[104:107], v[122:125], v[150:153]
    v_mul_f32 v216, v182, v216
    v_mul_f32_dpp v234, v138, v118 quad_perm:[0,1,2,3] row_mask:0x4 bank_mask:0xf
    v_mfma_f32_16x16x32_bf16 v[150:153], a[108:111], v[202:205], v[150:153]
    v_cvt_pk_bf16_f32 v234, v234, v234
    v_mul_f32 v217, v182, v217
    v_mfma_f32_16x16x32_bf16 v[150:153], a[112:115], v[230:233], v[150:153]
    ds_write_b16 v7, v234
    v_mfma_f32_16x16x32_bf16 v[150:153], a[116:119], v[238:241], v[150:153]
    v_cvt_pk_bf16_f32 v147, v216, v217
    v_mul_f32 v222, v182, v222
    v_mfma_f32_16x16x32_bf16 v[134:137], a[120:123], v[186:189], 0
    v_mul_f32 v223, v182, v223
    v_cvt_pk_bf16_f32 v148, v222, v223
    v_mfma_f32_16x16x32_bf16 v[134:137], a[124:127], v[194:197], v[134:137]
    v_mul_f32 v224, v182, v224
    v_mul_f32 v225, v182, v225
    v_mfma_f32_16x16x32_bf16 v[134:137], a[128:131], v[122:125], v[134:137]
    v_cvt_pk_bf16_f32 v149, v224, v225
    v_mul_f32 v226, v182, v226
    v_mfma_f32_16x16x32_bf16 v[134:137], a[132:135], v[202:205], v[134:137]
    ds_write_b128 v3, v[146:149] offset:0
    v_mfma_f32_16x16x32_bf16 v[134:137], a[136:139], v[230:233], v[134:137]
    v_mul_f32 v227, v182, v227
    v_cvt_pk_bf16_f32 v254, v226, v227
    v_mfma_f32_16x16x32_bf16 v[134:137], a[140:143], v[238:241], v[134:137]
    v_mul_f32 v228, v182, v228
    v_mul_f32 v229, v182, v229
    v_mfma_f32_16x16x32_bf16 v[138:141], a[0:3], v[186:189], 0
    v_cvt_pk_bf16_f32 v255, v228, v229
    v_xor_b32 v3, 65536, v3
    v_mfma_f32_16x16x32_bf16 v[138:141], a[4:7], v[194:197], v[138:141]
    ds_write_b64 v4, v[254:255] offset:4096
    v_mfma_f32_16x16x32_bf16 v[138:141], a[8:11], v[122:125], v[138:141]
    v_xor_b32 v4, 65536, v4
    v_add_u32 v7, s76, v7
    v_mfma_f32_16x16x32_bf16 v[138:141], a[12:15], v[202:205], v[138:141]
    v_cvt_pk_f16_f32 v146, v142, v143
    v_pk_mul_f16 v143, v146, v146
    v_mfma_f32_16x16x32_bf16 v[138:141], a[16:19], v[230:233], v[138:141]
    v_cvt_pk_f16_f32 v147, v144, v145
    v_pk_fma_f16 v143, v147, v147, v143
    v_mfma_f32_16x16x32_bf16 v[138:141], a[20:23], v[238:241], v[138:141]
    v_cvt_pk_f16_f32 v148, v150, v151
    v_pk_fma_f16 v143, v148, v148, v143
    v_mfma_f32_16x16x32_bf16 v[166:169], a[24:27], v[186:189], 0
    v_cvt_pk_f16_f32 v149, v152, v153
    v_pk_fma_f16 v143, v149, v149, v143
    v_mfma_f32_16x16x32_bf16 v[166:169], a[28:31], v[194:197], v[166:169]
    v_cvt_pk_f16_f32 v120, v134, v135
    v_pk_fma_f16 v143, v120, v120, v143
    v_mfma_f32_16x16x32_bf16 v[166:169], a[32:35], v[122:125], v[166:169]
    s_waitcnt lgkmcnt(0)
    v_cvt_pk_f16_f32 v121, v136, v137
    v_pk_fma_f16 v143, v121, v121, v143
    v_mfma_f32_16x16x32_bf16 v[166:169], a[36:39], v[202:205], v[166:169]
    s_nop 0
    v_mfma_f32_16x16x32_bf16 v[166:169], a[40:43], v[230:233], v[166:169]
    s_nop 0
    v_mfma_f32_16x16x32_bf16 v[166:169], a[44:47], v[238:241], v[166:169]
    s_nop 0
    v_mfma_f32_16x16x32_bf16 v[134:137], a[48:51], v[186:189], 0
    s_barrier
    v_mfma_f32_16x16x32_bf16 v[134:137], a[52:55], v[194:197], v[134:137]
    s_cbranch_scc1 L_loop_fast3
L_final_fast:
    v_mfma_f32_16x16x32_bf16 v[134:137], a[56:59], v[122:125], v[134:137]
    s_mov_b32 s12, s40
    ds_read_b128 v[150:153], v2 offset:18432
    ds_read_b128 v[162:165], v2 offset:19456
    v_mfma_f32_16x16x32_bf16 v[134:137], a[60:63], v[202:205], v[134:137]
    s_mov_b32 s13, s41
    ds_read_b128 v[170:173], v5 offset:32
    ds_read2_b64 v[174:177], v5 offset0:6 offset1:9
    v_mfma_f32_16x16x32_bf16 v[134:137], a[64:67], v[230:233], v[134:137]
    s_mov_b32 s14, s36
    v_cvt_pk_f16_f32 v138, v138, v139
    v_pk_mul_f16 v142, v138, v138
    v_mfma_f32_16x16x32_bf16 v[134:137], a[68:71], v[238:241], v[134:137]
    s_add_u32 s48, s40, s27
    ds_read_b128 v[182:185], v5
    ds_read_b32 v254, v6 offset:192
    v_mfma_f32_16x16x32_bf16 v[190:193], v[186:189], a[144:147], 0
    s_addc_u32 s49, s41, 0
    v_cvt_pk_f16_f32 v139, v140, v141
    v_pk_fma_f16 v142, v139, v139, v142
    v_mfma_f32_16x16x32_bf16 v[190:193], v[194:197], a[148:151], v[190:193]
    s_sub_u32 s50, s36, s27
    v_cvt_pk_f16_f32 v140, v166, v167
    v_pk_fma_f16 v142, v140, v140, v142
    v_mfma_f32_16x16x32_bf16 v[190:193], v[122:125], a[152:155], v[190:193]
    s_mov_b32 s51, 0x00020000
    v_cvt_pk_f16_f32 v141, v168, v169
    v_pk_fma_f16 v142, v141, v141, v142
    v_mfma_f32_16x16x32_bf16 v[190:193], v[202:205], a[156:159], v[190:193]
    s_add_u32 s52, s40, s26
    v_cvt_pk_f16_f32 v118, v134, v135
    v_pk_fma_f16 v142, v118, v118, v142
    v_mfma_f32_16x16x32_bf16 v[190:193], v[230:233], a[160:163], v[190:193]
    s_waitcnt lgkmcnt(4)
    v_cvt_pk_f16_f32 v119, v136, v137
    v_pk_fma_f16 v142, v119, v119, v142
    v_mfma_f32_16x16x32_bf16 v[134:137], v[32:35], v[150:153], 0
    s_waitcnt lgkmcnt(2)
    v_pk_mul_f16 v145, v146, v170
    v_pk_fma_f16 v145, v147, v171, v145
    v_mfma_f32_16x16x32_bf16 v[134:137], v[32:35], v[162:165], v[134:137]
    s_addc_u32 s53, s41, 0
    v_pk_fma_f16 v145, v148, v172, v145
    v_pk_fma_f16 v145, v149, v173, v145
    v_mfma_f32_16x16x32_bf16 v[190:193], v[238:241], a[164:167], v[190:193]
    s_waitcnt lgkmcnt(0)
    v_mov_b32_dpp v254, v23 quad_perm:[0,1,2,3] row_mask:0x7 bank_mask:0xf
    v_pk_fma_f16 v145, v120, v176, v145
    v_mfma_f32_16x16x32_bf16 v[150:153], v[186:189], a[168:171], 0
    s_sub_u32 s54, s36, s26
    v_mul_f32 v144, 0x3baaaaab, v135
    v_mul_f32 v255, 0x3baaaaab, v134
    v_mfma_f32_16x16x32_bf16 v[150:153], v[194:197], a[172:175], v[150:153]
    s_mov_b32 s55, 0x00020000
    v_rsq_f32 v144, v144
    v_mfma_f32_16x16x32_bf16 v[150:153], v[122:125], a[176:179], v[150:153]
    s_add_u32 s56, s40, s25
    v_mul_f32 v130, v144, v130
    v_mul_f32 v131, v144, v131
    v_mfma_f32_16x16x32_bf16 v[150:153], v[202:205], a[180:183], v[150:153]
    s_addc_u32 s57, s41, 0
    v_cvt_pk_bf16_f32 v130, v130, v131
    v_mul_f32 v132, v144, v132
    v_mfma_f32_16x16x32_bf16 v[150:153], v[230:233], a[184:187], v[150:153]
    s_sub_u32 s58, s36, s25
    ds_read_b128 v[162:165], v0 offset:26624
    v_mul_f32 v133, v144, v133
    v_mfma_f32_16x16x32_bf16 v[150:153], v[238:241], a[188:191], v[150:153]
    s_mov_b32 s59, 0x00020000
    ds_read_b128 v[166:169], v1 offset:26624
    v_cvt_pk_bf16_f32 v131, v132, v133
    v_mfma_f32_16x16x32_bf16 v[210:213], v[186:189], a[192:195], 0
    s_and_b32 s6, s2, 7
    ds_read_b128 v[186:189], v0 offset:26752
    v_mul_f32 v126, v144, v126
    v_mfma_f32_16x16x32_bf16 v[210:213], v[194:197], a[196:199], v[210:213]
    s_sub_u32 s6, 0, s6
    ds_read_b128 v[194:197], v1 offset:26752
    v_mul_f32 v127, v144, v127
    v_mfma_f32_16x16x32_bf16 v[210:213], v[122:125], a[200:203], v[210:213]
    s_lshl_b32 s3, s16, 6
    ds_read_b128 v[122:125], v0 offset:26880
    v_cvt_pk_bf16_f32 v132, v126, v127
    v_mfma_f32_16x16x32_bf16 v[210:213], v[202:205], a[204:207], v[210:213]
    s_lshl_b32 s4, s16, 5
    ds_read_b128 v[202:205], v1 offset:26880
    v_mul_f32 v128, v144, v128
    v_mfma_f32_16x16x32_bf16 v[210:213], v[230:233], a[208:211], v[210:213]
    s_add_u32 s4, s4, 256
    v_mul_f32 v129, v144, v129
    v_cvt_pk_bf16_f32 v133, v128, v129
    v_mfma_f32_16x16x32_bf16 v[210:213], v[238:241], a[212:215], v[210:213]
    s_mul_i32 s5, s16, 9408
    s_waitcnt lgkmcnt(5)
    ds_read_b128 v[126:129], v2 offset:0
    v_mfma_f32_16x16x32_bf16 v[214:217], a[72:75], v[162:165], 0
    s_add_u32 s5, s5, 104448
    ds_read_b128 v[218:221], v2 offset:1024
    ds_read_b128 v[222:225], v2 offset:2048
    v_mfma_f32_16x16x32_bf16 v[226:229], a[96:99], v[162:165], 0
    s_waitcnt lgkmcnt(7)
    ds_read_b128 v[230:233], v2 offset:3072
    buffer_store_dwordx4 v[130:133], v16, s[48:51], 0 offen nt
    ds_read_b128 v[234:237], v2 offset:4096
    v_mul_f32 v114, v144, v114
    v_mul_f32 v115, v144, v115
    v_cvt_pk_bf16_f32 v134, v114, v115
    v_mfma_f32_16x16x32_bf16 v[214:217], a[76:79], v[166:169], v[214:217]
    s_waitcnt lgkmcnt(7)
    ds_read_b128 v[130:133], v2 offset:5120
    v_mul_f32 v116, v144, v116
    v_mfma_f32_16x16x32_bf16 v[214:217], a[80:83], v[186:189], v[214:217]
    s_waitcnt lgkmcnt(7)
    v_mul_f32 v117, v144, v117
    v_cvt_pk_bf16_f32 v135, v116, v117
    v_mfma_f32_16x16x32_bf16 v[214:217], a[84:87], v[194:197], v[214:217]
    s_waitcnt lgkmcnt(6)
    v_rsq_f32 v255, v255
    v_mfma_f32_16x16x32_bf16 v[214:217], a[88:91], v[122:125], v[214:217]
    v_mul_f32 v178, v255, v178
    v_mul_f32 v179, v255, v179
    v_mfma_f32_16x16x32_bf16 v[214:217], a[92:95], v[202:205], v[214:217]
    s_waitcnt lgkmcnt(5)
    v_cvt_pk_bf16_f32 v114, v178, v179
    v_mul_f32 v180, v255, v180
    v_mfma_f32_16x16x32_bf16 v[226:229], a[100:103], v[166:169], v[226:229]
    s_waitcnt lgkmcnt(3)
    v_mul_f32 v181, v255, v181
    v_cvt_pk_bf16_f32 v115, v180, v181
    v_mfma_f32_16x16x32_bf16 v[178:181], a[216:219], v[126:129], 0
    s_waitcnt lgkmcnt(1)
    v_mul_f32 v198, v255, v198
    v_mul_f32 v199, v255, v199
    v_mfma_f32_16x16x32_bf16 v[178:181], a[220:223], v[218:221], v[178:181]
    v_cvt_pk_bf16_f32 v116, v198, v199
    v_mul_f32 v200, v255, v200
    v_mfma_f32_16x16x32_bf16 v[178:181], a[224:227], v[222:225], v[178:181]
    s_waitcnt lgkmcnt(0)
    v_mul_f32 v201, v255, v201
    v_cvt_pk_bf16_f32 v117, v200, v201
    v_mfma_f32_16x16x32_bf16 v[178:181], a[228:231], v[230:233], v[178:181]
    v_mul_f32 v206, v255, v206
    v_mul_f32 v207, v255, v207
    v_mfma_f32_16x16x32_bf16 v[178:181], a[232:235], v[234:237], v[178:181]
    v_cvt_pk_bf16_f32 v206, v206, v207
    v_mul_f32 v208, v255, v208
    v_mfma_f32_16x16x32_bf16 v[178:181], a[236:239], v[130:133], v[178:181]
    v_mul_f32 v209, v255, v209
    v_cvt_pk_bf16_f32 v207, v208, v209
    v_mfma_f32_16x16x32_bf16 v[198:201], a[240:243], v[126:129], 0
    v_pk_fma_f16 v145, v121, v177, v145
    v_pk_mul_f16 v144, v138, v182
    v_mfma_f32_16x16x32_bf16 v[198:201], a[244:247], v[218:221], v[198:201]
    v_pk_fma_f16 v144, v139, v183, v144
    v_pk_fma_f16 v144, v140, v184, v144
    v_mfma_f32_16x16x32_bf16 v[198:201], a[248:251], v[222:225], v[198:201]
    v_fma_f32 v255, v178, v178, s33
    v_fmac_f32 v255, v179, v179
    v_mfma_f32_16x16x32_bf16 v[198:201], a[252:255], v[230:233], v[198:201]
    buffer_store_dwordx2 v[134:135], v19, s[48:51], 0 offen nt
    v_fmac_f32 v255, v180, v180
    v_fmac_f32 v255, v181, v181
    v_mfma_f32_16x16x32_bf16 v[198:201], v[82:85], v[234:237], v[198:201]
    v_pk_fma_f16 v144, v141, v185, v144
    v_pk_fma_f16 v144, v118, v174, v144
    v_mfma_f32_16x16x32_bf16 v[198:201], v[86:89], v[130:133], v[198:201]
    v_pk_fma_f16 v144, v119, v175, v144
    v_cvt_pk_bf16_f32 v134, v190, v191
    v_mfma_f32_16x16x32_bf16 v[226:229], a[104:107], v[186:189], v[226:229]
    v_cvt_pk_bf16_f32 v135, v192, v193
    v_cvt_pk_bf16_f32 v150, v150, v151
    v_mfma_f32_16x16x32_f16 v[190:193], v[40:43], v[142:145], 0
    v_cvt_pk_bf16_f32 v151, v152, v153
    v_cvt_pk_bf16_f32 v142, v210, v211
    v_mfma_f32_16x16x32_bf16 v[238:241], v[90:93], v[126:129], 0
    v_fmac_f32 v255, v198, v198
    v_fmac_f32 v255, v199, v199
    v_mfma_f32_16x16x32_bf16 v[238:241], v[94:97], v[218:221], v[238:241]
    v_fmac_f32 v255, v200, v200
    v_fmac_f32 v255, v201, v201
    v_mfma_f32_16x16x32_bf16 v[238:241], v[98:101], v[222:225], v[238:241]
    v_rsq_f32 v190, v190
    v_mfma_f32_16x16x32_bf16 v[238:241], v[102:105], v[230:233], v[238:241]
    v_rsq_f32 v191, v191
    v_mfma_f32_16x16x32_bf16 v[238:241], v[106:109], v[234:237], v[238:241]
    v_mul_f32 v152, s31, v190
    v_cvt_pk_f16_f32 v153, v152, v191
    v_mfma_f32_16x16x32_bf16 v[238:241], v[110:113], v[130:133], v[238:241]
    v_cvt_pk_bf16_f32 v143, v212, v213
    v_fma_f32 v192, v192, v152, v22
    v_mfma_f32_16x16x32_bf16 v[226:229], a[108:111], v[194:197], v[226:229]
    v_fmac_f32_dpp v254, v193, v191 quad_perm:[0,1,2,3] row_mask:0x1 bank_mask:0xf
    v_pk_mul_f16 v146, v146, v153 op_sel:[0,1] op_sel_hi:[1,1]
    v_mfma_f32_16x16x32_bf16 v[226:229], a[112:115], v[122:125], v[226:229]
    v_pk_mul_f16 v147, v147, v153 op_sel:[0,1] op_sel_hi:[1,1]
    v_pk_mul_f16 v148, v148, v153 op_sel:[0,1] op_sel_hi:[1,1]
    v_mfma_f32_16x16x32_bf16 v[226:229], a[116:119], v[202:205], v[226:229]
    ds_read_b128 v[126:129], v2 offset:6144
    ds_read_b128 v[130:133], v2 offset:7168
    v_mfma_f32_16x16x32_bf16 v[210:213], a[120:123], v[162:165], 0
    ds_read_b128 v[218:221], v2 offset:8192
    ds_read_b128 v[222:225], v2 offset:9216
    v_mfma_f32_16x16x32_bf16 v[210:213], a[124:127], v[166:169], v[210:213]
    v_fmac_f32 v255, v238, v238
    v_fmac_f32 v255, v239, v239
    v_mfma_f32_16x16x32_bf16 v[210:213], a[128:131], v[186:189], v[210:213]
    ds_read_b128 v[230:233], v2 offset:10240
    buffer_store_dwordx4 v[114:117], v15, s[48:51], 0 offen nt
    ds_read_b128 v[234:237], v2 offset:11264
    v_fmac_f32 v255, v240, v240
    v_fmac_f32 v255, v241, v241
    v_pk_mul_f16 v149, v149, v153 op_sel:[0,1] op_sel_hi:[1,1]
    v_mfma_f32_16x16x32_bf16 v[210:213], a[132:135], v[194:197], v[210:213]
    v_pk_mul_f16 v120, v120, v153 op_sel:[0,1] op_sel_hi:[1,1]
    v_pk_mul_f16 v121, v121, v153 op_sel:[0,1] op_sel_hi:[1,1]
    v_mfma_f32_16x16x32_bf16 v[210:213], a[136:139], v[122:125], v[210:213]
    v_pk_mul_f16 v138, v138, v153 op_sel:[0,0] op_sel_hi:[1,0]
    v_pk_mul_f16 v139, v139, v153 op_sel:[0,0] op_sel_hi:[1,0]
    v_mfma_f32_16x16x32_bf16 v[210:213], a[140:143], v[202:205], v[210:213]
    v_pk_mul_f16 v140, v140, v153 op_sel:[0,0] op_sel_hi:[1,0]
    v_pk_mul_f16 v141, v141, v153 op_sel:[0,0] op_sel_hi:[1,0]
    v_pk_mul_f16 v118, v118, v153 op_sel:[0,0] op_sel_hi:[1,0]
    v_pk_mul_f16 v119, v119, v153 op_sel:[0,0] op_sel_hi:[1,0]
    v_mfma_f32_16x16x32_bf16 v[114:117], a[0:3], v[162:165], 0
    s_waitcnt lgkmcnt(2)
    v_max3_u32 v44, v44, v190, v191
    v_cvt_pk_f16_f32 v214, v214, v215
    v_mfma_f32_16x16x32_bf16 v[114:117], a[4:7], v[166:169], v[114:117]
    v_pk_mul_f16 v247, v214, v214
    v_cvt_pk_f16_f32 v215, v216, v217
    v_mfma_f32_16x16x32_bf16 v[114:117], a[8:11], v[186:189], v[114:117]
    s_waitcnt lgkmcnt(1)
    v_pk_fma_f16 v247, v215, v215, v247
    v_cvt_pk_f16_f32 v216, v226, v227
    v_mfma_f32_16x16x32_bf16 v[250:253], a[216:219], v[126:129], 0
    s_waitcnt lgkmcnt(0)
    v_pk_fma_f16 v247, v216, v216, v247
    v_cvt_pk_f16_f32 v217, v228, v229
    v_mfma_f32_16x16x32_bf16 v[250:253], a[220:223], v[130:133], v[250:253]
    v_pk_fma_f16 v247, v217, v217, v247
    v_cvt_pk_f16_f32 v208, v210, v211
    v_mfma_f32_16x16x32_bf16 v[250:253], a[224:227], v[218:221], v[250:253]
    v_pk_fma_f16 v247, v208, v208, v247
    v_cvt_pk_f16_f32 v209, v212, v213
    v_mfma_f32_16x16x32_bf16 v[250:253], a[228:231], v[222:225], v[250:253]
    v_pk_fma_f16 v247, v209, v209, v247
    v_pk_mul_f16 v249, v214, v170
    v_mfma_f32_16x16x32_bf16 v[250:253], a[232:235], v[230:233], v[250:253]
    v_pk_fma_f16 v249, v215, v171, v249
    v_pk_fma_f16 v249, v216, v172, v249
    v_mfma_f32_16x16x32_bf16 v[250:253], a[236:239], v[234:237], v[250:253]
    v_pk_fma_f16 v249, v217, v173, v249
    v_pk_fma_f16 v249, v208, v176, v249
    v_mfma_f32_16x16x32_bf16 v[114:117], a[12:15], v[194:197], v[114:117]
    v_pk_fma_f16 v249, v209, v177, v249
    v_mul_f32 v136, 0x3baaaaab, v136
    v_mfma_f32_16x16x32_bf16 v[114:117], a[16:19], v[122:125], v[114:117]
    v_rsq_f32 v136, v136
    v_mfma_f32_16x16x32_bf16 v[114:117], a[20:23], v[202:205], v[114:117]
    buffer_store_dwordx2 v[206:207], v18, s[48:51], 0 offen nt
    v_fma_f32 v137, v250, v250, s33
    v_fmac_f32 v137, v251, v251
    v_fmac_f32 v137, v252, v252
    v_fmac_f32 v137, v253, v253
    v_mul_f32 v242, v136, v242
    v_mul_f32 v243, v136, v243
    v_cvt_pk_bf16_f32 v210, v242, v243
    v_mfma_f32_16x16x32_bf16 v[226:229], a[240:243], v[126:129], 0
    v_cvt_pk_f16_f32 v114, v114, v115
    v_pk_mul_f16 v246, v114, v114
    v_mfma_f32_16x16x32_bf16 v[226:229], a[244:247], v[130:133], v[226:229]
    v_cvt_pk_f16_f32 v115, v116, v117
    v_pk_fma_f16 v246, v115, v115, v246
    v_mfma_f32_16x16x32_bf16 v[226:229], a[248:251], v[218:221], v[226:229]
    v_pk_mul_f16 v248, v114, v182
    v_pk_fma_f16 v248, v115, v183, v248
    v_mfma_f32_16x16x32_bf16 v[226:229], a[252:255], v[222:225], v[226:229]
    v_mul_f32 v244, v136, v244
    v_mul_f32 v245, v136, v245
    v_mfma_f32_16x16x32_bf16 v[226:229], v[82:85], v[230:233], v[226:229]
    v_cvt_pk_bf16_f32 v211, v244, v245
    v_mul_f32 v158, v136, v158
    v_mfma_f32_16x16x32_bf16 v[226:229], v[86:89], v[234:237], v[226:229]
    v_mul_f32 v159, v136, v159
    v_cvt_pk_bf16_f32 v212, v158, v159
    v_mul_f32 v160, v136, v160
    v_mul_f32 v161, v136, v161
    v_cvt_pk_bf16_f32 v213, v160, v161
    v_mul_f32 v154, v136, v154
    v_mul_f32 v155, v136, v155
    v_cvt_pk_bf16_f32 v144, v154, v155
    v_mfma_f32_16x16x32_bf16 v[158:161], v[90:93], v[126:129], 0
    v_fmac_f32 v137, v226, v226
    v_fmac_f32 v137, v227, v227
    v_mfma_f32_16x16x32_bf16 v[158:161], v[94:97], v[130:133], v[158:161]
    v_fmac_f32 v137, v228, v228
    v_fmac_f32 v137, v229, v229
    v_mfma_f32_16x16x32_bf16 v[158:161], v[98:101], v[218:221], v[158:161]
    v_mul_f32 v156, v136, v156
    v_mul_f32 v157, v136, v157
    v_mfma_f32_16x16x32_bf16 v[158:161], v[102:105], v[222:225], v[158:161]
    v_cvt_pk_bf16_f32 v145, v156, v157
    v_bfe_u32 v190, v2, 4, 6
    v_mfma_f32_16x16x32_bf16 v[158:161], v[106:109], v[230:233], v[158:161]
    v_lshrrev_b32 v191, 4, v190
    v_and_b32 v193, 15, v190
    v_mfma_f32_16x16x32_bf16 v[158:161], v[110:113], v[234:237], v[158:161]
    v_lshlrev_b32 v126, 9, v191
    v_lshl_add_u32 v126, v193, 4, v126
    v_mfma_f32_16x16x32_bf16 v[130:133], a[24:27], v[162:165], 0
    buffer_store_dwordx4 v[210:213], v17, s[48:51], 0 offen nt
    v_add_u32 v126, 149696, v126
    v_and_b32 v127, 0xffff, v2
    v_add_u32 v127, 38912, v127
    v_and_b32 v128, 0xffff, v4
    v_mfma_f32_16x16x32_bf16 v[130:133], a[28:31], v[166:169], v[130:133]
    v_fmac_f32 v137, v158, v158
    v_fmac_f32 v137, v159, v159
    v_mfma_f32_16x16x32_bf16 v[130:133], a[32:35], v[186:189], v[130:133]
    v_fmac_f32 v137, v160, v160
    v_fmac_f32 v137, v161, v161
    v_mfma_f32_16x16x32_bf16 v[130:133], a[36:39], v[194:197], v[130:133]
    v_cvt_pk_bf16_f32 v136, v255, v137
    v_cvt_pk_bf16_f32 v137, v137, v137
    v_mfma_f32_16x16x32_bf16 v[130:133], a[40:43], v[122:125], v[130:133]
    v_add_u32 v128, 38912, v128
    v_mov_b32 v129, 0x40000000
    v_mfma_f32_16x16x32_bf16 v[130:133], a[44:47], v[202:205], v[130:133]
    ds_write_b64 v128, v[136:137] offset:0
    v_mfma_f32_16x16x32_bf16 v[154:157], a[48:51], v[162:165], 0
    v_exp_f32 v192, v192
    v_mfma_f32_16x16x32_bf16 v[154:157], a[52:55], v[166:169], v[154:157]
    v_cvt_pk_bf16_f32 v39, v192, 0
    v_add_u32 v192, 0, v193
    v_mfma_f32_16x16x32_bf16 v[154:157], a[56:59], v[186:189], v[154:157]
    v_mul_u32_u24 v255, s20, v192
    v_cvt_pk_f16_f32 v116, v130, v131
    v_mfma_f32_16x16x32_bf16 v[154:157], a[60:63], v[194:197], v[154:157]
    v_pk_fma_f16 v246, v116, v116, v246
    v_cvt_pk_f16_f32 v117, v132, v133
    v_mfma_f32_16x16x32_bf16 v[154:157], a[64:67], v[122:125], v[154:157]
    v_pk_fma_f16 v246, v117, v117, v246
    v_pk_fma_f16 v248, v116, v184, v248
    v_mfma_f32_16x16x32_bf16 v[154:157], a[68:71], v[202:205], v[154:157]
    v_pk_fma_f16 v248, v117, v185, v248
    v_add_u32 v255, s38, v255
    v_mfma_f32_16x16x32_bf16 v[130:133], v[162:165], a[144:147], 0
    s_waitcnt lgkmcnt(0)
    v_mul_u32_u24 v136, 911, v255
    v_lshrrev_b32 v136, 16, v136
    v_mfma_f32_16x16x32_bf16 v[130:133], v[166:169], a[148:151], v[130:133]
    s_barrier
    ds_read_b128 v[210:213], v127 offset:0
    ds_read_b128 v[218:221], v127 offset:1024
    v_mfma_f32_16x16x32_bf16 v[130:133], v[186:189], a[152:155], v[130:133]
    v_cvt_pk_f16_f32 v206, v154, v155
    v_pk_fma_f16 v246, v206, v206, v246
    v_mfma_f32_16x16x32_bf16 v[130:133], v[194:197], a[156:159], v[130:133]
    buffer_store_dwordx2 v[144:145], v20, s[48:51], 0 offen nt
    v_cvt_pk_f16_f32 v207, v156, v157
    v_pk_fma_f16 v246, v207, v207, v246
    v_mfma_f32_16x16x32_bf16 v[130:133], v[122:125], a[160:163], v[130:133]
    v_pk_fma_f16 v248, v206, v174, v248
    v_pk_fma_f16 v248, v207, v175, v248
    v_mfma_f32_16x16x32_bf16 v[130:133], v[202:205], a[164:167], v[130:133]
    v_mul_u32_u24 v136, s22, v136
    v_mad_u32_u24 v136, v192, s21, v136
    v_mfma_f32_16x16x32_f16 v[154:157], v[40:43], v[246:249], 0
    v_bfe_u32 v255, s70, v192, 1
    v_cmp_ne_u32 vcc, 0, v255
    v_mfma_f32_16x16x32_bf16 v[222:225], v[162:165], a[168:171], 0
    v_add_u32 v192, s7, v136
    v_cndmask_b32 v192, v129, v192, vcc
    v_mfma_f32_16x16x32_bf16 v[222:225], v[166:169], a[172:175], v[222:225]
    s_waitcnt lgkmcnt(1)
    v_cvt_pk_bf16_f32 v136, v130, v131
    v_cvt_pk_bf16_f32 v137, v132, v133
    v_mfma_f32_16x16x32_bf16 v[130:133], v[32:35], v[210:213], 0
    s_waitcnt lgkmcnt(0)
    v_rsq_f32 v154, v154
    v_mfma_f32_16x16x32_bf16 v[130:133], v[32:35], v[218:221], v[130:133]
    v_rsq_f32 v155, v155
    v_mfma_f32_16x16x32_bf16 v[222:225], v[186:189], a[176:179], v[222:225]
    v_mul_f32 v210, s31, v154
    v_cvt_pk_f16_f32 v211, v210, v155
    v_mfma_f32_16x16x32_bf16 v[222:225], v[194:197], a[180:183], v[222:225]
    v_fma_f32 v156, v156, v210, v24
    v_fmac_f32_dpp v254, v157, v155 quad_perm:[0,1,2,3] row_mask:0x2 bank_mask:0xf
    v_mfma_f32_16x16x32_bf16 v[222:225], v[122:125], a[184:187], v[222:225]
    ds_read_b128 v[218:221], v0 offset:32768
    v_mul_f32 v157, 0x3baaaaab, v131
    v_mfma_f32_16x16x32_bf16 v[222:225], v[202:205], a[188:191], v[222:225]
    ds_read_b128 v[230:233], v1 offset:32768
    v_pk_mul_f16 v214, v214, v211 op_sel:[0,1] op_sel_hi:[1,1]
    v_mfma_f32_16x16x32_bf16 v[234:237], v[162:165], a[192:195], 0
    ds_read_b128 v[162:165], v0 offset:32896
    v_pk_mul_f16 v215, v215, v211 op_sel:[0,1] op_sel_hi:[1,1]
    v_mfma_f32_16x16x32_bf16 v[234:237], v[166:169], a[196:199], v[234:237]
    ds_read_b128 v[166:169], v1 offset:32896
    v_pk_mul_f16 v216, v216, v211 op_sel:[0,1] op_sel_hi:[1,1]
    v_mfma_f32_16x16x32_bf16 v[234:237], v[186:189], a[200:203], v[234:237]
    ds_read_b128 v[186:189], v0 offset:33024
    v_cvt_pk_bf16_f32 v152, v222, v223
    v_mfma_f32_16x16x32_bf16 v[234:237], v[194:197], a[204:207], v[234:237]
    ds_read_b128 v[194:197], v1 offset:33024
    v_cvt_pk_bf16_f32 v153, v224, v225
    v_mfma_f32_16x16x32_bf16 v[234:237], v[122:125], a[208:211], v[234:237]
    v_rsq_f32 v157, v157
    v_mfma_f32_16x16x32_bf16 v[234:237], v[202:205], a[212:215], v[234:237]
    v_mul_f32 v250, v157, v250
    v_mul_f32 v251, v157, v251
    v_mfma_f32_16x16x32_f16 v[122:125], v[146:149], v[138:141], v[46:49]
    s_waitcnt lgkmcnt(5)
    v_cvt_pk_bf16_f32 v202, v250, v251
    v_mul_f32 v252, v157, v252
    v_mfma_f32_16x16x32_bf16 v[222:225], a[72:75], v[218:221], 0
    s_waitcnt lgkmcnt(4)
    v_mul_f32 v253, v157, v253
    v_cvt_pk_bf16_f32 v203, v252, v253
    v_mfma_f32_16x16x32_bf16 v[222:225], a[76:79], v[230:233], v[222:225]
    s_waitcnt lgkmcnt(3)
    v_mul_f32 v226, v157, v226
    v_mul_f32 v227, v157, v227
    v_mfma_f32_16x16x32_bf16 v[222:225], a[80:83], v[162:165], v[222:225]
    s_waitcnt lgkmcnt(2)
    v_cvt_pk_bf16_f32 v204, v226, v227
    v_mul_f32 v228, v157, v228
    v_mfma_f32_16x16x32_bf16 v[222:225], a[84:87], v[166:169], v[222:225]
    s_waitcnt lgkmcnt(1)
    v_mul_f32 v229, v157, v229
    v_cvt_pk_bf16_f32 v205, v228, v229
    v_mfma_f32_16x16x32_bf16 v[222:225], a[88:91], v[186:189], v[222:225]
    s_waitcnt lgkmcnt(0)
    buffer_store_dwordx4 v[202:205], v16, s[52:55], 0 offen nt
    v_mul_f32 v158, v157, v158
    v_mul_f32 v159, v157, v159
    v_cvt_pk_bf16_f32 v132, v158, v159
    v_mul_f32 v160, v157, v160
    v_mfma_f32_16x16x32_bf16 v[222:225], a[92:95], v[194:197], v[222:225]
    v_mul_f32 v161, v157, v161
    v_cvt_pk_bf16_f32 v133, v160, v161
    v_mfma_f32_16x16x32_bf16 v[158:161], a[96:99], v[218:221], 0
    v_cvt_pk_bf16_f32 v144, v234, v235
    v_cvt_pk_bf16_f32 v145, v236, v237
    v_mfma_f32_16x16x32_bf16 v[158:161], a[100:103], v[230:233], v[158:161]
    v_pk_mul_f16 v217, v217, v211 op_sel:[0,1] op_sel_hi:[1,1]
    v_pk_mul_f16 v208, v208, v211 op_sel:[0,1] op_sel_hi:[1,1]
    v_mfma_f32_16x16x32_bf16 v[158:161], a[104:107], v[162:165], v[158:161]
    v_pk_mul_f16 v209, v209, v211 op_sel:[0,1] op_sel_hi:[1,1]
    v_pk_mul_f16 v114, v114, v211 op_sel:[0,0] op_sel_hi:[1,0]
    v_mfma_f32_16x16x32_bf16 v[158:161], a[108:111], v[166:169], v[158:161]
    v_pk_mul_f16 v115, v115, v211 op_sel:[0,0] op_sel_hi:[1,0]
    v_pk_mul_f16 v116, v116, v211 op_sel:[0,0] op_sel_hi:[1,0]
    v_mfma_f32_16x16x32_bf16 v[158:161], a[112:115], v[186:189], v[158:161]
    v_pk_mul_f16 v117, v117, v211 op_sel:[0,0] op_sel_hi:[1,0]
    v_pk_mul_f16 v206, v206, v211 op_sel:[0,0] op_sel_hi:[1,0]
    v_mfma_f32_16x16x32_bf16 v[158:161], a[116:119], v[194:197], v[158:161]
    v_pk_mul_f16 v207, v207, v211 op_sel:[0,0] op_sel_hi:[1,0]
    v_max3_u32 v44, v44, v154, v155
    v_mfma_f32_16x16x32_bf16 v[202:205], a[120:123], v[218:221], 0
    v_mul_f32 v255, 0x3baaaaab, v130
    v_cvt_pk_f16_f32 v130, v222, v223
    v_mfma_f32_16x16x32_bf16 v[202:205], a[124:127], v[230:233], v[202:205]
    v_rsq_f32 v255, v255
    v_mfma_f32_16x16x32_bf16 v[202:205], a[128:131], v[162:165], v[202:205]
    v_mul_f32 v178, v255, v178
    v_mul_f32 v179, v255, v179
    v_mfma_f32_16x16x32_bf16 v[202:205], a[132:135], v[166:169], v[202:205]
    v_cvt_pk_bf16_f32 v178, v178, v179
    v_mul_f32 v180, v255, v180
    v_mfma_f32_16x16x32_bf16 v[202:205], a[136:139], v[186:189], v[202:205]
    v_mul_f32 v181, v255, v181
    v_cvt_pk_bf16_f32 v179, v180, v181
    v_mfma_f32_16x16x32_bf16 v[202:205], a[140:143], v[194:197], v[202:205]
    v_mul_f32 v198, v255, v198
    v_mul_f32 v199, v255, v199
    v_mfma_f32_16x16x32_bf16 v[210:213], a[0:3], v[218:221], 0
    v_cvt_pk_bf16_f32 v180, v198, v199
    v_mul_f32 v200, v255, v200
    v_mfma_f32_16x16x32_bf16 v[210:213], a[4:7], v[230:233], v[210:213]
    v_mul_f32 v201, v255, v201
    v_cvt_pk_bf16_f32 v181, v200, v201
    v_mfma_f32_16x16x32_bf16 v[210:213], a[8:11], v[162:165], v[210:213]
    buffer_store_dwordx2 v[132:133], v19, s[52:55], 0 offen nt
    v_mul_f32 v238, v255, v238
    v_mul_f32 v239, v255, v239
    v_mfma_f32_16x16x32_bf16 v[210:213], a[12:15], v[166:169], v[210:213]
    v_cvt_pk_bf16_f32 v154, v238, v239
    v_mul_f32 v240, v255, v240
    v_mfma_f32_16x16x32_bf16 v[210:213], a[16:19], v[186:189], v[210:213]
    v_mul_f32 v241, v255, v241
    v_cvt_pk_bf16_f32 v155, v240, v241
    v_mfma_f32_16x16x32_bf16 v[210:213], a[20:23], v[194:197], v[210:213]
    v_pk_mul_f16 v199, v130, v130
    v_cvt_pk_f16_f32 v131, v224, v225
    v_mfma_f32_16x16x32_bf16 v[222:225], a[24:27], v[218:221], 0
    v_pk_fma_f16 v199, v131, v131, v199
    v_cvt_pk_f16_f32 v132, v158, v159
    v_mfma_f32_16x16x32_f16 v[226:229], v[214:217], v[138:141], v[50:53]
    v_pk_fma_f16 v199, v132, v132, v199
    v_cvt_pk_f16_f32 v133, v160, v161
    v_cvt_pk_f16_f32 v158, v210, v211
    v_mfma_f32_16x16x16_f16 v[122:125], v[120:121], v[118:119], v[122:125]
    v_pk_mul_f16 v198, v158, v158
    v_cvt_pk_f16_f32 v159, v212, v213
    v_pk_fma_f16 v198, v159, v159, v198
    v_mfma_f32_16x16x16_f16 v[226:229], v[208:209], v[118:119], v[226:229]
    v_pk_mul_f16 v200, v158, v182
    v_pk_fma_f16 v200, v159, v183, v200
    v_pk_fma_f16 v199, v133, v133, v199
    v_cvt_pk_f16_f32 v212, v202, v203
    v_mfma_f32_16x16x32_bf16 v[222:225], a[28:31], v[230:233], v[222:225]
    v_pk_fma_f16 v199, v212, v212, v199
    v_cvt_pk_f16_f32 v213, v204, v205
    v_mfma_f32_16x16x32_bf16 v[222:225], a[32:35], v[162:165], v[222:225]
    v_pk_fma_f16 v199, v213, v213, v199
    v_pk_mul_f16 v201, v130, v170
    v_mfma_f32_16x16x32_bf16 v[222:225], a[36:39], v[166:169], v[222:225]
    v_pk_fma_f16 v201, v131, v171, v201
    v_pk_fma_f16 v201, v132, v172, v201
    v_mfma_f32_16x16x32_bf16 v[222:225], a[40:43], v[186:189], v[222:225]
    v_pk_fma_f16 v201, v133, v173, v201
    v_pk_fma_f16 v201, v212, v176, v201
    v_mfma_f32_16x16x32_bf16 v[222:225], a[44:47], v[194:197], v[222:225]
    v_pk_fma_f16 v201, v213, v177, v201
    v_lshl_add_u32 v255, v191, 4, v192
    v_mfma_f32_16x16x32_bf16 v[170:173], a[48:51], v[218:221], 0
    v_exp_f32 v122, v122
    v_mfma_f32_16x16x32_bf16 v[170:173], a[52:55], v[230:233], v[170:173]
    v_exp_f32 v123, v123
    v_mfma_f32_16x16x32_bf16 v[170:173], a[56:59], v[162:165], v[170:173]
    v_cvt_pk_bf16_f32 v122, v122, v123
    v_cvt_pk_f16_f32 v160, v222, v223
    v_mfma_f32_16x16x32_bf16 v[170:173], a[60:63], v[166:169], v[170:173]
    buffer_store_dwordx4 v[178:181], v15, s[52:55], 0 offen nt
    v_pk_fma_f16 v198, v160, v160, v198
    v_cvt_pk_f16_f32 v161, v224, v225
    v_pk_fma_f16 v198, v161, v161, v198
    v_pk_fma_f16 v200, v160, v184, v200
    v_mfma_f32_16x16x32_bf16 v[170:173], a[64:67], v[186:189], v[170:173]
    v_pk_fma_f16 v200, v161, v185, v200
    v_add_u32 v255, s3, v255
    v_mfma_f32_16x16x32_bf16 v[170:173], a[68:71], v[194:197], v[170:173]
    ds_read2_b32 v[176:177], v6 offset0:0 offset1:0
    ds_read2_b32 v[180:181], v6 offset0:16 offset1:16
    v_mfma_f32_16x16x32_bf16 v[182:185], v[218:221], a[144:147], 0
    ds_read2_b32 v[204:205], v6 offset0:32 offset1:32
    v_lshl_add_u32 v192, v191, 3, v192
    v_mfma_f32_16x16x32_bf16 v[182:185], v[230:233], a[148:151], v[182:185]
    v_exp_f32 v124, v124
    v_mfma_f32_16x16x32_bf16 v[182:185], v[162:165], a[152:155], v[182:185]
    v_cvt_pk_f16_f32 v210, v170, v171
    v_pk_fma_f16 v198, v210, v210, v198
    v_mfma_f32_16x16x32_bf16 v[182:185], v[166:169], a[156:159], v[182:185]
    v_cvt_pk_f16_f32 v211, v172, v173
    v_pk_fma_f16 v198, v211, v211, v198
    v_mfma_f32_16x16x32_bf16 v[182:185], v[186:189], a[160:163], v[182:185]
    v_pk_fma_f16 v200, v210, v174, v200
    v_pk_fma_f16 v200, v211, v175, v200
    v_mfma_f32_16x16x32_bf16 v[182:185], v[194:197], a[164:167], v[182:185]
    v_exp_f32 v125, v125
    v_mfma_f32_16x16x32_f16 v[170:173], v[40:43], v[198:201], 0
    v_cvt_pk_bf16_f32 v123, v124, v125
    v_add_u32 v192, s4, v192
    v_mfma_f32_16x16x32_bf16 v[198:201], v[218:221], a[168:171], 0
    s_waitcnt lgkmcnt(1)
    v_exp_f32 v226, v226
    v_mfma_f32_16x16x32_bf16 v[198:201], v[230:233], a[172:175], v[198:201]
    s_waitcnt lgkmcnt(0)
    v_cvt_pk_bf16_f32 v174, v182, v183
    v_cvt_pk_bf16_f32 v175, v184, v185
    v_mfma_f32_16x16x32_bf16 v[198:201], v[162:165], a[176:179], v[198:201]
    v_rsq_f32 v170, v170
    v_mfma_f32_16x16x32_bf16 v[198:201], v[166:169], a[180:183], v[198:201]
    ds_read_b128 v[182:185], v2 offset:12288
    ds_read_b128 v[222:225], v2 offset:13312
    v_mfma_f32_16x16x32_bf16 v[198:201], v[186:189], a[184:187], v[198:201]
    ds_read_b128 v[234:237], v2 offset:14336
    ds_read_b128 v[238:241], v2 offset:15360
    v_mfma_f32_16x16x32_bf16 v[198:201], v[194:197], a[188:191], v[198:201]
    buffer_store_dwordx2 v[154:155], v18, s[52:55], 0 offen nt
    ds_read_b128 v[242:245], v2 offset:16384
    v_rsq_f32 v171, v171
    v_mul_f32 v124, s31, v170
    v_cvt_pk_f16_f32 v125, v124, v171
    v_fma_f32 v172, v172, v124, v26
    v_fmac_f32_dpp v254, v173, v171 quad_perm:[0,1,2,3] row_mask:0x4 bank_mask:0xf
    v_pk_mul_f16 v130, v130, v125 op_sel:[0,1] op_sel_hi:[1,1]
    v_cvt_pk_bf16_f32 v178, v198, v199
    v_cvt_pk_bf16_f32 v179, v200, v201
    v_pk_mul_f16 v131, v131, v125 op_sel:[0,1] op_sel_hi:[1,1]
    v_pk_mul_f16 v132, v132, v125 op_sel:[0,1] op_sel_hi:[1,1]
    v_pk_mul_f16 v133, v133, v125 op_sel:[0,1] op_sel_hi:[1,1]
    v_pk_mul_f16 v212, v212, v125 op_sel:[0,1] op_sel_hi:[1,1]
    v_pk_mul_f16 v213, v213, v125 op_sel:[0,1] op_sel_hi:[1,1]
    v_pk_mul_f16 v158, v158, v125 op_sel:[0,0] op_sel_hi:[1,0]
    v_pk_mul_f16 v159, v159, v125 op_sel:[0,0] op_sel_hi:[1,0]
    v_pk_mul_f16 v160, v160, v125 op_sel:[0,0] op_sel_hi:[1,0]
    v_pk_mul_f16 v161, v161, v125 op_sel:[0,0] op_sel_hi:[1,0]
    v_pk_mul_f16 v210, v210, v125 op_sel:[0,0] op_sel_hi:[1,0]
    v_pk_mul_f16 v211, v211, v125 op_sel:[0,0] op_sel_hi:[1,0]
    v_mfma_f32_16x16x32_f16 v[198:201], v[130:133], v[138:141], v[54:57]
    s_waitcnt lgkmcnt(2)
    ds_read_b128 v[138:141], v2 offset:17408
    v_max3_u32 v44, v44, v170, v171
    v_exp_f32 v227, v227
    v_exp_f32 v228, v228
    v_cvt_pk_bf16_f32 v124, v226, v227
    v_mfma_f32_16x16x16_f16 v[198:201], v[212:213], v[118:119], v[198:201]
    v_exp_f32 v229, v229
    v_sub_u32 v170, 0x40800000, v44
    v_cvt_pk_bf16_f32 v125, v228, v229
    v_mfma_f32_16x16x32_bf16 v[226:229], v[218:221], a[192:195], 0
    s_waitcnt lgkmcnt(1)
    v_or_b32 v170, v170, v44
    v_xor_b32 v171, 65536, v2
    v_mfma_f32_16x16x32_bf16 v[226:229], v[230:233], a[196:199], v[226:229]
    v_exp_f32 v198, v198
    v_mfma_f32_16x16x32_bf16 v[226:229], v[162:165], a[200:203], v[226:229]
    v_exp_f32 v199, v199
    v_mfma_f32_16x16x32_bf16 v[226:229], v[166:169], a[204:207], v[226:229]
    v_cvt_pk_bf16_f32 v36, v198, v199
    v_bfe_u32 v173, v193, 1, 2
    v_mfma_f32_16x16x32_bf16 v[226:229], v[186:189], a[208:211], v[226:229]
    s_waitcnt lgkmcnt(0)
    v_exp_f32 v200, v200
    v_mfma_f32_16x16x32_bf16 v[226:229], v[194:197], a[212:215], v[226:229]
    v_exp_f32 v201, v201
    v_mfma_f32_16x16x32_f16 v[162:165], v[146:149], v[114:117], v[58:61]
    v_cvt_pk_bf16_f32 v37, v200, v201
    v_xor_b32 v173, v173, v191
    v_mfma_f32_16x16x32_f16 v[166:169], v[214:217], v[114:117], v[62:65]
    v_exp_f32 v254, v254
    v_mfma_f32_16x16x32_bf16 v[186:189], v[28:31], v[36:39], 0
    v_cvt_pk_bf16_f32 v254, v254, v254
    v_cvt_pk_bf16_f32 v202, v226, v227
    v_mfma_f32_16x16x32_bf16 v[186:189], v[28:31], v[122:125], v[186:189]
    ds_write_b16 v8, v254
    v_mfma_f32_16x16x32_bf16 v[194:197], v[174:177], v[36:39], 0
    v_cvt_pk_bf16_f32 v203, v228, v229
    v_lshl_add_u32 v173, v193, 2, v173
    v_mfma_f32_16x16x32_bf16 v[194:197], v[134:137], v[122:125], v[194:197]
    ds_read_b128 v[198:201], v9
    ds_read_b128 v[218:221], v9 offset:64
    v_mfma_f32_16x16x32_bf16 v[226:229], v[178:181], v[36:39], 0
    v_exp_f32 v156, v156
    v_mfma_f32_16x16x32_bf16 v[226:229], v[150:153], v[122:125], v[226:229]
    v_exp_f32 v172, v172
    v_mfma_f32_16x16x32_bf16 v[230:233], v[202:205], v[36:39], 0
    v_cvt_pk_bf16_f32 v39, v156, 0
    v_lshl_add_u32 v254, v173, 4, s5
    v_mfma_f32_16x16x32_bf16 v[230:233], v[142:145], v[122:125], v[230:233]
    v_rcp_f32 v186, v186
    v_mfma_f32_16x16x32_f16 v[122:125], v[130:133], v[114:117], v[66:69]
    v_max3_u32 v25, v25, v186, v187
    v_mul_f32 v194, v186, v194
    v_mul_f32 v195, v186, v195
    v_mfma_f32_16x16x16_f16 v[162:165], v[120:121], v[206:207], v[162:165]
    v_cvt_pk_bf16_f32 v114, v194, v195
    v_mul_f32 v196, v186, v196
    v_mul_f32 v197, v186, v197
    v_mfma_f32_16x16x16_f16 v[166:169], v[208:209], v[206:207], v[166:169]
    v_cvt_pk_bf16_f32 v115, v196, v197
    v_mul_f32 v226, v186, v226
    v_mul_f32 v227, v186, v227
    v_mfma_f32_16x16x16_f16 v[122:125], v[212:213], v[206:207], v[122:125]
    v_exp_f32 v162, v162
    v_exp_f32 v163, v163
    v_mfma_f32_16x16x32_bf16 v[154:157], a[216:219], v[182:185], 0
    s_waitcnt lgkmcnt(0)
    v_cvt_pk_bf16_f32 v162, v162, v163
    v_cvt_pk_bf16_f32 v116, v226, v227
    v_mfma_f32_16x16x32_bf16 v[154:157], a[220:223], v[222:225], v[154:157]
    v_exp_f32 v164, v164
    v_mfma_f32_16x16x32_bf16 v[154:157], a[224:227], v[234:237], v[154:157]
    v_exp_f32 v165, v165
    v_mfma_f32_16x16x32_bf16 v[154:157], a[228:231], v[238:241], v[154:157]
    v_cvt_pk_bf16_f32 v163, v164, v165
    v_mul_f32 v228, v186, v228
    v_mfma_f32_16x16x32_bf16 v[154:157], a[232:235], v[242:245], v[154:157]
    v_exp_f32 v166, v166
    v_mfma_f32_16x16x32_f16 v[194:197], v[146:149], v[158:161], v[70:73]
    v_exp_f32 v167, v167
    v_mfma_f32_16x16x32_f16 v[146:149], v[214:217], v[158:161], v[74:77]
    v_cvt_pk_bf16_f32 v164, v166, v167
    v_mul_f32 v229, v186, v229
    v_mfma_f32_16x16x32_f16 v[214:217], v[130:133], v[158:161], v[78:81]
    v_exp_f32 v168, v168
    v_cvt_pk_bf16_f32 v117, v228, v229
    v_mfma_f32_16x16x16_f16 v[194:197], v[120:121], v[210:211], v[194:197]
    v_exp_f32 v169, v169
    v_mul_f32 v230, v186, v230
    v_mfma_f32_16x16x16_f16 v[146:149], v[208:209], v[210:211], v[146:149]
    v_cvt_pk_bf16_f32 v165, v168, v169
    v_exp_f32 v122, v122
    v_mfma_f32_16x16x16_f16 v[214:217], v[212:213], v[210:211], v[214:217]
    v_exp_f32 v123, v123
    v_exp_f32 v124, v124
    v_mfma_f32_16x16x32_bf16 v[154:157], a[236:239], v[138:141], v[154:157]
    ds_write_b128 v3, v[114:117] offset:0
    v_mfma_f32_16x16x32_bf16 v[114:117], a[240:243], v[182:185], 0
    v_cvt_pk_bf16_f32 v36, v122, v123
    v_mul_f32 v231, v186, v231
    v_mfma_f32_16x16x32_bf16 v[114:117], a[244:247], v[222:225], v[114:117]
    v_exp_f32 v125, v125
    v_mfma_f32_16x16x32_bf16 v[114:117], a[248:251], v[234:237], v[114:117]
    v_cvt_pk_bf16_f32 v37, v124, v125
    v_fma_f32 v187, v154, v154, s33
    v_mfma_f32_16x16x32_bf16 v[114:117], a[252:255], v[238:241], v[114:117]
    v_fmac_f32 v187, v155, v155
    v_fmac_f32 v187, v156, v156
    v_mfma_f32_16x16x32_bf16 v[118:121], v[28:31], v[36:39], 0
    v_fmac_f32 v187, v157, v157
    v_cvt_pk_bf16_f32 v230, v230, v231
    v_mfma_f32_16x16x32_bf16 v[118:121], v[28:31], v[162:165], v[118:121]
    v_exp_f32 v194, v194
    v_mfma_f32_16x16x32_bf16 v[122:125], v[174:177], v[36:39], 0
    v_exp_f32 v195, v195
    v_mfma_f32_16x16x32_bf16 v[122:125], v[134:137], v[162:165], v[122:125]
    v_cvt_pk_bf16_f32 v130, v194, v195
    v_mul_f32 v232, v186, v232
    v_mfma_f32_16x16x32_bf16 v[158:161], v[178:181], v[36:39], 0
    v_exp_f32 v196, v196
    v_mfma_f32_16x16x32_bf16 v[158:161], v[150:153], v[162:165], v[158:161]
    v_rcp_f32 v118, v118
    v_mfma_f32_16x16x32_bf16 v[166:169], v[202:205], v[36:39], 0
    v_exp_f32 v197, v197
    v_mfma_f32_16x16x32_bf16 v[166:169], v[142:145], v[162:165], v[166:169]
    v_mul_f32 v122, v118, v122
    v_mul_f32 v123, v118, v123
    v_mfma_f32_16x16x32_bf16 v[114:117], v[82:85], v[242:245], v[114:117]
    v_cvt_pk_bf16_f32 v122, v122, v123
    v_mul_f32 v124, v118, v124
    v_mfma_f32_16x16x32_bf16 v[114:117], v[86:89], v[138:141], v[114:117]
    ds_read_b128 v[162:165], v126 offset:0
    v_mul_f32 v125, v118, v125
    v_mfma_f32_16x16x32_bf16 v[206:209], v[90:93], v[182:185], 0
    ds_read_b128 v[182:185], v126 offset:2048
    v_cvt_pk_bf16_f32 v123, v124, v125
    v_mfma_f32_16x16x32_bf16 v[206:209], v[94:97], v[222:225], v[206:209]
    ds_read_b128 v[210:213], v126 offset:4096
    v_mul_f32 v158, v118, v158
    v_mfma_f32_16x16x32_bf16 v[206:209], v[98:101], v[234:237], v[206:209]
    ds_read_b128 v[222:225], v126 offset:6144
    v_fmac_f32 v187, v114, v114
    v_mfma_f32_16x16x32_bf16 v[206:209], v[102:105], v[238:241], v[206:209]
    ds_read_b128 v[226:229], v126 offset:8192
    v_fmac_f32 v187, v115, v115
    v_mfma_f32_16x16x32_bf16 v[206:209], v[106:109], v[242:245], v[206:209]
    ds_read_b128 v[234:237], v126 offset:10240
    v_fmac_f32 v187, v116, v116
    v_mfma_f32_16x16x32_bf16 v[206:209], v[110:113], v[138:141], v[206:209]
    v_fmac_f32 v187, v117, v117
    v_mul_f32 v159, v118, v159
    v_mfma_f32_16x16x32_bf16 v[138:141], v[198:201], v[28:31], 0
    v_cvt_pk_bf16_f32 v124, v158, v159
    v_mul_f32 v160, v118, v160
    v_mfma_f32_16x16x32_bf16 v[138:141], v[218:221], v[28:31], v[138:141]
    s_waitcnt lgkmcnt(5)
    v_mul_f32 v161, v118, v161
    v_fmac_f32 v187, v206, v206
    v_mfma_f32_16x16x32_bf16 v[238:241], a[216:219], v[162:165], 0
    s_waitcnt lgkmcnt(4)
    v_fmac_f32 v187, v207, v207
    v_fmac_f32 v187, v208, v208
    v_mfma_f32_16x16x32_bf16 v[238:241], a[220:223], v[182:185], v[238:241]
    s_waitcnt lgkmcnt(3)
    v_fmac_f32 v187, v209, v209
    v_cvt_pk_bf16_f32 v125, v160, v161
    v_mfma_f32_16x16x32_bf16 v[238:241], a[224:227], v[210:213], v[238:241]
    s_waitcnt lgkmcnt(2)
    ds_write_b128 v3, v[122:125] offset:6144
    v_mfma_f32_16x16x32_bf16 v[238:241], a[228:231], v[222:225], v[238:241]
    s_waitcnt lgkmcnt(1)
    v_mul_f32 v166, v118, v166
    v_mul_f32 v167, v118, v167
    v_mfma_f32_16x16x32_bf16 v[238:241], a[232:235], v[226:229], v[238:241]
    v_cvt_pk_bf16_f32 v120, v166, v167
    v_mul_f32 v168, v118, v168
    v_mfma_f32_16x16x32_bf16 v[238:241], a[236:239], v[234:237], v[238:241]
    v_mul_f32 v169, v118, v169
    v_cvt_pk_bf16_f32 v121, v168, v169
    v_mfma_f32_16x16x32_bf16 v[122:125], a[240:243], v[162:165], 0
    ds_write_b64 v4, v[120:121] offset:10240
    v_mfma_f32_16x16x32_bf16 v[122:125], a[244:247], v[182:185], v[122:125]
    v_rcp_f32 v138, v138
    v_mfma_f32_16x16x32_bf16 v[122:125], a[248:251], v[210:213], v[122:125]
    v_max3_u32 v25, v25, v138, v139
    v_fma_f32 v188, v238, v238, s33
    v_mfma_f32_16x16x32_bf16 v[122:125], a[252:255], v[222:225], v[122:125]
    v_fmac_f32 v188, v239, v239
    v_fmac_f32 v188, v240, v240
    v_mfma_f32_16x16x32_bf16 v[122:125], v[82:85], v[226:229], v[122:125]
    v_fmac_f32 v188, v241, v241
    v_max3_u32 v25, v25, v118, v119
    v_mfma_f32_16x16x32_bf16 v[122:125], v[86:89], v[234:237], v[122:125]
    v_cvt_pk_bf16_f32 v131, v196, v197
    v_cvt_pk_bf16_f32 v39, v172, 0
    v_mfma_f32_16x16x32_bf16 v[118:121], v[90:93], v[162:165], 0
    v_exp_f32 v146, v146
    v_mfma_f32_16x16x32_bf16 v[118:121], v[94:97], v[182:185], v[118:121]
    v_exp_f32 v147, v147
    v_mfma_f32_16x16x32_bf16 v[118:121], v[98:101], v[210:213], v[118:121]
    v_cvt_pk_bf16_f32 v132, v146, v147
    v_fmac_f32 v188, v122, v122
    v_mfma_f32_16x16x32_bf16 v[118:121], v[102:105], v[222:225], v[118:121]
    v_fmac_f32 v188, v123, v123
    v_fmac_f32 v188, v124, v124
    v_mfma_f32_16x16x32_bf16 v[118:121], v[106:109], v[226:229], v[118:121]
    v_fmac_f32 v188, v125, v125
    v_mul_f32 v233, v186, v233
    v_mfma_f32_16x16x32_bf16 v[118:121], v[110:113], v[234:237], v[118:121]
    v_exp_f32 v148, v148
    v_mfma_f32_16x16x32_bf16 v[158:161], v[198:201], v[134:137], 0
    v_exp_f32 v149, v149
    v_mfma_f32_16x16x32_bf16 v[158:161], v[218:221], v[174:177], v[158:161]
    v_cvt_pk_bf16_f32 v133, v148, v149
    v_cvt_pk_bf16_f32 v231, v232, v233
    v_mfma_f32_16x16x32_bf16 v[146:149], v[198:201], v[150:153], 0
    ds_write_b64 v4, v[230:231] offset:4096
    v_mfma_f32_16x16x32_bf16 v[146:149], v[218:221], v[178:181], v[146:149]
    v_fmac_f32 v188, v118, v118
    v_fmac_f32 v188, v119, v119
    v_mfma_f32_16x16x32_bf16 v[162:165], v[198:201], v[142:145], 0
    v_fmac_f32 v188, v120, v120
    v_fmac_f32 v188, v121, v121
    v_mfma_f32_16x16x32_bf16 v[162:165], v[218:221], v[202:205], v[162:165]
    v_cvt_pk_bf16_f32 v140, v187, v188
    v_cvt_pk_bf16_f32 v141, v188, v188
    ds_write_b64 v128, v[140:141] offset:2048
    v_mul_f32 v158, v158, v138
    v_exp_f32 v214, v214
    v_exp_f32 v215, v215
    v_mul_f32_dpp v158, v146, v138 quad_perm:[0,1,2,3] row_mask:0x2 bank_mask:0xf
    v_cvt_pk_bf16_f32 v36, v214, v215
    v_exp_f32 v216, v216
    v_mul_f32_dpp v158, v162, v138 quad_perm:[0,1,2,3] row_mask:0x4 bank_mask:0xf
    v_cvt_pk_bf16_f32 v158, v158, v158
    ds_write_b16 v7, v158
    v_exp_f32 v217, v217
    v_lshl_add_u32 v172, v173, 3, s5
    v_cvt_pk_bf16_f32 v37, v216, v217
    v_lshl_add_u32 v138, v190, 4, s5
    v_lshl_add_u32 v139, v190, 3, s5
    v_mfma_f32_16x16x32_bf16 v[146:149], v[28:31], v[36:39], 0
    v_lshlrev_b32 v173, 2, v173
    v_add_u32 v140, 16, v193
    v_mfma_f32_16x16x32_bf16 v[146:149], v[28:31], v[130:133], v[146:149]
    s_waitcnt lgkmcnt(1)
    ds_permute_b32 v141, v173, v16
    ds_permute_b32 v190, v173, v19
    v_mfma_f32_16x16x32_bf16 v[158:161], v[174:177], v[36:39], 0
    s_barrier
    ds_read_b128 v[162:165], v127 offset:2048
    ds_read_b128 v[166:169], v127 offset:3072
    v_mfma_f32_16x16x32_bf16 v[158:161], v[134:137], v[130:133], v[158:161]
    ds_read_b128 v[134:137], v171 offset:0
    ds_read_b128 v[174:177], v171 offset:1024
    v_mfma_f32_16x16x32_bf16 v[182:185], v[178:181], v[36:39], 0
    v_rcp_f32 v146, v146
    v_mfma_f32_16x16x32_bf16 v[182:185], v[150:153], v[130:133], v[182:185]
    ds_read_b128 v[150:153], v171 offset:2048
    ds_read_b128 v[178:181], v171 offset:3072
    v_mfma_f32_16x16x32_bf16 v[186:189], v[202:205], v[36:39], 0
    v_max3_u32 v25, v25, v146, v147
    v_sub_u32 v193, 0x67800000, v25
    v_mfma_f32_16x16x32_bf16 v[186:189], v[142:145], v[130:133], v[186:189]
    ds_read_b128 v[130:133], v171 offset:4096
    ds_read_b128 v[142:145], v171 offset:5120
    v_or3_b32 v170, v170, v193, v25
    v_lshl_add_u32 v193, s16, 2, v171
    ds_write_b32 v193, v170 offset:18432
    s_waitcnt lgkmcnt(8)
    v_mfma_f32_16x16x32_bf16 v[194:197], v[32:35], v[162:165], 0
    s_waitcnt lgkmcnt(7)
    v_mul_f32 v158, v146, v158
    v_mul_f32 v159, v146, v159
    v_mfma_f32_16x16x32_bf16 v[194:197], v[32:35], v[166:169], v[194:197]
    s_waitcnt lgkmcnt(5)
    ds_permute_b32 v170, v173, v17
    ds_permute_b32 v193, v173, v20
    v_mfma_f32_16x16x32_bf16 v[162:165], a[216:219], v[134:137], 0
    v_cvt_pk_bf16_f32 v158, v158, v159
    v_mul_f32 v160, v146, v160
    v_mfma_f32_16x16x32_bf16 v[162:165], a[220:223], v[174:177], v[162:165]
    s_waitcnt lgkmcnt(5)
    v_mul_f32 v159, 0x3baaaaab, v195
    v_mul_f32 v161, v146, v161
    v_mfma_f32_16x16x32_bf16 v[162:165], a[224:227], v[150:153], v[162:165]
    v_rsq_f32 v159, v159
    v_mfma_f32_16x16x32_bf16 v[162:165], a[228:231], v[178:181], v[162:165]
    s_waitcnt lgkmcnt(3)
    v_mul_f32 v238, v159, v238
    v_mul_f32 v239, v159, v239
    v_mfma_f32_16x16x32_bf16 v[162:165], a[232:235], v[130:133], v[162:165]
    v_cvt_pk_bf16_f32 v166, v238, v239
    v_mul_f32 v240, v159, v240
    v_mfma_f32_16x16x32_bf16 v[162:165], a[236:239], v[142:145], v[162:165]
    v_mul_f32 v241, v159, v241
    v_cvt_pk_bf16_f32 v167, v240, v241
    v_mfma_f32_16x16x32_bf16 v[198:201], a[240:243], v[134:137], 0
    v_mul_f32 v122, v159, v122
    v_mul_f32 v123, v159, v123
    v_mfma_f32_16x16x32_bf16 v[198:201], a[244:247], v[174:177], v[198:201]
    s_waitcnt lgkmcnt(0)
    v_cvt_pk_bf16_f32 v168, v122, v123
    v_mul_f32 v124, v159, v124
    v_mfma_f32_16x16x32_bf16 v[198:201], a[248:251], v[150:153], v[198:201]
    v_mul_f32 v125, v159, v125
    v_cvt_pk_bf16_f32 v169, v124, v125
    v_mfma_f32_16x16x32_bf16 v[198:201], a[252:255], v[178:181], v[198:201]
    buffer_store_dwordx4 v[166:169], v255, s[12:15], 0 offen nt
    v_mul_f32 v118, v159, v118
    v_mul_f32 v119, v159, v119
    v_cvt_pk_bf16_f32 v148, v118, v119
    v_mul_f32 v120, v159, v120
    v_mfma_f32_16x16x32_bf16 v[198:201], v[82:85], v[130:133], v[198:201]
    v_mul_f32 v121, v159, v121
    v_cvt_pk_bf16_f32 v149, v120, v121
    v_mfma_f32_16x16x32_bf16 v[198:201], v[86:89], v[142:145], v[198:201]
    ds_read_b128 v[118:121], v171 offset:6144
    v_fma_f32 v173, v162, v162, s33
    v_mfma_f32_16x16x32_bf16 v[122:125], v[90:93], v[134:137], 0
    ds_read_b128 v[134:137], v171 offset:7168
    v_fmac_f32 v173, v163, v163
    v_mfma_f32_16x16x32_bf16 v[122:125], v[94:97], v[174:177], v[122:125]
    ds_read_b128 v[166:169], v171 offset:8192
    v_fmac_f32 v173, v164, v164
    v_mfma_f32_16x16x32_bf16 v[122:125], v[98:101], v[150:153], v[122:125]
    ds_read_b128 v[150:153], v171 offset:9216
    v_fmac_f32 v173, v165, v165
    v_mfma_f32_16x16x32_bf16 v[122:125], v[102:105], v[178:181], v[122:125]
    ds_read_b128 v[174:177], v171 offset:10240
    v_fmac_f32 v173, v198, v198
    v_mfma_f32_16x16x32_bf16 v[122:125], v[106:109], v[130:133], v[122:125]
    ds_read_b128 v[130:133], v171 offset:11264
    v_fmac_f32 v173, v199, v199
    v_mfma_f32_16x16x32_bf16 v[122:125], v[110:113], v[142:145], v[122:125]
    v_fmac_f32 v173, v200, v200
    v_fmac_f32 v173, v201, v201
    v_cvt_pk_bf16_f32 v159, v160, v161
    v_mul_f32 v182, v146, v182
    s_waitcnt lgkmcnt(5)
    v_mfma_f32_16x16x32_bf16 v[142:145], a[216:219], v[118:121], 0
    v_mul_f32 v183, v146, v183
    v_cvt_pk_bf16_f32 v160, v182, v183
    v_mfma_f32_16x16x32_bf16 v[178:181], a[240:243], v[118:121], 0
    s_waitcnt lgkmcnt(4)
    v_fmac_f32 v173, v122, v122
    v_fmac_f32 v173, v123, v123
    v_mfma_f32_16x16x32_bf16 v[142:145], a[220:223], v[134:137], v[142:145]
    s_waitcnt lgkmcnt(3)
    v_fmac_f32 v173, v124, v124
    v_fmac_f32 v173, v125, v125
    v_mfma_f32_16x16x32_bf16 v[142:145], a[224:227], v[166:169], v[142:145]
    s_waitcnt lgkmcnt(2)
    v_mul_f32 v184, v146, v184
    v_mul_f32 v185, v146, v185
    v_mfma_f32_16x16x32_bf16 v[142:145], a[228:231], v[150:153], v[142:145]
    s_waitcnt lgkmcnt(1)
    v_cvt_pk_bf16_f32 v161, v184, v185
    v_mul_f32 v186, v146, v186
    v_mfma_f32_16x16x32_bf16 v[142:145], a[232:235], v[174:177], v[142:145]
    s_waitcnt lgkmcnt(0)
    ds_write_b128 v3, v[158:161] offset:12288
    v_mfma_f32_16x16x32_bf16 v[142:145], a[236:239], v[130:133], v[142:145]
    buffer_store_dwordx2 v[148:149], v192, s[12:15], 0 offen nt
    v_mul_f32 v187, v146, v187
    v_cvt_pk_bf16_f32 v186, v186, v187
    v_mfma_f32_16x16x32_bf16 v[178:181], a[244:247], v[134:137], v[178:181]
    v_mul_f32 v188, v146, v188
    v_mul_f32 v189, v146, v189
    v_mfma_f32_16x16x32_bf16 v[178:181], a[248:251], v[166:169], v[178:181]
    v_cvt_pk_bf16_f32 v187, v188, v189
    v_fma_f32 v192, v142, v142, s33
    v_mfma_f32_16x16x32_bf16 v[178:181], a[252:255], v[150:153], v[178:181]
    ds_write_b64 v4, v[186:187] offset:16384
    v_mfma_f32_16x16x32_bf16 v[178:181], v[82:85], v[174:177], v[178:181]
    v_fmac_f32 v192, v143, v143
    v_fmac_f32 v192, v144, v144
    v_mfma_f32_16x16x32_bf16 v[178:181], v[86:89], v[130:133], v[178:181]
    v_fmac_f32 v192, v145, v145
    v_mul_f32 v255, 0x3baaaaab, v194
    v_mfma_f32_16x16x32_bf16 v[146:149], v[90:93], v[118:121], 0
    v_rsq_f32 v255, v255
    v_mfma_f32_16x16x32_bf16 v[146:149], v[94:97], v[134:137], v[146:149]
    v_mul_f32 v154, v255, v154
    v_mul_f32 v155, v255, v155
    v_mfma_f32_16x16x32_bf16 v[146:149], v[98:101], v[166:169], v[146:149]
    v_fmac_f32 v192, v178, v178
    v_fmac_f32 v192, v179, v179
    v_mfma_f32_16x16x32_bf16 v[146:149], v[102:105], v[150:153], v[146:149]
    v_fmac_f32 v192, v180, v180
    v_fmac_f32 v192, v181, v181
    v_mfma_f32_16x16x32_bf16 v[146:149], v[106:109], v[174:177], v[146:149]
    v_cvt_pk_bf16_f32 v118, v154, v155
    v_mul_f32 v156, v255, v156
    v_mfma_f32_16x16x32_bf16 v[146:149], v[110:113], v[130:133], v[146:149]
    v_mul_f32 v157, v255, v157
    v_cvt_pk_bf16_f32 v119, v156, v157
    v_mul_f32 v114, v255, v114
    v_mul_f32 v115, v255, v115
    v_cvt_pk_bf16_f32 v120, v114, v115
    v_mul_f32 v116, v255, v116
    v_mul_f32 v117, v255, v117
    v_cvt_pk_bf16_f32 v121, v116, v117
    v_fmac_f32 v192, v146, v146
    v_fmac_f32 v192, v147, v147
    v_fmac_f32 v192, v148, v148
    v_fmac_f32 v192, v149, v149
    v_cvt_pk_bf16_f32 v114, v173, v192
    v_cvt_pk_bf16_f32 v115, v192, v192
    ds_write_b64 v128, v[114:115] offset:7616
    buffer_store_dwordx4 v[118:121], v17, s[52:55], 0 offen nt
    v_mul_f32 v206, v255, v206
    v_mul_f32 v207, v255, v207
    v_cvt_pk_bf16_f32 v206, v206, v207
    v_mul_f32 v208, v255, v208
    v_mul_f32 v209, v255, v209
    v_cvt_pk_bf16_f32 v207, v208, v209
    v_min_u32 v173, 20, v140
    v_add_u32 v192, 12, v140
    v_lshrrev_b32 v192, 5, v192
    v_sub_u32 v255, v140, v173
    v_mad_i32_i24 v255, v192, s6, v255
    v_mul_u32_u24 v208, s20, v173
    v_add3_u32 v208, v208, v255, s38
    v_mul_u32_u24 v192, 911, v208
    v_lshrrev_b32 v192, 16, v192
    v_mul_u32_u24 v192, s22, v192
    v_mad_u32_u24 v192, v173, s21, v192
    v_bfe_u32 v208, s70, v140, 1
    v_cmp_ne_u32 vcc, 0, v208
    v_mul_i32_i24 v255, 2688, v255
    v_add3_u32 v140, v192, v255, s7
    v_cndmask_b32 v140, v129, v140, vcc
    v_lshl_add_u32 v255, v191, 4, v140
    v_add_u32 v255, s3, v255
    s_waitcnt lgkmcnt(0)
    s_barrier
    ds_read_b128 v[114:117], v127 offset:7616
    ds_read_b128 v[118:121], v127 offset:8640
    ds_read_b128 v[130:133], v171 offset:12288
    ds_read_b128 v[134:137], v171 offset:13312
    ds_read_b128 v[150:153], v171 offset:14336
    ds_read_b128 v[154:157], v171 offset:15360
    ds_read_b128 v[158:161], v171 offset:16384
    ds_read_b128 v[166:169], v171 offset:17408
    v_lshl_add_u32 v173, v191, 3, v140
    v_add_u32 v173, s4, v173
    s_waitcnt lgkmcnt(7)
    v_mfma_f32_16x16x32_bf16 v[174:177], v[32:35], v[114:117], 0
    s_waitcnt lgkmcnt(6)
    v_mfma_f32_16x16x32_bf16 v[174:177], v[32:35], v[118:121], v[174:177]
    s_waitcnt lgkmcnt(4)
    v_mfma_f32_16x16x32_bf16 v[114:117], a[216:219], v[130:133], 0
    s_waitcnt lgkmcnt(3)
    buffer_store_dwordx2 v[206:207], v20, s[52:55], 0 offen nt
    v_mfma_f32_16x16x32_bf16 v[114:117], a[220:223], v[134:137], v[114:117]
    s_waitcnt lgkmcnt(2)
    v_mfma_f32_16x16x32_bf16 v[114:117], a[224:227], v[150:153], v[114:117]
    s_waitcnt lgkmcnt(1)
    v_mul_f32 v140, 0x3baaaaab, v174
    v_mul_f32 v129, 0x3baaaaab, v175
    v_mfma_f32_16x16x32_bf16 v[114:117], a[228:231], v[154:157], v[114:117]
    s_waitcnt lgkmcnt(0)
    v_rsq_f32 v140, v140
    v_mfma_f32_16x16x32_bf16 v[114:117], a[232:235], v[158:161], v[114:117]
    v_mul_f32 v162, v140, v162
    v_mul_f32 v163, v140, v163
    v_mfma_f32_16x16x32_bf16 v[114:117], a[236:239], v[166:169], v[114:117]
    v_cvt_pk_bf16_f32 v118, v162, v163
    v_mul_f32 v164, v140, v164
    v_mfma_f32_16x16x32_bf16 v[174:177], a[240:243], v[130:133], 0
    v_mul_f32 v165, v140, v165
    v_cvt_pk_bf16_f32 v119, v164, v165
    v_mfma_f32_16x16x32_bf16 v[174:177], a[244:247], v[134:137], v[174:177]
    v_mul_f32 v198, v140, v198
    v_mul_f32 v199, v140, v199
    v_mfma_f32_16x16x32_bf16 v[174:177], a[248:251], v[150:153], v[174:177]
    v_fma_f32 v191, v114, v114, s33
    v_fmac_f32 v191, v115, v115
    v_mfma_f32_16x16x32_bf16 v[174:177], a[252:255], v[154:157], v[174:177]
    v_fmac_f32 v191, v116, v116
    v_fmac_f32 v191, v117, v117
    v_mfma_f32_16x16x32_bf16 v[174:177], v[82:85], v[158:161], v[174:177]
    v_cvt_pk_bf16_f32 v120, v198, v199
    v_mul_f32 v200, v140, v200
    v_mfma_f32_16x16x32_bf16 v[174:177], v[86:89], v[166:169], v[174:177]
    ds_read_b128 v[162:165], v126 offset:256
    v_mul_f32 v201, v140, v201
    v_mfma_f32_16x16x32_bf16 v[182:185], v[90:93], v[130:133], 0
    ds_read_b128 v[130:133], v126 offset:2304
    v_cvt_pk_bf16_f32 v121, v200, v201
    v_mfma_f32_16x16x32_bf16 v[182:185], v[94:97], v[134:137], v[182:185]
    ds_read_b128 v[134:137], v126 offset:4352
    v_mul_f32 v122, v140, v122
    v_mfma_f32_16x16x32_bf16 v[182:185], v[98:101], v[150:153], v[182:185]
    ds_read_b128 v[150:153], v126 offset:6400
    v_fmac_f32 v191, v174, v174
    v_mfma_f32_16x16x32_bf16 v[182:185], v[102:105], v[154:157], v[182:185]
    ds_read_b128 v[154:157], v126 offset:8448
    v_fmac_f32 v191, v175, v175
    v_mfma_f32_16x16x32_bf16 v[182:185], v[106:109], v[158:161], v[182:185]
    ds_read_b128 v[158:161], v126 offset:10496
    buffer_store_dwordx4 v[118:121], v15, s[56:59], 0 offen nt
    v_fmac_f32 v191, v176, v176
    v_fmac_f32 v191, v177, v177
    v_mul_f32 v123, v140, v123
    v_cvt_pk_bf16_f32 v122, v122, v123
    v_mfma_f32_16x16x32_bf16 v[182:185], v[110:113], v[166:169], v[182:185]
    v_mul_f32 v124, v140, v124
    s_waitcnt lgkmcnt(5)
    v_mfma_f32_16x16x32_bf16 v[118:121], a[216:219], v[162:165], 0
    v_mul_f32 v125, v140, v125
    v_cvt_pk_bf16_f32 v123, v124, v125
    v_mfma_f32_16x16x32_bf16 v[166:169], a[240:243], v[162:165], 0
    s_waitcnt lgkmcnt(4)
    v_rsq_f32 v129, v129
    v_mfma_f32_16x16x32_bf16 v[118:121], a[220:223], v[130:133], v[118:121]
    s_waitcnt lgkmcnt(3)
    v_fmac_f32 v191, v182, v182
    v_fmac_f32 v191, v183, v183
    v_mfma_f32_16x16x32_bf16 v[118:121], a[224:227], v[134:137], v[118:121]
    s_waitcnt lgkmcnt(2)
    v_fmac_f32 v191, v184, v184
    v_fmac_f32 v191, v185, v185
    v_mfma_f32_16x16x32_bf16 v[118:121], a[228:231], v[150:153], v[118:121]
    s_waitcnt lgkmcnt(1)
    v_cvt_pk_bf16_f32 v124, v191, v191
    v_cvt_pk_bf16_f32 v125, v191, v191
    v_mfma_f32_16x16x32_bf16 v[118:121], a[232:235], v[154:157], v[118:121]
    s_waitcnt lgkmcnt(0)
    ds_write_b64 v128, v[124:125] offset:9664
    v_mfma_f32_16x16x32_bf16 v[118:121], a[236:239], v[158:161], v[118:121]
    v_mul_f32 v142, v129, v142
    v_mul_f32 v143, v129, v143
    v_mfma_f32_16x16x32_bf16 v[166:169], a[244:247], v[130:133], v[166:169]
    v_cvt_pk_bf16_f32 v142, v142, v143
    v_mul_f32 v144, v129, v144
    v_mfma_f32_16x16x32_bf16 v[166:169], a[248:251], v[134:137], v[166:169]
    v_mul_f32 v145, v129, v145
    v_cvt_pk_bf16_f32 v143, v144, v145
    v_mfma_f32_16x16x32_bf16 v[166:169], a[252:255], v[150:153], v[166:169]
    v_fma_f32 v140, v118, v118, s33
    v_fmac_f32 v140, v119, v119
    v_mfma_f32_16x16x32_bf16 v[166:169], v[82:85], v[154:157], v[166:169]
    v_fmac_f32 v140, v120, v120
    v_fmac_f32 v140, v121, v121
    v_mfma_f32_16x16x32_bf16 v[166:169], v[86:89], v[158:161], v[166:169]
    v_mul_f32 v178, v129, v178
    v_mul_f32 v179, v129, v179
    v_mfma_f32_16x16x32_bf16 v[186:189], v[90:93], v[162:165], 0
    v_cvt_pk_bf16_f32 v144, v178, v179
    v_mul_f32 v180, v129, v180
    v_mfma_f32_16x16x32_bf16 v[186:189], v[94:97], v[130:133], v[186:189]
    buffer_store_dwordx2 v[122:123], v18, s[56:59], 0 offen nt
    v_mul_f32 v181, v129, v181
    v_fmac_f32 v140, v166, v166
    v_mfma_f32_16x16x32_bf16 v[186:189], v[98:101], v[134:137], v[186:189]
    v_fmac_f32 v140, v167, v167
    v_fmac_f32 v140, v168, v168
    v_mfma_f32_16x16x32_bf16 v[186:189], v[102:105], v[150:153], v[186:189]
    v_fmac_f32 v140, v169, v169
    v_cvt_pk_bf16_f32 v145, v180, v181
    v_mfma_f32_16x16x32_bf16 v[186:189], v[106:109], v[154:157], v[186:189]
    ds_write_b128 v254, v[142:145] offset:1536
    v_mfma_f32_16x16x32_bf16 v[186:189], v[110:113], v[158:161], v[186:189]
    v_mul_f32 v146, v129, v146
    v_mul_f32 v147, v129, v147
    v_cvt_pk_bf16_f32 v146, v146, v147
    v_mul_f32 v148, v129, v148
    v_mul_f32 v149, v129, v149
    ds_read_b128 v[122:125], v138 offset:1536
    v_cvt_pk_bf16_f32 v147, v148, v149
    ds_write_b64 v172, v[146:147] offset:2560
    v_fmac_f32 v140, v186, v186
    v_fmac_f32 v140, v187, v187
    v_fmac_f32 v140, v188, v188
    v_fmac_f32 v140, v189, v189
    v_cvt_pk_bf16_f32 v130, v140, v140
    v_cvt_pk_bf16_f32 v131, v140, v140
    ds_write_b64 v128, v[130:131] offset:15232
    ds_read_b64 v[128:129], v139 offset:2560
    s_waitcnt lgkmcnt(3)
    buffer_store_dwordx4 v[122:125], v141, s[56:59], 0 offen nt
    s_waitcnt lgkmcnt(1)
    s_barrier
    ds_read_b128 v[130:133], v127 offset:9664
    ds_read_b128 v[122:125], v127 offset:10688
    ds_read_b128 v[134:137], v127 offset:15232
    ds_read_b128 v[142:145], v127 offset:16256
    ds_read_b128 v[146:149], v171 offset:18432
    s_waitcnt lgkmcnt(5)
    buffer_store_dwordx2 v[128:129], v190, s[56:59], 0 offen nt
    s_waitcnt lgkmcnt(4)
    v_mfma_f32_16x16x32_bf16 v[150:153], v[32:35], v[130:133], 0
    s_waitcnt lgkmcnt(3)
    v_mfma_f32_16x16x32_bf16 v[150:153], v[32:35], v[122:125], v[150:153]
    s_waitcnt lgkmcnt(1)
    v_mfma_f32_16x16x32_bf16 v[122:125], v[32:35], v[134:137], 0
    s_waitcnt lgkmcnt(0)
    v_or3_b32 v146, v146, v147, v148
    v_or_b32 v146, v146, v149
    v_mfma_f32_16x16x32_bf16 v[122:125], v[32:35], v[142:145], v[122:125]
    v_cmp_gt_i32 s[46:47], 0, v146
    s_nop 0
    v_mul_f32 v171, 0x3baaaaab, v150
    v_rsq_f32 v171, v171
    s_nop 0
    v_mul_f32 v114, v171, v114
    v_mul_f32 v115, v171, v115
    v_cvt_pk_bf16_f32 v114, v114, v115
    v_mul_f32 v115, 0x3baaaaab, v122
    v_rsq_f32 v115, v115
    v_mul_f32 v116, v171, v116
    v_mul_f32 v118, v115, v118
    v_mul_f32 v119, v115, v119
    v_cvt_pk_bf16_f32 v118, v118, v119
    v_mul_f32 v120, v115, v120
    v_mul_f32 v121, v115, v121
    v_cvt_pk_bf16_f32 v119, v120, v121
    v_mul_f32 v166, v115, v166
    v_mul_f32 v167, v115, v167
    v_cvt_pk_bf16_f32 v120, v166, v167
    v_mul_f32 v168, v115, v168
    v_mul_f32 v169, v115, v169
    v_cvt_pk_bf16_f32 v121, v168, v169
    buffer_store_dwordx4 v[118:121], v255, s[12:15], 0 offen nt
    v_mul_f32 v186, v115, v186
    v_mul_f32 v187, v115, v187
    v_cvt_pk_bf16_f32 v140, v186, v187
    v_mul_f32 v188, v115, v188
    v_mul_f32 v189, v115, v189
    v_cvt_pk_bf16_f32 v141, v188, v189
    v_mul_f32 v117, v171, v117
    v_cvt_pk_bf16_f32 v115, v116, v117
    v_mul_f32 v174, v171, v174
    v_mul_f32 v175, v171, v175
    v_cvt_pk_bf16_f32 v116, v174, v175
    v_mul_f32 v176, v171, v176
    v_mul_f32 v177, v171, v177
    v_cvt_pk_bf16_f32 v117, v176, v177
    ds_write_b128 v254, v[114:117] offset:3072
    v_mul_f32 v182, v171, v182
    v_mul_f32 v183, v171, v183
    v_cvt_pk_bf16_f32 v254, v182, v183
    v_mul_f32 v184, v171, v184
    v_mul_f32 v185, v171, v185
    v_cvt_pk_bf16_f32 v255, v184, v185
    buffer_store_dwordx2 v[140:141], v173, s[12:15], 0 offen nt
    ds_read_b128 v[114:117], v138 offset:3072
    ds_write_b64 v172, v[254:255] offset:4096
    ds_read_b64 v[254:255], v139 offset:4096
    s_waitcnt lgkmcnt(2)
    buffer_store_dwordx4 v[114:117], v170, s[56:59], 0 offen nt
    s_waitcnt lgkmcnt(0)
    buffer_store_dwordx2 v[254:255], v193, s[56:59], 0 offen nt
L_end:
    s_nop 1
    s_cmp_lg_u64 s[46:47], 0
    s_cbranch_scc1 L_rerun
L_done:
    s_endpgm
L_rerun:
    s_mov_b32 s44, 0x7f000000
    s_lshr_b32 s100, s70, 20
    s_waitcnt vmcnt(0) lgkmcnt(0)
    s_barrier
    v_mbcnt_lo_u32_b32 v0, -1, 0
    v_mbcnt_hi_u32_b32 v0, -1, v0
    v_lshl_add_u32 v0, s16, 6, v0
    s_nop 7
    s_branch L_again
L_edge:
    v_mov_b32 v254, v0
    v_mov_b32 v255, 0x40000000
    s_lshl_b32 s3, s16, 4
    s_load_dwordx4 s[92:95], s[0:1], s3
    v_and_b32 v114, 63, v0
    s_bfe_u32 s3, s2, 0x50003
    s_lshl_b32 s4, s16, 3
    s_lshr_b32 s98, 0x06143a01, s4
    s_and_b32 s98, s98, 0xff
    s_mul_i32 s3, s3, s98
    s_sub_u32 s98, s98, 1
    s_lshr_b32 s4, 0x0048d800, s4
    s_and_b32 s4, s4, 0xff
    s_lshl_b32 s4, s4, 3
    s_max_u32 s4, s4, 6
    s_sub_u32 s4, s4, s98
    s_sub_u32 s4, s4, 1
    s_min_u32 s3, s3, s4
    v_min_u32 v116, s98, v114
    v_add_lshl_u32 v116, v116, s3, 7
    v_mov_b32 v117, 0
    v_lshrrev_b32 v115, 4, v114
    v_and_b32 v118, 15, v114
    s_mov_b32 s10, 100270464
    s_mov_b32 s11, 0x00020000
    s_mov_b32 s50, 36096
    s_mov_b32 s51, 0x00020000
    s_mov_b32 s70, 193536
    s_mov_b32 s36, 100270464
    s_mov_b32 s22, 1180032
    s_mul_i32 s3, s2, 911
    s_lshr_b32 s3, s3, 16
    s_mul_i32 s35, s3, 72
    s_sub_u32 s38, s2, s35
    s_mul_i32 s3, s3, 1373568
    s_mul_i32 s35, s38, 2688
    s_add_u32 s3, s3, s35
    s_add_u32 s25, s3, 589824
    s_add_u32 s7, s3, 1769472
    s_mov_b32 s20, 31
    s_mov_b32 s21, 4204032
    s_mov_b32 s17, 20
    s_cmp_lt_u32 s2, 240
    s_cselect_b32 s45, 28, 24
    s_mov_b32 s5, 0
    s_mov_b32 s6, 0
    s_cmp_lt_u32 s2, 247
    s_cbranch_scc1 L_inner
    s_mov_b32 s20, 0
    s_mov_b32 s38, 0
    s_sub_u32 s3, s2, 247
    s_and_b32 s3, s3, 3
    s_mul_i32 s3, s3, 7
    s_add_u32 s3, s3, 3
    s_mov_b32 s35, 196224
    s_cmp_lt_u32 s2, 251
    s_cselect_b32 s35, s35, 384
    s_cselect_b32 s6, 1, 0
    s_cselect_b32 s5, 0, 1
    s_mul_i32 s25, s3, s35
    s_mul_i32 s21, s35, 28
    s_cmp_lt_u32 s2, 255
    s_cselect_b32 s17, 18, 1
    s_cselect_b32 s45, 18, 1
    s_cselect_b32 s25, s25, 0
    s_cselect_b32 s6, s6, 1
    s_add_u32 s7, s25, 1179648
L_inner:
    s_mul_i32 s3, s5, 99485568
    s_mul_i32 s35, s5, -784896
    v_mov_b32 v119, s3
    v_mov_b32 v120, s35
    s_add_u32 s7, s7, s35
    s_mul_i32 s3, s6, 194688
    s_mul_i32 s35, s6, -1536
    v_mov_b32 v121, s3
    v_mov_b32 v126, s35
    s_add_u32 s7, s7, s35
    s_bfm_b32 s34, s45, 0
    s_and_b32 s4, s2, 7
    s_sub_u32 s4, 0, s4
    v_mul_u32_u24 v127, 2731, v254
    v_bfe_u32 v128, v127, 17, 3
    v_lshrrev_b32 v127, 16, v127
    v_xor_b32 v129, v128, v254
    v_mul_u32_u24 v128, 37, v127
    v_lshrrev_b32 v128, 8, v128
    v_lshlrev_b32 v129, 4, v129
    v_mad_u32_u24 v10, v128, s70, v129
    v_mul_u32_u24 v128, 37, v127
    v_lshrrev_b32 v128, 8, v128
    v_mul_u32_u24 v130, 7, v128
    v_sub_u32 v130, v127, v130
    v_cmp_gt_u32 vcc, 4, v128
    s_nop 1
    v_cndmask_b32 v128, v120, v119, vcc
    v_cmp_gt_u32 vcc, 4, v130
    s_nop 1
    v_cndmask_b32 v130, v126, v121, vcc
    v_add3_u32 v10, v10, v128, v130
    v_mul_u32_u24 v128, s20, v127
    v_add_u32 v128, s38, v128
    v_mul_u32_u24 v130, 911, v128
    v_lshrrev_b32 v130, 16, v130
    v_mul_u32_u24 v130, s22, v130
    v_mad_u32_u24 v130, v127, s21, v130
    v_bfe_u32 v128, s34, v127, 1
    v_cmp_ne_u32 vcc, 0, v128
    v_add_u32 v128, s7, v130
    s_nop 0
    v_cndmask_b32 v128, v255, v128, vcc
    v_mul_u32_u24 v127, 384, v127
    v_sub_u32 v127, v129, v127
    v_add_u32 v128, v128, v127
    v_add_u32 v127, 256, v254
    v_mul_u32_u24 v129, 2731, v127
    v_bfe_u32 v130, v129, 17, 3
    v_lshrrev_b32 v129, 16, v129
    v_xor_b32 v127, v130, v127
    v_mul_u32_u24 v130, 37, v129
    v_lshrrev_b32 v130, 8, v130
    v_lshlrev_b32 v127, 4, v127
    v_mad_u32_u24 v11, v130, s70, v127
    v_mul_u32_u24 v130, 37, v129
    v_lshrrev_b32 v130, 8, v130
    v_mul_u32_u24 v131, 7, v130
    v_sub_u32 v131, v129, v131
    v_cmp_gt_u32 vcc, 4, v130
    s_nop 1
    v_cndmask_b32 v130, v120, v119, vcc
    v_cmp_gt_u32 vcc, 4, v131
    s_nop 1
    v_cndmask_b32 v131, v126, v121, vcc
    v_add3_u32 v11, v11, v130, v131
    v_min_u32 v130, 20, v129
    v_add_u32 v131, 12, v129
    v_lshrrev_b32 v131, 5, v131
    v_sub_u32 v132, v129, v130
    v_mad_i32_i24 v132, v131, s4, v132
    v_mul_u32_u24 v133, s20, v130
    v_add3_u32 v133, v133, v132, s38
    v_mul_u32_u24 v131, 911, v133
    v_lshrrev_b32 v131, 16, v131
    v_mul_u32_u24 v131, s22, v131
    v_mad_u32_u24 v131, v130, s21, v131
    v_bfe_u32 v133, s34, v129, 1
    v_cmp_ne_u32 vcc, 0, v133
    v_mul_i32_i24 v132, 2688, v132
    v_add3_u32 v130, v131, v132, s7
    v_cndmask_b32 v130, v255, v130, vcc
    v_mul_u32_u24 v129, 384, v129
    v_sub_u32 v129, v127, v129
    v_add_u32 v130, v130, v129
    v_add_u32 v127, 512, v254
    v_mul_u32_u24 v129, 2731, v127
    v_bfe_u32 v131, v129, 17, 3
    v_lshrrev_b32 v129, 16, v129
    v_xor_b32 v127, v131, v127
    v_mul_u32_u24 v131, 37, v129
    v_lshrrev_b32 v131, 8, v131
    v_lshlrev_b32 v127, 4, v127
    v_mad_u32_u24 v12, v131, s70, v127
    v_mul_u32_u24 v131, 37, v129
    v_lshrrev_b32 v131, 8, v131
    v_mul_u32_u24 v132, 7, v131
    v_sub_u32 v132, v129, v132
    v_cmp_gt_u32 vcc, 4, v131
    s_nop 1
    v_cndmask_b32 v131, v120, v119, vcc
    v_cmp_gt_u32 vcc, 4, v132
    s_nop 1
    v_cndmask_b32 v132, v126, v121, vcc
    v_add3_u32 v12, v12, v131, v132
    v_min_u32 v131, 20, v129
    v_add_u32 v132, 12, v129
    v_lshrrev_b32 v132, 5, v132
    v_sub_u32 v133, v129, v131
    v_mad_i32_i24 v133, v132, s4, v133
    v_mul_u32_u24 v142, s20, v131
    v_add3_u32 v142, v142, v133, s38
    v_mul_u32_u24 v132, 911, v142
    v_lshrrev_b32 v132, 16, v132
    v_mul_u32_u24 v132, s22, v132
    v_mad_u32_u24 v132, v131, s21, v132
    v_bfe_u32 v142, s34, v129, 1
    v_cmp_ne_u32 vcc, 0, v142
    v_mul_i32_i24 v133, 2688, v133
    v_add3_u32 v131, v132, v133, s7
    v_cndmask_b32 v131, v255, v131, vcc
    v_mul_u32_u24 v129, 384, v129
    v_sub_u32 v129, v127, v129
    v_add_u32 v131, v131, v129
    s_lshl_b32 s28, s16, 10
    s_add_u32 s28, s28, 20480
    s_waitcnt lgkmcnt(0)
    s_load_dword s101, s[92:93], 0
    s_load_dword s101, s[94:95], 0
    s_cmp_eq_u32 s16, 2
    s_cselect_b64 s[98:99], s[80:81], s[78:79]
    s_cmp_eq_u32 s16, 3
    s_cselect_b64 s[98:99], s[88:89], s[98:99]
    s_mov_b64 s[8:9], s[76:77]
    v_lshl_add_u64 v[116:117], s[98:99], 0, v[116:117]
    s_cmp_eq_u32 s16, 2
    s_cselect_b64 s[98:99], s[84:85], s[82:83]
    s_cmp_eq_u32 s16, 3
    s_cselect_b64 s[98:99], s[86:87], s[98:99]
    v_writelane_b32 v116, s98, 63
    v_writelane_b32 v117, s99, 63
    s_cmp_eq_u32 s16, 0
    s_cbranch_scc1 L_nowue
    global_load_dword a254, v[116:117], off
L_nowue:
    s_add_u32 m0, s28, 65536
    s_nop 0
    buffer_load_dwordx4 v128, s[8:11], 0 offen nt lds
    s_add_u32 m0, s28, 69632
    s_nop 0
    buffer_load_dwordx4 v130, s[8:11], 0 offen lds
    s_add_u32 m0, s28, 73728
    s_nop 0
    buffer_load_dwordx4 v131, s[8:11], 0 offen lds
    s_add_u32 m0, s28, 0
    s_nop 0
    buffer_load_dwordx4 v10, s[8:11], s25 offen nt lds
    s_add_u32 m0, s28, 4096
    s_nop 0
    buffer_load_dwordx4 v11, s[8:11], s25 offen nt lds
    s_mov_b64 s[48:49], s[78:79]
    s_mov_b64 s[52:53], s[80:81]
    s_mov_b64 s[60:61], s[84:85]
    s_mov_b64 s[64:65], s[86:87]
    s_mov_b64 s[56:57], s[88:89]
    s_mov_b64 s[46:47], s[82:83]
    s_load_dwordx4 s[40:43], s[0:1], 72
    s_mul_i32 s3, s16, 96
    v_lshl_add_u32 v116, v114, 4, s3
    v_mul_u32_u24 v117, 171, v114
    v_lshrrev_b32 v117, 10, v117
    v_lshrrev_b32 v127, 1, v117
    v_xor_b32 v127, v127, v117
    v_and_b32 v127, 4, v127
    v_mul_u32_u24 v127, 3, v127
    v_xor_b32 v127, v127, v117
    v_mul_u32_u24 v127, 1152, v127
    v_mul_u32_u24 v128, 96, v117
    v_sub_u32 v127, v127, v128
    v_add_u32 v128, v116, v127
    v_add_u32 v127, 64, v114
    v_mul_u32_u24 v127, 171, v127
    v_lshrrev_b32 v127, 10, v127
    v_lshrrev_b32 v129, 1, v127
    v_xor_b32 v129, v129, v127
    v_and_b32 v129, 4, v129
    v_mul_u32_u24 v129, 3, v129
    v_xor_b32 v129, v129, v127
    v_mul_u32_u24 v129, 1152, v129
    v_mul_u32_u24 v130, 96, v127
    v_sub_u32 v129, v129, v130
    v_add_u32 v130, v116, v129
    v_add_u32 v129, 128, v114
    v_mul_u32_u24 v129, 171, v129
    v_lshrrev_b32 v129, 10, v129
    v_lshrrev_b32 v131, 1, v129
    v_xor_b32 v131, v131, v129
    v_and_b32 v131, 4, v131
    v_mul_u32_u24 v131, 3, v131
    v_xor_b32 v131, v131, v129
    v_mul_u32_u24 v131, 1152, v131
    v_mul_u32_u24 v132, 96, v129
    v_sub_u32 v131, v131, v132
    v_add_u32 v132, v116, v131
    s_mul_i32 s68, s16, 6144
    s_add_u32 s69, s68, 65536
    s_cmp_eq_u32 s16, 3
    s_cselect_b32 s68, 149696, s68
    s_cselect_b32 s69, 155840, s69
    s_add_u32 s48, s48, 384
    s_addc_u32 s49, s49, 0
    s_add_u32 m0, s68, 0
    v_lshlrev_b32 v116, 1, v115
    s_mov_b32 s54, 12288
    s_mov_b32 s55, 0x00020000
    s_mov_b32 s62, 64
    s_mov_b32 s63, 0x00020000
    s_mov_b32 s66, 128
    s_mov_b32 s67, 0x00020000
    s_mov_b32 s58, 676
    s_mov_b32 s59, 0x00020000
    s_mov_b32 s14, 0
    s_mov_b32 s15, 0x00020000
    s_mul_i32 s90, s16, 16
    v_mov_b32 v123, 0
    v_cmp_lt_u32 s[92:93], 7, v118
    v_mov_b32 v137, 0
    v_mov_b32 v135, 0
    v_mov_b32 v125, 0
    v_lshlrev_b32 v124, 1, v114
    v_mul_u32_u24 v131, 12, v118
    s_mul_i32 s71, s16, 192
    v_add_u32 v131, s71, v131
    v_lshlrev_b32 v133, 5, v115
    s_mul_i32 s72, s16, 9408
    s_add_u32 s72, s72, 104448
    s_mul_i32 s73, s16, 7616
    s_add_u32 s73, s73, 38912
    s_cmp_eq_u32 s16, 3
    s_cselect_b32 s73, 142080, s73
    v_lshrrev_b32 v138, 2, v118
    v_and_b32 v134, 1, v138
    v_mul_u32_u24 v134, 0x020202, v134
    v_lshl_or_b32 v134, v134, 8, v134
    v_add_u32 v134, 0x05040100, v134
    v_and_b32 v139, 3, v118
    v_lshrrev_b32 v122, 1, v118
    v_xor_b32 v122, v122, v115
    v_mul_u32_u24 v136, 384, v118
    v_lshl_add_u32 v0, v122, 4, v136
    v_xor_b32 v1, 64, v0
    v_and_b32 v122, 2, v115
    v_add_u32 v122, v122, v115
    v_lshl_add_u32 v122, v122, 2, v138
    v_mul_u32_u24 v122, 96, v122
    v_lshl_add_u32 v122, v139, 3, v122
    v_add_u32 v142, s68, v122
    v_add_u32 v140, s69, v122
    v_add_u32 v141, s72, v122
    v_add_u32 v143, s73, v122
    v_mov_b32 v28, 0x3f803f80
    v_mov_b32 v29, 0x3f803f80
    v_mov_b32 v30, 0x3f803f80
    v_mov_b32 v31, 0x3f803f80
    v_mul_u32_u24 v144, 768, v115
    v_add_u32 v144, v131, v144
    v_add_u32 v144, 98304, v144
    s_mov_b32 s76, 0x3f80
    v_and_b32 v122, 1, v118
    v_lshlrev_b32 v122, 4, v122
    v_lshlrev_b32 v136, v122, s76
    v_mov_b32 v145, 0x3c003c00
    v_mov_b32 v44, 1.0
    v_lshlrev_b32 v146, 4, v115
    s_mov_b32 s19, s38
    s_mov_b32 s23, s25
    s_mov_b32 s26, 0
    s_mov_b32 s27, 0
    s_mov_b32 s18, 0
    s_add_u32 s19, s19, s20
    s_add_u32 s23, s23, s21
    s_cmp_ge_u32 s19, 72
    s_cselect_b32 s34, 72, 0
    s_cselect_b32 s35, s22, 0
    s_sub_u32 s19, s19, s34
    s_add_u32 s23, s23, s35
    s_mov_b32 s24, s23
    s_add_u32 s19, s19, s20
    s_add_u32 s23, s23, s21
    s_cmp_ge_u32 s19, 72
    s_cselect_b32 s34, 72, 0
    s_cselect_b32 s35, s22, 0
    s_sub_u32 s19, s19, s34
    s_add_u32 s23, s23, s35
    s_mul_i32 s79, s16, 64
    v_lshl_add_u32 v147, v115, 4, s79
    s_mul_i32 s80, s16, 32
    s_add_u32 s80, s80, 256
    v_lshl_add_u32 v149, v115, 3, s80
    v_add_u32 v151, 0, v118
    v_mul_u32_u24 v148, 37, v151
    v_mul_u32_u24 v150, 384, v151
    v_lshrrev_b32 v148, 8, v148
    v_mad_u32_u24 v150, v148, s70, v150
    v_add_u32 v15, v150, v147
    v_add_u32 v18, v150, v149
    v_mul_u32_u24 v150, 37, v151
    v_lshrrev_b32 v150, 8, v150
    v_mul_u32_u24 v153, 7, v150
    v_sub_u32 v153, v151, v153
    v_add_u32 v152, 16, v118
    v_mul_u32_u24 v155, 37, v152
    v_mul_u32_u24 v154, 384, v152
    v_lshrrev_b32 v155, 8, v155
    v_mad_u32_u24 v154, v155, s70, v154
    v_add_u32 v16, v154, v147
    v_add_u32 v19, v154, v149
    v_mul_u32_u24 v154, 37, v152
    v_lshrrev_b32 v154, 8, v154
    v_mul_u32_u24 v157, 7, v154
    v_sub_u32 v157, v152, v157
    v_add_u32 v159, 32, v118
    v_mul_u32_u24 v158, 37, v159
    v_mul_u32_u24 v156, 384, v159
    v_lshrrev_b32 v158, 8, v158
    v_mad_u32_u24 v156, v158, s70, v156
    v_add_u32 v17, v156, v147
    v_add_u32 v20, v156, v149
    v_mul_u32_u24 v156, 37, v159
    v_lshrrev_b32 v156, 8, v156
    v_mul_u32_u24 v147, 7, v156
    v_sub_u32 v147, v159, v147
    s_mul_i32 s81, s16, 768
    s_add_u32 s81, s81, 98304
    v_mul_u32_u24 v148, 24, v148
    v_lshl_add_u32 v148, v151, 2, v148
    v_add_u32 v22, s81, v148
    v_sub_u32 v23, s81, v148
    v_sub_u32 v148, v22, v146
    v_mul_u32_u24 v155, 24, v155
    v_lshl_add_u32 v155, v152, 2, v155
    v_add_u32 v24, s81, v155
    v_sub_u32 v25, s81, v155
    v_sub_u32 v149, v24, v146
    v_mul_u32_u24 v155, 24, v158
    v_lshl_add_u32 v155, v159, 2, v155
    v_add_u32 v26, s81, v155
    v_sub_u32 v27, s81, v155
    v_sub_u32 v155, v26, v146
    v_mul_u32_u24 v158, 148, v115
    s_mov_b32 s82, -24
    v_add_u32 v160, 0, v158
    v_lshrrev_b32 v160, 8, v160
    v_mad_i32_i24 v46, v160, s82, v148
    v_mad_i32_i24 v58, v160, s82, v149
    v_mad_i32_i24 v70, v160, s82, v155
    v_add_u32 v160, 37, v158
    v_lshrrev_b32 v160, 8, v160
    v_mad_i32_i24 v47, v160, s82, v148
    v_mad_i32_i24 v59, v160, s82, v149
    v_mad_i32_i24 v71, v160, s82, v155
    v_add_u32 v160, 74, v158
    v_lshrrev_b32 v160, 8, v160
    v_mad_i32_i24 v48, v160, s82, v148
    v_mad_i32_i24 v60, v160, s82, v149
    v_mad_i32_i24 v72, v160, s82, v155
    v_add_u32 v160, 111, v158
    v_lshrrev_b32 v160, 8, v160
    v_mad_i32_i24 v49, v160, s82, v148
    v_mad_i32_i24 v61, v160, s82, v149
    v_mad_i32_i24 v73, v160, s82, v155
    v_add_u32 v160, 592, v158
    v_lshrrev_b32 v160, 8, v160
    v_mad_i32_i24 v50, v160, s82, v148
    v_mad_i32_i24 v62, v160, s82, v149
    v_mad_i32_i24 v74, v160, s82, v155
    v_add_u32 v160, 629, v158
    v_lshrrev_b32 v160, 8, v160
    v_mad_i32_i24 v51, v160, s82, v148
    v_mad_i32_i24 v63, v160, s82, v149
    v_mad_i32_i24 v75, v160, s82, v155
    v_add_u32 v160, 666, v158
    v_lshrrev_b32 v160, 8, v160
    v_mad_i32_i24 v52, v160, s82, v148
    v_mad_i32_i24 v64, v160, s82, v149
    v_mad_i32_i24 v76, v160, s82, v155
    v_add_u32 v160, 703, v158
    v_lshrrev_b32 v160, 8, v160
    v_mad_i32_i24 v53, v160, s82, v148
    v_mad_i32_i24 v65, v160, s82, v149
    v_mad_i32_i24 v77, v160, s82, v155
    v_add_u32 v160, 1184, v158
    v_lshrrev_b32 v160, 8, v160
    v_mad_i32_i24 v54, v160, s82, v148
    v_mad_i32_i24 v66, v160, s82, v149
    v_mad_i32_i24 v78, v160, s82, v155
    v_add_u32 v160, 1221, v158
    v_lshrrev_b32 v160, 8, v160
    v_mad_i32_i24 v55, v160, s82, v148
    v_mad_i32_i24 v67, v160, s82, v149
    v_mad_i32_i24 v79, v160, s82, v155
    v_add_u32 v160, 1258, v158
    v_lshrrev_b32 v160, 8, v160
    v_mad_i32_i24 v56, v160, s82, v148
    v_mad_i32_i24 v68, v160, s82, v149
    v_mad_i32_i24 v80, v160, s82, v155
    v_add_u32 v158, 1295, v158
    v_lshrrev_b32 v158, 8, v158
    v_mad_i32_i24 v57, v158, s82, v148
    v_mad_i32_i24 v69, v158, s82, v149
    v_mad_i32_i24 v81, v158, s82, v155
    v_mov_b32 v155, s81
    v_lshlrev_b32 v148, 4, v114
    v_xor_b32 v2, 65536, v148
    v_lshl_add_u32 v3, s16, 10, v148
    s_lshr_b32 s83, s16, 1
    s_and_b32 s84, s16, 1
    s_lshl_b32 s84, s84, 3
    s_lshl_b32 s85, s83, 10
    s_add_u32 s85, s85, s84
    v_add_u32 v4, s85, v148
    s_lshl_b32 s83, s83, 11
    s_add_u32 s83, s83, s84
    s_add_u32 s83, s83, 157888
    s_mul_i32 s86, s16, 2048
    s_add_u32 s86, s86, 149696
    v_lshl_add_u32 v160, v115, 3, s86
    v_mov_b32 v148, s83
    v_mov_b32 v149, 163264
    v_mul_u32_u24 v158, 80, v115
    v_add3_u32 v5, v158, v122, s72
    v_lshl_add_u32 v6, v118, 2, s73
    s_mul_i32 s87, s16, 128
    s_add_u32 s87, s87, 61760
    s_mov_b32 s32, 0x2a8cbccc
    s_mov_b32 s33, 0x38fba882
    s_add_u32 s75, s28, 16384
    s_cmp_lt_u32 s16, 2
    s_cselect_b32 s29, s75, 161984
    s_cselect_b32 s30, 65536, 0
    s_xor_b32 s74, s29, s30
    s_lshl_b32 s94, s5, 1
    s_or_b32 s94, s94, s6
    s_mul_i32 s77, s16, 64
    s_mul_i32 s78, s16, 32
    s_add_u32 s78, s78, 192
    s_add_u32 s34, s18, 2
    s_mov_b32 s27, s26
    s_mov_b32 s26, s25
    s_add_u32 s19, s19, s20
    s_mov_b32 s18, 1
    s_mov_b32 s71, 1
    buffer_load_dwordx4 v128, s[48:51], 0 offen lds
    v_add_u32 v9, s87, v146
    v_lshrrev_b32 v122, 1, v115
    v_mul_u32_u24 v122, 48, v122
    buffer_load_dwordx4 v130, s[48:51], 0 offen offset:1024 lds
    v_lshl_add_u32 v122, v115, 3, v122
    v_lshl_add_u32 v122, v138, 4, v122
    v_lshl_add_u32 v122, v139, 1, v122
    buffer_load_dwordx4 v132, s[48:51], 0 offen offset:2048 lds
    s_add_u32 s48, s48, 36864
    s_addc_u32 s49, s49, 0
    s_add_u32 m0, s68, 3072
    v_add_u32 v8, s87, v122
    buffer_load_dwordx4 v128, s[48:51], 0 offen lds
    v_mov_b32 v37, 0
    v_mov_b32 v38, 0
    v_mov_b32 v39, 0
    buffer_load_dwordx4 v130, s[48:51], 0 offen offset:1024 lds
    v_add_u32 v161, 86016, v0
    v_add_u32 v174, 86016, v1
    v_lshlrev_b32 v162, 4, v118
    buffer_load_dwordx4 v132, s[48:51], 0 offen offset:2048 lds
    s_add_u32 s48, s48, 36864
    s_addc_u32 s49, s49, 0
    s_add_u32 m0, s69, 0
    buffer_load_ushort v122, v124, s[60:63], 0 offen
    s_mov_b64 s[60:61], s[8:9]
    s_sub_u32 s62, s45, s17
    s_sub_u32 s45, s17, 1
    buffer_load_dwordx3 v[166:168], v131, s[56:59], 0 offen
    v_add_u32 v162, 161984, v162
    buffer_load_dwordx4 v[170:173], v133, s[64:67], 0 offen
    v_mul_u32_u24 v175, 336, v118
    v_add3_u32 v175, v175, v158, s72
    v_mul_u32_u24 v131, 272, v118
    v_add3_u32 v131, v131, v146, s73
    v_mul_u32_u24 v177, 1088, v115
    v_add_u32 v177, v177, v6
    v_add_u32 v176, 5376, v175
    buffer_load_dwordx4 v[186:189], v133, s[64:67], 0 offen offset:16
    v_add_u32 v158, 4352, v131
    v_add_u32 v133, 4352, v177
    v_cmp_gt_u32 s[88:89], 16, v114
    v_mov_b32 v178, 0xf149f2ca
    v_add_u32 v124, 768, v254
    v_mul_u32_u24 v169, 2731, v124
    v_bfe_u32 v163, v169, 17, 3
    v_lshrrev_b32 v169, 16, v169
    v_xor_b32 v124, v163, v124
    v_mul_u32_u24 v163, 37, v169
    v_lshrrev_b32 v163, 8, v163
    v_lshlrev_b32 v124, 4, v124
    v_mad_u32_u24 v13, v163, s70, v124
    v_mul_u32_u24 v163, 37, v169
    v_lshrrev_b32 v163, 8, v163
    v_mul_u32_u24 v124, 7, v163
    v_sub_u32 v124, v169, v124
    v_cmp_gt_u32 vcc, 4, v163
    v_add_u32 v169, 1024, v254
    v_mul_u32_u24 v254, 2731, v169
    v_cndmask_b32 v163, v120, v119, vcc
    v_cmp_gt_u32 vcc, 4, v124
    v_bfe_u32 v164, v254, 17, 3
    v_lshrrev_b32 v254, 16, v254
    v_cndmask_b32 v124, v126, v121, vcc
    v_add3_u32 v13, v13, v163, v124
    v_xor_b32 v169, v164, v169
    v_mul_u32_u24 v164, 37, v254
    v_lshrrev_b32 v164, 8, v164
    v_lshlrev_b32 v169, 4, v169
    v_mad_u32_u24 v14, v164, s70, v169
    v_mul_u32_u24 v169, 37, v254
    v_lshrrev_b32 v169, 8, v169
    v_mul_u32_u24 v124, 7, v169
    v_sub_u32 v124, v254, v124
    v_cmp_gt_u32 vcc, 4, v169
    v_mov_b32 v180, 0xc31044fe
    v_mul_u32_u24 v179, 37, v151
    v_cndmask_b32 v169, v120, v119, vcc
    v_cmp_gt_u32 vcc, 4, v124
    v_lshrrev_b32 v179, 8, v179
    v_mul_u32_u24 v181, 7, v179
    v_cndmask_b32 v124, v126, v121, vcc
    v_add3_u32 v14, v14, v169, v124
    v_cmp_gt_u32 vcc, 48, v254
    v_sub_u32 v181, v151, v181
    v_lshrrev_b32 v179, 2, v179
    v_cndmask_b32 v14, v255, v14, vcc
    v_cmp_gt_u32 vcc, 2, v139
    v_lshrrev_b32 v181, 2, v181
    v_and_b32 v179, s5, v179
    v_cndmask_b32 v32, 0, v136, vcc
    v_cndmask_b32 v33, v136, 0, vcc
    v_cndmask_b32 v34, 0, v136, vcc
    v_cndmask_b32 v35, v136, 0, vcc
    v_cmp_eq_u32 vcc, 0, v139
    v_and_b32 v181, s6, v181
    v_lshl_or_b32 v179, v179, 1, v181
    v_cndmask_b32 v40, 0, v145, vcc
    v_cmp_eq_u32 vcc, 1, v139
    v_mul_u32_u24 v181, 37, v152
    v_lshrrev_b32 v181, 8, v181
    v_cndmask_b32 v41, 0, v145, vcc
    v_cmp_eq_u32 vcc, 2, v139
    v_mul_u32_u24 v124, 7, v181
    v_sub_u32 v124, v152, v124
    s_bfm_b32 s70, s17, 0
    s_waitcnt vmcnt(9)
    s_barrier
    global_load_ushort v116, v116, s[46:47]
    v_cndmask_b32 v42, 0, v145, vcc
    v_cmp_eq_u32 vcc, 3, v139
    v_lshrrev_b32 v181, 2, v181
    v_lshrrev_b32 v124, 2, v124
    v_cndmask_b32 v43, 0, v145, vcc
    v_cmp_eq_u32 vcc, v115, v138
    v_and_b32 v181, s5, v181
    v_and_b32 v124, s6, v124
    v_cndmask_b32 v254, 0, v32, vcc
    v_cndmask_b32 v255, 0, v33, vcc
    v_lshl_or_b32 v181, v181, 1, v124
    buffer_load_dwordx4 v128, s[48:51], 0 offen lds
    v_mul_u32_u24 v145, 37, v159
    v_lshrrev_b32 v145, 8, v145
    v_mul_u32_u24 v124, 7, v145
    v_sub_u32 v124, v159, v124
    v_lshrrev_b32 v145, 2, v145
    v_lshrrev_b32 v124, 2, v124
    v_and_b32 v145, s5, v145
    v_and_b32 v124, s6, v124
    v_lshl_or_b32 v145, v145, 1, v124
    v_mul_u32_u24 v124, 6, v117
    v_sub_u32 v136, v114, v124
    v_mul_u32_u24 v124, 384, v117
    v_lshl_add_u32 v124, v136, 4, v124
    v_add_u32 v117, s78, v124
    v_add_u32 v124, s77, v124
    buffer_load_dwordx4 v130, s[48:51], 0 offen offset:1024 lds
    s_waitcnt vmcnt(10)
    ds_read_b64_tr_b16 a[72:73], v142 offset:0
    ds_read_b64_tr_b16 a[74:75], v142 offset:768
    ds_read_b64_tr_b16 a[96:97], v142 offset:32
    ds_read_b64_tr_b16 a[98:99], v142 offset:800
    ds_read_b64_tr_b16 a[120:121], v142 offset:64
    ds_read_b64_tr_b16 a[122:123], v142 offset:832
    v_cmp_gt_i32 vcc, 4, v136
    v_mul_u32_u24 v136, 6, v127
    v_sub_u32 v159, v114, v136
    v_cndmask_b32 v117, v117, v124, vcc
    v_mul_u32_u24 v136, 384, v127
    v_lshl_add_u32 v136, v159, 4, v136
    v_add_u32 v124, s78, v136
    v_add_u32 v136, s77, v136
    buffer_load_dwordx4 v132, s[48:51], 0 offen offset:2048 lds
    s_add_u32 s48, s48, 36864
    s_addc_u32 s49, s49, 0
    s_add_u32 m0, s69, 3072
    v_cmp_gt_i32 vcc, -60, v159
    v_mul_u32_u24 v169, 6, v129
    v_sub_u32 v114, v114, v169
    v_cndmask_b32 v159, v124, v136, vcc
    v_mul_u32_u24 v169, 384, v129
    v_lshl_add_u32 v169, v114, 4, v169
    v_add_u32 v136, s78, v169
    v_add_u32 v169, s77, v169
    v_cmp_gt_i32 vcc, -124, v114
    v_mul_u32_u24 v124, 96, v118
    v_add3_u32 v127, v124, v146, s68
    v_cndmask_b32 v114, v136, v169, vcc
    s_and_b32 s77, s2, 0xf8
    s_add_u32 s77, s77, 4940
    s_mul_i32 s78, s77, 58255
    s_lshr_b32 s78, s78, 22
    buffer_load_dwordx4 v128, s[48:51], 0 offen lds
    v_cmp_gt_u32 vcc, 4, v150
    v_lshl_add_u32 v129, v115, 3, v124
    v_add3_u32 v129, v129, 64, s68
    v_cndmask_b32 v150, v120, v119, vcc
    v_cmp_gt_u32 vcc, 4, v153
    v_add3_u32 v182, v124, v146, s69
    v_lshl_add_u32 v183, v115, 3, v124
    v_cndmask_b32 v153, v126, v121, vcc
    v_add3_u32 v15, v15, v150, v153
    s_waitcnt vmcnt(9)
    ds_read_b64_tr_b16 a[76:77], v142 offset:3072
    ds_read_b64_tr_b16 a[78:79], v142 offset:3840
    s_waitcnt vmcnt(7)
    ds_read_b64_tr_b16 a[100:101], v142 offset:3104
    s_waitcnt vmcnt(6)
    ds_read_b64_tr_b16 a[102:103], v142 offset:3872
    s_waitcnt vmcnt(5)
    buffer_load_dwordx4 v130, s[48:51], 0 offen offset:1024 lds
    ds_read_b64_tr_b16 a[124:125], v142 offset:3136
    ds_read_b64_tr_b16 a[126:127], v142 offset:3904
    v_cndmask_b32 v170, v170, v171, s[92:93]
    v_cndmask_b32 v172, v172, v173, s[92:93]
    v_perm_b32 v184, v172, v170, v134
    v_cndmask_b32 v186, v186, v187, s[92:93]
    v_cndmask_b32 v188, v188, v189, s[92:93]
    v_perm_b32 v185, v188, v186, v134
    v_bfe_u32 v136, v166, v146, 16
    v_bfe_u32 v134, v167, v146, 16
    v_bfe_u32 v124, v168, v146, 16
    v_mfma_f32_16x16x16_bf16 v[170:173], v[122:123], v[136:137], 0
    v_add3_u32 v18, v18, v150, v153
    v_cmp_gt_u32 vcc, 4, v154
    v_add3_u32 v183, v183, 64, s69
    v_mfma_f32_16x16x16_bf16 v[150:153], v[122:123], v[134:135], 0
    v_cndmask_b32 v154, v120, v119, vcc
    v_cmp_gt_u32 vcc, 4, v157
    v_mfma_f32_16x16x16_bf16 v[134:137], v[122:123], v[124:125], 0
    buffer_load_dwordx4 v132, s[48:51], 0 offen offset:2048 lds
    s_add_u32 s48, s48, 36864
    s_addc_u32 s49, s49, 0
    s_add_u32 m0, s72, 0
    v_max_f32 v170, 0, v170
    v_max_f32 v171, 0, v171
    v_max_f32 v172, 0, v172
    v_max_f32 v173, 0, v173
    v_cvt_pk_bf16_f32 v164, v170, v171
    v_cvt_pk_bf16_f32 v165, v172, v173
    v_max_f32 v150, 0, v150
    v_max_f32 v151, 0, v151
    s_waitcnt vmcnt(6)
    v_mfma_f32_16x16x16_bf16 v[122:125], v[184:185], v[164:165], 0
    v_lshlrev_b32 v116, 16, v116
    buffer_load_dwordx4 v128, s[48:51], 0 offen lds
    v_max_f32 v116, 0xc2c80000, v116
    v_min_f32 v116, 0x40930000, v116
    v_mul_f32 v116, 0x3fb8aa3b, v116
    v_exp_f32 v116, v116
    v_max_f32 v152, 0, v152
    v_cvt_pk_bf16_f32 v116, v116, v116
    v_and_b32 v116, 0xffff0000, v116
    v_mul_f32 v116, 0x3fb8aa3b, v116
    v_mul_f32 v146, 0xbea8f5c3, v116
    v_add_f32 v146, 0xc138aa3b, v146
    v_readlane_b32 s31, v116, s90
    v_cvt_pk_bf16_f32 v122, v122, v122
    v_and_b32 v122, 0xffff0000, v122
    v_mul_f32 v122, 0xbfb8aa3b, v122
    buffer_load_dwordx4 v130, s[48:51], 0 offen offset:1024 lds
    v_exp_f32 v122, v122
    v_max_f32 v153, 0, v153
    v_add_f32 v122, 1.0, v122
    v_rcp_f32 v122, v122
    v_cvt_pk_bf16_f32 v150, v150, v151
    v_cvt_pk_bf16_f32 v122, v122, v122
    v_and_b32 v122, 0xffff0000, v122
    v_fmamk_f32 v122, v122, 0x41b8aa3b, v146
    ds_write_b32 v144, v122 offset:0
    v_cvt_pk_bf16_f32 v151, v152, v153
    buffer_load_dwordx4 v132, s[48:51], 0 offen offset:2048 lds
    s_add_u32 s48, s48, 36864
    v_mfma_f32_16x16x16_bf16 v[122:125], v[184:185], v[150:151], 0
    s_addc_u32 s49, s49, 0
    s_add_u32 m0, s72, 3072
    v_max_f32 v134, 0, v134
    v_max_f32 v135, 0, v135
    v_max_f32 v136, 0, v136
    v_max_f32 v137, 0, v137
    v_cvt_pk_bf16_f32 v134, v134, v135
    s_waitcnt vmcnt(6)
    s_mov_b32 s72, 2
    ds_read_b64_tr_b16 a[80:81], v140 offset:0
    ds_read_b64_tr_b16 a[82:83], v140 offset:768
    ds_read_b64_tr_b16 a[104:105], v140 offset:32
    ds_read_b64_tr_b16 a[106:107], v140 offset:800
    ds_read_b64_tr_b16 a[128:129], v140 offset:64
    ds_read_b64_tr_b16 a[130:131], v140 offset:832
    buffer_load_dwordx4 v128, s[48:51], 0 offen lds
    v_cvt_pk_bf16_f32 v122, v122, v122
    v_and_b32 v122, 0xffff0000, v122
    v_mul_f32 v122, 0xbfb8aa3b, v122
    v_exp_f32 v122, v122
    v_cvt_pk_bf16_f32 v135, v136, v137
    v_add_f32 v122, 1.0, v122
    v_rcp_f32 v122, v122
    v_mfma_f32_16x16x16_bf16 v[150:153], v[184:185], v[134:135], 0
    v_cvt_pk_bf16_f32 v122, v122, v122
    v_and_b32 v122, 0xffff0000, v122
    v_fmamk_f32 v122, v122, 0x41b8aa3b, v146
    ds_write_b32 v144, v122 offset:4
    buffer_load_dwordx4 v130, s[48:51], 0 offen offset:1024 lds
    v_cndmask_b32 v157, v126, v121, vcc
    v_add3_u32 v16, v16, v154, v157
    v_add3_u32 v19, v19, v154, v157
    v_cvt_pk_bf16_f32 v150, v150, v150
    v_and_b32 v150, 0xffff0000, v150
    v_mul_f32 v150, 0xbfb8aa3b, v150
    v_exp_f32 v150, v150
    v_cmp_gt_u32 vcc, 4, v156
    v_add_f32 v150, 1.0, v150
    v_rcp_f32 v150, v150
    v_cndmask_b32 v156, v120, v119, vcc
    v_cvt_pk_bf16_f32 v150, v150, v150
    v_and_b32 v150, 0xffff0000, v150
    buffer_load_dwordx4 v132, s[48:51], 0 offen offset:2048 lds
    s_sub_u32 s48, s48, 184704
    s_subb_u32 s49, s49, 0
    s_add_u32 m0, s73, 0
    v_fmamk_f32 v150, v150, 0x41b8aa3b, v146
    ds_write_b32 v144, v150 offset:8
    v_cmp_gt_u32 vcc, 4, v147
    s_nop 0
    s_nop 0
    v_cndmask_b32 v147, v126, v121, vcc
    v_add3_u32 v17, v17, v156, v147
    v_add3_u32 v20, v20, v156, v147
    v_cmp_gt_u32 vcc, 2, v115
    buffer_load_dwordx4 v128, s[48:51], 0 offen lds
    s_waitcnt vmcnt(7)
    ds_read_b64_tr_b16 a[84:85], v140 offset:3072
    ds_read_b64_tr_b16 a[86:87], v140 offset:3840
    ds_read_b64_tr_b16 a[108:109], v140 offset:3104
    ds_read_b64_tr_b16 a[110:111], v140 offset:3872
    ds_read_b64_tr_b16 a[132:133], v140 offset:3136
    ds_read_b64_tr_b16 a[134:135], v140 offset:3904
    v_cndmask_b32 v160, v148, v160, vcc
    v_lshl_add_u32 v160, v138, 9, v160
    v_lshl_add_u32 v160, v139, 1, v160
    v_cmp_gt_u32 vcc, 3, v115
    s_nop 0
    s_nop 0
    v_cndmask_b32 v7, v149, v160, vcc
    v_cmp_gt_u32 vcc, 12, v118
    buffer_load_dwordx4 v130, s[48:51], 0 offen offset:1024 lds
    s_waitcnt lgkmcnt(6)
    s_barrier
    ds_read_b32 v22, v22 offset:0
    ds_read_b32 v23, v23 offset:672
    ds_read_b32 v24, v24 offset:0
    ds_read_b32 v25, v25 offset:672
    ds_read_b32 v26, v26 offset:0
    ds_read_b32 v27, v27 offset:672
    ds_read_b32 v46, v46 offset:336
    ds_read_b32 v58, v58 offset:336
    v_cndmask_b32 v176, v162, v176, vcc
    v_cndmask_b32 v158, v162, v158, vcc
    v_cmp_gt_u32 vcc, 3, v115
    ds_read_b32 v70, v70 offset:336
    ds_read_b32 v47, v47 offset:332
    buffer_load_dwordx4 v132, s[48:51], 0 offen offset:2048 lds
    ds_read_b32 v59, v59 offset:332
    ds_read_b32 v71, v71 offset:332
    ds_read_b32 v48, v48 offset:328
    ds_read_b32 v60, v60 offset:328
    s_add_u32 s48, s48, 36864
    ds_read_b32 v72, v72 offset:328
    s_addc_u32 s49, s49, 0
    ds_read_b32 v49, v49 offset:324
    s_add_u32 m0, s73, 3072
    ds_read_b32 v61, v61 offset:324
    v_cndmask_b32 v133, v162, v133, vcc
    s_mov_b32 s73, 3
    ds_read_b32 v73, v73 offset:324
    ds_read_b32 v50, v50 offset:272
    ds_read_b32 v62, v62 offset:272
    s_waitcnt vmcnt(6)
    buffer_load_dwordx4 v128, s[48:51], 0 offen lds
    ds_read_b64_tr_b16 a[88:89], v141 offset:0
    ds_read_b64_tr_b16 a[90:91], v141 offset:768
    ds_read_b64_tr_b16 a[112:113], v141 offset:32
    ds_read_b64_tr_b16 a[114:115], v141 offset:800
    ds_read_b64_tr_b16 a[136:137], v141 offset:64
    ds_read_b64_tr_b16 a[138:139], v141 offset:832
    ds_read_b32 v74, v74 offset:272
    ds_read_b32 v51, v51 offset:268
    ds_read_b32 v63, v63 offset:268
    buffer_load_dwordx4 v130, s[48:51], 0 offen offset:1024 lds
    ds_read_b32 v75, v75 offset:268
    ds_read_b32 v52, v52 offset:264
    ds_read_b32 v64, v64 offset:264
    ds_read_b32 v76, v76 offset:264
    ds_read_b32 v53, v53 offset:260
    ds_read_b32 v65, v65 offset:260
    ds_read_b32 v77, v77 offset:260
    ds_read_b32 v54, v54 offset:208
    ds_read_b32 v66, v66 offset:208
    buffer_load_dwordx4 v132, s[48:51], 0 offen offset:2048 lds
    ds_read_b32 v78, v78 offset:208
    ds_read_b32 v55, v55 offset:204
    s_add_u32 s48, s48, 36864
    ds_read_b32 v67, v67 offset:204
    s_addc_u32 s49, s49, 0
    ds_read_b32 v79, v79 offset:204
    s_add_u32 m0, s68, 0
    ds_read_b32 v56, v56 offset:200
    ds_read_b32 v68, v68 offset:200
    ds_read_b32 v80, v80 offset:200
    ds_read_b32 v57, v57 offset:196
    ds_read_b32 v69, v69 offset:196
    s_waitcnt vmcnt(6)
    buffer_load_dwordx4 v128, s[48:51], 0 offen lds
    ds_read_b64_tr_b16 a[92:93], v141 offset:3072
    ds_read_b64_tr_b16 a[94:95], v141 offset:3840
    ds_read_b64_tr_b16 a[116:117], v141 offset:3104
    ds_read_b64_tr_b16 a[118:119], v141 offset:3872
    ds_read_b64_tr_b16 a[140:141], v141 offset:3136
    ds_read_b64_tr_b16 a[142:143], v141 offset:3904
    ds_read_b32 v81, v81 offset:196
    ds_read_b32 v155, v155 offset:336
    v_cmp_ne_u32 vcc, s94, v179
    buffer_load_dwordx4 v130, s[48:51], 0 offen offset:1024 lds
    v_lshl_add_u32 v126, v115, 2, 0
    v_cndmask_b32 v116, 0, v180, vcc
    s_waitcnt lgkmcnt(11)
    v_add_f32 v22, v22, v116
    v_cmp_ne_u32 vcc, s94, v179
    v_mul_u32_u24 v116, 37, v126
    v_lshrrev_b32 v116, 8, v116
    v_cndmask_b32 v144, 0, v180, vcc
    v_add_f32 v23, v23, v144
    v_cmp_ne_u32 vcc, s94, v181
    v_mul_u32_u24 v144, 7, v116
    v_sub_u32 v144, v126, v144
    v_cndmask_b32 v126, 0, v180, vcc
    v_add_f32 v24, v24, v126
    v_cmp_ne_u32 vcc, s94, v181
    buffer_load_dwordx4 v132, s[48:51], 0 offen offset:2048 lds
    s_add_u32 s48, s48, 36864
    s_addc_u32 s49, s49, 0
    s_add_u32 m0, s68, 3072
    v_cndmask_b32 v126, 0, v180, vcc
    s_waitcnt lgkmcnt(0)
    v_readfirstlane_b32 s39, v155
    v_add_f32 v25, v25, v126
    v_cmp_ne_u32 vcc, s94, v145
    v_lshrrev_b32 v116, 2, v116
    v_lshrrev_b32 v144, 2, v144
    v_cndmask_b32 v126, 0, v180, vcc
    v_add_f32 v26, v26, v126
    v_cmp_ne_u32 vcc, s94, v145
    v_and_b32 v116, s5, v116
    buffer_load_dwordx4 v128, s[48:51], 0 offen lds
    s_waitcnt vmcnt(7)
    ds_read_b64_tr_b16 a[0:1], v143 offset:0
    ds_read_b64_tr_b16 a[2:3], v143 offset:768
    ds_read_b64_tr_b16 a[24:25], v143 offset:32
    ds_read_b64_tr_b16 a[26:27], v143 offset:800
    ds_read_b64_tr_b16 a[48:49], v143 offset:64
    ds_read_b64_tr_b16 a[50:51], v143 offset:832
    v_cndmask_b32 v126, 0, v180, vcc
    v_add_f32 v27, v27, v126
    v_and_b32 v144, s6, v144
    v_lshl_or_b32 v116, v116, 1, v144
    v_cmp_ne_u32 vcc, v116, v179
    v_lshl_add_u32 v160, v115, 2, 1
    v_mul_u32_u24 v144, 37, v160
    v_cndmask_b32 v126, 0, v180, vcc
    buffer_load_dwordx4 v130, s[48:51], 0 offen offset:1024 lds
    v_add_f32 v46, v46, v126
    v_cmp_ne_u32 vcc, v116, v181
    v_lshrrev_b32 v144, 8, v144
    v_mul_u32_u24 v184, 7, v144
    v_cndmask_b32 v126, 0, v180, vcc
    v_add_f32 v58, v58, v126
    v_cmp_ne_u32 vcc, v116, v145
    v_sub_u32 v184, v160, v184
    v_lshrrev_b32 v144, 2, v144
    v_cndmask_b32 v116, 0, v180, vcc
    v_add_f32 v70, v70, v116
    v_lshrrev_b32 v184, 2, v184
    v_and_b32 v144, s5, v144
    v_and_b32 v184, s6, v184
    v_lshl_or_b32 v144, v144, 1, v184
    buffer_load_dwordx4 v132, s[48:51], 0 offen offset:2048 lds
    s_add_u32 s48, s48, 36864
    s_addc_u32 s49, s49, 0
    s_add_u32 m0, s69, 0
    v_cmp_ne_u32 vcc, v144, v179
    v_lshl_add_u32 v116, v115, 2, 2
    v_mul_u32_u24 v126, 37, v116
    v_cndmask_b32 v160, 0, v180, vcc
    v_add_f32 v47, v47, v160
    v_cmp_ne_u32 vcc, v144, v181
    v_lshrrev_b32 v126, 8, v126
    v_mul_u32_u24 v160, 7, v126
    v_cndmask_b32 v184, 0, v180, vcc
    v_add_f32 v59, v59, v184
    v_cmp_ne_u32 vcc, v144, v145
    v_sub_u32 v160, v116, v160
    buffer_load_dwordx4 v128, s[48:51], 0 offen lds
    s_waitcnt vmcnt(7)
    ds_read_b64_tr_b16 a[4:5], v143 offset:3072
    ds_read_b64_tr_b16 a[6:7], v143 offset:3840
    ds_read_b64_tr_b16 a[28:29], v143 offset:3104
    ds_read_b64_tr_b16 a[30:31], v143 offset:3872
    ds_read_b64_tr_b16 a[52:53], v143 offset:3136
    ds_read_b64_tr_b16 a[54:55], v143 offset:3904
    v_cndmask_b32 v116, 0, v180, vcc
    v_add_f32 v71, v71, v116
    v_lshrrev_b32 v126, 2, v126
    v_lshrrev_b32 v160, 2, v160
    v_and_b32 v126, s5, v126
    v_and_b32 v160, s6, v160
    v_lshl_or_b32 v126, v126, 1, v160
    v_cmp_ne_u32 vcc, v126, v179
    buffer_load_dwordx4 v130, s[48:51], 0 offen offset:1024 lds
    v_lshl_add_u32 v116, v115, 2, 3
    v_cndmask_b32 v160, 0, v180, vcc
    v_add_f32 v48, v48, v160
    v_cmp_ne_u32 vcc, v126, v181
    v_mul_u32_u24 v160, 37, v116
    v_lshrrev_b32 v160, 8, v160
    v_cndmask_b32 v143, 0, v180, vcc
    v_add_f32 v60, v60, v143
    v_cmp_ne_u32 vcc, v126, v145
    v_mul_u32_u24 v126, 7, v160
    v_sub_u32 v126, v116, v126
    v_cndmask_b32 v116, 0, v180, vcc
    v_add_f32 v72, v72, v116
    v_lshrrev_b32 v160, 2, v160
    v_lshrrev_b32 v126, 2, v126
    buffer_load_dwordx4 v132, s[48:51], 0 offen offset:2048 lds
    s_add_u32 s48, s48, 36864
    s_addc_u32 s49, s49, 0
    s_add_u32 m0, s69, 3072
    v_and_b32 v160, s5, v160
    v_and_b32 v126, s6, v126
    v_lshl_or_b32 v160, v160, 1, v126
    v_cmp_ne_u32 vcc, v160, v179
    v_lshl_add_u32 v126, v115, 2, 16
    v_mul_u32_u24 v116, 37, v126
    v_cndmask_b32 v143, 0, v180, vcc
    v_add_f32 v49, v49, v143
    v_cmp_ne_u32 vcc, v160, v181
    v_lshrrev_b32 v116, 8, v116
    v_mul_u32_u24 v143, 7, v116
    v_cndmask_b32 v144, 0, v180, vcc
    buffer_load_dwordx4 v128, s[48:51], 0 offen lds
    s_waitcnt vmcnt(7)
    ds_read_b64_tr_b16 a[8:9], v142 offset:0
    ds_read_b64_tr_b16 a[10:11], v142 offset:768
    ds_read_b64_tr_b16 a[32:33], v142 offset:32
    ds_read_b64_tr_b16 a[34:35], v142 offset:800
    ds_read_b64_tr_b16 a[56:57], v142 offset:64
    ds_read_b64_tr_b16 a[58:59], v142 offset:832
    v_add_f32 v61, v61, v144
    v_cmp_ne_u32 vcc, v160, v145
    v_sub_u32 v143, v126, v143
    v_lshrrev_b32 v116, 2, v116
    v_cndmask_b32 v126, 0, v180, vcc
    v_add_f32 v73, v73, v126
    v_lshrrev_b32 v143, 2, v143
    v_and_b32 v116, s5, v116
    buffer_load_dwordx4 v130, s[48:51], 0 offen offset:1024 lds
    v_and_b32 v143, s6, v143
    v_lshl_or_b32 v116, v116, 1, v143
    v_cmp_ne_u32 vcc, v116, v179
    v_lshl_add_u32 v126, v115, 2, 17
    v_mul_u32_u24 v143, 37, v126
    v_cndmask_b32 v160, 0, v180, vcc
    v_add_f32 v50, v50, v160
    v_cmp_ne_u32 vcc, v116, v181
    v_lshrrev_b32 v143, 8, v143
    v_mul_u32_u24 v160, 7, v143
    v_cndmask_b32 v144, 0, v180, vcc
    v_add_f32 v62, v62, v144
    v_cmp_ne_u32 vcc, v116, v145
    v_sub_u32 v160, v126, v160
    v_lshrrev_b32 v143, 2, v143
    buffer_load_dwordx4 v132, s[48:51], 0 offen offset:2048 lds
    s_sub_u32 s48, s48, 183552
    s_subb_u32 s49, s49, 0
    s_add_u32 m0, s68, 0
    s_waitcnt lgkmcnt(0)
    v_cndmask_b32 v116, 0, v180, vcc
    v_add_f32 v74, v74, v116
    v_lshrrev_b32 v160, 2, v160
    v_and_b32 v143, s5, v143
    v_and_b32 v160, s6, v160
    v_lshl_or_b32 v143, v143, 1, v160
    v_cmp_ne_u32 vcc, v143, v179
    v_lshl_add_u32 v116, v115, 2, 18
    v_mul_u32_u24 v126, 37, v116
    v_cndmask_b32 v144, 0, v180, vcc
    v_add_f32 v51, v51, v144
    buffer_load_dwordx4 v128, s[48:51], 0 offen lds
    s_waitcnt vmcnt(7)
    ds_read_b64_tr_b16 a[12:13], v142 offset:3072
    ds_read_b64_tr_b16 a[14:15], v142 offset:3840
    ds_read_b64_tr_b16 a[36:37], v142 offset:3104
    ds_read_b64_tr_b16 a[38:39], v142 offset:3872
    ds_read_b64_tr_b16 a[60:61], v142 offset:3136
    ds_read_b64_tr_b16 a[62:63], v142 offset:3904
    v_cmp_ne_u32 vcc, v143, v181
    v_lshrrev_b32 v126, 8, v126
    v_mul_u32_u24 v160, 7, v126
    v_cndmask_b32 v144, 0, v180, vcc
    v_add_f32 v63, v63, v144
    v_cmp_ne_u32 vcc, v143, v145
    v_sub_u32 v160, v116, v160
    v_lshrrev_b32 v126, 2, v126
    buffer_load_dwordx4 v130, s[48:51], 0 offen offset:1024 lds
    v_cndmask_b32 v116, 0, v180, vcc
    v_add_f32 v75, v75, v116
    v_lshrrev_b32 v160, 2, v160
    v_and_b32 v126, s5, v126
    v_and_b32 v160, s6, v160
    v_lshl_or_b32 v126, v126, 1, v160
    v_cmp_ne_u32 vcc, v126, v179
    v_lshl_add_u32 v116, v115, 2, 19
    v_mul_u32_u24 v143, 37, v116
    v_cndmask_b32 v160, 0, v180, vcc
    v_add_f32 v52, v52, v160
    v_cmp_ne_u32 vcc, v126, v181
    v_lshrrev_b32 v143, 8, v143
    v_mul_u32_u24 v160, 7, v143
    v_cndmask_b32 v144, 0, v180, vcc
    buffer_load_dwordx4 v132, s[48:51], 0 offen offset:2048 lds
    s_add_u32 s48, s48, 36864
    s_addc_u32 s49, s49, 0
    s_add_u32 m0, s68, 3072
    s_waitcnt lgkmcnt(0)
    v_add_f32 v64, v64, v144
    v_cmp_ne_u32 vcc, v126, v145
    v_sub_u32 v160, v116, v160
    v_lshrrev_b32 v143, 2, v143
    v_cndmask_b32 v116, 0, v180, vcc
    v_add_f32 v76, v76, v116
    v_lshrrev_b32 v160, 2, v160
    v_and_b32 v143, s5, v143
    v_and_b32 v160, s6, v160
    v_lshl_or_b32 v143, v143, 1, v160
    v_cmp_ne_u32 vcc, v143, v179
    buffer_load_dwordx4 v128, s[48:51], 0 offen lds
    s_waitcnt vmcnt(7)
    ds_read_b64_tr_b16 a[16:17], v140 offset:0
    ds_read_b64_tr_b16 a[18:19], v140 offset:768
    ds_read_b64_tr_b16 a[40:41], v140 offset:32
    ds_read_b64_tr_b16 a[42:43], v140 offset:800
    ds_read_b64_tr_b16 a[64:65], v140 offset:64
    ds_read_b64_tr_b16 a[66:67], v140 offset:832
    v_cndmask_b32 v116, 0, v180, vcc
    v_add_f32 v53, v53, v116
    v_cmp_ne_u32 vcc, v143, v181
    v_lshl_add_u32 v160, v115, 2, 32
    v_mul_u32_u24 v126, 37, v160
    v_cndmask_b32 v116, 0, v180, vcc
    v_add_f32 v65, v65, v116
    v_cmp_ne_u32 vcc, v143, v145
    buffer_load_dwordx4 v130, s[48:51], 0 offen offset:1024 lds
    v_lshrrev_b32 v126, 8, v126
    v_cndmask_b32 v116, 0, v180, vcc
    v_add_f32 v77, v77, v116
    v_mul_u32_u24 v116, 7, v126
    v_sub_u32 v116, v160, v116
    v_lshrrev_b32 v126, 2, v126
    v_lshrrev_b32 v116, 2, v116
    v_and_b32 v126, s5, v126
    v_and_b32 v116, s6, v116
    v_lshl_or_b32 v126, v126, 1, v116
    v_cmp_ne_u32 vcc, v126, v179
    v_lshl_add_u32 v143, v115, 2, 33
    v_mul_u32_u24 v160, 37, v143
    v_cndmask_b32 v116, 0, v180, vcc
    v_add_f32 v54, v54, v116
    buffer_load_dwordx4 v132, s[48:51], 0 offen offset:2048 lds
    s_add_u32 s48, s48, 36864
    s_addc_u32 s49, s49, 0
    s_add_u32 m0, s69, 0
    s_waitcnt lgkmcnt(0)
    v_cmp_ne_u32 vcc, v126, v181
    v_lshrrev_b32 v160, 8, v160
    v_mul_u32_u24 v144, 7, v160
    v_cndmask_b32 v116, 0, v180, vcc
    v_add_f32 v66, v66, v116
    v_cmp_ne_u32 vcc, v126, v145
    v_sub_u32 v144, v143, v144
    v_lshrrev_b32 v160, 2, v160
    v_cndmask_b32 v116, 0, v180, vcc
    v_add_f32 v78, v78, v116
    v_lshrrev_b32 v144, 2, v144
    buffer_load_dwordx4 v128, s[48:51], 0 offen lds
    s_waitcnt vmcnt(7)
    ds_read_b64_tr_b16 a[20:21], v140 offset:3072
    ds_read_b64_tr_b16 a[22:23], v140 offset:3840
    ds_read_b64_tr_b16 a[44:45], v140 offset:3104
    ds_read_b64_tr_b16 a[46:47], v140 offset:3872
    ds_read_b64_tr_b16 a[68:69], v140 offset:3136
    ds_read_b64_tr_b16 a[70:71], v140 offset:3904
    v_and_b32 v160, s5, v160
    v_and_b32 v144, s6, v144
    v_lshl_or_b32 v160, v160, 1, v144
    v_cmp_ne_u32 vcc, v160, v179
    v_lshl_add_u32 v116, v115, 2, 34
    v_mul_u32_u24 v126, 37, v116
    v_cndmask_b32 v143, 0, v180, vcc
    v_add_f32 v55, v55, v143
    buffer_load_dwordx4 v130, s[48:51], 0 offen offset:1024 lds
    v_cmp_ne_u32 vcc, v160, v181
    v_lshrrev_b32 v126, 8, v126
    v_mul_u32_u24 v144, 7, v126
    v_cndmask_b32 v143, 0, v180, vcc
    v_add_f32 v67, v67, v143
    v_cmp_ne_u32 vcc, v160, v145
    v_sub_u32 v144, v116, v144
    v_lshrrev_b32 v126, 2, v126
    v_cndmask_b32 v116, 0, v180, vcc
    v_add_f32 v79, v79, v116
    v_lshrrev_b32 v144, 2, v144
    v_and_b32 v126, s5, v126
    v_and_b32 v144, s6, v144
    v_lshl_or_b32 v126, v126, 1, v144
    v_cmp_ne_u32 vcc, v126, v179
    buffer_load_dwordx4 v132, s[48:51], 0 offen offset:2048 lds
    s_add_u32 s48, s48, 36864
    s_addc_u32 s49, s49, 0
    s_add_u32 m0, s69, 3072
    s_waitcnt lgkmcnt(0)
    v_cndmask_b32 v116, 0, v180, vcc
    v_add_f32 v56, v56, v116
    v_cmp_ne_u32 vcc, v126, v181
    v_lshl_add_u32 v160, v115, 2, 35
    v_mul_u32_u24 v116, 37, v160
    v_cndmask_b32 v115, 0, v180, vcc
    v_add_f32 v68, v68, v115
    v_cmp_ne_u32 vcc, v126, v145
    v_lshrrev_b32 v116, 8, v116
    v_mul_u32_u24 v115, 7, v116
    buffer_load_dwordx4 v128, s[48:51], 0 offen lds
    s_waitcnt vmcnt(7)
    ds_read_b64_tr_b16 a[144:145], v142 offset:0
    ds_read_b64_tr_b16 a[146:147], v142 offset:768
    ds_read_b64_tr_b16 a[168:169], v142 offset:32
    ds_read_b64_tr_b16 a[170:171], v142 offset:800
    ds_read_b64_tr_b16 a[192:193], v142 offset:64
    ds_read_b64_tr_b16 a[194:195], v142 offset:832
    v_cndmask_b32 v126, 0, v180, vcc
    v_add_f32 v80, v80, v126
    v_sub_u32 v115, v160, v115
    v_lshrrev_b32 v116, 2, v116
    v_lshrrev_b32 v115, 2, v115
    v_and_b32 v116, s5, v116
    v_and_b32 v115, s6, v115
    v_lshl_or_b32 v116, v116, 1, v115
    buffer_load_dwordx4 v130, s[48:51], 0 offen offset:1024 lds
    v_cmp_ne_u32 vcc, v116, v179
    v_cndmask_b32 v22, v178, v22, s[88:89]
    v_cndmask_b32 v24, v178, v24, s[88:89]
    v_cndmask_b32 v115, 0, v180, vcc
    v_add_f32 v57, v57, v115
    v_cmp_ne_u32 vcc, v116, v181
    v_mov_b32_dpp v23, v25 quad_perm:[0,1,2,3] row_mask:0x2 bank_mask:0xf
    v_cndmask_b32 v26, v178, v26, s[88:89]
    v_cndmask_b32 v115, 0, v180, vcc
    v_add_f32 v69, v69, v115
    v_cmp_ne_u32 vcc, v116, v145
    v_mov_b32_dpp v23, v27 quad_perm:[0,1,2,3] row_mask:0x4 bank_mask:0xf
    v_mov_b32 v134, 0
    v_cndmask_b32 v126, 0, v180, vcc
    v_add_f32 v81, v81, v126
    buffer_load_dwordx4 v132, s[48:51], 0 offen offset:2048 lds
    ds_read_b128 v[122:125], v161 offset:0
    ds_read_b128 v[170:173], v174 offset:0
    ds_read_b128 v[118:121], v161 offset:128
    s_add_u32 s48, s48, 36864
    s_addc_u32 s49, s49, 0
    ds_read_b128 v[150:153], v174 offset:128
    s_add_u32 m0, s68, 0
    s_waitcnt lgkmcnt(4)
    ds_read_b128 v[166:169], v161 offset:256
    ds_read_b128 v[162:165], v174 offset:256
    v_mov_b32 v135, 0
    buffer_load_dwordx4 v128, s[48:51], 0 offen lds
    s_waitcnt vmcnt(7)
    ds_read_b64_tr_b16 a[148:149], v142 offset:3072
    ds_read_b64_tr_b16 a[150:151], v142 offset:3840
    ds_read_b64_tr_b16 a[172:173], v142 offset:3104
    ds_read_b64_tr_b16 a[174:175], v142 offset:3872
    ds_read_b64_tr_b16 a[196:197], v142 offset:3136
    ds_read_b64_tr_b16 a[198:199], v142 offset:3904
    s_waitcnt lgkmcnt(11)
    v_mfma_f32_16x16x32_bf16 v[146:149], a[72:75], v[122:125], 0
    s_waitcnt lgkmcnt(9)
    ds_write_b64 v175, v[134:135] offset:56
    v_mfma_f32_16x16x32_bf16 v[146:149], a[76:79], v[170:173], v[146:149]
    s_waitcnt lgkmcnt(9)
    buffer_load_dwordx4 v130, s[48:51], 0 offen offset:1024 lds
    v_mov_b32 v136, 0
    v_mfma_f32_16x16x32_bf16 v[146:149], a[80:83], v[118:121], v[146:149]
    s_waitcnt lgkmcnt(8)
    ds_write_b64 v175, v[134:135] offset:64
    v_mfma_f32_16x16x32_bf16 v[146:149], a[84:87], v[150:153], v[146:149]
    s_waitcnt lgkmcnt(8)
    v_mov_b32 v137, 0
    v_mfma_f32_16x16x32_bf16 v[146:149], a[88:91], v[166:169], v[146:149]
    s_waitcnt lgkmcnt(6)
    ds_write_b128 v175, v[134:137] offset:16
    v_mfma_f32_16x16x32_bf16 v[146:149], a[92:95], v[162:165], v[146:149]
    s_waitcnt lgkmcnt(3)
    buffer_load_dwordx4 v132, s[48:51], 0 offen offset:2048 lds
    s_add_u32 s48, s48, 36864
    v_mfma_f32_16x16x32_bf16 v[154:157], a[96:99], v[122:125], 0
    s_addc_u32 s49, s49, 0
    s_add_u32 m0, s68, 3072
    v_mfma_f32_16x16x32_bf16 v[154:157], a[100:103], v[170:173], v[154:157]
    ds_write_b128 v176, v[134:137] offset:16
    v_mfma_f32_16x16x32_bf16 v[154:157], a[104:107], v[118:121], v[154:157]
    s_waitcnt vmcnt(6)
    v_fma_f32 v160, v146, v146, s32
    v_fmac_f32 v160, v147, v147
    v_mfma_f32_16x16x32_bf16 v[154:157], a[108:111], v[150:153], v[154:157]
    buffer_load_dwordx4 v128, s[48:51], 0 offen lds
    v_fmac_f32 v160, v148, v148
    v_mfma_f32_16x16x32_bf16 v[154:157], a[112:115], v[166:169], v[154:157]
    ds_read_b64_tr_b16 a[152:153], v140 offset:0
    ds_read_b64_tr_b16 a[154:155], v140 offset:768
    v_mfma_f32_16x16x32_bf16 v[154:157], a[116:119], v[162:165], v[154:157]
    ds_read_b64_tr_b16 a[176:177], v140 offset:32
    ds_read_b64_tr_b16 a[178:179], v140 offset:800
    v_mfma_f32_16x16x32_bf16 v[190:193], a[120:123], v[122:125], 0
    ds_read_b64_tr_b16 a[200:201], v140 offset:64
    ds_read_b64_tr_b16 a[202:203], v140 offset:832
    v_mfma_f32_16x16x32_bf16 v[190:193], a[124:127], v[170:173], v[190:193]
    ds_read_b128 v[202:205], v161 offset:6144
    ds_read_b128 v[230:233], v174 offset:6144
    v_mfma_f32_16x16x32_bf16 v[190:193], a[128:131], v[118:121], v[190:193]
    buffer_load_dwordx4 v130, s[48:51], 0 offen offset:1024 lds
    ds_read_b128 v[238:241], v161 offset:6272
    v_mfma_f32_16x16x32_bf16 v[190:193], a[132:135], v[150:153], v[190:193]
    ds_read_b128 v[206:209], v174 offset:6272
    ds_read_b128 v[198:201], v161 offset:6400
    v_mfma_f32_16x16x32_bf16 v[190:193], a[136:139], v[166:169], v[190:193]
    v_fmac_f32 v160, v149, v149
    v_fmac_f32 v160, v154, v154
    v_mfma_f32_16x16x32_bf16 v[190:193], a[140:143], v[162:165], v[190:193]
    ds_read_b128 v[210:213], v174 offset:6400
    v_fmac_f32 v160, v155, v155
    v_mfma_f32_16x16x32_bf16 v[214:217], a[0:3], v[122:125], 0
    s_waitcnt lgkmcnt(10)
    ds_write_b64 v176, v[134:135] offset:56
    v_mfma_f32_16x16x32_bf16 v[214:217], a[4:7], v[170:173], v[214:217]
    s_waitcnt lgkmcnt(8)
    buffer_load_dwordx4 v132, s[48:51], 0 offen offset:2048 lds
    v_fmac_f32 v160, v156, v156
    v_mfma_f32_16x16x32_bf16 v[214:217], a[8:11], v[118:121], v[214:217]
    s_waitcnt lgkmcnt(6)
    ds_write_b64 v176, v[134:135] offset:64
    v_mfma_f32_16x16x32_bf16 v[218:221], a[72:75], v[202:205], 0
    s_waitcnt vmcnt(6)
    v_fmac_f32 v160, v157, v157
    v_fmac_f32 v160, v190, v190
    v_mfma_f32_16x16x32_bf16 v[222:225], a[96:99], v[202:205], 0
    s_waitcnt lgkmcnt(3)
    ds_read_b64_tr_b16 a[156:157], v140 offset:3072
    ds_read_b64_tr_b16 a[158:159], v140 offset:3840
    v_mfma_f32_16x16x32_bf16 v[218:221], a[76:79], v[230:233], v[218:221]
    s_add_u32 m0, s28, 8192
    ds_read_b64_tr_b16 a[180:181], v140 offset:3104
    ds_read_b64_tr_b16 a[182:183], v140 offset:3872
    v_mfma_f32_16x16x32_bf16 v[218:221], a[80:83], v[238:241], v[218:221]
    s_waitcnt lgkmcnt(6)
    buffer_load_dwordx4 v12, s[8:11], s25 offen nt lds
    v_mfma_f32_16x16x32_bf16 v[218:221], a[84:87], v[206:209], v[218:221]
    s_add_u32 m0, s28, 12288
    ds_read_b64_tr_b16 a[204:205], v140 offset:3136
    ds_read_b64_tr_b16 a[206:207], v140 offset:3904
    v_mfma_f32_16x16x32_bf16 v[218:221], a[88:91], v[198:201], v[218:221]
    v_fmac_f32 v160, v191, v191
    v_fmac_f32 v160, v192, v192
    v_mfma_f32_16x16x32_bf16 v[218:221], a[92:95], v[210:213], v[218:221]
    v_fmac_f32 v160, v193, v193
    v_mfma_f32_16x16x32_bf16 v[222:225], a[100:103], v[230:233], v[222:225]
    v_mfma_f32_16x16x32_bf16 v[222:225], a[104:107], v[238:241], v[222:225]
    buffer_load_dwordx4 v13, s[8:11], s25 offen nt lds
    v_mfma_f32_16x16x32_bf16 v[222:225], a[108:111], v[206:209], v[222:225]
    s_add_u32 m0, s29, 0
    v_mfma_f32_16x16x32_bf16 v[222:225], a[112:115], v[198:201], v[222:225]
    s_waitcnt lgkmcnt(2)
    v_fma_f32 v115, v218, v218, s32
    v_fmac_f32 v115, v219, v219
    v_mfma_f32_16x16x32_bf16 v[222:225], a[116:119], v[210:213], v[222:225]
    v_fmac_f32 v115, v220, v220
    v_fmac_f32 v115, v221, v221
    v_mfma_f32_16x16x32_bf16 v[226:229], a[120:123], v[202:205], 0
    s_waitcnt lgkmcnt(0)
    v_mfma_f32_16x16x32_bf16 v[226:229], a[124:127], v[230:233], v[226:229]
    buffer_load_dwordx4 v14, s[8:11], s25 offen nt lds
    v_mfma_f32_16x16x32_bf16 v[226:229], a[128:131], v[238:241], v[226:229]
    s_add_u32 m0, s69, 0
    s_waitcnt vmcnt(6)
    ds_read_b64_tr_b16 a[160:161], v142 offset:0
    v_mfma_f32_16x16x32_bf16 v[226:229], a[132:135], v[206:209], v[226:229]
    s_lshr_b32 s10, s17, 1
    ds_read_b64_tr_b16 a[162:163], v142 offset:768
    ds_read_b64_tr_b16 a[184:185], v142 offset:32
    v_mfma_f32_16x16x32_bf16 v[226:229], a[136:139], v[198:201], v[226:229]
    s_cselect_b32 s10, s36, 0
    ds_read_b64_tr_b16 a[186:187], v142 offset:800
    ds_read_b64_tr_b16 a[208:209], v142 offset:64
    v_mfma_f32_16x16x32_bf16 v[226:229], a[140:143], v[210:213], v[226:229]
    s_mov_b32 s25, s24
    ds_read_b64_tr_b16 a[210:211], v142 offset:832
    v_fmac_f32 v115, v222, v222
    v_mfma_f32_16x16x32_bf16 v[214:217], a[12:15], v[150:153], v[214:217]
    buffer_load_dwordx4 v117, s[52:55], 0 offen lds
    v_fmac_f32 v115, v223, v223
    v_mfma_f32_16x16x32_bf16 v[214:217], a[16:19], v[166:169], v[214:217]
    v_fmac_f32 v115, v224, v224
    v_fmac_f32 v115, v225, v225
    v_mfma_f32_16x16x32_bf16 v[214:217], a[20:23], v[162:165], v[214:217]
    v_fmac_f32 v115, v226, v226
    v_fmac_f32 v115, v227, v227
    v_mfma_f32_16x16x32_bf16 v[138:141], a[24:27], v[122:125], 0
    v_fmac_f32 v115, v228, v228
    v_fmac_f32 v115, v229, v229
    v_mfma_f32_16x16x32_bf16 v[138:141], a[28:31], v[170:173], v[138:141]
    s_waitcnt lgkmcnt(5)
    v_xor_b32 v184, 65536, v2
    v_fma_f32 v116, v214, v214, s32
    v_mfma_f32_16x16x32_bf16 v[138:141], a[32:35], v[118:121], v[138:141]
    s_waitcnt lgkmcnt(3)
    buffer_load_dwordx4 v159, s[52:55], 0 offen offset:1024 lds
    v_fmac_f32 v116, v215, v215
    v_mfma_f32_16x16x32_bf16 v[138:141], a[36:39], v[150:153], v[138:141]
    s_waitcnt lgkmcnt(1)
    v_fmac_f32 v116, v216, v216
    v_fmac_f32 v116, v217, v217
    v_mfma_f32_16x16x32_bf16 v[138:141], a[40:43], v[166:169], v[138:141]
    s_waitcnt lgkmcnt(0)
    v_lshrrev_b32 v185, 2, v184
    v_lshrrev_b32 v126, 8, v184
    v_mfma_f32_16x16x32_bf16 v[138:141], a[44:47], v[162:165], v[138:141]
    v_lshl_add_u32 v128, s16, 2, v184
    v_add_u32 v185, 62784, v185
    v_mfma_f32_16x16x32_bf16 v[134:137], a[48:51], v[122:125], 0
    v_lshlrev_b32 v126, 4, v126
    v_add_u32 v126, 62784, v126
    v_mfma_f32_16x16x32_bf16 v[134:137], a[52:55], v[170:173], v[134:137]
    buffer_load_dwordx4 v114, s[52:55], 0 offen offset:2048 lds
    v_or_b32 v234, v32, v33
    v_mfma_f32_16x16x32_bf16 v[134:137], a[56:59], v[118:121], v[134:137]
    s_add_u32 s52, s52, 12288
    s_waitcnt vmcnt(6)
    ds_read_b64_tr_b16 a[164:165], v142 offset:3072
    v_mfma_f32_16x16x32_bf16 v[134:137], a[60:63], v[150:153], v[134:137]
    s_addc_u32 s53, s53, 0
    ds_read_b64_tr_b16 a[166:167], v142 offset:3840
    ds_read_b64_tr_b16 a[188:189], v142 offset:3104
    v_mfma_f32_16x16x32_bf16 v[134:137], a[64:67], v[166:169], v[134:137]
    s_add_u32 m0, s69, 3072
    ds_read_b64_tr_b16 a[190:191], v142 offset:3872
    ds_read_b64_tr_b16 a[212:213], v142 offset:3136
    v_mfma_f32_16x16x32_bf16 v[134:137], a[68:71], v[162:165], v[134:137]
    ds_read_b64_tr_b16 a[214:215], v142 offset:3904
    v_fmac_f32 v116, v138, v138
    v_mfma_f32_16x16x32_bf16 v[142:145], a[0:3], v[202:205], 0
    buffer_load_dwordx4 v117, s[52:55], 0 offen lds
    v_fmac_f32 v116, v139, v139
    v_mfma_f32_16x16x32_bf16 v[142:145], a[4:7], v[230:233], v[142:145]
    v_fmac_f32 v116, v140, v140
    v_fmac_f32 v116, v141, v141
    v_mfma_f32_16x16x32_bf16 v[142:145], a[8:11], v[238:241], v[142:145]
    v_fmac_f32 v116, v134, v134
    v_fmac_f32 v116, v135, v135
    v_mfma_f32_16x16x32_bf16 v[142:145], a[12:15], v[206:209], v[142:145]
    v_fmac_f32 v116, v136, v136
    v_fmac_f32 v116, v137, v137
    v_mfma_f32_16x16x32_bf16 v[142:145], a[16:19], v[198:201], v[142:145]
    s_waitcnt lgkmcnt(5)
    v_cvt_pk_bf16_f32 v36, v116, v160
    v_and_b32 v234, 0xffff, v234
    v_mfma_f32_16x16x32_bf16 v[142:145], a[20:23], v[210:213], v[142:145]
    s_waitcnt lgkmcnt(3)
    buffer_load_dwordx4 v159, s[52:55], 0 offen offset:1024 lds
    v_lshl_or_b32 v234, v234, 16, v234
    v_mfma_f32_16x16x32_bf16 v[242:245], v[32:35], v[36:39], 0
    s_waitcnt lgkmcnt(1)
    v_or_b32 v235, v32, v33
    v_and_b32 v235, 0xffff, v235
    v_mfma_f32_16x16x32_bf16 v[118:121], a[24:27], v[202:205], 0
    s_waitcnt lgkmcnt(0)
    v_lshl_or_b32 v235, v235, 16, v235
    v_or_b32 v236, v32, v33
    v_mfma_f32_16x16x32_bf16 v[118:121], a[28:31], v[230:233], v[118:121]
    v_rsq_f32 v243, v243
    v_mfma_f32_16x16x32_bf16 v[118:121], a[32:35], v[238:241], v[118:121]
    v_rsq_f32 v242, v242
    v_mfma_f32_16x16x32_bf16 v[118:121], a[36:39], v[206:209], v[118:121]
    buffer_load_dwordx4 v114, s[52:55], 0 offen offset:2048 lds
    ds_read_b128 v[186:189], v0 offset:20480
    v_mfma_f32_16x16x32_bf16 v[118:121], a[40:43], v[198:201], v[118:121]
    s_add_u32 s52, s52, 12288
    ds_read_b128 v[194:197], v1 offset:20480
    v_mul_f32 v242, s31, v242
    v_mfma_f32_16x16x32_bf16 v[118:121], a[44:47], v[210:213], v[118:121]
    s_addc_u32 s53, s53, 0
    ds_read_b128 v[122:125], v0 offset:20608
    v_mul_f32 v146, v243, v146
    v_mfma_f32_16x16x32_bf16 v[246:249], a[48:51], v[202:205], 0
    s_add_u32 m0, s68, 0
    ds_read_b128 v[202:205], v1 offset:20608
    v_mul_f32 v147, v243, v147
    v_mfma_f32_16x16x32_bf16 v[246:249], a[52:55], v[230:233], v[246:249]
    ds_read_b128 v[230:233], v0 offset:20736
    v_cvt_pk_f16_f32 v150, v146, v147
    v_mfma_f32_16x16x32_bf16 v[246:249], a[56:59], v[238:241], v[246:249]
    buffer_load_dwordx4 v117, s[52:55], 0 offen lds
    ds_read_b128 v[238:241], v1 offset:20736
    v_mfma_f32_16x16x32_bf16 v[246:249], a[60:63], v[206:209], v[246:249]
    v_mul_f32 v148, v243, v148
    v_mul_f32 v149, v243, v149
    v_mfma_f32_16x16x32_bf16 v[246:249], a[64:67], v[198:201], v[246:249]
    v_cvt_pk_f16_f32 v151, v148, v149
    v_mul_f32 v154, v243, v154
    v_mfma_f32_16x16x32_bf16 v[246:249], a[68:71], v[210:213], v[246:249]
    s_waitcnt lgkmcnt(5)
    v_mul_f32 v155, v243, v155
    v_cvt_pk_f16_f32 v152, v154, v155
    v_mfma_f32_16x16x32_bf16 v[162:165], a[96:99], v[186:189], 0
    s_waitcnt lgkmcnt(4)
    v_mul_f32 v156, v243, v156
    v_mul_f32 v157, v243, v157
    v_mfma_f32_16x16x32_bf16 v[162:165], a[100:103], v[194:197], v[162:165]
    s_waitcnt lgkmcnt(3)
    v_cvt_pk_f16_f32 v153, v156, v157
    v_mul_f32 v190, v243, v190
    v_mfma_f32_16x16x32_bf16 v[162:165], a[104:107], v[122:125], v[162:165]
    s_waitcnt lgkmcnt(2)
    ds_write_b128 v175, v[150:153]
    v_mfma_f32_16x16x32_bf16 v[162:165], a[108:111], v[202:205], v[162:165]
    s_waitcnt lgkmcnt(1)
    v_mul_f32 v191, v243, v191
    v_cvt_pk_f16_f32 v208, v190, v191
    v_mfma_f32_16x16x32_bf16 v[162:165], a[112:115], v[230:233], v[162:165]
    v_mul_f32 v192, v243, v192
    v_mul_f32 v193, v243, v193
    v_mfma_f32_16x16x32_bf16 v[162:165], a[116:119], v[238:241], v[162:165]
    v_cvt_pk_f16_f32 v209, v192, v193
    v_mul_f32 v214, v242, v214
    v_mfma_f32_16x16x32_bf16 v[170:173], a[120:123], v[186:189], 0
    ds_write_b64 v175, v[208:209] offset:48
    v_mfma_f32_16x16x32_bf16 v[170:173], a[124:127], v[194:197], v[170:173]
    v_mul_f32 v215, v242, v215
    v_cvt_pk_f16_f32 v150, v214, v215
    v_mfma_f32_16x16x32_bf16 v[170:173], a[128:131], v[122:125], v[170:173]
    v_mul_f32 v216, v242, v216
    v_mul_f32 v217, v242, v217
    v_mfma_f32_16x16x32_bf16 v[170:173], a[132:135], v[202:205], v[170:173]
    v_cvt_pk_f16_f32 v151, v216, v217
    v_mul_f32 v138, v242, v138
    v_mfma_f32_16x16x32_bf16 v[170:173], a[136:139], v[230:233], v[170:173]
    v_mul_f32 v139, v242, v139
    v_cvt_pk_f16_f32 v152, v138, v139
    v_mfma_f32_16x16x32_bf16 v[170:173], a[140:143], v[238:241], v[170:173]
    v_mul_f32 v140, v242, v140
    v_mul_f32 v141, v242, v141
    v_mfma_f32_16x16x32_bf16 v[166:169], a[24:27], v[186:189], 0
    v_cvt_pk_f16_f32 v153, v140, v141
    v_mul_f32 v134, v242, v134
    v_mfma_f32_16x16x32_bf16 v[166:169], a[28:31], v[194:197], v[166:169]
    ds_write_b128 v175, v[150:153] offset:32
    v_mfma_f32_16x16x32_bf16 v[150:153], a[72:75], v[186:189], 0
    v_mul_f32 v135, v242, v135
    v_cvt_pk_f16_f32 v206, v134, v135
    v_mfma_f32_16x16x32_bf16 v[150:153], a[76:79], v[194:197], v[150:153]
    v_mul_f32 v136, v242, v136
    v_mul_f32 v137, v242, v137
    v_mfma_f32_16x16x32_bf16 v[150:153], a[80:83], v[122:125], v[150:153]
    v_cvt_pk_f16_f32 v207, v136, v137
    v_mul_f32 v146, v214, v146
    v_mfma_f32_16x16x32_bf16 v[150:153], a[84:87], v[202:205], v[150:153]
    ds_write_b64 v175, v[206:207] offset:72
    v_mfma_f32_16x16x32_bf16 v[150:153], a[88:91], v[230:233], v[150:153]
    v_fmac_f32 v146, v215, v147
    v_fmac_f32 v146, v216, v148
    v_mfma_f32_16x16x32_bf16 v[150:153], a[92:95], v[238:241], v[150:153]
    v_fmac_f32 v146, v217, v149
    v_fmac_f32 v146, v138, v154
    v_mfma_f32_16x16x32_bf16 v[166:169], a[32:35], v[122:125], v[166:169]
    v_fmac_f32 v146, v139, v155
    v_fmac_f32 v146, v140, v156
    v_mfma_f32_16x16x32_bf16 v[166:169], a[36:39], v[202:205], v[166:169]
    v_fmac_f32 v146, v141, v157
    v_fmac_f32 v146, v134, v190
    v_mfma_f32_16x16x32_bf16 v[166:169], a[40:43], v[230:233], v[166:169]
    v_fmac_f32 v146, v135, v191
    v_fmac_f32 v146, v136, v192
    v_mfma_f32_16x16x32_bf16 v[166:169], a[44:47], v[238:241], v[166:169]
    v_fmac_f32 v146, v137, v193
    v_mov_b32 v116, v146
    v_mfma_f32_16x16x32_bf16 v[134:137], a[48:51], v[186:189], 0
    v_lshrrev_b32 v236, 16, v236
    v_lshl_or_b32 v236, v236, 16, v236
    v_mfma_f32_16x16x32_bf16 v[134:137], a[52:55], v[194:197], v[134:137]
    v_permlane32_swap_b32 v146, v116
    v_mfma_f32_16x16x32_bf16 v[134:137], a[56:59], v[122:125], v[134:137]
    v_add_f32 v146, v146, v116
    v_mov_b32 v116, v146
    v_mfma_f32_16x16x32_bf16 v[134:137], a[60:63], v[202:205], v[134:137]
    v_or_b32 v237, v32, v33
    v_lshrrev_b32 v237, 16, v237
    v_mfma_f32_16x16x32_bf16 v[134:137], a[64:67], v[230:233], v[134:137]
    v_permlane16_swap_b32 v146, v116
    v_mfma_f32_16x16x32_bf16 v[134:137], a[68:71], v[238:241], v[134:137]
    v_add_f32 v146, v146, v116
    v_add_f32 v146, s39, v146
    v_mfma_f32_16x16x32_bf16 v[138:141], v[186:189], a[144:147], 0
    v_mov_b32 v147, v178
    v_mov_b32 v148, v178
    v_mfma_f32_16x16x32_bf16 v[138:141], v[194:197], a[148:151], v[138:141]
    v_mov_b32 v149, v178
    v_cndmask_b32 v146, v178, v146, s[88:89]
    v_mfma_f32_16x16x32_bf16 v[138:141], v[122:125], a[152:155], v[138:141]
    ds_write_b128 v131, v[146:149] offset:192
    v_mfma_f32_16x16x32_bf16 v[138:141], v[202:205], a[156:159], v[138:141]
    v_lshl_or_b32 v237, v237, 16, v237
    v_fma_f32 v116, v142, v142, s32
    v_mfma_f32_16x16x32_bf16 v[138:141], v[230:233], a[160:163], v[138:141]
    v_fmac_f32 v116, v143, v143
    v_fmac_f32 v116, v144, v144
    v_mfma_f32_16x16x32_bf16 v[138:141], v[238:241], a[164:167], v[138:141]
    v_fmac_f32 v116, v145, v145
    v_fmac_f32 v116, v118, v118
    v_mfma_f32_16x16x32_bf16 v[146:149], v[186:189], a[168:171], 0
    v_fmac_f32 v116, v119, v119
    v_fmac_f32 v116, v120, v120
    v_mfma_f32_16x16x32_bf16 v[146:149], v[194:197], a[172:175], v[146:149]
    v_fmac_f32 v116, v121, v121
    v_fmac_f32 v116, v246, v246
    v_mfma_f32_16x16x32_bf16 v[146:149], v[122:125], a[176:179], v[146:149]
    v_fmac_f32 v116, v247, v247
    v_fmac_f32 v116, v248, v248
    v_mfma_f32_16x16x32_bf16 v[146:149], v[202:205], a[180:183], v[146:149]
    ds_read_b128 v[154:157], v161 offset:0
    v_fmac_f32 v116, v249, v249
    v_mfma_f32_16x16x32_bf16 v[146:149], v[230:233], a[184:187], v[146:149]
    ds_read_b128 v[214:217], v174 offset:0
    v_cvt_pk_bf16_f32 v36, v116, v115
    v_mfma_f32_16x16x32_bf16 v[146:149], v[238:241], a[188:191], v[146:149]
    ds_read_b128 v[190:193], v161 offset:128
    v_fma_f32 v160, v150, v150, s32
    v_fmac_f32 v160, v151, v151
    v_fmac_f32 v160, v152, v152
    v_fmac_f32 v160, v153, v153
    v_fmac_f32 v160, v162, v162
    v_fmac_f32 v160, v163, v163
    v_fmac_f32 v160, v164, v164
    v_fmac_f32 v160, v165, v165
    v_fmac_f32 v160, v170, v170
    v_fmac_f32 v160, v171, v171
    v_fmac_f32 v160, v172, v172
    v_fmac_f32 v160, v173, v173
    v_cvt_pk_bf16_f32 v198, v138, v139
    v_mfma_f32_16x16x32_bf16 v[206:209], v[32:35], v[36:39], 0
    v_cvt_pk_bf16_f32 v199, v140, v141
    v_cvt_pk_bf16_f32 v130, v146, v147
    v_mfma_f32_16x16x32_bf16 v[210:213], v[186:189], a[192:195], 0
    v_cvt_pk_bf16_f32 v131, v148, v149
    v_xor_b32 v2, 65536, v2
    v_mfma_f32_16x16x32_bf16 v[210:213], v[194:197], a[196:199], v[210:213]
    s_waitcnt lgkmcnt(2)
    v_mfma_f32_16x16x32_bf16 v[210:213], v[122:125], a[200:203], v[210:213]
    s_waitcnt lgkmcnt(1)
    v_rsq_f32 v207, v207
    v_mfma_f32_16x16x32_bf16 v[210:213], v[202:205], a[204:207], v[210:213]
    s_waitcnt lgkmcnt(0)
    v_rsq_f32 v206, v206
    v_mfma_f32_16x16x32_bf16 v[210:213], v[230:233], a[208:211], v[210:213]
    v_mul_f32 v206, s31, v206
    v_mul_f32 v218, v207, v218
    v_mfma_f32_16x16x32_bf16 v[210:213], v[238:241], a[212:215], v[210:213]
    v_mul_f32 v219, v207, v219
    v_cvt_pk_f16_f32 v138, v218, v219
    v_mul_f32 v220, v207, v220
    v_mul_f32 v221, v207, v221
    v_cvt_pk_f16_f32 v139, v220, v221
    v_mul_f32 v222, v207, v222
    v_mul_f32 v223, v207, v223
    v_cvt_pk_f16_f32 v140, v222, v223
    v_mul_f32 v224, v207, v224
    v_mul_f32 v225, v207, v225
    v_cvt_pk_f16_f32 v141, v224, v225
    v_mul_f32 v226, v207, v226
    v_mul_f32 v227, v207, v227
    v_cvt_pk_f16_f32 v148, v226, v227
    v_mul_f32 v228, v207, v228
    v_mul_f32 v229, v207, v229
    v_cvt_pk_f16_f32 v149, v228, v229
    v_mul_f32 v142, v206, v142
    v_mul_f32 v143, v206, v143
    v_cvt_pk_f16_f32 v242, v142, v143
    v_mul_f32 v144, v206, v144
    v_mul_f32 v145, v206, v145
    v_cvt_pk_f16_f32 v243, v144, v145
    v_mul_f32 v118, v206, v118
    v_mul_f32 v119, v206, v119
    v_cvt_pk_f16_f32 v244, v118, v119
    v_mul_f32 v120, v206, v120
    v_mul_f32 v121, v206, v121
    v_cvt_pk_f16_f32 v245, v120, v121
    v_mul_f32 v246, v206, v246
    v_mul_f32 v247, v206, v247
    v_cvt_pk_f16_f32 v146, v246, v247
    v_mul_f32 v248, v206, v248
    v_mul_f32 v249, v206, v249
    v_cvt_pk_f16_f32 v147, v248, v249
    v_mul_f32 v142, v142, v218
    v_fmac_f32 v142, v143, v219
    buffer_load_dwordx4 v159, s[52:55], 0 offen offset:1024 lds
    ds_write_b128 v176, v[138:141]
    v_fmac_f32 v142, v144, v220
    v_fmac_f32 v142, v145, v221
    v_fmac_f32 v142, v118, v222
    v_mfma_f32_16x16x32_bf16 v[138:141], a[0:3], v[186:189], 0
    v_fmac_f32 v142, v119, v223
    v_fmac_f32 v142, v120, v224
    v_mfma_f32_16x16x32_bf16 v[138:141], a[4:7], v[194:197], v[138:141]
    ds_read_b128 v[218:221], v174 offset:128
    ds_read_b128 v[186:189], v161 offset:256
    v_mfma_f32_16x16x32_bf16 v[138:141], a[8:11], v[122:125], v[138:141]
    ds_read_b128 v[122:125], v174 offset:256
    buffer_load_dwordx4 v114, s[52:55], 0 offen offset:2048 lds
    v_mfma_f32_16x16x32_bf16 v[138:141], a[12:15], v[202:205], v[138:141]
    s_add_u32 s52, s52, 12288
    ds_write_b64 v176, v[148:149] offset:48
    v_mfma_f32_16x16x32_bf16 v[138:141], a[16:19], v[230:233], v[138:141]
    s_addc_u32 s53, s53, 0
    v_fmac_f32 v142, v121, v225
    v_fmac_f32 v142, v246, v226
    v_mfma_f32_16x16x32_bf16 v[138:141], a[20:23], v[238:241], v[138:141]
    s_add_u32 m0, s68, 3072
    ds_write_b128 v176, v[242:245] offset:32
    v_mfma_f32_16x16x32_bf16 v[118:121], v[154:157], a[144:147], 0
    s_mul_i32 s68, s78, 72
    v_fmac_f32 v142, v247, v227
    v_fmac_f32 v142, v248, v228
    v_mfma_f32_16x16x32_bf16 v[118:121], v[214:217], a[148:151], v[118:121]
    buffer_load_dwordx4 v117, s[52:55], 0 offen lds
    v_fmac_f32 v142, v249, v229
    v_mfma_f32_16x16x32_bf16 v[118:121], v[190:193], a[152:155], v[118:121]
    s_waitcnt lgkmcnt(3)
    ds_write_b64 v176, v[146:147] offset:72
    v_mfma_f32_16x16x32_bf16 v[118:121], v[218:221], a[156:159], v[118:121]
    s_sub_u32 s68, s77, s68
    v_mov_b32 v115, v142
    v_fma_f32 v132, v138, v138, s32
    v_mfma_f32_16x16x32_bf16 v[118:121], v[186:189], a[160:163], v[118:121]
    s_waitcnt lgkmcnt(2)
    v_permlane32_swap_b32 v142, v115
    v_mfma_f32_16x16x32_bf16 v[118:121], v[122:125], a[164:167], v[118:121]
    s_mul_i32 s78, s78, 1373568
    v_add_f32 v142, v142, v115
    v_mov_b32 v115, v142
    v_mfma_f32_16x16x32_bf16 v[146:149], v[154:157], a[168:171], 0
    buffer_load_dwordx4 v159, s[52:55], 0 offen offset:1024 lds
    v_fmac_f32 v132, v139, v139
    v_mfma_f32_16x16x32_bf16 v[146:149], v[214:217], a[172:175], v[146:149]
    s_mul_i32 s77, s68, 2688
    v_permlane16_swap_b32 v142, v115
    v_mfma_f32_16x16x32_bf16 v[146:149], v[190:193], a[176:179], v[146:149]
    s_add_u32 s77, s77, s78
    v_add_f32 v142, v142, v115
    v_add_f32 v142, s39, v142
    v_mfma_f32_16x16x32_bf16 v[146:149], v[218:221], a[180:183], v[146:149]
    ds_read_b128 v[230:233], v161 offset:6144
    v_mov_b32 v143, v178
    v_mfma_f32_16x16x32_bf16 v[146:149], v[186:189], a[184:187], v[146:149]
    ds_read_b128 v[238:241], v174 offset:6144
    v_mov_b32 v144, v178
    v_mfma_f32_16x16x32_bf16 v[146:149], v[122:125], a[188:191], v[146:149]
    buffer_load_dwordx4 v114, s[52:55], 0 offen offset:2048 lds
    ds_read_b128 v[202:205], v161 offset:6272
    v_mfma_f32_16x16x32_bf16 v[222:225], v[154:157], a[192:195], 0
    s_add_u32 s52, s52, 12288
    ds_read_b128 v[154:157], v174 offset:6272
    v_mov_b32 v145, v178
    v_mfma_f32_16x16x32_bf16 v[222:225], v[214:217], a[196:199], v[222:225]
    s_waitcnt vmcnt(9)
    ds_read_b64 a[216:217], v182 offset:0
    ds_read_b64 a[218:219], v182 offset:1536
    v_mfma_f32_16x16x32_bf16 v[222:225], v[190:193], a[200:203], v[222:225]
    s_addc_u32 s53, s53, 0
    ds_read_b64 a[240:241], v182 offset:8
    ds_read_b64 a[242:243], v182 offset:1544
    v_mfma_f32_16x16x32_bf16 v[222:225], v[218:221], a[204:207], v[222:225]
    s_add_u32 m0, s69, 0
    ds_read_b64 v[90:91], v183 offset:0
    ds_read_b64 v[92:93], v183 offset:1536
    v_mfma_f32_16x16x32_bf16 v[222:225], v[186:189], a[208:211], v[222:225]
    ds_read_b128 v[218:221], v161 offset:6400
    ds_read_b128 v[186:189], v174 offset:6400
    v_mfma_f32_16x16x32_bf16 v[222:225], v[122:125], a[212:215], v[222:225]
    s_waitcnt lgkmcnt(11)
    v_cndmask_b32 v142, v178, v142, s[88:89]
    v_fmac_f32 v132, v140, v140
    v_mfma_f32_16x16x32_bf16 v[122:125], v[230:233], a[144:147], 0
    s_waitcnt lgkmcnt(10)
    ds_write_b128 v158, v[142:145] offset:192
    v_mfma_f32_16x16x32_bf16 v[122:125], v[238:241], a[148:151], v[122:125]
    s_waitcnt lgkmcnt(9)
    v_fmac_f32 v132, v141, v141
    v_fmac_f32 v132, v166, v166
    v_mfma_f32_16x16x32_bf16 v[122:125], v[202:205], a[152:155], v[122:125]
    s_waitcnt lgkmcnt(7)
    v_fmac_f32 v132, v167, v167
    v_fmac_f32 v132, v168, v168
    v_mfma_f32_16x16x32_bf16 v[142:145], v[234:237], a[216:219], 0
    s_waitcnt lgkmcnt(5)
    v_fmac_f32 v132, v169, v169
    v_fmac_f32 v132, v134, v134
    v_mfma_f32_16x16x32_bf16 v[142:145], v[234:237], a[240:243], v[142:145]
    s_waitcnt lgkmcnt(3)
    buffer_load_dwordx4 v117, s[52:55], 0 offen lds
    v_fmac_f32 v132, v135, v135
    v_mfma_f32_16x16x32_bf16 v[142:145], v[234:237], v[90:93], v[142:145]
    s_waitcnt lgkmcnt(1)
    v_fmac_f32 v132, v136, v136
    v_fmac_f32 v132, v137, v137
    v_mfma_f32_16x16x32_bf16 v[122:125], v[154:157], a[156:159], v[122:125]
    v_cvt_pk_bf16_f32 v36, v132, v160
    v_cvt_pk_bf16_f32 v158, v210, v211
    v_mfma_f32_16x16x32_bf16 v[122:125], v[218:221], a[160:163], v[122:125]
    s_waitcnt vmcnt(7)
    ds_read_b64 a[232:233], v182 offset:3072
    ds_read_b64 a[220:221], v182 offset:4608
    v_mfma_f32_16x16x32_bf16 v[178:181], v[32:35], v[36:39], 0
    ds_read_b64 v[82:83], v182 offset:3080
    ds_read_b64 a[244:245], v182 offset:4616
    v_mfma_f32_16x16x32_bf16 v[122:125], v[186:189], a[164:167], v[122:125]
    buffer_load_dwordx4 v159, s[52:55], 0 offen offset:1024 lds
    ds_read_b64 v[106:107], v183 offset:3072
    v_mfma_f32_16x16x32_bf16 v[190:193], v[230:233], a[168:171], 0
    ds_read_b64 v[94:95], v183 offset:4608
    v_mov_b32 v132, v142
    v_mfma_f32_16x16x32_bf16 v[190:193], v[238:241], a[172:175], v[190:193]
    v_rsq_f32 v179, v179
    v_mfma_f32_16x16x32_bf16 v[190:193], v[202:205], a[176:179], v[190:193]
    v_mov_b32_dpp v132, v143 quad_perm:[0,1,2,3] row_mask:0x2 bank_mask:0xf
    v_mul_f32 v150, v179, v150
    v_mfma_f32_16x16x32_bf16 v[190:193], v[154:157], a[180:183], v[190:193]
    v_rsq_f32 v178, v178
    v_mfma_f32_16x16x32_bf16 v[190:193], v[218:221], a[184:187], v[190:193]
    buffer_load_dwordx4 v114, s[52:55], 0 offen offset:2048 lds
    v_mul_f32 v178, s31, v178
    v_mfma_f32_16x16x32_bf16 v[190:193], v[186:189], a[188:191], v[190:193]
    s_add_u32 s52, s52, 12288
    v_mul_f32 v151, v179, v151
    v_cvt_pk_f16_f32 v142, v150, v151
    v_mfma_f32_16x16x32_bf16 v[214:217], v[230:233], a[192:195], 0
    s_addc_u32 s53, s53, 0
    v_mul_f32 v152, v179, v152
    v_mul_f32 v153, v179, v153
    v_mfma_f32_16x16x32_bf16 v[214:217], v[238:241], a[196:199], v[214:217]
    s_add_u32 m0, s69, 3072
    v_cvt_pk_f16_f32 v143, v152, v153
    v_mul_f32 v162, v179, v162
    v_mfma_f32_16x16x32_bf16 v[214:217], v[202:205], a[200:203], v[214:217]
    s_waitcnt lgkmcnt(0)
    v_mul_f32 v163, v179, v163
    v_cvt_pk_f16_f32 v144, v162, v163
    v_mfma_f32_16x16x32_bf16 v[214:217], v[154:157], a[204:207], v[214:217]
    buffer_load_dwordx4 v117, s[52:55], 0 offen lds
    v_mul_f32 v164, v179, v164
    s_waitcnt vmcnt(7)
    v_mfma_f32_16x16x32_bf16 v[214:217], v[218:221], a[208:211], v[214:217]
    s_add_u32 s69, s77, 589824
    ds_read_b64 a[222:223], v127 offset:0
    ds_read_b64 a[234:235], v127 offset:1536
    v_mfma_f32_16x16x32_bf16 v[214:217], v[186:189], a[212:215], v[214:217]
    s_barrier
    s_barrier
    ds_read_b64 a[246:247], v127 offset:8
    ds_read_b64 v[84:85], v127 offset:1544
    ds_read_b64 v[96:97], v129 offset:0
    ds_read_b64 v[108:109], v129 offset:1536
    ds_read_b128 v[154:157], v0 offset:26624
    ds_read_b128 v[150:153], v1 offset:26624
    buffer_load_dwordx4 v159, s[52:55], 0 offen offset:1024 lds
    ds_read_b128 v[238:241], v0 offset:26752
    ds_read_b128 v[230:233], v1 offset:26752
    ds_read_b128 v[186:189], v0 offset:26880
    ds_read_b128 v[202:205], v1 offset:26880
    v_mul_f32 v165, v179, v165
    s_waitcnt lgkmcnt(11)
    v_mfma_f32_16x16x32_bf16 v[218:221], v[234:237], a[220:223], 0
    s_waitcnt lgkmcnt(10)
    buffer_load_dwordx4 v114, s[52:55], 0 offen offset:2048 lds
    v_cvt_pk_f16_f32 v145, v164, v165
    v_mfma_f32_16x16x32_bf16 v[114:117], v[234:237], a[232:235], 0
    s_waitcnt lgkmcnt(8)
    v_mul_f32 v170, v179, v170
    v_mul_f32 v171, v179, v171
    v_mfma_f32_16x16x32_bf16 v[218:221], v[234:237], a[244:247], v[218:221]
    s_waitcnt lgkmcnt(4)
    v_cvt_pk_f16_f32 v164, v170, v171
    v_mul_f32 v172, v179, v172
    v_mfma_f32_16x16x32_bf16 v[218:221], v[234:237], v[94:97], v[218:221]
    s_add_u32 m0, s28, 65536
    v_mul_f32 v173, v179, v173
    v_cvt_pk_f16_f32 v165, v172, v173
    v_mfma_f32_16x16x32_bf16 v[114:117], v[234:237], v[82:85], v[114:117]
    s_waitcnt lgkmcnt(2)
    v_mul_f32 v138, v178, v138
    s_waitcnt vmcnt(6)
    v_mfma_f32_16x16x32_bf16 v[114:117], v[234:237], v[106:109], v[114:117]
    s_waitcnt lgkmcnt(1)
    buffer_load_dwordx4 v10, s[8:11], s24 offen nt lds
    v_mfma_f32_16x16x32_bf16 v[170:173], a[72:75], v[154:157], 0
    s_add_u32 m0, s28, 69632
    ds_read_b64 a[224:225], v127 offset:3072
    ds_read_b64 a[226:227], v127 offset:4608
    v_mfma_f32_16x16x32_bf16 v[170:173], a[76:79], v[150:153], v[170:173]
    s_waitcnt lgkmcnt(2)
    ds_read_b64 a[248:249], v127 offset:3080
    ds_read_b64 a[250:251], v127 offset:4616
    v_mfma_f32_16x16x32_bf16 v[170:173], a[80:83], v[238:241], v[170:173]
    ds_read_b64 v[98:99], v129 offset:3072
    ds_read_b64 v[100:101], v129 offset:4608
    v_mfma_f32_16x16x32_bf16 v[170:173], a[84:87], v[230:233], v[170:173]
    v_mov_b32_dpp v132, v114 quad_perm:[0,1,2,3] row_mask:0x4 bank_mask:0xf
    v_mov_b32 v127, v219
    v_mfma_f32_16x16x32_bf16 v[170:173], a[88:91], v[186:189], v[170:173]
    buffer_load_dwordx4 v11, s[8:11], s24 offen nt lds
    v_mfma_f32_16x16x32_bf16 v[170:173], a[92:95], v[202:205], v[170:173]
    s_add_u32 m0, s28, 73728
    v_mov_b32_dpp v132, v218 quad_perm:[0,1,2,3] row_mask:0x8 bank_mask:0xf
    v_mov_b32_dpp v127, v115 quad_perm:[0,1,2,3] row_mask:0x2 bank_mask:0xf
    v_mfma_f32_16x16x32_bf16 v[114:117], a[96:99], v[154:157], 0
    ds_write_b32 v128, v132 offset:18432
    v_mfma_f32_16x16x32_bf16 v[114:117], a[100:103], v[150:153], v[114:117]
    v_mul_f32 v139, v178, v139
    v_cvt_pk_f16_f32 v138, v138, v139
    v_mfma_f32_16x16x32_bf16 v[114:117], a[104:107], v[238:241], v[114:117]
    s_waitcnt lgkmcnt(5)
    v_mul_f32 v140, v178, v140
    v_mul_f32 v141, v178, v141
    v_mfma_f32_16x16x32_bf16 v[218:221], v[234:237], a[224:227], 0
    s_waitcnt lgkmcnt(3)
    buffer_load_dwordx4 v12, s[8:11], s24 offen nt lds
    v_mfma_f32_16x16x32_bf16 v[218:221], v[234:237], a[248:251], v[218:221]
    s_waitcnt lgkmcnt(1)
    v_cvt_pk_f16_f32 v139, v140, v141
    v_mul_f32 v166, v178, v166
    v_mfma_f32_16x16x32_bf16 v[218:221], v[234:237], v[98:101], v[218:221]
    s_add_u32 m0, s28, 77824
    v_mul_f32 v167, v178, v167
    s_waitcnt vmcnt(6)
    v_mfma_f32_16x16x32_bf16 v[114:117], a[108:111], v[230:233], v[114:117]
    ds_read_b64 a[236:237], v182 offset:0
    ds_read_b64 a[228:229], v182 offset:1536
    v_mfma_f32_16x16x32_bf16 v[114:117], a[112:115], v[186:189], v[114:117]
    ds_read_b64 v[86:87], v182 offset:8
    ds_read_b64 a[252:253], v182 offset:1544
    v_mfma_f32_16x16x32_bf16 v[114:117], a[116:119], v[202:205], v[114:117]
    buffer_load_dwordx4 v13, s[8:11], s24 offen nt lds
    v_mfma_f32_16x16x32_bf16 v[226:229], a[120:123], v[154:157], 0
    s_add_u32 m0, s74, 0
    ds_read_b64 v[110:111], v183 offset:0
    ds_read_b64 v[102:103], v183 offset:1536
    v_mfma_f32_16x16x32_bf16 v[226:229], a[124:127], v[150:153], v[226:229]
    v_mov_b32_dpp v127, v218 quad_perm:[0,1,2,3] row_mask:0x4 bank_mask:0xf
    v_cvt_pk_f16_f32 v140, v166, v167
    v_mfma_f32_16x16x32_bf16 v[226:229], a[128:131], v[238:241], v[226:229]
    v_mov_b32_dpp v127, v219 quad_perm:[0,1,2,3] row_mask:0x8 bank_mask:0xf
    v_mul_f32 v168, v178, v168
    v_mfma_f32_16x16x32_bf16 v[226:229], a[132:135], v[230:233], v[226:229]
    ds_write_b32 v128, v127 offset:19456
    v_mfma_f32_16x16x32_bf16 v[226:229], a[136:139], v[186:189], v[226:229]
    buffer_load_dwordx4 v14, s[8:11], s24 offen nt lds
    v_mfma_f32_16x16x32_bf16 v[226:229], a[140:143], v[202:205], v[226:229]
    s_add_u32 s8, s60, s23
    v_mul_f32 v169, v178, v169
    v_cvt_pk_f16_f32 v141, v168, v169
    v_mfma_f32_16x16x32_bf16 v[166:169], a[0:3], v[154:157], 0
    s_addc_u32 s9, s61, 0
    v_mul_f32 v134, v178, v134
    v_mul_f32 v135, v178, v135
    v_mfma_f32_16x16x32_bf16 v[166:169], a[4:7], v[150:153], v[166:169]
    s_sub_u32 s10, s36, s23
    v_cvt_pk_f16_f32 v162, v134, v135
    v_mul_f32 v136, v178, v136
    v_mfma_f32_16x16x32_bf16 v[166:169], a[8:11], v[238:241], v[166:169]
    s_cmp_lt_u32 s34, s17
    v_mul_f32 v137, v178, v137
    v_cvt_pk_f16_f32 v163, v136, v137
    v_mfma_f32_16x16x32_bf16 v[166:169], a[12:15], v[230:233], v[166:169]
    s_cselect_b32 s10, s10, 0
    v_cvt_pk_bf16_f32 v159, v212, v213
    v_cvt_pk_bf16_f32 v118, v118, v118
    v_mfma_f32_16x16x32_bf16 v[166:169], a[16:19], v[186:189], v[166:169]
    s_add_u32 m0, s28, 0
    v_cvt_pk_bf16_f32 v119, v119, v119
    s_waitcnt vmcnt(5)
    v_mfma_f32_16x16x32_bf16 v[166:169], a[20:23], v[202:205], v[166:169]
    s_mov_b32 s24, s23
    ds_read_b64 a[230:231], v182 offset:3072
    ds_read_b64 a[238:239], v182 offset:4608
    v_mfma_f32_16x16x32_bf16 v[134:137], a[24:27], v[154:157], 0
    s_add_u32 s23, s23, s21
    ds_read_b64 a[254:255], v182 offset:3080
    ds_read_b64 v[88:89], v182 offset:4616
    v_mfma_f32_16x16x32_bf16 v[134:137], a[28:31], v[150:153], v[134:137]
    s_cmp_ge_u32 s19, 72
    ds_read_b64 v[104:105], v183 offset:3072
    ds_read_b64 v[112:113], v183 offset:4608
    v_mfma_f32_16x16x32_bf16 v[134:137], a[32:35], v[238:241], v[134:137]
    s_cselect_b32 s34, 72, 0
    ds_write2_b32 v177, v118, v119 offset0:0 offset1:68
    v_mfma_f32_16x16x32_bf16 v[134:137], a[36:39], v[230:233], v[134:137]
    s_cselect_b32 s35, s22, 0
    v_cvt_pk_bf16_f32 v120, v120, v120
    v_cvt_pk_bf16_f32 v121, v121, v121
    v_mfma_f32_16x16x32_bf16 v[134:137], a[40:43], v[186:189], v[134:137]
    s_sub_u32 s19, s19, s34
    ds_write2_b32 v177, v120, v121 offset0:136 offset1:204
    v_mfma_f32_16x16x32_bf16 v[134:137], a[44:47], v[202:205], v[134:137]
    s_add_u32 s23, s23, s35
    v_cvt_pk_bf16_f32 v146, v146, v146
    v_cvt_pk_bf16_f32 v147, v147, v147
    v_mfma_f32_16x16x32_bf16 v[118:121], a[48:51], v[154:157], 0
    s_waitcnt lgkmcnt(6)
    ds_write2_b32 v177, v146, v147 offset0:16 offset1:84
    v_mfma_f32_16x16x32_bf16 v[178:181], v[234:237], a[228:231], 0
    s_waitcnt lgkmcnt(5)
    v_cvt_pk_bf16_f32 v148, v148, v148
    v_cvt_pk_bf16_f32 v149, v149, v149
    v_mfma_f32_16x16x32_bf16 v[178:181], v[234:237], a[252:255], v[178:181]
    s_waitcnt lgkmcnt(3)
    ds_write2_b32 v177, v148, v149 offset0:152 offset1:220
    v_mfma_f32_16x16x32_bf16 v[178:181], v[234:237], v[102:105], v[178:181]
    v_cvt_pk_bf16_f32 v222, v222, v222
    v_cvt_pk_bf16_f32 v223, v223, v223
    v_mfma_f32_16x16x32_bf16 v[146:149], v[234:237], a[236:239], 0
    ds_write2_b32 v177, v222, v223 offset0:32 offset1:100
    v_mfma_f32_16x16x32_bf16 v[146:149], v[234:237], v[86:89], v[146:149]
    v_cvt_pk_bf16_f32 v224, v224, v224
    v_cvt_pk_bf16_f32 v225, v225, v225
    v_mfma_f32_16x16x32_bf16 v[146:149], v[234:237], v[110:113], v[146:149]
    ds_write2_b32 v177, v224, v225 offset0:168 offset1:236
    v_mfma_f32_16x16x32_bf16 v[118:121], a[52:55], v[150:153], v[118:121]
    v_cvt_pk_bf16_f32 v122, v122, v122
    v_cvt_pk_bf16_f32 v123, v123, v123
    v_mfma_f32_16x16x32_bf16 v[118:121], a[56:59], v[238:241], v[118:121]
    ds_write2_b32 v133, v122, v123 offset0:0 offset1:68
    v_mfma_f32_16x16x32_bf16 v[118:121], a[60:63], v[230:233], v[118:121]
    v_cvt_pk_bf16_f32 v124, v124, v124
    v_mov_b32 v132, v146
    v_mfma_f32_16x16x32_bf16 v[118:121], a[64:67], v[186:189], v[118:121]
    v_cvt_pk_bf16_f32 v125, v125, v125
    v_mov_b32_dpp v132, v178 quad_perm:[0,1,2,3] row_mask:0x2 bank_mask:0xf
    v_mfma_f32_16x16x32_bf16 v[118:121], a[68:71], v[202:205], v[118:121]
    ds_write2_b32 v133, v124, v125 offset0:136 offset1:204
    v_mfma_f32_16x16x32_bf16 v[174:177], v[154:157], a[144:147], 0
    v_mov_b32_dpp v132, v179 quad_perm:[0,1,2,3] row_mask:0x4 bank_mask:0xf
    v_cvt_pk_bf16_f32 v190, v190, v190
    v_mfma_f32_16x16x32_bf16 v[174:177], v[150:153], a[148:151], v[174:177]
    v_mov_b32_dpp v132, v147 quad_perm:[0,1,2,3] row_mask:0x8 bank_mask:0xf
    v_cvt_pk_bf16_f32 v191, v191, v191
    v_mfma_f32_16x16x32_bf16 v[174:177], v[238:241], a[152:155], v[174:177]
    ds_write_b32 v128, v132 offset:63552
    v_mfma_f32_16x16x32_bf16 v[174:177], v[230:233], a[156:159], v[174:177]
    v_cvt_pk_bf16_f32 v192, v192, v192
    v_cvt_pk_bf16_f32 v193, v193, v193
    v_mfma_f32_16x16x32_bf16 v[174:177], v[186:189], a[160:163], v[174:177]
    ds_write2_b32 v133, v190, v191 offset0:16 offset1:84
    v_mfma_f32_16x16x32_bf16 v[174:177], v[202:205], a[164:167], v[174:177]
    v_cvt_pk_bf16_f32 v214, v214, v214
    v_cvt_pk_bf16_f32 v215, v215, v215
    v_mfma_f32_16x16x32_bf16 v[122:125], v[154:157], a[168:171], 0
    ds_write2_b32 v133, v192, v193 offset0:152 offset1:220
    v_mfma_f32_16x16x32_bf16 v[122:125], v[150:153], a[172:175], v[122:125]
    v_cvt_pk_bf16_f32 v216, v216, v216
    v_cvt_pk_bf16_f32 v217, v217, v217
    v_mfma_f32_16x16x32_bf16 v[122:125], v[238:241], a[176:179], v[122:125]
    ds_write2_b32 v133, v214, v215 offset0:32 offset1:100
    v_mfma_f32_16x16x32_bf16 v[122:125], v[230:233], a[180:183], v[122:125]
    s_waitcnt lgkmcnt(3)
    v_cvt_pk_bf16_f32 v200, v174, v175
    v_cvt_pk_bf16_f32 v201, v176, v177
    v_mfma_f32_16x16x32_bf16 v[122:125], v[186:189], a[184:187], v[122:125]
    s_barrier
    ds_read_b128 v[146:149], v0 offset:32768
    ds_read_b128 v[174:177], v1 offset:32768
    v_mfma_f32_16x16x32_bf16 v[122:125], v[202:205], a[188:191], v[122:125]
    ds_read_b128 v[190:193], v0 offset:32896
    ds_read_b128 v[178:181], v184 offset:18432
    v_mfma_f32_16x16x32_bf16 v[222:225], v[154:157], a[192:195], 0
    v_fma_f32 v132, v166, v166, s32
    v_fmac_f32 v132, v167, v167
    v_mfma_f32_16x16x32_bf16 v[222:225], v[150:153], a[196:199], v[222:225]
    ds_read_b128 v[150:153], v1 offset:32896
    ds_read_b128 v[154:157], v0 offset:33024
    v_mfma_f32_16x16x32_bf16 v[222:225], v[238:241], a[200:203], v[222:225]
    v_fmac_f32 v132, v168, v168
    v_fmac_f32 v132, v169, v169
    v_mfma_f32_16x16x32_bf16 v[222:225], v[230:233], a[204:207], v[222:225]
    ds_read_b128 v[238:241], v1 offset:33024
    ds_read_b128 v[230:233], v184 offset:19456
    v_mfma_f32_16x16x32_bf16 v[222:225], v[186:189], a[208:211], v[222:225]
    v_fmac_f32 v132, v134, v134
    v_fmac_f32 v132, v135, v135
    v_mfma_f32_16x16x32_bf16 v[222:225], v[202:205], a[212:215], v[222:225]
    ds_read_b128 v[202:205], v184 offset:63552
    v_fmac_f32 v132, v136, v136
    v_mfma_f32_16x16x32_f16 v[186:189], v[142:145], v[138:141], v[46:49]
    s_waitcnt lgkmcnt(7)
    ds_write2_b32 v133, v216, v217 offset0:168 offset1:236
    v_mfma_f32_16x16x32_bf16 v[214:217], a[72:75], v[146:149], 0
    s_waitcnt lgkmcnt(6)
    v_add_f32 v178, v178, v179
    v_add_f32 v180, v180, v181
    v_mfma_f32_16x16x32_bf16 v[214:217], a[76:79], v[174:177], v[214:217]
    s_waitcnt lgkmcnt(5)
    v_add_f32 v178, v178, v180
    v_mul_f32 v178, 0xbbaaaaab, v178
    v_mfma_f32_16x16x32_bf16 v[214:217], a[80:83], v[190:193], v[214:217]
    s_waitcnt lgkmcnt(4)
    ds_write_b32 v185, v178 offset:0
    v_mfma_f32_16x16x32_bf16 v[214:217], a[84:87], v[150:153], v[214:217]
    s_waitcnt lgkmcnt(4)
    v_fmac_f32 v132, v137, v137
    v_fmac_f32 v132, v118, v118
    v_mfma_f32_16x16x32_bf16 v[214:217], a[88:91], v[154:157], v[214:217]
    s_waitcnt lgkmcnt(3)
    ds_read_b128 v[218:221], v126 offset:0
    ds_read_b128 v[178:181], v126 offset:64
    v_mfma_f32_16x16x32_bf16 v[214:217], a[92:95], v[238:241], v[214:217]
    s_waitcnt lgkmcnt(4)
    v_add_f32 v230, v230, v231
    v_add_f32 v232, v232, v233
    v_mfma_f32_16x16x32_bf16 v[234:237], a[96:99], v[146:149], 0
    v_add_f32 v230, v230, v232
    v_mul_f32 v230, 0xbbaaaaab, v230
    v_mfma_f32_16x16x32_bf16 v[234:237], a[100:103], v[174:177], v[234:237]
    ds_write_b32 v185, v230 offset:256
    v_mfma_f32_16x16x32_bf16 v[234:237], a[104:107], v[190:193], v[234:237]
    v_add_f32 v202, v202, v203
    v_add_f32 v204, v204, v205
    v_mfma_f32_16x16x32_bf16 v[234:237], a[108:111], v[150:153], v[234:237]
    v_add_f32 v202, v202, v204
    v_mul_f32 v202, 0xbbaaaaab, v202
    v_mfma_f32_16x16x32_bf16 v[234:237], a[112:115], v[154:157], v[234:237]
    ds_write_b32 v185, v202 offset:512
    v_mfma_f32_16x16x32_bf16 v[234:237], a[116:119], v[238:241], v[234:237]
    v_fmac_f32 v132, v119, v119
    v_fmac_f32 v132, v120, v120
    v_mfma_f32_16x16x32_bf16 v[182:185], a[120:123], v[146:149], 0
    s_waitcnt lgkmcnt(2)
    v_fmac_f32 v132, v121, v121
    v_fma_f32 v133, v170, v170, s32
    v_mfma_f32_16x16x32_bf16 v[182:185], a[124:127], v[174:177], v[182:185]
    v_fmac_f32 v133, v171, v171
    v_fmac_f32 v133, v172, v172
    v_mfma_f32_16x16x32_bf16 v[182:185], a[128:131], v[190:193], v[182:185]
    v_fmac_f32 v133, v173, v173
    v_fmac_f32 v133, v114, v114
    v_mfma_f32_16x16x32_bf16 v[182:185], a[132:135], v[150:153], v[182:185]
    v_fmac_f32 v133, v115, v115
    v_fmac_f32 v133, v116, v116
    v_mfma_f32_16x16x32_bf16 v[182:185], a[136:139], v[154:157], v[182:185]
    v_fmac_f32 v133, v117, v117
    v_fmac_f32 v133, v226, v226
    v_mfma_f32_16x16x32_bf16 v[182:185], a[140:143], v[238:241], v[182:185]
    v_fmac_f32 v133, v227, v227
    v_fmac_f32 v133, v228, v228
    v_mfma_f32_16x16x32_bf16 v[202:205], a[0:3], v[146:149], 0
    v_fmac_f32 v133, v229, v229
    v_cvt_pk_bf16_f32 v36, v132, v133
    v_mfma_f32_16x16x32_bf16 v[202:205], a[4:7], v[174:177], v[202:205]
    v_cvt_pk_bf16_f32 v132, v122, v123
    v_cvt_pk_bf16_f32 v133, v124, v125
    v_mfma_f32_16x16x32_bf16 v[122:125], v[32:35], v[36:39], 0
    v_cvt_pk_bf16_f32 v160, v222, v223
    v_cvt_pk_bf16_f32 v161, v224, v225
    v_mfma_f32_16x16x32_bf16 v[202:205], a[8:11], v[190:193], v[202:205]
    v_fma_f32 v127, v214, v214, s32
    v_fmac_f32 v127, v215, v215
    v_mfma_f32_16x16x32_bf16 v[202:205], a[12:15], v[150:153], v[202:205]
    v_fmac_f32 v127, v216, v216
    v_fmac_f32 v127, v217, v217
    v_mfma_f32_16x16x32_bf16 v[202:205], a[16:19], v[154:157], v[202:205]
    v_rsq_f32 v123, v123
    v_mfma_f32_16x16x32_bf16 v[202:205], a[20:23], v[238:241], v[202:205]
    v_rsq_f32 v122, v122
    v_mfma_f32_16x16x32_bf16 v[230:233], a[24:27], v[146:149], 0
    v_mul_f32 v122, s31, v122
    v_mul_f32 v170, v123, v170
    v_mfma_f32_16x16x32_bf16 v[230:233], a[28:31], v[174:177], v[230:233]
    ds_read2_b32 v[212:213], v6 offset0:0 offset1:0
    ds_read2_b32 v[224:225], v6 offset0:16 offset1:16
    v_mfma_f32_16x16x32_bf16 v[230:233], a[32:35], v[190:193], v[230:233]
    ds_read2_b32 v[248:249], v6 offset0:32 offset1:32
    v_mul_f32 v171, v123, v171
    v_mfma_f32_16x16x32_bf16 v[230:233], a[36:39], v[150:153], v[230:233]
    v_cvt_pk_f16_f32 v170, v170, v171
    v_mul_f32 v172, v123, v172
    v_mfma_f32_16x16x32_bf16 v[230:233], a[40:43], v[154:157], v[230:233]
    v_mul_f32 v173, v123, v173
    v_cvt_pk_f16_f32 v171, v172, v173
    v_mfma_f32_16x16x32_bf16 v[230:233], a[44:47], v[238:241], v[230:233]
    v_mul_f32 v114, v123, v114
    v_mul_f32 v115, v123, v115
    v_cvt_pk_f16_f32 v172, v114, v115
    v_mfma_f32_16x16x16_f16 v[186:189], v[164:165], v[162:163], v[186:189]
    v_mul_f32 v116, v123, v116
    v_mul_f32 v117, v123, v117
    v_cvt_pk_f16_f32 v173, v116, v117
    v_mul_f32 v226, v123, v226
    v_mfma_f32_16x16x32_bf16 v[114:117], a[48:51], v[146:149], 0
    v_mul_f32 v227, v123, v227
    v_cvt_pk_f16_f32 v196, v226, v227
    v_mfma_f32_16x16x32_bf16 v[114:117], a[52:55], v[174:177], v[114:117]
    s_waitcnt lgkmcnt(1)
    v_mul_f32 v228, v123, v228
    v_mul_f32 v229, v123, v229
    v_mfma_f32_16x16x32_bf16 v[114:117], a[56:59], v[190:193], v[114:117]
    s_waitcnt lgkmcnt(0)
    v_cvt_pk_f16_f32 v197, v228, v229
    v_mul_f32 v166, v122, v166
    v_mfma_f32_16x16x32_bf16 v[114:117], a[60:63], v[150:153], v[114:117]
    v_mul_f32 v167, v122, v167
    v_cvt_pk_f16_f32 v166, v166, v167
    v_mfma_f32_16x16x32_bf16 v[114:117], a[64:67], v[154:157], v[114:117]
    v_mul_f32 v168, v122, v168
    v_mul_f32 v169, v122, v169
    v_mfma_f32_16x16x32_bf16 v[114:117], a[68:71], v[238:241], v[114:117]
    v_cvt_pk_f16_f32 v167, v168, v169
    v_mul_f32 v134, v122, v134
    v_mfma_f32_16x16x32_bf16 v[226:229], v[146:149], a[144:147], 0
    v_mul_f32 v135, v122, v135
    v_cvt_pk_f16_f32 v168, v134, v135
    v_mfma_f32_16x16x32_bf16 v[226:229], v[174:177], a[148:151], v[226:229]
    v_mul_f32 v136, v122, v136
    v_mul_f32 v137, v122, v137
    v_mfma_f32_16x16x32_bf16 v[226:229], v[190:193], a[152:155], v[226:229]
    v_cvt_pk_f16_f32 v169, v136, v137
    v_mul_f32 v118, v122, v118
    v_mfma_f32_16x16x32_bf16 v[226:229], v[150:153], a[156:159], v[226:229]
    v_mul_f32 v119, v122, v119
    v_cvt_pk_f16_f32 v194, v118, v119
    v_mfma_f32_16x16x32_bf16 v[226:229], v[154:157], a[160:163], v[226:229]
    v_mul_f32 v120, v122, v120
    v_mul_f32 v121, v122, v121
    v_mfma_f32_16x16x32_bf16 v[226:229], v[238:241], a[164:167], v[226:229]
    v_cvt_pk_f16_f32 v195, v120, v121
    v_fma_f32 v128, v202, v202, s32
    v_mfma_f32_16x16x32_bf16 v[118:121], v[146:149], a[168:171], 0
    v_fmac_f32 v128, v203, v203
    v_fmac_f32 v128, v204, v204
    v_mfma_f32_16x16x32_bf16 v[118:121], v[174:177], a[172:175], v[118:121]
    ds_read_b32 v129, v6 offset:192
    v_fmac_f32 v128, v205, v205
    v_mfma_f32_16x16x32_bf16 v[118:121], v[190:193], a[176:179], v[118:121]
    v_cvt_pk_bf16_f32 v210, v226, v227
    v_cvt_pk_bf16_f32 v211, v228, v229
    v_mfma_f32_16x16x32_bf16 v[118:121], v[150:153], a[180:183], v[118:121]
    v_fmac_f32 v128, v230, v230
    v_fmac_f32 v128, v231, v231
    v_mfma_f32_16x16x32_bf16 v[118:121], v[154:157], a[184:187], v[118:121]
    v_fmac_f32 v128, v232, v232
    v_fmac_f32 v128, v233, v233
    v_mfma_f32_16x16x32_bf16 v[118:121], v[238:241], a[188:191], v[118:121]
    v_fmac_f32 v128, v114, v114
    v_fmac_f32 v128, v115, v115
    v_fmac_f32 v128, v116, v116
    v_fmac_f32 v128, v117, v117
    v_fmac_f32 v127, v234, v234
    v_fmac_f32 v127, v235, v235
    v_fmac_f32 v127, v236, v236
    v_fmac_f32 v127, v237, v237
    v_fmac_f32 v127, v182, v182
    v_fmac_f32 v127, v183, v183
    v_fmac_f32 v127, v184, v184
    v_fmac_f32 v127, v185, v185
    v_cvt_pk_bf16_f32 v36, v128, v127
    v_mfma_f32_16x16x32_bf16 v[134:137], v[146:149], a[192:195], 0
    s_waitcnt lgkmcnt(0)
    ds_read_b128 v[122:125], v5 offset:0
    v_cvt_pk_bf16_f32 v222, v118, v119
    v_mfma_f32_16x16x32_bf16 v[134:137], v[174:177], a[196:199], v[134:137]
    ds_read_b128 v[174:177], v5 offset:16
    v_cvt_pk_bf16_f32 v223, v120, v121
    v_mfma_f32_16x16x32_bf16 v[134:137], v[190:193], a[200:203], v[134:137]
    ds_read_b128 v[118:121], v5 offset:48
    v_xor_b32 v0, 65536, v0
    v_mfma_f32_16x16x32_bf16 v[134:137], v[150:153], a[204:207], v[134:137]
    v_xor_b32 v1, 65536, v1
    v_add_u32 v5, 336, v5
    v_mfma_f32_16x16x32_bf16 v[150:153], v[32:35], v[36:39], 0
    v_add_u32 v6, 272, v6
    v_mfma_f32_16x16x32_bf16 v[134:137], v[154:157], a[208:211], v[134:137]
    v_mfma_f32_16x16x32_f16 v[154:157], v[170:173], v[138:141], v[50:53]
    v_mfma_f32_16x16x32_bf16 v[134:137], v[238:241], a[212:215], v[134:137]
    v_mfma_f32_16x16x16_bf16 v[238:241], a[216:217], v[254:255], v[218:221]
    v_mfma_f32_16x16x16_bf16 v[146:149], a[240:241], v[254:255], v[218:221]
    s_nop 0
    s_nop 0
    v_rsq_f32 v151, v151
    v_mfma_f32_16x16x16_f16 v[154:157], v[196:197], v[162:163], v[154:157]
    v_rsq_f32 v150, v150
    v_mul_f32 v214, v151, v214
    v_mul_f32 v150, s31, v150
    s_waitcnt vmcnt(0)
    s_barrier
    buffer_load_dwordx4 v10, s[8:11], 0 offen nt lds
    s_add_u32 m0, s28, 4096
    v_cvt_pk_bf16_f32 v246, v134, v135
    v_cvt_pk_bf16_f32 v247, v136, v137
    v_mul_f32 v215, v151, v215
    v_cvt_pk_f16_f32 v134, v214, v215
    v_mul_f32 v216, v151, v216
    v_mul_f32 v217, v151, v217
    v_cvt_pk_f16_f32 v135, v216, v217
    v_mfma_f32_16x16x16_bf16 v[190:193], v[90:91], v[254:255], v[218:221]
    v_mul_f32 v234, v151, v234
    v_mul_f32 v235, v151, v235
    v_cvt_pk_f16_f32 v136, v234, v235
    v_mfma_f32_16x16x16_bf16 v[214:217], a[218:219], v[254:255], v[178:181]
    v_mul_f32 v236, v151, v236
    v_mul_f32 v237, v151, v237
    buffer_load_dwordx4 v11, s[8:11], 0 offen nt lds
    s_add_u32 m0, s28, 8192
    v_cvt_pk_f16_f32 v137, v236, v237
    v_mul_f32 v182, v151, v182
    v_mul_f32 v183, v151, v183
    v_cvt_pk_f16_f32 v228, v182, v183
    v_mul_f32 v184, v151, v184
    v_mul_f32 v185, v151, v185
    v_mfma_f32_16x16x32_f16 v[218:221], v[134:137], v[138:141], v[54:57]
    v_cvt_pk_f16_f32 v229, v184, v185
    v_mul_f32 v202, v150, v202
    v_mul_f32 v203, v150, v203
    v_cvt_pk_f16_f32 v182, v202, v203
    v_mul_f32 v204, v150, v204
    v_mul_f32 v205, v150, v205
    v_mfma_f32_16x16x16_f16 v[218:221], v[228:229], v[162:163], v[218:221]
    buffer_load_dwordx4 v12, s[8:11], 0 offen nt lds
    s_add_u32 m0, s28, 12288
    s_xor_b32 s28, s28, 65536
    v_cvt_pk_f16_f32 v183, v204, v205
    v_mul_f32 v230, v150, v230
    v_mul_f32 v231, v150, v231
    v_cvt_pk_f16_f32 v184, v230, v231
    v_mfma_f32_16x16x16_bf16 v[202:205], a[242:243], v[254:255], v[178:181]
    v_mul_f32 v232, v150, v232
    v_mul_f32 v233, v150, v233
    v_cvt_pk_f16_f32 v185, v232, v233
    v_mul_f32 v114, v150, v114
    v_mul_f32 v115, v150, v115
    v_cvt_pk_f16_f32 v226, v114, v115
    v_mul_f32 v116, v150, v116
    v_mul_f32 v117, v150, v117
    buffer_load_dwordx4 v13, s[8:11], 0 offen nt lds
    s_mov_b32 m0, s29
    s_xor_b32 s29, s29, s30
    v_cvt_pk_f16_f32 v227, v116, v117
    v_mfma_f32_16x16x16_bf16 v[114:117], v[92:93], v[254:255], v[178:181]
    s_waitcnt lgkmcnt(0)
    v_cvt_pk_bf16_f32 v238, v238, v239
    v_accvgpr_write_b32 a216, v238
    v_cvt_pk_bf16_f32 v240, v240, v241
    v_mfma_f32_16x16x32_f16 v[150:153], v[122:125], v[138:141], v[22:25]
    v_accvgpr_write_b32 a217, v240
    v_cvt_pk_bf16_f32 v146, v146, v147
    v_mfma_f32_16x16x32_f16 v[150:153], v[174:177], v[142:145], v[150:153]
    v_accvgpr_write_b32 a240, v146
    v_cvt_pk_bf16_f32 v148, v148, v149
    v_mfma_f32_16x16x32_f16 v[150:153], v[118:121], v[162:165], v[150:153]
    buffer_load_dwordx4 v14, s[8:11], 0 offen nt lds
    v_accvgpr_write_b32 a241, v148
    v_mfma_f32_16x16x32_f16 v[146:149], v[122:125], v[166:169], v[24:27]
    v_cvt_pk_bf16_f32 v90, v190, v191
    v_cvt_pk_bf16_f32 v91, v192, v193
    v_mfma_f32_16x16x32_f16 v[146:149], v[174:177], v[170:173], v[146:149]
    ds_read_b128 v[138:141], v126 offset:128
    v_cvt_pk_bf16_f32 v214, v214, v215
    v_mfma_f32_16x16x32_f16 v[146:149], v[118:121], v[194:197], v[146:149]
    v_mov_b32_dpp v129, v151 quad_perm:[0,1,2,3] row_mask:0x1 bank_mask:0xf
    v_max3_f32 v127, v150, v186, v187
    v_mfma_f32_16x16x32_f16 v[178:181], v[122:125], v[182:185], v[26:29]
    v_max3_f32 v127, v127, v188, v189
    v_max3_f32 v127, v127, v154, v155
    v_mfma_f32_16x16x32_f16 v[178:181], v[174:177], v[134:137], v[178:181]
    v_max3_f32 v127, v127, v156, v157
    v_max3_f32 v127, v127, v218, v219
    v_mfma_f32_16x16x32_f16 v[178:181], v[118:121], v[226:229], v[178:181]
    v_mov_b32_dpp v129, v147 quad_perm:[0,1,2,3] row_mask:0x2 bank_mask:0xf
    v_max3_f32 v127, v127, v220, v221
    v_mov_b32 v128, v127
    v_accvgpr_write_b32 a218, v214
    v_cvt_pk_bf16_f32 v216, v216, v217
    v_permlane32_swap_b32 v127, v128
    v_max_f32 v127, v127, v128
    v_mov_b32 v128, v127
    v_mov_b32_dpp v129, v179 quad_perm:[0,1,2,3] row_mask:0x4 bank_mask:0xf
    v_accvgpr_write_b32 a219, v216
    v_permlane16_swap_b32 v127, v128
    s_waitcnt lgkmcnt(0)
    v_mfma_f32_16x16x16_bf16 v[118:121], a[232:233], v[254:255], v[138:141]
    v_max_f32 v127, v127, v128
    v_sub_f32 v186, v186, v127
    v_sub_f32 v187, v187, v127
    v_mfma_f32_16x16x16_bf16 v[174:177], v[82:83], v[254:255], v[138:141]
    v_exp_f32 v186, v186
    v_sub_f32 v188, v188, v127
    v_mfma_f32_16x16x16_bf16 v[122:125], v[106:107], v[254:255], v[138:141]
    v_exp_f32 v187, v187
    v_exp_f32 v188, v188
    v_cvt_pk_bf16_f32 v186, v186, v187
    v_sub_f32 v189, v189, v127
    v_exp_f32 v189, v189
    v_sub_f32 v154, v154, v127
    v_cvt_pk_bf16_f32 v187, v188, v189
    v_exp_f32 v154, v154
    v_mfma_f32_16x16x32_f16 v[138:141], v[142:145], v[166:169], v[58:61]
    v_sub_f32 v155, v155, v127
    v_exp_f32 v155, v155
    v_sub_f32 v156, v156, v127
    v_cvt_pk_bf16_f32 v188, v154, v155
    v_exp_f32 v156, v156
    v_sub_f32 v157, v157, v127
    v_mfma_f32_16x16x16_f16 v[138:141], v[164:165], v[194:195], v[138:141]
    v_exp_f32 v157, v157
    v_sub_f32 v218, v218, v127
    v_cvt_pk_bf16_f32 v189, v156, v157
    v_mfma_f32_16x16x32_f16 v[154:157], v[170:173], v[166:169], v[62:65]
    v_exp_f32 v218, v218
    v_sub_f32 v219, v219, v127
    v_exp_f32 v219, v219
    v_sub_f32 v220, v220, v127
    v_cvt_pk_bf16_f32 v36, v218, v219
    v_exp_f32 v220, v220
    v_mfma_f32_16x16x32_f16 v[238:241], v[134:137], v[166:169], v[66:69]
    v_sub_f32 v221, v221, v127
    v_exp_f32 v221, v221
    v_mfma_f32_16x16x16_f16 v[154:157], v[196:197], v[194:195], v[154:157]
    v_cvt_pk_bf16_f32 v37, v220, v221
    v_sub_f32 v150, v150, v127
    v_exp_f32 v150, v150
    v_mfma_f32_16x16x16_f16 v[238:241], v[228:229], v[194:195], v[238:241]
    v_cvt_pk_bf16_f32 v39, v150, 0
    v_cvt_pk_bf16_f32 v202, v202, v203
    v_accvgpr_write_b32 a242, v202
    v_cvt_pk_bf16_f32 v204, v204, v205
    v_mfma_f32_16x16x32_bf16 v[150:153], v[28:31], v[36:39], 0
    v_accvgpr_write_b32 a243, v204
    v_cvt_pk_bf16_f32 v92, v114, v115
    v_mfma_f32_16x16x32_bf16 v[150:153], v[28:31], v[186:189], v[150:153]
    v_cvt_pk_bf16_f32 v93, v116, v117
    v_cvt_pk_bf16_f32 v118, v118, v119
    v_mfma_f32_16x16x32_bf16 v[114:117], v[210:213], v[36:39], 0
    ds_read_b128 v[166:169], v126 offset:192
    v_accvgpr_write_b32 a232, v118
    v_mfma_f32_16x16x32_bf16 v[114:117], v[198:201], v[186:189], v[114:117]
    v_cvt_pk_bf16_f32 v120, v120, v121
    v_accvgpr_write_b32 a233, v120
    v_mfma_f32_16x16x32_bf16 v[202:205], v[222:225], v[36:39], 0
    v_rcp_f32 v150, v150
    v_mfma_f32_16x16x32_bf16 v[202:205], v[130:133], v[186:189], v[202:205]
    v_cvt_pk_bf16_f32 v82, v174, v175
    v_cvt_pk_bf16_f32 v83, v176, v177
    v_mfma_f32_16x16x32_bf16 v[118:121], v[246:249], v[36:39], 0
    v_mul_f32 v114, v150, v114
    v_mul_f32 v115, v150, v115
    v_mfma_f32_16x16x32_bf16 v[118:121], v[158:161], v[186:189], v[118:121]
    v_cvt_pk_bf16_f32 v114, v114, v115
    v_mul_f32 v116, v150, v116
    v_mul_f32 v117, v150, v117
    v_cvt_pk_bf16_f32 v115, v116, v117
    v_mul_f32 v202, v150, v202
    v_mul_f32 v203, v150, v203
    v_cvt_pk_bf16_f32 v116, v202, v203
    v_mul_f32 v204, v150, v204
    s_waitcnt lgkmcnt(0)
    v_mfma_f32_16x16x16_bf16 v[174:177], a[220:221], v[254:255], v[166:169]
    v_mul_f32 v205, v150, v205
    v_cvt_pk_bf16_f32 v117, v204, v205
    v_mul_f32 v118, v150, v118
    v_mfma_f32_16x16x16_bf16 v[186:189], a[244:245], v[254:255], v[166:169]
    v_mul_f32 v119, v150, v119
    v_cvt_pk_bf16_f32 v162, v118, v119
    v_mul_f32 v120, v150, v120
    v_mfma_f32_16x16x16_bf16 v[202:205], v[94:95], v[254:255], v[166:169]
    ds_write_b128 v3, v[114:117] offset:0
    v_mul_f32 v121, v150, v121
    v_cvt_pk_bf16_f32 v163, v120, v121
    v_cvt_pk_bf16_f32 v106, v122, v123
    v_cvt_pk_bf16_f32 v107, v124, v125
    v_cvt_pk_bf16_f32 v174, v174, v175
    v_accvgpr_write_b32 a220, v174
    v_cvt_pk_bf16_f32 v176, v176, v177
    ds_read_b128 v[114:117], v126 offset:256
    ds_write_b64 v4, v[162:163] offset:4096
    v_accvgpr_write_b32 a221, v176
    v_cvt_pk_bf16_f32 v186, v186, v187
    v_accvgpr_write_b32 a244, v186
    v_cvt_pk_bf16_f32 v188, v188, v189
    v_accvgpr_write_b32 a245, v188
    v_cvt_pk_bf16_f32 v94, v202, v203
    v_cvt_pk_bf16_f32 v95, v204, v205
    ds_read_b128 v[118:121], v126 offset:320
    v_mov_b32 v127, v129
    v_max3_f32 v194, v146, v138, v139
    v_max3_f32 v194, v194, v140, v141
    v_max_f32_dpp v127, v127, v127 quad_perm:[1,0,3,2] row_mask:0xf bank_mask:0xf
    v_max3_f32 v194, v194, v154, v155
    v_max3_f32 v194, v194, v156, v157
    v_max_f32_dpp v127, v127, v127 quad_perm:[2,3,0,1] row_mask:0xf bank_mask:0xf
    v_max3_f32 v194, v194, v238, v239
    v_max3_f32 v194, v194, v240, v241
    v_max_f32_dpp v127, v127, v127 row_half_mirror row_mask:0xf bank_mask:0xf
    v_mov_b32 v195, v194
    s_nop 0
    v_max_f32_dpp v127, v127, v127 row_mirror row_mask:0xf bank_mask:0xf
    v_mov_b32 v128, v127
    s_waitcnt lgkmcnt(2)
    v_mfma_f32_16x16x16_bf16 v[174:177], a[222:223], v[254:255], v[114:117]
    v_permlane32_swap_b32 v127, v128
    v_max_f32 v127, v127, v128
    v_mfma_f32_16x16x16_bf16 v[122:125], a[246:247], v[254:255], v[114:117]
    v_mov_b32 v128, v127
    v_permlane32_swap_b32 v194, v195
    v_mfma_f32_16x16x16_bf16 v[150:153], v[96:97], v[254:255], v[114:117]
    v_permlane16_swap_b32 v127, v128
    v_max_f32 v127, v127, v128
    s_waitcnt lgkmcnt(0)
    v_mfma_f32_16x16x16_bf16 v[166:169], a[234:235], v[254:255], v[118:121]
    v_cvt_pk_bf16_f32 v174, v174, v175
    v_accvgpr_write_b32 a222, v174
    v_cvt_pk_bf16_f32 v176, v176, v177
    v_mfma_f32_16x16x16_bf16 v[114:117], v[84:85], v[254:255], v[118:121]
    v_accvgpr_write_b32 a223, v176
    v_cvt_pk_bf16_f32 v122, v122, v123
    v_accvgpr_write_b32 a246, v122
    v_mfma_f32_16x16x16_bf16 v[174:177], v[108:109], v[254:255], v[118:121]
    v_cvt_pk_bf16_f32 v124, v124, v125
    v_accvgpr_write_b32 a247, v124
    v_cvt_pk_bf16_f32 v96, v150, v151
    v_cvt_pk_bf16_f32 v97, v152, v153
    ds_read_b128 v[118:121], v126 offset:384
    v_cvt_pk_bf16_f32 v166, v166, v167
    v_accvgpr_write_b32 a234, v166
    v_cvt_pk_bf16_f32 v168, v168, v169
    v_accvgpr_write_b32 a235, v168
    v_cvt_pk_bf16_f32 v84, v114, v115
    v_cvt_pk_bf16_f32 v85, v116, v117
    v_cvt_pk_bf16_f32 v108, v174, v175
    v_cvt_pk_bf16_f32 v109, v176, v177
    ds_read_b128 v[114:117], v126 offset:448
    v_sub_f32 v129, v129, v127
    v_exp_f32 v129, v129
    v_max_f32 v194, v194, v195
    v_cvt_pk_bf16_f32 v129, v129, v129
    ds_write_b16 v8, v129
    v_mov_b32 v195, v194
    ds_read_b128 v[174:177], v9
    ds_read_b128 v[150:153], v9 offset:64
    v_permlane16_swap_b32 v194, v195
    s_waitcnt lgkmcnt(4)
    v_mfma_f32_16x16x16_bf16 v[122:125], a[224:225], v[254:255], v[118:121]
    v_max_f32 v194, v194, v195
    v_sub_f32 v138, v138, v194
    v_sub_f32 v139, v139, v194
    v_mfma_f32_16x16x16_bf16 v[166:169], a[248:249], v[254:255], v[118:121]
    v_exp_f32 v138, v138
    v_sub_f32 v140, v140, v194
    v_mfma_f32_16x16x16_bf16 v[186:189], v[98:99], v[254:255], v[118:121]
    v_exp_f32 v139, v139
    s_waitcnt lgkmcnt(3)
    v_mfma_f32_16x16x16_bf16 v[202:205], a[226:227], v[254:255], v[114:117]
    v_cvt_pk_bf16_f32 v122, v122, v123
    v_accvgpr_write_b32 a224, v122
    v_cvt_pk_bf16_f32 v124, v124, v125
    v_mfma_f32_16x16x16_bf16 v[118:121], a[250:251], v[254:255], v[114:117]
    v_accvgpr_write_b32 a225, v124
    v_cvt_pk_bf16_f32 v166, v166, v167
    v_accvgpr_write_b32 a248, v166
    v_mfma_f32_16x16x16_bf16 v[122:125], v[100:101], v[254:255], v[114:117]
    v_cvt_pk_bf16_f32 v168, v168, v169
    v_accvgpr_write_b32 a249, v168
    s_waitcnt lgkmcnt(1)
    v_cvt_pk_bf16_f32 v98, v186, v187
    v_mfma_f32_16x16x32_bf16 v[114:117], v[174:177], v[28:31], 0
    s_waitcnt lgkmcnt(0)
    v_cvt_pk_bf16_f32 v99, v188, v189
    v_cvt_pk_bf16_f32 v202, v202, v203
    v_mfma_f32_16x16x32_bf16 v[114:117], v[150:153], v[28:31], v[114:117]
    ds_read_b128 v[166:169], v126 offset:512
    v_accvgpr_write_b32 a226, v202
    v_mfma_f32_16x16x32_bf16 v[186:189], v[174:177], v[198:201], 0
    v_cvt_pk_bf16_f32 v204, v204, v205
    v_accvgpr_write_b32 a227, v204
    v_mfma_f32_16x16x32_bf16 v[186:189], v[150:153], v[210:213], v[186:189]
    v_cvt_pk_bf16_f32 v118, v118, v119
    v_accvgpr_write_b32 a250, v118
    v_mfma_f32_16x16x32_bf16 v[202:205], v[174:177], v[130:133], 0
    v_cvt_pk_bf16_f32 v120, v120, v121
    v_accvgpr_write_b32 a251, v120
    v_mfma_f32_16x16x32_bf16 v[202:205], v[150:153], v[222:225], v[202:205]
    v_cvt_pk_bf16_f32 v100, v122, v123
    v_cvt_pk_bf16_f32 v101, v124, v125
    v_mfma_f32_16x16x32_bf16 v[118:121], v[174:177], v[158:161], 0
    ds_read_b128 v[174:177], v126 offset:576
    v_cvt_pk_bf16_f32 v138, v138, v139
    v_mfma_f32_16x16x32_bf16 v[118:121], v[150:153], v[246:249], v[118:121]
    v_exp_f32 v140, v140
    v_sub_f32 v141, v141, v194
    v_exp_f32 v141, v141
    s_waitcnt lgkmcnt(1)
    v_mfma_f32_16x16x16_bf16 v[122:125], a[236:237], v[254:255], v[166:169]
    v_cvt_pk_bf16_f32 v139, v140, v141
    v_sub_f32 v154, v154, v194
    v_sub_f32 v155, v155, v194
    v_mfma_f32_16x16x16_bf16 v[150:153], v[86:87], v[254:255], v[166:169]
    v_exp_f32 v154, v154
    v_sub_f32 v156, v156, v194
    v_mfma_f32_16x16x16_bf16 v[230:233], v[110:111], v[254:255], v[166:169]
    v_exp_f32 v155, v155
    v_cvt_pk_bf16_f32 v122, v122, v123
    v_accvgpr_write_b32 a236, v122
    v_cvt_pk_bf16_f32 v124, v124, v125
    v_accvgpr_write_b32 a237, v124
    v_cvt_pk_bf16_f32 v86, v150, v151
    v_cvt_pk_bf16_f32 v87, v152, v153
    v_cvt_pk_bf16_f32 v140, v154, v155
    s_waitcnt lgkmcnt(0)
    v_mfma_f32_16x16x16_bf16 v[122:125], a[228:229], v[254:255], v[174:177]
    v_cvt_pk_bf16_f32 v110, v230, v231
    v_cvt_pk_bf16_f32 v111, v232, v233
    v_sub_f32 v157, v157, v194
    v_mfma_f32_16x16x16_bf16 v[150:153], a[252:253], v[254:255], v[174:177]
    v_exp_f32 v156, v156
    v_sub_f32 v238, v238, v194
    v_mfma_f32_16x16x16_bf16 v[166:169], v[102:103], v[254:255], v[174:177]
    ds_read_b128 v[230:233], v126 offset:640
    v_cvt_pk_bf16_f32 v122, v122, v123
    v_accvgpr_write_b32 a228, v122
    v_cvt_pk_bf16_f32 v124, v124, v125
    v_accvgpr_write_b32 a229, v124
    v_cvt_pk_bf16_f32 v150, v150, v151
    v_accvgpr_write_b32 a252, v150
    v_cvt_pk_bf16_f32 v152, v152, v153
    v_accvgpr_write_b32 a253, v152
    v_cvt_pk_bf16_f32 v102, v166, v167
    v_cvt_pk_bf16_f32 v103, v168, v169
    ds_read_b128 v[174:177], v126 offset:704
    v_exp_f32 v157, v157
    v_mfma_f32_16x16x32_f16 v[126:129], v[142:145], v[182:185], v[70:73]
    v_cvt_pk_bf16_f32 v141, v156, v157
    v_exp_f32 v238, v238
    v_sub_f32 v239, v239, v194
    v_exp_f32 v239, v239
    v_sub_f32 v240, v240, v194
    v_cvt_pk_bf16_f32 v36, v238, v239
    v_mfma_f32_16x16x16_f16 v[126:129], v[164:165], v[226:227], v[126:129]
    v_exp_f32 v240, v240
    v_sub_f32 v241, v241, v194
    v_sub_f32 v146, v146, v194
    v_mfma_f32_16x16x32_f16 v[142:145], v[170:173], v[182:185], v[74:77]
    s_waitcnt lgkmcnt(1)
    v_exp_f32 v241, v241
    v_mfma_f32_16x16x32_f16 v[154:157], v[134:137], v[182:185], v[78:81]
    v_cvt_pk_bf16_f32 v37, v240, v241
    v_exp_f32 v146, v146
    v_mfma_f32_16x16x16_bf16 v[134:137], a[230:231], v[254:255], v[230:233]
    v_max3_f32 v179, v178, v126, v127
    v_max3_f32 v179, v179, v128, v129
    v_cvt_pk_bf16_f32 v39, v146, 0
    v_mfma_f32_16x16x16_f16 v[142:145], v[196:197], v[226:227], v[142:145]
    v_rcp_f32 v114, v114
    v_mfma_f32_16x16x16_f16 v[154:157], v[228:229], v[226:227], v[154:157]
    v_mul_f32 v186, v186, v114
    v_mfma_f32_16x16x32_bf16 v[122:125], v[28:31], v[36:39], 0
    s_waitcnt lgkmcnt(0)
    v_cvt_pk_bf16_f32 v134, v134, v135
    v_accvgpr_write_b32 a230, v134
    v_mfma_f32_16x16x32_bf16 v[122:125], v[28:31], v[138:141], v[122:125]
    v_cvt_pk_bf16_f32 v136, v136, v137
    v_accvgpr_write_b32 a231, v136
    v_mfma_f32_16x16x32_bf16 v[134:137], v[210:213], v[36:39], 0
    v_max3_f32 v179, v179, v142, v143
    v_max3_f32 v179, v179, v144, v145
    v_mfma_f32_16x16x32_bf16 v[134:137], v[198:201], v[138:141], v[134:137]
    v_max3_f32 v179, v179, v154, v155
    v_max3_f32 v179, v179, v156, v157
    v_mfma_f32_16x16x32_bf16 v[182:185], v[222:225], v[36:39], 0
    v_rcp_f32 v122, v122
    v_mfma_f32_16x16x32_bf16 v[182:185], v[130:133], v[138:141], v[182:185]
    v_mov_b32 v180, v179
    v_mul_f32_dpp v186, v202, v114 quad_perm:[0,1,2,3] row_mask:0x2 bank_mask:0xf
    v_mfma_f32_16x16x32_bf16 v[170:173], v[246:249], v[36:39], 0
    v_mul_f32 v134, v122, v134
    v_mul_f32 v135, v122, v135
    v_mfma_f32_16x16x32_bf16 v[170:173], v[158:161], v[138:141], v[170:173]
    v_cvt_pk_bf16_f32 v138, v134, v135
    v_mul_f32 v136, v122, v136
    v_mul_f32 v137, v122, v137
    v_mfma_f32_16x16x16_bf16 v[150:153], a[254:255], v[254:255], v[230:233]
    v_cvt_pk_bf16_f32 v139, v136, v137
    v_mul_f32 v182, v122, v182
    v_mul_f32 v183, v122, v183
    v_mfma_f32_16x16x16_bf16 v[134:137], v[104:105], v[254:255], v[230:233]
    v_cvt_pk_bf16_f32 v140, v182, v183
    v_mul_f32 v184, v122, v184
    v_mul_f32 v185, v122, v185
    v_mfma_f32_16x16x16_bf16 v[146:149], a[238:239], v[254:255], v[174:177]
    v_cvt_pk_bf16_f32 v141, v184, v185
    v_mul_f32 v170, v122, v170
    v_mul_f32 v171, v122, v171
    v_mfma_f32_16x16x16_bf16 v[182:185], v[88:89], v[254:255], v[174:177]
    v_cvt_pk_bf16_f32 v116, v170, v171
    v_mul_f32 v172, v122, v172
    v_mul_f32 v173, v122, v173
    v_mfma_f32_16x16x16_bf16 v[122:125], v[112:113], v[254:255], v[174:177]
    ds_write_b128 v3, v[138:141] offset:6144
    v_cvt_pk_bf16_f32 v117, v172, v173
    v_cvt_pk_bf16_f32 v150, v150, v151
    v_accvgpr_write_b32 a254, v150
    v_cvt_pk_bf16_f32 v152, v152, v153
    v_accvgpr_write_b32 a255, v152
    v_cvt_pk_bf16_f32 v104, v134, v135
    v_cvt_pk_bf16_f32 v105, v136, v137
    ds_write_b64 v4, v[116:117] offset:10240
    v_cvt_pk_bf16_f32 v146, v146, v147
    v_accvgpr_write_b32 a238, v146
    v_cvt_pk_bf16_f32 v148, v148, v149
    v_accvgpr_write_b32 a239, v148
    v_cvt_pk_bf16_f32 v88, v182, v183
    v_cvt_pk_bf16_f32 v89, v184, v185
    v_cvt_pk_bf16_f32 v112, v122, v123
    v_cvt_pk_bf16_f32 v113, v124, v125
    v_permlane32_swap_b32 v179, v180
    v_max_f32 v179, v179, v180
    v_mov_b32 v180, v179
    v_mul_f32_dpp v186, v118, v114 quad_perm:[0,1,2,3] row_mask:0x4 bank_mask:0xf
    v_cvt_pk_bf16_f32 v186, v186, v186
    ds_write_b16 v7, v186
    v_permlane16_swap_b32 v179, v180
    v_max_f32 v179, v179, v180
    v_sub_f32 v126, v126, v179
    v_exp_f32 v126, v126
    v_sub_f32 v127, v127, v179
    v_exp_f32 v127, v127
    v_sub_f32 v128, v128, v179
    v_cvt_pk_bf16_f32 v114, v126, v127
    v_exp_f32 v128, v128
    ds_read_b128 v[186:189], v0 offset:20480
    ds_read_b128 v[194:197], v1 offset:20480
    ds_read_b128 v[122:125], v0 offset:20608
    ds_read_b128 v[202:205], v1 offset:20608
    ds_read_b128 v[230:233], v0 offset:20736
    ds_read_b128 v[238:241], v1 offset:20736
    v_sub_f32 v129, v129, v179
    v_exp_f32 v129, v129
    v_sub_f32 v142, v142, v179
    v_cvt_pk_bf16_f32 v115, v128, v129
    v_exp_f32 v142, v142
    v_sub_f32 v143, v143, v179
    v_exp_f32 v143, v143
    v_sub_f32 v144, v144, v179
    v_cvt_pk_bf16_f32 v116, v142, v143
    v_exp_f32 v144, v144
    s_waitcnt lgkmcnt(5)
    v_mfma_f32_16x16x32_bf16 v[150:153], a[72:75], v[186:189], 0
    s_waitcnt lgkmcnt(3)
    v_sub_f32 v145, v145, v179
    v_sub_f32 v154, v154, v179
    v_mfma_f32_16x16x32_bf16 v[150:153], a[76:79], v[194:197], v[150:153]
    s_waitcnt lgkmcnt(2)
    v_exp_f32 v145, v145
    v_mfma_f32_16x16x32_bf16 v[150:153], a[80:83], v[122:125], v[150:153]
    s_waitcnt lgkmcnt(1)
    v_cvt_pk_bf16_f32 v117, v144, v145
    v_sub_f32 v155, v155, v179
    v_mfma_f32_16x16x32_bf16 v[150:153], a[84:87], v[202:205], v[150:153]
    s_waitcnt lgkmcnt(0)
    v_exp_f32 v154, v154
    v_mfma_f32_16x16x32_bf16 v[150:153], a[88:91], v[230:233], v[150:153]
    v_exp_f32 v155, v155
    v_mfma_f32_16x16x32_bf16 v[150:153], a[92:95], v[238:241], v[150:153]
    v_cvt_pk_bf16_f32 v36, v154, v155
    v_sub_f32 v156, v156, v179
    v_mfma_f32_16x16x32_bf16 v[162:165], a[96:99], v[186:189], 0
    v_exp_f32 v156, v156
    v_mfma_f32_16x16x32_bf16 v[162:165], a[100:103], v[194:197], v[162:165]
    v_sub_f32 v157, v157, v179
    v_sub_f32 v178, v178, v179
    v_mfma_f32_16x16x32_bf16 v[162:165], a[104:107], v[122:125], v[162:165]
    v_exp_f32 v157, v157
    v_mfma_f32_16x16x32_bf16 v[162:165], a[108:111], v[202:205], v[162:165]
    v_cvt_pk_bf16_f32 v37, v156, v157
    v_add_u32 v7, 16, v7
    v_mfma_f32_16x16x32_bf16 v[162:165], a[112:115], v[230:233], v[162:165]
    v_exp_f32 v178, v178
    v_mfma_f32_16x16x32_bf16 v[162:165], a[116:119], v[238:241], v[162:165]
    v_cvt_pk_bf16_f32 v39, v178, 0
    v_mfma_f32_16x16x32_bf16 v[170:173], a[120:123], v[186:189], 0
    v_mfma_f32_16x16x32_bf16 v[170:173], a[124:127], v[194:197], v[170:173]
    v_mfma_f32_16x16x32_bf16 v[142:145], v[28:31], v[36:39], 0
    v_mfma_f32_16x16x32_bf16 v[142:145], v[28:31], v[114:117], v[142:145]
    v_mfma_f32_16x16x32_bf16 v[174:177], v[210:213], v[36:39], 0
    v_mfma_f32_16x16x32_bf16 v[174:177], v[198:201], v[114:117], v[174:177]
    v_mfma_f32_16x16x32_bf16 v[126:129], v[222:225], v[36:39], 0
    v_mfma_f32_16x16x32_bf16 v[126:129], v[130:133], v[114:117], v[126:129]
    v_mfma_f32_16x16x32_bf16 v[130:133], v[246:249], v[36:39], 0
    v_mfma_f32_16x16x32_bf16 v[130:133], v[158:161], v[114:117], v[130:133]
    v_mfma_f32_16x16x32_bf16 v[170:173], a[128:131], v[122:125], v[170:173]
    v_mfma_f32_16x16x32_bf16 v[170:173], a[132:135], v[202:205], v[170:173]
    v_rcp_f32 v142, v142
    v_mfma_f32_16x16x32_bf16 v[170:173], a[136:139], v[230:233], v[170:173]
    v_mul_f32 v174, v142, v174
    v_mul_f32 v175, v142, v175
    v_mfma_f32_16x16x32_bf16 v[170:173], a[140:143], v[238:241], v[170:173]
    v_cvt_pk_bf16_f32 v114, v174, v175
    v_mul_f32 v176, v142, v176
    v_mfma_f32_16x16x32_bf16 v[138:141], a[0:3], v[186:189], 0
    v_mul_f32 v177, v142, v177
    v_cvt_pk_bf16_f32 v115, v176, v177
    v_mfma_f32_16x16x32_bf16 v[138:141], a[4:7], v[194:197], v[138:141]
    v_mul_f32 v126, v142, v126
    v_mul_f32 v127, v142, v127
    v_mfma_f32_16x16x32_bf16 v[138:141], a[8:11], v[122:125], v[138:141]
    v_cvt_pk_bf16_f32 v116, v126, v127
    v_mul_f32 v128, v142, v128
    v_mfma_f32_16x16x32_bf16 v[138:141], a[12:15], v[202:205], v[138:141]
    v_mul_f32 v129, v142, v129
    v_cvt_pk_bf16_f32 v117, v128, v129
    v_mfma_f32_16x16x32_bf16 v[138:141], a[16:19], v[230:233], v[138:141]
    ds_write_b128 v3, v[114:117] offset:12288
    v_mfma_f32_16x16x32_bf16 v[138:141], a[20:23], v[238:241], v[138:141]
    v_mul_f32 v130, v142, v130
    v_mul_f32 v131, v142, v131
    v_mfma_f32_16x16x32_bf16 v[166:169], a[24:27], v[186:189], 0
    v_cvt_pk_bf16_f32 v254, v130, v131
    v_mul_f32 v132, v142, v132
    v_mfma_f32_16x16x32_bf16 v[166:169], a[28:31], v[194:197], v[166:169]
    v_mul_f32 v133, v142, v133
    v_cvt_pk_bf16_f32 v255, v132, v133
    v_mfma_f32_16x16x32_bf16 v[166:169], a[32:35], v[122:125], v[166:169]
    ds_write_b64 v4, v[254:255] offset:16384
    v_mfma_f32_16x16x32_bf16 v[166:169], a[36:39], v[202:205], v[166:169]
    v_xor_b32 v3, 65536, v3
    v_xor_b32 v4, 65536, v4
    v_mfma_f32_16x16x32_bf16 v[166:169], a[40:43], v[230:233], v[166:169]
    v_mfma_f32_16x16x32_bf16 v[166:169], a[44:47], v[238:241], v[166:169]
    v_mfma_f32_16x16x32_bf16 v[134:137], a[48:51], v[186:189], 0
    v_mfma_f32_16x16x32_bf16 v[134:137], a[52:55], v[194:197], v[134:137]
    s_waitcnt lgkmcnt(0)
    s_barrier
    s_waitcnt lgkmcnt(0)
    s_cmp_eq_u32 s45, 0
    s_cbranch_scc1 L_drain
    s_nop 0
    s_lshr_b32 s3, s44, 8
    s_cbranch_scc1 L_safe
    v_cvt_pk_f16_f32 v146, v150, v151
    v_pk_mul_f16 v143, v146, v146
    v_cvt_pk_f16_f32 v147, v152, v153
    v_pk_fma_f16 v143, v147, v147, v143
    v_cvt_pk_f16_f32 v148, v162, v163
    v_pk_fma_f16 v143, v148, v148, v143
    v_cvt_pk_f16_f32 v149, v164, v165
    v_pk_fma_f16 v143, v149, v149, v143
    v_cvt_pk_f16_f32 v120, v170, v171
    v_pk_fma_f16 v143, v120, v120, v143
    v_cvt_pk_f16_f32 v121, v172, v173
    v_pk_fma_f16 v143, v121, v121, v143
    v_and_b32 v118, 16, v2
    v_sub_u32 v5, v5, v118
    v_mov_b32 v25, 0
    s_nop 7
    s_branch L_go
L_safe:
    v_fma_f32 v174, v150, v150, s32
    v_fmac_f32 v174, v151, v151
    v_fmac_f32 v174, v152, v152
    v_fmac_f32 v174, v153, v153
    s_nop 7
L_LOOP:
    v_mfma_f32_16x16x32_bf16 v[134:137], a[56:59], v[122:125], v[134:137]
    s_add_u32 s12, s40, s27
    ds_read_b128 v[118:121], v2 offset:18432
    ds_read_b128 v[142:145], v2 offset:19456
    v_mfma_f32_16x16x32_bf16 v[134:137], a[60:63], v[202:205], v[134:137]
    s_addc_u32 s13, s41, 0
    v_fmac_f32 v174, v162, v162
    v_fmac_f32 v174, v163, v163
    v_mfma_f32_16x16x32_bf16 v[134:137], a[64:67], v[230:233], v[134:137]
    s_sub_u32 s14, s36, s27
    v_fmac_f32 v174, v164, v164
    v_fmac_f32 v174, v165, v165
    v_mfma_f32_16x16x32_bf16 v[134:137], a[68:71], v[238:241], v[134:137]
    s_cmp_ge_u32 s18, 2
    v_fmac_f32 v174, v170, v170
    v_fmac_f32 v174, v171, v171
    v_mfma_f32_16x16x32_bf16 v[146:149], v[186:189], a[144:147], 0
    s_cselect_b32 s14, s14, 0
    v_fmac_f32 v174, v172, v172
    v_fmac_f32 v174, v173, v173
    v_mfma_f32_16x16x32_bf16 v[146:149], v[194:197], a[148:151], v[146:149]
    s_sub_u32 s82, s72, s71
    v_fma_f32 v254, v138, v138, s32
    v_fmac_f32 v254, v139, v139
    v_mfma_f32_16x16x32_bf16 v[146:149], v[122:125], a[152:155], v[146:149]
    s_mul_i32 s74, s82, 336
    v_fmac_f32 v254, v140, v140
    v_fmac_f32 v254, v141, v141
    v_mfma_f32_16x16x32_bf16 v[146:149], v[202:205], a[156:159], v[146:149]
    s_mul_i32 s75, s82, 272
    v_fmac_f32 v254, v166, v166
    v_fmac_f32 v254, v167, v167
    v_mfma_f32_16x16x32_bf16 v[146:149], v[230:233], a[160:163], v[146:149]
    s_waitcnt lgkmcnt(0)
    v_fmac_f32 v254, v168, v168
    v_fmac_f32 v254, v169, v169
    v_mfma_f32_16x16x32_bf16 v[182:185], v[32:35], v[118:121], 0
    s_mul_i32 s76, s82, 16
    v_fmac_f32 v254, v134, v134
    v_fmac_f32 v254, v135, v135
    v_mfma_f32_16x16x32_bf16 v[182:185], v[32:35], v[142:145], v[182:185]
    s_add_u32 s34, s18, 2
    v_fmac_f32 v254, v136, v136
    v_fmac_f32 v254, v137, v137
    v_mfma_f32_16x16x32_bf16 v[146:149], v[238:241], a[164:167], v[146:149]
    s_add_u32 s8, s60, s23
    ds_read_b128 v[190:193], v0 offset:26624
    v_cvt_pk_bf16_f32 v36, v254, v174
    v_mfma_f32_16x16x32_bf16 v[118:121], v[186:189], a[168:171], 0
    s_addc_u32 s9, s61, 0
    ds_read_b128 v[210:213], v1 offset:26624
    v_mul_f32 v254, 0x3baaaaab, v182
    v_mfma_f32_16x16x32_bf16 v[214:217], v[32:35], v[36:39], 0
    s_sub_u32 s10, s36, s23
    v_cvt_pk_bf16_f32 v142, v146, v147
    v_cvt_pk_bf16_f32 v143, v148, v149
    v_mfma_f32_16x16x32_bf16 v[118:121], v[194:197], a[172:175], v[118:121]
    s_cmp_le_u32 s34, s45
    ds_read_b128 v[218:221], v0 offset:26752
    v_mul_f32 v255, 0x3baaaaab, v183
    v_mfma_f32_16x16x32_bf16 v[118:121], v[122:125], a[176:179], v[118:121]
    s_cselect_b32 s10, s10, 0
    ds_read_b128 v[222:225], v1 offset:26752
    v_mul_f32 v144, 0x3baaaaab, v184
    v_mfma_f32_16x16x32_bf16 v[118:121], v[202:205], a[180:183], v[118:121]
    s_add_u32 m0, s28, 0
    v_rsq_f32 v215, v215
    v_mfma_f32_16x16x32_bf16 v[118:121], v[230:233], a[184:187], v[118:121]
    s_mov_b32 s27, s26
    v_rsq_f32 v214, v214
    v_mfma_f32_16x16x32_bf16 v[118:121], v[238:241], a[188:191], v[118:121]
    s_mov_b32 s26, s25
    v_mul_f32 v214, s31, v214
    v_mul_f32 v150, v215, v150
    v_mul_f32 v151, v215, v151
    v_cvt_pk_f16_f32 v174, v150, v151
    v_mfma_f32_16x16x32_bf16 v[182:185], v[186:189], a[192:195], 0
    s_waitcnt lgkmcnt(2)
    ds_read_b128 v[186:189], v0 offset:26880
    v_cvt_pk_bf16_f32 v146, v118, v119
    v_mfma_f32_16x16x32_bf16 v[182:185], v[194:197], a[196:199], v[182:185]
    s_mov_b32 s25, s24
    ds_read_b128 v[194:197], v1 offset:26880
    v_cvt_pk_bf16_f32 v147, v120, v121
    v_mfma_f32_16x16x32_bf16 v[182:185], v[122:125], a[200:203], v[182:185]
    s_mov_b32 s24, s23
    v_mul_f32 v152, v215, v152
    v_mul_f32 v153, v215, v153
    v_mfma_f32_16x16x32_bf16 v[182:185], v[202:205], a[204:207], v[182:185]
    s_ff1_i32_b32 s77, s100
    v_cvt_pk_f16_f32 v175, v152, v153
    v_mul_f32 v162, v215, v162
    v_mfma_f32_16x16x32_bf16 v[182:185], v[230:233], a[208:211], v[182:185]
    s_mul_i32 s78, s77, 2688
    v_mul_f32 v163, v215, v163
    v_cvt_pk_f16_f32 v176, v162, v163
    v_mfma_f32_16x16x32_bf16 v[182:185], v[238:241], a[212:215], v[182:185]
    s_mov_b32 s71, s72
    v_mul_f32 v164, v215, v164
    v_mul_f32 v165, v215, v165
    v_mfma_f32_16x16x32_bf16 v[122:125], a[72:75], v[190:193], 0
    s_mov_b32 s72, s73
    v_cvt_pk_f16_f32 v177, v164, v165
    v_mul_f32 v170, v215, v170
    v_mfma_f32_16x16x32_bf16 v[122:125], a[76:79], v[210:213], v[122:125]
    s_waitcnt lgkmcnt(2)
    v_cvt_pk_bf16_f32 v150, v182, v183
    v_cvt_pk_bf16_f32 v151, v184, v185
    v_mfma_f32_16x16x32_bf16 v[122:125], a[80:83], v[218:221], v[122:125]
    s_waitcnt lgkmcnt(1)
    v_mul_f32 v171, v215, v171
    v_cvt_pk_f16_f32 v120, v170, v171
    v_mfma_f32_16x16x32_bf16 v[122:125], a[84:87], v[222:225], v[122:125]
    s_waitcnt lgkmcnt(0)
    v_mul_f32 v172, v215, v172
    v_mul_f32 v173, v215, v173
    v_mfma_f32_16x16x32_bf16 v[122:125], a[88:91], v[186:189], v[122:125]
    v_cvt_pk_f16_f32 v121, v172, v173
    v_mul_f32 v138, v214, v138
    v_mfma_f32_16x16x32_bf16 v[122:125], a[92:95], v[194:197], v[122:125]
    v_mul_f32 v139, v214, v139
    v_cvt_pk_f16_f32 v202, v138, v139
    v_mfma_f32_16x16x32_bf16 v[162:165], a[96:99], v[190:193], 0
    v_mul_f32 v140, v214, v140
    v_mul_f32 v141, v214, v141
    v_mfma_f32_16x16x32_bf16 v[162:165], a[100:103], v[210:213], v[162:165]
    v_cvt_pk_f16_f32 v203, v140, v141
    v_mul_f32 v166, v214, v166
    v_mfma_f32_16x16x32_bf16 v[162:165], a[104:107], v[218:221], v[162:165]
    v_mul_f32 v167, v214, v167
    v_cvt_pk_f16_f32 v204, v166, v167
    v_mfma_f32_16x16x32_bf16 v[162:165], a[108:111], v[222:225], v[162:165]
    v_mul_f32 v168, v214, v168
    v_mul_f32 v169, v214, v169
    v_mfma_f32_16x16x32_bf16 v[162:165], a[112:115], v[186:189], v[162:165]
    v_cvt_pk_f16_f32 v205, v168, v169
    v_mul_f32 v134, v214, v134
    v_mfma_f32_16x16x32_bf16 v[162:165], a[116:119], v[194:197], v[162:165]
    v_mul_f32 v135, v214, v135
    v_cvt_pk_f16_f32 v118, v134, v135
    v_mfma_f32_16x16x32_bf16 v[166:169], a[120:123], v[190:193], 0
    v_mul_f32 v136, v214, v136
    v_mul_f32 v137, v214, v137
    v_mfma_f32_16x16x32_bf16 v[166:169], a[124:127], v[210:213], v[166:169]
    v_cvt_pk_f16_f32 v119, v136, v137
    v_fma_f32 v145, v122, v122, s32
    v_mfma_f32_16x16x32_bf16 v[166:169], a[128:131], v[218:221], v[166:169]
    v_rsq_f32 v254, v254
    v_mfma_f32_16x16x32_bf16 v[166:169], a[132:135], v[222:225], v[166:169]
    v_fmac_f32 v145, v123, v123
    v_fmac_f32 v145, v124, v124
    v_mfma_f32_16x16x32_bf16 v[166:169], a[136:139], v[186:189], v[166:169]
    v_fmac_f32 v145, v125, v125
    v_fmac_f32 v145, v162, v162
    v_mfma_f32_16x16x32_bf16 v[166:169], a[140:143], v[194:197], v[166:169]
    v_fmac_f32 v145, v163, v163
    v_fmac_f32 v145, v164, v164
    v_mfma_f32_16x16x32_bf16 v[134:137], a[0:3], v[190:193], 0
    v_fmac_f32 v145, v165, v165
    v_mul_f32 v178, v254, v178
    v_mfma_f32_16x16x32_bf16 v[134:137], a[4:7], v[210:213], v[134:137]
    v_rsq_f32 v255, v255
    v_mfma_f32_16x16x32_bf16 v[134:137], a[8:11], v[218:221], v[134:137]
    v_fmac_f32 v145, v166, v166
    v_fmac_f32 v145, v167, v167
    v_mfma_f32_16x16x32_bf16 v[134:137], a[12:15], v[222:225], v[134:137]
    v_fmac_f32 v145, v168, v168
    v_fmac_f32 v145, v169, v169
    v_mfma_f32_16x16x32_bf16 v[134:137], a[16:19], v[186:189], v[134:137]
    v_rsq_f32 v144, v144
    v_mfma_f32_16x16x32_bf16 v[134:137], a[20:23], v[194:197], v[134:137]
    v_mul_f32 v242, v144, v242
    v_mul_f32 v243, v144, v243
    v_mfma_f32_16x16x32_bf16 v[170:173], a[24:27], v[190:193], 0
    v_cvt_pk_bf16_f32 v138, v242, v243
    v_mul_f32 v244, v144, v244
    v_mfma_f32_16x16x32_bf16 v[170:173], a[28:31], v[210:213], v[170:173]
    v_mul_f32 v245, v144, v245
    v_cvt_pk_bf16_f32 v139, v244, v245
    v_mfma_f32_16x16x32_bf16 v[170:173], a[32:35], v[218:221], v[170:173]
    v_fma_f32 v148, v134, v134, s32
    v_fmac_f32 v148, v135, v135
    v_mfma_f32_16x16x32_bf16 v[170:173], a[36:39], v[222:225], v[170:173]
    v_fmac_f32 v148, v136, v136
    v_fmac_f32 v148, v137, v137
    v_mfma_f32_16x16x32_bf16 v[170:173], a[40:43], v[186:189], v[170:173]
    v_mul_f32 v158, v144, v158
    v_mul_f32 v159, v144, v159
    v_mfma_f32_16x16x32_bf16 v[170:173], a[44:47], v[194:197], v[170:173]
    v_cvt_pk_bf16_f32 v140, v158, v159
    v_mul_f32 v160, v144, v160
    v_mfma_f32_16x16x32_bf16 v[182:185], a[48:51], v[190:193], 0
    v_mul_f32 v161, v144, v161
    v_cvt_pk_bf16_f32 v141, v160, v161
    v_mfma_f32_16x16x32_bf16 v[182:185], a[52:55], v[210:213], v[182:185]
    buffer_store_dwordx4 v[138:141], v17, s[12:15], 0 offen nt
    v_mul_f32 v154, v144, v154
    v_fmac_f32 v148, v170, v170
    v_fmac_f32 v148, v171, v171
    v_fmac_f32 v148, v172, v172
    v_mfma_f32_16x16x32_bf16 v[182:185], a[56:59], v[218:221], v[182:185]
    v_fmac_f32 v148, v173, v173
    v_mul_f32 v155, v144, v155
    v_mfma_f32_16x16x32_bf16 v[182:185], a[60:63], v[222:225], v[182:185]
    v_cvt_pk_bf16_f32 v152, v154, v155
    v_mul_f32 v156, v144, v156
    v_mfma_f32_16x16x32_bf16 v[182:185], a[64:67], v[186:189], v[182:185]
    v_mul_f32 v157, v144, v157
    v_cvt_pk_bf16_f32 v153, v156, v157
    v_mfma_f32_16x16x32_bf16 v[182:185], a[68:71], v[194:197], v[182:185]
    v_mul_f32 v179, v254, v179
    v_cvt_pk_bf16_f32 v158, v178, v179
    v_mfma_f32_16x16x32_bf16 v[138:141], v[190:193], a[144:147], 0
    v_mul_f32 v180, v254, v180
    v_mul_f32 v181, v254, v181
    v_mfma_f32_16x16x32_bf16 v[138:141], v[210:213], a[148:151], v[138:141]
    v_cvt_pk_bf16_f32 v159, v180, v181
    v_mul_f32 v198, v254, v198
    v_mfma_f32_16x16x32_bf16 v[138:141], v[218:221], a[152:155], v[138:141]
    v_fmac_f32 v148, v182, v182
    v_fmac_f32 v148, v183, v183
    v_mfma_f32_16x16x32_bf16 v[138:141], v[222:225], a[156:159], v[138:141]
    v_fmac_f32 v148, v184, v184
    v_fmac_f32 v148, v185, v185
    v_mfma_f32_16x16x32_bf16 v[138:141], v[186:189], a[160:163], v[138:141]
    v_cvt_pk_bf16_f32 v36, v148, v145
    v_mul_f32 v199, v254, v199
    v_mfma_f32_16x16x32_bf16 v[138:141], v[194:197], a[164:167], v[138:141]
    ds_read_b128 v[214:217], v0 offset:32768
    v_cvt_pk_bf16_f32 v160, v198, v199
    v_mfma_f32_16x16x32_bf16 v[178:181], v[32:35], v[36:39], 0
    v_mul_f32 v200, v254, v200
    v_mul_f32 v201, v254, v201
    v_mfma_f32_16x16x32_bf16 v[154:157], v[190:193], a[168:171], 0
    ds_read_b128 v[226:229], v1 offset:32768
    v_cvt_pk_bf16_f32 v161, v200, v201
    v_mfma_f32_16x16x32_bf16 v[154:157], v[210:213], a[172:175], v[154:157]
    ds_read_b128 v[198:201], v0 offset:32896
    v_cvt_pk_bf16_f32 v144, v138, v139
    v_mfma_f32_16x16x32_bf16 v[154:157], v[218:221], a[176:179], v[154:157]
    v_cvt_pk_bf16_f32 v145, v140, v141
    v_mul_f32 v206, v254, v206
    v_mfma_f32_16x16x32_bf16 v[154:157], v[222:225], a[180:183], v[154:157]
    ds_read_b128 v[230:233], v1 offset:32896
    v_mul_f32 v207, v254, v207
    v_mfma_f32_16x16x32_bf16 v[154:157], v[186:189], a[184:187], v[154:157]
    v_rsq_f32 v179, v179
    v_mfma_f32_16x16x32_bf16 v[154:157], v[194:197], a[188:191], v[154:157]
    buffer_store_dwordx2 v[152:153], v20, s[12:15], 0 offen nt
    v_rsq_f32 v178, v178
    v_mul_f32 v122, v179, v122
    v_mul_f32 v178, s31, v178
    v_mul_f32 v123, v179, v123
    v_cvt_pk_f16_f32 v138, v122, v123
    v_mul_f32 v124, v179, v124
    v_mul_f32 v125, v179, v125
    v_cvt_pk_bf16_f32 v148, v154, v155
    v_mfma_f32_16x16x32_bf16 v[234:237], v[190:193], a[192:195], 0
    s_waitcnt lgkmcnt(2)
    ds_read_b128 v[190:193], v0 offset:33024
    v_cvt_pk_bf16_f32 v149, v156, v157
    v_mfma_f32_16x16x32_bf16 v[234:237], v[210:213], a[196:199], v[234:237]
    s_waitcnt lgkmcnt(2)
    ds_read_b128 v[210:213], v1 offset:33024
    v_cvt_pk_f16_f32 v139, v124, v125
    v_mfma_f32_16x16x32_bf16 v[234:237], v[218:221], a[200:203], v[234:237]
    v_mul_f32 v162, v179, v162
    v_mul_f32 v163, v179, v163
    v_mfma_f32_16x16x32_bf16 v[234:237], v[222:225], a[204:207], v[234:237]
    s_waitcnt vmcnt(2)
    v_cvt_pk_f16_f32 v140, v162, v163
    v_mul_f32 v164, v179, v164
    v_mfma_f32_16x16x32_bf16 v[234:237], v[186:189], a[208:211], v[234:237]
    s_waitcnt lgkmcnt(2)
    v_mul_f32 v165, v179, v165
    v_cvt_pk_f16_f32 v141, v164, v165
    v_mfma_f32_16x16x32_bf16 v[234:237], v[194:197], a[212:215], v[234:237]
    v_mul_f32 v166, v179, v166
    v_mul_f32 v167, v179, v167
    v_mfma_f32_16x16x32_bf16 v[186:189], a[72:75], v[214:217], 0
    v_cvt_pk_f16_f32 v124, v166, v167
    v_mul_f32 v168, v179, v168
    v_mfma_f32_16x16x32_bf16 v[186:189], a[76:79], v[226:229], v[186:189]
    v_mul_f32 v169, v179, v169
    v_cvt_pk_f16_f32 v125, v168, v169
    v_mfma_f32_16x16x32_bf16 v[186:189], a[80:83], v[198:201], v[186:189]
    s_waitcnt lgkmcnt(1)
    v_cvt_pk_bf16_f32 v152, v234, v235
    v_cvt_pk_bf16_f32 v153, v236, v237
    v_mfma_f32_16x16x32_bf16 v[186:189], a[84:87], v[230:233], v[186:189]
    s_waitcnt lgkmcnt(0)
    v_mul_f32 v134, v178, v134
    v_mul_f32 v135, v178, v135
    v_mfma_f32_16x16x32_bf16 v[186:189], a[88:91], v[190:193], v[186:189]
    s_barrier
    v_cvt_pk_f16_f32 v154, v134, v135
    v_mul_f32 v136, v178, v136
    v_mfma_f32_16x16x32_bf16 v[186:189], a[92:95], v[210:213], v[186:189]
    v_mul_f32 v137, v178, v137
    v_cvt_pk_f16_f32 v155, v136, v137
    v_mfma_f32_16x16x32_bf16 v[134:137], a[96:99], v[214:217], 0
    v_mul_f32 v170, v178, v170
    v_mul_f32 v171, v178, v171
    v_mfma_f32_16x16x32_bf16 v[134:137], a[100:103], v[226:229], v[134:137]
    v_cvt_pk_f16_f32 v156, v170, v171
    v_mul_f32 v172, v178, v172
    v_mfma_f32_16x16x32_bf16 v[134:137], a[104:107], v[198:201], v[134:137]
    buffer_load_dwordx4 v10, s[8:11], 0 offen nt lds
    v_mul_f32 v173, v178, v173
    v_mfma_f32_16x16x32_bf16 v[134:137], a[108:111], v[230:233], v[134:137]
    s_add_u32 m0, s28, 4096
    v_cvt_pk_f16_f32 v157, v172, v173
    v_mul_f32 v182, v178, v182
    v_mfma_f32_16x16x32_bf16 v[134:137], a[112:115], v[190:193], v[134:137]
    v_mul_f32 v183, v178, v183
    v_cvt_pk_f16_f32 v122, v182, v183
    v_mfma_f32_16x16x32_bf16 v[134:137], a[116:119], v[210:213], v[134:137]
    v_mul_f32 v184, v178, v184
    v_mul_f32 v185, v178, v185
    v_mfma_f32_16x16x32_bf16 v[218:221], a[120:123], v[214:217], 0
    v_cvt_pk_f16_f32 v123, v184, v185
    v_cvt_pk_bf16_f32 v170, v206, v207
    v_mfma_f32_16x16x32_bf16 v[218:221], a[124:127], v[226:229], v[218:221]
    buffer_load_dwordx4 v11, s[8:11], 0 offen nt lds
    v_mul_f32 v208, v254, v208
    v_mfma_f32_16x16x32_bf16 v[218:221], a[128:131], v[198:201], v[218:221]
    s_add_u32 m0, s28, 8192
    v_mul_f32 v209, v254, v209
    v_cvt_pk_bf16_f32 v171, v208, v209
    v_mfma_f32_16x16x32_bf16 v[218:221], a[132:135], v[230:233], v[218:221]
    v_fma_f32 v162, v186, v186, s32
    v_fmac_f32 v162, v187, v187
    v_mfma_f32_16x16x32_bf16 v[218:221], a[136:139], v[190:193], v[218:221]
    v_fmac_f32 v162, v188, v188
    v_fmac_f32 v162, v189, v189
    v_mfma_f32_16x16x32_bf16 v[218:221], a[140:143], v[210:213], v[218:221]
    v_fmac_f32 v162, v134, v134
    v_fmac_f32 v162, v135, v135
    v_mfma_f32_16x16x32_bf16 v[222:225], a[0:3], v[214:217], 0
    buffer_load_dwordx4 v12, s[8:11], 0 offen nt lds
    v_fmac_f32 v162, v136, v136
    v_mfma_f32_16x16x32_bf16 v[222:225], a[4:7], v[226:229], v[222:225]
    s_add_u32 m0, s28, 12288
    v_fmac_f32 v162, v137, v137
    v_fmac_f32 v162, v218, v218
    v_mfma_f32_16x16x32_bf16 v[222:225], a[8:11], v[198:201], v[222:225]
    s_xor_b32 s28, s28, 65536
    v_fmac_f32 v162, v219, v219
    v_fmac_f32 v162, v220, v220
    v_mfma_f32_16x16x32_bf16 v[222:225], a[12:15], v[230:233], v[222:225]
    v_fmac_f32 v162, v221, v221
    v_mul_f32 v130, v255, v130
    v_mfma_f32_16x16x32_bf16 v[222:225], a[16:19], v[190:193], v[222:225]
    v_mul_f32 v131, v255, v131
    v_cvt_pk_bf16_f32 v130, v130, v131
    v_mfma_f32_16x16x32_bf16 v[222:225], a[20:23], v[210:213], v[222:225]
    buffer_load_dwordx4 v13, s[8:11], 0 offen nt lds
    v_mul_f32 v132, v255, v132
    v_mfma_f32_16x16x32_bf16 v[238:241], a[24:27], v[214:217], 0
    s_mov_b32 m0, s29
    v_mul_f32 v133, v255, v133
    v_cvt_pk_bf16_f32 v131, v132, v133
    v_mfma_f32_16x16x32_bf16 v[238:241], a[28:31], v[226:229], v[238:241]
    s_xor_b32 s29, s29, s30
    v_fma_f32 v163, v222, v222, s32
    v_fmac_f32 v163, v223, v223
    v_mfma_f32_16x16x32_bf16 v[238:241], a[32:35], v[198:201], v[238:241]
    s_add_u32 s19, s19, s20
    v_fmac_f32 v163, v224, v224
    v_fmac_f32 v163, v225, v225
    v_mfma_f32_16x16x32_bf16 v[238:241], a[36:39], v[230:233], v[238:241]
    s_add_u32 s23, s23, s21
    v_mul_f32 v126, v255, v126
    v_mul_f32 v127, v255, v127
    v_mfma_f32_16x16x32_bf16 v[238:241], a[40:43], v[190:193], v[238:241]
    buffer_load_dwordx4 v14, s[8:11], 0 offen nt lds
    v_cvt_pk_bf16_f32 v132, v126, v127
    v_mfma_f32_16x16x32_bf16 v[238:241], a[44:47], v[210:213], v[238:241]
    s_cmp_ge_u32 s19, 72
    v_mul_f32 v128, v255, v128
    v_mul_f32 v129, v255, v129
    v_mfma_f32_16x16x32_bf16 v[178:181], a[48:51], v[214:217], 0
    s_cselect_b32 s34, 72, 0
    v_cvt_pk_bf16_f32 v133, v128, v129
    v_mul_f32 v114, v255, v114
    v_mfma_f32_16x16x32_bf16 v[178:181], a[52:55], v[226:229], v[178:181]
    s_cselect_b32 s35, s22, 0
    v_fmac_f32 v163, v238, v238
    v_fmac_f32 v163, v239, v239
    v_mfma_f32_16x16x32_bf16 v[178:181], a[56:59], v[198:201], v[178:181]
    s_sub_u32 s19, s19, s34
    v_fmac_f32 v163, v240, v240
    v_fmac_f32 v163, v241, v241
    v_mfma_f32_16x16x32_bf16 v[178:181], a[60:63], v[230:233], v[178:181]
    buffer_store_dwordx4 v[158:161], v15, s[12:15], 0 offen nt
    v_mul_f32 v115, v255, v115
    v_cvt_pk_bf16_f32 v254, v114, v115
    v_mul_f32 v116, v255, v116
    v_mul_f32 v117, v255, v117
    v_mfma_f32_16x16x32_bf16 v[178:181], a[64:67], v[190:193], v[178:181]
    s_add_u32 s23, s23, s35
    v_cvt_pk_bf16_f32 v255, v116, v117
    v_xor_b32 v0, 65536, v0
    v_mfma_f32_16x16x32_bf16 v[178:181], a[68:71], v[210:213], v[178:181]
    s_add_u32 s78, s78, s69
    v_xor_b32 v1, 65536, v1
    s_add_u32 s80, s77, s68
    v_mfma_f32_16x16x32_bf16 v[114:117], v[214:217], a[144:147], 0
    s_cmp_ge_u32 s80, 72
    s_cselect_b32 s80, s22, 0
    s_add_u32 s78, s78, s80
    v_mfma_f32_16x16x32_bf16 v[114:117], v[226:229], a[148:151], v[114:117]
    s_add_u32 s80, s77, 20
    v_fmac_f32 v163, v178, v178
    v_fmac_f32 v163, v179, v179
    v_mfma_f32_16x16x32_bf16 v[114:117], v[198:201], a[152:155], v[114:117]
    s_add_u32 s34, s18, 3
    v_fmac_f32 v163, v180, v180
    v_fmac_f32 v163, v181, v181
    v_mfma_f32_16x16x32_bf16 v[114:117], v[230:233], a[156:159], v[114:117]
    s_cmp_lt_u32 s77, s62
    ds_read2_b32 v[164:165], v6 offset0:0 offset1:0
    ds_read2_b32 v[168:169], v6 offset0:16 offset1:16
    v_mfma_f32_16x16x32_bf16 v[114:117], v[190:193], a[160:163], v[114:117]
    s_cselect_b32 s79, 1, 0
    ds_read2_b32 v[172:173], v6 offset0:32 offset1:32
    v_cvt_pk_bf16_f32 v36, v163, v162
    v_mfma_f32_16x16x32_bf16 v[114:117], v[210:213], a[164:167], v[114:117]
    s_cselect_b32 s78, s78, 0
    s_cmp_lt_u32 s34, s17
    s_cselect_b32 s23, s23, s78
    v_mfma_f32_16x16x32_bf16 v[234:237], v[32:35], v[36:39], 0
    s_cselect_b32 s73, s34, s80
    s_cselect_b32 s79, 0, s79
    s_cselect_b32 s81, 0, 1
    v_mfma_f32_16x16x32_bf16 v[126:129], v[214:217], a[168:171], 0
    s_sub_u32 s80, s100, s81
    v_cvt_pk_bf16_f32 v162, v114, v115
    v_cvt_pk_bf16_f32 v163, v116, v117
    v_mfma_f32_16x16x32_bf16 v[126:129], v[226:229], a[172:175], v[126:129]
    s_and_b32 s100, s100, s80
    v_rsq_f32 v235, v235
    v_mfma_f32_16x16x32_bf16 v[126:129], v[198:201], a[176:179], v[126:129]
    s_lshl_b32 s80, s79, s73
    v_rsq_f32 v234, v234
    v_mfma_f32_16x16x32_bf16 v[126:129], v[230:233], a[180:183], v[126:129]
    s_or_b32 s70, s70, s80
    v_mul_f32 v234, s31, v234
    v_mul_f32 v186, v235, v186
    v_mfma_f32_16x16x32_bf16 v[126:129], v[190:193], a[184:187], v[126:129]
    s_add_u32 s45, s45, s79
    v_mul_f32 v187, v235, v187
    v_cvt_pk_f16_f32 v114, v186, v187
    v_mfma_f32_16x16x32_bf16 v[126:129], v[210:213], a[188:191], v[126:129]
    s_add_u32 s18, s18, 1
    v_mul_f32 v188, v235, v188
    v_mul_f32 v189, v235, v189
    v_mfma_f32_16x16x32_bf16 v[158:161], v[214:217], a[192:195], 0
    s_cmp_lt_u32 s18, s45
    v_cvt_pk_f16_f32 v115, v188, v189
    v_mul_f32 v134, v235, v134
    v_mfma_f32_16x16x32_bf16 v[158:161], v[226:229], a[196:199], v[158:161]
    s_waitcnt lgkmcnt(0)
    buffer_store_dwordx2 v[170:171], v18, s[12:15], 0 offen nt
    v_cvt_pk_bf16_f32 v166, v126, v127
    v_cvt_pk_bf16_f32 v167, v128, v129
    v_mfma_f32_16x16x32_bf16 v[158:161], v[198:201], a[200:203], v[158:161]
    ds_read_b128 v[226:229], v5 offset:0
    ds_read_b128 v[206:209], v5 offset:16
    v_mfma_f32_16x16x32_bf16 v[158:161], v[230:233], a[204:207], v[158:161]
    ds_read_b128 v[198:201], v5 offset:48
    ds_read_b32 v236, v6 offset:192
    v_mfma_f32_16x16x32_bf16 v[158:161], v[190:193], a[208:211], v[158:161]
    v_mul_f32 v135, v235, v135
    v_cvt_pk_f16_f32 v116, v134, v135
    v_mfma_f32_16x16x32_f16 v[186:189], v[174:177], v[202:205], v[46:49]
    v_mul_f32 v136, v235, v136
    v_mul_f32 v137, v235, v137
    v_mfma_f32_16x16x32_f16 v[182:185], v[138:141], v[202:205], v[50:53]
    v_cvt_pk_f16_f32 v117, v136, v137
    v_mul_f32 v218, v235, v218
    v_mfma_f32_16x16x32_bf16 v[158:161], v[210:213], a[212:215], v[158:161]
    ds_read_b128 v[194:197], v2 offset:0
    ds_read_b128 v[190:193], v2 offset:1024
    v_mfma_f32_16x16x32_f16 v[126:129], v[114:117], v[202:205], v[54:57]
    v_mul_f32 v219, v235, v219
    v_cvt_pk_f16_f32 v136, v218, v219
    v_mul_f32 v220, v235, v220
    v_mfma_f32_16x16x16_f16 v[186:189], v[120:121], v[118:119], v[186:189]
    v_mul_f32 v221, v235, v221
    v_cvt_pk_bf16_f32 v170, v158, v159
    v_cvt_pk_bf16_f32 v171, v160, v161
    v_mfma_f32_16x16x16_f16 v[182:185], v[124:125], v[118:119], v[182:185]
    v_cvt_pk_f16_f32 v137, v220, v221
    v_mul_f32 v222, v234, v222
    v_mul_f32 v223, v234, v223
    v_mfma_f32_16x16x16_f16 v[126:129], v[136:137], v[118:119], v[126:129]
    v_cvt_pk_f16_f32 v158, v222, v223
    v_mul_f32 v224, v234, v224
    v_mul_f32 v225, v234, v225
    s_waitcnt lgkmcnt(2)
    v_mfma_f32_16x16x32_f16 v[230:233], v[226:229], v[202:205], v[22:25]
    ds_read_b128 v[210:213], v2 offset:2048
    ds_read_b128 v[202:205], v2 offset:3072
    v_mfma_f32_16x16x32_f16 v[230:233], v[206:209], v[174:177], v[230:233]
    v_cvt_pk_f16_f32 v159, v224, v225
    v_mul_f32 v238, v234, v238
    v_mfma_f32_16x16x32_f16 v[230:233], v[198:201], v[118:121], v[230:233]
    s_waitcnt lgkmcnt(2)
    ds_read_b128 v[214:217], v2 offset:4096
    v_mul_f32 v239, v234, v239
    v_cvt_pk_f16_f32 v160, v238, v239
    v_mul_f32 v240, v234, v240
    v_mul_f32 v241, v234, v241
    v_cvt_pk_f16_f32 v161, v240, v241
    v_mfma_f32_16x16x32_f16 v[218:221], v[226:229], v[154:157], v[24:27]
    v_mul_f32 v178, v234, v178
    v_mul_f32 v179, v234, v179
    v_mfma_f32_16x16x32_f16 v[218:221], v[206:209], v[138:141], v[218:221]
    v_cvt_pk_f16_f32 v134, v178, v179
    v_mul_f32 v180, v234, v180
    v_mfma_f32_16x16x32_f16 v[218:221], v[198:201], v[122:125], v[218:221]
    buffer_store_dwordx4 v[130:133], v16, s[12:15], 0 offen nt
    ds_read_b128 v[222:225], v2 offset:5120
    v_mul_f32 v181, v234, v181
    v_cvt_pk_f16_f32 v135, v180, v181
    v_mov_b32_dpp v236, v231 quad_perm:[0,1,2,3] row_mask:0x1 bank_mask:0xf
    v_mfma_f32_16x16x32_f16 v[238:241], v[226:229], v[158:161], v[26:29]
    s_waitcnt lgkmcnt(2)
    v_max3_f32 v118, v230, v186, v187
    v_mov_b32_dpp v236, v219 quad_perm:[0,1,2,3] row_mask:0x2 bank_mask:0xf
    v_mfma_f32_16x16x32_f16 v[238:241], v[206:209], v[114:117], v[238:241]
    v_max3_f32 v118, v118, v188, v189
    v_max3_f32 v118, v118, v182, v183
    v_mfma_f32_16x16x32_f16 v[238:241], v[198:201], v[134:137], v[238:241]
    s_waitcnt lgkmcnt(1)
    v_max3_f32 v118, v118, v184, v185
    v_max3_f32 v118, v118, v126, v127
    v_mfma_f32_16x16x32_bf16 v[178:181], a[216:219], v[194:197], 0
    v_max3_f32 v118, v118, v128, v129
    v_mov_b32 v119, v118
    v_mfma_f32_16x16x32_bf16 v[178:181], a[220:223], v[190:193], v[178:181]
    v_add_u32 v5, s74, v5
    v_mov_b32_dpp v236, v239 quad_perm:[0,1,2,3] row_mask:0x4 bank_mask:0xf
    v_mfma_f32_16x16x32_bf16 v[178:181], a[224:227], v[210:213], v[178:181]
    v_permlane32_swap_b32 v118, v119
    v_mfma_f32_16x16x32_bf16 v[178:181], a[228:231], v[202:205], v[178:181]
    s_waitcnt lgkmcnt(0)
    v_max_f32 v118, v118, v119
    v_mov_b32 v119, v118
    v_mfma_f32_16x16x32_bf16 v[178:181], a[232:235], v[214:217], v[178:181]
    v_mov_b32 v219, v236
    v_add_u32 v6, s75, v6
    v_mfma_f32_16x16x32_bf16 v[178:181], a[236:239], v[222:225], v[178:181]
    v_permlane16_swap_b32 v118, v119
    v_mfma_f32_16x16x32_bf16 v[198:201], a[240:243], v[194:197], 0
    v_max_f32 v118, v118, v119
    v_sub_f32 v186, v186, v118
    v_mfma_f32_16x16x32_bf16 v[198:201], a[244:247], v[190:193], v[198:201]
    v_exp_f32 v186, v186
    v_mfma_f32_16x16x32_bf16 v[198:201], a[248:251], v[210:213], v[198:201]
    v_sub_f32 v187, v187, v118
    v_sub_f32 v188, v188, v118
    v_mfma_f32_16x16x32_bf16 v[198:201], a[252:255], v[202:205], v[198:201]
    v_exp_f32 v187, v187
    v_mfma_f32_16x16x32_bf16 v[198:201], v[82:85], v[214:217], v[198:201]
    v_cvt_pk_bf16_f32 v186, v186, v187
    v_sub_f32 v189, v189, v118
    v_mfma_f32_16x16x32_bf16 v[198:201], v[86:89], v[222:225], v[198:201]
    v_exp_f32 v188, v188
    v_mfma_f32_16x16x32_bf16 v[206:209], v[90:93], v[194:197], 0
    ds_read_b128 v[194:197], v2 offset:6144
    buffer_store_dwordx2 v[254:255], v19, s[12:15], 0 offen nt
    v_exp_f32 v189, v189
    v_mfma_f32_16x16x32_bf16 v[206:209], v[94:97], v[190:193], v[206:209]
    ds_read_b128 v[190:193], v2 offset:7168
    v_cvt_pk_bf16_f32 v187, v188, v189
    v_mfma_f32_16x16x32_bf16 v[206:209], v[98:101], v[210:213], v[206:209]
    ds_read_b128 v[210:213], v2 offset:8192
    v_sub_f32 v182, v182, v118
    v_mfma_f32_16x16x32_bf16 v[206:209], v[102:105], v[202:205], v[206:209]
    ds_read_b128 v[202:205], v2 offset:9216
    v_sub_f32 v183, v183, v118
    v_mfma_f32_16x16x32_bf16 v[206:209], v[106:109], v[214:217], v[206:209]
    ds_read_b128 v[214:217], v2 offset:10240
    v_sub_f32 v184, v184, v118
    v_mfma_f32_16x16x32_bf16 v[206:209], v[110:113], v[222:225], v[206:209]
    ds_read_b128 v[222:225], v2 offset:11264
    v_exp_f32 v182, v182
    v_mfma_f32_16x16x32_f16 v[226:229], v[174:177], v[154:157], v[58:61]
    v_exp_f32 v183, v183
    s_waitcnt lgkmcnt(5)
    v_mfma_f32_16x16x32_bf16 v[130:133], a[216:219], v[194:197], 0
    v_cvt_pk_bf16_f32 v188, v182, v183
    v_exp_f32 v184, v184
    s_waitcnt lgkmcnt(4)
    v_mfma_f32_16x16x16_f16 v[226:229], v[120:121], v[122:123], v[226:229]
    v_sub_f32 v185, v185, v118
    v_exp_f32 v185, v185
    v_sub_f32 v126, v126, v118
    v_mfma_f32_16x16x32_bf16 v[130:133], a[220:223], v[190:193], v[130:133]
    s_waitcnt lgkmcnt(2)
    v_cvt_pk_bf16_f32 v189, v184, v185
    v_sub_f32 v127, v127, v118
    v_mfma_f32_16x16x32_bf16 v[130:133], a[224:227], v[210:213], v[130:133]
    s_waitcnt lgkmcnt(1)
    v_exp_f32 v126, v126
    v_mfma_f32_16x16x32_bf16 v[130:133], a[228:231], v[202:205], v[130:133]
    s_waitcnt lgkmcnt(0)
    v_exp_f32 v127, v127
    v_mfma_f32_16x16x32_bf16 v[130:133], a[232:235], v[214:217], v[130:133]
    v_cvt_pk_bf16_f32 v36, v126, v127
    v_sub_f32 v128, v128, v118
    v_mfma_f32_16x16x32_f16 v[182:185], v[138:141], v[154:157], v[62:65]
    v_exp_f32 v128, v128
    v_mfma_f32_16x16x32_bf16 v[130:133], a[236:239], v[222:225], v[130:133]
    v_sub_f32 v129, v129, v118
    v_exp_f32 v129, v129
    v_sub_f32 v230, v230, v118
    v_cvt_pk_bf16_f32 v37, v128, v129
    v_mfma_f32_16x16x16_f16 v[182:185], v[124:125], v[122:123], v[182:185]
    v_exp_f32 v230, v230
    v_max_f32_dpp v219, v219, v219 quad_perm:[1,0,3,2] row_mask:0xf bank_mask:0xf
    v_cvt_pk_bf16_f32 v39, v230, 0
    v_mfma_f32_16x16x32_f16 v[230:233], v[114:117], v[154:157], v[66:69]
    v_max_f32_dpp v219, v219, v219 quad_perm:[2,3,0,1] row_mask:0xf bank_mask:0xf
    v_max3_f32 v254, v218, v226, v227
    v_max3_f32 v254, v254, v228, v229
    v_max_f32_dpp v219, v219, v219 row_half_mirror row_mask:0xf bank_mask:0xf
    v_max3_f32 v254, v254, v182, v183
    v_max3_f32 v254, v254, v184, v185
    v_mfma_f32_16x16x16_f16 v[230:233], v[136:137], v[122:123], v[230:233]
    v_max_f32_dpp v219, v219, v219 row_mirror row_mask:0xf bank_mask:0xf
    v_mov_b32 v255, v219
    v_fma_f32 v118, v178, v178, s33
    v_fmac_f32 v118, v179, v179
    v_permlane32_swap_b32 v219, v255
    v_max_f32 v219, v219, v255
    v_mfma_f32_16x16x32_bf16 v[154:157], v[28:31], v[36:39], 0
    v_mov_b32 v255, v219
    v_max3_f32 v254, v254, v230, v231
    v_mfma_f32_16x16x32_bf16 v[154:157], v[28:31], v[186:189], v[154:157]
    v_permlane16_swap_b32 v219, v255
    v_max_f32 v219, v219, v255
    v_sub_f32 v236, v236, v219
    v_mfma_f32_16x16x32_bf16 v[126:129], v[162:165], v[36:39], 0
    v_exp_f32 v236, v236
    v_mfma_f32_16x16x32_bf16 v[126:129], v[142:145], v[186:189], v[126:129]
    v_cvt_pk_bf16_f32 v236, v236, v236
    v_max3_f32 v254, v254, v232, v233
    v_rcp_f32 v154, v154
    v_mov_b32 v119, v254
    v_fmac_f32 v118, v180, v180
    v_fmac_f32 v118, v181, v181
    v_permlane32_swap_b32 v254, v119
    v_max_f32 v254, v254, v119
    v_mul_f32 v126, v154, v126
    v_mul_f32 v127, v154, v127
    v_cvt_pk_bf16_f32 v126, v126, v127
    v_mul_f32 v128, v154, v128
    v_mul_f32 v129, v154, v129
    v_cvt_pk_bf16_f32 v127, v128, v129
    v_mov_b32 v119, v254
    v_fmac_f32 v118, v198, v198
    v_fmac_f32 v118, v199, v199
    v_permlane16_swap_b32 v254, v119
    v_max_f32 v254, v254, v119
    v_sub_f32 v226, v226, v254
    v_exp_f32 v226, v226
    v_sub_f32 v227, v227, v254
    v_exp_f32 v227, v227
    v_sub_f32 v228, v228, v254
    v_cvt_pk_bf16_f32 v226, v226, v227
    v_exp_f32 v228, v228
    v_sub_f32 v229, v229, v254
    v_exp_f32 v229, v229
    v_sub_f32 v182, v182, v254
    v_cvt_pk_bf16_f32 v227, v228, v229
    v_mfma_f32_16x16x32_bf16 v[242:245], v[166:169], v[36:39], 0
    ds_write_b16 v8, v236
    v_mfma_f32_16x16x32_bf16 v[242:245], v[146:149], v[186:189], v[242:245]
    v_exp_f32 v182, v182
    v_sub_f32 v183, v183, v254
    v_exp_f32 v183, v183
    v_sub_f32 v184, v184, v254
    v_cvt_pk_bf16_f32 v228, v182, v183
    v_exp_f32 v184, v184
    v_sub_f32 v185, v185, v254
    v_exp_f32 v185, v185
    v_mul_f32 v242, v154, v242
    v_mul_f32 v243, v154, v243
    v_cvt_pk_bf16_f32 v128, v242, v243
    v_mul_f32 v244, v154, v244
    v_mul_f32 v245, v154, v245
    v_cvt_pk_bf16_f32 v129, v244, v245
    v_mfma_f32_16x16x32_bf16 v[234:237], v[170:173], v[36:39], 0
    ds_write_b128 v3, v[126:129] offset:0
    v_mfma_f32_16x16x32_bf16 v[234:237], v[150:153], v[186:189], v[234:237]
    v_cvt_pk_bf16_f32 v229, v184, v185
    v_sub_f32 v230, v230, v254
    v_mfma_f32_16x16x32_f16 v[182:185], v[174:177], v[158:161], v[70:73]
    v_exp_f32 v230, v230
    v_mfma_f32_16x16x32_bf16 v[126:129], a[240:243], v[194:197], 0
    ds_read_b128 v[174:177], v9
    v_sub_f32 v231, v231, v254
    v_mfma_f32_16x16x32_bf16 v[126:129], a[244:247], v[190:193], v[126:129]
    v_mul_f32 v234, v154, v234
    v_mul_f32 v235, v154, v235
    v_cvt_pk_bf16_f32 v122, v234, v235
    v_mfma_f32_16x16x16_f16 v[182:185], v[120:121], v[134:135], v[182:185]
    v_mul_f32 v236, v154, v236
    v_mul_f32 v237, v154, v237
    v_cvt_pk_bf16_f32 v123, v236, v237
    v_sub_f32 v232, v232, v254
    v_mfma_f32_16x16x32_bf16 v[126:129], a[248:251], v[210:213], v[126:129]
    ds_read_b128 v[154:157], v9 offset:64
    v_sub_f32 v233, v233, v254
    v_mfma_f32_16x16x32_bf16 v[126:129], a[252:255], v[202:205], v[126:129]
    ds_write_b64 v4, v[122:123] offset:4096
    v_mfma_f32_16x16x32_bf16 v[126:129], v[82:85], v[214:217], v[126:129]
    v_max3_f32 v255, v238, v182, v183
    v_max3_f32 v255, v255, v184, v185
    v_mfma_f32_16x16x32_bf16 v[126:129], v[86:89], v[222:225], v[126:129]
    v_exp_f32 v231, v231
    v_exp_f32 v232, v232
    v_cvt_pk_bf16_f32 v36, v230, v231
    v_mfma_f32_16x16x32_f16 v[186:189], v[138:141], v[158:161], v[74:77]
    s_waitcnt lgkmcnt(2)
    v_exp_f32 v233, v233
    v_mfma_f32_16x16x32_f16 v[138:141], v[114:117], v[158:161], v[78:81]
    v_cvt_pk_bf16_f32 v37, v232, v233
    v_sub_f32 v218, v218, v254
    v_mfma_f32_16x16x32_bf16 v[234:237], v[174:177], v[28:31], 0
    v_exp_f32 v218, v218
    v_fmac_f32 v118, v200, v200
    v_mfma_f32_16x16x16_f16 v[186:189], v[124:125], v[134:135], v[186:189]
    v_cvt_pk_bf16_f32 v39, v218, 0
    v_fmac_f32 v118, v201, v201
    v_fmac_f32 v118, v206, v206
    v_mfma_f32_16x16x16_f16 v[138:141], v[136:137], v[134:135], v[138:141]
    v_fmac_f32 v118, v207, v207
    v_fmac_f32 v118, v208, v208
    v_fmac_f32 v118, v209, v209
    v_fma_f32 v254, v130, v130, s33
    v_mfma_f32_16x16x32_bf16 v[122:125], v[28:31], v[36:39], 0
    s_waitcnt lgkmcnt(0)
    v_max3_f32 v255, v255, v186, v187
    v_max3_f32 v255, v255, v188, v189
    v_mfma_f32_16x16x32_bf16 v[122:125], v[28:31], v[226:229], v[122:125]
    v_max3_f32 v255, v255, v138, v139
    v_max3_f32 v255, v255, v140, v141
    v_mfma_f32_16x16x32_bf16 v[114:117], v[162:165], v[36:39], 0
    v_mov_b32 v119, v255
    v_fmac_f32 v254, v131, v131
    v_mfma_f32_16x16x32_bf16 v[114:117], v[142:145], v[226:229], v[114:117]
    v_permlane32_swap_b32 v255, v119
    v_mfma_f32_16x16x32_bf16 v[134:137], v[166:169], v[36:39], 0
    v_rcp_f32 v122, v122
    v_mfma_f32_16x16x32_bf16 v[134:137], v[146:149], v[226:229], v[134:137]
    v_max_f32 v255, v255, v119
    v_mov_b32 v119, v255
    v_mfma_f32_16x16x32_bf16 v[158:161], v[170:173], v[36:39], 0
    v_fmac_f32 v254, v132, v132
    v_mul_f32 v114, v122, v114
    v_mfma_f32_16x16x32_bf16 v[158:161], v[150:153], v[226:229], v[158:161]
    v_mul_f32 v115, v122, v115
    v_cvt_pk_bf16_f32 v114, v114, v115
    v_mfma_f32_16x16x32_bf16 v[234:237], v[154:157], v[28:31], v[234:237]
    v_mul_f32 v116, v122, v116
    v_mul_f32 v117, v122, v117
    v_mfma_f32_16x16x32_bf16 v[218:221], v[174:177], v[142:145], 0
    v_cvt_pk_bf16_f32 v115, v116, v117
    v_mul_f32 v134, v122, v134
    v_mfma_f32_16x16x32_bf16 v[218:221], v[154:157], v[162:165], v[218:221]
    v_mul_f32 v135, v122, v135
    v_cvt_pk_bf16_f32 v116, v134, v135
    v_mfma_f32_16x16x32_bf16 v[226:229], v[174:177], v[146:149], 0
    v_mul_f32 v136, v122, v136
    v_mul_f32 v137, v122, v137
    v_mfma_f32_16x16x32_bf16 v[226:229], v[154:157], v[166:169], v[226:229]
    v_cvt_pk_bf16_f32 v117, v136, v137
    v_mul_f32 v158, v122, v158
    v_mfma_f32_16x16x32_bf16 v[134:137], v[174:177], v[150:153], 0
    ds_write_b128 v3, v[114:117] offset:6144
    v_mfma_f32_16x16x32_bf16 v[134:137], v[154:157], v[170:173], v[134:137]
    v_mul_f32 v159, v122, v159
    v_cvt_pk_bf16_f32 v120, v158, v159
    v_mfma_f32_16x16x32_bf16 v[114:117], v[90:93], v[194:197], 0
    v_mul_f32 v160, v122, v160
    v_mul_f32 v161, v122, v161
    v_mfma_f32_16x16x32_bf16 v[114:117], v[94:97], v[190:193], v[114:117]
    ds_read_b128 v[122:125], v2 offset:12288
    ds_read_b128 v[174:177], v2 offset:13312
    v_mfma_f32_16x16x32_bf16 v[114:117], v[98:101], v[210:213], v[114:117]
    ds_read_b128 v[190:193], v2 offset:14336
    v_cvt_pk_bf16_f32 v121, v160, v161
    v_mfma_f32_16x16x32_bf16 v[114:117], v[102:105], v[202:205], v[114:117]
    ds_read_b128 v[194:197], v2 offset:15360
    v_fmac_f32 v254, v133, v133
    v_mfma_f32_16x16x32_bf16 v[114:117], v[106:109], v[214:217], v[114:117]
    ds_read_b128 v[202:205], v2 offset:16384
    v_fmac_f32 v254, v126, v126
    v_mfma_f32_16x16x32_bf16 v[114:117], v[110:113], v[222:225], v[114:117]
    ds_read_b128 v[210:213], v2 offset:17408
    ds_write_b64 v4, v[120:121] offset:10240
    v_permlane16_swap_b32 v255, v119
    v_max_f32 v255, v255, v119
    v_sub_f32 v182, v182, v255
    v_exp_f32 v182, v182
    v_sub_f32 v183, v183, v255
    v_exp_f32 v183, v183
    s_waitcnt lgkmcnt(5)
    v_mfma_f32_16x16x32_bf16 v[242:245], a[216:219], v[122:125], 0
    v_cvt_pk_bf16_f32 v182, v182, v183
    v_sub_f32 v184, v184, v255
    v_mfma_f32_16x16x32_bf16 v[242:245], a[220:223], v[174:177], v[242:245]
    s_waitcnt lgkmcnt(4)
    v_exp_f32 v184, v184
    v_mfma_f32_16x16x32_bf16 v[242:245], a[224:227], v[190:193], v[242:245]
    s_waitcnt lgkmcnt(3)
    v_sub_f32 v185, v185, v255
    v_sub_f32 v186, v186, v255
    v_mfma_f32_16x16x32_bf16 v[242:245], a[228:231], v[194:197], v[242:245]
    s_waitcnt lgkmcnt(2)
    v_exp_f32 v185, v185
    v_mfma_f32_16x16x32_bf16 v[242:245], a[232:235], v[202:205], v[242:245]
    s_waitcnt lgkmcnt(0)
    v_cvt_pk_bf16_f32 v183, v184, v185
    v_sub_f32 v187, v187, v255
    v_mfma_f32_16x16x32_bf16 v[242:245], a[236:239], v[210:213], v[242:245]
    v_exp_f32 v186, v186
    v_mfma_f32_16x16x32_bf16 v[158:161], a[240:243], v[122:125], 0
    v_exp_f32 v187, v187
    v_mfma_f32_16x16x32_bf16 v[158:161], a[244:247], v[174:177], v[158:161]
    v_cvt_pk_bf16_f32 v184, v186, v187
    v_sub_f32 v188, v188, v255
    v_mfma_f32_16x16x32_bf16 v[158:161], a[248:251], v[190:193], v[158:161]
    v_exp_f32 v188, v188
    v_mfma_f32_16x16x32_bf16 v[158:161], a[252:255], v[194:197], v[158:161]
    v_sub_f32 v189, v189, v255
    v_sub_f32 v138, v138, v255
    v_mfma_f32_16x16x32_bf16 v[158:161], v[82:85], v[202:205], v[158:161]
    v_exp_f32 v189, v189
    v_mfma_f32_16x16x32_bf16 v[158:161], v[86:89], v[210:213], v[158:161]
    v_cvt_pk_bf16_f32 v185, v188, v189
    v_sub_f32 v139, v139, v255
    v_mfma_f32_16x16x32_bf16 v[154:157], v[90:93], v[122:125], 0
    v_exp_f32 v138, v138
    v_mfma_f32_16x16x32_bf16 v[154:157], v[94:97], v[174:177], v[154:157]
    v_exp_f32 v139, v139
    v_mfma_f32_16x16x32_bf16 v[154:157], v[98:101], v[190:193], v[154:157]
    v_cvt_pk_bf16_f32 v36, v138, v139
    v_sub_f32 v140, v140, v255
    v_mfma_f32_16x16x32_bf16 v[154:157], v[102:105], v[194:197], v[154:157]
    v_exp_f32 v140, v140
    v_mfma_f32_16x16x32_bf16 v[154:157], v[106:109], v[202:205], v[154:157]
    v_sub_f32 v141, v141, v255
    v_sub_f32 v238, v238, v255
    v_mfma_f32_16x16x32_bf16 v[154:157], v[110:113], v[210:213], v[154:157]
    ds_read_b128 v[186:189], v0 offset:20480
    ds_read_b128 v[194:197], v1 offset:20480
    ds_read_b128 v[122:125], v0 offset:20608
    v_exp_f32 v141, v141
    v_exp_f32 v238, v238
    v_cvt_pk_bf16_f32 v37, v140, v141
    v_cvt_pk_bf16_f32 v39, v238, 0
    v_fma_f32 v255, v242, v242, s33
    v_fmac_f32 v255, v243, v243
    v_mfma_f32_16x16x32_bf16 v[138:141], v[28:31], v[36:39], 0
    ds_read_b128 v[202:205], v1 offset:20608
    ds_read_b128 v[230:233], v0 offset:20736
    v_mfma_f32_16x16x32_bf16 v[138:141], v[28:31], v[182:185], v[138:141]
    ds_read_b128 v[238:241], v1 offset:20736
    v_fmac_f32 v255, v244, v244
    v_mfma_f32_16x16x32_bf16 v[174:177], v[162:165], v[36:39], 0
    v_fmac_f32 v255, v245, v245
    v_fmac_f32 v255, v158, v158
    v_mfma_f32_16x16x32_bf16 v[174:177], v[142:145], v[182:185], v[174:177]
    v_fmac_f32 v255, v159, v159
    v_fmac_f32 v255, v160, v160
    v_mfma_f32_16x16x32_bf16 v[142:145], v[166:169], v[36:39], 0
    s_waitcnt lgkmcnt(5)
    v_rcp_f32 v138, v138
    v_mfma_f32_16x16x32_bf16 v[142:145], v[146:149], v[182:185], v[142:145]
    s_waitcnt lgkmcnt(3)
    v_fmac_f32 v255, v161, v161
    v_mul_f32 v174, v138, v174
    v_mfma_f32_16x16x32_bf16 v[146:149], v[170:173], v[36:39], 0
    v_mul_f32 v175, v138, v175
    v_cvt_pk_bf16_f32 v162, v174, v175
    v_mfma_f32_16x16x32_bf16 v[146:149], v[150:153], v[182:185], v[146:149]
    v_mul_f32 v176, v138, v176
    v_mul_f32 v177, v138, v177
    v_mfma_f32_16x16x32_bf16 v[150:153], a[72:75], v[186:189], 0
    s_waitcnt lgkmcnt(1)
    v_cvt_pk_bf16_f32 v163, v176, v177
    v_mul_f32 v142, v138, v142
    v_mfma_f32_16x16x32_bf16 v[150:153], a[76:79], v[194:197], v[150:153]
    s_waitcnt lgkmcnt(0)
    v_mul_f32 v143, v138, v143
    v_cvt_pk_bf16_f32 v164, v142, v143
    v_mfma_f32_16x16x32_bf16 v[150:153], a[80:83], v[122:125], v[150:153]
    v_mul_f32 v144, v138, v144
    v_mul_f32 v145, v138, v145
    v_mfma_f32_16x16x32_bf16 v[150:153], a[84:87], v[202:205], v[150:153]
    v_cvt_pk_bf16_f32 v165, v144, v145
    v_mul_f32 v146, v138, v146
    v_mfma_f32_16x16x32_bf16 v[150:153], a[88:91], v[230:233], v[150:153]
    ds_write_b128 v3, v[162:165] offset:12288
    v_mfma_f32_16x16x32_bf16 v[150:153], a[92:95], v[238:241], v[150:153]
    v_mul_f32 v147, v138, v147
    v_cvt_pk_bf16_f32 v146, v146, v147
    v_mfma_f32_16x16x32_bf16 v[162:165], a[96:99], v[186:189], 0
    v_mul_f32 v148, v138, v148
    v_mul_f32 v149, v138, v149
    v_mfma_f32_16x16x32_bf16 v[162:165], a[100:103], v[194:197], v[162:165]
    v_cvt_pk_bf16_f32 v147, v148, v149
    v_fmac_f32 v255, v154, v154
    v_mfma_f32_16x16x32_bf16 v[162:165], a[104:107], v[122:125], v[162:165]
    ds_write_b64 v4, v[146:147] offset:16384
    v_mfma_f32_16x16x32_bf16 v[162:165], a[108:111], v[202:205], v[162:165]
    v_fmac_f32 v255, v155, v155
    v_fmac_f32 v255, v156, v156
    v_mfma_f32_16x16x32_bf16 v[162:165], a[112:115], v[230:233], v[162:165]
    v_fmac_f32 v255, v157, v157
    v_cvt_pk_bf16_f32 v255, v255, v255
    v_mfma_f32_16x16x32_bf16 v[162:165], a[116:119], v[238:241], v[162:165]
    v_rcp_f32 v234, v234
    v_mfma_f32_16x16x32_bf16 v[170:173], a[120:123], v[186:189], 0
    v_mul_f32 v218, v218, v234
    v_fmac_f32 v254, v127, v127
    v_mfma_f32_16x16x32_bf16 v[170:173], a[124:127], v[194:197], v[170:173]
    v_mul_f32_dpp v218, v226, v234 quad_perm:[0,1,2,3] row_mask:0x2 bank_mask:0xf
    v_fmac_f32 v254, v128, v128
    v_mfma_f32_16x16x32_bf16 v[170:173], a[128:131], v[122:125], v[170:173]
    v_mul_f32_dpp v218, v134, v234 quad_perm:[0,1,2,3] row_mask:0x4 bank_mask:0xf
    v_cvt_pk_bf16_f32 v218, v218, v218
    v_mfma_f32_16x16x32_bf16 v[170:173], a[132:135], v[202:205], v[170:173]
    ds_write_b16 v7, v218
    v_mfma_f32_16x16x32_bf16 v[170:173], a[136:139], v[230:233], v[170:173]
    v_fmac_f32 v254, v129, v129
    v_fmac_f32 v254, v114, v114
    v_mfma_f32_16x16x32_bf16 v[170:173], a[140:143], v[238:241], v[170:173]
    v_fmac_f32 v254, v115, v115
    v_fmac_f32 v254, v116, v116
    v_mfma_f32_16x16x32_bf16 v[138:141], a[0:3], v[186:189], 0
    v_fmac_f32 v254, v117, v117
    v_cvt_pk_bf16_f32 v254, v118, v254
    v_mfma_f32_16x16x32_bf16 v[138:141], a[4:7], v[194:197], v[138:141]
    ds_write_b64 v4, v[254:255] offset:18432
    v_mfma_f32_16x16x32_bf16 v[138:141], a[8:11], v[122:125], v[138:141]
    v_fma_f32 v174, v150, v150, s32
    v_fmac_f32 v174, v151, v151
    v_mfma_f32_16x16x32_bf16 v[138:141], a[12:15], v[202:205], v[138:141]
    v_fmac_f32 v174, v152, v152
    v_fmac_f32 v174, v153, v153
    v_mfma_f32_16x16x32_bf16 v[138:141], a[16:19], v[230:233], v[138:141]
    v_xor_b32 v2, 65536, v2
    v_xor_b32 v3, 65536, v3
    v_mfma_f32_16x16x32_bf16 v[138:141], a[20:23], v[238:241], v[138:141]
    v_xor_b32 v4, 65536, v4
    v_add_u32 v7, s76, v7
    v_mfma_f32_16x16x32_bf16 v[166:169], a[24:27], v[186:189], 0
    v_mfma_f32_16x16x32_bf16 v[166:169], a[28:31], v[194:197], v[166:169]
    v_mfma_f32_16x16x32_bf16 v[166:169], a[32:35], v[122:125], v[166:169]
    s_waitcnt lgkmcnt(0)
    v_mfma_f32_16x16x32_bf16 v[166:169], a[36:39], v[202:205], v[166:169]
    s_barrier
    v_mfma_f32_16x16x32_bf16 v[166:169], a[40:43], v[230:233], v[166:169]
    v_mfma_f32_16x16x32_bf16 v[166:169], a[44:47], v[238:241], v[166:169]
    v_mfma_f32_16x16x32_bf16 v[134:137], a[48:51], v[186:189], 0
    v_mfma_f32_16x16x32_bf16 v[134:137], a[52:55], v[194:197], v[134:137]
    s_cbranch_scc1 L_LOOP
    v_mfma_f32_16x16x32_bf16 v[134:137], a[56:59], v[122:125], v[134:137]
    s_mov_b32 s12, s40
    ds_read_b128 v[118:121], v2 offset:18432
    ds_read_b128 v[142:145], v2 offset:19456
    v_mfma_f32_16x16x32_bf16 v[134:137], a[60:63], v[202:205], v[134:137]
    s_mov_b32 s13, s41
    v_fmac_f32 v174, v162, v162
    v_fmac_f32 v174, v163, v163
    v_mfma_f32_16x16x32_bf16 v[134:137], a[64:67], v[230:233], v[134:137]
    s_mov_b32 s14, s36
    v_fmac_f32 v174, v164, v164
    v_fmac_f32 v174, v165, v165
    v_mfma_f32_16x16x32_bf16 v[134:137], a[68:71], v[238:241], v[134:137]
    s_add_u32 s48, s40, s27
    v_fmac_f32 v174, v170, v170
    v_fmac_f32 v174, v171, v171
    v_mfma_f32_16x16x32_bf16 v[146:149], v[186:189], a[144:147], 0
    s_addc_u32 s49, s41, 0
    v_fmac_f32 v174, v172, v172
    v_fmac_f32 v174, v173, v173
    v_mfma_f32_16x16x32_bf16 v[146:149], v[194:197], a[148:151], v[146:149]
    s_sub_u32 s50, s36, s27
    v_fma_f32 v254, v138, v138, s32
    v_fmac_f32 v254, v139, v139
    v_mfma_f32_16x16x32_bf16 v[146:149], v[122:125], a[152:155], v[146:149]
    s_mov_b32 s51, 0x00020000
    v_fmac_f32 v254, v140, v140
    v_fmac_f32 v254, v141, v141
    v_mfma_f32_16x16x32_bf16 v[146:149], v[202:205], a[156:159], v[146:149]
    s_add_u32 s52, s40, s26
    v_fmac_f32 v254, v166, v166
    v_fmac_f32 v254, v167, v167
    v_mfma_f32_16x16x32_bf16 v[146:149], v[230:233], a[160:163], v[146:149]
    s_waitcnt lgkmcnt(0)
    v_fmac_f32 v254, v168, v168
    v_fmac_f32 v254, v169, v169
    v_mfma_f32_16x16x32_bf16 v[182:185], v[32:35], v[118:121], 0
    s_addc_u32 s53, s41, 0
    v_fmac_f32 v254, v134, v134
    v_fmac_f32 v254, v135, v135
    v_mfma_f32_16x16x32_bf16 v[182:185], v[32:35], v[142:145], v[182:185]
    s_sub_u32 s54, s36, s26
    v_fmac_f32 v254, v136, v136
    v_fmac_f32 v254, v137, v137
    v_mfma_f32_16x16x32_bf16 v[146:149], v[238:241], a[164:167], v[146:149]
    s_mov_b32 s55, 0x00020000
    v_cvt_pk_bf16_f32 v36, v254, v174
    v_bfe_u32 v254, v2, 4, 6
    v_mfma_f32_16x16x32_bf16 v[118:121], v[186:189], a[168:171], 0
    s_add_u32 s56, s40, s25
    v_mul_f32 v255, 0x3baaaaab, v183
    v_mul_f32 v182, 0x3baaaaab, v182
    v_mfma_f32_16x16x32_bf16 v[142:145], v[32:35], v[36:39], 0
    s_addc_u32 s57, s41, 0
    v_rsq_f32 v255, v255
    v_mfma_f32_16x16x32_bf16 v[118:121], v[194:197], a[172:175], v[118:121]
    s_sub_u32 s58, s36, s25
    v_mul_f32 v130, v255, v130
    v_mul_f32 v131, v255, v131
    v_mfma_f32_16x16x32_bf16 v[118:121], v[122:125], a[176:179], v[118:121]
    s_mov_b32 s59, 0x00020000
    v_cvt_pk_bf16_f32 v130, v130, v131
    v_mul_f32 v132, v255, v132
    v_mfma_f32_16x16x32_bf16 v[118:121], v[202:205], a[180:183], v[118:121]
    s_and_b32 s6, s2, 7
    v_mul_f32 v133, v255, v133
    v_cvt_pk_bf16_f32 v131, v132, v133
    v_mfma_f32_16x16x32_bf16 v[118:121], v[230:233], a[184:187], v[118:121]
    s_sub_u32 s6, 0, s6
    ds_read_b128 v[174:177], v0 offset:26624
    v_mul_f32 v126, v255, v126
    v_mfma_f32_16x16x32_bf16 v[118:121], v[238:241], a[188:191], v[118:121]
    s_lshl_b32 s3, s16, 6
    ds_read_b128 v[190:193], v1 offset:26624
    v_mul_f32 v127, v255, v127
    v_mfma_f32_16x16x32_bf16 v[210:213], v[186:189], a[192:195], 0
    s_lshl_b32 s4, s16, 5
    ds_read_b128 v[186:189], v0 offset:26752
    v_cvt_pk_bf16_f32 v132, v126, v127
    v_mfma_f32_16x16x32_bf16 v[210:213], v[194:197], a[196:199], v[210:213]
    s_add_u32 s4, s4, 256
    ds_read_b128 v[194:197], v1 offset:26752
    v_mul_f32 v128, v255, v128
    v_mfma_f32_16x16x32_bf16 v[210:213], v[122:125], a[200:203], v[210:213]
    s_mul_i32 s5, s16, 9408
    ds_read_b128 v[122:125], v0 offset:26880
    v_mul_f32 v129, v255, v129
    v_mfma_f32_16x16x32_bf16 v[210:213], v[202:205], a[204:207], v[210:213]
    s_add_u32 s5, s5, 104448
    ds_read_b128 v[202:205], v1 offset:26880
    v_cvt_pk_bf16_f32 v133, v128, v129
    v_mfma_f32_16x16x32_bf16 v[210:213], v[230:233], a[208:211], v[210:213]
    buffer_store_dwordx4 v[130:133], v16, s[48:51], 0 offen nt
    v_mul_f32 v114, v255, v114
    v_mul_f32 v115, v255, v115
    v_cvt_pk_bf16_f32 v144, v114, v115
    v_mul_f32 v116, v255, v116
    v_mfma_f32_16x16x32_bf16 v[210:213], v[238:241], a[212:215], v[210:213]
    s_waitcnt lgkmcnt(5)
    ds_read_b128 v[126:129], v2 offset:0
    ds_read_b128 v[130:133], v2 offset:1024
    v_mfma_f32_16x16x32_bf16 v[214:217], a[72:75], v[174:177], 0
    s_waitcnt lgkmcnt(6)
    ds_read_b128 v[218:221], v2 offset:2048
    ds_read_b128 v[222:225], v2 offset:3072
    v_mfma_f32_16x16x32_bf16 v[214:217], a[76:79], v[190:193], v[214:217]
    s_waitcnt lgkmcnt(7)
    v_mul_f32 v117, v255, v117
    v_cvt_pk_bf16_f32 v145, v116, v117
    v_mfma_f32_16x16x32_bf16 v[214:217], a[80:83], v[186:189], v[214:217]
    s_waitcnt lgkmcnt(6)
    ds_read_b128 v[114:117], v2 offset:4096
    ds_read_b128 v[226:229], v2 offset:5120
    v_mfma_f32_16x16x32_bf16 v[214:217], a[84:87], v[194:197], v[214:217]
    s_waitcnt lgkmcnt(7)
    v_rsq_f32 v182, v182
    v_mfma_f32_16x16x32_bf16 v[214:217], a[88:91], v[122:125], v[214:217]
    s_waitcnt lgkmcnt(6)
    v_mul_f32 v178, v182, v178
    v_mul_f32 v179, v182, v179
    v_mfma_f32_16x16x32_bf16 v[214:217], a[92:95], v[202:205], v[214:217]
    v_cvt_pk_bf16_f32 v178, v178, v179
    v_mul_f32 v180, v182, v180
    v_mfma_f32_16x16x32_bf16 v[230:233], a[96:99], v[174:177], 0
    v_mul_f32 v181, v182, v181
    v_cvt_pk_bf16_f32 v179, v180, v181
    v_mfma_f32_16x16x32_bf16 v[230:233], a[100:103], v[190:193], v[230:233]
    s_waitcnt lgkmcnt(4)
    v_mul_f32 v198, v182, v198
    v_mul_f32 v199, v182, v199
    v_mfma_f32_16x16x32_bf16 v[230:233], a[104:107], v[186:189], v[230:233]
    s_waitcnt lgkmcnt(2)
    v_cvt_pk_bf16_f32 v180, v198, v199
    v_mul_f32 v200, v182, v200
    v_mfma_f32_16x16x32_bf16 v[230:233], a[108:111], v[194:197], v[230:233]
    v_mul_f32 v201, v182, v201
    v_cvt_pk_bf16_f32 v181, v200, v201
    v_mfma_f32_16x16x32_bf16 v[198:201], a[216:219], v[126:129], 0
    s_waitcnt lgkmcnt(0)
    v_mul_f32 v206, v182, v206
    v_mul_f32 v207, v182, v207
    v_mfma_f32_16x16x32_bf16 v[198:201], a[220:223], v[130:133], v[198:201]
    v_cvt_pk_bf16_f32 v206, v206, v207
    v_mul_f32 v208, v182, v208
    v_mfma_f32_16x16x32_bf16 v[198:201], a[224:227], v[218:221], v[198:201]
    v_mul_f32 v209, v182, v209
    v_cvt_pk_bf16_f32 v207, v208, v209
    v_mfma_f32_16x16x32_bf16 v[198:201], a[228:231], v[222:225], v[198:201]
    v_rsq_f32 v143, v143
    v_mfma_f32_16x16x32_bf16 v[198:201], a[232:235], v[114:117], v[198:201]
    buffer_store_dwordx2 v[144:145], v19, s[48:51], 0 offen nt
    v_rsq_f32 v142, v142
    v_mfma_f32_16x16x32_bf16 v[198:201], a[236:239], v[226:229], v[198:201]
    v_mul_f32 v142, s31, v142
    v_cvt_pk_bf16_f32 v146, v146, v147
    v_mfma_f32_16x16x32_bf16 v[234:237], a[240:243], v[126:129], 0
    v_cvt_pk_bf16_f32 v147, v148, v149
    v_cvt_pk_bf16_f32 v118, v118, v119
    v_mfma_f32_16x16x32_bf16 v[234:237], a[244:247], v[130:133], v[234:237]
    v_cvt_pk_bf16_f32 v119, v120, v121
    v_cvt_pk_bf16_f32 v182, v210, v211
    v_mfma_f32_16x16x32_bf16 v[234:237], a[248:251], v[218:221], v[234:237]
    v_fma_f32 v255, v198, v198, s33
    v_fmac_f32 v255, v199, v199
    v_mfma_f32_16x16x32_bf16 v[234:237], a[252:255], v[222:225], v[234:237]
    v_fmac_f32 v255, v200, v200
    v_fmac_f32 v255, v201, v201
    v_mfma_f32_16x16x32_bf16 v[234:237], v[82:85], v[114:117], v[234:237]
    v_cvt_pk_bf16_f32 v183, v212, v213
    v_mul_f32 v150, v143, v150
    v_mfma_f32_16x16x32_bf16 v[234:237], v[86:89], v[226:229], v[234:237]
    v_mul_f32 v151, v143, v151
    v_cvt_pk_f16_f32 v150, v150, v151
    v_mfma_f32_16x16x32_bf16 v[210:213], v[90:93], v[126:129], 0
    v_mul_f32 v152, v143, v152
    v_mul_f32 v153, v143, v153
    v_mfma_f32_16x16x32_bf16 v[210:213], v[94:97], v[130:133], v[210:213]
    v_cvt_pk_f16_f32 v151, v152, v153
    v_mul_f32 v162, v143, v162
    v_mfma_f32_16x16x32_bf16 v[210:213], v[98:101], v[218:221], v[210:213]
    v_fmac_f32 v255, v234, v234
    v_fmac_f32 v255, v235, v235
    v_mfma_f32_16x16x32_bf16 v[210:213], v[102:105], v[222:225], v[210:213]
    v_fmac_f32 v255, v236, v236
    v_fmac_f32 v255, v237, v237
    v_mfma_f32_16x16x32_bf16 v[210:213], v[106:109], v[114:117], v[210:213]
    v_mul_f32 v163, v143, v163
    v_cvt_pk_f16_f32 v152, v162, v163
    v_mfma_f32_16x16x32_bf16 v[210:213], v[110:113], v[226:229], v[210:213]
    v_mul_f32 v164, v143, v164
    v_mul_f32 v165, v143, v165
    v_mfma_f32_16x16x32_bf16 v[230:233], a[112:115], v[122:125], v[230:233]
    v_cvt_pk_f16_f32 v153, v164, v165
    v_mul_f32 v170, v143, v170
    v_mfma_f32_16x16x32_bf16 v[230:233], a[116:119], v[202:205], v[230:233]
    ds_read_b128 v[114:117], v2 offset:6144
    ds_read_b128 v[126:129], v2 offset:7168
    v_mfma_f32_16x16x32_bf16 v[130:133], a[120:123], v[174:177], 0
    ds_read_b128 v[162:165], v2 offset:8192
    ds_read_b128 v[218:221], v2 offset:9216
    v_mfma_f32_16x16x32_bf16 v[130:133], a[124:127], v[190:193], v[130:133]
    buffer_store_dwordx4 v[178:181], v15, s[48:51], 0 offen nt
    ds_read_b128 v[222:225], v2 offset:10240
    v_fmac_f32 v255, v210, v210
    v_fmac_f32 v255, v211, v211
    v_fmac_f32 v255, v212, v212
    v_mfma_f32_16x16x32_bf16 v[130:133], a[128:131], v[186:189], v[130:133]
    ds_read_b128 v[178:181], v2 offset:11264
    v_fmac_f32 v255, v213, v213
    v_mfma_f32_16x16x32_bf16 v[130:133], a[132:135], v[194:197], v[130:133]
    v_mul_f32 v171, v143, v171
    v_cvt_pk_f16_f32 v228, v170, v171
    v_mfma_f32_16x16x32_bf16 v[130:133], a[136:139], v[122:125], v[130:133]
    v_mul_f32 v172, v143, v172
    v_mul_f32 v173, v143, v173
    v_mfma_f32_16x16x32_bf16 v[130:133], a[140:143], v[202:205], v[130:133]
    v_cvt_pk_f16_f32 v229, v172, v173
    v_mul_f32 v138, v142, v138
    v_mfma_f32_16x16x32_bf16 v[170:173], a[0:3], v[174:177], 0
    s_waitcnt lgkmcnt(4)
    v_mul_f32 v139, v142, v139
    v_cvt_pk_f16_f32 v138, v138, v139
    v_mfma_f32_16x16x32_bf16 v[238:241], a[216:219], v[114:117], 0
    s_waitcnt lgkmcnt(2)
    v_mul_f32 v140, v142, v140
    v_mul_f32 v141, v142, v141
    v_mfma_f32_16x16x32_bf16 v[238:241], a[220:223], v[126:129], v[238:241]
    s_waitcnt lgkmcnt(1)
    v_cvt_pk_f16_f32 v139, v140, v141
    v_mul_f32 v166, v142, v166
    v_mfma_f32_16x16x32_bf16 v[238:241], a[224:227], v[162:165], v[238:241]
    v_mul_f32 v167, v142, v167
    v_cvt_pk_f16_f32 v140, v166, v167
    v_mfma_f32_16x16x32_bf16 v[238:241], a[228:231], v[218:221], v[238:241]
    s_waitcnt lgkmcnt(0)
    v_mul_f32 v168, v142, v168
    v_mul_f32 v169, v142, v169
    v_mfma_f32_16x16x32_bf16 v[238:241], a[232:235], v[222:225], v[238:241]
    v_cvt_pk_f16_f32 v141, v168, v169
    v_mul_f32 v134, v142, v134
    v_mfma_f32_16x16x32_bf16 v[238:241], a[236:239], v[178:181], v[238:241]
    v_mul_f32 v135, v142, v135
    v_cvt_pk_f16_f32 v226, v134, v135
    v_mfma_f32_16x16x32_bf16 v[166:169], a[240:243], v[114:117], 0
    v_mul_f32 v136, v142, v136
    v_mul_f32 v137, v142, v137
    v_mfma_f32_16x16x32_bf16 v[166:169], a[244:247], v[126:129], v[166:169]
    v_cvt_pk_f16_f32 v227, v136, v137
    v_fma_f32 v185, v214, v214, s32
    v_mfma_f32_16x16x32_bf16 v[166:169], a[248:251], v[162:165], v[166:169]
    v_fma_f32 v120, v238, v238, s33
    v_fmac_f32 v120, v239, v239
    v_mfma_f32_16x16x32_bf16 v[166:169], a[252:255], v[218:221], v[166:169]
    v_fmac_f32 v120, v240, v240
    v_fmac_f32 v120, v241, v241
    v_mfma_f32_16x16x32_bf16 v[166:169], v[82:85], v[222:225], v[166:169]
    buffer_store_dwordx2 v[206:207], v18, s[48:51], 0 offen nt
    v_fmac_f32 v185, v215, v215
    v_fmac_f32 v185, v216, v216
    v_mfma_f32_16x16x32_bf16 v[166:169], v[86:89], v[178:181], v[166:169]
    v_fmac_f32 v185, v217, v217
    v_fmac_f32 v185, v230, v230
    v_mfma_f32_16x16x32_bf16 v[134:137], v[90:93], v[114:117], 0
    v_fmac_f32 v185, v231, v231
    v_fmac_f32 v185, v232, v232
    v_mfma_f32_16x16x32_bf16 v[134:137], v[94:97], v[126:129], v[134:137]
    v_fmac_f32 v185, v233, v233
    v_fmac_f32 v185, v130, v130
    v_mfma_f32_16x16x32_bf16 v[134:137], v[98:101], v[162:165], v[134:137]
    v_fmac_f32 v120, v166, v166
    v_fmac_f32 v120, v167, v167
    v_mfma_f32_16x16x32_bf16 v[134:137], v[102:105], v[218:221], v[134:137]
    v_fmac_f32 v120, v168, v168
    v_fmac_f32 v120, v169, v169
    v_mfma_f32_16x16x32_bf16 v[134:137], v[106:109], v[222:225], v[134:137]
    v_fmac_f32 v185, v131, v131
    v_fmac_f32 v185, v132, v132
    v_mfma_f32_16x16x32_bf16 v[134:137], v[110:113], v[178:181], v[134:137]
    v_fmac_f32 v185, v133, v133
    v_mul_f32 v184, 0x3baaaaab, v184
    v_mfma_f32_16x16x32_bf16 v[170:173], a[4:7], v[190:193], v[170:173]
    v_rsq_f32 v184, v184
    v_mfma_f32_16x16x32_bf16 v[170:173], a[8:11], v[186:189], v[170:173]
    v_mul_f32 v242, v184, v242
    v_mul_f32 v243, v184, v243
    v_mfma_f32_16x16x32_bf16 v[170:173], a[12:15], v[194:197], v[170:173]
    v_fmac_f32 v120, v134, v134
    v_fmac_f32 v120, v135, v135
    v_mfma_f32_16x16x32_bf16 v[170:173], a[16:19], v[122:125], v[170:173]
    v_fmac_f32 v120, v136, v136
    v_fmac_f32 v120, v137, v137
    v_mfma_f32_16x16x32_bf16 v[170:173], a[20:23], v[202:205], v[170:173]
    v_cvt_pk_bf16_f32 v148, v255, v120
    v_cvt_pk_bf16_f32 v149, v120, v120
    v_mfma_f32_16x16x32_bf16 v[114:117], a[24:27], v[174:177], 0
    v_cvt_pk_bf16_f32 v126, v242, v243
    v_mul_f32 v244, v184, v244
    v_mfma_f32_16x16x32_bf16 v[114:117], a[28:31], v[190:193], v[114:117]
    v_mul_f32 v245, v184, v245
    v_cvt_pk_bf16_f32 v127, v244, v245
    v_mfma_f32_16x16x32_bf16 v[114:117], a[32:35], v[186:189], v[114:117]
    v_fma_f32 v255, v170, v170, s32
    v_fmac_f32 v255, v171, v171
    v_mfma_f32_16x16x32_bf16 v[114:117], a[36:39], v[194:197], v[114:117]
    v_fmac_f32 v255, v172, v172
    v_fmac_f32 v255, v173, v173
    v_mfma_f32_16x16x32_bf16 v[114:117], a[40:43], v[122:125], v[114:117]
    v_mul_f32 v158, v184, v158
    v_mul_f32 v159, v184, v159
    v_mfma_f32_16x16x32_bf16 v[114:117], a[44:47], v[202:205], v[114:117]
    v_cvt_pk_bf16_f32 v128, v158, v159
    v_mul_f32 v160, v184, v160
    v_mfma_f32_16x16x32_bf16 v[142:145], a[48:51], v[174:177], 0
    v_mul_f32 v161, v184, v161
    v_cvt_pk_bf16_f32 v129, v160, v161
    v_mfma_f32_16x16x32_bf16 v[142:145], a[52:55], v[190:193], v[142:145]
    buffer_store_dwordx4 v[126:129], v17, s[48:51], 0 offen nt
    v_mul_f32 v154, v184, v154
    v_fmac_f32 v255, v114, v114
    v_fmac_f32 v255, v115, v115
    v_fmac_f32 v255, v116, v116
    v_mfma_f32_16x16x32_bf16 v[142:145], a[56:59], v[186:189], v[142:145]
    v_fmac_f32 v255, v117, v117
    v_mul_f32 v155, v184, v155
    v_mfma_f32_16x16x32_bf16 v[142:145], a[60:63], v[194:197], v[142:145]
    v_cvt_pk_bf16_f32 v120, v154, v155
    v_mul_f32 v156, v184, v156
    v_mfma_f32_16x16x32_bf16 v[142:145], a[64:67], v[122:125], v[142:145]
    v_mul_f32 v157, v184, v157
    v_cvt_pk_bf16_f32 v121, v156, v157
    v_mfma_f32_16x16x32_bf16 v[142:145], a[68:71], v[202:205], v[142:145]
    v_lshrrev_b32 v126, 4, v254
    v_and_b32 v127, 15, v254
    v_mfma_f32_16x16x32_bf16 v[154:157], v[174:177], a[144:147], 0
    v_lshlrev_b32 v128, 9, v126
    v_lshl_add_u32 v128, v127, 4, v128
    v_mfma_f32_16x16x32_bf16 v[154:157], v[190:193], a[148:151], v[154:157]
    v_add_u32 v128, 149696, v128
    v_and_b32 v129, 0xffff, v2
    v_mfma_f32_16x16x32_bf16 v[154:157], v[186:189], a[152:155], v[154:157]
    v_fmac_f32 v255, v142, v142
    v_fmac_f32 v255, v143, v143
    v_mfma_f32_16x16x32_bf16 v[154:157], v[194:197], a[156:159], v[154:157]
    v_fmac_f32 v255, v144, v144
    v_fmac_f32 v255, v145, v145
    v_mfma_f32_16x16x32_bf16 v[154:157], v[122:125], a[160:163], v[154:157]
    v_cvt_pk_bf16_f32 v36, v255, v185
    v_add_u32 v129, 38912, v129
    v_mfma_f32_16x16x32_bf16 v[154:157], v[202:205], a[164:167], v[154:157]
    v_and_b32 v255, 0xffff, v4
    v_add_u32 v255, 38912, v255
    v_mfma_f32_16x16x32_bf16 v[158:161], v[32:35], v[36:39], 0
    ds_write_b64 v255, v[148:149] offset:0
    v_mfma_f32_16x16x32_bf16 v[162:165], v[174:177], a[168:171], 0
    v_mov_b32 v178, 0x40000000
    v_add_u32 v179, 0, v127
    v_mfma_f32_16x16x32_bf16 v[162:165], v[190:193], a[172:175], v[162:165]
    v_cvt_pk_bf16_f32 v148, v154, v155
    v_cvt_pk_bf16_f32 v149, v156, v157
    v_mfma_f32_16x16x32_bf16 v[162:165], v[186:189], a[176:179], v[162:165]
    v_rsq_f32 v159, v159
    v_mfma_f32_16x16x32_bf16 v[162:165], v[194:197], a[180:183], v[162:165]
    buffer_store_dwordx2 v[120:121], v20, s[48:51], 0 offen nt
    v_rsq_f32 v158, v158
    v_mfma_f32_16x16x32_bf16 v[162:165], v[122:125], a[184:187], v[162:165]
    ds_read_b128 v[154:157], v0 offset:32768
    v_mul_f32 v158, s31, v158
    v_mfma_f32_16x16x32_bf16 v[162:165], v[202:205], a[188:191], v[162:165]
    ds_read_b128 v[206:209], v1 offset:32768
    v_mul_f32 v214, v159, v214
    v_mfma_f32_16x16x32_bf16 v[218:221], v[174:177], a[192:195], 0
    s_waitcnt lgkmcnt(2)
    ds_read_b128 v[174:177], v0 offset:32896
    v_mul_f32 v215, v159, v215
    v_mfma_f32_16x16x32_bf16 v[218:221], v[190:193], a[196:199], v[218:221]
    s_barrier
    ds_read_b128 v[190:193], v129 offset:0
    ds_read_b128 v[222:225], v129 offset:1024
    v_mfma_f32_16x16x32_bf16 v[218:221], v[186:189], a[200:203], v[218:221]
    ds_read_b128 v[186:189], v1 offset:32896
    v_cvt_pk_bf16_f32 v120, v162, v163
    v_mfma_f32_16x16x32_bf16 v[218:221], v[194:197], a[204:207], v[218:221]
    ds_read_b128 v[194:197], v0 offset:33024
    v_cvt_pk_bf16_f32 v121, v164, v165
    v_mfma_f32_16x16x32_bf16 v[218:221], v[122:125], a[208:211], v[218:221]
    ds_read_b128 v[122:125], v1 offset:33024
    v_cvt_pk_f16_f32 v162, v214, v215
    v_mfma_f32_16x16x32_bf16 v[218:221], v[202:205], a[212:215], v[218:221]
    v_mul_f32 v216, v159, v216
    v_mul_f32 v217, v159, v217
    v_mfma_f32_16x16x32_f16 v[202:205], v[150:153], v[138:141], v[46:49]
    s_waitcnt lgkmcnt(7)
    v_cvt_pk_f16_f32 v163, v216, v217
    v_mul_f32 v230, v159, v230
    v_mfma_f32_16x16x32_bf16 v[214:217], a[72:75], v[154:157], 0
    s_waitcnt lgkmcnt(6)
    v_cvt_pk_bf16_f32 v184, v218, v219
    v_cvt_pk_bf16_f32 v185, v220, v221
    v_mfma_f32_16x16x32_bf16 v[214:217], a[76:79], v[206:209], v[214:217]
    s_waitcnt lgkmcnt(5)
    v_mul_f32 v231, v159, v231
    v_cvt_pk_f16_f32 v164, v230, v231
    v_mfma_f32_16x16x32_bf16 v[214:217], a[80:83], v[174:177], v[214:217]
    s_waitcnt lgkmcnt(3)
    v_mul_f32 v232, v159, v232
    v_mul_f32 v233, v159, v233
    v_mfma_f32_16x16x32_bf16 v[218:221], v[32:35], v[190:193], 0
    s_waitcnt lgkmcnt(2)
    v_cvt_pk_f16_f32 v165, v232, v233
    v_mul_f32 v130, v159, v130
    v_mfma_f32_16x16x32_bf16 v[218:221], v[32:35], v[222:225], v[218:221]
    s_waitcnt lgkmcnt(1)
    v_mul_f32 v131, v159, v131
    v_cvt_pk_f16_f32 v192, v130, v131
    v_mfma_f32_16x16x32_bf16 v[214:217], a[84:87], v[186:189], v[214:217]
    s_waitcnt lgkmcnt(0)
    v_mul_f32 v132, v159, v132
    v_mul_f32 v133, v159, v133
    v_mfma_f32_16x16x32_bf16 v[214:217], a[88:91], v[194:197], v[214:217]
    v_mul_f32 v180, 0x3baaaaab, v219
    v_cvt_pk_f16_f32 v193, v132, v133
    v_mfma_f32_16x16x32_bf16 v[214:217], a[92:95], v[122:125], v[214:217]
    v_rsq_f32 v180, v180
    v_mfma_f32_16x16x32_bf16 v[130:133], a[96:99], v[154:157], 0
    v_mul_f32 v238, v180, v238
    v_mul_f32 v239, v180, v239
    v_mfma_f32_16x16x32_bf16 v[130:133], a[100:103], v[206:209], v[130:133]
    v_cvt_pk_bf16_f32 v222, v238, v239
    v_mul_f32 v240, v180, v240
    v_mfma_f32_16x16x32_bf16 v[130:133], a[104:107], v[174:177], v[130:133]
    v_mul_f32 v241, v180, v241
    v_cvt_pk_bf16_f32 v223, v240, v241
    v_mfma_f32_16x16x32_bf16 v[130:133], a[108:111], v[186:189], v[130:133]
    v_mul_f32 v166, v180, v166
    v_mul_f32 v167, v180, v167
    v_mfma_f32_16x16x32_bf16 v[130:133], a[112:115], v[194:197], v[130:133]
    v_cvt_pk_bf16_f32 v224, v166, v167
    v_mul_f32 v168, v180, v168
    v_mfma_f32_16x16x32_bf16 v[130:133], a[116:119], v[122:125], v[130:133]
    v_mul_f32 v169, v180, v169
    v_cvt_pk_bf16_f32 v225, v168, v169
    v_mfma_f32_16x16x32_bf16 v[166:169], a[120:123], v[154:157], 0
    buffer_store_dwordx4 v[222:225], v16, s[52:55], 0 offen nt
    v_mul_f32 v134, v180, v134
    v_mul_f32 v135, v180, v135
    v_cvt_pk_bf16_f32 v220, v134, v135
    v_mul_f32 v136, v180, v136
    v_mfma_f32_16x16x32_bf16 v[166:169], a[124:127], v[206:209], v[166:169]
    v_mul_f32 v137, v180, v137
    v_cvt_pk_bf16_f32 v221, v136, v137
    v_mfma_f32_16x16x32_bf16 v[166:169], a[128:131], v[174:177], v[166:169]
    v_mul_f32 v170, v158, v170
    v_mul_f32 v171, v158, v171
    v_mfma_f32_16x16x32_bf16 v[166:169], a[132:135], v[186:189], v[166:169]
    v_cvt_pk_f16_f32 v134, v170, v171
    v_mul_f32 v172, v158, v172
    v_mfma_f32_16x16x32_bf16 v[166:169], a[136:139], v[194:197], v[166:169]
    v_mul_f32 v173, v158, v173
    v_cvt_pk_f16_f32 v135, v172, v173
    v_mfma_f32_16x16x32_bf16 v[166:169], a[140:143], v[122:125], v[166:169]
    v_mul_f32 v114, v158, v114
    v_mul_f32 v115, v158, v115
    v_mfma_f32_16x16x32_bf16 v[170:173], a[0:3], v[154:157], 0
    v_cvt_pk_f16_f32 v136, v114, v115
    v_mul_f32 v116, v158, v116
    v_mfma_f32_16x16x32_bf16 v[170:173], a[4:7], v[206:209], v[170:173]
    v_mul_f32 v117, v158, v117
    v_cvt_pk_f16_f32 v137, v116, v117
    v_mfma_f32_16x16x32_bf16 v[170:173], a[8:11], v[174:177], v[170:173]
    v_mul_f32 v142, v158, v142
    v_mul_f32 v143, v158, v143
    v_mfma_f32_16x16x32_bf16 v[170:173], a[12:15], v[186:189], v[170:173]
    v_cvt_pk_f16_f32 v190, v142, v143
    v_mul_f32 v144, v158, v144
    v_mfma_f32_16x16x32_bf16 v[170:173], a[16:19], v[194:197], v[170:173]
    v_mul_f32 v145, v158, v145
    v_cvt_pk_f16_f32 v191, v144, v145
    v_mfma_f32_16x16x32_bf16 v[170:173], a[20:23], v[122:125], v[170:173]
    v_mul_f32 v180, 0x3baaaaab, v218
    v_fma_f32 v181, v214, v214, s32
    v_mfma_f32_16x16x32_bf16 v[114:117], a[24:27], v[154:157], 0
    v_rsq_f32 v180, v180
    v_mfma_f32_16x16x32_f16 v[142:145], v[162:165], v[138:141], v[50:53]
    v_mul_f32 v198, v180, v198
    v_mul_f32 v199, v180, v199
    v_cvt_pk_bf16_f32 v158, v198, v199
    v_mfma_f32_16x16x16_f16 v[202:205], v[228:229], v[226:227], v[202:205]
    v_mul_f32 v200, v180, v200
    v_mul_f32 v201, v180, v201
    v_cvt_pk_bf16_f32 v159, v200, v201
    v_mfma_f32_16x16x16_f16 v[142:145], v[192:193], v[226:227], v[142:145]
    v_mul_f32 v234, v180, v234
    v_mul_f32 v235, v180, v235
    v_cvt_pk_bf16_f32 v160, v234, v235
    v_mul_f32 v236, v180, v236
    v_mfma_f32_16x16x32_bf16 v[114:117], a[28:31], v[206:209], v[114:117]
    buffer_store_dwordx2 v[220:221], v19, s[52:55], 0 offen nt
    v_mul_f32 v237, v180, v237
    v_cvt_pk_bf16_f32 v161, v236, v237
    v_mfma_f32_16x16x32_bf16 v[114:117], a[32:35], v[174:177], v[114:117]
    v_mul_f32 v210, v180, v210
    v_mul_f32 v211, v180, v211
    v_mfma_f32_16x16x32_bf16 v[114:117], a[36:39], v[186:189], v[114:117]
    v_cvt_pk_bf16_f32 v210, v210, v211
    v_mul_f32 v212, v180, v212
    v_mfma_f32_16x16x32_bf16 v[114:117], a[40:43], v[194:197], v[114:117]
    v_mul_f32 v213, v180, v213
    v_cvt_pk_bf16_f32 v211, v212, v213
    v_mfma_f32_16x16x32_bf16 v[114:117], a[44:47], v[122:125], v[114:117]
    v_fma_f32 v180, v170, v170, s32
    v_fmac_f32 v180, v171, v171
    v_mfma_f32_16x16x32_bf16 v[198:201], a[48:51], v[154:157], 0
    v_fmac_f32 v180, v172, v172
    v_fmac_f32 v180, v173, v173
    v_mfma_f32_16x16x32_bf16 v[198:201], a[52:55], v[206:209], v[198:201]
    v_fmac_f32 v181, v215, v215
    v_fmac_f32 v181, v216, v216
    v_mfma_f32_16x16x32_bf16 v[198:201], a[56:59], v[174:177], v[198:201]
    v_fmac_f32 v180, v114, v114
    v_fmac_f32 v180, v115, v115
    v_mfma_f32_16x16x32_bf16 v[198:201], a[60:63], v[186:189], v[198:201]
    v_fmac_f32 v180, v116, v116
    v_fmac_f32 v180, v117, v117
    v_mfma_f32_16x16x32_bf16 v[198:201], a[64:67], v[194:197], v[198:201]
    v_fmac_f32 v181, v217, v217
    v_fmac_f32 v181, v130, v130
    v_mfma_f32_16x16x32_bf16 v[198:201], a[68:71], v[122:125], v[198:201]
    ds_read2_b32 v[220:221], v6 offset0:0 offset1:0
    ds_read2_b32 v[224:225], v6 offset0:16 offset1:16
    v_mfma_f32_16x16x32_bf16 v[230:233], v[154:157], a[144:147], 0
    ds_read2_b32 v[212:213], v6 offset0:32 offset1:32
    v_fmac_f32 v181, v131, v131
    v_mfma_f32_16x16x32_bf16 v[230:233], v[206:209], a[148:151], v[230:233]
    v_fmac_f32 v181, v132, v132
    v_fmac_f32 v181, v133, v133
    v_mfma_f32_16x16x32_bf16 v[230:233], v[174:177], a[152:155], v[230:233]
    v_fmac_f32 v180, v198, v198
    v_fmac_f32 v180, v199, v199
    v_mfma_f32_16x16x32_bf16 v[230:233], v[186:189], a[156:159], v[230:233]
    v_fmac_f32 v180, v200, v200
    v_fmac_f32 v180, v201, v201
    v_mfma_f32_16x16x32_bf16 v[230:233], v[194:197], a[160:163], v[230:233]
    v_fmac_f32 v181, v166, v166
    v_fmac_f32 v181, v167, v167
    v_mfma_f32_16x16x32_bf16 v[230:233], v[122:125], a[164:167], v[230:233]
    buffer_store_dwordx4 v[158:161], v15, s[52:55], 0 offen nt
    v_fmac_f32 v181, v168, v168
    v_fmac_f32 v181, v169, v169
    v_cvt_pk_bf16_f32 v36, v180, v181
    v_mul_u32_u24 v222, s20, v179
    v_mfma_f32_16x16x32_bf16 v[158:161], v[154:157], a[168:171], 0
    s_waitcnt lgkmcnt(1)
    v_add_u32 v222, s38, v222
    v_cvt_pk_bf16_f32 v218, v230, v231
    v_mfma_f32_16x16x32_bf16 v[234:237], v[32:35], v[36:39], 0
    s_waitcnt lgkmcnt(0)
    v_cvt_pk_bf16_f32 v219, v232, v233
    v_mul_u32_u24 v180, 911, v222
    v_mfma_f32_16x16x32_bf16 v[158:161], v[206:209], a[172:175], v[158:161]
    v_lshrrev_b32 v180, 16, v180
    v_mul_u32_u24 v180, s22, v180
    v_mfma_f32_16x16x32_bf16 v[158:161], v[174:177], a[176:179], v[158:161]
    v_mad_u32_u24 v180, v179, s21, v180
    v_bfe_u32 v222, s70, v179, 1
    v_mfma_f32_16x16x32_bf16 v[158:161], v[186:189], a[180:183], v[158:161]
    ds_read_b128 v[230:233], v2 offset:12288
    v_cmp_ne_u32 vcc, 0, v222
    v_mfma_f32_16x16x32_bf16 v[158:161], v[194:197], a[184:187], v[158:161]
    v_rsq_f32 v235, v235
    v_mfma_f32_16x16x32_bf16 v[158:161], v[122:125], a[188:191], v[158:161]
    v_rsq_f32 v234, v234
    v_mul_f32 v214, v235, v214
    v_mul_f32 v234, s31, v234
    v_mul_f32 v215, v235, v215
    v_cvt_pk_f16_f32 v214, v214, v215
    v_mfma_f32_16x16x32_bf16 v[238:241], v[154:157], a[192:195], 0
    ds_read_b128 v[154:157], v2 offset:13312
    ds_read_b32 v179, v6 offset:192
    v_mfma_f32_16x16x32_bf16 v[238:241], v[206:209], a[196:199], v[238:241]
    v_cvt_pk_bf16_f32 v222, v158, v159
    v_cvt_pk_bf16_f32 v223, v160, v161
    v_mfma_f32_16x16x32_bf16 v[238:241], v[174:177], a[200:203], v[238:241]
    ds_read_b128 v[158:161], v2 offset:14336
    ds_read_b128 v[174:177], v2 offset:15360
    v_mfma_f32_16x16x32_bf16 v[238:241], v[186:189], a[204:207], v[238:241]
    ds_read_b128 v[186:189], v2 offset:16384
    v_mul_f32 v216, v235, v216
    v_mfma_f32_16x16x32_bf16 v[238:241], v[194:197], a[208:211], v[238:241]
    s_waitcnt lgkmcnt(5)
    ds_read_b128 v[194:197], v2 offset:17408
    v_mul_f32 v217, v235, v217
    v_mfma_f32_16x16x32_bf16 v[238:241], v[122:125], a[212:215], v[238:241]
    ds_read_b128 v[122:125], v5 offset:0
    v_cvt_pk_f16_f32 v215, v216, v217
    v_mul_f32 v130, v235, v130
    buffer_store_dwordx2 v[210:211], v18, s[52:55], 0 offen nt
    ds_read_b128 v[206:209], v5 offset:16
    v_mul_f32 v131, v235, v131
    v_cvt_pk_f16_f32 v216, v130, v131
    v_mul_f32 v132, v235, v132
    v_cvt_pk_bf16_f32 v210, v238, v239
    v_cvt_pk_bf16_f32 v211, v240, v241
    v_mul_f32 v133, v235, v133
    v_cvt_pk_f16_f32 v217, v132, v133
    v_mfma_f32_16x16x32_bf16 v[130:133], a[216:219], v[230:233], 0
    s_waitcnt lgkmcnt(6)
    v_mul_f32 v166, v235, v166
    v_mul_f32 v167, v235, v167
    v_mfma_f32_16x16x32_bf16 v[130:133], a[220:223], v[154:157], v[130:133]
    s_waitcnt lgkmcnt(4)
    v_cvt_pk_f16_f32 v240, v166, v167
    v_mul_f32 v168, v235, v168
    v_mfma_f32_16x16x32_bf16 v[130:133], a[224:227], v[158:161], v[130:133]
    s_waitcnt lgkmcnt(3)
    v_mul_f32 v169, v235, v169
    v_cvt_pk_f16_f32 v241, v168, v169
    v_mfma_f32_16x16x32_bf16 v[130:133], a[228:231], v[174:177], v[130:133]
    s_waitcnt lgkmcnt(2)
    v_mul_f32 v170, v234, v170
    v_mul_f32 v171, v234, v171
    v_mfma_f32_16x16x32_bf16 v[130:133], a[232:235], v[186:189], v[130:133]
    s_waitcnt lgkmcnt(1)
    v_cvt_pk_f16_f32 v166, v170, v171
    v_mul_f32 v172, v234, v172
    v_mfma_f32_16x16x32_f16 v[242:245], v[122:125], v[134:137], v[24:27]
    s_waitcnt lgkmcnt(0)
    v_mul_f32 v173, v234, v173
    v_cvt_pk_f16_f32 v167, v172, v173
    v_mfma_f32_16x16x32_f16 v[242:245], v[206:209], v[162:165], v[242:245]
    v_mul_f32 v114, v234, v114
    v_mul_f32 v115, v234, v115
    v_mfma_f32_16x16x32_bf16 v[130:133], a[236:239], v[194:197], v[130:133]
    v_cvt_pk_f16_f32 v168, v114, v115
    v_mul_f32 v116, v234, v116
    v_mul_f32 v117, v234, v117
    v_cvt_pk_f16_f32 v169, v116, v117
    v_mul_f32 v198, v234, v198
    v_mul_f32 v199, v234, v199
    v_cvt_pk_f16_f32 v238, v198, v199
    v_mfma_f32_16x16x32_f16 v[114:117], v[122:125], v[166:169], v[26:29]
    v_mul_f32 v200, v234, v200
    v_mul_f32 v201, v234, v201
    v_mfma_f32_16x16x32_f16 v[114:117], v[206:209], v[214:217], v[114:117]
    v_cvt_pk_f16_f32 v239, v200, v201
    v_add_u32 v180, s7, v180
    v_cndmask_b32 v180, v178, v180, vcc
    v_lshl_add_u32 v181, v126, 4, v180
    v_add_u32 v181, s3, v181
    v_lshl_add_u32 v180, v126, 3, v180
    v_add_u32 v180, s4, v180
    v_sub_u32 v170, 0x40800000, v44
    v_or_b32 v170, v170, v44
    v_fma_f32 v171, v130, v130, s33
    v_fmac_f32 v171, v131, v131
    v_fmac_f32 v171, v132, v132
    v_fmac_f32 v171, v133, v133
    v_xor_b32 v172, 65536, v2
    v_lshl_add_u32 v173, s16, 2, v172
    ds_write_b32 v173, v170 offset:18432
    v_bfe_u32 v170, v127, 1, 2
    v_xor_b32 v170, v170, v126
    v_lshl_add_u32 v170, v127, 2, v170
    v_lshl_add_u32 v173, v170, 4, s5
    v_lshl_add_u32 v198, v170, 3, s5
    v_lshl_add_u32 v199, v254, 4, s5
    v_lshl_add_u32 v254, v254, 3, s5
    v_lshlrev_b32 v170, 2, v170
    ds_permute_b32 v200, v170, v16
    ds_permute_b32 v201, v170, v19
    ds_permute_b32 v234, v170, v17
    ds_permute_b32 v235, v170, v20
    v_add_u32 v127, 16, v127
    v_min_u32 v170, 20, v127
    v_add_u32 v236, 12, v127
    v_lshrrev_b32 v236, 5, v236
    v_sub_u32 v237, v127, v170
    v_mad_i32_i24 v237, v236, s6, v237
    v_mul_u32_u24 v246, s20, v170
    v_add3_u32 v246, v246, v237, s38
    v_mul_u32_u24 v236, 911, v246
    v_lshrrev_b32 v236, 16, v236
    v_mul_u32_u24 v236, s22, v236
    v_mad_u32_u24 v236, v170, s21, v236
    v_bfe_u32 v246, s70, v127, 1
    v_cmp_ne_u32 vcc, 0, v246
    v_mul_i32_i24 v237, 2688, v237
    v_add3_u32 v127, v236, v237, s7
    v_cndmask_b32 v127, v178, v127, vcc
    v_lshl_add_u32 v170, v126, 4, v127
    v_add_u32 v170, s3, v170
    v_lshl_add_u32 v236, v126, 3, v127
    v_add_u32 v236, s4, v236
    ds_read_b128 v[246:249], v5 offset:48
    s_waitcnt lgkmcnt(0)
    v_mfma_f32_16x16x32_f16 v[114:117], v[246:249], v[238:241], v[114:117]
    v_mfma_f32_16x16x32_f16 v[242:245], v[246:249], v[190:193], v[242:245]
    v_mfma_f32_16x16x32_f16 v[250:253], v[122:125], v[138:141], v[22:25]
    v_mfma_f32_16x16x32_f16 v[250:253], v[206:209], v[150:153], v[250:253]
    v_mfma_f32_16x16x32_f16 v[250:253], v[246:249], v[226:229], v[250:253]
    s_nop 0
    s_nop 0
    s_nop 0
    s_nop 0
    s_nop 0
    s_nop 0
    s_nop 0
    s_nop 0
    v_max3_f32 v178, v250, v202, v203
    v_max3_f32 v178, v178, v204, v205
    v_max3_f32 v178, v178, v142, v143
    v_max3_f32 v178, v178, v144, v145
    v_mov_b32_dpp v179, v251 quad_perm:[0,1,2,3] row_mask:0x1 bank_mask:0xf
    s_nop 0
    s_nop 0
    v_mov_b32_dpp v179, v243 quad_perm:[0,1,2,3] row_mask:0x2 bank_mask:0xf
    v_mfma_f32_16x16x32_f16 v[122:125], v[214:217], v[138:141], v[54:57]
    v_mfma_f32_16x16x32_bf16 v[138:141], a[240:243], v[230:233], 0
    v_mov_b32_dpp v179, v115 quad_perm:[0,1,2,3] row_mask:0x4 bank_mask:0xf
    v_mov_b32 v237, v179
    v_mfma_f32_16x16x32_bf16 v[138:141], a[244:247], v[154:157], v[138:141]
    v_mfma_f32_16x16x32_bf16 v[138:141], a[248:251], v[158:161], v[138:141]
    v_max_f32_dpp v237, v237, v237 quad_perm:[1,0,3,2] row_mask:0xf bank_mask:0xf
    v_mfma_f32_16x16x16_f16 v[122:125], v[240:241], v[226:227], v[122:125]
    v_mfma_f32_16x16x32_bf16 v[138:141], a[252:255], v[174:177], v[138:141]
    v_max_f32_dpp v237, v237, v237 quad_perm:[2,3,0,1] row_mask:0xf bank_mask:0xf
    v_mfma_f32_16x16x32_bf16 v[138:141], v[82:85], v[186:189], v[138:141]
    v_mfma_f32_16x16x32_bf16 v[138:141], v[86:89], v[194:197], v[138:141]
    v_max_f32_dpp v237, v237, v237 row_half_mirror row_mask:0xf bank_mask:0xf
    s_nop 0
    s_nop 0
    v_max_f32_dpp v237, v237, v237 row_mirror row_mask:0xf bank_mask:0xf
    v_max3_f32 v178, v178, v122, v123
    v_max3_f32 v178, v178, v124, v125
    v_mov_b32 v126, v178
    v_mov_b32 v127, v237
    v_fmac_f32 v171, v138, v138
    v_permlane32_swap_b32 v178, v126
    v_max_f32 v178, v178, v126
    v_mov_b32 v126, v178
    v_fmac_f32 v171, v139, v139
    v_fmac_f32 v171, v140, v140
    v_permlane16_swap_b32 v178, v126
    v_max_f32 v178, v178, v126
    v_sub_f32 v202, v202, v178
    v_exp_f32 v202, v202
    v_sub_f32 v203, v203, v178
    v_exp_f32 v203, v203
    v_sub_f32 v204, v204, v178
    v_cvt_pk_bf16_f32 v202, v202, v203
    v_exp_f32 v204, v204
    v_sub_f32 v205, v205, v178
    v_exp_f32 v205, v205
    v_sub_f32 v142, v142, v178
    v_cvt_pk_bf16_f32 v203, v204, v205
    v_exp_f32 v142, v142
    v_sub_f32 v143, v143, v178
    v_exp_f32 v143, v143
    v_sub_f32 v144, v144, v178
    v_cvt_pk_bf16_f32 v204, v142, v143
    v_mfma_f32_16x16x32_bf16 v[206:209], v[90:93], v[230:233], 0
    ds_read_b128 v[230:233], v128 offset:0
    v_sub_f32 v145, v145, v178
    v_mfma_f32_16x16x32_bf16 v[206:209], v[94:97], v[154:157], v[206:209]
    ds_read_b128 v[154:157], v128 offset:2048
    v_sub_f32 v122, v122, v178
    v_mfma_f32_16x16x32_bf16 v[206:209], v[98:101], v[158:161], v[206:209]
    ds_read_b128 v[158:161], v128 offset:4096
    v_sub_f32 v123, v123, v178
    v_mfma_f32_16x16x32_bf16 v[206:209], v[102:105], v[174:177], v[206:209]
    ds_read_b128 v[174:177], v128 offset:6144
    v_sub_f32 v124, v124, v178
    v_mfma_f32_16x16x32_bf16 v[206:209], v[106:109], v[186:189], v[206:209]
    ds_read_b128 v[186:189], v128 offset:8192
    v_sub_f32 v125, v125, v178
    v_mfma_f32_16x16x32_bf16 v[206:209], v[110:113], v[194:197], v[206:209]
    ds_read_b128 v[194:197], v128 offset:10240
    v_exp_f32 v144, v144
    v_exp_f32 v145, v145
    v_exp_f32 v122, v122
    v_cvt_pk_bf16_f32 v205, v144, v145
    v_exp_f32 v123, v123
    v_exp_f32 v124, v124
    v_cvt_pk_bf16_f32 v36, v122, v123
    v_exp_f32 v125, v125
    v_sub_f32 v250, v250, v178
    v_mfma_f32_16x16x32_f16 v[142:145], v[150:153], v[134:137], v[58:61]
    v_cvt_pk_bf16_f32 v37, v124, v125
    v_exp_f32 v250, v250
    v_fmac_f32 v171, v141, v141
    v_cvt_pk_bf16_f32 v39, v250, 0
    v_fmac_f32 v171, v206, v206
    v_fmac_f32 v171, v207, v207
    v_mfma_f32_16x16x16_f16 v[142:145], v[228:229], v[190:191], v[142:145]
    v_fmac_f32 v171, v208, v208
    v_fmac_f32 v171, v209, v209
    v_permlane32_swap_b32 v237, v127
    v_max_f32 v237, v237, v127
    v_mfma_f32_16x16x32_bf16 v[122:125], v[28:31], v[36:39], 0
    s_waitcnt lgkmcnt(0)
    v_mov_b32 v127, v237
    v_mfma_f32_16x16x32_bf16 v[122:125], v[28:31], v[202:205], v[122:125]
    v_max3_f32 v178, v242, v142, v143
    v_permlane16_swap_b32 v237, v127
    v_max_f32 v237, v237, v127
    v_sub_f32 v179, v179, v237
    v_exp_f32 v179, v179
    v_max3_f32 v178, v178, v144, v145
    v_cvt_pk_bf16_f32 v179, v179, v179
    ds_write_b16 v8, v179
    v_mfma_f32_16x16x32_bf16 v[246:249], v[218:221], v[36:39], 0
    v_rcp_f32 v122, v122
    v_mfma_f32_16x16x32_bf16 v[246:249], v[146:149], v[202:205], v[246:249]
    s_nop 0
    s_nop 0
    s_nop 0
    s_nop 0
    s_nop 0
    s_nop 0
    s_nop 0
    s_nop 0
    v_mul_f32 v246, v122, v246
    v_mul_f32 v247, v122, v247
    v_cvt_pk_bf16_f32 v246, v246, v247
    v_mul_f32 v248, v122, v248
    v_mul_f32 v249, v122, v249
    v_cvt_pk_bf16_f32 v247, v248, v249
    v_mfma_f32_16x16x32_f16 v[250:253], v[162:165], v[134:137], v[62:65]
    s_nop 0
    s_nop 0
    s_nop 0
    s_nop 0
    s_nop 0
    s_nop 0
    v_mfma_f32_16x16x16_f16 v[250:253], v[192:193], v[190:191], v[250:253]
    s_nop 0
    s_nop 0
    s_nop 0
    s_nop 0
    s_nop 0
    s_nop 0
    s_nop 0
    s_nop 0
    v_max3_f32 v178, v178, v250, v251
    v_max3_f32 v178, v178, v252, v253
    v_mfma_f32_16x16x32_f16 v[124:127], v[214:217], v[134:137], v[66:69]
    s_nop 0
    s_nop 0
    s_nop 0
    s_nop 0
    s_nop 0
    s_nop 0
    v_mfma_f32_16x16x16_f16 v[124:127], v[240:241], v[190:191], v[124:127]
    s_nop 0
    s_nop 0
    s_nop 0
    s_nop 0
    s_nop 0
    s_nop 0
    s_nop 0
    s_nop 0
    v_max3_f32 v178, v178, v124, v125
    v_max3_f32 v178, v178, v126, v127
    v_mov_b32 v123, v178
    s_nop 0
    s_nop 0
    v_permlane32_swap_b32 v178, v123
    v_max_f32 v178, v178, v123
    v_mov_b32 v123, v178
    s_nop 0
    s_nop 0
    v_permlane16_swap_b32 v178, v123
    v_max_f32 v178, v178, v123
    v_sub_f32 v142, v142, v178
    v_exp_f32 v142, v142
    v_sub_f32 v143, v143, v178
    v_exp_f32 v143, v143
    v_sub_f32 v144, v144, v178
    v_cvt_pk_bf16_f32 v134, v142, v143
    v_exp_f32 v144, v144
    v_sub_f32 v145, v145, v178
    v_exp_f32 v145, v145
    v_sub_f32 v250, v250, v178
    v_cvt_pk_bf16_f32 v135, v144, v145
    v_exp_f32 v250, v250
    v_sub_f32 v251, v251, v178
    v_exp_f32 v251, v251
    v_sub_f32 v252, v252, v178
    v_cvt_pk_bf16_f32 v136, v250, v251
    v_exp_f32 v252, v252
    v_sub_f32 v253, v253, v178
    v_exp_f32 v253, v253
    v_sub_f32 v124, v124, v178
    v_cvt_pk_bf16_f32 v137, v252, v253
    v_mfma_f32_16x16x32_bf16 v[142:145], v[222:225], v[36:39], 0
    v_exp_f32 v124, v124
    v_mfma_f32_16x16x32_bf16 v[142:145], v[118:121], v[202:205], v[142:145]
    v_sub_f32 v125, v125, v178
    v_exp_f32 v125, v125
    v_sub_f32 v126, v126, v178
    v_exp_f32 v126, v126
    v_sub_f32 v127, v127, v178
    v_exp_f32 v127, v127
    v_sub_f32 v242, v242, v178
    v_exp_f32 v242, v242
    v_mul_f32 v142, v122, v142
    v_mul_f32 v143, v122, v143
    v_cvt_pk_bf16_f32 v248, v142, v143
    v_mul_f32 v144, v122, v144
    v_mul_f32 v145, v122, v145
    v_cvt_pk_bf16_f32 v249, v144, v145
    ds_write_b128 v3, v[246:249] offset:0
    v_mfma_f32_16x16x32_bf16 v[142:145], v[210:213], v[36:39], 0
    v_cvt_pk_bf16_f32 v36, v124, v125
    v_cvt_pk_bf16_f32 v37, v126, v127
    v_mfma_f32_16x16x32_bf16 v[142:145], v[182:185], v[202:205], v[142:145]
    v_cvt_pk_bf16_f32 v39, v242, 0
    v_mfma_f32_16x16x32_f16 v[202:205], v[150:153], v[166:169], v[70:73]
    ds_read_b128 v[150:153], v9
    ds_read_b128 v[242:245], v9 offset:64
    v_mfma_f32_16x16x32_f16 v[246:249], v[162:165], v[166:169], v[74:77]
    v_mfma_f32_16x16x32_f16 v[162:165], v[214:217], v[166:169], v[78:81]
    v_mfma_f32_16x16x32_bf16 v[166:169], v[28:31], v[36:39], 0
    v_mfma_f32_16x16x32_bf16 v[166:169], v[28:31], v[134:137], v[166:169]
    v_mul_f32 v142, v122, v142
    v_mul_f32 v143, v122, v143
    v_cvt_pk_bf16_f32 v126, v142, v143
    v_mfma_f32_16x16x16_f16 v[202:205], v[228:229], v[238:239], v[202:205]
    v_mul_f32 v144, v122, v144
    v_mul_f32 v145, v122, v145
    v_cvt_pk_bf16_f32 v127, v144, v145
    v_mfma_f32_16x16x16_f16 v[246:249], v[192:193], v[238:239], v[246:249]
    v_rcp_f32 v166, v166
    v_mfma_f32_16x16x16_f16 v[162:165], v[240:241], v[238:239], v[162:165]
    ds_write_b64 v4, v[126:127] offset:4096
    v_mfma_f32_16x16x32_bf16 v[122:125], v[218:221], v[36:39], 0
    s_waitcnt lgkmcnt(1)
    v_max3_f32 v237, v114, v202, v203
    v_max3_f32 v237, v237, v204, v205
    v_mfma_f32_16x16x32_bf16 v[122:125], v[146:149], v[134:137], v[122:125]
    v_max3_f32 v237, v237, v246, v247
    v_max3_f32 v237, v237, v248, v249
    v_mfma_f32_16x16x32_bf16 v[142:145], v[222:225], v[36:39], 0
    v_max3_f32 v237, v237, v162, v163
    v_max3_f32 v237, v237, v164, v165
    v_mfma_f32_16x16x32_bf16 v[142:145], v[118:121], v[134:137], v[142:145]
    v_mov_b32 v126, v237
    v_mfma_f32_16x16x32_bf16 v[190:193], v[210:213], v[36:39], 0
    v_mul_f32 v122, v166, v122
    v_mul_f32 v123, v166, v123
    v_mfma_f32_16x16x32_bf16 v[190:193], v[182:185], v[134:137], v[190:193]
    v_cvt_pk_bf16_f32 v122, v122, v123
    v_mul_f32 v124, v166, v124
    v_mfma_f32_16x16x32_bf16 v[134:137], a[216:219], v[230:233], 0
    v_mul_f32 v125, v166, v125
    v_cvt_pk_bf16_f32 v123, v124, v125
    v_mfma_f32_16x16x32_bf16 v[134:137], a[220:223], v[154:157], v[134:137]
    v_mul_f32 v142, v166, v142
    v_mul_f32 v143, v166, v143
    v_mfma_f32_16x16x32_bf16 v[134:137], a[224:227], v[158:161], v[134:137]
    v_cvt_pk_bf16_f32 v124, v142, v143
    v_mul_f32 v144, v166, v144
    v_mfma_f32_16x16x32_bf16 v[134:137], a[228:231], v[174:177], v[134:137]
    v_mul_f32 v145, v166, v145
    v_cvt_pk_bf16_f32 v125, v144, v145
    v_mfma_f32_16x16x32_bf16 v[134:137], a[232:235], v[186:189], v[134:137]
    ds_write_b128 v3, v[122:125] offset:6144
    v_mfma_f32_16x16x32_bf16 v[134:137], a[236:239], v[194:197], v[134:137]
    v_mul_f32 v190, v166, v190
    v_mul_f32 v191, v166, v191
    v_mfma_f32_16x16x32_bf16 v[122:125], a[240:243], v[230:233], 0
    v_cvt_pk_bf16_f32 v178, v190, v191
    v_mul_f32 v192, v166, v192
    v_mfma_f32_16x16x32_bf16 v[122:125], a[244:247], v[154:157], v[122:125]
    v_mul_f32 v193, v166, v193
    v_cvt_pk_bf16_f32 v179, v192, v193
    v_mfma_f32_16x16x32_bf16 v[122:125], a[248:251], v[158:161], v[122:125]
    ds_write_b64 v4, v[178:179] offset:10240
    v_mfma_f32_16x16x32_bf16 v[122:125], a[252:255], v[174:177], v[122:125]
    v_permlane32_swap_b32 v237, v126
    v_mfma_f32_16x16x32_bf16 v[122:125], v[82:85], v[186:189], v[122:125]
    v_fma_f32 v127, v134, v134, s33
    v_fmac_f32 v127, v135, v135
    v_mfma_f32_16x16x32_bf16 v[122:125], v[86:89], v[194:197], v[122:125]
    v_fmac_f32 v127, v136, v136
    v_fmac_f32 v127, v137, v137
    v_mfma_f32_16x16x32_bf16 v[142:145], v[90:93], v[230:233], 0
    v_max_f32 v237, v237, v126
    v_mov_b32 v126, v237
    v_mfma_f32_16x16x32_bf16 v[142:145], v[94:97], v[154:157], v[142:145]
    v_mfma_f32_16x16x32_bf16 v[142:145], v[98:101], v[158:161], v[142:145]
    v_permlane16_swap_b32 v237, v126
    v_mfma_f32_16x16x32_bf16 v[142:145], v[102:105], v[174:177], v[142:145]
    v_fmac_f32 v127, v122, v122
    v_fmac_f32 v127, v123, v123
    v_mfma_f32_16x16x32_bf16 v[142:145], v[106:109], v[186:189], v[142:145]
    v_fmac_f32 v127, v124, v124
    v_fmac_f32 v127, v125, v125
    v_mfma_f32_16x16x32_bf16 v[142:145], v[110:113], v[194:197], v[142:145]
    v_max_f32 v237, v237, v126
    v_sub_f32 v202, v202, v237
    v_mfma_f32_16x16x32_bf16 v[154:157], v[150:153], v[28:31], 0
    v_exp_f32 v202, v202
    v_mfma_f32_16x16x32_bf16 v[154:157], v[242:245], v[28:31], v[154:157]
    v_sub_f32 v203, v203, v237
    v_sub_f32 v204, v204, v237
    v_mfma_f32_16x16x32_bf16 v[158:161], v[150:153], v[146:149], 0
    v_fmac_f32 v127, v142, v142
    v_fmac_f32 v127, v143, v143
    v_mfma_f32_16x16x32_bf16 v[158:161], v[242:245], v[218:221], v[158:161]
    v_fmac_f32 v127, v144, v144
    v_fmac_f32 v127, v145, v145
    v_mfma_f32_16x16x32_bf16 v[166:169], v[150:153], v[118:121], 0
    v_cvt_pk_bf16_f32 v126, v171, v127
    v_cvt_pk_bf16_f32 v127, v127, v127
    v_mfma_f32_16x16x32_bf16 v[166:169], v[242:245], v[222:225], v[166:169]
    ds_write_b64 v255, v[126:127] offset:2048
    v_mfma_f32_16x16x32_bf16 v[174:177], v[150:153], v[182:185], 0
    v_rcp_f32 v154, v154
    v_mfma_f32_16x16x32_bf16 v[174:177], v[242:245], v[210:213], v[174:177]
    v_mul_f32 v158, v158, v154
    v_exp_f32 v203, v203
    v_exp_f32 v204, v204
    v_cvt_pk_bf16_f32 v150, v202, v203
    v_mul_f32_dpp v158, v166, v154 quad_perm:[0,1,2,3] row_mask:0x2 bank_mask:0xf
    v_sub_f32 v205, v205, v237
    v_exp_f32 v205, v205
    v_sub_f32 v246, v246, v237
    v_mul_f32_dpp v158, v174, v154 quad_perm:[0,1,2,3] row_mask:0x4 bank_mask:0xf
    v_cvt_pk_bf16_f32 v158, v158, v158
    ds_write_b16 v7, v158
    v_cvt_pk_bf16_f32 v151, v204, v205
    v_exp_f32 v246, v246
    s_waitcnt lgkmcnt(1)
    s_barrier
    ds_read_b128 v[154:157], v129 offset:2048
    ds_read_b128 v[158:161], v129 offset:3072
    ds_read_b128 v[166:169], v172 offset:0
    ds_read_b128 v[174:177], v172 offset:1024
    ds_read_b128 v[186:189], v172 offset:2048
    ds_read_b128 v[190:193], v172 offset:3072
    ds_read_b128 v[194:197], v172 offset:4096
    ds_read_b128 v[202:205], v172 offset:5120
    v_sub_f32 v247, v247, v237
    v_exp_f32 v247, v247
    v_sub_f32 v248, v248, v237
    v_cvt_pk_bf16_f32 v152, v246, v247
    v_exp_f32 v248, v248
    s_waitcnt lgkmcnt(6)
    v_mfma_f32_16x16x32_bf16 v[214:217], v[32:35], v[154:157], 0
    s_waitcnt lgkmcnt(5)
    v_sub_f32 v249, v249, v237
    v_sub_f32 v162, v162, v237
    v_mfma_f32_16x16x32_bf16 v[214:217], v[32:35], v[158:161], v[214:217]
    s_waitcnt lgkmcnt(4)
    v_exp_f32 v249, v249
    v_mfma_f32_16x16x32_bf16 v[154:157], a[216:219], v[166:169], 0
    s_waitcnt lgkmcnt(3)
    v_cvt_pk_bf16_f32 v153, v248, v249
    v_sub_f32 v163, v163, v237
    v_mfma_f32_16x16x32_bf16 v[154:157], a[220:223], v[174:177], v[154:157]
    s_waitcnt lgkmcnt(2)
    v_mul_f32 v171, 0x3baaaaab, v215
    v_mul_f32 v126, 0x3baaaaab, v214
    v_mfma_f32_16x16x32_bf16 v[154:157], a[224:227], v[186:189], v[154:157]
    s_waitcnt lgkmcnt(1)
    v_rsq_f32 v171, v171
    v_mfma_f32_16x16x32_bf16 v[154:157], a[228:231], v[190:193], v[154:157]
    s_waitcnt lgkmcnt(0)
    v_mul_f32 v134, v171, v134
    v_mul_f32 v135, v171, v135
    v_mfma_f32_16x16x32_bf16 v[154:157], a[232:235], v[194:197], v[154:157]
    v_cvt_pk_bf16_f32 v134, v134, v135
    v_mul_f32 v136, v171, v136
    v_mfma_f32_16x16x32_bf16 v[154:157], a[236:239], v[202:205], v[154:157]
    v_mul_f32 v137, v171, v137
    v_cvt_pk_bf16_f32 v135, v136, v137
    v_mfma_f32_16x16x32_bf16 v[158:161], a[240:243], v[166:169], 0
    v_mul_f32 v122, v171, v122
    v_mul_f32 v123, v171, v123
    v_mfma_f32_16x16x32_bf16 v[158:161], a[244:247], v[174:177], v[158:161]
    v_cvt_pk_bf16_f32 v136, v122, v123
    v_mul_f32 v124, v171, v124
    v_mfma_f32_16x16x32_bf16 v[158:161], a[248:251], v[186:189], v[158:161]
    v_mul_f32 v125, v171, v125
    v_cvt_pk_bf16_f32 v137, v124, v125
    v_mfma_f32_16x16x32_bf16 v[158:161], a[252:255], v[190:193], v[158:161]
    buffer_store_dwordx4 v[134:137], v181, s[12:15], 0 offen nt
    v_mul_f32 v142, v171, v142
    v_mul_f32 v143, v171, v143
    v_cvt_pk_bf16_f32 v116, v142, v143
    v_mul_f32 v144, v171, v144
    v_mfma_f32_16x16x32_bf16 v[158:161], v[82:85], v[194:197], v[158:161]
    v_mul_f32 v145, v171, v145
    v_cvt_pk_bf16_f32 v117, v144, v145
    v_mfma_f32_16x16x32_bf16 v[158:161], v[86:89], v[202:205], v[158:161]
    ds_read_b128 v[122:125], v172 offset:6144
    v_fma_f32 v171, v154, v154, s33
    v_mfma_f32_16x16x32_bf16 v[134:137], v[90:93], v[166:169], 0
    ds_read_b128 v[142:145], v172 offset:7168
    v_fmac_f32 v171, v155, v155
    v_mfma_f32_16x16x32_bf16 v[134:137], v[94:97], v[174:177], v[134:137]
    ds_read_b128 v[166:169], v172 offset:8192
    v_fmac_f32 v171, v156, v156
    v_mfma_f32_16x16x32_bf16 v[134:137], v[98:101], v[186:189], v[134:137]
    ds_read_b128 v[174:177], v172 offset:9216
    v_fmac_f32 v171, v157, v157
    v_mfma_f32_16x16x32_bf16 v[134:137], v[102:105], v[190:193], v[134:137]
    ds_read_b128 v[186:189], v172 offset:10240
    v_fmac_f32 v171, v158, v158
    v_mfma_f32_16x16x32_bf16 v[134:137], v[106:109], v[194:197], v[134:137]
    ds_read_b128 v[190:193], v172 offset:11264
    v_fmac_f32 v171, v159, v159
    v_mfma_f32_16x16x32_bf16 v[134:137], v[110:113], v[202:205], v[134:137]
    v_fmac_f32 v171, v160, v160
    v_fmac_f32 v171, v161, v161
    v_rsq_f32 v126, v126
    s_waitcnt lgkmcnt(5)
    v_mfma_f32_16x16x32_bf16 v[194:197], a[216:219], v[122:125], 0
    v_mul_f32 v130, v126, v130
    v_mul_f32 v131, v126, v131
    v_mfma_f32_16x16x32_bf16 v[202:205], a[240:243], v[122:125], 0
    s_waitcnt lgkmcnt(4)
    v_fmac_f32 v171, v134, v134
    v_fmac_f32 v171, v135, v135
    v_mfma_f32_16x16x32_bf16 v[194:197], a[220:223], v[142:145], v[194:197]
    s_waitcnt lgkmcnt(3)
    v_fmac_f32 v171, v136, v136
    v_fmac_f32 v171, v137, v137
    v_mfma_f32_16x16x32_bf16 v[194:197], a[224:227], v[166:169], v[194:197]
    s_waitcnt lgkmcnt(2)
    v_cvt_pk_bf16_f32 v130, v130, v131
    v_mul_f32 v132, v126, v132
    v_mfma_f32_16x16x32_bf16 v[194:197], a[228:231], v[174:177], v[194:197]
    s_waitcnt lgkmcnt(1)
    v_mul_f32 v133, v126, v133
    v_cvt_pk_bf16_f32 v131, v132, v133
    v_mfma_f32_16x16x32_bf16 v[194:197], a[232:235], v[186:189], v[194:197]
    s_waitcnt lgkmcnt(0)
    v_mul_f32 v138, v126, v138
    v_mul_f32 v139, v126, v139
    v_mfma_f32_16x16x32_bf16 v[194:197], a[236:239], v[190:193], v[194:197]
    buffer_store_dwordx2 v[116:117], v180, s[12:15], 0 offen nt
    v_cvt_pk_bf16_f32 v132, v138, v139
    v_mul_f32 v140, v126, v140
    v_mfma_f32_16x16x32_bf16 v[202:205], a[244:247], v[142:145], v[202:205]
    v_mul_f32 v141, v126, v141
    v_cvt_pk_bf16_f32 v133, v140, v141
    v_mfma_f32_16x16x32_bf16 v[202:205], a[248:251], v[166:169], v[202:205]
    v_mul_f32 v206, v126, v206
    v_fma_f32 v127, v194, v194, s33
    v_mfma_f32_16x16x32_bf16 v[202:205], a[252:255], v[174:177], v[202:205]
    v_fmac_f32 v127, v195, v195
    v_fmac_f32 v127, v196, v196
    v_mfma_f32_16x16x32_bf16 v[202:205], v[82:85], v[186:189], v[202:205]
    v_fmac_f32 v127, v197, v197
    v_mul_f32 v207, v126, v207
    v_mfma_f32_16x16x32_bf16 v[202:205], v[86:89], v[190:193], v[202:205]
    v_cvt_pk_bf16_f32 v116, v206, v207
    v_mul_f32 v208, v126, v208
    v_mfma_f32_16x16x32_bf16 v[138:141], v[90:93], v[122:125], 0
    v_mul_f32 v209, v126, v209
    v_cvt_pk_bf16_f32 v117, v208, v209
    v_mfma_f32_16x16x32_bf16 v[138:141], v[94:97], v[142:145], v[138:141]
    v_exp_f32 v162, v162
    v_mfma_f32_16x16x32_bf16 v[138:141], v[98:101], v[166:169], v[138:141]
    v_fmac_f32 v127, v202, v202
    v_fmac_f32 v127, v203, v203
    v_mfma_f32_16x16x32_bf16 v[138:141], v[102:105], v[174:177], v[138:141]
    v_fmac_f32 v127, v204, v204
    v_fmac_f32 v127, v205, v205
    v_mfma_f32_16x16x32_bf16 v[138:141], v[106:109], v[186:189], v[138:141]
    v_exp_f32 v163, v163
    v_mfma_f32_16x16x32_bf16 v[138:141], v[110:113], v[190:193], v[138:141]
    v_cvt_pk_bf16_f32 v36, v162, v163
    v_sub_f32 v164, v164, v237
    v_exp_f32 v164, v164
    v_sub_f32 v165, v165, v237
    v_exp_f32 v165, v165
    v_sub_f32 v114, v114, v237
    v_cvt_pk_bf16_f32 v37, v164, v165
    v_exp_f32 v114, v114
    v_fmac_f32 v127, v138, v138
    v_fmac_f32 v127, v139, v139
    v_fmac_f32 v127, v140, v140
    v_fmac_f32 v127, v141, v141
    v_cvt_pk_bf16_f32 v126, v171, v127
    v_cvt_pk_bf16_f32 v127, v127, v127
    ds_write_b64 v255, v[126:127] offset:7616
    buffer_store_dwordx4 v[130:133], v17, s[52:55], 0 offen nt
    v_cvt_pk_bf16_f32 v39, v114, 0
    s_nop 0
    s_nop 0
    v_mfma_f32_16x16x32_bf16 v[122:125], v[28:31], v[36:39], 0
    v_mfma_f32_16x16x32_bf16 v[122:125], v[28:31], v[150:153], v[122:125]
    v_mfma_f32_16x16x32_bf16 v[130:133], v[218:221], v[36:39], 0
    v_mfma_f32_16x16x32_bf16 v[130:133], v[146:149], v[150:153], v[130:133]
    v_mfma_f32_16x16x32_bf16 v[142:145], v[222:225], v[36:39], 0
    v_mfma_f32_16x16x32_bf16 v[142:145], v[118:121], v[150:153], v[142:145]
    v_mfma_f32_16x16x32_bf16 v[118:121], v[210:213], v[36:39], 0
    v_mfma_f32_16x16x32_bf16 v[118:121], v[182:185], v[150:153], v[118:121]
    s_nop 0
    s_nop 0
    v_rcp_f32 v122, v122
    s_nop 0
    v_mul_f32 v130, v122, v130
    v_mul_f32 v131, v122, v131
    v_cvt_pk_bf16_f32 v130, v130, v131
    v_mul_f32 v132, v122, v132
    v_mul_f32 v133, v122, v133
    v_cvt_pk_bf16_f32 v131, v132, v133
    v_mul_f32 v142, v122, v142
    v_mul_f32 v143, v122, v143
    v_cvt_pk_bf16_f32 v132, v142, v143
    v_mul_f32 v144, v122, v144
    v_mul_f32 v145, v122, v145
    v_cvt_pk_bf16_f32 v133, v144, v145
    ds_write_b128 v3, v[130:133] offset:12288
    v_mul_f32 v118, v122, v118
    v_mul_f32 v119, v122, v119
    v_cvt_pk_bf16_f32 v114, v118, v119
    v_mul_f32 v120, v122, v120
    v_mul_f32 v121, v122, v121
    v_cvt_pk_bf16_f32 v115, v120, v121
    buffer_store_dwordx2 v[116:117], v20, s[52:55], 0 offen nt
    ds_write_b64 v4, v[114:115] offset:16384
    s_waitcnt lgkmcnt(0)
    s_barrier
    ds_read_b128 v[114:117], v129 offset:7616
    ds_read_b128 v[118:121], v129 offset:8640
    ds_read_b128 v[122:125], v172 offset:12288
    ds_read_b128 v[130:133], v172 offset:13312
    ds_read_b128 v[142:145], v172 offset:14336
    ds_read_b128 v[146:149], v172 offset:15360
    ds_read_b128 v[150:153], v172 offset:16384
    ds_read_b128 v[162:165], v172 offset:17408
    s_waitcnt lgkmcnt(7)
    v_mfma_f32_16x16x32_bf16 v[166:169], v[32:35], v[114:117], 0
    s_waitcnt lgkmcnt(6)
    v_mfma_f32_16x16x32_bf16 v[166:169], v[32:35], v[118:121], v[166:169]
    s_waitcnt lgkmcnt(4)
    v_mfma_f32_16x16x32_bf16 v[114:117], a[216:219], v[122:125], 0
    s_waitcnt lgkmcnt(3)
    v_mfma_f32_16x16x32_bf16 v[114:117], a[220:223], v[130:133], v[114:117]
    s_waitcnt lgkmcnt(2)
    v_mfma_f32_16x16x32_bf16 v[114:117], a[224:227], v[142:145], v[114:117]
    s_waitcnt lgkmcnt(1)
    v_mfma_f32_16x16x32_bf16 v[114:117], a[228:231], v[146:149], v[114:117]
    s_waitcnt lgkmcnt(0)
    v_mul_f32 v171, 0x3baaaaab, v166
    v_mul_f32 v237, 0x3baaaaab, v167
    v_mfma_f32_16x16x32_bf16 v[114:117], a[232:235], v[150:153], v[114:117]
    v_rsq_f32 v171, v171
    v_mfma_f32_16x16x32_bf16 v[114:117], a[236:239], v[162:165], v[114:117]
    v_mul_f32 v154, v171, v154
    v_mul_f32 v155, v171, v155
    v_mfma_f32_16x16x32_bf16 v[118:121], a[240:243], v[122:125], 0
    v_cvt_pk_bf16_f32 v154, v154, v155
    v_mul_f32 v156, v171, v156
    v_mfma_f32_16x16x32_bf16 v[118:121], a[244:247], v[130:133], v[118:121]
    v_mul_f32 v157, v171, v157
    v_cvt_pk_bf16_f32 v155, v156, v157
    v_mfma_f32_16x16x32_bf16 v[118:121], a[248:251], v[142:145], v[118:121]
    v_fma_f32 v126, v114, v114, s33
    v_fmac_f32 v126, v115, v115
    v_mfma_f32_16x16x32_bf16 v[118:121], a[252:255], v[146:149], v[118:121]
    v_fmac_f32 v126, v116, v116
    v_fmac_f32 v126, v117, v117
    v_mfma_f32_16x16x32_bf16 v[118:121], v[82:85], v[150:153], v[118:121]
    v_mul_f32 v158, v171, v158
    v_mul_f32 v159, v171, v159
    v_mfma_f32_16x16x32_bf16 v[118:121], v[86:89], v[162:165], v[118:121]
    ds_read_b128 v[166:169], v128 offset:256
    v_cvt_pk_bf16_f32 v156, v158, v159
    v_mfma_f32_16x16x32_bf16 v[174:177], v[90:93], v[122:125], 0
    ds_read_b128 v[122:125], v128 offset:2304
    v_mul_f32 v160, v171, v160
    v_mfma_f32_16x16x32_bf16 v[174:177], v[94:97], v[130:133], v[174:177]
    ds_read_b128 v[130:133], v128 offset:4352
    v_mul_f32 v161, v171, v161
    v_mfma_f32_16x16x32_bf16 v[174:177], v[98:101], v[142:145], v[174:177]
    ds_read_b128 v[142:145], v128 offset:6400
    v_fmac_f32 v126, v118, v118
    v_mfma_f32_16x16x32_bf16 v[174:177], v[102:105], v[146:149], v[174:177]
    ds_read_b128 v[146:149], v128 offset:8448
    v_fmac_f32 v126, v119, v119
    v_mfma_f32_16x16x32_bf16 v[174:177], v[106:109], v[150:153], v[174:177]
    ds_read_b128 v[150:153], v128 offset:10496
    v_fmac_f32 v126, v120, v120
    v_mfma_f32_16x16x32_bf16 v[174:177], v[110:113], v[162:165], v[174:177]
    v_fmac_f32 v126, v121, v121
    v_cvt_pk_bf16_f32 v157, v160, v161
    buffer_store_dwordx4 v[154:157], v15, s[56:59], 0 offen nt
    s_waitcnt lgkmcnt(5)
    v_mul_f32 v134, v171, v134
    v_mul_f32 v135, v171, v135
    v_cvt_pk_bf16_f32 v134, v134, v135
    v_mfma_f32_16x16x32_bf16 v[154:157], a[216:219], v[166:169], 0
    s_waitcnt lgkmcnt(4)
    v_fmac_f32 v126, v174, v174
    v_fmac_f32 v126, v175, v175
    v_mfma_f32_16x16x32_bf16 v[154:157], a[220:223], v[122:125], v[154:157]
    s_waitcnt lgkmcnt(3)
    v_fmac_f32 v126, v176, v176
    v_fmac_f32 v126, v177, v177
    v_mfma_f32_16x16x32_bf16 v[154:157], a[224:227], v[130:133], v[154:157]
    s_waitcnt lgkmcnt(2)
    v_cvt_pk_bf16_f32 v158, v126, v126
    v_cvt_pk_bf16_f32 v159, v126, v126
    v_mfma_f32_16x16x32_bf16 v[154:157], a[228:231], v[142:145], v[154:157]
    s_waitcnt lgkmcnt(1)
    ds_write_b64 v255, v[158:159] offset:9664
    v_mfma_f32_16x16x32_bf16 v[154:157], a[232:235], v[146:149], v[154:157]
    s_waitcnt lgkmcnt(1)
    v_mul_f32 v136, v171, v136
    v_mul_f32 v137, v171, v137
    v_mfma_f32_16x16x32_bf16 v[154:157], a[236:239], v[150:153], v[154:157]
    v_rsq_f32 v237, v237
    v_mfma_f32_16x16x32_bf16 v[158:161], a[240:243], v[166:169], 0
    v_cvt_pk_bf16_f32 v135, v136, v137
    v_mul_f32 v194, v237, v194
    v_mfma_f32_16x16x32_bf16 v[158:161], a[244:247], v[122:125], v[158:161]
    v_mul_f32 v195, v237, v195
    v_cvt_pk_bf16_f32 v162, v194, v195
    v_mfma_f32_16x16x32_bf16 v[158:161], a[248:251], v[130:133], v[158:161]
    v_fma_f32 v171, v154, v154, s33
    v_fmac_f32 v171, v155, v155
    v_mfma_f32_16x16x32_bf16 v[158:161], a[252:255], v[142:145], v[158:161]
    v_fmac_f32 v171, v156, v156
    v_fmac_f32 v171, v157, v157
    v_mfma_f32_16x16x32_bf16 v[158:161], v[82:85], v[146:149], v[158:161]
    v_mul_f32 v196, v237, v196
    v_mul_f32 v197, v237, v197
    v_mfma_f32_16x16x32_bf16 v[158:161], v[86:89], v[150:153], v[158:161]
    v_cvt_pk_bf16_f32 v163, v196, v197
    v_mul_f32 v202, v237, v202
    v_mfma_f32_16x16x32_bf16 v[178:181], v[90:93], v[166:169], 0
    v_mul_f32 v203, v237, v203
    v_cvt_pk_bf16_f32 v164, v202, v203
    v_mfma_f32_16x16x32_bf16 v[178:181], v[94:97], v[122:125], v[178:181]
    v_mul_f32 v204, v237, v204
    v_mul_f32 v205, v237, v205
    v_mfma_f32_16x16x32_bf16 v[178:181], v[98:101], v[130:133], v[178:181]
    buffer_store_dwordx2 v[134:135], v18, s[56:59], 0 offen nt
    v_fmac_f32 v171, v158, v158
    v_fmac_f32 v171, v159, v159
    v_mfma_f32_16x16x32_bf16 v[178:181], v[102:105], v[142:145], v[178:181]
    v_fmac_f32 v171, v160, v160
    v_fmac_f32 v171, v161, v161
    v_mfma_f32_16x16x32_bf16 v[178:181], v[106:109], v[146:149], v[178:181]
    v_cvt_pk_bf16_f32 v165, v204, v205
    v_mul_f32 v138, v237, v138
    v_mfma_f32_16x16x32_bf16 v[178:181], v[110:113], v[150:153], v[178:181]
    ds_write_b128 v173, v[162:165] offset:1536
    v_mul_f32 v139, v237, v139
    v_cvt_pk_bf16_f32 v126, v138, v139
    v_mul_f32 v140, v237, v140
    v_mul_f32 v141, v237, v141
    v_cvt_pk_bf16_f32 v127, v140, v141
    s_nop 0
    s_nop 0
    v_fmac_f32 v171, v178, v178
    v_fmac_f32 v171, v179, v179
    v_fmac_f32 v171, v180, v180
    v_fmac_f32 v171, v181, v181
    v_cvt_pk_bf16_f32 v122, v171, v171
    v_cvt_pk_bf16_f32 v123, v171, v171
    ds_write_b64 v255, v[122:123] offset:15232
    ds_read_b128 v[122:125], v199 offset:1536
    ds_write_b64 v198, v[126:127] offset:2560
    ds_read_b64 v[126:127], v254 offset:2560
    s_waitcnt lgkmcnt(3)
    s_barrier
    ds_read_b128 v[130:133], v129 offset:9664
    ds_read_b128 v[134:137], v129 offset:10688
    ds_read_b128 v[138:141], v129 offset:15232
    ds_read_b128 v[142:145], v129 offset:16256
    ds_read_b128 v[146:149], v172 offset:18432
    s_waitcnt lgkmcnt(6)
    buffer_store_dwordx4 v[122:125], v200, s[56:59], 0 offen nt
    s_waitcnt lgkmcnt(5)
    s_waitcnt lgkmcnt(4)
    v_mfma_f32_16x16x32_bf16 v[150:153], v[32:35], v[130:133], 0
    s_waitcnt lgkmcnt(3)
    v_mfma_f32_16x16x32_bf16 v[150:153], v[32:35], v[134:137], v[150:153]
    s_waitcnt lgkmcnt(1)
    buffer_store_dwordx2 v[126:127], v201, s[56:59], 0 offen nt
    v_mfma_f32_16x16x32_bf16 v[122:125], v[32:35], v[138:141], 0
    s_waitcnt lgkmcnt(0)
    v_or3_b32 v146, v146, v147, v148
    v_or_b32 v146, v146, v149
    v_mfma_f32_16x16x32_bf16 v[122:125], v[32:35], v[142:145], v[122:125]
    v_cmp_gt_i32 s[46:47], 0, v146
    v_mul_f32 v237, 0x3baaaaab, v150
    v_rsq_f32 v237, v237
    s_nop 0
    v_mul_f32 v114, v237, v114
    v_mul_f32 v115, v237, v115
    v_cvt_pk_bf16_f32 v114, v114, v115
    v_mul_f32 v116, v237, v116
    v_mul_f32 v115, 0x3baaaaab, v122
    v_rsq_f32 v115, v115
    v_mul_f32 v117, v237, v117
    v_mul_f32 v154, v115, v154
    v_mul_f32 v155, v115, v155
    v_cvt_pk_bf16_f32 v122, v154, v155
    v_mul_f32 v156, v115, v156
    v_mul_f32 v157, v115, v157
    v_cvt_pk_bf16_f32 v123, v156, v157
    v_mul_f32 v158, v115, v158
    v_mul_f32 v159, v115, v159
    v_cvt_pk_bf16_f32 v124, v158, v159
    v_mul_f32 v160, v115, v160
    v_mul_f32 v161, v115, v161
    v_cvt_pk_bf16_f32 v125, v160, v161
    buffer_store_dwordx4 v[122:125], v170, s[12:15], 0 offen nt
    v_mul_f32 v178, v115, v178
    v_mul_f32 v179, v115, v179
    v_cvt_pk_bf16_f32 v200, v178, v179
    v_mul_f32 v180, v115, v180
    v_mul_f32 v181, v115, v181
    v_cvt_pk_bf16_f32 v201, v180, v181
    v_cvt_pk_bf16_f32 v115, v116, v117
    v_mul_f32 v118, v237, v118
    v_mul_f32 v119, v237, v119
    v_cvt_pk_bf16_f32 v116, v118, v119
    v_mul_f32 v120, v237, v120
    v_mul_f32 v121, v237, v121
    v_cvt_pk_bf16_f32 v117, v120, v121
    ds_write_b128 v173, v[114:117] offset:3072
    v_mul_f32 v174, v237, v174
    v_mul_f32 v175, v237, v175
    v_cvt_pk_bf16_f32 v174, v174, v175
    v_mul_f32 v176, v237, v176
    v_mul_f32 v177, v237, v177
    v_cvt_pk_bf16_f32 v175, v176, v177
    buffer_store_dwordx2 v[200:201], v236, s[12:15], 0 offen nt
    ds_read_b128 v[114:117], v199 offset:3072
    ds_write_b64 v198, v[174:175] offset:4096
    ds_read_b64 v[236:237], v254 offset:4096
    s_waitcnt lgkmcnt(2)
    buffer_store_dwordx4 v[114:117], v234, s[56:59], 0 offen nt
    s_waitcnt lgkmcnt(0)
    buffer_store_dwordx2 v[236:237], v235, s[56:59], 0 offen nt
    s_branch L_end
L_drain:
    ds_read_b128 v[118:121], v2 offset:18432
    ds_read_b128 v[122:125], v2 offset:19456
    s_nop 3
    ds_read_b128 v[134:137], v2 offset:0
    s_mul_i32 s5, s16, 9408
    s_mov_b32 s12, s40
    ds_read_b128 v[138:141], v2 offset:1024
    s_mov_b32 s13, s41
    s_cmp_ge_u32 s18, 2
    s_cselect_b32 s14, s36, 0
    ds_read_b128 v[142:145], v2 offset:2048
    s_add_u32 s5, s5, 104448
    s_and_b32 s6, s2, 7
    s_sub_u32 s6, 0, s6
    ds_read_b128 v[146:149], v2 offset:3072
    s_lshl_b32 s3, s16, 6
    s_lshl_b32 s4, s16, 5
    s_add_u32 s4, s4, 256
    ds_read_b128 v[150:153], v2 offset:4096
    ds_read_b128 v[162:165], v2 offset:5120
    v_bfe_u32 v254, v2, 4, 6
    v_lshrrev_b32 v255, 4, v254
    v_and_b32 v166, 15, v254
    v_lshlrev_b32 v167, 9, v255
    v_lshl_add_u32 v167, v166, 4, v167
    v_add_u32 v167, 149696, v167
    s_waitcnt lgkmcnt(7)
    v_mfma_f32_16x16x32_bf16 v[170:173], v[32:35], v[118:121], 0
    s_waitcnt lgkmcnt(5)
    v_xor_b32 v168, 65536, v2
    v_bfe_u32 v169, v166, 1, 2
    v_mfma_f32_16x16x32_bf16 v[170:173], v[32:35], v[122:125], v[170:173]
    s_waitcnt lgkmcnt(4)
    v_xor_b32 v169, v169, v255
    v_lshl_add_u32 v169, v166, 2, v169
    v_lshl_add_u32 v118, v169, 4, s5
    v_mfma_f32_16x16x32_bf16 v[122:125], a[216:219], v[134:137], 0
    s_waitcnt lgkmcnt(3)
    v_lshl_add_u32 v119, v169, 3, s5
    v_lshl_add_u32 v120, v254, 4, s5
    v_lshl_add_u32 v121, v254, 3, s5
    v_mfma_f32_16x16x32_bf16 v[122:125], a[220:223], v[138:141], v[122:125]
    s_waitcnt lgkmcnt(2)
    v_lshlrev_b32 v169, 2, v169
    v_mul_f32 v170, 0x3baaaaab, v170
    v_rsq_f32 v170, v170
    v_mfma_f32_16x16x32_bf16 v[122:125], a[224:227], v[142:145], v[122:125]
    s_waitcnt lgkmcnt(0)
    ds_permute_b32 v173, v169, v15
    ds_permute_b32 v174, v169, v18
    v_mul_f32 v178, v170, v178
    v_mfma_f32_16x16x32_bf16 v[122:125], a[228:231], v[146:149], v[122:125]
    ds_permute_b32 v175, v169, v16
    ds_permute_b32 v176, v169, v19
    v_mul_f32 v179, v170, v179
    v_mfma_f32_16x16x32_bf16 v[122:125], a[232:235], v[150:153], v[122:125]
    ds_permute_b32 v177, v169, v17
    ds_permute_b32 v182, v169, v20
    v_cvt_pk_bf16_f32 v178, v178, v179
    v_mfma_f32_16x16x32_bf16 v[122:125], a[236:239], v[162:165], v[122:125]
    v_mul_f32 v180, v170, v180
    v_mul_f32 v181, v170, v181
    v_cvt_pk_bf16_f32 v179, v180, v181
    v_mfma_f32_16x16x32_bf16 v[186:189], a[240:243], v[134:137], 0
    v_mul_f32 v198, v170, v198
    v_mul_f32 v199, v170, v199
    v_cvt_pk_bf16_f32 v180, v198, v199
    v_mfma_f32_16x16x32_bf16 v[186:189], a[244:247], v[138:141], v[186:189]
    v_mul_f32 v200, v170, v200
    v_mul_f32 v201, v170, v201
    v_cvt_pk_bf16_f32 v181, v200, v201
    v_mfma_f32_16x16x32_bf16 v[186:189], a[248:251], v[142:145], v[186:189]
    s_waitcnt lgkmcnt(4)
    ds_read_b128 v[190:193], v2 offset:6144
    v_mul_f32 v206, v170, v206
    v_mul_f32 v207, v170, v207
    v_mfma_f32_16x16x32_bf16 v[186:189], a[252:255], v[146:149], v[186:189]
    s_waitcnt lgkmcnt(3)
    ds_read_b128 v[194:197], v2 offset:7168
    v_cvt_pk_bf16_f32 v184, v206, v207
    v_mul_f32 v208, v170, v208
    v_mfma_f32_16x16x32_bf16 v[186:189], v[82:85], v[150:153], v[186:189]
    s_waitcnt lgkmcnt(2)
    ds_read_b128 v[198:201], v2 offset:8192
    v_mul_f32 v209, v170, v209
    v_cvt_pk_bf16_f32 v185, v208, v209
    v_mfma_f32_16x16x32_bf16 v[186:189], v[86:89], v[162:165], v[186:189]
    ds_read_b128 v[202:205], v2 offset:9216
    v_fma_f32 v169, v122, v122, s33
    v_fmac_f32 v169, v123, v123
    v_mfma_f32_16x16x32_bf16 v[206:209], v[90:93], v[134:137], 0
    ds_read_b128 v[134:137], v2 offset:10240
    v_fmac_f32 v169, v124, v124
    v_fmac_f32 v169, v125, v125
    v_mfma_f32_16x16x32_bf16 v[206:209], v[94:97], v[138:141], v[206:209]
    ds_read_b128 v[138:141], v2 offset:11264
    v_fmac_f32 v169, v186, v186
    v_fmac_f32 v169, v187, v187
    v_mfma_f32_16x16x32_bf16 v[206:209], v[98:101], v[142:145], v[206:209]
    s_waitcnt lgkmcnt(5)
    buffer_store_dwordx4 v[178:181], v15, s[12:15], s27 offen nt
    v_fmac_f32 v169, v188, v188
    v_fmac_f32 v169, v189, v189
    v_mul_f32 v183, 0x3baaaaab, v171
    v_mfma_f32_16x16x32_bf16 v[206:209], v[102:105], v[146:149], v[206:209]
    s_waitcnt lgkmcnt(4)
    v_rsq_f32 v183, v183
    v_sub_u32 v170, 0x40800000, v44
    v_mfma_f32_16x16x32_bf16 v[206:209], v[106:109], v[150:153], v[206:209]
    s_waitcnt lgkmcnt(3)
    v_mul_f32 v130, v183, v130
    v_mul_f32 v131, v183, v131
    v_cvt_pk_bf16_f32 v130, v130, v131
    v_mfma_f32_16x16x32_bf16 v[206:209], v[110:113], v[162:165], v[206:209]
    s_waitcnt lgkmcnt(2)
    v_mul_f32 v132, v183, v132
    v_mul_f32 v133, v183, v133
    v_cvt_pk_bf16_f32 v131, v132, v133
    v_mfma_f32_16x16x32_bf16 v[142:145], a[216:219], v[190:193], 0
    s_waitcnt lgkmcnt(1)
    v_mul_f32 v126, v183, v126
    v_mul_f32 v127, v183, v127
    v_fmac_f32 v169, v206, v206
    v_mfma_f32_16x16x32_bf16 v[142:145], a[220:223], v[194:197], v[142:145]
    s_waitcnt lgkmcnt(0)
    v_fmac_f32 v169, v207, v207
    v_fmac_f32 v169, v208, v208
    v_fmac_f32 v169, v209, v209
    v_mfma_f32_16x16x32_bf16 v[142:145], a[224:227], v[198:201], v[142:145]
    v_cvt_pk_bf16_f32 v132, v126, v127
    v_mul_f32 v128, v183, v128
    v_mul_f32 v129, v183, v129
    v_mfma_f32_16x16x32_bf16 v[142:145], a[228:231], v[202:205], v[142:145]
    v_cvt_pk_bf16_f32 v133, v128, v129
    v_mul_f32 v114, v183, v114
    v_mul_f32 v115, v183, v115
    v_mfma_f32_16x16x32_bf16 v[142:145], a[232:235], v[134:137], v[142:145]
    v_cvt_pk_bf16_f32 v114, v114, v115
    v_mul_f32 v116, v183, v116
    v_mul_f32 v117, v183, v117
    v_mfma_f32_16x16x32_bf16 v[142:145], a[236:239], v[138:141], v[142:145]
    v_cvt_pk_bf16_f32 v115, v116, v117
    v_or_b32 v170, v170, v44
    v_lshl_add_u32 v171, s16, 2, v168
    v_mfma_f32_16x16x32_bf16 v[126:129], a[240:243], v[190:193], 0
    ds_write_b32 v171, v170 offset:18432
    v_mul_f32 v183, 0x3baaaaab, v172
    v_mfma_f32_16x16x32_bf16 v[126:129], a[244:247], v[194:197], v[126:129]
    v_rsq_f32 v183, v183
    v_fma_f32 v116, v142, v142, s33
    v_mfma_f32_16x16x32_bf16 v[126:129], a[248:251], v[198:201], v[126:129]
    ds_read_b128 v[146:149], v2 offset:12288
    v_fmac_f32 v116, v143, v143
    v_fmac_f32 v116, v144, v144
    v_mfma_f32_16x16x32_bf16 v[126:129], a[252:255], v[202:205], v[126:129]
    ds_read_b128 v[150:153], v2 offset:13312
    v_fmac_f32 v116, v145, v145
    v_mul_f32 v242, v183, v242
    v_mfma_f32_16x16x32_bf16 v[126:129], v[82:85], v[134:137], v[126:129]
    ds_read_b128 v[162:165], v2 offset:14336
    v_mul_f32 v243, v183, v243
    v_cvt_pk_bf16_f32 v178, v242, v243
    v_mfma_f32_16x16x32_bf16 v[126:129], v[86:89], v[138:141], v[126:129]
    ds_read_b128 v[210:213], v2 offset:15360
    v_mul_f32 v244, v183, v244
    v_mul_f32 v245, v183, v245
    v_mfma_f32_16x16x32_bf16 v[214:217], v[90:93], v[190:193], 0
    ds_read_b128 v[190:193], v2 offset:16384
    v_cvt_pk_bf16_f32 v179, v244, v245
    v_mul_f32 v158, v183, v158
    v_mfma_f32_16x16x32_bf16 v[214:217], v[94:97], v[194:197], v[214:217]
    ds_read_b128 v[194:197], v2 offset:17408
    v_fmac_f32 v116, v126, v126
    v_fmac_f32 v116, v127, v127
    v_mfma_f32_16x16x32_bf16 v[214:217], v[98:101], v[198:201], v[214:217]
    s_waitcnt lgkmcnt(5)
    buffer_store_dwordx2 v[184:185], v18, s[12:15], s27 offen nt
    v_fmac_f32 v116, v128, v128
    v_mfma_f32_16x16x32_bf16 v[214:217], v[102:105], v[202:205], v[214:217]
    s_waitcnt lgkmcnt(4)
    v_fmac_f32 v116, v129, v129
    v_mul_f32 v159, v183, v159
    v_cvt_pk_bf16_f32 v180, v158, v159
    v_mfma_f32_16x16x32_bf16 v[214:217], v[106:109], v[134:137], v[214:217]
    s_waitcnt lgkmcnt(3)
    v_mul_f32 v160, v183, v160
    v_mul_f32 v161, v183, v161
    v_cvt_pk_bf16_f32 v181, v160, v161
    v_mfma_f32_16x16x32_bf16 v[214:217], v[110:113], v[138:141], v[214:217]
    s_waitcnt lgkmcnt(2)
    ds_write_b128 v118, v[178:181] offset:3072
    v_mfma_f32_16x16x32_bf16 v[134:137], a[216:219], v[146:149], 0
    s_waitcnt lgkmcnt(2)
    v_mul_f32 v154, v183, v154
    v_mul_f32 v155, v183, v155
    v_cvt_pk_bf16_f32 v154, v154, v155
    v_mfma_f32_16x16x32_bf16 v[134:137], a[220:223], v[150:153], v[134:137]
    s_waitcnt lgkmcnt(1)
    v_fmac_f32 v116, v214, v214
    v_fmac_f32 v116, v215, v215
    v_fmac_f32 v116, v216, v216
    v_mfma_f32_16x16x32_bf16 v[134:137], a[224:227], v[162:165], v[134:137]
    ds_read_b128 v[138:141], v120 offset:3072
    v_fmac_f32 v116, v217, v217
    v_cvt_pk_bf16_f32 v184, v169, v116
    v_mfma_f32_16x16x32_bf16 v[134:137], a[228:231], v[210:213], v[134:137]
    v_cvt_pk_bf16_f32 v185, v116, v116
    v_mul_f32 v156, v183, v156
    v_mul_f32 v157, v183, v157
    v_mfma_f32_16x16x32_bf16 v[134:137], a[232:235], v[190:193], v[134:137]
    ds_write_b64 v4, v[184:185] offset:0
    v_mfma_f32_16x16x32_bf16 v[134:137], a[236:239], v[194:197], v[134:137]
    v_cvt_pk_bf16_f32 v155, v156, v157
    v_mov_b32 v169, 0x40000000
    v_lshrrev_b32 v116, 2, v254
    v_mfma_f32_16x16x32_bf16 v[158:161], a[240:243], v[146:149], 0
    ds_write_b64 v119, v[154:155] offset:4096
    v_mfma_f32_16x16x32_bf16 v[158:161], a[244:247], v[150:153], v[158:161]
    v_lshrrev_b32 v117, 3, v254
    v_xor_b32 v117, v117, v254
    v_fma_f32 v254, v134, v134, s33
    v_mfma_f32_16x16x32_bf16 v[158:161], a[248:251], v[162:165], v[158:161]
    s_waitcnt lgkmcnt(2)
    ds_read_b128 v[154:157], v167 offset:0
    ds_read_b64 v[170:171], v121 offset:4096
    v_fmac_f32 v254, v135, v135
    v_mfma_f32_16x16x32_bf16 v[158:161], a[252:255], v[210:213], v[158:161]
    ds_read_b128 v[178:181], v167 offset:2048
    v_fmac_f32 v254, v136, v136
    v_fmac_f32 v254, v137, v137
    v_mfma_f32_16x16x32_bf16 v[158:161], v[82:85], v[190:193], v[158:161]
    s_waitcnt lgkmcnt(4)
    ds_read_b128 v[198:201], v167 offset:4096
    v_and_b32 v117, 3, v117
    v_add_u32 v116, 0, v116
    v_mfma_f32_16x16x32_bf16 v[158:161], v[86:89], v[194:197], v[158:161]
    s_barrier
    ds_read_b128 v[202:205], v168 offset:0
    ds_read_b128 v[218:221], v168 offset:1024
    v_mul_u32_u24 v172, s20, v116
    v_mfma_f32_16x16x32_bf16 v[222:225], v[90:93], v[146:149], 0
    ds_read_b128 v[146:149], v167 offset:6144
    ds_read_b128 v[226:229], v167 offset:8192
    v_add_u32 v172, s38, v172
    v_mfma_f32_16x16x32_bf16 v[222:225], v[94:97], v[150:153], v[222:225]
    ds_read_b128 v[150:153], v167 offset:10240
    v_fmac_f32 v254, v158, v158
    v_fmac_f32 v254, v159, v159
    v_mfma_f32_16x16x32_bf16 v[222:225], v[98:101], v[162:165], v[222:225]
    s_waitcnt lgkmcnt(7)
    buffer_store_dwordx4 v[130:133], v16, s[12:15], s27 offen nt
    ds_read_b128 v[162:165], v168 offset:18432
    v_fmac_f32 v254, v160, v160
    v_fmac_f32 v254, v161, v161
    v_mfma_f32_16x16x32_bf16 v[222:225], v[102:105], v[210:213], v[222:225]
    s_waitcnt lgkmcnt(7)
    v_mul_u32_u24 v183, 911, v172
    v_lshrrev_b32 v183, 16, v183
    v_mul_u32_u24 v183, s22, v183
    v_mfma_f32_16x16x32_bf16 v[222:225], v[106:109], v[190:193], v[222:225]
    s_waitcnt lgkmcnt(6)
    v_mad_u32_u24 v183, v116, s21, v183
    v_bfe_u32 v172, s70, v116, 1
    v_cmp_ne_u32 vcc, 0, v172
    v_mfma_f32_16x16x32_bf16 v[222:225], v[110:113], v[194:197], v[222:225]
    s_waitcnt lgkmcnt(4)
    v_add_u32 v116, s7, v183
    v_cndmask_b32 v116, v169, v116, vcc
    v_mfma_f32_16x16x32_bf16 v[130:133], v[32:35], v[202:205], 0
    s_waitcnt lgkmcnt(2)
    v_lshl_add_u32 v172, v117, 4, v116
    v_add_u32 v172, s3, v172
    v_mfma_f32_16x16x32_bf16 v[130:133], v[32:35], v[218:221], v[130:133]
    s_waitcnt lgkmcnt(1)
    v_fmac_f32 v254, v222, v222
    v_fmac_f32 v254, v223, v223
    v_fmac_f32 v254, v224, v224
    v_mfma_f32_16x16x32_bf16 v[190:193], a[216:219], v[154:157], 0
    v_fmac_f32 v254, v225, v225
    v_cvt_pk_bf16_f32 v184, v254, v254
    v_cvt_pk_bf16_f32 v185, v254, v254
    v_mfma_f32_16x16x32_bf16 v[190:193], a[220:223], v[178:181], v[190:193]
    s_waitcnt lgkmcnt(0)
    ds_write_b64 v4, v[184:185] offset:2048
    v_mfma_f32_16x16x32_bf16 v[190:193], a[224:227], v[198:201], v[190:193]
    v_lshl_add_u32 v254, v117, 3, v116
    v_add_u32 v254, s4, v254
    v_add_u32 v166, 16, v166
    v_mfma_f32_16x16x32_bf16 v[190:193], a[228:231], v[146:149], v[190:193]
    v_min_u32 v116, 20, v166
    v_add_u32 v132, 12, v166
    v_lshrrev_b32 v132, 5, v132
    v_mfma_f32_16x16x32_bf16 v[190:193], a[232:235], v[226:229], v[190:193]
    v_sub_u32 v133, v166, v116
    v_mad_i32_i24 v133, v132, s6, v133
    v_mul_u32_u24 v117, s20, v116
    v_mfma_f32_16x16x32_bf16 v[190:193], a[236:239], v[150:153], v[190:193]
    v_add3_u32 v117, v117, v133, s38
    v_mul_u32_u24 v132, 911, v117
    v_lshrrev_b32 v132, 16, v132
    v_mfma_f32_16x16x32_bf16 v[194:197], a[240:243], v[154:157], 0
    v_mul_u32_u24 v132, s22, v132
    v_mad_u32_u24 v132, v116, s21, v132
    v_bfe_u32 v117, s70, v166, 1
    v_mfma_f32_16x16x32_bf16 v[194:197], a[244:247], v[178:181], v[194:197]
    buffer_store_dwordx2 v[114:115], v19, s[12:15], s27 offen nt
    v_fma_f32 v166, v190, v190, s33
    v_mfma_f32_16x16x32_bf16 v[194:197], a[248:251], v[198:201], v[194:197]
    ds_read_b128 v[202:205], v167 offset:256
    v_fmac_f32 v166, v191, v191
    v_fmac_f32 v166, v192, v192
    v_mfma_f32_16x16x32_bf16 v[194:197], a[252:255], v[146:149], v[194:197]
    ds_read_b128 v[210:213], v167 offset:2304
    v_fmac_f32 v166, v193, v193
    v_cmp_ne_u32 vcc, 0, v117
    v_mfma_f32_16x16x32_bf16 v[194:197], v[82:85], v[226:229], v[194:197]
    ds_read_b128 v[114:117], v167 offset:4352
    v_mul_i32_i24 v133, 2688, v133
    v_add3_u32 v132, v132, v133, s7
    v_mfma_f32_16x16x32_bf16 v[194:197], v[86:89], v[150:153], v[194:197]
    ds_read_b128 v[218:221], v167 offset:6400
    v_cndmask_b32 v132, v169, v132, vcc
    v_lshl_add_u32 v169, v255, 4, v132
    v_mfma_f32_16x16x32_bf16 v[230:233], v[90:93], v[154:157], 0
    ds_read_b128 v[154:157], v167 offset:8448
    v_add_u32 v169, s3, v169
    v_lshl_add_u32 v255, v255, 3, v132
    v_mfma_f32_16x16x32_bf16 v[230:233], v[94:97], v[178:181], v[230:233]
    ds_read_b128 v[178:181], v167 offset:10496
    v_fmac_f32 v166, v194, v194
    v_fmac_f32 v166, v195, v195
    v_mfma_f32_16x16x32_bf16 v[230:233], v[98:101], v[198:201], v[230:233]
    s_waitcnt lgkmcnt(5)
    v_fmac_f32 v166, v196, v196
    v_fmac_f32 v166, v197, v197
    v_add_u32 v255, s4, v255
    v_mfma_f32_16x16x32_bf16 v[230:233], v[102:105], v[146:149], v[230:233]
    s_waitcnt lgkmcnt(4)
    v_mul_f32 v167, 0x3baaaaab, v130
    v_mul_f32 v183, 0x3baaaaab, v131
    v_rsq_f32 v167, v167
    v_mfma_f32_16x16x32_bf16 v[230:233], v[106:109], v[226:229], v[230:233]
    s_waitcnt lgkmcnt(3)
    v_mul_f32 v122, v167, v122
    v_mul_f32 v123, v167, v123
    v_cvt_pk_bf16_f32 v122, v122, v123
    v_mfma_f32_16x16x32_bf16 v[230:233], v[110:113], v[150:153], v[230:233]
    s_waitcnt lgkmcnt(2)
    v_mul_f32 v124, v167, v124
    v_mul_f32 v125, v167, v125
    v_cvt_pk_bf16_f32 v123, v124, v125
    v_mfma_f32_16x16x32_bf16 v[130:133], a[216:219], v[202:205], 0
    s_waitcnt lgkmcnt(1)
    v_mul_f32 v186, v167, v186
    v_mul_f32 v187, v167, v187
    v_fmac_f32 v166, v230, v230
    v_mfma_f32_16x16x32_bf16 v[130:133], a[220:223], v[210:213], v[130:133]
    s_waitcnt lgkmcnt(0)
    v_fmac_f32 v166, v231, v231
    v_fmac_f32 v166, v232, v232
    v_fmac_f32 v166, v233, v233
    v_mfma_f32_16x16x32_bf16 v[130:133], a[224:227], v[114:117], v[130:133]
    buffer_store_dwordx4 v[138:141], v177, s[12:15], s27 offen nt
    v_cvt_pk_bf16_f32 v184, v166, v166
    v_cvt_pk_bf16_f32 v185, v166, v166
    v_cvt_pk_bf16_f32 v124, v186, v187
    v_mfma_f32_16x16x32_bf16 v[130:133], a[228:231], v[218:221], v[130:133]
    ds_write_b64 v4, v[184:185] offset:4096
    v_mfma_f32_16x16x32_bf16 v[130:133], a[232:235], v[154:157], v[130:133]
    v_mul_f32 v188, v167, v188
    v_mul_f32 v189, v167, v189
    v_cvt_pk_bf16_f32 v125, v188, v189
    v_mfma_f32_16x16x32_bf16 v[130:133], a[236:239], v[178:181], v[130:133]
    ds_write_b128 v118, v[122:125] offset:4608
    v_mfma_f32_16x16x32_bf16 v[122:125], a[240:243], v[202:205], 0
    buffer_store_dwordx2 v[170:171], v182, s[12:15], s27 offen nt
    v_mul_f32 v206, v167, v206
    v_mfma_f32_16x16x32_bf16 v[122:125], a[244:247], v[210:213], v[122:125]
    s_mov_b32 s14, s36
    v_mul_f32 v207, v167, v207
    v_cvt_pk_bf16_f32 v166, v206, v207
    v_fma_f32 v184, v130, v130, s33
    v_mfma_f32_16x16x32_bf16 v[122:125], a[248:251], v[114:117], v[122:125]
    ds_read_b128 v[138:141], v120 offset:4608
    v_fmac_f32 v184, v131, v131
    v_fmac_f32 v184, v132, v132
    v_mfma_f32_16x16x32_bf16 v[122:125], a[252:255], v[218:221], v[122:125]
    s_waitcnt lgkmcnt(2)
    v_fmac_f32 v184, v133, v133
    v_mul_f32 v208, v167, v208
    v_mul_f32 v209, v167, v209
    v_mfma_f32_16x16x32_bf16 v[122:125], v[82:85], v[154:157], v[122:125]
    s_barrier
    ds_read_b128 v[146:149], v168 offset:2048
    ds_read_b128 v[150:153], v168 offset:3072
    v_cvt_pk_bf16_f32 v167, v208, v209
    v_mfma_f32_16x16x32_bf16 v[122:125], v[86:89], v[178:181], v[122:125]
    ds_read_b128 v[186:189], v168 offset:4096
    ds_read_b128 v[198:201], v168 offset:5120
    v_rsq_f32 v183, v183
    v_mfma_f32_16x16x32_bf16 v[206:209], v[90:93], v[202:205], 0
    ds_write_b64 v119, v[166:167] offset:5632
    v_mfma_f32_16x16x32_bf16 v[206:209], v[94:97], v[210:213], v[206:209]
    v_mul_f32 v142, v183, v142
    v_mul_f32 v143, v183, v143
    v_fmac_f32 v184, v122, v122
    v_mfma_f32_16x16x32_bf16 v[206:209], v[98:101], v[114:117], v[206:209]
    s_waitcnt lgkmcnt(5)
    buffer_store_dwordx4 v[138:141], v173, s[12:15], s26 offen nt
    ds_read_b64 v[166:167], v121 offset:5632
    v_fmac_f32 v184, v123, v123
    v_fmac_f32 v184, v124, v124
    v_mfma_f32_16x16x32_bf16 v[206:209], v[102:105], v[218:221], v[206:209]
    v_fmac_f32 v184, v125, v125
    v_cvt_pk_bf16_f32 v114, v142, v143
    v_mul_f32 v144, v183, v144
    v_mfma_f32_16x16x32_bf16 v[206:209], v[106:109], v[154:157], v[206:209]
    s_waitcnt lgkmcnt(4)
    v_mul_f32 v145, v183, v145
    v_cvt_pk_bf16_f32 v115, v144, v145
    v_mfma_f32_16x16x32_bf16 v[138:141], v[32:35], v[146:149], 0
    s_waitcnt lgkmcnt(2)
    v_mul_f32 v126, v183, v126
    v_mul_f32 v127, v183, v127
    v_mfma_f32_16x16x32_bf16 v[138:141], v[32:35], v[150:153], v[138:141]
    v_cvt_pk_bf16_f32 v116, v126, v127
    v_mul_f32 v128, v183, v128
    v_mfma_f32_16x16x32_bf16 v[142:145], v[32:35], v[186:189], 0
    v_mul_f32 v129, v183, v129
    v_cvt_pk_bf16_f32 v117, v128, v129
    v_mfma_f32_16x16x32_bf16 v[142:145], v[32:35], v[198:201], v[142:145]
    ds_write_b128 v118, v[114:117] offset:6144
    v_mfma_f32_16x16x32_bf16 v[206:209], v[110:113], v[178:181], v[206:209]
    s_waitcnt lgkmcnt(1)
    buffer_store_dwordx2 v[166:167], v174, s[12:15], s26 offen nt
    v_mul_f32 v214, v183, v214
    v_mul_f32 v215, v183, v215
    v_cvt_pk_bf16_f32 v166, v214, v215
    ds_read_b128 v[114:117], v120 offset:6144
    v_mul_f32 v216, v183, v216
    v_mul_f32 v217, v183, v217
    v_fmac_f32 v184, v206, v206
    v_fmac_f32 v184, v207, v207
    v_fmac_f32 v184, v208, v208
    v_fmac_f32 v184, v209, v209
    v_cvt_pk_bf16_f32 v214, v184, v184
    v_cvt_pk_bf16_f32 v215, v184, v184
    ds_write_b64 v4, v[214:215] offset:6144
    v_cvt_pk_bf16_f32 v167, v216, v217
    v_mul_f32 v174, 0x3baaaaab, v138
    v_rsq_f32 v174, v174
    ds_write_b64 v119, v[166:167] offset:7168
    v_mul_f32 v134, v174, v134
    v_mul_f32 v135, v174, v135
    v_cvt_pk_bf16_f32 v126, v134, v135
    ds_read_b64 v[166:167], v121 offset:7168
    s_waitcnt lgkmcnt(3)
    buffer_store_dwordx4 v[114:117], v175, s[12:15], s26 offen nt
    v_mul_f32 v136, v174, v136
    v_mul_f32 v137, v174, v137
    v_cvt_pk_bf16_f32 v127, v136, v137
    v_mul_f32 v158, v174, v158
    v_mul_f32 v159, v174, v159
    v_cvt_pk_bf16_f32 v128, v158, v159
    v_mul_f32 v160, v174, v160
    s_waitcnt lgkmcnt(2)
    s_barrier
    ds_read_b128 v[114:117], v168 offset:6144
    ds_read_b128 v[134:137], v168 offset:7168
    v_mul_f32 v161, v174, v161
    v_cvt_pk_bf16_f32 v129, v160, v161
    ds_write_b128 v118, v[126:129] offset:0
    v_mul_f32 v222, v174, v222
    v_mul_f32 v223, v174, v223
    v_cvt_pk_bf16_f32 v222, v222, v223
    v_mul_f32 v224, v174, v224
    s_waitcnt lgkmcnt(3)
    buffer_store_dwordx2 v[166:167], v176, s[12:15], s26 offen nt
    ds_read_b128 v[126:129], v120 offset:0
    v_mul_f32 v225, v174, v225
    v_cvt_pk_bf16_f32 v223, v224, v225
    ds_write_b64 v119, v[222:223] offset:1024
    s_waitcnt lgkmcnt(4)
    v_mfma_f32_16x16x32_bf16 v[138:141], v[32:35], v[114:117], 0
    s_waitcnt lgkmcnt(3)
    v_mul_f32 v166, 0x3baaaaab, v142
    v_or3_b32 v162, v162, v163, v164
    v_mfma_f32_16x16x32_bf16 v[138:141], v[32:35], v[134:137], v[138:141]
    ds_read_b64 v[170:171], v121 offset:1024
    v_rsq_f32 v166, v166
    v_or_b32 v162, v162, v165
    v_mul_f32 v190, v166, v190
    v_mul_f32 v191, v166, v191
    v_cvt_pk_bf16_f32 v114, v190, v191
    v_mul_f32 v192, v166, v192
    v_mul_f32 v193, v166, v193
    v_cvt_pk_bf16_f32 v115, v192, v193
    v_mul_f32 v194, v166, v194
    v_mul_f32 v195, v166, v195
    v_cvt_pk_bf16_f32 v116, v194, v195
    s_waitcnt lgkmcnt(2)
    buffer_store_dwordx4 v[126:129], v177, s[12:15], s26 offen nt
    v_mul_f32 v196, v166, v196
    v_mul_f32 v197, v166, v197
    v_cvt_pk_bf16_f32 v117, v196, v197
    ds_write_b128 v118, v[114:117] offset:1536
    v_mul_f32 v230, v166, v230
    s_waitcnt lgkmcnt(1)
    v_mul_f32 v231, v166, v231
    v_cvt_pk_bf16_f32 v230, v230, v231
    v_mul_f32 v232, v166, v232
    v_mul_f32 v233, v166, v233
    buffer_store_dwordx2 v[170:171], v182, s[12:15], s26 offen nt
    ds_read_b128 v[114:117], v120 offset:1536
    v_cvt_pk_bf16_f32 v231, v232, v233
    ds_write_b64 v119, v[230:231] offset:2560
    v_mul_f32 v163, 0x3baaaaab, v138
    v_rsq_f32 v163, v163
    ds_read_b64 v[164:165], v121 offset:2560
    v_mul_f32 v130, v163, v130
    v_mul_f32 v131, v163, v131
    v_cvt_pk_bf16_f32 v118, v130, v131
    v_mul_f32 v132, v163, v132
    v_mul_f32 v133, v163, v133
    v_cvt_pk_bf16_f32 v119, v132, v133
    v_mul_f32 v122, v163, v122
    v_mul_f32 v123, v163, v123
    v_cvt_pk_bf16_f32 v120, v122, v123
    v_mul_f32 v124, v163, v124
    v_mul_f32 v125, v163, v125
    v_cvt_pk_bf16_f32 v121, v124, v125
    buffer_store_dwordx4 v[118:121], v169, s[12:15], 0 offen nt
    s_waitcnt lgkmcnt(2)
    v_mul_f32 v206, v163, v206
    v_mul_f32 v207, v163, v207
    v_cvt_pk_bf16_f32 v170, v206, v207
    v_mul_f32 v208, v163, v208
    v_mul_f32 v209, v163, v209
    v_cvt_pk_bf16_f32 v171, v208, v209
    v_cmp_gt_i32 s[46:47], 0, v162
    s_waitcnt lgkmcnt(0)
    buffer_store_dwordx4 v[114:117], v172, s[12:15], 0 offen nt
    buffer_store_dwordx2 v[164:165], v254, s[12:15], 0 offen nt
    buffer_store_dwordx2 v[170:171], v255, s[12:15], 0 offen nt
    s_branch L_end
.section .rodata,"a"
.p2align 6
.amdhsa_kernel standalone__window_attn_swin_v2__vision_kernel
  .amdhsa_next_free_vgpr 512
  .amdhsa_next_free_sgpr 102
  .amdhsa_accum_offset 256
  .amdhsa_group_segment_fixed_size 0
  .amdhsa_kernarg_size 96
  .amdhsa_user_sgpr_count 2
  .amdhsa_user_sgpr_kernarg_segment_ptr 1
  .amdhsa_system_sgpr_workgroup_id_x 1
  .amdhsa_float_denorm_mode_32 3
.end_amdhsa_kernel
```

```asm
; @launch grid=(256,1,1) block=(256,1,1) lds=163840
.amdgcn_target "amdgcn-amd-amdhsa--gfx950"
.text
.globl standalone__window_attn_swin_v2__vision_kernel
.p2align 12
.p2align 8
.type standalone__window_attn_swin_v2__vision_kernel,@function
standalone__window_attn_swin_v2__vision_kernel:
    s_mov_b32 s44, 0
L_again:
    s_load_dwordx16 s[76:91], s[0:1], 0
    v_readfirstlane_b32 s16, v0
    s_cmp_ge_u32 s2, 256
    s_cbranch_scc1 L_done
    s_lshr_b32 s16, s16, 6
    s_cbranch_scc1 L_nopf
    s_getpc_b64 s[96:97]
    s_bfe_u32 s3, s2, 0x30003
    s_mul_i32 s3, s3, 44
    v_cmp_gt_u32 vcc, 20, v0
    v_add_u32 v114, s3, v0
    v_mov_b32 v115, 0
    v_cndmask_b32 v114, v114, v0, vcc
    v_lshlrev_b32 v114, 7, v114
    v_lshl_add_u64 v[114:115], s[96:97], 0, v[114:115]
    global_load_dword a255, v[114:115], off offset:992
L_nopf:
    s_max_u32 s3, s2, s44
    s_cmp_ge_u32 s3, 247
    s_cbranch_scc1 L_edge
    v_mov_b32 v114, v0
    v_mov_b32 v115, 0x40000000
    v_and_b32 v254, 63, v0
    s_bfe_u32 s3, s2, 0x50003
    s_lshl_b32 s4, s16, 3
    s_lshr_b32 s98, 0x06143a01, s4
    s_and_b32 s98, s98, 0xff
    s_mul_i32 s3, s3, s98
    s_sub_u32 s98, s98, 1
    s_lshr_b32 s4, 0x0048d800, s4
    s_and_b32 s4, s4, 0xff
    s_lshl_b32 s4, s4, 3
    s_max_u32 s4, s4, 6
    s_sub_u32 s4, s4, s98
    s_sub_u32 s4, s4, 1
    s_min_u32 s3, s3, s4
    v_min_u32 v126, s98, v254
    v_add_lshl_u32 v126, v126, s3, 7
    v_mov_b32 v127, 0
    v_lshrrev_b32 v255, 4, v254
    v_and_b32 v128, 15, v254
    s_mov_b32 s10, 100270464
    s_mov_b32 s11, 0x00020000
    s_mov_b32 s50, 36096
    s_mov_b32 s51, 0x00020000
    s_mul_i32 s3, s16, 96
    v_lshl_add_u32 v129, v254, 4, s3
    v_mul_u32_u24 v130, 171, v254
    v_lshrrev_b32 v130, 10, v130
    v_lshrrev_b32 v131, 1, v130
    v_xor_b32 v131, v131, v130
    v_and_b32 v131, 4, v131
    v_mul_u32_u24 v131, 3, v131
    v_xor_b32 v131, v131, v130
    v_mul_u32_u24 v131, 1152, v131
    v_mul_u32_u24 v132, 96, v130
    v_sub_u32 v131, v131, v132
    v_add_u32 v132, v129, v131
    v_add_u32 v131, 64, v254
    v_mul_u32_u24 v131, 171, v131
    v_lshrrev_b32 v131, 10, v131
    v_lshrrev_b32 v133, 1, v131
    v_xor_b32 v133, v133, v131
    v_and_b32 v133, 4, v133
    v_mul_u32_u24 v133, 3, v133
    v_xor_b32 v133, v133, v131
    v_mul_u32_u24 v133, 1152, v133
    v_mul_u32_u24 v150, 96, v131
    v_sub_u32 v133, v133, v150
    v_add_u32 v150, v129, v133
    v_add_u32 v133, 128, v254
    v_mul_u32_u24 v133, 171, v133
    v_lshrrev_b32 v133, 10, v133
    v_lshrrev_b32 v151, 1, v133
    v_xor_b32 v151, v151, v133
    v_and_b32 v151, 4, v151
    v_mul_u32_u24 v151, 3, v151
    v_xor_b32 v151, v151, v133
    v_mul_u32_u24 v151, 1152, v151
    v_mul_u32_u24 v152, 96, v133
    v_sub_u32 v151, v151, v152
    v_add_u32 v152, v129, v151
    s_mul_i32 s68, s16, 6144
    s_add_u32 s69, s68, 65536
    s_cmp_eq_u32 s16, 3
    s_cselect_b32 s68, 149696, s68
    s_cselect_b32 s69, 155840, s69
    s_waitcnt lgkmcnt(0)
    s_cmp_eq_u32 s16, 2
    s_cselect_b64 s[98:99], s[80:81], s[78:79]
    s_cmp_eq_u32 s16, 3
    s_cselect_b64 s[98:99], s[88:89], s[98:99]
    s_mov_b64 s[8:9], s[76:77]
    v_lshl_add_u64 v[126:127], s[98:99], 0, v[126:127]
    s_cmp_eq_u32 s16, 2
    s_cselect_b64 s[98:99], s[84:85], s[82:83]
    s_cmp_eq_u32 s16, 3
    s_cselect_b64 s[98:99], s[86:87], s[98:99]
    v_writelane_b32 v126, s98, 63
    v_writelane_b32 v127, s99, 63
    s_cmp_eq_u32 s16, 0
    s_cbranch_scc1 L_nowu
    global_load_dword a254, v[126:127], off
L_nowu:
    s_mov_b64 s[48:49], s[78:79]
    s_mov_b64 s[52:53], s[80:81]
    s_mov_b64 s[60:61], s[84:85]
    s_mov_b64 s[64:65], s[86:87]
    s_mov_b64 s[56:57], s[88:89]
    s_mov_b64 s[46:47], s[82:83]
    s_load_dwordx4 s[40:43], s[0:1], 72
    s_add_u32 s48, s48, 384
    s_addc_u32 s49, s49, 0
    s_add_u32 m0, s68, 0
    v_lshlrev_b32 v151, 1, v255
    s_mov_b32 s54, 12288
    s_mov_b32 s55, 0x00020000
    s_mov_b32 s62, 64
    s_mov_b32 s63, 0x00020000
    s_mov_b32 s66, 128
    s_mov_b32 s67, 0x00020000
    s_mov_b32 s58, 676
    s_mov_b32 s59, 0x00020000
    s_mov_b32 s14, 0
    s_mov_b32 s15, 0x00020000
    s_mul_i32 s90, s16, 16
    v_mov_b32 v117, 0
    v_cmp_lt_u32 s[92:93], 7, v128
    v_mov_b32 v127, 0
    v_mov_b32 v129, 0
    v_mov_b32 v119, 0
    v_lshlrev_b32 v153, 1, v254
    v_mul_u32_u24 v126, 12, v128
    s_mul_i32 s71, s16, 192
    v_add_u32 v126, s71, v126
    v_lshlrev_b32 v120, 5, v255
    s_mul_i32 s72, s16, 9408
    s_add_u32 s72, s72, 104448
    s_mul_i32 s73, s16, 7616
    s_add_u32 s73, s73, 38912
    s_cmp_eq_u32 s16, 3
    s_cselect_b32 s73, 142080, s73
    s_mov_b32 s70, 193536
    s_mov_b32 s36, 100270464
    s_mov_b32 s22, 1180032
    s_mul_i32 s3, s2, 911
    s_lshr_b32 s3, s3, 16
    s_mul_i32 s35, s3, 72
    s_sub_u32 s38, s2, s35
    s_mul_i32 s3, s3, 1373568
    s_mul_i32 s35, s38, 2688
    s_add_u32 s3, s3, s35
    s_add_u32 s25, s3, 589824
    s_add_u32 s7, s3, 1769472
    s_mov_b32 s20, 31
    s_mov_b32 s21, 4204032
    s_mov_b32 s17, 20
    s_cmp_lt_u32 s2, 240
    s_cselect_b32 s45, 28, 24
    s_bfm_b32 s34, s45, 0
    s_and_b32 s4, s2, 7
    s_sub_u32 s4, 0, s4
    s_lshl_b32 s28, s16, 10
    s_add_u32 s28, s28, 20480
    s_mov_b32 s76, 0x3f80
    s_mul_i32 s79, s16, 64
    s_mul_i32 s80, s16, 32
    s_add_u32 s80, s80, 256
    s_mul_i32 s81, s16, 768
    s_add_u32 s81, s81, 98304
    s_mov_b32 s82, -24
    s_lshr_b32 s83, s16, 1
    s_and_b32 s84, s16, 1
    s_lshl_b32 s84, s84, 3
    s_lshl_b32 s85, s83, 10
    s_add_u32 s85, s85, s84
    s_lshl_b32 s83, s83, 11
    s_add_u32 s83, s83, s84
    s_add_u32 s83, s83, 157888
    s_mul_i32 s86, s16, 2048
    s_add_u32 s86, s86, 149696
    s_mul_i32 s87, s16, 128
    s_add_u32 s87, s87, 61760
    s_mov_b32 s32, 0x2a8cbccc
    s_mov_b32 s33, 0x38fba882
    s_add_u32 s75, s28, 16384
    s_cmp_lt_u32 s16, 2
    s_cselect_b32 s29, s75, 161984
    s_cselect_b32 s30, 65536, 0
    s_xor_b32 s74, s29, s30
    s_mul_i32 s77, s16, 64
    s_mul_i32 s78, s16, 32
    s_add_u32 s78, s78, 192
    buffer_load_dwordx4 v132, s[48:51], 0 offen lds
    v_mul_u32_u24 v116, 2731, v114
    v_bfe_u32 v118, v116, 17, 3
    v_lshrrev_b32 v116, 16, v116
    buffer_load_dwordx4 v150, s[48:51], 0 offen offset:1024 lds
    v_xor_b32 v121, v118, v114
    v_mul_u32_u24 v118, 37, v116
    v_lshrrev_b32 v118, 8, v118
    buffer_load_dwordx4 v152, s[48:51], 0 offen offset:2048 lds
    s_add_u32 m0, s28, 65536
    s_add_u32 s48, s48, 36864
    s_addc_u32 s49, s49, 0
    v_lshlrev_b32 v121, 4, v121
    v_mad_u32_u24 v10, v118, s70, v121
    v_mul_u32_u24 v118, s20, v116
    v_add_u32 v118, s38, v118
    v_mul_u32_u24 v122, 911, v118
    v_lshrrev_b32 v122, 16, v122
    v_mul_u32_u24 v122, s22, v122
    v_mad_u32_u24 v122, v116, s21, v122
    v_bfe_u32 v118, s34, v116, 1
    v_cmp_ne_u32 vcc, 0, v118
    v_add_u32 v118, s7, v122
    v_mul_u32_u24 v116, 384, v116
    v_cndmask_b32 v118, v115, v118, vcc
    v_sub_u32 v116, v121, v116
    v_add_u32 v118, v118, v116
    buffer_load_dwordx4 v118, s[8:11], 0 offen nt lds
    s_add_u32 m0, s28, 69632
    v_add_u32 v116, 256, v114
    v_mul_u32_u24 v118, 2731, v116
    v_bfe_u32 v121, v118, 17, 3
    v_lshrrev_b32 v118, 16, v118
    v_xor_b32 v116, v121, v116
    v_mul_u32_u24 v121, 37, v118
    v_lshrrev_b32 v121, 8, v121
    v_lshlrev_b32 v116, 4, v116
    v_mad_u32_u24 v11, v121, s70, v116
    v_min_u32 v121, 20, v118
    v_add_u32 v122, 12, v118
    v_lshrrev_b32 v122, 5, v122
    v_sub_u32 v123, v118, v121
    v_mad_i32_i24 v123, v122, s4, v123
    v_mul_u32_u24 v124, s20, v121
    v_add3_u32 v124, v124, v123, s38
    v_mul_u32_u24 v122, 911, v124
    v_lshrrev_b32 v122, 16, v122
    v_mul_u32_u24 v122, s22, v122
    v_mad_u32_u24 v122, v121, s21, v122
    v_bfe_u32 v124, s34, v118, 1
    v_cmp_ne_u32 vcc, 0, v124
    v_mul_i32_i24 v123, 2688, v123
    v_add3_u32 v121, v122, v123, s7
    v_cndmask_b32 v121, v115, v121, vcc
    v_mul_u32_u24 v118, 384, v118
    v_sub_u32 v118, v116, v118
    v_add_u32 v121, v121, v118
    buffer_load_dwordx4 v121, s[8:11], 0 offen lds
    s_add_u32 m0, s28, 73728
    v_add_u32 v116, 512, v114
    v_mul_u32_u24 v118, 2731, v116
    v_bfe_u32 v121, v118, 17, 3
    v_lshrrev_b32 v118, 16, v118
    v_xor_b32 v116, v121, v116
    v_mul_u32_u24 v121, 37, v118
    v_lshrrev_b32 v121, 8, v121
    v_lshlrev_b32 v116, 4, v116
    v_mad_u32_u24 v12, v121, s70, v116
    v_min_u32 v121, 20, v118
    v_add_u32 v122, 12, v118
    v_lshrrev_b32 v122, 5, v122
    v_sub_u32 v123, v118, v121
    v_mad_i32_i24 v123, v122, s4, v123
    v_mul_u32_u24 v124, s20, v121
    v_add3_u32 v124, v124, v123, s38
    v_mul_u32_u24 v122, 911, v124
    v_lshrrev_b32 v122, 16, v122
    v_mul_u32_u24 v122, s22, v122
    v_mad_u32_u24 v122, v121, s21, v122
    v_bfe_u32 v124, s34, v118, 1
    v_cmp_ne_u32 vcc, 0, v124
    v_mul_i32_i24 v123, 2688, v123
    v_add3_u32 v121, v122, v123, s7
    v_cndmask_b32 v121, v115, v121, vcc
    v_mul_u32_u24 v118, 384, v118
    v_sub_u32 v118, v116, v118
    v_add_u32 v121, v121, v118
    buffer_load_dwordx4 v121, s[8:11], 0 offen lds
    s_add_u32 m0, s68, 3072
    v_lshrrev_b32 v116, 2, v128
    v_and_b32 v121, 1, v116
    v_mul_u32_u24 v121, 0x020202, v121
    v_lshl_or_b32 v121, v121, 8, v121
    v_add_u32 v121, 0x05040100, v121
    v_and_b32 v118, 3, v128
    v_lshrrev_b32 v122, 1, v128
    v_xor_b32 v122, v122, v255
    v_mul_u32_u24 v123, 384, v128
    v_lshl_add_u32 v0, v122, 4, v123
    v_xor_b32 v1, 64, v0
    v_and_b32 v122, 2, v255
    v_add_u32 v122, v122, v255
    v_lshl_add_u32 v122, v122, 2, v116
    v_mul_u32_u24 v122, 96, v122
    v_lshl_add_u32 v122, v118, 3, v122
    v_add_u32 v123, s68, v122
    buffer_load_dwordx4 v132, s[48:51], 0 offen lds
    v_add_u32 v124, s69, v122
    v_add_u32 v125, s72, v122
    v_add_u32 v122, s73, v122
    v_mul_u32_u24 v134, 768, v255
    v_add_u32 v134, v126, v134
    v_add_u32 v134, 98304, v134
    v_and_b32 v135, 1, v128
    v_lshlrev_b32 v135, 4, v135
    v_lshlrev_b32 v136, v135, s76
    v_mov_b32 v137, 0x3c003c00
    v_mov_b32 v28, 0x3f803f80
    v_mov_b32 v138, 2816
    v_mov_b32 v44, 1.0
    v_lshlrev_b32 v139, 4, v255
    v_lshl_add_u32 v140, v255, 4, s79
    v_lshl_add_u32 v141, v255, 3, s80
    v_add_u32 v142, 0, v128
    v_mul_u32_u24 v143, 37, v142
    buffer_load_dwordx4 v150, s[48:51], 0 offen offset:1024 lds
    v_mul_u32_u24 v144, 384, v142
    v_lshrrev_b32 v143, 8, v143
    v_mad_u32_u24 v144, v143, s70, v144
    v_add_u32 v15, v144, v140
    v_add_u32 v18, v144, v141
    v_add_u32 v144, 16, v128
    v_mul_u32_u24 v145, 37, v144
    v_mul_u32_u24 v146, 384, v144
    v_lshrrev_b32 v145, 8, v145
    v_mad_u32_u24 v146, v145, s70, v146
    v_add_u32 v16, v146, v140
    v_add_u32 v19, v146, v141
    v_add_u32 v146, 32, v128
    v_mul_u32_u24 v147, 37, v146
    v_mul_u32_u24 v148, 384, v146
    v_lshrrev_b32 v147, 8, v147
    v_mad_u32_u24 v148, v147, s70, v148
    v_add_u32 v17, v148, v140
    v_add_u32 v20, v148, v141
    v_mul_u32_u24 v143, 24, v143
    v_lshl_add_u32 v143, v142, 2, v143
    v_add_u32 v22, s81, v143
    v_sub_u32 v23, s81, v143
    v_sub_u32 v140, v22, v139
    v_mul_u32_u24 v141, 24, v145
    v_lshl_add_u32 v141, v144, 2, v141
    v_add_u32 v24, s81, v141
    v_sub_u32 v25, s81, v141
    v_sub_u32 v141, v24, v139
    v_mul_u32_u24 v147, 24, v147
    v_lshl_add_u32 v147, v146, 2, v147
    v_add_u32 v26, s81, v147
    v_sub_u32 v27, s81, v147
    v_sub_u32 v142, v26, v139
    v_mul_u32_u24 v143, 148, v255
    v_add_u32 v144, 0, v143
    v_lshrrev_b32 v144, 8, v144
    v_mad_i32_i24 v46, v144, s82, v140
    v_mad_i32_i24 v58, v144, s82, v141
    v_mad_i32_i24 v70, v144, s82, v142
    v_add_u32 v144, 37, v143
    v_lshrrev_b32 v144, 8, v144
    v_mad_i32_i24 v47, v144, s82, v140
    v_mad_i32_i24 v59, v144, s82, v141
    v_mad_i32_i24 v71, v144, s82, v142
    v_add_u32 v144, 74, v143
    v_lshrrev_b32 v144, 8, v144
    v_mad_i32_i24 v48, v144, s82, v140
    v_mad_i32_i24 v60, v144, s82, v141
    v_mad_i32_i24 v72, v144, s82, v142
    v_add_u32 v144, 111, v143
    v_lshrrev_b32 v144, 8, v144
    v_mad_i32_i24 v49, v144, s82, v140
    v_mad_i32_i24 v61, v144, s82, v141
    v_mad_i32_i24 v73, v144, s82, v142
    v_add_u32 v144, 592, v143
    v_lshrrev_b32 v144, 8, v144
    v_mad_i32_i24 v50, v144, s82, v140
    v_mad_i32_i24 v62, v144, s82, v141
    v_mad_i32_i24 v74, v144, s82, v142
    v_add_u32 v144, 629, v143
    v_lshrrev_b32 v144, 8, v144
    v_mad_i32_i24 v51, v144, s82, v140
    v_mad_i32_i24 v63, v144, s82, v141
    v_mad_i32_i24 v75, v144, s82, v142
    v_add_u32 v144, 666, v143
    v_lshrrev_b32 v144, 8, v144
    v_mad_i32_i24 v52, v144, s82, v140
    v_mad_i32_i24 v64, v144, s82, v141
    v_mad_i32_i24 v76, v144, s82, v142
    v_add_u32 v144, 703, v143
    v_lshrrev_b32 v144, 8, v144
    v_mad_i32_i24 v53, v144, s82, v140
    v_mad_i32_i24 v65, v144, s82, v141
    v_mad_i32_i24 v77, v144, s82, v142
    v_add_u32 v144, 1184, v143
    v_lshrrev_b32 v144, 8, v144
    v_mad_i32_i24 v54, v144, s82, v140
    v_mad_i32_i24 v66, v144, s82, v141
    v_mad_i32_i24 v78, v144, s82, v142
    v_add_u32 v144, 1221, v143
    v_lshrrev_b32 v144, 8, v144
    v_mad_i32_i24 v55, v144, s82, v140
    v_mad_i32_i24 v67, v144, s82, v141
    v_mad_i32_i24 v79, v144, s82, v142
    v_add_u32 v144, 1258, v143
    v_lshrrev_b32 v144, 8, v144
    v_mad_i32_i24 v56, v144, s82, v140
    v_mad_i32_i24 v68, v144, s82, v141
    v_mad_i32_i24 v80, v144, s82, v142
    v_add_u32 v143, 1295, v143
    v_lshrrev_b32 v143, 8, v143
    v_mad_i32_i24 v57, v143, s82, v140
    v_mad_i32_i24 v69, v143, s82, v141
    v_mad_i32_i24 v81, v143, s82, v142
    v_mov_b32 v140, s81
    v_lshlrev_b32 v141, 4, v254
    v_xor_b32 v2, 65536, v141
    v_lshl_add_u32 v3, s16, 10, v141
    v_add_u32 v4, s85, v141
    v_lshl_add_u32 v141, v255, 3, s86
    v_mov_b32 v142, s83
    v_mov_b32 v143, 163264
    v_mul_u32_u24 v144, 80, v255
    v_add3_u32 v154, v144, v135, s72
    v_add_u32 v5, s72, v144
    v_lshl_add_u32 v6, v128, 2, s73
    v_lshrrev_b32 v135, 1, v255
    v_mul_u32_u24 v135, 48, v135
    v_lshl_add_u32 v135, v255, 3, v135
    v_lshl_add_u32 v135, v116, 4, v135
    v_lshl_add_u32 v135, v118, 1, v135
    v_add_u32 v8, s87, v135
    v_mov_b32 v37, 0
    v_mov_b32 v38, 0
    v_mov_b32 v39, 0
    v_add_u32 v155, 86016, v0
    v_add_u32 v156, 86016, v1
    buffer_load_dwordx4 v152, s[48:51], 0 offen offset:2048 lds
    s_add_u32 s48, s48, 36864
    s_addc_u32 s49, s49, 0
    s_add_u32 m0, s69, 0
    v_lshlrev_b32 v157, 4, v128
    v_add_u32 v157, 161984, v157
    v_mul_u32_u24 v135, 336, v128
    v_add3_u32 v135, v135, v144, s72
    v_mul_u32_u24 v144, 272, v128
    v_add3_u32 v144, v144, v139, s73
    v_mul_u32_u24 v158, 1088, v255
    v_add_u32 v158, v158, v6
    v_add_u32 v145, 5376, v135
    v_add_u32 v159, 4352, v144
    v_add_u32 v160, 4352, v158
    v_cmp_gt_u32 s[88:89], 16, v254
    v_mov_b32 v161, 0xf149f2ca
    v_add_u32 v146, 768, v114
    v_mul_u32_u24 v147, 2731, v146
    buffer_load_dwordx4 v132, s[48:51], 0 offen lds
    v_bfe_u32 v148, v147, 17, 3
    v_lshrrev_b32 v147, 16, v147
    v_xor_b32 v146, v148, v146
    v_mul_u32_u24 v148, 37, v147
    v_lshrrev_b32 v148, 8, v148
    v_lshlrev_b32 v146, 4, v146
    v_mad_u32_u24 v13, v148, s70, v146
    v_add_u32 v114, 1024, v114
    v_mul_u32_u24 v146, 2731, v114
    v_bfe_u32 v147, v146, 17, 3
    v_lshrrev_b32 v146, 16, v146
    v_xor_b32 v114, v147, v114
    v_mul_u32_u24 v147, 37, v146
    s_waitcnt vmcnt(7)
    ds_read_b64_tr_b16 a[72:73], v123 offset:0
    ds_read_b64_tr_b16 a[74:75], v123 offset:768
    ds_read_b64_tr_b16 a[96:97], v123 offset:32
    ds_read_b64_tr_b16 a[98:99], v123 offset:800
    ds_read_b64_tr_b16 a[120:121], v123 offset:64
    buffer_load_dwordx4 v150, s[48:51], 0 offen offset:1024 lds
    ds_read_b64_tr_b16 a[122:123], v123 offset:832
    v_lshrrev_b32 v147, 8, v147
    v_lshlrev_b32 v114, 4, v114
    v_mad_u32_u24 v14, v147, s70, v114
    v_cmp_gt_u32 vcc, 48, v146
    v_mul_u32_u24 v114, 6, v130
    v_sub_u32 v146, v254, v114
    v_cndmask_b32 v14, v115, v14, vcc
    v_cmp_gt_u32 vcc, 2, v118
    v_mul_u32_u24 v114, 384, v130
    v_lshl_add_u32 v114, v146, 4, v114
    v_cndmask_b32 v32, 0, v136, vcc
    v_cndmask_b32 v33, v136, 0, vcc
    v_cndmask_b32 v34, 0, v136, vcc
    v_cndmask_b32 v35, v136, 0, vcc
    v_cmp_eq_u32 vcc, 0, v118
    v_add_u32 v115, s78, v114
    v_add_u32 v114, s77, v114
    buffer_load_dwordx4 v152, s[48:51], 0 offen offset:2048 lds
    s_add_u32 s48, s48, 36864
    s_addc_u32 s49, s49, 0
    s_add_u32 m0, s69, 3072
    v_cndmask_b32 v40, 0, v137, vcc
    v_cndmask_b32 v29, 0, v28, vcc
    v_cndmask_b32 v30, 0, v28, vcc
    v_cndmask_b32 v31, 0, v28, vcc
    v_cndmask_b32 v28, 0, v28, vcc
    v_cndmask_b32 v138, v138, 0, vcc
    v_cmp_eq_u32 vcc, 1, v118
    v_add3_u32 v9, v138, v139, s87
    v_mul_u32_u24 v138, 6, v131
    v_cndmask_b32 v41, 0, v137, vcc
    v_cmp_eq_u32 vcc, 2, v118
    v_sub_u32 v136, v254, v138
    v_mul_u32_u24 v138, 384, v131
    v_cndmask_b32 v42, 0, v137, vcc
    v_cmp_eq_u32 vcc, 3, v118
    v_lshl_add_u32 v138, v136, 4, v138
    v_add_u32 v130, s78, v138
    v_cndmask_b32 v43, 0, v137, vcc
    v_cmp_eq_u32 vcc, v255, v116
    v_add_u32 v138, s77, v138
    v_mul_u32_u24 v137, 6, v133
    v_cndmask_b32 v162, 0, v32, vcc
    v_cndmask_b32 v163, 0, v33, vcc
    v_cmp_gt_i32 vcc, 4, v146
    v_sub_u32 v254, v254, v137
    v_mul_u32_u24 v137, 384, v133
    v_cndmask_b32 v164, v115, v114, vcc
    v_cmp_gt_i32 vcc, -60, v136
    v_lshl_add_u32 v137, v254, 4, v137
    v_add_u32 v136, s78, v137
    v_cndmask_b32 v165, v130, v138, vcc
    v_add_u32 v137, s77, v137
    v_cmp_gt_i32 vcc, -124, v254
    v_mul_u32_u24 v138, 96, v128
    v_add3_u32 v254, v138, v139, s68
    v_cndmask_b32 v130, v136, v137, vcc
    v_cmp_gt_u32 vcc, 2, v255
    v_lshl_add_u32 v131, v255, 3, v138
    v_add3_u32 v131, v131, 64, s68
    v_cndmask_b32 v141, v142, v141, vcc
    v_lshl_add_u32 v141, v116, 9, v141
    v_lshl_add_u32 v141, v118, 1, v141
    v_cmp_gt_u32 vcc, 3, v255
    v_add3_u32 v133, v138, v139, s69
    v_lshl_add_u32 v114, v255, 3, v138
    v_cndmask_b32 v7, v143, v141, vcc
    v_cmp_gt_u32 vcc, 12, v128
    v_add3_u32 v114, v114, 64, s69
    v_add_u32 v118, 16, v128
    v_cndmask_b32 v145, v157, v145, vcc
    v_cndmask_b32 v159, v157, v159, vcc
    v_cmp_gt_u32 vcc, 3, v255
    v_cmp_gt_u32 s[94:95], s45, v118
    v_cndmask_b32 v255, v157, v144, s[88:89]
    v_cndmask_b32 v160, v157, v160, vcc
    v_cndmask_b32 v157, v157, v159, s[88:89]
    v_add_u32 v5, 336, v5
    buffer_load_dwordx4 v132, s[48:51], 0 offen lds
    buffer_load_dwordx4 v150, s[48:51], 0 offen offset:1024 lds
    buffer_load_dwordx4 v152, s[48:51], 0 offen offset:2048 lds
    s_waitcnt vmcnt(9)
    s_barrier
    ds_read_b128 v[146:149], v155 offset:6144
    ds_read_b128 v[166:169], v156 offset:6144
    ds_read_b128 v[170:173], v155 offset:6272
    s_add_u32 s48, s48, 36864
    s_addc_u32 s49, s49, 0
    ds_read_b128 v[174:177], v156 offset:6272
    s_add_u32 m0, s72, 0
    ds_read_b128 v[178:181], v155 offset:6400
    ds_read_b128 v[182:185], v156 offset:6400
    ds_read_b128 v[186:189], v155 offset:0
    buffer_load_ushort v116, v153, s[60:63], 0 offen
    s_mov_b64 s[60:61], s[8:9]
    ds_read_b128 v[190:193], v156 offset:0
    ds_read_b128 v[194:197], v155 offset:128
    ds_read_b128 v[198:201], v156 offset:128
    s_waitcnt lgkmcnt(7)
    v_mfma_f32_16x16x32_bf16 v[202:205], a[72:75], v[146:149], 0
    buffer_load_dwordx3 v[206:208], v126, s[56:59], 0 offen
    ds_read_b128 v[210:213], v155 offset:256
    v_mfma_f32_16x16x32_bf16 v[214:217], a[96:99], v[146:149], 0
    s_waitcnt lgkmcnt(7)
    ds_read_b128 v[218:221], v156 offset:256
    v_mfma_f32_16x16x32_bf16 v[222:225], a[120:123], v[146:149], 0
    s_waitcnt lgkmcnt(7)
    s_waitcnt lgkmcnt(5)
    v_mfma_f32_16x16x32_bf16 v[146:149], a[72:75], v[186:189], 0
    v_mfma_f32_16x16x32_bf16 v[226:229], a[96:99], v[186:189], 0
    s_waitcnt vmcnt(8)
    buffer_load_dwordx4 v[230:233], v120, s[64:67], 0 offen
    ds_read_b64_tr_b16 a[76:77], v123 offset:3072
    v_mfma_f32_16x16x32_bf16 v[234:237], a[120:123], v[186:189], 0
    s_mov_b32 s19, s38
    ds_read_b64_tr_b16 a[78:79], v123 offset:3840
    ds_read_b64_tr_b16 a[100:101], v123 offset:3104
    ds_read_b64_tr_b16 a[102:103], v123 offset:3872
    ds_read_b64_tr_b16 a[124:125], v123 offset:3136
    ds_read_b64_tr_b16 a[126:127], v123 offset:3904
    s_mov_b32 s23, s25
    s_mov_b32 s26, 0
    s_mov_b32 s27, 0
    s_mov_b32 s18, 0
    s_add_u32 s19, s19, s20
    s_add_u32 s23, s23, s21
    s_cmp_ge_u32 s19, 72
    s_cselect_b32 s34, 72, 0
    s_cselect_b32 s35, s22, 0
    s_sub_u32 s19, s19, s34
    s_add_u32 s23, s23, s35
    s_mov_b32 s24, s23
    s_add_u32 s19, s19, s20
    s_add_u32 s23, s23, s21
    s_cmp_ge_u32 s19, 72
    s_cselect_b32 s34, 72, 0
    s_cselect_b32 s35, s22, 0
    s_sub_u32 s19, s19, s34
    s_add_u32 s23, s23, s35
    s_sub_u32 s62, s45, s17
    s_sub_u32 s45, s17, 1
    s_bfm_b32 s70, s17, 0
    s_mov_b32 s71, 1
    s_waitcnt lgkmcnt(4)
    v_mfma_f32_16x16x32_bf16 v[202:205], a[76:79], v[166:169], v[202:205]
    s_waitcnt lgkmcnt(2)
    global_load_ushort v151, v151, s[46:47]
    s_and_b32 s77, s2, 0xf8
    v_mfma_f32_16x16x32_bf16 v[214:217], a[100:103], v[166:169], v[214:217]
    s_waitcnt lgkmcnt(0)
    buffer_load_dwordx4 v132, s[48:51], 0 offen lds
    s_add_u32 s77, s77, 4940
    v_mfma_f32_16x16x32_bf16 v[222:225], a[124:127], v[166:169], v[222:225]
    s_mul_i32 s78, s77, 58255
    ds_read_b128 v[166:169], v155 offset:6144
    s_lshr_b32 s78, s78, 22
    v_mfma_f32_16x16x32_bf16 v[146:149], a[76:79], v[190:193], v[146:149]
    s_add_u32 s34, s18, 2
    s_mov_b32 s18, 1
    s_mov_b32 s27, s26
    v_mfma_f32_16x16x32_bf16 v[226:229], a[100:103], v[190:193], v[226:229]
    s_mov_b32 s26, s25
    s_waitcnt vmcnt(8)
    ds_read_b64_tr_b16 a[80:81], v124 offset:0
    v_mfma_f32_16x16x32_bf16 v[234:237], a[124:127], v[190:193], v[234:237]
    s_add_u32 s19, s19, s20
    ds_read_b64_tr_b16 a[82:83], v124 offset:768
    ds_read_b64_tr_b16 a[104:105], v124 offset:32
    ds_read_b64_tr_b16 a[106:107], v124 offset:800
    ds_read_b64_tr_b16 a[128:129], v124 offset:64
    ds_read_b64_tr_b16 a[130:131], v124 offset:832
    buffer_load_dwordx4 v150, s[48:51], 0 offen offset:1024 lds
    buffer_load_dwordx4 v152, s[48:51], 0 offen offset:2048 lds
    s_add_u32 s48, s48, 36864
    s_waitcnt lgkmcnt(4)
    v_mfma_f32_16x16x32_bf16 v[202:205], a[80:83], v[170:173], v[202:205]
    s_waitcnt lgkmcnt(2)
    s_addc_u32 s49, s49, 0
    s_add_u32 m0, s72, 3072
    v_mfma_f32_16x16x32_bf16 v[214:217], a[104:107], v[170:173], v[214:217]
    s_waitcnt lgkmcnt(0)
    s_mov_b32 s72, 2
    v_mfma_f32_16x16x32_bf16 v[222:225], a[128:131], v[170:173], v[222:225]
    ds_read_b128 v[170:173], v156 offset:6144
    v_mfma_f32_16x16x32_bf16 v[146:149], a[80:83], v[194:197], v[146:149]
    v_mfma_f32_16x16x32_bf16 v[226:229], a[104:107], v[194:197], v[226:229]
    buffer_load_dwordx4 v132, s[48:51], 0 offen lds
    s_waitcnt vmcnt(8)
    v_mfma_f32_16x16x32_bf16 v[234:237], a[128:131], v[194:197], v[234:237]
    ds_read_b64_tr_b16 a[84:85], v124 offset:3072
    ds_read_b64_tr_b16 a[86:87], v124 offset:3840
    ds_read_b64_tr_b16 a[108:109], v124 offset:3104
    s_waitcnt vmcnt(6)
    ds_read_b64_tr_b16 a[110:111], v124 offset:3872
    ds_read_b64_tr_b16 a[132:133], v124 offset:3136
    ds_read_b64_tr_b16 a[134:135], v124 offset:3904
    v_bfe_u32 v126, v206, v139, 16
    v_bfe_u32 v128, v207, v139, 16
    v_bfe_u32 v118, v208, v139, 16
    buffer_load_dwordx4 v150, s[48:51], 0 offen offset:1024 lds
    s_waitcnt vmcnt(6)
    v_cndmask_b32 v230, v230, v231, s[92:93]
    v_mfma_f32_16x16x16_bf16 v[206:209], v[116:117], v[126:127], 0
    v_cndmask_b32 v232, v232, v233, s[92:93]
    v_perm_b32 v136, v232, v230, v121
    v_mfma_f32_16x16x16_bf16 v[230:233], v[116:117], v[128:129], 0
    s_nop 0
    s_nop 0
    s_nop 0
    s_waitcnt lgkmcnt(4)
    v_mfma_f32_16x16x32_bf16 v[202:205], a[84:87], v[174:177], v[202:205]
    s_waitcnt lgkmcnt(3)
    v_max_f32 v206, 0, v206
    v_max_f32 v207, 0, v207
    v_mfma_f32_16x16x32_bf16 v[146:149], a[84:87], v[198:201], v[146:149]
    s_waitcnt lgkmcnt(0)
    v_max_f32 v208, 0, v208
    v_max_f32 v209, 0, v209
    v_mfma_f32_16x16x32_bf16 v[214:217], a[108:111], v[174:177], v[214:217]
    buffer_load_dwordx4 v152, s[48:51], 0 offen offset:2048 lds
    v_cvt_pk_bf16_f32 v142, v206, v207
    v_mfma_f32_16x16x32_bf16 v[222:225], a[132:135], v[174:177], v[222:225]
    s_sub_u32 s48, s48, 184704
    ds_read_b128 v[126:129], v155 offset:6272
    v_cvt_pk_bf16_f32 v143, v208, v209
    v_max_f32 v230, 0, v230
    v_mfma_f32_16x16x16_bf16 v[174:177], v[116:117], v[118:119], 0
    v_max_f32 v231, 0, v231
    v_max_f32 v232, 0, v232
    v_max_f32 v233, 0, v233
    v_cvt_pk_bf16_f32 v118, v230, v231
    v_mfma_f32_16x16x32_bf16 v[226:229], a[108:111], v[198:201], v[226:229]
    s_subb_u32 s49, s49, 0
    ds_read_b128 v[206:209], v156 offset:6272
    s_waitcnt vmcnt(6)
    v_mfma_f32_16x16x32_bf16 v[234:237], a[132:135], v[198:201], v[234:237]
    s_add_u32 m0, s73, 0
    v_lshlrev_b32 v151, 16, v151
    buffer_load_dwordx4 v132, s[48:51], 0 offen lds
    v_max_f32 v151, 0xc2c80000, v151
    v_min_f32 v151, 0x40930000, v151
    v_mul_f32 v151, 0x3fb8aa3b, v151
    v_exp_f32 v151, v151
    v_cvt_pk_bf16_f32 v119, v232, v233
    v_cvt_pk_bf16_f32 v151, v151, v151
    v_and_b32 v151, 0xffff0000, v151
    v_mul_f32 v151, 0x3fb8aa3b, v151
    v_mul_f32 v153, 0xbea8f5c3, v151
    v_add_f32 v153, 0xc138aa3b, v153
    v_readlane_b32 s31, v151, s90
    v_max_f32 v174, 0, v174
    v_max_f32 v175, 0, v175
    v_max_f32 v176, 0, v176
    v_max_f32 v177, 0, v177
    v_cvt_pk_bf16_f32 v116, v174, v175
    v_cvt_pk_bf16_f32 v117, v176, v177
    buffer_load_dwordx4 v[174:177], v120, s[64:67], 0 offen offset:16
    buffer_load_dwordx4 v150, s[48:51], 0 offen offset:1024 lds
    buffer_load_dwordx4 v152, s[48:51], 0 offen offset:2048 lds
    s_waitcnt vmcnt(7)
    ds_read_b64_tr_b16 a[88:89], v125 offset:0
    ds_read_b64_tr_b16 a[90:91], v125 offset:768
    ds_read_b64_tr_b16 a[112:113], v125 offset:32
    ds_read_b64_tr_b16 a[114:115], v125 offset:800
    ds_read_b64_tr_b16 a[136:137], v125 offset:64
    ds_read_b64_tr_b16 a[138:139], v125 offset:832
    s_add_u32 s48, s48, 36864
    s_addc_u32 s49, s49, 0
    s_add_u32 m0, s73, 3072
    s_mov_b32 s73, 3
    buffer_load_dwordx4 v132, s[48:51], 0 offen lds
    s_waitcnt lgkmcnt(4)
    v_mfma_f32_16x16x32_bf16 v[202:205], a[88:91], v[178:181], v[202:205]
    s_waitcnt lgkmcnt(3)
    v_mfma_f32_16x16x32_bf16 v[146:149], a[88:91], v[210:213], v[146:149]
    s_waitcnt lgkmcnt(0)
    v_mfma_f32_16x16x32_bf16 v[214:217], a[112:115], v[178:181], v[214:217]
    v_mfma_f32_16x16x32_bf16 v[222:225], a[136:139], v[178:181], v[222:225]
    buffer_load_dwordx4 v150, s[48:51], 0 offen offset:1024 lds
    v_mfma_f32_16x16x32_bf16 v[226:229], a[112:115], v[210:213], v[226:229]
    ds_read_b128 v[178:181], v155 offset:6400
    v_mfma_f32_16x16x32_bf16 v[234:237], a[136:139], v[210:213], v[234:237]
    s_waitcnt vmcnt(6)
    ds_read_b64_tr_b16 a[92:93], v125 offset:3072
    ds_read_b64_tr_b16 a[94:95], v125 offset:3840
    ds_read_b64_tr_b16 a[116:117], v125 offset:3104
    ds_read_b64_tr_b16 a[118:119], v125 offset:3872
    ds_read_b64_tr_b16 a[140:141], v125 offset:3136
    ds_read_b64_tr_b16 a[142:143], v125 offset:3904
    buffer_load_dwordx4 v152, s[48:51], 0 offen offset:2048 lds
    s_add_u32 s48, s48, 36864
    s_addc_u32 s49, s49, 0
    s_add_u32 m0, s68, 0
    v_mov_b32 v230, 0
    v_mov_b32 v231, 0
    v_mov_b32 v232, 0
    v_mov_b32 v233, 0
    ds_write_b16 v8, v230 offset:2816
    v_mov_b32 v238, v161
    v_mov_b32 v239, v161
    v_mov_b32 v240, v161
    v_mov_b32 v241, v161
    buffer_load_dwordx4 v132, s[48:51], 0 offen lds
    s_waitcnt lgkmcnt(5)
    v_mfma_f32_16x16x32_bf16 v[202:205], a[92:95], v[182:185], v[202:205]
    s_waitcnt lgkmcnt(4)
    v_mfma_f32_16x16x32_bf16 v[146:149], a[92:95], v[218:221], v[146:149]
    s_waitcnt lgkmcnt(1)
    v_mfma_f32_16x16x32_bf16 v[214:217], a[116:119], v[182:185], v[214:217]
    v_mfma_f32_16x16x32_bf16 v[222:225], a[140:143], v[182:185], v[222:225]
    v_mfma_f32_16x16x32_bf16 v[226:229], a[116:119], v[218:221], v[226:229]
    s_waitcnt vmcnt(6)
    v_cndmask_b32 v174, v174, v175, s[92:93]
    v_cndmask_b32 v176, v176, v177, s[92:93]
    v_mfma_f32_16x16x32_bf16 v[234:237], a[140:143], v[218:221], v[234:237]
    buffer_load_dwordx4 v150, s[48:51], 0 offen offset:1024 lds
    v_perm_b32 v137, v176, v174, v121
    v_cvt_pk_f16_f32 v174, v202, v203
    v_pk_mul_f16 v139, v174, v174
    v_cvt_pk_f16_f32 v175, v204, v205
    v_pk_fma_f16 v139, v175, v175, v139
    v_cvt_pk_f16_f32 v176, v214, v215
    v_mfma_f32_16x16x16_bf16 v[182:185], v[136:137], v[142:143], 0
    v_pk_fma_f16 v139, v176, v176, v139
    v_cvt_pk_f16_f32 v177, v216, v217
    v_pk_fma_f16 v139, v177, v177, v139
    v_mfma_f32_16x16x16_bf16 v[202:205], v[136:137], v[118:119], 0
    v_cvt_pk_f16_f32 v120, v222, v223
    v_pk_fma_f16 v139, v120, v120, v139
    v_cvt_pk_f16_f32 v121, v224, v225
    v_mfma_f32_16x16x16_bf16 v[214:217], v[136:137], v[116:117], 0
    v_cvt_pk_bf16_f32 v182, v182, v182
    v_and_b32 v182, 0xffff0000, v182
    v_mul_f32 v182, 0xbfb8aa3b, v182
    buffer_load_dwordx4 v152, s[48:51], 0 offen offset:2048 lds
    ds_read_b128 v[222:225], v156 offset:6400
    s_add_u32 s48, s48, 36864
    s_addc_u32 s49, s49, 0
    s_add_u32 m0, s68, 3072
    v_exp_f32 v182, v182
    s_waitcnt vmcnt(6)
    ds_read_b64_tr_b16 a[0:1], v122 offset:0
    ds_read_b64_tr_b16 a[2:3], v122 offset:768
    ds_read_b64_tr_b16 a[24:25], v122 offset:32
    ds_read_b64_tr_b16 a[26:27], v122 offset:800
    ds_read_b64_tr_b16 a[48:49], v122 offset:64
    ds_read_b64_tr_b16 a[50:51], v122 offset:832
    v_add_f32 v182, 1.0, v182
    v_rcp_f32 v182, v182
    v_cvt_pk_bf16_f32 v202, v202, v202
    buffer_load_dwordx4 v132, s[48:51], 0 offen lds
    v_cvt_pk_bf16_f32 v182, v182, v182
    v_and_b32 v182, 0xffff0000, v182
    v_fmamk_f32 v182, v182, 0x41b8aa3b, v153
    ds_write_b32 v134, v182 offset:0
    v_and_b32 v202, 0xffff0000, v202
    v_mul_f32 v202, 0xbfb8aa3b, v202
    v_exp_f32 v202, v202
    v_cvt_pk_bf16_f32 v214, v214, v214
    v_add_f32 v202, 1.0, v202
    v_rcp_f32 v202, v202
    v_and_b32 v214, 0xffff0000, v214
    s_waitcnt lgkmcnt(5)
    v_mfma_f32_16x16x32_bf16 v[182:185], a[0:3], v[186:189], 0
    s_waitcnt lgkmcnt(3)
    v_cvt_pk_bf16_f32 v202, v202, v202
    v_and_b32 v202, 0xffff0000, v202
    v_mfma_f32_16x16x32_bf16 v[242:245], a[24:27], v[186:189], 0
    s_waitcnt lgkmcnt(1)
    buffer_load_dwordx4 v150, s[48:51], 0 offen offset:1024 lds
    v_fmamk_f32 v202, v202, 0x41b8aa3b, v153
    ds_write_b32 v134, v202 offset:4
    v_mul_f32 v214, 0xbfb8aa3b, v214
    v_exp_f32 v214, v214
    v_pk_fma_f16 v139, v121, v121, v139
    v_add_f32 v214, 1.0, v214
    v_rcp_f32 v214, v214
    v_cvt_pk_f16_f32 v146, v146, v147
    v_cvt_pk_bf16_f32 v214, v214, v214
    s_waitcnt vmcnt(5)
    ds_read_b64_tr_b16 a[4:5], v122 offset:3072
    ds_read_b64_tr_b16 a[6:7], v122 offset:3840
    ds_read_b64_tr_b16 a[28:29], v122 offset:3104
    ds_read_b64_tr_b16 a[30:31], v122 offset:3872
    buffer_load_dwordx4 v152, s[48:51], 0 offen offset:2048 lds
    ds_read_b64_tr_b16 a[52:53], v122 offset:3136
    ds_read_b64_tr_b16 a[54:55], v122 offset:3904
    v_mfma_f32_16x16x32_bf16 v[202:205], a[48:51], v[186:189], 0
    s_add_u32 s48, s48, 36864
    ds_write_b128 v135, v[230:233] offset:16
    v_mfma_f32_16x16x32_bf16 v[186:189], a[0:3], v[166:169], 0
    s_addc_u32 s49, s49, 0
    s_add_u32 m0, s69, 0
    v_and_b32 v214, 0xffff0000, v214
    v_fmamk_f32 v214, v214, 0x41b8aa3b, v153
    v_pk_mul_f16 v215, v146, v146
    v_cvt_pk_f16_f32 v147, v148, v149
    ds_write_b32 v134, v214 offset:8
    buffer_load_dwordx4 v132, s[48:51], 0 offen lds
    v_pk_fma_f16 v215, v147, v147, v215
    v_cvt_pk_f16_f32 v148, v226, v227
    v_mfma_f32_16x16x32_bf16 v[246:249], a[24:27], v[166:169], 0
    s_waitcnt lgkmcnt(6)
    v_pk_fma_f16 v215, v148, v148, v215
    v_cvt_pk_f16_f32 v149, v228, v229
    v_mfma_f32_16x16x32_bf16 v[182:185], a[4:7], v[190:193], v[182:185]
    s_waitcnt lgkmcnt(3)
    ds_write_b64 v135, v[230:231] offset:56
    v_mfma_f32_16x16x32_bf16 v[242:245], a[28:31], v[190:193], v[242:245]
    s_waitcnt lgkmcnt(2)
    v_pk_fma_f16 v215, v149, v149, v215
    v_cvt_pk_f16_f32 v228, v234, v235
    v_mfma_f32_16x16x32_bf16 v[202:205], a[52:55], v[190:193], v[202:205]
    ds_write_b64 v135, v[230:231] offset:64
    v_mfma_f32_16x16x32_bf16 v[186:189], a[4:7], v[170:173], v[186:189]
    buffer_load_dwordx4 v150, s[48:51], 0 offen offset:1024 lds
    v_pk_fma_f16 v215, v228, v228, v215
    v_mfma_f32_16x16x32_bf16 v[246:249], a[28:31], v[170:173], v[246:249]
    s_waitcnt lgkmcnt(2)
    ds_write_b128 v145, v[230:233] offset:16
    v_mfma_f32_16x16x32_bf16 v[190:193], a[48:51], v[166:169], 0
    s_barrier
    v_cvt_pk_f16_f32 v229, v236, v237
    v_pk_fma_f16 v215, v229, v229, v215
    v_mfma_f32_16x16x32_bf16 v[190:193], a[52:55], v[170:173], v[190:193]
    s_waitcnt vmcnt(5)
    buffer_load_dwordx4 v152, s[48:51], 0 offen offset:2048 lds
    ds_read_b64_tr_b16 a[8:9], v123 offset:0
    ds_read_b64_tr_b16 a[10:11], v123 offset:768
    ds_read_b64_tr_b16 a[32:33], v123 offset:32
    ds_read_b64_tr_b16 a[34:35], v123 offset:800
    ds_read_b64_tr_b16 a[56:57], v123 offset:64
    ds_read_b64_tr_b16 a[58:59], v123 offset:832
    ds_read_b32 v22, v22 offset:0
    ds_read_b32 v23, v23 offset:672
    s_add_u32 s48, s48, 36864
    ds_read_b32 v24, v24 offset:0
    s_addc_u32 s49, s49, 0
    ds_read_b32 v25, v25 offset:672
    s_add_u32 m0, s69, 3072
    ds_read_b32 v26, v26 offset:0
    ds_read_b32 v27, v27 offset:672
    ds_read_b32 v46, v46 offset:336
    buffer_load_dwordx4 v132, s[48:51], 0 offen lds
    ds_read_b32 v58, v58 offset:336
    ds_read_b32 v70, v70 offset:336
    ds_read_b32 v47, v47 offset:332
    ds_read_b32 v59, v59 offset:332
    ds_read_b32 v71, v71 offset:332
    ds_read_b32 v48, v48 offset:328
    s_waitcnt lgkmcnt(15)
    v_mfma_f32_16x16x32_bf16 v[182:185], a[8:11], v[194:197], v[182:185]
    s_waitcnt lgkmcnt(14)
    ds_read_b32 v60, v60 offset:328
    ds_read_b32 v72, v72 offset:328
    v_mfma_f32_16x16x32_bf16 v[242:245], a[32:35], v[194:197], v[242:245]
    s_waitcnt lgkmcnt(13)
    ds_read_b32 v49, v49 offset:324
    ds_read_b32 v61, v61 offset:324
    v_mfma_f32_16x16x32_bf16 v[202:205], a[56:59], v[194:197], v[202:205]
    s_waitcnt lgkmcnt(13)
    buffer_load_dwordx4 v150, s[48:51], 0 offen offset:1024 lds
    ds_read_b32 v73, v73 offset:324
    v_mfma_f32_16x16x32_bf16 v[186:189], a[8:11], v[126:129], v[186:189]
    s_waitcnt lgkmcnt(12)
    ds_read_b32 v50, v50 offset:272
    ds_read_b32 v62, v62 offset:272
    v_mfma_f32_16x16x32_bf16 v[246:249], a[32:35], v[126:129], v[246:249]
    s_waitcnt lgkmcnt(12)
    ds_read_b32 v74, v74 offset:272
    ds_read_b32 v51, v51 offset:268
    v_mfma_f32_16x16x32_bf16 v[190:193], a[56:59], v[126:129], v[190:193]
    s_waitcnt lgkmcnt(12)
    ds_read_b32 v63, v63 offset:268
    ds_read_b32 v75, v75 offset:268
    ds_read_b32 v52, v52 offset:264
    ds_read_b32 v64, v64 offset:264
    ds_read_b32 v76, v76 offset:264
    ds_read_b32 v53, v53 offset:260
    s_waitcnt vmcnt(5)
    ds_read_b64_tr_b16 a[12:13], v123 offset:3072
    buffer_load_dwordx4 v152, s[48:51], 0 offen offset:2048 lds
    ds_read_b64_tr_b16 a[14:15], v123 offset:3840
    s_add_u32 m0, s28, 0
    ds_read_b64_tr_b16 a[36:37], v123 offset:3104
    s_sub_u32 s48, s48, 183552
    ds_read_b64_tr_b16 a[38:39], v123 offset:3872
    s_subb_u32 s49, s49, 0
    ds_read_b64_tr_b16 a[60:61], v123 offset:3136
    ds_read_b64_tr_b16 a[62:63], v123 offset:3904
    ds_read_b32 v65, v65 offset:260
    ds_read_b32 v77, v77 offset:260
    ds_read_b32 v54, v54 offset:208
    ds_read_b32 v66, v66 offset:208
    ds_read_b32 v78, v78 offset:208
    buffer_load_dwordx4 v10, s[8:11], s25 offen nt lds
    ds_read_b32 v55, v55 offset:204
    ds_read_b32 v67, v67 offset:204
    s_add_u32 m0, s28, 4096
    ds_read_b32 v79, v79 offset:204
    ds_read_b32 v56, v56 offset:200
    ds_read_b32 v68, v68 offset:200
    s_waitcnt lgkmcnt(14)
    v_mfma_f32_16x16x32_bf16 v[182:185], a[12:15], v[198:201], v[182:185]
    s_waitcnt lgkmcnt(13)
    ds_read_b32 v80, v80 offset:200
    ds_read_b32 v57, v57 offset:196
    v_mfma_f32_16x16x32_bf16 v[186:189], a[12:15], v[206:209], v[186:189]
    s_waitcnt lgkmcnt(13)
    ds_read_b32 v69, v69 offset:196
    ds_read_b32 v81, v81 offset:196
    v_mfma_f32_16x16x32_bf16 v[242:245], a[36:39], v[198:201], v[242:245]
    s_waitcnt lgkmcnt(13)
    buffer_load_dwordx4 v11, s[8:11], s25 offen nt lds
    v_mfma_f32_16x16x32_bf16 v[202:205], a[60:63], v[198:201], v[202:205]
    s_add_u32 m0, s28, 8192
    ds_read_b32 v140, v140 offset:336
    v_cndmask_b32 v22, v161, v22, s[88:89]
    v_mfma_f32_16x16x32_bf16 v[246:249], a[36:39], v[206:209], v[246:249]
    s_waitcnt lgkmcnt(10)
    ds_write_b64 v145, v[230:231] offset:56
    v_mfma_f32_16x16x32_bf16 v[190:193], a[60:63], v[206:209], v[190:193]
    v_cndmask_b32 v24, v161, v24, s[88:89]
    v_mov_b32_dpp v23, v25 quad_perm:[0,1,2,3] row_mask:0x2 bank_mask:0xf
    v_cndmask_b32 v26, v161, v26, s[88:89]
    ds_write_b64 v145, v[230:231] offset:64
    s_waitcnt vmcnt(5)
    buffer_load_dwordx4 v12, s[8:11], s25 offen nt lds
    s_add_u32 m0, s28, 12288
    ds_read_b64_tr_b16 a[16:17], v124 offset:0
    ds_read_b64_tr_b16 a[18:19], v124 offset:768
    ds_read_b64_tr_b16 a[40:41], v124 offset:32
    ds_read_b64_tr_b16 a[42:43], v124 offset:800
    ds_read_b64_tr_b16 a[64:65], v124 offset:64
    ds_read_b64_tr_b16 a[66:67], v124 offset:832
    s_waitcnt lgkmcnt(8)
    ds_write_b128 v144, v[238:241] offset:192
    v_readfirstlane_b32 s39, v140
    v_mov_b32_dpp v23, v27 quad_perm:[0,1,2,3] row_mask:0x4 bank_mask:0xf
    buffer_load_dwordx4 v13, s[8:11], s25 offen nt lds
    s_add_u32 m0, s29, 0
    ds_write_b128 v159, v[238:241] offset:192
    s_waitcnt lgkmcnt(6)
    v_mfma_f32_16x16x32_bf16 v[182:185], a[16:19], v[210:213], v[182:185]
    s_waitcnt lgkmcnt(5)
    v_mfma_f32_16x16x32_bf16 v[186:189], a[16:19], v[178:181], v[186:189]
    s_waitcnt lgkmcnt(2)
    v_mfma_f32_16x16x32_bf16 v[242:245], a[40:43], v[210:213], v[242:245]
    buffer_load_dwordx4 v14, s[8:11], s25 offen nt lds
    v_mfma_f32_16x16x32_bf16 v[202:205], a[64:67], v[210:213], v[202:205]
    s_add_u32 m0, s68, 0
    s_lshr_b32 s10, s17, 1
    s_cselect_b32 s10, s36, 0
    v_mfma_f32_16x16x32_bf16 v[246:249], a[40:43], v[178:181], v[246:249]
    s_mov_b32 s25, s24
    v_mfma_f32_16x16x32_bf16 v[190:193], a[64:67], v[178:181], v[190:193]
    s_waitcnt vmcnt(5)
    ds_read_b64_tr_b16 a[20:21], v124 offset:3072
    buffer_load_dwordx4 v132, s[48:51], 0 offen lds
    ds_read_b64_tr_b16 a[22:23], v124 offset:3840
    ds_read_b64_tr_b16 a[44:45], v124 offset:3104
    ds_read_b64_tr_b16 a[46:47], v124 offset:3872
    ds_read_b64_tr_b16 a[68:69], v124 offset:3136
    ds_read_b64_tr_b16 a[70:71], v124 offset:3904
    buffer_load_dwordx4 v150, s[48:51], 0 offen offset:1024 lds
    s_waitcnt lgkmcnt(4)
    v_mfma_f32_16x16x32_bf16 v[182:185], a[20:23], v[218:221], v[182:185]
    s_waitcnt lgkmcnt(3)
    v_mfma_f32_16x16x32_bf16 v[186:189], a[20:23], v[222:225], v[186:189]
    s_waitcnt lgkmcnt(0)
    v_mfma_f32_16x16x32_bf16 v[242:245], a[44:47], v[218:221], v[242:245]
    v_mfma_f32_16x16x32_bf16 v[202:205], a[68:71], v[218:221], v[202:205]
    buffer_load_dwordx4 v152, s[48:51], 0 offen offset:2048 lds
    s_add_u32 s48, s48, 36864
    v_mfma_f32_16x16x32_bf16 v[246:249], a[44:47], v[222:225], v[246:249]
    s_addc_u32 s49, s49, 0
    v_cvt_pk_f16_f32 v126, v182, v183
    v_pk_mul_f16 v214, v126, v126
    v_mfma_f32_16x16x32_bf16 v[190:193], a[68:71], v[222:225], v[190:193]
    s_add_u32 m0, s68, 3072
    v_cvt_pk_f16_f32 v127, v184, v185
    v_pk_fma_f16 v214, v127, v127, v214
    v_cvt_pk_f16_f32 v128, v242, v243
    v_pk_fma_f16 v214, v128, v128, v214
    v_cvt_pk_f16_f32 v129, v244, v245
    v_pk_fma_f16 v214, v129, v129, v214
    v_cvt_pk_f16_f32 v226, v202, v203
    v_pk_fma_f16 v214, v226, v226, v214
    v_cvt_pk_f16_f32 v227, v204, v205
    v_pk_fma_f16 v214, v227, v227, v214
    v_pk_mul_f16 v216, v126, v146
    buffer_load_dwordx4 v132, s[48:51], 0 offen lds
    v_pk_fma_f16 v216, v127, v147, v216
    v_pk_fma_f16 v216, v128, v148, v216
    v_pk_fma_f16 v216, v129, v149, v216
    v_pk_fma_f16 v216, v226, v228, v216
    v_pk_fma_f16 v216, v227, v229, v216
    v_mov_b32 v217, v214
    v_cvt_pk_f16_f32 v166, v186, v187
    v_pk_mul_f16 v138, v166, v166
    v_mfma_f32_16x16x32_f16 v[170:173], v[40:43], v[214:217], 0
    v_cvt_pk_f16_f32 v167, v188, v189
    v_pk_fma_f16 v138, v167, v167, v138
    v_cvt_pk_f16_f32 v168, v246, v247
    v_pk_fma_f16 v138, v168, v168, v138
    v_cvt_pk_f16_f32 v169, v248, v249
    v_pk_fma_f16 v138, v169, v169, v138
    v_cvt_pk_f16_f32 v118, v190, v191
    v_pk_fma_f16 v138, v118, v118, v138
    v_rsq_f32 v170, v170
    v_rsq_f32 v171, v171
    v_mul_f32 v140, s31, v170
    v_cvt_pk_f16_f32 v141, v140, v171
    v_pk_mul_f16 v146, v146, v141 op_sel:[0,1] op_sel_hi:[1,1]
    v_pk_mul_f16 v147, v147, v141 op_sel:[0,1] op_sel_hi:[1,1]
    v_pk_mul_f16 v148, v148, v141 op_sel:[0,1] op_sel_hi:[1,1]
    v_pk_mul_f16 v149, v149, v141 op_sel:[0,1] op_sel_hi:[1,1]
    v_pk_mul_f16 v228, v228, v141 op_sel:[0,1] op_sel_hi:[1,1]
    v_pk_mul_f16 v229, v229, v141 op_sel:[0,1] op_sel_hi:[1,1]
    v_pk_mul_f16 v126, v126, v141 op_sel:[0,0] op_sel_hi:[1,0]
    v_pk_mul_f16 v127, v127, v141 op_sel:[0,0] op_sel_hi:[1,0]
    v_pk_mul_f16 v128, v128, v141 op_sel:[0,0] op_sel_hi:[1,0]
    v_pk_mul_f16 v129, v129, v141 op_sel:[0,0] op_sel_hi:[1,0]
    v_pk_mul_f16 v226, v226, v141 op_sel:[0,0] op_sel_hi:[1,0]
    v_pk_mul_f16 v227, v227, v141 op_sel:[0,0] op_sel_hi:[1,0]
    v_max3_u32 v44, v44, v170, v171
    v_mul_f32 v119, v172, v140
    v_fma_f32 v119, v119, v171, s39
    ds_write_b32 v255, v119 offset:192
    v_cvt_pk_f16_f32 v119, v192, v193
    v_pk_fma_f16 v138, v119, v119, v138
    v_pk_mul_f16 v140, v166, v174
    v_pk_fma_f16 v140, v167, v175, v140
    ds_write_b128 v135, v[146:149]
    v_pk_fma_f16 v140, v168, v176, v140
    v_pk_fma_f16 v140, v169, v177, v140
    v_pk_fma_f16 v140, v118, v120, v140
    v_pk_fma_f16 v140, v119, v121, v140
    v_mov_b32 v141, v138
    s_nop 0
    s_nop 0
    v_mfma_f32_16x16x32_f16 v[146:149], v[40:43], v[138:141], 0
    ds_write_b64 v135, v[228:229] offset:48
    s_nop 0
    s_nop 0
    s_nop 0
    ds_write_b128 v135, v[126:129] offset:32
    s_nop 0
    s_nop 0
    s_nop 0
    v_rsq_f32 v146, v146
    v_rsq_f32 v147, v147
    ds_write_b64 v135, v[226:227] offset:72
    v_mul_f32 v116, s31, v146
    v_cvt_pk_f16_f32 v117, v116, v147
    v_pk_mul_f16 v174, v174, v117 op_sel:[0,1] op_sel_hi:[1,1]
    v_pk_mul_f16 v175, v175, v117 op_sel:[0,1] op_sel_hi:[1,1]
    v_pk_mul_f16 v176, v176, v117 op_sel:[0,1] op_sel_hi:[1,1]
    v_pk_mul_f16 v177, v177, v117 op_sel:[0,1] op_sel_hi:[1,1]
    v_pk_mul_f16 v120, v120, v117 op_sel:[0,1] op_sel_hi:[1,1]
    v_pk_mul_f16 v121, v121, v117 op_sel:[0,1] op_sel_hi:[1,1]
    v_pk_mul_f16 v166, v166, v117 op_sel:[0,0] op_sel_hi:[1,0]
    v_pk_mul_f16 v167, v167, v117 op_sel:[0,0] op_sel_hi:[1,0]
    v_pk_mul_f16 v168, v168, v117 op_sel:[0,0] op_sel_hi:[1,0]
    v_pk_mul_f16 v169, v169, v117 op_sel:[0,0] op_sel_hi:[1,0]
    v_pk_mul_f16 v118, v118, v117 op_sel:[0,0] op_sel_hi:[1,0]
    v_pk_mul_f16 v119, v119, v117 op_sel:[0,0] op_sel_hi:[1,0]
    v_cndmask_b32 v146, 1.0, v146, s[94:95]
    v_cndmask_b32 v147, 1.0, v147, s[94:95]
    v_max3_u32 v44, v44, v146, v147
    v_mul_f32 v255, v148, v116
    v_fma_f32 v255, v255, v147, s39
    ds_write_b32 v157, v255 offset:192
    buffer_load_dwordx4 v150, s[48:51], 0 offen offset:1024 lds
    ds_write_b128 v145, v[174:177]
    buffer_load_dwordx4 v152, s[48:51], 0 offen offset:2048 lds
    ds_write_b64 v145, v[120:121] offset:48
    s_add_u32 s48, s48, 36864
    s_addc_u32 s49, s49, 0
    s_add_u32 m0, s69, 0
    ds_write_b128 v145, v[166:169] offset:32
    buffer_load_dwordx4 v132, s[48:51], 0 offen lds
    ds_write_b64 v145, v[118:119] offset:72
    buffer_load_dwordx4 v150, s[48:51], 0 offen offset:1024 lds
    buffer_load_dwordx4 v152, s[48:51], 0 offen offset:2048 lds
    s_waitcnt vmcnt(9)
    s_barrier
    ds_read_b128 v[126:129], v0 offset:20480
    ds_read_b128 v[170:173], v1 offset:20480
    ds_read_b128 v[174:177], v0 offset:20608
    s_add_u32 s48, s48, 36864
    s_addc_u32 s49, s49, 0
    ds_read_b128 v[178:181], v1 offset:20608
    s_add_u32 m0, s69, 3072
    ds_read_b128 v[182:185], v0 offset:20736
    ds_read_b128 v[186:189], v1 offset:20736
    buffer_load_dwordx4 v132, s[48:51], 0 offen lds
    s_waitcnt lgkmcnt(5)
    v_mfma_f32_16x16x32_bf16 v[118:121], a[72:75], v[126:129], 0
    s_waitcnt lgkmcnt(4)
    v_mfma_f32_16x16x32_bf16 v[118:121], a[76:79], v[170:173], v[118:121]
    s_waitcnt lgkmcnt(2)
    v_mfma_f32_16x16x32_bf16 v[118:121], a[80:83], v[174:177], v[118:121]
    s_waitcnt lgkmcnt(1)
    v_mfma_f32_16x16x32_bf16 v[118:121], a[84:87], v[178:181], v[118:121]
    s_waitcnt lgkmcnt(0)
    buffer_load_dwordx4 v150, s[48:51], 0 offen offset:1024 lds
    v_mfma_f32_16x16x32_bf16 v[118:121], a[88:91], v[182:185], v[118:121]
    v_mfma_f32_16x16x32_bf16 v[118:121], a[92:95], v[186:189], v[118:121]
    v_mfma_f32_16x16x32_bf16 v[190:193], a[96:99], v[126:129], 0
    s_waitcnt vmcnt(8)
    ds_read_b64_tr_b16 a[144:145], v123 offset:0
    ds_read_b64_tr_b16 a[146:147], v123 offset:768
    v_mfma_f32_16x16x32_bf16 v[190:193], a[100:103], v[170:173], v[190:193]
    ds_read_b64_tr_b16 a[168:169], v123 offset:32
    ds_read_b64_tr_b16 a[170:171], v123 offset:800
    v_mfma_f32_16x16x32_bf16 v[190:193], a[104:107], v[174:177], v[190:193]
    ds_read_b64_tr_b16 a[192:193], v123 offset:64
    buffer_load_dwordx4 v152, s[48:51], 0 offen offset:2048 lds
    v_mfma_f32_16x16x32_bf16 v[190:193], a[108:111], v[178:181], v[190:193]
    s_add_u32 s48, s48, 36864
    ds_read_b64_tr_b16 a[194:195], v123 offset:832
    v_cvt_pk_f16_f32 v146, v118, v119
    v_mfma_f32_16x16x32_bf16 v[190:193], a[112:115], v[182:185], v[190:193]
    s_addc_u32 s49, s49, 0
    v_pk_mul_f16 v143, v146, v146
    v_cvt_pk_f16_f32 v147, v120, v121
    v_mfma_f32_16x16x32_bf16 v[190:193], a[116:119], v[186:189], v[190:193]
    s_add_u32 m0, s68, 0
    v_pk_fma_f16 v143, v147, v147, v143
    v_mfma_f32_16x16x32_bf16 v[198:201], a[120:123], v[126:129], 0
    v_mfma_f32_16x16x32_bf16 v[198:201], a[124:127], v[170:173], v[198:201]
    v_mfma_f32_16x16x32_bf16 v[198:201], a[128:131], v[174:177], v[198:201]
    s_waitcnt lgkmcnt(4)
    v_mfma_f32_16x16x32_bf16 v[198:201], a[132:135], v[178:181], v[198:201]
    s_waitcnt lgkmcnt(2)
    v_cvt_pk_f16_f32 v148, v190, v191
    v_pk_fma_f16 v143, v148, v148, v143
    v_mfma_f32_16x16x32_bf16 v[198:201], a[136:139], v[182:185], v[198:201]
    s_waitcnt lgkmcnt(1)
    ds_read_b128 v[194:197], v0 offset:26624
    v_cvt_pk_f16_f32 v149, v192, v193
    v_mfma_f32_16x16x32_bf16 v[198:201], a[140:143], v[186:189], v[198:201]
    s_waitcnt lgkmcnt(1)
    buffer_load_dwordx4 v132, s[48:51], 0 offen lds
    ds_read_b128 v[190:193], v1 offset:26624
    v_mfma_f32_16x16x32_bf16 v[138:141], a[0:3], v[126:129], 0
    ds_read_b128 v[202:205], v0 offset:26752
    s_waitcnt vmcnt(7)
    v_mfma_f32_16x16x32_bf16 v[138:141], a[4:7], v[170:173], v[138:141]
    ds_read_b64_tr_b16 a[148:149], v123 offset:3072
    ds_read_b64_tr_b16 a[150:151], v123 offset:3840
    v_mfma_f32_16x16x32_bf16 v[138:141], a[8:11], v[174:177], v[138:141]
    ds_read_b64_tr_b16 a[172:173], v123 offset:3104
    ds_read_b64_tr_b16 a[174:175], v123 offset:3872
    v_mfma_f32_16x16x32_bf16 v[138:141], a[12:15], v[178:181], v[138:141]
    ds_read_b64_tr_b16 a[196:197], v123 offset:3136
    ds_read_b64_tr_b16 a[198:199], v123 offset:3904
    v_mfma_f32_16x16x32_bf16 v[138:141], a[16:19], v[182:185], v[138:141]
    ds_read_b128 v[206:209], v1 offset:26752
    buffer_load_dwordx4 v150, s[48:51], 0 offen offset:1024 lds
    v_mfma_f32_16x16x32_bf16 v[138:141], a[20:23], v[186:189], v[138:141]
    ds_read_b128 v[210:213], v0 offset:26880
    ds_read_b128 v[214:217], v1 offset:26880
    v_mfma_f32_16x16x32_bf16 v[166:169], a[24:27], v[126:129], 0
    s_waitcnt lgkmcnt(11)
    v_pk_fma_f16 v143, v149, v149, v143
    v_cvt_pk_f16_f32 v120, v198, v199
    v_mfma_f32_16x16x32_bf16 v[166:169], a[28:31], v[170:173], v[166:169]
    s_waitcnt lgkmcnt(10)
    v_pk_fma_f16 v143, v120, v120, v143
    v_cvt_pk_f16_f32 v121, v200, v201
    v_mfma_f32_16x16x32_bf16 v[166:169], a[32:35], v[174:177], v[166:169]
    s_waitcnt lgkmcnt(9)
    v_pk_fma_f16 v143, v121, v121, v143
    v_cvt_pk_f16_f32 v138, v138, v139
    v_mfma_f32_16x16x32_bf16 v[166:169], a[36:39], v[178:181], v[166:169]
    s_waitcnt lgkmcnt(7)
    v_pk_mul_f16 v142, v138, v138
    v_cvt_pk_f16_f32 v139, v140, v141
    v_mfma_f32_16x16x32_bf16 v[166:169], a[40:43], v[182:185], v[166:169]
    s_waitcnt lgkmcnt(5)
    buffer_load_dwordx4 v152, s[48:51], 0 offen offset:2048 lds
    v_pk_fma_f16 v142, v139, v139, v142
    v_mfma_f32_16x16x32_bf16 v[166:169], a[44:47], v[186:189], v[166:169]
    s_add_u32 s48, s48, 36864
    s_addc_u32 s49, s49, 0
    s_add_u32 m0, s68, 3072
    v_mfma_f32_16x16x32_bf16 v[134:137], a[48:51], v[126:129], 0
    s_waitcnt lgkmcnt(2)
    v_mfma_f32_16x16x32_bf16 v[134:137], a[52:55], v[170:173], v[134:137]
    s_waitcnt vmcnt(6)
    ds_read_b64_tr_b16 a[152:153], v124 offset:0
    ds_read_b64_tr_b16 a[154:155], v124 offset:768
    v_mfma_f32_16x16x32_bf16 v[134:137], a[56:59], v[174:177], v[134:137]
    s_waitcnt lgkmcnt(2)
    ds_read_b64_tr_b16 a[176:177], v124 offset:32
    ds_read_b64_tr_b16 a[178:179], v124 offset:800
    v_mfma_f32_16x16x32_bf16 v[134:137], a[60:63], v[178:181], v[134:137]
    ds_read_b64_tr_b16 a[200:201], v124 offset:64
    buffer_load_dwordx4 v132, s[48:51], 0 offen lds
    v_mfma_f32_16x16x32_bf16 v[134:137], a[64:67], v[182:185], v[134:137]
    ds_read_b64_tr_b16 a[202:203], v124 offset:832
    ds_read_b128 v[126:129], v0 offset:32768
    v_mfma_f32_16x16x32_bf16 v[134:137], a[68:71], v[186:189], v[134:137]
    ds_read_b128 v[170:173], v1 offset:32768
    v_cvt_pk_f16_f32 v140, v166, v167
    v_mfma_f32_16x16x32_bf16 v[174:177], a[72:75], v[194:197], 0
    ds_read_b128 v[178:181], v0 offset:32896
    v_pk_fma_f16 v142, v140, v140, v142
    v_mfma_f32_16x16x32_bf16 v[174:177], a[76:79], v[190:193], v[174:177]
    ds_read_b128 v[182:185], v1 offset:32896
    v_cvt_pk_f16_f32 v141, v168, v169
    v_mfma_f32_16x16x32_bf16 v[174:177], a[80:83], v[202:205], v[174:177]
    ds_read_b128 v[166:169], v0 offset:33024
    v_pk_fma_f16 v142, v141, v141, v142
    v_mfma_f32_16x16x32_bf16 v[174:177], a[84:87], v[206:209], v[174:177]
    s_waitcnt lgkmcnt(9)
    buffer_load_dwordx4 v150, s[48:51], 0 offen offset:1024 lds
    ds_read_b128 v[186:189], v1 offset:33024
    v_mfma_f32_16x16x32_bf16 v[174:177], a[88:91], v[210:213], v[174:177]
    s_waitcnt lgkmcnt(8)
    v_cvt_pk_f16_f32 v118, v134, v135
    v_pk_fma_f16 v142, v118, v118, v142
    v_mfma_f32_16x16x32_bf16 v[174:177], a[92:95], v[214:217], v[174:177]
    s_waitcnt lgkmcnt(7)
    v_cvt_pk_f16_f32 v119, v136, v137
    v_pk_fma_f16 v142, v119, v119, v142
    v_mfma_f32_16x16x32_bf16 v[134:137], a[96:99], v[194:197], 0
    s_waitcnt lgkmcnt(5)
    v_mov_b32 v144, v142
    v_mov_b32 v145, v142
    v_mfma_f32_16x16x32_bf16 v[134:137], a[100:103], v[190:193], v[134:137]
    s_waitcnt lgkmcnt(4)
    v_cvt_pk_f16_f32 v150, v174, v175
    v_pk_mul_f16 v175, v150, v150
    v_mfma_f32_16x16x32_f16 v[198:201], v[40:43], v[142:145], 0
    s_waitcnt vmcnt(5)
    ds_read_b64_tr_b16 a[156:157], v124 offset:3072
    buffer_load_dwordx4 v152, s[48:51], 0 offen offset:2048 lds
    v_mfma_f32_16x16x32_bf16 v[134:137], a[104:107], v[202:205], v[134:137]
    s_add_u32 m0, s69, 0
    ds_read_b64_tr_b16 a[158:159], v124 offset:3840
    ds_read_b64_tr_b16 a[180:181], v124 offset:3104
    v_mfma_f32_16x16x32_bf16 v[134:137], a[108:111], v[206:209], v[134:137]
    s_waitcnt lgkmcnt(4)
    ds_read_b64_tr_b16 a[182:183], v124 offset:3872
    ds_read_b64_tr_b16 a[204:205], v124 offset:3136
    v_mfma_f32_16x16x32_bf16 v[134:137], a[112:115], v[210:213], v[134:137]
    s_waitcnt lgkmcnt(5)
    ds_read_b64_tr_b16 a[206:207], v124 offset:3904
    v_cvt_pk_f16_f32 v151, v176, v177
    v_mfma_f32_16x16x32_bf16 v[134:137], a[116:119], v[214:217], v[134:137]
    v_rsq_f32 v198, v198
    v_mfma_f32_16x16x32_bf16 v[142:145], a[120:123], v[194:197], 0
    v_rsq_f32 v199, v199
    v_mfma_f32_16x16x32_bf16 v[142:145], a[124:127], v[190:193], v[142:145]
    buffer_load_dwordx4 v164, s[52:55], 0 offen lds
    v_mul_f32 v152, s31, v198
    v_mfma_f32_16x16x32_bf16 v[142:145], a[128:131], v[202:205], v[142:145]
    v_cvt_pk_f16_f32 v153, v152, v199
    v_pk_mul_f16 v146, v146, v153 op_sel:[0,1] op_sel_hi:[1,1]
    v_mfma_f32_16x16x32_bf16 v[142:145], a[132:135], v[206:209], v[142:145]
    s_waitcnt lgkmcnt(5)
    v_pk_mul_f16 v147, v147, v153 op_sel:[0,1] op_sel_hi:[1,1]
    v_pk_mul_f16 v148, v148, v153 op_sel:[0,1] op_sel_hi:[1,1]
    v_mfma_f32_16x16x32_bf16 v[142:145], a[136:139], v[210:213], v[142:145]
    s_waitcnt lgkmcnt(3)
    ds_read_b128 v[190:193], v155 offset:6144
    v_pk_mul_f16 v149, v149, v153 op_sel:[0,1] op_sel_hi:[1,1]
    v_mfma_f32_16x16x32_bf16 v[142:145], a[140:143], v[214:217], v[142:145]
    s_waitcnt lgkmcnt(2)
    ds_read_b128 v[194:197], v156 offset:6144
    v_pk_mul_f16 v120, v120, v153 op_sel:[0,1] op_sel_hi:[1,1]
    v_mfma_f32_16x16x32_bf16 v[202:205], a[72:75], v[126:129], 0
    s_waitcnt lgkmcnt(2)
    ds_read_b128 v[206:209], v155 offset:6272
    buffer_load_dwordx4 v165, s[52:55], 0 offen offset:1024 lds
    v_mfma_f32_16x16x32_bf16 v[202:205], a[76:79], v[170:173], v[202:205]
    ds_read_b128 v[210:213], v156 offset:6272
    v_pk_mul_f16 v121, v121, v153 op_sel:[0,1] op_sel_hi:[1,1]
    v_mfma_f32_16x16x32_bf16 v[202:205], a[80:83], v[178:181], v[202:205]
    ds_read_b128 v[214:217], v155 offset:6400
    v_pk_mul_f16 v138, v138, v153 op_sel:[0,0] op_sel_hi:[1,0]
    v_mfma_f32_16x16x32_bf16 v[202:205], a[84:87], v[182:185], v[202:205]
    ds_read_b128 v[218:221], v156 offset:6400
    v_pk_mul_f16 v139, v139, v153 op_sel:[0,0] op_sel_hi:[1,0]
    v_mfma_f32_16x16x32_bf16 v[202:205], a[88:91], v[166:169], v[202:205]
    v_pk_mul_f16 v140, v140, v153 op_sel:[0,0] op_sel_hi:[1,0]
    s_waitcnt vmcnt(5)
    v_mfma_f32_16x16x32_bf16 v[202:205], a[92:95], v[186:189], v[202:205]
    ds_read_b64_tr_b16 a[160:161], v123 offset:0
    ds_read_b64_tr_b16 a[162:163], v123 offset:768
    v_mfma_f32_16x16x32_bf16 v[222:225], a[96:99], v[126:129], 0
    s_waitcnt lgkmcnt(7)
    buffer_load_dwordx4 v130, s[52:55], 0 offen offset:2048 lds
    ds_read_b64_tr_b16 a[184:185], v123 offset:32
    v_mfma_f32_16x16x32_bf16 v[222:225], a[100:103], v[170:173], v[222:225]
    s_add_u32 s52, s52, 12288
    ds_read_b64_tr_b16 a[186:187], v123 offset:800
    ds_read_b64_tr_b16 a[208:209], v123 offset:64
    v_mfma_f32_16x16x32_bf16 v[222:225], a[104:107], v[178:181], v[222:225]
    s_addc_u32 s53, s53, 0
    ds_read_b64_tr_b16 a[210:211], v123 offset:832
    v_pk_mul_f16 v141, v141, v153 op_sel:[0,0] op_sel_hi:[1,0]
    v_mfma_f32_16x16x32_bf16 v[222:225], a[108:111], v[182:185], v[222:225]
    s_add_u32 m0, s69, 3072
    v_pk_mul_f16 v118, v118, v153 op_sel:[0,0] op_sel_hi:[1,0]
    v_pk_mul_f16 v119, v119, v153 op_sel:[0,0] op_sel_hi:[1,0]
    v_mfma_f32_16x16x32_bf16 v[222:225], a[112:115], v[166:169], v[222:225]
    s_waitcnt lgkmcnt(7)
    v_max3_u32 v44, v44, v198, v199
    v_pk_fma_f16 v175, v151, v151, v175
    v_mfma_f32_16x16x32_bf16 v[222:225], a[116:119], v[186:189], v[222:225]
    s_waitcnt lgkmcnt(6)
    v_cvt_pk_f16_f32 v152, v134, v135
    v_pk_fma_f16 v175, v152, v152, v175
    v_mfma_f32_16x16x32_bf16 v[198:201], a[120:123], v[126:129], 0
    buffer_load_dwordx4 v164, s[52:55], 0 offen lds
    v_cvt_pk_f16_f32 v153, v136, v137
    v_mfma_f32_16x16x32_bf16 v[198:201], a[124:127], v[170:173], v[198:201]
    s_waitcnt lgkmcnt(4)
    v_pk_fma_f16 v175, v153, v153, v175
    v_cvt_pk_f16_f32 v124, v142, v143
    v_mfma_f32_16x16x32_bf16 v[198:201], a[128:131], v[178:181], v[198:201]
    s_waitcnt lgkmcnt(3)
    v_pk_fma_f16 v175, v124, v124, v175
    v_cvt_pk_f16_f32 v125, v144, v145
    v_mfma_f32_16x16x32_bf16 v[198:201], a[132:135], v[182:185], v[198:201]
    s_waitcnt lgkmcnt(1)
    v_pk_fma_f16 v175, v125, v125, v175
    v_cvt_pk_f16_f32 v126, v202, v203
    v_mfma_f32_16x16x32_bf16 v[198:201], a[136:139], v[166:169], v[198:201]
    s_waitcnt lgkmcnt(0)
    ds_read_b128 v[134:137], v155 offset:0
    v_pk_mul_f16 v115, v126, v126
    v_mfma_f32_16x16x32_bf16 v[198:201], a[140:143], v[186:189], v[198:201]
    ds_read_b128 v[142:145], v156 offset:0
    buffer_load_dwordx4 v165, s[52:55], 0 offen offset:1024 lds
    v_mfma_f32_16x16x32_bf16 v[166:169], v[190:193], a[144:147], 0
    ds_read_b128 v[170:173], v155 offset:128
    v_cvt_pk_f16_f32 v127, v204, v205
    v_mfma_f32_16x16x32_bf16 v[166:169], v[194:197], a[148:151], v[166:169]
    ds_read_b128 v[178:181], v156 offset:128
    v_pk_fma_f16 v115, v127, v127, v115
    v_mfma_f32_16x16x32_bf16 v[166:169], v[206:209], a[152:155], v[166:169]
    ds_read_b128 v[182:185], v155 offset:256
    v_cvt_pk_f16_f32 v128, v222, v223
    s_waitcnt vmcnt(5)
    v_mfma_f32_16x16x32_bf16 v[166:169], v[210:213], a[156:159], v[166:169]
    ds_read_b64_tr_b16 a[164:165], v123 offset:3072
    ds_read_b64_tr_b16 a[166:167], v123 offset:3840
    v_mfma_f32_16x16x32_bf16 v[166:169], v[214:217], a[160:163], v[166:169]
    ds_read_b64_tr_b16 a[188:189], v123 offset:3104
    buffer_load_dwordx4 v130, s[52:55], 0 offen offset:2048 lds
    v_mfma_f32_16x16x32_bf16 v[186:189], v[190:193], a[168:171], 0
    s_waitcnt lgkmcnt(7)
    ds_read_b64_tr_b16 a[190:191], v123 offset:3872
    ds_read_b64_tr_b16 a[212:213], v123 offset:3136
    v_mfma_f32_16x16x32_bf16 v[186:189], v[194:197], a[172:175], v[186:189]
    s_add_u32 s52, s52, 12288
    ds_read_b64_tr_b16 a[214:215], v123 offset:3904
    ds_read_b128 v[202:205], v156 offset:256
    v_mfma_f32_16x16x32_bf16 v[186:189], v[206:209], a[176:179], v[186:189]
    s_addc_u32 s53, s53, 0
    v_pk_fma_f16 v115, v128, v128, v115
    v_cvt_pk_f16_f32 v129, v224, v225
    v_mfma_f32_16x16x32_bf16 v[186:189], v[210:213], a[180:183], v[186:189]
    s_add_u32 m0, s68, 0
    v_pk_fma_f16 v115, v129, v129, v115
    v_cvt_pk_f16_f32 v156, v198, v199
    v_mfma_f32_16x16x32_bf16 v[186:189], v[214:217], a[184:187], v[186:189]
    s_waitcnt lgkmcnt(7)
    v_pk_fma_f16 v115, v156, v156, v115
    v_cvt_pk_f16_f32 v157, v200, v201
    v_mfma_f32_16x16x32_bf16 v[198:201], v[190:193], a[192:195], 0
    buffer_load_dwordx4 v164, s[52:55], 0 offen lds
    v_pk_fma_f16 v115, v157, v157, v115
    v_mfma_f32_16x16x32_bf16 v[198:201], v[194:197], a[196:199], v[198:201]
    s_waitcnt lgkmcnt(5)
    v_xor_b32 v255, 65536, v2
    v_lshrrev_b32 v132, 2, v255
    v_mfma_f32_16x16x32_bf16 v[166:169], v[218:221], a[164:167], v[166:169]
    s_waitcnt lgkmcnt(4)
    v_lshrrev_b32 v159, 8, v255
    v_lshl_add_u32 v161, s16, 2, v255
    v_mfma_f32_16x16x32_bf16 v[198:201], v[206:209], a[200:203], v[198:201]
    s_waitcnt lgkmcnt(2)
    v_add_u32 v132, 62784, v132
    v_lshlrev_b32 v159, 4, v159
    v_mfma_f32_16x16x32_bf16 v[186:189], v[218:221], a[188:191], v[186:189]
    s_waitcnt lgkmcnt(0)
    v_cvt_pk_bf16_f32 v166, v166, 0
    v_cvt_pk_bf16_f32 v167, v167, 0
    v_mfma_f32_16x16x32_bf16 v[198:201], v[210:213], a[204:207], v[198:201]
    s_barrier
    ds_write2_b32 v160, v166, v167 offset0:0 offset1:68
    v_mfma_f32_16x16x32_bf16 v[198:201], v[214:217], a[208:211], v[198:201]
    buffer_load_dwordx4 v165, s[52:55], 0 offen offset:1024 lds
    v_cvt_pk_bf16_f32 v168, v168, 0
    v_mfma_f32_16x16x32_bf16 v[198:201], v[218:221], a[212:215], v[198:201]
    v_cvt_pk_bf16_f32 v169, v169, 0
    v_cvt_pk_bf16_f32 v186, v186, 0
    v_mfma_f32_16x16x32_bf16 v[190:193], v[134:137], a[144:147], 0
    ds_write2_b32 v160, v168, v169 offset0:136 offset1:204
    s_waitcnt vmcnt(5)
    v_mfma_f32_16x16x32_bf16 v[190:193], v[142:145], a[148:151], v[190:193]
    v_cvt_pk_bf16_f32 v187, v187, 0
    v_cvt_pk_bf16_f32 v188, v188, 0
    v_mfma_f32_16x16x32_bf16 v[190:193], v[170:173], a[152:155], v[190:193]
    ds_read_b64 a[216:217], v133 offset:0
    ds_read_b64 a[218:219], v133 offset:1536
    v_mfma_f32_16x16x32_bf16 v[190:193], v[178:181], a[156:159], v[190:193]
    buffer_load_dwordx4 v130, s[52:55], 0 offen offset:2048 lds
    ds_read_b64 a[240:241], v133 offset:8
    v_mfma_f32_16x16x32_bf16 v[190:193], v[182:185], a[160:163], v[190:193]
    s_add_u32 s52, s52, 12288
    ds_read_b64 a[242:243], v133 offset:1544
    ds_read_b64 v[90:91], v114 offset:0
    v_mfma_f32_16x16x32_bf16 v[190:193], v[202:205], a[164:167], v[190:193]
    s_addc_u32 s53, s53, 0
    ds_read_b64 v[92:93], v114 offset:1536
    ds_read_b128 v[166:169], v0 offset:26624
    v_mfma_f32_16x16x32_bf16 v[194:197], v[134:137], a[168:171], 0
    s_add_u32 m0, s68, 3072
    ds_read_b128 v[206:209], v1 offset:26624
    v_cvt_pk_bf16_f32 v189, v189, 0
    v_mfma_f32_16x16x32_bf16 v[194:197], v[142:145], a[172:175], v[194:197]
    s_mul_i32 s68, s78, 72
    ds_read_b128 v[210:213], v0 offset:26752
    v_cvt_pk_bf16_f32 v198, v198, 0
    v_mfma_f32_16x16x32_bf16 v[194:197], v[170:173], a[176:179], v[194:197]
    s_sub_u32 s68, s77, s68
    ds_read_b128 v[214:217], v1 offset:26752
    buffer_load_dwordx4 v164, s[52:55], 0 offen lds
    v_mfma_f32_16x16x32_bf16 v[194:197], v[178:181], a[180:183], v[194:197]
    s_mul_i32 s78, s78, 1373568
    ds_read_b128 v[218:221], v0 offset:26880
    v_cvt_pk_bf16_f32 v199, v199, 0
    v_mfma_f32_16x16x32_bf16 v[194:197], v[182:185], a[184:187], v[194:197]
    s_mul_i32 s77, s68, 2688
    ds_read_b128 v[222:225], v1 offset:26880
    v_cvt_pk_bf16_f32 v200, v200, 0
    v_mfma_f32_16x16x32_bf16 v[194:197], v[202:205], a[188:191], v[194:197]
    s_add_u32 s77, s77, s78
    ds_write2_b32 v160, v186, v187 offset0:16 offset1:84
    v_mfma_f32_16x16x32_bf16 v[226:229], v[134:137], a[192:195], 0
    s_waitcnt lgkmcnt(7)
    v_cvt_pk_bf16_f32 v201, v201, 0
    v_cvt_pk_bf16_f32 v190, v190, 0
    v_mfma_f32_16x16x32_bf16 v[226:229], v[142:145], a[196:199], v[226:229]
    s_waitcnt lgkmcnt(5)
    ds_write2_b32 v160, v188, v189 offset0:152 offset1:220
    v_mfma_f32_16x16x32_bf16 v[226:229], v[170:173], a[200:203], v[226:229]
    s_waitcnt lgkmcnt(5)
    buffer_load_dwordx4 v165, s[52:55], 0 offen offset:1024 lds
    v_cvt_pk_bf16_f32 v191, v191, 0
    v_mfma_f32_16x16x32_bf16 v[226:229], v[178:181], a[204:207], v[226:229]
    s_waitcnt lgkmcnt(4)
    ds_write2_b32 v160, v198, v199 offset0:32 offset1:100
    v_mfma_f32_16x16x32_bf16 v[226:229], v[182:185], a[208:211], v[226:229]
    s_waitcnt lgkmcnt(4)
    s_waitcnt vmcnt(5)
    v_cvt_pk_bf16_f32 v192, v192, 0
    v_mfma_f32_16x16x32_bf16 v[226:229], v[202:205], a[212:215], v[226:229]
    s_waitcnt lgkmcnt(3)
    ds_read_b64 a[232:233], v133 offset:3072
    ds_read_b64 a[220:221], v133 offset:4608
    v_mfma_f32_16x16x32_bf16 v[134:137], a[0:3], v[166:169], 0
    ds_read_b64 v[82:83], v133 offset:3080
    ds_read_b64 a[244:245], v133 offset:4616
    v_mfma_f32_16x16x32_bf16 v[134:137], a[4:7], v[206:209], v[134:137]
    buffer_load_dwordx4 v130, s[52:55], 0 offen offset:2048 lds
    ds_read_b64 v[106:107], v114 offset:3072
    v_mfma_f32_16x16x32_bf16 v[134:137], a[8:11], v[210:213], v[134:137]
    s_add_u32 s52, s52, 12288
    ds_read_b64 v[94:95], v114 offset:4608
    v_cvt_pk_bf16_f32 v193, v193, 0
    v_mfma_f32_16x16x32_bf16 v[134:137], a[12:15], v[214:217], v[134:137]
    s_addc_u32 s53, s53, 0
    ds_write2_b32 v160, v200, v201 offset0:168 offset1:236
    v_mfma_f32_16x16x32_bf16 v[134:137], a[16:19], v[218:221], v[134:137]
    s_add_u32 m0, s69, 0
    v_cvt_pk_bf16_f32 v194, v194, 0
    v_cvt_pk_bf16_f32 v195, v195, 0
    v_mfma_f32_16x16x32_bf16 v[134:137], a[20:23], v[222:225], v[134:137]
    ds_write2_b32 v158, v190, v191 offset0:0 offset1:68
    v_mfma_f32_16x16x32_bf16 v[142:145], a[24:27], v[166:169], 0
    s_waitcnt lgkmcnt(6)
    buffer_load_dwordx4 v164, s[52:55], 0 offen lds
    v_cvt_pk_bf16_f32 v196, v196, 0
    v_mfma_f32_16x16x32_bf16 v[142:145], a[28:31], v[206:209], v[142:145]
    s_waitcnt lgkmcnt(4)
    ds_write2_b32 v158, v192, v193 offset0:136 offset1:204
    v_mfma_f32_16x16x32_bf16 v[142:145], a[32:35], v[210:213], v[142:145]
    s_waitcnt lgkmcnt(4)
    v_cvt_pk_bf16_f32 v197, v197, 0
    v_cvt_pk_bf16_f32 v226, v226, 0
    v_mfma_f32_16x16x32_bf16 v[142:145], a[36:39], v[214:217], v[142:145]
    s_waitcnt lgkmcnt(3)
    ds_write2_b32 v158, v194, v195 offset0:16 offset1:84
    v_mfma_f32_16x16x32_bf16 v[142:145], a[40:43], v[218:221], v[142:145]
    v_cvt_pk_bf16_f32 v227, v227, 0
    v_cvt_pk_bf16_f32 v228, v228, 0
    v_mfma_f32_16x16x32_bf16 v[142:145], a[44:47], v[222:225], v[142:145]
    buffer_load_dwordx4 v165, s[52:55], 0 offen offset:1024 lds
    v_cvt_pk_bf16_f32 v229, v229, 0
    v_mfma_f32_16x16x32_bf16 v[170:173], a[48:51], v[166:169], 0
    ds_write2_b32 v158, v196, v197 offset0:152 offset1:220
    v_mfma_f32_16x16x32_bf16 v[170:173], a[52:55], v[206:209], v[170:173]
    v_cvt_pk_f16_f32 v134, v134, v135
    v_pk_mul_f16 v174, v134, v134
    v_mfma_f32_16x16x32_bf16 v[170:173], a[56:59], v[210:213], v[170:173]
    ds_write2_b32 v158, v226, v227 offset0:32 offset1:100
    s_waitcnt vmcnt(5)
    v_mfma_f32_16x16x32_bf16 v[170:173], a[60:63], v[214:217], v[170:173]
    v_cvt_pk_f16_f32 v135, v136, v137
    v_pk_fma_f16 v174, v135, v135, v174
    v_mfma_f32_16x16x32_bf16 v[170:173], a[64:67], v[218:221], v[170:173]
    buffer_load_dwordx4 v130, s[52:55], 0 offen offset:2048 lds
    ds_read_b64 a[222:223], v254 offset:0
    v_mfma_f32_16x16x32_bf16 v[170:173], a[68:71], v[222:225], v[170:173]
    s_add_u32 s52, s52, 12288
    ds_read_b64 a[234:235], v254 offset:1536
    ds_read_b64 a[246:247], v254 offset:8
    v_mfma_f32_16x16x32_bf16 v[178:181], v[166:169], a[144:147], 0
    s_addc_u32 s53, s53, 0
    ds_read_b64 v[84:85], v254 offset:1544
    ds_read_b64 v[96:97], v131 offset:0
    v_mfma_f32_16x16x32_bf16 v[178:181], v[206:209], a[148:151], v[178:181]
    s_add_u32 m0, s69, 3072
    ds_read_b64 v[108:109], v131 offset:1536
    v_cvt_pk_f16_f32 v136, v142, v143
    v_mfma_f32_16x16x32_bf16 v[178:181], v[210:213], a[152:155], v[178:181]
    s_add_u32 s69, s77, 589824
    ds_write2_b32 v158, v228, v229 offset0:168 offset1:236
    v_mfma_f32_16x16x32_bf16 v[178:181], v[214:217], a[156:159], v[178:181]
    buffer_load_dwordx4 v164, s[52:55], 0 offen lds
    v_pk_fma_f16 v174, v136, v136, v174
    v_mfma_f32_16x16x32_bf16 v[178:181], v[218:221], a[160:163], v[178:181]
    v_cvt_pk_f16_f32 v137, v144, v145
    v_pk_fma_f16 v174, v137, v137, v174
    v_mfma_f32_16x16x32_bf16 v[178:181], v[222:225], a[164:167], v[178:181]
    ds_read_b128 v[142:145], v0 offset:20480
    v_cvt_pk_f16_f32 v122, v170, v171
    v_mfma_f32_16x16x32_bf16 v[182:185], v[166:169], a[168:171], 0
    s_waitcnt lgkmcnt(6)
    ds_read_b128 v[186:189], v1 offset:20480
    v_pk_fma_f16 v174, v122, v122, v174
    v_mfma_f32_16x16x32_bf16 v[182:185], v[206:209], a[172:175], v[182:185]
    s_waitcnt lgkmcnt(5)
    ds_read_b128 v[190:193], v0 offset:20608
    v_cvt_pk_f16_f32 v123, v172, v173
    v_mfma_f32_16x16x32_bf16 v[182:185], v[210:213], a[176:179], v[182:185]
    s_waitcnt lgkmcnt(4)
    ds_read_b128 v[170:173], v1 offset:20608
    buffer_load_dwordx4 v165, s[52:55], 0 offen offset:1024 lds
    v_mfma_f32_16x16x32_bf16 v[182:185], v[214:217], a[180:183], v[182:185]
    ds_read_b128 v[194:197], v0 offset:20736
    v_pk_fma_f16 v174, v123, v123, v174
    v_mfma_f32_16x16x32_bf16 v[182:185], v[218:221], a[184:187], v[182:185]
    ds_read_b128 v[198:201], v1 offset:20736
    v_mov_b32 v176, v174
    v_mfma_f32_16x16x32_bf16 v[182:185], v[222:225], a[188:191], v[182:185]
    v_mov_b32 v177, v174
    v_cvt_pk_bf16_f32 v204, v178, v179
    v_mfma_f32_16x16x32_bf16 v[226:229], v[166:169], a[192:195], 0
    v_cvt_pk_bf16_f32 v205, v180, v181
    s_waitcnt vmcnt(5)
    v_mfma_f32_16x16x32_f16 v[166:169], v[40:43], v[174:177], 0
    s_waitcnt lgkmcnt(5)
    ds_read_b64 a[224:225], v254 offset:3072
    ds_read_b64 a[226:227], v254 offset:4608
    v_mfma_f32_16x16x32_bf16 v[226:229], v[206:209], a[196:199], v[226:229]
    s_waitcnt lgkmcnt(6)
    buffer_load_dwordx4 v130, s[52:55], 0 offen offset:2048 lds
    ds_read_b64 a[248:249], v254 offset:3080
    v_mfma_f32_16x16x32_bf16 v[226:229], v[210:213], a[200:203], v[226:229]
    s_add_u32 m0, s28, 65536
    ds_read_b64 a[250:251], v254 offset:4616
    ds_read_b64 v[98:99], v131 offset:3072
    v_mfma_f32_16x16x32_bf16 v[226:229], v[214:217], a[204:207], v[226:229]
    s_waitcnt lgkmcnt(7)
    ds_read_b64 v[100:101], v131 offset:4608
    v_cvt_pk_bf16_f32 v168, v182, v183
    v_mfma_f32_16x16x32_bf16 v[226:229], v[218:221], a[208:211], v[226:229]
    s_waitcnt lgkmcnt(7)
    v_rsq_f32 v166, v166
    v_mfma_f32_16x16x32_bf16 v[226:229], v[222:225], a[212:215], v[226:229]
    s_waitcnt lgkmcnt(6)
    v_rsq_f32 v167, v167
    v_mfma_f32_16x16x32_bf16 v[174:177], v[142:145], a[144:147], 0
    v_mul_f32 v116, s31, v166
    v_cvt_pk_f16_f32 v117, v116, v167
    v_mfma_f32_16x16x32_bf16 v[174:177], v[186:189], a[148:151], v[174:177]
    buffer_load_dwordx4 v10, s[8:11], s24 offen nt lds
    v_mfma_f32_16x16x32_bf16 v[174:177], v[190:193], a[152:155], v[174:177]
    s_add_u32 m0, s28, 69632
    v_pk_mul_f16 v150, v150, v117 op_sel:[0,1] op_sel_hi:[1,1]
    v_pk_mul_f16 v151, v151, v117 op_sel:[0,1] op_sel_hi:[1,1]
    v_mfma_f32_16x16x32_bf16 v[174:177], v[170:173], a[156:159], v[174:177]
    s_waitcnt lgkmcnt(3)
    v_pk_mul_f16 v152, v152, v117 op_sel:[0,1] op_sel_hi:[1,1]
    v_pk_mul_f16 v153, v153, v117 op_sel:[0,1] op_sel_hi:[1,1]
    v_mfma_f32_16x16x32_bf16 v[174:177], v[194:197], a[160:163], v[174:177]
    s_waitcnt lgkmcnt(1)
    v_pk_mul_f16 v124, v124, v117 op_sel:[0,1] op_sel_hi:[1,1]
    v_pk_mul_f16 v125, v125, v117 op_sel:[0,1] op_sel_hi:[1,1]
    v_mfma_f32_16x16x32_bf16 v[174:177], v[198:201], a[164:167], v[174:177]
    s_waitcnt lgkmcnt(0)
    ds_read_b128 v[178:181], v0 offset:32768
    v_pk_mul_f16 v134, v134, v117 op_sel:[0,0] op_sel_hi:[1,0]
    v_mfma_f32_16x16x32_bf16 v[206:209], v[142:145], a[168:171], 0
    ds_read_b128 v[210:213], v1 offset:32768
    v_pk_mul_f16 v135, v135, v117 op_sel:[0,0] op_sel_hi:[1,0]
    v_mfma_f32_16x16x32_bf16 v[206:209], v[186:189], a[172:175], v[206:209]
    buffer_load_dwordx4 v11, s[8:11], s24 offen nt lds
    v_mfma_f32_16x16x32_bf16 v[206:209], v[190:193], a[176:179], v[206:209]
    s_add_u32 m0, s28, 73728
    ds_read_b128 v[214:217], v0 offset:32896
    ds_read_b128 v[218:221], v1 offset:32896
    v_mfma_f32_16x16x32_bf16 v[206:209], v[170:173], a[180:183], v[206:209]
    ds_read_b128 v[222:225], v0 offset:33024
    v_pk_mul_f16 v136, v136, v117 op_sel:[0,0] op_sel_hi:[1,0]
    v_mfma_f32_16x16x32_bf16 v[206:209], v[194:197], a[184:187], v[206:209]
    ds_read_b128 v[230:233], v1 offset:33024
    s_waitcnt vmcnt(5)
    v_mfma_f32_16x16x32_bf16 v[206:209], v[198:201], a[188:191], v[206:209]
    ds_read_b64 a[236:237], v133 offset:0
    ds_read_b64 a[228:229], v133 offset:1536
    v_mfma_f32_16x16x32_bf16 v[234:237], v[142:145], a[192:195], 0
    ds_read_b64 v[86:87], v133 offset:8
    ds_read_b64 a[252:253], v133 offset:1544
    v_mfma_f32_16x16x32_bf16 v[234:237], v[186:189], a[196:199], v[234:237]
    s_waitcnt lgkmcnt(9)
    buffer_load_dwordx4 v12, s[8:11], s24 offen nt lds
    v_mfma_f32_16x16x32_bf16 v[234:237], v[190:193], a[200:203], v[234:237]
    s_add_u32 m0, s28, 77824
    ds_read_b64 v[110:111], v114 offset:0
    ds_read_b64 v[102:103], v114 offset:1536
    v_mfma_f32_16x16x32_bf16 v[234:237], v[170:173], a[204:207], v[234:237]
    s_waitcnt lgkmcnt(10)
    ds_read_b128 v[142:145], v154 offset:0
    ds_read_b128 v[170:173], v154 offset:16
    v_mfma_f32_16x16x32_bf16 v[234:237], v[194:197], a[208:211], v[234:237]
    s_waitcnt lgkmcnt(10)
    ds_read_b128 v[186:189], v154 offset:48
    ds_read_b32 v254, v6 offset:192
    v_mfma_f32_16x16x32_bf16 v[234:237], v[198:201], a[212:215], v[234:237]
    s_waitcnt lgkmcnt(11)
    v_pk_mul_f16 v137, v137, v117 op_sel:[0,0] op_sel_hi:[1,0]
    v_pk_mul_f16 v122, v122, v117 op_sel:[0,0] op_sel_hi:[1,0]
    v_mfma_f32_16x16x32_bf16 v[190:193], a[0:3], v[178:181], 0
    s_waitcnt lgkmcnt(10)
    v_pk_mul_f16 v123, v123, v117 op_sel:[0,0] op_sel_hi:[1,0]
    v_max3_u32 v44, v44, v166, v167
    v_mfma_f32_16x16x32_bf16 v[190:193], a[4:7], v[210:213], v[190:193]
    s_waitcnt lgkmcnt(8)
    buffer_load_dwordx4 v13, s[8:11], s24 offen nt lds
    v_mfma_f32_16x16x32_bf16 v[190:193], a[8:11], v[214:217], v[190:193]
    s_add_u32 m0, s74, 0
    v_cvt_pk_bf16_f32 v169, v184, v185
    v_cvt_pk_bf16_f32 v184, v226, v227
    v_mfma_f32_16x16x32_bf16 v[190:193], a[12:15], v[218:221], v[190:193]
    s_waitcnt lgkmcnt(6)
    v_cvt_pk_bf16_f32 v185, v228, v229
    v_cvt_pk_bf16_f32 v202, v174, v175
    v_mfma_f32_16x16x32_bf16 v[190:193], a[16:19], v[222:225], v[190:193]
    s_waitcnt lgkmcnt(4)
    v_cvt_pk_bf16_f32 v203, v176, v177
    v_cvt_pk_bf16_f32 v166, v206, v207
    v_mfma_f32_16x16x32_bf16 v[190:193], a[20:23], v[230:233], v[190:193]
    s_waitcnt lgkmcnt(2)
    v_cvt_pk_bf16_f32 v167, v208, v209
    v_cvt_pk_bf16_f32 v182, v234, v235
    v_mfma_f32_16x16x32_bf16 v[174:177], a[24:27], v[178:181], 0
    s_waitcnt lgkmcnt(0)
    v_cvt_pk_bf16_f32 v183, v236, v237
    v_xor_b32 v0, 65536, v0
    v_mfma_f32_16x16x32_bf16 v[174:177], a[28:31], v[210:213], v[174:177]
    buffer_load_dwordx4 v14, s[8:11], s24 offen nt lds
    v_mfma_f32_16x16x32_bf16 v[174:177], a[32:35], v[214:217], v[174:177]
    s_add_u32 s8, s60, s23
    v_cvt_pk_f16_f32 v190, v190, v191
    s_waitcnt vmcnt(5)
    v_mfma_f32_16x16x32_bf16 v[174:177], a[36:39], v[218:221], v[174:177]
    s_addc_u32 s9, s61, 0
    ds_read_b64 a[230:231], v133 offset:3072
    ds_read_b64 a[238:239], v133 offset:4608
    v_mfma_f32_16x16x32_bf16 v[174:177], a[40:43], v[222:225], v[174:177]
    s_sub_u32 s10, s36, s23
    ds_read_b64 a[254:255], v133 offset:3080
    ds_read_b64 v[88:89], v133 offset:4616
    v_mfma_f32_16x16x32_bf16 v[174:177], a[44:47], v[230:233], v[174:177]
    s_cmp_lt_u32 s34, s17
    ds_read_b64 v[104:105], v114 offset:3072
    ds_read_b64 v[112:113], v114 offset:4608
    v_mfma_f32_16x16x32_bf16 v[194:197], a[48:51], v[178:181], 0
    s_cselect_b32 s10, s10, 0
    v_pk_mul_f16 v114, v190, v190
    v_cvt_pk_f16_f32 v191, v192, v193
    v_mfma_f32_16x16x32_bf16 v[194:197], a[52:55], v[210:213], v[194:197]
    s_add_u32 m0, s28, 0
    v_pk_fma_f16 v114, v191, v191, v114
    v_cvt_pk_f16_f32 v192, v174, v175
    v_mfma_f32_16x16x32_f16 v[198:201], v[146:149], v[138:141], v[46:49]
    s_mov_b32 s24, s23
    v_pk_fma_f16 v114, v192, v192, v114
    v_cvt_pk_f16_f32 v193, v176, v177
    v_mfma_f32_16x16x32_f16 v[174:177], v[150:153], v[138:141], v[50:53]
    s_add_u32 s23, s23, s21
    v_pk_fma_f16 v114, v193, v193, v114
    v_xor_b32 v1, 65536, v1
    v_add_u32 v159, 62784, v159
    v_mfma_f32_16x16x16_f16 v[198:201], v[120:121], v[118:119], v[198:201]
    v_or_b32 v206, v32, v33
    v_and_b32 v206, 0xffff, v206
    v_lshl_or_b32 v206, v206, 16, v206
    v_mfma_f32_16x16x16_f16 v[174:177], v[124:125], v[118:119], v[174:177]
    v_or_b32 v207, v32, v33
    v_and_b32 v207, 0xffff, v207
    v_lshl_or_b32 v207, v207, 16, v207
    v_or_b32 v208, v32, v33
    v_mfma_f32_16x16x32_bf16 v[194:197], a[56:59], v[214:217], v[194:197]
    s_cmp_ge_u32 s19, 72
    v_exp_f32 v198, v198
    v_mfma_f32_16x16x32_bf16 v[194:197], a[60:63], v[218:221], v[194:197]
    s_cselect_b32 s34, 72, 0
    v_exp_f32 v199, v199
    v_mfma_f32_16x16x32_bf16 v[194:197], a[64:67], v[222:225], v[194:197]
    s_cselect_b32 s35, s22, 0
    v_cvt_pk_bf16_f32 v198, v198, v199
    v_lshrrev_b32 v208, 16, v208
    v_mfma_f32_16x16x32_bf16 v[194:197], a[68:71], v[230:233], v[194:197]
    s_sub_u32 s19, s19, s34
    v_exp_f32 v200, v200
    v_mfma_f32_16x16x32_bf16 v[226:229], v[178:181], a[144:147], 0
    s_add_u32 s23, s23, s35
    v_exp_f32 v201, v201
    v_mfma_f32_16x16x32_bf16 v[226:229], v[210:213], a[148:151], v[226:229]
    s_waitcnt lgkmcnt(0)
    v_cvt_pk_bf16_f32 v199, v200, v201
    v_cvt_pk_f16_f32 v154, v194, v195
    v_mfma_f32_16x16x32_bf16 v[226:229], v[214:217], a[152:155], v[226:229]
    v_pk_fma_f16 v114, v154, v154, v114
    v_cvt_pk_f16_f32 v155, v196, v197
    v_mfma_f32_16x16x32_bf16 v[226:229], v[218:221], a[156:159], v[226:229]
    v_pk_fma_f16 v114, v155, v155, v114
    v_mov_b32 v116, v114
    v_mfma_f32_16x16x32_f16 v[194:197], v[142:145], v[138:141], v[22:25]
    v_mov_b32 v117, v114
    v_lshl_or_b32 v208, v208, 16, v208
    v_mfma_f32_16x16x32_f16 v[194:197], v[170:173], v[146:149], v[194:197]
    v_exp_f32 v174, v174
    v_mfma_f32_16x16x32_f16 v[234:237], v[40:43], v[114:117], 0
    v_exp_f32 v175, v175
    v_mfma_f32_16x16x32_f16 v[194:197], v[186:189], v[118:121], v[194:197]
    v_cvt_pk_bf16_f32 v200, v174, v175
    v_or_b32 v209, v32, v33
    v_mfma_f32_16x16x32_bf16 v[226:229], v[222:225], a[160:163], v[226:229]
    v_exp_f32 v176, v176
    v_mfma_f32_16x16x32_bf16 v[226:229], v[230:233], a[164:167], v[226:229]
    v_exp_f32 v177, v177
    v_mfma_f32_16x16x32_bf16 v[114:117], v[178:181], a[168:171], 0
    v_rsq_f32 v234, v234
    v_mfma_f32_16x16x32_bf16 v[114:117], v[210:213], a[172:175], v[114:117]
    v_rsq_f32 v235, v235
    v_mfma_f32_16x16x32_bf16 v[114:117], v[214:217], a[176:179], v[114:117]
    v_mul_f32 v164, s31, v234
    v_cvt_pk_f16_f32 v165, v164, v235
    v_mfma_f32_16x16x32_bf16 v[114:117], v[218:221], a[180:183], v[114:117]
    v_pk_mul_f16 v126, v126, v165 op_sel:[0,1] op_sel_hi:[1,1]
    v_pk_mul_f16 v127, v127, v165 op_sel:[0,1] op_sel_hi:[1,1]
    v_mfma_f32_16x16x32_bf16 v[114:117], v[222:225], a[184:187], v[114:117]
    v_pk_mul_f16 v128, v128, v165 op_sel:[0,1] op_sel_hi:[1,1]
    v_pk_mul_f16 v129, v129, v165 op_sel:[0,1] op_sel_hi:[1,1]
    v_mfma_f32_16x16x32_bf16 v[114:117], v[230:233], a[188:191], v[114:117]
    v_pk_mul_f16 v156, v156, v165 op_sel:[0,1] op_sel_hi:[1,1]
    v_pk_mul_f16 v157, v157, v165 op_sel:[0,1] op_sel_hi:[1,1]
    v_pk_mul_f16 v190, v190, v165 op_sel:[0,0] op_sel_hi:[1,0]
    v_pk_mul_f16 v191, v191, v165 op_sel:[0,0] op_sel_hi:[1,0]
    v_pk_mul_f16 v192, v192, v165 op_sel:[0,0] op_sel_hi:[1,0]
    v_pk_mul_f16 v193, v193, v165 op_sel:[0,0] op_sel_hi:[1,0]
    v_pk_mul_f16 v154, v154, v165 op_sel:[0,0] op_sel_hi:[1,0]
    v_pk_mul_f16 v155, v155, v165 op_sel:[0,0] op_sel_hi:[1,0]
    v_mfma_f32_16x16x32_f16 v[238:241], v[126:129], v[138:141], v[54:57]
    v_max3_u32 v44, v44, v234, v235
    v_cvt_pk_bf16_f32 v138, v226, v227
    v_mfma_f32_16x16x32_f16 v[234:237], v[142:145], v[134:137], v[24:27]
    v_cvt_pk_bf16_f32 v139, v228, v229
    v_cvt_pk_bf16_f32 v114, v114, v115
    v_mfma_f32_16x16x32_f16 v[234:237], v[170:173], v[150:153], v[234:237]
    v_cvt_pk_bf16_f32 v115, v116, v117
    v_mov_b32_dpp v254, v195 quad_perm:[0,1,2,3] row_mask:0x1 bank_mask:0xf
    v_mov_b32 v25, 0
    v_mfma_f32_16x16x16_f16 v[238:241], v[156:157], v[118:119], v[238:241]
    v_cvt_pk_bf16_f32 v201, v176, v177
    v_exp_f32 v194, v194
    v_lshrrev_b32 v209, 16, v209
    v_mfma_f32_16x16x32_f16 v[234:237], v[186:189], v[122:125], v[234:237]
    v_cvt_pk_bf16_f32 v39, v194, 0
    v_lshl_or_b32 v209, v209, 16, v209
    v_mfma_f32_16x16x32_bf16 v[174:177], v[178:181], a[192:195], 0
    v_xor_b32 v2, 65536, v2
    v_mfma_f32_16x16x32_bf16 v[174:177], v[210:213], a[196:199], v[174:177]
    ds_read2_b32 v[140:141], v6 offset0:0 offset1:0
    ds_read2_b32 v[116:117], v6 offset0:16 offset1:16
    v_mfma_f32_16x16x32_bf16 v[174:177], v[214:217], a[200:203], v[174:177]
    ds_read2_b32 v[180:181], v6 offset0:32 offset1:32
    v_add_u32 v6, 272, v6
    v_mfma_f32_16x16x32_f16 v[194:197], v[142:145], v[190:193], v[26:29]
    v_exp_f32 v234, v234
    v_mfma_f32_16x16x32_f16 v[194:197], v[170:173], v[126:129], v[194:197]
    v_exp_f32 v238, v238
    v_mfma_f32_16x16x32_f16 v[194:197], v[186:189], v[154:157], v[194:197]
    v_exp_f32 v239, v239
    v_mfma_f32_16x16x32_bf16 v[174:177], v[218:221], a[204:207], v[174:177]
    v_mov_b32_dpp v254, v235 quad_perm:[0,1,2,3] row_mask:0x2 bank_mask:0xf
    v_cvt_pk_bf16_f32 v36, v238, v239
    v_mfma_f32_16x16x32_bf16 v[174:177], v[222:225], a[208:211], v[174:177]
    v_exp_f32 v240, v240
    v_mfma_f32_16x16x32_bf16 v[174:177], v[230:233], a[212:215], v[174:177]
    v_exp_f32 v241, v241
    v_mfma_f32_16x16x32_f16 v[142:145], v[146:149], v[134:137], v[58:61]
    s_waitcnt lgkmcnt(1)
    v_mov_b32_dpp v254, v195 quad_perm:[0,1,2,3] row_mask:0x4 bank_mask:0xf
    v_cvt_pk_bf16_f32 v37, v240, v241
    v_mfma_f32_16x16x32_f16 v[170:173], v[150:153], v[134:137], v[62:65]
    s_waitcnt lgkmcnt(0)
    v_exp_f32 v254, v254
    v_mfma_f32_16x16x32_bf16 v[186:189], v[28:31], v[36:39], 0
    v_cvt_pk_bf16_f32 v178, v174, v175
    v_cvt_pk_bf16_f32 v179, v176, v177
    v_mfma_f32_16x16x32_bf16 v[186:189], v[28:31], v[198:201], v[186:189]
    v_exp_f32 v194, v194
    v_mfma_f32_16x16x32_bf16 v[174:177], v[138:141], v[36:39], 0
    v_cvt_pk_bf16_f32 v254, v254, v254
    v_mfma_f32_16x16x32_bf16 v[174:177], v[202:205], v[198:201], v[174:177]
    ds_write_b16 v8, v254
    v_mfma_f32_16x16x32_bf16 v[210:213], v[114:117], v[36:39], 0
    v_mfma_f32_16x16x32_bf16 v[210:213], v[166:169], v[198:201], v[210:213]
    v_mfma_f32_16x16x32_bf16 v[214:217], v[178:181], v[36:39], 0
    v_rcp_f32 v187, v186
    v_mfma_f32_16x16x32_bf16 v[214:217], v[182:185], v[198:201], v[214:217]
    v_cvt_pk_bf16_f32 v39, v234, 0
    v_max3_u32 v25, v25, v187, v186
    v_mfma_f32_16x16x32_f16 v[198:201], v[126:129], v[134:137], v[66:69]
    v_mul_f32 v174, v187, v174
    v_mul_f32 v175, v187, v175
    v_cvt_pk_bf16_f32 v134, v174, v175
    v_mfma_f32_16x16x16_f16 v[142:145], v[120:121], v[122:123], v[142:145]
    v_mul_f32 v176, v187, v176
    v_mul_f32 v177, v187, v177
    v_cvt_pk_bf16_f32 v135, v176, v177
    v_mfma_f32_16x16x16_f16 v[170:173], v[124:125], v[122:123], v[170:173]
    v_mul_f32 v210, v187, v210
    v_mul_f32 v211, v187, v211
    v_cvt_pk_bf16_f32 v136, v210, v211
    v_mfma_f32_16x16x16_f16 v[198:201], v[156:157], v[122:123], v[198:201]
    v_exp_f32 v142, v142
    v_exp_f32 v143, v143
    v_mfma_f32_16x16x32_f16 v[174:177], v[146:149], v[190:193], v[70:73]
    v_cvt_pk_bf16_f32 v118, v142, v143
    v_mul_f32 v212, v187, v212
    v_mfma_f32_16x16x32_bf16 v[146:149], v[206:209], a[216:219], 0
    v_exp_f32 v144, v144
    v_mfma_f32_16x16x32_f16 v[218:221], v[150:153], v[190:193], v[74:77]
    v_exp_f32 v145, v145
    v_mul_f32 v213, v187, v213
    v_mfma_f32_16x16x16_f16 v[174:177], v[120:121], v[154:155], v[174:177]
    v_cvt_pk_bf16_f32 v119, v144, v145
    v_exp_f32 v170, v170
    v_cvt_pk_bf16_f32 v137, v212, v213
    v_mfma_f32_16x16x32_f16 v[142:145], v[126:129], v[190:193], v[78:81]
    v_exp_f32 v171, v171
    v_mul_f32 v214, v187, v214
    v_mfma_f32_16x16x16_f16 v[218:221], v[124:125], v[154:155], v[218:221]
    v_cvt_pk_bf16_f32 v120, v170, v171
    v_exp_f32 v172, v172
    v_mul_f32 v215, v187, v215
    v_mfma_f32_16x16x16_f16 v[142:145], v[156:157], v[154:155], v[142:145]
    v_exp_f32 v173, v173
    v_exp_f32 v198, v198
    v_mfma_f32_16x16x32_bf16 v[146:149], v[206:209], a[240:243], v[146:149]
    v_cvt_pk_bf16_f32 v121, v172, v173
    v_cvt_pk_bf16_f32 v164, v214, v215
    v_mfma_f32_16x16x32_bf16 v[146:149], v[206:209], v[90:93], v[146:149]
    v_exp_f32 v199, v199
    v_mfma_f32_16x16x32_bf16 v[122:125], v[206:209], a[220:223], 0
    v_cvt_pk_bf16_f32 v36, v198, v199
    v_mul_f32 v216, v187, v216
    v_mfma_f32_16x16x32_bf16 v[122:125], v[206:209], a[244:247], v[122:125]
    v_exp_f32 v200, v200
    v_mfma_f32_16x16x32_bf16 v[122:125], v[206:209], v[94:97], v[122:125]
    v_exp_f32 v201, v201
    v_mfma_f32_16x16x32_bf16 v[126:129], v[206:209], a[232:235], 0
    v_mov_b32 v254, v146
    v_cvt_pk_bf16_f32 v37, v200, v201
    v_mfma_f32_16x16x32_bf16 v[126:129], v[206:209], v[82:85], v[126:129]
    v_mov_b32_dpp v254, v147 quad_perm:[0,1,2,3] row_mask:0x2 bank_mask:0xf
    v_mul_f32 v217, v187, v217
    v_mfma_f32_16x16x32_bf16 v[146:149], v[28:31], v[36:39], 0
    v_mov_b32 v158, v123
    v_cvt_pk_bf16_f32 v165, v216, v217
    v_mfma_f32_16x16x32_bf16 v[146:149], v[28:31], v[118:121], v[146:149]
    v_exp_f32 v174, v174
    v_mfma_f32_16x16x32_bf16 v[150:153], v[138:141], v[36:39], 0
    v_exp_f32 v175, v175
    v_mfma_f32_16x16x32_bf16 v[150:153], v[202:205], v[118:121], v[150:153]
    v_exp_f32 v176, v176
    v_mfma_f32_16x16x32_bf16 v[154:157], v[114:117], v[36:39], 0
    v_exp_f32 v177, v177
    v_mfma_f32_16x16x32_bf16 v[154:157], v[166:169], v[118:121], v[154:157]
    v_cvt_pk_bf16_f32 v170, v174, v175
    v_cvt_pk_bf16_f32 v171, v176, v177
    v_mfma_f32_16x16x32_bf16 v[174:177], v[178:181], v[36:39], 0
    v_exp_f32 v218, v218
    v_mfma_f32_16x16x32_bf16 v[174:177], v[182:185], v[118:121], v[174:177]
    v_exp_f32 v219, v219
    v_mfma_f32_16x16x32_bf16 v[126:129], v[206:209], v[106:109], v[126:129]
    v_cvt_pk_bf16_f32 v172, v218, v219
    v_cvt_pk_bf16_f32 v39, v194, 0
    v_mfma_f32_16x16x32_bf16 v[118:121], v[206:209], a[224:227], 0
    v_exp_f32 v220, v220
    v_mfma_f32_16x16x32_bf16 v[118:121], v[206:209], a[248:251], v[118:121]
    v_exp_f32 v221, v221
    v_mfma_f32_16x16x32_bf16 v[118:121], v[206:209], v[98:101], v[118:121]
    v_exp_f32 v142, v142
    v_mfma_f32_16x16x32_bf16 v[186:189], v[206:209], a[228:231], 0
    v_mov_b32_dpp v254, v126 quad_perm:[0,1,2,3] row_mask:0x4 bank_mask:0xf
    v_mov_b32_dpp v158, v127 quad_perm:[0,1,2,3] row_mask:0x2 bank_mask:0xf
    v_mfma_f32_16x16x32_bf16 v[186:189], v[206:209], a[252:255], v[186:189]
    v_mov_b32_dpp v254, v122 quad_perm:[0,1,2,3] row_mask:0x8 bank_mask:0xf
    v_cvt_pk_bf16_f32 v173, v220, v221
    v_mfma_f32_16x16x32_bf16 v[186:189], v[206:209], v[102:105], v[186:189]
    ds_write_b32 v161, v254 offset:18432
    v_mfma_f32_16x16x32_bf16 v[122:125], v[206:209], a[236:239], 0
    v_exp_f32 v143, v143
    v_mfma_f32_16x16x32_bf16 v[122:125], v[206:209], v[86:89], v[122:125]
    v_mov_b32_dpp v158, v118 quad_perm:[0,1,2,3] row_mask:0x4 bank_mask:0xf
    v_cvt_pk_bf16_f32 v36, v142, v143
    v_mfma_f32_16x16x32_bf16 v[122:125], v[206:209], v[110:113], v[122:125]
    v_mov_b32_dpp v158, v119 quad_perm:[0,1,2,3] row_mask:0x8 bank_mask:0xf
    v_exp_f32 v144, v144
    v_exp_f32 v145, v145
    ds_read_b128 v[118:121], v9
    ds_read_b128 v[126:129], v9 offset:64
    ds_write_b32 v161, v158 offset:19456
    v_cvt_pk_bf16_f32 v37, v144, v145
    v_rcp_f32 v147, v146
    v_mov_b32 v254, v122
    v_mfma_f32_16x16x32_bf16 v[142:145], v[28:31], v[36:39], 0
    v_max3_u32 v25, v25, v147, v146
    v_mov_b32_dpp v254, v186 quad_perm:[0,1,2,3] row_mask:0x2 bank_mask:0xf
    v_mfma_f32_16x16x32_bf16 v[142:145], v[28:31], v[170:173], v[142:145]
    v_mul_f32 v150, v147, v150
    v_mov_b32_dpp v254, v187 quad_perm:[0,1,2,3] row_mask:0x4 bank_mask:0xf
    v_mfma_f32_16x16x32_bf16 v[186:189], v[138:141], v[36:39], 0
    v_mul_f32 v151, v147, v151
    v_mov_b32_dpp v254, v123 quad_perm:[0,1,2,3] row_mask:0x8 bank_mask:0xf
    v_mfma_f32_16x16x32_bf16 v[186:189], v[202:205], v[170:173], v[186:189]
    ds_write_b32 v161, v254 offset:63552
    v_mfma_f32_16x16x32_bf16 v[206:209], v[114:117], v[36:39], 0
    v_rcp_f32 v143, v142
    v_mfma_f32_16x16x32_bf16 v[206:209], v[166:169], v[170:173], v[206:209]
    s_waitcnt lgkmcnt(2)
    v_max3_u32 v25, v25, v143, v142
    v_cvt_pk_bf16_f32 v130, v150, v151
    v_mfma_f32_16x16x32_bf16 v[210:213], v[118:121], v[28:31], 0
    v_mul_f32 v186, v143, v186
    v_mul_f32 v187, v143, v187
    v_mfma_f32_16x16x32_bf16 v[210:213], v[126:129], v[28:31], v[210:213]
    v_cvt_pk_bf16_f32 v214, v186, v187
    v_mul_f32 v188, v143, v188
    v_mfma_f32_16x16x32_bf16 v[218:221], v[118:121], v[202:205], 0
    v_mul_f32 v189, v143, v189
    v_cvt_pk_bf16_f32 v215, v188, v189
    v_mfma_f32_16x16x32_bf16 v[218:221], v[126:129], v[138:141], v[218:221]
    v_mul_f32 v206, v143, v206
    v_mul_f32 v207, v143, v207
    v_mfma_f32_16x16x32_bf16 v[138:141], v[118:121], v[166:169], 0
    v_rcp_f32_dpp v211, v210 quad_perm:[0,0,0,0] row_mask:0xf bank_mask:0xf
    v_mfma_f32_16x16x32_bf16 v[138:141], v[126:129], v[114:117], v[138:141]
    s_waitcnt lgkmcnt(0)
    v_max3_u32 v25, v25, v210, v211
    v_cvt_pk_bf16_f32 v216, v206, v207
    v_mfma_f32_16x16x32_bf16 v[114:117], v[118:121], v[182:185], 0
    s_barrier
    s_waitcnt vmcnt(0)
    ds_read_b128 v[166:169], v255 offset:18432
    v_mfma_f32_16x16x32_bf16 v[114:117], v[126:129], v[178:181], v[114:117]
    s_barrier
    ds_read_b128 v[186:189], v0 offset:20480
    ds_read_b128 v[194:197], v1 offset:20480
    v_mfma_f32_16x16x32_bf16 v[126:129], v[178:181], v[36:39], 0
    ds_read_b128 v[122:125], v0 offset:20608
    buffer_load_dwordx4 v10, s[8:11], 0 offen nt lds
    v_mfma_f32_16x16x32_bf16 v[126:129], v[182:185], v[170:173], v[126:129]
    s_add_u32 m0, s28, 4096
    ds_read_b128 v[202:205], v1 offset:20608
    ds_read_b128 v[230:233], v0 offset:20736
    ds_read_b128 v[238:241], v1 offset:20736
    ds_read_b128 v[170:173], v255 offset:19456
    ds_read_b128 v[178:181], v255 offset:63552
    ds_write_b128 v3, v[134:137] offset:0
    s_waitcnt lgkmcnt(7)
    v_mfma_f32_16x16x32_bf16 v[118:121], a[72:75], v[186:189], 0
    s_waitcnt lgkmcnt(6)
    buffer_load_dwordx4 v11, s[8:11], 0 offen nt lds
    v_add_f32 v166, v166, v167
    v_mfma_f32_16x16x32_bf16 v[118:121], a[76:79], v[194:197], v[118:121]
    s_add_u32 m0, s28, 8192
    v_add_f32 v168, v168, v169
    v_add_f32 v166, v166, v168
    v_mfma_f32_16x16x32_bf16 v[118:121], a[80:83], v[122:125], v[118:121]
    s_waitcnt lgkmcnt(4)
    ds_write_b64 v4, v[164:165] offset:4096
    v_mfma_f32_16x16x32_bf16 v[118:121], a[84:87], v[202:205], v[118:121]
    s_waitcnt lgkmcnt(3)
    v_mul_f32 v166, 0xbbaaaaab, v166
    v_add_f32 v170, v170, v171
    v_mfma_f32_16x16x32_bf16 v[118:121], a[88:91], v[230:233], v[118:121]
    s_waitcnt lgkmcnt(2)
    ds_write_b32 v132, v166 offset:0
    v_mfma_f32_16x16x32_bf16 v[118:121], a[92:95], v[238:241], v[118:121]
    buffer_load_dwordx4 v12, s[8:11], 0 offen nt lds
    v_add_f32 v172, v172, v173
    v_mfma_f32_16x16x32_bf16 v[190:193], a[96:99], v[186:189], 0
    s_add_u32 m0, s28, 12288
    ds_read_b128 v[134:137], v159 offset:0
    ds_read_b128 v[166:169], v159 offset:64
    v_mfma_f32_16x16x32_bf16 v[190:193], a[100:103], v[194:197], v[190:193]
    s_xor_b32 s28, s28, 65536
    ds_read_b128 v[182:185], v159 offset:128
    ds_read_b128 v[222:225], v159 offset:192
    v_mfma_f32_16x16x32_bf16 v[190:193], a[104:107], v[122:125], v[190:193]
    v_add_f32 v170, v170, v172
    v_mul_f32 v170, 0xbbaaaaab, v170
    v_mfma_f32_16x16x32_bf16 v[190:193], a[108:111], v[202:205], v[190:193]
    ds_write_b32 v132, v170 offset:256
    v_mfma_f32_16x16x32_bf16 v[190:193], a[112:115], v[230:233], v[190:193]
    v_add_f32 v178, v178, v179
    v_add_f32 v180, v180, v181
    v_mfma_f32_16x16x32_bf16 v[190:193], a[116:119], v[238:241], v[190:193]
    buffer_load_dwordx4 v13, s[8:11], 0 offen nt lds
    v_add_f32 v178, v178, v180
    v_mfma_f32_16x16x32_bf16 v[198:201], a[120:123], v[186:189], 0
    s_mov_b32 m0, s29
    v_mul_f32 v178, 0xbbaaaaab, v178
    v_mul_f32 v218, v218, v211
    v_mfma_f32_16x16x32_bf16 v[198:201], a[124:127], v[194:197], v[198:201]
    s_xor_b32 s29, s29, s30
    ds_write_b32 v132, v178 offset:512
    v_mfma_f32_16x16x32_bf16 v[198:201], a[128:131], v[122:125], v[198:201]
    s_waitcnt lgkmcnt(4)
    v_mul_f32_dpp v218, v138, v211 quad_perm:[0,1,2,3] row_mask:0x2 bank_mask:0xf
    v_mul_f32 v208, v143, v208
    v_mul_f32 v209, v143, v209
    v_mfma_f32_16x16x16_bf16 v[138:141], a[216:217], v[162:163], v[134:137]
    v_mul_f32_dpp v218, v114, v211 quad_perm:[0,1,2,3] row_mask:0x4 bank_mask:0xf
    v_cvt_pk_bf16_f32 v218, v218, v218
    v_cvt_pk_bf16_f32 v217, v208, v209
    v_mfma_f32_16x16x16_bf16 v[114:117], a[240:241], v[162:163], v[134:137]
    v_mul_f32 v126, v143, v126
    v_mul_f32 v127, v143, v127
    v_cvt_pk_bf16_f32 v164, v126, v127
    v_mfma_f32_16x16x16_bf16 v[170:173], v[90:91], v[162:163], v[134:137]
    v_cvt_pk_bf16_f32 v138, v138, v139
    v_accvgpr_write_b32 a216, v138
    v_cvt_pk_bf16_f32 v140, v140, v141
    v_mfma_f32_16x16x16_bf16 v[178:181], a[218:219], v[162:163], v[166:169]
    v_accvgpr_write_b32 a217, v140
    v_cvt_pk_bf16_f32 v114, v114, v115
    v_accvgpr_write_b32 a240, v114
    v_mfma_f32_16x16x16_bf16 v[134:137], a[242:243], v[162:163], v[166:169]
    v_cvt_pk_bf16_f32 v116, v116, v117
    v_accvgpr_write_b32 a241, v116
    v_cvt_pk_bf16_f32 v90, v170, v171
    v_mfma_f32_16x16x16_bf16 v[114:117], v[92:93], v[162:163], v[166:169]
    v_cvt_pk_bf16_f32 v91, v172, v173
    v_cvt_pk_bf16_f32 v178, v178, v179
    v_accvgpr_write_b32 a218, v178
    v_cvt_pk_bf16_f32 v180, v180, v181
    v_mfma_f32_16x16x32_bf16 v[198:201], a[132:135], v[202:205], v[198:201]
    s_waitcnt lgkmcnt(0)
    buffer_load_dwordx4 v14, s[8:11], 0 offen nt lds
    ds_read_b128 v[138:141], v159 offset:256
    v_accvgpr_write_b32 a219, v180
    v_mfma_f32_16x16x16_bf16 v[166:169], a[232:233], v[162:163], v[182:185]
    v_cvt_pk_bf16_f32 v134, v134, v135
    v_accvgpr_write_b32 a242, v134
    v_cvt_pk_bf16_f32 v136, v136, v137
    v_mfma_f32_16x16x16_bf16 v[170:173], v[82:83], v[162:163], v[182:185]
    v_accvgpr_write_b32 a243, v136
    v_cvt_pk_bf16_f32 v92, v114, v115
    v_cvt_pk_bf16_f32 v93, v116, v117
    v_mfma_f32_16x16x16_bf16 v[114:117], v[106:107], v[162:163], v[182:185]
    v_cvt_pk_bf16_f32 v166, v166, v167
    v_accvgpr_write_b32 a232, v166
    v_cvt_pk_bf16_f32 v168, v168, v169
    v_mfma_f32_16x16x16_bf16 v[134:137], a[220:221], v[162:163], v[222:225]
    v_accvgpr_write_b32 a233, v168
    v_cvt_pk_bf16_f32 v82, v170, v171
    v_cvt_pk_bf16_f32 v83, v172, v173
    v_mfma_f32_16x16x16_bf16 v[166:169], a[244:245], v[162:163], v[222:225]
    v_cvt_pk_bf16_f32 v106, v114, v115
    v_cvt_pk_bf16_f32 v107, v116, v117
    v_mul_f32 v128, v143, v128
    v_mfma_f32_16x16x16_bf16 v[114:117], v[94:95], v[162:163], v[222:225]
    v_cvt_pk_bf16_f32 v134, v134, v135
    v_accvgpr_write_b32 a220, v134
    v_cvt_pk_bf16_f32 v136, v136, v137
    v_accvgpr_write_b32 a221, v136
    v_mfma_f32_16x16x32_bf16 v[198:201], a[136:139], v[230:233], v[198:201]
    s_waitcnt lgkmcnt(0)
    ds_read_b128 v[134:137], v159 offset:320
    ds_read_b128 v[170:173], v159 offset:384
    v_cvt_pk_bf16_f32 v166, v166, v167
    v_mfma_f32_16x16x16_bf16 v[178:181], a[222:223], v[162:163], v[138:141]
    v_accvgpr_write_b32 a244, v166
    v_cvt_pk_bf16_f32 v168, v168, v169
    v_accvgpr_write_b32 a245, v168
    v_mfma_f32_16x16x16_bf16 v[166:169], a[246:247], v[162:163], v[138:141]
    v_cvt_pk_bf16_f32 v94, v114, v115
    v_cvt_pk_bf16_f32 v95, v116, v117
    v_mul_f32 v129, v143, v129
    v_mfma_f32_16x16x16_bf16 v[114:117], v[96:97], v[162:163], v[138:141]
    v_cvt_pk_bf16_f32 v178, v178, v179
    v_accvgpr_write_b32 a222, v178
    v_cvt_pk_bf16_f32 v180, v180, v181
    v_accvgpr_write_b32 a223, v180
    v_mfma_f32_16x16x32_bf16 v[198:201], a[140:143], v[238:241], v[198:201]
    ds_read_b128 v[142:145], v159 offset:448
    v_cvt_pk_bf16_f32 v166, v166, v167
    v_mfma_f32_16x16x32_bf16 v[138:141], a[0:3], v[186:189], 0
    ds_write_b128 v3, v[214:217] offset:12288
    v_mfma_f32_16x16x32_bf16 v[138:141], a[4:7], v[194:197], v[138:141]
    s_waitcnt lgkmcnt(3)
    v_accvgpr_write_b32 a246, v166
    v_cvt_pk_bf16_f32 v168, v168, v169
    v_accvgpr_write_b32 a247, v168
    v_mfma_f32_16x16x16_bf16 v[166:169], a[234:235], v[162:163], v[134:137]
    v_cvt_pk_bf16_f32 v96, v114, v115
    v_cvt_pk_bf16_f32 v97, v116, v117
    v_cvt_pk_bf16_f32 v165, v128, v129
    v_mfma_f32_16x16x16_bf16 v[114:117], v[84:85], v[162:163], v[134:137]
    v_mul_f32 v152, v147, v152
    v_mul_f32 v153, v147, v153
    v_cvt_pk_bf16_f32 v131, v152, v153
    v_mfma_f32_16x16x16_bf16 v[126:129], v[108:109], v[162:163], v[134:137]
    v_cvt_pk_bf16_f32 v166, v166, v167
    v_accvgpr_write_b32 a234, v166
    v_cvt_pk_bf16_f32 v168, v168, v169
    v_accvgpr_write_b32 a235, v168
    v_mfma_f32_16x16x32_bf16 v[138:141], a[8:11], v[122:125], v[138:141]
    s_waitcnt lgkmcnt(1)
    ds_read_b128 v[134:137], v159 offset:512
    ds_write_b64 v4, v[164:165] offset:16384
    v_mfma_f32_16x16x16_bf16 v[150:153], a[224:225], v[162:163], v[170:173]
    v_cvt_pk_bf16_f32 v84, v114, v115
    v_cvt_pk_bf16_f32 v85, v116, v117
    v_cvt_pk_bf16_f32 v108, v126, v127
    v_mfma_f32_16x16x16_bf16 v[114:117], a[248:249], v[162:163], v[170:173]
    v_cvt_pk_bf16_f32 v109, v128, v129
    v_mul_f32 v154, v147, v154
    v_mul_f32 v155, v147, v155
    v_mfma_f32_16x16x16_bf16 v[126:129], v[98:99], v[162:163], v[170:173]
    v_cvt_pk_bf16_f32 v150, v150, v151
    v_accvgpr_write_b32 a224, v150
    v_cvt_pk_bf16_f32 v152, v152, v153
    v_mfma_f32_16x16x16_bf16 v[166:169], a[226:227], v[162:163], v[142:145]
    v_accvgpr_write_b32 a225, v152
    v_cvt_pk_bf16_f32 v114, v114, v115
    v_accvgpr_write_b32 a248, v114
    v_mfma_f32_16x16x16_bf16 v[150:153], a[250:251], v[162:163], v[142:145]
    v_cvt_pk_bf16_f32 v116, v116, v117
    v_accvgpr_write_b32 a249, v116
    v_cvt_pk_bf16_f32 v98, v126, v127
    v_mfma_f32_16x16x16_bf16 v[114:117], v[100:101], v[162:163], v[142:145]
    v_cvt_pk_bf16_f32 v99, v128, v129
    v_cvt_pk_bf16_f32 v166, v166, v167
    v_accvgpr_write_b32 a226, v166
    v_cvt_pk_bf16_f32 v168, v168, v169
    v_mfma_f32_16x16x32_bf16 v[138:141], a[12:15], v[202:205], v[138:141]
    s_waitcnt lgkmcnt(0)
    ds_read_b128 v[126:129], v159 offset:576
    ds_read_b128 v[142:145], v159 offset:640
    v_accvgpr_write_b32 a227, v168
    v_mfma_f32_16x16x16_bf16 v[166:169], a[236:237], v[162:163], v[134:137]
    v_cvt_pk_bf16_f32 v150, v150, v151
    v_accvgpr_write_b32 a250, v150
    v_cvt_pk_bf16_f32 v152, v152, v153
    v_mfma_f32_16x16x16_bf16 v[170:173], v[86:87], v[162:163], v[134:137]
    v_accvgpr_write_b32 a251, v152
    v_cvt_pk_bf16_f32 v100, v114, v115
    v_cvt_pk_bf16_f32 v101, v116, v117
    v_mfma_f32_16x16x16_bf16 v[114:117], v[110:111], v[162:163], v[134:137]
    v_cvt_pk_bf16_f32 v166, v166, v167
    v_accvgpr_write_b32 a236, v166
    v_cvt_pk_bf16_f32 v168, v168, v169
    v_accvgpr_write_b32 a237, v168
    v_mfma_f32_16x16x32_bf16 v[138:141], a[16:19], v[230:233], v[138:141]
    ds_read_b128 v[134:137], v159 offset:704
    v_cvt_pk_bf16_f32 v86, v170, v171
    v_mfma_f32_16x16x32_bf16 v[138:141], a[20:23], v[238:241], v[138:141]
    ds_write_b16 v7, v218
    v_mfma_f32_16x16x32_bf16 v[166:169], a[24:27], v[186:189], 0
    v_add_u32 v7, 16, v7
    v_cvt_pk_bf16_f32 v87, v172, v173
    v_mfma_f32_16x16x32_bf16 v[166:169], a[28:31], v[194:197], v[166:169]
    s_waitcnt lgkmcnt(2)
    v_cvt_pk_bf16_f32 v110, v114, v115
    v_cvt_pk_bf16_f32 v111, v116, v117
    v_cvt_pk_bf16_f32 v132, v154, v155
    v_mfma_f32_16x16x16_bf16 v[114:117], a[228:229], v[162:163], v[126:129]
    v_mul_f32 v156, v147, v156
    v_mul_f32 v157, v147, v157
    v_cvt_pk_bf16_f32 v133, v156, v157
    v_mfma_f32_16x16x16_bf16 v[150:153], a[252:253], v[162:163], v[126:129]
    v_mul_f32 v174, v147, v174
    v_mul_f32 v175, v147, v175
    v_cvt_pk_bf16_f32 v254, v174, v175
    v_mfma_f32_16x16x16_bf16 v[154:157], v[102:103], v[162:163], v[126:129]
    v_cvt_pk_bf16_f32 v114, v114, v115
    v_accvgpr_write_b32 a228, v114
    v_cvt_pk_bf16_f32 v116, v116, v117
    v_mfma_f32_16x16x16_bf16 v[158:161], a[230:231], v[162:163], v[142:145]
    v_accvgpr_write_b32 a229, v116
    v_cvt_pk_bf16_f32 v150, v150, v151
    v_accvgpr_write_b32 a252, v150
    v_mfma_f32_16x16x16_bf16 v[114:117], a[254:255], v[162:163], v[142:145]
    v_cvt_pk_bf16_f32 v152, v152, v153
    v_accvgpr_write_b32 a253, v152
    v_cvt_pk_bf16_f32 v102, v154, v155
    v_mfma_f32_16x16x16_bf16 v[126:129], v[104:105], v[162:163], v[142:145]
    v_cvt_pk_bf16_f32 v103, v156, v157
    v_cvt_pk_bf16_f32 v158, v158, v159
    v_accvgpr_write_b32 a230, v158
    v_cvt_pk_bf16_f32 v160, v160, v161
    v_mfma_f32_16x16x32_bf16 v[166:169], a[32:35], v[122:125], v[166:169]
    s_waitcnt lgkmcnt(0)
    ds_write_b128 v3, v[130:133] offset:6144
    v_mfma_f32_16x16x16_bf16 v[130:133], a[238:239], v[162:163], v[134:137]
    v_accvgpr_write_b32 a231, v160
    v_cvt_pk_bf16_f32 v114, v114, v115
    v_accvgpr_write_b32 a254, v114
    v_mfma_f32_16x16x16_bf16 v[142:145], v[88:89], v[162:163], v[134:137]
    v_cvt_pk_bf16_f32 v116, v116, v117
    v_accvgpr_write_b32 a255, v116
    v_cvt_pk_bf16_f32 v104, v126, v127
    v_mfma_f32_16x16x16_bf16 v[114:117], v[112:113], v[162:163], v[134:137]
    v_cvt_pk_bf16_f32 v105, v128, v129
    v_cvt_pk_bf16_f32 v130, v130, v131
    v_accvgpr_write_b32 a238, v130
    v_cvt_pk_bf16_f32 v132, v132, v133
    v_mfma_f32_16x16x32_bf16 v[166:169], a[36:39], v[202:205], v[166:169]
    v_accvgpr_write_b32 a239, v132
    v_cvt_pk_bf16_f32 v88, v142, v143
    v_mfma_f32_16x16x32_bf16 v[166:169], a[40:43], v[230:233], v[166:169]
    v_cvt_pk_bf16_f32 v89, v144, v145
    v_cvt_pk_bf16_f32 v112, v114, v115
    v_mfma_f32_16x16x32_bf16 v[166:169], a[44:47], v[238:241], v[166:169]
    v_cvt_pk_bf16_f32 v113, v116, v117
    v_mul_f32 v176, v147, v176
    v_mfma_f32_16x16x32_bf16 v[134:137], a[48:51], v[186:189], 0
    v_mul_f32 v177, v147, v177
    v_cvt_pk_bf16_f32 v255, v176, v177
    v_mfma_f32_16x16x32_bf16 v[134:137], a[52:55], v[194:197], v[134:137]
    ds_write_b64 v4, v[254:255] offset:10240
    v_cvt_pk_f16_f32 v146, v118, v119
    v_pk_mul_f16 v143, v146, v146
    v_cvt_pk_f16_f32 v147, v120, v121
    v_pk_fma_f16 v143, v147, v147, v143
    v_cvt_pk_f16_f32 v148, v190, v191
    v_pk_fma_f16 v143, v148, v148, v143
    v_cvt_pk_f16_f32 v149, v192, v193
    v_pk_fma_f16 v143, v149, v149, v143
    v_cvt_pk_f16_f32 v120, v198, v199
    v_pk_fma_f16 v143, v120, v120, v143
    v_cvt_pk_f16_f32 v121, v200, v201
    v_pk_fma_f16 v143, v121, v121, v143
    v_xor_b32 v3, 65536, v3
    v_xor_b32 v4, 65536, v4
    s_waitcnt lgkmcnt(0)
    s_barrier
L_go:
    s_waitcnt lgkmcnt(0)
    s_and_b32 s3, s2, 0xf8
    s_add_u32 s64, s42, s3
    s_addc_u32 s65, s43, 0
    s_mov_b32 s67, 0x00020000
    s_cmp_eq_u32 s16, 1
    s_cbranch_scc1 L_loop_fast1
    s_cmp_eq_u32 s16, 2
    s_cbranch_scc1 L_loop_fast2
    s_cmp_eq_u32 s16, 3
    s_cbranch_scc1 L_loop_fast3
    s_branch L_loop_fast0
.p2align 6
L_loop_fast0:
    v_mfma_f32_16x16x32_bf16 v[134:137], a[56:59], v[122:125], v[134:137]
    s_add_u32 s12, s40, s27
    ds_read_b128 v[190:193], v2 offset:18432
    v_cvt_pk_f16_f32 v150, v138, v139
    v_mfma_f32_16x16x32_bf16 v[134:137], a[60:63], v[202:205], v[134:137]
    s_addc_u32 s13, s41, 0
    ds_read_b128 v[210:213], v2 offset:19456
    v_pk_mul_f16 v142, v150, v150
    v_mfma_f32_16x16x32_bf16 v[134:137], a[64:67], v[230:233], v[134:137]
    s_sub_u32 s14, s36, s27
    ds_read_b128 v[174:177], v5 offset:32
    v_cvt_pk_f16_f32 v151, v140, v141
    v_mfma_f32_16x16x32_bf16 v[134:137], a[68:71], v[238:241], v[134:137]
    s_cmp_ge_u32 s18, 2
    ds_read2_b64 v[162:165], v5 offset0:6 offset1:9
    v_pk_fma_f16 v142, v151, v151, v142
    v_mfma_f32_16x16x32_bf16 v[138:141], v[186:189], a[144:147], 0
    s_cselect_b32 s14, s14, 0
    ds_read_b128 v[170:173], v5
    v_cvt_pk_f16_f32 v152, v166, v167
    v_mfma_f32_16x16x32_bf16 v[138:141], v[194:197], a[148:151], v[138:141]
    s_sub_u32 s82, s72, s71
    ds_read_b32 v254, v6 offset:192
    v_pk_fma_f16 v142, v152, v152, v142
    v_mfma_f32_16x16x32_bf16 v[138:141], v[122:125], a[152:155], v[138:141]
    s_mul_i32 s74, s82, 336
    v_cvt_pk_f16_f32 v153, v168, v169
    v_pk_fma_f16 v142, v153, v153, v142
    v_mfma_f32_16x16x32_bf16 v[138:141], v[202:205], a[156:159], v[138:141]
    s_mul_i32 s75, s82, 272
    v_cvt_pk_f16_f32 v118, v134, v135
    v_pk_fma_f16 v142, v118, v118, v142
    v_mfma_f32_16x16x32_bf16 v[138:141], v[230:233], a[160:163], v[138:141]
    s_waitcnt lgkmcnt(5)
    ds_read_b128 v[182:185], v0 offset:26624
    v_cvt_pk_f16_f32 v119, v136, v137
    v_mfma_f32_16x16x32_bf16 v[166:169], v[32:35], v[190:193], 0
    s_waitcnt lgkmcnt(5)
    v_pk_fma_f16 v142, v119, v119, v142
    v_add_u32 v5, s74, v5
    v_mfma_f32_16x16x32_bf16 v[166:169], v[32:35], v[210:213], v[166:169]
    s_waitcnt lgkmcnt(4)
    v_pk_mul_f16 v145, v146, v174
    v_pk_fma_f16 v145, v147, v175, v145
    v_mfma_f32_16x16x32_bf16 v[138:141], v[238:241], a[164:167], v[138:141]
    s_mul_i32 s76, s82, 16
    ds_read_b128 v[210:213], v1 offset:26624
    v_pk_fma_f16 v145, v148, v176, v145
    v_mfma_f32_16x16x32_bf16 v[214:217], v[186:189], a[168:171], 0
    s_waitcnt lgkmcnt(3)
    ds_read_b128 v[218:221], v0 offset:26752
    v_pk_fma_f16 v145, v149, v177, v145
    v_mfma_f32_16x16x32_bf16 v[214:217], v[194:197], a[172:175], v[214:217]
    s_waitcnt lgkmcnt(3)
    ds_read_b128 v[222:225], v1 offset:26752
    v_mov_b32_dpp v254, v23 quad_perm:[0,1,2,3] row_mask:0x7 bank_mask:0xf
    v_mfma_f32_16x16x32_bf16 v[214:217], v[122:125], a[176:179], v[214:217]
    s_add_u32 s34, s18, 2
    ds_read_b128 v[226:229], v0 offset:26880
    v_pk_fma_f16 v145, v120, v164, v145
    v_mfma_f32_16x16x32_bf16 v[214:217], v[202:205], a[180:183], v[214:217]
    s_add_u32 s8, s60, s23
    ds_read_b128 v[190:193], v1 offset:26880
    v_pk_fma_f16 v145, v121, v165, v145
    v_mfma_f32_16x16x32_bf16 v[214:217], v[230:233], a[184:187], v[214:217]
    s_waitcnt lgkmcnt(5)
    v_pk_mul_f16 v144, v150, v170
    v_pk_fma_f16 v144, v151, v171, v144
    v_mfma_f32_16x16x32_bf16 v[214:217], v[238:241], a[188:191], v[214:217]
    s_addc_u32 s9, s61, 0
    v_pk_fma_f16 v144, v152, v172, v144
    v_pk_fma_f16 v144, v153, v173, v144
    v_mfma_f32_16x16x32_bf16 v[246:249], v[186:189], a[192:195], 0
    s_sub_u32 s10, s36, s23
    v_pk_fma_f16 v144, v118, v162, v144
    v_pk_fma_f16 v144, v119, v163, v144
    v_mfma_f32_16x16x32_bf16 v[246:249], v[194:197], a[196:199], v[246:249]
    s_cmp_le_u32 s34, s45
    v_cvt_pk_bf16_f32 v134, v138, v139
    v_cvt_pk_bf16_f32 v135, v140, v141
    v_mfma_f32_16x16x32_f16 v[234:237], v[40:43], v[142:145], 0
    s_cselect_b32 s10, s10, 0
    v_cvt_pk_bf16_f32 v138, v214, v215
    v_cvt_pk_bf16_f32 v139, v216, v217
    v_mfma_f32_16x16x32_bf16 v[246:249], v[122:125], a[200:203], v[246:249]
    s_add_u32 m0, s28, 0
    v_mul_f32 v136, 0x3baaaaab, v166
    v_mul_f32 v255, 0x3baaaaab, v167
    v_mfma_f32_16x16x32_bf16 v[246:249], v[202:205], a[204:207], v[246:249]
    s_mov_b32 s27, s26
    v_rsq_f32 v234, v234
    v_mfma_f32_16x16x32_bf16 v[246:249], v[230:233], a[208:211], v[246:249]
    s_mov_b32 s26, s25
    v_rsq_f32 v235, v235
    v_mfma_f32_16x16x32_bf16 v[246:249], v[238:241], a[212:215], v[246:249]
    s_mov_b32 s25, s24
    v_mul_f32 v140, s31, v234
    v_cvt_pk_f16_f32 v141, v140, v235
    v_mfma_f32_16x16x32_bf16 v[122:125], a[72:75], v[182:185], 0
    s_waitcnt lgkmcnt(0)
    v_fma_f32 v236, v236, v140, v22
    v_fmac_f32_dpp v254, v237, v235 quad_perm:[0,1,2,3] row_mask:0x1 bank_mask:0xf
    v_mfma_f32_16x16x32_bf16 v[122:125], a[76:79], v[210:213], v[122:125]
    s_mov_b32 s24, s23
    v_cvt_pk_bf16_f32 v142, v246, v247
    v_cvt_pk_bf16_f32 v143, v248, v249
    v_mfma_f32_16x16x32_bf16 v[122:125], a[80:83], v[218:221], v[122:125]
    s_mov_b32 s71, s72
    v_pk_mul_f16 v146, v146, v141 op_sel:[0,1] op_sel_hi:[1,1]
    v_pk_mul_f16 v147, v147, v141 op_sel:[0,1] op_sel_hi:[1,1]
    v_mfma_f32_16x16x32_bf16 v[122:125], a[84:87], v[222:225], v[122:125]
    s_mov_b32 s72, s73
    v_pk_mul_f16 v148, v148, v141 op_sel:[0,1] op_sel_hi:[1,1]
    v_pk_mul_f16 v149, v149, v141 op_sel:[0,1] op_sel_hi:[1,1]
    v_mfma_f32_16x16x32_bf16 v[122:125], a[88:91], v[226:229], v[122:125]
    v_pk_mul_f16 v120, v120, v141 op_sel:[0,1] op_sel_hi:[1,1]
    v_pk_mul_f16 v121, v121, v141 op_sel:[0,1] op_sel_hi:[1,1]
    v_mfma_f32_16x16x32_bf16 v[122:125], a[92:95], v[190:193], v[122:125]
    v_pk_mul_f16 v150, v150, v141 op_sel:[0,0] op_sel_hi:[1,0]
    v_pk_mul_f16 v151, v151, v141 op_sel:[0,0] op_sel_hi:[1,0]
    v_mfma_f32_16x16x32_bf16 v[186:189], a[96:99], v[182:185], 0
    v_pk_mul_f16 v152, v152, v141 op_sel:[0,0] op_sel_hi:[1,0]
    v_pk_mul_f16 v153, v153, v141 op_sel:[0,0] op_sel_hi:[1,0]
    v_mfma_f32_16x16x32_bf16 v[186:189], a[100:103], v[210:213], v[186:189]
    v_pk_mul_f16 v118, v118, v141 op_sel:[0,0] op_sel_hi:[1,0]
    v_pk_mul_f16 v119, v119, v141 op_sel:[0,0] op_sel_hi:[1,0]
    v_mfma_f32_16x16x32_bf16 v[186:189], a[104:107], v[218:221], v[186:189]
    v_max3_u32 v44, v44, v234, v235
    v_mul_f32 v144, 0x3baaaaab, v168
    v_mfma_f32_16x16x32_bf16 v[186:189], a[108:111], v[222:225], v[186:189]
    v_rsq_f32 v136, v136
    v_mfma_f32_16x16x32_bf16 v[186:189], a[112:115], v[226:229], v[186:189]
    v_rsq_f32 v255, v255
    v_mfma_f32_16x16x32_bf16 v[186:189], a[116:119], v[190:193], v[186:189]
    v_rsq_f32 v144, v144
    v_mfma_f32_16x16x32_bf16 v[194:197], a[120:123], v[182:185], 0
    v_mul_f32 v178, v136, v178
    v_mul_f32 v179, v136, v179
    v_mfma_f32_16x16x32_bf16 v[194:197], a[124:127], v[210:213], v[194:197]
    v_cvt_pk_bf16_f32 v166, v178, v179
    v_mul_f32 v180, v136, v180
    v_mfma_f32_16x16x32_bf16 v[194:197], a[128:131], v[218:221], v[194:197]
    v_mul_f32 v181, v136, v181
    v_cvt_pk_bf16_f32 v167, v180, v181
    v_mfma_f32_16x16x32_bf16 v[194:197], a[132:135], v[222:225], v[194:197]
    v_mul_f32 v198, v136, v198
    v_mul_f32 v199, v136, v199
    v_mfma_f32_16x16x32_bf16 v[194:197], a[136:139], v[226:229], v[194:197]
    v_cvt_pk_bf16_f32 v168, v198, v199
    v_mul_f32 v200, v136, v200
    v_mfma_f32_16x16x32_bf16 v[194:197], a[140:143], v[190:193], v[194:197]
    v_mul_f32 v201, v136, v201
    v_cvt_pk_bf16_f32 v169, v200, v201
    v_mfma_f32_16x16x32_bf16 v[178:181], a[0:3], v[182:185], 0
    buffer_store_dwordx4 v[166:169], v15, s[12:15], 0 offen nt
    v_mul_f32 v206, v136, v206
    v_mul_f32 v207, v136, v207
    v_cvt_pk_bf16_f32 v140, v206, v207
    v_mul_f32 v208, v136, v208
    v_mfma_f32_16x16x32_bf16 v[178:181], a[4:7], v[210:213], v[178:181]
    v_mul_f32 v209, v136, v209
    v_cvt_pk_bf16_f32 v141, v208, v209
    v_mfma_f32_16x16x32_bf16 v[178:181], a[8:11], v[218:221], v[178:181]
    v_cvt_pk_f16_f32 v166, v122, v123
    v_pk_mul_f16 v199, v166, v166
    v_mfma_f32_16x16x32_bf16 v[178:181], a[12:15], v[222:225], v[178:181]
    v_cvt_pk_f16_f32 v167, v124, v125
    v_pk_fma_f16 v199, v167, v167, v199
    v_mfma_f32_16x16x32_bf16 v[178:181], a[16:19], v[226:229], v[178:181]
    v_cvt_pk_f16_f32 v168, v186, v187
    v_pk_fma_f16 v199, v168, v168, v199
    v_mfma_f32_16x16x32_bf16 v[178:181], a[20:23], v[190:193], v[178:181]
    v_cvt_pk_f16_f32 v169, v188, v189
    v_pk_fma_f16 v199, v169, v169, v199
    v_mfma_f32_16x16x32_bf16 v[186:189], a[24:27], v[182:185], 0
    v_cvt_pk_f16_f32 v124, v194, v195
    v_pk_fma_f16 v199, v124, v124, v199
    v_mfma_f32_16x16x32_bf16 v[186:189], a[28:31], v[210:213], v[186:189]
    v_cvt_pk_f16_f32 v125, v196, v197
    v_pk_fma_f16 v199, v125, v125, v199
    v_mfma_f32_16x16x32_bf16 v[186:189], a[32:35], v[218:221], v[186:189]
    v_cvt_pk_f16_f32 v178, v178, v179
    v_pk_mul_f16 v198, v178, v178
    v_mfma_f32_16x16x32_bf16 v[186:189], a[36:39], v[222:225], v[186:189]
    v_cvt_pk_f16_f32 v179, v180, v181
    v_pk_fma_f16 v198, v179, v179, v198
    v_mfma_f32_16x16x32_bf16 v[186:189], a[40:43], v[226:229], v[186:189]
    v_pk_mul_f16 v200, v178, v170
    v_pk_fma_f16 v200, v179, v171, v200
    v_mfma_f32_16x16x32_bf16 v[186:189], a[44:47], v[190:193], v[186:189]
    v_pk_mul_f16 v201, v166, v174
    v_pk_fma_f16 v201, v167, v175, v201
    v_mfma_f32_16x16x32_bf16 v[194:197], a[48:51], v[182:185], 0
    v_pk_fma_f16 v201, v168, v176, v201
    v_pk_fma_f16 v201, v169, v177, v201
    v_mfma_f32_16x16x32_bf16 v[194:197], a[52:55], v[210:213], v[194:197]
    v_pk_fma_f16 v201, v124, v164, v201
    v_pk_fma_f16 v201, v125, v165, v201
    v_mfma_f32_16x16x32_bf16 v[194:197], a[56:59], v[218:221], v[194:197]
    v_cvt_pk_f16_f32 v180, v186, v187
    v_pk_fma_f16 v198, v180, v180, v198
    v_mfma_f32_16x16x32_bf16 v[194:197], a[60:63], v[222:225], v[194:197]
    v_cvt_pk_f16_f32 v181, v188, v189
    v_pk_fma_f16 v198, v181, v181, v198
    v_mfma_f32_16x16x32_bf16 v[194:197], a[64:67], v[226:229], v[194:197]
    v_pk_fma_f16 v200, v180, v172, v200
    v_pk_fma_f16 v200, v181, v173, v200
    v_mfma_f32_16x16x32_bf16 v[194:197], a[68:71], v[190:193], v[194:197]
    buffer_store_dwordx2 v[140:141], v18, s[12:15], 0 offen nt
    v_mul_f32 v242, v144, v242
    v_mul_f32 v243, v144, v243
    v_mfma_f32_16x16x32_bf16 v[186:189], v[182:185], a[144:147], 0
    v_cvt_pk_bf16_f32 v238, v242, v243
    v_mul_f32 v244, v144, v244
    v_mfma_f32_16x16x32_bf16 v[186:189], v[210:213], a[148:151], v[186:189]
    v_mul_f32 v245, v144, v245
    v_cvt_pk_f16_f32 v122, v194, v195
    v_mfma_f32_16x16x32_bf16 v[186:189], v[218:221], a[152:155], v[186:189]
    v_pk_fma_f16 v198, v122, v122, v198
    v_cvt_pk_f16_f32 v123, v196, v197
    v_mfma_f32_16x16x32_bf16 v[186:189], v[222:225], a[156:159], v[186:189]
    v_pk_fma_f16 v198, v123, v123, v198
    v_pk_fma_f16 v200, v122, v162, v200
    v_mfma_f32_16x16x32_bf16 v[186:189], v[226:229], a[160:163], v[186:189]
    ds_read_b128 v[202:205], v0 offset:32768
    v_pk_fma_f16 v200, v123, v163, v200
    v_mfma_f32_16x16x32_bf16 v[186:189], v[190:193], a[164:167], v[186:189]
    ds_read_b128 v[194:197], v1 offset:32768
    v_cvt_pk_bf16_f32 v239, v244, v245
    v_mfma_f32_16x16x32_f16 v[230:233], v[40:43], v[198:201], 0
    v_mul_f32 v158, v144, v158
    v_mul_f32 v159, v144, v159
    v_mfma_f32_16x16x32_bf16 v[246:249], v[182:185], a[168:171], 0
    ds_read_b128 v[214:217], v0 offset:32896
    v_cvt_pk_bf16_f32 v240, v158, v159
    v_mfma_f32_16x16x32_bf16 v[246:249], v[210:213], a[172:175], v[246:249]
    ds_read_b128 v[206:209], v1 offset:32896
    v_cvt_pk_bf16_f32 v136, v186, v187
    v_mfma_f32_16x16x32_bf16 v[246:249], v[218:221], a[176:179], v[246:249]
    ds_read_b128 v[198:201], v0 offset:33024
    v_cvt_pk_bf16_f32 v137, v188, v189
    v_mfma_f32_16x16x32_bf16 v[246:249], v[222:225], a[180:183], v[246:249]
    ds_read_b128 v[186:189], v1 offset:33024
    v_mul_f32 v160, v144, v160
    v_mfma_f32_16x16x32_bf16 v[246:249], v[226:229], a[184:187], v[246:249]
    v_rsq_f32 v230, v230
    v_mfma_f32_16x16x32_bf16 v[246:249], v[190:193], a[188:191], v[246:249]
    s_waitcnt lgkmcnt(5)
    v_rsq_f32 v231, v231
    v_mfma_f32_16x16x32_bf16 v[242:245], v[182:185], a[192:195], 0
    s_waitcnt lgkmcnt(4)
    v_mul_f32 v234, s31, v230
    v_cvt_pk_f16_f32 v235, v234, v231
    v_mfma_f32_16x16x32_bf16 v[242:245], v[210:213], a[196:199], v[242:245]
    v_fma_f32 v232, v232, v234, v24
    v_fmac_f32_dpp v254, v233, v231 quad_perm:[0,1,2,3] row_mask:0x2 bank_mask:0xf
    v_mfma_f32_16x16x32_bf16 v[242:245], v[218:221], a[200:203], v[242:245]
    s_waitcnt lgkmcnt(3)
    v_cvt_pk_bf16_f32 v140, v246, v247
    v_cvt_pk_bf16_f32 v141, v248, v249
    v_mfma_f32_16x16x32_bf16 v[242:245], v[222:225], a[204:207], v[242:245]
    s_waitcnt lgkmcnt(2)
    v_mul_f32 v161, v144, v161
    v_cvt_pk_bf16_f32 v241, v160, v161
    v_mfma_f32_16x16x32_bf16 v[242:245], v[226:229], a[208:211], v[242:245]
    s_waitcnt lgkmcnt(1)
    buffer_store_dwordx4 v[238:241], v17, s[12:15], 0 offen nt
    v_mul_f32 v154, v144, v154
    v_mul_f32 v155, v144, v155
    v_cvt_pk_bf16_f32 v154, v154, v155
    v_mul_f32 v156, v144, v156
    v_mfma_f32_16x16x32_bf16 v[242:245], v[190:193], a[212:215], v[242:245]
    s_waitcnt lgkmcnt(0)
    v_mul_f32 v157, v144, v157
    v_cvt_pk_bf16_f32 v155, v156, v157
    v_mfma_f32_16x16x32_bf16 v[158:161], a[72:75], v[202:205], 0
    v_pk_mul_f16 v166, v166, v235 op_sel:[0,1] op_sel_hi:[1,1]
    v_pk_mul_f16 v167, v167, v235 op_sel:[0,1] op_sel_hi:[1,1]
    v_mfma_f32_16x16x32_bf16 v[158:161], a[76:79], v[194:197], v[158:161]
    v_pk_mul_f16 v168, v168, v235 op_sel:[0,1] op_sel_hi:[1,1]
    v_cvt_pk_bf16_f32 v144, v242, v243
    v_mfma_f32_16x16x32_bf16 v[158:161], a[80:83], v[214:217], v[158:161]
    v_cvt_pk_bf16_f32 v145, v244, v245
    v_pk_mul_f16 v169, v169, v235 op_sel:[0,1] op_sel_hi:[1,1]
    v_mfma_f32_16x16x32_bf16 v[158:161], a[84:87], v[206:209], v[158:161]
    v_pk_mul_f16 v124, v124, v235 op_sel:[0,1] op_sel_hi:[1,1]
    v_pk_mul_f16 v125, v125, v235 op_sel:[0,1] op_sel_hi:[1,1]
    v_mfma_f32_16x16x32_bf16 v[158:161], a[88:91], v[198:201], v[158:161]
    v_pk_mul_f16 v178, v178, v235 op_sel:[0,0] op_sel_hi:[1,0]
    v_pk_mul_f16 v179, v179, v235 op_sel:[0,0] op_sel_hi:[1,0]
    v_mfma_f32_16x16x32_bf16 v[158:161], a[92:95], v[186:189], v[158:161]
    v_pk_mul_f16 v180, v180, v235 op_sel:[0,0] op_sel_hi:[1,0]
    v_pk_mul_f16 v181, v181, v235 op_sel:[0,0] op_sel_hi:[1,0]
    v_mfma_f32_16x16x32_bf16 v[182:185], a[96:99], v[202:205], 0
    v_pk_mul_f16 v122, v122, v235 op_sel:[0,0] op_sel_hi:[1,0]
    v_pk_mul_f16 v123, v123, v235 op_sel:[0,0] op_sel_hi:[1,0]
    v_mfma_f32_16x16x32_bf16 v[182:185], a[100:103], v[194:197], v[182:185]
    v_max3_u32 v44, v44, v230, v231
    v_mul_f32 v130, v255, v130
    v_mfma_f32_16x16x32_bf16 v[182:185], a[104:107], v[214:217], v[182:185]
    v_cvt_pk_f16_f32 v158, v158, v159
    v_pk_mul_f16 v191, v158, v158
    v_mfma_f32_16x16x32_bf16 v[182:185], a[108:111], v[206:209], v[182:185]
    v_cvt_pk_f16_f32 v159, v160, v161
    v_pk_fma_f16 v191, v159, v159, v191
    v_mfma_f32_16x16x32_bf16 v[182:185], a[112:115], v[198:201], v[182:185]
    v_pk_mul_f16 v193, v158, v174
    v_pk_fma_f16 v193, v159, v175, v193
    v_mfma_f32_16x16x32_bf16 v[182:185], a[116:119], v[186:189], v[182:185]
    v_exp_f32 v232, v232
    v_mfma_f32_16x16x32_bf16 v[210:213], a[120:123], v[202:205], 0
    v_exp_f32 v236, v236
    v_mfma_f32_16x16x32_bf16 v[210:213], a[124:127], v[194:197], v[210:213]
    v_cvt_pk_bf16_f32 v39, v236, 0
    v_mul_f32 v131, v255, v131
    v_mfma_f32_16x16x32_bf16 v[210:213], a[128:131], v[214:217], v[210:213]
    s_waitcnt vmcnt(3)
    ds_write_b16 v8, v45 offset:512
    v_mfma_f32_16x16x32_bf16 v[210:213], a[132:135], v[206:209], v[210:213]
    buffer_store_dwordx2 v[154:155], v20, s[12:15], 0 offen nt
    v_mov_b32 v45, 1
    v_cvt_pk_f16_f32 v160, v182, v183
    v_mfma_f32_16x16x32_bf16 v[210:213], a[136:139], v[198:201], v[210:213]
    v_pk_fma_f16 v191, v160, v160, v191
    v_cvt_pk_f16_f32 v161, v184, v185
    v_mfma_f32_16x16x32_bf16 v[210:213], a[140:143], v[186:189], v[210:213]
    v_pk_fma_f16 v191, v161, v161, v191
    v_pk_fma_f16 v193, v160, v176, v193
    v_mfma_f32_16x16x32_bf16 v[154:157], a[0:3], v[202:205], 0
    v_pk_fma_f16 v193, v161, v177, v193
    v_cvt_pk_bf16_f32 v130, v130, v131
    v_mfma_f32_16x16x32_bf16 v[154:157], a[4:7], v[194:197], v[154:157]
    v_mul_f32 v132, v255, v132
    v_mul_f32 v133, v255, v133
    v_mfma_f32_16x16x32_bf16 v[154:157], a[8:11], v[214:217], v[154:157]
    v_cvt_pk_f16_f32 v176, v210, v211
    v_pk_fma_f16 v191, v176, v176, v191
    v_mfma_f32_16x16x32_bf16 v[154:157], a[12:15], v[206:209], v[154:157]
    s_waitcnt lgkmcnt(0)
    v_cvt_pk_f16_f32 v177, v212, v213
    v_pk_fma_f16 v191, v177, v177, v191
    v_mfma_f32_16x16x32_bf16 v[154:157], a[16:19], v[198:201], v[154:157]
    s_barrier
    v_pk_fma_f16 v193, v176, v164, v193
    v_mfma_f32_16x16x32_bf16 v[154:157], a[20:23], v[186:189], v[154:157]
    v_pk_fma_f16 v193, v177, v165, v193
    v_mfma_f32_16x16x32_bf16 v[182:185], a[24:27], v[202:205], 0
    v_cvt_pk_bf16_f32 v131, v132, v133
    v_mfma_f32_16x16x32_bf16 v[182:185], a[28:31], v[194:197], v[182:185]
    ds_read2_b32 v[164:165], v6 offset0:0 offset1:0
    v_mfma_f32_16x16x32_bf16 v[182:185], a[32:35], v[214:217], v[182:185]
    ds_read2_b32 v[212:213], v6 offset0:16 offset1:16
    s_nop 0
    v_cvt_pk_f16_f32 v154, v154, v155
    v_mfma_f32_16x16x32_bf16 v[182:185], a[36:39], v[206:209], v[182:185]
    ds_read2_b32 v[220:221], v6 offset0:32 offset1:32
    v_pk_mul_f16 v190, v154, v154
    v_mfma_f32_16x16x32_bf16 v[182:185], a[40:43], v[198:201], v[182:185]
    ds_read_u16 v133, v9 offset:512
    v_cvt_pk_f16_f32 v155, v156, v157
    v_mfma_f32_16x16x32_bf16 v[182:185], a[44:47], v[186:189], v[182:185]
    v_pk_fma_f16 v190, v155, v155, v190
    v_pk_mul_f16 v192, v154, v170
    v_mfma_f32_16x16x32_bf16 v[222:225], a[48:51], v[202:205], 0
    v_pk_fma_f16 v192, v155, v171, v192
    v_mul_f32 v126, v255, v126
    v_mfma_f32_16x16x32_bf16 v[222:225], a[52:55], v[194:197], v[222:225]
    v_mul_f32 v127, v255, v127
    v_cvt_pk_bf16_f32 v132, v126, v127
    v_mfma_f32_16x16x32_bf16 v[222:225], a[56:59], v[214:217], v[222:225]
    buffer_load_dwordx4 v10, s[8:11], 0 offen nt lds
    v_cvt_pk_f16_f32 v156, v182, v183
    v_mfma_f32_16x16x32_bf16 v[222:225], a[60:63], v[206:209], v[222:225]
    s_add_u32 m0, s28, 4096
    v_pk_fma_f16 v190, v156, v156, v190
    v_cvt_pk_f16_f32 v157, v184, v185
    v_mfma_f32_16x16x32_bf16 v[222:225], a[64:67], v[198:201], v[222:225]
    s_waitcnt lgkmcnt(2)
    v_pk_fma_f16 v190, v157, v157, v190
    v_pk_fma_f16 v192, v156, v172, v192
    v_mfma_f32_16x16x32_bf16 v[222:225], a[68:71], v[186:189], v[222:225]
    s_waitcnt lgkmcnt(1)
    ds_read_b128 v[182:185], v2 offset:0
    v_pk_fma_f16 v192, v157, v173, v192
    v_mfma_f32_16x16x32_bf16 v[170:173], v[202:205], a[144:147], 0
    s_waitcnt lgkmcnt(1)
    ds_read_b128 v[226:229], v2 offset:1024
    v_readfirstlane_b32 s77, v133
    v_mfma_f32_16x16x32_bf16 v[170:173], v[194:197], a[148:151], v[170:173]
    ds_read_b128 v[234:237], v2 offset:2048
    buffer_load_dwordx4 v11, s[8:11], 0 offen nt lds
    v_mfma_f32_16x16x32_bf16 v[170:173], v[214:217], a[152:155], v[170:173]
    s_add_u32 m0, s28, 8192
    ds_read_b128 v[238:241], v2 offset:3072
    v_cvt_pk_f16_f32 v174, v222, v223
    v_mfma_f32_16x16x32_bf16 v[170:173], v[206:209], a[156:159], v[170:173]
    s_mul_i32 s78, s77, 2688
    ds_read_b128 v[242:245], v2 offset:4096
    v_pk_fma_f16 v190, v174, v174, v190
    v_mfma_f32_16x16x32_bf16 v[170:173], v[198:201], a[160:163], v[170:173]
    ds_read_b128 v[246:249], v2 offset:5120
    v_cvt_pk_f16_f32 v175, v224, v225
    v_mfma_f32_16x16x32_bf16 v[170:173], v[186:189], a[164:167], v[170:173]
    v_pk_fma_f16 v190, v175, v175, v190
    v_pk_fma_f16 v192, v174, v162, v192
    v_mfma_f32_16x16x32_bf16 v[222:225], v[202:205], a[168:171], 0
    buffer_load_dwordx4 v12, s[8:11], 0 offen nt lds
    v_pk_fma_f16 v192, v175, v163, v192
    v_mfma_f32_16x16x32_bf16 v[222:225], v[194:197], a[172:175], v[222:225]
    s_waitcnt lgkmcnt(5)
    v_mul_f32 v128, v255, v128
    v_cvt_pk_bf16_f32 v162, v170, v171
    v_mfma_f32_16x16x32_f16 v[250:253], v[40:43], v[190:193], 0
    s_add_u32 m0, s28, 12288
    v_cvt_pk_bf16_f32 v163, v172, v173
    v_mul_f32 v129, v255, v129
    v_mfma_f32_16x16x32_bf16 v[222:225], v[214:217], a[176:179], v[222:225]
    s_xor_b32 s28, s28, 65536
    v_cvt_pk_bf16_f32 v133, v128, v129
    v_mul_f32 v114, v255, v114
    v_mfma_f32_16x16x32_bf16 v[222:225], v[206:209], a[180:183], v[222:225]
    s_waitcnt lgkmcnt(2)
    v_rsq_f32 v250, v250
    v_mfma_f32_16x16x32_bf16 v[222:225], v[198:201], a[184:187], v[222:225]
    s_waitcnt lgkmcnt(1)
    buffer_load_dwordx4 v13, s[8:11], 0 offen nt lds
    v_mul_f32 v230, s31, v250
    v_mfma_f32_16x16x32_bf16 v[222:225], v[186:189], a[188:191], v[222:225]
    s_mov_b32 m0, s29
    v_rsq_f32 v251, v251
    v_mfma_f32_16x16x32_bf16 v[126:129], v[202:205], a[192:195], 0
    s_xor_b32 s29, s29, s30
    v_cvt_pk_f16_f32 v231, v230, v251
    v_fma_f32 v252, v252, v230, v26
    v_mfma_f32_16x16x32_bf16 v[126:129], v[194:197], a[196:199], v[126:129]
    s_add_u32 s19, s19, s20
    v_fmac_f32_dpp v254, v253, v251 quad_perm:[0,1,2,3] row_mask:0x4 bank_mask:0xf
    v_cvt_pk_bf16_f32 v210, v222, v223
    v_mfma_f32_16x16x32_bf16 v[126:129], v[214:217], a[200:203], v[126:129]
    s_add_u32 s23, s23, s21
    v_cvt_pk_bf16_f32 v211, v224, v225
    v_pk_mul_f16 v158, v158, v231 op_sel:[0,1] op_sel_hi:[1,1]
    v_mfma_f32_16x16x32_bf16 v[126:129], v[206:209], a[204:207], v[126:129]
    s_waitcnt lgkmcnt(0)
    buffer_load_dwordx4 v14, s[8:11], 0 offen nt lds
    v_pk_mul_f16 v159, v159, v231 op_sel:[0,1] op_sel_hi:[1,1]
    v_mfma_f32_16x16x32_bf16 v[126:129], v[198:201], a[208:211], v[126:129]
    s_cmp_ge_u32 s19, 72
    v_pk_mul_f16 v160, v160, v231 op_sel:[0,1] op_sel_hi:[1,1]
    v_pk_mul_f16 v161, v161, v231 op_sel:[0,1] op_sel_hi:[1,1]
    v_mfma_f32_16x16x32_bf16 v[126:129], v[186:189], a[212:215], v[126:129]
    s_cselect_b32 s34, 72, 0
    v_pk_mul_f16 v176, v176, v231 op_sel:[0,1] op_sel_hi:[1,1]
    v_pk_mul_f16 v177, v177, v231 op_sel:[0,1] op_sel_hi:[1,1]
    v_mfma_f32_16x16x32_f16 v[170:173], v[146:149], v[150:153], v[46:49]
    s_cselect_b32 s35, s22, 0
    v_pk_mul_f16 v154, v154, v231 op_sel:[0,0] op_sel_hi:[1,0]
    v_pk_mul_f16 v155, v155, v231 op_sel:[0,0] op_sel_hi:[1,0]
    v_mfma_f32_16x16x32_f16 v[186:189], v[166:169], v[150:153], v[50:53]
    s_sub_u32 s19, s19, s34
    v_cvt_pk_bf16_f32 v218, v126, v127
    v_cvt_pk_bf16_f32 v219, v128, v129
    v_mfma_f32_16x16x32_f16 v[126:129], v[158:161], v[150:153], v[54:57]
    buffer_store_dwordx4 v[130:133], v16, s[12:15], 0 offen nt
    v_pk_mul_f16 v156, v156, v231 op_sel:[0,0] op_sel_hi:[1,0]
    v_pk_mul_f16 v157, v157, v231 op_sel:[0,0] op_sel_hi:[1,0]
    v_pk_mul_f16 v174, v174, v231 op_sel:[0,0] op_sel_hi:[1,0]
    v_pk_mul_f16 v175, v175, v231 op_sel:[0,0] op_sel_hi:[1,0]
    v_mfma_f32_16x16x16_f16 v[170:173], v[120:121], v[118:119], v[170:173]
    v_max3_u32 v44, v44, v250, v251
    v_exp_f32 v254, v254
    v_mfma_f32_16x16x16_f16 v[186:189], v[124:125], v[118:119], v[186:189]
    v_cvt_pk_bf16_f32 v254, v254, v254
    v_exp_f32 v252, v252
    v_mfma_f32_16x16x16_f16 v[126:129], v[176:177], v[118:119], v[126:129]
    v_mul_f32 v115, v255, v115
    v_cvt_pk_bf16_f32 v118, v114, v115
    v_exp_f32 v170, v170
    v_mfma_f32_16x16x32_f16 v[130:133], v[146:149], v[178:181], v[58:61]
    s_add_u32 s23, s23, s35
    ds_write_b16 v8, v254
    v_mfma_f32_16x16x32_f16 v[150:153], v[166:169], v[178:181], v[62:65]
    s_add_u32 s78, s78, s69
    v_exp_f32 v171, v171
    v_mfma_f32_16x16x32_f16 v[190:193], v[158:161], v[178:181], v[66:69]
    s_add_u32 s80, s77, s68
    v_cvt_pk_bf16_f32 v170, v170, v171
    v_exp_f32 v172, v172
    v_mfma_f32_16x16x16_f16 v[130:133], v[120:121], v[122:123], v[130:133]
    v_exp_f32 v173, v173
    v_mul_f32 v116, v255, v116
    v_mfma_f32_16x16x16_f16 v[150:153], v[124:125], v[122:123], v[150:153]
    v_cvt_pk_bf16_f32 v171, v172, v173
    v_exp_f32 v186, v186
    v_mfma_f32_16x16x16_f16 v[190:193], v[176:177], v[122:123], v[190:193]
    v_exp_f32 v187, v187
    v_exp_f32 v188, v188
    v_mfma_f32_16x16x32_bf16 v[178:181], a[216:219], v[182:185], 0
    s_cmp_ge_u32 s80, 72
    v_exp_f32 v130, v130
    v_mfma_f32_16x16x32_bf16 v[178:181], a[220:223], v[226:229], v[178:181]
    s_cselect_b32 s80, s22, 0
    v_exp_f32 v131, v131
    v_mfma_f32_16x16x32_bf16 v[178:181], a[224:227], v[234:237], v[178:181]
    s_add_u32 s78, s78, s80
    v_cvt_pk_bf16_f32 v194, v130, v131
    v_cvt_pk_bf16_f32 v172, v186, v187
    v_mfma_f32_16x16x32_bf16 v[178:181], a[228:231], v[238:241], v[178:181]
    s_add_u32 s80, s77, 20
    v_exp_f32 v132, v132
    v_mfma_f32_16x16x32_bf16 v[178:181], a[232:235], v[242:245], v[178:181]
    s_add_u32 s34, s18, 3
    v_exp_f32 v133, v133
    v_mfma_f32_16x16x32_bf16 v[178:181], a[236:239], v[246:249], v[178:181]
    s_cmp_lt_u32 s77, s62
    v_cvt_pk_bf16_f32 v195, v132, v133
    v_mul_f32 v117, v255, v117
    v_mfma_f32_16x16x32_bf16 v[198:201], a[240:243], v[182:185], 0
    s_cselect_b32 s79, 1, 0
    v_exp_f32 v150, v150
    v_mfma_f32_16x16x32_f16 v[202:205], v[146:149], v[154:157], v[70:73]
    s_cselect_b32 s78, s78, 0
    v_exp_f32 v151, v151
    v_mfma_f32_16x16x32_f16 v[146:149], v[166:169], v[154:157], v[74:77]
    s_cmp_lt_u32 s34, s17
    v_cvt_pk_bf16_f32 v196, v150, v151
    v_cvt_pk_bf16_f32 v119, v116, v117
    v_mfma_f32_16x16x32_f16 v[166:169], v[158:161], v[154:157], v[78:81]
    buffer_store_dwordx2 v[118:119], v19, s[12:15], 0 offen nt
    v_exp_f32 v152, v152
    v_mfma_f32_16x16x16_f16 v[202:205], v[120:121], v[174:175], v[202:205]
    v_exp_f32 v153, v153
    v_fma_f32 v254, v178, v178, s33
    v_mfma_f32_16x16x16_f16 v[146:149], v[124:125], v[174:175], v[146:149]
    v_cvt_pk_bf16_f32 v197, v152, v153
    v_exp_f32 v190, v190
    v_mfma_f32_16x16x16_f16 v[166:169], v[176:177], v[174:175], v[166:169]
    v_exp_f32 v191, v191
    v_exp_f32 v192, v192
    v_mfma_f32_16x16x32_bf16 v[198:201], a[244:247], v[226:229], v[198:201]
    s_cselect_b32 s23, s23, s78
    v_exp_f32 v193, v193
    v_mfma_f32_16x16x32_bf16 v[198:201], a[248:251], v[234:237], v[198:201]
    s_cselect_b32 s73, s34, s80
    ds_read_b128 v[118:121], v2 offset:6144
    v_fmac_f32 v254, v179, v179
    v_mfma_f32_16x16x32_bf16 v[198:201], a[252:255], v[238:241], v[198:201]
    s_cselect_b32 s79, 0, s79
    ds_read_b128 v[122:125], v2 offset:7168
    v_fmac_f32 v254, v180, v180
    v_mfma_f32_16x16x32_bf16 v[198:201], v[82:85], v[242:245], v[198:201]
    s_cselect_b32 s81, 0, 1
    ds_read_b128 v[150:153], v2 offset:8192
    v_fmac_f32 v254, v181, v181
    v_mfma_f32_16x16x32_bf16 v[198:201], v[86:89], v[246:249], v[198:201]
    s_add_u32 s80, s77, 1
    ds_read_b128 v[154:157], v2 offset:9216
    v_xor_b32 v0, 65536, v0
    v_mfma_f32_16x16x32_bf16 v[206:209], v[90:93], v[182:185], 0
    s_mul_i32 s80, s80, s81
    ds_read_b128 v[158:161], v2 offset:10240
    v_xor_b32 v1, 65536, v1
    v_mfma_f32_16x16x32_bf16 v[206:209], v[94:97], v[226:229], v[206:209]
    s_cmp_lt_u32 s80, s62
    ds_read_b128 v[174:177], v2 offset:11264
    v_fmac_f32 v254, v198, v198
    v_mfma_f32_16x16x32_bf16 v[206:209], v[98:101], v[234:237], v[206:209]
    s_cselect_b32 s62, s62, 0
    v_exp_f32 v189, v189
    v_mfma_f32_16x16x32_bf16 v[206:209], v[102:105], v[238:241], v[206:209]
    s_add_u32 s80, s18, 4
    v_cvt_pk_bf16_f32 v173, v188, v189
    v_fmac_f32 v254, v199, v199
    v_mfma_f32_16x16x32_bf16 v[206:209], v[106:109], v[242:245], v[206:209]
    s_waitcnt lgkmcnt(5)
    v_exp_f32 v126, v126
    v_mfma_f32_16x16x32_bf16 v[206:209], v[110:113], v[246:249], v[206:209]
    s_cmp_ge_u32 s80, s17
    v_exp_f32 v127, v127
    v_mfma_f32_16x16x32_bf16 v[130:133], a[216:219], v[118:121], 0
    s_waitcnt lgkmcnt(3)
    v_cvt_pk_bf16_f32 v36, v126, v127
    v_fmac_f32 v254, v200, v200
    v_mfma_f32_16x16x32_bf16 v[130:133], a[220:223], v[122:125], v[130:133]
    s_cselect_b32 s66, s62, 0
    v_exp_f32 v128, v128
    v_mfma_f32_16x16x32_bf16 v[130:133], a[224:227], v[150:153], v[130:133]
    s_waitcnt lgkmcnt(1)
    buffer_atomic_add v45, v10, s[64:67], 0 offen sc0 sc1
    v_fmac_f32 v254, v201, v201
    v_mfma_f32_16x16x32_bf16 v[130:133], a[228:231], v[154:157], v[130:133]
    s_lshl_b32 s80, s79, s73
    v_exp_f32 v129, v129
    v_mfma_f32_16x16x32_bf16 v[130:133], a[232:235], v[158:161], v[130:133]
    s_waitcnt lgkmcnt(0)
    v_cvt_pk_bf16_f32 v37, v128, v129
    v_fmac_f32 v254, v206, v206
    v_mfma_f32_16x16x32_bf16 v[130:133], a[236:239], v[174:177], v[130:133]
    s_or_b32 s70, s70, s80
    v_exp_f32 v202, v202
    v_mfma_f32_16x16x32_bf16 v[182:185], v[28:31], v[36:39], 0
    s_add_u32 s45, s45, s79
    v_exp_f32 v203, v203
    v_mfma_f32_16x16x32_bf16 v[182:185], v[28:31], v[170:173], v[182:185]
    s_add_u32 s18, s18, 1
    v_cvt_pk_bf16_f32 v186, v202, v203
    v_fma_f32 v255, v130, v130, s33
    v_mfma_f32_16x16x32_bf16 v[214:217], v[162:165], v[36:39], 0
    s_cmp_lt_u32 s18, s45
    v_fmac_f32 v255, v131, v131
    v_fmac_f32 v255, v132, v132
    v_mfma_f32_16x16x32_bf16 v[214:217], v[134:137], v[170:173], v[214:217]
    v_fmac_f32 v255, v133, v133
    v_fmac_f32 v254, v207, v207
    v_mfma_f32_16x16x32_bf16 v[222:225], v[210:213], v[36:39], 0
    v_exp_f32 v204, v204
    v_mfma_f32_16x16x32_bf16 v[222:225], v[138:141], v[170:173], v[222:225]
    v_exp_f32 v205, v205
    v_mfma_f32_16x16x32_bf16 v[226:229], v[218:221], v[36:39], 0
    v_cvt_pk_bf16_f32 v36, v190, v191
    v_cvt_pk_bf16_f32 v37, v192, v193
    v_mfma_f32_16x16x32_bf16 v[226:229], v[142:145], v[170:173], v[226:229]
    v_cvt_pk_bf16_f32 v39, v232, 0
    v_cvt_pk_bf16_f32 v187, v204, v205
    v_mfma_f32_16x16x32_bf16 v[126:129], a[240:243], v[118:121], 0
    v_exp_f32 v146, v146
    v_mfma_f32_16x16x32_bf16 v[170:173], v[28:31], v[36:39], 0
    v_exp_f32 v147, v147
    v_mfma_f32_16x16x32_bf16 v[170:173], v[28:31], v[194:197], v[170:173]
    v_cvt_pk_bf16_f32 v188, v146, v147
    v_fmac_f32 v254, v208, v208
    v_mfma_f32_16x16x32_bf16 v[114:117], v[162:165], v[36:39], 0
    v_exp_f32 v148, v148
    v_mfma_f32_16x16x32_bf16 v[114:117], v[134:137], v[194:197], v[114:117]
    v_exp_f32 v149, v149
    v_mfma_f32_16x16x32_bf16 v[190:193], v[210:213], v[36:39], 0
    v_cvt_pk_bf16_f32 v189, v148, v149
    v_fmac_f32 v254, v209, v209
    v_mfma_f32_16x16x32_bf16 v[190:193], v[138:141], v[194:197], v[190:193]
    v_rcp_f32 v171, v170
    v_mfma_f32_16x16x32_bf16 v[146:149], v[218:221], v[36:39], 0
    v_exp_f32 v166, v166
    v_mfma_f32_16x16x32_bf16 v[146:149], v[142:145], v[194:197], v[146:149]
    v_mul_f32 v114, v171, v114
    v_mul_f32 v115, v171, v115
    v_mfma_f32_16x16x32_bf16 v[126:129], a[244:247], v[122:125], v[126:129]
    v_cvt_pk_bf16_f32 v194, v114, v115
    v_mul_f32 v116, v171, v116
    v_mfma_f32_16x16x32_bf16 v[126:129], a[248:251], v[150:153], v[126:129]
    ds_read_b128 v[202:205], v2 offset:12288
    v_mul_f32 v117, v171, v117
    v_mfma_f32_16x16x32_bf16 v[126:129], a[252:255], v[154:157], v[126:129]
    ds_read_b128 v[230:233], v2 offset:13312
    v_cvt_pk_bf16_f32 v195, v116, v117
    v_mfma_f32_16x16x32_bf16 v[126:129], v[82:85], v[158:161], v[126:129]
    ds_read_b128 v[234:237], v2 offset:14336
    v_mul_f32 v190, v171, v190
    v_mfma_f32_16x16x32_bf16 v[126:129], v[86:89], v[174:177], v[126:129]
    ds_read_b128 v[238:241], v2 offset:15360
    v_mul_f32 v191, v171, v191
    v_mfma_f32_16x16x32_bf16 v[114:117], v[90:93], v[118:121], 0
    ds_read_b128 v[118:121], v2 offset:16384
    v_cvt_pk_bf16_f32 v196, v190, v191
    v_mfma_f32_16x16x32_bf16 v[114:117], v[94:97], v[122:125], v[114:117]
    ds_read_b128 v[122:125], v2 offset:17408
    v_mul_f32 v192, v171, v192
    v_mfma_f32_16x16x32_bf16 v[114:117], v[98:101], v[150:153], v[114:117]
    v_fmac_f32 v255, v126, v126
    v_fmac_f32 v255, v127, v127
    v_mfma_f32_16x16x32_bf16 v[114:117], v[102:105], v[154:157], v[114:117]
    v_fmac_f32 v255, v128, v128
    v_fmac_f32 v255, v129, v129
    v_mfma_f32_16x16x32_bf16 v[114:117], v[106:109], v[158:161], v[114:117]
    s_waitcnt lgkmcnt(5)
    v_mul_f32 v193, v171, v193
    v_cvt_pk_bf16_f32 v197, v192, v193
    v_mfma_f32_16x16x32_bf16 v[114:117], v[110:113], v[174:177], v[114:117]
    s_waitcnt lgkmcnt(4)
    ds_write_b128 v3, v[194:197] offset:6144
    v_mfma_f32_16x16x32_bf16 v[242:245], a[216:219], v[202:205], 0
    s_waitcnt lgkmcnt(3)
    v_mul_f32 v146, v171, v146
    v_mul_f32 v147, v171, v147
    v_mfma_f32_16x16x32_bf16 v[242:245], a[220:223], v[230:233], v[242:245]
    s_waitcnt lgkmcnt(2)
    v_fmac_f32 v255, v114, v114
    v_fmac_f32 v255, v115, v115
    v_mfma_f32_16x16x32_bf16 v[242:245], a[224:227], v[234:237], v[242:245]
    s_waitcnt lgkmcnt(1)
    v_fmac_f32 v255, v116, v116
    v_fmac_f32 v255, v117, v117
    v_mfma_f32_16x16x32_bf16 v[242:245], a[228:231], v[238:241], v[242:245]
    v_cvt_pk_bf16_f32 v254, v254, v255
    v_cvt_pk_bf16_f32 v172, v146, v147
    v_mfma_f32_16x16x32_bf16 v[242:245], a[232:235], v[118:121], v[242:245]
    v_mul_f32 v148, v171, v148
    v_mul_f32 v149, v171, v149
    v_mfma_f32_16x16x32_bf16 v[242:245], a[236:239], v[122:125], v[242:245]
    v_cvt_pk_bf16_f32 v173, v148, v149
    v_cvt_pk_bf16_f32 v39, v252, 0
    v_mfma_f32_16x16x32_bf16 v[158:161], a[240:243], v[202:205], 0
    ds_write_b64 v4, v[172:173] offset:10240
    v_mfma_f32_16x16x32_bf16 v[158:161], a[244:247], v[230:233], v[158:161]
    v_exp_f32 v167, v167
    v_mfma_f32_16x16x32_bf16 v[158:161], a[248:251], v[234:237], v[158:161]
    v_cvt_pk_bf16_f32 v36, v166, v167
    v_fma_f32 v255, v242, v242, s33
    v_mfma_f32_16x16x32_bf16 v[158:161], a[252:255], v[238:241], v[158:161]
    v_fmac_f32 v255, v243, v243
    v_fmac_f32 v255, v244, v244
    v_mfma_f32_16x16x32_bf16 v[158:161], v[82:85], v[118:121], v[158:161]
    v_fmac_f32 v255, v245, v245
    v_xor_b32 v2, 65536, v2
    v_mfma_f32_16x16x32_bf16 v[158:161], v[86:89], v[122:125], v[158:161]
    v_exp_f32 v168, v168
    v_mfma_f32_16x16x32_bf16 v[154:157], v[90:93], v[202:205], 0
    v_exp_f32 v169, v169
    v_mfma_f32_16x16x32_bf16 v[154:157], v[94:97], v[230:233], v[154:157]
    ds_read_b128 v[146:149], v9
    v_cvt_pk_bf16_f32 v37, v168, v169
    v_mfma_f32_16x16x32_bf16 v[154:157], v[98:101], v[234:237], v[154:157]
    ds_read_b128 v[150:153], v9 offset:64
    v_fmac_f32 v255, v158, v158
    v_mfma_f32_16x16x32_bf16 v[166:169], v[28:31], v[36:39], 0
    v_fmac_f32 v255, v159, v159
    v_fmac_f32 v255, v160, v160
    v_mfma_f32_16x16x32_bf16 v[166:169], v[28:31], v[186:189], v[166:169]
    v_fmac_f32 v255, v161, v161
    v_add_u32 v6, s75, v6
    v_mfma_f32_16x16x32_bf16 v[174:177], v[162:165], v[36:39], 0
    v_rcp_f32 v183, v182
    v_mfma_f32_16x16x32_bf16 v[174:177], v[134:137], v[186:189], v[174:177]
    v_max3_u32 v25, v25, v183, v182
    v_max3_u32 v25, v25, v171, v170
    v_mfma_f32_16x16x32_bf16 v[170:173], v[210:213], v[36:39], 0
    v_rcp_f32 v167, v166
    v_mfma_f32_16x16x32_bf16 v[170:173], v[138:141], v[186:189], v[170:173]
    v_max3_u32 v25, v25, v167, v166
    v_mul_f32 v214, v183, v214
    v_mfma_f32_16x16x32_bf16 v[190:193], v[218:221], v[36:39], 0
    s_waitcnt lgkmcnt(1)
    v_mul_f32 v174, v167, v174
    v_mul_f32 v175, v167, v175
    v_mfma_f32_16x16x32_bf16 v[190:193], v[142:145], v[186:189], v[190:193]
    s_waitcnt lgkmcnt(0)
    v_cvt_pk_bf16_f32 v174, v174, v175
    v_mul_f32 v176, v167, v176
    v_mfma_f32_16x16x32_bf16 v[154:157], v[102:105], v[238:241], v[154:157]
    ds_read_b128 v[186:189], v0 offset:20480
    v_mul_f32 v177, v167, v177
    v_mfma_f32_16x16x32_bf16 v[154:157], v[106:109], v[118:121], v[154:157]
    ds_read_b128 v[194:197], v1 offset:20480
    v_cvt_pk_bf16_f32 v175, v176, v177
    v_mfma_f32_16x16x32_bf16 v[154:157], v[110:113], v[122:125], v[154:157]
    ds_read_b128 v[122:125], v0 offset:20608
    v_mul_f32 v170, v167, v170
    v_mfma_f32_16x16x32_bf16 v[118:121], v[146:149], v[28:31], 0
    ds_read_b128 v[202:205], v1 offset:20608
    v_mul_f32 v171, v167, v171
    v_mfma_f32_16x16x32_bf16 v[118:121], v[150:153], v[28:31], v[118:121]
    ds_read_b128 v[230:233], v0 offset:20736
    v_cvt_pk_bf16_f32 v176, v170, v171
    v_mfma_f32_16x16x32_bf16 v[234:237], v[146:149], v[134:137], 0
    ds_read_b128 v[238:241], v1 offset:20736
    v_fmac_f32 v255, v154, v154
    v_mfma_f32_16x16x32_bf16 v[234:237], v[150:153], v[162:165], v[234:237]
    v_fmac_f32 v255, v155, v155
    v_fmac_f32 v255, v156, v156
    v_mfma_f32_16x16x32_bf16 v[134:137], v[146:149], v[138:141], 0
    v_fmac_f32 v255, v157, v157
    v_cvt_pk_bf16_f32 v255, v255, v255
    v_mfma_f32_16x16x32_bf16 v[134:137], v[150:153], v[210:213], v[134:137]
    s_waitcnt lgkmcnt(5)
    ds_write_b64 v4, v[254:255] offset:18432
    v_mfma_f32_16x16x32_bf16 v[138:141], v[146:149], v[142:145], 0
    s_waitcnt lgkmcnt(4)
    v_mul_f32 v172, v167, v172
    v_mul_f32 v173, v167, v173
    v_mfma_f32_16x16x32_bf16 v[138:141], v[150:153], v[218:221], v[138:141]
    s_waitcnt lgkmcnt(3)
    v_cvt_pk_bf16_f32 v177, v172, v173
    v_mul_f32 v190, v167, v190
    v_mfma_f32_16x16x32_bf16 v[142:145], a[72:75], v[186:189], 0
    s_waitcnt lgkmcnt(2)
    ds_write_b128 v3, v[174:177] offset:12288
    v_mfma_f32_16x16x32_bf16 v[142:145], a[76:79], v[194:197], v[142:145]
    s_waitcnt lgkmcnt(2)
    v_mul_f32 v191, v167, v191
    v_cvt_pk_bf16_f32 v254, v190, v191
    v_mfma_f32_16x16x32_bf16 v[142:145], a[80:83], v[122:125], v[142:145]
    v_mul_f32 v192, v167, v192
    v_mul_f32 v193, v167, v193
    v_mfma_f32_16x16x32_bf16 v[142:145], a[84:87], v[202:205], v[142:145]
    v_cvt_pk_bf16_f32 v255, v192, v193
    v_mul_f32 v215, v183, v215
    v_mfma_f32_16x16x32_bf16 v[142:145], a[88:91], v[230:233], v[142:145]
    ds_write_b64 v4, v[254:255] offset:16384
    v_mfma_f32_16x16x32_bf16 v[142:145], a[92:95], v[238:241], v[142:145]
    v_rcp_f32_dpp v119, v118 quad_perm:[0,0,0,0] row_mask:0xf bank_mask:0xf
    v_mfma_f32_16x16x32_bf16 v[150:153], a[96:99], v[186:189], 0
    v_max3_u32 v25, v25, v118, v119
    v_mul_f32 v234, v234, v119
    v_mfma_f32_16x16x32_bf16 v[150:153], a[100:103], v[194:197], v[150:153]
    v_cvt_pk_bf16_f32 v118, v214, v215
    v_mul_f32_dpp v234, v134, v119 quad_perm:[0,1,2,3] row_mask:0x2 bank_mask:0xf
    v_mfma_f32_16x16x32_bf16 v[150:153], a[104:107], v[122:125], v[150:153]
    v_mul_f32 v216, v183, v216
    v_mul_f32_dpp v234, v138, v119 quad_perm:[0,1,2,3] row_mask:0x4 bank_mask:0xf
    v_mfma_f32_16x16x32_bf16 v[150:153], a[108:111], v[202:205], v[150:153]
    v_cvt_pk_bf16_f32 v234, v234, v234
    v_mul_f32 v217, v183, v217
    v_mfma_f32_16x16x32_bf16 v[150:153], a[112:115], v[230:233], v[150:153]
    ds_write_b16 v7, v234
    v_mfma_f32_16x16x32_bf16 v[150:153], a[116:119], v[238:241], v[150:153]
    v_cvt_pk_bf16_f32 v119, v216, v217
    v_mul_f32 v222, v183, v222
    v_mfma_f32_16x16x32_bf16 v[134:137], a[120:123], v[186:189], 0
    v_mul_f32 v223, v183, v223
    v_cvt_pk_bf16_f32 v120, v222, v223
    v_mfma_f32_16x16x32_bf16 v[134:137], a[124:127], v[194:197], v[134:137]
    v_mul_f32 v224, v183, v224
    v_mul_f32 v225, v183, v225
    v_mfma_f32_16x16x32_bf16 v[134:137], a[128:131], v[122:125], v[134:137]
    v_cvt_pk_bf16_f32 v121, v224, v225
    v_mul_f32 v226, v183, v226
    v_mfma_f32_16x16x32_bf16 v[134:137], a[132:135], v[202:205], v[134:137]
    ds_write_b128 v3, v[118:121] offset:0
    v_mfma_f32_16x16x32_bf16 v[134:137], a[136:139], v[230:233], v[134:137]
    v_mul_f32 v227, v183, v227
    v_cvt_pk_bf16_f32 v254, v226, v227
    v_mfma_f32_16x16x32_bf16 v[134:137], a[140:143], v[238:241], v[134:137]
    v_mul_f32 v228, v183, v228
    v_mul_f32 v229, v183, v229
    v_mfma_f32_16x16x32_bf16 v[138:141], a[0:3], v[186:189], 0
    v_cvt_pk_bf16_f32 v255, v228, v229
    v_xor_b32 v3, 65536, v3
    v_mfma_f32_16x16x32_bf16 v[138:141], a[4:7], v[194:197], v[138:141]
    ds_write_b64 v4, v[254:255] offset:4096
    v_mfma_f32_16x16x32_bf16 v[138:141], a[8:11], v[122:125], v[138:141]
    v_xor_b32 v4, 65536, v4
    v_add_u32 v7, s76, v7
    v_mfma_f32_16x16x32_bf16 v[138:141], a[12:15], v[202:205], v[138:141]
    v_cvt_pk_f16_f32 v146, v142, v143
    v_pk_mul_f16 v143, v146, v146
    v_mfma_f32_16x16x32_bf16 v[138:141], a[16:19], v[230:233], v[138:141]
    v_cvt_pk_f16_f32 v147, v144, v145
    v_pk_fma_f16 v143, v147, v147, v143
    v_mfma_f32_16x16x32_bf16 v[138:141], a[20:23], v[238:241], v[138:141]
    v_cvt_pk_f16_f32 v148, v150, v151
    v_pk_fma_f16 v143, v148, v148, v143
    v_mfma_f32_16x16x32_bf16 v[166:169], a[24:27], v[186:189], 0
    v_cvt_pk_f16_f32 v149, v152, v153
    v_pk_fma_f16 v143, v149, v149, v143
    v_mfma_f32_16x16x32_bf16 v[166:169], a[28:31], v[194:197], v[166:169]
    v_cvt_pk_f16_f32 v120, v134, v135
    v_pk_fma_f16 v143, v120, v120, v143
    v_mfma_f32_16x16x32_bf16 v[166:169], a[32:35], v[122:125], v[166:169]
    s_waitcnt lgkmcnt(0)
    v_cvt_pk_f16_f32 v121, v136, v137
    v_pk_fma_f16 v143, v121, v121, v143
    v_mfma_f32_16x16x32_bf16 v[166:169], a[36:39], v[202:205], v[166:169]
    s_barrier
    v_mfma_f32_16x16x32_bf16 v[166:169], a[40:43], v[230:233], v[166:169]
    s_nop 0
    v_mfma_f32_16x16x32_bf16 v[166:169], a[44:47], v[238:241], v[166:169]
    s_nop 0
    v_mfma_f32_16x16x32_bf16 v[134:137], a[48:51], v[186:189], 0
    s_nop 0
    v_mfma_f32_16x16x32_bf16 v[134:137], a[52:55], v[194:197], v[134:137]
    s_cbranch_scc1 L_loop_fast0
    s_branch L_final_fast
.p2align 6
L_loop_fast1:
    v_mfma_f32_16x16x32_bf16 v[134:137], a[56:59], v[122:125], v[134:137]
    s_add_u32 s12, s40, s27
    ds_read_b128 v[190:193], v2 offset:18432
    v_cvt_pk_f16_f32 v150, v138, v139
    v_mfma_f32_16x16x32_bf16 v[134:137], a[60:63], v[202:205], v[134:137]
    s_addc_u32 s13, s41, 0
    ds_read_b128 v[210:213], v2 offset:19456
    v_pk_mul_f16 v142, v150, v150
    v_mfma_f32_16x16x32_bf16 v[134:137], a[64:67], v[230:233], v[134:137]
    s_sub_u32 s14, s36, s27
    ds_read_b128 v[174:177], v5 offset:32
    v_cvt_pk_f16_f32 v151, v140, v141
    v_mfma_f32_16x16x32_bf16 v[134:137], a[68:71], v[238:241], v[134:137]
    s_cmp_ge_u32 s18, 2
    ds_read2_b64 v[162:165], v5 offset0:6 offset1:9
    v_pk_fma_f16 v142, v151, v151, v142
    v_mfma_f32_16x16x32_bf16 v[138:141], v[186:189], a[144:147], 0
    s_cselect_b32 s14, s14, 0
    ds_read_b128 v[170:173], v5
    v_cvt_pk_f16_f32 v152, v166, v167
    v_mfma_f32_16x16x32_bf16 v[138:141], v[194:197], a[148:151], v[138:141]
    s_sub_u32 s82, s72, s71
    ds_read_b32 v254, v6 offset:192
    v_pk_fma_f16 v142, v152, v152, v142
    v_mfma_f32_16x16x32_bf16 v[138:141], v[122:125], a[152:155], v[138:141]
    s_mul_i32 s74, s82, 336
    v_cvt_pk_f16_f32 v153, v168, v169
    v_pk_fma_f16 v142, v153, v153, v142
    v_mfma_f32_16x16x32_bf16 v[138:141], v[202:205], a[156:159], v[138:141]
    s_mul_i32 s75, s82, 272
    v_cvt_pk_f16_f32 v118, v134, v135
    v_pk_fma_f16 v142, v118, v118, v142
    v_mfma_f32_16x16x32_bf16 v[138:141], v[230:233], a[160:163], v[138:141]
    s_waitcnt lgkmcnt(5)
    ds_read_b128 v[182:185], v0 offset:26624
    v_cvt_pk_f16_f32 v119, v136, v137
    v_mfma_f32_16x16x32_bf16 v[166:169], v[32:35], v[190:193], 0
    s_waitcnt lgkmcnt(5)
    v_pk_fma_f16 v142, v119, v119, v142
    v_add_u32 v5, s74, v5
    v_mfma_f32_16x16x32_bf16 v[166:169], v[32:35], v[210:213], v[166:169]
    s_waitcnt lgkmcnt(4)
    v_pk_mul_f16 v145, v146, v174
    v_pk_fma_f16 v145, v147, v175, v145
    v_mfma_f32_16x16x32_bf16 v[138:141], v[238:241], a[164:167], v[138:141]
    s_mul_i32 s76, s82, 16
    ds_read_b128 v[210:213], v1 offset:26624
    v_pk_fma_f16 v145, v148, v176, v145
    v_mfma_f32_16x16x32_bf16 v[214:217], v[186:189], a[168:171], 0
    s_waitcnt lgkmcnt(3)
    ds_read_b128 v[218:221], v0 offset:26752
    v_pk_fma_f16 v145, v149, v177, v145
    v_mfma_f32_16x16x32_bf16 v[214:217], v[194:197], a[172:175], v[214:217]
    s_waitcnt lgkmcnt(3)
    ds_read_b128 v[222:225], v1 offset:26752
    v_mov_b32_dpp v254, v23 quad_perm:[0,1,2,3] row_mask:0x7 bank_mask:0xf
    v_mfma_f32_16x16x32_bf16 v[214:217], v[122:125], a[176:179], v[214:217]
    s_add_u32 s34, s18, 2
    ds_read_b128 v[226:229], v0 offset:26880
    v_pk_fma_f16 v145, v120, v164, v145
    v_mfma_f32_16x16x32_bf16 v[214:217], v[202:205], a[180:183], v[214:217]
    s_add_u32 s8, s60, s23
    ds_read_b128 v[190:193], v1 offset:26880
    v_pk_fma_f16 v145, v121, v165, v145
    v_mfma_f32_16x16x32_bf16 v[214:217], v[230:233], a[184:187], v[214:217]
    s_waitcnt lgkmcnt(5)
    v_pk_mul_f16 v144, v150, v170
    v_pk_fma_f16 v144, v151, v171, v144
    v_mfma_f32_16x16x32_bf16 v[214:217], v[238:241], a[188:191], v[214:217]
    s_addc_u32 s9, s61, 0
    v_pk_fma_f16 v144, v152, v172, v144
    v_pk_fma_f16 v144, v153, v173, v144
    v_mfma_f32_16x16x32_bf16 v[246:249], v[186:189], a[192:195], 0
    s_sub_u32 s10, s36, s23
    v_pk_fma_f16 v144, v118, v162, v144
    v_pk_fma_f16 v144, v119, v163, v144
    v_mfma_f32_16x16x32_bf16 v[246:249], v[194:197], a[196:199], v[246:249]
    s_cmp_le_u32 s34, s45
    v_cvt_pk_bf16_f32 v134, v138, v139
    v_cvt_pk_bf16_f32 v135, v140, v141
    v_mfma_f32_16x16x32_f16 v[234:237], v[40:43], v[142:145], 0
    s_cselect_b32 s10, s10, 0
    v_cvt_pk_bf16_f32 v138, v214, v215
    v_cvt_pk_bf16_f32 v139, v216, v217
    v_mfma_f32_16x16x32_bf16 v[246:249], v[122:125], a[200:203], v[246:249]
    s_add_u32 m0, s28, 0
    v_mul_f32 v136, 0x3baaaaab, v166
    v_mul_f32 v255, 0x3baaaaab, v167
    v_mfma_f32_16x16x32_bf16 v[246:249], v[202:205], a[204:207], v[246:249]
    s_mov_b32 s27, s26
    v_rsq_f32 v234, v234
    v_mfma_f32_16x16x32_bf16 v[246:249], v[230:233], a[208:211], v[246:249]
    s_mov_b32 s26, s25
    v_rsq_f32 v235, v235
    v_mfma_f32_16x16x32_bf16 v[246:249], v[238:241], a[212:215], v[246:249]
    s_mov_b32 s25, s24
    v_mul_f32 v140, s31, v234
    v_cvt_pk_f16_f32 v141, v140, v235
    v_mfma_f32_16x16x32_bf16 v[122:125], a[72:75], v[182:185], 0
    s_waitcnt lgkmcnt(0)
    v_fma_f32 v236, v236, v140, v22
    v_fmac_f32_dpp v254, v237, v235 quad_perm:[0,1,2,3] row_mask:0x1 bank_mask:0xf
    v_mfma_f32_16x16x32_bf16 v[122:125], a[76:79], v[210:213], v[122:125]
    s_mov_b32 s24, s23
    v_cvt_pk_bf16_f32 v142, v246, v247
    v_cvt_pk_bf16_f32 v143, v248, v249
    v_mfma_f32_16x16x32_bf16 v[122:125], a[80:83], v[218:221], v[122:125]
    s_mov_b32 s71, s72
    v_pk_mul_f16 v146, v146, v141 op_sel:[0,1] op_sel_hi:[1,1]
    v_pk_mul_f16 v147, v147, v141 op_sel:[0,1] op_sel_hi:[1,1]
    v_mfma_f32_16x16x32_bf16 v[122:125], a[84:87], v[222:225], v[122:125]
    s_mov_b32 s72, s73
    v_pk_mul_f16 v148, v148, v141 op_sel:[0,1] op_sel_hi:[1,1]
    v_pk_mul_f16 v149, v149, v141 op_sel:[0,1] op_sel_hi:[1,1]
    v_mfma_f32_16x16x32_bf16 v[122:125], a[88:91], v[226:229], v[122:125]
    v_pk_mul_f16 v120, v120, v141 op_sel:[0,1] op_sel_hi:[1,1]
    v_pk_mul_f16 v121, v121, v141 op_sel:[0,1] op_sel_hi:[1,1]
    v_mfma_f32_16x16x32_bf16 v[122:125], a[92:95], v[190:193], v[122:125]
    v_pk_mul_f16 v150, v150, v141 op_sel:[0,0] op_sel_hi:[1,0]
    v_pk_mul_f16 v151, v151, v141 op_sel:[0,0] op_sel_hi:[1,0]
    v_mfma_f32_16x16x32_bf16 v[186:189], a[96:99], v[182:185], 0
    v_pk_mul_f16 v152, v152, v141 op_sel:[0,0] op_sel_hi:[1,0]
    v_pk_mul_f16 v153, v153, v141 op_sel:[0,0] op_sel_hi:[1,0]
    v_mfma_f32_16x16x32_bf16 v[186:189], a[100:103], v[210:213], v[186:189]
    v_pk_mul_f16 v118, v118, v141 op_sel:[0,0] op_sel_hi:[1,0]
    v_pk_mul_f16 v119, v119, v141 op_sel:[0,0] op_sel_hi:[1,0]
    v_mfma_f32_16x16x32_bf16 v[186:189], a[104:107], v[218:221], v[186:189]
    v_max3_u32 v44, v44, v234, v235
    v_mul_f32 v144, 0x3baaaaab, v168
    v_mfma_f32_16x16x32_bf16 v[186:189], a[108:111], v[222:225], v[186:189]
    v_rsq_f32 v136, v136
    v_mfma_f32_16x16x32_bf16 v[186:189], a[112:115], v[226:229], v[186:189]
    v_rsq_f32 v255, v255
    v_mfma_f32_16x16x32_bf16 v[186:189], a[116:119], v[190:193], v[186:189]
    v_rsq_f32 v144, v144
    v_mfma_f32_16x16x32_bf16 v[194:197], a[120:123], v[182:185], 0
    v_mul_f32 v178, v136, v178
    v_mul_f32 v179, v136, v179
    v_mfma_f32_16x16x32_bf16 v[194:197], a[124:127], v[210:213], v[194:197]
    v_cvt_pk_bf16_f32 v166, v178, v179
    v_mul_f32 v180, v136, v180
    v_mfma_f32_16x16x32_bf16 v[194:197], a[128:131], v[218:221], v[194:197]
    v_mul_f32 v181, v136, v181
    v_cvt_pk_bf16_f32 v167, v180, v181
    v_mfma_f32_16x16x32_bf16 v[194:197], a[132:135], v[222:225], v[194:197]
    v_mul_f32 v198, v136, v198
    v_mul_f32 v199, v136, v199
    v_mfma_f32_16x16x32_bf16 v[194:197], a[136:139], v[226:229], v[194:197]
    v_cvt_pk_bf16_f32 v168, v198, v199
    v_mul_f32 v200, v136, v200
    v_mfma_f32_16x16x32_bf16 v[194:197], a[140:143], v[190:193], v[194:197]
    v_mul_f32 v201, v136, v201
    v_cvt_pk_bf16_f32 v169, v200, v201
    v_mfma_f32_16x16x32_bf16 v[178:181], a[0:3], v[182:185], 0
    buffer_store_dwordx4 v[166:169], v15, s[12:15], 0 offen nt
    v_mul_f32 v206, v136, v206
    v_mul_f32 v207, v136, v207
    v_cvt_pk_bf16_f32 v140, v206, v207
    v_mul_f32 v208, v136, v208
    v_mfma_f32_16x16x32_bf16 v[178:181], a[4:7], v[210:213], v[178:181]
    v_mul_f32 v209, v136, v209
    v_cvt_pk_bf16_f32 v141, v208, v209
    v_mfma_f32_16x16x32_bf16 v[178:181], a[8:11], v[218:221], v[178:181]
    v_cvt_pk_f16_f32 v166, v122, v123
    v_pk_mul_f16 v199, v166, v166
    v_mfma_f32_16x16x32_bf16 v[178:181], a[12:15], v[222:225], v[178:181]
    v_cvt_pk_f16_f32 v167, v124, v125
    v_pk_fma_f16 v199, v167, v167, v199
    v_mfma_f32_16x16x32_bf16 v[178:181], a[16:19], v[226:229], v[178:181]
    v_cvt_pk_f16_f32 v168, v186, v187
    v_pk_fma_f16 v199, v168, v168, v199
    v_mfma_f32_16x16x32_bf16 v[178:181], a[20:23], v[190:193], v[178:181]
    v_cvt_pk_f16_f32 v169, v188, v189
    v_pk_fma_f16 v199, v169, v169, v199
    v_mfma_f32_16x16x32_bf16 v[186:189], a[24:27], v[182:185], 0
    v_cvt_pk_f16_f32 v124, v194, v195
    v_pk_fma_f16 v199, v124, v124, v199
    v_mfma_f32_16x16x32_bf16 v[186:189], a[28:31], v[210:213], v[186:189]
    v_cvt_pk_f16_f32 v125, v196, v197
    v_pk_fma_f16 v199, v125, v125, v199
    v_mfma_f32_16x16x32_bf16 v[186:189], a[32:35], v[218:221], v[186:189]
    v_cvt_pk_f16_f32 v178, v178, v179
    v_pk_mul_f16 v198, v178, v178
    v_mfma_f32_16x16x32_bf16 v[186:189], a[36:39], v[222:225], v[186:189]
    v_cvt_pk_f16_f32 v179, v180, v181
    v_pk_fma_f16 v198, v179, v179, v198
    v_mfma_f32_16x16x32_bf16 v[186:189], a[40:43], v[226:229], v[186:189]
    v_pk_mul_f16 v200, v178, v170
    v_pk_fma_f16 v200, v179, v171, v200
    v_mfma_f32_16x16x32_bf16 v[186:189], a[44:47], v[190:193], v[186:189]
    v_pk_mul_f16 v201, v166, v174
    v_pk_fma_f16 v201, v167, v175, v201
    v_mfma_f32_16x16x32_bf16 v[194:197], a[48:51], v[182:185], 0
    v_pk_fma_f16 v201, v168, v176, v201
    v_pk_fma_f16 v201, v169, v177, v201
    v_mfma_f32_16x16x32_bf16 v[194:197], a[52:55], v[210:213], v[194:197]
    v_pk_fma_f16 v201, v124, v164, v201
    v_pk_fma_f16 v201, v125, v165, v201
    v_mfma_f32_16x16x32_bf16 v[194:197], a[56:59], v[218:221], v[194:197]
    v_cvt_pk_f16_f32 v180, v186, v187
    v_pk_fma_f16 v198, v180, v180, v198
    v_mfma_f32_16x16x32_bf16 v[194:197], a[60:63], v[222:225], v[194:197]
    v_cvt_pk_f16_f32 v181, v188, v189
    v_pk_fma_f16 v198, v181, v181, v198
    v_mfma_f32_16x16x32_bf16 v[194:197], a[64:67], v[226:229], v[194:197]
    v_pk_fma_f16 v200, v180, v172, v200
    v_pk_fma_f16 v200, v181, v173, v200
    v_mfma_f32_16x16x32_bf16 v[194:197], a[68:71], v[190:193], v[194:197]
    buffer_store_dwordx2 v[140:141], v18, s[12:15], 0 offen nt
    v_mul_f32 v242, v144, v242
    v_mul_f32 v243, v144, v243
    v_mfma_f32_16x16x32_bf16 v[186:189], v[182:185], a[144:147], 0
    v_cvt_pk_bf16_f32 v238, v242, v243
    v_mul_f32 v244, v144, v244
    v_mfma_f32_16x16x32_bf16 v[186:189], v[210:213], a[148:151], v[186:189]
    v_mul_f32 v245, v144, v245
    v_cvt_pk_f16_f32 v122, v194, v195
    v_mfma_f32_16x16x32_bf16 v[186:189], v[218:221], a[152:155], v[186:189]
    v_pk_fma_f16 v198, v122, v122, v198
    v_cvt_pk_f16_f32 v123, v196, v197
    v_mfma_f32_16x16x32_bf16 v[186:189], v[222:225], a[156:159], v[186:189]
    v_pk_fma_f16 v198, v123, v123, v198
    v_pk_fma_f16 v200, v122, v162, v200
    v_mfma_f32_16x16x32_bf16 v[186:189], v[226:229], a[160:163], v[186:189]
    ds_read_b128 v[202:205], v0 offset:32768
    v_pk_fma_f16 v200, v123, v163, v200
    v_mfma_f32_16x16x32_bf16 v[186:189], v[190:193], a[164:167], v[186:189]
    ds_read_b128 v[194:197], v1 offset:32768
    v_cvt_pk_bf16_f32 v239, v244, v245
    v_mfma_f32_16x16x32_f16 v[230:233], v[40:43], v[198:201], 0
    v_mul_f32 v158, v144, v158
    v_mul_f32 v159, v144, v159
    v_mfma_f32_16x16x32_bf16 v[246:249], v[182:185], a[168:171], 0
    ds_read_b128 v[214:217], v0 offset:32896
    v_cvt_pk_bf16_f32 v240, v158, v159
    v_mfma_f32_16x16x32_bf16 v[246:249], v[210:213], a[172:175], v[246:249]
    ds_read_b128 v[206:209], v1 offset:32896
    v_cvt_pk_bf16_f32 v136, v186, v187
    v_mfma_f32_16x16x32_bf16 v[246:249], v[218:221], a[176:179], v[246:249]
    ds_read_b128 v[198:201], v0 offset:33024
    v_cvt_pk_bf16_f32 v137, v188, v189
    v_mfma_f32_16x16x32_bf16 v[246:249], v[222:225], a[180:183], v[246:249]
    ds_read_b128 v[186:189], v1 offset:33024
    v_mul_f32 v160, v144, v160
    v_mfma_f32_16x16x32_bf16 v[246:249], v[226:229], a[184:187], v[246:249]
    v_rsq_f32 v230, v230
    v_mfma_f32_16x16x32_bf16 v[246:249], v[190:193], a[188:191], v[246:249]
    s_waitcnt lgkmcnt(5)
    v_rsq_f32 v231, v231
    v_mfma_f32_16x16x32_bf16 v[242:245], v[182:185], a[192:195], 0
    s_waitcnt lgkmcnt(4)
    v_mul_f32 v234, s31, v230
    v_cvt_pk_f16_f32 v235, v234, v231
    v_mfma_f32_16x16x32_bf16 v[242:245], v[210:213], a[196:199], v[242:245]
    v_fma_f32 v232, v232, v234, v24
    v_fmac_f32_dpp v254, v233, v231 quad_perm:[0,1,2,3] row_mask:0x2 bank_mask:0xf
    v_mfma_f32_16x16x32_bf16 v[242:245], v[218:221], a[200:203], v[242:245]
    s_waitcnt lgkmcnt(3)
    v_cvt_pk_bf16_f32 v140, v246, v247
    v_cvt_pk_bf16_f32 v141, v248, v249
    v_mfma_f32_16x16x32_bf16 v[242:245], v[222:225], a[204:207], v[242:245]
    s_waitcnt lgkmcnt(2)
    v_mul_f32 v161, v144, v161
    v_cvt_pk_bf16_f32 v241, v160, v161
    v_mfma_f32_16x16x32_bf16 v[242:245], v[226:229], a[208:211], v[242:245]
    s_waitcnt lgkmcnt(1)
    buffer_store_dwordx4 v[238:241], v17, s[12:15], 0 offen nt
    v_mul_f32 v154, v144, v154
    v_mul_f32 v155, v144, v155
    v_cvt_pk_bf16_f32 v154, v154, v155
    v_mul_f32 v156, v144, v156
    v_mfma_f32_16x16x32_bf16 v[242:245], v[190:193], a[212:215], v[242:245]
    s_waitcnt lgkmcnt(0)
    v_mul_f32 v157, v144, v157
    v_cvt_pk_bf16_f32 v155, v156, v157
    v_mfma_f32_16x16x32_bf16 v[158:161], a[72:75], v[202:205], 0
    v_pk_mul_f16 v166, v166, v235 op_sel:[0,1] op_sel_hi:[1,1]
    v_pk_mul_f16 v167, v167, v235 op_sel:[0,1] op_sel_hi:[1,1]
    v_mfma_f32_16x16x32_bf16 v[158:161], a[76:79], v[194:197], v[158:161]
    v_pk_mul_f16 v168, v168, v235 op_sel:[0,1] op_sel_hi:[1,1]
    v_cvt_pk_bf16_f32 v144, v242, v243
    v_mfma_f32_16x16x32_bf16 v[158:161], a[80:83], v[214:217], v[158:161]
    v_cvt_pk_bf16_f32 v145, v244, v245
    v_pk_mul_f16 v169, v169, v235 op_sel:[0,1] op_sel_hi:[1,1]
    v_mfma_f32_16x16x32_bf16 v[158:161], a[84:87], v[206:209], v[158:161]
    v_pk_mul_f16 v124, v124, v235 op_sel:[0,1] op_sel_hi:[1,1]
    v_pk_mul_f16 v125, v125, v235 op_sel:[0,1] op_sel_hi:[1,1]
    v_mfma_f32_16x16x32_bf16 v[158:161], a[88:91], v[198:201], v[158:161]
    v_pk_mul_f16 v178, v178, v235 op_sel:[0,0] op_sel_hi:[1,0]
    v_pk_mul_f16 v179, v179, v235 op_sel:[0,0] op_sel_hi:[1,0]
    v_mfma_f32_16x16x32_bf16 v[158:161], a[92:95], v[186:189], v[158:161]
    v_pk_mul_f16 v180, v180, v235 op_sel:[0,0] op_sel_hi:[1,0]
    v_pk_mul_f16 v181, v181, v235 op_sel:[0,0] op_sel_hi:[1,0]
    v_mfma_f32_16x16x32_bf16 v[182:185], a[96:99], v[202:205], 0
    v_pk_mul_f16 v122, v122, v235 op_sel:[0,0] op_sel_hi:[1,0]
    v_pk_mul_f16 v123, v123, v235 op_sel:[0,0] op_sel_hi:[1,0]
    v_mfma_f32_16x16x32_bf16 v[182:185], a[100:103], v[194:197], v[182:185]
    v_max3_u32 v44, v44, v230, v231
    v_mul_f32 v130, v255, v130
    v_mfma_f32_16x16x32_bf16 v[182:185], a[104:107], v[214:217], v[182:185]
    v_cvt_pk_f16_f32 v158, v158, v159
    v_pk_mul_f16 v191, v158, v158
    v_mfma_f32_16x16x32_bf16 v[182:185], a[108:111], v[206:209], v[182:185]
    v_cvt_pk_f16_f32 v159, v160, v161
    v_pk_fma_f16 v191, v159, v159, v191
    v_mfma_f32_16x16x32_bf16 v[182:185], a[112:115], v[198:201], v[182:185]
    v_pk_mul_f16 v193, v158, v174
    v_pk_fma_f16 v193, v159, v175, v193
    v_mfma_f32_16x16x32_bf16 v[182:185], a[116:119], v[186:189], v[182:185]
    v_exp_f32 v232, v232
    v_mfma_f32_16x16x32_bf16 v[210:213], a[120:123], v[202:205], 0
    v_exp_f32 v236, v236
    v_mfma_f32_16x16x32_bf16 v[210:213], a[124:127], v[194:197], v[210:213]
    v_cvt_pk_bf16_f32 v39, v236, 0
    v_mul_f32 v131, v255, v131
    v_mfma_f32_16x16x32_bf16 v[210:213], a[128:131], v[214:217], v[210:213]
    s_waitcnt vmcnt(3)
    ds_write_b16 v8, v45 offset:512
    v_mfma_f32_16x16x32_bf16 v[210:213], a[132:135], v[206:209], v[210:213]
    buffer_store_dwordx2 v[154:155], v20, s[12:15], 0 offen nt
    v_cvt_pk_f16_f32 v160, v182, v183
    v_mfma_f32_16x16x32_bf16 v[210:213], a[136:139], v[198:201], v[210:213]
    v_pk_fma_f16 v191, v160, v160, v191
    v_cvt_pk_f16_f32 v161, v184, v185
    v_mfma_f32_16x16x32_bf16 v[210:213], a[140:143], v[186:189], v[210:213]
    v_pk_fma_f16 v191, v161, v161, v191
    v_pk_fma_f16 v193, v160, v176, v193
    v_mfma_f32_16x16x32_bf16 v[154:157], a[0:3], v[202:205], 0
    v_pk_fma_f16 v193, v161, v177, v193
    v_cvt_pk_bf16_f32 v130, v130, v131
    v_mfma_f32_16x16x32_bf16 v[154:157], a[4:7], v[194:197], v[154:157]
    v_mul_f32 v132, v255, v132
    v_mul_f32 v133, v255, v133
    v_mfma_f32_16x16x32_bf16 v[154:157], a[8:11], v[214:217], v[154:157]
    v_cvt_pk_f16_f32 v176, v210, v211
    v_pk_fma_f16 v191, v176, v176, v191
    v_mfma_f32_16x16x32_bf16 v[154:157], a[12:15], v[206:209], v[154:157]
    s_waitcnt lgkmcnt(0)
    v_cvt_pk_f16_f32 v177, v212, v213
    v_pk_fma_f16 v191, v177, v177, v191
    v_mfma_f32_16x16x32_bf16 v[154:157], a[16:19], v[198:201], v[154:157]
    v_pk_fma_f16 v193, v176, v164, v193
    v_mfma_f32_16x16x32_bf16 v[154:157], a[20:23], v[186:189], v[154:157]
    s_barrier
    v_pk_fma_f16 v193, v177, v165, v193
    v_mfma_f32_16x16x32_bf16 v[182:185], a[24:27], v[202:205], 0
    v_cvt_pk_bf16_f32 v131, v132, v133
    v_mfma_f32_16x16x32_bf16 v[182:185], a[28:31], v[194:197], v[182:185]
    ds_read2_b32 v[164:165], v6 offset0:0 offset1:0
    v_mfma_f32_16x16x32_bf16 v[182:185], a[32:35], v[214:217], v[182:185]
    ds_read2_b32 v[212:213], v6 offset0:16 offset1:16
    v_cvt_pk_f16_f32 v154, v154, v155
    v_mfma_f32_16x16x32_bf16 v[182:185], a[36:39], v[206:209], v[182:185]
    ds_read2_b32 v[220:221], v6 offset0:32 offset1:32
    v_pk_mul_f16 v190, v154, v154
    v_mfma_f32_16x16x32_bf16 v[182:185], a[40:43], v[198:201], v[182:185]
    ds_read_u16 v133, v9 offset:384
    v_cvt_pk_f16_f32 v155, v156, v157
    v_mfma_f32_16x16x32_bf16 v[182:185], a[44:47], v[186:189], v[182:185]
    v_pk_fma_f16 v190, v155, v155, v190
    v_pk_mul_f16 v192, v154, v170
    v_mfma_f32_16x16x32_bf16 v[222:225], a[48:51], v[202:205], 0
    v_pk_fma_f16 v192, v155, v171, v192
    v_mul_f32 v126, v255, v126
    v_mfma_f32_16x16x32_bf16 v[222:225], a[52:55], v[194:197], v[222:225]
    v_mul_f32 v127, v255, v127
    v_cvt_pk_bf16_f32 v132, v126, v127
    v_mfma_f32_16x16x32_bf16 v[222:225], a[56:59], v[214:217], v[222:225]
    buffer_load_dwordx4 v10, s[8:11], 0 offen nt lds
    v_cvt_pk_f16_f32 v156, v182, v183
    v_mfma_f32_16x16x32_bf16 v[222:225], a[60:63], v[206:209], v[222:225]
    s_add_u32 m0, s28, 4096
    v_pk_fma_f16 v190, v156, v156, v190
    v_cvt_pk_f16_f32 v157, v184, v185
    v_mfma_f32_16x16x32_bf16 v[222:225], a[64:67], v[198:201], v[222:225]
    s_waitcnt lgkmcnt(2)
    v_pk_fma_f16 v190, v157, v157, v190
    v_pk_fma_f16 v192, v156, v172, v192
    v_mfma_f32_16x16x32_bf16 v[222:225], a[68:71], v[186:189], v[222:225]
    s_waitcnt lgkmcnt(1)
    ds_read_b128 v[182:185], v2 offset:0
    v_pk_fma_f16 v192, v157, v173, v192
    v_mfma_f32_16x16x32_bf16 v[170:173], v[202:205], a[144:147], 0
    s_waitcnt lgkmcnt(1)
    ds_read_b128 v[226:229], v2 offset:1024
    v_readfirstlane_b32 s77, v133
    v_mfma_f32_16x16x32_bf16 v[170:173], v[194:197], a[148:151], v[170:173]
    ds_read_b128 v[234:237], v2 offset:2048
    buffer_load_dwordx4 v11, s[8:11], 0 offen nt lds
    v_mfma_f32_16x16x32_bf16 v[170:173], v[214:217], a[152:155], v[170:173]
    s_add_u32 m0, s28, 8192
    ds_read_b128 v[238:241], v2 offset:3072
    v_cvt_pk_f16_f32 v174, v222, v223
    v_mfma_f32_16x16x32_bf16 v[170:173], v[206:209], a[156:159], v[170:173]
    s_mul_i32 s78, s77, 2688
    ds_read_b128 v[242:245], v2 offset:4096
    v_pk_fma_f16 v190, v174, v174, v190
    v_mfma_f32_16x16x32_bf16 v[170:173], v[198:201], a[160:163], v[170:173]
    ds_read_b128 v[246:249], v2 offset:5120
    v_cvt_pk_f16_f32 v175, v224, v225
    v_mfma_f32_16x16x32_bf16 v[170:173], v[186:189], a[164:167], v[170:173]
    v_pk_fma_f16 v190, v175, v175, v190
    v_pk_fma_f16 v192, v174, v162, v192
    v_mfma_f32_16x16x32_bf16 v[222:225], v[202:205], a[168:171], 0
    buffer_load_dwordx4 v12, s[8:11], 0 offen nt lds
    v_pk_fma_f16 v192, v175, v163, v192
    v_mfma_f32_16x16x32_bf16 v[222:225], v[194:197], a[172:175], v[222:225]
    s_waitcnt lgkmcnt(5)
    v_mul_f32 v128, v255, v128
    v_cvt_pk_bf16_f32 v162, v170, v171
    v_mfma_f32_16x16x32_f16 v[250:253], v[40:43], v[190:193], 0
    s_add_u32 m0, s28, 12288
    v_cvt_pk_bf16_f32 v163, v172, v173
    v_mul_f32 v129, v255, v129
    v_mfma_f32_16x16x32_bf16 v[222:225], v[214:217], a[176:179], v[222:225]
    s_xor_b32 s28, s28, 65536
    v_cvt_pk_bf16_f32 v133, v128, v129
    v_mul_f32 v114, v255, v114
    v_mfma_f32_16x16x32_bf16 v[222:225], v[206:209], a[180:183], v[222:225]
    s_waitcnt lgkmcnt(2)
    v_rsq_f32 v250, v250
    v_mfma_f32_16x16x32_bf16 v[222:225], v[198:201], a[184:187], v[222:225]
    s_waitcnt lgkmcnt(1)
    buffer_load_dwordx4 v13, s[8:11], 0 offen nt lds
    v_mul_f32 v230, s31, v250
    v_mfma_f32_16x16x32_bf16 v[222:225], v[186:189], a[188:191], v[222:225]
    s_mov_b32 m0, s29
    v_rsq_f32 v251, v251
    v_mfma_f32_16x16x32_bf16 v[126:129], v[202:205], a[192:195], 0
    s_xor_b32 s29, s29, s30
    v_cvt_pk_f16_f32 v231, v230, v251
    v_fma_f32 v252, v252, v230, v26
    v_mfma_f32_16x16x32_bf16 v[126:129], v[194:197], a[196:199], v[126:129]
    s_add_u32 s19, s19, s20
    v_fmac_f32_dpp v254, v253, v251 quad_perm:[0,1,2,3] row_mask:0x4 bank_mask:0xf
    v_cvt_pk_bf16_f32 v210, v222, v223
    v_mfma_f32_16x16x32_bf16 v[126:129], v[214:217], a[200:203], v[126:129]
    s_add_u32 s23, s23, s21
    v_cvt_pk_bf16_f32 v211, v224, v225
    v_pk_mul_f16 v158, v158, v231 op_sel:[0,1] op_sel_hi:[1,1]
    v_mfma_f32_16x16x32_bf16 v[126:129], v[206:209], a[204:207], v[126:129]
    s_waitcnt lgkmcnt(0)
    buffer_load_dwordx4 v14, s[8:11], 0 offen nt lds
    v_pk_mul_f16 v159, v159, v231 op_sel:[0,1] op_sel_hi:[1,1]
    v_mfma_f32_16x16x32_bf16 v[126:129], v[198:201], a[208:211], v[126:129]
    s_cmp_ge_u32 s19, 72
    v_pk_mul_f16 v160, v160, v231 op_sel:[0,1] op_sel_hi:[1,1]
    v_pk_mul_f16 v161, v161, v231 op_sel:[0,1] op_sel_hi:[1,1]
    v_mfma_f32_16x16x32_bf16 v[126:129], v[186:189], a[212:215], v[126:129]
    s_cselect_b32 s34, 72, 0
    v_pk_mul_f16 v176, v176, v231 op_sel:[0,1] op_sel_hi:[1,1]
    v_pk_mul_f16 v177, v177, v231 op_sel:[0,1] op_sel_hi:[1,1]
    v_mfma_f32_16x16x32_f16 v[170:173], v[146:149], v[150:153], v[46:49]
    s_cselect_b32 s35, s22, 0
    v_pk_mul_f16 v154, v154, v231 op_sel:[0,0] op_sel_hi:[1,0]
    v_pk_mul_f16 v155, v155, v231 op_sel:[0,0] op_sel_hi:[1,0]
    v_mfma_f32_16x16x32_f16 v[186:189], v[166:169], v[150:153], v[50:53]
    s_sub_u32 s19, s19, s34
    v_cvt_pk_bf16_f32 v218, v126, v127
    v_cvt_pk_bf16_f32 v219, v128, v129
    v_mfma_f32_16x16x32_f16 v[126:129], v[158:161], v[150:153], v[54:57]
    buffer_store_dwordx4 v[130:133], v16, s[12:15], 0 offen nt
    v_pk_mul_f16 v156, v156, v231 op_sel:[0,0] op_sel_hi:[1,0]
    v_pk_mul_f16 v157, v157, v231 op_sel:[0,0] op_sel_hi:[1,0]
    v_pk_mul_f16 v174, v174, v231 op_sel:[0,0] op_sel_hi:[1,0]
    v_pk_mul_f16 v175, v175, v231 op_sel:[0,0] op_sel_hi:[1,0]
    v_mfma_f32_16x16x16_f16 v[170:173], v[120:121], v[118:119], v[170:173]
    v_max3_u32 v44, v44, v250, v251
    v_exp_f32 v254, v254
    v_mfma_f32_16x16x16_f16 v[186:189], v[124:125], v[118:119], v[186:189]
    v_cvt_pk_bf16_f32 v254, v254, v254
    v_exp_f32 v252, v252
    v_mfma_f32_16x16x16_f16 v[126:129], v[176:177], v[118:119], v[126:129]
    v_mul_f32 v115, v255, v115
    v_cvt_pk_bf16_f32 v118, v114, v115
    v_exp_f32 v170, v170
    v_mfma_f32_16x16x32_f16 v[130:133], v[146:149], v[178:181], v[58:61]
    s_add_u32 s23, s23, s35
    ds_write_b16 v8, v254
    v_mfma_f32_16x16x32_f16 v[150:153], v[166:169], v[178:181], v[62:65]
    s_add_u32 s78, s78, s69
    v_exp_f32 v171, v171
    v_mfma_f32_16x16x32_f16 v[190:193], v[158:161], v[178:181], v[66:69]
    s_add_u32 s80, s77, s68
    v_cvt_pk_bf16_f32 v170, v170, v171
    v_exp_f32 v172, v172
    v_mfma_f32_16x16x16_f16 v[130:133], v[120:121], v[122:123], v[130:133]
    v_exp_f32 v173, v173
    v_mul_f32 v116, v255, v116
    v_mfma_f32_16x16x16_f16 v[150:153], v[124:125], v[122:123], v[150:153]
    v_cvt_pk_bf16_f32 v171, v172, v173
    v_exp_f32 v186, v186
    v_mfma_f32_16x16x16_f16 v[190:193], v[176:177], v[122:123], v[190:193]
    v_exp_f32 v187, v187
    v_exp_f32 v188, v188
    v_mfma_f32_16x16x32_bf16 v[178:181], a[216:219], v[182:185], 0
    s_cmp_ge_u32 s80, 72
    v_exp_f32 v130, v130
    v_mfma_f32_16x16x32_bf16 v[178:181], a[220:223], v[226:229], v[178:181]
    s_cselect_b32 s80, s22, 0
    v_exp_f32 v131, v131
    v_mfma_f32_16x16x32_bf16 v[178:181], a[224:227], v[234:237], v[178:181]
    s_add_u32 s78, s78, s80
    v_cvt_pk_bf16_f32 v194, v130, v131
    v_cvt_pk_bf16_f32 v172, v186, v187
    v_mfma_f32_16x16x32_bf16 v[178:181], a[228:231], v[238:241], v[178:181]
    s_add_u32 s80, s77, 20
    v_exp_f32 v132, v132
    v_mfma_f32_16x16x32_bf16 v[178:181], a[232:235], v[242:245], v[178:181]
    s_add_u32 s34, s18, 3
    v_exp_f32 v133, v133
    v_mfma_f32_16x16x32_bf16 v[178:181], a[236:239], v[246:249], v[178:181]
    s_cmp_lt_u32 s77, s62
    v_cvt_pk_bf16_f32 v195, v132, v133
    v_mul_f32 v117, v255, v117
    v_mfma_f32_16x16x32_bf16 v[198:201], a[240:243], v[182:185], 0
    s_cselect_b32 s79, 1, 0
    v_exp_f32 v150, v150
    v_mfma_f32_16x16x32_f16 v[202:205], v[146:149], v[154:157], v[70:73]
    s_cselect_b32 s78, s78, 0
    v_exp_f32 v151, v151
    v_mfma_f32_16x16x32_f16 v[146:149], v[166:169], v[154:157], v[74:77]
    s_cmp_lt_u32 s34, s17
    v_cvt_pk_bf16_f32 v196, v150, v151
    v_cvt_pk_bf16_f32 v119, v116, v117
    v_mfma_f32_16x16x32_f16 v[166:169], v[158:161], v[154:157], v[78:81]
    buffer_store_dwordx2 v[118:119], v19, s[12:15], 0 offen nt
    v_exp_f32 v152, v152
    v_mfma_f32_16x16x16_f16 v[202:205], v[120:121], v[174:175], v[202:205]
    v_exp_f32 v153, v153
    v_fma_f32 v254, v178, v178, s33
    v_mfma_f32_16x16x16_f16 v[146:149], v[124:125], v[174:175], v[146:149]
    v_cvt_pk_bf16_f32 v197, v152, v153
    v_exp_f32 v190, v190
    v_mfma_f32_16x16x16_f16 v[166:169], v[176:177], v[174:175], v[166:169]
    v_exp_f32 v191, v191
    v_exp_f32 v192, v192
    v_mfma_f32_16x16x32_bf16 v[198:201], a[244:247], v[226:229], v[198:201]
    s_cselect_b32 s23, s23, s78
    v_exp_f32 v193, v193
    v_mfma_f32_16x16x32_bf16 v[198:201], a[248:251], v[234:237], v[198:201]
    s_cselect_b32 s73, s34, s80
    ds_read_b128 v[118:121], v2 offset:6144
    v_fmac_f32 v254, v179, v179
    v_mfma_f32_16x16x32_bf16 v[198:201], a[252:255], v[238:241], v[198:201]
    s_cselect_b32 s79, 0, s79
    ds_read_b128 v[122:125], v2 offset:7168
    v_fmac_f32 v254, v180, v180
    v_mfma_f32_16x16x32_bf16 v[198:201], v[82:85], v[242:245], v[198:201]
    s_cselect_b32 s81, 0, 1
    ds_read_b128 v[150:153], v2 offset:8192
    v_fmac_f32 v254, v181, v181
    v_mfma_f32_16x16x32_bf16 v[198:201], v[86:89], v[246:249], v[198:201]
    s_add_u32 s80, s77, 1
    ds_read_b128 v[154:157], v2 offset:9216
    v_xor_b32 v0, 65536, v0
    v_mfma_f32_16x16x32_bf16 v[206:209], v[90:93], v[182:185], 0
    s_mul_i32 s80, s80, s81
    ds_read_b128 v[158:161], v2 offset:10240
    v_xor_b32 v1, 65536, v1
    v_mfma_f32_16x16x32_bf16 v[206:209], v[94:97], v[226:229], v[206:209]
    s_cmp_lt_u32 s80, s62
    ds_read_b128 v[174:177], v2 offset:11264
    v_fmac_f32 v254, v198, v198
    v_mfma_f32_16x16x32_bf16 v[206:209], v[98:101], v[234:237], v[206:209]
    s_cselect_b32 s62, s62, 0
    v_exp_f32 v189, v189
    v_mfma_f32_16x16x32_bf16 v[206:209], v[102:105], v[238:241], v[206:209]
    s_add_u32 s80, s18, 4
    v_cvt_pk_bf16_f32 v173, v188, v189
    v_fmac_f32 v254, v199, v199
    v_mfma_f32_16x16x32_bf16 v[206:209], v[106:109], v[242:245], v[206:209]
    s_waitcnt lgkmcnt(5)
    v_exp_f32 v126, v126
    v_mfma_f32_16x16x32_bf16 v[206:209], v[110:113], v[246:249], v[206:209]
    s_cmp_ge_u32 s80, s17
    v_exp_f32 v127, v127
    v_mfma_f32_16x16x32_bf16 v[130:133], a[216:219], v[118:121], 0
    s_waitcnt lgkmcnt(3)
    v_cvt_pk_bf16_f32 v36, v126, v127
    v_fmac_f32 v254, v200, v200
    v_mfma_f32_16x16x32_bf16 v[130:133], a[220:223], v[122:125], v[130:133]
    s_cselect_b32 s66, s62, 0
    v_exp_f32 v128, v128
    v_mfma_f32_16x16x32_bf16 v[130:133], a[224:227], v[150:153], v[130:133]
    s_waitcnt lgkmcnt(1)
    v_fmac_f32 v254, v201, v201
    v_mfma_f32_16x16x32_bf16 v[130:133], a[228:231], v[154:157], v[130:133]
    s_lshl_b32 s80, s79, s73
    v_exp_f32 v129, v129
    v_mfma_f32_16x16x32_bf16 v[130:133], a[232:235], v[158:161], v[130:133]
    s_waitcnt lgkmcnt(0)
    v_cvt_pk_bf16_f32 v37, v128, v129
    v_fmac_f32 v254, v206, v206
    v_mfma_f32_16x16x32_bf16 v[130:133], a[236:239], v[174:177], v[130:133]
    s_or_b32 s70, s70, s80
    v_exp_f32 v202, v202
    v_mfma_f32_16x16x32_bf16 v[182:185], v[28:31], v[36:39], 0
    s_add_u32 s45, s45, s79
    v_exp_f32 v203, v203
    v_mfma_f32_16x16x32_bf16 v[182:185], v[28:31], v[170:173], v[182:185]
    s_add_u32 s18, s18, 1
    v_cvt_pk_bf16_f32 v186, v202, v203
    v_fma_f32 v255, v130, v130, s33
    v_mfma_f32_16x16x32_bf16 v[214:217], v[162:165], v[36:39], 0
    s_cmp_lt_u32 s18, s45
    v_fmac_f32 v255, v131, v131
    v_fmac_f32 v255, v132, v132
    v_mfma_f32_16x16x32_bf16 v[214:217], v[134:137], v[170:173], v[214:217]
    v_fmac_f32 v255, v133, v133
    v_fmac_f32 v254, v207, v207
    v_mfma_f32_16x16x32_bf16 v[222:225], v[210:213], v[36:39], 0
    v_exp_f32 v204, v204
    v_mfma_f32_16x16x32_bf16 v[222:225], v[138:141], v[170:173], v[222:225]
    v_exp_f32 v205, v205
    v_mfma_f32_16x16x32_bf16 v[226:229], v[218:221], v[36:39], 0
    v_cvt_pk_bf16_f32 v36, v190, v191
    v_cvt_pk_bf16_f32 v37, v192, v193
    v_mfma_f32_16x16x32_bf16 v[226:229], v[142:145], v[170:173], v[226:229]
    v_cvt_pk_bf16_f32 v39, v232, 0
    v_cvt_pk_bf16_f32 v187, v204, v205
    v_mfma_f32_16x16x32_bf16 v[126:129], a[240:243], v[118:121], 0
    v_exp_f32 v146, v146
    v_mfma_f32_16x16x32_bf16 v[170:173], v[28:31], v[36:39], 0
    v_exp_f32 v147, v147
    v_mfma_f32_16x16x32_bf16 v[170:173], v[28:31], v[194:197], v[170:173]
    v_cvt_pk_bf16_f32 v188, v146, v147
    v_fmac_f32 v254, v208, v208
    v_mfma_f32_16x16x32_bf16 v[114:117], v[162:165], v[36:39], 0
    v_exp_f32 v148, v148
    v_mfma_f32_16x16x32_bf16 v[114:117], v[134:137], v[194:197], v[114:117]
    v_exp_f32 v149, v149
    v_mfma_f32_16x16x32_bf16 v[190:193], v[210:213], v[36:39], 0
    v_cvt_pk_bf16_f32 v189, v148, v149
    v_fmac_f32 v254, v209, v209
    v_mfma_f32_16x16x32_bf16 v[190:193], v[138:141], v[194:197], v[190:193]
    v_rcp_f32 v171, v170
    v_mfma_f32_16x16x32_bf16 v[146:149], v[218:221], v[36:39], 0
    v_exp_f32 v166, v166
    v_mfma_f32_16x16x32_bf16 v[146:149], v[142:145], v[194:197], v[146:149]
    v_mul_f32 v114, v171, v114
    v_mul_f32 v115, v171, v115
    v_mfma_f32_16x16x32_bf16 v[126:129], a[244:247], v[122:125], v[126:129]
    v_cvt_pk_bf16_f32 v194, v114, v115
    v_mul_f32 v116, v171, v116
    v_mfma_f32_16x16x32_bf16 v[126:129], a[248:251], v[150:153], v[126:129]
    ds_read_b128 v[202:205], v2 offset:12288
    v_mul_f32 v117, v171, v117
    v_mfma_f32_16x16x32_bf16 v[126:129], a[252:255], v[154:157], v[126:129]
    ds_read_b128 v[230:233], v2 offset:13312
    v_cvt_pk_bf16_f32 v195, v116, v117
    v_mfma_f32_16x16x32_bf16 v[126:129], v[82:85], v[158:161], v[126:129]
    ds_read_b128 v[234:237], v2 offset:14336
    v_mul_f32 v190, v171, v190
    v_mfma_f32_16x16x32_bf16 v[126:129], v[86:89], v[174:177], v[126:129]
    ds_read_b128 v[238:241], v2 offset:15360
    v_mul_f32 v191, v171, v191
    v_mfma_f32_16x16x32_bf16 v[114:117], v[90:93], v[118:121], 0
    ds_read_b128 v[118:121], v2 offset:16384
    v_cvt_pk_bf16_f32 v196, v190, v191
    v_mfma_f32_16x16x32_bf16 v[114:117], v[94:97], v[122:125], v[114:117]
    ds_read_b128 v[122:125], v2 offset:17408
    v_mul_f32 v192, v171, v192
    v_mfma_f32_16x16x32_bf16 v[114:117], v[98:101], v[150:153], v[114:117]
    v_fmac_f32 v255, v126, v126
    v_fmac_f32 v255, v127, v127
    v_mfma_f32_16x16x32_bf16 v[114:117], v[102:105], v[154:157], v[114:117]
    v_fmac_f32 v255, v128, v128
    v_fmac_f32 v255, v129, v129
    v_mfma_f32_16x16x32_bf16 v[114:117], v[106:109], v[158:161], v[114:117]
    s_waitcnt lgkmcnt(5)
    v_mul_f32 v193, v171, v193
    v_cvt_pk_bf16_f32 v197, v192, v193
    v_mfma_f32_16x16x32_bf16 v[114:117], v[110:113], v[174:177], v[114:117]
    s_waitcnt lgkmcnt(4)
    ds_write_b128 v3, v[194:197] offset:6144
    v_mfma_f32_16x16x32_bf16 v[242:245], a[216:219], v[202:205], 0
    s_waitcnt lgkmcnt(3)
    v_mul_f32 v146, v171, v146
    v_mul_f32 v147, v171, v147
    v_mfma_f32_16x16x32_bf16 v[242:245], a[220:223], v[230:233], v[242:245]
    s_waitcnt lgkmcnt(2)
    v_fmac_f32 v255, v114, v114
    v_fmac_f32 v255, v115, v115
    v_mfma_f32_16x16x32_bf16 v[242:245], a[224:227], v[234:237], v[242:245]
    s_waitcnt lgkmcnt(1)
    v_fmac_f32 v255, v116, v116
    v_fmac_f32 v255, v117, v117
    v_mfma_f32_16x16x32_bf16 v[242:245], a[228:231], v[238:241], v[242:245]
    v_cvt_pk_bf16_f32 v254, v254, v255
    v_cvt_pk_bf16_f32 v172, v146, v147
    v_mfma_f32_16x16x32_bf16 v[242:245], a[232:235], v[118:121], v[242:245]
    v_mul_f32 v148, v171, v148
    v_mul_f32 v149, v171, v149
    v_mfma_f32_16x16x32_bf16 v[242:245], a[236:239], v[122:125], v[242:245]
    v_cvt_pk_bf16_f32 v173, v148, v149
    v_cvt_pk_bf16_f32 v39, v252, 0
    v_mfma_f32_16x16x32_bf16 v[158:161], a[240:243], v[202:205], 0
    ds_write_b64 v4, v[172:173] offset:10240
    v_mfma_f32_16x16x32_bf16 v[158:161], a[244:247], v[230:233], v[158:161]
    v_exp_f32 v167, v167
    v_mfma_f32_16x16x32_bf16 v[158:161], a[248:251], v[234:237], v[158:161]
    v_cvt_pk_bf16_f32 v36, v166, v167
    v_fma_f32 v255, v242, v242, s33
    v_mfma_f32_16x16x32_bf16 v[158:161], a[252:255], v[238:241], v[158:161]
    v_fmac_f32 v255, v243, v243
    v_fmac_f32 v255, v244, v244
    v_mfma_f32_16x16x32_bf16 v[158:161], v[82:85], v[118:121], v[158:161]
    v_fmac_f32 v255, v245, v245
    v_xor_b32 v2, 65536, v2
    v_mfma_f32_16x16x32_bf16 v[158:161], v[86:89], v[122:125], v[158:161]
    v_exp_f32 v168, v168
    v_mfma_f32_16x16x32_bf16 v[154:157], v[90:93], v[202:205], 0
    v_exp_f32 v169, v169
    v_mfma_f32_16x16x32_bf16 v[154:157], v[94:97], v[230:233], v[154:157]
    ds_read_b128 v[146:149], v9
    v_cvt_pk_bf16_f32 v37, v168, v169
    v_mfma_f32_16x16x32_bf16 v[154:157], v[98:101], v[234:237], v[154:157]
    ds_read_b128 v[150:153], v9 offset:64
    v_fmac_f32 v255, v158, v158
    v_mfma_f32_16x16x32_bf16 v[166:169], v[28:31], v[36:39], 0
    v_fmac_f32 v255, v159, v159
    v_fmac_f32 v255, v160, v160
    v_mfma_f32_16x16x32_bf16 v[166:169], v[28:31], v[186:189], v[166:169]
    v_fmac_f32 v255, v161, v161
    v_add_u32 v6, s75, v6
    v_mfma_f32_16x16x32_bf16 v[174:177], v[162:165], v[36:39], 0
    v_rcp_f32 v183, v182
    v_mfma_f32_16x16x32_bf16 v[174:177], v[134:137], v[186:189], v[174:177]
    v_max3_u32 v25, v25, v183, v182
    v_max3_u32 v25, v25, v171, v170
    v_mfma_f32_16x16x32_bf16 v[170:173], v[210:213], v[36:39], 0
    v_rcp_f32 v167, v166
    v_mfma_f32_16x16x32_bf16 v[170:173], v[138:141], v[186:189], v[170:173]
    v_max3_u32 v25, v25, v167, v166
    v_mul_f32 v214, v183, v214
    v_mfma_f32_16x16x32_bf16 v[190:193], v[218:221], v[36:39], 0
    s_waitcnt lgkmcnt(1)
    v_mul_f32 v174, v167, v174
    v_mul_f32 v175, v167, v175
    v_mfma_f32_16x16x32_bf16 v[190:193], v[142:145], v[186:189], v[190:193]
    s_waitcnt lgkmcnt(0)
    v_cvt_pk_bf16_f32 v174, v174, v175
    v_mul_f32 v176, v167, v176
    v_mfma_f32_16x16x32_bf16 v[154:157], v[102:105], v[238:241], v[154:157]
    ds_read_b128 v[186:189], v0 offset:20480
    v_mul_f32 v177, v167, v177
    v_mfma_f32_16x16x32_bf16 v[154:157], v[106:109], v[118:121], v[154:157]
    ds_read_b128 v[194:197], v1 offset:20480
    v_cvt_pk_bf16_f32 v175, v176, v177
    v_mfma_f32_16x16x32_bf16 v[154:157], v[110:113], v[122:125], v[154:157]
    ds_read_b128 v[122:125], v0 offset:20608
    v_mul_f32 v170, v167, v170
    v_mfma_f32_16x16x32_bf16 v[118:121], v[146:149], v[28:31], 0
    ds_read_b128 v[202:205], v1 offset:20608
    v_mul_f32 v171, v167, v171
    v_mfma_f32_16x16x32_bf16 v[118:121], v[150:153], v[28:31], v[118:121]
    ds_read_b128 v[230:233], v0 offset:20736
    v_cvt_pk_bf16_f32 v176, v170, v171
    v_mfma_f32_16x16x32_bf16 v[234:237], v[146:149], v[134:137], 0
    ds_read_b128 v[238:241], v1 offset:20736
    v_fmac_f32 v255, v154, v154
    v_mfma_f32_16x16x32_bf16 v[234:237], v[150:153], v[162:165], v[234:237]
    v_fmac_f32 v255, v155, v155
    v_fmac_f32 v255, v156, v156
    v_mfma_f32_16x16x32_bf16 v[134:137], v[146:149], v[138:141], 0
    v_fmac_f32 v255, v157, v157
    v_cvt_pk_bf16_f32 v255, v255, v255
    v_mfma_f32_16x16x32_bf16 v[134:137], v[150:153], v[210:213], v[134:137]
    s_waitcnt lgkmcnt(5)
    ds_write_b64 v4, v[254:255] offset:18432
    v_mfma_f32_16x16x32_bf16 v[138:141], v[146:149], v[142:145], 0
    s_waitcnt lgkmcnt(4)
    v_mul_f32 v172, v167, v172
    v_mul_f32 v173, v167, v173
    v_mfma_f32_16x16x32_bf16 v[138:141], v[150:153], v[218:221], v[138:141]
    s_waitcnt lgkmcnt(3)
    v_cvt_pk_bf16_f32 v177, v172, v173
    v_mul_f32 v190, v167, v190
    v_mfma_f32_16x16x32_bf16 v[142:145], a[72:75], v[186:189], 0
    s_waitcnt lgkmcnt(2)
    ds_write_b128 v3, v[174:177] offset:12288
    v_mfma_f32_16x16x32_bf16 v[142:145], a[76:79], v[194:197], v[142:145]
    s_waitcnt lgkmcnt(2)
    v_mul_f32 v191, v167, v191
    v_cvt_pk_bf16_f32 v254, v190, v191
    v_mfma_f32_16x16x32_bf16 v[142:145], a[80:83], v[122:125], v[142:145]
    v_mul_f32 v192, v167, v192
    v_mul_f32 v193, v167, v193
    v_mfma_f32_16x16x32_bf16 v[142:145], a[84:87], v[202:205], v[142:145]
    v_cvt_pk_bf16_f32 v255, v192, v193
    v_mul_f32 v215, v183, v215
    v_mfma_f32_16x16x32_bf16 v[142:145], a[88:91], v[230:233], v[142:145]
    ds_write_b64 v4, v[254:255] offset:16384
    v_mfma_f32_16x16x32_bf16 v[142:145], a[92:95], v[238:241], v[142:145]
    v_rcp_f32_dpp v119, v118 quad_perm:[0,0,0,0] row_mask:0xf bank_mask:0xf
    v_mfma_f32_16x16x32_bf16 v[150:153], a[96:99], v[186:189], 0
    v_max3_u32 v25, v25, v118, v119
    v_mul_f32 v234, v234, v119
    v_mfma_f32_16x16x32_bf16 v[150:153], a[100:103], v[194:197], v[150:153]
    v_cvt_pk_bf16_f32 v118, v214, v215
    v_mul_f32_dpp v234, v134, v119 quad_perm:[0,1,2,3] row_mask:0x2 bank_mask:0xf
    v_mfma_f32_16x16x32_bf16 v[150:153], a[104:107], v[122:125], v[150:153]
    v_mul_f32 v216, v183, v216
    v_mul_f32_dpp v234, v138, v119 quad_perm:[0,1,2,3] row_mask:0x4 bank_mask:0xf
    v_mfma_f32_16x16x32_bf16 v[150:153], a[108:111], v[202:205], v[150:153]
    v_cvt_pk_bf16_f32 v234, v234, v234
    v_mul_f32 v217, v183, v217
    v_mfma_f32_16x16x32_bf16 v[150:153], a[112:115], v[230:233], v[150:153]
    ds_write_b16 v7, v234
    v_mfma_f32_16x16x32_bf16 v[150:153], a[116:119], v[238:241], v[150:153]
    v_cvt_pk_bf16_f32 v119, v216, v217
    v_mul_f32 v222, v183, v222
    v_mfma_f32_16x16x32_bf16 v[134:137], a[120:123], v[186:189], 0
    v_mul_f32 v223, v183, v223
    v_cvt_pk_bf16_f32 v120, v222, v223
    v_mfma_f32_16x16x32_bf16 v[134:137], a[124:127], v[194:197], v[134:137]
    v_mul_f32 v224, v183, v224
    v_mul_f32 v225, v183, v225
    v_mfma_f32_16x16x32_bf16 v[134:137], a[128:131], v[122:125], v[134:137]
    v_cvt_pk_bf16_f32 v121, v224, v225
    v_mul_f32 v226, v183, v226
    v_mfma_f32_16x16x32_bf16 v[134:137], a[132:135], v[202:205], v[134:137]
    ds_write_b128 v3, v[118:121] offset:0
    v_mfma_f32_16x16x32_bf16 v[134:137], a[136:139], v[230:233], v[134:137]
    v_mul_f32 v227, v183, v227
    v_cvt_pk_bf16_f32 v254, v226, v227
    v_mfma_f32_16x16x32_bf16 v[134:137], a[140:143], v[238:241], v[134:137]
    v_mul_f32 v228, v183, v228
    v_mul_f32 v229, v183, v229
    v_mfma_f32_16x16x32_bf16 v[138:141], a[0:3], v[186:189], 0
    v_cvt_pk_bf16_f32 v255, v228, v229
    v_xor_b32 v3, 65536, v3
    v_mfma_f32_16x16x32_bf16 v[138:141], a[4:7], v[194:197], v[138:141]
    ds_write_b64 v4, v[254:255] offset:4096
    v_mfma_f32_16x16x32_bf16 v[138:141], a[8:11], v[122:125], v[138:141]
    v_xor_b32 v4, 65536, v4
    v_add_u32 v7, s76, v7
    v_mfma_f32_16x16x32_bf16 v[138:141], a[12:15], v[202:205], v[138:141]
    v_cvt_pk_f16_f32 v146, v142, v143
    v_pk_mul_f16 v143, v146, v146
    v_mfma_f32_16x16x32_bf16 v[138:141], a[16:19], v[230:233], v[138:141]
    v_cvt_pk_f16_f32 v147, v144, v145
    v_pk_fma_f16 v143, v147, v147, v143
    v_mfma_f32_16x16x32_bf16 v[138:141], a[20:23], v[238:241], v[138:141]
    v_cvt_pk_f16_f32 v148, v150, v151
    v_pk_fma_f16 v143, v148, v148, v143
    v_mfma_f32_16x16x32_bf16 v[166:169], a[24:27], v[186:189], 0
    v_cvt_pk_f16_f32 v149, v152, v153
    v_pk_fma_f16 v143, v149, v149, v143
    v_mfma_f32_16x16x32_bf16 v[166:169], a[28:31], v[194:197], v[166:169]
    v_cvt_pk_f16_f32 v120, v134, v135
    v_pk_fma_f16 v143, v120, v120, v143
    v_mfma_f32_16x16x32_bf16 v[166:169], a[32:35], v[122:125], v[166:169]
    s_waitcnt lgkmcnt(0)
    v_cvt_pk_f16_f32 v121, v136, v137
    v_pk_fma_f16 v143, v121, v121, v143
    v_mfma_f32_16x16x32_bf16 v[166:169], a[36:39], v[202:205], v[166:169]
    s_nop 0
    v_mfma_f32_16x16x32_bf16 v[166:169], a[40:43], v[230:233], v[166:169]
    s_barrier
    v_mfma_f32_16x16x32_bf16 v[166:169], a[44:47], v[238:241], v[166:169]
    s_nop 0
    v_mfma_f32_16x16x32_bf16 v[134:137], a[48:51], v[186:189], 0
    s_nop 0
    v_mfma_f32_16x16x32_bf16 v[134:137], a[52:55], v[194:197], v[134:137]
    s_cbranch_scc1 L_loop_fast1
    s_branch L_final_fast
.p2align 6
L_loop_fast2:
    v_mfma_f32_16x16x32_bf16 v[134:137], a[56:59], v[122:125], v[134:137]
    s_add_u32 s12, s40, s27
    ds_read_b128 v[190:193], v2 offset:18432
    v_cvt_pk_f16_f32 v150, v138, v139
    v_mfma_f32_16x16x32_bf16 v[134:137], a[60:63], v[202:205], v[134:137]
    s_addc_u32 s13, s41, 0
    ds_read_b128 v[210:213], v2 offset:19456
    v_pk_mul_f16 v142, v150, v150
    v_mfma_f32_16x16x32_bf16 v[134:137], a[64:67], v[230:233], v[134:137]
    s_sub_u32 s14, s36, s27
    ds_read_b128 v[174:177], v5 offset:32
    v_cvt_pk_f16_f32 v151, v140, v141
    v_mfma_f32_16x16x32_bf16 v[134:137], a[68:71], v[238:241], v[134:137]
    s_cmp_ge_u32 s18, 2
    ds_read2_b64 v[162:165], v5 offset0:6 offset1:9
    v_pk_fma_f16 v142, v151, v151, v142
    v_mfma_f32_16x16x32_bf16 v[138:141], v[186:189], a[144:147], 0
    s_cselect_b32 s14, s14, 0
    ds_read_b128 v[170:173], v5
    v_cvt_pk_f16_f32 v152, v166, v167
    v_mfma_f32_16x16x32_bf16 v[138:141], v[194:197], a[148:151], v[138:141]
    s_sub_u32 s82, s72, s71
    ds_read_b32 v254, v6 offset:192
    v_pk_fma_f16 v142, v152, v152, v142
    v_mfma_f32_16x16x32_bf16 v[138:141], v[122:125], a[152:155], v[138:141]
    s_mul_i32 s74, s82, 336
    v_cvt_pk_f16_f32 v153, v168, v169
    v_pk_fma_f16 v142, v153, v153, v142
    v_mfma_f32_16x16x32_bf16 v[138:141], v[202:205], a[156:159], v[138:141]
    s_mul_i32 s75, s82, 272
    v_cvt_pk_f16_f32 v118, v134, v135
    v_pk_fma_f16 v142, v118, v118, v142
    v_mfma_f32_16x16x32_bf16 v[138:141], v[230:233], a[160:163], v[138:141]
    s_waitcnt lgkmcnt(5)
    ds_read_b128 v[182:185], v0 offset:26624
    v_cvt_pk_f16_f32 v119, v136, v137
    v_mfma_f32_16x16x32_bf16 v[166:169], v[32:35], v[190:193], 0
    s_waitcnt lgkmcnt(5)
    v_pk_fma_f16 v142, v119, v119, v142
    v_add_u32 v5, s74, v5
    v_mfma_f32_16x16x32_bf16 v[166:169], v[32:35], v[210:213], v[166:169]
    s_waitcnt lgkmcnt(4)
    v_pk_mul_f16 v145, v146, v174
    v_pk_fma_f16 v145, v147, v175, v145
    v_mfma_f32_16x16x32_bf16 v[138:141], v[238:241], a[164:167], v[138:141]
    s_mul_i32 s76, s82, 16
    ds_read_b128 v[210:213], v1 offset:26624
    v_pk_fma_f16 v145, v148, v176, v145
    v_mfma_f32_16x16x32_bf16 v[214:217], v[186:189], a[168:171], 0
    s_waitcnt lgkmcnt(3)
    ds_read_b128 v[218:221], v0 offset:26752
    v_pk_fma_f16 v145, v149, v177, v145
    v_mfma_f32_16x16x32_bf16 v[214:217], v[194:197], a[172:175], v[214:217]
    s_waitcnt lgkmcnt(3)
    ds_read_b128 v[222:225], v1 offset:26752
    v_mov_b32_dpp v254, v23 quad_perm:[0,1,2,3] row_mask:0x7 bank_mask:0xf
    v_mfma_f32_16x16x32_bf16 v[214:217], v[122:125], a[176:179], v[214:217]
    s_add_u32 s34, s18, 2
    ds_read_b128 v[226:229], v0 offset:26880
    v_pk_fma_f16 v145, v120, v164, v145
    v_mfma_f32_16x16x32_bf16 v[214:217], v[202:205], a[180:183], v[214:217]
    s_add_u32 s8, s60, s23
    ds_read_b128 v[190:193], v1 offset:26880
    v_pk_fma_f16 v145, v121, v165, v145
    v_mfma_f32_16x16x32_bf16 v[214:217], v[230:233], a[184:187], v[214:217]
    s_waitcnt lgkmcnt(5)
    v_pk_mul_f16 v144, v150, v170
    v_pk_fma_f16 v144, v151, v171, v144
    v_mfma_f32_16x16x32_bf16 v[214:217], v[238:241], a[188:191], v[214:217]
    s_addc_u32 s9, s61, 0
    v_pk_fma_f16 v144, v152, v172, v144
    v_pk_fma_f16 v144, v153, v173, v144
    v_mfma_f32_16x16x32_bf16 v[246:249], v[186:189], a[192:195], 0
    s_sub_u32 s10, s36, s23
    v_pk_fma_f16 v144, v118, v162, v144
    v_pk_fma_f16 v144, v119, v163, v144
    v_mfma_f32_16x16x32_bf16 v[246:249], v[194:197], a[196:199], v[246:249]
    s_cmp_le_u32 s34, s45
    v_cvt_pk_bf16_f32 v134, v138, v139
    v_cvt_pk_bf16_f32 v135, v140, v141
    v_mfma_f32_16x16x32_f16 v[234:237], v[40:43], v[142:145], 0
    s_cselect_b32 s10, s10, 0
    v_cvt_pk_bf16_f32 v138, v214, v215
    v_cvt_pk_bf16_f32 v139, v216, v217
    v_mfma_f32_16x16x32_bf16 v[246:249], v[122:125], a[200:203], v[246:249]
    s_add_u32 m0, s28, 0
    v_mul_f32 v136, 0x3baaaaab, v166
    v_mul_f32 v255, 0x3baaaaab, v167
    v_mfma_f32_16x16x32_bf16 v[246:249], v[202:205], a[204:207], v[246:249]
    s_mov_b32 s27, s26
    v_rsq_f32 v234, v234
    v_mfma_f32_16x16x32_bf16 v[246:249], v[230:233], a[208:211], v[246:249]
    s_mov_b32 s26, s25
    v_rsq_f32 v235, v235
    v_mfma_f32_16x16x32_bf16 v[246:249], v[238:241], a[212:215], v[246:249]
    s_mov_b32 s25, s24
    v_mul_f32 v140, s31, v234
    v_cvt_pk_f16_f32 v141, v140, v235
    v_mfma_f32_16x16x32_bf16 v[122:125], a[72:75], v[182:185], 0
    s_waitcnt lgkmcnt(0)
    v_fma_f32 v236, v236, v140, v22
    v_fmac_f32_dpp v254, v237, v235 quad_perm:[0,1,2,3] row_mask:0x1 bank_mask:0xf
    v_mfma_f32_16x16x32_bf16 v[122:125], a[76:79], v[210:213], v[122:125]
    s_mov_b32 s24, s23
    v_cvt_pk_bf16_f32 v142, v246, v247
    v_cvt_pk_bf16_f32 v143, v248, v249
    v_mfma_f32_16x16x32_bf16 v[122:125], a[80:83], v[218:221], v[122:125]
    s_mov_b32 s71, s72
    v_pk_mul_f16 v146, v146, v141 op_sel:[0,1] op_sel_hi:[1,1]
    v_pk_mul_f16 v147, v147, v141 op_sel:[0,1] op_sel_hi:[1,1]
    v_mfma_f32_16x16x32_bf16 v[122:125], a[84:87], v[222:225], v[122:125]
    s_mov_b32 s72, s73
    v_pk_mul_f16 v148, v148, v141 op_sel:[0,1] op_sel_hi:[1,1]
    v_pk_mul_f16 v149, v149, v141 op_sel:[0,1] op_sel_hi:[1,1]
    v_mfma_f32_16x16x32_bf16 v[122:125], a[88:91], v[226:229], v[122:125]
    v_pk_mul_f16 v120, v120, v141 op_sel:[0,1] op_sel_hi:[1,1]
    v_pk_mul_f16 v121, v121, v141 op_sel:[0,1] op_sel_hi:[1,1]
    v_mfma_f32_16x16x32_bf16 v[122:125], a[92:95], v[190:193], v[122:125]
    v_pk_mul_f16 v150, v150, v141 op_sel:[0,0] op_sel_hi:[1,0]
    v_pk_mul_f16 v151, v151, v141 op_sel:[0,0] op_sel_hi:[1,0]
    v_mfma_f32_16x16x32_bf16 v[186:189], a[96:99], v[182:185], 0
    v_pk_mul_f16 v152, v152, v141 op_sel:[0,0] op_sel_hi:[1,0]
    v_pk_mul_f16 v153, v153, v141 op_sel:[0,0] op_sel_hi:[1,0]
    v_mfma_f32_16x16x32_bf16 v[186:189], a[100:103], v[210:213], v[186:189]
    v_pk_mul_f16 v118, v118, v141 op_sel:[0,0] op_sel_hi:[1,0]
    v_pk_mul_f16 v119, v119, v141 op_sel:[0,0] op_sel_hi:[1,0]
    v_mfma_f32_16x16x32_bf16 v[186:189], a[104:107], v[218:221], v[186:189]
    v_max3_u32 v44, v44, v234, v235
    v_mul_f32 v144, 0x3baaaaab, v168
    v_mfma_f32_16x16x32_bf16 v[186:189], a[108:111], v[222:225], v[186:189]
    v_rsq_f32 v136, v136
    v_mfma_f32_16x16x32_bf16 v[186:189], a[112:115], v[226:229], v[186:189]
    v_rsq_f32 v255, v255
    v_mfma_f32_16x16x32_bf16 v[186:189], a[116:119], v[190:193], v[186:189]
    v_rsq_f32 v144, v144
    v_mfma_f32_16x16x32_bf16 v[194:197], a[120:123], v[182:185], 0
    v_mul_f32 v178, v136, v178
    v_mul_f32 v179, v136, v179
    v_mfma_f32_16x16x32_bf16 v[194:197], a[124:127], v[210:213], v[194:197]
    v_cvt_pk_bf16_f32 v166, v178, v179
    v_mul_f32 v180, v136, v180
    v_mfma_f32_16x16x32_bf16 v[194:197], a[128:131], v[218:221], v[194:197]
    v_mul_f32 v181, v136, v181
    v_cvt_pk_bf16_f32 v167, v180, v181
    v_mfma_f32_16x16x32_bf16 v[194:197], a[132:135], v[222:225], v[194:197]
    v_mul_f32 v198, v136, v198
    v_mul_f32 v199, v136, v199
    v_mfma_f32_16x16x32_bf16 v[194:197], a[136:139], v[226:229], v[194:197]
    v_cvt_pk_bf16_f32 v168, v198, v199
    v_mul_f32 v200, v136, v200
    v_mfma_f32_16x16x32_bf16 v[194:197], a[140:143], v[190:193], v[194:197]
    v_mul_f32 v201, v136, v201
    v_cvt_pk_bf16_f32 v169, v200, v201
    v_mfma_f32_16x16x32_bf16 v[178:181], a[0:3], v[182:185], 0
    buffer_store_dwordx4 v[166:169], v15, s[12:15], 0 offen nt
    v_mul_f32 v206, v136, v206
    v_mul_f32 v207, v136, v207
    v_cvt_pk_bf16_f32 v140, v206, v207
    v_mul_f32 v208, v136, v208
    v_mfma_f32_16x16x32_bf16 v[178:181], a[4:7], v[210:213], v[178:181]
    v_mul_f32 v209, v136, v209
    v_cvt_pk_bf16_f32 v141, v208, v209
    v_mfma_f32_16x16x32_bf16 v[178:181], a[8:11], v[218:221], v[178:181]
    v_cvt_pk_f16_f32 v166, v122, v123
    v_pk_mul_f16 v199, v166, v166
    v_mfma_f32_16x16x32_bf16 v[178:181], a[12:15], v[222:225], v[178:181]
    v_cvt_pk_f16_f32 v167, v124, v125
    v_pk_fma_f16 v199, v167, v167, v199
    v_mfma_f32_16x16x32_bf16 v[178:181], a[16:19], v[226:229], v[178:181]
    v_cvt_pk_f16_f32 v168, v186, v187
    v_pk_fma_f16 v199, v168, v168, v199
    v_mfma_f32_16x16x32_bf16 v[178:181], a[20:23], v[190:193], v[178:181]
    v_cvt_pk_f16_f32 v169, v188, v189
    v_pk_fma_f16 v199, v169, v169, v199
    v_mfma_f32_16x16x32_bf16 v[186:189], a[24:27], v[182:185], 0
    v_cvt_pk_f16_f32 v124, v194, v195
    v_pk_fma_f16 v199, v124, v124, v199
    v_mfma_f32_16x16x32_bf16 v[186:189], a[28:31], v[210:213], v[186:189]
    v_cvt_pk_f16_f32 v125, v196, v197
    v_pk_fma_f16 v199, v125, v125, v199
    v_mfma_f32_16x16x32_bf16 v[186:189], a[32:35], v[218:221], v[186:189]
    v_cvt_pk_f16_f32 v178, v178, v179
    v_pk_mul_f16 v198, v178, v178
    v_mfma_f32_16x16x32_bf16 v[186:189], a[36:39], v[222:225], v[186:189]
    v_cvt_pk_f16_f32 v179, v180, v181
    v_pk_fma_f16 v198, v179, v179, v198
    v_mfma_f32_16x16x32_bf16 v[186:189], a[40:43], v[226:229], v[186:189]
    v_pk_mul_f16 v200, v178, v170
    v_pk_fma_f16 v200, v179, v171, v200
    v_mfma_f32_16x16x32_bf16 v[186:189], a[44:47], v[190:193], v[186:189]
    v_pk_mul_f16 v201, v166, v174
    v_pk_fma_f16 v201, v167, v175, v201
    v_mfma_f32_16x16x32_bf16 v[194:197], a[48:51], v[182:185], 0
    v_pk_fma_f16 v201, v168, v176, v201
    v_pk_fma_f16 v201, v169, v177, v201
    v_mfma_f32_16x16x32_bf16 v[194:197], a[52:55], v[210:213], v[194:197]
    v_pk_fma_f16 v201, v124, v164, v201
    v_pk_fma_f16 v201, v125, v165, v201
    v_mfma_f32_16x16x32_bf16 v[194:197], a[56:59], v[218:221], v[194:197]
    v_cvt_pk_f16_f32 v180, v186, v187
    v_pk_fma_f16 v198, v180, v180, v198
    v_mfma_f32_16x16x32_bf16 v[194:197], a[60:63], v[222:225], v[194:197]
    v_cvt_pk_f16_f32 v181, v188, v189
    v_pk_fma_f16 v198, v181, v181, v198
    v_mfma_f32_16x16x32_bf16 v[194:197], a[64:67], v[226:229], v[194:197]
    v_pk_fma_f16 v200, v180, v172, v200
    v_pk_fma_f16 v200, v181, v173, v200
    v_mfma_f32_16x16x32_bf16 v[194:197], a[68:71], v[190:193], v[194:197]
    buffer_store_dwordx2 v[140:141], v18, s[12:15], 0 offen nt
    v_mul_f32 v242, v144, v242
    v_mul_f32 v243, v144, v243
    v_mfma_f32_16x16x32_bf16 v[186:189], v[182:185], a[144:147], 0
    v_cvt_pk_bf16_f32 v238, v242, v243
    v_mul_f32 v244, v144, v244
    v_mfma_f32_16x16x32_bf16 v[186:189], v[210:213], a[148:151], v[186:189]
    v_mul_f32 v245, v144, v245
    v_cvt_pk_f16_f32 v122, v194, v195
    v_mfma_f32_16x16x32_bf16 v[186:189], v[218:221], a[152:155], v[186:189]
    v_pk_fma_f16 v198, v122, v122, v198
    v_cvt_pk_f16_f32 v123, v196, v197
    v_mfma_f32_16x16x32_bf16 v[186:189], v[222:225], a[156:159], v[186:189]
    v_pk_fma_f16 v198, v123, v123, v198
    v_pk_fma_f16 v200, v122, v162, v200
    v_mfma_f32_16x16x32_bf16 v[186:189], v[226:229], a[160:163], v[186:189]
    ds_read_b128 v[202:205], v0 offset:32768
    v_pk_fma_f16 v200, v123, v163, v200
    v_mfma_f32_16x16x32_bf16 v[186:189], v[190:193], a[164:167], v[186:189]
    ds_read_b128 v[194:197], v1 offset:32768
    v_cvt_pk_bf16_f32 v239, v244, v245
    v_mfma_f32_16x16x32_f16 v[230:233], v[40:43], v[198:201], 0
    v_mul_f32 v158, v144, v158
    v_mul_f32 v159, v144, v159
    v_mfma_f32_16x16x32_bf16 v[246:249], v[182:185], a[168:171], 0
    ds_read_b128 v[214:217], v0 offset:32896
    v_cvt_pk_bf16_f32 v240, v158, v159
    v_mfma_f32_16x16x32_bf16 v[246:249], v[210:213], a[172:175], v[246:249]
    ds_read_b128 v[206:209], v1 offset:32896
    v_cvt_pk_bf16_f32 v136, v186, v187
    v_mfma_f32_16x16x32_bf16 v[246:249], v[218:221], a[176:179], v[246:249]
    ds_read_b128 v[198:201], v0 offset:33024
    v_cvt_pk_bf16_f32 v137, v188, v189
    v_mfma_f32_16x16x32_bf16 v[246:249], v[222:225], a[180:183], v[246:249]
    ds_read_b128 v[186:189], v1 offset:33024
    v_mul_f32 v160, v144, v160
    v_mfma_f32_16x16x32_bf16 v[246:249], v[226:229], a[184:187], v[246:249]
    v_rsq_f32 v230, v230
    v_mfma_f32_16x16x32_bf16 v[246:249], v[190:193], a[188:191], v[246:249]
    s_waitcnt lgkmcnt(5)
    v_rsq_f32 v231, v231
    v_mfma_f32_16x16x32_bf16 v[242:245], v[182:185], a[192:195], 0
    s_waitcnt lgkmcnt(4)
    v_mul_f32 v234, s31, v230
    v_cvt_pk_f16_f32 v235, v234, v231
    v_mfma_f32_16x16x32_bf16 v[242:245], v[210:213], a[196:199], v[242:245]
    v_fma_f32 v232, v232, v234, v24
    v_fmac_f32_dpp v254, v233, v231 quad_perm:[0,1,2,3] row_mask:0x2 bank_mask:0xf
    v_mfma_f32_16x16x32_bf16 v[242:245], v[218:221], a[200:203], v[242:245]
    s_waitcnt lgkmcnt(3)
    v_cvt_pk_bf16_f32 v140, v246, v247
    v_cvt_pk_bf16_f32 v141, v248, v249
    v_mfma_f32_16x16x32_bf16 v[242:245], v[222:225], a[204:207], v[242:245]
    s_waitcnt lgkmcnt(2)
    v_mul_f32 v161, v144, v161
    v_cvt_pk_bf16_f32 v241, v160, v161
    v_mfma_f32_16x16x32_bf16 v[242:245], v[226:229], a[208:211], v[242:245]
    s_waitcnt lgkmcnt(1)
    buffer_store_dwordx4 v[238:241], v17, s[12:15], 0 offen nt
    v_mul_f32 v154, v144, v154
    v_mul_f32 v155, v144, v155
    v_cvt_pk_bf16_f32 v154, v154, v155
    v_mul_f32 v156, v144, v156
    v_mfma_f32_16x16x32_bf16 v[242:245], v[190:193], a[212:215], v[242:245]
    s_waitcnt lgkmcnt(0)
    v_mul_f32 v157, v144, v157
    v_cvt_pk_bf16_f32 v155, v156, v157
    v_mfma_f32_16x16x32_bf16 v[158:161], a[72:75], v[202:205], 0
    v_pk_mul_f16 v166, v166, v235 op_sel:[0,1] op_sel_hi:[1,1]
    v_pk_mul_f16 v167, v167, v235 op_sel:[0,1] op_sel_hi:[1,1]
    v_mfma_f32_16x16x32_bf16 v[158:161], a[76:79], v[194:197], v[158:161]
    v_pk_mul_f16 v168, v168, v235 op_sel:[0,1] op_sel_hi:[1,1]
    v_cvt_pk_bf16_f32 v144, v242, v243
    v_mfma_f32_16x16x32_bf16 v[158:161], a[80:83], v[214:217], v[158:161]
    v_cvt_pk_bf16_f32 v145, v244, v245
    v_pk_mul_f16 v169, v169, v235 op_sel:[0,1] op_sel_hi:[1,1]
    v_mfma_f32_16x16x32_bf16 v[158:161], a[84:87], v[206:209], v[158:161]
    v_pk_mul_f16 v124, v124, v235 op_sel:[0,1] op_sel_hi:[1,1]
    v_pk_mul_f16 v125, v125, v235 op_sel:[0,1] op_sel_hi:[1,1]
    v_mfma_f32_16x16x32_bf16 v[158:161], a[88:91], v[198:201], v[158:161]
    v_pk_mul_f16 v178, v178, v235 op_sel:[0,0] op_sel_hi:[1,0]
    v_pk_mul_f16 v179, v179, v235 op_sel:[0,0] op_sel_hi:[1,0]
    v_mfma_f32_16x16x32_bf16 v[158:161], a[92:95], v[186:189], v[158:161]
    v_pk_mul_f16 v180, v180, v235 op_sel:[0,0] op_sel_hi:[1,0]
    v_pk_mul_f16 v181, v181, v235 op_sel:[0,0] op_sel_hi:[1,0]
    v_mfma_f32_16x16x32_bf16 v[182:185], a[96:99], v[202:205], 0
    v_pk_mul_f16 v122, v122, v235 op_sel:[0,0] op_sel_hi:[1,0]
    v_pk_mul_f16 v123, v123, v235 op_sel:[0,0] op_sel_hi:[1,0]
    v_mfma_f32_16x16x32_bf16 v[182:185], a[100:103], v[194:197], v[182:185]
    v_max3_u32 v44, v44, v230, v231
    v_mul_f32 v130, v255, v130
    v_mfma_f32_16x16x32_bf16 v[182:185], a[104:107], v[214:217], v[182:185]
    v_cvt_pk_f16_f32 v158, v158, v159
    v_pk_mul_f16 v191, v158, v158
    v_mfma_f32_16x16x32_bf16 v[182:185], a[108:111], v[206:209], v[182:185]
    v_cvt_pk_f16_f32 v159, v160, v161
    v_pk_fma_f16 v191, v159, v159, v191
    v_mfma_f32_16x16x32_bf16 v[182:185], a[112:115], v[198:201], v[182:185]
    v_pk_mul_f16 v193, v158, v174
    v_pk_fma_f16 v193, v159, v175, v193
    v_mfma_f32_16x16x32_bf16 v[182:185], a[116:119], v[186:189], v[182:185]
    v_exp_f32 v232, v232
    v_mfma_f32_16x16x32_bf16 v[210:213], a[120:123], v[202:205], 0
    v_exp_f32 v236, v236
    v_mfma_f32_16x16x32_bf16 v[210:213], a[124:127], v[194:197], v[210:213]
    v_cvt_pk_bf16_f32 v39, v236, 0
    v_mul_f32 v131, v255, v131
    v_mfma_f32_16x16x32_bf16 v[210:213], a[128:131], v[214:217], v[210:213]
    s_waitcnt vmcnt(3)
    ds_write_b16 v8, v45 offset:512
    v_mfma_f32_16x16x32_bf16 v[210:213], a[132:135], v[206:209], v[210:213]
    buffer_store_dwordx2 v[154:155], v20, s[12:15], 0 offen nt
    v_cvt_pk_f16_f32 v160, v182, v183
    v_mfma_f32_16x16x32_bf16 v[210:213], a[136:139], v[198:201], v[210:213]
    v_pk_fma_f16 v191, v160, v160, v191
    v_cvt_pk_f16_f32 v161, v184, v185
    v_mfma_f32_16x16x32_bf16 v[210:213], a[140:143], v[186:189], v[210:213]
    v_pk_fma_f16 v191, v161, v161, v191
    v_pk_fma_f16 v193, v160, v176, v193
    v_mfma_f32_16x16x32_bf16 v[154:157], a[0:3], v[202:205], 0
    v_pk_fma_f16 v193, v161, v177, v193
    v_cvt_pk_bf16_f32 v130, v130, v131
    v_mfma_f32_16x16x32_bf16 v[154:157], a[4:7], v[194:197], v[154:157]
    v_mul_f32 v132, v255, v132
    v_mul_f32 v133, v255, v133
    v_mfma_f32_16x16x32_bf16 v[154:157], a[8:11], v[214:217], v[154:157]
    v_cvt_pk_f16_f32 v176, v210, v211
    v_pk_fma_f16 v191, v176, v176, v191
    v_mfma_f32_16x16x32_bf16 v[154:157], a[12:15], v[206:209], v[154:157]
    s_waitcnt lgkmcnt(0)
    v_cvt_pk_f16_f32 v177, v212, v213
    v_pk_fma_f16 v191, v177, v177, v191
    v_mfma_f32_16x16x32_bf16 v[154:157], a[16:19], v[198:201], v[154:157]
    v_pk_fma_f16 v193, v176, v164, v193
    v_mfma_f32_16x16x32_bf16 v[154:157], a[20:23], v[186:189], v[154:157]
    v_pk_fma_f16 v193, v177, v165, v193
    v_mfma_f32_16x16x32_bf16 v[182:185], a[24:27], v[202:205], 0
    s_barrier
    v_cvt_pk_bf16_f32 v131, v132, v133
    v_mfma_f32_16x16x32_bf16 v[182:185], a[28:31], v[194:197], v[182:185]
    ds_read2_b32 v[164:165], v6 offset0:0 offset1:0
    v_mfma_f32_16x16x32_bf16 v[182:185], a[32:35], v[214:217], v[182:185]
    ds_read2_b32 v[212:213], v6 offset0:16 offset1:16
    v_cvt_pk_f16_f32 v154, v154, v155
    v_mfma_f32_16x16x32_bf16 v[182:185], a[36:39], v[206:209], v[182:185]
    ds_read2_b32 v[220:221], v6 offset0:32 offset1:32
    v_pk_mul_f16 v190, v154, v154
    v_mfma_f32_16x16x32_bf16 v[182:185], a[40:43], v[198:201], v[182:185]
    ds_read_u16 v133, v9 offset:256
    v_cvt_pk_f16_f32 v155, v156, v157
    v_mfma_f32_16x16x32_bf16 v[182:185], a[44:47], v[186:189], v[182:185]
    v_pk_fma_f16 v190, v155, v155, v190
    v_pk_mul_f16 v192, v154, v170
    v_mfma_f32_16x16x32_bf16 v[222:225], a[48:51], v[202:205], 0
    v_pk_fma_f16 v192, v155, v171, v192
    v_mul_f32 v126, v255, v126
    v_mfma_f32_16x16x32_bf16 v[222:225], a[52:55], v[194:197], v[222:225]
    v_mul_f32 v127, v255, v127
    v_cvt_pk_bf16_f32 v132, v126, v127
    v_mfma_f32_16x16x32_bf16 v[222:225], a[56:59], v[214:217], v[222:225]
    buffer_load_dwordx4 v10, s[8:11], 0 offen nt lds
    v_cvt_pk_f16_f32 v156, v182, v183
    v_mfma_f32_16x16x32_bf16 v[222:225], a[60:63], v[206:209], v[222:225]
    s_add_u32 m0, s28, 4096
    v_pk_fma_f16 v190, v156, v156, v190
    v_cvt_pk_f16_f32 v157, v184, v185
    v_mfma_f32_16x16x32_bf16 v[222:225], a[64:67], v[198:201], v[222:225]
    s_waitcnt lgkmcnt(2)
    v_pk_fma_f16 v190, v157, v157, v190
    v_pk_fma_f16 v192, v156, v172, v192
    v_mfma_f32_16x16x32_bf16 v[222:225], a[68:71], v[186:189], v[222:225]
    s_waitcnt lgkmcnt(1)
    ds_read_b128 v[182:185], v2 offset:0
    v_pk_fma_f16 v192, v157, v173, v192
    v_mfma_f32_16x16x32_bf16 v[170:173], v[202:205], a[144:147], 0
    s_waitcnt lgkmcnt(1)
    ds_read_b128 v[226:229], v2 offset:1024
    v_readfirstlane_b32 s77, v133
    v_mfma_f32_16x16x32_bf16 v[170:173], v[194:197], a[148:151], v[170:173]
    ds_read_b128 v[234:237], v2 offset:2048
    buffer_load_dwordx4 v11, s[8:11], 0 offen nt lds
    v_mfma_f32_16x16x32_bf16 v[170:173], v[214:217], a[152:155], v[170:173]
    s_add_u32 m0, s28, 8192
    ds_read_b128 v[238:241], v2 offset:3072
    v_cvt_pk_f16_f32 v174, v222, v223
    v_mfma_f32_16x16x32_bf16 v[170:173], v[206:209], a[156:159], v[170:173]
    s_mul_i32 s78, s77, 2688
    ds_read_b128 v[242:245], v2 offset:4096
    v_pk_fma_f16 v190, v174, v174, v190
    v_mfma_f32_16x16x32_bf16 v[170:173], v[198:201], a[160:163], v[170:173]
    ds_read_b128 v[246:249], v2 offset:5120
    v_cvt_pk_f16_f32 v175, v224, v225
    v_mfma_f32_16x16x32_bf16 v[170:173], v[186:189], a[164:167], v[170:173]
    v_pk_fma_f16 v190, v175, v175, v190
    v_pk_fma_f16 v192, v174, v162, v192
    v_mfma_f32_16x16x32_bf16 v[222:225], v[202:205], a[168:171], 0
    buffer_load_dwordx4 v12, s[8:11], 0 offen nt lds
    v_pk_fma_f16 v192, v175, v163, v192
    v_mfma_f32_16x16x32_bf16 v[222:225], v[194:197], a[172:175], v[222:225]
    s_waitcnt lgkmcnt(5)
    v_mul_f32 v128, v255, v128
    v_cvt_pk_bf16_f32 v162, v170, v171
    v_mfma_f32_16x16x32_f16 v[250:253], v[40:43], v[190:193], 0
    s_add_u32 m0, s28, 12288
    v_cvt_pk_bf16_f32 v163, v172, v173
    v_mul_f32 v129, v255, v129
    v_mfma_f32_16x16x32_bf16 v[222:225], v[214:217], a[176:179], v[222:225]
    s_xor_b32 s28, s28, 65536
    v_cvt_pk_bf16_f32 v133, v128, v129
    v_mul_f32 v114, v255, v114
    v_mfma_f32_16x16x32_bf16 v[222:225], v[206:209], a[180:183], v[222:225]
    s_waitcnt lgkmcnt(2)
    v_rsq_f32 v250, v250
    v_mfma_f32_16x16x32_bf16 v[222:225], v[198:201], a[184:187], v[222:225]
    s_waitcnt lgkmcnt(1)
    buffer_load_dwordx4 v13, s[8:11], 0 offen nt lds
    v_mul_f32 v230, s31, v250
    v_mfma_f32_16x16x32_bf16 v[222:225], v[186:189], a[188:191], v[222:225]
    s_mov_b32 m0, s29
    v_rsq_f32 v251, v251
    v_mfma_f32_16x16x32_bf16 v[126:129], v[202:205], a[192:195], 0
    s_xor_b32 s29, s29, s30
    v_cvt_pk_f16_f32 v231, v230, v251
    v_fma_f32 v252, v252, v230, v26
    v_mfma_f32_16x16x32_bf16 v[126:129], v[194:197], a[196:199], v[126:129]
    s_add_u32 s19, s19, s20
    v_fmac_f32_dpp v254, v253, v251 quad_perm:[0,1,2,3] row_mask:0x4 bank_mask:0xf
    v_cvt_pk_bf16_f32 v210, v222, v223
    v_mfma_f32_16x16x32_bf16 v[126:129], v[214:217], a[200:203], v[126:129]
    s_add_u32 s23, s23, s21
    v_cvt_pk_bf16_f32 v211, v224, v225
    v_pk_mul_f16 v158, v158, v231 op_sel:[0,1] op_sel_hi:[1,1]
    v_mfma_f32_16x16x32_bf16 v[126:129], v[206:209], a[204:207], v[126:129]
    s_waitcnt lgkmcnt(0)
    v_pk_mul_f16 v159, v159, v231 op_sel:[0,1] op_sel_hi:[1,1]
    v_mfma_f32_16x16x32_bf16 v[126:129], v[198:201], a[208:211], v[126:129]
    s_cmp_ge_u32 s19, 72
    v_pk_mul_f16 v160, v160, v231 op_sel:[0,1] op_sel_hi:[1,1]
    v_pk_mul_f16 v161, v161, v231 op_sel:[0,1] op_sel_hi:[1,1]
    v_mfma_f32_16x16x32_bf16 v[126:129], v[186:189], a[212:215], v[126:129]
    s_cselect_b32 s34, 72, 0
    v_pk_mul_f16 v176, v176, v231 op_sel:[0,1] op_sel_hi:[1,1]
    v_pk_mul_f16 v177, v177, v231 op_sel:[0,1] op_sel_hi:[1,1]
    v_mfma_f32_16x16x32_f16 v[170:173], v[146:149], v[150:153], v[46:49]
    s_cselect_b32 s35, s22, 0
    v_pk_mul_f16 v154, v154, v231 op_sel:[0,0] op_sel_hi:[1,0]
    v_pk_mul_f16 v155, v155, v231 op_sel:[0,0] op_sel_hi:[1,0]
    v_mfma_f32_16x16x32_f16 v[186:189], v[166:169], v[150:153], v[50:53]
    s_sub_u32 s19, s19, s34
    v_cvt_pk_bf16_f32 v218, v126, v127
    v_cvt_pk_bf16_f32 v219, v128, v129
    v_mfma_f32_16x16x32_f16 v[126:129], v[158:161], v[150:153], v[54:57]
    buffer_store_dwordx4 v[130:133], v16, s[12:15], 0 offen nt
    v_pk_mul_f16 v156, v156, v231 op_sel:[0,0] op_sel_hi:[1,0]
    v_pk_mul_f16 v157, v157, v231 op_sel:[0,0] op_sel_hi:[1,0]
    v_pk_mul_f16 v174, v174, v231 op_sel:[0,0] op_sel_hi:[1,0]
    v_pk_mul_f16 v175, v175, v231 op_sel:[0,0] op_sel_hi:[1,0]
    v_mfma_f32_16x16x16_f16 v[170:173], v[120:121], v[118:119], v[170:173]
    v_max3_u32 v44, v44, v250, v251
    v_exp_f32 v254, v254
    v_mfma_f32_16x16x16_f16 v[186:189], v[124:125], v[118:119], v[186:189]
    v_cvt_pk_bf16_f32 v254, v254, v254
    v_exp_f32 v252, v252
    v_mfma_f32_16x16x16_f16 v[126:129], v[176:177], v[118:119], v[126:129]
    v_mul_f32 v115, v255, v115
    v_cvt_pk_bf16_f32 v118, v114, v115
    v_exp_f32 v170, v170
    v_mfma_f32_16x16x32_f16 v[130:133], v[146:149], v[178:181], v[58:61]
    s_add_u32 s23, s23, s35
    ds_write_b16 v8, v254
    v_mfma_f32_16x16x32_f16 v[150:153], v[166:169], v[178:181], v[62:65]
    s_add_u32 s78, s78, s69
    v_exp_f32 v171, v171
    v_mfma_f32_16x16x32_f16 v[190:193], v[158:161], v[178:181], v[66:69]
    s_add_u32 s80, s77, s68
    v_cvt_pk_bf16_f32 v170, v170, v171
    v_exp_f32 v172, v172
    v_mfma_f32_16x16x16_f16 v[130:133], v[120:121], v[122:123], v[130:133]
    v_exp_f32 v173, v173
    v_mul_f32 v116, v255, v116
    v_mfma_f32_16x16x16_f16 v[150:153], v[124:125], v[122:123], v[150:153]
    v_cvt_pk_bf16_f32 v171, v172, v173
    v_exp_f32 v186, v186
    v_mfma_f32_16x16x16_f16 v[190:193], v[176:177], v[122:123], v[190:193]
    v_exp_f32 v187, v187
    v_exp_f32 v188, v188
    v_mfma_f32_16x16x32_bf16 v[178:181], a[216:219], v[182:185], 0
    s_cmp_ge_u32 s80, 72
    v_exp_f32 v130, v130
    v_mfma_f32_16x16x32_bf16 v[178:181], a[220:223], v[226:229], v[178:181]
    s_cselect_b32 s80, s22, 0
    v_exp_f32 v131, v131
    v_mfma_f32_16x16x32_bf16 v[178:181], a[224:227], v[234:237], v[178:181]
    s_add_u32 s78, s78, s80
    v_cvt_pk_bf16_f32 v194, v130, v131
    v_cvt_pk_bf16_f32 v172, v186, v187
    v_mfma_f32_16x16x32_bf16 v[178:181], a[228:231], v[238:241], v[178:181]
    s_add_u32 s80, s77, 20
    v_exp_f32 v132, v132
    v_mfma_f32_16x16x32_bf16 v[178:181], a[232:235], v[242:245], v[178:181]
    s_add_u32 s34, s18, 3
    v_exp_f32 v133, v133
    v_mfma_f32_16x16x32_bf16 v[178:181], a[236:239], v[246:249], v[178:181]
    s_cmp_lt_u32 s77, s62
    v_cvt_pk_bf16_f32 v195, v132, v133
    v_mul_f32 v117, v255, v117
    v_mfma_f32_16x16x32_bf16 v[198:201], a[240:243], v[182:185], 0
    s_cselect_b32 s79, 1, 0
    v_exp_f32 v150, v150
    v_mfma_f32_16x16x32_f16 v[202:205], v[146:149], v[154:157], v[70:73]
    s_cselect_b32 s78, s78, 0
    v_exp_f32 v151, v151
    v_mfma_f32_16x16x32_f16 v[146:149], v[166:169], v[154:157], v[74:77]
    s_cmp_lt_u32 s34, s17
    v_cvt_pk_bf16_f32 v196, v150, v151
    v_cvt_pk_bf16_f32 v119, v116, v117
    v_mfma_f32_16x16x32_f16 v[166:169], v[158:161], v[154:157], v[78:81]
    buffer_store_dwordx2 v[118:119], v19, s[12:15], 0 offen nt
    v_exp_f32 v152, v152
    v_mfma_f32_16x16x16_f16 v[202:205], v[120:121], v[174:175], v[202:205]
    v_exp_f32 v153, v153
    v_fma_f32 v254, v178, v178, s33
    v_mfma_f32_16x16x16_f16 v[146:149], v[124:125], v[174:175], v[146:149]
    v_cvt_pk_bf16_f32 v197, v152, v153
    v_exp_f32 v190, v190
    v_mfma_f32_16x16x16_f16 v[166:169], v[176:177], v[174:175], v[166:169]
    v_exp_f32 v191, v191
    v_exp_f32 v192, v192
    v_mfma_f32_16x16x32_bf16 v[198:201], a[244:247], v[226:229], v[198:201]
    s_cselect_b32 s23, s23, s78
    v_exp_f32 v193, v193
    v_mfma_f32_16x16x32_bf16 v[198:201], a[248:251], v[234:237], v[198:201]
    s_cselect_b32 s73, s34, s80
    ds_read_b128 v[118:121], v2 offset:6144
    v_fmac_f32 v254, v179, v179
    v_mfma_f32_16x16x32_bf16 v[198:201], a[252:255], v[238:241], v[198:201]
    s_cselect_b32 s79, 0, s79
    ds_read_b128 v[122:125], v2 offset:7168
    v_fmac_f32 v254, v180, v180
    v_mfma_f32_16x16x32_bf16 v[198:201], v[82:85], v[242:245], v[198:201]
    s_cselect_b32 s81, 0, 1
    ds_read_b128 v[150:153], v2 offset:8192
    v_fmac_f32 v254, v181, v181
    v_mfma_f32_16x16x32_bf16 v[198:201], v[86:89], v[246:249], v[198:201]
    s_add_u32 s80, s77, 1
    ds_read_b128 v[154:157], v2 offset:9216
    v_xor_b32 v0, 65536, v0
    v_mfma_f32_16x16x32_bf16 v[206:209], v[90:93], v[182:185], 0
    s_mul_i32 s80, s80, s81
    ds_read_b128 v[158:161], v2 offset:10240
    v_xor_b32 v1, 65536, v1
    v_mfma_f32_16x16x32_bf16 v[206:209], v[94:97], v[226:229], v[206:209]
    s_cmp_lt_u32 s80, s62
    ds_read_b128 v[174:177], v2 offset:11264
    v_fmac_f32 v254, v198, v198
    v_mfma_f32_16x16x32_bf16 v[206:209], v[98:101], v[234:237], v[206:209]
    s_cselect_b32 s62, s62, 0
    v_exp_f32 v189, v189
    v_mfma_f32_16x16x32_bf16 v[206:209], v[102:105], v[238:241], v[206:209]
    s_add_u32 s80, s18, 4
    v_cvt_pk_bf16_f32 v173, v188, v189
    v_fmac_f32 v254, v199, v199
    v_mfma_f32_16x16x32_bf16 v[206:209], v[106:109], v[242:245], v[206:209]
    s_waitcnt lgkmcnt(5)
    v_exp_f32 v126, v126
    v_mfma_f32_16x16x32_bf16 v[206:209], v[110:113], v[246:249], v[206:209]
    s_cmp_ge_u32 s80, s17
    v_exp_f32 v127, v127
    v_mfma_f32_16x16x32_bf16 v[130:133], a[216:219], v[118:121], 0
    s_waitcnt lgkmcnt(3)
    v_cvt_pk_bf16_f32 v36, v126, v127
    v_fmac_f32 v254, v200, v200
    v_mfma_f32_16x16x32_bf16 v[130:133], a[220:223], v[122:125], v[130:133]
    s_cselect_b32 s66, s62, 0
    v_exp_f32 v128, v128
    v_mfma_f32_16x16x32_bf16 v[130:133], a[224:227], v[150:153], v[130:133]
    s_waitcnt lgkmcnt(1)
    v_fmac_f32 v254, v201, v201
    v_mfma_f32_16x16x32_bf16 v[130:133], a[228:231], v[154:157], v[130:133]
    s_lshl_b32 s80, s79, s73
    v_exp_f32 v129, v129
    v_mfma_f32_16x16x32_bf16 v[130:133], a[232:235], v[158:161], v[130:133]
    s_waitcnt lgkmcnt(0)
    v_cvt_pk_bf16_f32 v37, v128, v129
    v_fmac_f32 v254, v206, v206
    v_mfma_f32_16x16x32_bf16 v[130:133], a[236:239], v[174:177], v[130:133]
    s_or_b32 s70, s70, s80
    v_exp_f32 v202, v202
    v_mfma_f32_16x16x32_bf16 v[182:185], v[28:31], v[36:39], 0
    s_add_u32 s45, s45, s79
    v_exp_f32 v203, v203
    v_mfma_f32_16x16x32_bf16 v[182:185], v[28:31], v[170:173], v[182:185]
    s_add_u32 s18, s18, 1
    v_cvt_pk_bf16_f32 v186, v202, v203
    v_fma_f32 v255, v130, v130, s33
    v_mfma_f32_16x16x32_bf16 v[214:217], v[162:165], v[36:39], 0
    s_cmp_lt_u32 s18, s45
    v_fmac_f32 v255, v131, v131
    v_fmac_f32 v255, v132, v132
    v_mfma_f32_16x16x32_bf16 v[214:217], v[134:137], v[170:173], v[214:217]
    v_fmac_f32 v255, v133, v133
    v_fmac_f32 v254, v207, v207
    v_mfma_f32_16x16x32_bf16 v[222:225], v[210:213], v[36:39], 0
    v_exp_f32 v204, v204
    v_mfma_f32_16x16x32_bf16 v[222:225], v[138:141], v[170:173], v[222:225]
    v_exp_f32 v205, v205
    v_mfma_f32_16x16x32_bf16 v[226:229], v[218:221], v[36:39], 0
    v_cvt_pk_bf16_f32 v36, v190, v191
    v_cvt_pk_bf16_f32 v37, v192, v193
    v_mfma_f32_16x16x32_bf16 v[226:229], v[142:145], v[170:173], v[226:229]
    v_cvt_pk_bf16_f32 v39, v232, 0
    v_cvt_pk_bf16_f32 v187, v204, v205
    v_mfma_f32_16x16x32_bf16 v[126:129], a[240:243], v[118:121], 0
    v_exp_f32 v146, v146
    v_mfma_f32_16x16x32_bf16 v[170:173], v[28:31], v[36:39], 0
    v_exp_f32 v147, v147
    v_mfma_f32_16x16x32_bf16 v[170:173], v[28:31], v[194:197], v[170:173]
    v_cvt_pk_bf16_f32 v188, v146, v147
    v_fmac_f32 v254, v208, v208
    v_mfma_f32_16x16x32_bf16 v[114:117], v[162:165], v[36:39], 0
    v_exp_f32 v148, v148
    v_mfma_f32_16x16x32_bf16 v[114:117], v[134:137], v[194:197], v[114:117]
    v_exp_f32 v149, v149
    v_mfma_f32_16x16x32_bf16 v[190:193], v[210:213], v[36:39], 0
    v_cvt_pk_bf16_f32 v189, v148, v149
    v_fmac_f32 v254, v209, v209
    v_mfma_f32_16x16x32_bf16 v[190:193], v[138:141], v[194:197], v[190:193]
    v_rcp_f32 v171, v170
    v_mfma_f32_16x16x32_bf16 v[146:149], v[218:221], v[36:39], 0
    v_exp_f32 v166, v166
    v_mfma_f32_16x16x32_bf16 v[146:149], v[142:145], v[194:197], v[146:149]
    v_mul_f32 v114, v171, v114
    v_mul_f32 v115, v171, v115
    v_mfma_f32_16x16x32_bf16 v[126:129], a[244:247], v[122:125], v[126:129]
    v_cvt_pk_bf16_f32 v194, v114, v115
    v_mul_f32 v116, v171, v116
    v_mfma_f32_16x16x32_bf16 v[126:129], a[248:251], v[150:153], v[126:129]
    ds_read_b128 v[202:205], v2 offset:12288
    v_mul_f32 v117, v171, v117
    v_mfma_f32_16x16x32_bf16 v[126:129], a[252:255], v[154:157], v[126:129]
    ds_read_b128 v[230:233], v2 offset:13312
    v_cvt_pk_bf16_f32 v195, v116, v117
    v_mfma_f32_16x16x32_bf16 v[126:129], v[82:85], v[158:161], v[126:129]
    ds_read_b128 v[234:237], v2 offset:14336
    v_mul_f32 v190, v171, v190
    v_mfma_f32_16x16x32_bf16 v[126:129], v[86:89], v[174:177], v[126:129]
    ds_read_b128 v[238:241], v2 offset:15360
    v_mul_f32 v191, v171, v191
    v_mfma_f32_16x16x32_bf16 v[114:117], v[90:93], v[118:121], 0
    ds_read_b128 v[118:121], v2 offset:16384
    v_cvt_pk_bf16_f32 v196, v190, v191
    v_mfma_f32_16x16x32_bf16 v[114:117], v[94:97], v[122:125], v[114:117]
    ds_read_b128 v[122:125], v2 offset:17408
    v_mul_f32 v192, v171, v192
    v_mfma_f32_16x16x32_bf16 v[114:117], v[98:101], v[150:153], v[114:117]
    v_fmac_f32 v255, v126, v126
    v_fmac_f32 v255, v127, v127
    v_mfma_f32_16x16x32_bf16 v[114:117], v[102:105], v[154:157], v[114:117]
    v_fmac_f32 v255, v128, v128
    v_fmac_f32 v255, v129, v129
    v_mfma_f32_16x16x32_bf16 v[114:117], v[106:109], v[158:161], v[114:117]
    s_waitcnt lgkmcnt(5)
    v_mul_f32 v193, v171, v193
    v_cvt_pk_bf16_f32 v197, v192, v193
    v_mfma_f32_16x16x32_bf16 v[114:117], v[110:113], v[174:177], v[114:117]
    s_waitcnt lgkmcnt(4)
    ds_write_b128 v3, v[194:197] offset:6144
    v_mfma_f32_16x16x32_bf16 v[242:245], a[216:219], v[202:205], 0
    s_waitcnt lgkmcnt(3)
    v_mul_f32 v146, v171, v146
    v_mul_f32 v147, v171, v147
    v_mfma_f32_16x16x32_bf16 v[242:245], a[220:223], v[230:233], v[242:245]
    s_waitcnt lgkmcnt(2)
    v_fmac_f32 v255, v114, v114
    v_fmac_f32 v255, v115, v115
    v_mfma_f32_16x16x32_bf16 v[242:245], a[224:227], v[234:237], v[242:245]
    s_waitcnt lgkmcnt(1)
    v_fmac_f32 v255, v116, v116
    v_fmac_f32 v255, v117, v117
    v_mfma_f32_16x16x32_bf16 v[242:245], a[228:231], v[238:241], v[242:245]
    v_cvt_pk_bf16_f32 v254, v254, v255
    v_cvt_pk_bf16_f32 v172, v146, v147
    v_mfma_f32_16x16x32_bf16 v[242:245], a[232:235], v[118:121], v[242:245]
    v_mul_f32 v148, v171, v148
    v_mul_f32 v149, v171, v149
    v_mfma_f32_16x16x32_bf16 v[242:245], a[236:239], v[122:125], v[242:245]
    v_cvt_pk_bf16_f32 v173, v148, v149
    v_cvt_pk_bf16_f32 v39, v252, 0
    v_mfma_f32_16x16x32_bf16 v[158:161], a[240:243], v[202:205], 0
    ds_write_b64 v4, v[172:173] offset:10240
    v_mfma_f32_16x16x32_bf16 v[158:161], a[244:247], v[230:233], v[158:161]
    v_exp_f32 v167, v167
    v_mfma_f32_16x16x32_bf16 v[158:161], a[248:251], v[234:237], v[158:161]
    v_cvt_pk_bf16_f32 v36, v166, v167
    v_fma_f32 v255, v242, v242, s33
    v_mfma_f32_16x16x32_bf16 v[158:161], a[252:255], v[238:241], v[158:161]
    v_fmac_f32 v255, v243, v243
    v_fmac_f32 v255, v244, v244
    v_mfma_f32_16x16x32_bf16 v[158:161], v[82:85], v[118:121], v[158:161]
    v_fmac_f32 v255, v245, v245
    v_xor_b32 v2, 65536, v2
    v_mfma_f32_16x16x32_bf16 v[158:161], v[86:89], v[122:125], v[158:161]
    v_exp_f32 v168, v168
    v_mfma_f32_16x16x32_bf16 v[154:157], v[90:93], v[202:205], 0
    v_exp_f32 v169, v169
    v_mfma_f32_16x16x32_bf16 v[154:157], v[94:97], v[230:233], v[154:157]
    ds_read_b128 v[146:149], v9
    v_cvt_pk_bf16_f32 v37, v168, v169
    v_mfma_f32_16x16x32_bf16 v[154:157], v[98:101], v[234:237], v[154:157]
    ds_read_b128 v[150:153], v9 offset:64
    v_fmac_f32 v255, v158, v158
    v_mfma_f32_16x16x32_bf16 v[166:169], v[28:31], v[36:39], 0
    v_fmac_f32 v255, v159, v159
    v_fmac_f32 v255, v160, v160
    v_mfma_f32_16x16x32_bf16 v[166:169], v[28:31], v[186:189], v[166:169]
    v_fmac_f32 v255, v161, v161
    v_add_u32 v6, s75, v6
    v_mfma_f32_16x16x32_bf16 v[174:177], v[162:165], v[36:39], 0
    v_rcp_f32 v183, v182
    v_mfma_f32_16x16x32_bf16 v[174:177], v[134:137], v[186:189], v[174:177]
    v_max3_u32 v25, v25, v183, v182
    v_max3_u32 v25, v25, v171, v170
    v_mfma_f32_16x16x32_bf16 v[170:173], v[210:213], v[36:39], 0
    v_rcp_f32 v167, v166
    v_mfma_f32_16x16x32_bf16 v[170:173], v[138:141], v[186:189], v[170:173]
    v_max3_u32 v25, v25, v167, v166
    v_mul_f32 v214, v183, v214
    v_mfma_f32_16x16x32_bf16 v[190:193], v[218:221], v[36:39], 0
    s_waitcnt lgkmcnt(1)
    v_mul_f32 v174, v167, v174
    v_mul_f32 v175, v167, v175
    v_mfma_f32_16x16x32_bf16 v[190:193], v[142:145], v[186:189], v[190:193]
    s_waitcnt lgkmcnt(0)
    v_cvt_pk_bf16_f32 v174, v174, v175
    v_mul_f32 v176, v167, v176
    v_mfma_f32_16x16x32_bf16 v[154:157], v[102:105], v[238:241], v[154:157]
    ds_read_b128 v[186:189], v0 offset:20480
    v_mul_f32 v177, v167, v177
    v_mfma_f32_16x16x32_bf16 v[154:157], v[106:109], v[118:121], v[154:157]
    ds_read_b128 v[194:197], v1 offset:20480
    v_cvt_pk_bf16_f32 v175, v176, v177
    v_mfma_f32_16x16x32_bf16 v[154:157], v[110:113], v[122:125], v[154:157]
    ds_read_b128 v[122:125], v0 offset:20608
    v_mul_f32 v170, v167, v170
    v_mfma_f32_16x16x32_bf16 v[118:121], v[146:149], v[28:31], 0
    ds_read_b128 v[202:205], v1 offset:20608
    v_mul_f32 v171, v167, v171
    v_mfma_f32_16x16x32_bf16 v[118:121], v[150:153], v[28:31], v[118:121]
    ds_read_b128 v[230:233], v0 offset:20736
    v_cvt_pk_bf16_f32 v176, v170, v171
    v_mfma_f32_16x16x32_bf16 v[234:237], v[146:149], v[134:137], 0
    ds_read_b128 v[238:241], v1 offset:20736
    v_fmac_f32 v255, v154, v154
    v_mfma_f32_16x16x32_bf16 v[234:237], v[150:153], v[162:165], v[234:237]
    v_fmac_f32 v255, v155, v155
    v_fmac_f32 v255, v156, v156
    v_mfma_f32_16x16x32_bf16 v[134:137], v[146:149], v[138:141], 0
    v_fmac_f32 v255, v157, v157
    v_cvt_pk_bf16_f32 v255, v255, v255
    v_mfma_f32_16x16x32_bf16 v[134:137], v[150:153], v[210:213], v[134:137]
    s_waitcnt lgkmcnt(5)
    ds_write_b64 v4, v[254:255] offset:18432
    v_mfma_f32_16x16x32_bf16 v[138:141], v[146:149], v[142:145], 0
    s_waitcnt lgkmcnt(4)
    v_mul_f32 v172, v167, v172
    v_mul_f32 v173, v167, v173
    v_mfma_f32_16x16x32_bf16 v[138:141], v[150:153], v[218:221], v[138:141]
    s_waitcnt lgkmcnt(3)
    v_cvt_pk_bf16_f32 v177, v172, v173
    v_mul_f32 v190, v167, v190
    v_mfma_f32_16x16x32_bf16 v[142:145], a[72:75], v[186:189], 0
    s_waitcnt lgkmcnt(2)
    ds_write_b128 v3, v[174:177] offset:12288
    v_mfma_f32_16x16x32_bf16 v[142:145], a[76:79], v[194:197], v[142:145]
    s_waitcnt lgkmcnt(2)
    v_mul_f32 v191, v167, v191
    v_cvt_pk_bf16_f32 v254, v190, v191
    v_mfma_f32_16x16x32_bf16 v[142:145], a[80:83], v[122:125], v[142:145]
    v_mul_f32 v192, v167, v192
    v_mul_f32 v193, v167, v193
    v_mfma_f32_16x16x32_bf16 v[142:145], a[84:87], v[202:205], v[142:145]
    v_cvt_pk_bf16_f32 v255, v192, v193
    v_mul_f32 v215, v183, v215
    v_mfma_f32_16x16x32_bf16 v[142:145], a[88:91], v[230:233], v[142:145]
    ds_write_b64 v4, v[254:255] offset:16384
    v_mfma_f32_16x16x32_bf16 v[142:145], a[92:95], v[238:241], v[142:145]
    v_rcp_f32_dpp v119, v118 quad_perm:[0,0,0,0] row_mask:0xf bank_mask:0xf
    v_mfma_f32_16x16x32_bf16 v[150:153], a[96:99], v[186:189], 0
    v_max3_u32 v25, v25, v118, v119
    v_mul_f32 v234, v234, v119
    v_mfma_f32_16x16x32_bf16 v[150:153], a[100:103], v[194:197], v[150:153]
    v_cvt_pk_bf16_f32 v118, v214, v215
    v_mul_f32_dpp v234, v134, v119 quad_perm:[0,1,2,3] row_mask:0x2 bank_mask:0xf
    v_mfma_f32_16x16x32_bf16 v[150:153], a[104:107], v[122:125], v[150:153]
    v_mul_f32 v216, v183, v216
    v_mul_f32_dpp v234, v138, v119 quad_perm:[0,1,2,3] row_mask:0x4 bank_mask:0xf
    v_mfma_f32_16x16x32_bf16 v[150:153], a[108:111], v[202:205], v[150:153]
    v_cvt_pk_bf16_f32 v234, v234, v234
    v_mul_f32 v217, v183, v217
    v_mfma_f32_16x16x32_bf16 v[150:153], a[112:115], v[230:233], v[150:153]
    ds_write_b16 v7, v234
    v_mfma_f32_16x16x32_bf16 v[150:153], a[116:119], v[238:241], v[150:153]
    v_cvt_pk_bf16_f32 v119, v216, v217
    v_mul_f32 v222, v183, v222
    v_mfma_f32_16x16x32_bf16 v[134:137], a[120:123], v[186:189], 0
    v_mul_f32 v223, v183, v223
    v_cvt_pk_bf16_f32 v120, v222, v223
    v_mfma_f32_16x16x32_bf16 v[134:137], a[124:127], v[194:197], v[134:137]
    v_mul_f32 v224, v183, v224
    v_mul_f32 v225, v183, v225
    v_mfma_f32_16x16x32_bf16 v[134:137], a[128:131], v[122:125], v[134:137]
    v_cvt_pk_bf16_f32 v121, v224, v225
    v_mul_f32 v226, v183, v226
    v_mfma_f32_16x16x32_bf16 v[134:137], a[132:135], v[202:205], v[134:137]
    ds_write_b128 v3, v[118:121] offset:0
    v_mfma_f32_16x16x32_bf16 v[134:137], a[136:139], v[230:233], v[134:137]
    v_mul_f32 v227, v183, v227
    v_cvt_pk_bf16_f32 v254, v226, v227
    v_mfma_f32_16x16x32_bf16 v[134:137], a[140:143], v[238:241], v[134:137]
    v_mul_f32 v228, v183, v228
    v_mul_f32 v229, v183, v229
    v_mfma_f32_16x16x32_bf16 v[138:141], a[0:3], v[186:189], 0
    v_cvt_pk_bf16_f32 v255, v228, v229
    v_xor_b32 v3, 65536, v3
    v_mfma_f32_16x16x32_bf16 v[138:141], a[4:7], v[194:197], v[138:141]
    ds_write_b64 v4, v[254:255] offset:4096
    v_mfma_f32_16x16x32_bf16 v[138:141], a[8:11], v[122:125], v[138:141]
    v_xor_b32 v4, 65536, v4
    v_add_u32 v7, s76, v7
    v_mfma_f32_16x16x32_bf16 v[138:141], a[12:15], v[202:205], v[138:141]
    v_cvt_pk_f16_f32 v146, v142, v143
    v_pk_mul_f16 v143, v146, v146
    v_mfma_f32_16x16x32_bf16 v[138:141], a[16:19], v[230:233], v[138:141]
    v_cvt_pk_f16_f32 v147, v144, v145
    v_pk_fma_f16 v143, v147, v147, v143
    v_mfma_f32_16x16x32_bf16 v[138:141], a[20:23], v[238:241], v[138:141]
    v_cvt_pk_f16_f32 v148, v150, v151
    v_pk_fma_f16 v143, v148, v148, v143
    v_mfma_f32_16x16x32_bf16 v[166:169], a[24:27], v[186:189], 0
    v_cvt_pk_f16_f32 v149, v152, v153
    v_pk_fma_f16 v143, v149, v149, v143
    v_mfma_f32_16x16x32_bf16 v[166:169], a[28:31], v[194:197], v[166:169]
    v_cvt_pk_f16_f32 v120, v134, v135
    v_pk_fma_f16 v143, v120, v120, v143
    v_mfma_f32_16x16x32_bf16 v[166:169], a[32:35], v[122:125], v[166:169]
    s_waitcnt lgkmcnt(0)
    v_cvt_pk_f16_f32 v121, v136, v137
    v_pk_fma_f16 v143, v121, v121, v143
    v_mfma_f32_16x16x32_bf16 v[166:169], a[36:39], v[202:205], v[166:169]
    s_nop 0
    v_mfma_f32_16x16x32_bf16 v[166:169], a[40:43], v[230:233], v[166:169]
    s_nop 0
    v_mfma_f32_16x16x32_bf16 v[166:169], a[44:47], v[238:241], v[166:169]
    s_barrier
    v_mfma_f32_16x16x32_bf16 v[134:137], a[48:51], v[186:189], 0
    s_nop 0
    v_mfma_f32_16x16x32_bf16 v[134:137], a[52:55], v[194:197], v[134:137]
    s_cbranch_scc1 L_loop_fast2
    s_branch L_final_fast
.p2align 6
L_loop_fast3:
    v_mfma_f32_16x16x32_bf16 v[134:137], a[56:59], v[122:125], v[134:137]
    s_add_u32 s12, s40, s27
    ds_read_b128 v[190:193], v2 offset:18432
    v_cvt_pk_f16_f32 v150, v138, v139
    v_mfma_f32_16x16x32_bf16 v[134:137], a[60:63], v[202:205], v[134:137]
    s_addc_u32 s13, s41, 0
    ds_read_b128 v[210:213], v2 offset:19456
    v_pk_mul_f16 v142, v150, v150
    v_mfma_f32_16x16x32_bf16 v[134:137], a[64:67], v[230:233], v[134:137]
    s_sub_u32 s14, s36, s27
    ds_read_b128 v[174:177], v5 offset:32
    v_cvt_pk_f16_f32 v151, v140, v141
    v_mfma_f32_16x16x32_bf16 v[134:137], a[68:71], v[238:241], v[134:137]
    s_cmp_ge_u32 s18, 2
    ds_read2_b64 v[162:165], v5 offset0:6 offset1:9
    v_pk_fma_f16 v142, v151, v151, v142
    v_mfma_f32_16x16x32_bf16 v[138:141], v[186:189], a[144:147], 0
    s_cselect_b32 s14, s14, 0
    ds_read_b128 v[170:173], v5
    v_cvt_pk_f16_f32 v152, v166, v167
    v_mfma_f32_16x16x32_bf16 v[138:141], v[194:197], a[148:151], v[138:141]
    s_sub_u32 s82, s72, s71
    ds_read_b32 v254, v6 offset:192
    v_pk_fma_f16 v142, v152, v152, v142
    v_mfma_f32_16x16x32_bf16 v[138:141], v[122:125], a[152:155], v[138:141]
    s_mul_i32 s74, s82, 336
    v_cvt_pk_f16_f32 v153, v168, v169
    v_pk_fma_f16 v142, v153, v153, v142
    v_mfma_f32_16x16x32_bf16 v[138:141], v[202:205], a[156:159], v[138:141]
    s_mul_i32 s75, s82, 272
    v_cvt_pk_f16_f32 v118, v134, v135
    v_pk_fma_f16 v142, v118, v118, v142
    v_mfma_f32_16x16x32_bf16 v[138:141], v[230:233], a[160:163], v[138:141]
    s_waitcnt lgkmcnt(5)
    ds_read_b128 v[182:185], v0 offset:26624
    v_cvt_pk_f16_f32 v119, v136, v137
    v_mfma_f32_16x16x32_bf16 v[166:169], v[32:35], v[190:193], 0
    s_waitcnt lgkmcnt(5)
    v_pk_fma_f16 v142, v119, v119, v142
    v_add_u32 v5, s74, v5
    v_mfma_f32_16x16x32_bf16 v[166:169], v[32:35], v[210:213], v[166:169]
    s_waitcnt lgkmcnt(4)
    v_pk_mul_f16 v145, v146, v174
    v_pk_fma_f16 v145, v147, v175, v145
    v_mfma_f32_16x16x32_bf16 v[138:141], v[238:241], a[164:167], v[138:141]
    s_mul_i32 s76, s82, 16
    ds_read_b128 v[210:213], v1 offset:26624
    v_pk_fma_f16 v145, v148, v176, v145
    v_mfma_f32_16x16x32_bf16 v[214:217], v[186:189], a[168:171], 0
    s_waitcnt lgkmcnt(3)
    ds_read_b128 v[218:221], v0 offset:26752
    v_pk_fma_f16 v145, v149, v177, v145
    v_mfma_f32_16x16x32_bf16 v[214:217], v[194:197], a[172:175], v[214:217]
    s_waitcnt lgkmcnt(3)
    ds_read_b128 v[222:225], v1 offset:26752
    v_mov_b32_dpp v254, v23 quad_perm:[0,1,2,3] row_mask:0x7 bank_mask:0xf
    v_mfma_f32_16x16x32_bf16 v[214:217], v[122:125], a[176:179], v[214:217]
    s_add_u32 s34, s18, 2
    ds_read_b128 v[226:229], v0 offset:26880
    v_pk_fma_f16 v145, v120, v164, v145
    v_mfma_f32_16x16x32_bf16 v[214:217], v[202:205], a[180:183], v[214:217]
    s_add_u32 s8, s60, s23
    ds_read_b128 v[190:193], v1 offset:26880
    v_pk_fma_f16 v145, v121, v165, v145
    v_mfma_f32_16x16x32_bf16 v[214:217], v[230:233], a[184:187], v[214:217]
    s_waitcnt lgkmcnt(5)
    v_pk_mul_f16 v144, v150, v170
    v_pk_fma_f16 v144, v151, v171, v144
    v_mfma_f32_16x16x32_bf16 v[214:217], v[238:241], a[188:191], v[214:217]
    s_addc_u32 s9, s61, 0
    v_pk_fma_f16 v144, v152, v172, v144
    v_pk_fma_f16 v144, v153, v173, v144
    v_mfma_f32_16x16x32_bf16 v[246:249], v[186:189], a[192:195], 0
    s_sub_u32 s10, s36, s23
    v_pk_fma_f16 v144, v118, v162, v144
    v_pk_fma_f16 v144, v119, v163, v144
    v_mfma_f32_16x16x32_bf16 v[246:249], v[194:197], a[196:199], v[246:249]
    s_cmp_le_u32 s34, s45
    v_cvt_pk_bf16_f32 v134, v138, v139
    v_cvt_pk_bf16_f32 v135, v140, v141
    v_mfma_f32_16x16x32_f16 v[234:237], v[40:43], v[142:145], 0
    s_cselect_b32 s10, s10, 0
    v_cvt_pk_bf16_f32 v138, v214, v215
    v_cvt_pk_bf16_f32 v139, v216, v217
    v_mfma_f32_16x16x32_bf16 v[246:249], v[122:125], a[200:203], v[246:249]
    s_add_u32 m0, s28, 0
    v_mul_f32 v136, 0x3baaaaab, v166
    v_mul_f32 v255, 0x3baaaaab, v167
    v_mfma_f32_16x16x32_bf16 v[246:249], v[202:205], a[204:207], v[246:249]
    s_mov_b32 s27, s26
    v_rsq_f32 v234, v234
    v_mfma_f32_16x16x32_bf16 v[246:249], v[230:233], a[208:211], v[246:249]
    s_mov_b32 s26, s25
    v_rsq_f32 v235, v235
    v_mfma_f32_16x16x32_bf16 v[246:249], v[238:241], a[212:215], v[246:249]
    s_mov_b32 s25, s24
    v_mul_f32 v140, s31, v234
    v_cvt_pk_f16_f32 v141, v140, v235
    v_mfma_f32_16x16x32_bf16 v[122:125], a[72:75], v[182:185], 0
    s_waitcnt lgkmcnt(0)
    v_fma_f32 v236, v236, v140, v22
    v_fmac_f32_dpp v254, v237, v235 quad_perm:[0,1,2,3] row_mask:0x1 bank_mask:0xf
    v_mfma_f32_16x16x32_bf16 v[122:125], a[76:79], v[210:213], v[122:125]
    s_mov_b32 s24, s23
    v_cvt_pk_bf16_f32 v142, v246, v247
    v_cvt_pk_bf16_f32 v143, v248, v249
    v_mfma_f32_16x16x32_bf16 v[122:125], a[80:83], v[218:221], v[122:125]
    s_mov_b32 s71, s72
    v_pk_mul_f16 v146, v146, v141 op_sel:[0,1] op_sel_hi:[1,1]
    v_pk_mul_f16 v147, v147, v141 op_sel:[0,1] op_sel_hi:[1,1]
    v_mfma_f32_16x16x32_bf16 v[122:125], a[84:87], v[222:225], v[122:125]
    s_mov_b32 s72, s73
    v_pk_mul_f16 v148, v148, v141 op_sel:[0,1] op_sel_hi:[1,1]
    v_pk_mul_f16 v149, v149, v141 op_sel:[0,1] op_sel_hi:[1,1]
    v_mfma_f32_16x16x32_bf16 v[122:125], a[88:91], v[226:229], v[122:125]
    v_pk_mul_f16 v120, v120, v141 op_sel:[0,1] op_sel_hi:[1,1]
    v_pk_mul_f16 v121, v121, v141 op_sel:[0,1] op_sel_hi:[1,1]
    v_mfma_f32_16x16x32_bf16 v[122:125], a[92:95], v[190:193], v[122:125]
    v_pk_mul_f16 v150, v150, v141 op_sel:[0,0] op_sel_hi:[1,0]
    v_pk_mul_f16 v151, v151, v141 op_sel:[0,0] op_sel_hi:[1,0]
    v_mfma_f32_16x16x32_bf16 v[186:189], a[96:99], v[182:185], 0
    v_pk_mul_f16 v152, v152, v141 op_sel:[0,0] op_sel_hi:[1,0]
    v_pk_mul_f16 v153, v153, v141 op_sel:[0,0] op_sel_hi:[1,0]
    v_mfma_f32_16x16x32_bf16 v[186:189], a[100:103], v[210:213], v[186:189]
    v_pk_mul_f16 v118, v118, v141 op_sel:[0,0] op_sel_hi:[1,0]
    v_pk_mul_f16 v119, v119, v141 op_sel:[0,0] op_sel_hi:[1,0]
    v_mfma_f32_16x16x32_bf16 v[186:189], a[104:107], v[218:221], v[186:189]
    v_max3_u32 v44, v44, v234, v235
    v_mul_f32 v144, 0x3baaaaab, v168
    v_mfma_f32_16x16x32_bf16 v[186:189], a[108:111], v[222:225], v[186:189]
    v_rsq_f32 v136, v136
    v_mfma_f32_16x16x32_bf16 v[186:189], a[112:115], v[226:229], v[186:189]
    v_rsq_f32 v255, v255
    v_mfma_f32_16x16x32_bf16 v[186:189], a[116:119], v[190:193], v[186:189]
    v_rsq_f32 v144, v144
    v_mfma_f32_16x16x32_bf16 v[194:197], a[120:123], v[182:185], 0
    v_mul_f32 v178, v136, v178
    v_mul_f32 v179, v136, v179
    v_mfma_f32_16x16x32_bf16 v[194:197], a[124:127], v[210:213], v[194:197]
    v_cvt_pk_bf16_f32 v166, v178, v179
    v_mul_f32 v180, v136, v180
    v_mfma_f32_16x16x32_bf16 v[194:197], a[128:131], v[218:221], v[194:197]
    v_mul_f32 v181, v136, v181
    v_cvt_pk_bf16_f32 v167, v180, v181
    v_mfma_f32_16x16x32_bf16 v[194:197], a[132:135], v[222:225], v[194:197]
    v_mul_f32 v198, v136, v198
    v_mul_f32 v199, v136, v199
    v_mfma_f32_16x16x32_bf16 v[194:197], a[136:139], v[226:229], v[194:197]
    v_cvt_pk_bf16_f32 v168, v198, v199
    v_mul_f32 v200, v136, v200
    v_mfma_f32_16x16x32_bf16 v[194:197], a[140:143], v[190:193], v[194:197]
    v_mul_f32 v201, v136, v201
    v_cvt_pk_bf16_f32 v169, v200, v201
    v_mfma_f32_16x16x32_bf16 v[178:181], a[0:3], v[182:185], 0
    buffer_store_dwordx4 v[166:169], v15, s[12:15], 0 offen nt
    v_mul_f32 v206, v136, v206
    v_mul_f32 v207, v136, v207
    v_cvt_pk_bf16_f32 v140, v206, v207
    v_mul_f32 v208, v136, v208
    v_mfma_f32_16x16x32_bf16 v[178:181], a[4:7], v[210:213], v[178:181]
    v_mul_f32 v209, v136, v209
    v_cvt_pk_bf16_f32 v141, v208, v209
    v_mfma_f32_16x16x32_bf16 v[178:181], a[8:11], v[218:221], v[178:181]
    v_cvt_pk_f16_f32 v166, v122, v123
    v_pk_mul_f16 v199, v166, v166
    v_mfma_f32_16x16x32_bf16 v[178:181], a[12:15], v[222:225], v[178:181]
    v_cvt_pk_f16_f32 v167, v124, v125
    v_pk_fma_f16 v199, v167, v167, v199
    v_mfma_f32_16x16x32_bf16 v[178:181], a[16:19], v[226:229], v[178:181]
    v_cvt_pk_f16_f32 v168, v186, v187
    v_pk_fma_f16 v199, v168, v168, v199
    v_mfma_f32_16x16x32_bf16 v[178:181], a[20:23], v[190:193], v[178:181]
    v_cvt_pk_f16_f32 v169, v188, v189
    v_pk_fma_f16 v199, v169, v169, v199
    v_mfma_f32_16x16x32_bf16 v[186:189], a[24:27], v[182:185], 0
    v_cvt_pk_f16_f32 v124, v194, v195
    v_pk_fma_f16 v199, v124, v124, v199
    v_mfma_f32_16x16x32_bf16 v[186:189], a[28:31], v[210:213], v[186:189]
    v_cvt_pk_f16_f32 v125, v196, v197
    v_pk_fma_f16 v199, v125, v125, v199
    v_mfma_f32_16x16x32_bf16 v[186:189], a[32:35], v[218:221], v[186:189]
    v_cvt_pk_f16_f32 v178, v178, v179
    v_pk_mul_f16 v198, v178, v178
    v_mfma_f32_16x16x32_bf16 v[186:189], a[36:39], v[222:225], v[186:189]
    v_cvt_pk_f16_f32 v179, v180, v181
    v_pk_fma_f16 v198, v179, v179, v198
    v_mfma_f32_16x16x32_bf16 v[186:189], a[40:43], v[226:229], v[186:189]
    v_pk_mul_f16 v200, v178, v170
    v_pk_fma_f16 v200, v179, v171, v200
    v_mfma_f32_16x16x32_bf16 v[186:189], a[44:47], v[190:193], v[186:189]
    v_pk_mul_f16 v201, v166, v174
    v_pk_fma_f16 v201, v167, v175, v201
    v_mfma_f32_16x16x32_bf16 v[194:197], a[48:51], v[182:185], 0
    v_pk_fma_f16 v201, v168, v176, v201
    v_pk_fma_f16 v201, v169, v177, v201
    v_mfma_f32_16x16x32_bf16 v[194:197], a[52:55], v[210:213], v[194:197]
    v_pk_fma_f16 v201, v124, v164, v201
    v_pk_fma_f16 v201, v125, v165, v201
    v_mfma_f32_16x16x32_bf16 v[194:197], a[56:59], v[218:221], v[194:197]
    v_cvt_pk_f16_f32 v180, v186, v187
    v_pk_fma_f16 v198, v180, v180, v198
    v_mfma_f32_16x16x32_bf16 v[194:197], a[60:63], v[222:225], v[194:197]
    v_cvt_pk_f16_f32 v181, v188, v189
    v_pk_fma_f16 v198, v181, v181, v198
    v_mfma_f32_16x16x32_bf16 v[194:197], a[64:67], v[226:229], v[194:197]
    v_pk_fma_f16 v200, v180, v172, v200
    v_pk_fma_f16 v200, v181, v173, v200
    v_mfma_f32_16x16x32_bf16 v[194:197], a[68:71], v[190:193], v[194:197]
    buffer_store_dwordx2 v[140:141], v18, s[12:15], 0 offen nt
    v_mul_f32 v242, v144, v242
    v_mul_f32 v243, v144, v243
    v_mfma_f32_16x16x32_bf16 v[186:189], v[182:185], a[144:147], 0
    v_cvt_pk_bf16_f32 v238, v242, v243
    v_mul_f32 v244, v144, v244
    v_mfma_f32_16x16x32_bf16 v[186:189], v[210:213], a[148:151], v[186:189]
    v_mul_f32 v245, v144, v245
    v_cvt_pk_f16_f32 v122, v194, v195
    v_mfma_f32_16x16x32_bf16 v[186:189], v[218:221], a[152:155], v[186:189]
    v_pk_fma_f16 v198, v122, v122, v198
    v_cvt_pk_f16_f32 v123, v196, v197
    v_mfma_f32_16x16x32_bf16 v[186:189], v[222:225], a[156:159], v[186:189]
    v_pk_fma_f16 v198, v123, v123, v198
    v_pk_fma_f16 v200, v122, v162, v200
    v_mfma_f32_16x16x32_bf16 v[186:189], v[226:229], a[160:163], v[186:189]
    ds_read_b128 v[202:205], v0 offset:32768
    v_pk_fma_f16 v200, v123, v163, v200
    v_mfma_f32_16x16x32_bf16 v[186:189], v[190:193], a[164:167], v[186:189]
    ds_read_b128 v[194:197], v1 offset:32768
    v_cvt_pk_bf16_f32 v239, v244, v245
    v_mfma_f32_16x16x32_f16 v[230:233], v[40:43], v[198:201], 0
    v_mul_f32 v158, v144, v158
    v_mul_f32 v159, v144, v159
    v_mfma_f32_16x16x32_bf16 v[246:249], v[182:185], a[168:171], 0
    ds_read_b128 v[214:217], v0 offset:32896
    v_cvt_pk_bf16_f32 v240, v158, v159
    v_mfma_f32_16x16x32_bf16 v[246:249], v[210:213], a[172:175], v[246:249]
    ds_read_b128 v[206:209], v1 offset:32896
    v_cvt_pk_bf16_f32 v136, v186, v187
    v_mfma_f32_16x16x32_bf16 v[246:249], v[218:221], a[176:179], v[246:249]
    ds_read_b128 v[198:201], v0 offset:33024
    v_cvt_pk_bf16_f32 v137, v188, v189
    v_mfma_f32_16x16x32_bf16 v[246:249], v[222:225], a[180:183], v[246:249]
    ds_read_b128 v[186:189], v1 offset:33024
    v_mul_f32 v160, v144, v160
    v_mfma_f32_16x16x32_bf16 v[246:249], v[226:229], a[184:187], v[246:249]
    v_rsq_f32 v230, v230
    v_mfma_f32_16x16x32_bf16 v[246:249], v[190:193], a[188:191], v[246:249]
    s_waitcnt lgkmcnt(5)
    v_rsq_f32 v231, v231
    v_mfma_f32_16x16x32_bf16 v[242:245], v[182:185], a[192:195], 0
    s_waitcnt lgkmcnt(4)
    v_mul_f32 v234, s31, v230
    v_cvt_pk_f16_f32 v235, v234, v231
    v_mfma_f32_16x16x32_bf16 v[242:245], v[210:213], a[196:199], v[242:245]
    v_fma_f32 v232, v232, v234, v24
    v_fmac_f32_dpp v254, v233, v231 quad_perm:[0,1,2,3] row_mask:0x2 bank_mask:0xf
    v_mfma_f32_16x16x32_bf16 v[242:245], v[218:221], a[200:203], v[242:245]
    s_waitcnt lgkmcnt(3)
    v_cvt_pk_bf16_f32 v140, v246, v247
    v_cvt_pk_bf16_f32 v141, v248, v249
    v_mfma_f32_16x16x32_bf16 v[242:245], v[222:225], a[204:207], v[242:245]
    s_waitcnt lgkmcnt(2)
    v_mul_f32 v161, v144, v161
    v_cvt_pk_bf16_f32 v241, v160, v161
    v_mfma_f32_16x16x32_bf16 v[242:245], v[226:229], a[208:211], v[242:245]
    s_waitcnt lgkmcnt(1)
    buffer_store_dwordx4 v[238:241], v17, s[12:15], 0 offen nt
    v_mul_f32 v154, v144, v154
    v_mul_f32 v155, v144, v155
    v_cvt_pk_bf16_f32 v154, v154, v155
    v_mul_f32 v156, v144, v156
    v_mfma_f32_16x16x32_bf16 v[242:245], v[190:193], a[212:215], v[242:245]
    s_waitcnt lgkmcnt(0)
    v_mul_f32 v157, v144, v157
    v_cvt_pk_bf16_f32 v155, v156, v157
    v_mfma_f32_16x16x32_bf16 v[158:161], a[72:75], v[202:205], 0
    v_pk_mul_f16 v166, v166, v235 op_sel:[0,1] op_sel_hi:[1,1]
    v_pk_mul_f16 v167, v167, v235 op_sel:[0,1] op_sel_hi:[1,1]
    v_mfma_f32_16x16x32_bf16 v[158:161], a[76:79], v[194:197], v[158:161]
    v_pk_mul_f16 v168, v168, v235 op_sel:[0,1] op_sel_hi:[1,1]
    v_cvt_pk_bf16_f32 v144, v242, v243
    v_mfma_f32_16x16x32_bf16 v[158:161], a[80:83], v[214:217], v[158:161]
    v_cvt_pk_bf16_f32 v145, v244, v245
    v_pk_mul_f16 v169, v169, v235 op_sel:[0,1] op_sel_hi:[1,1]
    v_mfma_f32_16x16x32_bf16 v[158:161], a[84:87], v[206:209], v[158:161]
    v_pk_mul_f16 v124, v124, v235 op_sel:[0,1] op_sel_hi:[1,1]
    v_pk_mul_f16 v125, v125, v235 op_sel:[0,1] op_sel_hi:[1,1]
    v_mfma_f32_16x16x32_bf16 v[158:161], a[88:91], v[198:201], v[158:161]
    v_pk_mul_f16 v178, v178, v235 op_sel:[0,0] op_sel_hi:[1,0]
    v_pk_mul_f16 v179, v179, v235 op_sel:[0,0] op_sel_hi:[1,0]
    v_mfma_f32_16x16x32_bf16 v[158:161], a[92:95], v[186:189], v[158:161]
    v_pk_mul_f16 v180, v180, v235 op_sel:[0,0] op_sel_hi:[1,0]
    v_pk_mul_f16 v181, v181, v235 op_sel:[0,0] op_sel_hi:[1,0]
    v_mfma_f32_16x16x32_bf16 v[182:185], a[96:99], v[202:205], 0
    v_pk_mul_f16 v122, v122, v235 op_sel:[0,0] op_sel_hi:[1,0]
    v_pk_mul_f16 v123, v123, v235 op_sel:[0,0] op_sel_hi:[1,0]
    v_mfma_f32_16x16x32_bf16 v[182:185], a[100:103], v[194:197], v[182:185]
    v_max3_u32 v44, v44, v230, v231
    v_mul_f32 v130, v255, v130
    v_mfma_f32_16x16x32_bf16 v[182:185], a[104:107], v[214:217], v[182:185]
    v_cvt_pk_f16_f32 v158, v158, v159
    v_pk_mul_f16 v191, v158, v158
    v_mfma_f32_16x16x32_bf16 v[182:185], a[108:111], v[206:209], v[182:185]
    v_cvt_pk_f16_f32 v159, v160, v161
    v_pk_fma_f16 v191, v159, v159, v191
    v_mfma_f32_16x16x32_bf16 v[182:185], a[112:115], v[198:201], v[182:185]
    v_pk_mul_f16 v193, v158, v174
    v_pk_fma_f16 v193, v159, v175, v193
    v_mfma_f32_16x16x32_bf16 v[182:185], a[116:119], v[186:189], v[182:185]
    v_exp_f32 v232, v232
    v_mfma_f32_16x16x32_bf16 v[210:213], a[120:123], v[202:205], 0
    v_exp_f32 v236, v236
    v_mfma_f32_16x16x32_bf16 v[210:213], a[124:127], v[194:197], v[210:213]
    v_cvt_pk_bf16_f32 v39, v236, 0
    v_mul_f32 v131, v255, v131
    v_mfma_f32_16x16x32_bf16 v[210:213], a[128:131], v[214:217], v[210:213]
    s_waitcnt vmcnt(3)
    ds_write_b16 v8, v45 offset:512
    v_mfma_f32_16x16x32_bf16 v[210:213], a[132:135], v[206:209], v[210:213]
    buffer_store_dwordx2 v[154:155], v20, s[12:15], 0 offen nt
    v_cvt_pk_f16_f32 v160, v182, v183
    v_mfma_f32_16x16x32_bf16 v[210:213], a[136:139], v[198:201], v[210:213]
    v_pk_fma_f16 v191, v160, v160, v191
    v_cvt_pk_f16_f32 v161, v184, v185
    v_mfma_f32_16x16x32_bf16 v[210:213], a[140:143], v[186:189], v[210:213]
    v_pk_fma_f16 v191, v161, v161, v191
    v_pk_fma_f16 v193, v160, v176, v193
    v_mfma_f32_16x16x32_bf16 v[154:157], a[0:3], v[202:205], 0
    v_pk_fma_f16 v193, v161, v177, v193
    v_cvt_pk_bf16_f32 v130, v130, v131
    v_mfma_f32_16x16x32_bf16 v[154:157], a[4:7], v[194:197], v[154:157]
    v_mul_f32 v132, v255, v132
    v_mul_f32 v133, v255, v133
    v_mfma_f32_16x16x32_bf16 v[154:157], a[8:11], v[214:217], v[154:157]
    v_cvt_pk_f16_f32 v176, v210, v211
    v_pk_fma_f16 v191, v176, v176, v191
    v_mfma_f32_16x16x32_bf16 v[154:157], a[12:15], v[206:209], v[154:157]
    s_waitcnt lgkmcnt(0)
    v_cvt_pk_f16_f32 v177, v212, v213
    v_pk_fma_f16 v191, v177, v177, v191
    v_mfma_f32_16x16x32_bf16 v[154:157], a[16:19], v[198:201], v[154:157]
    v_pk_fma_f16 v193, v176, v164, v193
    v_mfma_f32_16x16x32_bf16 v[154:157], a[20:23], v[186:189], v[154:157]
    v_pk_fma_f16 v193, v177, v165, v193
    v_mfma_f32_16x16x32_bf16 v[182:185], a[24:27], v[202:205], 0
    v_cvt_pk_bf16_f32 v131, v132, v133
    v_mfma_f32_16x16x32_bf16 v[182:185], a[28:31], v[194:197], v[182:185]
    s_barrier
    ds_read2_b32 v[164:165], v6 offset0:0 offset1:0
    v_mfma_f32_16x16x32_bf16 v[182:185], a[32:35], v[214:217], v[182:185]
    ds_read2_b32 v[212:213], v6 offset0:16 offset1:16
    v_cvt_pk_f16_f32 v154, v154, v155
    v_mfma_f32_16x16x32_bf16 v[182:185], a[36:39], v[206:209], v[182:185]
    ds_read2_b32 v[220:221], v6 offset0:32 offset1:32
    v_pk_mul_f16 v190, v154, v154
    v_mfma_f32_16x16x32_bf16 v[182:185], a[40:43], v[198:201], v[182:185]
    ds_read_u16 v133, v9 offset:128
    v_cvt_pk_f16_f32 v155, v156, v157
    v_mfma_f32_16x16x32_bf16 v[182:185], a[44:47], v[186:189], v[182:185]
    v_pk_fma_f16 v190, v155, v155, v190
    v_pk_mul_f16 v192, v154, v170
    v_mfma_f32_16x16x32_bf16 v[222:225], a[48:51], v[202:205], 0
    v_pk_fma_f16 v192, v155, v171, v192
    v_mul_f32 v126, v255, v126
    v_mfma_f32_16x16x32_bf16 v[222:225], a[52:55], v[194:197], v[222:225]
    v_mul_f32 v127, v255, v127
    v_cvt_pk_bf16_f32 v132, v126, v127
    v_mfma_f32_16x16x32_bf16 v[222:225], a[56:59], v[214:217], v[222:225]
    buffer_load_dwordx4 v10, s[8:11], 0 offen nt lds
    v_cvt_pk_f16_f32 v156, v182, v183
    v_mfma_f32_16x16x32_bf16 v[222:225], a[60:63], v[206:209], v[222:225]
    s_add_u32 m0, s28, 4096
    v_pk_fma_f16 v190, v156, v156, v190
    v_cvt_pk_f16_f32 v157, v184, v185
    v_mfma_f32_16x16x32_bf16 v[222:225], a[64:67], v[198:201], v[222:225]
    s_waitcnt lgkmcnt(2)
    v_pk_fma_f16 v190, v157, v157, v190
    v_pk_fma_f16 v192, v156, v172, v192
    v_mfma_f32_16x16x32_bf16 v[222:225], a[68:71], v[186:189], v[222:225]
    s_waitcnt lgkmcnt(1)
    ds_read_b128 v[182:185], v2 offset:0
    v_pk_fma_f16 v192, v157, v173, v192
    v_mfma_f32_16x16x32_bf16 v[170:173], v[202:205], a[144:147], 0
    s_waitcnt lgkmcnt(1)
    ds_read_b128 v[226:229], v2 offset:1024
    v_readfirstlane_b32 s77, v133
    v_mfma_f32_16x16x32_bf16 v[170:173], v[194:197], a[148:151], v[170:173]
    ds_read_b128 v[234:237], v2 offset:2048
    buffer_load_dwordx4 v11, s[8:11], 0 offen nt lds
    v_mfma_f32_16x16x32_bf16 v[170:173], v[214:217], a[152:155], v[170:173]
    s_add_u32 m0, s28, 8192
    ds_read_b128 v[238:241], v2 offset:3072
    v_cvt_pk_f16_f32 v174, v222, v223
    v_mfma_f32_16x16x32_bf16 v[170:173], v[206:209], a[156:159], v[170:173]
    s_mul_i32 s78, s77, 2688
    ds_read_b128 v[242:245], v2 offset:4096
    v_pk_fma_f16 v190, v174, v174, v190
    v_mfma_f32_16x16x32_bf16 v[170:173], v[198:201], a[160:163], v[170:173]
    ds_read_b128 v[246:249], v2 offset:5120
    v_cvt_pk_f16_f32 v175, v224, v225
    v_mfma_f32_16x16x32_bf16 v[170:173], v[186:189], a[164:167], v[170:173]
    v_pk_fma_f16 v190, v175, v175, v190
    v_pk_fma_f16 v192, v174, v162, v192
    v_mfma_f32_16x16x32_bf16 v[222:225], v[202:205], a[168:171], 0
    buffer_load_dwordx4 v12, s[8:11], 0 offen nt lds
    v_pk_fma_f16 v192, v175, v163, v192
    v_mfma_f32_16x16x32_bf16 v[222:225], v[194:197], a[172:175], v[222:225]
    s_waitcnt lgkmcnt(5)
    v_mul_f32 v128, v255, v128
    v_cvt_pk_bf16_f32 v162, v170, v171
    v_mfma_f32_16x16x32_f16 v[250:253], v[40:43], v[190:193], 0
    s_add_u32 m0, s28, 12288
    v_cvt_pk_bf16_f32 v163, v172, v173
    v_mul_f32 v129, v255, v129
    v_mfma_f32_16x16x32_bf16 v[222:225], v[214:217], a[176:179], v[222:225]
    s_xor_b32 s28, s28, 65536
    v_cvt_pk_bf16_f32 v133, v128, v129
    v_mul_f32 v114, v255, v114
    v_mfma_f32_16x16x32_bf16 v[222:225], v[206:209], a[180:183], v[222:225]
    s_waitcnt lgkmcnt(2)
    v_rsq_f32 v250, v250
    v_mfma_f32_16x16x32_bf16 v[222:225], v[198:201], a[184:187], v[222:225]
    s_waitcnt lgkmcnt(1)
    buffer_load_dwordx4 v13, s[8:11], 0 offen nt lds
    v_mul_f32 v230, s31, v250
    v_mfma_f32_16x16x32_bf16 v[222:225], v[186:189], a[188:191], v[222:225]
    s_mov_b32 m0, s29
    v_rsq_f32 v251, v251
    v_mfma_f32_16x16x32_bf16 v[126:129], v[202:205], a[192:195], 0
    s_xor_b32 s29, s29, s30
    v_cvt_pk_f16_f32 v231, v230, v251
    v_fma_f32 v252, v252, v230, v26
    v_mfma_f32_16x16x32_bf16 v[126:129], v[194:197], a[196:199], v[126:129]
    s_add_u32 s19, s19, s20
    v_fmac_f32_dpp v254, v253, v251 quad_perm:[0,1,2,3] row_mask:0x4 bank_mask:0xf
    v_cvt_pk_bf16_f32 v210, v222, v223
    v_mfma_f32_16x16x32_bf16 v[126:129], v[214:217], a[200:203], v[126:129]
    s_add_u32 s23, s23, s21
    v_cvt_pk_bf16_f32 v211, v224, v225
    v_pk_mul_f16 v158, v158, v231 op_sel:[0,1] op_sel_hi:[1,1]
    v_mfma_f32_16x16x32_bf16 v[126:129], v[206:209], a[204:207], v[126:129]
    s_waitcnt lgkmcnt(0)
    v_pk_mul_f16 v159, v159, v231 op_sel:[0,1] op_sel_hi:[1,1]
    v_mfma_f32_16x16x32_bf16 v[126:129], v[198:201], a[208:211], v[126:129]
    s_cmp_ge_u32 s19, 72
    v_pk_mul_f16 v160, v160, v231 op_sel:[0,1] op_sel_hi:[1,1]
    v_pk_mul_f16 v161, v161, v231 op_sel:[0,1] op_sel_hi:[1,1]
    v_mfma_f32_16x16x32_bf16 v[126:129], v[186:189], a[212:215], v[126:129]
    s_cselect_b32 s34, 72, 0
    v_pk_mul_f16 v176, v176, v231 op_sel:[0,1] op_sel_hi:[1,1]
    v_pk_mul_f16 v177, v177, v231 op_sel:[0,1] op_sel_hi:[1,1]
    v_mfma_f32_16x16x32_f16 v[170:173], v[146:149], v[150:153], v[46:49]
    s_cselect_b32 s35, s22, 0
    v_pk_mul_f16 v154, v154, v231 op_sel:[0,0] op_sel_hi:[1,0]
    v_pk_mul_f16 v155, v155, v231 op_sel:[0,0] op_sel_hi:[1,0]
    v_mfma_f32_16x16x32_f16 v[186:189], v[166:169], v[150:153], v[50:53]
    s_sub_u32 s19, s19, s34
    v_cvt_pk_bf16_f32 v218, v126, v127
    v_cvt_pk_bf16_f32 v219, v128, v129
    v_mfma_f32_16x16x32_f16 v[126:129], v[158:161], v[150:153], v[54:57]
    buffer_store_dwordx4 v[130:133], v16, s[12:15], 0 offen nt
    v_pk_mul_f16 v156, v156, v231 op_sel:[0,0] op_sel_hi:[1,0]
    v_pk_mul_f16 v157, v157, v231 op_sel:[0,0] op_sel_hi:[1,0]
    v_pk_mul_f16 v174, v174, v231 op_sel:[0,0] op_sel_hi:[1,0]
    v_pk_mul_f16 v175, v175, v231 op_sel:[0,0] op_sel_hi:[1,0]
    v_mfma_f32_16x16x16_f16 v[170:173], v[120:121], v[118:119], v[170:173]
    v_max3_u32 v44, v44, v250, v251
    v_exp_f32 v254, v254
    v_mfma_f32_16x16x16_f16 v[186:189], v[124:125], v[118:119], v[186:189]
    v_cvt_pk_bf16_f32 v254, v254, v254
    v_exp_f32 v252, v252
    v_mfma_f32_16x16x16_f16 v[126:129], v[176:177], v[118:119], v[126:129]
    v_mul_f32 v115, v255, v115
    v_cvt_pk_bf16_f32 v118, v114, v115
    v_exp_f32 v170, v170
    v_mfma_f32_16x16x32_f16 v[130:133], v[146:149], v[178:181], v[58:61]
    s_add_u32 s23, s23, s35
    ds_write_b16 v8, v254
    v_mfma_f32_16x16x32_f16 v[150:153], v[166:169], v[178:181], v[62:65]
    s_add_u32 s78, s78, s69
    v_exp_f32 v171, v171
    v_mfma_f32_16x16x32_f16 v[190:193], v[158:161], v[178:181], v[66:69]
    s_add_u32 s80, s77, s68
    v_cvt_pk_bf16_f32 v170, v170, v171
    v_exp_f32 v172, v172
    v_mfma_f32_16x16x16_f16 v[130:133], v[120:121], v[122:123], v[130:133]
    v_exp_f32 v173, v173
    v_mul_f32 v116, v255, v116
    v_mfma_f32_16x16x16_f16 v[150:153], v[124:125], v[122:123], v[150:153]
    v_cvt_pk_bf16_f32 v171, v172, v173
    v_exp_f32 v186, v186
    v_mfma_f32_16x16x16_f16 v[190:193], v[176:177], v[122:123], v[190:193]
    v_exp_f32 v187, v187
    v_exp_f32 v188, v188
    v_mfma_f32_16x16x32_bf16 v[178:181], a[216:219], v[182:185], 0
    s_cmp_ge_u32 s80, 72
    v_exp_f32 v130, v130
    v_mfma_f32_16x16x32_bf16 v[178:181], a[220:223], v[226:229], v[178:181]
    s_cselect_b32 s80, s22, 0
    v_exp_f32 v131, v131
    v_mfma_f32_16x16x32_bf16 v[178:181], a[224:227], v[234:237], v[178:181]
    s_add_u32 s78, s78, s80
    v_cvt_pk_bf16_f32 v194, v130, v131
    v_cvt_pk_bf16_f32 v172, v186, v187
    v_mfma_f32_16x16x32_bf16 v[178:181], a[228:231], v[238:241], v[178:181]
    s_add_u32 s80, s77, 20
    v_exp_f32 v132, v132
    v_mfma_f32_16x16x32_bf16 v[178:181], a[232:235], v[242:245], v[178:181]
    s_add_u32 s34, s18, 3
    v_exp_f32 v133, v133
    v_mfma_f32_16x16x32_bf16 v[178:181], a[236:239], v[246:249], v[178:181]
    s_cmp_lt_u32 s77, s62
    v_cvt_pk_bf16_f32 v195, v132, v133
    v_mul_f32 v117, v255, v117
    v_mfma_f32_16x16x32_bf16 v[198:201], a[240:243], v[182:185], 0
    s_cselect_b32 s79, 1, 0
    v_exp_f32 v150, v150
    v_mfma_f32_16x16x32_f16 v[202:205], v[146:149], v[154:157], v[70:73]
    s_cselect_b32 s78, s78, 0
    v_exp_f32 v151, v151
    v_mfma_f32_16x16x32_f16 v[146:149], v[166:169], v[154:157], v[74:77]
    s_cmp_lt_u32 s34, s17
    v_cvt_pk_bf16_f32 v196, v150, v151
    v_cvt_pk_bf16_f32 v119, v116, v117
    v_mfma_f32_16x16x32_f16 v[166:169], v[158:161], v[154:157], v[78:81]
    buffer_store_dwordx2 v[118:119], v19, s[12:15], 0 offen nt
    v_exp_f32 v152, v152
    v_mfma_f32_16x16x16_f16 v[202:205], v[120:121], v[174:175], v[202:205]
    v_exp_f32 v153, v153
    v_fma_f32 v254, v178, v178, s33
    v_mfma_f32_16x16x16_f16 v[146:149], v[124:125], v[174:175], v[146:149]
    v_cvt_pk_bf16_f32 v197, v152, v153
    v_exp_f32 v190, v190
    v_mfma_f32_16x16x16_f16 v[166:169], v[176:177], v[174:175], v[166:169]
    v_exp_f32 v191, v191
    v_exp_f32 v192, v192
    v_mfma_f32_16x16x32_bf16 v[198:201], a[244:247], v[226:229], v[198:201]
    s_cselect_b32 s23, s23, s78
    v_exp_f32 v193, v193
    v_mfma_f32_16x16x32_bf16 v[198:201], a[248:251], v[234:237], v[198:201]
    s_cselect_b32 s73, s34, s80
    ds_read_b128 v[118:121], v2 offset:6144
    v_fmac_f32 v254, v179, v179
    v_mfma_f32_16x16x32_bf16 v[198:201], a[252:255], v[238:241], v[198:201]
    s_cselect_b32 s79, 0, s79
    ds_read_b128 v[122:125], v2 offset:7168
    v_fmac_f32 v254, v180, v180
    v_mfma_f32_16x16x32_bf16 v[198:201], v[82:85], v[242:245], v[198:201]
    s_cselect_b32 s81, 0, 1
    ds_read_b128 v[150:153], v2 offset:8192
    v_fmac_f32 v254, v181, v181
    v_mfma_f32_16x16x32_bf16 v[198:201], v[86:89], v[246:249], v[198:201]
    s_add_u32 s80, s77, 1
    ds_read_b128 v[154:157], v2 offset:9216
    v_xor_b32 v0, 65536, v0
    v_mfma_f32_16x16x32_bf16 v[206:209], v[90:93], v[182:185], 0
    s_mul_i32 s80, s80, s81
    ds_read_b128 v[158:161], v2 offset:10240
    v_xor_b32 v1, 65536, v1
    v_mfma_f32_16x16x32_bf16 v[206:209], v[94:97], v[226:229], v[206:209]
    s_cmp_lt_u32 s80, s62
    ds_read_b128 v[174:177], v2 offset:11264
    v_fmac_f32 v254, v198, v198
    v_mfma_f32_16x16x32_bf16 v[206:209], v[98:101], v[234:237], v[206:209]
    s_cselect_b32 s62, s62, 0
    v_exp_f32 v189, v189
    v_mfma_f32_16x16x32_bf16 v[206:209], v[102:105], v[238:241], v[206:209]
    s_add_u32 s80, s18, 4
    v_cvt_pk_bf16_f32 v173, v188, v189
    v_fmac_f32 v254, v199, v199
    v_mfma_f32_16x16x32_bf16 v[206:209], v[106:109], v[242:245], v[206:209]
    s_waitcnt lgkmcnt(5)
    v_exp_f32 v126, v126
    v_mfma_f32_16x16x32_bf16 v[206:209], v[110:113], v[246:249], v[206:209]
    s_cmp_ge_u32 s80, s17
    v_exp_f32 v127, v127
    v_mfma_f32_16x16x32_bf16 v[130:133], a[216:219], v[118:121], 0
    s_waitcnt lgkmcnt(3)
    v_cvt_pk_bf16_f32 v36, v126, v127
    v_fmac_f32 v254, v200, v200
    v_mfma_f32_16x16x32_bf16 v[130:133], a[220:223], v[122:125], v[130:133]
    s_cselect_b32 s66, s62, 0
    v_exp_f32 v128, v128
    v_mfma_f32_16x16x32_bf16 v[130:133], a[224:227], v[150:153], v[130:133]
    s_waitcnt lgkmcnt(1)
    v_fmac_f32 v254, v201, v201
    v_mfma_f32_16x16x32_bf16 v[130:133], a[228:231], v[154:157], v[130:133]
    s_lshl_b32 s80, s79, s73
    v_exp_f32 v129, v129
    v_mfma_f32_16x16x32_bf16 v[130:133], a[232:235], v[158:161], v[130:133]
    s_waitcnt lgkmcnt(0)
    v_cvt_pk_bf16_f32 v37, v128, v129
    v_fmac_f32 v254, v206, v206
    v_mfma_f32_16x16x32_bf16 v[130:133], a[236:239], v[174:177], v[130:133]
    s_or_b32 s70, s70, s80
    v_exp_f32 v202, v202
    v_mfma_f32_16x16x32_bf16 v[182:185], v[28:31], v[36:39], 0
    s_add_u32 s45, s45, s79
    v_exp_f32 v203, v203
    v_mfma_f32_16x16x32_bf16 v[182:185], v[28:31], v[170:173], v[182:185]
    s_add_u32 s18, s18, 1
    v_cvt_pk_bf16_f32 v186, v202, v203
    v_fma_f32 v255, v130, v130, s33
    v_mfma_f32_16x16x32_bf16 v[214:217], v[162:165], v[36:39], 0
    s_cmp_lt_u32 s18, s45
    v_fmac_f32 v255, v131, v131
    v_fmac_f32 v255, v132, v132
    v_mfma_f32_16x16x32_bf16 v[214:217], v[134:137], v[170:173], v[214:217]
    v_fmac_f32 v255, v133, v133
    v_fmac_f32 v254, v207, v207
    v_mfma_f32_16x16x32_bf16 v[222:225], v[210:213], v[36:39], 0
    v_exp_f32 v204, v204
    v_mfma_f32_16x16x32_bf16 v[222:225], v[138:141], v[170:173], v[222:225]
    v_exp_f32 v205, v205
    v_mfma_f32_16x16x32_bf16 v[226:229], v[218:221], v[36:39], 0
    v_cvt_pk_bf16_f32 v36, v190, v191
    v_cvt_pk_bf16_f32 v37, v192, v193
    v_mfma_f32_16x16x32_bf16 v[226:229], v[142:145], v[170:173], v[226:229]
    v_cvt_pk_bf16_f32 v39, v232, 0
    v_cvt_pk_bf16_f32 v187, v204, v205
    v_mfma_f32_16x16x32_bf16 v[126:129], a[240:243], v[118:121], 0
    v_exp_f32 v146, v146
    v_mfma_f32_16x16x32_bf16 v[170:173], v[28:31], v[36:39], 0
    v_exp_f32 v147, v147
    v_mfma_f32_16x16x32_bf16 v[170:173], v[28:31], v[194:197], v[170:173]
    v_cvt_pk_bf16_f32 v188, v146, v147
    v_fmac_f32 v254, v208, v208
    v_mfma_f32_16x16x32_bf16 v[114:117], v[162:165], v[36:39], 0
    v_exp_f32 v148, v148
    v_mfma_f32_16x16x32_bf16 v[114:117], v[134:137], v[194:197], v[114:117]
    v_exp_f32 v149, v149
    v_mfma_f32_16x16x32_bf16 v[190:193], v[210:213], v[36:39], 0
    v_cvt_pk_bf16_f32 v189, v148, v149
    v_fmac_f32 v254, v209, v209
    v_mfma_f32_16x16x32_bf16 v[190:193], v[138:141], v[194:197], v[190:193]
    v_rcp_f32 v171, v170
    v_mfma_f32_16x16x32_bf16 v[146:149], v[218:221], v[36:39], 0
    v_exp_f32 v166, v166
    v_mfma_f32_16x16x32_bf16 v[146:149], v[142:145], v[194:197], v[146:149]
    v_mul_f32 v114, v171, v114
    v_mul_f32 v115, v171, v115
    v_mfma_f32_16x16x32_bf16 v[126:129], a[244:247], v[122:125], v[126:129]
    v_cvt_pk_bf16_f32 v194, v114, v115
    v_mul_f32 v116, v171, v116
    v_mfma_f32_16x16x32_bf16 v[126:129], a[248:251], v[150:153], v[126:129]
    ds_read_b128 v[202:205], v2 offset:12288
    v_mul_f32 v117, v171, v117
    v_mfma_f32_16x16x32_bf16 v[126:129], a[252:255], v[154:157], v[126:129]
    ds_read_b128 v[230:233], v2 offset:13312
    v_cvt_pk_bf16_f32 v195, v116, v117
    v_mfma_f32_16x16x32_bf16 v[126:129], v[82:85], v[158:161], v[126:129]
    ds_read_b128 v[234:237], v2 offset:14336
    v_mul_f32 v190, v171, v190
    v_mfma_f32_16x16x32_bf16 v[126:129], v[86:89], v[174:177], v[126:129]
    ds_read_b128 v[238:241], v2 offset:15360
    v_mul_f32 v191, v171, v191
    v_mfma_f32_16x16x32_bf16 v[114:117], v[90:93], v[118:121], 0
    ds_read_b128 v[118:121], v2 offset:16384
    v_cvt_pk_bf16_f32 v196, v190, v191
    v_mfma_f32_16x16x32_bf16 v[114:117], v[94:97], v[122:125], v[114:117]
    ds_read_b128 v[122:125], v2 offset:17408
    v_mul_f32 v192, v171, v192
    v_mfma_f32_16x16x32_bf16 v[114:117], v[98:101], v[150:153], v[114:117]
    v_fmac_f32 v255, v126, v126
    v_fmac_f32 v255, v127, v127
    v_mfma_f32_16x16x32_bf16 v[114:117], v[102:105], v[154:157], v[114:117]
    v_fmac_f32 v255, v128, v128
    v_fmac_f32 v255, v129, v129
    v_mfma_f32_16x16x32_bf16 v[114:117], v[106:109], v[158:161], v[114:117]
    s_waitcnt lgkmcnt(5)
    v_mul_f32 v193, v171, v193
    v_cvt_pk_bf16_f32 v197, v192, v193
    v_mfma_f32_16x16x32_bf16 v[114:117], v[110:113], v[174:177], v[114:117]
    s_waitcnt lgkmcnt(4)
    ds_write_b128 v3, v[194:197] offset:6144
    v_mfma_f32_16x16x32_bf16 v[242:245], a[216:219], v[202:205], 0
    s_waitcnt lgkmcnt(3)
    v_mul_f32 v146, v171, v146
    v_mul_f32 v147, v171, v147
    v_mfma_f32_16x16x32_bf16 v[242:245], a[220:223], v[230:233], v[242:245]
    s_waitcnt lgkmcnt(2)
    v_fmac_f32 v255, v114, v114
    v_fmac_f32 v255, v115, v115
    v_mfma_f32_16x16x32_bf16 v[242:245], a[224:227], v[234:237], v[242:245]
    s_waitcnt lgkmcnt(1)
    v_fmac_f32 v255, v116, v116
    v_fmac_f32 v255, v117, v117
    v_mfma_f32_16x16x32_bf16 v[242:245], a[228:231], v[238:241], v[242:245]
    v_cvt_pk_bf16_f32 v254, v254, v255
    v_cvt_pk_bf16_f32 v172, v146, v147
    v_mfma_f32_16x16x32_bf16 v[242:245], a[232:235], v[118:121], v[242:245]
    v_mul_f32 v148, v171, v148
    v_mul_f32 v149, v171, v149
    v_mfma_f32_16x16x32_bf16 v[242:245], a[236:239], v[122:125], v[242:245]
    v_cvt_pk_bf16_f32 v173, v148, v149
    v_cvt_pk_bf16_f32 v39, v252, 0
    v_mfma_f32_16x16x32_bf16 v[158:161], a[240:243], v[202:205], 0
    ds_write_b64 v4, v[172:173] offset:10240
    v_mfma_f32_16x16x32_bf16 v[158:161], a[244:247], v[230:233], v[158:161]
    v_exp_f32 v167, v167
    v_mfma_f32_16x16x32_bf16 v[158:161], a[248:251], v[234:237], v[158:161]
    v_cvt_pk_bf16_f32 v36, v166, v167
    v_fma_f32 v255, v242, v242, s33
    v_mfma_f32_16x16x32_bf16 v[158:161], a[252:255], v[238:241], v[158:161]
    v_fmac_f32 v255, v243, v243
    v_fmac_f32 v255, v244, v244
    v_mfma_f32_16x16x32_bf16 v[158:161], v[82:85], v[118:121], v[158:161]
    v_fmac_f32 v255, v245, v245
    v_xor_b32 v2, 65536, v2
    v_mfma_f32_16x16x32_bf16 v[158:161], v[86:89], v[122:125], v[158:161]
    v_exp_f32 v168, v168
    v_mfma_f32_16x16x32_bf16 v[154:157], v[90:93], v[202:205], 0
    v_exp_f32 v169, v169
    v_mfma_f32_16x16x32_bf16 v[154:157], v[94:97], v[230:233], v[154:157]
    ds_read_b128 v[146:149], v9
    v_cvt_pk_bf16_f32 v37, v168, v169
    v_mfma_f32_16x16x32_bf16 v[154:157], v[98:101], v[234:237], v[154:157]
    ds_read_b128 v[150:153], v9 offset:64
    v_fmac_f32 v255, v158, v158
    v_mfma_f32_16x16x32_bf16 v[166:169], v[28:31], v[36:39], 0
    v_fmac_f32 v255, v159, v159
    v_fmac_f32 v255, v160, v160
    v_mfma_f32_16x16x32_bf16 v[166:169], v[28:31], v[186:189], v[166:169]
    v_fmac_f32 v255, v161, v161
    v_add_u32 v6, s75, v6
    v_mfma_f32_16x16x32_bf16 v[174:177], v[162:165], v[36:39], 0
    v_rcp_f32 v183, v182
    v_mfma_f32_16x16x32_bf16 v[174:177], v[134:137], v[186:189], v[174:177]
    v_max3_u32 v25, v25, v183, v182
    v_max3_u32 v25, v25, v171, v170
    v_mfma_f32_16x16x32_bf16 v[170:173], v[210:213], v[36:39], 0
    v_rcp_f32 v167, v166
    v_mfma_f32_16x16x32_bf16 v[170:173], v[138:141], v[186:189], v[170:173]
    v_max3_u32 v25, v25, v167, v166
    v_mul_f32 v214, v183, v214
    v_mfma_f32_16x16x32_bf16 v[190:193], v[218:221], v[36:39], 0
    s_waitcnt lgkmcnt(1)
    v_mul_f32 v174, v167, v174
    v_mul_f32 v175, v167, v175
    v_mfma_f32_16x16x32_bf16 v[190:193], v[142:145], v[186:189], v[190:193]
    s_waitcnt lgkmcnt(0)
    v_cvt_pk_bf16_f32 v174, v174, v175
    v_mul_f32 v176, v167, v176
    v_mfma_f32_16x16x32_bf16 v[154:157], v[102:105], v[238:241], v[154:157]
    ds_read_b128 v[186:189], v0 offset:20480
    v_mul_f32 v177, v167, v177
    v_mfma_f32_16x16x32_bf16 v[154:157], v[106:109], v[118:121], v[154:157]
    ds_read_b128 v[194:197], v1 offset:20480
    v_cvt_pk_bf16_f32 v175, v176, v177
    v_mfma_f32_16x16x32_bf16 v[154:157], v[110:113], v[122:125], v[154:157]
    ds_read_b128 v[122:125], v0 offset:20608
    v_mul_f32 v170, v167, v170
    v_mfma_f32_16x16x32_bf16 v[118:121], v[146:149], v[28:31], 0
    ds_read_b128 v[202:205], v1 offset:20608
    v_mul_f32 v171, v167, v171
    v_mfma_f32_16x16x32_bf16 v[118:121], v[150:153], v[28:31], v[118:121]
    ds_read_b128 v[230:233], v0 offset:20736
    v_cvt_pk_bf16_f32 v176, v170, v171
    v_mfma_f32_16x16x32_bf16 v[234:237], v[146:149], v[134:137], 0
    ds_read_b128 v[238:241], v1 offset:20736
    v_fmac_f32 v255, v154, v154
    v_mfma_f32_16x16x32_bf16 v[234:237], v[150:153], v[162:165], v[234:237]
    v_fmac_f32 v255, v155, v155
    v_fmac_f32 v255, v156, v156
    v_mfma_f32_16x16x32_bf16 v[134:137], v[146:149], v[138:141], 0
    v_fmac_f32 v255, v157, v157
    v_cvt_pk_bf16_f32 v255, v255, v255
    v_mfma_f32_16x16x32_bf16 v[134:137], v[150:153], v[210:213], v[134:137]
    s_waitcnt lgkmcnt(5)
    ds_write_b64 v4, v[254:255] offset:18432
    v_mfma_f32_16x16x32_bf16 v[138:141], v[146:149], v[142:145], 0
    s_waitcnt lgkmcnt(4)
    v_mul_f32 v172, v167, v172
    v_mul_f32 v173, v167, v173
    v_mfma_f32_16x16x32_bf16 v[138:141], v[150:153], v[218:221], v[138:141]
    s_waitcnt lgkmcnt(3)
    v_cvt_pk_bf16_f32 v177, v172, v173
    v_mul_f32 v190, v167, v190
    v_mfma_f32_16x16x32_bf16 v[142:145], a[72:75], v[186:189], 0
    s_waitcnt lgkmcnt(2)
    ds_write_b128 v3, v[174:177] offset:12288
    v_mfma_f32_16x16x32_bf16 v[142:145], a[76:79], v[194:197], v[142:145]
    s_waitcnt lgkmcnt(2)
    v_mul_f32 v191, v167, v191
    v_cvt_pk_bf16_f32 v254, v190, v191
    v_mfma_f32_16x16x32_bf16 v[142:145], a[80:83], v[122:125], v[142:145]
    v_mul_f32 v192, v167, v192
    v_mul_f32 v193, v167, v193
    v_mfma_f32_16x16x32_bf16 v[142:145], a[84:87], v[202:205], v[142:145]
    v_cvt_pk_bf16_f32 v255, v192, v193
    v_mul_f32 v215, v183, v215
    v_mfma_f32_16x16x32_bf16 v[142:145], a[88:91], v[230:233], v[142:145]
    ds_write_b64 v4, v[254:255] offset:16384
    v_mfma_f32_16x16x32_bf16 v[142:145], a[92:95], v[238:241], v[142:145]
    v_rcp_f32_dpp v119, v118 quad_perm:[0,0,0,0] row_mask:0xf bank_mask:0xf
    v_mfma_f32_16x16x32_bf16 v[150:153], a[96:99], v[186:189], 0
    v_max3_u32 v25, v25, v118, v119
    v_mul_f32 v234, v234, v119
    v_mfma_f32_16x16x32_bf16 v[150:153], a[100:103], v[194:197], v[150:153]
    v_cvt_pk_bf16_f32 v118, v214, v215
    v_mul_f32_dpp v234, v134, v119 quad_perm:[0,1,2,3] row_mask:0x2 bank_mask:0xf
    v_mfma_f32_16x16x32_bf16 v[150:153], a[104:107], v[122:125], v[150:153]
    v_mul_f32 v216, v183, v216
    v_mul_f32_dpp v234, v138, v119 quad_perm:[0,1,2,3] row_mask:0x4 bank_mask:0xf
    v_mfma_f32_16x16x32_bf16 v[150:153], a[108:111], v[202:205], v[150:153]
    v_cvt_pk_bf16_f32 v234, v234, v234
    v_mul_f32 v217, v183, v217
    v_mfma_f32_16x16x32_bf16 v[150:153], a[112:115], v[230:233], v[150:153]
    ds_write_b16 v7, v234
    v_mfma_f32_16x16x32_bf16 v[150:153], a[116:119], v[238:241], v[150:153]
    v_cvt_pk_bf16_f32 v119, v216, v217
    v_mul_f32 v222, v183, v222
    v_mfma_f32_16x16x32_bf16 v[134:137], a[120:123], v[186:189], 0
    v_mul_f32 v223, v183, v223
    v_cvt_pk_bf16_f32 v120, v222, v223
    v_mfma_f32_16x16x32_bf16 v[134:137], a[124:127], v[194:197], v[134:137]
    v_mul_f32 v224, v183, v224
    v_mul_f32 v225, v183, v225
    v_mfma_f32_16x16x32_bf16 v[134:137], a[128:131], v[122:125], v[134:137]
    v_cvt_pk_bf16_f32 v121, v224, v225
    v_mul_f32 v226, v183, v226
    v_mfma_f32_16x16x32_bf16 v[134:137], a[132:135], v[202:205], v[134:137]
    ds_write_b128 v3, v[118:121] offset:0
    v_mfma_f32_16x16x32_bf16 v[134:137], a[136:139], v[230:233], v[134:137]
    v_mul_f32 v227, v183, v227
    v_cvt_pk_bf16_f32 v254, v226, v227
    v_mfma_f32_16x16x32_bf16 v[134:137], a[140:143], v[238:241], v[134:137]
    v_mul_f32 v228, v183, v228
    v_mul_f32 v229, v183, v229
    v_mfma_f32_16x16x32_bf16 v[138:141], a[0:3], v[186:189], 0
    v_cvt_pk_bf16_f32 v255, v228, v229
    v_xor_b32 v3, 65536, v3
    v_mfma_f32_16x16x32_bf16 v[138:141], a[4:7], v[194:197], v[138:141]
    ds_write_b64 v4, v[254:255] offset:4096
    v_mfma_f32_16x16x32_bf16 v[138:141], a[8:11], v[122:125], v[138:141]
    v_xor_b32 v4, 65536, v4
    v_add_u32 v7, s76, v7
    v_mfma_f32_16x16x32_bf16 v[138:141], a[12:15], v[202:205], v[138:141]
    v_cvt_pk_f16_f32 v146, v142, v143
    v_pk_mul_f16 v143, v146, v146
    v_mfma_f32_16x16x32_bf16 v[138:141], a[16:19], v[230:233], v[138:141]
    v_cvt_pk_f16_f32 v147, v144, v145
    v_pk_fma_f16 v143, v147, v147, v143
    v_mfma_f32_16x16x32_bf16 v[138:141], a[20:23], v[238:241], v[138:141]
    v_cvt_pk_f16_f32 v148, v150, v151
    v_pk_fma_f16 v143, v148, v148, v143
    v_mfma_f32_16x16x32_bf16 v[166:169], a[24:27], v[186:189], 0
    v_cvt_pk_f16_f32 v149, v152, v153
    v_pk_fma_f16 v143, v149, v149, v143
    v_mfma_f32_16x16x32_bf16 v[166:169], a[28:31], v[194:197], v[166:169]
    v_cvt_pk_f16_f32 v120, v134, v135
    v_pk_fma_f16 v143, v120, v120, v143
    v_mfma_f32_16x16x32_bf16 v[166:169], a[32:35], v[122:125], v[166:169]
    s_waitcnt lgkmcnt(0)
    v_cvt_pk_f16_f32 v121, v136, v137
    v_pk_fma_f16 v143, v121, v121, v143
    v_mfma_f32_16x16x32_bf16 v[166:169], a[36:39], v[202:205], v[166:169]
    s_nop 0
    v_mfma_f32_16x16x32_bf16 v[166:169], a[40:43], v[230:233], v[166:169]
    s_nop 0
    v_mfma_f32_16x16x32_bf16 v[166:169], a[44:47], v[238:241], v[166:169]
    s_nop 0
    v_mfma_f32_16x16x32_bf16 v[134:137], a[48:51], v[186:189], 0
    s_barrier
    v_mfma_f32_16x16x32_bf16 v[134:137], a[52:55], v[194:197], v[134:137]
    s_cbranch_scc1 L_loop_fast3
L_final_fast:
    v_mfma_f32_16x16x32_bf16 v[134:137], a[56:59], v[122:125], v[134:137]
    s_mov_b32 s12, s40
    ds_read_b128 v[150:153], v2 offset:18432
    ds_read_b128 v[162:165], v2 offset:19456
    v_mfma_f32_16x16x32_bf16 v[134:137], a[60:63], v[202:205], v[134:137]
    s_mov_b32 s13, s41
    ds_read_b128 v[170:173], v5 offset:32
    ds_read2_b64 v[174:177], v5 offset0:6 offset1:9
    v_mfma_f32_16x16x32_bf16 v[134:137], a[64:67], v[230:233], v[134:137]
    s_mov_b32 s14, s36
    v_cvt_pk_f16_f32 v138, v138, v139
    v_pk_mul_f16 v142, v138, v138
    v_mfma_f32_16x16x32_bf16 v[134:137], a[68:71], v[238:241], v[134:137]
    s_add_u32 s48, s40, s27
    ds_read_b128 v[182:185], v5
    ds_read_b32 v254, v6 offset:192
    v_mfma_f32_16x16x32_bf16 v[190:193], v[186:189], a[144:147], 0
    s_addc_u32 s49, s41, 0
    v_cvt_pk_f16_f32 v139, v140, v141
    v_pk_fma_f16 v142, v139, v139, v142
    v_mfma_f32_16x16x32_bf16 v[190:193], v[194:197], a[148:151], v[190:193]
    s_sub_u32 s50, s36, s27
    v_cvt_pk_f16_f32 v140, v166, v167
    v_pk_fma_f16 v142, v140, v140, v142
    v_mfma_f32_16x16x32_bf16 v[190:193], v[122:125], a[152:155], v[190:193]
    s_mov_b32 s51, 0x00020000
    v_cvt_pk_f16_f32 v141, v168, v169
    v_pk_fma_f16 v142, v141, v141, v142
    v_mfma_f32_16x16x32_bf16 v[190:193], v[202:205], a[156:159], v[190:193]
    s_add_u32 s52, s40, s26
    v_cvt_pk_f16_f32 v118, v134, v135
    v_pk_fma_f16 v142, v118, v118, v142
    v_mfma_f32_16x16x32_bf16 v[190:193], v[230:233], a[160:163], v[190:193]
    s_waitcnt lgkmcnt(4)
    v_cvt_pk_f16_f32 v119, v136, v137
    v_pk_fma_f16 v142, v119, v119, v142
    v_mfma_f32_16x16x32_bf16 v[134:137], v[32:35], v[150:153], 0
    s_waitcnt lgkmcnt(2)
    v_pk_mul_f16 v145, v146, v170
    v_pk_fma_f16 v145, v147, v171, v145
    v_mfma_f32_16x16x32_bf16 v[134:137], v[32:35], v[162:165], v[134:137]
    s_addc_u32 s53, s41, 0
    v_pk_fma_f16 v145, v148, v172, v145
    v_pk_fma_f16 v145, v149, v173, v145
    v_mfma_f32_16x16x32_bf16 v[190:193], v[238:241], a[164:167], v[190:193]
    s_waitcnt lgkmcnt(0)
    v_mov_b32_dpp v254, v23 quad_perm:[0,1,2,3] row_mask:0x7 bank_mask:0xf
    v_pk_fma_f16 v145, v120, v176, v145
    v_mfma_f32_16x16x32_bf16 v[150:153], v[186:189], a[168:171], 0
    s_sub_u32 s54, s36, s26
    v_mul_f32 v144, 0x3baaaaab, v135
    v_mul_f32 v255, 0x3baaaaab, v134
    v_mfma_f32_16x16x32_bf16 v[150:153], v[194:197], a[172:175], v[150:153]
    s_mov_b32 s55, 0x00020000
    v_rsq_f32 v144, v144
    v_mfma_f32_16x16x32_bf16 v[150:153], v[122:125], a[176:179], v[150:153]
    s_add_u32 s56, s40, s25
    v_mul_f32 v130, v144, v130
    v_mul_f32 v131, v144, v131
    v_mfma_f32_16x16x32_bf16 v[150:153], v[202:205], a[180:183], v[150:153]
    s_addc_u32 s57, s41, 0
    v_cvt_pk_bf16_f32 v130, v130, v131
    v_mul_f32 v132, v144, v132
    v_mfma_f32_16x16x32_bf16 v[150:153], v[230:233], a[184:187], v[150:153]
    s_sub_u32 s58, s36, s25
    ds_read_b128 v[162:165], v0 offset:26624
    v_mul_f32 v133, v144, v133
    v_mfma_f32_16x16x32_bf16 v[150:153], v[238:241], a[188:191], v[150:153]
    s_mov_b32 s59, 0x00020000
    ds_read_b128 v[166:169], v1 offset:26624
    v_cvt_pk_bf16_f32 v131, v132, v133
    v_mfma_f32_16x16x32_bf16 v[210:213], v[186:189], a[192:195], 0
    s_and_b32 s6, s2, 7
    ds_read_b128 v[186:189], v0 offset:26752
    v_mul_f32 v126, v144, v126
    v_mfma_f32_16x16x32_bf16 v[210:213], v[194:197], a[196:199], v[210:213]
    s_sub_u32 s6, 0, s6
    ds_read_b128 v[194:197], v1 offset:26752
    v_mul_f32 v127, v144, v127
    v_mfma_f32_16x16x32_bf16 v[210:213], v[122:125], a[200:203], v[210:213]
    s_lshl_b32 s3, s16, 6
    ds_read_b128 v[122:125], v0 offset:26880
    v_cvt_pk_bf16_f32 v132, v126, v127
    v_mfma_f32_16x16x32_bf16 v[210:213], v[202:205], a[204:207], v[210:213]
    s_lshl_b32 s4, s16, 5
    ds_read_b128 v[202:205], v1 offset:26880
    v_mul_f32 v128, v144, v128
    v_mfma_f32_16x16x32_bf16 v[210:213], v[230:233], a[208:211], v[210:213]
    s_add_u32 s4, s4, 256
    v_mul_f32 v129, v144, v129
    v_cvt_pk_bf16_f32 v133, v128, v129
    v_mfma_f32_16x16x32_bf16 v[210:213], v[238:241], a[212:215], v[210:213]
    s_mul_i32 s5, s16, 9408
    s_waitcnt lgkmcnt(5)
    ds_read_b128 v[126:129], v2 offset:0
    v_mfma_f32_16x16x32_bf16 v[214:217], a[72:75], v[162:165], 0
    s_add_u32 s5, s5, 104448
    ds_read_b128 v[218:221], v2 offset:1024
    ds_read_b128 v[222:225], v2 offset:2048
    v_mfma_f32_16x16x32_bf16 v[226:229], a[96:99], v[162:165], 0
    s_waitcnt lgkmcnt(7)
    ds_read_b128 v[230:233], v2 offset:3072
    buffer_store_dwordx4 v[130:133], v16, s[48:51], 0 offen nt
    ds_read_b128 v[234:237], v2 offset:4096
    v_mul_f32 v114, v144, v114
    v_mul_f32 v115, v144, v115
    v_cvt_pk_bf16_f32 v134, v114, v115
    v_mfma_f32_16x16x32_bf16 v[214:217], a[76:79], v[166:169], v[214:217]
    s_waitcnt lgkmcnt(7)
    ds_read_b128 v[130:133], v2 offset:5120
    v_mul_f32 v116, v144, v116
    v_mfma_f32_16x16x32_bf16 v[214:217], a[80:83], v[186:189], v[214:217]
    s_waitcnt lgkmcnt(7)
    v_mul_f32 v117, v144, v117
    v_cvt_pk_bf16_f32 v135, v116, v117
    v_mfma_f32_16x16x32_bf16 v[214:217], a[84:87], v[194:197], v[214:217]
    s_waitcnt lgkmcnt(6)
    v_rsq_f32 v255, v255
    v_mfma_f32_16x16x32_bf16 v[214:217], a[88:91], v[122:125], v[214:217]
    v_mul_f32 v178, v255, v178
    v_mul_f32 v179, v255, v179
    v_mfma_f32_16x16x32_bf16 v[214:217], a[92:95], v[202:205], v[214:217]
    s_waitcnt lgkmcnt(5)
    v_cvt_pk_bf16_f32 v114, v178, v179
    v_mul_f32 v180, v255, v180
    v_mfma_f32_16x16x32_bf16 v[226:229], a[100:103], v[166:169], v[226:229]
    s_waitcnt lgkmcnt(3)
    v_mul_f32 v181, v255, v181
    v_cvt_pk_bf16_f32 v115, v180, v181
    v_mfma_f32_16x16x32_bf16 v[178:181], a[216:219], v[126:129], 0
    s_waitcnt lgkmcnt(1)
    v_mul_f32 v198, v255, v198
    v_mul_f32 v199, v255, v199
    v_mfma_f32_16x16x32_bf16 v[178:181], a[220:223], v[218:221], v[178:181]
    v_cvt_pk_bf16_f32 v116, v198, v199
    v_mul_f32 v200, v255, v200
    v_mfma_f32_16x16x32_bf16 v[178:181], a[224:227], v[222:225], v[178:181]
    s_waitcnt lgkmcnt(0)
    v_mul_f32 v201, v255, v201
    v_cvt_pk_bf16_f32 v117, v200, v201
    v_mfma_f32_16x16x32_bf16 v[178:181], a[228:231], v[230:233], v[178:181]
    v_mul_f32 v206, v255, v206
    v_mul_f32 v207, v255, v207
    v_mfma_f32_16x16x32_bf16 v[178:181], a[232:235], v[234:237], v[178:181]
    v_cvt_pk_bf16_f32 v206, v206, v207
    v_mul_f32 v208, v255, v208
    v_mfma_f32_16x16x32_bf16 v[178:181], a[236:239], v[130:133], v[178:181]
    v_mul_f32 v209, v255, v209
    v_cvt_pk_bf16_f32 v207, v208, v209
    v_mfma_f32_16x16x32_bf16 v[198:201], a[240:243], v[126:129], 0
    v_pk_fma_f16 v145, v121, v177, v145
    v_pk_mul_f16 v144, v138, v182
    v_mfma_f32_16x16x32_bf16 v[198:201], a[244:247], v[218:221], v[198:201]
    v_pk_fma_f16 v144, v139, v183, v144
    v_pk_fma_f16 v144, v140, v184, v144
    v_mfma_f32_16x16x32_bf16 v[198:201], a[248:251], v[222:225], v[198:201]
    v_fma_f32 v255, v178, v178, s33
    v_fmac_f32 v255, v179, v179
    v_mfma_f32_16x16x32_bf16 v[198:201], a[252:255], v[230:233], v[198:201]
    buffer_store_dwordx2 v[134:135], v19, s[48:51], 0 offen nt
    v_fmac_f32 v255, v180, v180
    v_fmac_f32 v255, v181, v181
    v_mfma_f32_16x16x32_bf16 v[198:201], v[82:85], v[234:237], v[198:201]
    v_pk_fma_f16 v144, v141, v185, v144
    v_pk_fma_f16 v144, v118, v174, v144
    v_mfma_f32_16x16x32_bf16 v[198:201], v[86:89], v[130:133], v[198:201]
    v_pk_fma_f16 v144, v119, v175, v144
    v_cvt_pk_bf16_f32 v134, v190, v191
    v_mfma_f32_16x16x32_bf16 v[226:229], a[104:107], v[186:189], v[226:229]
    v_cvt_pk_bf16_f32 v135, v192, v193
    v_cvt_pk_bf16_f32 v150, v150, v151
    v_mfma_f32_16x16x32_f16 v[190:193], v[40:43], v[142:145], 0
    v_cvt_pk_bf16_f32 v151, v152, v153
    v_cvt_pk_bf16_f32 v142, v210, v211
    v_mfma_f32_16x16x32_bf16 v[238:241], v[90:93], v[126:129], 0
    v_fmac_f32 v255, v198, v198
    v_fmac_f32 v255, v199, v199
    v_mfma_f32_16x16x32_bf16 v[238:241], v[94:97], v[218:221], v[238:241]
    v_fmac_f32 v255, v200, v200
    v_fmac_f32 v255, v201, v201
    v_mfma_f32_16x16x32_bf16 v[238:241], v[98:101], v[222:225], v[238:241]
    v_rsq_f32 v190, v190
    v_mfma_f32_16x16x32_bf16 v[238:241], v[102:105], v[230:233], v[238:241]
    v_rsq_f32 v191, v191
    v_mfma_f32_16x16x32_bf16 v[238:241], v[106:109], v[234:237], v[238:241]
    v_mul_f32 v152, s31, v190
    v_cvt_pk_f16_f32 v153, v152, v191
    v_mfma_f32_16x16x32_bf16 v[238:241], v[110:113], v[130:133], v[238:241]
    v_cvt_pk_bf16_f32 v143, v212, v213
    v_fma_f32 v192, v192, v152, v22
    v_mfma_f32_16x16x32_bf16 v[226:229], a[108:111], v[194:197], v[226:229]
    v_fmac_f32_dpp v254, v193, v191 quad_perm:[0,1,2,3] row_mask:0x1 bank_mask:0xf
    v_pk_mul_f16 v146, v146, v153 op_sel:[0,1] op_sel_hi:[1,1]
    v_mfma_f32_16x16x32_bf16 v[226:229], a[112:115], v[122:125], v[226:229]
    v_pk_mul_f16 v147, v147, v153 op_sel:[0,1] op_sel_hi:[1,1]
    v_pk_mul_f16 v148, v148, v153 op_sel:[0,1] op_sel_hi:[1,1]
    v_mfma_f32_16x16x32_bf16 v[226:229], a[116:119], v[202:205], v[226:229]
    v_fmac_f32 v255, v238, v238
    v_fmac_f32 v255, v239, v239
    v_mfma_f32_16x16x32_bf16 v[126:129], a[120:123], v[162:165], 0
    v_fmac_f32 v255, v240, v240
    v_fmac_f32 v255, v241, v241
    v_mfma_f32_16x16x32_bf16 v[126:129], a[124:127], v[166:169], v[126:129]
    ds_read_b128 v[130:133], v2 offset:6144
    ds_read_b128 v[210:213], v2 offset:7168
    v_mfma_f32_16x16x32_bf16 v[126:129], a[128:131], v[186:189], v[126:129]
    ds_read_b128 v[218:221], v2 offset:8192
    ds_read_b128 v[222:225], v2 offset:9216
    v_mfma_f32_16x16x32_bf16 v[126:129], a[132:135], v[194:197], v[126:129]
    buffer_store_dwordx4 v[114:117], v15, s[48:51], 0 offen nt
    ds_read_b128 v[230:233], v2 offset:10240
    v_pk_mul_f16 v149, v149, v153 op_sel:[0,1] op_sel_hi:[1,1]
    v_pk_mul_f16 v120, v120, v153 op_sel:[0,1] op_sel_hi:[1,1]
    v_pk_mul_f16 v121, v121, v153 op_sel:[0,1] op_sel_hi:[1,1]
    v_mfma_f32_16x16x32_bf16 v[126:129], a[136:139], v[122:125], v[126:129]
    ds_read_b128 v[114:117], v2 offset:11264
    v_pk_mul_f16 v138, v138, v153 op_sel:[0,0] op_sel_hi:[1,0]
    v_mfma_f32_16x16x32_bf16 v[126:129], a[140:143], v[202:205], v[126:129]
    v_pk_mul_f16 v139, v139, v153 op_sel:[0,0] op_sel_hi:[1,0]
    v_pk_mul_f16 v140, v140, v153 op_sel:[0,0] op_sel_hi:[1,0]
    v_pk_mul_f16 v141, v141, v153 op_sel:[0,0] op_sel_hi:[1,0]
    v_pk_mul_f16 v118, v118, v153 op_sel:[0,0] op_sel_hi:[1,0]
    v_pk_mul_f16 v119, v119, v153 op_sel:[0,0] op_sel_hi:[1,0]
    v_mfma_f32_16x16x32_bf16 v[234:237], a[0:3], v[162:165], 0
    v_max3_u32 v44, v44, v190, v191
    v_cvt_pk_f16_f32 v214, v214, v215
    v_mfma_f32_16x16x32_bf16 v[234:237], a[4:7], v[166:169], v[234:237]
    s_waitcnt lgkmcnt(4)
    v_pk_mul_f16 v247, v214, v214
    v_cvt_pk_f16_f32 v215, v216, v217
    v_mfma_f32_16x16x32_bf16 v[234:237], a[8:11], v[186:189], v[234:237]
    s_waitcnt lgkmcnt(2)
    v_pk_fma_f16 v247, v215, v215, v247
    v_cvt_pk_f16_f32 v216, v226, v227
    v_mfma_f32_16x16x32_bf16 v[250:253], a[216:219], v[130:133], 0
    s_waitcnt lgkmcnt(1)
    v_pk_fma_f16 v247, v216, v216, v247
    v_cvt_pk_f16_f32 v217, v228, v229
    v_mfma_f32_16x16x32_bf16 v[250:253], a[220:223], v[210:213], v[250:253]
    v_pk_fma_f16 v247, v217, v217, v247
    v_cvt_pk_f16_f32 v208, v126, v127
    v_mfma_f32_16x16x32_bf16 v[250:253], a[224:227], v[218:221], v[250:253]
    s_waitcnt lgkmcnt(0)
    v_pk_fma_f16 v247, v208, v208, v247
    v_cvt_pk_f16_f32 v209, v128, v129
    v_mfma_f32_16x16x32_bf16 v[250:253], a[228:231], v[222:225], v[250:253]
    v_pk_fma_f16 v247, v209, v209, v247
    v_pk_mul_f16 v249, v214, v170
    v_mfma_f32_16x16x32_bf16 v[250:253], a[232:235], v[230:233], v[250:253]
    v_pk_fma_f16 v249, v215, v171, v249
    v_pk_fma_f16 v249, v216, v172, v249
    v_mfma_f32_16x16x32_bf16 v[250:253], a[236:239], v[114:117], v[250:253]
    v_pk_fma_f16 v249, v217, v173, v249
    v_pk_fma_f16 v249, v208, v176, v249
    v_mfma_f32_16x16x32_bf16 v[234:237], a[12:15], v[194:197], v[234:237]
    v_pk_fma_f16 v249, v209, v177, v249
    v_mul_f32 v136, 0x3baaaaab, v136
    v_mfma_f32_16x16x32_bf16 v[234:237], a[16:19], v[122:125], v[234:237]
    v_rsq_f32 v136, v136
    v_mfma_f32_16x16x32_bf16 v[234:237], a[20:23], v[202:205], v[234:237]
    buffer_store_dwordx2 v[206:207], v18, s[48:51], 0 offen nt
    v_fma_f32 v137, v250, v250, s33
    v_fmac_f32 v137, v251, v251
    v_fmac_f32 v137, v252, v252
    v_fmac_f32 v137, v253, v253
    v_mul_f32 v242, v136, v242
    v_mul_f32 v243, v136, v243
    v_cvt_pk_bf16_f32 v126, v242, v243
    v_mfma_f32_16x16x32_bf16 v[226:229], a[240:243], v[130:133], 0
    v_cvt_pk_f16_f32 v190, v234, v235
    v_pk_mul_f16 v246, v190, v190
    v_mfma_f32_16x16x32_bf16 v[226:229], a[244:247], v[210:213], v[226:229]
    v_cvt_pk_f16_f32 v191, v236, v237
    v_pk_fma_f16 v246, v191, v191, v246
    v_mfma_f32_16x16x32_bf16 v[226:229], a[248:251], v[218:221], v[226:229]
    v_pk_mul_f16 v248, v190, v182
    v_pk_fma_f16 v248, v191, v183, v248
    v_mfma_f32_16x16x32_bf16 v[226:229], a[252:255], v[222:225], v[226:229]
    v_mul_f32 v244, v136, v244
    v_mul_f32 v245, v136, v245
    v_mfma_f32_16x16x32_bf16 v[226:229], v[82:85], v[230:233], v[226:229]
    v_cvt_pk_bf16_f32 v127, v244, v245
    v_mul_f32 v158, v136, v158
    v_mfma_f32_16x16x32_bf16 v[226:229], v[86:89], v[114:117], v[226:229]
    v_mul_f32 v159, v136, v159
    v_cvt_pk_bf16_f32 v128, v158, v159
    v_mul_f32 v160, v136, v160
    v_mul_f32 v161, v136, v161
    v_cvt_pk_bf16_f32 v129, v160, v161
    v_mul_f32 v154, v136, v154
    v_mul_f32 v155, v136, v155
    v_cvt_pk_bf16_f32 v144, v154, v155
    v_mfma_f32_16x16x32_bf16 v[158:161], v[90:93], v[130:133], 0
    v_fmac_f32 v137, v226, v226
    v_fmac_f32 v137, v227, v227
    v_mfma_f32_16x16x32_bf16 v[158:161], v[94:97], v[210:213], v[158:161]
    v_fmac_f32 v137, v228, v228
    v_fmac_f32 v137, v229, v229
    v_mfma_f32_16x16x32_bf16 v[158:161], v[98:101], v[218:221], v[158:161]
    v_mul_f32 v156, v136, v156
    v_mul_f32 v157, v136, v157
    v_mfma_f32_16x16x32_bf16 v[158:161], v[102:105], v[222:225], v[158:161]
    v_cvt_pk_bf16_f32 v145, v156, v157
    v_bfe_u32 v130, v2, 4, 6
    v_mfma_f32_16x16x32_bf16 v[158:161], v[106:109], v[230:233], v[158:161]
    v_lshrrev_b32 v131, 4, v130
    v_and_b32 v132, 15, v130
    v_mfma_f32_16x16x32_bf16 v[158:161], v[110:113], v[114:117], v[158:161]
    v_lshlrev_b32 v133, 9, v131
    v_lshl_add_u32 v133, v132, 4, v133
    v_mfma_f32_16x16x32_bf16 v[114:117], a[24:27], v[162:165], 0
    buffer_store_dwordx4 v[126:129], v17, s[48:51], 0 offen nt
    v_add_u32 v133, 149696, v133
    v_and_b32 v154, 0xffff, v2
    v_add_u32 v154, 38912, v154
    v_and_b32 v155, 0xffff, v4
    v_mfma_f32_16x16x32_bf16 v[114:117], a[28:31], v[166:169], v[114:117]
    v_fmac_f32 v137, v158, v158
    v_fmac_f32 v137, v159, v159
    v_mfma_f32_16x16x32_bf16 v[114:117], a[32:35], v[186:189], v[114:117]
    v_fmac_f32 v137, v160, v160
    v_fmac_f32 v137, v161, v161
    v_mfma_f32_16x16x32_bf16 v[114:117], a[36:39], v[194:197], v[114:117]
    v_cvt_pk_bf16_f32 v136, v255, v137
    v_cvt_pk_bf16_f32 v137, v137, v137
    v_mfma_f32_16x16x32_bf16 v[114:117], a[40:43], v[122:125], v[114:117]
    v_add_u32 v155, 38912, v155
    v_mov_b32 v255, 0x40000000
    v_mfma_f32_16x16x32_bf16 v[114:117], a[44:47], v[202:205], v[114:117]
    ds_write_b64 v155, v[136:137] offset:0
    v_mfma_f32_16x16x32_bf16 v[126:129], a[48:51], v[162:165], 0
    v_exp_f32 v192, v192
    v_mfma_f32_16x16x32_bf16 v[126:129], a[52:55], v[166:169], v[126:129]
    v_cvt_pk_bf16_f32 v39, v192, 0
    v_add_u32 v136, 0, v132
    v_mfma_f32_16x16x32_bf16 v[126:129], a[56:59], v[186:189], v[126:129]
    v_mul_u32_u24 v137, s20, v136
    v_cvt_pk_f16_f32 v192, v114, v115
    v_mfma_f32_16x16x32_bf16 v[126:129], a[60:63], v[194:197], v[126:129]
    v_pk_fma_f16 v246, v192, v192, v246
    v_cvt_pk_f16_f32 v193, v116, v117
    v_mfma_f32_16x16x32_bf16 v[126:129], a[64:67], v[122:125], v[126:129]
    v_pk_fma_f16 v246, v193, v193, v246
    v_pk_fma_f16 v248, v192, v184, v248
    v_mfma_f32_16x16x32_bf16 v[126:129], a[68:71], v[202:205], v[126:129]
    v_pk_fma_f16 v248, v193, v185, v248
    v_add_u32 v137, s38, v137
    v_mfma_f32_16x16x32_bf16 v[114:117], v[162:165], a[144:147], 0
    s_waitcnt lgkmcnt(0)
    v_mul_u32_u24 v152, 911, v137
    v_lshrrev_b32 v152, 16, v152
    v_mfma_f32_16x16x32_bf16 v[114:117], v[166:169], a[148:151], v[114:117]
    s_barrier
    ds_read_b128 v[210:213], v154 offset:0
    ds_read_b128 v[218:221], v154 offset:1024
    v_mfma_f32_16x16x32_bf16 v[114:117], v[186:189], a[152:155], v[114:117]
    v_cvt_pk_f16_f32 v206, v126, v127
    v_pk_fma_f16 v246, v206, v206, v246
    v_mfma_f32_16x16x32_bf16 v[114:117], v[194:197], a[156:159], v[114:117]
    buffer_store_dwordx2 v[144:145], v20, s[48:51], 0 offen nt
    v_cvt_pk_f16_f32 v207, v128, v129
    v_pk_fma_f16 v246, v207, v207, v246
    v_mfma_f32_16x16x32_bf16 v[114:117], v[122:125], a[160:163], v[114:117]
    v_pk_fma_f16 v248, v206, v174, v248
    v_pk_fma_f16 v248, v207, v175, v248
    v_mfma_f32_16x16x32_bf16 v[114:117], v[202:205], a[164:167], v[114:117]
    v_mul_u32_u24 v152, s22, v152
    v_mad_u32_u24 v152, v136, s21, v152
    v_mfma_f32_16x16x32_f16 v[126:129], v[40:43], v[246:249], 0
    v_bfe_u32 v137, s70, v136, 1
    v_cmp_ne_u32 vcc, 0, v137
    v_mfma_f32_16x16x32_bf16 v[222:225], v[162:165], a[168:171], 0
    v_add_u32 v156, s7, v152
    v_cndmask_b32 v156, v255, v156, vcc
    v_mfma_f32_16x16x32_bf16 v[222:225], v[166:169], a[172:175], v[222:225]
    s_waitcnt lgkmcnt(1)
    v_cvt_pk_bf16_f32 v136, v114, v115
    v_cvt_pk_bf16_f32 v137, v116, v117
    v_mfma_f32_16x16x32_bf16 v[114:117], v[32:35], v[210:213], 0
    s_waitcnt lgkmcnt(0)
    v_rsq_f32 v126, v126
    v_mfma_f32_16x16x32_bf16 v[114:117], v[32:35], v[218:221], v[114:117]
    v_rsq_f32 v127, v127
    v_mfma_f32_16x16x32_bf16 v[222:225], v[186:189], a[176:179], v[222:225]
    v_mul_f32 v210, s31, v126
    v_cvt_pk_f16_f32 v211, v210, v127
    v_mfma_f32_16x16x32_bf16 v[222:225], v[194:197], a[180:183], v[222:225]
    v_fma_f32 v128, v128, v210, v24
    v_fmac_f32_dpp v254, v129, v127 quad_perm:[0,1,2,3] row_mask:0x2 bank_mask:0xf
    v_mfma_f32_16x16x32_bf16 v[222:225], v[122:125], a[184:187], v[222:225]
    ds_read_b128 v[218:221], v0 offset:32768
    v_mul_f32 v129, 0x3baaaaab, v115
    v_mfma_f32_16x16x32_bf16 v[222:225], v[202:205], a[188:191], v[222:225]
    ds_read_b128 v[230:233], v1 offset:32768
    v_pk_mul_f16 v214, v214, v211 op_sel:[0,1] op_sel_hi:[1,1]
    v_mfma_f32_16x16x32_bf16 v[234:237], v[162:165], a[192:195], 0
    ds_read_b128 v[162:165], v0 offset:32896
    v_pk_mul_f16 v215, v215, v211 op_sel:[0,1] op_sel_hi:[1,1]
    v_mfma_f32_16x16x32_bf16 v[234:237], v[166:169], a[196:199], v[234:237]
    ds_read_b128 v[166:169], v1 offset:32896
    v_pk_mul_f16 v216, v216, v211 op_sel:[0,1] op_sel_hi:[1,1]
    v_mfma_f32_16x16x32_bf16 v[234:237], v[186:189], a[200:203], v[234:237]
    ds_read_b128 v[186:189], v0 offset:33024
    v_cvt_pk_bf16_f32 v152, v222, v223
    v_mfma_f32_16x16x32_bf16 v[234:237], v[194:197], a[204:207], v[234:237]
    ds_read_b128 v[194:197], v1 offset:33024
    v_cvt_pk_bf16_f32 v153, v224, v225
    v_mfma_f32_16x16x32_bf16 v[234:237], v[122:125], a[208:211], v[234:237]
    v_rsq_f32 v129, v129
    v_mfma_f32_16x16x32_bf16 v[234:237], v[202:205], a[212:215], v[234:237]
    v_mul_f32 v250, v129, v250
    v_mul_f32 v251, v129, v251
    v_mfma_f32_16x16x32_f16 v[122:125], v[146:149], v[138:141], v[46:49]
    s_waitcnt lgkmcnt(5)
    v_cvt_pk_bf16_f32 v202, v250, v251
    v_mul_f32 v252, v129, v252
    v_mfma_f32_16x16x32_bf16 v[222:225], a[72:75], v[218:221], 0
    s_waitcnt lgkmcnt(4)
    v_mul_f32 v253, v129, v253
    v_cvt_pk_bf16_f32 v203, v252, v253
    v_mfma_f32_16x16x32_bf16 v[222:225], a[76:79], v[230:233], v[222:225]
    s_waitcnt lgkmcnt(3)
    v_mul_f32 v226, v129, v226
    v_mul_f32 v227, v129, v227
    v_mfma_f32_16x16x32_bf16 v[222:225], a[80:83], v[162:165], v[222:225]
    s_waitcnt lgkmcnt(2)
    v_cvt_pk_bf16_f32 v204, v226, v227
    v_mul_f32 v228, v129, v228
    v_mfma_f32_16x16x32_bf16 v[222:225], a[84:87], v[166:169], v[222:225]
    s_waitcnt lgkmcnt(1)
    v_mul_f32 v229, v129, v229
    v_cvt_pk_bf16_f32 v205, v228, v229
    v_mfma_f32_16x16x32_bf16 v[222:225], a[88:91], v[186:189], v[222:225]
    s_waitcnt lgkmcnt(0)
    buffer_store_dwordx4 v[202:205], v16, s[52:55], 0 offen nt
    v_mul_f32 v158, v129, v158
    v_mul_f32 v159, v129, v159
    v_cvt_pk_bf16_f32 v116, v158, v159
    v_mul_f32 v160, v129, v160
    v_mfma_f32_16x16x32_bf16 v[222:225], a[92:95], v[194:197], v[222:225]
    v_mul_f32 v161, v129, v161
    v_cvt_pk_bf16_f32 v117, v160, v161
    v_mfma_f32_16x16x32_bf16 v[158:161], a[96:99], v[218:221], 0
    v_cvt_pk_bf16_f32 v144, v234, v235
    v_cvt_pk_bf16_f32 v145, v236, v237
    v_mfma_f32_16x16x32_bf16 v[158:161], a[100:103], v[230:233], v[158:161]
    v_pk_mul_f16 v217, v217, v211 op_sel:[0,1] op_sel_hi:[1,1]
    v_pk_mul_f16 v208, v208, v211 op_sel:[0,1] op_sel_hi:[1,1]
    v_mfma_f32_16x16x32_bf16 v[158:161], a[104:107], v[162:165], v[158:161]
    v_pk_mul_f16 v209, v209, v211 op_sel:[0,1] op_sel_hi:[1,1]
    v_pk_mul_f16 v190, v190, v211 op_sel:[0,0] op_sel_hi:[1,0]
    v_mfma_f32_16x16x32_bf16 v[158:161], a[108:111], v[166:169], v[158:161]
    v_pk_mul_f16 v191, v191, v211 op_sel:[0,0] op_sel_hi:[1,0]
    v_pk_mul_f16 v192, v192, v211 op_sel:[0,0] op_sel_hi:[1,0]
    v_mfma_f32_16x16x32_bf16 v[158:161], a[112:115], v[186:189], v[158:161]
    v_pk_mul_f16 v193, v193, v211 op_sel:[0,0] op_sel_hi:[1,0]
    v_pk_mul_f16 v206, v206, v211 op_sel:[0,0] op_sel_hi:[1,0]
    v_mfma_f32_16x16x32_bf16 v[158:161], a[116:119], v[194:197], v[158:161]
    v_pk_mul_f16 v207, v207, v211 op_sel:[0,0] op_sel_hi:[1,0]
    v_max3_u32 v44, v44, v126, v127
    v_mfma_f32_16x16x32_bf16 v[202:205], a[120:123], v[218:221], 0
    v_mul_f32 v157, 0x3baaaaab, v114
    v_cvt_pk_f16_f32 v114, v222, v223
    v_mfma_f32_16x16x32_bf16 v[202:205], a[124:127], v[230:233], v[202:205]
    v_rsq_f32 v157, v157
    v_mfma_f32_16x16x32_bf16 v[202:205], a[128:131], v[162:165], v[202:205]
    v_mul_f32 v178, v157, v178
    v_mul_f32 v179, v157, v179
    v_mfma_f32_16x16x32_bf16 v[202:205], a[132:135], v[166:169], v[202:205]
    v_cvt_pk_bf16_f32 v178, v178, v179
    v_mul_f32 v180, v157, v180
    v_mfma_f32_16x16x32_bf16 v[202:205], a[136:139], v[186:189], v[202:205]
    v_mul_f32 v181, v157, v181
    v_cvt_pk_bf16_f32 v179, v180, v181
    v_mfma_f32_16x16x32_bf16 v[202:205], a[140:143], v[194:197], v[202:205]
    v_mul_f32 v198, v157, v198
    v_mul_f32 v199, v157, v199
    v_mfma_f32_16x16x32_bf16 v[210:213], a[0:3], v[218:221], 0
    v_cvt_pk_bf16_f32 v180, v198, v199
    v_mul_f32 v200, v157, v200
    v_mfma_f32_16x16x32_bf16 v[210:213], a[4:7], v[230:233], v[210:213]
    v_mul_f32 v201, v157, v201
    v_cvt_pk_bf16_f32 v181, v200, v201
    v_mfma_f32_16x16x32_bf16 v[210:213], a[8:11], v[162:165], v[210:213]
    buffer_store_dwordx2 v[116:117], v19, s[52:55], 0 offen nt
    v_mul_f32 v238, v157, v238
    v_mul_f32 v239, v157, v239
    v_mfma_f32_16x16x32_bf16 v[210:213], a[12:15], v[166:169], v[210:213]
    v_cvt_pk_bf16_f32 v126, v238, v239
    v_mul_f32 v240, v157, v240
    v_mfma_f32_16x16x32_bf16 v[210:213], a[16:19], v[186:189], v[210:213]
    v_mul_f32 v241, v157, v241
    v_cvt_pk_bf16_f32 v127, v240, v241
    v_mfma_f32_16x16x32_bf16 v[210:213], a[20:23], v[194:197], v[210:213]
    v_pk_mul_f16 v199, v114, v114
    v_cvt_pk_f16_f32 v115, v224, v225
    v_mfma_f32_16x16x32_bf16 v[222:225], a[24:27], v[218:221], 0
    v_pk_fma_f16 v199, v115, v115, v199
    v_cvt_pk_f16_f32 v116, v158, v159
    v_mfma_f32_16x16x32_f16 v[226:229], v[214:217], v[138:141], v[50:53]
    v_pk_fma_f16 v199, v116, v116, v199
    v_cvt_pk_f16_f32 v117, v160, v161
    v_cvt_pk_f16_f32 v158, v210, v211
    v_mfma_f32_16x16x16_f16 v[122:125], v[120:121], v[118:119], v[122:125]
    v_pk_mul_f16 v198, v158, v158
    v_cvt_pk_f16_f32 v159, v212, v213
    v_pk_fma_f16 v198, v159, v159, v198
    v_mfma_f32_16x16x16_f16 v[226:229], v[208:209], v[118:119], v[226:229]
    v_pk_mul_f16 v200, v158, v182
    v_pk_fma_f16 v200, v159, v183, v200
    v_pk_fma_f16 v199, v117, v117, v199
    v_cvt_pk_f16_f32 v212, v202, v203
    v_mfma_f32_16x16x32_bf16 v[222:225], a[28:31], v[230:233], v[222:225]
    v_pk_fma_f16 v199, v212, v212, v199
    v_cvt_pk_f16_f32 v213, v204, v205
    v_mfma_f32_16x16x32_bf16 v[222:225], a[32:35], v[162:165], v[222:225]
    v_pk_fma_f16 v199, v213, v213, v199
    v_pk_mul_f16 v201, v114, v170
    v_mfma_f32_16x16x32_bf16 v[222:225], a[36:39], v[166:169], v[222:225]
    v_pk_fma_f16 v201, v115, v171, v201
    v_pk_fma_f16 v201, v116, v172, v201
    v_mfma_f32_16x16x32_bf16 v[222:225], a[40:43], v[186:189], v[222:225]
    v_pk_fma_f16 v201, v117, v173, v201
    v_pk_fma_f16 v201, v212, v176, v201
    v_mfma_f32_16x16x32_bf16 v[222:225], a[44:47], v[194:197], v[222:225]
    v_pk_fma_f16 v201, v213, v177, v201
    v_lshl_add_u32 v157, v131, 4, v156
    v_mfma_f32_16x16x32_bf16 v[170:173], a[48:51], v[218:221], 0
    v_exp_f32 v122, v122
    v_mfma_f32_16x16x32_bf16 v[170:173], a[52:55], v[230:233], v[170:173]
    v_exp_f32 v123, v123
    v_mfma_f32_16x16x32_bf16 v[170:173], a[56:59], v[162:165], v[170:173]
    v_cvt_pk_bf16_f32 v122, v122, v123
    v_cvt_pk_f16_f32 v160, v222, v223
    v_mfma_f32_16x16x32_bf16 v[170:173], a[60:63], v[166:169], v[170:173]
    buffer_store_dwordx4 v[178:181], v15, s[52:55], 0 offen nt
    v_pk_fma_f16 v198, v160, v160, v198
    v_cvt_pk_f16_f32 v161, v224, v225
    v_pk_fma_f16 v198, v161, v161, v198
    v_pk_fma_f16 v200, v160, v184, v200
    v_mfma_f32_16x16x32_bf16 v[170:173], a[64:67], v[186:189], v[170:173]
    v_pk_fma_f16 v200, v161, v185, v200
    v_add_u32 v157, s3, v157
    v_mfma_f32_16x16x32_bf16 v[170:173], a[68:71], v[194:197], v[170:173]
    ds_read2_b32 v[176:177], v6 offset0:0 offset1:0
    ds_read2_b32 v[180:181], v6 offset0:16 offset1:16
    v_mfma_f32_16x16x32_bf16 v[182:185], v[218:221], a[144:147], 0
    ds_read2_b32 v[204:205], v6 offset0:32 offset1:32
    v_lshl_add_u32 v156, v131, 3, v156
    v_mfma_f32_16x16x32_bf16 v[182:185], v[230:233], a[148:151], v[182:185]
    v_exp_f32 v124, v124
    v_mfma_f32_16x16x32_bf16 v[182:185], v[162:165], a[152:155], v[182:185]
    v_cvt_pk_f16_f32 v210, v170, v171
    v_pk_fma_f16 v198, v210, v210, v198
    v_mfma_f32_16x16x32_bf16 v[182:185], v[166:169], a[156:159], v[182:185]
    v_cvt_pk_f16_f32 v211, v172, v173
    v_pk_fma_f16 v198, v211, v211, v198
    v_mfma_f32_16x16x32_bf16 v[182:185], v[186:189], a[160:163], v[182:185]
    v_pk_fma_f16 v200, v210, v174, v200
    v_pk_fma_f16 v200, v211, v175, v200
    v_mfma_f32_16x16x32_bf16 v[182:185], v[194:197], a[164:167], v[182:185]
    v_exp_f32 v125, v125
    v_mfma_f32_16x16x32_f16 v[170:173], v[40:43], v[198:201], 0
    v_cvt_pk_bf16_f32 v123, v124, v125
    v_add_u32 v156, s4, v156
    v_mfma_f32_16x16x32_bf16 v[198:201], v[218:221], a[168:171], 0
    s_waitcnt lgkmcnt(1)
    v_exp_f32 v226, v226
    v_mfma_f32_16x16x32_bf16 v[198:201], v[230:233], a[172:175], v[198:201]
    s_waitcnt lgkmcnt(0)
    v_cvt_pk_bf16_f32 v174, v182, v183
    v_cvt_pk_bf16_f32 v175, v184, v185
    v_mfma_f32_16x16x32_bf16 v[198:201], v[162:165], a[176:179], v[198:201]
    v_rsq_f32 v170, v170
    v_mfma_f32_16x16x32_bf16 v[198:201], v[166:169], a[180:183], v[198:201]
    ds_read_b128 v[182:185], v2 offset:12288
    ds_read_b128 v[222:225], v2 offset:13312
    v_mfma_f32_16x16x32_bf16 v[198:201], v[186:189], a[184:187], v[198:201]
    ds_read_b128 v[234:237], v2 offset:14336
    ds_read_b128 v[238:241], v2 offset:15360
    v_mfma_f32_16x16x32_bf16 v[198:201], v[194:197], a[188:191], v[198:201]
    buffer_store_dwordx2 v[126:127], v18, s[52:55], 0 offen nt
    ds_read_b128 v[242:245], v2 offset:16384
    v_rsq_f32 v171, v171
    v_mul_f32 v124, s31, v170
    v_cvt_pk_f16_f32 v125, v124, v171
    v_fma_f32 v172, v172, v124, v26
    v_fmac_f32_dpp v254, v173, v171 quad_perm:[0,1,2,3] row_mask:0x4 bank_mask:0xf
    v_pk_mul_f16 v114, v114, v125 op_sel:[0,1] op_sel_hi:[1,1]
    v_cvt_pk_bf16_f32 v178, v198, v199
    v_cvt_pk_bf16_f32 v179, v200, v201
    v_pk_mul_f16 v115, v115, v125 op_sel:[0,1] op_sel_hi:[1,1]
    v_pk_mul_f16 v116, v116, v125 op_sel:[0,1] op_sel_hi:[1,1]
    v_pk_mul_f16 v117, v117, v125 op_sel:[0,1] op_sel_hi:[1,1]
    v_pk_mul_f16 v212, v212, v125 op_sel:[0,1] op_sel_hi:[1,1]
    v_pk_mul_f16 v213, v213, v125 op_sel:[0,1] op_sel_hi:[1,1]
    v_pk_mul_f16 v158, v158, v125 op_sel:[0,0] op_sel_hi:[1,0]
    v_pk_mul_f16 v159, v159, v125 op_sel:[0,0] op_sel_hi:[1,0]
    v_pk_mul_f16 v160, v160, v125 op_sel:[0,0] op_sel_hi:[1,0]
    v_pk_mul_f16 v161, v161, v125 op_sel:[0,0] op_sel_hi:[1,0]
    v_pk_mul_f16 v210, v210, v125 op_sel:[0,0] op_sel_hi:[1,0]
    v_pk_mul_f16 v211, v211, v125 op_sel:[0,0] op_sel_hi:[1,0]
    v_mfma_f32_16x16x32_f16 v[198:201], v[114:117], v[138:141], v[54:57]
    s_waitcnt lgkmcnt(2)
    ds_read_b128 v[138:141], v2 offset:17408
    v_max3_u32 v44, v44, v170, v171
    v_exp_f32 v227, v227
    v_exp_f32 v228, v228
    v_cvt_pk_bf16_f32 v124, v226, v227
    v_mfma_f32_16x16x16_f16 v[198:201], v[212:213], v[118:119], v[198:201]
    v_exp_f32 v229, v229
    v_sub_u32 v170, 0x40800000, v44
    v_cvt_pk_bf16_f32 v125, v228, v229
    v_mfma_f32_16x16x32_bf16 v[226:229], v[218:221], a[192:195], 0
    s_waitcnt lgkmcnt(1)
    v_or_b32 v170, v170, v44
    v_xor_b32 v171, 65536, v2
    v_mfma_f32_16x16x32_bf16 v[226:229], v[230:233], a[196:199], v[226:229]
    v_exp_f32 v198, v198
    v_mfma_f32_16x16x32_bf16 v[226:229], v[162:165], a[200:203], v[226:229]
    v_exp_f32 v199, v199
    v_mfma_f32_16x16x32_bf16 v[226:229], v[166:169], a[204:207], v[226:229]
    v_cvt_pk_bf16_f32 v36, v198, v199
    v_bfe_u32 v173, v132, 1, 2
    v_mfma_f32_16x16x32_bf16 v[226:229], v[186:189], a[208:211], v[226:229]
    s_waitcnt lgkmcnt(0)
    v_exp_f32 v200, v200
    v_mfma_f32_16x16x32_bf16 v[226:229], v[194:197], a[212:215], v[226:229]
    v_exp_f32 v201, v201
    v_mfma_f32_16x16x32_f16 v[162:165], v[146:149], v[190:193], v[58:61]
    v_cvt_pk_bf16_f32 v37, v200, v201
    v_xor_b32 v173, v173, v131
    v_mfma_f32_16x16x32_f16 v[166:169], v[214:217], v[190:193], v[62:65]
    v_exp_f32 v254, v254
    v_mfma_f32_16x16x32_bf16 v[186:189], v[28:31], v[36:39], 0
    v_cvt_pk_bf16_f32 v254, v254, v254
    v_cvt_pk_bf16_f32 v202, v226, v227
    v_mfma_f32_16x16x32_bf16 v[186:189], v[28:31], v[122:125], v[186:189]
    ds_write_b16 v8, v254
    v_mfma_f32_16x16x32_bf16 v[194:197], v[174:177], v[36:39], 0
    v_cvt_pk_bf16_f32 v203, v228, v229
    v_lshl_add_u32 v173, v132, 2, v173
    v_mfma_f32_16x16x32_bf16 v[194:197], v[134:137], v[122:125], v[194:197]
    ds_read_b128 v[198:201], v9
    ds_read_b128 v[218:221], v9 offset:64
    v_mfma_f32_16x16x32_bf16 v[226:229], v[178:181], v[36:39], 0
    v_exp_f32 v128, v128
    v_mfma_f32_16x16x32_bf16 v[226:229], v[150:153], v[122:125], v[226:229]
    v_exp_f32 v172, v172
    v_mfma_f32_16x16x32_bf16 v[230:233], v[202:205], v[36:39], 0
    v_cvt_pk_bf16_f32 v39, v128, 0
    v_lshl_add_u32 v254, v173, 4, s5
    v_mfma_f32_16x16x32_bf16 v[230:233], v[142:145], v[122:125], v[230:233]
    v_rcp_f32 v187, v186
    v_mfma_f32_16x16x32_f16 v[122:125], v[114:117], v[190:193], v[66:69]
    v_max3_u32 v25, v25, v187, v186
    v_mul_f32 v194, v187, v194
    v_mul_f32 v195, v187, v195
    v_mfma_f32_16x16x16_f16 v[162:165], v[120:121], v[206:207], v[162:165]
    v_cvt_pk_bf16_f32 v126, v194, v195
    v_mul_f32 v196, v187, v196
    v_mul_f32 v197, v187, v197
    v_mfma_f32_16x16x16_f16 v[166:169], v[208:209], v[206:207], v[166:169]
    v_cvt_pk_bf16_f32 v127, v196, v197
    v_mul_f32 v226, v187, v226
    v_mul_f32 v227, v187, v227
    v_mfma_f32_16x16x16_f16 v[122:125], v[212:213], v[206:207], v[122:125]
    v_exp_f32 v162, v162
    v_exp_f32 v163, v163
    v_mfma_f32_16x16x32_bf16 v[190:193], a[216:219], v[182:185], 0
    s_waitcnt lgkmcnt(0)
    v_cvt_pk_bf16_f32 v162, v162, v163
    v_cvt_pk_bf16_f32 v128, v226, v227
    v_mfma_f32_16x16x32_bf16 v[190:193], a[220:223], v[222:225], v[190:193]
    v_exp_f32 v164, v164
    v_mfma_f32_16x16x32_bf16 v[190:193], a[224:227], v[234:237], v[190:193]
    v_exp_f32 v165, v165
    v_mfma_f32_16x16x32_bf16 v[190:193], a[228:231], v[238:241], v[190:193]
    v_cvt_pk_bf16_f32 v163, v164, v165
    v_mul_f32 v228, v187, v228
    v_mfma_f32_16x16x32_bf16 v[190:193], a[232:235], v[242:245], v[190:193]
    v_exp_f32 v166, v166
    v_mfma_f32_16x16x32_f16 v[194:197], v[146:149], v[158:161], v[70:73]
    v_exp_f32 v167, v167
    v_mfma_f32_16x16x32_f16 v[146:149], v[214:217], v[158:161], v[74:77]
    v_cvt_pk_bf16_f32 v164, v166, v167
    v_mul_f32 v229, v187, v229
    v_mfma_f32_16x16x32_f16 v[214:217], v[114:117], v[158:161], v[78:81]
    v_exp_f32 v168, v168
    v_cvt_pk_bf16_f32 v129, v228, v229
    v_mfma_f32_16x16x16_f16 v[194:197], v[120:121], v[210:211], v[194:197]
    v_exp_f32 v169, v169
    v_mul_f32 v230, v187, v230
    v_mfma_f32_16x16x16_f16 v[146:149], v[208:209], v[210:211], v[146:149]
    v_cvt_pk_bf16_f32 v165, v168, v169
    v_exp_f32 v122, v122
    v_mfma_f32_16x16x16_f16 v[214:217], v[212:213], v[210:211], v[214:217]
    v_exp_f32 v123, v123
    v_exp_f32 v124, v124
    v_mfma_f32_16x16x32_bf16 v[190:193], a[236:239], v[138:141], v[190:193]
    ds_write_b128 v3, v[126:129] offset:0
    v_mfma_f32_16x16x32_bf16 v[114:117], a[240:243], v[182:185], 0
    v_cvt_pk_bf16_f32 v36, v122, v123
    v_mul_f32 v231, v187, v231
    v_mfma_f32_16x16x32_bf16 v[114:117], a[244:247], v[222:225], v[114:117]
    v_exp_f32 v125, v125
    v_mfma_f32_16x16x32_bf16 v[114:117], a[248:251], v[234:237], v[114:117]
    v_cvt_pk_bf16_f32 v37, v124, v125
    v_fma_f32 v186, v190, v190, s33
    v_mfma_f32_16x16x32_bf16 v[114:117], a[252:255], v[238:241], v[114:117]
    v_fmac_f32 v186, v191, v191
    v_fmac_f32 v186, v192, v192
    v_mfma_f32_16x16x32_bf16 v[118:121], v[28:31], v[36:39], 0
    v_fmac_f32 v186, v193, v193
    v_cvt_pk_bf16_f32 v230, v230, v231
    v_mfma_f32_16x16x32_bf16 v[118:121], v[28:31], v[162:165], v[118:121]
    v_exp_f32 v194, v194
    v_mfma_f32_16x16x32_bf16 v[122:125], v[174:177], v[36:39], 0
    v_exp_f32 v195, v195
    v_mfma_f32_16x16x32_bf16 v[122:125], v[134:137], v[162:165], v[122:125]
    v_cvt_pk_bf16_f32 v126, v194, v195
    v_mul_f32 v232, v187, v232
    v_mfma_f32_16x16x32_bf16 v[158:161], v[178:181], v[36:39], 0
    v_exp_f32 v196, v196
    v_mfma_f32_16x16x32_bf16 v[158:161], v[150:153], v[162:165], v[158:161]
    v_rcp_f32 v119, v118
    v_mfma_f32_16x16x32_bf16 v[166:169], v[202:205], v[36:39], 0
    v_exp_f32 v197, v197
    v_mfma_f32_16x16x32_bf16 v[166:169], v[142:145], v[162:165], v[166:169]
    v_mul_f32 v122, v119, v122
    v_mul_f32 v123, v119, v123
    v_mfma_f32_16x16x32_bf16 v[114:117], v[82:85], v[242:245], v[114:117]
    v_cvt_pk_bf16_f32 v122, v122, v123
    v_mul_f32 v124, v119, v124
    v_mfma_f32_16x16x32_bf16 v[114:117], v[86:89], v[138:141], v[114:117]
    ds_read_b128 v[162:165], v133 offset:0
    v_mul_f32 v125, v119, v125
    v_mfma_f32_16x16x32_bf16 v[206:209], v[90:93], v[182:185], 0
    ds_read_b128 v[182:185], v133 offset:2048
    v_cvt_pk_bf16_f32 v123, v124, v125
    v_mfma_f32_16x16x32_bf16 v[206:209], v[94:97], v[222:225], v[206:209]
    ds_read_b128 v[210:213], v133 offset:4096
    v_mul_f32 v158, v119, v158
    v_mfma_f32_16x16x32_bf16 v[206:209], v[98:101], v[234:237], v[206:209]
    ds_read_b128 v[222:225], v133 offset:6144
    v_fmac_f32 v186, v114, v114
    v_mfma_f32_16x16x32_bf16 v[206:209], v[102:105], v[238:241], v[206:209]
    ds_read_b128 v[226:229], v133 offset:8192
    v_fmac_f32 v186, v115, v115
    v_mfma_f32_16x16x32_bf16 v[206:209], v[106:109], v[242:245], v[206:209]
    ds_read_b128 v[234:237], v133 offset:10240
    v_fmac_f32 v186, v116, v116
    v_mfma_f32_16x16x32_bf16 v[206:209], v[110:113], v[138:141], v[206:209]
    v_fmac_f32 v186, v117, v117
    v_mul_f32 v159, v119, v159
    v_mfma_f32_16x16x32_bf16 v[138:141], v[198:201], v[28:31], 0
    v_cvt_pk_bf16_f32 v124, v158, v159
    v_mul_f32 v160, v119, v160
    v_mfma_f32_16x16x32_bf16 v[138:141], v[218:221], v[28:31], v[138:141]
    s_waitcnt lgkmcnt(5)
    v_mul_f32 v161, v119, v161
    v_fmac_f32 v186, v206, v206
    v_mfma_f32_16x16x32_bf16 v[238:241], a[216:219], v[162:165], 0
    s_waitcnt lgkmcnt(4)
    v_fmac_f32 v186, v207, v207
    v_fmac_f32 v186, v208, v208
    v_mfma_f32_16x16x32_bf16 v[238:241], a[220:223], v[182:185], v[238:241]
    s_waitcnt lgkmcnt(3)
    v_fmac_f32 v186, v209, v209
    v_cvt_pk_bf16_f32 v125, v160, v161
    v_mfma_f32_16x16x32_bf16 v[238:241], a[224:227], v[210:213], v[238:241]
    s_waitcnt lgkmcnt(2)
    ds_write_b128 v3, v[122:125] offset:6144
    v_mfma_f32_16x16x32_bf16 v[238:241], a[228:231], v[222:225], v[238:241]
    s_waitcnt lgkmcnt(1)
    v_mul_f32 v166, v119, v166
    v_mul_f32 v167, v119, v167
    v_mfma_f32_16x16x32_bf16 v[238:241], a[232:235], v[226:229], v[238:241]
    v_cvt_pk_bf16_f32 v120, v166, v167
    v_mul_f32 v168, v119, v168
    v_mfma_f32_16x16x32_bf16 v[238:241], a[236:239], v[234:237], v[238:241]
    v_mul_f32 v169, v119, v169
    v_cvt_pk_bf16_f32 v121, v168, v169
    v_mfma_f32_16x16x32_bf16 v[122:125], a[240:243], v[162:165], 0
    ds_write_b64 v4, v[120:121] offset:10240
    v_mfma_f32_16x16x32_bf16 v[122:125], a[244:247], v[182:185], v[122:125]
    v_rcp_f32_dpp v139, v138 quad_perm:[0,0,0,0] row_mask:0xf bank_mask:0xf
    v_mfma_f32_16x16x32_bf16 v[122:125], a[248:251], v[210:213], v[122:125]
    v_max3_u32 v25, v25, v138, v139
    v_fma_f32 v188, v238, v238, s33
    v_mfma_f32_16x16x32_bf16 v[122:125], a[252:255], v[222:225], v[122:125]
    v_fmac_f32 v188, v239, v239
    v_fmac_f32 v188, v240, v240
    v_mfma_f32_16x16x32_bf16 v[122:125], v[82:85], v[226:229], v[122:125]
    v_fmac_f32 v188, v241, v241
    v_max3_u32 v25, v25, v119, v118
    v_mfma_f32_16x16x32_bf16 v[122:125], v[86:89], v[234:237], v[122:125]
    v_cvt_pk_bf16_f32 v127, v196, v197
    v_cvt_pk_bf16_f32 v39, v172, 0
    v_mfma_f32_16x16x32_bf16 v[118:121], v[90:93], v[162:165], 0
    v_exp_f32 v146, v146
    v_mfma_f32_16x16x32_bf16 v[118:121], v[94:97], v[182:185], v[118:121]
    v_exp_f32 v147, v147
    v_mfma_f32_16x16x32_bf16 v[118:121], v[98:101], v[210:213], v[118:121]
    v_cvt_pk_bf16_f32 v128, v146, v147
    v_fmac_f32 v188, v122, v122
    v_mfma_f32_16x16x32_bf16 v[118:121], v[102:105], v[222:225], v[118:121]
    v_fmac_f32 v188, v123, v123
    v_fmac_f32 v188, v124, v124
    v_mfma_f32_16x16x32_bf16 v[118:121], v[106:109], v[226:229], v[118:121]
    v_fmac_f32 v188, v125, v125
    v_mul_f32 v233, v187, v233
    v_mfma_f32_16x16x32_bf16 v[118:121], v[110:113], v[234:237], v[118:121]
    v_exp_f32 v148, v148
    v_mfma_f32_16x16x32_bf16 v[158:161], v[198:201], v[134:137], 0
    v_exp_f32 v149, v149
    v_mfma_f32_16x16x32_bf16 v[158:161], v[218:221], v[174:177], v[158:161]
    v_cvt_pk_bf16_f32 v129, v148, v149
    v_cvt_pk_bf16_f32 v231, v232, v233
    v_mfma_f32_16x16x32_bf16 v[146:149], v[198:201], v[150:153], 0
    ds_write_b64 v4, v[230:231] offset:4096
    v_mfma_f32_16x16x32_bf16 v[146:149], v[218:221], v[178:181], v[146:149]
    v_fmac_f32 v188, v118, v118
    v_fmac_f32 v188, v119, v119
    v_mfma_f32_16x16x32_bf16 v[162:165], v[198:201], v[142:145], 0
    v_fmac_f32 v188, v120, v120
    v_fmac_f32 v188, v121, v121
    v_mfma_f32_16x16x32_bf16 v[162:165], v[218:221], v[202:205], v[162:165]
    v_cvt_pk_bf16_f32 v140, v186, v188
    v_cvt_pk_bf16_f32 v141, v188, v188
    ds_write_b64 v155, v[140:141] offset:2048
    v_mul_f32 v158, v158, v139
    v_exp_f32 v214, v214
    v_exp_f32 v215, v215
    v_mul_f32_dpp v158, v146, v139 quad_perm:[0,1,2,3] row_mask:0x2 bank_mask:0xf
    v_cvt_pk_bf16_f32 v36, v214, v215
    v_exp_f32 v216, v216
    v_mul_f32_dpp v158, v162, v139 quad_perm:[0,1,2,3] row_mask:0x4 bank_mask:0xf
    v_cvt_pk_bf16_f32 v158, v158, v158
    ds_write_b16 v7, v158
    v_exp_f32 v217, v217
    v_lshl_add_u32 v172, v173, 3, s5
    v_cvt_pk_bf16_f32 v37, v216, v217
    v_lshl_add_u32 v138, v130, 4, s5
    v_lshl_add_u32 v130, v130, 3, s5
    v_mfma_f32_16x16x32_bf16 v[146:149], v[28:31], v[36:39], 0
    v_lshlrev_b32 v173, 2, v173
    v_add_u32 v132, 16, v132
    v_mfma_f32_16x16x32_bf16 v[146:149], v[28:31], v[126:129], v[146:149]
    s_waitcnt lgkmcnt(1)
    ds_permute_b32 v139, v173, v16
    ds_permute_b32 v140, v173, v19
    v_mfma_f32_16x16x32_bf16 v[158:161], v[174:177], v[36:39], 0
    s_barrier
    ds_read_b128 v[162:165], v154 offset:2048
    ds_read_b128 v[166:169], v154 offset:3072
    v_mfma_f32_16x16x32_bf16 v[158:161], v[134:137], v[126:129], v[158:161]
    ds_read_b128 v[134:137], v171 offset:0
    ds_read_b128 v[174:177], v171 offset:1024
    v_mfma_f32_16x16x32_bf16 v[182:185], v[178:181], v[36:39], 0
    v_rcp_f32 v147, v146
    v_mfma_f32_16x16x32_bf16 v[182:185], v[150:153], v[126:129], v[182:185]
    ds_read_b128 v[150:153], v171 offset:2048
    ds_read_b128 v[178:181], v171 offset:3072
    v_mfma_f32_16x16x32_bf16 v[186:189], v[202:205], v[36:39], 0
    v_max3_u32 v25, v25, v147, v146
    v_sub_u32 v141, 0x67800000, v25
    v_mfma_f32_16x16x32_bf16 v[186:189], v[142:145], v[126:129], v[186:189]
    ds_read_b128 v[126:129], v171 offset:4096
    ds_read_b128 v[142:145], v171 offset:5120
    v_or3_b32 v170, v170, v141, v25
    v_lshl_add_u32 v141, s16, 2, v171
    ds_write_b32 v141, v170 offset:18432
    s_waitcnt lgkmcnt(8)
    v_mfma_f32_16x16x32_bf16 v[194:197], v[32:35], v[162:165], 0
    s_waitcnt lgkmcnt(7)
    v_mul_f32 v158, v147, v158
    v_mul_f32 v159, v147, v159
    v_mfma_f32_16x16x32_bf16 v[194:197], v[32:35], v[166:169], v[194:197]
    s_waitcnt lgkmcnt(5)
    ds_permute_b32 v141, v173, v17
    ds_permute_b32 v170, v173, v20
    v_mfma_f32_16x16x32_bf16 v[162:165], a[216:219], v[134:137], 0
    v_cvt_pk_bf16_f32 v158, v158, v159
    v_mul_f32 v160, v147, v160
    v_mfma_f32_16x16x32_bf16 v[162:165], a[220:223], v[174:177], v[162:165]
    s_waitcnt lgkmcnt(5)
    v_mul_f32 v159, 0x3baaaaab, v195
    v_mul_f32 v161, v147, v161
    v_mfma_f32_16x16x32_bf16 v[162:165], a[224:227], v[150:153], v[162:165]
    v_rsq_f32 v159, v159
    v_mfma_f32_16x16x32_bf16 v[162:165], a[228:231], v[178:181], v[162:165]
    s_waitcnt lgkmcnt(3)
    v_mul_f32 v238, v159, v238
    v_mul_f32 v239, v159, v239
    v_mfma_f32_16x16x32_bf16 v[162:165], a[232:235], v[126:129], v[162:165]
    v_cvt_pk_bf16_f32 v166, v238, v239
    v_mul_f32 v240, v159, v240
    v_mfma_f32_16x16x32_bf16 v[162:165], a[236:239], v[142:145], v[162:165]
    v_mul_f32 v241, v159, v241
    v_cvt_pk_bf16_f32 v167, v240, v241
    v_mfma_f32_16x16x32_bf16 v[198:201], a[240:243], v[134:137], 0
    v_mul_f32 v122, v159, v122
    v_mul_f32 v123, v159, v123
    v_mfma_f32_16x16x32_bf16 v[198:201], a[244:247], v[174:177], v[198:201]
    s_waitcnt lgkmcnt(0)
    v_cvt_pk_bf16_f32 v168, v122, v123
    v_mul_f32 v124, v159, v124
    v_mfma_f32_16x16x32_bf16 v[198:201], a[248:251], v[150:153], v[198:201]
    v_mul_f32 v125, v159, v125
    v_cvt_pk_bf16_f32 v169, v124, v125
    v_mfma_f32_16x16x32_bf16 v[198:201], a[252:255], v[178:181], v[198:201]
    buffer_store_dwordx4 v[166:169], v157, s[12:15], 0 offen nt
    v_mul_f32 v118, v159, v118
    v_mul_f32 v119, v159, v119
    v_cvt_pk_bf16_f32 v148, v118, v119
    v_mul_f32 v120, v159, v120
    v_mfma_f32_16x16x32_bf16 v[198:201], v[82:85], v[126:129], v[198:201]
    v_mul_f32 v121, v159, v121
    v_cvt_pk_bf16_f32 v149, v120, v121
    v_mfma_f32_16x16x32_bf16 v[198:201], v[86:89], v[142:145], v[198:201]
    ds_read_b128 v[118:121], v171 offset:6144
    v_fma_f32 v173, v162, v162, s33
    v_mfma_f32_16x16x32_bf16 v[122:125], v[90:93], v[134:137], 0
    ds_read_b128 v[134:137], v171 offset:7168
    v_fmac_f32 v173, v163, v163
    v_mfma_f32_16x16x32_bf16 v[122:125], v[94:97], v[174:177], v[122:125]
    ds_read_b128 v[166:169], v171 offset:8192
    v_fmac_f32 v173, v164, v164
    v_mfma_f32_16x16x32_bf16 v[122:125], v[98:101], v[150:153], v[122:125]
    ds_read_b128 v[150:153], v171 offset:9216
    v_fmac_f32 v173, v165, v165
    v_mfma_f32_16x16x32_bf16 v[122:125], v[102:105], v[178:181], v[122:125]
    ds_read_b128 v[174:177], v171 offset:10240
    v_fmac_f32 v173, v198, v198
    v_mfma_f32_16x16x32_bf16 v[122:125], v[106:109], v[126:129], v[122:125]
    ds_read_b128 v[126:129], v171 offset:11264
    v_fmac_f32 v173, v199, v199
    v_mfma_f32_16x16x32_bf16 v[122:125], v[110:113], v[142:145], v[122:125]
    v_fmac_f32 v173, v200, v200
    v_fmac_f32 v173, v201, v201
    v_cvt_pk_bf16_f32 v159, v160, v161
    v_mul_f32 v182, v147, v182
    s_waitcnt lgkmcnt(5)
    v_mfma_f32_16x16x32_bf16 v[142:145], a[216:219], v[118:121], 0
    v_mul_f32 v183, v147, v183
    v_cvt_pk_bf16_f32 v160, v182, v183
    v_mfma_f32_16x16x32_bf16 v[178:181], a[240:243], v[118:121], 0
    s_waitcnt lgkmcnt(4)
    v_fmac_f32 v173, v122, v122
    v_fmac_f32 v173, v123, v123
    v_mfma_f32_16x16x32_bf16 v[142:145], a[220:223], v[134:137], v[142:145]
    s_waitcnt lgkmcnt(3)
    v_fmac_f32 v173, v124, v124
    v_fmac_f32 v173, v125, v125
    v_mfma_f32_16x16x32_bf16 v[142:145], a[224:227], v[166:169], v[142:145]
    s_waitcnt lgkmcnt(2)
    v_mul_f32 v184, v147, v184
    v_mul_f32 v185, v147, v185
    v_mfma_f32_16x16x32_bf16 v[142:145], a[228:231], v[150:153], v[142:145]
    s_waitcnt lgkmcnt(1)
    v_cvt_pk_bf16_f32 v161, v184, v185
    v_mul_f32 v186, v147, v186
    v_mfma_f32_16x16x32_bf16 v[142:145], a[232:235], v[174:177], v[142:145]
    s_waitcnt lgkmcnt(0)
    ds_write_b128 v3, v[158:161] offset:12288
    v_mfma_f32_16x16x32_bf16 v[142:145], a[236:239], v[126:129], v[142:145]
    buffer_store_dwordx2 v[148:149], v156, s[12:15], 0 offen nt
    v_mul_f32 v187, v147, v187
    v_cvt_pk_bf16_f32 v156, v186, v187
    v_mfma_f32_16x16x32_bf16 v[178:181], a[244:247], v[134:137], v[178:181]
    v_mul_f32 v188, v147, v188
    v_mul_f32 v189, v147, v189
    v_mfma_f32_16x16x32_bf16 v[178:181], a[248:251], v[166:169], v[178:181]
    v_cvt_pk_bf16_f32 v157, v188, v189
    v_fma_f32 v195, v142, v142, s33
    v_mfma_f32_16x16x32_bf16 v[178:181], a[252:255], v[150:153], v[178:181]
    ds_write_b64 v4, v[156:157] offset:16384
    v_mfma_f32_16x16x32_bf16 v[178:181], v[82:85], v[174:177], v[178:181]
    v_fmac_f32 v195, v143, v143
    v_fmac_f32 v195, v144, v144
    v_mfma_f32_16x16x32_bf16 v[178:181], v[86:89], v[126:129], v[178:181]
    v_fmac_f32 v195, v145, v145
    v_mul_f32 v156, 0x3baaaaab, v194
    v_mfma_f32_16x16x32_bf16 v[146:149], v[90:93], v[118:121], 0
    v_rsq_f32 v156, v156
    v_mfma_f32_16x16x32_bf16 v[146:149], v[94:97], v[134:137], v[146:149]
    v_mul_f32 v190, v156, v190
    v_mul_f32 v191, v156, v191
    v_mfma_f32_16x16x32_bf16 v[146:149], v[98:101], v[166:169], v[146:149]
    v_fmac_f32 v195, v178, v178
    v_fmac_f32 v195, v179, v179
    v_mfma_f32_16x16x32_bf16 v[146:149], v[102:105], v[150:153], v[146:149]
    v_fmac_f32 v195, v180, v180
    v_fmac_f32 v195, v181, v181
    v_mfma_f32_16x16x32_bf16 v[146:149], v[106:109], v[174:177], v[146:149]
    v_cvt_pk_bf16_f32 v118, v190, v191
    v_mul_f32 v192, v156, v192
    v_mfma_f32_16x16x32_bf16 v[146:149], v[110:113], v[126:129], v[146:149]
    v_mul_f32 v193, v156, v193
    v_cvt_pk_bf16_f32 v119, v192, v193
    v_mul_f32 v114, v156, v114
    v_mul_f32 v115, v156, v115
    v_cvt_pk_bf16_f32 v120, v114, v115
    v_mul_f32 v116, v156, v116
    v_mul_f32 v117, v156, v117
    v_cvt_pk_bf16_f32 v121, v116, v117
    v_fmac_f32 v195, v146, v146
    v_fmac_f32 v195, v147, v147
    v_fmac_f32 v195, v148, v148
    v_fmac_f32 v195, v149, v149
    v_cvt_pk_bf16_f32 v194, v173, v195
    v_cvt_pk_bf16_f32 v195, v195, v195
    ds_write_b64 v155, v[194:195] offset:7616
    buffer_store_dwordx4 v[118:121], v17, s[52:55], 0 offen nt
    v_mul_f32 v206, v156, v206
    v_mul_f32 v207, v156, v207
    v_cvt_pk_bf16_f32 v206, v206, v207
    v_mul_f32 v208, v156, v208
    v_mul_f32 v209, v156, v209
    v_cvt_pk_bf16_f32 v207, v208, v209
    v_min_u32 v173, 20, v132
    v_add_u32 v156, 12, v132
    v_lshrrev_b32 v156, 5, v156
    v_sub_u32 v157, v132, v173
    v_mad_i32_i24 v157, v156, s6, v157
    v_mul_u32_u24 v208, s20, v173
    v_add3_u32 v208, v208, v157, s38
    v_mul_u32_u24 v156, 911, v208
    v_lshrrev_b32 v156, 16, v156
    v_mul_u32_u24 v156, s22, v156
    v_mad_u32_u24 v156, v173, s21, v156
    v_bfe_u32 v208, s70, v132, 1
    v_cmp_ne_u32 vcc, 0, v208
    v_mul_i32_i24 v157, 2688, v157
    v_add3_u32 v132, v156, v157, s7
    v_cndmask_b32 v132, v255, v132, vcc
    v_lshl_add_u32 v255, v131, 4, v132
    v_add_u32 v255, s3, v255
    s_waitcnt lgkmcnt(0)
    s_barrier
    ds_read_b128 v[114:117], v154 offset:7616
    ds_read_b128 v[118:121], v154 offset:8640
    ds_read_b128 v[126:129], v171 offset:12288
    ds_read_b128 v[134:137], v171 offset:13312
    ds_read_b128 v[150:153], v171 offset:14336
    ds_read_b128 v[158:161], v171 offset:15360
    ds_read_b128 v[166:169], v171 offset:16384
    ds_read_b128 v[174:177], v171 offset:17408
    v_lshl_add_u32 v173, v131, 3, v132
    v_add_u32 v173, s4, v173
    s_waitcnt lgkmcnt(7)
    v_mfma_f32_16x16x32_bf16 v[182:185], v[32:35], v[114:117], 0
    s_waitcnt lgkmcnt(6)
    v_mfma_f32_16x16x32_bf16 v[182:185], v[32:35], v[118:121], v[182:185]
    s_waitcnt lgkmcnt(4)
    v_mfma_f32_16x16x32_bf16 v[114:117], a[216:219], v[126:129], 0
    s_waitcnt lgkmcnt(3)
    buffer_store_dwordx2 v[206:207], v20, s[52:55], 0 offen nt
    v_mfma_f32_16x16x32_bf16 v[114:117], a[220:223], v[134:137], v[114:117]
    s_waitcnt lgkmcnt(2)
    v_mfma_f32_16x16x32_bf16 v[114:117], a[224:227], v[150:153], v[114:117]
    s_waitcnt lgkmcnt(1)
    v_mul_f32 v156, 0x3baaaaab, v182
    v_mul_f32 v157, 0x3baaaaab, v183
    v_mfma_f32_16x16x32_bf16 v[114:117], a[228:231], v[158:161], v[114:117]
    s_waitcnt lgkmcnt(0)
    v_rsq_f32 v156, v156
    v_mfma_f32_16x16x32_bf16 v[114:117], a[232:235], v[166:169], v[114:117]
    v_mul_f32 v162, v156, v162
    v_mul_f32 v163, v156, v163
    v_mfma_f32_16x16x32_bf16 v[114:117], a[236:239], v[174:177], v[114:117]
    v_cvt_pk_bf16_f32 v118, v162, v163
    v_mul_f32 v164, v156, v164
    v_mfma_f32_16x16x32_bf16 v[182:185], a[240:243], v[126:129], 0
    v_mul_f32 v165, v156, v165
    v_cvt_pk_bf16_f32 v119, v164, v165
    v_mfma_f32_16x16x32_bf16 v[182:185], a[244:247], v[134:137], v[182:185]
    v_mul_f32 v198, v156, v198
    v_mul_f32 v199, v156, v199
    v_mfma_f32_16x16x32_bf16 v[182:185], a[248:251], v[150:153], v[182:185]
    v_fma_f32 v131, v114, v114, s33
    v_fmac_f32 v131, v115, v115
    v_mfma_f32_16x16x32_bf16 v[182:185], a[252:255], v[158:161], v[182:185]
    v_fmac_f32 v131, v116, v116
    v_fmac_f32 v131, v117, v117
    v_mfma_f32_16x16x32_bf16 v[182:185], v[82:85], v[166:169], v[182:185]
    v_cvt_pk_bf16_f32 v120, v198, v199
    v_mul_f32 v200, v156, v200
    v_mfma_f32_16x16x32_bf16 v[182:185], v[86:89], v[174:177], v[182:185]
    ds_read_b128 v[162:165], v133 offset:256
    v_mul_f32 v201, v156, v201
    v_mfma_f32_16x16x32_bf16 v[186:189], v[90:93], v[126:129], 0
    ds_read_b128 v[126:129], v133 offset:2304
    v_cvt_pk_bf16_f32 v121, v200, v201
    v_mfma_f32_16x16x32_bf16 v[186:189], v[94:97], v[134:137], v[186:189]
    ds_read_b128 v[134:137], v133 offset:4352
    v_mul_f32 v122, v156, v122
    v_mfma_f32_16x16x32_bf16 v[186:189], v[98:101], v[150:153], v[186:189]
    ds_read_b128 v[150:153], v133 offset:6400
    v_fmac_f32 v131, v182, v182
    v_mfma_f32_16x16x32_bf16 v[186:189], v[102:105], v[158:161], v[186:189]
    ds_read_b128 v[158:161], v133 offset:8448
    v_fmac_f32 v131, v183, v183
    v_mfma_f32_16x16x32_bf16 v[186:189], v[106:109], v[166:169], v[186:189]
    ds_read_b128 v[166:169], v133 offset:10496
    buffer_store_dwordx4 v[118:121], v15, s[56:59], 0 offen nt
    v_fmac_f32 v131, v184, v184
    v_fmac_f32 v131, v185, v185
    v_mul_f32 v123, v156, v123
    v_cvt_pk_bf16_f32 v132, v122, v123
    v_mfma_f32_16x16x32_bf16 v[186:189], v[110:113], v[174:177], v[186:189]
    v_mul_f32 v124, v156, v124
    s_waitcnt lgkmcnt(5)
    v_mfma_f32_16x16x32_bf16 v[118:121], a[216:219], v[162:165], 0
    v_mul_f32 v125, v156, v125
    v_cvt_pk_bf16_f32 v133, v124, v125
    v_mfma_f32_16x16x32_bf16 v[122:125], a[240:243], v[162:165], 0
    s_waitcnt lgkmcnt(4)
    v_rsq_f32 v157, v157
    v_mfma_f32_16x16x32_bf16 v[118:121], a[220:223], v[126:129], v[118:121]
    s_waitcnt lgkmcnt(3)
    v_fmac_f32 v131, v186, v186
    v_fmac_f32 v131, v187, v187
    v_mfma_f32_16x16x32_bf16 v[118:121], a[224:227], v[134:137], v[118:121]
    s_waitcnt lgkmcnt(2)
    v_fmac_f32 v131, v188, v188
    v_fmac_f32 v131, v189, v189
    v_mfma_f32_16x16x32_bf16 v[118:121], a[228:231], v[150:153], v[118:121]
    s_waitcnt lgkmcnt(1)
    v_cvt_pk_bf16_f32 v174, v131, v131
    v_cvt_pk_bf16_f32 v175, v131, v131
    v_mfma_f32_16x16x32_bf16 v[118:121], a[232:235], v[158:161], v[118:121]
    s_waitcnt lgkmcnt(0)
    ds_write_b64 v155, v[174:175] offset:9664
    v_mfma_f32_16x16x32_bf16 v[118:121], a[236:239], v[166:169], v[118:121]
    v_mul_f32 v142, v157, v142
    v_mul_f32 v143, v157, v143
    v_mfma_f32_16x16x32_bf16 v[122:125], a[244:247], v[126:129], v[122:125]
    v_cvt_pk_bf16_f32 v142, v142, v143
    v_mul_f32 v144, v157, v144
    v_mfma_f32_16x16x32_bf16 v[122:125], a[248:251], v[134:137], v[122:125]
    v_mul_f32 v145, v157, v145
    v_cvt_pk_bf16_f32 v143, v144, v145
    v_mfma_f32_16x16x32_bf16 v[122:125], a[252:255], v[150:153], v[122:125]
    v_fma_f32 v156, v118, v118, s33
    v_fmac_f32 v156, v119, v119
    v_mfma_f32_16x16x32_bf16 v[122:125], v[82:85], v[158:161], v[122:125]
    v_fmac_f32 v156, v120, v120
    v_fmac_f32 v156, v121, v121
    v_mfma_f32_16x16x32_bf16 v[122:125], v[86:89], v[166:169], v[122:125]
    v_mul_f32 v178, v157, v178
    v_mul_f32 v179, v157, v179
    v_mfma_f32_16x16x32_bf16 v[174:177], v[90:93], v[162:165], 0
    v_cvt_pk_bf16_f32 v144, v178, v179
    v_mul_f32 v180, v157, v180
    v_mfma_f32_16x16x32_bf16 v[174:177], v[94:97], v[126:129], v[174:177]
    buffer_store_dwordx2 v[132:133], v18, s[56:59], 0 offen nt
    v_mul_f32 v181, v157, v181
    v_fmac_f32 v156, v122, v122
    v_mfma_f32_16x16x32_bf16 v[174:177], v[98:101], v[134:137], v[174:177]
    v_fmac_f32 v156, v123, v123
    v_fmac_f32 v156, v124, v124
    v_mfma_f32_16x16x32_bf16 v[174:177], v[102:105], v[150:153], v[174:177]
    v_fmac_f32 v156, v125, v125
    v_cvt_pk_bf16_f32 v145, v180, v181
    v_mfma_f32_16x16x32_bf16 v[174:177], v[106:109], v[158:161], v[174:177]
    ds_write_b128 v254, v[142:145] offset:1536
    v_mfma_f32_16x16x32_bf16 v[174:177], v[110:113], v[166:169], v[174:177]
    v_mul_f32 v146, v157, v146
    v_mul_f32 v147, v157, v147
    v_cvt_pk_bf16_f32 v146, v146, v147
    v_mul_f32 v148, v157, v148
    v_mul_f32 v149, v157, v149
    ds_read_b128 v[126:129], v138 offset:1536
    v_cvt_pk_bf16_f32 v147, v148, v149
    ds_write_b64 v172, v[146:147] offset:2560
    v_fmac_f32 v156, v174, v174
    v_fmac_f32 v156, v175, v175
    v_fmac_f32 v156, v176, v176
    v_fmac_f32 v156, v177, v177
    v_cvt_pk_bf16_f32 v132, v156, v156
    v_cvt_pk_bf16_f32 v133, v156, v156
    ds_write_b64 v155, v[132:133] offset:15232
    ds_read_b64 v[132:133], v130 offset:2560
    s_waitcnt lgkmcnt(3)
    buffer_store_dwordx4 v[126:129], v139, s[56:59], 0 offen nt
    s_waitcnt lgkmcnt(1)
    s_barrier
    ds_read_b128 v[134:137], v154 offset:9664
    ds_read_b128 v[126:129], v154 offset:10688
    ds_read_b128 v[142:145], v154 offset:15232
    ds_read_b128 v[146:149], v154 offset:16256
    ds_read_b128 v[150:153], v171 offset:18432
    s_waitcnt lgkmcnt(5)
    buffer_store_dwordx2 v[132:133], v140, s[56:59], 0 offen nt
    s_waitcnt lgkmcnt(4)
    v_mfma_f32_16x16x32_bf16 v[154:157], v[32:35], v[134:137], 0
    s_waitcnt lgkmcnt(3)
    v_mfma_f32_16x16x32_bf16 v[154:157], v[32:35], v[126:129], v[154:157]
    s_waitcnt lgkmcnt(1)
    v_mfma_f32_16x16x32_bf16 v[126:129], v[32:35], v[142:145], 0
    s_waitcnt lgkmcnt(0)
    v_or3_b32 v150, v150, v151, v152
    v_or_b32 v150, v150, v153
    v_mfma_f32_16x16x32_bf16 v[126:129], v[32:35], v[146:149], v[126:129]
    v_cmp_gt_i32 s[46:47], 0, v150
    s_nop 0
    v_mul_f32 v171, 0x3baaaaab, v154
    v_rsq_f32 v171, v171
    s_nop 0
    v_mul_f32 v114, v171, v114
    v_mul_f32 v115, v171, v115
    v_cvt_pk_bf16_f32 v114, v114, v115
    v_mul_f32 v115, 0x3baaaaab, v126
    v_rsq_f32 v115, v115
    v_mul_f32 v116, v171, v116
    v_mul_f32 v118, v115, v118
    v_mul_f32 v119, v115, v119
    v_cvt_pk_bf16_f32 v118, v118, v119
    v_mul_f32 v120, v115, v120
    v_mul_f32 v121, v115, v121
    v_cvt_pk_bf16_f32 v119, v120, v121
    v_mul_f32 v122, v115, v122
    v_mul_f32 v123, v115, v123
    v_cvt_pk_bf16_f32 v120, v122, v123
    v_mul_f32 v124, v115, v124
    v_mul_f32 v125, v115, v125
    v_cvt_pk_bf16_f32 v121, v124, v125
    buffer_store_dwordx4 v[118:121], v255, s[12:15], 0 offen nt
    v_mul_f32 v174, v115, v174
    v_mul_f32 v175, v115, v175
    v_cvt_pk_bf16_f32 v132, v174, v175
    v_mul_f32 v176, v115, v176
    v_mul_f32 v177, v115, v177
    v_cvt_pk_bf16_f32 v133, v176, v177
    v_mul_f32 v117, v171, v117
    v_cvt_pk_bf16_f32 v115, v116, v117
    v_mul_f32 v182, v171, v182
    v_mul_f32 v183, v171, v183
    v_cvt_pk_bf16_f32 v116, v182, v183
    v_mul_f32 v184, v171, v184
    v_mul_f32 v185, v171, v185
    v_cvt_pk_bf16_f32 v117, v184, v185
    ds_write_b128 v254, v[114:117] offset:3072
    v_mul_f32 v186, v171, v186
    v_mul_f32 v187, v171, v187
    v_cvt_pk_bf16_f32 v254, v186, v187
    v_mul_f32 v188, v171, v188
    v_mul_f32 v189, v171, v189
    v_cvt_pk_bf16_f32 v255, v188, v189
    buffer_store_dwordx2 v[132:133], v173, s[12:15], 0 offen nt
    ds_read_b128 v[114:117], v138 offset:3072
    ds_write_b64 v172, v[254:255] offset:4096
    ds_read_b64 v[254:255], v130 offset:4096
    s_waitcnt lgkmcnt(2)
    buffer_store_dwordx4 v[114:117], v141, s[56:59], 0 offen nt
    s_waitcnt lgkmcnt(0)
    buffer_store_dwordx2 v[254:255], v170, s[56:59], 0 offen nt
L_end:
    s_nop 1
    s_cmp_lg_u64 s[46:47], 0
    s_cbranch_scc1 L_rerun
L_done:
    s_endpgm
L_rerun:
    s_mov_b32 s44, 0x7f000000
    s_lshr_b32 s100, s70, 20
    s_waitcnt vmcnt(0) lgkmcnt(0)
    s_barrier
    v_mbcnt_lo_u32_b32 v0, -1, 0
    v_mbcnt_hi_u32_b32 v0, -1, v0
    v_lshl_add_u32 v0, s16, 6, v0
    s_nop 7
    s_branch L_again
L_edge:
    v_mov_b32 v254, v0
    v_mov_b32 v255, 0x40000000
    s_lshl_b32 s3, s16, 4
    s_load_dwordx4 s[92:95], s[0:1], s3
    v_and_b32 v114, 63, v0
    s_bfe_u32 s3, s2, 0x50003
    s_lshl_b32 s4, s16, 3
    s_lshr_b32 s98, 0x06143a01, s4
    s_and_b32 s98, s98, 0xff
    s_mul_i32 s3, s3, s98
    s_sub_u32 s98, s98, 1
    s_lshr_b32 s4, 0x0048d800, s4
    s_and_b32 s4, s4, 0xff
    s_lshl_b32 s4, s4, 3
    s_max_u32 s4, s4, 6
    s_sub_u32 s4, s4, s98
    s_sub_u32 s4, s4, 1
    s_min_u32 s3, s3, s4
    v_min_u32 v116, s98, v114
    v_add_lshl_u32 v116, v116, s3, 7
    v_mov_b32 v117, 0
    v_lshrrev_b32 v115, 4, v114
    v_and_b32 v118, 15, v114
    s_mov_b32 s10, 100270464
    s_mov_b32 s11, 0x00020000
    s_mov_b32 s50, 36096
    s_mov_b32 s51, 0x00020000
    s_mov_b32 s70, 193536
    s_mov_b32 s36, 100270464
    s_mov_b32 s22, 1180032
    s_mul_i32 s3, s2, 911
    s_lshr_b32 s3, s3, 16
    s_mul_i32 s35, s3, 72
    s_sub_u32 s38, s2, s35
    s_mul_i32 s3, s3, 1373568
    s_mul_i32 s35, s38, 2688
    s_add_u32 s3, s3, s35
    s_add_u32 s25, s3, 589824
    s_add_u32 s7, s3, 1769472
    s_mov_b32 s20, 31
    s_mov_b32 s21, 4204032
    s_mov_b32 s17, 20
    s_cmp_lt_u32 s2, 240
    s_cselect_b32 s45, 28, 24
    s_mov_b32 s5, 0
    s_mov_b32 s6, 0
    s_cmp_lt_u32 s2, 247
    s_cbranch_scc1 L_inner
    s_mov_b32 s20, 0
    s_mov_b32 s38, 0
    s_sub_u32 s3, s2, 247
    s_and_b32 s3, s3, 3
    s_mul_i32 s3, s3, 7
    s_add_u32 s3, s3, 3
    s_mov_b32 s35, 196224
    s_cmp_lt_u32 s2, 251
    s_cselect_b32 s35, s35, 384
    s_cselect_b32 s6, 1, 0
    s_cselect_b32 s5, 0, 1
    s_mul_i32 s25, s3, s35
    s_mul_i32 s21, s35, 28
    s_cmp_lt_u32 s2, 255
    s_cselect_b32 s17, 18, 1
    s_cselect_b32 s45, 18, 1
    s_cselect_b32 s25, s25, 0
    s_cselect_b32 s6, s6, 1
    s_add_u32 s7, s25, 1179648
L_inner:
    s_mul_i32 s3, s5, 99485568
    s_mul_i32 s35, s5, -784896
    v_mov_b32 v119, s3
    v_mov_b32 v120, s35
    s_add_u32 s7, s7, s35
    s_mul_i32 s3, s6, 194688
    s_mul_i32 s35, s6, -1536
    v_mov_b32 v121, s3
    v_mov_b32 v126, s35
    s_add_u32 s7, s7, s35
    s_bfm_b32 s34, s45, 0
    s_and_b32 s4, s2, 7
    s_sub_u32 s4, 0, s4
    v_mul_u32_u24 v127, 2731, v254
    v_bfe_u32 v128, v127, 17, 3
    v_lshrrev_b32 v127, 16, v127
    v_xor_b32 v129, v128, v254
    v_mul_u32_u24 v128, 37, v127
    v_lshrrev_b32 v128, 8, v128
    v_lshlrev_b32 v129, 4, v129
    v_mad_u32_u24 v10, v128, s70, v129
    v_mul_u32_u24 v128, 37, v127
    v_lshrrev_b32 v128, 8, v128
    v_mul_u32_u24 v130, 7, v128
    v_sub_u32 v130, v127, v130
    v_cmp_gt_u32 vcc, 4, v128
    s_nop 1
    v_cndmask_b32 v128, v120, v119, vcc
    v_cmp_gt_u32 vcc, 4, v130
    s_nop 1
    v_cndmask_b32 v130, v126, v121, vcc
    v_add3_u32 v10, v10, v128, v130
    v_mul_u32_u24 v128, s20, v127
    v_add_u32 v128, s38, v128
    v_mul_u32_u24 v130, 911, v128
    v_lshrrev_b32 v130, 16, v130
    v_mul_u32_u24 v130, s22, v130
    v_mad_u32_u24 v130, v127, s21, v130
    v_bfe_u32 v128, s34, v127, 1
    v_cmp_ne_u32 vcc, 0, v128
    v_add_u32 v128, s7, v130
    s_nop 0
    v_cndmask_b32 v128, v255, v128, vcc
    v_mul_u32_u24 v127, 384, v127
    v_sub_u32 v127, v129, v127
    v_add_u32 v128, v128, v127
    v_add_u32 v127, 256, v254
    v_mul_u32_u24 v129, 2731, v127
    v_bfe_u32 v130, v129, 17, 3
    v_lshrrev_b32 v129, 16, v129
    v_xor_b32 v127, v130, v127
    v_mul_u32_u24 v130, 37, v129
    v_lshrrev_b32 v130, 8, v130
    v_lshlrev_b32 v127, 4, v127
    v_mad_u32_u24 v11, v130, s70, v127
    v_mul_u32_u24 v130, 37, v129
    v_lshrrev_b32 v130, 8, v130
    v_mul_u32_u24 v131, 7, v130
    v_sub_u32 v131, v129, v131
    v_cmp_gt_u32 vcc, 4, v130
    s_nop 1
    v_cndmask_b32 v130, v120, v119, vcc
    v_cmp_gt_u32 vcc, 4, v131
    s_nop 1
    v_cndmask_b32 v131, v126, v121, vcc
    v_add3_u32 v11, v11, v130, v131
    v_min_u32 v130, 20, v129
    v_add_u32 v131, 12, v129
    v_lshrrev_b32 v131, 5, v131
    v_sub_u32 v132, v129, v130
    v_mad_i32_i24 v132, v131, s4, v132
    v_mul_u32_u24 v133, s20, v130
    v_add3_u32 v133, v133, v132, s38
    v_mul_u32_u24 v131, 911, v133
    v_lshrrev_b32 v131, 16, v131
    v_mul_u32_u24 v131, s22, v131
    v_mad_u32_u24 v131, v130, s21, v131
    v_bfe_u32 v133, s34, v129, 1
    v_cmp_ne_u32 vcc, 0, v133
    v_mul_i32_i24 v132, 2688, v132
    v_add3_u32 v130, v131, v132, s7
    v_cndmask_b32 v130, v255, v130, vcc
    v_mul_u32_u24 v129, 384, v129
    v_sub_u32 v129, v127, v129
    v_add_u32 v130, v130, v129
    v_add_u32 v127, 512, v254
    v_mul_u32_u24 v129, 2731, v127
    v_bfe_u32 v131, v129, 17, 3
    v_lshrrev_b32 v129, 16, v129
    v_xor_b32 v127, v131, v127
    v_mul_u32_u24 v131, 37, v129
    v_lshrrev_b32 v131, 8, v131
    v_lshlrev_b32 v127, 4, v127
    v_mad_u32_u24 v12, v131, s70, v127
    v_mul_u32_u24 v131, 37, v129
    v_lshrrev_b32 v131, 8, v131
    v_mul_u32_u24 v132, 7, v131
    v_sub_u32 v132, v129, v132
    v_cmp_gt_u32 vcc, 4, v131
    s_nop 1
    v_cndmask_b32 v131, v120, v119, vcc
    v_cmp_gt_u32 vcc, 4, v132
    s_nop 1
    v_cndmask_b32 v132, v126, v121, vcc
    v_add3_u32 v12, v12, v131, v132
    v_min_u32 v131, 20, v129
    v_add_u32 v132, 12, v129
    v_lshrrev_b32 v132, 5, v132
    v_sub_u32 v133, v129, v131
    v_mad_i32_i24 v133, v132, s4, v133
    v_mul_u32_u24 v142, s20, v131
    v_add3_u32 v142, v142, v133, s38
    v_mul_u32_u24 v132, 911, v142
    v_lshrrev_b32 v132, 16, v132
    v_mul_u32_u24 v132, s22, v132
    v_mad_u32_u24 v132, v131, s21, v132
    v_bfe_u32 v142, s34, v129, 1
    v_cmp_ne_u32 vcc, 0, v142
    v_mul_i32_i24 v133, 2688, v133
    v_add3_u32 v131, v132, v133, s7
    v_cndmask_b32 v131, v255, v131, vcc
    v_mul_u32_u24 v129, 384, v129
    v_sub_u32 v129, v127, v129
    v_add_u32 v131, v131, v129
    s_lshl_b32 s28, s16, 10
    s_add_u32 s28, s28, 20480
    s_waitcnt lgkmcnt(0)
    s_load_dword s101, s[92:93], 0
    s_load_dword s101, s[94:95], 0
    s_cmp_eq_u32 s16, 2
    s_cselect_b64 s[98:99], s[80:81], s[78:79]
    s_cmp_eq_u32 s16, 3
    s_cselect_b64 s[98:99], s[88:89], s[98:99]
    s_mov_b64 s[8:9], s[76:77]
    v_lshl_add_u64 v[116:117], s[98:99], 0, v[116:117]
    s_cmp_eq_u32 s16, 2
    s_cselect_b64 s[98:99], s[84:85], s[82:83]
    s_cmp_eq_u32 s16, 3
    s_cselect_b64 s[98:99], s[86:87], s[98:99]
    v_writelane_b32 v116, s98, 63
    v_writelane_b32 v117, s99, 63
    s_cmp_eq_u32 s16, 0
    s_cbranch_scc1 L_nowue
    global_load_dword a254, v[116:117], off
L_nowue:
    s_add_u32 m0, s28, 65536
    s_nop 0
    buffer_load_dwordx4 v128, s[8:11], 0 offen nt lds
    s_add_u32 m0, s28, 69632
    s_nop 0
    buffer_load_dwordx4 v130, s[8:11], 0 offen lds
    s_add_u32 m0, s28, 73728
    s_nop 0
    buffer_load_dwordx4 v131, s[8:11], 0 offen lds
    s_add_u32 m0, s28, 0
    s_nop 0
    buffer_load_dwordx4 v10, s[8:11], s25 offen nt lds
    s_add_u32 m0, s28, 4096
    s_nop 0
    buffer_load_dwordx4 v11, s[8:11], s25 offen nt lds
    s_mov_b64 s[48:49], s[78:79]
    s_mov_b64 s[52:53], s[80:81]
    s_mov_b64 s[60:61], s[84:85]
    s_mov_b64 s[64:65], s[86:87]
    s_mov_b64 s[56:57], s[88:89]
    s_mov_b64 s[46:47], s[82:83]
    s_load_dwordx4 s[40:43], s[0:1], 72
    s_mul_i32 s3, s16, 96
    v_lshl_add_u32 v116, v114, 4, s3
    v_mul_u32_u24 v117, 171, v114
    v_lshrrev_b32 v117, 10, v117
    v_lshrrev_b32 v127, 1, v117
    v_xor_b32 v127, v127, v117
    v_and_b32 v127, 4, v127
    v_mul_u32_u24 v127, 3, v127
    v_xor_b32 v127, v127, v117
    v_mul_u32_u24 v127, 1152, v127
    v_mul_u32_u24 v128, 96, v117
    v_sub_u32 v127, v127, v128
    v_add_u32 v128, v116, v127
    v_add_u32 v127, 64, v114
    v_mul_u32_u24 v127, 171, v127
    v_lshrrev_b32 v127, 10, v127
    v_lshrrev_b32 v129, 1, v127
    v_xor_b32 v129, v129, v127
    v_and_b32 v129, 4, v129
    v_mul_u32_u24 v129, 3, v129
    v_xor_b32 v129, v129, v127
    v_mul_u32_u24 v129, 1152, v129
    v_mul_u32_u24 v130, 96, v127
    v_sub_u32 v129, v129, v130
    v_add_u32 v130, v116, v129
    v_add_u32 v129, 128, v114
    v_mul_u32_u24 v129, 171, v129
    v_lshrrev_b32 v129, 10, v129
    v_lshrrev_b32 v131, 1, v129
    v_xor_b32 v131, v131, v129
    v_and_b32 v131, 4, v131
    v_mul_u32_u24 v131, 3, v131
    v_xor_b32 v131, v131, v129
    v_mul_u32_u24 v131, 1152, v131
    v_mul_u32_u24 v132, 96, v129
    v_sub_u32 v131, v131, v132
    v_add_u32 v132, v116, v131
    s_mul_i32 s68, s16, 6144
    s_add_u32 s69, s68, 65536
    s_cmp_eq_u32 s16, 3
    s_cselect_b32 s68, 149696, s68
    s_cselect_b32 s69, 155840, s69
    s_add_u32 s48, s48, 384
    s_addc_u32 s49, s49, 0
    s_add_u32 m0, s68, 0
    v_lshlrev_b32 v116, 1, v115
    s_mov_b32 s54, 12288
    s_mov_b32 s55, 0x00020000
    s_mov_b32 s62, 64
    s_mov_b32 s63, 0x00020000
    s_mov_b32 s66, 128
    s_mov_b32 s67, 0x00020000
    s_mov_b32 s58, 676
    s_mov_b32 s59, 0x00020000
    s_mov_b32 s14, 0
    s_mov_b32 s15, 0x00020000
    s_mul_i32 s90, s16, 16
    v_mov_b32 v123, 0
    v_cmp_lt_u32 s[92:93], 7, v118
    v_mov_b32 v137, 0
    v_mov_b32 v135, 0
    v_mov_b32 v125, 0
    v_lshlrev_b32 v124, 1, v114
    v_mul_u32_u24 v131, 12, v118
    s_mul_i32 s71, s16, 192
    v_add_u32 v131, s71, v131
    v_lshlrev_b32 v133, 5, v115
    s_mul_i32 s72, s16, 9408
    s_add_u32 s72, s72, 104448
    s_mul_i32 s73, s16, 7616
    s_add_u32 s73, s73, 38912
    s_cmp_eq_u32 s16, 3
    s_cselect_b32 s73, 142080, s73
    v_lshrrev_b32 v138, 2, v118
    v_and_b32 v134, 1, v138
    v_mul_u32_u24 v134, 0x020202, v134
    v_lshl_or_b32 v134, v134, 8, v134
    v_add_u32 v134, 0x05040100, v134
    v_and_b32 v139, 3, v118
    v_lshrrev_b32 v122, 1, v118
    v_xor_b32 v122, v122, v115
    v_mul_u32_u24 v136, 384, v118
    v_lshl_add_u32 v0, v122, 4, v136
    v_xor_b32 v1, 64, v0
    v_and_b32 v122, 2, v115
    v_add_u32 v122, v122, v115
    v_lshl_add_u32 v122, v122, 2, v138
    v_mul_u32_u24 v122, 96, v122
    v_lshl_add_u32 v122, v139, 3, v122
    v_add_u32 v140, s68, v122
    v_add_u32 v141, s69, v122
    v_add_u32 v144, s72, v122
    v_add_u32 v143, s73, v122
    v_mul_u32_u24 v142, 768, v115
    v_add_u32 v142, v131, v142
    v_add_u32 v142, 98304, v142
    s_mov_b32 s76, 0x3f80
    v_and_b32 v122, 1, v118
    v_lshlrev_b32 v122, 4, v122
    v_lshlrev_b32 v136, v122, s76
    v_mov_b32 v145, 0x3c003c00
    v_mov_b32 v28, 0x3f803f80
    v_mov_b32 v146, 2816
    v_mov_b32 v44, 1.0
    v_lshlrev_b32 v147, 4, v115
    s_mov_b32 s19, s38
    s_mov_b32 s23, s25
    s_mov_b32 s26, 0
    s_mov_b32 s27, 0
    s_mov_b32 s18, 0
    s_add_u32 s19, s19, s20
    s_add_u32 s23, s23, s21
    s_cmp_ge_u32 s19, 72
    s_cselect_b32 s34, 72, 0
    s_cselect_b32 s35, s22, 0
    s_sub_u32 s19, s19, s34
    s_add_u32 s23, s23, s35
    s_mov_b32 s24, s23
    s_add_u32 s19, s19, s20
    s_add_u32 s23, s23, s21
    s_cmp_ge_u32 s19, 72
    s_cselect_b32 s34, 72, 0
    s_cselect_b32 s35, s22, 0
    s_sub_u32 s19, s19, s34
    s_add_u32 s23, s23, s35
    s_mul_i32 s79, s16, 64
    v_lshl_add_u32 v148, v115, 4, s79
    s_mul_i32 s80, s16, 32
    s_add_u32 s80, s80, 256
    v_lshl_add_u32 v152, v115, 3, s80
    v_add_u32 v149, 0, v118
    v_mul_u32_u24 v150, 37, v149
    v_mul_u32_u24 v151, 384, v149
    v_lshrrev_b32 v150, 8, v150
    v_mad_u32_u24 v151, v150, s70, v151
    v_add_u32 v15, v151, v148
    v_add_u32 v18, v151, v152
    v_mul_u32_u24 v151, 37, v149
    v_lshrrev_b32 v151, 8, v151
    v_mul_u32_u24 v153, 7, v151
    v_sub_u32 v153, v149, v153
    v_add_u32 v155, 16, v118
    v_mul_u32_u24 v154, 37, v155
    v_mul_u32_u24 v156, 384, v155
    v_lshrrev_b32 v154, 8, v154
    v_mad_u32_u24 v156, v154, s70, v156
    v_add_u32 v16, v156, v148
    v_add_u32 v19, v156, v152
    v_mul_u32_u24 v156, 37, v155
    v_lshrrev_b32 v156, 8, v156
    v_mul_u32_u24 v158, 7, v156
    v_sub_u32 v158, v155, v158
    v_add_u32 v159, 32, v118
    v_mul_u32_u24 v157, 37, v159
    v_mul_u32_u24 v160, 384, v159
    v_lshrrev_b32 v157, 8, v157
    v_mad_u32_u24 v160, v157, s70, v160
    v_add_u32 v17, v160, v148
    v_add_u32 v20, v160, v152
    v_mul_u32_u24 v148, 37, v159
    v_lshrrev_b32 v148, 8, v148
    v_mul_u32_u24 v152, 7, v148
    v_sub_u32 v152, v159, v152
    s_mul_i32 s81, s16, 768
    s_add_u32 s81, s81, 98304
    v_mul_u32_u24 v150, 24, v150
    v_lshl_add_u32 v150, v149, 2, v150
    v_add_u32 v22, s81, v150
    v_sub_u32 v23, s81, v150
    v_sub_u32 v160, v22, v147
    v_mul_u32_u24 v150, 24, v154
    v_lshl_add_u32 v150, v155, 2, v150
    v_add_u32 v24, s81, v150
    v_sub_u32 v25, s81, v150
    v_sub_u32 v150, v24, v147
    v_mul_u32_u24 v161, 24, v157
    v_lshl_add_u32 v161, v159, 2, v161
    v_add_u32 v26, s81, v161
    v_sub_u32 v27, s81, v161
    v_sub_u32 v161, v26, v147
    v_mul_u32_u24 v157, 148, v115
    s_mov_b32 s82, -24
    v_add_u32 v154, 0, v157
    v_lshrrev_b32 v154, 8, v154
    v_mad_i32_i24 v46, v154, s82, v160
    v_mad_i32_i24 v58, v154, s82, v150
    v_mad_i32_i24 v70, v154, s82, v161
    v_add_u32 v154, 37, v157
    v_lshrrev_b32 v154, 8, v154
    v_mad_i32_i24 v47, v154, s82, v160
    v_mad_i32_i24 v59, v154, s82, v150
    v_mad_i32_i24 v71, v154, s82, v161
    v_add_u32 v154, 74, v157
    v_lshrrev_b32 v154, 8, v154
    v_mad_i32_i24 v48, v154, s82, v160
    v_mad_i32_i24 v60, v154, s82, v150
    v_mad_i32_i24 v72, v154, s82, v161
    v_add_u32 v154, 111, v157
    v_lshrrev_b32 v154, 8, v154
    v_mad_i32_i24 v49, v154, s82, v160
    v_mad_i32_i24 v61, v154, s82, v150
    v_mad_i32_i24 v73, v154, s82, v161
    v_add_u32 v154, 592, v157
    v_lshrrev_b32 v154, 8, v154
    v_mad_i32_i24 v50, v154, s82, v160
    v_mad_i32_i24 v62, v154, s82, v150
    v_mad_i32_i24 v74, v154, s82, v161
    v_add_u32 v154, 629, v157
    v_lshrrev_b32 v154, 8, v154
    v_mad_i32_i24 v51, v154, s82, v160
    v_mad_i32_i24 v63, v154, s82, v150
    v_mad_i32_i24 v75, v154, s82, v161
    v_add_u32 v154, 666, v157
    v_lshrrev_b32 v154, 8, v154
    v_mad_i32_i24 v52, v154, s82, v160
    v_mad_i32_i24 v64, v154, s82, v150
    v_mad_i32_i24 v76, v154, s82, v161
    v_add_u32 v154, 703, v157
    v_lshrrev_b32 v154, 8, v154
    v_mad_i32_i24 v53, v154, s82, v160
    v_mad_i32_i24 v65, v154, s82, v150
    v_mad_i32_i24 v77, v154, s82, v161
    v_add_u32 v154, 1184, v157
    v_lshrrev_b32 v154, 8, v154
    v_mad_i32_i24 v54, v154, s82, v160
    v_mad_i32_i24 v66, v154, s82, v150
    v_mad_i32_i24 v78, v154, s82, v161
    v_add_u32 v154, 1221, v157
    v_lshrrev_b32 v154, 8, v154
    v_mad_i32_i24 v55, v154, s82, v160
    v_mad_i32_i24 v67, v154, s82, v150
    v_mad_i32_i24 v79, v154, s82, v161
    v_add_u32 v154, 1258, v157
    v_lshrrev_b32 v154, 8, v154
    v_mad_i32_i24 v56, v154, s82, v160
    v_mad_i32_i24 v68, v154, s82, v150
    v_mad_i32_i24 v80, v154, s82, v161
    v_add_u32 v154, 1295, v157
    v_lshrrev_b32 v154, 8, v154
    v_mad_i32_i24 v57, v154, s82, v160
    v_mad_i32_i24 v69, v154, s82, v150
    v_mad_i32_i24 v81, v154, s82, v161
    v_mov_b32 v150, s81
    v_lshlrev_b32 v154, 4, v114
    v_xor_b32 v2, 65536, v154
    v_lshl_add_u32 v3, s16, 10, v154
    s_lshr_b32 s83, s16, 1
    s_and_b32 s84, s16, 1
    s_lshl_b32 s84, s84, 3
    s_lshl_b32 s85, s83, 10
    s_add_u32 s85, s85, s84
    v_add_u32 v4, s85, v154
    s_lshl_b32 s83, s83, 11
    s_add_u32 s83, s83, s84
    s_add_u32 s83, s83, 157888
    s_mul_i32 s86, s16, 2048
    s_add_u32 s86, s86, 149696
    v_lshl_add_u32 v154, v115, 3, s86
    v_mov_b32 v157, s83
    v_mov_b32 v160, 163264
    v_mul_u32_u24 v161, 80, v115
    v_add3_u32 v5, v161, v122, s72
    v_lshl_add_u32 v6, v118, 2, s73
    s_mul_i32 s87, s16, 128
    s_add_u32 s87, s87, 61760
    s_mov_b32 s32, 0x2a8cbccc
    s_mov_b32 s33, 0x38fba882
    s_add_u32 s75, s28, 16384
    s_cmp_lt_u32 s16, 2
    s_cselect_b32 s29, s75, 161984
    s_cselect_b32 s30, 65536, 0
    s_xor_b32 s74, s29, s30
    s_lshl_b32 s94, s5, 1
    s_or_b32 s94, s94, s6
    s_mul_i32 s77, s16, 64
    s_mul_i32 s78, s16, 32
    s_add_u32 s78, s78, 192
    s_add_u32 s34, s18, 2
    s_mov_b32 s27, s26
    s_mov_b32 s26, s25
    s_add_u32 s19, s19, s20
    s_mov_b32 s18, 1
    s_mov_b32 s71, 1
    buffer_load_dwordx4 v128, s[48:51], 0 offen lds
    v_lshrrev_b32 v122, 1, v115
    v_mul_u32_u24 v122, 48, v122
    v_lshl_add_u32 v122, v115, 3, v122
    buffer_load_dwordx4 v130, s[48:51], 0 offen offset:1024 lds
    v_lshl_add_u32 v122, v138, 4, v122
    v_lshl_add_u32 v122, v139, 1, v122
    v_add_u32 v8, s87, v122
    buffer_load_dwordx4 v132, s[48:51], 0 offen offset:2048 lds
    s_add_u32 s48, s48, 36864
    s_addc_u32 s49, s49, 0
    s_add_u32 m0, s68, 3072
    v_mov_b32 v37, 0
    buffer_load_dwordx4 v128, s[48:51], 0 offen lds
    v_mov_b32 v38, 0
    v_mov_b32 v39, 0
    v_add_u32 v175, 86016, v0
    buffer_load_dwordx4 v130, s[48:51], 0 offen offset:1024 lds
    v_add_u32 v174, 86016, v1
    v_lshlrev_b32 v176, 4, v118
    v_add_u32 v176, 161984, v176
    buffer_load_dwordx4 v132, s[48:51], 0 offen offset:2048 lds
    s_add_u32 s48, s48, 36864
    s_addc_u32 s49, s49, 0
    s_add_u32 m0, s69, 0
    buffer_load_ushort v122, v124, s[60:63], 0 offen
    s_mov_b64 s[60:61], s[8:9]
    s_sub_u32 s62, s45, s17
    s_sub_u32 s45, s17, 1
    buffer_load_dwordx3 v[166:168], v131, s[56:59], 0 offen
    v_mul_u32_u24 v177, 336, v118
    buffer_load_dwordx4 v[162:165], v133, s[64:67], 0 offen
    v_add3_u32 v177, v177, v161, s72
    v_mul_u32_u24 v161, 272, v118
    v_add3_u32 v161, v161, v147, s73
    v_mul_u32_u24 v131, 1088, v115
    v_add_u32 v131, v131, v6
    v_add_u32 v179, 5376, v177
    v_add_u32 v180, 4352, v161
    v_add_u32 v178, 4352, v131
    v_cmp_gt_u32 s[88:89], 16, v114
    buffer_load_dwordx4 v[170:173], v133, s[64:67], 0 offen offset:16
    v_mov_b32 v181, 0xf149f2ca
    v_add_u32 v124, 768, v254
    v_mul_u32_u24 v133, 2731, v124
    v_bfe_u32 v169, v133, 17, 3
    v_lshrrev_b32 v133, 16, v133
    v_xor_b32 v124, v169, v124
    v_mul_u32_u24 v169, 37, v133
    v_lshrrev_b32 v169, 8, v169
    v_lshlrev_b32 v124, 4, v124
    v_mad_u32_u24 v13, v169, s70, v124
    v_mul_u32_u24 v169, 37, v133
    v_lshrrev_b32 v169, 8, v169
    v_mul_u32_u24 v124, 7, v169
    v_sub_u32 v124, v133, v124
    v_cmp_gt_u32 vcc, 4, v169
    v_add_u32 v133, 1024, v254
    v_mul_u32_u24 v254, 2731, v133
    v_cndmask_b32 v169, v120, v119, vcc
    v_cmp_gt_u32 vcc, 4, v124
    v_bfe_u32 v182, v254, 17, 3
    v_lshrrev_b32 v254, 16, v254
    v_cndmask_b32 v124, v126, v121, vcc
    v_add3_u32 v13, v13, v169, v124
    v_xor_b32 v133, v182, v133
    v_mul_u32_u24 v182, 37, v254
    v_lshrrev_b32 v182, 8, v182
    v_lshlrev_b32 v133, 4, v133
    v_mad_u32_u24 v14, v182, s70, v133
    v_mul_u32_u24 v133, 37, v254
    v_lshrrev_b32 v133, 8, v133
    v_mul_u32_u24 v124, 7, v133
    v_sub_u32 v124, v254, v124
    v_cmp_gt_u32 vcc, 4, v133
    v_mov_b32 v169, 0xc31044fe
    v_mul_u32_u24 v182, 37, v149
    v_cndmask_b32 v133, v120, v119, vcc
    v_cmp_gt_u32 vcc, 4, v124
    v_lshrrev_b32 v182, 8, v182
    v_mul_u32_u24 v183, 7, v182
    v_cndmask_b32 v124, v126, v121, vcc
    v_add3_u32 v14, v14, v133, v124
    v_cmp_gt_u32 vcc, 48, v254
    v_sub_u32 v183, v149, v183
    v_lshrrev_b32 v182, 2, v182
    v_cndmask_b32 v14, v255, v14, vcc
    v_cmp_gt_u32 vcc, 2, v139
    v_lshrrev_b32 v183, 2, v183
    v_and_b32 v182, s5, v182
    v_cndmask_b32 v32, 0, v136, vcc
    v_cndmask_b32 v33, v136, 0, vcc
    v_cndmask_b32 v34, 0, v136, vcc
    v_cndmask_b32 v35, v136, 0, vcc
    v_cmp_eq_u32 vcc, 0, v139
    v_and_b32 v183, s6, v183
    v_lshl_or_b32 v182, v182, 1, v183
    v_cndmask_b32 v40, 0, v145, vcc
    v_cndmask_b32 v29, 0, v28, vcc
    v_cndmask_b32 v30, 0, v28, vcc
    v_cndmask_b32 v31, 0, v28, vcc
    v_cndmask_b32 v28, 0, v28, vcc
    v_cndmask_b32 v146, v146, 0, vcc
    v_cmp_eq_u32 vcc, 1, v139
    v_add3_u32 v9, v146, v147, s87
    v_mul_u32_u24 v133, 37, v155
    s_bfm_b32 s70, s17, 0
    s_waitcnt vmcnt(9)
    s_barrier
    global_load_ushort v116, v116, s[46:47]
    v_cndmask_b32 v41, 0, v145, vcc
    v_cmp_eq_u32 vcc, 2, v139
    v_lshrrev_b32 v133, 8, v133
    v_mul_u32_u24 v124, 7, v133
    v_cndmask_b32 v42, 0, v145, vcc
    v_cmp_eq_u32 vcc, 3, v139
    v_sub_u32 v124, v155, v124
    v_lshrrev_b32 v133, 2, v133
    v_cndmask_b32 v43, 0, v145, vcc
    v_cmp_eq_u32 vcc, v115, v138
    v_lshrrev_b32 v124, 2, v124
    buffer_load_dwordx4 v128, s[48:51], 0 offen lds
    v_cndmask_b32 v254, 0, v32, vcc
    v_cndmask_b32 v255, 0, v33, vcc
    v_and_b32 v133, s5, v133
    v_and_b32 v124, s6, v124
    v_lshl_or_b32 v133, v133, 1, v124
    v_mul_u32_u24 v145, 37, v159
    v_lshrrev_b32 v145, 8, v145
    v_mul_u32_u24 v124, 7, v145
    v_sub_u32 v124, v159, v124
    v_lshrrev_b32 v145, 2, v145
    v_lshrrev_b32 v124, 2, v124
    v_and_b32 v145, s5, v145
    v_and_b32 v124, s6, v124
    v_lshl_or_b32 v145, v145, 1, v124
    v_mul_u32_u24 v124, 6, v117
    buffer_load_dwordx4 v130, s[48:51], 0 offen offset:1024 lds
    s_waitcnt vmcnt(10)
    ds_read_b64_tr_b16 a[72:73], v140 offset:0
    ds_read_b64_tr_b16 a[74:75], v140 offset:768
    ds_read_b64_tr_b16 a[96:97], v140 offset:32
    ds_read_b64_tr_b16 a[98:99], v140 offset:800
    ds_read_b64_tr_b16 a[120:121], v140 offset:64
    ds_read_b64_tr_b16 a[122:123], v140 offset:832
    v_sub_u32 v136, v114, v124
    v_mul_u32_u24 v124, 384, v117
    v_lshl_add_u32 v124, v136, 4, v124
    v_add_u32 v155, s78, v124
    v_add_u32 v124, s77, v124
    v_cmp_gt_i32 vcc, 4, v136
    v_mul_u32_u24 v136, 6, v127
    v_sub_u32 v117, v114, v136
    buffer_load_dwordx4 v132, s[48:51], 0 offen offset:2048 lds
    s_add_u32 s48, s48, 36864
    s_addc_u32 s49, s49, 0
    s_add_u32 m0, s69, 3072
    v_cndmask_b32 v159, v155, v124, vcc
    v_mul_u32_u24 v136, 384, v127
    v_lshl_add_u32 v136, v117, 4, v136
    v_add_u32 v124, s78, v136
    v_add_u32 v136, s77, v136
    v_cmp_gt_i32 vcc, -60, v117
    v_mul_u32_u24 v117, 6, v129
    v_sub_u32 v155, v114, v117
    v_cndmask_b32 v127, v124, v136, vcc
    v_mul_u32_u24 v117, 384, v129
    v_lshl_add_u32 v117, v155, 4, v117
    v_add_u32 v114, s78, v117
    buffer_load_dwordx4 v128, s[48:51], 0 offen lds
    v_add_u32 v117, s77, v117
    v_cmp_gt_i32 vcc, -124, v155
    v_mul_u32_u24 v124, 96, v118
    v_add3_u32 v183, v124, v147, s68
    v_cndmask_b32 v185, v114, v117, vcc
    v_cmp_gt_u32 vcc, 4, v151
    v_lshl_add_u32 v129, v115, 3, v124
    v_add3_u32 v129, v129, 64, s68
    v_cndmask_b32 v151, v120, v119, vcc
    v_cmp_gt_u32 vcc, 4, v153
    v_add3_u32 v184, v124, v147, s69
    v_lshl_add_u32 v114, v115, 3, v124
    v_cndmask_b32 v153, v126, v121, vcc
    s_waitcnt vmcnt(9)
    s_and_b32 s77, s2, 0xf8
    ds_read_b64_tr_b16 a[76:77], v140 offset:3072
    ds_read_b64_tr_b16 a[78:79], v140 offset:3840
    s_waitcnt vmcnt(7)
    buffer_load_dwordx4 v130, s[48:51], 0 offen offset:1024 lds
    s_waitcnt vmcnt(7)
    ds_read_b64_tr_b16 a[100:101], v140 offset:3104
    s_waitcnt vmcnt(6)
    ds_read_b64_tr_b16 a[102:103], v140 offset:3872
    ds_read_b64_tr_b16 a[124:125], v140 offset:3136
    ds_read_b64_tr_b16 a[126:127], v140 offset:3904
    v_cndmask_b32 v162, v162, v163, s[92:93]
    v_cndmask_b32 v164, v164, v165, s[92:93]
    v_perm_b32 v162, v164, v162, v134
    v_cndmask_b32 v170, v170, v171, s[92:93]
    v_cndmask_b32 v172, v172, v173, s[92:93]
    v_perm_b32 v163, v172, v170, v134
    v_bfe_u32 v136, v166, v147, 16
    v_bfe_u32 v134, v167, v147, 16
    v_bfe_u32 v124, v168, v147, 16
    v_mfma_f32_16x16x16_bf16 v[170:173], v[122:123], v[136:137], 0
    v_add3_u32 v15, v15, v151, v153
    v_add3_u32 v18, v18, v151, v153
    v_cmp_gt_u32 vcc, 4, v156
    v_mfma_f32_16x16x16_bf16 v[194:197], v[122:123], v[134:135], 0
    v_add3_u32 v114, v114, 64, s69
    v_cndmask_b32 v156, v120, v119, vcc
    v_cmp_gt_u32 vcc, 4, v158
    v_mfma_f32_16x16x16_bf16 v[134:137], v[122:123], v[124:125], 0
    s_add_u32 s77, s77, 4940
    s_mul_i32 s78, s77, 58255
    s_lshr_b32 s78, s78, 22
    buffer_load_dwordx4 v132, s[48:51], 0 offen offset:2048 lds
    s_add_u32 s48, s48, 36864
    s_addc_u32 s49, s49, 0
    s_add_u32 m0, s72, 0
    v_max_f32 v170, 0, v170
    v_max_f32 v171, 0, v171
    s_waitcnt vmcnt(6)
    v_lshlrev_b32 v116, 16, v116
    v_max_f32 v116, 0xc2c80000, v116
    v_min_f32 v116, 0x40930000, v116
    v_mul_f32 v116, 0x3fb8aa3b, v116
    v_exp_f32 v116, v116
    v_max_f32 v172, 0, v172
    v_cvt_pk_bf16_f32 v116, v116, v116
    v_and_b32 v116, 0xffff0000, v116
    buffer_load_dwordx4 v128, s[48:51], 0 offen lds
    v_mul_f32 v116, 0x3fb8aa3b, v116
    v_mul_f32 v155, 0xbea8f5c3, v116
    v_add_f32 v155, 0xc138aa3b, v155
    v_readlane_b32 s31, v116, s90
    v_max_f32 v173, 0, v173
    v_cvt_pk_bf16_f32 v116, v170, v171
    v_cvt_pk_bf16_f32 v117, v172, v173
    v_max_f32 v194, 0, v194
    v_max_f32 v195, 0, v195
    v_mfma_f32_16x16x16_bf16 v[122:125], v[162:163], v[116:117], 0
    v_max_f32 v196, 0, v196
    v_max_f32 v197, 0, v197
    v_cvt_pk_bf16_f32 v116, v194, v195
    v_cvt_pk_bf16_f32 v117, v196, v197
    v_max_f32 v134, 0, v134
    buffer_load_dwordx4 v130, s[48:51], 0 offen offset:1024 lds
    v_mfma_f32_16x16x16_bf16 v[170:173], v[162:163], v[116:117], 0
    v_max_f32 v135, 0, v135
    v_cvt_pk_bf16_f32 v122, v122, v122
    v_and_b32 v122, 0xffff0000, v122
    v_mul_f32 v122, 0xbfb8aa3b, v122
    v_exp_f32 v122, v122
    v_max_f32 v136, 0, v136
    v_add_f32 v122, 1.0, v122
    v_rcp_f32 v122, v122
    v_cvt_pk_bf16_f32 v170, v170, v170
    v_cvt_pk_bf16_f32 v122, v122, v122
    v_and_b32 v122, 0xffff0000, v122
    v_fmamk_f32 v122, v122, 0x41b8aa3b, v155
    buffer_load_dwordx4 v132, s[48:51], 0 offen offset:2048 lds
    ds_write_b32 v142, v122 offset:0
    s_waitcnt vmcnt(6)
    s_add_u32 s48, s48, 36864
    s_addc_u32 s49, s49, 0
    s_add_u32 m0, s72, 3072
    s_mov_b32 s72, 2
    ds_read_b64_tr_b16 a[80:81], v141 offset:0
    ds_read_b64_tr_b16 a[82:83], v141 offset:768
    ds_read_b64_tr_b16 a[104:105], v141 offset:32
    ds_read_b64_tr_b16 a[106:107], v141 offset:800
    ds_read_b64_tr_b16 a[128:129], v141 offset:64
    ds_read_b64_tr_b16 a[130:131], v141 offset:832
    v_and_b32 v170, 0xffff0000, v170
    buffer_load_dwordx4 v128, s[48:51], 0 offen lds
    v_mul_f32 v170, 0xbfb8aa3b, v170
    v_exp_f32 v170, v170
    v_max_f32 v137, 0, v137
    v_add_f32 v170, 1.0, v170
    v_rcp_f32 v170, v170
    v_cvt_pk_bf16_f32 v116, v134, v135
    v_cvt_pk_bf16_f32 v170, v170, v170
    v_and_b32 v170, 0xffff0000, v170
    v_fmamk_f32 v170, v170, 0x41b8aa3b, v155
    ds_write_b32 v142, v170 offset:4
    buffer_load_dwordx4 v130, s[48:51], 0 offen offset:1024 lds
    v_cvt_pk_bf16_f32 v117, v136, v137
    v_cndmask_b32 v158, v126, v121, vcc
    v_add3_u32 v16, v16, v156, v158
    v_mfma_f32_16x16x16_bf16 v[134:137], v[162:163], v[116:117], 0
    v_add3_u32 v19, v19, v156, v158
    v_cmp_gt_u32 vcc, 4, v148
    s_nop 0
    s_nop 0
    v_cndmask_b32 v148, v120, v119, vcc
    v_cmp_gt_u32 vcc, 4, v152
    s_nop 0
    s_nop 0
    v_cvt_pk_bf16_f32 v134, v134, v134
    v_and_b32 v134, 0xffff0000, v134
    v_mul_f32 v134, 0xbfb8aa3b, v134
    buffer_load_dwordx4 v132, s[48:51], 0 offen offset:2048 lds
    s_sub_u32 s48, s48, 184704
    s_subb_u32 s49, s49, 0
    s_add_u32 m0, s73, 0
    v_exp_f32 v134, v134
    v_cndmask_b32 v152, v126, v121, vcc
    v_add_f32 v134, 1.0, v134
    v_rcp_f32 v134, v134
    v_add3_u32 v17, v17, v148, v152
    v_cvt_pk_bf16_f32 v134, v134, v134
    v_and_b32 v134, 0xffff0000, v134
    v_fmamk_f32 v134, v134, 0x41b8aa3b, v155
    ds_write_b32 v142, v134 offset:8
    s_waitcnt vmcnt(6)
    buffer_load_dwordx4 v128, s[48:51], 0 offen lds
    v_add3_u32 v20, v20, v148, v152
    v_cmp_gt_u32 vcc, 2, v115
    ds_read_b64_tr_b16 a[84:85], v141 offset:3072
    ds_read_b64_tr_b16 a[86:87], v141 offset:3840
    ds_read_b64_tr_b16 a[108:109], v141 offset:3104
    ds_read_b64_tr_b16 a[110:111], v141 offset:3872
    ds_read_b64_tr_b16 a[132:133], v141 offset:3136
    ds_read_b64_tr_b16 a[134:135], v141 offset:3904
    v_cndmask_b32 v154, v157, v154, vcc
    v_lshl_add_u32 v154, v138, 9, v154
    v_lshl_add_u32 v154, v139, 1, v154
    v_cmp_gt_u32 vcc, 3, v115
    s_nop 0
    buffer_load_dwordx4 v130, s[48:51], 0 offen offset:1024 lds
    v_cndmask_b32 v7, v160, v154, vcc
    v_cmp_gt_u32 vcc, 12, v118
    s_nop 0
    s_nop 0
    v_cndmask_b32 v179, v176, v179, vcc
    v_cndmask_b32 v180, v176, v180, vcc
    s_waitcnt lgkmcnt(6)
    s_barrier
    ds_read_b32 v22, v22 offset:0
    ds_read_b32 v23, v23 offset:672
    ds_read_b32 v24, v24 offset:0
    ds_read_b32 v25, v25 offset:672
    ds_read_b32 v26, v26 offset:0
    ds_read_b32 v27, v27 offset:672
    ds_read_b32 v46, v46 offset:336
    ds_read_b32 v58, v58 offset:336
    buffer_load_dwordx4 v132, s[48:51], 0 offen offset:2048 lds
    ds_read_b32 v70, v70 offset:336
    ds_read_b32 v47, v47 offset:332
    s_add_u32 s48, s48, 36864
    ds_read_b32 v59, v59 offset:332
    s_addc_u32 s49, s49, 0
    ds_read_b32 v71, v71 offset:332
    s_add_u32 m0, s73, 3072
    ds_read_b32 v48, v48 offset:328
    v_cmp_gt_u32 vcc, 3, v115
    s_mov_b32 s73, 3
    ds_read_b32 v60, v60 offset:328
    s_waitcnt vmcnt(6)
    ds_read_b64_tr_b16 a[88:89], v144 offset:0
    buffer_load_dwordx4 v128, s[48:51], 0 offen lds
    ds_read_b64_tr_b16 a[90:91], v144 offset:768
    ds_read_b64_tr_b16 a[112:113], v144 offset:32
    ds_read_b64_tr_b16 a[114:115], v144 offset:800
    ds_read_b64_tr_b16 a[136:137], v144 offset:64
    ds_read_b64_tr_b16 a[138:139], v144 offset:832
    ds_read_b32 v72, v72 offset:328
    v_cndmask_b32 v178, v176, v178, vcc
    ds_read_b32 v49, v49 offset:324
    ds_read_b32 v61, v61 offset:324
    ds_read_b32 v73, v73 offset:324
    ds_read_b32 v50, v50 offset:272
    ds_read_b32 v62, v62 offset:272
    buffer_load_dwordx4 v130, s[48:51], 0 offen offset:1024 lds
    ds_read_b32 v74, v74 offset:272
    ds_read_b32 v51, v51 offset:268
    ds_read_b32 v63, v63 offset:268
    ds_read_b32 v75, v75 offset:268
    ds_read_b32 v52, v52 offset:264
    ds_read_b32 v64, v64 offset:264
    ds_read_b32 v76, v76 offset:264
    ds_read_b32 v53, v53 offset:260
    ds_read_b32 v65, v65 offset:260
    buffer_load_dwordx4 v132, s[48:51], 0 offen offset:2048 lds
    ds_read_b32 v77, v77 offset:260
    ds_read_b32 v54, v54 offset:208
    s_add_u32 s48, s48, 36864
    ds_read_b32 v66, v66 offset:208
    s_addc_u32 s49, s49, 0
    ds_read_b32 v78, v78 offset:208
    s_add_u32 m0, s68, 0
    ds_read_b32 v55, v55 offset:204
    ds_read_b32 v67, v67 offset:204
    ds_read_b32 v79, v79 offset:204
    ds_read_b32 v56, v56 offset:200
    ds_read_b32 v68, v68 offset:200
    s_waitcnt vmcnt(6)
    buffer_load_dwordx4 v128, s[48:51], 0 offen lds
    ds_read_b64_tr_b16 a[92:93], v144 offset:3072
    ds_read_b64_tr_b16 a[94:95], v144 offset:3840
    ds_read_b64_tr_b16 a[116:117], v144 offset:3104
    ds_read_b64_tr_b16 a[118:119], v144 offset:3872
    ds_read_b64_tr_b16 a[140:141], v144 offset:3136
    ds_read_b64_tr_b16 a[142:143], v144 offset:3904
    ds_read_b32 v80, v80 offset:200
    ds_read_b32 v57, v57 offset:196
    ds_read_b32 v69, v69 offset:196
    buffer_load_dwordx4 v130, s[48:51], 0 offen offset:1024 lds
    ds_read_b32 v81, v81 offset:196
    ds_read_b32 v150, v150 offset:336
    v_cmp_ne_u32 vcc, s94, v182
    v_lshl_add_u32 v126, v115, 2, 0
    v_mul_u32_u24 v116, 37, v126
    v_cndmask_b32 v176, 0, v169, vcc
    s_waitcnt lgkmcnt(12)
    v_add_f32 v22, v22, v176
    v_cmp_ne_u32 vcc, s94, v182
    v_lshrrev_b32 v116, 8, v116
    v_mul_u32_u24 v117, 7, v116
    v_cndmask_b32 v176, 0, v169, vcc
    v_add_f32 v23, v23, v176
    v_cmp_ne_u32 vcc, s94, v133
    v_sub_u32 v117, v126, v117
    buffer_load_dwordx4 v132, s[48:51], 0 offen offset:2048 lds
    s_add_u32 s48, s48, 36864
    s_addc_u32 s49, s49, 0
    s_add_u32 m0, s68, 3072
    v_cndmask_b32 v126, 0, v169, vcc
    v_add_f32 v24, v24, v126
    v_cmp_ne_u32 vcc, s94, v133
    v_lshrrev_b32 v116, 2, v116
    v_lshrrev_b32 v117, 2, v117
    v_cndmask_b32 v126, 0, v169, vcc
    v_add_f32 v25, v25, v126
    v_cmp_ne_u32 vcc, s94, v145
    s_waitcnt lgkmcnt(0)
    v_readfirstlane_b32 s39, v150
    v_cndmask_b32 v126, 0, v169, vcc
    v_add_f32 v26, v26, v126
    buffer_load_dwordx4 v128, s[48:51], 0 offen lds
    s_waitcnt vmcnt(7)
    ds_read_b64_tr_b16 a[0:1], v143 offset:0
    ds_read_b64_tr_b16 a[2:3], v143 offset:768
    ds_read_b64_tr_b16 a[24:25], v143 offset:32
    ds_read_b64_tr_b16 a[26:27], v143 offset:800
    ds_read_b64_tr_b16 a[48:49], v143 offset:64
    ds_read_b64_tr_b16 a[50:51], v143 offset:832
    v_cmp_ne_u32 vcc, s94, v145
    v_and_b32 v116, s5, v116
    v_and_b32 v117, s6, v117
    v_cndmask_b32 v126, 0, v169, vcc
    v_add_f32 v27, v27, v126
    v_lshl_or_b32 v116, v116, 1, v117
    v_cmp_ne_u32 vcc, v116, v182
    v_lshl_add_u32 v126, v115, 2, 1
    buffer_load_dwordx4 v130, s[48:51], 0 offen offset:1024 lds
    v_cndmask_b32 v117, 0, v169, vcc
    v_add_f32 v46, v46, v117
    v_cmp_ne_u32 vcc, v116, v133
    v_mul_u32_u24 v176, 37, v126
    v_lshrrev_b32 v176, 8, v176
    v_cndmask_b32 v117, 0, v169, vcc
    v_add_f32 v58, v58, v117
    v_cmp_ne_u32 vcc, v116, v145
    v_mul_u32_u24 v116, 7, v176
    v_sub_u32 v116, v126, v116
    v_cndmask_b32 v117, 0, v169, vcc
    v_add_f32 v70, v70, v117
    v_lshrrev_b32 v176, 2, v176
    v_lshrrev_b32 v116, 2, v116
    v_and_b32 v176, s5, v176
    buffer_load_dwordx4 v132, s[48:51], 0 offen offset:2048 lds
    s_add_u32 s48, s48, 36864
    s_addc_u32 s49, s49, 0
    s_add_u32 m0, s69, 0
    v_and_b32 v116, s6, v116
    v_lshl_or_b32 v176, v176, 1, v116
    v_cmp_ne_u32 vcc, v176, v182
    v_lshl_add_u32 v116, v115, 2, 2
    v_mul_u32_u24 v126, 37, v116
    v_cndmask_b32 v117, 0, v169, vcc
    v_add_f32 v47, v47, v117
    v_cmp_ne_u32 vcc, v176, v133
    v_lshrrev_b32 v126, 8, v126
    v_mul_u32_u24 v138, 7, v126
    v_cndmask_b32 v117, 0, v169, vcc
    v_add_f32 v59, v59, v117
    buffer_load_dwordx4 v128, s[48:51], 0 offen lds
    s_waitcnt vmcnt(7)
    ds_read_b64_tr_b16 a[4:5], v143 offset:3072
    ds_read_b64_tr_b16 a[6:7], v143 offset:3840
    ds_read_b64_tr_b16 a[28:29], v143 offset:3104
    ds_read_b64_tr_b16 a[30:31], v143 offset:3872
    ds_read_b64_tr_b16 a[52:53], v143 offset:3136
    ds_read_b64_tr_b16 a[54:55], v143 offset:3904
    v_cmp_ne_u32 vcc, v176, v145
    v_sub_u32 v138, v116, v138
    v_lshrrev_b32 v126, 2, v126
    v_cndmask_b32 v139, 0, v169, vcc
    v_add_f32 v71, v71, v139
    v_lshrrev_b32 v138, 2, v138
    v_and_b32 v126, s5, v126
    v_and_b32 v138, s6, v138
    buffer_load_dwordx4 v130, s[48:51], 0 offen offset:1024 lds
    v_lshl_or_b32 v126, v126, 1, v138
    v_cmp_ne_u32 vcc, v126, v182
    v_lshl_add_u32 v116, v115, 2, 3
    v_mul_u32_u24 v176, 37, v116
    v_cndmask_b32 v117, 0, v169, vcc
    v_add_f32 v48, v48, v117
    v_cmp_ne_u32 vcc, v126, v133
    v_lshrrev_b32 v176, 8, v176
    v_mul_u32_u24 v117, 7, v176
    v_cndmask_b32 v138, 0, v169, vcc
    v_add_f32 v60, v60, v138
    v_cmp_ne_u32 vcc, v126, v145
    v_sub_u32 v117, v116, v117
    v_lshrrev_b32 v176, 2, v176
    v_cndmask_b32 v116, 0, v169, vcc
    buffer_load_dwordx4 v132, s[48:51], 0 offen offset:2048 lds
    s_add_u32 s48, s48, 36864
    s_addc_u32 s49, s49, 0
    s_add_u32 m0, s69, 3072
    v_add_f32 v72, v72, v116
    v_lshrrev_b32 v117, 2, v117
    v_and_b32 v176, s5, v176
    v_and_b32 v117, s6, v117
    v_lshl_or_b32 v176, v176, 1, v117
    v_cmp_ne_u32 vcc, v176, v182
    v_lshl_add_u32 v116, v115, 2, 16
    v_mul_u32_u24 v126, 37, v116
    v_cndmask_b32 v117, 0, v169, vcc
    v_add_f32 v49, v49, v117
    v_cmp_ne_u32 vcc, v176, v133
    v_lshrrev_b32 v126, 8, v126
    buffer_load_dwordx4 v128, s[48:51], 0 offen lds
    s_waitcnt vmcnt(7)
    ds_read_b64_tr_b16 a[8:9], v140 offset:0
    ds_read_b64_tr_b16 a[10:11], v140 offset:768
    ds_read_b64_tr_b16 a[32:33], v140 offset:32
    ds_read_b64_tr_b16 a[34:35], v140 offset:800
    ds_read_b64_tr_b16 a[56:57], v140 offset:64
    ds_read_b64_tr_b16 a[58:59], v140 offset:832
    v_cndmask_b32 v117, 0, v169, vcc
    v_add_f32 v61, v61, v117
    v_cmp_ne_u32 vcc, v176, v145
    v_mul_u32_u24 v176, 7, v126
    v_sub_u32 v176, v116, v176
    v_cndmask_b32 v116, 0, v169, vcc
    v_add_f32 v73, v73, v116
    v_lshrrev_b32 v126, 2, v126
    buffer_load_dwordx4 v130, s[48:51], 0 offen offset:1024 lds
    v_lshrrev_b32 v176, 2, v176
    v_and_b32 v126, s5, v126
    v_and_b32 v176, s6, v176
    v_lshl_or_b32 v126, v126, 1, v176
    v_cmp_ne_u32 vcc, v126, v182
    v_lshl_add_u32 v176, v115, 2, 17
    v_mul_u32_u24 v117, 37, v176
    v_cndmask_b32 v116, 0, v169, vcc
    v_add_f32 v50, v50, v116
    v_cmp_ne_u32 vcc, v126, v133
    v_lshrrev_b32 v117, 8, v117
    v_mul_u32_u24 v138, 7, v117
    v_cndmask_b32 v116, 0, v169, vcc
    v_add_f32 v62, v62, v116
    v_cmp_ne_u32 vcc, v126, v145
    buffer_load_dwordx4 v132, s[48:51], 0 offen offset:2048 lds
    s_sub_u32 s48, s48, 183552
    s_subb_u32 s49, s49, 0
    s_add_u32 m0, s68, 0
    s_waitcnt lgkmcnt(0)
    v_cndmask_b32 v116, 0, v169, vcc
    v_add_f32 v74, v74, v116
    v_sub_u32 v138, v176, v138
    v_lshrrev_b32 v117, 2, v117
    v_lshrrev_b32 v138, 2, v138
    v_and_b32 v117, s5, v117
    v_and_b32 v138, s6, v138
    v_lshl_or_b32 v117, v117, 1, v138
    v_cmp_ne_u32 vcc, v117, v182
    v_lshl_add_u32 v126, v115, 2, 18
    buffer_load_dwordx4 v128, s[48:51], 0 offen lds
    s_waitcnt vmcnt(7)
    ds_read_b64_tr_b16 a[12:13], v140 offset:3072
    ds_read_b64_tr_b16 a[14:15], v140 offset:3840
    ds_read_b64_tr_b16 a[36:37], v140 offset:3104
    ds_read_b64_tr_b16 a[38:39], v140 offset:3872
    ds_read_b64_tr_b16 a[60:61], v140 offset:3136
    ds_read_b64_tr_b16 a[62:63], v140 offset:3904
    v_cndmask_b32 v116, 0, v169, vcc
    v_add_f32 v51, v51, v116
    v_cmp_ne_u32 vcc, v117, v133
    v_mul_u32_u24 v176, 37, v126
    v_lshrrev_b32 v176, 8, v176
    v_cndmask_b32 v116, 0, v169, vcc
    v_add_f32 v63, v63, v116
    v_cmp_ne_u32 vcc, v117, v145
    buffer_load_dwordx4 v130, s[48:51], 0 offen offset:1024 lds
    v_mul_u32_u24 v117, 7, v176
    v_cndmask_b32 v116, 0, v169, vcc
    v_add_f32 v75, v75, v116
    v_sub_u32 v117, v126, v117
    v_lshrrev_b32 v176, 2, v176
    v_lshrrev_b32 v117, 2, v117
    v_and_b32 v176, s5, v176
    v_and_b32 v117, s6, v117
    v_lshl_or_b32 v176, v176, 1, v117
    v_cmp_ne_u32 vcc, v176, v182
    v_lshl_add_u32 v126, v115, 2, 19
    v_mul_u32_u24 v117, 37, v126
    v_cndmask_b32 v116, 0, v169, vcc
    v_add_f32 v52, v52, v116
    v_cmp_ne_u32 vcc, v176, v133
    buffer_load_dwordx4 v132, s[48:51], 0 offen offset:2048 lds
    s_add_u32 s48, s48, 36864
    s_addc_u32 s49, s49, 0
    s_add_u32 m0, s68, 3072
    s_waitcnt lgkmcnt(0)
    v_cndmask_b32 v116, 0, v169, vcc
    v_add_f32 v64, v64, v116
    v_cmp_ne_u32 vcc, v176, v145
    v_lshrrev_b32 v117, 8, v117
    v_mul_u32_u24 v176, 7, v117
    v_cndmask_b32 v116, 0, v169, vcc
    v_add_f32 v76, v76, v116
    v_sub_u32 v176, v126, v176
    v_lshrrev_b32 v117, 2, v117
    v_lshrrev_b32 v176, 2, v176
    buffer_load_dwordx4 v128, s[48:51], 0 offen lds
    s_waitcnt vmcnt(7)
    ds_read_b64_tr_b16 a[16:17], v141 offset:0
    ds_read_b64_tr_b16 a[18:19], v141 offset:768
    ds_read_b64_tr_b16 a[40:41], v141 offset:32
    ds_read_b64_tr_b16 a[42:43], v141 offset:800
    ds_read_b64_tr_b16 a[64:65], v141 offset:64
    ds_read_b64_tr_b16 a[66:67], v141 offset:832
    v_and_b32 v117, s5, v117
    v_and_b32 v176, s6, v176
    v_lshl_or_b32 v117, v117, 1, v176
    v_cmp_ne_u32 vcc, v117, v182
    v_lshl_add_u32 v126, v115, 2, 32
    v_mul_u32_u24 v176, 37, v126
    v_cndmask_b32 v116, 0, v169, vcc
    v_add_f32 v53, v53, v116
    buffer_load_dwordx4 v130, s[48:51], 0 offen offset:1024 lds
    v_cmp_ne_u32 vcc, v117, v133
    v_lshrrev_b32 v176, 8, v176
    v_mul_u32_u24 v116, 7, v176
    v_cndmask_b32 v138, 0, v169, vcc
    v_add_f32 v65, v65, v138
    v_cmp_ne_u32 vcc, v117, v145
    v_sub_u32 v116, v126, v116
    v_lshrrev_b32 v176, 2, v176
    v_cndmask_b32 v117, 0, v169, vcc
    v_add_f32 v77, v77, v117
    v_lshrrev_b32 v116, 2, v116
    v_and_b32 v176, s5, v176
    v_and_b32 v116, s6, v116
    v_lshl_or_b32 v176, v176, 1, v116
    v_cmp_ne_u32 vcc, v176, v182
    buffer_load_dwordx4 v132, s[48:51], 0 offen offset:2048 lds
    s_add_u32 s48, s48, 36864
    s_addc_u32 s49, s49, 0
    s_add_u32 m0, s69, 0
    s_waitcnt lgkmcnt(0)
    v_cndmask_b32 v126, 0, v169, vcc
    v_add_f32 v54, v54, v126
    v_cmp_ne_u32 vcc, v176, v133
    v_lshl_add_u32 v126, v115, 2, 33
    v_mul_u32_u24 v117, 37, v126
    v_cndmask_b32 v116, 0, v169, vcc
    v_add_f32 v66, v66, v116
    v_cmp_ne_u32 vcc, v176, v145
    v_lshrrev_b32 v117, 8, v117
    v_mul_u32_u24 v116, 7, v117
    buffer_load_dwordx4 v128, s[48:51], 0 offen lds
    s_waitcnt vmcnt(7)
    ds_read_b64_tr_b16 a[20:21], v141 offset:3072
    ds_read_b64_tr_b16 a[22:23], v141 offset:3840
    ds_read_b64_tr_b16 a[44:45], v141 offset:3104
    ds_read_b64_tr_b16 a[46:47], v141 offset:3872
    ds_read_b64_tr_b16 a[68:69], v141 offset:3136
    ds_read_b64_tr_b16 a[70:71], v141 offset:3904
    v_cndmask_b32 v176, 0, v169, vcc
    v_add_f32 v78, v78, v176
    v_sub_u32 v116, v126, v116
    v_lshrrev_b32 v117, 2, v117
    v_lshrrev_b32 v116, 2, v116
    v_and_b32 v117, s5, v117
    v_and_b32 v116, s6, v116
    v_lshl_or_b32 v117, v117, 1, v116
    buffer_load_dwordx4 v130, s[48:51], 0 offen offset:1024 lds
    v_cmp_ne_u32 vcc, v117, v182
    v_lshl_add_u32 v176, v115, 2, 34
    v_mul_u32_u24 v126, 37, v176
    v_cndmask_b32 v116, 0, v169, vcc
    v_add_f32 v55, v55, v116
    v_cmp_ne_u32 vcc, v117, v133
    v_lshrrev_b32 v126, 8, v126
    v_mul_u32_u24 v138, 7, v126
    v_cndmask_b32 v116, 0, v169, vcc
    v_add_f32 v67, v67, v116
    v_cmp_ne_u32 vcc, v117, v145
    v_sub_u32 v138, v176, v138
    v_lshrrev_b32 v126, 2, v126
    v_cndmask_b32 v176, 0, v169, vcc
    v_add_f32 v79, v79, v176
    buffer_load_dwordx4 v132, s[48:51], 0 offen offset:2048 lds
    s_add_u32 s48, s48, 36864
    s_addc_u32 s49, s49, 0
    s_add_u32 m0, s69, 3072
    s_waitcnt lgkmcnt(0)
    v_lshrrev_b32 v138, 2, v138
    v_and_b32 v126, s5, v126
    v_and_b32 v138, s6, v138
    v_lshl_or_b32 v126, v126, 1, v138
    v_cmp_ne_u32 vcc, v126, v182
    v_lshl_add_u32 v139, v115, 2, 35
    v_mul_u32_u24 v138, 37, v139
    v_cndmask_b32 v176, 0, v169, vcc
    v_add_f32 v56, v56, v176
    v_cmp_ne_u32 vcc, v126, v133
    v_lshrrev_b32 v138, 8, v138
    buffer_load_dwordx4 v128, s[48:51], 0 offen lds
    s_waitcnt vmcnt(7)
    ds_read_b64_tr_b16 a[144:145], v140 offset:0
    ds_read_b64_tr_b16 a[146:147], v140 offset:768
    ds_read_b64_tr_b16 a[168:169], v140 offset:32
    ds_read_b64_tr_b16 a[170:171], v140 offset:800
    ds_read_b64_tr_b16 a[192:193], v140 offset:64
    ds_read_b64_tr_b16 a[194:195], v140 offset:832
    v_cndmask_b32 v176, 0, v169, vcc
    v_add_f32 v68, v68, v176
    v_cmp_ne_u32 vcc, v126, v145
    v_mul_u32_u24 v126, 7, v138
    v_sub_u32 v126, v139, v126
    v_cndmask_b32 v139, 0, v169, vcc
    v_add_f32 v80, v80, v139
    v_lshrrev_b32 v138, 2, v138
    buffer_load_dwordx4 v130, s[48:51], 0 offen offset:1024 lds
    v_lshrrev_b32 v126, 2, v126
    v_and_b32 v138, s5, v138
    v_and_b32 v126, s6, v126
    v_lshl_or_b32 v138, v138, 1, v126
    v_cmp_ne_u32 vcc, v138, v182
    v_cndmask_b32 v22, v181, v22, s[88:89]
    v_cndmask_b32 v24, v181, v24, s[88:89]
    v_cndmask_b32 v126, 0, v169, vcc
    v_add_f32 v57, v57, v126
    v_cmp_ne_u32 vcc, v138, v133
    v_mov_b32_dpp v23, v25 quad_perm:[0,1,2,3] row_mask:0x2 bank_mask:0xf
    v_cndmask_b32 v26, v181, v26, s[88:89]
    v_cndmask_b32 v126, 0, v169, vcc
    v_add_f32 v69, v69, v126
    v_cmp_ne_u32 vcc, v138, v145
    buffer_load_dwordx4 v132, s[48:51], 0 offen offset:2048 lds
    s_add_u32 s48, s48, 36864
    s_addc_u32 s49, s49, 0
    s_add_u32 m0, s68, 0
    s_waitcnt lgkmcnt(0)
    v_cndmask_b32 v126, 0, v169, vcc
    v_add_f32 v81, v81, v126
    ds_read_b128 v[166:169], v175 offset:0
    ds_read_b128 v[122:125], v174 offset:0
    ds_read_b128 v[134:137], v175 offset:128
    ds_read_b128 v[150:153], v174 offset:128
    buffer_load_dwordx4 v128, s[48:51], 0 offen lds
    s_waitcnt vmcnt(7)
    ds_read_b64_tr_b16 a[148:149], v140 offset:3072
    ds_read_b64_tr_b16 a[150:151], v140 offset:3840
    ds_read_b64_tr_b16 a[172:173], v140 offset:3104
    ds_read_b64_tr_b16 a[174:175], v140 offset:3872
    ds_read_b64_tr_b16 a[196:197], v140 offset:3136
    ds_read_b64_tr_b16 a[198:199], v140 offset:3904
    ds_read_b128 v[142:145], v175 offset:256
    ds_read_b128 v[162:165], v174 offset:256
    buffer_load_dwordx4 v130, s[48:51], 0 offen offset:1024 lds
    v_mov_b32_dpp v23, v27 quad_perm:[0,1,2,3] row_mask:0x4 bank_mask:0xf
    s_waitcnt lgkmcnt(11)
    v_mfma_f32_16x16x32_bf16 v[118:121], a[72:75], v[166:169], 0
    s_waitcnt lgkmcnt(9)
    v_mov_b32 v170, 0
    v_mov_b32 v171, 0
    v_mfma_f32_16x16x32_bf16 v[118:121], a[76:79], v[122:125], v[118:121]
    s_waitcnt lgkmcnt(8)
    ds_write_b64 v177, v[170:171] offset:56
    v_mfma_f32_16x16x32_bf16 v[118:121], a[80:83], v[134:137], v[118:121]
    s_waitcnt lgkmcnt(7)
    v_mov_b32 v172, 0
    v_mov_b32 v173, 0
    v_mfma_f32_16x16x32_bf16 v[118:121], a[84:87], v[150:153], v[118:121]
    s_waitcnt lgkmcnt(5)
    buffer_load_dwordx4 v132, s[48:51], 0 offen offset:2048 lds
    s_add_u32 s48, s48, 36864
    v_mfma_f32_16x16x32_bf16 v[154:157], a[96:99], v[166:169], 0
    s_addc_u32 s49, s49, 0
    ds_write_b128 v177, v[170:173] offset:16
    v_mfma_f32_16x16x32_bf16 v[154:157], a[100:103], v[122:125], v[154:157]
    s_waitcnt lgkmcnt(2)
    s_add_u32 m0, s68, 3072
    v_mfma_f32_16x16x32_bf16 v[118:121], a[88:91], v[142:145], v[118:121]
    v_mfma_f32_16x16x32_bf16 v[118:121], a[92:95], v[162:165], v[118:121]
    s_waitcnt vmcnt(6)
    buffer_load_dwordx4 v128, s[48:51], 0 offen lds
    ds_read_b64_tr_b16 a[152:153], v141 offset:0
    v_mfma_f32_16x16x32_bf16 v[154:157], a[104:107], v[134:137], v[154:157]
    ds_read_b64_tr_b16 a[154:155], v141 offset:768
    ds_read_b64_tr_b16 a[176:177], v141 offset:32
    v_mfma_f32_16x16x32_bf16 v[154:157], a[108:111], v[150:153], v[154:157]
    ds_read_b64_tr_b16 a[178:179], v141 offset:800
    ds_read_b64_tr_b16 a[200:201], v141 offset:64
    v_mfma_f32_16x16x32_bf16 v[154:157], a[112:115], v[142:145], v[154:157]
    ds_read_b64_tr_b16 a[202:203], v141 offset:832
    ds_read_b128 v[146:149], v175 offset:6144
    v_mfma_f32_16x16x32_bf16 v[154:157], a[116:119], v[162:165], v[154:157]
    ds_read_b128 v[230:233], v174 offset:6144
    ds_read_b128 v[238:241], v175 offset:6272
    v_mfma_f32_16x16x32_bf16 v[198:201], a[120:123], v[166:169], 0
    buffer_load_dwordx4 v130, s[48:51], 0 offen offset:1024 lds
    ds_read_b128 v[190:193], v174 offset:6272
    v_mfma_f32_16x16x32_bf16 v[198:201], a[124:127], v[122:125], v[198:201]
    ds_read_b128 v[206:209], v175 offset:6400
    v_fma_f32 v176, v118, v118, s32
    v_mfma_f32_16x16x32_bf16 v[198:201], a[128:131], v[134:137], v[198:201]
    ds_read_b128 v[210:213], v174 offset:6400
    v_fmac_f32 v176, v119, v119
    v_mfma_f32_16x16x32_bf16 v[198:201], a[132:135], v[150:153], v[198:201]
    s_waitcnt lgkmcnt(11)
    ds_write_b64 v177, v[170:171] offset:64
    v_mfma_f32_16x16x32_bf16 v[198:201], a[136:139], v[142:145], v[198:201]
    s_waitcnt lgkmcnt(9)
    v_fmac_f32 v176, v120, v120
    v_fmac_f32 v176, v121, v121
    v_mfma_f32_16x16x32_bf16 v[198:201], a[140:143], v[162:165], v[198:201]
    s_waitcnt lgkmcnt(7)
    buffer_load_dwordx4 v132, s[48:51], 0 offen offset:2048 lds
    v_fmac_f32 v176, v154, v154
    v_mfma_f32_16x16x32_bf16 v[214:217], a[0:3], v[166:169], 0
    s_waitcnt lgkmcnt(5)
    ds_write_b128 v179, v[170:173] offset:16
    v_mfma_f32_16x16x32_bf16 v[218:221], a[72:75], v[146:149], 0
    s_add_u32 m0, s28, 8192
    s_waitcnt vmcnt(6)
    v_fmac_f32 v176, v155, v155
    v_mfma_f32_16x16x32_bf16 v[218:221], a[76:79], v[230:233], v[218:221]
    s_waitcnt lgkmcnt(3)
    v_fmac_f32 v176, v156, v156
    v_fmac_f32 v176, v157, v157
    v_mfma_f32_16x16x32_bf16 v[218:221], a[80:83], v[238:241], v[218:221]
    s_waitcnt lgkmcnt(2)
    buffer_load_dwordx4 v12, s[8:11], s25 offen nt lds
    v_mfma_f32_16x16x32_bf16 v[218:221], a[84:87], v[190:193], v[218:221]
    s_add_u32 m0, s28, 12288
    ds_read_b64_tr_b16 a[156:157], v141 offset:3072
    ds_read_b64_tr_b16 a[158:159], v141 offset:3840
    v_mfma_f32_16x16x32_bf16 v[218:221], a[88:91], v[206:209], v[218:221]
    ds_read_b64_tr_b16 a[180:181], v141 offset:3104
    ds_read_b64_tr_b16 a[182:183], v141 offset:3872
    v_mfma_f32_16x16x32_bf16 v[218:221], a[92:95], v[210:213], v[218:221]
    ds_read_b64_tr_b16 a[204:205], v141 offset:3136
    ds_read_b64_tr_b16 a[206:207], v141 offset:3904
    v_mfma_f32_16x16x32_bf16 v[222:225], a[96:99], v[146:149], 0
    ds_write_b64 v179, v[170:171] offset:56
    v_mfma_f32_16x16x32_bf16 v[222:225], a[100:103], v[230:233], v[222:225]
    buffer_load_dwordx4 v13, s[8:11], s25 offen nt lds
    v_mfma_f32_16x16x32_bf16 v[222:225], a[104:107], v[238:241], v[222:225]
    s_add_u32 m0, s29, 0
    ds_write_b64 v179, v[170:171] offset:64
    v_mfma_f32_16x16x32_bf16 v[222:225], a[108:111], v[190:193], v[222:225]
    v_fmac_f32 v176, v198, v198
    v_fmac_f32 v176, v199, v199
    v_mfma_f32_16x16x32_bf16 v[222:225], a[112:115], v[206:209], v[222:225]
    s_waitcnt lgkmcnt(6)
    ds_write_b16 v8, v170 offset:2816
    v_mfma_f32_16x16x32_bf16 v[222:225], a[116:119], v[210:213], v[222:225]
    s_waitcnt lgkmcnt(5)
    v_fmac_f32 v176, v200, v200
    v_fmac_f32 v176, v201, v201
    v_mfma_f32_16x16x32_bf16 v[226:229], a[120:123], v[146:149], 0
    s_waitcnt lgkmcnt(3)
    buffer_load_dwordx4 v14, s[8:11], s25 offen nt lds
    v_mfma_f32_16x16x32_bf16 v[226:229], a[124:127], v[230:233], v[226:229]
    s_add_u32 m0, s69, 0
    s_waitcnt vmcnt(6)
    ds_read_b64_tr_b16 a[160:161], v140 offset:0
    v_mfma_f32_16x16x32_bf16 v[226:229], a[128:131], v[238:241], v[226:229]
    s_lshr_b32 s10, s17, 1
    ds_read_b64_tr_b16 a[162:163], v140 offset:768
    ds_read_b64_tr_b16 a[184:185], v140 offset:32
    v_mfma_f32_16x16x32_bf16 v[226:229], a[132:135], v[190:193], v[226:229]
    s_cselect_b32 s10, s36, 0
    ds_read_b64_tr_b16 a[186:187], v140 offset:800
    ds_read_b64_tr_b16 a[208:209], v140 offset:64
    v_mfma_f32_16x16x32_bf16 v[226:229], a[136:139], v[206:209], v[226:229]
    s_mov_b32 s25, s24
    ds_read_b64_tr_b16 a[210:211], v140 offset:832
    v_fma_f32 v182, v218, v218, s32
    v_mfma_f32_16x16x32_bf16 v[226:229], a[140:143], v[210:213], v[226:229]
    buffer_load_dwordx4 v159, s[52:55], 0 offen lds
    v_fmac_f32 v182, v219, v219
    v_mfma_f32_16x16x32_bf16 v[214:217], a[4:7], v[122:125], v[214:217]
    v_fmac_f32 v182, v220, v220
    v_fmac_f32 v182, v221, v221
    v_mfma_f32_16x16x32_bf16 v[214:217], a[8:11], v[134:137], v[214:217]
    v_fmac_f32 v182, v222, v222
    v_fmac_f32 v182, v223, v223
    v_mfma_f32_16x16x32_bf16 v[214:217], a[12:15], v[150:153], v[214:217]
    v_fmac_f32 v182, v224, v224
    v_fmac_f32 v182, v225, v225
    v_mfma_f32_16x16x32_bf16 v[214:217], a[16:19], v[142:145], v[214:217]
    s_waitcnt lgkmcnt(5)
    v_fmac_f32 v182, v226, v226
    v_fmac_f32 v182, v227, v227
    v_mfma_f32_16x16x32_bf16 v[214:217], a[20:23], v[162:165], v[214:217]
    s_waitcnt lgkmcnt(3)
    buffer_load_dwordx4 v127, s[52:55], 0 offen offset:1024 lds
    v_fmac_f32 v182, v228, v228
    v_mfma_f32_16x16x32_bf16 v[234:237], a[24:27], v[166:169], 0
    s_waitcnt lgkmcnt(1)
    v_fmac_f32 v182, v229, v229
    v_xor_b32 v126, 65536, v2
    v_mfma_f32_16x16x32_bf16 v[234:237], a[28:31], v[122:125], v[234:237]
    s_waitcnt lgkmcnt(0)
    v_fma_f32 v128, v214, v214, s32
    v_fmac_f32 v128, v215, v215
    v_mfma_f32_16x16x32_bf16 v[234:237], a[32:35], v[134:137], v[234:237]
    v_fmac_f32 v128, v216, v216
    v_fmac_f32 v128, v217, v217
    v_mfma_f32_16x16x32_bf16 v[234:237], a[36:39], v[150:153], v[234:237]
    v_lshrrev_b32 v160, 2, v126
    v_lshrrev_b32 v158, 8, v126
    v_mfma_f32_16x16x32_bf16 v[234:237], a[40:43], v[142:145], v[234:237]
    buffer_load_dwordx4 v185, s[52:55], 0 offen offset:2048 lds
    v_lshl_add_u32 v130, s16, 2, v126
    v_mfma_f32_16x16x32_bf16 v[234:237], a[44:47], v[162:165], v[234:237]
    s_add_u32 s52, s52, 12288
    s_waitcnt vmcnt(6)
    ds_read_b64_tr_b16 a[164:165], v140 offset:3072
    v_mfma_f32_16x16x32_bf16 v[242:245], a[48:51], v[166:169], 0
    s_addc_u32 s53, s53, 0
    ds_read_b64_tr_b16 a[166:167], v140 offset:3840
    ds_read_b64_tr_b16 a[188:189], v140 offset:3104
    v_mfma_f32_16x16x32_bf16 v[242:245], a[52:55], v[122:125], v[242:245]
    s_add_u32 m0, s69, 3072
    ds_read_b64_tr_b16 a[190:191], v140 offset:3872
    ds_read_b64_tr_b16 a[212:213], v140 offset:3136
    v_mfma_f32_16x16x32_bf16 v[242:245], a[56:59], v[134:137], v[242:245]
    ds_read_b64_tr_b16 a[214:215], v140 offset:3904
    v_fmac_f32 v128, v234, v234
    v_mfma_f32_16x16x32_bf16 v[242:245], a[60:63], v[150:153], v[242:245]
    buffer_load_dwordx4 v159, s[52:55], 0 offen lds
    v_fmac_f32 v128, v235, v235
    v_mfma_f32_16x16x32_bf16 v[242:245], a[64:67], v[142:145], v[242:245]
    v_fmac_f32 v128, v236, v236
    v_fmac_f32 v128, v237, v237
    v_mfma_f32_16x16x32_bf16 v[242:245], a[68:71], v[162:165], v[242:245]
    v_add_u32 v160, 62784, v160
    v_lshlrev_b32 v158, 4, v158
    v_mfma_f32_16x16x32_bf16 v[138:141], a[0:3], v[146:149], 0
    v_add_u32 v158, 62784, v158
    v_or_b32 v142, v32, v33
    v_mfma_f32_16x16x32_bf16 v[138:141], a[4:7], v[230:233], v[138:141]
    s_waitcnt lgkmcnt(5)
    v_and_b32 v142, 0xffff, v142
    v_fmac_f32 v128, v242, v242
    v_mfma_f32_16x16x32_bf16 v[138:141], a[8:11], v[238:241], v[138:141]
    s_waitcnt lgkmcnt(3)
    buffer_load_dwordx4 v127, s[52:55], 0 offen offset:1024 lds
    v_fmac_f32 v128, v243, v243
    v_mfma_f32_16x16x32_bf16 v[138:141], a[12:15], v[190:193], v[138:141]
    s_waitcnt lgkmcnt(1)
    v_fmac_f32 v128, v244, v244
    v_fmac_f32 v128, v245, v245
    v_mfma_f32_16x16x32_bf16 v[138:141], a[16:19], v[206:209], v[138:141]
    s_waitcnt lgkmcnt(0)
    v_cvt_pk_bf16_f32 v36, v128, v176
    v_lshl_or_b32 v142, v142, 16, v142
    v_mfma_f32_16x16x32_bf16 v[138:141], a[20:23], v[210:213], v[138:141]
    v_or_b32 v143, v32, v33
    v_and_b32 v143, 0xffff, v143
    v_mfma_f32_16x16x32_bf16 v[134:137], v[32:35], v[36:39], 0
    v_lshl_or_b32 v143, v143, 16, v143
    v_or_b32 v144, v32, v33
    v_mfma_f32_16x16x32_bf16 v[246:249], a[24:27], v[146:149], 0
    buffer_load_dwordx4 v185, s[52:55], 0 offen offset:2048 lds
    v_lshrrev_b32 v144, 16, v144
    v_mfma_f32_16x16x32_bf16 v[246:249], a[28:31], v[230:233], v[246:249]
    s_add_u32 s52, s52, 12288
    v_lshl_or_b32 v144, v144, 16, v144
    v_or_b32 v145, v32, v33
    v_mfma_f32_16x16x32_bf16 v[246:249], a[32:35], v[238:241], v[246:249]
    s_addc_u32 s53, s53, 0
    v_rsq_f32 v135, v135
    v_mfma_f32_16x16x32_bf16 v[246:249], a[36:39], v[190:193], v[246:249]
    s_add_u32 m0, s68, 0
    ds_read_b128 v[186:189], v0 offset:20480
    v_mul_f32 v118, v135, v118
    v_mfma_f32_16x16x32_bf16 v[246:249], a[40:43], v[206:209], v[246:249]
    ds_read_b128 v[194:197], v1 offset:20480
    v_mul_f32 v119, v135, v119
    v_mfma_f32_16x16x32_bf16 v[246:249], a[44:47], v[210:213], v[246:249]
    buffer_load_dwordx4 v159, s[52:55], 0 offen lds
    ds_read_b128 v[122:125], v0 offset:20608
    v_mfma_f32_16x16x32_bf16 v[250:253], a[48:51], v[146:149], 0
    ds_read_b128 v[202:205], v1 offset:20608
    v_cvt_pk_f16_f32 v150, v118, v119
    v_mfma_f32_16x16x32_bf16 v[250:253], a[52:55], v[230:233], v[250:253]
    ds_read_b128 v[230:233], v0 offset:20736
    v_mul_f32 v120, v135, v120
    v_mfma_f32_16x16x32_bf16 v[250:253], a[56:59], v[238:241], v[250:253]
    ds_read_b128 v[238:241], v1 offset:20736
    v_mul_f32 v121, v135, v121
    v_mfma_f32_16x16x32_bf16 v[250:253], a[60:63], v[190:193], v[250:253]
    v_rsq_f32 v134, v134
    v_mfma_f32_16x16x32_bf16 v[250:253], a[64:67], v[206:209], v[250:253]
    v_mul_f32 v134, s31, v134
    v_cvt_pk_f16_f32 v151, v120, v121
    v_mfma_f32_16x16x32_bf16 v[250:253], a[68:71], v[210:213], v[250:253]
    s_waitcnt lgkmcnt(5)
    v_mul_f32 v154, v135, v154
    v_mul_f32 v155, v135, v155
    v_mfma_f32_16x16x32_bf16 v[162:165], a[96:99], v[186:189], 0
    s_waitcnt lgkmcnt(4)
    v_cvt_pk_f16_f32 v152, v154, v155
    v_mul_f32 v156, v135, v156
    v_mfma_f32_16x16x32_bf16 v[162:165], a[100:103], v[194:197], v[162:165]
    s_waitcnt lgkmcnt(3)
    v_mul_f32 v157, v135, v157
    v_cvt_pk_f16_f32 v153, v156, v157
    v_mfma_f32_16x16x32_bf16 v[162:165], a[104:107], v[122:125], v[162:165]
    s_waitcnt lgkmcnt(2)
    ds_write_b128 v177, v[150:153]
    v_mfma_f32_16x16x32_bf16 v[162:165], a[108:111], v[202:205], v[162:165]
    s_waitcnt lgkmcnt(1)
    v_mul_f32 v198, v135, v198
    v_mul_f32 v199, v135, v199
    v_mfma_f32_16x16x32_bf16 v[162:165], a[112:115], v[230:233], v[162:165]
    v_cvt_pk_f16_f32 v148, v198, v199
    v_mul_f32 v200, v135, v200
    v_mfma_f32_16x16x32_bf16 v[162:165], a[116:119], v[238:241], v[162:165]
    v_mul_f32 v201, v135, v201
    v_cvt_pk_f16_f32 v149, v200, v201
    v_mfma_f32_16x16x32_bf16 v[170:173], a[120:123], v[186:189], 0
    ds_write_b64 v177, v[148:149] offset:48
    v_mfma_f32_16x16x32_bf16 v[170:173], a[124:127], v[194:197], v[170:173]
    v_mul_f32 v214, v134, v214
    v_mul_f32 v215, v134, v215
    v_mfma_f32_16x16x32_bf16 v[170:173], a[128:131], v[122:125], v[170:173]
    v_cvt_pk_f16_f32 v150, v214, v215
    v_mul_f32 v216, v134, v216
    v_mfma_f32_16x16x32_bf16 v[170:173], a[132:135], v[202:205], v[170:173]
    v_mul_f32 v217, v134, v217
    v_cvt_pk_f16_f32 v151, v216, v217
    v_mfma_f32_16x16x32_bf16 v[170:173], a[136:139], v[230:233], v[170:173]
    v_mul_f32 v234, v134, v234
    v_mul_f32 v235, v134, v235
    v_mfma_f32_16x16x32_bf16 v[170:173], a[140:143], v[238:241], v[170:173]
    v_cvt_pk_f16_f32 v152, v234, v235
    v_mul_f32 v236, v134, v236
    v_mfma_f32_16x16x32_bf16 v[166:169], a[24:27], v[186:189], 0
    v_mul_f32 v237, v134, v237
    v_cvt_pk_f16_f32 v153, v236, v237
    v_mfma_f32_16x16x32_bf16 v[166:169], a[28:31], v[194:197], v[166:169]
    ds_write_b128 v177, v[150:153] offset:32
    v_mfma_f32_16x16x32_bf16 v[150:153], a[72:75], v[186:189], 0
    v_mul_f32 v242, v134, v242
    v_mul_f32 v243, v134, v243
    v_mfma_f32_16x16x32_bf16 v[150:153], a[76:79], v[194:197], v[150:153]
    v_cvt_pk_f16_f32 v146, v242, v243
    v_mul_f32 v244, v134, v244
    v_mfma_f32_16x16x32_bf16 v[150:153], a[80:83], v[122:125], v[150:153]
    v_mul_f32 v245, v134, v245
    v_cvt_pk_f16_f32 v147, v244, v245
    v_mfma_f32_16x16x32_bf16 v[150:153], a[84:87], v[202:205], v[150:153]
    ds_write_b64 v177, v[146:147] offset:72
    v_mfma_f32_16x16x32_bf16 v[150:153], a[88:91], v[230:233], v[150:153]
    v_mul_f32 v118, v214, v118
    v_fmac_f32 v118, v215, v119
    v_mfma_f32_16x16x32_bf16 v[150:153], a[92:95], v[238:241], v[150:153]
    v_fmac_f32 v118, v216, v120
    v_fmac_f32 v118, v217, v121
    v_mfma_f32_16x16x32_bf16 v[166:169], a[32:35], v[122:125], v[166:169]
    v_fmac_f32 v118, v234, v154
    v_fmac_f32 v118, v235, v155
    v_mfma_f32_16x16x32_bf16 v[166:169], a[36:39], v[202:205], v[166:169]
    v_fmac_f32 v118, v236, v156
    v_fmac_f32 v118, v237, v157
    v_mfma_f32_16x16x32_bf16 v[166:169], a[40:43], v[230:233], v[166:169]
    v_fmac_f32 v118, v242, v198
    v_fmac_f32 v118, v243, v199
    v_mfma_f32_16x16x32_bf16 v[166:169], a[44:47], v[238:241], v[166:169]
    v_fmac_f32 v118, v244, v200
    v_fmac_f32 v118, v245, v201
    v_mfma_f32_16x16x32_bf16 v[134:137], a[48:51], v[186:189], 0
    v_mov_b32 v128, v118
    v_lshrrev_b32 v145, 16, v145
    v_mfma_f32_16x16x32_bf16 v[134:137], a[52:55], v[194:197], v[134:137]
    v_permlane32_swap_b32 v118, v128
    v_mfma_f32_16x16x32_bf16 v[134:137], a[56:59], v[122:125], v[134:137]
    v_add_f32 v118, v118, v128
    v_mov_b32 v128, v118
    v_mfma_f32_16x16x32_bf16 v[134:137], a[60:63], v[202:205], v[134:137]
    v_lshl_or_b32 v145, v145, 16, v145
    v_fma_f32 v132, v138, v138, s32
    v_mfma_f32_16x16x32_bf16 v[134:137], a[64:67], v[230:233], v[134:137]
    v_permlane16_swap_b32 v118, v128
    v_mfma_f32_16x16x32_bf16 v[134:137], a[68:71], v[238:241], v[134:137]
    v_add_f32 v118, v118, v128
    v_add_f32 v118, s39, v118
    v_mfma_f32_16x16x32_bf16 v[154:157], v[186:189], a[144:147], 0
    v_mov_b32 v119, v181
    v_mov_b32 v120, v181
    v_mfma_f32_16x16x32_bf16 v[154:157], v[194:197], a[148:151], v[154:157]
    v_mov_b32 v121, v181
    v_cndmask_b32 v118, v181, v118, s[88:89]
    v_mfma_f32_16x16x32_bf16 v[154:157], v[122:125], a[152:155], v[154:157]
    ds_write_b128 v161, v[118:121] offset:192
    v_mfma_f32_16x16x32_bf16 v[154:157], v[202:205], a[156:159], v[154:157]
    v_fmac_f32 v132, v139, v139
    v_fmac_f32 v132, v140, v140
    v_mfma_f32_16x16x32_bf16 v[154:157], v[230:233], a[160:163], v[154:157]
    v_fmac_f32 v132, v141, v141
    v_fmac_f32 v132, v246, v246
    v_mfma_f32_16x16x32_bf16 v[154:157], v[238:241], a[164:167], v[154:157]
    v_fmac_f32 v132, v247, v247
    v_fmac_f32 v132, v248, v248
    v_mfma_f32_16x16x32_bf16 v[118:121], v[186:189], a[168:171], 0
    v_fmac_f32 v132, v249, v249
    v_fmac_f32 v132, v250, v250
    v_mfma_f32_16x16x32_bf16 v[118:121], v[194:197], a[172:175], v[118:121]
    v_fmac_f32 v132, v251, v251
    v_fmac_f32 v132, v252, v252
    v_mfma_f32_16x16x32_bf16 v[118:121], v[122:125], a[176:179], v[118:121]
    v_fmac_f32 v132, v253, v253
    v_cvt_pk_bf16_f32 v36, v132, v182
    v_mfma_f32_16x16x32_bf16 v[118:121], v[202:205], a[180:183], v[118:121]
    ds_read_b128 v[198:201], v175 offset:0
    v_fma_f32 v128, v150, v150, s32
    v_mfma_f32_16x16x32_bf16 v[146:149], v[32:35], v[36:39], 0
    v_fmac_f32 v128, v151, v151
    v_fmac_f32 v128, v152, v152
    v_mfma_f32_16x16x32_bf16 v[118:121], v[230:233], a[184:187], v[118:121]
    ds_read_b128 v[214:217], v174 offset:0
    v_fmac_f32 v128, v153, v153
    v_mfma_f32_16x16x32_bf16 v[118:121], v[238:241], a[188:191], v[118:121]
    ds_read_b128 v[190:193], v175 offset:128
    v_fmac_f32 v128, v162, v162
    v_rsq_f32 v147, v147
    v_rsq_f32 v146, v146
    v_mul_f32 v218, v147, v218
    v_mul_f32 v146, s31, v146
    v_mul_f32 v219, v147, v219
    v_cvt_pk_f16_f32 v206, v218, v219
    v_mul_f32 v220, v147, v220
    v_mul_f32 v221, v147, v221
    v_cvt_pk_f16_f32 v207, v220, v221
    v_mul_f32 v222, v147, v222
    v_mul_f32 v223, v147, v223
    v_cvt_pk_f16_f32 v208, v222, v223
    v_mul_f32 v224, v147, v224
    v_mul_f32 v225, v147, v225
    v_cvt_pk_f16_f32 v209, v224, v225
    v_mul_f32 v226, v147, v226
    v_mul_f32 v227, v147, v227
    v_cvt_pk_f16_f32 v236, v226, v227
    v_mul_f32 v228, v147, v228
    v_mul_f32 v229, v147, v229
    v_cvt_pk_f16_f32 v237, v228, v229
    v_mul_f32 v138, v146, v138
    v_mul_f32 v139, v146, v139
    v_cvt_pk_f16_f32 v210, v138, v139
    v_mul_f32 v140, v146, v140
    v_mul_f32 v141, v146, v141
    v_cvt_pk_f16_f32 v211, v140, v141
    v_mul_f32 v246, v146, v246
    v_mul_f32 v247, v146, v247
    v_cvt_pk_f16_f32 v212, v246, v247
    v_mul_f32 v248, v146, v248
    v_mul_f32 v249, v146, v249
    v_cvt_pk_f16_f32 v213, v248, v249
    v_mul_f32 v250, v146, v250
    v_mul_f32 v251, v146, v251
    v_cvt_pk_f16_f32 v234, v250, v251
    v_mul_f32 v252, v146, v252
    v_mul_f32 v253, v146, v253
    v_cvt_pk_f16_f32 v235, v252, v253
    v_mul_f32 v146, v138, v218
    v_fmac_f32 v146, v139, v219
    v_fmac_f32 v146, v140, v220
    v_fmac_f32 v146, v141, v221
    v_fmac_f32 v146, v246, v222
    v_fmac_f32 v146, v247, v223
    v_fmac_f32 v146, v248, v224
    v_mfma_f32_16x16x32_bf16 v[218:221], v[186:189], a[192:195], 0
    s_waitcnt lgkmcnt(0)
    ds_write_b128 v179, v[206:209]
    v_mfma_f32_16x16x32_bf16 v[138:141], a[0:3], v[186:189], 0
    v_fmac_f32 v146, v249, v225
    v_fmac_f32 v146, v250, v226
    v_mfma_f32_16x16x32_bf16 v[138:141], a[4:7], v[194:197], v[138:141]
    buffer_load_dwordx4 v127, s[52:55], 0 offen offset:1024 lds
    v_fmac_f32 v146, v251, v227
    v_mfma_f32_16x16x32_bf16 v[138:141], a[8:11], v[122:125], v[138:141]
    ds_read_b128 v[222:225], v174 offset:128
    v_fmac_f32 v146, v252, v228
    v_mfma_f32_16x16x32_bf16 v[138:141], a[12:15], v[202:205], v[138:141]
    ds_write_b64 v179, v[236:237] offset:48
    v_mfma_f32_16x16x32_bf16 v[138:141], a[16:19], v[230:233], v[138:141]
    v_fmac_f32 v146, v253, v229
    v_mov_b32 v161, v146
    v_mfma_f32_16x16x32_bf16 v[138:141], a[20:23], v[238:241], v[138:141]
    ds_write_b128 v179, v[210:213] offset:32
    v_mfma_f32_16x16x32_bf16 v[218:221], v[194:197], a[196:199], v[218:221]
    buffer_load_dwordx4 v185, s[52:55], 0 offen offset:2048 lds
    v_fmac_f32 v128, v163, v163
    v_mfma_f32_16x16x32_bf16 v[218:221], v[122:125], a[200:203], v[218:221]
    s_add_u32 s52, s52, 12288
    v_permlane32_swap_b32 v146, v161
    v_mfma_f32_16x16x32_bf16 v[218:221], v[202:205], a[204:207], v[218:221]
    s_addc_u32 s53, s53, 0
    ds_read_b128 v[194:197], v175 offset:256
    ds_read_b128 v[122:125], v174 offset:256
    v_mfma_f32_16x16x32_bf16 v[218:221], v[230:233], a[208:211], v[218:221]
    s_add_u32 m0, s68, 3072
    ds_write_b64 v179, v[234:235] offset:72
    v_mfma_f32_16x16x32_bf16 v[218:221], v[238:241], a[212:215], v[218:221]
    s_mul_i32 s68, s78, 72
    v_add_f32 v146, v146, v161
    v_mov_b32 v161, v146
    v_mfma_f32_16x16x32_bf16 v[238:241], v[198:201], a[144:147], 0
    s_waitcnt lgkmcnt(4)
    buffer_load_dwordx4 v159, s[52:55], 0 offen lds
    v_fmac_f32 v128, v164, v164
    v_mfma_f32_16x16x32_bf16 v[238:241], v[214:217], a[148:151], v[238:241]
    s_sub_u32 s68, s77, s68
    v_permlane16_swap_b32 v146, v161
    v_mfma_f32_16x16x32_bf16 v[238:241], v[190:193], a[152:155], v[238:241]
    s_mul_i32 s78, s78, 1373568
    v_add_f32 v146, v146, v161
    v_add_f32 v146, s39, v146
    v_mfma_f32_16x16x32_bf16 v[238:241], v[222:225], a[156:159], v[238:241]
    s_mul_i32 s77, s68, 2688
    v_mov_b32 v147, v181
    v_mov_b32 v148, v181
    v_mfma_f32_16x16x32_bf16 v[230:233], v[198:201], a[168:171], 0
    s_waitcnt lgkmcnt(2)
    v_mov_b32 v149, v181
    v_cndmask_b32 v146, v181, v146, s[88:89]
    v_mfma_f32_16x16x32_bf16 v[238:241], v[194:197], a[160:163], v[238:241]
    s_waitcnt lgkmcnt(0)
    buffer_load_dwordx4 v127, s[52:55], 0 offen offset:1024 lds
    v_fmac_f32 v128, v165, v165
    v_mfma_f32_16x16x32_bf16 v[238:241], v[122:125], a[164:167], v[238:241]
    s_add_u32 s77, s77, s78
    ds_write_b128 v180, v[146:149] offset:192
    v_mfma_f32_16x16x32_bf16 v[230:233], v[214:217], a[172:175], v[230:233]
    v_fmac_f32 v128, v170, v170
    v_fmac_f32 v128, v171, v171
    v_mfma_f32_16x16x32_bf16 v[230:233], v[190:193], a[176:179], v[230:233]
    v_fmac_f32 v128, v172, v172
    v_fmac_f32 v128, v173, v173
    v_mfma_f32_16x16x32_bf16 v[230:233], v[222:225], a[180:183], v[230:233]
    buffer_load_dwordx4 v185, s[52:55], 0 offen offset:2048 lds
    ds_read_b128 v[146:149], v175 offset:6144
    v_mfma_f32_16x16x32_bf16 v[230:233], v[194:197], a[184:187], v[230:233]
    s_add_u32 s52, s52, 12288
    ds_read_b128 v[226:229], v174 offset:6144
    v_fma_f32 v161, v138, v138, s32
    v_mfma_f32_16x16x32_bf16 v[230:233], v[122:125], a[188:191], v[230:233]
    s_waitcnt vmcnt(9)
    ds_read_b64 a[216:217], v184 offset:0
    ds_read_b64 a[218:219], v184 offset:1536
    v_mfma_f32_16x16x32_bf16 v[202:205], v[198:201], a[192:195], 0
    s_addc_u32 s53, s53, 0
    ds_read_b64 a[240:241], v184 offset:8
    ds_read_b64 a[242:243], v184 offset:1544
    v_mfma_f32_16x16x32_bf16 v[202:205], v[214:217], a[196:199], v[202:205]
    s_add_u32 m0, s69, 0
    ds_read_b64 v[90:91], v114 offset:0
    ds_read_b64 v[92:93], v114 offset:1536
    v_mfma_f32_16x16x32_bf16 v[202:205], v[190:193], a[200:203], v[202:205]
    ds_read_b128 v[198:201], v175 offset:6272
    ds_read_b128 v[214:217], v174 offset:6272
    v_mfma_f32_16x16x32_bf16 v[202:205], v[222:225], a[204:207], v[202:205]
    ds_read_b128 v[222:225], v175 offset:6400
    v_fmac_f32 v161, v139, v139
    v_mfma_f32_16x16x32_bf16 v[202:205], v[194:197], a[208:211], v[202:205]
    ds_read_b128 v[194:197], v174 offset:6400
    v_fmac_f32 v161, v140, v140
    v_mfma_f32_16x16x32_bf16 v[202:205], v[122:125], a[212:215], v[202:205]
    s_waitcnt lgkmcnt(11)
    v_fmac_f32 v161, v141, v141
    v_fmac_f32 v161, v166, v166
    v_mfma_f32_16x16x32_bf16 v[174:177], v[146:149], a[144:147], 0
    s_waitcnt lgkmcnt(10)
    v_fmac_f32 v161, v167, v167
    v_fmac_f32 v161, v168, v168
    v_mfma_f32_16x16x32_bf16 v[174:177], v[226:229], a[148:151], v[174:177]
    s_waitcnt lgkmcnt(8)
    v_fmac_f32 v161, v169, v169
    v_fmac_f32 v161, v134, v134
    v_mfma_f32_16x16x32_bf16 v[122:125], v[142:145], a[216:219], 0
    s_waitcnt lgkmcnt(6)
    v_fmac_f32 v161, v135, v135
    v_fmac_f32 v161, v136, v136
    v_mfma_f32_16x16x32_bf16 v[122:125], v[142:145], a[240:243], v[122:125]
    s_waitcnt lgkmcnt(4)
    buffer_load_dwordx4 v159, s[52:55], 0 offen lds
    v_fmac_f32 v161, v137, v137
    v_mfma_f32_16x16x32_bf16 v[122:125], v[142:145], v[90:93], v[122:125]
    s_waitcnt lgkmcnt(2)
    v_cvt_pk_bf16_f32 v36, v161, v128
    v_cvt_pk_bf16_f32 v154, v154, v155
    v_mfma_f32_16x16x32_bf16 v[174:177], v[198:201], a[152:155], v[174:177]
    s_waitcnt lgkmcnt(1)
    v_cvt_pk_bf16_f32 v155, v156, v157
    v_cvt_pk_bf16_f32 v182, v118, v119
    s_waitcnt vmcnt(7)
    v_mfma_f32_16x16x32_bf16 v[190:193], v[32:35], v[36:39], 0
    s_waitcnt lgkmcnt(0)
    ds_read_b64 a[232:233], v184 offset:3072
    ds_read_b64 a[220:221], v184 offset:4608
    v_mfma_f32_16x16x32_bf16 v[174:177], v[214:217], a[156:159], v[174:177]
    ds_read_b64 v[82:83], v184 offset:3080
    buffer_load_dwordx4 v127, s[52:55], 0 offen offset:1024 lds
    v_mfma_f32_16x16x32_bf16 v[174:177], v[222:225], a[160:163], v[174:177]
    ds_read_b64 a[244:245], v184 offset:4616
    ds_read_b64 v[106:107], v114 offset:3072
    v_mfma_f32_16x16x32_bf16 v[174:177], v[194:197], a[164:167], v[174:177]
    ds_read_b64 v[94:95], v114 offset:4608
    v_mov_b32 v128, v122
    v_mfma_f32_16x16x32_bf16 v[186:189], v[146:149], a[168:171], 0
    v_rsq_f32 v191, v191
    v_mfma_f32_16x16x32_bf16 v[186:189], v[226:229], a[172:175], v[186:189]
    v_mov_b32_dpp v128, v123 quad_perm:[0,1,2,3] row_mask:0x2 bank_mask:0xf
    v_mul_f32 v150, v191, v150
    v_mfma_f32_16x16x32_bf16 v[186:189], v[198:201], a[176:179], v[186:189]
    buffer_load_dwordx4 v185, s[52:55], 0 offen offset:2048 lds
    v_mul_f32 v151, v191, v151
    v_mfma_f32_16x16x32_bf16 v[186:189], v[214:217], a[180:183], v[186:189]
    s_add_u32 s52, s52, 12288
    v_rsq_f32 v190, v190
    v_mfma_f32_16x16x32_bf16 v[186:189], v[222:225], a[184:187], v[186:189]
    s_addc_u32 s53, s53, 0
    v_mul_f32 v190, s31, v190
    v_cvt_pk_f16_f32 v150, v150, v151
    v_mfma_f32_16x16x32_bf16 v[186:189], v[194:197], a[188:191], v[186:189]
    s_add_u32 m0, s69, 3072
    v_mul_f32 v152, v191, v152
    v_mul_f32 v153, v191, v153
    v_mfma_f32_16x16x32_bf16 v[122:125], v[146:149], a[192:195], 0
    s_add_u32 s69, s77, 589824
    v_cvt_pk_f16_f32 v151, v152, v153
    v_mul_f32 v162, v191, v162
    v_mfma_f32_16x16x32_bf16 v[122:125], v[226:229], a[196:199], v[122:125]
    s_waitcnt lgkmcnt(0)
    buffer_load_dwordx4 v159, s[52:55], 0 offen lds
    v_mul_f32 v163, v191, v163
    v_mfma_f32_16x16x32_bf16 v[122:125], v[198:201], a[200:203], v[122:125]
    v_cvt_pk_f16_f32 v152, v162, v163
    s_waitcnt vmcnt(7)
    v_mfma_f32_16x16x32_bf16 v[122:125], v[214:217], a[204:207], v[122:125]
    ds_read_b64 a[222:223], v183 offset:0
    ds_read_b64 a[234:235], v183 offset:1536
    v_mfma_f32_16x16x32_bf16 v[122:125], v[222:225], a[208:211], v[122:125]
    ds_read_b64 a[246:247], v183 offset:8
    ds_read_b64 v[84:85], v183 offset:1544
    v_mfma_f32_16x16x32_bf16 v[122:125], v[194:197], a[212:215], v[122:125]
    s_barrier
    s_barrier
    ds_read_b64 v[96:97], v129 offset:0
    buffer_load_dwordx4 v127, s[52:55], 0 offen offset:1024 lds
    ds_read_b64 v[108:109], v129 offset:1536
    ds_read_b128 v[194:197], v0 offset:26624
    ds_read_b128 v[198:201], v1 offset:26624
    ds_read_b128 v[222:225], v0 offset:26752
    ds_read_b128 v[146:149], v1 offset:26752
    ds_read_b128 v[214:217], v0 offset:26880
    ds_read_b128 v[226:229], v1 offset:26880
    buffer_load_dwordx4 v185, s[52:55], 0 offen offset:2048 lds
    s_waitcnt lgkmcnt(10)
    v_mfma_f32_16x16x32_bf16 v[206:209], v[142:145], a[220:223], 0
    s_add_u32 m0, s28, 65536
    v_mul_f32 v164, v191, v164
    v_mul_f32 v165, v191, v165
    v_mfma_f32_16x16x32_bf16 v[210:213], v[142:145], a[232:235], 0
    s_waitcnt lgkmcnt(8)
    v_cvt_pk_f16_f32 v153, v164, v165
    v_mul_f32 v170, v191, v170
    v_mfma_f32_16x16x32_bf16 v[206:209], v[142:145], a[244:247], v[206:209]
    s_waitcnt lgkmcnt(6)
    v_mul_f32 v171, v191, v171
    v_cvt_pk_f16_f32 v164, v170, v171
    v_mfma_f32_16x16x32_bf16 v[206:209], v[142:145], v[94:97], v[206:209]
    s_waitcnt lgkmcnt(3)
    v_mul_f32 v172, v191, v172
    v_mul_f32 v173, v191, v173
    v_mfma_f32_16x16x32_bf16 v[210:213], v[142:145], v[82:85], v[210:213]
    s_waitcnt vmcnt(6)
    buffer_load_dwordx4 v10, s[8:11], s24 offen nt lds
    v_mfma_f32_16x16x32_bf16 v[210:213], v[142:145], v[106:109], v[210:213]
    s_add_u32 m0, s28, 69632
    ds_read_b64 a[224:225], v183 offset:3072
    ds_read_b64 a[226:227], v183 offset:4608
    v_mfma_f32_16x16x32_bf16 v[246:249], a[72:75], v[194:197], 0
    s_waitcnt lgkmcnt(2)
    ds_read_b64 a[248:249], v183 offset:3080
    ds_read_b64 a[250:251], v183 offset:4616
    v_mfma_f32_16x16x32_bf16 v[246:249], a[76:79], v[198:201], v[246:249]
    ds_read_b64 v[98:99], v129 offset:3072
    ds_read_b64 v[100:101], v129 offset:4608
    v_mfma_f32_16x16x32_bf16 v[246:249], a[80:83], v[222:225], v[246:249]
    v_mov_b32_dpp v128, v210 quad_perm:[0,1,2,3] row_mask:0x4 bank_mask:0xf
    v_mov_b32 v118, v207
    v_mfma_f32_16x16x32_bf16 v[246:249], a[84:87], v[146:149], v[246:249]
    buffer_load_dwordx4 v11, s[8:11], s24 offen nt lds
    v_mfma_f32_16x16x32_bf16 v[246:249], a[88:91], v[214:217], v[246:249]
    s_add_u32 m0, s28, 73728
    v_mov_b32_dpp v128, v206 quad_perm:[0,1,2,3] row_mask:0x8 bank_mask:0xf
    v_mov_b32_dpp v118, v211 quad_perm:[0,1,2,3] row_mask:0x2 bank_mask:0xf
    v_mfma_f32_16x16x32_bf16 v[246:249], a[92:95], v[226:229], v[246:249]
    ds_write_b32 v130, v128 offset:18432
    v_mfma_f32_16x16x32_bf16 v[206:209], a[96:99], v[194:197], 0
    v_cvt_pk_f16_f32 v165, v172, v173
    v_mul_f32 v138, v190, v138
    v_mfma_f32_16x16x32_bf16 v[206:209], a[100:103], v[198:201], v[206:209]
    s_waitcnt lgkmcnt(5)
    v_mul_f32 v139, v190, v139
    v_cvt_pk_f16_f32 v138, v138, v139
    v_mfma_f32_16x16x32_bf16 v[170:173], v[142:145], a[224:227], 0
    s_waitcnt lgkmcnt(3)
    buffer_load_dwordx4 v12, s[8:11], s24 offen nt lds
    v_mfma_f32_16x16x32_bf16 v[170:173], v[142:145], a[248:251], v[170:173]
    s_waitcnt lgkmcnt(1)
    v_mul_f32 v140, v190, v140
    v_mul_f32 v141, v190, v141
    v_mfma_f32_16x16x32_bf16 v[170:173], v[142:145], v[98:101], v[170:173]
    s_add_u32 m0, s28, 77824
    v_cvt_pk_f16_f32 v139, v140, v141
    v_mul_f32 v166, v190, v166
    s_waitcnt vmcnt(6)
    v_mfma_f32_16x16x32_bf16 v[206:209], a[104:107], v[222:225], v[206:209]
    ds_read_b64 a[236:237], v184 offset:0
    ds_read_b64 a[228:229], v184 offset:1536
    v_mfma_f32_16x16x32_bf16 v[206:209], a[108:111], v[146:149], v[206:209]
    ds_read_b64 v[86:87], v184 offset:8
    ds_read_b64 a[252:253], v184 offset:1544
    v_mfma_f32_16x16x32_bf16 v[206:209], a[112:115], v[214:217], v[206:209]
    buffer_load_dwordx4 v13, s[8:11], s24 offen nt lds
    v_mfma_f32_16x16x32_bf16 v[206:209], a[116:119], v[226:229], v[206:209]
    s_add_u32 m0, s74, 0
    ds_read_b64 v[110:111], v114 offset:0
    ds_read_b64 v[102:103], v114 offset:1536
    v_mfma_f32_16x16x32_bf16 v[210:213], a[120:123], v[194:197], 0
    v_mov_b32_dpp v118, v170 quad_perm:[0,1,2,3] row_mask:0x4 bank_mask:0xf
    v_mul_f32 v167, v190, v167
    v_mfma_f32_16x16x32_bf16 v[210:213], a[124:127], v[198:201], v[210:213]
    v_mov_b32_dpp v118, v171 quad_perm:[0,1,2,3] row_mask:0x8 bank_mask:0xf
    v_cvt_pk_f16_f32 v140, v166, v167
    v_mfma_f32_16x16x32_bf16 v[210:213], a[128:131], v[222:225], v[210:213]
    ds_write_b32 v130, v118 offset:19456
    v_mfma_f32_16x16x32_bf16 v[210:213], a[132:135], v[146:149], v[210:213]
    buffer_load_dwordx4 v14, s[8:11], s24 offen nt lds
    v_mfma_f32_16x16x32_bf16 v[210:213], a[136:139], v[214:217], v[210:213]
    s_add_u32 s8, s60, s23
    v_mul_f32 v168, v190, v168
    v_mul_f32 v169, v190, v169
    v_mfma_f32_16x16x32_bf16 v[210:213], a[140:143], v[226:229], v[210:213]
    s_addc_u32 s9, s61, 0
    v_cvt_pk_f16_f32 v141, v168, v169
    v_mul_f32 v134, v190, v134
    v_mfma_f32_16x16x32_bf16 v[166:169], a[0:3], v[194:197], 0
    s_sub_u32 s10, s36, s23
    v_mul_f32 v135, v190, v135
    v_cvt_pk_f16_f32 v162, v134, v135
    v_mfma_f32_16x16x32_bf16 v[166:169], a[4:7], v[198:201], v[166:169]
    s_cmp_lt_u32 s34, s17
    v_mul_f32 v136, v190, v136
    v_mul_f32 v137, v190, v137
    v_mfma_f32_16x16x32_bf16 v[166:169], a[8:11], v[222:225], v[166:169]
    s_cselect_b32 s10, s10, 0
    v_cvt_pk_f16_f32 v163, v136, v137
    v_cvt_pk_bf16_f32 v183, v120, v121
    v_mfma_f32_16x16x32_bf16 v[166:169], a[12:15], v[146:149], v[166:169]
    s_add_u32 m0, s28, 0
    s_waitcnt vmcnt(5)
    ds_read_b64 a[230:231], v184 offset:3072
    v_mfma_f32_16x16x32_bf16 v[166:169], a[16:19], v[214:217], v[166:169]
    s_mov_b32 s24, s23
    ds_read_b64 a[238:239], v184 offset:4608
    ds_read_b64 a[254:255], v184 offset:3080
    v_mfma_f32_16x16x32_bf16 v[166:169], a[20:23], v[226:229], v[166:169]
    s_add_u32 s23, s23, s21
    ds_read_b64 v[88:89], v184 offset:4616
    ds_read_b64 v[104:105], v114 offset:3072
    v_mfma_f32_16x16x32_bf16 v[118:121], a[24:27], v[194:197], 0
    s_cmp_ge_u32 s19, 72
    ds_read_b64 v[112:113], v114 offset:4608
    v_cvt_pk_bf16_f32 v134, v218, v219
    v_mfma_f32_16x16x32_bf16 v[118:121], a[28:31], v[198:201], v[118:121]
    s_cselect_b32 s34, 72, 0
    v_cvt_pk_bf16_f32 v135, v220, v221
    v_cvt_pk_bf16_f32 v238, v238, 0
    v_mfma_f32_16x16x32_bf16 v[118:121], a[32:35], v[222:225], v[118:121]
    s_cselect_b32 s35, s22, 0
    v_cvt_pk_bf16_f32 v239, v239, 0
    v_cvt_pk_bf16_f32 v240, v240, 0
    v_mfma_f32_16x16x32_bf16 v[118:121], a[36:39], v[146:149], v[118:121]
    s_sub_u32 s19, s19, s34
    ds_write2_b32 v131, v238, v239 offset0:0 offset1:68
    v_mfma_f32_16x16x32_bf16 v[118:121], a[40:43], v[214:217], v[118:121]
    s_add_u32 s23, s23, s35
    v_cvt_pk_bf16_f32 v241, v241, 0
    v_cvt_pk_bf16_f32 v230, v230, 0
    v_mfma_f32_16x16x32_bf16 v[118:121], a[44:47], v[226:229], v[118:121]
    s_waitcnt lgkmcnt(5)
    ds_write2_b32 v131, v240, v241 offset0:136 offset1:204
    v_mfma_f32_16x16x32_bf16 v[114:117], v[142:145], a[228:231], 0
    s_waitcnt lgkmcnt(3)
    v_cvt_pk_bf16_f32 v231, v231, 0
    v_cvt_pk_bf16_f32 v232, v232, 0
    v_mfma_f32_16x16x32_bf16 v[114:117], v[142:145], a[252:255], v[114:117]
    s_waitcnt lgkmcnt(2)
    ds_write2_b32 v131, v230, v231 offset0:16 offset1:84
    v_mfma_f32_16x16x32_bf16 v[114:117], v[142:145], v[102:105], v[114:117]
    v_cvt_pk_bf16_f32 v233, v233, 0
    v_cvt_pk_bf16_f32 v202, v202, 0
    v_mfma_f32_16x16x32_bf16 v[238:241], v[142:145], a[236:239], 0
    ds_write2_b32 v131, v232, v233 offset0:152 offset1:220
    v_mfma_f32_16x16x32_bf16 v[238:241], v[142:145], v[86:89], v[238:241]
    v_cvt_pk_bf16_f32 v203, v203, 0
    v_cvt_pk_bf16_f32 v204, v204, 0
    v_mfma_f32_16x16x32_bf16 v[238:241], v[142:145], v[110:113], v[238:241]
    ds_write2_b32 v131, v202, v203 offset0:32 offset1:100
    v_mfma_f32_16x16x32_bf16 v[142:145], a[48:51], v[194:197], 0
    v_cvt_pk_bf16_f32 v205, v205, 0
    v_cvt_pk_bf16_f32 v174, v174, 0
    v_mfma_f32_16x16x32_bf16 v[142:145], a[52:55], v[198:201], v[142:145]
    ds_write2_b32 v131, v204, v205 offset0:168 offset1:236
    v_mfma_f32_16x16x32_bf16 v[142:145], a[56:59], v[222:225], v[142:145]
    v_cvt_pk_bf16_f32 v175, v175, 0
    v_mov_b32 v136, v238
    v_mfma_f32_16x16x32_bf16 v[142:145], a[60:63], v[146:149], v[142:145]
    ds_write2_b32 v178, v174, v175 offset0:0 offset1:68
    v_mfma_f32_16x16x32_bf16 v[142:145], a[64:67], v[214:217], v[142:145]
    v_mov_b32_dpp v136, v114 quad_perm:[0,1,2,3] row_mask:0x2 bank_mask:0xf
    v_cvt_pk_bf16_f32 v176, v176, 0
    v_mfma_f32_16x16x32_bf16 v[142:145], a[68:71], v[226:229], v[142:145]
    v_mov_b32_dpp v136, v115 quad_perm:[0,1,2,3] row_mask:0x4 bank_mask:0xf
    v_cvt_pk_bf16_f32 v177, v177, 0
    v_mfma_f32_16x16x32_bf16 v[114:117], v[194:197], a[144:147], 0
    ds_write2_b32 v178, v176, v177 offset0:136 offset1:204
    v_mfma_f32_16x16x32_bf16 v[114:117], v[198:201], a[148:151], v[114:117]
    v_mov_b32_dpp v136, v239 quad_perm:[0,1,2,3] row_mask:0x8 bank_mask:0xf
    v_cvt_pk_bf16_f32 v186, v186, 0
    v_mfma_f32_16x16x32_bf16 v[114:117], v[222:225], a[152:155], v[114:117]
    ds_write_b32 v130, v136 offset:63552
    v_mfma_f32_16x16x32_bf16 v[114:117], v[146:149], a[156:159], v[114:117]
    v_cvt_pk_bf16_f32 v187, v187, 0
    v_cvt_pk_bf16_f32 v188, v188, 0
    v_mfma_f32_16x16x32_bf16 v[114:117], v[214:217], a[160:163], v[114:117]
    ds_write2_b32 v178, v186, v187 offset0:16 offset1:84
    v_mfma_f32_16x16x32_bf16 v[114:117], v[226:229], a[164:167], v[114:117]
    v_cvt_pk_bf16_f32 v189, v189, 0
    v_cvt_pk_bf16_f32 v122, v122, 0
    v_mfma_f32_16x16x32_bf16 v[130:133], v[194:197], a[168:171], 0
    ds_write2_b32 v178, v188, v189 offset0:152 offset1:220
    v_mfma_f32_16x16x32_bf16 v[130:133], v[198:201], a[172:175], v[130:133]
    v_cvt_pk_bf16_f32 v123, v123, 0
    v_cvt_pk_bf16_f32 v124, v124, 0
    v_mfma_f32_16x16x32_bf16 v[130:133], v[222:225], a[176:179], v[130:133]
    ds_write2_b32 v178, v122, v123 offset0:32 offset1:100
    v_mfma_f32_16x16x32_bf16 v[130:133], v[146:149], a[180:183], v[130:133]
    s_waitcnt lgkmcnt(3)
    v_cvt_pk_bf16_f32 v125, v125, 0
    v_cvt_pk_bf16_f32 v156, v114, v115
    v_mfma_f32_16x16x32_bf16 v[130:133], v[214:217], a[184:187], v[130:133]
    s_barrier
    ds_read_b128 v[174:177], v0 offset:32768
    ds_read_b128 v[170:173], v1 offset:32768
    v_mfma_f32_16x16x32_bf16 v[130:133], v[226:229], a[188:191], v[130:133]
    ds_read_b128 v[230:233], v0 offset:32896
    ds_read_b128 v[218:221], v126 offset:18432
    v_mfma_f32_16x16x32_bf16 v[238:241], v[194:197], a[192:195], 0
    v_cvt_pk_bf16_f32 v157, v116, v117
    v_fma_f32 v136, v166, v166, s32
    v_mfma_f32_16x16x32_bf16 v[238:241], v[198:201], a[196:199], v[238:241]
    ds_read_b128 v[114:117], v1 offset:32896
    ds_read_b128 v[194:197], v0 offset:33024
    v_mfma_f32_16x16x32_bf16 v[238:241], v[222:225], a[200:203], v[238:241]
    v_fmac_f32 v136, v167, v167
    v_fmac_f32 v136, v168, v168
    v_mfma_f32_16x16x32_bf16 v[238:241], v[146:149], a[204:207], v[238:241]
    ds_read_b128 v[222:225], v1 offset:33024
    ds_read_b128 v[146:149], v126 offset:19456
    v_mfma_f32_16x16x32_bf16 v[238:241], v[214:217], a[208:211], v[238:241]
    v_fmac_f32 v136, v169, v169
    v_fmac_f32 v136, v118, v118
    v_mfma_f32_16x16x32_bf16 v[238:241], v[226:229], a[212:215], v[238:241]
    ds_read_b128 v[198:201], v126 offset:63552
    v_fmac_f32 v136, v119, v119
    v_mfma_f32_16x16x32_f16 v[126:129], v[150:153], v[138:141], v[46:49]
    s_waitcnt lgkmcnt(7)
    ds_write2_b32 v178, v124, v125 offset0:168 offset1:236
    v_mfma_f32_16x16x32_bf16 v[178:181], a[72:75], v[174:177], 0
    s_waitcnt lgkmcnt(6)
    v_add_f32 v218, v218, v219
    v_add_f32 v220, v220, v221
    v_mfma_f32_16x16x32_bf16 v[178:181], a[76:79], v[170:173], v[178:181]
    s_waitcnt lgkmcnt(5)
    v_add_f32 v218, v218, v220
    v_mul_f32 v218, 0xbbaaaaab, v218
    v_mfma_f32_16x16x32_bf16 v[178:181], a[80:83], v[230:233], v[178:181]
    s_waitcnt lgkmcnt(4)
    ds_write_b32 v160, v218 offset:0
    v_mfma_f32_16x16x32_bf16 v[178:181], a[84:87], v[114:117], v[178:181]
    s_waitcnt lgkmcnt(4)
    v_fmac_f32 v136, v120, v120
    v_fmac_f32 v136, v121, v121
    v_mfma_f32_16x16x32_bf16 v[178:181], a[88:91], v[194:197], v[178:181]
    s_waitcnt lgkmcnt(3)
    ds_read_b128 v[218:221], v158 offset:0
    ds_read_b128 v[122:125], v158 offset:64
    v_mfma_f32_16x16x32_bf16 v[178:181], a[92:95], v[222:225], v[178:181]
    s_waitcnt lgkmcnt(4)
    v_add_f32 v146, v146, v147
    v_add_f32 v148, v148, v149
    v_mfma_f32_16x16x32_bf16 v[214:217], a[96:99], v[174:177], 0
    v_add_f32 v146, v146, v148
    v_mul_f32 v146, 0xbbaaaaab, v146
    v_mfma_f32_16x16x32_bf16 v[214:217], a[100:103], v[170:173], v[214:217]
    ds_write_b32 v160, v146 offset:256
    v_mfma_f32_16x16x32_bf16 v[214:217], a[104:107], v[230:233], v[214:217]
    v_add_f32 v198, v198, v199
    v_add_f32 v200, v200, v201
    v_mfma_f32_16x16x32_bf16 v[214:217], a[108:111], v[114:117], v[214:217]
    v_add_f32 v198, v198, v200
    v_mul_f32 v198, 0xbbaaaaab, v198
    v_mfma_f32_16x16x32_bf16 v[214:217], a[112:115], v[194:197], v[214:217]
    ds_write_b32 v160, v198 offset:512
    v_mfma_f32_16x16x32_bf16 v[214:217], a[116:119], v[222:225], v[214:217]
    v_fmac_f32 v136, v142, v142
    v_fmac_f32 v136, v143, v143
    v_mfma_f32_16x16x32_bf16 v[146:149], a[120:123], v[174:177], 0
    s_waitcnt lgkmcnt(2)
    v_fmac_f32 v136, v144, v144
    v_fmac_f32 v136, v145, v145
    v_mfma_f32_16x16x32_bf16 v[146:149], a[124:127], v[170:173], v[146:149]
    v_fma_f32 v137, v246, v246, s32
    v_fmac_f32 v137, v247, v247
    v_mfma_f32_16x16x32_bf16 v[146:149], a[128:131], v[230:233], v[146:149]
    v_fmac_f32 v137, v248, v248
    v_fmac_f32 v137, v249, v249
    v_mfma_f32_16x16x32_bf16 v[146:149], a[132:135], v[114:117], v[146:149]
    v_fmac_f32 v137, v206, v206
    v_fmac_f32 v137, v207, v207
    v_mfma_f32_16x16x32_bf16 v[146:149], a[136:139], v[194:197], v[146:149]
    v_fmac_f32 v137, v208, v208
    v_fmac_f32 v137, v209, v209
    v_mfma_f32_16x16x32_bf16 v[146:149], a[140:143], v[222:225], v[146:149]
    v_fmac_f32 v137, v210, v210
    v_fmac_f32 v137, v211, v211
    v_mfma_f32_16x16x32_bf16 v[198:201], a[0:3], v[174:177], 0
    v_fmac_f32 v137, v212, v212
    v_fmac_f32 v137, v213, v213
    v_mfma_f32_16x16x32_bf16 v[198:201], a[4:7], v[170:173], v[198:201]
    v_cvt_pk_bf16_f32 v36, v136, v137
    v_cvt_pk_bf16_f32 v184, v130, v131
    v_mfma_f32_16x16x32_bf16 v[198:201], a[8:11], v[230:233], v[198:201]
    v_cvt_pk_bf16_f32 v185, v132, v133
    v_cvt_pk_bf16_f32 v136, v238, v239
    v_mfma_f32_16x16x32_bf16 v[130:133], v[32:35], v[36:39], 0
    v_cvt_pk_bf16_f32 v137, v240, v241
    v_fma_f32 v159, v178, v178, s32
    v_mfma_f32_16x16x32_bf16 v[198:201], a[12:15], v[114:117], v[198:201]
    v_fmac_f32 v159, v179, v179
    v_fmac_f32 v159, v180, v180
    v_mfma_f32_16x16x32_bf16 v[198:201], a[16:19], v[194:197], v[198:201]
    v_fmac_f32 v159, v181, v181
    v_fmac_f32 v159, v214, v214
    v_mfma_f32_16x16x32_bf16 v[198:201], a[20:23], v[222:225], v[198:201]
    v_rsq_f32 v131, v131
    v_mfma_f32_16x16x32_bf16 v[238:241], a[24:27], v[174:177], 0
    v_rsq_f32 v130, v130
    v_mfma_f32_16x16x32_bf16 v[238:241], a[28:31], v[170:173], v[238:241]
    ds_read2_b32 v[132:133], v6 offset0:0 offset1:0
    ds_read2_b32 v[228:229], v6 offset0:16 offset1:16
    v_mfma_f32_16x16x32_bf16 v[238:241], a[32:35], v[230:233], v[238:241]
    ds_read2_b32 v[192:193], v6 offset0:32 offset1:32
    v_mul_f32 v130, s31, v130
    v_mfma_f32_16x16x32_bf16 v[238:241], a[36:39], v[114:117], v[238:241]
    v_mul_f32 v246, v131, v246
    v_mul_f32 v247, v131, v247
    v_mfma_f32_16x16x32_bf16 v[238:241], a[40:43], v[194:197], v[238:241]
    v_cvt_pk_f16_f32 v202, v246, v247
    v_mul_f32 v248, v131, v248
    v_mfma_f32_16x16x32_bf16 v[238:241], a[44:47], v[222:225], v[238:241]
    v_mul_f32 v249, v131, v249
    v_cvt_pk_f16_f32 v203, v248, v249
    v_mul_f32 v206, v131, v206
    v_mfma_f32_16x16x16_f16 v[126:129], v[164:165], v[162:163], v[126:129]
    v_mul_f32 v207, v131, v207
    v_cvt_pk_f16_f32 v204, v206, v207
    v_mul_f32 v208, v131, v208
    v_mul_f32 v209, v131, v209
    v_cvt_pk_f16_f32 v205, v208, v209
    v_mfma_f32_16x16x32_bf16 v[206:209], a[48:51], v[174:177], 0
    v_mul_f32 v210, v131, v210
    v_mul_f32 v211, v131, v211
    v_mfma_f32_16x16x32_bf16 v[206:209], a[52:55], v[170:173], v[206:209]
    s_waitcnt lgkmcnt(1)
    v_cvt_pk_f16_f32 v188, v210, v211
    v_mul_f32 v212, v131, v212
    v_mfma_f32_16x16x32_bf16 v[206:209], a[56:59], v[230:233], v[206:209]
    s_waitcnt lgkmcnt(0)
    v_mul_f32 v213, v131, v213
    v_cvt_pk_f16_f32 v189, v212, v213
    v_mfma_f32_16x16x32_bf16 v[206:209], a[60:63], v[114:117], v[206:209]
    v_mul_f32 v166, v130, v166
    v_mul_f32 v167, v130, v167
    v_mfma_f32_16x16x32_bf16 v[206:209], a[64:67], v[194:197], v[206:209]
    v_cvt_pk_f16_f32 v166, v166, v167
    v_mul_f32 v168, v130, v168
    v_mfma_f32_16x16x32_bf16 v[206:209], a[68:71], v[222:225], v[206:209]
    v_mul_f32 v169, v130, v169
    v_cvt_pk_f16_f32 v167, v168, v169
    v_mfma_f32_16x16x32_bf16 v[210:213], v[174:177], a[144:147], 0
    v_mul_f32 v118, v130, v118
    v_mul_f32 v119, v130, v119
    v_mfma_f32_16x16x32_bf16 v[210:213], v[170:173], a[148:151], v[210:213]
    v_cvt_pk_f16_f32 v168, v118, v119
    v_mul_f32 v120, v130, v120
    v_mfma_f32_16x16x32_bf16 v[210:213], v[230:233], a[152:155], v[210:213]
    v_mul_f32 v121, v130, v121
    v_cvt_pk_f16_f32 v169, v120, v121
    v_mfma_f32_16x16x32_bf16 v[210:213], v[114:117], a[156:159], v[210:213]
    v_mul_f32 v142, v130, v142
    v_mul_f32 v143, v130, v143
    v_mfma_f32_16x16x32_bf16 v[210:213], v[194:197], a[160:163], v[210:213]
    v_cvt_pk_f16_f32 v186, v142, v143
    v_mul_f32 v144, v130, v144
    v_mfma_f32_16x16x32_bf16 v[210:213], v[222:225], a[164:167], v[210:213]
    v_mul_f32 v145, v130, v145
    v_cvt_pk_f16_f32 v187, v144, v145
    v_mfma_f32_16x16x32_bf16 v[142:145], v[174:177], a[168:171], 0
    v_fma_f32 v160, v198, v198, s32
    v_fmac_f32 v160, v199, v199
    v_mfma_f32_16x16x32_bf16 v[142:145], v[170:173], a[172:175], v[142:145]
    ds_read_b32 v161, v6 offset:192
    v_fmac_f32 v160, v200, v200
    v_mfma_f32_16x16x32_bf16 v[142:145], v[230:233], a[176:179], v[142:145]
    v_cvt_pk_bf16_f32 v130, v210, v211
    v_cvt_pk_bf16_f32 v131, v212, v213
    v_mfma_f32_16x16x32_bf16 v[142:145], v[114:117], a[180:183], v[142:145]
    v_fmac_f32 v160, v201, v201
    v_fmac_f32 v160, v238, v238
    v_mfma_f32_16x16x32_bf16 v[142:145], v[194:197], a[184:187], v[142:145]
    v_fmac_f32 v160, v239, v239
    v_fmac_f32 v160, v240, v240
    v_mfma_f32_16x16x32_bf16 v[142:145], v[222:225], a[188:191], v[142:145]
    v_fmac_f32 v160, v241, v241
    v_fmac_f32 v160, v206, v206
    v_fmac_f32 v160, v207, v207
    v_fmac_f32 v160, v208, v208
    v_fmac_f32 v160, v209, v209
    v_fmac_f32 v159, v215, v215
    v_fmac_f32 v159, v216, v216
    v_fmac_f32 v159, v217, v217
    v_fmac_f32 v159, v146, v146
    v_fmac_f32 v159, v147, v147
    v_fmac_f32 v159, v148, v148
    v_fmac_f32 v159, v149, v149
    v_cvt_pk_bf16_f32 v36, v160, v159
    v_mfma_f32_16x16x32_bf16 v[118:121], v[174:177], a[192:195], 0
    s_waitcnt lgkmcnt(0)
    ds_read_b128 v[174:177], v5 offset:0
    v_cvt_pk_bf16_f32 v226, v142, v143
    v_mfma_f32_16x16x32_bf16 v[118:121], v[170:173], a[196:199], v[118:121]
    ds_read_b128 v[170:173], v5 offset:16
    v_cvt_pk_bf16_f32 v227, v144, v145
    v_mfma_f32_16x16x32_bf16 v[118:121], v[230:233], a[200:203], v[118:121]
    ds_read_b128 v[142:145], v5 offset:48
    v_xor_b32 v0, 65536, v0
    v_mfma_f32_16x16x32_bf16 v[118:121], v[114:117], a[204:207], v[118:121]
    v_xor_b32 v1, 65536, v1
    v_add_u32 v5, 336, v5
    v_mfma_f32_16x16x32_bf16 v[114:117], v[32:35], v[36:39], 0
    v_add_u32 v6, 272, v6
    v_xor_b32 v2, 65536, v2
    v_mfma_f32_16x16x32_bf16 v[118:121], v[194:197], a[208:211], v[118:121]
    v_mfma_f32_16x16x32_f16 v[230:233], v[202:205], v[138:141], v[50:53]
    v_mfma_f32_16x16x32_bf16 v[118:121], v[222:225], a[212:215], v[118:121]
    v_mfma_f32_16x16x16_bf16 v[222:225], a[216:217], v[254:255], v[218:221]
    v_mfma_f32_16x16x16_bf16 v[194:197], a[240:241], v[254:255], v[218:221]
    s_nop 0
    v_rsq_f32 v115, v115
    v_rsq_f32 v114, v114
    s_waitcnt vmcnt(0)
    v_mfma_f32_16x16x16_f16 v[230:233], v[188:189], v[162:163], v[230:233]
    s_barrier
    buffer_load_dwordx4 v10, s[8:11], 0 offen nt lds
    s_add_u32 m0, s28, 4096
    v_mul_f32 v114, s31, v114
    v_cvt_pk_bf16_f32 v190, v118, v119
    v_cvt_pk_bf16_f32 v191, v120, v121
    v_mul_f32 v178, v115, v178
    v_mul_f32 v179, v115, v179
    v_cvt_pk_f16_f32 v178, v178, v179
    v_mul_f32 v180, v115, v180
    v_mul_f32 v181, v115, v181
    v_cvt_pk_f16_f32 v179, v180, v181
    v_mfma_f32_16x16x16_bf16 v[210:213], v[90:91], v[254:255], v[218:221]
    v_mul_f32 v214, v115, v214
    v_mul_f32 v215, v115, v215
    v_cvt_pk_f16_f32 v180, v214, v215
    v_mfma_f32_16x16x16_bf16 v[118:121], a[218:219], v[254:255], v[122:125]
    buffer_load_dwordx4 v11, s[8:11], 0 offen nt lds
    s_add_u32 m0, s28, 8192
    v_mul_f32 v216, v115, v216
    v_mul_f32 v217, v115, v217
    v_cvt_pk_f16_f32 v181, v216, v217
    v_mul_f32 v146, v115, v146
    v_mul_f32 v147, v115, v147
    v_cvt_pk_f16_f32 v220, v146, v147
    v_mul_f32 v148, v115, v148
    v_mul_f32 v149, v115, v149
    v_mfma_f32_16x16x32_f16 v[214:217], v[178:181], v[138:141], v[54:57]
    v_cvt_pk_f16_f32 v221, v148, v149
    v_mul_f32 v198, v114, v198
    v_mul_f32 v199, v114, v199
    v_cvt_pk_f16_f32 v146, v198, v199
    buffer_load_dwordx4 v12, s[8:11], 0 offen nt lds
    s_add_u32 m0, s28, 12288
    v_mfma_f32_16x16x16_f16 v[214:217], v[220:221], v[162:163], v[214:217]
    s_xor_b32 s28, s28, 65536
    v_mul_f32 v200, v114, v200
    v_mul_f32 v201, v114, v201
    v_cvt_pk_f16_f32 v147, v200, v201
    v_mul_f32 v238, v114, v238
    v_mul_f32 v239, v114, v239
    v_cvt_pk_f16_f32 v148, v238, v239
    v_mfma_f32_16x16x16_bf16 v[198:201], a[242:243], v[254:255], v[122:125]
    v_mul_f32 v240, v114, v240
    v_mul_f32 v241, v114, v241
    v_cvt_pk_f16_f32 v149, v240, v241
    v_mul_f32 v206, v114, v206
    v_mul_f32 v207, v114, v207
    buffer_load_dwordx4 v13, s[8:11], 0 offen nt lds
    s_mov_b32 m0, s29
    s_xor_b32 s29, s29, s30
    v_cvt_pk_f16_f32 v218, v206, v207
    v_mul_f32 v208, v114, v208
    v_mul_f32 v209, v114, v209
    v_cvt_pk_f16_f32 v219, v208, v209
    v_mfma_f32_16x16x16_bf16 v[114:117], v[92:93], v[254:255], v[122:125]
    s_waitcnt lgkmcnt(0)
    v_cvt_pk_bf16_f32 v222, v222, v223
    v_accvgpr_write_b32 a216, v222
    v_cvt_pk_bf16_f32 v224, v224, v225
    v_mfma_f32_16x16x32_f16 v[122:125], v[174:177], v[138:141], v[22:25]
    v_accvgpr_write_b32 a217, v224
    v_cvt_pk_bf16_f32 v194, v194, v195
    v_mfma_f32_16x16x32_f16 v[122:125], v[170:173], v[150:153], v[122:125]
    buffer_load_dwordx4 v14, s[8:11], 0 offen nt lds
    v_accvgpr_write_b32 a240, v194
    v_mfma_f32_16x16x32_f16 v[122:125], v[142:145], v[162:165], v[122:125]
    v_cvt_pk_bf16_f32 v196, v196, v197
    v_accvgpr_write_b32 a241, v196
    v_mfma_f32_16x16x32_f16 v[238:241], v[174:177], v[166:169], v[24:27]
    v_cvt_pk_bf16_f32 v90, v210, v211
    v_cvt_pk_bf16_f32 v91, v212, v213
    v_mfma_f32_16x16x32_f16 v[238:241], v[170:173], v[202:205], v[238:241]
    ds_read_b128 v[138:141], v158 offset:128
    v_cvt_pk_bf16_f32 v118, v118, v119
    v_mfma_f32_16x16x32_f16 v[238:241], v[142:145], v[186:189], v[238:241]
    v_mov_b32_dpp v161, v123 quad_perm:[0,1,2,3] row_mask:0x1 bank_mask:0xf
    v_max3_f32 v159, v122, v126, v127
    v_mfma_f32_16x16x32_f16 v[222:225], v[174:177], v[146:149], v[26:29]
    v_max3_f32 v159, v159, v128, v129
    v_max3_f32 v159, v159, v230, v231
    v_mfma_f32_16x16x32_f16 v[222:225], v[170:173], v[178:181], v[222:225]
    v_max3_f32 v159, v159, v232, v233
    v_max3_f32 v159, v159, v214, v215
    v_mfma_f32_16x16x32_f16 v[222:225], v[142:145], v[218:221], v[222:225]
    v_mov_b32_dpp v161, v239 quad_perm:[0,1,2,3] row_mask:0x2 bank_mask:0xf
    v_max3_f32 v159, v159, v216, v217
    v_mov_b32 v160, v159
    v_accvgpr_write_b32 a218, v118
    v_cvt_pk_bf16_f32 v120, v120, v121
    v_permlane32_swap_b32 v159, v160
    v_max_f32 v159, v159, v160
    v_mov_b32 v160, v159
    v_mov_b32_dpp v161, v223 quad_perm:[0,1,2,3] row_mask:0x4 bank_mask:0xf
    v_accvgpr_write_b32 a219, v120
    v_permlane16_swap_b32 v159, v160
    s_waitcnt lgkmcnt(0)
    v_mfma_f32_16x16x16_bf16 v[142:145], a[232:233], v[254:255], v[138:141]
    v_max_f32 v159, v159, v160
    v_sub_f32 v126, v126, v159
    v_sub_f32 v127, v127, v159
    v_mfma_f32_16x16x16_bf16 v[174:177], v[82:83], v[254:255], v[138:141]
    v_exp_f32 v126, v126
    v_sub_f32 v128, v128, v159
    v_mfma_f32_16x16x16_bf16 v[118:121], v[106:107], v[254:255], v[138:141]
    v_exp_f32 v127, v127
    v_exp_f32 v128, v128
    v_cvt_pk_bf16_f32 v126, v126, v127
    v_sub_f32 v129, v129, v159
    v_exp_f32 v129, v129
    v_sub_f32 v230, v230, v159
    v_cvt_pk_bf16_f32 v127, v128, v129
    v_exp_f32 v230, v230
    v_mfma_f32_16x16x32_f16 v[138:141], v[150:153], v[166:169], v[58:61]
    v_sub_f32 v231, v231, v159
    v_exp_f32 v231, v231
    v_sub_f32 v232, v232, v159
    v_cvt_pk_bf16_f32 v128, v230, v231
    v_exp_f32 v232, v232
    v_sub_f32 v233, v233, v159
    v_mfma_f32_16x16x16_f16 v[138:141], v[164:165], v[186:187], v[138:141]
    v_exp_f32 v233, v233
    v_sub_f32 v214, v214, v159
    v_cvt_pk_bf16_f32 v129, v232, v233
    v_mfma_f32_16x16x32_f16 v[230:233], v[202:205], v[166:169], v[62:65]
    v_exp_f32 v214, v214
    v_sub_f32 v215, v215, v159
    v_exp_f32 v215, v215
    v_sub_f32 v216, v216, v159
    v_cvt_pk_bf16_f32 v36, v214, v215
    v_exp_f32 v216, v216
    v_mfma_f32_16x16x32_f16 v[170:173], v[178:181], v[166:169], v[66:69]
    v_sub_f32 v217, v217, v159
    v_exp_f32 v217, v217
    v_mfma_f32_16x16x16_f16 v[230:233], v[188:189], v[186:187], v[230:233]
    v_cvt_pk_bf16_f32 v37, v216, v217
    v_sub_f32 v122, v122, v159
    v_exp_f32 v122, v122
    v_mfma_f32_16x16x16_f16 v[170:173], v[220:221], v[186:187], v[170:173]
    v_cvt_pk_bf16_f32 v39, v122, 0
    v_cvt_pk_bf16_f32 v198, v198, v199
    v_accvgpr_write_b32 a242, v198
    v_cvt_pk_bf16_f32 v200, v200, v201
    v_mfma_f32_16x16x32_bf16 v[122:125], v[28:31], v[36:39], 0
    v_accvgpr_write_b32 a243, v200
    v_cvt_pk_bf16_f32 v92, v114, v115
    v_mfma_f32_16x16x32_bf16 v[122:125], v[28:31], v[126:129], v[122:125]
    v_cvt_pk_bf16_f32 v93, v116, v117
    v_cvt_pk_bf16_f32 v142, v142, v143
    v_mfma_f32_16x16x32_bf16 v[166:169], v[130:133], v[36:39], 0
    ds_read_b128 v[114:117], v158 offset:192
    v_accvgpr_write_b32 a232, v142
    v_mfma_f32_16x16x32_bf16 v[166:169], v[154:157], v[126:129], v[166:169]
    v_cvt_pk_bf16_f32 v144, v144, v145
    v_accvgpr_write_b32 a233, v144
    v_mfma_f32_16x16x32_bf16 v[198:201], v[226:229], v[36:39], 0
    v_rcp_f32 v123, v122
    v_mfma_f32_16x16x32_bf16 v[198:201], v[182:185], v[126:129], v[198:201]
    v_cvt_pk_bf16_f32 v82, v174, v175
    v_cvt_pk_bf16_f32 v83, v176, v177
    v_mfma_f32_16x16x32_bf16 v[142:145], v[190:193], v[36:39], 0
    v_mul_f32 v166, v123, v166
    v_mul_f32 v167, v123, v167
    v_mfma_f32_16x16x32_bf16 v[142:145], v[134:137], v[126:129], v[142:145]
    v_cvt_pk_bf16_f32 v126, v166, v167
    v_mul_f32 v168, v123, v168
    v_mul_f32 v169, v123, v169
    v_cvt_pk_bf16_f32 v127, v168, v169
    v_mul_f32 v198, v123, v198
    v_mul_f32 v199, v123, v199
    v_cvt_pk_bf16_f32 v128, v198, v199
    v_mul_f32 v200, v123, v200
    s_waitcnt lgkmcnt(0)
    v_mfma_f32_16x16x16_bf16 v[174:177], a[220:221], v[254:255], v[114:117]
    v_mul_f32 v201, v123, v201
    v_cvt_pk_bf16_f32 v129, v200, v201
    v_mul_f32 v142, v123, v142
    v_mfma_f32_16x16x16_bf16 v[166:169], a[244:245], v[254:255], v[114:117]
    v_mul_f32 v143, v123, v143
    v_cvt_pk_bf16_f32 v162, v142, v143
    v_mul_f32 v144, v123, v144
    v_mfma_f32_16x16x16_bf16 v[198:201], v[94:95], v[254:255], v[114:117]
    ds_write_b128 v3, v[126:129] offset:0
    v_mul_f32 v145, v123, v145
    v_cvt_pk_bf16_f32 v163, v144, v145
    v_cvt_pk_bf16_f32 v106, v118, v119
    v_cvt_pk_bf16_f32 v107, v120, v121
    v_cvt_pk_bf16_f32 v174, v174, v175
    v_accvgpr_write_b32 a220, v174
    v_cvt_pk_bf16_f32 v176, v176, v177
    ds_read_b128 v[126:129], v158 offset:256
    ds_write_b64 v4, v[162:163] offset:4096
    v_accvgpr_write_b32 a221, v176
    v_cvt_pk_bf16_f32 v166, v166, v167
    v_accvgpr_write_b32 a244, v166
    v_cvt_pk_bf16_f32 v168, v168, v169
    v_accvgpr_write_b32 a245, v168
    v_cvt_pk_bf16_f32 v94, v198, v199
    v_cvt_pk_bf16_f32 v95, v200, v201
    ds_read_b128 v[142:145], v158 offset:320
    v_mov_b32 v159, v161
    v_max3_f32 v186, v238, v138, v139
    v_max3_f32 v186, v186, v140, v141
    v_max_f32_dpp v159, v159, v159 quad_perm:[1,0,3,2] row_mask:0xf bank_mask:0xf
    v_max3_f32 v186, v186, v230, v231
    v_max3_f32 v186, v186, v232, v233
    v_max_f32_dpp v159, v159, v159 quad_perm:[2,3,0,1] row_mask:0xf bank_mask:0xf
    v_max3_f32 v186, v186, v170, v171
    v_max3_f32 v186, v186, v172, v173
    v_max_f32_dpp v159, v159, v159 row_half_mirror row_mask:0xf bank_mask:0xf
    v_mov_b32 v187, v186
    s_nop 0
    v_max_f32_dpp v159, v159, v159 row_mirror row_mask:0xf bank_mask:0xf
    v_mov_b32 v160, v159
    s_waitcnt lgkmcnt(2)
    v_mfma_f32_16x16x16_bf16 v[174:177], a[222:223], v[254:255], v[126:129]
    v_permlane32_swap_b32 v159, v160
    v_max_f32 v159, v159, v160
    v_mfma_f32_16x16x16_bf16 v[118:121], a[246:247], v[254:255], v[126:129]
    v_mov_b32 v160, v159
    v_permlane32_swap_b32 v186, v187
    v_mfma_f32_16x16x16_bf16 v[122:125], v[96:97], v[254:255], v[126:129]
    v_permlane16_swap_b32 v159, v160
    v_max_f32 v159, v159, v160
    s_waitcnt lgkmcnt(0)
    v_mfma_f32_16x16x16_bf16 v[166:169], a[234:235], v[254:255], v[142:145]
    v_cvt_pk_bf16_f32 v174, v174, v175
    v_accvgpr_write_b32 a222, v174
    v_cvt_pk_bf16_f32 v176, v176, v177
    v_mfma_f32_16x16x16_bf16 v[114:117], v[84:85], v[254:255], v[142:145]
    v_accvgpr_write_b32 a223, v176
    v_cvt_pk_bf16_f32 v118, v118, v119
    v_accvgpr_write_b32 a246, v118
    v_mfma_f32_16x16x16_bf16 v[126:129], v[108:109], v[254:255], v[142:145]
    v_cvt_pk_bf16_f32 v120, v120, v121
    v_accvgpr_write_b32 a247, v120
    v_cvt_pk_bf16_f32 v96, v122, v123
    v_cvt_pk_bf16_f32 v97, v124, v125
    ds_read_b128 v[142:145], v158 offset:384
    v_cvt_pk_bf16_f32 v166, v166, v167
    v_accvgpr_write_b32 a234, v166
    v_cvt_pk_bf16_f32 v168, v168, v169
    v_accvgpr_write_b32 a235, v168
    v_cvt_pk_bf16_f32 v84, v114, v115
    v_cvt_pk_bf16_f32 v85, v116, v117
    v_cvt_pk_bf16_f32 v108, v126, v127
    v_cvt_pk_bf16_f32 v109, v128, v129
    ds_read_b128 v[126:129], v158 offset:448
    v_sub_f32 v161, v161, v159
    v_exp_f32 v161, v161
    v_max_f32 v186, v186, v187
    v_cvt_pk_bf16_f32 v161, v161, v161
    ds_write_b16 v8, v161
    v_mov_b32 v187, v186
    ds_read_b128 v[174:177], v9
    ds_read_b128 v[122:125], v9 offset:64
    v_permlane16_swap_b32 v186, v187
    s_waitcnt lgkmcnt(4)
    v_mfma_f32_16x16x16_bf16 v[118:121], a[224:225], v[254:255], v[142:145]
    v_max_f32 v186, v186, v187
    v_sub_f32 v138, v138, v186
    v_sub_f32 v139, v139, v186
    v_mfma_f32_16x16x16_bf16 v[166:169], a[248:249], v[254:255], v[142:145]
    v_exp_f32 v138, v138
    v_sub_f32 v140, v140, v186
    v_mfma_f32_16x16x16_bf16 v[114:117], v[98:99], v[254:255], v[142:145]
    v_exp_f32 v139, v139
    s_waitcnt lgkmcnt(3)
    v_mfma_f32_16x16x16_bf16 v[198:201], a[226:227], v[254:255], v[126:129]
    v_cvt_pk_bf16_f32 v118, v118, v119
    v_accvgpr_write_b32 a224, v118
    v_cvt_pk_bf16_f32 v120, v120, v121
    v_mfma_f32_16x16x16_bf16 v[142:145], a[250:251], v[254:255], v[126:129]
    v_accvgpr_write_b32 a225, v120
    v_cvt_pk_bf16_f32 v166, v166, v167
    v_accvgpr_write_b32 a248, v166
    v_mfma_f32_16x16x16_bf16 v[118:121], v[100:101], v[254:255], v[126:129]
    v_cvt_pk_bf16_f32 v168, v168, v169
    v_accvgpr_write_b32 a249, v168
    s_waitcnt lgkmcnt(1)
    v_cvt_pk_bf16_f32 v98, v114, v115
    v_mfma_f32_16x16x32_bf16 v[126:129], v[174:177], v[28:31], 0
    s_waitcnt lgkmcnt(0)
    v_cvt_pk_bf16_f32 v99, v116, v117
    v_cvt_pk_bf16_f32 v198, v198, v199
    v_mfma_f32_16x16x32_bf16 v[126:129], v[122:125], v[28:31], v[126:129]
    ds_read_b128 v[166:169], v158 offset:512
    v_accvgpr_write_b32 a226, v198
    v_mfma_f32_16x16x32_bf16 v[114:117], v[174:177], v[154:157], 0
    v_cvt_pk_bf16_f32 v200, v200, v201
    v_accvgpr_write_b32 a227, v200
    v_mfma_f32_16x16x32_bf16 v[114:117], v[122:125], v[130:133], v[114:117]
    v_cvt_pk_bf16_f32 v142, v142, v143
    v_accvgpr_write_b32 a250, v142
    v_mfma_f32_16x16x32_bf16 v[198:201], v[174:177], v[182:185], 0
    v_cvt_pk_bf16_f32 v144, v144, v145
    v_accvgpr_write_b32 a251, v144
    v_mfma_f32_16x16x32_bf16 v[198:201], v[122:125], v[226:229], v[198:201]
    v_cvt_pk_bf16_f32 v100, v118, v119
    v_cvt_pk_bf16_f32 v101, v120, v121
    v_mfma_f32_16x16x32_bf16 v[142:145], v[174:177], v[134:137], 0
    ds_read_b128 v[174:177], v158 offset:576
    v_cvt_pk_bf16_f32 v138, v138, v139
    v_mfma_f32_16x16x32_bf16 v[142:145], v[122:125], v[190:193], v[142:145]
    v_exp_f32 v140, v140
    v_sub_f32 v141, v141, v186
    v_exp_f32 v141, v141
    s_waitcnt lgkmcnt(1)
    v_mfma_f32_16x16x16_bf16 v[118:121], a[236:237], v[254:255], v[166:169]
    v_cvt_pk_bf16_f32 v139, v140, v141
    v_sub_f32 v230, v230, v186
    v_sub_f32 v231, v231, v186
    v_mfma_f32_16x16x16_bf16 v[122:125], v[86:87], v[254:255], v[166:169]
    v_exp_f32 v230, v230
    v_sub_f32 v232, v232, v186
    v_mfma_f32_16x16x16_bf16 v[194:197], v[110:111], v[254:255], v[166:169]
    v_exp_f32 v231, v231
    v_cvt_pk_bf16_f32 v118, v118, v119
    v_accvgpr_write_b32 a236, v118
    v_cvt_pk_bf16_f32 v120, v120, v121
    v_accvgpr_write_b32 a237, v120
    v_cvt_pk_bf16_f32 v86, v122, v123
    v_cvt_pk_bf16_f32 v87, v124, v125
    v_cvt_pk_bf16_f32 v140, v230, v231
    s_waitcnt lgkmcnt(0)
    v_mfma_f32_16x16x16_bf16 v[118:121], a[228:229], v[254:255], v[174:177]
    v_cvt_pk_bf16_f32 v110, v194, v195
    v_cvt_pk_bf16_f32 v111, v196, v197
    v_sub_f32 v233, v233, v186
    v_mfma_f32_16x16x16_bf16 v[122:125], a[252:253], v[254:255], v[174:177]
    v_exp_f32 v232, v232
    v_sub_f32 v170, v170, v186
    v_mfma_f32_16x16x16_bf16 v[194:197], v[102:103], v[254:255], v[174:177]
    ds_read_b128 v[166:169], v158 offset:640
    v_cvt_pk_bf16_f32 v118, v118, v119
    v_accvgpr_write_b32 a228, v118
    v_cvt_pk_bf16_f32 v120, v120, v121
    v_accvgpr_write_b32 a229, v120
    v_cvt_pk_bf16_f32 v122, v122, v123
    v_accvgpr_write_b32 a252, v122
    v_cvt_pk_bf16_f32 v124, v124, v125
    v_accvgpr_write_b32 a253, v124
    v_cvt_pk_bf16_f32 v102, v194, v195
    v_cvt_pk_bf16_f32 v103, v196, v197
    ds_read_b128 v[174:177], v158 offset:704
    v_exp_f32 v233, v233
    v_mfma_f32_16x16x32_f16 v[118:121], v[150:153], v[146:149], v[70:73]
    v_cvt_pk_bf16_f32 v141, v232, v233
    v_exp_f32 v170, v170
    v_sub_f32 v171, v171, v186
    v_exp_f32 v171, v171
    v_sub_f32 v172, v172, v186
    v_cvt_pk_bf16_f32 v36, v170, v171
    v_mfma_f32_16x16x16_f16 v[118:121], v[164:165], v[218:219], v[118:121]
    v_exp_f32 v172, v172
    v_sub_f32 v173, v173, v186
    v_sub_f32 v238, v238, v186
    v_mfma_f32_16x16x32_f16 v[158:161], v[202:205], v[146:149], v[74:77]
    s_waitcnt lgkmcnt(1)
    v_exp_f32 v173, v173
    v_mfma_f32_16x16x32_f16 v[214:217], v[178:181], v[146:149], v[78:81]
    v_cvt_pk_bf16_f32 v37, v172, v173
    v_exp_f32 v238, v238
    v_mfma_f32_16x16x16_bf16 v[178:181], a[230:231], v[254:255], v[166:169]
    v_max3_f32 v223, v222, v118, v119
    v_max3_f32 v223, v223, v120, v121
    v_cvt_pk_bf16_f32 v39, v238, 0
    v_mfma_f32_16x16x16_f16 v[158:161], v[188:189], v[218:219], v[158:161]
    v_rcp_f32_dpp v127, v126 quad_perm:[0,0,0,0] row_mask:0xf bank_mask:0xf
    v_mfma_f32_16x16x16_f16 v[214:217], v[220:221], v[218:219], v[214:217]
    v_mul_f32 v114, v114, v127
    v_mfma_f32_16x16x32_bf16 v[150:153], v[28:31], v[36:39], 0
    s_waitcnt lgkmcnt(0)
    v_cvt_pk_bf16_f32 v178, v178, v179
    v_accvgpr_write_b32 a230, v178
    v_mfma_f32_16x16x32_bf16 v[150:153], v[28:31], v[138:141], v[150:153]
    v_cvt_pk_bf16_f32 v180, v180, v181
    v_accvgpr_write_b32 a231, v180
    v_mfma_f32_16x16x32_bf16 v[178:181], v[130:133], v[36:39], 0
    v_max3_f32 v223, v223, v158, v159
    v_max3_f32 v223, v223, v160, v161
    v_mfma_f32_16x16x32_bf16 v[178:181], v[154:157], v[138:141], v[178:181]
    v_max3_f32 v223, v223, v214, v215
    v_max3_f32 v223, v223, v216, v217
    v_mfma_f32_16x16x32_bf16 v[122:125], v[226:229], v[36:39], 0
    v_rcp_f32 v151, v150
    v_mfma_f32_16x16x32_bf16 v[122:125], v[182:185], v[138:141], v[122:125]
    v_mov_b32 v224, v223
    v_mul_f32_dpp v114, v198, v127 quad_perm:[0,1,2,3] row_mask:0x2 bank_mask:0xf
    v_mfma_f32_16x16x32_bf16 v[146:149], v[190:193], v[36:39], 0
    v_mul_f32 v178, v151, v178
    v_mul_f32 v179, v151, v179
    v_mfma_f32_16x16x32_bf16 v[146:149], v[134:137], v[138:141], v[146:149]
    v_cvt_pk_bf16_f32 v138, v178, v179
    v_mul_f32 v180, v151, v180
    v_mul_f32 v181, v151, v181
    v_mfma_f32_16x16x16_bf16 v[162:165], a[254:255], v[254:255], v[166:169]
    v_cvt_pk_bf16_f32 v139, v180, v181
    v_mul_f32 v122, v151, v122
    v_mul_f32 v123, v151, v123
    v_mfma_f32_16x16x16_bf16 v[178:181], v[104:105], v[254:255], v[166:169]
    v_cvt_pk_bf16_f32 v140, v122, v123
    v_mul_f32 v124, v151, v124
    v_mul_f32 v125, v151, v125
    v_mfma_f32_16x16x16_bf16 v[230:233], a[238:239], v[254:255], v[174:177]
    v_cvt_pk_bf16_f32 v141, v124, v125
    v_mul_f32 v146, v151, v146
    v_mul_f32 v147, v151, v147
    v_mfma_f32_16x16x16_bf16 v[122:125], v[88:89], v[254:255], v[174:177]
    v_cvt_pk_bf16_f32 v116, v146, v147
    v_mul_f32 v148, v151, v148
    v_mul_f32 v149, v151, v149
    v_mfma_f32_16x16x16_bf16 v[150:153], v[112:113], v[254:255], v[174:177]
    ds_write_b128 v3, v[138:141] offset:6144
    v_cvt_pk_bf16_f32 v117, v148, v149
    v_cvt_pk_bf16_f32 v162, v162, v163
    v_accvgpr_write_b32 a254, v162
    v_cvt_pk_bf16_f32 v164, v164, v165
    v_accvgpr_write_b32 a255, v164
    v_cvt_pk_bf16_f32 v104, v178, v179
    v_cvt_pk_bf16_f32 v105, v180, v181
    ds_write_b64 v4, v[116:117] offset:10240
    v_cvt_pk_bf16_f32 v230, v230, v231
    v_accvgpr_write_b32 a238, v230
    v_cvt_pk_bf16_f32 v232, v232, v233
    v_accvgpr_write_b32 a239, v232
    v_cvt_pk_bf16_f32 v88, v122, v123
    v_cvt_pk_bf16_f32 v89, v124, v125
    v_cvt_pk_bf16_f32 v112, v150, v151
    v_cvt_pk_bf16_f32 v113, v152, v153
    v_permlane32_swap_b32 v223, v224
    v_max_f32 v223, v223, v224
    v_mov_b32 v224, v223
    v_mul_f32_dpp v114, v142, v127 quad_perm:[0,1,2,3] row_mask:0x4 bank_mask:0xf
    v_cvt_pk_bf16_f32 v114, v114, v114
    ds_write_b16 v7, v114
    v_permlane16_swap_b32 v223, v224
    v_max_f32 v223, v223, v224
    v_sub_f32 v118, v118, v223
    v_exp_f32 v118, v118
    v_sub_f32 v119, v119, v223
    v_exp_f32 v119, v119
    v_sub_f32 v120, v120, v223
    v_cvt_pk_bf16_f32 v138, v118, v119
    v_exp_f32 v120, v120
    ds_read_b128 v[186:189], v0 offset:20480
    ds_read_b128 v[194:197], v1 offset:20480
    ds_read_b128 v[122:125], v0 offset:20608
    ds_read_b128 v[202:205], v1 offset:20608
    ds_read_b128 v[230:233], v0 offset:20736
    ds_read_b128 v[238:241], v1 offset:20736
    v_sub_f32 v121, v121, v223
    v_exp_f32 v121, v121
    v_sub_f32 v158, v158, v223
    v_cvt_pk_bf16_f32 v139, v120, v121
    v_exp_f32 v158, v158
    v_sub_f32 v159, v159, v223
    v_exp_f32 v159, v159
    v_sub_f32 v160, v160, v223
    v_cvt_pk_bf16_f32 v140, v158, v159
    v_exp_f32 v160, v160
    s_waitcnt lgkmcnt(5)
    v_mfma_f32_16x16x32_bf16 v[150:153], a[72:75], v[186:189], 0
    s_waitcnt lgkmcnt(3)
    v_sub_f32 v161, v161, v223
    v_sub_f32 v214, v214, v223
    v_mfma_f32_16x16x32_bf16 v[150:153], a[76:79], v[194:197], v[150:153]
    s_waitcnt lgkmcnt(2)
    v_exp_f32 v161, v161
    v_mfma_f32_16x16x32_bf16 v[150:153], a[80:83], v[122:125], v[150:153]
    s_waitcnt lgkmcnt(1)
    v_cvt_pk_bf16_f32 v141, v160, v161
    v_sub_f32 v215, v215, v223
    v_mfma_f32_16x16x32_bf16 v[150:153], a[84:87], v[202:205], v[150:153]
    s_waitcnt lgkmcnt(0)
    v_exp_f32 v214, v214
    v_mfma_f32_16x16x32_bf16 v[150:153], a[88:91], v[230:233], v[150:153]
    v_exp_f32 v215, v215
    v_mfma_f32_16x16x32_bf16 v[150:153], a[92:95], v[238:241], v[150:153]
    v_cvt_pk_bf16_f32 v36, v214, v215
    v_sub_f32 v216, v216, v223
    v_mfma_f32_16x16x32_bf16 v[162:165], a[96:99], v[186:189], 0
    v_exp_f32 v216, v216
    v_mfma_f32_16x16x32_bf16 v[162:165], a[100:103], v[194:197], v[162:165]
    v_sub_f32 v217, v217, v223
    v_sub_f32 v222, v222, v223
    v_mfma_f32_16x16x32_bf16 v[162:165], a[104:107], v[122:125], v[162:165]
    v_exp_f32 v217, v217
    v_mfma_f32_16x16x32_bf16 v[162:165], a[108:111], v[202:205], v[162:165]
    v_cvt_pk_bf16_f32 v37, v216, v217
    v_add_u32 v7, 16, v7
    v_mfma_f32_16x16x32_bf16 v[162:165], a[112:115], v[230:233], v[162:165]
    v_exp_f32 v222, v222
    v_mfma_f32_16x16x32_bf16 v[162:165], a[116:119], v[238:241], v[162:165]
    v_cvt_pk_bf16_f32 v39, v222, 0
    v_mfma_f32_16x16x32_bf16 v[170:173], a[120:123], v[186:189], 0
    v_mfma_f32_16x16x32_bf16 v[170:173], a[124:127], v[194:197], v[170:173]
    v_mfma_f32_16x16x32_bf16 v[126:129], v[28:31], v[36:39], 0
    v_mfma_f32_16x16x32_bf16 v[126:129], v[28:31], v[138:141], v[126:129]
    v_mfma_f32_16x16x32_bf16 v[142:145], v[130:133], v[36:39], 0
    v_mfma_f32_16x16x32_bf16 v[142:145], v[154:157], v[138:141], v[142:145]
    v_mfma_f32_16x16x32_bf16 v[130:133], v[226:229], v[36:39], 0
    v_mfma_f32_16x16x32_bf16 v[130:133], v[182:185], v[138:141], v[130:133]
    v_mfma_f32_16x16x32_bf16 v[182:185], v[190:193], v[36:39], 0
    v_mfma_f32_16x16x32_bf16 v[182:185], v[134:137], v[138:141], v[182:185]
    v_mfma_f32_16x16x32_bf16 v[170:173], a[128:131], v[122:125], v[170:173]
    v_mfma_f32_16x16x32_bf16 v[170:173], a[132:135], v[202:205], v[170:173]
    v_rcp_f32 v127, v126
    v_mfma_f32_16x16x32_bf16 v[170:173], a[136:139], v[230:233], v[170:173]
    v_mul_f32 v142, v127, v142
    v_mul_f32 v143, v127, v143
    v_mfma_f32_16x16x32_bf16 v[170:173], a[140:143], v[238:241], v[170:173]
    v_cvt_pk_bf16_f32 v142, v142, v143
    v_mul_f32 v144, v127, v144
    v_mfma_f32_16x16x32_bf16 v[138:141], a[0:3], v[186:189], 0
    v_mul_f32 v145, v127, v145
    v_cvt_pk_bf16_f32 v143, v144, v145
    v_mfma_f32_16x16x32_bf16 v[138:141], a[4:7], v[194:197], v[138:141]
    v_mul_f32 v130, v127, v130
    v_mul_f32 v131, v127, v131
    v_mfma_f32_16x16x32_bf16 v[138:141], a[8:11], v[122:125], v[138:141]
    v_cvt_pk_bf16_f32 v144, v130, v131
    v_mul_f32 v132, v127, v132
    v_mfma_f32_16x16x32_bf16 v[138:141], a[12:15], v[202:205], v[138:141]
    v_mul_f32 v133, v127, v133
    v_cvt_pk_bf16_f32 v145, v132, v133
    v_mfma_f32_16x16x32_bf16 v[138:141], a[16:19], v[230:233], v[138:141]
    ds_write_b128 v3, v[142:145] offset:12288
    v_mfma_f32_16x16x32_bf16 v[138:141], a[20:23], v[238:241], v[138:141]
    v_mul_f32 v182, v127, v182
    v_mul_f32 v183, v127, v183
    v_mfma_f32_16x16x32_bf16 v[166:169], a[24:27], v[186:189], 0
    v_cvt_pk_bf16_f32 v254, v182, v183
    v_mul_f32 v184, v127, v184
    v_mfma_f32_16x16x32_bf16 v[166:169], a[28:31], v[194:197], v[166:169]
    v_mul_f32 v185, v127, v185
    v_cvt_pk_bf16_f32 v255, v184, v185
    v_mfma_f32_16x16x32_bf16 v[166:169], a[32:35], v[122:125], v[166:169]
    ds_write_b64 v4, v[254:255] offset:16384
    v_mfma_f32_16x16x32_bf16 v[166:169], a[36:39], v[202:205], v[166:169]
    v_xor_b32 v3, 65536, v3
    v_xor_b32 v4, 65536, v4
    v_mfma_f32_16x16x32_bf16 v[166:169], a[40:43], v[230:233], v[166:169]
    v_mfma_f32_16x16x32_bf16 v[166:169], a[44:47], v[238:241], v[166:169]
    v_mfma_f32_16x16x32_bf16 v[134:137], a[48:51], v[186:189], 0
    v_mfma_f32_16x16x32_bf16 v[134:137], a[52:55], v[194:197], v[134:137]
    s_waitcnt lgkmcnt(0)
    s_barrier
    s_waitcnt lgkmcnt(0)
    s_cmp_eq_u32 s45, 0
    s_cbranch_scc1 L_drain
    s_nop 0
    s_lshr_b32 s3, s44, 8
    s_cbranch_scc1 L_safe
    v_cvt_pk_f16_f32 v146, v150, v151
    v_pk_mul_f16 v143, v146, v146
    v_cvt_pk_f16_f32 v147, v152, v153
    v_pk_fma_f16 v143, v147, v147, v143
    v_cvt_pk_f16_f32 v148, v162, v163
    v_pk_fma_f16 v143, v148, v148, v143
    v_cvt_pk_f16_f32 v149, v164, v165
    v_pk_fma_f16 v143, v149, v149, v143
    v_cvt_pk_f16_f32 v120, v170, v171
    v_pk_fma_f16 v143, v120, v120, v143
    v_cvt_pk_f16_f32 v121, v172, v173
    v_pk_fma_f16 v143, v121, v121, v143
    v_and_b32 v118, 16, v2
    v_sub_u32 v5, v5, v118
    v_mov_b32 v25, 0
    s_nop 7
    s_branch L_go
L_safe:
    v_fma_f32 v174, v150, v150, s32
    v_fmac_f32 v174, v151, v151
    v_fmac_f32 v174, v152, v152
    v_fmac_f32 v174, v153, v153
    s_nop 7
L_LOOP:
    v_mfma_f32_16x16x32_bf16 v[134:137], a[56:59], v[122:125], v[134:137]
    s_add_u32 s12, s40, s27
    ds_read_b128 v[118:121], v2 offset:18432
    ds_read_b128 v[142:145], v2 offset:19456
    v_mfma_f32_16x16x32_bf16 v[134:137], a[60:63], v[202:205], v[134:137]
    s_addc_u32 s13, s41, 0
    v_fmac_f32 v174, v162, v162
    v_fmac_f32 v174, v163, v163
    v_mfma_f32_16x16x32_bf16 v[134:137], a[64:67], v[230:233], v[134:137]
    s_sub_u32 s14, s36, s27
    v_fmac_f32 v174, v164, v164
    v_fmac_f32 v174, v165, v165
    v_mfma_f32_16x16x32_bf16 v[134:137], a[68:71], v[238:241], v[134:137]
    s_cmp_ge_u32 s18, 2
    v_fmac_f32 v174, v170, v170
    v_fmac_f32 v174, v171, v171
    v_mfma_f32_16x16x32_bf16 v[146:149], v[186:189], a[144:147], 0
    s_cselect_b32 s14, s14, 0
    v_fmac_f32 v174, v172, v172
    v_fmac_f32 v174, v173, v173
    v_mfma_f32_16x16x32_bf16 v[146:149], v[194:197], a[148:151], v[146:149]
    s_sub_u32 s82, s72, s71
    v_fma_f32 v254, v138, v138, s32
    v_fmac_f32 v254, v139, v139
    v_mfma_f32_16x16x32_bf16 v[146:149], v[122:125], a[152:155], v[146:149]
    s_mul_i32 s74, s82, 336
    v_fmac_f32 v254, v140, v140
    v_fmac_f32 v254, v141, v141
    v_mfma_f32_16x16x32_bf16 v[146:149], v[202:205], a[156:159], v[146:149]
    s_mul_i32 s75, s82, 272
    v_fmac_f32 v254, v166, v166
    v_fmac_f32 v254, v167, v167
    v_mfma_f32_16x16x32_bf16 v[146:149], v[230:233], a[160:163], v[146:149]
    s_waitcnt lgkmcnt(0)
    v_fmac_f32 v254, v168, v168
    v_fmac_f32 v254, v169, v169
    v_mfma_f32_16x16x32_bf16 v[182:185], v[32:35], v[118:121], 0
    s_mul_i32 s76, s82, 16
    v_fmac_f32 v254, v134, v134
    v_fmac_f32 v254, v135, v135
    v_mfma_f32_16x16x32_bf16 v[182:185], v[32:35], v[142:145], v[182:185]
    s_add_u32 s34, s18, 2
    v_fmac_f32 v254, v136, v136
    v_fmac_f32 v254, v137, v137
    v_mfma_f32_16x16x32_bf16 v[146:149], v[238:241], a[164:167], v[146:149]
    s_add_u32 s8, s60, s23
    ds_read_b128 v[190:193], v0 offset:26624
    v_cvt_pk_bf16_f32 v36, v254, v174
    v_mfma_f32_16x16x32_bf16 v[118:121], v[186:189], a[168:171], 0
    s_addc_u32 s9, s61, 0
    ds_read_b128 v[210:213], v1 offset:26624
    v_mul_f32 v254, 0x3baaaaab, v182
    v_mfma_f32_16x16x32_bf16 v[214:217], v[32:35], v[36:39], 0
    s_sub_u32 s10, s36, s23
    v_cvt_pk_bf16_f32 v142, v146, v147
    v_cvt_pk_bf16_f32 v143, v148, v149
    v_mfma_f32_16x16x32_bf16 v[118:121], v[194:197], a[172:175], v[118:121]
    s_cmp_le_u32 s34, s45
    ds_read_b128 v[218:221], v0 offset:26752
    v_mul_f32 v255, 0x3baaaaab, v183
    v_mfma_f32_16x16x32_bf16 v[118:121], v[122:125], a[176:179], v[118:121]
    s_cselect_b32 s10, s10, 0
    ds_read_b128 v[222:225], v1 offset:26752
    v_mul_f32 v144, 0x3baaaaab, v184
    v_mfma_f32_16x16x32_bf16 v[118:121], v[202:205], a[180:183], v[118:121]
    s_add_u32 m0, s28, 0
    v_rsq_f32 v215, v215
    v_mfma_f32_16x16x32_bf16 v[118:121], v[230:233], a[184:187], v[118:121]
    s_mov_b32 s27, s26
    v_rsq_f32 v214, v214
    v_mfma_f32_16x16x32_bf16 v[118:121], v[238:241], a[188:191], v[118:121]
    s_mov_b32 s26, s25
    v_mul_f32 v214, s31, v214
    v_mul_f32 v150, v215, v150
    v_mul_f32 v151, v215, v151
    v_cvt_pk_f16_f32 v174, v150, v151
    v_mfma_f32_16x16x32_bf16 v[182:185], v[186:189], a[192:195], 0
    s_waitcnt lgkmcnt(2)
    ds_read_b128 v[186:189], v0 offset:26880
    v_cvt_pk_bf16_f32 v146, v118, v119
    v_mfma_f32_16x16x32_bf16 v[182:185], v[194:197], a[196:199], v[182:185]
    s_mov_b32 s25, s24
    ds_read_b128 v[194:197], v1 offset:26880
    v_cvt_pk_bf16_f32 v147, v120, v121
    v_mfma_f32_16x16x32_bf16 v[182:185], v[122:125], a[200:203], v[182:185]
    s_mov_b32 s24, s23
    v_mul_f32 v152, v215, v152
    v_mul_f32 v153, v215, v153
    v_mfma_f32_16x16x32_bf16 v[182:185], v[202:205], a[204:207], v[182:185]
    s_ff1_i32_b32 s77, s100
    v_cvt_pk_f16_f32 v175, v152, v153
    v_mul_f32 v162, v215, v162
    v_mfma_f32_16x16x32_bf16 v[182:185], v[230:233], a[208:211], v[182:185]
    s_mul_i32 s78, s77, 2688
    v_mul_f32 v163, v215, v163
    v_cvt_pk_f16_f32 v176, v162, v163
    v_mfma_f32_16x16x32_bf16 v[182:185], v[238:241], a[212:215], v[182:185]
    s_mov_b32 s71, s72
    v_mul_f32 v164, v215, v164
    v_mul_f32 v165, v215, v165
    v_mfma_f32_16x16x32_bf16 v[122:125], a[72:75], v[190:193], 0
    s_mov_b32 s72, s73
    v_cvt_pk_f16_f32 v177, v164, v165
    v_mul_f32 v170, v215, v170
    v_mfma_f32_16x16x32_bf16 v[122:125], a[76:79], v[210:213], v[122:125]
    s_waitcnt lgkmcnt(2)
    v_cvt_pk_bf16_f32 v150, v182, v183
    v_cvt_pk_bf16_f32 v151, v184, v185
    v_mfma_f32_16x16x32_bf16 v[122:125], a[80:83], v[218:221], v[122:125]
    s_waitcnt lgkmcnt(1)
    v_mul_f32 v171, v215, v171
    v_cvt_pk_f16_f32 v120, v170, v171
    v_mfma_f32_16x16x32_bf16 v[122:125], a[84:87], v[222:225], v[122:125]
    s_waitcnt lgkmcnt(0)
    v_mul_f32 v172, v215, v172
    v_mul_f32 v173, v215, v173
    v_mfma_f32_16x16x32_bf16 v[122:125], a[88:91], v[186:189], v[122:125]
    v_cvt_pk_f16_f32 v121, v172, v173
    v_mul_f32 v138, v214, v138
    v_mfma_f32_16x16x32_bf16 v[122:125], a[92:95], v[194:197], v[122:125]
    v_mul_f32 v139, v214, v139
    v_cvt_pk_f16_f32 v202, v138, v139
    v_mfma_f32_16x16x32_bf16 v[162:165], a[96:99], v[190:193], 0
    v_mul_f32 v140, v214, v140
    v_mul_f32 v141, v214, v141
    v_mfma_f32_16x16x32_bf16 v[162:165], a[100:103], v[210:213], v[162:165]
    v_cvt_pk_f16_f32 v203, v140, v141
    v_mul_f32 v166, v214, v166
    v_mfma_f32_16x16x32_bf16 v[162:165], a[104:107], v[218:221], v[162:165]
    v_mul_f32 v167, v214, v167
    v_cvt_pk_f16_f32 v204, v166, v167
    v_mfma_f32_16x16x32_bf16 v[162:165], a[108:111], v[222:225], v[162:165]
    v_mul_f32 v168, v214, v168
    v_mul_f32 v169, v214, v169
    v_mfma_f32_16x16x32_bf16 v[162:165], a[112:115], v[186:189], v[162:165]
    v_cvt_pk_f16_f32 v205, v168, v169
    v_mul_f32 v134, v214, v134
    v_mfma_f32_16x16x32_bf16 v[162:165], a[116:119], v[194:197], v[162:165]
    v_mul_f32 v135, v214, v135
    v_cvt_pk_f16_f32 v118, v134, v135
    v_mfma_f32_16x16x32_bf16 v[166:169], a[120:123], v[190:193], 0
    v_mul_f32 v136, v214, v136
    v_mul_f32 v137, v214, v137
    v_mfma_f32_16x16x32_bf16 v[166:169], a[124:127], v[210:213], v[166:169]
    v_cvt_pk_f16_f32 v119, v136, v137
    v_fma_f32 v145, v122, v122, s32
    v_mfma_f32_16x16x32_bf16 v[166:169], a[128:131], v[218:221], v[166:169]
    v_rsq_f32 v254, v254
    v_mfma_f32_16x16x32_bf16 v[166:169], a[132:135], v[222:225], v[166:169]
    v_fmac_f32 v145, v123, v123
    v_fmac_f32 v145, v124, v124
    v_mfma_f32_16x16x32_bf16 v[166:169], a[136:139], v[186:189], v[166:169]
    v_fmac_f32 v145, v125, v125
    v_fmac_f32 v145, v162, v162
    v_mfma_f32_16x16x32_bf16 v[166:169], a[140:143], v[194:197], v[166:169]
    v_fmac_f32 v145, v163, v163
    v_fmac_f32 v145, v164, v164
    v_mfma_f32_16x16x32_bf16 v[134:137], a[0:3], v[190:193], 0
    v_fmac_f32 v145, v165, v165
    v_mul_f32 v178, v254, v178
    v_mfma_f32_16x16x32_bf16 v[134:137], a[4:7], v[210:213], v[134:137]
    v_rsq_f32 v255, v255
    v_mfma_f32_16x16x32_bf16 v[134:137], a[8:11], v[218:221], v[134:137]
    v_fmac_f32 v145, v166, v166
    v_fmac_f32 v145, v167, v167
    v_mfma_f32_16x16x32_bf16 v[134:137], a[12:15], v[222:225], v[134:137]
    v_fmac_f32 v145, v168, v168
    v_fmac_f32 v145, v169, v169
    v_mfma_f32_16x16x32_bf16 v[134:137], a[16:19], v[186:189], v[134:137]
    v_rsq_f32 v144, v144
    v_mfma_f32_16x16x32_bf16 v[134:137], a[20:23], v[194:197], v[134:137]
    v_mul_f32 v242, v144, v242
    v_mul_f32 v243, v144, v243
    v_mfma_f32_16x16x32_bf16 v[170:173], a[24:27], v[190:193], 0
    v_cvt_pk_bf16_f32 v138, v242, v243
    v_mul_f32 v244, v144, v244
    v_mfma_f32_16x16x32_bf16 v[170:173], a[28:31], v[210:213], v[170:173]
    v_mul_f32 v245, v144, v245
    v_cvt_pk_bf16_f32 v139, v244, v245
    v_mfma_f32_16x16x32_bf16 v[170:173], a[32:35], v[218:221], v[170:173]
    v_fma_f32 v148, v134, v134, s32
    v_fmac_f32 v148, v135, v135
    v_mfma_f32_16x16x32_bf16 v[170:173], a[36:39], v[222:225], v[170:173]
    v_fmac_f32 v148, v136, v136
    v_fmac_f32 v148, v137, v137
    v_mfma_f32_16x16x32_bf16 v[170:173], a[40:43], v[186:189], v[170:173]
    v_mul_f32 v158, v144, v158
    v_mul_f32 v159, v144, v159
    v_mfma_f32_16x16x32_bf16 v[170:173], a[44:47], v[194:197], v[170:173]
    v_cvt_pk_bf16_f32 v140, v158, v159
    v_mul_f32 v160, v144, v160
    v_mfma_f32_16x16x32_bf16 v[182:185], a[48:51], v[190:193], 0
    v_mul_f32 v161, v144, v161
    v_cvt_pk_bf16_f32 v141, v160, v161
    v_mfma_f32_16x16x32_bf16 v[182:185], a[52:55], v[210:213], v[182:185]
    buffer_store_dwordx4 v[138:141], v17, s[12:15], 0 offen nt
    v_mul_f32 v154, v144, v154
    v_fmac_f32 v148, v170, v170
    v_fmac_f32 v148, v171, v171
    v_fmac_f32 v148, v172, v172
    v_mfma_f32_16x16x32_bf16 v[182:185], a[56:59], v[218:221], v[182:185]
    v_fmac_f32 v148, v173, v173
    v_mul_f32 v155, v144, v155
    v_mfma_f32_16x16x32_bf16 v[182:185], a[60:63], v[222:225], v[182:185]
    v_cvt_pk_bf16_f32 v152, v154, v155
    v_mul_f32 v156, v144, v156
    v_mfma_f32_16x16x32_bf16 v[182:185], a[64:67], v[186:189], v[182:185]
    v_mul_f32 v157, v144, v157
    v_cvt_pk_bf16_f32 v153, v156, v157
    v_mfma_f32_16x16x32_bf16 v[182:185], a[68:71], v[194:197], v[182:185]
    v_mul_f32 v179, v254, v179
    v_cvt_pk_bf16_f32 v158, v178, v179
    v_mfma_f32_16x16x32_bf16 v[138:141], v[190:193], a[144:147], 0
    v_mul_f32 v180, v254, v180
    v_mul_f32 v181, v254, v181
    v_mfma_f32_16x16x32_bf16 v[138:141], v[210:213], a[148:151], v[138:141]
    v_cvt_pk_bf16_f32 v159, v180, v181
    v_mul_f32 v198, v254, v198
    v_mfma_f32_16x16x32_bf16 v[138:141], v[218:221], a[152:155], v[138:141]
    v_fmac_f32 v148, v182, v182
    v_fmac_f32 v148, v183, v183
    v_mfma_f32_16x16x32_bf16 v[138:141], v[222:225], a[156:159], v[138:141]
    v_fmac_f32 v148, v184, v184
    v_fmac_f32 v148, v185, v185
    v_mfma_f32_16x16x32_bf16 v[138:141], v[186:189], a[160:163], v[138:141]
    v_cvt_pk_bf16_f32 v36, v148, v145
    v_mul_f32 v199, v254, v199
    v_mfma_f32_16x16x32_bf16 v[138:141], v[194:197], a[164:167], v[138:141]
    ds_read_b128 v[214:217], v0 offset:32768
    v_cvt_pk_bf16_f32 v160, v198, v199
    v_mfma_f32_16x16x32_bf16 v[178:181], v[32:35], v[36:39], 0
    v_mul_f32 v200, v254, v200
    v_mul_f32 v201, v254, v201
    v_mfma_f32_16x16x32_bf16 v[154:157], v[190:193], a[168:171], 0
    ds_read_b128 v[226:229], v1 offset:32768
    v_cvt_pk_bf16_f32 v161, v200, v201
    v_mfma_f32_16x16x32_bf16 v[154:157], v[210:213], a[172:175], v[154:157]
    ds_read_b128 v[198:201], v0 offset:32896
    v_cvt_pk_bf16_f32 v144, v138, v139
    v_mfma_f32_16x16x32_bf16 v[154:157], v[218:221], a[176:179], v[154:157]
    v_cvt_pk_bf16_f32 v145, v140, v141
    v_mul_f32 v206, v254, v206
    v_mfma_f32_16x16x32_bf16 v[154:157], v[222:225], a[180:183], v[154:157]
    ds_read_b128 v[230:233], v1 offset:32896
    v_mul_f32 v207, v254, v207
    v_mfma_f32_16x16x32_bf16 v[154:157], v[186:189], a[184:187], v[154:157]
    v_rsq_f32 v179, v179
    v_mfma_f32_16x16x32_bf16 v[154:157], v[194:197], a[188:191], v[154:157]
    buffer_store_dwordx2 v[152:153], v20, s[12:15], 0 offen nt
    v_rsq_f32 v178, v178
    v_mul_f32 v122, v179, v122
    v_mul_f32 v178, s31, v178
    v_mul_f32 v123, v179, v123
    v_cvt_pk_f16_f32 v138, v122, v123
    v_mul_f32 v124, v179, v124
    v_mul_f32 v125, v179, v125
    v_cvt_pk_bf16_f32 v148, v154, v155
    v_mfma_f32_16x16x32_bf16 v[234:237], v[190:193], a[192:195], 0
    s_waitcnt lgkmcnt(2)
    ds_read_b128 v[190:193], v0 offset:33024
    v_cvt_pk_bf16_f32 v149, v156, v157
    v_mfma_f32_16x16x32_bf16 v[234:237], v[210:213], a[196:199], v[234:237]
    s_waitcnt lgkmcnt(2)
    ds_read_b128 v[210:213], v1 offset:33024
    v_cvt_pk_f16_f32 v139, v124, v125
    v_mfma_f32_16x16x32_bf16 v[234:237], v[218:221], a[200:203], v[234:237]
    v_mul_f32 v162, v179, v162
    v_mul_f32 v163, v179, v163
    v_mfma_f32_16x16x32_bf16 v[234:237], v[222:225], a[204:207], v[234:237]
    s_waitcnt vmcnt(2)
    v_cvt_pk_f16_f32 v140, v162, v163
    v_mul_f32 v164, v179, v164
    v_mfma_f32_16x16x32_bf16 v[234:237], v[186:189], a[208:211], v[234:237]
    s_waitcnt lgkmcnt(2)
    v_mul_f32 v165, v179, v165
    v_cvt_pk_f16_f32 v141, v164, v165
    v_mfma_f32_16x16x32_bf16 v[234:237], v[194:197], a[212:215], v[234:237]
    v_mul_f32 v166, v179, v166
    v_mul_f32 v167, v179, v167
    v_mfma_f32_16x16x32_bf16 v[186:189], a[72:75], v[214:217], 0
    v_cvt_pk_f16_f32 v124, v166, v167
    v_mul_f32 v168, v179, v168
    v_mfma_f32_16x16x32_bf16 v[186:189], a[76:79], v[226:229], v[186:189]
    v_mul_f32 v169, v179, v169
    v_cvt_pk_f16_f32 v125, v168, v169
    v_mfma_f32_16x16x32_bf16 v[186:189], a[80:83], v[198:201], v[186:189]
    s_waitcnt lgkmcnt(1)
    v_cvt_pk_bf16_f32 v152, v234, v235
    v_cvt_pk_bf16_f32 v153, v236, v237
    v_mfma_f32_16x16x32_bf16 v[186:189], a[84:87], v[230:233], v[186:189]
    s_waitcnt lgkmcnt(0)
    v_mul_f32 v134, v178, v134
    v_mul_f32 v135, v178, v135
    v_mfma_f32_16x16x32_bf16 v[186:189], a[88:91], v[190:193], v[186:189]
    s_barrier
    v_cvt_pk_f16_f32 v154, v134, v135
    v_mul_f32 v136, v178, v136
    v_mfma_f32_16x16x32_bf16 v[186:189], a[92:95], v[210:213], v[186:189]
    v_mul_f32 v137, v178, v137
    v_cvt_pk_f16_f32 v155, v136, v137
    v_mfma_f32_16x16x32_bf16 v[134:137], a[96:99], v[214:217], 0
    v_mul_f32 v170, v178, v170
    v_mul_f32 v171, v178, v171
    v_mfma_f32_16x16x32_bf16 v[134:137], a[100:103], v[226:229], v[134:137]
    v_cvt_pk_f16_f32 v156, v170, v171
    v_mul_f32 v172, v178, v172
    v_mfma_f32_16x16x32_bf16 v[134:137], a[104:107], v[198:201], v[134:137]
    buffer_load_dwordx4 v10, s[8:11], 0 offen nt lds
    v_mul_f32 v173, v178, v173
    v_mfma_f32_16x16x32_bf16 v[134:137], a[108:111], v[230:233], v[134:137]
    s_add_u32 m0, s28, 4096
    v_cvt_pk_f16_f32 v157, v172, v173
    v_mul_f32 v182, v178, v182
    v_mfma_f32_16x16x32_bf16 v[134:137], a[112:115], v[190:193], v[134:137]
    v_mul_f32 v183, v178, v183
    v_cvt_pk_f16_f32 v122, v182, v183
    v_mfma_f32_16x16x32_bf16 v[134:137], a[116:119], v[210:213], v[134:137]
    v_mul_f32 v184, v178, v184
    v_mul_f32 v185, v178, v185
    v_mfma_f32_16x16x32_bf16 v[218:221], a[120:123], v[214:217], 0
    v_cvt_pk_f16_f32 v123, v184, v185
    v_cvt_pk_bf16_f32 v170, v206, v207
    v_mfma_f32_16x16x32_bf16 v[218:221], a[124:127], v[226:229], v[218:221]
    buffer_load_dwordx4 v11, s[8:11], 0 offen nt lds
    v_mul_f32 v208, v254, v208
    v_mfma_f32_16x16x32_bf16 v[218:221], a[128:131], v[198:201], v[218:221]
    s_add_u32 m0, s28, 8192
    v_mul_f32 v209, v254, v209
    v_cvt_pk_bf16_f32 v171, v208, v209
    v_mfma_f32_16x16x32_bf16 v[218:221], a[132:135], v[230:233], v[218:221]
    v_fma_f32 v162, v186, v186, s32
    v_fmac_f32 v162, v187, v187
    v_mfma_f32_16x16x32_bf16 v[218:221], a[136:139], v[190:193], v[218:221]
    v_fmac_f32 v162, v188, v188
    v_fmac_f32 v162, v189, v189
    v_mfma_f32_16x16x32_bf16 v[218:221], a[140:143], v[210:213], v[218:221]
    v_fmac_f32 v162, v134, v134
    v_fmac_f32 v162, v135, v135
    v_mfma_f32_16x16x32_bf16 v[222:225], a[0:3], v[214:217], 0
    buffer_load_dwordx4 v12, s[8:11], 0 offen nt lds
    v_fmac_f32 v162, v136, v136
    v_mfma_f32_16x16x32_bf16 v[222:225], a[4:7], v[226:229], v[222:225]
    s_add_u32 m0, s28, 12288
    v_fmac_f32 v162, v137, v137
    v_fmac_f32 v162, v218, v218
    v_mfma_f32_16x16x32_bf16 v[222:225], a[8:11], v[198:201], v[222:225]
    s_xor_b32 s28, s28, 65536
    v_fmac_f32 v162, v219, v219
    v_fmac_f32 v162, v220, v220
    v_mfma_f32_16x16x32_bf16 v[222:225], a[12:15], v[230:233], v[222:225]
    v_fmac_f32 v162, v221, v221
    v_mul_f32 v130, v255, v130
    v_mfma_f32_16x16x32_bf16 v[222:225], a[16:19], v[190:193], v[222:225]
    v_mul_f32 v131, v255, v131
    v_cvt_pk_bf16_f32 v130, v130, v131
    v_mfma_f32_16x16x32_bf16 v[222:225], a[20:23], v[210:213], v[222:225]
    buffer_load_dwordx4 v13, s[8:11], 0 offen nt lds
    v_mul_f32 v132, v255, v132
    v_mfma_f32_16x16x32_bf16 v[238:241], a[24:27], v[214:217], 0
    s_mov_b32 m0, s29
    v_mul_f32 v133, v255, v133
    v_cvt_pk_bf16_f32 v131, v132, v133
    v_mfma_f32_16x16x32_bf16 v[238:241], a[28:31], v[226:229], v[238:241]
    s_xor_b32 s29, s29, s30
    v_fma_f32 v163, v222, v222, s32
    v_fmac_f32 v163, v223, v223
    v_mfma_f32_16x16x32_bf16 v[238:241], a[32:35], v[198:201], v[238:241]
    s_add_u32 s19, s19, s20
    v_fmac_f32 v163, v224, v224
    v_fmac_f32 v163, v225, v225
    v_mfma_f32_16x16x32_bf16 v[238:241], a[36:39], v[230:233], v[238:241]
    s_add_u32 s23, s23, s21
    v_mul_f32 v126, v255, v126
    v_mul_f32 v127, v255, v127
    v_mfma_f32_16x16x32_bf16 v[238:241], a[40:43], v[190:193], v[238:241]
    buffer_load_dwordx4 v14, s[8:11], 0 offen nt lds
    v_cvt_pk_bf16_f32 v132, v126, v127
    v_mfma_f32_16x16x32_bf16 v[238:241], a[44:47], v[210:213], v[238:241]
    s_cmp_ge_u32 s19, 72
    v_mul_f32 v128, v255, v128
    v_mul_f32 v129, v255, v129
    v_mfma_f32_16x16x32_bf16 v[178:181], a[48:51], v[214:217], 0
    s_cselect_b32 s34, 72, 0
    v_cvt_pk_bf16_f32 v133, v128, v129
    v_mul_f32 v114, v255, v114
    v_mfma_f32_16x16x32_bf16 v[178:181], a[52:55], v[226:229], v[178:181]
    s_cselect_b32 s35, s22, 0
    v_fmac_f32 v163, v238, v238
    v_fmac_f32 v163, v239, v239
    v_mfma_f32_16x16x32_bf16 v[178:181], a[56:59], v[198:201], v[178:181]
    s_sub_u32 s19, s19, s34
    v_fmac_f32 v163, v240, v240
    v_fmac_f32 v163, v241, v241
    v_mfma_f32_16x16x32_bf16 v[178:181], a[60:63], v[230:233], v[178:181]
    buffer_store_dwordx4 v[158:161], v15, s[12:15], 0 offen nt
    v_mul_f32 v115, v255, v115
    v_cvt_pk_bf16_f32 v254, v114, v115
    v_mul_f32 v116, v255, v116
    v_mul_f32 v117, v255, v117
    v_mfma_f32_16x16x32_bf16 v[178:181], a[64:67], v[190:193], v[178:181]
    s_add_u32 s23, s23, s35
    v_cvt_pk_bf16_f32 v255, v116, v117
    v_xor_b32 v0, 65536, v0
    v_mfma_f32_16x16x32_bf16 v[178:181], a[68:71], v[210:213], v[178:181]
    s_add_u32 s78, s78, s69
    v_xor_b32 v1, 65536, v1
    s_add_u32 s80, s77, s68
    v_mfma_f32_16x16x32_bf16 v[114:117], v[214:217], a[144:147], 0
    s_cmp_ge_u32 s80, 72
    s_cselect_b32 s80, s22, 0
    s_add_u32 s78, s78, s80
    v_mfma_f32_16x16x32_bf16 v[114:117], v[226:229], a[148:151], v[114:117]
    s_add_u32 s80, s77, 20
    v_fmac_f32 v163, v178, v178
    v_fmac_f32 v163, v179, v179
    v_mfma_f32_16x16x32_bf16 v[114:117], v[198:201], a[152:155], v[114:117]
    s_add_u32 s34, s18, 3
    v_fmac_f32 v163, v180, v180
    v_fmac_f32 v163, v181, v181
    v_mfma_f32_16x16x32_bf16 v[114:117], v[230:233], a[156:159], v[114:117]
    s_cmp_lt_u32 s77, s62
    ds_read2_b32 v[164:165], v6 offset0:0 offset1:0
    ds_read2_b32 v[168:169], v6 offset0:16 offset1:16
    v_mfma_f32_16x16x32_bf16 v[114:117], v[190:193], a[160:163], v[114:117]
    s_cselect_b32 s79, 1, 0
    ds_read2_b32 v[172:173], v6 offset0:32 offset1:32
    v_cvt_pk_bf16_f32 v36, v163, v162
    v_mfma_f32_16x16x32_bf16 v[114:117], v[210:213], a[164:167], v[114:117]
    s_cselect_b32 s78, s78, 0
    s_cmp_lt_u32 s34, s17
    s_cselect_b32 s23, s23, s78
    v_mfma_f32_16x16x32_bf16 v[234:237], v[32:35], v[36:39], 0
    s_cselect_b32 s73, s34, s80
    s_cselect_b32 s79, 0, s79
    s_cselect_b32 s81, 0, 1
    v_mfma_f32_16x16x32_bf16 v[126:129], v[214:217], a[168:171], 0
    s_sub_u32 s80, s100, s81
    v_cvt_pk_bf16_f32 v162, v114, v115
    v_cvt_pk_bf16_f32 v163, v116, v117
    v_mfma_f32_16x16x32_bf16 v[126:129], v[226:229], a[172:175], v[126:129]
    s_and_b32 s100, s100, s80
    v_rsq_f32 v235, v235
    v_mfma_f32_16x16x32_bf16 v[126:129], v[198:201], a[176:179], v[126:129]
    s_lshl_b32 s80, s79, s73
    v_rsq_f32 v234, v234
    v_mfma_f32_16x16x32_bf16 v[126:129], v[230:233], a[180:183], v[126:129]
    s_or_b32 s70, s70, s80
    v_mul_f32 v234, s31, v234
    v_mul_f32 v186, v235, v186
    v_mfma_f32_16x16x32_bf16 v[126:129], v[190:193], a[184:187], v[126:129]
    s_add_u32 s45, s45, s79
    v_mul_f32 v187, v235, v187
    v_cvt_pk_f16_f32 v114, v186, v187
    v_mfma_f32_16x16x32_bf16 v[126:129], v[210:213], a[188:191], v[126:129]
    s_add_u32 s18, s18, 1
    v_mul_f32 v188, v235, v188
    v_mul_f32 v189, v235, v189
    v_mfma_f32_16x16x32_bf16 v[158:161], v[214:217], a[192:195], 0
    s_cmp_lt_u32 s18, s45
    v_cvt_pk_f16_f32 v115, v188, v189
    v_mul_f32 v134, v235, v134
    v_mfma_f32_16x16x32_bf16 v[158:161], v[226:229], a[196:199], v[158:161]
    s_waitcnt lgkmcnt(0)
    buffer_store_dwordx2 v[170:171], v18, s[12:15], 0 offen nt
    v_cvt_pk_bf16_f32 v166, v126, v127
    v_cvt_pk_bf16_f32 v167, v128, v129
    v_mfma_f32_16x16x32_bf16 v[158:161], v[198:201], a[200:203], v[158:161]
    ds_read_b128 v[226:229], v5 offset:0
    ds_read_b128 v[206:209], v5 offset:16
    v_mfma_f32_16x16x32_bf16 v[158:161], v[230:233], a[204:207], v[158:161]
    ds_read_b128 v[198:201], v5 offset:48
    ds_read_b32 v236, v6 offset:192
    v_mfma_f32_16x16x32_bf16 v[158:161], v[190:193], a[208:211], v[158:161]
    v_mul_f32 v135, v235, v135
    v_cvt_pk_f16_f32 v116, v134, v135
    v_mfma_f32_16x16x32_f16 v[186:189], v[174:177], v[202:205], v[46:49]
    v_mul_f32 v136, v235, v136
    v_mul_f32 v137, v235, v137
    v_mfma_f32_16x16x32_f16 v[182:185], v[138:141], v[202:205], v[50:53]
    v_cvt_pk_f16_f32 v117, v136, v137
    v_mul_f32 v218, v235, v218
    v_mfma_f32_16x16x32_bf16 v[158:161], v[210:213], a[212:215], v[158:161]
    ds_read_b128 v[194:197], v2 offset:0
    ds_read_b128 v[190:193], v2 offset:1024
    v_mfma_f32_16x16x32_f16 v[126:129], v[114:117], v[202:205], v[54:57]
    v_mul_f32 v219, v235, v219
    v_cvt_pk_f16_f32 v136, v218, v219
    v_mul_f32 v220, v235, v220
    v_mfma_f32_16x16x16_f16 v[186:189], v[120:121], v[118:119], v[186:189]
    v_mul_f32 v221, v235, v221
    v_cvt_pk_bf16_f32 v170, v158, v159
    v_cvt_pk_bf16_f32 v171, v160, v161
    v_mfma_f32_16x16x16_f16 v[182:185], v[124:125], v[118:119], v[182:185]
    v_cvt_pk_f16_f32 v137, v220, v221
    v_mul_f32 v222, v234, v222
    v_mul_f32 v223, v234, v223
    v_mfma_f32_16x16x16_f16 v[126:129], v[136:137], v[118:119], v[126:129]
    v_cvt_pk_f16_f32 v158, v222, v223
    v_mul_f32 v224, v234, v224
    v_mul_f32 v225, v234, v225
    s_waitcnt lgkmcnt(2)
    v_mfma_f32_16x16x32_f16 v[230:233], v[226:229], v[202:205], v[22:25]
    ds_read_b128 v[210:213], v2 offset:2048
    ds_read_b128 v[202:205], v2 offset:3072
    v_mfma_f32_16x16x32_f16 v[230:233], v[206:209], v[174:177], v[230:233]
    v_cvt_pk_f16_f32 v159, v224, v225
    v_mul_f32 v238, v234, v238
    v_mfma_f32_16x16x32_f16 v[230:233], v[198:201], v[118:121], v[230:233]
    s_waitcnt lgkmcnt(2)
    ds_read_b128 v[214:217], v2 offset:4096
    v_mul_f32 v239, v234, v239
    v_cvt_pk_f16_f32 v160, v238, v239
    v_mul_f32 v240, v234, v240
    v_mul_f32 v241, v234, v241
    v_cvt_pk_f16_f32 v161, v240, v241
    v_mfma_f32_16x16x32_f16 v[218:221], v[226:229], v[154:157], v[24:27]
    v_mul_f32 v178, v234, v178
    v_mul_f32 v179, v234, v179
    v_mfma_f32_16x16x32_f16 v[218:221], v[206:209], v[138:141], v[218:221]
    v_cvt_pk_f16_f32 v134, v178, v179
    v_mul_f32 v180, v234, v180
    v_mfma_f32_16x16x32_f16 v[218:221], v[198:201], v[122:125], v[218:221]
    buffer_store_dwordx4 v[130:133], v16, s[12:15], 0 offen nt
    ds_read_b128 v[222:225], v2 offset:5120
    v_mul_f32 v181, v234, v181
    v_cvt_pk_f16_f32 v135, v180, v181
    v_mov_b32_dpp v236, v231 quad_perm:[0,1,2,3] row_mask:0x1 bank_mask:0xf
    v_mfma_f32_16x16x32_f16 v[238:241], v[226:229], v[158:161], v[26:29]
    s_waitcnt lgkmcnt(2)
    v_max3_f32 v118, v230, v186, v187
    v_mov_b32_dpp v236, v219 quad_perm:[0,1,2,3] row_mask:0x2 bank_mask:0xf
    v_mfma_f32_16x16x32_f16 v[238:241], v[206:209], v[114:117], v[238:241]
    v_max3_f32 v118, v118, v188, v189
    v_max3_f32 v118, v118, v182, v183
    v_mfma_f32_16x16x32_f16 v[238:241], v[198:201], v[134:137], v[238:241]
    s_waitcnt lgkmcnt(1)
    v_max3_f32 v118, v118, v184, v185
    v_max3_f32 v118, v118, v126, v127
    v_mfma_f32_16x16x32_bf16 v[178:181], a[216:219], v[194:197], 0
    v_max3_f32 v118, v118, v128, v129
    v_mov_b32 v119, v118
    v_mfma_f32_16x16x32_bf16 v[178:181], a[220:223], v[190:193], v[178:181]
    v_add_u32 v5, s74, v5
    v_mov_b32_dpp v236, v239 quad_perm:[0,1,2,3] row_mask:0x4 bank_mask:0xf
    v_mfma_f32_16x16x32_bf16 v[178:181], a[224:227], v[210:213], v[178:181]
    v_permlane32_swap_b32 v118, v119
    v_mfma_f32_16x16x32_bf16 v[178:181], a[228:231], v[202:205], v[178:181]
    s_waitcnt lgkmcnt(0)
    v_max_f32 v118, v118, v119
    v_mov_b32 v119, v118
    v_mfma_f32_16x16x32_bf16 v[178:181], a[232:235], v[214:217], v[178:181]
    v_mov_b32 v219, v236
    v_add_u32 v6, s75, v6
    v_mfma_f32_16x16x32_bf16 v[178:181], a[236:239], v[222:225], v[178:181]
    v_permlane16_swap_b32 v118, v119
    v_mfma_f32_16x16x32_bf16 v[198:201], a[240:243], v[194:197], 0
    v_max_f32 v118, v118, v119
    v_sub_f32 v186, v186, v118
    v_mfma_f32_16x16x32_bf16 v[198:201], a[244:247], v[190:193], v[198:201]
    v_exp_f32 v186, v186
    v_mfma_f32_16x16x32_bf16 v[198:201], a[248:251], v[210:213], v[198:201]
    v_sub_f32 v187, v187, v118
    v_sub_f32 v188, v188, v118
    v_mfma_f32_16x16x32_bf16 v[198:201], a[252:255], v[202:205], v[198:201]
    v_exp_f32 v187, v187
    v_mfma_f32_16x16x32_bf16 v[198:201], v[82:85], v[214:217], v[198:201]
    v_cvt_pk_bf16_f32 v186, v186, v187
    v_sub_f32 v189, v189, v118
    v_mfma_f32_16x16x32_bf16 v[198:201], v[86:89], v[222:225], v[198:201]
    v_exp_f32 v188, v188
    v_mfma_f32_16x16x32_bf16 v[206:209], v[90:93], v[194:197], 0
    ds_read_b128 v[194:197], v2 offset:6144
    buffer_store_dwordx2 v[254:255], v19, s[12:15], 0 offen nt
    v_exp_f32 v189, v189
    v_mfma_f32_16x16x32_bf16 v[206:209], v[94:97], v[190:193], v[206:209]
    ds_read_b128 v[190:193], v2 offset:7168
    v_cvt_pk_bf16_f32 v187, v188, v189
    v_mfma_f32_16x16x32_bf16 v[206:209], v[98:101], v[210:213], v[206:209]
    ds_read_b128 v[210:213], v2 offset:8192
    v_sub_f32 v182, v182, v118
    v_mfma_f32_16x16x32_bf16 v[206:209], v[102:105], v[202:205], v[206:209]
    ds_read_b128 v[202:205], v2 offset:9216
    v_sub_f32 v183, v183, v118
    v_mfma_f32_16x16x32_bf16 v[206:209], v[106:109], v[214:217], v[206:209]
    ds_read_b128 v[214:217], v2 offset:10240
    v_sub_f32 v184, v184, v118
    v_mfma_f32_16x16x32_bf16 v[206:209], v[110:113], v[222:225], v[206:209]
    ds_read_b128 v[222:225], v2 offset:11264
    v_exp_f32 v182, v182
    v_mfma_f32_16x16x32_f16 v[226:229], v[174:177], v[154:157], v[58:61]
    v_exp_f32 v183, v183
    s_waitcnt lgkmcnt(5)
    v_mfma_f32_16x16x32_bf16 v[130:133], a[216:219], v[194:197], 0
    v_cvt_pk_bf16_f32 v188, v182, v183
    v_exp_f32 v184, v184
    s_waitcnt lgkmcnt(4)
    v_mfma_f32_16x16x16_f16 v[226:229], v[120:121], v[122:123], v[226:229]
    v_sub_f32 v185, v185, v118
    v_exp_f32 v185, v185
    v_sub_f32 v126, v126, v118
    v_mfma_f32_16x16x32_bf16 v[130:133], a[220:223], v[190:193], v[130:133]
    s_waitcnt lgkmcnt(2)
    v_cvt_pk_bf16_f32 v189, v184, v185
    v_sub_f32 v127, v127, v118
    v_mfma_f32_16x16x32_bf16 v[130:133], a[224:227], v[210:213], v[130:133]
    s_waitcnt lgkmcnt(1)
    v_exp_f32 v126, v126
    v_mfma_f32_16x16x32_bf16 v[130:133], a[228:231], v[202:205], v[130:133]
    s_waitcnt lgkmcnt(0)
    v_exp_f32 v127, v127
    v_mfma_f32_16x16x32_bf16 v[130:133], a[232:235], v[214:217], v[130:133]
    v_cvt_pk_bf16_f32 v36, v126, v127
    v_sub_f32 v128, v128, v118
    v_mfma_f32_16x16x32_f16 v[182:185], v[138:141], v[154:157], v[62:65]
    v_exp_f32 v128, v128
    v_mfma_f32_16x16x32_bf16 v[130:133], a[236:239], v[222:225], v[130:133]
    v_sub_f32 v129, v129, v118
    v_exp_f32 v129, v129
    v_sub_f32 v230, v230, v118
    v_cvt_pk_bf16_f32 v37, v128, v129
    v_mfma_f32_16x16x16_f16 v[182:185], v[124:125], v[122:123], v[182:185]
    v_exp_f32 v230, v230
    v_max_f32_dpp v219, v219, v219 quad_perm:[1,0,3,2] row_mask:0xf bank_mask:0xf
    v_cvt_pk_bf16_f32 v39, v230, 0
    v_mfma_f32_16x16x32_f16 v[230:233], v[114:117], v[154:157], v[66:69]
    v_max_f32_dpp v219, v219, v219 quad_perm:[2,3,0,1] row_mask:0xf bank_mask:0xf
    v_max3_f32 v254, v218, v226, v227
    v_max3_f32 v254, v254, v228, v229
    v_max_f32_dpp v219, v219, v219 row_half_mirror row_mask:0xf bank_mask:0xf
    v_max3_f32 v254, v254, v182, v183
    v_max3_f32 v254, v254, v184, v185
    v_mfma_f32_16x16x16_f16 v[230:233], v[136:137], v[122:123], v[230:233]
    v_max_f32_dpp v219, v219, v219 row_mirror row_mask:0xf bank_mask:0xf
    v_mov_b32 v255, v219
    v_fma_f32 v118, v178, v178, s33
    v_fmac_f32 v118, v179, v179
    v_permlane32_swap_b32 v219, v255
    v_max_f32 v219, v219, v255
    v_mfma_f32_16x16x32_bf16 v[154:157], v[28:31], v[36:39], 0
    v_mov_b32 v255, v219
    v_max3_f32 v254, v254, v230, v231
    v_mfma_f32_16x16x32_bf16 v[154:157], v[28:31], v[186:189], v[154:157]
    v_permlane16_swap_b32 v219, v255
    v_max_f32 v219, v219, v255
    v_sub_f32 v236, v236, v219
    v_mfma_f32_16x16x32_bf16 v[126:129], v[162:165], v[36:39], 0
    v_exp_f32 v236, v236
    v_mfma_f32_16x16x32_bf16 v[126:129], v[142:145], v[186:189], v[126:129]
    v_cvt_pk_bf16_f32 v236, v236, v236
    v_max3_f32 v254, v254, v232, v233
    v_rcp_f32 v155, v154
    v_mov_b32 v119, v254
    v_fmac_f32 v118, v180, v180
    v_fmac_f32 v118, v181, v181
    v_permlane32_swap_b32 v254, v119
    v_max_f32 v254, v254, v119
    v_mul_f32 v126, v155, v126
    v_mul_f32 v127, v155, v127
    v_cvt_pk_bf16_f32 v126, v126, v127
    v_mul_f32 v128, v155, v128
    v_mul_f32 v129, v155, v129
    v_cvt_pk_bf16_f32 v127, v128, v129
    v_mov_b32 v119, v254
    v_fmac_f32 v118, v198, v198
    v_fmac_f32 v118, v199, v199
    v_permlane16_swap_b32 v254, v119
    v_max_f32 v254, v254, v119
    v_sub_f32 v226, v226, v254
    v_exp_f32 v226, v226
    v_sub_f32 v227, v227, v254
    v_exp_f32 v227, v227
    v_sub_f32 v228, v228, v254
    v_cvt_pk_bf16_f32 v226, v226, v227
    v_exp_f32 v228, v228
    v_sub_f32 v229, v229, v254
    v_exp_f32 v229, v229
    v_sub_f32 v182, v182, v254
    v_cvt_pk_bf16_f32 v227, v228, v229
    v_mfma_f32_16x16x32_bf16 v[242:245], v[166:169], v[36:39], 0
    ds_write_b16 v8, v236
    v_mfma_f32_16x16x32_bf16 v[242:245], v[146:149], v[186:189], v[242:245]
    v_exp_f32 v182, v182
    v_sub_f32 v183, v183, v254
    v_exp_f32 v183, v183
    v_sub_f32 v184, v184, v254
    v_cvt_pk_bf16_f32 v228, v182, v183
    v_exp_f32 v184, v184
    v_sub_f32 v185, v185, v254
    v_exp_f32 v185, v185
    v_mul_f32 v242, v155, v242
    v_mul_f32 v243, v155, v243
    v_cvt_pk_bf16_f32 v128, v242, v243
    v_mul_f32 v244, v155, v244
    v_mul_f32 v245, v155, v245
    v_cvt_pk_bf16_f32 v129, v244, v245
    v_mfma_f32_16x16x32_bf16 v[234:237], v[170:173], v[36:39], 0
    ds_write_b128 v3, v[126:129] offset:0
    v_mfma_f32_16x16x32_bf16 v[234:237], v[150:153], v[186:189], v[234:237]
    v_cvt_pk_bf16_f32 v229, v184, v185
    v_sub_f32 v230, v230, v254
    v_mfma_f32_16x16x32_f16 v[182:185], v[174:177], v[158:161], v[70:73]
    v_exp_f32 v230, v230
    v_mfma_f32_16x16x32_bf16 v[126:129], a[240:243], v[194:197], 0
    ds_read_b128 v[174:177], v9
    v_sub_f32 v231, v231, v254
    v_mfma_f32_16x16x32_bf16 v[126:129], a[244:247], v[190:193], v[126:129]
    v_mul_f32 v234, v155, v234
    v_mul_f32 v235, v155, v235
    v_cvt_pk_bf16_f32 v122, v234, v235
    v_mfma_f32_16x16x16_f16 v[182:185], v[120:121], v[134:135], v[182:185]
    v_mul_f32 v236, v155, v236
    v_mul_f32 v237, v155, v237
    v_cvt_pk_bf16_f32 v123, v236, v237
    v_sub_f32 v232, v232, v254
    v_mfma_f32_16x16x32_bf16 v[126:129], a[248:251], v[210:213], v[126:129]
    ds_read_b128 v[154:157], v9 offset:64
    v_sub_f32 v233, v233, v254
    v_mfma_f32_16x16x32_bf16 v[126:129], a[252:255], v[202:205], v[126:129]
    ds_write_b64 v4, v[122:123] offset:4096
    v_mfma_f32_16x16x32_bf16 v[126:129], v[82:85], v[214:217], v[126:129]
    v_max3_f32 v255, v238, v182, v183
    v_max3_f32 v255, v255, v184, v185
    v_mfma_f32_16x16x32_bf16 v[126:129], v[86:89], v[222:225], v[126:129]
    v_exp_f32 v231, v231
    v_exp_f32 v232, v232
    v_cvt_pk_bf16_f32 v36, v230, v231
    v_mfma_f32_16x16x32_f16 v[186:189], v[138:141], v[158:161], v[74:77]
    s_waitcnt lgkmcnt(2)
    v_exp_f32 v233, v233
    v_mfma_f32_16x16x32_f16 v[138:141], v[114:117], v[158:161], v[78:81]
    v_cvt_pk_bf16_f32 v37, v232, v233
    v_sub_f32 v218, v218, v254
    v_mfma_f32_16x16x32_bf16 v[234:237], v[174:177], v[28:31], 0
    v_exp_f32 v218, v218
    v_fmac_f32 v118, v200, v200
    v_mfma_f32_16x16x16_f16 v[186:189], v[124:125], v[134:135], v[186:189]
    v_cvt_pk_bf16_f32 v39, v218, 0
    v_fmac_f32 v118, v201, v201
    v_fmac_f32 v118, v206, v206
    v_mfma_f32_16x16x16_f16 v[138:141], v[136:137], v[134:135], v[138:141]
    v_fmac_f32 v118, v207, v207
    v_fmac_f32 v118, v208, v208
    v_fmac_f32 v118, v209, v209
    v_fma_f32 v254, v130, v130, s33
    v_mfma_f32_16x16x32_bf16 v[122:125], v[28:31], v[36:39], 0
    s_waitcnt lgkmcnt(0)
    v_max3_f32 v255, v255, v186, v187
    v_max3_f32 v255, v255, v188, v189
    v_mfma_f32_16x16x32_bf16 v[122:125], v[28:31], v[226:229], v[122:125]
    v_max3_f32 v255, v255, v138, v139
    v_max3_f32 v255, v255, v140, v141
    v_mfma_f32_16x16x32_bf16 v[114:117], v[162:165], v[36:39], 0
    v_mov_b32 v119, v255
    v_fmac_f32 v254, v131, v131
    v_mfma_f32_16x16x32_bf16 v[114:117], v[142:145], v[226:229], v[114:117]
    v_permlane32_swap_b32 v255, v119
    v_mfma_f32_16x16x32_bf16 v[134:137], v[166:169], v[36:39], 0
    v_rcp_f32 v123, v122
    v_mfma_f32_16x16x32_bf16 v[134:137], v[146:149], v[226:229], v[134:137]
    v_max_f32 v255, v255, v119
    v_mov_b32 v119, v255
    v_mfma_f32_16x16x32_bf16 v[158:161], v[170:173], v[36:39], 0
    v_fmac_f32 v254, v132, v132
    v_mul_f32 v114, v123, v114
    v_mfma_f32_16x16x32_bf16 v[158:161], v[150:153], v[226:229], v[158:161]
    v_mul_f32 v115, v123, v115
    v_cvt_pk_bf16_f32 v114, v114, v115
    v_mfma_f32_16x16x32_bf16 v[234:237], v[154:157], v[28:31], v[234:237]
    v_mul_f32 v116, v123, v116
    v_mul_f32 v117, v123, v117
    v_mfma_f32_16x16x32_bf16 v[218:221], v[174:177], v[142:145], 0
    v_cvt_pk_bf16_f32 v115, v116, v117
    v_mul_f32 v134, v123, v134
    v_mfma_f32_16x16x32_bf16 v[218:221], v[154:157], v[162:165], v[218:221]
    v_mul_f32 v135, v123, v135
    v_cvt_pk_bf16_f32 v116, v134, v135
    v_mfma_f32_16x16x32_bf16 v[226:229], v[174:177], v[146:149], 0
    v_mul_f32 v136, v123, v136
    v_mul_f32 v137, v123, v137
    v_mfma_f32_16x16x32_bf16 v[226:229], v[154:157], v[166:169], v[226:229]
    v_cvt_pk_bf16_f32 v117, v136, v137
    v_mul_f32 v158, v123, v158
    v_mfma_f32_16x16x32_bf16 v[134:137], v[174:177], v[150:153], 0
    ds_write_b128 v3, v[114:117] offset:6144
    v_mfma_f32_16x16x32_bf16 v[134:137], v[154:157], v[170:173], v[134:137]
    v_mul_f32 v159, v123, v159
    v_cvt_pk_bf16_f32 v120, v158, v159
    v_mfma_f32_16x16x32_bf16 v[114:117], v[90:93], v[194:197], 0
    v_mul_f32 v160, v123, v160
    v_mul_f32 v161, v123, v161
    v_mfma_f32_16x16x32_bf16 v[114:117], v[94:97], v[190:193], v[114:117]
    ds_read_b128 v[122:125], v2 offset:12288
    ds_read_b128 v[174:177], v2 offset:13312
    v_mfma_f32_16x16x32_bf16 v[114:117], v[98:101], v[210:213], v[114:117]
    ds_read_b128 v[190:193], v2 offset:14336
    v_cvt_pk_bf16_f32 v121, v160, v161
    v_mfma_f32_16x16x32_bf16 v[114:117], v[102:105], v[202:205], v[114:117]
    ds_read_b128 v[194:197], v2 offset:15360
    v_fmac_f32 v254, v133, v133
    v_mfma_f32_16x16x32_bf16 v[114:117], v[106:109], v[214:217], v[114:117]
    ds_read_b128 v[202:205], v2 offset:16384
    v_fmac_f32 v254, v126, v126
    v_mfma_f32_16x16x32_bf16 v[114:117], v[110:113], v[222:225], v[114:117]
    ds_read_b128 v[210:213], v2 offset:17408
    ds_write_b64 v4, v[120:121] offset:10240
    v_permlane16_swap_b32 v255, v119
    v_max_f32 v255, v255, v119
    v_sub_f32 v182, v182, v255
    v_exp_f32 v182, v182
    v_sub_f32 v183, v183, v255
    v_exp_f32 v183, v183
    s_waitcnt lgkmcnt(5)
    v_mfma_f32_16x16x32_bf16 v[242:245], a[216:219], v[122:125], 0
    v_cvt_pk_bf16_f32 v182, v182, v183
    v_sub_f32 v184, v184, v255
    v_mfma_f32_16x16x32_bf16 v[242:245], a[220:223], v[174:177], v[242:245]
    s_waitcnt lgkmcnt(4)
    v_exp_f32 v184, v184
    v_mfma_f32_16x16x32_bf16 v[242:245], a[224:227], v[190:193], v[242:245]
    s_waitcnt lgkmcnt(3)
    v_sub_f32 v185, v185, v255
    v_sub_f32 v186, v186, v255
    v_mfma_f32_16x16x32_bf16 v[242:245], a[228:231], v[194:197], v[242:245]
    s_waitcnt lgkmcnt(2)
    v_exp_f32 v185, v185
    v_mfma_f32_16x16x32_bf16 v[242:245], a[232:235], v[202:205], v[242:245]
    s_waitcnt lgkmcnt(0)
    v_cvt_pk_bf16_f32 v183, v184, v185
    v_sub_f32 v187, v187, v255
    v_mfma_f32_16x16x32_bf16 v[242:245], a[236:239], v[210:213], v[242:245]
    v_exp_f32 v186, v186
    v_mfma_f32_16x16x32_bf16 v[158:161], a[240:243], v[122:125], 0
    v_exp_f32 v187, v187
    v_mfma_f32_16x16x32_bf16 v[158:161], a[244:247], v[174:177], v[158:161]
    v_cvt_pk_bf16_f32 v184, v186, v187
    v_sub_f32 v188, v188, v255
    v_mfma_f32_16x16x32_bf16 v[158:161], a[248:251], v[190:193], v[158:161]
    v_exp_f32 v188, v188
    v_mfma_f32_16x16x32_bf16 v[158:161], a[252:255], v[194:197], v[158:161]
    v_sub_f32 v189, v189, v255
    v_sub_f32 v138, v138, v255
    v_mfma_f32_16x16x32_bf16 v[158:161], v[82:85], v[202:205], v[158:161]
    v_exp_f32 v189, v189
    v_mfma_f32_16x16x32_bf16 v[158:161], v[86:89], v[210:213], v[158:161]
    v_cvt_pk_bf16_f32 v185, v188, v189
    v_sub_f32 v139, v139, v255
    v_mfma_f32_16x16x32_bf16 v[154:157], v[90:93], v[122:125], 0
    v_exp_f32 v138, v138
    v_mfma_f32_16x16x32_bf16 v[154:157], v[94:97], v[174:177], v[154:157]
    v_exp_f32 v139, v139
    v_mfma_f32_16x16x32_bf16 v[154:157], v[98:101], v[190:193], v[154:157]
    v_cvt_pk_bf16_f32 v36, v138, v139
    v_sub_f32 v140, v140, v255
    v_mfma_f32_16x16x32_bf16 v[154:157], v[102:105], v[194:197], v[154:157]
    v_exp_f32 v140, v140
    v_mfma_f32_16x16x32_bf16 v[154:157], v[106:109], v[202:205], v[154:157]
    v_sub_f32 v141, v141, v255
    v_sub_f32 v238, v238, v255
    v_mfma_f32_16x16x32_bf16 v[154:157], v[110:113], v[210:213], v[154:157]
    ds_read_b128 v[186:189], v0 offset:20480
    ds_read_b128 v[194:197], v1 offset:20480
    ds_read_b128 v[122:125], v0 offset:20608
    v_exp_f32 v141, v141
    v_exp_f32 v238, v238
    v_cvt_pk_bf16_f32 v37, v140, v141
    v_cvt_pk_bf16_f32 v39, v238, 0
    v_fma_f32 v255, v242, v242, s33
    v_fmac_f32 v255, v243, v243
    v_mfma_f32_16x16x32_bf16 v[138:141], v[28:31], v[36:39], 0
    ds_read_b128 v[202:205], v1 offset:20608
    ds_read_b128 v[230:233], v0 offset:20736
    v_mfma_f32_16x16x32_bf16 v[138:141], v[28:31], v[182:185], v[138:141]
    ds_read_b128 v[238:241], v1 offset:20736
    v_fmac_f32 v255, v244, v244
    v_mfma_f32_16x16x32_bf16 v[174:177], v[162:165], v[36:39], 0
    v_fmac_f32 v255, v245, v245
    v_fmac_f32 v255, v158, v158
    v_mfma_f32_16x16x32_bf16 v[174:177], v[142:145], v[182:185], v[174:177]
    v_fmac_f32 v255, v159, v159
    v_fmac_f32 v255, v160, v160
    v_mfma_f32_16x16x32_bf16 v[142:145], v[166:169], v[36:39], 0
    s_waitcnt lgkmcnt(5)
    v_rcp_f32 v139, v138
    v_mfma_f32_16x16x32_bf16 v[142:145], v[146:149], v[182:185], v[142:145]
    s_waitcnt lgkmcnt(3)
    v_fmac_f32 v255, v161, v161
    v_mul_f32 v174, v139, v174
    v_mfma_f32_16x16x32_bf16 v[146:149], v[170:173], v[36:39], 0
    v_mul_f32 v175, v139, v175
    v_cvt_pk_bf16_f32 v162, v174, v175
    v_mfma_f32_16x16x32_bf16 v[146:149], v[150:153], v[182:185], v[146:149]
    v_mul_f32 v176, v139, v176
    v_mul_f32 v177, v139, v177
    v_mfma_f32_16x16x32_bf16 v[150:153], a[72:75], v[186:189], 0
    s_waitcnt lgkmcnt(1)
    v_cvt_pk_bf16_f32 v163, v176, v177
    v_mul_f32 v142, v139, v142
    v_mfma_f32_16x16x32_bf16 v[150:153], a[76:79], v[194:197], v[150:153]
    s_waitcnt lgkmcnt(0)
    v_mul_f32 v143, v139, v143
    v_cvt_pk_bf16_f32 v164, v142, v143
    v_mfma_f32_16x16x32_bf16 v[150:153], a[80:83], v[122:125], v[150:153]
    v_mul_f32 v144, v139, v144
    v_mul_f32 v145, v139, v145
    v_mfma_f32_16x16x32_bf16 v[150:153], a[84:87], v[202:205], v[150:153]
    v_cvt_pk_bf16_f32 v165, v144, v145
    v_mul_f32 v146, v139, v146
    v_mfma_f32_16x16x32_bf16 v[150:153], a[88:91], v[230:233], v[150:153]
    ds_write_b128 v3, v[162:165] offset:12288
    v_mfma_f32_16x16x32_bf16 v[150:153], a[92:95], v[238:241], v[150:153]
    v_mul_f32 v147, v139, v147
    v_cvt_pk_bf16_f32 v146, v146, v147
    v_mfma_f32_16x16x32_bf16 v[162:165], a[96:99], v[186:189], 0
    v_mul_f32 v148, v139, v148
    v_mul_f32 v149, v139, v149
    v_mfma_f32_16x16x32_bf16 v[162:165], a[100:103], v[194:197], v[162:165]
    v_cvt_pk_bf16_f32 v147, v148, v149
    v_fmac_f32 v255, v154, v154
    v_mfma_f32_16x16x32_bf16 v[162:165], a[104:107], v[122:125], v[162:165]
    ds_write_b64 v4, v[146:147] offset:16384
    v_mfma_f32_16x16x32_bf16 v[162:165], a[108:111], v[202:205], v[162:165]
    v_fmac_f32 v255, v155, v155
    v_fmac_f32 v255, v156, v156
    v_mfma_f32_16x16x32_bf16 v[162:165], a[112:115], v[230:233], v[162:165]
    v_fmac_f32 v255, v157, v157
    v_cvt_pk_bf16_f32 v255, v255, v255
    v_mfma_f32_16x16x32_bf16 v[162:165], a[116:119], v[238:241], v[162:165]
    v_rcp_f32_dpp v235, v234 quad_perm:[0,0,0,0] row_mask:0xf bank_mask:0xf
    v_mfma_f32_16x16x32_bf16 v[170:173], a[120:123], v[186:189], 0
    v_mul_f32 v218, v218, v235
    v_fmac_f32 v254, v127, v127
    v_mfma_f32_16x16x32_bf16 v[170:173], a[124:127], v[194:197], v[170:173]
    v_mul_f32_dpp v218, v226, v235 quad_perm:[0,1,2,3] row_mask:0x2 bank_mask:0xf
    v_fmac_f32 v254, v128, v128
    v_mfma_f32_16x16x32_bf16 v[170:173], a[128:131], v[122:125], v[170:173]
    v_mul_f32_dpp v218, v134, v235 quad_perm:[0,1,2,3] row_mask:0x4 bank_mask:0xf
    v_cvt_pk_bf16_f32 v218, v218, v218
    v_mfma_f32_16x16x32_bf16 v[170:173], a[132:135], v[202:205], v[170:173]
    ds_write_b16 v7, v218
    v_mfma_f32_16x16x32_bf16 v[170:173], a[136:139], v[230:233], v[170:173]
    v_fmac_f32 v254, v129, v129
    v_fmac_f32 v254, v114, v114
    v_mfma_f32_16x16x32_bf16 v[170:173], a[140:143], v[238:241], v[170:173]
    v_fmac_f32 v254, v115, v115
    v_fmac_f32 v254, v116, v116
    v_mfma_f32_16x16x32_bf16 v[138:141], a[0:3], v[186:189], 0
    v_fmac_f32 v254, v117, v117
    v_cvt_pk_bf16_f32 v254, v118, v254
    v_mfma_f32_16x16x32_bf16 v[138:141], a[4:7], v[194:197], v[138:141]
    ds_write_b64 v4, v[254:255] offset:18432
    v_mfma_f32_16x16x32_bf16 v[138:141], a[8:11], v[122:125], v[138:141]
    v_fma_f32 v174, v150, v150, s32
    v_fmac_f32 v174, v151, v151
    v_mfma_f32_16x16x32_bf16 v[138:141], a[12:15], v[202:205], v[138:141]
    v_fmac_f32 v174, v152, v152
    v_fmac_f32 v174, v153, v153
    v_mfma_f32_16x16x32_bf16 v[138:141], a[16:19], v[230:233], v[138:141]
    v_xor_b32 v2, 65536, v2
    v_xor_b32 v3, 65536, v3
    v_mfma_f32_16x16x32_bf16 v[138:141], a[20:23], v[238:241], v[138:141]
    v_xor_b32 v4, 65536, v4
    v_add_u32 v7, s76, v7
    v_mfma_f32_16x16x32_bf16 v[166:169], a[24:27], v[186:189], 0
    v_mfma_f32_16x16x32_bf16 v[166:169], a[28:31], v[194:197], v[166:169]
    v_mfma_f32_16x16x32_bf16 v[166:169], a[32:35], v[122:125], v[166:169]
    s_waitcnt lgkmcnt(0)
    v_mfma_f32_16x16x32_bf16 v[166:169], a[36:39], v[202:205], v[166:169]
    s_barrier
    v_mfma_f32_16x16x32_bf16 v[166:169], a[40:43], v[230:233], v[166:169]
    v_mfma_f32_16x16x32_bf16 v[166:169], a[44:47], v[238:241], v[166:169]
    v_mfma_f32_16x16x32_bf16 v[134:137], a[48:51], v[186:189], 0
    v_mfma_f32_16x16x32_bf16 v[134:137], a[52:55], v[194:197], v[134:137]
    s_cbranch_scc1 L_LOOP
    v_mfma_f32_16x16x32_bf16 v[134:137], a[56:59], v[122:125], v[134:137]
    s_mov_b32 s12, s40
    ds_read_b128 v[118:121], v2 offset:18432
    ds_read_b128 v[142:145], v2 offset:19456
    v_mfma_f32_16x16x32_bf16 v[134:137], a[60:63], v[202:205], v[134:137]
    s_mov_b32 s13, s41
    v_fmac_f32 v174, v162, v162
    v_fmac_f32 v174, v163, v163
    v_mfma_f32_16x16x32_bf16 v[134:137], a[64:67], v[230:233], v[134:137]
    s_mov_b32 s14, s36
    v_fmac_f32 v174, v164, v164
    v_fmac_f32 v174, v165, v165
    v_mfma_f32_16x16x32_bf16 v[134:137], a[68:71], v[238:241], v[134:137]
    s_add_u32 s48, s40, s27
    v_fmac_f32 v174, v170, v170
    v_fmac_f32 v174, v171, v171
    v_mfma_f32_16x16x32_bf16 v[146:149], v[186:189], a[144:147], 0
    s_addc_u32 s49, s41, 0
    v_fmac_f32 v174, v172, v172
    v_fmac_f32 v174, v173, v173
    v_mfma_f32_16x16x32_bf16 v[146:149], v[194:197], a[148:151], v[146:149]
    s_sub_u32 s50, s36, s27
    v_fma_f32 v254, v138, v138, s32
    v_fmac_f32 v254, v139, v139
    v_mfma_f32_16x16x32_bf16 v[146:149], v[122:125], a[152:155], v[146:149]
    s_mov_b32 s51, 0x00020000
    v_fmac_f32 v254, v140, v140
    v_fmac_f32 v254, v141, v141
    v_mfma_f32_16x16x32_bf16 v[146:149], v[202:205], a[156:159], v[146:149]
    s_add_u32 s52, s40, s26
    v_fmac_f32 v254, v166, v166
    v_fmac_f32 v254, v167, v167
    v_mfma_f32_16x16x32_bf16 v[146:149], v[230:233], a[160:163], v[146:149]
    s_waitcnt lgkmcnt(0)
    v_fmac_f32 v254, v168, v168
    v_fmac_f32 v254, v169, v169
    v_mfma_f32_16x16x32_bf16 v[182:185], v[32:35], v[118:121], 0
    s_addc_u32 s53, s41, 0
    v_fmac_f32 v254, v134, v134
    v_fmac_f32 v254, v135, v135
    v_mfma_f32_16x16x32_bf16 v[182:185], v[32:35], v[142:145], v[182:185]
    s_sub_u32 s54, s36, s26
    v_fmac_f32 v254, v136, v136
    v_fmac_f32 v254, v137, v137
    v_mfma_f32_16x16x32_bf16 v[146:149], v[238:241], a[164:167], v[146:149]
    s_mov_b32 s55, 0x00020000
    v_cvt_pk_bf16_f32 v36, v254, v174
    v_bfe_u32 v254, v2, 4, 6
    v_mfma_f32_16x16x32_bf16 v[118:121], v[186:189], a[168:171], 0
    s_add_u32 s56, s40, s25
    v_mul_f32 v255, 0x3baaaaab, v183
    v_mul_f32 v182, 0x3baaaaab, v182
    v_mfma_f32_16x16x32_bf16 v[142:145], v[32:35], v[36:39], 0
    s_addc_u32 s57, s41, 0
    v_rsq_f32 v255, v255
    v_mfma_f32_16x16x32_bf16 v[118:121], v[194:197], a[172:175], v[118:121]
    s_sub_u32 s58, s36, s25
    v_mul_f32 v130, v255, v130
    v_mul_f32 v131, v255, v131
    v_mfma_f32_16x16x32_bf16 v[118:121], v[122:125], a[176:179], v[118:121]
    s_mov_b32 s59, 0x00020000
    v_cvt_pk_bf16_f32 v130, v130, v131
    v_mul_f32 v132, v255, v132
    v_mfma_f32_16x16x32_bf16 v[118:121], v[202:205], a[180:183], v[118:121]
    s_and_b32 s6, s2, 7
    v_mul_f32 v133, v255, v133
    v_cvt_pk_bf16_f32 v131, v132, v133
    v_mfma_f32_16x16x32_bf16 v[118:121], v[230:233], a[184:187], v[118:121]
    s_sub_u32 s6, 0, s6
    ds_read_b128 v[174:177], v0 offset:26624
    v_mul_f32 v126, v255, v126
    v_mfma_f32_16x16x32_bf16 v[118:121], v[238:241], a[188:191], v[118:121]
    s_lshl_b32 s3, s16, 6
    ds_read_b128 v[190:193], v1 offset:26624
    v_mul_f32 v127, v255, v127
    v_mfma_f32_16x16x32_bf16 v[210:213], v[186:189], a[192:195], 0
    s_lshl_b32 s4, s16, 5
    ds_read_b128 v[186:189], v0 offset:26752
    v_cvt_pk_bf16_f32 v132, v126, v127
    v_mfma_f32_16x16x32_bf16 v[210:213], v[194:197], a[196:199], v[210:213]
    s_add_u32 s4, s4, 256
    ds_read_b128 v[194:197], v1 offset:26752
    v_mul_f32 v128, v255, v128
    v_mfma_f32_16x16x32_bf16 v[210:213], v[122:125], a[200:203], v[210:213]
    s_mul_i32 s5, s16, 9408
    ds_read_b128 v[122:125], v0 offset:26880
    v_mul_f32 v129, v255, v129
    v_mfma_f32_16x16x32_bf16 v[210:213], v[202:205], a[204:207], v[210:213]
    s_add_u32 s5, s5, 104448
    ds_read_b128 v[202:205], v1 offset:26880
    v_cvt_pk_bf16_f32 v133, v128, v129
    v_mfma_f32_16x16x32_bf16 v[210:213], v[230:233], a[208:211], v[210:213]
    buffer_store_dwordx4 v[130:133], v16, s[48:51], 0 offen nt
    v_mul_f32 v114, v255, v114
    v_mul_f32 v115, v255, v115
    v_cvt_pk_bf16_f32 v144, v114, v115
    v_mul_f32 v116, v255, v116
    v_mfma_f32_16x16x32_bf16 v[210:213], v[238:241], a[212:215], v[210:213]
    s_waitcnt lgkmcnt(5)
    ds_read_b128 v[126:129], v2 offset:0
    ds_read_b128 v[130:133], v2 offset:1024
    v_mfma_f32_16x16x32_bf16 v[214:217], a[72:75], v[174:177], 0
    s_waitcnt lgkmcnt(6)
    ds_read_b128 v[218:221], v2 offset:2048
    ds_read_b128 v[222:225], v2 offset:3072
    v_mfma_f32_16x16x32_bf16 v[214:217], a[76:79], v[190:193], v[214:217]
    s_waitcnt lgkmcnt(7)
    v_mul_f32 v117, v255, v117
    v_cvt_pk_bf16_f32 v145, v116, v117
    v_mfma_f32_16x16x32_bf16 v[214:217], a[80:83], v[186:189], v[214:217]
    s_waitcnt lgkmcnt(6)
    ds_read_b128 v[114:117], v2 offset:4096
    ds_read_b128 v[226:229], v2 offset:5120
    v_mfma_f32_16x16x32_bf16 v[214:217], a[84:87], v[194:197], v[214:217]
    s_waitcnt lgkmcnt(7)
    v_rsq_f32 v182, v182
    v_mfma_f32_16x16x32_bf16 v[214:217], a[88:91], v[122:125], v[214:217]
    s_waitcnt lgkmcnt(6)
    v_mul_f32 v178, v182, v178
    v_mul_f32 v179, v182, v179
    v_mfma_f32_16x16x32_bf16 v[214:217], a[92:95], v[202:205], v[214:217]
    v_cvt_pk_bf16_f32 v178, v178, v179
    v_mul_f32 v180, v182, v180
    v_mfma_f32_16x16x32_bf16 v[230:233], a[96:99], v[174:177], 0
    v_mul_f32 v181, v182, v181
    v_cvt_pk_bf16_f32 v179, v180, v181
    v_mfma_f32_16x16x32_bf16 v[230:233], a[100:103], v[190:193], v[230:233]
    s_waitcnt lgkmcnt(4)
    v_mul_f32 v198, v182, v198
    v_mul_f32 v199, v182, v199
    v_mfma_f32_16x16x32_bf16 v[230:233], a[104:107], v[186:189], v[230:233]
    s_waitcnt lgkmcnt(2)
    v_cvt_pk_bf16_f32 v180, v198, v199
    v_mul_f32 v200, v182, v200
    v_mfma_f32_16x16x32_bf16 v[230:233], a[108:111], v[194:197], v[230:233]
    v_mul_f32 v201, v182, v201
    v_cvt_pk_bf16_f32 v181, v200, v201
    v_mfma_f32_16x16x32_bf16 v[198:201], a[216:219], v[126:129], 0
    s_waitcnt lgkmcnt(0)
    v_mul_f32 v206, v182, v206
    v_mul_f32 v207, v182, v207
    v_mfma_f32_16x16x32_bf16 v[198:201], a[220:223], v[130:133], v[198:201]
    v_cvt_pk_bf16_f32 v206, v206, v207
    v_mul_f32 v208, v182, v208
    v_mfma_f32_16x16x32_bf16 v[198:201], a[224:227], v[218:221], v[198:201]
    v_mul_f32 v209, v182, v209
    v_cvt_pk_bf16_f32 v207, v208, v209
    v_mfma_f32_16x16x32_bf16 v[198:201], a[228:231], v[222:225], v[198:201]
    v_rsq_f32 v143, v143
    v_mfma_f32_16x16x32_bf16 v[198:201], a[232:235], v[114:117], v[198:201]
    buffer_store_dwordx2 v[144:145], v19, s[48:51], 0 offen nt
    v_rsq_f32 v142, v142
    v_mfma_f32_16x16x32_bf16 v[198:201], a[236:239], v[226:229], v[198:201]
    v_mul_f32 v142, s31, v142
    v_cvt_pk_bf16_f32 v146, v146, v147
    v_mfma_f32_16x16x32_bf16 v[234:237], a[240:243], v[126:129], 0
    v_cvt_pk_bf16_f32 v147, v148, v149
    v_cvt_pk_bf16_f32 v118, v118, v119
    v_mfma_f32_16x16x32_bf16 v[234:237], a[244:247], v[130:133], v[234:237]
    v_cvt_pk_bf16_f32 v119, v120, v121
    v_cvt_pk_bf16_f32 v182, v210, v211
    v_mfma_f32_16x16x32_bf16 v[234:237], a[248:251], v[218:221], v[234:237]
    v_fma_f32 v255, v198, v198, s33
    v_fmac_f32 v255, v199, v199
    v_mfma_f32_16x16x32_bf16 v[234:237], a[252:255], v[222:225], v[234:237]
    v_fmac_f32 v255, v200, v200
    v_fmac_f32 v255, v201, v201
    v_mfma_f32_16x16x32_bf16 v[234:237], v[82:85], v[114:117], v[234:237]
    v_cvt_pk_bf16_f32 v183, v212, v213
    v_mul_f32 v150, v143, v150
    v_mfma_f32_16x16x32_bf16 v[234:237], v[86:89], v[226:229], v[234:237]
    v_mul_f32 v151, v143, v151
    v_cvt_pk_f16_f32 v150, v150, v151
    v_mfma_f32_16x16x32_bf16 v[210:213], v[90:93], v[126:129], 0
    v_mul_f32 v152, v143, v152
    v_mul_f32 v153, v143, v153
    v_mfma_f32_16x16x32_bf16 v[210:213], v[94:97], v[130:133], v[210:213]
    v_cvt_pk_f16_f32 v151, v152, v153
    v_mul_f32 v162, v143, v162
    v_mfma_f32_16x16x32_bf16 v[210:213], v[98:101], v[218:221], v[210:213]
    v_fmac_f32 v255, v234, v234
    v_fmac_f32 v255, v235, v235
    v_mfma_f32_16x16x32_bf16 v[210:213], v[102:105], v[222:225], v[210:213]
    v_fmac_f32 v255, v236, v236
    v_fmac_f32 v255, v237, v237
    v_mfma_f32_16x16x32_bf16 v[210:213], v[106:109], v[114:117], v[210:213]
    v_mul_f32 v163, v143, v163
    v_cvt_pk_f16_f32 v152, v162, v163
    v_mfma_f32_16x16x32_bf16 v[210:213], v[110:113], v[226:229], v[210:213]
    v_mul_f32 v164, v143, v164
    v_mul_f32 v165, v143, v165
    v_mfma_f32_16x16x32_bf16 v[230:233], a[112:115], v[122:125], v[230:233]
    v_cvt_pk_f16_f32 v153, v164, v165
    v_mul_f32 v170, v143, v170
    v_mfma_f32_16x16x32_bf16 v[230:233], a[116:119], v[202:205], v[230:233]
    v_mul_f32 v171, v143, v171
    v_cvt_pk_f16_f32 v128, v170, v171
    v_mfma_f32_16x16x32_bf16 v[114:117], a[120:123], v[174:177], 0
    buffer_store_dwordx4 v[178:181], v15, s[48:51], 0 offen nt
    v_fmac_f32 v255, v210, v210
    v_fmac_f32 v255, v211, v211
    v_fmac_f32 v255, v212, v212
    v_fmac_f32 v255, v213, v213
    v_mfma_f32_16x16x32_bf16 v[114:117], a[124:127], v[190:193], v[114:117]
    ds_read_b128 v[130:133], v2 offset:6144
    ds_read_b128 v[162:165], v2 offset:7168
    v_mfma_f32_16x16x32_bf16 v[114:117], a[128:131], v[186:189], v[114:117]
    ds_read_b128 v[178:181], v2 offset:8192
    ds_read_b128 v[218:221], v2 offset:9216
    v_mfma_f32_16x16x32_bf16 v[114:117], a[132:135], v[194:197], v[114:117]
    v_mul_f32 v172, v143, v172
    v_mul_f32 v173, v143, v173
    v_mfma_f32_16x16x32_bf16 v[114:117], a[136:139], v[122:125], v[114:117]
    ds_read_b128 v[222:225], v2 offset:10240
    ds_read_b128 v[226:229], v2 offset:11264
    v_mfma_f32_16x16x32_bf16 v[114:117], a[140:143], v[202:205], v[114:117]
    v_cvt_pk_f16_f32 v129, v172, v173
    v_mul_f32 v138, v142, v138
    v_mfma_f32_16x16x32_bf16 v[170:173], a[0:3], v[174:177], 0
    v_mul_f32 v139, v142, v139
    v_cvt_pk_f16_f32 v138, v138, v139
    v_mfma_f32_16x16x32_bf16 v[170:173], a[4:7], v[190:193], v[170:173]
    v_mul_f32 v140, v142, v140
    v_mul_f32 v141, v142, v141
    v_mfma_f32_16x16x32_bf16 v[170:173], a[8:11], v[186:189], v[170:173]
    v_cvt_pk_f16_f32 v139, v140, v141
    v_mul_f32 v166, v142, v166
    v_mfma_f32_16x16x32_bf16 v[170:173], a[12:15], v[194:197], v[170:173]
    s_waitcnt lgkmcnt(4)
    v_mul_f32 v167, v142, v167
    v_cvt_pk_f16_f32 v140, v166, v167
    v_mfma_f32_16x16x32_bf16 v[238:241], a[216:219], v[130:133], 0
    s_waitcnt lgkmcnt(2)
    v_mul_f32 v168, v142, v168
    v_mul_f32 v169, v142, v169
    v_mfma_f32_16x16x32_bf16 v[238:241], a[220:223], v[162:165], v[238:241]
    v_cvt_pk_f16_f32 v141, v168, v169
    v_mul_f32 v134, v142, v134
    v_mfma_f32_16x16x32_bf16 v[238:241], a[224:227], v[178:181], v[238:241]
    s_waitcnt lgkmcnt(0)
    v_mul_f32 v135, v142, v135
    v_cvt_pk_f16_f32 v126, v134, v135
    v_mfma_f32_16x16x32_bf16 v[238:241], a[228:231], v[218:221], v[238:241]
    v_mul_f32 v136, v142, v136
    v_mul_f32 v137, v142, v137
    v_mfma_f32_16x16x32_bf16 v[238:241], a[232:235], v[222:225], v[238:241]
    v_cvt_pk_f16_f32 v127, v136, v137
    v_fma_f32 v185, v214, v214, s32
    v_mfma_f32_16x16x32_bf16 v[238:241], a[236:239], v[226:229], v[238:241]
    v_fmac_f32 v185, v215, v215
    v_fmac_f32 v185, v216, v216
    v_mfma_f32_16x16x32_bf16 v[134:137], a[240:243], v[130:133], 0
    buffer_store_dwordx2 v[206:207], v18, s[48:51], 0 offen nt
    v_fmac_f32 v185, v217, v217
    v_fmac_f32 v185, v230, v230
    v_mfma_f32_16x16x32_bf16 v[134:137], a[244:247], v[162:165], v[134:137]
    v_fmac_f32 v185, v231, v231
    v_fma_f32 v120, v238, v238, s33
    v_mfma_f32_16x16x32_bf16 v[134:137], a[248:251], v[178:181], v[134:137]
    v_fmac_f32 v120, v239, v239
    v_fmac_f32 v120, v240, v240
    v_mfma_f32_16x16x32_bf16 v[134:137], a[252:255], v[218:221], v[134:137]
    v_fmac_f32 v120, v241, v241
    v_fmac_f32 v185, v232, v232
    v_mfma_f32_16x16x32_bf16 v[134:137], v[82:85], v[222:225], v[134:137]
    v_fmac_f32 v185, v233, v233
    v_fmac_f32 v185, v114, v114
    v_mfma_f32_16x16x32_bf16 v[134:137], v[86:89], v[226:229], v[134:137]
    v_fmac_f32 v185, v115, v115
    v_fmac_f32 v185, v116, v116
    v_mfma_f32_16x16x32_bf16 v[142:145], v[90:93], v[130:133], 0
    v_fmac_f32 v185, v117, v117
    v_mul_f32 v184, 0x3baaaaab, v184
    v_mfma_f32_16x16x32_bf16 v[142:145], v[94:97], v[162:165], v[142:145]
    v_rsq_f32 v184, v184
    v_mfma_f32_16x16x32_bf16 v[142:145], v[98:101], v[178:181], v[142:145]
    v_fmac_f32 v120, v134, v134
    v_fmac_f32 v120, v135, v135
    v_mfma_f32_16x16x32_bf16 v[142:145], v[102:105], v[218:221], v[142:145]
    v_fmac_f32 v120, v136, v136
    v_fmac_f32 v120, v137, v137
    v_mfma_f32_16x16x32_bf16 v[142:145], v[106:109], v[222:225], v[142:145]
    v_mul_f32 v242, v184, v242
    v_mul_f32 v243, v184, v243
    v_mfma_f32_16x16x32_bf16 v[142:145], v[110:113], v[226:229], v[142:145]
    v_cvt_pk_bf16_f32 v130, v242, v243
    v_mul_f32 v244, v184, v244
    v_mfma_f32_16x16x32_bf16 v[170:173], a[16:19], v[122:125], v[170:173]
    v_mul_f32 v245, v184, v245
    v_cvt_pk_bf16_f32 v131, v244, v245
    v_mfma_f32_16x16x32_bf16 v[170:173], a[20:23], v[202:205], v[170:173]
    v_mul_f32 v158, v184, v158
    v_mul_f32 v159, v184, v159
    v_mfma_f32_16x16x32_bf16 v[162:165], a[24:27], v[174:177], 0
    v_fmac_f32 v120, v142, v142
    v_fmac_f32 v120, v143, v143
    v_mfma_f32_16x16x32_bf16 v[162:165], a[28:31], v[190:193], v[162:165]
    v_fmac_f32 v120, v144, v144
    v_fmac_f32 v120, v145, v145
    v_mfma_f32_16x16x32_bf16 v[162:165], a[32:35], v[186:189], v[162:165]
    v_cvt_pk_bf16_f32 v148, v255, v120
    v_cvt_pk_bf16_f32 v149, v120, v120
    v_mfma_f32_16x16x32_bf16 v[162:165], a[36:39], v[194:197], v[162:165]
    v_fma_f32 v255, v170, v170, s32
    v_fmac_f32 v255, v171, v171
    v_mfma_f32_16x16x32_bf16 v[162:165], a[40:43], v[122:125], v[162:165]
    v_fmac_f32 v255, v172, v172
    v_fmac_f32 v255, v173, v173
    v_mfma_f32_16x16x32_bf16 v[162:165], a[44:47], v[202:205], v[162:165]
    v_cvt_pk_bf16_f32 v132, v158, v159
    v_mul_f32 v160, v184, v160
    v_mfma_f32_16x16x32_bf16 v[166:169], a[48:51], v[174:177], 0
    v_mul_f32 v161, v184, v161
    v_cvt_pk_bf16_f32 v133, v160, v161
    v_mfma_f32_16x16x32_bf16 v[166:169], a[52:55], v[190:193], v[166:169]
    buffer_store_dwordx4 v[130:133], v17, s[48:51], 0 offen nt
    v_mul_f32 v154, v184, v154
    v_fmac_f32 v255, v162, v162
    v_fmac_f32 v255, v163, v163
    v_fmac_f32 v255, v164, v164
    v_mfma_f32_16x16x32_bf16 v[166:169], a[56:59], v[186:189], v[166:169]
    v_fmac_f32 v255, v165, v165
    v_mul_f32 v155, v184, v155
    v_mfma_f32_16x16x32_bf16 v[166:169], a[60:63], v[194:197], v[166:169]
    v_cvt_pk_bf16_f32 v120, v154, v155
    v_mul_f32 v156, v184, v156
    v_mfma_f32_16x16x32_bf16 v[166:169], a[64:67], v[122:125], v[166:169]
    v_mul_f32 v157, v184, v157
    v_cvt_pk_bf16_f32 v121, v156, v157
    v_mfma_f32_16x16x32_bf16 v[166:169], a[68:71], v[202:205], v[166:169]
    v_lshrrev_b32 v130, 4, v254
    v_and_b32 v131, 15, v254
    v_mfma_f32_16x16x32_bf16 v[154:157], v[174:177], a[144:147], 0
    v_lshlrev_b32 v132, 9, v130
    v_lshl_add_u32 v132, v131, 4, v132
    v_mfma_f32_16x16x32_bf16 v[154:157], v[190:193], a[148:151], v[154:157]
    v_add_u32 v132, 149696, v132
    v_and_b32 v133, 0xffff, v2
    v_mfma_f32_16x16x32_bf16 v[154:157], v[186:189], a[152:155], v[154:157]
    v_fmac_f32 v255, v166, v166
    v_fmac_f32 v255, v167, v167
    v_mfma_f32_16x16x32_bf16 v[154:157], v[194:197], a[156:159], v[154:157]
    v_fmac_f32 v255, v168, v168
    v_fmac_f32 v255, v169, v169
    v_mfma_f32_16x16x32_bf16 v[154:157], v[122:125], a[160:163], v[154:157]
    v_cvt_pk_bf16_f32 v36, v255, v185
    v_add_u32 v133, 38912, v133
    v_mfma_f32_16x16x32_bf16 v[154:157], v[202:205], a[164:167], v[154:157]
    v_and_b32 v255, 0xffff, v4
    v_add_u32 v255, 38912, v255
    v_mfma_f32_16x16x32_bf16 v[158:161], v[32:35], v[36:39], 0
    ds_write_b64 v255, v[148:149] offset:0
    v_mfma_f32_16x16x32_bf16 v[178:181], v[174:177], a[168:171], 0
    v_mov_b32 v206, 0x40000000
    v_add_u32 v207, 0, v131
    v_mfma_f32_16x16x32_bf16 v[178:181], v[190:193], a[172:175], v[178:181]
    v_cvt_pk_bf16_f32 v148, v154, v155
    v_cvt_pk_bf16_f32 v149, v156, v157
    v_mfma_f32_16x16x32_bf16 v[178:181], v[186:189], a[176:179], v[178:181]
    v_rsq_f32 v159, v159
    v_mfma_f32_16x16x32_bf16 v[178:181], v[194:197], a[180:183], v[178:181]
    buffer_store_dwordx2 v[120:121], v20, s[48:51], 0 offen nt
    v_rsq_f32 v158, v158
    v_mfma_f32_16x16x32_bf16 v[178:181], v[122:125], a[184:187], v[178:181]
    ds_read_b128 v[154:157], v0 offset:32768
    v_mul_f32 v158, s31, v158
    v_mfma_f32_16x16x32_bf16 v[178:181], v[202:205], a[188:191], v[178:181]
    ds_read_b128 v[218:221], v1 offset:32768
    v_mul_f32 v214, v159, v214
    v_mfma_f32_16x16x32_bf16 v[222:225], v[174:177], a[192:195], 0
    s_waitcnt lgkmcnt(2)
    ds_read_b128 v[174:177], v0 offset:32896
    v_mul_f32 v215, v159, v215
    v_mfma_f32_16x16x32_bf16 v[222:225], v[190:193], a[196:199], v[222:225]
    s_barrier
    ds_read_b128 v[190:193], v133 offset:0
    ds_read_b128 v[226:229], v133 offset:1024
    v_mfma_f32_16x16x32_bf16 v[222:225], v[186:189], a[200:203], v[222:225]
    ds_read_b128 v[186:189], v1 offset:32896
    v_cvt_pk_bf16_f32 v120, v178, v179
    v_mfma_f32_16x16x32_bf16 v[222:225], v[194:197], a[204:207], v[222:225]
    ds_read_b128 v[194:197], v0 offset:33024
    v_cvt_pk_bf16_f32 v121, v180, v181
    v_mfma_f32_16x16x32_bf16 v[222:225], v[122:125], a[208:211], v[222:225]
    ds_read_b128 v[122:125], v1 offset:33024
    v_cvt_pk_f16_f32 v178, v214, v215
    v_mfma_f32_16x16x32_bf16 v[222:225], v[202:205], a[212:215], v[222:225]
    v_mul_f32 v216, v159, v216
    v_mul_f32 v217, v159, v217
    v_mfma_f32_16x16x32_f16 v[202:205], v[150:153], v[138:141], v[46:49]
    s_waitcnt lgkmcnt(7)
    v_cvt_pk_f16_f32 v179, v216, v217
    v_mul_f32 v230, v159, v230
    v_mfma_f32_16x16x32_bf16 v[214:217], a[72:75], v[154:157], 0
    s_waitcnt lgkmcnt(6)
    v_cvt_pk_bf16_f32 v184, v222, v223
    v_cvt_pk_bf16_f32 v185, v224, v225
    v_mfma_f32_16x16x32_bf16 v[214:217], a[76:79], v[218:221], v[214:217]
    s_waitcnt lgkmcnt(5)
    v_mul_f32 v231, v159, v231
    v_cvt_pk_f16_f32 v180, v230, v231
    v_mfma_f32_16x16x32_bf16 v[214:217], a[80:83], v[174:177], v[214:217]
    s_waitcnt lgkmcnt(3)
    v_mul_f32 v232, v159, v232
    v_mul_f32 v233, v159, v233
    v_mfma_f32_16x16x32_bf16 v[222:225], v[32:35], v[190:193], 0
    s_waitcnt lgkmcnt(2)
    v_cvt_pk_f16_f32 v181, v232, v233
    v_mul_f32 v114, v159, v114
    v_mfma_f32_16x16x32_bf16 v[222:225], v[32:35], v[226:229], v[222:225]
    s_waitcnt lgkmcnt(1)
    v_mul_f32 v115, v159, v115
    v_cvt_pk_f16_f32 v192, v114, v115
    v_mfma_f32_16x16x32_bf16 v[214:217], a[84:87], v[186:189], v[214:217]
    s_waitcnt lgkmcnt(0)
    v_mul_f32 v116, v159, v116
    v_mul_f32 v117, v159, v117
    v_mfma_f32_16x16x32_bf16 v[214:217], a[88:91], v[194:197], v[214:217]
    v_mul_f32 v208, 0x3baaaaab, v223
    v_cvt_pk_f16_f32 v193, v116, v117
    v_mfma_f32_16x16x32_bf16 v[214:217], a[92:95], v[122:125], v[214:217]
    v_rsq_f32 v208, v208
    v_mfma_f32_16x16x32_bf16 v[114:117], a[96:99], v[154:157], 0
    v_mul_f32 v238, v208, v238
    v_mul_f32 v239, v208, v239
    v_mfma_f32_16x16x32_bf16 v[114:117], a[100:103], v[218:221], v[114:117]
    v_cvt_pk_bf16_f32 v226, v238, v239
    v_mul_f32 v240, v208, v240
    v_mfma_f32_16x16x32_bf16 v[114:117], a[104:107], v[174:177], v[114:117]
    v_mul_f32 v241, v208, v241
    v_cvt_pk_bf16_f32 v227, v240, v241
    v_mfma_f32_16x16x32_bf16 v[114:117], a[108:111], v[186:189], v[114:117]
    v_mul_f32 v134, v208, v134
    v_mul_f32 v135, v208, v135
    v_mfma_f32_16x16x32_bf16 v[114:117], a[112:115], v[194:197], v[114:117]
    v_cvt_pk_bf16_f32 v228, v134, v135
    v_mul_f32 v136, v208, v136
    v_mfma_f32_16x16x32_bf16 v[114:117], a[116:119], v[122:125], v[114:117]
    v_mul_f32 v137, v208, v137
    v_cvt_pk_bf16_f32 v229, v136, v137
    v_mfma_f32_16x16x32_bf16 v[134:137], a[120:123], v[154:157], 0
    buffer_store_dwordx4 v[226:229], v16, s[52:55], 0 offen nt
    v_mul_f32 v142, v208, v142
    v_mul_f32 v143, v208, v143
    v_cvt_pk_bf16_f32 v224, v142, v143
    v_mul_f32 v144, v208, v144
    v_mfma_f32_16x16x32_bf16 v[134:137], a[124:127], v[218:221], v[134:137]
    v_mul_f32 v145, v208, v145
    v_cvt_pk_bf16_f32 v225, v144, v145
    v_mfma_f32_16x16x32_bf16 v[134:137], a[128:131], v[174:177], v[134:137]
    v_mul_f32 v170, v158, v170
    v_mul_f32 v171, v158, v171
    v_mfma_f32_16x16x32_bf16 v[134:137], a[132:135], v[186:189], v[134:137]
    v_cvt_pk_f16_f32 v142, v170, v171
    v_mul_f32 v172, v158, v172
    v_mfma_f32_16x16x32_bf16 v[134:137], a[136:139], v[194:197], v[134:137]
    v_mul_f32 v173, v158, v173
    v_cvt_pk_f16_f32 v143, v172, v173
    v_mfma_f32_16x16x32_bf16 v[134:137], a[140:143], v[122:125], v[134:137]
    v_mul_f32 v162, v158, v162
    v_mul_f32 v163, v158, v163
    v_mfma_f32_16x16x32_bf16 v[170:173], a[0:3], v[154:157], 0
    v_cvt_pk_f16_f32 v144, v162, v163
    v_mul_f32 v164, v158, v164
    v_mfma_f32_16x16x32_bf16 v[170:173], a[4:7], v[218:221], v[170:173]
    v_mul_f32 v165, v158, v165
    v_cvt_pk_f16_f32 v145, v164, v165
    v_mfma_f32_16x16x32_bf16 v[170:173], a[8:11], v[174:177], v[170:173]
    v_mul_f32 v166, v158, v166
    v_mul_f32 v167, v158, v167
    v_mfma_f32_16x16x32_bf16 v[170:173], a[12:15], v[186:189], v[170:173]
    v_cvt_pk_f16_f32 v190, v166, v167
    v_mul_f32 v168, v158, v168
    v_mfma_f32_16x16x32_bf16 v[170:173], a[16:19], v[194:197], v[170:173]
    v_mul_f32 v169, v158, v169
    v_cvt_pk_f16_f32 v191, v168, v169
    v_mfma_f32_16x16x32_bf16 v[170:173], a[20:23], v[122:125], v[170:173]
    v_mul_f32 v208, 0x3baaaaab, v222
    v_fma_f32 v209, v214, v214, s32
    v_mfma_f32_16x16x32_bf16 v[158:161], a[24:27], v[154:157], 0
    v_rsq_f32 v208, v208
    v_mfma_f32_16x16x32_f16 v[162:165], v[178:181], v[138:141], v[50:53]
    v_mul_f32 v198, v208, v198
    v_mul_f32 v199, v208, v199
    v_cvt_pk_bf16_f32 v166, v198, v199
    v_mfma_f32_16x16x16_f16 v[202:205], v[128:129], v[126:127], v[202:205]
    v_mul_f32 v200, v208, v200
    v_mul_f32 v201, v208, v201
    v_cvt_pk_bf16_f32 v167, v200, v201
    v_mfma_f32_16x16x16_f16 v[162:165], v[192:193], v[126:127], v[162:165]
    v_mul_f32 v234, v208, v234
    v_mul_f32 v235, v208, v235
    v_cvt_pk_bf16_f32 v168, v234, v235
    v_mul_f32 v236, v208, v236
    v_mfma_f32_16x16x32_bf16 v[158:161], a[28:31], v[218:221], v[158:161]
    buffer_store_dwordx2 v[224:225], v19, s[52:55], 0 offen nt
    v_mul_f32 v237, v208, v237
    v_cvt_pk_bf16_f32 v169, v236, v237
    v_mfma_f32_16x16x32_bf16 v[158:161], a[32:35], v[174:177], v[158:161]
    v_mul_f32 v210, v208, v210
    v_mul_f32 v211, v208, v211
    v_mfma_f32_16x16x32_bf16 v[158:161], a[36:39], v[186:189], v[158:161]
    v_cvt_pk_bf16_f32 v210, v210, v211
    v_mul_f32 v212, v208, v212
    v_mfma_f32_16x16x32_bf16 v[158:161], a[40:43], v[194:197], v[158:161]
    v_mul_f32 v213, v208, v213
    v_cvt_pk_bf16_f32 v211, v212, v213
    v_mfma_f32_16x16x32_bf16 v[158:161], a[44:47], v[122:125], v[158:161]
    v_fma_f32 v208, v170, v170, s32
    v_fmac_f32 v208, v171, v171
    v_mfma_f32_16x16x32_bf16 v[198:201], a[48:51], v[154:157], 0
    v_fmac_f32 v208, v172, v172
    v_fmac_f32 v208, v173, v173
    v_mfma_f32_16x16x32_bf16 v[198:201], a[52:55], v[218:221], v[198:201]
    v_fmac_f32 v209, v215, v215
    v_fmac_f32 v209, v216, v216
    v_mfma_f32_16x16x32_bf16 v[198:201], a[56:59], v[174:177], v[198:201]
    v_fmac_f32 v208, v158, v158
    v_fmac_f32 v208, v159, v159
    v_mfma_f32_16x16x32_bf16 v[198:201], a[60:63], v[186:189], v[198:201]
    v_fmac_f32 v208, v160, v160
    v_fmac_f32 v208, v161, v161
    v_mfma_f32_16x16x32_bf16 v[198:201], a[64:67], v[194:197], v[198:201]
    v_fmac_f32 v209, v217, v217
    v_fmac_f32 v209, v114, v114
    v_mfma_f32_16x16x32_bf16 v[198:201], a[68:71], v[122:125], v[198:201]
    ds_read2_b32 v[224:225], v6 offset0:0 offset1:0
    ds_read2_b32 v[228:229], v6 offset0:16 offset1:16
    v_mfma_f32_16x16x32_bf16 v[230:233], v[154:157], a[144:147], 0
    ds_read2_b32 v[212:213], v6 offset0:32 offset1:32
    v_fmac_f32 v209, v115, v115
    v_mfma_f32_16x16x32_bf16 v[230:233], v[218:221], a[148:151], v[230:233]
    v_fmac_f32 v209, v116, v116
    v_fmac_f32 v209, v117, v117
    v_mfma_f32_16x16x32_bf16 v[230:233], v[174:177], a[152:155], v[230:233]
    v_fmac_f32 v208, v198, v198
    v_fmac_f32 v208, v199, v199
    v_mfma_f32_16x16x32_bf16 v[230:233], v[186:189], a[156:159], v[230:233]
    v_fmac_f32 v208, v200, v200
    v_fmac_f32 v208, v201, v201
    v_mfma_f32_16x16x32_bf16 v[230:233], v[194:197], a[160:163], v[230:233]
    v_fmac_f32 v209, v134, v134
    v_fmac_f32 v209, v135, v135
    v_mfma_f32_16x16x32_bf16 v[230:233], v[122:125], a[164:167], v[230:233]
    buffer_store_dwordx4 v[166:169], v15, s[52:55], 0 offen nt
    v_fmac_f32 v209, v136, v136
    v_fmac_f32 v209, v137, v137
    v_cvt_pk_bf16_f32 v36, v208, v209
    v_mul_u32_u24 v226, s20, v207
    v_mfma_f32_16x16x32_bf16 v[166:169], v[154:157], a[168:171], 0
    s_waitcnt lgkmcnt(1)
    v_add_u32 v226, s38, v226
    v_cvt_pk_bf16_f32 v222, v230, v231
    v_mfma_f32_16x16x32_bf16 v[234:237], v[32:35], v[36:39], 0
    s_waitcnt lgkmcnt(0)
    v_cvt_pk_bf16_f32 v223, v232, v233
    v_mul_u32_u24 v208, 911, v226
    v_mfma_f32_16x16x32_bf16 v[166:169], v[218:221], a[172:175], v[166:169]
    v_lshrrev_b32 v208, 16, v208
    v_mul_u32_u24 v208, s22, v208
    v_mfma_f32_16x16x32_bf16 v[166:169], v[174:177], a[176:179], v[166:169]
    v_mad_u32_u24 v208, v207, s21, v208
    v_bfe_u32 v226, s70, v207, 1
    v_mfma_f32_16x16x32_bf16 v[166:169], v[186:189], a[180:183], v[166:169]
    ds_read_b128 v[230:233], v2 offset:12288
    v_cmp_ne_u32 vcc, 0, v226
    v_mfma_f32_16x16x32_bf16 v[166:169], v[194:197], a[184:187], v[166:169]
    v_rsq_f32 v235, v235
    v_mfma_f32_16x16x32_bf16 v[166:169], v[122:125], a[188:191], v[166:169]
    v_rsq_f32 v234, v234
    v_mul_f32 v214, v235, v214
    v_mul_f32 v234, s31, v234
    v_mul_f32 v215, v235, v215
    v_cvt_pk_f16_f32 v214, v214, v215
    v_mfma_f32_16x16x32_bf16 v[238:241], v[154:157], a[192:195], 0
    ds_read_b128 v[154:157], v2 offset:13312
    ds_read_b32 v207, v6 offset:192
    v_mfma_f32_16x16x32_bf16 v[238:241], v[218:221], a[196:199], v[238:241]
    v_cvt_pk_bf16_f32 v226, v166, v167
    v_cvt_pk_bf16_f32 v227, v168, v169
    v_mfma_f32_16x16x32_bf16 v[238:241], v[174:177], a[200:203], v[238:241]
    ds_read_b128 v[166:169], v2 offset:14336
    ds_read_b128 v[174:177], v2 offset:15360
    v_mfma_f32_16x16x32_bf16 v[238:241], v[186:189], a[204:207], v[238:241]
    ds_read_b128 v[186:189], v2 offset:16384
    v_mul_f32 v216, v235, v216
    v_mfma_f32_16x16x32_bf16 v[238:241], v[194:197], a[208:211], v[238:241]
    s_waitcnt lgkmcnt(5)
    ds_read_b128 v[194:197], v2 offset:17408
    v_mul_f32 v217, v235, v217
    v_mfma_f32_16x16x32_bf16 v[238:241], v[122:125], a[212:215], v[238:241]
    ds_read_b128 v[122:125], v5 offset:0
    v_cvt_pk_f16_f32 v215, v216, v217
    v_mul_f32 v114, v235, v114
    buffer_store_dwordx2 v[210:211], v18, s[52:55], 0 offen nt
    ds_read_b128 v[218:221], v5 offset:16
    v_mul_f32 v115, v235, v115
    v_cvt_pk_f16_f32 v216, v114, v115
    v_mul_f32 v116, v235, v116
    v_cvt_pk_bf16_f32 v210, v238, v239
    v_cvt_pk_bf16_f32 v211, v240, v241
    v_mul_f32 v117, v235, v117
    v_cvt_pk_f16_f32 v217, v116, v117
    v_mfma_f32_16x16x32_bf16 v[114:117], a[216:219], v[230:233], 0
    s_waitcnt lgkmcnt(6)
    v_mul_f32 v134, v235, v134
    v_mul_f32 v135, v235, v135
    v_mfma_f32_16x16x32_bf16 v[114:117], a[220:223], v[154:157], v[114:117]
    s_waitcnt lgkmcnt(4)
    v_cvt_pk_f16_f32 v240, v134, v135
    v_mul_f32 v136, v235, v136
    v_mfma_f32_16x16x32_bf16 v[114:117], a[224:227], v[166:169], v[114:117]
    s_waitcnt lgkmcnt(3)
    v_mul_f32 v137, v235, v137
    v_cvt_pk_f16_f32 v241, v136, v137
    v_mfma_f32_16x16x32_bf16 v[114:117], a[228:231], v[174:177], v[114:117]
    s_waitcnt lgkmcnt(2)
    v_mul_f32 v170, v234, v170
    v_mul_f32 v171, v234, v171
    v_mfma_f32_16x16x32_bf16 v[114:117], a[232:235], v[186:189], v[114:117]
    s_waitcnt lgkmcnt(1)
    v_cvt_pk_f16_f32 v134, v170, v171
    v_mul_f32 v172, v234, v172
    v_mfma_f32_16x16x32_f16 v[242:245], v[122:125], v[142:145], v[24:27]
    s_waitcnt lgkmcnt(0)
    v_mul_f32 v173, v234, v173
    v_cvt_pk_f16_f32 v135, v172, v173
    v_mfma_f32_16x16x32_f16 v[242:245], v[218:221], v[178:181], v[242:245]
    v_mul_f32 v158, v234, v158
    v_mul_f32 v159, v234, v159
    v_mfma_f32_16x16x32_bf16 v[114:117], a[236:239], v[194:197], v[114:117]
    v_cvt_pk_f16_f32 v136, v158, v159
    v_mul_f32 v160, v234, v160
    v_mul_f32 v161, v234, v161
    v_cvt_pk_f16_f32 v137, v160, v161
    v_mul_f32 v198, v234, v198
    v_mul_f32 v199, v234, v199
    v_cvt_pk_f16_f32 v238, v198, v199
    v_mfma_f32_16x16x32_f16 v[158:161], v[122:125], v[134:137], v[26:29]
    v_mul_f32 v200, v234, v200
    v_mul_f32 v201, v234, v201
    v_mfma_f32_16x16x32_f16 v[158:161], v[218:221], v[214:217], v[158:161]
    v_cvt_pk_f16_f32 v239, v200, v201
    v_add_u32 v208, s7, v208
    v_cndmask_b32 v208, v206, v208, vcc
    v_lshl_add_u32 v209, v130, 4, v208
    v_add_u32 v209, s3, v209
    v_lshl_add_u32 v208, v130, 3, v208
    v_add_u32 v208, s4, v208
    v_sub_u32 v170, 0x40800000, v44
    v_or_b32 v170, v170, v44
    v_fma_f32 v171, v114, v114, s33
    v_fmac_f32 v171, v115, v115
    v_fmac_f32 v171, v116, v116
    v_fmac_f32 v171, v117, v117
    v_xor_b32 v172, 65536, v2
    v_lshl_add_u32 v173, s16, 2, v172
    ds_write_b32 v173, v170 offset:18432
    v_bfe_u32 v170, v131, 1, 2
    v_xor_b32 v170, v170, v130
    v_lshl_add_u32 v170, v131, 2, v170
    v_lshl_add_u32 v173, v170, 4, s5
    v_lshl_add_u32 v198, v170, 3, s5
    v_lshl_add_u32 v199, v254, 4, s5
    v_lshl_add_u32 v254, v254, 3, s5
    v_lshlrev_b32 v170, 2, v170
    ds_permute_b32 v200, v170, v16
    ds_permute_b32 v201, v170, v19
    ds_permute_b32 v234, v170, v17
    ds_permute_b32 v235, v170, v20
    v_add_u32 v131, 16, v131
    v_min_u32 v170, 20, v131
    v_add_u32 v236, 12, v131
    v_lshrrev_b32 v236, 5, v236
    v_sub_u32 v237, v131, v170
    v_mad_i32_i24 v237, v236, s6, v237
    v_mul_u32_u24 v246, s20, v170
    v_add3_u32 v246, v246, v237, s38
    v_mul_u32_u24 v236, 911, v246
    v_lshrrev_b32 v236, 16, v236
    v_mul_u32_u24 v236, s22, v236
    v_mad_u32_u24 v236, v170, s21, v236
    v_bfe_u32 v246, s70, v131, 1
    v_cmp_ne_u32 vcc, 0, v246
    v_mul_i32_i24 v237, 2688, v237
    v_add3_u32 v131, v236, v237, s7
    v_cndmask_b32 v131, v206, v131, vcc
    v_lshl_add_u32 v170, v130, 4, v131
    v_add_u32 v170, s3, v170
    v_lshl_add_u32 v236, v130, 3, v131
    v_add_u32 v236, s4, v236
    ds_read_b128 v[246:249], v5 offset:48
    s_waitcnt lgkmcnt(0)
    v_mfma_f32_16x16x32_f16 v[158:161], v[246:249], v[238:241], v[158:161]
    v_mfma_f32_16x16x32_f16 v[242:245], v[246:249], v[190:193], v[242:245]
    v_mfma_f32_16x16x32_f16 v[250:253], v[122:125], v[138:141], v[22:25]
    v_mfma_f32_16x16x32_f16 v[250:253], v[218:221], v[150:153], v[250:253]
    v_mfma_f32_16x16x32_f16 v[250:253], v[246:249], v[126:129], v[250:253]
    s_nop 0
    s_nop 0
    s_nop 0
    s_nop 0
    s_nop 0
    s_nop 0
    s_nop 0
    s_nop 0
    v_max3_f32 v206, v250, v202, v203
    v_max3_f32 v206, v206, v204, v205
    v_max3_f32 v206, v206, v162, v163
    v_max3_f32 v206, v206, v164, v165
    v_mov_b32_dpp v207, v251 quad_perm:[0,1,2,3] row_mask:0x1 bank_mask:0xf
    s_nop 0
    s_nop 0
    v_mov_b32_dpp v207, v243 quad_perm:[0,1,2,3] row_mask:0x2 bank_mask:0xf
    v_mfma_f32_16x16x32_f16 v[122:125], v[214:217], v[138:141], v[54:57]
    v_mfma_f32_16x16x32_bf16 v[138:141], a[240:243], v[230:233], 0
    v_mov_b32_dpp v207, v159 quad_perm:[0,1,2,3] row_mask:0x4 bank_mask:0xf
    v_mov_b32 v237, v207
    v_mfma_f32_16x16x32_bf16 v[138:141], a[244:247], v[154:157], v[138:141]
    v_mfma_f32_16x16x32_bf16 v[138:141], a[248:251], v[166:169], v[138:141]
    v_max_f32_dpp v237, v237, v237 quad_perm:[1,0,3,2] row_mask:0xf bank_mask:0xf
    v_mfma_f32_16x16x16_f16 v[122:125], v[240:241], v[126:127], v[122:125]
    v_mfma_f32_16x16x32_bf16 v[138:141], a[252:255], v[174:177], v[138:141]
    v_max_f32_dpp v237, v237, v237 quad_perm:[2,3,0,1] row_mask:0xf bank_mask:0xf
    v_mfma_f32_16x16x32_bf16 v[138:141], v[82:85], v[186:189], v[138:141]
    v_mfma_f32_16x16x32_bf16 v[138:141], v[86:89], v[194:197], v[138:141]
    v_max_f32_dpp v237, v237, v237 row_half_mirror row_mask:0xf bank_mask:0xf
    s_nop 0
    s_nop 0
    v_max_f32_dpp v237, v237, v237 row_mirror row_mask:0xf bank_mask:0xf
    v_max3_f32 v206, v206, v122, v123
    v_max3_f32 v206, v206, v124, v125
    v_mov_b32 v126, v206
    v_mov_b32 v127, v237
    v_fmac_f32 v171, v138, v138
    v_permlane32_swap_b32 v206, v126
    v_max_f32 v206, v206, v126
    v_mov_b32 v126, v206
    v_fmac_f32 v171, v139, v139
    v_fmac_f32 v171, v140, v140
    v_permlane16_swap_b32 v206, v126
    v_max_f32 v206, v206, v126
    v_sub_f32 v202, v202, v206
    v_exp_f32 v202, v202
    v_sub_f32 v203, v203, v206
    v_exp_f32 v203, v203
    v_sub_f32 v204, v204, v206
    v_cvt_pk_bf16_f32 v202, v202, v203
    v_exp_f32 v204, v204
    v_sub_f32 v205, v205, v206
    v_exp_f32 v205, v205
    v_sub_f32 v162, v162, v206
    v_cvt_pk_bf16_f32 v203, v204, v205
    v_exp_f32 v162, v162
    v_sub_f32 v163, v163, v206
    v_exp_f32 v163, v163
    v_sub_f32 v164, v164, v206
    v_cvt_pk_bf16_f32 v204, v162, v163
    v_mfma_f32_16x16x32_bf16 v[218:221], v[90:93], v[230:233], 0
    ds_read_b128 v[230:233], v132 offset:0
    v_sub_f32 v165, v165, v206
    v_mfma_f32_16x16x32_bf16 v[218:221], v[94:97], v[154:157], v[218:221]
    ds_read_b128 v[154:157], v132 offset:2048
    v_sub_f32 v122, v122, v206
    v_mfma_f32_16x16x32_bf16 v[218:221], v[98:101], v[166:169], v[218:221]
    ds_read_b128 v[166:169], v132 offset:4096
    v_sub_f32 v123, v123, v206
    v_mfma_f32_16x16x32_bf16 v[218:221], v[102:105], v[174:177], v[218:221]
    ds_read_b128 v[174:177], v132 offset:6144
    v_sub_f32 v124, v124, v206
    v_mfma_f32_16x16x32_bf16 v[218:221], v[106:109], v[186:189], v[218:221]
    ds_read_b128 v[186:189], v132 offset:8192
    v_sub_f32 v125, v125, v206
    v_mfma_f32_16x16x32_bf16 v[218:221], v[110:113], v[194:197], v[218:221]
    ds_read_b128 v[194:197], v132 offset:10240
    v_exp_f32 v164, v164
    v_exp_f32 v165, v165
    v_exp_f32 v122, v122
    v_cvt_pk_bf16_f32 v205, v164, v165
    v_exp_f32 v123, v123
    v_exp_f32 v124, v124
    v_cvt_pk_bf16_f32 v36, v122, v123
    v_exp_f32 v125, v125
    v_sub_f32 v250, v250, v206
    v_mfma_f32_16x16x32_f16 v[162:165], v[150:153], v[142:145], v[58:61]
    v_cvt_pk_bf16_f32 v37, v124, v125
    v_exp_f32 v250, v250
    v_fmac_f32 v171, v141, v141
    v_cvt_pk_bf16_f32 v39, v250, 0
    v_fmac_f32 v171, v218, v218
    v_fmac_f32 v171, v219, v219
    v_mfma_f32_16x16x16_f16 v[162:165], v[128:129], v[190:191], v[162:165]
    v_fmac_f32 v171, v220, v220
    v_fmac_f32 v171, v221, v221
    v_permlane32_swap_b32 v237, v127
    v_max_f32 v237, v237, v127
    v_mfma_f32_16x16x32_bf16 v[122:125], v[28:31], v[36:39], 0
    s_waitcnt lgkmcnt(0)
    v_mov_b32 v127, v237
    v_mfma_f32_16x16x32_bf16 v[122:125], v[28:31], v[202:205], v[122:125]
    v_max3_f32 v206, v242, v162, v163
    v_permlane16_swap_b32 v237, v127
    v_max_f32 v237, v237, v127
    v_sub_f32 v207, v207, v237
    v_exp_f32 v207, v207
    v_max3_f32 v206, v206, v164, v165
    v_cvt_pk_bf16_f32 v207, v207, v207
    ds_write_b16 v8, v207
    v_mfma_f32_16x16x32_bf16 v[246:249], v[222:225], v[36:39], 0
    v_rcp_f32 v123, v122
    v_mfma_f32_16x16x32_bf16 v[246:249], v[146:149], v[202:205], v[246:249]
    s_nop 0
    s_nop 0
    s_nop 0
    s_nop 0
    s_nop 0
    s_nop 0
    s_nop 0
    s_nop 0
    v_mul_f32 v246, v123, v246
    v_mul_f32 v247, v123, v247
    v_cvt_pk_bf16_f32 v246, v246, v247
    v_mul_f32 v248, v123, v248
    v_mul_f32 v249, v123, v249
    v_cvt_pk_bf16_f32 v247, v248, v249
    v_mfma_f32_16x16x32_f16 v[250:253], v[178:181], v[142:145], v[62:65]
    s_nop 0
    s_nop 0
    s_nop 0
    s_nop 0
    s_nop 0
    s_nop 0
    v_mfma_f32_16x16x16_f16 v[250:253], v[192:193], v[190:191], v[250:253]
    s_nop 0
    s_nop 0
    s_nop 0
    s_nop 0
    s_nop 0
    s_nop 0
    s_nop 0
    s_nop 0
    v_max3_f32 v206, v206, v250, v251
    v_max3_f32 v206, v206, v252, v253
    v_mfma_f32_16x16x32_f16 v[124:127], v[214:217], v[142:145], v[66:69]
    s_nop 0
    s_nop 0
    s_nop 0
    s_nop 0
    s_nop 0
    s_nop 0
    v_mfma_f32_16x16x16_f16 v[124:127], v[240:241], v[190:191], v[124:127]
    s_nop 0
    s_nop 0
    s_nop 0
    s_nop 0
    s_nop 0
    s_nop 0
    s_nop 0
    s_nop 0
    v_max3_f32 v206, v206, v124, v125
    v_max3_f32 v206, v206, v126, v127
    v_mov_b32 v122, v206
    s_nop 0
    s_nop 0
    v_permlane32_swap_b32 v206, v122
    v_max_f32 v206, v206, v122
    v_mov_b32 v122, v206
    s_nop 0
    s_nop 0
    v_permlane16_swap_b32 v206, v122
    v_max_f32 v206, v206, v122
    v_sub_f32 v162, v162, v206
    v_exp_f32 v162, v162
    v_sub_f32 v163, v163, v206
    v_exp_f32 v163, v163
    v_sub_f32 v164, v164, v206
    v_cvt_pk_bf16_f32 v142, v162, v163
    v_exp_f32 v164, v164
    v_sub_f32 v165, v165, v206
    v_exp_f32 v165, v165
    v_sub_f32 v250, v250, v206
    v_cvt_pk_bf16_f32 v143, v164, v165
    v_exp_f32 v250, v250
    v_sub_f32 v251, v251, v206
    v_exp_f32 v251, v251
    v_sub_f32 v252, v252, v206
    v_cvt_pk_bf16_f32 v144, v250, v251
    v_exp_f32 v252, v252
    v_sub_f32 v253, v253, v206
    v_exp_f32 v253, v253
    v_sub_f32 v124, v124, v206
    v_cvt_pk_bf16_f32 v145, v252, v253
    v_mfma_f32_16x16x32_bf16 v[162:165], v[226:229], v[36:39], 0
    v_exp_f32 v124, v124
    v_mfma_f32_16x16x32_bf16 v[162:165], v[118:121], v[202:205], v[162:165]
    v_sub_f32 v125, v125, v206
    v_exp_f32 v125, v125
    v_sub_f32 v126, v126, v206
    v_exp_f32 v126, v126
    v_sub_f32 v127, v127, v206
    v_exp_f32 v127, v127
    v_sub_f32 v242, v242, v206
    v_exp_f32 v242, v242
    v_mul_f32 v162, v123, v162
    v_mul_f32 v163, v123, v163
    v_cvt_pk_bf16_f32 v248, v162, v163
    v_mul_f32 v164, v123, v164
    v_mul_f32 v165, v123, v165
    v_cvt_pk_bf16_f32 v249, v164, v165
    ds_write_b128 v3, v[246:249] offset:0
    v_mfma_f32_16x16x32_bf16 v[162:165], v[210:213], v[36:39], 0
    v_cvt_pk_bf16_f32 v36, v124, v125
    v_cvt_pk_bf16_f32 v37, v126, v127
    v_mfma_f32_16x16x32_bf16 v[162:165], v[182:185], v[202:205], v[162:165]
    v_cvt_pk_bf16_f32 v39, v242, 0
    v_mfma_f32_16x16x32_f16 v[202:205], v[150:153], v[134:137], v[70:73]
    ds_read_b128 v[150:153], v9
    ds_read_b128 v[242:245], v9 offset:64
    v_mfma_f32_16x16x32_f16 v[246:249], v[178:181], v[134:137], v[74:77]
    v_mfma_f32_16x16x32_f16 v[178:181], v[214:217], v[134:137], v[78:81]
    v_mfma_f32_16x16x32_bf16 v[134:137], v[28:31], v[36:39], 0
    v_mfma_f32_16x16x32_bf16 v[134:137], v[28:31], v[142:145], v[134:137]
    v_mul_f32 v162, v123, v162
    v_mul_f32 v163, v123, v163
    v_cvt_pk_bf16_f32 v130, v162, v163
    v_mfma_f32_16x16x16_f16 v[202:205], v[128:129], v[238:239], v[202:205]
    v_mul_f32 v164, v123, v164
    v_mul_f32 v165, v123, v165
    v_cvt_pk_bf16_f32 v131, v164, v165
    v_mfma_f32_16x16x16_f16 v[246:249], v[192:193], v[238:239], v[246:249]
    v_rcp_f32 v135, v134
    v_mfma_f32_16x16x16_f16 v[178:181], v[240:241], v[238:239], v[178:181]
    ds_write_b64 v4, v[130:131] offset:4096
    v_mfma_f32_16x16x32_bf16 v[122:125], v[222:225], v[36:39], 0
    s_waitcnt lgkmcnt(1)
    v_max3_f32 v237, v158, v202, v203
    v_max3_f32 v237, v237, v204, v205
    v_mfma_f32_16x16x32_bf16 v[122:125], v[146:149], v[142:145], v[122:125]
    v_max3_f32 v237, v237, v246, v247
    v_max3_f32 v237, v237, v248, v249
    v_mfma_f32_16x16x32_bf16 v[126:129], v[226:229], v[36:39], 0
    v_max3_f32 v237, v237, v178, v179
    v_max3_f32 v237, v237, v180, v181
    v_mfma_f32_16x16x32_bf16 v[126:129], v[118:121], v[142:145], v[126:129]
    v_mov_b32 v130, v237
    v_mfma_f32_16x16x32_bf16 v[162:165], v[210:213], v[36:39], 0
    v_mul_f32 v122, v135, v122
    v_mul_f32 v123, v135, v123
    v_mfma_f32_16x16x32_bf16 v[162:165], v[182:185], v[142:145], v[162:165]
    v_cvt_pk_bf16_f32 v122, v122, v123
    v_mul_f32 v124, v135, v124
    v_mfma_f32_16x16x32_bf16 v[142:145], a[216:219], v[230:233], 0
    v_mul_f32 v125, v135, v125
    v_cvt_pk_bf16_f32 v123, v124, v125
    v_mfma_f32_16x16x32_bf16 v[142:145], a[220:223], v[154:157], v[142:145]
    v_mul_f32 v126, v135, v126
    v_mul_f32 v127, v135, v127
    v_mfma_f32_16x16x32_bf16 v[142:145], a[224:227], v[166:169], v[142:145]
    v_cvt_pk_bf16_f32 v124, v126, v127
    v_mul_f32 v128, v135, v128
    v_mfma_f32_16x16x32_bf16 v[142:145], a[228:231], v[174:177], v[142:145]
    v_mul_f32 v129, v135, v129
    v_cvt_pk_bf16_f32 v125, v128, v129
    v_mfma_f32_16x16x32_bf16 v[142:145], a[232:235], v[186:189], v[142:145]
    ds_write_b128 v3, v[122:125] offset:6144
    v_mfma_f32_16x16x32_bf16 v[142:145], a[236:239], v[194:197], v[142:145]
    v_mul_f32 v162, v135, v162
    v_mul_f32 v163, v135, v163
    v_mfma_f32_16x16x32_bf16 v[122:125], a[240:243], v[230:233], 0
    v_cvt_pk_bf16_f32 v206, v162, v163
    v_mul_f32 v164, v135, v164
    v_mfma_f32_16x16x32_bf16 v[122:125], a[244:247], v[154:157], v[122:125]
    v_mul_f32 v165, v135, v165
    v_cvt_pk_bf16_f32 v207, v164, v165
    v_mfma_f32_16x16x32_bf16 v[122:125], a[248:251], v[166:169], v[122:125]
    ds_write_b64 v4, v[206:207] offset:10240
    v_mfma_f32_16x16x32_bf16 v[122:125], a[252:255], v[174:177], v[122:125]
    v_permlane32_swap_b32 v237, v130
    v_mfma_f32_16x16x32_bf16 v[122:125], v[82:85], v[186:189], v[122:125]
    v_fma_f32 v131, v142, v142, s33
    v_fmac_f32 v131, v143, v143
    v_mfma_f32_16x16x32_bf16 v[122:125], v[86:89], v[194:197], v[122:125]
    v_fmac_f32 v131, v144, v144
    v_fmac_f32 v131, v145, v145
    v_mfma_f32_16x16x32_bf16 v[126:129], v[90:93], v[230:233], 0
    v_max_f32 v237, v237, v130
    v_mov_b32 v130, v237
    v_mfma_f32_16x16x32_bf16 v[126:129], v[94:97], v[154:157], v[126:129]
    v_mfma_f32_16x16x32_bf16 v[126:129], v[98:101], v[166:169], v[126:129]
    v_permlane16_swap_b32 v237, v130
    v_mfma_f32_16x16x32_bf16 v[126:129], v[102:105], v[174:177], v[126:129]
    v_fmac_f32 v131, v122, v122
    v_fmac_f32 v131, v123, v123
    v_mfma_f32_16x16x32_bf16 v[126:129], v[106:109], v[186:189], v[126:129]
    v_fmac_f32 v131, v124, v124
    v_fmac_f32 v131, v125, v125
    v_mfma_f32_16x16x32_bf16 v[126:129], v[110:113], v[194:197], v[126:129]
    v_max_f32 v237, v237, v130
    v_sub_f32 v202, v202, v237
    v_mfma_f32_16x16x32_bf16 v[134:137], v[150:153], v[28:31], 0
    v_exp_f32 v202, v202
    v_mfma_f32_16x16x32_bf16 v[134:137], v[242:245], v[28:31], v[134:137]
    v_sub_f32 v203, v203, v237
    v_sub_f32 v204, v204, v237
    v_mfma_f32_16x16x32_bf16 v[154:157], v[150:153], v[146:149], 0
    v_fmac_f32 v131, v126, v126
    v_fmac_f32 v131, v127, v127
    v_mfma_f32_16x16x32_bf16 v[154:157], v[242:245], v[222:225], v[154:157]
    v_fmac_f32 v131, v128, v128
    v_fmac_f32 v131, v129, v129
    v_mfma_f32_16x16x32_bf16 v[162:165], v[150:153], v[118:121], 0
    v_cvt_pk_bf16_f32 v130, v171, v131
    v_cvt_pk_bf16_f32 v131, v131, v131
    v_mfma_f32_16x16x32_bf16 v[162:165], v[242:245], v[226:229], v[162:165]
    ds_write_b64 v255, v[130:131] offset:2048
    v_mfma_f32_16x16x32_bf16 v[166:169], v[150:153], v[182:185], 0
    v_rcp_f32_dpp v135, v134 quad_perm:[0,0,0,0] row_mask:0xf bank_mask:0xf
    v_mfma_f32_16x16x32_bf16 v[166:169], v[242:245], v[210:213], v[166:169]
    v_mul_f32 v154, v154, v135
    v_exp_f32 v203, v203
    v_exp_f32 v204, v204
    v_cvt_pk_bf16_f32 v134, v202, v203
    v_mul_f32_dpp v154, v162, v135 quad_perm:[0,1,2,3] row_mask:0x2 bank_mask:0xf
    v_sub_f32 v205, v205, v237
    v_exp_f32 v205, v205
    v_sub_f32 v246, v246, v237
    v_mul_f32_dpp v154, v166, v135 quad_perm:[0,1,2,3] row_mask:0x4 bank_mask:0xf
    v_cvt_pk_bf16_f32 v154, v154, v154
    ds_write_b16 v7, v154
    v_cvt_pk_bf16_f32 v135, v204, v205
    v_exp_f32 v246, v246
    s_waitcnt lgkmcnt(1)
    s_barrier
    ds_read_b128 v[150:153], v133 offset:2048
    ds_read_b128 v[154:157], v133 offset:3072
    ds_read_b128 v[162:165], v172 offset:0
    ds_read_b128 v[166:169], v172 offset:1024
    ds_read_b128 v[174:177], v172 offset:2048
    ds_read_b128 v[186:189], v172 offset:3072
    ds_read_b128 v[190:193], v172 offset:4096
    ds_read_b128 v[194:197], v172 offset:5120
    v_sub_f32 v247, v247, v237
    v_exp_f32 v247, v247
    v_sub_f32 v248, v248, v237
    v_cvt_pk_bf16_f32 v136, v246, v247
    v_exp_f32 v248, v248
    s_waitcnt lgkmcnt(6)
    v_mfma_f32_16x16x32_bf16 v[202:205], v[32:35], v[150:153], 0
    s_waitcnt lgkmcnt(5)
    v_sub_f32 v249, v249, v237
    v_sub_f32 v178, v178, v237
    v_mfma_f32_16x16x32_bf16 v[202:205], v[32:35], v[154:157], v[202:205]
    s_waitcnt lgkmcnt(4)
    v_exp_f32 v249, v249
    v_mfma_f32_16x16x32_bf16 v[150:153], a[216:219], v[162:165], 0
    s_waitcnt lgkmcnt(3)
    v_cvt_pk_bf16_f32 v137, v248, v249
    v_sub_f32 v179, v179, v237
    v_mfma_f32_16x16x32_bf16 v[150:153], a[220:223], v[166:169], v[150:153]
    s_waitcnt lgkmcnt(2)
    v_mul_f32 v171, 0x3baaaaab, v203
    v_mul_f32 v130, 0x3baaaaab, v202
    v_mfma_f32_16x16x32_bf16 v[150:153], a[224:227], v[174:177], v[150:153]
    s_waitcnt lgkmcnt(1)
    v_rsq_f32 v171, v171
    v_mfma_f32_16x16x32_bf16 v[150:153], a[228:231], v[186:189], v[150:153]
    s_waitcnt lgkmcnt(0)
    v_mul_f32 v142, v171, v142
    v_mul_f32 v143, v171, v143
    v_mfma_f32_16x16x32_bf16 v[150:153], a[232:235], v[190:193], v[150:153]
    v_cvt_pk_bf16_f32 v142, v142, v143
    v_mul_f32 v144, v171, v144
    v_mfma_f32_16x16x32_bf16 v[150:153], a[236:239], v[194:197], v[150:153]
    v_mul_f32 v145, v171, v145
    v_cvt_pk_bf16_f32 v143, v144, v145
    v_mfma_f32_16x16x32_bf16 v[154:157], a[240:243], v[162:165], 0
    v_mul_f32 v122, v171, v122
    v_mul_f32 v123, v171, v123
    v_mfma_f32_16x16x32_bf16 v[154:157], a[244:247], v[166:169], v[154:157]
    v_cvt_pk_bf16_f32 v144, v122, v123
    v_mul_f32 v124, v171, v124
    v_mfma_f32_16x16x32_bf16 v[154:157], a[248:251], v[174:177], v[154:157]
    v_mul_f32 v125, v171, v125
    v_cvt_pk_bf16_f32 v145, v124, v125
    v_mfma_f32_16x16x32_bf16 v[154:157], a[252:255], v[186:189], v[154:157]
    buffer_store_dwordx4 v[142:145], v209, s[12:15], 0 offen nt
    v_mul_f32 v126, v171, v126
    v_mul_f32 v127, v171, v127
    v_cvt_pk_bf16_f32 v160, v126, v127
    v_mul_f32 v128, v171, v128
    v_mfma_f32_16x16x32_bf16 v[154:157], v[82:85], v[190:193], v[154:157]
    v_mul_f32 v129, v171, v129
    v_cvt_pk_bf16_f32 v161, v128, v129
    v_mfma_f32_16x16x32_bf16 v[154:157], v[86:89], v[194:197], v[154:157]
    ds_read_b128 v[122:125], v172 offset:6144
    v_fma_f32 v171, v150, v150, s33
    v_mfma_f32_16x16x32_bf16 v[126:129], v[90:93], v[162:165], 0
    ds_read_b128 v[142:145], v172 offset:7168
    v_fmac_f32 v171, v151, v151
    v_mfma_f32_16x16x32_bf16 v[126:129], v[94:97], v[166:169], v[126:129]
    ds_read_b128 v[162:165], v172 offset:8192
    v_fmac_f32 v171, v152, v152
    v_mfma_f32_16x16x32_bf16 v[126:129], v[98:101], v[174:177], v[126:129]
    ds_read_b128 v[166:169], v172 offset:9216
    v_fmac_f32 v171, v153, v153
    v_mfma_f32_16x16x32_bf16 v[126:129], v[102:105], v[186:189], v[126:129]
    ds_read_b128 v[174:177], v172 offset:10240
    v_fmac_f32 v171, v154, v154
    v_mfma_f32_16x16x32_bf16 v[126:129], v[106:109], v[190:193], v[126:129]
    ds_read_b128 v[186:189], v172 offset:11264
    v_fmac_f32 v171, v155, v155
    v_mfma_f32_16x16x32_bf16 v[126:129], v[110:113], v[194:197], v[126:129]
    v_fmac_f32 v171, v156, v156
    v_fmac_f32 v171, v157, v157
    v_rsq_f32 v130, v130
    s_waitcnt lgkmcnt(5)
    v_mfma_f32_16x16x32_bf16 v[190:193], a[216:219], v[122:125], 0
    v_mul_f32 v114, v130, v114
    v_mul_f32 v115, v130, v115
    v_mfma_f32_16x16x32_bf16 v[194:197], a[240:243], v[122:125], 0
    s_waitcnt lgkmcnt(4)
    v_fmac_f32 v171, v126, v126
    v_fmac_f32 v171, v127, v127
    v_mfma_f32_16x16x32_bf16 v[190:193], a[220:223], v[142:145], v[190:193]
    s_waitcnt lgkmcnt(3)
    v_fmac_f32 v171, v128, v128
    v_fmac_f32 v171, v129, v129
    v_mfma_f32_16x16x32_bf16 v[190:193], a[224:227], v[162:165], v[190:193]
    s_waitcnt lgkmcnt(2)
    v_cvt_pk_bf16_f32 v114, v114, v115
    v_mul_f32 v116, v130, v116
    v_mfma_f32_16x16x32_bf16 v[190:193], a[228:231], v[166:169], v[190:193]
    s_waitcnt lgkmcnt(1)
    v_mul_f32 v117, v130, v117
    v_cvt_pk_bf16_f32 v115, v116, v117
    v_mfma_f32_16x16x32_bf16 v[190:193], a[232:235], v[174:177], v[190:193]
    s_waitcnt lgkmcnt(0)
    v_mul_f32 v138, v130, v138
    v_mul_f32 v139, v130, v139
    v_mfma_f32_16x16x32_bf16 v[190:193], a[236:239], v[186:189], v[190:193]
    buffer_store_dwordx2 v[160:161], v208, s[12:15], 0 offen nt
    v_cvt_pk_bf16_f32 v116, v138, v139
    v_mul_f32 v140, v130, v140
    v_mfma_f32_16x16x32_bf16 v[194:197], a[244:247], v[142:145], v[194:197]
    v_mul_f32 v141, v130, v141
    v_cvt_pk_bf16_f32 v117, v140, v141
    v_mfma_f32_16x16x32_bf16 v[194:197], a[248:251], v[162:165], v[194:197]
    v_mul_f32 v218, v130, v218
    v_fma_f32 v131, v190, v190, s33
    v_mfma_f32_16x16x32_bf16 v[194:197], a[252:255], v[166:169], v[194:197]
    v_fmac_f32 v131, v191, v191
    v_fmac_f32 v131, v192, v192
    v_mfma_f32_16x16x32_bf16 v[194:197], v[82:85], v[174:177], v[194:197]
    v_fmac_f32 v131, v193, v193
    v_mul_f32 v219, v130, v219
    v_mfma_f32_16x16x32_bf16 v[194:197], v[86:89], v[186:189], v[194:197]
    v_cvt_pk_bf16_f32 v160, v218, v219
    v_mul_f32 v220, v130, v220
    v_mfma_f32_16x16x32_bf16 v[138:141], v[90:93], v[122:125], 0
    v_mul_f32 v221, v130, v221
    v_cvt_pk_bf16_f32 v161, v220, v221
    v_mfma_f32_16x16x32_bf16 v[138:141], v[94:97], v[142:145], v[138:141]
    v_exp_f32 v178, v178
    v_mfma_f32_16x16x32_bf16 v[138:141], v[98:101], v[162:165], v[138:141]
    v_fmac_f32 v131, v194, v194
    v_fmac_f32 v131, v195, v195
    v_mfma_f32_16x16x32_bf16 v[138:141], v[102:105], v[166:169], v[138:141]
    v_fmac_f32 v131, v196, v196
    v_fmac_f32 v131, v197, v197
    v_mfma_f32_16x16x32_bf16 v[138:141], v[106:109], v[174:177], v[138:141]
    v_exp_f32 v179, v179
    v_mfma_f32_16x16x32_bf16 v[138:141], v[110:113], v[186:189], v[138:141]
    v_cvt_pk_bf16_f32 v36, v178, v179
    v_sub_f32 v180, v180, v237
    v_exp_f32 v180, v180
    v_sub_f32 v181, v181, v237
    v_exp_f32 v181, v181
    v_sub_f32 v158, v158, v237
    v_cvt_pk_bf16_f32 v37, v180, v181
    v_exp_f32 v158, v158
    v_fmac_f32 v131, v138, v138
    v_fmac_f32 v131, v139, v139
    v_fmac_f32 v131, v140, v140
    v_fmac_f32 v131, v141, v141
    v_cvt_pk_bf16_f32 v130, v171, v131
    v_cvt_pk_bf16_f32 v131, v131, v131
    ds_write_b64 v255, v[130:131] offset:7616
    buffer_store_dwordx4 v[114:117], v17, s[52:55], 0 offen nt
    v_cvt_pk_bf16_f32 v39, v158, 0
    s_nop 0
    s_nop 0
    v_mfma_f32_16x16x32_bf16 v[114:117], v[28:31], v[36:39], 0
    v_mfma_f32_16x16x32_bf16 v[114:117], v[28:31], v[134:137], v[114:117]
    v_mfma_f32_16x16x32_bf16 v[122:125], v[222:225], v[36:39], 0
    v_mfma_f32_16x16x32_bf16 v[122:125], v[146:149], v[134:137], v[122:125]
    v_mfma_f32_16x16x32_bf16 v[142:145], v[226:229], v[36:39], 0
    v_mfma_f32_16x16x32_bf16 v[142:145], v[118:121], v[134:137], v[142:145]
    v_mfma_f32_16x16x32_bf16 v[118:121], v[210:213], v[36:39], 0
    v_mfma_f32_16x16x32_bf16 v[118:121], v[182:185], v[134:137], v[118:121]
    s_nop 0
    s_nop 0
    v_rcp_f32 v115, v114
    s_nop 0
    v_mul_f32 v122, v115, v122
    v_mul_f32 v123, v115, v123
    v_cvt_pk_bf16_f32 v122, v122, v123
    v_mul_f32 v124, v115, v124
    v_mul_f32 v125, v115, v125
    v_cvt_pk_bf16_f32 v123, v124, v125
    v_mul_f32 v142, v115, v142
    v_mul_f32 v143, v115, v143
    v_cvt_pk_bf16_f32 v124, v142, v143
    v_mul_f32 v144, v115, v144
    v_mul_f32 v145, v115, v145
    v_cvt_pk_bf16_f32 v125, v144, v145
    ds_write_b128 v3, v[122:125] offset:12288
    v_mul_f32 v118, v115, v118
    v_mul_f32 v119, v115, v119
    v_cvt_pk_bf16_f32 v130, v118, v119
    v_mul_f32 v120, v115, v120
    v_mul_f32 v121, v115, v121
    v_cvt_pk_bf16_f32 v131, v120, v121
    buffer_store_dwordx2 v[160:161], v20, s[52:55], 0 offen nt
    ds_write_b64 v4, v[130:131] offset:16384
    s_waitcnt lgkmcnt(0)
    s_barrier
    ds_read_b128 v[114:117], v133 offset:7616
    ds_read_b128 v[118:121], v133 offset:8640
    ds_read_b128 v[122:125], v172 offset:12288
    ds_read_b128 v[134:137], v172 offset:13312
    ds_read_b128 v[142:145], v172 offset:14336
    ds_read_b128 v[146:149], v172 offset:15360
    ds_read_b128 v[158:161], v172 offset:16384
    ds_read_b128 v[162:165], v172 offset:17408
    s_waitcnt lgkmcnt(7)
    v_mfma_f32_16x16x32_bf16 v[166:169], v[32:35], v[114:117], 0
    s_waitcnt lgkmcnt(6)
    v_mfma_f32_16x16x32_bf16 v[166:169], v[32:35], v[118:121], v[166:169]
    s_waitcnt lgkmcnt(4)
    v_mfma_f32_16x16x32_bf16 v[114:117], a[216:219], v[122:125], 0
    s_waitcnt lgkmcnt(3)
    v_mfma_f32_16x16x32_bf16 v[114:117], a[220:223], v[134:137], v[114:117]
    s_waitcnt lgkmcnt(2)
    v_mfma_f32_16x16x32_bf16 v[114:117], a[224:227], v[142:145], v[114:117]
    s_waitcnt lgkmcnt(1)
    v_mfma_f32_16x16x32_bf16 v[114:117], a[228:231], v[146:149], v[114:117]
    s_waitcnt lgkmcnt(0)
    v_mul_f32 v171, 0x3baaaaab, v166
    v_mul_f32 v237, 0x3baaaaab, v167
    v_mfma_f32_16x16x32_bf16 v[114:117], a[232:235], v[158:161], v[114:117]
    v_rsq_f32 v171, v171
    v_mfma_f32_16x16x32_bf16 v[114:117], a[236:239], v[162:165], v[114:117]
    v_mul_f32 v150, v171, v150
    v_mul_f32 v151, v171, v151
    v_mfma_f32_16x16x32_bf16 v[118:121], a[240:243], v[122:125], 0
    v_cvt_pk_bf16_f32 v150, v150, v151
    v_mul_f32 v152, v171, v152
    v_mfma_f32_16x16x32_bf16 v[118:121], a[244:247], v[134:137], v[118:121]
    v_mul_f32 v153, v171, v153
    v_cvt_pk_bf16_f32 v151, v152, v153
    v_mfma_f32_16x16x32_bf16 v[118:121], a[248:251], v[142:145], v[118:121]
    v_fma_f32 v130, v114, v114, s33
    v_fmac_f32 v130, v115, v115
    v_mfma_f32_16x16x32_bf16 v[118:121], a[252:255], v[146:149], v[118:121]
    v_fmac_f32 v130, v116, v116
    v_fmac_f32 v130, v117, v117
    v_mfma_f32_16x16x32_bf16 v[118:121], v[82:85], v[158:161], v[118:121]
    v_mul_f32 v154, v171, v154
    v_mul_f32 v155, v171, v155
    v_mfma_f32_16x16x32_bf16 v[118:121], v[86:89], v[162:165], v[118:121]
    ds_read_b128 v[166:169], v132 offset:256
    v_cvt_pk_bf16_f32 v152, v154, v155
    v_mfma_f32_16x16x32_bf16 v[174:177], v[90:93], v[122:125], 0
    ds_read_b128 v[122:125], v132 offset:2304
    v_mul_f32 v156, v171, v156
    v_mfma_f32_16x16x32_bf16 v[174:177], v[94:97], v[134:137], v[174:177]
    ds_read_b128 v[134:137], v132 offset:4352
    v_mul_f32 v157, v171, v157
    v_mfma_f32_16x16x32_bf16 v[174:177], v[98:101], v[142:145], v[174:177]
    ds_read_b128 v[142:145], v132 offset:6400
    v_fmac_f32 v130, v118, v118
    v_mfma_f32_16x16x32_bf16 v[174:177], v[102:105], v[146:149], v[174:177]
    ds_read_b128 v[146:149], v132 offset:8448
    v_fmac_f32 v130, v119, v119
    v_mfma_f32_16x16x32_bf16 v[174:177], v[106:109], v[158:161], v[174:177]
    ds_read_b128 v[158:161], v132 offset:10496
    v_fmac_f32 v130, v120, v120
    v_mfma_f32_16x16x32_bf16 v[174:177], v[110:113], v[162:165], v[174:177]
    v_fmac_f32 v130, v121, v121
    v_cvt_pk_bf16_f32 v153, v156, v157
    buffer_store_dwordx4 v[150:153], v15, s[56:59], 0 offen nt
    s_waitcnt lgkmcnt(5)
    v_mul_f32 v126, v171, v126
    v_mul_f32 v127, v171, v127
    v_cvt_pk_bf16_f32 v126, v126, v127
    v_mfma_f32_16x16x32_bf16 v[150:153], a[216:219], v[166:169], 0
    s_waitcnt lgkmcnt(4)
    v_fmac_f32 v130, v174, v174
    v_fmac_f32 v130, v175, v175
    v_mfma_f32_16x16x32_bf16 v[150:153], a[220:223], v[122:125], v[150:153]
    s_waitcnt lgkmcnt(3)
    v_fmac_f32 v130, v176, v176
    v_fmac_f32 v130, v177, v177
    v_mfma_f32_16x16x32_bf16 v[150:153], a[224:227], v[134:137], v[150:153]
    s_waitcnt lgkmcnt(2)
    v_cvt_pk_bf16_f32 v154, v130, v130
    v_cvt_pk_bf16_f32 v155, v130, v130
    v_mfma_f32_16x16x32_bf16 v[150:153], a[228:231], v[142:145], v[150:153]
    s_waitcnt lgkmcnt(1)
    ds_write_b64 v255, v[154:155] offset:9664
    v_mfma_f32_16x16x32_bf16 v[150:153], a[232:235], v[146:149], v[150:153]
    s_waitcnt lgkmcnt(1)
    v_mul_f32 v128, v171, v128
    v_mul_f32 v129, v171, v129
    v_mfma_f32_16x16x32_bf16 v[150:153], a[236:239], v[158:161], v[150:153]
    v_rsq_f32 v237, v237
    v_mfma_f32_16x16x32_bf16 v[154:157], a[240:243], v[166:169], 0
    v_cvt_pk_bf16_f32 v127, v128, v129
    v_mul_f32 v190, v237, v190
    v_mfma_f32_16x16x32_bf16 v[154:157], a[244:247], v[122:125], v[154:157]
    v_mul_f32 v191, v237, v191
    v_cvt_pk_bf16_f32 v162, v190, v191
    v_mfma_f32_16x16x32_bf16 v[154:157], a[248:251], v[134:137], v[154:157]
    v_fma_f32 v171, v150, v150, s33
    v_fmac_f32 v171, v151, v151
    v_mfma_f32_16x16x32_bf16 v[154:157], a[252:255], v[142:145], v[154:157]
    v_fmac_f32 v171, v152, v152
    v_fmac_f32 v171, v153, v153
    v_mfma_f32_16x16x32_bf16 v[154:157], v[82:85], v[146:149], v[154:157]
    v_mul_f32 v192, v237, v192
    v_mul_f32 v193, v237, v193
    v_mfma_f32_16x16x32_bf16 v[154:157], v[86:89], v[158:161], v[154:157]
    v_cvt_pk_bf16_f32 v163, v192, v193
    v_mul_f32 v194, v237, v194
    v_mfma_f32_16x16x32_bf16 v[178:181], v[90:93], v[166:169], 0
    v_mul_f32 v195, v237, v195
    v_cvt_pk_bf16_f32 v164, v194, v195
    v_mfma_f32_16x16x32_bf16 v[178:181], v[94:97], v[122:125], v[178:181]
    v_mul_f32 v196, v237, v196
    v_mul_f32 v197, v237, v197
    v_mfma_f32_16x16x32_bf16 v[178:181], v[98:101], v[134:137], v[178:181]
    buffer_store_dwordx2 v[126:127], v18, s[56:59], 0 offen nt
    v_fmac_f32 v171, v154, v154
    v_fmac_f32 v171, v155, v155
    v_mfma_f32_16x16x32_bf16 v[178:181], v[102:105], v[142:145], v[178:181]
    v_fmac_f32 v171, v156, v156
    v_fmac_f32 v171, v157, v157
    v_mfma_f32_16x16x32_bf16 v[178:181], v[106:109], v[146:149], v[178:181]
    v_cvt_pk_bf16_f32 v165, v196, v197
    v_mul_f32 v138, v237, v138
    v_mfma_f32_16x16x32_bf16 v[178:181], v[110:113], v[158:161], v[178:181]
    ds_write_b128 v173, v[162:165] offset:1536
    v_mul_f32 v139, v237, v139
    v_cvt_pk_bf16_f32 v130, v138, v139
    v_mul_f32 v140, v237, v140
    v_mul_f32 v141, v237, v141
    v_cvt_pk_bf16_f32 v131, v140, v141
    s_nop 0
    s_nop 0
    v_fmac_f32 v171, v178, v178
    v_fmac_f32 v171, v179, v179
    v_fmac_f32 v171, v180, v180
    v_fmac_f32 v171, v181, v181
    v_cvt_pk_bf16_f32 v122, v171, v171
    v_cvt_pk_bf16_f32 v123, v171, v171
    ds_write_b64 v255, v[122:123] offset:15232
    ds_read_b128 v[122:125], v199 offset:1536
    ds_write_b64 v198, v[130:131] offset:2560
    ds_read_b64 v[130:131], v254 offset:2560
    s_waitcnt lgkmcnt(3)
    s_barrier
    ds_read_b128 v[126:129], v133 offset:9664
    ds_read_b128 v[134:137], v133 offset:10688
    ds_read_b128 v[138:141], v133 offset:15232
    ds_read_b128 v[142:145], v133 offset:16256
    ds_read_b128 v[146:149], v172 offset:18432
    s_waitcnt lgkmcnt(6)
    buffer_store_dwordx4 v[122:125], v200, s[56:59], 0 offen nt
    s_waitcnt lgkmcnt(5)
    s_waitcnt lgkmcnt(4)
    v_mfma_f32_16x16x32_bf16 v[158:161], v[32:35], v[126:129], 0
    s_waitcnt lgkmcnt(3)
    v_mfma_f32_16x16x32_bf16 v[158:161], v[32:35], v[134:137], v[158:161]
    s_waitcnt lgkmcnt(1)
    buffer_store_dwordx2 v[130:131], v201, s[56:59], 0 offen nt
    v_mfma_f32_16x16x32_bf16 v[122:125], v[32:35], v[138:141], 0
    s_waitcnt lgkmcnt(0)
    v_or3_b32 v146, v146, v147, v148
    v_or_b32 v146, v146, v149
    v_mfma_f32_16x16x32_bf16 v[122:125], v[32:35], v[142:145], v[122:125]
    v_cmp_gt_i32 s[46:47], 0, v146
    v_mul_f32 v237, 0x3baaaaab, v158
    v_rsq_f32 v237, v237
    s_nop 0
    v_mul_f32 v114, v237, v114
    v_mul_f32 v115, v237, v115
    v_cvt_pk_bf16_f32 v114, v114, v115
    v_mul_f32 v116, v237, v116
    v_mul_f32 v115, 0x3baaaaab, v122
    v_rsq_f32 v115, v115
    v_mul_f32 v117, v237, v117
    v_mul_f32 v150, v115, v150
    v_mul_f32 v151, v115, v151
    v_cvt_pk_bf16_f32 v122, v150, v151
    v_mul_f32 v152, v115, v152
    v_mul_f32 v153, v115, v153
    v_cvt_pk_bf16_f32 v123, v152, v153
    v_mul_f32 v154, v115, v154
    v_mul_f32 v155, v115, v155
    v_cvt_pk_bf16_f32 v124, v154, v155
    v_mul_f32 v156, v115, v156
    v_mul_f32 v157, v115, v157
    v_cvt_pk_bf16_f32 v125, v156, v157
    buffer_store_dwordx4 v[122:125], v170, s[12:15], 0 offen nt
    v_mul_f32 v178, v115, v178
    v_mul_f32 v179, v115, v179
    v_cvt_pk_bf16_f32 v200, v178, v179
    v_mul_f32 v180, v115, v180
    v_mul_f32 v181, v115, v181
    v_cvt_pk_bf16_f32 v201, v180, v181
    v_cvt_pk_bf16_f32 v115, v116, v117
    v_mul_f32 v118, v237, v118
    v_mul_f32 v119, v237, v119
    v_cvt_pk_bf16_f32 v116, v118, v119
    v_mul_f32 v120, v237, v120
    v_mul_f32 v121, v237, v121
    v_cvt_pk_bf16_f32 v117, v120, v121
    ds_write_b128 v173, v[114:117] offset:3072
    v_mul_f32 v174, v237, v174
    v_mul_f32 v175, v237, v175
    v_cvt_pk_bf16_f32 v174, v174, v175
    v_mul_f32 v176, v237, v176
    v_mul_f32 v177, v237, v177
    v_cvt_pk_bf16_f32 v175, v176, v177
    buffer_store_dwordx2 v[200:201], v236, s[12:15], 0 offen nt
    ds_read_b128 v[114:117], v199 offset:3072
    ds_write_b64 v198, v[174:175] offset:4096
    ds_read_b64 v[236:237], v254 offset:4096
    s_waitcnt lgkmcnt(2)
    buffer_store_dwordx4 v[114:117], v234, s[56:59], 0 offen nt
    s_waitcnt lgkmcnt(0)
    buffer_store_dwordx2 v[236:237], v235, s[56:59], 0 offen nt
    s_branch L_end
L_drain:
    ds_read_b128 v[118:121], v2 offset:18432
    ds_read_b128 v[122:125], v2 offset:19456
    s_nop 3
    ds_read_b128 v[134:137], v2 offset:0
    s_mul_i32 s5, s16, 9408
    s_mov_b32 s12, s40
    ds_read_b128 v[138:141], v2 offset:1024
    s_mov_b32 s13, s41
    s_cmp_ge_u32 s18, 2
    s_cselect_b32 s14, s36, 0
    ds_read_b128 v[142:145], v2 offset:2048
    s_add_u32 s5, s5, 104448
    s_and_b32 s6, s2, 7
    s_sub_u32 s6, 0, s6
    ds_read_b128 v[146:149], v2 offset:3072
    s_lshl_b32 s3, s16, 6
    s_lshl_b32 s4, s16, 5
    s_add_u32 s4, s4, 256
    ds_read_b128 v[150:153], v2 offset:4096
    ds_read_b128 v[162:165], v2 offset:5120
    v_bfe_u32 v254, v2, 4, 6
    v_lshrrev_b32 v255, 4, v254
    v_and_b32 v166, 15, v254
    v_lshlrev_b32 v167, 9, v255
    v_lshl_add_u32 v167, v166, 4, v167
    v_add_u32 v167, 149696, v167
    s_waitcnt lgkmcnt(7)
    v_mfma_f32_16x16x32_bf16 v[170:173], v[32:35], v[118:121], 0
    s_waitcnt lgkmcnt(5)
    v_xor_b32 v168, 65536, v2
    v_bfe_u32 v169, v166, 1, 2
    v_mfma_f32_16x16x32_bf16 v[170:173], v[32:35], v[122:125], v[170:173]
    s_waitcnt lgkmcnt(4)
    v_xor_b32 v169, v169, v255
    v_lshl_add_u32 v169, v166, 2, v169
    v_lshl_add_u32 v118, v169, 4, s5
    v_mfma_f32_16x16x32_bf16 v[122:125], a[216:219], v[134:137], 0
    s_waitcnt lgkmcnt(3)
    v_lshl_add_u32 v119, v169, 3, s5
    v_lshl_add_u32 v120, v254, 4, s5
    v_lshl_add_u32 v121, v254, 3, s5
    v_mfma_f32_16x16x32_bf16 v[122:125], a[220:223], v[138:141], v[122:125]
    s_waitcnt lgkmcnt(2)
    v_lshlrev_b32 v169, 2, v169
    v_mul_f32 v170, 0x3baaaaab, v170
    v_rsq_f32 v170, v170
    v_mfma_f32_16x16x32_bf16 v[122:125], a[224:227], v[142:145], v[122:125]
    s_waitcnt lgkmcnt(0)
    ds_permute_b32 v173, v169, v15
    ds_permute_b32 v174, v169, v18
    v_mul_f32 v178, v170, v178
    v_mfma_f32_16x16x32_bf16 v[122:125], a[228:231], v[146:149], v[122:125]
    ds_permute_b32 v175, v169, v16
    ds_permute_b32 v176, v169, v19
    v_mul_f32 v179, v170, v179
    v_mfma_f32_16x16x32_bf16 v[122:125], a[232:235], v[150:153], v[122:125]
    ds_permute_b32 v177, v169, v17
    ds_permute_b32 v182, v169, v20
    v_cvt_pk_bf16_f32 v178, v178, v179
    v_mfma_f32_16x16x32_bf16 v[122:125], a[236:239], v[162:165], v[122:125]
    v_mul_f32 v180, v170, v180
    v_mul_f32 v181, v170, v181
    v_cvt_pk_bf16_f32 v179, v180, v181
    v_mfma_f32_16x16x32_bf16 v[186:189], a[240:243], v[134:137], 0
    v_mul_f32 v198, v170, v198
    v_mul_f32 v199, v170, v199
    v_cvt_pk_bf16_f32 v180, v198, v199
    v_mfma_f32_16x16x32_bf16 v[186:189], a[244:247], v[138:141], v[186:189]
    v_mul_f32 v200, v170, v200
    v_mul_f32 v201, v170, v201
    v_cvt_pk_bf16_f32 v181, v200, v201
    v_mfma_f32_16x16x32_bf16 v[186:189], a[248:251], v[142:145], v[186:189]
    s_waitcnt lgkmcnt(4)
    ds_read_b128 v[190:193], v2 offset:6144
    v_mul_f32 v206, v170, v206
    v_mul_f32 v207, v170, v207
    v_mfma_f32_16x16x32_bf16 v[186:189], a[252:255], v[146:149], v[186:189]
    s_waitcnt lgkmcnt(3)
    ds_read_b128 v[194:197], v2 offset:7168
    v_cvt_pk_bf16_f32 v184, v206, v207
    v_mul_f32 v208, v170, v208
    v_mfma_f32_16x16x32_bf16 v[186:189], v[82:85], v[150:153], v[186:189]
    s_waitcnt lgkmcnt(2)
    ds_read_b128 v[198:201], v2 offset:8192
    v_mul_f32 v209, v170, v209
    v_cvt_pk_bf16_f32 v185, v208, v209
    v_mfma_f32_16x16x32_bf16 v[186:189], v[86:89], v[162:165], v[186:189]
    ds_read_b128 v[202:205], v2 offset:9216
    v_fma_f32 v169, v122, v122, s33
    v_fmac_f32 v169, v123, v123
    v_mfma_f32_16x16x32_bf16 v[206:209], v[90:93], v[134:137], 0
    ds_read_b128 v[134:137], v2 offset:10240
    v_fmac_f32 v169, v124, v124
    v_fmac_f32 v169, v125, v125
    v_mfma_f32_16x16x32_bf16 v[206:209], v[94:97], v[138:141], v[206:209]
    ds_read_b128 v[138:141], v2 offset:11264
    v_fmac_f32 v169, v186, v186
    v_fmac_f32 v169, v187, v187
    v_mfma_f32_16x16x32_bf16 v[206:209], v[98:101], v[142:145], v[206:209]
    s_waitcnt lgkmcnt(5)
    buffer_store_dwordx4 v[178:181], v15, s[12:15], s27 offen nt
    v_fmac_f32 v169, v188, v188
    v_fmac_f32 v169, v189, v189
    v_mul_f32 v183, 0x3baaaaab, v171
    v_mfma_f32_16x16x32_bf16 v[206:209], v[102:105], v[146:149], v[206:209]
    s_waitcnt lgkmcnt(4)
    v_rsq_f32 v183, v183
    v_sub_u32 v170, 0x40800000, v44
    v_mfma_f32_16x16x32_bf16 v[206:209], v[106:109], v[150:153], v[206:209]
    s_waitcnt lgkmcnt(3)
    v_mul_f32 v130, v183, v130
    v_mul_f32 v131, v183, v131
    v_cvt_pk_bf16_f32 v130, v130, v131
    v_mfma_f32_16x16x32_bf16 v[206:209], v[110:113], v[162:165], v[206:209]
    s_waitcnt lgkmcnt(2)
    v_mul_f32 v132, v183, v132
    v_mul_f32 v133, v183, v133
    v_cvt_pk_bf16_f32 v131, v132, v133
    v_mfma_f32_16x16x32_bf16 v[142:145], a[216:219], v[190:193], 0
    s_waitcnt lgkmcnt(1)
    v_mul_f32 v126, v183, v126
    v_mul_f32 v127, v183, v127
    v_fmac_f32 v169, v206, v206
    v_mfma_f32_16x16x32_bf16 v[142:145], a[220:223], v[194:197], v[142:145]
    s_waitcnt lgkmcnt(0)
    v_fmac_f32 v169, v207, v207
    v_fmac_f32 v169, v208, v208
    v_fmac_f32 v169, v209, v209
    v_mfma_f32_16x16x32_bf16 v[142:145], a[224:227], v[198:201], v[142:145]
    v_cvt_pk_bf16_f32 v132, v126, v127
    v_mul_f32 v128, v183, v128
    v_mul_f32 v129, v183, v129
    v_mfma_f32_16x16x32_bf16 v[142:145], a[228:231], v[202:205], v[142:145]
    v_cvt_pk_bf16_f32 v133, v128, v129
    v_mul_f32 v114, v183, v114
    v_mul_f32 v115, v183, v115
    v_mfma_f32_16x16x32_bf16 v[142:145], a[232:235], v[134:137], v[142:145]
    v_cvt_pk_bf16_f32 v114, v114, v115
    v_mul_f32 v116, v183, v116
    v_mul_f32 v117, v183, v117
    v_mfma_f32_16x16x32_bf16 v[142:145], a[236:239], v[138:141], v[142:145]
    v_cvt_pk_bf16_f32 v115, v116, v117
    v_or_b32 v170, v170, v44
    v_lshl_add_u32 v171, s16, 2, v168
    v_mfma_f32_16x16x32_bf16 v[126:129], a[240:243], v[190:193], 0
    ds_write_b32 v171, v170 offset:18432
    v_mul_f32 v183, 0x3baaaaab, v172
    v_mfma_f32_16x16x32_bf16 v[126:129], a[244:247], v[194:197], v[126:129]
    v_rsq_f32 v183, v183
    v_fma_f32 v116, v142, v142, s33
    v_mfma_f32_16x16x32_bf16 v[126:129], a[248:251], v[198:201], v[126:129]
    ds_read_b128 v[146:149], v2 offset:12288
    v_fmac_f32 v116, v143, v143
    v_fmac_f32 v116, v144, v144
    v_mfma_f32_16x16x32_bf16 v[126:129], a[252:255], v[202:205], v[126:129]
    ds_read_b128 v[150:153], v2 offset:13312
    v_fmac_f32 v116, v145, v145
    v_mul_f32 v242, v183, v242
    v_mfma_f32_16x16x32_bf16 v[126:129], v[82:85], v[134:137], v[126:129]
    ds_read_b128 v[162:165], v2 offset:14336
    v_mul_f32 v243, v183, v243
    v_cvt_pk_bf16_f32 v178, v242, v243
    v_mfma_f32_16x16x32_bf16 v[126:129], v[86:89], v[138:141], v[126:129]
    ds_read_b128 v[210:213], v2 offset:15360
    v_mul_f32 v244, v183, v244
    v_mul_f32 v245, v183, v245
    v_mfma_f32_16x16x32_bf16 v[214:217], v[90:93], v[190:193], 0
    ds_read_b128 v[190:193], v2 offset:16384
    v_cvt_pk_bf16_f32 v179, v244, v245
    v_mul_f32 v158, v183, v158
    v_mfma_f32_16x16x32_bf16 v[214:217], v[94:97], v[194:197], v[214:217]
    ds_read_b128 v[194:197], v2 offset:17408
    v_fmac_f32 v116, v126, v126
    v_fmac_f32 v116, v127, v127
    v_mfma_f32_16x16x32_bf16 v[214:217], v[98:101], v[198:201], v[214:217]
    s_waitcnt lgkmcnt(5)
    buffer_store_dwordx2 v[184:185], v18, s[12:15], s27 offen nt
    v_fmac_f32 v116, v128, v128
    v_mfma_f32_16x16x32_bf16 v[214:217], v[102:105], v[202:205], v[214:217]
    s_waitcnt lgkmcnt(4)
    v_fmac_f32 v116, v129, v129
    v_mul_f32 v159, v183, v159
    v_cvt_pk_bf16_f32 v180, v158, v159
    v_mfma_f32_16x16x32_bf16 v[214:217], v[106:109], v[134:137], v[214:217]
    s_waitcnt lgkmcnt(3)
    v_mul_f32 v160, v183, v160
    v_mul_f32 v161, v183, v161
    v_cvt_pk_bf16_f32 v181, v160, v161
    v_mfma_f32_16x16x32_bf16 v[214:217], v[110:113], v[138:141], v[214:217]
    s_waitcnt lgkmcnt(2)
    ds_write_b128 v118, v[178:181] offset:3072
    v_mfma_f32_16x16x32_bf16 v[134:137], a[216:219], v[146:149], 0
    s_waitcnt lgkmcnt(2)
    v_mul_f32 v154, v183, v154
    v_mul_f32 v155, v183, v155
    v_cvt_pk_bf16_f32 v154, v154, v155
    v_mfma_f32_16x16x32_bf16 v[134:137], a[220:223], v[150:153], v[134:137]
    s_waitcnt lgkmcnt(1)
    v_fmac_f32 v116, v214, v214
    v_fmac_f32 v116, v215, v215
    v_fmac_f32 v116, v216, v216
    v_mfma_f32_16x16x32_bf16 v[134:137], a[224:227], v[162:165], v[134:137]
    ds_read_b128 v[138:141], v120 offset:3072
    v_fmac_f32 v116, v217, v217
    v_cvt_pk_bf16_f32 v184, v169, v116
    v_mfma_f32_16x16x32_bf16 v[134:137], a[228:231], v[210:213], v[134:137]
    v_cvt_pk_bf16_f32 v185, v116, v116
    v_mul_f32 v156, v183, v156
    v_mul_f32 v157, v183, v157
    v_mfma_f32_16x16x32_bf16 v[134:137], a[232:235], v[190:193], v[134:137]
    ds_write_b64 v4, v[184:185] offset:0
    v_mfma_f32_16x16x32_bf16 v[134:137], a[236:239], v[194:197], v[134:137]
    v_cvt_pk_bf16_f32 v155, v156, v157
    v_mov_b32 v169, 0x40000000
    v_lshrrev_b32 v116, 2, v254
    v_mfma_f32_16x16x32_bf16 v[158:161], a[240:243], v[146:149], 0
    ds_write_b64 v119, v[154:155] offset:4096
    v_mfma_f32_16x16x32_bf16 v[158:161], a[244:247], v[150:153], v[158:161]
    v_lshrrev_b32 v117, 3, v254
    v_xor_b32 v117, v117, v254
    v_fma_f32 v254, v134, v134, s33
    v_mfma_f32_16x16x32_bf16 v[158:161], a[248:251], v[162:165], v[158:161]
    s_waitcnt lgkmcnt(2)
    ds_read_b128 v[154:157], v167 offset:0
    ds_read_b64 v[170:171], v121 offset:4096
    v_fmac_f32 v254, v135, v135
    v_mfma_f32_16x16x32_bf16 v[158:161], a[252:255], v[210:213], v[158:161]
    ds_read_b128 v[178:181], v167 offset:2048
    v_fmac_f32 v254, v136, v136
    v_fmac_f32 v254, v137, v137
    v_mfma_f32_16x16x32_bf16 v[158:161], v[82:85], v[190:193], v[158:161]
    s_waitcnt lgkmcnt(4)
    ds_read_b128 v[198:201], v167 offset:4096
    v_and_b32 v117, 3, v117
    v_add_u32 v116, 0, v116
    v_mfma_f32_16x16x32_bf16 v[158:161], v[86:89], v[194:197], v[158:161]
    s_barrier
    ds_read_b128 v[202:205], v168 offset:0
    ds_read_b128 v[218:221], v168 offset:1024
    v_mul_u32_u24 v172, s20, v116
    v_mfma_f32_16x16x32_bf16 v[222:225], v[90:93], v[146:149], 0
    ds_read_b128 v[146:149], v167 offset:6144
    ds_read_b128 v[226:229], v167 offset:8192
    v_add_u32 v172, s38, v172
    v_mfma_f32_16x16x32_bf16 v[222:225], v[94:97], v[150:153], v[222:225]
    ds_read_b128 v[150:153], v167 offset:10240
    v_fmac_f32 v254, v158, v158
    v_fmac_f32 v254, v159, v159
    v_mfma_f32_16x16x32_bf16 v[222:225], v[98:101], v[162:165], v[222:225]
    s_waitcnt lgkmcnt(7)
    buffer_store_dwordx4 v[130:133], v16, s[12:15], s27 offen nt
    ds_read_b128 v[162:165], v168 offset:18432
    v_fmac_f32 v254, v160, v160
    v_fmac_f32 v254, v161, v161
    v_mfma_f32_16x16x32_bf16 v[222:225], v[102:105], v[210:213], v[222:225]
    s_waitcnt lgkmcnt(7)
    v_mul_u32_u24 v183, 911, v172
    v_lshrrev_b32 v183, 16, v183
    v_mul_u32_u24 v183, s22, v183
    v_mfma_f32_16x16x32_bf16 v[222:225], v[106:109], v[190:193], v[222:225]
    s_waitcnt lgkmcnt(6)
    v_mad_u32_u24 v183, v116, s21, v183
    v_bfe_u32 v172, s70, v116, 1
    v_cmp_ne_u32 vcc, 0, v172
    v_mfma_f32_16x16x32_bf16 v[222:225], v[110:113], v[194:197], v[222:225]
    s_waitcnt lgkmcnt(4)
    v_add_u32 v116, s7, v183
    v_cndmask_b32 v116, v169, v116, vcc
    v_mfma_f32_16x16x32_bf16 v[130:133], v[32:35], v[202:205], 0
    s_waitcnt lgkmcnt(2)
    v_lshl_add_u32 v172, v117, 4, v116
    v_add_u32 v172, s3, v172
    v_mfma_f32_16x16x32_bf16 v[130:133], v[32:35], v[218:221], v[130:133]
    s_waitcnt lgkmcnt(1)
    v_fmac_f32 v254, v222, v222
    v_fmac_f32 v254, v223, v223
    v_fmac_f32 v254, v224, v224
    v_mfma_f32_16x16x32_bf16 v[190:193], a[216:219], v[154:157], 0
    v_fmac_f32 v254, v225, v225
    v_cvt_pk_bf16_f32 v184, v254, v254
    v_cvt_pk_bf16_f32 v185, v254, v254
    v_mfma_f32_16x16x32_bf16 v[190:193], a[220:223], v[178:181], v[190:193]
    s_waitcnt lgkmcnt(0)
    ds_write_b64 v4, v[184:185] offset:2048
    v_mfma_f32_16x16x32_bf16 v[190:193], a[224:227], v[198:201], v[190:193]
    v_lshl_add_u32 v254, v117, 3, v116
    v_add_u32 v254, s4, v254
    v_add_u32 v166, 16, v166
    v_mfma_f32_16x16x32_bf16 v[190:193], a[228:231], v[146:149], v[190:193]
    v_min_u32 v116, 20, v166
    v_add_u32 v132, 12, v166
    v_lshrrev_b32 v132, 5, v132
    v_mfma_f32_16x16x32_bf16 v[190:193], a[232:235], v[226:229], v[190:193]
    v_sub_u32 v133, v166, v116
    v_mad_i32_i24 v133, v132, s6, v133
    v_mul_u32_u24 v117, s20, v116
    v_mfma_f32_16x16x32_bf16 v[190:193], a[236:239], v[150:153], v[190:193]
    v_add3_u32 v117, v117, v133, s38
    v_mul_u32_u24 v132, 911, v117
    v_lshrrev_b32 v132, 16, v132
    v_mfma_f32_16x16x32_bf16 v[194:197], a[240:243], v[154:157], 0
    v_mul_u32_u24 v132, s22, v132
    v_mad_u32_u24 v132, v116, s21, v132
    v_bfe_u32 v117, s70, v166, 1
    v_mfma_f32_16x16x32_bf16 v[194:197], a[244:247], v[178:181], v[194:197]
    buffer_store_dwordx2 v[114:115], v19, s[12:15], s27 offen nt
    v_fma_f32 v166, v190, v190, s33
    v_mfma_f32_16x16x32_bf16 v[194:197], a[248:251], v[198:201], v[194:197]
    ds_read_b128 v[202:205], v167 offset:256
    v_fmac_f32 v166, v191, v191
    v_fmac_f32 v166, v192, v192
    v_mfma_f32_16x16x32_bf16 v[194:197], a[252:255], v[146:149], v[194:197]
    ds_read_b128 v[210:213], v167 offset:2304
    v_fmac_f32 v166, v193, v193
    v_cmp_ne_u32 vcc, 0, v117
    v_mfma_f32_16x16x32_bf16 v[194:197], v[82:85], v[226:229], v[194:197]
    ds_read_b128 v[114:117], v167 offset:4352
    v_mul_i32_i24 v133, 2688, v133
    v_add3_u32 v132, v132, v133, s7
    v_mfma_f32_16x16x32_bf16 v[194:197], v[86:89], v[150:153], v[194:197]
    ds_read_b128 v[218:221], v167 offset:6400
    v_cndmask_b32 v132, v169, v132, vcc
    v_lshl_add_u32 v169, v255, 4, v132
    v_mfma_f32_16x16x32_bf16 v[230:233], v[90:93], v[154:157], 0
    ds_read_b128 v[154:157], v167 offset:8448
    v_add_u32 v169, s3, v169
    v_lshl_add_u32 v255, v255, 3, v132
    v_mfma_f32_16x16x32_bf16 v[230:233], v[94:97], v[178:181], v[230:233]
    ds_read_b128 v[178:181], v167 offset:10496
    v_fmac_f32 v166, v194, v194
    v_fmac_f32 v166, v195, v195
    v_mfma_f32_16x16x32_bf16 v[230:233], v[98:101], v[198:201], v[230:233]
    s_waitcnt lgkmcnt(5)
    v_fmac_f32 v166, v196, v196
    v_fmac_f32 v166, v197, v197
    v_add_u32 v255, s4, v255
    v_mfma_f32_16x16x32_bf16 v[230:233], v[102:105], v[146:149], v[230:233]
    s_waitcnt lgkmcnt(4)
    v_mul_f32 v167, 0x3baaaaab, v130
    v_mul_f32 v183, 0x3baaaaab, v131
    v_rsq_f32 v167, v167
    v_mfma_f32_16x16x32_bf16 v[230:233], v[106:109], v[226:229], v[230:233]
    s_waitcnt lgkmcnt(3)
    v_mul_f32 v122, v167, v122
    v_mul_f32 v123, v167, v123
    v_cvt_pk_bf16_f32 v122, v122, v123
    v_mfma_f32_16x16x32_bf16 v[230:233], v[110:113], v[150:153], v[230:233]
    s_waitcnt lgkmcnt(2)
    v_mul_f32 v124, v167, v124
    v_mul_f32 v125, v167, v125
    v_cvt_pk_bf16_f32 v123, v124, v125
    v_mfma_f32_16x16x32_bf16 v[130:133], a[216:219], v[202:205], 0
    s_waitcnt lgkmcnt(1)
    v_mul_f32 v186, v167, v186
    v_mul_f32 v187, v167, v187
    v_fmac_f32 v166, v230, v230
    v_mfma_f32_16x16x32_bf16 v[130:133], a[220:223], v[210:213], v[130:133]
    s_waitcnt lgkmcnt(0)
    v_fmac_f32 v166, v231, v231
    v_fmac_f32 v166, v232, v232
    v_fmac_f32 v166, v233, v233
    v_mfma_f32_16x16x32_bf16 v[130:133], a[224:227], v[114:117], v[130:133]
    buffer_store_dwordx4 v[138:141], v177, s[12:15], s27 offen nt
    v_cvt_pk_bf16_f32 v184, v166, v166
    v_cvt_pk_bf16_f32 v185, v166, v166
    v_cvt_pk_bf16_f32 v124, v186, v187
    v_mfma_f32_16x16x32_bf16 v[130:133], a[228:231], v[218:221], v[130:133]
    ds_write_b64 v4, v[184:185] offset:4096
    v_mfma_f32_16x16x32_bf16 v[130:133], a[232:235], v[154:157], v[130:133]
    v_mul_f32 v188, v167, v188
    v_mul_f32 v189, v167, v189
    v_cvt_pk_bf16_f32 v125, v188, v189
    v_mfma_f32_16x16x32_bf16 v[130:133], a[236:239], v[178:181], v[130:133]
    ds_write_b128 v118, v[122:125] offset:4608
    v_mfma_f32_16x16x32_bf16 v[122:125], a[240:243], v[202:205], 0
    buffer_store_dwordx2 v[170:171], v182, s[12:15], s27 offen nt
    v_mul_f32 v206, v167, v206
    v_mfma_f32_16x16x32_bf16 v[122:125], a[244:247], v[210:213], v[122:125]
    s_mov_b32 s14, s36
    v_mul_f32 v207, v167, v207
    v_cvt_pk_bf16_f32 v166, v206, v207
    v_fma_f32 v184, v130, v130, s33
    v_mfma_f32_16x16x32_bf16 v[122:125], a[248:251], v[114:117], v[122:125]
    ds_read_b128 v[138:141], v120 offset:4608
    v_fmac_f32 v184, v131, v131
    v_fmac_f32 v184, v132, v132
    v_mfma_f32_16x16x32_bf16 v[122:125], a[252:255], v[218:221], v[122:125]
    s_waitcnt lgkmcnt(2)
    v_fmac_f32 v184, v133, v133
    v_mul_f32 v208, v167, v208
    v_mul_f32 v209, v167, v209
    v_mfma_f32_16x16x32_bf16 v[122:125], v[82:85], v[154:157], v[122:125]
    s_barrier
    ds_read_b128 v[146:149], v168 offset:2048
    ds_read_b128 v[150:153], v168 offset:3072
    v_cvt_pk_bf16_f32 v167, v208, v209
    v_mfma_f32_16x16x32_bf16 v[122:125], v[86:89], v[178:181], v[122:125]
    ds_read_b128 v[186:189], v168 offset:4096
    ds_read_b128 v[198:201], v168 offset:5120
    v_rsq_f32 v183, v183
    v_mfma_f32_16x16x32_bf16 v[206:209], v[90:93], v[202:205], 0
    ds_write_b64 v119, v[166:167] offset:5632
    v_mfma_f32_16x16x32_bf16 v[206:209], v[94:97], v[210:213], v[206:209]
    v_mul_f32 v142, v183, v142
    v_mul_f32 v143, v183, v143
    v_fmac_f32 v184, v122, v122
    v_mfma_f32_16x16x32_bf16 v[206:209], v[98:101], v[114:117], v[206:209]
    s_waitcnt lgkmcnt(5)
    buffer_store_dwordx4 v[138:141], v173, s[12:15], s26 offen nt
    ds_read_b64 v[166:167], v121 offset:5632
    v_fmac_f32 v184, v123, v123
    v_fmac_f32 v184, v124, v124
    v_mfma_f32_16x16x32_bf16 v[206:209], v[102:105], v[218:221], v[206:209]
    v_fmac_f32 v184, v125, v125
    v_cvt_pk_bf16_f32 v114, v142, v143
    v_mul_f32 v144, v183, v144
    v_mfma_f32_16x16x32_bf16 v[206:209], v[106:109], v[154:157], v[206:209]
    s_waitcnt lgkmcnt(4)
    v_mul_f32 v145, v183, v145
    v_cvt_pk_bf16_f32 v115, v144, v145
    v_mfma_f32_16x16x32_bf16 v[138:141], v[32:35], v[146:149], 0
    s_waitcnt lgkmcnt(2)
    v_mul_f32 v126, v183, v126
    v_mul_f32 v127, v183, v127
    v_mfma_f32_16x16x32_bf16 v[138:141], v[32:35], v[150:153], v[138:141]
    v_cvt_pk_bf16_f32 v116, v126, v127
    v_mul_f32 v128, v183, v128
    v_mfma_f32_16x16x32_bf16 v[142:145], v[32:35], v[186:189], 0
    v_mul_f32 v129, v183, v129
    v_cvt_pk_bf16_f32 v117, v128, v129
    v_mfma_f32_16x16x32_bf16 v[142:145], v[32:35], v[198:201], v[142:145]
    ds_write_b128 v118, v[114:117] offset:6144
    v_mfma_f32_16x16x32_bf16 v[206:209], v[110:113], v[178:181], v[206:209]
    s_waitcnt lgkmcnt(1)
    buffer_store_dwordx2 v[166:167], v174, s[12:15], s26 offen nt
    v_mul_f32 v214, v183, v214
    v_mul_f32 v215, v183, v215
    v_cvt_pk_bf16_f32 v166, v214, v215
    ds_read_b128 v[114:117], v120 offset:6144
    v_mul_f32 v216, v183, v216
    v_mul_f32 v217, v183, v217
    v_fmac_f32 v184, v206, v206
    v_fmac_f32 v184, v207, v207
    v_fmac_f32 v184, v208, v208
    v_fmac_f32 v184, v209, v209
    v_cvt_pk_bf16_f32 v214, v184, v184
    v_cvt_pk_bf16_f32 v215, v184, v184
    ds_write_b64 v4, v[214:215] offset:6144
    v_cvt_pk_bf16_f32 v167, v216, v217
    v_mul_f32 v174, 0x3baaaaab, v138
    v_rsq_f32 v174, v174
    ds_write_b64 v119, v[166:167] offset:7168
    v_mul_f32 v134, v174, v134
    v_mul_f32 v135, v174, v135
    v_cvt_pk_bf16_f32 v126, v134, v135
    ds_read_b64 v[166:167], v121 offset:7168
    s_waitcnt lgkmcnt(3)
    buffer_store_dwordx4 v[114:117], v175, s[12:15], s26 offen nt
    v_mul_f32 v136, v174, v136
    v_mul_f32 v137, v174, v137
    v_cvt_pk_bf16_f32 v127, v136, v137
    v_mul_f32 v158, v174, v158
    v_mul_f32 v159, v174, v159
    v_cvt_pk_bf16_f32 v128, v158, v159
    v_mul_f32 v160, v174, v160
    s_waitcnt lgkmcnt(2)
    s_barrier
    ds_read_b128 v[114:117], v168 offset:6144
    ds_read_b128 v[134:137], v168 offset:7168
    v_mul_f32 v161, v174, v161
    v_cvt_pk_bf16_f32 v129, v160, v161
    ds_write_b128 v118, v[126:129] offset:0
    v_mul_f32 v222, v174, v222
    v_mul_f32 v223, v174, v223
    v_cvt_pk_bf16_f32 v222, v222, v223
    v_mul_f32 v224, v174, v224
    s_waitcnt lgkmcnt(3)
    buffer_store_dwordx2 v[166:167], v176, s[12:15], s26 offen nt
    ds_read_b128 v[126:129], v120 offset:0
    v_mul_f32 v225, v174, v225
    v_cvt_pk_bf16_f32 v223, v224, v225
    ds_write_b64 v119, v[222:223] offset:1024
    s_waitcnt lgkmcnt(4)
    v_mfma_f32_16x16x32_bf16 v[138:141], v[32:35], v[114:117], 0
    s_waitcnt lgkmcnt(3)
    v_mul_f32 v166, 0x3baaaaab, v142
    v_or3_b32 v162, v162, v163, v164
    v_mfma_f32_16x16x32_bf16 v[138:141], v[32:35], v[134:137], v[138:141]
    ds_read_b64 v[170:171], v121 offset:1024
    v_rsq_f32 v166, v166
    v_or_b32 v162, v162, v165
    v_mul_f32 v190, v166, v190
    v_mul_f32 v191, v166, v191
    v_cvt_pk_bf16_f32 v114, v190, v191
    v_mul_f32 v192, v166, v192
    v_mul_f32 v193, v166, v193
    v_cvt_pk_bf16_f32 v115, v192, v193
    v_mul_f32 v194, v166, v194
    v_mul_f32 v195, v166, v195
    v_cvt_pk_bf16_f32 v116, v194, v195
    s_waitcnt lgkmcnt(2)
    buffer_store_dwordx4 v[126:129], v177, s[12:15], s26 offen nt
    v_mul_f32 v196, v166, v196
    v_mul_f32 v197, v166, v197
    v_cvt_pk_bf16_f32 v117, v196, v197
    ds_write_b128 v118, v[114:117] offset:1536
    v_mul_f32 v230, v166, v230
    s_waitcnt lgkmcnt(1)
    v_mul_f32 v231, v166, v231
    v_cvt_pk_bf16_f32 v230, v230, v231
    v_mul_f32 v232, v166, v232
    v_mul_f32 v233, v166, v233
    buffer_store_dwordx2 v[170:171], v182, s[12:15], s26 offen nt
    ds_read_b128 v[114:117], v120 offset:1536
    v_cvt_pk_bf16_f32 v231, v232, v233
    ds_write_b64 v119, v[230:231] offset:2560
    v_mul_f32 v163, 0x3baaaaab, v138
    v_rsq_f32 v163, v163
    ds_read_b64 v[164:165], v121 offset:2560
    v_mul_f32 v130, v163, v130
    v_mul_f32 v131, v163, v131
    v_cvt_pk_bf16_f32 v118, v130, v131
    v_mul_f32 v132, v163, v132
    v_mul_f32 v133, v163, v133
    v_cvt_pk_bf16_f32 v119, v132, v133
    v_mul_f32 v122, v163, v122
    v_mul_f32 v123, v163, v123
    v_cvt_pk_bf16_f32 v120, v122, v123
    v_mul_f32 v124, v163, v124
    v_mul_f32 v125, v163, v125
    v_cvt_pk_bf16_f32 v121, v124, v125
    buffer_store_dwordx4 v[118:121], v169, s[12:15], 0 offen nt
    s_waitcnt lgkmcnt(2)
    v_mul_f32 v206, v163, v206
    v_mul_f32 v207, v163, v207
    v_cvt_pk_bf16_f32 v170, v206, v207
    v_mul_f32 v208, v163, v208
    v_mul_f32 v209, v163, v209
    v_cvt_pk_bf16_f32 v171, v208, v209
    v_cmp_gt_i32 s[46:47], 0, v162
    s_waitcnt lgkmcnt(0)
    buffer_store_dwordx4 v[114:117], v172, s[12:15], 0 offen nt
    buffer_store_dwordx2 v[164:165], v254, s[12:15], 0 offen nt
    buffer_store_dwordx2 v[170:171], v255, s[12:15], 0 offen nt
    s_branch L_end
.section .rodata,"a"
.p2align 6
.amdhsa_kernel standalone__window_attn_swin_v2__vision_kernel
  .amdhsa_next_free_vgpr 512
  .amdhsa_next_free_sgpr 102
  .amdhsa_accum_offset 256
  .amdhsa_group_segment_fixed_size 0
  .amdhsa_kernarg_size 96
  .amdhsa_user_sgpr_count 2
  .amdhsa_user_sgpr_kernarg_segment_ptr 1
  .amdhsa_system_sgpr_workgroup_id_x 1
  .amdhsa_float_denorm_mode_32 3
.end_amdhsa_kernel
```

```asm
; @launch grid=(256,1,1) block=(256,1,1) lds=163840
.amdgcn_target "amdgcn-amd-amdhsa--gfx950"
.text
.globl standalone__window_attn_swin_v2__vision_kernel
.p2align 12
.p2align 8
.type standalone__window_attn_swin_v2__vision_kernel,@function
standalone__window_attn_swin_v2__vision_kernel:
    s_mov_b32 s44, 0
L_again:
    s_load_dwordx16 s[76:91], s[0:1], 0
    v_readfirstlane_b32 s16, v0
    s_cmp_ge_u32 s2, 256
    s_cbranch_scc1 L_done
    s_lshr_b32 s16, s16, 6
    s_cbranch_scc1 L_nopf
    s_getpc_b64 s[96:97]
    s_bfe_u32 s3, s2, 0x30003
    s_mul_i32 s3, s3, 44
    v_cmp_gt_u32 vcc, 20, v0
    v_add_u32 v162, s3, v0
    v_mov_b32 v163, 0
    v_cndmask_b32 v162, v162, v0, vcc
    v_lshlrev_b32 v162, 7, v162
    v_lshl_add_u64 v[162:163], s[96:97], 0, v[162:163]
    global_load_dword a255, v[162:163], off offset:992
L_nopf:
    s_max_u32 s3, s2, s44
    s_cmp_ge_u32 s3, 247
    s_cbranch_scc1 L_edge
    v_mov_b32 v162, v0
    v_mov_b32 v163, 0x40000000
    v_and_b32 v254, 63, v0
    s_bfe_u32 s3, s2, 0x50003
    s_lshl_b32 s4, s16, 3
    s_lshr_b32 s98, 0x06143a01, s4
    s_and_b32 s98, s98, 0xff
    s_mul_i32 s3, s3, s98
    s_sub_u32 s98, s98, 1
    s_lshr_b32 s4, 0x0048d800, s4
    s_and_b32 s4, s4, 0xff
    s_lshl_b32 s4, s4, 3
    s_max_u32 s4, s4, 6
    s_sub_u32 s4, s4, s98
    s_sub_u32 s4, s4, 1
    s_min_u32 s3, s3, s4
    v_min_u32 v122, s98, v254
    v_add_lshl_u32 v122, v122, s3, 7
    v_mov_b32 v123, 0
    v_lshrrev_b32 v255, 4, v254
    v_and_b32 v124, 15, v254
    s_mov_b32 s10, 100270464
    s_mov_b32 s11, 0x00020000
    s_mov_b32 s50, 36096
    s_mov_b32 s51, 0x00020000
    s_mul_i32 s3, s16, 96
    v_lshl_add_u32 v125, v254, 4, s3
    v_mul_u32_u24 v126, 171, v254
    v_lshrrev_b32 v126, 10, v126
    v_lshrrev_b32 v127, 1, v126
    v_xor_b32 v127, v127, v126
    v_and_b32 v127, 4, v127
    v_mul_u32_u24 v127, 3, v127
    v_xor_b32 v127, v127, v126
    v_mul_u32_u24 v127, 1152, v127
    v_mul_u32_u24 v128, 96, v126
    v_sub_u32 v127, v127, v128
    v_add_u32 v128, v125, v127
    v_add_u32 v127, 64, v254
    v_mul_u32_u24 v127, 171, v127
    v_lshrrev_b32 v127, 10, v127
    v_lshrrev_b32 v129, 1, v127
    v_xor_b32 v129, v129, v127
    v_and_b32 v129, 4, v129
    v_mul_u32_u24 v129, 3, v129
    v_xor_b32 v129, v129, v127
    v_mul_u32_u24 v129, 1152, v129
    v_mul_u32_u24 v134, 96, v127
    v_sub_u32 v129, v129, v134
    v_add_u32 v134, v125, v129
    v_add_u32 v129, 128, v254
    v_mul_u32_u24 v129, 171, v129
    v_lshrrev_b32 v129, 10, v129
    v_lshrrev_b32 v135, 1, v129
    v_xor_b32 v135, v135, v129
    v_and_b32 v135, 4, v135
    v_mul_u32_u24 v135, 3, v135
    v_xor_b32 v135, v135, v129
    v_mul_u32_u24 v135, 1152, v135
    v_mul_u32_u24 v136, 96, v129
    v_sub_u32 v135, v135, v136
    v_add_u32 v136, v125, v135
    s_mul_i32 s68, s16, 6144
    s_add_u32 s69, s68, 65536
    s_cmp_eq_u32 s16, 3
    s_cselect_b32 s68, 149696, s68
    s_cselect_b32 s69, 155840, s69
    s_waitcnt lgkmcnt(0)
    s_cmp_eq_u32 s16, 2
    s_cselect_b64 s[98:99], s[80:81], s[78:79]
    s_cmp_eq_u32 s16, 3
    s_cselect_b64 s[98:99], s[88:89], s[98:99]
    s_mov_b64 s[8:9], s[76:77]
    v_lshl_add_u64 v[122:123], s[98:99], 0, v[122:123]
    s_cmp_eq_u32 s16, 2
    s_cselect_b64 s[98:99], s[84:85], s[82:83]
    s_cmp_eq_u32 s16, 3
    s_cselect_b64 s[98:99], s[86:87], s[98:99]
    v_writelane_b32 v122, s98, 63
    v_writelane_b32 v123, s99, 63
    s_cmp_eq_u32 s16, 0
    s_cbranch_scc1 L_nowu
    global_load_dword a254, v[122:123], off
L_nowu:
    s_mov_b64 s[48:49], s[78:79]
    s_mov_b64 s[52:53], s[80:81]
    s_mov_b64 s[60:61], s[84:85]
    s_mov_b64 s[64:65], s[86:87]
    s_mov_b64 s[56:57], s[88:89]
    s_mov_b64 s[46:47], s[82:83]
    s_load_dwordx4 s[40:43], s[0:1], 72
    s_add_u32 s48, s48, 384
    s_addc_u32 s49, s49, 0
    s_add_u32 m0, s68, 0
    v_lshlrev_b32 v135, 1, v255
    s_mov_b32 s54, 12288
    s_mov_b32 s55, 0x00020000
    s_mov_b32 s62, 64
    s_mov_b32 s63, 0x00020000
    s_mov_b32 s66, 128
    s_mov_b32 s67, 0x00020000
    s_mov_b32 s58, 676
    s_mov_b32 s59, 0x00020000
    s_mov_b32 s14, 0
    s_mov_b32 s15, 0x00020000
    s_mul_i32 s90, s16, 16
    v_mov_b32 v165, 0
    v_cmp_lt_u32 s[92:93], 7, v124
    v_mov_b32 v123, 0
    v_mov_b32 v125, 0
    v_mov_b32 v115, 0
    v_lshlrev_b32 v137, 1, v254
    v_mul_u32_u24 v122, 12, v124
    s_mul_i32 s71, s16, 192
    v_add_u32 v122, s71, v122
    v_lshlrev_b32 v116, 5, v255
    s_mul_i32 s72, s16, 9408
    s_add_u32 s72, s72, 104448
    s_mul_i32 s73, s16, 7616
    s_add_u32 s73, s73, 38912
    s_cmp_eq_u32 s16, 3
    s_cselect_b32 s73, 142080, s73
    s_mov_b32 s70, 193536
    s_mov_b32 s36, 100270464
    s_mov_b32 s22, 1180032
    s_mul_i32 s3, s2, 911
    s_lshr_b32 s3, s3, 16
    s_mul_i32 s35, s3, 72
    s_sub_u32 s38, s2, s35
    s_mul_i32 s3, s3, 1373568
    s_mul_i32 s35, s38, 2688
    s_add_u32 s3, s3, s35
    s_add_u32 s25, s3, 589824
    s_add_u32 s7, s3, 1769472
    s_mov_b32 s20, 31
    s_mov_b32 s21, 4204032
    s_mov_b32 s17, 20
    s_cmp_lt_u32 s2, 240
    s_cselect_b32 s45, 28, 24
    s_bfm_b32 s34, s45, 0
    s_and_b32 s4, s2, 7
    s_sub_u32 s4, 0, s4
    s_lshl_b32 s28, s16, 10
    s_add_u32 s28, s28, 20480
    s_mov_b32 s76, 0x3f80
    s_mul_i32 s79, s16, 64
    s_mul_i32 s80, s16, 32
    s_add_u32 s80, s80, 256
    s_mul_i32 s81, s16, 768
    s_add_u32 s81, s81, 98304
    s_mov_b32 s82, -24
    s_lshr_b32 s83, s16, 1
    s_and_b32 s84, s16, 1
    s_lshl_b32 s84, s84, 3
    s_lshl_b32 s85, s83, 10
    s_add_u32 s85, s85, s84
    s_lshl_b32 s83, s83, 11
    s_add_u32 s83, s83, s84
    s_add_u32 s83, s83, 157888
    s_mul_i32 s86, s16, 2048
    s_add_u32 s86, s86, 149696
    s_mul_i32 s87, s16, 128
    s_add_u32 s87, s87, 61760
    s_mov_b32 s32, 0x2a8cbccc
    s_mov_b32 s33, 0x38fba882
    s_add_u32 s75, s28, 16384
    s_cmp_lt_u32 s16, 2
    s_cselect_b32 s29, s75, 161984
    s_cselect_b32 s30, 65536, 0
    s_xor_b32 s74, s29, s30
    s_mul_i32 s77, s16, 64
    s_mul_i32 s78, s16, 32
    s_add_u32 s78, s78, 192
    buffer_load_dwordx4 v128, s[48:51], 0 offen lds
    v_mul_u32_u24 v164, 2731, v162
    v_bfe_u32 v114, v164, 17, 3
    v_lshrrev_b32 v164, 16, v164
    buffer_load_dwordx4 v134, s[48:51], 0 offen offset:1024 lds
    v_xor_b32 v117, v114, v162
    v_mul_u32_u24 v114, 37, v164
    v_lshrrev_b32 v114, 8, v114
    buffer_load_dwordx4 v136, s[48:51], 0 offen offset:2048 lds
    s_add_u32 m0, s28, 65536
    s_add_u32 s48, s48, 36864
    s_addc_u32 s49, s49, 0
    v_lshlrev_b32 v117, 4, v117
    v_mad_u32_u24 v10, v114, s70, v117
    v_mul_u32_u24 v114, s20, v164
    v_add_u32 v114, s38, v114
    v_mul_u32_u24 v118, 911, v114
    v_lshrrev_b32 v118, 16, v118
    v_mul_u32_u24 v118, s22, v118
    v_mad_u32_u24 v118, v164, s21, v118
    v_bfe_u32 v114, s34, v164, 1
    v_cmp_ne_u32 vcc, 0, v114
    v_add_u32 v114, s7, v118
    v_mul_u32_u24 v164, 384, v164
    v_cndmask_b32 v114, v163, v114, vcc
    v_sub_u32 v164, v117, v164
    v_add_u32 v114, v114, v164
    buffer_load_dwordx4 v114, s[8:11], 0 offen nt lds
    s_add_u32 m0, s28, 69632
    v_add_u32 v164, 256, v162
    v_mul_u32_u24 v114, 2731, v164
    v_bfe_u32 v117, v114, 17, 3
    v_lshrrev_b32 v114, 16, v114
    v_xor_b32 v164, v117, v164
    v_mul_u32_u24 v117, 37, v114
    v_lshrrev_b32 v117, 8, v117
    v_lshlrev_b32 v164, 4, v164
    v_mad_u32_u24 v11, v117, s70, v164
    v_min_u32 v117, 20, v114
    v_add_u32 v118, 12, v114
    v_lshrrev_b32 v118, 5, v118
    v_sub_u32 v119, v114, v117
    v_mad_i32_i24 v119, v118, s4, v119
    v_mul_u32_u24 v120, s20, v117
    v_add3_u32 v120, v120, v119, s38
    v_mul_u32_u24 v118, 911, v120
    v_lshrrev_b32 v118, 16, v118
    v_mul_u32_u24 v118, s22, v118
    v_mad_u32_u24 v118, v117, s21, v118
    v_bfe_u32 v120, s34, v114, 1
    v_cmp_ne_u32 vcc, 0, v120
    v_mul_i32_i24 v119, 2688, v119
    v_add3_u32 v117, v118, v119, s7
    v_cndmask_b32 v117, v163, v117, vcc
    v_mul_u32_u24 v114, 384, v114
    v_sub_u32 v114, v164, v114
    v_add_u32 v117, v117, v114
    buffer_load_dwordx4 v117, s[8:11], 0 offen lds
    s_add_u32 m0, s28, 73728
    v_add_u32 v164, 512, v162
    v_mul_u32_u24 v114, 2731, v164
    v_bfe_u32 v117, v114, 17, 3
    v_lshrrev_b32 v114, 16, v114
    v_xor_b32 v164, v117, v164
    v_mul_u32_u24 v117, 37, v114
    v_lshrrev_b32 v117, 8, v117
    v_lshlrev_b32 v164, 4, v164
    v_mad_u32_u24 v12, v117, s70, v164
    v_min_u32 v117, 20, v114
    v_add_u32 v118, 12, v114
    v_lshrrev_b32 v118, 5, v118
    v_sub_u32 v119, v114, v117
    v_mad_i32_i24 v119, v118, s4, v119
    v_mul_u32_u24 v120, s20, v117
    v_add3_u32 v120, v120, v119, s38
    v_mul_u32_u24 v118, 911, v120
    v_lshrrev_b32 v118, 16, v118
    v_mul_u32_u24 v118, s22, v118
    v_mad_u32_u24 v118, v117, s21, v118
    v_bfe_u32 v120, s34, v114, 1
    v_cmp_ne_u32 vcc, 0, v120
    v_mul_i32_i24 v119, 2688, v119
    v_add3_u32 v117, v118, v119, s7
    v_cndmask_b32 v117, v163, v117, vcc
    v_mul_u32_u24 v114, 384, v114
    v_sub_u32 v114, v164, v114
    v_add_u32 v117, v117, v114
    buffer_load_dwordx4 v117, s[8:11], 0 offen lds
    s_add_u32 m0, s68, 3072
    v_lshrrev_b32 v164, 2, v124
    v_and_b32 v117, 1, v164
    v_mul_u32_u24 v117, 0x020202, v117
    v_lshl_or_b32 v117, v117, 8, v117
    v_add_u32 v117, 0x05040100, v117
    v_and_b32 v114, 3, v124
    v_lshrrev_b32 v118, 1, v124
    v_xor_b32 v118, v118, v255
    v_mul_u32_u24 v119, 384, v124
    v_lshl_add_u32 v0, v118, 4, v119
    v_xor_b32 v1, 64, v0
    v_and_b32 v118, 2, v255
    v_add_u32 v118, v118, v255
    v_lshl_add_u32 v118, v118, 2, v164
    v_mul_u32_u24 v118, 96, v118
    v_lshl_add_u32 v118, v114, 3, v118
    v_add_u32 v142, s68, v118
    buffer_load_dwordx4 v128, s[48:51], 0 offen lds
    v_add_u32 v143, s69, v118
    v_add_u32 v144, s72, v118
    v_add_u32 v145, s73, v118
    v_mul_u32_u24 v118, 768, v255
    v_add_u32 v118, v122, v118
    v_add_u32 v118, 98304, v118
    v_and_b32 v119, 1, v124
    v_lshlrev_b32 v119, 4, v119
    v_lshlrev_b32 v120, v119, s76
    v_mov_b32 v121, 0x3c003c00
    v_mov_b32 v28, 0x3f803f80
    v_mov_b32 v130, 2816
    v_mov_b32 v44, 1.0
    v_lshlrev_b32 v131, 4, v255
    v_lshl_add_u32 v132, v255, 4, s79
    v_lshl_add_u32 v133, v255, 3, s80
    v_add_u32 v138, 0, v124
    v_mul_u32_u24 v139, 37, v138
    buffer_load_dwordx4 v134, s[48:51], 0 offen offset:1024 lds
    v_mul_u32_u24 v140, 384, v138
    v_lshrrev_b32 v139, 8, v139
    v_mad_u32_u24 v140, v139, s70, v140
    v_add_u32 v15, v140, v132
    v_add_u32 v18, v140, v133
    v_add_u32 v140, 16, v124
    v_mul_u32_u24 v141, 37, v140
    v_mul_u32_u24 v146, 384, v140
    v_lshrrev_b32 v141, 8, v141
    v_mad_u32_u24 v146, v141, s70, v146
    v_add_u32 v16, v146, v132
    v_add_u32 v19, v146, v133
    v_add_u32 v146, 32, v124
    v_mul_u32_u24 v147, 37, v146
    v_mul_u32_u24 v148, 384, v146
    v_lshrrev_b32 v147, 8, v147
    v_mad_u32_u24 v148, v147, s70, v148
    v_add_u32 v17, v148, v132
    v_add_u32 v20, v148, v133
    v_mul_u32_u24 v139, 24, v139
    v_lshl_add_u32 v139, v138, 2, v139
    v_add_u32 v22, s81, v139
    v_sub_u32 v23, s81, v139
    v_sub_u32 v132, v22, v131
    v_mul_u32_u24 v133, 24, v141
    v_lshl_add_u32 v133, v140, 2, v133
    v_add_u32 v24, s81, v133
    v_sub_u32 v25, s81, v133
    v_sub_u32 v133, v24, v131
    v_mul_u32_u24 v147, 24, v147
    v_lshl_add_u32 v147, v146, 2, v147
    v_add_u32 v26, s81, v147
    v_sub_u32 v27, s81, v147
    v_sub_u32 v138, v26, v131
    v_mul_u32_u24 v139, 148, v255
    v_add_u32 v140, 0, v139
    v_lshrrev_b32 v140, 8, v140
    v_mad_i32_i24 v46, v140, s82, v132
    v_mad_i32_i24 v58, v140, s82, v133
    v_mad_i32_i24 v70, v140, s82, v138
    v_add_u32 v140, 37, v139
    v_lshrrev_b32 v140, 8, v140
    v_mad_i32_i24 v47, v140, s82, v132
    v_mad_i32_i24 v59, v140, s82, v133
    v_mad_i32_i24 v71, v140, s82, v138
    v_add_u32 v140, 74, v139
    v_lshrrev_b32 v140, 8, v140
    v_mad_i32_i24 v48, v140, s82, v132
    v_mad_i32_i24 v60, v140, s82, v133
    v_mad_i32_i24 v72, v140, s82, v138
    v_add_u32 v140, 111, v139
    v_lshrrev_b32 v140, 8, v140
    v_mad_i32_i24 v49, v140, s82, v132
    v_mad_i32_i24 v61, v140, s82, v133
    v_mad_i32_i24 v73, v140, s82, v138
    v_add_u32 v140, 592, v139
    v_lshrrev_b32 v140, 8, v140
    v_mad_i32_i24 v50, v140, s82, v132
    v_mad_i32_i24 v62, v140, s82, v133
    v_mad_i32_i24 v74, v140, s82, v138
    v_add_u32 v140, 629, v139
    v_lshrrev_b32 v140, 8, v140
    v_mad_i32_i24 v51, v140, s82, v132
    v_mad_i32_i24 v63, v140, s82, v133
    v_mad_i32_i24 v75, v140, s82, v138
    v_add_u32 v140, 666, v139
    v_lshrrev_b32 v140, 8, v140
    v_mad_i32_i24 v52, v140, s82, v132
    v_mad_i32_i24 v64, v140, s82, v133
    v_mad_i32_i24 v76, v140, s82, v138
    v_add_u32 v140, 703, v139
    v_lshrrev_b32 v140, 8, v140
    v_mad_i32_i24 v53, v140, s82, v132
    v_mad_i32_i24 v65, v140, s82, v133
    v_mad_i32_i24 v77, v140, s82, v138
    v_add_u32 v140, 1184, v139
    v_lshrrev_b32 v140, 8, v140
    v_mad_i32_i24 v54, v140, s82, v132
    v_mad_i32_i24 v66, v140, s82, v133
    v_mad_i32_i24 v78, v140, s82, v138
    v_add_u32 v140, 1221, v139
    v_lshrrev_b32 v140, 8, v140
    v_mad_i32_i24 v55, v140, s82, v132
    v_mad_i32_i24 v67, v140, s82, v133
    v_mad_i32_i24 v79, v140, s82, v138
    v_add_u32 v140, 1258, v139
    v_lshrrev_b32 v140, 8, v140
    v_mad_i32_i24 v56, v140, s82, v132
    v_mad_i32_i24 v68, v140, s82, v133
    v_mad_i32_i24 v80, v140, s82, v138
    v_add_u32 v139, 1295, v139
    v_lshrrev_b32 v139, 8, v139
    v_mad_i32_i24 v57, v139, s82, v132
    v_mad_i32_i24 v69, v139, s82, v133
    v_mad_i32_i24 v81, v139, s82, v138
    v_mov_b32 v132, s81
    v_lshlrev_b32 v133, 4, v254
    v_xor_b32 v2, 65536, v133
    v_lshl_add_u32 v3, s16, 10, v133
    v_add_u32 v4, s85, v133
    v_lshl_add_u32 v133, v255, 3, s86
    v_mov_b32 v138, s83
    v_mov_b32 v139, 163264
    v_mul_u32_u24 v140, 80, v255
    v_add3_u32 v146, v140, v119, s72
    v_add_u32 v5, s72, v140
    v_lshl_add_u32 v6, v124, 2, s73
    v_lshrrev_b32 v119, 1, v255
    v_mul_u32_u24 v119, 48, v119
    v_lshl_add_u32 v119, v255, 3, v119
    v_lshl_add_u32 v119, v164, 4, v119
    v_lshl_add_u32 v119, v114, 1, v119
    v_add_u32 v8, s87, v119
    v_mov_b32 v37, 0
    v_mov_b32 v38, 0
    v_mov_b32 v39, 0
    v_add_u32 v147, 86016, v0
    v_add_u32 v148, 86016, v1
    buffer_load_dwordx4 v136, s[48:51], 0 offen offset:2048 lds
    s_add_u32 s48, s48, 36864
    s_addc_u32 s49, s49, 0
    s_add_u32 m0, s69, 0
    v_lshlrev_b32 v149, 4, v124
    v_add_u32 v149, 161984, v149
    v_mul_u32_u24 v119, 336, v124
    v_add3_u32 v119, v119, v140, s72
    v_mul_u32_u24 v140, 272, v124
    v_add3_u32 v140, v140, v131, s73
    v_mul_u32_u24 v150, 1088, v255
    v_add_u32 v150, v150, v6
    v_add_u32 v141, 5376, v119
    v_add_u32 v151, 4352, v140
    v_add_u32 v152, 4352, v150
    v_cmp_gt_u32 s[88:89], 16, v254
    v_mov_b32 v153, 0xf149f2ca
    v_add_u32 v154, 768, v162
    v_mul_u32_u24 v155, 2731, v154
    buffer_load_dwordx4 v128, s[48:51], 0 offen lds
    v_bfe_u32 v156, v155, 17, 3
    v_lshrrev_b32 v155, 16, v155
    v_xor_b32 v154, v156, v154
    v_mul_u32_u24 v156, 37, v155
    v_lshrrev_b32 v156, 8, v156
    v_lshlrev_b32 v154, 4, v154
    v_mad_u32_u24 v13, v156, s70, v154
    v_add_u32 v162, 1024, v162
    v_mul_u32_u24 v154, 2731, v162
    v_bfe_u32 v155, v154, 17, 3
    v_lshrrev_b32 v154, 16, v154
    v_xor_b32 v162, v155, v162
    v_mul_u32_u24 v155, 37, v154
    s_waitcnt vmcnt(7)
    ds_read_b64_tr_b16 a[72:73], v142 offset:0
    ds_read_b64_tr_b16 a[74:75], v142 offset:768
    ds_read_b64_tr_b16 a[96:97], v142 offset:32
    ds_read_b64_tr_b16 a[98:99], v142 offset:800
    ds_read_b64_tr_b16 a[120:121], v142 offset:64
    buffer_load_dwordx4 v134, s[48:51], 0 offen offset:1024 lds
    ds_read_b64_tr_b16 a[122:123], v142 offset:832
    v_lshrrev_b32 v155, 8, v155
    v_lshlrev_b32 v162, 4, v162
    v_mad_u32_u24 v14, v155, s70, v162
    v_cmp_gt_u32 vcc, 48, v154
    v_mul_u32_u24 v162, 6, v126
    v_sub_u32 v154, v254, v162
    v_cndmask_b32 v14, v163, v14, vcc
    v_cmp_gt_u32 vcc, 2, v114
    v_mul_u32_u24 v162, 384, v126
    v_lshl_add_u32 v162, v154, 4, v162
    v_cndmask_b32 v32, 0, v120, vcc
    v_cndmask_b32 v33, v120, 0, vcc
    v_cndmask_b32 v34, 0, v120, vcc
    v_cndmask_b32 v35, v120, 0, vcc
    v_cmp_eq_u32 vcc, 0, v114
    v_add_u32 v163, s78, v162
    v_add_u32 v162, s77, v162
    buffer_load_dwordx4 v136, s[48:51], 0 offen offset:2048 lds
    s_add_u32 s48, s48, 36864
    s_addc_u32 s49, s49, 0
    s_add_u32 m0, s69, 3072
    v_cndmask_b32 v40, 0, v121, vcc
    v_cndmask_b32 v29, 0, v28, vcc
    v_cndmask_b32 v30, 0, v28, vcc
    v_cndmask_b32 v31, 0, v28, vcc
    v_cndmask_b32 v28, 0, v28, vcc
    v_cndmask_b32 v130, v130, 0, vcc
    v_cmp_eq_u32 vcc, 1, v114
    v_add3_u32 v9, v130, v131, s87
    v_mul_u32_u24 v130, 6, v127
    v_cndmask_b32 v41, 0, v121, vcc
    v_cmp_eq_u32 vcc, 2, v114
    v_sub_u32 v120, v254, v130
    v_mul_u32_u24 v130, 384, v127
    v_cndmask_b32 v42, 0, v121, vcc
    v_cmp_eq_u32 vcc, 3, v114
    v_lshl_add_u32 v130, v120, 4, v130
    v_add_u32 v126, s78, v130
    v_cndmask_b32 v43, 0, v121, vcc
    v_cmp_eq_u32 vcc, v255, v164
    v_add_u32 v130, s77, v130
    v_mul_u32_u24 v121, 6, v129
    v_cndmask_b32 v158, 0, v32, vcc
    v_cndmask_b32 v159, 0, v33, vcc
    v_cmp_gt_i32 vcc, 4, v154
    v_sub_u32 v254, v254, v121
    v_mul_u32_u24 v121, 384, v129
    v_cndmask_b32 v160, v163, v162, vcc
    v_cmp_gt_i32 vcc, -60, v120
    v_lshl_add_u32 v121, v254, 4, v121
    v_add_u32 v120, s78, v121
    v_cndmask_b32 v161, v126, v130, vcc
    v_add_u32 v121, s77, v121
    v_cmp_gt_i32 vcc, -124, v254
    v_mul_u32_u24 v130, 96, v124
    v_add3_u32 v254, v130, v131, s68
    v_cndmask_b32 v126, v120, v121, vcc
    v_cmp_gt_u32 vcc, 2, v255
    v_lshl_add_u32 v127, v255, 3, v130
    v_add3_u32 v127, v127, 64, s68
    v_cndmask_b32 v133, v138, v133, vcc
    v_lshl_add_u32 v133, v164, 9, v133
    v_lshl_add_u32 v133, v114, 1, v133
    v_cmp_gt_u32 vcc, 3, v255
    v_add3_u32 v129, v130, v131, s69
    v_lshl_add_u32 v162, v255, 3, v130
    v_cndmask_b32 v7, v139, v133, vcc
    v_cmp_gt_u32 vcc, 12, v124
    v_add3_u32 v162, v162, 64, s69
    v_add_u32 v114, 16, v124
    v_cndmask_b32 v141, v149, v141, vcc
    v_cndmask_b32 v151, v149, v151, vcc
    v_cmp_gt_u32 vcc, 3, v255
    v_cmp_gt_u32 s[94:95], s45, v114
    v_cndmask_b32 v255, v149, v140, s[88:89]
    v_cndmask_b32 v152, v149, v152, vcc
    v_cndmask_b32 v149, v149, v151, s[88:89]
    v_add_u32 v5, 336, v5
    buffer_load_dwordx4 v128, s[48:51], 0 offen lds
    buffer_load_dwordx4 v134, s[48:51], 0 offen offset:1024 lds
    buffer_load_dwordx4 v136, s[48:51], 0 offen offset:2048 lds
    s_waitcnt vmcnt(9)
    s_barrier
    ds_read_b128 v[154:157], v147 offset:6144
    ds_read_b128 v[166:169], v148 offset:6144
    ds_read_b128 v[170:173], v147 offset:6272
    s_add_u32 s48, s48, 36864
    s_addc_u32 s49, s49, 0
    ds_read_b128 v[174:177], v148 offset:6272
    s_add_u32 m0, s72, 0
    ds_read_b128 v[178:181], v147 offset:6400
    ds_read_b128 v[182:185], v148 offset:6400
    ds_read_b128 v[186:189], v147 offset:0
    buffer_load_ushort v164, v137, s[60:63], 0 offen
    s_mov_b64 s[60:61], s[8:9]
    ds_read_b128 v[190:193], v148 offset:0
    ds_read_b128 v[194:197], v147 offset:128
    ds_read_b128 v[198:201], v148 offset:128
    s_waitcnt lgkmcnt(7)
    v_mfma_f32_16x16x32_bf16 v[202:205], a[72:75], v[154:157], 0
    buffer_load_dwordx3 v[206:208], v122, s[56:59], 0 offen
    ds_read_b128 v[210:213], v147 offset:256
    v_mfma_f32_16x16x32_bf16 v[214:217], a[96:99], v[154:157], 0
    s_waitcnt lgkmcnt(7)
    ds_read_b128 v[218:221], v148 offset:256
    v_mfma_f32_16x16x32_bf16 v[222:225], a[120:123], v[154:157], 0
    s_waitcnt lgkmcnt(7)
    s_waitcnt lgkmcnt(5)
    v_mfma_f32_16x16x32_bf16 v[154:157], a[72:75], v[186:189], 0
    v_mfma_f32_16x16x32_bf16 v[226:229], a[96:99], v[186:189], 0
    s_waitcnt vmcnt(8)
    buffer_load_dwordx4 v[230:233], v116, s[64:67], 0 offen
    ds_read_b64_tr_b16 a[76:77], v142 offset:3072
    v_mfma_f32_16x16x32_bf16 v[234:237], a[120:123], v[186:189], 0
    s_mov_b32 s19, s38
    ds_read_b64_tr_b16 a[78:79], v142 offset:3840
    ds_read_b64_tr_b16 a[100:101], v142 offset:3104
    ds_read_b64_tr_b16 a[102:103], v142 offset:3872
    ds_read_b64_tr_b16 a[124:125], v142 offset:3136
    ds_read_b64_tr_b16 a[126:127], v142 offset:3904
    s_mov_b32 s23, s25
    s_mov_b32 s26, 0
    s_mov_b32 s27, 0
    s_mov_b32 s18, 0
    s_add_u32 s19, s19, s20
    s_add_u32 s23, s23, s21
    s_cmp_ge_u32 s19, 72
    s_cselect_b32 s34, 72, 0
    s_cselect_b32 s35, s22, 0
    s_sub_u32 s19, s19, s34
    s_add_u32 s23, s23, s35
    s_mov_b32 s24, s23
    s_add_u32 s19, s19, s20
    s_add_u32 s23, s23, s21
    s_cmp_ge_u32 s19, 72
    s_cselect_b32 s34, 72, 0
    s_cselect_b32 s35, s22, 0
    s_sub_u32 s19, s19, s34
    s_add_u32 s23, s23, s35
    s_sub_u32 s62, s45, s17
    s_sub_u32 s45, s17, 1
    s_bfm_b32 s70, s17, 0
    s_mov_b32 s71, 1
    s_waitcnt lgkmcnt(4)
    v_mfma_f32_16x16x32_bf16 v[202:205], a[76:79], v[166:169], v[202:205]
    s_waitcnt lgkmcnt(2)
    global_load_ushort v135, v135, s[46:47]
    s_and_b32 s77, s2, 0xf8
    v_mfma_f32_16x16x32_bf16 v[214:217], a[100:103], v[166:169], v[214:217]
    s_waitcnt lgkmcnt(0)
    buffer_load_dwordx4 v128, s[48:51], 0 offen lds
    s_add_u32 s77, s77, 4940
    v_mfma_f32_16x16x32_bf16 v[222:225], a[124:127], v[166:169], v[222:225]
    s_mul_i32 s78, s77, 58255
    ds_read_b128 v[166:169], v147 offset:6144
    s_lshr_b32 s78, s78, 22
    v_mfma_f32_16x16x32_bf16 v[154:157], a[76:79], v[190:193], v[154:157]
    s_add_u32 s34, s18, 2
    s_mov_b32 s18, 1
    s_mov_b32 s27, s26
    v_mfma_f32_16x16x32_bf16 v[226:229], a[100:103], v[190:193], v[226:229]
    s_mov_b32 s26, s25
    s_waitcnt vmcnt(8)
    ds_read_b64_tr_b16 a[80:81], v143 offset:0
    v_mfma_f32_16x16x32_bf16 v[234:237], a[124:127], v[190:193], v[234:237]
    s_add_u32 s19, s19, s20
    ds_read_b64_tr_b16 a[82:83], v143 offset:768
    ds_read_b64_tr_b16 a[104:105], v143 offset:32
    ds_read_b64_tr_b16 a[106:107], v143 offset:800
    ds_read_b64_tr_b16 a[128:129], v143 offset:64
    ds_read_b64_tr_b16 a[130:131], v143 offset:832
    buffer_load_dwordx4 v134, s[48:51], 0 offen offset:1024 lds
    buffer_load_dwordx4 v136, s[48:51], 0 offen offset:2048 lds
    s_add_u32 s48, s48, 36864
    s_waitcnt lgkmcnt(4)
    v_mfma_f32_16x16x32_bf16 v[202:205], a[80:83], v[170:173], v[202:205]
    s_waitcnt lgkmcnt(2)
    s_addc_u32 s49, s49, 0
    s_add_u32 m0, s72, 3072
    v_mfma_f32_16x16x32_bf16 v[214:217], a[104:107], v[170:173], v[214:217]
    s_waitcnt lgkmcnt(0)
    s_mov_b32 s72, 2
    v_mfma_f32_16x16x32_bf16 v[222:225], a[128:131], v[170:173], v[222:225]
    ds_read_b128 v[170:173], v148 offset:6144
    v_mfma_f32_16x16x32_bf16 v[154:157], a[80:83], v[194:197], v[154:157]
    v_mfma_f32_16x16x32_bf16 v[226:229], a[104:107], v[194:197], v[226:229]
    buffer_load_dwordx4 v128, s[48:51], 0 offen lds
    s_waitcnt vmcnt(8)
    v_mfma_f32_16x16x32_bf16 v[234:237], a[128:131], v[194:197], v[234:237]
    ds_read_b64_tr_b16 a[84:85], v143 offset:3072
    ds_read_b64_tr_b16 a[86:87], v143 offset:3840
    ds_read_b64_tr_b16 a[108:109], v143 offset:3104
    s_waitcnt vmcnt(6)
    ds_read_b64_tr_b16 a[110:111], v143 offset:3872
    ds_read_b64_tr_b16 a[132:133], v143 offset:3136
    ds_read_b64_tr_b16 a[134:135], v143 offset:3904
    v_bfe_u32 v122, v206, v131, 16
    v_bfe_u32 v124, v207, v131, 16
    v_bfe_u32 v114, v208, v131, 16
    buffer_load_dwordx4 v134, s[48:51], 0 offen offset:1024 lds
    s_waitcnt vmcnt(6)
    v_cndmask_b32 v230, v230, v231, s[92:93]
    v_mfma_f32_16x16x16_bf16 v[206:209], v[164:165], v[122:123], 0
    v_cndmask_b32 v232, v232, v233, s[92:93]
    v_perm_b32 v120, v232, v230, v117
    v_mfma_f32_16x16x16_bf16 v[230:233], v[164:165], v[124:125], 0
    s_nop 0
    s_nop 0
    s_nop 0
    s_waitcnt lgkmcnt(4)
    v_mfma_f32_16x16x32_bf16 v[202:205], a[84:87], v[174:177], v[202:205]
    s_waitcnt lgkmcnt(3)
    v_max_f32 v206, 0, v206
    v_max_f32 v207, 0, v207
    v_mfma_f32_16x16x32_bf16 v[154:157], a[84:87], v[198:201], v[154:157]
    s_waitcnt lgkmcnt(0)
    v_max_f32 v208, 0, v208
    v_max_f32 v209, 0, v209
    v_mfma_f32_16x16x32_bf16 v[214:217], a[108:111], v[174:177], v[214:217]
    buffer_load_dwordx4 v136, s[48:51], 0 offen offset:2048 lds
    v_cvt_pk_bf16_f32 v138, v206, v207
    v_mfma_f32_16x16x32_bf16 v[222:225], a[132:135], v[174:177], v[222:225]
    s_sub_u32 s48, s48, 184704
    ds_read_b128 v[122:125], v147 offset:6272
    v_cvt_pk_bf16_f32 v139, v208, v209
    v_max_f32 v230, 0, v230
    v_mfma_f32_16x16x16_bf16 v[174:177], v[164:165], v[114:115], 0
    v_max_f32 v231, 0, v231
    v_max_f32 v232, 0, v232
    v_max_f32 v233, 0, v233
    v_cvt_pk_bf16_f32 v114, v230, v231
    v_mfma_f32_16x16x32_bf16 v[226:229], a[108:111], v[198:201], v[226:229]
    s_subb_u32 s49, s49, 0
    ds_read_b128 v[206:209], v148 offset:6272
    s_waitcnt vmcnt(6)
    v_mfma_f32_16x16x32_bf16 v[234:237], a[132:135], v[198:201], v[234:237]
    s_add_u32 m0, s73, 0
    v_lshlrev_b32 v135, 16, v135
    buffer_load_dwordx4 v128, s[48:51], 0 offen lds
    v_max_f32 v135, 0xc2c80000, v135
    v_min_f32 v135, 0x40930000, v135
    v_mul_f32 v135, 0x3fb8aa3b, v135
    v_exp_f32 v135, v135
    v_cvt_pk_bf16_f32 v115, v232, v233
    v_cvt_pk_bf16_f32 v135, v135, v135
    v_and_b32 v135, 0xffff0000, v135
    v_mul_f32 v135, 0x3fb8aa3b, v135
    v_mul_f32 v137, 0xbea8f5c3, v135
    v_add_f32 v137, 0xc138aa3b, v137
    v_readlane_b32 s31, v135, s90
    v_max_f32 v174, 0, v174
    v_max_f32 v175, 0, v175
    v_max_f32 v176, 0, v176
    v_max_f32 v177, 0, v177
    v_cvt_pk_bf16_f32 v130, v174, v175
    v_cvt_pk_bf16_f32 v131, v176, v177
    buffer_load_dwordx4 v[174:177], v116, s[64:67], 0 offen offset:16
    buffer_load_dwordx4 v134, s[48:51], 0 offen offset:1024 lds
    buffer_load_dwordx4 v136, s[48:51], 0 offen offset:2048 lds
    s_waitcnt vmcnt(7)
    ds_read_b64_tr_b16 a[88:89], v144 offset:0
    ds_read_b64_tr_b16 a[90:91], v144 offset:768
    ds_read_b64_tr_b16 a[112:113], v144 offset:32
    ds_read_b64_tr_b16 a[114:115], v144 offset:800
    ds_read_b64_tr_b16 a[136:137], v144 offset:64
    ds_read_b64_tr_b16 a[138:139], v144 offset:832
    s_add_u32 s48, s48, 36864
    s_addc_u32 s49, s49, 0
    s_add_u32 m0, s73, 3072
    s_mov_b32 s73, 3
    buffer_load_dwordx4 v128, s[48:51], 0 offen lds
    s_waitcnt lgkmcnt(4)
    v_mfma_f32_16x16x32_bf16 v[202:205], a[88:91], v[178:181], v[202:205]
    s_waitcnt lgkmcnt(3)
    v_mfma_f32_16x16x32_bf16 v[154:157], a[88:91], v[210:213], v[154:157]
    s_waitcnt lgkmcnt(0)
    v_mfma_f32_16x16x32_bf16 v[214:217], a[112:115], v[178:181], v[214:217]
    v_mfma_f32_16x16x32_bf16 v[222:225], a[136:139], v[178:181], v[222:225]
    buffer_load_dwordx4 v134, s[48:51], 0 offen offset:1024 lds
    v_mfma_f32_16x16x32_bf16 v[226:229], a[112:115], v[210:213], v[226:229]
    ds_read_b128 v[178:181], v147 offset:6400
    v_mfma_f32_16x16x32_bf16 v[234:237], a[136:139], v[210:213], v[234:237]
    s_waitcnt vmcnt(6)
    ds_read_b64_tr_b16 a[92:93], v144 offset:3072
    ds_read_b64_tr_b16 a[94:95], v144 offset:3840
    ds_read_b64_tr_b16 a[116:117], v144 offset:3104
    ds_read_b64_tr_b16 a[118:119], v144 offset:3872
    ds_read_b64_tr_b16 a[140:141], v144 offset:3136
    ds_read_b64_tr_b16 a[142:143], v144 offset:3904
    buffer_load_dwordx4 v136, s[48:51], 0 offen offset:2048 lds
    s_add_u32 s48, s48, 36864
    s_addc_u32 s49, s49, 0
    s_add_u32 m0, s68, 0
    v_mov_b32 v230, 0
    v_mov_b32 v231, 0
    v_mov_b32 v232, 0
    v_mov_b32 v233, 0
    ds_write_b16 v8, v230 offset:2816
    v_mov_b32 v238, v153
    v_mov_b32 v239, v153
    v_mov_b32 v240, v153
    v_mov_b32 v241, v153
    buffer_load_dwordx4 v128, s[48:51], 0 offen lds
    s_waitcnt lgkmcnt(5)
    v_mfma_f32_16x16x32_bf16 v[202:205], a[92:95], v[182:185], v[202:205]
    s_waitcnt lgkmcnt(4)
    v_mfma_f32_16x16x32_bf16 v[154:157], a[92:95], v[218:221], v[154:157]
    s_waitcnt lgkmcnt(1)
    v_mfma_f32_16x16x32_bf16 v[214:217], a[116:119], v[182:185], v[214:217]
    v_mfma_f32_16x16x32_bf16 v[222:225], a[140:143], v[182:185], v[222:225]
    v_mfma_f32_16x16x32_bf16 v[226:229], a[116:119], v[218:221], v[226:229]
    s_waitcnt vmcnt(6)
    v_cndmask_b32 v174, v174, v175, s[92:93]
    v_cndmask_b32 v176, v176, v177, s[92:93]
    v_mfma_f32_16x16x32_bf16 v[234:237], a[140:143], v[218:221], v[234:237]
    buffer_load_dwordx4 v134, s[48:51], 0 offen offset:1024 lds
    v_perm_b32 v121, v176, v174, v117
    v_cvt_pk_f16_f32 v174, v202, v203
    v_pk_mul_f16 v183, v174, v174
    v_cvt_pk_f16_f32 v175, v204, v205
    v_pk_fma_f16 v183, v175, v175, v183
    v_cvt_pk_f16_f32 v176, v214, v215
    v_mfma_f32_16x16x16_bf16 v[202:205], v[120:121], v[138:139], 0
    v_pk_fma_f16 v183, v176, v176, v183
    v_cvt_pk_f16_f32 v177, v216, v217
    v_pk_fma_f16 v183, v177, v177, v183
    v_mfma_f32_16x16x16_bf16 v[214:217], v[120:121], v[114:115], 0
    v_cvt_pk_f16_f32 v244, v222, v223
    v_pk_fma_f16 v183, v244, v244, v183
    v_cvt_pk_f16_f32 v245, v224, v225
    v_mfma_f32_16x16x16_bf16 v[114:117], v[120:121], v[130:131], 0
    v_cvt_pk_bf16_f32 v202, v202, v202
    v_and_b32 v202, 0xffff0000, v202
    v_mul_f32 v202, 0xbfb8aa3b, v202
    buffer_load_dwordx4 v136, s[48:51], 0 offen offset:2048 lds
    ds_read_b128 v[222:225], v148 offset:6400
    s_add_u32 s48, s48, 36864
    s_addc_u32 s49, s49, 0
    s_add_u32 m0, s68, 3072
    v_exp_f32 v202, v202
    s_waitcnt vmcnt(6)
    ds_read_b64_tr_b16 a[0:1], v145 offset:0
    ds_read_b64_tr_b16 a[2:3], v145 offset:768
    ds_read_b64_tr_b16 a[24:25], v145 offset:32
    ds_read_b64_tr_b16 a[26:27], v145 offset:800
    ds_read_b64_tr_b16 a[48:49], v145 offset:64
    ds_read_b64_tr_b16 a[50:51], v145 offset:832
    v_add_f32 v202, 1.0, v202
    v_rcp_f32 v202, v202
    v_cvt_pk_bf16_f32 v214, v214, v214
    buffer_load_dwordx4 v128, s[48:51], 0 offen lds
    v_cvt_pk_bf16_f32 v202, v202, v202
    v_and_b32 v202, 0xffff0000, v202
    v_fmamk_f32 v202, v202, 0x41b8aa3b, v137
    ds_write_b32 v118, v202 offset:0
    v_and_b32 v214, 0xffff0000, v214
    v_mul_f32 v214, 0xbfb8aa3b, v214
    v_exp_f32 v214, v214
    v_cvt_pk_bf16_f32 v114, v114, v114
    v_add_f32 v214, 1.0, v214
    v_rcp_f32 v214, v214
    v_and_b32 v114, 0xffff0000, v114
    s_waitcnt lgkmcnt(5)
    v_mfma_f32_16x16x32_bf16 v[202:205], a[0:3], v[186:189], 0
    s_waitcnt lgkmcnt(3)
    v_cvt_pk_bf16_f32 v214, v214, v214
    v_and_b32 v214, 0xffff0000, v214
    v_mfma_f32_16x16x32_bf16 v[246:249], a[24:27], v[186:189], 0
    s_waitcnt lgkmcnt(1)
    buffer_load_dwordx4 v134, s[48:51], 0 offen offset:1024 lds
    v_fmamk_f32 v214, v214, 0x41b8aa3b, v137
    ds_write_b32 v118, v214 offset:4
    v_mul_f32 v114, 0xbfb8aa3b, v114
    v_exp_f32 v114, v114
    v_pk_fma_f16 v183, v245, v245, v183
    v_add_f32 v114, 1.0, v114
    v_rcp_f32 v114, v114
    v_cvt_pk_f16_f32 v154, v154, v155
    v_cvt_pk_bf16_f32 v114, v114, v114
    s_waitcnt vmcnt(5)
    ds_read_b64_tr_b16 a[4:5], v145 offset:3072
    ds_read_b64_tr_b16 a[6:7], v145 offset:3840
    ds_read_b64_tr_b16 a[28:29], v145 offset:3104
    ds_read_b64_tr_b16 a[30:31], v145 offset:3872
    buffer_load_dwordx4 v136, s[48:51], 0 offen offset:2048 lds
    ds_read_b64_tr_b16 a[52:53], v145 offset:3136
    ds_read_b64_tr_b16 a[54:55], v145 offset:3904
    v_mfma_f32_16x16x32_bf16 v[214:217], a[48:51], v[186:189], 0
    s_add_u32 s48, s48, 36864
    ds_write_b128 v119, v[230:233] offset:16
    v_mfma_f32_16x16x32_bf16 v[186:189], a[0:3], v[166:169], 0
    s_addc_u32 s49, s49, 0
    s_add_u32 m0, s69, 0
    v_and_b32 v114, 0xffff0000, v114
    v_fmamk_f32 v114, v114, 0x41b8aa3b, v137
    v_pk_mul_f16 v115, v154, v154
    v_cvt_pk_f16_f32 v155, v156, v157
    ds_write_b32 v118, v114 offset:8
    buffer_load_dwordx4 v128, s[48:51], 0 offen lds
    v_pk_fma_f16 v115, v155, v155, v115
    v_cvt_pk_f16_f32 v156, v226, v227
    v_mfma_f32_16x16x32_bf16 v[250:253], a[24:27], v[166:169], 0
    s_waitcnt lgkmcnt(6)
    v_pk_fma_f16 v115, v156, v156, v115
    v_cvt_pk_f16_f32 v157, v228, v229
    v_mfma_f32_16x16x32_bf16 v[202:205], a[4:7], v[190:193], v[202:205]
    s_waitcnt lgkmcnt(3)
    ds_write_b64 v119, v[230:231] offset:56
    v_mfma_f32_16x16x32_bf16 v[246:249], a[28:31], v[190:193], v[246:249]
    s_waitcnt lgkmcnt(2)
    v_pk_fma_f16 v115, v157, v157, v115
    v_cvt_pk_f16_f32 v228, v234, v235
    v_mfma_f32_16x16x32_bf16 v[214:217], a[52:55], v[190:193], v[214:217]
    ds_write_b64 v119, v[230:231] offset:64
    v_mfma_f32_16x16x32_bf16 v[186:189], a[4:7], v[170:173], v[186:189]
    buffer_load_dwordx4 v134, s[48:51], 0 offen offset:1024 lds
    v_pk_fma_f16 v115, v228, v228, v115
    v_mfma_f32_16x16x32_bf16 v[250:253], a[28:31], v[170:173], v[250:253]
    s_waitcnt lgkmcnt(2)
    ds_write_b128 v141, v[230:233] offset:16
    v_mfma_f32_16x16x32_bf16 v[190:193], a[48:51], v[166:169], 0
    s_barrier
    v_cvt_pk_f16_f32 v229, v236, v237
    v_pk_fma_f16 v115, v229, v229, v115
    v_mfma_f32_16x16x32_bf16 v[190:193], a[52:55], v[170:173], v[190:193]
    s_waitcnt vmcnt(5)
    buffer_load_dwordx4 v136, s[48:51], 0 offen offset:2048 lds
    ds_read_b64_tr_b16 a[8:9], v142 offset:0
    ds_read_b64_tr_b16 a[10:11], v142 offset:768
    ds_read_b64_tr_b16 a[32:33], v142 offset:32
    ds_read_b64_tr_b16 a[34:35], v142 offset:800
    ds_read_b64_tr_b16 a[56:57], v142 offset:64
    ds_read_b64_tr_b16 a[58:59], v142 offset:832
    ds_read_b32 v22, v22 offset:0
    ds_read_b32 v23, v23 offset:672
    s_add_u32 s48, s48, 36864
    ds_read_b32 v24, v24 offset:0
    s_addc_u32 s49, s49, 0
    ds_read_b32 v25, v25 offset:672
    s_add_u32 m0, s69, 3072
    ds_read_b32 v26, v26 offset:0
    ds_read_b32 v27, v27 offset:672
    ds_read_b32 v46, v46 offset:336
    buffer_load_dwordx4 v128, s[48:51], 0 offen lds
    ds_read_b32 v58, v58 offset:336
    ds_read_b32 v70, v70 offset:336
    ds_read_b32 v47, v47 offset:332
    ds_read_b32 v59, v59 offset:332
    ds_read_b32 v71, v71 offset:332
    ds_read_b32 v48, v48 offset:328
    s_waitcnt lgkmcnt(15)
    v_mfma_f32_16x16x32_bf16 v[202:205], a[8:11], v[194:197], v[202:205]
    s_waitcnt lgkmcnt(14)
    ds_read_b32 v60, v60 offset:328
    ds_read_b32 v72, v72 offset:328
    v_mfma_f32_16x16x32_bf16 v[246:249], a[32:35], v[194:197], v[246:249]
    s_waitcnt lgkmcnt(13)
    ds_read_b32 v49, v49 offset:324
    ds_read_b32 v61, v61 offset:324
    v_mfma_f32_16x16x32_bf16 v[214:217], a[56:59], v[194:197], v[214:217]
    s_waitcnt lgkmcnt(13)
    buffer_load_dwordx4 v134, s[48:51], 0 offen offset:1024 lds
    ds_read_b32 v73, v73 offset:324
    v_mfma_f32_16x16x32_bf16 v[186:189], a[8:11], v[122:125], v[186:189]
    s_waitcnt lgkmcnt(12)
    ds_read_b32 v50, v50 offset:272
    ds_read_b32 v62, v62 offset:272
    v_mfma_f32_16x16x32_bf16 v[250:253], a[32:35], v[122:125], v[250:253]
    s_waitcnt lgkmcnt(12)
    ds_read_b32 v74, v74 offset:272
    ds_read_b32 v51, v51 offset:268
    v_mfma_f32_16x16x32_bf16 v[190:193], a[56:59], v[122:125], v[190:193]
    s_waitcnt lgkmcnt(12)
    ds_read_b32 v63, v63 offset:268
    ds_read_b32 v75, v75 offset:268
    ds_read_b32 v52, v52 offset:264
    ds_read_b32 v64, v64 offset:264
    ds_read_b32 v76, v76 offset:264
    ds_read_b32 v53, v53 offset:260
    s_waitcnt vmcnt(5)
    ds_read_b64_tr_b16 a[12:13], v142 offset:3072
    buffer_load_dwordx4 v136, s[48:51], 0 offen offset:2048 lds
    ds_read_b64_tr_b16 a[14:15], v142 offset:3840
    s_add_u32 m0, s28, 0
    ds_read_b64_tr_b16 a[36:37], v142 offset:3104
    s_sub_u32 s48, s48, 183552
    ds_read_b64_tr_b16 a[38:39], v142 offset:3872
    s_subb_u32 s49, s49, 0
    ds_read_b64_tr_b16 a[60:61], v142 offset:3136
    ds_read_b64_tr_b16 a[62:63], v142 offset:3904
    ds_read_b32 v65, v65 offset:260
    ds_read_b32 v77, v77 offset:260
    ds_read_b32 v54, v54 offset:208
    ds_read_b32 v66, v66 offset:208
    ds_read_b32 v78, v78 offset:208
    buffer_load_dwordx4 v10, s[8:11], s25 offen nt lds
    ds_read_b32 v55, v55 offset:204
    ds_read_b32 v67, v67 offset:204
    s_add_u32 m0, s28, 4096
    ds_read_b32 v79, v79 offset:204
    ds_read_b32 v56, v56 offset:200
    ds_read_b32 v68, v68 offset:200
    s_waitcnt lgkmcnt(14)
    v_mfma_f32_16x16x32_bf16 v[202:205], a[12:15], v[198:201], v[202:205]
    s_waitcnt lgkmcnt(13)
    ds_read_b32 v80, v80 offset:200
    ds_read_b32 v57, v57 offset:196
    v_mfma_f32_16x16x32_bf16 v[186:189], a[12:15], v[206:209], v[186:189]
    s_waitcnt lgkmcnt(13)
    ds_read_b32 v69, v69 offset:196
    ds_read_b32 v81, v81 offset:196
    v_mfma_f32_16x16x32_bf16 v[246:249], a[36:39], v[198:201], v[246:249]
    s_waitcnt lgkmcnt(13)
    buffer_load_dwordx4 v11, s[8:11], s25 offen nt lds
    v_mfma_f32_16x16x32_bf16 v[214:217], a[60:63], v[198:201], v[214:217]
    s_add_u32 m0, s28, 8192
    ds_read_b32 v132, v132 offset:336
    v_cndmask_b32 v22, v153, v22, s[88:89]
    v_mfma_f32_16x16x32_bf16 v[250:253], a[36:39], v[206:209], v[250:253]
    s_waitcnt lgkmcnt(10)
    ds_write_b64 v141, v[230:231] offset:56
    v_mfma_f32_16x16x32_bf16 v[190:193], a[60:63], v[206:209], v[190:193]
    v_cndmask_b32 v24, v153, v24, s[88:89]
    v_mov_b32_dpp v23, v25 quad_perm:[0,1,2,3] row_mask:0x2 bank_mask:0xf
    v_cndmask_b32 v26, v153, v26, s[88:89]
    ds_write_b64 v141, v[230:231] offset:64
    s_waitcnt vmcnt(5)
    buffer_load_dwordx4 v12, s[8:11], s25 offen nt lds
    s_add_u32 m0, s28, 12288
    ds_read_b64_tr_b16 a[16:17], v143 offset:0
    ds_read_b64_tr_b16 a[18:19], v143 offset:768
    ds_read_b64_tr_b16 a[40:41], v143 offset:32
    ds_read_b64_tr_b16 a[42:43], v143 offset:800
    ds_read_b64_tr_b16 a[64:65], v143 offset:64
    ds_read_b64_tr_b16 a[66:67], v143 offset:832
    s_waitcnt lgkmcnt(8)
    ds_write_b128 v140, v[238:241] offset:192
    v_readfirstlane_b32 s39, v132
    v_mov_b32_dpp v23, v27 quad_perm:[0,1,2,3] row_mask:0x4 bank_mask:0xf
    buffer_load_dwordx4 v13, s[8:11], s25 offen nt lds
    s_add_u32 m0, s29, 0
    ds_write_b128 v151, v[238:241] offset:192
    s_waitcnt lgkmcnt(6)
    v_mfma_f32_16x16x32_bf16 v[202:205], a[16:19], v[210:213], v[202:205]
    s_waitcnt lgkmcnt(5)
    v_mfma_f32_16x16x32_bf16 v[186:189], a[16:19], v[178:181], v[186:189]
    s_waitcnt lgkmcnt(2)
    v_mfma_f32_16x16x32_bf16 v[246:249], a[40:43], v[210:213], v[246:249]
    buffer_load_dwordx4 v14, s[8:11], s25 offen nt lds
    v_mfma_f32_16x16x32_bf16 v[214:217], a[64:67], v[210:213], v[214:217]
    s_add_u32 m0, s68, 0
    s_lshr_b32 s10, s17, 1
    s_cselect_b32 s10, s36, 0
    v_mfma_f32_16x16x32_bf16 v[250:253], a[40:43], v[178:181], v[250:253]
    s_mov_b32 s25, s24
    v_mfma_f32_16x16x32_bf16 v[190:193], a[64:67], v[178:181], v[190:193]
    s_waitcnt vmcnt(5)
    ds_read_b64_tr_b16 a[20:21], v143 offset:3072
    buffer_load_dwordx4 v128, s[48:51], 0 offen lds
    ds_read_b64_tr_b16 a[22:23], v143 offset:3840
    ds_read_b64_tr_b16 a[44:45], v143 offset:3104
    ds_read_b64_tr_b16 a[46:47], v143 offset:3872
    ds_read_b64_tr_b16 a[68:69], v143 offset:3136
    ds_read_b64_tr_b16 a[70:71], v143 offset:3904
    buffer_load_dwordx4 v134, s[48:51], 0 offen offset:1024 lds
    s_waitcnt lgkmcnt(4)
    v_mfma_f32_16x16x32_bf16 v[202:205], a[20:23], v[218:221], v[202:205]
    s_waitcnt lgkmcnt(3)
    v_mfma_f32_16x16x32_bf16 v[186:189], a[20:23], v[222:225], v[186:189]
    s_waitcnt lgkmcnt(0)
    v_mfma_f32_16x16x32_bf16 v[246:249], a[44:47], v[218:221], v[246:249]
    v_mfma_f32_16x16x32_bf16 v[214:217], a[68:71], v[218:221], v[214:217]
    buffer_load_dwordx4 v136, s[48:51], 0 offen offset:2048 lds
    s_add_u32 s48, s48, 36864
    v_mfma_f32_16x16x32_bf16 v[250:253], a[44:47], v[222:225], v[250:253]
    s_addc_u32 s49, s49, 0
    v_cvt_pk_f16_f32 v122, v202, v203
    v_pk_mul_f16 v114, v122, v122
    v_mfma_f32_16x16x32_bf16 v[190:193], a[68:71], v[222:225], v[190:193]
    s_add_u32 m0, s68, 3072
    v_cvt_pk_f16_f32 v123, v204, v205
    v_pk_fma_f16 v114, v123, v123, v114
    v_cvt_pk_f16_f32 v124, v246, v247
    v_pk_fma_f16 v114, v124, v124, v114
    v_cvt_pk_f16_f32 v125, v248, v249
    v_pk_fma_f16 v114, v125, v125, v114
    v_cvt_pk_f16_f32 v226, v214, v215
    v_pk_fma_f16 v114, v226, v226, v114
    v_cvt_pk_f16_f32 v227, v216, v217
    v_pk_fma_f16 v114, v227, v227, v114
    v_pk_mul_f16 v116, v122, v154
    buffer_load_dwordx4 v128, s[48:51], 0 offen lds
    v_pk_fma_f16 v116, v123, v155, v116
    v_pk_fma_f16 v116, v124, v156, v116
    v_pk_fma_f16 v116, v125, v157, v116
    v_pk_fma_f16 v116, v226, v228, v116
    v_pk_fma_f16 v116, v227, v229, v116
    v_mov_b32 v117, v114
    v_cvt_pk_f16_f32 v130, v186, v187
    v_pk_mul_f16 v182, v130, v130
    v_mfma_f32_16x16x32_f16 v[166:169], v[40:43], v[114:117], 0
    v_cvt_pk_f16_f32 v131, v188, v189
    v_pk_fma_f16 v182, v131, v131, v182
    v_cvt_pk_f16_f32 v132, v250, v251
    v_pk_fma_f16 v182, v132, v132, v182
    v_cvt_pk_f16_f32 v133, v252, v253
    v_pk_fma_f16 v182, v133, v133, v182
    v_cvt_pk_f16_f32 v242, v190, v191
    v_pk_fma_f16 v182, v242, v242, v182
    v_rsq_f32 v166, v166
    v_rsq_f32 v167, v167
    v_mul_f32 v144, s31, v166
    v_cvt_pk_f16_f32 v145, v144, v167
    v_pk_mul_f16 v154, v154, v145 op_sel:[0,1] op_sel_hi:[1,1]
    v_pk_mul_f16 v155, v155, v145 op_sel:[0,1] op_sel_hi:[1,1]
    v_pk_mul_f16 v156, v156, v145 op_sel:[0,1] op_sel_hi:[1,1]
    v_pk_mul_f16 v157, v157, v145 op_sel:[0,1] op_sel_hi:[1,1]
    v_pk_mul_f16 v228, v228, v145 op_sel:[0,1] op_sel_hi:[1,1]
    v_pk_mul_f16 v229, v229, v145 op_sel:[0,1] op_sel_hi:[1,1]
    v_pk_mul_f16 v122, v122, v145 op_sel:[0,0] op_sel_hi:[1,0]
    v_pk_mul_f16 v123, v123, v145 op_sel:[0,0] op_sel_hi:[1,0]
    v_pk_mul_f16 v124, v124, v145 op_sel:[0,0] op_sel_hi:[1,0]
    v_pk_mul_f16 v125, v125, v145 op_sel:[0,0] op_sel_hi:[1,0]
    v_pk_mul_f16 v226, v226, v145 op_sel:[0,0] op_sel_hi:[1,0]
    v_pk_mul_f16 v227, v227, v145 op_sel:[0,0] op_sel_hi:[1,0]
    v_max3_u32 v44, v44, v166, v167
    v_mul_f32 v243, v168, v144
    v_fma_f32 v243, v243, v167, s39
    ds_write_b32 v255, v243 offset:192
    v_cvt_pk_f16_f32 v243, v192, v193
    v_pk_fma_f16 v182, v243, v243, v182
    v_pk_mul_f16 v184, v130, v174
    v_pk_fma_f16 v184, v131, v175, v184
    ds_write_b128 v119, v[154:157]
    v_pk_fma_f16 v184, v132, v176, v184
    v_pk_fma_f16 v184, v133, v177, v184
    v_pk_fma_f16 v184, v242, v244, v184
    v_pk_fma_f16 v184, v243, v245, v184
    v_mov_b32 v185, v182
    s_nop 0
    s_nop 0
    v_mfma_f32_16x16x32_f16 v[114:117], v[40:43], v[182:185], 0
    ds_write_b64 v119, v[228:229] offset:48
    s_nop 0
    s_nop 0
    s_nop 0
    ds_write_b128 v119, v[122:125] offset:32
    s_nop 0
    s_nop 0
    s_nop 0
    v_rsq_f32 v114, v114
    v_rsq_f32 v115, v115
    ds_write_b64 v119, v[226:227] offset:72
    v_mul_f32 v144, s31, v114
    v_cvt_pk_f16_f32 v145, v144, v115
    v_pk_mul_f16 v174, v174, v145 op_sel:[0,1] op_sel_hi:[1,1]
    v_pk_mul_f16 v175, v175, v145 op_sel:[0,1] op_sel_hi:[1,1]
    v_pk_mul_f16 v176, v176, v145 op_sel:[0,1] op_sel_hi:[1,1]
    v_pk_mul_f16 v177, v177, v145 op_sel:[0,1] op_sel_hi:[1,1]
    v_pk_mul_f16 v244, v244, v145 op_sel:[0,1] op_sel_hi:[1,1]
    v_pk_mul_f16 v245, v245, v145 op_sel:[0,1] op_sel_hi:[1,1]
    v_pk_mul_f16 v130, v130, v145 op_sel:[0,0] op_sel_hi:[1,0]
    v_pk_mul_f16 v131, v131, v145 op_sel:[0,0] op_sel_hi:[1,0]
    v_pk_mul_f16 v132, v132, v145 op_sel:[0,0] op_sel_hi:[1,0]
    v_pk_mul_f16 v133, v133, v145 op_sel:[0,0] op_sel_hi:[1,0]
    v_pk_mul_f16 v242, v242, v145 op_sel:[0,0] op_sel_hi:[1,0]
    v_pk_mul_f16 v243, v243, v145 op_sel:[0,0] op_sel_hi:[1,0]
    v_cndmask_b32 v114, 1.0, v114, s[94:95]
    v_cndmask_b32 v115, 1.0, v115, s[94:95]
    v_max3_u32 v44, v44, v114, v115
    v_mul_f32 v255, v116, v144
    v_fma_f32 v255, v255, v115, s39
    ds_write_b32 v149, v255 offset:192
    buffer_load_dwordx4 v134, s[48:51], 0 offen offset:1024 lds
    ds_write_b128 v141, v[174:177]
    buffer_load_dwordx4 v136, s[48:51], 0 offen offset:2048 lds
    ds_write_b64 v141, v[244:245] offset:48
    s_add_u32 s48, s48, 36864
    s_addc_u32 s49, s49, 0
    s_add_u32 m0, s69, 0
    ds_write_b128 v141, v[130:133] offset:32
    buffer_load_dwordx4 v128, s[48:51], 0 offen lds
    ds_write_b64 v141, v[242:243] offset:72
    buffer_load_dwordx4 v134, s[48:51], 0 offen offset:1024 lds
    buffer_load_dwordx4 v136, s[48:51], 0 offen offset:2048 lds
    s_waitcnt vmcnt(9)
    s_barrier
    ds_read_b128 v[122:125], v0 offset:20480
    ds_read_b128 v[154:157], v1 offset:20480
    ds_read_b128 v[170:173], v0 offset:20608
    s_add_u32 s48, s48, 36864
    s_addc_u32 s49, s49, 0
    ds_read_b128 v[174:177], v1 offset:20608
    s_add_u32 m0, s69, 3072
    ds_read_b128 v[178:181], v0 offset:20736
    ds_read_b128 v[186:189], v1 offset:20736
    buffer_load_dwordx4 v128, s[48:51], 0 offen lds
    s_waitcnt lgkmcnt(5)
    v_mfma_f32_16x16x32_bf16 v[130:133], a[72:75], v[122:125], 0
    s_waitcnt lgkmcnt(4)
    v_mfma_f32_16x16x32_bf16 v[130:133], a[76:79], v[154:157], v[130:133]
    s_waitcnt lgkmcnt(2)
    v_mfma_f32_16x16x32_bf16 v[130:133], a[80:83], v[170:173], v[130:133]
    s_waitcnt lgkmcnt(1)
    v_mfma_f32_16x16x32_bf16 v[130:133], a[84:87], v[174:177], v[130:133]
    s_waitcnt lgkmcnt(0)
    buffer_load_dwordx4 v134, s[48:51], 0 offen offset:1024 lds
    v_mfma_f32_16x16x32_bf16 v[130:133], a[88:91], v[178:181], v[130:133]
    v_mfma_f32_16x16x32_bf16 v[130:133], a[92:95], v[186:189], v[130:133]
    v_mfma_f32_16x16x32_bf16 v[166:169], a[96:99], v[122:125], 0
    s_waitcnt vmcnt(8)
    ds_read_b64_tr_b16 a[144:145], v142 offset:0
    ds_read_b64_tr_b16 a[146:147], v142 offset:768
    v_mfma_f32_16x16x32_bf16 v[166:169], a[100:103], v[154:157], v[166:169]
    ds_read_b64_tr_b16 a[168:169], v142 offset:32
    ds_read_b64_tr_b16 a[170:171], v142 offset:800
    v_mfma_f32_16x16x32_bf16 v[166:169], a[104:107], v[170:173], v[166:169]
    ds_read_b64_tr_b16 a[192:193], v142 offset:64
    buffer_load_dwordx4 v136, s[48:51], 0 offen offset:2048 lds
    v_mfma_f32_16x16x32_bf16 v[166:169], a[108:111], v[174:177], v[166:169]
    s_add_u32 s48, s48, 36864
    ds_read_b64_tr_b16 a[194:195], v142 offset:832
    v_cvt_pk_f16_f32 v182, v130, v131
    v_mfma_f32_16x16x32_bf16 v[166:169], a[112:115], v[178:181], v[166:169]
    s_addc_u32 s49, s49, 0
    v_pk_mul_f16 v139, v182, v182
    v_cvt_pk_f16_f32 v183, v132, v133
    v_mfma_f32_16x16x32_bf16 v[166:169], a[116:119], v[186:189], v[166:169]
    s_add_u32 m0, s68, 0
    v_pk_fma_f16 v139, v183, v183, v139
    v_mfma_f32_16x16x32_bf16 v[194:197], a[120:123], v[122:125], 0
    v_mfma_f32_16x16x32_bf16 v[194:197], a[124:127], v[154:157], v[194:197]
    v_mfma_f32_16x16x32_bf16 v[194:197], a[128:131], v[170:173], v[194:197]
    s_waitcnt lgkmcnt(4)
    v_mfma_f32_16x16x32_bf16 v[194:197], a[132:135], v[174:177], v[194:197]
    s_waitcnt lgkmcnt(2)
    v_cvt_pk_f16_f32 v184, v166, v167
    v_pk_fma_f16 v139, v184, v184, v139
    v_mfma_f32_16x16x32_bf16 v[194:197], a[136:139], v[178:181], v[194:197]
    s_waitcnt lgkmcnt(1)
    ds_read_b128 v[190:193], v0 offset:26624
    v_cvt_pk_f16_f32 v185, v168, v169
    v_mfma_f32_16x16x32_bf16 v[194:197], a[140:143], v[186:189], v[194:197]
    s_waitcnt lgkmcnt(1)
    buffer_load_dwordx4 v128, s[48:51], 0 offen lds
    ds_read_b128 v[198:201], v1 offset:26624
    v_mfma_f32_16x16x32_bf16 v[114:117], a[0:3], v[122:125], 0
    ds_read_b128 v[202:205], v0 offset:26752
    s_waitcnt vmcnt(7)
    v_mfma_f32_16x16x32_bf16 v[114:117], a[4:7], v[154:157], v[114:117]
    ds_read_b64_tr_b16 a[148:149], v142 offset:3072
    ds_read_b64_tr_b16 a[150:151], v142 offset:3840
    v_mfma_f32_16x16x32_bf16 v[114:117], a[8:11], v[170:173], v[114:117]
    ds_read_b64_tr_b16 a[172:173], v142 offset:3104
    ds_read_b64_tr_b16 a[174:175], v142 offset:3872
    v_mfma_f32_16x16x32_bf16 v[114:117], a[12:15], v[174:177], v[114:117]
    ds_read_b64_tr_b16 a[196:197], v142 offset:3136
    ds_read_b64_tr_b16 a[198:199], v142 offset:3904
    v_mfma_f32_16x16x32_bf16 v[114:117], a[16:19], v[178:181], v[114:117]
    ds_read_b128 v[206:209], v1 offset:26752
    buffer_load_dwordx4 v134, s[48:51], 0 offen offset:1024 lds
    v_mfma_f32_16x16x32_bf16 v[114:117], a[20:23], v[186:189], v[114:117]
    ds_read_b128 v[210:213], v0 offset:26880
    ds_read_b128 v[214:217], v1 offset:26880
    v_mfma_f32_16x16x32_bf16 v[118:121], a[24:27], v[122:125], 0
    s_waitcnt lgkmcnt(11)
    v_pk_fma_f16 v139, v185, v185, v139
    v_cvt_pk_f16_f32 v168, v194, v195
    v_mfma_f32_16x16x32_bf16 v[118:121], a[28:31], v[154:157], v[118:121]
    s_waitcnt lgkmcnt(10)
    v_pk_fma_f16 v139, v168, v168, v139
    v_cvt_pk_f16_f32 v169, v196, v197
    v_mfma_f32_16x16x32_bf16 v[118:121], a[32:35], v[170:173], v[118:121]
    s_waitcnt lgkmcnt(9)
    v_pk_fma_f16 v139, v169, v169, v139
    v_cvt_pk_f16_f32 v130, v114, v115
    v_mfma_f32_16x16x32_bf16 v[118:121], a[36:39], v[174:177], v[118:121]
    s_waitcnt lgkmcnt(7)
    v_pk_mul_f16 v138, v130, v130
    v_cvt_pk_f16_f32 v131, v116, v117
    v_mfma_f32_16x16x32_bf16 v[118:121], a[40:43], v[178:181], v[118:121]
    s_waitcnt lgkmcnt(5)
    buffer_load_dwordx4 v136, s[48:51], 0 offen offset:2048 lds
    v_pk_fma_f16 v138, v131, v131, v138
    v_mfma_f32_16x16x32_bf16 v[118:121], a[44:47], v[186:189], v[118:121]
    s_add_u32 s48, s48, 36864
    s_addc_u32 s49, s49, 0
    s_add_u32 m0, s68, 3072
    v_mfma_f32_16x16x32_bf16 v[114:117], a[48:51], v[122:125], 0
    s_waitcnt lgkmcnt(2)
    v_mfma_f32_16x16x32_bf16 v[114:117], a[52:55], v[154:157], v[114:117]
    s_waitcnt vmcnt(6)
    ds_read_b64_tr_b16 a[152:153], v143 offset:0
    ds_read_b64_tr_b16 a[154:155], v143 offset:768
    v_mfma_f32_16x16x32_bf16 v[114:117], a[56:59], v[170:173], v[114:117]
    s_waitcnt lgkmcnt(2)
    ds_read_b64_tr_b16 a[176:177], v143 offset:32
    ds_read_b64_tr_b16 a[178:179], v143 offset:800
    v_mfma_f32_16x16x32_bf16 v[114:117], a[60:63], v[174:177], v[114:117]
    ds_read_b64_tr_b16 a[200:201], v143 offset:64
    buffer_load_dwordx4 v128, s[48:51], 0 offen lds
    v_mfma_f32_16x16x32_bf16 v[114:117], a[64:67], v[178:181], v[114:117]
    ds_read_b64_tr_b16 a[202:203], v143 offset:832
    ds_read_b128 v[122:125], v0 offset:32768
    v_mfma_f32_16x16x32_bf16 v[114:117], a[68:71], v[186:189], v[114:117]
    ds_read_b128 v[154:157], v1 offset:32768
    v_cvt_pk_f16_f32 v132, v118, v119
    v_mfma_f32_16x16x32_bf16 v[170:173], a[72:75], v[190:193], 0
    ds_read_b128 v[174:177], v0 offset:32896
    v_pk_fma_f16 v138, v132, v132, v138
    v_mfma_f32_16x16x32_bf16 v[170:173], a[76:79], v[198:201], v[170:173]
    ds_read_b128 v[178:181], v1 offset:32896
    v_cvt_pk_f16_f32 v133, v120, v121
    v_mfma_f32_16x16x32_bf16 v[170:173], a[80:83], v[202:205], v[170:173]
    ds_read_b128 v[118:121], v0 offset:33024
    v_pk_fma_f16 v138, v133, v133, v138
    v_mfma_f32_16x16x32_bf16 v[170:173], a[84:87], v[206:209], v[170:173]
    s_waitcnt lgkmcnt(9)
    buffer_load_dwordx4 v134, s[48:51], 0 offen offset:1024 lds
    ds_read_b128 v[186:189], v1 offset:33024
    v_mfma_f32_16x16x32_bf16 v[170:173], a[88:91], v[210:213], v[170:173]
    s_waitcnt lgkmcnt(8)
    v_cvt_pk_f16_f32 v166, v114, v115
    v_pk_fma_f16 v138, v166, v166, v138
    v_mfma_f32_16x16x32_bf16 v[170:173], a[92:95], v[214:217], v[170:173]
    s_waitcnt lgkmcnt(7)
    v_cvt_pk_f16_f32 v167, v116, v117
    v_pk_fma_f16 v138, v167, v167, v138
    v_mfma_f32_16x16x32_bf16 v[114:117], a[96:99], v[190:193], 0
    s_waitcnt lgkmcnt(5)
    v_mov_b32 v140, v138
    v_mov_b32 v141, v138
    v_mfma_f32_16x16x32_bf16 v[114:117], a[100:103], v[198:201], v[114:117]
    s_waitcnt lgkmcnt(4)
    v_cvt_pk_f16_f32 v134, v170, v171
    v_pk_mul_f16 v171, v134, v134
    v_mfma_f32_16x16x32_f16 v[194:197], v[40:43], v[138:141], 0
    s_waitcnt vmcnt(5)
    ds_read_b64_tr_b16 a[156:157], v143 offset:3072
    buffer_load_dwordx4 v136, s[48:51], 0 offen offset:2048 lds
    v_mfma_f32_16x16x32_bf16 v[114:117], a[104:107], v[202:205], v[114:117]
    s_add_u32 m0, s69, 0
    ds_read_b64_tr_b16 a[158:159], v143 offset:3840
    ds_read_b64_tr_b16 a[180:181], v143 offset:3104
    v_mfma_f32_16x16x32_bf16 v[114:117], a[108:111], v[206:209], v[114:117]
    s_waitcnt lgkmcnt(4)
    ds_read_b64_tr_b16 a[182:183], v143 offset:3872
    ds_read_b64_tr_b16 a[204:205], v143 offset:3136
    v_mfma_f32_16x16x32_bf16 v[114:117], a[112:115], v[210:213], v[114:117]
    s_waitcnt lgkmcnt(5)
    ds_read_b64_tr_b16 a[206:207], v143 offset:3904
    v_cvt_pk_f16_f32 v135, v172, v173
    v_mfma_f32_16x16x32_bf16 v[114:117], a[116:119], v[214:217], v[114:117]
    v_rsq_f32 v194, v194
    v_mfma_f32_16x16x32_bf16 v[138:141], a[120:123], v[190:193], 0
    v_rsq_f32 v195, v195
    v_mfma_f32_16x16x32_bf16 v[138:141], a[124:127], v[198:201], v[138:141]
    buffer_load_dwordx4 v160, s[52:55], 0 offen lds
    v_mul_f32 v136, s31, v194
    v_mfma_f32_16x16x32_bf16 v[138:141], a[128:131], v[202:205], v[138:141]
    v_cvt_pk_f16_f32 v137, v136, v195
    v_pk_mul_f16 v182, v182, v137 op_sel:[0,1] op_sel_hi:[1,1]
    v_mfma_f32_16x16x32_bf16 v[138:141], a[132:135], v[206:209], v[138:141]
    s_waitcnt lgkmcnt(5)
    v_pk_mul_f16 v183, v183, v137 op_sel:[0,1] op_sel_hi:[1,1]
    v_pk_mul_f16 v184, v184, v137 op_sel:[0,1] op_sel_hi:[1,1]
    v_mfma_f32_16x16x32_bf16 v[138:141], a[136:139], v[210:213], v[138:141]
    s_waitcnt lgkmcnt(3)
    ds_read_b128 v[190:193], v147 offset:6144
    v_pk_mul_f16 v185, v185, v137 op_sel:[0,1] op_sel_hi:[1,1]
    v_mfma_f32_16x16x32_bf16 v[138:141], a[140:143], v[214:217], v[138:141]
    s_waitcnt lgkmcnt(2)
    ds_read_b128 v[198:201], v148 offset:6144
    v_pk_mul_f16 v168, v168, v137 op_sel:[0,1] op_sel_hi:[1,1]
    v_mfma_f32_16x16x32_bf16 v[202:205], a[72:75], v[122:125], 0
    s_waitcnt lgkmcnt(2)
    ds_read_b128 v[206:209], v147 offset:6272
    buffer_load_dwordx4 v161, s[52:55], 0 offen offset:1024 lds
    v_mfma_f32_16x16x32_bf16 v[202:205], a[76:79], v[154:157], v[202:205]
    ds_read_b128 v[210:213], v148 offset:6272
    v_pk_mul_f16 v169, v169, v137 op_sel:[0,1] op_sel_hi:[1,1]
    v_mfma_f32_16x16x32_bf16 v[202:205], a[80:83], v[174:177], v[202:205]
    ds_read_b128 v[214:217], v147 offset:6400
    v_pk_mul_f16 v130, v130, v137 op_sel:[0,0] op_sel_hi:[1,0]
    v_mfma_f32_16x16x32_bf16 v[202:205], a[84:87], v[178:181], v[202:205]
    ds_read_b128 v[218:221], v148 offset:6400
    v_pk_mul_f16 v131, v131, v137 op_sel:[0,0] op_sel_hi:[1,0]
    v_mfma_f32_16x16x32_bf16 v[202:205], a[88:91], v[118:121], v[202:205]
    v_pk_mul_f16 v132, v132, v137 op_sel:[0,0] op_sel_hi:[1,0]
    s_waitcnt vmcnt(5)
    v_mfma_f32_16x16x32_bf16 v[202:205], a[92:95], v[186:189], v[202:205]
    ds_read_b64_tr_b16 a[160:161], v142 offset:0
    ds_read_b64_tr_b16 a[162:163], v142 offset:768
    v_mfma_f32_16x16x32_bf16 v[222:225], a[96:99], v[122:125], 0
    s_waitcnt lgkmcnt(7)
    buffer_load_dwordx4 v126, s[52:55], 0 offen offset:2048 lds
    ds_read_b64_tr_b16 a[184:185], v142 offset:32
    v_mfma_f32_16x16x32_bf16 v[222:225], a[100:103], v[154:157], v[222:225]
    s_add_u32 s52, s52, 12288
    ds_read_b64_tr_b16 a[186:187], v142 offset:800
    ds_read_b64_tr_b16 a[208:209], v142 offset:64
    v_mfma_f32_16x16x32_bf16 v[222:225], a[104:107], v[174:177], v[222:225]
    s_addc_u32 s53, s53, 0
    ds_read_b64_tr_b16 a[210:211], v142 offset:832
    v_pk_mul_f16 v133, v133, v137 op_sel:[0,0] op_sel_hi:[1,0]
    v_mfma_f32_16x16x32_bf16 v[222:225], a[108:111], v[178:181], v[222:225]
    s_add_u32 m0, s69, 3072
    v_pk_mul_f16 v166, v166, v137 op_sel:[0,0] op_sel_hi:[1,0]
    v_pk_mul_f16 v167, v167, v137 op_sel:[0,0] op_sel_hi:[1,0]
    v_mfma_f32_16x16x32_bf16 v[222:225], a[112:115], v[118:121], v[222:225]
    s_waitcnt lgkmcnt(7)
    v_max3_u32 v44, v44, v194, v195
    v_pk_fma_f16 v171, v135, v135, v171
    v_mfma_f32_16x16x32_bf16 v[222:225], a[116:119], v[186:189], v[222:225]
    s_waitcnt lgkmcnt(6)
    v_cvt_pk_f16_f32 v136, v114, v115
    v_pk_fma_f16 v171, v136, v136, v171
    v_mfma_f32_16x16x32_bf16 v[194:197], a[120:123], v[122:125], 0
    buffer_load_dwordx4 v160, s[52:55], 0 offen lds
    v_cvt_pk_f16_f32 v137, v116, v117
    v_mfma_f32_16x16x32_bf16 v[194:197], a[124:127], v[154:157], v[194:197]
    s_waitcnt lgkmcnt(4)
    v_pk_fma_f16 v171, v137, v137, v171
    v_cvt_pk_f16_f32 v124, v138, v139
    v_mfma_f32_16x16x32_bf16 v[194:197], a[128:131], v[174:177], v[194:197]
    s_waitcnt lgkmcnt(3)
    v_pk_fma_f16 v171, v124, v124, v171
    v_cvt_pk_f16_f32 v125, v140, v141
    v_mfma_f32_16x16x32_bf16 v[194:197], a[132:135], v[178:181], v[194:197]
    s_waitcnt lgkmcnt(1)
    v_pk_fma_f16 v171, v125, v125, v171
    v_cvt_pk_f16_f32 v114, v202, v203
    v_mfma_f32_16x16x32_bf16 v[194:197], a[136:139], v[118:121], v[194:197]
    s_waitcnt lgkmcnt(0)
    ds_read_b128 v[118:121], v147 offset:0
    v_pk_mul_f16 v139, v114, v114
    v_mfma_f32_16x16x32_bf16 v[194:197], a[140:143], v[186:189], v[194:197]
    ds_read_b128 v[154:157], v148 offset:0
    buffer_load_dwordx4 v161, s[52:55], 0 offen offset:1024 lds
    v_mfma_f32_16x16x32_bf16 v[174:177], v[190:193], a[144:147], 0
    ds_read_b128 v[178:181], v147 offset:128
    v_cvt_pk_f16_f32 v115, v204, v205
    v_mfma_f32_16x16x32_bf16 v[174:177], v[198:201], a[148:151], v[174:177]
    ds_read_b128 v[186:189], v148 offset:128
    v_pk_fma_f16 v139, v115, v115, v139
    v_mfma_f32_16x16x32_bf16 v[174:177], v[206:209], a[152:155], v[174:177]
    ds_read_b128 v[202:205], v147 offset:256
    v_cvt_pk_f16_f32 v116, v222, v223
    s_waitcnt vmcnt(5)
    v_mfma_f32_16x16x32_bf16 v[174:177], v[210:213], a[156:159], v[174:177]
    ds_read_b64_tr_b16 a[164:165], v142 offset:3072
    ds_read_b64_tr_b16 a[166:167], v142 offset:3840
    v_mfma_f32_16x16x32_bf16 v[174:177], v[214:217], a[160:163], v[174:177]
    ds_read_b64_tr_b16 a[188:189], v142 offset:3104
    buffer_load_dwordx4 v126, s[52:55], 0 offen offset:2048 lds
    v_mfma_f32_16x16x32_bf16 v[226:229], v[190:193], a[168:171], 0
    s_waitcnt lgkmcnt(7)
    ds_read_b64_tr_b16 a[190:191], v142 offset:3872
    ds_read_b64_tr_b16 a[212:213], v142 offset:3136
    v_mfma_f32_16x16x32_bf16 v[226:229], v[198:201], a[172:175], v[226:229]
    s_add_u32 s52, s52, 12288
    ds_read_b64_tr_b16 a[214:215], v142 offset:3904
    ds_read_b128 v[142:145], v148 offset:256
    v_mfma_f32_16x16x32_bf16 v[226:229], v[206:209], a[176:179], v[226:229]
    s_addc_u32 s53, s53, 0
    v_pk_fma_f16 v139, v116, v116, v139
    v_cvt_pk_f16_f32 v117, v224, v225
    v_mfma_f32_16x16x32_bf16 v[226:229], v[210:213], a[180:183], v[226:229]
    s_add_u32 m0, s68, 0
    v_pk_fma_f16 v139, v117, v117, v139
    v_cvt_pk_f16_f32 v148, v194, v195
    v_mfma_f32_16x16x32_bf16 v[226:229], v[214:217], a[184:187], v[226:229]
    s_waitcnt lgkmcnt(7)
    v_pk_fma_f16 v139, v148, v148, v139
    v_cvt_pk_f16_f32 v149, v196, v197
    v_mfma_f32_16x16x32_bf16 v[194:197], v[190:193], a[192:195], 0
    buffer_load_dwordx4 v160, s[52:55], 0 offen lds
    v_pk_fma_f16 v139, v149, v149, v139
    v_mfma_f32_16x16x32_bf16 v[194:197], v[198:201], a[196:199], v[194:197]
    s_waitcnt lgkmcnt(5)
    v_xor_b32 v255, 65536, v2
    v_lshrrev_b32 v128, 2, v255
    v_mfma_f32_16x16x32_bf16 v[174:177], v[218:221], a[164:167], v[174:177]
    s_waitcnt lgkmcnt(4)
    v_lshrrev_b32 v163, 8, v255
    v_lshl_add_u32 v164, s16, 2, v255
    v_mfma_f32_16x16x32_bf16 v[194:197], v[206:209], a[200:203], v[194:197]
    s_waitcnt lgkmcnt(2)
    v_add_u32 v128, 62784, v128
    v_lshlrev_b32 v163, 4, v163
    v_mfma_f32_16x16x32_bf16 v[226:229], v[218:221], a[188:191], v[226:229]
    s_waitcnt lgkmcnt(0)
    v_cvt_pk_bf16_f32 v174, v174, 0
    v_cvt_pk_bf16_f32 v175, v175, 0
    v_mfma_f32_16x16x32_bf16 v[194:197], v[210:213], a[204:207], v[194:197]
    s_barrier
    ds_write2_b32 v152, v174, v175 offset0:0 offset1:68
    v_mfma_f32_16x16x32_bf16 v[194:197], v[214:217], a[208:211], v[194:197]
    buffer_load_dwordx4 v161, s[52:55], 0 offen offset:1024 lds
    v_cvt_pk_bf16_f32 v176, v176, 0
    v_mfma_f32_16x16x32_bf16 v[194:197], v[218:221], a[212:215], v[194:197]
    v_cvt_pk_bf16_f32 v177, v177, 0
    v_cvt_pk_bf16_f32 v226, v226, 0
    v_mfma_f32_16x16x32_bf16 v[190:193], v[118:121], a[144:147], 0
    ds_write2_b32 v152, v176, v177 offset0:136 offset1:204
    s_waitcnt vmcnt(5)
    v_mfma_f32_16x16x32_bf16 v[190:193], v[154:157], a[148:151], v[190:193]
    v_cvt_pk_bf16_f32 v227, v227, 0
    v_cvt_pk_bf16_f32 v228, v228, 0
    v_mfma_f32_16x16x32_bf16 v[190:193], v[178:181], a[152:155], v[190:193]
    ds_read_b64 a[216:217], v129 offset:0
    ds_read_b64 a[218:219], v129 offset:1536
    v_mfma_f32_16x16x32_bf16 v[190:193], v[186:189], a[156:159], v[190:193]
    buffer_load_dwordx4 v126, s[52:55], 0 offen offset:2048 lds
    ds_read_b64 a[240:241], v129 offset:8
    v_mfma_f32_16x16x32_bf16 v[190:193], v[202:205], a[160:163], v[190:193]
    s_add_u32 s52, s52, 12288
    ds_read_b64 a[242:243], v129 offset:1544
    ds_read_b64 v[90:91], v162 offset:0
    v_mfma_f32_16x16x32_bf16 v[190:193], v[142:145], a[164:167], v[190:193]
    s_addc_u32 s53, s53, 0
    ds_read_b64 v[92:93], v162 offset:1536
    ds_read_b128 v[174:177], v0 offset:26624
    v_mfma_f32_16x16x32_bf16 v[198:201], v[118:121], a[168:171], 0
    s_add_u32 m0, s68, 3072
    ds_read_b128 v[206:209], v1 offset:26624
    v_cvt_pk_bf16_f32 v229, v229, 0
    v_mfma_f32_16x16x32_bf16 v[198:201], v[154:157], a[172:175], v[198:201]
    s_mul_i32 s68, s78, 72
    ds_read_b128 v[210:213], v0 offset:26752
    v_cvt_pk_bf16_f32 v194, v194, 0
    v_mfma_f32_16x16x32_bf16 v[198:201], v[178:181], a[176:179], v[198:201]
    s_sub_u32 s68, s77, s68
    ds_read_b128 v[214:217], v1 offset:26752
    buffer_load_dwordx4 v160, s[52:55], 0 offen lds
    v_mfma_f32_16x16x32_bf16 v[198:201], v[186:189], a[180:183], v[198:201]
    s_mul_i32 s78, s78, 1373568
    ds_read_b128 v[218:221], v0 offset:26880
    v_cvt_pk_bf16_f32 v195, v195, 0
    v_mfma_f32_16x16x32_bf16 v[198:201], v[202:205], a[184:187], v[198:201]
    s_mul_i32 s77, s68, 2688
    ds_read_b128 v[222:225], v1 offset:26880
    v_cvt_pk_bf16_f32 v196, v196, 0
    v_mfma_f32_16x16x32_bf16 v[198:201], v[142:145], a[188:191], v[198:201]
    s_add_u32 s77, s77, s78
    ds_write2_b32 v152, v226, v227 offset0:16 offset1:84
    v_mfma_f32_16x16x32_bf16 v[230:233], v[118:121], a[192:195], 0
    s_waitcnt lgkmcnt(7)
    v_cvt_pk_bf16_f32 v197, v197, 0
    v_cvt_pk_bf16_f32 v190, v190, 0
    v_mfma_f32_16x16x32_bf16 v[230:233], v[154:157], a[196:199], v[230:233]
    s_waitcnt lgkmcnt(5)
    ds_write2_b32 v152, v228, v229 offset0:152 offset1:220
    v_mfma_f32_16x16x32_bf16 v[230:233], v[178:181], a[200:203], v[230:233]
    s_waitcnt lgkmcnt(5)
    buffer_load_dwordx4 v161, s[52:55], 0 offen offset:1024 lds
    v_cvt_pk_bf16_f32 v191, v191, 0
    v_mfma_f32_16x16x32_bf16 v[230:233], v[186:189], a[204:207], v[230:233]
    s_waitcnt lgkmcnt(4)
    ds_write2_b32 v152, v194, v195 offset0:32 offset1:100
    v_mfma_f32_16x16x32_bf16 v[230:233], v[202:205], a[208:211], v[230:233]
    s_waitcnt lgkmcnt(4)
    s_waitcnt vmcnt(5)
    v_cvt_pk_bf16_f32 v192, v192, 0
    v_mfma_f32_16x16x32_bf16 v[230:233], v[142:145], a[212:215], v[230:233]
    s_waitcnt lgkmcnt(3)
    ds_read_b64 a[232:233], v129 offset:3072
    ds_read_b64 a[220:221], v129 offset:4608
    v_mfma_f32_16x16x32_bf16 v[118:121], a[0:3], v[174:177], 0
    ds_read_b64 v[82:83], v129 offset:3080
    ds_read_b64 a[244:245], v129 offset:4616
    v_mfma_f32_16x16x32_bf16 v[118:121], a[4:7], v[206:209], v[118:121]
    buffer_load_dwordx4 v126, s[52:55], 0 offen offset:2048 lds
    ds_read_b64 v[106:107], v162 offset:3072
    v_mfma_f32_16x16x32_bf16 v[118:121], a[8:11], v[210:213], v[118:121]
    s_add_u32 s52, s52, 12288
    ds_read_b64 v[94:95], v162 offset:4608
    v_cvt_pk_bf16_f32 v193, v193, 0
    v_mfma_f32_16x16x32_bf16 v[118:121], a[12:15], v[214:217], v[118:121]
    s_addc_u32 s53, s53, 0
    ds_write2_b32 v152, v196, v197 offset0:168 offset1:236
    v_mfma_f32_16x16x32_bf16 v[118:121], a[16:19], v[218:221], v[118:121]
    s_add_u32 m0, s69, 0
    v_cvt_pk_bf16_f32 v198, v198, 0
    v_cvt_pk_bf16_f32 v199, v199, 0
    v_mfma_f32_16x16x32_bf16 v[118:121], a[20:23], v[222:225], v[118:121]
    ds_write2_b32 v150, v190, v191 offset0:0 offset1:68
    v_mfma_f32_16x16x32_bf16 v[142:145], a[24:27], v[174:177], 0
    s_waitcnt lgkmcnt(6)
    buffer_load_dwordx4 v160, s[52:55], 0 offen lds
    v_cvt_pk_bf16_f32 v200, v200, 0
    v_mfma_f32_16x16x32_bf16 v[142:145], a[28:31], v[206:209], v[142:145]
    s_waitcnt lgkmcnt(4)
    ds_write2_b32 v150, v192, v193 offset0:136 offset1:204
    v_mfma_f32_16x16x32_bf16 v[142:145], a[32:35], v[210:213], v[142:145]
    s_waitcnt lgkmcnt(4)
    v_cvt_pk_bf16_f32 v201, v201, 0
    v_cvt_pk_bf16_f32 v230, v230, 0
    v_mfma_f32_16x16x32_bf16 v[142:145], a[36:39], v[214:217], v[142:145]
    s_waitcnt lgkmcnt(3)
    ds_write2_b32 v150, v198, v199 offset0:16 offset1:84
    v_mfma_f32_16x16x32_bf16 v[142:145], a[40:43], v[218:221], v[142:145]
    v_cvt_pk_bf16_f32 v231, v231, 0
    v_cvt_pk_bf16_f32 v232, v232, 0
    v_mfma_f32_16x16x32_bf16 v[142:145], a[44:47], v[222:225], v[142:145]
    buffer_load_dwordx4 v161, s[52:55], 0 offen offset:1024 lds
    v_cvt_pk_bf16_f32 v233, v233, 0
    v_mfma_f32_16x16x32_bf16 v[154:157], a[48:51], v[174:177], 0
    ds_write2_b32 v150, v200, v201 offset0:152 offset1:220
    v_mfma_f32_16x16x32_bf16 v[154:157], a[52:55], v[206:209], v[154:157]
    v_cvt_pk_f16_f32 v118, v118, v119
    v_pk_mul_f16 v170, v118, v118
    v_mfma_f32_16x16x32_bf16 v[154:157], a[56:59], v[210:213], v[154:157]
    ds_write2_b32 v150, v230, v231 offset0:32 offset1:100
    s_waitcnt vmcnt(5)
    v_mfma_f32_16x16x32_bf16 v[154:157], a[60:63], v[214:217], v[154:157]
    v_cvt_pk_f16_f32 v119, v120, v121
    v_pk_fma_f16 v170, v119, v119, v170
    v_mfma_f32_16x16x32_bf16 v[154:157], a[64:67], v[218:221], v[154:157]
    buffer_load_dwordx4 v126, s[52:55], 0 offen offset:2048 lds
    ds_read_b64 a[222:223], v254 offset:0
    v_mfma_f32_16x16x32_bf16 v[154:157], a[68:71], v[222:225], v[154:157]
    s_add_u32 s52, s52, 12288
    ds_read_b64 a[234:235], v254 offset:1536
    ds_read_b64 a[246:247], v254 offset:8
    v_mfma_f32_16x16x32_bf16 v[178:181], v[174:177], a[144:147], 0
    s_addc_u32 s53, s53, 0
    ds_read_b64 v[84:85], v254 offset:1544
    ds_read_b64 v[96:97], v127 offset:0
    v_mfma_f32_16x16x32_bf16 v[178:181], v[206:209], a[148:151], v[178:181]
    s_add_u32 m0, s69, 3072
    ds_read_b64 v[108:109], v127 offset:1536
    v_cvt_pk_f16_f32 v120, v142, v143
    v_mfma_f32_16x16x32_bf16 v[178:181], v[210:213], a[152:155], v[178:181]
    s_add_u32 s69, s77, 589824
    ds_write2_b32 v150, v232, v233 offset0:168 offset1:236
    v_mfma_f32_16x16x32_bf16 v[178:181], v[214:217], a[156:159], v[178:181]
    buffer_load_dwordx4 v160, s[52:55], 0 offen lds
    v_pk_fma_f16 v170, v120, v120, v170
    v_mfma_f32_16x16x32_bf16 v[178:181], v[218:221], a[160:163], v[178:181]
    v_cvt_pk_f16_f32 v121, v144, v145
    v_pk_fma_f16 v170, v121, v121, v170
    v_mfma_f32_16x16x32_bf16 v[178:181], v[222:225], a[164:167], v[178:181]
    ds_read_b128 v[142:145], v0 offset:20480
    v_cvt_pk_f16_f32 v122, v154, v155
    v_mfma_f32_16x16x32_bf16 v[150:153], v[174:177], a[168:171], 0
    s_waitcnt lgkmcnt(6)
    ds_read_b128 v[186:189], v1 offset:20480
    v_pk_fma_f16 v170, v122, v122, v170
    v_mfma_f32_16x16x32_bf16 v[150:153], v[206:209], a[172:175], v[150:153]
    s_waitcnt lgkmcnt(5)
    ds_read_b128 v[190:193], v0 offset:20608
    v_cvt_pk_f16_f32 v123, v156, v157
    v_mfma_f32_16x16x32_bf16 v[150:153], v[210:213], a[176:179], v[150:153]
    s_waitcnt lgkmcnt(4)
    ds_read_b128 v[154:157], v1 offset:20608
    buffer_load_dwordx4 v161, s[52:55], 0 offen offset:1024 lds
    v_mfma_f32_16x16x32_bf16 v[150:153], v[214:217], a[180:183], v[150:153]
    ds_read_b128 v[194:197], v0 offset:20736
    v_pk_fma_f16 v170, v123, v123, v170
    v_mfma_f32_16x16x32_bf16 v[150:153], v[218:221], a[184:187], v[150:153]
    ds_read_b128 v[198:201], v1 offset:20736
    v_mov_b32 v172, v170
    v_mfma_f32_16x16x32_bf16 v[150:153], v[222:225], a[188:191], v[150:153]
    v_mov_b32 v173, v170
    v_cvt_pk_bf16_f32 v204, v178, v179
    v_mfma_f32_16x16x32_bf16 v[226:229], v[174:177], a[192:195], 0
    v_cvt_pk_bf16_f32 v205, v180, v181
    s_waitcnt vmcnt(5)
    v_mfma_f32_16x16x32_f16 v[174:177], v[40:43], v[170:173], 0
    s_waitcnt lgkmcnt(5)
    ds_read_b64 a[224:225], v254 offset:3072
    ds_read_b64 a[226:227], v254 offset:4608
    v_mfma_f32_16x16x32_bf16 v[226:229], v[206:209], a[196:199], v[226:229]
    s_waitcnt lgkmcnt(6)
    buffer_load_dwordx4 v126, s[52:55], 0 offen offset:2048 lds
    ds_read_b64 a[248:249], v254 offset:3080
    v_mfma_f32_16x16x32_bf16 v[226:229], v[210:213], a[200:203], v[226:229]
    s_add_u32 m0, s28, 65536
    ds_read_b64 a[250:251], v254 offset:4616
    ds_read_b64 v[98:99], v127 offset:3072
    v_mfma_f32_16x16x32_bf16 v[226:229], v[214:217], a[204:207], v[226:229]
    s_waitcnt lgkmcnt(7)
    ds_read_b64 v[100:101], v127 offset:4608
    v_cvt_pk_bf16_f32 v172, v150, v151
    v_mfma_f32_16x16x32_bf16 v[226:229], v[218:221], a[208:211], v[226:229]
    s_waitcnt lgkmcnt(7)
    v_rsq_f32 v174, v174
    v_mfma_f32_16x16x32_bf16 v[226:229], v[222:225], a[212:215], v[226:229]
    s_waitcnt lgkmcnt(6)
    v_rsq_f32 v175, v175
    v_mfma_f32_16x16x32_bf16 v[178:181], v[142:145], a[144:147], 0
    v_mul_f32 v126, s31, v174
    v_cvt_pk_f16_f32 v127, v126, v175
    v_mfma_f32_16x16x32_bf16 v[178:181], v[186:189], a[148:151], v[178:181]
    buffer_load_dwordx4 v10, s[8:11], s24 offen nt lds
    v_mfma_f32_16x16x32_bf16 v[178:181], v[190:193], a[152:155], v[178:181]
    s_add_u32 m0, s28, 69632
    v_pk_mul_f16 v134, v134, v127 op_sel:[0,1] op_sel_hi:[1,1]
    v_pk_mul_f16 v135, v135, v127 op_sel:[0,1] op_sel_hi:[1,1]
    v_mfma_f32_16x16x32_bf16 v[178:181], v[154:157], a[156:159], v[178:181]
    s_waitcnt lgkmcnt(3)
    v_pk_mul_f16 v136, v136, v127 op_sel:[0,1] op_sel_hi:[1,1]
    v_pk_mul_f16 v137, v137, v127 op_sel:[0,1] op_sel_hi:[1,1]
    v_mfma_f32_16x16x32_bf16 v[178:181], v[194:197], a[160:163], v[178:181]
    s_waitcnt lgkmcnt(1)
    v_pk_mul_f16 v124, v124, v127 op_sel:[0,1] op_sel_hi:[1,1]
    v_pk_mul_f16 v125, v125, v127 op_sel:[0,1] op_sel_hi:[1,1]
    v_mfma_f32_16x16x32_bf16 v[178:181], v[198:201], a[164:167], v[178:181]
    s_waitcnt lgkmcnt(0)
    ds_read_b128 v[206:209], v0 offset:32768
    v_pk_mul_f16 v118, v118, v127 op_sel:[0,0] op_sel_hi:[1,0]
    v_mfma_f32_16x16x32_bf16 v[210:213], v[142:145], a[168:171], 0
    ds_read_b128 v[214:217], v1 offset:32768
    v_pk_mul_f16 v119, v119, v127 op_sel:[0,0] op_sel_hi:[1,0]
    v_mfma_f32_16x16x32_bf16 v[210:213], v[186:189], a[172:175], v[210:213]
    buffer_load_dwordx4 v11, s[8:11], s24 offen nt lds
    v_mfma_f32_16x16x32_bf16 v[210:213], v[190:193], a[176:179], v[210:213]
    s_add_u32 m0, s28, 73728
    ds_read_b128 v[218:221], v0 offset:32896
    ds_read_b128 v[222:225], v1 offset:32896
    v_mfma_f32_16x16x32_bf16 v[210:213], v[154:157], a[180:183], v[210:213]
    ds_read_b128 v[230:233], v0 offset:33024
    v_pk_mul_f16 v120, v120, v127 op_sel:[0,0] op_sel_hi:[1,0]
    v_mfma_f32_16x16x32_bf16 v[210:213], v[194:197], a[184:187], v[210:213]
    ds_read_b128 v[234:237], v1 offset:33024
    s_waitcnt vmcnt(5)
    v_mfma_f32_16x16x32_bf16 v[210:213], v[198:201], a[188:191], v[210:213]
    ds_read_b64 a[236:237], v129 offset:0
    ds_read_b64 a[228:229], v129 offset:1536
    v_mfma_f32_16x16x32_bf16 v[238:241], v[142:145], a[192:195], 0
    ds_read_b64 v[86:87], v129 offset:8
    ds_read_b64 a[252:253], v129 offset:1544
    v_mfma_f32_16x16x32_bf16 v[238:241], v[186:189], a[196:199], v[238:241]
    s_waitcnt lgkmcnt(9)
    buffer_load_dwordx4 v12, s[8:11], s24 offen nt lds
    v_mfma_f32_16x16x32_bf16 v[238:241], v[190:193], a[200:203], v[238:241]
    s_add_u32 m0, s28, 77824
    ds_read_b64 v[110:111], v162 offset:0
    ds_read_b64 v[102:103], v162 offset:1536
    v_mfma_f32_16x16x32_bf16 v[238:241], v[154:157], a[204:207], v[238:241]
    s_waitcnt lgkmcnt(10)
    ds_read_b128 v[142:145], v146 offset:0
    ds_read_b128 v[154:157], v146 offset:16
    v_mfma_f32_16x16x32_bf16 v[238:241], v[194:197], a[208:211], v[238:241]
    s_waitcnt lgkmcnt(10)
    ds_read_b128 v[186:189], v146 offset:48
    ds_read_b32 v254, v6 offset:192
    v_mfma_f32_16x16x32_bf16 v[238:241], v[198:201], a[212:215], v[238:241]
    s_waitcnt lgkmcnt(11)
    v_pk_mul_f16 v121, v121, v127 op_sel:[0,0] op_sel_hi:[1,0]
    v_pk_mul_f16 v122, v122, v127 op_sel:[0,0] op_sel_hi:[1,0]
    v_mfma_f32_16x16x32_bf16 v[190:193], a[0:3], v[206:209], 0
    s_waitcnt lgkmcnt(10)
    v_pk_mul_f16 v123, v123, v127 op_sel:[0,0] op_sel_hi:[1,0]
    v_max3_u32 v44, v44, v174, v175
    v_mfma_f32_16x16x32_bf16 v[190:193], a[4:7], v[214:217], v[190:193]
    s_waitcnt lgkmcnt(8)
    buffer_load_dwordx4 v13, s[8:11], s24 offen nt lds
    v_mfma_f32_16x16x32_bf16 v[190:193], a[8:11], v[218:221], v[190:193]
    s_add_u32 m0, s74, 0
    v_cvt_pk_bf16_f32 v173, v152, v153
    v_cvt_pk_bf16_f32 v152, v226, v227
    v_mfma_f32_16x16x32_bf16 v[190:193], a[12:15], v[222:225], v[190:193]
    s_waitcnt lgkmcnt(6)
    v_cvt_pk_bf16_f32 v153, v228, v229
    v_cvt_pk_bf16_f32 v202, v178, v179
    v_mfma_f32_16x16x32_bf16 v[190:193], a[16:19], v[230:233], v[190:193]
    s_waitcnt lgkmcnt(4)
    v_cvt_pk_bf16_f32 v203, v180, v181
    v_cvt_pk_bf16_f32 v170, v210, v211
    v_mfma_f32_16x16x32_bf16 v[190:193], a[20:23], v[234:237], v[190:193]
    s_waitcnt lgkmcnt(2)
    v_cvt_pk_bf16_f32 v171, v212, v213
    v_cvt_pk_bf16_f32 v150, v238, v239
    v_mfma_f32_16x16x32_bf16 v[174:177], a[24:27], v[206:209], 0
    s_waitcnt lgkmcnt(0)
    v_cvt_pk_bf16_f32 v151, v240, v241
    v_xor_b32 v0, 65536, v0
    v_mfma_f32_16x16x32_bf16 v[174:177], a[28:31], v[214:217], v[174:177]
    buffer_load_dwordx4 v14, s[8:11], s24 offen nt lds
    v_mfma_f32_16x16x32_bf16 v[174:177], a[32:35], v[218:221], v[174:177]
    s_add_u32 s8, s60, s23
    v_cvt_pk_f16_f32 v178, v190, v191
    s_waitcnt vmcnt(5)
    v_mfma_f32_16x16x32_bf16 v[174:177], a[36:39], v[222:225], v[174:177]
    s_addc_u32 s9, s61, 0
    ds_read_b64 a[230:231], v129 offset:3072
    ds_read_b64 a[238:239], v129 offset:4608
    v_mfma_f32_16x16x32_bf16 v[174:177], a[40:43], v[230:233], v[174:177]
    s_sub_u32 s10, s36, s23
    ds_read_b64 a[254:255], v129 offset:3080
    ds_read_b64 v[88:89], v129 offset:4616
    v_mfma_f32_16x16x32_bf16 v[174:177], a[44:47], v[234:237], v[174:177]
    s_cmp_lt_u32 s34, s17
    ds_read_b64 v[104:105], v162 offset:3072
    ds_read_b64 v[112:113], v162 offset:4608
    v_mfma_f32_16x16x32_bf16 v[194:197], a[48:51], v[206:209], 0
    s_cselect_b32 s10, s10, 0
    v_pk_mul_f16 v138, v178, v178
    v_cvt_pk_f16_f32 v179, v192, v193
    v_mfma_f32_16x16x32_bf16 v[194:197], a[52:55], v[214:217], v[194:197]
    s_add_u32 m0, s28, 0
    v_pk_fma_f16 v138, v179, v179, v138
    v_cvt_pk_f16_f32 v180, v174, v175
    v_mfma_f32_16x16x32_f16 v[190:193], v[182:185], v[130:133], v[46:49]
    s_mov_b32 s24, s23
    v_pk_fma_f16 v138, v180, v180, v138
    v_cvt_pk_f16_f32 v181, v176, v177
    v_mfma_f32_16x16x32_f16 v[174:177], v[134:137], v[130:133], v[50:53]
    s_add_u32 s23, s23, s21
    v_pk_fma_f16 v138, v181, v181, v138
    v_xor_b32 v1, 65536, v1
    v_add_u32 v163, 62784, v163
    v_mfma_f32_16x16x16_f16 v[190:193], v[168:169], v[166:167], v[190:193]
    v_or_b32 v198, v32, v33
    v_and_b32 v198, 0xffff, v198
    v_lshl_or_b32 v198, v198, 16, v198
    v_mfma_f32_16x16x16_f16 v[174:177], v[124:125], v[166:167], v[174:177]
    v_or_b32 v199, v32, v33
    v_and_b32 v199, 0xffff, v199
    v_lshl_or_b32 v199, v199, 16, v199
    v_or_b32 v200, v32, v33
    v_mfma_f32_16x16x32_bf16 v[194:197], a[56:59], v[218:221], v[194:197]
    s_cmp_ge_u32 s19, 72
    v_exp_f32 v190, v190
    v_mfma_f32_16x16x32_bf16 v[194:197], a[60:63], v[222:225], v[194:197]
    s_cselect_b32 s34, 72, 0
    v_exp_f32 v191, v191
    v_mfma_f32_16x16x32_bf16 v[194:197], a[64:67], v[230:233], v[194:197]
    s_cselect_b32 s35, s22, 0
    v_cvt_pk_bf16_f32 v190, v190, v191
    v_lshrrev_b32 v200, 16, v200
    v_mfma_f32_16x16x32_bf16 v[194:197], a[68:71], v[234:237], v[194:197]
    s_sub_u32 s19, s19, s34
    v_exp_f32 v192, v192
    v_mfma_f32_16x16x32_bf16 v[210:213], v[206:209], a[144:147], 0
    s_add_u32 s23, s23, s35
    v_exp_f32 v193, v193
    v_mfma_f32_16x16x32_bf16 v[210:213], v[214:217], a[148:151], v[210:213]
    s_waitcnt lgkmcnt(0)
    v_cvt_pk_bf16_f32 v191, v192, v193
    v_cvt_pk_f16_f32 v146, v194, v195
    v_mfma_f32_16x16x32_bf16 v[210:213], v[218:221], a[152:155], v[210:213]
    v_pk_fma_f16 v138, v146, v146, v138
    v_cvt_pk_f16_f32 v147, v196, v197
    v_mfma_f32_16x16x32_bf16 v[210:213], v[222:225], a[156:159], v[210:213]
    v_pk_fma_f16 v138, v147, v147, v138
    v_mov_b32 v140, v138
    v_mfma_f32_16x16x32_f16 v[194:197], v[142:145], v[130:133], v[22:25]
    v_mov_b32 v141, v138
    v_lshl_or_b32 v200, v200, 16, v200
    v_mfma_f32_16x16x32_f16 v[194:197], v[154:157], v[182:185], v[194:197]
    v_exp_f32 v174, v174
    v_mfma_f32_16x16x32_f16 v[226:229], v[40:43], v[138:141], 0
    v_exp_f32 v175, v175
    v_mfma_f32_16x16x32_f16 v[194:197], v[186:189], v[166:169], v[194:197]
    v_cvt_pk_bf16_f32 v192, v174, v175
    v_or_b32 v201, v32, v33
    v_mfma_f32_16x16x32_bf16 v[210:213], v[230:233], a[160:163], v[210:213]
    v_exp_f32 v176, v176
    v_mfma_f32_16x16x32_bf16 v[210:213], v[234:237], a[164:167], v[210:213]
    v_exp_f32 v177, v177
    v_mfma_f32_16x16x32_bf16 v[138:141], v[206:209], a[168:171], 0
    v_rsq_f32 v226, v226
    v_mfma_f32_16x16x32_bf16 v[138:141], v[214:217], a[172:175], v[138:141]
    v_rsq_f32 v227, v227
    v_mfma_f32_16x16x32_bf16 v[138:141], v[218:221], a[176:179], v[138:141]
    v_mul_f32 v160, s31, v226
    v_cvt_pk_f16_f32 v161, v160, v227
    v_mfma_f32_16x16x32_bf16 v[138:141], v[222:225], a[180:183], v[138:141]
    v_pk_mul_f16 v114, v114, v161 op_sel:[0,1] op_sel_hi:[1,1]
    v_pk_mul_f16 v115, v115, v161 op_sel:[0,1] op_sel_hi:[1,1]
    v_mfma_f32_16x16x32_bf16 v[138:141], v[230:233], a[184:187], v[138:141]
    v_pk_mul_f16 v116, v116, v161 op_sel:[0,1] op_sel_hi:[1,1]
    v_pk_mul_f16 v117, v117, v161 op_sel:[0,1] op_sel_hi:[1,1]
    v_mfma_f32_16x16x32_bf16 v[138:141], v[234:237], a[188:191], v[138:141]
    v_pk_mul_f16 v148, v148, v161 op_sel:[0,1] op_sel_hi:[1,1]
    v_pk_mul_f16 v149, v149, v161 op_sel:[0,1] op_sel_hi:[1,1]
    v_pk_mul_f16 v178, v178, v161 op_sel:[0,0] op_sel_hi:[1,0]
    v_pk_mul_f16 v179, v179, v161 op_sel:[0,0] op_sel_hi:[1,0]
    v_pk_mul_f16 v180, v180, v161 op_sel:[0,0] op_sel_hi:[1,0]
    v_pk_mul_f16 v181, v181, v161 op_sel:[0,0] op_sel_hi:[1,0]
    v_pk_mul_f16 v146, v146, v161 op_sel:[0,0] op_sel_hi:[1,0]
    v_pk_mul_f16 v147, v147, v161 op_sel:[0,0] op_sel_hi:[1,0]
    v_mfma_f32_16x16x32_f16 v[238:241], v[114:117], v[130:133], v[54:57]
    v_max3_u32 v44, v44, v226, v227
    v_cvt_pk_bf16_f32 v130, v210, v211
    v_mfma_f32_16x16x32_f16 v[226:229], v[142:145], v[118:121], v[24:27]
    v_cvt_pk_bf16_f32 v131, v212, v213
    v_cvt_pk_bf16_f32 v138, v138, v139
    v_mfma_f32_16x16x32_f16 v[226:229], v[154:157], v[134:137], v[226:229]
    v_cvt_pk_bf16_f32 v139, v140, v141
    v_mov_b32_dpp v254, v195 quad_perm:[0,1,2,3] row_mask:0x1 bank_mask:0xf
    v_mov_b32 v25, 0
    v_mfma_f32_16x16x16_f16 v[238:241], v[148:149], v[166:167], v[238:241]
    v_cvt_pk_bf16_f32 v193, v176, v177
    v_exp_f32 v194, v194
    v_lshrrev_b32 v201, 16, v201
    v_mfma_f32_16x16x32_f16 v[226:229], v[186:189], v[122:125], v[226:229]
    v_cvt_pk_bf16_f32 v39, v194, 0
    v_lshl_or_b32 v201, v201, 16, v201
    v_mfma_f32_16x16x32_bf16 v[174:177], v[206:209], a[192:195], 0
    v_xor_b32 v2, 65536, v2
    v_mfma_f32_16x16x32_bf16 v[174:177], v[214:217], a[196:199], v[174:177]
    ds_read2_b32 v[132:133], v6 offset0:0 offset1:0
    ds_read2_b32 v[140:141], v6 offset0:16 offset1:16
    v_mfma_f32_16x16x32_bf16 v[174:177], v[218:221], a[200:203], v[174:177]
    ds_read2_b32 v[196:197], v6 offset0:32 offset1:32
    v_add_u32 v6, 272, v6
    v_mfma_f32_16x16x32_f16 v[206:209], v[142:145], v[178:181], v[26:29]
    v_exp_f32 v226, v226
    v_mfma_f32_16x16x32_f16 v[206:209], v[154:157], v[114:117], v[206:209]
    v_exp_f32 v238, v238
    v_mfma_f32_16x16x32_f16 v[206:209], v[186:189], v[146:149], v[206:209]
    v_exp_f32 v239, v239
    v_mfma_f32_16x16x32_bf16 v[174:177], v[222:225], a[204:207], v[174:177]
    v_mov_b32_dpp v254, v227 quad_perm:[0,1,2,3] row_mask:0x2 bank_mask:0xf
    v_cvt_pk_bf16_f32 v36, v238, v239
    v_mfma_f32_16x16x32_bf16 v[174:177], v[230:233], a[208:211], v[174:177]
    v_exp_f32 v240, v240
    v_mfma_f32_16x16x32_bf16 v[174:177], v[234:237], a[212:215], v[174:177]
    v_exp_f32 v241, v241
    v_mfma_f32_16x16x32_f16 v[142:145], v[182:185], v[118:121], v[58:61]
    s_waitcnt lgkmcnt(1)
    v_mov_b32_dpp v254, v207 quad_perm:[0,1,2,3] row_mask:0x4 bank_mask:0xf
    v_cvt_pk_bf16_f32 v37, v240, v241
    v_mfma_f32_16x16x32_f16 v[154:157], v[134:137], v[118:121], v[62:65]
    s_waitcnt lgkmcnt(0)
    v_exp_f32 v254, v254
    v_mfma_f32_16x16x32_bf16 v[186:189], v[28:31], v[36:39], 0
    v_cvt_pk_bf16_f32 v194, v174, v175
    v_cvt_pk_bf16_f32 v195, v176, v177
    v_mfma_f32_16x16x32_bf16 v[186:189], v[28:31], v[190:193], v[186:189]
    v_exp_f32 v206, v206
    v_mfma_f32_16x16x32_bf16 v[174:177], v[202:205], v[190:193], 0
    v_cvt_pk_bf16_f32 v254, v254, v254
    v_mfma_f32_16x16x32_bf16 v[174:177], v[130:133], v[36:39], v[174:177]
    ds_write_b16 v8, v254
    v_mfma_f32_16x16x32_bf16 v[210:213], v[138:141], v[36:39], 0
    v_mfma_f32_16x16x32_bf16 v[210:213], v[170:173], v[190:193], v[210:213]
    v_mfma_f32_16x16x32_bf16 v[214:217], v[150:153], v[190:193], 0
    v_rcp_f32 v187, v186
    v_mfma_f32_16x16x32_bf16 v[214:217], v[194:197], v[36:39], v[214:217]
    v_cvt_pk_bf16_f32 v39, v226, 0
    v_max3_u32 v25, v25, v187, v186
    v_mfma_f32_16x16x32_f16 v[190:193], v[114:117], v[118:121], v[66:69]
    v_mul_f32 v174, v187, v174
    v_mul_f32 v175, v187, v175
    v_cvt_pk_bf16_f32 v118, v174, v175
    v_mfma_f32_16x16x16_f16 v[142:145], v[168:169], v[122:123], v[142:145]
    v_mul_f32 v176, v187, v176
    v_mul_f32 v177, v187, v177
    v_cvt_pk_bf16_f32 v119, v176, v177
    v_mfma_f32_16x16x16_f16 v[154:157], v[124:125], v[122:123], v[154:157]
    v_mul_f32 v210, v187, v210
    v_mul_f32 v211, v187, v211
    v_cvt_pk_bf16_f32 v120, v210, v211
    v_mfma_f32_16x16x16_f16 v[190:193], v[148:149], v[122:123], v[190:193]
    v_exp_f32 v142, v142
    v_exp_f32 v143, v143
    v_mfma_f32_16x16x32_f16 v[174:177], v[182:185], v[178:181], v[70:73]
    v_cvt_pk_bf16_f32 v122, v142, v143
    v_mul_f32 v212, v187, v212
    v_mfma_f32_16x16x32_bf16 v[182:185], v[198:201], a[216:219], 0
    v_exp_f32 v144, v144
    v_mfma_f32_16x16x32_f16 v[218:221], v[134:137], v[178:181], v[74:77]
    v_exp_f32 v145, v145
    v_mul_f32 v213, v187, v213
    v_mfma_f32_16x16x16_f16 v[174:177], v[168:169], v[146:147], v[174:177]
    v_cvt_pk_bf16_f32 v123, v144, v145
    v_exp_f32 v154, v154
    v_cvt_pk_bf16_f32 v121, v212, v213
    v_mfma_f32_16x16x32_f16 v[134:137], v[114:117], v[178:181], v[78:81]
    v_exp_f32 v155, v155
    v_mul_f32 v214, v187, v214
    v_mfma_f32_16x16x16_f16 v[218:221], v[124:125], v[146:147], v[218:221]
    v_cvt_pk_bf16_f32 v124, v154, v155
    v_exp_f32 v156, v156
    v_mul_f32 v215, v187, v215
    v_mfma_f32_16x16x16_f16 v[134:137], v[148:149], v[146:147], v[134:137]
    v_exp_f32 v157, v157
    v_exp_f32 v190, v190
    v_mfma_f32_16x16x32_bf16 v[182:185], v[198:201], a[240:243], v[182:185]
    v_cvt_pk_bf16_f32 v125, v156, v157
    v_cvt_pk_bf16_f32 v160, v214, v215
    v_mfma_f32_16x16x32_bf16 v[182:185], v[198:201], v[90:93], v[182:185]
    v_exp_f32 v191, v191
    v_mfma_f32_16x16x32_bf16 v[114:117], v[198:201], a[220:223], 0
    v_cvt_pk_bf16_f32 v36, v190, v191
    v_mul_f32 v216, v187, v216
    v_mfma_f32_16x16x32_bf16 v[114:117], v[198:201], a[244:247], v[114:117]
    v_exp_f32 v192, v192
    v_mfma_f32_16x16x32_bf16 v[114:117], v[198:201], v[94:97], v[114:117]
    v_exp_f32 v193, v193
    v_mfma_f32_16x16x32_bf16 v[142:145], v[198:201], a[232:235], 0
    v_mov_b32 v254, v182
    v_cvt_pk_bf16_f32 v37, v192, v193
    v_mfma_f32_16x16x32_bf16 v[142:145], v[198:201], v[82:85], v[142:145]
    v_mov_b32_dpp v254, v183 quad_perm:[0,1,2,3] row_mask:0x2 bank_mask:0xf
    v_mul_f32 v217, v187, v217
    v_mfma_f32_16x16x32_bf16 v[146:149], v[28:31], v[36:39], 0
    v_mov_b32 v162, v115
    v_cvt_pk_bf16_f32 v161, v216, v217
    v_mfma_f32_16x16x32_bf16 v[146:149], v[28:31], v[122:125], v[146:149]
    v_exp_f32 v174, v174
    v_mfma_f32_16x16x32_bf16 v[178:181], v[202:205], v[122:125], 0
    v_exp_f32 v175, v175
    v_mfma_f32_16x16x32_bf16 v[178:181], v[130:133], v[36:39], v[178:181]
    v_exp_f32 v176, v176
    v_mfma_f32_16x16x32_bf16 v[182:185], v[138:141], v[36:39], 0
    v_exp_f32 v177, v177
    v_mfma_f32_16x16x32_bf16 v[182:185], v[170:173], v[122:125], v[182:185]
    v_cvt_pk_bf16_f32 v166, v174, v175
    v_cvt_pk_bf16_f32 v167, v176, v177
    v_mfma_f32_16x16x32_bf16 v[174:177], v[150:153], v[122:125], 0
    v_exp_f32 v218, v218
    v_mfma_f32_16x16x32_bf16 v[174:177], v[194:197], v[36:39], v[174:177]
    v_exp_f32 v219, v219
    v_mfma_f32_16x16x32_bf16 v[142:145], v[198:201], v[106:109], v[142:145]
    v_cvt_pk_bf16_f32 v168, v218, v219
    v_cvt_pk_bf16_f32 v39, v206, 0
    v_mfma_f32_16x16x32_bf16 v[122:125], v[198:201], a[224:227], 0
    v_exp_f32 v220, v220
    v_mfma_f32_16x16x32_bf16 v[122:125], v[198:201], a[248:251], v[122:125]
    v_exp_f32 v221, v221
    v_mfma_f32_16x16x32_bf16 v[122:125], v[198:201], v[98:101], v[122:125]
    v_exp_f32 v134, v134
    v_mfma_f32_16x16x32_bf16 v[154:157], v[198:201], a[228:231], 0
    v_mov_b32_dpp v254, v142 quad_perm:[0,1,2,3] row_mask:0x4 bank_mask:0xf
    v_mov_b32_dpp v162, v143 quad_perm:[0,1,2,3] row_mask:0x2 bank_mask:0xf
    v_mfma_f32_16x16x32_bf16 v[154:157], v[198:201], a[252:255], v[154:157]
    v_mov_b32_dpp v254, v114 quad_perm:[0,1,2,3] row_mask:0x8 bank_mask:0xf
    v_cvt_pk_bf16_f32 v169, v220, v221
    v_mfma_f32_16x16x32_bf16 v[154:157], v[198:201], v[102:105], v[154:157]
    ds_write_b32 v164, v254 offset:18432
    v_mfma_f32_16x16x32_bf16 v[114:117], v[198:201], a[236:239], 0
    v_exp_f32 v135, v135
    v_mfma_f32_16x16x32_bf16 v[114:117], v[198:201], v[86:89], v[114:117]
    v_mov_b32_dpp v162, v122 quad_perm:[0,1,2,3] row_mask:0x4 bank_mask:0xf
    v_cvt_pk_bf16_f32 v36, v134, v135
    v_mfma_f32_16x16x32_bf16 v[114:117], v[198:201], v[110:113], v[114:117]
    v_mov_b32_dpp v162, v123 quad_perm:[0,1,2,3] row_mask:0x8 bank_mask:0xf
    v_exp_f32 v136, v136
    v_exp_f32 v137, v137
    ds_read_b128 v[122:125], v9
    ds_read_b128 v[142:145], v9 offset:64
    ds_write_b32 v164, v162 offset:19456
    v_cvt_pk_bf16_f32 v37, v136, v137
    v_rcp_f32 v147, v146
    v_mov_b32 v254, v114
    v_mfma_f32_16x16x32_bf16 v[134:137], v[28:31], v[36:39], 0
    v_max3_u32 v25, v25, v147, v146
    v_mov_b32_dpp v254, v154 quad_perm:[0,1,2,3] row_mask:0x2 bank_mask:0xf
    v_mfma_f32_16x16x32_bf16 v[134:137], v[28:31], v[166:169], v[134:137]
    v_mul_f32 v178, v147, v178
    v_mov_b32_dpp v254, v155 quad_perm:[0,1,2,3] row_mask:0x4 bank_mask:0xf
    v_mfma_f32_16x16x32_bf16 v[154:157], v[202:205], v[166:169], 0
    v_mul_f32 v179, v147, v179
    v_mov_b32_dpp v254, v115 quad_perm:[0,1,2,3] row_mask:0x8 bank_mask:0xf
    v_mfma_f32_16x16x32_bf16 v[154:157], v[130:133], v[36:39], v[154:157]
    ds_write_b32 v164, v254 offset:63552
    v_mfma_f32_16x16x32_bf16 v[114:117], v[138:141], v[36:39], 0
    v_rcp_f32 v135, v134
    v_mfma_f32_16x16x32_bf16 v[114:117], v[170:173], v[166:169], v[114:117]
    s_waitcnt lgkmcnt(2)
    v_max3_u32 v25, v25, v135, v134
    v_cvt_pk_bf16_f32 v126, v178, v179
    v_mfma_f32_16x16x32_bf16 v[198:201], v[122:125], v[28:31], 0
    v_mul_f32 v154, v135, v154
    v_mul_f32 v155, v135, v155
    v_mfma_f32_16x16x32_bf16 v[198:201], v[142:145], v[28:31], v[198:201]
    v_cvt_pk_bf16_f32 v210, v154, v155
    v_mul_f32 v156, v135, v156
    v_mfma_f32_16x16x32_bf16 v[214:217], v[142:145], v[130:133], 0
    v_mul_f32 v157, v135, v157
    v_cvt_pk_bf16_f32 v211, v156, v157
    v_mfma_f32_16x16x32_bf16 v[214:217], v[122:125], v[202:205], v[214:217]
    v_mul_f32 v114, v135, v114
    v_mul_f32 v115, v135, v115
    v_mfma_f32_16x16x32_bf16 v[202:205], v[122:125], v[170:173], 0
    v_rcp_f32_dpp v199, v198 quad_perm:[0,0,0,0] row_mask:0xf bank_mask:0xf
    v_mfma_f32_16x16x32_bf16 v[202:205], v[142:145], v[138:141], v[202:205]
    s_waitcnt lgkmcnt(0)
    v_max3_u32 v25, v25, v198, v199
    v_cvt_pk_bf16_f32 v212, v114, v115
    v_mfma_f32_16x16x32_bf16 v[138:141], v[142:145], v[194:197], 0
    s_barrier
    s_waitcnt vmcnt(0)
    ds_read_b128 v[142:145], v255 offset:18432
    v_mfma_f32_16x16x32_bf16 v[138:141], v[122:125], v[150:153], v[138:141]
    s_barrier
    ds_read_b128 v[154:157], v0 offset:20480
    ds_read_b128 v[186:189], v1 offset:20480
    v_mfma_f32_16x16x32_bf16 v[122:125], v[150:153], v[166:169], 0
    ds_read_b128 v[206:209], v0 offset:20608
    buffer_load_dwordx4 v10, s[8:11], 0 offen nt lds
    v_mfma_f32_16x16x32_bf16 v[122:125], v[194:197], v[36:39], v[122:125]
    s_add_u32 m0, s28, 4096
    ds_read_b128 v[190:193], v1 offset:20608
    ds_read_b128 v[226:229], v0 offset:20736
    ds_read_b128 v[234:237], v1 offset:20736
    ds_read_b128 v[150:153], v255 offset:19456
    ds_read_b128 v[170:173], v255 offset:63552
    ds_write_b128 v3, v[118:121] offset:0
    s_waitcnt lgkmcnt(7)
    v_mfma_f32_16x16x32_bf16 v[130:133], a[72:75], v[154:157], 0
    s_waitcnt lgkmcnt(6)
    buffer_load_dwordx4 v11, s[8:11], 0 offen nt lds
    v_add_f32 v142, v142, v143
    v_mfma_f32_16x16x32_bf16 v[130:133], a[76:79], v[186:189], v[130:133]
    s_add_u32 m0, s28, 8192
    v_add_f32 v144, v144, v145
    v_add_f32 v142, v142, v144
    v_mfma_f32_16x16x32_bf16 v[130:133], a[80:83], v[206:209], v[130:133]
    s_waitcnt lgkmcnt(4)
    ds_write_b64 v4, v[160:161] offset:4096
    v_mfma_f32_16x16x32_bf16 v[130:133], a[84:87], v[190:193], v[130:133]
    s_waitcnt lgkmcnt(3)
    v_mul_f32 v142, 0xbbaaaaab, v142
    v_add_f32 v150, v150, v151
    v_mfma_f32_16x16x32_bf16 v[130:133], a[88:91], v[226:229], v[130:133]
    s_waitcnt lgkmcnt(2)
    ds_write_b32 v128, v142 offset:0
    v_mfma_f32_16x16x32_bf16 v[130:133], a[92:95], v[234:237], v[130:133]
    buffer_load_dwordx4 v12, s[8:11], 0 offen nt lds
    v_add_f32 v152, v152, v153
    v_mfma_f32_16x16x32_bf16 v[166:169], a[116:119], v[234:237], 0
    s_add_u32 m0, s28, 12288
    ds_read_b128 v[118:121], v163 offset:0
    ds_read_b128 v[142:145], v163 offset:64
    v_mfma_f32_16x16x32_bf16 v[166:169], a[112:115], v[226:229], v[166:169]
    s_xor_b32 s28, s28, 65536
    ds_read_b128 v[218:221], v163 offset:128
    ds_read_b128 v[222:225], v163 offset:192
    v_mfma_f32_16x16x32_bf16 v[166:169], a[108:111], v[190:193], v[166:169]
    v_add_f32 v150, v150, v152
    v_mul_f32 v150, 0xbbaaaaab, v150
    v_mfma_f32_16x16x32_bf16 v[166:169], a[104:107], v[206:209], v[166:169]
    ds_write_b32 v128, v150 offset:256
    v_mfma_f32_16x16x32_bf16 v[166:169], a[100:103], v[186:189], v[166:169]
    v_add_f32 v170, v170, v171
    v_add_f32 v172, v172, v173
    v_mfma_f32_16x16x32_bf16 v[166:169], a[96:99], v[154:157], v[166:169]
    buffer_load_dwordx4 v13, s[8:11], 0 offen nt lds
    v_add_f32 v170, v170, v172
    v_mfma_f32_16x16x32_bf16 v[194:197], a[120:123], v[154:157], 0
    s_mov_b32 m0, s29
    v_mul_f32 v170, 0xbbaaaaab, v170
    v_mul_f32 v214, v214, v199
    v_mfma_f32_16x16x32_bf16 v[194:197], a[124:127], v[186:189], v[194:197]
    s_xor_b32 s29, s29, s30
    ds_write_b32 v128, v170 offset:512
    v_mfma_f32_16x16x32_bf16 v[194:197], a[128:131], v[206:209], v[194:197]
    s_waitcnt lgkmcnt(4)
    v_mul_f32_dpp v214, v202, v199 quad_perm:[0,1,2,3] row_mask:0x2 bank_mask:0xf
    v_mul_f32 v116, v135, v116
    v_mul_f32 v117, v135, v117
    v_mfma_f32_16x16x16_bf16 v[150:153], a[216:217], v[158:159], v[118:121]
    v_mul_f32_dpp v214, v138, v199 quad_perm:[0,1,2,3] row_mask:0x4 bank_mask:0xf
    v_cvt_pk_bf16_f32 v214, v214, v214
    v_cvt_pk_bf16_f32 v213, v116, v117
    v_mfma_f32_16x16x16_bf16 v[114:117], a[240:241], v[158:159], v[118:121]
    v_mul_f32 v122, v135, v122
    v_mul_f32 v123, v135, v123
    v_cvt_pk_bf16_f32 v160, v122, v123
    v_mfma_f32_16x16x16_bf16 v[138:141], v[90:91], v[158:159], v[118:121]
    v_cvt_pk_bf16_f32 v150, v150, v151
    v_accvgpr_write_b32 a216, v150
    v_cvt_pk_bf16_f32 v152, v152, v153
    v_mfma_f32_16x16x16_bf16 v[170:173], a[218:219], v[158:159], v[142:145]
    v_accvgpr_write_b32 a217, v152
    v_cvt_pk_bf16_f32 v114, v114, v115
    v_accvgpr_write_b32 a240, v114
    v_mfma_f32_16x16x16_bf16 v[118:121], a[242:243], v[158:159], v[142:145]
    v_cvt_pk_bf16_f32 v116, v116, v117
    v_accvgpr_write_b32 a241, v116
    v_cvt_pk_bf16_f32 v90, v138, v139
    v_mfma_f32_16x16x16_bf16 v[114:117], v[92:93], v[158:159], v[142:145]
    v_cvt_pk_bf16_f32 v91, v140, v141
    v_cvt_pk_bf16_f32 v170, v170, v171
    v_accvgpr_write_b32 a218, v170
    v_cvt_pk_bf16_f32 v172, v172, v173
    v_mfma_f32_16x16x32_bf16 v[194:197], a[132:135], v[190:193], v[194:197]
    s_waitcnt lgkmcnt(0)
    buffer_load_dwordx4 v14, s[8:11], 0 offen nt lds
    ds_read_b128 v[138:141], v163 offset:256
    v_accvgpr_write_b32 a219, v172
    v_mfma_f32_16x16x16_bf16 v[142:145], a[232:233], v[158:159], v[218:221]
    v_cvt_pk_bf16_f32 v118, v118, v119
    v_accvgpr_write_b32 a242, v118
    v_cvt_pk_bf16_f32 v120, v120, v121
    v_mfma_f32_16x16x16_bf16 v[150:153], v[82:83], v[158:159], v[218:221]
    v_accvgpr_write_b32 a243, v120
    v_cvt_pk_bf16_f32 v92, v114, v115
    v_cvt_pk_bf16_f32 v93, v116, v117
    v_mfma_f32_16x16x16_bf16 v[114:117], v[106:107], v[158:159], v[218:221]
    v_cvt_pk_bf16_f32 v142, v142, v143
    v_accvgpr_write_b32 a232, v142
    v_cvt_pk_bf16_f32 v144, v144, v145
    v_mfma_f32_16x16x16_bf16 v[118:121], a[220:221], v[158:159], v[222:225]
    v_accvgpr_write_b32 a233, v144
    v_cvt_pk_bf16_f32 v82, v150, v151
    v_cvt_pk_bf16_f32 v83, v152, v153
    v_mfma_f32_16x16x16_bf16 v[142:145], a[244:245], v[158:159], v[222:225]
    v_cvt_pk_bf16_f32 v106, v114, v115
    v_cvt_pk_bf16_f32 v107, v116, v117
    v_mul_f32 v124, v135, v124
    v_mfma_f32_16x16x16_bf16 v[114:117], v[94:95], v[158:159], v[222:225]
    v_cvt_pk_bf16_f32 v118, v118, v119
    v_accvgpr_write_b32 a220, v118
    v_cvt_pk_bf16_f32 v120, v120, v121
    v_accvgpr_write_b32 a221, v120
    v_mfma_f32_16x16x32_bf16 v[194:197], a[136:139], v[226:229], v[194:197]
    s_waitcnt lgkmcnt(0)
    ds_read_b128 v[118:121], v163 offset:320
    ds_read_b128 v[150:153], v163 offset:384
    v_cvt_pk_bf16_f32 v142, v142, v143
    v_mfma_f32_16x16x16_bf16 v[170:173], a[222:223], v[158:159], v[138:141]
    v_accvgpr_write_b32 a244, v142
    v_cvt_pk_bf16_f32 v144, v144, v145
    v_accvgpr_write_b32 a245, v144
    v_mfma_f32_16x16x16_bf16 v[142:145], a[246:247], v[158:159], v[138:141]
    v_cvt_pk_bf16_f32 v94, v114, v115
    v_cvt_pk_bf16_f32 v95, v116, v117
    v_mul_f32 v125, v135, v125
    v_mfma_f32_16x16x16_bf16 v[134:137], v[96:97], v[158:159], v[138:141]
    v_cvt_pk_bf16_f32 v170, v170, v171
    v_accvgpr_write_b32 a222, v170
    v_cvt_pk_bf16_f32 v172, v172, v173
    v_accvgpr_write_b32 a223, v172
    v_mfma_f32_16x16x32_bf16 v[194:197], a[140:143], v[234:237], v[194:197]
    ds_read_b128 v[138:141], v163 offset:448
    v_cvt_pk_bf16_f32 v142, v142, v143
    v_mfma_f32_16x16x32_bf16 v[114:117], a[20:23], v[234:237], 0
    ds_write_b128 v3, v[210:213] offset:12288
    v_mfma_f32_16x16x32_bf16 v[114:117], a[16:19], v[226:229], v[114:117]
    s_waitcnt lgkmcnt(3)
    v_accvgpr_write_b32 a246, v142
    v_cvt_pk_bf16_f32 v144, v144, v145
    v_accvgpr_write_b32 a247, v144
    v_mfma_f32_16x16x16_bf16 v[142:145], a[234:235], v[158:159], v[118:121]
    v_cvt_pk_bf16_f32 v96, v134, v135
    v_cvt_pk_bf16_f32 v97, v136, v137
    v_cvt_pk_bf16_f32 v161, v124, v125
    v_mfma_f32_16x16x16_bf16 v[122:125], v[84:85], v[158:159], v[118:121]
    v_mul_f32 v180, v147, v180
    v_mul_f32 v181, v147, v181
    v_cvt_pk_bf16_f32 v127, v180, v181
    v_mfma_f32_16x16x16_bf16 v[134:137], v[108:109], v[158:159], v[118:121]
    v_cvt_pk_bf16_f32 v142, v142, v143
    v_accvgpr_write_b32 a234, v142
    v_cvt_pk_bf16_f32 v144, v144, v145
    v_accvgpr_write_b32 a235, v144
    v_mfma_f32_16x16x32_bf16 v[114:117], a[12:15], v[190:193], v[114:117]
    s_waitcnt lgkmcnt(1)
    ds_read_b128 v[118:121], v163 offset:512
    ds_write_b64 v4, v[160:161] offset:16384
    v_mfma_f32_16x16x16_bf16 v[142:145], a[224:225], v[158:159], v[150:153]
    v_cvt_pk_bf16_f32 v84, v122, v123
    v_cvt_pk_bf16_f32 v85, v124, v125
    v_cvt_pk_bf16_f32 v108, v134, v135
    v_mfma_f32_16x16x16_bf16 v[122:125], a[248:249], v[158:159], v[150:153]
    v_cvt_pk_bf16_f32 v109, v136, v137
    v_mul_f32 v182, v147, v182
    v_mul_f32 v183, v147, v183
    v_mfma_f32_16x16x16_bf16 v[134:137], v[98:99], v[158:159], v[150:153]
    v_cvt_pk_bf16_f32 v142, v142, v143
    v_accvgpr_write_b32 a224, v142
    v_cvt_pk_bf16_f32 v144, v144, v145
    v_mfma_f32_16x16x16_bf16 v[170:173], a[226:227], v[158:159], v[138:141]
    v_accvgpr_write_b32 a225, v144
    v_cvt_pk_bf16_f32 v122, v122, v123
    v_accvgpr_write_b32 a248, v122
    v_mfma_f32_16x16x16_bf16 v[142:145], a[250:251], v[158:159], v[138:141]
    v_cvt_pk_bf16_f32 v124, v124, v125
    v_accvgpr_write_b32 a249, v124
    v_cvt_pk_bf16_f32 v98, v134, v135
    v_mfma_f32_16x16x16_bf16 v[122:125], v[100:101], v[158:159], v[138:141]
    v_cvt_pk_bf16_f32 v99, v136, v137
    v_cvt_pk_bf16_f32 v170, v170, v171
    v_accvgpr_write_b32 a226, v170
    v_cvt_pk_bf16_f32 v172, v172, v173
    v_mfma_f32_16x16x32_bf16 v[114:117], a[8:11], v[206:209], v[114:117]
    s_waitcnt lgkmcnt(0)
    ds_read_b128 v[134:137], v163 offset:576
    ds_read_b128 v[138:141], v163 offset:640
    v_accvgpr_write_b32 a227, v172
    v_mfma_f32_16x16x16_bf16 v[150:153], a[236:237], v[158:159], v[118:121]
    v_cvt_pk_bf16_f32 v142, v142, v143
    v_accvgpr_write_b32 a250, v142
    v_cvt_pk_bf16_f32 v144, v144, v145
    v_mfma_f32_16x16x16_bf16 v[170:173], v[86:87], v[158:159], v[118:121]
    v_accvgpr_write_b32 a251, v144
    v_cvt_pk_bf16_f32 v100, v122, v123
    v_cvt_pk_bf16_f32 v101, v124, v125
    v_mfma_f32_16x16x16_bf16 v[122:125], v[110:111], v[158:159], v[118:121]
    v_cvt_pk_bf16_f32 v150, v150, v151
    v_accvgpr_write_b32 a236, v150
    v_cvt_pk_bf16_f32 v152, v152, v153
    v_accvgpr_write_b32 a237, v152
    v_mfma_f32_16x16x32_bf16 v[114:117], a[4:7], v[186:189], v[114:117]
    ds_read_b128 v[142:145], v163 offset:704
    v_cvt_pk_bf16_f32 v86, v170, v171
    v_mfma_f32_16x16x32_bf16 v[114:117], a[0:3], v[154:157], v[114:117]
    ds_write_b16 v7, v214
    v_mfma_f32_16x16x32_bf16 v[118:121], a[24:27], v[154:157], 0
    v_add_u32 v7, 16, v7
    v_cvt_pk_bf16_f32 v87, v172, v173
    v_mfma_f32_16x16x32_bf16 v[118:121], a[28:31], v[186:189], v[118:121]
    s_waitcnt lgkmcnt(2)
    v_cvt_pk_bf16_f32 v110, v122, v123
    v_cvt_pk_bf16_f32 v111, v124, v125
    v_cvt_pk_bf16_f32 v128, v182, v183
    v_mfma_f32_16x16x16_bf16 v[122:125], a[228:229], v[158:159], v[134:137]
    v_mul_f32 v184, v147, v184
    v_mul_f32 v185, v147, v185
    v_cvt_pk_bf16_f32 v129, v184, v185
    v_mfma_f32_16x16x16_bf16 v[150:153], a[252:253], v[158:159], v[134:137]
    v_mul_f32 v174, v147, v174
    v_mul_f32 v175, v147, v175
    v_cvt_pk_bf16_f32 v254, v174, v175
    v_mfma_f32_16x16x16_bf16 v[162:165], v[102:103], v[158:159], v[134:137]
    v_cvt_pk_bf16_f32 v122, v122, v123
    v_accvgpr_write_b32 a228, v122
    v_cvt_pk_bf16_f32 v124, v124, v125
    v_mfma_f32_16x16x16_bf16 v[170:173], a[230:231], v[158:159], v[138:141]
    v_accvgpr_write_b32 a229, v124
    v_cvt_pk_bf16_f32 v150, v150, v151
    v_accvgpr_write_b32 a252, v150
    v_mfma_f32_16x16x16_bf16 v[122:125], a[254:255], v[158:159], v[138:141]
    v_cvt_pk_bf16_f32 v152, v152, v153
    v_accvgpr_write_b32 a253, v152
    v_cvt_pk_bf16_f32 v102, v162, v163
    v_mfma_f32_16x16x16_bf16 v[134:137], v[104:105], v[158:159], v[138:141]
    v_cvt_pk_bf16_f32 v103, v164, v165
    v_cvt_pk_bf16_f32 v170, v170, v171
    v_accvgpr_write_b32 a230, v170
    v_cvt_pk_bf16_f32 v172, v172, v173
    v_mfma_f32_16x16x32_bf16 v[118:121], a[32:35], v[206:209], v[118:121]
    s_waitcnt lgkmcnt(0)
    ds_write_b128 v3, v[126:129] offset:6144
    v_mfma_f32_16x16x16_bf16 v[126:129], a[238:239], v[158:159], v[142:145]
    v_accvgpr_write_b32 a231, v172
    v_cvt_pk_bf16_f32 v122, v122, v123
    v_accvgpr_write_b32 a254, v122
    v_mfma_f32_16x16x16_bf16 v[138:141], v[88:89], v[158:159], v[142:145]
    v_cvt_pk_bf16_f32 v124, v124, v125
    v_accvgpr_write_b32 a255, v124
    v_cvt_pk_bf16_f32 v104, v134, v135
    v_mfma_f32_16x16x16_bf16 v[122:125], v[112:113], v[158:159], v[142:145]
    v_cvt_pk_bf16_f32 v105, v136, v137
    v_cvt_pk_bf16_f32 v126, v126, v127
    v_accvgpr_write_b32 a238, v126
    v_cvt_pk_bf16_f32 v128, v128, v129
    v_mfma_f32_16x16x32_bf16 v[118:121], a[36:39], v[190:193], v[118:121]
    v_accvgpr_write_b32 a239, v128
    v_cvt_pk_bf16_f32 v88, v138, v139
    v_mfma_f32_16x16x32_bf16 v[118:121], a[40:43], v[226:229], v[118:121]
    v_cvt_pk_bf16_f32 v89, v140, v141
    v_cvt_pk_bf16_f32 v112, v122, v123
    v_mfma_f32_16x16x32_bf16 v[118:121], a[44:47], v[234:237], v[118:121]
    v_cvt_pk_bf16_f32 v113, v124, v125
    v_mul_f32 v176, v147, v176
    v_mul_f32 v177, v147, v177
    v_cvt_pk_bf16_f32 v255, v176, v177
    ds_write_b64 v4, v[254:255] offset:10240
    v_cvt_pk_f16_f32 v182, v130, v131
    v_pk_mul_f16 v139, v182, v182
    v_cvt_pk_f16_f32 v183, v132, v133
    v_pk_fma_f16 v139, v183, v183, v139
    v_cvt_pk_f16_f32 v184, v166, v167
    v_pk_fma_f16 v139, v184, v184, v139
    v_cvt_pk_f16_f32 v185, v168, v169
    v_pk_fma_f16 v139, v185, v185, v139
    v_cvt_pk_f16_f32 v168, v194, v195
    v_pk_fma_f16 v139, v168, v168, v139
    v_cvt_pk_f16_f32 v169, v196, v197
    v_pk_fma_f16 v139, v169, v169, v139
    v_cvt_pk_f16_f32 v130, v114, v115
    v_pk_mul_f16 v138, v130, v130
    v_xor_b32 v3, 65536, v3
    v_xor_b32 v4, 65536, v4
    s_waitcnt lgkmcnt(0)
    s_barrier
L_go:
    s_waitcnt lgkmcnt(0)
    s_and_b32 s3, s2, 0xf8
    s_add_u32 s64, s42, s3
    s_addc_u32 s65, s43, 0
    s_mov_b32 s67, 0x00020000
    s_cmp_eq_u32 s16, 1
    s_cbranch_scc1 L_loop_fast1
    s_cmp_eq_u32 s16, 2
    s_cbranch_scc1 L_loop_fast2
    s_cmp_eq_u32 s16, 3
    s_cbranch_scc1 L_loop_fast3
    s_branch L_loop_fast0
.p2align 6
L_loop_fast0:
    v_mfma_f32_16x16x32_bf16 v[126:129], a[68:71], v[234:237], 0
    s_add_u32 s12, s40, s27
    ds_read_b128 v[150:153], v2 offset:18432
    v_cvt_pk_f16_f32 v131, v116, v117
    v_mfma_f32_16x16x32_bf16 v[126:129], a[64:67], v[226:229], v[126:129]
    s_addc_u32 s13, s41, 0
    ds_read_b128 v[114:117], v2 offset:19456
    v_pk_fma_f16 v138, v131, v131, v138
    v_mfma_f32_16x16x32_bf16 v[126:129], a[60:63], v[190:193], v[126:129]
    s_sub_u32 s14, s36, s27
    ds_read_b128 v[202:205], v5 offset:32
    v_cvt_pk_f16_f32 v132, v118, v119
    v_mfma_f32_16x16x32_bf16 v[126:129], a[56:59], v[206:209], v[126:129]
    s_cmp_ge_u32 s18, 2
    ds_read2_b64 v[210:213], v5 offset0:6 offset1:9
    v_pk_fma_f16 v138, v132, v132, v138
    v_mfma_f32_16x16x32_bf16 v[126:129], a[52:55], v[186:189], v[126:129]
    s_cselect_b32 s14, s14, 0
    ds_read_b128 v[122:125], v5
    v_cvt_pk_f16_f32 v133, v120, v121
    v_mfma_f32_16x16x32_bf16 v[126:129], a[48:51], v[154:157], v[126:129]
    s_sub_u32 s82, s72, s71
    ds_read_b32 v146, v6 offset:192
    v_pk_fma_f16 v138, v133, v133, v138
    v_mfma_f32_16x16x32_bf16 v[118:121], v[154:157], a[144:147], 0
    s_mul_i32 s74, s82, 336
    v_add_u32 v5, s74, v5
    s_mul_i32 s75, s82, 272
    v_mfma_f32_16x16x32_bf16 v[118:121], v[186:189], a[148:151], v[118:121]
    s_mul_i32 s76, s82, 16
    v_cvt_pk_f16_f32 v166, v126, v127
    v_pk_fma_f16 v138, v166, v166, v138
    v_mfma_f32_16x16x32_bf16 v[118:121], v[206:209], a[152:155], v[118:121]
    s_waitcnt lgkmcnt(5)
    v_cvt_pk_f16_f32 v167, v128, v129
    v_pk_fma_f16 v138, v167, v167, v138
    v_mfma_f32_16x16x32_bf16 v[118:121], v[190:193], a[156:159], v[118:121]
    s_add_u32 s34, s18, 2
    s_add_u32 s8, s60, s23
    s_addc_u32 s9, s61, 0
    v_mfma_f32_16x16x32_bf16 v[118:121], v[226:229], a[160:163], v[118:121]
    s_waitcnt lgkmcnt(3)
    ds_read_b128 v[218:221], v0 offset:26624
    v_pk_mul_f16 v141, v182, v202
    v_mfma_f32_16x16x32_bf16 v[118:121], v[234:237], a[164:167], v[118:121]
    s_sub_u32 s10, s36, s23
    ds_read_b128 v[222:225], v1 offset:26624
    v_pk_fma_f16 v141, v183, v203, v141
    v_mfma_f32_16x16x32_bf16 v[126:129], v[32:35], v[150:153], 0
    s_waitcnt lgkmcnt(3)
    v_pk_fma_f16 v141, v184, v204, v141
    v_pk_fma_f16 v141, v185, v205, v141
    v_mfma_f32_16x16x32_bf16 v[126:129], v[32:35], v[114:117], v[126:129]
    s_waitcnt lgkmcnt(2)
    v_mov_b32_dpp v146, v23 quad_perm:[0,1,2,3] row_mask:0x7 bank_mask:0xf
    v_pk_fma_f16 v141, v168, v212, v141
    v_mfma_f32_16x16x32_bf16 v[150:153], v[234:237], a[188:191], 0
    s_cmp_le_u32 s34, s45
    ds_read_b128 v[230:233], v0 offset:26752
    v_pk_fma_f16 v141, v169, v213, v141
    v_mfma_f32_16x16x32_bf16 v[150:153], v[226:229], a[184:187], v[150:153]
    s_cselect_b32 s10, s10, 0
    ds_read_b128 v[246:249], v1 offset:26752
    v_pk_mul_f16 v140, v130, v122
    v_mfma_f32_16x16x32_bf16 v[150:153], v[190:193], a[180:183], v[150:153]
    s_add_u32 m0, s28, 0
    ds_read_b128 v[242:245], v0 offset:26880
    v_pk_fma_f16 v140, v131, v123, v140
    v_mfma_f32_16x16x32_bf16 v[150:153], v[206:209], a[176:179], v[150:153]
    s_mov_b32 s27, s26
    ds_read_b128 v[194:197], v1 offset:26880
    v_pk_fma_f16 v140, v132, v124, v140
    v_mfma_f32_16x16x32_bf16 v[150:153], v[186:189], a[172:175], v[150:153]
    s_waitcnt lgkmcnt(5)
    v_pk_fma_f16 v140, v133, v125, v140
    v_pk_fma_f16 v140, v166, v210, v140
    v_mfma_f32_16x16x32_bf16 v[150:153], v[154:157], a[168:171], v[150:153]
    s_mov_b32 s26, s25
    v_pk_fma_f16 v140, v167, v211, v140
    v_cvt_pk_bf16_f32 v114, v118, v119
    v_mfma_f32_16x16x32_bf16 v[198:201], v[154:157], a[192:195], 0
    s_mov_b32 s25, s24
    v_cvt_pk_bf16_f32 v115, v120, v121
    v_mul_f32 v116, 0x3baaaaab, v126
    v_mfma_f32_16x16x32_bf16 v[198:201], v[186:189], a[196:199], v[198:201]
    s_mov_b32 s24, s23
    v_cvt_pk_bf16_f32 v118, v150, v151
    v_cvt_pk_bf16_f32 v119, v152, v153
    v_mfma_f32_16x16x32_bf16 v[198:201], v[206:209], a[200:203], v[198:201]
    s_mov_b32 s71, s72
    v_rsq_f32 v116, v116
    v_mfma_f32_16x16x32_bf16 v[198:201], v[190:193], a[204:207], v[198:201]
    s_mov_b32 s72, s73
    v_mul_f32 v147, 0x3baaaaab, v127
    v_mul_f32 v117, 0x3baaaaab, v128
    v_mfma_f32_16x16x32_bf16 v[198:201], v[226:229], a[208:211], v[198:201]
    s_waitcnt lgkmcnt(1)
    v_rsq_f32 v147, v147
    v_mfma_f32_16x16x32_bf16 v[198:201], v[234:237], a[212:215], v[198:201]
    s_waitcnt lgkmcnt(0)
    v_rsq_f32 v117, v117
    v_mfma_f32_16x16x32_f16 v[186:189], v[40:43], v[138:141], 0
    v_mul_f32 v178, v116, v178
    v_mul_f32 v179, v116, v179
    v_mfma_f32_16x16x32_bf16 v[138:141], a[72:75], v[218:221], 0
    v_cvt_pk_bf16_f32 v126, v178, v179
    v_mul_f32 v180, v116, v180
    v_mfma_f32_16x16x32_bf16 v[138:141], a[76:79], v[222:225], v[138:141]
    v_cvt_pk_bf16_f32 v150, v198, v199
    v_cvt_pk_bf16_f32 v151, v200, v201
    v_mfma_f32_16x16x32_bf16 v[138:141], a[80:83], v[230:233], v[138:141]
    v_rsq_f32 v186, v186
    v_mfma_f32_16x16x32_bf16 v[138:141], a[84:87], v[246:249], v[138:141]
    v_rsq_f32 v187, v187
    v_mfma_f32_16x16x32_bf16 v[138:141], a[88:91], v[242:245], v[138:141]
    v_mul_f32 v120, s31, v186
    v_cvt_pk_f16_f32 v121, v120, v187
    v_mfma_f32_16x16x32_bf16 v[138:141], a[92:95], v[194:197], v[138:141]
    v_mul_f32 v181, v116, v181
    v_cvt_pk_bf16_f32 v127, v180, v181
    v_mfma_f32_16x16x32_bf16 v[154:157], a[116:119], v[194:197], 0
    v_mul_f32 v142, v116, v142
    v_mul_f32 v143, v116, v143
    v_mfma_f32_16x16x32_bf16 v[154:157], a[112:115], v[242:245], v[154:157]
    v_cvt_pk_bf16_f32 v128, v142, v143
    v_mul_f32 v144, v116, v144
    v_mfma_f32_16x16x32_bf16 v[154:157], a[108:111], v[246:249], v[154:157]
    v_mul_f32 v145, v116, v145
    v_cvt_pk_bf16_f32 v129, v144, v145
    v_mfma_f32_16x16x32_bf16 v[154:157], a[104:107], v[230:233], v[154:157]
    v_mul_f32 v134, v116, v134
    v_mul_f32 v135, v116, v135
    v_mfma_f32_16x16x32_bf16 v[154:157], a[100:103], v[222:225], v[154:157]
    v_cvt_pk_bf16_f32 v148, v134, v135
    v_mul_f32 v136, v116, v136
    v_mfma_f32_16x16x32_bf16 v[154:157], a[96:99], v[218:221], v[154:157]
    buffer_store_dwordx4 v[126:129], v15, s[12:15], 0 offen nt
    v_mul_f32 v137, v116, v137
    v_cvt_pk_bf16_f32 v149, v136, v137
    v_fma_f32 v188, v188, v120, v22
    v_fmac_f32_dpp v146, v189, v187 quad_perm:[0,1,2,3] row_mask:0x1 bank_mask:0xf
    v_mfma_f32_16x16x32_bf16 v[126:129], a[120:123], v[218:221], 0
    v_pk_mul_f16 v182, v182, v121 op_sel:[0,1] op_sel_hi:[1,1]
    v_pk_mul_f16 v183, v183, v121 op_sel:[0,1] op_sel_hi:[1,1]
    v_mfma_f32_16x16x32_bf16 v[126:129], a[124:127], v[222:225], v[126:129]
    v_pk_mul_f16 v184, v184, v121 op_sel:[0,1] op_sel_hi:[1,1]
    v_pk_mul_f16 v185, v185, v121 op_sel:[0,1] op_sel_hi:[1,1]
    v_mfma_f32_16x16x32_bf16 v[126:129], a[128:131], v[230:233], v[126:129]
    v_pk_mul_f16 v168, v168, v121 op_sel:[0,1] op_sel_hi:[1,1]
    v_pk_mul_f16 v169, v169, v121 op_sel:[0,1] op_sel_hi:[1,1]
    v_mfma_f32_16x16x32_bf16 v[126:129], a[132:135], v[246:249], v[126:129]
    v_pk_mul_f16 v130, v130, v121 op_sel:[0,0] op_sel_hi:[1,0]
    v_pk_mul_f16 v131, v131, v121 op_sel:[0,0] op_sel_hi:[1,0]
    v_mfma_f32_16x16x32_bf16 v[126:129], a[136:139], v[242:245], v[126:129]
    v_pk_mul_f16 v132, v132, v121 op_sel:[0,0] op_sel_hi:[1,0]
    v_pk_mul_f16 v133, v133, v121 op_sel:[0,0] op_sel_hi:[1,0]
    v_mfma_f32_16x16x32_bf16 v[126:129], a[140:143], v[194:197], v[126:129]
    v_pk_mul_f16 v166, v166, v121 op_sel:[0,0] op_sel_hi:[1,0]
    v_pk_mul_f16 v167, v167, v121 op_sel:[0,0] op_sel_hi:[1,0]
    v_mfma_f32_16x16x32_bf16 v[134:137], a[20:23], v[194:197], 0
    v_max3_u32 v44, v44, v186, v187
    v_mul_f32 v170, v117, v170
    v_mfma_f32_16x16x32_bf16 v[134:137], a[16:19], v[242:245], v[134:137]
    v_mul_f32 v171, v117, v171
    v_cvt_pk_bf16_f32 v226, v170, v171
    v_mfma_f32_16x16x32_bf16 v[134:137], a[12:15], v[246:249], v[134:137]
    v_mul_f32 v172, v117, v172
    v_mul_f32 v173, v117, v173
    v_mfma_f32_16x16x32_bf16 v[134:137], a[8:11], v[230:233], v[134:137]
    v_cvt_pk_bf16_f32 v227, v172, v173
    v_mul_f32 v158, v117, v158
    v_mfma_f32_16x16x32_bf16 v[134:137], a[4:7], v[222:225], v[134:137]
    v_mul_f32 v159, v117, v159
    v_cvt_pk_bf16_f32 v228, v158, v159
    v_mfma_f32_16x16x32_bf16 v[134:137], a[0:3], v[218:221], v[134:137]
    v_mul_f32 v160, v117, v160
    v_mul_f32 v161, v117, v161
    v_mfma_f32_16x16x32_bf16 v[142:145], a[24:27], v[218:221], 0
    v_cvt_pk_bf16_f32 v229, v160, v161
    v_mul_f32 v238, v117, v238
    v_mfma_f32_16x16x32_bf16 v[142:145], a[28:31], v[222:225], v[142:145]
    v_mul_f32 v239, v117, v239
    v_cvt_pk_bf16_f32 v254, v238, v239
    v_mfma_f32_16x16x32_bf16 v[142:145], a[32:35], v[230:233], v[142:145]
    v_mul_f32 v240, v117, v240
    v_mul_f32 v241, v117, v241
    v_mfma_f32_16x16x32_bf16 v[142:145], a[36:39], v[246:249], v[142:145]
    v_cvt_pk_bf16_f32 v255, v240, v241
    v_cvt_pk_f16_f32 v190, v134, v135
    v_mfma_f32_16x16x32_bf16 v[142:145], a[40:43], v[242:245], v[142:145]
    v_pk_mul_f16 v158, v190, v190
    v_cvt_pk_f16_f32 v191, v136, v137
    v_mfma_f32_16x16x32_bf16 v[142:145], a[44:47], v[194:197], v[142:145]
    buffer_store_dwordx2 v[148:149], v18, s[12:15], 0 offen nt
    v_pk_fma_f16 v158, v191, v191, v158
    v_pk_mul_f16 v160, v190, v122
    v_mfma_f32_16x16x32_bf16 v[134:137], a[68:71], v[194:197], 0
    v_pk_fma_f16 v160, v191, v123, v160
    v_cvt_pk_f16_f32 v198, v138, v139
    v_mfma_f32_16x16x32_bf16 v[134:137], a[64:67], v[242:245], v[134:137]
    v_pk_mul_f16 v159, v198, v198
    v_cvt_pk_f16_f32 v192, v142, v143
    v_mfma_f32_16x16x32_bf16 v[134:137], a[60:63], v[246:249], v[134:137]
    v_pk_fma_f16 v158, v192, v192, v158
    v_cvt_pk_f16_f32 v193, v144, v145
    v_mfma_f32_16x16x32_bf16 v[134:137], a[56:59], v[230:233], v[134:137]
    v_pk_fma_f16 v158, v193, v193, v158
    v_pk_fma_f16 v160, v192, v124, v160
    v_mfma_f32_16x16x32_bf16 v[134:137], a[52:55], v[222:225], v[134:137]
    v_pk_fma_f16 v160, v193, v125, v160
    v_cvt_pk_f16_f32 v199, v140, v141
    v_mfma_f32_16x16x32_bf16 v[134:137], a[48:51], v[218:221], v[134:137]
    v_pk_fma_f16 v159, v199, v199, v159
    v_cvt_pk_f16_f32 v200, v154, v155
    v_mfma_f32_16x16x32_bf16 v[234:237], v[218:221], a[144:147], 0
    v_pk_fma_f16 v159, v200, v200, v159
    v_cvt_pk_f16_f32 v201, v156, v157
    v_mfma_f32_16x16x32_bf16 v[234:237], v[222:225], a[148:151], v[234:237]
    v_pk_fma_f16 v159, v201, v201, v159
    v_cvt_pk_f16_f32 v140, v126, v127
    v_mfma_f32_16x16x32_bf16 v[234:237], v[230:233], a[152:155], v[234:237]
    v_cvt_pk_f16_f32 v138, v134, v135
    v_pk_fma_f16 v158, v138, v138, v158
    v_mfma_f32_16x16x32_bf16 v[234:237], v[246:249], a[156:159], v[234:237]
    v_cvt_pk_f16_f32 v139, v136, v137
    v_pk_fma_f16 v158, v139, v139, v158
    v_mfma_f32_16x16x32_bf16 v[234:237], v[242:245], a[160:163], v[234:237]
    ds_read_b128 v[142:145], v0 offset:32768
    v_pk_fma_f16 v160, v138, v210, v160
    v_mfma_f32_16x16x32_bf16 v[234:237], v[194:197], a[164:167], v[234:237]
    ds_read_b128 v[178:181], v1 offset:32768
    v_pk_fma_f16 v160, v139, v211, v160
    v_mfma_f32_16x16x32_bf16 v[238:241], v[194:197], a[188:191], 0
    ds_read_b128 v[154:157], v0 offset:32896
    v_pk_fma_f16 v159, v140, v140, v159
    v_mfma_f32_16x16x32_bf16 v[238:241], v[242:245], a[184:187], v[238:241]
    ds_read_b128 v[170:173], v1 offset:32896
    v_cvt_pk_f16_f32 v141, v128, v129
    v_mfma_f32_16x16x32_bf16 v[238:241], v[246:249], a[180:183], v[238:241]
    ds_read_b128 v[206:209], v0 offset:33024
    v_cvt_pk_bf16_f32 v116, v234, v235
    v_mfma_f32_16x16x32_bf16 v[238:241], v[230:233], a[176:179], v[238:241]
    ds_read_b128 v[134:137], v1 offset:33024
    v_cvt_pk_bf16_f32 v117, v236, v237
    v_mfma_f32_16x16x32_bf16 v[238:241], v[222:225], a[172:175], v[238:241]
    v_pk_fma_f16 v159, v141, v141, v159
    v_pk_mul_f16 v161, v198, v202
    v_mfma_f32_16x16x32_bf16 v[238:241], v[218:221], a[168:171], v[238:241]
    buffer_store_dwordx4 v[226:229], v17, s[12:15], 0 offen nt
    v_pk_fma_f16 v161, v199, v203, v161
    v_pk_fma_f16 v161, v200, v204, v161
    v_pk_fma_f16 v161, v201, v205, v161
    v_pk_fma_f16 v161, v140, v212, v161
    v_mfma_f32_16x16x32_bf16 v[126:129], v[218:221], a[192:195], 0
    s_waitcnt lgkmcnt(4)
    v_pk_fma_f16 v161, v141, v213, v161
    v_cvt_pk_bf16_f32 v120, v238, v239
    v_mfma_f32_16x16x32_bf16 v[126:129], v[222:225], a[196:199], v[126:129]
    s_waitcnt lgkmcnt(3)
    v_cvt_pk_bf16_f32 v121, v240, v241
    v_mul_f32 v174, v147, v174
    v_mfma_f32_16x16x32_bf16 v[126:129], v[230:233], a[200:203], v[126:129]
    s_waitcnt lgkmcnt(2)
    v_exp_f32 v188, v188
    v_mfma_f32_16x16x32_bf16 v[126:129], v[246:249], a[204:207], v[126:129]
    s_waitcnt vmcnt(3)
    ds_write_b16 v8, v45 offset:512
    v_mfma_f32_16x16x32_bf16 v[126:129], v[242:245], a[208:211], v[126:129]
    s_waitcnt lgkmcnt(1)
    v_mov_b32 v45, 1
    v_cvt_pk_bf16_f32 v39, v188, 0
    v_mfma_f32_16x16x32_bf16 v[126:129], v[194:197], a[212:215], v[126:129]
    v_mul_f32 v175, v147, v175
    v_cvt_pk_bf16_f32 v174, v174, v175
    v_mfma_f32_16x16x32_f16 v[186:189], v[40:43], v[158:161], 0
    v_mul_f32 v176, v147, v176
    v_mul_f32 v177, v147, v177
    v_mfma_f32_16x16x32_bf16 v[158:161], a[72:75], v[142:145], 0
    v_cvt_pk_bf16_f32 v175, v176, v177
    v_mul_f32 v162, v147, v162
    v_mfma_f32_16x16x32_bf16 v[158:161], a[76:79], v[178:181], v[158:161]
    v_cvt_pk_bf16_f32 v152, v126, v127
    v_cvt_pk_bf16_f32 v153, v128, v129
    v_mfma_f32_16x16x32_bf16 v[158:161], a[80:83], v[154:157], v[158:161]
    v_rsq_f32 v186, v186
    v_mfma_f32_16x16x32_bf16 v[158:161], a[84:87], v[170:173], v[158:161]
    v_rsq_f32 v187, v187
    v_mfma_f32_16x16x32_bf16 v[158:161], a[88:91], v[206:209], v[158:161]
    s_waitcnt lgkmcnt(0)
    v_mul_f32 v148, s31, v186
    v_cvt_pk_f16_f32 v149, v148, v187
    v_mfma_f32_16x16x32_bf16 v[158:161], a[92:95], v[134:137], v[158:161]
    s_barrier
    v_fma_f32 v188, v188, v148, v24
    v_mfma_f32_16x16x32_bf16 v[126:129], a[116:119], v[134:137], 0
    v_fmac_f32_dpp v146, v189, v187 quad_perm:[0,1,2,3] row_mask:0x2 bank_mask:0xf
    v_mfma_f32_16x16x32_bf16 v[126:129], a[112:115], v[206:209], v[126:129]
    v_pk_mul_f16 v198, v198, v149 op_sel:[0,1] op_sel_hi:[1,1]
    v_mfma_f32_16x16x32_bf16 v[126:129], a[108:111], v[170:173], v[126:129]
    buffer_load_dwordx4 v10, s[8:11], 0 offen nt lds
    v_mfma_f32_16x16x32_bf16 v[126:129], a[104:107], v[154:157], v[126:129]
    s_add_u32 m0, s28, 4096
    ds_read_u16 v148, v9 offset:512
    v_pk_mul_f16 v199, v199, v149 op_sel:[0,1] op_sel_hi:[1,1]
    v_mfma_f32_16x16x32_bf16 v[126:129], a[100:103], v[178:181], v[126:129]
    v_pk_mul_f16 v200, v200, v149 op_sel:[0,1] op_sel_hi:[1,1]
    v_pk_mul_f16 v201, v201, v149 op_sel:[0,1] op_sel_hi:[1,1]
    v_mfma_f32_16x16x32_bf16 v[126:129], a[96:99], v[142:145], v[126:129]
    v_pk_mul_f16 v140, v140, v149 op_sel:[0,1] op_sel_hi:[1,1]
    v_pk_mul_f16 v141, v141, v149 op_sel:[0,1] op_sel_hi:[1,1]
    v_mfma_f32_16x16x32_bf16 v[194:197], a[120:123], v[142:145], 0
    v_pk_mul_f16 v190, v190, v149 op_sel:[0,0] op_sel_hi:[1,0]
    v_pk_mul_f16 v191, v191, v149 op_sel:[0,0] op_sel_hi:[1,0]
    v_mfma_f32_16x16x32_bf16 v[194:197], a[124:127], v[178:181], v[194:197]
    buffer_load_dwordx4 v11, s[8:11], 0 offen nt lds
    v_pk_mul_f16 v192, v192, v149 op_sel:[0,0] op_sel_hi:[1,0]
    v_mfma_f32_16x16x32_bf16 v[194:197], a[128:131], v[154:157], v[194:197]
    s_add_u32 m0, s28, 8192
    v_pk_mul_f16 v193, v193, v149 op_sel:[0,0] op_sel_hi:[1,0]
    v_pk_mul_f16 v138, v138, v149 op_sel:[0,0] op_sel_hi:[1,0]
    v_mfma_f32_16x16x32_bf16 v[194:197], a[132:135], v[170:173], v[194:197]
    v_pk_mul_f16 v139, v139, v149 op_sel:[0,0] op_sel_hi:[1,0]
    v_max3_u32 v44, v44, v186, v187
    v_mfma_f32_16x16x32_bf16 v[194:197], a[136:139], v[206:209], v[194:197]
    v_cvt_pk_f16_f32 v218, v158, v159
    v_pk_mul_f16 v159, v218, v218
    v_mfma_f32_16x16x32_bf16 v[194:197], a[140:143], v[134:137], v[194:197]
    s_waitcnt lgkmcnt(0)
    v_readfirstlane_b32 s77, v148
    v_cvt_pk_f16_f32 v219, v160, v161
    v_mfma_f32_16x16x32_bf16 v[222:225], a[20:23], v[134:137], 0
    buffer_load_dwordx4 v12, s[8:11], 0 offen nt lds
    v_pk_fma_f16 v159, v219, v219, v159
    v_mfma_f32_16x16x32_bf16 v[222:225], a[16:19], v[206:209], v[222:225]
    s_add_u32 m0, s28, 12288
    v_cvt_pk_f16_f32 v220, v126, v127
    v_pk_fma_f16 v159, v220, v220, v159
    v_mfma_f32_16x16x32_bf16 v[222:225], a[12:15], v[170:173], v[222:225]
    s_xor_b32 s28, s28, 65536
    v_cvt_pk_f16_f32 v221, v128, v129
    v_pk_fma_f16 v159, v221, v221, v159
    v_mfma_f32_16x16x32_bf16 v[222:225], a[8:11], v[154:157], v[222:225]
    s_mul_i32 s78, s77, 2688
    v_cvt_pk_f16_f32 v128, v194, v195
    v_pk_fma_f16 v159, v128, v128, v159
    v_mfma_f32_16x16x32_bf16 v[222:225], a[4:7], v[178:181], v[222:225]
    v_cvt_pk_f16_f32 v129, v196, v197
    v_pk_fma_f16 v159, v129, v129, v159
    v_mfma_f32_16x16x32_bf16 v[222:225], a[0:3], v[142:145], v[222:225]
    buffer_load_dwordx4 v13, s[8:11], 0 offen nt lds
    v_pk_mul_f16 v161, v218, v202
    v_mfma_f32_16x16x32_bf16 v[194:197], a[24:27], v[142:145], 0
    s_mov_b32 m0, s29
    v_pk_fma_f16 v161, v219, v203, v161
    v_pk_fma_f16 v161, v220, v204, v161
    v_mfma_f32_16x16x32_bf16 v[194:197], a[28:31], v[178:181], v[194:197]
    s_xor_b32 s29, s29, s30
    v_cvt_pk_f16_f32 v202, v222, v223
    v_pk_mul_f16 v158, v202, v202
    v_mfma_f32_16x16x32_bf16 v[194:197], a[32:35], v[154:157], v[194:197]
    s_add_u32 s19, s19, s20
    ds_read2_b32 v[228:229], v6 offset0:0 offset1:0
    v_cvt_pk_f16_f32 v203, v224, v225
    v_mfma_f32_16x16x32_bf16 v[194:197], a[36:39], v[170:173], v[194:197]
    s_add_u32 s23, s23, s21
    ds_read2_b32 v[224:225], v6 offset0:16 offset1:16
    v_pk_fma_f16 v158, v203, v203, v158
    v_mfma_f32_16x16x32_bf16 v[194:197], a[40:43], v[206:209], v[194:197]
    buffer_load_dwordx4 v14, s[8:11], 0 offen nt lds
    ds_read2_b32 v[232:233], v6 offset0:32 offset1:32
    v_mfma_f32_16x16x32_bf16 v[194:197], a[44:47], v[134:137], v[194:197]
    s_cmp_ge_u32 s19, 72
    v_pk_mul_f16 v160, v202, v122
    v_pk_fma_f16 v160, v203, v123, v160
    v_mfma_f32_16x16x32_bf16 v[234:237], a[68:71], v[134:137], 0
    s_cselect_b32 s34, 72, 0
    v_pk_fma_f16 v161, v221, v205, v161
    v_pk_fma_f16 v161, v128, v212, v161
    v_mfma_f32_16x16x32_bf16 v[234:237], a[64:67], v[206:209], v[234:237]
    s_cselect_b32 s35, s22, 0
    v_cvt_pk_f16_f32 v204, v194, v195
    v_pk_fma_f16 v158, v204, v204, v158
    v_mfma_f32_16x16x32_bf16 v[234:237], a[60:63], v[170:173], v[234:237]
    s_sub_u32 s19, s19, s34
    v_cvt_pk_f16_f32 v205, v196, v197
    v_pk_fma_f16 v158, v205, v205, v158
    v_mfma_f32_16x16x32_bf16 v[234:237], a[56:59], v[154:157], v[234:237]
    s_add_u32 s23, s23, s35
    v_pk_fma_f16 v160, v204, v124, v160
    v_pk_fma_f16 v160, v205, v125, v160
    v_mfma_f32_16x16x32_bf16 v[234:237], a[52:55], v[178:181], v[234:237]
    s_add_u32 s78, s78, s69
    v_pk_fma_f16 v161, v129, v213, v161
    v_mul_f32 v163, v147, v163
    v_mfma_f32_16x16x32_bf16 v[234:237], a[48:51], v[142:145], v[234:237]
    s_waitcnt lgkmcnt(1)
    buffer_store_dwordx2 v[254:255], v20, s[12:15], 0 offen nt
    v_exp_f32 v188, v188
    v_mfma_f32_16x16x32_bf16 v[122:125], v[142:145], a[144:147], 0
    s_add_u32 s80, s77, s68
    v_cvt_pk_bf16_f32 v176, v162, v163
    v_mul_f32 v164, v147, v164
    v_mfma_f32_16x16x32_bf16 v[122:125], v[178:181], a[148:151], v[122:125]
    s_cmp_ge_u32 s80, 72
    v_cvt_pk_f16_f32 v126, v234, v235
    v_pk_fma_f16 v158, v126, v126, v158
    v_mfma_f32_16x16x32_bf16 v[122:125], v[154:157], a[152:155], v[122:125]
    s_cselect_b32 s80, s22, 0
    v_cvt_pk_f16_f32 v127, v236, v237
    v_pk_fma_f16 v158, v127, v127, v158
    v_mfma_f32_16x16x32_bf16 v[122:125], v[170:173], a[156:159], v[122:125]
    s_add_u32 s78, s78, s80
    v_pk_fma_f16 v160, v126, v210, v160
    v_pk_fma_f16 v160, v127, v211, v160
    v_mfma_f32_16x16x32_bf16 v[122:125], v[206:209], a[160:163], v[122:125]
    s_add_u32 s80, s77, 20
    v_mul_f32 v165, v147, v165
    v_cvt_pk_bf16_f32 v177, v164, v165
    v_mfma_f32_16x16x32_bf16 v[122:125], v[134:137], a[164:167], v[122:125]
    s_add_u32 s34, s18, 3
    ds_read_b128 v[194:197], v2 offset:0
    v_mul_f32 v214, v147, v214
    v_mfma_f32_16x16x32_f16 v[162:165], v[40:43], v[158:161], 0
    s_cmp_lt_u32 s77, s62
    v_mul_f32 v215, v147, v215
    v_cvt_pk_bf16_f32 v254, v214, v215
    v_mfma_f32_16x16x32_bf16 v[210:213], v[134:137], a[188:191], 0
    s_cselect_b32 s79, 1, 0
    ds_read_b128 v[158:161], v2 offset:1024
    v_cvt_pk_bf16_f32 v226, v122, v123
    v_mfma_f32_16x16x32_bf16 v[210:213], v[206:209], a[184:187], v[210:213]
    s_cselect_b32 s78, s78, 0
    ds_read_b128 v[234:237], v2 offset:2048
    v_cvt_pk_bf16_f32 v227, v124, v125
    v_mfma_f32_16x16x32_bf16 v[210:213], v[170:173], a[180:183], v[210:213]
    s_cmp_lt_u32 s34, s17
    ds_read_b128 v[122:125], v2 offset:3072
    v_mul_f32 v216, v147, v216
    v_mfma_f32_16x16x32_bf16 v[210:213], v[154:157], a[176:179], v[210:213]
    s_cselect_b32 s23, s23, s78
    ds_read_b128 v[238:241], v2 offset:4096
    v_mul_f32 v217, v147, v217
    v_mfma_f32_16x16x32_bf16 v[210:213], v[178:181], a[172:175], v[210:213]
    s_cselect_b32 s73, s34, s80
    ds_read_b128 v[242:245], v2 offset:5120
    v_cvt_pk_bf16_f32 v255, v216, v217
    v_mfma_f32_16x16x32_bf16 v[210:213], v[142:145], a[168:171], v[210:213]
    s_cselect_b32 s79, 0, s79
    v_rsq_f32 v162, v162
    v_mfma_f32_16x16x32_bf16 v[214:217], v[142:145], a[192:195], 0
    s_waitcnt lgkmcnt(5)
    v_rsq_f32 v163, v163
    v_mfma_f32_16x16x32_bf16 v[214:217], v[178:181], a[196:199], v[214:217]
    s_cselect_b32 s81, 0, 1
    v_mul_f32 v148, s31, v162
    v_cvt_pk_f16_f32 v149, v148, v163
    v_mfma_f32_16x16x32_bf16 v[214:217], v[154:157], a[200:203], v[214:217]
    s_add_u32 s80, s77, 1
    v_fma_f32 v164, v164, v148, v26
    v_fmac_f32_dpp v146, v165, v163 quad_perm:[0,1,2,3] row_mask:0x4 bank_mask:0xf
    v_mfma_f32_16x16x32_bf16 v[214:217], v[170:173], a[204:207], v[214:217]
    s_mul_i32 s80, s80, s81
    v_cvt_pk_bf16_f32 v222, v210, v211
    v_cvt_pk_bf16_f32 v223, v212, v213
    v_mfma_f32_16x16x32_bf16 v[214:217], v[206:209], a[208:211], v[214:217]
    s_cmp_lt_u32 s80, s62
    v_pk_mul_f16 v218, v218, v149 op_sel:[0,1] op_sel_hi:[1,1]
    v_pk_mul_f16 v219, v219, v149 op_sel:[0,1] op_sel_hi:[1,1]
    v_mfma_f32_16x16x32_bf16 v[214:217], v[134:137], a[212:215], v[214:217]
    s_waitcnt lgkmcnt(1)
    buffer_store_dwordx4 v[174:177], v16, s[12:15], 0 offen nt
    v_pk_mul_f16 v220, v220, v149 op_sel:[0,1] op_sel_hi:[1,1]
    v_pk_mul_f16 v221, v221, v149 op_sel:[0,1] op_sel_hi:[1,1]
    v_pk_mul_f16 v128, v128, v149 op_sel:[0,1] op_sel_hi:[1,1]
    v_pk_mul_f16 v129, v129, v149 op_sel:[0,1] op_sel_hi:[1,1]
    v_mfma_f32_16x16x32_f16 v[134:137], v[182:185], v[130:133], v[46:49]
    s_waitcnt lgkmcnt(0)
    v_cvt_pk_bf16_f32 v230, v214, v215
    v_cvt_pk_bf16_f32 v231, v216, v217
    v_mfma_f32_16x16x32_f16 v[142:145], v[198:201], v[130:133], v[50:53]
    s_cselect_b32 s62, s62, 0
    v_pk_mul_f16 v202, v202, v149 op_sel:[0,0] op_sel_hi:[1,0]
    v_pk_mul_f16 v203, v203, v149 op_sel:[0,0] op_sel_hi:[1,0]
    v_mfma_f32_16x16x32_f16 v[154:157], v[218:221], v[130:133], v[54:57]
    s_add_u32 s80, s18, 4
    v_pk_mul_f16 v204, v204, v149 op_sel:[0,0] op_sel_hi:[1,0]
    v_pk_mul_f16 v205, v205, v149 op_sel:[0,0] op_sel_hi:[1,0]
    v_pk_mul_f16 v126, v126, v149 op_sel:[0,0] op_sel_hi:[1,0]
    v_mfma_f32_16x16x16_f16 v[134:137], v[168:169], v[166:167], v[134:137]
    v_pk_mul_f16 v127, v127, v149 op_sel:[0,0] op_sel_hi:[1,0]
    v_max3_u32 v44, v44, v162, v163
    v_add_u32 v6, s75, v6
    v_mfma_f32_16x16x16_f16 v[142:145], v[140:141], v[166:167], v[142:145]
    v_exp_f32 v146, v146
    v_xor_b32 v0, 65536, v0
    v_mfma_f32_16x16x16_f16 v[154:157], v[128:129], v[166:167], v[154:157]
    v_cvt_pk_bf16_f32 v146, v146, v146
    v_exp_f32 v134, v134
    v_xor_b32 v1, 65536, v1
    v_mfma_f32_16x16x32_f16 v[130:133], v[182:185], v[190:193], v[58:61]
    s_cmp_ge_u32 s80, s17
    ds_write_b16 v8, v146
    v_mfma_f32_16x16x32_f16 v[146:149], v[198:201], v[190:193], v[62:65]
    s_cselect_b32 s66, s62, 0
    v_exp_f32 v135, v135
    v_mfma_f32_16x16x32_f16 v[170:173], v[218:221], v[190:193], v[66:69]
    s_lshl_b32 s80, s79, s73
    v_cvt_pk_bf16_f32 v134, v134, v135
    v_exp_f32 v136, v136
    v_mfma_f32_16x16x16_f16 v[130:133], v[168:169], v[138:139], v[130:133]
    v_exp_f32 v137, v137
    s_or_b32 s70, s70, s80
    v_mfma_f32_16x16x16_f16 v[146:149], v[140:141], v[138:139], v[146:149]
    v_cvt_pk_bf16_f32 v135, v136, v137
    v_exp_f32 v142, v142
    v_mfma_f32_16x16x16_f16 v[170:173], v[128:129], v[138:139], v[170:173]
    v_exp_f32 v143, v143
    v_exp_f32 v144, v144
    v_mfma_f32_16x16x32_bf16 v[178:181], a[216:219], v[194:197], 0
    s_add_u32 s45, s45, s79
    v_exp_f32 v145, v145
    v_mfma_f32_16x16x32_bf16 v[178:181], a[220:223], v[158:161], v[178:181]
    s_add_u32 s18, s18, 1
    v_cvt_pk_bf16_f32 v136, v142, v143
    v_cvt_pk_bf16_f32 v137, v144, v145
    v_mfma_f32_16x16x32_bf16 v[178:181], a[224:227], v[234:237], v[178:181]
    s_cmp_lt_u32 s18, s45
    v_exp_f32 v154, v154
    v_mfma_f32_16x16x32_bf16 v[178:181], a[228:231], v[122:125], v[178:181]
    buffer_atomic_add v45, v10, s[64:67], 0 offen sc0 sc1
    v_mfma_f32_16x16x32_bf16 v[178:181], a[232:235], v[238:241], v[178:181]
    v_exp_f32 v155, v155
    v_mfma_f32_16x16x32_bf16 v[178:181], a[236:239], v[242:245], v[178:181]
    buffer_store_dwordx2 v[254:255], v19, s[12:15], 0 offen nt
    v_exp_f32 v156, v156
    v_mfma_f32_16x16x32_bf16 v[142:145], v[86:89], v[242:245], 0
    v_exp_f32 v157, v157
    v_mfma_f32_16x16x32_bf16 v[142:145], v[82:85], v[238:241], v[142:145]
    v_cvt_pk_bf16_f32 v36, v154, v155
    v_cvt_pk_bf16_f32 v37, v156, v157
    v_mfma_f32_16x16x32_bf16 v[142:145], a[252:255], v[122:125], v[142:145]
    v_exp_f32 v164, v164
    v_mfma_f32_16x16x32_bf16 v[142:145], a[248:251], v[234:237], v[142:145]
    ds_read_b128 v[154:157], v2 offset:11264
    v_fma_f32 v254, v178, v178, s33
    v_mfma_f32_16x16x32_bf16 v[142:145], a[244:247], v[158:161], v[142:145]
    ds_read_b128 v[206:209], v2 offset:10240
    v_fmac_f32 v254, v179, v179
    v_mfma_f32_16x16x32_bf16 v[142:145], a[240:243], v[194:197], v[142:145]
    ds_read_b128 v[210:213], v2 offset:9216
    v_fmac_f32 v254, v180, v180
    v_mfma_f32_16x16x32_bf16 v[190:193], v[28:31], v[36:39], 0
    v_exp_f32 v130, v130
    v_mfma_f32_16x16x32_bf16 v[190:193], v[28:31], v[134:137], v[190:193]
    v_exp_f32 v131, v131
    v_mfma_f32_16x16x32_bf16 v[174:177], v[114:117], v[134:137], 0
    v_cvt_pk_bf16_f32 v130, v130, v131
    v_fmac_f32 v254, v181, v181
    v_mfma_f32_16x16x32_bf16 v[174:177], v[226:229], v[36:39], v[174:177]
    v_exp_f32 v132, v132
    v_mfma_f32_16x16x32_bf16 v[246:249], v[222:225], v[36:39], 0
    v_exp_f32 v133, v133
    v_mfma_f32_16x16x32_bf16 v[246:249], v[118:121], v[134:137], v[246:249]
    s_waitcnt lgkmcnt(2)
    v_cvt_pk_bf16_f32 v131, v132, v133
    v_fmac_f32 v254, v142, v142
    v_mfma_f32_16x16x32_bf16 v[250:253], v[150:153], v[134:137], 0
    s_waitcnt lgkmcnt(1)
    v_exp_f32 v146, v146
    v_mfma_f32_16x16x32_bf16 v[250:253], v[230:233], v[36:39], v[250:253]
    s_waitcnt lgkmcnt(0)
    v_exp_f32 v147, v147
    v_mfma_f32_16x16x32_bf16 v[134:137], v[90:93], v[194:197], 0
    ds_read_b128 v[194:197], v2 offset:8192
    v_cvt_pk_bf16_f32 v132, v146, v147
    v_mfma_f32_16x16x32_bf16 v[134:137], v[94:97], v[158:161], v[134:137]
    ds_read_b128 v[158:161], v2 offset:7168
    v_cvt_pk_bf16_f32 v39, v188, 0
    v_mfma_f32_16x16x32_bf16 v[134:137], v[98:101], v[234:237], v[134:137]
    ds_read_b128 v[186:189], v2 offset:6144
    v_fmac_f32 v254, v143, v143
    v_mfma_f32_16x16x32_bf16 v[134:137], v[102:105], v[122:125], v[134:137]
    v_exp_f32 v148, v148
    v_mfma_f32_16x16x32_bf16 v[134:137], v[106:109], v[238:241], v[134:137]
    v_exp_f32 v149, v149
    v_mfma_f32_16x16x32_bf16 v[134:137], v[110:113], v[242:245], v[134:137]
    v_cvt_pk_bf16_f32 v133, v148, v149
    v_fmac_f32 v254, v144, v144
    v_mfma_f32_16x16x32_f16 v[214:217], v[182:185], v[202:205], v[70:73]
    v_exp_f32 v170, v170
    v_mfma_f32_16x16x32_f16 v[146:149], v[198:201], v[202:205], v[74:77]
    v_exp_f32 v171, v171
    v_mfma_f32_16x16x32_f16 v[122:125], v[218:221], v[202:205], v[78:81]
    s_waitcnt lgkmcnt(2)
    v_cvt_pk_bf16_f32 v36, v170, v171
    v_exp_f32 v172, v172
    v_mfma_f32_16x16x16_f16 v[214:217], v[168:169], v[126:127], v[214:217]
    v_exp_f32 v173, v173
    v_fmac_f32 v254, v145, v145
    v_mfma_f32_16x16x16_f16 v[146:149], v[140:141], v[126:127], v[146:149]
    v_cvt_pk_bf16_f32 v37, v172, v173
    v_rcp_f32 v191, v190
    v_mfma_f32_16x16x16_f16 v[122:125], v[128:129], v[126:127], v[122:125]
    v_max3_u32 v25, v25, v191, v190
    v_mul_f32 v174, v191, v174
    v_exp_f32 v214, v214
    v_mfma_f32_16x16x32_bf16 v[126:129], v[28:31], v[36:39], 0
    s_waitcnt lgkmcnt(0)
    v_exp_f32 v215, v215
    v_mfma_f32_16x16x32_bf16 v[126:129], v[28:31], v[130:133], v[126:129]
    v_cvt_pk_bf16_f32 v170, v214, v215
    v_mul_f32 v175, v191, v175
    v_mfma_f32_16x16x32_bf16 v[138:141], v[114:117], v[130:133], 0
    v_exp_f32 v216, v216
    v_mfma_f32_16x16x32_bf16 v[138:141], v[226:229], v[36:39], v[138:141]
    ds_read_b128 v[166:169], v9
    v_cvt_pk_bf16_f32 v202, v174, v175
    v_mfma_f32_16x16x32_bf16 v[198:201], v[222:225], v[36:39], 0
    ds_read_b128 v[182:185], v9 offset:64
    v_mul_f32 v176, v191, v176
    v_mfma_f32_16x16x32_bf16 v[198:201], v[118:121], v[130:133], v[198:201]
    v_exp_f32 v217, v217
    v_mfma_f32_16x16x32_bf16 v[218:221], v[150:153], v[130:133], 0
    v_cvt_pk_bf16_f32 v171, v216, v217
    v_mul_f32 v177, v191, v177
    v_mfma_f32_16x16x32_bf16 v[218:221], v[230:233], v[36:39], v[218:221]
    v_exp_f32 v146, v146
    v_mfma_f32_16x16x32_bf16 v[214:217], v[110:113], v[154:157], 0
    v_exp_f32 v147, v147
    v_mfma_f32_16x16x32_bf16 v[214:217], v[106:109], v[206:209], v[214:217]
    v_cvt_pk_bf16_f32 v172, v146, v147
    v_cvt_pk_bf16_f32 v39, v164, 0
    v_mfma_f32_16x16x32_bf16 v[214:217], v[102:105], v[210:213], v[214:217]
    v_exp_f32 v148, v148
    v_mfma_f32_16x16x32_bf16 v[214:217], v[98:101], v[194:197], v[214:217]
    s_waitcnt lgkmcnt(1)
    v_exp_f32 v149, v149
    v_mfma_f32_16x16x32_bf16 v[214:217], v[94:97], v[158:161], v[214:217]
    s_waitcnt lgkmcnt(0)
    v_cvt_pk_bf16_f32 v173, v148, v149
    v_cvt_pk_bf16_f32 v203, v176, v177
    v_mfma_f32_16x16x32_bf16 v[214:217], v[90:93], v[186:189], v[214:217]
    v_exp_f32 v122, v122
    v_mfma_f32_16x16x32_bf16 v[162:165], a[240:243], v[186:189], 0
    v_exp_f32 v123, v123
    v_mfma_f32_16x16x32_bf16 v[162:165], a[244:247], v[158:161], v[162:165]
    v_cvt_pk_bf16_f32 v36, v122, v123
    v_mul_f32 v246, v191, v246
    v_mfma_f32_16x16x32_bf16 v[162:165], a[248:251], v[194:197], v[162:165]
    v_exp_f32 v124, v124
    v_mfma_f32_16x16x32_bf16 v[162:165], a[252:255], v[210:213], v[162:165]
    ds_read_b128 v[130:133], v2 offset:12288
    v_fma_f32 v255, v214, v214, s33
    v_mfma_f32_16x16x32_bf16 v[162:165], v[82:85], v[206:209], v[162:165]
    ds_read_b128 v[146:149], v2 offset:13312
    v_fmac_f32 v255, v215, v215
    v_mfma_f32_16x16x32_bf16 v[162:165], v[86:89], v[154:157], v[162:165]
    ds_read_b128 v[234:237], v2 offset:14336
    v_fmac_f32 v255, v216, v216
    v_mfma_f32_16x16x32_bf16 v[174:177], a[236:239], v[154:157], 0
    ds_read_b128 v[154:157], v2 offset:15360
    v_fmac_f32 v255, v217, v217
    v_mfma_f32_16x16x32_bf16 v[174:177], a[232:235], v[206:209], v[174:177]
    ds_read_b128 v[206:209], v2 offset:16384
    v_mul_f32 v247, v191, v247
    v_mfma_f32_16x16x32_bf16 v[174:177], a[228:231], v[210:213], v[174:177]
    ds_read_b128 v[210:213], v2 offset:17408
    v_fmac_f32 v255, v162, v162
    v_mfma_f32_16x16x32_bf16 v[174:177], a[224:227], v[194:197], v[174:177]
    v_exp_f32 v125, v125
    v_mfma_f32_16x16x32_bf16 v[174:177], a[220:223], v[158:161], v[174:177]
    v_cvt_pk_bf16_f32 v37, v124, v125
    v_fmac_f32 v255, v163, v163
    v_mfma_f32_16x16x32_bf16 v[174:177], a[216:219], v[186:189], v[174:177]
    s_waitcnt lgkmcnt(5)
    v_fmac_f32 v255, v164, v164
    v_fmac_f32 v255, v165, v165
    v_mfma_f32_16x16x32_bf16 v[122:125], v[28:31], v[36:39], 0
    s_waitcnt lgkmcnt(4)
    v_cvt_pk_bf16_f32 v204, v246, v247
    v_mul_f32 v248, v191, v248
    v_mfma_f32_16x16x32_bf16 v[122:125], v[28:31], v[170:173], v[122:125]
    s_waitcnt lgkmcnt(3)
    v_fmac_f32 v255, v174, v174
    v_fmac_f32 v255, v175, v175
    v_mfma_f32_16x16x32_bf16 v[158:161], v[114:117], v[170:173], 0
    s_waitcnt lgkmcnt(2)
    v_fmac_f32 v255, v176, v176
    v_fmac_f32 v255, v177, v177
    v_mfma_f32_16x16x32_bf16 v[158:161], v[226:229], v[36:39], v[158:161]
    s_waitcnt lgkmcnt(1)
    v_rcp_f32 v123, v122
    v_mfma_f32_16x16x32_bf16 v[186:189], v[222:225], v[36:39], 0
    s_waitcnt lgkmcnt(0)
    v_mul_f32 v249, v191, v249
    v_cvt_pk_bf16_f32 v205, v248, v249
    v_mfma_f32_16x16x32_bf16 v[186:189], v[118:121], v[170:173], v[186:189]
    ds_write_b128 v3, v[202:205] offset:0
    v_mfma_f32_16x16x32_bf16 v[194:197], v[150:153], v[170:173], 0
    v_mul_f32 v158, v123, v158
    v_mul_f32 v159, v123, v159
    v_mfma_f32_16x16x32_bf16 v[194:197], v[230:233], v[36:39], v[194:197]
    v_cvt_pk_bf16_f32 v158, v158, v159
    v_mul_f32 v160, v123, v160
    v_mfma_f32_16x16x32_bf16 v[170:173], a[216:219], v[130:133], 0
    v_mul_f32 v161, v123, v161
    v_cvt_pk_bf16_f32 v159, v160, v161
    v_mfma_f32_16x16x32_bf16 v[170:173], a[220:223], v[146:149], v[170:173]
    v_mul_f32 v186, v123, v186
    v_mul_f32 v187, v123, v187
    v_mfma_f32_16x16x32_bf16 v[170:173], a[224:227], v[234:237], v[170:173]
    v_cvt_pk_bf16_f32 v160, v186, v187
    v_mul_f32 v188, v123, v188
    v_mfma_f32_16x16x32_bf16 v[170:173], a[228:231], v[154:157], v[170:173]
    v_mul_f32 v189, v123, v189
    v_cvt_pk_bf16_f32 v161, v188, v189
    v_mfma_f32_16x16x32_bf16 v[170:173], a[232:235], v[206:209], v[170:173]
    v_mul_f32 v194, v123, v194
    v_mul_f32 v195, v123, v195
    v_mfma_f32_16x16x32_bf16 v[170:173], a[236:239], v[210:213], v[170:173]
    ds_write_b128 v3, v[158:161] offset:12288
    v_mfma_f32_16x16x32_bf16 v[158:161], v[86:89], v[210:213], 0
    v_cvt_pk_bf16_f32 v124, v194, v195
    v_mul_f32 v196, v123, v196
    v_mfma_f32_16x16x32_bf16 v[158:161], v[82:85], v[206:209], v[158:161]
    v_mul_f32 v197, v123, v197
    v_cvt_pk_bf16_f32 v125, v196, v197
    v_mfma_f32_16x16x32_bf16 v[158:161], a[252:255], v[154:157], v[158:161]
    v_fma_f32 v128, v170, v170, s33
    v_fmac_f32 v128, v171, v171
    v_mfma_f32_16x16x32_bf16 v[158:161], a[248:251], v[234:237], v[158:161]
    v_fmac_f32 v128, v172, v172
    v_fmac_f32 v128, v173, v173
    v_mfma_f32_16x16x32_bf16 v[158:161], a[244:247], v[146:149], v[158:161]
    v_mul_f32 v250, v191, v250
    v_mul_f32 v251, v191, v251
    v_mfma_f32_16x16x32_bf16 v[158:161], a[240:243], v[130:133], v[158:161]
    ds_write_b64 v4, v[124:125] offset:16384
    v_mfma_f32_16x16x32_bf16 v[238:241], v[90:93], v[130:133], 0
    v_cvt_pk_bf16_f32 v124, v250, v251
    v_mul_f32 v252, v191, v252
    v_mfma_f32_16x16x32_bf16 v[238:241], v[94:97], v[146:149], v[238:241]
    v_mul_f32 v253, v191, v253
    v_cvt_pk_bf16_f32 v125, v252, v253
    v_mfma_f32_16x16x32_bf16 v[238:241], v[98:101], v[234:237], v[238:241]
    v_fmac_f32 v128, v158, v158
    v_fmac_f32 v128, v159, v159
    v_mfma_f32_16x16x32_bf16 v[238:241], v[102:105], v[154:157], v[238:241]
    v_fmac_f32 v128, v160, v160
    v_fmac_f32 v128, v161, v161
    v_mfma_f32_16x16x32_bf16 v[238:241], v[106:109], v[206:209], v[238:241]
    v_rcp_f32 v127, v126
    v_mfma_f32_16x16x32_bf16 v[238:241], v[110:113], v[210:213], v[238:241]
    ds_read_b128 v[154:157], v0 offset:20480
    v_max3_u32 v25, v25, v127, v126
    v_mfma_f32_16x16x32_bf16 v[130:133], v[166:169], v[28:31], 0
    ds_read_b128 v[186:189], v1 offset:20480
    v_max3_u32 v25, v25, v123, v122
    v_mfma_f32_16x16x32_bf16 v[130:133], v[182:185], v[28:31], v[130:133]
    ds_read_b128 v[206:209], v0 offset:20608
    v_mul_f32 v138, v127, v138
    v_mfma_f32_16x16x32_bf16 v[146:149], v[182:185], v[226:229], 0
    ds_read_b128 v[190:193], v1 offset:20608
    v_fmac_f32 v128, v238, v238
    v_mfma_f32_16x16x32_bf16 v[146:149], v[166:169], v[114:117], v[146:149]
    ds_read_b128 v[226:229], v0 offset:20736
    v_fmac_f32 v128, v239, v239
    v_mfma_f32_16x16x32_bf16 v[114:117], v[166:169], v[118:121], 0
    ds_read_b128 v[234:237], v1 offset:20736
    v_fmac_f32 v128, v240, v240
    v_mfma_f32_16x16x32_bf16 v[114:117], v[182:185], v[222:225], v[114:117]
    ds_write_b64 v4, v[124:125] offset:4096
    v_mfma_f32_16x16x32_bf16 v[118:121], v[182:185], v[230:233], 0
    s_waitcnt lgkmcnt(6)
    v_fmac_f32 v128, v241, v241
    v_cvt_pk_bf16_f32 v147, v128, v128
    v_mfma_f32_16x16x32_bf16 v[118:121], v[166:169], v[150:153], v[118:121]
    s_waitcnt lgkmcnt(5)
    v_mul_f32 v139, v127, v139
    v_cvt_pk_bf16_f32 v122, v138, v139
    v_mfma_f32_16x16x32_bf16 v[150:153], a[72:75], v[154:157], 0
    s_waitcnt lgkmcnt(4)
    v_mul_f32 v140, v127, v140
    v_mul_f32 v141, v127, v141
    v_mfma_f32_16x16x32_bf16 v[150:153], a[76:79], v[186:189], v[150:153]
    s_waitcnt lgkmcnt(3)
    v_cvt_pk_bf16_f32 v123, v140, v141
    v_mul_f32 v198, v127, v198
    v_mfma_f32_16x16x32_bf16 v[150:153], a[80:83], v[206:209], v[150:153]
    s_waitcnt lgkmcnt(2)
    v_mul_f32 v199, v127, v199
    v_cvt_pk_bf16_f32 v124, v198, v199
    v_mfma_f32_16x16x32_bf16 v[150:153], a[84:87], v[190:193], v[150:153]
    s_waitcnt lgkmcnt(1)
    v_mul_f32 v200, v127, v200
    v_mul_f32 v201, v127, v201
    v_mfma_f32_16x16x32_bf16 v[150:153], a[88:91], v[226:229], v[150:153]
    v_cvt_pk_bf16_f32 v125, v200, v201
    v_mul_f32 v218, v127, v218
    v_mfma_f32_16x16x32_bf16 v[150:153], a[92:95], v[234:237], v[150:153]
    ds_write_b128 v3, v[122:125] offset:6144
    v_mfma_f32_16x16x32_bf16 v[122:125], a[116:119], v[234:237], 0
    v_mul_f32 v219, v127, v219
    v_cvt_pk_bf16_f32 v148, v218, v219
    v_mfma_f32_16x16x32_bf16 v[122:125], a[112:115], v[226:229], v[122:125]
    v_mul_f32 v220, v127, v220
    v_mul_f32 v221, v127, v221
    v_mfma_f32_16x16x32_bf16 v[122:125], a[108:111], v[190:193], v[122:125]
    v_cvt_pk_bf16_f32 v149, v220, v221
    v_fmac_f32 v254, v134, v134
    v_mfma_f32_16x16x32_bf16 v[122:125], a[104:107], v[206:209], v[122:125]
    v_rcp_f32_dpp v131, v130 quad_perm:[0,0,0,0] row_mask:0xf bank_mask:0xf
    v_mfma_f32_16x16x32_bf16 v[122:125], a[100:103], v[186:189], v[122:125]
    v_max3_u32 v25, v25, v130, v131
    v_mul_f32 v146, v146, v131
    v_mfma_f32_16x16x32_bf16 v[122:125], a[96:99], v[154:157], v[122:125]
    ds_write_b64 v4, v[148:149] offset:10240
    v_mfma_f32_16x16x32_bf16 v[126:129], a[120:123], v[154:157], 0
    v_mul_f32_dpp v146, v114, v131 quad_perm:[0,1,2,3] row_mask:0x2 bank_mask:0xf
    v_fmac_f32 v254, v135, v135
    v_mfma_f32_16x16x32_bf16 v[126:129], a[124:127], v[186:189], v[126:129]
    v_mul_f32_dpp v146, v118, v131 quad_perm:[0,1,2,3] row_mask:0x4 bank_mask:0xf
    v_cvt_pk_bf16_f32 v146, v146, v146
    v_mfma_f32_16x16x32_bf16 v[126:129], a[128:131], v[206:209], v[126:129]
    ds_write_b16 v7, v146
    v_mfma_f32_16x16x32_bf16 v[126:129], a[132:135], v[190:193], v[126:129]
    v_add_u32 v7, s76, v7
    v_fmac_f32 v254, v136, v136
    v_mfma_f32_16x16x32_bf16 v[126:129], a[136:139], v[226:229], v[126:129]
    v_fmac_f32 v254, v137, v137
    v_cvt_pk_bf16_f32 v146, v254, v255
    v_mfma_f32_16x16x32_bf16 v[126:129], a[140:143], v[234:237], v[126:129]
    ds_write_b64 v4, v[146:147] offset:18432
    v_mfma_f32_16x16x32_bf16 v[114:117], a[20:23], v[234:237], 0
    v_cvt_pk_f16_f32 v182, v150, v151
    v_pk_mul_f16 v139, v182, v182
    v_mfma_f32_16x16x32_bf16 v[114:117], a[16:19], v[226:229], v[114:117]
    v_cvt_pk_f16_f32 v183, v152, v153
    v_pk_fma_f16 v139, v183, v183, v139
    v_mfma_f32_16x16x32_bf16 v[114:117], a[12:15], v[190:193], v[114:117]
    v_cvt_pk_f16_f32 v184, v122, v123
    v_pk_fma_f16 v139, v184, v184, v139
    v_mfma_f32_16x16x32_bf16 v[114:117], a[8:11], v[206:209], v[114:117]
    v_cvt_pk_f16_f32 v185, v124, v125
    v_pk_fma_f16 v139, v185, v185, v139
    v_mfma_f32_16x16x32_bf16 v[114:117], a[4:7], v[186:189], v[114:117]
    v_cvt_pk_f16_f32 v168, v126, v127
    v_pk_fma_f16 v139, v168, v168, v139
    v_mfma_f32_16x16x32_bf16 v[114:117], a[0:3], v[154:157], v[114:117]
    v_cvt_pk_f16_f32 v169, v128, v129
    v_pk_fma_f16 v139, v169, v169, v139
    v_mfma_f32_16x16x32_bf16 v[118:121], a[24:27], v[154:157], 0
    s_waitcnt lgkmcnt(0)
    v_xor_b32 v2, 65536, v2
    v_xor_b32 v3, 65536, v3
    v_mfma_f32_16x16x32_bf16 v[118:121], a[28:31], v[186:189], v[118:121]
    s_barrier
    v_cvt_pk_f16_f32 v130, v114, v115
    v_mfma_f32_16x16x32_bf16 v[118:121], a[32:35], v[206:209], v[118:121]
    s_nop 0
    v_pk_mul_f16 v138, v130, v130
    v_mfma_f32_16x16x32_bf16 v[118:121], a[36:39], v[190:193], v[118:121]
    s_nop 0
    v_xor_b32 v4, 65536, v4
    v_mfma_f32_16x16x32_bf16 v[118:121], a[40:43], v[226:229], v[118:121]
    s_nop 0
    v_mfma_f32_16x16x32_bf16 v[118:121], a[44:47], v[234:237], v[118:121]
    s_cbranch_scc1 L_loop_fast0
    s_branch L_final_fast
.p2align 6
L_loop_fast1:
    v_mfma_f32_16x16x32_bf16 v[126:129], a[68:71], v[234:237], 0
    s_add_u32 s12, s40, s27
    ds_read_b128 v[150:153], v2 offset:18432
    v_cvt_pk_f16_f32 v131, v116, v117
    v_mfma_f32_16x16x32_bf16 v[126:129], a[64:67], v[226:229], v[126:129]
    s_addc_u32 s13, s41, 0
    ds_read_b128 v[114:117], v2 offset:19456
    v_pk_fma_f16 v138, v131, v131, v138
    v_mfma_f32_16x16x32_bf16 v[126:129], a[60:63], v[190:193], v[126:129]
    s_sub_u32 s14, s36, s27
    ds_read_b128 v[202:205], v5 offset:32
    v_cvt_pk_f16_f32 v132, v118, v119
    v_mfma_f32_16x16x32_bf16 v[126:129], a[56:59], v[206:209], v[126:129]
    s_cmp_ge_u32 s18, 2
    ds_read2_b64 v[210:213], v5 offset0:6 offset1:9
    v_pk_fma_f16 v138, v132, v132, v138
    v_mfma_f32_16x16x32_bf16 v[126:129], a[52:55], v[186:189], v[126:129]
    s_cselect_b32 s14, s14, 0
    ds_read_b128 v[122:125], v5
    v_cvt_pk_f16_f32 v133, v120, v121
    v_mfma_f32_16x16x32_bf16 v[126:129], a[48:51], v[154:157], v[126:129]
    s_sub_u32 s82, s72, s71
    ds_read_b32 v146, v6 offset:192
    v_pk_fma_f16 v138, v133, v133, v138
    v_mfma_f32_16x16x32_bf16 v[118:121], v[154:157], a[144:147], 0
    s_mul_i32 s74, s82, 336
    v_add_u32 v5, s74, v5
    s_mul_i32 s75, s82, 272
    v_mfma_f32_16x16x32_bf16 v[118:121], v[186:189], a[148:151], v[118:121]
    s_mul_i32 s76, s82, 16
    v_cvt_pk_f16_f32 v166, v126, v127
    v_pk_fma_f16 v138, v166, v166, v138
    v_mfma_f32_16x16x32_bf16 v[118:121], v[206:209], a[152:155], v[118:121]
    s_waitcnt lgkmcnt(5)
    v_cvt_pk_f16_f32 v167, v128, v129
    v_pk_fma_f16 v138, v167, v167, v138
    v_mfma_f32_16x16x32_bf16 v[118:121], v[190:193], a[156:159], v[118:121]
    s_add_u32 s34, s18, 2
    s_add_u32 s8, s60, s23
    s_addc_u32 s9, s61, 0
    v_mfma_f32_16x16x32_bf16 v[118:121], v[226:229], a[160:163], v[118:121]
    s_waitcnt lgkmcnt(3)
    ds_read_b128 v[218:221], v0 offset:26624
    v_pk_mul_f16 v141, v182, v202
    v_mfma_f32_16x16x32_bf16 v[118:121], v[234:237], a[164:167], v[118:121]
    s_sub_u32 s10, s36, s23
    ds_read_b128 v[222:225], v1 offset:26624
    v_pk_fma_f16 v141, v183, v203, v141
    v_mfma_f32_16x16x32_bf16 v[126:129], v[32:35], v[150:153], 0
    s_waitcnt lgkmcnt(3)
    v_pk_fma_f16 v141, v184, v204, v141
    v_pk_fma_f16 v141, v185, v205, v141
    v_mfma_f32_16x16x32_bf16 v[126:129], v[32:35], v[114:117], v[126:129]
    s_waitcnt lgkmcnt(2)
    v_mov_b32_dpp v146, v23 quad_perm:[0,1,2,3] row_mask:0x7 bank_mask:0xf
    v_pk_fma_f16 v141, v168, v212, v141
    v_mfma_f32_16x16x32_bf16 v[150:153], v[234:237], a[188:191], 0
    s_cmp_le_u32 s34, s45
    ds_read_b128 v[230:233], v0 offset:26752
    v_pk_fma_f16 v141, v169, v213, v141
    v_mfma_f32_16x16x32_bf16 v[150:153], v[226:229], a[184:187], v[150:153]
    s_cselect_b32 s10, s10, 0
    ds_read_b128 v[246:249], v1 offset:26752
    v_pk_mul_f16 v140, v130, v122
    v_mfma_f32_16x16x32_bf16 v[150:153], v[190:193], a[180:183], v[150:153]
    s_add_u32 m0, s28, 0
    ds_read_b128 v[242:245], v0 offset:26880
    v_pk_fma_f16 v140, v131, v123, v140
    v_mfma_f32_16x16x32_bf16 v[150:153], v[206:209], a[176:179], v[150:153]
    s_mov_b32 s27, s26
    ds_read_b128 v[194:197], v1 offset:26880
    v_pk_fma_f16 v140, v132, v124, v140
    v_mfma_f32_16x16x32_bf16 v[150:153], v[186:189], a[172:175], v[150:153]
    s_waitcnt lgkmcnt(5)
    v_pk_fma_f16 v140, v133, v125, v140
    v_pk_fma_f16 v140, v166, v210, v140
    v_mfma_f32_16x16x32_bf16 v[150:153], v[154:157], a[168:171], v[150:153]
    s_mov_b32 s26, s25
    v_pk_fma_f16 v140, v167, v211, v140
    v_cvt_pk_bf16_f32 v114, v118, v119
    v_mfma_f32_16x16x32_bf16 v[198:201], v[154:157], a[192:195], 0
    s_mov_b32 s25, s24
    v_cvt_pk_bf16_f32 v115, v120, v121
    v_mul_f32 v116, 0x3baaaaab, v126
    v_mfma_f32_16x16x32_bf16 v[198:201], v[186:189], a[196:199], v[198:201]
    s_mov_b32 s24, s23
    v_cvt_pk_bf16_f32 v118, v150, v151
    v_cvt_pk_bf16_f32 v119, v152, v153
    v_mfma_f32_16x16x32_bf16 v[198:201], v[206:209], a[200:203], v[198:201]
    s_mov_b32 s71, s72
    v_rsq_f32 v116, v116
    v_mfma_f32_16x16x32_bf16 v[198:201], v[190:193], a[204:207], v[198:201]
    s_mov_b32 s72, s73
    v_mul_f32 v147, 0x3baaaaab, v127
    v_mul_f32 v117, 0x3baaaaab, v128
    v_mfma_f32_16x16x32_bf16 v[198:201], v[226:229], a[208:211], v[198:201]
    s_waitcnt lgkmcnt(1)
    v_rsq_f32 v147, v147
    v_mfma_f32_16x16x32_bf16 v[198:201], v[234:237], a[212:215], v[198:201]
    s_waitcnt lgkmcnt(0)
    v_rsq_f32 v117, v117
    v_mfma_f32_16x16x32_f16 v[186:189], v[40:43], v[138:141], 0
    v_mul_f32 v178, v116, v178
    v_mul_f32 v179, v116, v179
    v_mfma_f32_16x16x32_bf16 v[138:141], a[72:75], v[218:221], 0
    v_cvt_pk_bf16_f32 v126, v178, v179
    v_mul_f32 v180, v116, v180
    v_mfma_f32_16x16x32_bf16 v[138:141], a[76:79], v[222:225], v[138:141]
    v_cvt_pk_bf16_f32 v150, v198, v199
    v_cvt_pk_bf16_f32 v151, v200, v201
    v_mfma_f32_16x16x32_bf16 v[138:141], a[80:83], v[230:233], v[138:141]
    v_rsq_f32 v186, v186
    v_mfma_f32_16x16x32_bf16 v[138:141], a[84:87], v[246:249], v[138:141]
    v_rsq_f32 v187, v187
    v_mfma_f32_16x16x32_bf16 v[138:141], a[88:91], v[242:245], v[138:141]
    v_mul_f32 v120, s31, v186
    v_cvt_pk_f16_f32 v121, v120, v187
    v_mfma_f32_16x16x32_bf16 v[138:141], a[92:95], v[194:197], v[138:141]
    v_mul_f32 v181, v116, v181
    v_cvt_pk_bf16_f32 v127, v180, v181
    v_mfma_f32_16x16x32_bf16 v[154:157], a[116:119], v[194:197], 0
    v_mul_f32 v142, v116, v142
    v_mul_f32 v143, v116, v143
    v_mfma_f32_16x16x32_bf16 v[154:157], a[112:115], v[242:245], v[154:157]
    v_cvt_pk_bf16_f32 v128, v142, v143
    v_mul_f32 v144, v116, v144
    v_mfma_f32_16x16x32_bf16 v[154:157], a[108:111], v[246:249], v[154:157]
    v_mul_f32 v145, v116, v145
    v_cvt_pk_bf16_f32 v129, v144, v145
    v_mfma_f32_16x16x32_bf16 v[154:157], a[104:107], v[230:233], v[154:157]
    v_mul_f32 v134, v116, v134
    v_mul_f32 v135, v116, v135
    v_mfma_f32_16x16x32_bf16 v[154:157], a[100:103], v[222:225], v[154:157]
    v_cvt_pk_bf16_f32 v148, v134, v135
    v_mul_f32 v136, v116, v136
    v_mfma_f32_16x16x32_bf16 v[154:157], a[96:99], v[218:221], v[154:157]
    buffer_store_dwordx4 v[126:129], v15, s[12:15], 0 offen nt
    v_mul_f32 v137, v116, v137
    v_cvt_pk_bf16_f32 v149, v136, v137
    v_fma_f32 v188, v188, v120, v22
    v_fmac_f32_dpp v146, v189, v187 quad_perm:[0,1,2,3] row_mask:0x1 bank_mask:0xf
    v_mfma_f32_16x16x32_bf16 v[126:129], a[120:123], v[218:221], 0
    v_pk_mul_f16 v182, v182, v121 op_sel:[0,1] op_sel_hi:[1,1]
    v_pk_mul_f16 v183, v183, v121 op_sel:[0,1] op_sel_hi:[1,1]
    v_mfma_f32_16x16x32_bf16 v[126:129], a[124:127], v[222:225], v[126:129]
    v_pk_mul_f16 v184, v184, v121 op_sel:[0,1] op_sel_hi:[1,1]
    v_pk_mul_f16 v185, v185, v121 op_sel:[0,1] op_sel_hi:[1,1]
    v_mfma_f32_16x16x32_bf16 v[126:129], a[128:131], v[230:233], v[126:129]
    v_pk_mul_f16 v168, v168, v121 op_sel:[0,1] op_sel_hi:[1,1]
    v_pk_mul_f16 v169, v169, v121 op_sel:[0,1] op_sel_hi:[1,1]
    v_mfma_f32_16x16x32_bf16 v[126:129], a[132:135], v[246:249], v[126:129]
    v_pk_mul_f16 v130, v130, v121 op_sel:[0,0] op_sel_hi:[1,0]
    v_pk_mul_f16 v131, v131, v121 op_sel:[0,0] op_sel_hi:[1,0]
    v_mfma_f32_16x16x32_bf16 v[126:129], a[136:139], v[242:245], v[126:129]
    v_pk_mul_f16 v132, v132, v121 op_sel:[0,0] op_sel_hi:[1,0]
    v_pk_mul_f16 v133, v133, v121 op_sel:[0,0] op_sel_hi:[1,0]
    v_mfma_f32_16x16x32_bf16 v[126:129], a[140:143], v[194:197], v[126:129]
    v_pk_mul_f16 v166, v166, v121 op_sel:[0,0] op_sel_hi:[1,0]
    v_pk_mul_f16 v167, v167, v121 op_sel:[0,0] op_sel_hi:[1,0]
    v_mfma_f32_16x16x32_bf16 v[134:137], a[20:23], v[194:197], 0
    v_max3_u32 v44, v44, v186, v187
    v_mul_f32 v170, v117, v170
    v_mfma_f32_16x16x32_bf16 v[134:137], a[16:19], v[242:245], v[134:137]
    v_mul_f32 v171, v117, v171
    v_cvt_pk_bf16_f32 v226, v170, v171
    v_mfma_f32_16x16x32_bf16 v[134:137], a[12:15], v[246:249], v[134:137]
    v_mul_f32 v172, v117, v172
    v_mul_f32 v173, v117, v173
    v_mfma_f32_16x16x32_bf16 v[134:137], a[8:11], v[230:233], v[134:137]
    v_cvt_pk_bf16_f32 v227, v172, v173
    v_mul_f32 v158, v117, v158
    v_mfma_f32_16x16x32_bf16 v[134:137], a[4:7], v[222:225], v[134:137]
    v_mul_f32 v159, v117, v159
    v_cvt_pk_bf16_f32 v228, v158, v159
    v_mfma_f32_16x16x32_bf16 v[134:137], a[0:3], v[218:221], v[134:137]
    v_mul_f32 v160, v117, v160
    v_mul_f32 v161, v117, v161
    v_mfma_f32_16x16x32_bf16 v[142:145], a[24:27], v[218:221], 0
    v_cvt_pk_bf16_f32 v229, v160, v161
    v_mul_f32 v238, v117, v238
    v_mfma_f32_16x16x32_bf16 v[142:145], a[28:31], v[222:225], v[142:145]
    v_mul_f32 v239, v117, v239
    v_cvt_pk_bf16_f32 v254, v238, v239
    v_mfma_f32_16x16x32_bf16 v[142:145], a[32:35], v[230:233], v[142:145]
    v_mul_f32 v240, v117, v240
    v_mul_f32 v241, v117, v241
    v_mfma_f32_16x16x32_bf16 v[142:145], a[36:39], v[246:249], v[142:145]
    v_cvt_pk_bf16_f32 v255, v240, v241
    v_cvt_pk_f16_f32 v190, v134, v135
    v_mfma_f32_16x16x32_bf16 v[142:145], a[40:43], v[242:245], v[142:145]
    v_pk_mul_f16 v158, v190, v190
    v_cvt_pk_f16_f32 v191, v136, v137
    v_mfma_f32_16x16x32_bf16 v[142:145], a[44:47], v[194:197], v[142:145]
    buffer_store_dwordx2 v[148:149], v18, s[12:15], 0 offen nt
    v_pk_fma_f16 v158, v191, v191, v158
    v_pk_mul_f16 v160, v190, v122
    v_mfma_f32_16x16x32_bf16 v[134:137], a[68:71], v[194:197], 0
    v_pk_fma_f16 v160, v191, v123, v160
    v_cvt_pk_f16_f32 v198, v138, v139
    v_mfma_f32_16x16x32_bf16 v[134:137], a[64:67], v[242:245], v[134:137]
    v_pk_mul_f16 v159, v198, v198
    v_cvt_pk_f16_f32 v192, v142, v143
    v_mfma_f32_16x16x32_bf16 v[134:137], a[60:63], v[246:249], v[134:137]
    v_pk_fma_f16 v158, v192, v192, v158
    v_cvt_pk_f16_f32 v193, v144, v145
    v_mfma_f32_16x16x32_bf16 v[134:137], a[56:59], v[230:233], v[134:137]
    v_pk_fma_f16 v158, v193, v193, v158
    v_pk_fma_f16 v160, v192, v124, v160
    v_mfma_f32_16x16x32_bf16 v[134:137], a[52:55], v[222:225], v[134:137]
    v_pk_fma_f16 v160, v193, v125, v160
    v_cvt_pk_f16_f32 v199, v140, v141
    v_mfma_f32_16x16x32_bf16 v[134:137], a[48:51], v[218:221], v[134:137]
    v_pk_fma_f16 v159, v199, v199, v159
    v_cvt_pk_f16_f32 v200, v154, v155
    v_mfma_f32_16x16x32_bf16 v[234:237], v[218:221], a[144:147], 0
    v_pk_fma_f16 v159, v200, v200, v159
    v_cvt_pk_f16_f32 v201, v156, v157
    v_mfma_f32_16x16x32_bf16 v[234:237], v[222:225], a[148:151], v[234:237]
    v_pk_fma_f16 v159, v201, v201, v159
    v_cvt_pk_f16_f32 v140, v126, v127
    v_mfma_f32_16x16x32_bf16 v[234:237], v[230:233], a[152:155], v[234:237]
    v_cvt_pk_f16_f32 v138, v134, v135
    v_pk_fma_f16 v158, v138, v138, v158
    v_mfma_f32_16x16x32_bf16 v[234:237], v[246:249], a[156:159], v[234:237]
    v_cvt_pk_f16_f32 v139, v136, v137
    v_pk_fma_f16 v158, v139, v139, v158
    v_mfma_f32_16x16x32_bf16 v[234:237], v[242:245], a[160:163], v[234:237]
    ds_read_b128 v[142:145], v0 offset:32768
    v_pk_fma_f16 v160, v138, v210, v160
    v_mfma_f32_16x16x32_bf16 v[234:237], v[194:197], a[164:167], v[234:237]
    ds_read_b128 v[178:181], v1 offset:32768
    v_pk_fma_f16 v160, v139, v211, v160
    v_mfma_f32_16x16x32_bf16 v[238:241], v[194:197], a[188:191], 0
    ds_read_b128 v[154:157], v0 offset:32896
    v_pk_fma_f16 v159, v140, v140, v159
    v_mfma_f32_16x16x32_bf16 v[238:241], v[242:245], a[184:187], v[238:241]
    ds_read_b128 v[170:173], v1 offset:32896
    v_cvt_pk_f16_f32 v141, v128, v129
    v_mfma_f32_16x16x32_bf16 v[238:241], v[246:249], a[180:183], v[238:241]
    ds_read_b128 v[206:209], v0 offset:33024
    v_cvt_pk_bf16_f32 v116, v234, v235
    v_mfma_f32_16x16x32_bf16 v[238:241], v[230:233], a[176:179], v[238:241]
    ds_read_b128 v[134:137], v1 offset:33024
    v_cvt_pk_bf16_f32 v117, v236, v237
    v_mfma_f32_16x16x32_bf16 v[238:241], v[222:225], a[172:175], v[238:241]
    v_pk_fma_f16 v159, v141, v141, v159
    v_pk_mul_f16 v161, v198, v202
    v_mfma_f32_16x16x32_bf16 v[238:241], v[218:221], a[168:171], v[238:241]
    buffer_store_dwordx4 v[226:229], v17, s[12:15], 0 offen nt
    v_pk_fma_f16 v161, v199, v203, v161
    v_pk_fma_f16 v161, v200, v204, v161
    v_pk_fma_f16 v161, v201, v205, v161
    v_pk_fma_f16 v161, v140, v212, v161
    v_mfma_f32_16x16x32_bf16 v[126:129], v[218:221], a[192:195], 0
    s_waitcnt lgkmcnt(4)
    v_pk_fma_f16 v161, v141, v213, v161
    v_cvt_pk_bf16_f32 v120, v238, v239
    v_mfma_f32_16x16x32_bf16 v[126:129], v[222:225], a[196:199], v[126:129]
    s_waitcnt lgkmcnt(3)
    v_cvt_pk_bf16_f32 v121, v240, v241
    v_mul_f32 v174, v147, v174
    v_mfma_f32_16x16x32_bf16 v[126:129], v[230:233], a[200:203], v[126:129]
    s_waitcnt lgkmcnt(2)
    v_exp_f32 v188, v188
    v_mfma_f32_16x16x32_bf16 v[126:129], v[246:249], a[204:207], v[126:129]
    s_waitcnt vmcnt(3)
    ds_write_b16 v8, v45 offset:512
    v_mfma_f32_16x16x32_bf16 v[126:129], v[242:245], a[208:211], v[126:129]
    s_waitcnt lgkmcnt(1)
    v_cvt_pk_bf16_f32 v39, v188, 0
    v_mfma_f32_16x16x32_bf16 v[126:129], v[194:197], a[212:215], v[126:129]
    v_mul_f32 v175, v147, v175
    v_cvt_pk_bf16_f32 v174, v174, v175
    v_mfma_f32_16x16x32_f16 v[186:189], v[40:43], v[158:161], 0
    v_mul_f32 v176, v147, v176
    v_mul_f32 v177, v147, v177
    v_mfma_f32_16x16x32_bf16 v[158:161], a[72:75], v[142:145], 0
    v_cvt_pk_bf16_f32 v175, v176, v177
    v_mul_f32 v162, v147, v162
    v_mfma_f32_16x16x32_bf16 v[158:161], a[76:79], v[178:181], v[158:161]
    v_cvt_pk_bf16_f32 v152, v126, v127
    v_cvt_pk_bf16_f32 v153, v128, v129
    v_mfma_f32_16x16x32_bf16 v[158:161], a[80:83], v[154:157], v[158:161]
    v_rsq_f32 v186, v186
    v_mfma_f32_16x16x32_bf16 v[158:161], a[84:87], v[170:173], v[158:161]
    v_rsq_f32 v187, v187
    v_mfma_f32_16x16x32_bf16 v[158:161], a[88:91], v[206:209], v[158:161]
    s_waitcnt lgkmcnt(0)
    v_mul_f32 v148, s31, v186
    v_cvt_pk_f16_f32 v149, v148, v187
    v_mfma_f32_16x16x32_bf16 v[158:161], a[92:95], v[134:137], v[158:161]
    v_fma_f32 v188, v188, v148, v24
    v_mfma_f32_16x16x32_bf16 v[126:129], a[116:119], v[134:137], 0
    s_barrier
    v_fmac_f32_dpp v146, v189, v187 quad_perm:[0,1,2,3] row_mask:0x2 bank_mask:0xf
    v_mfma_f32_16x16x32_bf16 v[126:129], a[112:115], v[206:209], v[126:129]
    v_pk_mul_f16 v198, v198, v149 op_sel:[0,1] op_sel_hi:[1,1]
    v_mfma_f32_16x16x32_bf16 v[126:129], a[108:111], v[170:173], v[126:129]
    buffer_load_dwordx4 v10, s[8:11], 0 offen nt lds
    v_mfma_f32_16x16x32_bf16 v[126:129], a[104:107], v[154:157], v[126:129]
    s_add_u32 m0, s28, 4096
    ds_read_u16 v148, v9 offset:384
    v_pk_mul_f16 v199, v199, v149 op_sel:[0,1] op_sel_hi:[1,1]
    v_mfma_f32_16x16x32_bf16 v[126:129], a[100:103], v[178:181], v[126:129]
    v_pk_mul_f16 v200, v200, v149 op_sel:[0,1] op_sel_hi:[1,1]
    v_pk_mul_f16 v201, v201, v149 op_sel:[0,1] op_sel_hi:[1,1]
    v_mfma_f32_16x16x32_bf16 v[126:129], a[96:99], v[142:145], v[126:129]
    v_pk_mul_f16 v140, v140, v149 op_sel:[0,1] op_sel_hi:[1,1]
    v_pk_mul_f16 v141, v141, v149 op_sel:[0,1] op_sel_hi:[1,1]
    v_mfma_f32_16x16x32_bf16 v[194:197], a[120:123], v[142:145], 0
    v_pk_mul_f16 v190, v190, v149 op_sel:[0,0] op_sel_hi:[1,0]
    v_pk_mul_f16 v191, v191, v149 op_sel:[0,0] op_sel_hi:[1,0]
    v_mfma_f32_16x16x32_bf16 v[194:197], a[124:127], v[178:181], v[194:197]
    buffer_load_dwordx4 v11, s[8:11], 0 offen nt lds
    v_pk_mul_f16 v192, v192, v149 op_sel:[0,0] op_sel_hi:[1,0]
    v_mfma_f32_16x16x32_bf16 v[194:197], a[128:131], v[154:157], v[194:197]
    s_add_u32 m0, s28, 8192
    v_pk_mul_f16 v193, v193, v149 op_sel:[0,0] op_sel_hi:[1,0]
    v_pk_mul_f16 v138, v138, v149 op_sel:[0,0] op_sel_hi:[1,0]
    v_mfma_f32_16x16x32_bf16 v[194:197], a[132:135], v[170:173], v[194:197]
    v_pk_mul_f16 v139, v139, v149 op_sel:[0,0] op_sel_hi:[1,0]
    v_max3_u32 v44, v44, v186, v187
    v_mfma_f32_16x16x32_bf16 v[194:197], a[136:139], v[206:209], v[194:197]
    v_cvt_pk_f16_f32 v218, v158, v159
    v_pk_mul_f16 v159, v218, v218
    v_mfma_f32_16x16x32_bf16 v[194:197], a[140:143], v[134:137], v[194:197]
    s_waitcnt lgkmcnt(0)
    v_readfirstlane_b32 s77, v148
    v_cvt_pk_f16_f32 v219, v160, v161
    v_mfma_f32_16x16x32_bf16 v[222:225], a[20:23], v[134:137], 0
    buffer_load_dwordx4 v12, s[8:11], 0 offen nt lds
    v_pk_fma_f16 v159, v219, v219, v159
    v_mfma_f32_16x16x32_bf16 v[222:225], a[16:19], v[206:209], v[222:225]
    s_add_u32 m0, s28, 12288
    v_cvt_pk_f16_f32 v220, v126, v127
    v_pk_fma_f16 v159, v220, v220, v159
    v_mfma_f32_16x16x32_bf16 v[222:225], a[12:15], v[170:173], v[222:225]
    s_xor_b32 s28, s28, 65536
    v_cvt_pk_f16_f32 v221, v128, v129
    v_pk_fma_f16 v159, v221, v221, v159
    v_mfma_f32_16x16x32_bf16 v[222:225], a[8:11], v[154:157], v[222:225]
    s_mul_i32 s78, s77, 2688
    v_cvt_pk_f16_f32 v128, v194, v195
    v_pk_fma_f16 v159, v128, v128, v159
    v_mfma_f32_16x16x32_bf16 v[222:225], a[4:7], v[178:181], v[222:225]
    v_cvt_pk_f16_f32 v129, v196, v197
    v_pk_fma_f16 v159, v129, v129, v159
    v_mfma_f32_16x16x32_bf16 v[222:225], a[0:3], v[142:145], v[222:225]
    buffer_load_dwordx4 v13, s[8:11], 0 offen nt lds
    v_pk_mul_f16 v161, v218, v202
    v_mfma_f32_16x16x32_bf16 v[194:197], a[24:27], v[142:145], 0
    s_mov_b32 m0, s29
    v_pk_fma_f16 v161, v219, v203, v161
    v_pk_fma_f16 v161, v220, v204, v161
    v_mfma_f32_16x16x32_bf16 v[194:197], a[28:31], v[178:181], v[194:197]
    s_xor_b32 s29, s29, s30
    v_cvt_pk_f16_f32 v202, v222, v223
    v_pk_mul_f16 v158, v202, v202
    v_mfma_f32_16x16x32_bf16 v[194:197], a[32:35], v[154:157], v[194:197]
    s_add_u32 s19, s19, s20
    ds_read2_b32 v[228:229], v6 offset0:0 offset1:0
    v_cvt_pk_f16_f32 v203, v224, v225
    v_mfma_f32_16x16x32_bf16 v[194:197], a[36:39], v[170:173], v[194:197]
    s_add_u32 s23, s23, s21
    ds_read2_b32 v[224:225], v6 offset0:16 offset1:16
    v_pk_fma_f16 v158, v203, v203, v158
    v_mfma_f32_16x16x32_bf16 v[194:197], a[40:43], v[206:209], v[194:197]
    buffer_load_dwordx4 v14, s[8:11], 0 offen nt lds
    ds_read2_b32 v[232:233], v6 offset0:32 offset1:32
    v_mfma_f32_16x16x32_bf16 v[194:197], a[44:47], v[134:137], v[194:197]
    s_cmp_ge_u32 s19, 72
    v_pk_mul_f16 v160, v202, v122
    v_pk_fma_f16 v160, v203, v123, v160
    v_mfma_f32_16x16x32_bf16 v[234:237], a[68:71], v[134:137], 0
    s_cselect_b32 s34, 72, 0
    v_pk_fma_f16 v161, v221, v205, v161
    v_pk_fma_f16 v161, v128, v212, v161
    v_mfma_f32_16x16x32_bf16 v[234:237], a[64:67], v[206:209], v[234:237]
    s_cselect_b32 s35, s22, 0
    v_cvt_pk_f16_f32 v204, v194, v195
    v_pk_fma_f16 v158, v204, v204, v158
    v_mfma_f32_16x16x32_bf16 v[234:237], a[60:63], v[170:173], v[234:237]
    s_sub_u32 s19, s19, s34
    v_cvt_pk_f16_f32 v205, v196, v197
    v_pk_fma_f16 v158, v205, v205, v158
    v_mfma_f32_16x16x32_bf16 v[234:237], a[56:59], v[154:157], v[234:237]
    s_add_u32 s23, s23, s35
    v_pk_fma_f16 v160, v204, v124, v160
    v_pk_fma_f16 v160, v205, v125, v160
    v_mfma_f32_16x16x32_bf16 v[234:237], a[52:55], v[178:181], v[234:237]
    s_add_u32 s78, s78, s69
    v_pk_fma_f16 v161, v129, v213, v161
    v_mul_f32 v163, v147, v163
    v_mfma_f32_16x16x32_bf16 v[234:237], a[48:51], v[142:145], v[234:237]
    s_waitcnt lgkmcnt(1)
    buffer_store_dwordx2 v[254:255], v20, s[12:15], 0 offen nt
    v_exp_f32 v188, v188
    v_mfma_f32_16x16x32_bf16 v[122:125], v[142:145], a[144:147], 0
    s_add_u32 s80, s77, s68
    v_cvt_pk_bf16_f32 v176, v162, v163
    v_mul_f32 v164, v147, v164
    v_mfma_f32_16x16x32_bf16 v[122:125], v[178:181], a[148:151], v[122:125]
    s_cmp_ge_u32 s80, 72
    v_cvt_pk_f16_f32 v126, v234, v235
    v_pk_fma_f16 v158, v126, v126, v158
    v_mfma_f32_16x16x32_bf16 v[122:125], v[154:157], a[152:155], v[122:125]
    s_cselect_b32 s80, s22, 0
    v_cvt_pk_f16_f32 v127, v236, v237
    v_pk_fma_f16 v158, v127, v127, v158
    v_mfma_f32_16x16x32_bf16 v[122:125], v[170:173], a[156:159], v[122:125]
    s_add_u32 s78, s78, s80
    v_pk_fma_f16 v160, v126, v210, v160
    v_pk_fma_f16 v160, v127, v211, v160
    v_mfma_f32_16x16x32_bf16 v[122:125], v[206:209], a[160:163], v[122:125]
    s_add_u32 s80, s77, 20
    v_mul_f32 v165, v147, v165
    v_cvt_pk_bf16_f32 v177, v164, v165
    v_mfma_f32_16x16x32_bf16 v[122:125], v[134:137], a[164:167], v[122:125]
    s_add_u32 s34, s18, 3
    ds_read_b128 v[194:197], v2 offset:0
    v_mul_f32 v214, v147, v214
    v_mfma_f32_16x16x32_f16 v[162:165], v[40:43], v[158:161], 0
    s_cmp_lt_u32 s77, s62
    v_mul_f32 v215, v147, v215
    v_cvt_pk_bf16_f32 v254, v214, v215
    v_mfma_f32_16x16x32_bf16 v[210:213], v[134:137], a[188:191], 0
    s_cselect_b32 s79, 1, 0
    ds_read_b128 v[158:161], v2 offset:1024
    v_cvt_pk_bf16_f32 v226, v122, v123
    v_mfma_f32_16x16x32_bf16 v[210:213], v[206:209], a[184:187], v[210:213]
    s_cselect_b32 s78, s78, 0
    ds_read_b128 v[234:237], v2 offset:2048
    v_cvt_pk_bf16_f32 v227, v124, v125
    v_mfma_f32_16x16x32_bf16 v[210:213], v[170:173], a[180:183], v[210:213]
    s_cmp_lt_u32 s34, s17
    ds_read_b128 v[122:125], v2 offset:3072
    v_mul_f32 v216, v147, v216
    v_mfma_f32_16x16x32_bf16 v[210:213], v[154:157], a[176:179], v[210:213]
    s_cselect_b32 s23, s23, s78
    ds_read_b128 v[238:241], v2 offset:4096
    v_mul_f32 v217, v147, v217
    v_mfma_f32_16x16x32_bf16 v[210:213], v[178:181], a[172:175], v[210:213]
    s_cselect_b32 s73, s34, s80
    ds_read_b128 v[242:245], v2 offset:5120
    v_cvt_pk_bf16_f32 v255, v216, v217
    v_mfma_f32_16x16x32_bf16 v[210:213], v[142:145], a[168:171], v[210:213]
    s_cselect_b32 s79, 0, s79
    v_rsq_f32 v162, v162
    v_mfma_f32_16x16x32_bf16 v[214:217], v[142:145], a[192:195], 0
    s_waitcnt lgkmcnt(5)
    v_rsq_f32 v163, v163
    v_mfma_f32_16x16x32_bf16 v[214:217], v[178:181], a[196:199], v[214:217]
    s_cselect_b32 s81, 0, 1
    v_mul_f32 v148, s31, v162
    v_cvt_pk_f16_f32 v149, v148, v163
    v_mfma_f32_16x16x32_bf16 v[214:217], v[154:157], a[200:203], v[214:217]
    s_add_u32 s80, s77, 1
    v_fma_f32 v164, v164, v148, v26
    v_fmac_f32_dpp v146, v165, v163 quad_perm:[0,1,2,3] row_mask:0x4 bank_mask:0xf
    v_mfma_f32_16x16x32_bf16 v[214:217], v[170:173], a[204:207], v[214:217]
    s_mul_i32 s80, s80, s81
    v_cvt_pk_bf16_f32 v222, v210, v211
    v_cvt_pk_bf16_f32 v223, v212, v213
    v_mfma_f32_16x16x32_bf16 v[214:217], v[206:209], a[208:211], v[214:217]
    s_cmp_lt_u32 s80, s62
    v_pk_mul_f16 v218, v218, v149 op_sel:[0,1] op_sel_hi:[1,1]
    v_pk_mul_f16 v219, v219, v149 op_sel:[0,1] op_sel_hi:[1,1]
    v_mfma_f32_16x16x32_bf16 v[214:217], v[134:137], a[212:215], v[214:217]
    s_waitcnt lgkmcnt(1)
    buffer_store_dwordx4 v[174:177], v16, s[12:15], 0 offen nt
    v_pk_mul_f16 v220, v220, v149 op_sel:[0,1] op_sel_hi:[1,1]
    v_pk_mul_f16 v221, v221, v149 op_sel:[0,1] op_sel_hi:[1,1]
    v_pk_mul_f16 v128, v128, v149 op_sel:[0,1] op_sel_hi:[1,1]
    v_pk_mul_f16 v129, v129, v149 op_sel:[0,1] op_sel_hi:[1,1]
    v_mfma_f32_16x16x32_f16 v[134:137], v[182:185], v[130:133], v[46:49]
    s_waitcnt lgkmcnt(0)
    v_cvt_pk_bf16_f32 v230, v214, v215
    v_cvt_pk_bf16_f32 v231, v216, v217
    v_mfma_f32_16x16x32_f16 v[142:145], v[198:201], v[130:133], v[50:53]
    s_cselect_b32 s62, s62, 0
    v_pk_mul_f16 v202, v202, v149 op_sel:[0,0] op_sel_hi:[1,0]
    v_pk_mul_f16 v203, v203, v149 op_sel:[0,0] op_sel_hi:[1,0]
    v_mfma_f32_16x16x32_f16 v[154:157], v[218:221], v[130:133], v[54:57]
    s_add_u32 s80, s18, 4
    v_pk_mul_f16 v204, v204, v149 op_sel:[0,0] op_sel_hi:[1,0]
    v_pk_mul_f16 v205, v205, v149 op_sel:[0,0] op_sel_hi:[1,0]
    v_pk_mul_f16 v126, v126, v149 op_sel:[0,0] op_sel_hi:[1,0]
    v_mfma_f32_16x16x16_f16 v[134:137], v[168:169], v[166:167], v[134:137]
    v_pk_mul_f16 v127, v127, v149 op_sel:[0,0] op_sel_hi:[1,0]
    v_max3_u32 v44, v44, v162, v163
    v_add_u32 v6, s75, v6
    v_mfma_f32_16x16x16_f16 v[142:145], v[140:141], v[166:167], v[142:145]
    v_exp_f32 v146, v146
    v_xor_b32 v0, 65536, v0
    v_mfma_f32_16x16x16_f16 v[154:157], v[128:129], v[166:167], v[154:157]
    v_cvt_pk_bf16_f32 v146, v146, v146
    v_exp_f32 v134, v134
    v_xor_b32 v1, 65536, v1
    v_mfma_f32_16x16x32_f16 v[130:133], v[182:185], v[190:193], v[58:61]
    s_cmp_ge_u32 s80, s17
    ds_write_b16 v8, v146
    v_mfma_f32_16x16x32_f16 v[146:149], v[198:201], v[190:193], v[62:65]
    s_cselect_b32 s66, s62, 0
    v_exp_f32 v135, v135
    v_mfma_f32_16x16x32_f16 v[170:173], v[218:221], v[190:193], v[66:69]
    s_lshl_b32 s80, s79, s73
    v_cvt_pk_bf16_f32 v134, v134, v135
    v_exp_f32 v136, v136
    v_mfma_f32_16x16x16_f16 v[130:133], v[168:169], v[138:139], v[130:133]
    v_exp_f32 v137, v137
    s_or_b32 s70, s70, s80
    v_mfma_f32_16x16x16_f16 v[146:149], v[140:141], v[138:139], v[146:149]
    v_cvt_pk_bf16_f32 v135, v136, v137
    v_exp_f32 v142, v142
    v_mfma_f32_16x16x16_f16 v[170:173], v[128:129], v[138:139], v[170:173]
    v_exp_f32 v143, v143
    v_exp_f32 v144, v144
    v_mfma_f32_16x16x32_bf16 v[178:181], a[216:219], v[194:197], 0
    s_add_u32 s45, s45, s79
    v_exp_f32 v145, v145
    v_mfma_f32_16x16x32_bf16 v[178:181], a[220:223], v[158:161], v[178:181]
    s_add_u32 s18, s18, 1
    v_cvt_pk_bf16_f32 v136, v142, v143
    v_cvt_pk_bf16_f32 v137, v144, v145
    v_mfma_f32_16x16x32_bf16 v[178:181], a[224:227], v[234:237], v[178:181]
    s_cmp_lt_u32 s18, s45
    v_exp_f32 v154, v154
    v_mfma_f32_16x16x32_bf16 v[178:181], a[228:231], v[122:125], v[178:181]
    v_mfma_f32_16x16x32_bf16 v[178:181], a[232:235], v[238:241], v[178:181]
    v_exp_f32 v155, v155
    v_mfma_f32_16x16x32_bf16 v[178:181], a[236:239], v[242:245], v[178:181]
    buffer_store_dwordx2 v[254:255], v19, s[12:15], 0 offen nt
    v_exp_f32 v156, v156
    v_mfma_f32_16x16x32_bf16 v[142:145], v[86:89], v[242:245], 0
    v_exp_f32 v157, v157
    v_mfma_f32_16x16x32_bf16 v[142:145], v[82:85], v[238:241], v[142:145]
    v_cvt_pk_bf16_f32 v36, v154, v155
    v_cvt_pk_bf16_f32 v37, v156, v157
    v_mfma_f32_16x16x32_bf16 v[142:145], a[252:255], v[122:125], v[142:145]
    v_exp_f32 v164, v164
    v_mfma_f32_16x16x32_bf16 v[142:145], a[248:251], v[234:237], v[142:145]
    ds_read_b128 v[154:157], v2 offset:11264
    v_fma_f32 v254, v178, v178, s33
    v_mfma_f32_16x16x32_bf16 v[142:145], a[244:247], v[158:161], v[142:145]
    ds_read_b128 v[206:209], v2 offset:10240
    v_fmac_f32 v254, v179, v179
    v_mfma_f32_16x16x32_bf16 v[142:145], a[240:243], v[194:197], v[142:145]
    ds_read_b128 v[210:213], v2 offset:9216
    v_fmac_f32 v254, v180, v180
    v_mfma_f32_16x16x32_bf16 v[190:193], v[28:31], v[36:39], 0
    v_exp_f32 v130, v130
    v_mfma_f32_16x16x32_bf16 v[190:193], v[28:31], v[134:137], v[190:193]
    v_exp_f32 v131, v131
    v_mfma_f32_16x16x32_bf16 v[174:177], v[114:117], v[134:137], 0
    v_cvt_pk_bf16_f32 v130, v130, v131
    v_fmac_f32 v254, v181, v181
    v_mfma_f32_16x16x32_bf16 v[174:177], v[226:229], v[36:39], v[174:177]
    v_exp_f32 v132, v132
    v_mfma_f32_16x16x32_bf16 v[246:249], v[222:225], v[36:39], 0
    v_exp_f32 v133, v133
    v_mfma_f32_16x16x32_bf16 v[246:249], v[118:121], v[134:137], v[246:249]
    s_waitcnt lgkmcnt(2)
    v_cvt_pk_bf16_f32 v131, v132, v133
    v_fmac_f32 v254, v142, v142
    v_mfma_f32_16x16x32_bf16 v[250:253], v[150:153], v[134:137], 0
    s_waitcnt lgkmcnt(1)
    v_exp_f32 v146, v146
    v_mfma_f32_16x16x32_bf16 v[250:253], v[230:233], v[36:39], v[250:253]
    s_waitcnt lgkmcnt(0)
    v_exp_f32 v147, v147
    v_mfma_f32_16x16x32_bf16 v[134:137], v[90:93], v[194:197], 0
    ds_read_b128 v[194:197], v2 offset:8192
    v_cvt_pk_bf16_f32 v132, v146, v147
    v_mfma_f32_16x16x32_bf16 v[134:137], v[94:97], v[158:161], v[134:137]
    ds_read_b128 v[158:161], v2 offset:7168
    v_cvt_pk_bf16_f32 v39, v188, 0
    v_mfma_f32_16x16x32_bf16 v[134:137], v[98:101], v[234:237], v[134:137]
    ds_read_b128 v[186:189], v2 offset:6144
    v_fmac_f32 v254, v143, v143
    v_mfma_f32_16x16x32_bf16 v[134:137], v[102:105], v[122:125], v[134:137]
    v_exp_f32 v148, v148
    v_mfma_f32_16x16x32_bf16 v[134:137], v[106:109], v[238:241], v[134:137]
    v_exp_f32 v149, v149
    v_mfma_f32_16x16x32_bf16 v[134:137], v[110:113], v[242:245], v[134:137]
    v_cvt_pk_bf16_f32 v133, v148, v149
    v_fmac_f32 v254, v144, v144
    v_mfma_f32_16x16x32_f16 v[214:217], v[182:185], v[202:205], v[70:73]
    v_exp_f32 v170, v170
    v_mfma_f32_16x16x32_f16 v[146:149], v[198:201], v[202:205], v[74:77]
    v_exp_f32 v171, v171
    v_mfma_f32_16x16x32_f16 v[122:125], v[218:221], v[202:205], v[78:81]
    s_waitcnt lgkmcnt(2)
    v_cvt_pk_bf16_f32 v36, v170, v171
    v_exp_f32 v172, v172
    v_mfma_f32_16x16x16_f16 v[214:217], v[168:169], v[126:127], v[214:217]
    v_exp_f32 v173, v173
    v_fmac_f32 v254, v145, v145
    v_mfma_f32_16x16x16_f16 v[146:149], v[140:141], v[126:127], v[146:149]
    v_cvt_pk_bf16_f32 v37, v172, v173
    v_rcp_f32 v191, v190
    v_mfma_f32_16x16x16_f16 v[122:125], v[128:129], v[126:127], v[122:125]
    v_max3_u32 v25, v25, v191, v190
    v_mul_f32 v174, v191, v174
    v_exp_f32 v214, v214
    v_mfma_f32_16x16x32_bf16 v[126:129], v[28:31], v[36:39], 0
    s_waitcnt lgkmcnt(0)
    v_exp_f32 v215, v215
    v_mfma_f32_16x16x32_bf16 v[126:129], v[28:31], v[130:133], v[126:129]
    v_cvt_pk_bf16_f32 v170, v214, v215
    v_mul_f32 v175, v191, v175
    v_mfma_f32_16x16x32_bf16 v[138:141], v[114:117], v[130:133], 0
    v_exp_f32 v216, v216
    v_mfma_f32_16x16x32_bf16 v[138:141], v[226:229], v[36:39], v[138:141]
    ds_read_b128 v[166:169], v9
    v_cvt_pk_bf16_f32 v202, v174, v175
    v_mfma_f32_16x16x32_bf16 v[198:201], v[222:225], v[36:39], 0
    ds_read_b128 v[182:185], v9 offset:64
    v_mul_f32 v176, v191, v176
    v_mfma_f32_16x16x32_bf16 v[198:201], v[118:121], v[130:133], v[198:201]
    v_exp_f32 v217, v217
    v_mfma_f32_16x16x32_bf16 v[218:221], v[150:153], v[130:133], 0
    v_cvt_pk_bf16_f32 v171, v216, v217
    v_mul_f32 v177, v191, v177
    v_mfma_f32_16x16x32_bf16 v[218:221], v[230:233], v[36:39], v[218:221]
    v_exp_f32 v146, v146
    v_mfma_f32_16x16x32_bf16 v[214:217], v[110:113], v[154:157], 0
    v_exp_f32 v147, v147
    v_mfma_f32_16x16x32_bf16 v[214:217], v[106:109], v[206:209], v[214:217]
    v_cvt_pk_bf16_f32 v172, v146, v147
    v_cvt_pk_bf16_f32 v39, v164, 0
    v_mfma_f32_16x16x32_bf16 v[214:217], v[102:105], v[210:213], v[214:217]
    v_exp_f32 v148, v148
    v_mfma_f32_16x16x32_bf16 v[214:217], v[98:101], v[194:197], v[214:217]
    s_waitcnt lgkmcnt(1)
    v_exp_f32 v149, v149
    v_mfma_f32_16x16x32_bf16 v[214:217], v[94:97], v[158:161], v[214:217]
    s_waitcnt lgkmcnt(0)
    v_cvt_pk_bf16_f32 v173, v148, v149
    v_cvt_pk_bf16_f32 v203, v176, v177
    v_mfma_f32_16x16x32_bf16 v[214:217], v[90:93], v[186:189], v[214:217]
    v_exp_f32 v122, v122
    v_mfma_f32_16x16x32_bf16 v[162:165], a[240:243], v[186:189], 0
    v_exp_f32 v123, v123
    v_mfma_f32_16x16x32_bf16 v[162:165], a[244:247], v[158:161], v[162:165]
    v_cvt_pk_bf16_f32 v36, v122, v123
    v_mul_f32 v246, v191, v246
    v_mfma_f32_16x16x32_bf16 v[162:165], a[248:251], v[194:197], v[162:165]
    v_exp_f32 v124, v124
    v_mfma_f32_16x16x32_bf16 v[162:165], a[252:255], v[210:213], v[162:165]
    ds_read_b128 v[130:133], v2 offset:12288
    v_fma_f32 v255, v214, v214, s33
    v_mfma_f32_16x16x32_bf16 v[162:165], v[82:85], v[206:209], v[162:165]
    ds_read_b128 v[146:149], v2 offset:13312
    v_fmac_f32 v255, v215, v215
    v_mfma_f32_16x16x32_bf16 v[162:165], v[86:89], v[154:157], v[162:165]
    ds_read_b128 v[234:237], v2 offset:14336
    v_fmac_f32 v255, v216, v216
    v_mfma_f32_16x16x32_bf16 v[174:177], a[236:239], v[154:157], 0
    ds_read_b128 v[154:157], v2 offset:15360
    v_fmac_f32 v255, v217, v217
    v_mfma_f32_16x16x32_bf16 v[174:177], a[232:235], v[206:209], v[174:177]
    ds_read_b128 v[206:209], v2 offset:16384
    v_mul_f32 v247, v191, v247
    v_mfma_f32_16x16x32_bf16 v[174:177], a[228:231], v[210:213], v[174:177]
    ds_read_b128 v[210:213], v2 offset:17408
    v_fmac_f32 v255, v162, v162
    v_mfma_f32_16x16x32_bf16 v[174:177], a[224:227], v[194:197], v[174:177]
    v_exp_f32 v125, v125
    v_mfma_f32_16x16x32_bf16 v[174:177], a[220:223], v[158:161], v[174:177]
    v_cvt_pk_bf16_f32 v37, v124, v125
    v_fmac_f32 v255, v163, v163
    v_mfma_f32_16x16x32_bf16 v[174:177], a[216:219], v[186:189], v[174:177]
    s_waitcnt lgkmcnt(5)
    v_fmac_f32 v255, v164, v164
    v_fmac_f32 v255, v165, v165
    v_mfma_f32_16x16x32_bf16 v[122:125], v[28:31], v[36:39], 0
    s_waitcnt lgkmcnt(4)
    v_cvt_pk_bf16_f32 v204, v246, v247
    v_mul_f32 v248, v191, v248
    v_mfma_f32_16x16x32_bf16 v[122:125], v[28:31], v[170:173], v[122:125]
    s_waitcnt lgkmcnt(3)
    v_fmac_f32 v255, v174, v174
    v_fmac_f32 v255, v175, v175
    v_mfma_f32_16x16x32_bf16 v[158:161], v[114:117], v[170:173], 0
    s_waitcnt lgkmcnt(2)
    v_fmac_f32 v255, v176, v176
    v_fmac_f32 v255, v177, v177
    v_mfma_f32_16x16x32_bf16 v[158:161], v[226:229], v[36:39], v[158:161]
    s_waitcnt lgkmcnt(1)
    v_rcp_f32 v123, v122
    v_mfma_f32_16x16x32_bf16 v[186:189], v[222:225], v[36:39], 0
    s_waitcnt lgkmcnt(0)
    v_mul_f32 v249, v191, v249
    v_cvt_pk_bf16_f32 v205, v248, v249
    v_mfma_f32_16x16x32_bf16 v[186:189], v[118:121], v[170:173], v[186:189]
    ds_write_b128 v3, v[202:205] offset:0
    v_mfma_f32_16x16x32_bf16 v[194:197], v[150:153], v[170:173], 0
    v_mul_f32 v158, v123, v158
    v_mul_f32 v159, v123, v159
    v_mfma_f32_16x16x32_bf16 v[194:197], v[230:233], v[36:39], v[194:197]
    v_cvt_pk_bf16_f32 v158, v158, v159
    v_mul_f32 v160, v123, v160
    v_mfma_f32_16x16x32_bf16 v[170:173], a[216:219], v[130:133], 0
    v_mul_f32 v161, v123, v161
    v_cvt_pk_bf16_f32 v159, v160, v161
    v_mfma_f32_16x16x32_bf16 v[170:173], a[220:223], v[146:149], v[170:173]
    v_mul_f32 v186, v123, v186
    v_mul_f32 v187, v123, v187
    v_mfma_f32_16x16x32_bf16 v[170:173], a[224:227], v[234:237], v[170:173]
    v_cvt_pk_bf16_f32 v160, v186, v187
    v_mul_f32 v188, v123, v188
    v_mfma_f32_16x16x32_bf16 v[170:173], a[228:231], v[154:157], v[170:173]
    v_mul_f32 v189, v123, v189
    v_cvt_pk_bf16_f32 v161, v188, v189
    v_mfma_f32_16x16x32_bf16 v[170:173], a[232:235], v[206:209], v[170:173]
    v_mul_f32 v194, v123, v194
    v_mul_f32 v195, v123, v195
    v_mfma_f32_16x16x32_bf16 v[170:173], a[236:239], v[210:213], v[170:173]
    ds_write_b128 v3, v[158:161] offset:12288
    v_mfma_f32_16x16x32_bf16 v[158:161], v[86:89], v[210:213], 0
    v_cvt_pk_bf16_f32 v124, v194, v195
    v_mul_f32 v196, v123, v196
    v_mfma_f32_16x16x32_bf16 v[158:161], v[82:85], v[206:209], v[158:161]
    v_mul_f32 v197, v123, v197
    v_cvt_pk_bf16_f32 v125, v196, v197
    v_mfma_f32_16x16x32_bf16 v[158:161], a[252:255], v[154:157], v[158:161]
    v_fma_f32 v128, v170, v170, s33
    v_fmac_f32 v128, v171, v171
    v_mfma_f32_16x16x32_bf16 v[158:161], a[248:251], v[234:237], v[158:161]
    v_fmac_f32 v128, v172, v172
    v_fmac_f32 v128, v173, v173
    v_mfma_f32_16x16x32_bf16 v[158:161], a[244:247], v[146:149], v[158:161]
    v_mul_f32 v250, v191, v250
    v_mul_f32 v251, v191, v251
    v_mfma_f32_16x16x32_bf16 v[158:161], a[240:243], v[130:133], v[158:161]
    ds_write_b64 v4, v[124:125] offset:16384
    v_mfma_f32_16x16x32_bf16 v[238:241], v[90:93], v[130:133], 0
    v_cvt_pk_bf16_f32 v124, v250, v251
    v_mul_f32 v252, v191, v252
    v_mfma_f32_16x16x32_bf16 v[238:241], v[94:97], v[146:149], v[238:241]
    v_mul_f32 v253, v191, v253
    v_cvt_pk_bf16_f32 v125, v252, v253
    v_mfma_f32_16x16x32_bf16 v[238:241], v[98:101], v[234:237], v[238:241]
    v_fmac_f32 v128, v158, v158
    v_fmac_f32 v128, v159, v159
    v_mfma_f32_16x16x32_bf16 v[238:241], v[102:105], v[154:157], v[238:241]
    v_fmac_f32 v128, v160, v160
    v_fmac_f32 v128, v161, v161
    v_mfma_f32_16x16x32_bf16 v[238:241], v[106:109], v[206:209], v[238:241]
    v_rcp_f32 v127, v126
    v_mfma_f32_16x16x32_bf16 v[238:241], v[110:113], v[210:213], v[238:241]
    ds_read_b128 v[154:157], v0 offset:20480
    v_max3_u32 v25, v25, v127, v126
    v_mfma_f32_16x16x32_bf16 v[130:133], v[166:169], v[28:31], 0
    ds_read_b128 v[186:189], v1 offset:20480
    v_max3_u32 v25, v25, v123, v122
    v_mfma_f32_16x16x32_bf16 v[130:133], v[182:185], v[28:31], v[130:133]
    ds_read_b128 v[206:209], v0 offset:20608
    v_mul_f32 v138, v127, v138
    v_mfma_f32_16x16x32_bf16 v[146:149], v[182:185], v[226:229], 0
    ds_read_b128 v[190:193], v1 offset:20608
    v_fmac_f32 v128, v238, v238
    v_mfma_f32_16x16x32_bf16 v[146:149], v[166:169], v[114:117], v[146:149]
    ds_read_b128 v[226:229], v0 offset:20736
    v_fmac_f32 v128, v239, v239
    v_mfma_f32_16x16x32_bf16 v[114:117], v[166:169], v[118:121], 0
    ds_read_b128 v[234:237], v1 offset:20736
    v_fmac_f32 v128, v240, v240
    v_mfma_f32_16x16x32_bf16 v[114:117], v[182:185], v[222:225], v[114:117]
    ds_write_b64 v4, v[124:125] offset:4096
    v_mfma_f32_16x16x32_bf16 v[118:121], v[182:185], v[230:233], 0
    s_waitcnt lgkmcnt(6)
    v_fmac_f32 v128, v241, v241
    v_cvt_pk_bf16_f32 v147, v128, v128
    v_mfma_f32_16x16x32_bf16 v[118:121], v[166:169], v[150:153], v[118:121]
    s_waitcnt lgkmcnt(5)
    v_mul_f32 v139, v127, v139
    v_cvt_pk_bf16_f32 v122, v138, v139
    v_mfma_f32_16x16x32_bf16 v[150:153], a[72:75], v[154:157], 0
    s_waitcnt lgkmcnt(4)
    v_mul_f32 v140, v127, v140
    v_mul_f32 v141, v127, v141
    v_mfma_f32_16x16x32_bf16 v[150:153], a[76:79], v[186:189], v[150:153]
    s_waitcnt lgkmcnt(3)
    v_cvt_pk_bf16_f32 v123, v140, v141
    v_mul_f32 v198, v127, v198
    v_mfma_f32_16x16x32_bf16 v[150:153], a[80:83], v[206:209], v[150:153]
    s_waitcnt lgkmcnt(2)
    v_mul_f32 v199, v127, v199
    v_cvt_pk_bf16_f32 v124, v198, v199
    v_mfma_f32_16x16x32_bf16 v[150:153], a[84:87], v[190:193], v[150:153]
    s_waitcnt lgkmcnt(1)
    v_mul_f32 v200, v127, v200
    v_mul_f32 v201, v127, v201
    v_mfma_f32_16x16x32_bf16 v[150:153], a[88:91], v[226:229], v[150:153]
    v_cvt_pk_bf16_f32 v125, v200, v201
    v_mul_f32 v218, v127, v218
    v_mfma_f32_16x16x32_bf16 v[150:153], a[92:95], v[234:237], v[150:153]
    ds_write_b128 v3, v[122:125] offset:6144
    v_mfma_f32_16x16x32_bf16 v[122:125], a[116:119], v[234:237], 0
    v_mul_f32 v219, v127, v219
    v_cvt_pk_bf16_f32 v148, v218, v219
    v_mfma_f32_16x16x32_bf16 v[122:125], a[112:115], v[226:229], v[122:125]
    v_mul_f32 v220, v127, v220
    v_mul_f32 v221, v127, v221
    v_mfma_f32_16x16x32_bf16 v[122:125], a[108:111], v[190:193], v[122:125]
    v_cvt_pk_bf16_f32 v149, v220, v221
    v_fmac_f32 v254, v134, v134
    v_mfma_f32_16x16x32_bf16 v[122:125], a[104:107], v[206:209], v[122:125]
    v_rcp_f32_dpp v131, v130 quad_perm:[0,0,0,0] row_mask:0xf bank_mask:0xf
    v_mfma_f32_16x16x32_bf16 v[122:125], a[100:103], v[186:189], v[122:125]
    v_max3_u32 v25, v25, v130, v131
    v_mul_f32 v146, v146, v131
    v_mfma_f32_16x16x32_bf16 v[122:125], a[96:99], v[154:157], v[122:125]
    ds_write_b64 v4, v[148:149] offset:10240
    v_mfma_f32_16x16x32_bf16 v[126:129], a[120:123], v[154:157], 0
    v_mul_f32_dpp v146, v114, v131 quad_perm:[0,1,2,3] row_mask:0x2 bank_mask:0xf
    v_fmac_f32 v254, v135, v135
    v_mfma_f32_16x16x32_bf16 v[126:129], a[124:127], v[186:189], v[126:129]
    v_mul_f32_dpp v146, v118, v131 quad_perm:[0,1,2,3] row_mask:0x4 bank_mask:0xf
    v_cvt_pk_bf16_f32 v146, v146, v146
    v_mfma_f32_16x16x32_bf16 v[126:129], a[128:131], v[206:209], v[126:129]
    ds_write_b16 v7, v146
    v_mfma_f32_16x16x32_bf16 v[126:129], a[132:135], v[190:193], v[126:129]
    v_add_u32 v7, s76, v7
    v_fmac_f32 v254, v136, v136
    v_mfma_f32_16x16x32_bf16 v[126:129], a[136:139], v[226:229], v[126:129]
    v_fmac_f32 v254, v137, v137
    v_cvt_pk_bf16_f32 v146, v254, v255
    v_mfma_f32_16x16x32_bf16 v[126:129], a[140:143], v[234:237], v[126:129]
    ds_write_b64 v4, v[146:147] offset:18432
    v_mfma_f32_16x16x32_bf16 v[114:117], a[20:23], v[234:237], 0
    v_cvt_pk_f16_f32 v182, v150, v151
    v_pk_mul_f16 v139, v182, v182
    v_mfma_f32_16x16x32_bf16 v[114:117], a[16:19], v[226:229], v[114:117]
    v_cvt_pk_f16_f32 v183, v152, v153
    v_pk_fma_f16 v139, v183, v183, v139
    v_mfma_f32_16x16x32_bf16 v[114:117], a[12:15], v[190:193], v[114:117]
    v_cvt_pk_f16_f32 v184, v122, v123
    v_pk_fma_f16 v139, v184, v184, v139
    v_mfma_f32_16x16x32_bf16 v[114:117], a[8:11], v[206:209], v[114:117]
    v_cvt_pk_f16_f32 v185, v124, v125
    v_pk_fma_f16 v139, v185, v185, v139
    v_mfma_f32_16x16x32_bf16 v[114:117], a[4:7], v[186:189], v[114:117]
    v_cvt_pk_f16_f32 v168, v126, v127
    v_pk_fma_f16 v139, v168, v168, v139
    v_mfma_f32_16x16x32_bf16 v[114:117], a[0:3], v[154:157], v[114:117]
    v_cvt_pk_f16_f32 v169, v128, v129
    v_pk_fma_f16 v139, v169, v169, v139
    v_mfma_f32_16x16x32_bf16 v[118:121], a[24:27], v[154:157], 0
    s_waitcnt lgkmcnt(0)
    v_xor_b32 v2, 65536, v2
    v_xor_b32 v3, 65536, v3
    v_mfma_f32_16x16x32_bf16 v[118:121], a[28:31], v[186:189], v[118:121]
    s_nop 0
    v_cvt_pk_f16_f32 v130, v114, v115
    v_mfma_f32_16x16x32_bf16 v[118:121], a[32:35], v[206:209], v[118:121]
    s_barrier
    v_pk_mul_f16 v138, v130, v130
    v_mfma_f32_16x16x32_bf16 v[118:121], a[36:39], v[190:193], v[118:121]
    s_nop 0
    v_xor_b32 v4, 65536, v4
    v_mfma_f32_16x16x32_bf16 v[118:121], a[40:43], v[226:229], v[118:121]
    s_nop 0
    v_mfma_f32_16x16x32_bf16 v[118:121], a[44:47], v[234:237], v[118:121]
    s_cbranch_scc1 L_loop_fast1
    s_branch L_final_fast
.p2align 6
L_loop_fast2:
    v_mfma_f32_16x16x32_bf16 v[126:129], a[68:71], v[234:237], 0
    s_add_u32 s12, s40, s27
    ds_read_b128 v[150:153], v2 offset:18432
    v_cvt_pk_f16_f32 v131, v116, v117
    v_mfma_f32_16x16x32_bf16 v[126:129], a[64:67], v[226:229], v[126:129]
    s_addc_u32 s13, s41, 0
    ds_read_b128 v[114:117], v2 offset:19456
    v_pk_fma_f16 v138, v131, v131, v138
    v_mfma_f32_16x16x32_bf16 v[126:129], a[60:63], v[190:193], v[126:129]
    s_sub_u32 s14, s36, s27
    ds_read_b128 v[202:205], v5 offset:32
    v_cvt_pk_f16_f32 v132, v118, v119
    v_mfma_f32_16x16x32_bf16 v[126:129], a[56:59], v[206:209], v[126:129]
    s_cmp_ge_u32 s18, 2
    ds_read2_b64 v[210:213], v5 offset0:6 offset1:9
    v_pk_fma_f16 v138, v132, v132, v138
    v_mfma_f32_16x16x32_bf16 v[126:129], a[52:55], v[186:189], v[126:129]
    s_cselect_b32 s14, s14, 0
    ds_read_b128 v[122:125], v5
    v_cvt_pk_f16_f32 v133, v120, v121
    v_mfma_f32_16x16x32_bf16 v[126:129], a[48:51], v[154:157], v[126:129]
    s_sub_u32 s82, s72, s71
    ds_read_b32 v146, v6 offset:192
    v_pk_fma_f16 v138, v133, v133, v138
    v_mfma_f32_16x16x32_bf16 v[118:121], v[154:157], a[144:147], 0
    s_mul_i32 s74, s82, 336
    v_add_u32 v5, s74, v5
    s_mul_i32 s75, s82, 272
    v_mfma_f32_16x16x32_bf16 v[118:121], v[186:189], a[148:151], v[118:121]
    s_mul_i32 s76, s82, 16
    v_cvt_pk_f16_f32 v166, v126, v127
    v_pk_fma_f16 v138, v166, v166, v138
    v_mfma_f32_16x16x32_bf16 v[118:121], v[206:209], a[152:155], v[118:121]
    s_waitcnt lgkmcnt(5)
    v_cvt_pk_f16_f32 v167, v128, v129
    v_pk_fma_f16 v138, v167, v167, v138
    v_mfma_f32_16x16x32_bf16 v[118:121], v[190:193], a[156:159], v[118:121]
    s_add_u32 s34, s18, 2
    s_add_u32 s8, s60, s23
    s_addc_u32 s9, s61, 0
    v_mfma_f32_16x16x32_bf16 v[118:121], v[226:229], a[160:163], v[118:121]
    s_waitcnt lgkmcnt(3)
    ds_read_b128 v[218:221], v0 offset:26624
    v_pk_mul_f16 v141, v182, v202
    v_mfma_f32_16x16x32_bf16 v[118:121], v[234:237], a[164:167], v[118:121]
    s_sub_u32 s10, s36, s23
    ds_read_b128 v[222:225], v1 offset:26624
    v_pk_fma_f16 v141, v183, v203, v141
    v_mfma_f32_16x16x32_bf16 v[126:129], v[32:35], v[150:153], 0
    s_waitcnt lgkmcnt(3)
    v_pk_fma_f16 v141, v184, v204, v141
    v_pk_fma_f16 v141, v185, v205, v141
    v_mfma_f32_16x16x32_bf16 v[126:129], v[32:35], v[114:117], v[126:129]
    s_waitcnt lgkmcnt(2)
    v_mov_b32_dpp v146, v23 quad_perm:[0,1,2,3] row_mask:0x7 bank_mask:0xf
    v_pk_fma_f16 v141, v168, v212, v141
    v_mfma_f32_16x16x32_bf16 v[150:153], v[234:237], a[188:191], 0
    s_cmp_le_u32 s34, s45
    ds_read_b128 v[230:233], v0 offset:26752
    v_pk_fma_f16 v141, v169, v213, v141
    v_mfma_f32_16x16x32_bf16 v[150:153], v[226:229], a[184:187], v[150:153]
    s_cselect_b32 s10, s10, 0
    ds_read_b128 v[246:249], v1 offset:26752
    v_pk_mul_f16 v140, v130, v122
    v_mfma_f32_16x16x32_bf16 v[150:153], v[190:193], a[180:183], v[150:153]
    s_add_u32 m0, s28, 0
    ds_read_b128 v[242:245], v0 offset:26880
    v_pk_fma_f16 v140, v131, v123, v140
    v_mfma_f32_16x16x32_bf16 v[150:153], v[206:209], a[176:179], v[150:153]
    s_mov_b32 s27, s26
    ds_read_b128 v[194:197], v1 offset:26880
    v_pk_fma_f16 v140, v132, v124, v140
    v_mfma_f32_16x16x32_bf16 v[150:153], v[186:189], a[172:175], v[150:153]
    s_waitcnt lgkmcnt(5)
    v_pk_fma_f16 v140, v133, v125, v140
    v_pk_fma_f16 v140, v166, v210, v140
    v_mfma_f32_16x16x32_bf16 v[150:153], v[154:157], a[168:171], v[150:153]
    s_mov_b32 s26, s25
    v_pk_fma_f16 v140, v167, v211, v140
    v_cvt_pk_bf16_f32 v114, v118, v119
    v_mfma_f32_16x16x32_bf16 v[198:201], v[154:157], a[192:195], 0
    s_mov_b32 s25, s24
    v_cvt_pk_bf16_f32 v115, v120, v121
    v_mul_f32 v116, 0x3baaaaab, v126
    v_mfma_f32_16x16x32_bf16 v[198:201], v[186:189], a[196:199], v[198:201]
    s_mov_b32 s24, s23
    v_cvt_pk_bf16_f32 v118, v150, v151
    v_cvt_pk_bf16_f32 v119, v152, v153
    v_mfma_f32_16x16x32_bf16 v[198:201], v[206:209], a[200:203], v[198:201]
    s_mov_b32 s71, s72
    v_rsq_f32 v116, v116
    v_mfma_f32_16x16x32_bf16 v[198:201], v[190:193], a[204:207], v[198:201]
    s_mov_b32 s72, s73
    v_mul_f32 v147, 0x3baaaaab, v127
    v_mul_f32 v117, 0x3baaaaab, v128
    v_mfma_f32_16x16x32_bf16 v[198:201], v[226:229], a[208:211], v[198:201]
    s_waitcnt lgkmcnt(1)
    v_rsq_f32 v147, v147
    v_mfma_f32_16x16x32_bf16 v[198:201], v[234:237], a[212:215], v[198:201]
    s_waitcnt lgkmcnt(0)
    v_rsq_f32 v117, v117
    v_mfma_f32_16x16x32_f16 v[186:189], v[40:43], v[138:141], 0
    v_mul_f32 v178, v116, v178
    v_mul_f32 v179, v116, v179
    v_mfma_f32_16x16x32_bf16 v[138:141], a[72:75], v[218:221], 0
    v_cvt_pk_bf16_f32 v126, v178, v179
    v_mul_f32 v180, v116, v180
    v_mfma_f32_16x16x32_bf16 v[138:141], a[76:79], v[222:225], v[138:141]
    v_cvt_pk_bf16_f32 v150, v198, v199
    v_cvt_pk_bf16_f32 v151, v200, v201
    v_mfma_f32_16x16x32_bf16 v[138:141], a[80:83], v[230:233], v[138:141]
    v_rsq_f32 v186, v186
    v_mfma_f32_16x16x32_bf16 v[138:141], a[84:87], v[246:249], v[138:141]
    v_rsq_f32 v187, v187
    v_mfma_f32_16x16x32_bf16 v[138:141], a[88:91], v[242:245], v[138:141]
    v_mul_f32 v120, s31, v186
    v_cvt_pk_f16_f32 v121, v120, v187
    v_mfma_f32_16x16x32_bf16 v[138:141], a[92:95], v[194:197], v[138:141]
    v_mul_f32 v181, v116, v181
    v_cvt_pk_bf16_f32 v127, v180, v181
    v_mfma_f32_16x16x32_bf16 v[154:157], a[116:119], v[194:197], 0
    v_mul_f32 v142, v116, v142
    v_mul_f32 v143, v116, v143
    v_mfma_f32_16x16x32_bf16 v[154:157], a[112:115], v[242:245], v[154:157]
    v_cvt_pk_bf16_f32 v128, v142, v143
    v_mul_f32 v144, v116, v144
    v_mfma_f32_16x16x32_bf16 v[154:157], a[108:111], v[246:249], v[154:157]
    v_mul_f32 v145, v116, v145
    v_cvt_pk_bf16_f32 v129, v144, v145
    v_mfma_f32_16x16x32_bf16 v[154:157], a[104:107], v[230:233], v[154:157]
    v_mul_f32 v134, v116, v134
    v_mul_f32 v135, v116, v135
    v_mfma_f32_16x16x32_bf16 v[154:157], a[100:103], v[222:225], v[154:157]
    v_cvt_pk_bf16_f32 v148, v134, v135
    v_mul_f32 v136, v116, v136
    v_mfma_f32_16x16x32_bf16 v[154:157], a[96:99], v[218:221], v[154:157]
    buffer_store_dwordx4 v[126:129], v15, s[12:15], 0 offen nt
    v_mul_f32 v137, v116, v137
    v_cvt_pk_bf16_f32 v149, v136, v137
    v_fma_f32 v188, v188, v120, v22
    v_fmac_f32_dpp v146, v189, v187 quad_perm:[0,1,2,3] row_mask:0x1 bank_mask:0xf
    v_mfma_f32_16x16x32_bf16 v[126:129], a[120:123], v[218:221], 0
    v_pk_mul_f16 v182, v182, v121 op_sel:[0,1] op_sel_hi:[1,1]
    v_pk_mul_f16 v183, v183, v121 op_sel:[0,1] op_sel_hi:[1,1]
    v_mfma_f32_16x16x32_bf16 v[126:129], a[124:127], v[222:225], v[126:129]
    v_pk_mul_f16 v184, v184, v121 op_sel:[0,1] op_sel_hi:[1,1]
    v_pk_mul_f16 v185, v185, v121 op_sel:[0,1] op_sel_hi:[1,1]
    v_mfma_f32_16x16x32_bf16 v[126:129], a[128:131], v[230:233], v[126:129]
    v_pk_mul_f16 v168, v168, v121 op_sel:[0,1] op_sel_hi:[1,1]
    v_pk_mul_f16 v169, v169, v121 op_sel:[0,1] op_sel_hi:[1,1]
    v_mfma_f32_16x16x32_bf16 v[126:129], a[132:135], v[246:249], v[126:129]
    v_pk_mul_f16 v130, v130, v121 op_sel:[0,0] op_sel_hi:[1,0]
    v_pk_mul_f16 v131, v131, v121 op_sel:[0,0] op_sel_hi:[1,0]
    v_mfma_f32_16x16x32_bf16 v[126:129], a[136:139], v[242:245], v[126:129]
    v_pk_mul_f16 v132, v132, v121 op_sel:[0,0] op_sel_hi:[1,0]
    v_pk_mul_f16 v133, v133, v121 op_sel:[0,0] op_sel_hi:[1,0]
    v_mfma_f32_16x16x32_bf16 v[126:129], a[140:143], v[194:197], v[126:129]
    v_pk_mul_f16 v166, v166, v121 op_sel:[0,0] op_sel_hi:[1,0]
    v_pk_mul_f16 v167, v167, v121 op_sel:[0,0] op_sel_hi:[1,0]
    v_mfma_f32_16x16x32_bf16 v[134:137], a[20:23], v[194:197], 0
    v_max3_u32 v44, v44, v186, v187
    v_mul_f32 v170, v117, v170
    v_mfma_f32_16x16x32_bf16 v[134:137], a[16:19], v[242:245], v[134:137]
    v_mul_f32 v171, v117, v171
    v_cvt_pk_bf16_f32 v226, v170, v171
    v_mfma_f32_16x16x32_bf16 v[134:137], a[12:15], v[246:249], v[134:137]
    v_mul_f32 v172, v117, v172
    v_mul_f32 v173, v117, v173
    v_mfma_f32_16x16x32_bf16 v[134:137], a[8:11], v[230:233], v[134:137]
    v_cvt_pk_bf16_f32 v227, v172, v173
    v_mul_f32 v158, v117, v158
    v_mfma_f32_16x16x32_bf16 v[134:137], a[4:7], v[222:225], v[134:137]
    v_mul_f32 v159, v117, v159
    v_cvt_pk_bf16_f32 v228, v158, v159
    v_mfma_f32_16x16x32_bf16 v[134:137], a[0:3], v[218:221], v[134:137]
    v_mul_f32 v160, v117, v160
    v_mul_f32 v161, v117, v161
    v_mfma_f32_16x16x32_bf16 v[142:145], a[24:27], v[218:221], 0
    v_cvt_pk_bf16_f32 v229, v160, v161
    v_mul_f32 v238, v117, v238
    v_mfma_f32_16x16x32_bf16 v[142:145], a[28:31], v[222:225], v[142:145]
    v_mul_f32 v239, v117, v239
    v_cvt_pk_bf16_f32 v254, v238, v239
    v_mfma_f32_16x16x32_bf16 v[142:145], a[32:35], v[230:233], v[142:145]
    v_mul_f32 v240, v117, v240
    v_mul_f32 v241, v117, v241
    v_mfma_f32_16x16x32_bf16 v[142:145], a[36:39], v[246:249], v[142:145]
    v_cvt_pk_bf16_f32 v255, v240, v241
    v_cvt_pk_f16_f32 v190, v134, v135
    v_mfma_f32_16x16x32_bf16 v[142:145], a[40:43], v[242:245], v[142:145]
    v_pk_mul_f16 v158, v190, v190
    v_cvt_pk_f16_f32 v191, v136, v137
    v_mfma_f32_16x16x32_bf16 v[142:145], a[44:47], v[194:197], v[142:145]
    buffer_store_dwordx2 v[148:149], v18, s[12:15], 0 offen nt
    v_pk_fma_f16 v158, v191, v191, v158
    v_pk_mul_f16 v160, v190, v122
    v_mfma_f32_16x16x32_bf16 v[134:137], a[68:71], v[194:197], 0
    v_pk_fma_f16 v160, v191, v123, v160
    v_cvt_pk_f16_f32 v198, v138, v139
    v_mfma_f32_16x16x32_bf16 v[134:137], a[64:67], v[242:245], v[134:137]
    v_pk_mul_f16 v159, v198, v198
    v_cvt_pk_f16_f32 v192, v142, v143
    v_mfma_f32_16x16x32_bf16 v[134:137], a[60:63], v[246:249], v[134:137]
    v_pk_fma_f16 v158, v192, v192, v158
    v_cvt_pk_f16_f32 v193, v144, v145
    v_mfma_f32_16x16x32_bf16 v[134:137], a[56:59], v[230:233], v[134:137]
    v_pk_fma_f16 v158, v193, v193, v158
    v_pk_fma_f16 v160, v192, v124, v160
    v_mfma_f32_16x16x32_bf16 v[134:137], a[52:55], v[222:225], v[134:137]
    v_pk_fma_f16 v160, v193, v125, v160
    v_cvt_pk_f16_f32 v199, v140, v141
    v_mfma_f32_16x16x32_bf16 v[134:137], a[48:51], v[218:221], v[134:137]
    v_pk_fma_f16 v159, v199, v199, v159
    v_cvt_pk_f16_f32 v200, v154, v155
    v_mfma_f32_16x16x32_bf16 v[234:237], v[218:221], a[144:147], 0
    v_pk_fma_f16 v159, v200, v200, v159
    v_cvt_pk_f16_f32 v201, v156, v157
    v_mfma_f32_16x16x32_bf16 v[234:237], v[222:225], a[148:151], v[234:237]
    v_pk_fma_f16 v159, v201, v201, v159
    v_cvt_pk_f16_f32 v140, v126, v127
    v_mfma_f32_16x16x32_bf16 v[234:237], v[230:233], a[152:155], v[234:237]
    v_cvt_pk_f16_f32 v138, v134, v135
    v_pk_fma_f16 v158, v138, v138, v158
    v_mfma_f32_16x16x32_bf16 v[234:237], v[246:249], a[156:159], v[234:237]
    v_cvt_pk_f16_f32 v139, v136, v137
    v_pk_fma_f16 v158, v139, v139, v158
    v_mfma_f32_16x16x32_bf16 v[234:237], v[242:245], a[160:163], v[234:237]
    ds_read_b128 v[142:145], v0 offset:32768
    v_pk_fma_f16 v160, v138, v210, v160
    v_mfma_f32_16x16x32_bf16 v[234:237], v[194:197], a[164:167], v[234:237]
    ds_read_b128 v[178:181], v1 offset:32768
    v_pk_fma_f16 v160, v139, v211, v160
    v_mfma_f32_16x16x32_bf16 v[238:241], v[194:197], a[188:191], 0
    ds_read_b128 v[154:157], v0 offset:32896
    v_pk_fma_f16 v159, v140, v140, v159
    v_mfma_f32_16x16x32_bf16 v[238:241], v[242:245], a[184:187], v[238:241]
    ds_read_b128 v[170:173], v1 offset:32896
    v_cvt_pk_f16_f32 v141, v128, v129
    v_mfma_f32_16x16x32_bf16 v[238:241], v[246:249], a[180:183], v[238:241]
    ds_read_b128 v[206:209], v0 offset:33024
    v_cvt_pk_bf16_f32 v116, v234, v235
    v_mfma_f32_16x16x32_bf16 v[238:241], v[230:233], a[176:179], v[238:241]
    ds_read_b128 v[134:137], v1 offset:33024
    v_cvt_pk_bf16_f32 v117, v236, v237
    v_mfma_f32_16x16x32_bf16 v[238:241], v[222:225], a[172:175], v[238:241]
    v_pk_fma_f16 v159, v141, v141, v159
    v_pk_mul_f16 v161, v198, v202
    v_mfma_f32_16x16x32_bf16 v[238:241], v[218:221], a[168:171], v[238:241]
    buffer_store_dwordx4 v[226:229], v17, s[12:15], 0 offen nt
    v_pk_fma_f16 v161, v199, v203, v161
    v_pk_fma_f16 v161, v200, v204, v161
    v_pk_fma_f16 v161, v201, v205, v161
    v_pk_fma_f16 v161, v140, v212, v161
    v_mfma_f32_16x16x32_bf16 v[126:129], v[218:221], a[192:195], 0
    s_waitcnt lgkmcnt(4)
    v_pk_fma_f16 v161, v141, v213, v161
    v_cvt_pk_bf16_f32 v120, v238, v239
    v_mfma_f32_16x16x32_bf16 v[126:129], v[222:225], a[196:199], v[126:129]
    s_waitcnt lgkmcnt(3)
    v_cvt_pk_bf16_f32 v121, v240, v241
    v_mul_f32 v174, v147, v174
    v_mfma_f32_16x16x32_bf16 v[126:129], v[230:233], a[200:203], v[126:129]
    s_waitcnt lgkmcnt(2)
    v_exp_f32 v188, v188
    v_mfma_f32_16x16x32_bf16 v[126:129], v[246:249], a[204:207], v[126:129]
    s_waitcnt vmcnt(3)
    ds_write_b16 v8, v45 offset:512
    v_mfma_f32_16x16x32_bf16 v[126:129], v[242:245], a[208:211], v[126:129]
    s_waitcnt lgkmcnt(1)
    v_cvt_pk_bf16_f32 v39, v188, 0
    v_mfma_f32_16x16x32_bf16 v[126:129], v[194:197], a[212:215], v[126:129]
    v_mul_f32 v175, v147, v175
    v_cvt_pk_bf16_f32 v174, v174, v175
    v_mfma_f32_16x16x32_f16 v[186:189], v[40:43], v[158:161], 0
    v_mul_f32 v176, v147, v176
    v_mul_f32 v177, v147, v177
    v_mfma_f32_16x16x32_bf16 v[158:161], a[72:75], v[142:145], 0
    v_cvt_pk_bf16_f32 v175, v176, v177
    v_mul_f32 v162, v147, v162
    v_mfma_f32_16x16x32_bf16 v[158:161], a[76:79], v[178:181], v[158:161]
    v_cvt_pk_bf16_f32 v152, v126, v127
    v_cvt_pk_bf16_f32 v153, v128, v129
    v_mfma_f32_16x16x32_bf16 v[158:161], a[80:83], v[154:157], v[158:161]
    v_rsq_f32 v186, v186
    v_mfma_f32_16x16x32_bf16 v[158:161], a[84:87], v[170:173], v[158:161]
    v_rsq_f32 v187, v187
    v_mfma_f32_16x16x32_bf16 v[158:161], a[88:91], v[206:209], v[158:161]
    s_waitcnt lgkmcnt(0)
    v_mul_f32 v148, s31, v186
    v_cvt_pk_f16_f32 v149, v148, v187
    v_mfma_f32_16x16x32_bf16 v[158:161], a[92:95], v[134:137], v[158:161]
    v_fma_f32 v188, v188, v148, v24
    v_mfma_f32_16x16x32_bf16 v[126:129], a[116:119], v[134:137], 0
    v_fmac_f32_dpp v146, v189, v187 quad_perm:[0,1,2,3] row_mask:0x2 bank_mask:0xf
    v_mfma_f32_16x16x32_bf16 v[126:129], a[112:115], v[206:209], v[126:129]
    s_barrier
    v_pk_mul_f16 v198, v198, v149 op_sel:[0,1] op_sel_hi:[1,1]
    v_mfma_f32_16x16x32_bf16 v[126:129], a[108:111], v[170:173], v[126:129]
    buffer_load_dwordx4 v10, s[8:11], 0 offen nt lds
    v_mfma_f32_16x16x32_bf16 v[126:129], a[104:107], v[154:157], v[126:129]
    s_add_u32 m0, s28, 4096
    ds_read_u16 v148, v9 offset:256
    v_pk_mul_f16 v199, v199, v149 op_sel:[0,1] op_sel_hi:[1,1]
    v_mfma_f32_16x16x32_bf16 v[126:129], a[100:103], v[178:181], v[126:129]
    v_pk_mul_f16 v200, v200, v149 op_sel:[0,1] op_sel_hi:[1,1]
    v_pk_mul_f16 v201, v201, v149 op_sel:[0,1] op_sel_hi:[1,1]
    v_mfma_f32_16x16x32_bf16 v[126:129], a[96:99], v[142:145], v[126:129]
    v_pk_mul_f16 v140, v140, v149 op_sel:[0,1] op_sel_hi:[1,1]
    v_pk_mul_f16 v141, v141, v149 op_sel:[0,1] op_sel_hi:[1,1]
    v_mfma_f32_16x16x32_bf16 v[194:197], a[120:123], v[142:145], 0
    v_pk_mul_f16 v190, v190, v149 op_sel:[0,0] op_sel_hi:[1,0]
    v_pk_mul_f16 v191, v191, v149 op_sel:[0,0] op_sel_hi:[1,0]
    v_mfma_f32_16x16x32_bf16 v[194:197], a[124:127], v[178:181], v[194:197]
    buffer_load_dwordx4 v11, s[8:11], 0 offen nt lds
    v_pk_mul_f16 v192, v192, v149 op_sel:[0,0] op_sel_hi:[1,0]
    v_mfma_f32_16x16x32_bf16 v[194:197], a[128:131], v[154:157], v[194:197]
    s_add_u32 m0, s28, 8192
    v_pk_mul_f16 v193, v193, v149 op_sel:[0,0] op_sel_hi:[1,0]
    v_pk_mul_f16 v138, v138, v149 op_sel:[0,0] op_sel_hi:[1,0]
    v_mfma_f32_16x16x32_bf16 v[194:197], a[132:135], v[170:173], v[194:197]
    v_pk_mul_f16 v139, v139, v149 op_sel:[0,0] op_sel_hi:[1,0]
    v_max3_u32 v44, v44, v186, v187
    v_mfma_f32_16x16x32_bf16 v[194:197], a[136:139], v[206:209], v[194:197]
    v_cvt_pk_f16_f32 v218, v158, v159
    v_pk_mul_f16 v159, v218, v218
    v_mfma_f32_16x16x32_bf16 v[194:197], a[140:143], v[134:137], v[194:197]
    s_waitcnt lgkmcnt(0)
    v_readfirstlane_b32 s77, v148
    v_cvt_pk_f16_f32 v219, v160, v161
    v_mfma_f32_16x16x32_bf16 v[222:225], a[20:23], v[134:137], 0
    buffer_load_dwordx4 v12, s[8:11], 0 offen nt lds
    v_pk_fma_f16 v159, v219, v219, v159
    v_mfma_f32_16x16x32_bf16 v[222:225], a[16:19], v[206:209], v[222:225]
    s_add_u32 m0, s28, 12288
    v_cvt_pk_f16_f32 v220, v126, v127
    v_pk_fma_f16 v159, v220, v220, v159
    v_mfma_f32_16x16x32_bf16 v[222:225], a[12:15], v[170:173], v[222:225]
    s_xor_b32 s28, s28, 65536
    v_cvt_pk_f16_f32 v221, v128, v129
    v_pk_fma_f16 v159, v221, v221, v159
    v_mfma_f32_16x16x32_bf16 v[222:225], a[8:11], v[154:157], v[222:225]
    s_mul_i32 s78, s77, 2688
    v_cvt_pk_f16_f32 v128, v194, v195
    v_pk_fma_f16 v159, v128, v128, v159
    v_mfma_f32_16x16x32_bf16 v[222:225], a[4:7], v[178:181], v[222:225]
    v_cvt_pk_f16_f32 v129, v196, v197
    v_pk_fma_f16 v159, v129, v129, v159
    v_mfma_f32_16x16x32_bf16 v[222:225], a[0:3], v[142:145], v[222:225]
    buffer_load_dwordx4 v13, s[8:11], 0 offen nt lds
    v_pk_mul_f16 v161, v218, v202
    v_mfma_f32_16x16x32_bf16 v[194:197], a[24:27], v[142:145], 0
    s_mov_b32 m0, s29
    v_pk_fma_f16 v161, v219, v203, v161
    v_pk_fma_f16 v161, v220, v204, v161
    v_mfma_f32_16x16x32_bf16 v[194:197], a[28:31], v[178:181], v[194:197]
    s_xor_b32 s29, s29, s30
    v_cvt_pk_f16_f32 v202, v222, v223
    v_pk_mul_f16 v158, v202, v202
    v_mfma_f32_16x16x32_bf16 v[194:197], a[32:35], v[154:157], v[194:197]
    s_add_u32 s19, s19, s20
    ds_read2_b32 v[228:229], v6 offset0:0 offset1:0
    v_cvt_pk_f16_f32 v203, v224, v225
    v_mfma_f32_16x16x32_bf16 v[194:197], a[36:39], v[170:173], v[194:197]
    s_add_u32 s23, s23, s21
    ds_read2_b32 v[224:225], v6 offset0:16 offset1:16
    v_pk_fma_f16 v158, v203, v203, v158
    v_mfma_f32_16x16x32_bf16 v[194:197], a[40:43], v[206:209], v[194:197]
    ds_read2_b32 v[232:233], v6 offset0:32 offset1:32
    v_mfma_f32_16x16x32_bf16 v[194:197], a[44:47], v[134:137], v[194:197]
    s_cmp_ge_u32 s19, 72
    v_pk_mul_f16 v160, v202, v122
    v_pk_fma_f16 v160, v203, v123, v160
    v_mfma_f32_16x16x32_bf16 v[234:237], a[68:71], v[134:137], 0
    s_cselect_b32 s34, 72, 0
    v_pk_fma_f16 v161, v221, v205, v161
    v_pk_fma_f16 v161, v128, v212, v161
    v_mfma_f32_16x16x32_bf16 v[234:237], a[64:67], v[206:209], v[234:237]
    s_cselect_b32 s35, s22, 0
    v_cvt_pk_f16_f32 v204, v194, v195
    v_pk_fma_f16 v158, v204, v204, v158
    v_mfma_f32_16x16x32_bf16 v[234:237], a[60:63], v[170:173], v[234:237]
    s_sub_u32 s19, s19, s34
    v_cvt_pk_f16_f32 v205, v196, v197
    v_pk_fma_f16 v158, v205, v205, v158
    v_mfma_f32_16x16x32_bf16 v[234:237], a[56:59], v[154:157], v[234:237]
    s_add_u32 s23, s23, s35
    v_pk_fma_f16 v160, v204, v124, v160
    v_pk_fma_f16 v160, v205, v125, v160
    v_mfma_f32_16x16x32_bf16 v[234:237], a[52:55], v[178:181], v[234:237]
    s_add_u32 s78, s78, s69
    v_pk_fma_f16 v161, v129, v213, v161
    v_mul_f32 v163, v147, v163
    v_mfma_f32_16x16x32_bf16 v[234:237], a[48:51], v[142:145], v[234:237]
    s_waitcnt lgkmcnt(1)
    buffer_store_dwordx2 v[254:255], v20, s[12:15], 0 offen nt
    v_exp_f32 v188, v188
    v_mfma_f32_16x16x32_bf16 v[122:125], v[142:145], a[144:147], 0
    s_add_u32 s80, s77, s68
    v_cvt_pk_bf16_f32 v176, v162, v163
    v_mul_f32 v164, v147, v164
    v_mfma_f32_16x16x32_bf16 v[122:125], v[178:181], a[148:151], v[122:125]
    s_cmp_ge_u32 s80, 72
    v_cvt_pk_f16_f32 v126, v234, v235
    v_pk_fma_f16 v158, v126, v126, v158
    v_mfma_f32_16x16x32_bf16 v[122:125], v[154:157], a[152:155], v[122:125]
    s_cselect_b32 s80, s22, 0
    v_cvt_pk_f16_f32 v127, v236, v237
    v_pk_fma_f16 v158, v127, v127, v158
    v_mfma_f32_16x16x32_bf16 v[122:125], v[170:173], a[156:159], v[122:125]
    s_add_u32 s78, s78, s80
    v_pk_fma_f16 v160, v126, v210, v160
    v_pk_fma_f16 v160, v127, v211, v160
    v_mfma_f32_16x16x32_bf16 v[122:125], v[206:209], a[160:163], v[122:125]
    s_add_u32 s80, s77, 20
    v_mul_f32 v165, v147, v165
    v_cvt_pk_bf16_f32 v177, v164, v165
    v_mfma_f32_16x16x32_bf16 v[122:125], v[134:137], a[164:167], v[122:125]
    s_add_u32 s34, s18, 3
    ds_read_b128 v[194:197], v2 offset:0
    v_mul_f32 v214, v147, v214
    v_mfma_f32_16x16x32_f16 v[162:165], v[40:43], v[158:161], 0
    s_cmp_lt_u32 s77, s62
    v_mul_f32 v215, v147, v215
    v_cvt_pk_bf16_f32 v254, v214, v215
    v_mfma_f32_16x16x32_bf16 v[210:213], v[134:137], a[188:191], 0
    s_cselect_b32 s79, 1, 0
    ds_read_b128 v[158:161], v2 offset:1024
    v_cvt_pk_bf16_f32 v226, v122, v123
    v_mfma_f32_16x16x32_bf16 v[210:213], v[206:209], a[184:187], v[210:213]
    s_cselect_b32 s78, s78, 0
    ds_read_b128 v[234:237], v2 offset:2048
    v_cvt_pk_bf16_f32 v227, v124, v125
    v_mfma_f32_16x16x32_bf16 v[210:213], v[170:173], a[180:183], v[210:213]
    s_cmp_lt_u32 s34, s17
    ds_read_b128 v[122:125], v2 offset:3072
    v_mul_f32 v216, v147, v216
    v_mfma_f32_16x16x32_bf16 v[210:213], v[154:157], a[176:179], v[210:213]
    s_cselect_b32 s23, s23, s78
    ds_read_b128 v[238:241], v2 offset:4096
    v_mul_f32 v217, v147, v217
    v_mfma_f32_16x16x32_bf16 v[210:213], v[178:181], a[172:175], v[210:213]
    s_cselect_b32 s73, s34, s80
    ds_read_b128 v[242:245], v2 offset:5120
    v_cvt_pk_bf16_f32 v255, v216, v217
    v_mfma_f32_16x16x32_bf16 v[210:213], v[142:145], a[168:171], v[210:213]
    s_cselect_b32 s79, 0, s79
    v_rsq_f32 v162, v162
    v_mfma_f32_16x16x32_bf16 v[214:217], v[142:145], a[192:195], 0
    s_waitcnt lgkmcnt(5)
    v_rsq_f32 v163, v163
    v_mfma_f32_16x16x32_bf16 v[214:217], v[178:181], a[196:199], v[214:217]
    s_cselect_b32 s81, 0, 1
    v_mul_f32 v148, s31, v162
    v_cvt_pk_f16_f32 v149, v148, v163
    v_mfma_f32_16x16x32_bf16 v[214:217], v[154:157], a[200:203], v[214:217]
    s_add_u32 s80, s77, 1
    v_fma_f32 v164, v164, v148, v26
    v_fmac_f32_dpp v146, v165, v163 quad_perm:[0,1,2,3] row_mask:0x4 bank_mask:0xf
    v_mfma_f32_16x16x32_bf16 v[214:217], v[170:173], a[204:207], v[214:217]
    s_mul_i32 s80, s80, s81
    v_cvt_pk_bf16_f32 v222, v210, v211
    v_cvt_pk_bf16_f32 v223, v212, v213
    v_mfma_f32_16x16x32_bf16 v[214:217], v[206:209], a[208:211], v[214:217]
    s_cmp_lt_u32 s80, s62
    v_pk_mul_f16 v218, v218, v149 op_sel:[0,1] op_sel_hi:[1,1]
    v_pk_mul_f16 v219, v219, v149 op_sel:[0,1] op_sel_hi:[1,1]
    v_mfma_f32_16x16x32_bf16 v[214:217], v[134:137], a[212:215], v[214:217]
    s_waitcnt lgkmcnt(1)
    buffer_store_dwordx4 v[174:177], v16, s[12:15], 0 offen nt
    v_pk_mul_f16 v220, v220, v149 op_sel:[0,1] op_sel_hi:[1,1]
    v_pk_mul_f16 v221, v221, v149 op_sel:[0,1] op_sel_hi:[1,1]
    v_pk_mul_f16 v128, v128, v149 op_sel:[0,1] op_sel_hi:[1,1]
    v_pk_mul_f16 v129, v129, v149 op_sel:[0,1] op_sel_hi:[1,1]
    v_mfma_f32_16x16x32_f16 v[134:137], v[182:185], v[130:133], v[46:49]
    s_waitcnt lgkmcnt(0)
    v_cvt_pk_bf16_f32 v230, v214, v215
    v_cvt_pk_bf16_f32 v231, v216, v217
    v_mfma_f32_16x16x32_f16 v[142:145], v[198:201], v[130:133], v[50:53]
    s_cselect_b32 s62, s62, 0
    v_pk_mul_f16 v202, v202, v149 op_sel:[0,0] op_sel_hi:[1,0]
    v_pk_mul_f16 v203, v203, v149 op_sel:[0,0] op_sel_hi:[1,0]
    v_mfma_f32_16x16x32_f16 v[154:157], v[218:221], v[130:133], v[54:57]
    s_add_u32 s80, s18, 4
    v_pk_mul_f16 v204, v204, v149 op_sel:[0,0] op_sel_hi:[1,0]
    v_pk_mul_f16 v205, v205, v149 op_sel:[0,0] op_sel_hi:[1,0]
    v_pk_mul_f16 v126, v126, v149 op_sel:[0,0] op_sel_hi:[1,0]
    v_mfma_f32_16x16x16_f16 v[134:137], v[168:169], v[166:167], v[134:137]
    v_pk_mul_f16 v127, v127, v149 op_sel:[0,0] op_sel_hi:[1,0]
    v_max3_u32 v44, v44, v162, v163
    v_add_u32 v6, s75, v6
    v_mfma_f32_16x16x16_f16 v[142:145], v[140:141], v[166:167], v[142:145]
    v_exp_f32 v146, v146
    v_xor_b32 v0, 65536, v0
    v_mfma_f32_16x16x16_f16 v[154:157], v[128:129], v[166:167], v[154:157]
    v_cvt_pk_bf16_f32 v146, v146, v146
    v_exp_f32 v134, v134
    v_xor_b32 v1, 65536, v1
    v_mfma_f32_16x16x32_f16 v[130:133], v[182:185], v[190:193], v[58:61]
    s_cmp_ge_u32 s80, s17
    ds_write_b16 v8, v146
    v_mfma_f32_16x16x32_f16 v[146:149], v[198:201], v[190:193], v[62:65]
    s_cselect_b32 s66, s62, 0
    v_exp_f32 v135, v135
    v_mfma_f32_16x16x32_f16 v[170:173], v[218:221], v[190:193], v[66:69]
    s_lshl_b32 s80, s79, s73
    v_cvt_pk_bf16_f32 v134, v134, v135
    v_exp_f32 v136, v136
    v_mfma_f32_16x16x16_f16 v[130:133], v[168:169], v[138:139], v[130:133]
    v_exp_f32 v137, v137
    s_or_b32 s70, s70, s80
    v_mfma_f32_16x16x16_f16 v[146:149], v[140:141], v[138:139], v[146:149]
    v_cvt_pk_bf16_f32 v135, v136, v137
    v_exp_f32 v142, v142
    v_mfma_f32_16x16x16_f16 v[170:173], v[128:129], v[138:139], v[170:173]
    v_exp_f32 v143, v143
    v_exp_f32 v144, v144
    v_mfma_f32_16x16x32_bf16 v[178:181], a[216:219], v[194:197], 0
    s_add_u32 s45, s45, s79
    v_exp_f32 v145, v145
    v_mfma_f32_16x16x32_bf16 v[178:181], a[220:223], v[158:161], v[178:181]
    s_add_u32 s18, s18, 1
    v_cvt_pk_bf16_f32 v136, v142, v143
    v_cvt_pk_bf16_f32 v137, v144, v145
    v_mfma_f32_16x16x32_bf16 v[178:181], a[224:227], v[234:237], v[178:181]
    s_cmp_lt_u32 s18, s45
    v_exp_f32 v154, v154
    v_mfma_f32_16x16x32_bf16 v[178:181], a[228:231], v[122:125], v[178:181]
    v_mfma_f32_16x16x32_bf16 v[178:181], a[232:235], v[238:241], v[178:181]
    v_exp_f32 v155, v155
    v_mfma_f32_16x16x32_bf16 v[178:181], a[236:239], v[242:245], v[178:181]
    buffer_store_dwordx2 v[254:255], v19, s[12:15], 0 offen nt
    v_exp_f32 v156, v156
    v_mfma_f32_16x16x32_bf16 v[142:145], v[86:89], v[242:245], 0
    v_exp_f32 v157, v157
    v_mfma_f32_16x16x32_bf16 v[142:145], v[82:85], v[238:241], v[142:145]
    v_cvt_pk_bf16_f32 v36, v154, v155
    v_cvt_pk_bf16_f32 v37, v156, v157
    v_mfma_f32_16x16x32_bf16 v[142:145], a[252:255], v[122:125], v[142:145]
    v_exp_f32 v164, v164
    v_mfma_f32_16x16x32_bf16 v[142:145], a[248:251], v[234:237], v[142:145]
    ds_read_b128 v[154:157], v2 offset:11264
    v_fma_f32 v254, v178, v178, s33
    v_mfma_f32_16x16x32_bf16 v[142:145], a[244:247], v[158:161], v[142:145]
    ds_read_b128 v[206:209], v2 offset:10240
    v_fmac_f32 v254, v179, v179
    v_mfma_f32_16x16x32_bf16 v[142:145], a[240:243], v[194:197], v[142:145]
    ds_read_b128 v[210:213], v2 offset:9216
    v_fmac_f32 v254, v180, v180
    v_mfma_f32_16x16x32_bf16 v[190:193], v[28:31], v[36:39], 0
    v_exp_f32 v130, v130
    v_mfma_f32_16x16x32_bf16 v[190:193], v[28:31], v[134:137], v[190:193]
    v_exp_f32 v131, v131
    v_mfma_f32_16x16x32_bf16 v[174:177], v[114:117], v[134:137], 0
    v_cvt_pk_bf16_f32 v130, v130, v131
    v_fmac_f32 v254, v181, v181
    v_mfma_f32_16x16x32_bf16 v[174:177], v[226:229], v[36:39], v[174:177]
    v_exp_f32 v132, v132
    v_mfma_f32_16x16x32_bf16 v[246:249], v[222:225], v[36:39], 0
    v_exp_f32 v133, v133
    v_mfma_f32_16x16x32_bf16 v[246:249], v[118:121], v[134:137], v[246:249]
    s_waitcnt lgkmcnt(2)
    v_cvt_pk_bf16_f32 v131, v132, v133
    v_fmac_f32 v254, v142, v142
    v_mfma_f32_16x16x32_bf16 v[250:253], v[150:153], v[134:137], 0
    s_waitcnt lgkmcnt(1)
    v_exp_f32 v146, v146
    v_mfma_f32_16x16x32_bf16 v[250:253], v[230:233], v[36:39], v[250:253]
    s_waitcnt lgkmcnt(0)
    v_exp_f32 v147, v147
    v_mfma_f32_16x16x32_bf16 v[134:137], v[90:93], v[194:197], 0
    ds_read_b128 v[194:197], v2 offset:8192
    v_cvt_pk_bf16_f32 v132, v146, v147
    v_mfma_f32_16x16x32_bf16 v[134:137], v[94:97], v[158:161], v[134:137]
    ds_read_b128 v[158:161], v2 offset:7168
    v_cvt_pk_bf16_f32 v39, v188, 0
    v_mfma_f32_16x16x32_bf16 v[134:137], v[98:101], v[234:237], v[134:137]
    ds_read_b128 v[186:189], v2 offset:6144
    v_fmac_f32 v254, v143, v143
    v_mfma_f32_16x16x32_bf16 v[134:137], v[102:105], v[122:125], v[134:137]
    v_exp_f32 v148, v148
    v_mfma_f32_16x16x32_bf16 v[134:137], v[106:109], v[238:241], v[134:137]
    v_exp_f32 v149, v149
    v_mfma_f32_16x16x32_bf16 v[134:137], v[110:113], v[242:245], v[134:137]
    v_cvt_pk_bf16_f32 v133, v148, v149
    v_fmac_f32 v254, v144, v144
    v_mfma_f32_16x16x32_f16 v[214:217], v[182:185], v[202:205], v[70:73]
    v_exp_f32 v170, v170
    v_mfma_f32_16x16x32_f16 v[146:149], v[198:201], v[202:205], v[74:77]
    v_exp_f32 v171, v171
    v_mfma_f32_16x16x32_f16 v[122:125], v[218:221], v[202:205], v[78:81]
    s_waitcnt lgkmcnt(2)
    v_cvt_pk_bf16_f32 v36, v170, v171
    v_exp_f32 v172, v172
    v_mfma_f32_16x16x16_f16 v[214:217], v[168:169], v[126:127], v[214:217]
    v_exp_f32 v173, v173
    v_fmac_f32 v254, v145, v145
    v_mfma_f32_16x16x16_f16 v[146:149], v[140:141], v[126:127], v[146:149]
    v_cvt_pk_bf16_f32 v37, v172, v173
    v_rcp_f32 v191, v190
    v_mfma_f32_16x16x16_f16 v[122:125], v[128:129], v[126:127], v[122:125]
    v_max3_u32 v25, v25, v191, v190
    v_mul_f32 v174, v191, v174
    v_exp_f32 v214, v214
    v_mfma_f32_16x16x32_bf16 v[126:129], v[28:31], v[36:39], 0
    s_waitcnt lgkmcnt(0)
    v_exp_f32 v215, v215
    v_mfma_f32_16x16x32_bf16 v[126:129], v[28:31], v[130:133], v[126:129]
    v_cvt_pk_bf16_f32 v170, v214, v215
    v_mul_f32 v175, v191, v175
    v_mfma_f32_16x16x32_bf16 v[138:141], v[114:117], v[130:133], 0
    v_exp_f32 v216, v216
    v_mfma_f32_16x16x32_bf16 v[138:141], v[226:229], v[36:39], v[138:141]
    ds_read_b128 v[166:169], v9
    v_cvt_pk_bf16_f32 v202, v174, v175
    v_mfma_f32_16x16x32_bf16 v[198:201], v[222:225], v[36:39], 0
    ds_read_b128 v[182:185], v9 offset:64
    v_mul_f32 v176, v191, v176
    v_mfma_f32_16x16x32_bf16 v[198:201], v[118:121], v[130:133], v[198:201]
    v_exp_f32 v217, v217
    v_mfma_f32_16x16x32_bf16 v[218:221], v[150:153], v[130:133], 0
    v_cvt_pk_bf16_f32 v171, v216, v217
    v_mul_f32 v177, v191, v177
    v_mfma_f32_16x16x32_bf16 v[218:221], v[230:233], v[36:39], v[218:221]
    v_exp_f32 v146, v146
    v_mfma_f32_16x16x32_bf16 v[214:217], v[110:113], v[154:157], 0
    v_exp_f32 v147, v147
    v_mfma_f32_16x16x32_bf16 v[214:217], v[106:109], v[206:209], v[214:217]
    v_cvt_pk_bf16_f32 v172, v146, v147
    v_cvt_pk_bf16_f32 v39, v164, 0
    v_mfma_f32_16x16x32_bf16 v[214:217], v[102:105], v[210:213], v[214:217]
    v_exp_f32 v148, v148
    v_mfma_f32_16x16x32_bf16 v[214:217], v[98:101], v[194:197], v[214:217]
    s_waitcnt lgkmcnt(1)
    v_exp_f32 v149, v149
    v_mfma_f32_16x16x32_bf16 v[214:217], v[94:97], v[158:161], v[214:217]
    s_waitcnt lgkmcnt(0)
    v_cvt_pk_bf16_f32 v173, v148, v149
    v_cvt_pk_bf16_f32 v203, v176, v177
    v_mfma_f32_16x16x32_bf16 v[214:217], v[90:93], v[186:189], v[214:217]
    v_exp_f32 v122, v122
    v_mfma_f32_16x16x32_bf16 v[162:165], a[240:243], v[186:189], 0
    v_exp_f32 v123, v123
    v_mfma_f32_16x16x32_bf16 v[162:165], a[244:247], v[158:161], v[162:165]
    v_cvt_pk_bf16_f32 v36, v122, v123
    v_mul_f32 v246, v191, v246
    v_mfma_f32_16x16x32_bf16 v[162:165], a[248:251], v[194:197], v[162:165]
    v_exp_f32 v124, v124
    v_mfma_f32_16x16x32_bf16 v[162:165], a[252:255], v[210:213], v[162:165]
    ds_read_b128 v[130:133], v2 offset:12288
    v_fma_f32 v255, v214, v214, s33
    v_mfma_f32_16x16x32_bf16 v[162:165], v[82:85], v[206:209], v[162:165]
    ds_read_b128 v[146:149], v2 offset:13312
    v_fmac_f32 v255, v215, v215
    v_mfma_f32_16x16x32_bf16 v[162:165], v[86:89], v[154:157], v[162:165]
    ds_read_b128 v[234:237], v2 offset:14336
    v_fmac_f32 v255, v216, v216
    v_mfma_f32_16x16x32_bf16 v[174:177], a[236:239], v[154:157], 0
    ds_read_b128 v[154:157], v2 offset:15360
    v_fmac_f32 v255, v217, v217
    v_mfma_f32_16x16x32_bf16 v[174:177], a[232:235], v[206:209], v[174:177]
    ds_read_b128 v[206:209], v2 offset:16384
    v_mul_f32 v247, v191, v247
    v_mfma_f32_16x16x32_bf16 v[174:177], a[228:231], v[210:213], v[174:177]
    ds_read_b128 v[210:213], v2 offset:17408
    v_fmac_f32 v255, v162, v162
    v_mfma_f32_16x16x32_bf16 v[174:177], a[224:227], v[194:197], v[174:177]
    v_exp_f32 v125, v125
    v_mfma_f32_16x16x32_bf16 v[174:177], a[220:223], v[158:161], v[174:177]
    v_cvt_pk_bf16_f32 v37, v124, v125
    v_fmac_f32 v255, v163, v163
    v_mfma_f32_16x16x32_bf16 v[174:177], a[216:219], v[186:189], v[174:177]
    s_waitcnt lgkmcnt(5)
    v_fmac_f32 v255, v164, v164
    v_fmac_f32 v255, v165, v165
    v_mfma_f32_16x16x32_bf16 v[122:125], v[28:31], v[36:39], 0
    s_waitcnt lgkmcnt(4)
    v_cvt_pk_bf16_f32 v204, v246, v247
    v_mul_f32 v248, v191, v248
    v_mfma_f32_16x16x32_bf16 v[122:125], v[28:31], v[170:173], v[122:125]
    s_waitcnt lgkmcnt(3)
    v_fmac_f32 v255, v174, v174
    v_fmac_f32 v255, v175, v175
    v_mfma_f32_16x16x32_bf16 v[158:161], v[114:117], v[170:173], 0
    s_waitcnt lgkmcnt(2)
    v_fmac_f32 v255, v176, v176
    v_fmac_f32 v255, v177, v177
    v_mfma_f32_16x16x32_bf16 v[158:161], v[226:229], v[36:39], v[158:161]
    s_waitcnt lgkmcnt(1)
    v_rcp_f32 v123, v122
    v_mfma_f32_16x16x32_bf16 v[186:189], v[222:225], v[36:39], 0
    s_waitcnt lgkmcnt(0)
    v_mul_f32 v249, v191, v249
    v_cvt_pk_bf16_f32 v205, v248, v249
    v_mfma_f32_16x16x32_bf16 v[186:189], v[118:121], v[170:173], v[186:189]
    ds_write_b128 v3, v[202:205] offset:0
    v_mfma_f32_16x16x32_bf16 v[194:197], v[150:153], v[170:173], 0
    v_mul_f32 v158, v123, v158
    v_mul_f32 v159, v123, v159
    v_mfma_f32_16x16x32_bf16 v[194:197], v[230:233], v[36:39], v[194:197]
    v_cvt_pk_bf16_f32 v158, v158, v159
    v_mul_f32 v160, v123, v160
    v_mfma_f32_16x16x32_bf16 v[170:173], a[216:219], v[130:133], 0
    v_mul_f32 v161, v123, v161
    v_cvt_pk_bf16_f32 v159, v160, v161
    v_mfma_f32_16x16x32_bf16 v[170:173], a[220:223], v[146:149], v[170:173]
    v_mul_f32 v186, v123, v186
    v_mul_f32 v187, v123, v187
    v_mfma_f32_16x16x32_bf16 v[170:173], a[224:227], v[234:237], v[170:173]
    v_cvt_pk_bf16_f32 v160, v186, v187
    v_mul_f32 v188, v123, v188
    v_mfma_f32_16x16x32_bf16 v[170:173], a[228:231], v[154:157], v[170:173]
    v_mul_f32 v189, v123, v189
    v_cvt_pk_bf16_f32 v161, v188, v189
    v_mfma_f32_16x16x32_bf16 v[170:173], a[232:235], v[206:209], v[170:173]
    v_mul_f32 v194, v123, v194
    v_mul_f32 v195, v123, v195
    v_mfma_f32_16x16x32_bf16 v[170:173], a[236:239], v[210:213], v[170:173]
    ds_write_b128 v3, v[158:161] offset:12288
    v_mfma_f32_16x16x32_bf16 v[158:161], v[86:89], v[210:213], 0
    v_cvt_pk_bf16_f32 v124, v194, v195
    v_mul_f32 v196, v123, v196
    v_mfma_f32_16x16x32_bf16 v[158:161], v[82:85], v[206:209], v[158:161]
    v_mul_f32 v197, v123, v197
    v_cvt_pk_bf16_f32 v125, v196, v197
    v_mfma_f32_16x16x32_bf16 v[158:161], a[252:255], v[154:157], v[158:161]
    v_fma_f32 v128, v170, v170, s33
    v_fmac_f32 v128, v171, v171
    v_mfma_f32_16x16x32_bf16 v[158:161], a[248:251], v[234:237], v[158:161]
    v_fmac_f32 v128, v172, v172
    v_fmac_f32 v128, v173, v173
    v_mfma_f32_16x16x32_bf16 v[158:161], a[244:247], v[146:149], v[158:161]
    v_mul_f32 v250, v191, v250
    v_mul_f32 v251, v191, v251
    v_mfma_f32_16x16x32_bf16 v[158:161], a[240:243], v[130:133], v[158:161]
    ds_write_b64 v4, v[124:125] offset:16384
    v_mfma_f32_16x16x32_bf16 v[238:241], v[90:93], v[130:133], 0
    v_cvt_pk_bf16_f32 v124, v250, v251
    v_mul_f32 v252, v191, v252
    v_mfma_f32_16x16x32_bf16 v[238:241], v[94:97], v[146:149], v[238:241]
    v_mul_f32 v253, v191, v253
    v_cvt_pk_bf16_f32 v125, v252, v253
    v_mfma_f32_16x16x32_bf16 v[238:241], v[98:101], v[234:237], v[238:241]
    v_fmac_f32 v128, v158, v158
    v_fmac_f32 v128, v159, v159
    v_mfma_f32_16x16x32_bf16 v[238:241], v[102:105], v[154:157], v[238:241]
    v_fmac_f32 v128, v160, v160
    v_fmac_f32 v128, v161, v161
    v_mfma_f32_16x16x32_bf16 v[238:241], v[106:109], v[206:209], v[238:241]
    v_rcp_f32 v127, v126
    v_mfma_f32_16x16x32_bf16 v[238:241], v[110:113], v[210:213], v[238:241]
    ds_read_b128 v[154:157], v0 offset:20480
    v_max3_u32 v25, v25, v127, v126
    v_mfma_f32_16x16x32_bf16 v[130:133], v[166:169], v[28:31], 0
    ds_read_b128 v[186:189], v1 offset:20480
    v_max3_u32 v25, v25, v123, v122
    v_mfma_f32_16x16x32_bf16 v[130:133], v[182:185], v[28:31], v[130:133]
    ds_read_b128 v[206:209], v0 offset:20608
    v_mul_f32 v138, v127, v138
    v_mfma_f32_16x16x32_bf16 v[146:149], v[182:185], v[226:229], 0
    ds_read_b128 v[190:193], v1 offset:20608
    v_fmac_f32 v128, v238, v238
    v_mfma_f32_16x16x32_bf16 v[146:149], v[166:169], v[114:117], v[146:149]
    ds_read_b128 v[226:229], v0 offset:20736
    v_fmac_f32 v128, v239, v239
    v_mfma_f32_16x16x32_bf16 v[114:117], v[166:169], v[118:121], 0
    ds_read_b128 v[234:237], v1 offset:20736
    v_fmac_f32 v128, v240, v240
    v_mfma_f32_16x16x32_bf16 v[114:117], v[182:185], v[222:225], v[114:117]
    ds_write_b64 v4, v[124:125] offset:4096
    v_mfma_f32_16x16x32_bf16 v[118:121], v[182:185], v[230:233], 0
    s_waitcnt lgkmcnt(6)
    v_fmac_f32 v128, v241, v241
    v_cvt_pk_bf16_f32 v147, v128, v128
    v_mfma_f32_16x16x32_bf16 v[118:121], v[166:169], v[150:153], v[118:121]
    s_waitcnt lgkmcnt(5)
    v_mul_f32 v139, v127, v139
    v_cvt_pk_bf16_f32 v122, v138, v139
    v_mfma_f32_16x16x32_bf16 v[150:153], a[72:75], v[154:157], 0
    s_waitcnt lgkmcnt(4)
    v_mul_f32 v140, v127, v140
    v_mul_f32 v141, v127, v141
    v_mfma_f32_16x16x32_bf16 v[150:153], a[76:79], v[186:189], v[150:153]
    s_waitcnt lgkmcnt(3)
    v_cvt_pk_bf16_f32 v123, v140, v141
    v_mul_f32 v198, v127, v198
    v_mfma_f32_16x16x32_bf16 v[150:153], a[80:83], v[206:209], v[150:153]
    s_waitcnt lgkmcnt(2)
    v_mul_f32 v199, v127, v199
    v_cvt_pk_bf16_f32 v124, v198, v199
    v_mfma_f32_16x16x32_bf16 v[150:153], a[84:87], v[190:193], v[150:153]
    s_waitcnt lgkmcnt(1)
    v_mul_f32 v200, v127, v200
    v_mul_f32 v201, v127, v201
    v_mfma_f32_16x16x32_bf16 v[150:153], a[88:91], v[226:229], v[150:153]
    v_cvt_pk_bf16_f32 v125, v200, v201
    v_mul_f32 v218, v127, v218
    v_mfma_f32_16x16x32_bf16 v[150:153], a[92:95], v[234:237], v[150:153]
    ds_write_b128 v3, v[122:125] offset:6144
    v_mfma_f32_16x16x32_bf16 v[122:125], a[116:119], v[234:237], 0
    v_mul_f32 v219, v127, v219
    v_cvt_pk_bf16_f32 v148, v218, v219
    v_mfma_f32_16x16x32_bf16 v[122:125], a[112:115], v[226:229], v[122:125]
    v_mul_f32 v220, v127, v220
    v_mul_f32 v221, v127, v221
    v_mfma_f32_16x16x32_bf16 v[122:125], a[108:111], v[190:193], v[122:125]
    v_cvt_pk_bf16_f32 v149, v220, v221
    v_fmac_f32 v254, v134, v134
    v_mfma_f32_16x16x32_bf16 v[122:125], a[104:107], v[206:209], v[122:125]
    v_rcp_f32_dpp v131, v130 quad_perm:[0,0,0,0] row_mask:0xf bank_mask:0xf
    v_mfma_f32_16x16x32_bf16 v[122:125], a[100:103], v[186:189], v[122:125]
    v_max3_u32 v25, v25, v130, v131
    v_mul_f32 v146, v146, v131
    v_mfma_f32_16x16x32_bf16 v[122:125], a[96:99], v[154:157], v[122:125]
    ds_write_b64 v4, v[148:149] offset:10240
    v_mfma_f32_16x16x32_bf16 v[126:129], a[120:123], v[154:157], 0
    v_mul_f32_dpp v146, v114, v131 quad_perm:[0,1,2,3] row_mask:0x2 bank_mask:0xf
    v_fmac_f32 v254, v135, v135
    v_mfma_f32_16x16x32_bf16 v[126:129], a[124:127], v[186:189], v[126:129]
    v_mul_f32_dpp v146, v118, v131 quad_perm:[0,1,2,3] row_mask:0x4 bank_mask:0xf
    v_cvt_pk_bf16_f32 v146, v146, v146
    v_mfma_f32_16x16x32_bf16 v[126:129], a[128:131], v[206:209], v[126:129]
    ds_write_b16 v7, v146
    v_mfma_f32_16x16x32_bf16 v[126:129], a[132:135], v[190:193], v[126:129]
    v_add_u32 v7, s76, v7
    v_fmac_f32 v254, v136, v136
    v_mfma_f32_16x16x32_bf16 v[126:129], a[136:139], v[226:229], v[126:129]
    v_fmac_f32 v254, v137, v137
    v_cvt_pk_bf16_f32 v146, v254, v255
    v_mfma_f32_16x16x32_bf16 v[126:129], a[140:143], v[234:237], v[126:129]
    ds_write_b64 v4, v[146:147] offset:18432
    v_mfma_f32_16x16x32_bf16 v[114:117], a[20:23], v[234:237], 0
    v_cvt_pk_f16_f32 v182, v150, v151
    v_pk_mul_f16 v139, v182, v182
    v_mfma_f32_16x16x32_bf16 v[114:117], a[16:19], v[226:229], v[114:117]
    v_cvt_pk_f16_f32 v183, v152, v153
    v_pk_fma_f16 v139, v183, v183, v139
    v_mfma_f32_16x16x32_bf16 v[114:117], a[12:15], v[190:193], v[114:117]
    v_cvt_pk_f16_f32 v184, v122, v123
    v_pk_fma_f16 v139, v184, v184, v139
    v_mfma_f32_16x16x32_bf16 v[114:117], a[8:11], v[206:209], v[114:117]
    v_cvt_pk_f16_f32 v185, v124, v125
    v_pk_fma_f16 v139, v185, v185, v139
    v_mfma_f32_16x16x32_bf16 v[114:117], a[4:7], v[186:189], v[114:117]
    v_cvt_pk_f16_f32 v168, v126, v127
    v_pk_fma_f16 v139, v168, v168, v139
    v_mfma_f32_16x16x32_bf16 v[114:117], a[0:3], v[154:157], v[114:117]
    v_cvt_pk_f16_f32 v169, v128, v129
    v_pk_fma_f16 v139, v169, v169, v139
    v_mfma_f32_16x16x32_bf16 v[118:121], a[24:27], v[154:157], 0
    s_waitcnt lgkmcnt(0)
    v_xor_b32 v2, 65536, v2
    v_xor_b32 v3, 65536, v3
    v_mfma_f32_16x16x32_bf16 v[118:121], a[28:31], v[186:189], v[118:121]
    s_nop 0
    v_cvt_pk_f16_f32 v130, v114, v115
    v_mfma_f32_16x16x32_bf16 v[118:121], a[32:35], v[206:209], v[118:121]
    s_nop 0
    v_pk_mul_f16 v138, v130, v130
    v_mfma_f32_16x16x32_bf16 v[118:121], a[36:39], v[190:193], v[118:121]
    s_barrier
    v_xor_b32 v4, 65536, v4
    v_mfma_f32_16x16x32_bf16 v[118:121], a[40:43], v[226:229], v[118:121]
    s_nop 0
    v_mfma_f32_16x16x32_bf16 v[118:121], a[44:47], v[234:237], v[118:121]
    s_cbranch_scc1 L_loop_fast2
    s_branch L_final_fast
.p2align 6
L_loop_fast3:
    v_mfma_f32_16x16x32_bf16 v[126:129], a[68:71], v[234:237], 0
    s_add_u32 s12, s40, s27
    ds_read_b128 v[150:153], v2 offset:18432
    v_cvt_pk_f16_f32 v131, v116, v117
    v_mfma_f32_16x16x32_bf16 v[126:129], a[64:67], v[226:229], v[126:129]
    s_addc_u32 s13, s41, 0
    ds_read_b128 v[114:117], v2 offset:19456
    v_pk_fma_f16 v138, v131, v131, v138
    v_mfma_f32_16x16x32_bf16 v[126:129], a[60:63], v[190:193], v[126:129]
    s_sub_u32 s14, s36, s27
    ds_read_b128 v[202:205], v5 offset:32
    v_cvt_pk_f16_f32 v132, v118, v119
    v_mfma_f32_16x16x32_bf16 v[126:129], a[56:59], v[206:209], v[126:129]
    s_cmp_ge_u32 s18, 2
    ds_read2_b64 v[210:213], v5 offset0:6 offset1:9
    v_pk_fma_f16 v138, v132, v132, v138
    v_mfma_f32_16x16x32_bf16 v[126:129], a[52:55], v[186:189], v[126:129]
    s_cselect_b32 s14, s14, 0
    ds_read_b128 v[122:125], v5
    v_cvt_pk_f16_f32 v133, v120, v121
    v_mfma_f32_16x16x32_bf16 v[126:129], a[48:51], v[154:157], v[126:129]
    s_sub_u32 s82, s72, s71
    ds_read_b32 v146, v6 offset:192
    v_pk_fma_f16 v138, v133, v133, v138
    v_mfma_f32_16x16x32_bf16 v[118:121], v[154:157], a[144:147], 0
    s_mul_i32 s74, s82, 336
    v_add_u32 v5, s74, v5
    s_mul_i32 s75, s82, 272
    v_mfma_f32_16x16x32_bf16 v[118:121], v[186:189], a[148:151], v[118:121]
    s_mul_i32 s76, s82, 16
    v_cvt_pk_f16_f32 v166, v126, v127
    v_pk_fma_f16 v138, v166, v166, v138
    v_mfma_f32_16x16x32_bf16 v[118:121], v[206:209], a[152:155], v[118:121]
    s_waitcnt lgkmcnt(5)
    v_cvt_pk_f16_f32 v167, v128, v129
    v_pk_fma_f16 v138, v167, v167, v138
    v_mfma_f32_16x16x32_bf16 v[118:121], v[190:193], a[156:159], v[118:121]
    s_add_u32 s34, s18, 2
    s_add_u32 s8, s60, s23
    s_addc_u32 s9, s61, 0
    v_mfma_f32_16x16x32_bf16 v[118:121], v[226:229], a[160:163], v[118:121]
    s_waitcnt lgkmcnt(3)
    ds_read_b128 v[218:221], v0 offset:26624
    v_pk_mul_f16 v141, v182, v202
    v_mfma_f32_16x16x32_bf16 v[118:121], v[234:237], a[164:167], v[118:121]
    s_sub_u32 s10, s36, s23
    ds_read_b128 v[222:225], v1 offset:26624
    v_pk_fma_f16 v141, v183, v203, v141
    v_mfma_f32_16x16x32_bf16 v[126:129], v[32:35], v[150:153], 0
    s_waitcnt lgkmcnt(3)
    v_pk_fma_f16 v141, v184, v204, v141
    v_pk_fma_f16 v141, v185, v205, v141
    v_mfma_f32_16x16x32_bf16 v[126:129], v[32:35], v[114:117], v[126:129]
    s_waitcnt lgkmcnt(2)
    v_mov_b32_dpp v146, v23 quad_perm:[0,1,2,3] row_mask:0x7 bank_mask:0xf
    v_pk_fma_f16 v141, v168, v212, v141
    v_mfma_f32_16x16x32_bf16 v[150:153], v[234:237], a[188:191], 0
    s_cmp_le_u32 s34, s45
    ds_read_b128 v[230:233], v0 offset:26752
    v_pk_fma_f16 v141, v169, v213, v141
    v_mfma_f32_16x16x32_bf16 v[150:153], v[226:229], a[184:187], v[150:153]
    s_cselect_b32 s10, s10, 0
    ds_read_b128 v[246:249], v1 offset:26752
    v_pk_mul_f16 v140, v130, v122
    v_mfma_f32_16x16x32_bf16 v[150:153], v[190:193], a[180:183], v[150:153]
    s_add_u32 m0, s28, 0
    ds_read_b128 v[242:245], v0 offset:26880
    v_pk_fma_f16 v140, v131, v123, v140
    v_mfma_f32_16x16x32_bf16 v[150:153], v[206:209], a[176:179], v[150:153]
    s_mov_b32 s27, s26
    ds_read_b128 v[194:197], v1 offset:26880
    v_pk_fma_f16 v140, v132, v124, v140
    v_mfma_f32_16x16x32_bf16 v[150:153], v[186:189], a[172:175], v[150:153]
    s_waitcnt lgkmcnt(5)
    v_pk_fma_f16 v140, v133, v125, v140
    v_pk_fma_f16 v140, v166, v210, v140
    v_mfma_f32_16x16x32_bf16 v[150:153], v[154:157], a[168:171], v[150:153]
    s_mov_b32 s26, s25
    v_pk_fma_f16 v140, v167, v211, v140
    v_cvt_pk_bf16_f32 v114, v118, v119
    v_mfma_f32_16x16x32_bf16 v[198:201], v[154:157], a[192:195], 0
    s_mov_b32 s25, s24
    v_cvt_pk_bf16_f32 v115, v120, v121
    v_mul_f32 v116, 0x3baaaaab, v126
    v_mfma_f32_16x16x32_bf16 v[198:201], v[186:189], a[196:199], v[198:201]
    s_mov_b32 s24, s23
    v_cvt_pk_bf16_f32 v118, v150, v151
    v_cvt_pk_bf16_f32 v119, v152, v153
    v_mfma_f32_16x16x32_bf16 v[198:201], v[206:209], a[200:203], v[198:201]
    s_mov_b32 s71, s72
    v_rsq_f32 v116, v116
    v_mfma_f32_16x16x32_bf16 v[198:201], v[190:193], a[204:207], v[198:201]
    s_mov_b32 s72, s73
    v_mul_f32 v147, 0x3baaaaab, v127
    v_mul_f32 v117, 0x3baaaaab, v128
    v_mfma_f32_16x16x32_bf16 v[198:201], v[226:229], a[208:211], v[198:201]
    s_waitcnt lgkmcnt(1)
    v_rsq_f32 v147, v147
    v_mfma_f32_16x16x32_bf16 v[198:201], v[234:237], a[212:215], v[198:201]
    s_waitcnt lgkmcnt(0)
    v_rsq_f32 v117, v117
    v_mfma_f32_16x16x32_f16 v[186:189], v[40:43], v[138:141], 0
    v_mul_f32 v178, v116, v178
    v_mul_f32 v179, v116, v179
    v_mfma_f32_16x16x32_bf16 v[138:141], a[72:75], v[218:221], 0
    v_cvt_pk_bf16_f32 v126, v178, v179
    v_mul_f32 v180, v116, v180
    v_mfma_f32_16x16x32_bf16 v[138:141], a[76:79], v[222:225], v[138:141]
    v_cvt_pk_bf16_f32 v150, v198, v199
    v_cvt_pk_bf16_f32 v151, v200, v201
    v_mfma_f32_16x16x32_bf16 v[138:141], a[80:83], v[230:233], v[138:141]
    v_rsq_f32 v186, v186
    v_mfma_f32_16x16x32_bf16 v[138:141], a[84:87], v[246:249], v[138:141]
    v_rsq_f32 v187, v187
    v_mfma_f32_16x16x32_bf16 v[138:141], a[88:91], v[242:245], v[138:141]
    v_mul_f32 v120, s31, v186
    v_cvt_pk_f16_f32 v121, v120, v187
    v_mfma_f32_16x16x32_bf16 v[138:141], a[92:95], v[194:197], v[138:141]
    v_mul_f32 v181, v116, v181
    v_cvt_pk_bf16_f32 v127, v180, v181
    v_mfma_f32_16x16x32_bf16 v[154:157], a[116:119], v[194:197], 0
    v_mul_f32 v142, v116, v142
    v_mul_f32 v143, v116, v143
    v_mfma_f32_16x16x32_bf16 v[154:157], a[112:115], v[242:245], v[154:157]
    v_cvt_pk_bf16_f32 v128, v142, v143
    v_mul_f32 v144, v116, v144
    v_mfma_f32_16x16x32_bf16 v[154:157], a[108:111], v[246:249], v[154:157]
    v_mul_f32 v145, v116, v145
    v_cvt_pk_bf16_f32 v129, v144, v145
    v_mfma_f32_16x16x32_bf16 v[154:157], a[104:107], v[230:233], v[154:157]
    v_mul_f32 v134, v116, v134
    v_mul_f32 v135, v116, v135
    v_mfma_f32_16x16x32_bf16 v[154:157], a[100:103], v[222:225], v[154:157]
    v_cvt_pk_bf16_f32 v148, v134, v135
    v_mul_f32 v136, v116, v136
    v_mfma_f32_16x16x32_bf16 v[154:157], a[96:99], v[218:221], v[154:157]
    buffer_store_dwordx4 v[126:129], v15, s[12:15], 0 offen nt
    v_mul_f32 v137, v116, v137
    v_cvt_pk_bf16_f32 v149, v136, v137
    v_fma_f32 v188, v188, v120, v22
    v_fmac_f32_dpp v146, v189, v187 quad_perm:[0,1,2,3] row_mask:0x1 bank_mask:0xf
    v_mfma_f32_16x16x32_bf16 v[126:129], a[120:123], v[218:221], 0
    v_pk_mul_f16 v182, v182, v121 op_sel:[0,1] op_sel_hi:[1,1]
    v_pk_mul_f16 v183, v183, v121 op_sel:[0,1] op_sel_hi:[1,1]
    v_mfma_f32_16x16x32_bf16 v[126:129], a[124:127], v[222:225], v[126:129]
    v_pk_mul_f16 v184, v184, v121 op_sel:[0,1] op_sel_hi:[1,1]
    v_pk_mul_f16 v185, v185, v121 op_sel:[0,1] op_sel_hi:[1,1]
    v_mfma_f32_16x16x32_bf16 v[126:129], a[128:131], v[230:233], v[126:129]
    v_pk_mul_f16 v168, v168, v121 op_sel:[0,1] op_sel_hi:[1,1]
    v_pk_mul_f16 v169, v169, v121 op_sel:[0,1] op_sel_hi:[1,1]
    v_mfma_f32_16x16x32_bf16 v[126:129], a[132:135], v[246:249], v[126:129]
    v_pk_mul_f16 v130, v130, v121 op_sel:[0,0] op_sel_hi:[1,0]
    v_pk_mul_f16 v131, v131, v121 op_sel:[0,0] op_sel_hi:[1,0]
    v_mfma_f32_16x16x32_bf16 v[126:129], a[136:139], v[242:245], v[126:129]
    v_pk_mul_f16 v132, v132, v121 op_sel:[0,0] op_sel_hi:[1,0]
    v_pk_mul_f16 v133, v133, v121 op_sel:[0,0] op_sel_hi:[1,0]
    v_mfma_f32_16x16x32_bf16 v[126:129], a[140:143], v[194:197], v[126:129]
    v_pk_mul_f16 v166, v166, v121 op_sel:[0,0] op_sel_hi:[1,0]
    v_pk_mul_f16 v167, v167, v121 op_sel:[0,0] op_sel_hi:[1,0]
    v_mfma_f32_16x16x32_bf16 v[134:137], a[20:23], v[194:197], 0
    v_max3_u32 v44, v44, v186, v187
    v_mul_f32 v170, v117, v170
    v_mfma_f32_16x16x32_bf16 v[134:137], a[16:19], v[242:245], v[134:137]
    v_mul_f32 v171, v117, v171
    v_cvt_pk_bf16_f32 v226, v170, v171
    v_mfma_f32_16x16x32_bf16 v[134:137], a[12:15], v[246:249], v[134:137]
    v_mul_f32 v172, v117, v172
    v_mul_f32 v173, v117, v173
    v_mfma_f32_16x16x32_bf16 v[134:137], a[8:11], v[230:233], v[134:137]
    v_cvt_pk_bf16_f32 v227, v172, v173
    v_mul_f32 v158, v117, v158
    v_mfma_f32_16x16x32_bf16 v[134:137], a[4:7], v[222:225], v[134:137]
    v_mul_f32 v159, v117, v159
    v_cvt_pk_bf16_f32 v228, v158, v159
    v_mfma_f32_16x16x32_bf16 v[134:137], a[0:3], v[218:221], v[134:137]
    v_mul_f32 v160, v117, v160
    v_mul_f32 v161, v117, v161
    v_mfma_f32_16x16x32_bf16 v[142:145], a[24:27], v[218:221], 0
    v_cvt_pk_bf16_f32 v229, v160, v161
    v_mul_f32 v238, v117, v238
    v_mfma_f32_16x16x32_bf16 v[142:145], a[28:31], v[222:225], v[142:145]
    v_mul_f32 v239, v117, v239
    v_cvt_pk_bf16_f32 v254, v238, v239
    v_mfma_f32_16x16x32_bf16 v[142:145], a[32:35], v[230:233], v[142:145]
    v_mul_f32 v240, v117, v240
    v_mul_f32 v241, v117, v241
    v_mfma_f32_16x16x32_bf16 v[142:145], a[36:39], v[246:249], v[142:145]
    v_cvt_pk_bf16_f32 v255, v240, v241
    v_cvt_pk_f16_f32 v190, v134, v135
    v_mfma_f32_16x16x32_bf16 v[142:145], a[40:43], v[242:245], v[142:145]
    v_pk_mul_f16 v158, v190, v190
    v_cvt_pk_f16_f32 v191, v136, v137
    v_mfma_f32_16x16x32_bf16 v[142:145], a[44:47], v[194:197], v[142:145]
    buffer_store_dwordx2 v[148:149], v18, s[12:15], 0 offen nt
    v_pk_fma_f16 v158, v191, v191, v158
    v_pk_mul_f16 v160, v190, v122
    v_mfma_f32_16x16x32_bf16 v[134:137], a[68:71], v[194:197], 0
    v_pk_fma_f16 v160, v191, v123, v160
    v_cvt_pk_f16_f32 v198, v138, v139
    v_mfma_f32_16x16x32_bf16 v[134:137], a[64:67], v[242:245], v[134:137]
    v_pk_mul_f16 v159, v198, v198
    v_cvt_pk_f16_f32 v192, v142, v143
    v_mfma_f32_16x16x32_bf16 v[134:137], a[60:63], v[246:249], v[134:137]
    v_pk_fma_f16 v158, v192, v192, v158
    v_cvt_pk_f16_f32 v193, v144, v145
    v_mfma_f32_16x16x32_bf16 v[134:137], a[56:59], v[230:233], v[134:137]
    v_pk_fma_f16 v158, v193, v193, v158
    v_pk_fma_f16 v160, v192, v124, v160
    v_mfma_f32_16x16x32_bf16 v[134:137], a[52:55], v[222:225], v[134:137]
    v_pk_fma_f16 v160, v193, v125, v160
    v_cvt_pk_f16_f32 v199, v140, v141
    v_mfma_f32_16x16x32_bf16 v[134:137], a[48:51], v[218:221], v[134:137]
    v_pk_fma_f16 v159, v199, v199, v159
    v_cvt_pk_f16_f32 v200, v154, v155
    v_mfma_f32_16x16x32_bf16 v[234:237], v[218:221], a[144:147], 0
    v_pk_fma_f16 v159, v200, v200, v159
    v_cvt_pk_f16_f32 v201, v156, v157
    v_mfma_f32_16x16x32_bf16 v[234:237], v[222:225], a[148:151], v[234:237]
    v_pk_fma_f16 v159, v201, v201, v159
    v_cvt_pk_f16_f32 v140, v126, v127
    v_mfma_f32_16x16x32_bf16 v[234:237], v[230:233], a[152:155], v[234:237]
    v_cvt_pk_f16_f32 v138, v134, v135
    v_pk_fma_f16 v158, v138, v138, v158
    v_mfma_f32_16x16x32_bf16 v[234:237], v[246:249], a[156:159], v[234:237]
    v_cvt_pk_f16_f32 v139, v136, v137
    v_pk_fma_f16 v158, v139, v139, v158
    v_mfma_f32_16x16x32_bf16 v[234:237], v[242:245], a[160:163], v[234:237]
    ds_read_b128 v[142:145], v0 offset:32768
    v_pk_fma_f16 v160, v138, v210, v160
    v_mfma_f32_16x16x32_bf16 v[234:237], v[194:197], a[164:167], v[234:237]
    ds_read_b128 v[178:181], v1 offset:32768
    v_pk_fma_f16 v160, v139, v211, v160
    v_mfma_f32_16x16x32_bf16 v[238:241], v[194:197], a[188:191], 0
    ds_read_b128 v[154:157], v0 offset:32896
    v_pk_fma_f16 v159, v140, v140, v159
    v_mfma_f32_16x16x32_bf16 v[238:241], v[242:245], a[184:187], v[238:241]
    ds_read_b128 v[170:173], v1 offset:32896
    v_cvt_pk_f16_f32 v141, v128, v129
    v_mfma_f32_16x16x32_bf16 v[238:241], v[246:249], a[180:183], v[238:241]
    ds_read_b128 v[206:209], v0 offset:33024
    v_cvt_pk_bf16_f32 v116, v234, v235
    v_mfma_f32_16x16x32_bf16 v[238:241], v[230:233], a[176:179], v[238:241]
    ds_read_b128 v[134:137], v1 offset:33024
    v_cvt_pk_bf16_f32 v117, v236, v237
    v_mfma_f32_16x16x32_bf16 v[238:241], v[222:225], a[172:175], v[238:241]
    v_pk_fma_f16 v159, v141, v141, v159
    v_pk_mul_f16 v161, v198, v202
    v_mfma_f32_16x16x32_bf16 v[238:241], v[218:221], a[168:171], v[238:241]
    buffer_store_dwordx4 v[226:229], v17, s[12:15], 0 offen nt
    v_pk_fma_f16 v161, v199, v203, v161
    v_pk_fma_f16 v161, v200, v204, v161
    v_pk_fma_f16 v161, v201, v205, v161
    v_pk_fma_f16 v161, v140, v212, v161
    v_mfma_f32_16x16x32_bf16 v[126:129], v[218:221], a[192:195], 0
    s_waitcnt lgkmcnt(4)
    v_pk_fma_f16 v161, v141, v213, v161
    v_cvt_pk_bf16_f32 v120, v238, v239
    v_mfma_f32_16x16x32_bf16 v[126:129], v[222:225], a[196:199], v[126:129]
    s_waitcnt lgkmcnt(3)
    v_cvt_pk_bf16_f32 v121, v240, v241
    v_mul_f32 v174, v147, v174
    v_mfma_f32_16x16x32_bf16 v[126:129], v[230:233], a[200:203], v[126:129]
    s_waitcnt lgkmcnt(2)
    v_exp_f32 v188, v188
    v_mfma_f32_16x16x32_bf16 v[126:129], v[246:249], a[204:207], v[126:129]
    s_waitcnt vmcnt(3)
    ds_write_b16 v8, v45 offset:512
    v_mfma_f32_16x16x32_bf16 v[126:129], v[242:245], a[208:211], v[126:129]
    s_waitcnt lgkmcnt(1)
    v_cvt_pk_bf16_f32 v39, v188, 0
    v_mfma_f32_16x16x32_bf16 v[126:129], v[194:197], a[212:215], v[126:129]
    v_mul_f32 v175, v147, v175
    v_cvt_pk_bf16_f32 v174, v174, v175
    v_mfma_f32_16x16x32_f16 v[186:189], v[40:43], v[158:161], 0
    v_mul_f32 v176, v147, v176
    v_mul_f32 v177, v147, v177
    v_mfma_f32_16x16x32_bf16 v[158:161], a[72:75], v[142:145], 0
    v_cvt_pk_bf16_f32 v175, v176, v177
    v_mul_f32 v162, v147, v162
    v_mfma_f32_16x16x32_bf16 v[158:161], a[76:79], v[178:181], v[158:161]
    v_cvt_pk_bf16_f32 v152, v126, v127
    v_cvt_pk_bf16_f32 v153, v128, v129
    v_mfma_f32_16x16x32_bf16 v[158:161], a[80:83], v[154:157], v[158:161]
    v_rsq_f32 v186, v186
    v_mfma_f32_16x16x32_bf16 v[158:161], a[84:87], v[170:173], v[158:161]
    v_rsq_f32 v187, v187
    v_mfma_f32_16x16x32_bf16 v[158:161], a[88:91], v[206:209], v[158:161]
    s_waitcnt lgkmcnt(0)
    v_mul_f32 v148, s31, v186
    v_cvt_pk_f16_f32 v149, v148, v187
    v_mfma_f32_16x16x32_bf16 v[158:161], a[92:95], v[134:137], v[158:161]
    v_fma_f32 v188, v188, v148, v24
    v_mfma_f32_16x16x32_bf16 v[126:129], a[116:119], v[134:137], 0
    v_fmac_f32_dpp v146, v189, v187 quad_perm:[0,1,2,3] row_mask:0x2 bank_mask:0xf
    v_mfma_f32_16x16x32_bf16 v[126:129], a[112:115], v[206:209], v[126:129]
    v_pk_mul_f16 v198, v198, v149 op_sel:[0,1] op_sel_hi:[1,1]
    v_mfma_f32_16x16x32_bf16 v[126:129], a[108:111], v[170:173], v[126:129]
    s_barrier
    buffer_load_dwordx4 v10, s[8:11], 0 offen nt lds
    v_mfma_f32_16x16x32_bf16 v[126:129], a[104:107], v[154:157], v[126:129]
    s_add_u32 m0, s28, 4096
    ds_read_u16 v148, v9 offset:128
    v_pk_mul_f16 v199, v199, v149 op_sel:[0,1] op_sel_hi:[1,1]
    v_mfma_f32_16x16x32_bf16 v[126:129], a[100:103], v[178:181], v[126:129]
    v_pk_mul_f16 v200, v200, v149 op_sel:[0,1] op_sel_hi:[1,1]
    v_pk_mul_f16 v201, v201, v149 op_sel:[0,1] op_sel_hi:[1,1]
    v_mfma_f32_16x16x32_bf16 v[126:129], a[96:99], v[142:145], v[126:129]
    v_pk_mul_f16 v140, v140, v149 op_sel:[0,1] op_sel_hi:[1,1]
    v_pk_mul_f16 v141, v141, v149 op_sel:[0,1] op_sel_hi:[1,1]
    v_mfma_f32_16x16x32_bf16 v[194:197], a[120:123], v[142:145], 0
    v_pk_mul_f16 v190, v190, v149 op_sel:[0,0] op_sel_hi:[1,0]
    v_pk_mul_f16 v191, v191, v149 op_sel:[0,0] op_sel_hi:[1,0]
    v_mfma_f32_16x16x32_bf16 v[194:197], a[124:127], v[178:181], v[194:197]
    buffer_load_dwordx4 v11, s[8:11], 0 offen nt lds
    v_pk_mul_f16 v192, v192, v149 op_sel:[0,0] op_sel_hi:[1,0]
    v_mfma_f32_16x16x32_bf16 v[194:197], a[128:131], v[154:157], v[194:197]
    s_add_u32 m0, s28, 8192
    v_pk_mul_f16 v193, v193, v149 op_sel:[0,0] op_sel_hi:[1,0]
    v_pk_mul_f16 v138, v138, v149 op_sel:[0,0] op_sel_hi:[1,0]
    v_mfma_f32_16x16x32_bf16 v[194:197], a[132:135], v[170:173], v[194:197]
    v_pk_mul_f16 v139, v139, v149 op_sel:[0,0] op_sel_hi:[1,0]
    v_max3_u32 v44, v44, v186, v187
    v_mfma_f32_16x16x32_bf16 v[194:197], a[136:139], v[206:209], v[194:197]
    v_cvt_pk_f16_f32 v218, v158, v159
    v_pk_mul_f16 v159, v218, v218
    v_mfma_f32_16x16x32_bf16 v[194:197], a[140:143], v[134:137], v[194:197]
    s_waitcnt lgkmcnt(0)
    v_readfirstlane_b32 s77, v148
    v_cvt_pk_f16_f32 v219, v160, v161
    v_mfma_f32_16x16x32_bf16 v[222:225], a[20:23], v[134:137], 0
    buffer_load_dwordx4 v12, s[8:11], 0 offen nt lds
    v_pk_fma_f16 v159, v219, v219, v159
    v_mfma_f32_16x16x32_bf16 v[222:225], a[16:19], v[206:209], v[222:225]
    s_add_u32 m0, s28, 12288
    v_cvt_pk_f16_f32 v220, v126, v127
    v_pk_fma_f16 v159, v220, v220, v159
    v_mfma_f32_16x16x32_bf16 v[222:225], a[12:15], v[170:173], v[222:225]
    s_xor_b32 s28, s28, 65536
    v_cvt_pk_f16_f32 v221, v128, v129
    v_pk_fma_f16 v159, v221, v221, v159
    v_mfma_f32_16x16x32_bf16 v[222:225], a[8:11], v[154:157], v[222:225]
    s_mul_i32 s78, s77, 2688
    v_cvt_pk_f16_f32 v128, v194, v195
    v_pk_fma_f16 v159, v128, v128, v159
    v_mfma_f32_16x16x32_bf16 v[222:225], a[4:7], v[178:181], v[222:225]
    v_cvt_pk_f16_f32 v129, v196, v197
    v_pk_fma_f16 v159, v129, v129, v159
    v_mfma_f32_16x16x32_bf16 v[222:225], a[0:3], v[142:145], v[222:225]
    buffer_load_dwordx4 v13, s[8:11], 0 offen nt lds
    v_pk_mul_f16 v161, v218, v202
    v_mfma_f32_16x16x32_bf16 v[194:197], a[24:27], v[142:145], 0
    s_mov_b32 m0, s29
    v_pk_fma_f16 v161, v219, v203, v161
    v_pk_fma_f16 v161, v220, v204, v161
    v_mfma_f32_16x16x32_bf16 v[194:197], a[28:31], v[178:181], v[194:197]
    s_xor_b32 s29, s29, s30
    v_cvt_pk_f16_f32 v202, v222, v223
    v_pk_mul_f16 v158, v202, v202
    v_mfma_f32_16x16x32_bf16 v[194:197], a[32:35], v[154:157], v[194:197]
    s_add_u32 s19, s19, s20
    ds_read2_b32 v[228:229], v6 offset0:0 offset1:0
    v_cvt_pk_f16_f32 v203, v224, v225
    v_mfma_f32_16x16x32_bf16 v[194:197], a[36:39], v[170:173], v[194:197]
    s_add_u32 s23, s23, s21
    ds_read2_b32 v[224:225], v6 offset0:16 offset1:16
    v_pk_fma_f16 v158, v203, v203, v158
    v_mfma_f32_16x16x32_bf16 v[194:197], a[40:43], v[206:209], v[194:197]
    ds_read2_b32 v[232:233], v6 offset0:32 offset1:32
    v_mfma_f32_16x16x32_bf16 v[194:197], a[44:47], v[134:137], v[194:197]
    s_cmp_ge_u32 s19, 72
    v_pk_mul_f16 v160, v202, v122
    v_pk_fma_f16 v160, v203, v123, v160
    v_mfma_f32_16x16x32_bf16 v[234:237], a[68:71], v[134:137], 0
    s_cselect_b32 s34, 72, 0
    v_pk_fma_f16 v161, v221, v205, v161
    v_pk_fma_f16 v161, v128, v212, v161
    v_mfma_f32_16x16x32_bf16 v[234:237], a[64:67], v[206:209], v[234:237]
    s_cselect_b32 s35, s22, 0
    v_cvt_pk_f16_f32 v204, v194, v195
    v_pk_fma_f16 v158, v204, v204, v158
    v_mfma_f32_16x16x32_bf16 v[234:237], a[60:63], v[170:173], v[234:237]
    s_sub_u32 s19, s19, s34
    v_cvt_pk_f16_f32 v205, v196, v197
    v_pk_fma_f16 v158, v205, v205, v158
    v_mfma_f32_16x16x32_bf16 v[234:237], a[56:59], v[154:157], v[234:237]
    s_add_u32 s23, s23, s35
    v_pk_fma_f16 v160, v204, v124, v160
    v_pk_fma_f16 v160, v205, v125, v160
    v_mfma_f32_16x16x32_bf16 v[234:237], a[52:55], v[178:181], v[234:237]
    s_add_u32 s78, s78, s69
    v_pk_fma_f16 v161, v129, v213, v161
    v_mul_f32 v163, v147, v163
    v_mfma_f32_16x16x32_bf16 v[234:237], a[48:51], v[142:145], v[234:237]
    s_waitcnt lgkmcnt(1)
    buffer_store_dwordx2 v[254:255], v20, s[12:15], 0 offen nt
    v_exp_f32 v188, v188
    v_mfma_f32_16x16x32_bf16 v[122:125], v[142:145], a[144:147], 0
    s_add_u32 s80, s77, s68
    v_cvt_pk_bf16_f32 v176, v162, v163
    v_mul_f32 v164, v147, v164
    v_mfma_f32_16x16x32_bf16 v[122:125], v[178:181], a[148:151], v[122:125]
    s_cmp_ge_u32 s80, 72
    v_cvt_pk_f16_f32 v126, v234, v235
    v_pk_fma_f16 v158, v126, v126, v158
    v_mfma_f32_16x16x32_bf16 v[122:125], v[154:157], a[152:155], v[122:125]
    s_cselect_b32 s80, s22, 0
    v_cvt_pk_f16_f32 v127, v236, v237
    v_pk_fma_f16 v158, v127, v127, v158
    v_mfma_f32_16x16x32_bf16 v[122:125], v[170:173], a[156:159], v[122:125]
    s_add_u32 s78, s78, s80
    v_pk_fma_f16 v160, v126, v210, v160
    v_pk_fma_f16 v160, v127, v211, v160
    v_mfma_f32_16x16x32_bf16 v[122:125], v[206:209], a[160:163], v[122:125]
    s_add_u32 s80, s77, 20
    v_mul_f32 v165, v147, v165
    v_cvt_pk_bf16_f32 v177, v164, v165
    v_mfma_f32_16x16x32_bf16 v[122:125], v[134:137], a[164:167], v[122:125]
    s_add_u32 s34, s18, 3
    ds_read_b128 v[194:197], v2 offset:0
    v_mul_f32 v214, v147, v214
    v_mfma_f32_16x16x32_f16 v[162:165], v[40:43], v[158:161], 0
    s_cmp_lt_u32 s77, s62
    v_mul_f32 v215, v147, v215
    v_cvt_pk_bf16_f32 v254, v214, v215
    v_mfma_f32_16x16x32_bf16 v[210:213], v[134:137], a[188:191], 0
    s_cselect_b32 s79, 1, 0
    ds_read_b128 v[158:161], v2 offset:1024
    v_cvt_pk_bf16_f32 v226, v122, v123
    v_mfma_f32_16x16x32_bf16 v[210:213], v[206:209], a[184:187], v[210:213]
    s_cselect_b32 s78, s78, 0
    ds_read_b128 v[234:237], v2 offset:2048
    v_cvt_pk_bf16_f32 v227, v124, v125
    v_mfma_f32_16x16x32_bf16 v[210:213], v[170:173], a[180:183], v[210:213]
    s_cmp_lt_u32 s34, s17
    ds_read_b128 v[122:125], v2 offset:3072
    v_mul_f32 v216, v147, v216
    v_mfma_f32_16x16x32_bf16 v[210:213], v[154:157], a[176:179], v[210:213]
    s_cselect_b32 s23, s23, s78
    ds_read_b128 v[238:241], v2 offset:4096
    v_mul_f32 v217, v147, v217
    v_mfma_f32_16x16x32_bf16 v[210:213], v[178:181], a[172:175], v[210:213]
    s_cselect_b32 s73, s34, s80
    ds_read_b128 v[242:245], v2 offset:5120
    v_cvt_pk_bf16_f32 v255, v216, v217
    v_mfma_f32_16x16x32_bf16 v[210:213], v[142:145], a[168:171], v[210:213]
    s_cselect_b32 s79, 0, s79
    v_rsq_f32 v162, v162
    v_mfma_f32_16x16x32_bf16 v[214:217], v[142:145], a[192:195], 0
    s_waitcnt lgkmcnt(5)
    v_rsq_f32 v163, v163
    v_mfma_f32_16x16x32_bf16 v[214:217], v[178:181], a[196:199], v[214:217]
    s_cselect_b32 s81, 0, 1
    v_mul_f32 v148, s31, v162
    v_cvt_pk_f16_f32 v149, v148, v163
    v_mfma_f32_16x16x32_bf16 v[214:217], v[154:157], a[200:203], v[214:217]
    s_add_u32 s80, s77, 1
    v_fma_f32 v164, v164, v148, v26
    v_fmac_f32_dpp v146, v165, v163 quad_perm:[0,1,2,3] row_mask:0x4 bank_mask:0xf
    v_mfma_f32_16x16x32_bf16 v[214:217], v[170:173], a[204:207], v[214:217]
    s_mul_i32 s80, s80, s81
    v_cvt_pk_bf16_f32 v222, v210, v211
    v_cvt_pk_bf16_f32 v223, v212, v213
    v_mfma_f32_16x16x32_bf16 v[214:217], v[206:209], a[208:211], v[214:217]
    s_cmp_lt_u32 s80, s62
    v_pk_mul_f16 v218, v218, v149 op_sel:[0,1] op_sel_hi:[1,1]
    v_pk_mul_f16 v219, v219, v149 op_sel:[0,1] op_sel_hi:[1,1]
    v_mfma_f32_16x16x32_bf16 v[214:217], v[134:137], a[212:215], v[214:217]
    s_waitcnt lgkmcnt(1)
    buffer_store_dwordx4 v[174:177], v16, s[12:15], 0 offen nt
    v_pk_mul_f16 v220, v220, v149 op_sel:[0,1] op_sel_hi:[1,1]
    v_pk_mul_f16 v221, v221, v149 op_sel:[0,1] op_sel_hi:[1,1]
    v_pk_mul_f16 v128, v128, v149 op_sel:[0,1] op_sel_hi:[1,1]
    v_pk_mul_f16 v129, v129, v149 op_sel:[0,1] op_sel_hi:[1,1]
    v_mfma_f32_16x16x32_f16 v[134:137], v[182:185], v[130:133], v[46:49]
    s_waitcnt lgkmcnt(0)
    v_cvt_pk_bf16_f32 v230, v214, v215
    v_cvt_pk_bf16_f32 v231, v216, v217
    v_mfma_f32_16x16x32_f16 v[142:145], v[198:201], v[130:133], v[50:53]
    s_cselect_b32 s62, s62, 0
    v_pk_mul_f16 v202, v202, v149 op_sel:[0,0] op_sel_hi:[1,0]
    v_pk_mul_f16 v203, v203, v149 op_sel:[0,0] op_sel_hi:[1,0]
    v_mfma_f32_16x16x32_f16 v[154:157], v[218:221], v[130:133], v[54:57]
    s_add_u32 s80, s18, 4
    v_pk_mul_f16 v204, v204, v149 op_sel:[0,0] op_sel_hi:[1,0]
    v_pk_mul_f16 v205, v205, v149 op_sel:[0,0] op_sel_hi:[1,0]
    v_pk_mul_f16 v126, v126, v149 op_sel:[0,0] op_sel_hi:[1,0]
    v_mfma_f32_16x16x16_f16 v[134:137], v[168:169], v[166:167], v[134:137]
    v_pk_mul_f16 v127, v127, v149 op_sel:[0,0] op_sel_hi:[1,0]
    v_max3_u32 v44, v44, v162, v163
    v_add_u32 v6, s75, v6
    v_mfma_f32_16x16x16_f16 v[142:145], v[140:141], v[166:167], v[142:145]
    v_exp_f32 v146, v146
    v_xor_b32 v0, 65536, v0
    v_mfma_f32_16x16x16_f16 v[154:157], v[128:129], v[166:167], v[154:157]
    v_cvt_pk_bf16_f32 v146, v146, v146
    v_exp_f32 v134, v134
    v_xor_b32 v1, 65536, v1
    v_mfma_f32_16x16x32_f16 v[130:133], v[182:185], v[190:193], v[58:61]
    s_cmp_ge_u32 s80, s17
    ds_write_b16 v8, v146
    v_mfma_f32_16x16x32_f16 v[146:149], v[198:201], v[190:193], v[62:65]
    s_cselect_b32 s66, s62, 0
    v_exp_f32 v135, v135
    v_mfma_f32_16x16x32_f16 v[170:173], v[218:221], v[190:193], v[66:69]
    s_lshl_b32 s80, s79, s73
    v_cvt_pk_bf16_f32 v134, v134, v135
    v_exp_f32 v136, v136
    v_mfma_f32_16x16x16_f16 v[130:133], v[168:169], v[138:139], v[130:133]
    v_exp_f32 v137, v137
    s_or_b32 s70, s70, s80
    v_mfma_f32_16x16x16_f16 v[146:149], v[140:141], v[138:139], v[146:149]
    v_cvt_pk_bf16_f32 v135, v136, v137
    v_exp_f32 v142, v142
    v_mfma_f32_16x16x16_f16 v[170:173], v[128:129], v[138:139], v[170:173]
    v_exp_f32 v143, v143
    v_exp_f32 v144, v144
    v_mfma_f32_16x16x32_bf16 v[178:181], a[216:219], v[194:197], 0
    s_add_u32 s45, s45, s79
    v_exp_f32 v145, v145
    v_mfma_f32_16x16x32_bf16 v[178:181], a[220:223], v[158:161], v[178:181]
    s_add_u32 s18, s18, 1
    v_cvt_pk_bf16_f32 v136, v142, v143
    v_cvt_pk_bf16_f32 v137, v144, v145
    v_mfma_f32_16x16x32_bf16 v[178:181], a[224:227], v[234:237], v[178:181]
    s_cmp_lt_u32 s18, s45
    v_exp_f32 v154, v154
    v_mfma_f32_16x16x32_bf16 v[178:181], a[228:231], v[122:125], v[178:181]
    v_mfma_f32_16x16x32_bf16 v[178:181], a[232:235], v[238:241], v[178:181]
    v_exp_f32 v155, v155
    v_mfma_f32_16x16x32_bf16 v[178:181], a[236:239], v[242:245], v[178:181]
    buffer_store_dwordx2 v[254:255], v19, s[12:15], 0 offen nt
    v_exp_f32 v156, v156
    v_mfma_f32_16x16x32_bf16 v[142:145], v[86:89], v[242:245], 0
    v_exp_f32 v157, v157
    v_mfma_f32_16x16x32_bf16 v[142:145], v[82:85], v[238:241], v[142:145]
    v_cvt_pk_bf16_f32 v36, v154, v155
    v_cvt_pk_bf16_f32 v37, v156, v157
    v_mfma_f32_16x16x32_bf16 v[142:145], a[252:255], v[122:125], v[142:145]
    v_exp_f32 v164, v164
    v_mfma_f32_16x16x32_bf16 v[142:145], a[248:251], v[234:237], v[142:145]
    ds_read_b128 v[154:157], v2 offset:11264
    v_fma_f32 v254, v178, v178, s33
    v_mfma_f32_16x16x32_bf16 v[142:145], a[244:247], v[158:161], v[142:145]
    ds_read_b128 v[206:209], v2 offset:10240
    v_fmac_f32 v254, v179, v179
    v_mfma_f32_16x16x32_bf16 v[142:145], a[240:243], v[194:197], v[142:145]
    ds_read_b128 v[210:213], v2 offset:9216
    v_fmac_f32 v254, v180, v180
    v_mfma_f32_16x16x32_bf16 v[190:193], v[28:31], v[36:39], 0
    v_exp_f32 v130, v130
    v_mfma_f32_16x16x32_bf16 v[190:193], v[28:31], v[134:137], v[190:193]
    v_exp_f32 v131, v131
    v_mfma_f32_16x16x32_bf16 v[174:177], v[114:117], v[134:137], 0
    v_cvt_pk_bf16_f32 v130, v130, v131
    v_fmac_f32 v254, v181, v181
    v_mfma_f32_16x16x32_bf16 v[174:177], v[226:229], v[36:39], v[174:177]
    v_exp_f32 v132, v132
    v_mfma_f32_16x16x32_bf16 v[246:249], v[222:225], v[36:39], 0
    v_exp_f32 v133, v133
    v_mfma_f32_16x16x32_bf16 v[246:249], v[118:121], v[134:137], v[246:249]
    s_waitcnt lgkmcnt(2)
    v_cvt_pk_bf16_f32 v131, v132, v133
    v_fmac_f32 v254, v142, v142
    v_mfma_f32_16x16x32_bf16 v[250:253], v[150:153], v[134:137], 0
    s_waitcnt lgkmcnt(1)
    v_exp_f32 v146, v146
    v_mfma_f32_16x16x32_bf16 v[250:253], v[230:233], v[36:39], v[250:253]
    s_waitcnt lgkmcnt(0)
    v_exp_f32 v147, v147
    v_mfma_f32_16x16x32_bf16 v[134:137], v[90:93], v[194:197], 0
    ds_read_b128 v[194:197], v2 offset:8192
    v_cvt_pk_bf16_f32 v132, v146, v147
    v_mfma_f32_16x16x32_bf16 v[134:137], v[94:97], v[158:161], v[134:137]
    ds_read_b128 v[158:161], v2 offset:7168
    v_cvt_pk_bf16_f32 v39, v188, 0
    v_mfma_f32_16x16x32_bf16 v[134:137], v[98:101], v[234:237], v[134:137]
    ds_read_b128 v[186:189], v2 offset:6144
    v_fmac_f32 v254, v143, v143
    v_mfma_f32_16x16x32_bf16 v[134:137], v[102:105], v[122:125], v[134:137]
    v_exp_f32 v148, v148
    v_mfma_f32_16x16x32_bf16 v[134:137], v[106:109], v[238:241], v[134:137]
    v_exp_f32 v149, v149
    v_mfma_f32_16x16x32_bf16 v[134:137], v[110:113], v[242:245], v[134:137]
    v_cvt_pk_bf16_f32 v133, v148, v149
    v_fmac_f32 v254, v144, v144
    v_mfma_f32_16x16x32_f16 v[214:217], v[182:185], v[202:205], v[70:73]
    v_exp_f32 v170, v170
    v_mfma_f32_16x16x32_f16 v[146:149], v[198:201], v[202:205], v[74:77]
    v_exp_f32 v171, v171
    v_mfma_f32_16x16x32_f16 v[122:125], v[218:221], v[202:205], v[78:81]
    s_waitcnt lgkmcnt(2)
    v_cvt_pk_bf16_f32 v36, v170, v171
    v_exp_f32 v172, v172
    v_mfma_f32_16x16x16_f16 v[214:217], v[168:169], v[126:127], v[214:217]
    v_exp_f32 v173, v173
    v_fmac_f32 v254, v145, v145
    v_mfma_f32_16x16x16_f16 v[146:149], v[140:141], v[126:127], v[146:149]
    v_cvt_pk_bf16_f32 v37, v172, v173
    v_rcp_f32 v191, v190
    v_mfma_f32_16x16x16_f16 v[122:125], v[128:129], v[126:127], v[122:125]
    v_max3_u32 v25, v25, v191, v190
    v_mul_f32 v174, v191, v174
    v_exp_f32 v214, v214
    v_mfma_f32_16x16x32_bf16 v[126:129], v[28:31], v[36:39], 0
    s_waitcnt lgkmcnt(0)
    v_exp_f32 v215, v215
    v_mfma_f32_16x16x32_bf16 v[126:129], v[28:31], v[130:133], v[126:129]
    v_cvt_pk_bf16_f32 v170, v214, v215
    v_mul_f32 v175, v191, v175
    v_mfma_f32_16x16x32_bf16 v[138:141], v[114:117], v[130:133], 0
    v_exp_f32 v216, v216
    v_mfma_f32_16x16x32_bf16 v[138:141], v[226:229], v[36:39], v[138:141]
    ds_read_b128 v[166:169], v9
    v_cvt_pk_bf16_f32 v202, v174, v175
    v_mfma_f32_16x16x32_bf16 v[198:201], v[222:225], v[36:39], 0
    ds_read_b128 v[182:185], v9 offset:64
    v_mul_f32 v176, v191, v176
    v_mfma_f32_16x16x32_bf16 v[198:201], v[118:121], v[130:133], v[198:201]
    v_exp_f32 v217, v217
    v_mfma_f32_16x16x32_bf16 v[218:221], v[150:153], v[130:133], 0
    v_cvt_pk_bf16_f32 v171, v216, v217
    v_mul_f32 v177, v191, v177
    v_mfma_f32_16x16x32_bf16 v[218:221], v[230:233], v[36:39], v[218:221]
    v_exp_f32 v146, v146
    v_mfma_f32_16x16x32_bf16 v[214:217], v[110:113], v[154:157], 0
    v_exp_f32 v147, v147
    v_mfma_f32_16x16x32_bf16 v[214:217], v[106:109], v[206:209], v[214:217]
    v_cvt_pk_bf16_f32 v172, v146, v147
    v_cvt_pk_bf16_f32 v39, v164, 0
    v_mfma_f32_16x16x32_bf16 v[214:217], v[102:105], v[210:213], v[214:217]
    v_exp_f32 v148, v148
    v_mfma_f32_16x16x32_bf16 v[214:217], v[98:101], v[194:197], v[214:217]
    s_waitcnt lgkmcnt(1)
    v_exp_f32 v149, v149
    v_mfma_f32_16x16x32_bf16 v[214:217], v[94:97], v[158:161], v[214:217]
    s_waitcnt lgkmcnt(0)
    v_cvt_pk_bf16_f32 v173, v148, v149
    v_cvt_pk_bf16_f32 v203, v176, v177
    v_mfma_f32_16x16x32_bf16 v[214:217], v[90:93], v[186:189], v[214:217]
    v_exp_f32 v122, v122
    v_mfma_f32_16x16x32_bf16 v[162:165], a[240:243], v[186:189], 0
    v_exp_f32 v123, v123
    v_mfma_f32_16x16x32_bf16 v[162:165], a[244:247], v[158:161], v[162:165]
    v_cvt_pk_bf16_f32 v36, v122, v123
    v_mul_f32 v246, v191, v246
    v_mfma_f32_16x16x32_bf16 v[162:165], a[248:251], v[194:197], v[162:165]
    v_exp_f32 v124, v124
    v_mfma_f32_16x16x32_bf16 v[162:165], a[252:255], v[210:213], v[162:165]
    ds_read_b128 v[130:133], v2 offset:12288
    v_fma_f32 v255, v214, v214, s33
    v_mfma_f32_16x16x32_bf16 v[162:165], v[82:85], v[206:209], v[162:165]
    ds_read_b128 v[146:149], v2 offset:13312
    v_fmac_f32 v255, v215, v215
    v_mfma_f32_16x16x32_bf16 v[162:165], v[86:89], v[154:157], v[162:165]
    ds_read_b128 v[234:237], v2 offset:14336
    v_fmac_f32 v255, v216, v216
    v_mfma_f32_16x16x32_bf16 v[174:177], a[236:239], v[154:157], 0
    ds_read_b128 v[154:157], v2 offset:15360
    v_fmac_f32 v255, v217, v217
    v_mfma_f32_16x16x32_bf16 v[174:177], a[232:235], v[206:209], v[174:177]
    ds_read_b128 v[206:209], v2 offset:16384
    v_mul_f32 v247, v191, v247
    v_mfma_f32_16x16x32_bf16 v[174:177], a[228:231], v[210:213], v[174:177]
    ds_read_b128 v[210:213], v2 offset:17408
    v_fmac_f32 v255, v162, v162
    v_mfma_f32_16x16x32_bf16 v[174:177], a[224:227], v[194:197], v[174:177]
    v_exp_f32 v125, v125
    v_mfma_f32_16x16x32_bf16 v[174:177], a[220:223], v[158:161], v[174:177]
    v_cvt_pk_bf16_f32 v37, v124, v125
    v_fmac_f32 v255, v163, v163
    v_mfma_f32_16x16x32_bf16 v[174:177], a[216:219], v[186:189], v[174:177]
    s_waitcnt lgkmcnt(5)
    v_fmac_f32 v255, v164, v164
    v_fmac_f32 v255, v165, v165
    v_mfma_f32_16x16x32_bf16 v[122:125], v[28:31], v[36:39], 0
    s_waitcnt lgkmcnt(4)
    v_cvt_pk_bf16_f32 v204, v246, v247
    v_mul_f32 v248, v191, v248
    v_mfma_f32_16x16x32_bf16 v[122:125], v[28:31], v[170:173], v[122:125]
    s_waitcnt lgkmcnt(3)
    v_fmac_f32 v255, v174, v174
    v_fmac_f32 v255, v175, v175
    v_mfma_f32_16x16x32_bf16 v[158:161], v[114:117], v[170:173], 0
    s_waitcnt lgkmcnt(2)
    v_fmac_f32 v255, v176, v176
    v_fmac_f32 v255, v177, v177
    v_mfma_f32_16x16x32_bf16 v[158:161], v[226:229], v[36:39], v[158:161]
    s_waitcnt lgkmcnt(1)
    v_rcp_f32 v123, v122
    v_mfma_f32_16x16x32_bf16 v[186:189], v[222:225], v[36:39], 0
    s_waitcnt lgkmcnt(0)
    v_mul_f32 v249, v191, v249
    v_cvt_pk_bf16_f32 v205, v248, v249
    v_mfma_f32_16x16x32_bf16 v[186:189], v[118:121], v[170:173], v[186:189]
    ds_write_b128 v3, v[202:205] offset:0
    v_mfma_f32_16x16x32_bf16 v[194:197], v[150:153], v[170:173], 0
    v_mul_f32 v158, v123, v158
    v_mul_f32 v159, v123, v159
    v_mfma_f32_16x16x32_bf16 v[194:197], v[230:233], v[36:39], v[194:197]
    v_cvt_pk_bf16_f32 v158, v158, v159
    v_mul_f32 v160, v123, v160
    v_mfma_f32_16x16x32_bf16 v[170:173], a[216:219], v[130:133], 0
    v_mul_f32 v161, v123, v161
    v_cvt_pk_bf16_f32 v159, v160, v161
    v_mfma_f32_16x16x32_bf16 v[170:173], a[220:223], v[146:149], v[170:173]
    v_mul_f32 v186, v123, v186
    v_mul_f32 v187, v123, v187
    v_mfma_f32_16x16x32_bf16 v[170:173], a[224:227], v[234:237], v[170:173]
    v_cvt_pk_bf16_f32 v160, v186, v187
    v_mul_f32 v188, v123, v188
    v_mfma_f32_16x16x32_bf16 v[170:173], a[228:231], v[154:157], v[170:173]
    v_mul_f32 v189, v123, v189
    v_cvt_pk_bf16_f32 v161, v188, v189
    v_mfma_f32_16x16x32_bf16 v[170:173], a[232:235], v[206:209], v[170:173]
    v_mul_f32 v194, v123, v194
    v_mul_f32 v195, v123, v195
    v_mfma_f32_16x16x32_bf16 v[170:173], a[236:239], v[210:213], v[170:173]
    ds_write_b128 v3, v[158:161] offset:12288
    v_mfma_f32_16x16x32_bf16 v[158:161], v[86:89], v[210:213], 0
    v_cvt_pk_bf16_f32 v124, v194, v195
    v_mul_f32 v196, v123, v196
    v_mfma_f32_16x16x32_bf16 v[158:161], v[82:85], v[206:209], v[158:161]
    v_mul_f32 v197, v123, v197
    v_cvt_pk_bf16_f32 v125, v196, v197
    v_mfma_f32_16x16x32_bf16 v[158:161], a[252:255], v[154:157], v[158:161]
    v_fma_f32 v128, v170, v170, s33
    v_fmac_f32 v128, v171, v171
    v_mfma_f32_16x16x32_bf16 v[158:161], a[248:251], v[234:237], v[158:161]
    v_fmac_f32 v128, v172, v172
    v_fmac_f32 v128, v173, v173
    v_mfma_f32_16x16x32_bf16 v[158:161], a[244:247], v[146:149], v[158:161]
    v_mul_f32 v250, v191, v250
    v_mul_f32 v251, v191, v251
    v_mfma_f32_16x16x32_bf16 v[158:161], a[240:243], v[130:133], v[158:161]
    ds_write_b64 v4, v[124:125] offset:16384
    v_mfma_f32_16x16x32_bf16 v[238:241], v[90:93], v[130:133], 0
    v_cvt_pk_bf16_f32 v124, v250, v251
    v_mul_f32 v252, v191, v252
    v_mfma_f32_16x16x32_bf16 v[238:241], v[94:97], v[146:149], v[238:241]
    v_mul_f32 v253, v191, v253
    v_cvt_pk_bf16_f32 v125, v252, v253
    v_mfma_f32_16x16x32_bf16 v[238:241], v[98:101], v[234:237], v[238:241]
    v_fmac_f32 v128, v158, v158
    v_fmac_f32 v128, v159, v159
    v_mfma_f32_16x16x32_bf16 v[238:241], v[102:105], v[154:157], v[238:241]
    v_fmac_f32 v128, v160, v160
    v_fmac_f32 v128, v161, v161
    v_mfma_f32_16x16x32_bf16 v[238:241], v[106:109], v[206:209], v[238:241]
    v_rcp_f32 v127, v126
    v_mfma_f32_16x16x32_bf16 v[238:241], v[110:113], v[210:213], v[238:241]
    ds_read_b128 v[154:157], v0 offset:20480
    v_max3_u32 v25, v25, v127, v126
    v_mfma_f32_16x16x32_bf16 v[130:133], v[166:169], v[28:31], 0
    ds_read_b128 v[186:189], v1 offset:20480
    v_max3_u32 v25, v25, v123, v122
    v_mfma_f32_16x16x32_bf16 v[130:133], v[182:185], v[28:31], v[130:133]
    ds_read_b128 v[206:209], v0 offset:20608
    v_mul_f32 v138, v127, v138
    v_mfma_f32_16x16x32_bf16 v[146:149], v[182:185], v[226:229], 0
    ds_read_b128 v[190:193], v1 offset:20608
    v_fmac_f32 v128, v238, v238
    v_mfma_f32_16x16x32_bf16 v[146:149], v[166:169], v[114:117], v[146:149]
    ds_read_b128 v[226:229], v0 offset:20736
    v_fmac_f32 v128, v239, v239
    v_mfma_f32_16x16x32_bf16 v[114:117], v[166:169], v[118:121], 0
    ds_read_b128 v[234:237], v1 offset:20736
    v_fmac_f32 v128, v240, v240
    v_mfma_f32_16x16x32_bf16 v[114:117], v[182:185], v[222:225], v[114:117]
    ds_write_b64 v4, v[124:125] offset:4096
    v_mfma_f32_16x16x32_bf16 v[118:121], v[182:185], v[230:233], 0
    s_waitcnt lgkmcnt(6)
    v_fmac_f32 v128, v241, v241
    v_cvt_pk_bf16_f32 v147, v128, v128
    v_mfma_f32_16x16x32_bf16 v[118:121], v[166:169], v[150:153], v[118:121]
    s_waitcnt lgkmcnt(5)
    v_mul_f32 v139, v127, v139
    v_cvt_pk_bf16_f32 v122, v138, v139
    v_mfma_f32_16x16x32_bf16 v[150:153], a[72:75], v[154:157], 0
    s_waitcnt lgkmcnt(4)
    v_mul_f32 v140, v127, v140
    v_mul_f32 v141, v127, v141
    v_mfma_f32_16x16x32_bf16 v[150:153], a[76:79], v[186:189], v[150:153]
    s_waitcnt lgkmcnt(3)
    v_cvt_pk_bf16_f32 v123, v140, v141
    v_mul_f32 v198, v127, v198
    v_mfma_f32_16x16x32_bf16 v[150:153], a[80:83], v[206:209], v[150:153]
    s_waitcnt lgkmcnt(2)
    v_mul_f32 v199, v127, v199
    v_cvt_pk_bf16_f32 v124, v198, v199
    v_mfma_f32_16x16x32_bf16 v[150:153], a[84:87], v[190:193], v[150:153]
    s_waitcnt lgkmcnt(1)
    v_mul_f32 v200, v127, v200
    v_mul_f32 v201, v127, v201
    v_mfma_f32_16x16x32_bf16 v[150:153], a[88:91], v[226:229], v[150:153]
    v_cvt_pk_bf16_f32 v125, v200, v201
    v_mul_f32 v218, v127, v218
    v_mfma_f32_16x16x32_bf16 v[150:153], a[92:95], v[234:237], v[150:153]
    ds_write_b128 v3, v[122:125] offset:6144
    v_mfma_f32_16x16x32_bf16 v[122:125], a[116:119], v[234:237], 0
    v_mul_f32 v219, v127, v219
    v_cvt_pk_bf16_f32 v148, v218, v219
    v_mfma_f32_16x16x32_bf16 v[122:125], a[112:115], v[226:229], v[122:125]
    v_mul_f32 v220, v127, v220
    v_mul_f32 v221, v127, v221
    v_mfma_f32_16x16x32_bf16 v[122:125], a[108:111], v[190:193], v[122:125]
    v_cvt_pk_bf16_f32 v149, v220, v221
    v_fmac_f32 v254, v134, v134
    v_mfma_f32_16x16x32_bf16 v[122:125], a[104:107], v[206:209], v[122:125]
    v_rcp_f32_dpp v131, v130 quad_perm:[0,0,0,0] row_mask:0xf bank_mask:0xf
    v_mfma_f32_16x16x32_bf16 v[122:125], a[100:103], v[186:189], v[122:125]
    v_max3_u32 v25, v25, v130, v131
    v_mul_f32 v146, v146, v131
    v_mfma_f32_16x16x32_bf16 v[122:125], a[96:99], v[154:157], v[122:125]
    ds_write_b64 v4, v[148:149] offset:10240
    v_mfma_f32_16x16x32_bf16 v[126:129], a[120:123], v[154:157], 0
    v_mul_f32_dpp v146, v114, v131 quad_perm:[0,1,2,3] row_mask:0x2 bank_mask:0xf
    v_fmac_f32 v254, v135, v135
    v_mfma_f32_16x16x32_bf16 v[126:129], a[124:127], v[186:189], v[126:129]
    v_mul_f32_dpp v146, v118, v131 quad_perm:[0,1,2,3] row_mask:0x4 bank_mask:0xf
    v_cvt_pk_bf16_f32 v146, v146, v146
    v_mfma_f32_16x16x32_bf16 v[126:129], a[128:131], v[206:209], v[126:129]
    ds_write_b16 v7, v146
    v_mfma_f32_16x16x32_bf16 v[126:129], a[132:135], v[190:193], v[126:129]
    v_add_u32 v7, s76, v7
    v_fmac_f32 v254, v136, v136
    v_mfma_f32_16x16x32_bf16 v[126:129], a[136:139], v[226:229], v[126:129]
    v_fmac_f32 v254, v137, v137
    v_cvt_pk_bf16_f32 v146, v254, v255
    v_mfma_f32_16x16x32_bf16 v[126:129], a[140:143], v[234:237], v[126:129]
    ds_write_b64 v4, v[146:147] offset:18432
    v_mfma_f32_16x16x32_bf16 v[114:117], a[20:23], v[234:237], 0
    v_cvt_pk_f16_f32 v182, v150, v151
    v_pk_mul_f16 v139, v182, v182
    v_mfma_f32_16x16x32_bf16 v[114:117], a[16:19], v[226:229], v[114:117]
    v_cvt_pk_f16_f32 v183, v152, v153
    v_pk_fma_f16 v139, v183, v183, v139
    v_mfma_f32_16x16x32_bf16 v[114:117], a[12:15], v[190:193], v[114:117]
    v_cvt_pk_f16_f32 v184, v122, v123
    v_pk_fma_f16 v139, v184, v184, v139
    v_mfma_f32_16x16x32_bf16 v[114:117], a[8:11], v[206:209], v[114:117]
    v_cvt_pk_f16_f32 v185, v124, v125
    v_pk_fma_f16 v139, v185, v185, v139
    v_mfma_f32_16x16x32_bf16 v[114:117], a[4:7], v[186:189], v[114:117]
    v_cvt_pk_f16_f32 v168, v126, v127
    v_pk_fma_f16 v139, v168, v168, v139
    v_mfma_f32_16x16x32_bf16 v[114:117], a[0:3], v[154:157], v[114:117]
    v_cvt_pk_f16_f32 v169, v128, v129
    v_pk_fma_f16 v139, v169, v169, v139
    v_mfma_f32_16x16x32_bf16 v[118:121], a[24:27], v[154:157], 0
    s_waitcnt lgkmcnt(0)
    v_xor_b32 v2, 65536, v2
    v_xor_b32 v3, 65536, v3
    v_mfma_f32_16x16x32_bf16 v[118:121], a[28:31], v[186:189], v[118:121]
    s_nop 0
    v_cvt_pk_f16_f32 v130, v114, v115
    v_mfma_f32_16x16x32_bf16 v[118:121], a[32:35], v[206:209], v[118:121]
    s_nop 0
    v_pk_mul_f16 v138, v130, v130
    v_mfma_f32_16x16x32_bf16 v[118:121], a[36:39], v[190:193], v[118:121]
    s_nop 0
    v_xor_b32 v4, 65536, v4
    v_mfma_f32_16x16x32_bf16 v[118:121], a[40:43], v[226:229], v[118:121]
    s_barrier
    v_mfma_f32_16x16x32_bf16 v[118:121], a[44:47], v[234:237], v[118:121]
    s_cbranch_scc1 L_loop_fast3
L_final_fast:
    v_mfma_f32_16x16x32_bf16 v[122:125], a[68:71], v[234:237], 0
    s_mov_b32 s12, s40
    ds_read_b128 v[126:129], v2 offset:18432
    ds_read_b128 v[146:149], v2 offset:19456
    v_mfma_f32_16x16x32_bf16 v[122:125], a[64:67], v[226:229], v[122:125]
    s_mov_b32 s13, s41
    ds_read_b128 v[150:153], v5 offset:32
    ds_read2_b64 v[194:197], v5 offset0:6 offset1:9
    v_mfma_f32_16x16x32_bf16 v[122:125], a[60:63], v[190:193], v[122:125]
    s_mov_b32 s14, s36
    v_cvt_pk_f16_f32 v131, v116, v117
    v_pk_fma_f16 v138, v131, v131, v138
    v_mfma_f32_16x16x32_bf16 v[122:125], a[56:59], v[206:209], v[122:125]
    s_add_u32 s48, s40, s27
    ds_read_b128 v[114:117], v5
    ds_read_b32 v254, v6 offset:192
    v_mfma_f32_16x16x32_bf16 v[122:125], a[52:55], v[186:189], v[122:125]
    s_addc_u32 s49, s41, 0
    v_cvt_pk_f16_f32 v132, v118, v119
    v_pk_fma_f16 v138, v132, v132, v138
    v_mfma_f32_16x16x32_bf16 v[122:125], a[48:51], v[154:157], v[122:125]
    s_sub_u32 s50, s36, s27
    v_cvt_pk_f16_f32 v133, v120, v121
    v_pk_fma_f16 v138, v133, v133, v138
    v_mfma_f32_16x16x32_bf16 v[118:121], v[154:157], a[144:147], 0
    s_mov_b32 s51, 0x00020000
    v_bfe_u32 v255, v2, 4, 6
    v_lshrrev_b32 v198, 4, v255
    v_mfma_f32_16x16x32_bf16 v[118:121], v[186:189], a[148:151], v[118:121]
    s_add_u32 s52, s40, s26
    v_cvt_pk_f16_f32 v166, v122, v123
    v_pk_fma_f16 v138, v166, v166, v138
    v_mfma_f32_16x16x32_bf16 v[118:121], v[206:209], a[152:155], v[118:121]
    s_waitcnt lgkmcnt(4)
    v_cvt_pk_f16_f32 v167, v124, v125
    v_pk_fma_f16 v138, v167, v167, v138
    v_mfma_f32_16x16x32_bf16 v[122:125], v[32:35], v[126:129], 0
    s_waitcnt lgkmcnt(2)
    v_pk_mul_f16 v141, v182, v150
    v_pk_fma_f16 v141, v183, v151, v141
    v_mfma_f32_16x16x32_bf16 v[122:125], v[32:35], v[146:149], v[122:125]
    s_addc_u32 s53, s41, 0
    v_pk_fma_f16 v141, v184, v152, v141
    v_pk_fma_f16 v141, v185, v153, v141
    v_mfma_f32_16x16x32_bf16 v[118:121], v[190:193], a[156:159], v[118:121]
    s_waitcnt lgkmcnt(0)
    v_mov_b32_dpp v254, v23 quad_perm:[0,1,2,3] row_mask:0x7 bank_mask:0xf
    v_pk_fma_f16 v141, v168, v196, v141
    v_mfma_f32_16x16x32_bf16 v[118:121], v[226:229], a[160:163], v[118:121]
    s_sub_u32 s54, s36, s26
    v_mul_f32 v140, 0x3baaaaab, v122
    v_pk_fma_f16 v141, v169, v197, v141
    v_mfma_f32_16x16x32_bf16 v[118:121], v[234:237], a[164:167], v[118:121]
    s_mov_b32 s55, 0x00020000
    v_rsq_f32 v140, v140
    v_mfma_f32_16x16x32_bf16 v[126:129], v[234:237], a[188:191], 0
    s_add_u32 s56, s40, s25
    v_mul_f32 v178, v140, v178
    v_mul_f32 v179, v140, v179
    v_mfma_f32_16x16x32_bf16 v[126:129], v[226:229], a[184:187], v[126:129]
    s_addc_u32 s57, s41, 0
    v_cvt_pk_bf16_f32 v146, v178, v179
    v_mul_f32 v180, v140, v180
    v_mfma_f32_16x16x32_bf16 v[126:129], v[190:193], a[180:183], v[126:129]
    s_sub_u32 s58, s36, s25
    ds_read_b128 v[202:205], v0 offset:26624
    v_mul_f32 v181, v140, v181
    v_mfma_f32_16x16x32_bf16 v[126:129], v[206:209], a[176:179], v[126:129]
    s_mov_b32 s59, 0x00020000
    ds_read_b128 v[210:213], v1 offset:26624
    v_cvt_pk_bf16_f32 v147, v180, v181
    v_mfma_f32_16x16x32_bf16 v[126:129], v[186:189], a[172:175], v[126:129]
    s_and_b32 s6, s2, 7
    ds_read_b128 v[178:181], v0 offset:26752
    v_mul_f32 v142, v140, v142
    v_mfma_f32_16x16x32_bf16 v[126:129], v[154:157], a[168:171], v[126:129]
    s_sub_u32 s6, 0, s6
    ds_read_b128 v[218:221], v1 offset:26752
    v_mul_f32 v143, v140, v143
    v_mfma_f32_16x16x32_bf16 v[222:225], v[154:157], a[192:195], 0
    s_lshl_b32 s3, s16, 6
    ds_read_b128 v[154:157], v0 offset:26880
    v_cvt_pk_bf16_f32 v148, v142, v143
    v_mfma_f32_16x16x32_bf16 v[222:225], v[186:189], a[196:199], v[222:225]
    s_lshl_b32 s4, s16, 5
    ds_read_b128 v[186:189], v1 offset:26880
    v_mul_f32 v144, v140, v144
    v_mfma_f32_16x16x32_bf16 v[222:225], v[206:209], a[200:203], v[222:225]
    s_add_u32 s4, s4, 256
    v_mul_f32 v145, v140, v145
    v_cvt_pk_bf16_f32 v149, v144, v145
    v_mfma_f32_16x16x32_bf16 v[222:225], v[190:193], a[204:207], v[222:225]
    buffer_store_dwordx4 v[146:149], v15, s[48:51], 0 offen nt
    v_mul_f32 v134, v140, v134
    v_mul_f32 v135, v140, v135
    v_cvt_pk_bf16_f32 v200, v134, v135
    v_mul_f32 v136, v140, v136
    v_mfma_f32_16x16x32_bf16 v[222:225], v[226:229], a[208:211], v[222:225]
    s_waitcnt lgkmcnt(4)
    v_mul_f32 v137, v140, v137
    v_cvt_pk_bf16_f32 v201, v136, v137
    v_mfma_f32_16x16x32_bf16 v[222:225], v[234:237], a[212:215], v[222:225]
    s_mul_i32 s5, s16, 9408
    v_pk_mul_f16 v140, v130, v114
    v_pk_fma_f16 v140, v131, v115, v140
    v_mfma_f32_16x16x32_bf16 v[134:137], a[72:75], v[202:205], 0
    s_add_u32 s5, s5, 104448
    v_pk_fma_f16 v140, v132, v116, v140
    v_pk_fma_f16 v140, v133, v117, v140
    v_mfma_f32_16x16x32_bf16 v[134:137], a[76:79], v[210:213], v[134:137]
    s_waitcnt lgkmcnt(1)
    v_pk_fma_f16 v140, v166, v194, v140
    v_pk_fma_f16 v140, v167, v195, v140
    v_mfma_f32_16x16x32_bf16 v[134:137], a[80:83], v[178:181], v[134:137]
    s_waitcnt lgkmcnt(0)
    v_cvt_pk_bf16_f32 v118, v118, v119
    v_cvt_pk_bf16_f32 v119, v120, v121
    v_mfma_f32_16x16x32_f16 v[142:145], v[40:43], v[138:141], 0
    v_cvt_pk_bf16_f32 v126, v126, v127
    v_cvt_pk_bf16_f32 v127, v128, v129
    v_mfma_f32_16x16x32_bf16 v[134:137], a[84:87], v[218:221], v[134:137]
    v_cvt_pk_bf16_f32 v138, v222, v223
    v_cvt_pk_bf16_f32 v139, v224, v225
    v_mfma_f32_16x16x32_bf16 v[134:137], a[88:91], v[154:157], v[134:137]
    v_mul_f32 v120, 0x3baaaaab, v124
    v_mul_f32 v121, 0x3baaaaab, v123
    v_mfma_f32_16x16x32_bf16 v[134:137], a[92:95], v[186:189], v[134:137]
    v_rsq_f32 v142, v142
    v_mfma_f32_16x16x32_bf16 v[122:125], a[116:119], v[186:189], 0
    v_rsq_f32 v143, v143
    v_mfma_f32_16x16x32_bf16 v[122:125], a[112:115], v[154:157], v[122:125]
    v_mul_f32 v128, s31, v142
    v_cvt_pk_f16_f32 v129, v128, v143
    v_mfma_f32_16x16x32_bf16 v[122:125], a[108:111], v[218:221], v[122:125]
    v_fma_f32 v144, v144, v128, v22
    v_fmac_f32_dpp v254, v145, v143 quad_perm:[0,1,2,3] row_mask:0x1 bank_mask:0xf
    v_mfma_f32_16x16x32_bf16 v[122:125], a[104:107], v[178:181], v[122:125]
    v_pk_mul_f16 v182, v182, v129 op_sel:[0,1] op_sel_hi:[1,1]
    v_pk_mul_f16 v183, v183, v129 op_sel:[0,1] op_sel_hi:[1,1]
    v_mfma_f32_16x16x32_bf16 v[122:125], a[100:103], v[210:213], v[122:125]
    v_pk_mul_f16 v184, v184, v129 op_sel:[0,1] op_sel_hi:[1,1]
    v_pk_mul_f16 v185, v185, v129 op_sel:[0,1] op_sel_hi:[1,1]
    v_mfma_f32_16x16x32_bf16 v[122:125], a[96:99], v[202:205], v[122:125]
    v_pk_mul_f16 v168, v168, v129 op_sel:[0,1] op_sel_hi:[1,1]
    v_pk_mul_f16 v169, v169, v129 op_sel:[0,1] op_sel_hi:[1,1]
    v_mfma_f32_16x16x32_bf16 v[146:149], a[120:123], v[202:205], 0
    buffer_store_dwordx2 v[200:201], v18, s[48:51], 0 offen nt
    v_pk_mul_f16 v130, v130, v129 op_sel:[0,0] op_sel_hi:[1,0]
    v_pk_mul_f16 v131, v131, v129 op_sel:[0,0] op_sel_hi:[1,0]
    v_mfma_f32_16x16x32_bf16 v[146:149], a[124:127], v[210:213], v[146:149]
    v_pk_mul_f16 v132, v132, v129 op_sel:[0,0] op_sel_hi:[1,0]
    v_pk_mul_f16 v133, v133, v129 op_sel:[0,0] op_sel_hi:[1,0]
    v_mfma_f32_16x16x32_bf16 v[146:149], a[128:131], v[178:181], v[146:149]
    v_pk_mul_f16 v166, v166, v129 op_sel:[0,0] op_sel_hi:[1,0]
    v_pk_mul_f16 v167, v167, v129 op_sel:[0,0] op_sel_hi:[1,0]
    v_mfma_f32_16x16x32_bf16 v[146:149], a[132:135], v[218:221], v[146:149]
    v_max3_u32 v44, v44, v142, v143
    v_cvt_pk_f16_f32 v134, v134, v135
    v_mfma_f32_16x16x32_bf16 v[146:149], a[136:139], v[154:157], v[146:149]
    ds_read_b128 v[190:193], v2 offset:0
    ds_read_b128 v[206:209], v2 offset:1024
    v_mfma_f32_16x16x32_bf16 v[146:149], a[140:143], v[186:189], v[146:149]
    ds_read_b128 v[222:225], v2 offset:2048
    ds_read_b128 v[226:229], v2 offset:3072
    v_mfma_f32_16x16x32_bf16 v[230:233], a[20:23], v[186:189], 0
    v_rsq_f32 v120, v120
    v_mfma_f32_16x16x32_bf16 v[230:233], a[16:19], v[154:157], v[230:233]
    ds_read_b128 v[234:237], v2 offset:4096
    ds_read_b128 v[242:245], v2 offset:5120
    v_mfma_f32_16x16x32_bf16 v[230:233], a[12:15], v[218:221], v[230:233]
    v_mul_f32 v170, v120, v170
    v_mul_f32 v171, v120, v171
    v_mfma_f32_16x16x32_bf16 v[230:233], a[8:11], v[178:181], v[230:233]
    v_cvt_pk_bf16_f32 v170, v170, v171
    v_mul_f32 v172, v120, v172
    v_mfma_f32_16x16x32_bf16 v[230:233], a[4:7], v[210:213], v[230:233]
    v_mul_f32 v173, v120, v173
    v_cvt_pk_bf16_f32 v171, v172, v173
    v_mfma_f32_16x16x32_bf16 v[230:233], a[0:3], v[202:205], v[230:233]
    v_mul_f32 v158, v120, v158
    v_mul_f32 v159, v120, v159
    v_mfma_f32_16x16x32_bf16 v[246:249], a[24:27], v[202:205], 0
    s_waitcnt lgkmcnt(4)
    v_cvt_pk_bf16_f32 v172, v158, v159
    v_mul_f32 v160, v120, v160
    v_mfma_f32_16x16x32_bf16 v[250:253], a[216:219], v[190:193], 0
    s_waitcnt lgkmcnt(2)
    v_mul_f32 v161, v120, v161
    v_cvt_pk_bf16_f32 v173, v160, v161
    v_mfma_f32_16x16x32_bf16 v[250:253], a[220:223], v[206:209], v[250:253]
    v_mul_f32 v238, v120, v238
    v_mul_f32 v239, v120, v239
    v_mfma_f32_16x16x32_bf16 v[250:253], a[224:227], v[222:225], v[250:253]
    s_waitcnt lgkmcnt(0)
    v_cvt_pk_bf16_f32 v128, v238, v239
    v_mul_f32 v240, v120, v240
    v_mfma_f32_16x16x32_bf16 v[250:253], a[228:231], v[226:229], v[250:253]
    buffer_store_dwordx4 v[170:173], v17, s[48:51], 0 offen nt
    v_mul_f32 v241, v120, v241
    v_cvt_pk_bf16_f32 v129, v240, v241
    v_rsq_f32 v121, v121
    v_mfma_f32_16x16x32_bf16 v[250:253], a[232:235], v[234:237], v[250:253]
    v_mul_f32 v174, v121, v174
    v_mul_f32 v175, v121, v175
    v_mfma_f32_16x16x32_bf16 v[250:253], a[236:239], v[242:245], v[250:253]
    v_cvt_pk_bf16_f32 v158, v174, v175
    v_mul_f32 v176, v121, v176
    v_mfma_f32_16x16x32_bf16 v[170:173], v[86:89], v[242:245], 0
    v_mul_f32 v177, v121, v177
    v_cvt_pk_bf16_f32 v159, v176, v177
    v_mfma_f32_16x16x32_bf16 v[170:173], v[82:85], v[234:237], v[170:173]
    ds_read_b128 v[174:177], v2 offset:11264
    v_mul_f32 v162, v121, v162
    v_mfma_f32_16x16x32_bf16 v[170:173], a[252:255], v[226:229], v[170:173]
    v_fma_f32 v120, v250, v250, s33
    v_fmac_f32 v120, v251, v251
    v_mfma_f32_16x16x32_bf16 v[170:173], a[248:251], v[222:225], v[170:173]
    v_fmac_f32 v120, v252, v252
    v_fmac_f32 v120, v253, v253
    v_mfma_f32_16x16x32_bf16 v[170:173], a[244:247], v[206:209], v[170:173]
    v_mul_f32 v163, v121, v163
    v_cvt_pk_bf16_f32 v160, v162, v163
    v_mfma_f32_16x16x32_bf16 v[170:173], a[240:243], v[190:193], v[170:173]
    v_mul_f32 v164, v121, v164
    v_mul_f32 v165, v121, v165
    v_mfma_f32_16x16x32_bf16 v[246:249], a[28:31], v[210:213], v[246:249]
    v_cvt_pk_bf16_f32 v161, v164, v165
    v_mul_f32 v214, v121, v214
    v_mfma_f32_16x16x32_bf16 v[246:249], a[32:35], v[178:181], v[246:249]
    v_mul_f32 v215, v121, v215
    v_cvt_pk_bf16_f32 v140, v214, v215
    v_mfma_f32_16x16x32_bf16 v[162:165], v[90:93], v[190:193], 0
    ds_read_b128 v[190:193], v2 offset:10240
    v_fmac_f32 v120, v170, v170
    v_mfma_f32_16x16x32_bf16 v[162:165], v[94:97], v[206:209], v[162:165]
    s_waitcnt lgkmcnt(1)
    ds_read_b128 v[206:209], v2 offset:9216
    v_fmac_f32 v120, v171, v171
    v_mfma_f32_16x16x32_bf16 v[162:165], v[98:101], v[222:225], v[162:165]
    ds_read_b128 v[222:225], v2 offset:8192
    v_fmac_f32 v120, v172, v172
    v_mfma_f32_16x16x32_bf16 v[162:165], v[102:105], v[226:229], v[162:165]
    ds_read_b128 v[226:229], v2 offset:7168
    v_fmac_f32 v120, v173, v173
    v_mfma_f32_16x16x32_bf16 v[162:165], v[106:109], v[234:237], v[162:165]
    ds_read_b128 v[234:237], v2 offset:6144
    buffer_store_dwordx2 v[128:129], v20, s[48:51], 0 offen nt
    v_mul_f32 v216, v121, v216
    v_mul_f32 v217, v121, v217
    v_mfma_f32_16x16x32_bf16 v[162:165], v[110:113], v[242:245], v[162:165]
    v_cvt_pk_bf16_f32 v141, v216, v217
    v_cvt_pk_f16_f32 v214, v230, v231
    v_mfma_f32_16x16x32_bf16 v[238:241], v[110:113], v[174:177], 0
    v_pk_mul_f16 v230, v214, v214
    v_cvt_pk_f16_f32 v215, v232, v233
    v_mfma_f32_16x16x32_bf16 v[242:245], a[236:239], v[174:177], 0
    s_waitcnt lgkmcnt(4)
    v_pk_fma_f16 v230, v215, v215, v230
    v_fmac_f32 v120, v162, v162
    v_mfma_f32_16x16x32_bf16 v[238:241], v[106:109], v[190:193], v[238:241]
    s_waitcnt lgkmcnt(3)
    v_fmac_f32 v120, v163, v163
    v_fmac_f32 v120, v164, v164
    v_mfma_f32_16x16x32_bf16 v[238:241], v[102:105], v[206:209], v[238:241]
    s_waitcnt lgkmcnt(2)
    v_fmac_f32 v120, v165, v165
    v_pk_mul_f16 v232, v214, v114
    v_mfma_f32_16x16x32_bf16 v[238:241], v[98:101], v[222:225], v[238:241]
    s_waitcnt lgkmcnt(1)
    v_pk_fma_f16 v232, v215, v115, v232
    v_pk_mul_f16 v231, v134, v134
    v_mfma_f32_16x16x32_bf16 v[238:241], v[94:97], v[226:229], v[238:241]
    s_waitcnt lgkmcnt(0)
    v_cvt_pk_f16_f32 v135, v136, v137
    v_pk_fma_f16 v231, v135, v135, v231
    v_mfma_f32_16x16x32_bf16 v[238:241], v[90:93], v[234:237], v[238:241]
    v_cvt_pk_f16_f32 v136, v122, v123
    v_pk_fma_f16 v231, v136, v136, v231
    v_mfma_f32_16x16x32_bf16 v[242:245], a[232:235], v[190:193], v[242:245]
    v_cvt_pk_f16_f32 v137, v124, v125
    v_pk_fma_f16 v231, v137, v137, v231
    v_mfma_f32_16x16x32_bf16 v[242:245], a[228:231], v[206:209], v[242:245]
    v_cvt_pk_f16_f32 v124, v146, v147
    v_pk_fma_f16 v231, v124, v124, v231
    v_mfma_f32_16x16x32_bf16 v[242:245], a[224:227], v[222:225], v[242:245]
    v_fma_f32 v121, v238, v238, s33
    v_fmac_f32 v121, v239, v239
    v_mfma_f32_16x16x32_bf16 v[242:245], a[220:223], v[226:229], v[242:245]
    v_fmac_f32 v121, v240, v240
    v_fmac_f32 v121, v241, v241
    v_mfma_f32_16x16x32_bf16 v[242:245], a[216:219], v[234:237], v[242:245]
    v_cvt_pk_f16_f32 v125, v148, v149
    v_pk_fma_f16 v231, v125, v125, v231
    v_mfma_f32_16x16x32_bf16 v[246:249], a[36:39], v[218:221], v[246:249]
    v_pk_mul_f16 v233, v134, v150
    v_pk_fma_f16 v233, v135, v151, v233
    v_mfma_f32_16x16x32_bf16 v[246:249], a[40:43], v[154:157], v[246:249]
    v_pk_fma_f16 v233, v136, v152, v233
    v_pk_fma_f16 v233, v137, v153, v233
    v_mfma_f32_16x16x32_bf16 v[246:249], a[44:47], v[186:189], v[246:249]
    buffer_store_dwordx4 v[158:161], v16, s[48:51], 0 offen nt
    v_pk_fma_f16 v233, v124, v196, v233
    v_pk_fma_f16 v233, v125, v197, v233
    v_and_b32 v199, 15, v255
    v_lshlrev_b32 v200, 9, v198
    v_mfma_f32_16x16x32_bf16 v[146:149], a[240:243], v[234:237], 0
    v_lshl_add_u32 v200, v199, 4, v200
    v_add_u32 v200, 149696, v200
    v_mfma_f32_16x16x32_bf16 v[146:149], a[244:247], v[226:229], v[146:149]
    v_cvt_pk_f16_f32 v216, v246, v247
    v_pk_fma_f16 v230, v216, v216, v230
    v_mfma_f32_16x16x32_bf16 v[146:149], a[248:251], v[222:225], v[146:149]
    v_cvt_pk_f16_f32 v217, v248, v249
    v_pk_fma_f16 v230, v217, v217, v230
    v_mfma_f32_16x16x32_bf16 v[146:149], a[252:255], v[206:209], v[146:149]
    v_pk_fma_f16 v232, v216, v116, v232
    v_pk_fma_f16 v232, v217, v117, v232
    v_mfma_f32_16x16x32_bf16 v[146:149], v[82:85], v[190:193], v[146:149]
    v_and_b32 v201, 0xffff, v2
    v_add_u32 v201, 38912, v201
    v_mfma_f32_16x16x32_bf16 v[146:149], v[86:89], v[174:177], v[146:149]
    v_and_b32 v142, 0xffff, v4
    v_add_u32 v142, 38912, v142
    v_mfma_f32_16x16x32_bf16 v[158:161], a[68:71], v[186:189], 0
    v_exp_f32 v144, v144
    v_mfma_f32_16x16x32_bf16 v[158:161], a[64:67], v[154:157], v[158:161]
    v_cvt_pk_bf16_f32 v39, v144, 0
    v_mov_b32 v143, 0x40000000
    v_mfma_f32_16x16x32_bf16 v[158:161], a[60:63], v[218:221], v[158:161]
    v_fmac_f32 v121, v146, v146
    v_fmac_f32 v121, v147, v147
    v_mfma_f32_16x16x32_bf16 v[158:161], a[56:59], v[178:181], v[158:161]
    v_fmac_f32 v121, v148, v148
    v_fmac_f32 v121, v149, v149
    v_mfma_f32_16x16x32_bf16 v[158:161], a[52:55], v[210:213], v[158:161]
    v_fmac_f32 v121, v242, v242
    v_fmac_f32 v121, v243, v243
    v_mfma_f32_16x16x32_bf16 v[158:161], a[48:51], v[202:205], v[158:161]
    v_fmac_f32 v121, v244, v244
    v_fmac_f32 v121, v245, v245
    v_mfma_f32_16x16x32_bf16 v[174:177], v[202:205], a[144:147], 0
    v_cvt_pk_bf16_f32 v120, v120, v121
    v_cvt_pk_bf16_f32 v121, v121, v121
    v_mfma_f32_16x16x32_bf16 v[174:177], v[210:213], a[148:151], v[174:177]
    ds_write_b64 v142, v[120:121] offset:0
    v_mfma_f32_16x16x32_bf16 v[174:177], v[178:181], a[152:155], v[174:177]
    buffer_store_dwordx2 v[140:141], v19, s[48:51], 0 offen nt
    v_cvt_pk_f16_f32 v122, v158, v159
    v_pk_fma_f16 v230, v122, v122, v230
    v_mfma_f32_16x16x32_bf16 v[174:177], v[218:221], a[156:159], v[174:177]
    v_cvt_pk_f16_f32 v123, v160, v161
    v_pk_fma_f16 v230, v123, v123, v230
    v_mfma_f32_16x16x32_bf16 v[174:177], v[154:157], a[160:163], v[174:177]
    v_pk_fma_f16 v232, v122, v194, v232
    v_pk_fma_f16 v232, v123, v195, v232
    v_mfma_f32_16x16x32_bf16 v[174:177], v[186:189], a[164:167], v[174:177]
    v_add_u32 v140, 0, v199
    v_mul_u32_u24 v144, s20, v140
    v_mfma_f32_16x16x32_f16 v[158:161], v[40:43], v[230:233], 0
    v_add_u32 v144, s38, v144
    v_mul_u32_u24 v145, 911, v144
    v_mfma_f32_16x16x32_bf16 v[190:193], v[186:189], a[188:191], 0
    v_lshrrev_b32 v145, 16, v145
    v_mul_u32_u24 v145, s22, v145
    v_mfma_f32_16x16x32_bf16 v[190:193], v[154:157], a[184:187], v[190:193]
    s_waitcnt lgkmcnt(0)
    v_cvt_pk_bf16_f32 v120, v174, v175
    v_cvt_pk_bf16_f32 v121, v176, v177
    v_mfma_f32_16x16x32_bf16 v[190:193], v[218:221], a[180:183], v[190:193]
    s_barrier
    ds_read_b128 v[174:177], v201 offset:0
    ds_read_b128 v[206:209], v201 offset:1024
    v_mfma_f32_16x16x32_bf16 v[190:193], v[178:181], a[176:179], v[190:193]
    ds_read_b128 v[222:225], v0 offset:32768
    ds_read_b128 v[226:229], v1 offset:32768
    v_mfma_f32_16x16x32_bf16 v[190:193], v[210:213], a[172:175], v[190:193]
    v_rsq_f32 v158, v158
    v_mfma_f32_16x16x32_bf16 v[190:193], v[202:205], a[168:171], v[190:193]
    v_rsq_f32 v159, v159
    v_mul_f32 v230, s31, v158
    v_cvt_pk_f16_f32 v231, v230, v159
    v_fma_f32 v160, v160, v230, v24
    v_fmac_f32_dpp v254, v161, v159 quad_perm:[0,1,2,3] row_mask:0x2 bank_mask:0xf
    v_pk_mul_f16 v134, v134, v231 op_sel:[0,1] op_sel_hi:[1,1]
    v_pk_mul_f16 v135, v135, v231 op_sel:[0,1] op_sel_hi:[1,1]
    v_pk_mul_f16 v136, v136, v231 op_sel:[0,1] op_sel_hi:[1,1]
    v_cvt_pk_bf16_f32 v128, v190, v191
    v_cvt_pk_bf16_f32 v129, v192, v193
    v_mfma_f32_16x16x32_bf16 v[190:193], v[202:205], a[192:195], 0
    ds_read_b128 v[202:205], v0 offset:32896
    v_pk_mul_f16 v137, v137, v231 op_sel:[0,1] op_sel_hi:[1,1]
    v_mfma_f32_16x16x32_bf16 v[190:193], v[210:213], a[196:199], v[190:193]
    s_waitcnt lgkmcnt(4)
    ds_read_b128 v[210:213], v1 offset:32896
    v_pk_mul_f16 v124, v124, v231 op_sel:[0,1] op_sel_hi:[1,1]
    v_mfma_f32_16x16x32_bf16 v[190:193], v[178:181], a[200:203], v[190:193]
    s_waitcnt lgkmcnt(3)
    ds_read_b128 v[178:181], v0 offset:33024
    v_pk_mul_f16 v125, v125, v231 op_sel:[0,1] op_sel_hi:[1,1]
    v_mfma_f32_16x16x32_bf16 v[190:193], v[218:221], a[204:207], v[190:193]
    s_waitcnt lgkmcnt(3)
    ds_read_b128 v[218:221], v1 offset:33024
    v_pk_mul_f16 v214, v214, v231 op_sel:[0,0] op_sel_hi:[1,0]
    v_mfma_f32_16x16x32_bf16 v[190:193], v[154:157], a[208:211], v[190:193]
    v_pk_mul_f16 v215, v215, v231 op_sel:[0,0] op_sel_hi:[1,0]
    v_pk_mul_f16 v216, v216, v231 op_sel:[0,0] op_sel_hi:[1,0]
    v_mfma_f32_16x16x32_bf16 v[154:157], v[32:35], v[174:177], 0
    v_pk_mul_f16 v217, v217, v231 op_sel:[0,0] op_sel_hi:[1,0]
    v_pk_mul_f16 v122, v122, v231 op_sel:[0,0] op_sel_hi:[1,0]
    v_mfma_f32_16x16x32_bf16 v[154:157], v[32:35], v[206:209], v[154:157]
    v_pk_mul_f16 v123, v123, v231 op_sel:[0,0] op_sel_hi:[1,0]
    v_max3_u32 v44, v44, v158, v159
    v_mfma_f32_16x16x32_bf16 v[190:193], v[186:189], a[212:215], v[190:193]
    v_exp_f32 v160, v160
    v_mfma_f32_16x16x32_bf16 v[174:177], a[72:75], v[222:225], 0
    s_waitcnt lgkmcnt(3)
    v_mad_u32_u24 v145, v140, s21, v145
    v_bfe_u32 v144, s70, v140, 1
    v_mfma_f32_16x16x32_bf16 v[174:177], a[76:79], v[226:229], v[174:177]
    s_waitcnt lgkmcnt(2)
    v_mul_f32 v141, 0x3baaaaab, v154
    v_cvt_pk_bf16_f32 v140, v190, v191
    v_mfma_f32_16x16x32_bf16 v[174:177], a[80:83], v[202:205], v[174:177]
    s_waitcnt lgkmcnt(1)
    v_rsq_f32 v141, v141
    v_mfma_f32_16x16x32_bf16 v[174:177], a[84:87], v[210:213], v[174:177]
    s_waitcnt lgkmcnt(0)
    v_mul_f32 v250, v141, v250
    v_mul_f32 v251, v141, v251
    v_mfma_f32_16x16x32_bf16 v[174:177], a[88:91], v[178:181], v[174:177]
    v_cvt_pk_bf16_f32 v186, v250, v251
    v_mul_f32 v252, v141, v252
    v_mfma_f32_16x16x32_bf16 v[174:177], a[92:95], v[218:221], v[174:177]
    v_mul_f32 v253, v141, v253
    v_cvt_pk_bf16_f32 v187, v252, v253
    v_mfma_f32_16x16x32_bf16 v[206:209], a[116:119], v[218:221], 0
    v_mul_f32 v170, v141, v170
    v_mul_f32 v171, v141, v171
    v_mfma_f32_16x16x32_bf16 v[206:209], a[112:115], v[178:181], v[206:209]
    v_cvt_pk_bf16_f32 v188, v170, v171
    v_mul_f32 v172, v141, v172
    v_mfma_f32_16x16x32_bf16 v[206:209], a[108:111], v[210:213], v[206:209]
    v_mul_f32 v173, v141, v173
    v_cvt_pk_bf16_f32 v189, v172, v173
    v_mfma_f32_16x16x32_bf16 v[206:209], a[104:107], v[202:205], v[206:209]
    buffer_store_dwordx4 v[186:189], v15, s[52:55], 0 offen nt
    v_mul_f32 v162, v141, v162
    v_mul_f32 v163, v141, v163
    v_cvt_pk_bf16_f32 v158, v162, v163
    v_mul_f32 v164, v141, v164
    v_mfma_f32_16x16x32_bf16 v[206:209], a[100:103], v[226:229], v[206:209]
    v_mul_f32 v165, v141, v165
    v_cvt_pk_bf16_f32 v159, v164, v165
    v_mfma_f32_16x16x32_bf16 v[206:209], a[96:99], v[222:225], v[206:209]
    v_cvt_pk_bf16_f32 v141, v192, v193
    v_cvt_pk_f16_f32 v162, v174, v175
    v_mfma_f32_16x16x32_bf16 v[170:173], a[120:123], v[222:225], 0
    v_pk_mul_f16 v175, v162, v162
    v_cvt_pk_f16_f32 v163, v176, v177
    v_mfma_f32_16x16x32_bf16 v[170:173], a[124:127], v[226:229], v[170:173]
    v_pk_fma_f16 v175, v163, v163, v175
    v_pk_mul_f16 v177, v162, v150
    v_mfma_f32_16x16x32_bf16 v[170:173], a[128:131], v[202:205], v[170:173]
    v_cvt_pk_f16_f32 v164, v206, v207
    v_pk_fma_f16 v175, v164, v164, v175
    v_mfma_f32_16x16x32_bf16 v[170:173], a[132:135], v[210:213], v[170:173]
    v_cvt_pk_f16_f32 v165, v208, v209
    v_pk_fma_f16 v175, v165, v165, v175
    v_mfma_f32_16x16x32_bf16 v[170:173], a[136:139], v[178:181], v[170:173]
    v_pk_fma_f16 v177, v163, v151, v177
    v_pk_fma_f16 v177, v164, v152, v177
    v_mfma_f32_16x16x32_bf16 v[170:173], a[140:143], v[218:221], v[170:173]
    v_pk_fma_f16 v177, v165, v153, v177
    v_mul_f32 v161, 0x3baaaaab, v155
    v_mfma_f32_16x16x32_bf16 v[150:153], a[20:23], v[218:221], 0
    v_rsq_f32 v161, v161
    v_mfma_f32_16x16x32_bf16 v[150:153], a[16:19], v[178:181], v[150:153]
    v_mul_f32 v242, v161, v242
    v_mul_f32 v243, v161, v243
    v_mfma_f32_16x16x32_bf16 v[150:153], a[12:15], v[210:213], v[150:153]
    v_cvt_pk_f16_f32 v156, v170, v171
    v_pk_fma_f16 v175, v156, v156, v175
    v_mfma_f32_16x16x32_bf16 v[150:153], a[8:11], v[202:205], v[150:153]
    v_cvt_pk_f16_f32 v157, v172, v173
    v_pk_fma_f16 v175, v157, v157, v175
    v_mfma_f32_16x16x32_bf16 v[150:153], a[4:7], v[226:229], v[150:153]
    v_pk_fma_f16 v177, v156, v196, v177
    v_pk_fma_f16 v177, v157, v197, v177
    v_mfma_f32_16x16x32_bf16 v[150:153], a[0:3], v[222:225], v[150:153]
    v_cvt_pk_bf16_f32 v170, v242, v243
    v_mul_f32 v244, v161, v244
    v_mfma_f32_16x16x32_bf16 v[186:189], a[24:27], v[222:225], 0
    v_mul_f32 v245, v161, v245
    v_cvt_pk_bf16_f32 v171, v244, v245
    v_mfma_f32_16x16x32_f16 v[190:193], v[182:185], v[130:133], v[46:49]
    buffer_store_dwordx2 v[158:159], v18, s[52:55], 0 offen nt
    v_mul_f32 v146, v161, v146
    v_cvt_pk_f16_f32 v150, v150, v151
    v_mfma_f32_16x16x32_f16 v[206:209], v[134:137], v[130:133], v[50:53]
    v_pk_mul_f16 v174, v150, v150
    v_cvt_pk_f16_f32 v151, v152, v153
    v_pk_fma_f16 v174, v151, v151, v174
    v_mfma_f32_16x16x16_f16 v[190:193], v[168:169], v[166:167], v[190:193]
    v_pk_mul_f16 v176, v150, v114
    v_pk_fma_f16 v176, v151, v115, v176
    v_mul_f32 v147, v161, v147
    v_mfma_f32_16x16x16_f16 v[206:209], v[124:125], v[166:167], v[206:209]
    v_cvt_pk_bf16_f32 v172, v146, v147
    v_mul_f32 v148, v161, v148
    v_mul_f32 v149, v161, v149
    v_cvt_pk_bf16_f32 v173, v148, v149
    v_mfma_f32_16x16x32_bf16 v[186:189], a[28:31], v[226:229], v[186:189]
    v_exp_f32 v190, v190
    v_mfma_f32_16x16x32_bf16 v[186:189], a[32:35], v[202:205], v[186:189]
    v_exp_f32 v191, v191
    v_mfma_f32_16x16x32_bf16 v[186:189], a[36:39], v[210:213], v[186:189]
    v_cvt_pk_bf16_f32 v114, v190, v191
    v_mul_f32 v238, v161, v238
    v_mfma_f32_16x16x32_bf16 v[186:189], a[40:43], v[178:181], v[186:189]
    v_exp_f32 v192, v192
    v_mfma_f32_16x16x32_bf16 v[186:189], a[44:47], v[218:221], v[186:189]
    v_exp_f32 v193, v193
    v_mfma_f32_16x16x32_bf16 v[146:149], a[68:71], v[218:221], 0
    v_cvt_pk_bf16_f32 v115, v192, v193
    v_mul_f32 v239, v161, v239
    v_mfma_f32_16x16x32_bf16 v[146:149], a[64:67], v[178:181], v[146:149]
    v_exp_f32 v206, v206
    v_mfma_f32_16x16x32_bf16 v[146:149], a[60:63], v[210:213], v[146:149]
    v_exp_f32 v207, v207
    v_mfma_f32_16x16x32_bf16 v[146:149], a[56:59], v[202:205], v[146:149]
    v_cvt_pk_f16_f32 v152, v186, v187
    v_pk_fma_f16 v174, v152, v152, v174
    v_mfma_f32_16x16x32_bf16 v[146:149], a[52:55], v[226:229], v[146:149]
    v_cvt_pk_f16_f32 v153, v188, v189
    v_pk_fma_f16 v174, v153, v153, v174
    v_mfma_f32_16x16x32_bf16 v[146:149], a[48:51], v[222:225], v[146:149]
    v_pk_fma_f16 v176, v152, v116, v176
    v_pk_fma_f16 v176, v153, v117, v176
    v_mfma_f32_16x16x32_bf16 v[186:189], v[222:225], a[144:147], 0
    v_cvt_pk_bf16_f32 v116, v206, v207
    v_cvt_pk_bf16_f32 v238, v238, v239
    v_mfma_f32_16x16x32_bf16 v[186:189], v[226:229], a[148:151], v[186:189]
    buffer_store_dwordx4 v[170:173], v16, s[52:55], 0 offen nt
    v_exp_f32 v208, v208
    v_cvt_pk_f16_f32 v154, v146, v147
    v_pk_fma_f16 v174, v154, v154, v174
    v_mfma_f32_16x16x32_bf16 v[186:189], v[202:205], a[152:155], v[186:189]
    v_cvt_pk_f16_f32 v155, v148, v149
    v_pk_fma_f16 v174, v155, v155, v174
    v_mfma_f32_16x16x32_bf16 v[186:189], v[210:213], a[156:159], v[186:189]
    v_pk_fma_f16 v176, v154, v194, v176
    v_pk_fma_f16 v176, v155, v195, v176
    v_mfma_f32_16x16x32_bf16 v[186:189], v[178:181], a[160:163], v[186:189]
    ds_read2_b32 v[148:149], v6 offset0:0 offset1:0
    ds_read2_b32 v[172:173], v6 offset0:16 offset1:16
    v_mfma_f32_16x16x32_f16 v[190:193], v[40:43], v[174:177], 0
    ds_read2_b32 v[176:177], v6 offset0:32 offset1:32
    v_mul_f32 v240, v161, v240
    v_mfma_f32_16x16x32_bf16 v[186:189], v[218:221], a[164:167], v[186:189]
    v_exp_f32 v209, v209
    v_mfma_f32_16x16x32_bf16 v[194:197], v[218:221], a[188:191], 0
    v_cvt_pk_bf16_f32 v117, v208, v209
    v_mul_f32 v241, v161, v241
    v_mfma_f32_16x16x32_bf16 v[194:197], v[178:181], a[184:187], v[194:197]
    v_rsq_f32 v190, v190
    v_mfma_f32_16x16x32_bf16 v[194:197], v[210:213], a[180:183], v[194:197]
    ds_read_b128 v[206:209], v2 offset:12288
    ds_read_b128 v[230:233], v2 offset:13312
    v_mfma_f32_16x16x32_bf16 v[194:197], v[202:205], a[176:179], v[194:197]
    ds_read_b128 v[234:237], v2 offset:14336
    ds_read_b128 v[242:245], v2 offset:15360
    v_mfma_f32_16x16x32_bf16 v[194:197], v[226:229], a[172:175], v[194:197]
    v_cvt_pk_bf16_f32 v146, v186, v187
    v_cvt_pk_bf16_f32 v147, v188, v189
    v_mfma_f32_16x16x32_bf16 v[194:197], v[222:225], a[168:171], v[194:197]
    s_waitcnt lgkmcnt(5)
    ds_read_b128 v[186:189], v2 offset:16384
    v_rsq_f32 v191, v191
    v_mul_f32 v174, s31, v190
    v_cvt_pk_f16_f32 v175, v174, v191
    v_fma_f32 v192, v192, v174, v26
    v_fmac_f32_dpp v254, v193, v191 quad_perm:[0,1,2,3] row_mask:0x4 bank_mask:0xf
    v_pk_mul_f16 v162, v162, v175 op_sel:[0,1] op_sel_hi:[1,1]
    v_cvt_pk_bf16_f32 v170, v194, v195
    v_cvt_pk_bf16_f32 v171, v196, v197
    v_mfma_f32_16x16x32_bf16 v[194:197], v[222:225], a[192:195], 0
    s_waitcnt lgkmcnt(5)
    ds_read_b128 v[222:225], v2 offset:17408
    v_pk_mul_f16 v163, v163, v175 op_sel:[0,1] op_sel_hi:[1,1]
    v_mfma_f32_16x16x32_bf16 v[194:197], v[226:229], a[196:199], v[194:197]
    v_pk_mul_f16 v164, v164, v175 op_sel:[0,1] op_sel_hi:[1,1]
    v_pk_mul_f16 v165, v165, v175 op_sel:[0,1] op_sel_hi:[1,1]
    v_mfma_f32_16x16x32_bf16 v[194:197], v[202:205], a[200:203], v[194:197]
    s_waitcnt lgkmcnt(4)
    v_pk_mul_f16 v156, v156, v175 op_sel:[0,1] op_sel_hi:[1,1]
    v_pk_mul_f16 v157, v157, v175 op_sel:[0,1] op_sel_hi:[1,1]
    v_mfma_f32_16x16x32_f16 v[202:205], v[162:165], v[130:133], v[54:57]
    s_waitcnt lgkmcnt(2)
    v_pk_mul_f16 v150, v150, v175 op_sel:[0,0] op_sel_hi:[1,0]
    v_pk_mul_f16 v151, v151, v175 op_sel:[0,0] op_sel_hi:[1,0]
    v_mfma_f32_16x16x32_bf16 v[194:197], v[210:213], a[204:207], v[194:197]
    v_pk_mul_f16 v152, v152, v175 op_sel:[0,0] op_sel_hi:[1,0]
    v_pk_mul_f16 v153, v153, v175 op_sel:[0,0] op_sel_hi:[1,0]
    v_pk_mul_f16 v154, v154, v175 op_sel:[0,0] op_sel_hi:[1,0]
    v_mfma_f32_16x16x16_f16 v[202:205], v[156:157], v[166:167], v[202:205]
    v_pk_mul_f16 v155, v155, v175 op_sel:[0,0] op_sel_hi:[1,0]
    v_max3_u32 v44, v44, v190, v191
    v_exp_f32 v254, v254
    v_mfma_f32_16x16x32_bf16 v[194:197], v[178:181], a[208:211], v[194:197]
    s_waitcnt lgkmcnt(1)
    v_cvt_pk_bf16_f32 v254, v254, v254
    v_sub_u32 v190, 0x40800000, v44
    v_mfma_f32_16x16x32_bf16 v[194:197], v[218:221], a[212:215], v[194:197]
    s_waitcnt lgkmcnt(0)
    ds_write_b16 v8, v254
    v_mfma_f32_16x16x32_f16 v[130:133], v[182:185], v[214:217], v[58:61]
    v_exp_f32 v202, v202
    v_mfma_f32_16x16x32_bf16 v[178:181], a[216:219], v[206:209], 0
    v_exp_f32 v203, v203
    v_mfma_f32_16x16x32_bf16 v[178:181], a[220:223], v[230:233], v[178:181]
    v_cvt_pk_bf16_f32 v36, v202, v203
    v_cvt_pk_bf16_f32 v174, v194, v195
    v_cvt_pk_bf16_f32 v175, v196, v197
    v_mfma_f32_16x16x16_f16 v[130:133], v[168:169], v[122:123], v[130:133]
    v_exp_f32 v204, v204
    v_exp_f32 v205, v205
    v_mfma_f32_16x16x32_f16 v[194:197], v[134:137], v[214:217], v[62:65]
    v_cvt_pk_bf16_f32 v37, v204, v205
    v_or_b32 v190, v190, v44
    v_mfma_f32_16x16x32_f16 v[202:205], v[162:165], v[214:217], v[66:69]
    v_exp_f32 v192, v192
    v_mfma_f32_16x16x32_bf16 v[210:213], v[28:31], v[36:39], 0
    v_exp_f32 v130, v130
    v_mfma_f32_16x16x32_bf16 v[210:213], v[28:31], v[114:117], v[210:213]
    v_exp_f32 v131, v131
    v_mfma_f32_16x16x32_bf16 v[214:217], v[118:121], v[114:117], 0
    v_cvt_pk_bf16_f32 v130, v130, v131
    v_cvt_pk_bf16_f32 v239, v240, v241
    v_mfma_f32_16x16x32_bf16 v[214:217], v[146:149], v[36:39], v[214:217]
    buffer_store_dwordx2 v[238:239], v19, s[52:55], 0 offen nt
    v_exp_f32 v132, v132
    v_mfma_f32_16x16x32_bf16 v[218:221], v[170:173], v[36:39], 0
    v_exp_f32 v133, v133
    v_mfma_f32_16x16x32_bf16 v[218:221], v[126:129], v[114:117], v[218:221]
    v_cvt_pk_bf16_f32 v131, v132, v133
    v_cmp_ne_u32 vcc, 0, v144
    v_mfma_f32_16x16x32_bf16 v[226:229], v[138:141], v[114:117], 0
    v_rcp_f32 v211, v210
    v_mfma_f32_16x16x32_bf16 v[226:229], v[174:177], v[36:39], v[226:229]
    v_cvt_pk_bf16_f32 v39, v160, 0
    v_max3_u32 v25, v25, v211, v210
    v_mul_f32 v214, v211, v214
    v_mfma_f32_16x16x16_f16 v[194:197], v[124:125], v[122:123], v[194:197]
    v_mul_f32 v215, v211, v215
    v_cvt_pk_bf16_f32 v114, v214, v215
    v_mul_f32 v216, v211, v216
    v_mfma_f32_16x16x16_f16 v[202:205], v[156:157], v[122:123], v[202:205]
    v_mul_f32 v217, v211, v217
    v_cvt_pk_bf16_f32 v115, v216, v217
    v_mul_f32 v218, v211, v218
    v_mul_f32 v219, v211, v219
    v_mfma_f32_16x16x32_f16 v[158:161], v[182:185], v[150:153], v[70:73]
    ds_write_b64 v3, v[114:115] offset:0
    v_mfma_f32_16x16x32_bf16 v[178:181], a[224:227], v[234:237], v[178:181]
    v_exp_f32 v194, v194
    v_mfma_f32_16x16x32_f16 v[182:185], v[134:137], v[150:153], v[74:77]
    v_exp_f32 v195, v195
    v_mfma_f32_16x16x32_bf16 v[178:181], a[228:231], v[242:245], v[178:181]
    v_cvt_pk_bf16_f32 v132, v194, v195
    v_exp_f32 v196, v196
    v_mfma_f32_16x16x16_f16 v[158:161], v[168:169], v[154:155], v[158:161]
    v_exp_f32 v197, v197
    v_cvt_pk_bf16_f32 v116, v218, v219
    v_mfma_f32_16x16x16_f16 v[182:185], v[124:125], v[154:155], v[182:185]
    v_cvt_pk_bf16_f32 v133, v196, v197
    v_exp_f32 v202, v202
    v_mul_f32 v220, v211, v220
    v_mfma_f32_16x16x32_f16 v[122:125], v[162:165], v[150:153], v[78:81]
    v_exp_f32 v203, v203
    v_mfma_f32_16x16x32_bf16 v[178:181], a[232:235], v[186:189], v[178:181]
    v_cvt_pk_bf16_f32 v36, v202, v203
    v_mul_f32 v221, v211, v221
    v_mfma_f32_16x16x32_bf16 v[178:181], a[236:239], v[222:225], v[178:181]
    v_exp_f32 v204, v204
    v_cvt_pk_bf16_f32 v117, v220, v221
    v_mfma_f32_16x16x16_f16 v[122:125], v[156:157], v[154:155], v[122:125]
    v_exp_f32 v205, v205
    v_exp_f32 v158, v158
    v_mfma_f32_16x16x32_bf16 v[134:137], v[86:89], v[222:225], 0
    ds_write_b64 v3, v[116:117] offset:8
    v_mfma_f32_16x16x32_bf16 v[134:137], v[82:85], v[186:189], v[134:137]
    v_fma_f32 v144, v178, v178, s33
    v_fmac_f32 v144, v179, v179
    v_mfma_f32_16x16x32_bf16 v[134:137], a[252:255], v[242:245], v[134:137]
    ds_read_b128 v[114:117], v200 offset:0
    ds_read_b128 v[150:153], v200 offset:2048
    v_mfma_f32_16x16x32_bf16 v[134:137], a[248:251], v[234:237], v[134:137]
    ds_read_b128 v[154:157], v200 offset:4096
    v_fmac_f32 v144, v180, v180
    v_mfma_f32_16x16x32_bf16 v[134:137], a[244:247], v[230:233], v[134:137]
    ds_read_b128 v[162:165], v200 offset:6144
    v_fmac_f32 v144, v181, v181
    v_mfma_f32_16x16x32_bf16 v[134:137], a[240:243], v[206:209], v[134:137]
    ds_read_b128 v[166:169], v200 offset:8192
    v_cvt_pk_bf16_f32 v37, v204, v205
    v_mfma_f32_16x16x32_bf16 v[194:197], v[90:93], v[206:209], 0
    ds_read_b128 v[202:205], v200 offset:10240
    v_mul_f32 v226, v211, v226
    v_mfma_f32_16x16x32_bf16 v[206:209], v[28:31], v[36:39], 0
    v_exp_f32 v159, v159
    v_mfma_f32_16x16x32_bf16 v[206:209], v[28:31], v[130:133], v[206:209]
    v_fmac_f32 v144, v134, v134
    v_fmac_f32 v144, v135, v135
    v_mfma_f32_16x16x32_bf16 v[214:217], v[118:121], v[130:133], 0
    v_fmac_f32 v144, v136, v136
    v_fmac_f32 v144, v137, v137
    v_mfma_f32_16x16x32_bf16 v[214:217], v[146:149], v[36:39], v[214:217]
    s_waitcnt lgkmcnt(4)
    v_cvt_pk_bf16_f32 v158, v158, v159
    v_mul_f32 v227, v211, v227
    v_mfma_f32_16x16x32_bf16 v[218:221], v[170:173], v[36:39], 0
    s_waitcnt lgkmcnt(3)
    v_rcp_f32 v207, v206
    v_mfma_f32_16x16x32_bf16 v[218:221], v[126:129], v[130:133], v[218:221]
    s_waitcnt lgkmcnt(2)
    v_max3_u32 v25, v25, v207, v206
    v_mul_f32 v214, v207, v214
    v_mfma_f32_16x16x32_bf16 v[238:241], v[138:141], v[130:133], 0
    s_waitcnt lgkmcnt(1)
    v_mul_f32 v215, v207, v215
    v_cvt_pk_bf16_f32 v130, v214, v215
    v_mfma_f32_16x16x32_bf16 v[238:241], v[174:177], v[36:39], v[238:241]
    s_waitcnt lgkmcnt(0)
    v_mul_f32 v216, v207, v216
    v_mul_f32 v217, v207, v217
    v_mfma_f32_16x16x32_bf16 v[194:197], v[94:97], v[230:233], v[194:197]
    v_cvt_pk_bf16_f32 v131, v216, v217
    v_mul_f32 v218, v207, v218
    v_mfma_f32_16x16x32_bf16 v[194:197], v[98:101], v[234:237], v[194:197]
    ds_write_b64 v3, v[130:131] offset:6144
    v_mfma_f32_16x16x32_bf16 v[194:197], v[102:105], v[242:245], v[194:197]
    v_mul_f32 v219, v207, v219
    v_cvt_pk_bf16_f32 v132, v218, v219
    v_mfma_f32_16x16x32_bf16 v[194:197], v[106:109], v[186:189], v[194:197]
    v_mul_f32 v220, v207, v220
    v_mul_f32 v221, v207, v221
    v_mfma_f32_16x16x32_bf16 v[194:197], v[110:113], v[222:225], v[194:197]
    v_cvt_pk_bf16_f32 v133, v220, v221
    v_mul_f32 v238, v207, v238
    v_mfma_f32_16x16x32_bf16 v[186:189], a[216:219], v[114:117], 0
    ds_write_b64 v3, v[132:133] offset:6152
    v_mfma_f32_16x16x32_bf16 v[186:189], a[220:223], v[150:153], v[186:189]
    v_mul_f32 v239, v207, v239
    v_cvt_pk_bf16_f32 v238, v238, v239
    v_mfma_f32_16x16x32_bf16 v[186:189], a[224:227], v[154:157], v[186:189]
    v_fmac_f32 v144, v194, v194
    v_fmac_f32 v144, v195, v195
    v_mfma_f32_16x16x32_bf16 v[186:189], a[228:231], v[162:165], v[186:189]
    v_fmac_f32 v144, v196, v196
    v_fmac_f32 v144, v197, v197
    v_mfma_f32_16x16x32_bf16 v[186:189], a[232:235], v[166:169], v[186:189]
    v_mul_f32 v240, v207, v240
    v_mul_f32 v241, v207, v241
    v_mfma_f32_16x16x32_bf16 v[186:189], a[236:239], v[202:205], v[186:189]
    v_cvt_pk_bf16_f32 v239, v240, v241
    v_cvt_pk_bf16_f32 v39, v192, 0
    v_mfma_f32_16x16x32_bf16 v[130:133], v[86:89], v[202:205], 0
    ds_write_b64 v4, v[238:239] offset:10240
    v_mfma_f32_16x16x32_bf16 v[130:133], v[82:85], v[166:169], v[130:133]
    v_exp_f32 v160, v160
    v_mfma_f32_16x16x32_bf16 v[130:133], a[252:255], v[162:165], v[130:133]
    v_exp_f32 v161, v161
    v_mfma_f32_16x16x32_bf16 v[130:133], a[248:251], v[154:157], v[130:133]
    v_fma_f32 v254, v186, v186, s33
    v_fmac_f32 v254, v187, v187
    v_mfma_f32_16x16x32_bf16 v[130:133], a[244:247], v[150:153], v[130:133]
    v_fmac_f32 v254, v188, v188
    v_fmac_f32 v254, v189, v189
    v_mfma_f32_16x16x32_bf16 v[130:133], a[240:243], v[114:117], v[130:133]
    v_cvt_pk_bf16_f32 v159, v160, v161
    v_cvt_pk_bf16_f32 v226, v226, v227
    v_mfma_f32_16x16x32_bf16 v[206:209], v[90:93], v[114:117], 0
    v_exp_f32 v182, v182
    v_mfma_f32_16x16x32_bf16 v[206:209], v[94:97], v[150:153], v[206:209]
    v_exp_f32 v183, v183
    v_mfma_f32_16x16x32_bf16 v[206:209], v[98:101], v[154:157], v[206:209]
    v_cvt_pk_bf16_f32 v160, v182, v183
    v_fmac_f32 v254, v130, v130
    v_mfma_f32_16x16x32_bf16 v[206:209], v[102:105], v[162:165], v[206:209]
    v_fmac_f32 v254, v131, v131
    v_fmac_f32 v254, v132, v132
    v_mfma_f32_16x16x32_bf16 v[206:209], v[106:109], v[166:169], v[206:209]
    v_fmac_f32 v254, v133, v133
    v_mul_f32 v228, v211, v228
    v_mfma_f32_16x16x32_bf16 v[206:209], v[110:113], v[202:205], v[206:209]
    v_exp_f32 v184, v184
    v_exp_f32 v185, v185
    v_exp_f32 v122, v122
    v_cvt_pk_bf16_f32 v161, v184, v185
    v_exp_f32 v123, v123
    v_exp_f32 v124, v124
    v_cvt_pk_bf16_f32 v36, v122, v123
    v_exp_f32 v125, v125
    ds_read_b128 v[114:117], v9
    ds_read_b128 v[150:153], v9 offset:64
    v_fmac_f32 v254, v206, v206
    v_fmac_f32 v254, v207, v207
    v_fmac_f32 v254, v208, v208
    v_fmac_f32 v254, v209, v209
    v_cvt_pk_bf16_f32 v122, v144, v254
    v_cvt_pk_bf16_f32 v123, v254, v254
    ds_write_b64 v142, v[122:123] offset:2048
    v_cvt_pk_bf16_f32 v37, v124, v125
    v_mul_f32 v229, v211, v229
    v_cvt_pk_bf16_f32 v227, v228, v229
    v_mfma_f32_16x16x32_bf16 v[122:125], v[28:31], v[36:39], 0
    ds_write_b64 v4, v[226:227] offset:4096
    v_mfma_f32_16x16x32_bf16 v[122:125], v[28:31], v[158:161], v[122:125]
    v_add_u32 v254, s7, v145
    v_cndmask_b32 v254, v143, v254, vcc
    v_mfma_f32_16x16x32_bf16 v[154:157], v[118:121], v[158:161], 0
    v_lshl_add_u32 v144, v198, 4, v254
    v_add_u32 v144, s3, v144
    v_mfma_f32_16x16x32_bf16 v[154:157], v[146:149], v[36:39], v[154:157]
    s_waitcnt lgkmcnt(2)
    v_lshl_add_u32 v254, v198, 3, v254
    v_add_u32 v254, s4, v254
    v_mfma_f32_16x16x32_bf16 v[162:165], v[170:173], v[36:39], 0
    v_rcp_f32 v123, v122
    v_mfma_f32_16x16x32_bf16 v[162:165], v[126:129], v[158:161], v[162:165]
    v_max3_u32 v25, v25, v123, v122
    v_xor_b32 v145, 65536, v2
    v_mfma_f32_16x16x32_bf16 v[166:169], v[138:141], v[158:161], 0
    v_mul_f32 v154, v123, v154
    v_mul_f32 v155, v123, v155
    v_mfma_f32_16x16x32_bf16 v[166:169], v[174:177], v[36:39], v[166:169]
    s_waitcnt lgkmcnt(0)
    v_cvt_pk_bf16_f32 v154, v154, v155
    v_mul_f32 v156, v123, v156
    v_mfma_f32_16x16x32_bf16 v[158:161], v[114:117], v[28:31], 0
    s_barrier
    ds_read_b128 v[182:185], v201 offset:2048
    ds_read_b128 v[202:205], v201 offset:3072
    v_mfma_f32_16x16x32_bf16 v[158:161], v[150:153], v[28:31], v[158:161]
    ds_read_b128 v[210:213], v145 offset:0
    ds_read_b128 v[214:217], v145 offset:1024
    v_mfma_f32_16x16x32_bf16 v[218:221], v[150:153], v[146:149], 0
    v_mul_f32 v157, v123, v157
    v_cvt_pk_bf16_f32 v155, v156, v157
    v_mfma_f32_16x16x32_bf16 v[218:221], v[114:117], v[118:121], v[218:221]
    ds_read_b128 v[118:121], v145 offset:2048
    ds_read_b128 v[146:149], v145 offset:3072
    v_mfma_f32_16x16x32_bf16 v[222:225], v[114:117], v[126:129], 0
    v_mul_f32 v162, v123, v162
    v_mul_f32 v163, v123, v163
    v_mfma_f32_16x16x32_bf16 v[222:225], v[150:153], v[170:173], v[222:225]
    ds_read_b128 v[126:129], v145 offset:4096
    ds_read_b128 v[170:173], v145 offset:5120
    v_mfma_f32_16x16x32_bf16 v[226:229], v[150:153], v[174:177], 0
    v_cvt_pk_bf16_f32 v156, v162, v163
    v_mul_f32 v164, v123, v164
    v_mfma_f32_16x16x32_bf16 v[226:229], v[114:117], v[138:141], v[226:229]
    ds_write_b64 v3, v[154:155] offset:12288
    s_waitcnt lgkmcnt(7)
    v_mfma_f32_16x16x32_bf16 v[114:117], v[32:35], v[182:185], 0
    s_waitcnt lgkmcnt(5)
    v_mul_f32 v165, v123, v165
    v_cvt_pk_bf16_f32 v157, v164, v165
    v_mfma_f32_16x16x32_bf16 v[114:117], v[32:35], v[202:205], v[114:117]
    ds_write_b64 v3, v[156:157] offset:12296
    v_mfma_f32_16x16x32_bf16 v[138:141], a[216:219], v[210:213], 0
    s_waitcnt lgkmcnt(4)
    v_mul_f32 v166, v123, v166
    v_mul_f32 v167, v123, v167
    v_mfma_f32_16x16x32_bf16 v[138:141], a[220:223], v[214:217], v[138:141]
    v_cvt_pk_bf16_f32 v166, v166, v167
    v_mul_f32 v168, v123, v168
    v_mfma_f32_16x16x32_bf16 v[138:141], a[224:227], v[118:121], v[138:141]
    s_waitcnt lgkmcnt(2)
    v_mul_f32 v167, 0x3baaaaab, v115
    v_mul_f32 v169, v123, v169
    v_mfma_f32_16x16x32_bf16 v[138:141], a[228:231], v[146:149], v[138:141]
    v_rsq_f32 v167, v167
    v_mfma_f32_16x16x32_bf16 v[138:141], a[232:235], v[126:129], v[138:141]
    v_mul_f32 v186, v167, v186
    v_mul_f32 v187, v167, v187
    v_mfma_f32_16x16x32_bf16 v[138:141], a[236:239], v[170:173], v[138:141]
    v_cvt_pk_bf16_f32 v122, v186, v187
    v_mul_f32 v188, v167, v188
    v_mfma_f32_16x16x32_bf16 v[150:153], v[86:89], v[170:173], 0
    v_mul_f32 v189, v167, v189
    v_cvt_pk_bf16_f32 v123, v188, v189
    v_mfma_f32_16x16x32_bf16 v[150:153], v[82:85], v[126:129], v[150:153]
    ds_read_b128 v[154:157], v145 offset:11264
    v_mul_f32 v130, v167, v130
    v_mfma_f32_16x16x32_bf16 v[150:153], a[252:255], v[146:149], v[150:153]
    ds_read_b128 v[162:165], v145 offset:10240
    v_mul_f32 v131, v167, v131
    v_mfma_f32_16x16x32_bf16 v[150:153], a[248:251], v[118:121], v[150:153]
    ds_read_b128 v[174:177], v145 offset:9216
    v_cvt_pk_bf16_f32 v124, v130, v131
    v_mfma_f32_16x16x32_bf16 v[150:153], a[244:247], v[214:217], v[150:153]
    ds_read_b128 v[182:185], v145 offset:8192
    v_mul_f32 v132, v167, v132
    v_mfma_f32_16x16x32_bf16 v[150:153], a[240:243], v[210:213], v[150:153]
    ds_read_b128 v[186:189], v145 offset:7168
    v_mul_f32 v133, v167, v133
    v_mfma_f32_16x16x32_bf16 v[202:205], v[90:93], v[210:213], 0
    ds_read_b128 v[210:213], v145 offset:6144
    v_cvt_pk_bf16_f32 v125, v132, v133
    v_mfma_f32_16x16x32_bf16 v[202:205], v[94:97], v[214:217], v[202:205]
    buffer_store_dwordx4 v[122:125], v144, s[12:15], 0 offen nt
    v_mul_f32 v206, v167, v206
    v_mul_f32 v207, v167, v207
    v_cvt_pk_bf16_f32 v160, v206, v207
    v_mul_f32 v208, v167, v208
    v_mfma_f32_16x16x32_bf16 v[202:205], v[98:101], v[118:121], v[202:205]
    s_waitcnt lgkmcnt(5)
    v_mul_f32 v209, v167, v209
    v_cvt_pk_bf16_f32 v161, v208, v209
    v_mfma_f32_16x16x32_bf16 v[118:121], v[110:113], v[154:157], 0
    s_waitcnt lgkmcnt(4)
    v_cvt_pk_bf16_f32 v167, v168, v169
    v_fma_f32 v144, v138, v138, s33
    v_mfma_f32_16x16x32_bf16 v[118:121], v[106:109], v[162:165], v[118:121]
    s_waitcnt lgkmcnt(3)
    ds_write_b64 v4, v[166:167] offset:16384
    v_mfma_f32_16x16x32_bf16 v[118:121], v[102:105], v[174:177], v[118:121]
    s_waitcnt lgkmcnt(3)
    v_fmac_f32 v144, v139, v139
    v_fmac_f32 v144, v140, v140
    v_mfma_f32_16x16x32_bf16 v[118:121], v[98:101], v[182:185], v[118:121]
    s_waitcnt lgkmcnt(2)
    v_fmac_f32 v144, v141, v141
    v_fmac_f32 v144, v150, v150
    v_mfma_f32_16x16x32_bf16 v[118:121], v[94:97], v[186:189], v[118:121]
    s_waitcnt lgkmcnt(1)
    v_fmac_f32 v144, v151, v151
    v_fmac_f32 v144, v152, v152
    v_mfma_f32_16x16x32_bf16 v[118:121], v[90:93], v[210:213], v[118:121]
    v_fmac_f32 v144, v153, v153
    v_mul_f32 v219, 0x3baaaaab, v114
    v_mfma_f32_16x16x32_bf16 v[114:117], a[240:243], v[210:213], 0
    v_rcp_f32_dpp v159, v158 quad_perm:[0,0,0,0] row_mask:0xf bank_mask:0xf
    v_mfma_f32_16x16x32_bf16 v[114:117], a[244:247], v[186:189], v[114:117]
    v_max3_u32 v25, v25, v158, v159
    v_sub_u32 v158, 0x67800000, v25
    v_mfma_f32_16x16x32_bf16 v[114:117], a[248:251], v[182:185], v[114:117]
    v_fma_f32 v220, v118, v118, s33
    v_fmac_f32 v220, v119, v119
    v_mfma_f32_16x16x32_bf16 v[114:117], a[252:255], v[174:177], v[114:117]
    v_fmac_f32 v220, v120, v120
    v_fmac_f32 v220, v121, v121
    v_mfma_f32_16x16x32_bf16 v[114:117], v[82:85], v[162:165], v[114:117]
    v_or3_b32 v190, v190, v158, v25
    v_lshl_add_u32 v158, s16, 2, v145
    v_mfma_f32_16x16x32_bf16 v[114:117], v[86:89], v[154:157], v[114:117]
    ds_write_b32 v158, v190 offset:18432
    v_mfma_f32_16x16x32_bf16 v[122:125], a[236:239], v[154:157], 0
    v_mul_f32 v218, v218, v159
    v_bfe_u32 v221, v199, 1, 2
    v_mfma_f32_16x16x32_bf16 v[122:125], a[232:235], v[162:165], v[122:125]
    buffer_store_dwordx2 v[160:161], v254, s[12:15], 0 offen nt
    v_mul_f32_dpp v218, v222, v159 quad_perm:[0,1,2,3] row_mask:0x2 bank_mask:0xf
    v_xor_b32 v221, v221, v198
    v_mfma_f32_16x16x32_bf16 v[122:125], a[228:231], v[174:177], v[122:125]
    v_fmac_f32 v220, v114, v114
    v_fmac_f32 v220, v115, v115
    v_mfma_f32_16x16x32_bf16 v[122:125], a[224:227], v[182:185], v[122:125]
    v_fmac_f32 v220, v116, v116
    v_fmac_f32 v220, v117, v117
    v_mfma_f32_16x16x32_bf16 v[122:125], a[220:223], v[186:189], v[122:125]
    v_mul_f32_dpp v218, v226, v159 quad_perm:[0,1,2,3] row_mask:0x4 bank_mask:0xf
    v_cvt_pk_bf16_f32 v218, v218, v218
    v_mfma_f32_16x16x32_bf16 v[122:125], a[216:219], v[210:213], v[122:125]
    ds_write_b16 v7, v218
    v_mfma_f32_16x16x32_bf16 v[202:205], v[102:105], v[146:149], v[202:205]
    v_rsq_f32 v219, v219
    v_mfma_f32_16x16x32_bf16 v[202:205], v[106:109], v[126:129], v[202:205]
    v_mul_f32 v178, v219, v178
    v_mul_f32 v179, v219, v179
    v_mfma_f32_16x16x32_bf16 v[202:205], v[110:113], v[170:173], v[202:205]
    v_cvt_pk_bf16_f32 v126, v178, v179
    v_fmac_f32 v220, v122, v122
    v_fmac_f32 v220, v123, v123
    v_fmac_f32 v220, v124, v124
    v_fmac_f32 v220, v125, v125
    v_cvt_pk_bf16_f32 v179, v220, v220
    v_mul_f32 v180, v219, v180
    v_mul_f32 v181, v219, v181
    v_fmac_f32 v144, v202, v202
    v_fmac_f32 v144, v203, v203
    v_fmac_f32 v144, v204, v204
    v_fmac_f32 v144, v205, v205
    v_cvt_pk_bf16_f32 v178, v144, v220
    ds_write_b64 v142, v[178:179] offset:7616
    v_cvt_pk_bf16_f32 v127, v180, v181
    v_mul_f32 v134, v219, v134
    v_mul_f32 v135, v219, v135
    v_cvt_pk_bf16_f32 v128, v134, v135
    v_mul_f32 v136, v219, v136
    v_mul_f32 v137, v219, v137
    v_cvt_pk_bf16_f32 v129, v136, v137
    v_mul_f32 v194, v219, v194
    v_mul_f32 v195, v219, v195
    v_cvt_pk_bf16_f32 v218, v194, v195
    v_mul_f32 v196, v219, v196
    v_mul_f32 v197, v219, v197
    v_cvt_pk_bf16_f32 v219, v196, v197
    v_lshl_add_u32 v221, v199, 2, v221
    v_lshl_add_u32 v144, v221, 4, s5
    ds_write_b128 v144, v[126:129] offset:3072
    v_lshl_add_u32 v254, v221, 3, s5
    v_lshl_add_u32 v220, v255, 4, s5
    v_lshl_add_u32 v255, v255, 3, s5
    s_waitcnt lgkmcnt(1)
    s_barrier
    v_lshlrev_b32 v221, 2, v221
    v_add_u32 v199, 16, v199
    ds_read_b128 v[126:129], v201 offset:7616
    ds_read_b128 v[130:133], v201 offset:8640
    ds_read_b128 v[134:137], v145 offset:12288
    ds_read_b128 v[146:149], v145 offset:13312
    ds_read_b128 v[154:157], v145 offset:14336
    ds_read_b128 v[158:161], v145 offset:15360
    ds_read_b128 v[162:165], v145 offset:16384
    ds_read_b128 v[166:169], v145 offset:17408
    ds_read_b128 v[170:173], v220 offset:3072
    ds_write_b64 v254, v[218:219] offset:4096
    s_waitcnt lgkmcnt(7)
    v_mfma_f32_16x16x32_bf16 v[174:177], v[32:35], v[126:129], 0
    s_waitcnt lgkmcnt(6)
    v_min_u32 v218, 20, v199
    v_add_u32 v219, 12, v199
    v_mfma_f32_16x16x32_bf16 v[174:177], v[32:35], v[130:133], v[174:177]
    s_waitcnt lgkmcnt(5)
    ds_read_b64 v[126:127], v255 offset:4096
    ds_permute_b32 v128, v221, v16
    v_mfma_f32_16x16x32_bf16 v[130:133], a[216:219], v[134:137], 0
    s_waitcnt lgkmcnt(6)
    ds_permute_b32 v129, v221, v19
    ds_permute_b32 v178, v221, v17
    v_mfma_f32_16x16x32_bf16 v[130:133], a[220:223], v[146:149], v[130:133]
    s_waitcnt lgkmcnt(7)
    ds_permute_b32 v179, v221, v20
    v_mul_f32 v221, 0x3baaaaab, v174
    v_mfma_f32_16x16x32_bf16 v[130:133], a[224:227], v[154:157], v[130:133]
    s_waitcnt lgkmcnt(7)
    v_rsq_f32 v221, v221
    v_mfma_f32_16x16x32_bf16 v[130:133], a[228:231], v[158:161], v[130:133]
    s_waitcnt lgkmcnt(6)
    v_mul_f32 v138, v221, v138
    v_mul_f32 v139, v221, v139
    v_mfma_f32_16x16x32_bf16 v[130:133], a[232:235], v[162:165], v[130:133]
    v_cvt_pk_bf16_f32 v138, v138, v139
    v_mul_f32 v140, v221, v140
    v_mfma_f32_16x16x32_bf16 v[130:133], a[236:239], v[166:169], v[130:133]
    v_mul_f32 v141, v221, v141
    v_cvt_pk_bf16_f32 v139, v140, v141
    v_mfma_f32_16x16x32_bf16 v[182:185], v[86:89], v[166:169], 0
    v_mul_f32 v150, v221, v150
    v_mul_f32 v151, v221, v151
    v_mfma_f32_16x16x32_bf16 v[182:185], v[82:85], v[162:165], v[182:185]
    s_waitcnt lgkmcnt(3)
    ds_read_b128 v[186:189], v200 offset:10496
    v_cvt_pk_bf16_f32 v140, v150, v151
    v_mfma_f32_16x16x32_bf16 v[182:185], a[252:255], v[158:161], v[182:185]
    s_waitcnt lgkmcnt(2)
    ds_read_b128 v[190:193], v200 offset:8448
    buffer_store_dwordx4 v[170:173], v178, s[52:55], 0 offen nt
    v_mul_f32 v152, v221, v152
    v_mul_f32 v153, v221, v153
    v_cvt_pk_bf16_f32 v141, v152, v153
    v_mul_f32 v202, v221, v202
    v_mfma_f32_16x16x32_bf16 v[182:185], a[248:251], v[154:157], v[182:185]
    s_waitcnt lgkmcnt(2)
    ds_read_b128 v[150:153], v200 offset:6400
    v_mul_f32 v203, v221, v203
    v_mfma_f32_16x16x32_bf16 v[182:185], a[244:247], v[146:149], v[182:185]
    ds_read_b128 v[170:173], v200 offset:4352
    v_cvt_pk_bf16_f32 v180, v202, v203
    v_mfma_f32_16x16x32_bf16 v[182:185], a[240:243], v[134:137], v[182:185]
    ds_read_b128 v[194:197], v200 offset:2304
    v_mul_f32 v204, v221, v204
    v_mfma_f32_16x16x32_bf16 v[206:209], v[90:93], v[134:137], 0
    ds_read_b128 v[134:137], v200 offset:256
    buffer_store_dwordx2 v[126:127], v179, s[52:55], 0 offen nt
    v_mul_f32 v205, v221, v205
    v_cvt_pk_bf16_f32 v181, v204, v205
    v_mfma_f32_16x16x32_bf16 v[206:209], v[94:97], v[146:149], v[206:209]
    s_waitcnt lgkmcnt(5)
    v_fma_f32 v200, v130, v130, s33
    v_fmac_f32 v200, v131, v131
    v_mfma_f32_16x16x32_bf16 v[206:209], v[98:101], v[154:157], v[206:209]
    s_waitcnt lgkmcnt(4)
    v_fmac_f32 v200, v132, v132
    v_fmac_f32 v200, v133, v133
    v_mfma_f32_16x16x32_bf16 v[206:209], v[102:105], v[158:161], v[206:209]
    v_fmac_f32 v200, v182, v182
    v_fmac_f32 v200, v183, v183
    v_mfma_f32_16x16x32_bf16 v[206:209], v[106:109], v[162:165], v[206:209]
    s_waitcnt lgkmcnt(3)
    v_fmac_f32 v200, v184, v184
    v_fmac_f32 v200, v185, v185
    v_mfma_f32_16x16x32_bf16 v[206:209], v[110:113], v[166:169], v[206:209]
    s_waitcnt lgkmcnt(2)
    buffer_store_dwordx4 v[138:141], v15, s[56:59], 0 offen nt
    v_lshrrev_b32 v219, 5, v219
    v_sub_u32 v221, v199, v218
    v_mad_i32_i24 v221, v219, s6, v221
    v_mul_u32_u24 v126, s20, v218
    v_mfma_f32_16x16x32_bf16 v[138:141], v[110:113], v[186:189], 0
    s_waitcnt lgkmcnt(0)
    v_fmac_f32 v200, v206, v206
    v_fmac_f32 v200, v207, v207
    v_mfma_f32_16x16x32_bf16 v[138:141], v[106:109], v[190:193], v[138:141]
    v_fmac_f32 v200, v208, v208
    v_fmac_f32 v200, v209, v209
    v_mfma_f32_16x16x32_bf16 v[138:141], v[102:105], v[150:153], v[138:141]
    v_cvt_pk_bf16_f32 v176, v200, v200
    v_cvt_pk_bf16_f32 v177, v200, v200
    v_mfma_f32_16x16x32_bf16 v[138:141], v[98:101], v[170:173], v[138:141]
    ds_write_b64 v142, v[176:177] offset:9664
    v_mfma_f32_16x16x32_bf16 v[138:141], v[94:97], v[194:197], v[138:141]
    v_add3_u32 v126, v126, v221, s38
    v_mul_u32_u24 v219, 911, v126
    v_mfma_f32_16x16x32_bf16 v[138:141], v[90:93], v[134:137], v[138:141]
    v_lshrrev_b32 v219, 16, v219
    v_mul_u32_u24 v219, s22, v219
    v_mfma_f32_16x16x32_bf16 v[146:149], a[240:243], v[134:137], 0
    v_mad_u32_u24 v219, v218, s21, v219
    v_bfe_u32 v126, s70, v199, 1
    v_mfma_f32_16x16x32_bf16 v[146:149], a[244:247], v[194:197], v[146:149]
    v_cmp_ne_u32 vcc, 0, v126
    v_mul_i32_i24 v221, 2688, v221
    v_mfma_f32_16x16x32_bf16 v[146:149], a[248:251], v[170:173], v[146:149]
    v_fma_f32 v126, v138, v138, s33
    v_fmac_f32 v126, v139, v139
    v_mfma_f32_16x16x32_bf16 v[146:149], a[252:255], v[150:153], v[146:149]
    v_fmac_f32 v126, v140, v140
    v_fmac_f32 v126, v141, v141
    v_mfma_f32_16x16x32_bf16 v[146:149], v[82:85], v[190:193], v[146:149]
    v_add3_u32 v127, v219, v221, s7
    v_cndmask_b32 v127, v143, v127, vcc
    v_mfma_f32_16x16x32_bf16 v[146:149], v[86:89], v[186:189], v[146:149]
    v_lshl_add_u32 v143, v198, 4, v127
    v_add_u32 v143, s3, v143
    v_mfma_f32_16x16x32_bf16 v[154:157], a[236:239], v[186:189], 0
    v_lshl_add_u32 v127, v198, 3, v127
    v_add_u32 v127, s4, v127
    v_mfma_f32_16x16x32_bf16 v[154:157], a[232:235], v[190:193], v[154:157]
    v_mul_f32 v198, 0x3baaaaab, v175
    v_mfma_f32_16x16x32_bf16 v[154:157], a[228:231], v[150:153], v[154:157]
    buffer_store_dwordx2 v[180:181], v18, s[56:59], 0 offen nt
    v_rsq_f32 v198, v198
    v_mfma_f32_16x16x32_bf16 v[154:157], a[224:227], v[170:173], v[154:157]
    v_fmac_f32 v126, v146, v146
    v_fmac_f32 v126, v147, v147
    v_mfma_f32_16x16x32_bf16 v[154:157], a[220:223], v[194:197], v[154:157]
    v_fmac_f32 v126, v148, v148
    v_fmac_f32 v126, v149, v149
    v_mfma_f32_16x16x32_bf16 v[154:157], a[216:219], v[134:137], v[154:157]
    v_mul_f32 v122, v198, v122
    v_mul_f32 v123, v198, v123
    v_cvt_pk_bf16_f32 v122, v122, v123
    v_mul_f32 v124, v198, v124
    v_mul_f32 v125, v198, v125
    v_cvt_pk_bf16_f32 v123, v124, v125
    v_mul_f32 v114, v198, v114
    v_mul_f32 v115, v198, v115
    v_fmac_f32 v126, v154, v154
    v_fmac_f32 v126, v155, v155
    v_fmac_f32 v126, v156, v156
    v_fmac_f32 v126, v157, v157
    v_cvt_pk_bf16_f32 v124, v126, v126
    v_cvt_pk_bf16_f32 v125, v126, v126
    ds_write_b64 v142, v[124:125] offset:15232
    v_cvt_pk_bf16_f32 v124, v114, v115
    v_mul_f32 v116, v198, v116
    v_mul_f32 v117, v198, v117
    v_cvt_pk_bf16_f32 v125, v116, v117
    ds_write_b128 v144, v[122:125] offset:1536
    v_mul_f32 v118, v198, v118
    v_mul_f32 v119, v198, v119
    v_cvt_pk_bf16_f32 v180, v118, v119
    v_mul_f32 v120, v198, v120
    v_mul_f32 v121, v198, v121
    v_cvt_pk_bf16_f32 v181, v120, v121
    ds_read_b128 v[114:117], v220 offset:1536
    ds_write_b64 v254, v[180:181] offset:2560
    s_waitcnt lgkmcnt(3)
    s_barrier
    ds_read_b128 v[118:121], v201 offset:9664
    ds_read_b128 v[122:125], v201 offset:10688
    ds_read_b128 v[134:137], v201 offset:15232
    ds_read_b128 v[150:153], v201 offset:16256
    ds_read_b128 v[158:161], v145 offset:18432
    ds_read_b64 v[180:181], v255 offset:2560
    s_waitcnt lgkmcnt(7)
    buffer_store_dwordx4 v[114:117], v128, s[56:59], 0 offen nt
    s_waitcnt lgkmcnt(5)
    v_mfma_f32_16x16x32_bf16 v[162:165], v[32:35], v[118:121], 0
    s_waitcnt lgkmcnt(4)
    v_mfma_f32_16x16x32_bf16 v[162:165], v[32:35], v[122:125], v[162:165]
    s_waitcnt lgkmcnt(2)
    v_mfma_f32_16x16x32_bf16 v[114:117], v[32:35], v[134:137], 0
    s_waitcnt lgkmcnt(1)
    v_or3_b32 v158, v158, v159, v160
    v_or_b32 v158, v158, v161
    v_mfma_f32_16x16x32_bf16 v[114:117], v[32:35], v[150:153], v[114:117]
    s_waitcnt lgkmcnt(0)
    buffer_store_dwordx2 v[180:181], v129, s[56:59], 0 offen nt
    v_cmp_gt_i32 s[46:47], 0, v158
    v_mul_f32 v142, 0x3baaaaab, v162
    v_rsq_f32 v142, v142
    s_nop 0
    v_mul_f32 v130, v142, v130
    v_mul_f32 v131, v142, v131
    v_mul_f32 v145, 0x3baaaaab, v114
    v_rsq_f32 v145, v145
    v_cvt_pk_bf16_f32 v114, v130, v131
    v_mul_f32 v154, v145, v154
    v_mul_f32 v155, v145, v155
    v_cvt_pk_bf16_f32 v118, v154, v155
    v_mul_f32 v156, v145, v156
    v_mul_f32 v157, v145, v157
    v_cvt_pk_bf16_f32 v119, v156, v157
    v_mul_f32 v146, v145, v146
    v_mul_f32 v147, v145, v147
    v_cvt_pk_bf16_f32 v120, v146, v147
    v_mul_f32 v148, v145, v148
    v_mul_f32 v149, v145, v149
    v_cvt_pk_bf16_f32 v121, v148, v149
    buffer_store_dwordx4 v[118:121], v143, s[12:15], 0 offen nt
    v_mul_f32 v138, v145, v138
    v_mul_f32 v139, v145, v139
    v_cvt_pk_bf16_f32 v180, v138, v139
    v_mul_f32 v140, v145, v140
    v_mul_f32 v141, v145, v141
    v_cvt_pk_bf16_f32 v181, v140, v141
    v_mul_f32 v132, v142, v132
    v_mul_f32 v133, v142, v133
    v_cvt_pk_bf16_f32 v115, v132, v133
    v_mul_f32 v182, v142, v182
    v_mul_f32 v183, v142, v183
    v_cvt_pk_bf16_f32 v116, v182, v183
    v_mul_f32 v184, v142, v184
    v_mul_f32 v185, v142, v185
    v_cvt_pk_bf16_f32 v117, v184, v185
    ds_write_b128 v144, v[114:117] offset:3072
    v_mul_f32 v206, v142, v206
    v_mul_f32 v207, v142, v207
    v_cvt_pk_bf16_f32 v206, v206, v207
    v_mul_f32 v208, v142, v208
    v_mul_f32 v209, v142, v209
    v_cvt_pk_bf16_f32 v207, v208, v209
    buffer_store_dwordx2 v[180:181], v127, s[12:15], 0 offen nt
    ds_read_b128 v[114:117], v220 offset:3072
    ds_write_b64 v254, v[206:207] offset:4096
    ds_read_b64 v[118:119], v255 offset:4096
    s_waitcnt lgkmcnt(2)
    buffer_store_dwordx4 v[114:117], v178, s[56:59], 0 offen nt
    s_waitcnt lgkmcnt(0)
    buffer_store_dwordx2 v[118:119], v179, s[56:59], 0 offen nt
L_end:
    s_nop 1
    s_cmp_lg_u64 s[46:47], 0
    s_cbranch_scc1 L_rerun
L_done:
    s_endpgm
L_rerun:
    s_mov_b32 s44, 0x7f000000
    s_lshr_b32 s100, s70, 20
    s_waitcnt vmcnt(0) lgkmcnt(0)
    s_barrier
    v_mbcnt_lo_u32_b32 v0, -1, 0
    v_mbcnt_hi_u32_b32 v0, -1, v0
    v_lshl_add_u32 v0, s16, 6, v0
    s_nop 7
    s_branch L_again
L_edge:
    v_mov_b32 v254, v0
    v_mov_b32 v255, 0x40000000
    s_lshl_b32 s3, s16, 4
    s_load_dwordx4 s[92:95], s[0:1], s3
    v_and_b32 v130, 63, v0
    s_bfe_u32 s3, s2, 0x50003
    s_lshl_b32 s4, s16, 3
    s_lshr_b32 s98, 0x06143a01, s4
    s_and_b32 s98, s98, 0xff
    s_mul_i32 s3, s3, s98
    s_sub_u32 s98, s98, 1
    s_lshr_b32 s4, 0x0048d800, s4
    s_and_b32 s4, s4, 0xff
    s_lshl_b32 s4, s4, 3
    s_max_u32 s4, s4, 6
    s_sub_u32 s4, s4, s98
    s_sub_u32 s4, s4, 1
    s_min_u32 s3, s3, s4
    v_min_u32 v132, s98, v130
    v_add_lshl_u32 v132, v132, s3, 7
    v_mov_b32 v133, 0
    v_lshrrev_b32 v131, 4, v130
    v_and_b32 v134, 15, v130
    s_mov_b32 s10, 100270464
    s_mov_b32 s11, 0x00020000
    s_mov_b32 s50, 36096
    s_mov_b32 s51, 0x00020000
    s_mov_b32 s70, 193536
    s_mov_b32 s36, 100270464
    s_mov_b32 s22, 1180032
    s_mul_i32 s3, s2, 911
    s_lshr_b32 s3, s3, 16
    s_mul_i32 s35, s3, 72
    s_sub_u32 s38, s2, s35
    s_mul_i32 s3, s3, 1373568
    s_mul_i32 s35, s38, 2688
    s_add_u32 s3, s3, s35
    s_add_u32 s25, s3, 589824
    s_add_u32 s7, s3, 1769472
    s_mov_b32 s20, 31
    s_mov_b32 s21, 4204032
    s_mov_b32 s17, 20
    s_cmp_lt_u32 s2, 240
    s_cselect_b32 s45, 28, 24
    s_mov_b32 s5, 0
    s_mov_b32 s6, 0
    s_cmp_lt_u32 s2, 247
    s_cbranch_scc1 L_inner
    s_mov_b32 s20, 0
    s_mov_b32 s38, 0
    s_sub_u32 s3, s2, 247
    s_and_b32 s3, s3, 3
    s_mul_i32 s3, s3, 7
    s_add_u32 s3, s3, 3
    s_mov_b32 s35, 196224
    s_cmp_lt_u32 s2, 251
    s_cselect_b32 s35, s35, 384
    s_cselect_b32 s6, 1, 0
    s_cselect_b32 s5, 0, 1
    s_mul_i32 s25, s3, s35
    s_mul_i32 s21, s35, 28
    s_cmp_lt_u32 s2, 255
    s_cselect_b32 s17, 18, 1
    s_cselect_b32 s45, 18, 1
    s_cselect_b32 s25, s25, 0
    s_cselect_b32 s6, s6, 1
    s_add_u32 s7, s25, 1179648
L_inner:
    s_mul_i32 s3, s5, 99485568
    s_mul_i32 s35, s5, -784896
    v_mov_b32 v135, s3
    v_mov_b32 v136, s35
    s_add_u32 s7, s7, s35
    s_mul_i32 s3, s6, 194688
    s_mul_i32 s35, s6, -1536
    v_mov_b32 v137, s3
    v_mov_b32 v138, s35
    s_add_u32 s7, s7, s35
    s_bfm_b32 s34, s45, 0
    s_and_b32 s4, s2, 7
    s_sub_u32 s4, 0, s4
    v_mul_u32_u24 v139, 2731, v254
    v_bfe_u32 v140, v139, 17, 3
    v_lshrrev_b32 v139, 16, v139
    v_xor_b32 v141, v140, v254
    v_mul_u32_u24 v140, 37, v139
    v_lshrrev_b32 v140, 8, v140
    v_lshlrev_b32 v141, 4, v141
    v_mad_u32_u24 v10, v140, s70, v141
    v_mul_u32_u24 v140, 37, v139
    v_lshrrev_b32 v140, 8, v140
    v_mul_u32_u24 v142, 7, v140
    v_sub_u32 v142, v139, v142
    v_cmp_gt_u32 vcc, 4, v140
    s_nop 1
    v_cndmask_b32 v140, v136, v135, vcc
    v_cmp_gt_u32 vcc, 4, v142
    s_nop 1
    v_cndmask_b32 v142, v138, v137, vcc
    v_add3_u32 v10, v10, v140, v142
    v_mul_u32_u24 v140, s20, v139
    v_add_u32 v140, s38, v140
    v_mul_u32_u24 v142, 911, v140
    v_lshrrev_b32 v142, 16, v142
    v_mul_u32_u24 v142, s22, v142
    v_mad_u32_u24 v142, v139, s21, v142
    v_bfe_u32 v140, s34, v139, 1
    v_cmp_ne_u32 vcc, 0, v140
    v_add_u32 v140, s7, v142
    s_nop 0
    v_cndmask_b32 v140, v255, v140, vcc
    v_mul_u32_u24 v139, 384, v139
    v_sub_u32 v139, v141, v139
    v_add_u32 v140, v140, v139
    v_add_u32 v139, 256, v254
    v_mul_u32_u24 v141, 2731, v139
    v_bfe_u32 v142, v141, 17, 3
    v_lshrrev_b32 v141, 16, v141
    v_xor_b32 v139, v142, v139
    v_mul_u32_u24 v142, 37, v141
    v_lshrrev_b32 v142, 8, v142
    v_lshlrev_b32 v139, 4, v139
    v_mad_u32_u24 v11, v142, s70, v139
    v_mul_u32_u24 v142, 37, v141
    v_lshrrev_b32 v142, 8, v142
    v_mul_u32_u24 v143, 7, v142
    v_sub_u32 v143, v141, v143
    v_cmp_gt_u32 vcc, 4, v142
    s_nop 1
    v_cndmask_b32 v142, v136, v135, vcc
    v_cmp_gt_u32 vcc, 4, v143
    s_nop 1
    v_cndmask_b32 v143, v138, v137, vcc
    v_add3_u32 v11, v11, v142, v143
    v_min_u32 v142, 20, v141
    v_add_u32 v143, 12, v141
    v_lshrrev_b32 v143, 5, v143
    v_sub_u32 v144, v141, v142
    v_mad_i32_i24 v144, v143, s4, v144
    v_mul_u32_u24 v145, s20, v142
    v_add3_u32 v145, v145, v144, s38
    v_mul_u32_u24 v143, 911, v145
    v_lshrrev_b32 v143, 16, v143
    v_mul_u32_u24 v143, s22, v143
    v_mad_u32_u24 v143, v142, s21, v143
    v_bfe_u32 v145, s34, v141, 1
    v_cmp_ne_u32 vcc, 0, v145
    v_mul_i32_i24 v144, 2688, v144
    v_add3_u32 v142, v143, v144, s7
    v_cndmask_b32 v142, v255, v142, vcc
    v_mul_u32_u24 v141, 384, v141
    v_sub_u32 v141, v139, v141
    v_add_u32 v142, v142, v141
    v_add_u32 v139, 512, v254
    v_mul_u32_u24 v141, 2731, v139
    v_bfe_u32 v143, v141, 17, 3
    v_lshrrev_b32 v141, 16, v141
    v_xor_b32 v139, v143, v139
    v_mul_u32_u24 v143, 37, v141
    v_lshrrev_b32 v143, 8, v143
    v_lshlrev_b32 v139, 4, v139
    v_mad_u32_u24 v12, v143, s70, v139
    v_mul_u32_u24 v143, 37, v141
    v_lshrrev_b32 v143, 8, v143
    v_mul_u32_u24 v144, 7, v143
    v_sub_u32 v144, v141, v144
    v_cmp_gt_u32 vcc, 4, v143
    s_nop 1
    v_cndmask_b32 v143, v136, v135, vcc
    v_cmp_gt_u32 vcc, 4, v144
    s_nop 1
    v_cndmask_b32 v144, v138, v137, vcc
    v_add3_u32 v12, v12, v143, v144
    v_min_u32 v143, 20, v141
    v_add_u32 v144, 12, v141
    v_lshrrev_b32 v144, 5, v144
    v_sub_u32 v145, v141, v143
    v_mad_i32_i24 v145, v144, s4, v145
    v_mul_u32_u24 v150, s20, v143
    v_add3_u32 v150, v150, v145, s38
    v_mul_u32_u24 v144, 911, v150
    v_lshrrev_b32 v144, 16, v144
    v_mul_u32_u24 v144, s22, v144
    v_mad_u32_u24 v144, v143, s21, v144
    v_bfe_u32 v150, s34, v141, 1
    v_cmp_ne_u32 vcc, 0, v150
    v_mul_i32_i24 v145, 2688, v145
    v_add3_u32 v143, v144, v145, s7
    v_cndmask_b32 v143, v255, v143, vcc
    v_mul_u32_u24 v141, 384, v141
    v_sub_u32 v141, v139, v141
    v_add_u32 v143, v143, v141
    s_lshl_b32 s28, s16, 10
    s_add_u32 s28, s28, 20480
    s_waitcnt lgkmcnt(0)
    s_load_dword s101, s[92:93], 0
    s_load_dword s101, s[94:95], 0
    s_cmp_eq_u32 s16, 2
    s_cselect_b64 s[98:99], s[80:81], s[78:79]
    s_cmp_eq_u32 s16, 3
    s_cselect_b64 s[98:99], s[88:89], s[98:99]
    s_mov_b64 s[8:9], s[76:77]
    v_lshl_add_u64 v[132:133], s[98:99], 0, v[132:133]
    s_cmp_eq_u32 s16, 2
    s_cselect_b64 s[98:99], s[84:85], s[82:83]
    s_cmp_eq_u32 s16, 3
    s_cselect_b64 s[98:99], s[86:87], s[98:99]
    v_writelane_b32 v132, s98, 63
    v_writelane_b32 v133, s99, 63
    s_cmp_eq_u32 s16, 0
    s_cbranch_scc1 L_nowue
    global_load_dword a254, v[132:133], off
L_nowue:
    s_add_u32 m0, s28, 65536
    s_nop 0
    buffer_load_dwordx4 v140, s[8:11], 0 offen nt lds
    s_add_u32 m0, s28, 69632
    s_nop 0
    buffer_load_dwordx4 v142, s[8:11], 0 offen lds
    s_add_u32 m0, s28, 73728
    s_nop 0
    buffer_load_dwordx4 v143, s[8:11], 0 offen lds
    s_add_u32 m0, s28, 0
    s_nop 0
    buffer_load_dwordx4 v10, s[8:11], s25 offen nt lds
    s_add_u32 m0, s28, 4096
    s_nop 0
    buffer_load_dwordx4 v11, s[8:11], s25 offen nt lds
    s_mov_b64 s[48:49], s[78:79]
    s_mov_b64 s[52:53], s[80:81]
    s_mov_b64 s[60:61], s[84:85]
    s_mov_b64 s[64:65], s[86:87]
    s_mov_b64 s[56:57], s[88:89]
    s_mov_b64 s[46:47], s[82:83]
    s_load_dwordx4 s[40:43], s[0:1], 72
    s_mul_i32 s3, s16, 96
    v_lshl_add_u32 v132, v130, 4, s3
    v_mul_u32_u24 v133, 171, v130
    v_lshrrev_b32 v133, 10, v133
    v_lshrrev_b32 v139, 1, v133
    v_xor_b32 v139, v139, v133
    v_and_b32 v139, 4, v139
    v_mul_u32_u24 v139, 3, v139
    v_xor_b32 v139, v139, v133
    v_mul_u32_u24 v139, 1152, v139
    v_mul_u32_u24 v140, 96, v133
    v_sub_u32 v139, v139, v140
    v_add_u32 v140, v132, v139
    v_add_u32 v139, 64, v130
    v_mul_u32_u24 v139, 171, v139
    v_lshrrev_b32 v139, 10, v139
    v_lshrrev_b32 v141, 1, v139
    v_xor_b32 v141, v141, v139
    v_and_b32 v141, 4, v141
    v_mul_u32_u24 v141, 3, v141
    v_xor_b32 v141, v141, v139
    v_mul_u32_u24 v141, 1152, v141
    v_mul_u32_u24 v142, 96, v139
    v_sub_u32 v141, v141, v142
    v_add_u32 v142, v132, v141
    v_add_u32 v141, 128, v130
    v_mul_u32_u24 v141, 171, v141
    v_lshrrev_b32 v141, 10, v141
    v_lshrrev_b32 v143, 1, v141
    v_xor_b32 v143, v143, v141
    v_and_b32 v143, 4, v143
    v_mul_u32_u24 v143, 3, v143
    v_xor_b32 v143, v143, v141
    v_mul_u32_u24 v143, 1152, v143
    v_mul_u32_u24 v144, 96, v141
    v_sub_u32 v143, v143, v144
    v_add_u32 v144, v132, v143
    s_mul_i32 s68, s16, 6144
    s_add_u32 s69, s68, 65536
    s_cmp_eq_u32 s16, 3
    s_cselect_b32 s68, 149696, s68
    s_cselect_b32 s69, 155840, s69
    s_add_u32 s48, s48, 384
    s_addc_u32 s49, s49, 0
    s_add_u32 m0, s68, 0
    v_lshlrev_b32 v145, 1, v131
    s_mov_b32 s54, 12288
    s_mov_b32 s55, 0x00020000
    s_mov_b32 s62, 64
    s_mov_b32 s63, 0x00020000
    s_mov_b32 s66, 128
    s_mov_b32 s67, 0x00020000
    s_mov_b32 s58, 676
    s_mov_b32 s59, 0x00020000
    s_mov_b32 s14, 0
    s_mov_b32 s15, 0x00020000
    s_mul_i32 s90, s16, 16
    v_mov_b32 v117, 0
    v_cmp_lt_u32 s[92:93], 7, v134
    v_mov_b32 v119, 0
    v_mov_b32 v123, 0
    v_mov_b32 v115, 0
    v_lshlrev_b32 v114, 1, v130
    v_mul_u32_u24 v143, 12, v134
    s_mul_i32 s71, s16, 192
    v_add_u32 v143, s71, v143
    v_lshlrev_b32 v132, 5, v131
    s_mul_i32 s72, s16, 9408
    s_add_u32 s72, s72, 104448
    s_mul_i32 s73, s16, 7616
    s_add_u32 s73, s73, 38912
    s_cmp_eq_u32 s16, 3
    s_cselect_b32 s73, 142080, s73
    v_lshrrev_b32 v120, 2, v134
    v_and_b32 v118, 1, v120
    v_mul_u32_u24 v118, 0x020202, v118
    v_lshl_or_b32 v118, v118, 8, v118
    v_add_u32 v118, 0x05040100, v118
    v_and_b32 v124, 3, v134
    v_lshrrev_b32 v116, 1, v134
    v_xor_b32 v121, v116, v131
    v_mul_u32_u24 v116, 384, v134
    v_lshl_add_u32 v0, v121, 4, v116
    v_xor_b32 v1, 64, v0
    v_and_b32 v116, 2, v131
    v_add_u32 v116, v116, v131
    v_lshl_add_u32 v116, v116, 2, v120
    v_mul_u32_u24 v116, 96, v116
    v_lshl_add_u32 v116, v124, 3, v116
    v_add_u32 v127, s68, v116
    v_add_u32 v121, s69, v116
    v_add_u32 v126, s72, v116
    v_add_u32 v147, s73, v116
    v_mul_u32_u24 v128, 768, v131
    v_add_u32 v128, v143, v128
    v_add_u32 v128, 98304, v128
    s_mov_b32 s76, 0x3f80
    v_and_b32 v116, 1, v134
    v_lshlrev_b32 v116, 4, v116
    v_lshlrev_b32 v125, v116, s76
    v_mov_b32 v122, 0x3c003c00
    v_mov_b32 v28, 0x3f803f80
    v_mov_b32 v146, 2816
    v_mov_b32 v44, 1.0
    v_lshlrev_b32 v129, 4, v131
    s_mov_b32 s19, s38
    s_mov_b32 s23, s25
    s_mov_b32 s26, 0
    s_mov_b32 s27, 0
    s_mov_b32 s18, 0
    s_add_u32 s19, s19, s20
    s_add_u32 s23, s23, s21
    s_cmp_ge_u32 s19, 72
    s_cselect_b32 s34, 72, 0
    s_cselect_b32 s35, s22, 0
    s_sub_u32 s19, s19, s34
    s_add_u32 s23, s23, s35
    s_mov_b32 s24, s23
    s_add_u32 s19, s19, s20
    s_add_u32 s23, s23, s21
    s_cmp_ge_u32 s19, 72
    s_cselect_b32 s34, 72, 0
    s_cselect_b32 s35, s22, 0
    s_sub_u32 s19, s19, s34
    s_add_u32 s23, s23, s35
    s_mul_i32 s79, s16, 64
    v_lshl_add_u32 v148, v131, 4, s79
    s_mul_i32 s80, s16, 32
    s_add_u32 s80, s80, 256
    v_lshl_add_u32 v149, v131, 3, s80
    v_add_u32 v150, 0, v134
    v_mul_u32_u24 v154, 37, v150
    v_mul_u32_u24 v151, 384, v150
    v_lshrrev_b32 v154, 8, v154
    v_mad_u32_u24 v151, v154, s70, v151
    v_add_u32 v15, v151, v148
    v_add_u32 v18, v151, v149
    v_mul_u32_u24 v152, 37, v150
    v_lshrrev_b32 v152, 8, v152
    v_mul_u32_u24 v153, 7, v152
    v_sub_u32 v153, v150, v153
    v_add_u32 v157, 16, v134
    v_mul_u32_u24 v155, 37, v157
    v_mul_u32_u24 v151, 384, v157
    v_lshrrev_b32 v155, 8, v155
    v_mad_u32_u24 v151, v155, s70, v151
    v_add_u32 v16, v151, v148
    v_add_u32 v19, v151, v149
    v_mul_u32_u24 v151, 37, v157
    v_lshrrev_b32 v151, 8, v151
    v_mul_u32_u24 v158, 7, v151
    v_sub_u32 v158, v157, v158
    v_add_u32 v159, 32, v134
    v_mul_u32_u24 v161, 37, v159
    v_mul_u32_u24 v156, 384, v159
    v_lshrrev_b32 v161, 8, v161
    v_mad_u32_u24 v156, v161, s70, v156
    v_add_u32 v17, v156, v148
    v_add_u32 v20, v156, v149
    v_mul_u32_u24 v156, 37, v159
    v_lshrrev_b32 v156, 8, v156
    v_mul_u32_u24 v160, 7, v156
    v_sub_u32 v160, v159, v160
    s_mul_i32 s81, s16, 768
    s_add_u32 s81, s81, 98304
    v_mul_u32_u24 v148, 24, v154
    v_lshl_add_u32 v148, v150, 2, v148
    v_add_u32 v22, s81, v148
    v_sub_u32 v23, s81, v148
    v_sub_u32 v149, v22, v129
    v_mul_u32_u24 v148, 24, v155
    v_lshl_add_u32 v148, v157, 2, v148
    v_add_u32 v24, s81, v148
    v_sub_u32 v25, s81, v148
    v_sub_u32 v148, v24, v129
    v_mul_u32_u24 v161, 24, v161
    v_lshl_add_u32 v161, v159, 2, v161
    v_add_u32 v26, s81, v161
    v_sub_u32 v27, s81, v161
    v_sub_u32 v154, v26, v129
    v_mul_u32_u24 v162, 148, v131
    s_mov_b32 s82, -24
    v_add_u32 v161, 0, v162
    v_lshrrev_b32 v161, 8, v161
    v_mad_i32_i24 v46, v161, s82, v149
    v_mad_i32_i24 v58, v161, s82, v148
    v_mad_i32_i24 v70, v161, s82, v154
    v_add_u32 v155, 37, v162
    v_lshrrev_b32 v155, 8, v155
    v_mad_i32_i24 v47, v155, s82, v149
    v_mad_i32_i24 v59, v155, s82, v148
    v_mad_i32_i24 v71, v155, s82, v154
    v_add_u32 v161, 74, v162
    v_lshrrev_b32 v161, 8, v161
    v_mad_i32_i24 v48, v161, s82, v149
    v_mad_i32_i24 v60, v161, s82, v148
    v_mad_i32_i24 v72, v161, s82, v154
    v_add_u32 v155, 111, v162
    v_lshrrev_b32 v155, 8, v155
    v_mad_i32_i24 v49, v155, s82, v149
    v_mad_i32_i24 v61, v155, s82, v148
    v_mad_i32_i24 v73, v155, s82, v154
    v_add_u32 v155, 592, v162
    v_lshrrev_b32 v155, 8, v155
    v_mad_i32_i24 v50, v155, s82, v149
    v_mad_i32_i24 v62, v155, s82, v148
    v_mad_i32_i24 v74, v155, s82, v154
    v_add_u32 v155, 629, v162
    v_lshrrev_b32 v155, 8, v155
    v_mad_i32_i24 v51, v155, s82, v149
    v_mad_i32_i24 v63, v155, s82, v148
    v_mad_i32_i24 v75, v155, s82, v154
    v_add_u32 v155, 666, v162
    v_lshrrev_b32 v155, 8, v155
    v_mad_i32_i24 v52, v155, s82, v149
    v_mad_i32_i24 v64, v155, s82, v148
    v_mad_i32_i24 v76, v155, s82, v154
    v_add_u32 v155, 703, v162
    v_lshrrev_b32 v155, 8, v155
    v_mad_i32_i24 v53, v155, s82, v149
    v_mad_i32_i24 v65, v155, s82, v148
    v_mad_i32_i24 v77, v155, s82, v154
    v_add_u32 v155, 1184, v162
    v_lshrrev_b32 v155, 8, v155
    v_mad_i32_i24 v54, v155, s82, v149
    v_mad_i32_i24 v66, v155, s82, v148
    v_mad_i32_i24 v78, v155, s82, v154
    v_add_u32 v155, 1221, v162
    v_lshrrev_b32 v155, 8, v155
    v_mad_i32_i24 v55, v155, s82, v149
    v_mad_i32_i24 v67, v155, s82, v148
    v_mad_i32_i24 v79, v155, s82, v154
    v_add_u32 v155, 1258, v162
    v_lshrrev_b32 v155, 8, v155
    v_mad_i32_i24 v56, v155, s82, v149
    v_mad_i32_i24 v68, v155, s82, v148
    v_mad_i32_i24 v80, v155, s82, v154
    v_add_u32 v155, 1295, v162
    v_lshrrev_b32 v155, 8, v155
    v_mad_i32_i24 v57, v155, s82, v149
    v_mad_i32_i24 v69, v155, s82, v148
    v_mad_i32_i24 v81, v155, s82, v154
    v_mov_b32 v155, s81
    v_lshlrev_b32 v161, 4, v130
    v_xor_b32 v2, 65536, v161
    v_lshl_add_u32 v3, s16, 10, v161
    s_lshr_b32 s83, s16, 1
    s_and_b32 s84, s16, 1
    s_lshl_b32 s84, s84, 3
    s_lshl_b32 s85, s83, 10
    s_add_u32 s85, s85, s84
    v_add_u32 v4, s85, v161
    s_lshl_b32 s83, s83, 11
    s_add_u32 s83, s83, s84
    s_add_u32 s83, s83, 157888
    s_mul_i32 s86, s16, 2048
    s_add_u32 s86, s86, 149696
    v_lshl_add_u32 v161, v131, 3, s86
    v_mov_b32 v154, s83
    v_mov_b32 v148, 163264
    v_mul_u32_u24 v149, 80, v131
    v_add3_u32 v5, v149, v116, s72
    v_lshl_add_u32 v6, v134, 2, s73
    s_mul_i32 s87, s16, 128
    s_add_u32 s87, s87, 61760
    s_mov_b32 s32, 0x2a8cbccc
    s_mov_b32 s33, 0x38fba882
    s_add_u32 s75, s28, 16384
    s_cmp_lt_u32 s16, 2
    s_cselect_b32 s29, s75, 161984
    s_cselect_b32 s30, 65536, 0
    s_xor_b32 s74, s29, s30
    s_lshl_b32 s94, s5, 1
    s_or_b32 s94, s94, s6
    s_mul_i32 s77, s16, 64
    s_mul_i32 s78, s16, 32
    s_add_u32 s78, s78, 192
    s_add_u32 s34, s18, 2
    s_mov_b32 s27, s26
    s_mov_b32 s26, s25
    s_add_u32 s19, s19, s20
    s_mov_b32 s18, 1
    s_mov_b32 s71, 1
    buffer_load_dwordx4 v140, s[48:51], 0 offen lds
    v_lshrrev_b32 v116, 1, v131
    v_mul_u32_u24 v116, 48, v116
    v_lshl_add_u32 v116, v131, 3, v116
    buffer_load_dwordx4 v142, s[48:51], 0 offen offset:1024 lds
    v_lshl_add_u32 v116, v120, 4, v116
    v_lshl_add_u32 v116, v124, 1, v116
    v_add_u32 v8, s87, v116
    buffer_load_dwordx4 v144, s[48:51], 0 offen offset:2048 lds
    s_add_u32 s48, s48, 36864
    s_addc_u32 s49, s49, 0
    s_add_u32 m0, s68, 3072
    v_mov_b32 v37, 0
    buffer_load_dwordx4 v140, s[48:51], 0 offen lds
    v_mov_b32 v38, 0
    v_mov_b32 v39, 0
    v_add_u32 v162, 86016, v0
    buffer_load_dwordx4 v142, s[48:51], 0 offen offset:1024 lds
    v_add_u32 v164, 86016, v1
    v_lshlrev_b32 v163, 4, v134
    v_add_u32 v163, 161984, v163
    buffer_load_dwordx4 v144, s[48:51], 0 offen offset:2048 lds
    s_add_u32 s48, s48, 36864
    s_addc_u32 s49, s49, 0
    s_add_u32 m0, s69, 0
    buffer_load_ushort v116, v114, s[60:63], 0 offen
    s_mov_b64 s[60:61], s[8:9]
    s_sub_u32 s62, s45, s17
    s_sub_u32 s45, s17, 1
    buffer_load_dwordx3 v[186:188], v143, s[56:59], 0 offen
    v_mul_u32_u24 v166, 336, v134
    buffer_load_dwordx4 v[190:193], v132, s[64:67], 0 offen
    v_add3_u32 v166, v166, v149, s72
    v_mul_u32_u24 v165, 272, v134
    v_add3_u32 v165, v165, v129, s73
    v_mul_u32_u24 v167, 1088, v131
    v_add_u32 v167, v167, v6
    v_add_u32 v169, 5376, v166
    v_add_u32 v143, 4352, v165
    v_add_u32 v170, 4352, v167
    v_cmp_gt_u32 s[88:89], 16, v130
    buffer_load_dwordx4 v[206:209], v132, s[64:67], 0 offen offset:16
    v_mov_b32 v168, 0xf149f2ca
    v_add_u32 v149, 768, v254
    v_mul_u32_u24 v132, 2731, v149
    v_bfe_u32 v114, v132, 17, 3
    v_lshrrev_b32 v132, 16, v132
    v_xor_b32 v149, v114, v149
    v_mul_u32_u24 v114, 37, v132
    v_lshrrev_b32 v114, 8, v114
    v_lshlrev_b32 v149, 4, v149
    v_mad_u32_u24 v13, v114, s70, v149
    v_mul_u32_u24 v149, 37, v132
    v_lshrrev_b32 v149, 8, v149
    v_mul_u32_u24 v114, 7, v149
    v_sub_u32 v114, v132, v114
    v_cmp_gt_u32 vcc, 4, v149
    v_add_u32 v254, 1024, v254
    v_mul_u32_u24 v132, 2731, v254
    v_cndmask_b32 v149, v136, v135, vcc
    v_cmp_gt_u32 vcc, 4, v114
    v_bfe_u32 v189, v132, 17, 3
    v_lshrrev_b32 v132, 16, v132
    v_cndmask_b32 v114, v138, v137, vcc
    v_add3_u32 v13, v13, v149, v114
    v_xor_b32 v254, v189, v254
    v_mul_u32_u24 v189, 37, v132
    v_lshrrev_b32 v189, 8, v189
    v_lshlrev_b32 v254, 4, v254
    v_mad_u32_u24 v14, v189, s70, v254
    v_mul_u32_u24 v114, 37, v132
    v_lshrrev_b32 v114, 8, v114
    v_mul_u32_u24 v149, 7, v114
    v_sub_u32 v149, v132, v149
    v_cmp_gt_u32 vcc, 4, v114
    v_mov_b32 v171, 0xc31044fe
    v_mul_u32_u24 v254, 37, v150
    v_cndmask_b32 v114, v136, v135, vcc
    v_cmp_gt_u32 vcc, 4, v149
    v_lshrrev_b32 v254, 8, v254
    v_mul_u32_u24 v189, 7, v254
    v_cndmask_b32 v149, v138, v137, vcc
    v_add3_u32 v14, v14, v114, v149
    v_cmp_gt_u32 vcc, 48, v132
    v_sub_u32 v189, v150, v189
    v_lshrrev_b32 v254, 2, v254
    v_cndmask_b32 v14, v255, v14, vcc
    v_cmp_gt_u32 vcc, 2, v124
    v_lshrrev_b32 v189, 2, v189
    v_and_b32 v254, s5, v254
    v_cndmask_b32 v32, 0, v125, vcc
    v_cndmask_b32 v33, v125, 0, vcc
    v_cndmask_b32 v34, 0, v125, vcc
    v_cndmask_b32 v35, v125, 0, vcc
    v_cmp_eq_u32 vcc, 0, v124
    v_and_b32 v189, s6, v189
    v_lshl_or_b32 v254, v254, 1, v189
    v_cndmask_b32 v40, 0, v122, vcc
    v_cndmask_b32 v29, 0, v28, vcc
    v_cndmask_b32 v30, 0, v28, vcc
    v_cndmask_b32 v31, 0, v28, vcc
    v_cndmask_b32 v28, 0, v28, vcc
    v_cndmask_b32 v146, v146, 0, vcc
    v_cmp_eq_u32 vcc, 1, v124
    v_add3_u32 v9, v146, v129, s87
    v_mul_u32_u24 v255, 37, v157
    s_bfm_b32 s70, s17, 0
    s_waitcnt vmcnt(9)
    s_barrier
    global_load_ushort v145, v145, s[46:47]
    v_cndmask_b32 v41, 0, v122, vcc
    v_cmp_eq_u32 vcc, 2, v124
    v_lshrrev_b32 v255, 8, v255
    v_mul_u32_u24 v114, 7, v255
    v_cndmask_b32 v42, 0, v122, vcc
    v_cmp_eq_u32 vcc, 3, v124
    v_sub_u32 v114, v157, v114
    v_lshrrev_b32 v255, 2, v255
    v_cndmask_b32 v43, 0, v122, vcc
    v_cmp_eq_u32 vcc, v131, v120
    v_lshrrev_b32 v114, 2, v114
    buffer_load_dwordx4 v140, s[48:51], 0 offen lds
    v_cndmask_b32 v172, 0, v32, vcc
    v_cndmask_b32 v173, 0, v33, vcc
    v_and_b32 v255, s5, v255
    v_and_b32 v114, s6, v114
    v_lshl_or_b32 v255, v255, 1, v114
    v_mul_u32_u24 v157, 37, v159
    v_lshrrev_b32 v157, 8, v157
    v_mul_u32_u24 v114, 7, v157
    v_sub_u32 v114, v159, v114
    v_lshrrev_b32 v157, 2, v157
    v_lshrrev_b32 v114, 2, v114
    v_and_b32 v157, s5, v157
    v_and_b32 v114, s6, v114
    v_lshl_or_b32 v157, v157, 1, v114
    v_mul_u32_u24 v114, 6, v133
    buffer_load_dwordx4 v142, s[48:51], 0 offen offset:1024 lds
    s_waitcnt vmcnt(10)
    ds_read_b64_tr_b16 a[72:73], v127 offset:0
    ds_read_b64_tr_b16 a[74:75], v127 offset:768
    ds_read_b64_tr_b16 a[96:97], v127 offset:32
    ds_read_b64_tr_b16 a[98:99], v127 offset:800
    ds_read_b64_tr_b16 a[120:121], v127 offset:64
    ds_read_b64_tr_b16 a[122:123], v127 offset:832
    v_sub_u32 v159, v130, v114
    v_mul_u32_u24 v114, 384, v133
    v_lshl_add_u32 v114, v159, 4, v114
    v_add_u32 v150, s78, v114
    v_add_u32 v114, s77, v114
    v_cmp_gt_i32 vcc, 4, v159
    v_mul_u32_u24 v159, 6, v139
    v_sub_u32 v189, v130, v159
    buffer_load_dwordx4 v144, s[48:51], 0 offen offset:2048 lds
    s_add_u32 s48, s48, 36864
    s_addc_u32 s49, s49, 0
    s_add_u32 m0, s69, 3072
    v_cndmask_b32 v174, v150, v114, vcc
    v_mul_u32_u24 v159, 384, v139
    v_lshl_add_u32 v159, v189, 4, v159
    v_add_u32 v139, s78, v159
    v_add_u32 v159, s77, v159
    v_cmp_gt_i32 vcc, -60, v189
    v_mul_u32_u24 v114, 6, v141
    v_sub_u32 v150, v130, v114
    v_cndmask_b32 v139, v139, v159, vcc
    v_mul_u32_u24 v114, 384, v141
    v_lshl_add_u32 v114, v150, 4, v114
    v_add_u32 v159, s78, v114
    buffer_load_dwordx4 v140, s[48:51], 0 offen lds
    v_add_u32 v114, s77, v114
    v_cmp_gt_i32 vcc, -124, v150
    v_mul_u32_u24 v189, 96, v134
    v_add3_u32 v141, v189, v129, s68
    v_cndmask_b32 v130, v159, v114, vcc
    v_cmp_gt_u32 vcc, 4, v152
    v_lshl_add_u32 v175, v131, 3, v189
    v_add3_u32 v175, v175, 64, s68
    v_cndmask_b32 v152, v136, v135, vcc
    v_cmp_gt_u32 vcc, 4, v153
    v_add3_u32 v133, v189, v129, s69
    v_lshl_add_u32 v132, v131, 3, v189
    v_cndmask_b32 v153, v138, v137, vcc
    s_waitcnt vmcnt(9)
    s_and_b32 s77, s2, 0xf8
    ds_read_b64_tr_b16 a[76:77], v127 offset:3072
    ds_read_b64_tr_b16 a[78:79], v127 offset:3840
    s_waitcnt vmcnt(7)
    buffer_load_dwordx4 v142, s[48:51], 0 offen offset:1024 lds
    s_waitcnt vmcnt(7)
    ds_read_b64_tr_b16 a[100:101], v127 offset:3104
    s_waitcnt vmcnt(6)
    ds_read_b64_tr_b16 a[102:103], v127 offset:3872
    ds_read_b64_tr_b16 a[124:125], v127 offset:3136
    ds_read_b64_tr_b16 a[126:127], v127 offset:3904
    v_cndmask_b32 v190, v190, v191, s[92:93]
    v_cndmask_b32 v192, v192, v193, s[92:93]
    v_perm_b32 v176, v192, v190, v118
    v_cndmask_b32 v206, v206, v207, s[92:93]
    v_cndmask_b32 v208, v208, v209, s[92:93]
    v_perm_b32 v177, v208, v206, v118
    v_bfe_u32 v118, v186, v129, 16
    v_bfe_u32 v122, v187, v129, 16
    v_bfe_u32 v114, v188, v129, 16
    v_mfma_f32_16x16x16_bf16 v[190:193], v[116:117], v[118:119], 0
    v_add3_u32 v15, v15, v152, v153
    v_add3_u32 v18, v18, v152, v153
    v_cmp_gt_u32 vcc, 4, v151
    v_mfma_f32_16x16x16_bf16 v[206:209], v[116:117], v[122:123], 0
    v_add3_u32 v132, v132, 64, s69
    v_cndmask_b32 v151, v136, v135, vcc
    v_cmp_gt_u32 vcc, 4, v158
    v_mfma_f32_16x16x16_bf16 v[186:189], v[116:117], v[114:115], 0
    s_add_u32 s77, s77, 4940
    s_mul_i32 s78, s77, 58255
    s_lshr_b32 s78, s78, 22
    buffer_load_dwordx4 v144, s[48:51], 0 offen offset:2048 lds
    s_add_u32 s48, s48, 36864
    s_addc_u32 s49, s49, 0
    s_add_u32 m0, s72, 0
    v_max_f32 v190, 0, v190
    v_max_f32 v191, 0, v191
    s_waitcnt vmcnt(6)
    v_lshlrev_b32 v145, 16, v145
    v_max_f32 v145, 0xc2c80000, v145
    v_min_f32 v145, 0x40930000, v145
    v_mul_f32 v145, 0x3fb8aa3b, v145
    v_exp_f32 v145, v145
    v_max_f32 v192, 0, v192
    v_cvt_pk_bf16_f32 v145, v145, v145
    v_and_b32 v145, 0xffff0000, v145
    buffer_load_dwordx4 v140, s[48:51], 0 offen lds
    v_mul_f32 v145, 0x3fb8aa3b, v145
    v_mul_f32 v129, 0xbea8f5c3, v145
    v_add_f32 v129, 0xc138aa3b, v129
    v_readlane_b32 s31, v145, s90
    v_max_f32 v193, 0, v193
    v_cvt_pk_bf16_f32 v118, v190, v191
    v_cvt_pk_bf16_f32 v119, v192, v193
    v_max_f32 v206, 0, v206
    v_max_f32 v207, 0, v207
    v_mfma_f32_16x16x16_bf16 v[114:117], v[176:177], v[118:119], 0
    v_max_f32 v208, 0, v208
    v_max_f32 v209, 0, v209
    v_cvt_pk_bf16_f32 v118, v206, v207
    v_cvt_pk_bf16_f32 v119, v208, v209
    v_max_f32 v186, 0, v186
    buffer_load_dwordx4 v142, s[48:51], 0 offen offset:1024 lds
    v_mfma_f32_16x16x16_bf16 v[190:193], v[176:177], v[118:119], 0
    v_max_f32 v187, 0, v187
    v_cvt_pk_bf16_f32 v114, v114, v114
    v_and_b32 v114, 0xffff0000, v114
    v_mul_f32 v114, 0xbfb8aa3b, v114
    v_exp_f32 v114, v114
    v_max_f32 v188, 0, v188
    v_add_f32 v114, 1.0, v114
    v_rcp_f32 v114, v114
    v_cvt_pk_bf16_f32 v190, v190, v190
    v_cvt_pk_bf16_f32 v114, v114, v114
    v_and_b32 v114, 0xffff0000, v114
    v_fmamk_f32 v114, v114, 0x41b8aa3b, v129
    buffer_load_dwordx4 v144, s[48:51], 0 offen offset:2048 lds
    ds_write_b32 v128, v114 offset:0
    s_waitcnt vmcnt(6)
    s_add_u32 s48, s48, 36864
    s_addc_u32 s49, s49, 0
    s_add_u32 m0, s72, 3072
    s_mov_b32 s72, 2
    ds_read_b64_tr_b16 a[80:81], v121 offset:0
    ds_read_b64_tr_b16 a[82:83], v121 offset:768
    ds_read_b64_tr_b16 a[104:105], v121 offset:32
    ds_read_b64_tr_b16 a[106:107], v121 offset:800
    ds_read_b64_tr_b16 a[128:129], v121 offset:64
    ds_read_b64_tr_b16 a[130:131], v121 offset:832
    v_and_b32 v190, 0xffff0000, v190
    buffer_load_dwordx4 v140, s[48:51], 0 offen lds
    v_mul_f32 v190, 0xbfb8aa3b, v190
    v_exp_f32 v190, v190
    v_max_f32 v189, 0, v189
    v_add_f32 v190, 1.0, v190
    v_rcp_f32 v190, v190
    v_cvt_pk_bf16_f32 v118, v186, v187
    v_cvt_pk_bf16_f32 v190, v190, v190
    v_and_b32 v190, 0xffff0000, v190
    v_fmamk_f32 v190, v190, 0x41b8aa3b, v129
    ds_write_b32 v128, v190 offset:4
    buffer_load_dwordx4 v142, s[48:51], 0 offen offset:1024 lds
    v_cvt_pk_bf16_f32 v119, v188, v189
    v_cndmask_b32 v158, v138, v137, vcc
    v_add3_u32 v16, v16, v151, v158
    v_mfma_f32_16x16x16_bf16 v[114:117], v[176:177], v[118:119], 0
    v_add3_u32 v19, v19, v151, v158
    v_cmp_gt_u32 vcc, 4, v156
    s_nop 0
    s_nop 0
    v_cndmask_b32 v156, v136, v135, vcc
    v_cmp_gt_u32 vcc, 4, v160
    s_nop 0
    s_nop 0
    v_cvt_pk_bf16_f32 v114, v114, v114
    v_and_b32 v114, 0xffff0000, v114
    v_mul_f32 v114, 0xbfb8aa3b, v114
    buffer_load_dwordx4 v144, s[48:51], 0 offen offset:2048 lds
    s_sub_u32 s48, s48, 184704
    s_subb_u32 s49, s49, 0
    s_add_u32 m0, s73, 0
    v_exp_f32 v114, v114
    v_cndmask_b32 v160, v138, v137, vcc
    v_add_f32 v114, 1.0, v114
    v_rcp_f32 v114, v114
    v_add3_u32 v17, v17, v156, v160
    v_cvt_pk_bf16_f32 v114, v114, v114
    v_and_b32 v114, 0xffff0000, v114
    v_fmamk_f32 v114, v114, 0x41b8aa3b, v129
    ds_write_b32 v128, v114 offset:8
    s_waitcnt vmcnt(6)
    buffer_load_dwordx4 v140, s[48:51], 0 offen lds
    v_add3_u32 v20, v20, v156, v160
    v_cmp_gt_u32 vcc, 2, v131
    ds_read_b64_tr_b16 a[84:85], v121 offset:3072
    ds_read_b64_tr_b16 a[86:87], v121 offset:3840
    ds_read_b64_tr_b16 a[108:109], v121 offset:3104
    ds_read_b64_tr_b16 a[110:111], v121 offset:3872
    ds_read_b64_tr_b16 a[132:133], v121 offset:3136
    ds_read_b64_tr_b16 a[134:135], v121 offset:3904
    v_cndmask_b32 v161, v154, v161, vcc
    v_lshl_add_u32 v161, v120, 9, v161
    v_lshl_add_u32 v161, v124, 1, v161
    v_cmp_gt_u32 vcc, 3, v131
    s_nop 0
    buffer_load_dwordx4 v142, s[48:51], 0 offen offset:1024 lds
    v_cndmask_b32 v7, v148, v161, vcc
    v_cmp_gt_u32 vcc, 12, v134
    s_nop 0
    s_nop 0
    v_cndmask_b32 v169, v163, v169, vcc
    v_cndmask_b32 v143, v163, v143, vcc
    s_waitcnt lgkmcnt(6)
    s_barrier
    ds_read_b32 v22, v22 offset:0
    ds_read_b32 v23, v23 offset:672
    ds_read_b32 v24, v24 offset:0
    ds_read_b32 v25, v25 offset:672
    ds_read_b32 v26, v26 offset:0
    ds_read_b32 v27, v27 offset:672
    ds_read_b32 v46, v46 offset:336
    ds_read_b32 v58, v58 offset:336
    buffer_load_dwordx4 v144, s[48:51], 0 offen offset:2048 lds
    ds_read_b32 v70, v70 offset:336
    ds_read_b32 v47, v47 offset:332
    s_add_u32 s48, s48, 36864
    ds_read_b32 v59, v59 offset:332
    s_addc_u32 s49, s49, 0
    ds_read_b32 v71, v71 offset:332
    s_add_u32 m0, s73, 3072
    ds_read_b32 v48, v48 offset:328
    v_cmp_gt_u32 vcc, 3, v131
    s_mov_b32 s73, 3
    ds_read_b32 v60, v60 offset:328
    s_waitcnt vmcnt(6)
    ds_read_b64_tr_b16 a[88:89], v126 offset:0
    buffer_load_dwordx4 v140, s[48:51], 0 offen lds
    ds_read_b64_tr_b16 a[90:91], v126 offset:768
    ds_read_b64_tr_b16 a[112:113], v126 offset:32
    ds_read_b64_tr_b16 a[114:115], v126 offset:800
    ds_read_b64_tr_b16 a[136:137], v126 offset:64
    ds_read_b64_tr_b16 a[138:139], v126 offset:832
    ds_read_b32 v72, v72 offset:328
    v_cndmask_b32 v170, v163, v170, vcc
    ds_read_b32 v49, v49 offset:324
    ds_read_b32 v61, v61 offset:324
    ds_read_b32 v73, v73 offset:324
    ds_read_b32 v50, v50 offset:272
    ds_read_b32 v62, v62 offset:272
    buffer_load_dwordx4 v142, s[48:51], 0 offen offset:1024 lds
    ds_read_b32 v74, v74 offset:272
    ds_read_b32 v51, v51 offset:268
    ds_read_b32 v63, v63 offset:268
    ds_read_b32 v75, v75 offset:268
    ds_read_b32 v52, v52 offset:264
    ds_read_b32 v64, v64 offset:264
    ds_read_b32 v76, v76 offset:264
    ds_read_b32 v53, v53 offset:260
    ds_read_b32 v65, v65 offset:260
    buffer_load_dwordx4 v144, s[48:51], 0 offen offset:2048 lds
    ds_read_b32 v77, v77 offset:260
    ds_read_b32 v54, v54 offset:208
    s_add_u32 s48, s48, 36864
    ds_read_b32 v66, v66 offset:208
    s_addc_u32 s49, s49, 0
    ds_read_b32 v78, v78 offset:208
    s_add_u32 m0, s68, 0
    ds_read_b32 v55, v55 offset:204
    ds_read_b32 v67, v67 offset:204
    ds_read_b32 v79, v79 offset:204
    ds_read_b32 v56, v56 offset:200
    ds_read_b32 v68, v68 offset:200
    s_waitcnt vmcnt(6)
    buffer_load_dwordx4 v140, s[48:51], 0 offen lds
    ds_read_b64_tr_b16 a[92:93], v126 offset:3072
    ds_read_b64_tr_b16 a[94:95], v126 offset:3840
    ds_read_b64_tr_b16 a[116:117], v126 offset:3104
    ds_read_b64_tr_b16 a[118:119], v126 offset:3872
    ds_read_b64_tr_b16 a[140:141], v126 offset:3136
    ds_read_b64_tr_b16 a[142:143], v126 offset:3904
    ds_read_b32 v80, v80 offset:200
    ds_read_b32 v57, v57 offset:196
    ds_read_b32 v69, v69 offset:196
    buffer_load_dwordx4 v142, s[48:51], 0 offen offset:1024 lds
    ds_read_b32 v81, v81 offset:196
    ds_read_b32 v155, v155 offset:336
    v_cmp_ne_u32 vcc, s94, v254
    v_lshl_add_u32 v163, v131, 2, 0
    v_mul_u32_u24 v145, 37, v163
    v_cndmask_b32 v138, 0, v171, vcc
    s_waitcnt lgkmcnt(12)
    v_add_f32 v22, v22, v138
    v_cmp_ne_u32 vcc, s94, v254
    v_lshrrev_b32 v145, 8, v145
    v_mul_u32_u24 v176, 7, v145
    v_cndmask_b32 v138, 0, v171, vcc
    v_add_f32 v23, v23, v138
    v_cmp_ne_u32 vcc, s94, v255
    v_sub_u32 v176, v163, v176
    buffer_load_dwordx4 v144, s[48:51], 0 offen offset:2048 lds
    s_add_u32 s48, s48, 36864
    s_addc_u32 s49, s49, 0
    s_add_u32 m0, s68, 3072
    v_cndmask_b32 v138, 0, v171, vcc
    v_add_f32 v24, v24, v138
    v_cmp_ne_u32 vcc, s94, v255
    v_lshrrev_b32 v145, 2, v145
    v_lshrrev_b32 v176, 2, v176
    v_cndmask_b32 v138, 0, v171, vcc
    v_add_f32 v25, v25, v138
    v_cmp_ne_u32 vcc, s94, v157
    s_waitcnt lgkmcnt(0)
    v_readfirstlane_b32 s39, v155
    v_cndmask_b32 v138, 0, v171, vcc
    v_add_f32 v26, v26, v138
    buffer_load_dwordx4 v140, s[48:51], 0 offen lds
    s_waitcnt vmcnt(7)
    ds_read_b64_tr_b16 a[0:1], v147 offset:0
    ds_read_b64_tr_b16 a[2:3], v147 offset:768
    ds_read_b64_tr_b16 a[24:25], v147 offset:32
    ds_read_b64_tr_b16 a[26:27], v147 offset:800
    ds_read_b64_tr_b16 a[48:49], v147 offset:64
    ds_read_b64_tr_b16 a[50:51], v147 offset:832
    v_cmp_ne_u32 vcc, s94, v157
    v_and_b32 v145, s5, v145
    v_and_b32 v176, s6, v176
    v_cndmask_b32 v138, 0, v171, vcc
    v_add_f32 v27, v27, v138
    v_lshl_or_b32 v145, v145, 1, v176
    v_cmp_ne_u32 vcc, v145, v254
    v_lshl_add_u32 v163, v131, 2, 1
    buffer_load_dwordx4 v142, s[48:51], 0 offen offset:1024 lds
    v_cndmask_b32 v138, 0, v171, vcc
    v_add_f32 v46, v46, v138
    v_cmp_ne_u32 vcc, v145, v255
    v_mul_u32_u24 v138, 37, v163
    v_lshrrev_b32 v138, 8, v138
    v_cndmask_b32 v176, 0, v171, vcc
    v_add_f32 v58, v58, v176
    v_cmp_ne_u32 vcc, v145, v157
    v_mul_u32_u24 v176, 7, v138
    v_sub_u32 v176, v163, v176
    v_cndmask_b32 v145, 0, v171, vcc
    v_add_f32 v70, v70, v145
    v_lshrrev_b32 v138, 2, v138
    v_lshrrev_b32 v176, 2, v176
    v_and_b32 v138, s5, v138
    buffer_load_dwordx4 v144, s[48:51], 0 offen offset:2048 lds
    s_add_u32 s48, s48, 36864
    s_addc_u32 s49, s49, 0
    s_add_u32 m0, s69, 0
    v_and_b32 v176, s6, v176
    v_lshl_or_b32 v138, v138, 1, v176
    v_cmp_ne_u32 vcc, v138, v254
    v_lshl_add_u32 v176, v131, 2, 2
    v_mul_u32_u24 v163, 37, v176
    v_cndmask_b32 v145, 0, v171, vcc
    v_add_f32 v47, v47, v145
    v_cmp_ne_u32 vcc, v138, v255
    v_lshrrev_b32 v163, 8, v163
    v_mul_u32_u24 v145, 7, v163
    v_cndmask_b32 v177, 0, v171, vcc
    v_add_f32 v59, v59, v177
    buffer_load_dwordx4 v140, s[48:51], 0 offen lds
    s_waitcnt vmcnt(7)
    ds_read_b64_tr_b16 a[4:5], v147 offset:3072
    ds_read_b64_tr_b16 a[6:7], v147 offset:3840
    ds_read_b64_tr_b16 a[28:29], v147 offset:3104
    ds_read_b64_tr_b16 a[30:31], v147 offset:3872
    ds_read_b64_tr_b16 a[52:53], v147 offset:3136
    ds_read_b64_tr_b16 a[54:55], v147 offset:3904
    v_cmp_ne_u32 vcc, v138, v157
    v_sub_u32 v145, v176, v145
    v_lshrrev_b32 v163, 2, v163
    v_cndmask_b32 v138, 0, v171, vcc
    v_add_f32 v71, v71, v138
    v_lshrrev_b32 v145, 2, v145
    v_and_b32 v163, s5, v163
    v_and_b32 v145, s6, v145
    buffer_load_dwordx4 v142, s[48:51], 0 offen offset:1024 lds
    v_lshl_or_b32 v163, v163, 1, v145
    v_cmp_ne_u32 vcc, v163, v254
    v_lshl_add_u32 v138, v131, 2, 3
    v_mul_u32_u24 v177, 37, v138
    v_cndmask_b32 v145, 0, v171, vcc
    v_add_f32 v48, v48, v145
    v_cmp_ne_u32 vcc, v163, v255
    v_lshrrev_b32 v177, 8, v177
    v_mul_u32_u24 v145, 7, v177
    v_cndmask_b32 v176, 0, v171, vcc
    v_add_f32 v60, v60, v176
    v_cmp_ne_u32 vcc, v163, v157
    v_sub_u32 v145, v138, v145
    v_lshrrev_b32 v177, 2, v177
    v_cndmask_b32 v138, 0, v171, vcc
    buffer_load_dwordx4 v144, s[48:51], 0 offen offset:2048 lds
    s_add_u32 s48, s48, 36864
    s_addc_u32 s49, s49, 0
    s_add_u32 m0, s69, 3072
    v_add_f32 v72, v72, v138
    v_lshrrev_b32 v145, 2, v145
    v_and_b32 v177, s5, v177
    v_and_b32 v145, s6, v145
    v_lshl_or_b32 v177, v177, 1, v145
    v_cmp_ne_u32 vcc, v177, v254
    v_lshl_add_u32 v138, v131, 2, 16
    v_mul_u32_u24 v163, 37, v138
    v_cndmask_b32 v145, 0, v171, vcc
    v_add_f32 v49, v49, v145
    v_cmp_ne_u32 vcc, v177, v255
    v_lshrrev_b32 v163, 8, v163
    buffer_load_dwordx4 v140, s[48:51], 0 offen lds
    s_waitcnt vmcnt(7)
    ds_read_b64_tr_b16 a[8:9], v127 offset:0
    ds_read_b64_tr_b16 a[10:11], v127 offset:768
    ds_read_b64_tr_b16 a[32:33], v127 offset:32
    ds_read_b64_tr_b16 a[34:35], v127 offset:800
    ds_read_b64_tr_b16 a[56:57], v127 offset:64
    ds_read_b64_tr_b16 a[58:59], v127 offset:832
    v_cndmask_b32 v145, 0, v171, vcc
    v_add_f32 v61, v61, v145
    v_cmp_ne_u32 vcc, v177, v157
    v_mul_u32_u24 v145, 7, v163
    v_sub_u32 v145, v138, v145
    v_cndmask_b32 v138, 0, v171, vcc
    v_add_f32 v73, v73, v138
    v_lshrrev_b32 v163, 2, v163
    buffer_load_dwordx4 v142, s[48:51], 0 offen offset:1024 lds
    v_lshrrev_b32 v145, 2, v145
    v_and_b32 v163, s5, v163
    v_and_b32 v145, s6, v145
    v_lshl_or_b32 v163, v163, 1, v145
    v_cmp_ne_u32 vcc, v163, v254
    v_lshl_add_u32 v138, v131, 2, 17
    v_mul_u32_u24 v176, 37, v138
    v_cndmask_b32 v145, 0, v171, vcc
    v_add_f32 v50, v50, v145
    v_cmp_ne_u32 vcc, v163, v255
    v_lshrrev_b32 v176, 8, v176
    v_mul_u32_u24 v177, 7, v176
    v_cndmask_b32 v145, 0, v171, vcc
    v_add_f32 v62, v62, v145
    v_cmp_ne_u32 vcc, v163, v157
    buffer_load_dwordx4 v144, s[48:51], 0 offen offset:2048 lds
    s_sub_u32 s48, s48, 183552
    s_subb_u32 s49, s49, 0
    s_add_u32 m0, s68, 0
    s_waitcnt lgkmcnt(0)
    v_cndmask_b32 v145, 0, v171, vcc
    v_add_f32 v74, v74, v145
    v_sub_u32 v177, v138, v177
    v_lshrrev_b32 v176, 2, v176
    v_lshrrev_b32 v177, 2, v177
    v_and_b32 v176, s5, v176
    v_and_b32 v177, s6, v177
    v_lshl_or_b32 v176, v176, 1, v177
    v_cmp_ne_u32 vcc, v176, v254
    v_lshl_add_u32 v145, v131, 2, 18
    buffer_load_dwordx4 v140, s[48:51], 0 offen lds
    s_waitcnt vmcnt(7)
    ds_read_b64_tr_b16 a[12:13], v127 offset:3072
    ds_read_b64_tr_b16 a[14:15], v127 offset:3840
    ds_read_b64_tr_b16 a[36:37], v127 offset:3104
    ds_read_b64_tr_b16 a[38:39], v127 offset:3872
    ds_read_b64_tr_b16 a[60:61], v127 offset:3136
    ds_read_b64_tr_b16 a[62:63], v127 offset:3904
    v_cndmask_b32 v138, 0, v171, vcc
    v_add_f32 v51, v51, v138
    v_cmp_ne_u32 vcc, v176, v255
    v_mul_u32_u24 v138, 37, v145
    v_lshrrev_b32 v138, 8, v138
    v_cndmask_b32 v163, 0, v171, vcc
    v_add_f32 v63, v63, v163
    v_cmp_ne_u32 vcc, v176, v157
    buffer_load_dwordx4 v142, s[48:51], 0 offen offset:1024 lds
    v_mul_u32_u24 v176, 7, v138
    v_cndmask_b32 v163, 0, v171, vcc
    v_add_f32 v75, v75, v163
    v_sub_u32 v176, v145, v176
    v_lshrrev_b32 v138, 2, v138
    v_lshrrev_b32 v176, 2, v176
    v_and_b32 v138, s5, v138
    v_and_b32 v176, s6, v176
    v_lshl_or_b32 v138, v138, 1, v176
    v_cmp_ne_u32 vcc, v138, v254
    v_lshl_add_u32 v163, v131, 2, 19
    v_mul_u32_u24 v176, 37, v163
    v_cndmask_b32 v145, 0, v171, vcc
    v_add_f32 v52, v52, v145
    v_cmp_ne_u32 vcc, v138, v255
    buffer_load_dwordx4 v144, s[48:51], 0 offen offset:2048 lds
    s_add_u32 s48, s48, 36864
    s_addc_u32 s49, s49, 0
    s_add_u32 m0, s68, 3072
    s_waitcnt lgkmcnt(0)
    v_cndmask_b32 v145, 0, v171, vcc
    v_add_f32 v64, v64, v145
    v_cmp_ne_u32 vcc, v138, v157
    v_lshrrev_b32 v176, 8, v176
    v_mul_u32_u24 v138, 7, v176
    v_cndmask_b32 v145, 0, v171, vcc
    v_add_f32 v76, v76, v145
    v_sub_u32 v138, v163, v138
    v_lshrrev_b32 v176, 2, v176
    v_lshrrev_b32 v138, 2, v138
    buffer_load_dwordx4 v140, s[48:51], 0 offen lds
    s_waitcnt vmcnt(7)
    ds_read_b64_tr_b16 a[16:17], v121 offset:0
    ds_read_b64_tr_b16 a[18:19], v121 offset:768
    ds_read_b64_tr_b16 a[40:41], v121 offset:32
    ds_read_b64_tr_b16 a[42:43], v121 offset:800
    ds_read_b64_tr_b16 a[64:65], v121 offset:64
    ds_read_b64_tr_b16 a[66:67], v121 offset:832
    v_and_b32 v176, s5, v176
    v_and_b32 v138, s6, v138
    v_lshl_or_b32 v176, v176, 1, v138
    v_cmp_ne_u32 vcc, v176, v254
    v_lshl_add_u32 v163, v131, 2, 32
    v_mul_u32_u24 v138, 37, v163
    v_cndmask_b32 v145, 0, v171, vcc
    v_add_f32 v53, v53, v145
    buffer_load_dwordx4 v142, s[48:51], 0 offen offset:1024 lds
    v_cmp_ne_u32 vcc, v176, v255
    v_lshrrev_b32 v138, 8, v138
    v_mul_u32_u24 v177, 7, v138
    v_cndmask_b32 v145, 0, v171, vcc
    v_add_f32 v65, v65, v145
    v_cmp_ne_u32 vcc, v176, v157
    v_sub_u32 v177, v163, v177
    v_lshrrev_b32 v138, 2, v138
    v_cndmask_b32 v145, 0, v171, vcc
    v_add_f32 v77, v77, v145
    v_lshrrev_b32 v177, 2, v177
    v_and_b32 v138, s5, v138
    v_and_b32 v177, s6, v177
    v_lshl_or_b32 v138, v138, 1, v177
    v_cmp_ne_u32 vcc, v138, v254
    buffer_load_dwordx4 v144, s[48:51], 0 offen offset:2048 lds
    s_add_u32 s48, s48, 36864
    s_addc_u32 s49, s49, 0
    s_add_u32 m0, s69, 0
    s_waitcnt lgkmcnt(0)
    v_cndmask_b32 v145, 0, v171, vcc
    v_add_f32 v54, v54, v145
    v_cmp_ne_u32 vcc, v138, v255
    v_lshl_add_u32 v145, v131, 2, 33
    v_mul_u32_u24 v176, 37, v145
    v_cndmask_b32 v163, 0, v171, vcc
    v_add_f32 v66, v66, v163
    v_cmp_ne_u32 vcc, v138, v157
    v_lshrrev_b32 v176, 8, v176
    v_mul_u32_u24 v163, 7, v176
    buffer_load_dwordx4 v140, s[48:51], 0 offen lds
    s_waitcnt vmcnt(7)
    ds_read_b64_tr_b16 a[20:21], v121 offset:3072
    ds_read_b64_tr_b16 a[22:23], v121 offset:3840
    ds_read_b64_tr_b16 a[44:45], v121 offset:3104
    ds_read_b64_tr_b16 a[46:47], v121 offset:3872
    ds_read_b64_tr_b16 a[68:69], v121 offset:3136
    ds_read_b64_tr_b16 a[70:71], v121 offset:3904
    v_cndmask_b32 v138, 0, v171, vcc
    v_add_f32 v78, v78, v138
    v_sub_u32 v163, v145, v163
    v_lshrrev_b32 v176, 2, v176
    v_lshrrev_b32 v163, 2, v163
    v_and_b32 v176, s5, v176
    v_and_b32 v163, s6, v163
    v_lshl_or_b32 v176, v176, 1, v163
    buffer_load_dwordx4 v142, s[48:51], 0 offen offset:1024 lds
    v_cmp_ne_u32 vcc, v176, v254
    v_lshl_add_u32 v145, v131, 2, 34
    v_mul_u32_u24 v163, 37, v145
    v_cndmask_b32 v138, 0, v171, vcc
    v_add_f32 v55, v55, v138
    v_cmp_ne_u32 vcc, v176, v255
    v_lshrrev_b32 v163, 8, v163
    v_mul_u32_u24 v138, 7, v163
    v_cndmask_b32 v177, 0, v171, vcc
    v_add_f32 v67, v67, v177
    v_cmp_ne_u32 vcc, v176, v157
    v_sub_u32 v138, v145, v138
    v_lshrrev_b32 v163, 2, v163
    v_cndmask_b32 v145, 0, v171, vcc
    v_add_f32 v79, v79, v145
    buffer_load_dwordx4 v144, s[48:51], 0 offen offset:2048 lds
    s_add_u32 s48, s48, 36864
    s_addc_u32 s49, s49, 0
    s_add_u32 m0, s69, 3072
    s_waitcnt lgkmcnt(0)
    v_lshrrev_b32 v138, 2, v138
    v_and_b32 v163, s5, v163
    v_and_b32 v138, s6, v138
    v_lshl_or_b32 v163, v163, 1, v138
    v_cmp_ne_u32 vcc, v163, v254
    v_lshl_add_u32 v138, v131, 2, 35
    v_mul_u32_u24 v145, 37, v138
    v_cndmask_b32 v131, 0, v171, vcc
    v_add_f32 v56, v56, v131
    v_cmp_ne_u32 vcc, v163, v255
    v_lshrrev_b32 v145, 8, v145
    buffer_load_dwordx4 v140, s[48:51], 0 offen lds
    s_waitcnt vmcnt(7)
    ds_read_b64_tr_b16 a[144:145], v127 offset:0
    ds_read_b64_tr_b16 a[146:147], v127 offset:768
    ds_read_b64_tr_b16 a[168:169], v127 offset:32
    ds_read_b64_tr_b16 a[170:171], v127 offset:800
    ds_read_b64_tr_b16 a[192:193], v127 offset:64
    ds_read_b64_tr_b16 a[194:195], v127 offset:832
    v_cndmask_b32 v131, 0, v171, vcc
    v_add_f32 v68, v68, v131
    v_cmp_ne_u32 vcc, v163, v157
    v_mul_u32_u24 v163, 7, v145
    v_sub_u32 v163, v138, v163
    v_cndmask_b32 v131, 0, v171, vcc
    v_add_f32 v80, v80, v131
    v_lshrrev_b32 v145, 2, v145
    buffer_load_dwordx4 v142, s[48:51], 0 offen offset:1024 lds
    v_lshrrev_b32 v163, 2, v163
    v_and_b32 v145, s5, v145
    v_and_b32 v163, s6, v163
    v_lshl_or_b32 v145, v145, 1, v163
    v_cmp_ne_u32 vcc, v145, v254
    v_cndmask_b32 v22, v168, v22, s[88:89]
    v_cndmask_b32 v24, v168, v24, s[88:89]
    v_cndmask_b32 v131, 0, v171, vcc
    v_add_f32 v57, v57, v131
    v_cmp_ne_u32 vcc, v145, v255
    v_mov_b32_dpp v23, v25 quad_perm:[0,1,2,3] row_mask:0x2 bank_mask:0xf
    v_cndmask_b32 v26, v168, v26, s[88:89]
    v_cndmask_b32 v131, 0, v171, vcc
    v_add_f32 v69, v69, v131
    v_cmp_ne_u32 vcc, v145, v157
    buffer_load_dwordx4 v144, s[48:51], 0 offen offset:2048 lds
    s_add_u32 s48, s48, 36864
    s_addc_u32 s49, s49, 0
    s_add_u32 m0, s68, 0
    s_waitcnt lgkmcnt(0)
    v_cndmask_b32 v131, 0, v171, vcc
    v_add_f32 v81, v81, v131
    ds_read_b128 v[146:149], v162 offset:0
    ds_read_b128 v[154:157], v164 offset:0
    ds_read_b128 v[122:125], v162 offset:128
    ds_read_b128 v[114:117], v164 offset:128
    buffer_load_dwordx4 v140, s[48:51], 0 offen lds
    s_waitcnt vmcnt(7)
    ds_read_b64_tr_b16 a[148:149], v127 offset:3072
    ds_read_b64_tr_b16 a[150:151], v127 offset:3840
    ds_read_b64_tr_b16 a[172:173], v127 offset:3104
    ds_read_b64_tr_b16 a[174:175], v127 offset:3872
    ds_read_b64_tr_b16 a[196:197], v127 offset:3136
    ds_read_b64_tr_b16 a[198:199], v127 offset:3904
    ds_read_b128 v[190:193], v162 offset:256
    ds_read_b128 v[134:137], v164 offset:256
    buffer_load_dwordx4 v142, s[48:51], 0 offen offset:1024 lds
    v_mov_b32_dpp v23, v27 quad_perm:[0,1,2,3] row_mask:0x4 bank_mask:0xf
    s_waitcnt lgkmcnt(11)
    v_mfma_f32_16x16x32_bf16 v[158:161], a[72:75], v[146:149], 0
    s_waitcnt lgkmcnt(9)
    v_mov_b32 v186, 0
    v_mov_b32 v187, 0
    v_mfma_f32_16x16x32_bf16 v[158:161], a[76:79], v[154:157], v[158:161]
    s_waitcnt lgkmcnt(8)
    ds_write_b64 v166, v[186:187] offset:56
    v_mfma_f32_16x16x32_bf16 v[158:161], a[80:83], v[122:125], v[158:161]
    s_waitcnt lgkmcnt(7)
    v_mov_b32 v188, 0
    v_mov_b32 v189, 0
    v_mfma_f32_16x16x32_bf16 v[158:161], a[84:87], v[114:117], v[158:161]
    s_waitcnt lgkmcnt(5)
    buffer_load_dwordx4 v144, s[48:51], 0 offen offset:2048 lds
    s_add_u32 s48, s48, 36864
    v_mfma_f32_16x16x32_bf16 v[150:153], a[96:99], v[146:149], 0
    s_addc_u32 s49, s49, 0
    ds_write_b128 v166, v[186:189] offset:16
    v_mfma_f32_16x16x32_bf16 v[150:153], a[100:103], v[154:157], v[150:153]
    s_waitcnt lgkmcnt(2)
    s_add_u32 m0, s68, 3072
    v_mfma_f32_16x16x32_bf16 v[158:161], a[88:91], v[190:193], v[158:161]
    v_mfma_f32_16x16x32_bf16 v[158:161], a[92:95], v[134:137], v[158:161]
    s_waitcnt vmcnt(6)
    buffer_load_dwordx4 v140, s[48:51], 0 offen lds
    ds_read_b64_tr_b16 a[152:153], v121 offset:0
    v_mfma_f32_16x16x32_bf16 v[150:153], a[104:107], v[122:125], v[150:153]
    ds_read_b64_tr_b16 a[154:155], v121 offset:768
    ds_read_b64_tr_b16 a[176:177], v121 offset:32
    v_mfma_f32_16x16x32_bf16 v[150:153], a[108:111], v[114:117], v[150:153]
    ds_read_b64_tr_b16 a[178:179], v121 offset:800
    ds_read_b64_tr_b16 a[200:201], v121 offset:64
    v_mfma_f32_16x16x32_bf16 v[150:153], a[112:115], v[190:193], v[150:153]
    ds_read_b64_tr_b16 a[202:203], v121 offset:832
    ds_read_b128 v[202:205], v162 offset:6144
    v_mfma_f32_16x16x32_bf16 v[150:153], a[116:119], v[134:137], v[150:153]
    ds_read_b128 v[226:229], v164 offset:6144
    ds_read_b128 v[234:237], v162 offset:6272
    v_mfma_f32_16x16x32_bf16 v[194:197], a[120:123], v[146:149], 0
    buffer_load_dwordx4 v142, s[48:51], 0 offen offset:1024 lds
    ds_read_b128 v[182:185], v164 offset:6272
    v_mfma_f32_16x16x32_bf16 v[194:197], a[124:127], v[154:157], v[194:197]
    ds_read_b128 v[178:181], v162 offset:6400
    v_fma_f32 v131, v158, v158, s32
    v_mfma_f32_16x16x32_bf16 v[194:197], a[128:131], v[122:125], v[194:197]
    ds_read_b128 v[198:201], v164 offset:6400
    v_fmac_f32 v131, v159, v159
    v_mfma_f32_16x16x32_bf16 v[194:197], a[132:135], v[114:117], v[194:197]
    s_waitcnt lgkmcnt(11)
    ds_write_b64 v166, v[186:187] offset:64
    v_mfma_f32_16x16x32_bf16 v[194:197], a[136:139], v[190:193], v[194:197]
    s_waitcnt lgkmcnt(9)
    v_fmac_f32 v131, v160, v160
    v_fmac_f32 v131, v161, v161
    v_mfma_f32_16x16x32_bf16 v[194:197], a[140:143], v[134:137], v[194:197]
    s_waitcnt lgkmcnt(7)
    buffer_load_dwordx4 v144, s[48:51], 0 offen offset:2048 lds
    v_fmac_f32 v131, v150, v150
    v_mfma_f32_16x16x32_bf16 v[214:217], a[0:3], v[146:149], 0
    s_waitcnt lgkmcnt(5)
    ds_write_b128 v169, v[186:189] offset:16
    v_mfma_f32_16x16x32_bf16 v[210:213], a[72:75], v[202:205], 0
    s_add_u32 m0, s28, 8192
    s_waitcnt vmcnt(6)
    v_fmac_f32 v131, v151, v151
    v_mfma_f32_16x16x32_bf16 v[210:213], a[76:79], v[226:229], v[210:213]
    s_waitcnt lgkmcnt(3)
    v_fmac_f32 v131, v152, v152
    v_fmac_f32 v131, v153, v153
    v_mfma_f32_16x16x32_bf16 v[210:213], a[80:83], v[234:237], v[210:213]
    s_waitcnt lgkmcnt(2)
    buffer_load_dwordx4 v12, s[8:11], s25 offen nt lds
    v_mfma_f32_16x16x32_bf16 v[210:213], a[84:87], v[182:185], v[210:213]
    s_add_u32 m0, s28, 12288
    ds_read_b64_tr_b16 a[156:157], v121 offset:3072
    ds_read_b64_tr_b16 a[158:159], v121 offset:3840
    v_mfma_f32_16x16x32_bf16 v[210:213], a[88:91], v[178:181], v[210:213]
    ds_read_b64_tr_b16 a[180:181], v121 offset:3104
    ds_read_b64_tr_b16 a[182:183], v121 offset:3872
    v_mfma_f32_16x16x32_bf16 v[210:213], a[92:95], v[198:201], v[210:213]
    ds_read_b64_tr_b16 a[204:205], v121 offset:3136
    ds_read_b64_tr_b16 a[206:207], v121 offset:3904
    v_mfma_f32_16x16x32_bf16 v[218:221], a[96:99], v[202:205], 0
    ds_write_b64 v169, v[186:187] offset:56
    v_mfma_f32_16x16x32_bf16 v[218:221], a[100:103], v[226:229], v[218:221]
    buffer_load_dwordx4 v13, s[8:11], s25 offen nt lds
    v_mfma_f32_16x16x32_bf16 v[218:221], a[104:107], v[234:237], v[218:221]
    s_add_u32 m0, s29, 0
    ds_write_b64 v169, v[186:187] offset:64
    v_mfma_f32_16x16x32_bf16 v[218:221], a[108:111], v[182:185], v[218:221]
    v_fmac_f32 v131, v194, v194
    v_fmac_f32 v131, v195, v195
    v_mfma_f32_16x16x32_bf16 v[218:221], a[112:115], v[178:181], v[218:221]
    s_waitcnt lgkmcnt(6)
    ds_write_b16 v8, v186 offset:2816
    v_mfma_f32_16x16x32_bf16 v[218:221], a[116:119], v[198:201], v[218:221]
    s_waitcnt lgkmcnt(5)
    v_fmac_f32 v131, v196, v196
    v_fmac_f32 v131, v197, v197
    v_mfma_f32_16x16x32_bf16 v[222:225], a[120:123], v[202:205], 0
    s_waitcnt lgkmcnt(3)
    buffer_load_dwordx4 v14, s[8:11], s25 offen nt lds
    v_mfma_f32_16x16x32_bf16 v[222:225], a[124:127], v[226:229], v[222:225]
    s_add_u32 m0, s69, 0
    s_waitcnt vmcnt(6)
    ds_read_b64_tr_b16 a[160:161], v127 offset:0
    v_mfma_f32_16x16x32_bf16 v[222:225], a[128:131], v[234:237], v[222:225]
    s_lshr_b32 s10, s17, 1
    ds_read_b64_tr_b16 a[162:163], v127 offset:768
    ds_read_b64_tr_b16 a[184:185], v127 offset:32
    v_mfma_f32_16x16x32_bf16 v[222:225], a[132:135], v[182:185], v[222:225]
    s_cselect_b32 s10, s36, 0
    ds_read_b64_tr_b16 a[186:187], v127 offset:800
    ds_read_b64_tr_b16 a[208:209], v127 offset:64
    v_mfma_f32_16x16x32_bf16 v[222:225], a[136:139], v[178:181], v[222:225]
    s_mov_b32 s25, s24
    ds_read_b64_tr_b16 a[210:211], v127 offset:832
    v_fma_f32 v171, v210, v210, s32
    v_mfma_f32_16x16x32_bf16 v[222:225], a[140:143], v[198:201], v[222:225]
    buffer_load_dwordx4 v174, s[52:55], 0 offen lds
    v_fmac_f32 v171, v211, v211
    v_mfma_f32_16x16x32_bf16 v[214:217], a[4:7], v[154:157], v[214:217]
    v_fmac_f32 v171, v212, v212
    v_fmac_f32 v171, v213, v213
    v_mfma_f32_16x16x32_bf16 v[214:217], a[8:11], v[122:125], v[214:217]
    v_fmac_f32 v171, v218, v218
    v_fmac_f32 v171, v219, v219
    v_mfma_f32_16x16x32_bf16 v[214:217], a[12:15], v[114:117], v[214:217]
    v_fmac_f32 v171, v220, v220
    v_fmac_f32 v171, v221, v221
    v_mfma_f32_16x16x32_bf16 v[214:217], a[16:19], v[190:193], v[214:217]
    s_waitcnt lgkmcnt(5)
    v_fmac_f32 v171, v222, v222
    v_fmac_f32 v171, v223, v223
    v_mfma_f32_16x16x32_bf16 v[214:217], a[20:23], v[134:137], v[214:217]
    s_waitcnt lgkmcnt(3)
    buffer_load_dwordx4 v139, s[52:55], 0 offen offset:1024 lds
    v_fmac_f32 v171, v224, v224
    v_mfma_f32_16x16x32_bf16 v[230:233], a[24:27], v[146:149], 0
    s_waitcnt lgkmcnt(1)
    v_fmac_f32 v171, v225, v225
    v_xor_b32 v254, 65536, v2
    v_mfma_f32_16x16x32_bf16 v[230:233], a[28:31], v[154:157], v[230:233]
    s_waitcnt lgkmcnt(0)
    v_fma_f32 v163, v214, v214, s32
    v_fmac_f32 v163, v215, v215
    v_mfma_f32_16x16x32_bf16 v[230:233], a[32:35], v[122:125], v[230:233]
    v_fmac_f32 v163, v216, v216
    v_fmac_f32 v163, v217, v217
    v_mfma_f32_16x16x32_bf16 v[230:233], a[36:39], v[114:117], v[230:233]
    v_lshrrev_b32 v138, 2, v254
    v_lshrrev_b32 v255, 8, v254
    v_mfma_f32_16x16x32_bf16 v[230:233], a[40:43], v[190:193], v[230:233]
    buffer_load_dwordx4 v130, s[52:55], 0 offen offset:2048 lds
    v_lshl_add_u32 v140, s16, 2, v254
    v_mfma_f32_16x16x32_bf16 v[230:233], a[44:47], v[134:137], v[230:233]
    s_add_u32 s52, s52, 12288
    s_waitcnt vmcnt(6)
    ds_read_b64_tr_b16 a[164:165], v127 offset:3072
    v_mfma_f32_16x16x32_bf16 v[238:241], a[48:51], v[146:149], 0
    s_addc_u32 s53, s53, 0
    ds_read_b64_tr_b16 a[166:167], v127 offset:3840
    ds_read_b64_tr_b16 a[188:189], v127 offset:3104
    v_mfma_f32_16x16x32_bf16 v[238:241], a[52:55], v[154:157], v[238:241]
    s_add_u32 m0, s69, 3072
    ds_read_b64_tr_b16 a[190:191], v127 offset:3872
    ds_read_b64_tr_b16 a[212:213], v127 offset:3136
    v_mfma_f32_16x16x32_bf16 v[238:241], a[56:59], v[122:125], v[238:241]
    ds_read_b64_tr_b16 a[214:215], v127 offset:3904
    v_fmac_f32 v163, v230, v230
    v_mfma_f32_16x16x32_bf16 v[238:241], a[60:63], v[114:117], v[238:241]
    buffer_load_dwordx4 v174, s[52:55], 0 offen lds
    v_fmac_f32 v163, v231, v231
    v_mfma_f32_16x16x32_bf16 v[238:241], a[64:67], v[190:193], v[238:241]
    v_fmac_f32 v163, v232, v232
    v_fmac_f32 v163, v233, v233
    v_mfma_f32_16x16x32_bf16 v[238:241], a[68:71], v[134:137], v[238:241]
    v_add_u32 v138, 62784, v138
    v_lshlrev_b32 v255, 4, v255
    v_mfma_f32_16x16x32_bf16 v[114:117], a[0:3], v[202:205], 0
    v_add_u32 v255, 62784, v255
    v_or_b32 v134, v32, v33
    v_mfma_f32_16x16x32_bf16 v[114:117], a[4:7], v[226:229], v[114:117]
    s_waitcnt lgkmcnt(5)
    v_and_b32 v134, 0xffff, v134
    v_fmac_f32 v163, v238, v238
    v_mfma_f32_16x16x32_bf16 v[114:117], a[8:11], v[234:237], v[114:117]
    s_waitcnt lgkmcnt(3)
    buffer_load_dwordx4 v139, s[52:55], 0 offen offset:1024 lds
    v_fmac_f32 v163, v239, v239
    v_mfma_f32_16x16x32_bf16 v[114:117], a[12:15], v[182:185], v[114:117]
    s_waitcnt lgkmcnt(1)
    v_fmac_f32 v163, v240, v240
    v_fmac_f32 v163, v241, v241
    v_mfma_f32_16x16x32_bf16 v[114:117], a[16:19], v[178:181], v[114:117]
    s_waitcnt lgkmcnt(0)
    v_cvt_pk_bf16_f32 v36, v163, v131
    v_lshl_or_b32 v134, v134, 16, v134
    v_mfma_f32_16x16x32_bf16 v[114:117], a[20:23], v[198:201], v[114:117]
    v_or_b32 v135, v32, v33
    v_and_b32 v135, 0xffff, v135
    v_mfma_f32_16x16x32_bf16 v[246:249], v[32:35], v[36:39], 0
    v_lshl_or_b32 v135, v135, 16, v135
    v_or_b32 v136, v32, v33
    v_mfma_f32_16x16x32_bf16 v[242:245], a[24:27], v[202:205], 0
    buffer_load_dwordx4 v130, s[52:55], 0 offen offset:2048 lds
    v_lshrrev_b32 v136, 16, v136
    v_mfma_f32_16x16x32_bf16 v[242:245], a[28:31], v[226:229], v[242:245]
    s_add_u32 s52, s52, 12288
    v_lshl_or_b32 v136, v136, 16, v136
    v_or_b32 v137, v32, v33
    v_mfma_f32_16x16x32_bf16 v[242:245], a[32:35], v[234:237], v[242:245]
    s_addc_u32 s53, s53, 0
    v_rsq_f32 v247, v247
    v_mfma_f32_16x16x32_bf16 v[242:245], a[36:39], v[182:185], v[242:245]
    s_add_u32 m0, s68, 0
    ds_read_b128 v[154:157], v0 offset:20480
    v_mul_f32 v158, v247, v158
    v_mfma_f32_16x16x32_bf16 v[242:245], a[40:43], v[178:181], v[242:245]
    ds_read_b128 v[186:189], v1 offset:20480
    v_mul_f32 v159, v247, v159
    v_mfma_f32_16x16x32_bf16 v[242:245], a[44:47], v[198:201], v[242:245]
    buffer_load_dwordx4 v174, s[52:55], 0 offen lds
    ds_read_b128 v[206:209], v0 offset:20608
    v_mfma_f32_16x16x32_bf16 v[250:253], a[48:51], v[202:205], 0
    ds_read_b128 v[190:193], v1 offset:20608
    v_cvt_pk_f16_f32 v118, v158, v159
    v_mfma_f32_16x16x32_bf16 v[250:253], a[52:55], v[226:229], v[250:253]
    ds_read_b128 v[226:229], v0 offset:20736
    v_mul_f32 v160, v247, v160
    v_mfma_f32_16x16x32_bf16 v[250:253], a[56:59], v[234:237], v[250:253]
    ds_read_b128 v[234:237], v1 offset:20736
    v_mul_f32 v161, v247, v161
    v_mfma_f32_16x16x32_bf16 v[250:253], a[60:63], v[182:185], v[250:253]
    v_rsq_f32 v246, v246
    v_mfma_f32_16x16x32_bf16 v[250:253], a[64:67], v[178:181], v[250:253]
    v_mul_f32 v246, s31, v246
    v_cvt_pk_f16_f32 v119, v160, v161
    v_mfma_f32_16x16x32_bf16 v[250:253], a[68:71], v[198:201], v[250:253]
    s_waitcnt lgkmcnt(5)
    v_mul_f32 v150, v247, v150
    v_mul_f32 v151, v247, v151
    v_mfma_f32_16x16x32_bf16 v[126:129], a[96:99], v[154:157], 0
    s_waitcnt lgkmcnt(4)
    v_cvt_pk_f16_f32 v120, v150, v151
    v_mul_f32 v152, v247, v152
    v_mfma_f32_16x16x32_bf16 v[126:129], a[100:103], v[186:189], v[126:129]
    s_waitcnt lgkmcnt(3)
    v_mul_f32 v153, v247, v153
    v_cvt_pk_f16_f32 v121, v152, v153
    v_mfma_f32_16x16x32_bf16 v[126:129], a[104:107], v[206:209], v[126:129]
    s_waitcnt lgkmcnt(2)
    ds_write_b128 v166, v[118:121]
    v_mfma_f32_16x16x32_bf16 v[126:129], a[108:111], v[190:193], v[126:129]
    s_waitcnt lgkmcnt(1)
    v_mul_f32 v194, v247, v194
    v_mul_f32 v195, v247, v195
    v_mfma_f32_16x16x32_bf16 v[126:129], a[112:115], v[226:229], v[126:129]
    v_cvt_pk_f16_f32 v200, v194, v195
    v_mul_f32 v196, v247, v196
    v_mfma_f32_16x16x32_bf16 v[126:129], a[116:119], v[234:237], v[126:129]
    v_mul_f32 v197, v247, v197
    v_cvt_pk_f16_f32 v201, v196, v197
    v_mfma_f32_16x16x32_bf16 v[146:149], a[120:123], v[154:157], 0
    ds_write_b64 v166, v[200:201] offset:48
    v_mfma_f32_16x16x32_bf16 v[146:149], a[124:127], v[186:189], v[146:149]
    v_mul_f32 v214, v246, v214
    v_mul_f32 v215, v246, v215
    v_mfma_f32_16x16x32_bf16 v[146:149], a[128:131], v[206:209], v[146:149]
    v_cvt_pk_f16_f32 v122, v214, v215
    v_mul_f32 v216, v246, v216
    v_mfma_f32_16x16x32_bf16 v[146:149], a[132:135], v[190:193], v[146:149]
    v_mul_f32 v217, v246, v217
    v_cvt_pk_f16_f32 v123, v216, v217
    v_mfma_f32_16x16x32_bf16 v[146:149], a[136:139], v[226:229], v[146:149]
    v_mul_f32 v230, v246, v230
    v_mul_f32 v231, v246, v231
    v_mfma_f32_16x16x32_bf16 v[146:149], a[140:143], v[234:237], v[146:149]
    v_cvt_pk_f16_f32 v124, v230, v231
    v_mul_f32 v232, v246, v232
    v_mfma_f32_16x16x32_bf16 v[118:121], a[24:27], v[154:157], 0
    v_mul_f32 v233, v246, v233
    v_cvt_pk_f16_f32 v125, v232, v233
    v_mfma_f32_16x16x32_bf16 v[118:121], a[28:31], v[186:189], v[118:121]
    ds_write_b128 v166, v[122:125] offset:32
    v_mfma_f32_16x16x32_bf16 v[122:125], a[72:75], v[154:157], 0
    v_mul_f32 v238, v246, v238
    v_mul_f32 v239, v246, v239
    v_mfma_f32_16x16x32_bf16 v[122:125], a[76:79], v[186:189], v[122:125]
    v_cvt_pk_f16_f32 v198, v238, v239
    v_mul_f32 v240, v246, v240
    v_mfma_f32_16x16x32_bf16 v[122:125], a[80:83], v[206:209], v[122:125]
    v_mul_f32 v241, v246, v241
    v_cvt_pk_f16_f32 v199, v240, v241
    v_mfma_f32_16x16x32_bf16 v[122:125], a[84:87], v[190:193], v[122:125]
    ds_write_b64 v166, v[198:199] offset:72
    v_mfma_f32_16x16x32_bf16 v[122:125], a[88:91], v[226:229], v[122:125]
    v_mul_f32 v158, v214, v158
    v_fmac_f32 v158, v215, v159
    v_mfma_f32_16x16x32_bf16 v[122:125], a[92:95], v[234:237], v[122:125]
    v_fmac_f32 v158, v216, v160
    v_fmac_f32 v158, v217, v161
    v_mfma_f32_16x16x32_bf16 v[118:121], a[32:35], v[206:209], v[118:121]
    v_fmac_f32 v158, v230, v150
    v_fmac_f32 v158, v231, v151
    v_mfma_f32_16x16x32_bf16 v[118:121], a[36:39], v[190:193], v[118:121]
    v_fmac_f32 v158, v232, v152
    v_fmac_f32 v158, v233, v153
    v_mfma_f32_16x16x32_bf16 v[118:121], a[40:43], v[226:229], v[118:121]
    v_fmac_f32 v158, v238, v194
    v_fmac_f32 v158, v239, v195
    v_mfma_f32_16x16x32_bf16 v[118:121], a[44:47], v[234:237], v[118:121]
    v_fmac_f32 v158, v240, v196
    v_fmac_f32 v158, v241, v197
    v_mfma_f32_16x16x32_bf16 v[150:153], a[48:51], v[154:157], 0
    v_mov_b32 v131, v158
    v_lshrrev_b32 v137, 16, v137
    v_mfma_f32_16x16x32_bf16 v[150:153], a[52:55], v[186:189], v[150:153]
    v_permlane32_swap_b32 v158, v131
    v_mfma_f32_16x16x32_bf16 v[150:153], a[56:59], v[206:209], v[150:153]
    v_add_f32 v158, v158, v131
    v_mov_b32 v131, v158
    v_mfma_f32_16x16x32_bf16 v[150:153], a[60:63], v[190:193], v[150:153]
    v_lshl_or_b32 v137, v137, 16, v137
    v_fma_f32 v166, v114, v114, s32
    v_mfma_f32_16x16x32_bf16 v[150:153], a[64:67], v[226:229], v[150:153]
    v_permlane16_swap_b32 v158, v131
    v_mfma_f32_16x16x32_bf16 v[150:153], a[68:71], v[234:237], v[150:153]
    v_add_f32 v158, v158, v131
    v_add_f32 v158, s39, v158
    v_mfma_f32_16x16x32_bf16 v[194:197], v[154:157], a[144:147], 0
    v_mov_b32 v159, v168
    v_mov_b32 v160, v168
    v_mfma_f32_16x16x32_bf16 v[194:197], v[186:189], a[148:151], v[194:197]
    v_mov_b32 v161, v168
    v_cndmask_b32 v158, v168, v158, s[88:89]
    v_mfma_f32_16x16x32_bf16 v[194:197], v[206:209], a[152:155], v[194:197]
    ds_write_b128 v165, v[158:161] offset:192
    v_mfma_f32_16x16x32_bf16 v[194:197], v[190:193], a[156:159], v[194:197]
    v_fmac_f32 v166, v115, v115
    v_fmac_f32 v166, v116, v116
    v_mfma_f32_16x16x32_bf16 v[194:197], v[226:229], a[160:163], v[194:197]
    v_fmac_f32 v166, v117, v117
    v_fmac_f32 v166, v242, v242
    v_mfma_f32_16x16x32_bf16 v[194:197], v[234:237], a[164:167], v[194:197]
    v_fmac_f32 v166, v243, v243
    v_fmac_f32 v166, v244, v244
    v_mfma_f32_16x16x32_bf16 v[158:161], v[154:157], a[168:171], 0
    v_fmac_f32 v166, v245, v245
    v_fmac_f32 v166, v250, v250
    v_mfma_f32_16x16x32_bf16 v[158:161], v[186:189], a[172:175], v[158:161]
    v_fmac_f32 v166, v251, v251
    v_fmac_f32 v166, v252, v252
    v_mfma_f32_16x16x32_bf16 v[158:161], v[206:209], a[176:179], v[158:161]
    v_fmac_f32 v166, v253, v253
    v_cvt_pk_bf16_f32 v36, v166, v171
    v_mfma_f32_16x16x32_bf16 v[158:161], v[190:193], a[180:183], v[158:161]
    ds_read_b128 v[198:201], v162 offset:0
    v_fma_f32 v131, v122, v122, s32
    v_mfma_f32_16x16x32_bf16 v[214:217], v[32:35], v[36:39], 0
    v_fmac_f32 v131, v123, v123
    v_fmac_f32 v131, v124, v124
    v_mfma_f32_16x16x32_bf16 v[158:161], v[226:229], a[184:187], v[158:161]
    ds_read_b128 v[178:181], v164 offset:0
    v_fmac_f32 v131, v125, v125
    v_mfma_f32_16x16x32_bf16 v[158:161], v[234:237], a[188:191], v[158:161]
    ds_read_b128 v[182:185], v162 offset:128
    v_fmac_f32 v131, v126, v126
    v_rsq_f32 v215, v215
    v_rsq_f32 v214, v214
    v_mul_f32 v210, v215, v210
    v_mul_f32 v214, s31, v214
    v_mul_f32 v211, v215, v211
    v_cvt_pk_f16_f32 v202, v210, v211
    v_mul_f32 v212, v215, v212
    v_mul_f32 v213, v215, v213
    v_cvt_pk_f16_f32 v203, v212, v213
    v_mul_f32 v218, v215, v218
    v_mul_f32 v219, v215, v219
    v_cvt_pk_f16_f32 v204, v218, v219
    v_mul_f32 v220, v215, v220
    v_mul_f32 v221, v215, v221
    v_cvt_pk_f16_f32 v205, v220, v221
    v_mul_f32 v222, v215, v222
    v_mul_f32 v223, v215, v223
    v_cvt_pk_f16_f32 v232, v222, v223
    v_mul_f32 v224, v215, v224
    v_mul_f32 v225, v215, v225
    v_cvt_pk_f16_f32 v233, v224, v225
    v_mul_f32 v114, v214, v114
    v_mul_f32 v115, v214, v115
    v_cvt_pk_f16_f32 v238, v114, v115
    v_mul_f32 v116, v214, v116
    v_mul_f32 v117, v214, v117
    v_cvt_pk_f16_f32 v239, v116, v117
    v_mul_f32 v242, v214, v242
    v_mul_f32 v243, v214, v243
    v_cvt_pk_f16_f32 v240, v242, v243
    v_mul_f32 v244, v214, v244
    v_mul_f32 v245, v214, v245
    v_cvt_pk_f16_f32 v241, v244, v245
    v_mul_f32 v250, v214, v250
    v_mul_f32 v251, v214, v251
    v_cvt_pk_f16_f32 v230, v250, v251
    v_mul_f32 v252, v214, v252
    v_mul_f32 v253, v214, v253
    v_cvt_pk_f16_f32 v231, v252, v253
    v_mul_f32 v210, v114, v210
    v_fmac_f32 v210, v115, v211
    v_fmac_f32 v210, v116, v212
    v_fmac_f32 v210, v117, v213
    v_fmac_f32 v210, v242, v218
    v_fmac_f32 v210, v243, v219
    v_fmac_f32 v210, v244, v220
    v_mfma_f32_16x16x32_bf16 v[214:217], v[154:157], a[192:195], 0
    s_waitcnt lgkmcnt(0)
    ds_write_b128 v169, v[202:205]
    v_mfma_f32_16x16x32_bf16 v[114:117], a[0:3], v[154:157], 0
    v_fmac_f32 v210, v245, v221
    v_fmac_f32 v210, v250, v222
    v_mfma_f32_16x16x32_bf16 v[114:117], a[4:7], v[186:189], v[114:117]
    buffer_load_dwordx4 v139, s[52:55], 0 offen offset:1024 lds
    v_fmac_f32 v210, v251, v223
    v_mfma_f32_16x16x32_bf16 v[114:117], a[8:11], v[206:209], v[114:117]
    ds_read_b128 v[154:157], v164 offset:128
    v_fmac_f32 v210, v252, v224
    v_mfma_f32_16x16x32_bf16 v[114:117], a[12:15], v[190:193], v[114:117]
    ds_write_b64 v169, v[232:233] offset:48
    v_mfma_f32_16x16x32_bf16 v[114:117], a[16:19], v[226:229], v[114:117]
    v_fmac_f32 v210, v253, v225
    v_mov_b32 v171, v210
    v_mfma_f32_16x16x32_bf16 v[114:117], a[20:23], v[234:237], v[114:117]
    ds_write_b128 v169, v[238:241] offset:32
    v_mfma_f32_16x16x32_bf16 v[214:217], v[186:189], a[196:199], v[214:217]
    buffer_load_dwordx4 v130, s[52:55], 0 offen offset:2048 lds
    v_fmac_f32 v131, v127, v127
    v_mfma_f32_16x16x32_bf16 v[214:217], v[206:209], a[200:203], v[214:217]
    s_add_u32 s52, s52, 12288
    v_permlane32_swap_b32 v210, v171
    v_mfma_f32_16x16x32_bf16 v[214:217], v[190:193], a[204:207], v[214:217]
    s_addc_u32 s53, s53, 0
    ds_read_b128 v[186:189], v162 offset:256
    ds_read_b128 v[190:193], v164 offset:256
    v_mfma_f32_16x16x32_bf16 v[214:217], v[226:229], a[208:211], v[214:217]
    s_add_u32 m0, s68, 3072
    ds_write_b64 v169, v[230:231] offset:72
    v_mfma_f32_16x16x32_bf16 v[214:217], v[234:237], a[212:215], v[214:217]
    s_mul_i32 s68, s78, 72
    v_add_f32 v210, v210, v171
    v_mov_b32 v171, v210
    v_mfma_f32_16x16x32_bf16 v[234:237], v[198:201], a[144:147], 0
    s_waitcnt lgkmcnt(4)
    buffer_load_dwordx4 v174, s[52:55], 0 offen lds
    v_fmac_f32 v131, v128, v128
    v_mfma_f32_16x16x32_bf16 v[234:237], v[178:181], a[148:151], v[234:237]
    s_sub_u32 s68, s77, s68
    v_permlane16_swap_b32 v210, v171
    v_mfma_f32_16x16x32_bf16 v[234:237], v[182:185], a[152:155], v[234:237]
    s_mul_i32 s78, s78, 1373568
    v_add_f32 v210, v210, v171
    v_add_f32 v210, s39, v210
    v_mfma_f32_16x16x32_bf16 v[234:237], v[154:157], a[156:159], v[234:237]
    s_mul_i32 s77, s68, 2688
    v_mov_b32 v211, v168
    v_mov_b32 v212, v168
    v_mfma_f32_16x16x32_bf16 v[206:209], v[198:201], a[168:171], 0
    s_waitcnt lgkmcnt(2)
    v_mov_b32 v213, v168
    v_cndmask_b32 v210, v168, v210, s[88:89]
    v_mfma_f32_16x16x32_bf16 v[234:237], v[186:189], a[160:163], v[234:237]
    s_waitcnt lgkmcnt(0)
    buffer_load_dwordx4 v139, s[52:55], 0 offen offset:1024 lds
    v_fmac_f32 v131, v129, v129
    v_mfma_f32_16x16x32_bf16 v[234:237], v[190:193], a[164:167], v[234:237]
    s_add_u32 s77, s77, s78
    ds_write_b128 v143, v[210:213] offset:192
    v_mfma_f32_16x16x32_bf16 v[206:209], v[178:181], a[172:175], v[206:209]
    v_fmac_f32 v131, v146, v146
    v_fmac_f32 v131, v147, v147
    v_mfma_f32_16x16x32_bf16 v[206:209], v[182:185], a[176:179], v[206:209]
    v_fmac_f32 v131, v148, v148
    v_fmac_f32 v131, v149, v149
    v_mfma_f32_16x16x32_bf16 v[206:209], v[154:157], a[180:183], v[206:209]
    buffer_load_dwordx4 v130, s[52:55], 0 offen offset:2048 lds
    ds_read_b128 v[142:145], v162 offset:6144
    v_mfma_f32_16x16x32_bf16 v[206:209], v[186:189], a[184:187], v[206:209]
    s_add_u32 s52, s52, 12288
    ds_read_b128 v[218:221], v164 offset:6144
    v_fma_f32 v171, v114, v114, s32
    v_mfma_f32_16x16x32_bf16 v[206:209], v[190:193], a[188:191], v[206:209]
    s_waitcnt vmcnt(9)
    ds_read_b64 a[216:217], v133 offset:0
    ds_read_b64 a[218:219], v133 offset:1536
    v_mfma_f32_16x16x32_bf16 v[226:229], v[198:201], a[192:195], 0
    s_addc_u32 s53, s53, 0
    ds_read_b64 a[240:241], v133 offset:8
    ds_read_b64 a[242:243], v133 offset:1544
    v_mfma_f32_16x16x32_bf16 v[226:229], v[178:181], a[196:199], v[226:229]
    s_add_u32 m0, s69, 0
    ds_read_b64 v[90:91], v132 offset:0
    ds_read_b64 v[92:93], v132 offset:1536
    v_mfma_f32_16x16x32_bf16 v[226:229], v[182:185], a[200:203], v[226:229]
    ds_read_b128 v[210:213], v162 offset:6272
    ds_read_b128 v[198:201], v164 offset:6272
    v_mfma_f32_16x16x32_bf16 v[226:229], v[154:157], a[204:207], v[226:229]
    ds_read_b128 v[182:185], v162 offset:6400
    v_fmac_f32 v171, v115, v115
    v_mfma_f32_16x16x32_bf16 v[226:229], v[186:189], a[208:211], v[226:229]
    ds_read_b128 v[154:157], v164 offset:6400
    v_fmac_f32 v171, v116, v116
    v_mfma_f32_16x16x32_bf16 v[226:229], v[190:193], a[212:215], v[226:229]
    s_waitcnt lgkmcnt(11)
    v_fmac_f32 v171, v117, v117
    v_fmac_f32 v171, v118, v118
    v_mfma_f32_16x16x32_bf16 v[190:193], v[142:145], a[144:147], 0
    s_waitcnt lgkmcnt(10)
    v_fmac_f32 v171, v119, v119
    v_fmac_f32 v171, v120, v120
    v_mfma_f32_16x16x32_bf16 v[190:193], v[218:221], a[148:151], v[190:193]
    s_waitcnt lgkmcnt(8)
    v_fmac_f32 v171, v121, v121
    v_fmac_f32 v171, v150, v150
    v_mfma_f32_16x16x32_bf16 v[162:165], v[134:137], a[216:219], 0
    s_waitcnt lgkmcnt(6)
    v_fmac_f32 v171, v151, v151
    v_fmac_f32 v171, v152, v152
    v_mfma_f32_16x16x32_bf16 v[162:165], v[134:137], a[240:243], v[162:165]
    s_waitcnt lgkmcnt(4)
    buffer_load_dwordx4 v174, s[52:55], 0 offen lds
    v_fmac_f32 v171, v153, v153
    v_mfma_f32_16x16x32_bf16 v[162:165], v[134:137], v[90:93], v[162:165]
    s_waitcnt lgkmcnt(2)
    v_cvt_pk_bf16_f32 v36, v171, v131
    v_cvt_pk_bf16_f32 v194, v194, v195
    v_mfma_f32_16x16x32_bf16 v[190:193], v[210:213], a[152:155], v[190:193]
    s_waitcnt lgkmcnt(1)
    v_cvt_pk_bf16_f32 v195, v196, v197
    v_cvt_pk_bf16_f32 v158, v158, v159
    s_waitcnt vmcnt(7)
    v_mfma_f32_16x16x32_bf16 v[186:189], v[32:35], v[36:39], 0
    s_waitcnt lgkmcnt(0)
    ds_read_b64 a[232:233], v133 offset:3072
    ds_read_b64 a[220:221], v133 offset:4608
    v_mfma_f32_16x16x32_bf16 v[190:193], v[198:201], a[156:159], v[190:193]
    ds_read_b64 v[82:83], v133 offset:3080
    buffer_load_dwordx4 v139, s[52:55], 0 offen offset:1024 lds
    v_mfma_f32_16x16x32_bf16 v[190:193], v[182:185], a[160:163], v[190:193]
    ds_read_b64 a[244:245], v133 offset:4616
    ds_read_b64 v[106:107], v132 offset:3072
    v_mfma_f32_16x16x32_bf16 v[190:193], v[154:157], a[164:167], v[190:193]
    ds_read_b64 v[94:95], v132 offset:4608
    v_mov_b32 v159, v162
    v_mfma_f32_16x16x32_bf16 v[178:181], v[142:145], a[168:171], 0
    v_rsq_f32 v187, v187
    v_mfma_f32_16x16x32_bf16 v[178:181], v[218:221], a[172:175], v[178:181]
    v_mov_b32_dpp v159, v163 quad_perm:[0,1,2,3] row_mask:0x2 bank_mask:0xf
    v_mul_f32 v122, v187, v122
    v_mfma_f32_16x16x32_bf16 v[178:181], v[210:213], a[176:179], v[178:181]
    buffer_load_dwordx4 v130, s[52:55], 0 offen offset:2048 lds
    v_mul_f32 v123, v187, v123
    v_mfma_f32_16x16x32_bf16 v[178:181], v[198:201], a[180:183], v[178:181]
    s_add_u32 s52, s52, 12288
    v_rsq_f32 v186, v186
    v_mfma_f32_16x16x32_bf16 v[178:181], v[182:185], a[184:187], v[178:181]
    s_addc_u32 s53, s53, 0
    v_mul_f32 v186, s31, v186
    v_cvt_pk_f16_f32 v122, v122, v123
    v_mfma_f32_16x16x32_bf16 v[178:181], v[154:157], a[188:191], v[178:181]
    s_add_u32 m0, s69, 3072
    v_mul_f32 v124, v187, v124
    v_mul_f32 v125, v187, v125
    v_mfma_f32_16x16x32_bf16 v[162:165], v[142:145], a[192:195], 0
    s_add_u32 s69, s77, 589824
    v_cvt_pk_f16_f32 v123, v124, v125
    v_mul_f32 v126, v187, v126
    v_mfma_f32_16x16x32_bf16 v[162:165], v[218:221], a[196:199], v[162:165]
    s_waitcnt lgkmcnt(0)
    buffer_load_dwordx4 v174, s[52:55], 0 offen lds
    v_mul_f32 v127, v187, v127
    v_mfma_f32_16x16x32_bf16 v[162:165], v[210:213], a[200:203], v[162:165]
    v_cvt_pk_f16_f32 v124, v126, v127
    s_waitcnt vmcnt(7)
    v_mfma_f32_16x16x32_bf16 v[162:165], v[198:201], a[204:207], v[162:165]
    ds_read_b64 a[222:223], v141 offset:0
    ds_read_b64 a[234:235], v141 offset:1536
    v_mfma_f32_16x16x32_bf16 v[162:165], v[182:185], a[208:211], v[162:165]
    ds_read_b64 a[246:247], v141 offset:8
    ds_read_b64 v[84:85], v141 offset:1544
    v_mfma_f32_16x16x32_bf16 v[162:165], v[154:157], a[212:215], v[162:165]
    s_barrier
    s_barrier
    ds_read_b64 v[96:97], v175 offset:0
    buffer_load_dwordx4 v139, s[52:55], 0 offen offset:1024 lds
    ds_read_b64 v[108:109], v175 offset:1536
    ds_read_b128 v[198:201], v0 offset:26624
    ds_read_b128 v[154:157], v1 offset:26624
    ds_read_b128 v[182:185], v0 offset:26752
    ds_read_b128 v[218:221], v1 offset:26752
    ds_read_b128 v[142:145], v0 offset:26880
    ds_read_b128 v[202:205], v1 offset:26880
    buffer_load_dwordx4 v130, s[52:55], 0 offen offset:2048 lds
    s_waitcnt lgkmcnt(10)
    v_mfma_f32_16x16x32_bf16 v[210:213], v[134:137], a[220:223], 0
    s_add_u32 m0, s28, 65536
    v_mul_f32 v128, v187, v128
    v_mul_f32 v129, v187, v129
    v_mfma_f32_16x16x32_bf16 v[222:225], v[134:137], a[232:235], 0
    s_waitcnt lgkmcnt(8)
    v_cvt_pk_f16_f32 v125, v128, v129
    v_mul_f32 v146, v187, v146
    v_mfma_f32_16x16x32_bf16 v[210:213], v[134:137], a[244:247], v[210:213]
    s_waitcnt lgkmcnt(6)
    v_mul_f32 v147, v187, v147
    v_cvt_pk_f16_f32 v128, v146, v147
    v_mfma_f32_16x16x32_bf16 v[210:213], v[134:137], v[94:97], v[210:213]
    s_waitcnt lgkmcnt(3)
    v_mul_f32 v148, v187, v148
    v_mul_f32 v149, v187, v149
    v_mfma_f32_16x16x32_bf16 v[222:225], v[134:137], v[82:85], v[222:225]
    s_waitcnt vmcnt(6)
    buffer_load_dwordx4 v10, s[8:11], s24 offen nt lds
    v_mfma_f32_16x16x32_bf16 v[222:225], v[134:137], v[106:109], v[222:225]
    s_add_u32 m0, s28, 69632
    ds_read_b64 a[224:225], v141 offset:3072
    ds_read_b64 a[226:227], v141 offset:4608
    v_mfma_f32_16x16x32_bf16 v[242:245], a[72:75], v[198:201], 0
    s_waitcnt lgkmcnt(2)
    ds_read_b64 a[248:249], v141 offset:3080
    ds_read_b64 a[250:251], v141 offset:4616
    v_mfma_f32_16x16x32_bf16 v[242:245], a[76:79], v[154:157], v[242:245]
    ds_read_b64 v[98:99], v175 offset:3072
    ds_read_b64 v[100:101], v175 offset:4608
    v_mfma_f32_16x16x32_bf16 v[242:245], a[80:83], v[182:185], v[242:245]
    v_mov_b32_dpp v159, v222 quad_perm:[0,1,2,3] row_mask:0x4 bank_mask:0xf
    v_mov_b32 v171, v211
    v_mfma_f32_16x16x32_bf16 v[242:245], a[84:87], v[218:221], v[242:245]
    buffer_load_dwordx4 v11, s[8:11], s24 offen nt lds
    v_mfma_f32_16x16x32_bf16 v[242:245], a[88:91], v[142:145], v[242:245]
    s_add_u32 m0, s28, 73728
    v_mov_b32_dpp v159, v210 quad_perm:[0,1,2,3] row_mask:0x8 bank_mask:0xf
    v_mov_b32_dpp v171, v223 quad_perm:[0,1,2,3] row_mask:0x2 bank_mask:0xf
    v_mfma_f32_16x16x32_bf16 v[242:245], a[92:95], v[202:205], v[242:245]
    ds_write_b32 v140, v159 offset:18432
    v_mfma_f32_16x16x32_bf16 v[174:177], a[116:119], v[202:205], 0
    v_cvt_pk_f16_f32 v129, v148, v149
    v_mul_f32 v114, v186, v114
    v_mfma_f32_16x16x32_bf16 v[174:177], a[112:115], v[142:145], v[174:177]
    s_waitcnt lgkmcnt(5)
    v_mul_f32 v115, v186, v115
    v_cvt_pk_f16_f32 v114, v114, v115
    v_mfma_f32_16x16x32_bf16 v[146:149], v[134:137], a[224:227], 0
    s_waitcnt lgkmcnt(3)
    buffer_load_dwordx4 v12, s[8:11], s24 offen nt lds
    v_mfma_f32_16x16x32_bf16 v[146:149], v[134:137], a[248:251], v[146:149]
    s_waitcnt lgkmcnt(1)
    v_mul_f32 v116, v186, v116
    v_mul_f32 v117, v186, v117
    v_mfma_f32_16x16x32_bf16 v[146:149], v[134:137], v[98:101], v[146:149]
    s_add_u32 m0, s28, 77824
    v_cvt_pk_f16_f32 v115, v116, v117
    v_mul_f32 v118, v186, v118
    s_waitcnt vmcnt(6)
    v_mfma_f32_16x16x32_bf16 v[174:177], a[108:111], v[218:221], v[174:177]
    ds_read_b64 a[236:237], v133 offset:0
    ds_read_b64 a[228:229], v133 offset:1536
    v_mfma_f32_16x16x32_bf16 v[174:177], a[104:107], v[182:185], v[174:177]
    ds_read_b64 v[86:87], v133 offset:8
    ds_read_b64 a[252:253], v133 offset:1544
    v_mfma_f32_16x16x32_bf16 v[174:177], a[100:103], v[154:157], v[174:177]
    buffer_load_dwordx4 v13, s[8:11], s24 offen nt lds
    v_mfma_f32_16x16x32_bf16 v[174:177], a[96:99], v[198:201], v[174:177]
    s_add_u32 m0, s74, 0
    ds_read_b64 v[110:111], v132 offset:0
    ds_read_b64 v[102:103], v132 offset:1536
    v_mfma_f32_16x16x32_bf16 v[210:213], a[120:123], v[198:201], 0
    v_mov_b32_dpp v171, v146 quad_perm:[0,1,2,3] row_mask:0x4 bank_mask:0xf
    v_mul_f32 v119, v186, v119
    v_mfma_f32_16x16x32_bf16 v[210:213], a[124:127], v[154:157], v[210:213]
    v_mov_b32_dpp v171, v147 quad_perm:[0,1,2,3] row_mask:0x8 bank_mask:0xf
    v_cvt_pk_f16_f32 v116, v118, v119
    v_mfma_f32_16x16x32_bf16 v[210:213], a[128:131], v[182:185], v[210:213]
    ds_write_b32 v140, v171 offset:19456
    v_mfma_f32_16x16x32_bf16 v[210:213], a[132:135], v[218:221], v[210:213]
    buffer_load_dwordx4 v14, s[8:11], s24 offen nt lds
    v_mfma_f32_16x16x32_bf16 v[210:213], a[136:139], v[142:145], v[210:213]
    s_add_u32 s8, s60, s23
    v_mul_f32 v120, v186, v120
    v_mul_f32 v121, v186, v121
    v_mfma_f32_16x16x32_bf16 v[210:213], a[140:143], v[202:205], v[210:213]
    s_addc_u32 s9, s61, 0
    v_cvt_pk_f16_f32 v117, v120, v121
    v_mul_f32 v150, v186, v150
    v_mfma_f32_16x16x32_bf16 v[118:121], a[20:23], v[202:205], 0
    s_sub_u32 s10, s36, s23
    v_mul_f32 v151, v186, v151
    v_cvt_pk_f16_f32 v126, v150, v151
    v_mfma_f32_16x16x32_bf16 v[118:121], a[16:19], v[142:145], v[118:121]
    s_cmp_lt_u32 s34, s17
    v_mul_f32 v152, v186, v152
    v_mul_f32 v153, v186, v153
    v_mfma_f32_16x16x32_bf16 v[118:121], a[12:15], v[218:221], v[118:121]
    s_cselect_b32 s10, s10, 0
    v_cvt_pk_f16_f32 v127, v152, v153
    v_cvt_pk_bf16_f32 v159, v160, v161
    v_mfma_f32_16x16x32_bf16 v[118:121], a[8:11], v[182:185], v[118:121]
    s_add_u32 m0, s28, 0
    s_waitcnt vmcnt(5)
    ds_read_b64 a[230:231], v133 offset:3072
    v_mfma_f32_16x16x32_bf16 v[118:121], a[4:7], v[154:157], v[118:121]
    s_mov_b32 s24, s23
    ds_read_b64 a[238:239], v133 offset:4608
    ds_read_b64 a[254:255], v133 offset:3080
    v_mfma_f32_16x16x32_bf16 v[118:121], a[0:3], v[198:201], v[118:121]
    s_add_u32 s23, s23, s21
    ds_read_b64 v[88:89], v133 offset:4616
    ds_read_b64 v[104:105], v132 offset:3072
    v_mfma_f32_16x16x32_bf16 v[150:153], a[24:27], v[198:201], 0
    s_cmp_ge_u32 s19, 72
    ds_read_b64 v[112:113], v132 offset:4608
    v_cvt_pk_bf16_f32 v130, v214, v215
    v_mfma_f32_16x16x32_bf16 v[150:153], a[28:31], v[154:157], v[150:153]
    s_cselect_b32 s34, 72, 0
    v_cvt_pk_bf16_f32 v131, v216, v217
    v_cvt_pk_bf16_f32 v234, v234, 0
    v_mfma_f32_16x16x32_bf16 v[150:153], a[32:35], v[182:185], v[150:153]
    s_cselect_b32 s35, s22, 0
    v_cvt_pk_bf16_f32 v235, v235, 0
    v_cvt_pk_bf16_f32 v236, v236, 0
    v_mfma_f32_16x16x32_bf16 v[150:153], a[36:39], v[218:221], v[150:153]
    s_sub_u32 s19, s19, s34
    ds_write2_b32 v167, v234, v235 offset0:0 offset1:68
    v_mfma_f32_16x16x32_bf16 v[150:153], a[40:43], v[142:145], v[150:153]
    s_add_u32 s23, s23, s35
    v_cvt_pk_bf16_f32 v237, v237, 0
    v_cvt_pk_bf16_f32 v206, v206, 0
    v_mfma_f32_16x16x32_bf16 v[150:153], a[44:47], v[202:205], v[150:153]
    s_waitcnt lgkmcnt(5)
    ds_write2_b32 v167, v236, v237 offset0:136 offset1:204
    v_mfma_f32_16x16x32_bf16 v[146:149], v[134:137], a[228:231], 0
    s_waitcnt lgkmcnt(3)
    v_cvt_pk_bf16_f32 v207, v207, 0
    v_cvt_pk_bf16_f32 v208, v208, 0
    v_mfma_f32_16x16x32_bf16 v[146:149], v[134:137], a[252:255], v[146:149]
    s_waitcnt lgkmcnt(2)
    ds_write2_b32 v167, v206, v207 offset0:16 offset1:84
    v_mfma_f32_16x16x32_bf16 v[146:149], v[134:137], v[102:105], v[146:149]
    v_cvt_pk_bf16_f32 v209, v209, 0
    v_cvt_pk_bf16_f32 v226, v226, 0
    v_mfma_f32_16x16x32_bf16 v[234:237], v[134:137], a[236:239], 0
    ds_write2_b32 v167, v208, v209 offset0:152 offset1:220
    v_mfma_f32_16x16x32_bf16 v[234:237], v[134:137], v[86:89], v[234:237]
    v_cvt_pk_bf16_f32 v227, v227, 0
    v_cvt_pk_bf16_f32 v228, v228, 0
    v_mfma_f32_16x16x32_bf16 v[234:237], v[134:137], v[110:113], v[234:237]
    ds_write2_b32 v167, v226, v227 offset0:32 offset1:100
    v_mfma_f32_16x16x32_bf16 v[134:137], a[68:71], v[202:205], 0
    v_cvt_pk_bf16_f32 v229, v229, 0
    v_cvt_pk_bf16_f32 v190, v190, 0
    v_mfma_f32_16x16x32_bf16 v[134:137], a[64:67], v[142:145], v[134:137]
    ds_write2_b32 v167, v228, v229 offset0:168 offset1:236
    v_mfma_f32_16x16x32_bf16 v[134:137], a[60:63], v[218:221], v[134:137]
    v_cvt_pk_bf16_f32 v191, v191, 0
    v_mov_b32 v171, v234
    v_mfma_f32_16x16x32_bf16 v[134:137], a[56:59], v[182:185], v[134:137]
    ds_write2_b32 v170, v190, v191 offset0:0 offset1:68
    v_mfma_f32_16x16x32_bf16 v[134:137], a[52:55], v[154:157], v[134:137]
    v_mov_b32_dpp v171, v146 quad_perm:[0,1,2,3] row_mask:0x2 bank_mask:0xf
    v_cvt_pk_bf16_f32 v192, v192, 0
    v_mfma_f32_16x16x32_bf16 v[134:137], a[48:51], v[198:201], v[134:137]
    v_mov_b32_dpp v171, v147 quad_perm:[0,1,2,3] row_mask:0x4 bank_mask:0xf
    v_cvt_pk_bf16_f32 v193, v193, 0
    v_mfma_f32_16x16x32_bf16 v[166:169], v[198:201], a[144:147], 0
    ds_write2_b32 v170, v192, v193 offset0:136 offset1:204
    v_mfma_f32_16x16x32_bf16 v[166:169], v[154:157], a[148:151], v[166:169]
    v_mov_b32_dpp v171, v235 quad_perm:[0,1,2,3] row_mask:0x8 bank_mask:0xf
    v_cvt_pk_bf16_f32 v178, v178, 0
    v_mfma_f32_16x16x32_bf16 v[166:169], v[182:185], a[152:155], v[166:169]
    ds_write_b32 v140, v171 offset:63552
    v_mfma_f32_16x16x32_bf16 v[166:169], v[218:221], a[156:159], v[166:169]
    v_cvt_pk_bf16_f32 v179, v179, 0
    v_cvt_pk_bf16_f32 v180, v180, 0
    v_mfma_f32_16x16x32_bf16 v[166:169], v[142:145], a[160:163], v[166:169]
    ds_write2_b32 v170, v178, v179 offset0:16 offset1:84
    v_mfma_f32_16x16x32_bf16 v[166:169], v[202:205], a[164:167], v[166:169]
    v_cvt_pk_bf16_f32 v181, v181, 0
    v_cvt_pk_bf16_f32 v162, v162, 0
    v_mfma_f32_16x16x32_bf16 v[146:149], v[202:205], a[188:191], 0
    ds_write2_b32 v170, v180, v181 offset0:152 offset1:220
    v_mfma_f32_16x16x32_bf16 v[146:149], v[142:145], a[184:187], v[146:149]
    v_cvt_pk_bf16_f32 v163, v163, 0
    v_cvt_pk_bf16_f32 v164, v164, 0
    v_mfma_f32_16x16x32_bf16 v[146:149], v[218:221], a[180:183], v[146:149]
    ds_write2_b32 v170, v162, v163 offset0:32 offset1:100
    v_mfma_f32_16x16x32_bf16 v[146:149], v[182:185], a[176:179], v[146:149]
    s_waitcnt lgkmcnt(3)
    v_cvt_pk_bf16_f32 v165, v165, 0
    v_cvt_pk_bf16_f32 v196, v166, v167
    v_mfma_f32_16x16x32_bf16 v[146:149], v[154:157], a[172:175], v[146:149]
    s_barrier
    ds_read_b128 v[234:237], v0 offset:32768
    ds_read_b128 v[190:193], v1 offset:32768
    v_mfma_f32_16x16x32_bf16 v[146:149], v[198:201], a[168:171], v[146:149]
    ds_read_b128 v[186:189], v0 offset:32896
    ds_read_b128 v[206:209], v254 offset:18432
    v_mfma_f32_16x16x32_bf16 v[226:229], v[198:201], a[192:195], 0
    v_cvt_pk_bf16_f32 v197, v168, v169
    v_fma_f32 v171, v118, v118, s32
    v_mfma_f32_16x16x32_bf16 v[226:229], v[154:157], a[196:199], v[226:229]
    ds_read_b128 v[214:217], v1 offset:32896
    ds_read_b128 v[198:201], v0 offset:33024
    v_mfma_f32_16x16x32_bf16 v[226:229], v[182:185], a[200:203], v[226:229]
    v_fmac_f32 v171, v119, v119
    v_fmac_f32 v171, v120, v120
    v_mfma_f32_16x16x32_bf16 v[226:229], v[218:221], a[204:207], v[226:229]
    ds_read_b128 v[218:221], v1 offset:33024
    ds_read_b128 v[166:169], v254 offset:19456
    v_mfma_f32_16x16x32_bf16 v[226:229], v[142:145], a[208:211], v[226:229]
    v_fmac_f32 v171, v121, v121
    v_fmac_f32 v171, v150, v150
    v_mfma_f32_16x16x32_bf16 v[226:229], v[202:205], a[212:215], v[226:229]
    ds_read_b128 v[154:157], v254 offset:63552
    v_fmac_f32 v171, v151, v151
    v_mfma_f32_16x16x32_f16 v[182:185], v[122:125], v[114:117], v[46:49]
    s_waitcnt lgkmcnt(7)
    ds_write2_b32 v170, v164, v165 offset0:168 offset1:236
    v_mfma_f32_16x16x32_bf16 v[142:145], a[72:75], v[234:237], 0
    s_waitcnt lgkmcnt(6)
    v_add_f32 v206, v206, v207
    v_add_f32 v208, v208, v209
    v_mfma_f32_16x16x32_bf16 v[142:145], a[76:79], v[190:193], v[142:145]
    s_waitcnt lgkmcnt(5)
    v_add_f32 v206, v206, v208
    v_mul_f32 v206, 0xbbaaaaab, v206
    v_mfma_f32_16x16x32_bf16 v[142:145], a[80:83], v[186:189], v[142:145]
    s_waitcnt lgkmcnt(4)
    ds_write_b32 v138, v206 offset:0
    v_mfma_f32_16x16x32_bf16 v[142:145], a[84:87], v[214:217], v[142:145]
    s_waitcnt lgkmcnt(4)
    v_fmac_f32 v171, v152, v152
    v_fmac_f32 v171, v153, v153
    v_mfma_f32_16x16x32_bf16 v[142:145], a[88:91], v[198:201], v[142:145]
    s_waitcnt lgkmcnt(3)
    ds_read_b128 v[162:165], v255 offset:0
    ds_read_b128 v[178:181], v255 offset:64
    v_mfma_f32_16x16x32_bf16 v[142:145], a[92:95], v[218:221], v[142:145]
    s_waitcnt lgkmcnt(4)
    v_add_f32 v166, v166, v167
    v_add_f32 v168, v168, v169
    v_mfma_f32_16x16x32_bf16 v[206:209], a[116:119], v[218:221], 0
    v_add_f32 v166, v166, v168
    v_mul_f32 v166, 0xbbaaaaab, v166
    v_mfma_f32_16x16x32_bf16 v[206:209], a[112:115], v[198:201], v[206:209]
    ds_write_b32 v138, v166 offset:256
    v_mfma_f32_16x16x32_bf16 v[206:209], a[108:111], v[214:217], v[206:209]
    v_add_f32 v154, v154, v155
    v_add_f32 v156, v156, v157
    v_mfma_f32_16x16x32_bf16 v[206:209], a[104:107], v[186:189], v[206:209]
    v_add_f32 v154, v154, v156
    v_mul_f32 v154, 0xbbaaaaab, v154
    v_mfma_f32_16x16x32_bf16 v[206:209], a[100:103], v[190:193], v[206:209]
    ds_write_b32 v138, v154 offset:512
    v_mfma_f32_16x16x32_bf16 v[206:209], a[96:99], v[234:237], v[206:209]
    v_fmac_f32 v171, v134, v134
    v_fmac_f32 v171, v135, v135
    v_mfma_f32_16x16x32_bf16 v[138:141], a[120:123], v[234:237], 0
    s_waitcnt lgkmcnt(2)
    v_fmac_f32 v171, v136, v136
    v_fmac_f32 v171, v137, v137
    v_mfma_f32_16x16x32_bf16 v[138:141], a[124:127], v[190:193], v[138:141]
    v_fma_f32 v170, v242, v242, s32
    v_fmac_f32 v170, v243, v243
    v_mfma_f32_16x16x32_bf16 v[138:141], a[128:131], v[186:189], v[138:141]
    v_fmac_f32 v170, v244, v244
    v_fmac_f32 v170, v245, v245
    v_mfma_f32_16x16x32_bf16 v[138:141], a[132:135], v[214:217], v[138:141]
    v_fmac_f32 v170, v174, v174
    v_fmac_f32 v170, v175, v175
    v_mfma_f32_16x16x32_bf16 v[138:141], a[136:139], v[198:201], v[138:141]
    v_fmac_f32 v170, v176, v176
    v_fmac_f32 v170, v177, v177
    v_mfma_f32_16x16x32_bf16 v[138:141], a[140:143], v[218:221], v[138:141]
    v_fmac_f32 v170, v210, v210
    v_fmac_f32 v170, v211, v211
    v_mfma_f32_16x16x32_bf16 v[154:157], a[20:23], v[218:221], 0
    v_fmac_f32 v170, v212, v212
    v_fmac_f32 v170, v213, v213
    v_mfma_f32_16x16x32_bf16 v[154:157], a[16:19], v[198:201], v[154:157]
    v_cvt_pk_bf16_f32 v36, v171, v170
    v_cvt_pk_bf16_f32 v160, v146, v147
    v_mfma_f32_16x16x32_bf16 v[154:157], a[12:15], v[214:217], v[154:157]
    v_cvt_pk_bf16_f32 v161, v148, v149
    v_cvt_pk_bf16_f32 v132, v226, v227
    v_mfma_f32_16x16x32_bf16 v[166:169], v[32:35], v[36:39], 0
    v_cvt_pk_bf16_f32 v133, v228, v229
    v_fma_f32 v170, v142, v142, s32
    v_mfma_f32_16x16x32_bf16 v[154:157], a[8:11], v[186:189], v[154:157]
    v_fmac_f32 v170, v143, v143
    v_fmac_f32 v170, v144, v144
    v_mfma_f32_16x16x32_bf16 v[154:157], a[4:7], v[190:193], v[154:157]
    v_fmac_f32 v170, v145, v145
    v_fmac_f32 v170, v206, v206
    v_mfma_f32_16x16x32_bf16 v[154:157], a[0:3], v[234:237], v[154:157]
    v_rsq_f32 v167, v167
    v_mfma_f32_16x16x32_bf16 v[226:229], a[24:27], v[234:237], 0
    ds_read_b128 v[146:149], v5 offset:0
    ds_read_b32 v254, v6 offset:192
    v_mfma_f32_16x16x32_bf16 v[226:229], a[28:31], v[190:193], v[226:229]
    v_rsq_f32 v166, v166
    v_mfma_f32_16x16x32_bf16 v[226:229], a[32:35], v[186:189], v[226:229]
    v_mul_f32 v166, s31, v166
    v_mul_f32 v242, v167, v242
    v_mfma_f32_16x16x32_bf16 v[226:229], a[36:39], v[214:217], v[226:229]
    v_mul_f32 v243, v167, v243
    v_cvt_pk_f16_f32 v242, v242, v243
    v_mfma_f32_16x16x32_bf16 v[226:229], a[40:43], v[198:201], v[226:229]
    ds_read2_b32 v[168:169], v6 offset0:0 offset1:0
    v_mul_f32 v244, v167, v244
    v_mfma_f32_16x16x32_bf16 v[226:229], a[44:47], v[218:221], v[226:229]
    v_mul_f32 v245, v167, v245
    v_cvt_pk_f16_f32 v243, v244, v245
    v_mul_f32 v174, v167, v174
    v_mfma_f32_16x16x16_f16 v[182:185], v[128:129], v[126:127], v[182:185]
    v_mul_f32 v175, v167, v175
    v_cvt_pk_f16_f32 v244, v174, v175
    ds_read2_b32 v[204:205], v6 offset0:16 offset1:16
    v_mul_f32 v176, v167, v176
    v_mul_f32 v177, v167, v177
    v_cvt_pk_f16_f32 v245, v176, v177
    v_mul_f32 v210, v167, v210
    v_mul_f32 v211, v167, v211
    v_cvt_pk_f16_f32 v176, v210, v211
    ds_read2_b32 v[224:225], v6 offset0:32 offset1:32
    v_mul_f32 v212, v167, v212
    v_mul_f32 v213, v167, v213
    v_cvt_pk_f16_f32 v177, v212, v213
    v_mul_f32 v118, v166, v118
    v_mul_f32 v119, v166, v119
    v_cvt_pk_f16_f32 v118, v118, v119
    v_mul_f32 v120, v166, v120
    v_mul_f32 v121, v166, v121
    v_cvt_pk_f16_f32 v119, v120, v121
    v_mfma_f32_16x16x32_bf16 v[210:213], a[68:71], v[218:221], 0
    s_waitcnt lgkmcnt(2)
    v_mul_f32 v150, v166, v150
    v_mul_f32 v151, v166, v151
    v_mfma_f32_16x16x32_bf16 v[210:213], a[64:67], v[198:201], v[210:213]
    v_cvt_pk_f16_f32 v120, v150, v151
    v_mul_f32 v152, v166, v152
    v_mfma_f32_16x16x32_bf16 v[210:213], a[60:63], v[214:217], v[210:213]
    s_waitcnt lgkmcnt(1)
    v_mul_f32 v153, v166, v153
    v_cvt_pk_f16_f32 v121, v152, v153
    v_mfma_f32_16x16x32_bf16 v[210:213], a[56:59], v[186:189], v[210:213]
    v_mul_f32 v134, v166, v134
    v_mul_f32 v135, v166, v135
    v_mfma_f32_16x16x32_bf16 v[210:213], a[52:55], v[190:193], v[210:213]
    v_cvt_pk_f16_f32 v174, v134, v135
    v_mul_f32 v136, v166, v136
    v_mfma_f32_16x16x32_bf16 v[210:213], a[48:51], v[234:237], v[210:213]
    v_mul_f32 v137, v166, v137
    v_cvt_pk_f16_f32 v175, v136, v137
    v_mfma_f32_16x16x32_bf16 v[134:137], v[234:237], a[144:147], 0
    s_waitcnt lgkmcnt(0)
    v_fma_f32 v171, v154, v154, s32
    v_fmac_f32 v171, v155, v155
    v_mfma_f32_16x16x32_bf16 v[134:137], v[190:193], a[148:151], v[134:137]
    v_fmac_f32 v171, v156, v156
    v_fmac_f32 v171, v157, v157
    v_mfma_f32_16x16x32_bf16 v[134:137], v[186:189], a[152:155], v[134:137]
    v_fmac_f32 v171, v226, v226
    v_fmac_f32 v171, v227, v227
    v_mfma_f32_16x16x32_bf16 v[134:137], v[214:217], a[156:159], v[134:137]
    v_fmac_f32 v171, v228, v228
    v_fmac_f32 v171, v229, v229
    v_mfma_f32_16x16x32_bf16 v[134:137], v[198:201], a[160:163], v[134:137]
    v_fmac_f32 v171, v210, v210
    v_fmac_f32 v171, v211, v211
    v_mfma_f32_16x16x32_bf16 v[134:137], v[218:221], a[164:167], v[134:137]
    v_fmac_f32 v171, v212, v212
    v_fmac_f32 v171, v213, v213
    v_fmac_f32 v170, v207, v207
    v_fmac_f32 v170, v208, v208
    v_fmac_f32 v170, v209, v209
    v_fmac_f32 v170, v138, v138
    v_fmac_f32 v170, v139, v139
    v_fmac_f32 v170, v140, v140
    v_cvt_pk_bf16_f32 v166, v134, v135
    v_cvt_pk_bf16_f32 v167, v136, v137
    v_fmac_f32 v170, v141, v141
    v_cvt_pk_bf16_f32 v36, v171, v170
    v_mfma_f32_16x16x32_f16 v[150:153], v[146:149], v[114:117], v[22:25]
    v_add_u32 v6, 272, v6
    v_xor_b32 v2, 65536, v2
    v_xor_b32 v0, 65536, v0
    v_xor_b32 v1, 65536, v1
    v_mfma_f32_16x16x32_bf16 v[134:137], v[32:35], v[36:39], 0
    s_nop 0
    s_nop 0
    s_nop 0
    s_nop 0
    s_nop 0
    s_nop 0
    s_nop 0
    s_nop 0
    v_rsq_f32 v135, v135
    v_rsq_f32 v134, v134
    v_mul_f32 v142, v135, v142
    v_mul_f32 v134, s31, v134
    v_mul_f32 v143, v135, v143
    v_cvt_pk_f16_f32 v142, v142, v143
    v_mul_f32 v144, v135, v144
    v_mul_f32 v145, v135, v145
    v_cvt_pk_f16_f32 v143, v144, v145
    v_mul_f32 v206, v135, v206
    v_mul_f32 v207, v135, v207
    v_cvt_pk_f16_f32 v144, v206, v207
    v_mul_f32 v208, v135, v208
    v_mul_f32 v209, v135, v209
    v_cvt_pk_f16_f32 v145, v208, v209
    v_mul_f32 v138, v135, v138
    v_mul_f32 v139, v135, v139
    v_cvt_pk_f16_f32 v208, v138, v139
    v_mul_f32 v140, v135, v140
    v_mul_f32 v141, v135, v141
    v_mfma_f32_16x16x32_bf16 v[230:233], v[218:221], a[188:191], 0
    v_cvt_pk_f16_f32 v209, v140, v141
    v_mul_f32 v154, v134, v154
    v_mfma_f32_16x16x32_bf16 v[230:233], v[198:201], a[184:187], v[230:233]
    v_mul_f32 v155, v134, v155
    v_cvt_pk_f16_f32 v138, v154, v155
    v_mfma_f32_16x16x32_bf16 v[230:233], v[214:217], a[180:183], v[230:233]
    v_mul_f32 v156, v134, v156
    v_mul_f32 v157, v134, v157
    v_mfma_f32_16x16x32_bf16 v[230:233], v[186:189], a[176:179], v[230:233]
    v_cvt_pk_f16_f32 v139, v156, v157
    v_mul_f32 v226, v134, v226
    v_mfma_f32_16x16x32_bf16 v[230:233], v[190:193], a[172:175], v[230:233]
    v_mul_f32 v227, v134, v227
    v_cvt_pk_f16_f32 v140, v226, v227
    v_mfma_f32_16x16x32_bf16 v[230:233], v[234:237], a[168:171], v[230:233]
    ds_read_b128 v[154:157], v5 offset:16
    v_mul_f32 v228, v134, v228
    v_mul_f32 v229, v134, v229
    v_cvt_pk_f16_f32 v141, v228, v229
    v_mul_f32 v210, v134, v210
    v_mul_f32 v211, v134, v211
    v_cvt_pk_f16_f32 v206, v210, v211
    v_mul_f32 v212, v134, v212
    v_cvt_pk_bf16_f32 v202, v230, v231
    v_cvt_pk_bf16_f32 v203, v232, v233
    v_mfma_f32_16x16x32_bf16 v[226:229], v[234:237], a[192:195], 0
    ds_read_b128 v[234:237], v5 offset:48
    v_mul_f32 v213, v134, v213
    v_mfma_f32_16x16x32_bf16 v[226:229], v[190:193], a[196:199], v[226:229]
    v_cvt_pk_f16_f32 v207, v212, v213
    v_add_u32 v5, 336, v5
    v_mfma_f32_16x16x32_bf16 v[226:229], v[186:189], a[200:203], v[226:229]
    v_mfma_f32_16x16x32_bf16 v[226:229], v[214:217], a[204:207], v[226:229]
    v_mfma_f32_16x16x32_bf16 v[226:229], v[198:201], a[208:211], v[226:229]
    v_mfma_f32_16x16x32_f16 v[134:137], v[242:245], v[114:117], v[50:53]
    s_waitcnt lgkmcnt(1)
    v_mfma_f32_16x16x32_f16 v[150:153], v[154:157], v[122:125], v[150:153]
    v_mfma_f32_16x16x32_f16 v[190:193], v[142:145], v[114:117], v[54:57]
    v_mfma_f32_16x16x32_bf16 v[226:229], v[218:221], a[212:215], v[226:229]
    s_waitcnt vmcnt(0)
    v_mfma_f32_16x16x32_f16 v[114:117], v[146:149], v[118:121], v[24:27]
    s_barrier
    buffer_load_dwordx4 v10, s[8:11], 0 offen nt lds
    s_add_u32 m0, s28, 4096
    v_mfma_f32_16x16x16_f16 v[134:137], v[176:177], v[126:127], v[134:137]
    v_mfma_f32_16x16x16_f16 v[190:193], v[208:209], v[126:127], v[190:193]
    v_mfma_f32_16x16x32_f16 v[114:117], v[154:157], v[242:245], v[114:117]
    s_waitcnt lgkmcnt(0)
    v_cvt_pk_bf16_f32 v222, v226, v227
    v_cvt_pk_bf16_f32 v223, v228, v229
    v_mfma_f32_16x16x32_f16 v[150:153], v[234:237], v[126:129], v[150:153]
    buffer_load_dwordx4 v11, s[8:11], 0 offen nt lds
    s_add_u32 m0, s28, 8192
    v_mfma_f32_16x16x32_f16 v[114:117], v[234:237], v[174:177], v[114:117]
    v_mfma_f32_16x16x32_f16 v[218:221], v[146:149], v[138:141], v[26:29]
    v_mfma_f32_16x16x32_f16 v[218:221], v[154:157], v[142:145], v[218:221]
    v_mfma_f32_16x16x32_f16 v[218:221], v[234:237], v[206:209], v[218:221]
    v_mfma_f32_16x16x16_bf16 v[146:149], a[216:217], v[172:173], v[162:165]
    buffer_load_dwordx4 v12, s[8:11], 0 offen nt lds
    v_mov_b32_dpp v254, v151 quad_perm:[0,1,2,3] row_mask:0x1 bank_mask:0xf
    v_max3_f32 v126, v150, v182, v183
    v_mfma_f32_16x16x16_bf16 v[226:229], a[240:241], v[172:173], v[162:165]
    v_mov_b32_dpp v254, v115 quad_perm:[0,1,2,3] row_mask:0x2 bank_mask:0xf
    v_max3_f32 v126, v126, v184, v185
    v_max3_f32 v126, v126, v134, v135
    v_mfma_f32_16x16x16_bf16 v[154:157], v[90:91], v[172:173], v[162:165]
    v_max3_f32 v126, v126, v136, v137
    v_max3_f32 v126, v126, v190, v191
    v_max3_f32 v126, v126, v192, v193
    v_mfma_f32_16x16x16_bf16 v[234:237], a[218:219], v[172:173], v[178:181]
    v_mov_b32 v127, v126
    v_mov_b32_dpp v254, v219 quad_perm:[0,1,2,3] row_mask:0x4 bank_mask:0xf
    v_cvt_pk_bf16_f32 v146, v146, v147
    v_mfma_f32_16x16x16_bf16 v[162:165], a[242:243], v[172:173], v[178:181]
    v_permlane32_swap_b32 v126, v127
    v_max_f32 v126, v126, v127
    v_mfma_f32_16x16x16_bf16 v[186:189], v[92:93], v[172:173], v[178:181]
    s_add_u32 m0, s28, 12288
    s_xor_b32 s28, s28, 65536
    buffer_load_dwordx4 v13, s[8:11], 0 offen nt lds
    s_mov_b32 m0, s29
    s_xor_b32 s29, s29, s30
    v_mov_b32 v127, v126
    v_accvgpr_write_b32 a216, v146
    v_cvt_pk_bf16_f32 v148, v148, v149
    v_permlane16_swap_b32 v126, v127
    v_max_f32 v126, v126, v127
    v_sub_f32 v182, v182, v126
    v_exp_f32 v182, v182
    v_sub_f32 v183, v183, v126
    v_exp_f32 v183, v183
    v_sub_f32 v184, v184, v126
    buffer_load_dwordx4 v14, s[8:11], 0 offen nt lds
    v_cvt_pk_bf16_f32 v182, v182, v183
    v_exp_f32 v184, v184
    v_sub_f32 v185, v185, v126
    v_exp_f32 v185, v185
    v_sub_f32 v134, v134, v126
    v_cvt_pk_bf16_f32 v183, v184, v185
    v_exp_f32 v134, v134
    v_mfma_f32_16x16x32_f16 v[198:201], v[122:125], v[118:121], v[58:61]
    v_sub_f32 v135, v135, v126
    v_exp_f32 v135, v135
    v_sub_f32 v136, v136, v126
    v_cvt_pk_bf16_f32 v184, v134, v135
    v_exp_f32 v136, v136
    v_sub_f32 v137, v137, v126
    v_mfma_f32_16x16x16_f16 v[198:201], v[128:129], v[174:175], v[198:201]
    v_exp_f32 v137, v137
    v_sub_f32 v190, v190, v126
    v_cvt_pk_bf16_f32 v185, v136, v137
    v_mfma_f32_16x16x32_f16 v[210:213], v[242:245], v[118:121], v[62:65]
    v_exp_f32 v190, v190
    v_sub_f32 v191, v191, v126
    v_exp_f32 v191, v191
    v_sub_f32 v192, v192, v126
    v_cvt_pk_bf16_f32 v36, v190, v191
    v_exp_f32 v192, v192
    v_mfma_f32_16x16x32_f16 v[134:137], v[142:145], v[118:121], v[66:69]
    v_sub_f32 v193, v193, v126
    v_exp_f32 v193, v193
    v_mfma_f32_16x16x16_f16 v[210:213], v[176:177], v[174:175], v[210:213]
    v_cvt_pk_bf16_f32 v37, v192, v193
    v_sub_f32 v150, v150, v126
    v_exp_f32 v150, v150
    v_mfma_f32_16x16x16_f16 v[134:137], v[208:209], v[174:175], v[134:137]
    v_cvt_pk_bf16_f32 v39, v150, 0
    v_accvgpr_write_b32 a217, v148
    v_cvt_pk_bf16_f32 v226, v226, v227
    v_accvgpr_write_b32 a240, v226
    v_mfma_f32_16x16x32_bf16 v[118:121], v[28:31], v[36:39], 0
    v_cvt_pk_bf16_f32 v228, v228, v229
    v_accvgpr_write_b32 a241, v228
    v_mfma_f32_16x16x32_bf16 v[118:121], v[28:31], v[182:185], v[118:121]
    v_cvt_pk_bf16_f32 v90, v154, v155
    v_cvt_pk_bf16_f32 v91, v156, v157
    v_mfma_f32_16x16x32_bf16 v[150:153], v[194:197], v[182:185], 0
    ds_read_b128 v[190:193], v255 offset:128
    v_cvt_pk_bf16_f32 v234, v234, v235
    v_mfma_f32_16x16x32_bf16 v[150:153], v[166:169], v[36:39], v[150:153]
    v_accvgpr_write_b32 a218, v234
    v_cvt_pk_bf16_f32 v236, v236, v237
    v_mfma_f32_16x16x32_bf16 v[154:157], v[202:205], v[36:39], 0
    v_rcp_f32 v119, v118
    v_mfma_f32_16x16x32_bf16 v[154:157], v[158:161], v[182:185], v[154:157]
    v_accvgpr_write_b32 a219, v236
    v_cvt_pk_bf16_f32 v162, v162, v163
    v_mfma_f32_16x16x32_bf16 v[234:237], v[130:133], v[182:185], 0
    v_mul_f32 v150, v119, v150
    v_mul_f32 v151, v119, v151
    v_mfma_f32_16x16x32_bf16 v[234:237], v[222:225], v[36:39], v[234:237]
    v_cvt_pk_bf16_f32 v150, v150, v151
    v_mul_f32 v152, v119, v152
    v_mul_f32 v153, v119, v153
    v_cvt_pk_bf16_f32 v151, v152, v153
    v_mul_f32 v154, v119, v154
    v_mul_f32 v155, v119, v155
    v_cvt_pk_bf16_f32 v152, v154, v155
    v_mul_f32 v156, v119, v156
    s_waitcnt lgkmcnt(0)
    v_mfma_f32_16x16x16_bf16 v[146:149], a[232:233], v[172:173], v[190:193]
    v_mul_f32 v157, v119, v157
    v_cvt_pk_bf16_f32 v153, v156, v157
    v_mul_f32 v234, v119, v234
    v_mfma_f32_16x16x16_bf16 v[182:185], v[82:83], v[172:173], v[190:193]
    v_mul_f32 v235, v119, v235
    v_cvt_pk_bf16_f32 v126, v234, v235
    v_mul_f32 v236, v119, v236
    v_mfma_f32_16x16x16_bf16 v[226:229], v[106:107], v[172:173], v[190:193]
    ds_write_b128 v3, v[150:153] offset:0
    v_mul_f32 v237, v119, v237
    v_cvt_pk_bf16_f32 v127, v236, v237
    v_accvgpr_write_b32 a242, v162
    v_cvt_pk_bf16_f32 v164, v164, v165
    v_accvgpr_write_b32 a243, v164
    v_cvt_pk_bf16_f32 v92, v186, v187
    v_cvt_pk_bf16_f32 v93, v188, v189
    ds_read_b128 v[154:157], v255 offset:192
    ds_write_b64 v4, v[126:127] offset:4096
    v_cvt_pk_bf16_f32 v146, v146, v147
    v_accvgpr_write_b32 a232, v146
    v_cvt_pk_bf16_f32 v148, v148, v149
    v_accvgpr_write_b32 a233, v148
    v_cvt_pk_bf16_f32 v82, v182, v183
    v_cvt_pk_bf16_f32 v83, v184, v185
    v_cvt_pk_bf16_f32 v106, v226, v227
    v_cvt_pk_bf16_f32 v107, v228, v229
    ds_read_b128 v[162:165], v255 offset:256
    v_mov_b32 v171, v254
    v_max3_f32 v170, v114, v198, v199
    v_max3_f32 v170, v170, v200, v201
    v_max_f32_dpp v171, v171, v171 quad_perm:[1,0,3,2] row_mask:0xf bank_mask:0xf
    v_max3_f32 v170, v170, v210, v211
    v_max3_f32 v170, v170, v212, v213
    v_max_f32_dpp v171, v171, v171 quad_perm:[2,3,0,1] row_mask:0xf bank_mask:0xf
    v_max3_f32 v170, v170, v134, v135
    v_max3_f32 v170, v170, v136, v137
    v_max_f32_dpp v171, v171, v171 row_half_mirror row_mask:0xf bank_mask:0xf
    v_mov_b32 v126, v170
    s_nop 0
    v_max_f32_dpp v171, v171, v171 row_mirror row_mask:0xf bank_mask:0xf
    s_waitcnt lgkmcnt(2)
    v_mfma_f32_16x16x16_bf16 v[118:121], a[220:221], v[172:173], v[154:157]
    v_mov_b32 v127, v171
    v_permlane32_swap_b32 v170, v126
    v_mfma_f32_16x16x16_bf16 v[150:153], a[244:245], v[172:173], v[154:157]
    v_permlane32_swap_b32 v171, v127
    v_max_f32 v171, v171, v127
    v_mfma_f32_16x16x16_bf16 v[190:193], v[94:95], v[172:173], v[154:157]
    v_mov_b32 v127, v171
    v_max_f32 v170, v170, v126
    v_cvt_pk_bf16_f32 v118, v118, v119
    v_accvgpr_write_b32 a220, v118
    s_waitcnt lgkmcnt(0)
    v_mfma_f32_16x16x16_bf16 v[154:157], a[222:223], v[172:173], v[162:165]
    v_cvt_pk_bf16_f32 v120, v120, v121
    v_accvgpr_write_b32 a221, v120
    v_cvt_pk_bf16_f32 v150, v150, v151
    v_mfma_f32_16x16x16_bf16 v[118:121], a[246:247], v[172:173], v[162:165]
    v_accvgpr_write_b32 a244, v150
    v_cvt_pk_bf16_f32 v152, v152, v153
    v_accvgpr_write_b32 a245, v152
    v_mfma_f32_16x16x16_bf16 v[150:153], v[96:97], v[172:173], v[162:165]
    v_cvt_pk_bf16_f32 v94, v190, v191
    v_cvt_pk_bf16_f32 v95, v192, v193
    ds_read_b128 v[190:193], v255 offset:320
    v_cvt_pk_bf16_f32 v154, v154, v155
    v_accvgpr_write_b32 a222, v154
    v_cvt_pk_bf16_f32 v156, v156, v157
    v_accvgpr_write_b32 a223, v156
    v_cvt_pk_bf16_f32 v118, v118, v119
    v_accvgpr_write_b32 a246, v118
    v_cvt_pk_bf16_f32 v120, v120, v121
    v_accvgpr_write_b32 a247, v120
    v_cvt_pk_bf16_f32 v96, v150, v151
    v_cvt_pk_bf16_f32 v97, v152, v153
    ds_read_b128 v[154:157], v255 offset:384
    v_permlane16_swap_b32 v171, v127
    v_max_f32 v171, v171, v127
    v_sub_f32 v254, v254, v171
    v_exp_f32 v254, v254
    v_mov_b32 v126, v170
    v_cvt_pk_bf16_f32 v254, v254, v254
    ds_write_b16 v8, v254
    v_permlane16_swap_b32 v170, v126
    s_waitcnt lgkmcnt(2)
    v_mfma_f32_16x16x16_bf16 v[162:165], a[234:235], v[172:173], v[190:193]
    ds_read_b128 v[234:237], v9
    ds_read_b128 v[118:121], v9 offset:64
    v_max_f32 v170, v170, v126
    v_mfma_f32_16x16x16_bf16 v[150:153], v[84:85], v[172:173], v[190:193]
    v_sub_f32 v198, v198, v170
    v_exp_f32 v198, v198
    v_mfma_f32_16x16x16_bf16 v[146:149], v[108:109], v[172:173], v[190:193]
    v_sub_f32 v199, v199, v170
    v_cvt_pk_bf16_f32 v162, v162, v163
    v_accvgpr_write_b32 a234, v162
    s_waitcnt lgkmcnt(3)
    v_mfma_f32_16x16x16_bf16 v[190:193], a[224:225], v[172:173], v[154:157]
    v_cvt_pk_bf16_f32 v164, v164, v165
    v_accvgpr_write_b32 a235, v164
    v_cvt_pk_bf16_f32 v84, v150, v151
    v_mfma_f32_16x16x16_bf16 v[226:229], a[248:249], v[172:173], v[154:157]
    v_cvt_pk_bf16_f32 v85, v152, v153
    v_cvt_pk_bf16_f32 v108, v146, v147
    v_cvt_pk_bf16_f32 v109, v148, v149
    v_mfma_f32_16x16x16_bf16 v[150:153], v[98:99], v[172:173], v[154:157]
    ds_read_b128 v[162:165], v255 offset:448
    v_cvt_pk_bf16_f32 v190, v190, v191
    v_accvgpr_write_b32 a224, v190
    v_cvt_pk_bf16_f32 v192, v192, v193
    v_accvgpr_write_b32 a225, v192
    v_cvt_pk_bf16_f32 v226, v226, v227
    s_waitcnt lgkmcnt(2)
    v_mfma_f32_16x16x32_bf16 v[154:157], v[234:237], v[28:31], 0
    s_waitcnt lgkmcnt(1)
    v_accvgpr_write_b32 a248, v226
    v_cvt_pk_bf16_f32 v228, v228, v229
    v_mfma_f32_16x16x32_bf16 v[154:157], v[118:121], v[28:31], v[154:157]
    v_accvgpr_write_b32 a249, v228
    v_cvt_pk_bf16_f32 v98, v150, v151
    v_mfma_f32_16x16x32_bf16 v[190:193], v[118:121], v[166:169], 0
    v_cvt_pk_bf16_f32 v99, v152, v153
    v_sub_f32 v200, v200, v170
    v_mfma_f32_16x16x32_bf16 v[190:193], v[234:237], v[194:197], v[190:193]
    ds_read_b128 v[226:229], v255 offset:512
    v_sub_f32 v201, v201, v170
    v_mfma_f32_16x16x32_bf16 v[150:153], v[234:237], v[158:161], 0
    v_exp_f32 v199, v199
    v_mfma_f32_16x16x32_bf16 v[150:153], v[118:121], v[202:205], v[150:153]
    s_waitcnt lgkmcnt(1)
    v_cvt_pk_bf16_f32 v186, v198, v199
    v_sub_f32 v210, v210, v170
    v_mfma_f32_16x16x32_bf16 v[182:185], v[118:121], v[222:225], 0
    v_exp_f32 v200, v200
    v_mfma_f32_16x16x32_bf16 v[182:185], v[234:237], v[130:133], v[182:185]
    v_exp_f32 v201, v201
    v_sub_f32 v211, v211, v170
    v_mfma_f32_16x16x16_bf16 v[146:149], a[226:227], v[172:173], v[162:165]
    v_cvt_pk_bf16_f32 v187, v200, v201
    v_exp_f32 v210, v210
    v_mfma_f32_16x16x16_bf16 v[118:121], a[250:251], v[172:173], v[162:165]
    v_exp_f32 v211, v211
    v_sub_f32 v212, v212, v170
    v_mfma_f32_16x16x16_bf16 v[198:201], v[100:101], v[172:173], v[162:165]
    s_waitcnt lgkmcnt(0)
    v_cvt_pk_bf16_f32 v188, v210, v211
    v_cvt_pk_bf16_f32 v146, v146, v147
    v_mfma_f32_16x16x16_bf16 v[234:237], a[236:237], v[172:173], v[226:229]
    v_accvgpr_write_b32 a226, v146
    v_cvt_pk_bf16_f32 v148, v148, v149
    v_accvgpr_write_b32 a227, v148
    v_mfma_f32_16x16x16_bf16 v[162:165], v[86:87], v[172:173], v[226:229]
    v_cvt_pk_bf16_f32 v118, v118, v119
    v_accvgpr_write_b32 a250, v118
    v_cvt_pk_bf16_f32 v120, v120, v121
    v_mfma_f32_16x16x16_bf16 v[146:149], v[110:111], v[172:173], v[226:229]
    v_accvgpr_write_b32 a251, v120
    v_cvt_pk_bf16_f32 v100, v198, v199
    v_cvt_pk_bf16_f32 v101, v200, v201
    ds_read_b128 v[118:121], v255 offset:576
    v_cvt_pk_bf16_f32 v234, v234, v235
    v_accvgpr_write_b32 a236, v234
    v_cvt_pk_bf16_f32 v236, v236, v237
    v_accvgpr_write_b32 a237, v236
    v_cvt_pk_bf16_f32 v86, v162, v163
    v_cvt_pk_bf16_f32 v87, v164, v165
    v_cvt_pk_bf16_f32 v110, v146, v147
    v_cvt_pk_bf16_f32 v111, v148, v149
    ds_read_b128 v[162:165], v255 offset:640
    v_exp_f32 v212, v212
    v_sub_f32 v213, v213, v170
    v_exp_f32 v213, v213
    v_mfma_f32_16x16x32_f16 v[146:149], v[122:125], v[138:141], v[70:73]
    v_cvt_pk_bf16_f32 v189, v212, v213
    v_sub_f32 v134, v134, v170
    v_exp_f32 v134, v134
    v_sub_f32 v135, v135, v170
    v_exp_f32 v135, v135
    v_sub_f32 v136, v136, v170
    v_mfma_f32_16x16x16_f16 v[146:149], v[128:129], v[206:207], v[146:149]
    s_waitcnt lgkmcnt(1)
    v_cvt_pk_bf16_f32 v36, v134, v135
    v_sub_f32 v137, v137, v170
    v_mfma_f32_16x16x16_bf16 v[122:125], a[228:229], v[172:173], v[118:121]
    v_exp_f32 v136, v136
    v_exp_f32 v137, v137
    v_mfma_f32_16x16x32_f16 v[126:129], v[242:245], v[138:141], v[74:77]
    v_cvt_pk_bf16_f32 v37, v136, v137
    v_max3_f32 v254, v218, v146, v147
    v_mfma_f32_16x16x32_f16 v[134:137], v[142:145], v[138:141], v[78:81]
    s_waitcnt lgkmcnt(0)
    v_max3_f32 v254, v254, v148, v149
    v_cvt_pk_bf16_f32 v122, v122, v123
    v_accvgpr_write_b32 a228, v122
    v_mfma_f32_16x16x16_f16 v[126:129], v[176:177], v[206:207], v[126:129]
    v_cvt_pk_bf16_f32 v124, v124, v125
    v_accvgpr_write_b32 a229, v124
    v_sub_f32 v114, v114, v170
    v_mfma_f32_16x16x16_f16 v[134:137], v[208:209], v[206:207], v[134:137]
    v_exp_f32 v114, v114
    v_mfma_f32_16x16x16_bf16 v[138:141], a[252:253], v[172:173], v[118:121]
    v_cvt_pk_bf16_f32 v39, v114, 0
    v_rcp_f32_dpp v155, v154 quad_perm:[0,0,0,0] row_mask:0xf bank_mask:0xf
    v_mfma_f32_16x16x16_bf16 v[142:145], v[102:103], v[172:173], v[118:121]
    v_max3_f32 v254, v254, v126, v127
    v_max3_f32 v254, v254, v128, v129
    v_mul_f32 v190, v190, v155
    v_max3_f32 v254, v254, v134, v135
    v_mfma_f32_16x16x32_bf16 v[122:125], v[28:31], v[36:39], 0
    v_cvt_pk_bf16_f32 v138, v138, v139
    v_accvgpr_write_b32 a252, v138
    v_mfma_f32_16x16x32_bf16 v[122:125], v[28:31], v[186:189], v[122:125]
    v_cvt_pk_bf16_f32 v140, v140, v141
    v_accvgpr_write_b32 a253, v140
    v_mfma_f32_16x16x32_bf16 v[118:121], v[194:197], v[186:189], 0
    v_cvt_pk_bf16_f32 v102, v142, v143
    v_cvt_pk_bf16_f32 v103, v144, v145
    v_mfma_f32_16x16x32_bf16 v[118:121], v[166:169], v[36:39], v[118:121]
    ds_read_b128 v[138:141], v255 offset:704
    v_max3_f32 v254, v254, v136, v137
    v_mfma_f32_16x16x32_bf16 v[142:145], v[202:205], v[36:39], 0
    v_rcp_f32 v123, v122
    v_mfma_f32_16x16x32_bf16 v[142:145], v[158:161], v[186:189], v[142:145]
    v_mov_b32 v255, v254
    v_mul_f32_dpp v190, v150, v155 quad_perm:[0,1,2,3] row_mask:0x2 bank_mask:0xf
    v_mfma_f32_16x16x32_bf16 v[150:153], v[130:133], v[186:189], 0
    v_mul_f32 v118, v123, v118
    v_mul_f32 v119, v123, v119
    v_mfma_f32_16x16x32_bf16 v[150:153], v[222:225], v[36:39], v[150:153]
    v_cvt_pk_bf16_f32 v118, v118, v119
    v_mul_f32 v120, v123, v120
    v_mul_f32 v121, v123, v121
    v_mfma_f32_16x16x16_bf16 v[206:209], a[230:231], v[172:173], v[162:165]
    v_cvt_pk_bf16_f32 v119, v120, v121
    v_mul_f32 v142, v123, v142
    v_mul_f32 v143, v123, v143
    v_mfma_f32_16x16x16_bf16 v[114:117], a[254:255], v[172:173], v[162:165]
    v_cvt_pk_bf16_f32 v120, v142, v143
    v_mul_f32 v144, v123, v144
    v_mul_f32 v145, v123, v145
    v_mfma_f32_16x16x16_bf16 v[174:177], v[104:105], v[172:173], v[162:165]
    s_waitcnt lgkmcnt(0)
    v_cvt_pk_bf16_f32 v121, v144, v145
    v_mul_f32 v150, v123, v150
    v_mfma_f32_16x16x16_bf16 v[234:237], a[238:239], v[172:173], v[138:141]
    v_mul_f32 v151, v123, v151
    v_cvt_pk_bf16_f32 v156, v150, v151
    v_mul_f32 v152, v123, v152
    v_mfma_f32_16x16x16_bf16 v[142:145], v[88:89], v[172:173], v[138:141]
    v_mul_f32 v153, v123, v153
    v_cvt_pk_bf16_f32 v157, v152, v153
    v_cvt_pk_bf16_f32 v206, v206, v207
    v_mfma_f32_16x16x16_bf16 v[162:165], v[112:113], v[172:173], v[138:141]
    ds_write_b128 v3, v[118:121] offset:6144
    v_accvgpr_write_b32 a230, v206
    v_cvt_pk_bf16_f32 v208, v208, v209
    v_accvgpr_write_b32 a231, v208
    v_cvt_pk_bf16_f32 v114, v114, v115
    v_accvgpr_write_b32 a254, v114
    v_cvt_pk_bf16_f32 v116, v116, v117
    v_accvgpr_write_b32 a255, v116
    ds_write_b64 v4, v[156:157] offset:10240
    v_cvt_pk_bf16_f32 v104, v174, v175
    v_cvt_pk_bf16_f32 v105, v176, v177
    v_cvt_pk_bf16_f32 v234, v234, v235
    v_accvgpr_write_b32 a238, v234
    v_cvt_pk_bf16_f32 v236, v236, v237
    v_accvgpr_write_b32 a239, v236
    v_cvt_pk_bf16_f32 v88, v142, v143
    v_cvt_pk_bf16_f32 v89, v144, v145
    v_cvt_pk_bf16_f32 v112, v162, v163
    v_cvt_pk_bf16_f32 v113, v164, v165
    v_permlane32_swap_b32 v254, v255
    v_max_f32 v254, v254, v255
    v_mov_b32 v255, v254
    v_mul_f32_dpp v190, v182, v155 quad_perm:[0,1,2,3] row_mask:0x4 bank_mask:0xf
    v_cvt_pk_bf16_f32 v190, v190, v190
    ds_write_b16 v7, v190
    v_permlane16_swap_b32 v254, v255
    v_max_f32 v254, v254, v255
    v_sub_f32 v146, v146, v254
    v_exp_f32 v146, v146
    v_sub_f32 v147, v147, v254
    v_exp_f32 v147, v147
    v_sub_f32 v148, v148, v254
    v_cvt_pk_bf16_f32 v138, v146, v147
    v_exp_f32 v148, v148
    ds_read_b128 v[154:157], v0 offset:20480
    ds_read_b128 v[186:189], v1 offset:20480
    ds_read_b128 v[206:209], v0 offset:20608
    ds_read_b128 v[190:193], v1 offset:20608
    ds_read_b128 v[226:229], v0 offset:20736
    ds_read_b128 v[234:237], v1 offset:20736
    v_sub_f32 v149, v149, v254
    v_exp_f32 v149, v149
    v_sub_f32 v126, v126, v254
    v_cvt_pk_bf16_f32 v139, v148, v149
    v_exp_f32 v126, v126
    v_sub_f32 v127, v127, v254
    v_exp_f32 v127, v127
    v_sub_f32 v128, v128, v254
    v_cvt_pk_bf16_f32 v140, v126, v127
    v_exp_f32 v128, v128
    s_waitcnt lgkmcnt(5)
    v_mfma_f32_16x16x32_bf16 v[122:125], a[72:75], v[154:157], 0
    s_waitcnt lgkmcnt(3)
    v_sub_f32 v129, v129, v254
    v_sub_f32 v134, v134, v254
    v_mfma_f32_16x16x32_bf16 v[122:125], a[76:79], v[186:189], v[122:125]
    s_waitcnt lgkmcnt(2)
    v_exp_f32 v129, v129
    v_mfma_f32_16x16x32_bf16 v[122:125], a[80:83], v[206:209], v[122:125]
    s_waitcnt lgkmcnt(1)
    v_cvt_pk_bf16_f32 v141, v128, v129
    v_sub_f32 v135, v135, v254
    v_mfma_f32_16x16x32_bf16 v[122:125], a[84:87], v[190:193], v[122:125]
    s_waitcnt lgkmcnt(0)
    v_exp_f32 v134, v134
    v_mfma_f32_16x16x32_bf16 v[122:125], a[88:91], v[226:229], v[122:125]
    v_exp_f32 v135, v135
    v_mfma_f32_16x16x32_bf16 v[122:125], a[92:95], v[234:237], v[122:125]
    v_cvt_pk_bf16_f32 v36, v134, v135
    v_sub_f32 v136, v136, v254
    v_mfma_f32_16x16x32_bf16 v[126:129], a[116:119], v[234:237], 0
    v_exp_f32 v136, v136
    v_mfma_f32_16x16x32_bf16 v[126:129], a[112:115], v[226:229], v[126:129]
    v_sub_f32 v137, v137, v254
    v_sub_f32 v218, v218, v254
    v_mfma_f32_16x16x32_bf16 v[126:129], a[108:111], v[190:193], v[126:129]
    v_exp_f32 v137, v137
    v_mfma_f32_16x16x32_bf16 v[126:129], a[104:107], v[206:209], v[126:129]
    v_cvt_pk_bf16_f32 v37, v136, v137
    v_add_u32 v7, 16, v7
    v_mfma_f32_16x16x32_bf16 v[126:129], a[100:103], v[186:189], v[126:129]
    v_exp_f32 v218, v218
    v_mfma_f32_16x16x32_bf16 v[126:129], a[96:99], v[154:157], v[126:129]
    v_cvt_pk_bf16_f32 v39, v218, 0
    v_mfma_f32_16x16x32_bf16 v[146:149], a[120:123], v[154:157], 0
    v_mfma_f32_16x16x32_bf16 v[146:149], a[124:127], v[186:189], v[146:149]
    v_mfma_f32_16x16x32_bf16 v[142:145], v[28:31], v[36:39], 0
    v_mfma_f32_16x16x32_bf16 v[142:145], v[28:31], v[138:141], v[142:145]
    v_mfma_f32_16x16x32_bf16 v[134:137], v[194:197], v[138:141], 0
    v_mfma_f32_16x16x32_bf16 v[134:137], v[166:169], v[36:39], v[134:137]
    v_mfma_f32_16x16x32_bf16 v[162:165], v[202:205], v[36:39], 0
    v_mfma_f32_16x16x32_bf16 v[162:165], v[158:161], v[138:141], v[162:165]
    v_mfma_f32_16x16x32_bf16 v[166:169], v[130:133], v[138:141], 0
    v_mfma_f32_16x16x32_bf16 v[166:169], v[222:225], v[36:39], v[166:169]
    v_mfma_f32_16x16x32_bf16 v[146:149], a[128:131], v[206:209], v[146:149]
    v_mfma_f32_16x16x32_bf16 v[146:149], a[132:135], v[190:193], v[146:149]
    v_rcp_f32 v143, v142
    v_mfma_f32_16x16x32_bf16 v[146:149], a[136:139], v[226:229], v[146:149]
    v_mul_f32 v134, v143, v134
    v_mul_f32 v135, v143, v135
    v_mfma_f32_16x16x32_bf16 v[146:149], a[140:143], v[234:237], v[146:149]
    v_cvt_pk_bf16_f32 v130, v134, v135
    v_mul_f32 v136, v143, v136
    v_mfma_f32_16x16x32_bf16 v[114:117], a[20:23], v[234:237], 0
    v_mul_f32 v137, v143, v137
    v_cvt_pk_bf16_f32 v131, v136, v137
    v_mfma_f32_16x16x32_bf16 v[114:117], a[16:19], v[226:229], v[114:117]
    v_mul_f32 v162, v143, v162
    v_mul_f32 v163, v143, v163
    v_mfma_f32_16x16x32_bf16 v[114:117], a[12:15], v[190:193], v[114:117]
    v_cvt_pk_bf16_f32 v132, v162, v163
    v_mul_f32 v164, v143, v164
    v_mfma_f32_16x16x32_bf16 v[114:117], a[8:11], v[206:209], v[114:117]
    v_mul_f32 v165, v143, v165
    v_cvt_pk_bf16_f32 v133, v164, v165
    v_mfma_f32_16x16x32_bf16 v[114:117], a[4:7], v[186:189], v[114:117]
    ds_write_b128 v3, v[130:133] offset:12288
    v_mfma_f32_16x16x32_bf16 v[114:117], a[0:3], v[154:157], v[114:117]
    v_mul_f32 v166, v143, v166
    v_mul_f32 v167, v143, v167
    v_mfma_f32_16x16x32_bf16 v[118:121], a[24:27], v[154:157], 0
    v_cvt_pk_bf16_f32 v254, v166, v167
    v_mul_f32 v168, v143, v168
    v_mfma_f32_16x16x32_bf16 v[118:121], a[28:31], v[186:189], v[118:121]
    v_mul_f32 v169, v143, v169
    v_cvt_pk_bf16_f32 v255, v168, v169
    v_mfma_f32_16x16x32_bf16 v[118:121], a[32:35], v[206:209], v[118:121]
    ds_write_b64 v4, v[254:255] offset:16384
    v_mfma_f32_16x16x32_bf16 v[118:121], a[36:39], v[190:193], v[118:121]
    v_xor_b32 v3, 65536, v3
    v_xor_b32 v4, 65536, v4
    v_mfma_f32_16x16x32_bf16 v[118:121], a[40:43], v[226:229], v[118:121]
    v_mfma_f32_16x16x32_bf16 v[118:121], a[44:47], v[234:237], v[118:121]
    s_waitcnt lgkmcnt(0)
    s_barrier
    s_waitcnt lgkmcnt(0)
    s_cmp_eq_u32 s45, 0
    s_cbranch_scc1 L_drain
    s_nop 0
    s_lshr_b32 s3, s44, 8
    s_cbranch_scc1 L_safe
    v_cvt_pk_f16_f32 v182, v122, v123
    v_pk_mul_f16 v139, v182, v182
    v_cvt_pk_f16_f32 v183, v124, v125
    v_pk_fma_f16 v139, v183, v183, v139
    v_cvt_pk_f16_f32 v184, v126, v127
    v_pk_fma_f16 v139, v184, v184, v139
    v_cvt_pk_f16_f32 v185, v128, v129
    v_pk_fma_f16 v139, v185, v185, v139
    v_cvt_pk_f16_f32 v168, v146, v147
    v_pk_fma_f16 v139, v168, v168, v139
    v_cvt_pk_f16_f32 v169, v148, v149
    v_pk_fma_f16 v139, v169, v169, v139
    v_cvt_pk_f16_f32 v130, v114, v115
    v_pk_mul_f16 v138, v130, v130
    v_and_b32 v114, 16, v2
    v_sub_u32 v5, v5, v114
    v_mov_b32 v25, 0
    s_nop 7
    s_branch L_go
L_safe:
    v_fma_f32 v150, v122, v122, s32
    v_fmac_f32 v150, v123, v123
    v_fmac_f32 v150, v124, v124
    v_fmac_f32 v150, v125, v125
    s_nop 7
L_LOOP:
    v_mfma_f32_16x16x32_bf16 v[166:169], a[68:71], v[234:237], 0
    s_add_u32 s12, s40, s27
    ds_read_b128 v[130:133], v2 offset:18432
    ds_read_b128 v[138:141], v2 offset:19456
    v_mfma_f32_16x16x32_bf16 v[166:169], a[64:67], v[226:229], v[166:169]
    s_addc_u32 s13, s41, 0
    v_fmac_f32 v150, v126, v126
    v_fmac_f32 v150, v127, v127
    v_mfma_f32_16x16x32_bf16 v[166:169], a[60:63], v[190:193], v[166:169]
    s_sub_u32 s14, s36, s27
    v_fmac_f32 v150, v128, v128
    v_fmac_f32 v150, v129, v129
    v_mfma_f32_16x16x32_bf16 v[166:169], a[56:59], v[206:209], v[166:169]
    s_cmp_ge_u32 s18, 2
    v_fmac_f32 v150, v146, v146
    v_fmac_f32 v150, v147, v147
    v_mfma_f32_16x16x32_bf16 v[166:169], a[52:55], v[186:189], v[166:169]
    s_cselect_b32 s14, s14, 0
    v_fmac_f32 v150, v148, v148
    v_fmac_f32 v150, v149, v149
    v_mfma_f32_16x16x32_bf16 v[166:169], a[48:51], v[154:157], v[166:169]
    s_sub_u32 s82, s72, s71
    v_fma_f32 v254, v114, v114, s32
    v_fmac_f32 v254, v115, v115
    v_mfma_f32_16x16x32_bf16 v[182:185], v[154:157], a[144:147], 0
    s_mul_i32 s74, s82, 336
    v_fmac_f32 v254, v116, v116
    v_fmac_f32 v254, v117, v117
    v_mfma_f32_16x16x32_bf16 v[182:185], v[186:189], a[148:151], v[182:185]
    s_mul_i32 s75, s82, 272
    v_fmac_f32 v254, v118, v118
    v_fmac_f32 v254, v119, v119
    v_mfma_f32_16x16x32_bf16 v[182:185], v[206:209], a[152:155], v[182:185]
    s_waitcnt lgkmcnt(0)
    v_fmac_f32 v254, v120, v120
    v_fmac_f32 v254, v121, v121
    v_mfma_f32_16x16x32_bf16 v[194:197], v[32:35], v[130:133], 0
    s_mul_i32 s76, s82, 16
    v_fmac_f32 v254, v166, v166
    v_fmac_f32 v254, v167, v167
    v_mfma_f32_16x16x32_bf16 v[194:197], v[32:35], v[138:141], v[194:197]
    s_add_u32 s34, s18, 2
    v_fmac_f32 v254, v168, v168
    v_fmac_f32 v254, v169, v169
    v_mfma_f32_16x16x32_bf16 v[182:185], v[190:193], a[156:159], v[182:185]
    s_add_u32 s8, s60, s23
    v_cvt_pk_bf16_f32 v36, v254, v150
    s_addc_u32 s9, s61, 0
    v_mfma_f32_16x16x32_bf16 v[182:185], v[226:229], a[160:163], v[182:185]
    s_sub_u32 s10, s36, s23
    v_mul_f32 v254, 0x3baaaaab, v194
    v_mul_f32 v255, 0x3baaaaab, v195
    v_mfma_f32_16x16x32_bf16 v[198:201], v[32:35], v[36:39], 0
    s_cmp_le_u32 s34, s45
    v_rsq_f32 v254, v254
    v_mfma_f32_16x16x32_bf16 v[182:185], v[234:237], a[164:167], v[182:185]
    s_cselect_b32 s10, s10, 0
    ds_read_b128 v[202:205], v0 offset:26624
    v_mul_f32 v132, 0x3baaaaab, v196
    v_mfma_f32_16x16x32_bf16 v[138:141], v[234:237], a[188:191], 0
    s_add_u32 m0, s28, 0
    ds_read_b128 v[194:197], v1 offset:26624
    v_mul_f32 v178, v254, v178
    v_mfma_f32_16x16x32_bf16 v[138:141], v[226:229], a[184:187], v[138:141]
    s_mov_b32 s27, s26
    ds_read_b128 v[210:213], v0 offset:26752
    v_cvt_pk_bf16_f32 v130, v182, v183
    v_mfma_f32_16x16x32_bf16 v[138:141], v[190:193], a[180:183], v[138:141]
    s_mov_b32 s26, s25
    ds_read_b128 v[218:221], v1 offset:26752
    v_cvt_pk_bf16_f32 v131, v184, v185
    v_mfma_f32_16x16x32_bf16 v[138:141], v[206:209], a[176:179], v[138:141]
    s_mov_b32 s25, s24
    v_rsq_f32 v199, v199
    v_mfma_f32_16x16x32_bf16 v[138:141], v[186:189], a[172:175], v[138:141]
    s_mov_b32 s24, s23
    v_rsq_f32 v198, v198
    v_mfma_f32_16x16x32_bf16 v[138:141], v[154:157], a[168:171], v[138:141]
    s_ff1_i32_b32 s77, s100
    v_mul_f32 v198, s31, v198
    v_mul_f32 v122, v199, v122
    v_mul_f32 v123, v199, v123
    v_cvt_pk_f16_f32 v150, v122, v123
    v_mfma_f32_16x16x32_bf16 v[182:185], v[154:157], a[192:195], 0
    s_waitcnt lgkmcnt(3)
    ds_read_b128 v[154:157], v0 offset:26880
    v_cvt_pk_bf16_f32 v138, v138, v139
    v_mfma_f32_16x16x32_bf16 v[182:185], v[186:189], a[196:199], v[182:185]
    s_mul_i32 s78, s77, 2688
    ds_read_b128 v[186:189], v1 offset:26880
    v_cvt_pk_bf16_f32 v139, v140, v141
    v_mfma_f32_16x16x32_bf16 v[182:185], v[206:209], a[200:203], v[182:185]
    s_mov_b32 s71, s72
    v_mul_f32 v124, v199, v124
    v_mul_f32 v125, v199, v125
    v_mfma_f32_16x16x32_bf16 v[182:185], v[190:193], a[204:207], v[182:185]
    s_mov_b32 s72, s73
    v_cvt_pk_f16_f32 v151, v124, v125
    v_mul_f32 v126, v199, v126
    v_mfma_f32_16x16x32_bf16 v[182:185], v[226:229], a[208:211], v[182:185]
    s_waitcnt lgkmcnt(2)
    v_mul_f32 v127, v199, v127
    v_cvt_pk_f16_f32 v152, v126, v127
    v_mfma_f32_16x16x32_bf16 v[182:185], v[234:237], a[212:215], v[182:185]
    v_mul_f32 v128, v199, v128
    v_mul_f32 v129, v199, v129
    v_mfma_f32_16x16x32_bf16 v[190:193], a[72:75], v[202:205], 0
    v_cvt_pk_f16_f32 v153, v128, v129
    v_mul_f32 v146, v199, v146
    v_mfma_f32_16x16x32_bf16 v[190:193], a[76:79], v[194:197], v[190:193]
    v_mul_f32 v147, v199, v147
    v_cvt_pk_f16_f32 v124, v146, v147
    v_mfma_f32_16x16x32_bf16 v[190:193], a[80:83], v[210:213], v[190:193]
    s_waitcnt lgkmcnt(1)
    v_cvt_pk_bf16_f32 v146, v182, v183
    v_cvt_pk_bf16_f32 v147, v184, v185
    v_mfma_f32_16x16x32_bf16 v[190:193], a[84:87], v[218:221], v[190:193]
    s_waitcnt lgkmcnt(0)
    v_mul_f32 v148, v199, v148
    v_mul_f32 v149, v199, v149
    v_mfma_f32_16x16x32_bf16 v[190:193], a[88:91], v[154:157], v[190:193]
    v_cvt_pk_f16_f32 v125, v148, v149
    v_mul_f32 v114, v198, v114
    v_mfma_f32_16x16x32_bf16 v[190:193], a[92:95], v[186:189], v[190:193]
    v_mul_f32 v115, v198, v115
    v_cvt_pk_f16_f32 v206, v114, v115
    v_mfma_f32_16x16x32_bf16 v[126:129], a[116:119], v[186:189], 0
    v_mul_f32 v116, v198, v116
    v_mul_f32 v117, v198, v117
    v_mfma_f32_16x16x32_bf16 v[126:129], a[112:115], v[154:157], v[126:129]
    v_cvt_pk_f16_f32 v207, v116, v117
    v_mul_f32 v118, v198, v118
    v_mfma_f32_16x16x32_bf16 v[126:129], a[108:111], v[218:221], v[126:129]
    v_mul_f32 v119, v198, v119
    v_cvt_pk_f16_f32 v208, v118, v119
    v_mfma_f32_16x16x32_bf16 v[126:129], a[104:107], v[210:213], v[126:129]
    v_mul_f32 v120, v198, v120
    v_mul_f32 v121, v198, v121
    v_mfma_f32_16x16x32_bf16 v[126:129], a[100:103], v[194:197], v[126:129]
    v_cvt_pk_f16_f32 v209, v120, v121
    v_mul_f32 v166, v198, v166
    v_mfma_f32_16x16x32_bf16 v[126:129], a[96:99], v[202:205], v[126:129]
    v_mul_f32 v167, v198, v167
    v_cvt_pk_f16_f32 v122, v166, v167
    v_mfma_f32_16x16x32_bf16 v[182:185], a[120:123], v[202:205], 0
    v_mul_f32 v168, v198, v168
    v_mul_f32 v169, v198, v169
    v_mfma_f32_16x16x32_bf16 v[182:185], a[124:127], v[194:197], v[182:185]
    v_cvt_pk_f16_f32 v123, v168, v169
    v_fma_f32 v133, v190, v190, s32
    v_mfma_f32_16x16x32_bf16 v[182:185], a[128:131], v[210:213], v[182:185]
    v_fmac_f32 v133, v191, v191
    v_fmac_f32 v133, v192, v192
    v_mfma_f32_16x16x32_bf16 v[182:185], a[132:135], v[218:221], v[182:185]
    v_fmac_f32 v133, v193, v193
    v_fmac_f32 v133, v126, v126
    v_mfma_f32_16x16x32_bf16 v[182:185], a[136:139], v[154:157], v[182:185]
    v_fmac_f32 v133, v127, v127
    v_fmac_f32 v133, v128, v128
    v_mfma_f32_16x16x32_bf16 v[182:185], a[140:143], v[186:189], v[182:185]
    v_fmac_f32 v133, v129, v129
    v_mul_f32 v179, v254, v179
    v_mfma_f32_16x16x32_bf16 v[166:169], a[20:23], v[186:189], 0
    v_rsq_f32 v255, v255
    v_mfma_f32_16x16x32_bf16 v[166:169], a[16:19], v[154:157], v[166:169]
    v_rsq_f32 v132, v132
    v_mfma_f32_16x16x32_bf16 v[166:169], a[12:15], v[218:221], v[166:169]
    v_mul_f32 v170, v132, v170
    v_fmac_f32 v133, v182, v182
    v_mfma_f32_16x16x32_bf16 v[166:169], a[8:11], v[210:213], v[166:169]
    v_fmac_f32 v133, v183, v183
    v_fmac_f32 v133, v184, v184
    v_mfma_f32_16x16x32_bf16 v[166:169], a[4:7], v[194:197], v[166:169]
    v_fmac_f32 v133, v185, v185
    v_mul_f32 v171, v132, v171
    v_mfma_f32_16x16x32_bf16 v[166:169], a[0:3], v[202:205], v[166:169]
    v_cvt_pk_bf16_f32 v114, v170, v171
    v_mul_f32 v172, v132, v172
    v_mfma_f32_16x16x32_bf16 v[198:201], a[24:27], v[202:205], 0
    v_mul_f32 v173, v132, v173
    v_cvt_pk_bf16_f32 v115, v172, v173
    v_mfma_f32_16x16x32_bf16 v[198:201], a[28:31], v[194:197], v[198:201]
    v_mul_f32 v158, v132, v158
    v_mul_f32 v159, v132, v159
    v_mfma_f32_16x16x32_bf16 v[198:201], a[32:35], v[210:213], v[198:201]
    v_fma_f32 v140, v166, v166, s32
    v_fmac_f32 v140, v167, v167
    v_mfma_f32_16x16x32_bf16 v[198:201], a[36:39], v[218:221], v[198:201]
    v_fmac_f32 v140, v168, v168
    v_fmac_f32 v140, v169, v169
    v_mfma_f32_16x16x32_bf16 v[198:201], a[40:43], v[154:157], v[198:201]
    v_cvt_pk_bf16_f32 v116, v158, v159
    v_mul_f32 v160, v132, v160
    v_mfma_f32_16x16x32_bf16 v[198:201], a[44:47], v[186:189], v[198:201]
    v_mul_f32 v161, v132, v161
    v_cvt_pk_bf16_f32 v117, v160, v161
    v_mfma_f32_16x16x32_bf16 v[158:161], a[68:71], v[186:189], 0
    buffer_store_dwordx4 v[114:117], v17, s[12:15], 0 offen nt
    v_mul_f32 v238, v132, v238
    v_mul_f32 v239, v132, v239
    v_cvt_pk_bf16_f32 v148, v238, v239
    v_mul_f32 v240, v132, v240
    v_mfma_f32_16x16x32_bf16 v[158:161], a[64:67], v[154:157], v[158:161]
    v_fmac_f32 v140, v198, v198
    v_fmac_f32 v140, v199, v199
    v_mfma_f32_16x16x32_bf16 v[158:161], a[60:63], v[218:221], v[158:161]
    v_fmac_f32 v140, v200, v200
    v_fmac_f32 v140, v201, v201
    v_mfma_f32_16x16x32_bf16 v[158:161], a[56:59], v[210:213], v[158:161]
    v_mul_f32 v241, v132, v241
    v_cvt_pk_bf16_f32 v149, v240, v241
    v_mfma_f32_16x16x32_bf16 v[158:161], a[52:55], v[194:197], v[158:161]
    v_cvt_pk_bf16_f32 v170, v178, v179
    v_mul_f32 v180, v254, v180
    v_mfma_f32_16x16x32_bf16 v[158:161], a[48:51], v[202:205], v[158:161]
    v_mul_f32 v181, v254, v181
    v_cvt_pk_bf16_f32 v171, v180, v181
    v_mfma_f32_16x16x32_bf16 v[114:117], v[202:205], a[144:147], 0
    v_mul_f32 v142, v254, v142
    v_mul_f32 v143, v254, v143
    v_mfma_f32_16x16x32_bf16 v[114:117], v[194:197], a[148:151], v[114:117]
    v_cvt_pk_bf16_f32 v172, v142, v143
    v_mul_f32 v144, v254, v144
    v_mfma_f32_16x16x32_bf16 v[114:117], v[210:213], a[152:155], v[114:117]
    v_fmac_f32 v140, v158, v158
    v_fmac_f32 v140, v159, v159
    v_mfma_f32_16x16x32_bf16 v[114:117], v[218:221], a[156:159], v[114:117]
    v_fmac_f32 v140, v160, v160
    v_fmac_f32 v140, v161, v161
    v_mfma_f32_16x16x32_bf16 v[114:117], v[154:157], a[160:163], v[114:117]
    v_cvt_pk_bf16_f32 v36, v140, v133
    v_mul_f32 v145, v254, v145
    v_mfma_f32_16x16x32_bf16 v[114:117], v[186:189], a[164:167], v[114:117]
    ds_read_b128 v[178:181], v0 offset:32768
    v_cvt_pk_bf16_f32 v173, v144, v145
    v_mfma_f32_16x16x32_bf16 v[142:145], v[32:35], v[36:39], 0
    v_mul_f32 v134, v254, v134
    v_mul_f32 v135, v254, v135
    v_mfma_f32_16x16x32_bf16 v[118:121], v[186:189], a[188:191], 0
    ds_read_b128 v[222:225], v1 offset:32768
    v_cvt_pk_bf16_f32 v226, v134, v135
    v_mfma_f32_16x16x32_bf16 v[118:121], v[154:157], a[184:187], v[118:121]
    ds_read_b128 v[234:237], v0 offset:32896
    v_cvt_pk_bf16_f32 v132, v114, v115
    v_mfma_f32_16x16x32_bf16 v[118:121], v[218:221], a[180:183], v[118:121]
    ds_read_b128 v[238:241], v1 offset:32896
    v_cvt_pk_bf16_f32 v133, v116, v117
    v_mfma_f32_16x16x32_bf16 v[118:121], v[210:213], a[176:179], v[118:121]
    v_rsq_f32 v143, v143
    v_mfma_f32_16x16x32_bf16 v[118:121], v[194:197], a[172:175], v[118:121]
    buffer_store_dwordx2 v[148:149], v20, s[12:15], 0 offen nt
    v_rsq_f32 v142, v142
    v_mfma_f32_16x16x32_bf16 v[118:121], v[202:205], a[168:171], v[118:121]
    s_waitcnt lgkmcnt(3)
    v_mul_f32 v142, s31, v142
    v_mul_f32 v190, v143, v190
    v_mul_f32 v191, v143, v191
    v_cvt_pk_f16_f32 v114, v190, v191
    v_mfma_f32_16x16x32_bf16 v[230:233], v[202:205], a[192:195], 0
    ds_read_b128 v[202:205], v0 offset:33024
    v_mul_f32 v192, v143, v192
    v_mfma_f32_16x16x32_bf16 v[230:233], v[194:197], a[196:199], v[230:233]
    s_waitcnt lgkmcnt(3)
    ds_read_b128 v[242:245], v1 offset:33024
    v_cvt_pk_bf16_f32 v140, v118, v119
    v_mfma_f32_16x16x32_bf16 v[230:233], v[210:213], a[200:203], v[230:233]
    s_waitcnt lgkmcnt(3)
    v_cvt_pk_bf16_f32 v141, v120, v121
    v_mul_f32 v193, v143, v193
    v_mfma_f32_16x16x32_bf16 v[230:233], v[218:221], a[204:207], v[230:233]
    s_waitcnt vmcnt(2)
    v_cvt_pk_f16_f32 v115, v192, v193
    v_mul_f32 v126, v143, v126
    v_mfma_f32_16x16x32_bf16 v[230:233], v[154:157], a[208:211], v[230:233]
    s_waitcnt lgkmcnt(2)
    v_mul_f32 v127, v143, v127
    v_cvt_pk_f16_f32 v116, v126, v127
    v_mfma_f32_16x16x32_bf16 v[230:233], v[186:189], a[212:215], v[230:233]
    v_mul_f32 v128, v143, v128
    v_mul_f32 v129, v143, v129
    v_mfma_f32_16x16x32_bf16 v[186:189], a[72:75], v[178:181], 0
    v_cvt_pk_f16_f32 v117, v128, v129
    v_mul_f32 v182, v143, v182
    v_mfma_f32_16x16x32_bf16 v[186:189], a[76:79], v[222:225], v[186:189]
    v_mul_f32 v183, v143, v183
    v_cvt_pk_f16_f32 v120, v182, v183
    v_mfma_f32_16x16x32_bf16 v[186:189], a[80:83], v[234:237], v[186:189]
    s_waitcnt lgkmcnt(1)
    v_cvt_pk_bf16_f32 v148, v230, v231
    v_cvt_pk_bf16_f32 v149, v232, v233
    v_mfma_f32_16x16x32_bf16 v[186:189], a[84:87], v[238:241], v[186:189]
    s_waitcnt lgkmcnt(0)
    v_mul_f32 v184, v143, v184
    v_mul_f32 v185, v143, v185
    v_mfma_f32_16x16x32_bf16 v[186:189], a[88:91], v[202:205], v[186:189]
    s_barrier
    v_cvt_pk_f16_f32 v121, v184, v185
    v_mul_f32 v166, v142, v166
    v_mfma_f32_16x16x32_bf16 v[186:189], a[92:95], v[242:245], v[186:189]
    v_mul_f32 v167, v142, v167
    v_cvt_pk_f16_f32 v154, v166, v167
    v_mfma_f32_16x16x32_bf16 v[126:129], a[116:119], v[242:245], 0
    v_mul_f32 v168, v142, v168
    v_mul_f32 v169, v142, v169
    v_mfma_f32_16x16x32_bf16 v[126:129], a[112:115], v[202:205], v[126:129]
    v_cvt_pk_f16_f32 v155, v168, v169
    v_mul_f32 v198, v142, v198
    v_mfma_f32_16x16x32_bf16 v[126:129], a[108:111], v[238:241], v[126:129]
    v_mul_f32 v199, v142, v199
    v_cvt_pk_f16_f32 v156, v198, v199
    v_mfma_f32_16x16x32_bf16 v[126:129], a[104:107], v[234:237], v[126:129]
    buffer_load_dwordx4 v10, s[8:11], 0 offen nt lds
    v_mul_f32 v200, v142, v200
    v_mfma_f32_16x16x32_bf16 v[126:129], a[100:103], v[222:225], v[126:129]
    s_add_u32 m0, s28, 4096
    v_mul_f32 v201, v142, v201
    v_cvt_pk_f16_f32 v157, v200, v201
    v_mfma_f32_16x16x32_bf16 v[126:129], a[96:99], v[178:181], v[126:129]
    v_mul_f32 v158, v142, v158
    v_mul_f32 v159, v142, v159
    v_mfma_f32_16x16x32_bf16 v[210:213], a[120:123], v[178:181], 0
    v_cvt_pk_f16_f32 v118, v158, v159
    v_mul_f32 v160, v142, v160
    v_mfma_f32_16x16x32_bf16 v[210:213], a[124:127], v[222:225], v[210:213]
    v_mul_f32 v161, v142, v161
    v_cvt_pk_f16_f32 v119, v160, v161
    v_mfma_f32_16x16x32_bf16 v[210:213], a[128:131], v[234:237], v[210:213]
    buffer_load_dwordx4 v11, s[8:11], 0 offen nt lds
    v_mul_f32 v136, v254, v136
    v_mfma_f32_16x16x32_bf16 v[210:213], a[132:135], v[238:241], v[210:213]
    s_add_u32 m0, s28, 8192
    v_mul_f32 v137, v254, v137
    v_cvt_pk_bf16_f32 v227, v136, v137
    v_mfma_f32_16x16x32_bf16 v[210:213], a[136:139], v[202:205], v[210:213]
    v_fma_f32 v228, v186, v186, s32
    v_fmac_f32 v228, v187, v187
    v_mfma_f32_16x16x32_bf16 v[210:213], a[140:143], v[242:245], v[210:213]
    v_fmac_f32 v228, v188, v188
    v_fmac_f32 v228, v189, v189
    v_mfma_f32_16x16x32_bf16 v[218:221], a[20:23], v[242:245], 0
    v_fmac_f32 v228, v126, v126
    v_fmac_f32 v228, v127, v127
    v_mfma_f32_16x16x32_bf16 v[218:221], a[16:19], v[202:205], v[218:221]
    buffer_load_dwordx4 v12, s[8:11], 0 offen nt lds
    v_fmac_f32 v228, v128, v128
    v_mfma_f32_16x16x32_bf16 v[218:221], a[12:15], v[238:241], v[218:221]
    s_add_u32 m0, s28, 12288
    v_fmac_f32 v228, v129, v129
    v_fmac_f32 v228, v210, v210
    v_mfma_f32_16x16x32_bf16 v[218:221], a[8:11], v[234:237], v[218:221]
    s_xor_b32 s28, s28, 65536
    v_fmac_f32 v228, v211, v211
    v_fmac_f32 v228, v212, v212
    v_mfma_f32_16x16x32_bf16 v[218:221], a[4:7], v[222:225], v[218:221]
    v_fmac_f32 v228, v213, v213
    v_mul_f32 v174, v255, v174
    v_mfma_f32_16x16x32_bf16 v[218:221], a[0:3], v[178:181], v[218:221]
    v_mul_f32 v175, v255, v175
    v_cvt_pk_bf16_f32 v134, v174, v175
    v_mfma_f32_16x16x32_bf16 v[246:249], a[24:27], v[178:181], 0
    buffer_load_dwordx4 v13, s[8:11], 0 offen nt lds
    v_mul_f32 v176, v255, v176
    v_mfma_f32_16x16x32_bf16 v[246:249], a[28:31], v[222:225], v[246:249]
    s_mov_b32 m0, s29
    v_mul_f32 v177, v255, v177
    v_fma_f32 v229, v218, v218, s32
    v_mfma_f32_16x16x32_bf16 v[246:249], a[32:35], v[234:237], v[246:249]
    s_xor_b32 s29, s29, s30
    v_fmac_f32 v229, v219, v219
    v_fmac_f32 v229, v220, v220
    v_mfma_f32_16x16x32_bf16 v[246:249], a[36:39], v[238:241], v[246:249]
    s_add_u32 s19, s19, s20
    v_fmac_f32 v229, v221, v221
    v_cvt_pk_bf16_f32 v135, v176, v177
    v_mfma_f32_16x16x32_bf16 v[246:249], a[40:43], v[202:205], v[246:249]
    s_add_u32 s23, s23, s21
    v_mul_f32 v162, v255, v162
    v_mul_f32 v163, v255, v163
    v_mfma_f32_16x16x32_bf16 v[246:249], a[44:47], v[242:245], v[246:249]
    buffer_load_dwordx4 v14, s[8:11], 0 offen nt lds
    v_cvt_pk_bf16_f32 v136, v162, v163
    v_mfma_f32_16x16x32_bf16 v[142:145], a[68:71], v[242:245], 0
    s_cmp_ge_u32 s19, 72
    v_mul_f32 v164, v255, v164
    v_mul_f32 v165, v255, v165
    v_mfma_f32_16x16x32_bf16 v[142:145], a[64:67], v[202:205], v[142:145]
    s_cselect_b32 s34, 72, 0
    v_fmac_f32 v229, v246, v246
    v_fmac_f32 v229, v247, v247
    v_mfma_f32_16x16x32_bf16 v[142:145], a[60:63], v[238:241], v[142:145]
    s_cselect_b32 s35, s22, 0
    v_fmac_f32 v229, v248, v248
    v_fmac_f32 v229, v249, v249
    v_mfma_f32_16x16x32_bf16 v[142:145], a[56:59], v[234:237], v[142:145]
    s_sub_u32 s19, s19, s34
    v_cvt_pk_bf16_f32 v137, v164, v165
    v_mul_f32 v214, v255, v214
    v_mfma_f32_16x16x32_bf16 v[142:145], a[52:55], v[222:225], v[142:145]
    buffer_store_dwordx4 v[170:173], v15, s[12:15], 0 offen nt
    v_mul_f32 v215, v255, v215
    v_cvt_pk_bf16_f32 v254, v214, v215
    v_mul_f32 v216, v255, v216
    v_mul_f32 v217, v255, v217
    v_mfma_f32_16x16x32_bf16 v[142:145], a[48:51], v[178:181], v[142:145]
    s_add_u32 s23, s23, s35
    v_cvt_pk_bf16_f32 v255, v216, v217
    v_xor_b32 v0, 65536, v0
    v_mfma_f32_16x16x32_bf16 v[158:161], v[178:181], a[144:147], 0
    s_add_u32 s78, s78, s69
    v_xor_b32 v1, 65536, v1
    s_add_u32 s80, s77, s68
    v_mfma_f32_16x16x32_bf16 v[158:161], v[222:225], a[148:151], v[158:161]
    s_cmp_ge_u32 s80, 72
    v_fmac_f32 v229, v142, v142
    v_fmac_f32 v229, v143, v143
    v_mfma_f32_16x16x32_bf16 v[158:161], v[234:237], a[152:155], v[158:161]
    s_cselect_b32 s80, s22, 0
    v_fmac_f32 v229, v144, v144
    v_fmac_f32 v229, v145, v145
    v_mfma_f32_16x16x32_bf16 v[158:161], v[238:241], a[156:159], v[158:161]
    s_add_u32 s78, s78, s80
    ds_read2_b32 v[168:169], v6 offset0:0 offset1:0
    ds_read2_b32 v[184:185], v6 offset0:16 offset1:16
    v_mfma_f32_16x16x32_bf16 v[158:161], v[202:205], a[160:163], v[158:161]
    s_add_u32 s80, s77, 20
    ds_read2_b32 v[196:197], v6 offset0:32 offset1:32
    v_cvt_pk_bf16_f32 v36, v229, v228
    v_mfma_f32_16x16x32_bf16 v[158:161], v[242:245], a[164:167], v[158:161]
    s_add_u32 s34, s18, 3
    s_cmp_lt_u32 s77, s62
    s_cselect_b32 s79, 1, 0
    v_mfma_f32_16x16x32_bf16 v[230:233], v[32:35], v[36:39], 0
    s_cselect_b32 s78, s78, 0
    s_cmp_lt_u32 s34, s17
    s_cselect_b32 s23, s23, s78
    v_mfma_f32_16x16x32_bf16 v[162:165], v[242:245], a[188:191], 0
    s_cselect_b32 s73, s34, s80
    v_cvt_pk_bf16_f32 v166, v158, v159
    v_cvt_pk_bf16_f32 v167, v160, v161
    v_mfma_f32_16x16x32_bf16 v[162:165], v[202:205], a[184:187], v[162:165]
    s_cselect_b32 s79, 0, s79
    v_rsq_f32 v231, v231
    v_mfma_f32_16x16x32_bf16 v[162:165], v[238:241], a[180:183], v[162:165]
    s_cselect_b32 s81, 0, 1
    v_rsq_f32 v230, v230
    v_mfma_f32_16x16x32_bf16 v[162:165], v[234:237], a[176:179], v[162:165]
    s_sub_u32 s80, s100, s81
    v_mul_f32 v230, s31, v230
    v_mul_f32 v186, v231, v186
    v_mfma_f32_16x16x32_bf16 v[162:165], v[222:225], a[172:175], v[162:165]
    s_and_b32 s100, s100, s80
    v_mul_f32 v187, v231, v187
    v_cvt_pk_f16_f32 v158, v186, v187
    v_mfma_f32_16x16x32_bf16 v[162:165], v[178:181], a[168:171], v[162:165]
    s_lshl_b32 s80, s79, s73
    v_mul_f32 v188, v231, v188
    v_mul_f32 v189, v231, v189
    v_mfma_f32_16x16x32_bf16 v[170:173], v[178:181], a[192:195], 0
    s_or_b32 s70, s70, s80
    v_cvt_pk_f16_f32 v159, v188, v189
    v_mul_f32 v126, v231, v126
    v_mfma_f32_16x16x32_bf16 v[170:173], v[222:225], a[196:199], v[170:173]
    s_add_u32 s45, s45, s79
    v_cvt_pk_bf16_f32 v182, v162, v163
    v_cvt_pk_bf16_f32 v183, v164, v165
    v_mfma_f32_16x16x32_bf16 v[170:173], v[234:237], a[200:203], v[170:173]
    s_add_u32 s18, s18, 1
    ds_read_b128 v[222:225], v5 offset:0
    ds_read_b128 v[214:217], v5 offset:16
    v_mfma_f32_16x16x32_bf16 v[170:173], v[238:241], a[204:207], v[170:173]
    s_cmp_lt_u32 s18, s45
    ds_read_b128 v[178:181], v5 offset:48
    ds_read_b32 v232, v6 offset:192
    v_mfma_f32_16x16x32_bf16 v[170:173], v[202:205], a[208:211], v[170:173]
    s_waitcnt lgkmcnt(4)
    buffer_store_dwordx2 v[226:227], v18, s[12:15], 0 offen nt
    v_mul_f32 v127, v231, v127
    v_cvt_pk_f16_f32 v160, v126, v127
    v_mfma_f32_16x16x32_f16 v[186:189], v[150:153], v[206:209], v[46:49]
    v_mul_f32 v128, v231, v128
    v_mul_f32 v129, v231, v129
    v_mfma_f32_16x16x32_f16 v[174:177], v[114:117], v[206:209], v[50:53]
    v_cvt_pk_f16_f32 v161, v128, v129
    v_mul_f32 v210, v231, v210
    v_mfma_f32_16x16x32_bf16 v[170:173], v[242:245], a[212:215], v[170:173]
    ds_read_b128 v[198:201], v2 offset:0
    ds_read_b128 v[190:193], v2 offset:1024
    v_mfma_f32_16x16x32_f16 v[162:165], v[158:161], v[206:209], v[54:57]
    v_mul_f32 v211, v231, v211
    v_cvt_pk_f16_f32 v128, v210, v211
    v_mul_f32 v212, v231, v212
    v_mfma_f32_16x16x16_f16 v[186:189], v[124:125], v[122:123], v[186:189]
    v_mul_f32 v213, v231, v213
    v_cvt_pk_bf16_f32 v194, v170, v171
    v_cvt_pk_bf16_f32 v195, v172, v173
    v_mfma_f32_16x16x16_f16 v[174:177], v[120:121], v[122:123], v[174:177]
    v_cvt_pk_f16_f32 v129, v212, v213
    v_mul_f32 v218, v230, v218
    v_mul_f32 v219, v230, v219
    v_mfma_f32_16x16x16_f16 v[162:165], v[128:129], v[122:123], v[162:165]
    v_cvt_pk_f16_f32 v170, v218, v219
    v_mul_f32 v220, v230, v220
    v_mul_f32 v221, v230, v221
    s_waitcnt lgkmcnt(2)
    v_mfma_f32_16x16x32_f16 v[226:229], v[222:225], v[206:209], v[22:25]
    ds_read_b128 v[210:213], v2 offset:2048
    ds_read_b128 v[202:205], v2 offset:3072
    v_mfma_f32_16x16x32_f16 v[226:229], v[214:217], v[150:153], v[226:229]
    v_cvt_pk_f16_f32 v171, v220, v221
    v_mul_f32 v246, v230, v246
    v_mfma_f32_16x16x32_f16 v[226:229], v[178:181], v[122:125], v[226:229]
    s_waitcnt lgkmcnt(2)
    ds_read_b128 v[206:209], v2 offset:4096
    v_mul_f32 v247, v230, v247
    v_cvt_pk_f16_f32 v172, v246, v247
    v_mul_f32 v248, v230, v248
    v_mul_f32 v249, v230, v249
    v_cvt_pk_f16_f32 v173, v248, v249
    v_mfma_f32_16x16x32_f16 v[218:221], v[222:225], v[154:157], v[24:27]
    v_mul_f32 v142, v230, v142
    v_mul_f32 v143, v230, v143
    v_mfma_f32_16x16x32_f16 v[218:221], v[214:217], v[114:117], v[218:221]
    v_cvt_pk_f16_f32 v126, v142, v143
    v_mul_f32 v144, v230, v144
    v_mfma_f32_16x16x32_f16 v[218:221], v[178:181], v[118:121], v[218:221]
    v_mul_f32 v145, v230, v145
    v_cvt_pk_f16_f32 v127, v144, v145
    v_mfma_f32_16x16x32_f16 v[234:237], v[222:225], v[170:173], v[26:29]
    ds_read_b128 v[222:225], v2 offset:5120
    v_mov_b32_dpp v232, v227 quad_perm:[0,1,2,3] row_mask:0x1 bank_mask:0xf
    v_mfma_f32_16x16x32_f16 v[234:237], v[214:217], v[158:161], v[234:237]
    s_waitcnt lgkmcnt(2)
    v_max3_f32 v122, v226, v186, v187
    v_mov_b32_dpp v232, v219 quad_perm:[0,1,2,3] row_mask:0x2 bank_mask:0xf
    v_mfma_f32_16x16x32_f16 v[234:237], v[178:181], v[126:129], v[234:237]
    buffer_store_dwordx4 v[134:137], v16, s[12:15], 0 offen nt
    v_max3_f32 v122, v122, v188, v189
    v_max3_f32 v122, v122, v174, v175
    v_max3_f32 v122, v122, v176, v177
    v_max3_f32 v122, v122, v162, v163
    v_mfma_f32_16x16x32_bf16 v[178:181], a[216:219], v[198:201], 0
    s_waitcnt lgkmcnt(1)
    v_max3_f32 v122, v122, v164, v165
    v_mov_b32 v123, v122
    v_mfma_f32_16x16x32_bf16 v[178:181], a[220:223], v[190:193], v[178:181]
    v_mov_b32_dpp v232, v235 quad_perm:[0,1,2,3] row_mask:0x4 bank_mask:0xf
    v_mov_b32 v219, v232
    v_mfma_f32_16x16x32_bf16 v[178:181], a[224:227], v[210:213], v[178:181]
    v_permlane32_swap_b32 v122, v123
    v_mfma_f32_16x16x32_bf16 v[178:181], a[228:231], v[202:205], v[178:181]
    v_max_f32 v122, v122, v123
    v_mov_b32 v123, v122
    v_mfma_f32_16x16x32_bf16 v[178:181], a[232:235], v[206:209], v[178:181]
    s_waitcnt lgkmcnt(0)
    v_permlane16_swap_b32 v122, v123
    v_mfma_f32_16x16x32_bf16 v[178:181], a[236:239], v[222:225], v[178:181]
    v_max_f32 v122, v122, v123
    v_sub_f32 v186, v186, v122
    v_mfma_f32_16x16x32_bf16 v[142:145], v[86:89], v[222:225], 0
    v_exp_f32 v186, v186
    v_mfma_f32_16x16x32_bf16 v[142:145], v[82:85], v[206:209], v[142:145]
    v_sub_f32 v187, v187, v122
    v_sub_f32 v188, v188, v122
    v_mfma_f32_16x16x32_bf16 v[142:145], a[252:255], v[202:205], v[142:145]
    v_exp_f32 v187, v187
    v_mfma_f32_16x16x32_bf16 v[142:145], a[248:251], v[210:213], v[142:145]
    v_cvt_pk_bf16_f32 v186, v186, v187
    v_sub_f32 v189, v189, v122
    v_mfma_f32_16x16x32_bf16 v[142:145], a[244:247], v[190:193], v[142:145]
    v_exp_f32 v188, v188
    v_mfma_f32_16x16x32_bf16 v[142:145], a[240:243], v[198:201], v[142:145]
    v_exp_f32 v189, v189
    v_mfma_f32_16x16x32_bf16 v[134:137], v[90:93], v[198:201], 0
    ds_read_b128 v[198:201], v2 offset:11264
    v_cvt_pk_bf16_f32 v187, v188, v189
    v_mfma_f32_16x16x32_bf16 v[134:137], v[94:97], v[190:193], v[134:137]
    ds_read_b128 v[190:193], v2 offset:10240
    v_sub_f32 v174, v174, v122
    v_mfma_f32_16x16x32_bf16 v[134:137], v[98:101], v[210:213], v[134:137]
    ds_read_b128 v[210:213], v2 offset:9216
    v_sub_f32 v175, v175, v122
    v_mfma_f32_16x16x32_bf16 v[134:137], v[102:105], v[202:205], v[134:137]
    ds_read_b128 v[202:205], v2 offset:8192
    buffer_store_dwordx2 v[254:255], v19, s[12:15], 0 offen nt
    v_exp_f32 v174, v174
    v_mfma_f32_16x16x32_f16 v[238:241], v[150:153], v[154:157], v[58:61]
    v_exp_f32 v175, v175
    v_mfma_f32_16x16x32_bf16 v[134:137], v[106:109], v[206:209], v[134:137]
    ds_read_b128 v[206:209], v2 offset:7168
    v_cvt_pk_bf16_f32 v188, v174, v175
    v_mfma_f32_16x16x32_bf16 v[134:137], v[110:113], v[222:225], v[134:137]
    ds_read_b128 v[222:225], v2 offset:6144
    v_sub_f32 v176, v176, v122
    v_sub_f32 v177, v177, v122
    v_mfma_f32_16x16x16_f16 v[238:241], v[124:125], v[118:119], v[238:241]
    v_exp_f32 v176, v176
    v_exp_f32 v177, v177
    v_mfma_f32_16x16x32_f16 v[242:245], v[114:117], v[154:157], v[62:65]
    s_waitcnt lgkmcnt(4)
    v_cvt_pk_bf16_f32 v189, v176, v177
    v_sub_f32 v162, v162, v122
    v_exp_f32 v162, v162
    v_sub_f32 v163, v163, v122
    v_exp_f32 v163, v163
    v_mfma_f32_16x16x16_f16 v[242:245], v[120:121], v[118:119], v[242:245]
    v_cvt_pk_bf16_f32 v36, v162, v163
    v_sub_f32 v164, v164, v122
    v_exp_f32 v164, v164
    v_mfma_f32_16x16x32_f16 v[174:177], v[158:161], v[154:157], v[66:69]
    s_waitcnt lgkmcnt(2)
    v_sub_f32 v165, v165, v122
    v_sub_f32 v226, v226, v122
    v_mfma_f32_16x16x32_bf16 v[214:217], v[110:113], v[198:201], 0
    s_waitcnt lgkmcnt(1)
    v_exp_f32 v165, v165
    v_max_f32_dpp v219, v219, v219 quad_perm:[1,0,3,2] row_mask:0xf bank_mask:0xf
    v_mfma_f32_16x16x16_f16 v[174:177], v[128:129], v[118:119], v[174:177]
    v_cvt_pk_bf16_f32 v37, v164, v165
    v_exp_f32 v226, v226
    v_max_f32_dpp v219, v219, v219 quad_perm:[2,3,0,1] row_mask:0xf bank_mask:0xf
    v_mfma_f32_16x16x32_bf16 v[214:217], v[106:109], v[190:193], v[214:217]
    s_waitcnt lgkmcnt(0)
    v_cvt_pk_bf16_f32 v39, v226, 0
    v_max_f32_dpp v219, v219, v219 row_half_mirror row_mask:0xf bank_mask:0xf
    v_mfma_f32_16x16x32_bf16 v[214:217], v[102:105], v[210:213], v[214:217]
    v_max3_f32 v118, v218, v238, v239
    v_max_f32_dpp v219, v219, v219 row_mirror row_mask:0xf bank_mask:0xf
    v_mfma_f32_16x16x32_bf16 v[154:157], v[28:31], v[36:39], 0
    v_mov_b32 v119, v219
    v_max3_f32 v118, v118, v240, v241
    v_mfma_f32_16x16x32_bf16 v[154:157], v[28:31], v[186:189], v[154:157]
    v_permlane32_swap_b32 v219, v119
    v_mfma_f32_16x16x32_bf16 v[214:217], v[98:101], v[202:205], v[214:217]
    v_max_f32 v219, v219, v119
    v_mov_b32 v119, v219
    v_mfma_f32_16x16x32_bf16 v[214:217], v[94:97], v[206:209], v[214:217]
    v_max3_f32 v118, v118, v242, v243
    v_max3_f32 v118, v118, v244, v245
    v_mfma_f32_16x16x32_bf16 v[214:217], v[90:93], v[222:225], v[214:217]
    v_rcp_f32 v155, v154
    v_permlane16_swap_b32 v219, v119
    v_max_f32 v219, v219, v119
    v_mfma_f32_16x16x32_bf16 v[162:165], v[130:133], v[186:189], 0
    v_sub_f32 v232, v232, v219
    v_max3_f32 v118, v118, v174, v175
    v_mfma_f32_16x16x32_bf16 v[162:165], v[166:169], v[36:39], v[162:165]
    v_exp_f32 v232, v232
    v_max3_f32 v118, v118, v176, v177
    v_cvt_pk_bf16_f32 v232, v232, v232
    v_mov_b32 v119, v118
    v_fma_f32 v254, v178, v178, s33
    v_fmac_f32 v254, v179, v179
    v_permlane32_swap_b32 v118, v119
    v_max_f32 v118, v118, v119
    v_mul_f32 v162, v155, v162
    v_mul_f32 v163, v155, v163
    v_cvt_pk_bf16_f32 v162, v162, v163
    v_mul_f32 v164, v155, v164
    v_mul_f32 v165, v155, v165
    v_cvt_pk_bf16_f32 v163, v164, v165
    v_mov_b32 v119, v118
    v_fmac_f32 v254, v180, v180
    v_fmac_f32 v254, v181, v181
    v_permlane16_swap_b32 v118, v119
    v_max_f32 v118, v118, v119
    v_sub_f32 v238, v238, v118
    v_exp_f32 v238, v238
    v_sub_f32 v239, v239, v118
    v_exp_f32 v239, v239
    v_sub_f32 v240, v240, v118
    v_cvt_pk_bf16_f32 v226, v238, v239
    v_exp_f32 v240, v240
    v_sub_f32 v241, v241, v118
    v_exp_f32 v241, v241
    v_sub_f32 v242, v242, v118
    v_cvt_pk_bf16_f32 v227, v240, v241
    v_mfma_f32_16x16x32_bf16 v[238:241], v[182:185], v[36:39], 0
    ds_write_b16 v8, v232
    v_mfma_f32_16x16x32_bf16 v[238:241], v[138:141], v[186:189], v[238:241]
    v_exp_f32 v242, v242
    v_sub_f32 v243, v243, v118
    v_exp_f32 v243, v243
    v_sub_f32 v244, v244, v118
    v_cvt_pk_bf16_f32 v228, v242, v243
    v_exp_f32 v244, v244
    v_sub_f32 v245, v245, v118
    v_exp_f32 v245, v245
    v_mul_f32 v238, v155, v238
    v_mul_f32 v239, v155, v239
    v_cvt_pk_bf16_f32 v164, v238, v239
    v_mul_f32 v240, v155, v240
    v_mul_f32 v241, v155, v241
    v_cvt_pk_bf16_f32 v165, v240, v241
    v_mfma_f32_16x16x32_bf16 v[230:233], v[146:149], v[186:189], 0
    ds_read_b128 v[186:189], v9
    v_cvt_pk_bf16_f32 v229, v244, v245
    v_mfma_f32_16x16x32_bf16 v[230:233], v[194:197], v[36:39], v[230:233]
    ds_write_b128 v3, v[162:165] offset:0
    v_mfma_f32_16x16x32_f16 v[238:241], v[150:153], v[170:173], v[70:73]
    v_sub_f32 v174, v174, v118
    v_sub_f32 v175, v175, v118
    v_mfma_f32_16x16x32_bf16 v[162:165], a[240:243], v[222:225], 0
    v_exp_f32 v174, v174
    v_mfma_f32_16x16x32_bf16 v[162:165], a[244:247], v[206:209], v[162:165]
    v_exp_f32 v175, v175
    v_mul_f32 v230, v155, v230
    v_mfma_f32_16x16x16_f16 v[238:241], v[124:125], v[126:127], v[238:241]
    v_mul_f32 v231, v155, v231
    v_cvt_pk_bf16_f32 v230, v230, v231
    v_mul_f32 v232, v155, v232
    v_mul_f32 v233, v155, v233
    v_mfma_f32_16x16x32_bf16 v[162:165], a[248:251], v[202:205], v[162:165]
    s_waitcnt lgkmcnt(1)
    ds_read_b128 v[122:125], v9 offset:64
    v_cvt_pk_bf16_f32 v231, v232, v233
    v_mfma_f32_16x16x32_bf16 v[162:165], a[252:255], v[210:213], v[162:165]
    ds_write_b64 v4, v[230:231] offset:4096
    v_mfma_f32_16x16x32_bf16 v[150:153], v[186:189], v[28:31], 0
    v_max3_f32 v255, v234, v238, v239
    v_max3_f32 v255, v255, v240, v241
    v_mfma_f32_16x16x32_bf16 v[162:165], v[82:85], v[190:193], v[162:165]
    v_cvt_pk_bf16_f32 v36, v174, v175
    v_sub_f32 v176, v176, v118
    v_mfma_f32_16x16x32_bf16 v[162:165], v[86:89], v[198:201], v[162:165]
    v_exp_f32 v176, v176
    v_sub_f32 v177, v177, v118
    v_exp_f32 v177, v177
    v_sub_f32 v218, v218, v118
    v_cvt_pk_bf16_f32 v37, v176, v177
    v_mfma_f32_16x16x32_f16 v[154:157], v[114:117], v[170:173], v[74:77]
    v_exp_f32 v218, v218
    v_mfma_f32_16x16x32_f16 v[114:117], v[158:161], v[170:173], v[78:81]
    s_waitcnt lgkmcnt(1)
    v_cvt_pk_bf16_f32 v39, v218, 0
    v_fmac_f32 v254, v142, v142
    v_mfma_f32_16x16x32_bf16 v[150:153], v[122:125], v[28:31], v[150:153]
    v_fmac_f32 v254, v143, v143
    v_fmac_f32 v254, v144, v144
    v_fmac_f32 v254, v145, v145
    v_mfma_f32_16x16x16_f16 v[154:157], v[120:121], v[126:127], v[154:157]
    v_fmac_f32 v254, v134, v134
    v_fmac_f32 v254, v135, v135
    v_fmac_f32 v254, v136, v136
    v_mfma_f32_16x16x16_f16 v[114:117], v[128:129], v[126:127], v[114:117]
    v_fmac_f32 v254, v137, v137
    v_rcp_f32_dpp v151, v150 quad_perm:[0,0,0,0] row_mask:0xf bank_mask:0xf
    v_fma_f32 v150, v214, v214, s33
    v_mfma_f32_16x16x32_bf16 v[118:121], v[28:31], v[36:39], 0
    v_max3_f32 v255, v255, v154, v155
    v_max3_f32 v255, v255, v156, v157
    v_mfma_f32_16x16x32_bf16 v[118:121], v[28:31], v[226:229], v[118:121]
    v_fmac_f32 v150, v215, v215
    v_max3_f32 v255, v255, v114, v115
    v_mfma_f32_16x16x32_bf16 v[126:129], v[130:133], v[226:229], 0
    v_max3_f32 v255, v255, v116, v117
    v_mov_b32 v152, v255
    v_mfma_f32_16x16x32_bf16 v[126:129], v[166:169], v[36:39], v[126:129]
    v_fmac_f32 v150, v216, v216
    v_fmac_f32 v150, v217, v217
    v_mfma_f32_16x16x32_bf16 v[158:161], v[182:185], v[36:39], 0
    v_rcp_f32 v119, v118
    v_mfma_f32_16x16x32_bf16 v[158:161], v[138:141], v[226:229], v[158:161]
    v_permlane32_swap_b32 v255, v152
    v_mfma_f32_16x16x32_bf16 v[170:173], v[146:149], v[226:229], 0
    v_max_f32 v255, v255, v152
    v_mul_f32 v126, v119, v126
    v_mfma_f32_16x16x32_bf16 v[170:173], v[194:197], v[36:39], v[170:173]
    v_mul_f32 v127, v119, v127
    v_cvt_pk_bf16_f32 v126, v126, v127
    v_mfma_f32_16x16x32_bf16 v[218:221], v[122:125], v[166:169], 0
    v_mul_f32 v128, v119, v128
    v_mul_f32 v129, v119, v129
    v_mfma_f32_16x16x32_bf16 v[218:221], v[186:189], v[130:133], v[218:221]
    v_cvt_pk_bf16_f32 v127, v128, v129
    v_mul_f32 v158, v119, v158
    v_mfma_f32_16x16x32_bf16 v[230:233], v[186:189], v[138:141], 0
    v_mul_f32 v159, v119, v159
    v_cvt_pk_bf16_f32 v128, v158, v159
    v_mfma_f32_16x16x32_bf16 v[230:233], v[122:125], v[182:185], v[230:233]
    v_mul_f32 v160, v119, v160
    v_mul_f32 v161, v119, v161
    v_mfma_f32_16x16x32_bf16 v[242:245], v[122:125], v[194:197], 0
    v_cvt_pk_bf16_f32 v129, v160, v161
    v_mul_f32 v170, v119, v170
    v_mfma_f32_16x16x32_bf16 v[242:245], v[186:189], v[146:149], v[242:245]
    ds_write_b128 v3, v[126:129] offset:6144
    v_mfma_f32_16x16x32_bf16 v[174:177], a[236:239], v[198:201], 0
    v_mul_f32 v171, v119, v171
    v_cvt_pk_bf16_f32 v220, v170, v171
    v_mfma_f32_16x16x32_bf16 v[174:177], a[232:235], v[190:193], v[174:177]
    v_mul_f32 v172, v119, v172
    v_mul_f32 v173, v119, v173
    v_mfma_f32_16x16x32_bf16 v[174:177], a[228:231], v[210:213], v[174:177]
    ds_read_b128 v[118:121], v2 offset:12288
    ds_read_b128 v[122:125], v2 offset:13312
    v_mfma_f32_16x16x32_bf16 v[174:177], a[224:227], v[202:205], v[174:177]
    ds_read_b128 v[126:129], v2 offset:14336
    ds_read_b128 v[186:189], v2 offset:15360
    v_mfma_f32_16x16x32_bf16 v[174:177], a[220:223], v[206:209], v[174:177]
    v_cvt_pk_bf16_f32 v221, v172, v173
    v_mov_b32 v152, v255
    v_mfma_f32_16x16x32_bf16 v[174:177], a[216:219], v[222:225], v[174:177]
    ds_read_b128 v[190:193], v2 offset:16384
    ds_read_b128 v[198:201], v2 offset:17408
    v_permlane16_swap_b32 v255, v152
    v_max_f32 v255, v255, v152
    v_sub_f32 v238, v238, v255
    v_exp_f32 v238, v238
    v_sub_f32 v239, v239, v255
    v_exp_f32 v239, v239
    v_sub_f32 v240, v240, v255
    v_cvt_pk_bf16_f32 v202, v238, v239
    v_exp_f32 v240, v240
    v_sub_f32 v241, v241, v255
    s_waitcnt lgkmcnt(5)
    v_mfma_f32_16x16x32_bf16 v[170:173], a[216:219], v[118:121], 0
    s_waitcnt lgkmcnt(4)
    ds_write_b64 v4, v[220:221] offset:10240
    v_mfma_f32_16x16x32_bf16 v[170:173], a[220:223], v[122:125], v[170:173]
    s_waitcnt lgkmcnt(3)
    v_exp_f32 v241, v241
    v_mfma_f32_16x16x32_bf16 v[170:173], a[224:227], v[126:129], v[170:173]
    v_cvt_pk_bf16_f32 v203, v240, v241
    v_sub_f32 v154, v154, v255
    v_mfma_f32_16x16x32_bf16 v[170:173], a[228:231], v[186:189], v[170:173]
    s_waitcnt lgkmcnt(1)
    v_exp_f32 v154, v154
    v_mfma_f32_16x16x32_bf16 v[170:173], a[232:235], v[190:193], v[170:173]
    v_sub_f32 v155, v155, v255
    v_sub_f32 v156, v156, v255
    v_mfma_f32_16x16x32_bf16 v[170:173], a[236:239], v[198:201], v[170:173]
    v_exp_f32 v155, v155
    v_mfma_f32_16x16x32_bf16 v[158:161], v[86:89], v[198:201], 0
    v_cvt_pk_bf16_f32 v204, v154, v155
    v_sub_f32 v157, v157, v255
    v_mfma_f32_16x16x32_bf16 v[158:161], v[82:85], v[190:193], v[158:161]
    v_exp_f32 v156, v156
    v_mfma_f32_16x16x32_bf16 v[158:161], a[252:255], v[186:189], v[158:161]
    v_exp_f32 v157, v157
    v_mfma_f32_16x16x32_bf16 v[158:161], a[248:251], v[126:129], v[158:161]
    v_cvt_pk_bf16_f32 v205, v156, v157
    v_sub_f32 v114, v114, v255
    v_mfma_f32_16x16x32_bf16 v[158:161], a[244:247], v[122:125], v[158:161]
    v_exp_f32 v114, v114
    v_mfma_f32_16x16x32_bf16 v[158:161], a[240:243], v[118:121], v[158:161]
    v_sub_f32 v115, v115, v255
    v_sub_f32 v116, v116, v255
    v_mfma_f32_16x16x32_bf16 v[238:241], v[90:93], v[118:121], 0
    v_exp_f32 v115, v115
    v_mfma_f32_16x16x32_bf16 v[238:241], v[94:97], v[122:125], v[238:241]
    v_cvt_pk_bf16_f32 v36, v114, v115
    v_sub_f32 v117, v117, v255
    v_mfma_f32_16x16x32_bf16 v[238:241], v[98:101], v[126:129], v[238:241]
    v_exp_f32 v116, v116
    v_mfma_f32_16x16x32_bf16 v[238:241], v[102:105], v[186:189], v[238:241]
    v_exp_f32 v117, v117
    v_mfma_f32_16x16x32_bf16 v[238:241], v[106:109], v[190:193], v[238:241]
    v_cvt_pk_bf16_f32 v37, v116, v117
    v_sub_f32 v234, v234, v255
    v_mfma_f32_16x16x32_bf16 v[238:241], v[110:113], v[198:201], v[238:241]
    ds_read_b128 v[154:157], v0 offset:20480
    ds_read_b128 v[186:189], v1 offset:20480
    ds_read_b128 v[206:209], v0 offset:20608
    v_exp_f32 v234, v234
    v_fma_f32 v255, v170, v170, s33
    v_cvt_pk_bf16_f32 v39, v234, 0
    v_fmac_f32 v255, v171, v171
    v_fmac_f32 v255, v172, v172
    v_mfma_f32_16x16x32_bf16 v[114:117], v[28:31], v[36:39], 0
    ds_read_b128 v[190:193], v1 offset:20608
    ds_read_b128 v[226:229], v0 offset:20736
    v_mfma_f32_16x16x32_bf16 v[114:117], v[28:31], v[202:205], v[114:117]
    ds_read_b128 v[234:237], v1 offset:20736
    v_fmac_f32 v255, v173, v173
    v_mfma_f32_16x16x32_bf16 v[118:121], v[130:133], v[202:205], 0
    v_fmac_f32 v255, v158, v158
    v_fmac_f32 v255, v159, v159
    v_mfma_f32_16x16x32_bf16 v[118:121], v[166:169], v[36:39], v[118:121]
    v_fmac_f32 v255, v160, v160
    v_fmac_f32 v255, v161, v161
    v_mfma_f32_16x16x32_bf16 v[126:129], v[182:185], v[36:39], 0
    v_rcp_f32 v115, v114
    v_mfma_f32_16x16x32_bf16 v[126:129], v[138:141], v[202:205], v[126:129]
    s_waitcnt lgkmcnt(3)
    v_fmac_f32 v255, v238, v238
    v_fmac_f32 v255, v239, v239
    v_mfma_f32_16x16x32_bf16 v[130:133], v[146:149], v[202:205], 0
    v_mul_f32 v118, v115, v118
    v_mul_f32 v119, v115, v119
    v_mfma_f32_16x16x32_bf16 v[130:133], v[194:197], v[36:39], v[130:133]
    v_cvt_pk_bf16_f32 v118, v118, v119
    v_mul_f32 v120, v115, v120
    v_mfma_f32_16x16x32_bf16 v[122:125], a[72:75], v[154:157], 0
    s_waitcnt lgkmcnt(1)
    v_mul_f32 v121, v115, v121
    v_cvt_pk_bf16_f32 v119, v120, v121
    v_mfma_f32_16x16x32_bf16 v[122:125], a[76:79], v[186:189], v[122:125]
    s_waitcnt lgkmcnt(0)
    v_mul_f32 v126, v115, v126
    v_mul_f32 v127, v115, v127
    v_mfma_f32_16x16x32_bf16 v[122:125], a[80:83], v[206:209], v[122:125]
    v_cvt_pk_bf16_f32 v120, v126, v127
    v_mul_f32 v128, v115, v128
    v_mfma_f32_16x16x32_bf16 v[122:125], a[84:87], v[190:193], v[122:125]
    v_mul_f32 v129, v115, v129
    v_cvt_pk_bf16_f32 v121, v128, v129
    v_mfma_f32_16x16x32_bf16 v[122:125], a[88:91], v[226:229], v[122:125]
    ds_write_b128 v3, v[118:121] offset:12288
    v_mfma_f32_16x16x32_bf16 v[122:125], a[92:95], v[234:237], v[122:125]
    v_mul_f32 v130, v115, v130
    v_mul_f32 v131, v115, v131
    v_mfma_f32_16x16x32_bf16 v[126:129], a[116:119], v[234:237], 0
    v_cvt_pk_bf16_f32 v152, v130, v131
    v_mul_f32 v132, v115, v132
    v_mfma_f32_16x16x32_bf16 v[126:129], a[112:115], v[226:229], v[126:129]
    v_mul_f32 v133, v115, v133
    v_cvt_pk_bf16_f32 v153, v132, v133
    v_mfma_f32_16x16x32_bf16 v[126:129], a[108:111], v[190:193], v[126:129]
    ds_write_b64 v4, v[152:153] offset:16384
    v_mfma_f32_16x16x32_bf16 v[126:129], a[104:107], v[206:209], v[126:129]
    v_fmac_f32 v255, v240, v240
    v_fmac_f32 v255, v241, v241
    v_mfma_f32_16x16x32_bf16 v[126:129], a[100:103], v[186:189], v[126:129]
    v_cvt_pk_bf16_f32 v255, v255, v255
    v_mul_f32 v218, v218, v151
    v_mfma_f32_16x16x32_bf16 v[126:129], a[96:99], v[154:157], v[126:129]
    v_fmac_f32 v150, v162, v162
    v_mul_f32_dpp v218, v230, v151 quad_perm:[0,1,2,3] row_mask:0x2 bank_mask:0xf
    v_mfma_f32_16x16x32_bf16 v[146:149], a[120:123], v[154:157], 0
    v_fmac_f32 v150, v163, v163
    v_mul_f32_dpp v218, v242, v151 quad_perm:[0,1,2,3] row_mask:0x4 bank_mask:0xf
    v_mfma_f32_16x16x32_bf16 v[146:149], a[124:127], v[186:189], v[146:149]
    v_cvt_pk_bf16_f32 v218, v218, v218
    v_fmac_f32 v150, v164, v164
    v_mfma_f32_16x16x32_bf16 v[146:149], a[128:131], v[206:209], v[146:149]
    ds_write_b16 v7, v218
    v_mfma_f32_16x16x32_bf16 v[146:149], a[132:135], v[190:193], v[146:149]
    v_fmac_f32 v150, v165, v165
    v_fmac_f32 v150, v174, v174
    v_mfma_f32_16x16x32_bf16 v[146:149], a[136:139], v[226:229], v[146:149]
    v_fmac_f32 v150, v175, v175
    v_fmac_f32 v150, v176, v176
    v_mfma_f32_16x16x32_bf16 v[146:149], a[140:143], v[234:237], v[146:149]
    v_fmac_f32 v150, v177, v177
    v_cvt_pk_bf16_f32 v254, v254, v150
    v_mfma_f32_16x16x32_bf16 v[114:117], a[20:23], v[234:237], 0
    ds_write_b64 v4, v[254:255] offset:18432
    v_mfma_f32_16x16x32_bf16 v[114:117], a[16:19], v[226:229], v[114:117]
    v_fma_f32 v150, v122, v122, s32
    v_fmac_f32 v150, v123, v123
    v_mfma_f32_16x16x32_bf16 v[114:117], a[12:15], v[190:193], v[114:117]
    v_fmac_f32 v150, v124, v124
    v_fmac_f32 v150, v125, v125
    v_mfma_f32_16x16x32_bf16 v[114:117], a[8:11], v[206:209], v[114:117]
    v_xor_b32 v2, 65536, v2
    v_xor_b32 v3, 65536, v3
    v_mfma_f32_16x16x32_bf16 v[114:117], a[4:7], v[186:189], v[114:117]
    v_xor_b32 v4, 65536, v4
    v_add_u32 v5, s74, v5
    v_mfma_f32_16x16x32_bf16 v[114:117], a[0:3], v[154:157], v[114:117]
    v_add_u32 v6, s75, v6
    v_add_u32 v7, s76, v7
    v_mfma_f32_16x16x32_bf16 v[118:121], a[24:27], v[154:157], 0
    v_mfma_f32_16x16x32_bf16 v[118:121], a[28:31], v[186:189], v[118:121]
    s_waitcnt lgkmcnt(0)
    v_mfma_f32_16x16x32_bf16 v[118:121], a[32:35], v[206:209], v[118:121]
    s_barrier
    v_mfma_f32_16x16x32_bf16 v[118:121], a[36:39], v[190:193], v[118:121]
    v_mfma_f32_16x16x32_bf16 v[118:121], a[40:43], v[226:229], v[118:121]
    v_mfma_f32_16x16x32_bf16 v[118:121], a[44:47], v[234:237], v[118:121]
    s_cbranch_scc1 L_LOOP
    v_mfma_f32_16x16x32_bf16 v[130:133], a[68:71], v[234:237], 0
    s_mov_b32 s12, s40
    ds_read_b128 v[138:141], v2 offset:18432
    ds_read_b128 v[166:169], v2 offset:19456
    v_mfma_f32_16x16x32_bf16 v[130:133], a[64:67], v[226:229], v[130:133]
    s_mov_b32 s13, s41
    v_fmac_f32 v150, v126, v126
    v_fmac_f32 v150, v127, v127
    v_mfma_f32_16x16x32_bf16 v[130:133], a[60:63], v[190:193], v[130:133]
    s_mov_b32 s14, s36
    v_fmac_f32 v150, v128, v128
    v_fmac_f32 v150, v129, v129
    v_mfma_f32_16x16x32_bf16 v[130:133], a[56:59], v[206:209], v[130:133]
    s_add_u32 s48, s40, s27
    v_fmac_f32 v150, v146, v146
    v_fmac_f32 v150, v147, v147
    v_mfma_f32_16x16x32_bf16 v[130:133], a[52:55], v[186:189], v[130:133]
    s_addc_u32 s49, s41, 0
    v_fmac_f32 v150, v148, v148
    v_fmac_f32 v150, v149, v149
    v_mfma_f32_16x16x32_bf16 v[130:133], a[48:51], v[154:157], v[130:133]
    s_sub_u32 s50, s36, s27
    v_fma_f32 v254, v114, v114, s32
    v_fmac_f32 v254, v115, v115
    v_mfma_f32_16x16x32_bf16 v[182:185], v[154:157], a[144:147], 0
    s_mov_b32 s51, 0x00020000
    v_fmac_f32 v254, v116, v116
    v_fmac_f32 v254, v117, v117
    v_mfma_f32_16x16x32_bf16 v[182:185], v[186:189], a[148:151], v[182:185]
    s_add_u32 s52, s40, s26
    v_fmac_f32 v254, v118, v118
    v_fmac_f32 v254, v119, v119
    v_mfma_f32_16x16x32_bf16 v[182:185], v[206:209], a[152:155], v[182:185]
    s_waitcnt lgkmcnt(0)
    v_fmac_f32 v254, v120, v120
    v_fmac_f32 v254, v121, v121
    v_mfma_f32_16x16x32_bf16 v[194:197], v[32:35], v[138:141], 0
    s_addc_u32 s53, s41, 0
    v_fmac_f32 v254, v130, v130
    v_fmac_f32 v254, v131, v131
    v_mfma_f32_16x16x32_bf16 v[194:197], v[32:35], v[166:169], v[194:197]
    s_sub_u32 s54, s36, s26
    v_fmac_f32 v254, v132, v132
    v_fmac_f32 v254, v133, v133
    v_mfma_f32_16x16x32_bf16 v[182:185], v[190:193], a[156:159], v[182:185]
    s_mov_b32 s55, 0x00020000
    v_cvt_pk_bf16_f32 v36, v254, v150
    v_bfe_u32 v254, v2, 4, 6
    v_mfma_f32_16x16x32_bf16 v[182:185], v[226:229], a[160:163], v[182:185]
    s_add_u32 s56, s40, s25
    v_mul_f32 v255, 0x3baaaaab, v194
    v_mul_f32 v194, 0x3baaaaab, v196
    v_mfma_f32_16x16x32_bf16 v[138:141], v[32:35], v[36:39], 0
    s_addc_u32 s57, s41, 0
    v_rsq_f32 v255, v255
    v_mfma_f32_16x16x32_bf16 v[182:185], v[234:237], a[164:167], v[182:185]
    s_sub_u32 s58, s36, s25
    v_mul_f32 v178, v255, v178
    v_mul_f32 v179, v255, v179
    v_mfma_f32_16x16x32_bf16 v[150:153], v[234:237], a[188:191], 0
    s_mov_b32 s59, 0x00020000
    v_cvt_pk_bf16_f32 v166, v178, v179
    v_mul_f32 v180, v255, v180
    v_mfma_f32_16x16x32_bf16 v[150:153], v[226:229], a[184:187], v[150:153]
    s_and_b32 s6, s2, 7
    v_mul_f32 v181, v255, v181
    v_cvt_pk_bf16_f32 v167, v180, v181
    v_mfma_f32_16x16x32_bf16 v[150:153], v[190:193], a[180:183], v[150:153]
    s_sub_u32 s6, 0, s6
    ds_read_b128 v[178:181], v0 offset:26624
    v_mul_f32 v142, v255, v142
    v_mfma_f32_16x16x32_bf16 v[150:153], v[206:209], a[176:179], v[150:153]
    s_lshl_b32 s3, s16, 6
    ds_read_b128 v[198:201], v1 offset:26624
    v_mul_f32 v143, v255, v143
    v_mfma_f32_16x16x32_bf16 v[150:153], v[186:189], a[172:175], v[150:153]
    s_lshl_b32 s4, s16, 5
    ds_read_b128 v[202:205], v0 offset:26752
    v_cvt_pk_bf16_f32 v168, v142, v143
    v_mfma_f32_16x16x32_bf16 v[150:153], v[154:157], a[168:171], v[150:153]
    s_add_u32 s4, s4, 256
    ds_read_b128 v[210:213], v1 offset:26752
    v_mul_f32 v144, v255, v144
    v_mfma_f32_16x16x32_bf16 v[218:221], v[154:157], a[192:195], 0
    s_mul_i32 s5, s16, 9408
    ds_read_b128 v[154:157], v0 offset:26880
    v_mul_f32 v145, v255, v145
    v_mfma_f32_16x16x32_bf16 v[218:221], v[186:189], a[196:199], v[218:221]
    s_add_u32 s5, s5, 104448
    ds_read_b128 v[186:189], v1 offset:26880
    v_cvt_pk_bf16_f32 v169, v144, v145
    v_mfma_f32_16x16x32_bf16 v[218:221], v[206:209], a[200:203], v[218:221]
    buffer_store_dwordx4 v[166:169], v15, s[48:51], 0 offen nt
    v_mul_f32 v134, v255, v134
    v_mul_f32 v135, v255, v135
    v_cvt_pk_bf16_f32 v196, v134, v135
    v_mul_f32 v136, v255, v136
    v_mfma_f32_16x16x32_bf16 v[218:221], v[190:193], a[204:207], v[218:221]
    s_waitcnt lgkmcnt(5)
    v_mul_f32 v137, v255, v137
    v_cvt_pk_bf16_f32 v197, v136, v137
    v_mfma_f32_16x16x32_bf16 v[218:221], v[226:229], a[208:211], v[218:221]
    s_waitcnt lgkmcnt(4)
    v_rsq_f32 v139, v139
    v_mfma_f32_16x16x32_bf16 v[218:221], v[234:237], a[212:215], v[218:221]
    s_waitcnt lgkmcnt(3)
    v_rsq_f32 v138, v138
    v_mfma_f32_16x16x32_bf16 v[134:137], a[72:75], v[178:181], 0
    s_waitcnt lgkmcnt(2)
    v_mul_f32 v138, s31, v138
    v_cvt_pk_bf16_f32 v142, v182, v183
    v_mfma_f32_16x16x32_bf16 v[134:137], a[76:79], v[198:201], v[134:137]
    s_waitcnt lgkmcnt(1)
    v_cvt_pk_bf16_f32 v143, v184, v185
    v_cvt_pk_bf16_f32 v150, v150, v151
    v_mfma_f32_16x16x32_bf16 v[134:137], a[80:83], v[202:205], v[134:137]
    s_waitcnt lgkmcnt(0)
    v_cvt_pk_bf16_f32 v151, v152, v153
    v_cvt_pk_bf16_f32 v166, v218, v219
    v_mfma_f32_16x16x32_bf16 v[134:137], a[84:87], v[210:213], v[134:137]
    v_cvt_pk_bf16_f32 v167, v220, v221
    v_mul_f32 v122, v139, v122
    v_mfma_f32_16x16x32_bf16 v[134:137], a[88:91], v[154:157], v[134:137]
    v_mul_f32 v123, v139, v123
    v_cvt_pk_f16_f32 v122, v122, v123
    v_mfma_f32_16x16x32_bf16 v[134:137], a[92:95], v[186:189], v[134:137]
    v_mul_f32 v124, v139, v124
    v_mul_f32 v125, v139, v125
    v_mfma_f32_16x16x32_bf16 v[182:185], a[116:119], v[186:189], 0
    v_cvt_pk_f16_f32 v123, v124, v125
    v_mul_f32 v126, v139, v126
    v_mfma_f32_16x16x32_bf16 v[182:185], a[112:115], v[154:157], v[182:185]
    v_mul_f32 v127, v139, v127
    v_cvt_pk_f16_f32 v124, v126, v127
    v_mfma_f32_16x16x32_bf16 v[182:185], a[108:111], v[210:213], v[182:185]
    v_mul_f32 v128, v139, v128
    v_mul_f32 v129, v139, v129
    v_mfma_f32_16x16x32_bf16 v[182:185], a[104:107], v[202:205], v[182:185]
    v_cvt_pk_f16_f32 v125, v128, v129
    v_mul_f32 v146, v139, v146
    v_mfma_f32_16x16x32_bf16 v[182:185], a[100:103], v[198:201], v[182:185]
    v_mul_f32 v147, v139, v147
    v_cvt_pk_f16_f32 v128, v146, v147
    v_mfma_f32_16x16x32_bf16 v[182:185], a[96:99], v[178:181], v[182:185]
    v_mul_f32 v148, v139, v148
    v_mul_f32 v149, v139, v149
    v_mfma_f32_16x16x32_bf16 v[190:193], a[120:123], v[178:181], 0
    buffer_store_dwordx2 v[196:197], v18, s[48:51], 0 offen nt
    v_cvt_pk_f16_f32 v129, v148, v149
    v_mul_f32 v114, v138, v114
    v_mfma_f32_16x16x32_bf16 v[190:193], a[124:127], v[198:201], v[190:193]
    v_mul_f32 v115, v138, v115
    v_cvt_pk_f16_f32 v114, v114, v115
    v_mfma_f32_16x16x32_bf16 v[190:193], a[128:131], v[202:205], v[190:193]
    v_mul_f32 v116, v138, v116
    v_mul_f32 v117, v138, v117
    v_mfma_f32_16x16x32_bf16 v[190:193], a[132:135], v[210:213], v[190:193]
    v_cvt_pk_f16_f32 v115, v116, v117
    v_mul_f32 v118, v138, v118
    v_mfma_f32_16x16x32_bf16 v[190:193], a[136:139], v[154:157], v[190:193]
    ds_read_b128 v[146:149], v2 offset:0
    ds_read_b128 v[206:209], v2 offset:1024
    v_mfma_f32_16x16x32_bf16 v[190:193], a[140:143], v[186:189], v[190:193]
    ds_read_b128 v[218:221], v2 offset:2048
    ds_read_b128 v[222:225], v2 offset:3072
    v_mfma_f32_16x16x32_bf16 v[226:229], a[20:23], v[186:189], 0
    v_mul_f32 v119, v138, v119
    v_cvt_pk_f16_f32 v116, v118, v119
    v_mfma_f32_16x16x32_bf16 v[226:229], a[16:19], v[154:157], v[226:229]
    ds_read_b128 v[230:233], v2 offset:4096
    ds_read_b128 v[234:237], v2 offset:5120
    v_mfma_f32_16x16x32_bf16 v[226:229], a[12:15], v[210:213], v[226:229]
    v_mul_f32 v120, v138, v120
    v_mul_f32 v121, v138, v121
    v_mfma_f32_16x16x32_bf16 v[226:229], a[8:11], v[202:205], v[226:229]
    v_cvt_pk_f16_f32 v117, v120, v121
    v_mul_f32 v130, v138, v130
    v_mfma_f32_16x16x32_bf16 v[226:229], a[4:7], v[198:201], v[226:229]
    v_mul_f32 v131, v138, v131
    v_cvt_pk_f16_f32 v126, v130, v131
    v_mfma_f32_16x16x32_bf16 v[226:229], a[0:3], v[178:181], v[226:229]
    v_mul_f32 v132, v138, v132
    v_mul_f32 v133, v138, v133
    v_mfma_f32_16x16x32_bf16 v[118:121], a[24:27], v[178:181], 0
    s_waitcnt lgkmcnt(4)
    v_cvt_pk_f16_f32 v127, v132, v133
    v_mul_f32 v255, 0x3baaaaab, v195
    v_mfma_f32_16x16x32_bf16 v[130:133], a[216:219], v[146:149], 0
    s_waitcnt lgkmcnt(2)
    v_rsq_f32 v194, v194
    v_mfma_f32_16x16x32_bf16 v[130:133], a[220:223], v[206:209], v[130:133]
    v_mul_f32 v170, v194, v170
    v_mul_f32 v171, v194, v171
    v_mfma_f32_16x16x32_bf16 v[130:133], a[224:227], v[218:221], v[130:133]
    s_waitcnt lgkmcnt(0)
    v_cvt_pk_bf16_f32 v138, v170, v171
    v_mul_f32 v172, v194, v172
    v_mfma_f32_16x16x32_bf16 v[130:133], a[228:231], v[222:225], v[130:133]
    v_mul_f32 v173, v194, v173
    v_cvt_pk_bf16_f32 v139, v172, v173
    v_mfma_f32_16x16x32_bf16 v[130:133], a[232:235], v[230:233], v[130:133]
    v_mul_f32 v158, v194, v158
    v_mul_f32 v159, v194, v159
    v_mfma_f32_16x16x32_bf16 v[130:133], a[236:239], v[234:237], v[130:133]
    v_cvt_pk_bf16_f32 v140, v158, v159
    v_mul_f32 v160, v194, v160
    v_mfma_f32_16x16x32_bf16 v[170:173], v[86:89], v[234:237], 0
    v_mul_f32 v161, v194, v161
    v_cvt_pk_bf16_f32 v141, v160, v161
    v_mfma_f32_16x16x32_bf16 v[170:173], v[82:85], v[230:233], v[170:173]
    ds_read_b128 v[158:161], v2 offset:11264
    buffer_store_dwordx4 v[138:141], v17, s[48:51], 0 offen nt
    v_fma_f32 v144, v130, v130, s33
    v_fmac_f32 v144, v131, v131
    v_fmac_f32 v144, v132, v132
    v_fmac_f32 v144, v133, v133
    v_mfma_f32_16x16x32_bf16 v[170:173], a[252:255], v[222:225], v[170:173]
    ds_read_b128 v[138:141], v2 offset:10240
    v_mul_f32 v238, v194, v238
    v_mfma_f32_16x16x32_bf16 v[170:173], a[248:251], v[218:221], v[170:173]
    ds_read_b128 v[242:245], v2 offset:9216
    v_mul_f32 v239, v194, v239
    v_mfma_f32_16x16x32_bf16 v[170:173], a[244:247], v[206:209], v[170:173]
    v_cvt_pk_bf16_f32 v152, v238, v239
    v_mul_f32 v240, v194, v240
    v_mfma_f32_16x16x32_bf16 v[170:173], a[240:243], v[146:149], v[170:173]
    v_mul_f32 v241, v194, v241
    v_cvt_pk_bf16_f32 v153, v240, v241
    v_mfma_f32_16x16x32_bf16 v[194:197], v[90:93], v[146:149], 0
    ds_read_b128 v[146:149], v2 offset:8192
    v_fma_f32 v145, v226, v226, s32
    v_mfma_f32_16x16x32_bf16 v[194:197], v[94:97], v[206:209], v[194:197]
    ds_read_b128 v[206:209], v2 offset:7168
    v_fmac_f32 v145, v227, v227
    v_mfma_f32_16x16x32_bf16 v[194:197], v[98:101], v[218:221], v[194:197]
    s_waitcnt lgkmcnt(4)
    ds_read_b128 v[218:221], v2 offset:6144
    v_fmac_f32 v144, v170, v170
    v_mfma_f32_16x16x32_bf16 v[194:197], v[102:105], v[222:225], v[194:197]
    v_fmac_f32 v144, v171, v171
    v_fmac_f32 v144, v172, v172
    v_mfma_f32_16x16x32_bf16 v[194:197], v[106:109], v[230:233], v[194:197]
    s_waitcnt lgkmcnt(4)
    v_fmac_f32 v144, v173, v173
    v_fmac_f32 v145, v228, v228
    v_mfma_f32_16x16x32_bf16 v[194:197], v[110:113], v[234:237], v[194:197]
    s_waitcnt lgkmcnt(3)
    v_rsq_f32 v255, v255
    v_mfma_f32_16x16x32_bf16 v[222:225], v[110:113], v[158:161], 0
    v_mul_f32 v174, v255, v174
    v_mul_f32 v175, v255, v175
    v_mfma_f32_16x16x32_bf16 v[222:225], v[106:109], v[138:141], v[222:225]
    v_cvt_pk_bf16_f32 v174, v174, v175
    v_mul_f32 v176, v255, v176
    v_mfma_f32_16x16x32_bf16 v[222:225], v[102:105], v[242:245], v[222:225]
    s_waitcnt lgkmcnt(2)
    v_fmac_f32 v144, v194, v194
    v_fmac_f32 v144, v195, v195
    v_mfma_f32_16x16x32_bf16 v[222:225], v[98:101], v[146:149], v[222:225]
    s_waitcnt lgkmcnt(1)
    v_fmac_f32 v144, v196, v196
    v_fmac_f32 v144, v197, v197
    v_mfma_f32_16x16x32_bf16 v[222:225], v[94:97], v[206:209], v[222:225]
    s_waitcnt lgkmcnt(0)
    v_mul_f32 v177, v255, v177
    v_cvt_pk_bf16_f32 v175, v176, v177
    v_mfma_f32_16x16x32_bf16 v[222:225], v[90:93], v[218:221], v[222:225]
    buffer_store_dwordx2 v[152:153], v20, s[48:51], 0 offen nt
    v_mul_f32 v162, v255, v162
    v_mul_f32 v163, v255, v163
    v_mfma_f32_16x16x32_bf16 v[230:233], a[240:243], v[218:221], 0
    v_cvt_pk_bf16_f32 v176, v162, v163
    v_mul_f32 v164, v255, v164
    v_mfma_f32_16x16x32_bf16 v[230:233], a[244:247], v[206:209], v[230:233]
    v_mul_f32 v165, v255, v165
    v_fma_f32 v152, v222, v222, s33
    v_mfma_f32_16x16x32_bf16 v[230:233], a[248:251], v[146:149], v[230:233]
    v_fmac_f32 v152, v223, v223
    v_fmac_f32 v152, v224, v224
    v_mfma_f32_16x16x32_bf16 v[230:233], a[252:255], v[242:245], v[230:233]
    v_fmac_f32 v152, v225, v225
    v_cvt_pk_bf16_f32 v177, v164, v165
    v_mfma_f32_16x16x32_bf16 v[230:233], v[82:85], v[138:141], v[230:233]
    v_mul_f32 v214, v255, v214
    v_mul_f32 v215, v255, v215
    v_mfma_f32_16x16x32_bf16 v[230:233], v[86:89], v[158:161], v[230:233]
    v_cvt_pk_bf16_f32 v168, v214, v215
    v_mul_f32 v216, v255, v216
    v_mfma_f32_16x16x32_bf16 v[162:165], a[236:239], v[158:161], 0
    v_mul_f32 v217, v255, v217
    v_cvt_pk_bf16_f32 v169, v216, v217
    v_mfma_f32_16x16x32_bf16 v[162:165], a[232:235], v[138:141], v[162:165]
    v_fmac_f32 v145, v229, v229
    v_fma_f32 v255, v134, v134, s32
    v_mfma_f32_16x16x32_bf16 v[162:165], a[228:231], v[242:245], v[162:165]
    v_fmac_f32 v152, v230, v230
    v_fmac_f32 v152, v231, v231
    v_mfma_f32_16x16x32_bf16 v[162:165], a[224:227], v[146:149], v[162:165]
    v_fmac_f32 v152, v232, v232
    v_fmac_f32 v152, v233, v233
    v_mfma_f32_16x16x32_bf16 v[162:165], a[220:223], v[206:209], v[162:165]
    v_fmac_f32 v255, v135, v135
    v_fmac_f32 v255, v136, v136
    v_mfma_f32_16x16x32_bf16 v[162:165], a[216:219], v[218:221], v[162:165]
    v_fmac_f32 v255, v137, v137
    v_fmac_f32 v255, v182, v182
    v_mfma_f32_16x16x32_bf16 v[118:121], a[28:31], v[198:201], v[118:121]
    v_fmac_f32 v255, v183, v183
    v_fmac_f32 v255, v184, v184
    v_mfma_f32_16x16x32_bf16 v[118:121], a[32:35], v[202:205], v[118:121]
    v_fmac_f32 v255, v185, v185
    v_fmac_f32 v255, v190, v190
    v_mfma_f32_16x16x32_bf16 v[118:121], a[36:39], v[210:213], v[118:121]
    v_fmac_f32 v152, v162, v162
    v_fmac_f32 v152, v163, v163
    v_mfma_f32_16x16x32_bf16 v[118:121], a[40:43], v[154:157], v[118:121]
    buffer_store_dwordx4 v[174:177], v16, s[48:51], 0 offen nt
    v_fmac_f32 v152, v164, v164
    v_fmac_f32 v152, v165, v165
    v_cvt_pk_bf16_f32 v138, v144, v152
    v_cvt_pk_bf16_f32 v139, v152, v152
    v_mfma_f32_16x16x32_bf16 v[118:121], a[44:47], v[186:189], v[118:121]
    v_fmac_f32 v255, v191, v191
    v_fmac_f32 v255, v192, v192
    v_mfma_f32_16x16x32_bf16 v[146:149], a[68:71], v[186:189], 0
    v_fmac_f32 v255, v193, v193
    v_lshrrev_b32 v140, 4, v254
    v_mfma_f32_16x16x32_bf16 v[146:149], a[64:67], v[154:157], v[146:149]
    v_and_b32 v141, 15, v254
    v_lshlrev_b32 v158, 9, v140
    v_mfma_f32_16x16x32_bf16 v[146:149], a[60:63], v[210:213], v[146:149]
    v_fmac_f32 v145, v118, v118
    v_fmac_f32 v145, v119, v119
    v_mfma_f32_16x16x32_bf16 v[146:149], a[56:59], v[202:205], v[146:149]
    v_fmac_f32 v145, v120, v120
    v_fmac_f32 v145, v121, v121
    v_mfma_f32_16x16x32_bf16 v[146:149], a[52:55], v[198:201], v[146:149]
    v_lshl_add_u32 v158, v141, 4, v158
    v_add_u32 v158, 149696, v158
    v_mfma_f32_16x16x32_bf16 v[146:149], a[48:51], v[178:181], v[146:149]
    v_and_b32 v159, 0xffff, v2
    v_add_u32 v159, 38912, v159
    v_mfma_f32_16x16x32_bf16 v[174:177], v[178:181], a[144:147], 0
    v_and_b32 v160, 0xffff, v4
    v_add_u32 v160, 38912, v160
    v_mfma_f32_16x16x32_bf16 v[174:177], v[198:201], a[148:151], v[174:177]
    ds_write_b64 v160, v[138:139] offset:0
    v_mfma_f32_16x16x32_bf16 v[174:177], v[202:205], a[152:155], v[174:177]
    v_fmac_f32 v145, v146, v146
    v_fmac_f32 v145, v147, v147
    v_mfma_f32_16x16x32_bf16 v[174:177], v[210:213], a[156:159], v[174:177]
    v_fmac_f32 v145, v148, v148
    v_fmac_f32 v145, v149, v149
    v_mfma_f32_16x16x32_bf16 v[174:177], v[154:157], a[160:163], v[174:177]
    v_cvt_pk_bf16_f32 v36, v145, v255
    v_sub_u32 v161, 0x40800000, v44
    v_mfma_f32_16x16x32_bf16 v[174:177], v[186:189], a[164:167], v[174:177]
    v_or_b32 v161, v161, v44
    v_mov_b32 v255, 0x40000000
    v_mfma_f32_16x16x32_bf16 v[206:209], v[32:35], v[36:39], 0
    v_add_u32 v138, 0, v141
    v_mul_u32_u24 v139, s20, v138
    v_mfma_f32_16x16x32_bf16 v[214:217], v[186:189], a[188:191], 0
    buffer_store_dwordx2 v[168:169], v19, s[48:51], 0 offen nt
    v_add_u32 v139, s38, v139
    v_cvt_pk_bf16_f32 v144, v174, v175
    v_mfma_f32_16x16x32_bf16 v[214:217], v[154:157], a[184:187], v[214:217]
    s_waitcnt lgkmcnt(0)
    v_cvt_pk_bf16_f32 v145, v176, v177
    v_mul_u32_u24 v208, 911, v139
    v_mfma_f32_16x16x32_bf16 v[214:217], v[210:213], a[180:183], v[214:217]
    s_barrier
    ds_read_b128 v[174:177], v159 offset:0
    ds_read_b128 v[218:221], v159 offset:1024
    v_mfma_f32_16x16x32_bf16 v[214:217], v[202:205], a[176:179], v[214:217]
    ds_read_b128 v[234:237], v0 offset:32768
    ds_read_b128 v[238:241], v1 offset:32768
    v_mfma_f32_16x16x32_bf16 v[214:217], v[198:201], a[172:175], v[214:217]
    v_rsq_f32 v207, v207
    v_mfma_f32_16x16x32_bf16 v[214:217], v[178:181], a[168:171], v[214:217]
    ds_read_b128 v[242:245], v0 offset:32896
    v_rsq_f32 v206, v206
    v_mul_f32 v134, v207, v134
    v_mul_f32 v206, s31, v206
    v_mul_f32 v135, v207, v135
    v_cvt_pk_f16_f32 v134, v134, v135
    v_mul_f32 v136, v207, v136
    v_mul_f32 v137, v207, v137
    v_cvt_pk_bf16_f32 v152, v214, v215
    v_cvt_pk_bf16_f32 v153, v216, v217
    v_cvt_pk_f16_f32 v135, v136, v137
    v_mfma_f32_16x16x32_bf16 v[214:217], v[178:181], a[192:195], 0
    ds_read_b128 v[178:181], v1 offset:32896
    v_mul_f32 v182, v207, v182
    v_mfma_f32_16x16x32_bf16 v[214:217], v[198:201], a[196:199], v[214:217]
    s_waitcnt lgkmcnt(4)
    ds_read_b128 v[198:201], v0 offset:33024
    v_mul_f32 v183, v207, v183
    v_mfma_f32_16x16x32_bf16 v[214:217], v[202:205], a[200:203], v[214:217]
    s_waitcnt lgkmcnt(3)
    ds_read_b128 v[202:205], v1 offset:33024
    v_cvt_pk_f16_f32 v136, v182, v183
    v_mfma_f32_16x16x32_bf16 v[214:217], v[210:213], a[204:207], v[214:217]
    v_mul_f32 v184, v207, v184
    v_mul_f32 v185, v207, v185
    v_mfma_f32_16x16x32_bf16 v[210:213], v[32:35], v[174:177], 0
    s_waitcnt lgkmcnt(3)
    v_cvt_pk_f16_f32 v137, v184, v185
    v_mul_f32 v190, v207, v190
    v_mfma_f32_16x16x32_bf16 v[210:213], v[32:35], v[218:221], v[210:213]
    v_mul_f32 v191, v207, v191
    v_cvt_pk_f16_f32 v176, v190, v191
    v_mfma_f32_16x16x32_bf16 v[214:217], v[154:157], a[208:211], v[214:217]
    v_mul_f32 v192, v207, v192
    v_mul_f32 v193, v207, v193
    v_mfma_f32_16x16x32_bf16 v[214:217], v[186:189], a[212:215], v[214:217]
    v_cvt_pk_f16_f32 v177, v192, v193
    v_mul_f32 v226, v206, v226
    v_mfma_f32_16x16x32_bf16 v[154:157], a[72:75], v[234:237], 0
    s_waitcnt lgkmcnt(2)
    v_mul_f32 v139, 0x3baaaaab, v210
    v_mul_f32 v227, v206, v227
    v_mfma_f32_16x16x32_bf16 v[154:157], a[76:79], v[238:241], v[154:157]
    s_waitcnt lgkmcnt(1)
    v_rsq_f32 v139, v139
    v_mfma_f32_16x16x32_bf16 v[154:157], a[80:83], v[242:245], v[154:157]
    s_waitcnt lgkmcnt(0)
    v_mul_f32 v130, v139, v130
    v_mul_f32 v131, v139, v131
    v_mfma_f32_16x16x32_bf16 v[154:157], a[84:87], v[178:181], v[154:157]
    v_cvt_pk_bf16_f32 v130, v130, v131
    v_mul_f32 v132, v139, v132
    v_mfma_f32_16x16x32_bf16 v[154:157], a[88:91], v[198:201], v[154:157]
    v_mul_f32 v133, v139, v133
    v_cvt_pk_bf16_f32 v131, v132, v133
    v_mfma_f32_16x16x32_bf16 v[154:157], a[92:95], v[202:205], v[154:157]
    v_mul_f32 v170, v139, v170
    v_mul_f32 v171, v139, v171
    v_mfma_f32_16x16x32_bf16 v[182:185], a[116:119], v[202:205], 0
    v_cvt_pk_bf16_f32 v132, v170, v171
    v_mul_f32 v172, v139, v172
    v_mfma_f32_16x16x32_bf16 v[182:185], a[112:115], v[198:201], v[182:185]
    v_mul_f32 v173, v139, v173
    v_cvt_pk_bf16_f32 v133, v172, v173
    v_mfma_f32_16x16x32_bf16 v[182:185], a[108:111], v[178:181], v[182:185]
    buffer_store_dwordx4 v[130:133], v15, s[52:55], 0 offen nt
    v_mul_f32 v194, v139, v194
    v_mul_f32 v195, v139, v195
    v_cvt_pk_bf16_f32 v212, v194, v195
    v_mul_f32 v196, v139, v196
    v_mfma_f32_16x16x32_bf16 v[182:185], a[104:107], v[242:245], v[182:185]
    v_mul_f32 v197, v139, v197
    v_cvt_pk_bf16_f32 v213, v196, v197
    v_mfma_f32_16x16x32_bf16 v[182:185], a[100:103], v[238:241], v[182:185]
    v_cvt_pk_bf16_f32 v168, v214, v215
    v_cvt_pk_bf16_f32 v169, v216, v217
    v_mfma_f32_16x16x32_bf16 v[182:185], a[96:99], v[234:237], v[182:185]
    v_cvt_pk_f16_f32 v130, v226, v227
    v_mul_f32 v228, v206, v228
    v_mfma_f32_16x16x32_bf16 v[170:173], a[120:123], v[234:237], 0
    v_mul_f32 v229, v206, v229
    v_cvt_pk_f16_f32 v131, v228, v229
    v_mfma_f32_16x16x32_bf16 v[170:173], a[124:127], v[238:241], v[170:173]
    v_mul_f32 v118, v206, v118
    v_mul_f32 v119, v206, v119
    v_mfma_f32_16x16x32_bf16 v[170:173], a[128:131], v[242:245], v[170:173]
    v_cvt_pk_f16_f32 v132, v118, v119
    v_mul_f32 v120, v206, v120
    v_mfma_f32_16x16x32_bf16 v[170:173], a[132:135], v[178:181], v[170:173]
    v_mul_f32 v121, v206, v121
    v_cvt_pk_f16_f32 v133, v120, v121
    v_mfma_f32_16x16x32_bf16 v[170:173], a[136:139], v[198:201], v[170:173]
    v_mul_f32 v146, v206, v146
    v_mul_f32 v147, v206, v147
    v_mfma_f32_16x16x32_bf16 v[170:173], a[140:143], v[202:205], v[170:173]
    v_cvt_pk_f16_f32 v174, v146, v147
    v_mul_f32 v148, v206, v148
    v_mfma_f32_16x16x32_bf16 v[118:121], a[20:23], v[202:205], 0
    v_mul_f32 v149, v206, v149
    v_cvt_pk_f16_f32 v175, v148, v149
    v_mfma_f32_16x16x32_bf16 v[118:121], a[16:19], v[198:201], v[118:121]
    v_fma_f32 v206, v154, v154, s32
    v_fmac_f32 v206, v155, v155
    v_mfma_f32_16x16x32_bf16 v[118:121], a[12:15], v[178:181], v[118:121]
    v_fmac_f32 v206, v156, v156
    v_fmac_f32 v206, v157, v157
    v_mfma_f32_16x16x32_bf16 v[118:121], a[8:11], v[242:245], v[118:121]
    v_fmac_f32 v206, v182, v182
    v_fmac_f32 v206, v183, v183
    v_mfma_f32_16x16x32_bf16 v[118:121], a[4:7], v[238:241], v[118:121]
    v_fmac_f32 v206, v184, v184
    v_fmac_f32 v206, v185, v185
    v_mfma_f32_16x16x32_bf16 v[118:121], a[0:3], v[234:237], v[118:121]
    v_fmac_f32 v206, v170, v170
    v_fmac_f32 v206, v171, v171
    v_mfma_f32_16x16x32_bf16 v[146:149], a[24:27], v[234:237], 0
    buffer_store_dwordx2 v[212:213], v18, s[52:55], 0 offen nt
    v_fmac_f32 v206, v172, v172
    v_fmac_f32 v206, v173, v173
    v_mfma_f32_16x16x32_f16 v[186:189], v[122:125], v[114:117], v[46:49]
    v_mul_f32 v139, 0x3baaaaab, v211
    v_fma_f32 v207, v118, v118, s32
    v_mfma_f32_16x16x32_f16 v[190:193], v[134:137], v[114:117], v[50:53]
    v_fmac_f32 v207, v119, v119
    v_fmac_f32 v207, v120, v120
    v_mfma_f32_16x16x32_bf16 v[146:149], a[28:31], v[238:241], v[146:149]
    v_fmac_f32 v207, v121, v121
    v_rsq_f32 v139, v139
    v_mfma_f32_16x16x16_f16 v[186:189], v[128:129], v[126:127], v[186:189]
    v_mul_f32 v162, v139, v162
    v_mul_f32 v163, v139, v163
    v_cvt_pk_bf16_f32 v162, v162, v163
    v_mfma_f32_16x16x16_f16 v[190:193], v[176:177], v[126:127], v[190:193]
    v_mul_f32 v164, v139, v164
    v_mul_f32 v165, v139, v165
    v_cvt_pk_bf16_f32 v163, v164, v165
    v_mul_f32 v230, v139, v230
    v_mfma_f32_16x16x32_bf16 v[146:149], a[32:35], v[242:245], v[146:149]
    v_mul_f32 v231, v139, v231
    v_cvt_pk_bf16_f32 v164, v230, v231
    v_mfma_f32_16x16x32_bf16 v[146:149], a[36:39], v[178:181], v[146:149]
    v_mul_f32 v232, v139, v232
    v_mul_f32 v233, v139, v233
    v_mfma_f32_16x16x32_bf16 v[146:149], a[40:43], v[198:201], v[146:149]
    v_cvt_pk_bf16_f32 v165, v232, v233
    v_mul_f32 v222, v139, v222
    v_mfma_f32_16x16x32_bf16 v[146:149], a[44:47], v[202:205], v[146:149]
    v_mul_f32 v223, v139, v223
    v_cvt_pk_bf16_f32 v222, v222, v223
    v_mfma_f32_16x16x32_bf16 v[194:197], a[68:71], v[202:205], 0
    v_mul_f32 v224, v139, v224
    v_mul_f32 v225, v139, v225
    v_mfma_f32_16x16x32_bf16 v[194:197], a[64:67], v[198:201], v[194:197]
    v_cvt_pk_bf16_f32 v223, v224, v225
    v_lshrrev_b32 v208, 16, v208
    v_mfma_f32_16x16x32_bf16 v[194:197], a[60:63], v[178:181], v[194:197]
    v_fmac_f32 v207, v146, v146
    v_fmac_f32 v207, v147, v147
    v_mfma_f32_16x16x32_bf16 v[194:197], a[56:59], v[242:245], v[194:197]
    v_fmac_f32 v207, v148, v148
    v_fmac_f32 v207, v149, v149
    v_mfma_f32_16x16x32_bf16 v[194:197], a[52:55], v[238:241], v[194:197]
    v_mul_u32_u24 v208, s22, v208
    v_mad_u32_u24 v208, v138, s21, v208
    v_mfma_f32_16x16x32_bf16 v[194:197], a[48:51], v[234:237], v[194:197]
    v_bfe_u32 v139, s70, v138, 1
    v_cmp_ne_u32 vcc, 0, v139
    v_mfma_f32_16x16x32_bf16 v[210:213], v[234:237], a[144:147], 0
    buffer_store_dwordx4 v[162:165], v16, s[52:55], 0 offen nt
    v_add_u32 v138, s7, v208
    v_cndmask_b32 v138, v255, v138, vcc
    v_lshl_add_u32 v139, v140, 4, v138
    v_add_u32 v139, s3, v139
    v_mfma_f32_16x16x32_bf16 v[210:213], v[238:241], a[148:151], v[210:213]
    v_fmac_f32 v207, v194, v194
    v_fmac_f32 v207, v195, v195
    v_mfma_f32_16x16x32_bf16 v[210:213], v[242:245], a[152:155], v[210:213]
    v_fmac_f32 v207, v196, v196
    v_fmac_f32 v207, v197, v197
    v_mfma_f32_16x16x32_bf16 v[210:213], v[178:181], a[156:159], v[210:213]
    v_cvt_pk_bf16_f32 v36, v207, v206
    v_lshl_add_u32 v138, v140, 3, v138
    v_mfma_f32_16x16x32_bf16 v[210:213], v[198:201], a[160:163], v[210:213]
    ds_read2_b32 v[164:165], v6 offset0:0 offset1:0
    ds_read2_b32 v[208:209], v6 offset0:16 offset1:16
    v_mfma_f32_16x16x32_bf16 v[214:217], v[32:35], v[36:39], 0
    ds_read2_b32 v[220:221], v6 offset0:32 offset1:32
    v_add_u32 v138, s4, v138
    v_mfma_f32_16x16x32_bf16 v[210:213], v[202:205], a[164:167], v[210:213]
    v_xor_b32 v224, 65536, v2
    v_lshl_add_u32 v225, s16, 2, v224
    v_mfma_f32_16x16x32_bf16 v[226:229], v[202:205], a[188:191], 0
    ds_read_b128 v[230:233], v5 offset:0
    ds_read_b32 v246, v6 offset:192
    v_mfma_f32_16x16x32_bf16 v[226:229], v[198:201], a[184:187], v[226:229]
    ds_write_b32 v225, v161 offset:18432
    v_mfma_f32_16x16x32_bf16 v[226:229], v[178:181], a[180:183], v[226:229]
    v_cvt_pk_bf16_f32 v162, v210, v211
    v_cvt_pk_bf16_f32 v163, v212, v213
    v_mfma_f32_16x16x32_bf16 v[226:229], v[242:245], a[176:179], v[226:229]
    ds_read_b128 v[210:213], v2 offset:12288
    v_bfe_u32 v161, v141, 1, 2
    v_mfma_f32_16x16x32_bf16 v[226:229], v[238:241], a[172:175], v[226:229]
    v_rsq_f32 v215, v215
    v_mfma_f32_16x16x32_bf16 v[226:229], v[234:237], a[168:171], v[226:229]
    v_rsq_f32 v214, v214
    v_mul_f32 v154, v215, v154
    v_mul_f32 v214, s31, v214
    v_mul_f32 v155, v215, v155
    v_cvt_pk_f16_f32 v154, v154, v155
    v_mul_f32 v156, v215, v156
    v_mul_f32 v157, v215, v157
    v_cvt_pk_f16_f32 v155, v156, v157
    v_cvt_pk_bf16_f32 v206, v226, v227
    v_cvt_pk_bf16_f32 v207, v228, v229
    v_mfma_f32_16x16x32_bf16 v[226:229], v[234:237], a[192:195], 0
    s_waitcnt lgkmcnt(1)
    ds_read_b128 v[234:237], v2 offset:13312
    buffer_store_dwordx2 v[222:223], v19, s[52:55], 0 offen nt
    v_mul_f32 v182, v215, v182
    v_mul_f32 v183, v215, v183
    v_mfma_f32_16x16x32_bf16 v[226:229], v[238:241], a[196:199], v[226:229]
    ds_read_b128 v[238:241], v2 offset:14336
    v_cvt_pk_f16_f32 v156, v182, v183
    v_mfma_f32_16x16x32_bf16 v[226:229], v[242:245], a[200:203], v[226:229]
    s_waitcnt lgkmcnt(2)
    ds_read_b128 v[242:245], v2 offset:15360
    v_mul_f32 v184, v215, v184
    v_mfma_f32_16x16x32_bf16 v[226:229], v[178:181], a[204:207], v[226:229]
    ds_read_b128 v[178:181], v2 offset:16384
    v_mul_f32 v185, v215, v185
    v_mfma_f32_16x16x32_bf16 v[226:229], v[198:201], a[208:211], v[226:229]
    ds_read_b128 v[198:201], v2 offset:17408
    v_cvt_pk_f16_f32 v157, v184, v185
    v_mfma_f32_16x16x32_f16 v[182:185], v[230:233], v[114:117], v[22:25]
    v_mul_f32 v170, v215, v170
    v_mul_f32 v171, v215, v171
    v_mfma_f32_16x16x32_bf16 v[226:229], v[202:205], a[212:215], v[226:229]
    ds_read_b128 v[202:205], v5 offset:16
    v_cvt_pk_f16_f32 v252, v170, v171
    v_mul_f32 v172, v215, v172
    v_mul_f32 v173, v215, v173
    v_cvt_pk_f16_f32 v253, v172, v173
    v_mul_f32 v118, v214, v118
    v_mul_f32 v119, v214, v119
    v_cvt_pk_f16_f32 v118, v118, v119
    v_mfma_f32_16x16x32_f16 v[170:173], v[154:157], v[114:117], v[54:57]
    s_waitcnt lgkmcnt(4)
    ds_read_b128 v[114:117], v5 offset:48
    v_cvt_pk_bf16_f32 v218, v226, v227
    v_cvt_pk_bf16_f32 v219, v228, v229
    v_mul_f32 v120, v214, v120
    v_mul_f32 v121, v214, v121
    v_mfma_f32_16x16x16_f16 v[170:173], v[252:253], v[126:127], v[170:173]
    v_cvt_pk_f16_f32 v119, v120, v121
    v_mul_f32 v146, v214, v146
    v_mul_f32 v147, v214, v147
    v_cvt_pk_f16_f32 v120, v146, v147
    v_mfma_f32_16x16x32_f16 v[226:229], v[230:233], v[130:133], v[24:27]
    v_mul_f32 v148, v214, v148
    v_mul_f32 v149, v214, v149
    v_cvt_pk_f16_f32 v121, v148, v149
    v_mul_f32 v194, v214, v194
    v_mul_f32 v195, v214, v195
    v_cvt_pk_f16_f32 v250, v194, v195
    s_waitcnt lgkmcnt(1)
    v_mfma_f32_16x16x32_f16 v[182:185], v[202:205], v[122:125], v[182:185]
    v_mul_f32 v196, v214, v196
    v_mul_f32 v197, v214, v197
    v_mfma_f32_16x16x32_f16 v[226:229], v[202:205], v[134:137], v[226:229]
    v_cvt_pk_f16_f32 v251, v196, v197
    v_xor_b32 v161, v161, v140
    v_mfma_f32_16x16x32_f16 v[146:149], v[230:233], v[118:121], v[26:29]
    s_waitcnt lgkmcnt(0)
    v_lshl_add_u32 v161, v141, 2, v161
    v_lshl_add_u32 v222, v161, 4, s5
    v_mfma_f32_16x16x32_f16 v[182:185], v[114:117], v[126:129], v[182:185]
    v_lshl_add_u32 v223, v161, 3, s5
    v_lshl_add_u32 v225, v254, 4, s5
    v_mfma_f32_16x16x32_f16 v[146:149], v[202:205], v[154:157], v[146:149]
    v_lshl_add_u32 v254, v254, 3, s5
    v_lshlrev_b32 v161, 2, v161
    v_mfma_f32_16x16x32_f16 v[146:149], v[114:117], v[250:253], v[146:149]
    ds_permute_b32 v126, v161, v16
    ds_permute_b32 v127, v161, v19
    v_mfma_f32_16x16x32_f16 v[226:229], v[114:117], v[174:177], v[226:229]
    ds_permute_b32 v247, v161, v17
    ds_permute_b32 v248, v161, v20
    v_mfma_f32_16x16x32_bf16 v[114:117], a[216:219], v[210:213], 0
    v_mov_b32_dpp v246, v183 quad_perm:[0,1,2,3] row_mask:0x1 bank_mask:0xf
    v_max3_f32 v161, v182, v186, v187
    v_mfma_f32_16x16x32_bf16 v[114:117], a[220:223], v[234:237], v[114:117]
    v_max3_f32 v161, v161, v188, v189
    v_max3_f32 v161, v161, v190, v191
    v_mfma_f32_16x16x32_bf16 v[114:117], a[224:227], v[238:241], v[114:117]
    v_max3_f32 v161, v161, v192, v193
    v_max3_f32 v161, v161, v170, v171
    v_mfma_f32_16x16x32_bf16 v[114:117], a[228:231], v[242:245], v[114:117]
    v_max3_f32 v161, v161, v172, v173
    v_mov_b32 v249, v161
    v_mfma_f32_16x16x32_bf16 v[114:117], a[232:235], v[178:181], v[114:117]
    v_mov_b32_dpp v246, v227 quad_perm:[0,1,2,3] row_mask:0x2 bank_mask:0xf
    v_add_u32 v141, 16, v141
    v_mfma_f32_16x16x32_bf16 v[114:117], a[236:239], v[198:201], v[114:117]
    v_mov_b32_dpp v246, v147 quad_perm:[0,1,2,3] row_mask:0x4 bank_mask:0xf
    v_mov_b32 v147, v246
    v_mfma_f32_16x16x32_bf16 v[194:197], v[86:89], v[198:201], 0
    s_waitcnt lgkmcnt(2)
    v_permlane32_swap_b32 v161, v249
    v_mfma_f32_16x16x32_bf16 v[194:197], v[82:85], v[178:181], v[194:197]
    s_waitcnt lgkmcnt(0)
    ds_read_b128 v[202:205], v158 offset:0
    v_fma_f32 v148, v114, v114, s33
    v_mfma_f32_16x16x32_bf16 v[194:197], a[252:255], v[242:245], v[194:197]
    v_fmac_f32 v148, v115, v115
    v_fmac_f32 v148, v116, v116
    v_mfma_f32_16x16x32_bf16 v[194:197], a[248:251], v[238:241], v[194:197]
    v_fmac_f32 v148, v117, v117
    v_max_f32 v161, v161, v249
    v_mfma_f32_16x16x32_bf16 v[194:197], a[244:247], v[234:237], v[194:197]
    v_mov_b32 v249, v161
    v_max_f32_dpp v147, v147, v147 quad_perm:[1,0,3,2] row_mask:0xf bank_mask:0xf
    v_mfma_f32_16x16x32_bf16 v[194:197], a[240:243], v[210:213], v[194:197]
    v_permlane16_swap_b32 v161, v249
    v_max_f32 v161, v161, v249
    v_sub_f32 v186, v186, v161
    v_exp_f32 v186, v186
    v_sub_f32 v187, v187, v161
    v_exp_f32 v187, v187
    v_sub_f32 v188, v188, v161
    v_cvt_pk_bf16_f32 v186, v186, v187
    v_fmac_f32 v148, v194, v194
    v_fmac_f32 v148, v195, v195
    v_fmac_f32 v148, v196, v196
    v_fmac_f32 v148, v197, v197
    v_exp_f32 v188, v188
    v_sub_f32 v189, v189, v161
    v_exp_f32 v189, v189
    v_sub_f32 v190, v190, v161
    v_cvt_pk_bf16_f32 v187, v188, v189
    v_mfma_f32_16x16x32_bf16 v[214:217], v[90:93], v[210:213], 0
    s_waitcnt lgkmcnt(0)
    ds_read_b128 v[210:213], v158 offset:2048
    v_sub_f32 v191, v191, v161
    v_mfma_f32_16x16x32_bf16 v[214:217], v[94:97], v[234:237], v[214:217]
    ds_read_b128 v[230:233], v158 offset:4096
    v_sub_f32 v192, v192, v161
    v_mfma_f32_16x16x32_bf16 v[214:217], v[98:101], v[238:241], v[214:217]
    ds_read_b128 v[234:237], v158 offset:6144
    v_sub_f32 v193, v193, v161
    v_mfma_f32_16x16x32_bf16 v[214:217], v[102:105], v[242:245], v[214:217]
    ds_read_b128 v[238:241], v158 offset:8192
    v_sub_f32 v170, v170, v161
    v_mfma_f32_16x16x32_bf16 v[214:217], v[106:109], v[178:181], v[214:217]
    ds_read_b128 v[178:181], v158 offset:10240
    v_sub_f32 v171, v171, v161
    v_mfma_f32_16x16x32_bf16 v[214:217], v[110:113], v[198:201], v[214:217]
    v_exp_f32 v190, v190
    v_mfma_f32_16x16x32_bf16 v[198:201], a[216:219], v[202:205], 0
    v_exp_f32 v191, v191
    v_exp_f32 v192, v192
    s_waitcnt lgkmcnt(4)
    v_mfma_f32_16x16x32_bf16 v[198:201], a[220:223], v[210:213], v[198:201]
    v_cvt_pk_bf16_f32 v188, v190, v191
    s_waitcnt lgkmcnt(3)
    v_mfma_f32_16x16x32_bf16 v[198:201], a[224:227], v[230:233], v[198:201]
    v_fmac_f32 v148, v214, v214
    s_waitcnt lgkmcnt(2)
    v_mfma_f32_16x16x32_bf16 v[198:201], a[228:231], v[234:237], v[198:201]
    v_fmac_f32 v148, v215, v215
    s_waitcnt lgkmcnt(1)
    v_mfma_f32_16x16x32_bf16 v[198:201], a[232:235], v[238:241], v[198:201]
    v_fmac_f32 v148, v216, v216
    s_waitcnt lgkmcnt(0)
    v_mfma_f32_16x16x32_bf16 v[198:201], a[236:239], v[178:181], v[198:201]
    v_fmac_f32 v148, v217, v217
    v_exp_f32 v193, v193
    v_exp_f32 v170, v170
    v_cvt_pk_bf16_f32 v189, v192, v193
    v_exp_f32 v171, v171
    v_sub_f32 v172, v172, v161
    v_cvt_pk_bf16_f32 v36, v170, v171
    v_mfma_f32_16x16x32_f16 v[190:193], v[122:125], v[130:133], v[58:61]
    v_fma_f32 v249, v198, v198, s33
    v_fmac_f32 v249, v199, v199
    v_fmac_f32 v249, v200, v200
    v_fmac_f32 v249, v201, v201
    v_exp_f32 v172, v172
    v_sub_f32 v173, v173, v161
    v_mfma_f32_16x16x16_f16 v[190:193], v[128:129], v[174:175], v[190:193]
    v_exp_f32 v173, v173
    v_sub_f32 v182, v182, v161
    v_cvt_pk_bf16_f32 v37, v172, v173
    v_exp_f32 v182, v182
    v_max_f32_dpp v147, v147, v147 quad_perm:[2,3,0,1] row_mask:0xf bank_mask:0xf
    v_cvt_pk_bf16_f32 v39, v182, 0
    v_min_u32 v161, 20, v141
    v_max_f32_dpp v147, v147, v147 row_half_mirror row_mask:0xf bank_mask:0xf
    v_max3_f32 v149, v226, v190, v191
    v_max3_f32 v149, v149, v192, v193
    v_max_f32_dpp v147, v147, v147 row_mirror row_mask:0xf bank_mask:0xf
    v_mov_b32 v227, v147
    v_add_u32 v228, 12, v141
    v_lshrrev_b32 v228, 5, v228
    v_permlane32_swap_b32 v147, v227
    v_max_f32 v147, v147, v227
    v_mov_b32 v227, v147
    v_sub_u32 v229, v141, v161
    v_mad_i32_i24 v229, v228, s6, v229
    v_permlane16_swap_b32 v147, v227
    v_max_f32 v147, v147, v227
    v_sub_f32 v246, v246, v147
    v_exp_f32 v246, v246
    v_mul_u32_u24 v147, s20, v161
    v_cvt_pk_bf16_f32 v246, v246, v246
    ds_write_b16 v8, v246
    v_add3_u32 v147, v147, v229, s38
    v_mul_u32_u24 v228, 911, v147
    v_lshrrev_b32 v228, 16, v228
    v_mul_u32_u24 v228, s22, v228
    v_mad_u32_u24 v228, v161, s21, v228
    v_bfe_u32 v147, s70, v141, 1
    v_cmp_ne_u32 vcc, 0, v147
    v_mul_i32_i24 v229, 2688, v229
    v_add3_u32 v141, v228, v229, s7
    v_mfma_f32_16x16x32_bf16 v[170:173], v[28:31], v[36:39], 0
    v_cndmask_b32 v141, v255, v141, vcc
    v_lshl_add_u32 v255, v140, 4, v141
    v_mfma_f32_16x16x32_bf16 v[170:173], v[28:31], v[186:189], v[170:173]
    v_add_u32 v255, s3, v255
    v_lshl_add_u32 v161, v140, 3, v141
    v_mfma_f32_16x16x32_bf16 v[182:185], v[142:145], v[186:189], 0
    v_add_u32 v161, s4, v161
    v_mfma_f32_16x16x32_bf16 v[182:185], v[162:165], v[36:39], v[182:185]
    s_nop 0
    s_nop 0
    s_nop 0
    v_rcp_f32 v171, v170
    s_nop 0
    s_nop 0
    s_nop 0
    s_nop 0
    v_mul_f32 v182, v171, v182
    v_mul_f32 v183, v171, v183
    v_cvt_pk_bf16_f32 v182, v182, v183
    v_mul_f32 v184, v171, v184
    v_mul_f32 v185, v171, v185
    v_cvt_pk_bf16_f32 v183, v184, v185
    ds_write_b64 v3, v[182:183] offset:0
    v_mfma_f32_16x16x32_bf16 v[242:245], v[206:209], v[36:39], 0
    v_mfma_f32_16x16x32_bf16 v[242:245], v[150:153], v[186:189], v[242:245]
    s_nop 0
    s_nop 0
    s_nop 0
    s_nop 0
    s_nop 0
    s_nop 0
    s_nop 0
    s_nop 0
    v_mul_f32 v242, v171, v242
    v_mul_f32 v243, v171, v243
    v_cvt_pk_bf16_f32 v184, v242, v243
    v_mul_f32 v244, v171, v244
    v_mul_f32 v245, v171, v245
    v_cvt_pk_bf16_f32 v185, v244, v245
    ds_write_b64 v3, v[184:185] offset:8
    v_mfma_f32_16x16x32_bf16 v[182:185], v[166:169], v[186:189], 0
    v_mfma_f32_16x16x32_bf16 v[182:185], v[218:221], v[36:39], v[182:185]
    v_mfma_f32_16x16x32_f16 v[186:189], v[134:137], v[130:133], v[62:65]
    s_nop 0
    s_nop 0
    s_nop 0
    s_nop 0
    s_nop 0
    s_nop 0
    v_mfma_f32_16x16x16_f16 v[186:189], v[176:177], v[174:175], v[186:189]
    v_mul_f32 v182, v171, v182
    v_mul_f32 v183, v171, v183
    v_cvt_pk_bf16_f32 v140, v182, v183
    v_mul_f32 v184, v171, v184
    v_mul_f32 v185, v171, v185
    v_cvt_pk_bf16_f32 v141, v184, v185
    ds_write_b64 v4, v[140:141] offset:4096
    v_mfma_f32_16x16x32_f16 v[170:173], v[154:157], v[130:133], v[66:69]
    v_max3_f32 v149, v149, v186, v187
    v_max3_f32 v149, v149, v188, v189
    v_mfma_f32_16x16x32_bf16 v[130:133], v[86:89], v[178:181], 0
    v_mfma_f32_16x16x32_bf16 v[130:133], v[82:85], v[238:241], v[130:133]
    v_mfma_f32_16x16x32_bf16 v[130:133], a[252:255], v[234:237], v[130:133]
    v_mfma_f32_16x16x32_bf16 v[130:133], a[248:251], v[230:233], v[130:133]
    v_mfma_f32_16x16x16_f16 v[170:173], v[252:253], v[174:175], v[170:173]
    v_mfma_f32_16x16x32_bf16 v[130:133], a[244:247], v[210:213], v[130:133]
    v_mfma_f32_16x16x32_bf16 v[130:133], a[240:243], v[202:205], v[130:133]
    s_nop 0
    s_nop 0
    s_nop 0
    s_nop 0
    s_nop 0
    s_nop 0
    v_max3_f32 v149, v149, v170, v171
    v_max3_f32 v149, v149, v172, v173
    v_fmac_f32 v249, v130, v130
    v_fmac_f32 v249, v131, v131
    v_fmac_f32 v249, v132, v132
    v_fmac_f32 v249, v133, v133
    v_mov_b32 v147, v149
    s_nop 0
    s_nop 0
    v_permlane32_swap_b32 v149, v147
    v_max_f32 v149, v149, v147
    v_mov_b32 v147, v149
    s_nop 0
    s_nop 0
    v_permlane16_swap_b32 v149, v147
    v_max_f32 v149, v149, v147
    v_sub_f32 v190, v190, v149
    v_exp_f32 v190, v190
    v_sub_f32 v191, v191, v149
    v_exp_f32 v191, v191
    v_sub_f32 v192, v192, v149
    v_cvt_pk_bf16_f32 v182, v190, v191
    v_mfma_f32_16x16x32_f16 v[242:245], v[122:125], v[118:121], v[70:73]
    v_exp_f32 v192, v192
    v_mfma_f32_16x16x32_bf16 v[122:125], v[90:93], v[202:205], 0
    v_sub_f32 v193, v193, v149
    v_sub_f32 v186, v186, v149
    v_mfma_f32_16x16x32_bf16 v[122:125], v[94:97], v[210:213], v[122:125]
    v_exp_f32 v193, v193
    v_sub_f32 v187, v187, v149
    v_mfma_f32_16x16x16_f16 v[242:245], v[128:129], v[250:251], v[242:245]
    v_cvt_pk_bf16_f32 v183, v192, v193
    v_exp_f32 v186, v186
    v_sub_f32 v188, v188, v149
    v_mfma_f32_16x16x32_f16 v[190:193], v[134:137], v[118:121], v[74:77]
    v_exp_f32 v187, v187
    v_mfma_f32_16x16x32_bf16 v[122:125], v[98:101], v[230:233], v[122:125]
    v_cvt_pk_bf16_f32 v184, v186, v187
    v_sub_f32 v189, v189, v149
    v_mfma_f32_16x16x32_bf16 v[122:125], v[102:105], v[234:237], v[122:125]
    v_exp_f32 v188, v188
    v_sub_f32 v170, v170, v149
    v_mfma_f32_16x16x16_f16 v[190:193], v[176:177], v[250:251], v[190:193]
    v_exp_f32 v189, v189
    v_exp_f32 v170, v170
    v_mfma_f32_16x16x32_f16 v[134:137], v[154:157], v[118:121], v[78:81]
    v_cvt_pk_bf16_f32 v185, v188, v189
    v_sub_f32 v171, v171, v149
    v_mfma_f32_16x16x32_bf16 v[122:125], v[106:109], v[238:241], v[122:125]
    v_exp_f32 v171, v171
    v_mfma_f32_16x16x32_bf16 v[122:125], v[110:113], v[178:181], v[122:125]
    v_cvt_pk_bf16_f32 v36, v170, v171
    v_sub_f32 v172, v172, v149
    v_sub_f32 v173, v173, v149
    v_mfma_f32_16x16x16_f16 v[134:137], v[252:253], v[250:251], v[134:137]
    v_exp_f32 v172, v172
    v_exp_f32 v173, v173
    v_sub_f32 v226, v226, v149
    v_cvt_pk_bf16_f32 v37, v172, v173
    v_fmac_f32 v249, v122, v122
    v_fmac_f32 v249, v123, v123
    v_fmac_f32 v249, v124, v124
    v_fmac_f32 v249, v125, v125
    v_cvt_pk_bf16_f32 v128, v148, v249
    v_cvt_pk_bf16_f32 v129, v249, v249
    ds_write_b64 v160, v[128:129] offset:2048
    v_exp_f32 v226, v226
    v_max3_f32 v128, v146, v242, v243
    v_cvt_pk_bf16_f32 v39, v226, 0
    v_max3_f32 v128, v128, v244, v245
    v_max3_f32 v128, v128, v190, v191
    v_mfma_f32_16x16x32_bf16 v[118:121], v[28:31], v[36:39], 0
    v_max3_f32 v128, v128, v192, v193
    v_max3_f32 v128, v128, v134, v135
    v_mfma_f32_16x16x32_bf16 v[118:121], v[28:31], v[182:185], v[118:121]
    v_max3_f32 v128, v128, v136, v137
    v_mov_b32 v129, v128
    v_mfma_f32_16x16x32_bf16 v[154:157], v[142:145], v[182:185], 0
    v_mfma_f32_16x16x32_bf16 v[154:157], v[162:165], v[36:39], v[154:157]
    v_permlane32_swap_b32 v128, v129
    v_mfma_f32_16x16x32_bf16 v[170:173], v[206:209], v[36:39], 0
    v_max_f32 v128, v128, v129
    v_mov_b32 v129, v128
    v_mfma_f32_16x16x32_bf16 v[170:173], v[150:153], v[182:185], v[170:173]
    v_rcp_f32 v119, v118
    v_mfma_f32_16x16x32_bf16 v[174:177], v[166:169], v[182:185], 0
    v_permlane16_swap_b32 v128, v129
    v_mfma_f32_16x16x32_bf16 v[174:177], v[218:221], v[36:39], v[174:177]
    v_mul_f32 v154, v119, v154
    v_mul_f32 v155, v119, v155
    v_cvt_pk_bf16_f32 v154, v154, v155
    v_mul_f32 v156, v119, v156
    v_mul_f32 v157, v119, v157
    v_cvt_pk_bf16_f32 v155, v156, v157
    ds_write_b64 v3, v[154:155] offset:6144
    v_mul_f32 v170, v119, v170
    v_mul_f32 v171, v119, v171
    v_cvt_pk_bf16_f32 v156, v170, v171
    v_mul_f32 v172, v119, v172
    v_mul_f32 v173, v119, v173
    v_cvt_pk_bf16_f32 v157, v172, v173
    ds_write_b64 v3, v[156:157] offset:6152
    v_mul_f32 v174, v119, v174
    v_mul_f32 v175, v119, v175
    v_cvt_pk_bf16_f32 v140, v174, v175
    v_mul_f32 v176, v119, v176
    v_mul_f32 v177, v119, v177
    v_cvt_pk_bf16_f32 v141, v176, v177
    ds_write_b64 v4, v[140:141] offset:10240
    v_max_f32 v128, v128, v129
    v_sub_f32 v242, v242, v128
    v_exp_f32 v242, v242
    v_sub_f32 v243, v243, v128
    v_exp_f32 v243, v243
    v_sub_f32 v244, v244, v128
    v_cvt_pk_bf16_f32 v118, v242, v243
    v_exp_f32 v244, v244
    v_sub_f32 v245, v245, v128
    v_exp_f32 v245, v245
    v_sub_f32 v190, v190, v128
    v_cvt_pk_bf16_f32 v119, v244, v245
    v_exp_f32 v190, v190
    v_sub_f32 v191, v191, v128
    v_exp_f32 v191, v191
    v_sub_f32 v192, v192, v128
    v_cvt_pk_bf16_f32 v120, v190, v191
    v_exp_f32 v192, v192
    s_waitcnt lgkmcnt(0)
    s_barrier
    ds_read_b128 v[154:157], v159 offset:2048
    ds_read_b128 v[170:173], v159 offset:3072
    ds_read_b128 v[174:177], v224 offset:0
    ds_read_b128 v[178:181], v224 offset:1024
    ds_read_b128 v[182:185], v224 offset:2048
    ds_read_b128 v[186:189], v224 offset:3072
    ds_read_b128 v[202:205], v224 offset:4096
    ds_read_b128 v[210:213], v224 offset:5120
    v_sub_f32 v193, v193, v128
    v_exp_f32 v193, v193
    v_sub_f32 v134, v134, v128
    v_cvt_pk_bf16_f32 v121, v192, v193
    v_exp_f32 v134, v134
    s_waitcnt lgkmcnt(6)
    v_mfma_f32_16x16x32_bf16 v[190:193], v[32:35], v[154:157], 0
    s_waitcnt lgkmcnt(5)
    v_sub_f32 v135, v135, v128
    v_sub_f32 v136, v136, v128
    v_mfma_f32_16x16x32_bf16 v[190:193], v[32:35], v[170:173], v[190:193]
    s_waitcnt lgkmcnt(4)
    v_exp_f32 v135, v135
    v_mfma_f32_16x16x32_bf16 v[154:157], a[216:219], v[174:177], 0
    s_waitcnt lgkmcnt(3)
    v_cvt_pk_bf16_f32 v36, v134, v135
    v_sub_f32 v137, v137, v128
    v_mfma_f32_16x16x32_bf16 v[154:157], a[220:223], v[178:181], v[154:157]
    s_waitcnt lgkmcnt(2)
    v_mul_f32 v129, 0x3baaaaab, v191
    v_sub_f32 v146, v146, v128
    v_mfma_f32_16x16x32_bf16 v[154:157], a[224:227], v[182:185], v[154:157]
    s_waitcnt lgkmcnt(1)
    v_rsq_f32 v129, v129
    v_mfma_f32_16x16x32_bf16 v[154:157], a[228:231], v[186:189], v[154:157]
    s_waitcnt lgkmcnt(0)
    v_mul_f32 v198, v129, v198
    v_mul_f32 v199, v129, v199
    v_mfma_f32_16x16x32_bf16 v[154:157], a[232:235], v[202:205], v[154:157]
    v_cvt_pk_bf16_f32 v170, v198, v199
    v_mul_f32 v200, v129, v200
    v_mfma_f32_16x16x32_bf16 v[154:157], a[236:239], v[210:213], v[154:157]
    v_mul_f32 v201, v129, v201
    v_cvt_pk_bf16_f32 v171, v200, v201
    v_mfma_f32_16x16x32_bf16 v[198:201], v[86:89], v[210:213], 0
    v_mul_f32 v130, v129, v130
    v_mul_f32 v131, v129, v131
    v_mfma_f32_16x16x32_bf16 v[198:201], v[82:85], v[202:205], v[198:201]
    ds_read_b128 v[226:229], v224 offset:11264
    v_cvt_pk_bf16_f32 v172, v130, v131
    v_mfma_f32_16x16x32_bf16 v[198:201], a[252:255], v[186:189], v[198:201]
    ds_read_b128 v[230:233], v224 offset:10240
    v_mul_f32 v132, v129, v132
    v_mfma_f32_16x16x32_bf16 v[198:201], a[248:251], v[182:185], v[198:201]
    ds_read_b128 v[234:237], v224 offset:9216
    v_mul_f32 v133, v129, v133
    v_mfma_f32_16x16x32_bf16 v[198:201], a[244:247], v[178:181], v[198:201]
    ds_read_b128 v[238:241], v224 offset:8192
    v_cvt_pk_bf16_f32 v173, v132, v133
    v_mfma_f32_16x16x32_bf16 v[198:201], a[240:243], v[174:177], v[198:201]
    ds_read_b128 v[130:133], v224 offset:7168
    buffer_store_dwordx4 v[170:173], v139, s[12:15], 0 offen nt
    v_mul_f32 v122, v129, v122
    v_mul_f32 v123, v129, v123
    v_cvt_pk_bf16_f32 v128, v122, v123
    v_mul_f32 v124, v129, v124
    v_mfma_f32_16x16x32_bf16 v[170:173], v[90:93], v[174:177], 0
    ds_read_b128 v[174:177], v224 offset:6144
    v_mul_f32 v125, v129, v125
    v_mfma_f32_16x16x32_bf16 v[170:173], v[94:97], v[178:181], v[170:173]
    v_cvt_pk_bf16_f32 v129, v124, v125
    v_fma_f32 v246, v154, v154, s33
    v_mfma_f32_16x16x32_bf16 v[170:173], v[98:101], v[182:185], v[170:173]
    s_waitcnt lgkmcnt(5)
    v_fmac_f32 v246, v155, v155
    v_fmac_f32 v246, v156, v156
    v_mfma_f32_16x16x32_bf16 v[122:125], v[110:113], v[226:229], 0
    s_waitcnt lgkmcnt(4)
    v_fmac_f32 v246, v157, v157
    v_fmac_f32 v246, v198, v198
    v_mfma_f32_16x16x32_bf16 v[122:125], v[106:109], v[230:233], v[122:125]
    s_waitcnt lgkmcnt(3)
    v_fmac_f32 v246, v199, v199
    v_fmac_f32 v246, v200, v200
    v_mfma_f32_16x16x32_bf16 v[122:125], v[102:105], v[234:237], v[122:125]
    s_waitcnt lgkmcnt(2)
    v_fmac_f32 v246, v201, v201
    v_mul_f32 v249, 0x3baaaaab, v190
    v_mfma_f32_16x16x32_bf16 v[122:125], v[98:101], v[238:241], v[122:125]
    s_waitcnt lgkmcnt(1)
    v_exp_f32 v136, v136
    v_mfma_f32_16x16x32_bf16 v[122:125], v[94:97], v[130:133], v[122:125]
    v_exp_f32 v137, v137
    v_mfma_f32_16x16x32_bf16 v[178:181], a[236:239], v[226:229], 0
    s_waitcnt lgkmcnt(0)
    ds_read_b128 v[182:185], v9
    ds_read_b128 v[190:193], v9 offset:64
    v_mfma_f32_16x16x32_bf16 v[122:125], v[90:93], v[174:177], v[122:125]
    v_exp_f32 v146, v146
    v_mfma_f32_16x16x32_bf16 v[178:181], a[232:235], v[230:233], v[178:181]
    v_cvt_pk_bf16_f32 v37, v136, v137
    v_cvt_pk_bf16_f32 v39, v146, 0
    v_mfma_f32_16x16x32_bf16 v[134:137], a[240:243], v[174:177], 0
    v_rsq_f32 v249, v249
    v_mfma_f32_16x16x32_bf16 v[134:137], a[244:247], v[130:133], v[134:137]
    v_mul_f32 v114, v249, v114
    v_fma_f32 v139, v122, v122, s33
    v_mfma_f32_16x16x32_bf16 v[134:137], a[248:251], v[238:241], v[134:137]
    v_fmac_f32 v139, v123, v123
    v_fmac_f32 v139, v124, v124
    v_mfma_f32_16x16x32_bf16 v[134:137], a[252:255], v[234:237], v[134:137]
    v_fmac_f32 v139, v125, v125
    v_mul_f32 v115, v249, v115
    v_mfma_f32_16x16x32_bf16 v[134:137], v[82:85], v[230:233], v[134:137]
    buffer_store_dwordx2 v[128:129], v138, s[12:15], 0 offen nt
    v_cvt_pk_bf16_f32 v114, v114, v115
    v_mul_f32 v116, v249, v116
    v_mfma_f32_16x16x32_bf16 v[134:137], v[86:89], v[226:229], v[134:137]
    s_waitcnt lgkmcnt(0)
    v_mul_f32 v117, v249, v117
    v_cvt_pk_bf16_f32 v115, v116, v117
    v_mfma_f32_16x16x32_bf16 v[178:181], a[228:231], v[234:237], v[178:181]
    v_mul_f32 v194, v249, v194
    v_mul_f32 v195, v249, v195
    v_mfma_f32_16x16x32_bf16 v[178:181], a[224:227], v[238:241], v[178:181]
    v_cvt_pk_bf16_f32 v116, v194, v195
    v_fmac_f32 v139, v134, v134
    v_mfma_f32_16x16x32_bf16 v[178:181], a[220:223], v[130:133], v[178:181]
    v_fmac_f32 v139, v135, v135
    v_fmac_f32 v139, v136, v136
    v_mfma_f32_16x16x32_bf16 v[178:181], a[216:219], v[174:177], v[178:181]
    v_fmac_f32 v139, v137, v137
    v_mul_f32 v196, v249, v196
    v_mfma_f32_16x16x32_bf16 v[130:133], v[28:31], v[36:39], 0
    v_mul_f32 v197, v249, v197
    v_cvt_pk_bf16_f32 v117, v196, v197
    v_mfma_f32_16x16x32_bf16 v[130:133], v[28:31], v[118:121], v[130:133]
    ds_write_b128 v222, v[114:117] offset:3072
    v_mfma_f32_16x16x32_bf16 v[114:117], v[142:145], v[118:121], 0
    v_fmac_f32 v139, v178, v178
    v_fmac_f32 v139, v179, v179
    v_mfma_f32_16x16x32_bf16 v[114:117], v[162:165], v[36:39], v[114:117]
    v_fmac_f32 v139, v180, v180
    v_fmac_f32 v139, v181, v181
    v_mfma_f32_16x16x32_bf16 v[146:149], v[206:209], v[36:39], 0
    ds_read_b128 v[174:177], v225 offset:3072
    v_cvt_pk_bf16_f32 v129, v139, v139
    v_mfma_f32_16x16x32_bf16 v[146:149], v[150:153], v[118:121], v[146:149]
    v_rcp_f32 v131, v130
    v_mfma_f32_16x16x32_bf16 v[194:197], v[166:169], v[118:121], 0
    v_mul_f32 v114, v131, v114
    v_mul_f32 v115, v131, v115
    v_mfma_f32_16x16x32_bf16 v[194:197], v[218:221], v[36:39], v[194:197]
    v_cvt_pk_bf16_f32 v114, v114, v115
    v_mul_f32 v116, v131, v116
    v_mfma_f32_16x16x32_bf16 v[170:173], v[102:105], v[186:189], v[170:173]
    v_mul_f32 v117, v131, v117
    v_cvt_pk_bf16_f32 v115, v116, v117
    v_mfma_f32_16x16x32_bf16 v[170:173], v[106:109], v[202:205], v[170:173]
    ds_write_b64 v3, v[114:115] offset:12288
    v_mfma_f32_16x16x32_bf16 v[170:173], v[110:113], v[210:213], v[170:173]
    v_mul_f32 v146, v131, v146
    v_mul_f32 v147, v131, v147
    v_mfma_f32_16x16x32_bf16 v[118:121], v[182:185], v[28:31], 0
    s_waitcnt lgkmcnt(1)
    buffer_store_dwordx4 v[174:177], v247, s[52:55], 0 offen nt
    v_cvt_pk_bf16_f32 v116, v146, v147
    v_mul_f32 v148, v131, v148
    v_mul_f32 v149, v131, v149
    v_cvt_pk_bf16_f32 v117, v148, v149
    v_mfma_f32_16x16x32_bf16 v[118:121], v[190:193], v[28:31], v[118:121]
    ds_write_b64 v3, v[116:117] offset:12296
    v_mfma_f32_16x16x32_bf16 v[114:117], v[190:193], v[162:165], 0
    v_mul_f32 v194, v131, v194
    v_mul_f32 v195, v131, v195
    v_mfma_f32_16x16x32_bf16 v[114:117], v[182:185], v[142:145], v[114:117]
    v_cvt_pk_bf16_f32 v194, v194, v195
    v_mul_f32 v196, v131, v196
    v_mfma_f32_16x16x32_bf16 v[142:145], v[182:185], v[150:153], 0
    v_mul_f32 v197, v131, v197
    v_cvt_pk_bf16_f32 v195, v196, v197
    v_mfma_f32_16x16x32_bf16 v[142:145], v[190:193], v[206:209], v[142:145]
    ds_write_b64 v4, v[194:195] offset:16384
    v_mfma_f32_16x16x32_bf16 v[130:133], v[190:193], v[218:221], 0
    v_fmac_f32 v246, v170, v170
    v_fmac_f32 v246, v171, v171
    v_mfma_f32_16x16x32_bf16 v[130:133], v[182:185], v[166:169], v[130:133]
    v_fmac_f32 v246, v172, v172
    v_fmac_f32 v246, v173, v173
    v_cvt_pk_bf16_f32 v128, v246, v139
    ds_write_b64 v160, v[128:129] offset:7616
    v_rcp_f32_dpp v119, v118 quad_perm:[0,0,0,0] row_mask:0xf bank_mask:0xf
    v_mul_f32 v214, v249, v214
    v_mul_f32 v114, v114, v119
    v_mul_f32 v215, v249, v215
    v_cvt_pk_bf16_f32 v128, v214, v215
    v_mul_f32_dpp v114, v142, v119 quad_perm:[0,1,2,3] row_mask:0x2 bank_mask:0xf
    v_mul_f32 v216, v249, v216
    v_mul_f32 v217, v249, v217
    v_mul_f32_dpp v114, v130, v119 quad_perm:[0,1,2,3] row_mask:0x4 bank_mask:0xf
    v_cvt_pk_bf16_f32 v114, v114, v114
    ds_write_b16 v7, v114
    v_cvt_pk_bf16_f32 v129, v216, v217
    ds_write_b64 v223, v[128:129] offset:4096
    ds_read_b64 v[128:129], v254 offset:4096
    s_waitcnt lgkmcnt(2)
    s_barrier
    ds_read_b128 v[114:117], v159 offset:7616
    ds_read_b128 v[118:121], v159 offset:8640
    ds_read_b128 v[130:133], v224 offset:12288
    ds_read_b128 v[138:141], v224 offset:13312
    ds_read_b128 v[142:145], v224 offset:14336
    ds_read_b128 v[146:149], v224 offset:15360
    s_waitcnt lgkmcnt(6)
    buffer_store_dwordx2 v[128:129], v248, s[52:55], 0 offen nt
    ds_read_b128 v[150:153], v224 offset:16384
    ds_read_b128 v[162:165], v224 offset:17408
    s_waitcnt lgkmcnt(7)
    v_mfma_f32_16x16x32_bf16 v[166:169], v[32:35], v[114:117], 0
    s_waitcnt lgkmcnt(6)
    v_mfma_f32_16x16x32_bf16 v[166:169], v[32:35], v[118:121], v[166:169]
    s_waitcnt lgkmcnt(4)
    v_mfma_f32_16x16x32_bf16 v[114:117], a[216:219], v[130:133], 0
    s_waitcnt lgkmcnt(3)
    v_mfma_f32_16x16x32_bf16 v[114:117], a[220:223], v[138:141], v[114:117]
    s_waitcnt lgkmcnt(2)
    v_mfma_f32_16x16x32_bf16 v[114:117], a[224:227], v[142:145], v[114:117]
    s_waitcnt lgkmcnt(1)
    v_mfma_f32_16x16x32_bf16 v[114:117], a[228:231], v[146:149], v[114:117]
    s_waitcnt lgkmcnt(0)
    v_mul_f32 v128, 0x3baaaaab, v166
    v_mul_f32 v129, 0x3baaaaab, v167
    v_mfma_f32_16x16x32_bf16 v[114:117], a[232:235], v[150:153], v[114:117]
    v_rsq_f32 v128, v128
    v_mfma_f32_16x16x32_bf16 v[114:117], a[236:239], v[162:165], v[114:117]
    v_mul_f32 v154, v128, v154
    v_mul_f32 v155, v128, v155
    v_mfma_f32_16x16x32_bf16 v[118:121], v[86:89], v[162:165], 0
    v_cvt_pk_bf16_f32 v154, v154, v155
    v_mul_f32 v156, v128, v156
    v_mfma_f32_16x16x32_bf16 v[118:121], v[82:85], v[150:153], v[118:121]
    ds_read_b128 v[166:169], v158 offset:10496
    v_mul_f32 v157, v128, v157
    v_mfma_f32_16x16x32_bf16 v[118:121], a[252:255], v[146:149], v[118:121]
    ds_read_b128 v[174:177], v158 offset:8448
    v_cvt_pk_bf16_f32 v155, v156, v157
    v_mfma_f32_16x16x32_bf16 v[118:121], a[248:251], v[142:145], v[118:121]
    ds_read_b128 v[182:185], v158 offset:6400
    v_mul_f32 v198, v128, v198
    v_mfma_f32_16x16x32_bf16 v[118:121], a[244:247], v[138:141], v[118:121]
    ds_read_b128 v[186:189], v158 offset:4352
    v_mul_f32 v199, v128, v199
    v_mfma_f32_16x16x32_bf16 v[118:121], a[240:243], v[130:133], v[118:121]
    ds_read_b128 v[190:193], v158 offset:2304
    v_cvt_pk_bf16_f32 v156, v198, v199
    v_mfma_f32_16x16x32_bf16 v[194:197], v[90:93], v[130:133], 0
    ds_read_b128 v[130:133], v158 offset:256
    v_mul_f32 v200, v128, v200
    v_mfma_f32_16x16x32_bf16 v[194:197], v[94:97], v[138:141], v[194:197]
    v_mul_f32 v201, v128, v201
    v_cvt_pk_bf16_f32 v157, v200, v201
    v_mfma_f32_16x16x32_bf16 v[194:197], v[98:101], v[142:145], v[194:197]
    buffer_store_dwordx4 v[154:157], v15, s[56:59], 0 offen nt
    v_mul_f32 v170, v128, v170
    v_mul_f32 v171, v128, v171
    v_cvt_pk_bf16_f32 v170, v170, v171
    v_mul_f32 v172, v128, v172
    v_mfma_f32_16x16x32_bf16 v[194:197], v[102:105], v[146:149], v[194:197]
    s_waitcnt lgkmcnt(4)
    v_mul_f32 v173, v128, v173
    v_cvt_pk_bf16_f32 v171, v172, v173
    v_mfma_f32_16x16x32_bf16 v[194:197], v[106:109], v[150:153], v[194:197]
    s_waitcnt lgkmcnt(3)
    v_rsq_f32 v129, v129
    v_mfma_f32_16x16x32_bf16 v[194:197], v[110:113], v[162:165], v[194:197]
    s_waitcnt lgkmcnt(2)
    v_fma_f32 v128, v114, v114, s33
    v_fmac_f32 v128, v115, v115
    v_mfma_f32_16x16x32_bf16 v[138:141], v[110:113], v[166:169], 0
    s_waitcnt lgkmcnt(1)
    v_fmac_f32 v128, v116, v116
    v_fmac_f32 v128, v117, v117
    v_mfma_f32_16x16x32_bf16 v[138:141], v[106:109], v[174:177], v[138:141]
    s_waitcnt lgkmcnt(0)
    v_fmac_f32 v128, v118, v118
    v_fmac_f32 v128, v119, v119
    v_mfma_f32_16x16x32_bf16 v[138:141], v[102:105], v[182:185], v[138:141]
    v_fmac_f32 v128, v120, v120
    v_fmac_f32 v128, v121, v121
    v_mfma_f32_16x16x32_bf16 v[138:141], v[98:101], v[186:189], v[138:141]
    v_fmac_f32 v128, v194, v194
    v_fmac_f32 v128, v195, v195
    v_mfma_f32_16x16x32_bf16 v[138:141], v[94:97], v[190:193], v[138:141]
    v_fmac_f32 v128, v196, v196
    v_fmac_f32 v128, v197, v197
    v_mfma_f32_16x16x32_bf16 v[138:141], v[90:93], v[130:133], v[138:141]
    v_cvt_pk_bf16_f32 v172, v128, v128
    v_cvt_pk_bf16_f32 v173, v128, v128
    v_mfma_f32_16x16x32_bf16 v[142:145], a[240:243], v[130:133], 0
    ds_write_b64 v160, v[172:173] offset:9664
    v_mfma_f32_16x16x32_bf16 v[142:145], a[244:247], v[190:193], v[142:145]
    v_mul_f32 v178, v129, v178
    v_mul_f32 v179, v129, v179
    v_mfma_f32_16x16x32_bf16 v[142:145], a[248:251], v[186:189], v[142:145]
    v_fma_f32 v158, v138, v138, s33
    v_fmac_f32 v158, v139, v139
    v_mfma_f32_16x16x32_bf16 v[142:145], a[252:255], v[182:185], v[142:145]
    v_fmac_f32 v158, v140, v140
    v_fmac_f32 v158, v141, v141
    v_mfma_f32_16x16x32_bf16 v[142:145], v[82:85], v[174:177], v[142:145]
    v_cvt_pk_bf16_f32 v146, v178, v179
    v_mul_f32 v180, v129, v180
    v_mfma_f32_16x16x32_bf16 v[142:145], v[86:89], v[166:169], v[142:145]
    buffer_store_dwordx2 v[170:171], v18, s[56:59], 0 offen nt
    v_mul_f32 v181, v129, v181
    v_cvt_pk_bf16_f32 v147, v180, v181
    v_mfma_f32_16x16x32_bf16 v[150:153], a[236:239], v[166:169], 0
    v_mul_f32 v134, v129, v134
    v_mul_f32 v135, v129, v135
    v_mfma_f32_16x16x32_bf16 v[150:153], a[232:235], v[174:177], v[150:153]
    v_cvt_pk_bf16_f32 v148, v134, v135
    v_fmac_f32 v158, v142, v142
    v_mfma_f32_16x16x32_bf16 v[150:153], a[228:231], v[182:185], v[150:153]
    v_fmac_f32 v158, v143, v143
    v_fmac_f32 v158, v144, v144
    v_mfma_f32_16x16x32_bf16 v[150:153], a[224:227], v[186:189], v[150:153]
    v_fmac_f32 v158, v145, v145
    v_mul_f32 v136, v129, v136
    v_mfma_f32_16x16x32_bf16 v[150:153], a[220:223], v[190:193], v[150:153]
    v_mul_f32 v137, v129, v137
    v_cvt_pk_bf16_f32 v149, v136, v137
    v_mfma_f32_16x16x32_bf16 v[150:153], a[216:219], v[130:133], v[150:153]
    ds_write_b128 v222, v[146:149] offset:1536
    v_mul_f32 v122, v129, v122
    v_mul_f32 v123, v129, v123
    v_cvt_pk_bf16_f32 v128, v122, v123
    v_mul_f32 v124, v129, v124
    v_mul_f32 v125, v129, v125
    v_cvt_pk_bf16_f32 v129, v124, v125
    s_nop 0
    v_fmac_f32 v158, v150, v150
    v_fmac_f32 v158, v151, v151
    v_fmac_f32 v158, v152, v152
    v_fmac_f32 v158, v153, v153
    v_cvt_pk_bf16_f32 v122, v158, v158
    v_cvt_pk_bf16_f32 v123, v158, v158
    ds_write_b64 v160, v[122:123] offset:15232
    ds_read_b128 v[122:125], v225 offset:1536
    ds_write_b64 v223, v[128:129] offset:2560
    ds_read_b64 v[128:129], v254 offset:2560
    s_waitcnt lgkmcnt(3)
    s_barrier
    ds_read_b128 v[130:133], v159 offset:9664
    ds_read_b128 v[134:137], v159 offset:10688
    ds_read_b128 v[146:149], v159 offset:15232
    ds_read_b128 v[154:157], v159 offset:16256
    ds_read_b128 v[162:165], v224 offset:18432
    s_waitcnt lgkmcnt(6)
    buffer_store_dwordx4 v[122:125], v126, s[56:59], 0 offen nt
    s_waitcnt lgkmcnt(5)
    s_waitcnt lgkmcnt(4)
    v_mfma_f32_16x16x32_bf16 v[166:169], v[32:35], v[130:133], 0
    s_waitcnt lgkmcnt(3)
    v_mfma_f32_16x16x32_bf16 v[166:169], v[32:35], v[134:137], v[166:169]
    s_waitcnt lgkmcnt(1)
    buffer_store_dwordx2 v[128:129], v127, s[56:59], 0 offen nt
    v_mfma_f32_16x16x32_bf16 v[122:125], v[32:35], v[146:149], 0
    s_waitcnt lgkmcnt(0)
    v_or3_b32 v162, v162, v163, v164
    v_or_b32 v162, v162, v165
    v_mfma_f32_16x16x32_bf16 v[122:125], v[32:35], v[154:157], v[122:125]
    v_cmp_gt_i32 s[46:47], 0, v162
    v_mul_f32 v224, 0x3baaaaab, v166
    v_rsq_f32 v224, v224
    s_nop 0
    v_mul_f32 v114, v224, v114
    v_mul_f32 v115, v224, v115
    v_cvt_pk_bf16_f32 v114, v114, v115
    v_mul_f32 v116, v224, v116
    v_mul_f32 v115, 0x3baaaaab, v122
    v_rsq_f32 v115, v115
    v_mul_f32 v117, v224, v117
    v_mul_f32 v150, v115, v150
    v_mul_f32 v151, v115, v151
    v_cvt_pk_bf16_f32 v122, v150, v151
    v_mul_f32 v152, v115, v152
    v_mul_f32 v153, v115, v153
    v_cvt_pk_bf16_f32 v123, v152, v153
    v_mul_f32 v142, v115, v142
    v_mul_f32 v143, v115, v143
    v_cvt_pk_bf16_f32 v124, v142, v143
    v_mul_f32 v144, v115, v144
    v_mul_f32 v145, v115, v145
    v_cvt_pk_bf16_f32 v125, v144, v145
    buffer_store_dwordx4 v[122:125], v255, s[12:15], 0 offen nt
    v_mul_f32 v138, v115, v138
    v_mul_f32 v139, v115, v139
    v_cvt_pk_bf16_f32 v158, v138, v139
    v_mul_f32 v140, v115, v140
    v_mul_f32 v141, v115, v141
    v_cvt_pk_bf16_f32 v159, v140, v141
    v_cvt_pk_bf16_f32 v115, v116, v117
    v_mul_f32 v118, v224, v118
    v_mul_f32 v119, v224, v119
    v_cvt_pk_bf16_f32 v116, v118, v119
    v_mul_f32 v120, v224, v120
    v_mul_f32 v121, v224, v121
    v_cvt_pk_bf16_f32 v117, v120, v121
    ds_write_b128 v222, v[114:117] offset:3072
    v_mul_f32 v194, v224, v194
    v_mul_f32 v195, v224, v195
    v_cvt_pk_bf16_f32 v194, v194, v195
    v_mul_f32 v196, v224, v196
    v_mul_f32 v197, v224, v197
    v_cvt_pk_bf16_f32 v195, v196, v197
    buffer_store_dwordx2 v[158:159], v161, s[12:15], 0 offen nt
    ds_read_b128 v[114:117], v225 offset:3072
    ds_write_b64 v223, v[194:195] offset:4096
    ds_read_b64 v[160:161], v254 offset:4096
    s_waitcnt lgkmcnt(2)
    buffer_store_dwordx4 v[114:117], v247, s[56:59], 0 offen nt
    s_waitcnt lgkmcnt(0)
    buffer_store_dwordx2 v[160:161], v248, s[56:59], 0 offen nt
    s_branch L_end
L_drain:
    ds_read_b128 v[114:117], v2 offset:18432
    s_nop 4
    ds_read_b128 v[118:121], v2 offset:19456
    ds_read_b128 v[122:125], v2 offset:0
    s_mul_i32 s5, s16, 9408
    s_mov_b32 s12, s40
    ds_read_b128 v[126:129], v2 offset:1024
    s_mov_b32 s13, s41
    s_cmp_ge_u32 s18, 2
    s_cselect_b32 s14, s36, 0
    ds_read_b128 v[130:133], v2 offset:2048
    s_add_u32 s5, s5, 104448
    s_and_b32 s6, s2, 7
    s_sub_u32 s6, 0, s6
    ds_read_b128 v[138:141], v2 offset:3072
    s_lshl_b32 s3, s16, 6
    s_lshl_b32 s4, s16, 5
    s_add_u32 s4, s4, 256
    ds_read_b128 v[146:149], v2 offset:4096
    ds_read_b128 v[150:153], v2 offset:5120
    v_bfe_u32 v254, v2, 4, 6
    v_lshrrev_b32 v255, 4, v254
    v_and_b32 v154, 15, v254
    v_lshlrev_b32 v155, 9, v255
    v_lshl_add_u32 v155, v154, 4, v155
    v_add_u32 v155, 149696, v155
    s_waitcnt lgkmcnt(7)
    v_mfma_f32_16x16x32_bf16 v[166:169], v[32:35], v[114:117], 0
    s_waitcnt lgkmcnt(5)
    v_xor_b32 v156, 65536, v2
    v_bfe_u32 v157, v154, 1, 2
    v_mfma_f32_16x16x32_bf16 v[166:169], v[32:35], v[118:121], v[166:169]
    s_waitcnt lgkmcnt(4)
    v_xor_b32 v157, v157, v255
    v_lshl_add_u32 v157, v154, 2, v157
    v_lshl_add_u32 v114, v157, 4, s5
    v_mfma_f32_16x16x32_bf16 v[118:121], a[216:219], v[122:125], 0
    s_waitcnt lgkmcnt(3)
    v_lshl_add_u32 v115, v157, 3, s5
    v_lshl_add_u32 v116, v254, 4, s5
    v_lshl_add_u32 v117, v254, 3, s5
    v_mfma_f32_16x16x32_bf16 v[118:121], a[220:223], v[126:129], v[118:121]
    s_waitcnt lgkmcnt(2)
    v_lshlrev_b32 v157, 2, v157
    v_mul_f32 v166, 0x3baaaaab, v166
    v_rsq_f32 v166, v166
    v_mfma_f32_16x16x32_bf16 v[118:121], a[224:227], v[130:133], v[118:121]
    s_waitcnt lgkmcnt(0)
    ds_permute_b32 v169, v157, v15
    ds_permute_b32 v182, v157, v18
    v_mul_f32 v178, v166, v178
    v_mfma_f32_16x16x32_bf16 v[118:121], a[228:231], v[138:141], v[118:121]
    ds_permute_b32 v183, v157, v16
    ds_permute_b32 v184, v157, v19
    v_mul_f32 v179, v166, v179
    v_mfma_f32_16x16x32_bf16 v[118:121], a[232:235], v[146:149], v[118:121]
    ds_permute_b32 v185, v157, v17
    ds_permute_b32 v186, v157, v20
    v_cvt_pk_bf16_f32 v178, v178, v179
    v_mfma_f32_16x16x32_bf16 v[118:121], a[236:239], v[150:153], v[118:121]
    v_mul_f32 v180, v166, v180
    v_mul_f32 v181, v166, v181
    v_cvt_pk_bf16_f32 v179, v180, v181
    v_mfma_f32_16x16x32_bf16 v[190:193], v[86:89], v[150:153], 0
    v_mul_f32 v142, v166, v142
    v_mul_f32 v143, v166, v143
    v_cvt_pk_bf16_f32 v180, v142, v143
    v_mfma_f32_16x16x32_bf16 v[190:193], v[82:85], v[146:149], v[190:193]
    v_mul_f32 v144, v166, v144
    v_mul_f32 v145, v166, v145
    v_cvt_pk_bf16_f32 v181, v144, v145
    v_mfma_f32_16x16x32_bf16 v[190:193], a[252:255], v[138:141], v[190:193]
    s_waitcnt lgkmcnt(4)
    ds_read_b128 v[142:145], v2 offset:6144
    v_mul_f32 v134, v166, v134
    v_mul_f32 v135, v166, v135
    v_mfma_f32_16x16x32_bf16 v[190:193], a[248:251], v[130:133], v[190:193]
    s_waitcnt lgkmcnt(3)
    ds_read_b128 v[194:197], v2 offset:7168
    v_cvt_pk_bf16_f32 v188, v134, v135
    v_mul_f32 v136, v166, v136
    v_mfma_f32_16x16x32_bf16 v[190:193], a[244:247], v[126:129], v[190:193]
    s_waitcnt lgkmcnt(2)
    ds_read_b128 v[198:201], v2 offset:8192
    v_mul_f32 v137, v166, v137
    v_cvt_pk_bf16_f32 v189, v136, v137
    v_mfma_f32_16x16x32_bf16 v[190:193], a[240:243], v[122:125], v[190:193]
    ds_read_b128 v[134:137], v2 offset:9216
    v_fma_f32 v157, v118, v118, s33
    v_fmac_f32 v157, v119, v119
    v_mfma_f32_16x16x32_bf16 v[202:205], v[90:93], v[122:125], 0
    ds_read_b128 v[122:125], v2 offset:10240
    v_fmac_f32 v157, v120, v120
    v_fmac_f32 v157, v121, v121
    v_mfma_f32_16x16x32_bf16 v[202:205], v[94:97], v[126:129], v[202:205]
    ds_read_b128 v[126:129], v2 offset:11264
    v_fmac_f32 v157, v190, v190
    v_fmac_f32 v157, v191, v191
    v_mfma_f32_16x16x32_bf16 v[202:205], v[98:101], v[130:133], v[202:205]
    s_waitcnt lgkmcnt(5)
    buffer_store_dwordx4 v[178:181], v15, s[12:15], s27 offen nt
    v_fmac_f32 v157, v192, v192
    v_fmac_f32 v157, v193, v193
    v_mul_f32 v187, 0x3baaaaab, v167
    v_mfma_f32_16x16x32_bf16 v[202:205], v[102:105], v[138:141], v[202:205]
    s_waitcnt lgkmcnt(4)
    v_rsq_f32 v187, v187
    v_sub_u32 v166, 0x40800000, v44
    v_mfma_f32_16x16x32_bf16 v[202:205], v[106:109], v[146:149], v[202:205]
    s_waitcnt lgkmcnt(3)
    v_mul_f32 v174, v187, v174
    v_mul_f32 v175, v187, v175
    v_cvt_pk_bf16_f32 v130, v174, v175
    v_mfma_f32_16x16x32_bf16 v[202:205], v[110:113], v[150:153], v[202:205]
    s_waitcnt lgkmcnt(2)
    v_mul_f32 v176, v187, v176
    v_mul_f32 v177, v187, v177
    v_cvt_pk_bf16_f32 v131, v176, v177
    v_mfma_f32_16x16x32_bf16 v[138:141], a[216:219], v[142:145], 0
    s_waitcnt lgkmcnt(1)
    v_mul_f32 v162, v187, v162
    v_mul_f32 v163, v187, v163
    v_fmac_f32 v157, v202, v202
    v_mfma_f32_16x16x32_bf16 v[138:141], a[220:223], v[194:197], v[138:141]
    s_waitcnt lgkmcnt(0)
    v_fmac_f32 v157, v203, v203
    v_fmac_f32 v157, v204, v204
    v_fmac_f32 v157, v205, v205
    v_mfma_f32_16x16x32_bf16 v[138:141], a[224:227], v[198:201], v[138:141]
    v_cvt_pk_bf16_f32 v132, v162, v163
    v_mul_f32 v164, v187, v164
    v_mul_f32 v165, v187, v165
    v_mfma_f32_16x16x32_bf16 v[138:141], a[228:231], v[134:137], v[138:141]
    v_cvt_pk_bf16_f32 v133, v164, v165
    v_mul_f32 v214, v187, v214
    v_mul_f32 v215, v187, v215
    v_mfma_f32_16x16x32_bf16 v[138:141], a[232:235], v[122:125], v[138:141]
    v_cvt_pk_bf16_f32 v214, v214, v215
    v_mul_f32 v216, v187, v216
    v_mul_f32 v217, v187, v217
    v_mfma_f32_16x16x32_bf16 v[138:141], a[236:239], v[126:129], v[138:141]
    v_cvt_pk_bf16_f32 v215, v216, v217
    v_or_b32 v166, v166, v44
    v_lshl_add_u32 v167, s16, 2, v156
    v_mfma_f32_16x16x32_bf16 v[146:149], v[86:89], v[126:129], 0
    ds_write_b32 v167, v166 offset:18432
    v_mul_f32 v187, 0x3baaaaab, v168
    v_mfma_f32_16x16x32_bf16 v[146:149], v[82:85], v[122:125], v[146:149]
    v_rsq_f32 v187, v187
    v_fma_f32 v216, v138, v138, s33
    v_mfma_f32_16x16x32_bf16 v[146:149], a[252:255], v[134:137], v[146:149]
    ds_read_b128 v[150:153], v2 offset:12288
    v_fmac_f32 v216, v139, v139
    v_fmac_f32 v216, v140, v140
    v_mfma_f32_16x16x32_bf16 v[146:149], a[248:251], v[198:201], v[146:149]
    ds_read_b128 v[162:165], v2 offset:13312
    v_fmac_f32 v216, v141, v141
    v_mul_f32 v170, v187, v170
    v_mfma_f32_16x16x32_bf16 v[146:149], a[244:247], v[194:197], v[146:149]
    ds_read_b128 v[174:177], v2 offset:14336
    v_mul_f32 v171, v187, v171
    v_cvt_pk_bf16_f32 v170, v170, v171
    v_mfma_f32_16x16x32_bf16 v[146:149], a[240:243], v[142:145], v[146:149]
    ds_read_b128 v[178:181], v2 offset:15360
    v_mul_f32 v172, v187, v172
    v_mul_f32 v173, v187, v173
    v_mfma_f32_16x16x32_bf16 v[206:209], v[90:93], v[142:145], 0
    ds_read_b128 v[142:145], v2 offset:16384
    v_cvt_pk_bf16_f32 v171, v172, v173
    v_mul_f32 v158, v187, v158
    v_mfma_f32_16x16x32_bf16 v[206:209], v[94:97], v[194:197], v[206:209]
    ds_read_b128 v[194:197], v2 offset:17408
    v_fmac_f32 v216, v146, v146
    v_fmac_f32 v216, v147, v147
    v_mfma_f32_16x16x32_bf16 v[206:209], v[98:101], v[198:201], v[206:209]
    s_waitcnt lgkmcnt(5)
    buffer_store_dwordx2 v[188:189], v18, s[12:15], s27 offen nt
    v_fmac_f32 v216, v148, v148
    v_mfma_f32_16x16x32_bf16 v[206:209], v[102:105], v[134:137], v[206:209]
    s_waitcnt lgkmcnt(4)
    v_fmac_f32 v216, v149, v149
    v_mul_f32 v159, v187, v159
    v_cvt_pk_bf16_f32 v172, v158, v159
    v_mfma_f32_16x16x32_bf16 v[206:209], v[106:109], v[122:125], v[206:209]
    s_waitcnt lgkmcnt(3)
    v_mul_f32 v160, v187, v160
    v_mul_f32 v161, v187, v161
    v_cvt_pk_bf16_f32 v173, v160, v161
    v_mfma_f32_16x16x32_bf16 v[206:209], v[110:113], v[126:129], v[206:209]
    s_waitcnt lgkmcnt(2)
    ds_write_b128 v114, v[170:173] offset:3072
    v_mfma_f32_16x16x32_bf16 v[122:125], a[216:219], v[150:153], 0
    s_waitcnt lgkmcnt(2)
    v_mul_f32 v238, v187, v238
    v_mul_f32 v239, v187, v239
    v_cvt_pk_bf16_f32 v188, v238, v239
    v_mfma_f32_16x16x32_bf16 v[122:125], a[220:223], v[162:165], v[122:125]
    s_waitcnt lgkmcnt(1)
    v_fmac_f32 v216, v206, v206
    v_fmac_f32 v216, v207, v207
    v_fmac_f32 v216, v208, v208
    v_mfma_f32_16x16x32_bf16 v[122:125], a[224:227], v[174:177], v[122:125]
    ds_read_b128 v[126:129], v116 offset:3072
    v_fmac_f32 v216, v209, v209
    v_cvt_pk_bf16_f32 v238, v157, v216
    v_mfma_f32_16x16x32_bf16 v[122:125], a[228:231], v[178:181], v[122:125]
    v_cvt_pk_bf16_f32 v239, v216, v216
    v_mul_f32 v240, v187, v240
    v_mul_f32 v241, v187, v241
    v_mfma_f32_16x16x32_bf16 v[122:125], a[232:235], v[142:145], v[122:125]
    ds_write_b64 v4, v[238:239] offset:0
    v_mfma_f32_16x16x32_bf16 v[122:125], a[236:239], v[194:197], v[122:125]
    v_cvt_pk_bf16_f32 v189, v240, v241
    v_mov_b32 v157, 0x40000000
    v_lshrrev_b32 v216, 2, v254
    v_mfma_f32_16x16x32_bf16 v[134:137], v[86:89], v[194:197], 0
    ds_write_b64 v115, v[188:189] offset:4096
    v_mfma_f32_16x16x32_bf16 v[134:137], v[82:85], v[142:145], v[134:137]
    v_lshrrev_b32 v217, 3, v254
    v_xor_b32 v217, v217, v254
    v_fma_f32 v254, v122, v122, s33
    v_mfma_f32_16x16x32_bf16 v[134:137], a[252:255], v[178:181], v[134:137]
    s_waitcnt lgkmcnt(2)
    ds_read_b128 v[158:161], v155 offset:0
    ds_read_b64 v[166:167], v117 offset:4096
    v_fmac_f32 v254, v123, v123
    v_mfma_f32_16x16x32_bf16 v[134:137], a[248:251], v[174:177], v[134:137]
    ds_read_b128 v[170:173], v155 offset:2048
    v_fmac_f32 v254, v124, v124
    v_fmac_f32 v254, v125, v125
    v_mfma_f32_16x16x32_bf16 v[134:137], a[244:247], v[162:165], v[134:137]
    s_waitcnt lgkmcnt(4)
    ds_read_b128 v[198:201], v155 offset:4096
    v_and_b32 v217, 3, v217
    v_add_u32 v168, 0, v216
    v_mfma_f32_16x16x32_bf16 v[134:137], a[240:243], v[150:153], v[134:137]
    s_barrier
    ds_read_b128 v[210:213], v156 offset:0
    ds_read_b128 v[218:221], v156 offset:1024
    v_mul_u32_u24 v216, s20, v168
    v_mfma_f32_16x16x32_bf16 v[222:225], v[90:93], v[150:153], 0
    ds_read_b128 v[150:153], v155 offset:6144
    ds_read_b128 v[226:229], v155 offset:8192
    v_add_u32 v216, s38, v216
    v_mfma_f32_16x16x32_bf16 v[222:225], v[94:97], v[162:165], v[222:225]
    ds_read_b128 v[162:165], v155 offset:10240
    v_fmac_f32 v254, v134, v134
    v_fmac_f32 v254, v135, v135
    v_mfma_f32_16x16x32_bf16 v[222:225], v[98:101], v[174:177], v[222:225]
    s_waitcnt lgkmcnt(7)
    buffer_store_dwordx4 v[130:133], v16, s[12:15], s27 offen nt
    ds_read_b128 v[174:177], v156 offset:18432
    v_fmac_f32 v254, v136, v136
    v_fmac_f32 v254, v137, v137
    v_mfma_f32_16x16x32_bf16 v[222:225], v[102:105], v[178:181], v[222:225]
    s_waitcnt lgkmcnt(7)
    v_mul_u32_u24 v187, 911, v216
    v_lshrrev_b32 v187, 16, v187
    v_mul_u32_u24 v187, s22, v187
    v_mfma_f32_16x16x32_bf16 v[222:225], v[106:109], v[142:145], v[222:225]
    s_waitcnt lgkmcnt(6)
    v_mad_u32_u24 v187, v168, s21, v187
    v_bfe_u32 v216, s70, v168, 1
    v_cmp_ne_u32 vcc, 0, v216
    v_mfma_f32_16x16x32_bf16 v[222:225], v[110:113], v[194:197], v[222:225]
    s_waitcnt lgkmcnt(4)
    v_add_u32 v168, s7, v187
    v_cndmask_b32 v168, v157, v168, vcc
    v_mfma_f32_16x16x32_bf16 v[130:133], v[32:35], v[210:213], 0
    s_waitcnt lgkmcnt(2)
    v_lshl_add_u32 v187, v217, 4, v168
    v_add_u32 v187, s3, v187
    v_mfma_f32_16x16x32_bf16 v[130:133], v[32:35], v[218:221], v[130:133]
    s_waitcnt lgkmcnt(1)
    v_fmac_f32 v254, v222, v222
    v_fmac_f32 v254, v223, v223
    v_fmac_f32 v254, v224, v224
    v_mfma_f32_16x16x32_bf16 v[142:145], a[216:219], v[158:161], 0
    v_fmac_f32 v254, v225, v225
    v_cvt_pk_bf16_f32 v188, v254, v254
    v_cvt_pk_bf16_f32 v189, v254, v254
    v_mfma_f32_16x16x32_bf16 v[142:145], a[220:223], v[170:173], v[142:145]
    s_waitcnt lgkmcnt(0)
    ds_write_b64 v4, v[188:189] offset:2048
    v_mfma_f32_16x16x32_bf16 v[142:145], a[224:227], v[198:201], v[142:145]
    v_lshl_add_u32 v254, v217, 3, v168
    v_add_u32 v254, s4, v254
    v_add_u32 v154, 16, v154
    v_mfma_f32_16x16x32_bf16 v[142:145], a[228:231], v[150:153], v[142:145]
    v_min_u32 v168, 20, v154
    v_add_u32 v132, 12, v154
    v_lshrrev_b32 v132, 5, v132
    v_mfma_f32_16x16x32_bf16 v[142:145], a[232:235], v[226:229], v[142:145]
    v_sub_u32 v133, v154, v168
    v_mad_i32_i24 v133, v132, s6, v133
    v_mul_u32_u24 v188, s20, v168
    v_mfma_f32_16x16x32_bf16 v[142:145], a[236:239], v[162:165], v[142:145]
    v_add3_u32 v188, v188, v133, s38
    v_mul_u32_u24 v132, 911, v188
    v_lshrrev_b32 v132, 16, v132
    v_mfma_f32_16x16x32_bf16 v[178:181], v[86:89], v[162:165], 0
    v_mul_u32_u24 v132, s22, v132
    v_mad_u32_u24 v132, v168, s21, v132
    v_bfe_u32 v188, s70, v154, 1
    v_mfma_f32_16x16x32_bf16 v[178:181], v[82:85], v[226:229], v[178:181]
    buffer_store_dwordx2 v[214:215], v19, s[12:15], s27 offen nt
    v_fma_f32 v168, v142, v142, s33
    v_mfma_f32_16x16x32_bf16 v[178:181], a[252:255], v[150:153], v[178:181]
    ds_read_b128 v[194:197], v155 offset:256
    v_fmac_f32 v168, v143, v143
    v_fmac_f32 v168, v144, v144
    v_mfma_f32_16x16x32_bf16 v[178:181], a[248:251], v[198:201], v[178:181]
    ds_read_b128 v[210:213], v155 offset:2304
    v_fmac_f32 v168, v145, v145
    v_cmp_ne_u32 vcc, 0, v188
    v_mfma_f32_16x16x32_bf16 v[178:181], a[244:247], v[170:173], v[178:181]
    ds_read_b128 v[214:217], v155 offset:4352
    v_mul_i32_i24 v133, 2688, v133
    v_add3_u32 v154, v132, v133, s7
    v_mfma_f32_16x16x32_bf16 v[178:181], a[240:243], v[158:161], v[178:181]
    ds_read_b128 v[218:221], v155 offset:6400
    v_cndmask_b32 v154, v157, v154, vcc
    v_lshl_add_u32 v188, v255, 4, v154
    v_mfma_f32_16x16x32_bf16 v[230:233], v[90:93], v[158:161], 0
    ds_read_b128 v[158:161], v155 offset:8448
    v_add_u32 v188, s3, v188
    v_lshl_add_u32 v255, v255, 3, v154
    v_mfma_f32_16x16x32_bf16 v[230:233], v[94:97], v[170:173], v[230:233]
    ds_read_b128 v[170:173], v155 offset:10496
    v_fmac_f32 v168, v178, v178
    v_fmac_f32 v168, v179, v179
    v_mfma_f32_16x16x32_bf16 v[230:233], v[98:101], v[198:201], v[230:233]
    s_waitcnt lgkmcnt(5)
    v_fmac_f32 v168, v180, v180
    v_fmac_f32 v168, v181, v181
    v_add_u32 v255, s4, v255
    v_mfma_f32_16x16x32_bf16 v[230:233], v[102:105], v[150:153], v[230:233]
    s_waitcnt lgkmcnt(4)
    v_mul_f32 v189, 0x3baaaaab, v130
    v_mul_f32 v154, 0x3baaaaab, v131
    v_rsq_f32 v189, v189
    v_mfma_f32_16x16x32_bf16 v[230:233], v[106:109], v[226:229], v[230:233]
    s_waitcnt lgkmcnt(3)
    v_mul_f32 v118, v189, v118
    v_mul_f32 v119, v189, v119
    v_cvt_pk_bf16_f32 v118, v118, v119
    v_mfma_f32_16x16x32_bf16 v[230:233], v[110:113], v[162:165], v[230:233]
    s_waitcnt lgkmcnt(2)
    v_mul_f32 v120, v189, v120
    v_mul_f32 v121, v189, v121
    v_cvt_pk_bf16_f32 v119, v120, v121
    v_mfma_f32_16x16x32_bf16 v[130:133], a[216:219], v[194:197], 0
    s_waitcnt lgkmcnt(1)
    v_mul_f32 v190, v189, v190
    v_mul_f32 v191, v189, v191
    v_fmac_f32 v168, v230, v230
    v_mfma_f32_16x16x32_bf16 v[130:133], a[220:223], v[210:213], v[130:133]
    s_waitcnt lgkmcnt(0)
    v_fmac_f32 v168, v231, v231
    v_fmac_f32 v168, v232, v232
    v_fmac_f32 v168, v233, v233
    v_mfma_f32_16x16x32_bf16 v[130:133], a[224:227], v[214:217], v[130:133]
    buffer_store_dwordx4 v[126:129], v185, s[12:15], s27 offen nt
    v_cvt_pk_bf16_f32 v150, v168, v168
    v_cvt_pk_bf16_f32 v151, v168, v168
    v_cvt_pk_bf16_f32 v120, v190, v191
    v_mfma_f32_16x16x32_bf16 v[130:133], a[228:231], v[218:221], v[130:133]
    ds_write_b64 v4, v[150:151] offset:4096
    v_mfma_f32_16x16x32_bf16 v[130:133], a[232:235], v[158:161], v[130:133]
    v_mul_f32 v192, v189, v192
    v_mul_f32 v193, v189, v193
    v_cvt_pk_bf16_f32 v121, v192, v193
    v_mfma_f32_16x16x32_bf16 v[130:133], a[236:239], v[170:173], v[130:133]
    ds_write_b128 v114, v[118:121] offset:4608
    v_mfma_f32_16x16x32_bf16 v[118:121], v[86:89], v[170:173], 0
    buffer_store_dwordx2 v[166:167], v186, s[12:15], s27 offen nt
    v_mul_f32 v202, v189, v202
    v_mfma_f32_16x16x32_bf16 v[118:121], v[82:85], v[158:161], v[118:121]
    s_mov_b32 s14, s36
    v_mul_f32 v203, v189, v203
    v_cvt_pk_bf16_f32 v202, v202, v203
    v_fma_f32 v155, v130, v130, s33
    v_mfma_f32_16x16x32_bf16 v[118:121], a[252:255], v[218:221], v[118:121]
    ds_read_b128 v[126:129], v116 offset:4608
    v_fmac_f32 v155, v131, v131
    v_fmac_f32 v155, v132, v132
    v_mfma_f32_16x16x32_bf16 v[118:121], a[248:251], v[214:217], v[118:121]
    s_waitcnt lgkmcnt(2)
    v_fmac_f32 v155, v133, v133
    v_mul_f32 v204, v189, v204
    v_mul_f32 v205, v189, v205
    v_mfma_f32_16x16x32_bf16 v[118:121], a[244:247], v[210:213], v[118:121]
    s_barrier
    ds_read_b128 v[150:153], v156 offset:2048
    ds_read_b128 v[162:165], v156 offset:3072
    v_cvt_pk_bf16_f32 v203, v204, v205
    v_mfma_f32_16x16x32_bf16 v[118:121], a[240:243], v[194:197], v[118:121]
    ds_read_b128 v[190:193], v156 offset:4096
    ds_read_b128 v[198:201], v156 offset:5120
    v_rsq_f32 v154, v154
    v_mfma_f32_16x16x32_bf16 v[226:229], v[90:93], v[194:197], 0
    ds_write_b64 v115, v[202:203] offset:5632
    v_mfma_f32_16x16x32_bf16 v[226:229], v[94:97], v[210:213], v[226:229]
    v_mul_f32 v138, v154, v138
    v_mul_f32 v139, v154, v139
    v_fmac_f32 v155, v118, v118
    v_mfma_f32_16x16x32_bf16 v[226:229], v[98:101], v[214:217], v[226:229]
    s_waitcnt lgkmcnt(5)
    buffer_store_dwordx4 v[126:129], v169, s[12:15], s26 offen nt
    ds_read_b64 v[166:167], v117 offset:5632
    v_fmac_f32 v155, v119, v119
    v_fmac_f32 v155, v120, v120
    v_mfma_f32_16x16x32_bf16 v[226:229], v[102:105], v[218:221], v[226:229]
    v_fmac_f32 v155, v121, v121
    v_cvt_pk_bf16_f32 v126, v138, v139
    v_mul_f32 v140, v154, v140
    v_mfma_f32_16x16x32_bf16 v[226:229], v[106:109], v[158:161], v[226:229]
    s_waitcnt lgkmcnt(4)
    v_mul_f32 v141, v154, v141
    v_cvt_pk_bf16_f32 v127, v140, v141
    v_mfma_f32_16x16x32_bf16 v[138:141], v[32:35], v[150:153], 0
    s_waitcnt lgkmcnt(2)
    v_mul_f32 v146, v154, v146
    v_mul_f32 v147, v154, v147
    v_mfma_f32_16x16x32_bf16 v[138:141], v[32:35], v[162:165], v[138:141]
    v_cvt_pk_bf16_f32 v128, v146, v147
    v_mul_f32 v148, v154, v148
    v_mfma_f32_16x16x32_bf16 v[150:153], v[32:35], v[190:193], 0
    v_mul_f32 v149, v154, v149
    v_cvt_pk_bf16_f32 v129, v148, v149
    v_mfma_f32_16x16x32_bf16 v[150:153], v[32:35], v[198:201], v[150:153]
    ds_write_b128 v114, v[126:129] offset:6144
    v_mfma_f32_16x16x32_bf16 v[226:229], v[110:113], v[170:173], v[226:229]
    s_waitcnt lgkmcnt(1)
    buffer_store_dwordx2 v[166:167], v182, s[12:15], s26 offen nt
    v_mul_f32 v206, v154, v206
    v_mul_f32 v207, v154, v207
    v_cvt_pk_bf16_f32 v206, v206, v207
    ds_read_b128 v[126:129], v116 offset:6144
    v_mul_f32 v208, v154, v208
    v_mul_f32 v209, v154, v209
    v_fmac_f32 v155, v226, v226
    v_fmac_f32 v155, v227, v227
    v_fmac_f32 v155, v228, v228
    v_fmac_f32 v155, v229, v229
    v_cvt_pk_bf16_f32 v154, v155, v155
    v_cvt_pk_bf16_f32 v155, v155, v155
    ds_write_b64 v4, v[154:155] offset:6144
    v_cvt_pk_bf16_f32 v207, v208, v209
    v_mul_f32 v189, 0x3baaaaab, v138
    v_rsq_f32 v189, v189
    ds_write_b64 v115, v[206:207] offset:7168
    v_mul_f32 v122, v189, v122
    v_mul_f32 v123, v189, v123
    v_cvt_pk_bf16_f32 v122, v122, v123
    ds_read_b64 v[152:153], v117 offset:7168
    s_waitcnt lgkmcnt(3)
    buffer_store_dwordx4 v[126:129], v183, s[12:15], s26 offen nt
    v_mul_f32 v124, v189, v124
    v_mul_f32 v125, v189, v125
    v_cvt_pk_bf16_f32 v123, v124, v125
    v_mul_f32 v134, v189, v134
    v_mul_f32 v135, v189, v135
    v_cvt_pk_bf16_f32 v124, v134, v135
    v_mul_f32 v136, v189, v136
    s_waitcnt lgkmcnt(2)
    s_barrier
    ds_read_b128 v[126:129], v156 offset:6144
    ds_read_b128 v[138:141], v156 offset:7168
    v_mul_f32 v137, v189, v137
    v_cvt_pk_bf16_f32 v125, v136, v137
    ds_write_b128 v114, v[122:125] offset:0
    v_mul_f32 v222, v189, v222
    v_mul_f32 v223, v189, v223
    v_cvt_pk_bf16_f32 v222, v222, v223
    v_mul_f32 v224, v189, v224
    s_waitcnt lgkmcnt(3)
    buffer_store_dwordx2 v[152:153], v184, s[12:15], s26 offen nt
    ds_read_b128 v[122:125], v116 offset:0
    v_mul_f32 v225, v189, v225
    v_cvt_pk_bf16_f32 v223, v224, v225
    ds_write_b64 v115, v[222:223] offset:1024
    s_waitcnt lgkmcnt(4)
    v_mfma_f32_16x16x32_bf16 v[134:137], v[32:35], v[126:129], 0
    s_waitcnt lgkmcnt(3)
    v_mul_f32 v189, 0x3baaaaab, v150
    v_or3_b32 v174, v174, v175, v176
    v_mfma_f32_16x16x32_bf16 v[134:137], v[32:35], v[138:141], v[134:137]
    ds_read_b64 v[182:183], v117 offset:1024
    v_rsq_f32 v189, v189
    v_or_b32 v174, v174, v177
    v_mul_f32 v142, v189, v142
    v_mul_f32 v143, v189, v143
    v_cvt_pk_bf16_f32 v126, v142, v143
    v_mul_f32 v144, v189, v144
    v_mul_f32 v145, v189, v145
    v_cvt_pk_bf16_f32 v127, v144, v145
    v_mul_f32 v178, v189, v178
    v_mul_f32 v179, v189, v179
    v_cvt_pk_bf16_f32 v128, v178, v179
    s_waitcnt lgkmcnt(2)
    buffer_store_dwordx4 v[122:125], v185, s[12:15], s26 offen nt
    v_mul_f32 v180, v189, v180
    v_mul_f32 v181, v189, v181
    v_cvt_pk_bf16_f32 v129, v180, v181
    ds_write_b128 v114, v[126:129] offset:1536
    v_mul_f32 v230, v189, v230
    s_waitcnt lgkmcnt(1)
    v_mul_f32 v231, v189, v231
    v_cvt_pk_bf16_f32 v184, v230, v231
    v_mul_f32 v232, v189, v232
    v_mul_f32 v233, v189, v233
    buffer_store_dwordx2 v[182:183], v186, s[12:15], s26 offen nt
    ds_read_b128 v[122:125], v116 offset:1536
    v_cvt_pk_bf16_f32 v185, v232, v233
    ds_write_b64 v115, v[184:185] offset:2560
    v_mul_f32 v186, 0x3baaaaab, v134
    v_rsq_f32 v186, v186
    ds_read_b64 v[176:177], v117 offset:2560
    v_mul_f32 v130, v186, v130
    v_mul_f32 v131, v186, v131
    v_cvt_pk_bf16_f32 v114, v130, v131
    v_mul_f32 v132, v186, v132
    v_mul_f32 v133, v186, v133
    v_cvt_pk_bf16_f32 v115, v132, v133
    v_mul_f32 v118, v186, v118
    v_mul_f32 v119, v186, v119
    v_cvt_pk_bf16_f32 v116, v118, v119
    v_mul_f32 v120, v186, v120
    v_mul_f32 v121, v186, v121
    v_cvt_pk_bf16_f32 v117, v120, v121
    buffer_store_dwordx4 v[114:117], v188, s[12:15], 0 offen nt
    s_waitcnt lgkmcnt(2)
    v_mul_f32 v226, v186, v226
    v_mul_f32 v227, v186, v227
    v_cvt_pk_bf16_f32 v188, v226, v227
    v_mul_f32 v228, v186, v228
    v_mul_f32 v229, v186, v229
    v_cvt_pk_bf16_f32 v189, v228, v229
    v_cmp_gt_i32 s[46:47], 0, v174
    s_waitcnt lgkmcnt(0)
    buffer_store_dwordx4 v[122:125], v187, s[12:15], 0 offen nt
    buffer_store_dwordx2 v[176:177], v254, s[12:15], 0 offen nt
    buffer_store_dwordx2 v[188:189], v255, s[12:15], 0 offen nt
    s_branch L_end
.section .rodata,"a"
.p2align 6
.amdhsa_kernel standalone__window_attn_swin_v2__vision_kernel
  .amdhsa_next_free_vgpr 512
  .amdhsa_next_free_sgpr 102
  .amdhsa_accum_offset 256
  .amdhsa_group_segment_fixed_size 0
  .amdhsa_kernarg_size 96
  .amdhsa_user_sgpr_count 2
  .amdhsa_user_sgpr_kernarg_segment_ptr 1
  .amdhsa_system_sgpr_workgroup_id_x 1
  .amdhsa_float_denorm_mode_32 3
.end_amdhsa_kernel
```
